```python
import torch

def _softmax(x, axis=-1):
    return torch.softmax(x, dim=axis)
def _gelu(x):
    return torch.nn.functional.gelu(x, approximate="tanh")
def _silu(x):
    return torch.nn.functional.silu(x)
def _sigmoid(x):
    return torch.sigmoid(x)
def _layernorm(x, axis=-1, eps=1e-5):
    m = x.mean(dim=axis, keepdim=True)
    v = x.var(dim=axis, keepdim=True, unbiased=False)
    return (x - m) / torch.sqrt(v + eps)
def _scatter_add(tgt, idx, src, axis=0):
    return tgt.clone().index_add_(axis, idx, src)
def _segment_sum(src, seg, n):
    out = torch.zeros((n,) + src.shape[1:], dtype=src.dtype)
    return out.index_add_(0, seg, src)
def _pad(x, pw):
    flat = tuple(v for pair in reversed(pw) for v in pair)
    return torch.nn.functional.pad(x, flat)

kernel_name = 'sequential_preLN__sliding_local_dilated__glu_gated_geglu__prompt'

def setup_inputs():

    _w = (lambda a: (lambda t: t.to(torch.bfloat16) if t.is_floating_point() else t)(torch.as_tensor(a)))
    def _A_setup():
        B, S, D = 1, 2048, 1024
        return {
            "x": _w((lambda *s: torch.randn(*s, dtype=torch.bfloat16) * 0.05)(B, S, D)),
            "wqkv": _w((lambda *s: torch.randn(*s, dtype=torch.bfloat16) * 0.05)(D, 3 * D)),
            "wo": _w((lambda *s: torch.randn(*s, dtype=torch.bfloat16) * 0.05)(D, D)),
        }
    _A_in = _A_setup()

    def _B_setup():
        B, S, Dm, Df = 1, 2048, 1024, 3584
        return {
            "x": _w((lambda *s: torch.randn(*s, dtype=torch.bfloat16) * 0.05)(B, S, Dm)),
            "w_gate": _w((lambda *s: torch.randn(*s, dtype=torch.bfloat16) * 0.8)(Dm, Df) * (Dm ** -0.5)),
            "w_up": _w((lambda *s: torch.randn(*s, dtype=torch.bfloat16) * 0.8)(Dm, Df) * (Dm ** -0.5)),
            "w_down": _w((lambda *s: torch.randn(*s, dtype=torch.bfloat16) * 0.8)(Df, Dm) * (Df ** -0.5)),
        }
    _B_in = _B_setup()

    return {
        "A_x": _A_in["x"],
        "A_wqkv": _A_in["wqkv"],
        "A_wo": _A_in["wo"],
        "B_x": _B_in["x"],
        "B_w_gate": _B_in["w_gate"],
        "B_w_up": _B_in["w_up"],
        "B_w_down": _B_in["w_down"],
    }

def reference(A_x, A_wqkv, A_wo, B_x, B_w_gate, B_w_up, B_w_down):
    def _A_ref(x, wqkv, wo):
        B, S, D = x.shape
        H = 32; Dh = D // H
        W, dil = 8, 2
        qkv = (lambda x, *d: x.permute(*d))((x @ wqkv).reshape(B, S, 3, H, Dh), 2, 0, 3, 1, 4)
        q, k, v = qkv[0], qkv[1], qkv[2]
        scale = Dh ** -0.5
        pos = torch.arange(S)
        off = torch.arange(W) * dil
        idx = pos[:, None] - off[None, :]
        mask = idx >= 0
        idx_c = torch.where(mask, idx, 0).reshape(-1)
        kg = k[:, :, idx_c, :].reshape(B, H, S, W, Dh)
        vg = v[:, :, idx_c, :].reshape(B, H, S, W, Dh)
        logits = torch.einsum("bhsd,bhswd->bhsw", q, kg) * scale
        logits = torch.where(mask[None, None, :, :], logits, -1e9)
        attn = _softmax(logits, axis=-1)
        o = torch.einsum("bhsw,bhswd->bhsd", attn, vg)
        return (lambda x, *d: x.permute(*d))(o, 0, 2, 1, 3).reshape(B, S, D) @ wo

    def _B_ref(x, w_gate, w_up, w_down):
        g = torch.einsum("bsd,df->bsf", x, w_gate)
        u = torch.einsum("bsd,df->bsf", x, w_up)
        h = _gelu(g) * u
        return torch.einsum("bsf,fd->bsd", h, w_down)

    x = A_x
    h = x + _A_ref(_layernorm(x, axis=-1), A_wqkv, A_wo)
    h2 = h + _B_ref(_layernorm(h, axis=-1), B_w_gate, B_w_up, B_w_down)
    return h2
```

```asm
; @launch grid=(256,1,1) block=(512,1,1) lds=163840
.amdgcn_target "amdgcn-amd-amdhsa--gfx950"
.text
.globl sequential_preLN__sliding_local_dilated__glu_gated_geglu__prompt_kernel
.p2align 8
.type sequential_preLN__sliding_local_dilated__glu_gated_geglu__prompt_kernel,@function
sequential_preLN__sliding_local_dilated__glu_gated_geglu__prompt_kernel:
s_cmp_ge_u32 s2, 256
s_cbranch_scc1 Lexit_2
s_load_dwordx16 s[64:79], s[0:1], 0
s_load_dwordx4 s[80:83], s[0:1], 64
s_and_b32 s3, s2, 7
s_lshr_b32 s42, s2, 3
s_and_b32 s34, s3, 1
s_lshl_b32 s34, s34, 3
s_and_b32 s48, s42, 7
s_add_u32 s34, s34, s48
s_lshr_b32 s35, s3, 1
s_lshr_b32 s49, s42, 3
s_lshl_b32 s35, s35, 2
s_add_u32 s35, s35, s49
v_lshrrev_b32 v12, 6, v0
v_and_b32 v1, 63, v0
v_readfirstlane_b32 s36, v12
s_lshl_b32 s43, s35, 7
s_lshl_b32 s50, s34, 7
s_sub_u32 s50, s50, 16
s_waitcnt lgkmcnt(0)
s_mov_b32 s8, s64
s_mov_b32 s9, s65
s_mov_b32 s10, 4194304
s_mov_b32 s11, 0x20000
s_add_u32 s12, s66, s43
s_addc_u32 s13, s67, 0
s_mov_b32 s14, 6289536
s_mov_b32 s15, 0x20000
v_and_b32 v12, 15, v1
v_lshrrev_b32 v13, 4, v1
s_cmp_ge_u32 s36, 4
s_cbranch_scc1 Lprod_3
v_lshrrev_b32 v16, 1, v12
v_xor_b32 v15, v13, v16
v_lshlrev_b32 v15, 4, v15
v_lshl_add_u32 v2, v12, 7, v15
v_xor_b32 v3, 64, v2
v_add_u32 v4, 86016, v2
v_add_u32 v5, 86016, v3
v_lshrrev_b32 v15, 2, v12
v_and_b32 v16, 3, v1
v_lshl_add_u32 v19, v13, 3, v15
v_lshlrev_b32 v19, 7, v19
v_and_b32 v15, 2, v15
v_and_b32 v17, 1, v13
v_lshl_add_u32 v15, v17, 2, v15
v_lshrrev_b32 v17, 1, v16
s_lshl_b32 s43, s36, 1
v_add_u32 v17, s43, v17
v_xor_b32 v15, v15, v17
v_lshl_add_u32 v19, v15, 4, v19
v_and_b32 v16, 1, v16
v_lshl_add_u32 v19, v16, 3, v19
v_add_u32 v6, 18432, v19
v_add_u32 v7, 61440, v19
v_add_u32 v8, 104448, v19
v_mov_b32 v128, 0
v_mov_b32 v129, 0
v_mov_b32 v130, 0
v_mov_b32 v131, 0
v_mov_b32 v132, 0
v_mov_b32 v133, 0
v_mov_b32 v134, 0
v_mov_b32 v135, 0
v_mov_b32 v136, 0
v_mov_b32 v137, 0
v_mov_b32 v138, 0
v_mov_b32 v139, 0
v_mov_b32 v140, 0
v_mov_b32 v141, 0
v_mov_b32 v142, 0
v_mov_b32 v143, 0
v_mov_b32 v144, 0
v_mov_b32 v145, 0
v_mov_b32 v146, 0
v_mov_b32 v147, 0
v_mov_b32 v148, 0
v_mov_b32 v149, 0
v_mov_b32 v150, 0
v_mov_b32 v151, 0
v_mov_b32 v152, 0
v_mov_b32 v153, 0
v_mov_b32 v154, 0
v_mov_b32 v155, 0
v_mov_b32 v156, 0
v_mov_b32 v157, 0
v_mov_b32 v158, 0
v_mov_b32 v159, 0
v_mov_b32 v160, 0
v_mov_b32 v161, 0
v_mov_b32 v162, 0
v_mov_b32 v163, 0
v_mov_b32 v164, 0
v_mov_b32 v165, 0
v_mov_b32 v166, 0
v_mov_b32 v167, 0
v_mov_b32 v168, 0
v_mov_b32 v169, 0
v_mov_b32 v170, 0
v_mov_b32 v171, 0
v_mov_b32 v172, 0
v_mov_b32 v173, 0
v_mov_b32 v174, 0
v_mov_b32 v175, 0
v_mov_b32 v176, 0
v_mov_b32 v177, 0
v_mov_b32 v178, 0
v_mov_b32 v179, 0
v_mov_b32 v180, 0
v_mov_b32 v181, 0
v_mov_b32 v182, 0
v_mov_b32 v183, 0
v_mov_b32 v184, 0
v_mov_b32 v185, 0
v_mov_b32 v186, 0
v_mov_b32 v187, 0
v_mov_b32 v188, 0
v_mov_b32 v189, 0
v_mov_b32 v190, 0
v_mov_b32 v191, 0
v_mov_b32 v192, 0
v_mov_b32 v193, 0
v_mov_b32 v194, 0
v_mov_b32 v195, 0
v_mov_b32 v196, 0
v_mov_b32 v197, 0
v_mov_b32 v198, 0
v_mov_b32 v199, 0
v_mov_b32 v200, 0
v_mov_b32 v201, 0
v_mov_b32 v202, 0
v_mov_b32 v203, 0
v_mov_b32 v204, 0
v_mov_b32 v205, 0
v_mov_b32 v206, 0
v_mov_b32 v207, 0
v_mov_b32 v208, 0
v_mov_b32 v209, 0
v_mov_b32 v210, 0
v_mov_b32 v211, 0
v_mov_b32 v212, 0
v_mov_b32 v213, 0
v_mov_b32 v214, 0
v_mov_b32 v215, 0
v_mov_b32 v216, 0
v_mov_b32 v217, 0
v_mov_b32 v218, 0
v_mov_b32 v219, 0
v_mov_b32 v220, 0
v_mov_b32 v221, 0
v_mov_b32 v222, 0
v_mov_b32 v223, 0
v_mov_b32 v224, 0
v_mov_b32 v225, 0
v_mov_b32 v226, 0
v_mov_b32 v227, 0
v_mov_b32 v228, 0
v_mov_b32 v229, 0
v_mov_b32 v230, 0
v_mov_b32 v231, 0
v_mov_b32 v232, 0
v_mov_b32 v233, 0
v_mov_b32 v234, 0
v_mov_b32 v235, 0
s_barrier
ds_read_b128 v[32:35], v2 offset:0
ds_read_b64_tr_b16 v[72:73], v6 offset:8192
ds_read_b64_tr_b16 v[74:75], v6 offset:8704
ds_read_b64_tr_b16 v[76:77], v6 offset:16384
ds_read_b64_tr_b16 v[78:79], v6 offset:16896
ds_read_b64_tr_b16 v[68:69], v6 offset:0
ds_read_b64_tr_b16 v[70:71], v6 offset:512
ds_read_b128 v[36:39], v2 offset:2048
ds_read_b128 v[40:43], v2 offset:4096
ds_read_b128 v[44:47], v2 offset:6144
ds_read_b128 v[48:51], v2 offset:8192
ds_read_b128 v[52:55], v2 offset:10240
ds_read_b128 v[56:59], v2 offset:12288
ds_read_b128 v[60:63], v2 offset:14336
ds_read_b128 v[64:67], v2 offset:16384
s_mov_b32 s41, 5
Lcl_6:
s_waitcnt lgkmcnt(0)
v_mfma_f32_16x16x32_bf16 v[164:167], v[72:75], v[32:35], v[164:167]
ds_read_b128 v[80:83], v3 offset:0
v_mfma_f32_16x16x32_bf16 v[200:203], v[76:79], v[32:35], v[200:203]
ds_read_b64_tr_b16 v[120:121], v6 offset:12288
v_mfma_f32_16x16x32_bf16 v[128:131], v[68:71], v[32:35], v[128:131]
ds_read_b64_tr_b16 v[122:123], v6 offset:12800
v_mfma_f32_16x16x32_bf16 v[132:135], v[68:71], v[36:39], v[132:135]
ds_read_b64_tr_b16 v[124:125], v6 offset:20480
v_mfma_f32_16x16x32_bf16 v[204:207], v[76:79], v[36:39], v[204:207]
ds_read_b64_tr_b16 v[126:127], v6 offset:20992
v_mfma_f32_16x16x32_bf16 v[168:171], v[72:75], v[36:39], v[168:171]
ds_read_b64_tr_b16 v[116:117], v6 offset:4096
v_mfma_f32_16x16x32_bf16 v[172:175], v[72:75], v[40:43], v[172:175]
ds_read_b64_tr_b16 v[118:119], v6 offset:4608
v_mfma_f32_16x16x32_bf16 v[208:211], v[76:79], v[40:43], v[208:211]
ds_read_b128 v[84:87], v3 offset:2048
v_mfma_f32_16x16x32_bf16 v[136:139], v[68:71], v[40:43], v[136:139]
ds_read_b128 v[88:91], v3 offset:4096
v_mfma_f32_16x16x32_bf16 v[140:143], v[68:71], v[44:47], v[140:143]
ds_read_b128 v[92:95], v3 offset:6144
v_mfma_f32_16x16x32_bf16 v[212:215], v[76:79], v[44:47], v[212:215]
ds_read_b128 v[96:99], v3 offset:8192
v_mfma_f32_16x16x32_bf16 v[176:179], v[72:75], v[44:47], v[176:179]
ds_read_b128 v[100:103], v3 offset:10240
v_mfma_f32_16x16x32_bf16 v[180:183], v[72:75], v[48:51], v[180:183]
ds_read_b128 v[104:107], v3 offset:12288
v_mfma_f32_16x16x32_bf16 v[216:219], v[76:79], v[48:51], v[216:219]
ds_read_b128 v[108:111], v3 offset:14336
v_mfma_f32_16x16x32_bf16 v[144:147], v[68:71], v[48:51], v[144:147]
ds_read_b128 v[112:115], v3 offset:16384
v_mfma_f32_16x16x32_bf16 v[148:151], v[68:71], v[52:55], v[148:151]
v_mfma_f32_16x16x32_bf16 v[220:223], v[76:79], v[52:55], v[220:223]
v_mfma_f32_16x16x32_bf16 v[184:187], v[72:75], v[52:55], v[184:187]
v_mfma_f32_16x16x32_bf16 v[188:191], v[72:75], v[56:59], v[188:191]
v_mfma_f32_16x16x32_bf16 v[224:227], v[76:79], v[56:59], v[224:227]
v_mfma_f32_16x16x32_bf16 v[152:155], v[68:71], v[56:59], v[152:155]
v_mfma_f32_16x16x32_bf16 v[156:159], v[68:71], v[60:63], v[156:159]
v_mfma_f32_16x16x32_bf16 v[228:231], v[76:79], v[60:63], v[228:231]
v_mfma_f32_16x16x32_bf16 v[192:195], v[72:75], v[60:63], v[192:195]
v_mfma_f32_16x16x32_bf16 v[196:199], v[72:75], v[64:67], v[196:199]
v_mfma_f32_16x16x32_bf16 v[232:235], v[76:79], v[64:67], v[232:235]
v_mfma_f32_16x16x32_bf16 v[160:163], v[68:71], v[64:67], v[160:163]
s_waitcnt lgkmcnt(0)
s_barrier
v_mfma_f32_16x16x32_bf16 v[164:167], v[120:123], v[80:83], v[164:167]
ds_read_b128 v[32:35], v2 offset:43008
v_mfma_f32_16x16x32_bf16 v[200:203], v[124:127], v[80:83], v[200:203]
ds_read_b64_tr_b16 v[72:73], v7 offset:8192
v_mfma_f32_16x16x32_bf16 v[128:131], v[116:119], v[80:83], v[128:131]
ds_read_b64_tr_b16 v[74:75], v7 offset:8704
v_mfma_f32_16x16x32_bf16 v[132:135], v[116:119], v[84:87], v[132:135]
ds_read_b64_tr_b16 v[76:77], v7 offset:16384
v_mfma_f32_16x16x32_bf16 v[204:207], v[124:127], v[84:87], v[204:207]
ds_read_b64_tr_b16 v[78:79], v7 offset:16896
v_mfma_f32_16x16x32_bf16 v[168:171], v[120:123], v[84:87], v[168:171]
ds_read_b64_tr_b16 v[68:69], v7 offset:0
v_mfma_f32_16x16x32_bf16 v[172:175], v[120:123], v[88:91], v[172:175]
ds_read_b64_tr_b16 v[70:71], v7 offset:512
v_mfma_f32_16x16x32_bf16 v[208:211], v[124:127], v[88:91], v[208:211]
ds_read_b128 v[36:39], v2 offset:45056
v_mfma_f32_16x16x32_bf16 v[136:139], v[116:119], v[88:91], v[136:139]
ds_read_b128 v[40:43], v2 offset:47104
v_mfma_f32_16x16x32_bf16 v[140:143], v[116:119], v[92:95], v[140:143]
ds_read_b128 v[44:47], v2 offset:49152
v_mfma_f32_16x16x32_bf16 v[212:215], v[124:127], v[92:95], v[212:215]
ds_read_b128 v[48:51], v2 offset:51200
v_mfma_f32_16x16x32_bf16 v[176:179], v[120:123], v[92:95], v[176:179]
ds_read_b128 v[52:55], v2 offset:53248
v_mfma_f32_16x16x32_bf16 v[180:183], v[120:123], v[96:99], v[180:183]
ds_read_b128 v[56:59], v2 offset:55296
v_mfma_f32_16x16x32_bf16 v[216:219], v[124:127], v[96:99], v[216:219]
ds_read_b128 v[60:63], v2 offset:57344
v_mfma_f32_16x16x32_bf16 v[144:147], v[116:119], v[96:99], v[144:147]
ds_read_b128 v[64:67], v2 offset:59392
v_mfma_f32_16x16x32_bf16 v[148:151], v[116:119], v[100:103], v[148:151]
v_mfma_f32_16x16x32_bf16 v[220:223], v[124:127], v[100:103], v[220:223]
v_mfma_f32_16x16x32_bf16 v[184:187], v[120:123], v[100:103], v[184:187]
v_mfma_f32_16x16x32_bf16 v[188:191], v[120:123], v[104:107], v[188:191]
v_mfma_f32_16x16x32_bf16 v[224:227], v[124:127], v[104:107], v[224:227]
v_mfma_f32_16x16x32_bf16 v[152:155], v[116:119], v[104:107], v[152:155]
v_mfma_f32_16x16x32_bf16 v[156:159], v[116:119], v[108:111], v[156:159]
v_mfma_f32_16x16x32_bf16 v[228:231], v[124:127], v[108:111], v[228:231]
v_mfma_f32_16x16x32_bf16 v[192:195], v[120:123], v[108:111], v[192:195]
v_mfma_f32_16x16x32_bf16 v[196:199], v[120:123], v[112:115], v[196:199]
v_mfma_f32_16x16x32_bf16 v[232:235], v[124:127], v[112:115], v[232:235]
v_mfma_f32_16x16x32_bf16 v[160:163], v[116:119], v[112:115], v[160:163]
s_waitcnt lgkmcnt(0)
v_mfma_f32_16x16x32_bf16 v[164:167], v[72:75], v[32:35], v[164:167]
ds_read_b128 v[80:83], v3 offset:43008
v_mfma_f32_16x16x32_bf16 v[200:203], v[76:79], v[32:35], v[200:203]
ds_read_b64_tr_b16 v[120:121], v7 offset:12288
v_mfma_f32_16x16x32_bf16 v[128:131], v[68:71], v[32:35], v[128:131]
ds_read_b64_tr_b16 v[122:123], v7 offset:12800
v_mfma_f32_16x16x32_bf16 v[132:135], v[68:71], v[36:39], v[132:135]
ds_read_b64_tr_b16 v[124:125], v7 offset:20480
v_mfma_f32_16x16x32_bf16 v[204:207], v[76:79], v[36:39], v[204:207]
ds_read_b64_tr_b16 v[126:127], v7 offset:20992
v_mfma_f32_16x16x32_bf16 v[168:171], v[72:75], v[36:39], v[168:171]
ds_read_b64_tr_b16 v[116:117], v7 offset:4096
v_mfma_f32_16x16x32_bf16 v[172:175], v[72:75], v[40:43], v[172:175]
ds_read_b64_tr_b16 v[118:119], v7 offset:4608
v_mfma_f32_16x16x32_bf16 v[208:211], v[76:79], v[40:43], v[208:211]
ds_read_b128 v[84:87], v3 offset:45056
v_mfma_f32_16x16x32_bf16 v[136:139], v[68:71], v[40:43], v[136:139]
ds_read_b128 v[88:91], v3 offset:47104
v_mfma_f32_16x16x32_bf16 v[140:143], v[68:71], v[44:47], v[140:143]
ds_read_b128 v[92:95], v3 offset:49152
v_mfma_f32_16x16x32_bf16 v[212:215], v[76:79], v[44:47], v[212:215]
ds_read_b128 v[96:99], v3 offset:51200
v_mfma_f32_16x16x32_bf16 v[176:179], v[72:75], v[44:47], v[176:179]
ds_read_b128 v[100:103], v3 offset:53248
v_mfma_f32_16x16x32_bf16 v[180:183], v[72:75], v[48:51], v[180:183]
ds_read_b128 v[104:107], v3 offset:55296
v_mfma_f32_16x16x32_bf16 v[216:219], v[76:79], v[48:51], v[216:219]
ds_read_b128 v[108:111], v3 offset:57344
v_mfma_f32_16x16x32_bf16 v[144:147], v[68:71], v[48:51], v[144:147]
ds_read_b128 v[112:115], v3 offset:59392
v_mfma_f32_16x16x32_bf16 v[148:151], v[68:71], v[52:55], v[148:151]
v_mfma_f32_16x16x32_bf16 v[220:223], v[76:79], v[52:55], v[220:223]
v_mfma_f32_16x16x32_bf16 v[184:187], v[72:75], v[52:55], v[184:187]
v_mfma_f32_16x16x32_bf16 v[188:191], v[72:75], v[56:59], v[188:191]
v_mfma_f32_16x16x32_bf16 v[224:227], v[76:79], v[56:59], v[224:227]
v_mfma_f32_16x16x32_bf16 v[152:155], v[68:71], v[56:59], v[152:155]
v_mfma_f32_16x16x32_bf16 v[156:159], v[68:71], v[60:63], v[156:159]
v_mfma_f32_16x16x32_bf16 v[228:231], v[76:79], v[60:63], v[228:231]
v_mfma_f32_16x16x32_bf16 v[192:195], v[72:75], v[60:63], v[192:195]
v_mfma_f32_16x16x32_bf16 v[196:199], v[72:75], v[64:67], v[196:199]
v_mfma_f32_16x16x32_bf16 v[232:235], v[76:79], v[64:67], v[232:235]
v_mfma_f32_16x16x32_bf16 v[160:163], v[68:71], v[64:67], v[160:163]
s_waitcnt lgkmcnt(0)
s_barrier
v_mfma_f32_16x16x32_bf16 v[164:167], v[120:123], v[80:83], v[164:167]
ds_read_b128 v[32:35], v4 offset:0
v_mfma_f32_16x16x32_bf16 v[200:203], v[124:127], v[80:83], v[200:203]
ds_read_b64_tr_b16 v[72:73], v8 offset:8192
v_mfma_f32_16x16x32_bf16 v[128:131], v[116:119], v[80:83], v[128:131]
ds_read_b64_tr_b16 v[74:75], v8 offset:8704
v_mfma_f32_16x16x32_bf16 v[132:135], v[116:119], v[84:87], v[132:135]
ds_read_b64_tr_b16 v[76:77], v8 offset:16384
v_mfma_f32_16x16x32_bf16 v[204:207], v[124:127], v[84:87], v[204:207]
ds_read_b64_tr_b16 v[78:79], v8 offset:16896
v_mfma_f32_16x16x32_bf16 v[168:171], v[120:123], v[84:87], v[168:171]
ds_read_b64_tr_b16 v[68:69], v8 offset:0
v_mfma_f32_16x16x32_bf16 v[172:175], v[120:123], v[88:91], v[172:175]
ds_read_b64_tr_b16 v[70:71], v8 offset:512
v_mfma_f32_16x16x32_bf16 v[208:211], v[124:127], v[88:91], v[208:211]
ds_read_b128 v[36:39], v4 offset:2048
v_mfma_f32_16x16x32_bf16 v[136:139], v[116:119], v[88:91], v[136:139]
ds_read_b128 v[40:43], v4 offset:4096
v_mfma_f32_16x16x32_bf16 v[140:143], v[116:119], v[92:95], v[140:143]
ds_read_b128 v[44:47], v4 offset:6144
v_mfma_f32_16x16x32_bf16 v[212:215], v[124:127], v[92:95], v[212:215]
ds_read_b128 v[48:51], v4 offset:8192
v_mfma_f32_16x16x32_bf16 v[176:179], v[120:123], v[92:95], v[176:179]
ds_read_b128 v[52:55], v4 offset:10240
v_mfma_f32_16x16x32_bf16 v[180:183], v[120:123], v[96:99], v[180:183]
ds_read_b128 v[56:59], v4 offset:12288
v_mfma_f32_16x16x32_bf16 v[216:219], v[124:127], v[96:99], v[216:219]
ds_read_b128 v[60:63], v4 offset:14336
v_mfma_f32_16x16x32_bf16 v[144:147], v[116:119], v[96:99], v[144:147]
ds_read_b128 v[64:67], v4 offset:16384
v_mfma_f32_16x16x32_bf16 v[148:151], v[116:119], v[100:103], v[148:151]
v_mfma_f32_16x16x32_bf16 v[220:223], v[124:127], v[100:103], v[220:223]
v_mfma_f32_16x16x32_bf16 v[184:187], v[120:123], v[100:103], v[184:187]
v_mfma_f32_16x16x32_bf16 v[188:191], v[120:123], v[104:107], v[188:191]
v_mfma_f32_16x16x32_bf16 v[224:227], v[124:127], v[104:107], v[224:227]
v_mfma_f32_16x16x32_bf16 v[152:155], v[116:119], v[104:107], v[152:155]
v_mfma_f32_16x16x32_bf16 v[156:159], v[116:119], v[108:111], v[156:159]
v_mfma_f32_16x16x32_bf16 v[228:231], v[124:127], v[108:111], v[228:231]
v_mfma_f32_16x16x32_bf16 v[192:195], v[120:123], v[108:111], v[192:195]
v_mfma_f32_16x16x32_bf16 v[196:199], v[120:123], v[112:115], v[196:199]
v_mfma_f32_16x16x32_bf16 v[232:235], v[124:127], v[112:115], v[232:235]
v_mfma_f32_16x16x32_bf16 v[160:163], v[116:119], v[112:115], v[160:163]
s_waitcnt lgkmcnt(0)
v_mfma_f32_16x16x32_bf16 v[164:167], v[72:75], v[32:35], v[164:167]
ds_read_b128 v[80:83], v5 offset:0
v_mfma_f32_16x16x32_bf16 v[200:203], v[76:79], v[32:35], v[200:203]
ds_read_b64_tr_b16 v[120:121], v8 offset:12288
v_mfma_f32_16x16x32_bf16 v[128:131], v[68:71], v[32:35], v[128:131]
ds_read_b64_tr_b16 v[122:123], v8 offset:12800
v_mfma_f32_16x16x32_bf16 v[132:135], v[68:71], v[36:39], v[132:135]
ds_read_b64_tr_b16 v[124:125], v8 offset:20480
v_mfma_f32_16x16x32_bf16 v[204:207], v[76:79], v[36:39], v[204:207]
ds_read_b64_tr_b16 v[126:127], v8 offset:20992
v_mfma_f32_16x16x32_bf16 v[168:171], v[72:75], v[36:39], v[168:171]
ds_read_b64_tr_b16 v[116:117], v8 offset:4096
v_mfma_f32_16x16x32_bf16 v[172:175], v[72:75], v[40:43], v[172:175]
ds_read_b64_tr_b16 v[118:119], v8 offset:4608
v_mfma_f32_16x16x32_bf16 v[208:211], v[76:79], v[40:43], v[208:211]
ds_read_b128 v[84:87], v5 offset:2048
v_mfma_f32_16x16x32_bf16 v[136:139], v[68:71], v[40:43], v[136:139]
ds_read_b128 v[88:91], v5 offset:4096
v_mfma_f32_16x16x32_bf16 v[140:143], v[68:71], v[44:47], v[140:143]
ds_read_b128 v[92:95], v5 offset:6144
v_mfma_f32_16x16x32_bf16 v[212:215], v[76:79], v[44:47], v[212:215]
ds_read_b128 v[96:99], v5 offset:8192
v_mfma_f32_16x16x32_bf16 v[176:179], v[72:75], v[44:47], v[176:179]
ds_read_b128 v[100:103], v5 offset:10240
v_mfma_f32_16x16x32_bf16 v[180:183], v[72:75], v[48:51], v[180:183]
ds_read_b128 v[104:107], v5 offset:12288
v_mfma_f32_16x16x32_bf16 v[216:219], v[76:79], v[48:51], v[216:219]
ds_read_b128 v[108:111], v5 offset:14336
v_mfma_f32_16x16x32_bf16 v[144:147], v[68:71], v[48:51], v[144:147]
ds_read_b128 v[112:115], v5 offset:16384
v_mfma_f32_16x16x32_bf16 v[148:151], v[68:71], v[52:55], v[148:151]
v_mfma_f32_16x16x32_bf16 v[220:223], v[76:79], v[52:55], v[220:223]
v_mfma_f32_16x16x32_bf16 v[184:187], v[72:75], v[52:55], v[184:187]
v_mfma_f32_16x16x32_bf16 v[188:191], v[72:75], v[56:59], v[188:191]
v_mfma_f32_16x16x32_bf16 v[224:227], v[76:79], v[56:59], v[224:227]
v_mfma_f32_16x16x32_bf16 v[152:155], v[68:71], v[56:59], v[152:155]
v_mfma_f32_16x16x32_bf16 v[156:159], v[68:71], v[60:63], v[156:159]
v_mfma_f32_16x16x32_bf16 v[228:231], v[76:79], v[60:63], v[228:231]
v_mfma_f32_16x16x32_bf16 v[192:195], v[72:75], v[60:63], v[192:195]
v_mfma_f32_16x16x32_bf16 v[196:199], v[72:75], v[64:67], v[196:199]
v_mfma_f32_16x16x32_bf16 v[232:235], v[76:79], v[64:67], v[232:235]
v_mfma_f32_16x16x32_bf16 v[160:163], v[68:71], v[64:67], v[160:163]
s_waitcnt lgkmcnt(0)
s_barrier
v_mfma_f32_16x16x32_bf16 v[164:167], v[120:123], v[80:83], v[164:167]
ds_read_b128 v[32:35], v2 offset:0
v_mfma_f32_16x16x32_bf16 v[200:203], v[124:127], v[80:83], v[200:203]
ds_read_b64_tr_b16 v[72:73], v6 offset:8192
v_mfma_f32_16x16x32_bf16 v[128:131], v[116:119], v[80:83], v[128:131]
ds_read_b64_tr_b16 v[74:75], v6 offset:8704
v_mfma_f32_16x16x32_bf16 v[132:135], v[116:119], v[84:87], v[132:135]
ds_read_b64_tr_b16 v[76:77], v6 offset:16384
v_mfma_f32_16x16x32_bf16 v[204:207], v[124:127], v[84:87], v[204:207]
ds_read_b64_tr_b16 v[78:79], v6 offset:16896
v_mfma_f32_16x16x32_bf16 v[168:171], v[120:123], v[84:87], v[168:171]
ds_read_b64_tr_b16 v[68:69], v6 offset:0
v_mfma_f32_16x16x32_bf16 v[172:175], v[120:123], v[88:91], v[172:175]
ds_read_b64_tr_b16 v[70:71], v6 offset:512
v_mfma_f32_16x16x32_bf16 v[208:211], v[124:127], v[88:91], v[208:211]
ds_read_b128 v[36:39], v2 offset:2048
v_mfma_f32_16x16x32_bf16 v[136:139], v[116:119], v[88:91], v[136:139]
ds_read_b128 v[40:43], v2 offset:4096
v_mfma_f32_16x16x32_bf16 v[140:143], v[116:119], v[92:95], v[140:143]
ds_read_b128 v[44:47], v2 offset:6144
v_mfma_f32_16x16x32_bf16 v[212:215], v[124:127], v[92:95], v[212:215]
ds_read_b128 v[48:51], v2 offset:8192
v_mfma_f32_16x16x32_bf16 v[176:179], v[120:123], v[92:95], v[176:179]
ds_read_b128 v[52:55], v2 offset:10240
v_mfma_f32_16x16x32_bf16 v[180:183], v[120:123], v[96:99], v[180:183]
ds_read_b128 v[56:59], v2 offset:12288
v_mfma_f32_16x16x32_bf16 v[216:219], v[124:127], v[96:99], v[216:219]
ds_read_b128 v[60:63], v2 offset:14336
v_mfma_f32_16x16x32_bf16 v[144:147], v[116:119], v[96:99], v[144:147]
ds_read_b128 v[64:67], v2 offset:16384
v_mfma_f32_16x16x32_bf16 v[148:151], v[116:119], v[100:103], v[148:151]
v_mfma_f32_16x16x32_bf16 v[220:223], v[124:127], v[100:103], v[220:223]
v_mfma_f32_16x16x32_bf16 v[184:187], v[120:123], v[100:103], v[184:187]
v_mfma_f32_16x16x32_bf16 v[188:191], v[120:123], v[104:107], v[188:191]
v_mfma_f32_16x16x32_bf16 v[224:227], v[124:127], v[104:107], v[224:227]
v_mfma_f32_16x16x32_bf16 v[152:155], v[116:119], v[104:107], v[152:155]
v_mfma_f32_16x16x32_bf16 v[156:159], v[116:119], v[108:111], v[156:159]
v_mfma_f32_16x16x32_bf16 v[228:231], v[124:127], v[108:111], v[228:231]
v_mfma_f32_16x16x32_bf16 v[192:195], v[120:123], v[108:111], v[192:195]
v_mfma_f32_16x16x32_bf16 v[196:199], v[120:123], v[112:115], v[196:199]
v_mfma_f32_16x16x32_bf16 v[232:235], v[124:127], v[112:115], v[232:235]
v_mfma_f32_16x16x32_bf16 v[160:163], v[116:119], v[112:115], v[160:163]
s_sub_u32 s41, s41, 1
s_cmp_lg_u32 s41, 0
s_cbranch_scc1 Lcl_6
s_waitcnt lgkmcnt(0)
v_mfma_f32_16x16x32_bf16 v[164:167], v[72:75], v[32:35], v[164:167]
ds_read_b128 v[80:83], v3 offset:0
v_mfma_f32_16x16x32_bf16 v[200:203], v[76:79], v[32:35], v[200:203]
ds_read_b64_tr_b16 v[120:121], v6 offset:12288
v_mfma_f32_16x16x32_bf16 v[128:131], v[68:71], v[32:35], v[128:131]
ds_read_b64_tr_b16 v[122:123], v6 offset:12800
v_mfma_f32_16x16x32_bf16 v[132:135], v[68:71], v[36:39], v[132:135]
ds_read_b64_tr_b16 v[124:125], v6 offset:20480
v_mfma_f32_16x16x32_bf16 v[204:207], v[76:79], v[36:39], v[204:207]
ds_read_b64_tr_b16 v[126:127], v6 offset:20992
v_mfma_f32_16x16x32_bf16 v[168:171], v[72:75], v[36:39], v[168:171]
ds_read_b64_tr_b16 v[116:117], v6 offset:4096
v_mfma_f32_16x16x32_bf16 v[172:175], v[72:75], v[40:43], v[172:175]
ds_read_b64_tr_b16 v[118:119], v6 offset:4608
v_mfma_f32_16x16x32_bf16 v[208:211], v[76:79], v[40:43], v[208:211]
ds_read_b128 v[84:87], v3 offset:2048
v_mfma_f32_16x16x32_bf16 v[136:139], v[68:71], v[40:43], v[136:139]
ds_read_b128 v[88:91], v3 offset:4096
v_mfma_f32_16x16x32_bf16 v[140:143], v[68:71], v[44:47], v[140:143]
ds_read_b128 v[92:95], v3 offset:6144
v_mfma_f32_16x16x32_bf16 v[212:215], v[76:79], v[44:47], v[212:215]
ds_read_b128 v[96:99], v3 offset:8192
v_mfma_f32_16x16x32_bf16 v[176:179], v[72:75], v[44:47], v[176:179]
ds_read_b128 v[100:103], v3 offset:10240
v_mfma_f32_16x16x32_bf16 v[180:183], v[72:75], v[48:51], v[180:183]
ds_read_b128 v[104:107], v3 offset:12288
v_mfma_f32_16x16x32_bf16 v[216:219], v[76:79], v[48:51], v[216:219]
ds_read_b128 v[108:111], v3 offset:14336
v_mfma_f32_16x16x32_bf16 v[144:147], v[68:71], v[48:51], v[144:147]
ds_read_b128 v[112:115], v3 offset:16384
v_mfma_f32_16x16x32_bf16 v[148:151], v[68:71], v[52:55], v[148:151]
v_mfma_f32_16x16x32_bf16 v[220:223], v[76:79], v[52:55], v[220:223]
v_mfma_f32_16x16x32_bf16 v[184:187], v[72:75], v[52:55], v[184:187]
v_mfma_f32_16x16x32_bf16 v[188:191], v[72:75], v[56:59], v[188:191]
v_mfma_f32_16x16x32_bf16 v[224:227], v[76:79], v[56:59], v[224:227]
v_mfma_f32_16x16x32_bf16 v[152:155], v[68:71], v[56:59], v[152:155]
v_mfma_f32_16x16x32_bf16 v[156:159], v[68:71], v[60:63], v[156:159]
v_mfma_f32_16x16x32_bf16 v[228:231], v[76:79], v[60:63], v[228:231]
v_mfma_f32_16x16x32_bf16 v[192:195], v[72:75], v[60:63], v[192:195]
v_mfma_f32_16x16x32_bf16 v[196:199], v[72:75], v[64:67], v[196:199]
v_mfma_f32_16x16x32_bf16 v[232:235], v[76:79], v[64:67], v[232:235]
v_mfma_f32_16x16x32_bf16 v[160:163], v[68:71], v[64:67], v[160:163]
s_waitcnt lgkmcnt(0)
s_barrier
v_mfma_f32_16x16x32_bf16 v[164:167], v[120:123], v[80:83], v[164:167]
v_mfma_f32_16x16x32_bf16 v[200:203], v[124:127], v[80:83], v[200:203]
v_mfma_f32_16x16x32_bf16 v[128:131], v[116:119], v[80:83], v[128:131]
v_mfma_f32_16x16x32_bf16 v[132:135], v[116:119], v[84:87], v[132:135]
v_mfma_f32_16x16x32_bf16 v[204:207], v[124:127], v[84:87], v[204:207]
v_mfma_f32_16x16x32_bf16 v[168:171], v[120:123], v[84:87], v[168:171]
v_mfma_f32_16x16x32_bf16 v[172:175], v[120:123], v[88:91], v[172:175]
v_mfma_f32_16x16x32_bf16 v[208:211], v[124:127], v[88:91], v[208:211]
v_mfma_f32_16x16x32_bf16 v[136:139], v[116:119], v[88:91], v[136:139]
v_mfma_f32_16x16x32_bf16 v[140:143], v[116:119], v[92:95], v[140:143]
v_mfma_f32_16x16x32_bf16 v[212:215], v[124:127], v[92:95], v[212:215]
v_mfma_f32_16x16x32_bf16 v[176:179], v[120:123], v[92:95], v[176:179]
v_mfma_f32_16x16x32_bf16 v[180:183], v[120:123], v[96:99], v[180:183]
v_mfma_f32_16x16x32_bf16 v[216:219], v[124:127], v[96:99], v[216:219]
v_mfma_f32_16x16x32_bf16 v[144:147], v[116:119], v[96:99], v[144:147]
v_mfma_f32_16x16x32_bf16 v[148:151], v[116:119], v[100:103], v[148:151]
v_mfma_f32_16x16x32_bf16 v[220:223], v[124:127], v[100:103], v[220:223]
v_mfma_f32_16x16x32_bf16 v[184:187], v[120:123], v[100:103], v[184:187]
v_mfma_f32_16x16x32_bf16 v[188:191], v[120:123], v[104:107], v[188:191]
v_mfma_f32_16x16x32_bf16 v[224:227], v[124:127], v[104:107], v[224:227]
v_mfma_f32_16x16x32_bf16 v[152:155], v[116:119], v[104:107], v[152:155]
v_mfma_f32_16x16x32_bf16 v[156:159], v[116:119], v[108:111], v[156:159]
v_mfma_f32_16x16x32_bf16 v[228:231], v[124:127], v[108:111], v[228:231]
v_mfma_f32_16x16x32_bf16 v[192:195], v[120:123], v[108:111], v[192:195]
v_mfma_f32_16x16x32_bf16 v[196:199], v[120:123], v[112:115], v[196:199]
v_mfma_f32_16x16x32_bf16 v[232:235], v[124:127], v[112:115], v[232:235]
v_mfma_f32_16x16x32_bf16 v[160:163], v[116:119], v[112:115], v[160:163]
v_lshlrev_b32 v14, 3, v12
v_add_u32 v14, 147456, v14
v_mul_u32_u24 v15, 400, v12
v_lshl_add_u32 v15, v13, 3, v15
s_lshl_b32 s43, s36, 5
v_add_u32 v15, s43, v15
s_barrier
ds_read_b64 v[32:33], v14 offset:0
ds_read_b64 v[34:35], v14 offset:128
ds_read_b64 v[36:37], v14 offset:256
ds_read_b64 v[38:39], v14 offset:384
ds_read_b64 v[40:41], v14 offset:512
ds_read_b64 v[42:43], v14 offset:640
ds_read_b64 v[44:45], v14 offset:768
ds_read_b64 v[46:47], v14 offset:896
ds_read_b64 v[48:49], v14 offset:1024
v_mov_b32_dpp v52, v128 row_newbcast:0 row_mask:0xf bank_mask:0xf
v_mov_b32_dpp v53, v129 row_newbcast:0 row_mask:0xf bank_mask:0xf
v_mov_b32_dpp v54, v130 row_newbcast:0 row_mask:0xf bank_mask:0xf
v_mov_b32_dpp v55, v131 row_newbcast:0 row_mask:0xf bank_mask:0xf
v_mov_b32_dpp v56, v164 row_newbcast:0 row_mask:0xf bank_mask:0xf
v_mov_b32_dpp v57, v165 row_newbcast:0 row_mask:0xf bank_mask:0xf
v_mov_b32_dpp v58, v166 row_newbcast:0 row_mask:0xf bank_mask:0xf
v_mov_b32_dpp v59, v167 row_newbcast:0 row_mask:0xf bank_mask:0xf
v_mov_b32_dpp v60, v200 row_newbcast:0 row_mask:0xf bank_mask:0xf
v_mov_b32_dpp v61, v201 row_newbcast:0 row_mask:0xf bank_mask:0xf
v_mov_b32_dpp v62, v202 row_newbcast:0 row_mask:0xf bank_mask:0xf
v_mov_b32_dpp v63, v203 row_newbcast:0 row_mask:0xf bank_mask:0xf
s_waitcnt lgkmcnt(0)
v_pk_fma_f32 v[164:165], v[32:33], v[56:57], v[164:165] op_sel_hi:[0,1,1] neg_lo:[1,0,0] neg_hi:[1,0,0]
v_pk_fma_f32 v[166:167], v[32:33], v[58:59], v[166:167] op_sel_hi:[0,1,1] neg_lo:[1,0,0] neg_hi:[1,0,0]
v_pk_fma_f32 v[200:201], v[32:33], v[60:61], v[200:201] op_sel_hi:[0,1,1] neg_lo:[1,0,0] neg_hi:[1,0,0]
v_pk_fma_f32 v[202:203], v[32:33], v[62:63], v[202:203] op_sel_hi:[0,1,1] neg_lo:[1,0,0] neg_hi:[1,0,0]
v_pk_mul_f32 v[164:165], v[32:33], v[164:165] op_sel:[1,0] op_sel_hi:[1,1]
v_pk_mul_f32 v[166:167], v[32:33], v[166:167] op_sel:[1,0] op_sel_hi:[1,1]
v_pk_fma_f32 v[132:133], v[34:35], v[52:53], v[132:133] op_sel_hi:[0,1,1] neg_lo:[1,0,0] neg_hi:[1,0,0]
v_pk_fma_f32 v[134:135], v[34:35], v[54:55], v[134:135] op_sel_hi:[0,1,1] neg_lo:[1,0,0] neg_hi:[1,0,0]
v_pk_mul_f32 v[200:201], v[32:33], v[200:201] op_sel:[1,0] op_sel_hi:[1,1]
v_pk_mul_f32 v[202:203], v[32:33], v[202:203] op_sel:[1,0] op_sel_hi:[1,1]
v_cvt_pk_bf16_f32 v164, v164, v165
v_cvt_pk_bf16_f32 v165, v166, v167
ds_write_b64 v15, v[164:165] offset:128
v_pk_fma_f32 v[168:169], v[34:35], v[56:57], v[168:169] op_sel_hi:[0,1,1] neg_lo:[1,0,0] neg_hi:[1,0,0]
v_pk_fma_f32 v[170:171], v[34:35], v[58:59], v[170:171] op_sel_hi:[0,1,1] neg_lo:[1,0,0] neg_hi:[1,0,0]
v_pk_mul_f32 v[132:133], v[34:35], v[132:133] op_sel:[1,0] op_sel_hi:[1,1]
v_pk_mul_f32 v[134:135], v[34:35], v[134:135] op_sel:[1,0] op_sel_hi:[1,1]
v_cvt_pk_bf16_f32 v200, v200, v201
v_cvt_pk_bf16_f32 v201, v202, v203
ds_write_b64 v15, v[200:201] offset:256
v_pk_fma_f32 v[204:205], v[34:35], v[60:61], v[204:205] op_sel_hi:[0,1,1] neg_lo:[1,0,0] neg_hi:[1,0,0]
v_pk_fma_f32 v[206:207], v[34:35], v[62:63], v[206:207] op_sel_hi:[0,1,1] neg_lo:[1,0,0] neg_hi:[1,0,0]
v_pk_mul_f32 v[168:169], v[34:35], v[168:169] op_sel:[1,0] op_sel_hi:[1,1]
v_pk_mul_f32 v[170:171], v[34:35], v[170:171] op_sel:[1,0] op_sel_hi:[1,1]
v_cvt_pk_bf16_f32 v132, v132, v133
v_cvt_pk_bf16_f32 v133, v134, v135
ds_write_b64 v15, v[132:133] offset:6400
v_pk_fma_f32 v[136:137], v[36:37], v[52:53], v[136:137] op_sel_hi:[0,1,1] neg_lo:[1,0,0] neg_hi:[1,0,0]
v_pk_fma_f32 v[138:139], v[36:37], v[54:55], v[138:139] op_sel_hi:[0,1,1] neg_lo:[1,0,0] neg_hi:[1,0,0]
v_pk_mul_f32 v[204:205], v[34:35], v[204:205] op_sel:[1,0] op_sel_hi:[1,1]
v_pk_mul_f32 v[206:207], v[34:35], v[206:207] op_sel:[1,0] op_sel_hi:[1,1]
v_cvt_pk_bf16_f32 v168, v168, v169
v_cvt_pk_bf16_f32 v169, v170, v171
ds_write_b64 v15, v[168:169] offset:6528
v_pk_fma_f32 v[172:173], v[36:37], v[56:57], v[172:173] op_sel_hi:[0,1,1] neg_lo:[1,0,0] neg_hi:[1,0,0]
v_pk_fma_f32 v[174:175], v[36:37], v[58:59], v[174:175] op_sel_hi:[0,1,1] neg_lo:[1,0,0] neg_hi:[1,0,0]
v_pk_mul_f32 v[136:137], v[36:37], v[136:137] op_sel:[1,0] op_sel_hi:[1,1]
v_pk_mul_f32 v[138:139], v[36:37], v[138:139] op_sel:[1,0] op_sel_hi:[1,1]
v_cvt_pk_bf16_f32 v204, v204, v205
v_cvt_pk_bf16_f32 v205, v206, v207
ds_write_b64 v15, v[204:205] offset:6656
v_pk_fma_f32 v[208:209], v[36:37], v[60:61], v[208:209] op_sel_hi:[0,1,1] neg_lo:[1,0,0] neg_hi:[1,0,0]
v_pk_fma_f32 v[210:211], v[36:37], v[62:63], v[210:211] op_sel_hi:[0,1,1] neg_lo:[1,0,0] neg_hi:[1,0,0]
v_pk_mul_f32 v[172:173], v[36:37], v[172:173] op_sel:[1,0] op_sel_hi:[1,1]
v_pk_mul_f32 v[174:175], v[36:37], v[174:175] op_sel:[1,0] op_sel_hi:[1,1]
v_cvt_pk_bf16_f32 v136, v136, v137
v_cvt_pk_bf16_f32 v137, v138, v139
ds_write_b64 v15, v[136:137] offset:12800
v_pk_fma_f32 v[140:141], v[38:39], v[52:53], v[140:141] op_sel_hi:[0,1,1] neg_lo:[1,0,0] neg_hi:[1,0,0]
v_pk_fma_f32 v[142:143], v[38:39], v[54:55], v[142:143] op_sel_hi:[0,1,1] neg_lo:[1,0,0] neg_hi:[1,0,0]
v_pk_mul_f32 v[208:209], v[36:37], v[208:209] op_sel:[1,0] op_sel_hi:[1,1]
v_pk_mul_f32 v[210:211], v[36:37], v[210:211] op_sel:[1,0] op_sel_hi:[1,1]
v_cvt_pk_bf16_f32 v172, v172, v173
v_cvt_pk_bf16_f32 v173, v174, v175
ds_write_b64 v15, v[172:173] offset:12928
v_pk_fma_f32 v[176:177], v[38:39], v[56:57], v[176:177] op_sel_hi:[0,1,1] neg_lo:[1,0,0] neg_hi:[1,0,0]
v_pk_fma_f32 v[178:179], v[38:39], v[58:59], v[178:179] op_sel_hi:[0,1,1] neg_lo:[1,0,0] neg_hi:[1,0,0]
v_pk_mul_f32 v[140:141], v[38:39], v[140:141] op_sel:[1,0] op_sel_hi:[1,1]
v_pk_mul_f32 v[142:143], v[38:39], v[142:143] op_sel:[1,0] op_sel_hi:[1,1]
v_cvt_pk_bf16_f32 v208, v208, v209
v_cvt_pk_bf16_f32 v209, v210, v211
ds_write_b64 v15, v[208:209] offset:13056
v_pk_fma_f32 v[212:213], v[38:39], v[60:61], v[212:213] op_sel_hi:[0,1,1] neg_lo:[1,0,0] neg_hi:[1,0,0]
v_pk_fma_f32 v[214:215], v[38:39], v[62:63], v[214:215] op_sel_hi:[0,1,1] neg_lo:[1,0,0] neg_hi:[1,0,0]
v_pk_mul_f32 v[176:177], v[38:39], v[176:177] op_sel:[1,0] op_sel_hi:[1,1]
v_pk_mul_f32 v[178:179], v[38:39], v[178:179] op_sel:[1,0] op_sel_hi:[1,1]
v_cvt_pk_bf16_f32 v140, v140, v141
v_cvt_pk_bf16_f32 v141, v142, v143
ds_write_b64 v15, v[140:141] offset:19200
v_pk_fma_f32 v[144:145], v[40:41], v[52:53], v[144:145] op_sel_hi:[0,1,1] neg_lo:[1,0,0] neg_hi:[1,0,0]
v_pk_fma_f32 v[146:147], v[40:41], v[54:55], v[146:147] op_sel_hi:[0,1,1] neg_lo:[1,0,0] neg_hi:[1,0,0]
v_pk_mul_f32 v[212:213], v[38:39], v[212:213] op_sel:[1,0] op_sel_hi:[1,1]
v_pk_mul_f32 v[214:215], v[38:39], v[214:215] op_sel:[1,0] op_sel_hi:[1,1]
v_cvt_pk_bf16_f32 v176, v176, v177
v_cvt_pk_bf16_f32 v177, v178, v179
ds_write_b64 v15, v[176:177] offset:19328
v_pk_fma_f32 v[180:181], v[40:41], v[56:57], v[180:181] op_sel_hi:[0,1,1] neg_lo:[1,0,0] neg_hi:[1,0,0]
v_pk_fma_f32 v[182:183], v[40:41], v[58:59], v[182:183] op_sel_hi:[0,1,1] neg_lo:[1,0,0] neg_hi:[1,0,0]
v_pk_mul_f32 v[144:145], v[40:41], v[144:145] op_sel:[1,0] op_sel_hi:[1,1]
v_pk_mul_f32 v[146:147], v[40:41], v[146:147] op_sel:[1,0] op_sel_hi:[1,1]
v_cvt_pk_bf16_f32 v212, v212, v213
v_cvt_pk_bf16_f32 v213, v214, v215
ds_write_b64 v15, v[212:213] offset:19456
v_pk_fma_f32 v[216:217], v[40:41], v[60:61], v[216:217] op_sel_hi:[0,1,1] neg_lo:[1,0,0] neg_hi:[1,0,0]
v_pk_fma_f32 v[218:219], v[40:41], v[62:63], v[218:219] op_sel_hi:[0,1,1] neg_lo:[1,0,0] neg_hi:[1,0,0]
v_pk_mul_f32 v[180:181], v[40:41], v[180:181] op_sel:[1,0] op_sel_hi:[1,1]
v_pk_mul_f32 v[182:183], v[40:41], v[182:183] op_sel:[1,0] op_sel_hi:[1,1]
v_cvt_pk_bf16_f32 v144, v144, v145
v_cvt_pk_bf16_f32 v145, v146, v147
ds_write_b64 v15, v[144:145] offset:25600
v_pk_fma_f32 v[148:149], v[42:43], v[52:53], v[148:149] op_sel_hi:[0,1,1] neg_lo:[1,0,0] neg_hi:[1,0,0]
v_pk_fma_f32 v[150:151], v[42:43], v[54:55], v[150:151] op_sel_hi:[0,1,1] neg_lo:[1,0,0] neg_hi:[1,0,0]
v_pk_mul_f32 v[216:217], v[40:41], v[216:217] op_sel:[1,0] op_sel_hi:[1,1]
v_pk_mul_f32 v[218:219], v[40:41], v[218:219] op_sel:[1,0] op_sel_hi:[1,1]
v_cvt_pk_bf16_f32 v180, v180, v181
v_cvt_pk_bf16_f32 v181, v182, v183
ds_write_b64 v15, v[180:181] offset:25728
v_pk_fma_f32 v[184:185], v[42:43], v[56:57], v[184:185] op_sel_hi:[0,1,1] neg_lo:[1,0,0] neg_hi:[1,0,0]
v_pk_fma_f32 v[186:187], v[42:43], v[58:59], v[186:187] op_sel_hi:[0,1,1] neg_lo:[1,0,0] neg_hi:[1,0,0]
v_pk_mul_f32 v[148:149], v[42:43], v[148:149] op_sel:[1,0] op_sel_hi:[1,1]
v_pk_mul_f32 v[150:151], v[42:43], v[150:151] op_sel:[1,0] op_sel_hi:[1,1]
v_cvt_pk_bf16_f32 v216, v216, v217
v_cvt_pk_bf16_f32 v217, v218, v219
ds_write_b64 v15, v[216:217] offset:25856
v_pk_fma_f32 v[220:221], v[42:43], v[60:61], v[220:221] op_sel_hi:[0,1,1] neg_lo:[1,0,0] neg_hi:[1,0,0]
v_pk_fma_f32 v[222:223], v[42:43], v[62:63], v[222:223] op_sel_hi:[0,1,1] neg_lo:[1,0,0] neg_hi:[1,0,0]
v_pk_mul_f32 v[184:185], v[42:43], v[184:185] op_sel:[1,0] op_sel_hi:[1,1]
v_pk_mul_f32 v[186:187], v[42:43], v[186:187] op_sel:[1,0] op_sel_hi:[1,1]
v_cvt_pk_bf16_f32 v148, v148, v149
v_cvt_pk_bf16_f32 v149, v150, v151
ds_write_b64 v15, v[148:149] offset:32000
v_pk_fma_f32 v[152:153], v[44:45], v[52:53], v[152:153] op_sel_hi:[0,1,1] neg_lo:[1,0,0] neg_hi:[1,0,0]
v_pk_fma_f32 v[154:155], v[44:45], v[54:55], v[154:155] op_sel_hi:[0,1,1] neg_lo:[1,0,0] neg_hi:[1,0,0]
v_pk_mul_f32 v[220:221], v[42:43], v[220:221] op_sel:[1,0] op_sel_hi:[1,1]
v_pk_mul_f32 v[222:223], v[42:43], v[222:223] op_sel:[1,0] op_sel_hi:[1,1]
v_cvt_pk_bf16_f32 v184, v184, v185
v_cvt_pk_bf16_f32 v185, v186, v187
ds_write_b64 v15, v[184:185] offset:32128
v_pk_fma_f32 v[188:189], v[44:45], v[56:57], v[188:189] op_sel_hi:[0,1,1] neg_lo:[1,0,0] neg_hi:[1,0,0]
v_pk_fma_f32 v[190:191], v[44:45], v[58:59], v[190:191] op_sel_hi:[0,1,1] neg_lo:[1,0,0] neg_hi:[1,0,0]
v_pk_mul_f32 v[152:153], v[44:45], v[152:153] op_sel:[1,0] op_sel_hi:[1,1]
v_pk_mul_f32 v[154:155], v[44:45], v[154:155] op_sel:[1,0] op_sel_hi:[1,1]
v_cvt_pk_bf16_f32 v220, v220, v221
v_cvt_pk_bf16_f32 v221, v222, v223
ds_write_b64 v15, v[220:221] offset:32256
v_pk_fma_f32 v[224:225], v[44:45], v[60:61], v[224:225] op_sel_hi:[0,1,1] neg_lo:[1,0,0] neg_hi:[1,0,0]
v_pk_fma_f32 v[226:227], v[44:45], v[62:63], v[226:227] op_sel_hi:[0,1,1] neg_lo:[1,0,0] neg_hi:[1,0,0]
v_pk_mul_f32 v[188:189], v[44:45], v[188:189] op_sel:[1,0] op_sel_hi:[1,1]
v_pk_mul_f32 v[190:191], v[44:45], v[190:191] op_sel:[1,0] op_sel_hi:[1,1]
v_cvt_pk_bf16_f32 v152, v152, v153
v_cvt_pk_bf16_f32 v153, v154, v155
ds_write_b64 v15, v[152:153] offset:38400
v_pk_fma_f32 v[156:157], v[46:47], v[52:53], v[156:157] op_sel_hi:[0,1,1] neg_lo:[1,0,0] neg_hi:[1,0,0]
v_pk_fma_f32 v[158:159], v[46:47], v[54:55], v[158:159] op_sel_hi:[0,1,1] neg_lo:[1,0,0] neg_hi:[1,0,0]
v_pk_mul_f32 v[224:225], v[44:45], v[224:225] op_sel:[1,0] op_sel_hi:[1,1]
v_pk_mul_f32 v[226:227], v[44:45], v[226:227] op_sel:[1,0] op_sel_hi:[1,1]
v_cvt_pk_bf16_f32 v188, v188, v189
v_cvt_pk_bf16_f32 v189, v190, v191
ds_write_b64 v15, v[188:189] offset:38528
v_pk_fma_f32 v[192:193], v[46:47], v[56:57], v[192:193] op_sel_hi:[0,1,1] neg_lo:[1,0,0] neg_hi:[1,0,0]
v_pk_fma_f32 v[194:195], v[46:47], v[58:59], v[194:195] op_sel_hi:[0,1,1] neg_lo:[1,0,0] neg_hi:[1,0,0]
v_pk_mul_f32 v[156:157], v[46:47], v[156:157] op_sel:[1,0] op_sel_hi:[1,1]
v_pk_mul_f32 v[158:159], v[46:47], v[158:159] op_sel:[1,0] op_sel_hi:[1,1]
v_cvt_pk_bf16_f32 v224, v224, v225
v_cvt_pk_bf16_f32 v225, v226, v227
ds_write_b64 v15, v[224:225] offset:38656
v_pk_fma_f32 v[228:229], v[46:47], v[60:61], v[228:229] op_sel_hi:[0,1,1] neg_lo:[1,0,0] neg_hi:[1,0,0]
v_pk_fma_f32 v[230:231], v[46:47], v[62:63], v[230:231] op_sel_hi:[0,1,1] neg_lo:[1,0,0] neg_hi:[1,0,0]
v_pk_mul_f32 v[192:193], v[46:47], v[192:193] op_sel:[1,0] op_sel_hi:[1,1]
v_pk_mul_f32 v[194:195], v[46:47], v[194:195] op_sel:[1,0] op_sel_hi:[1,1]
v_cvt_pk_bf16_f32 v156, v156, v157
v_cvt_pk_bf16_f32 v157, v158, v159
ds_write_b64 v15, v[156:157] offset:44800
v_pk_fma_f32 v[160:161], v[48:49], v[52:53], v[160:161] op_sel_hi:[0,1,1] neg_lo:[1,0,0] neg_hi:[1,0,0]
v_pk_fma_f32 v[162:163], v[48:49], v[54:55], v[162:163] op_sel_hi:[0,1,1] neg_lo:[1,0,0] neg_hi:[1,0,0]
v_pk_mul_f32 v[228:229], v[46:47], v[228:229] op_sel:[1,0] op_sel_hi:[1,1]
v_pk_mul_f32 v[230:231], v[46:47], v[230:231] op_sel:[1,0] op_sel_hi:[1,1]
v_cvt_pk_bf16_f32 v192, v192, v193
v_cvt_pk_bf16_f32 v193, v194, v195
ds_write_b64 v15, v[192:193] offset:44928
v_pk_fma_f32 v[196:197], v[48:49], v[56:57], v[196:197] op_sel_hi:[0,1,1] neg_lo:[1,0,0] neg_hi:[1,0,0]
v_pk_fma_f32 v[198:199], v[48:49], v[58:59], v[198:199] op_sel_hi:[0,1,1] neg_lo:[1,0,0] neg_hi:[1,0,0]
v_pk_mul_f32 v[160:161], v[48:49], v[160:161] op_sel:[1,0] op_sel_hi:[1,1]
v_pk_mul_f32 v[162:163], v[48:49], v[162:163] op_sel:[1,0] op_sel_hi:[1,1]
v_cvt_pk_bf16_f32 v228, v228, v229
v_cvt_pk_bf16_f32 v229, v230, v231
ds_write_b64 v15, v[228:229] offset:45056
v_pk_fma_f32 v[232:233], v[48:49], v[60:61], v[232:233] op_sel_hi:[0,1,1] neg_lo:[1,0,0] neg_hi:[1,0,0]
v_pk_fma_f32 v[234:235], v[48:49], v[62:63], v[234:235] op_sel_hi:[0,1,1] neg_lo:[1,0,0] neg_hi:[1,0,0]
v_pk_mul_f32 v[196:197], v[48:49], v[196:197] op_sel:[1,0] op_sel_hi:[1,1]
v_pk_mul_f32 v[198:199], v[48:49], v[198:199] op_sel:[1,0] op_sel_hi:[1,1]
v_cvt_pk_bf16_f32 v160, v160, v161
v_cvt_pk_bf16_f32 v161, v162, v163
ds_write_b64 v15, v[160:161] offset:51200
v_pk_mul_f32 v[232:233], v[48:49], v[232:233] op_sel:[1,0] op_sel_hi:[1,1]
v_pk_mul_f32 v[234:235], v[48:49], v[234:235] op_sel:[1,0] op_sel_hi:[1,1]
v_cvt_pk_bf16_f32 v196, v196, v197
v_cvt_pk_bf16_f32 v197, v198, v199
ds_write_b64 v15, v[196:197] offset:51328
v_cvt_pk_bf16_f32 v232, v232, v233
v_cvt_pk_bf16_f32 v233, v234, v235
ds_write_b64 v15, v[232:233] offset:51456
s_waitcnt lgkmcnt(0)
s_branch Latt_5
Lprod_3:
s_sub_u32 s47, s36, 4
s_lshl_b32 s43, s34, 7
s_lshl_b32 s44, s35, 3
s_add_u32 s63, s43, s44
s_lshl_b32 s44, s47, 1
s_add_u32 s51, s63, s44
v_lshlrev_b32 v10, 4, v1
s_cmp_eq_u32 s47, 3
s_cbranch_scc1 Lpf_4
v_lshrrev_b32 v14, 3, v1
v_and_b32 v15, 7, v1
v_and_b32 v16, 2, v14
v_xor_b32 v16, v15, v16
v_lshlrev_b32 v16, 4, v16
v_mul_u32_u24 v17, 6144, v14
s_lshl_b32 s43, s47, 11
v_add3_u32 v2, v17, v16, s43
v_xor_b32 v3, 64, v2
v_lshrrev_b32 v16, 1, v14
v_xor_b32 v16, v15, v16
v_lshlrev_b32 v16, 4, v16
s_lshl_b32 s43, s47, 3
s_add_u32 s43, s43, s50
v_add_u32 v17, s43, v14
s_and_b32 s44, s47, 1
s_lshl_b32 s44, s44, 6
v_add_u32 v18, 0, v17
v_max_i32 v18, 0, v18
v_lshl_add_u32 v18, v18, 11, v16
v_xor_b32 v18, s44, v18
v_mov_b32 v4, v18
v_add_u32 v18, 24, v17
v_max_i32 v18, 0, v18
v_lshl_add_u32 v18, v18, 11, v16
v_xor_b32 v18, s44, v18
v_xor_b32 v5, 64, v18
v_add_u32 v18, 48, v17
v_max_i32 v18, 0, v18
v_lshl_add_u32 v18, v18, 11, v16
v_xor_b32 v18, s44, v18
v_mov_b32 v6, v18
v_add_u32 v18, 72, v17
v_max_i32 v18, 0, v18
v_lshl_add_u32 v18, v18, 11, v16
v_xor_b32 v18, s44, v18
v_xor_b32 v7, 64, v18
v_add_u32 v18, 96, v17
v_max_i32 v18, 0, v18
v_lshl_add_u32 v18, v18, 11, v16
v_xor_b32 v18, s44, v18
v_mov_b32 v8, v18
v_add_u32 v18, 120, v17
v_max_i32 v18, 0, v18
v_lshl_add_u32 v18, v18, 11, v16
v_xor_b32 v18, s44, v18
v_xor_b32 v9, 64, v18
s_lshl_b32 s39, s47, 10
s_lshl_b32 s40, s47, 13
s_add_u32 s40, s40, 18432
s_mov_b32 s37, 0
s_mov_b32 s38, 0
s_bfm_b64 s[60:61], 56, 8
s_cmp_eq_u32 s47, 0
s_cselect_b64 s[60:61], s[60:61], -1
s_add_u32 m0, s39, 0
s_mov_b64 exec, s[60:61]
buffer_load_dwordx4 v4, s[8:11], s37 offen lds
s_mov_b64 exec, -1
s_add_u32 m0, s39, 3072
s_nop 0
buffer_load_dwordx4 v5, s[8:11], s37 offen lds
s_add_u32 m0, s39, 6144
s_nop 0
buffer_load_dwordx4 v6, s[8:11], s37 offen lds
s_add_u32 m0, s39, 9216
s_nop 0
buffer_load_dwordx4 v7, s[8:11], s37 offen lds
s_add_u32 m0, s39, 12288
s_nop 0
buffer_load_dwordx4 v8, s[8:11], s37 offen lds
s_add_u32 m0, s39, 15360
s_nop 0
buffer_load_dwordx4 v9, s[8:11], s37 offen lds
s_add_u32 m0, s40, 0
s_add_u32 s43, s38, 0
buffer_load_dwordx4 v2, s[12:15], s43 offen lds
s_add_u32 m0, s40, 1024
s_add_u32 s43, s38, 49152
buffer_load_dwordx4 v3, s[12:15], s43 offen lds
s_add_u32 m0, s40, 2048
s_add_u32 s43, s38, 98304
buffer_load_dwordx4 v2, s[12:15], s43 offen lds
s_add_u32 m0, s40, 3072
s_add_u32 s43, s38, 147456
buffer_load_dwordx4 v3, s[12:15], s43 offen lds
s_add_u32 m0, s40, 4096
s_add_u32 s43, s38, 196608
buffer_load_dwordx4 v2, s[12:15], s43 offen lds
s_add_u32 m0, s40, 5120
s_add_u32 s43, s38, 245760
buffer_load_dwordx4 v3, s[12:15], s43 offen lds
s_add_u32 m0, s40, 6144
s_add_u32 s43, s38, 294912
buffer_load_dwordx4 v2, s[12:15], s43 offen lds
s_add_u32 m0, s40, 7168
s_add_u32 s43, s38, 344064
buffer_load_dwordx4 v3, s[12:15], s43 offen lds
s_add_u32 s37, s37, 128
s_add_u32 s38, s38, 393216
s_add_u32 m0, s39, 43008
s_mov_b64 exec, s[60:61]
buffer_load_dwordx4 v4, s[8:11], s37 offen lds
s_mov_b64 exec, -1
s_add_u32 m0, s39, 46080
s_nop 0
buffer_load_dwordx4 v5, s[8:11], s37 offen lds
s_add_u32 m0, s39, 49152
s_nop 0
buffer_load_dwordx4 v6, s[8:11], s37 offen lds
s_add_u32 m0, s39, 52224
s_nop 0
buffer_load_dwordx4 v7, s[8:11], s37 offen lds
s_add_u32 m0, s39, 55296
s_nop 0
buffer_load_dwordx4 v8, s[8:11], s37 offen lds
s_add_u32 m0, s39, 58368
s_nop 0
buffer_load_dwordx4 v9, s[8:11], s37 offen lds
s_add_u32 m0, s40, 43008
s_add_u32 s43, s38, 0
buffer_load_dwordx4 v2, s[12:15], s43 offen lds
s_add_u32 m0, s40, 44032
s_add_u32 s43, s38, 49152
buffer_load_dwordx4 v3, s[12:15], s43 offen lds
s_add_u32 m0, s40, 45056
s_add_u32 s43, s38, 98304
buffer_load_dwordx4 v2, s[12:15], s43 offen lds
s_add_u32 m0, s40, 46080
s_add_u32 s43, s38, 147456
buffer_load_dwordx4 v3, s[12:15], s43 offen lds
s_add_u32 m0, s40, 47104
s_add_u32 s43, s38, 196608
buffer_load_dwordx4 v2, s[12:15], s43 offen lds
s_add_u32 m0, s40, 48128
s_add_u32 s43, s38, 245760
buffer_load_dwordx4 v3, s[12:15], s43 offen lds
s_add_u32 m0, s40, 49152
s_add_u32 s43, s38, 294912
buffer_load_dwordx4 v2, s[12:15], s43 offen lds
s_add_u32 m0, s40, 50176
s_add_u32 s43, s38, 344064
buffer_load_dwordx4 v3, s[12:15], s43 offen lds
s_add_u32 s37, s37, 128
s_add_u32 s38, s38, 393216
s_add_u32 m0, s39, 86016
s_mov_b64 exec, s[60:61]
buffer_load_dwordx4 v4, s[8:11], s37 offen lds
s_mov_b64 exec, -1
s_add_u32 m0, s39, 89088
s_nop 0
buffer_load_dwordx4 v5, s[8:11], s37 offen lds
s_add_u32 m0, s39, 92160
s_nop 0
buffer_load_dwordx4 v6, s[8:11], s37 offen lds
s_add_u32 m0, s39, 95232
s_nop 0
buffer_load_dwordx4 v7, s[8:11], s37 offen lds
s_add_u32 m0, s39, 98304
s_nop 0
buffer_load_dwordx4 v8, s[8:11], s37 offen lds
s_add_u32 m0, s39, 101376
s_nop 0
buffer_load_dwordx4 v9, s[8:11], s37 offen lds
s_add_u32 m0, s40, 86016
s_add_u32 s43, s38, 0
buffer_load_dwordx4 v2, s[12:15], s43 offen lds
s_add_u32 m0, s40, 87040
s_add_u32 s43, s38, 49152
buffer_load_dwordx4 v3, s[12:15], s43 offen lds
s_add_u32 m0, s40, 88064
s_add_u32 s43, s38, 98304
buffer_load_dwordx4 v2, s[12:15], s43 offen lds
s_add_u32 m0, s40, 89088
s_add_u32 s43, s38, 147456
buffer_load_dwordx4 v3, s[12:15], s43 offen lds
s_add_u32 m0, s40, 90112
s_add_u32 s43, s38, 196608
buffer_load_dwordx4 v2, s[12:15], s43 offen lds
s_add_u32 m0, s40, 91136
s_add_u32 s43, s38, 245760
buffer_load_dwordx4 v3, s[12:15], s43 offen lds
s_add_u32 m0, s40, 92160
s_add_u32 s43, s38, 294912
buffer_load_dwordx4 v2, s[12:15], s43 offen lds
s_add_u32 m0, s40, 93184
s_add_u32 s43, s38, 344064
buffer_load_dwordx4 v3, s[12:15], s43 offen lds
s_add_u32 s37, s37, 128
s_add_u32 s38, s38, 393216
s_lshl_b32 s43, s51, 11
buffer_load_dwordx4 v[96:99], v10, s[8:11], s43 offen offset:0
buffer_load_dwordx4 v[100:103], v10, s[8:11], s43 offen offset:1024
buffer_load_dwordx4 v[104:107], v10, s[8:11], s43 offen offset:2048
buffer_load_dwordx4 v[108:111], v10, s[8:11], s43 offen offset:3072
s_waitcnt vmcnt(32)
s_barrier
s_waitcnt vmcnt(18)
s_barrier
s_add_u32 m0, s39, 0
s_mov_b64 exec, s[60:61]
buffer_load_dwordx4 v4, s[8:11], s37 offen lds
s_mov_b64 exec, -1
s_add_u32 m0, s39, 3072
s_nop 0
buffer_load_dwordx4 v5, s[8:11], s37 offen lds
s_add_u32 m0, s39, 6144
s_nop 0
buffer_load_dwordx4 v6, s[8:11], s37 offen lds
s_add_u32 m0, s39, 9216
s_nop 0
buffer_load_dwordx4 v7, s[8:11], s37 offen lds
s_add_u32 m0, s39, 12288
s_nop 0
buffer_load_dwordx4 v8, s[8:11], s37 offen lds
s_add_u32 m0, s39, 15360
s_nop 0
buffer_load_dwordx4 v9, s[8:11], s37 offen lds
s_add_u32 m0, s40, 0
s_add_u32 s43, s38, 0
buffer_load_dwordx4 v2, s[12:15], s43 offen lds
s_add_u32 m0, s40, 1024
s_add_u32 s43, s38, 49152
buffer_load_dwordx4 v3, s[12:15], s43 offen lds
s_add_u32 m0, s40, 2048
s_add_u32 s43, s38, 98304
buffer_load_dwordx4 v2, s[12:15], s43 offen lds
s_add_u32 m0, s40, 3072
s_add_u32 s43, s38, 147456
buffer_load_dwordx4 v3, s[12:15], s43 offen lds
s_add_u32 m0, s40, 4096
s_add_u32 s43, s38, 196608
buffer_load_dwordx4 v2, s[12:15], s43 offen lds
s_add_u32 m0, s40, 5120
s_add_u32 s43, s38, 245760
buffer_load_dwordx4 v3, s[12:15], s43 offen lds
s_add_u32 m0, s40, 6144
s_add_u32 s43, s38, 294912
buffer_load_dwordx4 v2, s[12:15], s43 offen lds
s_add_u32 m0, s40, 7168
s_add_u32 s43, s38, 344064
buffer_load_dwordx4 v3, s[12:15], s43 offen lds
s_add_u32 s37, s37, 128
s_add_u32 s38, s38, 393216
s_waitcnt vmcnt(14)
s_barrier
s_add_u32 m0, s39, 43008
s_mov_b64 exec, s[60:61]
buffer_load_dwordx4 v4, s[8:11], s37 offen lds
s_mov_b64 exec, -1
s_add_u32 m0, s39, 46080
s_nop 0
buffer_load_dwordx4 v5, s[8:11], s37 offen lds
s_add_u32 m0, s39, 49152
s_nop 0
buffer_load_dwordx4 v6, s[8:11], s37 offen lds
s_add_u32 m0, s39, 52224
s_nop 0
buffer_load_dwordx4 v7, s[8:11], s37 offen lds
s_add_u32 m0, s39, 55296
s_nop 0
buffer_load_dwordx4 v8, s[8:11], s37 offen lds
s_add_u32 m0, s39, 58368
s_nop 0
buffer_load_dwordx4 v9, s[8:11], s37 offen lds
s_add_u32 m0, s40, 43008
s_add_u32 s43, s38, 0
buffer_load_dwordx4 v2, s[12:15], s43 offen lds
s_add_u32 m0, s40, 44032
s_add_u32 s43, s38, 49152
buffer_load_dwordx4 v3, s[12:15], s43 offen lds
s_add_u32 m0, s40, 45056
s_add_u32 s43, s38, 98304
buffer_load_dwordx4 v2, s[12:15], s43 offen lds
s_add_u32 m0, s40, 46080
s_add_u32 s43, s38, 147456
buffer_load_dwordx4 v3, s[12:15], s43 offen lds
s_add_u32 m0, s40, 47104
s_add_u32 s43, s38, 196608
buffer_load_dwordx4 v2, s[12:15], s43 offen lds
s_add_u32 m0, s40, 48128
s_add_u32 s43, s38, 245760
buffer_load_dwordx4 v3, s[12:15], s43 offen lds
s_add_u32 m0, s40, 49152
s_add_u32 s43, s38, 294912
buffer_load_dwordx4 v2, s[12:15], s43 offen lds
s_add_u32 m0, s40, 50176
s_add_u32 s43, s38, 344064
buffer_load_dwordx4 v3, s[12:15], s43 offen lds
s_add_u32 s37, s37, 128
s_add_u32 s38, s38, 393216
v_lshlrev_b32 v124, 16, v96
v_and_b32 v125, 0xffff0000, v96
v_mov_b32 v116, v124
v_mov_b32 v117, v125
v_mul_f32 v118, v124, v124
v_mul_f32 v119, v125, v125
v_lshlrev_b32 v126, 16, v97
v_and_b32 v127, 0xffff0000, v97
v_add_f32 v116, v116, v126
v_add_f32 v117, v117, v127
v_fmac_f32 v118, v126, v126
v_fmac_f32 v119, v127, v127
v_lshlrev_b32 v124, 16, v98
v_and_b32 v125, 0xffff0000, v98
v_add_f32 v116, v116, v124
v_add_f32 v117, v117, v125
v_fmac_f32 v118, v124, v124
v_fmac_f32 v119, v125, v125
v_lshlrev_b32 v126, 16, v99
v_and_b32 v127, 0xffff0000, v99
v_add_f32 v116, v116, v126
v_add_f32 v117, v117, v127
v_fmac_f32 v118, v126, v126
v_fmac_f32 v119, v127, v127
v_lshlrev_b32 v124, 16, v100
v_and_b32 v125, 0xffff0000, v100
v_add_f32 v116, v116, v124
v_add_f32 v117, v117, v125
v_fmac_f32 v118, v124, v124
v_fmac_f32 v119, v125, v125
v_lshlrev_b32 v126, 16, v101
v_and_b32 v127, 0xffff0000, v101
v_add_f32 v116, v116, v126
v_add_f32 v117, v117, v127
v_fmac_f32 v118, v126, v126
v_fmac_f32 v119, v127, v127
v_lshlrev_b32 v124, 16, v102
v_and_b32 v125, 0xffff0000, v102
v_add_f32 v116, v116, v124
v_add_f32 v117, v117, v125
v_fmac_f32 v118, v124, v124
v_fmac_f32 v119, v125, v125
v_lshlrev_b32 v126, 16, v103
v_and_b32 v127, 0xffff0000, v103
v_add_f32 v116, v116, v126
v_add_f32 v117, v117, v127
v_fmac_f32 v118, v126, v126
v_fmac_f32 v119, v127, v127
v_lshlrev_b32 v124, 16, v104
v_and_b32 v125, 0xffff0000, v104
v_mov_b32 v120, v124
v_mov_b32 v121, v125
v_mul_f32 v122, v124, v124
v_mul_f32 v123, v125, v125
v_lshlrev_b32 v126, 16, v105
v_and_b32 v127, 0xffff0000, v105
v_add_f32 v120, v120, v126
v_add_f32 v121, v121, v127
v_fmac_f32 v122, v126, v126
v_fmac_f32 v123, v127, v127
v_lshlrev_b32 v124, 16, v106
v_and_b32 v125, 0xffff0000, v106
v_add_f32 v120, v120, v124
v_add_f32 v121, v121, v125
v_fmac_f32 v122, v124, v124
v_fmac_f32 v123, v125, v125
v_lshlrev_b32 v126, 16, v107
v_and_b32 v127, 0xffff0000, v107
v_add_f32 v120, v120, v126
v_add_f32 v121, v121, v127
v_fmac_f32 v122, v126, v126
v_fmac_f32 v123, v127, v127
v_lshlrev_b32 v124, 16, v108
v_and_b32 v125, 0xffff0000, v108
v_add_f32 v120, v120, v124
v_add_f32 v121, v121, v125
v_fmac_f32 v122, v124, v124
v_fmac_f32 v123, v125, v125
v_lshlrev_b32 v126, 16, v109
v_and_b32 v127, 0xffff0000, v109
v_add_f32 v120, v120, v126
v_add_f32 v121, v121, v127
v_fmac_f32 v122, v126, v126
v_fmac_f32 v123, v127, v127
v_lshlrev_b32 v124, 16, v110
v_and_b32 v125, 0xffff0000, v110
v_add_f32 v120, v120, v124
v_add_f32 v121, v121, v125
v_fmac_f32 v122, v124, v124
v_fmac_f32 v123, v125, v125
v_lshlrev_b32 v126, 16, v111
v_and_b32 v127, 0xffff0000, v111
v_add_f32 v120, v120, v126
v_add_f32 v121, v121, v127
v_fmac_f32 v122, v126, v126
v_fmac_f32 v123, v127, v127
v_add_f32 v116, v116, v117
v_add_f32 v118, v118, v119
v_add_f32 v120, v120, v121
v_add_f32 v122, v122, v123
s_nop 0
v_add_f32_dpp v116, v116, v116 row_ror:8 row_mask:0xf bank_mask:0xf
v_add_f32_dpp v118, v118, v118 row_ror:8 row_mask:0xf bank_mask:0xf
v_add_f32_dpp v120, v120, v120 row_ror:8 row_mask:0xf bank_mask:0xf
v_add_f32_dpp v122, v122, v122 row_ror:8 row_mask:0xf bank_mask:0xf
v_add_f32_dpp v116, v116, v116 row_ror:4 row_mask:0xf bank_mask:0xf
v_add_f32_dpp v118, v118, v118 row_ror:4 row_mask:0xf bank_mask:0xf
v_add_f32_dpp v120, v120, v120 row_ror:4 row_mask:0xf bank_mask:0xf
v_add_f32_dpp v122, v122, v122 row_ror:4 row_mask:0xf bank_mask:0xf
v_add_f32_dpp v116, v116, v116 row_ror:2 row_mask:0xf bank_mask:0xf
v_add_f32_dpp v118, v118, v118 row_ror:2 row_mask:0xf bank_mask:0xf
v_add_f32_dpp v120, v120, v120 row_ror:2 row_mask:0xf bank_mask:0xf
v_add_f32_dpp v122, v122, v122 row_ror:2 row_mask:0xf bank_mask:0xf
v_add_f32_dpp v116, v116, v116 row_ror:1 row_mask:0xf bank_mask:0xf
v_add_f32_dpp v118, v118, v118 row_ror:1 row_mask:0xf bank_mask:0xf
v_add_f32_dpp v120, v120, v120 row_ror:1 row_mask:0xf bank_mask:0xf
v_add_f32_dpp v122, v122, v122 row_ror:1 row_mask:0xf bank_mask:0xf
v_mov_b32 v117, v116
v_mov_b32 v119, v118
v_mov_b32 v121, v120
v_mov_b32 v123, v122
s_nop 0
v_permlane16_swap_b32 v116, v117
v_permlane16_swap_b32 v118, v119
v_permlane16_swap_b32 v120, v121
v_permlane16_swap_b32 v122, v123
v_add_f32 v116, v116, v117
v_add_f32 v118, v118, v119
v_add_f32 v120, v120, v121
v_add_f32 v122, v122, v123
v_mov_b32 v117, v116
v_mov_b32 v119, v118
v_mov_b32 v121, v120
v_mov_b32 v123, v122
s_nop 0
v_permlane32_swap_b32 v116, v117
v_permlane32_swap_b32 v118, v119
v_permlane32_swap_b32 v120, v121
v_permlane32_swap_b32 v122, v123
v_add_f32 v116, v116, v117
v_add_f32 v118, v118, v119
v_add_f32 v120, v120, v121
v_add_f32 v122, v122, v123
v_mul_f32 v112, 0x3a800000, v116
v_mul_f32 v113, 0x3a800000, v118
v_fma_f32 v113, -v112, v112, v113
v_max_f32 v113, 0, v113
v_add_f32 v113, 0x3727c5ac, v113
v_rsq_f32 v113, v113
v_mul_f32 v114, 0x3a800000, v120
v_mul_f32 v115, 0x3a800000, v122
v_fma_f32 v115, -v114, v114, v115
v_max_f32 v115, 0, v115
v_add_f32 v115, 0x3727c5ac, v115
v_rsq_f32 v115, v115
s_nop 0
s_lshl_b32 s43, s47, 4
s_add_u32 s43, s43, 148608
v_mov_b32 v11, s43
ds_write_b128 v11, v[112:115]
s_waitcnt lgkmcnt(0)
s_waitcnt vmcnt(14)
s_barrier
s_add_u32 m0, s39, 86016
s_mov_b64 exec, s[60:61]
buffer_load_dwordx4 v4, s[8:11], s37 offen lds
s_mov_b64 exec, -1
s_add_u32 m0, s39, 89088
s_nop 0
buffer_load_dwordx4 v5, s[8:11], s37 offen lds
s_add_u32 m0, s39, 92160
s_nop 0
buffer_load_dwordx4 v6, s[8:11], s37 offen lds
s_add_u32 m0, s39, 95232
s_nop 0
buffer_load_dwordx4 v7, s[8:11], s37 offen lds
s_add_u32 m0, s39, 98304
s_nop 0
buffer_load_dwordx4 v8, s[8:11], s37 offen lds
s_add_u32 m0, s39, 101376
s_nop 0
buffer_load_dwordx4 v9, s[8:11], s37 offen lds
s_add_u32 m0, s40, 86016
s_add_u32 s43, s38, 0
buffer_load_dwordx4 v2, s[12:15], s43 offen lds
s_add_u32 m0, s40, 87040
s_add_u32 s43, s38, 49152
buffer_load_dwordx4 v3, s[12:15], s43 offen lds
s_add_u32 m0, s40, 88064
s_add_u32 s43, s38, 98304
buffer_load_dwordx4 v2, s[12:15], s43 offen lds
s_add_u32 m0, s40, 89088
s_add_u32 s43, s38, 147456
buffer_load_dwordx4 v3, s[12:15], s43 offen lds
s_add_u32 m0, s40, 90112
s_add_u32 s43, s38, 196608
buffer_load_dwordx4 v2, s[12:15], s43 offen lds
s_add_u32 m0, s40, 91136
s_add_u32 s43, s38, 245760
buffer_load_dwordx4 v3, s[12:15], s43 offen lds
s_add_u32 m0, s40, 92160
s_add_u32 s43, s38, 294912
buffer_load_dwordx4 v2, s[12:15], s43 offen lds
s_add_u32 m0, s40, 93184
s_add_u32 s43, s38, 344064
buffer_load_dwordx4 v3, s[12:15], s43 offen lds
s_add_u32 s37, s37, 128
s_add_u32 s38, s38, 393216
s_waitcnt vmcnt(14)
s_barrier
s_mov_b32 s41, 3
Lpl_7:
s_add_u32 m0, s39, 0
s_mov_b64 exec, s[60:61]
buffer_load_dwordx4 v4, s[8:11], s37 offen lds
s_mov_b64 exec, -1
s_add_u32 m0, s39, 3072
s_nop 0
buffer_load_dwordx4 v5, s[8:11], s37 offen lds
s_add_u32 m0, s39, 6144
s_nop 0
buffer_load_dwordx4 v6, s[8:11], s37 offen lds
s_add_u32 m0, s39, 9216
s_nop 0
buffer_load_dwordx4 v7, s[8:11], s37 offen lds
s_add_u32 m0, s39, 12288
s_nop 0
buffer_load_dwordx4 v8, s[8:11], s37 offen lds
s_add_u32 m0, s39, 15360
s_nop 0
buffer_load_dwordx4 v9, s[8:11], s37 offen lds
s_add_u32 m0, s40, 0
s_add_u32 s43, s38, 0
buffer_load_dwordx4 v2, s[12:15], s43 offen lds
s_add_u32 m0, s40, 1024
s_add_u32 s43, s38, 49152
buffer_load_dwordx4 v3, s[12:15], s43 offen lds
s_add_u32 m0, s40, 2048
s_add_u32 s43, s38, 98304
buffer_load_dwordx4 v2, s[12:15], s43 offen lds
s_add_u32 m0, s40, 3072
s_add_u32 s43, s38, 147456
buffer_load_dwordx4 v3, s[12:15], s43 offen lds
s_add_u32 m0, s40, 4096
s_add_u32 s43, s38, 196608
buffer_load_dwordx4 v2, s[12:15], s43 offen lds
s_add_u32 m0, s40, 5120
s_add_u32 s43, s38, 245760
buffer_load_dwordx4 v3, s[12:15], s43 offen lds
s_add_u32 m0, s40, 6144
s_add_u32 s43, s38, 294912
buffer_load_dwordx4 v2, s[12:15], s43 offen lds
s_add_u32 m0, s40, 7168
s_add_u32 s43, s38, 344064
buffer_load_dwordx4 v3, s[12:15], s43 offen lds
s_add_u32 s37, s37, 128
s_add_u32 s38, s38, 393216
s_waitcnt vmcnt(14)
s_barrier
s_add_u32 m0, s39, 43008
s_mov_b64 exec, s[60:61]
buffer_load_dwordx4 v4, s[8:11], s37 offen lds
s_mov_b64 exec, -1
s_add_u32 m0, s39, 46080
s_nop 0
buffer_load_dwordx4 v5, s[8:11], s37 offen lds
s_add_u32 m0, s39, 49152
s_nop 0
buffer_load_dwordx4 v6, s[8:11], s37 offen lds
s_add_u32 m0, s39, 52224
s_nop 0
buffer_load_dwordx4 v7, s[8:11], s37 offen lds
s_add_u32 m0, s39, 55296
s_nop 0
buffer_load_dwordx4 v8, s[8:11], s37 offen lds
s_add_u32 m0, s39, 58368
s_nop 0
buffer_load_dwordx4 v9, s[8:11], s37 offen lds
s_add_u32 m0, s40, 43008
s_add_u32 s43, s38, 0
buffer_load_dwordx4 v2, s[12:15], s43 offen lds
s_add_u32 m0, s40, 44032
s_add_u32 s43, s38, 49152
buffer_load_dwordx4 v3, s[12:15], s43 offen lds
s_add_u32 m0, s40, 45056
s_add_u32 s43, s38, 98304
buffer_load_dwordx4 v2, s[12:15], s43 offen lds
s_add_u32 m0, s40, 46080
s_add_u32 s43, s38, 147456
buffer_load_dwordx4 v3, s[12:15], s43 offen lds
s_add_u32 m0, s40, 47104
s_add_u32 s43, s38, 196608
buffer_load_dwordx4 v2, s[12:15], s43 offen lds
s_add_u32 m0, s40, 48128
s_add_u32 s43, s38, 245760
buffer_load_dwordx4 v3, s[12:15], s43 offen lds
s_add_u32 m0, s40, 49152
s_add_u32 s43, s38, 294912
buffer_load_dwordx4 v2, s[12:15], s43 offen lds
s_add_u32 m0, s40, 50176
s_add_u32 s43, s38, 344064
buffer_load_dwordx4 v3, s[12:15], s43 offen lds
s_add_u32 s37, s37, 128
s_add_u32 s38, s38, 393216
s_waitcnt vmcnt(14)
s_barrier
s_add_u32 m0, s39, 86016
s_mov_b64 exec, s[60:61]
buffer_load_dwordx4 v4, s[8:11], s37 offen lds
s_mov_b64 exec, -1
s_add_u32 m0, s39, 89088
s_nop 0
buffer_load_dwordx4 v5, s[8:11], s37 offen lds
s_add_u32 m0, s39, 92160
s_nop 0
buffer_load_dwordx4 v6, s[8:11], s37 offen lds
s_add_u32 m0, s39, 95232
s_nop 0
buffer_load_dwordx4 v7, s[8:11], s37 offen lds
s_add_u32 m0, s39, 98304
s_nop 0
buffer_load_dwordx4 v8, s[8:11], s37 offen lds
s_add_u32 m0, s39, 101376
s_nop 0
buffer_load_dwordx4 v9, s[8:11], s37 offen lds
s_add_u32 m0, s40, 86016
s_add_u32 s43, s38, 0
buffer_load_dwordx4 v2, s[12:15], s43 offen lds
s_add_u32 m0, s40, 87040
s_add_u32 s43, s38, 49152
buffer_load_dwordx4 v3, s[12:15], s43 offen lds
s_add_u32 m0, s40, 88064
s_add_u32 s43, s38, 98304
buffer_load_dwordx4 v2, s[12:15], s43 offen lds
s_add_u32 m0, s40, 89088
s_add_u32 s43, s38, 147456
buffer_load_dwordx4 v3, s[12:15], s43 offen lds
s_add_u32 m0, s40, 90112
s_add_u32 s43, s38, 196608
buffer_load_dwordx4 v2, s[12:15], s43 offen lds
s_add_u32 m0, s40, 91136
s_add_u32 s43, s38, 245760
buffer_load_dwordx4 v3, s[12:15], s43 offen lds
s_add_u32 m0, s40, 92160
s_add_u32 s43, s38, 294912
buffer_load_dwordx4 v2, s[12:15], s43 offen lds
s_add_u32 m0, s40, 93184
s_add_u32 s43, s38, 344064
buffer_load_dwordx4 v3, s[12:15], s43 offen lds
s_add_u32 s37, s37, 128
s_add_u32 s38, s38, 393216
s_waitcnt vmcnt(14)
s_barrier
s_sub_u32 s41, s41, 1
s_cmp_lg_u32 s41, 0
s_cbranch_scc1 Lpl_7
s_add_u32 m0, s39, 0
s_mov_b64 exec, s[60:61]
buffer_load_dwordx4 v4, s[8:11], s37 offen lds
s_mov_b64 exec, -1
s_add_u32 m0, s39, 3072
s_nop 0
buffer_load_dwordx4 v5, s[8:11], s37 offen lds
s_add_u32 m0, s39, 6144
s_nop 0
buffer_load_dwordx4 v6, s[8:11], s37 offen lds
s_add_u32 m0, s39, 9216
s_nop 0
buffer_load_dwordx4 v7, s[8:11], s37 offen lds
s_add_u32 m0, s39, 12288
s_nop 0
buffer_load_dwordx4 v8, s[8:11], s37 offen lds
s_add_u32 m0, s39, 15360
s_nop 0
buffer_load_dwordx4 v9, s[8:11], s37 offen lds
s_add_u32 m0, s40, 0
s_add_u32 s43, s38, 0
buffer_load_dwordx4 v2, s[12:15], s43 offen lds
s_add_u32 m0, s40, 1024
s_add_u32 s43, s38, 49152
buffer_load_dwordx4 v3, s[12:15], s43 offen lds
s_add_u32 m0, s40, 2048
s_add_u32 s43, s38, 98304
buffer_load_dwordx4 v2, s[12:15], s43 offen lds
s_add_u32 m0, s40, 3072
s_add_u32 s43, s38, 147456
buffer_load_dwordx4 v3, s[12:15], s43 offen lds
s_add_u32 m0, s40, 4096
s_add_u32 s43, s38, 196608
buffer_load_dwordx4 v2, s[12:15], s43 offen lds
s_add_u32 m0, s40, 5120
s_add_u32 s43, s38, 245760
buffer_load_dwordx4 v3, s[12:15], s43 offen lds
s_add_u32 m0, s40, 6144
s_add_u32 s43, s38, 294912
buffer_load_dwordx4 v2, s[12:15], s43 offen lds
s_add_u32 m0, s40, 7168
s_add_u32 s43, s38, 344064
buffer_load_dwordx4 v3, s[12:15], s43 offen lds
s_add_u32 s37, s37, 128
s_add_u32 s38, s38, 393216
s_waitcnt vmcnt(14)
s_barrier
s_waitcnt vmcnt(0)
s_barrier
s_barrier
s_barrier
s_lshl_b32 s43, s35, 7
s_add_u32 s24, s68, s43
s_addc_u32 s25, s69, 0
s_mov_b32 s26, 2095232
s_mov_b32 s27, 0x20000
v_lshrrev_b32 v15, 3, v1
v_and_b32 v16, 6, v15
v_and_b32 v14, 7, v1
v_xor_b32 v14, v14, v16
v_lshlrev_b32 v14, 4, v14
v_mul_u32_u24 v15, 2048, v15
v_add_u32 v14, v14, v15
s_sub_u32 s44, s36, 4
s_lshl_b32 s45, s44, 13
s_lshl_b32 s44, s44, 17
s_add_u32 m0, s45, 114688
s_add_u32 s43, s44, 0
buffer_load_dwordx4 v14, s[24:27], s43 offen lds
s_add_u32 m0, s45, 115712
s_add_u32 s43, s44, 16384
buffer_load_dwordx4 v14, s[24:27], s43 offen lds
s_add_u32 m0, s45, 116736
s_add_u32 s43, s44, 32768
buffer_load_dwordx4 v14, s[24:27], s43 offen lds
s_add_u32 m0, s45, 117760
s_add_u32 s43, s44, 49152
buffer_load_dwordx4 v14, s[24:27], s43 offen lds
s_add_u32 m0, s45, 118784
s_add_u32 s43, s44, 65536
buffer_load_dwordx4 v14, s[24:27], s43 offen lds
s_add_u32 m0, s45, 119808
s_add_u32 s43, s44, 81920
buffer_load_dwordx4 v14, s[24:27], s43 offen lds
s_add_u32 m0, s45, 120832
s_add_u32 s43, s44, 98304
buffer_load_dwordx4 v14, s[24:27], s43 offen lds
s_add_u32 m0, s45, 121856
s_add_u32 s43, s44, 114688
buffer_load_dwordx4 v14, s[24:27], s43 offen lds
s_branch Latt_5
Lpf_4:
s_lshl_b32 s43, s51, 11
buffer_load_dwordx4 v[96:99], v10, s[8:11], s43 offen offset:0
buffer_load_dwordx4 v[100:103], v10, s[8:11], s43 offen offset:1024
buffer_load_dwordx4 v[104:107], v10, s[8:11], s43 offen offset:2048
buffer_load_dwordx4 v[108:111], v10, s[8:11], s43 offen offset:3072
v_min_u32 v14, 23, v1
v_mul_u32_u24 v15, 21846, v14
v_lshrrev_b32 v15, 16, v15
v_mul_u32_u24 v16, 3, v15
v_sub_u32 v16, v14, v16
s_lshl_b32 s43, s48, 3
v_add_u32 v15, s43, v15
v_mul_u32_u24 v15, 6144, v15
v_lshl_add_u32 v3, v16, 11, v15
v_min_u32 v14, 23, v1
v_lshrrev_b32 v15, 3, v14
v_mul_u32_u24 v15, 43008, v15
v_and_b32 v14, 7, v14
v_lshl_add_u32 v15, v14, 4, v15
v_mov_b32 v32, 0x3f803f80
v_mov_b32 v33, 0x3f803f80
v_mov_b32 v34, 0x3f803f80
v_mov_b32 v35, 0x3f803f80
ds_write_b128 v15, v[32:35]
s_add_u32 s20, s82, 26214400
s_addc_u32 s21, s83, 0
s_mov_b32 s22, 16384
s_mov_b32 s23, 0x20000
s_mov_b32 s56, s80
s_mov_b32 s57, s81
s_mov_b32 s58, 256
s_mov_b32 s59, 0x20000
s_add_u32 s84, s82, 28311552
s_addc_u32 s85, s83, 0
s_mov_b32 s86, 49152
s_mov_b32 s87, 0x20000
v_mov_b32 v5, 0
s_add_u32 s43, s2, 128
s_lshl_b32 s43, s43, 7
v_lshlrev_b32 v14, 2, v1
s_mov_b64 exec, 15
buffer_store_dword v5, v14, s[84:87], s43 offen sc1
s_mov_b64 exec, -1
v_lshlrev_b32 v14, 7, v1
s_or_b32 s43, s34, s35
s_cmp_eq_u32 s43, 0
s_cselect_b32 s43, 0, 0x7fffffff
s_cselect_b32 s44, 0x2000, s43
buffer_store_dword v5, v14, s[84:87], s43 offen sc1
s_mov_b64 exec, 0xffff
buffer_store_dword v5, v14, s[84:87], s44 offen sc1
s_mov_b64 exec, -1
s_waitcnt lgkmcnt(0)
s_barrier
s_mov_b32 s43, 1179648
buffer_load_dword v31, v3, s[12:15], s43 offen
s_mov_b32 s43, 1572864
buffer_load_dword v31, v3, s[12:15], s43 offen
s_mov_b32 s43, 1966080
buffer_load_dword v31, v3, s[12:15], s43 offen
s_mov_b32 s43, 2359296
buffer_load_dword v31, v3, s[12:15], s43 offen
s_barrier
s_mov_b32 s43, 2752512
buffer_load_dword v31, v3, s[12:15], s43 offen
s_mov_b32 s43, 3145728
buffer_load_dword v31, v3, s[12:15], s43 offen
s_mov_b32 s43, 3538944
buffer_load_dword v31, v3, s[12:15], s43 offen
s_mov_b32 s43, 3932160
buffer_load_dword v31, v3, s[12:15], s43 offen
s_barrier
s_waitcnt vmcnt(11)
v_lshlrev_b32 v124, 16, v96
v_and_b32 v125, 0xffff0000, v96
v_mov_b32 v116, v124
v_mov_b32 v117, v125
v_mul_f32 v118, v124, v124
v_mul_f32 v119, v125, v125
v_lshlrev_b32 v126, 16, v97
v_and_b32 v127, 0xffff0000, v97
v_add_f32 v116, v116, v126
v_add_f32 v117, v117, v127
v_fmac_f32 v118, v126, v126
v_fmac_f32 v119, v127, v127
v_lshlrev_b32 v124, 16, v98
v_and_b32 v125, 0xffff0000, v98
v_add_f32 v116, v116, v124
v_add_f32 v117, v117, v125
v_fmac_f32 v118, v124, v124
v_fmac_f32 v119, v125, v125
v_lshlrev_b32 v126, 16, v99
v_and_b32 v127, 0xffff0000, v99
v_add_f32 v116, v116, v126
v_add_f32 v117, v117, v127
v_fmac_f32 v118, v126, v126
v_fmac_f32 v119, v127, v127
v_lshlrev_b32 v124, 16, v100
v_and_b32 v125, 0xffff0000, v100
v_add_f32 v116, v116, v124
v_add_f32 v117, v117, v125
v_fmac_f32 v118, v124, v124
v_fmac_f32 v119, v125, v125
v_lshlrev_b32 v126, 16, v101
v_and_b32 v127, 0xffff0000, v101
v_add_f32 v116, v116, v126
v_add_f32 v117, v117, v127
v_fmac_f32 v118, v126, v126
v_fmac_f32 v119, v127, v127
v_lshlrev_b32 v124, 16, v102
v_and_b32 v125, 0xffff0000, v102
v_add_f32 v116, v116, v124
v_add_f32 v117, v117, v125
v_fmac_f32 v118, v124, v124
v_fmac_f32 v119, v125, v125
v_lshlrev_b32 v126, 16, v103
v_and_b32 v127, 0xffff0000, v103
v_add_f32 v116, v116, v126
v_add_f32 v117, v117, v127
v_fmac_f32 v118, v126, v126
v_fmac_f32 v119, v127, v127
v_lshlrev_b32 v124, 16, v104
v_and_b32 v125, 0xffff0000, v104
v_mov_b32 v120, v124
v_mov_b32 v121, v125
v_mul_f32 v122, v124, v124
v_mul_f32 v123, v125, v125
v_lshlrev_b32 v126, 16, v105
v_and_b32 v127, 0xffff0000, v105
v_add_f32 v120, v120, v126
v_add_f32 v121, v121, v127
v_fmac_f32 v122, v126, v126
v_fmac_f32 v123, v127, v127
v_lshlrev_b32 v124, 16, v106
v_and_b32 v125, 0xffff0000, v106
v_add_f32 v120, v120, v124
v_add_f32 v121, v121, v125
v_fmac_f32 v122, v124, v124
v_fmac_f32 v123, v125, v125
v_lshlrev_b32 v126, 16, v107
v_and_b32 v127, 0xffff0000, v107
v_add_f32 v120, v120, v126
v_add_f32 v121, v121, v127
v_fmac_f32 v122, v126, v126
v_fmac_f32 v123, v127, v127
v_lshlrev_b32 v124, 16, v108
v_and_b32 v125, 0xffff0000, v108
v_add_f32 v120, v120, v124
v_add_f32 v121, v121, v125
v_fmac_f32 v122, v124, v124
v_fmac_f32 v123, v125, v125
v_lshlrev_b32 v126, 16, v109
v_and_b32 v127, 0xffff0000, v109
v_add_f32 v120, v120, v126
v_add_f32 v121, v121, v127
v_fmac_f32 v122, v126, v126
v_fmac_f32 v123, v127, v127
v_lshlrev_b32 v124, 16, v110
v_and_b32 v125, 0xffff0000, v110
v_add_f32 v120, v120, v124
v_add_f32 v121, v121, v125
v_fmac_f32 v122, v124, v124
v_fmac_f32 v123, v125, v125
v_lshlrev_b32 v126, 16, v111
v_and_b32 v127, 0xffff0000, v111
v_add_f32 v120, v120, v126
v_add_f32 v121, v121, v127
v_fmac_f32 v122, v126, v126
v_fmac_f32 v123, v127, v127
v_add_f32 v116, v116, v117
v_add_f32 v118, v118, v119
v_add_f32 v120, v120, v121
v_add_f32 v122, v122, v123
s_nop 0
v_add_f32_dpp v116, v116, v116 row_ror:8 row_mask:0xf bank_mask:0xf
v_add_f32_dpp v118, v118, v118 row_ror:8 row_mask:0xf bank_mask:0xf
v_add_f32_dpp v120, v120, v120 row_ror:8 row_mask:0xf bank_mask:0xf
v_add_f32_dpp v122, v122, v122 row_ror:8 row_mask:0xf bank_mask:0xf
v_add_f32_dpp v116, v116, v116 row_ror:4 row_mask:0xf bank_mask:0xf
v_add_f32_dpp v118, v118, v118 row_ror:4 row_mask:0xf bank_mask:0xf
v_add_f32_dpp v120, v120, v120 row_ror:4 row_mask:0xf bank_mask:0xf
v_add_f32_dpp v122, v122, v122 row_ror:4 row_mask:0xf bank_mask:0xf
v_add_f32_dpp v116, v116, v116 row_ror:2 row_mask:0xf bank_mask:0xf
v_add_f32_dpp v118, v118, v118 row_ror:2 row_mask:0xf bank_mask:0xf
v_add_f32_dpp v120, v120, v120 row_ror:2 row_mask:0xf bank_mask:0xf
v_add_f32_dpp v122, v122, v122 row_ror:2 row_mask:0xf bank_mask:0xf
v_add_f32_dpp v116, v116, v116 row_ror:1 row_mask:0xf bank_mask:0xf
v_add_f32_dpp v118, v118, v118 row_ror:1 row_mask:0xf bank_mask:0xf
v_add_f32_dpp v120, v120, v120 row_ror:1 row_mask:0xf bank_mask:0xf
v_add_f32_dpp v122, v122, v122 row_ror:1 row_mask:0xf bank_mask:0xf
v_mov_b32 v117, v116
v_mov_b32 v119, v118
v_mov_b32 v121, v120
v_mov_b32 v123, v122
s_nop 0
v_permlane16_swap_b32 v116, v117
v_permlane16_swap_b32 v118, v119
v_permlane16_swap_b32 v120, v121
v_permlane16_swap_b32 v122, v123
v_add_f32 v116, v116, v117
v_add_f32 v118, v118, v119
v_add_f32 v120, v120, v121
v_add_f32 v122, v122, v123
v_mov_b32 v117, v116
v_mov_b32 v119, v118
v_mov_b32 v121, v120
v_mov_b32 v123, v122
s_nop 0
v_permlane32_swap_b32 v116, v117
v_permlane32_swap_b32 v118, v119
v_permlane32_swap_b32 v120, v121
v_permlane32_swap_b32 v122, v123
v_add_f32 v116, v116, v117
v_add_f32 v118, v118, v119
v_add_f32 v120, v120, v121
v_add_f32 v122, v122, v123
v_mul_f32 v112, 0x3a800000, v116
v_mul_f32 v113, 0x3a800000, v118
v_fma_f32 v113, -v112, v112, v113
v_max_f32 v113, 0, v113
v_add_f32 v113, 0x3727c5ac, v113
v_rsq_f32 v113, v113
v_mul_f32 v114, 0x3a800000, v120
v_mul_f32 v115, 0x3a800000, v122
v_fma_f32 v115, -v114, v114, v115
v_max_f32 v115, 0, v115
v_add_f32 v115, 0x3727c5ac, v115
v_rsq_f32 v115, v115
s_nop 0
s_lshl_b32 s43, s47, 4
s_add_u32 s43, s43, 148608
v_mov_b32 v11, s43
ds_write_b128 v11, v[112:115]
s_waitcnt lgkmcnt(0)
s_mov_b32 s43, 4325376
buffer_load_dword v31, v3, s[12:15], s43 offen
s_mov_b32 s43, 4718592
buffer_load_dword v31, v3, s[12:15], s43 offen
s_mov_b32 s43, 5111808
buffer_load_dword v31, v3, s[12:15], s43 offen
s_mov_b32 s43, 5505024
buffer_load_dword v31, v3, s[12:15], s43 offen
s_barrier
v_lshlrev_b32 v5, 4, v1
v_and_b32 v5, 63, v5
v_add_u32 v6, 148608, v5
ds_read_b128 v[112:115], v6
s_lshl_b32 s43, s63, 3
v_add_u32 v5, s43, v5
s_waitcnt lgkmcnt(0)
s_mov_b64 exec, 15
buffer_store_dwordx4 v[112:115], v5, s[20:23], 0 offen sc1
s_mov_b64 exec, -1
s_mov_b32 s43, 5898240
buffer_load_dword v31, v3, s[12:15], s43 offen
s_barrier
s_barrier
s_barrier
s_waitcnt vmcnt(1)
s_lshl_b32 s43, s34, 4
s_add_u32 s43, s43, s35
v_mov_b32 v5, s43
v_mov_b32 v6, 1
s_mov_b64 exec, 1
buffer_store_byte v6, v5, s[56:59], 0 offen sc1
s_mov_b64 exec, -1
s_barrier
s_barrier
s_lshl_b32 s43, s34, 4
s_sub_u32 s44, s43, 4
s_max_i32 s44, s44, 0
v_lshl_add_u32 v4, v1, 2, s43
v_mov_b32 v6, s44
v_cmp_gt_u32 vcc, 4, v1
s_nop 1
v_cndmask_b32 v4, v6, v4, vcc
v_cmp_eq_u32 vcc, 5, v1
s_nop 1
v_cndmask_b32 v4, v4, 0, vcc
buffer_load_dword v6, v4, s[56:59], 0 offen sc1
s_mov_b32 s62, 0
s_barrier
s_cmp_eq_u32 s62, 2
s_cbranch_scc1 Lste_9
s_waitcnt vmcnt(0)
s_cmp_eq_u32 s62, 1
s_cbranch_scc1 Lst1_8
v_and_b32 v6, 0x01010101, v6
v_cmp_ne_u32 vcc, 0x01010101, v6
s_nop 4
s_cbranch_vccz Lok_10
buffer_load_dword v6, v4, s[56:59], 0 offen sc1
s_branch Lste_9
Lok_10:
v_add_u32 v5, 0, v1
v_min_u32 v5, 143, v5
v_lshlrev_b32 v20, 3, v5
v_add_u32 v5, s50, v5
v_max_i32 v5, 0, v5
v_lshlrev_b32 v5, 3, v5
buffer_load_dwordx2 v[32:33], v5, s[20:23], 0 offen sc1
v_add_u32 v5, 64, v1
v_min_u32 v5, 143, v5
v_lshlrev_b32 v21, 3, v5
v_add_u32 v5, s50, v5
v_max_i32 v5, 0, v5
v_lshlrev_b32 v5, 3, v5
buffer_load_dwordx2 v[34:35], v5, s[20:23], 0 offen sc1
v_add_u32 v5, 128, v1
v_min_u32 v5, 143, v5
v_lshlrev_b32 v22, 3, v5
v_add_u32 v5, s50, v5
v_max_i32 v5, 0, v5
v_lshlrev_b32 v5, 3, v5
buffer_load_dwordx2 v[36:37], v5, s[20:23], 0 offen sc1
s_mov_b32 s62, 1
s_branch Lste_9
Lst1_8:
v_add_u32 v20, 147456, v20
ds_write_b64 v20, v[32:33]
v_add_u32 v21, 147456, v21
ds_write_b64 v21, v[34:35]
v_add_u32 v22, 147456, v22
ds_write_b64 v22, v[36:37]
s_waitcnt lgkmcnt(0)
s_mov_b32 s62, 2
Lste_9:
s_barrier
s_cmp_eq_u32 s62, 2
s_cbranch_scc1 Lste_12
s_waitcnt vmcnt(0)
s_cmp_eq_u32 s62, 1
s_cbranch_scc1 Lst1_11
v_and_b32 v6, 0x01010101, v6
v_cmp_ne_u32 vcc, 0x01010101, v6
s_nop 4
s_cbranch_vccz Lok_13
buffer_load_dword v6, v4, s[56:59], 0 offen sc1
s_branch Lste_12
Lok_13:
v_add_u32 v5, 0, v1
v_min_u32 v5, 143, v5
v_lshlrev_b32 v20, 3, v5
v_add_u32 v5, s50, v5
v_max_i32 v5, 0, v5
v_lshlrev_b32 v5, 3, v5
buffer_load_dwordx2 v[32:33], v5, s[20:23], 0 offen sc1
v_add_u32 v5, 64, v1
v_min_u32 v5, 143, v5
v_lshlrev_b32 v21, 3, v5
v_add_u32 v5, s50, v5
v_max_i32 v5, 0, v5
v_lshlrev_b32 v5, 3, v5
buffer_load_dwordx2 v[34:35], v5, s[20:23], 0 offen sc1
v_add_u32 v5, 128, v1
v_min_u32 v5, 143, v5
v_lshlrev_b32 v22, 3, v5
v_add_u32 v5, s50, v5
v_max_i32 v5, 0, v5
v_lshlrev_b32 v5, 3, v5
buffer_load_dwordx2 v[36:37], v5, s[20:23], 0 offen sc1
s_mov_b32 s62, 1
s_branch Lste_12
Lst1_11:
v_add_u32 v20, 147456, v20
ds_write_b64 v20, v[32:33]
v_add_u32 v21, 147456, v21
ds_write_b64 v21, v[34:35]
v_add_u32 v22, 147456, v22
ds_write_b64 v22, v[36:37]
s_waitcnt lgkmcnt(0)
s_mov_b32 s62, 2
Lste_12:
s_barrier
s_cmp_eq_u32 s62, 2
s_cbranch_scc1 Lste_15
s_waitcnt vmcnt(0)
s_cmp_eq_u32 s62, 1
s_cbranch_scc1 Lst1_14
v_and_b32 v6, 0x01010101, v6
v_cmp_ne_u32 vcc, 0x01010101, v6
s_nop 4
s_cbranch_vccz Lok_16
buffer_load_dword v6, v4, s[56:59], 0 offen sc1
s_branch Lste_15
Lok_16:
v_add_u32 v5, 0, v1
v_min_u32 v5, 143, v5
v_lshlrev_b32 v20, 3, v5
v_add_u32 v5, s50, v5
v_max_i32 v5, 0, v5
v_lshlrev_b32 v5, 3, v5
buffer_load_dwordx2 v[32:33], v5, s[20:23], 0 offen sc1
v_add_u32 v5, 64, v1
v_min_u32 v5, 143, v5
v_lshlrev_b32 v21, 3, v5
v_add_u32 v5, s50, v5
v_max_i32 v5, 0, v5
v_lshlrev_b32 v5, 3, v5
buffer_load_dwordx2 v[34:35], v5, s[20:23], 0 offen sc1
v_add_u32 v5, 128, v1
v_min_u32 v5, 143, v5
v_lshlrev_b32 v22, 3, v5
v_add_u32 v5, s50, v5
v_max_i32 v5, 0, v5
v_lshlrev_b32 v5, 3, v5
buffer_load_dwordx2 v[36:37], v5, s[20:23], 0 offen sc1
s_mov_b32 s62, 1
s_branch Lste_15
Lst1_14:
v_add_u32 v20, 147456, v20
ds_write_b64 v20, v[32:33]
v_add_u32 v21, 147456, v21
ds_write_b64 v21, v[34:35]
v_add_u32 v22, 147456, v22
ds_write_b64 v22, v[36:37]
s_waitcnt lgkmcnt(0)
s_mov_b32 s62, 2
Lste_15:
s_barrier
s_cmp_eq_u32 s62, 2
s_cbranch_scc1 Lste_18
s_waitcnt vmcnt(0)
s_cmp_eq_u32 s62, 1
s_cbranch_scc1 Lst1_17
v_and_b32 v6, 0x01010101, v6
v_cmp_ne_u32 vcc, 0x01010101, v6
s_nop 4
s_cbranch_vccz Lok_19
buffer_load_dword v6, v4, s[56:59], 0 offen sc1
s_branch Lste_18
Lok_19:
v_add_u32 v5, 0, v1
v_min_u32 v5, 143, v5
v_lshlrev_b32 v20, 3, v5
v_add_u32 v5, s50, v5
v_max_i32 v5, 0, v5
v_lshlrev_b32 v5, 3, v5
buffer_load_dwordx2 v[32:33], v5, s[20:23], 0 offen sc1
v_add_u32 v5, 64, v1
v_min_u32 v5, 143, v5
v_lshlrev_b32 v21, 3, v5
v_add_u32 v5, s50, v5
v_max_i32 v5, 0, v5
v_lshlrev_b32 v5, 3, v5
buffer_load_dwordx2 v[34:35], v5, s[20:23], 0 offen sc1
v_add_u32 v5, 128, v1
v_min_u32 v5, 143, v5
v_lshlrev_b32 v22, 3, v5
v_add_u32 v5, s50, v5
v_max_i32 v5, 0, v5
v_lshlrev_b32 v5, 3, v5
buffer_load_dwordx2 v[36:37], v5, s[20:23], 0 offen sc1
s_mov_b32 s62, 1
s_branch Lste_18
Lst1_17:
v_add_u32 v20, 147456, v20
ds_write_b64 v20, v[32:33]
v_add_u32 v21, 147456, v21
ds_write_b64 v21, v[34:35]
v_add_u32 v22, 147456, v22
ds_write_b64 v22, v[36:37]
s_waitcnt lgkmcnt(0)
s_mov_b32 s62, 2
Lste_18:
s_lshl_b32 s43, s35, 7
s_add_u32 s52, s68, s43
s_addc_u32 s53, s69, 0
s_mov_b32 s54, 2095232
s_mov_b32 s55, 0x20000
v_and_b32 v29, 7, v1
v_lshrrev_b32 v30, 3, v1
v_lshl_add_u32 v29, v30, 6, v29
s_lshl_b32 s43, s48, 3
v_add_u32 v29, s43, v29
v_lshlrev_b32 v29, 11, v29
s_mov_b32 s43, 1048576
buffer_load_dword v30, v29, s[52:55], 0 offen
buffer_load_dword v30, v29, s[52:55], s43 offen
s_lshr_b32 s43, s2, 1
s_cmp_ge_u32 s43, 112
s_cbranch_scc1 Lnj_20
s_and_b32 s44, s2, 1
s_cmp_eq_u32 s44, 0
s_cselect_b32 s84, s72, s74
s_cselect_b32 s85, s73, s75
s_mov_b32 s86, 7340032
s_mov_b32 s87, 0x20000
s_mul_i32 s45, s43, 2341
s_lshr_b32 s45, s45, 16
s_mul_i32 s46, s45, 28
s_sub_u32 s46, s43, s46
v_lshrrev_b32 v28, 4, v1
s_lshl_b32 s43, s45, 8
v_add_u32 v28, s43, v28
v_mul_u32_u24 v28, 7168, v28
v_and_b32 v29, 15, v1
v_lshl_add_u32 v28, v29, 4, v28
s_lshl_b32 s43, s46, 8
v_add_u32 v28, s43, v28
s_mov_b32 s43, 0
buffer_load_dwordx4 v[128:131], v28, s[84:87], s43 offen
s_mov_b32 s43, 28672
buffer_load_dwordx4 v[132:135], v28, s[84:87], s43 offen
s_mov_b32 s43, 57344
buffer_load_dwordx4 v[136:139], v28, s[84:87], s43 offen
s_mov_b32 s43, 86016
buffer_load_dwordx4 v[140:143], v28, s[84:87], s43 offen
s_mov_b32 s43, 114688
buffer_load_dwordx4 v[144:147], v28, s[84:87], s43 offen
s_mov_b32 s43, 143360
buffer_load_dwordx4 v[148:151], v28, s[84:87], s43 offen
s_mov_b32 s43, 172032
buffer_load_dwordx4 v[152:155], v28, s[84:87], s43 offen
s_mov_b32 s43, 200704
buffer_load_dwordx4 v[156:159], v28, s[84:87], s43 offen
s_mov_b32 s43, 229376
buffer_load_dwordx4 v[160:163], v28, s[84:87], s43 offen
s_mov_b32 s43, 258048
buffer_load_dwordx4 v[164:167], v28, s[84:87], s43 offen
s_mov_b32 s43, 286720
buffer_load_dwordx4 v[168:171], v28, s[84:87], s43 offen
s_mov_b32 s43, 315392
buffer_load_dwordx4 v[172:175], v28, s[84:87], s43 offen
s_mov_b32 s43, 344064
buffer_load_dwordx4 v[176:179], v28, s[84:87], s43 offen
s_mov_b32 s43, 372736
buffer_load_dwordx4 v[180:183], v28, s[84:87], s43 offen
s_mov_b32 s43, 401408
buffer_load_dwordx4 v[184:187], v28, s[84:87], s43 offen
s_mov_b32 s43, 430080
buffer_load_dwordx4 v[188:191], v28, s[84:87], s43 offen
s_mov_b32 s43, 458752
buffer_load_dwordx4 v[192:195], v28, s[84:87], s43 offen
s_mov_b32 s43, 487424
buffer_load_dwordx4 v[196:199], v28, s[84:87], s43 offen
s_mov_b32 s43, 516096
buffer_load_dwordx4 v[200:203], v28, s[84:87], s43 offen
s_mov_b32 s43, 544768
buffer_load_dwordx4 v[204:207], v28, s[84:87], s43 offen
s_mov_b32 s43, 573440
buffer_load_dwordx4 v[208:211], v28, s[84:87], s43 offen
s_mov_b32 s43, 602112
buffer_load_dwordx4 v[212:215], v28, s[84:87], s43 offen
s_mov_b32 s43, 630784
buffer_load_dwordx4 v[216:219], v28, s[84:87], s43 offen
s_mov_b32 s43, 659456
buffer_load_dwordx4 v[220:223], v28, s[84:87], s43 offen
s_mov_b32 s43, 688128
buffer_load_dwordx4 v[224:227], v28, s[84:87], s43 offen
s_mov_b32 s43, 716800
buffer_load_dwordx4 v[228:231], v28, s[84:87], s43 offen
s_mov_b32 s43, 745472
buffer_load_dwordx4 v[232:235], v28, s[84:87], s43 offen
s_mov_b32 s43, 774144
buffer_load_dwordx4 v[236:239], v28, s[84:87], s43 offen
Lnj_20:
s_barrier
s_cmp_eq_u32 s62, 2
s_cbranch_scc1 Lste_22
s_waitcnt vmcnt(0)
s_cmp_eq_u32 s62, 1
s_cbranch_scc1 Lst1_21
v_and_b32 v6, 0x01010101, v6
v_cmp_ne_u32 vcc, 0x01010101, v6
s_nop 4
s_cbranch_vccz Lok_23
buffer_load_dword v6, v4, s[56:59], 0 offen sc1
s_branch Lste_22
Lok_23:
v_add_u32 v5, 0, v1
v_min_u32 v5, 143, v5
v_lshlrev_b32 v20, 3, v5
v_add_u32 v5, s50, v5
v_max_i32 v5, 0, v5
v_lshlrev_b32 v5, 3, v5
buffer_load_dwordx2 v[32:33], v5, s[20:23], 0 offen sc1
v_add_u32 v5, 64, v1
v_min_u32 v5, 143, v5
v_lshlrev_b32 v21, 3, v5
v_add_u32 v5, s50, v5
v_max_i32 v5, 0, v5
v_lshlrev_b32 v5, 3, v5
buffer_load_dwordx2 v[34:35], v5, s[20:23], 0 offen sc1
v_add_u32 v5, 128, v1
v_min_u32 v5, 143, v5
v_lshlrev_b32 v22, 3, v5
v_add_u32 v5, s50, v5
v_max_i32 v5, 0, v5
v_lshlrev_b32 v5, 3, v5
buffer_load_dwordx2 v[36:37], v5, s[20:23], 0 offen sc1
s_mov_b32 s62, 1
s_branch Lste_22
Lst1_21:
v_add_u32 v20, 147456, v20
ds_write_b64 v20, v[32:33]
v_add_u32 v21, 147456, v21
ds_write_b64 v21, v[34:35]
v_add_u32 v22, 147456, v22
ds_write_b64 v22, v[36:37]
s_waitcnt lgkmcnt(0)
s_mov_b32 s62, 2
Lste_22:
s_barrier
s_cmp_eq_u32 s62, 2
s_cbranch_scc1 Lste_25
s_waitcnt vmcnt(0)
s_cmp_eq_u32 s62, 1
s_cbranch_scc1 Lst1_24
v_and_b32 v6, 0x01010101, v6
v_cmp_ne_u32 vcc, 0x01010101, v6
s_nop 4
s_cbranch_vccz Lok_26
buffer_load_dword v6, v4, s[56:59], 0 offen sc1
s_branch Lste_25
Lok_26:
v_add_u32 v5, 0, v1
v_min_u32 v5, 143, v5
v_lshlrev_b32 v20, 3, v5
v_add_u32 v5, s50, v5
v_max_i32 v5, 0, v5
v_lshlrev_b32 v5, 3, v5
buffer_load_dwordx2 v[32:33], v5, s[20:23], 0 offen sc1
v_add_u32 v5, 64, v1
v_min_u32 v5, 143, v5
v_lshlrev_b32 v21, 3, v5
v_add_u32 v5, s50, v5
v_max_i32 v5, 0, v5
v_lshlrev_b32 v5, 3, v5
buffer_load_dwordx2 v[34:35], v5, s[20:23], 0 offen sc1
v_add_u32 v5, 128, v1
v_min_u32 v5, 143, v5
v_lshlrev_b32 v22, 3, v5
v_add_u32 v5, s50, v5
v_max_i32 v5, 0, v5
v_lshlrev_b32 v5, 3, v5
buffer_load_dwordx2 v[36:37], v5, s[20:23], 0 offen sc1
s_mov_b32 s62, 1
s_branch Lste_25
Lst1_24:
v_add_u32 v20, 147456, v20
ds_write_b64 v20, v[32:33]
v_add_u32 v21, 147456, v21
ds_write_b64 v21, v[34:35]
v_add_u32 v22, 147456, v22
ds_write_b64 v22, v[36:37]
s_waitcnt lgkmcnt(0)
s_mov_b32 s62, 2
Lste_25:
s_barrier
s_cmp_eq_u32 s62, 2
s_cbranch_scc1 Lste_28
s_waitcnt vmcnt(0)
s_cmp_eq_u32 s62, 1
s_cbranch_scc1 Lst1_27
s_mov_b32 s41, 200
Lpoll_30:
v_and_b32 v6, 0x01010101, v6
v_cmp_ne_u32 vcc, 0x01010101, v6
s_nop 4
s_cbranch_vccz Lok_29
buffer_load_dword v6, v4, s[56:59], 0 offen sc1
s_waitcnt vmcnt(0)
s_sub_u32 s41, s41, 1
s_cmp_lg_u32 s41, 0
s_cbranch_scc1 Lpoll_30
s_mov_b32 s41, 0
Lfb_31:
s_add_u32 s62, s50, s41
s_max_i32 s62, s62, 0
s_lshl_b32 s43, s62, 11
buffer_load_dwordx4 v[96:99], v10, s[8:11], s43 offen offset:0
buffer_load_dwordx4 v[100:103], v10, s[8:11], s43 offen offset:1024
buffer_load_dwordx4 v[104:107], v10, s[8:11], s43 offen offset:2048
buffer_load_dwordx4 v[108:111], v10, s[8:11], s43 offen offset:3072
s_waitcnt vmcnt(0)
v_lshlrev_b32 v124, 16, v96
v_and_b32 v125, 0xffff0000, v96
v_mov_b32 v116, v124
v_mov_b32 v117, v125
v_mul_f32 v118, v124, v124
v_mul_f32 v119, v125, v125
v_lshlrev_b32 v126, 16, v97
v_and_b32 v127, 0xffff0000, v97
v_add_f32 v116, v116, v126
v_add_f32 v117, v117, v127
v_fmac_f32 v118, v126, v126
v_fmac_f32 v119, v127, v127
v_lshlrev_b32 v124, 16, v98
v_and_b32 v125, 0xffff0000, v98
v_add_f32 v116, v116, v124
v_add_f32 v117, v117, v125
v_fmac_f32 v118, v124, v124
v_fmac_f32 v119, v125, v125
v_lshlrev_b32 v126, 16, v99
v_and_b32 v127, 0xffff0000, v99
v_add_f32 v116, v116, v126
v_add_f32 v117, v117, v127
v_fmac_f32 v118, v126, v126
v_fmac_f32 v119, v127, v127
v_lshlrev_b32 v124, 16, v100
v_and_b32 v125, 0xffff0000, v100
v_add_f32 v116, v116, v124
v_add_f32 v117, v117, v125
v_fmac_f32 v118, v124, v124
v_fmac_f32 v119, v125, v125
v_lshlrev_b32 v126, 16, v101
v_and_b32 v127, 0xffff0000, v101
v_add_f32 v116, v116, v126
v_add_f32 v117, v117, v127
v_fmac_f32 v118, v126, v126
v_fmac_f32 v119, v127, v127
v_lshlrev_b32 v124, 16, v102
v_and_b32 v125, 0xffff0000, v102
v_add_f32 v116, v116, v124
v_add_f32 v117, v117, v125
v_fmac_f32 v118, v124, v124
v_fmac_f32 v119, v125, v125
v_lshlrev_b32 v126, 16, v103
v_and_b32 v127, 0xffff0000, v103
v_add_f32 v116, v116, v126
v_add_f32 v117, v117, v127
v_fmac_f32 v118, v126, v126
v_fmac_f32 v119, v127, v127
v_lshlrev_b32 v124, 16, v104
v_and_b32 v125, 0xffff0000, v104
v_mov_b32 v120, v124
v_mov_b32 v121, v125
v_mul_f32 v122, v124, v124
v_mul_f32 v123, v125, v125
v_lshlrev_b32 v126, 16, v105
v_and_b32 v127, 0xffff0000, v105
v_add_f32 v120, v120, v126
v_add_f32 v121, v121, v127
v_fmac_f32 v122, v126, v126
v_fmac_f32 v123, v127, v127
v_lshlrev_b32 v124, 16, v106
v_and_b32 v125, 0xffff0000, v106
v_add_f32 v120, v120, v124
v_add_f32 v121, v121, v125
v_fmac_f32 v122, v124, v124
v_fmac_f32 v123, v125, v125
v_lshlrev_b32 v126, 16, v107
v_and_b32 v127, 0xffff0000, v107
v_add_f32 v120, v120, v126
v_add_f32 v121, v121, v127
v_fmac_f32 v122, v126, v126
v_fmac_f32 v123, v127, v127
v_lshlrev_b32 v124, 16, v108
v_and_b32 v125, 0xffff0000, v108
v_add_f32 v120, v120, v124
v_add_f32 v121, v121, v125
v_fmac_f32 v122, v124, v124
v_fmac_f32 v123, v125, v125
v_lshlrev_b32 v126, 16, v109
v_and_b32 v127, 0xffff0000, v109
v_add_f32 v120, v120, v126
v_add_f32 v121, v121, v127
v_fmac_f32 v122, v126, v126
v_fmac_f32 v123, v127, v127
v_lshlrev_b32 v124, 16, v110
v_and_b32 v125, 0xffff0000, v110
v_add_f32 v120, v120, v124
v_add_f32 v121, v121, v125
v_fmac_f32 v122, v124, v124
v_fmac_f32 v123, v125, v125
v_lshlrev_b32 v126, 16, v111
v_and_b32 v127, 0xffff0000, v111
v_add_f32 v120, v120, v126
v_add_f32 v121, v121, v127
v_fmac_f32 v122, v126, v126
v_fmac_f32 v123, v127, v127
v_add_f32 v116, v116, v117
v_add_f32 v118, v118, v119
v_add_f32 v120, v120, v121
v_add_f32 v122, v122, v123
s_nop 0
v_add_f32_dpp v116, v116, v116 row_ror:8 row_mask:0xf bank_mask:0xf
v_add_f32_dpp v118, v118, v118 row_ror:8 row_mask:0xf bank_mask:0xf
v_add_f32_dpp v120, v120, v120 row_ror:8 row_mask:0xf bank_mask:0xf
v_add_f32_dpp v122, v122, v122 row_ror:8 row_mask:0xf bank_mask:0xf
v_add_f32_dpp v116, v116, v116 row_ror:4 row_mask:0xf bank_mask:0xf
v_add_f32_dpp v118, v118, v118 row_ror:4 row_mask:0xf bank_mask:0xf
v_add_f32_dpp v120, v120, v120 row_ror:4 row_mask:0xf bank_mask:0xf
v_add_f32_dpp v122, v122, v122 row_ror:4 row_mask:0xf bank_mask:0xf
v_add_f32_dpp v116, v116, v116 row_ror:2 row_mask:0xf bank_mask:0xf
v_add_f32_dpp v118, v118, v118 row_ror:2 row_mask:0xf bank_mask:0xf
v_add_f32_dpp v120, v120, v120 row_ror:2 row_mask:0xf bank_mask:0xf
v_add_f32_dpp v122, v122, v122 row_ror:2 row_mask:0xf bank_mask:0xf
v_add_f32_dpp v116, v116, v116 row_ror:1 row_mask:0xf bank_mask:0xf
v_add_f32_dpp v118, v118, v118 row_ror:1 row_mask:0xf bank_mask:0xf
v_add_f32_dpp v120, v120, v120 row_ror:1 row_mask:0xf bank_mask:0xf
v_add_f32_dpp v122, v122, v122 row_ror:1 row_mask:0xf bank_mask:0xf
v_mov_b32 v117, v116
v_mov_b32 v119, v118
v_mov_b32 v121, v120
v_mov_b32 v123, v122
s_nop 0
v_permlane16_swap_b32 v116, v117
v_permlane16_swap_b32 v118, v119
v_permlane16_swap_b32 v120, v121
v_permlane16_swap_b32 v122, v123
v_add_f32 v116, v116, v117
v_add_f32 v118, v118, v119
v_add_f32 v120, v120, v121
v_add_f32 v122, v122, v123
v_mov_b32 v117, v116
v_mov_b32 v119, v118
v_mov_b32 v121, v120
v_mov_b32 v123, v122
s_nop 0
v_permlane32_swap_b32 v116, v117
v_permlane32_swap_b32 v118, v119
v_permlane32_swap_b32 v120, v121
v_permlane32_swap_b32 v122, v123
v_add_f32 v116, v116, v117
v_add_f32 v118, v118, v119
v_add_f32 v120, v120, v121
v_add_f32 v122, v122, v123
v_mul_f32 v112, 0x3a800000, v116
v_mul_f32 v113, 0x3a800000, v118
v_fma_f32 v113, -v112, v112, v113
v_max_f32 v113, 0, v113
v_add_f32 v113, 0x3727c5ac, v113
v_rsq_f32 v113, v113
v_mul_f32 v114, 0x3a800000, v120
v_mul_f32 v115, 0x3a800000, v122
v_fma_f32 v115, -v114, v114, v115
v_max_f32 v115, 0, v115
v_add_f32 v115, 0x3727c5ac, v115
v_rsq_f32 v115, v115
s_nop 0
s_lshl_b32 s43, s41, 3
s_add_u32 s43, s43, 147456
v_mov_b32 v5, s43
ds_write_b128 v5, v[112:115]
s_add_u32 s41, s41, 2
s_cmp_lt_u32 s41, 144
s_cbranch_scc1 Lfb_31
v_mov_b32 v5, 0
s_mov_b32 s41, 0x40000
s_waitcnt lgkmcnt(0)
Lz0_32:
buffer_load_ubyte v6, v5, s[56:59], 0 offen sc1
s_waitcnt vmcnt(0)
v_cmp_eq_u32 vcc, 0, v6
s_nop 4
s_cbranch_vccz Lste_28
s_sub_u32 s41, s41, 1
s_cmp_lg_u32 s41, 0
s_cbranch_scc1 Lz0_32
s_branch Lste_28
Lok_29:
v_add_u32 v5, 0, v1
v_min_u32 v5, 143, v5
v_lshlrev_b32 v20, 3, v5
v_add_u32 v5, s50, v5
v_max_i32 v5, 0, v5
v_lshlrev_b32 v5, 3, v5
buffer_load_dwordx2 v[32:33], v5, s[20:23], 0 offen sc1
v_add_u32 v5, 64, v1
v_min_u32 v5, 143, v5
v_lshlrev_b32 v21, 3, v5
v_add_u32 v5, s50, v5
v_max_i32 v5, 0, v5
v_lshlrev_b32 v5, 3, v5
buffer_load_dwordx2 v[34:35], v5, s[20:23], 0 offen sc1
v_add_u32 v5, 128, v1
v_min_u32 v5, 143, v5
v_lshlrev_b32 v22, 3, v5
v_add_u32 v5, s50, v5
v_max_i32 v5, 0, v5
v_lshlrev_b32 v5, 3, v5
buffer_load_dwordx2 v[36:37], v5, s[20:23], 0 offen sc1
s_waitcnt vmcnt(0)
Lst1_27:
v_add_u32 v20, 147456, v20
ds_write_b64 v20, v[32:33]
v_add_u32 v21, 147456, v21
ds_write_b64 v21, v[34:35]
v_add_u32 v22, 147456, v22
ds_write_b64 v22, v[36:37]
s_waitcnt lgkmcnt(0)
Lste_28:
s_barrier
s_barrier
s_lshl_b32 s43, s35, 7
s_add_u32 s24, s68, s43
s_addc_u32 s25, s69, 0
s_mov_b32 s26, 2095232
s_mov_b32 s27, 0x20000
v_lshrrev_b32 v15, 3, v1
v_and_b32 v16, 6, v15
v_and_b32 v14, 7, v1
v_xor_b32 v14, v14, v16
v_lshlrev_b32 v14, 4, v14
v_mul_u32_u24 v15, 2048, v15
v_add_u32 v14, v14, v15
s_sub_u32 s44, s36, 4
s_lshl_b32 s45, s44, 13
s_lshl_b32 s44, s44, 17
s_add_u32 m0, s45, 114688
s_add_u32 s43, s44, 0
buffer_load_dwordx4 v14, s[24:27], s43 offen lds
s_add_u32 m0, s45, 115712
s_add_u32 s43, s44, 16384
buffer_load_dwordx4 v14, s[24:27], s43 offen lds
s_add_u32 m0, s45, 116736
s_add_u32 s43, s44, 32768
buffer_load_dwordx4 v14, s[24:27], s43 offen lds
s_add_u32 m0, s45, 117760
s_add_u32 s43, s44, 49152
buffer_load_dwordx4 v14, s[24:27], s43 offen lds
s_add_u32 m0, s45, 118784
s_add_u32 s43, s44, 65536
buffer_load_dwordx4 v14, s[24:27], s43 offen lds
s_add_u32 m0, s45, 119808
s_add_u32 s43, s44, 81920
buffer_load_dwordx4 v14, s[24:27], s43 offen lds
s_add_u32 m0, s45, 120832
s_add_u32 s43, s44, 98304
buffer_load_dwordx4 v14, s[24:27], s43 offen lds
s_add_u32 m0, s45, 121856
s_add_u32 s43, s44, 114688
buffer_load_dwordx4 v14, s[24:27], s43 offen lds
Latt_5:
s_and_b32 s43, s36, 1
s_lshr_b32 s44, s36, 1
s_and_b32 s44, s44, 1
s_lshr_b32 s45, s36, 2
v_lshlrev_b32 v14, 2, v13
v_sub_u32 v14, v12, v14
v_subrev_u32 v15, 0, v14
v_cmp_ge_u32 s[52:53], 7, v15
v_add_u32 v15, 16, v15
v_cmp_ge_u32 s[84:85], 7, v15
v_subrev_u32 v15, 1, v14
v_cmp_ge_u32 s[54:55], 7, v15
v_add_u32 v15, 16, v15
v_cmp_ge_u32 s[86:87], 7, v15
v_subrev_u32 v15, 2, v14
v_cmp_ge_u32 s[56:57], 7, v15
v_add_u32 v15, 16, v15
v_cmp_ge_u32 s[88:89], 7, v15
v_subrev_u32 v15, 3, v14
v_cmp_ge_u32 s[58:59], 7, v15
v_add_u32 v15, 16, v15
v_cmp_ge_u32 s[90:91], 7, v15
s_lshl_b32 s46, s45, 6
s_add_u32 s46, s46, s44
s_add_u32 s46, s46, 16
v_lshl_add_u32 v14, v12, 1, s46
s_lshl_b32 s47, s43, 6
v_lshl_add_u32 v15, v13, 4, s47
v_mul_u32_u24 v2, 400, v14
v_add_u32 v2, v2, v15
v_subrev_u32 v16, 32, v14
v_max_i32 v16, 0, v16
v_mul_u32_u24 v3, 400, v16
v_add_u32 v3, v3, v15
v_lshrrev_b32 v16, 2, v12
v_lshl_add_u32 v16, v13, 2, v16
v_lshl_add_u32 v16, v16, 1, s46
v_and_b32 v17, 3, v1
v_lshl_add_u32 v17, v17, 3, s47
v_mul_u32_u24 v4, 400, v16
v_add_u32 v4, v4, v17
v_subrev_u32 v16, 32, v16
v_max_i32 v16, 0, v16
v_mul_u32_u24 v5, 400, v16
v_add_u32 v5, v5, v17
s_mul_i32 s60, s34, 262144
s_add_u32 s16, s82, s60
s_addc_u32 s17, s83, 0
s_mov_b32 s18, 262144
s_mov_b32 s19, 0x20000
s_lshl_b32 s60, s35, 14
s_lshl_b32 s43, s43, 13
s_add_u32 s60, s60, s43
s_lshl_b32 s43, s45, 12
s_add_u32 s60, s60, s43
s_lshl_b32 s43, s44, 10
s_add_u32 s60, s60, s43
v_lshlrev_b32 v6, 4, v1
v_mov_b32 v8, 0xff800000
s_mov_b32 s61, 0x3e8293ee
s_or_b32 s62, s34, s45
s_barrier
ds_read_b128 v[32:35], v2 offset:0
ds_read_b128 v[36:39], v2 offset:128
ds_read_b128 v[40:43], v3 offset:128
ds_read_b128 v[80:83], v2 offset:12800
ds_read_b128 v[84:87], v2 offset:12928
ds_read_b128 v[88:91], v2 offset:128
ds_read_b64_tr_b16 v[44:45], v5 offset:256
ds_read_b64_tr_b16 v[46:47], v4 offset:256
ds_read_b64_tr_b16 v[48:49], v5 offset:288
ds_read_b64_tr_b16 v[50:51], v4 offset:288
ds_read_b64_tr_b16 v[92:93], v4 offset:256
ds_read_b64_tr_b16 v[94:95], v4 offset:13056
ds_read_b64_tr_b16 v[96:97], v4 offset:288
ds_read_b64_tr_b16 v[98:99], v4 offset:13088
s_waitcnt lgkmcnt(11)
v_mfma_f32_16x16x32_bf16 v[52:55], v[40:43], v[32:35], 0
v_mfma_f32_16x16x32_bf16 v[56:59], v[36:39], v[32:35], 0
s_waitcnt lgkmcnt(8)
v_mfma_f32_16x16x32_bf16 v[100:103], v[88:91], v[80:83], 0
v_mfma_f32_16x16x32_bf16 v[104:107], v[84:87], v[80:83], 0
s_cmp_lg_u32 s62, 0
s_cselect_b64 s[24:25], s[84:85], 0
s_cselect_b64 s[26:27], s[86:87], 0
s_cselect_b64 s[28:29], s[88:89], 0
s_cselect_b64 s[30:31], s[90:91], 0
s_nop 1
v_cndmask_b32 v52, v8, v52, s[24:25]
v_cndmask_b32 v100, v8, v100, s[84:85]
v_cndmask_b32 v53, v8, v53, s[26:27]
v_cndmask_b32 v101, v8, v101, s[86:87]
v_cndmask_b32 v54, v8, v54, s[28:29]
v_cndmask_b32 v102, v8, v102, s[88:89]
v_cndmask_b32 v55, v8, v55, s[30:31]
v_cndmask_b32 v103, v8, v103, s[90:91]
v_cndmask_b32 v56, v8, v56, s[52:53]
v_cndmask_b32 v104, v8, v104, s[52:53]
v_cndmask_b32 v57, v8, v57, s[54:55]
v_cndmask_b32 v105, v8, v105, s[54:55]
v_cndmask_b32 v58, v8, v58, s[56:57]
v_cndmask_b32 v106, v8, v106, s[56:57]
v_cndmask_b32 v59, v8, v59, s[58:59]
v_cndmask_b32 v107, v8, v107, s[58:59]
v_max3_f32 v60, v52, v53, v54
v_max3_f32 v108, v100, v101, v102
v_max3_f32 v61, v55, v56, v57
v_max3_f32 v109, v103, v104, v105
v_max3_f32 v60, v60, v58, v59
v_max3_f32 v108, v108, v106, v107
v_max_f32 v60, v60, v61
v_max_f32 v108, v108, v109
v_mov_b32 v61, v60
v_mov_b32 v109, v108
s_nop 0
s_nop 0
v_permlane32_swap_b32 v60, v61
v_permlane32_swap_b32 v108, v109
v_max_f32 v60, v60, v61
v_max_f32 v108, v108, v109
v_mov_b32 v61, v60
v_mov_b32 v109, v108
s_nop 0
s_nop 0
v_permlane16_swap_b32 v60, v61
v_permlane16_swap_b32 v108, v109
v_max_f32 v60, v60, v61
v_max_f32 v108, v108, v109
v_mul_f32 v60, s61, v60
v_mul_f32 v108, s61, v108
v_fma_f32 v52, v52, s61, -v60
v_fma_f32 v100, v100, s61, -v108
v_fma_f32 v53, v53, s61, -v60
v_fma_f32 v101, v101, s61, -v108
v_fma_f32 v54, v54, s61, -v60
v_fma_f32 v102, v102, s61, -v108
v_fma_f32 v55, v55, s61, -v60
v_fma_f32 v103, v103, s61, -v108
v_fma_f32 v56, v56, s61, -v60
v_fma_f32 v104, v104, s61, -v108
v_fma_f32 v57, v57, s61, -v60
v_fma_f32 v105, v105, s61, -v108
v_fma_f32 v58, v58, s61, -v60
v_fma_f32 v106, v106, s61, -v108
v_fma_f32 v59, v59, s61, -v60
v_fma_f32 v107, v107, s61, -v108
v_exp_f32 v52, v52
v_exp_f32 v100, v100
v_exp_f32 v53, v53
v_exp_f32 v101, v101
v_exp_f32 v54, v54
v_exp_f32 v102, v102
v_exp_f32 v55, v55
v_exp_f32 v103, v103
v_exp_f32 v56, v56
v_exp_f32 v104, v104
v_exp_f32 v57, v57
v_exp_f32 v105, v105
v_exp_f32 v58, v58
v_exp_f32 v106, v106
v_exp_f32 v59, v59
v_exp_f32 v107, v107
v_cvt_pk_bf16_f32 v64, v52, v53
v_cvt_pk_bf16_f32 v112, v100, v101
v_cvt_pk_bf16_f32 v65, v54, v55
v_cvt_pk_bf16_f32 v113, v102, v103
v_cvt_pk_bf16_f32 v66, v56, v57
v_cvt_pk_bf16_f32 v114, v104, v105
v_cvt_pk_bf16_f32 v67, v58, v59
v_cvt_pk_bf16_f32 v115, v106, v107
v_add_f32 v60, v52, v53
v_add_f32 v108, v100, v101
v_add_f32 v61, v54, v55
v_add_f32 v109, v102, v103
v_add_f32 v56, v56, v57
v_add_f32 v104, v104, v105
v_add_f32 v58, v58, v59
v_add_f32 v106, v106, v107
s_waitcnt lgkmcnt(0)
s_waitcnt lgkmcnt(0)
v_mfma_f32_16x16x32_bf16 v[68:71], v[44:47], v[64:67], 0
v_mfma_f32_16x16x32_bf16 v[116:119], v[92:95], v[112:115], 0
v_mfma_f32_16x16x32_bf16 v[72:75], v[48:51], v[64:67], 0
v_mfma_f32_16x16x32_bf16 v[120:123], v[96:99], v[112:115], 0
v_add_f32 v60, v60, v61
v_add_f32 v108, v108, v109
v_add_f32 v56, v56, v58
v_add_f32 v104, v104, v106
v_add_f32 v60, v60, v56
v_add_f32 v108, v108, v104
v_mov_b32 v61, v60
v_mov_b32 v109, v108
s_nop 0
s_nop 0
v_permlane32_swap_b32 v60, v61
v_permlane32_swap_b32 v108, v109
v_add_f32 v60, v60, v61
v_add_f32 v108, v108, v109
v_mov_b32 v61, v60
v_mov_b32 v109, v108
s_nop 0
s_nop 0
v_permlane16_swap_b32 v60, v61
v_permlane16_swap_b32 v108, v109
v_add_f32 v60, v60, v61
v_add_f32 v108, v108, v109
v_rcp_f32 v60, v60
v_rcp_f32 v108, v108
s_nop 0
s_nop 0
v_pk_mul_f32 v[68:69], v[60:61], v[68:69] op_sel_hi:[0,1]
v_pk_mul_f32 v[116:117], v[108:109], v[116:117] op_sel_hi:[0,1]
v_pk_mul_f32 v[70:71], v[60:61], v[70:71] op_sel_hi:[0,1]
v_pk_mul_f32 v[118:119], v[108:109], v[118:119] op_sel_hi:[0,1]
v_pk_mul_f32 v[72:73], v[60:61], v[72:73] op_sel_hi:[0,1]
v_pk_mul_f32 v[120:121], v[108:109], v[120:121] op_sel_hi:[0,1]
v_pk_mul_f32 v[74:75], v[60:61], v[74:75] op_sel_hi:[0,1]
v_pk_mul_f32 v[122:123], v[108:109], v[122:123] op_sel_hi:[0,1]
v_cvt_pk_bf16_f32 v64, v68, v69
v_cvt_pk_bf16_f32 v112, v116, v117
v_cvt_pk_bf16_f32 v65, v70, v71
v_cvt_pk_bf16_f32 v113, v118, v119
v_cvt_pk_bf16_f32 v66, v72, v73
v_cvt_pk_bf16_f32 v114, v120, v121
v_cvt_pk_bf16_f32 v67, v74, v75
v_cvt_pk_bf16_f32 v115, v122, v123
buffer_store_dwordx4 v[64:67], v6, s[16:19], s60 offen offset:0 sc1
buffer_store_dwordx4 v[112:115], v6, s[16:19], s60 offen offset:2048 sc1
s_add_u32 s56, s82, 28311552
s_addc_u32 s57, s83, 0
s_mov_b32 s58, 49152
s_mov_b32 s59, 0x20000
s_waitcnt vmcnt(0)
s_barrier
s_cmp_lg_u32 s36, 0
s_cbranch_scc1 Lsig_33
s_add_u32 s43, s34, 0
s_lshl_b32 s43, s43, 7
v_mov_b32 v4, s43
v_mov_b32 v5, 1
s_mov_b64 exec, 1
buffer_atomic_add v5, v4, s[56:59], 0 offen sc1
s_mov_b64 exec, -1
Lsig_33:
s_cmp_ge_u32 s36, 4
s_cbranch_scc1 Lprod_35
v_and_b32 v12, 15, v1
v_lshrrev_b32 v13, 4, v1
v_lshlrev_b32 v10, 12, v12
v_and_b32 v14, 1, v13
v_lshl_add_u32 v10, v14, 5, v10
v_lshrrev_b32 v14, 1, v13
v_lshl_add_u32 v10, v14, 4, v10
s_lshl_b32 s43, s34, 18
s_lshl_b32 s44, s36, 16
s_add_u32 s43, s43, s44
s_lshl_b32 s44, s35, 7
s_add_u32 s43, s43, s44
buffer_load_dwordx4 v[128:131], v10, s[8:11], s43 offen offset:0
buffer_load_dwordx4 v[132:135], v10, s[8:11], s43 offen offset:64
buffer_load_dwordx4 v[136:139], v10, s[8:11], s43 offen offset:2048
buffer_load_dwordx4 v[140:143], v10, s[8:11], s43 offen offset:2112
s_mul_i32 s43, s34, 262144
s_add_u32 s20, s82, s43
s_addc_u32 s21, s83, 0
s_add_u32 s20, s20, 4194304
s_addc_u32 s21, s21, 0
s_mov_b32 s22, 262144
s_mov_b32 s23, 0x20000
s_mul_i32 s43, s34, 16384
s_add_u32 s24, s82, s43
s_addc_u32 s25, s83, 0
s_add_u32 s24, s24, 25165824
s_addc_u32 s25, s25, 0
s_mov_b32 s26, 16384
s_mov_b32 s27, 0x20000
v_lshlrev_b32 v11, 4, v1
s_lshl_b32 s43, s36, 11
v_add_u32 v2, s43, v11
v_add_u32 v3, 98304, v2
v_lshrrev_b32 v14, 2, v1
v_bfe_u32 v15, v14, 1, 2
v_mul_u32_u24 v14, 128, v14
v_lshl_add_u32 v14, v15, 5, v14
v_and_b32 v15, 3, v1
v_lshl_add_u32 v4, v15, 3, v14
v_add_u32 v4, 114688, v4
v_xor_b32 v5, 32, v4
v_xor_b32 v6, 64, v4
v_xor_b32 v7, 96, v4
s_lshl_b32 s44, s35, 14
s_add_u32 s60, s44, s43
v_lshrrev_b32 v14, 1, v13
v_lshlrev_b32 v14, 11, v14
v_lshl_add_u32 v14, v12, 3, v14
v_and_b32 v15, 1, v13
v_lshl_add_u32 v14, v15, 2, v14
s_lshl_b32 s43, s36, 12
s_lshl_b32 s44, s35, 7
s_add_u32 s43, s43, s44
v_add_u32 v9, s43, v14
s_mov_b32 s61, 0x3f803f80
s_waitcnt vmcnt(0)
v_permlane16_swap_b32 v128, v130
v_permlane16_swap_b32 v129, v131
v_permlane16_swap_b32 v132, v134
v_permlane16_swap_b32 v133, v135
v_permlane16_swap_b32 v136, v138
v_permlane16_swap_b32 v137, v139
v_permlane16_swap_b32 v140, v142
v_permlane16_swap_b32 v141, v143
v_lshlrev_b32 v96, 16, v128
v_and_b32 v97, 0xffff0000, v128
v_lshlrev_b32 v98, 16, v129
v_and_b32 v99, 0xffff0000, v129
v_lshlrev_b32 v100, 16, v130
v_and_b32 v101, 0xffff0000, v130
v_lshlrev_b32 v102, 16, v131
v_and_b32 v103, 0xffff0000, v131
v_lshlrev_b32 v104, 16, v132
v_and_b32 v105, 0xffff0000, v132
v_lshlrev_b32 v106, 16, v133
v_and_b32 v107, 0xffff0000, v133
v_lshlrev_b32 v108, 16, v134
v_and_b32 v109, 0xffff0000, v134
v_lshlrev_b32 v110, 16, v135
v_and_b32 v111, 0xffff0000, v135
v_lshlrev_b32 v112, 16, v136
v_and_b32 v113, 0xffff0000, v136
v_lshlrev_b32 v114, 16, v137
v_and_b32 v115, 0xffff0000, v137
v_lshlrev_b32 v116, 16, v138
v_and_b32 v117, 0xffff0000, v138
v_lshlrev_b32 v118, 16, v139
v_and_b32 v119, 0xffff0000, v139
v_lshlrev_b32 v120, 16, v140
v_and_b32 v121, 0xffff0000, v140
v_lshlrev_b32 v122, 16, v141
v_and_b32 v123, 0xffff0000, v141
v_lshlrev_b32 v124, 16, v142
v_and_b32 v125, 0xffff0000, v142
v_lshlrev_b32 v126, 16, v143
v_and_b32 v127, 0xffff0000, v143
s_barrier
s_barrier
ds_read_b128 v[32:35], v2 offset:0
ds_read_b64_tr_b16 v[40:41], v4 offset:0
ds_read_b64_tr_b16 v[42:43], v4 offset:2048
ds_read_b64_tr_b16 v[44:45], v5 offset:0
ds_read_b64_tr_b16 v[46:47], v5 offset:2048
ds_read_b64_tr_b16 v[48:49], v6 offset:0
ds_read_b64_tr_b16 v[50:51], v6 offset:2048
ds_read_b64_tr_b16 v[52:53], v7 offset:0
ds_read_b64_tr_b16 v[54:55], v7 offset:2048
ds_read_b128 v[36:39], v2 offset:1024
ds_read_b128 v[56:59], v2 offset:8192
ds_read_b64_tr_b16 v[64:65], v4 offset:4096
ds_read_b64_tr_b16 v[66:67], v4 offset:6144
ds_read_b64_tr_b16 v[68:69], v5 offset:4096
ds_read_b64_tr_b16 v[70:71], v5 offset:6144
ds_read_b64_tr_b16 v[72:73], v6 offset:4096
ds_read_b64_tr_b16 v[74:75], v6 offset:6144
ds_read_b64_tr_b16 v[76:77], v7 offset:4096
ds_read_b64_tr_b16 v[78:79], v7 offset:6144
ds_read_b128 v[60:63], v2 offset:9216
s_mov_b32 s41, 3
Lcl_37:
s_waitcnt lgkmcnt(0)
s_barrier
v_mfma_f32_16x16x32_bf16 v[96:99], v[40:43], v[32:35], v[96:99]
ds_read_b128 v[144:147], v2 offset:49152
ds_read_b64_tr_b16 v[152:153], v4 offset:8192
v_mfma_f32_16x16x32_bf16 v[100:103], v[44:47], v[32:35], v[100:103]
ds_read_b64_tr_b16 v[154:155], v4 offset:10240
ds_read_b64_tr_b16 v[156:157], v5 offset:8192
v_mfma_f32_16x16x32_bf16 v[104:107], v[48:51], v[32:35], v[104:107]
ds_read_b64_tr_b16 v[158:159], v5 offset:10240
ds_read_b64_tr_b16 v[160:161], v6 offset:8192
v_mfma_f32_16x16x32_bf16 v[108:111], v[52:55], v[32:35], v[108:111]
ds_read_b64_tr_b16 v[162:163], v6 offset:10240
ds_read_b64_tr_b16 v[164:165], v7 offset:8192
v_mfma_f32_16x16x32_bf16 v[124:127], v[52:55], v[36:39], v[124:127]
ds_read_b64_tr_b16 v[166:167], v7 offset:10240
ds_read_b128 v[148:151], v2 offset:50176
v_mfma_f32_16x16x32_bf16 v[120:123], v[48:51], v[36:39], v[120:123]
ds_read_b128 v[168:171], v2 offset:57344
ds_read_b64_tr_b16 v[176:177], v4 offset:12288
v_mfma_f32_16x16x32_bf16 v[116:119], v[44:47], v[36:39], v[116:119]
ds_read_b64_tr_b16 v[178:179], v4 offset:14336
ds_read_b64_tr_b16 v[180:181], v5 offset:12288
v_mfma_f32_16x16x32_bf16 v[112:115], v[40:43], v[36:39], v[112:115]
ds_read_b64_tr_b16 v[182:183], v5 offset:14336
ds_read_b64_tr_b16 v[184:185], v6 offset:12288
v_mfma_f32_16x16x32_bf16 v[96:99], v[64:67], v[56:59], v[96:99]
ds_read_b64_tr_b16 v[186:187], v6 offset:14336
ds_read_b64_tr_b16 v[188:189], v7 offset:12288
v_mfma_f32_16x16x32_bf16 v[100:103], v[68:71], v[56:59], v[100:103]
ds_read_b64_tr_b16 v[190:191], v7 offset:14336
ds_read_b128 v[172:175], v2 offset:58368
v_mfma_f32_16x16x32_bf16 v[104:107], v[72:75], v[56:59], v[104:107]
v_mfma_f32_16x16x32_bf16 v[108:111], v[76:79], v[56:59], v[108:111]
v_mfma_f32_16x16x32_bf16 v[124:127], v[76:79], v[60:63], v[124:127]
v_mfma_f32_16x16x32_bf16 v[120:123], v[72:75], v[60:63], v[120:123]
v_mfma_f32_16x16x32_bf16 v[116:119], v[68:71], v[60:63], v[116:119]
v_mfma_f32_16x16x32_bf16 v[112:115], v[64:67], v[60:63], v[112:115]
s_waitcnt lgkmcnt(0)
s_barrier
v_mfma_f32_16x16x32_bf16 v[96:99], v[152:155], v[144:147], v[96:99]
ds_read_b128 v[32:35], v3 offset:0
ds_read_b64_tr_b16 v[40:41], v4 offset:16384
v_mfma_f32_16x16x32_bf16 v[100:103], v[156:159], v[144:147], v[100:103]
ds_read_b64_tr_b16 v[42:43], v4 offset:18432
ds_read_b64_tr_b16 v[44:45], v5 offset:16384
v_mfma_f32_16x16x32_bf16 v[104:107], v[160:163], v[144:147], v[104:107]
ds_read_b64_tr_b16 v[46:47], v5 offset:18432
ds_read_b64_tr_b16 v[48:49], v6 offset:16384
v_mfma_f32_16x16x32_bf16 v[108:111], v[164:167], v[144:147], v[108:111]
ds_read_b64_tr_b16 v[50:51], v6 offset:18432
ds_read_b64_tr_b16 v[52:53], v7 offset:16384
v_mfma_f32_16x16x32_bf16 v[124:127], v[164:167], v[148:151], v[124:127]
ds_read_b64_tr_b16 v[54:55], v7 offset:18432
ds_read_b128 v[36:39], v3 offset:1024
v_mfma_f32_16x16x32_bf16 v[120:123], v[160:163], v[148:151], v[120:123]
ds_read_b128 v[56:59], v3 offset:8192
ds_read_b64_tr_b16 v[64:65], v4 offset:20480
v_mfma_f32_16x16x32_bf16 v[116:119], v[156:159], v[148:151], v[116:119]
ds_read_b64_tr_b16 v[66:67], v4 offset:22528
ds_read_b64_tr_b16 v[68:69], v5 offset:20480
v_mfma_f32_16x16x32_bf16 v[112:115], v[152:155], v[148:151], v[112:115]
ds_read_b64_tr_b16 v[70:71], v5 offset:22528
ds_read_b64_tr_b16 v[72:73], v6 offset:20480
v_mfma_f32_16x16x32_bf16 v[96:99], v[176:179], v[168:171], v[96:99]
ds_read_b64_tr_b16 v[74:75], v6 offset:22528
ds_read_b64_tr_b16 v[76:77], v7 offset:20480
v_mfma_f32_16x16x32_bf16 v[100:103], v[180:183], v[168:171], v[100:103]
ds_read_b64_tr_b16 v[78:79], v7 offset:22528
ds_read_b128 v[60:63], v3 offset:9216
v_mfma_f32_16x16x32_bf16 v[104:107], v[184:187], v[168:171], v[104:107]
v_mfma_f32_16x16x32_bf16 v[108:111], v[188:191], v[168:171], v[108:111]
v_mfma_f32_16x16x32_bf16 v[124:127], v[188:191], v[172:175], v[124:127]
v_mfma_f32_16x16x32_bf16 v[120:123], v[184:187], v[172:175], v[120:123]
v_mfma_f32_16x16x32_bf16 v[116:119], v[180:183], v[172:175], v[116:119]
v_mfma_f32_16x16x32_bf16 v[112:115], v[176:179], v[172:175], v[112:115]
s_waitcnt lgkmcnt(0)
s_barrier
v_mfma_f32_16x16x32_bf16 v[96:99], v[40:43], v[32:35], v[96:99]
ds_read_b128 v[144:147], v3 offset:49152
ds_read_b64_tr_b16 v[152:153], v4 offset:24576
v_mfma_f32_16x16x32_bf16 v[100:103], v[44:47], v[32:35], v[100:103]
ds_read_b64_tr_b16 v[154:155], v4 offset:26624
ds_read_b64_tr_b16 v[156:157], v5 offset:24576
v_mfma_f32_16x16x32_bf16 v[104:107], v[48:51], v[32:35], v[104:107]
ds_read_b64_tr_b16 v[158:159], v5 offset:26624
ds_read_b64_tr_b16 v[160:161], v6 offset:24576
v_mfma_f32_16x16x32_bf16 v[108:111], v[52:55], v[32:35], v[108:111]
ds_read_b64_tr_b16 v[162:163], v6 offset:26624
ds_read_b64_tr_b16 v[164:165], v7 offset:24576
v_mfma_f32_16x16x32_bf16 v[124:127], v[52:55], v[36:39], v[124:127]
ds_read_b64_tr_b16 v[166:167], v7 offset:26624
ds_read_b128 v[148:151], v3 offset:50176
v_mfma_f32_16x16x32_bf16 v[120:123], v[48:51], v[36:39], v[120:123]
ds_read_b128 v[168:171], v3 offset:57344
ds_read_b64_tr_b16 v[176:177], v4 offset:28672
v_mfma_f32_16x16x32_bf16 v[116:119], v[44:47], v[36:39], v[116:119]
ds_read_b64_tr_b16 v[178:179], v4 offset:30720
ds_read_b64_tr_b16 v[180:181], v5 offset:28672
v_mfma_f32_16x16x32_bf16 v[112:115], v[40:43], v[36:39], v[112:115]
ds_read_b64_tr_b16 v[182:183], v5 offset:30720
ds_read_b64_tr_b16 v[184:185], v6 offset:28672
v_mfma_f32_16x16x32_bf16 v[96:99], v[64:67], v[56:59], v[96:99]
ds_read_b64_tr_b16 v[186:187], v6 offset:30720
ds_read_b64_tr_b16 v[188:189], v7 offset:28672
v_mfma_f32_16x16x32_bf16 v[100:103], v[68:71], v[56:59], v[100:103]
ds_read_b64_tr_b16 v[190:191], v7 offset:30720
ds_read_b128 v[172:175], v3 offset:58368
v_mfma_f32_16x16x32_bf16 v[104:107], v[72:75], v[56:59], v[104:107]
v_mfma_f32_16x16x32_bf16 v[108:111], v[76:79], v[56:59], v[108:111]
v_mfma_f32_16x16x32_bf16 v[124:127], v[76:79], v[60:63], v[124:127]
v_mfma_f32_16x16x32_bf16 v[120:123], v[72:75], v[60:63], v[120:123]
v_mfma_f32_16x16x32_bf16 v[116:119], v[68:71], v[60:63], v[116:119]
v_mfma_f32_16x16x32_bf16 v[112:115], v[64:67], v[60:63], v[112:115]
s_waitcnt lgkmcnt(0)
s_barrier
v_mfma_f32_16x16x32_bf16 v[96:99], v[152:155], v[144:147], v[96:99]
ds_read_b128 v[32:35], v2 offset:0
ds_read_b64_tr_b16 v[40:41], v4 offset:0
v_mfma_f32_16x16x32_bf16 v[100:103], v[156:159], v[144:147], v[100:103]
ds_read_b64_tr_b16 v[42:43], v4 offset:2048
ds_read_b64_tr_b16 v[44:45], v5 offset:0
v_mfma_f32_16x16x32_bf16 v[104:107], v[160:163], v[144:147], v[104:107]
ds_read_b64_tr_b16 v[46:47], v5 offset:2048
ds_read_b64_tr_b16 v[48:49], v6 offset:0
v_mfma_f32_16x16x32_bf16 v[108:111], v[164:167], v[144:147], v[108:111]
ds_read_b64_tr_b16 v[50:51], v6 offset:2048
ds_read_b64_tr_b16 v[52:53], v7 offset:0
v_mfma_f32_16x16x32_bf16 v[124:127], v[164:167], v[148:151], v[124:127]
ds_read_b64_tr_b16 v[54:55], v7 offset:2048
ds_read_b128 v[36:39], v2 offset:1024
v_mfma_f32_16x16x32_bf16 v[120:123], v[160:163], v[148:151], v[120:123]
ds_read_b128 v[56:59], v2 offset:8192
ds_read_b64_tr_b16 v[64:65], v4 offset:4096
v_mfma_f32_16x16x32_bf16 v[116:119], v[156:159], v[148:151], v[116:119]
ds_read_b64_tr_b16 v[66:67], v4 offset:6144
ds_read_b64_tr_b16 v[68:69], v5 offset:4096
v_mfma_f32_16x16x32_bf16 v[112:115], v[152:155], v[148:151], v[112:115]
ds_read_b64_tr_b16 v[70:71], v5 offset:6144
ds_read_b64_tr_b16 v[72:73], v6 offset:4096
v_mfma_f32_16x16x32_bf16 v[96:99], v[176:179], v[168:171], v[96:99]
ds_read_b64_tr_b16 v[74:75], v6 offset:6144
ds_read_b64_tr_b16 v[76:77], v7 offset:4096
v_mfma_f32_16x16x32_bf16 v[100:103], v[180:183], v[168:171], v[100:103]
ds_read_b64_tr_b16 v[78:79], v7 offset:6144
ds_read_b128 v[60:63], v2 offset:9216
v_mfma_f32_16x16x32_bf16 v[104:107], v[184:187], v[168:171], v[104:107]
v_mfma_f32_16x16x32_bf16 v[108:111], v[188:191], v[168:171], v[108:111]
v_mfma_f32_16x16x32_bf16 v[124:127], v[188:191], v[172:175], v[124:127]
v_mfma_f32_16x16x32_bf16 v[120:123], v[184:187], v[172:175], v[120:123]
v_mfma_f32_16x16x32_bf16 v[116:119], v[180:183], v[172:175], v[116:119]
v_mfma_f32_16x16x32_bf16 v[112:115], v[176:179], v[172:175], v[112:115]
s_sub_u32 s41, s41, 1
s_cmp_lg_u32 s41, 0
s_cbranch_scc1 Lcl_37
s_waitcnt lgkmcnt(0)
s_barrier
v_mfma_f32_16x16x32_bf16 v[96:99], v[40:43], v[32:35], v[96:99]
ds_read_b128 v[144:147], v2 offset:49152
ds_read_b64_tr_b16 v[152:153], v4 offset:8192
v_mfma_f32_16x16x32_bf16 v[100:103], v[44:47], v[32:35], v[100:103]
ds_read_b64_tr_b16 v[154:155], v4 offset:10240
ds_read_b64_tr_b16 v[156:157], v5 offset:8192
v_mfma_f32_16x16x32_bf16 v[104:107], v[48:51], v[32:35], v[104:107]
ds_read_b64_tr_b16 v[158:159], v5 offset:10240
ds_read_b64_tr_b16 v[160:161], v6 offset:8192
v_mfma_f32_16x16x32_bf16 v[108:111], v[52:55], v[32:35], v[108:111]
ds_read_b64_tr_b16 v[162:163], v6 offset:10240
ds_read_b64_tr_b16 v[164:165], v7 offset:8192
v_mfma_f32_16x16x32_bf16 v[124:127], v[52:55], v[36:39], v[124:127]
ds_read_b64_tr_b16 v[166:167], v7 offset:10240
ds_read_b128 v[148:151], v2 offset:50176
v_mfma_f32_16x16x32_bf16 v[120:123], v[48:51], v[36:39], v[120:123]
ds_read_b128 v[168:171], v2 offset:57344
ds_read_b64_tr_b16 v[176:177], v4 offset:12288
v_mfma_f32_16x16x32_bf16 v[116:119], v[44:47], v[36:39], v[116:119]
ds_read_b64_tr_b16 v[178:179], v4 offset:14336
ds_read_b64_tr_b16 v[180:181], v5 offset:12288
v_mfma_f32_16x16x32_bf16 v[112:115], v[40:43], v[36:39], v[112:115]
ds_read_b64_tr_b16 v[182:183], v5 offset:14336
ds_read_b64_tr_b16 v[184:185], v6 offset:12288
v_mfma_f32_16x16x32_bf16 v[96:99], v[64:67], v[56:59], v[96:99]
ds_read_b64_tr_b16 v[186:187], v6 offset:14336
ds_read_b64_tr_b16 v[188:189], v7 offset:12288
v_mfma_f32_16x16x32_bf16 v[100:103], v[68:71], v[56:59], v[100:103]
ds_read_b64_tr_b16 v[190:191], v7 offset:14336
ds_read_b128 v[172:175], v2 offset:58368
v_mfma_f32_16x16x32_bf16 v[104:107], v[72:75], v[56:59], v[104:107]
v_mfma_f32_16x16x32_bf16 v[108:111], v[76:79], v[56:59], v[108:111]
v_mfma_f32_16x16x32_bf16 v[124:127], v[76:79], v[60:63], v[124:127]
v_mfma_f32_16x16x32_bf16 v[120:123], v[72:75], v[60:63], v[120:123]
v_mfma_f32_16x16x32_bf16 v[116:119], v[68:71], v[60:63], v[116:119]
v_mfma_f32_16x16x32_bf16 v[112:115], v[64:67], v[60:63], v[112:115]
s_waitcnt lgkmcnt(0)
s_barrier
v_mfma_f32_16x16x32_bf16 v[96:99], v[152:155], v[144:147], v[96:99]
ds_read_b128 v[32:35], v3 offset:0
ds_read_b64_tr_b16 v[40:41], v4 offset:16384
v_mfma_f32_16x16x32_bf16 v[100:103], v[156:159], v[144:147], v[100:103]
ds_read_b64_tr_b16 v[42:43], v4 offset:18432
ds_read_b64_tr_b16 v[44:45], v5 offset:16384
v_mfma_f32_16x16x32_bf16 v[104:107], v[160:163], v[144:147], v[104:107]
ds_read_b64_tr_b16 v[46:47], v5 offset:18432
ds_read_b64_tr_b16 v[48:49], v6 offset:16384
v_mfma_f32_16x16x32_bf16 v[108:111], v[164:167], v[144:147], v[108:111]
ds_read_b64_tr_b16 v[50:51], v6 offset:18432
ds_read_b64_tr_b16 v[52:53], v7 offset:16384
v_mfma_f32_16x16x32_bf16 v[124:127], v[164:167], v[148:151], v[124:127]
ds_read_b64_tr_b16 v[54:55], v7 offset:18432
ds_read_b128 v[36:39], v3 offset:1024
v_mfma_f32_16x16x32_bf16 v[120:123], v[160:163], v[148:151], v[120:123]
ds_read_b128 v[56:59], v3 offset:8192
ds_read_b64_tr_b16 v[64:65], v4 offset:20480
v_mfma_f32_16x16x32_bf16 v[116:119], v[156:159], v[148:151], v[116:119]
ds_read_b64_tr_b16 v[66:67], v4 offset:22528
ds_read_b64_tr_b16 v[68:69], v5 offset:20480
v_mfma_f32_16x16x32_bf16 v[112:115], v[152:155], v[148:151], v[112:115]
ds_read_b64_tr_b16 v[70:71], v5 offset:22528
ds_read_b64_tr_b16 v[72:73], v6 offset:20480
v_mfma_f32_16x16x32_bf16 v[96:99], v[176:179], v[168:171], v[96:99]
ds_read_b64_tr_b16 v[74:75], v6 offset:22528
ds_read_b64_tr_b16 v[76:77], v7 offset:20480
v_mfma_f32_16x16x32_bf16 v[100:103], v[180:183], v[168:171], v[100:103]
ds_read_b64_tr_b16 v[78:79], v7 offset:22528
ds_read_b128 v[60:63], v3 offset:9216
v_mfma_f32_16x16x32_bf16 v[104:107], v[184:187], v[168:171], v[104:107]
v_mfma_f32_16x16x32_bf16 v[108:111], v[188:191], v[168:171], v[108:111]
v_mfma_f32_16x16x32_bf16 v[124:127], v[188:191], v[172:175], v[124:127]
v_mfma_f32_16x16x32_bf16 v[120:123], v[184:187], v[172:175], v[120:123]
v_mfma_f32_16x16x32_bf16 v[116:119], v[180:183], v[172:175], v[116:119]
v_mfma_f32_16x16x32_bf16 v[112:115], v[176:179], v[172:175], v[112:115]
s_waitcnt lgkmcnt(0)
s_barrier
v_mfma_f32_16x16x32_bf16 v[96:99], v[40:43], v[32:35], v[96:99]
ds_read_b128 v[144:147], v3 offset:49152
ds_read_b64_tr_b16 v[152:153], v4 offset:24576
v_mfma_f32_16x16x32_bf16 v[100:103], v[44:47], v[32:35], v[100:103]
ds_read_b64_tr_b16 v[154:155], v4 offset:26624
ds_read_b64_tr_b16 v[156:157], v5 offset:24576
v_mfma_f32_16x16x32_bf16 v[104:107], v[48:51], v[32:35], v[104:107]
ds_read_b64_tr_b16 v[158:159], v5 offset:26624
ds_read_b64_tr_b16 v[160:161], v6 offset:24576
v_mfma_f32_16x16x32_bf16 v[108:111], v[52:55], v[32:35], v[108:111]
ds_read_b64_tr_b16 v[162:163], v6 offset:26624
ds_read_b64_tr_b16 v[164:165], v7 offset:24576
v_mfma_f32_16x16x32_bf16 v[124:127], v[52:55], v[36:39], v[124:127]
ds_read_b64_tr_b16 v[166:167], v7 offset:26624
ds_read_b128 v[148:151], v3 offset:50176
v_mfma_f32_16x16x32_bf16 v[120:123], v[48:51], v[36:39], v[120:123]
ds_read_b128 v[168:171], v3 offset:57344
ds_read_b64_tr_b16 v[176:177], v4 offset:28672
v_mfma_f32_16x16x32_bf16 v[116:119], v[44:47], v[36:39], v[116:119]
ds_read_b64_tr_b16 v[178:179], v4 offset:30720
ds_read_b64_tr_b16 v[180:181], v5 offset:28672
v_mfma_f32_16x16x32_bf16 v[112:115], v[40:43], v[36:39], v[112:115]
ds_read_b64_tr_b16 v[182:183], v5 offset:30720
ds_read_b64_tr_b16 v[184:185], v6 offset:28672
v_mfma_f32_16x16x32_bf16 v[96:99], v[64:67], v[56:59], v[96:99]
ds_read_b64_tr_b16 v[186:187], v6 offset:30720
ds_read_b64_tr_b16 v[188:189], v7 offset:28672
v_mfma_f32_16x16x32_bf16 v[100:103], v[68:71], v[56:59], v[100:103]
ds_read_b64_tr_b16 v[190:191], v7 offset:30720
ds_read_b128 v[172:175], v3 offset:58368
v_mfma_f32_16x16x32_bf16 v[104:107], v[72:75], v[56:59], v[104:107]
v_mfma_f32_16x16x32_bf16 v[108:111], v[76:79], v[56:59], v[108:111]
v_mfma_f32_16x16x32_bf16 v[124:127], v[76:79], v[60:63], v[124:127]
v_mfma_f32_16x16x32_bf16 v[120:123], v[72:75], v[60:63], v[120:123]
v_mfma_f32_16x16x32_bf16 v[116:119], v[68:71], v[60:63], v[116:119]
v_mfma_f32_16x16x32_bf16 v[112:115], v[64:67], v[60:63], v[112:115]
s_waitcnt lgkmcnt(0)
s_barrier
v_mfma_f32_16x16x32_bf16 v[96:99], v[152:155], v[144:147], v[96:99]
v_mfma_f32_16x16x32_bf16 v[100:103], v[156:159], v[144:147], v[100:103]
v_mfma_f32_16x16x32_bf16 v[104:107], v[160:163], v[144:147], v[104:107]
v_mfma_f32_16x16x32_bf16 v[108:111], v[164:167], v[144:147], v[108:111]
v_mfma_f32_16x16x32_bf16 v[124:127], v[164:167], v[148:151], v[124:127]
v_mfma_f32_16x16x32_bf16 v[120:123], v[160:163], v[148:151], v[120:123]
v_mfma_f32_16x16x32_bf16 v[116:119], v[156:159], v[148:151], v[116:119]
v_mfma_f32_16x16x32_bf16 v[112:115], v[152:155], v[148:151], v[112:115]
v_mfma_f32_16x16x32_bf16 v[96:99], v[176:179], v[168:171], v[96:99]
v_mfma_f32_16x16x32_bf16 v[100:103], v[180:183], v[168:171], v[100:103]
v_mfma_f32_16x16x32_bf16 v[104:107], v[184:187], v[168:171], v[104:107]
v_mfma_f32_16x16x32_bf16 v[108:111], v[188:191], v[168:171], v[108:111]
v_mfma_f32_16x16x32_bf16 v[124:127], v[188:191], v[172:175], v[124:127]
v_mfma_f32_16x16x32_bf16 v[120:123], v[184:187], v[172:175], v[120:123]
v_mfma_f32_16x16x32_bf16 v[116:119], v[180:183], v[172:175], v[116:119]
v_mfma_f32_16x16x32_bf16 v[112:115], v[176:179], v[172:175], v[112:115]
s_nop 3
v_cvt_pk_bf16_f32 v32, v96, v97
v_cvt_pk_bf16_f32 v33, v98, v99
v_cvt_pk_bf16_f32 v34, v100, v101
v_cvt_pk_bf16_f32 v35, v102, v103
s_add_u32 s43, s60, 0
buffer_store_dwordx4 v[32:35], v11, s[20:23], s43 offen offset:0 sc1
v_cvt_pk_bf16_f32 v36, v104, v105
v_cvt_pk_bf16_f32 v37, v106, v107
v_cvt_pk_bf16_f32 v38, v108, v109
v_cvt_pk_bf16_f32 v39, v110, v111
s_add_u32 s43, s60, 8192
buffer_store_dwordx4 v[36:39], v11, s[20:23], s43 offen offset:0 sc1
v_cvt_pk_bf16_f32 v44, v120, v121
v_cvt_pk_bf16_f32 v45, v122, v123
v_cvt_pk_bf16_f32 v46, v124, v125
v_cvt_pk_bf16_f32 v47, v126, v127
s_add_u32 s43, s60, 8192
buffer_store_dwordx4 v[44:47], v11, s[20:23], s43 offen offset:1024 sc1
v_cvt_pk_bf16_f32 v40, v112, v113
v_cvt_pk_bf16_f32 v41, v114, v115
v_cvt_pk_bf16_f32 v42, v116, v117
v_cvt_pk_bf16_f32 v43, v118, v119
s_add_u32 s43, s60, 0
buffer_store_dwordx4 v[40:43], v11, s[20:23], s43 offen offset:1024 sc1
v_mov_b32 v64, 0
v_mov_b32 v65, 0
v_mov_b32 v66, 0
v_mov_b32 v67, 0
v_mov_b32 v68, 0
v_mov_b32 v69, 0
v_mov_b32 v70, 0
v_mov_b32 v71, 0
v_dot2_f32_bf16 v64, v32, s61, v64
v_dot2_f32_bf16 v66, v32, v32, v66
v_dot2_f32_bf16 v68, v40, s61, v68
v_dot2_f32_bf16 v70, v40, v40, v70
v_dot2_f32_bf16 v65, v33, s61, v65
v_dot2_f32_bf16 v67, v33, v33, v67
v_dot2_f32_bf16 v69, v41, s61, v69
v_dot2_f32_bf16 v71, v41, v41, v71
v_dot2_f32_bf16 v64, v34, s61, v64
v_dot2_f32_bf16 v66, v34, v34, v66
v_dot2_f32_bf16 v68, v42, s61, v68
v_dot2_f32_bf16 v70, v42, v42, v70
v_dot2_f32_bf16 v65, v35, s61, v65
v_dot2_f32_bf16 v67, v35, v35, v67
v_dot2_f32_bf16 v69, v43, s61, v69
v_dot2_f32_bf16 v71, v43, v43, v71
v_dot2_f32_bf16 v64, v36, s61, v64
v_dot2_f32_bf16 v66, v36, v36, v66
v_dot2_f32_bf16 v68, v44, s61, v68
v_dot2_f32_bf16 v70, v44, v44, v70
v_dot2_f32_bf16 v65, v37, s61, v65
v_dot2_f32_bf16 v67, v37, v37, v67
v_dot2_f32_bf16 v69, v45, s61, v69
v_dot2_f32_bf16 v71, v45, v45, v71
v_dot2_f32_bf16 v64, v38, s61, v64
v_dot2_f32_bf16 v66, v38, v38, v66
v_dot2_f32_bf16 v68, v46, s61, v68
v_dot2_f32_bf16 v70, v46, v46, v70
v_dot2_f32_bf16 v65, v39, s61, v65
v_dot2_f32_bf16 v67, v39, v39, v67
v_dot2_f32_bf16 v69, v47, s61, v69
v_dot2_f32_bf16 v71, v47, v47, v71
s_nop 2
v_add_f32 v64, v64, v65
v_add_f32 v66, v66, v67
v_add_f32 v68, v68, v69
v_add_f32 v70, v70, v71
s_nop 1
v_permlane32_swap_b32 v64, v68
v_permlane32_swap_b32 v66, v70
v_add_f32 v64, v64, v68
v_add_f32 v66, v66, v70
s_nop 1
v_permlane16_swap_b32 v64, v66
v_add_f32 v64, v64, v66
buffer_store_dword v64, v9, s[24:27], 0 offen sc1
s_waitcnt vmcnt(0)
s_barrier
s_cmp_lg_u32 s36, 0
s_cbranch_scc1 Lk2end_34
s_add_u32 s43, s34, 16
s_lshl_b32 s43, s43, 7
v_mov_b32 v4, s43
v_mov_b32 v5, 1
s_mov_b64 exec, 1
buffer_atomic_add v5, v4, s[56:59], 0 offen sc1
s_mov_b64 exec, -1
s_branch Lk2end_34
Lprod_35:
s_cmp_eq_u32 s36, 7
s_cbranch_scc1 Lpf_36
s_mul_i32 s43, s34, 262144
s_add_u32 s8, s82, s43
s_addc_u32 s9, s83, 0
s_mov_b32 s10, 262144
s_mov_b32 s11, 0x20000
s_lshl_b32 s43, s35, 7
s_add_u32 s12, s68, s43
s_addc_u32 s13, s69, 0
s_mov_b32 s14, 2095232
s_mov_b32 s15, 0x20000
v_lshlrev_b32 v2, 4, v1
v_lshrrev_b32 v12, 3, v1
v_and_b32 v13, 6, v12
v_and_b32 v3, 7, v1
v_xor_b32 v3, v3, v13
v_lshlrev_b32 v3, 4, v3
v_mul_u32_u24 v12, 2048, v12
v_add_u32 v3, v3, v12
s_cmp_eq_u32 s36, 5
s_cbranch_scc1 Lp_39
s_cmp_eq_u32 s36, 6
s_cbranch_scc1 Lp_40
Lp_38:
v_add_u32 v16, 0, v2
v_add_u32 v17, 3072, v2
v_add_u32 v18, 6144, v2
v_add_u32 v19, 9216, v2
v_add_u32 v20, 12288, v2
v_add_u32 v21, 15360, v2
v_add_u32 v22, 32768, v3
v_add_u32 v23, 81920, v3
s_add_u32 s43, s34, 0
s_lshl_b32 s43, s43, 7
v_mov_b32 v8, s43
s_mov_b32 s41, 0x40000
Lpoll_41:
buffer_load_dword v9, v8, s[56:59], 0 offen sc1
s_waitcnt vmcnt(0)
Lpchk_43:
v_readfirstlane_b32 s42, v9
s_cmp_eq_u32 s42, 16
s_cbranch_scc1 Lpok_42
s_sub_u32 s41, s41, 1
s_cmp_lg_u32 s41, 0
s_cbranch_scc1 Lpoll_41
Lpok_42:
s_barrier
s_mov_b32 s37, 0
s_mov_b32 m0, 0
s_nop 0
buffer_load_dwordx4 v16, s[8:11], s37 offen sc1 lds
s_mov_b32 m0, 3072
s_nop 0
buffer_load_dwordx4 v17, s[8:11], s37 offen sc1 lds
s_mov_b32 m0, 6144
s_nop 0
buffer_load_dwordx4 v18, s[8:11], s37 offen sc1 lds
s_mov_b32 m0, 9216
s_nop 0
buffer_load_dwordx4 v19, s[8:11], s37 offen sc1 lds
s_mov_b32 m0, 12288
s_nop 0
buffer_load_dwordx4 v20, s[8:11], s37 offen sc1 lds
s_mov_b32 m0, 15360
s_nop 0
buffer_load_dwordx4 v21, s[8:11], s37 offen sc1 lds
s_mov_b32 s37, 16384
s_mov_b32 m0, 49152
s_nop 0
buffer_load_dwordx4 v16, s[8:11], s37 offen sc1 lds
s_mov_b32 m0, 52224
s_nop 0
buffer_load_dwordx4 v17, s[8:11], s37 offen sc1 lds
s_mov_b32 m0, 55296
s_nop 0
buffer_load_dwordx4 v18, s[8:11], s37 offen sc1 lds
s_mov_b32 m0, 58368
s_nop 0
buffer_load_dwordx4 v19, s[8:11], s37 offen sc1 lds
s_mov_b32 m0, 61440
s_nop 0
buffer_load_dwordx4 v20, s[8:11], s37 offen sc1 lds
s_mov_b32 m0, 64512
s_nop 0
buffer_load_dwordx4 v21, s[8:11], s37 offen sc1 lds
s_mov_b32 s37, 32768
s_mov_b32 m0, 98304
s_nop 0
buffer_load_dwordx4 v16, s[8:11], s37 offen sc1 lds
s_mov_b32 m0, 101376
s_nop 0
buffer_load_dwordx4 v17, s[8:11], s37 offen sc1 lds
s_mov_b32 m0, 104448
s_nop 0
buffer_load_dwordx4 v18, s[8:11], s37 offen sc1 lds
s_mov_b32 m0, 107520
s_nop 0
buffer_load_dwordx4 v19, s[8:11], s37 offen sc1 lds
s_mov_b32 m0, 110592
s_nop 0
buffer_load_dwordx4 v20, s[8:11], s37 offen sc1 lds
s_mov_b32 m0, 113664
s_nop 0
buffer_load_dwordx4 v21, s[8:11], s37 offen sc1 lds
s_mov_b32 s37, 49152
s_mov_b32 m0, 147456
s_nop 0
buffer_load_dwordx4 v16, s[8:11], s37 offen sc1 lds
s_mov_b32 m0, 150528
s_nop 0
buffer_load_dwordx4 v17, s[8:11], s37 offen sc1 lds
s_mov_b32 m0, 153600
s_nop 0
buffer_load_dwordx4 v18, s[8:11], s37 offen sc1 lds
s_mov_b32 m0, 156672
s_nop 0
buffer_load_dwordx4 v19, s[8:11], s37 offen sc1 lds
s_mov_b32 m0, 159744
s_nop 0
buffer_load_dwordx4 v20, s[8:11], s37 offen sc1 lds
s_mov_b32 m0, 162816
s_nop 0
buffer_load_dwordx4 v21, s[8:11], s37 offen sc1 lds
s_mov_b32 s37, 65536
s_mov_b32 s38, 524288
s_waitcnt vmcnt(18)
s_barrier
s_waitcnt vmcnt(12)
s_barrier
s_mov_b32 m0, 0
s_nop 0
buffer_load_dwordx4 v16, s[8:11], s37 offen sc1 lds
s_mov_b32 m0, 3072
s_nop 0
buffer_load_dwordx4 v17, s[8:11], s37 offen sc1 lds
s_mov_b32 m0, 6144
s_nop 0
buffer_load_dwordx4 v18, s[8:11], s37 offen sc1 lds
s_mov_b32 m0, 9216
s_nop 0
buffer_load_dwordx4 v19, s[8:11], s37 offen sc1 lds
s_mov_b32 m0, 12288
s_nop 0
buffer_load_dwordx4 v20, s[8:11], s37 offen sc1 lds
s_mov_b32 m0, 15360
s_nop 0
buffer_load_dwordx4 v21, s[8:11], s37 offen sc1 lds
s_mov_b32 m0, 116736
s_nop 0
buffer_load_dwordx4 v22, s[12:15], s38 offen lds
s_mov_b32 m0, 119808
s_nop 0
buffer_load_dwordx4 v23, s[12:15], s38 offen lds
s_add_u32 s37, s37, 16384
s_add_u32 s38, s38, 131072
s_waitcnt vmcnt(14)
s_barrier
s_mov_b32 m0, 49152
s_nop 0
buffer_load_dwordx4 v16, s[8:11], s37 offen sc1 lds
s_mov_b32 m0, 52224
s_nop 0
buffer_load_dwordx4 v17, s[8:11], s37 offen sc1 lds
s_mov_b32 m0, 55296
s_nop 0
buffer_load_dwordx4 v18, s[8:11], s37 offen sc1 lds
s_mov_b32 m0, 58368
s_nop 0
buffer_load_dwordx4 v19, s[8:11], s37 offen sc1 lds
s_mov_b32 m0, 61440
s_nop 0
buffer_load_dwordx4 v20, s[8:11], s37 offen sc1 lds
s_mov_b32 m0, 64512
s_nop 0
buffer_load_dwordx4 v21, s[8:11], s37 offen sc1 lds
s_mov_b32 m0, 124928
s_nop 0
buffer_load_dwordx4 v22, s[12:15], s38 offen lds
s_mov_b32 m0, 128000
s_nop 0
buffer_load_dwordx4 v23, s[12:15], s38 offen lds
s_add_u32 s37, s37, 16384
s_add_u32 s38, s38, 131072
s_waitcnt vmcnt(16)
s_barrier
s_mov_b32 m0, 98304
s_nop 0
buffer_load_dwordx4 v16, s[8:11], s37 offen sc1 lds
s_mov_b32 m0, 101376
s_nop 0
buffer_load_dwordx4 v17, s[8:11], s37 offen sc1 lds
s_mov_b32 m0, 104448
s_nop 0
buffer_load_dwordx4 v18, s[8:11], s37 offen sc1 lds
s_mov_b32 m0, 107520
s_nop 0
buffer_load_dwordx4 v19, s[8:11], s37 offen sc1 lds
s_mov_b32 m0, 110592
s_nop 0
buffer_load_dwordx4 v20, s[8:11], s37 offen sc1 lds
s_mov_b32 m0, 113664
s_nop 0
buffer_load_dwordx4 v21, s[8:11], s37 offen sc1 lds
s_mov_b32 m0, 133120
s_nop 0
buffer_load_dwordx4 v22, s[12:15], s38 offen lds
s_mov_b32 m0, 136192
s_nop 0
buffer_load_dwordx4 v23, s[12:15], s38 offen lds
s_add_u32 s37, s37, 16384
s_add_u32 s38, s38, 131072
s_waitcnt vmcnt(16)
s_barrier
s_mov_b32 m0, 147456
s_nop 0
buffer_load_dwordx4 v16, s[8:11], s37 offen sc1 lds
s_mov_b32 m0, 150528
s_nop 0
buffer_load_dwordx4 v17, s[8:11], s37 offen sc1 lds
s_mov_b32 m0, 153600
s_nop 0
buffer_load_dwordx4 v18, s[8:11], s37 offen sc1 lds
s_mov_b32 m0, 156672
s_nop 0
buffer_load_dwordx4 v19, s[8:11], s37 offen sc1 lds
s_mov_b32 m0, 159744
s_nop 0
buffer_load_dwordx4 v20, s[8:11], s37 offen sc1 lds
s_mov_b32 m0, 162816
s_nop 0
buffer_load_dwordx4 v21, s[8:11], s37 offen sc1 lds
s_mov_b32 m0, 141312
s_nop 0
buffer_load_dwordx4 v22, s[12:15], s38 offen lds
s_mov_b32 m0, 144384
s_nop 0
buffer_load_dwordx4 v23, s[12:15], s38 offen lds
s_add_u32 s37, s37, 16384
s_add_u32 s38, s38, 131072
s_waitcnt vmcnt(16)
s_barrier
s_mov_b32 m0, 0
s_nop 0
buffer_load_dwordx4 v16, s[8:11], s37 offen sc1 lds
s_mov_b32 m0, 3072
s_nop 0
buffer_load_dwordx4 v17, s[8:11], s37 offen sc1 lds
s_mov_b32 m0, 6144
s_nop 0
buffer_load_dwordx4 v18, s[8:11], s37 offen sc1 lds
s_mov_b32 m0, 9216
s_nop 0
buffer_load_dwordx4 v19, s[8:11], s37 offen sc1 lds
s_mov_b32 m0, 12288
s_nop 0
buffer_load_dwordx4 v20, s[8:11], s37 offen sc1 lds
s_mov_b32 m0, 15360
s_nop 0
buffer_load_dwordx4 v21, s[8:11], s37 offen sc1 lds
s_mov_b32 m0, 116736
s_nop 0
buffer_load_dwordx4 v22, s[12:15], s38 offen lds
s_mov_b32 m0, 119808
s_nop 0
buffer_load_dwordx4 v23, s[12:15], s38 offen lds
s_add_u32 s37, s37, 16384
s_add_u32 s38, s38, 131072
s_waitcnt vmcnt(16)
s_barrier
s_mov_b32 m0, 49152
s_nop 0
buffer_load_dwordx4 v16, s[8:11], s37 offen sc1 lds
s_mov_b32 m0, 52224
s_nop 0
buffer_load_dwordx4 v17, s[8:11], s37 offen sc1 lds
s_mov_b32 m0, 55296
s_nop 0
buffer_load_dwordx4 v18, s[8:11], s37 offen sc1 lds
s_mov_b32 m0, 58368
s_nop 0
buffer_load_dwordx4 v19, s[8:11], s37 offen sc1 lds
s_mov_b32 m0, 61440
s_nop 0
buffer_load_dwordx4 v20, s[8:11], s37 offen sc1 lds
s_mov_b32 m0, 64512
s_nop 0
buffer_load_dwordx4 v21, s[8:11], s37 offen sc1 lds
s_mov_b32 m0, 124928
s_nop 0
buffer_load_dwordx4 v22, s[12:15], s38 offen lds
s_mov_b32 m0, 128000
s_nop 0
buffer_load_dwordx4 v23, s[12:15], s38 offen lds
s_add_u32 s37, s37, 16384
s_add_u32 s38, s38, 131072
s_waitcnt vmcnt(16)
s_barrier
s_mov_b32 m0, 98304
s_nop 0
buffer_load_dwordx4 v16, s[8:11], s37 offen sc1 lds
s_mov_b32 m0, 101376
s_nop 0
buffer_load_dwordx4 v17, s[8:11], s37 offen sc1 lds
s_mov_b32 m0, 104448
s_nop 0
buffer_load_dwordx4 v18, s[8:11], s37 offen sc1 lds
s_mov_b32 m0, 107520
s_nop 0
buffer_load_dwordx4 v19, s[8:11], s37 offen sc1 lds
s_mov_b32 m0, 110592
s_nop 0
buffer_load_dwordx4 v20, s[8:11], s37 offen sc1 lds
s_mov_b32 m0, 113664
s_nop 0
buffer_load_dwordx4 v21, s[8:11], s37 offen sc1 lds
s_mov_b32 m0, 133120
s_nop 0
buffer_load_dwordx4 v22, s[12:15], s38 offen lds
s_mov_b32 m0, 136192
s_nop 0
buffer_load_dwordx4 v23, s[12:15], s38 offen lds
s_add_u32 s37, s37, 16384
s_add_u32 s38, s38, 131072
s_waitcnt vmcnt(16)
s_barrier
s_mov_b32 m0, 147456
s_nop 0
buffer_load_dwordx4 v16, s[8:11], s37 offen sc1 lds
s_mov_b32 m0, 150528
s_nop 0
buffer_load_dwordx4 v17, s[8:11], s37 offen sc1 lds
s_mov_b32 m0, 153600
s_nop 0
buffer_load_dwordx4 v18, s[8:11], s37 offen sc1 lds
s_mov_b32 m0, 156672
s_nop 0
buffer_load_dwordx4 v19, s[8:11], s37 offen sc1 lds
s_mov_b32 m0, 159744
s_nop 0
buffer_load_dwordx4 v20, s[8:11], s37 offen sc1 lds
s_mov_b32 m0, 162816
s_nop 0
buffer_load_dwordx4 v21, s[8:11], s37 offen sc1 lds
s_mov_b32 m0, 141312
s_nop 0
buffer_load_dwordx4 v22, s[12:15], s38 offen lds
s_mov_b32 m0, 144384
s_nop 0
buffer_load_dwordx4 v23, s[12:15], s38 offen lds
s_add_u32 s37, s37, 16384
s_add_u32 s38, s38, 131072
s_waitcnt vmcnt(16)
s_barrier
s_mov_b32 m0, 0
s_nop 0
buffer_load_dwordx4 v16, s[8:11], s37 offen sc1 lds
s_mov_b32 m0, 3072
s_nop 0
buffer_load_dwordx4 v17, s[8:11], s37 offen sc1 lds
s_mov_b32 m0, 6144
s_nop 0
buffer_load_dwordx4 v18, s[8:11], s37 offen sc1 lds
s_mov_b32 m0, 9216
s_nop 0
buffer_load_dwordx4 v19, s[8:11], s37 offen sc1 lds
s_mov_b32 m0, 12288
s_nop 0
buffer_load_dwordx4 v20, s[8:11], s37 offen sc1 lds
s_mov_b32 m0, 15360
s_nop 0
buffer_load_dwordx4 v21, s[8:11], s37 offen sc1 lds
s_mov_b32 m0, 116736
s_nop 0
buffer_load_dwordx4 v22, s[12:15], s38 offen lds
s_mov_b32 m0, 119808
s_nop 0
buffer_load_dwordx4 v23, s[12:15], s38 offen lds
s_add_u32 s37, s37, 16384
s_add_u32 s38, s38, 131072
s_cmp_lt_u32 s36, 6
s_cselect_b32 s88, s72, s74
s_cselect_b32 s89, s73, s75
s_lshl_b32 s43, s35, 8
s_add_u32 s88, s88, s43
s_addc_u32 s89, s89, 0
s_mov_b32 s90, 7333120
s_mov_b32 s91, 0x20000
v_lshrrev_b32 v12, 4, v1
v_lshlrev_b32 v13, 1, v12
v_and_b32 v10, 15, v1
v_xor_b32 v10, v10, v13
v_lshlrev_b32 v10, 4, v10
v_mul_u32_u24 v12, 7168, v12
v_add_u32 v10, v10, v12
v_xor_b32 v11, 128, v10
v_add_u32 v11, 28672, v11
s_and_b32 s44, s36, 1
s_mul_i32 s44, s44, 229376
s_sub_u32 s45, s36, 4
s_lshl_b32 s45, s45, 13
s_add_u32 m0, s45, 16384
s_add_u32 s43, s44, 0
buffer_load_dwordx4 v10, s[88:91], s43 offen lds
s_add_u32 m0, s45, 17408
s_add_u32 s43, s44, 0
buffer_load_dwordx4 v11, s[88:91], s43 offen lds
s_add_u32 m0, s45, 18432
s_add_u32 s43, s44, 57344
buffer_load_dwordx4 v10, s[88:91], s43 offen lds
s_add_u32 m0, s45, 19456
s_add_u32 s43, s44, 57344
buffer_load_dwordx4 v11, s[88:91], s43 offen lds
s_add_u32 m0, s45, 20480
s_add_u32 s43, s44, 114688
buffer_load_dwordx4 v10, s[88:91], s43 offen lds
s_add_u32 m0, s45, 21504
s_add_u32 s43, s44, 114688
buffer_load_dwordx4 v11, s[88:91], s43 offen lds
s_add_u32 m0, s45, 22528
s_add_u32 s43, s44, 172032
buffer_load_dwordx4 v10, s[88:91], s43 offen lds
s_add_u32 m0, s45, 23552
s_add_u32 s43, s44, 172032
buffer_load_dwordx4 v11, s[88:91], s43 offen lds
s_add_u32 m0, s45, 65536
s_add_u32 s43, s44, 458752
buffer_load_dwordx4 v10, s[88:91], s43 offen lds
s_add_u32 m0, s45, 66560
s_add_u32 s43, s44, 458752
buffer_load_dwordx4 v11, s[88:91], s43 offen lds
s_add_u32 m0, s45, 67584
s_add_u32 s43, s44, 516096
buffer_load_dwordx4 v10, s[88:91], s43 offen lds
s_add_u32 m0, s45, 68608
s_add_u32 s43, s44, 516096
buffer_load_dwordx4 v11, s[88:91], s43 offen lds
s_add_u32 m0, s45, 69632
s_add_u32 s43, s44, 573440
buffer_load_dwordx4 v10, s[88:91], s43 offen lds
s_add_u32 m0, s45, 70656
s_add_u32 s43, s44, 573440
buffer_load_dwordx4 v11, s[88:91], s43 offen lds
s_add_u32 m0, s45, 71680
s_add_u32 s43, s44, 630784
buffer_load_dwordx4 v10, s[88:91], s43 offen lds
s_add_u32 m0, s45, 72704
s_add_u32 s43, s44, 630784
buffer_load_dwordx4 v11, s[88:91], s43 offen lds
s_waitcnt vmcnt(32)
s_barrier
s_mov_b32 m0, 49152
s_nop 0
buffer_load_dwordx4 v16, s[8:11], s37 offen sc1 lds
s_mov_b32 m0, 52224
s_nop 0
buffer_load_dwordx4 v17, s[8:11], s37 offen sc1 lds
s_mov_b32 m0, 55296
s_nop 0
buffer_load_dwordx4 v18, s[8:11], s37 offen sc1 lds
s_mov_b32 m0, 58368
s_nop 0
buffer_load_dwordx4 v19, s[8:11], s37 offen sc1 lds
s_mov_b32 m0, 61440
s_nop 0
buffer_load_dwordx4 v20, s[8:11], s37 offen sc1 lds
s_mov_b32 m0, 64512
s_nop 0
buffer_load_dwordx4 v21, s[8:11], s37 offen sc1 lds
s_mov_b32 m0, 124928
s_nop 0
buffer_load_dwordx4 v22, s[12:15], s38 offen lds
s_mov_b32 m0, 128000
s_nop 0
buffer_load_dwordx4 v23, s[12:15], s38 offen lds
s_add_u32 s37, s37, 16384
s_add_u32 s38, s38, 131072
s_waitcnt vmcnt(32)
s_barrier
s_mov_b32 m0, 98304
s_nop 0
buffer_load_dwordx4 v16, s[8:11], s37 offen sc1 lds
s_mov_b32 m0, 101376
s_nop 0
buffer_load_dwordx4 v17, s[8:11], s37 offen sc1 lds
s_mov_b32 m0, 104448
s_nop 0
buffer_load_dwordx4 v18, s[8:11], s37 offen sc1 lds
s_mov_b32 m0, 107520
s_nop 0
buffer_load_dwordx4 v19, s[8:11], s37 offen sc1 lds
s_mov_b32 m0, 110592
s_nop 0
buffer_load_dwordx4 v20, s[8:11], s37 offen sc1 lds
s_mov_b32 m0, 113664
s_nop 0
buffer_load_dwordx4 v21, s[8:11], s37 offen sc1 lds
s_mov_b32 m0, 133120
s_nop 0
buffer_load_dwordx4 v22, s[12:15], s38 offen lds
s_mov_b32 m0, 136192
s_nop 0
buffer_load_dwordx4 v23, s[12:15], s38 offen lds
s_add_u32 s37, s37, 16384
s_add_u32 s38, s38, 131072
s_waitcnt vmcnt(32)
s_barrier
s_mov_b32 m0, 147456
s_nop 0
buffer_load_dwordx4 v16, s[8:11], s37 offen sc1 lds
s_mov_b32 m0, 150528
s_nop 0
buffer_load_dwordx4 v17, s[8:11], s37 offen sc1 lds
s_mov_b32 m0, 153600
s_nop 0
buffer_load_dwordx4 v18, s[8:11], s37 offen sc1 lds
s_mov_b32 m0, 156672
s_nop 0
buffer_load_dwordx4 v19, s[8:11], s37 offen sc1 lds
s_mov_b32 m0, 159744
s_nop 0
buffer_load_dwordx4 v20, s[8:11], s37 offen sc1 lds
s_mov_b32 m0, 162816
s_nop 0
buffer_load_dwordx4 v21, s[8:11], s37 offen sc1 lds
s_mov_b32 m0, 141312
s_nop 0
buffer_load_dwordx4 v22, s[12:15], s38 offen lds
s_mov_b32 m0, 144384
s_nop 0
buffer_load_dwordx4 v23, s[12:15], s38 offen lds
s_add_u32 s37, s37, 16384
s_add_u32 s38, s38, 131072
s_waitcnt vmcnt(16)
s_barrier
s_waitcnt vmcnt(8)
s_barrier
s_waitcnt vmcnt(0)
s_barrier
s_barrier
s_barrier
s_branch Lk2end_34
Lp_39:
v_add_u32 v16, 1024, v2
v_add_u32 v17, 4096, v2
v_add_u32 v18, 7168, v2
v_add_u32 v19, 10240, v2
v_add_u32 v20, 13312, v2
v_add_u32 v21, 0, v3
v_add_u32 v22, 49152, v3
v_add_u32 v23, 98304, v3
s_barrier
s_mov_b32 s37, 0
s_mov_b32 m0, 1024
s_nop 0
buffer_load_dwordx4 v16, s[8:11], s37 offen sc1 lds
s_mov_b32 m0, 4096
s_nop 0
buffer_load_dwordx4 v17, s[8:11], s37 offen sc1 lds
s_mov_b32 m0, 7168
s_nop 0
buffer_load_dwordx4 v18, s[8:11], s37 offen sc1 lds
s_mov_b32 m0, 10240
s_nop 0
buffer_load_dwordx4 v19, s[8:11], s37 offen sc1 lds
s_mov_b32 m0, 13312
s_nop 0
buffer_load_dwordx4 v20, s[8:11], s37 offen sc1 lds
s_mov_b32 s37, 16384
s_mov_b32 m0, 50176
s_nop 0
buffer_load_dwordx4 v16, s[8:11], s37 offen sc1 lds
s_mov_b32 m0, 53248
s_nop 0
buffer_load_dwordx4 v17, s[8:11], s37 offen sc1 lds
s_mov_b32 m0, 56320
s_nop 0
buffer_load_dwordx4 v18, s[8:11], s37 offen sc1 lds
s_mov_b32 m0, 59392
s_nop 0
buffer_load_dwordx4 v19, s[8:11], s37 offen sc1 lds
s_mov_b32 m0, 62464
s_nop 0
buffer_load_dwordx4 v20, s[8:11], s37 offen sc1 lds
s_mov_b32 s37, 32768
s_mov_b32 m0, 99328
s_nop 0
buffer_load_dwordx4 v16, s[8:11], s37 offen sc1 lds
s_mov_b32 m0, 102400
s_nop 0
buffer_load_dwordx4 v17, s[8:11], s37 offen sc1 lds
s_mov_b32 m0, 105472
s_nop 0
buffer_load_dwordx4 v18, s[8:11], s37 offen sc1 lds
s_mov_b32 m0, 108544
s_nop 0
buffer_load_dwordx4 v19, s[8:11], s37 offen sc1 lds
s_mov_b32 m0, 111616
s_nop 0
buffer_load_dwordx4 v20, s[8:11], s37 offen sc1 lds
s_mov_b32 s37, 49152
s_mov_b32 m0, 148480
s_nop 0
buffer_load_dwordx4 v16, s[8:11], s37 offen sc1 lds
s_mov_b32 m0, 151552
s_nop 0
buffer_load_dwordx4 v17, s[8:11], s37 offen sc1 lds
s_mov_b32 m0, 154624
s_nop 0
buffer_load_dwordx4 v18, s[8:11], s37 offen sc1 lds
s_mov_b32 m0, 157696
s_nop 0
buffer_load_dwordx4 v19, s[8:11], s37 offen sc1 lds
s_mov_b32 m0, 160768
s_nop 0
buffer_load_dwordx4 v20, s[8:11], s37 offen sc1 lds
s_mov_b32 s37, 65536
s_mov_b32 s38, 524288
s_waitcnt vmcnt(15)
s_barrier
s_waitcnt vmcnt(10)
s_barrier
s_mov_b32 m0, 1024
s_nop 0
buffer_load_dwordx4 v16, s[8:11], s37 offen sc1 lds
s_mov_b32 m0, 4096
s_nop 0
buffer_load_dwordx4 v17, s[8:11], s37 offen sc1 lds
s_mov_b32 m0, 7168
s_nop 0
buffer_load_dwordx4 v18, s[8:11], s37 offen sc1 lds
s_mov_b32 m0, 10240
s_nop 0
buffer_load_dwordx4 v19, s[8:11], s37 offen sc1 lds
s_mov_b32 m0, 13312
s_nop 0
buffer_load_dwordx4 v20, s[8:11], s37 offen sc1 lds
s_mov_b32 m0, 114688
s_nop 0
buffer_load_dwordx4 v21, s[12:15], s38 offen lds
s_mov_b32 m0, 117760
s_nop 0
buffer_load_dwordx4 v22, s[12:15], s38 offen lds
s_mov_b32 m0, 120832
s_nop 0
buffer_load_dwordx4 v23, s[12:15], s38 offen lds
s_add_u32 s37, s37, 16384
s_add_u32 s38, s38, 131072
s_waitcnt vmcnt(13)
s_barrier
s_mov_b32 m0, 50176
s_nop 0
buffer_load_dwordx4 v16, s[8:11], s37 offen sc1 lds
s_mov_b32 m0, 53248
s_nop 0
buffer_load_dwordx4 v17, s[8:11], s37 offen sc1 lds
s_mov_b32 m0, 56320
s_nop 0
buffer_load_dwordx4 v18, s[8:11], s37 offen sc1 lds
s_mov_b32 m0, 59392
s_nop 0
buffer_load_dwordx4 v19, s[8:11], s37 offen sc1 lds
s_mov_b32 m0, 62464
s_nop 0
buffer_load_dwordx4 v20, s[8:11], s37 offen sc1 lds
s_mov_b32 m0, 122880
s_nop 0
buffer_load_dwordx4 v21, s[12:15], s38 offen lds
s_mov_b32 m0, 125952
s_nop 0
buffer_load_dwordx4 v22, s[12:15], s38 offen lds
s_mov_b32 m0, 129024
s_nop 0
buffer_load_dwordx4 v23, s[12:15], s38 offen lds
s_add_u32 s37, s37, 16384
s_add_u32 s38, s38, 131072
s_waitcnt vmcnt(16)
s_barrier
s_mov_b32 m0, 99328
s_nop 0
buffer_load_dwordx4 v16, s[8:11], s37 offen sc1 lds
s_mov_b32 m0, 102400
s_nop 0
buffer_load_dwordx4 v17, s[8:11], s37 offen sc1 lds
s_mov_b32 m0, 105472
s_nop 0
buffer_load_dwordx4 v18, s[8:11], s37 offen sc1 lds
s_mov_b32 m0, 108544
s_nop 0
buffer_load_dwordx4 v19, s[8:11], s37 offen sc1 lds
s_mov_b32 m0, 111616
s_nop 0
buffer_load_dwordx4 v20, s[8:11], s37 offen sc1 lds
s_mov_b32 m0, 131072
s_nop 0
buffer_load_dwordx4 v21, s[12:15], s38 offen lds
s_mov_b32 m0, 134144
s_nop 0
buffer_load_dwordx4 v22, s[12:15], s38 offen lds
s_mov_b32 m0, 137216
s_nop 0
buffer_load_dwordx4 v23, s[12:15], s38 offen lds
s_add_u32 s37, s37, 16384
s_add_u32 s38, s38, 131072
s_waitcnt vmcnt(16)
s_barrier
s_mov_b32 m0, 148480
s_nop 0
buffer_load_dwordx4 v16, s[8:11], s37 offen sc1 lds
s_mov_b32 m0, 151552
s_nop 0
buffer_load_dwordx4 v17, s[8:11], s37 offen sc1 lds
s_mov_b32 m0, 154624
s_nop 0
buffer_load_dwordx4 v18, s[8:11], s37 offen sc1 lds
s_mov_b32 m0, 157696
s_nop 0
buffer_load_dwordx4 v19, s[8:11], s37 offen sc1 lds
s_mov_b32 m0, 160768
s_nop 0
buffer_load_dwordx4 v20, s[8:11], s37 offen sc1 lds
s_mov_b32 m0, 139264
s_nop 0
buffer_load_dwordx4 v21, s[12:15], s38 offen lds
s_mov_b32 m0, 142336
s_nop 0
buffer_load_dwordx4 v22, s[12:15], s38 offen lds
s_mov_b32 m0, 145408
s_nop 0
buffer_load_dwordx4 v23, s[12:15], s38 offen lds
s_add_u32 s37, s37, 16384
s_add_u32 s38, s38, 131072
s_waitcnt vmcnt(16)
s_barrier
s_mov_b32 m0, 1024
s_nop 0
buffer_load_dwordx4 v16, s[8:11], s37 offen sc1 lds
s_mov_b32 m0, 4096
s_nop 0
buffer_load_dwordx4 v17, s[8:11], s37 offen sc1 lds
s_mov_b32 m0, 7168
s_nop 0
buffer_load_dwordx4 v18, s[8:11], s37 offen sc1 lds
s_mov_b32 m0, 10240
s_nop 0
buffer_load_dwordx4 v19, s[8:11], s37 offen sc1 lds
s_mov_b32 m0, 13312
s_nop 0
buffer_load_dwordx4 v20, s[8:11], s37 offen sc1 lds
s_mov_b32 m0, 114688
s_nop 0
buffer_load_dwordx4 v21, s[12:15], s38 offen lds
s_mov_b32 m0, 117760
s_nop 0
buffer_load_dwordx4 v22, s[12:15], s38 offen lds
s_mov_b32 m0, 120832
s_nop 0
buffer_load_dwordx4 v23, s[12:15], s38 offen lds
s_add_u32 s37, s37, 16384
s_add_u32 s38, s38, 131072
s_waitcnt vmcnt(16)
s_barrier
s_mov_b32 m0, 50176
s_nop 0
buffer_load_dwordx4 v16, s[8:11], s37 offen sc1 lds
s_mov_b32 m0, 53248
s_nop 0
buffer_load_dwordx4 v17, s[8:11], s37 offen sc1 lds
s_mov_b32 m0, 56320
s_nop 0
buffer_load_dwordx4 v18, s[8:11], s37 offen sc1 lds
s_mov_b32 m0, 59392
s_nop 0
buffer_load_dwordx4 v19, s[8:11], s37 offen sc1 lds
s_mov_b32 m0, 62464
s_nop 0
buffer_load_dwordx4 v20, s[8:11], s37 offen sc1 lds
s_mov_b32 m0, 122880
s_nop 0
buffer_load_dwordx4 v21, s[12:15], s38 offen lds
s_mov_b32 m0, 125952
s_nop 0
buffer_load_dwordx4 v22, s[12:15], s38 offen lds
s_mov_b32 m0, 129024
s_nop 0
buffer_load_dwordx4 v23, s[12:15], s38 offen lds
s_add_u32 s37, s37, 16384
s_add_u32 s38, s38, 131072
s_waitcnt vmcnt(16)
s_barrier
s_mov_b32 m0, 99328
s_nop 0
buffer_load_dwordx4 v16, s[8:11], s37 offen sc1 lds
s_mov_b32 m0, 102400
s_nop 0
buffer_load_dwordx4 v17, s[8:11], s37 offen sc1 lds
s_mov_b32 m0, 105472
s_nop 0
buffer_load_dwordx4 v18, s[8:11], s37 offen sc1 lds
s_mov_b32 m0, 108544
s_nop 0
buffer_load_dwordx4 v19, s[8:11], s37 offen sc1 lds
s_mov_b32 m0, 111616
s_nop 0
buffer_load_dwordx4 v20, s[8:11], s37 offen sc1 lds
s_mov_b32 m0, 131072
s_nop 0
buffer_load_dwordx4 v21, s[12:15], s38 offen lds
s_mov_b32 m0, 134144
s_nop 0
buffer_load_dwordx4 v22, s[12:15], s38 offen lds
s_mov_b32 m0, 137216
s_nop 0
buffer_load_dwordx4 v23, s[12:15], s38 offen lds
s_add_u32 s37, s37, 16384
s_add_u32 s38, s38, 131072
s_waitcnt vmcnt(16)
s_barrier
s_mov_b32 m0, 148480
s_nop 0
buffer_load_dwordx4 v16, s[8:11], s37 offen sc1 lds
s_mov_b32 m0, 151552
s_nop 0
buffer_load_dwordx4 v17, s[8:11], s37 offen sc1 lds
s_mov_b32 m0, 154624
s_nop 0
buffer_load_dwordx4 v18, s[8:11], s37 offen sc1 lds
s_mov_b32 m0, 157696
s_nop 0
buffer_load_dwordx4 v19, s[8:11], s37 offen sc1 lds
s_mov_b32 m0, 160768
s_nop 0
buffer_load_dwordx4 v20, s[8:11], s37 offen sc1 lds
s_mov_b32 m0, 139264
s_nop 0
buffer_load_dwordx4 v21, s[12:15], s38 offen lds
s_mov_b32 m0, 142336
s_nop 0
buffer_load_dwordx4 v22, s[12:15], s38 offen lds
s_mov_b32 m0, 145408
s_nop 0
buffer_load_dwordx4 v23, s[12:15], s38 offen lds
s_add_u32 s37, s37, 16384
s_add_u32 s38, s38, 131072
s_waitcnt vmcnt(16)
s_barrier
s_mov_b32 m0, 1024
s_nop 0
buffer_load_dwordx4 v16, s[8:11], s37 offen sc1 lds
s_mov_b32 m0, 4096
s_nop 0
buffer_load_dwordx4 v17, s[8:11], s37 offen sc1 lds
s_mov_b32 m0, 7168
s_nop 0
buffer_load_dwordx4 v18, s[8:11], s37 offen sc1 lds
s_mov_b32 m0, 10240
s_nop 0
buffer_load_dwordx4 v19, s[8:11], s37 offen sc1 lds
s_mov_b32 m0, 13312
s_nop 0
buffer_load_dwordx4 v20, s[8:11], s37 offen sc1 lds
s_mov_b32 m0, 114688
s_nop 0
buffer_load_dwordx4 v21, s[12:15], s38 offen lds
s_mov_b32 m0, 117760
s_nop 0
buffer_load_dwordx4 v22, s[12:15], s38 offen lds
s_mov_b32 m0, 120832
s_nop 0
buffer_load_dwordx4 v23, s[12:15], s38 offen lds
s_add_u32 s37, s37, 16384
s_add_u32 s38, s38, 131072
s_cmp_lt_u32 s36, 6
s_cselect_b32 s88, s72, s74
s_cselect_b32 s89, s73, s75
s_lshl_b32 s43, s35, 8
s_add_u32 s88, s88, s43
s_addc_u32 s89, s89, 0
s_mov_b32 s90, 7333120
s_mov_b32 s91, 0x20000
v_lshrrev_b32 v12, 4, v1
v_lshlrev_b32 v13, 1, v12
v_and_b32 v10, 15, v1
v_xor_b32 v10, v10, v13
v_lshlrev_b32 v10, 4, v10
v_mul_u32_u24 v12, 7168, v12
v_add_u32 v10, v10, v12
v_xor_b32 v11, 128, v10
v_add_u32 v11, 28672, v11
s_and_b32 s44, s36, 1
s_mul_i32 s44, s44, 229376
s_sub_u32 s45, s36, 4
s_lshl_b32 s45, s45, 13
s_add_u32 m0, s45, 16384
s_add_u32 s43, s44, 0
buffer_load_dwordx4 v10, s[88:91], s43 offen lds
s_add_u32 m0, s45, 17408
s_add_u32 s43, s44, 0
buffer_load_dwordx4 v11, s[88:91], s43 offen lds
s_add_u32 m0, s45, 18432
s_add_u32 s43, s44, 57344
buffer_load_dwordx4 v10, s[88:91], s43 offen lds
s_add_u32 m0, s45, 19456
s_add_u32 s43, s44, 57344
buffer_load_dwordx4 v11, s[88:91], s43 offen lds
s_add_u32 m0, s45, 20480
s_add_u32 s43, s44, 114688
buffer_load_dwordx4 v10, s[88:91], s43 offen lds
s_add_u32 m0, s45, 21504
s_add_u32 s43, s44, 114688
buffer_load_dwordx4 v11, s[88:91], s43 offen lds
s_add_u32 m0, s45, 22528
s_add_u32 s43, s44, 172032
buffer_load_dwordx4 v10, s[88:91], s43 offen lds
s_add_u32 m0, s45, 23552
s_add_u32 s43, s44, 172032
buffer_load_dwordx4 v11, s[88:91], s43 offen lds
s_add_u32 m0, s45, 65536
s_add_u32 s43, s44, 458752
buffer_load_dwordx4 v10, s[88:91], s43 offen lds
s_add_u32 m0, s45, 66560
s_add_u32 s43, s44, 458752
buffer_load_dwordx4 v11, s[88:91], s43 offen lds
s_add_u32 m0, s45, 67584
s_add_u32 s43, s44, 516096
buffer_load_dwordx4 v10, s[88:91], s43 offen lds
s_add_u32 m0, s45, 68608
s_add_u32 s43, s44, 516096
buffer_load_dwordx4 v11, s[88:91], s43 offen lds
s_add_u32 m0, s45, 69632
s_add_u32 s43, s44, 573440
buffer_load_dwordx4 v10, s[88:91], s43 offen lds
s_add_u32 m0, s45, 70656
s_add_u32 s43, s44, 573440
buffer_load_dwordx4 v11, s[88:91], s43 offen lds
s_add_u32 m0, s45, 71680
s_add_u32 s43, s44, 630784
buffer_load_dwordx4 v10, s[88:91], s43 offen lds
s_add_u32 m0, s45, 72704
s_add_u32 s43, s44, 630784
buffer_load_dwordx4 v11, s[88:91], s43 offen lds
s_waitcnt vmcnt(32)
s_barrier
s_mov_b32 m0, 50176
s_nop 0
buffer_load_dwordx4 v16, s[8:11], s37 offen sc1 lds
s_mov_b32 m0, 53248
s_nop 0
buffer_load_dwordx4 v17, s[8:11], s37 offen sc1 lds
s_mov_b32 m0, 56320
s_nop 0
buffer_load_dwordx4 v18, s[8:11], s37 offen sc1 lds
s_mov_b32 m0, 59392
s_nop 0
buffer_load_dwordx4 v19, s[8:11], s37 offen sc1 lds
s_mov_b32 m0, 62464
s_nop 0
buffer_load_dwordx4 v20, s[8:11], s37 offen sc1 lds
s_mov_b32 m0, 122880
s_nop 0
buffer_load_dwordx4 v21, s[12:15], s38 offen lds
s_mov_b32 m0, 125952
s_nop 0
buffer_load_dwordx4 v22, s[12:15], s38 offen lds
s_mov_b32 m0, 129024
s_nop 0
buffer_load_dwordx4 v23, s[12:15], s38 offen lds
s_add_u32 s37, s37, 16384
s_add_u32 s38, s38, 131072
s_waitcnt vmcnt(32)
s_barrier
s_mov_b32 m0, 99328
s_nop 0
buffer_load_dwordx4 v16, s[8:11], s37 offen sc1 lds
s_mov_b32 m0, 102400
s_nop 0
buffer_load_dwordx4 v17, s[8:11], s37 offen sc1 lds
s_mov_b32 m0, 105472
s_nop 0
buffer_load_dwordx4 v18, s[8:11], s37 offen sc1 lds
s_mov_b32 m0, 108544
s_nop 0
buffer_load_dwordx4 v19, s[8:11], s37 offen sc1 lds
s_mov_b32 m0, 111616
s_nop 0
buffer_load_dwordx4 v20, s[8:11], s37 offen sc1 lds
s_mov_b32 m0, 131072
s_nop 0
buffer_load_dwordx4 v21, s[12:15], s38 offen lds
s_mov_b32 m0, 134144
s_nop 0
buffer_load_dwordx4 v22, s[12:15], s38 offen lds
s_mov_b32 m0, 137216
s_nop 0
buffer_load_dwordx4 v23, s[12:15], s38 offen lds
s_add_u32 s37, s37, 16384
s_add_u32 s38, s38, 131072
s_waitcnt vmcnt(32)
s_barrier
s_mov_b32 m0, 148480
s_nop 0
buffer_load_dwordx4 v16, s[8:11], s37 offen sc1 lds
s_mov_b32 m0, 151552
s_nop 0
buffer_load_dwordx4 v17, s[8:11], s37 offen sc1 lds
s_mov_b32 m0, 154624
s_nop 0
buffer_load_dwordx4 v18, s[8:11], s37 offen sc1 lds
s_mov_b32 m0, 157696
s_nop 0
buffer_load_dwordx4 v19, s[8:11], s37 offen sc1 lds
s_mov_b32 m0, 160768
s_nop 0
buffer_load_dwordx4 v20, s[8:11], s37 offen sc1 lds
s_mov_b32 m0, 139264
s_nop 0
buffer_load_dwordx4 v21, s[12:15], s38 offen lds
s_mov_b32 m0, 142336
s_nop 0
buffer_load_dwordx4 v22, s[12:15], s38 offen lds
s_mov_b32 m0, 145408
s_nop 0
buffer_load_dwordx4 v23, s[12:15], s38 offen lds
s_add_u32 s37, s37, 16384
s_add_u32 s38, s38, 131072
s_waitcnt vmcnt(16)
s_barrier
s_waitcnt vmcnt(8)
s_barrier
s_waitcnt vmcnt(0)
s_barrier
s_barrier
s_barrier
s_branch Lk2end_34
Lp_40:
v_add_u32 v16, 2048, v2
v_add_u32 v17, 5120, v2
v_add_u32 v18, 8192, v2
v_add_u32 v19, 11264, v2
v_add_u32 v20, 14336, v2
v_add_u32 v21, 16384, v3
v_add_u32 v22, 65536, v3
v_add_u32 v23, 114688, v3
s_barrier
s_mov_b32 s37, 0
s_mov_b32 m0, 2048
s_nop 0
buffer_load_dwordx4 v16, s[8:11], s37 offen sc1 lds
s_mov_b32 m0, 5120
s_nop 0
buffer_load_dwordx4 v17, s[8:11], s37 offen sc1 lds
s_mov_b32 m0, 8192
s_nop 0
buffer_load_dwordx4 v18, s[8:11], s37 offen sc1 lds
s_mov_b32 m0, 11264
s_nop 0
buffer_load_dwordx4 v19, s[8:11], s37 offen sc1 lds
s_mov_b32 m0, 14336
s_nop 0
buffer_load_dwordx4 v20, s[8:11], s37 offen sc1 lds
s_mov_b32 s37, 16384
s_mov_b32 m0, 51200
s_nop 0
buffer_load_dwordx4 v16, s[8:11], s37 offen sc1 lds
s_mov_b32 m0, 54272
s_nop 0
buffer_load_dwordx4 v17, s[8:11], s37 offen sc1 lds
s_mov_b32 m0, 57344
s_nop 0
buffer_load_dwordx4 v18, s[8:11], s37 offen sc1 lds
s_mov_b32 m0, 60416
s_nop 0
buffer_load_dwordx4 v19, s[8:11], s37 offen sc1 lds
s_mov_b32 m0, 63488
s_nop 0
buffer_load_dwordx4 v20, s[8:11], s37 offen sc1 lds
s_mov_b32 s37, 32768
s_mov_b32 m0, 100352
s_nop 0
buffer_load_dwordx4 v16, s[8:11], s37 offen sc1 lds
s_mov_b32 m0, 103424
s_nop 0
buffer_load_dwordx4 v17, s[8:11], s37 offen sc1 lds
s_mov_b32 m0, 106496
s_nop 0
buffer_load_dwordx4 v18, s[8:11], s37 offen sc1 lds
s_mov_b32 m0, 109568
s_nop 0
buffer_load_dwordx4 v19, s[8:11], s37 offen sc1 lds
s_mov_b32 m0, 112640
s_nop 0
buffer_load_dwordx4 v20, s[8:11], s37 offen sc1 lds
s_mov_b32 s37, 49152
s_mov_b32 m0, 149504
s_nop 0
buffer_load_dwordx4 v16, s[8:11], s37 offen sc1 lds
s_mov_b32 m0, 152576
s_nop 0
buffer_load_dwordx4 v17, s[8:11], s37 offen sc1 lds
s_mov_b32 m0, 155648
s_nop 0
buffer_load_dwordx4 v18, s[8:11], s37 offen sc1 lds
s_mov_b32 m0, 158720
s_nop 0
buffer_load_dwordx4 v19, s[8:11], s37 offen sc1 lds
s_mov_b32 m0, 161792
s_nop 0
buffer_load_dwordx4 v20, s[8:11], s37 offen sc1 lds
s_mov_b32 s37, 65536
s_mov_b32 s38, 524288
s_waitcnt vmcnt(15)
s_barrier
s_waitcnt vmcnt(10)
s_barrier
s_mov_b32 m0, 2048
s_nop 0
buffer_load_dwordx4 v16, s[8:11], s37 offen sc1 lds
s_mov_b32 m0, 5120
s_nop 0
buffer_load_dwordx4 v17, s[8:11], s37 offen sc1 lds
s_mov_b32 m0, 8192
s_nop 0
buffer_load_dwordx4 v18, s[8:11], s37 offen sc1 lds
s_mov_b32 m0, 11264
s_nop 0
buffer_load_dwordx4 v19, s[8:11], s37 offen sc1 lds
s_mov_b32 m0, 14336
s_nop 0
buffer_load_dwordx4 v20, s[8:11], s37 offen sc1 lds
s_mov_b32 m0, 115712
s_nop 0
buffer_load_dwordx4 v21, s[12:15], s38 offen lds
s_mov_b32 m0, 118784
s_nop 0
buffer_load_dwordx4 v22, s[12:15], s38 offen lds
s_mov_b32 m0, 121856
s_nop 0
buffer_load_dwordx4 v23, s[12:15], s38 offen lds
s_add_u32 s37, s37, 16384
s_add_u32 s38, s38, 131072
s_waitcnt vmcnt(13)
s_barrier
s_mov_b32 m0, 51200
s_nop 0
buffer_load_dwordx4 v16, s[8:11], s37 offen sc1 lds
s_mov_b32 m0, 54272
s_nop 0
buffer_load_dwordx4 v17, s[8:11], s37 offen sc1 lds
s_mov_b32 m0, 57344
s_nop 0
buffer_load_dwordx4 v18, s[8:11], s37 offen sc1 lds
s_mov_b32 m0, 60416
s_nop 0
buffer_load_dwordx4 v19, s[8:11], s37 offen sc1 lds
s_mov_b32 m0, 63488
s_nop 0
buffer_load_dwordx4 v20, s[8:11], s37 offen sc1 lds
s_mov_b32 m0, 123904
s_nop 0
buffer_load_dwordx4 v21, s[12:15], s38 offen lds
s_mov_b32 m0, 126976
s_nop 0
buffer_load_dwordx4 v22, s[12:15], s38 offen lds
s_mov_b32 m0, 130048
s_nop 0
buffer_load_dwordx4 v23, s[12:15], s38 offen lds
s_add_u32 s37, s37, 16384
s_add_u32 s38, s38, 131072
s_waitcnt vmcnt(16)
s_barrier
s_mov_b32 m0, 100352
s_nop 0
buffer_load_dwordx4 v16, s[8:11], s37 offen sc1 lds
s_mov_b32 m0, 103424
s_nop 0
buffer_load_dwordx4 v17, s[8:11], s37 offen sc1 lds
s_mov_b32 m0, 106496
s_nop 0
buffer_load_dwordx4 v18, s[8:11], s37 offen sc1 lds
s_mov_b32 m0, 109568
s_nop 0
buffer_load_dwordx4 v19, s[8:11], s37 offen sc1 lds
s_mov_b32 m0, 112640
s_nop 0
buffer_load_dwordx4 v20, s[8:11], s37 offen sc1 lds
s_mov_b32 m0, 132096
s_nop 0
buffer_load_dwordx4 v21, s[12:15], s38 offen lds
s_mov_b32 m0, 135168
s_nop 0
buffer_load_dwordx4 v22, s[12:15], s38 offen lds
s_mov_b32 m0, 138240
s_nop 0
buffer_load_dwordx4 v23, s[12:15], s38 offen lds
s_add_u32 s37, s37, 16384
s_add_u32 s38, s38, 131072
s_waitcnt vmcnt(16)
s_barrier
s_mov_b32 m0, 149504
s_nop 0
buffer_load_dwordx4 v16, s[8:11], s37 offen sc1 lds
s_mov_b32 m0, 152576
s_nop 0
buffer_load_dwordx4 v17, s[8:11], s37 offen sc1 lds
s_mov_b32 m0, 155648
s_nop 0
buffer_load_dwordx4 v18, s[8:11], s37 offen sc1 lds
s_mov_b32 m0, 158720
s_nop 0
buffer_load_dwordx4 v19, s[8:11], s37 offen sc1 lds
s_mov_b32 m0, 161792
s_nop 0
buffer_load_dwordx4 v20, s[8:11], s37 offen sc1 lds
s_mov_b32 m0, 140288
s_nop 0
buffer_load_dwordx4 v21, s[12:15], s38 offen lds
s_mov_b32 m0, 143360
s_nop 0
buffer_load_dwordx4 v22, s[12:15], s38 offen lds
s_mov_b32 m0, 146432
s_nop 0
buffer_load_dwordx4 v23, s[12:15], s38 offen lds
s_add_u32 s37, s37, 16384
s_add_u32 s38, s38, 131072
s_waitcnt vmcnt(16)
s_barrier
s_mov_b32 m0, 2048
s_nop 0
buffer_load_dwordx4 v16, s[8:11], s37 offen sc1 lds
s_mov_b32 m0, 5120
s_nop 0
buffer_load_dwordx4 v17, s[8:11], s37 offen sc1 lds
s_mov_b32 m0, 8192
s_nop 0
buffer_load_dwordx4 v18, s[8:11], s37 offen sc1 lds
s_mov_b32 m0, 11264
s_nop 0
buffer_load_dwordx4 v19, s[8:11], s37 offen sc1 lds
s_mov_b32 m0, 14336
s_nop 0
buffer_load_dwordx4 v20, s[8:11], s37 offen sc1 lds
s_mov_b32 m0, 115712
s_nop 0
buffer_load_dwordx4 v21, s[12:15], s38 offen lds
s_mov_b32 m0, 118784
s_nop 0
buffer_load_dwordx4 v22, s[12:15], s38 offen lds
s_mov_b32 m0, 121856
s_nop 0
buffer_load_dwordx4 v23, s[12:15], s38 offen lds
s_add_u32 s37, s37, 16384
s_add_u32 s38, s38, 131072
s_waitcnt vmcnt(16)
s_barrier
s_mov_b32 m0, 51200
s_nop 0
buffer_load_dwordx4 v16, s[8:11], s37 offen sc1 lds
s_mov_b32 m0, 54272
s_nop 0
buffer_load_dwordx4 v17, s[8:11], s37 offen sc1 lds
s_mov_b32 m0, 57344
s_nop 0
buffer_load_dwordx4 v18, s[8:11], s37 offen sc1 lds
s_mov_b32 m0, 60416
s_nop 0
buffer_load_dwordx4 v19, s[8:11], s37 offen sc1 lds
s_mov_b32 m0, 63488
s_nop 0
buffer_load_dwordx4 v20, s[8:11], s37 offen sc1 lds
s_mov_b32 m0, 123904
s_nop 0
buffer_load_dwordx4 v21, s[12:15], s38 offen lds
s_mov_b32 m0, 126976
s_nop 0
buffer_load_dwordx4 v22, s[12:15], s38 offen lds
s_mov_b32 m0, 130048
s_nop 0
buffer_load_dwordx4 v23, s[12:15], s38 offen lds
s_add_u32 s37, s37, 16384
s_add_u32 s38, s38, 131072
s_waitcnt vmcnt(16)
s_barrier
s_mov_b32 m0, 100352
s_nop 0
buffer_load_dwordx4 v16, s[8:11], s37 offen sc1 lds
s_mov_b32 m0, 103424
s_nop 0
buffer_load_dwordx4 v17, s[8:11], s37 offen sc1 lds
s_mov_b32 m0, 106496
s_nop 0
buffer_load_dwordx4 v18, s[8:11], s37 offen sc1 lds
s_mov_b32 m0, 109568
s_nop 0
buffer_load_dwordx4 v19, s[8:11], s37 offen sc1 lds
s_mov_b32 m0, 112640
s_nop 0
buffer_load_dwordx4 v20, s[8:11], s37 offen sc1 lds
s_mov_b32 m0, 132096
s_nop 0
buffer_load_dwordx4 v21, s[12:15], s38 offen lds
s_mov_b32 m0, 135168
s_nop 0
buffer_load_dwordx4 v22, s[12:15], s38 offen lds
s_mov_b32 m0, 138240
s_nop 0
buffer_load_dwordx4 v23, s[12:15], s38 offen lds
s_add_u32 s37, s37, 16384
s_add_u32 s38, s38, 131072
s_waitcnt vmcnt(16)
s_barrier
s_mov_b32 m0, 149504
s_nop 0
buffer_load_dwordx4 v16, s[8:11], s37 offen sc1 lds
s_mov_b32 m0, 152576
s_nop 0
buffer_load_dwordx4 v17, s[8:11], s37 offen sc1 lds
s_mov_b32 m0, 155648
s_nop 0
buffer_load_dwordx4 v18, s[8:11], s37 offen sc1 lds
s_mov_b32 m0, 158720
s_nop 0
buffer_load_dwordx4 v19, s[8:11], s37 offen sc1 lds
s_mov_b32 m0, 161792
s_nop 0
buffer_load_dwordx4 v20, s[8:11], s37 offen sc1 lds
s_mov_b32 m0, 140288
s_nop 0
buffer_load_dwordx4 v21, s[12:15], s38 offen lds
s_mov_b32 m0, 143360
s_nop 0
buffer_load_dwordx4 v22, s[12:15], s38 offen lds
s_mov_b32 m0, 146432
s_nop 0
buffer_load_dwordx4 v23, s[12:15], s38 offen lds
s_add_u32 s37, s37, 16384
s_add_u32 s38, s38, 131072
s_waitcnt vmcnt(16)
s_barrier
s_mov_b32 m0, 2048
s_nop 0
buffer_load_dwordx4 v16, s[8:11], s37 offen sc1 lds
s_mov_b32 m0, 5120
s_nop 0
buffer_load_dwordx4 v17, s[8:11], s37 offen sc1 lds
s_mov_b32 m0, 8192
s_nop 0
buffer_load_dwordx4 v18, s[8:11], s37 offen sc1 lds
s_mov_b32 m0, 11264
s_nop 0
buffer_load_dwordx4 v19, s[8:11], s37 offen sc1 lds
s_mov_b32 m0, 14336
s_nop 0
buffer_load_dwordx4 v20, s[8:11], s37 offen sc1 lds
s_mov_b32 m0, 115712
s_nop 0
buffer_load_dwordx4 v21, s[12:15], s38 offen lds
s_mov_b32 m0, 118784
s_nop 0
buffer_load_dwordx4 v22, s[12:15], s38 offen lds
s_mov_b32 m0, 121856
s_nop 0
buffer_load_dwordx4 v23, s[12:15], s38 offen lds
s_add_u32 s37, s37, 16384
s_add_u32 s38, s38, 131072
s_cmp_lt_u32 s36, 6
s_cselect_b32 s88, s72, s74
s_cselect_b32 s89, s73, s75
s_lshl_b32 s43, s35, 8
s_add_u32 s88, s88, s43
s_addc_u32 s89, s89, 0
s_mov_b32 s90, 7333120
s_mov_b32 s91, 0x20000
v_lshrrev_b32 v12, 4, v1
v_lshlrev_b32 v13, 1, v12
v_and_b32 v10, 15, v1
v_xor_b32 v10, v10, v13
v_lshlrev_b32 v10, 4, v10
v_mul_u32_u24 v12, 7168, v12
v_add_u32 v10, v10, v12
v_xor_b32 v11, 128, v10
v_add_u32 v11, 28672, v11
s_and_b32 s44, s36, 1
s_mul_i32 s44, s44, 229376
s_sub_u32 s45, s36, 4
s_lshl_b32 s45, s45, 13
s_add_u32 m0, s45, 16384
s_add_u32 s43, s44, 0
buffer_load_dwordx4 v10, s[88:91], s43 offen lds
s_add_u32 m0, s45, 17408
s_add_u32 s43, s44, 0
buffer_load_dwordx4 v11, s[88:91], s43 offen lds
s_add_u32 m0, s45, 18432
s_add_u32 s43, s44, 57344
buffer_load_dwordx4 v10, s[88:91], s43 offen lds
s_add_u32 m0, s45, 19456
s_add_u32 s43, s44, 57344
buffer_load_dwordx4 v11, s[88:91], s43 offen lds
s_add_u32 m0, s45, 20480
s_add_u32 s43, s44, 114688
buffer_load_dwordx4 v10, s[88:91], s43 offen lds
s_add_u32 m0, s45, 21504
s_add_u32 s43, s44, 114688
buffer_load_dwordx4 v11, s[88:91], s43 offen lds
s_add_u32 m0, s45, 22528
s_add_u32 s43, s44, 172032
buffer_load_dwordx4 v10, s[88:91], s43 offen lds
s_add_u32 m0, s45, 23552
s_add_u32 s43, s44, 172032
buffer_load_dwordx4 v11, s[88:91], s43 offen lds
s_add_u32 m0, s45, 65536
s_add_u32 s43, s44, 458752
buffer_load_dwordx4 v10, s[88:91], s43 offen lds
s_add_u32 m0, s45, 66560
s_add_u32 s43, s44, 458752
buffer_load_dwordx4 v11, s[88:91], s43 offen lds
s_add_u32 m0, s45, 67584
s_add_u32 s43, s44, 516096
buffer_load_dwordx4 v10, s[88:91], s43 offen lds
s_add_u32 m0, s45, 68608
s_add_u32 s43, s44, 516096
buffer_load_dwordx4 v11, s[88:91], s43 offen lds
s_add_u32 m0, s45, 69632
s_add_u32 s43, s44, 573440
buffer_load_dwordx4 v10, s[88:91], s43 offen lds
s_add_u32 m0, s45, 70656
s_add_u32 s43, s44, 573440
buffer_load_dwordx4 v11, s[88:91], s43 offen lds
s_add_u32 m0, s45, 71680
s_add_u32 s43, s44, 630784
buffer_load_dwordx4 v10, s[88:91], s43 offen lds
s_add_u32 m0, s45, 72704
s_add_u32 s43, s44, 630784
buffer_load_dwordx4 v11, s[88:91], s43 offen lds
s_waitcnt vmcnt(32)
s_barrier
s_mov_b32 m0, 51200
s_nop 0
buffer_load_dwordx4 v16, s[8:11], s37 offen sc1 lds
s_mov_b32 m0, 54272
s_nop 0
buffer_load_dwordx4 v17, s[8:11], s37 offen sc1 lds
s_mov_b32 m0, 57344
s_nop 0
buffer_load_dwordx4 v18, s[8:11], s37 offen sc1 lds
s_mov_b32 m0, 60416
s_nop 0
buffer_load_dwordx4 v19, s[8:11], s37 offen sc1 lds
s_mov_b32 m0, 63488
s_nop 0
buffer_load_dwordx4 v20, s[8:11], s37 offen sc1 lds
s_mov_b32 m0, 123904
s_nop 0
buffer_load_dwordx4 v21, s[12:15], s38 offen lds
s_mov_b32 m0, 126976
s_nop 0
buffer_load_dwordx4 v22, s[12:15], s38 offen lds
s_mov_b32 m0, 130048
s_nop 0
buffer_load_dwordx4 v23, s[12:15], s38 offen lds
s_add_u32 s37, s37, 16384
s_add_u32 s38, s38, 131072
s_waitcnt vmcnt(32)
s_barrier
s_mov_b32 m0, 100352
s_nop 0
buffer_load_dwordx4 v16, s[8:11], s37 offen sc1 lds
s_mov_b32 m0, 103424
s_nop 0
buffer_load_dwordx4 v17, s[8:11], s37 offen sc1 lds
s_mov_b32 m0, 106496
s_nop 0
buffer_load_dwordx4 v18, s[8:11], s37 offen sc1 lds
s_mov_b32 m0, 109568
s_nop 0
buffer_load_dwordx4 v19, s[8:11], s37 offen sc1 lds
s_mov_b32 m0, 112640
s_nop 0
buffer_load_dwordx4 v20, s[8:11], s37 offen sc1 lds
s_mov_b32 m0, 132096
s_nop 0
buffer_load_dwordx4 v21, s[12:15], s38 offen lds
s_mov_b32 m0, 135168
s_nop 0
buffer_load_dwordx4 v22, s[12:15], s38 offen lds
s_mov_b32 m0, 138240
s_nop 0
buffer_load_dwordx4 v23, s[12:15], s38 offen lds
s_add_u32 s37, s37, 16384
s_add_u32 s38, s38, 131072
s_waitcnt vmcnt(32)
s_barrier
s_mov_b32 m0, 149504
s_nop 0
buffer_load_dwordx4 v16, s[8:11], s37 offen sc1 lds
s_mov_b32 m0, 152576
s_nop 0
buffer_load_dwordx4 v17, s[8:11], s37 offen sc1 lds
s_mov_b32 m0, 155648
s_nop 0
buffer_load_dwordx4 v18, s[8:11], s37 offen sc1 lds
s_mov_b32 m0, 158720
s_nop 0
buffer_load_dwordx4 v19, s[8:11], s37 offen sc1 lds
s_mov_b32 m0, 161792
s_nop 0
buffer_load_dwordx4 v20, s[8:11], s37 offen sc1 lds
s_mov_b32 m0, 140288
s_nop 0
buffer_load_dwordx4 v21, s[12:15], s38 offen lds
s_mov_b32 m0, 143360
s_nop 0
buffer_load_dwordx4 v22, s[12:15], s38 offen lds
s_mov_b32 m0, 146432
s_nop 0
buffer_load_dwordx4 v23, s[12:15], s38 offen lds
s_add_u32 s37, s37, 16384
s_add_u32 s38, s38, 131072
s_waitcnt vmcnt(16)
s_barrier
s_waitcnt vmcnt(8)
s_barrier
s_waitcnt vmcnt(0)
s_barrier
s_barrier
s_barrier
s_branch Lk2end_34
Lpf_36:
s_lshr_b32 s43, s2, 1
s_cmp_ge_u32 s43, 112
s_cbranch_scc1 Lnojob_44
s_and_b32 s44, s2, 1
s_cmp_eq_u32 s44, 0
s_cselect_b32 s52, s72, s74
s_cselect_b32 s53, s73, s75
s_mov_b32 s54, 7340032
s_mov_b32 s55, 0x20000
s_mul_i32 s45, s43, 2341
s_lshr_b32 s45, s45, 16
s_mul_i32 s46, s45, 28
s_sub_u32 s46, s43, s46
v_lshrrev_b32 v4, 4, v1
s_lshl_b32 s43, s45, 8
v_add_u32 v4, s43, v4
v_mul_u32_u24 v4, 7168, v4
v_and_b32 v5, 15, v1
v_lshl_add_u32 v4, v5, 4, v4
s_lshl_b32 s43, s46, 8
v_add_u32 v4, s43, v4
s_lshl_b32 s47, s45, 1
s_add_u32 s47, s47, s44
s_mul_i32 s47, s47, 14336
s_lshl_b32 s46, s46, 9
s_add_u32 s47, s47, s46
v_lshl_add_u32 v5, v5, 5, s47
s_add_u32 s60, s82, 27262976
s_addc_u32 s61, s83, 0
s_mov_b32 s62, 114688
s_mov_b32 s63, 0x20000
v_mov_b32 v16, 0
v_mov_b32 v17, 0
v_mov_b32 v18, 0
v_mov_b32 v19, 0
v_mov_b32 v20, 0
v_mov_b32 v21, 0
v_mov_b32 v22, 0
v_mov_b32 v23, 0
v_lshlrev_b32 v24, 16, v128
v_and_b32 v25, 0xffff0000, v128
v_lshlrev_b32 v26, 16, v129
v_and_b32 v27, 0xffff0000, v129
v_lshlrev_b32 v28, 16, v130
v_and_b32 v29, 0xffff0000, v130
v_lshlrev_b32 v30, 16, v131
v_and_b32 v31, 0xffff0000, v131
s_mov_b32 s43, 802816
buffer_load_dwordx4 v[128:131], v4, s[52:55], s43 offen
v_pk_add_f32 v[16:17], v[16:17], v[24:25]
v_pk_add_f32 v[18:19], v[18:19], v[26:27]
v_pk_add_f32 v[20:21], v[20:21], v[28:29]
v_pk_add_f32 v[22:23], v[22:23], v[30:31]
v_lshlrev_b32 v24, 16, v132
v_and_b32 v25, 0xffff0000, v132
v_lshlrev_b32 v26, 16, v133
v_and_b32 v27, 0xffff0000, v133
v_lshlrev_b32 v28, 16, v134
v_and_b32 v29, 0xffff0000, v134
v_lshlrev_b32 v30, 16, v135
v_and_b32 v31, 0xffff0000, v135
s_mov_b32 s43, 831488
buffer_load_dwordx4 v[132:135], v4, s[52:55], s43 offen
v_pk_add_f32 v[16:17], v[16:17], v[24:25]
v_pk_add_f32 v[18:19], v[18:19], v[26:27]
v_pk_add_f32 v[20:21], v[20:21], v[28:29]
v_pk_add_f32 v[22:23], v[22:23], v[30:31]
v_lshlrev_b32 v24, 16, v136
v_and_b32 v25, 0xffff0000, v136
v_lshlrev_b32 v26, 16, v137
v_and_b32 v27, 0xffff0000, v137
v_lshlrev_b32 v28, 16, v138
v_and_b32 v29, 0xffff0000, v138
v_lshlrev_b32 v30, 16, v139
v_and_b32 v31, 0xffff0000, v139
s_mov_b32 s43, 860160
buffer_load_dwordx4 v[136:139], v4, s[52:55], s43 offen
v_pk_add_f32 v[16:17], v[16:17], v[24:25]
v_pk_add_f32 v[18:19], v[18:19], v[26:27]
v_pk_add_f32 v[20:21], v[20:21], v[28:29]
v_pk_add_f32 v[22:23], v[22:23], v[30:31]
v_lshlrev_b32 v24, 16, v140
v_and_b32 v25, 0xffff0000, v140
v_lshlrev_b32 v26, 16, v141
v_and_b32 v27, 0xffff0000, v141
v_lshlrev_b32 v28, 16, v142
v_and_b32 v29, 0xffff0000, v142
v_lshlrev_b32 v30, 16, v143
v_and_b32 v31, 0xffff0000, v143
s_mov_b32 s43, 888832
buffer_load_dwordx4 v[140:143], v4, s[52:55], s43 offen
v_pk_add_f32 v[16:17], v[16:17], v[24:25]
v_pk_add_f32 v[18:19], v[18:19], v[26:27]
v_pk_add_f32 v[20:21], v[20:21], v[28:29]
v_pk_add_f32 v[22:23], v[22:23], v[30:31]
v_lshlrev_b32 v24, 16, v144
v_and_b32 v25, 0xffff0000, v144
v_lshlrev_b32 v26, 16, v145
v_and_b32 v27, 0xffff0000, v145
v_lshlrev_b32 v28, 16, v146
v_and_b32 v29, 0xffff0000, v146
v_lshlrev_b32 v30, 16, v147
v_and_b32 v31, 0xffff0000, v147
s_mov_b32 s43, 917504
buffer_load_dwordx4 v[144:147], v4, s[52:55], s43 offen
v_pk_add_f32 v[16:17], v[16:17], v[24:25]
v_pk_add_f32 v[18:19], v[18:19], v[26:27]
v_pk_add_f32 v[20:21], v[20:21], v[28:29]
v_pk_add_f32 v[22:23], v[22:23], v[30:31]
v_lshlrev_b32 v24, 16, v148
v_and_b32 v25, 0xffff0000, v148
v_lshlrev_b32 v26, 16, v149
v_and_b32 v27, 0xffff0000, v149
v_lshlrev_b32 v28, 16, v150
v_and_b32 v29, 0xffff0000, v150
v_lshlrev_b32 v30, 16, v151
v_and_b32 v31, 0xffff0000, v151
s_mov_b32 s43, 946176
buffer_load_dwordx4 v[148:151], v4, s[52:55], s43 offen
v_pk_add_f32 v[16:17], v[16:17], v[24:25]
v_pk_add_f32 v[18:19], v[18:19], v[26:27]
v_pk_add_f32 v[20:21], v[20:21], v[28:29]
v_pk_add_f32 v[22:23], v[22:23], v[30:31]
v_lshlrev_b32 v24, 16, v152
v_and_b32 v25, 0xffff0000, v152
v_lshlrev_b32 v26, 16, v153
v_and_b32 v27, 0xffff0000, v153
v_lshlrev_b32 v28, 16, v154
v_and_b32 v29, 0xffff0000, v154
v_lshlrev_b32 v30, 16, v155
v_and_b32 v31, 0xffff0000, v155
s_mov_b32 s43, 974848
buffer_load_dwordx4 v[152:155], v4, s[52:55], s43 offen
v_pk_add_f32 v[16:17], v[16:17], v[24:25]
v_pk_add_f32 v[18:19], v[18:19], v[26:27]
v_pk_add_f32 v[20:21], v[20:21], v[28:29]
v_pk_add_f32 v[22:23], v[22:23], v[30:31]
v_lshlrev_b32 v24, 16, v156
v_and_b32 v25, 0xffff0000, v156
v_lshlrev_b32 v26, 16, v157
v_and_b32 v27, 0xffff0000, v157
v_lshlrev_b32 v28, 16, v158
v_and_b32 v29, 0xffff0000, v158
v_lshlrev_b32 v30, 16, v159
v_and_b32 v31, 0xffff0000, v159
s_mov_b32 s43, 1003520
buffer_load_dwordx4 v[156:159], v4, s[52:55], s43 offen
v_pk_add_f32 v[16:17], v[16:17], v[24:25]
v_pk_add_f32 v[18:19], v[18:19], v[26:27]
v_pk_add_f32 v[20:21], v[20:21], v[28:29]
v_pk_add_f32 v[22:23], v[22:23], v[30:31]
v_lshlrev_b32 v24, 16, v160
v_and_b32 v25, 0xffff0000, v160
v_lshlrev_b32 v26, 16, v161
v_and_b32 v27, 0xffff0000, v161
v_lshlrev_b32 v28, 16, v162
v_and_b32 v29, 0xffff0000, v162
v_lshlrev_b32 v30, 16, v163
v_and_b32 v31, 0xffff0000, v163
s_mov_b32 s43, 1032192
buffer_load_dwordx4 v[160:163], v4, s[52:55], s43 offen
v_pk_add_f32 v[16:17], v[16:17], v[24:25]
v_pk_add_f32 v[18:19], v[18:19], v[26:27]
v_pk_add_f32 v[20:21], v[20:21], v[28:29]
v_pk_add_f32 v[22:23], v[22:23], v[30:31]
v_lshlrev_b32 v24, 16, v164
v_and_b32 v25, 0xffff0000, v164
v_lshlrev_b32 v26, 16, v165
v_and_b32 v27, 0xffff0000, v165
v_lshlrev_b32 v28, 16, v166
v_and_b32 v29, 0xffff0000, v166
v_lshlrev_b32 v30, 16, v167
v_and_b32 v31, 0xffff0000, v167
s_mov_b32 s43, 1060864
buffer_load_dwordx4 v[164:167], v4, s[52:55], s43 offen
v_pk_add_f32 v[16:17], v[16:17], v[24:25]
v_pk_add_f32 v[18:19], v[18:19], v[26:27]
v_pk_add_f32 v[20:21], v[20:21], v[28:29]
v_pk_add_f32 v[22:23], v[22:23], v[30:31]
v_lshlrev_b32 v24, 16, v168
v_and_b32 v25, 0xffff0000, v168
v_lshlrev_b32 v26, 16, v169
v_and_b32 v27, 0xffff0000, v169
v_lshlrev_b32 v28, 16, v170
v_and_b32 v29, 0xffff0000, v170
v_lshlrev_b32 v30, 16, v171
v_and_b32 v31, 0xffff0000, v171
s_mov_b32 s43, 1089536
buffer_load_dwordx4 v[168:171], v4, s[52:55], s43 offen
v_pk_add_f32 v[16:17], v[16:17], v[24:25]
v_pk_add_f32 v[18:19], v[18:19], v[26:27]
v_pk_add_f32 v[20:21], v[20:21], v[28:29]
v_pk_add_f32 v[22:23], v[22:23], v[30:31]
v_lshlrev_b32 v24, 16, v172
v_and_b32 v25, 0xffff0000, v172
v_lshlrev_b32 v26, 16, v173
v_and_b32 v27, 0xffff0000, v173
v_lshlrev_b32 v28, 16, v174
v_and_b32 v29, 0xffff0000, v174
v_lshlrev_b32 v30, 16, v175
v_and_b32 v31, 0xffff0000, v175
s_mov_b32 s43, 1118208
buffer_load_dwordx4 v[172:175], v4, s[52:55], s43 offen
v_pk_add_f32 v[16:17], v[16:17], v[24:25]
v_pk_add_f32 v[18:19], v[18:19], v[26:27]
v_pk_add_f32 v[20:21], v[20:21], v[28:29]
v_pk_add_f32 v[22:23], v[22:23], v[30:31]
v_lshlrev_b32 v24, 16, v176
v_and_b32 v25, 0xffff0000, v176
v_lshlrev_b32 v26, 16, v177
v_and_b32 v27, 0xffff0000, v177
v_lshlrev_b32 v28, 16, v178
v_and_b32 v29, 0xffff0000, v178
v_lshlrev_b32 v30, 16, v179
v_and_b32 v31, 0xffff0000, v179
s_mov_b32 s43, 1146880
buffer_load_dwordx4 v[176:179], v4, s[52:55], s43 offen
v_pk_add_f32 v[16:17], v[16:17], v[24:25]
v_pk_add_f32 v[18:19], v[18:19], v[26:27]
v_pk_add_f32 v[20:21], v[20:21], v[28:29]
v_pk_add_f32 v[22:23], v[22:23], v[30:31]
v_lshlrev_b32 v24, 16, v180
v_and_b32 v25, 0xffff0000, v180
v_lshlrev_b32 v26, 16, v181
v_and_b32 v27, 0xffff0000, v181
v_lshlrev_b32 v28, 16, v182
v_and_b32 v29, 0xffff0000, v182
v_lshlrev_b32 v30, 16, v183
v_and_b32 v31, 0xffff0000, v183
s_mov_b32 s43, 1175552
buffer_load_dwordx4 v[180:183], v4, s[52:55], s43 offen
v_pk_add_f32 v[16:17], v[16:17], v[24:25]
v_pk_add_f32 v[18:19], v[18:19], v[26:27]
v_pk_add_f32 v[20:21], v[20:21], v[28:29]
v_pk_add_f32 v[22:23], v[22:23], v[30:31]
v_lshlrev_b32 v24, 16, v184
v_and_b32 v25, 0xffff0000, v184
v_lshlrev_b32 v26, 16, v185
v_and_b32 v27, 0xffff0000, v185
v_lshlrev_b32 v28, 16, v186
v_and_b32 v29, 0xffff0000, v186
v_lshlrev_b32 v30, 16, v187
v_and_b32 v31, 0xffff0000, v187
s_mov_b32 s43, 1204224
buffer_load_dwordx4 v[184:187], v4, s[52:55], s43 offen
v_pk_add_f32 v[16:17], v[16:17], v[24:25]
v_pk_add_f32 v[18:19], v[18:19], v[26:27]
v_pk_add_f32 v[20:21], v[20:21], v[28:29]
v_pk_add_f32 v[22:23], v[22:23], v[30:31]
v_lshlrev_b32 v24, 16, v188
v_and_b32 v25, 0xffff0000, v188
v_lshlrev_b32 v26, 16, v189
v_and_b32 v27, 0xffff0000, v189
v_lshlrev_b32 v28, 16, v190
v_and_b32 v29, 0xffff0000, v190
v_lshlrev_b32 v30, 16, v191
v_and_b32 v31, 0xffff0000, v191
s_mov_b32 s43, 1232896
buffer_load_dwordx4 v[188:191], v4, s[52:55], s43 offen
v_pk_add_f32 v[16:17], v[16:17], v[24:25]
v_pk_add_f32 v[18:19], v[18:19], v[26:27]
v_pk_add_f32 v[20:21], v[20:21], v[28:29]
v_pk_add_f32 v[22:23], v[22:23], v[30:31]
v_lshlrev_b32 v24, 16, v192
v_and_b32 v25, 0xffff0000, v192
v_lshlrev_b32 v26, 16, v193
v_and_b32 v27, 0xffff0000, v193
v_lshlrev_b32 v28, 16, v194
v_and_b32 v29, 0xffff0000, v194
v_lshlrev_b32 v30, 16, v195
v_and_b32 v31, 0xffff0000, v195
s_mov_b32 s43, 1261568
buffer_load_dwordx4 v[192:195], v4, s[52:55], s43 offen
v_pk_add_f32 v[16:17], v[16:17], v[24:25]
v_pk_add_f32 v[18:19], v[18:19], v[26:27]
v_pk_add_f32 v[20:21], v[20:21], v[28:29]
v_pk_add_f32 v[22:23], v[22:23], v[30:31]
v_lshlrev_b32 v24, 16, v196
v_and_b32 v25, 0xffff0000, v196
v_lshlrev_b32 v26, 16, v197
v_and_b32 v27, 0xffff0000, v197
v_lshlrev_b32 v28, 16, v198
v_and_b32 v29, 0xffff0000, v198
v_lshlrev_b32 v30, 16, v199
v_and_b32 v31, 0xffff0000, v199
s_mov_b32 s43, 1290240
buffer_load_dwordx4 v[196:199], v4, s[52:55], s43 offen
v_pk_add_f32 v[16:17], v[16:17], v[24:25]
v_pk_add_f32 v[18:19], v[18:19], v[26:27]
v_pk_add_f32 v[20:21], v[20:21], v[28:29]
v_pk_add_f32 v[22:23], v[22:23], v[30:31]
v_lshlrev_b32 v24, 16, v200
v_and_b32 v25, 0xffff0000, v200
v_lshlrev_b32 v26, 16, v201
v_and_b32 v27, 0xffff0000, v201
v_lshlrev_b32 v28, 16, v202
v_and_b32 v29, 0xffff0000, v202
v_lshlrev_b32 v30, 16, v203
v_and_b32 v31, 0xffff0000, v203
s_mov_b32 s43, 1318912
buffer_load_dwordx4 v[200:203], v4, s[52:55], s43 offen
v_pk_add_f32 v[16:17], v[16:17], v[24:25]
v_pk_add_f32 v[18:19], v[18:19], v[26:27]
v_pk_add_f32 v[20:21], v[20:21], v[28:29]
v_pk_add_f32 v[22:23], v[22:23], v[30:31]
v_lshlrev_b32 v24, 16, v204
v_and_b32 v25, 0xffff0000, v204
v_lshlrev_b32 v26, 16, v205
v_and_b32 v27, 0xffff0000, v205
v_lshlrev_b32 v28, 16, v206
v_and_b32 v29, 0xffff0000, v206
v_lshlrev_b32 v30, 16, v207
v_and_b32 v31, 0xffff0000, v207
s_mov_b32 s43, 1347584
buffer_load_dwordx4 v[204:207], v4, s[52:55], s43 offen
v_pk_add_f32 v[16:17], v[16:17], v[24:25]
v_pk_add_f32 v[18:19], v[18:19], v[26:27]
v_pk_add_f32 v[20:21], v[20:21], v[28:29]
v_pk_add_f32 v[22:23], v[22:23], v[30:31]
v_lshlrev_b32 v24, 16, v208
v_and_b32 v25, 0xffff0000, v208
v_lshlrev_b32 v26, 16, v209
v_and_b32 v27, 0xffff0000, v209
v_lshlrev_b32 v28, 16, v210
v_and_b32 v29, 0xffff0000, v210
v_lshlrev_b32 v30, 16, v211
v_and_b32 v31, 0xffff0000, v211
s_mov_b32 s43, 1376256
buffer_load_dwordx4 v[208:211], v4, s[52:55], s43 offen
v_pk_add_f32 v[16:17], v[16:17], v[24:25]
v_pk_add_f32 v[18:19], v[18:19], v[26:27]
v_pk_add_f32 v[20:21], v[20:21], v[28:29]
v_pk_add_f32 v[22:23], v[22:23], v[30:31]
v_lshlrev_b32 v24, 16, v212
v_and_b32 v25, 0xffff0000, v212
v_lshlrev_b32 v26, 16, v213
v_and_b32 v27, 0xffff0000, v213
v_lshlrev_b32 v28, 16, v214
v_and_b32 v29, 0xffff0000, v214
v_lshlrev_b32 v30, 16, v215
v_and_b32 v31, 0xffff0000, v215
s_mov_b32 s43, 1404928
buffer_load_dwordx4 v[212:215], v4, s[52:55], s43 offen
v_pk_add_f32 v[16:17], v[16:17], v[24:25]
v_pk_add_f32 v[18:19], v[18:19], v[26:27]
v_pk_add_f32 v[20:21], v[20:21], v[28:29]
v_pk_add_f32 v[22:23], v[22:23], v[30:31]
v_lshlrev_b32 v24, 16, v216
v_and_b32 v25, 0xffff0000, v216
v_lshlrev_b32 v26, 16, v217
v_and_b32 v27, 0xffff0000, v217
v_lshlrev_b32 v28, 16, v218
v_and_b32 v29, 0xffff0000, v218
v_lshlrev_b32 v30, 16, v219
v_and_b32 v31, 0xffff0000, v219
s_mov_b32 s43, 1433600
buffer_load_dwordx4 v[216:219], v4, s[52:55], s43 offen
v_pk_add_f32 v[16:17], v[16:17], v[24:25]
v_pk_add_f32 v[18:19], v[18:19], v[26:27]
v_pk_add_f32 v[20:21], v[20:21], v[28:29]
v_pk_add_f32 v[22:23], v[22:23], v[30:31]
v_lshlrev_b32 v24, 16, v220
v_and_b32 v25, 0xffff0000, v220
v_lshlrev_b32 v26, 16, v221
v_and_b32 v27, 0xffff0000, v221
v_lshlrev_b32 v28, 16, v222
v_and_b32 v29, 0xffff0000, v222
v_lshlrev_b32 v30, 16, v223
v_and_b32 v31, 0xffff0000, v223
s_mov_b32 s43, 1462272
buffer_load_dwordx4 v[220:223], v4, s[52:55], s43 offen
v_pk_add_f32 v[16:17], v[16:17], v[24:25]
v_pk_add_f32 v[18:19], v[18:19], v[26:27]
v_pk_add_f32 v[20:21], v[20:21], v[28:29]
v_pk_add_f32 v[22:23], v[22:23], v[30:31]
v_lshlrev_b32 v24, 16, v224
v_and_b32 v25, 0xffff0000, v224
v_lshlrev_b32 v26, 16, v225
v_and_b32 v27, 0xffff0000, v225
v_lshlrev_b32 v28, 16, v226
v_and_b32 v29, 0xffff0000, v226
v_lshlrev_b32 v30, 16, v227
v_and_b32 v31, 0xffff0000, v227
s_mov_b32 s43, 1490944
buffer_load_dwordx4 v[224:227], v4, s[52:55], s43 offen
v_pk_add_f32 v[16:17], v[16:17], v[24:25]
v_pk_add_f32 v[18:19], v[18:19], v[26:27]
v_pk_add_f32 v[20:21], v[20:21], v[28:29]
v_pk_add_f32 v[22:23], v[22:23], v[30:31]
v_lshlrev_b32 v24, 16, v228
v_and_b32 v25, 0xffff0000, v228
v_lshlrev_b32 v26, 16, v229
v_and_b32 v27, 0xffff0000, v229
v_lshlrev_b32 v28, 16, v230
v_and_b32 v29, 0xffff0000, v230
v_lshlrev_b32 v30, 16, v231
v_and_b32 v31, 0xffff0000, v231
s_mov_b32 s43, 1519616
buffer_load_dwordx4 v[228:231], v4, s[52:55], s43 offen
v_pk_add_f32 v[16:17], v[16:17], v[24:25]
v_pk_add_f32 v[18:19], v[18:19], v[26:27]
v_pk_add_f32 v[20:21], v[20:21], v[28:29]
v_pk_add_f32 v[22:23], v[22:23], v[30:31]
v_lshlrev_b32 v24, 16, v232
v_and_b32 v25, 0xffff0000, v232
v_lshlrev_b32 v26, 16, v233
v_and_b32 v27, 0xffff0000, v233
v_lshlrev_b32 v28, 16, v234
v_and_b32 v29, 0xffff0000, v234
v_lshlrev_b32 v30, 16, v235
v_and_b32 v31, 0xffff0000, v235
s_mov_b32 s43, 1548288
buffer_load_dwordx4 v[232:235], v4, s[52:55], s43 offen
v_pk_add_f32 v[16:17], v[16:17], v[24:25]
v_pk_add_f32 v[18:19], v[18:19], v[26:27]
v_pk_add_f32 v[20:21], v[20:21], v[28:29]
v_pk_add_f32 v[22:23], v[22:23], v[30:31]
v_lshlrev_b32 v24, 16, v236
v_and_b32 v25, 0xffff0000, v236
v_lshlrev_b32 v26, 16, v237
v_and_b32 v27, 0xffff0000, v237
v_lshlrev_b32 v28, 16, v238
v_and_b32 v29, 0xffff0000, v238
v_lshlrev_b32 v30, 16, v239
v_and_b32 v31, 0xffff0000, v239
s_mov_b32 s43, 1576960
buffer_load_dwordx4 v[236:239], v4, s[52:55], s43 offen
v_pk_add_f32 v[16:17], v[16:17], v[24:25]
v_pk_add_f32 v[18:19], v[18:19], v[26:27]
v_pk_add_f32 v[20:21], v[20:21], v[28:29]
v_pk_add_f32 v[22:23], v[22:23], v[30:31]
s_barrier
s_barrier
s_barrier
s_barrier
s_waitcnt vmcnt(27)
v_lshlrev_b32 v24, 16, v128
v_and_b32 v25, 0xffff0000, v128
v_lshlrev_b32 v26, 16, v129
v_and_b32 v27, 0xffff0000, v129
v_lshlrev_b32 v28, 16, v130
v_and_b32 v29, 0xffff0000, v130
v_lshlrev_b32 v30, 16, v131
v_and_b32 v31, 0xffff0000, v131
s_mov_b32 s43, 1605632
buffer_load_dwordx4 v[128:131], v4, s[52:55], s43 offen
v_pk_add_f32 v[16:17], v[16:17], v[24:25]
v_pk_add_f32 v[18:19], v[18:19], v[26:27]
v_pk_add_f32 v[20:21], v[20:21], v[28:29]
v_pk_add_f32 v[22:23], v[22:23], v[30:31]
s_waitcnt vmcnt(27)
v_lshlrev_b32 v24, 16, v132
v_and_b32 v25, 0xffff0000, v132
v_lshlrev_b32 v26, 16, v133
v_and_b32 v27, 0xffff0000, v133
v_lshlrev_b32 v28, 16, v134
v_and_b32 v29, 0xffff0000, v134
v_lshlrev_b32 v30, 16, v135
v_and_b32 v31, 0xffff0000, v135
s_mov_b32 s43, 1634304
buffer_load_dwordx4 v[132:135], v4, s[52:55], s43 offen
v_pk_add_f32 v[16:17], v[16:17], v[24:25]
v_pk_add_f32 v[18:19], v[18:19], v[26:27]
v_pk_add_f32 v[20:21], v[20:21], v[28:29]
v_pk_add_f32 v[22:23], v[22:23], v[30:31]
s_waitcnt vmcnt(27)
v_lshlrev_b32 v24, 16, v136
v_and_b32 v25, 0xffff0000, v136
v_lshlrev_b32 v26, 16, v137
v_and_b32 v27, 0xffff0000, v137
v_lshlrev_b32 v28, 16, v138
v_and_b32 v29, 0xffff0000, v138
v_lshlrev_b32 v30, 16, v139
v_and_b32 v31, 0xffff0000, v139
s_mov_b32 s43, 1662976
buffer_load_dwordx4 v[136:139], v4, s[52:55], s43 offen
v_pk_add_f32 v[16:17], v[16:17], v[24:25]
v_pk_add_f32 v[18:19], v[18:19], v[26:27]
v_pk_add_f32 v[20:21], v[20:21], v[28:29]
v_pk_add_f32 v[22:23], v[22:23], v[30:31]
s_waitcnt vmcnt(27)
v_lshlrev_b32 v24, 16, v140
v_and_b32 v25, 0xffff0000, v140
v_lshlrev_b32 v26, 16, v141
v_and_b32 v27, 0xffff0000, v141
v_lshlrev_b32 v28, 16, v142
v_and_b32 v29, 0xffff0000, v142
v_lshlrev_b32 v30, 16, v143
v_and_b32 v31, 0xffff0000, v143
s_mov_b32 s43, 1691648
buffer_load_dwordx4 v[140:143], v4, s[52:55], s43 offen
v_pk_add_f32 v[16:17], v[16:17], v[24:25]
v_pk_add_f32 v[18:19], v[18:19], v[26:27]
v_pk_add_f32 v[20:21], v[20:21], v[28:29]
v_pk_add_f32 v[22:23], v[22:23], v[30:31]
s_waitcnt vmcnt(27)
v_lshlrev_b32 v24, 16, v144
v_and_b32 v25, 0xffff0000, v144
v_lshlrev_b32 v26, 16, v145
v_and_b32 v27, 0xffff0000, v145
v_lshlrev_b32 v28, 16, v146
v_and_b32 v29, 0xffff0000, v146
v_lshlrev_b32 v30, 16, v147
v_and_b32 v31, 0xffff0000, v147
s_mov_b32 s43, 1720320
buffer_load_dwordx4 v[144:147], v4, s[52:55], s43 offen
v_pk_add_f32 v[16:17], v[16:17], v[24:25]
v_pk_add_f32 v[18:19], v[18:19], v[26:27]
v_pk_add_f32 v[20:21], v[20:21], v[28:29]
v_pk_add_f32 v[22:23], v[22:23], v[30:31]
s_waitcnt vmcnt(27)
v_lshlrev_b32 v24, 16, v148
v_and_b32 v25, 0xffff0000, v148
v_lshlrev_b32 v26, 16, v149
v_and_b32 v27, 0xffff0000, v149
v_lshlrev_b32 v28, 16, v150
v_and_b32 v29, 0xffff0000, v150
v_lshlrev_b32 v30, 16, v151
v_and_b32 v31, 0xffff0000, v151
s_mov_b32 s43, 1748992
buffer_load_dwordx4 v[148:151], v4, s[52:55], s43 offen
v_pk_add_f32 v[16:17], v[16:17], v[24:25]
v_pk_add_f32 v[18:19], v[18:19], v[26:27]
v_pk_add_f32 v[20:21], v[20:21], v[28:29]
v_pk_add_f32 v[22:23], v[22:23], v[30:31]
s_waitcnt vmcnt(27)
v_lshlrev_b32 v24, 16, v152
v_and_b32 v25, 0xffff0000, v152
v_lshlrev_b32 v26, 16, v153
v_and_b32 v27, 0xffff0000, v153
v_lshlrev_b32 v28, 16, v154
v_and_b32 v29, 0xffff0000, v154
v_lshlrev_b32 v30, 16, v155
v_and_b32 v31, 0xffff0000, v155
s_mov_b32 s43, 1777664
buffer_load_dwordx4 v[152:155], v4, s[52:55], s43 offen
v_pk_add_f32 v[16:17], v[16:17], v[24:25]
v_pk_add_f32 v[18:19], v[18:19], v[26:27]
v_pk_add_f32 v[20:21], v[20:21], v[28:29]
v_pk_add_f32 v[22:23], v[22:23], v[30:31]
s_barrier
s_waitcnt vmcnt(27)
v_lshlrev_b32 v24, 16, v156
v_and_b32 v25, 0xffff0000, v156
v_lshlrev_b32 v26, 16, v157
v_and_b32 v27, 0xffff0000, v157
v_lshlrev_b32 v28, 16, v158
v_and_b32 v29, 0xffff0000, v158
v_lshlrev_b32 v30, 16, v159
v_and_b32 v31, 0xffff0000, v159
s_mov_b32 s43, 1806336
buffer_load_dwordx4 v[156:159], v4, s[52:55], s43 offen
v_pk_add_f32 v[16:17], v[16:17], v[24:25]
v_pk_add_f32 v[18:19], v[18:19], v[26:27]
v_pk_add_f32 v[20:21], v[20:21], v[28:29]
v_pk_add_f32 v[22:23], v[22:23], v[30:31]
s_waitcnt vmcnt(27)
v_lshlrev_b32 v24, 16, v160
v_and_b32 v25, 0xffff0000, v160
v_lshlrev_b32 v26, 16, v161
v_and_b32 v27, 0xffff0000, v161
v_lshlrev_b32 v28, 16, v162
v_and_b32 v29, 0xffff0000, v162
v_lshlrev_b32 v30, 16, v163
v_and_b32 v31, 0xffff0000, v163
v_pk_add_f32 v[16:17], v[16:17], v[24:25]
v_pk_add_f32 v[18:19], v[18:19], v[26:27]
v_pk_add_f32 v[20:21], v[20:21], v[28:29]
v_pk_add_f32 v[22:23], v[22:23], v[30:31]
s_waitcnt vmcnt(26)
v_lshlrev_b32 v24, 16, v164
v_and_b32 v25, 0xffff0000, v164
v_lshlrev_b32 v26, 16, v165
v_and_b32 v27, 0xffff0000, v165
v_lshlrev_b32 v28, 16, v166
v_and_b32 v29, 0xffff0000, v166
v_lshlrev_b32 v30, 16, v167
v_and_b32 v31, 0xffff0000, v167
v_pk_add_f32 v[16:17], v[16:17], v[24:25]
v_pk_add_f32 v[18:19], v[18:19], v[26:27]
v_pk_add_f32 v[20:21], v[20:21], v[28:29]
v_pk_add_f32 v[22:23], v[22:23], v[30:31]
s_waitcnt vmcnt(25)
v_lshlrev_b32 v24, 16, v168
v_and_b32 v25, 0xffff0000, v168
v_lshlrev_b32 v26, 16, v169
v_and_b32 v27, 0xffff0000, v169
v_lshlrev_b32 v28, 16, v170
v_and_b32 v29, 0xffff0000, v170
v_lshlrev_b32 v30, 16, v171
v_and_b32 v31, 0xffff0000, v171
v_pk_add_f32 v[16:17], v[16:17], v[24:25]
v_pk_add_f32 v[18:19], v[18:19], v[26:27]
v_pk_add_f32 v[20:21], v[20:21], v[28:29]
v_pk_add_f32 v[22:23], v[22:23], v[30:31]
s_waitcnt vmcnt(24)
v_lshlrev_b32 v24, 16, v172
v_and_b32 v25, 0xffff0000, v172
v_lshlrev_b32 v26, 16, v173
v_and_b32 v27, 0xffff0000, v173
v_lshlrev_b32 v28, 16, v174
v_and_b32 v29, 0xffff0000, v174
v_lshlrev_b32 v30, 16, v175
v_and_b32 v31, 0xffff0000, v175
v_pk_add_f32 v[16:17], v[16:17], v[24:25]
v_pk_add_f32 v[18:19], v[18:19], v[26:27]
v_pk_add_f32 v[20:21], v[20:21], v[28:29]
v_pk_add_f32 v[22:23], v[22:23], v[30:31]
s_waitcnt vmcnt(23)
v_lshlrev_b32 v24, 16, v176
v_and_b32 v25, 0xffff0000, v176
v_lshlrev_b32 v26, 16, v177
v_and_b32 v27, 0xffff0000, v177
v_lshlrev_b32 v28, 16, v178
v_and_b32 v29, 0xffff0000, v178
v_lshlrev_b32 v30, 16, v179
v_and_b32 v31, 0xffff0000, v179
v_pk_add_f32 v[16:17], v[16:17], v[24:25]
v_pk_add_f32 v[18:19], v[18:19], v[26:27]
v_pk_add_f32 v[20:21], v[20:21], v[28:29]
v_pk_add_f32 v[22:23], v[22:23], v[30:31]
s_waitcnt vmcnt(22)
v_lshlrev_b32 v24, 16, v180
v_and_b32 v25, 0xffff0000, v180
v_lshlrev_b32 v26, 16, v181
v_and_b32 v27, 0xffff0000, v181
v_lshlrev_b32 v28, 16, v182
v_and_b32 v29, 0xffff0000, v182
v_lshlrev_b32 v30, 16, v183
v_and_b32 v31, 0xffff0000, v183
v_pk_add_f32 v[16:17], v[16:17], v[24:25]
v_pk_add_f32 v[18:19], v[18:19], v[26:27]
v_pk_add_f32 v[20:21], v[20:21], v[28:29]
v_pk_add_f32 v[22:23], v[22:23], v[30:31]
s_barrier
s_waitcnt vmcnt(21)
v_lshlrev_b32 v24, 16, v184
v_and_b32 v25, 0xffff0000, v184
v_lshlrev_b32 v26, 16, v185
v_and_b32 v27, 0xffff0000, v185
v_lshlrev_b32 v28, 16, v186
v_and_b32 v29, 0xffff0000, v186
v_lshlrev_b32 v30, 16, v187
v_and_b32 v31, 0xffff0000, v187
v_pk_add_f32 v[16:17], v[16:17], v[24:25]
v_pk_add_f32 v[18:19], v[18:19], v[26:27]
v_pk_add_f32 v[20:21], v[20:21], v[28:29]
v_pk_add_f32 v[22:23], v[22:23], v[30:31]
s_waitcnt vmcnt(20)
v_lshlrev_b32 v24, 16, v188
v_and_b32 v25, 0xffff0000, v188
v_lshlrev_b32 v26, 16, v189
v_and_b32 v27, 0xffff0000, v189
v_lshlrev_b32 v28, 16, v190
v_and_b32 v29, 0xffff0000, v190
v_lshlrev_b32 v30, 16, v191
v_and_b32 v31, 0xffff0000, v191
v_pk_add_f32 v[16:17], v[16:17], v[24:25]
v_pk_add_f32 v[18:19], v[18:19], v[26:27]
v_pk_add_f32 v[20:21], v[20:21], v[28:29]
v_pk_add_f32 v[22:23], v[22:23], v[30:31]
s_waitcnt vmcnt(19)
v_lshlrev_b32 v24, 16, v192
v_and_b32 v25, 0xffff0000, v192
v_lshlrev_b32 v26, 16, v193
v_and_b32 v27, 0xffff0000, v193
v_lshlrev_b32 v28, 16, v194
v_and_b32 v29, 0xffff0000, v194
v_lshlrev_b32 v30, 16, v195
v_and_b32 v31, 0xffff0000, v195
v_pk_add_f32 v[16:17], v[16:17], v[24:25]
v_pk_add_f32 v[18:19], v[18:19], v[26:27]
v_pk_add_f32 v[20:21], v[20:21], v[28:29]
v_pk_add_f32 v[22:23], v[22:23], v[30:31]
s_waitcnt vmcnt(18)
v_lshlrev_b32 v24, 16, v196
v_and_b32 v25, 0xffff0000, v196
v_lshlrev_b32 v26, 16, v197
v_and_b32 v27, 0xffff0000, v197
v_lshlrev_b32 v28, 16, v198
v_and_b32 v29, 0xffff0000, v198
v_lshlrev_b32 v30, 16, v199
v_and_b32 v31, 0xffff0000, v199
v_pk_add_f32 v[16:17], v[16:17], v[24:25]
v_pk_add_f32 v[18:19], v[18:19], v[26:27]
v_pk_add_f32 v[20:21], v[20:21], v[28:29]
v_pk_add_f32 v[22:23], v[22:23], v[30:31]
s_waitcnt vmcnt(17)
v_lshlrev_b32 v24, 16, v200
v_and_b32 v25, 0xffff0000, v200
v_lshlrev_b32 v26, 16, v201
v_and_b32 v27, 0xffff0000, v201
v_lshlrev_b32 v28, 16, v202
v_and_b32 v29, 0xffff0000, v202
v_lshlrev_b32 v30, 16, v203
v_and_b32 v31, 0xffff0000, v203
v_pk_add_f32 v[16:17], v[16:17], v[24:25]
v_pk_add_f32 v[18:19], v[18:19], v[26:27]
v_pk_add_f32 v[20:21], v[20:21], v[28:29]
v_pk_add_f32 v[22:23], v[22:23], v[30:31]
s_waitcnt vmcnt(16)
v_lshlrev_b32 v24, 16, v204
v_and_b32 v25, 0xffff0000, v204
v_lshlrev_b32 v26, 16, v205
v_and_b32 v27, 0xffff0000, v205
v_lshlrev_b32 v28, 16, v206
v_and_b32 v29, 0xffff0000, v206
v_lshlrev_b32 v30, 16, v207
v_and_b32 v31, 0xffff0000, v207
v_pk_add_f32 v[16:17], v[16:17], v[24:25]
v_pk_add_f32 v[18:19], v[18:19], v[26:27]
v_pk_add_f32 v[20:21], v[20:21], v[28:29]
v_pk_add_f32 v[22:23], v[22:23], v[30:31]
s_waitcnt vmcnt(15)
v_lshlrev_b32 v24, 16, v208
v_and_b32 v25, 0xffff0000, v208
v_lshlrev_b32 v26, 16, v209
v_and_b32 v27, 0xffff0000, v209
v_lshlrev_b32 v28, 16, v210
v_and_b32 v29, 0xffff0000, v210
v_lshlrev_b32 v30, 16, v211
v_and_b32 v31, 0xffff0000, v211
v_pk_add_f32 v[16:17], v[16:17], v[24:25]
v_pk_add_f32 v[18:19], v[18:19], v[26:27]
v_pk_add_f32 v[20:21], v[20:21], v[28:29]
v_pk_add_f32 v[22:23], v[22:23], v[30:31]
s_barrier
s_waitcnt vmcnt(14)
v_lshlrev_b32 v24, 16, v212
v_and_b32 v25, 0xffff0000, v212
v_lshlrev_b32 v26, 16, v213
v_and_b32 v27, 0xffff0000, v213
v_lshlrev_b32 v28, 16, v214
v_and_b32 v29, 0xffff0000, v214
v_lshlrev_b32 v30, 16, v215
v_and_b32 v31, 0xffff0000, v215
v_pk_add_f32 v[16:17], v[16:17], v[24:25]
v_pk_add_f32 v[18:19], v[18:19], v[26:27]
v_pk_add_f32 v[20:21], v[20:21], v[28:29]
v_pk_add_f32 v[22:23], v[22:23], v[30:31]
s_waitcnt vmcnt(13)
v_lshlrev_b32 v24, 16, v216
v_and_b32 v25, 0xffff0000, v216
v_lshlrev_b32 v26, 16, v217
v_and_b32 v27, 0xffff0000, v217
v_lshlrev_b32 v28, 16, v218
v_and_b32 v29, 0xffff0000, v218
v_lshlrev_b32 v30, 16, v219
v_and_b32 v31, 0xffff0000, v219
v_pk_add_f32 v[16:17], v[16:17], v[24:25]
v_pk_add_f32 v[18:19], v[18:19], v[26:27]
v_pk_add_f32 v[20:21], v[20:21], v[28:29]
v_pk_add_f32 v[22:23], v[22:23], v[30:31]
s_waitcnt vmcnt(12)
v_lshlrev_b32 v24, 16, v220
v_and_b32 v25, 0xffff0000, v220
v_lshlrev_b32 v26, 16, v221
v_and_b32 v27, 0xffff0000, v221
v_lshlrev_b32 v28, 16, v222
v_and_b32 v29, 0xffff0000, v222
v_lshlrev_b32 v30, 16, v223
v_and_b32 v31, 0xffff0000, v223
v_pk_add_f32 v[16:17], v[16:17], v[24:25]
v_pk_add_f32 v[18:19], v[18:19], v[26:27]
v_pk_add_f32 v[20:21], v[20:21], v[28:29]
v_pk_add_f32 v[22:23], v[22:23], v[30:31]
s_waitcnt vmcnt(11)
v_lshlrev_b32 v24, 16, v224
v_and_b32 v25, 0xffff0000, v224
v_lshlrev_b32 v26, 16, v225
v_and_b32 v27, 0xffff0000, v225
v_lshlrev_b32 v28, 16, v226
v_and_b32 v29, 0xffff0000, v226
v_lshlrev_b32 v30, 16, v227
v_and_b32 v31, 0xffff0000, v227
v_pk_add_f32 v[16:17], v[16:17], v[24:25]
v_pk_add_f32 v[18:19], v[18:19], v[26:27]
v_pk_add_f32 v[20:21], v[20:21], v[28:29]
v_pk_add_f32 v[22:23], v[22:23], v[30:31]
s_waitcnt vmcnt(10)
v_lshlrev_b32 v24, 16, v228
v_and_b32 v25, 0xffff0000, v228
v_lshlrev_b32 v26, 16, v229
v_and_b32 v27, 0xffff0000, v229
v_lshlrev_b32 v28, 16, v230
v_and_b32 v29, 0xffff0000, v230
v_lshlrev_b32 v30, 16, v231
v_and_b32 v31, 0xffff0000, v231
v_pk_add_f32 v[16:17], v[16:17], v[24:25]
v_pk_add_f32 v[18:19], v[18:19], v[26:27]
v_pk_add_f32 v[20:21], v[20:21], v[28:29]
v_pk_add_f32 v[22:23], v[22:23], v[30:31]
s_waitcnt vmcnt(9)
v_lshlrev_b32 v24, 16, v232
v_and_b32 v25, 0xffff0000, v232
v_lshlrev_b32 v26, 16, v233
v_and_b32 v27, 0xffff0000, v233
v_lshlrev_b32 v28, 16, v234
v_and_b32 v29, 0xffff0000, v234
v_lshlrev_b32 v30, 16, v235
v_and_b32 v31, 0xffff0000, v235
v_pk_add_f32 v[16:17], v[16:17], v[24:25]
v_pk_add_f32 v[18:19], v[18:19], v[26:27]
v_pk_add_f32 v[20:21], v[20:21], v[28:29]
v_pk_add_f32 v[22:23], v[22:23], v[30:31]
s_waitcnt vmcnt(8)
v_lshlrev_b32 v24, 16, v236
v_and_b32 v25, 0xffff0000, v236
v_lshlrev_b32 v26, 16, v237
v_and_b32 v27, 0xffff0000, v237
v_lshlrev_b32 v28, 16, v238
v_and_b32 v29, 0xffff0000, v238
v_lshlrev_b32 v30, 16, v239
v_and_b32 v31, 0xffff0000, v239
v_pk_add_f32 v[16:17], v[16:17], v[24:25]
v_pk_add_f32 v[18:19], v[18:19], v[26:27]
v_pk_add_f32 v[20:21], v[20:21], v[28:29]
v_pk_add_f32 v[22:23], v[22:23], v[30:31]
s_barrier
s_barrier
s_mov_b32 s28, s76
s_mov_b32 s29, s77
s_mov_b32 s30, 7340032
s_mov_b32 s31, 0x20000
v_lshlrev_b32 v6, 7, v1
s_mul_i32 s43, s2, 28672
v_add_u32 v6, s43, v6
s_mov_b32 s43, 0
buffer_load_dword v7, v6, s[28:31], s43 offen
s_mov_b32 s43, 8192
buffer_load_dword v7, v6, s[28:31], s43 offen
s_mov_b32 s43, 16384
buffer_load_dword v7, v6, s[28:31], s43 offen
s_mov_b32 s43, 24576
s_mov_b64 exec, 0xffffffff
buffer_load_dword v7, v6, s[28:31], s43 offen
s_mov_b64 exec, -1
s_barrier
s_barrier
s_cmp_lt_u32 s36, 6
s_cselect_b32 s88, s72, s74
s_cselect_b32 s89, s73, s75
s_lshl_b32 s43, s35, 8
s_add_u32 s88, s88, s43
s_addc_u32 s89, s89, 0
s_mov_b32 s90, 7333120
s_mov_b32 s91, 0x20000
v_lshrrev_b32 v12, 4, v1
v_lshlrev_b32 v13, 1, v12
v_and_b32 v10, 15, v1
v_xor_b32 v10, v10, v13
v_lshlrev_b32 v10, 4, v10
v_mul_u32_u24 v12, 7168, v12
v_add_u32 v10, v10, v12
v_xor_b32 v11, 128, v10
v_add_u32 v11, 28672, v11
s_and_b32 s44, s36, 1
s_mul_i32 s44, s44, 229376
s_sub_u32 s45, s36, 4
s_lshl_b32 s45, s45, 13
s_add_u32 m0, s45, 16384
s_add_u32 s43, s44, 0
buffer_load_dwordx4 v10, s[88:91], s43 offen lds
s_add_u32 m0, s45, 17408
s_add_u32 s43, s44, 0
buffer_load_dwordx4 v11, s[88:91], s43 offen lds
s_add_u32 m0, s45, 18432
s_add_u32 s43, s44, 57344
buffer_load_dwordx4 v10, s[88:91], s43 offen lds
s_add_u32 m0, s45, 19456
s_add_u32 s43, s44, 57344
buffer_load_dwordx4 v11, s[88:91], s43 offen lds
s_add_u32 m0, s45, 20480
s_add_u32 s43, s44, 114688
buffer_load_dwordx4 v10, s[88:91], s43 offen lds
s_add_u32 m0, s45, 21504
s_add_u32 s43, s44, 114688
buffer_load_dwordx4 v11, s[88:91], s43 offen lds
s_add_u32 m0, s45, 22528
s_add_u32 s43, s44, 172032
buffer_load_dwordx4 v10, s[88:91], s43 offen lds
s_add_u32 m0, s45, 23552
s_add_u32 s43, s44, 172032
buffer_load_dwordx4 v11, s[88:91], s43 offen lds
s_add_u32 m0, s45, 65536
s_add_u32 s43, s44, 458752
buffer_load_dwordx4 v10, s[88:91], s43 offen lds
s_add_u32 m0, s45, 66560
s_add_u32 s43, s44, 458752
buffer_load_dwordx4 v11, s[88:91], s43 offen lds
s_add_u32 m0, s45, 67584
s_add_u32 s43, s44, 516096
buffer_load_dwordx4 v10, s[88:91], s43 offen lds
s_add_u32 m0, s45, 68608
s_add_u32 s43, s44, 516096
buffer_load_dwordx4 v11, s[88:91], s43 offen lds
s_add_u32 m0, s45, 69632
s_add_u32 s43, s44, 573440
buffer_load_dwordx4 v10, s[88:91], s43 offen lds
s_add_u32 m0, s45, 70656
s_add_u32 s43, s44, 573440
buffer_load_dwordx4 v11, s[88:91], s43 offen lds
s_add_u32 m0, s45, 71680
s_add_u32 s43, s44, 630784
buffer_load_dwordx4 v10, s[88:91], s43 offen lds
s_add_u32 m0, s45, 72704
s_add_u32 s43, s44, 630784
buffer_load_dwordx4 v11, s[88:91], s43 offen lds
s_barrier
s_waitcnt vmcnt(27)
v_lshlrev_b32 v24, 16, v128
v_and_b32 v25, 0xffff0000, v128
v_lshlrev_b32 v26, 16, v129
v_and_b32 v27, 0xffff0000, v129
v_lshlrev_b32 v28, 16, v130
v_and_b32 v29, 0xffff0000, v130
v_lshlrev_b32 v30, 16, v131
v_and_b32 v31, 0xffff0000, v131
v_pk_add_f32 v[16:17], v[16:17], v[24:25]
v_pk_add_f32 v[18:19], v[18:19], v[26:27]
v_pk_add_f32 v[20:21], v[20:21], v[28:29]
v_pk_add_f32 v[22:23], v[22:23], v[30:31]
s_waitcnt vmcnt(26)
v_lshlrev_b32 v24, 16, v132
v_and_b32 v25, 0xffff0000, v132
v_lshlrev_b32 v26, 16, v133
v_and_b32 v27, 0xffff0000, v133
v_lshlrev_b32 v28, 16, v134
v_and_b32 v29, 0xffff0000, v134
v_lshlrev_b32 v30, 16, v135
v_and_b32 v31, 0xffff0000, v135
v_pk_add_f32 v[16:17], v[16:17], v[24:25]
v_pk_add_f32 v[18:19], v[18:19], v[26:27]
v_pk_add_f32 v[20:21], v[20:21], v[28:29]
v_pk_add_f32 v[22:23], v[22:23], v[30:31]
s_waitcnt vmcnt(25)
v_lshlrev_b32 v24, 16, v136
v_and_b32 v25, 0xffff0000, v136
v_lshlrev_b32 v26, 16, v137
v_and_b32 v27, 0xffff0000, v137
v_lshlrev_b32 v28, 16, v138
v_and_b32 v29, 0xffff0000, v138
v_lshlrev_b32 v30, 16, v139
v_and_b32 v31, 0xffff0000, v139
v_pk_add_f32 v[16:17], v[16:17], v[24:25]
v_pk_add_f32 v[18:19], v[18:19], v[26:27]
v_pk_add_f32 v[20:21], v[20:21], v[28:29]
v_pk_add_f32 v[22:23], v[22:23], v[30:31]
s_waitcnt vmcnt(24)
v_lshlrev_b32 v24, 16, v140
v_and_b32 v25, 0xffff0000, v140
v_lshlrev_b32 v26, 16, v141
v_and_b32 v27, 0xffff0000, v141
v_lshlrev_b32 v28, 16, v142
v_and_b32 v29, 0xffff0000, v142
v_lshlrev_b32 v30, 16, v143
v_and_b32 v31, 0xffff0000, v143
v_pk_add_f32 v[16:17], v[16:17], v[24:25]
v_pk_add_f32 v[18:19], v[18:19], v[26:27]
v_pk_add_f32 v[20:21], v[20:21], v[28:29]
v_pk_add_f32 v[22:23], v[22:23], v[30:31]
s_barrier
s_waitcnt vmcnt(23)
v_lshlrev_b32 v24, 16, v144
v_and_b32 v25, 0xffff0000, v144
v_lshlrev_b32 v26, 16, v145
v_and_b32 v27, 0xffff0000, v145
v_lshlrev_b32 v28, 16, v146
v_and_b32 v29, 0xffff0000, v146
v_lshlrev_b32 v30, 16, v147
v_and_b32 v31, 0xffff0000, v147
v_pk_add_f32 v[16:17], v[16:17], v[24:25]
v_pk_add_f32 v[18:19], v[18:19], v[26:27]
v_pk_add_f32 v[20:21], v[20:21], v[28:29]
v_pk_add_f32 v[22:23], v[22:23], v[30:31]
s_waitcnt vmcnt(22)
v_lshlrev_b32 v24, 16, v148
v_and_b32 v25, 0xffff0000, v148
v_lshlrev_b32 v26, 16, v149
v_and_b32 v27, 0xffff0000, v149
v_lshlrev_b32 v28, 16, v150
v_and_b32 v29, 0xffff0000, v150
v_lshlrev_b32 v30, 16, v151
v_and_b32 v31, 0xffff0000, v151
v_pk_add_f32 v[16:17], v[16:17], v[24:25]
v_pk_add_f32 v[18:19], v[18:19], v[26:27]
v_pk_add_f32 v[20:21], v[20:21], v[28:29]
v_pk_add_f32 v[22:23], v[22:23], v[30:31]
s_waitcnt vmcnt(21)
v_lshlrev_b32 v24, 16, v152
v_and_b32 v25, 0xffff0000, v152
v_lshlrev_b32 v26, 16, v153
v_and_b32 v27, 0xffff0000, v153
v_lshlrev_b32 v28, 16, v154
v_and_b32 v29, 0xffff0000, v154
v_lshlrev_b32 v30, 16, v155
v_and_b32 v31, 0xffff0000, v155
v_pk_add_f32 v[16:17], v[16:17], v[24:25]
v_pk_add_f32 v[18:19], v[18:19], v[26:27]
v_pk_add_f32 v[20:21], v[20:21], v[28:29]
v_pk_add_f32 v[22:23], v[22:23], v[30:31]
s_waitcnt vmcnt(20)
v_lshlrev_b32 v24, 16, v156
v_and_b32 v25, 0xffff0000, v156
v_lshlrev_b32 v26, 16, v157
v_and_b32 v27, 0xffff0000, v157
v_lshlrev_b32 v28, 16, v158
v_and_b32 v29, 0xffff0000, v158
v_lshlrev_b32 v30, 16, v159
v_and_b32 v31, 0xffff0000, v159
v_pk_add_f32 v[16:17], v[16:17], v[24:25]
v_pk_add_f32 v[18:19], v[18:19], v[26:27]
v_pk_add_f32 v[20:21], v[20:21], v[28:29]
v_pk_add_f32 v[22:23], v[22:23], v[30:31]
s_barrier
v_mov_b32 v24, v16
v_mov_b32 v25, v17
v_mov_b32 v26, v18
v_mov_b32 v27, v19
v_mov_b32 v28, v20
v_mov_b32 v29, v21
v_mov_b32 v30, v22
v_mov_b32 v31, v23
s_nop 0
v_permlane16_swap_b32 v16, v24
v_permlane16_swap_b32 v17, v25
v_permlane16_swap_b32 v18, v26
v_permlane16_swap_b32 v19, v27
v_permlane16_swap_b32 v20, v28
v_permlane16_swap_b32 v21, v29
v_permlane16_swap_b32 v22, v30
v_permlane16_swap_b32 v23, v31
v_add_f32 v16, v16, v24
v_add_f32 v17, v17, v25
v_add_f32 v18, v18, v26
v_add_f32 v19, v19, v27
v_add_f32 v20, v20, v28
v_add_f32 v21, v21, v29
v_add_f32 v22, v22, v30
v_add_f32 v23, v23, v31
v_mov_b32 v24, v16
v_mov_b32 v25, v17
v_mov_b32 v26, v18
v_mov_b32 v27, v19
v_mov_b32 v28, v20
v_mov_b32 v29, v21
v_mov_b32 v30, v22
v_mov_b32 v31, v23
s_nop 0
v_permlane32_swap_b32 v16, v24
v_permlane32_swap_b32 v17, v25
v_permlane32_swap_b32 v18, v26
v_permlane32_swap_b32 v19, v27
v_permlane32_swap_b32 v20, v28
v_permlane32_swap_b32 v21, v29
v_permlane32_swap_b32 v22, v30
v_permlane32_swap_b32 v23, v31
v_add_f32 v16, v16, v24
v_add_f32 v17, v17, v25
v_add_f32 v18, v18, v26
v_add_f32 v19, v19, v27
v_add_f32 v20, v20, v28
v_add_f32 v21, v21, v29
v_add_f32 v22, v22, v30
v_add_f32 v23, v23, v31
s_mov_b64 exec, 0xffff
buffer_store_dwordx4 v[16:19], v5, s[60:63], 0 offen sc1
buffer_store_dwordx4 v[20:23], v5, s[60:63], 0 offen offset:16 sc1
s_mov_b64 exec, -1
s_barrier
s_barrier
s_barrier
s_waitcnt vmcnt(0)
v_mov_b32 v8, 8192
v_mov_b32 v9, 1
s_mov_b64 exec, 1
buffer_atomic_add v9, v8, s[56:59], 0 offen sc1
s_mov_b64 exec, -1
s_barrier
s_barrier
s_branch Lk2end_34
Lnojob_44:
s_barrier
s_barrier
s_barrier
s_barrier
s_barrier
s_barrier
s_barrier
s_barrier
s_barrier
s_mov_b32 s28, s76
s_mov_b32 s29, s77
s_mov_b32 s30, 7340032
s_mov_b32 s31, 0x20000
v_lshlrev_b32 v6, 7, v1
s_mul_i32 s43, s2, 28672
v_add_u32 v6, s43, v6
s_mov_b32 s43, 0
buffer_load_dword v7, v6, s[28:31], s43 offen
s_mov_b32 s43, 8192
buffer_load_dword v7, v6, s[28:31], s43 offen
s_mov_b32 s43, 16384
buffer_load_dword v7, v6, s[28:31], s43 offen
s_mov_b32 s43, 24576
s_mov_b64 exec, 0xffffffff
buffer_load_dword v7, v6, s[28:31], s43 offen
s_mov_b64 exec, -1
s_barrier
s_barrier
s_cmp_lt_u32 s36, 6
s_cselect_b32 s88, s72, s74
s_cselect_b32 s89, s73, s75
s_lshl_b32 s43, s35, 8
s_add_u32 s88, s88, s43
s_addc_u32 s89, s89, 0
s_mov_b32 s90, 7333120
s_mov_b32 s91, 0x20000
v_lshrrev_b32 v12, 4, v1
v_lshlrev_b32 v13, 1, v12
v_and_b32 v10, 15, v1
v_xor_b32 v10, v10, v13
v_lshlrev_b32 v10, 4, v10
v_mul_u32_u24 v12, 7168, v12
v_add_u32 v10, v10, v12
v_xor_b32 v11, 128, v10
v_add_u32 v11, 28672, v11
s_and_b32 s44, s36, 1
s_mul_i32 s44, s44, 229376
s_sub_u32 s45, s36, 4
s_lshl_b32 s45, s45, 13
s_add_u32 m0, s45, 16384
s_add_u32 s43, s44, 0
buffer_load_dwordx4 v10, s[88:91], s43 offen lds
s_add_u32 m0, s45, 17408
s_add_u32 s43, s44, 0
buffer_load_dwordx4 v11, s[88:91], s43 offen lds
s_add_u32 m0, s45, 18432
s_add_u32 s43, s44, 57344
buffer_load_dwordx4 v10, s[88:91], s43 offen lds
s_add_u32 m0, s45, 19456
s_add_u32 s43, s44, 57344
buffer_load_dwordx4 v11, s[88:91], s43 offen lds
s_add_u32 m0, s45, 20480
s_add_u32 s43, s44, 114688
buffer_load_dwordx4 v10, s[88:91], s43 offen lds
s_add_u32 m0, s45, 21504
s_add_u32 s43, s44, 114688
buffer_load_dwordx4 v11, s[88:91], s43 offen lds
s_add_u32 m0, s45, 22528
s_add_u32 s43, s44, 172032
buffer_load_dwordx4 v10, s[88:91], s43 offen lds
s_add_u32 m0, s45, 23552
s_add_u32 s43, s44, 172032
buffer_load_dwordx4 v11, s[88:91], s43 offen lds
s_add_u32 m0, s45, 65536
s_add_u32 s43, s44, 458752
buffer_load_dwordx4 v10, s[88:91], s43 offen lds
s_add_u32 m0, s45, 66560
s_add_u32 s43, s44, 458752
buffer_load_dwordx4 v11, s[88:91], s43 offen lds
s_add_u32 m0, s45, 67584
s_add_u32 s43, s44, 516096
buffer_load_dwordx4 v10, s[88:91], s43 offen lds
s_add_u32 m0, s45, 68608
s_add_u32 s43, s44, 516096
buffer_load_dwordx4 v11, s[88:91], s43 offen lds
s_add_u32 m0, s45, 69632
s_add_u32 s43, s44, 573440
buffer_load_dwordx4 v10, s[88:91], s43 offen lds
s_add_u32 m0, s45, 70656
s_add_u32 s43, s44, 573440
buffer_load_dwordx4 v11, s[88:91], s43 offen lds
s_add_u32 m0, s45, 71680
s_add_u32 s43, s44, 630784
buffer_load_dwordx4 v10, s[88:91], s43 offen lds
s_add_u32 m0, s45, 72704
s_add_u32 s43, s44, 630784
buffer_load_dwordx4 v11, s[88:91], s43 offen lds
s_barrier
s_barrier
s_barrier
s_barrier
s_barrier
s_barrier
s_barrier
s_barrier
Lk2end_34:
s_mul_i32 s43, s34, 262144
s_add_u32 s8, s82, s43
s_addc_u32 s9, s83, 0
s_add_u32 s8, s8, 4194304
s_addc_u32 s9, s9, 0
s_mov_b32 s10, 262144
s_mov_b32 s11, 0x20000
s_cmp_lt_u32 s36, 4
s_cselect_b32 s44, s72, s74
s_cselect_b32 s45, s73, s75
s_lshl_b32 s43, s35, 8
s_add_u32 s12, s44, s43
s_addc_u32 s13, s45, 0
s_mov_b32 s14, 7333120
s_mov_b32 s15, 0x20000
s_mul_i32 s43, s35, 192
s_add_u32 s16, s44, s43
s_addc_u32 s17, s45, 0
s_add_u32 s16, s16, 4096
s_addc_u32 s17, s17, 0
s_mov_b32 s18, 7333056
s_mov_b32 s19, 0x20000
s_and_b32 s47, s36, 3
s_lshr_b32 s46, s36, 2
v_lshrrev_b32 v12, 4, v1
v_lshlrev_b32 v13, 1, v12
v_and_b32 v3, 15, v1
v_xor_b32 v3, v3, v13
v_lshlrev_b32 v3, 4, v3
v_mul_u32_u24 v12, 7168, v12
v_add_u32 v3, v3, v12
s_mul_i32 s43, s47, 114688
v_add_u32 v3, s43, v3
v_xor_b32 v4, 128, v3
v_add_u32 v4, 28672, v4
s_lshl_b32 s40, s36, 12
s_add_u32 s40, s40, 16384
s_add_u32 m0, s40, 98304
s_mov_b32 s38, 917504
buffer_load_dwordx4 v3, s[12:15], s38 offen lds
s_add_u32 m0, s40, 99328
s_mov_b32 s38, 917504
buffer_load_dwordx4 v4, s[12:15], s38 offen lds
s_add_u32 m0, s40, 100352
s_mov_b32 s38, 974848
buffer_load_dwordx4 v3, s[12:15], s38 offen lds
s_add_u32 m0, s40, 101376
s_mov_b32 s38, 974848
buffer_load_dwordx4 v4, s[12:15], s38 offen lds
v_lshlrev_b32 v31, 4, v1
s_lshl_b32 s39, s36, 11
v_add_u32 v2, s39, v31
s_mul_i32 s43, s34, 16384
s_add_u32 s20, s82, s43
s_addc_u32 s21, s83, 0
s_add_u32 s20, s20, 25165824
s_addc_u32 s21, s21, 0
s_mov_b32 s22, 16384
s_mov_b32 s23, 0x20000
s_mul_i32 s43, s34, 917504
s_add_u32 s24, s82, s43
s_addc_u32 s25, s83, 0
s_add_u32 s24, s24, 8388608
s_addc_u32 s25, s25, 0
s_mov_b32 s26, 917504
s_mov_b32 s27, 0x20000
v_add_u32 v12, 0, v1
v_mul_u32_u24 v13, 5462, v12
v_lshrrev_b32 v13, 16, v13
v_mul_u32_u24 v14, 12, v13
v_sub_u32 v14, v12, v14
v_bfe_u32 v15, v13, 2, 1
v_cmp_gt_u32 vcc, 8, v14
v_lshlrev_b32 v16, 1, v15
v_mul_u32_u24 v13, 7168, v13
v_cndmask_b32 v15, v15, v16, vcc
v_xor_b32 v14, v14, v15
v_lshl_add_u32 v5, v14, 4, v13
v_add_u32 v12, 64, v1
v_mul_u32_u24 v13, 5462, v12
v_lshrrev_b32 v13, 16, v13
v_mul_u32_u24 v14, 12, v13
v_sub_u32 v14, v12, v14
v_bfe_u32 v15, v13, 2, 1
v_cmp_gt_u32 vcc, 8, v14
v_lshlrev_b32 v16, 1, v15
v_mul_u32_u24 v13, 7168, v13
v_cndmask_b32 v15, v15, v16, vcc
v_xor_b32 v14, v14, v15
v_lshl_add_u32 v6, v14, 4, v13
v_add_u32 v12, 128, v1
v_mul_u32_u24 v13, 5462, v12
v_lshrrev_b32 v13, 16, v13
v_mul_u32_u24 v14, 12, v13
v_sub_u32 v14, v12, v14
v_bfe_u32 v15, v13, 2, 1
v_cmp_gt_u32 vcc, 8, v14
v_lshlrev_b32 v16, 1, v15
v_mul_u32_u24 v13, 7168, v13
v_cndmask_b32 v15, v15, v16, vcc
v_xor_b32 v14, v14, v15
v_lshl_add_u32 v7, v14, 4, v13
s_mul_i32 s43, s47, 114688
v_add_u32 v5, s43, v5
v_add_u32 v6, s43, v6
v_add_u32 v7, s43, v7
s_mul_i32 s50, s46, 12288
s_mul_i32 s43, s47, 3072
s_add_u32 s50, s50, s43
s_add_u32 s50, s50, 16384
s_lshl_b32 s43, s46, 12
v_add_u32 v8, s43, v31
v_add_u32 v9, 98304, v8
s_lshr_b32 s43, s36, 1
s_lshl_b32 s43, s43, 11
v_add_u32 v10, s43, v31
v_add_u32 v11, 98304, v10
v_lshrrev_b32 v14, 2, v1
v_and_b32 v15, 7, v14
v_mul_u32_u24 v14, 256, v14
v_lshl_add_u32 v14, v15, 5, v14
v_and_b32 v15, 3, v1
v_lshl_add_u32 v12, v15, 3, v14
s_lshl_b32 s43, s47, 6
v_xor_b32 v12, s43, v12
v_add_u32 v12, 16384, v12
v_xor_b32 v13, 32, v12
v_add_u32 v14, 49152, v12
v_add_u32 v15, 49152, v13
v_add_u32 v16, 98304, v12
v_add_u32 v17, 98304, v13
s_and_b32 s51, s36, 1
v_lshrrev_b32 v27, 2, v1
v_bfe_u32 v28, v27, 2, 1
v_mul_u32_u24 v27, 192, v27
v_add_u32 v27, 16384, v27
v_and_b32 v29, 3, v1
v_lshl_add_u32 v18, v29, 3, v27
s_lshl_b32 s43, s51, 6
v_add_u32 v18, s43, v18
v_lshl_add_u32 v19, v28, 5, v18
v_xor_b32 v30, 1, v28
v_lshl_add_u32 v18, v30, 5, v18
v_mov_b32 v30, v18
v_mov_b32 v18, v19
v_mov_b32 v19, v30
v_xor_b32 v28, s51, v28
v_lshl_add_u32 v27, v28, 4, v27
v_lshrrev_b32 v28, 1, v29
v_lshl_add_u32 v27, v28, 5, v27
v_and_b32 v28, 1, v29
v_lshl_add_u32 v27, v28, 3, v27
v_add_u32 v20, 128, v27
v_add_u32 v21, 49152, v18
v_add_u32 v22, 49152, v19
v_add_u32 v23, 49152, v20
v_add_u32 v24, 98304, v18
v_add_u32 v25, 98304, v19
v_add_u32 v26, 98304, v20
v_and_b32 v27, 7, v1
v_lshrrev_b32 v28, 2, v27
v_lshlrev_b32 v28, 6, v28
v_bfe_u32 v29, v27, 1, 1
s_lshl_b32 s43, s48, 3
s_lshl_b32 s44, s47, 1
s_add_u32 s43, s43, s44
v_add3_u32 v28, v28, v29, s43
v_mul_u32_u24 v28, 7168, v28
v_and_b32 v27, 1, v27
v_mul_u32_u24 v27, 188, v27
v_add_u32 v27, v27, v28
s_mov_b32 s38, 1835008
buffer_load_dword v28, v27, s[12:15], s38 offen
s_mov_b32 s38, 2752512
buffer_load_dword v28, v27, s[12:15], s38 offen
v_mov_b32 v128, 0
v_mov_b32 v129, 0
v_mov_b32 v130, 0
v_mov_b32 v131, 0
v_mov_b32 v132, 0
v_mov_b32 v133, 0
v_mov_b32 v134, 0
v_mov_b32 v135, 0
v_mov_b32 v136, 0
v_mov_b32 v137, 0
v_mov_b32 v138, 0
v_mov_b32 v139, 0
v_mov_b32 v140, 0
v_mov_b32 v141, 0
v_mov_b32 v142, 0
v_mov_b32 v143, 0
v_mov_b32 v144, 0
v_mov_b32 v145, 0
v_mov_b32 v146, 0
v_mov_b32 v147, 0
v_mov_b32 v148, 0
v_mov_b32 v149, 0
v_mov_b32 v150, 0
v_mov_b32 v151, 0
v_mov_b32 v152, 0
v_mov_b32 v153, 0
v_mov_b32 v154, 0
v_mov_b32 v155, 0
v_mov_b32 v156, 0
v_mov_b32 v157, 0
v_mov_b32 v158, 0
v_mov_b32 v159, 0
v_mov_b32 v160, 0
v_mov_b32 v161, 0
v_mov_b32 v162, 0
v_mov_b32 v163, 0
v_mov_b32 v164, 0
v_mov_b32 v165, 0
v_mov_b32 v166, 0
v_mov_b32 v167, 0
v_mov_b32 v168, 0
v_mov_b32 v169, 0
v_mov_b32 v170, 0
v_mov_b32 v171, 0
v_mov_b32 v172, 0
v_mov_b32 v173, 0
v_mov_b32 v174, 0
v_mov_b32 v175, 0
v_mov_b32 v176, 0
v_mov_b32 v177, 0
v_mov_b32 v178, 0
v_mov_b32 v179, 0
v_mov_b32 v180, 0
v_mov_b32 v181, 0
v_mov_b32 v182, 0
v_mov_b32 v183, 0
v_mov_b32 v184, 0
v_mov_b32 v185, 0
v_mov_b32 v186, 0
v_mov_b32 v187, 0
v_mov_b32 v188, 0
v_mov_b32 v189, 0
v_mov_b32 v190, 0
v_mov_b32 v191, 0
s_cmp_lg_u32 s36, 4
s_cbranch_scc1 Lnp_45
s_add_u32 s43, s34, 16
s_lshl_b32 s43, s43, 7
v_mov_b32 v29, s43
s_mov_b32 s41, 0x40000
Lpoll_46:
buffer_load_dword v30, v29, s[56:59], 0 offen sc1
s_waitcnt vmcnt(0)
Lpchk_48:
v_readfirstlane_b32 s42, v30
s_cmp_eq_u32 s42, 16
s_cbranch_scc1 Lpok_47
s_sub_u32 s41, s41, 1
s_cmp_lg_u32 s41, 0
s_cbranch_scc1 Lpoll_46
Lpok_47:
Lnp_45:
s_barrier
s_add_u32 m0, s39, 0
s_mov_b32 s37, 0
buffer_load_dwordx4 v2, s[8:11], s37 offen sc1 lds
buffer_load_dwordx4 v2, s[8:11], s37 offen offset:1024 sc1 lds
buffer_load_dwordx4 v[96:99], v2, s[20:23], 0 offen sc1
buffer_load_dwordx4 v[100:103], v2, s[20:23], 0 offen offset:1024 sc1
s_add_u32 m0, s39, 49152
s_mov_b32 s37, 16384
buffer_load_dwordx4 v2, s[8:11], s37 offen sc1 lds
buffer_load_dwordx4 v2, s[8:11], s37 offen offset:1024 sc1 lds
s_add_u32 m0, s39, 98304
s_mov_b32 s37, 32768
buffer_load_dwordx4 v2, s[8:11], s37 offen sc1 lds
buffer_load_dwordx4 v2, s[8:11], s37 offen offset:1024 sc1 lds
s_waitcnt vmcnt(6)
s_barrier
ds_read_b128 v[32:35], v8 offset:0
ds_read_b64_tr_b16 v[48:49], v12 offset:0
ds_read_b64_tr_b16 v[50:51], v12 offset:4096
ds_read_b64_tr_b16 v[52:53], v13 offset:0
ds_read_b64_tr_b16 v[54:55], v13 offset:4096
ds_read_b64_tr_b16 v[56:57], v12 offset:16384
ds_read_b64_tr_b16 v[58:59], v12 offset:20480
ds_read_b64_tr_b16 v[60:61], v13 offset:16384
ds_read_b64_tr_b16 v[62:63], v13 offset:20480
ds_read_b128 v[36:39], v8 offset:1024
ds_read_b128 v[40:43], v8 offset:2048
ds_read_b128 v[44:47], v8 offset:3072
s_waitcnt lgkmcnt(0)
v_mfma_f32_16x16x32_bf16 v[128:131], v[48:51], v[32:35], v[128:131]
ds_read_b128 v[64:67], v8 offset:8192
ds_read_b64_tr_b16 v[80:81], v12 offset:8192
v_mfma_f32_16x16x32_bf16 v[132:135], v[52:55], v[32:35], v[132:135]
ds_read_b64_tr_b16 v[82:83], v12 offset:12288
ds_read_b64_tr_b16 v[84:85], v13 offset:8192
v_mfma_f32_16x16x32_bf16 v[136:139], v[56:59], v[32:35], v[136:139]
ds_read_b64_tr_b16 v[86:87], v13 offset:12288
ds_read_b64_tr_b16 v[88:89], v12 offset:24576
v_mfma_f32_16x16x32_bf16 v[140:143], v[60:63], v[32:35], v[140:143]
ds_read_b64_tr_b16 v[90:91], v12 offset:28672
ds_read_b64_tr_b16 v[92:93], v13 offset:24576
v_mfma_f32_16x16x32_bf16 v[156:159], v[60:63], v[36:39], v[156:159]
ds_read_b64_tr_b16 v[94:95], v13 offset:28672
ds_read_b128 v[68:71], v8 offset:9216
v_mfma_f32_16x16x32_bf16 v[152:155], v[56:59], v[36:39], v[152:155]
ds_read_b128 v[72:75], v8 offset:10240
ds_read_b128 v[76:79], v8 offset:11264
v_mfma_f32_16x16x32_bf16 v[148:151], v[52:55], v[36:39], v[148:151]
v_mfma_f32_16x16x32_bf16 v[144:147], v[48:51], v[36:39], v[144:147]
v_mfma_f32_16x16x32_bf16 v[160:163], v[48:51], v[40:43], v[160:163]
v_mfma_f32_16x16x32_bf16 v[164:167], v[52:55], v[40:43], v[164:167]
v_mfma_f32_16x16x32_bf16 v[168:171], v[56:59], v[40:43], v[168:171]
v_mfma_f32_16x16x32_bf16 v[172:175], v[60:63], v[40:43], v[172:175]
v_mfma_f32_16x16x32_bf16 v[188:191], v[60:63], v[44:47], v[188:191]
v_mfma_f32_16x16x32_bf16 v[184:187], v[56:59], v[44:47], v[184:187]
v_mfma_f32_16x16x32_bf16 v[180:183], v[52:55], v[44:47], v[180:183]
v_mfma_f32_16x16x32_bf16 v[176:179], v[48:51], v[44:47], v[176:179]
s_waitcnt vmcnt(2) lgkmcnt(0)
s_barrier
v_mfma_f32_16x16x32_bf16 v[128:131], v[80:83], v[64:67], v[128:131]
ds_read_b128 v[32:35], v8 offset:49152
ds_read_b64_tr_b16 v[48:49], v14 offset:0
v_pk_add_f32 v[96:97], v[96:97], v[100:101]
v_mfma_f32_16x16x32_bf16 v[132:135], v[84:87], v[64:67], v[132:135]
ds_read_b64_tr_b16 v[50:51], v14 offset:4096
ds_read_b64_tr_b16 v[52:53], v15 offset:0
v_pk_add_f32 v[98:99], v[98:99], v[102:103]
v_mfma_f32_16x16x32_bf16 v[136:139], v[88:91], v[64:67], v[136:139]
ds_read_b64_tr_b16 v[54:55], v15 offset:4096
ds_read_b64_tr_b16 v[56:57], v14 offset:16384
s_nop 1
s_add_u32 m0, s40, 0
s_mov_b32 s38, 1376256
buffer_load_dwordx4 v3, s[12:15], s38 offen lds
v_mfma_f32_16x16x32_bf16 v[140:143], v[92:95], v[64:67], v[140:143]
ds_read_b64_tr_b16 v[58:59], v14 offset:20480
ds_read_b64_tr_b16 v[60:61], v15 offset:16384
v_add_f32_dpp v96, v96, v96 row_ror:8 row_mask:0xf bank_mask:0xf
v_mfma_f32_16x16x32_bf16 v[156:159], v[92:95], v[68:71], v[156:159]
ds_read_b64_tr_b16 v[62:63], v15 offset:20480
ds_read_b128 v[36:39], v8 offset:50176
v_add_f32_dpp v97, v97, v97 row_ror:8 row_mask:0xf bank_mask:0xf
s_add_u32 m0, s40, 1024
s_mov_b32 s38, 1376256
buffer_load_dwordx4 v4, s[12:15], s38 offen lds
v_mfma_f32_16x16x32_bf16 v[152:155], v[88:91], v[68:71], v[152:155]
ds_read_b128 v[40:43], v8 offset:51200
ds_read_b128 v[44:47], v8 offset:52224
v_add_f32_dpp v98, v98, v98 row_ror:8 row_mask:0xf bank_mask:0xf
v_mfma_f32_16x16x32_bf16 v[148:151], v[84:87], v[68:71], v[148:151]
v_add_f32_dpp v99, v99, v99 row_ror:8 row_mask:0xf bank_mask:0xf
s_add_u32 m0, s40, 2048
s_mov_b32 s38, 1433600
buffer_load_dwordx4 v3, s[12:15], s38 offen lds
v_mfma_f32_16x16x32_bf16 v[144:147], v[80:83], v[68:71], v[144:147]
v_mov_b32 v100, v96
v_mfma_f32_16x16x32_bf16 v[160:163], v[80:83], v[72:75], v[160:163]
v_mov_b32 v101, v97
s_add_u32 m0, s40, 3072
s_mov_b32 s38, 1433600
buffer_load_dwordx4 v4, s[12:15], s38 offen lds
v_mfma_f32_16x16x32_bf16 v[164:167], v[84:87], v[72:75], v[164:167]
v_mov_b32 v102, v98
v_mfma_f32_16x16x32_bf16 v[168:171], v[88:91], v[72:75], v[168:171]
v_mov_b32 v103, v99
s_add_u32 m0, s39, 0
s_mov_b32 s37, 49152
buffer_load_dwordx4 v2, s[8:11], s37 offen sc1 lds
v_mfma_f32_16x16x32_bf16 v[172:175], v[92:95], v[72:75], v[172:175]
s_nop 0
v_mfma_f32_16x16x32_bf16 v[188:191], v[92:95], v[76:79], v[188:191]
v_permlane16_swap_b32 v96, v100
buffer_load_dwordx4 v2, s[8:11], s37 offen offset:1024 sc1 lds
v_mfma_f32_16x16x32_bf16 v[184:187], v[88:91], v[76:79], v[184:187]
v_permlane16_swap_b32 v97, v101
v_mfma_f32_16x16x32_bf16 v[180:183], v[84:87], v[76:79], v[180:183]
v_permlane16_swap_b32 v98, v102
s_mov_b32 s38, 3670016
buffer_load_dword v28, v27, s[12:15], s38 offen
v_mfma_f32_16x16x32_bf16 v[176:179], v[80:83], v[76:79], v[176:179]
v_permlane16_swap_b32 v99, v103
s_waitcnt lgkmcnt(0)
v_mfma_f32_16x16x32_bf16 v[128:131], v[48:51], v[32:35], v[128:131]
ds_read_b128 v[64:67], v8 offset:57344
ds_read_b64_tr_b16 v[80:81], v14 offset:8192
v_add_f32 v96, v96, v100
v_mfma_f32_16x16x32_bf16 v[132:135], v[52:55], v[32:35], v[132:135]
ds_read_b64_tr_b16 v[82:83], v14 offset:12288
ds_read_b64_tr_b16 v[84:85], v15 offset:8192
v_add_f32 v97, v97, v101
v_mfma_f32_16x16x32_bf16 v[136:139], v[56:59], v[32:35], v[136:139]
ds_read_b64_tr_b16 v[86:87], v15 offset:12288
ds_read_b64_tr_b16 v[88:89], v14 offset:24576
v_add_f32 v98, v98, v102
v_mfma_f32_16x16x32_bf16 v[140:143], v[60:63], v[32:35], v[140:143]
ds_read_b64_tr_b16 v[90:91], v14 offset:28672
ds_read_b64_tr_b16 v[92:93], v15 offset:24576
v_add_f32 v99, v99, v103
v_mfma_f32_16x16x32_bf16 v[156:159], v[60:63], v[36:39], v[156:159]
ds_read_b64_tr_b16 v[94:95], v15 offset:28672
ds_read_b128 v[68:71], v8 offset:58368
v_mov_b32 v100, v96
v_mfma_f32_16x16x32_bf16 v[152:155], v[56:59], v[36:39], v[152:155]
ds_read_b128 v[72:75], v8 offset:59392
ds_read_b128 v[76:79], v8 offset:60416
v_mov_b32 v101, v97
v_mfma_f32_16x16x32_bf16 v[148:151], v[52:55], v[36:39], v[148:151]
v_mov_b32 v102, v98
v_mfma_f32_16x16x32_bf16 v[144:147], v[48:51], v[36:39], v[144:147]
v_mov_b32 v103, v99
v_mfma_f32_16x16x32_bf16 v[160:163], v[48:51], v[40:43], v[160:163]
s_nop 0
v_mfma_f32_16x16x32_bf16 v[164:167], v[52:55], v[40:43], v[164:167]
v_permlane32_swap_b32 v96, v100
v_mfma_f32_16x16x32_bf16 v[168:171], v[56:59], v[40:43], v[168:171]
v_permlane32_swap_b32 v97, v101
v_mfma_f32_16x16x32_bf16 v[172:175], v[60:63], v[40:43], v[172:175]
v_permlane32_swap_b32 v98, v102
v_mfma_f32_16x16x32_bf16 v[188:191], v[60:63], v[44:47], v[188:191]
v_permlane32_swap_b32 v99, v103
v_mfma_f32_16x16x32_bf16 v[184:187], v[56:59], v[44:47], v[184:187]
v_add_f32 v96, v96, v100
v_mfma_f32_16x16x32_bf16 v[180:183], v[52:55], v[44:47], v[180:183]
v_add_f32 v97, v97, v101
v_mfma_f32_16x16x32_bf16 v[176:179], v[48:51], v[44:47], v[176:179]
v_add_f32 v98, v98, v102
v_add_f32 v99, v99, v103
s_waitcnt vmcnt(7) lgkmcnt(0)
s_barrier
v_mfma_f32_16x16x32_bf16 v[128:131], v[80:83], v[64:67], v[128:131]
ds_read_b128 v[32:35], v9 offset:0
ds_read_b64_tr_b16 v[48:49], v16 offset:0
v_mul_f32 v96, 0x3a800000, v96
v_mfma_f32_16x16x32_bf16 v[132:135], v[84:87], v[64:67], v[132:135]
ds_read_b64_tr_b16 v[50:51], v16 offset:4096
ds_read_b64_tr_b16 v[52:53], v17 offset:0
v_mul_f32 v97, 0x3a800000, v97
v_mfma_f32_16x16x32_bf16 v[136:139], v[88:91], v[64:67], v[136:139]
ds_read_b64_tr_b16 v[54:55], v17 offset:4096
ds_read_b64_tr_b16 v[56:57], v16 offset:16384
v_mul_f32 v98, 0x3a800000, v98
v_mfma_f32_16x16x32_bf16 v[140:143], v[92:95], v[64:67], v[140:143]
ds_read_b64_tr_b16 v[58:59], v16 offset:20480
ds_read_b64_tr_b16 v[60:61], v17 offset:16384
v_mul_f32 v99, 0x3a800000, v99
v_mfma_f32_16x16x32_bf16 v[156:159], v[92:95], v[68:71], v[156:159]
ds_read_b64_tr_b16 v[62:63], v17 offset:20480
ds_read_b128 v[36:39], v9 offset:1024
v_fma_f32 v97, -v96, v96, v97
s_add_u32 m0, s40, 49152
s_mov_b32 s38, 1835008
buffer_load_dwordx4 v3, s[12:15], s38 offen lds
v_mfma_f32_16x16x32_bf16 v[152:155], v[88:91], v[68:71], v[152:155]
ds_read_b128 v[40:43], v9 offset:2048
ds_read_b128 v[44:47], v9 offset:3072
v_fma_f32 v99, -v98, v98, v99
v_mfma_f32_16x16x32_bf16 v[148:151], v[84:87], v[68:71], v[148:151]
v_max_f32 v97, 0, v97
s_add_u32 m0, s40, 50176
s_mov_b32 s38, 1835008
buffer_load_dwordx4 v4, s[12:15], s38 offen lds
v_mfma_f32_16x16x32_bf16 v[144:147], v[80:83], v[68:71], v[144:147]
v_max_f32 v99, 0, v99
v_mfma_f32_16x16x32_bf16 v[160:163], v[80:83], v[72:75], v[160:163]
v_add_f32 v97, 0x3727c5ac, v97
s_add_u32 m0, s40, 51200
s_mov_b32 s38, 1892352
buffer_load_dwordx4 v3, s[12:15], s38 offen lds
v_mfma_f32_16x16x32_bf16 v[164:167], v[84:87], v[72:75], v[164:167]
v_add_f32 v99, 0x3727c5ac, v99
v_mfma_f32_16x16x32_bf16 v[168:171], v[88:91], v[72:75], v[168:171]
v_rsq_f32 v97, v97
s_add_u32 m0, s40, 52224
s_mov_b32 s38, 1892352
buffer_load_dwordx4 v4, s[12:15], s38 offen lds
v_mfma_f32_16x16x32_bf16 v[172:175], v[92:95], v[72:75], v[172:175]
v_rsq_f32 v99, v99
v_mfma_f32_16x16x32_bf16 v[188:191], v[92:95], v[76:79], v[188:191]
v_and_b32 v100, 7, v1
s_add_u32 m0, s39, 49152
s_mov_b32 s37, 65536
buffer_load_dwordx4 v2, s[8:11], s37 offen sc1 lds
v_mfma_f32_16x16x32_bf16 v[184:187], v[88:91], v[76:79], v[184:187]
s_lshl_b32 s43, s36, 7
v_mfma_f32_16x16x32_bf16 v[180:183], v[84:87], v[76:79], v[180:183]
s_add_u32 s43, s43, 147456
buffer_load_dwordx4 v2, s[8:11], s37 offen offset:1024 sc1 lds
v_mfma_f32_16x16x32_bf16 v[176:179], v[80:83], v[76:79], v[176:179]
v_lshl_add_u32 v100, v100, 4, s43
ds_write_b128 v100, v[96:99]
s_waitcnt lgkmcnt(0)
v_mfma_f32_16x16x32_bf16 v[128:131], v[48:51], v[32:35], v[128:131]
ds_read_b128 v[64:67], v9 offset:8192
ds_read_b64_tr_b16 v[80:81], v16 offset:8192
v_mfma_f32_16x16x32_bf16 v[132:135], v[52:55], v[32:35], v[132:135]
ds_read_b64_tr_b16 v[82:83], v16 offset:12288
ds_read_b64_tr_b16 v[84:85], v17 offset:8192
v_mfma_f32_16x16x32_bf16 v[136:139], v[56:59], v[32:35], v[136:139]
ds_read_b64_tr_b16 v[86:87], v17 offset:12288
ds_read_b64_tr_b16 v[88:89], v16 offset:24576
v_mfma_f32_16x16x32_bf16 v[140:143], v[60:63], v[32:35], v[140:143]
ds_read_b64_tr_b16 v[90:91], v16 offset:28672
ds_read_b64_tr_b16 v[92:93], v17 offset:24576
v_mfma_f32_16x16x32_bf16 v[156:159], v[60:63], v[36:39], v[156:159]
ds_read_b64_tr_b16 v[94:95], v17 offset:28672
ds_read_b128 v[68:71], v9 offset:9216
v_mfma_f32_16x16x32_bf16 v[152:155], v[56:59], v[36:39], v[152:155]
ds_read_b128 v[72:75], v9 offset:10240
ds_read_b128 v[76:79], v9 offset:11264
v_mfma_f32_16x16x32_bf16 v[148:151], v[52:55], v[36:39], v[148:151]
v_mfma_f32_16x16x32_bf16 v[144:147], v[48:51], v[36:39], v[144:147]
v_mfma_f32_16x16x32_bf16 v[160:163], v[48:51], v[40:43], v[160:163]
v_mfma_f32_16x16x32_bf16 v[164:167], v[52:55], v[40:43], v[164:167]
v_mfma_f32_16x16x32_bf16 v[168:171], v[56:59], v[40:43], v[168:171]
v_mfma_f32_16x16x32_bf16 v[172:175], v[60:63], v[40:43], v[172:175]
v_mfma_f32_16x16x32_bf16 v[188:191], v[60:63], v[44:47], v[188:191]
v_mfma_f32_16x16x32_bf16 v[184:187], v[56:59], v[44:47], v[184:187]
v_mfma_f32_16x16x32_bf16 v[180:183], v[52:55], v[44:47], v[180:183]
v_mfma_f32_16x16x32_bf16 v[176:179], v[48:51], v[44:47], v[176:179]
s_waitcnt vmcnt(7) lgkmcnt(0)
s_barrier
v_mfma_f32_16x16x32_bf16 v[128:131], v[80:83], v[64:67], v[128:131]
ds_read_b128 v[32:35], v8 offset:0
ds_read_b64_tr_b16 v[48:49], v12 offset:0
v_mfma_f32_16x16x32_bf16 v[132:135], v[84:87], v[64:67], v[132:135]
ds_read_b64_tr_b16 v[50:51], v12 offset:4096
ds_read_b64_tr_b16 v[52:53], v13 offset:0
v_mfma_f32_16x16x32_bf16 v[136:139], v[88:91], v[64:67], v[136:139]
ds_read_b64_tr_b16 v[54:55], v13 offset:4096
ds_read_b64_tr_b16 v[56:57], v12 offset:16384
s_add_u32 m0, s40, 98304
s_mov_b32 s38, 2293760
buffer_load_dwordx4 v3, s[12:15], s38 offen lds
v_mfma_f32_16x16x32_bf16 v[140:143], v[92:95], v[64:67], v[140:143]
ds_read_b64_tr_b16 v[58:59], v12 offset:20480
ds_read_b64_tr_b16 v[60:61], v13 offset:16384
v_mfma_f32_16x16x32_bf16 v[156:159], v[92:95], v[68:71], v[156:159]
ds_read_b64_tr_b16 v[62:63], v13 offset:20480
ds_read_b128 v[36:39], v8 offset:1024
s_add_u32 m0, s40, 99328
s_mov_b32 s38, 2293760
buffer_load_dwordx4 v4, s[12:15], s38 offen lds
v_mfma_f32_16x16x32_bf16 v[152:155], v[88:91], v[68:71], v[152:155]
ds_read_b128 v[40:43], v8 offset:2048
ds_read_b128 v[44:47], v8 offset:3072
v_mfma_f32_16x16x32_bf16 v[148:151], v[84:87], v[68:71], v[148:151]
s_add_u32 m0, s40, 100352
s_mov_b32 s38, 2351104
buffer_load_dwordx4 v3, s[12:15], s38 offen lds
v_mfma_f32_16x16x32_bf16 v[144:147], v[80:83], v[68:71], v[144:147]
v_mfma_f32_16x16x32_bf16 v[160:163], v[80:83], v[72:75], v[160:163]
s_add_u32 m0, s40, 101376
s_mov_b32 s38, 2351104
buffer_load_dwordx4 v4, s[12:15], s38 offen lds
v_mfma_f32_16x16x32_bf16 v[164:167], v[84:87], v[72:75], v[164:167]
v_mfma_f32_16x16x32_bf16 v[168:171], v[88:91], v[72:75], v[168:171]
s_add_u32 m0, s39, 98304
s_mov_b32 s37, 81920
buffer_load_dwordx4 v2, s[8:11], s37 offen sc1 lds
v_mfma_f32_16x16x32_bf16 v[172:175], v[92:95], v[72:75], v[172:175]
v_mfma_f32_16x16x32_bf16 v[188:191], v[92:95], v[76:79], v[188:191]
buffer_load_dwordx4 v2, s[8:11], s37 offen offset:1024 sc1 lds
v_mfma_f32_16x16x32_bf16 v[184:187], v[88:91], v[76:79], v[184:187]
v_mfma_f32_16x16x32_bf16 v[180:183], v[84:87], v[76:79], v[180:183]
s_mov_b32 s38, 4587520
buffer_load_dword v28, v27, s[12:15], s38 offen
v_mfma_f32_16x16x32_bf16 v[176:179], v[80:83], v[76:79], v[176:179]
s_waitcnt lgkmcnt(0)
v_mfma_f32_16x16x32_bf16 v[128:131], v[48:51], v[32:35], v[128:131]
ds_read_b128 v[64:67], v8 offset:8192
ds_read_b64_tr_b16 v[80:81], v12 offset:8192
v_mfma_f32_16x16x32_bf16 v[132:135], v[52:55], v[32:35], v[132:135]
ds_read_b64_tr_b16 v[82:83], v12 offset:12288
ds_read_b64_tr_b16 v[84:85], v13 offset:8192
v_mfma_f32_16x16x32_bf16 v[136:139], v[56:59], v[32:35], v[136:139]
ds_read_b64_tr_b16 v[86:87], v13 offset:12288
ds_read_b64_tr_b16 v[88:89], v12 offset:24576
v_mfma_f32_16x16x32_bf16 v[140:143], v[60:63], v[32:35], v[140:143]
ds_read_b64_tr_b16 v[90:91], v12 offset:28672
ds_read_b64_tr_b16 v[92:93], v13 offset:24576
v_mfma_f32_16x16x32_bf16 v[156:159], v[60:63], v[36:39], v[156:159]
ds_read_b64_tr_b16 v[94:95], v13 offset:28672
ds_read_b128 v[68:71], v8 offset:9216
v_mfma_f32_16x16x32_bf16 v[152:155], v[56:59], v[36:39], v[152:155]
ds_read_b128 v[72:75], v8 offset:10240
ds_read_b128 v[76:79], v8 offset:11264
v_mfma_f32_16x16x32_bf16 v[148:151], v[52:55], v[36:39], v[148:151]
v_mfma_f32_16x16x32_bf16 v[144:147], v[48:51], v[36:39], v[144:147]
v_mfma_f32_16x16x32_bf16 v[160:163], v[48:51], v[40:43], v[160:163]
v_mfma_f32_16x16x32_bf16 v[164:167], v[52:55], v[40:43], v[164:167]
v_mfma_f32_16x16x32_bf16 v[168:171], v[56:59], v[40:43], v[168:171]
v_mfma_f32_16x16x32_bf16 v[172:175], v[60:63], v[40:43], v[172:175]
v_mfma_f32_16x16x32_bf16 v[188:191], v[60:63], v[44:47], v[188:191]
v_mfma_f32_16x16x32_bf16 v[184:187], v[56:59], v[44:47], v[184:187]
v_mfma_f32_16x16x32_bf16 v[180:183], v[52:55], v[44:47], v[180:183]
v_mfma_f32_16x16x32_bf16 v[176:179], v[48:51], v[44:47], v[176:179]
s_waitcnt vmcnt(7) lgkmcnt(0)
s_barrier
v_mfma_f32_16x16x32_bf16 v[128:131], v[80:83], v[64:67], v[128:131]
ds_read_b128 v[32:35], v8 offset:49152
ds_read_b64_tr_b16 v[48:49], v14 offset:0
v_mfma_f32_16x16x32_bf16 v[132:135], v[84:87], v[64:67], v[132:135]
ds_read_b64_tr_b16 v[50:51], v14 offset:4096
ds_read_b64_tr_b16 v[52:53], v15 offset:0
v_mfma_f32_16x16x32_bf16 v[136:139], v[88:91], v[64:67], v[136:139]
ds_read_b64_tr_b16 v[54:55], v15 offset:4096
ds_read_b64_tr_b16 v[56:57], v14 offset:16384
v_mfma_f32_16x16x32_bf16 v[140:143], v[92:95], v[64:67], v[140:143]
ds_read_b64_tr_b16 v[58:59], v14 offset:20480
ds_read_b64_tr_b16 v[60:61], v15 offset:16384
v_mfma_f32_16x16x32_bf16 v[156:159], v[92:95], v[68:71], v[156:159]
ds_read_b64_tr_b16 v[62:63], v15 offset:20480
ds_read_b128 v[36:39], v8 offset:50176
s_add_u32 m0, s40, 0
s_mov_b32 s38, 2752512
buffer_load_dwordx4 v3, s[12:15], s38 offen lds
v_mfma_f32_16x16x32_bf16 v[152:155], v[88:91], v[68:71], v[152:155]
ds_read_b128 v[40:43], v8 offset:51200
ds_read_b128 v[44:47], v8 offset:52224
v_mfma_f32_16x16x32_bf16 v[148:151], v[84:87], v[68:71], v[148:151]
s_add_u32 m0, s40, 1024
s_mov_b32 s38, 2752512
buffer_load_dwordx4 v4, s[12:15], s38 offen lds
v_mfma_f32_16x16x32_bf16 v[144:147], v[80:83], v[68:71], v[144:147]
v_mfma_f32_16x16x32_bf16 v[160:163], v[80:83], v[72:75], v[160:163]
s_add_u32 m0, s40, 2048
s_mov_b32 s38, 2809856
buffer_load_dwordx4 v3, s[12:15], s38 offen lds
v_mfma_f32_16x16x32_bf16 v[164:167], v[84:87], v[72:75], v[164:167]
v_mfma_f32_16x16x32_bf16 v[168:171], v[88:91], v[72:75], v[168:171]
s_add_u32 m0, s40, 3072
s_mov_b32 s38, 2809856
buffer_load_dwordx4 v4, s[12:15], s38 offen lds
v_mfma_f32_16x16x32_bf16 v[172:175], v[92:95], v[72:75], v[172:175]
v_mfma_f32_16x16x32_bf16 v[188:191], v[92:95], v[76:79], v[188:191]
s_add_u32 m0, s39, 0
s_mov_b32 s37, 98304
buffer_load_dwordx4 v2, s[8:11], s37 offen sc1 lds
v_mfma_f32_16x16x32_bf16 v[184:187], v[88:91], v[76:79], v[184:187]
v_mfma_f32_16x16x32_bf16 v[180:183], v[84:87], v[76:79], v[180:183]
buffer_load_dwordx4 v2, s[8:11], s37 offen offset:1024 sc1 lds
v_mfma_f32_16x16x32_bf16 v[176:179], v[80:83], v[76:79], v[176:179]
s_waitcnt lgkmcnt(0)
v_mfma_f32_16x16x32_bf16 v[128:131], v[48:51], v[32:35], v[128:131]
ds_read_b128 v[64:67], v8 offset:57344
ds_read_b64_tr_b16 v[80:81], v14 offset:8192
v_mfma_f32_16x16x32_bf16 v[132:135], v[52:55], v[32:35], v[132:135]
ds_read_b64_tr_b16 v[82:83], v14 offset:12288
ds_read_b64_tr_b16 v[84:85], v15 offset:8192
v_mfma_f32_16x16x32_bf16 v[136:139], v[56:59], v[32:35], v[136:139]
ds_read_b64_tr_b16 v[86:87], v15 offset:12288
ds_read_b64_tr_b16 v[88:89], v14 offset:24576
v_mfma_f32_16x16x32_bf16 v[140:143], v[60:63], v[32:35], v[140:143]
ds_read_b64_tr_b16 v[90:91], v14 offset:28672
ds_read_b64_tr_b16 v[92:93], v15 offset:24576
v_mfma_f32_16x16x32_bf16 v[156:159], v[60:63], v[36:39], v[156:159]
ds_read_b64_tr_b16 v[94:95], v15 offset:28672
ds_read_b128 v[68:71], v8 offset:58368
v_mfma_f32_16x16x32_bf16 v[152:155], v[56:59], v[36:39], v[152:155]
ds_read_b128 v[72:75], v8 offset:59392
ds_read_b128 v[76:79], v8 offset:60416
v_mfma_f32_16x16x32_bf16 v[148:151], v[52:55], v[36:39], v[148:151]
v_mfma_f32_16x16x32_bf16 v[144:147], v[48:51], v[36:39], v[144:147]
v_mfma_f32_16x16x32_bf16 v[160:163], v[48:51], v[40:43], v[160:163]
v_mfma_f32_16x16x32_bf16 v[164:167], v[52:55], v[40:43], v[164:167]
v_mfma_f32_16x16x32_bf16 v[168:171], v[56:59], v[40:43], v[168:171]
v_mfma_f32_16x16x32_bf16 v[172:175], v[60:63], v[40:43], v[172:175]
v_mfma_f32_16x16x32_bf16 v[188:191], v[60:63], v[44:47], v[188:191]
v_mfma_f32_16x16x32_bf16 v[184:187], v[56:59], v[44:47], v[184:187]
v_mfma_f32_16x16x32_bf16 v[180:183], v[52:55], v[44:47], v[180:183]
v_mfma_f32_16x16x32_bf16 v[176:179], v[48:51], v[44:47], v[176:179]
s_waitcnt vmcnt(7) lgkmcnt(0)
s_barrier
v_mfma_f32_16x16x32_bf16 v[128:131], v[80:83], v[64:67], v[128:131]
ds_read_b128 v[32:35], v9 offset:0
ds_read_b64_tr_b16 v[48:49], v16 offset:0
v_mfma_f32_16x16x32_bf16 v[132:135], v[84:87], v[64:67], v[132:135]
ds_read_b64_tr_b16 v[50:51], v16 offset:4096
ds_read_b64_tr_b16 v[52:53], v17 offset:0
v_mfma_f32_16x16x32_bf16 v[136:139], v[88:91], v[64:67], v[136:139]
ds_read_b64_tr_b16 v[54:55], v17 offset:4096
ds_read_b64_tr_b16 v[56:57], v16 offset:16384
s_add_u32 m0, s40, 49152
s_mov_b32 s38, 3211264
buffer_load_dwordx4 v3, s[12:15], s38 offen lds
v_mfma_f32_16x16x32_bf16 v[140:143], v[92:95], v[64:67], v[140:143]
ds_read_b64_tr_b16 v[58:59], v16 offset:20480
ds_read_b64_tr_b16 v[60:61], v17 offset:16384
v_mfma_f32_16x16x32_bf16 v[156:159], v[92:95], v[68:71], v[156:159]
ds_read_b64_tr_b16 v[62:63], v17 offset:20480
ds_read_b128 v[36:39], v9 offset:1024
s_add_u32 m0, s40, 50176
s_mov_b32 s38, 3211264
buffer_load_dwordx4 v4, s[12:15], s38 offen lds
v_mfma_f32_16x16x32_bf16 v[152:155], v[88:91], v[68:71], v[152:155]
ds_read_b128 v[40:43], v9 offset:2048
ds_read_b128 v[44:47], v9 offset:3072
v_mfma_f32_16x16x32_bf16 v[148:151], v[84:87], v[68:71], v[148:151]
s_add_u32 m0, s40, 51200
s_mov_b32 s38, 3268608
buffer_load_dwordx4 v3, s[12:15], s38 offen lds
v_mfma_f32_16x16x32_bf16 v[144:147], v[80:83], v[68:71], v[144:147]
v_mfma_f32_16x16x32_bf16 v[160:163], v[80:83], v[72:75], v[160:163]
s_add_u32 m0, s40, 52224
s_mov_b32 s38, 3268608
buffer_load_dwordx4 v4, s[12:15], s38 offen lds
v_mfma_f32_16x16x32_bf16 v[164:167], v[84:87], v[72:75], v[164:167]
v_mfma_f32_16x16x32_bf16 v[168:171], v[88:91], v[72:75], v[168:171]
s_add_u32 m0, s39, 49152
s_mov_b32 s37, 114688
buffer_load_dwordx4 v2, s[8:11], s37 offen sc1 lds
v_mfma_f32_16x16x32_bf16 v[172:175], v[92:95], v[72:75], v[172:175]
v_mfma_f32_16x16x32_bf16 v[188:191], v[92:95], v[76:79], v[188:191]
buffer_load_dwordx4 v2, s[8:11], s37 offen offset:1024 sc1 lds
v_mfma_f32_16x16x32_bf16 v[184:187], v[88:91], v[76:79], v[184:187]
v_mfma_f32_16x16x32_bf16 v[180:183], v[84:87], v[76:79], v[180:183]
s_mov_b32 s38, 5505024
buffer_load_dword v28, v27, s[12:15], s38 offen
v_mfma_f32_16x16x32_bf16 v[176:179], v[80:83], v[76:79], v[176:179]
s_waitcnt lgkmcnt(0)
v_mfma_f32_16x16x32_bf16 v[128:131], v[48:51], v[32:35], v[128:131]
ds_read_b128 v[64:67], v9 offset:8192
ds_read_b64_tr_b16 v[80:81], v16 offset:8192
v_mfma_f32_16x16x32_bf16 v[132:135], v[52:55], v[32:35], v[132:135]
ds_read_b64_tr_b16 v[82:83], v16 offset:12288
ds_read_b64_tr_b16 v[84:85], v17 offset:8192
v_mfma_f32_16x16x32_bf16 v[136:139], v[56:59], v[32:35], v[136:139]
ds_read_b64_tr_b16 v[86:87], v17 offset:12288
ds_read_b64_tr_b16 v[88:89], v16 offset:24576
v_mfma_f32_16x16x32_bf16 v[140:143], v[60:63], v[32:35], v[140:143]
ds_read_b64_tr_b16 v[90:91], v16 offset:28672
ds_read_b64_tr_b16 v[92:93], v17 offset:24576
v_mfma_f32_16x16x32_bf16 v[156:159], v[60:63], v[36:39], v[156:159]
ds_read_b64_tr_b16 v[94:95], v17 offset:28672
ds_read_b128 v[68:71], v9 offset:9216
v_mfma_f32_16x16x32_bf16 v[152:155], v[56:59], v[36:39], v[152:155]
ds_read_b128 v[72:75], v9 offset:10240
ds_read_b128 v[76:79], v9 offset:11264
v_mfma_f32_16x16x32_bf16 v[148:151], v[52:55], v[36:39], v[148:151]
v_mfma_f32_16x16x32_bf16 v[144:147], v[48:51], v[36:39], v[144:147]
v_mfma_f32_16x16x32_bf16 v[160:163], v[48:51], v[40:43], v[160:163]
v_mfma_f32_16x16x32_bf16 v[164:167], v[52:55], v[40:43], v[164:167]
v_mfma_f32_16x16x32_bf16 v[168:171], v[56:59], v[40:43], v[168:171]
v_mfma_f32_16x16x32_bf16 v[172:175], v[60:63], v[40:43], v[172:175]
v_mfma_f32_16x16x32_bf16 v[188:191], v[60:63], v[44:47], v[188:191]
v_mfma_f32_16x16x32_bf16 v[184:187], v[56:59], v[44:47], v[184:187]
v_mfma_f32_16x16x32_bf16 v[180:183], v[52:55], v[44:47], v[180:183]
v_mfma_f32_16x16x32_bf16 v[176:179], v[48:51], v[44:47], v[176:179]
s_waitcnt vmcnt(7) lgkmcnt(0)
s_barrier
v_mfma_f32_16x16x32_bf16 v[128:131], v[80:83], v[64:67], v[128:131]
ds_read_b128 v[32:35], v8 offset:0
ds_read_b64_tr_b16 v[48:49], v12 offset:0
v_mfma_f32_16x16x32_bf16 v[132:135], v[84:87], v[64:67], v[132:135]
ds_read_b64_tr_b16 v[50:51], v12 offset:4096
ds_read_b64_tr_b16 v[52:53], v13 offset:0
v_mfma_f32_16x16x32_bf16 v[136:139], v[88:91], v[64:67], v[136:139]
ds_read_b64_tr_b16 v[54:55], v13 offset:4096
ds_read_b64_tr_b16 v[56:57], v12 offset:16384
v_mfma_f32_16x16x32_bf16 v[140:143], v[92:95], v[64:67], v[140:143]
ds_read_b64_tr_b16 v[58:59], v12 offset:20480
ds_read_b64_tr_b16 v[60:61], v13 offset:16384
v_mfma_f32_16x16x32_bf16 v[156:159], v[92:95], v[68:71], v[156:159]
ds_read_b64_tr_b16 v[62:63], v13 offset:20480
ds_read_b128 v[36:39], v8 offset:1024
s_add_u32 m0, s40, 98304
s_mov_b32 s38, 3670016
buffer_load_dwordx4 v3, s[12:15], s38 offen lds
v_mfma_f32_16x16x32_bf16 v[152:155], v[88:91], v[68:71], v[152:155]
ds_read_b128 v[40:43], v8 offset:2048
ds_read_b128 v[44:47], v8 offset:3072
v_mfma_f32_16x16x32_bf16 v[148:151], v[84:87], v[68:71], v[148:151]
s_add_u32 m0, s40, 99328
s_mov_b32 s38, 3670016
buffer_load_dwordx4 v4, s[12:15], s38 offen lds
v_mfma_f32_16x16x32_bf16 v[144:147], v[80:83], v[68:71], v[144:147]
v_mfma_f32_16x16x32_bf16 v[160:163], v[80:83], v[72:75], v[160:163]
s_add_u32 m0, s40, 100352
s_mov_b32 s38, 3727360
buffer_load_dwordx4 v3, s[12:15], s38 offen lds
v_mfma_f32_16x16x32_bf16 v[164:167], v[84:87], v[72:75], v[164:167]
v_mfma_f32_16x16x32_bf16 v[168:171], v[88:91], v[72:75], v[168:171]
s_add_u32 m0, s40, 101376
s_mov_b32 s38, 3727360
buffer_load_dwordx4 v4, s[12:15], s38 offen lds
v_mfma_f32_16x16x32_bf16 v[172:175], v[92:95], v[72:75], v[172:175]
v_mfma_f32_16x16x32_bf16 v[188:191], v[92:95], v[76:79], v[188:191]
s_add_u32 m0, s39, 98304
s_mov_b32 s37, 131072
buffer_load_dwordx4 v2, s[8:11], s37 offen sc1 lds
v_mfma_f32_16x16x32_bf16 v[184:187], v[88:91], v[76:79], v[184:187]
v_mfma_f32_16x16x32_bf16 v[180:183], v[84:87], v[76:79], v[180:183]
buffer_load_dwordx4 v2, s[8:11], s37 offen offset:1024 sc1 lds
v_mfma_f32_16x16x32_bf16 v[176:179], v[80:83], v[76:79], v[176:179]
s_waitcnt lgkmcnt(0)
v_mfma_f32_16x16x32_bf16 v[128:131], v[48:51], v[32:35], v[128:131]
ds_read_b128 v[64:67], v8 offset:8192
ds_read_b64_tr_b16 v[80:81], v12 offset:8192
v_mfma_f32_16x16x32_bf16 v[132:135], v[52:55], v[32:35], v[132:135]
ds_read_b64_tr_b16 v[82:83], v12 offset:12288
ds_read_b64_tr_b16 v[84:85], v13 offset:8192
v_mfma_f32_16x16x32_bf16 v[136:139], v[56:59], v[32:35], v[136:139]
ds_read_b64_tr_b16 v[86:87], v13 offset:12288
ds_read_b64_tr_b16 v[88:89], v12 offset:24576
v_mfma_f32_16x16x32_bf16 v[140:143], v[60:63], v[32:35], v[140:143]
ds_read_b64_tr_b16 v[90:91], v12 offset:28672
ds_read_b64_tr_b16 v[92:93], v13 offset:24576
v_mfma_f32_16x16x32_bf16 v[156:159], v[60:63], v[36:39], v[156:159]
ds_read_b64_tr_b16 v[94:95], v13 offset:28672
ds_read_b128 v[68:71], v8 offset:9216
v_mfma_f32_16x16x32_bf16 v[152:155], v[56:59], v[36:39], v[152:155]
ds_read_b128 v[72:75], v8 offset:10240
ds_read_b128 v[76:79], v8 offset:11264
v_mfma_f32_16x16x32_bf16 v[148:151], v[52:55], v[36:39], v[148:151]
v_mfma_f32_16x16x32_bf16 v[144:147], v[48:51], v[36:39], v[144:147]
v_mfma_f32_16x16x32_bf16 v[160:163], v[48:51], v[40:43], v[160:163]
v_mfma_f32_16x16x32_bf16 v[164:167], v[52:55], v[40:43], v[164:167]
v_mfma_f32_16x16x32_bf16 v[168:171], v[56:59], v[40:43], v[168:171]
v_mfma_f32_16x16x32_bf16 v[172:175], v[60:63], v[40:43], v[172:175]
v_mfma_f32_16x16x32_bf16 v[188:191], v[60:63], v[44:47], v[188:191]
v_mfma_f32_16x16x32_bf16 v[184:187], v[56:59], v[44:47], v[184:187]
v_mfma_f32_16x16x32_bf16 v[180:183], v[52:55], v[44:47], v[180:183]
v_mfma_f32_16x16x32_bf16 v[176:179], v[48:51], v[44:47], v[176:179]
s_waitcnt vmcnt(7) lgkmcnt(0)
s_barrier
s_cmp_eq_u32 s36, 7
s_cbranch_scc0 Lw_49
v_mov_b32 v29, 8192
buffer_load_dword v30, v29, s[56:59], 0 offen sc1
Lw_49:
v_mfma_f32_16x16x32_bf16 v[128:131], v[80:83], v[64:67], v[128:131]
ds_read_b128 v[32:35], v8 offset:49152
ds_read_b64_tr_b16 v[48:49], v14 offset:0
v_mfma_f32_16x16x32_bf16 v[132:135], v[84:87], v[64:67], v[132:135]
ds_read_b64_tr_b16 v[50:51], v14 offset:4096
ds_read_b64_tr_b16 v[52:53], v15 offset:0
v_mfma_f32_16x16x32_bf16 v[136:139], v[88:91], v[64:67], v[136:139]
ds_read_b64_tr_b16 v[54:55], v15 offset:4096
ds_read_b64_tr_b16 v[56:57], v14 offset:16384
s_add_u32 m0, s40, 0
s_mov_b32 s38, 4128768
buffer_load_dwordx4 v3, s[12:15], s38 offen lds
v_mfma_f32_16x16x32_bf16 v[140:143], v[92:95], v[64:67], v[140:143]
ds_read_b64_tr_b16 v[58:59], v14 offset:20480
ds_read_b64_tr_b16 v[60:61], v15 offset:16384
v_mfma_f32_16x16x32_bf16 v[156:159], v[92:95], v[68:71], v[156:159]
ds_read_b64_tr_b16 v[62:63], v15 offset:20480
ds_read_b128 v[36:39], v8 offset:50176
s_add_u32 m0, s40, 1024
s_mov_b32 s38, 4128768
buffer_load_dwordx4 v4, s[12:15], s38 offen lds
v_mfma_f32_16x16x32_bf16 v[152:155], v[88:91], v[68:71], v[152:155]
ds_read_b128 v[40:43], v8 offset:51200
ds_read_b128 v[44:47], v8 offset:52224
v_mfma_f32_16x16x32_bf16 v[148:151], v[84:87], v[68:71], v[148:151]
s_add_u32 m0, s40, 2048
s_mov_b32 s38, 4186112
buffer_load_dwordx4 v3, s[12:15], s38 offen lds
v_mfma_f32_16x16x32_bf16 v[144:147], v[80:83], v[68:71], v[144:147]
v_mfma_f32_16x16x32_bf16 v[160:163], v[80:83], v[72:75], v[160:163]
s_add_u32 m0, s40, 3072
s_mov_b32 s38, 4186112
buffer_load_dwordx4 v4, s[12:15], s38 offen lds
v_mfma_f32_16x16x32_bf16 v[164:167], v[84:87], v[72:75], v[164:167]
v_mfma_f32_16x16x32_bf16 v[168:171], v[88:91], v[72:75], v[168:171]
s_add_u32 m0, s39, 0
s_mov_b32 s37, 147456
buffer_load_dwordx4 v2, s[8:11], s37 offen sc1 lds
v_mfma_f32_16x16x32_bf16 v[172:175], v[92:95], v[72:75], v[172:175]
v_mfma_f32_16x16x32_bf16 v[188:191], v[92:95], v[76:79], v[188:191]
buffer_load_dwordx4 v2, s[8:11], s37 offen offset:1024 sc1 lds
v_mfma_f32_16x16x32_bf16 v[184:187], v[88:91], v[76:79], v[184:187]
v_mfma_f32_16x16x32_bf16 v[180:183], v[84:87], v[76:79], v[180:183]
s_mov_b32 s38, 6422528
buffer_load_dword v28, v27, s[12:15], s38 offen
v_mfma_f32_16x16x32_bf16 v[176:179], v[80:83], v[76:79], v[176:179]
s_waitcnt lgkmcnt(0)
v_mfma_f32_16x16x32_bf16 v[128:131], v[48:51], v[32:35], v[128:131]
ds_read_b128 v[64:67], v8 offset:57344
ds_read_b64_tr_b16 v[80:81], v14 offset:8192
v_mfma_f32_16x16x32_bf16 v[132:135], v[52:55], v[32:35], v[132:135]
ds_read_b64_tr_b16 v[82:83], v14 offset:12288
ds_read_b64_tr_b16 v[84:85], v15 offset:8192
v_mfma_f32_16x16x32_bf16 v[136:139], v[56:59], v[32:35], v[136:139]
ds_read_b64_tr_b16 v[86:87], v15 offset:12288
ds_read_b64_tr_b16 v[88:89], v14 offset:24576
v_mfma_f32_16x16x32_bf16 v[140:143], v[60:63], v[32:35], v[140:143]
ds_read_b64_tr_b16 v[90:91], v14 offset:28672
ds_read_b64_tr_b16 v[92:93], v15 offset:24576
v_mfma_f32_16x16x32_bf16 v[156:159], v[60:63], v[36:39], v[156:159]
ds_read_b64_tr_b16 v[94:95], v15 offset:28672
ds_read_b128 v[68:71], v8 offset:58368
v_mfma_f32_16x16x32_bf16 v[152:155], v[56:59], v[36:39], v[152:155]
ds_read_b128 v[72:75], v8 offset:59392
ds_read_b128 v[76:79], v8 offset:60416
v_mfma_f32_16x16x32_bf16 v[148:151], v[52:55], v[36:39], v[148:151]
v_mfma_f32_16x16x32_bf16 v[144:147], v[48:51], v[36:39], v[144:147]
v_mfma_f32_16x16x32_bf16 v[160:163], v[48:51], v[40:43], v[160:163]
v_mfma_f32_16x16x32_bf16 v[164:167], v[52:55], v[40:43], v[164:167]
v_mfma_f32_16x16x32_bf16 v[168:171], v[56:59], v[40:43], v[168:171]
v_mfma_f32_16x16x32_bf16 v[172:175], v[60:63], v[40:43], v[172:175]
v_mfma_f32_16x16x32_bf16 v[188:191], v[60:63], v[44:47], v[188:191]
v_mfma_f32_16x16x32_bf16 v[184:187], v[56:59], v[44:47], v[184:187]
v_mfma_f32_16x16x32_bf16 v[180:183], v[52:55], v[44:47], v[180:183]
v_mfma_f32_16x16x32_bf16 v[176:179], v[48:51], v[44:47], v[176:179]
s_waitcnt vmcnt(7) lgkmcnt(0)
s_cmp_eq_u32 s36, 7
s_cbranch_scc0 Lw_50
s_waitcnt vmcnt(7)
s_mov_b32 s41, 0x40000
s_branch Lpchk_53
Lpoll_51:
buffer_load_dword v30, v29, s[56:59], 0 offen sc1
s_waitcnt vmcnt(0)
Lpchk_53:
v_readfirstlane_b32 s42, v30
s_cmp_eq_u32 s42, 224
s_cbranch_scc1 Lpok_52
s_sub_u32 s41, s41, 1
s_cmp_lg_u32 s41, 0
s_cbranch_scc1 Lpoll_51
Lpok_52:
s_add_u32 s84, s82, 27262976
s_addc_u32 s85, s83, 0
s_mov_b32 s86, 114688
s_mov_b32 s87, 0x20000
v_min_u32 v29, 55, v1
v_cmp_gt_u32 vcc, 32, v29
s_lshl_b32 s43, s35, 9
s_mul_i32 s44, s35, 384
s_add_u32 s44, s44, 7680
v_mov_b32 v30, s44
v_mov_b32 v126, s43
v_cndmask_b32 v30, v30, v126, vcc
v_lshl_add_u32 v30, v29, 4, v30
s_mov_b32 s43, 0
buffer_load_dwordx4 v[96:99], v30, s[84:87], s43 offen sc1
s_mov_b32 s43, 14336
buffer_load_dwordx4 v[100:103], v30, s[84:87], s43 offen sc1
s_mov_b32 s43, 28672
buffer_load_dwordx4 v[104:107], v30, s[84:87], s43 offen sc1
s_mov_b32 s43, 43008
buffer_load_dwordx4 v[108:111], v30, s[84:87], s43 offen sc1
s_mov_b32 s43, 57344
buffer_load_dwordx4 v[112:115], v30, s[84:87], s43 offen sc1
s_mov_b32 s43, 71680
buffer_load_dwordx4 v[116:119], v30, s[84:87], s43 offen sc1
s_mov_b32 s43, 86016
buffer_load_dwordx4 v[120:123], v30, s[84:87], s43 offen sc1
s_mov_b32 s43, 100352
buffer_load_dwordx4 v[124:127], v30, s[84:87], s43 offen sc1
Lw_50:
s_barrier
v_mfma_f32_16x16x32_bf16 v[128:131], v[80:83], v[64:67], v[128:131]
ds_read_b128 v[32:35], v9 offset:0
ds_read_b64_tr_b16 v[48:49], v16 offset:0
v_mfma_f32_16x16x32_bf16 v[132:135], v[84:87], v[64:67], v[132:135]
ds_read_b64_tr_b16 v[50:51], v16 offset:4096
ds_read_b64_tr_b16 v[52:53], v17 offset:0
v_mfma_f32_16x16x32_bf16 v[136:139], v[88:91], v[64:67], v[136:139]
ds_read_b64_tr_b16 v[54:55], v17 offset:4096
ds_read_b64_tr_b16 v[56:57], v16 offset:16384
v_mfma_f32_16x16x32_bf16 v[140:143], v[92:95], v[64:67], v[140:143]
ds_read_b64_tr_b16 v[58:59], v16 offset:20480
ds_read_b64_tr_b16 v[60:61], v17 offset:16384
v_mfma_f32_16x16x32_bf16 v[156:159], v[92:95], v[68:71], v[156:159]
ds_read_b64_tr_b16 v[62:63], v17 offset:20480
ds_read_b128 v[36:39], v9 offset:1024
s_add_u32 m0, s40, 49152
s_mov_b32 s38, 4587520
buffer_load_dwordx4 v3, s[12:15], s38 offen lds
v_mfma_f32_16x16x32_bf16 v[152:155], v[88:91], v[68:71], v[152:155]
ds_read_b128 v[40:43], v9 offset:2048
ds_read_b128 v[44:47], v9 offset:3072
v_mfma_f32_16x16x32_bf16 v[148:151], v[84:87], v[68:71], v[148:151]
s_add_u32 m0, s40, 50176
s_mov_b32 s38, 4587520
buffer_load_dwordx4 v4, s[12:15], s38 offen lds
v_mfma_f32_16x16x32_bf16 v[144:147], v[80:83], v[68:71], v[144:147]
v_mfma_f32_16x16x32_bf16 v[160:163], v[80:83], v[72:75], v[160:163]
s_add_u32 m0, s40, 51200
s_mov_b32 s38, 4644864
buffer_load_dwordx4 v3, s[12:15], s38 offen lds
v_mfma_f32_16x16x32_bf16 v[164:167], v[84:87], v[72:75], v[164:167]
v_mfma_f32_16x16x32_bf16 v[168:171], v[88:91], v[72:75], v[168:171]
s_add_u32 m0, s40, 52224
s_mov_b32 s38, 4644864
buffer_load_dwordx4 v4, s[12:15], s38 offen lds
v_mfma_f32_16x16x32_bf16 v[172:175], v[92:95], v[72:75], v[172:175]
v_mfma_f32_16x16x32_bf16 v[188:191], v[92:95], v[76:79], v[188:191]
s_add_u32 m0, s39, 49152
s_mov_b32 s37, 163840
buffer_load_dwordx4 v2, s[8:11], s37 offen sc1 lds
v_mfma_f32_16x16x32_bf16 v[184:187], v[88:91], v[76:79], v[184:187]
v_mfma_f32_16x16x32_bf16 v[180:183], v[84:87], v[76:79], v[180:183]
buffer_load_dwordx4 v2, s[8:11], s37 offen offset:1024 sc1 lds
v_mfma_f32_16x16x32_bf16 v[176:179], v[80:83], v[76:79], v[176:179]
s_waitcnt lgkmcnt(0)
v_mfma_f32_16x16x32_bf16 v[128:131], v[48:51], v[32:35], v[128:131]
ds_read_b128 v[64:67], v9 offset:8192
ds_read_b64_tr_b16 v[80:81], v16 offset:8192
v_mfma_f32_16x16x32_bf16 v[132:135], v[52:55], v[32:35], v[132:135]
ds_read_b64_tr_b16 v[82:83], v16 offset:12288
ds_read_b64_tr_b16 v[84:85], v17 offset:8192
v_mfma_f32_16x16x32_bf16 v[136:139], v[56:59], v[32:35], v[136:139]
ds_read_b64_tr_b16 v[86:87], v17 offset:12288
ds_read_b64_tr_b16 v[88:89], v16 offset:24576
v_mfma_f32_16x16x32_bf16 v[140:143], v[60:63], v[32:35], v[140:143]
ds_read_b64_tr_b16 v[90:91], v16 offset:28672
ds_read_b64_tr_b16 v[92:93], v17 offset:24576
v_mfma_f32_16x16x32_bf16 v[156:159], v[60:63], v[36:39], v[156:159]
ds_read_b64_tr_b16 v[94:95], v17 offset:28672
ds_read_b128 v[68:71], v9 offset:9216
v_mfma_f32_16x16x32_bf16 v[152:155], v[56:59], v[36:39], v[152:155]
ds_read_b128 v[72:75], v9 offset:10240
ds_read_b128 v[76:79], v9 offset:11264
v_mfma_f32_16x16x32_bf16 v[148:151], v[52:55], v[36:39], v[148:151]
v_mfma_f32_16x16x32_bf16 v[144:147], v[48:51], v[36:39], v[144:147]
v_mfma_f32_16x16x32_bf16 v[160:163], v[48:51], v[40:43], v[160:163]
v_mfma_f32_16x16x32_bf16 v[164:167], v[52:55], v[40:43], v[164:167]
v_mfma_f32_16x16x32_bf16 v[168:171], v[56:59], v[40:43], v[168:171]
v_mfma_f32_16x16x32_bf16 v[172:175], v[60:63], v[40:43], v[172:175]
v_mfma_f32_16x16x32_bf16 v[188:191], v[60:63], v[44:47], v[188:191]
v_mfma_f32_16x16x32_bf16 v[184:187], v[56:59], v[44:47], v[184:187]
v_mfma_f32_16x16x32_bf16 v[180:183], v[52:55], v[44:47], v[180:183]
v_mfma_f32_16x16x32_bf16 v[176:179], v[48:51], v[44:47], v[176:179]
s_waitcnt vmcnt(7) lgkmcnt(0)
s_barrier
v_mfma_f32_16x16x32_bf16 v[128:131], v[80:83], v[64:67], v[128:131]
ds_read_b128 v[32:35], v8 offset:0
ds_read_b64_tr_b16 v[48:49], v12 offset:0
v_mfma_f32_16x16x32_bf16 v[132:135], v[84:87], v[64:67], v[132:135]
ds_read_b64_tr_b16 v[50:51], v12 offset:4096
ds_read_b64_tr_b16 v[52:53], v13 offset:0
v_mfma_f32_16x16x32_bf16 v[136:139], v[88:91], v[64:67], v[136:139]
ds_read_b64_tr_b16 v[54:55], v13 offset:4096
ds_read_b64_tr_b16 v[56:57], v12 offset:16384
s_add_u32 m0, s40, 98304
s_mov_b32 s38, 5046272
buffer_load_dwordx4 v3, s[12:15], s38 offen lds
v_mfma_f32_16x16x32_bf16 v[140:143], v[92:95], v[64:67], v[140:143]
ds_read_b64_tr_b16 v[58:59], v12 offset:20480
ds_read_b64_tr_b16 v[60:61], v13 offset:16384
v_mfma_f32_16x16x32_bf16 v[156:159], v[92:95], v[68:71], v[156:159]
ds_read_b64_tr_b16 v[62:63], v13 offset:20480
ds_read_b128 v[36:39], v8 offset:1024
s_add_u32 m0, s40, 99328
s_mov_b32 s38, 5046272
buffer_load_dwordx4 v4, s[12:15], s38 offen lds
v_mfma_f32_16x16x32_bf16 v[152:155], v[88:91], v[68:71], v[152:155]
ds_read_b128 v[40:43], v8 offset:2048
ds_read_b128 v[44:47], v8 offset:3072
v_mfma_f32_16x16x32_bf16 v[148:151], v[84:87], v[68:71], v[148:151]
s_add_u32 m0, s40, 100352
s_mov_b32 s38, 5103616
buffer_load_dwordx4 v3, s[12:15], s38 offen lds
v_mfma_f32_16x16x32_bf16 v[144:147], v[80:83], v[68:71], v[144:147]
v_mfma_f32_16x16x32_bf16 v[160:163], v[80:83], v[72:75], v[160:163]
s_add_u32 m0, s40, 101376
s_mov_b32 s38, 5103616
buffer_load_dwordx4 v4, s[12:15], s38 offen lds
v_mfma_f32_16x16x32_bf16 v[164:167], v[84:87], v[72:75], v[164:167]
v_mfma_f32_16x16x32_bf16 v[168:171], v[88:91], v[72:75], v[168:171]
s_add_u32 m0, s39, 98304
s_mov_b32 s37, 180224
buffer_load_dwordx4 v2, s[8:11], s37 offen sc1 lds
v_mfma_f32_16x16x32_bf16 v[172:175], v[92:95], v[72:75], v[172:175]
v_mfma_f32_16x16x32_bf16 v[188:191], v[92:95], v[76:79], v[188:191]
buffer_load_dwordx4 v2, s[8:11], s37 offen offset:1024 sc1 lds
v_mfma_f32_16x16x32_bf16 v[184:187], v[88:91], v[76:79], v[184:187]
v_mfma_f32_16x16x32_bf16 v[180:183], v[84:87], v[76:79], v[180:183]
s_mov_b32 s38, 0
buffer_load_dword v28, v27, s[16:19], s38 offen
v_mfma_f32_16x16x32_bf16 v[176:179], v[80:83], v[76:79], v[176:179]
s_waitcnt lgkmcnt(0)
v_mfma_f32_16x16x32_bf16 v[128:131], v[48:51], v[32:35], v[128:131]
ds_read_b128 v[64:67], v8 offset:8192
ds_read_b64_tr_b16 v[80:81], v12 offset:8192
v_mfma_f32_16x16x32_bf16 v[132:135], v[52:55], v[32:35], v[132:135]
ds_read_b64_tr_b16 v[82:83], v12 offset:12288
ds_read_b64_tr_b16 v[84:85], v13 offset:8192
v_mfma_f32_16x16x32_bf16 v[136:139], v[56:59], v[32:35], v[136:139]
ds_read_b64_tr_b16 v[86:87], v13 offset:12288
ds_read_b64_tr_b16 v[88:89], v12 offset:24576
v_mfma_f32_16x16x32_bf16 v[140:143], v[60:63], v[32:35], v[140:143]
ds_read_b64_tr_b16 v[90:91], v12 offset:28672
ds_read_b64_tr_b16 v[92:93], v13 offset:24576
v_mfma_f32_16x16x32_bf16 v[156:159], v[60:63], v[36:39], v[156:159]
ds_read_b64_tr_b16 v[94:95], v13 offset:28672
ds_read_b128 v[68:71], v8 offset:9216
v_mfma_f32_16x16x32_bf16 v[152:155], v[56:59], v[36:39], v[152:155]
ds_read_b128 v[72:75], v8 offset:10240
ds_read_b128 v[76:79], v8 offset:11264
v_mfma_f32_16x16x32_bf16 v[148:151], v[52:55], v[36:39], v[148:151]
v_mfma_f32_16x16x32_bf16 v[144:147], v[48:51], v[36:39], v[144:147]
v_mfma_f32_16x16x32_bf16 v[160:163], v[48:51], v[40:43], v[160:163]
v_mfma_f32_16x16x32_bf16 v[164:167], v[52:55], v[40:43], v[164:167]
v_mfma_f32_16x16x32_bf16 v[168:171], v[56:59], v[40:43], v[168:171]
v_mfma_f32_16x16x32_bf16 v[172:175], v[60:63], v[40:43], v[172:175]
v_mfma_f32_16x16x32_bf16 v[188:191], v[60:63], v[44:47], v[188:191]
v_mfma_f32_16x16x32_bf16 v[184:187], v[56:59], v[44:47], v[184:187]
v_mfma_f32_16x16x32_bf16 v[180:183], v[52:55], v[44:47], v[180:183]
v_mfma_f32_16x16x32_bf16 v[176:179], v[48:51], v[44:47], v[176:179]
s_waitcnt vmcnt(7) lgkmcnt(0)
s_cmp_eq_u32 s36, 7
s_cbranch_scc0 Lw_54
v_pk_add_f32 v[96:97], v[96:97], v[104:105]
v_pk_add_f32 v[112:113], v[112:113], v[120:121]
v_pk_add_f32 v[98:99], v[98:99], v[106:107]
v_pk_add_f32 v[114:115], v[114:115], v[122:123]
v_pk_add_f32 v[96:97], v[96:97], v[112:113]
v_pk_add_f32 v[98:99], v[98:99], v[114:115]
v_pk_add_f32 v[100:101], v[100:101], v[108:109]
v_pk_add_f32 v[116:117], v[116:117], v[124:125]
v_pk_add_f32 v[102:103], v[102:103], v[110:111]
v_pk_add_f32 v[118:119], v[118:119], v[126:127]
v_pk_add_f32 v[100:101], v[100:101], v[116:117]
v_pk_add_f32 v[102:103], v[102:103], v[118:119]
v_lshlrev_b32 v29, 4, v29
v_add_u32 v29, 148480, v29
ds_write_b128 v29, v[96:99]
ds_write_b128 v29, v[100:103] offset:896
s_waitcnt lgkmcnt(0)
Lw_54:
s_barrier
v_mfma_f32_16x16x32_bf16 v[128:131], v[80:83], v[64:67], v[128:131]
ds_read_b128 v[32:35], v8 offset:49152
ds_read_b64_tr_b16 v[48:49], v14 offset:0
v_mfma_f32_16x16x32_bf16 v[132:135], v[84:87], v[64:67], v[132:135]
ds_read_b64_tr_b16 v[50:51], v14 offset:4096
ds_read_b64_tr_b16 v[52:53], v15 offset:0
v_mfma_f32_16x16x32_bf16 v[136:139], v[88:91], v[64:67], v[136:139]
ds_read_b64_tr_b16 v[54:55], v15 offset:4096
ds_read_b64_tr_b16 v[56:57], v14 offset:16384
v_mfma_f32_16x16x32_bf16 v[140:143], v[92:95], v[64:67], v[140:143]
ds_read_b64_tr_b16 v[58:59], v14 offset:20480
ds_read_b64_tr_b16 v[60:61], v15 offset:16384
v_mfma_f32_16x16x32_bf16 v[156:159], v[92:95], v[68:71], v[156:159]
ds_read_b64_tr_b16 v[62:63], v15 offset:20480
ds_read_b128 v[36:39], v8 offset:50176
s_add_u32 m0, s40, 0
s_mov_b32 s38, 5505024
buffer_load_dwordx4 v3, s[12:15], s38 offen lds
v_mfma_f32_16x16x32_bf16 v[152:155], v[88:91], v[68:71], v[152:155]
ds_read_b128 v[40:43], v8 offset:51200
ds_read_b128 v[44:47], v8 offset:52224
v_mfma_f32_16x16x32_bf16 v[148:151], v[84:87], v[68:71], v[148:151]
s_add_u32 m0, s40, 1024
s_mov_b32 s38, 5505024
buffer_load_dwordx4 v4, s[12:15], s38 offen lds
v_mfma_f32_16x16x32_bf16 v[144:147], v[80:83], v[68:71], v[144:147]
v_mfma_f32_16x16x32_bf16 v[160:163], v[80:83], v[72:75], v[160:163]
s_add_u32 m0, s40, 2048
s_mov_b32 s38, 5562368
buffer_load_dwordx4 v3, s[12:15], s38 offen lds
v_mfma_f32_16x16x32_bf16 v[164:167], v[84:87], v[72:75], v[164:167]
v_mfma_f32_16x16x32_bf16 v[168:171], v[88:91], v[72:75], v[168:171]
s_add_u32 m0, s40, 3072
s_mov_b32 s38, 5562368
buffer_load_dwordx4 v4, s[12:15], s38 offen lds
v_mfma_f32_16x16x32_bf16 v[172:175], v[92:95], v[72:75], v[172:175]
v_mfma_f32_16x16x32_bf16 v[188:191], v[92:95], v[76:79], v[188:191]
s_add_u32 m0, s39, 0
s_mov_b32 s37, 196608
buffer_load_dwordx4 v2, s[8:11], s37 offen sc1 lds
v_mfma_f32_16x16x32_bf16 v[184:187], v[88:91], v[76:79], v[184:187]
v_mfma_f32_16x16x32_bf16 v[180:183], v[84:87], v[76:79], v[180:183]
buffer_load_dwordx4 v2, s[8:11], s37 offen offset:1024 sc1 lds
v_mfma_f32_16x16x32_bf16 v[176:179], v[80:83], v[76:79], v[176:179]
s_waitcnt lgkmcnt(0)
v_mfma_f32_16x16x32_bf16 v[128:131], v[48:51], v[32:35], v[128:131]
ds_read_b128 v[64:67], v8 offset:57344
ds_read_b64_tr_b16 v[80:81], v14 offset:8192
v_mfma_f32_16x16x32_bf16 v[132:135], v[52:55], v[32:35], v[132:135]
ds_read_b64_tr_b16 v[82:83], v14 offset:12288
ds_read_b64_tr_b16 v[84:85], v15 offset:8192
v_mfma_f32_16x16x32_bf16 v[136:139], v[56:59], v[32:35], v[136:139]
ds_read_b64_tr_b16 v[86:87], v15 offset:12288
ds_read_b64_tr_b16 v[88:89], v14 offset:24576
v_mfma_f32_16x16x32_bf16 v[140:143], v[60:63], v[32:35], v[140:143]
ds_read_b64_tr_b16 v[90:91], v14 offset:28672
ds_read_b64_tr_b16 v[92:93], v15 offset:24576
v_mfma_f32_16x16x32_bf16 v[156:159], v[60:63], v[36:39], v[156:159]
ds_read_b64_tr_b16 v[94:95], v15 offset:28672
ds_read_b128 v[68:71], v8 offset:58368
v_mfma_f32_16x16x32_bf16 v[152:155], v[56:59], v[36:39], v[152:155]
ds_read_b128 v[72:75], v8 offset:59392
ds_read_b128 v[76:79], v8 offset:60416
v_mfma_f32_16x16x32_bf16 v[148:151], v[52:55], v[36:39], v[148:151]
v_mfma_f32_16x16x32_bf16 v[144:147], v[48:51], v[36:39], v[144:147]
v_mfma_f32_16x16x32_bf16 v[160:163], v[48:51], v[40:43], v[160:163]
v_mfma_f32_16x16x32_bf16 v[164:167], v[52:55], v[40:43], v[164:167]
v_mfma_f32_16x16x32_bf16 v[168:171], v[56:59], v[40:43], v[168:171]
v_mfma_f32_16x16x32_bf16 v[172:175], v[60:63], v[40:43], v[172:175]
v_mfma_f32_16x16x32_bf16 v[188:191], v[60:63], v[44:47], v[188:191]
v_mfma_f32_16x16x32_bf16 v[184:187], v[56:59], v[44:47], v[184:187]
v_mfma_f32_16x16x32_bf16 v[180:183], v[52:55], v[44:47], v[180:183]
v_mfma_f32_16x16x32_bf16 v[176:179], v[48:51], v[44:47], v[176:179]
s_waitcnt vmcnt(7) lgkmcnt(0)
s_barrier
v_mfma_f32_16x16x32_bf16 v[128:131], v[80:83], v[64:67], v[128:131]
ds_read_b128 v[32:35], v9 offset:0
ds_read_b64_tr_b16 v[48:49], v16 offset:0
v_mfma_f32_16x16x32_bf16 v[132:135], v[84:87], v[64:67], v[132:135]
ds_read_b64_tr_b16 v[50:51], v16 offset:4096
ds_read_b64_tr_b16 v[52:53], v17 offset:0
v_mfma_f32_16x16x32_bf16 v[136:139], v[88:91], v[64:67], v[136:139]
ds_read_b64_tr_b16 v[54:55], v17 offset:4096
ds_read_b64_tr_b16 v[56:57], v16 offset:16384
s_add_u32 m0, s40, 49152
s_mov_b32 s38, 5963776
buffer_load_dwordx4 v3, s[12:15], s38 offen lds
v_mfma_f32_16x16x32_bf16 v[140:143], v[92:95], v[64:67], v[140:143]
ds_read_b64_tr_b16 v[58:59], v16 offset:20480
ds_read_b64_tr_b16 v[60:61], v17 offset:16384
v_mfma_f32_16x16x32_bf16 v[156:159], v[92:95], v[68:71], v[156:159]
ds_read_b64_tr_b16 v[62:63], v17 offset:20480
ds_read_b128 v[36:39], v9 offset:1024
s_add_u32 m0, s40, 50176
s_mov_b32 s38, 5963776
buffer_load_dwordx4 v4, s[12:15], s38 offen lds
v_mfma_f32_16x16x32_bf16 v[152:155], v[88:91], v[68:71], v[152:155]
ds_read_b128 v[40:43], v9 offset:2048
ds_read_b128 v[44:47], v9 offset:3072
v_mfma_f32_16x16x32_bf16 v[148:151], v[84:87], v[68:71], v[148:151]
s_add_u32 m0, s40, 51200
s_mov_b32 s38, 6021120
buffer_load_dwordx4 v3, s[12:15], s38 offen lds
v_mfma_f32_16x16x32_bf16 v[144:147], v[80:83], v[68:71], v[144:147]
v_mfma_f32_16x16x32_bf16 v[160:163], v[80:83], v[72:75], v[160:163]
s_add_u32 m0, s40, 52224
s_mov_b32 s38, 6021120
buffer_load_dwordx4 v4, s[12:15], s38 offen lds
v_mfma_f32_16x16x32_bf16 v[164:167], v[84:87], v[72:75], v[164:167]
v_mfma_f32_16x16x32_bf16 v[168:171], v[88:91], v[72:75], v[168:171]
s_add_u32 m0, s39, 49152
s_mov_b32 s37, 212992
buffer_load_dwordx4 v2, s[8:11], s37 offen sc1 lds
v_mfma_f32_16x16x32_bf16 v[172:175], v[92:95], v[72:75], v[172:175]
v_mfma_f32_16x16x32_bf16 v[188:191], v[92:95], v[76:79], v[188:191]
buffer_load_dwordx4 v2, s[8:11], s37 offen offset:1024 sc1 lds
v_mfma_f32_16x16x32_bf16 v[184:187], v[88:91], v[76:79], v[184:187]
v_mfma_f32_16x16x32_bf16 v[180:183], v[84:87], v[76:79], v[180:183]
s_mov_b32 s38, 917504
buffer_load_dword v28, v27, s[16:19], s38 offen
v_mfma_f32_16x16x32_bf16 v[176:179], v[80:83], v[76:79], v[176:179]
s_waitcnt lgkmcnt(0)
v_mfma_f32_16x16x32_bf16 v[128:131], v[48:51], v[32:35], v[128:131]
ds_read_b128 v[64:67], v9 offset:8192
ds_read_b64_tr_b16 v[80:81], v16 offset:8192
v_mfma_f32_16x16x32_bf16 v[132:135], v[52:55], v[32:35], v[132:135]
ds_read_b64_tr_b16 v[82:83], v16 offset:12288
ds_read_b64_tr_b16 v[84:85], v17 offset:8192
v_mfma_f32_16x16x32_bf16 v[136:139], v[56:59], v[32:35], v[136:139]
ds_read_b64_tr_b16 v[86:87], v17 offset:12288
ds_read_b64_tr_b16 v[88:89], v16 offset:24576
v_mfma_f32_16x16x32_bf16 v[140:143], v[60:63], v[32:35], v[140:143]
ds_read_b64_tr_b16 v[90:91], v16 offset:28672
ds_read_b64_tr_b16 v[92:93], v17 offset:24576
v_mfma_f32_16x16x32_bf16 v[156:159], v[60:63], v[36:39], v[156:159]
ds_read_b64_tr_b16 v[94:95], v17 offset:28672
ds_read_b128 v[68:71], v9 offset:9216
v_mfma_f32_16x16x32_bf16 v[152:155], v[56:59], v[36:39], v[152:155]
ds_read_b128 v[72:75], v9 offset:10240
ds_read_b128 v[76:79], v9 offset:11264
v_mfma_f32_16x16x32_bf16 v[148:151], v[52:55], v[36:39], v[148:151]
v_mfma_f32_16x16x32_bf16 v[144:147], v[48:51], v[36:39], v[144:147]
v_mfma_f32_16x16x32_bf16 v[160:163], v[48:51], v[40:43], v[160:163]
v_mfma_f32_16x16x32_bf16 v[164:167], v[52:55], v[40:43], v[164:167]
v_mfma_f32_16x16x32_bf16 v[168:171], v[56:59], v[40:43], v[168:171]
v_mfma_f32_16x16x32_bf16 v[172:175], v[60:63], v[40:43], v[172:175]
v_mfma_f32_16x16x32_bf16 v[188:191], v[60:63], v[44:47], v[188:191]
v_mfma_f32_16x16x32_bf16 v[184:187], v[56:59], v[44:47], v[184:187]
v_mfma_f32_16x16x32_bf16 v[180:183], v[52:55], v[44:47], v[180:183]
v_mfma_f32_16x16x32_bf16 v[176:179], v[48:51], v[44:47], v[176:179]
s_waitcnt vmcnt(7) lgkmcnt(0)
s_barrier
v_mfma_f32_16x16x32_bf16 v[128:131], v[80:83], v[64:67], v[128:131]
ds_read_b128 v[32:35], v8 offset:0
ds_read_b64_tr_b16 v[48:49], v12 offset:0
v_mfma_f32_16x16x32_bf16 v[132:135], v[84:87], v[64:67], v[132:135]
ds_read_b64_tr_b16 v[50:51], v12 offset:4096
ds_read_b64_tr_b16 v[52:53], v13 offset:0
v_mfma_f32_16x16x32_bf16 v[136:139], v[88:91], v[64:67], v[136:139]
ds_read_b64_tr_b16 v[54:55], v13 offset:4096
ds_read_b64_tr_b16 v[56:57], v12 offset:16384
v_mfma_f32_16x16x32_bf16 v[140:143], v[92:95], v[64:67], v[140:143]
ds_read_b64_tr_b16 v[58:59], v12 offset:20480
ds_read_b64_tr_b16 v[60:61], v13 offset:16384
v_mfma_f32_16x16x32_bf16 v[156:159], v[92:95], v[68:71], v[156:159]
ds_read_b64_tr_b16 v[62:63], v13 offset:20480
ds_read_b128 v[36:39], v8 offset:1024
s_add_u32 m0, s40, 98304
s_mov_b32 s38, 6422528
buffer_load_dwordx4 v3, s[12:15], s38 offen lds
v_mfma_f32_16x16x32_bf16 v[152:155], v[88:91], v[68:71], v[152:155]
ds_read_b128 v[40:43], v8 offset:2048
ds_read_b128 v[44:47], v8 offset:3072
v_mfma_f32_16x16x32_bf16 v[148:151], v[84:87], v[68:71], v[148:151]
s_add_u32 m0, s40, 99328
s_mov_b32 s38, 6422528
buffer_load_dwordx4 v4, s[12:15], s38 offen lds
v_mfma_f32_16x16x32_bf16 v[144:147], v[80:83], v[68:71], v[144:147]
v_mfma_f32_16x16x32_bf16 v[160:163], v[80:83], v[72:75], v[160:163]
s_add_u32 m0, s40, 100352
s_mov_b32 s38, 6479872
buffer_load_dwordx4 v3, s[12:15], s38 offen lds
v_mfma_f32_16x16x32_bf16 v[164:167], v[84:87], v[72:75], v[164:167]
v_mfma_f32_16x16x32_bf16 v[168:171], v[88:91], v[72:75], v[168:171]
s_add_u32 m0, s40, 101376
s_mov_b32 s38, 6479872
buffer_load_dwordx4 v4, s[12:15], s38 offen lds
v_mfma_f32_16x16x32_bf16 v[172:175], v[92:95], v[72:75], v[172:175]
v_mfma_f32_16x16x32_bf16 v[188:191], v[92:95], v[76:79], v[188:191]
s_add_u32 m0, s39, 98304
s_mov_b32 s37, 229376
buffer_load_dwordx4 v2, s[8:11], s37 offen sc1 lds
v_mfma_f32_16x16x32_bf16 v[184:187], v[88:91], v[76:79], v[184:187]
v_mfma_f32_16x16x32_bf16 v[180:183], v[84:87], v[76:79], v[180:183]
buffer_load_dwordx4 v2, s[8:11], s37 offen offset:1024 sc1 lds
v_mfma_f32_16x16x32_bf16 v[176:179], v[80:83], v[76:79], v[176:179]
s_waitcnt lgkmcnt(0)
v_mfma_f32_16x16x32_bf16 v[128:131], v[48:51], v[32:35], v[128:131]
ds_read_b128 v[64:67], v8 offset:8192
ds_read_b64_tr_b16 v[80:81], v12 offset:8192
v_mfma_f32_16x16x32_bf16 v[132:135], v[52:55], v[32:35], v[132:135]
ds_read_b64_tr_b16 v[82:83], v12 offset:12288
ds_read_b64_tr_b16 v[84:85], v13 offset:8192
v_mfma_f32_16x16x32_bf16 v[136:139], v[56:59], v[32:35], v[136:139]
ds_read_b64_tr_b16 v[86:87], v13 offset:12288
ds_read_b64_tr_b16 v[88:89], v12 offset:24576
v_mfma_f32_16x16x32_bf16 v[140:143], v[60:63], v[32:35], v[140:143]
ds_read_b64_tr_b16 v[90:91], v12 offset:28672
ds_read_b64_tr_b16 v[92:93], v13 offset:24576
v_mfma_f32_16x16x32_bf16 v[156:159], v[60:63], v[36:39], v[156:159]
ds_read_b64_tr_b16 v[94:95], v13 offset:28672
ds_read_b128 v[68:71], v8 offset:9216
v_mfma_f32_16x16x32_bf16 v[152:155], v[56:59], v[36:39], v[152:155]
ds_read_b128 v[72:75], v8 offset:10240
ds_read_b128 v[76:79], v8 offset:11264
v_mfma_f32_16x16x32_bf16 v[148:151], v[52:55], v[36:39], v[148:151]
v_mfma_f32_16x16x32_bf16 v[144:147], v[48:51], v[36:39], v[144:147]
v_mfma_f32_16x16x32_bf16 v[160:163], v[48:51], v[40:43], v[160:163]
v_mfma_f32_16x16x32_bf16 v[164:167], v[52:55], v[40:43], v[164:167]
v_mfma_f32_16x16x32_bf16 v[168:171], v[56:59], v[40:43], v[168:171]
v_mfma_f32_16x16x32_bf16 v[172:175], v[60:63], v[40:43], v[172:175]
v_mfma_f32_16x16x32_bf16 v[188:191], v[60:63], v[44:47], v[188:191]
v_mfma_f32_16x16x32_bf16 v[184:187], v[56:59], v[44:47], v[184:187]
v_mfma_f32_16x16x32_bf16 v[180:183], v[52:55], v[44:47], v[180:183]
v_mfma_f32_16x16x32_bf16 v[176:179], v[48:51], v[44:47], v[176:179]
s_waitcnt vmcnt(7) lgkmcnt(0)
s_barrier
v_mfma_f32_16x16x32_bf16 v[128:131], v[80:83], v[64:67], v[128:131]
ds_read_b128 v[32:35], v8 offset:49152
ds_read_b64_tr_b16 v[48:49], v14 offset:0
v_mfma_f32_16x16x32_bf16 v[132:135], v[84:87], v[64:67], v[132:135]
ds_read_b64_tr_b16 v[50:51], v14 offset:4096
ds_read_b64_tr_b16 v[52:53], v15 offset:0
v_mfma_f32_16x16x32_bf16 v[136:139], v[88:91], v[64:67], v[136:139]
ds_read_b64_tr_b16 v[54:55], v15 offset:4096
ds_read_b64_tr_b16 v[56:57], v14 offset:16384
s_add_u32 m0, s40, 0
s_mov_b32 s38, 6881280
buffer_load_dwordx4 v3, s[12:15], s38 offen lds
v_mfma_f32_16x16x32_bf16 v[140:143], v[92:95], v[64:67], v[140:143]
ds_read_b64_tr_b16 v[58:59], v14 offset:20480
ds_read_b64_tr_b16 v[60:61], v15 offset:16384
v_mfma_f32_16x16x32_bf16 v[156:159], v[92:95], v[68:71], v[156:159]
ds_read_b64_tr_b16 v[62:63], v15 offset:20480
ds_read_b128 v[36:39], v8 offset:50176
s_add_u32 m0, s40, 1024
s_mov_b32 s38, 6881280
buffer_load_dwordx4 v4, s[12:15], s38 offen lds
v_mfma_f32_16x16x32_bf16 v[152:155], v[88:91], v[68:71], v[152:155]
ds_read_b128 v[40:43], v8 offset:51200
ds_read_b128 v[44:47], v8 offset:52224
v_mfma_f32_16x16x32_bf16 v[148:151], v[84:87], v[68:71], v[148:151]
s_add_u32 m0, s40, 2048
s_mov_b32 s38, 6938624
buffer_load_dwordx4 v3, s[12:15], s38 offen lds
v_mfma_f32_16x16x32_bf16 v[144:147], v[80:83], v[68:71], v[144:147]
v_mfma_f32_16x16x32_bf16 v[160:163], v[80:83], v[72:75], v[160:163]
s_add_u32 m0, s40, 3072
s_mov_b32 s38, 6938624
buffer_load_dwordx4 v4, s[12:15], s38 offen lds
v_mfma_f32_16x16x32_bf16 v[164:167], v[84:87], v[72:75], v[164:167]
v_mfma_f32_16x16x32_bf16 v[168:171], v[88:91], v[72:75], v[168:171]
s_add_u32 m0, s39, 0
s_mov_b32 s37, 245760
buffer_load_dwordx4 v2, s[8:11], s37 offen sc1 lds
v_mfma_f32_16x16x32_bf16 v[172:175], v[92:95], v[72:75], v[172:175]
v_mfma_f32_16x16x32_bf16 v[188:191], v[92:95], v[76:79], v[188:191]
buffer_load_dwordx4 v2, s[8:11], s37 offen offset:1024 sc1 lds
v_mfma_f32_16x16x32_bf16 v[184:187], v[88:91], v[76:79], v[184:187]
v_mfma_f32_16x16x32_bf16 v[180:183], v[84:87], v[76:79], v[180:183]
s_mov_b32 s38, 1835008
buffer_load_dword v28, v27, s[16:19], s38 offen
v_mfma_f32_16x16x32_bf16 v[176:179], v[80:83], v[76:79], v[176:179]
s_waitcnt lgkmcnt(0)
v_mfma_f32_16x16x32_bf16 v[128:131], v[48:51], v[32:35], v[128:131]
ds_read_b128 v[64:67], v8 offset:57344
ds_read_b64_tr_b16 v[80:81], v14 offset:8192
v_mfma_f32_16x16x32_bf16 v[132:135], v[52:55], v[32:35], v[132:135]
ds_read_b64_tr_b16 v[82:83], v14 offset:12288
ds_read_b64_tr_b16 v[84:85], v15 offset:8192
v_mfma_f32_16x16x32_bf16 v[136:139], v[56:59], v[32:35], v[136:139]
ds_read_b64_tr_b16 v[86:87], v15 offset:12288
ds_read_b64_tr_b16 v[88:89], v14 offset:24576
v_mfma_f32_16x16x32_bf16 v[140:143], v[60:63], v[32:35], v[140:143]
ds_read_b64_tr_b16 v[90:91], v14 offset:28672
ds_read_b64_tr_b16 v[92:93], v15 offset:24576
v_mfma_f32_16x16x32_bf16 v[156:159], v[60:63], v[36:39], v[156:159]
ds_read_b64_tr_b16 v[94:95], v15 offset:28672
ds_read_b128 v[68:71], v8 offset:58368
v_mfma_f32_16x16x32_bf16 v[152:155], v[56:59], v[36:39], v[152:155]
ds_read_b128 v[72:75], v8 offset:59392
ds_read_b128 v[76:79], v8 offset:60416
v_mfma_f32_16x16x32_bf16 v[148:151], v[52:55], v[36:39], v[148:151]
v_mfma_f32_16x16x32_bf16 v[144:147], v[48:51], v[36:39], v[144:147]
v_mfma_f32_16x16x32_bf16 v[160:163], v[48:51], v[40:43], v[160:163]
v_mfma_f32_16x16x32_bf16 v[164:167], v[52:55], v[40:43], v[164:167]
v_mfma_f32_16x16x32_bf16 v[168:171], v[56:59], v[40:43], v[168:171]
v_mfma_f32_16x16x32_bf16 v[172:175], v[60:63], v[40:43], v[172:175]
v_mfma_f32_16x16x32_bf16 v[188:191], v[60:63], v[44:47], v[188:191]
v_mfma_f32_16x16x32_bf16 v[184:187], v[56:59], v[44:47], v[184:187]
v_mfma_f32_16x16x32_bf16 v[180:183], v[52:55], v[44:47], v[180:183]
v_mfma_f32_16x16x32_bf16 v[176:179], v[48:51], v[44:47], v[176:179]
s_waitcnt vmcnt(7) lgkmcnt(0)
s_barrier
v_mfma_f32_16x16x32_bf16 v[128:131], v[80:83], v[64:67], v[128:131]
ds_read_b128 v[32:35], v9 offset:0
ds_read_b64_tr_b16 v[48:49], v16 offset:0
v_lshrrev_b32 v120, 4, v1
v_mfma_f32_16x16x32_bf16 v[132:135], v[84:87], v[64:67], v[132:135]
ds_read_b64_tr_b16 v[50:51], v16 offset:4096
ds_read_b64_tr_b16 v[52:53], v17 offset:0
s_lshl_b32 s43, s51, 7
v_mfma_f32_16x16x32_bf16 v[136:139], v[88:91], v[64:67], v[136:139]
ds_read_b64_tr_b16 v[54:55], v17 offset:4096
ds_read_b64_tr_b16 v[56:57], v16 offset:16384
s_add_u32 s43, s43, 148992
v_lshl_add_u32 v121, v120, 4, s43
v_mfma_f32_16x16x32_bf16 v[140:143], v[92:95], v[64:67], v[140:143]
ds_read_b64_tr_b16 v[58:59], v16 offset:20480
ds_read_b64_tr_b16 v[60:61], v17 offset:16384
v_lshrrev_b32 v122, 1, v120
v_mfma_f32_16x16x32_bf16 v[156:159], v[92:95], v[68:71], v[156:159]
ds_read_b64_tr_b16 v[62:63], v17 offset:20480
ds_read_b128 v[36:39], v9 offset:1024
v_and_b32 v120, 1, v120
s_lshl_b32 s43, s51, 5
v_mfma_f32_16x16x32_bf16 v[152:155], v[88:91], v[68:71], v[152:155]
ds_read_b128 v[40:43], v9 offset:2048
ds_read_b128 v[44:47], v9 offset:3072
s_add_u32 s43, s43, 149248
v_mfma_f32_16x16x32_bf16 v[148:151], v[84:87], v[68:71], v[148:151]
v_lshl_add_u32 v122, v122, 6, s43
v_lshl_add_u32 v122, v120, 4, v122
s_add_u32 m0, s50, 49152
s_mov_b32 s38, 0
buffer_load_dwordx4 v5, s[16:19], s38 offen lds
v_mfma_f32_16x16x32_bf16 v[144:147], v[80:83], v[68:71], v[144:147]
v_and_b32 v120, 15, v1
v_mfma_f32_16x16x32_bf16 v[160:163], v[80:83], v[72:75], v[160:163]
s_lshr_b32 s43, s36, 1
s_add_u32 m0, s50, 50176
s_mov_b32 s38, 0
buffer_load_dwordx4 v6, s[16:19], s38 offen lds
v_mfma_f32_16x16x32_bf16 v[164:167], v[84:87], v[72:75], v[164:167]
s_lshl_b32 s43, s43, 8
s_add_u32 s43, s43, 147456
v_mfma_f32_16x16x32_bf16 v[168:171], v[88:91], v[72:75], v[168:171]
v_lshl_add_u32 v120, v120, 3, s43
s_add_u32 m0, s50, 51200
s_mov_b32 s38, 0
buffer_load_dwordx4 v7, s[16:19], s38 offen lds
v_mfma_f32_16x16x32_bf16 v[172:175], v[92:95], v[72:75], v[172:175]
ds_read_b128 v[96:99], v121 offset:0
ds_read_b128 v[100:103], v121 offset:64
v_mfma_f32_16x16x32_bf16 v[188:191], v[92:95], v[76:79], v[188:191]
ds_read_b128 v[104:107], v122 offset:0
s_add_u32 m0, s39, 49152
s_mov_b32 s37, 0
buffer_load_dwordx4 v2, s[8:11], s37 offen sc1 lds
v_mfma_f32_16x16x32_bf16 v[184:187], v[88:91], v[76:79], v[184:187]
ds_read_b128 v[108:111], v121 offset:896
ds_read_b128 v[112:115], v121 offset:960
v_mfma_f32_16x16x32_bf16 v[180:183], v[84:87], v[76:79], v[180:183]
ds_read_b128 v[116:119], v122 offset:896
buffer_load_dwordx4 v2, s[8:11], s37 offen offset:1024 sc1 lds
v_mfma_f32_16x16x32_bf16 v[176:179], v[80:83], v[76:79], v[176:179]
ds_read_b64 v[240:241], v120 offset:0
ds_read_b64 v[242:243], v120 offset:128
s_waitcnt lgkmcnt(0)
v_mfma_f32_16x16x32_bf16 v[128:131], v[48:51], v[32:35], v[128:131]
ds_read_b128 v[64:67], v9 offset:8192
ds_read_b64_tr_b16 v[80:81], v16 offset:8192
v_mfma_f32_16x16x32_bf16 v[132:135], v[52:55], v[32:35], v[132:135]
ds_read_b64_tr_b16 v[82:83], v16 offset:12288
ds_read_b64_tr_b16 v[84:85], v17 offset:8192
v_mul_f32 v192, -v240, v96
v_mfma_f32_16x16x32_bf16 v[136:139], v[56:59], v[32:35], v[136:139]
ds_read_b64_tr_b16 v[86:87], v17 offset:12288
ds_read_b64_tr_b16 v[88:89], v16 offset:24576
v_mul_f32 v193, -v240, v97
v_mfma_f32_16x16x32_bf16 v[140:143], v[60:63], v[32:35], v[140:143]
ds_read_b64_tr_b16 v[90:91], v16 offset:28672
ds_read_b64_tr_b16 v[92:93], v17 offset:24576
v_mul_f32 v194, -v240, v98
v_mfma_f32_16x16x32_bf16 v[156:159], v[60:63], v[36:39], v[156:159]
ds_read_b64_tr_b16 v[94:95], v17 offset:28672
ds_read_b128 v[68:71], v9 offset:9216
v_mfma_f32_16x16x32_bf16 v[152:155], v[56:59], v[36:39], v[152:155]
ds_read_b128 v[72:75], v9 offset:10240
ds_read_b128 v[76:79], v9 offset:11264
v_mul_f32 v195, -v240, v99
v_mfma_f32_16x16x32_bf16 v[148:151], v[52:55], v[36:39], v[148:151]
v_mul_f32 v216, -v242, v96
v_mfma_f32_16x16x32_bf16 v[144:147], v[48:51], v[36:39], v[144:147]
v_mul_f32 v217, -v242, v97
v_mfma_f32_16x16x32_bf16 v[160:163], v[48:51], v[40:43], v[160:163]
v_mfma_f32_16x16x32_bf16 v[164:167], v[52:55], v[40:43], v[164:167]
v_mul_f32 v218, -v242, v98
v_mfma_f32_16x16x32_bf16 v[168:171], v[56:59], v[40:43], v[168:171]
v_mul_f32 v219, -v242, v99
v_mfma_f32_16x16x32_bf16 v[172:175], v[60:63], v[40:43], v[172:175]
v_mul_f32 v196, -v240, v100
v_mfma_f32_16x16x32_bf16 v[188:191], v[60:63], v[44:47], v[188:191]
v_mfma_f32_16x16x32_bf16 v[184:187], v[56:59], v[44:47], v[184:187]
v_mul_f32 v197, -v240, v101
v_mfma_f32_16x16x32_bf16 v[180:183], v[52:55], v[44:47], v[180:183]
v_mul_f32 v198, -v240, v102
v_mfma_f32_16x16x32_bf16 v[176:179], v[48:51], v[44:47], v[176:179]
v_mul_f32 v199, -v240, v103
s_waitcnt vmcnt(6) lgkmcnt(0)
s_barrier
v_mfma_f32_16x16x32_bf16 v[128:131], v[80:83], v[64:67], v[128:131]
ds_read_b128 v[32:35], v8 offset:0
ds_read_b64_tr_b16 v[48:49], v12 offset:0
v_mfma_f32_16x16x32_bf16 v[132:135], v[84:87], v[64:67], v[132:135]
ds_read_b64_tr_b16 v[50:51], v12 offset:4096
ds_read_b64_tr_b16 v[52:53], v13 offset:0
v_mul_f32 v220, -v242, v100
v_mfma_f32_16x16x32_bf16 v[136:139], v[88:91], v[64:67], v[136:139]
ds_read_b64_tr_b16 v[54:55], v13 offset:4096
ds_read_b64_tr_b16 v[56:57], v12 offset:16384
v_mul_f32 v221, -v242, v101
v_mfma_f32_16x16x32_bf16 v[140:143], v[92:95], v[64:67], v[140:143]
ds_read_b64_tr_b16 v[58:59], v12 offset:20480
ds_read_b64_tr_b16 v[60:61], v13 offset:16384
v_mul_f32 v222, -v242, v102
v_mfma_f32_16x16x32_bf16 v[156:159], v[92:95], v[68:71], v[156:159]
ds_read_b64_tr_b16 v[62:63], v13 offset:20480
ds_read_b128 v[36:39], v8 offset:1024
s_add_u32 m0, s50, 98304
s_mov_b32 s38, 458752
buffer_load_dwordx4 v5, s[16:19], s38 offen lds
v_mfma_f32_16x16x32_bf16 v[152:155], v[88:91], v[68:71], v[152:155]
ds_read_b128 v[40:43], v8 offset:2048
ds_read_b128 v[44:47], v8 offset:3072
v_mul_f32 v223, -v242, v103
v_mfma_f32_16x16x32_bf16 v[148:151], v[84:87], v[68:71], v[148:151]
v_mul_f32 v200, -v240, v104
s_add_u32 m0, s50, 99328
s_mov_b32 s38, 458752
buffer_load_dwordx4 v6, s[16:19], s38 offen lds
v_mfma_f32_16x16x32_bf16 v[144:147], v[80:83], v[68:71], v[144:147]
v_mul_f32 v201, -v240, v105
v_mfma_f32_16x16x32_bf16 v[160:163], v[80:83], v[72:75], v[160:163]
s_add_u32 m0, s50, 100352
s_mov_b32 s38, 458752
buffer_load_dwordx4 v7, s[16:19], s38 offen lds
v_mfma_f32_16x16x32_bf16 v[164:167], v[84:87], v[72:75], v[164:167]
v_mul_f32 v202, -v240, v106
v_mfma_f32_16x16x32_bf16 v[168:171], v[88:91], v[72:75], v[168:171]
v_mul_f32 v203, -v240, v107
s_add_u32 m0, s39, 98304
s_mov_b32 s37, 16384
buffer_load_dwordx4 v2, s[8:11], s37 offen sc1 lds
v_mfma_f32_16x16x32_bf16 v[172:175], v[92:95], v[72:75], v[172:175]
v_mul_f32 v224, -v242, v104
v_mfma_f32_16x16x32_bf16 v[188:191], v[92:95], v[76:79], v[188:191]
buffer_load_dwordx4 v2, s[8:11], s37 offen offset:1024 sc1 lds
v_mfma_f32_16x16x32_bf16 v[184:187], v[88:91], v[76:79], v[184:187]
v_mul_f32 v225, -v242, v105
v_mfma_f32_16x16x32_bf16 v[180:183], v[84:87], v[76:79], v[180:183]
v_mul_f32 v226, -v242, v106
s_mov_b32 s38, 2752512
buffer_load_dword v28, v27, s[16:19], s38 offen
v_mfma_f32_16x16x32_bf16 v[176:179], v[80:83], v[76:79], v[176:179]
v_mul_f32 v227, -v242, v107
s_waitcnt lgkmcnt(0)
v_mfma_f32_16x16x32_bf16 v[128:131], v[48:51], v[32:35], v[128:131]
ds_read_b128 v[64:67], v8 offset:8192
ds_read_b64_tr_b16 v[80:81], v12 offset:8192
v_mfma_f32_16x16x32_bf16 v[132:135], v[52:55], v[32:35], v[132:135]
ds_read_b64_tr_b16 v[82:83], v12 offset:12288
ds_read_b64_tr_b16 v[84:85], v13 offset:8192
v_mul_f32 v204, -v240, v108
v_mfma_f32_16x16x32_bf16 v[136:139], v[56:59], v[32:35], v[136:139]
ds_read_b64_tr_b16 v[86:87], v13 offset:12288
ds_read_b64_tr_b16 v[88:89], v12 offset:24576
v_mul_f32 v205, -v240, v109
v_mfma_f32_16x16x32_bf16 v[140:143], v[60:63], v[32:35], v[140:143]
ds_read_b64_tr_b16 v[90:91], v12 offset:28672
ds_read_b64_tr_b16 v[92:93], v13 offset:24576
v_mul_f32 v206, -v240, v110
v_mfma_f32_16x16x32_bf16 v[156:159], v[60:63], v[36:39], v[156:159]
ds_read_b64_tr_b16 v[94:95], v13 offset:28672
ds_read_b128 v[68:71], v8 offset:9216
v_mfma_f32_16x16x32_bf16 v[152:155], v[56:59], v[36:39], v[152:155]
ds_read_b128 v[72:75], v8 offset:10240
ds_read_b128 v[76:79], v8 offset:11264
v_mul_f32 v207, -v240, v111
v_mfma_f32_16x16x32_bf16 v[148:151], v[52:55], v[36:39], v[148:151]
v_mul_f32 v228, -v242, v108
v_mfma_f32_16x16x32_bf16 v[144:147], v[48:51], v[36:39], v[144:147]
v_mul_f32 v229, -v242, v109
v_mfma_f32_16x16x32_bf16 v[160:163], v[48:51], v[40:43], v[160:163]
v_mfma_f32_16x16x32_bf16 v[164:167], v[52:55], v[40:43], v[164:167]
v_mul_f32 v230, -v242, v110
v_mfma_f32_16x16x32_bf16 v[168:171], v[56:59], v[40:43], v[168:171]
v_mul_f32 v231, -v242, v111
v_mfma_f32_16x16x32_bf16 v[172:175], v[60:63], v[40:43], v[172:175]
v_mul_f32 v208, -v240, v112
v_mfma_f32_16x16x32_bf16 v[188:191], v[60:63], v[44:47], v[188:191]
v_mfma_f32_16x16x32_bf16 v[184:187], v[56:59], v[44:47], v[184:187]
v_mul_f32 v209, -v240, v113
v_mfma_f32_16x16x32_bf16 v[180:183], v[52:55], v[44:47], v[180:183]
v_mul_f32 v210, -v240, v114
v_mfma_f32_16x16x32_bf16 v[176:179], v[48:51], v[44:47], v[176:179]
v_mul_f32 v211, -v240, v115
s_waitcnt vmcnt(6) lgkmcnt(0)
s_barrier
v_mfma_f32_16x16x32_bf16 v[128:131], v[80:83], v[64:67], v[128:131]
ds_read_b128 v[32:35], v10 offset:49152
ds_read_b128 v[36:39], v10 offset:50176
v_mfma_f32_16x16x32_bf16 v[132:135], v[84:87], v[64:67], v[132:135]
ds_read_b64_tr_b16 v[40:41], v21 offset:0
ds_read_b64_tr_b16 v[42:43], v21 offset:3072
v_mul_f32 v232, -v242, v112
v_mfma_f32_16x16x32_bf16 v[136:139], v[88:91], v[64:67], v[136:139]
ds_read_b64_tr_b16 v[44:45], v22 offset:0
ds_read_b64_tr_b16 v[46:47], v22 offset:3072
v_mul_f32 v233, -v242, v113
v_mfma_f32_16x16x32_bf16 v[140:143], v[92:95], v[64:67], v[140:143]
ds_read_b64_tr_b16 v[48:49], v23 offset:0
ds_read_b64_tr_b16 v[50:51], v23 offset:3072
v_mul_f32 v234, -v242, v114
v_mfma_f32_16x16x32_bf16 v[156:159], v[92:95], v[68:71], v[156:159]
ds_read_b64_tr_b16 v[52:53], v21 offset:12288
ds_read_b64_tr_b16 v[54:55], v21 offset:15360
v_mfma_f32_16x16x32_bf16 v[152:155], v[88:91], v[68:71], v[152:155]
ds_read_b64_tr_b16 v[56:57], v22 offset:12288
ds_read_b64_tr_b16 v[58:59], v22 offset:15360
v_mul_f32 v235, -v242, v115
v_mfma_f32_16x16x32_bf16 v[148:151], v[84:87], v[68:71], v[148:151]
ds_read_b64_tr_b16 v[60:61], v23 offset:12288
ds_read_b64_tr_b16 v[62:63], v23 offset:15360
v_mul_f32 v212, -v240, v116
s_add_u32 m0, s50, 0
s_mov_b32 s38, 917504
buffer_load_dwordx4 v5, s[16:19], s38 offen lds
v_mfma_f32_16x16x32_bf16 v[144:147], v[80:83], v[68:71], v[144:147]
v_mul_f32 v213, -v240, v117
v_mfma_f32_16x16x32_bf16 v[160:163], v[80:83], v[72:75], v[160:163]
s_add_u32 m0, s50, 1024
s_mov_b32 s38, 917504
buffer_load_dwordx4 v6, s[16:19], s38 offen lds
v_mfma_f32_16x16x32_bf16 v[164:167], v[84:87], v[72:75], v[164:167]
v_mul_f32 v214, -v240, v118
v_mfma_f32_16x16x32_bf16 v[168:171], v[88:91], v[72:75], v[168:171]
v_mul_f32 v215, -v240, v119
s_add_u32 m0, s50, 2048
s_mov_b32 s38, 917504
buffer_load_dwordx4 v7, s[16:19], s38 offen lds
v_mfma_f32_16x16x32_bf16 v[172:175], v[92:95], v[72:75], v[172:175]
v_mul_f32 v236, -v242, v116
v_mfma_f32_16x16x32_bf16 v[188:191], v[92:95], v[76:79], v[188:191]
s_add_u32 m0, s39, 0
s_mov_b32 s37, 32768
buffer_load_dwordx4 v2, s[8:11], s37 offen sc1 lds
v_mfma_f32_16x16x32_bf16 v[184:187], v[88:91], v[76:79], v[184:187]
v_mul_f32 v237, -v242, v117
v_mfma_f32_16x16x32_bf16 v[180:183], v[84:87], v[76:79], v[180:183]
v_mul_f32 v238, -v242, v118
buffer_load_dwordx4 v2, s[8:11], s37 offen offset:1024 sc1 lds
v_mfma_f32_16x16x32_bf16 v[176:179], v[80:83], v[76:79], v[176:179]
v_mul_f32 v239, -v242, v119
s_waitcnt lgkmcnt(0)
v_mfma_f32_16x16x32_bf16 v[192:195], v[40:43], v[32:35], v[192:195]
ds_read_b128 v[64:67], v10 offset:57344
ds_read_b128 v[68:71], v10 offset:58368
v_lshrrev_b32 v120, 4, v1
v_mfma_f32_16x16x32_bf16 v[216:219], v[40:43], v[36:39], v[216:219]
ds_read_b64_tr_b16 v[72:73], v21 offset:6144
ds_read_b64_tr_b16 v[74:75], v21 offset:9216
s_lshl_b32 s43, s47, 7
s_add_u32 s43, s43, 148480
v_mfma_f32_16x16x32_bf16 v[220:223], v[44:47], v[36:39], v[220:223]
ds_read_b64_tr_b16 v[76:77], v22 offset:6144
ds_read_b64_tr_b16 v[78:79], v22 offset:9216
v_lshl_add_u32 v121, v120, 4, s43
v_and_b32 v120, 15, v1
v_mfma_f32_16x16x32_bf16 v[196:199], v[44:47], v[32:35], v[196:199]
ds_read_b64_tr_b16 v[80:81], v23 offset:6144
ds_read_b64_tr_b16 v[82:83], v23 offset:9216
s_lshl_b32 s43, s46, 9
s_add_u32 s43, s43, 147456
v_mfma_f32_16x16x32_bf16 v[200:203], v[48:51], v[32:35], v[200:203]
ds_read_b64_tr_b16 v[84:85], v21 offset:18432
ds_read_b64_tr_b16 v[86:87], v21 offset:21504
v_lshl_add_u32 v120, v120, 3, s43
v_mfma_f32_16x16x32_bf16 v[224:227], v[48:51], v[36:39], v[224:227]
ds_read_b64_tr_b16 v[88:89], v22 offset:18432
ds_read_b64_tr_b16 v[90:91], v22 offset:21504
s_lshl_b32 s54, s35, 15
s_lshl_b32 s43, s47, 13
v_mfma_f32_16x16x32_bf16 v[228:231], v[52:55], v[36:39], v[228:231]
ds_read_b64_tr_b16 v[92:93], v23 offset:18432
ds_read_b64_tr_b16 v[94:95], v23 offset:21504
s_add_u32 s54, s54, s43
s_lshl_b32 s43, s46, 12
v_mfma_f32_16x16x32_bf16 v[204:207], v[52:55], v[32:35], v[204:207]
s_add_u32 s54, s54, s43
ds_read_b128 v[96:99], v121 offset:0
v_mfma_f32_16x16x32_bf16 v[208:211], v[56:59], v[32:35], v[208:211]
ds_read_b128 v[100:103], v121 offset:64
v_mfma_f32_16x16x32_bf16 v[232:235], v[56:59], v[36:39], v[232:235]
ds_read_b128 v[104:107], v121 offset:896
ds_read_b128 v[108:111], v121 offset:960
v_mfma_f32_16x16x32_bf16 v[236:239], v[60:63], v[36:39], v[236:239]
ds_read_b64 v[112:113], v120 offset:0
ds_read_b64 v[114:115], v120 offset:128
v_mfma_f32_16x16x32_bf16 v[212:215], v[60:63], v[32:35], v[212:215]
ds_read_b64 v[116:117], v120 offset:256
ds_read_b64 v[118:119], v120 offset:384
s_waitcnt vmcnt(6) lgkmcnt(0)
s_barrier
v_mfma_f32_16x16x32_bf16 v[192:195], v[72:75], v[64:67], v[192:195]
ds_read_b128 v[32:35], v11 offset:0
ds_read_b128 v[36:39], v11 offset:1024
v_mul_f32 v122, v113, v113
s_add_u32 m0, s50, 49152
s_mov_b32 s38, 1376256
buffer_load_dwordx4 v5, s[16:19], s38 offen lds
v_mfma_f32_16x16x32_bf16 v[216:219], v[72:75], v[68:71], v[216:219]
ds_read_b64_tr_b16 v[40:41], v24 offset:0
ds_read_b64_tr_b16 v[42:43], v24 offset:3072
v_mul_f32 v120, 0xc0135761, v113
v_mul_f32 v121, 0xbdd2d3e8, v113
v_mfma_f32_16x16x32_bf16 v[220:223], v[76:79], v[68:71], v[220:223]
ds_read_b64_tr_b16 v[44:45], v25 offset:0
ds_read_b64_tr_b16 v[46:47], v25 offset:3072
v_mul_f32 v121, v121, v122
v_rcp_f32 v122, v122
s_add_u32 m0, s50, 50176
s_mov_b32 s38, 1376256
buffer_load_dwordx4 v6, s[16:19], s38 offen lds
v_mfma_f32_16x16x32_bf16 v[196:199], v[76:79], v[64:67], v[196:199]
ds_read_b64_tr_b16 v[48:49], v26 offset:0
ds_read_b64_tr_b16 v[50:51], v26 offset:3072
v_fma_f32 v128, -v112, v96, v128
v_fma_f32 v129, -v112, v97, v129
v_mfma_f32_16x16x32_bf16 v[200:203], v[80:83], v[64:67], v[200:203]
ds_read_b64_tr_b16 v[52:53], v24 offset:12288
ds_read_b64_tr_b16 v[54:55], v24 offset:15360
v_fma_f32 v130, -v112, v98, v130
v_fma_f32 v131, -v112, v99, v131
s_add_u32 m0, s50, 51200
s_mov_b32 s38, 1376256
buffer_load_dwordx4 v7, s[16:19], s38 offen lds
v_mfma_f32_16x16x32_bf16 v[224:227], v[80:83], v[68:71], v[224:227]
ds_read_b64_tr_b16 v[56:57], v25 offset:12288
ds_read_b64_tr_b16 v[58:59], v25 offset:15360
v_mul_f32 v124, v128, v128
v_mul_f32 v125, v129, v129
v_mfma_f32_16x16x32_bf16 v[228:231], v[84:87], v[68:71], v[228:231]
ds_read_b64_tr_b16 v[60:61], v26 offset:12288
ds_read_b64_tr_b16 v[62:63], v26 offset:15360
v_mul_f32 v126, v130, v130
s_add_u32 m0, s39, 49152
s_mov_b32 s37, 49152
buffer_load_dwordx4 v2, s[8:11], s37 offen sc1 lds
v_mfma_f32_16x16x32_bf16 v[204:207], v[84:87], v[64:67], v[204:207]
v_mul_f32 v127, v131, v131
v_fma_f32 v124, v124, v121, v120
v_mfma_f32_16x16x32_bf16 v[208:211], v[88:91], v[64:67], v[208:211]
v_fma_f32 v125, v125, v121, v120
v_fma_f32 v126, v126, v121, v120
buffer_load_dwordx4 v2, s[8:11], s37 offen offset:1024 sc1 lds
v_mfma_f32_16x16x32_bf16 v[232:235], v[88:91], v[68:71], v[232:235]
v_fma_f32 v127, v127, v121, v120
v_mul_f32 v124, v124, v128
v_mfma_f32_16x16x32_bf16 v[236:239], v[92:95], v[68:71], v[236:239]
v_mul_f32 v125, v125, v129
v_mul_f32 v126, v126, v130
s_mov_b32 s38, 3670016
buffer_load_dword v28, v27, s[16:19], s38 offen
v_mfma_f32_16x16x32_bf16 v[212:215], v[92:95], v[64:67], v[212:215]
v_mul_f32 v127, v127, v131
v_exp_f32 v124, v124
s_waitcnt lgkmcnt(0)
v_mfma_f32_16x16x32_bf16 v[192:195], v[40:43], v[32:35], v[192:195]
ds_read_b128 v[64:67], v11 offset:8192
ds_read_b128 v[68:71], v11 offset:9216
v_fma_f32 v136, -v112, v104, v136
v_mfma_f32_16x16x32_bf16 v[216:219], v[40:43], v[36:39], v[216:219]
ds_read_b64_tr_b16 v[72:73], v24 offset:6144
ds_read_b64_tr_b16 v[74:75], v24 offset:9216
v_exp_f32 v125, v125
v_fma_f32 v137, -v112, v105, v137
v_mfma_f32_16x16x32_bf16 v[220:223], v[44:47], v[36:39], v[220:223]
ds_read_b64_tr_b16 v[76:77], v25 offset:6144
ds_read_b64_tr_b16 v[78:79], v25 offset:9216
v_exp_f32 v126, v126
v_fma_f32 v138, -v112, v106, v138
v_mfma_f32_16x16x32_bf16 v[196:199], v[44:47], v[32:35], v[196:199]
ds_read_b64_tr_b16 v[80:81], v26 offset:6144
ds_read_b64_tr_b16 v[82:83], v26 offset:9216
v_exp_f32 v127, v127
v_fma_f32 v139, -v112, v107, v139
v_mfma_f32_16x16x32_bf16 v[200:203], v[48:51], v[32:35], v[200:203]
ds_read_b64_tr_b16 v[84:85], v24 offset:18432
ds_read_b64_tr_b16 v[86:87], v24 offset:21504
v_fma_f32 v124, v124, v122, v122
v_fma_f32 v125, v125, v122, v122
v_mfma_f32_16x16x32_bf16 v[224:227], v[48:51], v[36:39], v[224:227]
ds_read_b64_tr_b16 v[88:89], v25 offset:18432
ds_read_b64_tr_b16 v[90:91], v25 offset:21504
v_fma_f32 v126, v126, v122, v122
v_fma_f32 v127, v127, v122, v122
v_mfma_f32_16x16x32_bf16 v[228:231], v[52:55], v[36:39], v[228:231]
ds_read_b64_tr_b16 v[92:93], v26 offset:18432
ds_read_b64_tr_b16 v[94:95], v26 offset:21504
v_rcp_f32 v124, v124
v_mfma_f32_16x16x32_bf16 v[204:207], v[52:55], v[32:35], v[204:207]
v_mul_f32 v136, v128, v136
v_rcp_f32 v125, v125
v_mfma_f32_16x16x32_bf16 v[208:211], v[56:59], v[32:35], v[208:211]
v_mul_f32 v137, v129, v137
v_rcp_f32 v126, v126
v_mfma_f32_16x16x32_bf16 v[232:235], v[56:59], v[36:39], v[232:235]
v_mul_f32 v138, v130, v138
v_rcp_f32 v127, v127
v_mfma_f32_16x16x32_bf16 v[236:239], v[60:63], v[36:39], v[236:239]
v_mul_f32 v139, v131, v139
v_mul_f32 v136, v136, v124
v_mfma_f32_16x16x32_bf16 v[212:215], v[60:63], v[32:35], v[212:215]
v_mul_f32 v137, v137, v125
v_mul_f32 v138, v138, v126
s_waitcnt vmcnt(6) lgkmcnt(0)
s_barrier
v_mfma_f32_16x16x32_bf16 v[192:195], v[72:75], v[64:67], v[192:195]
ds_read_b128 v[32:35], v10 offset:0
ds_read_b128 v[36:39], v10 offset:1024
v_mul_f32 v139, v139, v127
v_mfma_f32_16x16x32_bf16 v[216:219], v[72:75], v[68:71], v[216:219]
ds_read_b64_tr_b16 v[40:41], v18 offset:0
ds_read_b64_tr_b16 v[42:43], v18 offset:3072
v_cvt_pk_bf16_f32 v128, v136, v137
v_cvt_pk_bf16_f32 v129, v138, v139
v_mfma_f32_16x16x32_bf16 v[220:223], v[76:79], v[68:71], v[220:223]
ds_read_b64_tr_b16 v[44:45], v19 offset:0
ds_read_b64_tr_b16 v[46:47], v19 offset:3072
v_fma_f32 v132, -v112, v100, v132
v_fma_f32 v133, -v112, v101, v133
s_add_u32 m0, s50, 98304
s_mov_b32 s38, 1835008
buffer_load_dwordx4 v5, s[16:19], s38 offen lds
v_mfma_f32_16x16x32_bf16 v[196:199], v[76:79], v[64:67], v[196:199]
ds_read_b64_tr_b16 v[48:49], v20 offset:0
ds_read_b64_tr_b16 v[50:51], v20 offset:3072
v_fma_f32 v134, -v112, v102, v134
v_fma_f32 v135, -v112, v103, v135
v_mfma_f32_16x16x32_bf16 v[200:203], v[80:83], v[64:67], v[200:203]
ds_read_b64_tr_b16 v[52:53], v18 offset:12288
ds_read_b64_tr_b16 v[54:55], v18 offset:15360
v_mul_f32 v124, v132, v132
v_mul_f32 v125, v133, v133
s_add_u32 m0, s50, 99328
s_mov_b32 s38, 1835008
buffer_load_dwordx4 v6, s[16:19], s38 offen lds
v_mfma_f32_16x16x32_bf16 v[224:227], v[80:83], v[68:71], v[224:227]
ds_read_b64_tr_b16 v[56:57], v19 offset:12288
ds_read_b64_tr_b16 v[58:59], v19 offset:15360
v_mul_f32 v126, v134, v134
v_mul_f32 v127, v135, v135
v_mfma_f32_16x16x32_bf16 v[228:231], v[84:87], v[68:71], v[228:231]
ds_read_b64_tr_b16 v[60:61], v20 offset:12288
ds_read_b64_tr_b16 v[62:63], v20 offset:15360
v_fma_f32 v124, v124, v121, v120
s_add_u32 m0, s50, 100352
s_mov_b32 s38, 1835008
buffer_load_dwordx4 v7, s[16:19], s38 offen lds
v_mfma_f32_16x16x32_bf16 v[204:207], v[84:87], v[64:67], v[204:207]
v_fma_f32 v125, v125, v121, v120
v_fma_f32 v126, v126, v121, v120
v_mfma_f32_16x16x32_bf16 v[208:211], v[88:91], v[64:67], v[208:211]
v_fma_f32 v127, v127, v121, v120
v_mul_f32 v124, v124, v132
s_add_u32 m0, s39, 98304
s_mov_b32 s37, 65536
buffer_load_dwordx4 v2, s[8:11], s37 offen sc1 lds
v_mfma_f32_16x16x32_bf16 v[232:235], v[88:91], v[68:71], v[232:235]
v_mul_f32 v125, v125, v133
v_mul_f32 v126, v126, v134
v_mfma_f32_16x16x32_bf16 v[236:239], v[92:95], v[68:71], v[236:239]
v_mul_f32 v127, v127, v135
v_exp_f32 v124, v124
buffer_load_dwordx4 v2, s[8:11], s37 offen offset:1024 sc1 lds
v_mfma_f32_16x16x32_bf16 v[212:215], v[92:95], v[64:67], v[212:215]
v_fma_f32 v140, -v112, v108, v140
v_exp_f32 v125, v125
s_waitcnt lgkmcnt(0)
v_mfma_f32_16x16x32_bf16 v[192:195], v[40:43], v[32:35], v[192:195]
ds_read_b128 v[64:67], v10 offset:8192
ds_read_b128 v[68:71], v10 offset:9216
v_fma_f32 v141, -v112, v109, v141
v_mfma_f32_16x16x32_bf16 v[216:219], v[40:43], v[36:39], v[216:219]
ds_read_b64_tr_b16 v[72:73], v18 offset:6144
ds_read_b64_tr_b16 v[74:75], v18 offset:9216
v_exp_f32 v126, v126
v_fma_f32 v142, -v112, v110, v142
v_mfma_f32_16x16x32_bf16 v[220:223], v[44:47], v[36:39], v[220:223]
ds_read_b64_tr_b16 v[76:77], v19 offset:6144
ds_read_b64_tr_b16 v[78:79], v19 offset:9216
v_exp_f32 v127, v127
v_fma_f32 v143, -v112, v111, v143
v_mfma_f32_16x16x32_bf16 v[196:199], v[44:47], v[32:35], v[196:199]
ds_read_b64_tr_b16 v[80:81], v20 offset:6144
ds_read_b64_tr_b16 v[82:83], v20 offset:9216
v_fma_f32 v124, v124, v122, v122
v_fma_f32 v125, v125, v122, v122
v_mfma_f32_16x16x32_bf16 v[200:203], v[48:51], v[32:35], v[200:203]
ds_read_b64_tr_b16 v[84:85], v18 offset:18432
ds_read_b64_tr_b16 v[86:87], v18 offset:21504
v_fma_f32 v126, v126, v122, v122
v_fma_f32 v127, v127, v122, v122
v_mfma_f32_16x16x32_bf16 v[224:227], v[48:51], v[36:39], v[224:227]
ds_read_b64_tr_b16 v[88:89], v19 offset:18432
ds_read_b64_tr_b16 v[90:91], v19 offset:21504
v_rcp_f32 v124, v124
v_mul_f32 v140, v132, v140
v_mfma_f32_16x16x32_bf16 v[228:231], v[52:55], v[36:39], v[228:231]
ds_read_b64_tr_b16 v[92:93], v20 offset:18432
ds_read_b64_tr_b16 v[94:95], v20 offset:21504
v_rcp_f32 v125, v125
v_mul_f32 v141, v133, v141
v_mfma_f32_16x16x32_bf16 v[204:207], v[52:55], v[32:35], v[204:207]
v_rcp_f32 v126, v126
v_mul_f32 v142, v134, v142
v_mfma_f32_16x16x32_bf16 v[208:211], v[56:59], v[32:35], v[208:211]
v_rcp_f32 v127, v127
v_mul_f32 v143, v135, v143
v_mfma_f32_16x16x32_bf16 v[232:235], v[56:59], v[36:39], v[232:235]
v_mul_f32 v140, v140, v124
v_mul_f32 v141, v141, v125
v_mfma_f32_16x16x32_bf16 v[236:239], v[60:63], v[36:39], v[236:239]
v_mul_f32 v142, v142, v126
v_mul_f32 v143, v143, v127
v_mfma_f32_16x16x32_bf16 v[212:215], v[60:63], v[32:35], v[212:215]
v_cvt_pk_bf16_f32 v130, v140, v141
v_cvt_pk_bf16_f32 v131, v142, v143
s_waitcnt vmcnt(6) lgkmcnt(0)
s_barrier
v_mfma_f32_16x16x32_bf16 v[192:195], v[72:75], v[64:67], v[192:195]
ds_read_b128 v[32:35], v10 offset:49152
ds_read_b128 v[36:39], v10 offset:50176
v_mul_f32 v122, v115, v115
s_add_u32 m0, s50, 0
s_mov_b32 s38, 2293760
buffer_load_dwordx4 v5, s[16:19], s38 offen lds
v_mfma_f32_16x16x32_bf16 v[216:219], v[72:75], v[68:71], v[216:219]
ds_read_b64_tr_b16 v[40:41], v21 offset:0
ds_read_b64_tr_b16 v[42:43], v21 offset:3072
v_mul_f32 v120, 0xc0135761, v115
v_mul_f32 v121, 0xbdd2d3e8, v115
v_mfma_f32_16x16x32_bf16 v[220:223], v[76:79], v[68:71], v[220:223]
ds_read_b64_tr_b16 v[44:45], v22 offset:0
ds_read_b64_tr_b16 v[46:47], v22 offset:3072
v_mul_f32 v121, v121, v122
v_rcp_f32 v122, v122
s_add_u32 m0, s50, 1024
s_mov_b32 s38, 2293760
buffer_load_dwordx4 v6, s[16:19], s38 offen lds
v_mfma_f32_16x16x32_bf16 v[196:199], v[76:79], v[64:67], v[196:199]
ds_read_b64_tr_b16 v[48:49], v23 offset:0
ds_read_b64_tr_b16 v[50:51], v23 offset:3072
v_fma_f32 v144, -v114, v96, v144
v_fma_f32 v145, -v114, v97, v145
v_mfma_f32_16x16x32_bf16 v[200:203], v[80:83], v[64:67], v[200:203]
ds_read_b64_tr_b16 v[52:53], v21 offset:12288
ds_read_b64_tr_b16 v[54:55], v21 offset:15360
v_fma_f32 v146, -v114, v98, v146
v_fma_f32 v147, -v114, v99, v147
s_add_u32 m0, s50, 2048
s_mov_b32 s38, 2293760
buffer_load_dwordx4 v7, s[16:19], s38 offen lds
v_mfma_f32_16x16x32_bf16 v[224:227], v[80:83], v[68:71], v[224:227]
ds_read_b64_tr_b16 v[56:57], v22 offset:12288
ds_read_b64_tr_b16 v[58:59], v22 offset:15360
v_mul_f32 v124, v144, v144
v_mul_f32 v125, v145, v145
v_mfma_f32_16x16x32_bf16 v[228:231], v[84:87], v[68:71], v[228:231]
ds_read_b64_tr_b16 v[60:61], v23 offset:12288
ds_read_b64_tr_b16 v[62:63], v23 offset:15360
v_mul_f32 v126, v146, v146
s_add_u32 m0, s39, 0
s_mov_b32 s37, 81920
buffer_load_dwordx4 v2, s[8:11], s37 offen sc1 lds
v_mfma_f32_16x16x32_bf16 v[204:207], v[84:87], v[64:67], v[204:207]
v_mul_f32 v127, v147, v147
v_fma_f32 v124, v124, v121, v120
v_mfma_f32_16x16x32_bf16 v[208:211], v[88:91], v[64:67], v[208:211]
v_fma_f32 v125, v125, v121, v120
v_fma_f32 v126, v126, v121, v120
buffer_load_dwordx4 v2, s[8:11], s37 offen offset:1024 sc1 lds
v_mfma_f32_16x16x32_bf16 v[232:235], v[88:91], v[68:71], v[232:235]
v_fma_f32 v127, v127, v121, v120
v_mul_f32 v124, v124, v144
v_mfma_f32_16x16x32_bf16 v[236:239], v[92:95], v[68:71], v[236:239]
v_mul_f32 v125, v125, v145
v_mul_f32 v126, v126, v146
s_mov_b32 s38, 4587520
buffer_load_dword v28, v27, s[16:19], s38 offen
v_mfma_f32_16x16x32_bf16 v[212:215], v[92:95], v[64:67], v[212:215]
v_mul_f32 v127, v127, v147
v_exp_f32 v124, v124
buffer_store_dwordx4 v[128:131], v31, s[24:27], s54 offen offset:0 sc1
s_waitcnt lgkmcnt(0)
v_mfma_f32_16x16x32_bf16 v[192:195], v[40:43], v[32:35], v[192:195]
ds_read_b128 v[64:67], v10 offset:57344
ds_read_b128 v[68:71], v10 offset:58368
v_fma_f32 v152, -v114, v104, v152
v_mfma_f32_16x16x32_bf16 v[216:219], v[40:43], v[36:39], v[216:219]
ds_read_b64_tr_b16 v[72:73], v21 offset:6144
ds_read_b64_tr_b16 v[74:75], v21 offset:9216
v_exp_f32 v125, v125
v_fma_f32 v153, -v114, v105, v153
v_mfma_f32_16x16x32_bf16 v[220:223], v[44:47], v[36:39], v[220:223]
ds_read_b64_tr_b16 v[76:77], v22 offset:6144
ds_read_b64_tr_b16 v[78:79], v22 offset:9216
v_exp_f32 v126, v126
v_fma_f32 v154, -v114, v106, v154
v_mfma_f32_16x16x32_bf16 v[196:199], v[44:47], v[32:35], v[196:199]
ds_read_b64_tr_b16 v[80:81], v23 offset:6144
ds_read_b64_tr_b16 v[82:83], v23 offset:9216
v_exp_f32 v127, v127
v_fma_f32 v155, -v114, v107, v155
v_mfma_f32_16x16x32_bf16 v[200:203], v[48:51], v[32:35], v[200:203]
ds_read_b64_tr_b16 v[84:85], v21 offset:18432
ds_read_b64_tr_b16 v[86:87], v21 offset:21504
v_fma_f32 v124, v124, v122, v122
v_fma_f32 v125, v125, v122, v122
v_mfma_f32_16x16x32_bf16 v[224:227], v[48:51], v[36:39], v[224:227]
ds_read_b64_tr_b16 v[88:89], v22 offset:18432
ds_read_b64_tr_b16 v[90:91], v22 offset:21504
v_fma_f32 v126, v126, v122, v122
v_fma_f32 v127, v127, v122, v122
v_mfma_f32_16x16x32_bf16 v[228:231], v[52:55], v[36:39], v[228:231]
ds_read_b64_tr_b16 v[92:93], v23 offset:18432
ds_read_b64_tr_b16 v[94:95], v23 offset:21504
v_rcp_f32 v124, v124
v_mfma_f32_16x16x32_bf16 v[204:207], v[52:55], v[32:35], v[204:207]
v_mul_f32 v152, v144, v152
v_rcp_f32 v125, v125
v_mfma_f32_16x16x32_bf16 v[208:211], v[56:59], v[32:35], v[208:211]
v_mul_f32 v153, v145, v153
v_rcp_f32 v126, v126
v_mfma_f32_16x16x32_bf16 v[232:235], v[56:59], v[36:39], v[232:235]
v_mul_f32 v154, v146, v154
v_rcp_f32 v127, v127
v_mfma_f32_16x16x32_bf16 v[236:239], v[60:63], v[36:39], v[236:239]
v_mul_f32 v155, v147, v155
v_mul_f32 v152, v152, v124
v_mfma_f32_16x16x32_bf16 v[212:215], v[60:63], v[32:35], v[212:215]
v_mul_f32 v153, v153, v125
v_mul_f32 v154, v154, v126
s_waitcnt vmcnt(7) lgkmcnt(0)
s_barrier
v_mfma_f32_16x16x32_bf16 v[192:195], v[72:75], v[64:67], v[192:195]
ds_read_b128 v[32:35], v11 offset:0
ds_read_b128 v[36:39], v11 offset:1024
v_mul_f32 v155, v155, v127
v_mfma_f32_16x16x32_bf16 v[216:219], v[72:75], v[68:71], v[216:219]
ds_read_b64_tr_b16 v[40:41], v24 offset:0
ds_read_b64_tr_b16 v[42:43], v24 offset:3072
v_cvt_pk_bf16_f32 v144, v152, v153
v_cvt_pk_bf16_f32 v145, v154, v155
v_mfma_f32_16x16x32_bf16 v[220:223], v[76:79], v[68:71], v[220:223]
ds_read_b64_tr_b16 v[44:45], v25 offset:0
ds_read_b64_tr_b16 v[46:47], v25 offset:3072
v_fma_f32 v148, -v114, v100, v148
v_fma_f32 v149, -v114, v101, v149
s_add_u32 m0, s50, 49152
s_mov_b32 s38, 2752512
buffer_load_dwordx4 v5, s[16:19], s38 offen lds
v_mfma_f32_16x16x32_bf16 v[196:199], v[76:79], v[64:67], v[196:199]
ds_read_b64_tr_b16 v[48:49], v26 offset:0
ds_read_b64_tr_b16 v[50:51], v26 offset:3072
v_fma_f32 v150, -v114, v102, v150
v_fma_f32 v151, -v114, v103, v151
v_mfma_f32_16x16x32_bf16 v[200:203], v[80:83], v[64:67], v[200:203]
ds_read_b64_tr_b16 v[52:53], v24 offset:12288
ds_read_b64_tr_b16 v[54:55], v24 offset:15360
v_mul_f32 v124, v148, v148
v_mul_f32 v125, v149, v149
s_add_u32 m0, s50, 50176
s_mov_b32 s38, 2752512
buffer_load_dwordx4 v6, s[16:19], s38 offen lds
v_mfma_f32_16x16x32_bf16 v[224:227], v[80:83], v[68:71], v[224:227]
ds_read_b64_tr_b16 v[56:57], v25 offset:12288
ds_read_b64_tr_b16 v[58:59], v25 offset:15360
v_mul_f32 v126, v150, v150
v_mul_f32 v127, v151, v151
v_mfma_f32_16x16x32_bf16 v[228:231], v[84:87], v[68:71], v[228:231]
ds_read_b64_tr_b16 v[60:61], v26 offset:12288
ds_read_b64_tr_b16 v[62:63], v26 offset:15360
v_fma_f32 v124, v124, v121, v120
s_add_u32 m0, s50, 51200
s_mov_b32 s38, 2752512
buffer_load_dwordx4 v7, s[16:19], s38 offen lds
v_mfma_f32_16x16x32_bf16 v[204:207], v[84:87], v[64:67], v[204:207]
v_fma_f32 v125, v125, v121, v120
v_fma_f32 v126, v126, v121, v120
v_mfma_f32_16x16x32_bf16 v[208:211], v[88:91], v[64:67], v[208:211]
v_fma_f32 v127, v127, v121, v120
v_mul_f32 v124, v124, v148
s_add_u32 m0, s39, 49152
s_mov_b32 s37, 98304
buffer_load_dwordx4 v2, s[8:11], s37 offen sc1 lds
v_mfma_f32_16x16x32_bf16 v[232:235], v[88:91], v[68:71], v[232:235]
v_mul_f32 v125, v125, v149
v_mul_f32 v126, v126, v150
v_mfma_f32_16x16x32_bf16 v[236:239], v[92:95], v[68:71], v[236:239]
v_mul_f32 v127, v127, v151
v_exp_f32 v124, v124
buffer_load_dwordx4 v2, s[8:11], s37 offen offset:1024 sc1 lds
v_mfma_f32_16x16x32_bf16 v[212:215], v[92:95], v[64:67], v[212:215]
v_fma_f32 v156, -v114, v108, v156
v_exp_f32 v125, v125
s_waitcnt lgkmcnt(0)
v_mfma_f32_16x16x32_bf16 v[192:195], v[40:43], v[32:35], v[192:195]
ds_read_b128 v[64:67], v11 offset:8192
ds_read_b128 v[68:71], v11 offset:9216
v_fma_f32 v157, -v114, v109, v157
v_mfma_f32_16x16x32_bf16 v[216:219], v[40:43], v[36:39], v[216:219]
ds_read_b64_tr_b16 v[72:73], v24 offset:6144
ds_read_b64_tr_b16 v[74:75], v24 offset:9216
v_exp_f32 v126, v126
v_fma_f32 v158, -v114, v110, v158
v_mfma_f32_16x16x32_bf16 v[220:223], v[44:47], v[36:39], v[220:223]
ds_read_b64_tr_b16 v[76:77], v25 offset:6144
ds_read_b64_tr_b16 v[78:79], v25 offset:9216
v_exp_f32 v127, v127
v_fma_f32 v159, -v114, v111, v159
v_mfma_f32_16x16x32_bf16 v[196:199], v[44:47], v[32:35], v[196:199]
ds_read_b64_tr_b16 v[80:81], v26 offset:6144
ds_read_b64_tr_b16 v[82:83], v26 offset:9216
v_fma_f32 v124, v124, v122, v122
v_fma_f32 v125, v125, v122, v122
v_mfma_f32_16x16x32_bf16 v[200:203], v[48:51], v[32:35], v[200:203]
ds_read_b64_tr_b16 v[84:85], v24 offset:18432
ds_read_b64_tr_b16 v[86:87], v24 offset:21504
v_fma_f32 v126, v126, v122, v122
v_fma_f32 v127, v127, v122, v122
v_mfma_f32_16x16x32_bf16 v[224:227], v[48:51], v[36:39], v[224:227]
ds_read_b64_tr_b16 v[88:89], v25 offset:18432
ds_read_b64_tr_b16 v[90:91], v25 offset:21504
v_rcp_f32 v124, v124
v_mul_f32 v156, v148, v156
v_mfma_f32_16x16x32_bf16 v[228:231], v[52:55], v[36:39], v[228:231]
ds_read_b64_tr_b16 v[92:93], v26 offset:18432
ds_read_b64_tr_b16 v[94:95], v26 offset:21504
v_rcp_f32 v125, v125
v_mul_f32 v157, v149, v157
v_mfma_f32_16x16x32_bf16 v[204:207], v[52:55], v[32:35], v[204:207]
v_rcp_f32 v126, v126
v_mul_f32 v158, v150, v158
v_mfma_f32_16x16x32_bf16 v[208:211], v[56:59], v[32:35], v[208:211]
v_rcp_f32 v127, v127
v_mul_f32 v159, v151, v159
v_mfma_f32_16x16x32_bf16 v[232:235], v[56:59], v[36:39], v[232:235]
v_mul_f32 v156, v156, v124
v_mul_f32 v157, v157, v125
v_mfma_f32_16x16x32_bf16 v[236:239], v[60:63], v[36:39], v[236:239]
v_mul_f32 v158, v158, v126
v_mul_f32 v159, v159, v127
v_mfma_f32_16x16x32_bf16 v[212:215], v[60:63], v[32:35], v[212:215]
v_cvt_pk_bf16_f32 v146, v156, v157
v_cvt_pk_bf16_f32 v147, v158, v159
s_waitcnt vmcnt(7) lgkmcnt(0)
s_barrier
v_mfma_f32_16x16x32_bf16 v[192:195], v[72:75], v[64:67], v[192:195]
ds_read_b128 v[32:35], v10 offset:0
ds_read_b128 v[36:39], v10 offset:1024
v_mul_f32 v122, v117, v117
s_add_u32 m0, s50, 98304
s_mov_b32 s38, 3211264
buffer_load_dwordx4 v5, s[16:19], s38 offen lds
v_mfma_f32_16x16x32_bf16 v[216:219], v[72:75], v[68:71], v[216:219]
ds_read_b64_tr_b16 v[40:41], v18 offset:0
ds_read_b64_tr_b16 v[42:43], v18 offset:3072
v_mul_f32 v120, 0xc0135761, v117
v_mul_f32 v121, 0xbdd2d3e8, v117
v_mfma_f32_16x16x32_bf16 v[220:223], v[76:79], v[68:71], v[220:223]
ds_read_b64_tr_b16 v[44:45], v19 offset:0
ds_read_b64_tr_b16 v[46:47], v19 offset:3072
v_mul_f32 v121, v121, v122
v_rcp_f32 v122, v122
s_add_u32 m0, s50, 99328
s_mov_b32 s38, 3211264
buffer_load_dwordx4 v6, s[16:19], s38 offen lds
v_mfma_f32_16x16x32_bf16 v[196:199], v[76:79], v[64:67], v[196:199]
ds_read_b64_tr_b16 v[48:49], v20 offset:0
ds_read_b64_tr_b16 v[50:51], v20 offset:3072
v_fma_f32 v160, -v116, v96, v160
v_fma_f32 v161, -v116, v97, v161
v_mfma_f32_16x16x32_bf16 v[200:203], v[80:83], v[64:67], v[200:203]
ds_read_b64_tr_b16 v[52:53], v18 offset:12288
ds_read_b64_tr_b16 v[54:55], v18 offset:15360
v_fma_f32 v162, -v116, v98, v162
v_fma_f32 v163, -v116, v99, v163
s_add_u32 m0, s50, 100352
s_mov_b32 s38, 3211264
buffer_load_dwordx4 v7, s[16:19], s38 offen lds
v_mfma_f32_16x16x32_bf16 v[224:227], v[80:83], v[68:71], v[224:227]
ds_read_b64_tr_b16 v[56:57], v19 offset:12288
ds_read_b64_tr_b16 v[58:59], v19 offset:15360
v_mul_f32 v124, v160, v160
v_mul_f32 v125, v161, v161
v_mfma_f32_16x16x32_bf16 v[228:231], v[84:87], v[68:71], v[228:231]
ds_read_b64_tr_b16 v[60:61], v20 offset:12288
ds_read_b64_tr_b16 v[62:63], v20 offset:15360
v_mul_f32 v126, v162, v162
s_add_u32 m0, s39, 98304
s_mov_b32 s37, 114688
buffer_load_dwordx4 v2, s[8:11], s37 offen sc1 lds
v_mfma_f32_16x16x32_bf16 v[204:207], v[84:87], v[64:67], v[204:207]
v_mul_f32 v127, v163, v163
v_fma_f32 v124, v124, v121, v120
v_mfma_f32_16x16x32_bf16 v[208:211], v[88:91], v[64:67], v[208:211]
v_fma_f32 v125, v125, v121, v120
v_fma_f32 v126, v126, v121, v120
buffer_load_dwordx4 v2, s[8:11], s37 offen offset:1024 sc1 lds
v_mfma_f32_16x16x32_bf16 v[232:235], v[88:91], v[68:71], v[232:235]
v_fma_f32 v127, v127, v121, v120
v_mul_f32 v124, v124, v160
v_mfma_f32_16x16x32_bf16 v[236:239], v[92:95], v[68:71], v[236:239]
v_mul_f32 v125, v125, v161
v_mul_f32 v126, v126, v162
s_mov_b32 s38, 5505024
buffer_load_dword v28, v27, s[16:19], s38 offen
v_mfma_f32_16x16x32_bf16 v[212:215], v[92:95], v[64:67], v[212:215]
v_mul_f32 v127, v127, v163
v_exp_f32 v124, v124
buffer_store_dwordx4 v[144:147], v31, s[24:27], s54 offen offset:1024 sc1
s_waitcnt lgkmcnt(0)
v_mfma_f32_16x16x32_bf16 v[192:195], v[40:43], v[32:35], v[192:195]
ds_read_b128 v[64:67], v10 offset:8192
ds_read_b128 v[68:71], v10 offset:9216
v_fma_f32 v168, -v116, v104, v168
v_mfma_f32_16x16x32_bf16 v[216:219], v[40:43], v[36:39], v[216:219]
ds_read_b64_tr_b16 v[72:73], v18 offset:6144
ds_read_b64_tr_b16 v[74:75], v18 offset:9216
v_exp_f32 v125, v125
v_fma_f32 v169, -v116, v105, v169
v_mfma_f32_16x16x32_bf16 v[220:223], v[44:47], v[36:39], v[220:223]
ds_read_b64_tr_b16 v[76:77], v19 offset:6144
ds_read_b64_tr_b16 v[78:79], v19 offset:9216
v_exp_f32 v126, v126
v_fma_f32 v170, -v116, v106, v170
v_mfma_f32_16x16x32_bf16 v[196:199], v[44:47], v[32:35], v[196:199]
ds_read_b64_tr_b16 v[80:81], v20 offset:6144
ds_read_b64_tr_b16 v[82:83], v20 offset:9216
v_exp_f32 v127, v127
v_fma_f32 v171, -v116, v107, v171
v_mfma_f32_16x16x32_bf16 v[200:203], v[48:51], v[32:35], v[200:203]
ds_read_b64_tr_b16 v[84:85], v18 offset:18432
ds_read_b64_tr_b16 v[86:87], v18 offset:21504
v_fma_f32 v124, v124, v122, v122
v_fma_f32 v125, v125, v122, v122
v_mfma_f32_16x16x32_bf16 v[224:227], v[48:51], v[36:39], v[224:227]
ds_read_b64_tr_b16 v[88:89], v19 offset:18432
ds_read_b64_tr_b16 v[90:91], v19 offset:21504
v_fma_f32 v126, v126, v122, v122
v_fma_f32 v127, v127, v122, v122
v_mfma_f32_16x16x32_bf16 v[228:231], v[52:55], v[36:39], v[228:231]
ds_read_b64_tr_b16 v[92:93], v20 offset:18432
ds_read_b64_tr_b16 v[94:95], v20 offset:21504
v_rcp_f32 v124, v124
v_mfma_f32_16x16x32_bf16 v[204:207], v[52:55], v[32:35], v[204:207]
v_mul_f32 v168, v160, v168
v_rcp_f32 v125, v125
v_mfma_f32_16x16x32_bf16 v[208:211], v[56:59], v[32:35], v[208:211]
v_mul_f32 v169, v161, v169
v_rcp_f32 v126, v126
v_mfma_f32_16x16x32_bf16 v[232:235], v[56:59], v[36:39], v[232:235]
v_mul_f32 v170, v162, v170
v_rcp_f32 v127, v127
v_mfma_f32_16x16x32_bf16 v[236:239], v[60:63], v[36:39], v[236:239]
v_mul_f32 v171, v163, v171
v_mul_f32 v168, v168, v124
v_mfma_f32_16x16x32_bf16 v[212:215], v[60:63], v[32:35], v[212:215]
v_mul_f32 v169, v169, v125
v_mul_f32 v170, v170, v126
s_waitcnt vmcnt(7) lgkmcnt(0)
s_barrier
v_mfma_f32_16x16x32_bf16 v[192:195], v[72:75], v[64:67], v[192:195]
ds_read_b128 v[32:35], v10 offset:49152
ds_read_b128 v[36:39], v10 offset:50176
v_mul_f32 v171, v171, v127
v_mfma_f32_16x16x32_bf16 v[216:219], v[72:75], v[68:71], v[216:219]
ds_read_b64_tr_b16 v[40:41], v21 offset:0
ds_read_b64_tr_b16 v[42:43], v21 offset:3072
v_cvt_pk_bf16_f32 v160, v168, v169
v_cvt_pk_bf16_f32 v161, v170, v171
v_mfma_f32_16x16x32_bf16 v[220:223], v[76:79], v[68:71], v[220:223]
ds_read_b64_tr_b16 v[44:45], v22 offset:0
ds_read_b64_tr_b16 v[46:47], v22 offset:3072
v_fma_f32 v164, -v116, v100, v164
v_fma_f32 v165, -v116, v101, v165
s_add_u32 m0, s50, 0
s_mov_b32 s38, 3670016
buffer_load_dwordx4 v5, s[16:19], s38 offen lds
v_mfma_f32_16x16x32_bf16 v[196:199], v[76:79], v[64:67], v[196:199]
ds_read_b64_tr_b16 v[48:49], v23 offset:0
ds_read_b64_tr_b16 v[50:51], v23 offset:3072
v_fma_f32 v166, -v116, v102, v166
v_fma_f32 v167, -v116, v103, v167
v_mfma_f32_16x16x32_bf16 v[200:203], v[80:83], v[64:67], v[200:203]
ds_read_b64_tr_b16 v[52:53], v21 offset:12288
ds_read_b64_tr_b16 v[54:55], v21 offset:15360
v_mul_f32 v124, v164, v164
v_mul_f32 v125, v165, v165
s_add_u32 m0, s50, 1024
s_mov_b32 s38, 3670016
buffer_load_dwordx4 v6, s[16:19], s38 offen lds
v_mfma_f32_16x16x32_bf16 v[224:227], v[80:83], v[68:71], v[224:227]
ds_read_b64_tr_b16 v[56:57], v22 offset:12288
ds_read_b64_tr_b16 v[58:59], v22 offset:15360
v_mul_f32 v126, v166, v166
v_mul_f32 v127, v167, v167
v_mfma_f32_16x16x32_bf16 v[228:231], v[84:87], v[68:71], v[228:231]
ds_read_b64_tr_b16 v[60:61], v23 offset:12288
ds_read_b64_tr_b16 v[62:63], v23 offset:15360
v_fma_f32 v124, v124, v121, v120
s_add_u32 m0, s50, 2048
s_mov_b32 s38, 3670016
buffer_load_dwordx4 v7, s[16:19], s38 offen lds
v_mfma_f32_16x16x32_bf16 v[204:207], v[84:87], v[64:67], v[204:207]
v_fma_f32 v125, v125, v121, v120
v_fma_f32 v126, v126, v121, v120
v_mfma_f32_16x16x32_bf16 v[208:211], v[88:91], v[64:67], v[208:211]
v_fma_f32 v127, v127, v121, v120
v_mul_f32 v124, v124, v164
s_add_u32 m0, s39, 0
s_mov_b32 s37, 131072
buffer_load_dwordx4 v2, s[8:11], s37 offen sc1 lds
v_mfma_f32_16x16x32_bf16 v[232:235], v[88:91], v[68:71], v[232:235]
v_mul_f32 v125, v125, v165
v_mul_f32 v126, v126, v166
v_mfma_f32_16x16x32_bf16 v[236:239], v[92:95], v[68:71], v[236:239]
v_mul_f32 v127, v127, v167
v_exp_f32 v124, v124
buffer_load_dwordx4 v2, s[8:11], s37 offen offset:1024 sc1 lds
v_mfma_f32_16x16x32_bf16 v[212:215], v[92:95], v[64:67], v[212:215]
v_fma_f32 v172, -v116, v108, v172
v_exp_f32 v125, v125
s_waitcnt lgkmcnt(0)
v_mfma_f32_16x16x32_bf16 v[192:195], v[40:43], v[32:35], v[192:195]
ds_read_b128 v[64:67], v10 offset:57344
ds_read_b128 v[68:71], v10 offset:58368
v_fma_f32 v173, -v116, v109, v173
v_mfma_f32_16x16x32_bf16 v[216:219], v[40:43], v[36:39], v[216:219]
ds_read_b64_tr_b16 v[72:73], v21 offset:6144
ds_read_b64_tr_b16 v[74:75], v21 offset:9216
v_exp_f32 v126, v126
v_fma_f32 v174, -v116, v110, v174
v_mfma_f32_16x16x32_bf16 v[220:223], v[44:47], v[36:39], v[220:223]
ds_read_b64_tr_b16 v[76:77], v22 offset:6144
ds_read_b64_tr_b16 v[78:79], v22 offset:9216
v_exp_f32 v127, v127
v_fma_f32 v175, -v116, v111, v175
v_mfma_f32_16x16x32_bf16 v[196:199], v[44:47], v[32:35], v[196:199]
ds_read_b64_tr_b16 v[80:81], v23 offset:6144
ds_read_b64_tr_b16 v[82:83], v23 offset:9216
v_fma_f32 v124, v124, v122, v122
v_fma_f32 v125, v125, v122, v122
v_mfma_f32_16x16x32_bf16 v[200:203], v[48:51], v[32:35], v[200:203]
ds_read_b64_tr_b16 v[84:85], v21 offset:18432
ds_read_b64_tr_b16 v[86:87], v21 offset:21504
v_fma_f32 v126, v126, v122, v122
v_fma_f32 v127, v127, v122, v122
v_mfma_f32_16x16x32_bf16 v[224:227], v[48:51], v[36:39], v[224:227]
ds_read_b64_tr_b16 v[88:89], v22 offset:18432
ds_read_b64_tr_b16 v[90:91], v22 offset:21504
v_rcp_f32 v124, v124
v_mul_f32 v172, v164, v172
v_mfma_f32_16x16x32_bf16 v[228:231], v[52:55], v[36:39], v[228:231]
ds_read_b64_tr_b16 v[92:93], v23 offset:18432
ds_read_b64_tr_b16 v[94:95], v23 offset:21504
v_rcp_f32 v125, v125
v_mul_f32 v173, v165, v173
v_mfma_f32_16x16x32_bf16 v[204:207], v[52:55], v[32:35], v[204:207]
v_rcp_f32 v126, v126
v_mul_f32 v174, v166, v174
v_mfma_f32_16x16x32_bf16 v[208:211], v[56:59], v[32:35], v[208:211]
v_rcp_f32 v127, v127
v_mul_f32 v175, v167, v175
v_mfma_f32_16x16x32_bf16 v[232:235], v[56:59], v[36:39], v[232:235]
v_mul_f32 v172, v172, v124
v_mul_f32 v173, v173, v125
v_mfma_f32_16x16x32_bf16 v[236:239], v[60:63], v[36:39], v[236:239]
v_mul_f32 v174, v174, v126
v_mul_f32 v175, v175, v127
v_mfma_f32_16x16x32_bf16 v[212:215], v[60:63], v[32:35], v[212:215]
v_cvt_pk_bf16_f32 v162, v172, v173
v_cvt_pk_bf16_f32 v163, v174, v175
s_waitcnt vmcnt(7) lgkmcnt(0)
s_barrier
v_mfma_f32_16x16x32_bf16 v[192:195], v[72:75], v[64:67], v[192:195]
ds_read_b128 v[32:35], v11 offset:0
ds_read_b128 v[36:39], v11 offset:1024
v_mul_f32 v122, v119, v119
s_add_u32 m0, s50, 49152
s_mov_b32 s38, 4128768
buffer_load_dwordx4 v5, s[16:19], s38 offen lds
v_mfma_f32_16x16x32_bf16 v[216:219], v[72:75], v[68:71], v[216:219]
ds_read_b64_tr_b16 v[40:41], v24 offset:0
ds_read_b64_tr_b16 v[42:43], v24 offset:3072
v_mul_f32 v120, 0xc0135761, v119
v_mul_f32 v121, 0xbdd2d3e8, v119
v_mfma_f32_16x16x32_bf16 v[220:223], v[76:79], v[68:71], v[220:223]
ds_read_b64_tr_b16 v[44:45], v25 offset:0
ds_read_b64_tr_b16 v[46:47], v25 offset:3072
v_mul_f32 v121, v121, v122
v_rcp_f32 v122, v122
s_add_u32 m0, s50, 50176
s_mov_b32 s38, 4128768
buffer_load_dwordx4 v6, s[16:19], s38 offen lds
v_mfma_f32_16x16x32_bf16 v[196:199], v[76:79], v[64:67], v[196:199]
ds_read_b64_tr_b16 v[48:49], v26 offset:0
ds_read_b64_tr_b16 v[50:51], v26 offset:3072
v_fma_f32 v176, -v118, v96, v176
v_fma_f32 v177, -v118, v97, v177
v_mfma_f32_16x16x32_bf16 v[200:203], v[80:83], v[64:67], v[200:203]
ds_read_b64_tr_b16 v[52:53], v24 offset:12288
ds_read_b64_tr_b16 v[54:55], v24 offset:15360
v_fma_f32 v178, -v118, v98, v178
v_fma_f32 v179, -v118, v99, v179
s_add_u32 m0, s50, 51200
s_mov_b32 s38, 4128768
buffer_load_dwordx4 v7, s[16:19], s38 offen lds
v_mfma_f32_16x16x32_bf16 v[224:227], v[80:83], v[68:71], v[224:227]
ds_read_b64_tr_b16 v[56:57], v25 offset:12288
ds_read_b64_tr_b16 v[58:59], v25 offset:15360
v_mul_f32 v124, v176, v176
v_mul_f32 v125, v177, v177
v_mfma_f32_16x16x32_bf16 v[228:231], v[84:87], v[68:71], v[228:231]
ds_read_b64_tr_b16 v[60:61], v26 offset:12288
ds_read_b64_tr_b16 v[62:63], v26 offset:15360
v_mul_f32 v126, v178, v178
s_add_u32 m0, s39, 49152
s_mov_b32 s37, 147456
buffer_load_dwordx4 v2, s[8:11], s37 offen sc1 lds
v_mfma_f32_16x16x32_bf16 v[204:207], v[84:87], v[64:67], v[204:207]
v_mul_f32 v127, v179, v179
v_fma_f32 v124, v124, v121, v120
v_mfma_f32_16x16x32_bf16 v[208:211], v[88:91], v[64:67], v[208:211]
v_fma_f32 v125, v125, v121, v120
v_fma_f32 v126, v126, v121, v120
buffer_load_dwordx4 v2, s[8:11], s37 offen offset:1024 sc1 lds
v_mfma_f32_16x16x32_bf16 v[232:235], v[88:91], v[68:71], v[232:235]
v_fma_f32 v127, v127, v121, v120
v_mul_f32 v124, v124, v176
v_mfma_f32_16x16x32_bf16 v[236:239], v[92:95], v[68:71], v[236:239]
v_mul_f32 v125, v125, v177
v_mul_f32 v126, v126, v178
s_mov_b32 s38, 6422528
buffer_load_dword v28, v27, s[16:19], s38 offen
v_mfma_f32_16x16x32_bf16 v[212:215], v[92:95], v[64:67], v[212:215]
v_mul_f32 v127, v127, v179
v_exp_f32 v124, v124
buffer_store_dwordx4 v[160:163], v31, s[24:27], s54 offen offset:2048 sc1
s_waitcnt lgkmcnt(0)
v_mfma_f32_16x16x32_bf16 v[192:195], v[40:43], v[32:35], v[192:195]
ds_read_b128 v[64:67], v11 offset:8192
ds_read_b128 v[68:71], v11 offset:9216
v_fma_f32 v184, -v118, v104, v184
v_mfma_f32_16x16x32_bf16 v[216:219], v[40:43], v[36:39], v[216:219]
ds_read_b64_tr_b16 v[72:73], v24 offset:6144
ds_read_b64_tr_b16 v[74:75], v24 offset:9216
v_exp_f32 v125, v125
v_fma_f32 v185, -v118, v105, v185
v_mfma_f32_16x16x32_bf16 v[220:223], v[44:47], v[36:39], v[220:223]
ds_read_b64_tr_b16 v[76:77], v25 offset:6144
ds_read_b64_tr_b16 v[78:79], v25 offset:9216
v_exp_f32 v126, v126
v_fma_f32 v186, -v118, v106, v186
v_mfma_f32_16x16x32_bf16 v[196:199], v[44:47], v[32:35], v[196:199]
ds_read_b64_tr_b16 v[80:81], v26 offset:6144
ds_read_b64_tr_b16 v[82:83], v26 offset:9216
v_exp_f32 v127, v127
v_fma_f32 v187, -v118, v107, v187
v_mfma_f32_16x16x32_bf16 v[200:203], v[48:51], v[32:35], v[200:203]
ds_read_b64_tr_b16 v[84:85], v24 offset:18432
ds_read_b64_tr_b16 v[86:87], v24 offset:21504
v_fma_f32 v124, v124, v122, v122
v_fma_f32 v125, v125, v122, v122
v_mfma_f32_16x16x32_bf16 v[224:227], v[48:51], v[36:39], v[224:227]
ds_read_b64_tr_b16 v[88:89], v25 offset:18432
ds_read_b64_tr_b16 v[90:91], v25 offset:21504
v_fma_f32 v126, v126, v122, v122
v_fma_f32 v127, v127, v122, v122
v_mfma_f32_16x16x32_bf16 v[228:231], v[52:55], v[36:39], v[228:231]
ds_read_b64_tr_b16 v[92:93], v26 offset:18432
ds_read_b64_tr_b16 v[94:95], v26 offset:21504
v_rcp_f32 v124, v124
v_mfma_f32_16x16x32_bf16 v[204:207], v[52:55], v[32:35], v[204:207]
v_mul_f32 v184, v176, v184
v_rcp_f32 v125, v125
v_mfma_f32_16x16x32_bf16 v[208:211], v[56:59], v[32:35], v[208:211]
v_mul_f32 v185, v177, v185
v_rcp_f32 v126, v126
v_mfma_f32_16x16x32_bf16 v[232:235], v[56:59], v[36:39], v[232:235]
v_mul_f32 v186, v178, v186
v_rcp_f32 v127, v127
v_mfma_f32_16x16x32_bf16 v[236:239], v[60:63], v[36:39], v[236:239]
v_mul_f32 v187, v179, v187
v_mul_f32 v184, v184, v124
v_mfma_f32_16x16x32_bf16 v[212:215], v[60:63], v[32:35], v[212:215]
v_mul_f32 v185, v185, v125
v_mul_f32 v186, v186, v126
s_waitcnt vmcnt(7) lgkmcnt(0)
s_barrier
v_mfma_f32_16x16x32_bf16 v[192:195], v[72:75], v[64:67], v[192:195]
ds_read_b128 v[32:35], v10 offset:0
ds_read_b128 v[36:39], v10 offset:1024
v_mul_f32 v187, v187, v127
v_mfma_f32_16x16x32_bf16 v[216:219], v[72:75], v[68:71], v[216:219]
ds_read_b64_tr_b16 v[40:41], v18 offset:0
ds_read_b64_tr_b16 v[42:43], v18 offset:3072
v_cvt_pk_bf16_f32 v176, v184, v185
v_cvt_pk_bf16_f32 v177, v186, v187
v_mfma_f32_16x16x32_bf16 v[220:223], v[76:79], v[68:71], v[220:223]
ds_read_b64_tr_b16 v[44:45], v19 offset:0
ds_read_b64_tr_b16 v[46:47], v19 offset:3072
v_fma_f32 v180, -v118, v100, v180
v_fma_f32 v181, -v118, v101, v181
s_add_u32 m0, s50, 98304
s_mov_b32 s38, 4587520
buffer_load_dwordx4 v5, s[16:19], s38 offen lds
v_mfma_f32_16x16x32_bf16 v[196:199], v[76:79], v[64:67], v[196:199]
ds_read_b64_tr_b16 v[48:49], v20 offset:0
ds_read_b64_tr_b16 v[50:51], v20 offset:3072
v_fma_f32 v182, -v118, v102, v182
v_fma_f32 v183, -v118, v103, v183
v_mfma_f32_16x16x32_bf16 v[200:203], v[80:83], v[64:67], v[200:203]
ds_read_b64_tr_b16 v[52:53], v18 offset:12288
ds_read_b64_tr_b16 v[54:55], v18 offset:15360
v_mul_f32 v124, v180, v180
v_mul_f32 v125, v181, v181
s_add_u32 m0, s50, 99328
s_mov_b32 s38, 4587520
buffer_load_dwordx4 v6, s[16:19], s38 offen lds
v_mfma_f32_16x16x32_bf16 v[224:227], v[80:83], v[68:71], v[224:227]
ds_read_b64_tr_b16 v[56:57], v19 offset:12288
ds_read_b64_tr_b16 v[58:59], v19 offset:15360
v_mul_f32 v126, v182, v182
v_mul_f32 v127, v183, v183
v_mfma_f32_16x16x32_bf16 v[228:231], v[84:87], v[68:71], v[228:231]
ds_read_b64_tr_b16 v[60:61], v20 offset:12288
ds_read_b64_tr_b16 v[62:63], v20 offset:15360
v_fma_f32 v124, v124, v121, v120
s_add_u32 m0, s50, 100352
s_mov_b32 s38, 4587520
buffer_load_dwordx4 v7, s[16:19], s38 offen lds
v_mfma_f32_16x16x32_bf16 v[204:207], v[84:87], v[64:67], v[204:207]
v_fma_f32 v125, v125, v121, v120
v_fma_f32 v126, v126, v121, v120
v_mfma_f32_16x16x32_bf16 v[208:211], v[88:91], v[64:67], v[208:211]
v_fma_f32 v127, v127, v121, v120
v_mul_f32 v124, v124, v180
s_add_u32 m0, s39, 98304
s_mov_b32 s37, 163840
buffer_load_dwordx4 v2, s[8:11], s37 offen sc1 lds
v_mfma_f32_16x16x32_bf16 v[232:235], v[88:91], v[68:71], v[232:235]
v_mul_f32 v125, v125, v181
v_mul_f32 v126, v126, v182
v_mfma_f32_16x16x32_bf16 v[236:239], v[92:95], v[68:71], v[236:239]
v_mul_f32 v127, v127, v183
v_exp_f32 v124, v124
buffer_load_dwordx4 v2, s[8:11], s37 offen offset:1024 sc1 lds
v_mfma_f32_16x16x32_bf16 v[212:215], v[92:95], v[64:67], v[212:215]
v_fma_f32 v188, -v118, v108, v188
v_exp_f32 v125, v125
s_waitcnt lgkmcnt(0)
v_mfma_f32_16x16x32_bf16 v[192:195], v[40:43], v[32:35], v[192:195]
ds_read_b128 v[64:67], v10 offset:8192
ds_read_b128 v[68:71], v10 offset:9216
v_fma_f32 v189, -v118, v109, v189
v_mfma_f32_16x16x32_bf16 v[216:219], v[40:43], v[36:39], v[216:219]
ds_read_b64_tr_b16 v[72:73], v18 offset:6144
ds_read_b64_tr_b16 v[74:75], v18 offset:9216
v_exp_f32 v126, v126
v_fma_f32 v190, -v118, v110, v190
v_mfma_f32_16x16x32_bf16 v[220:223], v[44:47], v[36:39], v[220:223]
ds_read_b64_tr_b16 v[76:77], v19 offset:6144
ds_read_b64_tr_b16 v[78:79], v19 offset:9216
v_exp_f32 v127, v127
v_fma_f32 v191, -v118, v111, v191
v_mfma_f32_16x16x32_bf16 v[196:199], v[44:47], v[32:35], v[196:199]
ds_read_b64_tr_b16 v[80:81], v20 offset:6144
ds_read_b64_tr_b16 v[82:83], v20 offset:9216
v_fma_f32 v124, v124, v122, v122
v_fma_f32 v125, v125, v122, v122
v_mfma_f32_16x16x32_bf16 v[200:203], v[48:51], v[32:35], v[200:203]
ds_read_b64_tr_b16 v[84:85], v18 offset:18432
ds_read_b64_tr_b16 v[86:87], v18 offset:21504
v_fma_f32 v126, v126, v122, v122
v_fma_f32 v127, v127, v122, v122
v_mfma_f32_16x16x32_bf16 v[224:227], v[48:51], v[36:39], v[224:227]
ds_read_b64_tr_b16 v[88:89], v19 offset:18432
ds_read_b64_tr_b16 v[90:91], v19 offset:21504
v_rcp_f32 v124, v124
v_mul_f32 v188, v180, v188
v_mfma_f32_16x16x32_bf16 v[228:231], v[52:55], v[36:39], v[228:231]
ds_read_b64_tr_b16 v[92:93], v20 offset:18432
ds_read_b64_tr_b16 v[94:95], v20 offset:21504
v_rcp_f32 v125, v125
v_mul_f32 v189, v181, v189
v_mfma_f32_16x16x32_bf16 v[204:207], v[52:55], v[32:35], v[204:207]
v_rcp_f32 v126, v126
v_mul_f32 v190, v182, v190
v_mfma_f32_16x16x32_bf16 v[208:211], v[56:59], v[32:35], v[208:211]
v_rcp_f32 v127, v127
v_mul_f32 v191, v183, v191
v_mfma_f32_16x16x32_bf16 v[232:235], v[56:59], v[36:39], v[232:235]
v_mul_f32 v188, v188, v124
v_mul_f32 v189, v189, v125
v_mfma_f32_16x16x32_bf16 v[236:239], v[60:63], v[36:39], v[236:239]
v_mul_f32 v190, v190, v126
v_mul_f32 v191, v191, v127
v_mfma_f32_16x16x32_bf16 v[212:215], v[60:63], v[32:35], v[212:215]
v_cvt_pk_bf16_f32 v178, v188, v189
v_cvt_pk_bf16_f32 v179, v190, v191
s_waitcnt vmcnt(7) lgkmcnt(0)
s_barrier
v_mfma_f32_16x16x32_bf16 v[192:195], v[72:75], v[64:67], v[192:195]
ds_read_b128 v[32:35], v10 offset:49152
ds_read_b128 v[36:39], v10 offset:50176
s_add_u32 m0, s50, 0
s_mov_b32 s38, 5046272
buffer_load_dwordx4 v5, s[16:19], s38 offen lds
v_mfma_f32_16x16x32_bf16 v[216:219], v[72:75], v[68:71], v[216:219]
ds_read_b64_tr_b16 v[40:41], v21 offset:0
ds_read_b64_tr_b16 v[42:43], v21 offset:3072
v_mfma_f32_16x16x32_bf16 v[220:223], v[76:79], v[68:71], v[220:223]
ds_read_b64_tr_b16 v[44:45], v22 offset:0
ds_read_b64_tr_b16 v[46:47], v22 offset:3072
s_add_u32 m0, s50, 1024
s_mov_b32 s38, 5046272
buffer_load_dwordx4 v6, s[16:19], s38 offen lds
v_mfma_f32_16x16x32_bf16 v[196:199], v[76:79], v[64:67], v[196:199]
ds_read_b64_tr_b16 v[48:49], v23 offset:0
ds_read_b64_tr_b16 v[50:51], v23 offset:3072
v_mfma_f32_16x16x32_bf16 v[200:203], v[80:83], v[64:67], v[200:203]
ds_read_b64_tr_b16 v[52:53], v21 offset:12288
ds_read_b64_tr_b16 v[54:55], v21 offset:15360
s_add_u32 m0, s50, 2048
s_mov_b32 s38, 5046272
buffer_load_dwordx4 v7, s[16:19], s38 offen lds
v_mfma_f32_16x16x32_bf16 v[224:227], v[80:83], v[68:71], v[224:227]
ds_read_b64_tr_b16 v[56:57], v22 offset:12288
ds_read_b64_tr_b16 v[58:59], v22 offset:15360
v_mfma_f32_16x16x32_bf16 v[228:231], v[84:87], v[68:71], v[228:231]
ds_read_b64_tr_b16 v[60:61], v23 offset:12288
ds_read_b64_tr_b16 v[62:63], v23 offset:15360
s_add_u32 m0, s39, 0
s_mov_b32 s37, 180224
buffer_load_dwordx4 v2, s[8:11], s37 offen sc1 lds
v_mfma_f32_16x16x32_bf16 v[204:207], v[84:87], v[64:67], v[204:207]
v_mfma_f32_16x16x32_bf16 v[208:211], v[88:91], v[64:67], v[208:211]
buffer_load_dwordx4 v2, s[8:11], s37 offen offset:1024 sc1 lds
v_mfma_f32_16x16x32_bf16 v[232:235], v[88:91], v[68:71], v[232:235]
v_mfma_f32_16x16x32_bf16 v[236:239], v[92:95], v[68:71], v[236:239]
buffer_store_dwordx4 v[176:179], v31, s[24:27], s54 offen offset:3072 sc1
v_mfma_f32_16x16x32_bf16 v[212:215], v[92:95], v[64:67], v[212:215]
s_waitcnt lgkmcnt(0)
v_mfma_f32_16x16x32_bf16 v[192:195], v[40:43], v[32:35], v[192:195]
ds_read_b128 v[64:67], v10 offset:57344
ds_read_b128 v[68:71], v10 offset:58368
v_mfma_f32_16x16x32_bf16 v[216:219], v[40:43], v[36:39], v[216:219]
ds_read_b64_tr_b16 v[72:73], v21 offset:6144
ds_read_b64_tr_b16 v[74:75], v21 offset:9216
v_mfma_f32_16x16x32_bf16 v[220:223], v[44:47], v[36:39], v[220:223]
ds_read_b64_tr_b16 v[76:77], v22 offset:6144
ds_read_b64_tr_b16 v[78:79], v22 offset:9216
v_mfma_f32_16x16x32_bf16 v[196:199], v[44:47], v[32:35], v[196:199]
ds_read_b64_tr_b16 v[80:81], v23 offset:6144
ds_read_b64_tr_b16 v[82:83], v23 offset:9216
v_mfma_f32_16x16x32_bf16 v[200:203], v[48:51], v[32:35], v[200:203]
ds_read_b64_tr_b16 v[84:85], v21 offset:18432
ds_read_b64_tr_b16 v[86:87], v21 offset:21504
v_mfma_f32_16x16x32_bf16 v[224:227], v[48:51], v[36:39], v[224:227]
ds_read_b64_tr_b16 v[88:89], v22 offset:18432
ds_read_b64_tr_b16 v[90:91], v22 offset:21504
v_mfma_f32_16x16x32_bf16 v[228:231], v[52:55], v[36:39], v[228:231]
ds_read_b64_tr_b16 v[92:93], v23 offset:18432
ds_read_b64_tr_b16 v[94:95], v23 offset:21504
v_mfma_f32_16x16x32_bf16 v[204:207], v[52:55], v[32:35], v[204:207]
v_mfma_f32_16x16x32_bf16 v[208:211], v[56:59], v[32:35], v[208:211]
v_mfma_f32_16x16x32_bf16 v[232:235], v[56:59], v[36:39], v[232:235]
v_mfma_f32_16x16x32_bf16 v[236:239], v[60:63], v[36:39], v[236:239]
v_mfma_f32_16x16x32_bf16 v[212:215], v[60:63], v[32:35], v[212:215]
s_waitcnt vmcnt(6) lgkmcnt(0)
s_barrier
v_mfma_f32_16x16x32_bf16 v[192:195], v[72:75], v[64:67], v[192:195]
ds_read_b128 v[32:35], v11 offset:0
ds_read_b128 v[36:39], v11 offset:1024
v_mfma_f32_16x16x32_bf16 v[216:219], v[72:75], v[68:71], v[216:219]
ds_read_b64_tr_b16 v[40:41], v24 offset:0
ds_read_b64_tr_b16 v[42:43], v24 offset:3072
v_mfma_f32_16x16x32_bf16 v[220:223], v[76:79], v[68:71], v[220:223]
ds_read_b64_tr_b16 v[44:45], v25 offset:0
ds_read_b64_tr_b16 v[46:47], v25 offset:3072
s_add_u32 m0, s50, 49152
s_mov_b32 s38, 5505024
buffer_load_dwordx4 v5, s[16:19], s38 offen lds
v_mfma_f32_16x16x32_bf16 v[196:199], v[76:79], v[64:67], v[196:199]
ds_read_b64_tr_b16 v[48:49], v26 offset:0
ds_read_b64_tr_b16 v[50:51], v26 offset:3072
v_mfma_f32_16x16x32_bf16 v[200:203], v[80:83], v[64:67], v[200:203]
ds_read_b64_tr_b16 v[52:53], v24 offset:12288
ds_read_b64_tr_b16 v[54:55], v24 offset:15360
s_add_u32 m0, s50, 50176
s_mov_b32 s38, 5505024
buffer_load_dwordx4 v6, s[16:19], s38 offen lds
v_mfma_f32_16x16x32_bf16 v[224:227], v[80:83], v[68:71], v[224:227]
ds_read_b64_tr_b16 v[56:57], v25 offset:12288
ds_read_b64_tr_b16 v[58:59], v25 offset:15360
v_mfma_f32_16x16x32_bf16 v[228:231], v[84:87], v[68:71], v[228:231]
ds_read_b64_tr_b16 v[60:61], v26 offset:12288
ds_read_b64_tr_b16 v[62:63], v26 offset:15360
s_add_u32 m0, s50, 51200
s_mov_b32 s38, 5505024
buffer_load_dwordx4 v7, s[16:19], s38 offen lds
v_mfma_f32_16x16x32_bf16 v[204:207], v[84:87], v[64:67], v[204:207]
v_mfma_f32_16x16x32_bf16 v[208:211], v[88:91], v[64:67], v[208:211]
s_add_u32 m0, s39, 49152
s_mov_b32 s37, 196608
buffer_load_dwordx4 v2, s[8:11], s37 offen sc1 lds
v_mfma_f32_16x16x32_bf16 v[232:235], v[88:91], v[68:71], v[232:235]
v_mfma_f32_16x16x32_bf16 v[236:239], v[92:95], v[68:71], v[236:239]
buffer_load_dwordx4 v2, s[8:11], s37 offen offset:1024 sc1 lds
v_mfma_f32_16x16x32_bf16 v[212:215], v[92:95], v[64:67], v[212:215]
s_waitcnt lgkmcnt(0)
v_mfma_f32_16x16x32_bf16 v[192:195], v[40:43], v[32:35], v[192:195]
ds_read_b128 v[64:67], v11 offset:8192
ds_read_b128 v[68:71], v11 offset:9216
v_mfma_f32_16x16x32_bf16 v[216:219], v[40:43], v[36:39], v[216:219]
ds_read_b64_tr_b16 v[72:73], v24 offset:6144
ds_read_b64_tr_b16 v[74:75], v24 offset:9216
v_mfma_f32_16x16x32_bf16 v[220:223], v[44:47], v[36:39], v[220:223]
ds_read_b64_tr_b16 v[76:77], v25 offset:6144
ds_read_b64_tr_b16 v[78:79], v25 offset:9216
v_mfma_f32_16x16x32_bf16 v[196:199], v[44:47], v[32:35], v[196:199]
ds_read_b64_tr_b16 v[80:81], v26 offset:6144
ds_read_b64_tr_b16 v[82:83], v26 offset:9216
v_mfma_f32_16x16x32_bf16 v[200:203], v[48:51], v[32:35], v[200:203]
ds_read_b64_tr_b16 v[84:85], v24 offset:18432
ds_read_b64_tr_b16 v[86:87], v24 offset:21504
v_mfma_f32_16x16x32_bf16 v[224:227], v[48:51], v[36:39], v[224:227]
ds_read_b64_tr_b16 v[88:89], v25 offset:18432
ds_read_b64_tr_b16 v[90:91], v25 offset:21504
v_mfma_f32_16x16x32_bf16 v[228:231], v[52:55], v[36:39], v[228:231]
ds_read_b64_tr_b16 v[92:93], v26 offset:18432
ds_read_b64_tr_b16 v[94:95], v26 offset:21504
v_mfma_f32_16x16x32_bf16 v[204:207], v[52:55], v[32:35], v[204:207]
v_mfma_f32_16x16x32_bf16 v[208:211], v[56:59], v[32:35], v[208:211]
v_mfma_f32_16x16x32_bf16 v[232:235], v[56:59], v[36:39], v[232:235]
v_mfma_f32_16x16x32_bf16 v[236:239], v[60:63], v[36:39], v[236:239]
v_mfma_f32_16x16x32_bf16 v[212:215], v[60:63], v[32:35], v[212:215]
s_waitcnt vmcnt(6) lgkmcnt(0)
s_barrier
s_cmp_eq_u32 s36, 0
s_cbranch_scc0 Lw_55
s_add_u32 s43, s34, 32
s_lshl_b32 s43, s43, 7
v_mov_b32 v29, s43
v_mov_b32 v30, 1
s_mov_b64 exec, 1
buffer_atomic_add v30, v29, s[56:59], 0 offen sc1
s_mov_b64 exec, -1
Lw_55:
v_mfma_f32_16x16x32_bf16 v[192:195], v[72:75], v[64:67], v[192:195]
ds_read_b128 v[32:35], v10 offset:0
ds_read_b128 v[36:39], v10 offset:1024
v_mfma_f32_16x16x32_bf16 v[216:219], v[72:75], v[68:71], v[216:219]
ds_read_b64_tr_b16 v[40:41], v18 offset:0
ds_read_b64_tr_b16 v[42:43], v18 offset:3072
v_mfma_f32_16x16x32_bf16 v[220:223], v[76:79], v[68:71], v[220:223]
ds_read_b64_tr_b16 v[44:45], v19 offset:0
ds_read_b64_tr_b16 v[46:47], v19 offset:3072
s_add_u32 m0, s50, 98304
s_mov_b32 s38, 5963776
buffer_load_dwordx4 v5, s[16:19], s38 offen lds
v_mfma_f32_16x16x32_bf16 v[196:199], v[76:79], v[64:67], v[196:199]
ds_read_b64_tr_b16 v[48:49], v20 offset:0
ds_read_b64_tr_b16 v[50:51], v20 offset:3072
v_mfma_f32_16x16x32_bf16 v[200:203], v[80:83], v[64:67], v[200:203]
ds_read_b64_tr_b16 v[52:53], v18 offset:12288
ds_read_b64_tr_b16 v[54:55], v18 offset:15360
s_add_u32 m0, s50, 99328
s_mov_b32 s38, 5963776
buffer_load_dwordx4 v6, s[16:19], s38 offen lds
v_mfma_f32_16x16x32_bf16 v[224:227], v[80:83], v[68:71], v[224:227]
ds_read_b64_tr_b16 v[56:57], v19 offset:12288
ds_read_b64_tr_b16 v[58:59], v19 offset:15360
v_mfma_f32_16x16x32_bf16 v[228:231], v[84:87], v[68:71], v[228:231]
ds_read_b64_tr_b16 v[60:61], v20 offset:12288
ds_read_b64_tr_b16 v[62:63], v20 offset:15360
s_add_u32 m0, s50, 100352
s_mov_b32 s38, 5963776
buffer_load_dwordx4 v7, s[16:19], s38 offen lds
v_mfma_f32_16x16x32_bf16 v[204:207], v[84:87], v[64:67], v[204:207]
v_mfma_f32_16x16x32_bf16 v[208:211], v[88:91], v[64:67], v[208:211]
s_add_u32 m0, s39, 98304
s_mov_b32 s37, 212992
buffer_load_dwordx4 v2, s[8:11], s37 offen sc1 lds
v_mfma_f32_16x16x32_bf16 v[232:235], v[88:91], v[68:71], v[232:235]
v_mfma_f32_16x16x32_bf16 v[236:239], v[92:95], v[68:71], v[236:239]
buffer_load_dwordx4 v2, s[8:11], s37 offen offset:1024 sc1 lds
v_mfma_f32_16x16x32_bf16 v[212:215], v[92:95], v[64:67], v[212:215]
s_waitcnt lgkmcnt(0)
v_mfma_f32_16x16x32_bf16 v[192:195], v[40:43], v[32:35], v[192:195]
ds_read_b128 v[64:67], v10 offset:8192
ds_read_b128 v[68:71], v10 offset:9216
v_mfma_f32_16x16x32_bf16 v[216:219], v[40:43], v[36:39], v[216:219]
ds_read_b64_tr_b16 v[72:73], v18 offset:6144
ds_read_b64_tr_b16 v[74:75], v18 offset:9216
v_mfma_f32_16x16x32_bf16 v[220:223], v[44:47], v[36:39], v[220:223]
ds_read_b64_tr_b16 v[76:77], v19 offset:6144
ds_read_b64_tr_b16 v[78:79], v19 offset:9216
v_mfma_f32_16x16x32_bf16 v[196:199], v[44:47], v[32:35], v[196:199]
ds_read_b64_tr_b16 v[80:81], v20 offset:6144
ds_read_b64_tr_b16 v[82:83], v20 offset:9216
v_mfma_f32_16x16x32_bf16 v[200:203], v[48:51], v[32:35], v[200:203]
ds_read_b64_tr_b16 v[84:85], v18 offset:18432
ds_read_b64_tr_b16 v[86:87], v18 offset:21504
v_mfma_f32_16x16x32_bf16 v[224:227], v[48:51], v[36:39], v[224:227]
ds_read_b64_tr_b16 v[88:89], v19 offset:18432
ds_read_b64_tr_b16 v[90:91], v19 offset:21504
v_mfma_f32_16x16x32_bf16 v[228:231], v[52:55], v[36:39], v[228:231]
ds_read_b64_tr_b16 v[92:93], v20 offset:18432
ds_read_b64_tr_b16 v[94:95], v20 offset:21504
v_mfma_f32_16x16x32_bf16 v[204:207], v[52:55], v[32:35], v[204:207]
v_mfma_f32_16x16x32_bf16 v[208:211], v[56:59], v[32:35], v[208:211]
v_mfma_f32_16x16x32_bf16 v[232:235], v[56:59], v[36:39], v[232:235]
v_mfma_f32_16x16x32_bf16 v[236:239], v[60:63], v[36:39], v[236:239]
v_mfma_f32_16x16x32_bf16 v[212:215], v[60:63], v[32:35], v[212:215]
s_waitcnt vmcnt(5) lgkmcnt(0)
s_barrier
v_mfma_f32_16x16x32_bf16 v[192:195], v[72:75], v[64:67], v[192:195]
ds_read_b128 v[32:35], v10 offset:49152
ds_read_b128 v[36:39], v10 offset:50176
v_mfma_f32_16x16x32_bf16 v[216:219], v[72:75], v[68:71], v[216:219]
ds_read_b64_tr_b16 v[40:41], v21 offset:0
ds_read_b64_tr_b16 v[42:43], v21 offset:3072
v_mfma_f32_16x16x32_bf16 v[220:223], v[76:79], v[68:71], v[220:223]
ds_read_b64_tr_b16 v[44:45], v22 offset:0
ds_read_b64_tr_b16 v[46:47], v22 offset:3072
s_add_u32 m0, s50, 0
s_mov_b32 s38, 6422528
buffer_load_dwordx4 v5, s[16:19], s38 offen lds
v_mfma_f32_16x16x32_bf16 v[196:199], v[76:79], v[64:67], v[196:199]
ds_read_b64_tr_b16 v[48:49], v23 offset:0
ds_read_b64_tr_b16 v[50:51], v23 offset:3072
v_mfma_f32_16x16x32_bf16 v[200:203], v[80:83], v[64:67], v[200:203]
ds_read_b64_tr_b16 v[52:53], v21 offset:12288
ds_read_b64_tr_b16 v[54:55], v21 offset:15360
s_add_u32 m0, s50, 1024
s_mov_b32 s38, 6422528
buffer_load_dwordx4 v6, s[16:19], s38 offen lds
v_mfma_f32_16x16x32_bf16 v[224:227], v[80:83], v[68:71], v[224:227]
ds_read_b64_tr_b16 v[56:57], v22 offset:12288
ds_read_b64_tr_b16 v[58:59], v22 offset:15360
v_mfma_f32_16x16x32_bf16 v[228:231], v[84:87], v[68:71], v[228:231]
ds_read_b64_tr_b16 v[60:61], v23 offset:12288
ds_read_b64_tr_b16 v[62:63], v23 offset:15360
s_add_u32 m0, s50, 2048
s_mov_b32 s38, 6422528
buffer_load_dwordx4 v7, s[16:19], s38 offen lds
v_mfma_f32_16x16x32_bf16 v[204:207], v[84:87], v[64:67], v[204:207]
v_mfma_f32_16x16x32_bf16 v[208:211], v[88:91], v[64:67], v[208:211]
s_add_u32 m0, s39, 0
s_mov_b32 s37, 229376
buffer_load_dwordx4 v2, s[8:11], s37 offen sc1 lds
v_mfma_f32_16x16x32_bf16 v[232:235], v[88:91], v[68:71], v[232:235]
v_mfma_f32_16x16x32_bf16 v[236:239], v[92:95], v[68:71], v[236:239]
buffer_load_dwordx4 v2, s[8:11], s37 offen offset:1024 sc1 lds
v_mfma_f32_16x16x32_bf16 v[212:215], v[92:95], v[64:67], v[212:215]
s_waitcnt lgkmcnt(0)
v_mfma_f32_16x16x32_bf16 v[192:195], v[40:43], v[32:35], v[192:195]
ds_read_b128 v[64:67], v10 offset:57344
ds_read_b128 v[68:71], v10 offset:58368
v_mfma_f32_16x16x32_bf16 v[216:219], v[40:43], v[36:39], v[216:219]
ds_read_b64_tr_b16 v[72:73], v21 offset:6144
ds_read_b64_tr_b16 v[74:75], v21 offset:9216
v_mfma_f32_16x16x32_bf16 v[220:223], v[44:47], v[36:39], v[220:223]
ds_read_b64_tr_b16 v[76:77], v22 offset:6144
ds_read_b64_tr_b16 v[78:79], v22 offset:9216
v_mfma_f32_16x16x32_bf16 v[196:199], v[44:47], v[32:35], v[196:199]
ds_read_b64_tr_b16 v[80:81], v23 offset:6144
ds_read_b64_tr_b16 v[82:83], v23 offset:9216
v_mfma_f32_16x16x32_bf16 v[200:203], v[48:51], v[32:35], v[200:203]
ds_read_b64_tr_b16 v[84:85], v21 offset:18432
ds_read_b64_tr_b16 v[86:87], v21 offset:21504
v_mfma_f32_16x16x32_bf16 v[224:227], v[48:51], v[36:39], v[224:227]
ds_read_b64_tr_b16 v[88:89], v22 offset:18432
ds_read_b64_tr_b16 v[90:91], v22 offset:21504
v_mfma_f32_16x16x32_bf16 v[228:231], v[52:55], v[36:39], v[228:231]
ds_read_b64_tr_b16 v[92:93], v23 offset:18432
ds_read_b64_tr_b16 v[94:95], v23 offset:21504
v_mfma_f32_16x16x32_bf16 v[204:207], v[52:55], v[32:35], v[204:207]
v_mfma_f32_16x16x32_bf16 v[208:211], v[56:59], v[32:35], v[208:211]
v_mfma_f32_16x16x32_bf16 v[232:235], v[56:59], v[36:39], v[232:235]
v_mfma_f32_16x16x32_bf16 v[236:239], v[60:63], v[36:39], v[236:239]
v_mfma_f32_16x16x32_bf16 v[212:215], v[60:63], v[32:35], v[212:215]
s_waitcnt vmcnt(5) lgkmcnt(0)
s_barrier
s_cmp_eq_u32 s36, 7
s_cbranch_scc0 Lw_56
s_add_u32 s43, s34, 32
s_lshl_b32 s43, s43, 7
v_mov_b32 v29, s43
buffer_load_dword v30, v29, s[56:59], 0 offen sc1
Lw_56:
s_bfe_u32 s61, s35, 0x10002
s_lshr_b32 s60, s35, 3
s_lshl_b32 s60, s60, 2
s_and_b32 s43, s35, 3
s_add_u32 s60, s60, s43
s_lshl_b32 s43, s60, 8
s_add_u32 s28, s76, s43
s_addc_u32 s29, s77, 0
s_mov_b32 s30, 7338240
s_mov_b32 s31, 0x20000
s_cmp_lt_u32 s36, 4
s_cbranch_scc0 Lw_57
s_lshr_b32 s62, s36, 1
s_and_b32 s63, s36, 1
s_lshl_b32 s43, s60, 2
s_lshl_b32 s44, s61, 1
s_add_u32 s43, s43, s44
s_add_u32 s43, s43, s63
s_lshl_b32 s43, s43, 13
s_lshl_b32 s44, s62, 12
s_add_u32 s43, s43, s44
buffer_load_dwordx4 v[160:163], v31, s[8:11], s43 offen offset:0 sc1
buffer_load_dwordx4 v[164:167], v31, s[8:11], s43 offen offset:1024 sc1
buffer_load_dwordx4 v[168:171], v31, s[8:11], s43 offen offset:2048 sc1
buffer_load_dwordx4 v[172:175], v31, s[8:11], s43 offen offset:3072 sc1
v_add_u32 v244, s44, v31
v_add_u32 v244, 0x10000, v244
v_lshrrev_b32 v118, 2, v1
v_and_b32 v119, 7, v118
v_mul_u32_u24 v118, 256, v118
v_lshl_add_u32 v118, v119, 5, v118
v_and_b32 v119, 3, v1
v_lshl_add_u32 v245, v119, 3, v118
v_add_u32 v245, 81920, v245
s_lshl_b32 s43, s61, 7
s_lshl_b32 s44, s63, 6
s_add_u32 s43, s43, s44
v_xor_b32 v245, s43, v245
v_xor_b32 v246, 32, v245
v_xor_b32 v247, 128, v245
v_xor_b32 v248, 128, v246
Lw_57:
s_cmp_ge_u32 s36, 4
s_cbranch_scc0 Lw_58
s_lshl_b32 s52, s61, 18
s_lshl_b32 s53, s61, 21
v_lshrrev_b32 v152, 4, v1
v_lshlrev_b32 v153, 1, v152
v_and_b32 v150, 15, v1
v_xor_b32 v150, v150, v153
v_lshlrev_b32 v150, 4, v150
v_mul_u32_u24 v152, 2048, v152
v_add_u32 v150, v150, v152
v_xor_b32 v151, 128, v150
v_lshrrev_b32 v152, 3, v1
v_and_b32 v153, 6, v152
v_and_b32 v154, 7, v1
v_xor_b32 v154, v154, v153
v_lshlrev_b32 v154, 4, v154
v_mul_u32_u24 v152, 2048, v152
v_add_u32 v154, v154, v152
s_lshl_b32 s43, s61, 7
v_add_u32 v154, s43, v154
Lw_58:
s_cmp_eq_u32 s36, 4
s_cbranch_scc0 Lw_59
v_add_u32 v128, 0, v31
v_add_u32 v129, 3072, v31
v_add_u32 v130, 6144, v31
v_add_u32 v131, 9216, v31
v_add_u32 v132, 12288, v31
v_add_u32 v133, 15360, v31
v_add_u32 v134, 16384, v150
v_add_u32 v135, 40960, v151
v_add_u32 v136, 65536, v150
v_add_u32 v137, 90112, v151
v_add_u32 v138, 114688, v150
v_add_u32 v139, 32768, v154
v_add_u32 v140, 81920, v154
Lw_59:
s_cmp_eq_u32 s36, 5
s_cbranch_scc0 Lw_60
v_add_u32 v128, 1024, v31
v_add_u32 v129, 4096, v31
v_add_u32 v130, 7168, v31
v_add_u32 v131, 10240, v31
v_add_u32 v132, 13312, v31
v_add_u32 v133, 0, v150
v_add_u32 v134, 24576, v151
v_add_u32 v135, 49152, v150
v_add_u32 v136, 73728, v151
v_add_u32 v137, 98304, v150
v_add_u32 v138, 122880, v151
v_add_u32 v139, 0, v154
v_add_u32 v140, 49152, v154
v_add_u32 v141, 98304, v154
Lw_60:
s_cmp_eq_u32 s36, 6
s_cbranch_scc0 Lw_61
v_add_u32 v128, 2048, v31
v_add_u32 v129, 5120, v31
v_add_u32 v130, 8192, v31
v_add_u32 v131, 11264, v31
v_add_u32 v132, 14336, v31
v_add_u32 v133, 8192, v151
v_add_u32 v134, 32768, v150
v_add_u32 v135, 57344, v151
v_add_u32 v136, 81920, v150
v_add_u32 v137, 106496, v151
v_add_u32 v139, 16384, v154
v_add_u32 v140, 65536, v154
v_add_u32 v141, 114688, v154
Lw_61:
v_mfma_f32_16x16x32_bf16 v[192:195], v[72:75], v[64:67], v[192:195]
ds_read_b128 v[32:35], v11 offset:0
ds_read_b128 v[36:39], v11 offset:1024
v_mfma_f32_16x16x32_bf16 v[216:219], v[72:75], v[68:71], v[216:219]
ds_read_b64_tr_b16 v[40:41], v24 offset:0
ds_read_b64_tr_b16 v[42:43], v24 offset:3072
v_mfma_f32_16x16x32_bf16 v[220:223], v[76:79], v[68:71], v[220:223]
ds_read_b64_tr_b16 v[44:45], v25 offset:0
ds_read_b64_tr_b16 v[46:47], v25 offset:3072
s_add_u32 m0, s50, 49152
s_mov_b32 s38, 6881280
buffer_load_dwordx4 v5, s[16:19], s38 offen lds
v_mfma_f32_16x16x32_bf16 v[196:199], v[76:79], v[64:67], v[196:199]
ds_read_b64_tr_b16 v[48:49], v26 offset:0
ds_read_b64_tr_b16 v[50:51], v26 offset:3072
v_mfma_f32_16x16x32_bf16 v[200:203], v[80:83], v[64:67], v[200:203]
ds_read_b64_tr_b16 v[52:53], v24 offset:12288
ds_read_b64_tr_b16 v[54:55], v24 offset:15360
s_add_u32 m0, s50, 50176
s_mov_b32 s38, 6881280
buffer_load_dwordx4 v6, s[16:19], s38 offen lds
v_mfma_f32_16x16x32_bf16 v[224:227], v[80:83], v[68:71], v[224:227]
ds_read_b64_tr_b16 v[56:57], v25 offset:12288
ds_read_b64_tr_b16 v[58:59], v25 offset:15360
v_mfma_f32_16x16x32_bf16 v[228:231], v[84:87], v[68:71], v[228:231]
ds_read_b64_tr_b16 v[60:61], v26 offset:12288
ds_read_b64_tr_b16 v[62:63], v26 offset:15360
s_add_u32 m0, s50, 51200
s_mov_b32 s38, 6881280
buffer_load_dwordx4 v7, s[16:19], s38 offen lds
v_mfma_f32_16x16x32_bf16 v[204:207], v[84:87], v[64:67], v[204:207]
v_mfma_f32_16x16x32_bf16 v[208:211], v[88:91], v[64:67], v[208:211]
s_add_u32 m0, s39, 49152
s_mov_b32 s37, 245760
buffer_load_dwordx4 v2, s[8:11], s37 offen sc1 lds
v_mfma_f32_16x16x32_bf16 v[232:235], v[88:91], v[68:71], v[232:235]
v_mfma_f32_16x16x32_bf16 v[236:239], v[92:95], v[68:71], v[236:239]
buffer_load_dwordx4 v2, s[8:11], s37 offen offset:1024 sc1 lds
v_mfma_f32_16x16x32_bf16 v[212:215], v[92:95], v[64:67], v[212:215]
s_waitcnt lgkmcnt(0)
v_mfma_f32_16x16x32_bf16 v[192:195], v[40:43], v[32:35], v[192:195]
ds_read_b128 v[64:67], v11 offset:8192
ds_read_b128 v[68:71], v11 offset:9216
v_mfma_f32_16x16x32_bf16 v[216:219], v[40:43], v[36:39], v[216:219]
ds_read_b64_tr_b16 v[72:73], v24 offset:6144
ds_read_b64_tr_b16 v[74:75], v24 offset:9216
v_mfma_f32_16x16x32_bf16 v[220:223], v[44:47], v[36:39], v[220:223]
ds_read_b64_tr_b16 v[76:77], v25 offset:6144
ds_read_b64_tr_b16 v[78:79], v25 offset:9216
v_mfma_f32_16x16x32_bf16 v[196:199], v[44:47], v[32:35], v[196:199]
ds_read_b64_tr_b16 v[80:81], v26 offset:6144
ds_read_b64_tr_b16 v[82:83], v26 offset:9216
v_mfma_f32_16x16x32_bf16 v[200:203], v[48:51], v[32:35], v[200:203]
ds_read_b64_tr_b16 v[84:85], v24 offset:18432
ds_read_b64_tr_b16 v[86:87], v24 offset:21504
v_mfma_f32_16x16x32_bf16 v[224:227], v[48:51], v[36:39], v[224:227]
ds_read_b64_tr_b16 v[88:89], v25 offset:18432
ds_read_b64_tr_b16 v[90:91], v25 offset:21504
v_mfma_f32_16x16x32_bf16 v[228:231], v[52:55], v[36:39], v[228:231]
ds_read_b64_tr_b16 v[92:93], v26 offset:18432
ds_read_b64_tr_b16 v[94:95], v26 offset:21504
v_mfma_f32_16x16x32_bf16 v[204:207], v[52:55], v[32:35], v[204:207]
v_mfma_f32_16x16x32_bf16 v[208:211], v[56:59], v[32:35], v[208:211]
v_mfma_f32_16x16x32_bf16 v[232:235], v[56:59], v[36:39], v[232:235]
v_mfma_f32_16x16x32_bf16 v[236:239], v[60:63], v[36:39], v[236:239]
v_mfma_f32_16x16x32_bf16 v[212:215], v[60:63], v[32:35], v[212:215]
s_waitcnt vmcnt(5) lgkmcnt(0)
s_cmp_eq_u32 s36, 7
s_cbranch_scc0 Lw_62
s_waitcnt vmcnt(5)
s_mov_b32 s41, 0x40000
s_branch Lpchk_65
Lpoll_63:
buffer_load_dword v30, v29, s[56:59], 0 offen sc1
s_waitcnt vmcnt(0)
Lpchk_65:
v_readfirstlane_b32 s42, v30
s_cmp_eq_u32 s42, 16
s_cbranch_scc1 Lpok_64
s_sub_u32 s41, s41, 1
s_cmp_lg_u32 s41, 0
s_cbranch_scc1 Lpoll_63
Lpok_64:
Lw_62:
s_barrier
s_cmp_lt_u32 s36, 4
s_cbranch_scc1 Led_66
s_cmp_eq_u32 s36, 4
s_cbranch_scc0 Lw_67
s_mov_b32 m0, 98304
s_nop 0
buffer_load_dwordx4 v128, s[24:27], s52 offen sc1 lds
s_mov_b32 m0, 101376
s_nop 0
buffer_load_dwordx4 v129, s[24:27], s52 offen sc1 lds
s_mov_b32 m0, 104448
s_nop 0
buffer_load_dwordx4 v130, s[24:27], s52 offen sc1 lds
s_mov_b32 m0, 107520
s_nop 0
buffer_load_dwordx4 v131, s[24:27], s52 offen sc1 lds
s_mov_b32 m0, 110592
s_nop 0
buffer_load_dwordx4 v132, s[24:27], s52 offen sc1 lds
s_mov_b32 m0, 113664
s_nop 0
buffer_load_dwordx4 v133, s[24:27], s52 offen sc1 lds
s_mov_b32 m0, 116736
s_nop 0
buffer_load_dwordx4 v134, s[28:31], s53 offen lds
s_mov_b32 m0, 119808
s_nop 0
buffer_load_dwordx4 v135, s[28:31], s53 offen lds
s_mov_b32 m0, 122880
s_nop 0
buffer_load_dwordx4 v136, s[28:31], s53 offen lds
s_mov_b32 m0, 125952
s_nop 0
buffer_load_dwordx4 v137, s[28:31], s53 offen lds
s_mov_b32 m0, 129024
s_nop 0
buffer_load_dwordx4 v138, s[28:31], s53 offen lds
s_add_u32 s52, s52, 16384
s_add_u32 s53, s53, 131072
s_mov_b32 m0, 131072
s_nop 0
buffer_load_dwordx4 v128, s[24:27], s52 offen sc1 lds
s_mov_b32 m0, 134144
s_nop 0
buffer_load_dwordx4 v129, s[24:27], s52 offen sc1 lds
s_mov_b32 m0, 137216
s_nop 0
buffer_load_dwordx4 v130, s[24:27], s52 offen sc1 lds
s_mov_b32 m0, 140288
s_nop 0
buffer_load_dwordx4 v131, s[24:27], s52 offen sc1 lds
s_mov_b32 m0, 143360
s_nop 0
buffer_load_dwordx4 v132, s[24:27], s52 offen sc1 lds
s_mov_b32 m0, 146432
s_nop 0
buffer_load_dwordx4 v133, s[24:27], s52 offen sc1 lds
s_mov_b32 m0, 149504
s_nop 0
buffer_load_dwordx4 v134, s[28:31], s53 offen lds
s_mov_b32 m0, 152576
s_nop 0
buffer_load_dwordx4 v135, s[28:31], s53 offen lds
s_mov_b32 m0, 155648
s_nop 0
buffer_load_dwordx4 v136, s[28:31], s53 offen lds
s_mov_b32 m0, 158720
s_nop 0
buffer_load_dwordx4 v137, s[28:31], s53 offen lds
s_mov_b32 m0, 161792
s_nop 0
buffer_load_dwordx4 v138, s[28:31], s53 offen lds
s_add_u32 s52, s52, 16384
s_add_u32 s53, s53, 131072
Lw_67:
s_cmp_eq_u32 s36, 5
s_cbranch_scc0 Lw_68
s_mov_b32 m0, 99328
s_nop 0
buffer_load_dwordx4 v128, s[24:27], s52 offen sc1 lds
s_mov_b32 m0, 102400
s_nop 0
buffer_load_dwordx4 v129, s[24:27], s52 offen sc1 lds
s_mov_b32 m0, 105472
s_nop 0
buffer_load_dwordx4 v130, s[24:27], s52 offen sc1 lds
s_mov_b32 m0, 108544
s_nop 0
buffer_load_dwordx4 v131, s[24:27], s52 offen sc1 lds
s_mov_b32 m0, 111616
s_nop 0
buffer_load_dwordx4 v132, s[24:27], s52 offen sc1 lds
s_mov_b32 m0, 114688
s_nop 0
buffer_load_dwordx4 v133, s[28:31], s53 offen lds
s_mov_b32 m0, 117760
s_nop 0
buffer_load_dwordx4 v134, s[28:31], s53 offen lds
s_mov_b32 m0, 120832
s_nop 0
buffer_load_dwordx4 v135, s[28:31], s53 offen lds
s_mov_b32 m0, 123904
s_nop 0
buffer_load_dwordx4 v136, s[28:31], s53 offen lds
s_mov_b32 m0, 126976
s_nop 0
buffer_load_dwordx4 v137, s[28:31], s53 offen lds
s_mov_b32 m0, 130048
s_nop 0
buffer_load_dwordx4 v138, s[28:31], s53 offen lds
s_add_u32 s52, s52, 16384
s_add_u32 s53, s53, 131072
s_mov_b32 m0, 132096
s_nop 0
buffer_load_dwordx4 v128, s[24:27], s52 offen sc1 lds
s_mov_b32 m0, 135168
s_nop 0
buffer_load_dwordx4 v129, s[24:27], s52 offen sc1 lds
s_mov_b32 m0, 138240
s_nop 0
buffer_load_dwordx4 v130, s[24:27], s52 offen sc1 lds
s_mov_b32 m0, 141312
s_nop 0
buffer_load_dwordx4 v131, s[24:27], s52 offen sc1 lds
s_mov_b32 m0, 144384
s_nop 0
buffer_load_dwordx4 v132, s[24:27], s52 offen sc1 lds
s_mov_b32 m0, 147456
s_nop 0
buffer_load_dwordx4 v133, s[28:31], s53 offen lds
s_mov_b32 m0, 150528
s_nop 0
buffer_load_dwordx4 v134, s[28:31], s53 offen lds
s_mov_b32 m0, 153600
s_nop 0
buffer_load_dwordx4 v135, s[28:31], s53 offen lds
s_mov_b32 m0, 156672
s_nop 0
buffer_load_dwordx4 v136, s[28:31], s53 offen lds
s_mov_b32 m0, 159744
s_nop 0
buffer_load_dwordx4 v137, s[28:31], s53 offen lds
s_mov_b32 m0, 162816
s_nop 0
buffer_load_dwordx4 v138, s[28:31], s53 offen lds
s_add_u32 s52, s52, 16384
s_add_u32 s53, s53, 131072
Lw_68:
s_cmp_eq_u32 s36, 6
s_cbranch_scc0 Lw_69
s_mov_b32 m0, 100352
s_nop 0
buffer_load_dwordx4 v128, s[24:27], s52 offen sc1 lds
s_mov_b32 m0, 103424
s_nop 0
buffer_load_dwordx4 v129, s[24:27], s52 offen sc1 lds
s_mov_b32 m0, 106496
s_nop 0
buffer_load_dwordx4 v130, s[24:27], s52 offen sc1 lds
s_mov_b32 m0, 109568
s_nop 0
buffer_load_dwordx4 v131, s[24:27], s52 offen sc1 lds
s_mov_b32 m0, 112640
s_nop 0
buffer_load_dwordx4 v132, s[24:27], s52 offen sc1 lds
s_mov_b32 m0, 115712
s_nop 0
buffer_load_dwordx4 v133, s[28:31], s53 offen lds
s_mov_b32 m0, 118784
s_nop 0
buffer_load_dwordx4 v134, s[28:31], s53 offen lds
s_mov_b32 m0, 121856
s_nop 0
buffer_load_dwordx4 v135, s[28:31], s53 offen lds
s_mov_b32 m0, 124928
s_nop 0
buffer_load_dwordx4 v136, s[28:31], s53 offen lds
s_mov_b32 m0, 128000
s_nop 0
buffer_load_dwordx4 v137, s[28:31], s53 offen lds
s_add_u32 s52, s52, 16384
s_add_u32 s53, s53, 131072
s_mov_b32 m0, 133120
s_nop 0
buffer_load_dwordx4 v128, s[24:27], s52 offen sc1 lds
s_mov_b32 m0, 136192
s_nop 0
buffer_load_dwordx4 v129, s[24:27], s52 offen sc1 lds
s_mov_b32 m0, 139264
s_nop 0
buffer_load_dwordx4 v130, s[24:27], s52 offen sc1 lds
s_mov_b32 m0, 142336
s_nop 0
buffer_load_dwordx4 v131, s[24:27], s52 offen sc1 lds
s_mov_b32 m0, 145408
s_nop 0
buffer_load_dwordx4 v132, s[24:27], s52 offen sc1 lds
s_mov_b32 m0, 148480
s_nop 0
buffer_load_dwordx4 v133, s[28:31], s53 offen lds
s_mov_b32 m0, 151552
s_nop 0
buffer_load_dwordx4 v134, s[28:31], s53 offen lds
s_mov_b32 m0, 154624
s_nop 0
buffer_load_dwordx4 v135, s[28:31], s53 offen lds
s_mov_b32 m0, 157696
s_nop 0
buffer_load_dwordx4 v136, s[28:31], s53 offen lds
s_mov_b32 m0, 160768
s_nop 0
buffer_load_dwordx4 v137, s[28:31], s53 offen lds
s_add_u32 s52, s52, 16384
s_add_u32 s53, s53, 131072
Lw_69:
Led_66:
v_mfma_f32_16x16x32_bf16 v[192:195], v[72:75], v[64:67], v[192:195]
ds_read_b128 v[32:35], v10 offset:0
ds_read_b128 v[36:39], v10 offset:1024
v_mfma_f32_16x16x32_bf16 v[216:219], v[72:75], v[68:71], v[216:219]
ds_read_b64_tr_b16 v[40:41], v18 offset:0
ds_read_b64_tr_b16 v[42:43], v18 offset:3072
v_mfma_f32_16x16x32_bf16 v[220:223], v[76:79], v[68:71], v[220:223]
ds_read_b64_tr_b16 v[44:45], v19 offset:0
ds_read_b64_tr_b16 v[46:47], v19 offset:3072
v_mfma_f32_16x16x32_bf16 v[196:199], v[76:79], v[64:67], v[196:199]
ds_read_b64_tr_b16 v[48:49], v20 offset:0
ds_read_b64_tr_b16 v[50:51], v20 offset:3072
v_mfma_f32_16x16x32_bf16 v[200:203], v[80:83], v[64:67], v[200:203]
ds_read_b64_tr_b16 v[52:53], v18 offset:12288
ds_read_b64_tr_b16 v[54:55], v18 offset:15360
v_mfma_f32_16x16x32_bf16 v[224:227], v[80:83], v[68:71], v[224:227]
ds_read_b64_tr_b16 v[56:57], v19 offset:12288
ds_read_b64_tr_b16 v[58:59], v19 offset:15360
v_mfma_f32_16x16x32_bf16 v[228:231], v[84:87], v[68:71], v[228:231]
ds_read_b64_tr_b16 v[60:61], v20 offset:12288
ds_read_b64_tr_b16 v[62:63], v20 offset:15360
v_mfma_f32_16x16x32_bf16 v[204:207], v[84:87], v[64:67], v[204:207]
v_mfma_f32_16x16x32_bf16 v[208:211], v[88:91], v[64:67], v[208:211]
v_mfma_f32_16x16x32_bf16 v[232:235], v[88:91], v[68:71], v[232:235]
v_mfma_f32_16x16x32_bf16 v[236:239], v[92:95], v[68:71], v[236:239]
v_mfma_f32_16x16x32_bf16 v[212:215], v[92:95], v[64:67], v[212:215]
s_waitcnt lgkmcnt(0)
v_mfma_f32_16x16x32_bf16 v[192:195], v[40:43], v[32:35], v[192:195]
ds_read_b128 v[64:67], v10 offset:8192
ds_read_b128 v[68:71], v10 offset:9216
v_mfma_f32_16x16x32_bf16 v[216:219], v[40:43], v[36:39], v[216:219]
ds_read_b64_tr_b16 v[72:73], v18 offset:6144
ds_read_b64_tr_b16 v[74:75], v18 offset:9216
v_mfma_f32_16x16x32_bf16 v[220:223], v[44:47], v[36:39], v[220:223]
ds_read_b64_tr_b16 v[76:77], v19 offset:6144
ds_read_b64_tr_b16 v[78:79], v19 offset:9216
v_mfma_f32_16x16x32_bf16 v[196:199], v[44:47], v[32:35], v[196:199]
ds_read_b64_tr_b16 v[80:81], v20 offset:6144
ds_read_b64_tr_b16 v[82:83], v20 offset:9216
v_mfma_f32_16x16x32_bf16 v[200:203], v[48:51], v[32:35], v[200:203]
ds_read_b64_tr_b16 v[84:85], v18 offset:18432
ds_read_b64_tr_b16 v[86:87], v18 offset:21504
v_mfma_f32_16x16x32_bf16 v[224:227], v[48:51], v[36:39], v[224:227]
ds_read_b64_tr_b16 v[88:89], v19 offset:18432
ds_read_b64_tr_b16 v[90:91], v19 offset:21504
v_mfma_f32_16x16x32_bf16 v[228:231], v[52:55], v[36:39], v[228:231]
ds_read_b64_tr_b16 v[92:93], v20 offset:18432
ds_read_b64_tr_b16 v[94:95], v20 offset:21504
v_mfma_f32_16x16x32_bf16 v[204:207], v[52:55], v[32:35], v[204:207]
v_mfma_f32_16x16x32_bf16 v[208:211], v[56:59], v[32:35], v[208:211]
v_mfma_f32_16x16x32_bf16 v[232:235], v[56:59], v[36:39], v[232:235]
v_mfma_f32_16x16x32_bf16 v[236:239], v[60:63], v[36:39], v[236:239]
v_mfma_f32_16x16x32_bf16 v[212:215], v[60:63], v[32:35], v[212:215]
s_sub_u32 s43, s36, 4
s_cmp_lt_u32 s43, 3
s_cbranch_scc0 Lw_70
s_waitcnt vmcnt(20)
s_branch Lw_71
Lw_70:
s_waitcnt vmcnt(0)
Lw_71:
s_waitcnt lgkmcnt(0)
s_barrier
s_cmp_lt_u32 s36, 4
s_cbranch_scc1 Led_72
s_cmp_eq_u32 s36, 4
s_cbranch_scc0 Lw_73
s_mov_b32 m0, 0
s_nop 0
buffer_load_dwordx4 v128, s[24:27], s52 offen sc1 lds
s_mov_b32 m0, 3072
s_nop 0
buffer_load_dwordx4 v129, s[24:27], s52 offen sc1 lds
s_mov_b32 m0, 6144
s_nop 0
buffer_load_dwordx4 v130, s[24:27], s52 offen sc1 lds
s_mov_b32 m0, 9216
s_nop 0
buffer_load_dwordx4 v131, s[24:27], s52 offen sc1 lds
s_mov_b32 m0, 12288
s_nop 0
buffer_load_dwordx4 v132, s[24:27], s52 offen sc1 lds
s_mov_b32 m0, 15360
s_nop 0
buffer_load_dwordx4 v133, s[24:27], s52 offen sc1 lds
s_mov_b32 m0, 18432
s_nop 0
buffer_load_dwordx4 v134, s[28:31], s53 offen lds
s_mov_b32 m0, 21504
s_nop 0
buffer_load_dwordx4 v135, s[28:31], s53 offen lds
s_mov_b32 m0, 24576
s_nop 0
buffer_load_dwordx4 v136, s[28:31], s53 offen lds
s_mov_b32 m0, 27648
s_nop 0
buffer_load_dwordx4 v137, s[28:31], s53 offen lds
s_mov_b32 m0, 30720
s_nop 0
buffer_load_dwordx4 v138, s[28:31], s53 offen lds
s_add_u32 s52, s52, 16384
s_add_u32 s53, s53, 131072
Lw_73:
s_cmp_eq_u32 s36, 5
s_cbranch_scc0 Lw_74
s_mov_b32 m0, 1024
s_nop 0
buffer_load_dwordx4 v128, s[24:27], s52 offen sc1 lds
s_mov_b32 m0, 4096
s_nop 0
buffer_load_dwordx4 v129, s[24:27], s52 offen sc1 lds
s_mov_b32 m0, 7168
s_nop 0
buffer_load_dwordx4 v130, s[24:27], s52 offen sc1 lds
s_mov_b32 m0, 10240
s_nop 0
buffer_load_dwordx4 v131, s[24:27], s52 offen sc1 lds
s_mov_b32 m0, 13312
s_nop 0
buffer_load_dwordx4 v132, s[24:27], s52 offen sc1 lds
s_mov_b32 m0, 16384
s_nop 0
buffer_load_dwordx4 v133, s[28:31], s53 offen lds
s_mov_b32 m0, 19456
s_nop 0
buffer_load_dwordx4 v134, s[28:31], s53 offen lds
s_mov_b32 m0, 22528
s_nop 0
buffer_load_dwordx4 v135, s[28:31], s53 offen lds
s_mov_b32 m0, 25600
s_nop 0
buffer_load_dwordx4 v136, s[28:31], s53 offen lds
s_mov_b32 m0, 28672
s_nop 0
buffer_load_dwordx4 v137, s[28:31], s53 offen lds
s_mov_b32 m0, 31744
s_nop 0
buffer_load_dwordx4 v138, s[28:31], s53 offen lds
s_add_u32 s52, s52, 16384
s_add_u32 s53, s53, 131072
Lw_74:
s_cmp_eq_u32 s36, 6
s_cbranch_scc0 Lw_75
s_mov_b32 m0, 2048
s_nop 0
buffer_load_dwordx4 v128, s[24:27], s52 offen sc1 lds
s_mov_b32 m0, 5120
s_nop 0
buffer_load_dwordx4 v129, s[24:27], s52 offen sc1 lds
s_mov_b32 m0, 8192
s_nop 0
buffer_load_dwordx4 v130, s[24:27], s52 offen sc1 lds
s_mov_b32 m0, 11264
s_nop 0
buffer_load_dwordx4 v131, s[24:27], s52 offen sc1 lds
s_mov_b32 m0, 14336
s_nop 0
buffer_load_dwordx4 v132, s[24:27], s52 offen sc1 lds
s_mov_b32 m0, 17408
s_nop 0
buffer_load_dwordx4 v133, s[28:31], s53 offen lds
s_mov_b32 m0, 20480
s_nop 0
buffer_load_dwordx4 v134, s[28:31], s53 offen lds
s_mov_b32 m0, 23552
s_nop 0
buffer_load_dwordx4 v135, s[28:31], s53 offen lds
s_mov_b32 m0, 26624
s_nop 0
buffer_load_dwordx4 v136, s[28:31], s53 offen lds
s_mov_b32 m0, 29696
s_nop 0
buffer_load_dwordx4 v137, s[28:31], s53 offen lds
s_add_u32 s52, s52, 16384
s_add_u32 s53, s53, 131072
Lw_75:
Led_72:
v_mfma_f32_16x16x32_bf16 v[192:195], v[72:75], v[64:67], v[192:195]
ds_read_b128 v[32:35], v10 offset:49152
ds_read_b128 v[36:39], v10 offset:50176
v_mfma_f32_16x16x32_bf16 v[216:219], v[72:75], v[68:71], v[216:219]
ds_read_b64_tr_b16 v[40:41], v21 offset:0
ds_read_b64_tr_b16 v[42:43], v21 offset:3072
v_mfma_f32_16x16x32_bf16 v[220:223], v[76:79], v[68:71], v[220:223]
ds_read_b64_tr_b16 v[44:45], v22 offset:0
ds_read_b64_tr_b16 v[46:47], v22 offset:3072
v_mfma_f32_16x16x32_bf16 v[196:199], v[76:79], v[64:67], v[196:199]
ds_read_b64_tr_b16 v[48:49], v23 offset:0
ds_read_b64_tr_b16 v[50:51], v23 offset:3072
v_mfma_f32_16x16x32_bf16 v[200:203], v[80:83], v[64:67], v[200:203]
ds_read_b64_tr_b16 v[52:53], v21 offset:12288
ds_read_b64_tr_b16 v[54:55], v21 offset:15360
v_mfma_f32_16x16x32_bf16 v[224:227], v[80:83], v[68:71], v[224:227]
ds_read_b64_tr_b16 v[56:57], v22 offset:12288
ds_read_b64_tr_b16 v[58:59], v22 offset:15360
v_mfma_f32_16x16x32_bf16 v[228:231], v[84:87], v[68:71], v[228:231]
ds_read_b64_tr_b16 v[60:61], v23 offset:12288
ds_read_b64_tr_b16 v[62:63], v23 offset:15360
v_mfma_f32_16x16x32_bf16 v[204:207], v[84:87], v[64:67], v[204:207]
v_mfma_f32_16x16x32_bf16 v[208:211], v[88:91], v[64:67], v[208:211]
v_mfma_f32_16x16x32_bf16 v[232:235], v[88:91], v[68:71], v[232:235]
v_mfma_f32_16x16x32_bf16 v[236:239], v[92:95], v[68:71], v[236:239]
v_mfma_f32_16x16x32_bf16 v[212:215], v[92:95], v[64:67], v[212:215]
s_cmp_lt_u32 s36, 4
s_cbranch_scc0 Lw_76
v_lshlrev_b32 v128, 16, v160
v_and_b32 v129, 0xffff0000, v160
v_lshlrev_b32 v130, 16, v161
v_and_b32 v131, 0xffff0000, v161
v_lshlrev_b32 v132, 16, v162
v_and_b32 v133, 0xffff0000, v162
v_lshlrev_b32 v134, 16, v163
v_and_b32 v135, 0xffff0000, v163
v_lshlrev_b32 v136, 16, v164
v_and_b32 v137, 0xffff0000, v164
v_lshlrev_b32 v138, 16, v165
v_and_b32 v139, 0xffff0000, v165
v_lshlrev_b32 v140, 16, v166
v_and_b32 v141, 0xffff0000, v166
v_lshlrev_b32 v142, 16, v167
v_and_b32 v143, 0xffff0000, v167
v_lshlrev_b32 v144, 16, v168
v_and_b32 v145, 0xffff0000, v168
v_lshlrev_b32 v146, 16, v169
v_and_b32 v147, 0xffff0000, v169
v_lshlrev_b32 v148, 16, v170
v_and_b32 v149, 0xffff0000, v170
v_lshlrev_b32 v150, 16, v171
v_and_b32 v151, 0xffff0000, v171
v_lshlrev_b32 v152, 16, v172
v_and_b32 v153, 0xffff0000, v172
v_lshlrev_b32 v154, 16, v173
v_and_b32 v155, 0xffff0000, v173
v_lshlrev_b32 v156, 16, v174
v_and_b32 v157, 0xffff0000, v174
v_lshlrev_b32 v158, 16, v175
v_and_b32 v159, 0xffff0000, v175
v_mov_b32 v160, 0
v_mov_b32 v161, 0
v_mov_b32 v162, 0
v_mov_b32 v163, 0
v_mov_b32 v164, 0
v_mov_b32 v165, 0
v_mov_b32 v166, 0
v_mov_b32 v167, 0
v_mov_b32 v168, 0
v_mov_b32 v169, 0
v_mov_b32 v170, 0
v_mov_b32 v171, 0
v_mov_b32 v172, 0
v_mov_b32 v173, 0
v_mov_b32 v174, 0
v_mov_b32 v175, 0
v_mov_b32 v176, 0
v_mov_b32 v177, 0
v_mov_b32 v178, 0
v_mov_b32 v179, 0
v_mov_b32 v180, 0
v_mov_b32 v181, 0
v_mov_b32 v182, 0
v_mov_b32 v183, 0
v_mov_b32 v184, 0
v_mov_b32 v185, 0
v_mov_b32 v186, 0
v_mov_b32 v187, 0
v_mov_b32 v188, 0
v_mov_b32 v189, 0
v_mov_b32 v190, 0
v_mov_b32 v191, 0
Lw_76:
s_waitcnt lgkmcnt(0)
v_mfma_f32_16x16x32_bf16 v[192:195], v[40:43], v[32:35], v[192:195]
ds_read_b128 v[64:67], v10 offset:57344
ds_read_b128 v[68:71], v10 offset:58368
v_mfma_f32_16x16x32_bf16 v[216:219], v[40:43], v[36:39], v[216:219]
ds_read_b64_tr_b16 v[72:73], v21 offset:6144
ds_read_b64_tr_b16 v[74:75], v21 offset:9216
v_mfma_f32_16x16x32_bf16 v[220:223], v[44:47], v[36:39], v[220:223]
ds_read_b64_tr_b16 v[76:77], v22 offset:6144
ds_read_b64_tr_b16 v[78:79], v22 offset:9216
v_mfma_f32_16x16x32_bf16 v[196:199], v[44:47], v[32:35], v[196:199]
ds_read_b64_tr_b16 v[80:81], v23 offset:6144
ds_read_b64_tr_b16 v[82:83], v23 offset:9216
v_mfma_f32_16x16x32_bf16 v[200:203], v[48:51], v[32:35], v[200:203]
ds_read_b64_tr_b16 v[84:85], v21 offset:18432
ds_read_b64_tr_b16 v[86:87], v21 offset:21504
v_mfma_f32_16x16x32_bf16 v[224:227], v[48:51], v[36:39], v[224:227]
ds_read_b64_tr_b16 v[88:89], v22 offset:18432
ds_read_b64_tr_b16 v[90:91], v22 offset:21504
v_mfma_f32_16x16x32_bf16 v[228:231], v[52:55], v[36:39], v[228:231]
ds_read_b64_tr_b16 v[92:93], v23 offset:18432
ds_read_b64_tr_b16 v[94:95], v23 offset:21504
v_mfma_f32_16x16x32_bf16 v[204:207], v[52:55], v[32:35], v[204:207]
v_mfma_f32_16x16x32_bf16 v[208:211], v[56:59], v[32:35], v[208:211]
v_mfma_f32_16x16x32_bf16 v[232:235], v[56:59], v[36:39], v[232:235]
v_mfma_f32_16x16x32_bf16 v[236:239], v[60:63], v[36:39], v[236:239]
v_mfma_f32_16x16x32_bf16 v[212:215], v[60:63], v[32:35], v[212:215]
s_sub_u32 s43, s36, 4
s_cmp_lt_u32 s43, 3
s_cbranch_scc0 Lw_77
s_waitcnt vmcnt(20)
Lw_77:
s_waitcnt lgkmcnt(0)
s_barrier
s_cmp_lt_u32 s36, 4
s_cbranch_scc1 Led_78
s_cmp_eq_u32 s36, 4
s_cbranch_scc0 Lw_79
s_mov_b32 m0, 32768
s_nop 0
buffer_load_dwordx4 v128, s[24:27], s52 offen sc1 lds
s_mov_b32 m0, 35840
s_nop 0
buffer_load_dwordx4 v129, s[24:27], s52 offen sc1 lds
s_mov_b32 m0, 38912
s_nop 0
buffer_load_dwordx4 v130, s[24:27], s52 offen sc1 lds
s_mov_b32 m0, 41984
s_nop 0
buffer_load_dwordx4 v131, s[24:27], s52 offen sc1 lds
s_mov_b32 m0, 45056
s_nop 0
buffer_load_dwordx4 v132, s[24:27], s52 offen sc1 lds
s_mov_b32 m0, 48128
s_nop 0
buffer_load_dwordx4 v133, s[24:27], s52 offen sc1 lds
s_mov_b32 m0, 51200
s_nop 0
buffer_load_dwordx4 v134, s[28:31], s53 offen lds
s_mov_b32 m0, 54272
s_nop 0
buffer_load_dwordx4 v135, s[28:31], s53 offen lds
s_mov_b32 m0, 57344
s_nop 0
buffer_load_dwordx4 v136, s[28:31], s53 offen lds
s_mov_b32 m0, 60416
s_nop 0
buffer_load_dwordx4 v137, s[28:31], s53 offen lds
s_mov_b32 m0, 63488
s_nop 0
buffer_load_dwordx4 v138, s[28:31], s53 offen lds
s_add_u32 s52, s52, 16384
s_add_u32 s53, s53, 131072
s_mov_b32 m0, 65536
s_nop 0
buffer_load_dwordx4 v128, s[24:27], s52 offen sc1 lds
s_mov_b32 m0, 68608
s_nop 0
buffer_load_dwordx4 v129, s[24:27], s52 offen sc1 lds
s_mov_b32 m0, 71680
s_nop 0
buffer_load_dwordx4 v130, s[24:27], s52 offen sc1 lds
s_mov_b32 m0, 74752
s_nop 0
buffer_load_dwordx4 v131, s[24:27], s52 offen sc1 lds
s_mov_b32 m0, 77824
s_nop 0
buffer_load_dwordx4 v132, s[24:27], s52 offen sc1 lds
s_mov_b32 m0, 80896
s_nop 0
buffer_load_dwordx4 v133, s[24:27], s52 offen sc1 lds
s_mov_b32 m0, 83968
s_nop 0
buffer_load_dwordx4 v134, s[28:31], s53 offen lds
s_mov_b32 m0, 87040
s_nop 0
buffer_load_dwordx4 v135, s[28:31], s53 offen lds
s_mov_b32 m0, 90112
s_nop 0
buffer_load_dwordx4 v136, s[28:31], s53 offen lds
s_mov_b32 m0, 93184
s_nop 0
buffer_load_dwordx4 v137, s[28:31], s53 offen lds
s_mov_b32 m0, 96256
s_nop 0
buffer_load_dwordx4 v138, s[28:31], s53 offen lds
s_add_u32 s52, s52, 16384
s_add_u32 s53, s53, 131072
Lw_79:
s_cmp_eq_u32 s36, 5
s_cbranch_scc0 Lw_80
s_mov_b32 m0, 33792
s_nop 0
buffer_load_dwordx4 v128, s[24:27], s52 offen sc1 lds
s_mov_b32 m0, 36864
s_nop 0
buffer_load_dwordx4 v129, s[24:27], s52 offen sc1 lds
s_mov_b32 m0, 39936
s_nop 0
buffer_load_dwordx4 v130, s[24:27], s52 offen sc1 lds
s_mov_b32 m0, 43008
s_nop 0
buffer_load_dwordx4 v131, s[24:27], s52 offen sc1 lds
s_mov_b32 m0, 46080
s_nop 0
buffer_load_dwordx4 v132, s[24:27], s52 offen sc1 lds
s_mov_b32 m0, 49152
s_nop 0
buffer_load_dwordx4 v133, s[28:31], s53 offen lds
s_mov_b32 m0, 52224
s_nop 0
buffer_load_dwordx4 v134, s[28:31], s53 offen lds
s_mov_b32 m0, 55296
s_nop 0
buffer_load_dwordx4 v135, s[28:31], s53 offen lds
s_mov_b32 m0, 58368
s_nop 0
buffer_load_dwordx4 v136, s[28:31], s53 offen lds
s_mov_b32 m0, 61440
s_nop 0
buffer_load_dwordx4 v137, s[28:31], s53 offen lds
s_mov_b32 m0, 64512
s_nop 0
buffer_load_dwordx4 v138, s[28:31], s53 offen lds
s_add_u32 s52, s52, 16384
s_add_u32 s53, s53, 131072
s_mov_b32 m0, 66560
s_nop 0
buffer_load_dwordx4 v128, s[24:27], s52 offen sc1 lds
s_mov_b32 m0, 69632
s_nop 0
buffer_load_dwordx4 v129, s[24:27], s52 offen sc1 lds
s_mov_b32 m0, 72704
s_nop 0
buffer_load_dwordx4 v130, s[24:27], s52 offen sc1 lds
s_mov_b32 m0, 75776
s_nop 0
buffer_load_dwordx4 v131, s[24:27], s52 offen sc1 lds
s_mov_b32 m0, 78848
s_nop 0
buffer_load_dwordx4 v132, s[24:27], s52 offen sc1 lds
s_mov_b32 m0, 81920
s_nop 0
buffer_load_dwordx4 v133, s[28:31], s53 offen lds
s_mov_b32 m0, 84992
s_nop 0
buffer_load_dwordx4 v134, s[28:31], s53 offen lds
s_mov_b32 m0, 88064
s_nop 0
buffer_load_dwordx4 v135, s[28:31], s53 offen lds
s_mov_b32 m0, 91136
s_nop 0
buffer_load_dwordx4 v136, s[28:31], s53 offen lds
s_mov_b32 m0, 94208
s_nop 0
buffer_load_dwordx4 v137, s[28:31], s53 offen lds
s_mov_b32 m0, 97280
s_nop 0
buffer_load_dwordx4 v138, s[28:31], s53 offen lds
s_add_u32 s52, s52, 16384
s_add_u32 s53, s53, 131072
Lw_80:
s_cmp_eq_u32 s36, 6
s_cbranch_scc0 Lw_81
s_mov_b32 m0, 34816
s_nop 0
buffer_load_dwordx4 v128, s[24:27], s52 offen sc1 lds
s_mov_b32 m0, 37888
s_nop 0
buffer_load_dwordx4 v129, s[24:27], s52 offen sc1 lds
s_mov_b32 m0, 40960
s_nop 0
buffer_load_dwordx4 v130, s[24:27], s52 offen sc1 lds
s_mov_b32 m0, 44032
s_nop 0
buffer_load_dwordx4 v131, s[24:27], s52 offen sc1 lds
s_mov_b32 m0, 47104
s_nop 0
buffer_load_dwordx4 v132, s[24:27], s52 offen sc1 lds
s_mov_b32 m0, 50176
s_nop 0
buffer_load_dwordx4 v133, s[28:31], s53 offen lds
s_mov_b32 m0, 53248
s_nop 0
buffer_load_dwordx4 v134, s[28:31], s53 offen lds
s_mov_b32 m0, 56320
s_nop 0
buffer_load_dwordx4 v135, s[28:31], s53 offen lds
s_mov_b32 m0, 59392
s_nop 0
buffer_load_dwordx4 v136, s[28:31], s53 offen lds
s_mov_b32 m0, 62464
s_nop 0
buffer_load_dwordx4 v137, s[28:31], s53 offen lds
s_add_u32 s52, s52, 16384
s_add_u32 s53, s53, 131072
s_mov_b32 m0, 67584
s_nop 0
buffer_load_dwordx4 v128, s[24:27], s52 offen sc1 lds
s_mov_b32 m0, 70656
s_nop 0
buffer_load_dwordx4 v129, s[24:27], s52 offen sc1 lds
s_mov_b32 m0, 73728
s_nop 0
buffer_load_dwordx4 v130, s[24:27], s52 offen sc1 lds
s_mov_b32 m0, 76800
s_nop 0
buffer_load_dwordx4 v131, s[24:27], s52 offen sc1 lds
s_mov_b32 m0, 79872
s_nop 0
buffer_load_dwordx4 v132, s[24:27], s52 offen sc1 lds
s_mov_b32 m0, 82944
s_nop 0
buffer_load_dwordx4 v133, s[28:31], s53 offen lds
s_mov_b32 m0, 86016
s_nop 0
buffer_load_dwordx4 v134, s[28:31], s53 offen lds
s_mov_b32 m0, 89088
s_nop 0
buffer_load_dwordx4 v135, s[28:31], s53 offen lds
s_mov_b32 m0, 92160
s_nop 0
buffer_load_dwordx4 v136, s[28:31], s53 offen lds
s_mov_b32 m0, 95232
s_nop 0
buffer_load_dwordx4 v137, s[28:31], s53 offen lds
s_add_u32 s52, s52, 16384
s_add_u32 s53, s53, 131072
Lw_81:
Led_78:
s_cmp_lt_u32 s36, 4
s_cbranch_scc0 Lw_82
ds_read_b128 v[32:35], v244 offset:32768
ds_read_b64_tr_b16 v[48:49], v245 offset:32768
ds_read_b64_tr_b16 v[50:51], v245 offset:36864
ds_read_b64_tr_b16 v[52:53], v246 offset:32768
ds_read_b64_tr_b16 v[54:55], v246 offset:36864
ds_read_b64_tr_b16 v[56:57], v247 offset:32768
ds_read_b64_tr_b16 v[58:59], v247 offset:36864
ds_read_b64_tr_b16 v[60:61], v248 offset:32768
ds_read_b64_tr_b16 v[62:63], v248 offset:36864
ds_read_b128 v[36:39], v244 offset:33792
ds_read_b128 v[40:43], v244 offset:34816
ds_read_b128 v[44:47], v244 offset:35840
Lw_82:
v_mfma_f32_16x16x32_bf16 v[192:195], v[72:75], v[64:67], v[192:195]
v_mfma_f32_16x16x32_bf16 v[216:219], v[72:75], v[68:71], v[216:219]
v_mfma_f32_16x16x32_bf16 v[220:223], v[76:79], v[68:71], v[220:223]
v_mfma_f32_16x16x32_bf16 v[196:199], v[76:79], v[64:67], v[196:199]
v_mfma_f32_16x16x32_bf16 v[200:203], v[80:83], v[64:67], v[200:203]
v_mfma_f32_16x16x32_bf16 v[224:227], v[80:83], v[68:71], v[224:227]
v_mfma_f32_16x16x32_bf16 v[228:231], v[84:87], v[68:71], v[228:231]
v_mfma_f32_16x16x32_bf16 v[204:207], v[84:87], v[64:67], v[204:207]
v_mfma_f32_16x16x32_bf16 v[208:211], v[88:91], v[64:67], v[208:211]
v_mfma_f32_16x16x32_bf16 v[232:235], v[88:91], v[68:71], v[232:235]
v_mfma_f32_16x16x32_bf16 v[236:239], v[92:95], v[68:71], v[236:239]
v_mfma_f32_16x16x32_bf16 v[212:215], v[92:95], v[64:67], v[212:215]
s_cmp_lt_u32 s36, 4
s_cbranch_scc0 Lw_83
ds_read_b128 v[64:67], v244 offset:40960
ds_read_b64_tr_b16 v[80:81], v245 offset:40960
ds_read_b64_tr_b16 v[82:83], v245 offset:45056
ds_read_b64_tr_b16 v[84:85], v246 offset:40960
ds_read_b64_tr_b16 v[86:87], v246 offset:45056
ds_read_b64_tr_b16 v[88:89], v247 offset:40960
ds_read_b64_tr_b16 v[90:91], v247 offset:45056
ds_read_b64_tr_b16 v[92:93], v248 offset:40960
ds_read_b64_tr_b16 v[94:95], v248 offset:45056
ds_read_b128 v[68:71], v244 offset:41984
ds_read_b128 v[72:75], v244 offset:43008
ds_read_b128 v[76:79], v244 offset:44032
Lw_83:
v_mul_f32 v4, v241, v241
v_mul_f32 v2, 0xc0135761, v241
v_mul_f32 v3, 0xbdd2d3e8, v241
v_mul_f32 v3, v3, v4
v_rcp_f32 v4, v4
v_mul_f32 v8, v243, v243
v_mul_f32 v6, 0xc0135761, v243
v_mul_f32 v7, 0xbdd2d3e8, v243
v_mul_f32 v7, v7, v8
v_rcp_f32 v8, v8
s_mul_i32 s54, s35, 24576
s_lshr_b32 s43, s36, 1
s_lshl_b32 s43, s43, 11
s_add_u32 s54, s54, s43
s_add_u32 s54, s54, 524288
s_lshl_b32 s43, s51, 9
s_add_u32 s55, s54, s43
s_add_u32 s55, s55, 16384
s_lshl_b32 s43, s51, 13
s_add_u32 s54, s54, s43
v_and_b32 v10, 32, v1
v_lshlrev_b32 v10, 4, v10
v_add_u32 v10, v10, v31
v_pk_mul_f32 v[16:17], v[192:193], v[192:193]
v_pk_mul_f32 v[18:19], v[194:195], v[194:195]
v_pk_mul_f32 v[20:21], v[216:217], v[216:217]
v_pk_mul_f32 v[22:23], v[218:219], v[218:219]
v_pk_fma_f32 v[16:17], v[16:17], v[2:3], v[2:3] op_sel:[0,1,0] op_sel_hi:[1,1,0]
v_pk_fma_f32 v[18:19], v[18:19], v[2:3], v[2:3] op_sel:[0,1,0] op_sel_hi:[1,1,0]
v_pk_fma_f32 v[20:21], v[20:21], v[6:7], v[6:7] op_sel:[0,1,0] op_sel_hi:[1,1,0]
v_pk_fma_f32 v[22:23], v[22:23], v[6:7], v[6:7] op_sel:[0,1,0] op_sel_hi:[1,1,0]
v_pk_mul_f32 v[16:17], v[16:17], v[192:193]
v_pk_mul_f32 v[18:19], v[18:19], v[194:195]
v_pk_mul_f32 v[20:21], v[20:21], v[216:217]
v_pk_mul_f32 v[22:23], v[22:23], v[218:219]
v_exp_f32 v16, v16
v_exp_f32 v17, v17
v_exp_f32 v18, v18
v_exp_f32 v19, v19
v_exp_f32 v20, v20
v_exp_f32 v21, v21
v_exp_f32 v22, v22
v_exp_f32 v23, v23
v_pk_mul_f32 v[204:205], v[192:193], v[204:205]
v_pk_mul_f32 v[206:207], v[194:195], v[206:207]
v_pk_mul_f32 v[228:229], v[216:217], v[228:229]
v_pk_mul_f32 v[230:231], v[218:219], v[230:231]
v_pk_fma_f32 v[16:17], v[16:17], v[4:5], v[4:5] op_sel_hi:[1,0,0]
v_pk_fma_f32 v[18:19], v[18:19], v[4:5], v[4:5] op_sel_hi:[1,0,0]
v_pk_fma_f32 v[20:21], v[20:21], v[8:9], v[8:9] op_sel_hi:[1,0,0]
v_pk_fma_f32 v[22:23], v[22:23], v[8:9], v[8:9] op_sel_hi:[1,0,0]
v_rcp_f32 v16, v16
v_rcp_f32 v17, v17
v_rcp_f32 v18, v18
v_rcp_f32 v19, v19
v_rcp_f32 v20, v20
v_rcp_f32 v21, v21
v_rcp_f32 v22, v22
v_rcp_f32 v23, v23
v_pk_mul_f32 v[204:205], v[204:205], v[16:17]
v_pk_mul_f32 v[206:207], v[206:207], v[18:19]
v_pk_mul_f32 v[228:229], v[228:229], v[20:21]
v_pk_mul_f32 v[230:231], v[230:231], v[22:23]
v_cvt_pk_bf16_f32 v192, v204, v205
v_cvt_pk_bf16_f32 v193, v206, v207
v_cvt_pk_bf16_f32 v216, v228, v229
v_cvt_pk_bf16_f32 v217, v230, v231
v_pk_mul_f32 v[16:17], v[196:197], v[196:197]
v_pk_mul_f32 v[18:19], v[198:199], v[198:199]
v_pk_mul_f32 v[20:21], v[220:221], v[220:221]
v_pk_mul_f32 v[22:23], v[222:223], v[222:223]
v_pk_fma_f32 v[16:17], v[16:17], v[2:3], v[2:3] op_sel:[0,1,0] op_sel_hi:[1,1,0]
v_pk_fma_f32 v[18:19], v[18:19], v[2:3], v[2:3] op_sel:[0,1,0] op_sel_hi:[1,1,0]
v_pk_fma_f32 v[20:21], v[20:21], v[6:7], v[6:7] op_sel:[0,1,0] op_sel_hi:[1,1,0]
v_pk_fma_f32 v[22:23], v[22:23], v[6:7], v[6:7] op_sel:[0,1,0] op_sel_hi:[1,1,0]
v_pk_mul_f32 v[16:17], v[16:17], v[196:197]
v_pk_mul_f32 v[18:19], v[18:19], v[198:199]
v_pk_mul_f32 v[20:21], v[20:21], v[220:221]
v_pk_mul_f32 v[22:23], v[22:23], v[222:223]
v_exp_f32 v16, v16
v_exp_f32 v17, v17
v_exp_f32 v18, v18
v_exp_f32 v19, v19
v_exp_f32 v20, v20
v_exp_f32 v21, v21
v_exp_f32 v22, v22
v_exp_f32 v23, v23
v_pk_mul_f32 v[208:209], v[196:197], v[208:209]
v_pk_mul_f32 v[210:211], v[198:199], v[210:211]
v_pk_mul_f32 v[232:233], v[220:221], v[232:233]
v_pk_mul_f32 v[234:235], v[222:223], v[234:235]
v_pk_fma_f32 v[16:17], v[16:17], v[4:5], v[4:5] op_sel_hi:[1,0,0]
v_pk_fma_f32 v[18:19], v[18:19], v[4:5], v[4:5] op_sel_hi:[1,0,0]
v_pk_fma_f32 v[20:21], v[20:21], v[8:9], v[8:9] op_sel_hi:[1,0,0]
v_pk_fma_f32 v[22:23], v[22:23], v[8:9], v[8:9] op_sel_hi:[1,0,0]
v_rcp_f32 v16, v16
v_rcp_f32 v17, v17
v_rcp_f32 v18, v18
v_rcp_f32 v19, v19
v_rcp_f32 v20, v20
v_rcp_f32 v21, v21
v_rcp_f32 v22, v22
v_rcp_f32 v23, v23
v_pk_mul_f32 v[208:209], v[208:209], v[16:17]
v_pk_mul_f32 v[210:211], v[210:211], v[18:19]
v_pk_mul_f32 v[232:233], v[232:233], v[20:21]
v_pk_mul_f32 v[234:235], v[234:235], v[22:23]
v_cvt_pk_bf16_f32 v194, v208, v209
v_cvt_pk_bf16_f32 v195, v210, v211
v_cvt_pk_bf16_f32 v218, v232, v233
v_cvt_pk_bf16_f32 v219, v234, v235
buffer_store_dwordx4 v[192:195], v31, s[24:27], s54 offen offset:0 sc1
buffer_store_dwordx4 v[216:219], v31, s[24:27], s54 offen offset:1024 sc1
v_pk_mul_f32 v[16:17], v[200:201], v[200:201]
v_pk_mul_f32 v[18:19], v[202:203], v[202:203]
v_pk_mul_f32 v[20:21], v[224:225], v[224:225]
v_pk_mul_f32 v[22:23], v[226:227], v[226:227]
v_pk_fma_f32 v[16:17], v[16:17], v[2:3], v[2:3] op_sel:[0,1,0] op_sel_hi:[1,1,0]
v_pk_fma_f32 v[18:19], v[18:19], v[2:3], v[2:3] op_sel:[0,1,0] op_sel_hi:[1,1,0]
v_pk_fma_f32 v[20:21], v[20:21], v[6:7], v[6:7] op_sel:[0,1,0] op_sel_hi:[1,1,0]
v_pk_fma_f32 v[22:23], v[22:23], v[6:7], v[6:7] op_sel:[0,1,0] op_sel_hi:[1,1,0]
v_pk_mul_f32 v[16:17], v[16:17], v[200:201]
v_pk_mul_f32 v[18:19], v[18:19], v[202:203]
v_pk_mul_f32 v[20:21], v[20:21], v[224:225]
v_pk_mul_f32 v[22:23], v[22:23], v[226:227]
v_exp_f32 v16, v16
v_exp_f32 v17, v17
v_exp_f32 v18, v18
v_exp_f32 v19, v19
v_exp_f32 v20, v20
v_exp_f32 v21, v21
v_exp_f32 v22, v22
v_exp_f32 v23, v23
v_pk_mul_f32 v[212:213], v[200:201], v[212:213]
v_pk_mul_f32 v[214:215], v[202:203], v[214:215]
v_pk_mul_f32 v[236:237], v[224:225], v[236:237]
v_pk_mul_f32 v[238:239], v[226:227], v[238:239]
v_pk_fma_f32 v[16:17], v[16:17], v[4:5], v[4:5] op_sel_hi:[1,0,0]
v_pk_fma_f32 v[18:19], v[18:19], v[4:5], v[4:5] op_sel_hi:[1,0,0]
v_pk_fma_f32 v[20:21], v[20:21], v[8:9], v[8:9] op_sel_hi:[1,0,0]
v_pk_fma_f32 v[22:23], v[22:23], v[8:9], v[8:9] op_sel_hi:[1,0,0]
v_rcp_f32 v16, v16
v_rcp_f32 v17, v17
v_rcp_f32 v18, v18
v_rcp_f32 v19, v19
v_rcp_f32 v20, v20
v_rcp_f32 v21, v21
v_rcp_f32 v22, v22
v_rcp_f32 v23, v23
v_pk_mul_f32 v[212:213], v[212:213], v[16:17]
v_pk_mul_f32 v[214:215], v[214:215], v[18:19]
v_pk_mul_f32 v[236:237], v[236:237], v[20:21]
v_pk_mul_f32 v[238:239], v[238:239], v[22:23]
v_cvt_pk_bf16_f32 v12, v212, v213
v_cvt_pk_bf16_f32 v13, v214, v215
v_cvt_pk_bf16_f32 v14, v236, v237
v_cvt_pk_bf16_f32 v15, v238, v239
s_nop 1
v_permlane32_swap_b32 v12, v14
v_permlane32_swap_b32 v13, v15
buffer_store_dwordx4 v[12:15], v10, s[24:27], s55 offen sc1
s_cmp_ge_u32 s36, 4
s_cbranch_scc1 Lprod_84
v_subrev_u32 v9, 0x10000, v244
v_add_u32 v10, 0x10000, v244
v_subrev_u32 v11, 0x10000, v245
v_add_u32 v15, 0x10000, v245
v_subrev_u32 v12, 0x10000, v246
v_add_u32 v16, 0x10000, v246
v_subrev_u32 v13, 0x10000, v247
v_add_u32 v17, 0x10000, v247
v_subrev_u32 v14, 0x10000, v248
v_add_u32 v18, 0x10000, v248
s_waitcnt lgkmcnt(0)
s_barrier
v_mfma_f32_16x16x32_bf16 v[128:131], v[48:51], v[32:35], v[128:131]
ds_read_b128 v[96:99], v10 offset:0
ds_read_b64_tr_b16 v[112:113], v15 offset:0
v_mfma_f32_16x16x32_bf16 v[132:135], v[52:55], v[32:35], v[132:135]
ds_read_b64_tr_b16 v[114:115], v15 offset:4096
ds_read_b64_tr_b16 v[116:117], v16 offset:0
v_mfma_f32_16x16x32_bf16 v[160:163], v[56:59], v[32:35], v[160:163]
ds_read_b64_tr_b16 v[118:119], v16 offset:4096
ds_read_b64_tr_b16 v[120:121], v17 offset:0
v_mfma_f32_16x16x32_bf16 v[164:167], v[60:63], v[32:35], v[164:167]
ds_read_b64_tr_b16 v[122:123], v17 offset:4096
ds_read_b64_tr_b16 v[124:125], v18 offset:0
v_mfma_f32_16x16x32_bf16 v[172:175], v[60:63], v[36:39], v[172:175]
ds_read_b64_tr_b16 v[126:127], v18 offset:4096
ds_read_b128 v[100:103], v10 offset:1024
v_mfma_f32_16x16x32_bf16 v[168:171], v[56:59], v[36:39], v[168:171]
ds_read_b128 v[104:107], v10 offset:2048
ds_read_b128 v[108:111], v10 offset:3072
v_mfma_f32_16x16x32_bf16 v[140:143], v[52:55], v[36:39], v[140:143]
ds_read_b128 v[192:195], v10 offset:8192
ds_read_b64_tr_b16 v[208:209], v15 offset:8192
v_mfma_f32_16x16x32_bf16 v[136:139], v[48:51], v[36:39], v[136:139]
ds_read_b64_tr_b16 v[210:211], v15 offset:12288
ds_read_b64_tr_b16 v[212:213], v16 offset:8192
v_mfma_f32_16x16x32_bf16 v[144:147], v[48:51], v[40:43], v[144:147]
ds_read_b64_tr_b16 v[214:215], v16 offset:12288
ds_read_b64_tr_b16 v[216:217], v17 offset:8192
v_mfma_f32_16x16x32_bf16 v[148:151], v[52:55], v[40:43], v[148:151]
ds_read_b64_tr_b16 v[218:219], v17 offset:12288
ds_read_b64_tr_b16 v[220:221], v18 offset:8192
v_mfma_f32_16x16x32_bf16 v[176:179], v[56:59], v[40:43], v[176:179]
ds_read_b64_tr_b16 v[222:223], v18 offset:12288
ds_read_b128 v[196:199], v10 offset:9216
v_mfma_f32_16x16x32_bf16 v[180:183], v[60:63], v[40:43], v[180:183]
ds_read_b128 v[200:203], v10 offset:10240
ds_read_b128 v[204:207], v10 offset:11264
v_mfma_f32_16x16x32_bf16 v[188:191], v[60:63], v[44:47], v[188:191]
v_mfma_f32_16x16x32_bf16 v[184:187], v[56:59], v[44:47], v[184:187]
v_mfma_f32_16x16x32_bf16 v[156:159], v[52:55], v[44:47], v[156:159]
v_mfma_f32_16x16x32_bf16 v[152:155], v[48:51], v[44:47], v[152:155]
v_mfma_f32_16x16x32_bf16 v[128:131], v[80:83], v[64:67], v[128:131]
v_mfma_f32_16x16x32_bf16 v[132:135], v[84:87], v[64:67], v[132:135]
v_mfma_f32_16x16x32_bf16 v[160:163], v[88:91], v[64:67], v[160:163]
v_mfma_f32_16x16x32_bf16 v[164:167], v[92:95], v[64:67], v[164:167]
v_mfma_f32_16x16x32_bf16 v[172:175], v[92:95], v[68:71], v[172:175]
v_mfma_f32_16x16x32_bf16 v[168:171], v[88:91], v[68:71], v[168:171]
v_mfma_f32_16x16x32_bf16 v[140:143], v[84:87], v[68:71], v[140:143]
v_mfma_f32_16x16x32_bf16 v[136:139], v[80:83], v[68:71], v[136:139]
v_mfma_f32_16x16x32_bf16 v[144:147], v[80:83], v[72:75], v[144:147]
v_mfma_f32_16x16x32_bf16 v[148:151], v[84:87], v[72:75], v[148:151]
v_mfma_f32_16x16x32_bf16 v[176:179], v[88:91], v[72:75], v[176:179]
v_mfma_f32_16x16x32_bf16 v[180:183], v[92:95], v[72:75], v[180:183]
v_mfma_f32_16x16x32_bf16 v[188:191], v[92:95], v[76:79], v[188:191]
v_mfma_f32_16x16x32_bf16 v[184:187], v[88:91], v[76:79], v[184:187]
v_mfma_f32_16x16x32_bf16 v[156:159], v[84:87], v[76:79], v[156:159]
v_mfma_f32_16x16x32_bf16 v[152:155], v[80:83], v[76:79], v[152:155]
s_add_u32 s84, s82, 33554432
s_addc_u32 s85, s83, 0
s_mov_b32 s86, 8388608
s_mov_b32 s87, 0x20000
s_xor_b32 s43, s2, 2
s_lshl_b32 s44, s43, 2
s_add_u32 s44, s44, s36
s_lshl_b32 s44, s44, 13
s_add_u32 s45, s44, 4096
s_lshl_b32 s46, s2, 2
s_add_u32 s46, s46, s36
s_lshl_b32 s46, s46, 13
s_add_u32 s47, s46, 4096
s_add_u32 s43, s43, 128
s_lshl_b32 s43, s43, 7
s_lshl_b32 s42, s36, 2
s_add_u32 s43, s43, s42
v_mov_b32 v4, s43
s_add_u32 s43, s2, 128
s_lshl_b32 s43, s43, 7
s_add_u32 s43, s43, s42
v_mov_b32 v5, s43
v_mov_b32 v3, 1
s_lshl_b32 s43, s34, 18
s_lshl_b32 s42, s60, 8
s_add_u32 s43, s43, s42
s_lshl_b32 s42, s61, 7
s_add_u32 s43, s43, s42
s_lshl_b32 s42, s63, 6
s_add_u32 s43, s43, s42
s_add_u32 s20, s78, s43
s_addc_u32 s21, s79, 0
s_mov_b32 s22, 260160
s_mov_b32 s23, 0x20000
v_and_b32 v7, 15, v1
v_lshlrev_b32 v7, 12, v7
v_bfe_u32 v8, v1, 4, 1
v_lshl_add_u32 v7, v8, 5, v7
v_bfe_u32 v8, v1, 5, 1
v_lshl_add_u32 v7, v8, 4, v7
s_lshl_b32 s50, s62, 17
s_add_u32 s51, s50, 65536
v_lshrrev_b32 v25, 2, v1
v_bfe_u32 v26, v25, 1, 2
v_mul_u32_u24 v25, 128, v25
v_lshl_add_u32 v25, v26, 5, v25
v_and_b32 v26, 3, v1
v_lshl_add_u32 v19, v26, 3, v25
v_add_u32 v19, 16384, v19
s_lshl_b32 s43, s63, 6
v_xor_b32 v19, s43, v19
v_xor_b32 v20, 32, v19
v_add_u32 v21, 65536, v19
v_add_u32 v22, 65536, v20
v_add_u32 v23, 131072, v19
v_add_u32 v24, 131072, v20
s_waitcnt lgkmcnt(0)
s_barrier
v_mfma_f32_16x16x32_bf16 v[128:131], v[112:115], v[96:99], v[128:131]
ds_read_b128 v[32:35], v9 offset:0
ds_read_b64_tr_b16 v[48:49], v11 offset:0
v_mfma_f32_16x16x32_bf16 v[132:135], v[116:119], v[96:99], v[132:135]
ds_read_b64_tr_b16 v[50:51], v11 offset:4096
ds_read_b64_tr_b16 v[52:53], v12 offset:0
v_mfma_f32_16x16x32_bf16 v[160:163], v[120:123], v[96:99], v[160:163]
ds_read_b64_tr_b16 v[54:55], v12 offset:4096
ds_read_b64_tr_b16 v[56:57], v13 offset:0
v_mfma_f32_16x16x32_bf16 v[164:167], v[124:127], v[96:99], v[164:167]
ds_read_b64_tr_b16 v[58:59], v13 offset:4096
ds_read_b64_tr_b16 v[60:61], v14 offset:0
v_mfma_f32_16x16x32_bf16 v[172:175], v[124:127], v[100:103], v[172:175]
ds_read_b64_tr_b16 v[62:63], v14 offset:4096
ds_read_b128 v[36:39], v9 offset:1024
v_mfma_f32_16x16x32_bf16 v[168:171], v[120:123], v[100:103], v[168:171]
ds_read_b128 v[40:43], v9 offset:2048
ds_read_b128 v[44:47], v9 offset:3072
v_mfma_f32_16x16x32_bf16 v[140:143], v[116:119], v[100:103], v[140:143]
ds_read_b128 v[64:67], v9 offset:8192
ds_read_b64_tr_b16 v[80:81], v11 offset:8192
v_mfma_f32_16x16x32_bf16 v[136:139], v[112:115], v[100:103], v[136:139]
ds_read_b64_tr_b16 v[82:83], v11 offset:12288
ds_read_b64_tr_b16 v[84:85], v12 offset:8192
v_mfma_f32_16x16x32_bf16 v[144:147], v[112:115], v[104:107], v[144:147]
ds_read_b64_tr_b16 v[86:87], v12 offset:12288
ds_read_b64_tr_b16 v[88:89], v13 offset:8192
v_mfma_f32_16x16x32_bf16 v[148:151], v[116:119], v[104:107], v[148:151]
ds_read_b64_tr_b16 v[90:91], v13 offset:12288
ds_read_b64_tr_b16 v[92:93], v14 offset:8192
v_mfma_f32_16x16x32_bf16 v[176:179], v[120:123], v[104:107], v[176:179]
ds_read_b64_tr_b16 v[94:95], v14 offset:12288
ds_read_b128 v[68:71], v9 offset:9216
v_mfma_f32_16x16x32_bf16 v[180:183], v[124:127], v[104:107], v[180:183]
ds_read_b128 v[72:75], v9 offset:10240
ds_read_b128 v[76:79], v9 offset:11264
v_mfma_f32_16x16x32_bf16 v[188:191], v[124:127], v[108:111], v[188:191]
v_mfma_f32_16x16x32_bf16 v[184:187], v[120:123], v[108:111], v[184:187]
v_mfma_f32_16x16x32_bf16 v[156:159], v[116:119], v[108:111], v[156:159]
v_mfma_f32_16x16x32_bf16 v[152:155], v[112:115], v[108:111], v[152:155]
v_mfma_f32_16x16x32_bf16 v[128:131], v[208:211], v[192:195], v[128:131]
v_mfma_f32_16x16x32_bf16 v[132:135], v[212:215], v[192:195], v[132:135]
v_mfma_f32_16x16x32_bf16 v[160:163], v[216:219], v[192:195], v[160:163]
v_mfma_f32_16x16x32_bf16 v[164:167], v[220:223], v[192:195], v[164:167]
v_mfma_f32_16x16x32_bf16 v[172:175], v[220:223], v[196:199], v[172:175]
v_mfma_f32_16x16x32_bf16 v[168:171], v[216:219], v[196:199], v[168:171]
v_mfma_f32_16x16x32_bf16 v[140:143], v[212:215], v[196:199], v[140:143]
v_mfma_f32_16x16x32_bf16 v[136:139], v[208:211], v[196:199], v[136:139]
v_mfma_f32_16x16x32_bf16 v[144:147], v[208:211], v[200:203], v[144:147]
v_mfma_f32_16x16x32_bf16 v[148:151], v[212:215], v[200:203], v[148:151]
v_mfma_f32_16x16x32_bf16 v[176:179], v[216:219], v[200:203], v[176:179]
v_mfma_f32_16x16x32_bf16 v[180:183], v[220:223], v[200:203], v[180:183]
v_mfma_f32_16x16x32_bf16 v[188:191], v[220:223], v[204:207], v[188:191]
v_mfma_f32_16x16x32_bf16 v[184:187], v[216:219], v[204:207], v[184:187]
v_mfma_f32_16x16x32_bf16 v[156:159], v[212:215], v[204:207], v[156:159]
v_mfma_f32_16x16x32_bf16 v[152:155], v[208:211], v[204:207], v[152:155]
s_waitcnt vmcnt(0)
s_waitcnt lgkmcnt(0)
s_barrier
v_mfma_f32_16x16x32_bf16 v[128:131], v[48:51], v[32:35], v[128:131]
ds_read_b128 v[96:99], v9 offset:32768
ds_read_b64_tr_b16 v[112:113], v11 offset:32768
v_mfma_f32_16x16x32_bf16 v[132:135], v[52:55], v[32:35], v[132:135]
ds_read_b64_tr_b16 v[114:115], v11 offset:36864
ds_read_b64_tr_b16 v[116:117], v12 offset:32768
v_mfma_f32_16x16x32_bf16 v[160:163], v[56:59], v[32:35], v[160:163]
ds_read_b64_tr_b16 v[118:119], v12 offset:36864
ds_read_b64_tr_b16 v[120:121], v13 offset:32768
v_mfma_f32_16x16x32_bf16 v[164:167], v[60:63], v[32:35], v[164:167]
ds_read_b64_tr_b16 v[122:123], v13 offset:36864
ds_read_b64_tr_b16 v[124:125], v14 offset:32768
v_mfma_f32_16x16x32_bf16 v[172:175], v[60:63], v[36:39], v[172:175]
ds_read_b64_tr_b16 v[126:127], v14 offset:36864
ds_read_b128 v[100:103], v9 offset:33792
v_mfma_f32_16x16x32_bf16 v[168:171], v[56:59], v[36:39], v[168:171]
ds_read_b128 v[104:107], v9 offset:34816
ds_read_b128 v[108:111], v9 offset:35840
v_mfma_f32_16x16x32_bf16 v[140:143], v[52:55], v[36:39], v[140:143]
ds_read_b128 v[192:195], v9 offset:40960
ds_read_b64_tr_b16 v[208:209], v11 offset:40960
v_mfma_f32_16x16x32_bf16 v[136:139], v[48:51], v[36:39], v[136:139]
ds_read_b64_tr_b16 v[210:211], v11 offset:45056
ds_read_b64_tr_b16 v[212:213], v12 offset:40960
v_mfma_f32_16x16x32_bf16 v[144:147], v[48:51], v[40:43], v[144:147]
ds_read_b64_tr_b16 v[214:215], v12 offset:45056
ds_read_b64_tr_b16 v[216:217], v13 offset:40960
v_mfma_f32_16x16x32_bf16 v[148:151], v[52:55], v[40:43], v[148:151]
ds_read_b64_tr_b16 v[218:219], v13 offset:45056
ds_read_b64_tr_b16 v[220:221], v14 offset:40960
v_mfma_f32_16x16x32_bf16 v[176:179], v[56:59], v[40:43], v[176:179]
ds_read_b64_tr_b16 v[222:223], v14 offset:45056
ds_read_b128 v[196:199], v9 offset:41984
v_mfma_f32_16x16x32_bf16 v[180:183], v[60:63], v[40:43], v[180:183]
ds_read_b128 v[200:203], v9 offset:43008
ds_read_b128 v[204:207], v9 offset:44032
v_mfma_f32_16x16x32_bf16 v[188:191], v[60:63], v[44:47], v[188:191]
v_mfma_f32_16x16x32_bf16 v[184:187], v[56:59], v[44:47], v[184:187]
v_mfma_f32_16x16x32_bf16 v[156:159], v[52:55], v[44:47], v[156:159]
v_mfma_f32_16x16x32_bf16 v[152:155], v[48:51], v[44:47], v[152:155]
v_mfma_f32_16x16x32_bf16 v[128:131], v[80:83], v[64:67], v[128:131]
v_mfma_f32_16x16x32_bf16 v[132:135], v[84:87], v[64:67], v[132:135]
v_mfma_f32_16x16x32_bf16 v[160:163], v[88:91], v[64:67], v[160:163]
v_mfma_f32_16x16x32_bf16 v[164:167], v[92:95], v[64:67], v[164:167]
v_mfma_f32_16x16x32_bf16 v[172:175], v[92:95], v[68:71], v[172:175]
v_mfma_f32_16x16x32_bf16 v[168:171], v[88:91], v[68:71], v[168:171]
v_mfma_f32_16x16x32_bf16 v[140:143], v[84:87], v[68:71], v[140:143]
v_mfma_f32_16x16x32_bf16 v[136:139], v[80:83], v[68:71], v[136:139]
v_mfma_f32_16x16x32_bf16 v[144:147], v[80:83], v[72:75], v[144:147]
v_mfma_f32_16x16x32_bf16 v[148:151], v[84:87], v[72:75], v[148:151]
v_mfma_f32_16x16x32_bf16 v[176:179], v[88:91], v[72:75], v[176:179]
v_mfma_f32_16x16x32_bf16 v[180:183], v[92:95], v[72:75], v[180:183]
v_mfma_f32_16x16x32_bf16 v[188:191], v[92:95], v[76:79], v[188:191]
v_mfma_f32_16x16x32_bf16 v[184:187], v[88:91], v[76:79], v[184:187]
v_mfma_f32_16x16x32_bf16 v[156:159], v[84:87], v[76:79], v[156:159]
v_mfma_f32_16x16x32_bf16 v[152:155], v[80:83], v[76:79], v[152:155]
s_waitcnt lgkmcnt(0)
s_barrier
v_mfma_f32_16x16x32_bf16 v[128:131], v[112:115], v[96:99], v[128:131]
ds_read_b128 v[32:35], v244 offset:0
ds_read_b64_tr_b16 v[48:49], v245 offset:0
v_mfma_f32_16x16x32_bf16 v[132:135], v[116:119], v[96:99], v[132:135]
ds_read_b64_tr_b16 v[50:51], v245 offset:4096
ds_read_b64_tr_b16 v[52:53], v246 offset:0
v_mfma_f32_16x16x32_bf16 v[160:163], v[120:123], v[96:99], v[160:163]
ds_read_b64_tr_b16 v[54:55], v246 offset:4096
ds_read_b64_tr_b16 v[56:57], v247 offset:0
v_mfma_f32_16x16x32_bf16 v[164:167], v[124:127], v[96:99], v[164:167]
ds_read_b64_tr_b16 v[58:59], v247 offset:4096
ds_read_b64_tr_b16 v[60:61], v248 offset:0
v_mfma_f32_16x16x32_bf16 v[172:175], v[124:127], v[100:103], v[172:175]
ds_read_b64_tr_b16 v[62:63], v248 offset:4096
ds_read_b128 v[36:39], v244 offset:1024
v_mfma_f32_16x16x32_bf16 v[168:171], v[120:123], v[100:103], v[168:171]
ds_read_b128 v[40:43], v244 offset:2048
ds_read_b128 v[44:47], v244 offset:3072
v_mfma_f32_16x16x32_bf16 v[140:143], v[116:119], v[100:103], v[140:143]
ds_read_b128 v[64:67], v244 offset:8192
ds_read_b64_tr_b16 v[80:81], v245 offset:8192
v_mfma_f32_16x16x32_bf16 v[136:139], v[112:115], v[100:103], v[136:139]
ds_read_b64_tr_b16 v[82:83], v245 offset:12288
ds_read_b64_tr_b16 v[84:85], v246 offset:8192
v_mfma_f32_16x16x32_bf16 v[144:147], v[112:115], v[104:107], v[144:147]
ds_read_b64_tr_b16 v[86:87], v246 offset:12288
ds_read_b64_tr_b16 v[88:89], v247 offset:8192
v_mfma_f32_16x16x32_bf16 v[148:151], v[116:119], v[104:107], v[148:151]
ds_read_b64_tr_b16 v[90:91], v247 offset:12288
ds_read_b64_tr_b16 v[92:93], v248 offset:8192
v_mfma_f32_16x16x32_bf16 v[176:179], v[120:123], v[104:107], v[176:179]
ds_read_b64_tr_b16 v[94:95], v248 offset:12288
ds_read_b128 v[68:71], v244 offset:9216
v_mfma_f32_16x16x32_bf16 v[180:183], v[124:127], v[104:107], v[180:183]
ds_read_b128 v[72:75], v244 offset:10240
ds_read_b128 v[76:79], v244 offset:11264
v_mfma_f32_16x16x32_bf16 v[188:191], v[124:127], v[108:111], v[188:191]
v_mfma_f32_16x16x32_bf16 v[184:187], v[120:123], v[108:111], v[184:187]
v_mfma_f32_16x16x32_bf16 v[156:159], v[116:119], v[108:111], v[156:159]
v_mfma_f32_16x16x32_bf16 v[152:155], v[112:115], v[108:111], v[152:155]
v_mfma_f32_16x16x32_bf16 v[128:131], v[208:211], v[192:195], v[128:131]
v_mfma_f32_16x16x32_bf16 v[132:135], v[212:215], v[192:195], v[132:135]
v_mfma_f32_16x16x32_bf16 v[160:163], v[216:219], v[192:195], v[160:163]
v_mfma_f32_16x16x32_bf16 v[164:167], v[220:223], v[192:195], v[164:167]
v_mfma_f32_16x16x32_bf16 v[172:175], v[220:223], v[196:199], v[172:175]
v_mfma_f32_16x16x32_bf16 v[168:171], v[216:219], v[196:199], v[168:171]
v_mfma_f32_16x16x32_bf16 v[140:143], v[212:215], v[196:199], v[140:143]
v_mfma_f32_16x16x32_bf16 v[136:139], v[208:211], v[196:199], v[136:139]
v_mfma_f32_16x16x32_bf16 v[144:147], v[208:211], v[200:203], v[144:147]
v_mfma_f32_16x16x32_bf16 v[148:151], v[212:215], v[200:203], v[148:151]
v_mfma_f32_16x16x32_bf16 v[176:179], v[216:219], v[200:203], v[176:179]
v_mfma_f32_16x16x32_bf16 v[180:183], v[220:223], v[200:203], v[180:183]
v_mfma_f32_16x16x32_bf16 v[188:191], v[220:223], v[204:207], v[188:191]
v_mfma_f32_16x16x32_bf16 v[184:187], v[216:219], v[204:207], v[184:187]
v_mfma_f32_16x16x32_bf16 v[156:159], v[212:215], v[204:207], v[156:159]
v_mfma_f32_16x16x32_bf16 v[152:155], v[208:211], v[204:207], v[152:155]
s_waitcnt lgkmcnt(0)
s_barrier
v_mfma_f32_16x16x32_bf16 v[128:131], v[48:51], v[32:35], v[128:131]
ds_read_b128 v[96:99], v244 offset:32768
ds_read_b64_tr_b16 v[112:113], v245 offset:32768
v_mfma_f32_16x16x32_bf16 v[132:135], v[52:55], v[32:35], v[132:135]
ds_read_b64_tr_b16 v[114:115], v245 offset:36864
ds_read_b64_tr_b16 v[116:117], v246 offset:32768
v_mfma_f32_16x16x32_bf16 v[160:163], v[56:59], v[32:35], v[160:163]
ds_read_b64_tr_b16 v[118:119], v246 offset:36864
ds_read_b64_tr_b16 v[120:121], v247 offset:32768
v_mfma_f32_16x16x32_bf16 v[164:167], v[60:63], v[32:35], v[164:167]
ds_read_b64_tr_b16 v[122:123], v247 offset:36864
ds_read_b64_tr_b16 v[124:125], v248 offset:32768
v_mfma_f32_16x16x32_bf16 v[172:175], v[60:63], v[36:39], v[172:175]
ds_read_b64_tr_b16 v[126:127], v248 offset:36864
ds_read_b128 v[100:103], v244 offset:33792
v_mfma_f32_16x16x32_bf16 v[168:171], v[56:59], v[36:39], v[168:171]
ds_read_b128 v[104:107], v244 offset:34816
ds_read_b128 v[108:111], v244 offset:35840
v_mfma_f32_16x16x32_bf16 v[140:143], v[52:55], v[36:39], v[140:143]
ds_read_b128 v[192:195], v244 offset:40960
ds_read_b64_tr_b16 v[208:209], v245 offset:40960
v_mfma_f32_16x16x32_bf16 v[136:139], v[48:51], v[36:39], v[136:139]
ds_read_b64_tr_b16 v[210:211], v245 offset:45056
ds_read_b64_tr_b16 v[212:213], v246 offset:40960
v_mfma_f32_16x16x32_bf16 v[144:147], v[48:51], v[40:43], v[144:147]
ds_read_b64_tr_b16 v[214:215], v246 offset:45056
ds_read_b64_tr_b16 v[216:217], v247 offset:40960
v_mfma_f32_16x16x32_bf16 v[148:151], v[52:55], v[40:43], v[148:151]
ds_read_b64_tr_b16 v[218:219], v247 offset:45056
ds_read_b64_tr_b16 v[220:221], v248 offset:40960
v_mfma_f32_16x16x32_bf16 v[176:179], v[56:59], v[40:43], v[176:179]
ds_read_b64_tr_b16 v[222:223], v248 offset:45056
ds_read_b128 v[196:199], v244 offset:41984
v_mfma_f32_16x16x32_bf16 v[180:183], v[60:63], v[40:43], v[180:183]
ds_read_b128 v[200:203], v244 offset:43008
ds_read_b128 v[204:207], v244 offset:44032
v_mfma_f32_16x16x32_bf16 v[188:191], v[60:63], v[44:47], v[188:191]
v_mfma_f32_16x16x32_bf16 v[184:187], v[56:59], v[44:47], v[184:187]
v_mfma_f32_16x16x32_bf16 v[156:159], v[52:55], v[44:47], v[156:159]
v_mfma_f32_16x16x32_bf16 v[152:155], v[48:51], v[44:47], v[152:155]
v_mfma_f32_16x16x32_bf16 v[128:131], v[80:83], v[64:67], v[128:131]
v_mfma_f32_16x16x32_bf16 v[132:135], v[84:87], v[64:67], v[132:135]
v_mfma_f32_16x16x32_bf16 v[160:163], v[88:91], v[64:67], v[160:163]
v_mfma_f32_16x16x32_bf16 v[164:167], v[92:95], v[64:67], v[164:167]
v_mfma_f32_16x16x32_bf16 v[172:175], v[92:95], v[68:71], v[172:175]
v_mfma_f32_16x16x32_bf16 v[168:171], v[88:91], v[68:71], v[168:171]
v_mfma_f32_16x16x32_bf16 v[140:143], v[84:87], v[68:71], v[140:143]
v_mfma_f32_16x16x32_bf16 v[136:139], v[80:83], v[68:71], v[136:139]
v_mfma_f32_16x16x32_bf16 v[144:147], v[80:83], v[72:75], v[144:147]
v_mfma_f32_16x16x32_bf16 v[148:151], v[84:87], v[72:75], v[148:151]
v_mfma_f32_16x16x32_bf16 v[176:179], v[88:91], v[72:75], v[176:179]
v_mfma_f32_16x16x32_bf16 v[180:183], v[92:95], v[72:75], v[180:183]
v_mfma_f32_16x16x32_bf16 v[188:191], v[92:95], v[76:79], v[188:191]
v_mfma_f32_16x16x32_bf16 v[184:187], v[88:91], v[76:79], v[184:187]
v_mfma_f32_16x16x32_bf16 v[156:159], v[84:87], v[76:79], v[156:159]
v_mfma_f32_16x16x32_bf16 v[152:155], v[80:83], v[76:79], v[152:155]
s_waitcnt lgkmcnt(0)
s_barrier
v_mfma_f32_16x16x32_bf16 v[128:131], v[112:115], v[96:99], v[128:131]
ds_read_b128 v[32:35], v10 offset:0
ds_read_b64_tr_b16 v[48:49], v15 offset:0
v_mfma_f32_16x16x32_bf16 v[132:135], v[116:119], v[96:99], v[132:135]
ds_read_b64_tr_b16 v[50:51], v15 offset:4096
ds_read_b64_tr_b16 v[52:53], v16 offset:0
v_mfma_f32_16x16x32_bf16 v[160:163], v[120:123], v[96:99], v[160:163]
ds_read_b64_tr_b16 v[54:55], v16 offset:4096
ds_read_b64_tr_b16 v[56:57], v17 offset:0
v_mfma_f32_16x16x32_bf16 v[164:167], v[124:127], v[96:99], v[164:167]
ds_read_b64_tr_b16 v[58:59], v17 offset:4096
ds_read_b64_tr_b16 v[60:61], v18 offset:0
v_mfma_f32_16x16x32_bf16 v[172:175], v[124:127], v[100:103], v[172:175]
ds_read_b64_tr_b16 v[62:63], v18 offset:4096
ds_read_b128 v[36:39], v10 offset:1024
v_mfma_f32_16x16x32_bf16 v[168:171], v[120:123], v[100:103], v[168:171]
ds_read_b128 v[40:43], v10 offset:2048
ds_read_b128 v[44:47], v10 offset:3072
v_mfma_f32_16x16x32_bf16 v[140:143], v[116:119], v[100:103], v[140:143]
ds_read_b128 v[64:67], v10 offset:8192
ds_read_b64_tr_b16 v[80:81], v15 offset:8192
v_mfma_f32_16x16x32_bf16 v[136:139], v[112:115], v[100:103], v[136:139]
ds_read_b64_tr_b16 v[82:83], v15 offset:12288
ds_read_b64_tr_b16 v[84:85], v16 offset:8192
v_mfma_f32_16x16x32_bf16 v[144:147], v[112:115], v[104:107], v[144:147]
ds_read_b64_tr_b16 v[86:87], v16 offset:12288
ds_read_b64_tr_b16 v[88:89], v17 offset:8192
v_mfma_f32_16x16x32_bf16 v[148:151], v[116:119], v[104:107], v[148:151]
ds_read_b64_tr_b16 v[90:91], v17 offset:12288
ds_read_b64_tr_b16 v[92:93], v18 offset:8192
v_mfma_f32_16x16x32_bf16 v[176:179], v[120:123], v[104:107], v[176:179]
ds_read_b64_tr_b16 v[94:95], v18 offset:12288
ds_read_b128 v[68:71], v10 offset:9216
v_mfma_f32_16x16x32_bf16 v[180:183], v[124:127], v[104:107], v[180:183]
ds_read_b128 v[72:75], v10 offset:10240
ds_read_b128 v[76:79], v10 offset:11264
v_mfma_f32_16x16x32_bf16 v[188:191], v[124:127], v[108:111], v[188:191]
v_mfma_f32_16x16x32_bf16 v[184:187], v[120:123], v[108:111], v[184:187]
v_mfma_f32_16x16x32_bf16 v[156:159], v[116:119], v[108:111], v[156:159]
v_mfma_f32_16x16x32_bf16 v[152:155], v[112:115], v[108:111], v[152:155]
v_mfma_f32_16x16x32_bf16 v[128:131], v[208:211], v[192:195], v[128:131]
v_mfma_f32_16x16x32_bf16 v[132:135], v[212:215], v[192:195], v[132:135]
v_mfma_f32_16x16x32_bf16 v[160:163], v[216:219], v[192:195], v[160:163]
v_mfma_f32_16x16x32_bf16 v[164:167], v[220:223], v[192:195], v[164:167]
v_mfma_f32_16x16x32_bf16 v[172:175], v[220:223], v[196:199], v[172:175]
v_mfma_f32_16x16x32_bf16 v[168:171], v[216:219], v[196:199], v[168:171]
v_mfma_f32_16x16x32_bf16 v[140:143], v[212:215], v[196:199], v[140:143]
v_mfma_f32_16x16x32_bf16 v[136:139], v[208:211], v[196:199], v[136:139]
v_mfma_f32_16x16x32_bf16 v[144:147], v[208:211], v[200:203], v[144:147]
v_mfma_f32_16x16x32_bf16 v[148:151], v[212:215], v[200:203], v[148:151]
v_mfma_f32_16x16x32_bf16 v[176:179], v[216:219], v[200:203], v[176:179]
v_mfma_f32_16x16x32_bf16 v[180:183], v[220:223], v[200:203], v[180:183]
v_mfma_f32_16x16x32_bf16 v[188:191], v[220:223], v[204:207], v[188:191]
v_mfma_f32_16x16x32_bf16 v[184:187], v[216:219], v[204:207], v[184:187]
v_mfma_f32_16x16x32_bf16 v[156:159], v[212:215], v[204:207], v[156:159]
v_mfma_f32_16x16x32_bf16 v[152:155], v[208:211], v[204:207], v[152:155]
s_waitcnt lgkmcnt(0)
s_barrier
v_mfma_f32_16x16x32_bf16 v[128:131], v[48:51], v[32:35], v[128:131]
ds_read_b128 v[96:99], v9 offset:0
ds_read_b64_tr_b16 v[112:113], v11 offset:0
v_mfma_f32_16x16x32_bf16 v[132:135], v[52:55], v[32:35], v[132:135]
ds_read_b64_tr_b16 v[114:115], v11 offset:4096
ds_read_b64_tr_b16 v[116:117], v12 offset:0
v_mfma_f32_16x16x32_bf16 v[160:163], v[56:59], v[32:35], v[160:163]
ds_read_b64_tr_b16 v[118:119], v12 offset:4096
ds_read_b64_tr_b16 v[120:121], v13 offset:0
v_mfma_f32_16x16x32_bf16 v[164:167], v[60:63], v[32:35], v[164:167]
ds_read_b64_tr_b16 v[122:123], v13 offset:4096
ds_read_b64_tr_b16 v[124:125], v14 offset:0
v_mfma_f32_16x16x32_bf16 v[172:175], v[60:63], v[36:39], v[172:175]
ds_read_b64_tr_b16 v[126:127], v14 offset:4096
ds_read_b128 v[100:103], v9 offset:1024
v_mfma_f32_16x16x32_bf16 v[168:171], v[56:59], v[36:39], v[168:171]
ds_read_b128 v[104:107], v9 offset:2048
ds_read_b128 v[108:111], v9 offset:3072
v_mfma_f32_16x16x32_bf16 v[140:143], v[52:55], v[36:39], v[140:143]
ds_read_b128 v[192:195], v9 offset:8192
ds_read_b64_tr_b16 v[208:209], v11 offset:8192
v_mfma_f32_16x16x32_bf16 v[136:139], v[48:51], v[36:39], v[136:139]
ds_read_b64_tr_b16 v[210:211], v11 offset:12288
ds_read_b64_tr_b16 v[212:213], v12 offset:8192
v_mfma_f32_16x16x32_bf16 v[144:147], v[48:51], v[40:43], v[144:147]
ds_read_b64_tr_b16 v[214:215], v12 offset:12288
ds_read_b64_tr_b16 v[216:217], v13 offset:8192
v_mfma_f32_16x16x32_bf16 v[148:151], v[52:55], v[40:43], v[148:151]
ds_read_b64_tr_b16 v[218:219], v13 offset:12288
ds_read_b64_tr_b16 v[220:221], v14 offset:8192
v_mfma_f32_16x16x32_bf16 v[176:179], v[56:59], v[40:43], v[176:179]
ds_read_b64_tr_b16 v[222:223], v14 offset:12288
ds_read_b128 v[196:199], v9 offset:9216
v_mfma_f32_16x16x32_bf16 v[180:183], v[60:63], v[40:43], v[180:183]
ds_read_b128 v[200:203], v9 offset:10240
ds_read_b128 v[204:207], v9 offset:11264
v_mfma_f32_16x16x32_bf16 v[188:191], v[60:63], v[44:47], v[188:191]
v_mfma_f32_16x16x32_bf16 v[184:187], v[56:59], v[44:47], v[184:187]
v_mfma_f32_16x16x32_bf16 v[156:159], v[52:55], v[44:47], v[156:159]
v_mfma_f32_16x16x32_bf16 v[152:155], v[48:51], v[44:47], v[152:155]
v_mfma_f32_16x16x32_bf16 v[128:131], v[80:83], v[64:67], v[128:131]
v_mfma_f32_16x16x32_bf16 v[132:135], v[84:87], v[64:67], v[132:135]
v_mfma_f32_16x16x32_bf16 v[160:163], v[88:91], v[64:67], v[160:163]
v_mfma_f32_16x16x32_bf16 v[164:167], v[92:95], v[64:67], v[164:167]
v_mfma_f32_16x16x32_bf16 v[172:175], v[92:95], v[68:71], v[172:175]
v_mfma_f32_16x16x32_bf16 v[168:171], v[88:91], v[68:71], v[168:171]
v_mfma_f32_16x16x32_bf16 v[140:143], v[84:87], v[68:71], v[140:143]
v_mfma_f32_16x16x32_bf16 v[136:139], v[80:83], v[68:71], v[136:139]
v_mfma_f32_16x16x32_bf16 v[144:147], v[80:83], v[72:75], v[144:147]
v_mfma_f32_16x16x32_bf16 v[148:151], v[84:87], v[72:75], v[148:151]
v_mfma_f32_16x16x32_bf16 v[176:179], v[88:91], v[72:75], v[176:179]
v_mfma_f32_16x16x32_bf16 v[180:183], v[92:95], v[72:75], v[180:183]
v_mfma_f32_16x16x32_bf16 v[188:191], v[92:95], v[76:79], v[188:191]
v_mfma_f32_16x16x32_bf16 v[184:187], v[88:91], v[76:79], v[184:187]
v_mfma_f32_16x16x32_bf16 v[156:159], v[84:87], v[76:79], v[156:159]
v_mfma_f32_16x16x32_bf16 v[152:155], v[80:83], v[76:79], v[152:155]
s_waitcnt lgkmcnt(0)
s_barrier
v_mfma_f32_16x16x32_bf16 v[128:131], v[112:115], v[96:99], v[128:131]
ds_read_b128 v[32:35], v9 offset:32768
ds_read_b64_tr_b16 v[48:49], v11 offset:32768
v_mfma_f32_16x16x32_bf16 v[132:135], v[116:119], v[96:99], v[132:135]
ds_read_b64_tr_b16 v[50:51], v11 offset:36864
ds_read_b64_tr_b16 v[52:53], v12 offset:32768
v_mfma_f32_16x16x32_bf16 v[160:163], v[120:123], v[96:99], v[160:163]
ds_read_b64_tr_b16 v[54:55], v12 offset:36864
ds_read_b64_tr_b16 v[56:57], v13 offset:32768
v_mfma_f32_16x16x32_bf16 v[164:167], v[124:127], v[96:99], v[164:167]
ds_read_b64_tr_b16 v[58:59], v13 offset:36864
ds_read_b64_tr_b16 v[60:61], v14 offset:32768
v_mfma_f32_16x16x32_bf16 v[172:175], v[124:127], v[100:103], v[172:175]
ds_read_b64_tr_b16 v[62:63], v14 offset:36864
ds_read_b128 v[36:39], v9 offset:33792
v_mfma_f32_16x16x32_bf16 v[168:171], v[120:123], v[100:103], v[168:171]
ds_read_b128 v[40:43], v9 offset:34816
ds_read_b128 v[44:47], v9 offset:35840
v_mfma_f32_16x16x32_bf16 v[140:143], v[116:119], v[100:103], v[140:143]
ds_read_b128 v[64:67], v9 offset:40960
ds_read_b64_tr_b16 v[80:81], v11 offset:40960
v_mfma_f32_16x16x32_bf16 v[136:139], v[112:115], v[100:103], v[136:139]
ds_read_b64_tr_b16 v[82:83], v11 offset:45056
ds_read_b64_tr_b16 v[84:85], v12 offset:40960
v_mfma_f32_16x16x32_bf16 v[144:147], v[112:115], v[104:107], v[144:147]
ds_read_b64_tr_b16 v[86:87], v12 offset:45056
ds_read_b64_tr_b16 v[88:89], v13 offset:40960
v_mfma_f32_16x16x32_bf16 v[148:151], v[116:119], v[104:107], v[148:151]
ds_read_b64_tr_b16 v[90:91], v13 offset:45056
ds_read_b64_tr_b16 v[92:93], v14 offset:40960
v_mfma_f32_16x16x32_bf16 v[176:179], v[120:123], v[104:107], v[176:179]
ds_read_b64_tr_b16 v[94:95], v14 offset:45056
ds_read_b128 v[68:71], v9 offset:41984
v_mfma_f32_16x16x32_bf16 v[180:183], v[124:127], v[104:107], v[180:183]
ds_read_b128 v[72:75], v9 offset:43008
ds_read_b128 v[76:79], v9 offset:44032
v_mfma_f32_16x16x32_bf16 v[188:191], v[124:127], v[108:111], v[188:191]
v_mfma_f32_16x16x32_bf16 v[184:187], v[120:123], v[108:111], v[184:187]
v_mfma_f32_16x16x32_bf16 v[156:159], v[116:119], v[108:111], v[156:159]
v_mfma_f32_16x16x32_bf16 v[152:155], v[112:115], v[108:111], v[152:155]
v_mfma_f32_16x16x32_bf16 v[128:131], v[208:211], v[192:195], v[128:131]
v_mfma_f32_16x16x32_bf16 v[132:135], v[212:215], v[192:195], v[132:135]
v_mfma_f32_16x16x32_bf16 v[160:163], v[216:219], v[192:195], v[160:163]
v_mfma_f32_16x16x32_bf16 v[164:167], v[220:223], v[192:195], v[164:167]
v_mfma_f32_16x16x32_bf16 v[172:175], v[220:223], v[196:199], v[172:175]
v_mfma_f32_16x16x32_bf16 v[168:171], v[216:219], v[196:199], v[168:171]
v_mfma_f32_16x16x32_bf16 v[140:143], v[212:215], v[196:199], v[140:143]
v_mfma_f32_16x16x32_bf16 v[136:139], v[208:211], v[196:199], v[136:139]
v_mfma_f32_16x16x32_bf16 v[144:147], v[208:211], v[200:203], v[144:147]
v_mfma_f32_16x16x32_bf16 v[148:151], v[212:215], v[200:203], v[148:151]
v_mfma_f32_16x16x32_bf16 v[176:179], v[216:219], v[200:203], v[176:179]
v_mfma_f32_16x16x32_bf16 v[180:183], v[220:223], v[200:203], v[180:183]
v_mfma_f32_16x16x32_bf16 v[188:191], v[220:223], v[204:207], v[188:191]
v_mfma_f32_16x16x32_bf16 v[184:187], v[216:219], v[204:207], v[184:187]
v_mfma_f32_16x16x32_bf16 v[156:159], v[212:215], v[204:207], v[156:159]
v_mfma_f32_16x16x32_bf16 v[152:155], v[208:211], v[204:207], v[152:155]
s_waitcnt lgkmcnt(0)
s_barrier
v_mfma_f32_16x16x32_bf16 v[128:131], v[48:51], v[32:35], v[128:131]
ds_read_b128 v[96:99], v244 offset:0
ds_read_b64_tr_b16 v[112:113], v245 offset:0
v_mfma_f32_16x16x32_bf16 v[132:135], v[52:55], v[32:35], v[132:135]
ds_read_b64_tr_b16 v[114:115], v245 offset:4096
ds_read_b64_tr_b16 v[116:117], v246 offset:0
v_mfma_f32_16x16x32_bf16 v[160:163], v[56:59], v[32:35], v[160:163]
ds_read_b64_tr_b16 v[118:119], v246 offset:4096
ds_read_b64_tr_b16 v[120:121], v247 offset:0
v_mfma_f32_16x16x32_bf16 v[164:167], v[60:63], v[32:35], v[164:167]
ds_read_b64_tr_b16 v[122:123], v247 offset:4096
ds_read_b64_tr_b16 v[124:125], v248 offset:0
v_mfma_f32_16x16x32_bf16 v[172:175], v[60:63], v[36:39], v[172:175]
ds_read_b64_tr_b16 v[126:127], v248 offset:4096
ds_read_b128 v[100:103], v244 offset:1024
v_mfma_f32_16x16x32_bf16 v[168:171], v[56:59], v[36:39], v[168:171]
ds_read_b128 v[104:107], v244 offset:2048
ds_read_b128 v[108:111], v244 offset:3072
v_mfma_f32_16x16x32_bf16 v[140:143], v[52:55], v[36:39], v[140:143]
ds_read_b128 v[192:195], v244 offset:8192
ds_read_b64_tr_b16 v[208:209], v245 offset:8192
v_mfma_f32_16x16x32_bf16 v[136:139], v[48:51], v[36:39], v[136:139]
ds_read_b64_tr_b16 v[210:211], v245 offset:12288
ds_read_b64_tr_b16 v[212:213], v246 offset:8192
v_mfma_f32_16x16x32_bf16 v[144:147], v[48:51], v[40:43], v[144:147]
ds_read_b64_tr_b16 v[214:215], v246 offset:12288
ds_read_b64_tr_b16 v[216:217], v247 offset:8192
v_mfma_f32_16x16x32_bf16 v[148:151], v[52:55], v[40:43], v[148:151]
ds_read_b64_tr_b16 v[218:219], v247 offset:12288
ds_read_b64_tr_b16 v[220:221], v248 offset:8192
v_mfma_f32_16x16x32_bf16 v[176:179], v[56:59], v[40:43], v[176:179]
ds_read_b64_tr_b16 v[222:223], v248 offset:12288
ds_read_b128 v[196:199], v244 offset:9216
v_mfma_f32_16x16x32_bf16 v[180:183], v[60:63], v[40:43], v[180:183]
ds_read_b128 v[200:203], v244 offset:10240
ds_read_b128 v[204:207], v244 offset:11264
v_mfma_f32_16x16x32_bf16 v[188:191], v[60:63], v[44:47], v[188:191]
v_mfma_f32_16x16x32_bf16 v[184:187], v[56:59], v[44:47], v[184:187]
v_mfma_f32_16x16x32_bf16 v[156:159], v[52:55], v[44:47], v[156:159]
v_mfma_f32_16x16x32_bf16 v[152:155], v[48:51], v[44:47], v[152:155]
v_mfma_f32_16x16x32_bf16 v[128:131], v[80:83], v[64:67], v[128:131]
v_mfma_f32_16x16x32_bf16 v[132:135], v[84:87], v[64:67], v[132:135]
v_mfma_f32_16x16x32_bf16 v[160:163], v[88:91], v[64:67], v[160:163]
v_mfma_f32_16x16x32_bf16 v[164:167], v[92:95], v[64:67], v[164:167]
v_mfma_f32_16x16x32_bf16 v[172:175], v[92:95], v[68:71], v[172:175]
v_mfma_f32_16x16x32_bf16 v[168:171], v[88:91], v[68:71], v[168:171]
v_mfma_f32_16x16x32_bf16 v[140:143], v[84:87], v[68:71], v[140:143]
v_mfma_f32_16x16x32_bf16 v[136:139], v[80:83], v[68:71], v[136:139]
v_mfma_f32_16x16x32_bf16 v[144:147], v[80:83], v[72:75], v[144:147]
v_mfma_f32_16x16x32_bf16 v[148:151], v[84:87], v[72:75], v[148:151]
v_mfma_f32_16x16x32_bf16 v[176:179], v[88:91], v[72:75], v[176:179]
v_mfma_f32_16x16x32_bf16 v[180:183], v[92:95], v[72:75], v[180:183]
v_mfma_f32_16x16x32_bf16 v[188:191], v[92:95], v[76:79], v[188:191]
v_mfma_f32_16x16x32_bf16 v[184:187], v[88:91], v[76:79], v[184:187]
v_mfma_f32_16x16x32_bf16 v[156:159], v[84:87], v[76:79], v[156:159]
v_mfma_f32_16x16x32_bf16 v[152:155], v[80:83], v[76:79], v[152:155]
s_waitcnt lgkmcnt(0)
s_barrier
v_mfma_f32_16x16x32_bf16 v[128:131], v[112:115], v[96:99], v[128:131]
ds_read_b128 v[32:35], v244 offset:32768
ds_read_b64_tr_b16 v[48:49], v245 offset:32768
v_mfma_f32_16x16x32_bf16 v[132:135], v[116:119], v[96:99], v[132:135]
ds_read_b64_tr_b16 v[50:51], v245 offset:36864
ds_read_b64_tr_b16 v[52:53], v246 offset:32768
v_mfma_f32_16x16x32_bf16 v[160:163], v[120:123], v[96:99], v[160:163]
ds_read_b64_tr_b16 v[54:55], v246 offset:36864
ds_read_b64_tr_b16 v[56:57], v247 offset:32768
v_mfma_f32_16x16x32_bf16 v[164:167], v[124:127], v[96:99], v[164:167]
ds_read_b64_tr_b16 v[58:59], v247 offset:36864
ds_read_b64_tr_b16 v[60:61], v248 offset:32768
v_mfma_f32_16x16x32_bf16 v[172:175], v[124:127], v[100:103], v[172:175]
ds_read_b64_tr_b16 v[62:63], v248 offset:36864
ds_read_b128 v[36:39], v244 offset:33792
v_mfma_f32_16x16x32_bf16 v[168:171], v[120:123], v[100:103], v[168:171]
ds_read_b128 v[40:43], v244 offset:34816
ds_read_b128 v[44:47], v244 offset:35840
v_mfma_f32_16x16x32_bf16 v[140:143], v[116:119], v[100:103], v[140:143]
ds_read_b128 v[64:67], v244 offset:40960
ds_read_b64_tr_b16 v[80:81], v245 offset:40960
v_mfma_f32_16x16x32_bf16 v[136:139], v[112:115], v[100:103], v[136:139]
ds_read_b64_tr_b16 v[82:83], v245 offset:45056
ds_read_b64_tr_b16 v[84:85], v246 offset:40960
v_mfma_f32_16x16x32_bf16 v[144:147], v[112:115], v[104:107], v[144:147]
ds_read_b64_tr_b16 v[86:87], v246 offset:45056
ds_read_b64_tr_b16 v[88:89], v247 offset:40960
v_mfma_f32_16x16x32_bf16 v[148:151], v[116:119], v[104:107], v[148:151]
ds_read_b64_tr_b16 v[90:91], v247 offset:45056
ds_read_b64_tr_b16 v[92:93], v248 offset:40960
v_mfma_f32_16x16x32_bf16 v[176:179], v[120:123], v[104:107], v[176:179]
ds_read_b64_tr_b16 v[94:95], v248 offset:45056
ds_read_b128 v[68:71], v244 offset:41984
v_mfma_f32_16x16x32_bf16 v[180:183], v[124:127], v[104:107], v[180:183]
ds_read_b128 v[72:75], v244 offset:43008
ds_read_b128 v[76:79], v244 offset:44032
v_mfma_f32_16x16x32_bf16 v[188:191], v[124:127], v[108:111], v[188:191]
v_mfma_f32_16x16x32_bf16 v[184:187], v[120:123], v[108:111], v[184:187]
v_mfma_f32_16x16x32_bf16 v[156:159], v[116:119], v[108:111], v[156:159]
v_mfma_f32_16x16x32_bf16 v[152:155], v[112:115], v[108:111], v[152:155]
v_mfma_f32_16x16x32_bf16 v[128:131], v[208:211], v[192:195], v[128:131]
v_mfma_f32_16x16x32_bf16 v[132:135], v[212:215], v[192:195], v[132:135]
v_mfma_f32_16x16x32_bf16 v[160:163], v[216:219], v[192:195], v[160:163]
v_mfma_f32_16x16x32_bf16 v[164:167], v[220:223], v[192:195], v[164:167]
v_mfma_f32_16x16x32_bf16 v[172:175], v[220:223], v[196:199], v[172:175]
v_mfma_f32_16x16x32_bf16 v[168:171], v[216:219], v[196:199], v[168:171]
v_mfma_f32_16x16x32_bf16 v[140:143], v[212:215], v[196:199], v[140:143]
v_mfma_f32_16x16x32_bf16 v[136:139], v[208:211], v[196:199], v[136:139]
v_mfma_f32_16x16x32_bf16 v[144:147], v[208:211], v[200:203], v[144:147]
v_mfma_f32_16x16x32_bf16 v[148:151], v[212:215], v[200:203], v[148:151]
v_mfma_f32_16x16x32_bf16 v[176:179], v[216:219], v[200:203], v[176:179]
v_mfma_f32_16x16x32_bf16 v[180:183], v[220:223], v[200:203], v[180:183]
v_mfma_f32_16x16x32_bf16 v[188:191], v[220:223], v[204:207], v[188:191]
v_mfma_f32_16x16x32_bf16 v[184:187], v[216:219], v[204:207], v[184:187]
v_mfma_f32_16x16x32_bf16 v[156:159], v[212:215], v[204:207], v[156:159]
v_mfma_f32_16x16x32_bf16 v[152:155], v[208:211], v[204:207], v[152:155]
s_waitcnt lgkmcnt(0)
s_barrier
v_mfma_f32_16x16x32_bf16 v[128:131], v[48:51], v[32:35], v[128:131]
ds_read_b128 v[96:99], v10 offset:0
ds_read_b64_tr_b16 v[112:113], v15 offset:0
v_mfma_f32_16x16x32_bf16 v[132:135], v[52:55], v[32:35], v[132:135]
ds_read_b64_tr_b16 v[114:115], v15 offset:4096
ds_read_b64_tr_b16 v[116:117], v16 offset:0
v_mfma_f32_16x16x32_bf16 v[160:163], v[56:59], v[32:35], v[160:163]
ds_read_b64_tr_b16 v[118:119], v16 offset:4096
ds_read_b64_tr_b16 v[120:121], v17 offset:0
v_mfma_f32_16x16x32_bf16 v[164:167], v[60:63], v[32:35], v[164:167]
ds_read_b64_tr_b16 v[122:123], v17 offset:4096
ds_read_b64_tr_b16 v[124:125], v18 offset:0
v_mfma_f32_16x16x32_bf16 v[172:175], v[60:63], v[36:39], v[172:175]
ds_read_b64_tr_b16 v[126:127], v18 offset:4096
ds_read_b128 v[100:103], v10 offset:1024
v_mfma_f32_16x16x32_bf16 v[168:171], v[56:59], v[36:39], v[168:171]
ds_read_b128 v[104:107], v10 offset:2048
ds_read_b128 v[108:111], v10 offset:3072
v_mfma_f32_16x16x32_bf16 v[140:143], v[52:55], v[36:39], v[140:143]
ds_read_b128 v[192:195], v10 offset:8192
ds_read_b64_tr_b16 v[208:209], v15 offset:8192
v_mfma_f32_16x16x32_bf16 v[136:139], v[48:51], v[36:39], v[136:139]
ds_read_b64_tr_b16 v[210:211], v15 offset:12288
ds_read_b64_tr_b16 v[212:213], v16 offset:8192
v_mfma_f32_16x16x32_bf16 v[144:147], v[48:51], v[40:43], v[144:147]
ds_read_b64_tr_b16 v[214:215], v16 offset:12288
ds_read_b64_tr_b16 v[216:217], v17 offset:8192
v_mfma_f32_16x16x32_bf16 v[148:151], v[52:55], v[40:43], v[148:151]
ds_read_b64_tr_b16 v[218:219], v17 offset:12288
ds_read_b64_tr_b16 v[220:221], v18 offset:8192
v_mfma_f32_16x16x32_bf16 v[176:179], v[56:59], v[40:43], v[176:179]
ds_read_b64_tr_b16 v[222:223], v18 offset:12288
ds_read_b128 v[196:199], v10 offset:9216
v_mfma_f32_16x16x32_bf16 v[180:183], v[60:63], v[40:43], v[180:183]
ds_read_b128 v[200:203], v10 offset:10240
ds_read_b128 v[204:207], v10 offset:11264
v_mfma_f32_16x16x32_bf16 v[188:191], v[60:63], v[44:47], v[188:191]
v_mfma_f32_16x16x32_bf16 v[184:187], v[56:59], v[44:47], v[184:187]
v_mfma_f32_16x16x32_bf16 v[156:159], v[52:55], v[44:47], v[156:159]
v_mfma_f32_16x16x32_bf16 v[152:155], v[48:51], v[44:47], v[152:155]
v_mfma_f32_16x16x32_bf16 v[128:131], v[80:83], v[64:67], v[128:131]
v_mfma_f32_16x16x32_bf16 v[132:135], v[84:87], v[64:67], v[132:135]
v_mfma_f32_16x16x32_bf16 v[160:163], v[88:91], v[64:67], v[160:163]
v_mfma_f32_16x16x32_bf16 v[164:167], v[92:95], v[64:67], v[164:167]
v_mfma_f32_16x16x32_bf16 v[172:175], v[92:95], v[68:71], v[172:175]
v_mfma_f32_16x16x32_bf16 v[168:171], v[88:91], v[68:71], v[168:171]
v_mfma_f32_16x16x32_bf16 v[140:143], v[84:87], v[68:71], v[140:143]
v_mfma_f32_16x16x32_bf16 v[136:139], v[80:83], v[68:71], v[136:139]
v_mfma_f32_16x16x32_bf16 v[144:147], v[80:83], v[72:75], v[144:147]
v_mfma_f32_16x16x32_bf16 v[148:151], v[84:87], v[72:75], v[148:151]
v_mfma_f32_16x16x32_bf16 v[176:179], v[88:91], v[72:75], v[176:179]
v_mfma_f32_16x16x32_bf16 v[180:183], v[92:95], v[72:75], v[180:183]
v_mfma_f32_16x16x32_bf16 v[188:191], v[92:95], v[76:79], v[188:191]
v_mfma_f32_16x16x32_bf16 v[184:187], v[88:91], v[76:79], v[184:187]
v_mfma_f32_16x16x32_bf16 v[156:159], v[84:87], v[76:79], v[156:159]
v_mfma_f32_16x16x32_bf16 v[152:155], v[80:83], v[76:79], v[152:155]
s_waitcnt lgkmcnt(0)
s_barrier
v_mfma_f32_16x16x32_bf16 v[128:131], v[112:115], v[96:99], v[128:131]
ds_read_b128 v[32:35], v9 offset:0
ds_read_b64_tr_b16 v[48:49], v11 offset:0
v_mfma_f32_16x16x32_bf16 v[132:135], v[116:119], v[96:99], v[132:135]
ds_read_b64_tr_b16 v[50:51], v11 offset:4096
ds_read_b64_tr_b16 v[52:53], v12 offset:0
v_mfma_f32_16x16x32_bf16 v[160:163], v[120:123], v[96:99], v[160:163]
ds_read_b64_tr_b16 v[54:55], v12 offset:4096
ds_read_b64_tr_b16 v[56:57], v13 offset:0
v_mfma_f32_16x16x32_bf16 v[164:167], v[124:127], v[96:99], v[164:167]
ds_read_b64_tr_b16 v[58:59], v13 offset:4096
ds_read_b64_tr_b16 v[60:61], v14 offset:0
v_mfma_f32_16x16x32_bf16 v[172:175], v[124:127], v[100:103], v[172:175]
ds_read_b64_tr_b16 v[62:63], v14 offset:4096
ds_read_b128 v[36:39], v9 offset:1024
v_mfma_f32_16x16x32_bf16 v[168:171], v[120:123], v[100:103], v[168:171]
ds_read_b128 v[40:43], v9 offset:2048
ds_read_b128 v[44:47], v9 offset:3072
v_mfma_f32_16x16x32_bf16 v[140:143], v[116:119], v[100:103], v[140:143]
ds_read_b128 v[64:67], v9 offset:8192
ds_read_b64_tr_b16 v[80:81], v11 offset:8192
v_mfma_f32_16x16x32_bf16 v[136:139], v[112:115], v[100:103], v[136:139]
ds_read_b64_tr_b16 v[82:83], v11 offset:12288
ds_read_b64_tr_b16 v[84:85], v12 offset:8192
v_mfma_f32_16x16x32_bf16 v[144:147], v[112:115], v[104:107], v[144:147]
ds_read_b64_tr_b16 v[86:87], v12 offset:12288
ds_read_b64_tr_b16 v[88:89], v13 offset:8192
v_mfma_f32_16x16x32_bf16 v[148:151], v[116:119], v[104:107], v[148:151]
ds_read_b64_tr_b16 v[90:91], v13 offset:12288
ds_read_b64_tr_b16 v[92:93], v14 offset:8192
v_mfma_f32_16x16x32_bf16 v[176:179], v[120:123], v[104:107], v[176:179]
ds_read_b64_tr_b16 v[94:95], v14 offset:12288
ds_read_b128 v[68:71], v9 offset:9216
v_mfma_f32_16x16x32_bf16 v[180:183], v[124:127], v[104:107], v[180:183]
ds_read_b128 v[72:75], v9 offset:10240
ds_read_b128 v[76:79], v9 offset:11264
v_mfma_f32_16x16x32_bf16 v[188:191], v[124:127], v[108:111], v[188:191]
v_mfma_f32_16x16x32_bf16 v[184:187], v[120:123], v[108:111], v[184:187]
v_mfma_f32_16x16x32_bf16 v[156:159], v[116:119], v[108:111], v[156:159]
v_mfma_f32_16x16x32_bf16 v[152:155], v[112:115], v[108:111], v[152:155]
v_mfma_f32_16x16x32_bf16 v[128:131], v[208:211], v[192:195], v[128:131]
v_mfma_f32_16x16x32_bf16 v[132:135], v[212:215], v[192:195], v[132:135]
v_mfma_f32_16x16x32_bf16 v[160:163], v[216:219], v[192:195], v[160:163]
v_mfma_f32_16x16x32_bf16 v[164:167], v[220:223], v[192:195], v[164:167]
v_mfma_f32_16x16x32_bf16 v[172:175], v[220:223], v[196:199], v[172:175]
v_mfma_f32_16x16x32_bf16 v[168:171], v[216:219], v[196:199], v[168:171]
v_mfma_f32_16x16x32_bf16 v[140:143], v[212:215], v[196:199], v[140:143]
v_mfma_f32_16x16x32_bf16 v[136:139], v[208:211], v[196:199], v[136:139]
v_mfma_f32_16x16x32_bf16 v[144:147], v[208:211], v[200:203], v[144:147]
v_mfma_f32_16x16x32_bf16 v[148:151], v[212:215], v[200:203], v[148:151]
v_mfma_f32_16x16x32_bf16 v[176:179], v[216:219], v[200:203], v[176:179]
v_mfma_f32_16x16x32_bf16 v[180:183], v[220:223], v[200:203], v[180:183]
v_mfma_f32_16x16x32_bf16 v[188:191], v[220:223], v[204:207], v[188:191]
v_mfma_f32_16x16x32_bf16 v[184:187], v[216:219], v[204:207], v[184:187]
v_mfma_f32_16x16x32_bf16 v[156:159], v[212:215], v[204:207], v[156:159]
v_mfma_f32_16x16x32_bf16 v[152:155], v[208:211], v[204:207], v[152:155]
s_waitcnt lgkmcnt(0)
s_barrier
v_mfma_f32_16x16x32_bf16 v[128:131], v[48:51], v[32:35], v[128:131]
ds_read_b128 v[96:99], v9 offset:32768
ds_read_b64_tr_b16 v[112:113], v11 offset:32768
v_mfma_f32_16x16x32_bf16 v[132:135], v[52:55], v[32:35], v[132:135]
ds_read_b64_tr_b16 v[114:115], v11 offset:36864
ds_read_b64_tr_b16 v[116:117], v12 offset:32768
v_mfma_f32_16x16x32_bf16 v[160:163], v[56:59], v[32:35], v[160:163]
ds_read_b64_tr_b16 v[118:119], v12 offset:36864
ds_read_b64_tr_b16 v[120:121], v13 offset:32768
v_mfma_f32_16x16x32_bf16 v[164:167], v[60:63], v[32:35], v[164:167]
ds_read_b64_tr_b16 v[122:123], v13 offset:36864
ds_read_b64_tr_b16 v[124:125], v14 offset:32768
v_mfma_f32_16x16x32_bf16 v[172:175], v[60:63], v[36:39], v[172:175]
ds_read_b64_tr_b16 v[126:127], v14 offset:36864
ds_read_b128 v[100:103], v9 offset:33792
v_mfma_f32_16x16x32_bf16 v[168:171], v[56:59], v[36:39], v[168:171]
ds_read_b128 v[104:107], v9 offset:34816
ds_read_b128 v[108:111], v9 offset:35840
v_mfma_f32_16x16x32_bf16 v[140:143], v[52:55], v[36:39], v[140:143]
ds_read_b128 v[192:195], v9 offset:40960
ds_read_b64_tr_b16 v[208:209], v11 offset:40960
v_mfma_f32_16x16x32_bf16 v[136:139], v[48:51], v[36:39], v[136:139]
ds_read_b64_tr_b16 v[210:211], v11 offset:45056
ds_read_b64_tr_b16 v[212:213], v12 offset:40960
v_mfma_f32_16x16x32_bf16 v[144:147], v[48:51], v[40:43], v[144:147]
ds_read_b64_tr_b16 v[214:215], v12 offset:45056
ds_read_b64_tr_b16 v[216:217], v13 offset:40960
v_mfma_f32_16x16x32_bf16 v[148:151], v[52:55], v[40:43], v[148:151]
ds_read_b64_tr_b16 v[218:219], v13 offset:45056
ds_read_b64_tr_b16 v[220:221], v14 offset:40960
v_mfma_f32_16x16x32_bf16 v[176:179], v[56:59], v[40:43], v[176:179]
ds_read_b64_tr_b16 v[222:223], v14 offset:45056
ds_read_b128 v[196:199], v9 offset:41984
v_mfma_f32_16x16x32_bf16 v[180:183], v[60:63], v[40:43], v[180:183]
ds_read_b128 v[200:203], v9 offset:43008
ds_read_b128 v[204:207], v9 offset:44032
v_mfma_f32_16x16x32_bf16 v[188:191], v[60:63], v[44:47], v[188:191]
v_mfma_f32_16x16x32_bf16 v[184:187], v[56:59], v[44:47], v[184:187]
v_mfma_f32_16x16x32_bf16 v[156:159], v[52:55], v[44:47], v[156:159]
v_mfma_f32_16x16x32_bf16 v[152:155], v[48:51], v[44:47], v[152:155]
v_mfma_f32_16x16x32_bf16 v[128:131], v[80:83], v[64:67], v[128:131]
v_mfma_f32_16x16x32_bf16 v[132:135], v[84:87], v[64:67], v[132:135]
v_mfma_f32_16x16x32_bf16 v[160:163], v[88:91], v[64:67], v[160:163]
v_mfma_f32_16x16x32_bf16 v[164:167], v[92:95], v[64:67], v[164:167]
v_mfma_f32_16x16x32_bf16 v[172:175], v[92:95], v[68:71], v[172:175]
v_mfma_f32_16x16x32_bf16 v[168:171], v[88:91], v[68:71], v[168:171]
v_mfma_f32_16x16x32_bf16 v[140:143], v[84:87], v[68:71], v[140:143]
v_mfma_f32_16x16x32_bf16 v[136:139], v[80:83], v[68:71], v[136:139]
v_mfma_f32_16x16x32_bf16 v[144:147], v[80:83], v[72:75], v[144:147]
v_mfma_f32_16x16x32_bf16 v[148:151], v[84:87], v[72:75], v[148:151]
v_mfma_f32_16x16x32_bf16 v[176:179], v[88:91], v[72:75], v[176:179]
v_mfma_f32_16x16x32_bf16 v[180:183], v[92:95], v[72:75], v[180:183]
v_mfma_f32_16x16x32_bf16 v[188:191], v[92:95], v[76:79], v[188:191]
v_mfma_f32_16x16x32_bf16 v[184:187], v[88:91], v[76:79], v[184:187]
v_mfma_f32_16x16x32_bf16 v[156:159], v[84:87], v[76:79], v[156:159]
v_mfma_f32_16x16x32_bf16 v[152:155], v[80:83], v[76:79], v[152:155]
s_waitcnt lgkmcnt(0)
s_barrier
v_mfma_f32_16x16x32_bf16 v[128:131], v[112:115], v[96:99], v[128:131]
ds_read_b128 v[32:35], v244 offset:0
ds_read_b64_tr_b16 v[48:49], v245 offset:0
v_mfma_f32_16x16x32_bf16 v[132:135], v[116:119], v[96:99], v[132:135]
ds_read_b64_tr_b16 v[50:51], v245 offset:4096
ds_read_b64_tr_b16 v[52:53], v246 offset:0
v_mfma_f32_16x16x32_bf16 v[160:163], v[120:123], v[96:99], v[160:163]
ds_read_b64_tr_b16 v[54:55], v246 offset:4096
ds_read_b64_tr_b16 v[56:57], v247 offset:0
v_mfma_f32_16x16x32_bf16 v[164:167], v[124:127], v[96:99], v[164:167]
ds_read_b64_tr_b16 v[58:59], v247 offset:4096
ds_read_b64_tr_b16 v[60:61], v248 offset:0
v_mfma_f32_16x16x32_bf16 v[172:175], v[124:127], v[100:103], v[172:175]
ds_read_b64_tr_b16 v[62:63], v248 offset:4096
ds_read_b128 v[36:39], v244 offset:1024
v_mfma_f32_16x16x32_bf16 v[168:171], v[120:123], v[100:103], v[168:171]
ds_read_b128 v[40:43], v244 offset:2048
ds_read_b128 v[44:47], v244 offset:3072
v_mfma_f32_16x16x32_bf16 v[140:143], v[116:119], v[100:103], v[140:143]
ds_read_b128 v[64:67], v244 offset:8192
ds_read_b64_tr_b16 v[80:81], v245 offset:8192
v_mfma_f32_16x16x32_bf16 v[136:139], v[112:115], v[100:103], v[136:139]
ds_read_b64_tr_b16 v[82:83], v245 offset:12288
ds_read_b64_tr_b16 v[84:85], v246 offset:8192
v_mfma_f32_16x16x32_bf16 v[144:147], v[112:115], v[104:107], v[144:147]
ds_read_b64_tr_b16 v[86:87], v246 offset:12288
ds_read_b64_tr_b16 v[88:89], v247 offset:8192
v_mfma_f32_16x16x32_bf16 v[148:151], v[116:119], v[104:107], v[148:151]
ds_read_b64_tr_b16 v[90:91], v247 offset:12288
ds_read_b64_tr_b16 v[92:93], v248 offset:8192
v_mfma_f32_16x16x32_bf16 v[176:179], v[120:123], v[104:107], v[176:179]
ds_read_b64_tr_b16 v[94:95], v248 offset:12288
ds_read_b128 v[68:71], v244 offset:9216
v_mfma_f32_16x16x32_bf16 v[180:183], v[124:127], v[104:107], v[180:183]
ds_read_b128 v[72:75], v244 offset:10240
ds_read_b128 v[76:79], v244 offset:11264
v_mfma_f32_16x16x32_bf16 v[188:191], v[124:127], v[108:111], v[188:191]
v_mfma_f32_16x16x32_bf16 v[184:187], v[120:123], v[108:111], v[184:187]
v_mfma_f32_16x16x32_bf16 v[156:159], v[116:119], v[108:111], v[156:159]
v_mfma_f32_16x16x32_bf16 v[152:155], v[112:115], v[108:111], v[152:155]
v_mfma_f32_16x16x32_bf16 v[128:131], v[208:211], v[192:195], v[128:131]
v_mfma_f32_16x16x32_bf16 v[132:135], v[212:215], v[192:195], v[132:135]
v_mfma_f32_16x16x32_bf16 v[160:163], v[216:219], v[192:195], v[160:163]
v_mfma_f32_16x16x32_bf16 v[164:167], v[220:223], v[192:195], v[164:167]
v_mfma_f32_16x16x32_bf16 v[172:175], v[220:223], v[196:199], v[172:175]
v_mfma_f32_16x16x32_bf16 v[168:171], v[216:219], v[196:199], v[168:171]
v_mfma_f32_16x16x32_bf16 v[140:143], v[212:215], v[196:199], v[140:143]
v_mfma_f32_16x16x32_bf16 v[136:139], v[208:211], v[196:199], v[136:139]
v_mfma_f32_16x16x32_bf16 v[144:147], v[208:211], v[200:203], v[144:147]
v_mfma_f32_16x16x32_bf16 v[148:151], v[212:215], v[200:203], v[148:151]
v_mfma_f32_16x16x32_bf16 v[176:179], v[216:219], v[200:203], v[176:179]
v_mfma_f32_16x16x32_bf16 v[180:183], v[220:223], v[200:203], v[180:183]
v_mfma_f32_16x16x32_bf16 v[188:191], v[220:223], v[204:207], v[188:191]
v_mfma_f32_16x16x32_bf16 v[184:187], v[216:219], v[204:207], v[184:187]
v_mfma_f32_16x16x32_bf16 v[156:159], v[212:215], v[204:207], v[156:159]
v_mfma_f32_16x16x32_bf16 v[152:155], v[208:211], v[204:207], v[152:155]
s_waitcnt lgkmcnt(0)
s_barrier
v_mfma_f32_16x16x32_bf16 v[128:131], v[48:51], v[32:35], v[128:131]
ds_read_b128 v[96:99], v244 offset:32768
ds_read_b64_tr_b16 v[112:113], v245 offset:32768
v_mfma_f32_16x16x32_bf16 v[132:135], v[52:55], v[32:35], v[132:135]
ds_read_b64_tr_b16 v[114:115], v245 offset:36864
ds_read_b64_tr_b16 v[116:117], v246 offset:32768
v_mfma_f32_16x16x32_bf16 v[160:163], v[56:59], v[32:35], v[160:163]
ds_read_b64_tr_b16 v[118:119], v246 offset:36864
ds_read_b64_tr_b16 v[120:121], v247 offset:32768
v_mfma_f32_16x16x32_bf16 v[164:167], v[60:63], v[32:35], v[164:167]
ds_read_b64_tr_b16 v[122:123], v247 offset:36864
ds_read_b64_tr_b16 v[124:125], v248 offset:32768
v_mfma_f32_16x16x32_bf16 v[172:175], v[60:63], v[36:39], v[172:175]
ds_read_b64_tr_b16 v[126:127], v248 offset:36864
ds_read_b128 v[100:103], v244 offset:33792
v_mfma_f32_16x16x32_bf16 v[168:171], v[56:59], v[36:39], v[168:171]
ds_read_b128 v[104:107], v244 offset:34816
ds_read_b128 v[108:111], v244 offset:35840
v_mfma_f32_16x16x32_bf16 v[140:143], v[52:55], v[36:39], v[140:143]
ds_read_b128 v[192:195], v244 offset:40960
ds_read_b64_tr_b16 v[208:209], v245 offset:40960
v_mfma_f32_16x16x32_bf16 v[136:139], v[48:51], v[36:39], v[136:139]
ds_read_b64_tr_b16 v[210:211], v245 offset:45056
ds_read_b64_tr_b16 v[212:213], v246 offset:40960
v_mfma_f32_16x16x32_bf16 v[144:147], v[48:51], v[40:43], v[144:147]
ds_read_b64_tr_b16 v[214:215], v246 offset:45056
ds_read_b64_tr_b16 v[216:217], v247 offset:40960
v_mfma_f32_16x16x32_bf16 v[148:151], v[52:55], v[40:43], v[148:151]
ds_read_b64_tr_b16 v[218:219], v247 offset:45056
ds_read_b64_tr_b16 v[220:221], v248 offset:40960
v_mfma_f32_16x16x32_bf16 v[176:179], v[56:59], v[40:43], v[176:179]
ds_read_b64_tr_b16 v[222:223], v248 offset:45056
ds_read_b128 v[196:199], v244 offset:41984
v_mfma_f32_16x16x32_bf16 v[180:183], v[60:63], v[40:43], v[180:183]
ds_read_b128 v[200:203], v244 offset:43008
ds_read_b128 v[204:207], v244 offset:44032
v_mfma_f32_16x16x32_bf16 v[188:191], v[60:63], v[44:47], v[188:191]
v_mfma_f32_16x16x32_bf16 v[184:187], v[56:59], v[44:47], v[184:187]
v_mfma_f32_16x16x32_bf16 v[156:159], v[52:55], v[44:47], v[156:159]
v_mfma_f32_16x16x32_bf16 v[152:155], v[48:51], v[44:47], v[152:155]
v_mfma_f32_16x16x32_bf16 v[128:131], v[80:83], v[64:67], v[128:131]
v_mfma_f32_16x16x32_bf16 v[132:135], v[84:87], v[64:67], v[132:135]
v_mfma_f32_16x16x32_bf16 v[160:163], v[88:91], v[64:67], v[160:163]
v_mfma_f32_16x16x32_bf16 v[164:167], v[92:95], v[64:67], v[164:167]
v_mfma_f32_16x16x32_bf16 v[172:175], v[92:95], v[68:71], v[172:175]
v_mfma_f32_16x16x32_bf16 v[168:171], v[88:91], v[68:71], v[168:171]
v_mfma_f32_16x16x32_bf16 v[140:143], v[84:87], v[68:71], v[140:143]
v_mfma_f32_16x16x32_bf16 v[136:139], v[80:83], v[68:71], v[136:139]
v_mfma_f32_16x16x32_bf16 v[144:147], v[80:83], v[72:75], v[144:147]
v_mfma_f32_16x16x32_bf16 v[148:151], v[84:87], v[72:75], v[148:151]
v_mfma_f32_16x16x32_bf16 v[176:179], v[88:91], v[72:75], v[176:179]
v_mfma_f32_16x16x32_bf16 v[180:183], v[92:95], v[72:75], v[180:183]
v_mfma_f32_16x16x32_bf16 v[188:191], v[92:95], v[76:79], v[188:191]
v_mfma_f32_16x16x32_bf16 v[184:187], v[88:91], v[76:79], v[184:187]
v_mfma_f32_16x16x32_bf16 v[156:159], v[84:87], v[76:79], v[156:159]
v_mfma_f32_16x16x32_bf16 v[152:155], v[80:83], v[76:79], v[152:155]
s_waitcnt lgkmcnt(0)
s_barrier
v_mfma_f32_16x16x32_bf16 v[128:131], v[112:115], v[96:99], v[128:131]
ds_read_b128 v[32:35], v10 offset:0
ds_read_b64_tr_b16 v[48:49], v15 offset:0
v_mfma_f32_16x16x32_bf16 v[132:135], v[116:119], v[96:99], v[132:135]
ds_read_b64_tr_b16 v[50:51], v15 offset:4096
ds_read_b64_tr_b16 v[52:53], v16 offset:0
v_mfma_f32_16x16x32_bf16 v[160:163], v[120:123], v[96:99], v[160:163]
ds_read_b64_tr_b16 v[54:55], v16 offset:4096
ds_read_b64_tr_b16 v[56:57], v17 offset:0
v_mfma_f32_16x16x32_bf16 v[164:167], v[124:127], v[96:99], v[164:167]
ds_read_b64_tr_b16 v[58:59], v17 offset:4096
ds_read_b64_tr_b16 v[60:61], v18 offset:0
v_mfma_f32_16x16x32_bf16 v[172:175], v[124:127], v[100:103], v[172:175]
ds_read_b64_tr_b16 v[62:63], v18 offset:4096
ds_read_b128 v[36:39], v10 offset:1024
v_mfma_f32_16x16x32_bf16 v[168:171], v[120:123], v[100:103], v[168:171]
ds_read_b128 v[40:43], v10 offset:2048
ds_read_b128 v[44:47], v10 offset:3072
v_mfma_f32_16x16x32_bf16 v[140:143], v[116:119], v[100:103], v[140:143]
ds_read_b128 v[64:67], v10 offset:8192
ds_read_b64_tr_b16 v[80:81], v15 offset:8192
v_mfma_f32_16x16x32_bf16 v[136:139], v[112:115], v[100:103], v[136:139]
ds_read_b64_tr_b16 v[82:83], v15 offset:12288
ds_read_b64_tr_b16 v[84:85], v16 offset:8192
v_mfma_f32_16x16x32_bf16 v[144:147], v[112:115], v[104:107], v[144:147]
ds_read_b64_tr_b16 v[86:87], v16 offset:12288
ds_read_b64_tr_b16 v[88:89], v17 offset:8192
v_mfma_f32_16x16x32_bf16 v[148:151], v[116:119], v[104:107], v[148:151]
ds_read_b64_tr_b16 v[90:91], v17 offset:12288
ds_read_b64_tr_b16 v[92:93], v18 offset:8192
v_mfma_f32_16x16x32_bf16 v[176:179], v[120:123], v[104:107], v[176:179]
ds_read_b64_tr_b16 v[94:95], v18 offset:12288
ds_read_b128 v[68:71], v10 offset:9216
v_mfma_f32_16x16x32_bf16 v[180:183], v[124:127], v[104:107], v[180:183]
ds_read_b128 v[72:75], v10 offset:10240
ds_read_b128 v[76:79], v10 offset:11264
v_mfma_f32_16x16x32_bf16 v[188:191], v[124:127], v[108:111], v[188:191]
v_mfma_f32_16x16x32_bf16 v[184:187], v[120:123], v[108:111], v[184:187]
v_mfma_f32_16x16x32_bf16 v[156:159], v[116:119], v[108:111], v[156:159]
v_mfma_f32_16x16x32_bf16 v[152:155], v[112:115], v[108:111], v[152:155]
v_mfma_f32_16x16x32_bf16 v[128:131], v[208:211], v[192:195], v[128:131]
v_mfma_f32_16x16x32_bf16 v[132:135], v[212:215], v[192:195], v[132:135]
v_mfma_f32_16x16x32_bf16 v[160:163], v[216:219], v[192:195], v[160:163]
v_mfma_f32_16x16x32_bf16 v[164:167], v[220:223], v[192:195], v[164:167]
v_mfma_f32_16x16x32_bf16 v[172:175], v[220:223], v[196:199], v[172:175]
v_mfma_f32_16x16x32_bf16 v[168:171], v[216:219], v[196:199], v[168:171]
v_mfma_f32_16x16x32_bf16 v[140:143], v[212:215], v[196:199], v[140:143]
v_mfma_f32_16x16x32_bf16 v[136:139], v[208:211], v[196:199], v[136:139]
v_mfma_f32_16x16x32_bf16 v[144:147], v[208:211], v[200:203], v[144:147]
v_mfma_f32_16x16x32_bf16 v[148:151], v[212:215], v[200:203], v[148:151]
v_mfma_f32_16x16x32_bf16 v[176:179], v[216:219], v[200:203], v[176:179]
v_mfma_f32_16x16x32_bf16 v[180:183], v[220:223], v[200:203], v[180:183]
v_mfma_f32_16x16x32_bf16 v[188:191], v[220:223], v[204:207], v[188:191]
v_mfma_f32_16x16x32_bf16 v[184:187], v[216:219], v[204:207], v[184:187]
v_mfma_f32_16x16x32_bf16 v[156:159], v[212:215], v[204:207], v[156:159]
v_mfma_f32_16x16x32_bf16 v[152:155], v[208:211], v[204:207], v[152:155]
s_waitcnt lgkmcnt(0)
s_barrier
v_mfma_f32_16x16x32_bf16 v[128:131], v[48:51], v[32:35], v[128:131]
ds_read_b128 v[96:99], v9 offset:0
ds_read_b64_tr_b16 v[112:113], v11 offset:0
v_mfma_f32_16x16x32_bf16 v[132:135], v[52:55], v[32:35], v[132:135]
ds_read_b64_tr_b16 v[114:115], v11 offset:4096
ds_read_b64_tr_b16 v[116:117], v12 offset:0
v_mfma_f32_16x16x32_bf16 v[160:163], v[56:59], v[32:35], v[160:163]
ds_read_b64_tr_b16 v[118:119], v12 offset:4096
ds_read_b64_tr_b16 v[120:121], v13 offset:0
v_mfma_f32_16x16x32_bf16 v[164:167], v[60:63], v[32:35], v[164:167]
ds_read_b64_tr_b16 v[122:123], v13 offset:4096
ds_read_b64_tr_b16 v[124:125], v14 offset:0
v_mfma_f32_16x16x32_bf16 v[172:175], v[60:63], v[36:39], v[172:175]
ds_read_b64_tr_b16 v[126:127], v14 offset:4096
ds_read_b128 v[100:103], v9 offset:1024
v_mfma_f32_16x16x32_bf16 v[168:171], v[56:59], v[36:39], v[168:171]
ds_read_b128 v[104:107], v9 offset:2048
ds_read_b128 v[108:111], v9 offset:3072
v_mfma_f32_16x16x32_bf16 v[140:143], v[52:55], v[36:39], v[140:143]
ds_read_b128 v[192:195], v9 offset:8192
ds_read_b64_tr_b16 v[208:209], v11 offset:8192
v_mfma_f32_16x16x32_bf16 v[136:139], v[48:51], v[36:39], v[136:139]
ds_read_b64_tr_b16 v[210:211], v11 offset:12288
ds_read_b64_tr_b16 v[212:213], v12 offset:8192
v_mfma_f32_16x16x32_bf16 v[144:147], v[48:51], v[40:43], v[144:147]
ds_read_b64_tr_b16 v[214:215], v12 offset:12288
ds_read_b64_tr_b16 v[216:217], v13 offset:8192
v_mfma_f32_16x16x32_bf16 v[148:151], v[52:55], v[40:43], v[148:151]
ds_read_b64_tr_b16 v[218:219], v13 offset:12288
ds_read_b64_tr_b16 v[220:221], v14 offset:8192
v_mfma_f32_16x16x32_bf16 v[176:179], v[56:59], v[40:43], v[176:179]
ds_read_b64_tr_b16 v[222:223], v14 offset:12288
ds_read_b128 v[196:199], v9 offset:9216
v_mfma_f32_16x16x32_bf16 v[180:183], v[60:63], v[40:43], v[180:183]
ds_read_b128 v[200:203], v9 offset:10240
ds_read_b128 v[204:207], v9 offset:11264
v_mfma_f32_16x16x32_bf16 v[188:191], v[60:63], v[44:47], v[188:191]
v_mfma_f32_16x16x32_bf16 v[184:187], v[56:59], v[44:47], v[184:187]
v_mfma_f32_16x16x32_bf16 v[156:159], v[52:55], v[44:47], v[156:159]
v_mfma_f32_16x16x32_bf16 v[152:155], v[48:51], v[44:47], v[152:155]
v_mfma_f32_16x16x32_bf16 v[128:131], v[80:83], v[64:67], v[128:131]
v_mfma_f32_16x16x32_bf16 v[132:135], v[84:87], v[64:67], v[132:135]
v_mfma_f32_16x16x32_bf16 v[160:163], v[88:91], v[64:67], v[160:163]
v_mfma_f32_16x16x32_bf16 v[164:167], v[92:95], v[64:67], v[164:167]
v_mfma_f32_16x16x32_bf16 v[172:175], v[92:95], v[68:71], v[172:175]
v_mfma_f32_16x16x32_bf16 v[168:171], v[88:91], v[68:71], v[168:171]
v_mfma_f32_16x16x32_bf16 v[140:143], v[84:87], v[68:71], v[140:143]
v_mfma_f32_16x16x32_bf16 v[136:139], v[80:83], v[68:71], v[136:139]
v_mfma_f32_16x16x32_bf16 v[144:147], v[80:83], v[72:75], v[144:147]
v_mfma_f32_16x16x32_bf16 v[148:151], v[84:87], v[72:75], v[148:151]
v_mfma_f32_16x16x32_bf16 v[176:179], v[88:91], v[72:75], v[176:179]
v_mfma_f32_16x16x32_bf16 v[180:183], v[92:95], v[72:75], v[180:183]
v_mfma_f32_16x16x32_bf16 v[188:191], v[92:95], v[76:79], v[188:191]
v_mfma_f32_16x16x32_bf16 v[184:187], v[88:91], v[76:79], v[184:187]
v_mfma_f32_16x16x32_bf16 v[156:159], v[84:87], v[76:79], v[156:159]
v_mfma_f32_16x16x32_bf16 v[152:155], v[80:83], v[76:79], v[152:155]
s_waitcnt lgkmcnt(0)
s_barrier
v_mfma_f32_16x16x32_bf16 v[128:131], v[112:115], v[96:99], v[128:131]
ds_read_b128 v[32:35], v9 offset:32768
ds_read_b64_tr_b16 v[48:49], v11 offset:32768
v_mfma_f32_16x16x32_bf16 v[132:135], v[116:119], v[96:99], v[132:135]
ds_read_b64_tr_b16 v[50:51], v11 offset:36864
ds_read_b64_tr_b16 v[52:53], v12 offset:32768
v_mfma_f32_16x16x32_bf16 v[160:163], v[120:123], v[96:99], v[160:163]
ds_read_b64_tr_b16 v[54:55], v12 offset:36864
ds_read_b64_tr_b16 v[56:57], v13 offset:32768
v_mfma_f32_16x16x32_bf16 v[164:167], v[124:127], v[96:99], v[164:167]
ds_read_b64_tr_b16 v[58:59], v13 offset:36864
ds_read_b64_tr_b16 v[60:61], v14 offset:32768
v_mfma_f32_16x16x32_bf16 v[172:175], v[124:127], v[100:103], v[172:175]
ds_read_b64_tr_b16 v[62:63], v14 offset:36864
ds_read_b128 v[36:39], v9 offset:33792
v_mfma_f32_16x16x32_bf16 v[168:171], v[120:123], v[100:103], v[168:171]
ds_read_b128 v[40:43], v9 offset:34816
ds_read_b128 v[44:47], v9 offset:35840
v_mfma_f32_16x16x32_bf16 v[140:143], v[116:119], v[100:103], v[140:143]
ds_read_b128 v[64:67], v9 offset:40960
ds_read_b64_tr_b16 v[80:81], v11 offset:40960
v_mfma_f32_16x16x32_bf16 v[136:139], v[112:115], v[100:103], v[136:139]
ds_read_b64_tr_b16 v[82:83], v11 offset:45056
ds_read_b64_tr_b16 v[84:85], v12 offset:40960
v_mfma_f32_16x16x32_bf16 v[144:147], v[112:115], v[104:107], v[144:147]
ds_read_b64_tr_b16 v[86:87], v12 offset:45056
ds_read_b64_tr_b16 v[88:89], v13 offset:40960
v_mfma_f32_16x16x32_bf16 v[148:151], v[116:119], v[104:107], v[148:151]
ds_read_b64_tr_b16 v[90:91], v13 offset:45056
ds_read_b64_tr_b16 v[92:93], v14 offset:40960
v_mfma_f32_16x16x32_bf16 v[176:179], v[120:123], v[104:107], v[176:179]
ds_read_b64_tr_b16 v[94:95], v14 offset:45056
ds_read_b128 v[68:71], v9 offset:41984
v_mfma_f32_16x16x32_bf16 v[180:183], v[124:127], v[104:107], v[180:183]
ds_read_b128 v[72:75], v9 offset:43008
ds_read_b128 v[76:79], v9 offset:44032
v_mfma_f32_16x16x32_bf16 v[188:191], v[124:127], v[108:111], v[188:191]
v_mfma_f32_16x16x32_bf16 v[184:187], v[120:123], v[108:111], v[184:187]
v_mfma_f32_16x16x32_bf16 v[156:159], v[116:119], v[108:111], v[156:159]
v_mfma_f32_16x16x32_bf16 v[152:155], v[112:115], v[108:111], v[152:155]
v_mfma_f32_16x16x32_bf16 v[128:131], v[208:211], v[192:195], v[128:131]
v_mfma_f32_16x16x32_bf16 v[132:135], v[212:215], v[192:195], v[132:135]
v_mfma_f32_16x16x32_bf16 v[160:163], v[216:219], v[192:195], v[160:163]
v_mfma_f32_16x16x32_bf16 v[164:167], v[220:223], v[192:195], v[164:167]
v_mfma_f32_16x16x32_bf16 v[172:175], v[220:223], v[196:199], v[172:175]
v_mfma_f32_16x16x32_bf16 v[168:171], v[216:219], v[196:199], v[168:171]
v_mfma_f32_16x16x32_bf16 v[140:143], v[212:215], v[196:199], v[140:143]
v_mfma_f32_16x16x32_bf16 v[136:139], v[208:211], v[196:199], v[136:139]
v_mfma_f32_16x16x32_bf16 v[144:147], v[208:211], v[200:203], v[144:147]
v_mfma_f32_16x16x32_bf16 v[148:151], v[212:215], v[200:203], v[148:151]
v_mfma_f32_16x16x32_bf16 v[176:179], v[216:219], v[200:203], v[176:179]
v_mfma_f32_16x16x32_bf16 v[180:183], v[220:223], v[200:203], v[180:183]
v_mfma_f32_16x16x32_bf16 v[188:191], v[220:223], v[204:207], v[188:191]
v_mfma_f32_16x16x32_bf16 v[184:187], v[216:219], v[204:207], v[184:187]
v_mfma_f32_16x16x32_bf16 v[156:159], v[212:215], v[204:207], v[156:159]
v_mfma_f32_16x16x32_bf16 v[152:155], v[208:211], v[204:207], v[152:155]
s_waitcnt lgkmcnt(0)
s_barrier
v_mfma_f32_16x16x32_bf16 v[128:131], v[48:51], v[32:35], v[128:131]
ds_read_b128 v[96:99], v244 offset:0
ds_read_b64_tr_b16 v[112:113], v245 offset:0
v_mfma_f32_16x16x32_bf16 v[132:135], v[52:55], v[32:35], v[132:135]
ds_read_b64_tr_b16 v[114:115], v245 offset:4096
ds_read_b64_tr_b16 v[116:117], v246 offset:0
v_mfma_f32_16x16x32_bf16 v[160:163], v[56:59], v[32:35], v[160:163]
ds_read_b64_tr_b16 v[118:119], v246 offset:4096
ds_read_b64_tr_b16 v[120:121], v247 offset:0
v_mfma_f32_16x16x32_bf16 v[164:167], v[60:63], v[32:35], v[164:167]
ds_read_b64_tr_b16 v[122:123], v247 offset:4096
ds_read_b64_tr_b16 v[124:125], v248 offset:0
v_mfma_f32_16x16x32_bf16 v[172:175], v[60:63], v[36:39], v[172:175]
ds_read_b64_tr_b16 v[126:127], v248 offset:4096
ds_read_b128 v[100:103], v244 offset:1024
v_mfma_f32_16x16x32_bf16 v[168:171], v[56:59], v[36:39], v[168:171]
ds_read_b128 v[104:107], v244 offset:2048
ds_read_b128 v[108:111], v244 offset:3072
v_mfma_f32_16x16x32_bf16 v[140:143], v[52:55], v[36:39], v[140:143]
ds_read_b128 v[192:195], v244 offset:8192
ds_read_b64_tr_b16 v[208:209], v245 offset:8192
v_mfma_f32_16x16x32_bf16 v[136:139], v[48:51], v[36:39], v[136:139]
ds_read_b64_tr_b16 v[210:211], v245 offset:12288
ds_read_b64_tr_b16 v[212:213], v246 offset:8192
v_mfma_f32_16x16x32_bf16 v[144:147], v[48:51], v[40:43], v[144:147]
ds_read_b64_tr_b16 v[214:215], v246 offset:12288
ds_read_b64_tr_b16 v[216:217], v247 offset:8192
v_mfma_f32_16x16x32_bf16 v[148:151], v[52:55], v[40:43], v[148:151]
ds_read_b64_tr_b16 v[218:219], v247 offset:12288
ds_read_b64_tr_b16 v[220:221], v248 offset:8192
v_mfma_f32_16x16x32_bf16 v[176:179], v[56:59], v[40:43], v[176:179]
ds_read_b64_tr_b16 v[222:223], v248 offset:12288
ds_read_b128 v[196:199], v244 offset:9216
v_mfma_f32_16x16x32_bf16 v[180:183], v[60:63], v[40:43], v[180:183]
ds_read_b128 v[200:203], v244 offset:10240
ds_read_b128 v[204:207], v244 offset:11264
v_mfma_f32_16x16x32_bf16 v[188:191], v[60:63], v[44:47], v[188:191]
v_mfma_f32_16x16x32_bf16 v[184:187], v[56:59], v[44:47], v[184:187]
v_mfma_f32_16x16x32_bf16 v[156:159], v[52:55], v[44:47], v[156:159]
v_mfma_f32_16x16x32_bf16 v[152:155], v[48:51], v[44:47], v[152:155]
v_mfma_f32_16x16x32_bf16 v[128:131], v[80:83], v[64:67], v[128:131]
v_mfma_f32_16x16x32_bf16 v[132:135], v[84:87], v[64:67], v[132:135]
v_mfma_f32_16x16x32_bf16 v[160:163], v[88:91], v[64:67], v[160:163]
v_mfma_f32_16x16x32_bf16 v[164:167], v[92:95], v[64:67], v[164:167]
v_mfma_f32_16x16x32_bf16 v[172:175], v[92:95], v[68:71], v[172:175]
v_mfma_f32_16x16x32_bf16 v[168:171], v[88:91], v[68:71], v[168:171]
v_mfma_f32_16x16x32_bf16 v[140:143], v[84:87], v[68:71], v[140:143]
v_mfma_f32_16x16x32_bf16 v[136:139], v[80:83], v[68:71], v[136:139]
v_mfma_f32_16x16x32_bf16 v[144:147], v[80:83], v[72:75], v[144:147]
v_mfma_f32_16x16x32_bf16 v[148:151], v[84:87], v[72:75], v[148:151]
v_mfma_f32_16x16x32_bf16 v[176:179], v[88:91], v[72:75], v[176:179]
v_mfma_f32_16x16x32_bf16 v[180:183], v[92:95], v[72:75], v[180:183]
v_mfma_f32_16x16x32_bf16 v[188:191], v[92:95], v[76:79], v[188:191]
v_mfma_f32_16x16x32_bf16 v[184:187], v[88:91], v[76:79], v[184:187]
v_mfma_f32_16x16x32_bf16 v[156:159], v[84:87], v[76:79], v[156:159]
v_mfma_f32_16x16x32_bf16 v[152:155], v[80:83], v[76:79], v[152:155]
s_waitcnt lgkmcnt(0)
s_barrier
v_mfma_f32_16x16x32_bf16 v[128:131], v[112:115], v[96:99], v[128:131]
ds_read_b128 v[32:35], v244 offset:32768
ds_read_b64_tr_b16 v[48:49], v245 offset:32768
v_mfma_f32_16x16x32_bf16 v[132:135], v[116:119], v[96:99], v[132:135]
ds_read_b64_tr_b16 v[50:51], v245 offset:36864
ds_read_b64_tr_b16 v[52:53], v246 offset:32768
v_mfma_f32_16x16x32_bf16 v[160:163], v[120:123], v[96:99], v[160:163]
ds_read_b64_tr_b16 v[54:55], v246 offset:36864
ds_read_b64_tr_b16 v[56:57], v247 offset:32768
v_mfma_f32_16x16x32_bf16 v[164:167], v[124:127], v[96:99], v[164:167]
ds_read_b64_tr_b16 v[58:59], v247 offset:36864
ds_read_b64_tr_b16 v[60:61], v248 offset:32768
v_mfma_f32_16x16x32_bf16 v[172:175], v[124:127], v[100:103], v[172:175]
ds_read_b64_tr_b16 v[62:63], v248 offset:36864
ds_read_b128 v[36:39], v244 offset:33792
v_mfma_f32_16x16x32_bf16 v[168:171], v[120:123], v[100:103], v[168:171]
ds_read_b128 v[40:43], v244 offset:34816
ds_read_b128 v[44:47], v244 offset:35840
v_mfma_f32_16x16x32_bf16 v[140:143], v[116:119], v[100:103], v[140:143]
ds_read_b128 v[64:67], v244 offset:40960
ds_read_b64_tr_b16 v[80:81], v245 offset:40960
v_mfma_f32_16x16x32_bf16 v[136:139], v[112:115], v[100:103], v[136:139]
ds_read_b64_tr_b16 v[82:83], v245 offset:45056
ds_read_b64_tr_b16 v[84:85], v246 offset:40960
v_mfma_f32_16x16x32_bf16 v[144:147], v[112:115], v[104:107], v[144:147]
ds_read_b64_tr_b16 v[86:87], v246 offset:45056
ds_read_b64_tr_b16 v[88:89], v247 offset:40960
v_mfma_f32_16x16x32_bf16 v[148:151], v[116:119], v[104:107], v[148:151]
ds_read_b64_tr_b16 v[90:91], v247 offset:45056
ds_read_b64_tr_b16 v[92:93], v248 offset:40960
v_mfma_f32_16x16x32_bf16 v[176:179], v[120:123], v[104:107], v[176:179]
ds_read_b64_tr_b16 v[94:95], v248 offset:45056
ds_read_b128 v[68:71], v244 offset:41984
v_mfma_f32_16x16x32_bf16 v[180:183], v[124:127], v[104:107], v[180:183]
ds_read_b128 v[72:75], v244 offset:43008
ds_read_b128 v[76:79], v244 offset:44032
v_mfma_f32_16x16x32_bf16 v[188:191], v[124:127], v[108:111], v[188:191]
v_mfma_f32_16x16x32_bf16 v[184:187], v[120:123], v[108:111], v[184:187]
v_mfma_f32_16x16x32_bf16 v[156:159], v[116:119], v[108:111], v[156:159]
v_mfma_f32_16x16x32_bf16 v[152:155], v[112:115], v[108:111], v[152:155]
v_mfma_f32_16x16x32_bf16 v[128:131], v[208:211], v[192:195], v[128:131]
v_mfma_f32_16x16x32_bf16 v[132:135], v[212:215], v[192:195], v[132:135]
v_mfma_f32_16x16x32_bf16 v[160:163], v[216:219], v[192:195], v[160:163]
v_mfma_f32_16x16x32_bf16 v[164:167], v[220:223], v[192:195], v[164:167]
v_mfma_f32_16x16x32_bf16 v[172:175], v[220:223], v[196:199], v[172:175]
v_mfma_f32_16x16x32_bf16 v[168:171], v[216:219], v[196:199], v[168:171]
v_mfma_f32_16x16x32_bf16 v[140:143], v[212:215], v[196:199], v[140:143]
v_mfma_f32_16x16x32_bf16 v[136:139], v[208:211], v[196:199], v[136:139]
v_mfma_f32_16x16x32_bf16 v[144:147], v[208:211], v[200:203], v[144:147]
v_mfma_f32_16x16x32_bf16 v[148:151], v[212:215], v[200:203], v[148:151]
v_mfma_f32_16x16x32_bf16 v[176:179], v[216:219], v[200:203], v[176:179]
v_mfma_f32_16x16x32_bf16 v[180:183], v[220:223], v[200:203], v[180:183]
v_mfma_f32_16x16x32_bf16 v[188:191], v[220:223], v[204:207], v[188:191]
v_mfma_f32_16x16x32_bf16 v[184:187], v[216:219], v[204:207], v[184:187]
v_mfma_f32_16x16x32_bf16 v[156:159], v[212:215], v[204:207], v[156:159]
v_mfma_f32_16x16x32_bf16 v[152:155], v[208:211], v[204:207], v[152:155]
s_waitcnt lgkmcnt(0)
s_barrier
v_mfma_f32_16x16x32_bf16 v[128:131], v[48:51], v[32:35], v[128:131]
ds_read_b128 v[96:99], v10 offset:0
ds_read_b64_tr_b16 v[112:113], v15 offset:0
v_mfma_f32_16x16x32_bf16 v[132:135], v[52:55], v[32:35], v[132:135]
ds_read_b64_tr_b16 v[114:115], v15 offset:4096
ds_read_b64_tr_b16 v[116:117], v16 offset:0
v_mfma_f32_16x16x32_bf16 v[160:163], v[56:59], v[32:35], v[160:163]
ds_read_b64_tr_b16 v[118:119], v16 offset:4096
ds_read_b64_tr_b16 v[120:121], v17 offset:0
v_mfma_f32_16x16x32_bf16 v[164:167], v[60:63], v[32:35], v[164:167]
ds_read_b64_tr_b16 v[122:123], v17 offset:4096
ds_read_b64_tr_b16 v[124:125], v18 offset:0
v_mfma_f32_16x16x32_bf16 v[172:175], v[60:63], v[36:39], v[172:175]
ds_read_b64_tr_b16 v[126:127], v18 offset:4096
ds_read_b128 v[100:103], v10 offset:1024
v_mfma_f32_16x16x32_bf16 v[168:171], v[56:59], v[36:39], v[168:171]
ds_read_b128 v[104:107], v10 offset:2048
ds_read_b128 v[108:111], v10 offset:3072
v_mfma_f32_16x16x32_bf16 v[140:143], v[52:55], v[36:39], v[140:143]
ds_read_b128 v[192:195], v10 offset:8192
ds_read_b64_tr_b16 v[208:209], v15 offset:8192
v_mfma_f32_16x16x32_bf16 v[136:139], v[48:51], v[36:39], v[136:139]
ds_read_b64_tr_b16 v[210:211], v15 offset:12288
ds_read_b64_tr_b16 v[212:213], v16 offset:8192
v_mfma_f32_16x16x32_bf16 v[144:147], v[48:51], v[40:43], v[144:147]
ds_read_b64_tr_b16 v[214:215], v16 offset:12288
ds_read_b64_tr_b16 v[216:217], v17 offset:8192
v_mfma_f32_16x16x32_bf16 v[148:151], v[52:55], v[40:43], v[148:151]
ds_read_b64_tr_b16 v[218:219], v17 offset:12288
ds_read_b64_tr_b16 v[220:221], v18 offset:8192
v_mfma_f32_16x16x32_bf16 v[176:179], v[56:59], v[40:43], v[176:179]
ds_read_b64_tr_b16 v[222:223], v18 offset:12288
ds_read_b128 v[196:199], v10 offset:9216
v_mfma_f32_16x16x32_bf16 v[180:183], v[60:63], v[40:43], v[180:183]
ds_read_b128 v[200:203], v10 offset:10240
ds_read_b128 v[204:207], v10 offset:11264
v_mfma_f32_16x16x32_bf16 v[188:191], v[60:63], v[44:47], v[188:191]
v_mfma_f32_16x16x32_bf16 v[184:187], v[56:59], v[44:47], v[184:187]
v_mfma_f32_16x16x32_bf16 v[156:159], v[52:55], v[44:47], v[156:159]
v_mfma_f32_16x16x32_bf16 v[152:155], v[48:51], v[44:47], v[152:155]
v_mfma_f32_16x16x32_bf16 v[128:131], v[80:83], v[64:67], v[128:131]
v_mfma_f32_16x16x32_bf16 v[132:135], v[84:87], v[64:67], v[132:135]
v_mfma_f32_16x16x32_bf16 v[160:163], v[88:91], v[64:67], v[160:163]
v_mfma_f32_16x16x32_bf16 v[164:167], v[92:95], v[64:67], v[164:167]
v_mfma_f32_16x16x32_bf16 v[172:175], v[92:95], v[68:71], v[172:175]
v_mfma_f32_16x16x32_bf16 v[168:171], v[88:91], v[68:71], v[168:171]
v_mfma_f32_16x16x32_bf16 v[140:143], v[84:87], v[68:71], v[140:143]
v_mfma_f32_16x16x32_bf16 v[136:139], v[80:83], v[68:71], v[136:139]
v_mfma_f32_16x16x32_bf16 v[144:147], v[80:83], v[72:75], v[144:147]
v_mfma_f32_16x16x32_bf16 v[148:151], v[84:87], v[72:75], v[148:151]
v_mfma_f32_16x16x32_bf16 v[176:179], v[88:91], v[72:75], v[176:179]
v_mfma_f32_16x16x32_bf16 v[180:183], v[92:95], v[72:75], v[180:183]
v_mfma_f32_16x16x32_bf16 v[188:191], v[92:95], v[76:79], v[188:191]
v_mfma_f32_16x16x32_bf16 v[184:187], v[88:91], v[76:79], v[184:187]
v_mfma_f32_16x16x32_bf16 v[156:159], v[84:87], v[76:79], v[156:159]
v_mfma_f32_16x16x32_bf16 v[152:155], v[80:83], v[76:79], v[152:155]
s_waitcnt lgkmcnt(0)
s_barrier
v_mfma_f32_16x16x32_bf16 v[128:131], v[112:115], v[96:99], v[128:131]
ds_read_b128 v[32:35], v9 offset:0
ds_read_b64_tr_b16 v[48:49], v19 offset:0
v_mfma_f32_16x16x32_bf16 v[132:135], v[116:119], v[96:99], v[132:135]
ds_read_b64_tr_b16 v[50:51], v19 offset:2048
ds_read_b64_tr_b16 v[52:53], v20 offset:0
v_mfma_f32_16x16x32_bf16 v[160:163], v[120:123], v[96:99], v[160:163]
ds_read_b64_tr_b16 v[54:55], v20 offset:2048
ds_read_b128 v[36:39], v9 offset:1024
v_mfma_f32_16x16x32_bf16 v[164:167], v[124:127], v[96:99], v[164:167]
ds_read_b128 v[40:43], v9 offset:2048
ds_read_b128 v[44:47], v9 offset:3072
v_mfma_f32_16x16x32_bf16 v[172:175], v[124:127], v[100:103], v[172:175]
ds_read_b128 v[64:67], v9 offset:8192
ds_read_b64_tr_b16 v[80:81], v19 offset:4096
v_mfma_f32_16x16x32_bf16 v[168:171], v[120:123], v[100:103], v[168:171]
ds_read_b64_tr_b16 v[82:83], v19 offset:6144
ds_read_b64_tr_b16 v[84:85], v20 offset:4096
v_mfma_f32_16x16x32_bf16 v[140:143], v[116:119], v[100:103], v[140:143]
ds_read_b64_tr_b16 v[86:87], v20 offset:6144
ds_read_b128 v[68:71], v9 offset:9216
v_mfma_f32_16x16x32_bf16 v[136:139], v[112:115], v[100:103], v[136:139]
ds_read_b128 v[72:75], v9 offset:10240
ds_read_b128 v[76:79], v9 offset:11264
v_mfma_f32_16x16x32_bf16 v[144:147], v[112:115], v[104:107], v[144:147]
v_mfma_f32_16x16x32_bf16 v[148:151], v[116:119], v[104:107], v[148:151]
v_mfma_f32_16x16x32_bf16 v[176:179], v[120:123], v[104:107], v[176:179]
v_mfma_f32_16x16x32_bf16 v[180:183], v[124:127], v[104:107], v[180:183]
v_mfma_f32_16x16x32_bf16 v[188:191], v[124:127], v[108:111], v[188:191]
v_mfma_f32_16x16x32_bf16 v[184:187], v[120:123], v[108:111], v[184:187]
v_mfma_f32_16x16x32_bf16 v[156:159], v[116:119], v[108:111], v[156:159]
v_mfma_f32_16x16x32_bf16 v[152:155], v[112:115], v[108:111], v[152:155]
v_mfma_f32_16x16x32_bf16 v[128:131], v[208:211], v[192:195], v[128:131]
v_mfma_f32_16x16x32_bf16 v[132:135], v[212:215], v[192:195], v[132:135]
v_mfma_f32_16x16x32_bf16 v[160:163], v[216:219], v[192:195], v[160:163]
v_mfma_f32_16x16x32_bf16 v[164:167], v[220:223], v[192:195], v[164:167]
v_mfma_f32_16x16x32_bf16 v[172:175], v[220:223], v[196:199], v[172:175]
v_mfma_f32_16x16x32_bf16 v[168:171], v[216:219], v[196:199], v[168:171]
v_mfma_f32_16x16x32_bf16 v[140:143], v[212:215], v[196:199], v[140:143]
v_mfma_f32_16x16x32_bf16 v[136:139], v[208:211], v[196:199], v[136:139]
v_mfma_f32_16x16x32_bf16 v[144:147], v[208:211], v[200:203], v[144:147]
v_mfma_f32_16x16x32_bf16 v[148:151], v[212:215], v[200:203], v[148:151]
v_mfma_f32_16x16x32_bf16 v[176:179], v[216:219], v[200:203], v[176:179]
v_mfma_f32_16x16x32_bf16 v[180:183], v[220:223], v[200:203], v[180:183]
v_mfma_f32_16x16x32_bf16 v[188:191], v[220:223], v[204:207], v[188:191]
v_mfma_f32_16x16x32_bf16 v[184:187], v[216:219], v[204:207], v[184:187]
v_mfma_f32_16x16x32_bf16 v[156:159], v[212:215], v[204:207], v[156:159]
v_mfma_f32_16x16x32_bf16 v[152:155], v[208:211], v[204:207], v[152:155]
s_waitcnt lgkmcnt(0)
s_barrier
v_mfma_f32_16x16x32_bf16 v[128:131], v[48:51], v[32:35], v[128:131]
ds_read_b128 v[96:99], v9 offset:32768
ds_read_b64_tr_b16 v[112:113], v19 offset:32768
v_mfma_f32_16x16x32_bf16 v[132:135], v[52:55], v[32:35], v[132:135]
ds_read_b64_tr_b16 v[114:115], v19 offset:34816
ds_read_b64_tr_b16 v[116:117], v20 offset:32768
v_mfma_f32_16x16x32_bf16 v[140:143], v[52:55], v[36:39], v[140:143]
ds_read_b64_tr_b16 v[118:119], v20 offset:34816
ds_read_b128 v[100:103], v9 offset:33792
v_mfma_f32_16x16x32_bf16 v[136:139], v[48:51], v[36:39], v[136:139]
ds_read_b128 v[104:107], v9 offset:34816
ds_read_b128 v[108:111], v9 offset:35840
v_mfma_f32_16x16x32_bf16 v[144:147], v[48:51], v[40:43], v[144:147]
ds_read_b128 v[192:195], v9 offset:40960
ds_read_b64_tr_b16 v[208:209], v19 offset:36864
v_mfma_f32_16x16x32_bf16 v[148:151], v[52:55], v[40:43], v[148:151]
ds_read_b64_tr_b16 v[210:211], v19 offset:38912
ds_read_b64_tr_b16 v[212:213], v20 offset:36864
v_mfma_f32_16x16x32_bf16 v[156:159], v[52:55], v[44:47], v[156:159]
ds_read_b64_tr_b16 v[214:215], v20 offset:38912
ds_read_b128 v[196:199], v9 offset:41984
v_mfma_f32_16x16x32_bf16 v[152:155], v[48:51], v[44:47], v[152:155]
ds_read_b128 v[200:203], v9 offset:43008
ds_read_b128 v[204:207], v9 offset:44032
v_mfma_f32_16x16x32_bf16 v[128:131], v[80:83], v[64:67], v[128:131]
buffer_store_dwordx4 v[160:163], v31, s[84:87], s44 offen offset:0 sc1
v_mfma_f32_16x16x32_bf16 v[132:135], v[84:87], v[64:67], v[132:135]
buffer_store_dwordx4 v[164:167], v31, s[84:87], s44 offen offset:1024 sc1
v_mfma_f32_16x16x32_bf16 v[140:143], v[84:87], v[68:71], v[140:143]
buffer_store_dwordx4 v[168:171], v31, s[84:87], s44 offen offset:2048 sc1
v_mfma_f32_16x16x32_bf16 v[136:139], v[80:83], v[68:71], v[136:139]
buffer_store_dwordx4 v[172:175], v31, s[84:87], s44 offen offset:3072 sc1
v_mfma_f32_16x16x32_bf16 v[144:147], v[80:83], v[72:75], v[144:147]
buffer_store_dwordx4 v[176:179], v31, s[84:87], s45 offen offset:0 sc1
v_mfma_f32_16x16x32_bf16 v[148:151], v[84:87], v[72:75], v[148:151]
buffer_store_dwordx4 v[180:183], v31, s[84:87], s45 offen offset:1024 sc1
v_mfma_f32_16x16x32_bf16 v[156:159], v[84:87], v[76:79], v[156:159]
buffer_store_dwordx4 v[184:187], v31, s[84:87], s45 offen offset:2048 sc1
v_mfma_f32_16x16x32_bf16 v[152:155], v[80:83], v[76:79], v[152:155]
buffer_store_dwordx4 v[188:191], v31, s[84:87], s45 offen offset:3072 sc1
s_waitcnt lgkmcnt(0)
s_barrier
v_mfma_f32_16x16x32_bf16 v[128:131], v[112:115], v[96:99], v[128:131]
ds_read_b128 v[32:35], v244 offset:0
ds_read_b64_tr_b16 v[48:49], v21 offset:0
v_mfma_f32_16x16x32_bf16 v[132:135], v[116:119], v[96:99], v[132:135]
ds_read_b64_tr_b16 v[50:51], v21 offset:2048
ds_read_b64_tr_b16 v[52:53], v22 offset:0
v_mfma_f32_16x16x32_bf16 v[140:143], v[116:119], v[100:103], v[140:143]
ds_read_b64_tr_b16 v[54:55], v22 offset:2048
ds_read_b128 v[36:39], v244 offset:1024
v_mfma_f32_16x16x32_bf16 v[136:139], v[112:115], v[100:103], v[136:139]
ds_read_b128 v[40:43], v244 offset:2048
ds_read_b128 v[44:47], v244 offset:3072
v_mfma_f32_16x16x32_bf16 v[144:147], v[112:115], v[104:107], v[144:147]
ds_read_b128 v[64:67], v244 offset:8192
ds_read_b64_tr_b16 v[80:81], v21 offset:4096
v_mfma_f32_16x16x32_bf16 v[148:151], v[116:119], v[104:107], v[148:151]
ds_read_b64_tr_b16 v[82:83], v21 offset:6144
ds_read_b64_tr_b16 v[84:85], v22 offset:4096
v_mfma_f32_16x16x32_bf16 v[156:159], v[116:119], v[108:111], v[156:159]
ds_read_b64_tr_b16 v[86:87], v22 offset:6144
ds_read_b128 v[68:71], v244 offset:9216
v_mfma_f32_16x16x32_bf16 v[152:155], v[112:115], v[108:111], v[152:155]
ds_read_b128 v[72:75], v244 offset:10240
ds_read_b128 v[76:79], v244 offset:11264
v_mfma_f32_16x16x32_bf16 v[128:131], v[208:211], v[192:195], v[128:131]
v_mfma_f32_16x16x32_bf16 v[132:135], v[212:215], v[192:195], v[132:135]
v_mfma_f32_16x16x32_bf16 v[140:143], v[212:215], v[196:199], v[140:143]
v_mfma_f32_16x16x32_bf16 v[136:139], v[208:211], v[196:199], v[136:139]
v_mfma_f32_16x16x32_bf16 v[144:147], v[208:211], v[200:203], v[144:147]
v_mfma_f32_16x16x32_bf16 v[148:151], v[212:215], v[200:203], v[148:151]
v_mfma_f32_16x16x32_bf16 v[156:159], v[212:215], v[204:207], v[156:159]
v_mfma_f32_16x16x32_bf16 v[152:155], v[208:211], v[204:207], v[152:155]
s_waitcnt lgkmcnt(0)
s_barrier
v_mfma_f32_16x16x32_bf16 v[128:131], v[48:51], v[32:35], v[128:131]
ds_read_b128 v[96:99], v244 offset:32768
ds_read_b64_tr_b16 v[112:113], v21 offset:32768
v_mfma_f32_16x16x32_bf16 v[132:135], v[52:55], v[32:35], v[132:135]
ds_read_b64_tr_b16 v[114:115], v21 offset:34816
ds_read_b64_tr_b16 v[116:117], v22 offset:32768
v_mfma_f32_16x16x32_bf16 v[140:143], v[52:55], v[36:39], v[140:143]
ds_read_b64_tr_b16 v[118:119], v22 offset:34816
ds_read_b128 v[100:103], v244 offset:33792
v_mfma_f32_16x16x32_bf16 v[136:139], v[48:51], v[36:39], v[136:139]
ds_read_b128 v[104:107], v244 offset:34816
ds_read_b128 v[108:111], v244 offset:35840
v_mfma_f32_16x16x32_bf16 v[144:147], v[48:51], v[40:43], v[144:147]
ds_read_b128 v[192:195], v244 offset:40960
ds_read_b64_tr_b16 v[208:209], v21 offset:36864
v_mfma_f32_16x16x32_bf16 v[148:151], v[52:55], v[40:43], v[148:151]
ds_read_b64_tr_b16 v[210:211], v21 offset:38912
ds_read_b64_tr_b16 v[212:213], v22 offset:36864
v_mfma_f32_16x16x32_bf16 v[156:159], v[52:55], v[44:47], v[156:159]
ds_read_b64_tr_b16 v[214:215], v22 offset:38912
ds_read_b128 v[196:199], v244 offset:41984
v_mfma_f32_16x16x32_bf16 v[152:155], v[48:51], v[44:47], v[152:155]
ds_read_b128 v[200:203], v244 offset:43008
ds_read_b128 v[204:207], v244 offset:44032
v_mfma_f32_16x16x32_bf16 v[128:131], v[80:83], v[64:67], v[128:131]
v_mfma_f32_16x16x32_bf16 v[132:135], v[84:87], v[64:67], v[132:135]
v_mfma_f32_16x16x32_bf16 v[140:143], v[84:87], v[68:71], v[140:143]
v_mfma_f32_16x16x32_bf16 v[136:139], v[80:83], v[68:71], v[136:139]
v_mfma_f32_16x16x32_bf16 v[144:147], v[80:83], v[72:75], v[144:147]
v_mfma_f32_16x16x32_bf16 v[148:151], v[84:87], v[72:75], v[148:151]
v_mfma_f32_16x16x32_bf16 v[156:159], v[84:87], v[76:79], v[156:159]
v_mfma_f32_16x16x32_bf16 v[152:155], v[80:83], v[76:79], v[152:155]
s_waitcnt lgkmcnt(0)
s_barrier
s_waitcnt vmcnt(0)
s_mov_b64 exec, 1
buffer_store_dword v3, v4, s[56:59], 0 offen sc1
s_mov_b64 exec, -1
v_mfma_f32_16x16x32_bf16 v[128:131], v[112:115], v[96:99], v[128:131]
ds_read_b128 v[32:35], v10 offset:0
ds_read_b64_tr_b16 v[48:49], v23 offset:0
v_mfma_f32_16x16x32_bf16 v[132:135], v[116:119], v[96:99], v[132:135]
ds_read_b64_tr_b16 v[50:51], v23 offset:2048
ds_read_b64_tr_b16 v[52:53], v24 offset:0
v_mfma_f32_16x16x32_bf16 v[140:143], v[116:119], v[100:103], v[140:143]
ds_read_b64_tr_b16 v[54:55], v24 offset:2048
ds_read_b128 v[36:39], v10 offset:1024
v_mfma_f32_16x16x32_bf16 v[136:139], v[112:115], v[100:103], v[136:139]
ds_read_b128 v[40:43], v10 offset:2048
ds_read_b128 v[44:47], v10 offset:3072
v_mfma_f32_16x16x32_bf16 v[144:147], v[112:115], v[104:107], v[144:147]
ds_read_b128 v[64:67], v10 offset:8192
ds_read_b64_tr_b16 v[80:81], v23 offset:4096
v_mfma_f32_16x16x32_bf16 v[148:151], v[116:119], v[104:107], v[148:151]
ds_read_b64_tr_b16 v[82:83], v23 offset:6144
ds_read_b64_tr_b16 v[84:85], v24 offset:4096
v_mfma_f32_16x16x32_bf16 v[156:159], v[116:119], v[108:111], v[156:159]
ds_read_b64_tr_b16 v[86:87], v24 offset:6144
ds_read_b128 v[68:71], v10 offset:9216
v_mfma_f32_16x16x32_bf16 v[152:155], v[112:115], v[108:111], v[152:155]
ds_read_b128 v[72:75], v10 offset:10240
ds_read_b128 v[76:79], v10 offset:11264
v_mfma_f32_16x16x32_bf16 v[128:131], v[208:211], v[192:195], v[128:131]
v_mfma_f32_16x16x32_bf16 v[132:135], v[212:215], v[192:195], v[132:135]
v_mfma_f32_16x16x32_bf16 v[140:143], v[212:215], v[196:199], v[140:143]
v_mfma_f32_16x16x32_bf16 v[136:139], v[208:211], v[196:199], v[136:139]
v_mfma_f32_16x16x32_bf16 v[144:147], v[208:211], v[200:203], v[144:147]
v_mfma_f32_16x16x32_bf16 v[148:151], v[212:215], v[200:203], v[148:151]
v_mfma_f32_16x16x32_bf16 v[156:159], v[212:215], v[204:207], v[156:159]
v_mfma_f32_16x16x32_bf16 v[152:155], v[208:211], v[204:207], v[152:155]
s_waitcnt lgkmcnt(0)
s_barrier
v_mfma_f32_16x16x32_bf16 v[128:131], v[48:51], v[32:35], v[128:131]
ds_read_b128 v[96:99], v9 offset:0
ds_read_b64_tr_b16 v[112:113], v19 offset:0
v_mfma_f32_16x16x32_bf16 v[132:135], v[52:55], v[32:35], v[132:135]
ds_read_b64_tr_b16 v[114:115], v19 offset:2048
ds_read_b64_tr_b16 v[116:117], v20 offset:0
v_mfma_f32_16x16x32_bf16 v[140:143], v[52:55], v[36:39], v[140:143]
ds_read_b64_tr_b16 v[118:119], v20 offset:2048
ds_read_b128 v[100:103], v9 offset:1024
v_mfma_f32_16x16x32_bf16 v[136:139], v[48:51], v[36:39], v[136:139]
ds_read_b128 v[104:107], v9 offset:2048
ds_read_b128 v[108:111], v9 offset:3072
v_mfma_f32_16x16x32_bf16 v[144:147], v[48:51], v[40:43], v[144:147]
ds_read_b128 v[192:195], v9 offset:8192
ds_read_b64_tr_b16 v[208:209], v19 offset:4096
v_mfma_f32_16x16x32_bf16 v[148:151], v[52:55], v[40:43], v[148:151]
ds_read_b64_tr_b16 v[210:211], v19 offset:6144
ds_read_b64_tr_b16 v[212:213], v20 offset:4096
v_mfma_f32_16x16x32_bf16 v[156:159], v[52:55], v[44:47], v[156:159]
ds_read_b64_tr_b16 v[214:215], v20 offset:6144
ds_read_b128 v[196:199], v9 offset:9216
v_mfma_f32_16x16x32_bf16 v[152:155], v[48:51], v[44:47], v[152:155]
ds_read_b128 v[200:203], v9 offset:10240
ds_read_b128 v[204:207], v9 offset:11264
v_mfma_f32_16x16x32_bf16 v[128:131], v[80:83], v[64:67], v[128:131]
v_mfma_f32_16x16x32_bf16 v[132:135], v[84:87], v[64:67], v[132:135]
v_mfma_f32_16x16x32_bf16 v[140:143], v[84:87], v[68:71], v[140:143]
v_mfma_f32_16x16x32_bf16 v[136:139], v[80:83], v[68:71], v[136:139]
v_mfma_f32_16x16x32_bf16 v[144:147], v[80:83], v[72:75], v[144:147]
v_mfma_f32_16x16x32_bf16 v[148:151], v[84:87], v[72:75], v[148:151]
v_mfma_f32_16x16x32_bf16 v[156:159], v[84:87], v[76:79], v[156:159]
v_mfma_f32_16x16x32_bf16 v[152:155], v[80:83], v[76:79], v[152:155]
s_waitcnt lgkmcnt(0)
s_barrier
v_mfma_f32_16x16x32_bf16 v[128:131], v[112:115], v[96:99], v[128:131]
ds_read_b128 v[32:35], v9 offset:32768
ds_read_b64_tr_b16 v[48:49], v19 offset:32768
v_mfma_f32_16x16x32_bf16 v[132:135], v[116:119], v[96:99], v[132:135]
ds_read_b64_tr_b16 v[50:51], v19 offset:34816
ds_read_b64_tr_b16 v[52:53], v20 offset:32768
v_mfma_f32_16x16x32_bf16 v[140:143], v[116:119], v[100:103], v[140:143]
ds_read_b64_tr_b16 v[54:55], v20 offset:34816
ds_read_b128 v[36:39], v9 offset:33792
v_mfma_f32_16x16x32_bf16 v[136:139], v[112:115], v[100:103], v[136:139]
ds_read_b128 v[40:43], v9 offset:34816
ds_read_b128 v[44:47], v9 offset:35840
v_mfma_f32_16x16x32_bf16 v[144:147], v[112:115], v[104:107], v[144:147]
ds_read_b128 v[64:67], v9 offset:40960
ds_read_b64_tr_b16 v[80:81], v19 offset:36864
v_mfma_f32_16x16x32_bf16 v[148:151], v[116:119], v[104:107], v[148:151]
ds_read_b64_tr_b16 v[82:83], v19 offset:38912
ds_read_b64_tr_b16 v[84:85], v20 offset:36864
v_mfma_f32_16x16x32_bf16 v[156:159], v[116:119], v[108:111], v[156:159]
ds_read_b64_tr_b16 v[86:87], v20 offset:38912
ds_read_b128 v[68:71], v9 offset:41984
v_mfma_f32_16x16x32_bf16 v[152:155], v[112:115], v[108:111], v[152:155]
ds_read_b128 v[72:75], v9 offset:43008
ds_read_b128 v[76:79], v9 offset:44032
v_mfma_f32_16x16x32_bf16 v[128:131], v[208:211], v[192:195], v[128:131]
v_mfma_f32_16x16x32_bf16 v[132:135], v[212:215], v[192:195], v[132:135]
v_mfma_f32_16x16x32_bf16 v[140:143], v[212:215], v[196:199], v[140:143]
v_mfma_f32_16x16x32_bf16 v[136:139], v[208:211], v[196:199], v[136:139]
v_mfma_f32_16x16x32_bf16 v[144:147], v[208:211], v[200:203], v[144:147]
v_mfma_f32_16x16x32_bf16 v[148:151], v[212:215], v[200:203], v[148:151]
v_mfma_f32_16x16x32_bf16 v[156:159], v[212:215], v[204:207], v[156:159]
v_mfma_f32_16x16x32_bf16 v[152:155], v[208:211], v[204:207], v[152:155]
s_waitcnt lgkmcnt(0)
s_barrier
v_mfma_f32_16x16x32_bf16 v[128:131], v[48:51], v[32:35], v[128:131]
ds_read_b128 v[96:99], v244 offset:0
ds_read_b64_tr_b16 v[112:113], v21 offset:0
v_mfma_f32_16x16x32_bf16 v[132:135], v[52:55], v[32:35], v[132:135]
ds_read_b64_tr_b16 v[114:115], v21 offset:2048
ds_read_b64_tr_b16 v[116:117], v22 offset:0
v_mfma_f32_16x16x32_bf16 v[140:143], v[52:55], v[36:39], v[140:143]
ds_read_b64_tr_b16 v[118:119], v22 offset:2048
ds_read_b128 v[100:103], v244 offset:1024
v_mfma_f32_16x16x32_bf16 v[136:139], v[48:51], v[36:39], v[136:139]
ds_read_b128 v[104:107], v244 offset:2048
ds_read_b128 v[108:111], v244 offset:3072
v_mfma_f32_16x16x32_bf16 v[144:147], v[48:51], v[40:43], v[144:147]
ds_read_b128 v[192:195], v244 offset:8192
ds_read_b64_tr_b16 v[208:209], v21 offset:4096
v_mfma_f32_16x16x32_bf16 v[148:151], v[52:55], v[40:43], v[148:151]
ds_read_b64_tr_b16 v[210:211], v21 offset:6144
ds_read_b64_tr_b16 v[212:213], v22 offset:4096
v_mfma_f32_16x16x32_bf16 v[156:159], v[52:55], v[44:47], v[156:159]
ds_read_b64_tr_b16 v[214:215], v22 offset:6144
ds_read_b128 v[196:199], v244 offset:9216
v_mfma_f32_16x16x32_bf16 v[152:155], v[48:51], v[44:47], v[152:155]
ds_read_b128 v[200:203], v244 offset:10240
ds_read_b128 v[204:207], v244 offset:11264
v_mfma_f32_16x16x32_bf16 v[128:131], v[80:83], v[64:67], v[128:131]
v_mfma_f32_16x16x32_bf16 v[132:135], v[84:87], v[64:67], v[132:135]
v_mfma_f32_16x16x32_bf16 v[140:143], v[84:87], v[68:71], v[140:143]
v_mfma_f32_16x16x32_bf16 v[136:139], v[80:83], v[68:71], v[136:139]
v_mfma_f32_16x16x32_bf16 v[144:147], v[80:83], v[72:75], v[144:147]
v_mfma_f32_16x16x32_bf16 v[148:151], v[84:87], v[72:75], v[148:151]
v_mfma_f32_16x16x32_bf16 v[156:159], v[84:87], v[76:79], v[156:159]
v_mfma_f32_16x16x32_bf16 v[152:155], v[80:83], v[76:79], v[152:155]
s_waitcnt lgkmcnt(0)
s_barrier
v_mfma_f32_16x16x32_bf16 v[128:131], v[112:115], v[96:99], v[128:131]
ds_read_b128 v[32:35], v244 offset:32768
ds_read_b64_tr_b16 v[48:49], v21 offset:32768
v_mfma_f32_16x16x32_bf16 v[132:135], v[116:119], v[96:99], v[132:135]
ds_read_b64_tr_b16 v[50:51], v21 offset:34816
ds_read_b64_tr_b16 v[52:53], v22 offset:32768
v_mfma_f32_16x16x32_bf16 v[140:143], v[116:119], v[100:103], v[140:143]
ds_read_b64_tr_b16 v[54:55], v22 offset:34816
ds_read_b128 v[36:39], v244 offset:33792
v_mfma_f32_16x16x32_bf16 v[136:139], v[112:115], v[100:103], v[136:139]
ds_read_b128 v[40:43], v244 offset:34816
ds_read_b128 v[44:47], v244 offset:35840
v_mfma_f32_16x16x32_bf16 v[144:147], v[112:115], v[104:107], v[144:147]
ds_read_b128 v[64:67], v244 offset:40960
ds_read_b64_tr_b16 v[80:81], v21 offset:36864
v_mfma_f32_16x16x32_bf16 v[148:151], v[116:119], v[104:107], v[148:151]
ds_read_b64_tr_b16 v[82:83], v21 offset:38912
ds_read_b64_tr_b16 v[84:85], v22 offset:36864
v_mfma_f32_16x16x32_bf16 v[156:159], v[116:119], v[108:111], v[156:159]
ds_read_b64_tr_b16 v[86:87], v22 offset:38912
ds_read_b128 v[68:71], v244 offset:41984
v_mfma_f32_16x16x32_bf16 v[152:155], v[112:115], v[108:111], v[152:155]
ds_read_b128 v[72:75], v244 offset:43008
ds_read_b128 v[76:79], v244 offset:44032
v_mfma_f32_16x16x32_bf16 v[128:131], v[208:211], v[192:195], v[128:131]
v_mfma_f32_16x16x32_bf16 v[132:135], v[212:215], v[192:195], v[132:135]
v_mfma_f32_16x16x32_bf16 v[140:143], v[212:215], v[196:199], v[140:143]
v_mfma_f32_16x16x32_bf16 v[136:139], v[208:211], v[196:199], v[136:139]
v_mfma_f32_16x16x32_bf16 v[144:147], v[208:211], v[200:203], v[144:147]
v_mfma_f32_16x16x32_bf16 v[148:151], v[212:215], v[200:203], v[148:151]
v_mfma_f32_16x16x32_bf16 v[156:159], v[212:215], v[204:207], v[156:159]
v_mfma_f32_16x16x32_bf16 v[152:155], v[208:211], v[204:207], v[152:155]
s_waitcnt lgkmcnt(0)
s_barrier
buffer_load_dword v6, v5, s[56:59], 0 offen sc1
v_mfma_f32_16x16x32_bf16 v[128:131], v[48:51], v[32:35], v[128:131]
ds_read_b128 v[96:99], v10 offset:0
ds_read_b64_tr_b16 v[112:113], v23 offset:0
v_mfma_f32_16x16x32_bf16 v[132:135], v[52:55], v[32:35], v[132:135]
ds_read_b64_tr_b16 v[114:115], v23 offset:2048
ds_read_b64_tr_b16 v[116:117], v24 offset:0
v_mfma_f32_16x16x32_bf16 v[140:143], v[52:55], v[36:39], v[140:143]
ds_read_b64_tr_b16 v[118:119], v24 offset:2048
ds_read_b128 v[100:103], v10 offset:1024
v_mfma_f32_16x16x32_bf16 v[136:139], v[48:51], v[36:39], v[136:139]
ds_read_b128 v[104:107], v10 offset:2048
ds_read_b128 v[108:111], v10 offset:3072
v_mfma_f32_16x16x32_bf16 v[144:147], v[48:51], v[40:43], v[144:147]
ds_read_b128 v[192:195], v10 offset:8192
ds_read_b64_tr_b16 v[208:209], v23 offset:4096
v_mfma_f32_16x16x32_bf16 v[148:151], v[52:55], v[40:43], v[148:151]
ds_read_b64_tr_b16 v[210:211], v23 offset:6144
ds_read_b64_tr_b16 v[212:213], v24 offset:4096
v_mfma_f32_16x16x32_bf16 v[156:159], v[52:55], v[44:47], v[156:159]
ds_read_b64_tr_b16 v[214:215], v24 offset:6144
ds_read_b128 v[196:199], v10 offset:9216
v_mfma_f32_16x16x32_bf16 v[152:155], v[48:51], v[44:47], v[152:155]
ds_read_b128 v[200:203], v10 offset:10240
ds_read_b128 v[204:207], v10 offset:11264
v_mfma_f32_16x16x32_bf16 v[128:131], v[80:83], v[64:67], v[128:131]
v_mfma_f32_16x16x32_bf16 v[132:135], v[84:87], v[64:67], v[132:135]
v_mfma_f32_16x16x32_bf16 v[140:143], v[84:87], v[68:71], v[140:143]
v_mfma_f32_16x16x32_bf16 v[136:139], v[80:83], v[68:71], v[136:139]
v_mfma_f32_16x16x32_bf16 v[144:147], v[80:83], v[72:75], v[144:147]
v_mfma_f32_16x16x32_bf16 v[148:151], v[84:87], v[72:75], v[148:151]
v_mfma_f32_16x16x32_bf16 v[156:159], v[84:87], v[76:79], v[156:159]
v_mfma_f32_16x16x32_bf16 v[152:155], v[80:83], v[76:79], v[152:155]
s_waitcnt lgkmcnt(0)
s_barrier
s_waitcnt vmcnt(0)
s_mov_b32 s40, 0x40000
s_branch Lpchk_88
Lpoll_86:
buffer_load_dword v6, v5, s[56:59], 0 offen sc1
s_waitcnt vmcnt(0)
Lpchk_88:
v_readfirstlane_b32 s42, v6
s_cmp_eq_u32 s42, 1
s_cbranch_scc1 Lpok_87
s_sub_u32 s40, s40, 1
s_cmp_lg_u32 s40, 0
s_cbranch_scc1 Lpoll_86
Lpok_87:
buffer_load_dwordx4 v[160:163], v31, s[84:87], s46 offen offset:0 sc1
buffer_load_dwordx4 v[164:167], v31, s[84:87], s46 offen offset:1024 sc1
buffer_load_dwordx4 v[168:171], v31, s[84:87], s46 offen offset:2048 sc1
buffer_load_dwordx4 v[172:175], v31, s[84:87], s46 offen offset:3072 sc1
buffer_load_dwordx4 v[176:179], v31, s[84:87], s47 offen offset:0 sc1
buffer_load_dwordx4 v[180:183], v31, s[84:87], s47 offen offset:1024 sc1
buffer_load_dwordx4 v[184:187], v31, s[84:87], s47 offen offset:2048 sc1
buffer_load_dwordx4 v[188:191], v31, s[84:87], s47 offen offset:3072 sc1
v_mfma_f32_16x16x32_bf16 v[128:131], v[112:115], v[96:99], v[128:131]
ds_read_b128 v[32:35], v9 offset:0
ds_read_b64_tr_b16 v[48:49], v19 offset:0
v_mfma_f32_16x16x32_bf16 v[132:135], v[116:119], v[96:99], v[132:135]
ds_read_b64_tr_b16 v[50:51], v19 offset:2048
ds_read_b64_tr_b16 v[52:53], v20 offset:0
v_mfma_f32_16x16x32_bf16 v[140:143], v[116:119], v[100:103], v[140:143]
ds_read_b64_tr_b16 v[54:55], v20 offset:2048
ds_read_b128 v[36:39], v9 offset:1024
v_mfma_f32_16x16x32_bf16 v[136:139], v[112:115], v[100:103], v[136:139]
ds_read_b128 v[40:43], v9 offset:2048
ds_read_b128 v[44:47], v9 offset:3072
v_mfma_f32_16x16x32_bf16 v[144:147], v[112:115], v[104:107], v[144:147]
ds_read_b128 v[64:67], v9 offset:8192
ds_read_b64_tr_b16 v[80:81], v19 offset:4096
v_mfma_f32_16x16x32_bf16 v[148:151], v[116:119], v[104:107], v[148:151]
ds_read_b64_tr_b16 v[82:83], v19 offset:6144
ds_read_b64_tr_b16 v[84:85], v20 offset:4096
v_mfma_f32_16x16x32_bf16 v[156:159], v[116:119], v[108:111], v[156:159]
ds_read_b64_tr_b16 v[86:87], v20 offset:6144
ds_read_b128 v[68:71], v9 offset:9216
v_mfma_f32_16x16x32_bf16 v[152:155], v[112:115], v[108:111], v[152:155]
ds_read_b128 v[72:75], v9 offset:10240
ds_read_b128 v[76:79], v9 offset:11264
v_mfma_f32_16x16x32_bf16 v[128:131], v[208:211], v[192:195], v[128:131]
v_mfma_f32_16x16x32_bf16 v[132:135], v[212:215], v[192:195], v[132:135]
v_mfma_f32_16x16x32_bf16 v[140:143], v[212:215], v[196:199], v[140:143]
v_mfma_f32_16x16x32_bf16 v[136:139], v[208:211], v[196:199], v[136:139]
v_mfma_f32_16x16x32_bf16 v[144:147], v[208:211], v[200:203], v[144:147]
v_mfma_f32_16x16x32_bf16 v[148:151], v[212:215], v[200:203], v[148:151]
v_mfma_f32_16x16x32_bf16 v[156:159], v[212:215], v[204:207], v[156:159]
v_mfma_f32_16x16x32_bf16 v[152:155], v[208:211], v[204:207], v[152:155]
s_waitcnt lgkmcnt(0)
s_barrier
v_mfma_f32_16x16x32_bf16 v[128:131], v[48:51], v[32:35], v[128:131]
ds_read_b128 v[96:99], v9 offset:32768
ds_read_b64_tr_b16 v[112:113], v19 offset:32768
v_mfma_f32_16x16x32_bf16 v[132:135], v[52:55], v[32:35], v[132:135]
ds_read_b64_tr_b16 v[114:115], v19 offset:34816
ds_read_b64_tr_b16 v[116:117], v20 offset:32768
v_mfma_f32_16x16x32_bf16 v[140:143], v[52:55], v[36:39], v[140:143]
ds_read_b64_tr_b16 v[118:119], v20 offset:34816
ds_read_b128 v[100:103], v9 offset:33792
v_mfma_f32_16x16x32_bf16 v[136:139], v[48:51], v[36:39], v[136:139]
ds_read_b128 v[104:107], v9 offset:34816
ds_read_b128 v[108:111], v9 offset:35840
v_mfma_f32_16x16x32_bf16 v[144:147], v[48:51], v[40:43], v[144:147]
ds_read_b128 v[192:195], v9 offset:40960
ds_read_b64_tr_b16 v[208:209], v19 offset:36864
v_mfma_f32_16x16x32_bf16 v[148:151], v[52:55], v[40:43], v[148:151]
ds_read_b64_tr_b16 v[210:211], v19 offset:38912
ds_read_b64_tr_b16 v[212:213], v20 offset:36864
v_mfma_f32_16x16x32_bf16 v[156:159], v[52:55], v[44:47], v[156:159]
ds_read_b64_tr_b16 v[214:215], v20 offset:38912
ds_read_b128 v[196:199], v9 offset:41984
v_mfma_f32_16x16x32_bf16 v[152:155], v[48:51], v[44:47], v[152:155]
ds_read_b128 v[200:203], v9 offset:43008
ds_read_b128 v[204:207], v9 offset:44032
v_mfma_f32_16x16x32_bf16 v[128:131], v[80:83], v[64:67], v[128:131]
v_mfma_f32_16x16x32_bf16 v[132:135], v[84:87], v[64:67], v[132:135]
v_mfma_f32_16x16x32_bf16 v[140:143], v[84:87], v[68:71], v[140:143]
v_mfma_f32_16x16x32_bf16 v[136:139], v[80:83], v[68:71], v[136:139]
v_mfma_f32_16x16x32_bf16 v[144:147], v[80:83], v[72:75], v[144:147]
v_mfma_f32_16x16x32_bf16 v[148:151], v[84:87], v[72:75], v[148:151]
v_mfma_f32_16x16x32_bf16 v[156:159], v[84:87], v[76:79], v[156:159]
v_mfma_f32_16x16x32_bf16 v[152:155], v[80:83], v[76:79], v[152:155]
s_waitcnt lgkmcnt(0)
s_barrier
v_mfma_f32_16x16x32_bf16 v[128:131], v[112:115], v[96:99], v[128:131]
v_mfma_f32_16x16x32_bf16 v[132:135], v[116:119], v[96:99], v[132:135]
v_mfma_f32_16x16x32_bf16 v[140:143], v[116:119], v[100:103], v[140:143]
v_mfma_f32_16x16x32_bf16 v[136:139], v[112:115], v[100:103], v[136:139]
v_mfma_f32_16x16x32_bf16 v[144:147], v[112:115], v[104:107], v[144:147]
v_mfma_f32_16x16x32_bf16 v[148:151], v[116:119], v[104:107], v[148:151]
v_mfma_f32_16x16x32_bf16 v[156:159], v[116:119], v[108:111], v[156:159]
v_mfma_f32_16x16x32_bf16 v[152:155], v[112:115], v[108:111], v[152:155]
v_mfma_f32_16x16x32_bf16 v[128:131], v[208:211], v[192:195], v[128:131]
v_mfma_f32_16x16x32_bf16 v[132:135], v[212:215], v[192:195], v[132:135]
v_mfma_f32_16x16x32_bf16 v[140:143], v[212:215], v[196:199], v[140:143]
v_mfma_f32_16x16x32_bf16 v[136:139], v[208:211], v[196:199], v[136:139]
v_mfma_f32_16x16x32_bf16 v[144:147], v[208:211], v[200:203], v[144:147]
v_mfma_f32_16x16x32_bf16 v[148:151], v[212:215], v[200:203], v[148:151]
v_mfma_f32_16x16x32_bf16 v[156:159], v[212:215], v[204:207], v[156:159]
v_mfma_f32_16x16x32_bf16 v[152:155], v[208:211], v[204:207], v[152:155]
s_waitcnt vmcnt(0)
v_pk_add_f32 v[128:129], v[128:129], v[160:161]
v_pk_add_f32 v[130:131], v[130:131], v[162:163]
v_pk_add_f32 v[132:133], v[132:133], v[164:165]
v_pk_add_f32 v[134:135], v[134:135], v[166:167]
v_cvt_pk_bf16_f32 v32, v128, v129
v_cvt_pk_bf16_f32 v33, v130, v131
v_cvt_pk_bf16_f32 v34, v132, v133
v_cvt_pk_bf16_f32 v35, v134, v135
v_pk_add_f32 v[136:137], v[136:137], v[168:169]
v_pk_add_f32 v[138:139], v[138:139], v[170:171]
v_pk_add_f32 v[140:141], v[140:141], v[172:173]
v_pk_add_f32 v[142:143], v[142:143], v[174:175]
v_cvt_pk_bf16_f32 v36, v136, v137
v_cvt_pk_bf16_f32 v37, v138, v139
v_cvt_pk_bf16_f32 v38, v140, v141
v_cvt_pk_bf16_f32 v39, v142, v143
v_permlane16_swap_b32 v32, v34
v_permlane16_swap_b32 v33, v35
buffer_store_dwordx4 v[32:35], v7, s[20:23], s50 offen offset:0
v_pk_add_f32 v[144:145], v[144:145], v[176:177]
v_pk_add_f32 v[146:147], v[146:147], v[178:179]
v_pk_add_f32 v[148:149], v[148:149], v[180:181]
v_pk_add_f32 v[150:151], v[150:151], v[182:183]
v_cvt_pk_bf16_f32 v40, v144, v145
v_cvt_pk_bf16_f32 v41, v146, v147
v_cvt_pk_bf16_f32 v42, v148, v149
v_cvt_pk_bf16_f32 v43, v150, v151
v_permlane16_swap_b32 v36, v38
v_permlane16_swap_b32 v37, v39
buffer_store_dwordx4 v[36:39], v7, s[20:23], s50 offen offset:2048
v_pk_add_f32 v[152:153], v[152:153], v[184:185]
v_pk_add_f32 v[154:155], v[154:155], v[186:187]
v_pk_add_f32 v[156:157], v[156:157], v[188:189]
v_pk_add_f32 v[158:159], v[158:159], v[190:191]
v_cvt_pk_bf16_f32 v44, v152, v153
v_cvt_pk_bf16_f32 v45, v154, v155
v_cvt_pk_bf16_f32 v46, v156, v157
v_cvt_pk_bf16_f32 v47, v158, v159
v_permlane16_swap_b32 v40, v42
v_permlane16_swap_b32 v41, v43
buffer_store_dwordx4 v[40:43], v7, s[20:23], s51 offen offset:0
s_nop 1
v_permlane16_swap_b32 v44, v46
v_permlane16_swap_b32 v45, v47
buffer_store_dwordx4 v[44:47], v7, s[20:23], s51 offen offset:2048
s_branch Ldone_1
Lprod_84:
s_cmp_eq_u32 s36, 7
s_cbranch_scc1 Lpf_85
s_cmp_eq_u32 s36, 5
s_cbranch_scc1 Lp_90
s_cmp_eq_u32 s36, 6
s_cbranch_scc1 Lp_91
Lp_89:
s_waitcnt vmcnt(36)
s_barrier
s_mov_b32 m0, 98304
s_nop 0
buffer_load_dwordx4 v128, s[24:27], s52 offen sc1 lds
s_mov_b32 m0, 101376
s_nop 0
buffer_load_dwordx4 v129, s[24:27], s52 offen sc1 lds
s_mov_b32 m0, 104448
s_nop 0
buffer_load_dwordx4 v130, s[24:27], s52 offen sc1 lds
s_mov_b32 m0, 107520
s_nop 0
buffer_load_dwordx4 v131, s[24:27], s52 offen sc1 lds
s_mov_b32 m0, 110592
s_nop 0
buffer_load_dwordx4 v132, s[24:27], s52 offen sc1 lds
s_mov_b32 m0, 113664
s_nop 0
buffer_load_dwordx4 v133, s[24:27], s52 offen sc1 lds
s_mov_b32 m0, 116736
s_nop 0
buffer_load_dwordx4 v134, s[28:31], s53 offen lds
s_mov_b32 m0, 119808
s_nop 0
buffer_load_dwordx4 v135, s[28:31], s53 offen lds
s_mov_b32 m0, 122880
s_nop 0
buffer_load_dwordx4 v136, s[28:31], s53 offen lds
s_mov_b32 m0, 125952
s_nop 0
buffer_load_dwordx4 v137, s[28:31], s53 offen lds
s_mov_b32 m0, 129024
s_nop 0
buffer_load_dwordx4 v138, s[28:31], s53 offen lds
s_add_u32 s52, s52, 16384
s_add_u32 s53, s53, 131072
s_waitcnt vmcnt(36)
s_barrier
s_mov_b32 m0, 131072
s_nop 0
buffer_load_dwordx4 v128, s[24:27], s52 offen sc1 lds
s_mov_b32 m0, 134144
s_nop 0
buffer_load_dwordx4 v129, s[24:27], s52 offen sc1 lds
s_mov_b32 m0, 137216
s_nop 0
buffer_load_dwordx4 v130, s[24:27], s52 offen sc1 lds
s_mov_b32 m0, 140288
s_nop 0
buffer_load_dwordx4 v131, s[24:27], s52 offen sc1 lds
s_mov_b32 m0, 143360
s_nop 0
buffer_load_dwordx4 v132, s[24:27], s52 offen sc1 lds
s_mov_b32 m0, 146432
s_nop 0
buffer_load_dwordx4 v133, s[24:27], s52 offen sc1 lds
s_mov_b32 m0, 149504
s_nop 0
buffer_load_dwordx4 v134, s[28:31], s53 offen lds
s_mov_b32 m0, 152576
s_nop 0
buffer_load_dwordx4 v135, s[28:31], s53 offen lds
s_mov_b32 m0, 155648
s_nop 0
buffer_load_dwordx4 v136, s[28:31], s53 offen lds
s_mov_b32 m0, 158720
s_nop 0
buffer_load_dwordx4 v137, s[28:31], s53 offen lds
s_mov_b32 m0, 161792
s_nop 0
buffer_load_dwordx4 v138, s[28:31], s53 offen lds
s_add_u32 s52, s52, 16384
s_add_u32 s53, s53, 131072
s_waitcnt vmcnt(22)
s_barrier
s_mov_b32 m0, 0
s_nop 0
buffer_load_dwordx4 v128, s[24:27], s52 offen sc1 lds
s_mov_b32 m0, 3072
s_nop 0
buffer_load_dwordx4 v129, s[24:27], s52 offen sc1 lds
s_mov_b32 m0, 6144
s_nop 0
buffer_load_dwordx4 v130, s[24:27], s52 offen sc1 lds
s_mov_b32 m0, 9216
s_nop 0
buffer_load_dwordx4 v131, s[24:27], s52 offen sc1 lds
s_mov_b32 m0, 12288
s_nop 0
buffer_load_dwordx4 v132, s[24:27], s52 offen sc1 lds
s_mov_b32 m0, 15360
s_nop 0
buffer_load_dwordx4 v133, s[24:27], s52 offen sc1 lds
s_mov_b32 m0, 18432
s_nop 0
buffer_load_dwordx4 v134, s[28:31], s53 offen lds
s_mov_b32 m0, 21504
s_nop 0
buffer_load_dwordx4 v135, s[28:31], s53 offen lds
s_mov_b32 m0, 24576
s_nop 0
buffer_load_dwordx4 v136, s[28:31], s53 offen lds
s_mov_b32 m0, 27648
s_nop 0
buffer_load_dwordx4 v137, s[28:31], s53 offen lds
s_mov_b32 m0, 30720
s_nop 0
buffer_load_dwordx4 v138, s[28:31], s53 offen lds
s_add_u32 s52, s52, 16384
s_add_u32 s53, s53, 131072
s_waitcnt vmcnt(36)
s_barrier
s_mov_b32 m0, 32768
s_nop 0
buffer_load_dwordx4 v128, s[24:27], s52 offen sc1 lds
s_mov_b32 m0, 35840
s_nop 0
buffer_load_dwordx4 v129, s[24:27], s52 offen sc1 lds
s_mov_b32 m0, 38912
s_nop 0
buffer_load_dwordx4 v130, s[24:27], s52 offen sc1 lds
s_mov_b32 m0, 41984
s_nop 0
buffer_load_dwordx4 v131, s[24:27], s52 offen sc1 lds
s_mov_b32 m0, 45056
s_nop 0
buffer_load_dwordx4 v132, s[24:27], s52 offen sc1 lds
s_mov_b32 m0, 48128
s_nop 0
buffer_load_dwordx4 v133, s[24:27], s52 offen sc1 lds
s_mov_b32 m0, 51200
s_nop 0
buffer_load_dwordx4 v134, s[28:31], s53 offen lds
s_mov_b32 m0, 54272
s_nop 0
buffer_load_dwordx4 v135, s[28:31], s53 offen lds
s_mov_b32 m0, 57344
s_nop 0
buffer_load_dwordx4 v136, s[28:31], s53 offen lds
s_mov_b32 m0, 60416
s_nop 0
buffer_load_dwordx4 v137, s[28:31], s53 offen lds
s_mov_b32 m0, 63488
s_nop 0
buffer_load_dwordx4 v138, s[28:31], s53 offen lds
s_add_u32 s52, s52, 16384
s_add_u32 s53, s53, 131072
s_waitcnt vmcnt(33)
s_barrier
s_mov_b32 m0, 65536
s_nop 0
buffer_load_dwordx4 v128, s[24:27], s52 offen sc1 lds
s_mov_b32 m0, 68608
s_nop 0
buffer_load_dwordx4 v129, s[24:27], s52 offen sc1 lds
s_mov_b32 m0, 71680
s_nop 0
buffer_load_dwordx4 v130, s[24:27], s52 offen sc1 lds
s_mov_b32 m0, 74752
s_nop 0
buffer_load_dwordx4 v131, s[24:27], s52 offen sc1 lds
s_mov_b32 m0, 77824
s_nop 0
buffer_load_dwordx4 v132, s[24:27], s52 offen sc1 lds
s_mov_b32 m0, 80896
s_nop 0
buffer_load_dwordx4 v133, s[24:27], s52 offen sc1 lds
s_mov_b32 m0, 83968
s_nop 0
buffer_load_dwordx4 v134, s[28:31], s53 offen lds
s_mov_b32 m0, 87040
s_nop 0
buffer_load_dwordx4 v135, s[28:31], s53 offen lds
s_mov_b32 m0, 90112
s_nop 0
buffer_load_dwordx4 v136, s[28:31], s53 offen lds
s_mov_b32 m0, 93184
s_nop 0
buffer_load_dwordx4 v137, s[28:31], s53 offen lds
s_mov_b32 m0, 96256
s_nop 0
buffer_load_dwordx4 v138, s[28:31], s53 offen lds
s_add_u32 s52, s52, 16384
s_add_u32 s53, s53, 131072
s_waitcnt vmcnt(33)
s_barrier
s_mov_b32 m0, 98304
s_nop 0
buffer_load_dwordx4 v128, s[24:27], s52 offen sc1 lds
s_mov_b32 m0, 101376
s_nop 0
buffer_load_dwordx4 v129, s[24:27], s52 offen sc1 lds
s_mov_b32 m0, 104448
s_nop 0
buffer_load_dwordx4 v130, s[24:27], s52 offen sc1 lds
s_mov_b32 m0, 107520
s_nop 0
buffer_load_dwordx4 v131, s[24:27], s52 offen sc1 lds
s_mov_b32 m0, 110592
s_nop 0
buffer_load_dwordx4 v132, s[24:27], s52 offen sc1 lds
s_mov_b32 m0, 113664
s_nop 0
buffer_load_dwordx4 v133, s[24:27], s52 offen sc1 lds
s_mov_b32 m0, 116736
s_nop 0
buffer_load_dwordx4 v134, s[28:31], s53 offen lds
s_mov_b32 m0, 119808
s_nop 0
buffer_load_dwordx4 v135, s[28:31], s53 offen lds
s_mov_b32 m0, 122880
s_nop 0
buffer_load_dwordx4 v136, s[28:31], s53 offen lds
s_mov_b32 m0, 125952
s_nop 0
buffer_load_dwordx4 v137, s[28:31], s53 offen lds
s_mov_b32 m0, 129024
s_nop 0
buffer_load_dwordx4 v138, s[28:31], s53 offen lds
s_add_u32 s52, s52, 16384
s_add_u32 s53, s53, 131072
s_waitcnt vmcnt(33)
s_barrier
s_mov_b32 m0, 131072
s_nop 0
buffer_load_dwordx4 v128, s[24:27], s52 offen sc1 lds
s_mov_b32 m0, 134144
s_nop 0
buffer_load_dwordx4 v129, s[24:27], s52 offen sc1 lds
s_mov_b32 m0, 137216
s_nop 0
buffer_load_dwordx4 v130, s[24:27], s52 offen sc1 lds
s_mov_b32 m0, 140288
s_nop 0
buffer_load_dwordx4 v131, s[24:27], s52 offen sc1 lds
s_mov_b32 m0, 143360
s_nop 0
buffer_load_dwordx4 v132, s[24:27], s52 offen sc1 lds
s_mov_b32 m0, 146432
s_nop 0
buffer_load_dwordx4 v133, s[24:27], s52 offen sc1 lds
s_mov_b32 m0, 149504
s_nop 0
buffer_load_dwordx4 v134, s[28:31], s53 offen lds
s_mov_b32 m0, 152576
s_nop 0
buffer_load_dwordx4 v135, s[28:31], s53 offen lds
s_mov_b32 m0, 155648
s_nop 0
buffer_load_dwordx4 v136, s[28:31], s53 offen lds
s_mov_b32 m0, 158720
s_nop 0
buffer_load_dwordx4 v137, s[28:31], s53 offen lds
s_mov_b32 m0, 161792
s_nop 0
buffer_load_dwordx4 v138, s[28:31], s53 offen lds
s_add_u32 s52, s52, 16384
s_add_u32 s53, s53, 131072
s_waitcnt vmcnt(33)
s_barrier
s_mov_b32 m0, 0
s_nop 0
buffer_load_dwordx4 v128, s[24:27], s52 offen sc1 lds
s_mov_b32 m0, 3072
s_nop 0
buffer_load_dwordx4 v129, s[24:27], s52 offen sc1 lds
s_mov_b32 m0, 6144
s_nop 0
buffer_load_dwordx4 v130, s[24:27], s52 offen sc1 lds
s_mov_b32 m0, 9216
s_nop 0
buffer_load_dwordx4 v131, s[24:27], s52 offen sc1 lds
s_mov_b32 m0, 12288
s_nop 0
buffer_load_dwordx4 v132, s[24:27], s52 offen sc1 lds
s_mov_b32 m0, 15360
s_nop 0
buffer_load_dwordx4 v133, s[24:27], s52 offen sc1 lds
s_mov_b32 m0, 18432
s_nop 0
buffer_load_dwordx4 v134, s[28:31], s53 offen lds
s_mov_b32 m0, 21504
s_nop 0
buffer_load_dwordx4 v135, s[28:31], s53 offen lds
s_mov_b32 m0, 24576
s_nop 0
buffer_load_dwordx4 v136, s[28:31], s53 offen lds
s_mov_b32 m0, 27648
s_nop 0
buffer_load_dwordx4 v137, s[28:31], s53 offen lds
s_mov_b32 m0, 30720
s_nop 0
buffer_load_dwordx4 v138, s[28:31], s53 offen lds
s_add_u32 s52, s52, 16384
s_add_u32 s53, s53, 131072
s_waitcnt vmcnt(33)
s_barrier
s_mov_b32 m0, 32768
s_nop 0
buffer_load_dwordx4 v128, s[24:27], s52 offen sc1 lds
s_mov_b32 m0, 35840
s_nop 0
buffer_load_dwordx4 v129, s[24:27], s52 offen sc1 lds
s_mov_b32 m0, 38912
s_nop 0
buffer_load_dwordx4 v130, s[24:27], s52 offen sc1 lds
s_mov_b32 m0, 41984
s_nop 0
buffer_load_dwordx4 v131, s[24:27], s52 offen sc1 lds
s_mov_b32 m0, 45056
s_nop 0
buffer_load_dwordx4 v132, s[24:27], s52 offen sc1 lds
s_mov_b32 m0, 48128
s_nop 0
buffer_load_dwordx4 v133, s[24:27], s52 offen sc1 lds
s_mov_b32 m0, 51200
s_nop 0
buffer_load_dwordx4 v134, s[28:31], s53 offen lds
s_mov_b32 m0, 54272
s_nop 0
buffer_load_dwordx4 v135, s[28:31], s53 offen lds
s_mov_b32 m0, 57344
s_nop 0
buffer_load_dwordx4 v136, s[28:31], s53 offen lds
s_mov_b32 m0, 60416
s_nop 0
buffer_load_dwordx4 v137, s[28:31], s53 offen lds
s_mov_b32 m0, 63488
s_nop 0
buffer_load_dwordx4 v138, s[28:31], s53 offen lds
s_add_u32 s52, s52, 16384
s_add_u32 s53, s53, 131072
s_waitcnt vmcnt(33)
s_barrier
s_mov_b32 m0, 65536
s_nop 0
buffer_load_dwordx4 v128, s[24:27], s52 offen sc1 lds
s_mov_b32 m0, 68608
s_nop 0
buffer_load_dwordx4 v129, s[24:27], s52 offen sc1 lds
s_mov_b32 m0, 71680
s_nop 0
buffer_load_dwordx4 v130, s[24:27], s52 offen sc1 lds
s_mov_b32 m0, 74752
s_nop 0
buffer_load_dwordx4 v131, s[24:27], s52 offen sc1 lds
s_mov_b32 m0, 77824
s_nop 0
buffer_load_dwordx4 v132, s[24:27], s52 offen sc1 lds
s_mov_b32 m0, 80896
s_nop 0
buffer_load_dwordx4 v133, s[24:27], s52 offen sc1 lds
s_mov_b32 m0, 83968
s_nop 0
buffer_load_dwordx4 v134, s[28:31], s53 offen lds
s_mov_b32 m0, 87040
s_nop 0
buffer_load_dwordx4 v135, s[28:31], s53 offen lds
s_mov_b32 m0, 90112
s_nop 0
buffer_load_dwordx4 v136, s[28:31], s53 offen lds
s_mov_b32 m0, 93184
s_nop 0
buffer_load_dwordx4 v137, s[28:31], s53 offen lds
s_mov_b32 m0, 96256
s_nop 0
buffer_load_dwordx4 v138, s[28:31], s53 offen lds
s_add_u32 s52, s52, 16384
s_add_u32 s53, s53, 131072
s_waitcnt vmcnt(33)
s_barrier
s_mov_b32 m0, 98304
s_nop 0
buffer_load_dwordx4 v128, s[24:27], s52 offen sc1 lds
s_mov_b32 m0, 101376
s_nop 0
buffer_load_dwordx4 v129, s[24:27], s52 offen sc1 lds
s_mov_b32 m0, 104448
s_nop 0
buffer_load_dwordx4 v130, s[24:27], s52 offen sc1 lds
s_mov_b32 m0, 107520
s_nop 0
buffer_load_dwordx4 v131, s[24:27], s52 offen sc1 lds
s_mov_b32 m0, 110592
s_nop 0
buffer_load_dwordx4 v132, s[24:27], s52 offen sc1 lds
s_mov_b32 m0, 113664
s_nop 0
buffer_load_dwordx4 v133, s[24:27], s52 offen sc1 lds
s_mov_b32 m0, 116736
s_nop 0
buffer_load_dwordx4 v134, s[28:31], s53 offen lds
s_mov_b32 m0, 119808
s_nop 0
buffer_load_dwordx4 v135, s[28:31], s53 offen lds
s_mov_b32 m0, 122880
s_nop 0
buffer_load_dwordx4 v136, s[28:31], s53 offen lds
s_mov_b32 m0, 125952
s_nop 0
buffer_load_dwordx4 v137, s[28:31], s53 offen lds
s_mov_b32 m0, 129024
s_nop 0
buffer_load_dwordx4 v138, s[28:31], s53 offen lds
s_add_u32 s52, s52, 16384
s_add_u32 s53, s53, 131072
s_waitcnt vmcnt(33)
s_barrier
s_mul_i32 s52, s61, 6
s_add_u32 s52, s52, 32
s_lshl_b32 s53, s52, 17
s_lshl_b32 s52, s52, 14
s_mov_b32 m0, 131072
s_nop 0
buffer_load_dwordx4 v128, s[24:27], s52 offen sc1 lds
s_mov_b32 m0, 134144
s_nop 0
buffer_load_dwordx4 v129, s[24:27], s52 offen sc1 lds
s_mov_b32 m0, 137216
s_nop 0
buffer_load_dwordx4 v130, s[24:27], s52 offen sc1 lds
s_mov_b32 m0, 140288
s_nop 0
buffer_load_dwordx4 v131, s[24:27], s52 offen sc1 lds
s_mov_b32 m0, 143360
s_nop 0
buffer_load_dwordx4 v132, s[24:27], s52 offen sc1 lds
s_mov_b32 m0, 146432
s_nop 0
buffer_load_dwordx4 v133, s[24:27], s52 offen sc1 lds
s_mov_b32 m0, 149504
s_nop 0
buffer_load_dwordx4 v134, s[28:31], s53 offen lds
s_mov_b32 m0, 152576
s_nop 0
buffer_load_dwordx4 v135, s[28:31], s53 offen lds
s_mov_b32 m0, 155648
s_nop 0
buffer_load_dwordx4 v136, s[28:31], s53 offen lds
s_mov_b32 m0, 158720
s_nop 0
buffer_load_dwordx4 v137, s[28:31], s53 offen lds
s_mov_b32 m0, 161792
s_nop 0
buffer_load_dwordx4 v138, s[28:31], s53 offen lds
s_add_u32 s52, s52, 16384
s_add_u32 s53, s53, 131072
s_waitcnt vmcnt(33)
s_barrier
s_mov_b32 m0, 0
s_nop 0
buffer_load_dwordx4 v128, s[24:27], s52 offen sc1 lds
s_mov_b32 m0, 3072
s_nop 0
buffer_load_dwordx4 v129, s[24:27], s52 offen sc1 lds
s_mov_b32 m0, 6144
s_nop 0
buffer_load_dwordx4 v130, s[24:27], s52 offen sc1 lds
s_mov_b32 m0, 9216
s_nop 0
buffer_load_dwordx4 v131, s[24:27], s52 offen sc1 lds
s_mov_b32 m0, 12288
s_nop 0
buffer_load_dwordx4 v132, s[24:27], s52 offen sc1 lds
s_mov_b32 m0, 15360
s_nop 0
buffer_load_dwordx4 v133, s[24:27], s52 offen sc1 lds
s_mov_b32 m0, 18432
s_nop 0
buffer_load_dwordx4 v134, s[28:31], s53 offen lds
s_mov_b32 m0, 21504
s_nop 0
buffer_load_dwordx4 v135, s[28:31], s53 offen lds
s_mov_b32 m0, 24576
s_nop 0
buffer_load_dwordx4 v136, s[28:31], s53 offen lds
s_mov_b32 m0, 27648
s_nop 0
buffer_load_dwordx4 v137, s[28:31], s53 offen lds
s_mov_b32 m0, 30720
s_nop 0
buffer_load_dwordx4 v138, s[28:31], s53 offen lds
s_add_u32 s52, s52, 16384
s_add_u32 s53, s53, 131072
s_waitcnt vmcnt(33)
s_barrier
s_mov_b32 m0, 32768
s_nop 0
buffer_load_dwordx4 v128, s[24:27], s52 offen sc1 lds
s_mov_b32 m0, 35840
s_nop 0
buffer_load_dwordx4 v129, s[24:27], s52 offen sc1 lds
s_mov_b32 m0, 38912
s_nop 0
buffer_load_dwordx4 v130, s[24:27], s52 offen sc1 lds
s_mov_b32 m0, 41984
s_nop 0
buffer_load_dwordx4 v131, s[24:27], s52 offen sc1 lds
s_mov_b32 m0, 45056
s_nop 0
buffer_load_dwordx4 v132, s[24:27], s52 offen sc1 lds
s_mov_b32 m0, 48128
s_nop 0
buffer_load_dwordx4 v133, s[24:27], s52 offen sc1 lds
s_mov_b32 m0, 51200
s_nop 0
buffer_load_dwordx4 v134, s[28:31], s53 offen lds
s_mov_b32 m0, 54272
s_nop 0
buffer_load_dwordx4 v135, s[28:31], s53 offen lds
s_mov_b32 m0, 57344
s_nop 0
buffer_load_dwordx4 v136, s[28:31], s53 offen lds
s_mov_b32 m0, 60416
s_nop 0
buffer_load_dwordx4 v137, s[28:31], s53 offen lds
s_mov_b32 m0, 63488
s_nop 0
buffer_load_dwordx4 v138, s[28:31], s53 offen lds
s_add_u32 s52, s52, 16384
s_add_u32 s53, s53, 131072
s_waitcnt vmcnt(33)
s_barrier
s_mov_b32 m0, 65536
s_nop 0
buffer_load_dwordx4 v128, s[24:27], s52 offen sc1 lds
s_mov_b32 m0, 68608
s_nop 0
buffer_load_dwordx4 v129, s[24:27], s52 offen sc1 lds
s_mov_b32 m0, 71680
s_nop 0
buffer_load_dwordx4 v130, s[24:27], s52 offen sc1 lds
s_mov_b32 m0, 74752
s_nop 0
buffer_load_dwordx4 v131, s[24:27], s52 offen sc1 lds
s_mov_b32 m0, 77824
s_nop 0
buffer_load_dwordx4 v132, s[24:27], s52 offen sc1 lds
s_mov_b32 m0, 80896
s_nop 0
buffer_load_dwordx4 v133, s[24:27], s52 offen sc1 lds
s_mov_b32 m0, 83968
s_nop 0
buffer_load_dwordx4 v134, s[28:31], s53 offen lds
s_mov_b32 m0, 87040
s_nop 0
buffer_load_dwordx4 v135, s[28:31], s53 offen lds
s_mov_b32 m0, 90112
s_nop 0
buffer_load_dwordx4 v136, s[28:31], s53 offen lds
s_mov_b32 m0, 93184
s_nop 0
buffer_load_dwordx4 v137, s[28:31], s53 offen lds
s_mov_b32 m0, 96256
s_nop 0
buffer_load_dwordx4 v138, s[28:31], s53 offen lds
s_add_u32 s52, s52, 16384
s_add_u32 s53, s53, 131072
s_waitcnt vmcnt(33)
s_barrier
s_mov_b32 m0, 98304
s_nop 0
buffer_load_dwordx4 v128, s[24:27], s52 offen sc1 lds
s_mov_b32 m0, 101376
s_nop 0
buffer_load_dwordx4 v129, s[24:27], s52 offen sc1 lds
s_mov_b32 m0, 104448
s_nop 0
buffer_load_dwordx4 v130, s[24:27], s52 offen sc1 lds
s_mov_b32 m0, 107520
s_nop 0
buffer_load_dwordx4 v131, s[24:27], s52 offen sc1 lds
s_mov_b32 m0, 110592
s_nop 0
buffer_load_dwordx4 v132, s[24:27], s52 offen sc1 lds
s_mov_b32 m0, 113664
s_nop 0
buffer_load_dwordx4 v133, s[24:27], s52 offen sc1 lds
s_mov_b32 m0, 116736
s_nop 0
buffer_load_dwordx4 v134, s[28:31], s53 offen lds
s_mov_b32 m0, 119808
s_nop 0
buffer_load_dwordx4 v135, s[28:31], s53 offen lds
s_mov_b32 m0, 122880
s_nop 0
buffer_load_dwordx4 v136, s[28:31], s53 offen lds
s_mov_b32 m0, 125952
s_nop 0
buffer_load_dwordx4 v137, s[28:31], s53 offen lds
s_mov_b32 m0, 129024
s_nop 0
buffer_load_dwordx4 v138, s[28:31], s53 offen lds
s_add_u32 s52, s52, 16384
s_add_u32 s53, s53, 131072
s_waitcnt vmcnt(33)
s_barrier
s_mov_b32 m0, 131072
s_nop 0
buffer_load_dwordx4 v128, s[24:27], s52 offen sc1 lds
s_mov_b32 m0, 134144
s_nop 0
buffer_load_dwordx4 v129, s[24:27], s52 offen sc1 lds
s_mov_b32 m0, 137216
s_nop 0
buffer_load_dwordx4 v130, s[24:27], s52 offen sc1 lds
s_mov_b32 m0, 140288
s_nop 0
buffer_load_dwordx4 v131, s[24:27], s52 offen sc1 lds
s_mov_b32 m0, 143360
s_nop 0
buffer_load_dwordx4 v132, s[24:27], s52 offen sc1 lds
s_mov_b32 m0, 146432
s_nop 0
buffer_load_dwordx4 v133, s[24:27], s52 offen sc1 lds
s_mov_b32 m0, 149504
s_nop 0
buffer_load_dwordx4 v134, s[28:31], s53 offen lds
s_mov_b32 m0, 152576
s_nop 0
buffer_load_dwordx4 v135, s[28:31], s53 offen lds
s_mov_b32 m0, 155648
s_nop 0
buffer_load_dwordx4 v136, s[28:31], s53 offen lds
s_mov_b32 m0, 158720
s_nop 0
buffer_load_dwordx4 v137, s[28:31], s53 offen lds
s_mov_b32 m0, 161792
s_nop 0
buffer_load_dwordx4 v138, s[28:31], s53 offen lds
s_add_u32 s52, s52, 16384
s_add_u32 s53, s53, 131072
s_waitcnt vmcnt(33)
s_barrier
s_mov_b32 s52, 720896
s_mov_b32 s53, 5767168
s_mov_b32 m0, 0
s_nop 0
buffer_load_dwordx4 v128, s[24:27], s52 offen sc1 lds
s_mov_b32 m0, 3072
s_nop 0
buffer_load_dwordx4 v129, s[24:27], s52 offen sc1 lds
s_mov_b32 m0, 6144
s_nop 0
buffer_load_dwordx4 v130, s[24:27], s52 offen sc1 lds
s_mov_b32 m0, 9216
s_nop 0
buffer_load_dwordx4 v131, s[24:27], s52 offen sc1 lds
s_mov_b32 m0, 12288
s_nop 0
buffer_load_dwordx4 v132, s[24:27], s52 offen sc1 lds
s_mov_b32 m0, 15360
s_nop 0
buffer_load_dwordx4 v133, s[24:27], s52 offen sc1 lds
s_mov_b32 m0, 18432
s_nop 0
buffer_load_dwordx4 v139, s[28:31], s53 offen lds
s_mov_b32 m0, 21504
s_nop 0
buffer_load_dwordx4 v140, s[28:31], s53 offen lds
s_add_u32 s52, s52, 16384
s_add_u32 s53, s53, 131072
s_waitcnt vmcnt(30)
s_barrier
s_mov_b32 m0, 32768
s_nop 0
buffer_load_dwordx4 v128, s[24:27], s52 offen sc1 lds
s_mov_b32 m0, 35840
s_nop 0
buffer_load_dwordx4 v129, s[24:27], s52 offen sc1 lds
s_mov_b32 m0, 38912
s_nop 0
buffer_load_dwordx4 v130, s[24:27], s52 offen sc1 lds
s_mov_b32 m0, 41984
s_nop 0
buffer_load_dwordx4 v131, s[24:27], s52 offen sc1 lds
s_mov_b32 m0, 45056
s_nop 0
buffer_load_dwordx4 v132, s[24:27], s52 offen sc1 lds
s_mov_b32 m0, 48128
s_nop 0
buffer_load_dwordx4 v133, s[24:27], s52 offen sc1 lds
s_mov_b32 m0, 51200
s_nop 0
buffer_load_dwordx4 v139, s[28:31], s53 offen lds
s_mov_b32 m0, 54272
s_nop 0
buffer_load_dwordx4 v140, s[28:31], s53 offen lds
s_add_u32 s52, s52, 16384
s_add_u32 s53, s53, 131072
s_waitcnt vmcnt(27)
s_barrier
s_mov_b32 m0, 65536
s_nop 0
buffer_load_dwordx4 v128, s[24:27], s52 offen sc1 lds
s_mov_b32 m0, 68608
s_nop 0
buffer_load_dwordx4 v129, s[24:27], s52 offen sc1 lds
s_mov_b32 m0, 71680
s_nop 0
buffer_load_dwordx4 v130, s[24:27], s52 offen sc1 lds
s_mov_b32 m0, 74752
s_nop 0
buffer_load_dwordx4 v131, s[24:27], s52 offen sc1 lds
s_mov_b32 m0, 77824
s_nop 0
buffer_load_dwordx4 v132, s[24:27], s52 offen sc1 lds
s_mov_b32 m0, 80896
s_nop 0
buffer_load_dwordx4 v133, s[24:27], s52 offen sc1 lds
s_mov_b32 m0, 83968
s_nop 0
buffer_load_dwordx4 v139, s[28:31], s53 offen lds
s_mov_b32 m0, 87040
s_nop 0
buffer_load_dwordx4 v140, s[28:31], s53 offen lds
s_add_u32 s52, s52, 16384
s_add_u32 s53, s53, 131072
s_waitcnt vmcnt(24)
s_barrier
s_mov_b32 m0, 98304
s_nop 0
buffer_load_dwordx4 v128, s[24:27], s52 offen sc1 lds
s_mov_b32 m0, 101376
s_nop 0
buffer_load_dwordx4 v129, s[24:27], s52 offen sc1 lds
s_mov_b32 m0, 104448
s_nop 0
buffer_load_dwordx4 v130, s[24:27], s52 offen sc1 lds
s_mov_b32 m0, 107520
s_nop 0
buffer_load_dwordx4 v131, s[24:27], s52 offen sc1 lds
s_mov_b32 m0, 110592
s_nop 0
buffer_load_dwordx4 v132, s[24:27], s52 offen sc1 lds
s_mov_b32 m0, 113664
s_nop 0
buffer_load_dwordx4 v133, s[24:27], s52 offen sc1 lds
s_mov_b32 m0, 116736
s_nop 0
buffer_load_dwordx4 v139, s[28:31], s53 offen lds
s_mov_b32 m0, 119808
s_nop 0
buffer_load_dwordx4 v140, s[28:31], s53 offen lds
s_add_u32 s52, s52, 16384
s_add_u32 s53, s53, 131072
s_waitcnt vmcnt(24)
s_barrier
s_mov_b32 m0, 131072
s_nop 0
buffer_load_dwordx4 v128, s[24:27], s52 offen sc1 lds
s_mov_b32 m0, 134144
s_nop 0
buffer_load_dwordx4 v129, s[24:27], s52 offen sc1 lds
s_mov_b32 m0, 137216
s_nop 0
buffer_load_dwordx4 v130, s[24:27], s52 offen sc1 lds
s_mov_b32 m0, 140288
s_nop 0
buffer_load_dwordx4 v131, s[24:27], s52 offen sc1 lds
s_mov_b32 m0, 143360
s_nop 0
buffer_load_dwordx4 v132, s[24:27], s52 offen sc1 lds
s_mov_b32 m0, 146432
s_nop 0
buffer_load_dwordx4 v133, s[24:27], s52 offen sc1 lds
s_mov_b32 m0, 149504
s_nop 0
buffer_load_dwordx4 v139, s[28:31], s53 offen lds
s_mov_b32 m0, 152576
s_nop 0
buffer_load_dwordx4 v140, s[28:31], s53 offen lds
s_add_u32 s52, s52, 16384
s_add_u32 s53, s53, 131072
s_waitcnt vmcnt(24)
s_barrier
s_mov_b32 m0, 0
s_nop 0
buffer_load_dwordx4 v128, s[24:27], s52 offen sc1 lds
s_mov_b32 m0, 3072
s_nop 0
buffer_load_dwordx4 v129, s[24:27], s52 offen sc1 lds
s_mov_b32 m0, 6144
s_nop 0
buffer_load_dwordx4 v130, s[24:27], s52 offen sc1 lds
s_mov_b32 m0, 9216
s_nop 0
buffer_load_dwordx4 v131, s[24:27], s52 offen sc1 lds
s_mov_b32 m0, 12288
s_nop 0
buffer_load_dwordx4 v132, s[24:27], s52 offen sc1 lds
s_mov_b32 m0, 15360
s_nop 0
buffer_load_dwordx4 v133, s[24:27], s52 offen sc1 lds
s_mov_b32 m0, 18432
s_nop 0
buffer_load_dwordx4 v139, s[28:31], s53 offen lds
s_mov_b32 m0, 21504
s_nop 0
buffer_load_dwordx4 v140, s[28:31], s53 offen lds
s_add_u32 s52, s52, 16384
s_add_u32 s53, s53, 131072
s_waitcnt vmcnt(24)
s_barrier
s_mov_b32 m0, 32768
s_nop 0
buffer_load_dwordx4 v128, s[24:27], s52 offen sc1 lds
s_mov_b32 m0, 35840
s_nop 0
buffer_load_dwordx4 v129, s[24:27], s52 offen sc1 lds
s_mov_b32 m0, 38912
s_nop 0
buffer_load_dwordx4 v130, s[24:27], s52 offen sc1 lds
s_mov_b32 m0, 41984
s_nop 0
buffer_load_dwordx4 v131, s[24:27], s52 offen sc1 lds
s_mov_b32 m0, 45056
s_nop 0
buffer_load_dwordx4 v132, s[24:27], s52 offen sc1 lds
s_mov_b32 m0, 48128
s_nop 0
buffer_load_dwordx4 v133, s[24:27], s52 offen sc1 lds
s_mov_b32 m0, 51200
s_nop 0
buffer_load_dwordx4 v139, s[28:31], s53 offen lds
s_mov_b32 m0, 54272
s_nop 0
buffer_load_dwordx4 v140, s[28:31], s53 offen lds
s_add_u32 s52, s52, 16384
s_add_u32 s53, s53, 131072
s_waitcnt vmcnt(24)
s_barrier
s_mov_b32 m0, 65536
s_nop 0
buffer_load_dwordx4 v128, s[24:27], s52 offen sc1 lds
s_mov_b32 m0, 68608
s_nop 0
buffer_load_dwordx4 v129, s[24:27], s52 offen sc1 lds
s_mov_b32 m0, 71680
s_nop 0
buffer_load_dwordx4 v130, s[24:27], s52 offen sc1 lds
s_mov_b32 m0, 74752
s_nop 0
buffer_load_dwordx4 v131, s[24:27], s52 offen sc1 lds
s_mov_b32 m0, 77824
s_nop 0
buffer_load_dwordx4 v132, s[24:27], s52 offen sc1 lds
s_mov_b32 m0, 80896
s_nop 0
buffer_load_dwordx4 v133, s[24:27], s52 offen sc1 lds
s_mov_b32 m0, 83968
s_nop 0
buffer_load_dwordx4 v139, s[28:31], s53 offen lds
s_mov_b32 m0, 87040
s_nop 0
buffer_load_dwordx4 v140, s[28:31], s53 offen lds
s_add_u32 s52, s52, 16384
s_add_u32 s53, s53, 131072
s_waitcnt vmcnt(24)
s_barrier
s_mov_b32 m0, 98304
s_nop 0
buffer_load_dwordx4 v128, s[24:27], s52 offen sc1 lds
s_mov_b32 m0, 101376
s_nop 0
buffer_load_dwordx4 v129, s[24:27], s52 offen sc1 lds
s_mov_b32 m0, 104448
s_nop 0
buffer_load_dwordx4 v130, s[24:27], s52 offen sc1 lds
s_mov_b32 m0, 107520
s_nop 0
buffer_load_dwordx4 v131, s[24:27], s52 offen sc1 lds
s_mov_b32 m0, 110592
s_nop 0
buffer_load_dwordx4 v132, s[24:27], s52 offen sc1 lds
s_mov_b32 m0, 113664
s_nop 0
buffer_load_dwordx4 v133, s[24:27], s52 offen sc1 lds
s_mov_b32 m0, 116736
s_nop 0
buffer_load_dwordx4 v139, s[28:31], s53 offen lds
s_mov_b32 m0, 119808
s_nop 0
buffer_load_dwordx4 v140, s[28:31], s53 offen lds
s_add_u32 s52, s52, 16384
s_add_u32 s53, s53, 131072
s_waitcnt vmcnt(24)
s_barrier
s_mov_b32 m0, 131072
s_nop 0
buffer_load_dwordx4 v128, s[24:27], s52 offen sc1 lds
s_mov_b32 m0, 134144
s_nop 0
buffer_load_dwordx4 v129, s[24:27], s52 offen sc1 lds
s_mov_b32 m0, 137216
s_nop 0
buffer_load_dwordx4 v130, s[24:27], s52 offen sc1 lds
s_mov_b32 m0, 140288
s_nop 0
buffer_load_dwordx4 v131, s[24:27], s52 offen sc1 lds
s_mov_b32 m0, 143360
s_nop 0
buffer_load_dwordx4 v132, s[24:27], s52 offen sc1 lds
s_mov_b32 m0, 146432
s_nop 0
buffer_load_dwordx4 v133, s[24:27], s52 offen sc1 lds
s_mov_b32 m0, 149504
s_nop 0
buffer_load_dwordx4 v139, s[28:31], s53 offen lds
s_mov_b32 m0, 152576
s_nop 0
buffer_load_dwordx4 v140, s[28:31], s53 offen lds
s_add_u32 s52, s52, 16384
s_add_u32 s53, s53, 131072
s_waitcnt vmcnt(24)
s_barrier
s_mov_b32 m0, 0
s_nop 0
buffer_load_dwordx4 v128, s[24:27], s52 offen sc1 lds
s_mov_b32 m0, 3072
s_nop 0
buffer_load_dwordx4 v129, s[24:27], s52 offen sc1 lds
s_mov_b32 m0, 6144
s_nop 0
buffer_load_dwordx4 v130, s[24:27], s52 offen sc1 lds
s_mov_b32 m0, 9216
s_nop 0
buffer_load_dwordx4 v131, s[24:27], s52 offen sc1 lds
s_mov_b32 m0, 12288
s_nop 0
buffer_load_dwordx4 v132, s[24:27], s52 offen sc1 lds
s_mov_b32 m0, 15360
s_nop 0
buffer_load_dwordx4 v133, s[24:27], s52 offen sc1 lds
s_mov_b32 m0, 18432
s_nop 0
buffer_load_dwordx4 v139, s[28:31], s53 offen lds
s_mov_b32 m0, 21504
s_nop 0
buffer_load_dwordx4 v140, s[28:31], s53 offen lds
s_add_u32 s52, s52, 16384
s_add_u32 s53, s53, 131072
s_waitcnt vmcnt(24)
s_barrier
s_mov_b32 m0, 32768
s_nop 0
buffer_load_dwordx4 v128, s[24:27], s52 offen sc1 lds
s_mov_b32 m0, 35840
s_nop 0
buffer_load_dwordx4 v129, s[24:27], s52 offen sc1 lds
s_mov_b32 m0, 38912
s_nop 0
buffer_load_dwordx4 v130, s[24:27], s52 offen sc1 lds
s_mov_b32 m0, 41984
s_nop 0
buffer_load_dwordx4 v131, s[24:27], s52 offen sc1 lds
s_mov_b32 m0, 45056
s_nop 0
buffer_load_dwordx4 v132, s[24:27], s52 offen sc1 lds
s_mov_b32 m0, 48128
s_nop 0
buffer_load_dwordx4 v133, s[24:27], s52 offen sc1 lds
s_mov_b32 m0, 51200
s_nop 0
buffer_load_dwordx4 v139, s[28:31], s53 offen lds
s_mov_b32 m0, 54272
s_nop 0
buffer_load_dwordx4 v140, s[28:31], s53 offen lds
s_add_u32 s52, s52, 16384
s_add_u32 s53, s53, 131072
s_waitcnt vmcnt(24)
s_barrier
s_waitcnt vmcnt(16)
s_barrier
s_waitcnt vmcnt(8)
s_barrier
s_waitcnt vmcnt(0)
s_barrier
s_barrier
s_branch Ldone_1
Lp_90:
s_waitcnt vmcnt(36)
s_barrier
s_mov_b32 m0, 99328
s_nop 0
buffer_load_dwordx4 v128, s[24:27], s52 offen sc1 lds
s_mov_b32 m0, 102400
s_nop 0
buffer_load_dwordx4 v129, s[24:27], s52 offen sc1 lds
s_mov_b32 m0, 105472
s_nop 0
buffer_load_dwordx4 v130, s[24:27], s52 offen sc1 lds
s_mov_b32 m0, 108544
s_nop 0
buffer_load_dwordx4 v131, s[24:27], s52 offen sc1 lds
s_mov_b32 m0, 111616
s_nop 0
buffer_load_dwordx4 v132, s[24:27], s52 offen sc1 lds
s_mov_b32 m0, 114688
s_nop 0
buffer_load_dwordx4 v133, s[28:31], s53 offen lds
s_mov_b32 m0, 117760
s_nop 0
buffer_load_dwordx4 v134, s[28:31], s53 offen lds
s_mov_b32 m0, 120832
s_nop 0
buffer_load_dwordx4 v135, s[28:31], s53 offen lds
s_mov_b32 m0, 123904
s_nop 0
buffer_load_dwordx4 v136, s[28:31], s53 offen lds
s_mov_b32 m0, 126976
s_nop 0
buffer_load_dwordx4 v137, s[28:31], s53 offen lds
s_mov_b32 m0, 130048
s_nop 0
buffer_load_dwordx4 v138, s[28:31], s53 offen lds
s_add_u32 s52, s52, 16384
s_add_u32 s53, s53, 131072
s_waitcnt vmcnt(36)
s_barrier
s_mov_b32 m0, 132096
s_nop 0
buffer_load_dwordx4 v128, s[24:27], s52 offen sc1 lds
s_mov_b32 m0, 135168
s_nop 0
buffer_load_dwordx4 v129, s[24:27], s52 offen sc1 lds
s_mov_b32 m0, 138240
s_nop 0
buffer_load_dwordx4 v130, s[24:27], s52 offen sc1 lds
s_mov_b32 m0, 141312
s_nop 0
buffer_load_dwordx4 v131, s[24:27], s52 offen sc1 lds
s_mov_b32 m0, 144384
s_nop 0
buffer_load_dwordx4 v132, s[24:27], s52 offen sc1 lds
s_mov_b32 m0, 147456
s_nop 0
buffer_load_dwordx4 v133, s[28:31], s53 offen lds
s_mov_b32 m0, 150528
s_nop 0
buffer_load_dwordx4 v134, s[28:31], s53 offen lds
s_mov_b32 m0, 153600
s_nop 0
buffer_load_dwordx4 v135, s[28:31], s53 offen lds
s_mov_b32 m0, 156672
s_nop 0
buffer_load_dwordx4 v136, s[28:31], s53 offen lds
s_mov_b32 m0, 159744
s_nop 0
buffer_load_dwordx4 v137, s[28:31], s53 offen lds
s_mov_b32 m0, 162816
s_nop 0
buffer_load_dwordx4 v138, s[28:31], s53 offen lds
s_add_u32 s52, s52, 16384
s_add_u32 s53, s53, 131072
s_waitcnt vmcnt(22)
s_barrier
s_mov_b32 m0, 1024
s_nop 0
buffer_load_dwordx4 v128, s[24:27], s52 offen sc1 lds
s_mov_b32 m0, 4096
s_nop 0
buffer_load_dwordx4 v129, s[24:27], s52 offen sc1 lds
s_mov_b32 m0, 7168
s_nop 0
buffer_load_dwordx4 v130, s[24:27], s52 offen sc1 lds
s_mov_b32 m0, 10240
s_nop 0
buffer_load_dwordx4 v131, s[24:27], s52 offen sc1 lds
s_mov_b32 m0, 13312
s_nop 0
buffer_load_dwordx4 v132, s[24:27], s52 offen sc1 lds
s_mov_b32 m0, 16384
s_nop 0
buffer_load_dwordx4 v133, s[28:31], s53 offen lds
s_mov_b32 m0, 19456
s_nop 0
buffer_load_dwordx4 v134, s[28:31], s53 offen lds
s_mov_b32 m0, 22528
s_nop 0
buffer_load_dwordx4 v135, s[28:31], s53 offen lds
s_mov_b32 m0, 25600
s_nop 0
buffer_load_dwordx4 v136, s[28:31], s53 offen lds
s_mov_b32 m0, 28672
s_nop 0
buffer_load_dwordx4 v137, s[28:31], s53 offen lds
s_mov_b32 m0, 31744
s_nop 0
buffer_load_dwordx4 v138, s[28:31], s53 offen lds
s_add_u32 s52, s52, 16384
s_add_u32 s53, s53, 131072
s_waitcnt vmcnt(36)
s_barrier
s_mov_b32 m0, 33792
s_nop 0
buffer_load_dwordx4 v128, s[24:27], s52 offen sc1 lds
s_mov_b32 m0, 36864
s_nop 0
buffer_load_dwordx4 v129, s[24:27], s52 offen sc1 lds
s_mov_b32 m0, 39936
s_nop 0
buffer_load_dwordx4 v130, s[24:27], s52 offen sc1 lds
s_mov_b32 m0, 43008
s_nop 0
buffer_load_dwordx4 v131, s[24:27], s52 offen sc1 lds
s_mov_b32 m0, 46080
s_nop 0
buffer_load_dwordx4 v132, s[24:27], s52 offen sc1 lds
s_mov_b32 m0, 49152
s_nop 0
buffer_load_dwordx4 v133, s[28:31], s53 offen lds
s_mov_b32 m0, 52224
s_nop 0
buffer_load_dwordx4 v134, s[28:31], s53 offen lds
s_mov_b32 m0, 55296
s_nop 0
buffer_load_dwordx4 v135, s[28:31], s53 offen lds
s_mov_b32 m0, 58368
s_nop 0
buffer_load_dwordx4 v136, s[28:31], s53 offen lds
s_mov_b32 m0, 61440
s_nop 0
buffer_load_dwordx4 v137, s[28:31], s53 offen lds
s_mov_b32 m0, 64512
s_nop 0
buffer_load_dwordx4 v138, s[28:31], s53 offen lds
s_add_u32 s52, s52, 16384
s_add_u32 s53, s53, 131072
s_waitcnt vmcnt(33)
s_barrier
s_mov_b32 m0, 66560
s_nop 0
buffer_load_dwordx4 v128, s[24:27], s52 offen sc1 lds
s_mov_b32 m0, 69632
s_nop 0
buffer_load_dwordx4 v129, s[24:27], s52 offen sc1 lds
s_mov_b32 m0, 72704
s_nop 0
buffer_load_dwordx4 v130, s[24:27], s52 offen sc1 lds
s_mov_b32 m0, 75776
s_nop 0
buffer_load_dwordx4 v131, s[24:27], s52 offen sc1 lds
s_mov_b32 m0, 78848
s_nop 0
buffer_load_dwordx4 v132, s[24:27], s52 offen sc1 lds
s_mov_b32 m0, 81920
s_nop 0
buffer_load_dwordx4 v133, s[28:31], s53 offen lds
s_mov_b32 m0, 84992
s_nop 0
buffer_load_dwordx4 v134, s[28:31], s53 offen lds
s_mov_b32 m0, 88064
s_nop 0
buffer_load_dwordx4 v135, s[28:31], s53 offen lds
s_mov_b32 m0, 91136
s_nop 0
buffer_load_dwordx4 v136, s[28:31], s53 offen lds
s_mov_b32 m0, 94208
s_nop 0
buffer_load_dwordx4 v137, s[28:31], s53 offen lds
s_mov_b32 m0, 97280
s_nop 0
buffer_load_dwordx4 v138, s[28:31], s53 offen lds
s_add_u32 s52, s52, 16384
s_add_u32 s53, s53, 131072
s_waitcnt vmcnt(33)
s_barrier
s_mov_b32 m0, 99328
s_nop 0
buffer_load_dwordx4 v128, s[24:27], s52 offen sc1 lds
s_mov_b32 m0, 102400
s_nop 0
buffer_load_dwordx4 v129, s[24:27], s52 offen sc1 lds
s_mov_b32 m0, 105472
s_nop 0
buffer_load_dwordx4 v130, s[24:27], s52 offen sc1 lds
s_mov_b32 m0, 108544
s_nop 0
buffer_load_dwordx4 v131, s[24:27], s52 offen sc1 lds
s_mov_b32 m0, 111616
s_nop 0
buffer_load_dwordx4 v132, s[24:27], s52 offen sc1 lds
s_mov_b32 m0, 114688
s_nop 0
buffer_load_dwordx4 v133, s[28:31], s53 offen lds
s_mov_b32 m0, 117760
s_nop 0
buffer_load_dwordx4 v134, s[28:31], s53 offen lds
s_mov_b32 m0, 120832
s_nop 0
buffer_load_dwordx4 v135, s[28:31], s53 offen lds
s_mov_b32 m0, 123904
s_nop 0
buffer_load_dwordx4 v136, s[28:31], s53 offen lds
s_mov_b32 m0, 126976
s_nop 0
buffer_load_dwordx4 v137, s[28:31], s53 offen lds
s_mov_b32 m0, 130048
s_nop 0
buffer_load_dwordx4 v138, s[28:31], s53 offen lds
s_add_u32 s52, s52, 16384
s_add_u32 s53, s53, 131072
s_waitcnt vmcnt(33)
s_barrier
s_mov_b32 m0, 132096
s_nop 0
buffer_load_dwordx4 v128, s[24:27], s52 offen sc1 lds
s_mov_b32 m0, 135168
s_nop 0
buffer_load_dwordx4 v129, s[24:27], s52 offen sc1 lds
s_mov_b32 m0, 138240
s_nop 0
buffer_load_dwordx4 v130, s[24:27], s52 offen sc1 lds
s_mov_b32 m0, 141312
s_nop 0
buffer_load_dwordx4 v131, s[24:27], s52 offen sc1 lds
s_mov_b32 m0, 144384
s_nop 0
buffer_load_dwordx4 v132, s[24:27], s52 offen sc1 lds
s_mov_b32 m0, 147456
s_nop 0
buffer_load_dwordx4 v133, s[28:31], s53 offen lds
s_mov_b32 m0, 150528
s_nop 0
buffer_load_dwordx4 v134, s[28:31], s53 offen lds
s_mov_b32 m0, 153600
s_nop 0
buffer_load_dwordx4 v135, s[28:31], s53 offen lds
s_mov_b32 m0, 156672
s_nop 0
buffer_load_dwordx4 v136, s[28:31], s53 offen lds
s_mov_b32 m0, 159744
s_nop 0
buffer_load_dwordx4 v137, s[28:31], s53 offen lds
s_mov_b32 m0, 162816
s_nop 0
buffer_load_dwordx4 v138, s[28:31], s53 offen lds
s_add_u32 s52, s52, 16384
s_add_u32 s53, s53, 131072
s_waitcnt vmcnt(33)
s_barrier
s_mov_b32 m0, 1024
s_nop 0
buffer_load_dwordx4 v128, s[24:27], s52 offen sc1 lds
s_mov_b32 m0, 4096
s_nop 0
buffer_load_dwordx4 v129, s[24:27], s52 offen sc1 lds
s_mov_b32 m0, 7168
s_nop 0
buffer_load_dwordx4 v130, s[24:27], s52 offen sc1 lds
s_mov_b32 m0, 10240
s_nop 0
buffer_load_dwordx4 v131, s[24:27], s52 offen sc1 lds
s_mov_b32 m0, 13312
s_nop 0
buffer_load_dwordx4 v132, s[24:27], s52 offen sc1 lds
s_mov_b32 m0, 16384
s_nop 0
buffer_load_dwordx4 v133, s[28:31], s53 offen lds
s_mov_b32 m0, 19456
s_nop 0
buffer_load_dwordx4 v134, s[28:31], s53 offen lds
s_mov_b32 m0, 22528
s_nop 0
buffer_load_dwordx4 v135, s[28:31], s53 offen lds
s_mov_b32 m0, 25600
s_nop 0
buffer_load_dwordx4 v136, s[28:31], s53 offen lds
s_mov_b32 m0, 28672
s_nop 0
buffer_load_dwordx4 v137, s[28:31], s53 offen lds
s_mov_b32 m0, 31744
s_nop 0
buffer_load_dwordx4 v138, s[28:31], s53 offen lds
s_add_u32 s52, s52, 16384
s_add_u32 s53, s53, 131072
s_waitcnt vmcnt(33)
s_barrier
s_mov_b32 m0, 33792
s_nop 0
buffer_load_dwordx4 v128, s[24:27], s52 offen sc1 lds
s_mov_b32 m0, 36864
s_nop 0
buffer_load_dwordx4 v129, s[24:27], s52 offen sc1 lds
s_mov_b32 m0, 39936
s_nop 0
buffer_load_dwordx4 v130, s[24:27], s52 offen sc1 lds
s_mov_b32 m0, 43008
s_nop 0
buffer_load_dwordx4 v131, s[24:27], s52 offen sc1 lds
s_mov_b32 m0, 46080
s_nop 0
buffer_load_dwordx4 v132, s[24:27], s52 offen sc1 lds
s_mov_b32 m0, 49152
s_nop 0
buffer_load_dwordx4 v133, s[28:31], s53 offen lds
s_mov_b32 m0, 52224
s_nop 0
buffer_load_dwordx4 v134, s[28:31], s53 offen lds
s_mov_b32 m0, 55296
s_nop 0
buffer_load_dwordx4 v135, s[28:31], s53 offen lds
s_mov_b32 m0, 58368
s_nop 0
buffer_load_dwordx4 v136, s[28:31], s53 offen lds
s_mov_b32 m0, 61440
s_nop 0
buffer_load_dwordx4 v137, s[28:31], s53 offen lds
s_mov_b32 m0, 64512
s_nop 0
buffer_load_dwordx4 v138, s[28:31], s53 offen lds
s_add_u32 s52, s52, 16384
s_add_u32 s53, s53, 131072
s_waitcnt vmcnt(33)
s_barrier
s_mov_b32 m0, 66560
s_nop 0
buffer_load_dwordx4 v128, s[24:27], s52 offen sc1 lds
s_mov_b32 m0, 69632
s_nop 0
buffer_load_dwordx4 v129, s[24:27], s52 offen sc1 lds
s_mov_b32 m0, 72704
s_nop 0
buffer_load_dwordx4 v130, s[24:27], s52 offen sc1 lds
s_mov_b32 m0, 75776
s_nop 0
buffer_load_dwordx4 v131, s[24:27], s52 offen sc1 lds
s_mov_b32 m0, 78848
s_nop 0
buffer_load_dwordx4 v132, s[24:27], s52 offen sc1 lds
s_mov_b32 m0, 81920
s_nop 0
buffer_load_dwordx4 v133, s[28:31], s53 offen lds
s_mov_b32 m0, 84992
s_nop 0
buffer_load_dwordx4 v134, s[28:31], s53 offen lds
s_mov_b32 m0, 88064
s_nop 0
buffer_load_dwordx4 v135, s[28:31], s53 offen lds
s_mov_b32 m0, 91136
s_nop 0
buffer_load_dwordx4 v136, s[28:31], s53 offen lds
s_mov_b32 m0, 94208
s_nop 0
buffer_load_dwordx4 v137, s[28:31], s53 offen lds
s_mov_b32 m0, 97280
s_nop 0
buffer_load_dwordx4 v138, s[28:31], s53 offen lds
s_add_u32 s52, s52, 16384
s_add_u32 s53, s53, 131072
s_waitcnt vmcnt(33)
s_barrier
s_mov_b32 m0, 99328
s_nop 0
buffer_load_dwordx4 v128, s[24:27], s52 offen sc1 lds
s_mov_b32 m0, 102400
s_nop 0
buffer_load_dwordx4 v129, s[24:27], s52 offen sc1 lds
s_mov_b32 m0, 105472
s_nop 0
buffer_load_dwordx4 v130, s[24:27], s52 offen sc1 lds
s_mov_b32 m0, 108544
s_nop 0
buffer_load_dwordx4 v131, s[24:27], s52 offen sc1 lds
s_mov_b32 m0, 111616
s_nop 0
buffer_load_dwordx4 v132, s[24:27], s52 offen sc1 lds
s_mov_b32 m0, 114688
s_nop 0
buffer_load_dwordx4 v133, s[28:31], s53 offen lds
s_mov_b32 m0, 117760
s_nop 0
buffer_load_dwordx4 v134, s[28:31], s53 offen lds
s_mov_b32 m0, 120832
s_nop 0
buffer_load_dwordx4 v135, s[28:31], s53 offen lds
s_mov_b32 m0, 123904
s_nop 0
buffer_load_dwordx4 v136, s[28:31], s53 offen lds
s_mov_b32 m0, 126976
s_nop 0
buffer_load_dwordx4 v137, s[28:31], s53 offen lds
s_mov_b32 m0, 130048
s_nop 0
buffer_load_dwordx4 v138, s[28:31], s53 offen lds
s_add_u32 s52, s52, 16384
s_add_u32 s53, s53, 131072
s_waitcnt vmcnt(33)
s_barrier
s_mul_i32 s52, s61, 6
s_add_u32 s52, s52, 32
s_lshl_b32 s53, s52, 17
s_lshl_b32 s52, s52, 14
s_mov_b32 m0, 132096
s_nop 0
buffer_load_dwordx4 v128, s[24:27], s52 offen sc1 lds
s_mov_b32 m0, 135168
s_nop 0
buffer_load_dwordx4 v129, s[24:27], s52 offen sc1 lds
s_mov_b32 m0, 138240
s_nop 0
buffer_load_dwordx4 v130, s[24:27], s52 offen sc1 lds
s_mov_b32 m0, 141312
s_nop 0
buffer_load_dwordx4 v131, s[24:27], s52 offen sc1 lds
s_mov_b32 m0, 144384
s_nop 0
buffer_load_dwordx4 v132, s[24:27], s52 offen sc1 lds
s_mov_b32 m0, 147456
s_nop 0
buffer_load_dwordx4 v133, s[28:31], s53 offen lds
s_mov_b32 m0, 150528
s_nop 0
buffer_load_dwordx4 v134, s[28:31], s53 offen lds
s_mov_b32 m0, 153600
s_nop 0
buffer_load_dwordx4 v135, s[28:31], s53 offen lds
s_mov_b32 m0, 156672
s_nop 0
buffer_load_dwordx4 v136, s[28:31], s53 offen lds
s_mov_b32 m0, 159744
s_nop 0
buffer_load_dwordx4 v137, s[28:31], s53 offen lds
s_mov_b32 m0, 162816
s_nop 0
buffer_load_dwordx4 v138, s[28:31], s53 offen lds
s_add_u32 s52, s52, 16384
s_add_u32 s53, s53, 131072
s_waitcnt vmcnt(33)
s_barrier
s_mov_b32 m0, 1024
s_nop 0
buffer_load_dwordx4 v128, s[24:27], s52 offen sc1 lds
s_mov_b32 m0, 4096
s_nop 0
buffer_load_dwordx4 v129, s[24:27], s52 offen sc1 lds
s_mov_b32 m0, 7168
s_nop 0
buffer_load_dwordx4 v130, s[24:27], s52 offen sc1 lds
s_mov_b32 m0, 10240
s_nop 0
buffer_load_dwordx4 v131, s[24:27], s52 offen sc1 lds
s_mov_b32 m0, 13312
s_nop 0
buffer_load_dwordx4 v132, s[24:27], s52 offen sc1 lds
s_mov_b32 m0, 16384
s_nop 0
buffer_load_dwordx4 v133, s[28:31], s53 offen lds
s_mov_b32 m0, 19456
s_nop 0
buffer_load_dwordx4 v134, s[28:31], s53 offen lds
s_mov_b32 m0, 22528
s_nop 0
buffer_load_dwordx4 v135, s[28:31], s53 offen lds
s_mov_b32 m0, 25600
s_nop 0
buffer_load_dwordx4 v136, s[28:31], s53 offen lds
s_mov_b32 m0, 28672
s_nop 0
buffer_load_dwordx4 v137, s[28:31], s53 offen lds
s_mov_b32 m0, 31744
s_nop 0
buffer_load_dwordx4 v138, s[28:31], s53 offen lds
s_add_u32 s52, s52, 16384
s_add_u32 s53, s53, 131072
s_waitcnt vmcnt(33)
s_barrier
s_mov_b32 m0, 33792
s_nop 0
buffer_load_dwordx4 v128, s[24:27], s52 offen sc1 lds
s_mov_b32 m0, 36864
s_nop 0
buffer_load_dwordx4 v129, s[24:27], s52 offen sc1 lds
s_mov_b32 m0, 39936
s_nop 0
buffer_load_dwordx4 v130, s[24:27], s52 offen sc1 lds
s_mov_b32 m0, 43008
s_nop 0
buffer_load_dwordx4 v131, s[24:27], s52 offen sc1 lds
s_mov_b32 m0, 46080
s_nop 0
buffer_load_dwordx4 v132, s[24:27], s52 offen sc1 lds
s_mov_b32 m0, 49152
s_nop 0
buffer_load_dwordx4 v133, s[28:31], s53 offen lds
s_mov_b32 m0, 52224
s_nop 0
buffer_load_dwordx4 v134, s[28:31], s53 offen lds
s_mov_b32 m0, 55296
s_nop 0
buffer_load_dwordx4 v135, s[28:31], s53 offen lds
s_mov_b32 m0, 58368
s_nop 0
buffer_load_dwordx4 v136, s[28:31], s53 offen lds
s_mov_b32 m0, 61440
s_nop 0
buffer_load_dwordx4 v137, s[28:31], s53 offen lds
s_mov_b32 m0, 64512
s_nop 0
buffer_load_dwordx4 v138, s[28:31], s53 offen lds
s_add_u32 s52, s52, 16384
s_add_u32 s53, s53, 131072
s_waitcnt vmcnt(33)
s_barrier
s_mov_b32 m0, 66560
s_nop 0
buffer_load_dwordx4 v128, s[24:27], s52 offen sc1 lds
s_mov_b32 m0, 69632
s_nop 0
buffer_load_dwordx4 v129, s[24:27], s52 offen sc1 lds
s_mov_b32 m0, 72704
s_nop 0
buffer_load_dwordx4 v130, s[24:27], s52 offen sc1 lds
s_mov_b32 m0, 75776
s_nop 0
buffer_load_dwordx4 v131, s[24:27], s52 offen sc1 lds
s_mov_b32 m0, 78848
s_nop 0
buffer_load_dwordx4 v132, s[24:27], s52 offen sc1 lds
s_mov_b32 m0, 81920
s_nop 0
buffer_load_dwordx4 v133, s[28:31], s53 offen lds
s_mov_b32 m0, 84992
s_nop 0
buffer_load_dwordx4 v134, s[28:31], s53 offen lds
s_mov_b32 m0, 88064
s_nop 0
buffer_load_dwordx4 v135, s[28:31], s53 offen lds
s_mov_b32 m0, 91136
s_nop 0
buffer_load_dwordx4 v136, s[28:31], s53 offen lds
s_mov_b32 m0, 94208
s_nop 0
buffer_load_dwordx4 v137, s[28:31], s53 offen lds
s_mov_b32 m0, 97280
s_nop 0
buffer_load_dwordx4 v138, s[28:31], s53 offen lds
s_add_u32 s52, s52, 16384
s_add_u32 s53, s53, 131072
s_waitcnt vmcnt(33)
s_barrier
s_mov_b32 m0, 99328
s_nop 0
buffer_load_dwordx4 v128, s[24:27], s52 offen sc1 lds
s_mov_b32 m0, 102400
s_nop 0
buffer_load_dwordx4 v129, s[24:27], s52 offen sc1 lds
s_mov_b32 m0, 105472
s_nop 0
buffer_load_dwordx4 v130, s[24:27], s52 offen sc1 lds
s_mov_b32 m0, 108544
s_nop 0
buffer_load_dwordx4 v131, s[24:27], s52 offen sc1 lds
s_mov_b32 m0, 111616
s_nop 0
buffer_load_dwordx4 v132, s[24:27], s52 offen sc1 lds
s_mov_b32 m0, 114688
s_nop 0
buffer_load_dwordx4 v133, s[28:31], s53 offen lds
s_mov_b32 m0, 117760
s_nop 0
buffer_load_dwordx4 v134, s[28:31], s53 offen lds
s_mov_b32 m0, 120832
s_nop 0
buffer_load_dwordx4 v135, s[28:31], s53 offen lds
s_mov_b32 m0, 123904
s_nop 0
buffer_load_dwordx4 v136, s[28:31], s53 offen lds
s_mov_b32 m0, 126976
s_nop 0
buffer_load_dwordx4 v137, s[28:31], s53 offen lds
s_mov_b32 m0, 130048
s_nop 0
buffer_load_dwordx4 v138, s[28:31], s53 offen lds
s_add_u32 s52, s52, 16384
s_add_u32 s53, s53, 131072
s_waitcnt vmcnt(33)
s_barrier
s_mov_b32 m0, 132096
s_nop 0
buffer_load_dwordx4 v128, s[24:27], s52 offen sc1 lds
s_mov_b32 m0, 135168
s_nop 0
buffer_load_dwordx4 v129, s[24:27], s52 offen sc1 lds
s_mov_b32 m0, 138240
s_nop 0
buffer_load_dwordx4 v130, s[24:27], s52 offen sc1 lds
s_mov_b32 m0, 141312
s_nop 0
buffer_load_dwordx4 v131, s[24:27], s52 offen sc1 lds
s_mov_b32 m0, 144384
s_nop 0
buffer_load_dwordx4 v132, s[24:27], s52 offen sc1 lds
s_mov_b32 m0, 147456
s_nop 0
buffer_load_dwordx4 v133, s[28:31], s53 offen lds
s_mov_b32 m0, 150528
s_nop 0
buffer_load_dwordx4 v134, s[28:31], s53 offen lds
s_mov_b32 m0, 153600
s_nop 0
buffer_load_dwordx4 v135, s[28:31], s53 offen lds
s_mov_b32 m0, 156672
s_nop 0
buffer_load_dwordx4 v136, s[28:31], s53 offen lds
s_mov_b32 m0, 159744
s_nop 0
buffer_load_dwordx4 v137, s[28:31], s53 offen lds
s_mov_b32 m0, 162816
s_nop 0
buffer_load_dwordx4 v138, s[28:31], s53 offen lds
s_add_u32 s52, s52, 16384
s_add_u32 s53, s53, 131072
s_waitcnt vmcnt(33)
s_barrier
s_mov_b32 s52, 720896
s_mov_b32 s53, 5767168
s_mov_b32 m0, 1024
s_nop 0
buffer_load_dwordx4 v128, s[24:27], s52 offen sc1 lds
s_mov_b32 m0, 4096
s_nop 0
buffer_load_dwordx4 v129, s[24:27], s52 offen sc1 lds
s_mov_b32 m0, 7168
s_nop 0
buffer_load_dwordx4 v130, s[24:27], s52 offen sc1 lds
s_mov_b32 m0, 10240
s_nop 0
buffer_load_dwordx4 v131, s[24:27], s52 offen sc1 lds
s_mov_b32 m0, 13312
s_nop 0
buffer_load_dwordx4 v132, s[24:27], s52 offen sc1 lds
s_mov_b32 m0, 16384
s_nop 0
buffer_load_dwordx4 v139, s[28:31], s53 offen lds
s_mov_b32 m0, 19456
s_nop 0
buffer_load_dwordx4 v140, s[28:31], s53 offen lds
s_mov_b32 m0, 22528
s_nop 0
buffer_load_dwordx4 v141, s[28:31], s53 offen lds
s_add_u32 s52, s52, 16384
s_add_u32 s53, s53, 131072
s_waitcnt vmcnt(30)
s_barrier
s_mov_b32 m0, 33792
s_nop 0
buffer_load_dwordx4 v128, s[24:27], s52 offen sc1 lds
s_mov_b32 m0, 36864
s_nop 0
buffer_load_dwordx4 v129, s[24:27], s52 offen sc1 lds
s_mov_b32 m0, 39936
s_nop 0
buffer_load_dwordx4 v130, s[24:27], s52 offen sc1 lds
s_mov_b32 m0, 43008
s_nop 0
buffer_load_dwordx4 v131, s[24:27], s52 offen sc1 lds
s_mov_b32 m0, 46080
s_nop 0
buffer_load_dwordx4 v132, s[24:27], s52 offen sc1 lds
s_mov_b32 m0, 49152
s_nop 0
buffer_load_dwordx4 v139, s[28:31], s53 offen lds
s_mov_b32 m0, 52224
s_nop 0
buffer_load_dwordx4 v140, s[28:31], s53 offen lds
s_mov_b32 m0, 55296
s_nop 0
buffer_load_dwordx4 v141, s[28:31], s53 offen lds
s_add_u32 s52, s52, 16384
s_add_u32 s53, s53, 131072
s_waitcnt vmcnt(27)
s_barrier
s_mov_b32 m0, 66560
s_nop 0
buffer_load_dwordx4 v128, s[24:27], s52 offen sc1 lds
s_mov_b32 m0, 69632
s_nop 0
buffer_load_dwordx4 v129, s[24:27], s52 offen sc1 lds
s_mov_b32 m0, 72704
s_nop 0
buffer_load_dwordx4 v130, s[24:27], s52 offen sc1 lds
s_mov_b32 m0, 75776
s_nop 0
buffer_load_dwordx4 v131, s[24:27], s52 offen sc1 lds
s_mov_b32 m0, 78848
s_nop 0
buffer_load_dwordx4 v132, s[24:27], s52 offen sc1 lds
s_mov_b32 m0, 81920
s_nop 0
buffer_load_dwordx4 v139, s[28:31], s53 offen lds
s_mov_b32 m0, 84992
s_nop 0
buffer_load_dwordx4 v140, s[28:31], s53 offen lds
s_mov_b32 m0, 88064
s_nop 0
buffer_load_dwordx4 v141, s[28:31], s53 offen lds
s_add_u32 s52, s52, 16384
s_add_u32 s53, s53, 131072
s_waitcnt vmcnt(24)
s_barrier
s_mov_b32 m0, 99328
s_nop 0
buffer_load_dwordx4 v128, s[24:27], s52 offen sc1 lds
s_mov_b32 m0, 102400
s_nop 0
buffer_load_dwordx4 v129, s[24:27], s52 offen sc1 lds
s_mov_b32 m0, 105472
s_nop 0
buffer_load_dwordx4 v130, s[24:27], s52 offen sc1 lds
s_mov_b32 m0, 108544
s_nop 0
buffer_load_dwordx4 v131, s[24:27], s52 offen sc1 lds
s_mov_b32 m0, 111616
s_nop 0
buffer_load_dwordx4 v132, s[24:27], s52 offen sc1 lds
s_mov_b32 m0, 114688
s_nop 0
buffer_load_dwordx4 v139, s[28:31], s53 offen lds
s_mov_b32 m0, 117760
s_nop 0
buffer_load_dwordx4 v140, s[28:31], s53 offen lds
s_mov_b32 m0, 120832
s_nop 0
buffer_load_dwordx4 v141, s[28:31], s53 offen lds
s_add_u32 s52, s52, 16384
s_add_u32 s53, s53, 131072
s_waitcnt vmcnt(24)
s_barrier
s_mov_b32 m0, 132096
s_nop 0
buffer_load_dwordx4 v128, s[24:27], s52 offen sc1 lds
s_mov_b32 m0, 135168
s_nop 0
buffer_load_dwordx4 v129, s[24:27], s52 offen sc1 lds
s_mov_b32 m0, 138240
s_nop 0
buffer_load_dwordx4 v130, s[24:27], s52 offen sc1 lds
s_mov_b32 m0, 141312
s_nop 0
buffer_load_dwordx4 v131, s[24:27], s52 offen sc1 lds
s_mov_b32 m0, 144384
s_nop 0
buffer_load_dwordx4 v132, s[24:27], s52 offen sc1 lds
s_mov_b32 m0, 147456
s_nop 0
buffer_load_dwordx4 v139, s[28:31], s53 offen lds
s_mov_b32 m0, 150528
s_nop 0
buffer_load_dwordx4 v140, s[28:31], s53 offen lds
s_mov_b32 m0, 153600
s_nop 0
buffer_load_dwordx4 v141, s[28:31], s53 offen lds
s_add_u32 s52, s52, 16384
s_add_u32 s53, s53, 131072
s_waitcnt vmcnt(24)
s_barrier
s_mov_b32 m0, 1024
s_nop 0
buffer_load_dwordx4 v128, s[24:27], s52 offen sc1 lds
s_mov_b32 m0, 4096
s_nop 0
buffer_load_dwordx4 v129, s[24:27], s52 offen sc1 lds
s_mov_b32 m0, 7168
s_nop 0
buffer_load_dwordx4 v130, s[24:27], s52 offen sc1 lds
s_mov_b32 m0, 10240
s_nop 0
buffer_load_dwordx4 v131, s[24:27], s52 offen sc1 lds
s_mov_b32 m0, 13312
s_nop 0
buffer_load_dwordx4 v132, s[24:27], s52 offen sc1 lds
s_mov_b32 m0, 16384
s_nop 0
buffer_load_dwordx4 v139, s[28:31], s53 offen lds
s_mov_b32 m0, 19456
s_nop 0
buffer_load_dwordx4 v140, s[28:31], s53 offen lds
s_mov_b32 m0, 22528
s_nop 0
buffer_load_dwordx4 v141, s[28:31], s53 offen lds
s_add_u32 s52, s52, 16384
s_add_u32 s53, s53, 131072
s_waitcnt vmcnt(24)
s_barrier
s_mov_b32 m0, 33792
s_nop 0
buffer_load_dwordx4 v128, s[24:27], s52 offen sc1 lds
s_mov_b32 m0, 36864
s_nop 0
buffer_load_dwordx4 v129, s[24:27], s52 offen sc1 lds
s_mov_b32 m0, 39936
s_nop 0
buffer_load_dwordx4 v130, s[24:27], s52 offen sc1 lds
s_mov_b32 m0, 43008
s_nop 0
buffer_load_dwordx4 v131, s[24:27], s52 offen sc1 lds
s_mov_b32 m0, 46080
s_nop 0
buffer_load_dwordx4 v132, s[24:27], s52 offen sc1 lds
s_mov_b32 m0, 49152
s_nop 0
buffer_load_dwordx4 v139, s[28:31], s53 offen lds
s_mov_b32 m0, 52224
s_nop 0
buffer_load_dwordx4 v140, s[28:31], s53 offen lds
s_mov_b32 m0, 55296
s_nop 0
buffer_load_dwordx4 v141, s[28:31], s53 offen lds
s_add_u32 s52, s52, 16384
s_add_u32 s53, s53, 131072
s_waitcnt vmcnt(24)
s_barrier
s_mov_b32 m0, 66560
s_nop 0
buffer_load_dwordx4 v128, s[24:27], s52 offen sc1 lds
s_mov_b32 m0, 69632
s_nop 0
buffer_load_dwordx4 v129, s[24:27], s52 offen sc1 lds
s_mov_b32 m0, 72704
s_nop 0
buffer_load_dwordx4 v130, s[24:27], s52 offen sc1 lds
s_mov_b32 m0, 75776
s_nop 0
buffer_load_dwordx4 v131, s[24:27], s52 offen sc1 lds
s_mov_b32 m0, 78848
s_nop 0
buffer_load_dwordx4 v132, s[24:27], s52 offen sc1 lds
s_mov_b32 m0, 81920
s_nop 0
buffer_load_dwordx4 v139, s[28:31], s53 offen lds
s_mov_b32 m0, 84992
s_nop 0
buffer_load_dwordx4 v140, s[28:31], s53 offen lds
s_mov_b32 m0, 88064
s_nop 0
buffer_load_dwordx4 v141, s[28:31], s53 offen lds
s_add_u32 s52, s52, 16384
s_add_u32 s53, s53, 131072
s_waitcnt vmcnt(24)
s_barrier
s_mov_b32 m0, 99328
s_nop 0
buffer_load_dwordx4 v128, s[24:27], s52 offen sc1 lds
s_mov_b32 m0, 102400
s_nop 0
buffer_load_dwordx4 v129, s[24:27], s52 offen sc1 lds
s_mov_b32 m0, 105472
s_nop 0
buffer_load_dwordx4 v130, s[24:27], s52 offen sc1 lds
s_mov_b32 m0, 108544
s_nop 0
buffer_load_dwordx4 v131, s[24:27], s52 offen sc1 lds
s_mov_b32 m0, 111616
s_nop 0
buffer_load_dwordx4 v132, s[24:27], s52 offen sc1 lds
s_mov_b32 m0, 114688
s_nop 0
buffer_load_dwordx4 v139, s[28:31], s53 offen lds
s_mov_b32 m0, 117760
s_nop 0
buffer_load_dwordx4 v140, s[28:31], s53 offen lds
s_mov_b32 m0, 120832
s_nop 0
buffer_load_dwordx4 v141, s[28:31], s53 offen lds
s_add_u32 s52, s52, 16384
s_add_u32 s53, s53, 131072
s_waitcnt vmcnt(24)
s_barrier
s_mov_b32 m0, 132096
s_nop 0
buffer_load_dwordx4 v128, s[24:27], s52 offen sc1 lds
s_mov_b32 m0, 135168
s_nop 0
buffer_load_dwordx4 v129, s[24:27], s52 offen sc1 lds
s_mov_b32 m0, 138240
s_nop 0
buffer_load_dwordx4 v130, s[24:27], s52 offen sc1 lds
s_mov_b32 m0, 141312
s_nop 0
buffer_load_dwordx4 v131, s[24:27], s52 offen sc1 lds
s_mov_b32 m0, 144384
s_nop 0
buffer_load_dwordx4 v132, s[24:27], s52 offen sc1 lds
s_mov_b32 m0, 147456
s_nop 0
buffer_load_dwordx4 v139, s[28:31], s53 offen lds
s_mov_b32 m0, 150528
s_nop 0
buffer_load_dwordx4 v140, s[28:31], s53 offen lds
s_mov_b32 m0, 153600
s_nop 0
buffer_load_dwordx4 v141, s[28:31], s53 offen lds
s_add_u32 s52, s52, 16384
s_add_u32 s53, s53, 131072
s_waitcnt vmcnt(24)
s_barrier
s_mov_b32 m0, 1024
s_nop 0
buffer_load_dwordx4 v128, s[24:27], s52 offen sc1 lds
s_mov_b32 m0, 4096
s_nop 0
buffer_load_dwordx4 v129, s[24:27], s52 offen sc1 lds
s_mov_b32 m0, 7168
s_nop 0
buffer_load_dwordx4 v130, s[24:27], s52 offen sc1 lds
s_mov_b32 m0, 10240
s_nop 0
buffer_load_dwordx4 v131, s[24:27], s52 offen sc1 lds
s_mov_b32 m0, 13312
s_nop 0
buffer_load_dwordx4 v132, s[24:27], s52 offen sc1 lds
s_mov_b32 m0, 16384
s_nop 0
buffer_load_dwordx4 v139, s[28:31], s53 offen lds
s_mov_b32 m0, 19456
s_nop 0
buffer_load_dwordx4 v140, s[28:31], s53 offen lds
s_mov_b32 m0, 22528
s_nop 0
buffer_load_dwordx4 v141, s[28:31], s53 offen lds
s_add_u32 s52, s52, 16384
s_add_u32 s53, s53, 131072
s_waitcnt vmcnt(24)
s_barrier
s_mov_b32 m0, 33792
s_nop 0
buffer_load_dwordx4 v128, s[24:27], s52 offen sc1 lds
s_mov_b32 m0, 36864
s_nop 0
buffer_load_dwordx4 v129, s[24:27], s52 offen sc1 lds
s_mov_b32 m0, 39936
s_nop 0
buffer_load_dwordx4 v130, s[24:27], s52 offen sc1 lds
s_mov_b32 m0, 43008
s_nop 0
buffer_load_dwordx4 v131, s[24:27], s52 offen sc1 lds
s_mov_b32 m0, 46080
s_nop 0
buffer_load_dwordx4 v132, s[24:27], s52 offen sc1 lds
s_mov_b32 m0, 49152
s_nop 0
buffer_load_dwordx4 v139, s[28:31], s53 offen lds
s_mov_b32 m0, 52224
s_nop 0
buffer_load_dwordx4 v140, s[28:31], s53 offen lds
s_mov_b32 m0, 55296
s_nop 0
buffer_load_dwordx4 v141, s[28:31], s53 offen lds
s_add_u32 s52, s52, 16384
s_add_u32 s53, s53, 131072
s_waitcnt vmcnt(24)
s_barrier
s_waitcnt vmcnt(16)
s_barrier
s_waitcnt vmcnt(8)
s_barrier
s_waitcnt vmcnt(0)
s_barrier
s_barrier
s_branch Ldone_1
Lp_91:
s_waitcnt vmcnt(33)
s_barrier
s_mov_b32 m0, 100352
s_nop 0
buffer_load_dwordx4 v128, s[24:27], s52 offen sc1 lds
s_mov_b32 m0, 103424
s_nop 0
buffer_load_dwordx4 v129, s[24:27], s52 offen sc1 lds
s_mov_b32 m0, 106496
s_nop 0
buffer_load_dwordx4 v130, s[24:27], s52 offen sc1 lds
s_mov_b32 m0, 109568
s_nop 0
buffer_load_dwordx4 v131, s[24:27], s52 offen sc1 lds
s_mov_b32 m0, 112640
s_nop 0
buffer_load_dwordx4 v132, s[24:27], s52 offen sc1 lds
s_mov_b32 m0, 115712
s_nop 0
buffer_load_dwordx4 v133, s[28:31], s53 offen lds
s_mov_b32 m0, 118784
s_nop 0
buffer_load_dwordx4 v134, s[28:31], s53 offen lds
s_mov_b32 m0, 121856
s_nop 0
buffer_load_dwordx4 v135, s[28:31], s53 offen lds
s_mov_b32 m0, 124928
s_nop 0
buffer_load_dwordx4 v136, s[28:31], s53 offen lds
s_mov_b32 m0, 128000
s_nop 0
buffer_load_dwordx4 v137, s[28:31], s53 offen lds
s_add_u32 s52, s52, 16384
s_add_u32 s53, s53, 131072
s_waitcnt vmcnt(33)
s_barrier
s_mov_b32 m0, 133120
s_nop 0
buffer_load_dwordx4 v128, s[24:27], s52 offen sc1 lds
s_mov_b32 m0, 136192
s_nop 0
buffer_load_dwordx4 v129, s[24:27], s52 offen sc1 lds
s_mov_b32 m0, 139264
s_nop 0
buffer_load_dwordx4 v130, s[24:27], s52 offen sc1 lds
s_mov_b32 m0, 142336
s_nop 0
buffer_load_dwordx4 v131, s[24:27], s52 offen sc1 lds
s_mov_b32 m0, 145408
s_nop 0
buffer_load_dwordx4 v132, s[24:27], s52 offen sc1 lds
s_mov_b32 m0, 148480
s_nop 0
buffer_load_dwordx4 v133, s[28:31], s53 offen lds
s_mov_b32 m0, 151552
s_nop 0
buffer_load_dwordx4 v134, s[28:31], s53 offen lds
s_mov_b32 m0, 154624
s_nop 0
buffer_load_dwordx4 v135, s[28:31], s53 offen lds
s_mov_b32 m0, 157696
s_nop 0
buffer_load_dwordx4 v136, s[28:31], s53 offen lds
s_mov_b32 m0, 160768
s_nop 0
buffer_load_dwordx4 v137, s[28:31], s53 offen lds
s_add_u32 s52, s52, 16384
s_add_u32 s53, s53, 131072
s_waitcnt vmcnt(20)
s_barrier
s_mov_b32 m0, 2048
s_nop 0
buffer_load_dwordx4 v128, s[24:27], s52 offen sc1 lds
s_mov_b32 m0, 5120
s_nop 0
buffer_load_dwordx4 v129, s[24:27], s52 offen sc1 lds
s_mov_b32 m0, 8192
s_nop 0
buffer_load_dwordx4 v130, s[24:27], s52 offen sc1 lds
s_mov_b32 m0, 11264
s_nop 0
buffer_load_dwordx4 v131, s[24:27], s52 offen sc1 lds
s_mov_b32 m0, 14336
s_nop 0
buffer_load_dwordx4 v132, s[24:27], s52 offen sc1 lds
s_mov_b32 m0, 17408
s_nop 0
buffer_load_dwordx4 v133, s[28:31], s53 offen lds
s_mov_b32 m0, 20480
s_nop 0
buffer_load_dwordx4 v134, s[28:31], s53 offen lds
s_mov_b32 m0, 23552
s_nop 0
buffer_load_dwordx4 v135, s[28:31], s53 offen lds
s_mov_b32 m0, 26624
s_nop 0
buffer_load_dwordx4 v136, s[28:31], s53 offen lds
s_mov_b32 m0, 29696
s_nop 0
buffer_load_dwordx4 v137, s[28:31], s53 offen lds
s_add_u32 s52, s52, 16384
s_add_u32 s53, s53, 131072
s_waitcnt vmcnt(33)
s_barrier
s_mov_b32 m0, 34816
s_nop 0
buffer_load_dwordx4 v128, s[24:27], s52 offen sc1 lds
s_mov_b32 m0, 37888
s_nop 0
buffer_load_dwordx4 v129, s[24:27], s52 offen sc1 lds
s_mov_b32 m0, 40960
s_nop 0
buffer_load_dwordx4 v130, s[24:27], s52 offen sc1 lds
s_mov_b32 m0, 44032
s_nop 0
buffer_load_dwordx4 v131, s[24:27], s52 offen sc1 lds
s_mov_b32 m0, 47104
s_nop 0
buffer_load_dwordx4 v132, s[24:27], s52 offen sc1 lds
s_mov_b32 m0, 50176
s_nop 0
buffer_load_dwordx4 v133, s[28:31], s53 offen lds
s_mov_b32 m0, 53248
s_nop 0
buffer_load_dwordx4 v134, s[28:31], s53 offen lds
s_mov_b32 m0, 56320
s_nop 0
buffer_load_dwordx4 v135, s[28:31], s53 offen lds
s_mov_b32 m0, 59392
s_nop 0
buffer_load_dwordx4 v136, s[28:31], s53 offen lds
s_mov_b32 m0, 62464
s_nop 0
buffer_load_dwordx4 v137, s[28:31], s53 offen lds
s_add_u32 s52, s52, 16384
s_add_u32 s53, s53, 131072
s_waitcnt vmcnt(30)
s_barrier
s_mov_b32 m0, 67584
s_nop 0
buffer_load_dwordx4 v128, s[24:27], s52 offen sc1 lds
s_mov_b32 m0, 70656
s_nop 0
buffer_load_dwordx4 v129, s[24:27], s52 offen sc1 lds
s_mov_b32 m0, 73728
s_nop 0
buffer_load_dwordx4 v130, s[24:27], s52 offen sc1 lds
s_mov_b32 m0, 76800
s_nop 0
buffer_load_dwordx4 v131, s[24:27], s52 offen sc1 lds
s_mov_b32 m0, 79872
s_nop 0
buffer_load_dwordx4 v132, s[24:27], s52 offen sc1 lds
s_mov_b32 m0, 82944
s_nop 0
buffer_load_dwordx4 v133, s[28:31], s53 offen lds
s_mov_b32 m0, 86016
s_nop 0
buffer_load_dwordx4 v134, s[28:31], s53 offen lds
s_mov_b32 m0, 89088
s_nop 0
buffer_load_dwordx4 v135, s[28:31], s53 offen lds
s_mov_b32 m0, 92160
s_nop 0
buffer_load_dwordx4 v136, s[28:31], s53 offen lds
s_mov_b32 m0, 95232
s_nop 0
buffer_load_dwordx4 v137, s[28:31], s53 offen lds
s_add_u32 s52, s52, 16384
s_add_u32 s53, s53, 131072
s_waitcnt vmcnt(30)
s_barrier
s_mov_b32 m0, 100352
s_nop 0
buffer_load_dwordx4 v128, s[24:27], s52 offen sc1 lds
s_mov_b32 m0, 103424
s_nop 0
buffer_load_dwordx4 v129, s[24:27], s52 offen sc1 lds
s_mov_b32 m0, 106496
s_nop 0
buffer_load_dwordx4 v130, s[24:27], s52 offen sc1 lds
s_mov_b32 m0, 109568
s_nop 0
buffer_load_dwordx4 v131, s[24:27], s52 offen sc1 lds
s_mov_b32 m0, 112640
s_nop 0
buffer_load_dwordx4 v132, s[24:27], s52 offen sc1 lds
s_mov_b32 m0, 115712
s_nop 0
buffer_load_dwordx4 v133, s[28:31], s53 offen lds
s_mov_b32 m0, 118784
s_nop 0
buffer_load_dwordx4 v134, s[28:31], s53 offen lds
s_mov_b32 m0, 121856
s_nop 0
buffer_load_dwordx4 v135, s[28:31], s53 offen lds
s_mov_b32 m0, 124928
s_nop 0
buffer_load_dwordx4 v136, s[28:31], s53 offen lds
s_mov_b32 m0, 128000
s_nop 0
buffer_load_dwordx4 v137, s[28:31], s53 offen lds
s_add_u32 s52, s52, 16384
s_add_u32 s53, s53, 131072
s_waitcnt vmcnt(30)
s_barrier
s_mov_b32 m0, 133120
s_nop 0
buffer_load_dwordx4 v128, s[24:27], s52 offen sc1 lds
s_mov_b32 m0, 136192
s_nop 0
buffer_load_dwordx4 v129, s[24:27], s52 offen sc1 lds
s_mov_b32 m0, 139264
s_nop 0
buffer_load_dwordx4 v130, s[24:27], s52 offen sc1 lds
s_mov_b32 m0, 142336
s_nop 0
buffer_load_dwordx4 v131, s[24:27], s52 offen sc1 lds
s_mov_b32 m0, 145408
s_nop 0
buffer_load_dwordx4 v132, s[24:27], s52 offen sc1 lds
s_mov_b32 m0, 148480
s_nop 0
buffer_load_dwordx4 v133, s[28:31], s53 offen lds
s_mov_b32 m0, 151552
s_nop 0
buffer_load_dwordx4 v134, s[28:31], s53 offen lds
s_mov_b32 m0, 154624
s_nop 0
buffer_load_dwordx4 v135, s[28:31], s53 offen lds
s_mov_b32 m0, 157696
s_nop 0
buffer_load_dwordx4 v136, s[28:31], s53 offen lds
s_mov_b32 m0, 160768
s_nop 0
buffer_load_dwordx4 v137, s[28:31], s53 offen lds
s_add_u32 s52, s52, 16384
s_add_u32 s53, s53, 131072
s_waitcnt vmcnt(30)
s_barrier
s_mov_b32 m0, 2048
s_nop 0
buffer_load_dwordx4 v128, s[24:27], s52 offen sc1 lds
s_mov_b32 m0, 5120
s_nop 0
buffer_load_dwordx4 v129, s[24:27], s52 offen sc1 lds
s_mov_b32 m0, 8192
s_nop 0
buffer_load_dwordx4 v130, s[24:27], s52 offen sc1 lds
s_mov_b32 m0, 11264
s_nop 0
buffer_load_dwordx4 v131, s[24:27], s52 offen sc1 lds
s_mov_b32 m0, 14336
s_nop 0
buffer_load_dwordx4 v132, s[24:27], s52 offen sc1 lds
s_mov_b32 m0, 17408
s_nop 0
buffer_load_dwordx4 v133, s[28:31], s53 offen lds
s_mov_b32 m0, 20480
s_nop 0
buffer_load_dwordx4 v134, s[28:31], s53 offen lds
s_mov_b32 m0, 23552
s_nop 0
buffer_load_dwordx4 v135, s[28:31], s53 offen lds
s_mov_b32 m0, 26624
s_nop 0
buffer_load_dwordx4 v136, s[28:31], s53 offen lds
s_mov_b32 m0, 29696
s_nop 0
buffer_load_dwordx4 v137, s[28:31], s53 offen lds
s_add_u32 s52, s52, 16384
s_add_u32 s53, s53, 131072
s_waitcnt vmcnt(30)
s_barrier
s_mov_b32 m0, 34816
s_nop 0
buffer_load_dwordx4 v128, s[24:27], s52 offen sc1 lds
s_mov_b32 m0, 37888
s_nop 0
buffer_load_dwordx4 v129, s[24:27], s52 offen sc1 lds
s_mov_b32 m0, 40960
s_nop 0
buffer_load_dwordx4 v130, s[24:27], s52 offen sc1 lds
s_mov_b32 m0, 44032
s_nop 0
buffer_load_dwordx4 v131, s[24:27], s52 offen sc1 lds
s_mov_b32 m0, 47104
s_nop 0
buffer_load_dwordx4 v132, s[24:27], s52 offen sc1 lds
s_mov_b32 m0, 50176
s_nop 0
buffer_load_dwordx4 v133, s[28:31], s53 offen lds
s_mov_b32 m0, 53248
s_nop 0
buffer_load_dwordx4 v134, s[28:31], s53 offen lds
s_mov_b32 m0, 56320
s_nop 0
buffer_load_dwordx4 v135, s[28:31], s53 offen lds
s_mov_b32 m0, 59392
s_nop 0
buffer_load_dwordx4 v136, s[28:31], s53 offen lds
s_mov_b32 m0, 62464
s_nop 0
buffer_load_dwordx4 v137, s[28:31], s53 offen lds
s_add_u32 s52, s52, 16384
s_add_u32 s53, s53, 131072
s_waitcnt vmcnt(30)
s_barrier
s_mov_b32 m0, 67584
s_nop 0
buffer_load_dwordx4 v128, s[24:27], s52 offen sc1 lds
s_mov_b32 m0, 70656
s_nop 0
buffer_load_dwordx4 v129, s[24:27], s52 offen sc1 lds
s_mov_b32 m0, 73728
s_nop 0
buffer_load_dwordx4 v130, s[24:27], s52 offen sc1 lds
s_mov_b32 m0, 76800
s_nop 0
buffer_load_dwordx4 v131, s[24:27], s52 offen sc1 lds
s_mov_b32 m0, 79872
s_nop 0
buffer_load_dwordx4 v132, s[24:27], s52 offen sc1 lds
s_mov_b32 m0, 82944
s_nop 0
buffer_load_dwordx4 v133, s[28:31], s53 offen lds
s_mov_b32 m0, 86016
s_nop 0
buffer_load_dwordx4 v134, s[28:31], s53 offen lds
s_mov_b32 m0, 89088
s_nop 0
buffer_load_dwordx4 v135, s[28:31], s53 offen lds
s_mov_b32 m0, 92160
s_nop 0
buffer_load_dwordx4 v136, s[28:31], s53 offen lds
s_mov_b32 m0, 95232
s_nop 0
buffer_load_dwordx4 v137, s[28:31], s53 offen lds
s_add_u32 s52, s52, 16384
s_add_u32 s53, s53, 131072
s_waitcnt vmcnt(30)
s_barrier
s_mov_b32 m0, 100352
s_nop 0
buffer_load_dwordx4 v128, s[24:27], s52 offen sc1 lds
s_mov_b32 m0, 103424
s_nop 0
buffer_load_dwordx4 v129, s[24:27], s52 offen sc1 lds
s_mov_b32 m0, 106496
s_nop 0
buffer_load_dwordx4 v130, s[24:27], s52 offen sc1 lds
s_mov_b32 m0, 109568
s_nop 0
buffer_load_dwordx4 v131, s[24:27], s52 offen sc1 lds
s_mov_b32 m0, 112640
s_nop 0
buffer_load_dwordx4 v132, s[24:27], s52 offen sc1 lds
s_mov_b32 m0, 115712
s_nop 0
buffer_load_dwordx4 v133, s[28:31], s53 offen lds
s_mov_b32 m0, 118784
s_nop 0
buffer_load_dwordx4 v134, s[28:31], s53 offen lds
s_mov_b32 m0, 121856
s_nop 0
buffer_load_dwordx4 v135, s[28:31], s53 offen lds
s_mov_b32 m0, 124928
s_nop 0
buffer_load_dwordx4 v136, s[28:31], s53 offen lds
s_mov_b32 m0, 128000
s_nop 0
buffer_load_dwordx4 v137, s[28:31], s53 offen lds
s_add_u32 s52, s52, 16384
s_add_u32 s53, s53, 131072
s_waitcnt vmcnt(30)
s_barrier
s_mul_i32 s52, s61, 6
s_add_u32 s52, s52, 32
s_lshl_b32 s53, s52, 17
s_lshl_b32 s52, s52, 14
s_mov_b32 m0, 133120
s_nop 0
buffer_load_dwordx4 v128, s[24:27], s52 offen sc1 lds
s_mov_b32 m0, 136192
s_nop 0
buffer_load_dwordx4 v129, s[24:27], s52 offen sc1 lds
s_mov_b32 m0, 139264
s_nop 0
buffer_load_dwordx4 v130, s[24:27], s52 offen sc1 lds
s_mov_b32 m0, 142336
s_nop 0
buffer_load_dwordx4 v131, s[24:27], s52 offen sc1 lds
s_mov_b32 m0, 145408
s_nop 0
buffer_load_dwordx4 v132, s[24:27], s52 offen sc1 lds
s_mov_b32 m0, 148480
s_nop 0
buffer_load_dwordx4 v133, s[28:31], s53 offen lds
s_mov_b32 m0, 151552
s_nop 0
buffer_load_dwordx4 v134, s[28:31], s53 offen lds
s_mov_b32 m0, 154624
s_nop 0
buffer_load_dwordx4 v135, s[28:31], s53 offen lds
s_mov_b32 m0, 157696
s_nop 0
buffer_load_dwordx4 v136, s[28:31], s53 offen lds
s_mov_b32 m0, 160768
s_nop 0
buffer_load_dwordx4 v137, s[28:31], s53 offen lds
s_add_u32 s52, s52, 16384
s_add_u32 s53, s53, 131072
s_waitcnt vmcnt(30)
s_barrier
s_mov_b32 m0, 2048
s_nop 0
buffer_load_dwordx4 v128, s[24:27], s52 offen sc1 lds
s_mov_b32 m0, 5120
s_nop 0
buffer_load_dwordx4 v129, s[24:27], s52 offen sc1 lds
s_mov_b32 m0, 8192
s_nop 0
buffer_load_dwordx4 v130, s[24:27], s52 offen sc1 lds
s_mov_b32 m0, 11264
s_nop 0
buffer_load_dwordx4 v131, s[24:27], s52 offen sc1 lds
s_mov_b32 m0, 14336
s_nop 0
buffer_load_dwordx4 v132, s[24:27], s52 offen sc1 lds
s_mov_b32 m0, 17408
s_nop 0
buffer_load_dwordx4 v133, s[28:31], s53 offen lds
s_mov_b32 m0, 20480
s_nop 0
buffer_load_dwordx4 v134, s[28:31], s53 offen lds
s_mov_b32 m0, 23552
s_nop 0
buffer_load_dwordx4 v135, s[28:31], s53 offen lds
s_mov_b32 m0, 26624
s_nop 0
buffer_load_dwordx4 v136, s[28:31], s53 offen lds
s_mov_b32 m0, 29696
s_nop 0
buffer_load_dwordx4 v137, s[28:31], s53 offen lds
s_add_u32 s52, s52, 16384
s_add_u32 s53, s53, 131072
s_waitcnt vmcnt(30)
s_barrier
s_mov_b32 m0, 34816
s_nop 0
buffer_load_dwordx4 v128, s[24:27], s52 offen sc1 lds
s_mov_b32 m0, 37888
s_nop 0
buffer_load_dwordx4 v129, s[24:27], s52 offen sc1 lds
s_mov_b32 m0, 40960
s_nop 0
buffer_load_dwordx4 v130, s[24:27], s52 offen sc1 lds
s_mov_b32 m0, 44032
s_nop 0
buffer_load_dwordx4 v131, s[24:27], s52 offen sc1 lds
s_mov_b32 m0, 47104
s_nop 0
buffer_load_dwordx4 v132, s[24:27], s52 offen sc1 lds
s_mov_b32 m0, 50176
s_nop 0
buffer_load_dwordx4 v133, s[28:31], s53 offen lds
s_mov_b32 m0, 53248
s_nop 0
buffer_load_dwordx4 v134, s[28:31], s53 offen lds
s_mov_b32 m0, 56320
s_nop 0
buffer_load_dwordx4 v135, s[28:31], s53 offen lds
s_mov_b32 m0, 59392
s_nop 0
buffer_load_dwordx4 v136, s[28:31], s53 offen lds
s_mov_b32 m0, 62464
s_nop 0
buffer_load_dwordx4 v137, s[28:31], s53 offen lds
s_add_u32 s52, s52, 16384
s_add_u32 s53, s53, 131072
s_waitcnt vmcnt(30)
s_barrier
s_mov_b32 m0, 67584
s_nop 0
buffer_load_dwordx4 v128, s[24:27], s52 offen sc1 lds
s_mov_b32 m0, 70656
s_nop 0
buffer_load_dwordx4 v129, s[24:27], s52 offen sc1 lds
s_mov_b32 m0, 73728
s_nop 0
buffer_load_dwordx4 v130, s[24:27], s52 offen sc1 lds
s_mov_b32 m0, 76800
s_nop 0
buffer_load_dwordx4 v131, s[24:27], s52 offen sc1 lds
s_mov_b32 m0, 79872
s_nop 0
buffer_load_dwordx4 v132, s[24:27], s52 offen sc1 lds
s_mov_b32 m0, 82944
s_nop 0
buffer_load_dwordx4 v133, s[28:31], s53 offen lds
s_mov_b32 m0, 86016
s_nop 0
buffer_load_dwordx4 v134, s[28:31], s53 offen lds
s_mov_b32 m0, 89088
s_nop 0
buffer_load_dwordx4 v135, s[28:31], s53 offen lds
s_mov_b32 m0, 92160
s_nop 0
buffer_load_dwordx4 v136, s[28:31], s53 offen lds
s_mov_b32 m0, 95232
s_nop 0
buffer_load_dwordx4 v137, s[28:31], s53 offen lds
s_add_u32 s52, s52, 16384
s_add_u32 s53, s53, 131072
s_waitcnt vmcnt(30)
s_barrier
s_mov_b32 m0, 100352
s_nop 0
buffer_load_dwordx4 v128, s[24:27], s52 offen sc1 lds
s_mov_b32 m0, 103424
s_nop 0
buffer_load_dwordx4 v129, s[24:27], s52 offen sc1 lds
s_mov_b32 m0, 106496
s_nop 0
buffer_load_dwordx4 v130, s[24:27], s52 offen sc1 lds
s_mov_b32 m0, 109568
s_nop 0
buffer_load_dwordx4 v131, s[24:27], s52 offen sc1 lds
s_mov_b32 m0, 112640
s_nop 0
buffer_load_dwordx4 v132, s[24:27], s52 offen sc1 lds
s_mov_b32 m0, 115712
s_nop 0
buffer_load_dwordx4 v133, s[28:31], s53 offen lds
s_mov_b32 m0, 118784
s_nop 0
buffer_load_dwordx4 v134, s[28:31], s53 offen lds
s_mov_b32 m0, 121856
s_nop 0
buffer_load_dwordx4 v135, s[28:31], s53 offen lds
s_mov_b32 m0, 124928
s_nop 0
buffer_load_dwordx4 v136, s[28:31], s53 offen lds
s_mov_b32 m0, 128000
s_nop 0
buffer_load_dwordx4 v137, s[28:31], s53 offen lds
s_add_u32 s52, s52, 16384
s_add_u32 s53, s53, 131072
s_waitcnt vmcnt(30)
s_barrier
s_mov_b32 m0, 133120
s_nop 0
buffer_load_dwordx4 v128, s[24:27], s52 offen sc1 lds
s_mov_b32 m0, 136192
s_nop 0
buffer_load_dwordx4 v129, s[24:27], s52 offen sc1 lds
s_mov_b32 m0, 139264
s_nop 0
buffer_load_dwordx4 v130, s[24:27], s52 offen sc1 lds
s_mov_b32 m0, 142336
s_nop 0
buffer_load_dwordx4 v131, s[24:27], s52 offen sc1 lds
s_mov_b32 m0, 145408
s_nop 0
buffer_load_dwordx4 v132, s[24:27], s52 offen sc1 lds
s_mov_b32 m0, 148480
s_nop 0
buffer_load_dwordx4 v133, s[28:31], s53 offen lds
s_mov_b32 m0, 151552
s_nop 0
buffer_load_dwordx4 v134, s[28:31], s53 offen lds
s_mov_b32 m0, 154624
s_nop 0
buffer_load_dwordx4 v135, s[28:31], s53 offen lds
s_mov_b32 m0, 157696
s_nop 0
buffer_load_dwordx4 v136, s[28:31], s53 offen lds
s_mov_b32 m0, 160768
s_nop 0
buffer_load_dwordx4 v137, s[28:31], s53 offen lds
s_add_u32 s52, s52, 16384
s_add_u32 s53, s53, 131072
s_waitcnt vmcnt(30)
s_barrier
s_mov_b32 s52, 720896
s_mov_b32 s53, 5767168
s_mov_b32 m0, 2048
s_nop 0
buffer_load_dwordx4 v128, s[24:27], s52 offen sc1 lds
s_mov_b32 m0, 5120
s_nop 0
buffer_load_dwordx4 v129, s[24:27], s52 offen sc1 lds
s_mov_b32 m0, 8192
s_nop 0
buffer_load_dwordx4 v130, s[24:27], s52 offen sc1 lds
s_mov_b32 m0, 11264
s_nop 0
buffer_load_dwordx4 v131, s[24:27], s52 offen sc1 lds
s_mov_b32 m0, 14336
s_nop 0
buffer_load_dwordx4 v132, s[24:27], s52 offen sc1 lds
s_mov_b32 m0, 17408
s_nop 0
buffer_load_dwordx4 v139, s[28:31], s53 offen lds
s_mov_b32 m0, 20480
s_nop 0
buffer_load_dwordx4 v140, s[28:31], s53 offen lds
s_mov_b32 m0, 23552
s_nop 0
buffer_load_dwordx4 v141, s[28:31], s53 offen lds
s_add_u32 s52, s52, 16384
s_add_u32 s53, s53, 131072
s_waitcnt vmcnt(28)
s_barrier
s_mov_b32 m0, 34816
s_nop 0
buffer_load_dwordx4 v128, s[24:27], s52 offen sc1 lds
s_mov_b32 m0, 37888
s_nop 0
buffer_load_dwordx4 v129, s[24:27], s52 offen sc1 lds
s_mov_b32 m0, 40960
s_nop 0
buffer_load_dwordx4 v130, s[24:27], s52 offen sc1 lds
s_mov_b32 m0, 44032
s_nop 0
buffer_load_dwordx4 v131, s[24:27], s52 offen sc1 lds
s_mov_b32 m0, 47104
s_nop 0
buffer_load_dwordx4 v132, s[24:27], s52 offen sc1 lds
s_mov_b32 m0, 50176
s_nop 0
buffer_load_dwordx4 v139, s[28:31], s53 offen lds
s_mov_b32 m0, 53248
s_nop 0
buffer_load_dwordx4 v140, s[28:31], s53 offen lds
s_mov_b32 m0, 56320
s_nop 0
buffer_load_dwordx4 v141, s[28:31], s53 offen lds
s_add_u32 s52, s52, 16384
s_add_u32 s53, s53, 131072
s_waitcnt vmcnt(26)
s_barrier
s_mov_b32 m0, 67584
s_nop 0
buffer_load_dwordx4 v128, s[24:27], s52 offen sc1 lds
s_mov_b32 m0, 70656
s_nop 0
buffer_load_dwordx4 v129, s[24:27], s52 offen sc1 lds
s_mov_b32 m0, 73728
s_nop 0
buffer_load_dwordx4 v130, s[24:27], s52 offen sc1 lds
s_mov_b32 m0, 76800
s_nop 0
buffer_load_dwordx4 v131, s[24:27], s52 offen sc1 lds
s_mov_b32 m0, 79872
s_nop 0
buffer_load_dwordx4 v132, s[24:27], s52 offen sc1 lds
s_mov_b32 m0, 82944
s_nop 0
buffer_load_dwordx4 v139, s[28:31], s53 offen lds
s_mov_b32 m0, 86016
s_nop 0
buffer_load_dwordx4 v140, s[28:31], s53 offen lds
s_mov_b32 m0, 89088
s_nop 0
buffer_load_dwordx4 v141, s[28:31], s53 offen lds
s_add_u32 s52, s52, 16384
s_add_u32 s53, s53, 131072
s_waitcnt vmcnt(24)
s_barrier
s_mov_b32 m0, 100352
s_nop 0
buffer_load_dwordx4 v128, s[24:27], s52 offen sc1 lds
s_mov_b32 m0, 103424
s_nop 0
buffer_load_dwordx4 v129, s[24:27], s52 offen sc1 lds
s_mov_b32 m0, 106496
s_nop 0
buffer_load_dwordx4 v130, s[24:27], s52 offen sc1 lds
s_mov_b32 m0, 109568
s_nop 0
buffer_load_dwordx4 v131, s[24:27], s52 offen sc1 lds
s_mov_b32 m0, 112640
s_nop 0
buffer_load_dwordx4 v132, s[24:27], s52 offen sc1 lds
s_mov_b32 m0, 115712
s_nop 0
buffer_load_dwordx4 v139, s[28:31], s53 offen lds
s_mov_b32 m0, 118784
s_nop 0
buffer_load_dwordx4 v140, s[28:31], s53 offen lds
s_mov_b32 m0, 121856
s_nop 0
buffer_load_dwordx4 v141, s[28:31], s53 offen lds
s_add_u32 s52, s52, 16384
s_add_u32 s53, s53, 131072
s_waitcnt vmcnt(24)
s_barrier
s_mov_b32 m0, 133120
s_nop 0
buffer_load_dwordx4 v128, s[24:27], s52 offen sc1 lds
s_mov_b32 m0, 136192
s_nop 0
buffer_load_dwordx4 v129, s[24:27], s52 offen sc1 lds
s_mov_b32 m0, 139264
s_nop 0
buffer_load_dwordx4 v130, s[24:27], s52 offen sc1 lds
s_mov_b32 m0, 142336
s_nop 0
buffer_load_dwordx4 v131, s[24:27], s52 offen sc1 lds
s_mov_b32 m0, 145408
s_nop 0
buffer_load_dwordx4 v132, s[24:27], s52 offen sc1 lds
s_mov_b32 m0, 148480
s_nop 0
buffer_load_dwordx4 v139, s[28:31], s53 offen lds
s_mov_b32 m0, 151552
s_nop 0
buffer_load_dwordx4 v140, s[28:31], s53 offen lds
s_mov_b32 m0, 154624
s_nop 0
buffer_load_dwordx4 v141, s[28:31], s53 offen lds
s_add_u32 s52, s52, 16384
s_add_u32 s53, s53, 131072
s_waitcnt vmcnt(24)
s_barrier
s_mov_b32 m0, 2048
s_nop 0
buffer_load_dwordx4 v128, s[24:27], s52 offen sc1 lds
s_mov_b32 m0, 5120
s_nop 0
buffer_load_dwordx4 v129, s[24:27], s52 offen sc1 lds
s_mov_b32 m0, 8192
s_nop 0
buffer_load_dwordx4 v130, s[24:27], s52 offen sc1 lds
s_mov_b32 m0, 11264
s_nop 0
buffer_load_dwordx4 v131, s[24:27], s52 offen sc1 lds
s_mov_b32 m0, 14336
s_nop 0
buffer_load_dwordx4 v132, s[24:27], s52 offen sc1 lds
s_mov_b32 m0, 17408
s_nop 0
buffer_load_dwordx4 v139, s[28:31], s53 offen lds
s_mov_b32 m0, 20480
s_nop 0
buffer_load_dwordx4 v140, s[28:31], s53 offen lds
s_mov_b32 m0, 23552
s_nop 0
buffer_load_dwordx4 v141, s[28:31], s53 offen lds
s_add_u32 s52, s52, 16384
s_add_u32 s53, s53, 131072
s_waitcnt vmcnt(24)
s_barrier
s_mov_b32 m0, 34816
s_nop 0
buffer_load_dwordx4 v128, s[24:27], s52 offen sc1 lds
s_mov_b32 m0, 37888
s_nop 0
buffer_load_dwordx4 v129, s[24:27], s52 offen sc1 lds
s_mov_b32 m0, 40960
s_nop 0
buffer_load_dwordx4 v130, s[24:27], s52 offen sc1 lds
s_mov_b32 m0, 44032
s_nop 0
buffer_load_dwordx4 v131, s[24:27], s52 offen sc1 lds
s_mov_b32 m0, 47104
s_nop 0
buffer_load_dwordx4 v132, s[24:27], s52 offen sc1 lds
s_mov_b32 m0, 50176
s_nop 0
buffer_load_dwordx4 v139, s[28:31], s53 offen lds
s_mov_b32 m0, 53248
s_nop 0
buffer_load_dwordx4 v140, s[28:31], s53 offen lds
s_mov_b32 m0, 56320
s_nop 0
buffer_load_dwordx4 v141, s[28:31], s53 offen lds
s_add_u32 s52, s52, 16384
s_add_u32 s53, s53, 131072
s_waitcnt vmcnt(24)
s_barrier
s_mov_b32 m0, 67584
s_nop 0
buffer_load_dwordx4 v128, s[24:27], s52 offen sc1 lds
s_mov_b32 m0, 70656
s_nop 0
buffer_load_dwordx4 v129, s[24:27], s52 offen sc1 lds
s_mov_b32 m0, 73728
s_nop 0
buffer_load_dwordx4 v130, s[24:27], s52 offen sc1 lds
s_mov_b32 m0, 76800
s_nop 0
buffer_load_dwordx4 v131, s[24:27], s52 offen sc1 lds
s_mov_b32 m0, 79872
s_nop 0
buffer_load_dwordx4 v132, s[24:27], s52 offen sc1 lds
s_mov_b32 m0, 82944
s_nop 0
buffer_load_dwordx4 v139, s[28:31], s53 offen lds
s_mov_b32 m0, 86016
s_nop 0
buffer_load_dwordx4 v140, s[28:31], s53 offen lds
s_mov_b32 m0, 89088
s_nop 0
buffer_load_dwordx4 v141, s[28:31], s53 offen lds
s_add_u32 s52, s52, 16384
s_add_u32 s53, s53, 131072
s_waitcnt vmcnt(24)
s_barrier
s_mov_b32 m0, 100352
s_nop 0
buffer_load_dwordx4 v128, s[24:27], s52 offen sc1 lds
s_mov_b32 m0, 103424
s_nop 0
buffer_load_dwordx4 v129, s[24:27], s52 offen sc1 lds
s_mov_b32 m0, 106496
s_nop 0
buffer_load_dwordx4 v130, s[24:27], s52 offen sc1 lds
s_mov_b32 m0, 109568
s_nop 0
buffer_load_dwordx4 v131, s[24:27], s52 offen sc1 lds
s_mov_b32 m0, 112640
s_nop 0
buffer_load_dwordx4 v132, s[24:27], s52 offen sc1 lds
s_mov_b32 m0, 115712
s_nop 0
buffer_load_dwordx4 v139, s[28:31], s53 offen lds
s_mov_b32 m0, 118784
s_nop 0
buffer_load_dwordx4 v140, s[28:31], s53 offen lds
s_mov_b32 m0, 121856
s_nop 0
buffer_load_dwordx4 v141, s[28:31], s53 offen lds
s_add_u32 s52, s52, 16384
s_add_u32 s53, s53, 131072
s_waitcnt vmcnt(24)
s_barrier
s_mov_b32 m0, 133120
s_nop 0
buffer_load_dwordx4 v128, s[24:27], s52 offen sc1 lds
s_mov_b32 m0, 136192
s_nop 0
buffer_load_dwordx4 v129, s[24:27], s52 offen sc1 lds
s_mov_b32 m0, 139264
s_nop 0
buffer_load_dwordx4 v130, s[24:27], s52 offen sc1 lds
s_mov_b32 m0, 142336
s_nop 0
buffer_load_dwordx4 v131, s[24:27], s52 offen sc1 lds
s_mov_b32 m0, 145408
s_nop 0
buffer_load_dwordx4 v132, s[24:27], s52 offen sc1 lds
s_mov_b32 m0, 148480
s_nop 0
buffer_load_dwordx4 v139, s[28:31], s53 offen lds
s_mov_b32 m0, 151552
s_nop 0
buffer_load_dwordx4 v140, s[28:31], s53 offen lds
s_mov_b32 m0, 154624
s_nop 0
buffer_load_dwordx4 v141, s[28:31], s53 offen lds
s_add_u32 s52, s52, 16384
s_add_u32 s53, s53, 131072
s_waitcnt vmcnt(24)
s_barrier
s_mov_b32 m0, 2048
s_nop 0
buffer_load_dwordx4 v128, s[24:27], s52 offen sc1 lds
s_mov_b32 m0, 5120
s_nop 0
buffer_load_dwordx4 v129, s[24:27], s52 offen sc1 lds
s_mov_b32 m0, 8192
s_nop 0
buffer_load_dwordx4 v130, s[24:27], s52 offen sc1 lds
s_mov_b32 m0, 11264
s_nop 0
buffer_load_dwordx4 v131, s[24:27], s52 offen sc1 lds
s_mov_b32 m0, 14336
s_nop 0
buffer_load_dwordx4 v132, s[24:27], s52 offen sc1 lds
s_mov_b32 m0, 17408
s_nop 0
buffer_load_dwordx4 v139, s[28:31], s53 offen lds
s_mov_b32 m0, 20480
s_nop 0
buffer_load_dwordx4 v140, s[28:31], s53 offen lds
s_mov_b32 m0, 23552
s_nop 0
buffer_load_dwordx4 v141, s[28:31], s53 offen lds
s_add_u32 s52, s52, 16384
s_add_u32 s53, s53, 131072
s_waitcnt vmcnt(24)
s_barrier
s_mov_b32 m0, 34816
s_nop 0
buffer_load_dwordx4 v128, s[24:27], s52 offen sc1 lds
s_mov_b32 m0, 37888
s_nop 0
buffer_load_dwordx4 v129, s[24:27], s52 offen sc1 lds
s_mov_b32 m0, 40960
s_nop 0
buffer_load_dwordx4 v130, s[24:27], s52 offen sc1 lds
s_mov_b32 m0, 44032
s_nop 0
buffer_load_dwordx4 v131, s[24:27], s52 offen sc1 lds
s_mov_b32 m0, 47104
s_nop 0
buffer_load_dwordx4 v132, s[24:27], s52 offen sc1 lds
s_mov_b32 m0, 50176
s_nop 0
buffer_load_dwordx4 v139, s[28:31], s53 offen lds
s_mov_b32 m0, 53248
s_nop 0
buffer_load_dwordx4 v140, s[28:31], s53 offen lds
s_mov_b32 m0, 56320
s_nop 0
buffer_load_dwordx4 v141, s[28:31], s53 offen lds
s_add_u32 s52, s52, 16384
s_add_u32 s53, s53, 131072
s_waitcnt vmcnt(24)
s_barrier
s_waitcnt vmcnt(16)
s_barrier
s_waitcnt vmcnt(8)
s_barrier
s_waitcnt vmcnt(0)
s_barrier
s_barrier
s_branch Ldone_1
Lpf_85:
s_add_u32 s43, s34, 48
s_lshl_b32 s43, s43, 7
v_mov_b32 v8, s43
s_barrier
s_barrier
s_waitcnt vmcnt(0)
s_barrier
s_add_u32 s43, s34, 48
s_lshl_b32 s43, s43, 7
v_mov_b32 v10, s43
v_mov_b32 v11, 1
s_mov_b64 exec, 1
buffer_atomic_add v11, v10, s[56:59], 0 offen sc1
s_mov_b64 exec, -1
s_barrier
s_barrier
s_barrier
s_barrier
s_barrier
s_barrier
s_barrier
buffer_load_dword v9, v8, s[56:59], 0 offen sc1
s_barrier
s_waitcnt vmcnt(0)
s_mov_b32 s41, 0x40000
s_branch Lpchk_94
Lpoll_92:
buffer_load_dword v9, v8, s[56:59], 0 offen sc1
s_waitcnt vmcnt(0)
Lpchk_94:
v_readfirstlane_b32 s42, v9
s_cmp_eq_u32 s42, 16
s_cbranch_scc1 Lpok_93
s_sub_u32 s41, s41, 1
s_cmp_lg_u32 s41, 0
s_cbranch_scc1 Lpoll_92
Lpok_93:
s_barrier
s_barrier
s_barrier
s_barrier
s_barrier
s_barrier
s_barrier
s_barrier
s_barrier
s_barrier
s_barrier
s_barrier
s_barrier
s_barrier
s_barrier
s_barrier
s_barrier
s_barrier
s_barrier
s_barrier
s_barrier
s_barrier
s_barrier
s_branch Ldone_1
Ldone_1:
Lexit_2:
s_endpgm
.section .rodata,"a"
.p2align 6
.amdhsa_kernel sequential_preLN__sliding_local_dilated__glu_gated_geglu__prompt_kernel
  .amdhsa_next_free_vgpr 256
  .amdhsa_next_free_sgpr 100
  .amdhsa_accum_offset 256
  .amdhsa_group_segment_fixed_size 0
  .amdhsa_kernarg_size 80
  .amdhsa_user_sgpr_count 2
  .amdhsa_user_sgpr_kernarg_segment_ptr 1
  .amdhsa_system_sgpr_workgroup_id_x 1
  .amdhsa_float_denorm_mode_32 3
  .amdhsa_float_denorm_mode_16_64 3
.end_amdhsa_kernel
```

```asm
; @launch grid=(256,1,1) block=(512,1,1) lds=163840
.amdgcn_target "amdgcn-amd-amdhsa--gfx950"
.text
.globl sequential_preLN__sliding_local_dilated__glu_gated_geglu__prompt_kernel
.p2align 8
.type sequential_preLN__sliding_local_dilated__glu_gated_geglu__prompt_kernel,@function
sequential_preLN__sliding_local_dilated__glu_gated_geglu__prompt_kernel:
s_cmp_ge_u32 s2, 256
s_cbranch_scc1 Lexit_2
s_load_dwordx16 s[64:79], s[0:1], 0
s_load_dwordx4 s[80:83], s[0:1], 64
s_and_b32 s3, s2, 7
s_lshr_b32 s42, s2, 3
s_and_b32 s34, s3, 1
s_lshl_b32 s34, s34, 3
s_and_b32 s48, s42, 7
s_add_u32 s34, s34, s48
s_lshr_b32 s35, s3, 1
s_lshr_b32 s49, s42, 3
s_lshl_b32 s35, s35, 2
s_add_u32 s35, s35, s49
v_lshrrev_b32 v12, 6, v0
v_and_b32 v1, 63, v0
v_readfirstlane_b32 s36, v12
Lbeg:
s_lshl_b32 s43, s35, 7
s_lshl_b32 s50, s34, 7
s_sub_u32 s50, s50, 16
s_waitcnt lgkmcnt(0)
s_mov_b32 s8, s64
s_mov_b32 s9, s65
s_mov_b32 s10, 4194304
s_mov_b32 s11, 0x20000
s_add_u32 s12, s66, s43
s_addc_u32 s13, s67, 0
s_mov_b32 s14, 6289536
s_mov_b32 s15, 0x20000
v_and_b32 v12, 15, v1
v_lshrrev_b32 v13, 4, v1
s_cmp_ge_u32 s36, 4
s_cbranch_scc1 Lprod_3
v_lshrrev_b32 v16, 1, v12
v_xor_b32 v15, v13, v16
v_lshlrev_b32 v15, 4, v15
v_lshl_add_u32 v2, v12, 7, v15
v_xor_b32 v3, 64, v2
v_add_u32 v4, 86016, v2
v_add_u32 v5, 86016, v3
v_lshrrev_b32 v15, 2, v12
v_and_b32 v16, 3, v1
v_lshl_add_u32 v19, v13, 3, v15
v_lshlrev_b32 v19, 7, v19
v_and_b32 v15, 2, v15
v_and_b32 v17, 1, v13
v_lshl_add_u32 v15, v17, 2, v15
v_lshrrev_b32 v17, 1, v16
s_lshl_b32 s43, s36, 1
v_add_u32 v17, s43, v17
v_xor_b32 v15, v15, v17
v_lshl_add_u32 v19, v15, 4, v19
v_and_b32 v16, 1, v16
v_lshl_add_u32 v19, v16, 3, v19
v_add_u32 v6, 18432, v19
v_add_u32 v7, 61440, v19
v_add_u32 v8, 104448, v19
v_mov_b32 v128, 0
v_mov_b32 v129, 0
v_mov_b32 v130, 0
v_mov_b32 v131, 0
v_mov_b32 v132, 0
v_mov_b32 v133, 0
v_mov_b32 v134, 0
v_mov_b32 v135, 0
v_mov_b32 v136, 0
v_mov_b32 v137, 0
v_mov_b32 v138, 0
v_mov_b32 v139, 0
v_mov_b32 v140, 0
v_mov_b32 v141, 0
v_mov_b32 v142, 0
v_mov_b32 v143, 0
v_mov_b32 v144, 0
v_mov_b32 v145, 0
v_mov_b32 v146, 0
v_mov_b32 v147, 0
v_mov_b32 v148, 0
v_mov_b32 v149, 0
v_mov_b32 v150, 0
v_mov_b32 v151, 0
v_mov_b32 v152, 0
v_mov_b32 v153, 0
v_mov_b32 v154, 0
v_mov_b32 v155, 0
v_mov_b32 v156, 0
v_mov_b32 v157, 0
v_mov_b32 v158, 0
v_mov_b32 v159, 0
v_mov_b32 v160, 0
v_mov_b32 v161, 0
v_mov_b32 v162, 0
v_mov_b32 v163, 0
v_mov_b32 v164, 0
v_mov_b32 v165, 0
v_mov_b32 v166, 0
v_mov_b32 v167, 0
v_mov_b32 v168, 0
v_mov_b32 v169, 0
v_mov_b32 v170, 0
v_mov_b32 v171, 0
v_mov_b32 v172, 0
v_mov_b32 v173, 0
v_mov_b32 v174, 0
v_mov_b32 v175, 0
v_mov_b32 v176, 0
v_mov_b32 v177, 0
v_mov_b32 v178, 0
v_mov_b32 v179, 0
v_mov_b32 v180, 0
v_mov_b32 v181, 0
v_mov_b32 v182, 0
v_mov_b32 v183, 0
v_mov_b32 v184, 0
v_mov_b32 v185, 0
v_mov_b32 v186, 0
v_mov_b32 v187, 0
v_mov_b32 v188, 0
v_mov_b32 v189, 0
v_mov_b32 v190, 0
v_mov_b32 v191, 0
v_mov_b32 v192, 0
v_mov_b32 v193, 0
v_mov_b32 v194, 0
v_mov_b32 v195, 0
v_mov_b32 v196, 0
v_mov_b32 v197, 0
v_mov_b32 v198, 0
v_mov_b32 v199, 0
v_mov_b32 v200, 0
v_mov_b32 v201, 0
v_mov_b32 v202, 0
v_mov_b32 v203, 0
v_mov_b32 v204, 0
v_mov_b32 v205, 0
v_mov_b32 v206, 0
v_mov_b32 v207, 0
v_mov_b32 v208, 0
v_mov_b32 v209, 0
v_mov_b32 v210, 0
v_mov_b32 v211, 0
v_mov_b32 v212, 0
v_mov_b32 v213, 0
v_mov_b32 v214, 0
v_mov_b32 v215, 0
v_mov_b32 v216, 0
v_mov_b32 v217, 0
v_mov_b32 v218, 0
v_mov_b32 v219, 0
v_mov_b32 v220, 0
v_mov_b32 v221, 0
v_mov_b32 v222, 0
v_mov_b32 v223, 0
v_mov_b32 v224, 0
v_mov_b32 v225, 0
v_mov_b32 v226, 0
v_mov_b32 v227, 0
v_mov_b32 v228, 0
v_mov_b32 v229, 0
v_mov_b32 v230, 0
v_mov_b32 v231, 0
v_mov_b32 v232, 0
v_mov_b32 v233, 0
v_mov_b32 v234, 0
v_mov_b32 v235, 0
s_cmp_lg_u32 s36, 0
s_cbranch_scc1 Lwm_7
s_branch Lst_0_0
Lwr_125:
s_branch Lwe_6
Lwm_7:
s_cmp_lg_u32 s36, 1
s_cbranch_scc1 Lwm_8
s_branch Lst_1_0
Lwr_126:
s_branch Lwe_6
Lwm_8:
s_cmp_lg_u32 s36, 2
s_cbranch_scc1 Lwm_9
s_branch Lst_2_0
Lwr_127:
s_branch Lwe_6
Lwm_9:
s_cmp_lg_u32 s36, 3
s_cbranch_scc1 Lwm_10
s_branch Lst_3_0
Lwr_128:
s_branch Lwe_6
Lwm_10:
Lwe_6:
s_barrier
ds_read_b128 v[32:35], v2 offset:0
ds_read_b64_tr_b16 v[72:73], v6 offset:8192
ds_read_b64_tr_b16 v[74:75], v6 offset:8704
ds_read_b64_tr_b16 v[76:77], v6 offset:16384
ds_read_b64_tr_b16 v[78:79], v6 offset:16896
ds_read_b64_tr_b16 v[68:69], v6 offset:0
ds_read_b64_tr_b16 v[70:71], v6 offset:512
ds_read_b128 v[36:39], v2 offset:2048
ds_read_b128 v[40:43], v2 offset:4096
ds_read_b128 v[44:47], v2 offset:6144
ds_read_b128 v[48:51], v2 offset:8192
ds_read_b128 v[52:55], v2 offset:10240
ds_read_b128 v[56:59], v2 offset:12288
ds_read_b128 v[60:63], v2 offset:14336
ds_read_b128 v[64:67], v2 offset:16384
s_mov_b32 s41, 5
Lcl_11:
s_waitcnt lgkmcnt(0)
v_mfma_f32_16x16x32_bf16 v[164:167], v[72:75], v[32:35], v[164:167]
ds_read_b128 v[80:83], v3 offset:0
v_mfma_f32_16x16x32_bf16 v[200:203], v[76:79], v[32:35], v[200:203]
ds_read_b64_tr_b16 v[120:121], v6 offset:12288
v_mfma_f32_16x16x32_bf16 v[128:131], v[68:71], v[32:35], v[128:131]
ds_read_b64_tr_b16 v[122:123], v6 offset:12800
v_mfma_f32_16x16x32_bf16 v[132:135], v[68:71], v[36:39], v[132:135]
ds_read_b64_tr_b16 v[124:125], v6 offset:20480
v_mfma_f32_16x16x32_bf16 v[204:207], v[76:79], v[36:39], v[204:207]
ds_read_b64_tr_b16 v[126:127], v6 offset:20992
v_mfma_f32_16x16x32_bf16 v[168:171], v[72:75], v[36:39], v[168:171]
ds_read_b64_tr_b16 v[116:117], v6 offset:4096
v_mfma_f32_16x16x32_bf16 v[172:175], v[72:75], v[40:43], v[172:175]
ds_read_b64_tr_b16 v[118:119], v6 offset:4608
v_mfma_f32_16x16x32_bf16 v[208:211], v[76:79], v[40:43], v[208:211]
ds_read_b128 v[84:87], v3 offset:2048
v_mfma_f32_16x16x32_bf16 v[136:139], v[68:71], v[40:43], v[136:139]
ds_read_b128 v[88:91], v3 offset:4096
v_mfma_f32_16x16x32_bf16 v[140:143], v[68:71], v[44:47], v[140:143]
ds_read_b128 v[92:95], v3 offset:6144
v_mfma_f32_16x16x32_bf16 v[212:215], v[76:79], v[44:47], v[212:215]
ds_read_b128 v[96:99], v3 offset:8192
v_mfma_f32_16x16x32_bf16 v[176:179], v[72:75], v[44:47], v[176:179]
ds_read_b128 v[100:103], v3 offset:10240
v_mfma_f32_16x16x32_bf16 v[180:183], v[72:75], v[48:51], v[180:183]
ds_read_b128 v[104:107], v3 offset:12288
v_mfma_f32_16x16x32_bf16 v[216:219], v[76:79], v[48:51], v[216:219]
ds_read_b128 v[108:111], v3 offset:14336
v_mfma_f32_16x16x32_bf16 v[144:147], v[68:71], v[48:51], v[144:147]
ds_read_b128 v[112:115], v3 offset:16384
v_mfma_f32_16x16x32_bf16 v[148:151], v[68:71], v[52:55], v[148:151]
v_mfma_f32_16x16x32_bf16 v[220:223], v[76:79], v[52:55], v[220:223]
v_mfma_f32_16x16x32_bf16 v[184:187], v[72:75], v[52:55], v[184:187]
v_mfma_f32_16x16x32_bf16 v[188:191], v[72:75], v[56:59], v[188:191]
v_mfma_f32_16x16x32_bf16 v[224:227], v[76:79], v[56:59], v[224:227]
v_mfma_f32_16x16x32_bf16 v[152:155], v[68:71], v[56:59], v[152:155]
v_mfma_f32_16x16x32_bf16 v[156:159], v[68:71], v[60:63], v[156:159]
v_mfma_f32_16x16x32_bf16 v[228:231], v[76:79], v[60:63], v[228:231]
v_mfma_f32_16x16x32_bf16 v[192:195], v[72:75], v[60:63], v[192:195]
v_mfma_f32_16x16x32_bf16 v[196:199], v[72:75], v[64:67], v[196:199]
v_mfma_f32_16x16x32_bf16 v[232:235], v[76:79], v[64:67], v[232:235]
v_mfma_f32_16x16x32_bf16 v[160:163], v[68:71], v[64:67], v[160:163]
s_waitcnt lgkmcnt(0)
s_barrier
v_mfma_f32_16x16x32_bf16 v[164:167], v[120:123], v[80:83], v[164:167]
ds_read_b128 v[32:35], v2 offset:43008
v_mfma_f32_16x16x32_bf16 v[200:203], v[124:127], v[80:83], v[200:203]
ds_read_b64_tr_b16 v[72:73], v7 offset:8192
v_mfma_f32_16x16x32_bf16 v[128:131], v[116:119], v[80:83], v[128:131]
ds_read_b64_tr_b16 v[74:75], v7 offset:8704
v_mfma_f32_16x16x32_bf16 v[132:135], v[116:119], v[84:87], v[132:135]
ds_read_b64_tr_b16 v[76:77], v7 offset:16384
v_mfma_f32_16x16x32_bf16 v[204:207], v[124:127], v[84:87], v[204:207]
ds_read_b64_tr_b16 v[78:79], v7 offset:16896
v_mfma_f32_16x16x32_bf16 v[168:171], v[120:123], v[84:87], v[168:171]
ds_read_b64_tr_b16 v[68:69], v7 offset:0
v_mfma_f32_16x16x32_bf16 v[172:175], v[120:123], v[88:91], v[172:175]
ds_read_b64_tr_b16 v[70:71], v7 offset:512
v_mfma_f32_16x16x32_bf16 v[208:211], v[124:127], v[88:91], v[208:211]
ds_read_b128 v[36:39], v2 offset:45056
v_mfma_f32_16x16x32_bf16 v[136:139], v[116:119], v[88:91], v[136:139]
ds_read_b128 v[40:43], v2 offset:47104
v_mfma_f32_16x16x32_bf16 v[140:143], v[116:119], v[92:95], v[140:143]
ds_read_b128 v[44:47], v2 offset:49152
v_mfma_f32_16x16x32_bf16 v[212:215], v[124:127], v[92:95], v[212:215]
ds_read_b128 v[48:51], v2 offset:51200
v_mfma_f32_16x16x32_bf16 v[176:179], v[120:123], v[92:95], v[176:179]
ds_read_b128 v[52:55], v2 offset:53248
v_mfma_f32_16x16x32_bf16 v[180:183], v[120:123], v[96:99], v[180:183]
ds_read_b128 v[56:59], v2 offset:55296
v_mfma_f32_16x16x32_bf16 v[216:219], v[124:127], v[96:99], v[216:219]
ds_read_b128 v[60:63], v2 offset:57344
v_mfma_f32_16x16x32_bf16 v[144:147], v[116:119], v[96:99], v[144:147]
ds_read_b128 v[64:67], v2 offset:59392
v_mfma_f32_16x16x32_bf16 v[148:151], v[116:119], v[100:103], v[148:151]
v_mfma_f32_16x16x32_bf16 v[220:223], v[124:127], v[100:103], v[220:223]
v_mfma_f32_16x16x32_bf16 v[184:187], v[120:123], v[100:103], v[184:187]
v_mfma_f32_16x16x32_bf16 v[188:191], v[120:123], v[104:107], v[188:191]
v_mfma_f32_16x16x32_bf16 v[224:227], v[124:127], v[104:107], v[224:227]
v_mfma_f32_16x16x32_bf16 v[152:155], v[116:119], v[104:107], v[152:155]
v_mfma_f32_16x16x32_bf16 v[156:159], v[116:119], v[108:111], v[156:159]
v_mfma_f32_16x16x32_bf16 v[228:231], v[124:127], v[108:111], v[228:231]
v_mfma_f32_16x16x32_bf16 v[192:195], v[120:123], v[108:111], v[192:195]
v_mfma_f32_16x16x32_bf16 v[196:199], v[120:123], v[112:115], v[196:199]
v_mfma_f32_16x16x32_bf16 v[232:235], v[124:127], v[112:115], v[232:235]
v_mfma_f32_16x16x32_bf16 v[160:163], v[116:119], v[112:115], v[160:163]
s_waitcnt lgkmcnt(0)
v_mfma_f32_16x16x32_bf16 v[164:167], v[72:75], v[32:35], v[164:167]
ds_read_b128 v[80:83], v3 offset:43008
v_mfma_f32_16x16x32_bf16 v[200:203], v[76:79], v[32:35], v[200:203]
ds_read_b64_tr_b16 v[120:121], v7 offset:12288
v_mfma_f32_16x16x32_bf16 v[128:131], v[68:71], v[32:35], v[128:131]
ds_read_b64_tr_b16 v[122:123], v7 offset:12800
v_mfma_f32_16x16x32_bf16 v[132:135], v[68:71], v[36:39], v[132:135]
ds_read_b64_tr_b16 v[124:125], v7 offset:20480
v_mfma_f32_16x16x32_bf16 v[204:207], v[76:79], v[36:39], v[204:207]
ds_read_b64_tr_b16 v[126:127], v7 offset:20992
v_mfma_f32_16x16x32_bf16 v[168:171], v[72:75], v[36:39], v[168:171]
ds_read_b64_tr_b16 v[116:117], v7 offset:4096
v_mfma_f32_16x16x32_bf16 v[172:175], v[72:75], v[40:43], v[172:175]
ds_read_b64_tr_b16 v[118:119], v7 offset:4608
v_mfma_f32_16x16x32_bf16 v[208:211], v[76:79], v[40:43], v[208:211]
ds_read_b128 v[84:87], v3 offset:45056
v_mfma_f32_16x16x32_bf16 v[136:139], v[68:71], v[40:43], v[136:139]
ds_read_b128 v[88:91], v3 offset:47104
v_mfma_f32_16x16x32_bf16 v[140:143], v[68:71], v[44:47], v[140:143]
ds_read_b128 v[92:95], v3 offset:49152
v_mfma_f32_16x16x32_bf16 v[212:215], v[76:79], v[44:47], v[212:215]
ds_read_b128 v[96:99], v3 offset:51200
v_mfma_f32_16x16x32_bf16 v[176:179], v[72:75], v[44:47], v[176:179]
ds_read_b128 v[100:103], v3 offset:53248
v_mfma_f32_16x16x32_bf16 v[180:183], v[72:75], v[48:51], v[180:183]
ds_read_b128 v[104:107], v3 offset:55296
v_mfma_f32_16x16x32_bf16 v[216:219], v[76:79], v[48:51], v[216:219]
ds_read_b128 v[108:111], v3 offset:57344
v_mfma_f32_16x16x32_bf16 v[144:147], v[68:71], v[48:51], v[144:147]
ds_read_b128 v[112:115], v3 offset:59392
v_mfma_f32_16x16x32_bf16 v[148:151], v[68:71], v[52:55], v[148:151]
v_mfma_f32_16x16x32_bf16 v[220:223], v[76:79], v[52:55], v[220:223]
v_mfma_f32_16x16x32_bf16 v[184:187], v[72:75], v[52:55], v[184:187]
v_mfma_f32_16x16x32_bf16 v[188:191], v[72:75], v[56:59], v[188:191]
v_mfma_f32_16x16x32_bf16 v[224:227], v[76:79], v[56:59], v[224:227]
v_mfma_f32_16x16x32_bf16 v[152:155], v[68:71], v[56:59], v[152:155]
v_mfma_f32_16x16x32_bf16 v[156:159], v[68:71], v[60:63], v[156:159]
v_mfma_f32_16x16x32_bf16 v[228:231], v[76:79], v[60:63], v[228:231]
v_mfma_f32_16x16x32_bf16 v[192:195], v[72:75], v[60:63], v[192:195]
v_mfma_f32_16x16x32_bf16 v[196:199], v[72:75], v[64:67], v[196:199]
v_mfma_f32_16x16x32_bf16 v[232:235], v[76:79], v[64:67], v[232:235]
v_mfma_f32_16x16x32_bf16 v[160:163], v[68:71], v[64:67], v[160:163]
s_waitcnt lgkmcnt(0)
s_barrier
v_mfma_f32_16x16x32_bf16 v[164:167], v[120:123], v[80:83], v[164:167]
ds_read_b128 v[32:35], v4 offset:0
v_mfma_f32_16x16x32_bf16 v[200:203], v[124:127], v[80:83], v[200:203]
ds_read_b64_tr_b16 v[72:73], v8 offset:8192
v_mfma_f32_16x16x32_bf16 v[128:131], v[116:119], v[80:83], v[128:131]
ds_read_b64_tr_b16 v[74:75], v8 offset:8704
v_mfma_f32_16x16x32_bf16 v[132:135], v[116:119], v[84:87], v[132:135]
ds_read_b64_tr_b16 v[76:77], v8 offset:16384
v_mfma_f32_16x16x32_bf16 v[204:207], v[124:127], v[84:87], v[204:207]
ds_read_b64_tr_b16 v[78:79], v8 offset:16896
v_mfma_f32_16x16x32_bf16 v[168:171], v[120:123], v[84:87], v[168:171]
ds_read_b64_tr_b16 v[68:69], v8 offset:0
v_mfma_f32_16x16x32_bf16 v[172:175], v[120:123], v[88:91], v[172:175]
ds_read_b64_tr_b16 v[70:71], v8 offset:512
v_mfma_f32_16x16x32_bf16 v[208:211], v[124:127], v[88:91], v[208:211]
ds_read_b128 v[36:39], v4 offset:2048
v_mfma_f32_16x16x32_bf16 v[136:139], v[116:119], v[88:91], v[136:139]
ds_read_b128 v[40:43], v4 offset:4096
v_mfma_f32_16x16x32_bf16 v[140:143], v[116:119], v[92:95], v[140:143]
ds_read_b128 v[44:47], v4 offset:6144
v_mfma_f32_16x16x32_bf16 v[212:215], v[124:127], v[92:95], v[212:215]
ds_read_b128 v[48:51], v4 offset:8192
v_mfma_f32_16x16x32_bf16 v[176:179], v[120:123], v[92:95], v[176:179]
ds_read_b128 v[52:55], v4 offset:10240
v_mfma_f32_16x16x32_bf16 v[180:183], v[120:123], v[96:99], v[180:183]
ds_read_b128 v[56:59], v4 offset:12288
v_mfma_f32_16x16x32_bf16 v[216:219], v[124:127], v[96:99], v[216:219]
ds_read_b128 v[60:63], v4 offset:14336
v_mfma_f32_16x16x32_bf16 v[144:147], v[116:119], v[96:99], v[144:147]
ds_read_b128 v[64:67], v4 offset:16384
v_mfma_f32_16x16x32_bf16 v[148:151], v[116:119], v[100:103], v[148:151]
v_mfma_f32_16x16x32_bf16 v[220:223], v[124:127], v[100:103], v[220:223]
v_mfma_f32_16x16x32_bf16 v[184:187], v[120:123], v[100:103], v[184:187]
v_mfma_f32_16x16x32_bf16 v[188:191], v[120:123], v[104:107], v[188:191]
v_mfma_f32_16x16x32_bf16 v[224:227], v[124:127], v[104:107], v[224:227]
v_mfma_f32_16x16x32_bf16 v[152:155], v[116:119], v[104:107], v[152:155]
v_mfma_f32_16x16x32_bf16 v[156:159], v[116:119], v[108:111], v[156:159]
v_mfma_f32_16x16x32_bf16 v[228:231], v[124:127], v[108:111], v[228:231]
v_mfma_f32_16x16x32_bf16 v[192:195], v[120:123], v[108:111], v[192:195]
v_mfma_f32_16x16x32_bf16 v[196:199], v[120:123], v[112:115], v[196:199]
v_mfma_f32_16x16x32_bf16 v[232:235], v[124:127], v[112:115], v[232:235]
v_mfma_f32_16x16x32_bf16 v[160:163], v[116:119], v[112:115], v[160:163]
s_waitcnt lgkmcnt(0)
v_mfma_f32_16x16x32_bf16 v[164:167], v[72:75], v[32:35], v[164:167]
ds_read_b128 v[80:83], v5 offset:0
v_mfma_f32_16x16x32_bf16 v[200:203], v[76:79], v[32:35], v[200:203]
ds_read_b64_tr_b16 v[120:121], v8 offset:12288
v_mfma_f32_16x16x32_bf16 v[128:131], v[68:71], v[32:35], v[128:131]
ds_read_b64_tr_b16 v[122:123], v8 offset:12800
v_mfma_f32_16x16x32_bf16 v[132:135], v[68:71], v[36:39], v[132:135]
ds_read_b64_tr_b16 v[124:125], v8 offset:20480
v_mfma_f32_16x16x32_bf16 v[204:207], v[76:79], v[36:39], v[204:207]
ds_read_b64_tr_b16 v[126:127], v8 offset:20992
v_mfma_f32_16x16x32_bf16 v[168:171], v[72:75], v[36:39], v[168:171]
ds_read_b64_tr_b16 v[116:117], v8 offset:4096
v_mfma_f32_16x16x32_bf16 v[172:175], v[72:75], v[40:43], v[172:175]
ds_read_b64_tr_b16 v[118:119], v8 offset:4608
v_mfma_f32_16x16x32_bf16 v[208:211], v[76:79], v[40:43], v[208:211]
ds_read_b128 v[84:87], v5 offset:2048
v_mfma_f32_16x16x32_bf16 v[136:139], v[68:71], v[40:43], v[136:139]
ds_read_b128 v[88:91], v5 offset:4096
v_mfma_f32_16x16x32_bf16 v[140:143], v[68:71], v[44:47], v[140:143]
ds_read_b128 v[92:95], v5 offset:6144
v_mfma_f32_16x16x32_bf16 v[212:215], v[76:79], v[44:47], v[212:215]
ds_read_b128 v[96:99], v5 offset:8192
v_mfma_f32_16x16x32_bf16 v[176:179], v[72:75], v[44:47], v[176:179]
ds_read_b128 v[100:103], v5 offset:10240
v_mfma_f32_16x16x32_bf16 v[180:183], v[72:75], v[48:51], v[180:183]
ds_read_b128 v[104:107], v5 offset:12288
v_mfma_f32_16x16x32_bf16 v[216:219], v[76:79], v[48:51], v[216:219]
ds_read_b128 v[108:111], v5 offset:14336
v_mfma_f32_16x16x32_bf16 v[144:147], v[68:71], v[48:51], v[144:147]
ds_read_b128 v[112:115], v5 offset:16384
v_mfma_f32_16x16x32_bf16 v[148:151], v[68:71], v[52:55], v[148:151]
v_mfma_f32_16x16x32_bf16 v[220:223], v[76:79], v[52:55], v[220:223]
v_mfma_f32_16x16x32_bf16 v[184:187], v[72:75], v[52:55], v[184:187]
v_mfma_f32_16x16x32_bf16 v[188:191], v[72:75], v[56:59], v[188:191]
v_mfma_f32_16x16x32_bf16 v[224:227], v[76:79], v[56:59], v[224:227]
v_mfma_f32_16x16x32_bf16 v[152:155], v[68:71], v[56:59], v[152:155]
v_mfma_f32_16x16x32_bf16 v[156:159], v[68:71], v[60:63], v[156:159]
v_mfma_f32_16x16x32_bf16 v[228:231], v[76:79], v[60:63], v[228:231]
v_mfma_f32_16x16x32_bf16 v[192:195], v[72:75], v[60:63], v[192:195]
v_mfma_f32_16x16x32_bf16 v[196:199], v[72:75], v[64:67], v[196:199]
v_mfma_f32_16x16x32_bf16 v[232:235], v[76:79], v[64:67], v[232:235]
v_mfma_f32_16x16x32_bf16 v[160:163], v[68:71], v[64:67], v[160:163]
s_waitcnt lgkmcnt(0)
s_barrier
v_mfma_f32_16x16x32_bf16 v[164:167], v[120:123], v[80:83], v[164:167]
ds_read_b128 v[32:35], v2 offset:0
v_mfma_f32_16x16x32_bf16 v[200:203], v[124:127], v[80:83], v[200:203]
ds_read_b64_tr_b16 v[72:73], v6 offset:8192
v_mfma_f32_16x16x32_bf16 v[128:131], v[116:119], v[80:83], v[128:131]
ds_read_b64_tr_b16 v[74:75], v6 offset:8704
v_mfma_f32_16x16x32_bf16 v[132:135], v[116:119], v[84:87], v[132:135]
ds_read_b64_tr_b16 v[76:77], v6 offset:16384
v_mfma_f32_16x16x32_bf16 v[204:207], v[124:127], v[84:87], v[204:207]
ds_read_b64_tr_b16 v[78:79], v6 offset:16896
v_mfma_f32_16x16x32_bf16 v[168:171], v[120:123], v[84:87], v[168:171]
ds_read_b64_tr_b16 v[68:69], v6 offset:0
v_mfma_f32_16x16x32_bf16 v[172:175], v[120:123], v[88:91], v[172:175]
ds_read_b64_tr_b16 v[70:71], v6 offset:512
v_mfma_f32_16x16x32_bf16 v[208:211], v[124:127], v[88:91], v[208:211]
ds_read_b128 v[36:39], v2 offset:2048
v_mfma_f32_16x16x32_bf16 v[136:139], v[116:119], v[88:91], v[136:139]
ds_read_b128 v[40:43], v2 offset:4096
v_mfma_f32_16x16x32_bf16 v[140:143], v[116:119], v[92:95], v[140:143]
ds_read_b128 v[44:47], v2 offset:6144
v_mfma_f32_16x16x32_bf16 v[212:215], v[124:127], v[92:95], v[212:215]
ds_read_b128 v[48:51], v2 offset:8192
v_mfma_f32_16x16x32_bf16 v[176:179], v[120:123], v[92:95], v[176:179]
ds_read_b128 v[52:55], v2 offset:10240
v_mfma_f32_16x16x32_bf16 v[180:183], v[120:123], v[96:99], v[180:183]
ds_read_b128 v[56:59], v2 offset:12288
v_mfma_f32_16x16x32_bf16 v[216:219], v[124:127], v[96:99], v[216:219]
ds_read_b128 v[60:63], v2 offset:14336
v_mfma_f32_16x16x32_bf16 v[144:147], v[116:119], v[96:99], v[144:147]
ds_read_b128 v[64:67], v2 offset:16384
v_mfma_f32_16x16x32_bf16 v[148:151], v[116:119], v[100:103], v[148:151]
v_mfma_f32_16x16x32_bf16 v[220:223], v[124:127], v[100:103], v[220:223]
v_mfma_f32_16x16x32_bf16 v[184:187], v[120:123], v[100:103], v[184:187]
v_mfma_f32_16x16x32_bf16 v[188:191], v[120:123], v[104:107], v[188:191]
v_mfma_f32_16x16x32_bf16 v[224:227], v[124:127], v[104:107], v[224:227]
v_mfma_f32_16x16x32_bf16 v[152:155], v[116:119], v[104:107], v[152:155]
v_mfma_f32_16x16x32_bf16 v[156:159], v[116:119], v[108:111], v[156:159]
v_mfma_f32_16x16x32_bf16 v[228:231], v[124:127], v[108:111], v[228:231]
v_mfma_f32_16x16x32_bf16 v[192:195], v[120:123], v[108:111], v[192:195]
v_mfma_f32_16x16x32_bf16 v[196:199], v[120:123], v[112:115], v[196:199]
v_mfma_f32_16x16x32_bf16 v[232:235], v[124:127], v[112:115], v[232:235]
v_mfma_f32_16x16x32_bf16 v[160:163], v[116:119], v[112:115], v[160:163]
s_sub_u32 s41, s41, 1
s_cmp_lg_u32 s41, 0
s_cbranch_scc1 Lcl_11
s_waitcnt lgkmcnt(0)
v_mfma_f32_16x16x32_bf16 v[164:167], v[72:75], v[32:35], v[164:167]
ds_read_b128 v[80:83], v3 offset:0
v_mfma_f32_16x16x32_bf16 v[200:203], v[76:79], v[32:35], v[200:203]
ds_read_b64_tr_b16 v[120:121], v6 offset:12288
v_mfma_f32_16x16x32_bf16 v[128:131], v[68:71], v[32:35], v[128:131]
ds_read_b64_tr_b16 v[122:123], v6 offset:12800
v_mfma_f32_16x16x32_bf16 v[132:135], v[68:71], v[36:39], v[132:135]
ds_read_b64_tr_b16 v[124:125], v6 offset:20480
v_mfma_f32_16x16x32_bf16 v[204:207], v[76:79], v[36:39], v[204:207]
ds_read_b64_tr_b16 v[126:127], v6 offset:20992
v_mfma_f32_16x16x32_bf16 v[168:171], v[72:75], v[36:39], v[168:171]
ds_read_b64_tr_b16 v[116:117], v6 offset:4096
v_mfma_f32_16x16x32_bf16 v[172:175], v[72:75], v[40:43], v[172:175]
ds_read_b64_tr_b16 v[118:119], v6 offset:4608
v_mfma_f32_16x16x32_bf16 v[208:211], v[76:79], v[40:43], v[208:211]
ds_read_b128 v[84:87], v3 offset:2048
v_mfma_f32_16x16x32_bf16 v[136:139], v[68:71], v[40:43], v[136:139]
ds_read_b128 v[88:91], v3 offset:4096
v_mfma_f32_16x16x32_bf16 v[140:143], v[68:71], v[44:47], v[140:143]
ds_read_b128 v[92:95], v3 offset:6144
v_mfma_f32_16x16x32_bf16 v[212:215], v[76:79], v[44:47], v[212:215]
ds_read_b128 v[96:99], v3 offset:8192
v_mfma_f32_16x16x32_bf16 v[176:179], v[72:75], v[44:47], v[176:179]
ds_read_b128 v[100:103], v3 offset:10240
v_mfma_f32_16x16x32_bf16 v[180:183], v[72:75], v[48:51], v[180:183]
ds_read_b128 v[104:107], v3 offset:12288
v_mfma_f32_16x16x32_bf16 v[216:219], v[76:79], v[48:51], v[216:219]
ds_read_b128 v[108:111], v3 offset:14336
v_mfma_f32_16x16x32_bf16 v[144:147], v[68:71], v[48:51], v[144:147]
ds_read_b128 v[112:115], v3 offset:16384
v_mfma_f32_16x16x32_bf16 v[148:151], v[68:71], v[52:55], v[148:151]
v_mfma_f32_16x16x32_bf16 v[220:223], v[76:79], v[52:55], v[220:223]
v_mfma_f32_16x16x32_bf16 v[184:187], v[72:75], v[52:55], v[184:187]
v_mfma_f32_16x16x32_bf16 v[188:191], v[72:75], v[56:59], v[188:191]
v_mfma_f32_16x16x32_bf16 v[224:227], v[76:79], v[56:59], v[224:227]
v_mfma_f32_16x16x32_bf16 v[152:155], v[68:71], v[56:59], v[152:155]
v_mfma_f32_16x16x32_bf16 v[156:159], v[68:71], v[60:63], v[156:159]
v_mfma_f32_16x16x32_bf16 v[228:231], v[76:79], v[60:63], v[228:231]
v_mfma_f32_16x16x32_bf16 v[192:195], v[72:75], v[60:63], v[192:195]
v_mfma_f32_16x16x32_bf16 v[196:199], v[72:75], v[64:67], v[196:199]
v_mfma_f32_16x16x32_bf16 v[232:235], v[76:79], v[64:67], v[232:235]
v_mfma_f32_16x16x32_bf16 v[160:163], v[68:71], v[64:67], v[160:163]
s_branch Lov_0
.p2align 12
Lst_0_0:
s_branch Lst_4_0
s_nop 0
Lov_0:
s_waitcnt lgkmcnt(0)
v_mfma_f32_16x16x32_bf16 v[164:167], v[120:123], v[80:83], v[164:167]
v_mfma_f32_16x16x32_bf16 v[200:203], v[124:127], v[80:83], v[200:203]
v_mfma_f32_16x16x32_bf16 v[128:131], v[116:119], v[80:83], v[128:131]
v_mfma_f32_16x16x32_bf16 v[132:135], v[116:119], v[84:87], v[132:135]
v_mfma_f32_16x16x32_bf16 v[204:207], v[124:127], v[84:87], v[204:207]
v_mfma_f32_16x16x32_bf16 v[168:171], v[120:123], v[84:87], v[168:171]
v_mfma_f32_16x16x32_bf16 v[172:175], v[120:123], v[88:91], v[172:175]
v_mfma_f32_16x16x32_bf16 v[208:211], v[124:127], v[88:91], v[208:211]
v_mfma_f32_16x16x32_bf16 v[136:139], v[116:119], v[88:91], v[136:139]
v_mfma_f32_16x16x32_bf16 v[140:143], v[116:119], v[92:95], v[140:143]
v_mfma_f32_16x16x32_bf16 v[212:215], v[124:127], v[92:95], v[212:215]
v_mfma_f32_16x16x32_bf16 v[176:179], v[120:123], v[92:95], v[176:179]
v_mfma_f32_16x16x32_bf16 v[180:183], v[120:123], v[96:99], v[180:183]
v_mfma_f32_16x16x32_bf16 v[216:219], v[124:127], v[96:99], v[216:219]
v_mfma_f32_16x16x32_bf16 v[144:147], v[116:119], v[96:99], v[144:147]
v_mfma_f32_16x16x32_bf16 v[148:151], v[116:119], v[100:103], v[148:151]
v_mfma_f32_16x16x32_bf16 v[220:223], v[124:127], v[100:103], v[220:223]
v_mfma_f32_16x16x32_bf16 v[184:187], v[120:123], v[100:103], v[184:187]
v_mfma_f32_16x16x32_bf16 v[188:191], v[120:123], v[104:107], v[188:191]
v_mfma_f32_16x16x32_bf16 v[224:227], v[124:127], v[104:107], v[224:227]
v_mfma_f32_16x16x32_bf16 v[152:155], v[116:119], v[104:107], v[152:155]
v_mfma_f32_16x16x32_bf16 v[156:159], v[116:119], v[108:111], v[156:159]
v_mfma_f32_16x16x32_bf16 v[228:231], v[124:127], v[108:111], v[228:231]
v_mfma_f32_16x16x32_bf16 v[192:195], v[120:123], v[108:111], v[192:195]
v_mfma_f32_16x16x32_bf16 v[196:199], v[120:123], v[112:115], v[196:199]
v_mfma_f32_16x16x32_bf16 v[232:235], v[124:127], v[112:115], v[232:235]
v_mfma_f32_16x16x32_bf16 v[160:163], v[116:119], v[112:115], v[160:163]
v_lshlrev_b32 v14, 3, v12
v_add_u32 v14, 147456, v14
v_mul_u32_u24 v15, 400, v12
v_lshl_add_u32 v15, v13, 3, v15
s_lshl_b32 s43, s36, 5
v_add_u32 v15, s43, v15
s_barrier
ds_read_b64 v[32:33], v14 offset:0
ds_read_b64 v[34:35], v14 offset:128
ds_read_b64 v[36:37], v14 offset:256
ds_read_b64 v[38:39], v14 offset:384
ds_read_b64 v[40:41], v14 offset:512
ds_read_b64 v[42:43], v14 offset:640
ds_read_b64 v[44:45], v14 offset:768
ds_read_b64 v[46:47], v14 offset:896
ds_read_b64 v[48:49], v14 offset:1024
v_mov_b32_dpp v52, v128 row_newbcast:0 row_mask:0xf bank_mask:0xf
v_mov_b32_dpp v53, v129 row_newbcast:0 row_mask:0xf bank_mask:0xf
v_mov_b32_dpp v54, v130 row_newbcast:0 row_mask:0xf bank_mask:0xf
v_mov_b32_dpp v55, v131 row_newbcast:0 row_mask:0xf bank_mask:0xf
v_mov_b32_dpp v56, v164 row_newbcast:0 row_mask:0xf bank_mask:0xf
v_mov_b32_dpp v57, v165 row_newbcast:0 row_mask:0xf bank_mask:0xf
v_mov_b32_dpp v58, v166 row_newbcast:0 row_mask:0xf bank_mask:0xf
v_mov_b32_dpp v59, v167 row_newbcast:0 row_mask:0xf bank_mask:0xf
v_mov_b32_dpp v60, v200 row_newbcast:0 row_mask:0xf bank_mask:0xf
v_mov_b32_dpp v61, v201 row_newbcast:0 row_mask:0xf bank_mask:0xf
v_mov_b32_dpp v62, v202 row_newbcast:0 row_mask:0xf bank_mask:0xf
v_mov_b32_dpp v63, v203 row_newbcast:0 row_mask:0xf bank_mask:0xf
s_waitcnt lgkmcnt(0)
v_pk_fma_f32 v[164:165], v[32:33], v[56:57], v[164:165] op_sel_hi:[0,1,1] neg_lo:[1,0,0] neg_hi:[1,0,0]
v_pk_fma_f32 v[166:167], v[32:33], v[58:59], v[166:167] op_sel_hi:[0,1,1] neg_lo:[1,0,0] neg_hi:[1,0,0]
v_pk_fma_f32 v[200:201], v[32:33], v[60:61], v[200:201] op_sel_hi:[0,1,1] neg_lo:[1,0,0] neg_hi:[1,0,0]
v_pk_fma_f32 v[202:203], v[32:33], v[62:63], v[202:203] op_sel_hi:[0,1,1] neg_lo:[1,0,0] neg_hi:[1,0,0]
v_pk_mul_f32 v[164:165], v[32:33], v[164:165] op_sel:[1,0] op_sel_hi:[1,1]
v_pk_mul_f32 v[166:167], v[32:33], v[166:167] op_sel:[1,0] op_sel_hi:[1,1]
v_pk_fma_f32 v[132:133], v[34:35], v[52:53], v[132:133] op_sel_hi:[0,1,1] neg_lo:[1,0,0] neg_hi:[1,0,0]
v_pk_fma_f32 v[134:135], v[34:35], v[54:55], v[134:135] op_sel_hi:[0,1,1] neg_lo:[1,0,0] neg_hi:[1,0,0]
v_pk_mul_f32 v[200:201], v[32:33], v[200:201] op_sel:[1,0] op_sel_hi:[1,1]
v_pk_mul_f32 v[202:203], v[32:33], v[202:203] op_sel:[1,0] op_sel_hi:[1,1]
v_cvt_pk_bf16_f32 v164, v164, v165
v_cvt_pk_bf16_f32 v165, v166, v167
ds_write_b64 v15, v[164:165] offset:128
v_pk_fma_f32 v[168:169], v[34:35], v[56:57], v[168:169] op_sel_hi:[0,1,1] neg_lo:[1,0,0] neg_hi:[1,0,0]
v_pk_fma_f32 v[170:171], v[34:35], v[58:59], v[170:171] op_sel_hi:[0,1,1] neg_lo:[1,0,0] neg_hi:[1,0,0]
v_pk_mul_f32 v[132:133], v[34:35], v[132:133] op_sel:[1,0] op_sel_hi:[1,1]
v_pk_mul_f32 v[134:135], v[34:35], v[134:135] op_sel:[1,0] op_sel_hi:[1,1]
v_cvt_pk_bf16_f32 v200, v200, v201
v_cvt_pk_bf16_f32 v201, v202, v203
ds_write_b64 v15, v[200:201] offset:256
v_pk_fma_f32 v[204:205], v[34:35], v[60:61], v[204:205] op_sel_hi:[0,1,1] neg_lo:[1,0,0] neg_hi:[1,0,0]
v_pk_fma_f32 v[206:207], v[34:35], v[62:63], v[206:207] op_sel_hi:[0,1,1] neg_lo:[1,0,0] neg_hi:[1,0,0]
v_pk_mul_f32 v[168:169], v[34:35], v[168:169] op_sel:[1,0] op_sel_hi:[1,1]
v_pk_mul_f32 v[170:171], v[34:35], v[170:171] op_sel:[1,0] op_sel_hi:[1,1]
v_cvt_pk_bf16_f32 v132, v132, v133
v_cvt_pk_bf16_f32 v133, v134, v135
ds_write_b64 v15, v[132:133] offset:6400
v_pk_fma_f32 v[136:137], v[36:37], v[52:53], v[136:137] op_sel_hi:[0,1,1] neg_lo:[1,0,0] neg_hi:[1,0,0]
v_pk_fma_f32 v[138:139], v[36:37], v[54:55], v[138:139] op_sel_hi:[0,1,1] neg_lo:[1,0,0] neg_hi:[1,0,0]
v_pk_mul_f32 v[204:205], v[34:35], v[204:205] op_sel:[1,0] op_sel_hi:[1,1]
v_pk_mul_f32 v[206:207], v[34:35], v[206:207] op_sel:[1,0] op_sel_hi:[1,1]
v_cvt_pk_bf16_f32 v168, v168, v169
v_cvt_pk_bf16_f32 v169, v170, v171
ds_write_b64 v15, v[168:169] offset:6528
v_pk_fma_f32 v[172:173], v[36:37], v[56:57], v[172:173] op_sel_hi:[0,1,1] neg_lo:[1,0,0] neg_hi:[1,0,0]
v_pk_fma_f32 v[174:175], v[36:37], v[58:59], v[174:175] op_sel_hi:[0,1,1] neg_lo:[1,0,0] neg_hi:[1,0,0]
v_pk_mul_f32 v[136:137], v[36:37], v[136:137] op_sel:[1,0] op_sel_hi:[1,1]
v_pk_mul_f32 v[138:139], v[36:37], v[138:139] op_sel:[1,0] op_sel_hi:[1,1]
v_cvt_pk_bf16_f32 v204, v204, v205
v_cvt_pk_bf16_f32 v205, v206, v207
ds_write_b64 v15, v[204:205] offset:6656
v_pk_fma_f32 v[208:209], v[36:37], v[60:61], v[208:209] op_sel_hi:[0,1,1] neg_lo:[1,0,0] neg_hi:[1,0,0]
v_pk_fma_f32 v[210:211], v[36:37], v[62:63], v[210:211] op_sel_hi:[0,1,1] neg_lo:[1,0,0] neg_hi:[1,0,0]
v_pk_mul_f32 v[172:173], v[36:37], v[172:173] op_sel:[1,0] op_sel_hi:[1,1]
v_pk_mul_f32 v[174:175], v[36:37], v[174:175] op_sel:[1,0] op_sel_hi:[1,1]
v_cvt_pk_bf16_f32 v136, v136, v137
v_cvt_pk_bf16_f32 v137, v138, v139
ds_write_b64 v15, v[136:137] offset:12800
v_pk_fma_f32 v[140:141], v[38:39], v[52:53], v[140:141] op_sel_hi:[0,1,1] neg_lo:[1,0,0] neg_hi:[1,0,0]
v_pk_fma_f32 v[142:143], v[38:39], v[54:55], v[142:143] op_sel_hi:[0,1,1] neg_lo:[1,0,0] neg_hi:[1,0,0]
v_pk_mul_f32 v[208:209], v[36:37], v[208:209] op_sel:[1,0] op_sel_hi:[1,1]
v_pk_mul_f32 v[210:211], v[36:37], v[210:211] op_sel:[1,0] op_sel_hi:[1,1]
v_cvt_pk_bf16_f32 v172, v172, v173
v_cvt_pk_bf16_f32 v173, v174, v175
ds_write_b64 v15, v[172:173] offset:12928
v_pk_fma_f32 v[176:177], v[38:39], v[56:57], v[176:177] op_sel_hi:[0,1,1] neg_lo:[1,0,0] neg_hi:[1,0,0]
v_pk_fma_f32 v[178:179], v[38:39], v[58:59], v[178:179] op_sel_hi:[0,1,1] neg_lo:[1,0,0] neg_hi:[1,0,0]
v_pk_mul_f32 v[140:141], v[38:39], v[140:141] op_sel:[1,0] op_sel_hi:[1,1]
v_pk_mul_f32 v[142:143], v[38:39], v[142:143] op_sel:[1,0] op_sel_hi:[1,1]
v_cvt_pk_bf16_f32 v208, v208, v209
v_cvt_pk_bf16_f32 v209, v210, v211
ds_write_b64 v15, v[208:209] offset:13056
v_pk_fma_f32 v[212:213], v[38:39], v[60:61], v[212:213] op_sel_hi:[0,1,1] neg_lo:[1,0,0] neg_hi:[1,0,0]
v_pk_fma_f32 v[214:215], v[38:39], v[62:63], v[214:215] op_sel_hi:[0,1,1] neg_lo:[1,0,0] neg_hi:[1,0,0]
v_pk_mul_f32 v[176:177], v[38:39], v[176:177] op_sel:[1,0] op_sel_hi:[1,1]
v_pk_mul_f32 v[178:179], v[38:39], v[178:179] op_sel:[1,0] op_sel_hi:[1,1]
v_cvt_pk_bf16_f32 v140, v140, v141
v_cvt_pk_bf16_f32 v141, v142, v143
ds_write_b64 v15, v[140:141] offset:19200
v_pk_fma_f32 v[144:145], v[40:41], v[52:53], v[144:145] op_sel_hi:[0,1,1] neg_lo:[1,0,0] neg_hi:[1,0,0]
v_pk_fma_f32 v[146:147], v[40:41], v[54:55], v[146:147] op_sel_hi:[0,1,1] neg_lo:[1,0,0] neg_hi:[1,0,0]
v_pk_mul_f32 v[212:213], v[38:39], v[212:213] op_sel:[1,0] op_sel_hi:[1,1]
v_pk_mul_f32 v[214:215], v[38:39], v[214:215] op_sel:[1,0] op_sel_hi:[1,1]
v_cvt_pk_bf16_f32 v176, v176, v177
v_cvt_pk_bf16_f32 v177, v178, v179
ds_write_b64 v15, v[176:177] offset:19328
v_pk_fma_f32 v[180:181], v[40:41], v[56:57], v[180:181] op_sel_hi:[0,1,1] neg_lo:[1,0,0] neg_hi:[1,0,0]
v_pk_fma_f32 v[182:183], v[40:41], v[58:59], v[182:183] op_sel_hi:[0,1,1] neg_lo:[1,0,0] neg_hi:[1,0,0]
v_pk_mul_f32 v[144:145], v[40:41], v[144:145] op_sel:[1,0] op_sel_hi:[1,1]
v_pk_mul_f32 v[146:147], v[40:41], v[146:147] op_sel:[1,0] op_sel_hi:[1,1]
v_cvt_pk_bf16_f32 v212, v212, v213
v_cvt_pk_bf16_f32 v213, v214, v215
ds_write_b64 v15, v[212:213] offset:19456
v_pk_fma_f32 v[216:217], v[40:41], v[60:61], v[216:217] op_sel_hi:[0,1,1] neg_lo:[1,0,0] neg_hi:[1,0,0]
v_pk_fma_f32 v[218:219], v[40:41], v[62:63], v[218:219] op_sel_hi:[0,1,1] neg_lo:[1,0,0] neg_hi:[1,0,0]
v_pk_mul_f32 v[180:181], v[40:41], v[180:181] op_sel:[1,0] op_sel_hi:[1,1]
v_pk_mul_f32 v[182:183], v[40:41], v[182:183] op_sel:[1,0] op_sel_hi:[1,1]
v_cvt_pk_bf16_f32 v144, v144, v145
v_cvt_pk_bf16_f32 v145, v146, v147
ds_write_b64 v15, v[144:145] offset:25600
v_pk_fma_f32 v[148:149], v[42:43], v[52:53], v[148:149] op_sel_hi:[0,1,1] neg_lo:[1,0,0] neg_hi:[1,0,0]
v_pk_fma_f32 v[150:151], v[42:43], v[54:55], v[150:151] op_sel_hi:[0,1,1] neg_lo:[1,0,0] neg_hi:[1,0,0]
v_pk_mul_f32 v[216:217], v[40:41], v[216:217] op_sel:[1,0] op_sel_hi:[1,1]
v_pk_mul_f32 v[218:219], v[40:41], v[218:219] op_sel:[1,0] op_sel_hi:[1,1]
v_cvt_pk_bf16_f32 v180, v180, v181
v_cvt_pk_bf16_f32 v181, v182, v183
ds_write_b64 v15, v[180:181] offset:25728
v_pk_fma_f32 v[184:185], v[42:43], v[56:57], v[184:185] op_sel_hi:[0,1,1] neg_lo:[1,0,0] neg_hi:[1,0,0]
v_pk_fma_f32 v[186:187], v[42:43], v[58:59], v[186:187] op_sel_hi:[0,1,1] neg_lo:[1,0,0] neg_hi:[1,0,0]
v_pk_mul_f32 v[148:149], v[42:43], v[148:149] op_sel:[1,0] op_sel_hi:[1,1]
v_pk_mul_f32 v[150:151], v[42:43], v[150:151] op_sel:[1,0] op_sel_hi:[1,1]
v_cvt_pk_bf16_f32 v216, v216, v217
v_cvt_pk_bf16_f32 v217, v218, v219
ds_write_b64 v15, v[216:217] offset:25856
v_pk_fma_f32 v[220:221], v[42:43], v[60:61], v[220:221] op_sel_hi:[0,1,1] neg_lo:[1,0,0] neg_hi:[1,0,0]
v_pk_fma_f32 v[222:223], v[42:43], v[62:63], v[222:223] op_sel_hi:[0,1,1] neg_lo:[1,0,0] neg_hi:[1,0,0]
v_pk_mul_f32 v[184:185], v[42:43], v[184:185] op_sel:[1,0] op_sel_hi:[1,1]
v_pk_mul_f32 v[186:187], v[42:43], v[186:187] op_sel:[1,0] op_sel_hi:[1,1]
v_cvt_pk_bf16_f32 v148, v148, v149
v_cvt_pk_bf16_f32 v149, v150, v151
ds_write_b64 v15, v[148:149] offset:32000
v_pk_fma_f32 v[152:153], v[44:45], v[52:53], v[152:153] op_sel_hi:[0,1,1] neg_lo:[1,0,0] neg_hi:[1,0,0]
v_pk_fma_f32 v[154:155], v[44:45], v[54:55], v[154:155] op_sel_hi:[0,1,1] neg_lo:[1,0,0] neg_hi:[1,0,0]
v_pk_mul_f32 v[220:221], v[42:43], v[220:221] op_sel:[1,0] op_sel_hi:[1,1]
v_pk_mul_f32 v[222:223], v[42:43], v[222:223] op_sel:[1,0] op_sel_hi:[1,1]
v_cvt_pk_bf16_f32 v184, v184, v185
v_cvt_pk_bf16_f32 v185, v186, v187
ds_write_b64 v15, v[184:185] offset:32128
v_pk_fma_f32 v[188:189], v[44:45], v[56:57], v[188:189] op_sel_hi:[0,1,1] neg_lo:[1,0,0] neg_hi:[1,0,0]
v_pk_fma_f32 v[190:191], v[44:45], v[58:59], v[190:191] op_sel_hi:[0,1,1] neg_lo:[1,0,0] neg_hi:[1,0,0]
v_pk_mul_f32 v[152:153], v[44:45], v[152:153] op_sel:[1,0] op_sel_hi:[1,1]
v_pk_mul_f32 v[154:155], v[44:45], v[154:155] op_sel:[1,0] op_sel_hi:[1,1]
v_cvt_pk_bf16_f32 v220, v220, v221
v_cvt_pk_bf16_f32 v221, v222, v223
ds_write_b64 v15, v[220:221] offset:32256
v_pk_fma_f32 v[224:225], v[44:45], v[60:61], v[224:225] op_sel_hi:[0,1,1] neg_lo:[1,0,0] neg_hi:[1,0,0]
v_pk_fma_f32 v[226:227], v[44:45], v[62:63], v[226:227] op_sel_hi:[0,1,1] neg_lo:[1,0,0] neg_hi:[1,0,0]
v_pk_mul_f32 v[188:189], v[44:45], v[188:189] op_sel:[1,0] op_sel_hi:[1,1]
v_pk_mul_f32 v[190:191], v[44:45], v[190:191] op_sel:[1,0] op_sel_hi:[1,1]
v_cvt_pk_bf16_f32 v152, v152, v153
v_cvt_pk_bf16_f32 v153, v154, v155
ds_write_b64 v15, v[152:153] offset:38400
v_pk_fma_f32 v[156:157], v[46:47], v[52:53], v[156:157] op_sel_hi:[0,1,1] neg_lo:[1,0,0] neg_hi:[1,0,0]
v_pk_fma_f32 v[158:159], v[46:47], v[54:55], v[158:159] op_sel_hi:[0,1,1] neg_lo:[1,0,0] neg_hi:[1,0,0]
v_pk_mul_f32 v[224:225], v[44:45], v[224:225] op_sel:[1,0] op_sel_hi:[1,1]
v_pk_mul_f32 v[226:227], v[44:45], v[226:227] op_sel:[1,0] op_sel_hi:[1,1]
v_cvt_pk_bf16_f32 v188, v188, v189
v_cvt_pk_bf16_f32 v189, v190, v191
ds_write_b64 v15, v[188:189] offset:38528
v_pk_fma_f32 v[192:193], v[46:47], v[56:57], v[192:193] op_sel_hi:[0,1,1] neg_lo:[1,0,0] neg_hi:[1,0,0]
v_pk_fma_f32 v[194:195], v[46:47], v[58:59], v[194:195] op_sel_hi:[0,1,1] neg_lo:[1,0,0] neg_hi:[1,0,0]
v_pk_mul_f32 v[156:157], v[46:47], v[156:157] op_sel:[1,0] op_sel_hi:[1,1]
v_pk_mul_f32 v[158:159], v[46:47], v[158:159] op_sel:[1,0] op_sel_hi:[1,1]
v_cvt_pk_bf16_f32 v224, v224, v225
v_cvt_pk_bf16_f32 v225, v226, v227
ds_write_b64 v15, v[224:225] offset:38656
v_pk_fma_f32 v[228:229], v[46:47], v[60:61], v[228:229] op_sel_hi:[0,1,1] neg_lo:[1,0,0] neg_hi:[1,0,0]
v_pk_fma_f32 v[230:231], v[46:47], v[62:63], v[230:231] op_sel_hi:[0,1,1] neg_lo:[1,0,0] neg_hi:[1,0,0]
v_pk_mul_f32 v[192:193], v[46:47], v[192:193] op_sel:[1,0] op_sel_hi:[1,1]
v_pk_mul_f32 v[194:195], v[46:47], v[194:195] op_sel:[1,0] op_sel_hi:[1,1]
v_cvt_pk_bf16_f32 v156, v156, v157
v_cvt_pk_bf16_f32 v157, v158, v159
ds_write_b64 v15, v[156:157] offset:44800
v_pk_fma_f32 v[160:161], v[48:49], v[52:53], v[160:161] op_sel_hi:[0,1,1] neg_lo:[1,0,0] neg_hi:[1,0,0]
v_pk_fma_f32 v[162:163], v[48:49], v[54:55], v[162:163] op_sel_hi:[0,1,1] neg_lo:[1,0,0] neg_hi:[1,0,0]
v_pk_mul_f32 v[228:229], v[46:47], v[228:229] op_sel:[1,0] op_sel_hi:[1,1]
v_pk_mul_f32 v[230:231], v[46:47], v[230:231] op_sel:[1,0] op_sel_hi:[1,1]
v_cvt_pk_bf16_f32 v192, v192, v193
v_cvt_pk_bf16_f32 v193, v194, v195
ds_write_b64 v15, v[192:193] offset:44928
v_pk_fma_f32 v[196:197], v[48:49], v[56:57], v[196:197] op_sel_hi:[0,1,1] neg_lo:[1,0,0] neg_hi:[1,0,0]
v_pk_fma_f32 v[198:199], v[48:49], v[58:59], v[198:199] op_sel_hi:[0,1,1] neg_lo:[1,0,0] neg_hi:[1,0,0]
v_pk_mul_f32 v[160:161], v[48:49], v[160:161] op_sel:[1,0] op_sel_hi:[1,1]
v_pk_mul_f32 v[162:163], v[48:49], v[162:163] op_sel:[1,0] op_sel_hi:[1,1]
v_cvt_pk_bf16_f32 v228, v228, v229
v_cvt_pk_bf16_f32 v229, v230, v231
ds_write_b64 v15, v[228:229] offset:45056
v_pk_fma_f32 v[232:233], v[48:49], v[60:61], v[232:233] op_sel_hi:[0,1,1] neg_lo:[1,0,0] neg_hi:[1,0,0]
v_pk_fma_f32 v[234:235], v[48:49], v[62:63], v[234:235] op_sel_hi:[0,1,1] neg_lo:[1,0,0] neg_hi:[1,0,0]
v_pk_mul_f32 v[196:197], v[48:49], v[196:197] op_sel:[1,0] op_sel_hi:[1,1]
v_pk_mul_f32 v[198:199], v[48:49], v[198:199] op_sel:[1,0] op_sel_hi:[1,1]
v_cvt_pk_bf16_f32 v160, v160, v161
v_cvt_pk_bf16_f32 v161, v162, v163
ds_write_b64 v15, v[160:161] offset:51200
v_pk_mul_f32 v[232:233], v[48:49], v[232:233] op_sel:[1,0] op_sel_hi:[1,1]
v_pk_mul_f32 v[234:235], v[48:49], v[234:235] op_sel:[1,0] op_sel_hi:[1,1]
v_cvt_pk_bf16_f32 v196, v196, v197
v_cvt_pk_bf16_f32 v197, v198, v199
ds_write_b64 v15, v[196:197] offset:51328
v_cvt_pk_bf16_f32 v232, v232, v233
v_cvt_pk_bf16_f32 v233, v234, v235
ds_write_b64 v15, v[232:233] offset:51456
s_waitcnt lgkmcnt(0)
s_branch Latt_5
Lprod_3:
s_sub_u32 s47, s36, 4
s_lshl_b32 s43, s34, 7
s_lshl_b32 s44, s35, 3
s_add_u32 s63, s43, s44
s_lshl_b32 s44, s47, 1
s_add_u32 s51, s63, s44
v_lshlrev_b32 v10, 4, v1
s_cmp_eq_u32 s47, 3
s_cbranch_scc1 Lpf_4
v_lshrrev_b32 v14, 3, v1
v_and_b32 v15, 7, v1
v_and_b32 v16, 2, v14
v_xor_b32 v16, v15, v16
v_lshlrev_b32 v16, 4, v16
v_mul_u32_u24 v17, 6144, v14
s_lshl_b32 s43, s47, 11
v_add3_u32 v2, v17, v16, s43
v_xor_b32 v3, 64, v2
v_lshrrev_b32 v16, 1, v14
v_xor_b32 v16, v15, v16
v_lshlrev_b32 v16, 4, v16
s_lshl_b32 s43, s47, 3
s_add_u32 s43, s43, s50
v_add_u32 v17, s43, v14
s_and_b32 s44, s47, 1
s_lshl_b32 s44, s44, 6
v_add_u32 v18, 0, v17
v_max_i32 v18, 0, v18
v_lshl_add_u32 v18, v18, 11, v16
v_xor_b32 v18, s44, v18
v_mov_b32 v4, v18
v_add_u32 v18, 24, v17
v_max_i32 v18, 0, v18
v_lshl_add_u32 v18, v18, 11, v16
v_xor_b32 v18, s44, v18
v_xor_b32 v5, 64, v18
v_add_u32 v18, 48, v17
v_max_i32 v18, 0, v18
v_lshl_add_u32 v18, v18, 11, v16
v_xor_b32 v18, s44, v18
v_mov_b32 v6, v18
v_add_u32 v18, 72, v17
v_max_i32 v18, 0, v18
v_lshl_add_u32 v18, v18, 11, v16
v_xor_b32 v18, s44, v18
v_xor_b32 v7, 64, v18
v_add_u32 v18, 96, v17
v_max_i32 v18, 0, v18
v_lshl_add_u32 v18, v18, 11, v16
v_xor_b32 v18, s44, v18
v_mov_b32 v8, v18
v_add_u32 v18, 120, v17
v_max_i32 v18, 0, v18
v_lshl_add_u32 v18, v18, 11, v16
v_xor_b32 v18, s44, v18
v_xor_b32 v9, 64, v18
s_lshl_b32 s39, s47, 10
s_lshl_b32 s40, s47, 13
s_add_u32 s40, s40, 18432
s_mov_b32 s37, 0
s_mov_b32 s38, 0
s_bfm_b64 s[60:61], 56, 8
s_cmp_eq_u32 s47, 0
s_cselect_b64 s[60:61], s[60:61], -1
s_add_u32 m0, s39, 0
s_mov_b64 exec, s[60:61]
buffer_load_dwordx4 v4, s[8:11], s37 offen lds
s_mov_b64 exec, -1
s_add_u32 m0, s39, 3072
s_nop 0
buffer_load_dwordx4 v5, s[8:11], s37 offen lds
s_add_u32 m0, s39, 6144
s_nop 0
buffer_load_dwordx4 v6, s[8:11], s37 offen lds
s_add_u32 m0, s39, 9216
s_nop 0
buffer_load_dwordx4 v7, s[8:11], s37 offen lds
s_add_u32 m0, s39, 12288
s_nop 0
buffer_load_dwordx4 v8, s[8:11], s37 offen lds
s_add_u32 m0, s39, 15360
s_nop 0
buffer_load_dwordx4 v9, s[8:11], s37 offen lds
s_add_u32 m0, s40, 0
s_add_u32 s43, s38, 0
buffer_load_dwordx4 v2, s[12:15], s43 offen lds
s_add_u32 m0, s40, 1024
s_add_u32 s43, s38, 49152
buffer_load_dwordx4 v3, s[12:15], s43 offen lds
s_add_u32 m0, s40, 2048
s_add_u32 s43, s38, 98304
buffer_load_dwordx4 v2, s[12:15], s43 offen lds
s_add_u32 m0, s40, 3072
s_add_u32 s43, s38, 147456
buffer_load_dwordx4 v3, s[12:15], s43 offen lds
s_add_u32 m0, s40, 4096
s_add_u32 s43, s38, 196608
buffer_load_dwordx4 v2, s[12:15], s43 offen lds
s_add_u32 m0, s40, 5120
s_add_u32 s43, s38, 245760
buffer_load_dwordx4 v3, s[12:15], s43 offen lds
s_add_u32 m0, s40, 6144
s_add_u32 s43, s38, 294912
buffer_load_dwordx4 v2, s[12:15], s43 offen lds
s_add_u32 m0, s40, 7168
s_add_u32 s43, s38, 344064
buffer_load_dwordx4 v3, s[12:15], s43 offen lds
s_add_u32 s37, s37, 128
s_add_u32 s38, s38, 393216
s_add_u32 m0, s39, 43008
s_mov_b64 exec, s[60:61]
buffer_load_dwordx4 v4, s[8:11], s37 offen lds
s_mov_b64 exec, -1
s_add_u32 m0, s39, 46080
s_nop 0
buffer_load_dwordx4 v5, s[8:11], s37 offen lds
s_add_u32 m0, s39, 49152
s_nop 0
buffer_load_dwordx4 v6, s[8:11], s37 offen lds
s_add_u32 m0, s39, 52224
s_nop 0
buffer_load_dwordx4 v7, s[8:11], s37 offen lds
s_add_u32 m0, s39, 55296
s_nop 0
buffer_load_dwordx4 v8, s[8:11], s37 offen lds
s_add_u32 m0, s39, 58368
s_nop 0
buffer_load_dwordx4 v9, s[8:11], s37 offen lds
s_add_u32 m0, s40, 43008
s_add_u32 s43, s38, 0
buffer_load_dwordx4 v2, s[12:15], s43 offen lds
s_add_u32 m0, s40, 44032
s_add_u32 s43, s38, 49152
buffer_load_dwordx4 v3, s[12:15], s43 offen lds
s_add_u32 m0, s40, 45056
s_add_u32 s43, s38, 98304
buffer_load_dwordx4 v2, s[12:15], s43 offen lds
s_add_u32 m0, s40, 46080
s_add_u32 s43, s38, 147456
buffer_load_dwordx4 v3, s[12:15], s43 offen lds
s_add_u32 m0, s40, 47104
s_add_u32 s43, s38, 196608
buffer_load_dwordx4 v2, s[12:15], s43 offen lds
s_add_u32 m0, s40, 48128
s_add_u32 s43, s38, 245760
buffer_load_dwordx4 v3, s[12:15], s43 offen lds
s_add_u32 m0, s40, 49152
s_add_u32 s43, s38, 294912
buffer_load_dwordx4 v2, s[12:15], s43 offen lds
s_add_u32 m0, s40, 50176
s_add_u32 s43, s38, 344064
buffer_load_dwordx4 v3, s[12:15], s43 offen lds
s_add_u32 s37, s37, 128
s_add_u32 s38, s38, 393216
s_add_u32 m0, s39, 86016
s_mov_b64 exec, s[60:61]
buffer_load_dwordx4 v4, s[8:11], s37 offen lds
s_mov_b64 exec, -1
s_add_u32 m0, s39, 89088
s_nop 0
buffer_load_dwordx4 v5, s[8:11], s37 offen lds
s_add_u32 m0, s39, 92160
s_nop 0
buffer_load_dwordx4 v6, s[8:11], s37 offen lds
s_add_u32 m0, s39, 95232
s_nop 0
buffer_load_dwordx4 v7, s[8:11], s37 offen lds
s_add_u32 m0, s39, 98304
s_nop 0
buffer_load_dwordx4 v8, s[8:11], s37 offen lds
s_add_u32 m0, s39, 101376
s_nop 0
buffer_load_dwordx4 v9, s[8:11], s37 offen lds
s_add_u32 m0, s40, 86016
s_add_u32 s43, s38, 0
buffer_load_dwordx4 v2, s[12:15], s43 offen lds
s_add_u32 m0, s40, 87040
s_add_u32 s43, s38, 49152
buffer_load_dwordx4 v3, s[12:15], s43 offen lds
s_add_u32 m0, s40, 88064
s_add_u32 s43, s38, 98304
buffer_load_dwordx4 v2, s[12:15], s43 offen lds
s_add_u32 m0, s40, 89088
s_add_u32 s43, s38, 147456
buffer_load_dwordx4 v3, s[12:15], s43 offen lds
s_add_u32 m0, s40, 90112
s_add_u32 s43, s38, 196608
buffer_load_dwordx4 v2, s[12:15], s43 offen lds
s_add_u32 m0, s40, 91136
s_add_u32 s43, s38, 245760
buffer_load_dwordx4 v3, s[12:15], s43 offen lds
s_add_u32 m0, s40, 92160
s_add_u32 s43, s38, 294912
buffer_load_dwordx4 v2, s[12:15], s43 offen lds
s_add_u32 m0, s40, 93184
s_add_u32 s43, s38, 344064
buffer_load_dwordx4 v3, s[12:15], s43 offen lds
s_add_u32 s37, s37, 128
s_add_u32 s38, s38, 393216
s_lshl_b32 s43, s51, 11
buffer_load_dwordx4 v[96:99], v10, s[8:11], s43 offen offset:0
buffer_load_dwordx4 v[100:103], v10, s[8:11], s43 offen offset:1024
buffer_load_dwordx4 v[104:107], v10, s[8:11], s43 offen offset:2048
buffer_load_dwordx4 v[108:111], v10, s[8:11], s43 offen offset:3072
s_waitcnt vmcnt(32)
s_barrier
s_waitcnt vmcnt(18)
s_barrier
s_add_u32 m0, s39, 0
s_mov_b64 exec, s[60:61]
buffer_load_dwordx4 v4, s[8:11], s37 offen lds
s_mov_b64 exec, -1
s_add_u32 m0, s39, 3072
s_nop 0
buffer_load_dwordx4 v5, s[8:11], s37 offen lds
s_add_u32 m0, s39, 6144
s_nop 0
buffer_load_dwordx4 v6, s[8:11], s37 offen lds
s_add_u32 m0, s39, 9216
s_nop 0
buffer_load_dwordx4 v7, s[8:11], s37 offen lds
s_add_u32 m0, s39, 12288
s_nop 0
buffer_load_dwordx4 v8, s[8:11], s37 offen lds
s_add_u32 m0, s39, 15360
s_nop 0
buffer_load_dwordx4 v9, s[8:11], s37 offen lds
s_add_u32 m0, s40, 0
s_add_u32 s43, s38, 0
buffer_load_dwordx4 v2, s[12:15], s43 offen lds
s_add_u32 m0, s40, 1024
s_add_u32 s43, s38, 49152
buffer_load_dwordx4 v3, s[12:15], s43 offen lds
s_add_u32 m0, s40, 2048
s_add_u32 s43, s38, 98304
buffer_load_dwordx4 v2, s[12:15], s43 offen lds
s_add_u32 m0, s40, 3072
s_add_u32 s43, s38, 147456
buffer_load_dwordx4 v3, s[12:15], s43 offen lds
s_add_u32 m0, s40, 4096
s_add_u32 s43, s38, 196608
buffer_load_dwordx4 v2, s[12:15], s43 offen lds
s_add_u32 m0, s40, 5120
s_add_u32 s43, s38, 245760
buffer_load_dwordx4 v3, s[12:15], s43 offen lds
s_add_u32 m0, s40, 6144
s_add_u32 s43, s38, 294912
buffer_load_dwordx4 v2, s[12:15], s43 offen lds
s_add_u32 m0, s40, 7168
s_add_u32 s43, s38, 344064
buffer_load_dwordx4 v3, s[12:15], s43 offen lds
s_add_u32 s37, s37, 128
s_add_u32 s38, s38, 393216
s_waitcnt vmcnt(14)
s_barrier
s_add_u32 m0, s39, 43008
s_mov_b64 exec, s[60:61]
buffer_load_dwordx4 v4, s[8:11], s37 offen lds
s_mov_b64 exec, -1
s_add_u32 m0, s39, 46080
s_nop 0
buffer_load_dwordx4 v5, s[8:11], s37 offen lds
s_add_u32 m0, s39, 49152
s_nop 0
buffer_load_dwordx4 v6, s[8:11], s37 offen lds
s_add_u32 m0, s39, 52224
s_nop 0
buffer_load_dwordx4 v7, s[8:11], s37 offen lds
s_add_u32 m0, s39, 55296
s_nop 0
buffer_load_dwordx4 v8, s[8:11], s37 offen lds
s_add_u32 m0, s39, 58368
s_nop 0
buffer_load_dwordx4 v9, s[8:11], s37 offen lds
s_add_u32 m0, s40, 43008
s_add_u32 s43, s38, 0
buffer_load_dwordx4 v2, s[12:15], s43 offen lds
s_add_u32 m0, s40, 44032
s_add_u32 s43, s38, 49152
buffer_load_dwordx4 v3, s[12:15], s43 offen lds
s_add_u32 m0, s40, 45056
s_add_u32 s43, s38, 98304
buffer_load_dwordx4 v2, s[12:15], s43 offen lds
s_add_u32 m0, s40, 46080
s_add_u32 s43, s38, 147456
buffer_load_dwordx4 v3, s[12:15], s43 offen lds
s_add_u32 m0, s40, 47104
s_add_u32 s43, s38, 196608
buffer_load_dwordx4 v2, s[12:15], s43 offen lds
s_add_u32 m0, s40, 48128
s_add_u32 s43, s38, 245760
buffer_load_dwordx4 v3, s[12:15], s43 offen lds
s_add_u32 m0, s40, 49152
s_add_u32 s43, s38, 294912
buffer_load_dwordx4 v2, s[12:15], s43 offen lds
s_add_u32 m0, s40, 50176
s_add_u32 s43, s38, 344064
buffer_load_dwordx4 v3, s[12:15], s43 offen lds
s_add_u32 s37, s37, 128
s_add_u32 s38, s38, 393216
s_mov_b32 s43, 0x3f803f80
v_mov_b32 v116, 0
v_mov_b32 v117, 0
v_mov_b32 v118, 0
v_mov_b32 v119, 0
v_mov_b32 v120, 0
v_mov_b32 v121, 0
v_mov_b32 v122, 0
v_mov_b32 v123, 0
v_dot2_f32_bf16 v116, v96, s43, v116
v_dot2_f32_bf16 v120, v96, v96, v120
v_dot2_f32_bf16 v118, v104, s43, v118
v_dot2_f32_bf16 v122, v104, v104, v122
v_dot2_f32_bf16 v117, v97, s43, v117
v_dot2_f32_bf16 v121, v97, v97, v121
v_dot2_f32_bf16 v119, v105, s43, v119
v_dot2_f32_bf16 v123, v105, v105, v123
v_dot2_f32_bf16 v116, v98, s43, v116
v_dot2_f32_bf16 v120, v98, v98, v120
v_dot2_f32_bf16 v118, v106, s43, v118
v_dot2_f32_bf16 v122, v106, v106, v122
v_dot2_f32_bf16 v117, v99, s43, v117
v_dot2_f32_bf16 v121, v99, v99, v121
v_dot2_f32_bf16 v119, v107, s43, v119
v_dot2_f32_bf16 v123, v107, v107, v123
v_dot2_f32_bf16 v116, v100, s43, v116
v_dot2_f32_bf16 v120, v100, v100, v120
v_dot2_f32_bf16 v118, v108, s43, v118
v_dot2_f32_bf16 v122, v108, v108, v122
s_branch Lov_1
.p2align 12
Lst_1_0:
s_branch Lst_5_0
s_nop 0
Lov_1:
v_dot2_f32_bf16 v117, v101, s43, v117
v_dot2_f32_bf16 v121, v101, v101, v121
v_dot2_f32_bf16 v119, v109, s43, v119
v_dot2_f32_bf16 v123, v109, v109, v123
v_dot2_f32_bf16 v116, v102, s43, v116
v_dot2_f32_bf16 v120, v102, v102, v120
v_dot2_f32_bf16 v118, v110, s43, v118
v_dot2_f32_bf16 v122, v110, v110, v122
v_dot2_f32_bf16 v117, v103, s43, v117
v_dot2_f32_bf16 v121, v103, v103, v121
v_dot2_f32_bf16 v119, v111, s43, v119
v_dot2_f32_bf16 v123, v111, v111, v123
s_nop 2
v_add_f32 v116, v116, v117
v_add_f32 v118, v118, v119
v_add_f32 v120, v120, v121
v_add_f32 v122, v122, v123
s_nop 1
v_permlane32_swap_b32 v116, v118
v_permlane32_swap_b32 v120, v122
v_add_f32 v116, v116, v118
v_add_f32 v120, v120, v122
s_nop 1
v_permlane16_swap_b32 v116, v120
v_add_f32 v116, v116, v120
s_nop 1
v_add_f32_dpp v116, v116, v116 row_ror:8 row_mask:0xf bank_mask:0xf
s_nop 1
v_add_f32_dpp v116, v116, v116 row_ror:4 row_mask:0xf bank_mask:0xf
s_nop 1
v_add_f32_dpp v116, v116, v116 row_ror:2 row_mask:0xf bank_mask:0xf
s_nop 1
v_add_f32_dpp v116, v116, v116 row_ror:1 row_mask:0xf bank_mask:0xf
v_mov_b32 v117, v116
s_nop 1
v_permlane16_swap_b32 v116, v117
v_mul_f32 v112, 0x3a800000, v116
v_mul_f32 v113, 0x3a800000, v117
v_fma_f32 v113, -v112, v112, v113
v_max_f32 v113, 0, v113
v_add_f32 v113, 0x3727c5ac, v113
v_rsq_f32 v113, v113
v_lshrrev_b32 v11, 5, v1
s_lshl_b32 s43, s47, 4
s_add_u32 s43, s43, 148608
v_lshl_add_u32 v11, v11, 3, s43
ds_write_b64 v11, v[112:113]
s_waitcnt lgkmcnt(0)
s_and_b32 s44, s36, 3
s_mul_i32 s44, s44, 20
s_bfe_u32 s43, s2, 0x30001
s_lshl_b32 s43, s43, 7
s_add_u32 s44, s44, s43
s_mul_i32 s44, s44, 7168
s_lshr_b32 s43, s2, 4
s_lshl_b32 s43, s43, 8
s_add_u32 s43, s43, s44
s_bitcmp0_b32 s2, 0
s_cselect_b32 s4, s72, s74
s_cselect_b32 s5, s73, s75
s_add_u32 s4, s4, s43
s_addc_u32 s5, s5, 0
s_waitcnt lgkmcnt(0)
s_load_dword s3, s[4:5], 0
s_load_dword s3, s[4:5], 64
s_load_dword s3, s[4:5], 128
s_load_dword s3, s[4:5], 192
s_load_dword s3, s[4:5], 7168
s_load_dword s3, s[4:5], 7232
s_load_dword s3, s[4:5], 7296
s_load_dword s3, s[4:5], 7360
s_load_dword s3, s[4:5], 14336
s_load_dword s3, s[4:5], 14400
s_load_dword s3, s[4:5], 14464
s_load_dword s3, s[4:5], 14528
s_load_dword s3, s[4:5], 21504
s_load_dword s3, s[4:5], 21568
s_waitcnt vmcnt(14)
s_barrier
s_add_u32 m0, s39, 86016
s_mov_b64 exec, s[60:61]
buffer_load_dwordx4 v4, s[8:11], s37 offen lds
s_mov_b64 exec, -1
s_add_u32 m0, s39, 89088
s_nop 0
buffer_load_dwordx4 v5, s[8:11], s37 offen lds
s_add_u32 m0, s39, 92160
s_nop 0
buffer_load_dwordx4 v6, s[8:11], s37 offen lds
s_add_u32 m0, s39, 95232
s_nop 0
buffer_load_dwordx4 v7, s[8:11], s37 offen lds
s_add_u32 m0, s39, 98304
s_nop 0
buffer_load_dwordx4 v8, s[8:11], s37 offen lds
s_add_u32 m0, s39, 101376
s_nop 0
buffer_load_dwordx4 v9, s[8:11], s37 offen lds
s_add_u32 m0, s40, 86016
s_add_u32 s43, s38, 0
buffer_load_dwordx4 v2, s[12:15], s43 offen lds
s_add_u32 m0, s40, 87040
s_add_u32 s43, s38, 49152
buffer_load_dwordx4 v3, s[12:15], s43 offen lds
s_add_u32 m0, s40, 88064
s_add_u32 s43, s38, 98304
buffer_load_dwordx4 v2, s[12:15], s43 offen lds
s_add_u32 m0, s40, 89088
s_add_u32 s43, s38, 147456
buffer_load_dwordx4 v3, s[12:15], s43 offen lds
s_add_u32 m0, s40, 90112
s_add_u32 s43, s38, 196608
buffer_load_dwordx4 v2, s[12:15], s43 offen lds
s_add_u32 m0, s40, 91136
s_add_u32 s43, s38, 245760
buffer_load_dwordx4 v3, s[12:15], s43 offen lds
s_add_u32 m0, s40, 92160
s_add_u32 s43, s38, 294912
buffer_load_dwordx4 v2, s[12:15], s43 offen lds
s_add_u32 m0, s40, 93184
s_add_u32 s43, s38, 344064
buffer_load_dwordx4 v3, s[12:15], s43 offen lds
s_add_u32 s37, s37, 128
s_add_u32 s38, s38, 393216
s_waitcnt vmcnt(14)
s_barrier
s_add_u32 m0, s39, 0
s_mov_b64 exec, s[60:61]
buffer_load_dwordx4 v4, s[8:11], s37 offen lds
s_mov_b64 exec, -1
s_add_u32 m0, s39, 3072
s_nop 0
buffer_load_dwordx4 v5, s[8:11], s37 offen lds
s_add_u32 m0, s39, 6144
s_nop 0
buffer_load_dwordx4 v6, s[8:11], s37 offen lds
s_add_u32 m0, s39, 9216
s_nop 0
buffer_load_dwordx4 v7, s[8:11], s37 offen lds
s_add_u32 m0, s39, 12288
s_nop 0
buffer_load_dwordx4 v8, s[8:11], s37 offen lds
s_add_u32 m0, s39, 15360
s_nop 0
buffer_load_dwordx4 v9, s[8:11], s37 offen lds
s_add_u32 m0, s40, 0
s_add_u32 s43, s38, 0
buffer_load_dwordx4 v2, s[12:15], s43 offen lds
s_add_u32 m0, s40, 1024
s_add_u32 s43, s38, 49152
buffer_load_dwordx4 v3, s[12:15], s43 offen lds
s_add_u32 m0, s40, 2048
s_add_u32 s43, s38, 98304
buffer_load_dwordx4 v2, s[12:15], s43 offen lds
s_add_u32 m0, s40, 3072
s_add_u32 s43, s38, 147456
buffer_load_dwordx4 v3, s[12:15], s43 offen lds
s_add_u32 m0, s40, 4096
s_add_u32 s43, s38, 196608
buffer_load_dwordx4 v2, s[12:15], s43 offen lds
s_add_u32 m0, s40, 5120
s_add_u32 s43, s38, 245760
buffer_load_dwordx4 v3, s[12:15], s43 offen lds
s_add_u32 m0, s40, 6144
s_add_u32 s43, s38, 294912
buffer_load_dwordx4 v2, s[12:15], s43 offen lds
s_add_u32 m0, s40, 7168
s_add_u32 s43, s38, 344064
buffer_load_dwordx4 v3, s[12:15], s43 offen lds
s_add_u32 s37, s37, 128
s_add_u32 s38, s38, 393216
s_waitcnt lgkmcnt(0)
s_load_dword s3, s[4:5], 21632
s_load_dword s3, s[4:5], 21696
s_load_dword s3, s[4:5], 28672
s_load_dword s3, s[4:5], 28736
s_load_dword s3, s[4:5], 28800
s_load_dword s3, s[4:5], 28864
s_load_dword s3, s[4:5], 35840
s_load_dword s3, s[4:5], 35904
s_load_dword s3, s[4:5], 35968
s_load_dword s3, s[4:5], 36032
s_load_dword s3, s[4:5], 43008
s_load_dword s3, s[4:5], 43072
s_load_dword s3, s[4:5], 43136
s_load_dword s3, s[4:5], 43200
s_waitcnt vmcnt(14)
s_barrier
s_add_u32 m0, s39, 43008
s_mov_b64 exec, s[60:61]
buffer_load_dwordx4 v4, s[8:11], s37 offen lds
s_mov_b64 exec, -1
s_add_u32 m0, s39, 46080
s_nop 0
buffer_load_dwordx4 v5, s[8:11], s37 offen lds
s_add_u32 m0, s39, 49152
s_nop 0
buffer_load_dwordx4 v6, s[8:11], s37 offen lds
s_add_u32 m0, s39, 52224
s_nop 0
buffer_load_dwordx4 v7, s[8:11], s37 offen lds
s_add_u32 m0, s39, 55296
s_nop 0
buffer_load_dwordx4 v8, s[8:11], s37 offen lds
s_add_u32 m0, s39, 58368
s_nop 0
buffer_load_dwordx4 v9, s[8:11], s37 offen lds
s_add_u32 m0, s40, 43008
s_add_u32 s43, s38, 0
buffer_load_dwordx4 v2, s[12:15], s43 offen lds
s_add_u32 m0, s40, 44032
s_add_u32 s43, s38, 49152
buffer_load_dwordx4 v3, s[12:15], s43 offen lds
s_add_u32 m0, s40, 45056
s_add_u32 s43, s38, 98304
buffer_load_dwordx4 v2, s[12:15], s43 offen lds
s_add_u32 m0, s40, 46080
s_add_u32 s43, s38, 147456
buffer_load_dwordx4 v3, s[12:15], s43 offen lds
s_add_u32 m0, s40, 47104
s_add_u32 s43, s38, 196608
buffer_load_dwordx4 v2, s[12:15], s43 offen lds
s_add_u32 m0, s40, 48128
s_add_u32 s43, s38, 245760
buffer_load_dwordx4 v3, s[12:15], s43 offen lds
s_add_u32 m0, s40, 49152
s_add_u32 s43, s38, 294912
buffer_load_dwordx4 v2, s[12:15], s43 offen lds
s_add_u32 m0, s40, 50176
s_add_u32 s43, s38, 344064
buffer_load_dwordx4 v3, s[12:15], s43 offen lds
s_add_u32 s37, s37, 128
s_add_u32 s38, s38, 393216
s_waitcnt vmcnt(14)
s_barrier
s_add_u32 m0, s39, 86016
s_mov_b64 exec, s[60:61]
buffer_load_dwordx4 v4, s[8:11], s37 offen lds
s_mov_b64 exec, -1
s_add_u32 m0, s39, 89088
s_nop 0
buffer_load_dwordx4 v5, s[8:11], s37 offen lds
s_add_u32 m0, s39, 92160
s_nop 0
buffer_load_dwordx4 v6, s[8:11], s37 offen lds
s_add_u32 m0, s39, 95232
s_nop 0
buffer_load_dwordx4 v7, s[8:11], s37 offen lds
s_add_u32 m0, s39, 98304
s_nop 0
buffer_load_dwordx4 v8, s[8:11], s37 offen lds
s_add_u32 m0, s39, 101376
s_nop 0
buffer_load_dwordx4 v9, s[8:11], s37 offen lds
s_add_u32 m0, s40, 86016
s_add_u32 s43, s38, 0
buffer_load_dwordx4 v2, s[12:15], s43 offen lds
s_add_u32 m0, s40, 87040
s_add_u32 s43, s38, 49152
buffer_load_dwordx4 v3, s[12:15], s43 offen lds
s_add_u32 m0, s40, 88064
s_add_u32 s43, s38, 98304
buffer_load_dwordx4 v2, s[12:15], s43 offen lds
s_add_u32 m0, s40, 89088
s_add_u32 s43, s38, 147456
buffer_load_dwordx4 v3, s[12:15], s43 offen lds
s_add_u32 m0, s40, 90112
s_add_u32 s43, s38, 196608
buffer_load_dwordx4 v2, s[12:15], s43 offen lds
s_add_u32 m0, s40, 91136
s_add_u32 s43, s38, 245760
buffer_load_dwordx4 v3, s[12:15], s43 offen lds
s_add_u32 m0, s40, 92160
s_add_u32 s43, s38, 294912
buffer_load_dwordx4 v2, s[12:15], s43 offen lds
s_add_u32 m0, s40, 93184
s_add_u32 s43, s38, 344064
buffer_load_dwordx4 v3, s[12:15], s43 offen lds
s_add_u32 s37, s37, 128
s_add_u32 s38, s38, 393216
s_waitcnt lgkmcnt(0)
s_load_dword s3, s[4:5], 50176
s_load_dword s3, s[4:5], 50240
s_load_dword s3, s[4:5], 50304
s_load_dword s3, s[4:5], 50368
s_load_dword s3, s[4:5], 57344
s_load_dword s3, s[4:5], 57408
s_load_dword s3, s[4:5], 57472
s_load_dword s3, s[4:5], 57536
s_load_dword s3, s[4:5], 64512
s_load_dword s3, s[4:5], 64576
s_load_dword s3, s[4:5], 64640
s_load_dword s3, s[4:5], 64704
s_load_dword s3, s[4:5], 71680
s_load_dword s3, s[4:5], 71744
s_waitcnt vmcnt(14)
s_barrier
s_add_u32 m0, s39, 0
s_mov_b64 exec, s[60:61]
buffer_load_dwordx4 v4, s[8:11], s37 offen lds
s_mov_b64 exec, -1
s_add_u32 m0, s39, 3072
s_nop 0
buffer_load_dwordx4 v5, s[8:11], s37 offen lds
s_add_u32 m0, s39, 6144
s_nop 0
buffer_load_dwordx4 v6, s[8:11], s37 offen lds
s_add_u32 m0, s39, 9216
s_nop 0
buffer_load_dwordx4 v7, s[8:11], s37 offen lds
s_add_u32 m0, s39, 12288
s_nop 0
buffer_load_dwordx4 v8, s[8:11], s37 offen lds
s_add_u32 m0, s39, 15360
s_nop 0
buffer_load_dwordx4 v9, s[8:11], s37 offen lds
s_add_u32 m0, s40, 0
s_add_u32 s43, s38, 0
buffer_load_dwordx4 v2, s[12:15], s43 offen lds
s_add_u32 m0, s40, 1024
s_add_u32 s43, s38, 49152
buffer_load_dwordx4 v3, s[12:15], s43 offen lds
s_add_u32 m0, s40, 2048
s_add_u32 s43, s38, 98304
buffer_load_dwordx4 v2, s[12:15], s43 offen lds
s_add_u32 m0, s40, 3072
s_add_u32 s43, s38, 147456
buffer_load_dwordx4 v3, s[12:15], s43 offen lds
s_add_u32 m0, s40, 4096
s_add_u32 s43, s38, 196608
buffer_load_dwordx4 v2, s[12:15], s43 offen lds
s_add_u32 m0, s40, 5120
s_add_u32 s43, s38, 245760
buffer_load_dwordx4 v3, s[12:15], s43 offen lds
s_add_u32 m0, s40, 6144
s_add_u32 s43, s38, 294912
buffer_load_dwordx4 v2, s[12:15], s43 offen lds
s_add_u32 m0, s40, 7168
s_add_u32 s43, s38, 344064
buffer_load_dwordx4 v3, s[12:15], s43 offen lds
s_add_u32 s37, s37, 128
s_add_u32 s38, s38, 393216
s_waitcnt vmcnt(14)
s_barrier
s_add_u32 m0, s39, 43008
s_mov_b64 exec, s[60:61]
buffer_load_dwordx4 v4, s[8:11], s37 offen lds
s_mov_b64 exec, -1
s_add_u32 m0, s39, 46080
s_nop 0
buffer_load_dwordx4 v5, s[8:11], s37 offen lds
s_add_u32 m0, s39, 49152
s_nop 0
buffer_load_dwordx4 v6, s[8:11], s37 offen lds
s_add_u32 m0, s39, 52224
s_nop 0
buffer_load_dwordx4 v7, s[8:11], s37 offen lds
s_add_u32 m0, s39, 55296
s_nop 0
buffer_load_dwordx4 v8, s[8:11], s37 offen lds
s_add_u32 m0, s39, 58368
s_nop 0
buffer_load_dwordx4 v9, s[8:11], s37 offen lds
s_add_u32 m0, s40, 43008
s_add_u32 s43, s38, 0
buffer_load_dwordx4 v2, s[12:15], s43 offen lds
s_add_u32 m0, s40, 44032
s_add_u32 s43, s38, 49152
buffer_load_dwordx4 v3, s[12:15], s43 offen lds
s_add_u32 m0, s40, 45056
s_add_u32 s43, s38, 98304
buffer_load_dwordx4 v2, s[12:15], s43 offen lds
s_add_u32 m0, s40, 46080
s_add_u32 s43, s38, 147456
buffer_load_dwordx4 v3, s[12:15], s43 offen lds
s_add_u32 m0, s40, 47104
s_add_u32 s43, s38, 196608
buffer_load_dwordx4 v2, s[12:15], s43 offen lds
s_add_u32 m0, s40, 48128
s_add_u32 s43, s38, 245760
buffer_load_dwordx4 v3, s[12:15], s43 offen lds
s_add_u32 m0, s40, 49152
s_add_u32 s43, s38, 294912
buffer_load_dwordx4 v2, s[12:15], s43 offen lds
s_add_u32 m0, s40, 50176
s_add_u32 s43, s38, 344064
buffer_load_dwordx4 v3, s[12:15], s43 offen lds
s_add_u32 s37, s37, 128
s_add_u32 s38, s38, 393216
s_waitcnt lgkmcnt(0)
s_load_dword s3, s[4:5], 71808
s_load_dword s3, s[4:5], 71872
s_load_dword s3, s[4:5], 78848
s_load_dword s3, s[4:5], 78912
s_load_dword s3, s[4:5], 78976
s_load_dword s3, s[4:5], 79040
s_load_dword s3, s[4:5], 86016
s_load_dword s3, s[4:5], 86080
s_load_dword s3, s[4:5], 86144
s_load_dword s3, s[4:5], 86208
s_load_dword s3, s[4:5], 93184
s_load_dword s3, s[4:5], 93248
s_load_dword s3, s[4:5], 93312
s_load_dword s3, s[4:5], 93376
s_waitcnt vmcnt(14)
s_barrier
s_add_u32 m0, s39, 86016
s_mov_b64 exec, s[60:61]
buffer_load_dwordx4 v4, s[8:11], s37 offen lds
s_mov_b64 exec, -1
s_add_u32 m0, s39, 89088
s_nop 0
buffer_load_dwordx4 v5, s[8:11], s37 offen lds
s_add_u32 m0, s39, 92160
s_nop 0
buffer_load_dwordx4 v6, s[8:11], s37 offen lds
s_add_u32 m0, s39, 95232
s_nop 0
buffer_load_dwordx4 v7, s[8:11], s37 offen lds
s_add_u32 m0, s39, 98304
s_nop 0
buffer_load_dwordx4 v8, s[8:11], s37 offen lds
s_add_u32 m0, s39, 101376
s_nop 0
buffer_load_dwordx4 v9, s[8:11], s37 offen lds
s_add_u32 m0, s40, 86016
s_add_u32 s43, s38, 0
buffer_load_dwordx4 v2, s[12:15], s43 offen lds
s_add_u32 m0, s40, 87040
s_add_u32 s43, s38, 49152
buffer_load_dwordx4 v3, s[12:15], s43 offen lds
s_add_u32 m0, s40, 88064
s_add_u32 s43, s38, 98304
buffer_load_dwordx4 v2, s[12:15], s43 offen lds
s_add_u32 m0, s40, 89088
s_add_u32 s43, s38, 147456
buffer_load_dwordx4 v3, s[12:15], s43 offen lds
s_add_u32 m0, s40, 90112
s_add_u32 s43, s38, 196608
buffer_load_dwordx4 v2, s[12:15], s43 offen lds
s_add_u32 m0, s40, 91136
s_add_u32 s43, s38, 245760
buffer_load_dwordx4 v3, s[12:15], s43 offen lds
s_add_u32 m0, s40, 92160
s_add_u32 s43, s38, 294912
buffer_load_dwordx4 v2, s[12:15], s43 offen lds
s_add_u32 m0, s40, 93184
s_add_u32 s43, s38, 344064
buffer_load_dwordx4 v3, s[12:15], s43 offen lds
s_add_u32 s37, s37, 128
s_add_u32 s38, s38, 393216
s_waitcnt vmcnt(14)
s_barrier
s_add_u32 m0, s39, 0
s_mov_b64 exec, s[60:61]
buffer_load_dwordx4 v4, s[8:11], s37 offen lds
s_mov_b64 exec, -1
s_add_u32 m0, s39, 3072
s_nop 0
buffer_load_dwordx4 v5, s[8:11], s37 offen lds
s_add_u32 m0, s39, 6144
s_nop 0
buffer_load_dwordx4 v6, s[8:11], s37 offen lds
s_add_u32 m0, s39, 9216
s_nop 0
buffer_load_dwordx4 v7, s[8:11], s37 offen lds
s_add_u32 m0, s39, 12288
s_nop 0
buffer_load_dwordx4 v8, s[8:11], s37 offen lds
s_add_u32 m0, s39, 15360
s_nop 0
buffer_load_dwordx4 v9, s[8:11], s37 offen lds
s_add_u32 m0, s40, 0
s_add_u32 s43, s38, 0
buffer_load_dwordx4 v2, s[12:15], s43 offen lds
s_add_u32 m0, s40, 1024
s_add_u32 s43, s38, 49152
buffer_load_dwordx4 v3, s[12:15], s43 offen lds
s_add_u32 m0, s40, 2048
s_add_u32 s43, s38, 98304
buffer_load_dwordx4 v2, s[12:15], s43 offen lds
s_add_u32 m0, s40, 3072
s_add_u32 s43, s38, 147456
buffer_load_dwordx4 v3, s[12:15], s43 offen lds
s_add_u32 m0, s40, 4096
s_add_u32 s43, s38, 196608
buffer_load_dwordx4 v2, s[12:15], s43 offen lds
s_add_u32 m0, s40, 5120
s_add_u32 s43, s38, 245760
buffer_load_dwordx4 v3, s[12:15], s43 offen lds
s_add_u32 m0, s40, 6144
s_add_u32 s43, s38, 294912
buffer_load_dwordx4 v2, s[12:15], s43 offen lds
s_add_u32 m0, s40, 7168
s_add_u32 s43, s38, 344064
buffer_load_dwordx4 v3, s[12:15], s43 offen lds
s_add_u32 s37, s37, 128
s_add_u32 s38, s38, 393216
s_waitcnt lgkmcnt(0)
s_load_dword s3, s[4:5], 100352
s_load_dword s3, s[4:5], 100416
s_load_dword s3, s[4:5], 100480
s_load_dword s3, s[4:5], 100544
s_load_dword s3, s[4:5], 107520
s_load_dword s3, s[4:5], 107584
s_load_dword s3, s[4:5], 107648
s_load_dword s3, s[4:5], 107712
s_load_dword s3, s[4:5], 114688
s_load_dword s3, s[4:5], 114752
s_load_dword s3, s[4:5], 114816
s_load_dword s3, s[4:5], 114880
s_load_dword s3, s[4:5], 121856
s_load_dword s3, s[4:5], 121920
s_waitcnt vmcnt(14)
s_barrier
s_add_u32 m0, s39, 43008
s_mov_b64 exec, s[60:61]
buffer_load_dwordx4 v4, s[8:11], s37 offen lds
s_mov_b64 exec, -1
s_add_u32 m0, s39, 46080
s_nop 0
buffer_load_dwordx4 v5, s[8:11], s37 offen lds
s_add_u32 m0, s39, 49152
s_nop 0
buffer_load_dwordx4 v6, s[8:11], s37 offen lds
s_add_u32 m0, s39, 52224
s_nop 0
buffer_load_dwordx4 v7, s[8:11], s37 offen lds
s_add_u32 m0, s39, 55296
s_nop 0
buffer_load_dwordx4 v8, s[8:11], s37 offen lds
s_add_u32 m0, s39, 58368
s_nop 0
buffer_load_dwordx4 v9, s[8:11], s37 offen lds
s_add_u32 m0, s40, 43008
s_add_u32 s43, s38, 0
buffer_load_dwordx4 v2, s[12:15], s43 offen lds
s_add_u32 m0, s40, 44032
s_add_u32 s43, s38, 49152
buffer_load_dwordx4 v3, s[12:15], s43 offen lds
s_add_u32 m0, s40, 45056
s_add_u32 s43, s38, 98304
buffer_load_dwordx4 v2, s[12:15], s43 offen lds
s_add_u32 m0, s40, 46080
s_add_u32 s43, s38, 147456
buffer_load_dwordx4 v3, s[12:15], s43 offen lds
s_add_u32 m0, s40, 47104
s_add_u32 s43, s38, 196608
buffer_load_dwordx4 v2, s[12:15], s43 offen lds
s_add_u32 m0, s40, 48128
s_add_u32 s43, s38, 245760
buffer_load_dwordx4 v3, s[12:15], s43 offen lds
s_add_u32 m0, s40, 49152
s_add_u32 s43, s38, 294912
buffer_load_dwordx4 v2, s[12:15], s43 offen lds
s_add_u32 m0, s40, 50176
s_add_u32 s43, s38, 344064
buffer_load_dwordx4 v3, s[12:15], s43 offen lds
s_add_u32 s37, s37, 128
s_add_u32 s38, s38, 393216
s_waitcnt vmcnt(14)
s_barrier
s_add_u32 m0, s39, 86016
s_mov_b64 exec, s[60:61]
buffer_load_dwordx4 v4, s[8:11], s37 offen lds
s_mov_b64 exec, -1
s_add_u32 m0, s39, 89088
s_nop 0
buffer_load_dwordx4 v5, s[8:11], s37 offen lds
s_add_u32 m0, s39, 92160
s_nop 0
buffer_load_dwordx4 v6, s[8:11], s37 offen lds
s_add_u32 m0, s39, 95232
s_nop 0
buffer_load_dwordx4 v7, s[8:11], s37 offen lds
s_add_u32 m0, s39, 98304
s_nop 0
buffer_load_dwordx4 v8, s[8:11], s37 offen lds
s_add_u32 m0, s39, 101376
s_nop 0
buffer_load_dwordx4 v9, s[8:11], s37 offen lds
s_add_u32 m0, s40, 86016
s_add_u32 s43, s38, 0
buffer_load_dwordx4 v2, s[12:15], s43 offen lds
s_branch Lov_2
.p2align 12
Lst_2_0:
s_branch Lst_6_0
s_nop 0
Lov_2:
s_add_u32 m0, s40, 87040
s_add_u32 s43, s38, 49152
buffer_load_dwordx4 v3, s[12:15], s43 offen lds
s_add_u32 m0, s40, 88064
s_add_u32 s43, s38, 98304
buffer_load_dwordx4 v2, s[12:15], s43 offen lds
s_add_u32 m0, s40, 89088
s_add_u32 s43, s38, 147456
buffer_load_dwordx4 v3, s[12:15], s43 offen lds
s_add_u32 m0, s40, 90112
s_add_u32 s43, s38, 196608
buffer_load_dwordx4 v2, s[12:15], s43 offen lds
s_add_u32 m0, s40, 91136
s_add_u32 s43, s38, 245760
buffer_load_dwordx4 v3, s[12:15], s43 offen lds
s_add_u32 m0, s40, 92160
s_add_u32 s43, s38, 294912
buffer_load_dwordx4 v2, s[12:15], s43 offen lds
s_add_u32 m0, s40, 93184
s_add_u32 s43, s38, 344064
buffer_load_dwordx4 v3, s[12:15], s43 offen lds
s_add_u32 s37, s37, 128
s_add_u32 s38, s38, 393216
s_waitcnt lgkmcnt(0)
s_load_dword s3, s[4:5], 121984
s_load_dword s3, s[4:5], 122048
s_load_dword s3, s[4:5], 129024
s_load_dword s3, s[4:5], 129088
s_load_dword s3, s[4:5], 129152
s_load_dword s3, s[4:5], 129216
s_load_dword s3, s[4:5], 136192
s_load_dword s3, s[4:5], 136256
s_load_dword s3, s[4:5], 136320
s_load_dword s3, s[4:5], 136384
s_waitcnt vmcnt(14)
s_barrier
s_add_u32 m0, s39, 0
s_mov_b64 exec, s[60:61]
buffer_load_dwordx4 v4, s[8:11], s37 offen lds
s_mov_b64 exec, -1
s_add_u32 m0, s39, 3072
s_nop 0
buffer_load_dwordx4 v5, s[8:11], s37 offen lds
s_add_u32 m0, s39, 6144
s_nop 0
buffer_load_dwordx4 v6, s[8:11], s37 offen lds
s_add_u32 m0, s39, 9216
s_nop 0
buffer_load_dwordx4 v7, s[8:11], s37 offen lds
s_add_u32 m0, s39, 12288
s_nop 0
buffer_load_dwordx4 v8, s[8:11], s37 offen lds
s_add_u32 m0, s39, 15360
s_nop 0
buffer_load_dwordx4 v9, s[8:11], s37 offen lds
s_add_u32 m0, s40, 0
s_add_u32 s43, s38, 0
buffer_load_dwordx4 v2, s[12:15], s43 offen lds
s_add_u32 m0, s40, 1024
s_add_u32 s43, s38, 49152
buffer_load_dwordx4 v3, s[12:15], s43 offen lds
s_add_u32 m0, s40, 2048
s_add_u32 s43, s38, 98304
buffer_load_dwordx4 v2, s[12:15], s43 offen lds
s_add_u32 m0, s40, 3072
s_add_u32 s43, s38, 147456
buffer_load_dwordx4 v3, s[12:15], s43 offen lds
s_add_u32 m0, s40, 4096
s_add_u32 s43, s38, 196608
buffer_load_dwordx4 v2, s[12:15], s43 offen lds
s_add_u32 m0, s40, 5120
s_add_u32 s43, s38, 245760
buffer_load_dwordx4 v3, s[12:15], s43 offen lds
s_add_u32 m0, s40, 6144
s_add_u32 s43, s38, 294912
buffer_load_dwordx4 v2, s[12:15], s43 offen lds
s_add_u32 m0, s40, 7168
s_add_u32 s43, s38, 344064
buffer_load_dwordx4 v3, s[12:15], s43 offen lds
s_add_u32 s37, s37, 128
s_add_u32 s38, s38, 393216
s_waitcnt vmcnt(14)
s_barrier
s_waitcnt vmcnt(0)
s_barrier
s_bitcmp0_b32 s2, 0
s_cselect_b32 s88, s72, s74
s_cselect_b32 s89, s73, s75
s_cmp_lt_u32 s2, 192
s_cselect_b32 s90, 7340032, 0
s_mov_b32 s91, 0x20000
s_bfe_u32 s44, s2, 0x30001
s_lshl_b32 s44, s44, 2
s_and_b32 s43, s36, 3
s_add_u32 s44, s44, s43
s_lshl_b32 s44, s44, 5
v_lshrrev_b32 v18, 4, v1
v_add_u32 v18, s44, v18
v_mul_u32_u24 v18, 7168, v18
v_and_b32 v19, 15, v1
v_lshl_add_u32 v18, v19, 4, v18
s_lshr_b32 s43, s2, 4
s_lshl_b32 s43, s43, 8
s_add_u32 s43, s43, 4096
v_add_u32 v18, s43, v18
s_mov_b32 s43, 0
buffer_load_dwordx4 v[128:131], v18, s[88:91], s43 offen
s_mov_b32 s43, 28672
buffer_load_dwordx4 v[132:135], v18, s[88:91], s43 offen
s_mov_b32 s43, 57344
buffer_load_dwordx4 v[136:139], v18, s[88:91], s43 offen
s_mov_b32 s43, 86016
buffer_load_dwordx4 v[140:143], v18, s[88:91], s43 offen
s_mov_b32 s43, 114688
buffer_load_dwordx4 v[144:147], v18, s[88:91], s43 offen
s_mov_b32 s43, 143360
buffer_load_dwordx4 v[148:151], v18, s[88:91], s43 offen
s_mov_b32 s43, 172032
buffer_load_dwordx4 v[152:155], v18, s[88:91], s43 offen
s_mov_b32 s43, 200704
buffer_load_dwordx4 v[156:159], v18, s[88:91], s43 offen
s_barrier
s_lshl_b32 s43, s35, 7
s_add_u32 s24, s68, s43
s_addc_u32 s25, s69, 0
s_mov_b32 s26, 2095232
s_mov_b32 s27, 0x20000
v_lshrrev_b32 v15, 3, v1
v_and_b32 v16, 6, v15
v_and_b32 v14, 7, v1
v_xor_b32 v14, v14, v16
v_lshlrev_b32 v14, 4, v14
v_mul_u32_u24 v15, 2048, v15
v_add_u32 v14, v14, v15
s_sub_u32 s44, s36, 4
s_lshl_b32 s45, s44, 13
s_lshl_b32 s44, s44, 17
s_add_u32 m0, s45, 114688
s_add_u32 s43, s44, 0
buffer_load_dwordx4 v14, s[24:27], s43 offen lds
s_add_u32 m0, s45, 115712
s_add_u32 s43, s44, 16384
buffer_load_dwordx4 v14, s[24:27], s43 offen lds
s_add_u32 m0, s45, 116736
s_add_u32 s43, s44, 32768
buffer_load_dwordx4 v14, s[24:27], s43 offen lds
s_add_u32 m0, s45, 117760
s_add_u32 s43, s44, 49152
buffer_load_dwordx4 v14, s[24:27], s43 offen lds
s_add_u32 m0, s45, 118784
s_add_u32 s43, s44, 65536
buffer_load_dwordx4 v14, s[24:27], s43 offen lds
s_add_u32 m0, s45, 119808
s_add_u32 s43, s44, 81920
buffer_load_dwordx4 v14, s[24:27], s43 offen lds
s_add_u32 m0, s45, 120832
s_add_u32 s43, s44, 98304
buffer_load_dwordx4 v14, s[24:27], s43 offen lds
s_add_u32 m0, s45, 121856
s_add_u32 s43, s44, 114688
buffer_load_dwordx4 v14, s[24:27], s43 offen lds
s_branch Latt_5
Lpf_4:
s_add_u32 s84, s82, 28311552
s_addc_u32 s85, s83, 0
s_mov_b32 s86, 49152
s_mov_b32 s87, 0x20000
s_mov_b32 s56, s80
s_mov_b32 s57, s81
s_mov_b32 s58, 256
s_mov_b32 s59, 0x20000
v_mov_b32 v5, 0
v_lshlrev_b32 v14, 7, v1
s_or_b32 s43, s34, s35
s_cmp_lg_u32 s43, 0
s_cbranch_scc1 Lz_12
s_movk_i32 s43, 0x2000
buffer_store_dword v5, v14, s[84:87], 0 offen sc1
s_bfm_b64 exec, 44, 0
buffer_store_dword v5, v14, s[84:87], s43 offen sc1
s_mov_b64 exec, 1
v_mov_b32 v6, 1
s_waitcnt vmcnt(0)
buffer_store_dword v6, v5, s[56:59], 0 offen sc1
s_mov_b64 exec, -1
Lz_12:
s_lshl_b32 s43, s51, 11
buffer_load_dwordx4 v[96:99], v10, s[8:11], s43 offen offset:0
buffer_load_dwordx4 v[100:103], v10, s[8:11], s43 offen offset:1024
buffer_load_dwordx4 v[104:107], v10, s[8:11], s43 offen offset:2048
buffer_load_dwordx4 v[108:111], v10, s[8:11], s43 offen offset:3072
v_min_u32 v14, 23, v1
v_mul_u32_u24 v15, 21846, v14
v_lshrrev_b32 v15, 16, v15
v_mul_u32_u24 v16, 3, v15
v_sub_u32 v16, v14, v16
s_lshl_b32 s43, s48, 3
v_add_u32 v15, s43, v15
v_mul_u32_u24 v15, 6144, v15
v_lshl_add_u32 v3, v16, 11, v15
v_min_u32 v14, 23, v1
v_lshrrev_b32 v15, 3, v14
v_mul_u32_u24 v15, 43008, v15
v_and_b32 v14, 7, v14
v_lshl_add_u32 v15, v14, 4, v15
v_mov_b32 v32, 0x3f803f80
v_mov_b32 v33, 0x3f803f80
v_mov_b32 v34, 0x3f803f80
v_mov_b32 v35, 0x3f803f80
ds_write_b128 v15, v[32:35]
s_add_u32 s20, s82, 26214400
s_addc_u32 s21, s83, 0
s_mov_b32 s22, 16384
s_mov_b32 s23, 0x20000
s_add_u32 s43, s2, 128
s_lshl_b32 s43, s43, 7
v_lshlrev_b32 v14, 2, v1
s_mov_b64 exec, 15
buffer_store_dword v5, v14, s[84:87], s43 offen sc1
s_mov_b64 exec, -1
s_lshl_b32 s52, s34, 7
s_add_u32 s52, s52, 28319744
s_sub_u32 s53, s52, 128
s_cmp_eq_u32 s34, 0
s_cselect_b32 s53, s52, s53
s_waitcnt lgkmcnt(0)
s_barrier
s_mov_b32 s43, 1179648
buffer_load_dword v31, v3, s[12:15], s43 offen
s_mov_b32 s43, 1572864
buffer_load_dword v31, v3, s[12:15], s43 offen
s_mov_b32 s43, 1966080
buffer_load_dword v31, v3, s[12:15], s43 offen
s_mov_b32 s43, 2359296
buffer_load_dword v31, v3, s[12:15], s43 offen
s_barrier
s_mov_b32 s43, 2752512
buffer_load_dword v31, v3, s[12:15], s43 offen
s_mov_b32 s43, 3145728
buffer_load_dword v31, v3, s[12:15], s43 offen
s_mov_b32 s43, 3538944
buffer_load_dword v31, v3, s[12:15], s43 offen
s_mov_b32 s43, 3932160
buffer_load_dword v31, v3, s[12:15], s43 offen
s_barrier
s_waitcnt vmcnt(9)
s_mov_b32 s43, 0x3f803f80
v_mov_b32 v116, 0
v_mov_b32 v117, 0
v_mov_b32 v118, 0
v_mov_b32 v119, 0
v_mov_b32 v120, 0
v_mov_b32 v121, 0
v_mov_b32 v122, 0
v_mov_b32 v123, 0
v_dot2_f32_bf16 v116, v96, s43, v116
v_dot2_f32_bf16 v120, v96, v96, v120
v_dot2_f32_bf16 v118, v104, s43, v118
v_dot2_f32_bf16 v122, v104, v104, v122
v_dot2_f32_bf16 v117, v97, s43, v117
v_dot2_f32_bf16 v121, v97, v97, v121
v_dot2_f32_bf16 v119, v105, s43, v119
v_dot2_f32_bf16 v123, v105, v105, v123
v_dot2_f32_bf16 v116, v98, s43, v116
v_dot2_f32_bf16 v120, v98, v98, v120
v_dot2_f32_bf16 v118, v106, s43, v118
v_dot2_f32_bf16 v122, v106, v106, v122
v_dot2_f32_bf16 v117, v99, s43, v117
v_dot2_f32_bf16 v121, v99, v99, v121
v_dot2_f32_bf16 v119, v107, s43, v119
v_dot2_f32_bf16 v123, v107, v107, v123
v_dot2_f32_bf16 v116, v100, s43, v116
v_dot2_f32_bf16 v120, v100, v100, v120
v_dot2_f32_bf16 v118, v108, s43, v118
v_dot2_f32_bf16 v122, v108, v108, v122
v_dot2_f32_bf16 v117, v101, s43, v117
v_dot2_f32_bf16 v121, v101, v101, v121
v_dot2_f32_bf16 v119, v109, s43, v119
v_dot2_f32_bf16 v123, v109, v109, v123
v_dot2_f32_bf16 v116, v102, s43, v116
v_dot2_f32_bf16 v120, v102, v102, v120
v_dot2_f32_bf16 v118, v110, s43, v118
v_dot2_f32_bf16 v122, v110, v110, v122
v_dot2_f32_bf16 v117, v103, s43, v117
v_dot2_f32_bf16 v121, v103, v103, v121
v_dot2_f32_bf16 v119, v111, s43, v119
v_dot2_f32_bf16 v123, v111, v111, v123
s_nop 2
v_add_f32 v116, v116, v117
v_add_f32 v118, v118, v119
v_add_f32 v120, v120, v121
v_add_f32 v122, v122, v123
s_nop 1
v_permlane32_swap_b32 v116, v118
v_permlane32_swap_b32 v120, v122
v_add_f32 v116, v116, v118
v_add_f32 v120, v120, v122
s_nop 1
v_permlane16_swap_b32 v116, v120
v_add_f32 v116, v116, v120
s_nop 1
v_add_f32_dpp v116, v116, v116 row_ror:8 row_mask:0xf bank_mask:0xf
s_nop 1
v_add_f32_dpp v116, v116, v116 row_ror:4 row_mask:0xf bank_mask:0xf
s_nop 1
v_add_f32_dpp v116, v116, v116 row_ror:2 row_mask:0xf bank_mask:0xf
s_nop 1
v_add_f32_dpp v116, v116, v116 row_ror:1 row_mask:0xf bank_mask:0xf
v_mov_b32 v117, v116
s_nop 1
v_permlane16_swap_b32 v116, v117
v_mul_f32 v112, 0x3a800000, v116
v_mul_f32 v113, 0x3a800000, v117
v_fma_f32 v113, -v112, v112, v113
v_max_f32 v113, 0, v113
v_add_f32 v113, 0x3727c5ac, v113
v_rsq_f32 v113, v113
v_lshrrev_b32 v11, 5, v1
s_lshl_b32 s43, s47, 4
s_add_u32 s43, s43, 148608
v_lshl_add_u32 v11, v11, 3, s43
ds_write_b64 v11, v[112:113]
s_waitcnt lgkmcnt(0)
s_mov_b32 s43, 4325376
buffer_load_dword v31, v3, s[12:15], s43 offen
s_mov_b32 s43, 4718592
buffer_load_dword v31, v3, s[12:15], s43 offen
s_mov_b32 s43, 5111808
buffer_load_dword v31, v3, s[12:15], s43 offen
s_mov_b32 s43, 5505024
buffer_load_dword v31, v3, s[12:15], s43 offen
s_barrier
v_lshlrev_b32 v5, 4, v1
v_and_b32 v5, 63, v5
v_add_u32 v6, 148608, v5
ds_read_b128 v[112:115], v6
s_lshl_b32 s43, s63, 3
v_add_u32 v5, s43, v5
s_waitcnt lgkmcnt(0)
s_mov_b64 exec, 15
buffer_store_dwordx4 v[112:115], v5, s[20:23], 0 offen sc1
s_mov_b64 exec, -1
s_mov_b32 s43, 5898240
buffer_load_dword v31, v3, s[12:15], s43 offen
s_barrier
v_mov_b32 v4, 0
buffer_load_dword v6, v4, s[56:59], 0 offen sc1
s_mov_b32 s62, 0
s_barrier
s_cmp_eq_u32 s62, 3
s_cbranch_scc1 Lste_15
s_cmp_eq_u32 s62, 2
s_cbranch_scc1 Lst2_14
s_waitcnt lgkmcnt(0)
s_cmp_eq_u32 s62, 1
s_cbranch_scc1 Lst1_13
s_waitcnt vmcnt(0)
v_readfirstlane_b32 s54, v6
s_cmp_eq_u32 s54, 0
s_cbranch_scc0 Lrep_16
buffer_load_dword v6, v4, s[56:59], 0 offen sc1
s_branch Lste_15
Lrep_16:
s_add_u32 s7, s34, 64
s_lshl_b32 s7, s7, 7
v_mov_b32 v5, s7
v_mov_b32 v6, 1
s_mov_b64 exec, 1
buffer_atomic_add v6, v5, s[84:87], 0 offen sc1
s_mov_b64 exec, -1
s_mov_b32 s62, 1
s_load_dword s54, s[82:83], s52 glc
s_load_dword s55, s[82:83], s53 glc
s_branch Lste_15
Lst1_13:
s_and_b32 s54, s54, s55
s_cmp_eq_u32 s54, 16
s_cbranch_scc1 Lg_17
s_load_dword s54, s[82:83], s52 glc
s_load_dword s55, s[82:83], s53 glc
s_branch Lste_15
Lg_17:
v_add_u32 v5, 0, v1
v_min_u32 v5, 143, v5
v_lshlrev_b32 v20, 3, v5
v_add_u32 v5, s50, v5
v_max_i32 v5, 0, v5
v_lshlrev_b32 v5, 3, v5
buffer_load_dwordx2 v[32:33], v5, s[20:23], 0 offen sc1
v_add_u32 v5, 64, v1
v_min_u32 v5, 143, v5
v_lshlrev_b32 v21, 3, v5
v_add_u32 v5, s50, v5
v_max_i32 v5, 0, v5
v_lshlrev_b32 v5, 3, v5
buffer_load_dwordx2 v[34:35], v5, s[20:23], 0 offen sc1
v_add_u32 v5, 128, v1
v_min_u32 v5, 143, v5
v_lshlrev_b32 v22, 3, v5
v_add_u32 v5, s50, v5
v_max_i32 v5, 0, v5
v_lshlrev_b32 v5, 3, v5
buffer_load_dwordx2 v[36:37], v5, s[20:23], 0 offen sc1
s_mov_b32 s62, 2
s_branch Lste_15
Lst2_14:
s_waitcnt vmcnt(0)
v_add_u32 v20, 147456, v20
ds_write_b64 v20, v[32:33]
v_add_u32 v21, 147456, v21
ds_write_b64 v21, v[34:35]
v_add_u32 v22, 147456, v22
ds_write_b64 v22, v[36:37]
s_waitcnt lgkmcnt(0)
s_mov_b32 s62, 3
Lste_15:
s_barrier
s_cmp_eq_u32 s62, 3
s_cbranch_scc1 Lste_20
s_cmp_eq_u32 s62, 2
s_cbranch_scc1 Lst2_19
s_waitcnt lgkmcnt(0)
s_cmp_eq_u32 s62, 1
s_cbranch_scc1 Lst1_18
s_waitcnt vmcnt(0)
v_readfirstlane_b32 s54, v6
s_cmp_eq_u32 s54, 0
s_cbranch_scc0 Lrep_21
buffer_load_dword v6, v4, s[56:59], 0 offen sc1
s_branch Lste_20
Lrep_21:
s_add_u32 s7, s34, 64
s_lshl_b32 s7, s7, 7
v_mov_b32 v5, s7
v_mov_b32 v6, 1
s_mov_b64 exec, 1
buffer_atomic_add v6, v5, s[84:87], 0 offen sc1
s_mov_b64 exec, -1
s_mov_b32 s62, 1
s_load_dword s54, s[82:83], s52 glc
s_load_dword s55, s[82:83], s53 glc
s_branch Lste_20
Lst1_18:
s_and_b32 s54, s54, s55
s_cmp_eq_u32 s54, 16
s_cbranch_scc1 Lg_22
s_load_dword s54, s[82:83], s52 glc
s_load_dword s55, s[82:83], s53 glc
s_branch Lste_20
Lg_22:
v_add_u32 v5, 0, v1
v_min_u32 v5, 143, v5
v_lshlrev_b32 v20, 3, v5
v_add_u32 v5, s50, v5
v_max_i32 v5, 0, v5
v_lshlrev_b32 v5, 3, v5
buffer_load_dwordx2 v[32:33], v5, s[20:23], 0 offen sc1
v_add_u32 v5, 64, v1
v_min_u32 v5, 143, v5
v_lshlrev_b32 v21, 3, v5
v_add_u32 v5, s50, v5
v_max_i32 v5, 0, v5
v_lshlrev_b32 v5, 3, v5
buffer_load_dwordx2 v[34:35], v5, s[20:23], 0 offen sc1
v_add_u32 v5, 128, v1
v_min_u32 v5, 143, v5
v_lshlrev_b32 v22, 3, v5
v_add_u32 v5, s50, v5
v_max_i32 v5, 0, v5
v_lshlrev_b32 v5, 3, v5
buffer_load_dwordx2 v[36:37], v5, s[20:23], 0 offen sc1
s_mov_b32 s62, 2
s_branch Lste_20
Lst2_19:
s_waitcnt vmcnt(0)
v_add_u32 v20, 147456, v20
ds_write_b64 v20, v[32:33]
v_add_u32 v21, 147456, v21
ds_write_b64 v21, v[34:35]
v_add_u32 v22, 147456, v22
ds_write_b64 v22, v[36:37]
s_waitcnt lgkmcnt(0)
s_mov_b32 s62, 3
Lste_20:
s_barrier
s_cmp_eq_u32 s62, 3
s_cbranch_scc1 Lste_25
s_cmp_eq_u32 s62, 2
s_cbranch_scc1 Lst2_24
s_waitcnt lgkmcnt(0)
s_cmp_eq_u32 s62, 1
s_cbranch_scc1 Lst1_23
s_waitcnt vmcnt(0)
v_readfirstlane_b32 s54, v6
s_cmp_eq_u32 s54, 0
s_cbranch_scc0 Lrep_26
buffer_load_dword v6, v4, s[56:59], 0 offen sc1
s_branch Lste_25
Lrep_26:
s_add_u32 s7, s34, 64
s_lshl_b32 s7, s7, 7
v_mov_b32 v5, s7
v_mov_b32 v6, 1
s_mov_b64 exec, 1
buffer_atomic_add v6, v5, s[84:87], 0 offen sc1
s_mov_b64 exec, -1
s_mov_b32 s62, 1
s_load_dword s54, s[82:83], s52 glc
s_load_dword s55, s[82:83], s53 glc
s_branch Lste_25
Lst1_23:
s_and_b32 s54, s54, s55
s_cmp_eq_u32 s54, 16
s_cbranch_scc1 Lg_27
s_load_dword s54, s[82:83], s52 glc
s_load_dword s55, s[82:83], s53 glc
s_branch Lste_25
Lg_27:
v_add_u32 v5, 0, v1
v_min_u32 v5, 143, v5
v_lshlrev_b32 v20, 3, v5
v_add_u32 v5, s50, v5
v_max_i32 v5, 0, v5
v_lshlrev_b32 v5, 3, v5
buffer_load_dwordx2 v[32:33], v5, s[20:23], 0 offen sc1
v_add_u32 v5, 64, v1
v_min_u32 v5, 143, v5
v_lshlrev_b32 v21, 3, v5
v_add_u32 v5, s50, v5
v_max_i32 v5, 0, v5
v_lshlrev_b32 v5, 3, v5
buffer_load_dwordx2 v[34:35], v5, s[20:23], 0 offen sc1
v_add_u32 v5, 128, v1
v_min_u32 v5, 143, v5
v_lshlrev_b32 v22, 3, v5
v_add_u32 v5, s50, v5
v_max_i32 v5, 0, v5
v_lshlrev_b32 v5, 3, v5
buffer_load_dwordx2 v[36:37], v5, s[20:23], 0 offen sc1
s_mov_b32 s62, 2
s_branch Lste_25
Lst2_24:
s_waitcnt vmcnt(0)
v_add_u32 v20, 147456, v20
ds_write_b64 v20, v[32:33]
v_add_u32 v21, 147456, v21
ds_write_b64 v21, v[34:35]
v_add_u32 v22, 147456, v22
ds_write_b64 v22, v[36:37]
s_waitcnt lgkmcnt(0)
s_mov_b32 s62, 3
Lste_25:
s_barrier
s_cmp_eq_u32 s62, 3
s_cbranch_scc1 Lste_30
s_cmp_eq_u32 s62, 2
s_cbranch_scc1 Lst2_29
s_waitcnt lgkmcnt(0)
s_cmp_eq_u32 s62, 1
s_cbranch_scc1 Lst1_28
s_waitcnt vmcnt(0)
v_readfirstlane_b32 s54, v6
s_cmp_eq_u32 s54, 0
s_cbranch_scc0 Lrep_31
buffer_load_dword v6, v4, s[56:59], 0 offen sc1
s_branch Lste_30
Lrep_31:
s_add_u32 s7, s34, 64
s_lshl_b32 s7, s7, 7
v_mov_b32 v5, s7
v_mov_b32 v6, 1
s_mov_b64 exec, 1
buffer_atomic_add v6, v5, s[84:87], 0 offen sc1
s_mov_b64 exec, -1
s_mov_b32 s62, 1
s_load_dword s54, s[82:83], s52 glc
s_load_dword s55, s[82:83], s53 glc
s_branch Lste_30
Lst1_28:
s_and_b32 s54, s54, s55
s_cmp_eq_u32 s54, 16
s_cbranch_scc1 Lg_32
s_load_dword s54, s[82:83], s52 glc
s_load_dword s55, s[82:83], s53 glc
s_branch Lste_30
Lg_32:
v_add_u32 v5, 0, v1
v_min_u32 v5, 143, v5
v_lshlrev_b32 v20, 3, v5
v_add_u32 v5, s50, v5
v_max_i32 v5, 0, v5
v_lshlrev_b32 v5, 3, v5
buffer_load_dwordx2 v[32:33], v5, s[20:23], 0 offen sc1
v_add_u32 v5, 64, v1
v_min_u32 v5, 143, v5
v_lshlrev_b32 v21, 3, v5
v_add_u32 v5, s50, v5
v_max_i32 v5, 0, v5
v_lshlrev_b32 v5, 3, v5
buffer_load_dwordx2 v[34:35], v5, s[20:23], 0 offen sc1
v_add_u32 v5, 128, v1
v_min_u32 v5, 143, v5
v_lshlrev_b32 v22, 3, v5
v_add_u32 v5, s50, v5
v_max_i32 v5, 0, v5
v_lshlrev_b32 v5, 3, v5
buffer_load_dwordx2 v[36:37], v5, s[20:23], 0 offen sc1
s_mov_b32 s62, 2
s_branch Lste_30
Lst2_29:
s_waitcnt vmcnt(0)
v_add_u32 v20, 147456, v20
ds_write_b64 v20, v[32:33]
v_add_u32 v21, 147456, v21
ds_write_b64 v21, v[34:35]
v_add_u32 v22, 147456, v22
ds_write_b64 v22, v[36:37]
s_waitcnt lgkmcnt(0)
s_mov_b32 s62, 3
Lste_30:
s_barrier
s_cmp_eq_u32 s62, 3
s_cbranch_scc1 Lste_35
s_cmp_eq_u32 s62, 2
s_cbranch_scc1 Lst2_34
s_waitcnt lgkmcnt(0)
s_cmp_eq_u32 s62, 1
s_cbranch_scc1 Lst1_33
s_waitcnt vmcnt(0)
v_readfirstlane_b32 s54, v6
s_cmp_eq_u32 s54, 0
s_cbranch_scc0 Lrep_36
buffer_load_dword v6, v4, s[56:59], 0 offen sc1
s_branch Lste_35
Lrep_36:
s_add_u32 s7, s34, 64
s_lshl_b32 s7, s7, 7
v_mov_b32 v5, s7
v_mov_b32 v6, 1
s_mov_b64 exec, 1
buffer_atomic_add v6, v5, s[84:87], 0 offen sc1
s_mov_b64 exec, -1
s_mov_b32 s62, 1
s_load_dword s54, s[82:83], s52 glc
s_load_dword s55, s[82:83], s53 glc
s_branch Lste_35
Lst1_33:
s_and_b32 s54, s54, s55
s_cmp_eq_u32 s54, 16
s_cbranch_scc1 Lg_37
s_load_dword s54, s[82:83], s52 glc
s_load_dword s55, s[82:83], s53 glc
s_branch Lste_35
Lg_37:
v_add_u32 v5, 0, v1
v_min_u32 v5, 143, v5
v_lshlrev_b32 v20, 3, v5
v_add_u32 v5, s50, v5
v_max_i32 v5, 0, v5
v_lshlrev_b32 v5, 3, v5
buffer_load_dwordx2 v[32:33], v5, s[20:23], 0 offen sc1
v_add_u32 v5, 64, v1
v_min_u32 v5, 143, v5
v_lshlrev_b32 v21, 3, v5
v_add_u32 v5, s50, v5
v_max_i32 v5, 0, v5
v_lshlrev_b32 v5, 3, v5
buffer_load_dwordx2 v[34:35], v5, s[20:23], 0 offen sc1
v_add_u32 v5, 128, v1
v_min_u32 v5, 143, v5
v_lshlrev_b32 v22, 3, v5
v_add_u32 v5, s50, v5
v_max_i32 v5, 0, v5
v_lshlrev_b32 v5, 3, v5
buffer_load_dwordx2 v[36:37], v5, s[20:23], 0 offen sc1
s_mov_b32 s62, 2
s_branch Lste_35
Lst2_34:
s_waitcnt vmcnt(0)
v_add_u32 v20, 147456, v20
ds_write_b64 v20, v[32:33]
v_add_u32 v21, 147456, v21
ds_write_b64 v21, v[34:35]
v_add_u32 v22, 147456, v22
ds_write_b64 v22, v[36:37]
s_waitcnt lgkmcnt(0)
s_mov_b32 s62, 3
Lste_35:
s_barrier
s_cmp_eq_u32 s62, 3
s_cbranch_scc1 Lste_40
s_cmp_eq_u32 s62, 2
s_cbranch_scc1 Lst2_39
s_waitcnt lgkmcnt(0)
s_cmp_eq_u32 s62, 1
s_cbranch_scc1 Lst1_38
s_waitcnt vmcnt(0)
v_readfirstlane_b32 s54, v6
s_cmp_eq_u32 s54, 0
s_cbranch_scc0 Lrep_41
buffer_load_dword v6, v4, s[56:59], 0 offen sc1
s_branch Lste_40
Lrep_41:
s_add_u32 s7, s34, 64
s_lshl_b32 s7, s7, 7
v_mov_b32 v5, s7
v_mov_b32 v6, 1
s_mov_b64 exec, 1
buffer_atomic_add v6, v5, s[84:87], 0 offen sc1
s_mov_b64 exec, -1
s_mov_b32 s62, 1
s_load_dword s54, s[82:83], s52 glc
s_load_dword s55, s[82:83], s53 glc
s_branch Lste_40
Lst1_38:
s_and_b32 s54, s54, s55
s_cmp_eq_u32 s54, 16
s_cbranch_scc1 Lg_42
s_load_dword s54, s[82:83], s52 glc
s_load_dword s55, s[82:83], s53 glc
s_branch Lste_40
Lg_42:
v_add_u32 v5, 0, v1
v_min_u32 v5, 143, v5
v_lshlrev_b32 v20, 3, v5
v_add_u32 v5, s50, v5
v_max_i32 v5, 0, v5
v_lshlrev_b32 v5, 3, v5
buffer_load_dwordx2 v[32:33], v5, s[20:23], 0 offen sc1
s_branch Lov_3
.p2align 12
Lst_3_0:
s_branch Lst_7_0
s_nop 0
Lov_3:
v_add_u32 v5, 64, v1
v_min_u32 v5, 143, v5
v_lshlrev_b32 v21, 3, v5
v_add_u32 v5, s50, v5
v_max_i32 v5, 0, v5
v_lshlrev_b32 v5, 3, v5
buffer_load_dwordx2 v[34:35], v5, s[20:23], 0 offen sc1
v_add_u32 v5, 128, v1
v_min_u32 v5, 143, v5
v_lshlrev_b32 v22, 3, v5
v_add_u32 v5, s50, v5
v_max_i32 v5, 0, v5
v_lshlrev_b32 v5, 3, v5
buffer_load_dwordx2 v[36:37], v5, s[20:23], 0 offen sc1
s_mov_b32 s62, 2
s_branch Lste_40
Lst2_39:
s_waitcnt vmcnt(0)
v_add_u32 v20, 147456, v20
ds_write_b64 v20, v[32:33]
v_add_u32 v21, 147456, v21
ds_write_b64 v21, v[34:35]
v_add_u32 v22, 147456, v22
ds_write_b64 v22, v[36:37]
s_waitcnt lgkmcnt(0)
s_mov_b32 s62, 3
Lste_40:
s_barrier
s_cmp_eq_u32 s62, 3
s_cbranch_scc1 Lste_45
s_cmp_eq_u32 s62, 2
s_cbranch_scc1 Lst2_44
s_waitcnt lgkmcnt(0)
s_cmp_eq_u32 s62, 1
s_cbranch_scc1 Lst1_43
s_waitcnt vmcnt(0)
v_readfirstlane_b32 s54, v6
s_cmp_eq_u32 s54, 0
s_cbranch_scc0 Lrep_46
buffer_load_dword v6, v4, s[56:59], 0 offen sc1
s_branch Lste_45
Lrep_46:
s_add_u32 s7, s34, 64
s_lshl_b32 s7, s7, 7
v_mov_b32 v5, s7
v_mov_b32 v6, 1
s_mov_b64 exec, 1
buffer_atomic_add v6, v5, s[84:87], 0 offen sc1
s_mov_b64 exec, -1
s_mov_b32 s62, 1
s_load_dword s54, s[82:83], s52 glc
s_load_dword s55, s[82:83], s53 glc
s_branch Lste_45
Lst1_43:
s_and_b32 s54, s54, s55
s_cmp_eq_u32 s54, 16
s_cbranch_scc1 Lg_47
s_load_dword s54, s[82:83], s52 glc
s_load_dword s55, s[82:83], s53 glc
s_branch Lste_45
Lg_47:
v_add_u32 v5, 0, v1
v_min_u32 v5, 143, v5
v_lshlrev_b32 v20, 3, v5
v_add_u32 v5, s50, v5
v_max_i32 v5, 0, v5
v_lshlrev_b32 v5, 3, v5
buffer_load_dwordx2 v[32:33], v5, s[20:23], 0 offen sc1
v_add_u32 v5, 64, v1
v_min_u32 v5, 143, v5
v_lshlrev_b32 v21, 3, v5
v_add_u32 v5, s50, v5
v_max_i32 v5, 0, v5
v_lshlrev_b32 v5, 3, v5
buffer_load_dwordx2 v[34:35], v5, s[20:23], 0 offen sc1
v_add_u32 v5, 128, v1
v_min_u32 v5, 143, v5
v_lshlrev_b32 v22, 3, v5
v_add_u32 v5, s50, v5
v_max_i32 v5, 0, v5
v_lshlrev_b32 v5, 3, v5
buffer_load_dwordx2 v[36:37], v5, s[20:23], 0 offen sc1
s_mov_b32 s62, 2
s_branch Lste_45
Lst2_44:
s_waitcnt vmcnt(0)
v_add_u32 v20, 147456, v20
ds_write_b64 v20, v[32:33]
v_add_u32 v21, 147456, v21
ds_write_b64 v21, v[34:35]
v_add_u32 v22, 147456, v22
ds_write_b64 v22, v[36:37]
s_waitcnt lgkmcnt(0)
s_mov_b32 s62, 3
Lste_45:
s_barrier
s_cmp_eq_u32 s62, 3
s_cbranch_scc1 Lste_50
s_cmp_eq_u32 s62, 2
s_cbranch_scc1 Lst2_49
s_waitcnt lgkmcnt(0)
s_cmp_eq_u32 s62, 1
s_cbranch_scc1 Lst1_48
s_waitcnt vmcnt(0)
v_readfirstlane_b32 s54, v6
s_cmp_eq_u32 s54, 0
s_cbranch_scc0 Lrep_51
buffer_load_dword v6, v4, s[56:59], 0 offen sc1
s_branch Lste_50
Lrep_51:
s_add_u32 s7, s34, 64
s_lshl_b32 s7, s7, 7
v_mov_b32 v5, s7
v_mov_b32 v6, 1
s_mov_b64 exec, 1
buffer_atomic_add v6, v5, s[84:87], 0 offen sc1
s_mov_b64 exec, -1
s_mov_b32 s62, 1
s_load_dword s54, s[82:83], s52 glc
s_load_dword s55, s[82:83], s53 glc
s_branch Lste_50
Lst1_48:
s_and_b32 s54, s54, s55
s_cmp_eq_u32 s54, 16
s_cbranch_scc1 Lg_52
s_load_dword s54, s[82:83], s52 glc
s_load_dword s55, s[82:83], s53 glc
s_branch Lste_50
Lg_52:
v_add_u32 v5, 0, v1
v_min_u32 v5, 143, v5
v_lshlrev_b32 v20, 3, v5
v_add_u32 v5, s50, v5
v_max_i32 v5, 0, v5
v_lshlrev_b32 v5, 3, v5
buffer_load_dwordx2 v[32:33], v5, s[20:23], 0 offen sc1
v_add_u32 v5, 64, v1
v_min_u32 v5, 143, v5
v_lshlrev_b32 v21, 3, v5
v_add_u32 v5, s50, v5
v_max_i32 v5, 0, v5
v_lshlrev_b32 v5, 3, v5
buffer_load_dwordx2 v[34:35], v5, s[20:23], 0 offen sc1
v_add_u32 v5, 128, v1
v_min_u32 v5, 143, v5
v_lshlrev_b32 v22, 3, v5
v_add_u32 v5, s50, v5
v_max_i32 v5, 0, v5
v_lshlrev_b32 v5, 3, v5
buffer_load_dwordx2 v[36:37], v5, s[20:23], 0 offen sc1
s_mov_b32 s62, 2
s_branch Lste_50
Lst2_49:
s_waitcnt vmcnt(0)
v_add_u32 v20, 147456, v20
ds_write_b64 v20, v[32:33]
v_add_u32 v21, 147456, v21
ds_write_b64 v21, v[34:35]
v_add_u32 v22, 147456, v22
ds_write_b64 v22, v[36:37]
s_waitcnt lgkmcnt(0)
s_mov_b32 s62, 3
Lste_50:
s_barrier
s_cmp_eq_u32 s62, 3
s_cbranch_scc1 Lste_55
s_cmp_eq_u32 s62, 2
s_cbranch_scc1 Lst2_54
s_waitcnt lgkmcnt(0)
s_cmp_eq_u32 s62, 1
s_cbranch_scc1 Lst1_53
s_waitcnt vmcnt(0)
v_readfirstlane_b32 s54, v6
s_cmp_eq_u32 s54, 0
s_cbranch_scc0 Lrep_56
buffer_load_dword v6, v4, s[56:59], 0 offen sc1
s_branch Lste_55
Lrep_56:
s_add_u32 s7, s34, 64
s_lshl_b32 s7, s7, 7
v_mov_b32 v5, s7
v_mov_b32 v6, 1
s_mov_b64 exec, 1
buffer_atomic_add v6, v5, s[84:87], 0 offen sc1
s_mov_b64 exec, -1
s_mov_b32 s62, 1
s_load_dword s54, s[82:83], s52 glc
s_load_dword s55, s[82:83], s53 glc
s_branch Lste_55
Lst1_53:
s_and_b32 s54, s54, s55
s_cmp_eq_u32 s54, 16
s_cbranch_scc1 Lg_57
s_load_dword s54, s[82:83], s52 glc
s_load_dword s55, s[82:83], s53 glc
s_branch Lste_55
Lg_57:
v_add_u32 v5, 0, v1
v_min_u32 v5, 143, v5
v_lshlrev_b32 v20, 3, v5
v_add_u32 v5, s50, v5
v_max_i32 v5, 0, v5
v_lshlrev_b32 v5, 3, v5
buffer_load_dwordx2 v[32:33], v5, s[20:23], 0 offen sc1
v_add_u32 v5, 64, v1
v_min_u32 v5, 143, v5
v_lshlrev_b32 v21, 3, v5
v_add_u32 v5, s50, v5
v_max_i32 v5, 0, v5
v_lshlrev_b32 v5, 3, v5
buffer_load_dwordx2 v[34:35], v5, s[20:23], 0 offen sc1
v_add_u32 v5, 128, v1
v_min_u32 v5, 143, v5
v_lshlrev_b32 v22, 3, v5
v_add_u32 v5, s50, v5
v_max_i32 v5, 0, v5
v_lshlrev_b32 v5, 3, v5
buffer_load_dwordx2 v[36:37], v5, s[20:23], 0 offen sc1
s_mov_b32 s62, 2
s_branch Lste_55
Lst2_54:
s_waitcnt vmcnt(0)
v_add_u32 v20, 147456, v20
ds_write_b64 v20, v[32:33]
v_add_u32 v21, 147456, v21
ds_write_b64 v21, v[34:35]
v_add_u32 v22, 147456, v22
ds_write_b64 v22, v[36:37]
s_waitcnt lgkmcnt(0)
s_mov_b32 s62, 3
Lste_55:
s_barrier
s_cmp_eq_u32 s62, 3
s_cbranch_scc1 Lste_60
s_cmp_eq_u32 s62, 2
s_cbranch_scc1 Lst2_59
s_waitcnt lgkmcnt(0)
s_cmp_eq_u32 s62, 1
s_cbranch_scc1 Lst1_58
s_waitcnt vmcnt(0)
v_readfirstlane_b32 s54, v6
s_cmp_eq_u32 s54, 0
s_cbranch_scc0 Lrep_61
buffer_load_dword v6, v4, s[56:59], 0 offen sc1
s_branch Lste_60
Lrep_61:
s_add_u32 s7, s34, 64
s_lshl_b32 s7, s7, 7
v_mov_b32 v5, s7
v_mov_b32 v6, 1
s_mov_b64 exec, 1
buffer_atomic_add v6, v5, s[84:87], 0 offen sc1
s_mov_b64 exec, -1
s_mov_b32 s62, 1
s_load_dword s54, s[82:83], s52 glc
s_load_dword s55, s[82:83], s53 glc
s_branch Lste_60
Lst1_58:
s_and_b32 s54, s54, s55
s_cmp_eq_u32 s54, 16
s_cbranch_scc1 Lg_62
s_load_dword s54, s[82:83], s52 glc
s_load_dword s55, s[82:83], s53 glc
s_branch Lste_60
Lg_62:
v_add_u32 v5, 0, v1
v_min_u32 v5, 143, v5
v_lshlrev_b32 v20, 3, v5
v_add_u32 v5, s50, v5
v_max_i32 v5, 0, v5
v_lshlrev_b32 v5, 3, v5
buffer_load_dwordx2 v[32:33], v5, s[20:23], 0 offen sc1
v_add_u32 v5, 64, v1
v_min_u32 v5, 143, v5
v_lshlrev_b32 v21, 3, v5
v_add_u32 v5, s50, v5
v_max_i32 v5, 0, v5
v_lshlrev_b32 v5, 3, v5
buffer_load_dwordx2 v[34:35], v5, s[20:23], 0 offen sc1
v_add_u32 v5, 128, v1
v_min_u32 v5, 143, v5
v_lshlrev_b32 v22, 3, v5
v_add_u32 v5, s50, v5
v_max_i32 v5, 0, v5
v_lshlrev_b32 v5, 3, v5
buffer_load_dwordx2 v[36:37], v5, s[20:23], 0 offen sc1
s_mov_b32 s62, 2
s_branch Lste_60
Lst2_59:
s_waitcnt vmcnt(0)
v_add_u32 v20, 147456, v20
ds_write_b64 v20, v[32:33]
v_add_u32 v21, 147456, v21
ds_write_b64 v21, v[34:35]
v_add_u32 v22, 147456, v22
ds_write_b64 v22, v[36:37]
s_waitcnt lgkmcnt(0)
s_mov_b32 s62, 3
Lste_60:
s_barrier
s_cmp_eq_u32 s62, 3
s_cbranch_scc1 Lste_65
s_cmp_eq_u32 s62, 2
s_cbranch_scc1 Lst2_64
s_cmp_eq_u32 s62, 1
s_cbranch_scc1 Lst1_63
s_mov_b32 s41, 0x40000
Lz0_66:
s_waitcnt vmcnt(0)
v_readfirstlane_b32 s54, v6
s_cmp_eq_u32 s54, 0
s_cbranch_scc0 Lzok_67
buffer_load_dword v6, v4, s[56:59], 0 offen sc1
s_sub_u32 s41, s41, 1
s_cmp_lg_u32 s41, 0
s_cbranch_scc1 Lz0_66
s_waitcnt lgkmcnt(0)
Lzok_67:
s_add_u32 s7, s34, 64
s_lshl_b32 s7, s7, 7
v_mov_b32 v5, s7
v_mov_b32 v6, 1
s_mov_b64 exec, 1
buffer_atomic_add v6, v5, s[84:87], 0 offen sc1
s_mov_b64 exec, -1
s_load_dword s54, s[82:83], s52 glc
s_load_dword s55, s[82:83], s53 glc
Lst1_63:
s_mov_b32 s41, 200
Lpoll_68:
s_waitcnt lgkmcnt(0)
s_and_b32 s54, s54, s55
s_cmp_eq_u32 s54, 16
s_cbranch_scc1 Lg_70
s_load_dword s54, s[82:83], s52 glc
s_load_dword s55, s[82:83], s53 glc
s_sub_u32 s41, s41, 1
s_cmp_lg_u32 s41, 0
s_cbranch_scc1 Lpoll_68
s_waitcnt lgkmcnt(0)
s_mov_b32 s41, 0
Lfb_69:
s_add_u32 s62, s50, s41
s_max_i32 s62, s62, 0
s_lshl_b32 s43, s62, 11
buffer_load_dwordx4 v[96:99], v10, s[8:11], s43 offen offset:0
buffer_load_dwordx4 v[100:103], v10, s[8:11], s43 offen offset:1024
buffer_load_dwordx4 v[104:107], v10, s[8:11], s43 offen offset:2048
buffer_load_dwordx4 v[108:111], v10, s[8:11], s43 offen offset:3072
s_waitcnt vmcnt(0)
s_mov_b32 s43, 0x3f803f80
v_mov_b32 v116, 0
v_mov_b32 v117, 0
v_mov_b32 v118, 0
v_mov_b32 v119, 0
v_mov_b32 v120, 0
v_mov_b32 v121, 0
v_mov_b32 v122, 0
v_mov_b32 v123, 0
v_dot2_f32_bf16 v116, v96, s43, v116
v_dot2_f32_bf16 v120, v96, v96, v120
v_dot2_f32_bf16 v118, v104, s43, v118
v_dot2_f32_bf16 v122, v104, v104, v122
v_dot2_f32_bf16 v117, v97, s43, v117
v_dot2_f32_bf16 v121, v97, v97, v121
v_dot2_f32_bf16 v119, v105, s43, v119
v_dot2_f32_bf16 v123, v105, v105, v123
v_dot2_f32_bf16 v116, v98, s43, v116
v_dot2_f32_bf16 v120, v98, v98, v120
v_dot2_f32_bf16 v118, v106, s43, v118
v_dot2_f32_bf16 v122, v106, v106, v122
v_dot2_f32_bf16 v117, v99, s43, v117
v_dot2_f32_bf16 v121, v99, v99, v121
v_dot2_f32_bf16 v119, v107, s43, v119
v_dot2_f32_bf16 v123, v107, v107, v123
v_dot2_f32_bf16 v116, v100, s43, v116
v_dot2_f32_bf16 v120, v100, v100, v120
v_dot2_f32_bf16 v118, v108, s43, v118
v_dot2_f32_bf16 v122, v108, v108, v122
v_dot2_f32_bf16 v117, v101, s43, v117
v_dot2_f32_bf16 v121, v101, v101, v121
v_dot2_f32_bf16 v119, v109, s43, v119
v_dot2_f32_bf16 v123, v109, v109, v123
v_dot2_f32_bf16 v116, v102, s43, v116
v_dot2_f32_bf16 v120, v102, v102, v120
v_dot2_f32_bf16 v118, v110, s43, v118
v_dot2_f32_bf16 v122, v110, v110, v122
v_dot2_f32_bf16 v117, v103, s43, v117
v_dot2_f32_bf16 v121, v103, v103, v121
v_dot2_f32_bf16 v119, v111, s43, v119
v_dot2_f32_bf16 v123, v111, v111, v123
s_nop 2
v_add_f32 v116, v116, v117
v_add_f32 v118, v118, v119
v_add_f32 v120, v120, v121
v_add_f32 v122, v122, v123
s_nop 1
v_permlane32_swap_b32 v116, v118
v_permlane32_swap_b32 v120, v122
v_add_f32 v116, v116, v118
v_add_f32 v120, v120, v122
s_nop 1
v_permlane16_swap_b32 v116, v120
v_add_f32 v116, v116, v120
s_nop 1
v_add_f32_dpp v116, v116, v116 row_ror:8 row_mask:0xf bank_mask:0xf
s_nop 1
v_add_f32_dpp v116, v116, v116 row_ror:4 row_mask:0xf bank_mask:0xf
s_nop 1
v_add_f32_dpp v116, v116, v116 row_ror:2 row_mask:0xf bank_mask:0xf
s_nop 1
v_add_f32_dpp v116, v116, v116 row_ror:1 row_mask:0xf bank_mask:0xf
v_mov_b32 v117, v116
s_nop 1
v_permlane16_swap_b32 v116, v117
v_mul_f32 v112, 0x3a800000, v116
v_mul_f32 v113, 0x3a800000, v117
v_fma_f32 v113, -v112, v112, v113
v_max_f32 v113, 0, v113
v_add_f32 v113, 0x3727c5ac, v113
v_rsq_f32 v113, v113
v_lshrrev_b32 v11, 5, v1
s_lshl_b32 s43, s41, 3
s_add_u32 s43, s43, 147456
v_lshl_add_u32 v11, v11, 3, s43
ds_write_b64 v11, v[112:113]
s_add_u32 s41, s41, 2
s_cmp_lt_u32 s41, 144
s_cbranch_scc1 Lfb_69
s_waitcnt lgkmcnt(0)
s_branch Lste_65
Lg_70:
v_add_u32 v5, 0, v1
v_min_u32 v5, 143, v5
v_lshlrev_b32 v20, 3, v5
v_add_u32 v5, s50, v5
v_max_i32 v5, 0, v5
v_lshlrev_b32 v5, 3, v5
buffer_load_dwordx2 v[32:33], v5, s[20:23], 0 offen sc1
v_add_u32 v5, 64, v1
v_min_u32 v5, 143, v5
v_lshlrev_b32 v21, 3, v5
v_add_u32 v5, s50, v5
v_max_i32 v5, 0, v5
v_lshlrev_b32 v5, 3, v5
buffer_load_dwordx2 v[34:35], v5, s[20:23], 0 offen sc1
v_add_u32 v5, 128, v1
v_min_u32 v5, 143, v5
v_lshlrev_b32 v22, 3, v5
v_add_u32 v5, s50, v5
v_max_i32 v5, 0, v5
v_lshlrev_b32 v5, 3, v5
buffer_load_dwordx2 v[36:37], v5, s[20:23], 0 offen sc1
Lst2_64:
s_waitcnt vmcnt(0)
v_add_u32 v20, 147456, v20
ds_write_b64 v20, v[32:33]
v_add_u32 v21, 147456, v21
ds_write_b64 v21, v[34:35]
v_add_u32 v22, 147456, v22
ds_write_b64 v22, v[36:37]
s_waitcnt lgkmcnt(0)
Lste_65:
s_lshl_b32 s43, s35, 7
s_add_u32 s28, s68, s43
s_addc_u32 s29, s69, 0
s_mov_b32 s30, 2095232
s_mov_b32 s31, 0x20000
v_and_b32 v29, 7, v1
v_lshrrev_b32 v30, 3, v1
v_lshl_add_u32 v29, v30, 6, v29
s_lshl_b32 s43, s48, 3
v_add_u32 v29, s43, v29
v_lshlrev_b32 v29, 11, v29
s_mov_b32 s43, 1048576
buffer_load_dword v30, v29, s[28:31], 0 offen
buffer_load_dword v30, v29, s[28:31], s43 offen
s_bitcmp0_b32 s2, 0
s_cselect_b32 s88, s72, s74
s_cselect_b32 s89, s73, s75
s_cmp_lt_u32 s2, 192
s_cselect_b32 s90, 7340032, 0
s_mov_b32 s91, 0x20000
s_bfe_u32 s44, s2, 0x30001
s_lshl_b32 s44, s44, 2
s_and_b32 s43, s36, 3
s_add_u32 s44, s44, s43
s_lshl_b32 s44, s44, 5
v_lshrrev_b32 v18, 4, v1
v_add_u32 v18, s44, v18
v_mul_u32_u24 v18, 7168, v18
v_and_b32 v19, 15, v1
v_lshl_add_u32 v18, v19, 4, v18
s_lshr_b32 s43, s2, 4
s_lshl_b32 s43, s43, 8
s_add_u32 s43, s43, 4096
v_add_u32 v18, s43, v18
s_mov_b32 s43, 0
buffer_load_dwordx4 v[128:131], v18, s[88:91], s43 offen
s_mov_b32 s43, 28672
buffer_load_dwordx4 v[132:135], v18, s[88:91], s43 offen
s_mov_b32 s43, 57344
buffer_load_dwordx4 v[136:139], v18, s[88:91], s43 offen
s_mov_b32 s43, 86016
buffer_load_dwordx4 v[140:143], v18, s[88:91], s43 offen
s_mov_b32 s43, 114688
buffer_load_dwordx4 v[144:147], v18, s[88:91], s43 offen
s_mov_b32 s43, 143360
buffer_load_dwordx4 v[148:151], v18, s[88:91], s43 offen
s_mov_b32 s43, 172032
buffer_load_dwordx4 v[152:155], v18, s[88:91], s43 offen
s_mov_b32 s43, 200704
buffer_load_dwordx4 v[156:159], v18, s[88:91], s43 offen
s_barrier
s_lshl_b32 s43, s35, 7
s_add_u32 s24, s68, s43
s_addc_u32 s25, s69, 0
s_mov_b32 s26, 2095232
s_mov_b32 s27, 0x20000
v_lshrrev_b32 v15, 3, v1
v_and_b32 v16, 6, v15
v_and_b32 v14, 7, v1
v_xor_b32 v14, v14, v16
v_lshlrev_b32 v14, 4, v14
v_mul_u32_u24 v15, 2048, v15
v_add_u32 v14, v14, v15
s_sub_u32 s44, s36, 4
s_lshl_b32 s45, s44, 13
s_lshl_b32 s44, s44, 17
s_add_u32 m0, s45, 114688
s_add_u32 s43, s44, 0
buffer_load_dwordx4 v14, s[24:27], s43 offen lds
s_add_u32 m0, s45, 115712
s_add_u32 s43, s44, 16384
buffer_load_dwordx4 v14, s[24:27], s43 offen lds
s_add_u32 m0, s45, 116736
s_add_u32 s43, s44, 32768
buffer_load_dwordx4 v14, s[24:27], s43 offen lds
s_add_u32 m0, s45, 117760
s_add_u32 s43, s44, 49152
buffer_load_dwordx4 v14, s[24:27], s43 offen lds
s_add_u32 m0, s45, 118784
s_add_u32 s43, s44, 65536
buffer_load_dwordx4 v14, s[24:27], s43 offen lds
s_add_u32 m0, s45, 119808
s_add_u32 s43, s44, 81920
buffer_load_dwordx4 v14, s[24:27], s43 offen lds
s_add_u32 m0, s45, 120832
s_add_u32 s43, s44, 98304
buffer_load_dwordx4 v14, s[24:27], s43 offen lds
s_add_u32 m0, s45, 121856
s_add_u32 s43, s44, 114688
buffer_load_dwordx4 v14, s[24:27], s43 offen lds
Latt_5:
s_and_b32 s43, s36, 1
s_lshr_b32 s44, s36, 1
s_and_b32 s44, s44, 1
s_lshr_b32 s45, s36, 2
v_lshlrev_b32 v14, 2, v13
v_sub_u32 v14, v12, v14
v_subrev_u32 v15, 0, v14
v_cmp_ge_u32 s[52:53], 7, v15
v_add_u32 v15, 16, v15
v_cmp_ge_u32 s[84:85], 7, v15
v_subrev_u32 v15, 1, v14
v_cmp_ge_u32 s[54:55], 7, v15
v_add_u32 v15, 16, v15
v_cmp_ge_u32 s[86:87], 7, v15
v_subrev_u32 v15, 2, v14
v_cmp_ge_u32 s[56:57], 7, v15
v_add_u32 v15, 16, v15
v_cmp_ge_u32 s[88:89], 7, v15
v_subrev_u32 v15, 3, v14
v_cmp_ge_u32 s[58:59], 7, v15
v_add_u32 v15, 16, v15
v_cmp_ge_u32 s[90:91], 7, v15
s_lshl_b32 s46, s45, 6
s_add_u32 s46, s46, s44
s_add_u32 s46, s46, 16
v_lshl_add_u32 v14, v12, 1, s46
s_lshl_b32 s47, s43, 6
v_lshl_add_u32 v15, v13, 4, s47
v_mul_u32_u24 v2, 400, v14
v_add_u32 v2, v2, v15
v_subrev_u32 v16, 32, v14
v_max_i32 v16, 0, v16
v_mul_u32_u24 v3, 400, v16
v_add_u32 v3, v3, v15
v_lshrrev_b32 v16, 2, v12
v_lshl_add_u32 v16, v13, 2, v16
v_lshl_add_u32 v16, v16, 1, s46
v_and_b32 v17, 3, v1
v_lshl_add_u32 v17, v17, 3, s47
v_mul_u32_u24 v4, 400, v16
v_add_u32 v4, v4, v17
v_subrev_u32 v16, 32, v16
v_max_i32 v16, 0, v16
v_mul_u32_u24 v5, 400, v16
v_add_u32 v5, v5, v17
s_mul_i32 s60, s34, 262144
s_add_u32 s16, s82, s60
s_addc_u32 s17, s83, 0
s_mov_b32 s18, 262144
s_mov_b32 s19, 0x20000
s_lshl_b32 s60, s35, 14
s_lshl_b32 s43, s43, 13
s_add_u32 s60, s60, s43
s_lshl_b32 s43, s45, 12
s_add_u32 s60, s60, s43
s_lshl_b32 s43, s44, 10
s_add_u32 s60, s60, s43
v_lshlrev_b32 v6, 4, v1
v_mov_b32 v8, 0xff800000
s_mov_b32 s61, 0x3e8293ee
s_or_b32 s62, s34, s45
s_barrier
ds_read_b128 v[32:35], v2 offset:0
ds_read_b128 v[36:39], v2 offset:128
ds_read_b128 v[40:43], v3 offset:128
ds_read_b128 v[80:83], v2 offset:12800
ds_read_b128 v[84:87], v2 offset:12928
ds_read_b128 v[88:91], v2 offset:128
ds_read_b64_tr_b16 v[44:45], v5 offset:256
ds_read_b64_tr_b16 v[46:47], v4 offset:256
ds_read_b64_tr_b16 v[48:49], v5 offset:288
ds_read_b64_tr_b16 v[50:51], v4 offset:288
ds_read_b64_tr_b16 v[92:93], v4 offset:256
ds_read_b64_tr_b16 v[94:95], v4 offset:13056
ds_read_b64_tr_b16 v[96:97], v4 offset:288
ds_read_b64_tr_b16 v[98:99], v4 offset:13088
s_waitcnt lgkmcnt(11)
v_mfma_f32_16x16x32_bf16 v[52:55], v[40:43], v[32:35], 0
v_mfma_f32_16x16x32_bf16 v[56:59], v[36:39], v[32:35], 0
s_waitcnt lgkmcnt(8)
v_mfma_f32_16x16x32_bf16 v[100:103], v[88:91], v[80:83], 0
v_mfma_f32_16x16x32_bf16 v[104:107], v[84:87], v[80:83], 0
s_cmp_lg_u32 s62, 0
s_cselect_b64 s[24:25], s[84:85], 0
s_cselect_b64 s[26:27], s[86:87], 0
s_cselect_b64 s[28:29], s[88:89], 0
s_cselect_b64 s[30:31], s[90:91], 0
s_nop 1
v_cndmask_b32 v52, v8, v52, s[24:25]
v_cndmask_b32 v100, v8, v100, s[84:85]
v_cndmask_b32 v53, v8, v53, s[26:27]
v_cndmask_b32 v101, v8, v101, s[86:87]
v_cndmask_b32 v54, v8, v54, s[28:29]
v_cndmask_b32 v102, v8, v102, s[88:89]
v_cndmask_b32 v55, v8, v55, s[30:31]
v_cndmask_b32 v103, v8, v103, s[90:91]
v_cndmask_b32 v56, v8, v56, s[52:53]
v_cndmask_b32 v104, v8, v104, s[52:53]
v_cndmask_b32 v57, v8, v57, s[54:55]
v_cndmask_b32 v105, v8, v105, s[54:55]
v_cndmask_b32 v58, v8, v58, s[56:57]
v_cndmask_b32 v106, v8, v106, s[56:57]
v_cndmask_b32 v59, v8, v59, s[58:59]
v_cndmask_b32 v107, v8, v107, s[58:59]
v_max3_f32 v60, v52, v53, v54
v_max3_f32 v108, v100, v101, v102
v_max3_f32 v61, v55, v56, v57
v_max3_f32 v109, v103, v104, v105
v_max3_f32 v60, v60, v58, v59
v_max3_f32 v108, v108, v106, v107
v_max_f32 v60, v60, v61
v_max_f32 v108, v108, v109
v_mov_b32 v61, v60
v_mov_b32 v109, v108
s_nop 0
s_nop 0
v_permlane32_swap_b32 v60, v61
v_permlane32_swap_b32 v108, v109
v_max_f32 v60, v60, v61
v_max_f32 v108, v108, v109
v_mov_b32 v61, v60
v_mov_b32 v109, v108
s_nop 0
s_nop 0
v_permlane16_swap_b32 v60, v61
v_permlane16_swap_b32 v108, v109
v_max_f32 v60, v60, v61
v_max_f32 v108, v108, v109
v_mul_f32 v60, s61, v60
v_mul_f32 v108, s61, v108
v_fma_f32 v52, v52, s61, -v60
v_fma_f32 v100, v100, s61, -v108
v_fma_f32 v53, v53, s61, -v60
v_fma_f32 v101, v101, s61, -v108
v_fma_f32 v54, v54, s61, -v60
v_fma_f32 v102, v102, s61, -v108
v_fma_f32 v55, v55, s61, -v60
v_fma_f32 v103, v103, s61, -v108
v_fma_f32 v56, v56, s61, -v60
v_fma_f32 v104, v104, s61, -v108
v_fma_f32 v57, v57, s61, -v60
v_fma_f32 v105, v105, s61, -v108
v_fma_f32 v58, v58, s61, -v60
v_fma_f32 v106, v106, s61, -v108
v_fma_f32 v59, v59, s61, -v60
v_fma_f32 v107, v107, s61, -v108
v_exp_f32 v52, v52
v_exp_f32 v100, v100
v_exp_f32 v53, v53
v_exp_f32 v101, v101
v_exp_f32 v54, v54
v_exp_f32 v102, v102
v_exp_f32 v55, v55
v_exp_f32 v103, v103
v_exp_f32 v56, v56
v_exp_f32 v104, v104
v_exp_f32 v57, v57
v_exp_f32 v105, v105
v_exp_f32 v58, v58
v_exp_f32 v106, v106
v_exp_f32 v59, v59
v_exp_f32 v107, v107
v_cvt_pk_bf16_f32 v64, v52, v53
v_cvt_pk_bf16_f32 v112, v100, v101
v_cvt_pk_bf16_f32 v65, v54, v55
v_cvt_pk_bf16_f32 v113, v102, v103
v_cvt_pk_bf16_f32 v66, v56, v57
v_cvt_pk_bf16_f32 v114, v104, v105
v_cvt_pk_bf16_f32 v67, v58, v59
v_cvt_pk_bf16_f32 v115, v106, v107
v_add_f32 v60, v52, v53
v_add_f32 v108, v100, v101
v_add_f32 v61, v54, v55
v_add_f32 v109, v102, v103
v_add_f32 v56, v56, v57
v_add_f32 v104, v104, v105
v_add_f32 v58, v58, v59
v_add_f32 v106, v106, v107
s_waitcnt lgkmcnt(0)
s_waitcnt lgkmcnt(0)
v_mfma_f32_16x16x32_bf16 v[68:71], v[44:47], v[64:67], 0
v_mfma_f32_16x16x32_bf16 v[116:119], v[92:95], v[112:115], 0
v_mfma_f32_16x16x32_bf16 v[72:75], v[48:51], v[64:67], 0
v_mfma_f32_16x16x32_bf16 v[120:123], v[96:99], v[112:115], 0
v_add_f32 v60, v60, v61
v_add_f32 v108, v108, v109
v_add_f32 v56, v56, v58
v_add_f32 v104, v104, v106
v_add_f32 v60, v60, v56
v_add_f32 v108, v108, v104
v_mov_b32 v61, v60
v_mov_b32 v109, v108
s_nop 0
s_nop 0
v_permlane32_swap_b32 v60, v61
v_permlane32_swap_b32 v108, v109
v_add_f32 v60, v60, v61
s_branch Lov_4
.p2align 12
Lst_4_0:
s_branch Lst_8_0
s_nop 0
Lov_4:
v_add_f32 v108, v108, v109
v_mov_b32 v61, v60
v_mov_b32 v109, v108
s_nop 0
s_nop 0
v_permlane16_swap_b32 v60, v61
v_permlane16_swap_b32 v108, v109
v_add_f32 v60, v60, v61
v_add_f32 v108, v108, v109
v_rcp_f32 v60, v60
v_rcp_f32 v108, v108
s_nop 0
s_nop 0
v_pk_mul_f32 v[68:69], v[60:61], v[68:69] op_sel_hi:[0,1]
v_pk_mul_f32 v[116:117], v[108:109], v[116:117] op_sel_hi:[0,1]
v_pk_mul_f32 v[70:71], v[60:61], v[70:71] op_sel_hi:[0,1]
v_pk_mul_f32 v[118:119], v[108:109], v[118:119] op_sel_hi:[0,1]
v_pk_mul_f32 v[72:73], v[60:61], v[72:73] op_sel_hi:[0,1]
v_pk_mul_f32 v[120:121], v[108:109], v[120:121] op_sel_hi:[0,1]
v_pk_mul_f32 v[74:75], v[60:61], v[74:75] op_sel_hi:[0,1]
v_pk_mul_f32 v[122:123], v[108:109], v[122:123] op_sel_hi:[0,1]
v_cvt_pk_bf16_f32 v64, v68, v69
v_cvt_pk_bf16_f32 v112, v116, v117
v_cvt_pk_bf16_f32 v65, v70, v71
v_cvt_pk_bf16_f32 v113, v118, v119
v_cvt_pk_bf16_f32 v66, v72, v73
v_cvt_pk_bf16_f32 v114, v120, v121
v_cvt_pk_bf16_f32 v67, v74, v75
v_cvt_pk_bf16_f32 v115, v122, v123
buffer_store_dwordx4 v[64:67], v6, s[16:19], s60 offen offset:0 sc1
buffer_store_dwordx4 v[112:115], v6, s[16:19], s60 offen offset:2048 sc1
s_add_u32 s56, s82, 28311552
s_addc_u32 s57, s83, 0
s_mov_b32 s58, 49152
s_mov_b32 s59, 0x20000
s_waitcnt vmcnt(0)
s_barrier
s_cmp_lg_u32 s36, 0
s_cbranch_scc1 Lsig_71
s_add_u32 s7, s34, 0
s_lshl_b32 s7, s7, 7
v_mov_b32 v4, s7
v_mov_b32 v5, 1
s_mov_b64 exec, 1
buffer_atomic_add v5, v4, s[56:59], 0 offen sc1
s_mov_b64 exec, -1
Lsig_71:
s_cmp_ge_u32 s36, 4
s_cbranch_scc1 Lprod_73
v_and_b32 v12, 15, v1
v_lshrrev_b32 v13, 4, v1
v_lshlrev_b32 v10, 12, v12
v_and_b32 v14, 1, v13
v_lshl_add_u32 v10, v14, 5, v10
v_lshrrev_b32 v14, 1, v13
v_lshl_add_u32 v10, v14, 4, v10
s_lshl_b32 s43, s34, 18
s_lshl_b32 s44, s36, 16
s_add_u32 s43, s43, s44
s_lshl_b32 s44, s35, 7
s_add_u32 s43, s43, s44
buffer_load_dwordx4 v[128:131], v10, s[8:11], s43 offen offset:0
buffer_load_dwordx4 v[132:135], v10, s[8:11], s43 offen offset:64
buffer_load_dwordx4 v[136:139], v10, s[8:11], s43 offen offset:2048
buffer_load_dwordx4 v[140:143], v10, s[8:11], s43 offen offset:2112
s_mul_i32 s43, s34, 262144
s_add_u32 s20, s82, s43
s_addc_u32 s21, s83, 0
s_add_u32 s20, s20, 4194304
s_addc_u32 s21, s21, 0
s_mov_b32 s22, 262144
s_mov_b32 s23, 0x20000
s_mul_i32 s43, s34, 16384
s_add_u32 s24, s82, s43
s_addc_u32 s25, s83, 0
s_add_u32 s24, s24, 25165824
s_addc_u32 s25, s25, 0
s_mov_b32 s26, 16384
s_mov_b32 s27, 0x20000
v_lshlrev_b32 v11, 4, v1
s_lshl_b32 s43, s36, 11
v_add_u32 v2, s43, v11
v_add_u32 v3, 98304, v2
v_lshrrev_b32 v14, 2, v1
v_bfe_u32 v15, v14, 1, 2
v_mul_u32_u24 v14, 128, v14
v_lshl_add_u32 v14, v15, 5, v14
v_and_b32 v15, 3, v1
v_lshl_add_u32 v4, v15, 3, v14
v_add_u32 v4, 114688, v4
v_xor_b32 v5, 32, v4
v_xor_b32 v6, 64, v4
v_xor_b32 v7, 96, v4
s_lshl_b32 s44, s35, 14
s_add_u32 s60, s44, s43
v_lshrrev_b32 v14, 1, v13
v_lshlrev_b32 v14, 11, v14
v_lshl_add_u32 v14, v12, 3, v14
v_and_b32 v15, 1, v13
v_lshl_add_u32 v14, v15, 2, v14
s_lshl_b32 s43, s36, 12
s_lshl_b32 s44, s35, 7
s_add_u32 s43, s43, s44
v_add_u32 v9, s43, v14
s_mov_b32 s61, 0x3f803f80
s_waitcnt vmcnt(0)
v_permlane16_swap_b32 v128, v130
v_permlane16_swap_b32 v129, v131
v_permlane16_swap_b32 v132, v134
v_permlane16_swap_b32 v133, v135
v_permlane16_swap_b32 v136, v138
v_permlane16_swap_b32 v137, v139
v_permlane16_swap_b32 v140, v142
v_permlane16_swap_b32 v141, v143
v_lshlrev_b32 v96, 16, v128
v_and_b32 v97, 0xffff0000, v128
v_lshlrev_b32 v98, 16, v129
v_and_b32 v99, 0xffff0000, v129
v_lshlrev_b32 v100, 16, v130
v_and_b32 v101, 0xffff0000, v130
v_lshlrev_b32 v102, 16, v131
v_and_b32 v103, 0xffff0000, v131
v_lshlrev_b32 v104, 16, v132
v_and_b32 v105, 0xffff0000, v132
v_lshlrev_b32 v106, 16, v133
v_and_b32 v107, 0xffff0000, v133
v_lshlrev_b32 v108, 16, v134
v_and_b32 v109, 0xffff0000, v134
v_lshlrev_b32 v110, 16, v135
v_and_b32 v111, 0xffff0000, v135
v_lshlrev_b32 v112, 16, v136
v_and_b32 v113, 0xffff0000, v136
v_lshlrev_b32 v114, 16, v137
v_and_b32 v115, 0xffff0000, v137
v_lshlrev_b32 v116, 16, v138
v_and_b32 v117, 0xffff0000, v138
v_lshlrev_b32 v118, 16, v139
v_and_b32 v119, 0xffff0000, v139
v_lshlrev_b32 v120, 16, v140
v_and_b32 v121, 0xffff0000, v140
v_lshlrev_b32 v122, 16, v141
v_and_b32 v123, 0xffff0000, v141
v_lshlrev_b32 v124, 16, v142
v_and_b32 v125, 0xffff0000, v142
v_lshlrev_b32 v126, 16, v143
v_and_b32 v127, 0xffff0000, v143
s_barrier
s_barrier
ds_read_b128 v[32:35], v2 offset:0
ds_read_b64_tr_b16 v[40:41], v4 offset:0
ds_read_b64_tr_b16 v[42:43], v4 offset:2048
ds_read_b64_tr_b16 v[44:45], v5 offset:0
ds_read_b64_tr_b16 v[46:47], v5 offset:2048
ds_read_b64_tr_b16 v[48:49], v6 offset:0
ds_read_b64_tr_b16 v[50:51], v6 offset:2048
ds_read_b64_tr_b16 v[52:53], v7 offset:0
ds_read_b64_tr_b16 v[54:55], v7 offset:2048
ds_read_b128 v[36:39], v2 offset:1024
ds_read_b128 v[56:59], v2 offset:8192
ds_read_b64_tr_b16 v[64:65], v4 offset:4096
ds_read_b64_tr_b16 v[66:67], v4 offset:6144
ds_read_b64_tr_b16 v[68:69], v5 offset:4096
ds_read_b64_tr_b16 v[70:71], v5 offset:6144
ds_read_b64_tr_b16 v[72:73], v6 offset:4096
ds_read_b64_tr_b16 v[74:75], v6 offset:6144
ds_read_b64_tr_b16 v[76:77], v7 offset:4096
ds_read_b64_tr_b16 v[78:79], v7 offset:6144
ds_read_b128 v[60:63], v2 offset:9216
s_mov_b32 s41, 3
Lcl_75:
s_waitcnt lgkmcnt(0)
s_barrier
v_mfma_f32_16x16x32_bf16 v[96:99], v[40:43], v[32:35], v[96:99]
ds_read_b128 v[144:147], v2 offset:49152
ds_read_b64_tr_b16 v[152:153], v4 offset:8192
v_mfma_f32_16x16x32_bf16 v[100:103], v[44:47], v[32:35], v[100:103]
ds_read_b64_tr_b16 v[154:155], v4 offset:10240
ds_read_b64_tr_b16 v[156:157], v5 offset:8192
v_mfma_f32_16x16x32_bf16 v[104:107], v[48:51], v[32:35], v[104:107]
ds_read_b64_tr_b16 v[158:159], v5 offset:10240
ds_read_b64_tr_b16 v[160:161], v6 offset:8192
v_mfma_f32_16x16x32_bf16 v[108:111], v[52:55], v[32:35], v[108:111]
ds_read_b64_tr_b16 v[162:163], v6 offset:10240
ds_read_b64_tr_b16 v[164:165], v7 offset:8192
v_mfma_f32_16x16x32_bf16 v[124:127], v[52:55], v[36:39], v[124:127]
ds_read_b64_tr_b16 v[166:167], v7 offset:10240
ds_read_b128 v[148:151], v2 offset:50176
v_mfma_f32_16x16x32_bf16 v[120:123], v[48:51], v[36:39], v[120:123]
ds_read_b128 v[168:171], v2 offset:57344
ds_read_b64_tr_b16 v[176:177], v4 offset:12288
v_mfma_f32_16x16x32_bf16 v[116:119], v[44:47], v[36:39], v[116:119]
ds_read_b64_tr_b16 v[178:179], v4 offset:14336
ds_read_b64_tr_b16 v[180:181], v5 offset:12288
v_mfma_f32_16x16x32_bf16 v[112:115], v[40:43], v[36:39], v[112:115]
ds_read_b64_tr_b16 v[182:183], v5 offset:14336
ds_read_b64_tr_b16 v[184:185], v6 offset:12288
v_mfma_f32_16x16x32_bf16 v[96:99], v[64:67], v[56:59], v[96:99]
ds_read_b64_tr_b16 v[186:187], v6 offset:14336
ds_read_b64_tr_b16 v[188:189], v7 offset:12288
v_mfma_f32_16x16x32_bf16 v[100:103], v[68:71], v[56:59], v[100:103]
ds_read_b64_tr_b16 v[190:191], v7 offset:14336
ds_read_b128 v[172:175], v2 offset:58368
v_mfma_f32_16x16x32_bf16 v[104:107], v[72:75], v[56:59], v[104:107]
v_mfma_f32_16x16x32_bf16 v[108:111], v[76:79], v[56:59], v[108:111]
v_mfma_f32_16x16x32_bf16 v[124:127], v[76:79], v[60:63], v[124:127]
v_mfma_f32_16x16x32_bf16 v[120:123], v[72:75], v[60:63], v[120:123]
v_mfma_f32_16x16x32_bf16 v[116:119], v[68:71], v[60:63], v[116:119]
v_mfma_f32_16x16x32_bf16 v[112:115], v[64:67], v[60:63], v[112:115]
s_waitcnt lgkmcnt(0)
s_barrier
v_mfma_f32_16x16x32_bf16 v[96:99], v[152:155], v[144:147], v[96:99]
ds_read_b128 v[32:35], v3 offset:0
ds_read_b64_tr_b16 v[40:41], v4 offset:16384
v_mfma_f32_16x16x32_bf16 v[100:103], v[156:159], v[144:147], v[100:103]
ds_read_b64_tr_b16 v[42:43], v4 offset:18432
ds_read_b64_tr_b16 v[44:45], v5 offset:16384
v_mfma_f32_16x16x32_bf16 v[104:107], v[160:163], v[144:147], v[104:107]
ds_read_b64_tr_b16 v[46:47], v5 offset:18432
ds_read_b64_tr_b16 v[48:49], v6 offset:16384
v_mfma_f32_16x16x32_bf16 v[108:111], v[164:167], v[144:147], v[108:111]
ds_read_b64_tr_b16 v[50:51], v6 offset:18432
ds_read_b64_tr_b16 v[52:53], v7 offset:16384
v_mfma_f32_16x16x32_bf16 v[124:127], v[164:167], v[148:151], v[124:127]
ds_read_b64_tr_b16 v[54:55], v7 offset:18432
ds_read_b128 v[36:39], v3 offset:1024
v_mfma_f32_16x16x32_bf16 v[120:123], v[160:163], v[148:151], v[120:123]
ds_read_b128 v[56:59], v3 offset:8192
ds_read_b64_tr_b16 v[64:65], v4 offset:20480
v_mfma_f32_16x16x32_bf16 v[116:119], v[156:159], v[148:151], v[116:119]
ds_read_b64_tr_b16 v[66:67], v4 offset:22528
ds_read_b64_tr_b16 v[68:69], v5 offset:20480
v_mfma_f32_16x16x32_bf16 v[112:115], v[152:155], v[148:151], v[112:115]
ds_read_b64_tr_b16 v[70:71], v5 offset:22528
ds_read_b64_tr_b16 v[72:73], v6 offset:20480
v_mfma_f32_16x16x32_bf16 v[96:99], v[176:179], v[168:171], v[96:99]
ds_read_b64_tr_b16 v[74:75], v6 offset:22528
ds_read_b64_tr_b16 v[76:77], v7 offset:20480
v_mfma_f32_16x16x32_bf16 v[100:103], v[180:183], v[168:171], v[100:103]
ds_read_b64_tr_b16 v[78:79], v7 offset:22528
ds_read_b128 v[60:63], v3 offset:9216
v_mfma_f32_16x16x32_bf16 v[104:107], v[184:187], v[168:171], v[104:107]
v_mfma_f32_16x16x32_bf16 v[108:111], v[188:191], v[168:171], v[108:111]
v_mfma_f32_16x16x32_bf16 v[124:127], v[188:191], v[172:175], v[124:127]
v_mfma_f32_16x16x32_bf16 v[120:123], v[184:187], v[172:175], v[120:123]
v_mfma_f32_16x16x32_bf16 v[116:119], v[180:183], v[172:175], v[116:119]
v_mfma_f32_16x16x32_bf16 v[112:115], v[176:179], v[172:175], v[112:115]
s_waitcnt lgkmcnt(0)
s_barrier
v_mfma_f32_16x16x32_bf16 v[96:99], v[40:43], v[32:35], v[96:99]
ds_read_b128 v[144:147], v3 offset:49152
ds_read_b64_tr_b16 v[152:153], v4 offset:24576
v_mfma_f32_16x16x32_bf16 v[100:103], v[44:47], v[32:35], v[100:103]
ds_read_b64_tr_b16 v[154:155], v4 offset:26624
ds_read_b64_tr_b16 v[156:157], v5 offset:24576
v_mfma_f32_16x16x32_bf16 v[104:107], v[48:51], v[32:35], v[104:107]
ds_read_b64_tr_b16 v[158:159], v5 offset:26624
ds_read_b64_tr_b16 v[160:161], v6 offset:24576
v_mfma_f32_16x16x32_bf16 v[108:111], v[52:55], v[32:35], v[108:111]
ds_read_b64_tr_b16 v[162:163], v6 offset:26624
ds_read_b64_tr_b16 v[164:165], v7 offset:24576
v_mfma_f32_16x16x32_bf16 v[124:127], v[52:55], v[36:39], v[124:127]
ds_read_b64_tr_b16 v[166:167], v7 offset:26624
ds_read_b128 v[148:151], v3 offset:50176
v_mfma_f32_16x16x32_bf16 v[120:123], v[48:51], v[36:39], v[120:123]
ds_read_b128 v[168:171], v3 offset:57344
ds_read_b64_tr_b16 v[176:177], v4 offset:28672
v_mfma_f32_16x16x32_bf16 v[116:119], v[44:47], v[36:39], v[116:119]
ds_read_b64_tr_b16 v[178:179], v4 offset:30720
ds_read_b64_tr_b16 v[180:181], v5 offset:28672
v_mfma_f32_16x16x32_bf16 v[112:115], v[40:43], v[36:39], v[112:115]
ds_read_b64_tr_b16 v[182:183], v5 offset:30720
ds_read_b64_tr_b16 v[184:185], v6 offset:28672
v_mfma_f32_16x16x32_bf16 v[96:99], v[64:67], v[56:59], v[96:99]
ds_read_b64_tr_b16 v[186:187], v6 offset:30720
ds_read_b64_tr_b16 v[188:189], v7 offset:28672
v_mfma_f32_16x16x32_bf16 v[100:103], v[68:71], v[56:59], v[100:103]
ds_read_b64_tr_b16 v[190:191], v7 offset:30720
ds_read_b128 v[172:175], v3 offset:58368
v_mfma_f32_16x16x32_bf16 v[104:107], v[72:75], v[56:59], v[104:107]
v_mfma_f32_16x16x32_bf16 v[108:111], v[76:79], v[56:59], v[108:111]
v_mfma_f32_16x16x32_bf16 v[124:127], v[76:79], v[60:63], v[124:127]
v_mfma_f32_16x16x32_bf16 v[120:123], v[72:75], v[60:63], v[120:123]
v_mfma_f32_16x16x32_bf16 v[116:119], v[68:71], v[60:63], v[116:119]
v_mfma_f32_16x16x32_bf16 v[112:115], v[64:67], v[60:63], v[112:115]
s_waitcnt lgkmcnt(0)
s_barrier
v_mfma_f32_16x16x32_bf16 v[96:99], v[152:155], v[144:147], v[96:99]
ds_read_b128 v[32:35], v2 offset:0
ds_read_b64_tr_b16 v[40:41], v4 offset:0
v_mfma_f32_16x16x32_bf16 v[100:103], v[156:159], v[144:147], v[100:103]
ds_read_b64_tr_b16 v[42:43], v4 offset:2048
ds_read_b64_tr_b16 v[44:45], v5 offset:0
v_mfma_f32_16x16x32_bf16 v[104:107], v[160:163], v[144:147], v[104:107]
ds_read_b64_tr_b16 v[46:47], v5 offset:2048
ds_read_b64_tr_b16 v[48:49], v6 offset:0
v_mfma_f32_16x16x32_bf16 v[108:111], v[164:167], v[144:147], v[108:111]
ds_read_b64_tr_b16 v[50:51], v6 offset:2048
ds_read_b64_tr_b16 v[52:53], v7 offset:0
v_mfma_f32_16x16x32_bf16 v[124:127], v[164:167], v[148:151], v[124:127]
ds_read_b64_tr_b16 v[54:55], v7 offset:2048
ds_read_b128 v[36:39], v2 offset:1024
v_mfma_f32_16x16x32_bf16 v[120:123], v[160:163], v[148:151], v[120:123]
ds_read_b128 v[56:59], v2 offset:8192
ds_read_b64_tr_b16 v[64:65], v4 offset:4096
v_mfma_f32_16x16x32_bf16 v[116:119], v[156:159], v[148:151], v[116:119]
ds_read_b64_tr_b16 v[66:67], v4 offset:6144
ds_read_b64_tr_b16 v[68:69], v5 offset:4096
v_mfma_f32_16x16x32_bf16 v[112:115], v[152:155], v[148:151], v[112:115]
ds_read_b64_tr_b16 v[70:71], v5 offset:6144
ds_read_b64_tr_b16 v[72:73], v6 offset:4096
v_mfma_f32_16x16x32_bf16 v[96:99], v[176:179], v[168:171], v[96:99]
ds_read_b64_tr_b16 v[74:75], v6 offset:6144
ds_read_b64_tr_b16 v[76:77], v7 offset:4096
v_mfma_f32_16x16x32_bf16 v[100:103], v[180:183], v[168:171], v[100:103]
ds_read_b64_tr_b16 v[78:79], v7 offset:6144
ds_read_b128 v[60:63], v2 offset:9216
v_mfma_f32_16x16x32_bf16 v[104:107], v[184:187], v[168:171], v[104:107]
v_mfma_f32_16x16x32_bf16 v[108:111], v[188:191], v[168:171], v[108:111]
v_mfma_f32_16x16x32_bf16 v[124:127], v[188:191], v[172:175], v[124:127]
v_mfma_f32_16x16x32_bf16 v[120:123], v[184:187], v[172:175], v[120:123]
v_mfma_f32_16x16x32_bf16 v[116:119], v[180:183], v[172:175], v[116:119]
v_mfma_f32_16x16x32_bf16 v[112:115], v[176:179], v[172:175], v[112:115]
s_sub_u32 s41, s41, 1
s_cmp_lg_u32 s41, 0
s_cbranch_scc1 Lcl_75
s_waitcnt lgkmcnt(0)
s_barrier
v_mfma_f32_16x16x32_bf16 v[96:99], v[40:43], v[32:35], v[96:99]
ds_read_b128 v[144:147], v2 offset:49152
ds_read_b64_tr_b16 v[152:153], v4 offset:8192
v_mfma_f32_16x16x32_bf16 v[100:103], v[44:47], v[32:35], v[100:103]
ds_read_b64_tr_b16 v[154:155], v4 offset:10240
ds_read_b64_tr_b16 v[156:157], v5 offset:8192
v_mfma_f32_16x16x32_bf16 v[104:107], v[48:51], v[32:35], v[104:107]
ds_read_b64_tr_b16 v[158:159], v5 offset:10240
ds_read_b64_tr_b16 v[160:161], v6 offset:8192
v_mfma_f32_16x16x32_bf16 v[108:111], v[52:55], v[32:35], v[108:111]
ds_read_b64_tr_b16 v[162:163], v6 offset:10240
ds_read_b64_tr_b16 v[164:165], v7 offset:8192
v_mfma_f32_16x16x32_bf16 v[124:127], v[52:55], v[36:39], v[124:127]
ds_read_b64_tr_b16 v[166:167], v7 offset:10240
ds_read_b128 v[148:151], v2 offset:50176
v_mfma_f32_16x16x32_bf16 v[120:123], v[48:51], v[36:39], v[120:123]
ds_read_b128 v[168:171], v2 offset:57344
ds_read_b64_tr_b16 v[176:177], v4 offset:12288
v_mfma_f32_16x16x32_bf16 v[116:119], v[44:47], v[36:39], v[116:119]
ds_read_b64_tr_b16 v[178:179], v4 offset:14336
ds_read_b64_tr_b16 v[180:181], v5 offset:12288
v_mfma_f32_16x16x32_bf16 v[112:115], v[40:43], v[36:39], v[112:115]
ds_read_b64_tr_b16 v[182:183], v5 offset:14336
ds_read_b64_tr_b16 v[184:185], v6 offset:12288
v_mfma_f32_16x16x32_bf16 v[96:99], v[64:67], v[56:59], v[96:99]
ds_read_b64_tr_b16 v[186:187], v6 offset:14336
ds_read_b64_tr_b16 v[188:189], v7 offset:12288
v_mfma_f32_16x16x32_bf16 v[100:103], v[68:71], v[56:59], v[100:103]
ds_read_b64_tr_b16 v[190:191], v7 offset:14336
ds_read_b128 v[172:175], v2 offset:58368
v_mfma_f32_16x16x32_bf16 v[104:107], v[72:75], v[56:59], v[104:107]
v_mfma_f32_16x16x32_bf16 v[108:111], v[76:79], v[56:59], v[108:111]
v_mfma_f32_16x16x32_bf16 v[124:127], v[76:79], v[60:63], v[124:127]
v_mfma_f32_16x16x32_bf16 v[120:123], v[72:75], v[60:63], v[120:123]
v_mfma_f32_16x16x32_bf16 v[116:119], v[68:71], v[60:63], v[116:119]
v_mfma_f32_16x16x32_bf16 v[112:115], v[64:67], v[60:63], v[112:115]
s_waitcnt lgkmcnt(0)
s_barrier
v_mfma_f32_16x16x32_bf16 v[96:99], v[152:155], v[144:147], v[96:99]
ds_read_b128 v[32:35], v3 offset:0
ds_read_b64_tr_b16 v[40:41], v4 offset:16384
v_mfma_f32_16x16x32_bf16 v[100:103], v[156:159], v[144:147], v[100:103]
ds_read_b64_tr_b16 v[42:43], v4 offset:18432
ds_read_b64_tr_b16 v[44:45], v5 offset:16384
v_mfma_f32_16x16x32_bf16 v[104:107], v[160:163], v[144:147], v[104:107]
ds_read_b64_tr_b16 v[46:47], v5 offset:18432
ds_read_b64_tr_b16 v[48:49], v6 offset:16384
v_mfma_f32_16x16x32_bf16 v[108:111], v[164:167], v[144:147], v[108:111]
ds_read_b64_tr_b16 v[50:51], v6 offset:18432
ds_read_b64_tr_b16 v[52:53], v7 offset:16384
v_mfma_f32_16x16x32_bf16 v[124:127], v[164:167], v[148:151], v[124:127]
ds_read_b64_tr_b16 v[54:55], v7 offset:18432
ds_read_b128 v[36:39], v3 offset:1024
v_mfma_f32_16x16x32_bf16 v[120:123], v[160:163], v[148:151], v[120:123]
ds_read_b128 v[56:59], v3 offset:8192
ds_read_b64_tr_b16 v[64:65], v4 offset:20480
v_mfma_f32_16x16x32_bf16 v[116:119], v[156:159], v[148:151], v[116:119]
ds_read_b64_tr_b16 v[66:67], v4 offset:22528
ds_read_b64_tr_b16 v[68:69], v5 offset:20480
v_mfma_f32_16x16x32_bf16 v[112:115], v[152:155], v[148:151], v[112:115]
ds_read_b64_tr_b16 v[70:71], v5 offset:22528
ds_read_b64_tr_b16 v[72:73], v6 offset:20480
v_mfma_f32_16x16x32_bf16 v[96:99], v[176:179], v[168:171], v[96:99]
ds_read_b64_tr_b16 v[74:75], v6 offset:22528
ds_read_b64_tr_b16 v[76:77], v7 offset:20480
v_mfma_f32_16x16x32_bf16 v[100:103], v[180:183], v[168:171], v[100:103]
ds_read_b64_tr_b16 v[78:79], v7 offset:22528
ds_read_b128 v[60:63], v3 offset:9216
v_mfma_f32_16x16x32_bf16 v[104:107], v[184:187], v[168:171], v[104:107]
v_mfma_f32_16x16x32_bf16 v[108:111], v[188:191], v[168:171], v[108:111]
v_mfma_f32_16x16x32_bf16 v[124:127], v[188:191], v[172:175], v[124:127]
v_mfma_f32_16x16x32_bf16 v[120:123], v[184:187], v[172:175], v[120:123]
v_mfma_f32_16x16x32_bf16 v[116:119], v[180:183], v[172:175], v[116:119]
v_mfma_f32_16x16x32_bf16 v[112:115], v[176:179], v[172:175], v[112:115]
s_waitcnt lgkmcnt(0)
s_barrier
v_mfma_f32_16x16x32_bf16 v[96:99], v[40:43], v[32:35], v[96:99]
ds_read_b128 v[144:147], v3 offset:49152
ds_read_b64_tr_b16 v[152:153], v4 offset:24576
v_mfma_f32_16x16x32_bf16 v[100:103], v[44:47], v[32:35], v[100:103]
ds_read_b64_tr_b16 v[154:155], v4 offset:26624
ds_read_b64_tr_b16 v[156:157], v5 offset:24576
v_mfma_f32_16x16x32_bf16 v[104:107], v[48:51], v[32:35], v[104:107]
ds_read_b64_tr_b16 v[158:159], v5 offset:26624
ds_read_b64_tr_b16 v[160:161], v6 offset:24576
v_mfma_f32_16x16x32_bf16 v[108:111], v[52:55], v[32:35], v[108:111]
ds_read_b64_tr_b16 v[162:163], v6 offset:26624
ds_read_b64_tr_b16 v[164:165], v7 offset:24576
v_mfma_f32_16x16x32_bf16 v[124:127], v[52:55], v[36:39], v[124:127]
ds_read_b64_tr_b16 v[166:167], v7 offset:26624
ds_read_b128 v[148:151], v3 offset:50176
v_mfma_f32_16x16x32_bf16 v[120:123], v[48:51], v[36:39], v[120:123]
ds_read_b128 v[168:171], v3 offset:57344
ds_read_b64_tr_b16 v[176:177], v4 offset:28672
v_mfma_f32_16x16x32_bf16 v[116:119], v[44:47], v[36:39], v[116:119]
ds_read_b64_tr_b16 v[178:179], v4 offset:30720
ds_read_b64_tr_b16 v[180:181], v5 offset:28672
v_mfma_f32_16x16x32_bf16 v[112:115], v[40:43], v[36:39], v[112:115]
ds_read_b64_tr_b16 v[182:183], v5 offset:30720
ds_read_b64_tr_b16 v[184:185], v6 offset:28672
v_mfma_f32_16x16x32_bf16 v[96:99], v[64:67], v[56:59], v[96:99]
ds_read_b64_tr_b16 v[186:187], v6 offset:30720
ds_read_b64_tr_b16 v[188:189], v7 offset:28672
v_mfma_f32_16x16x32_bf16 v[100:103], v[68:71], v[56:59], v[100:103]
ds_read_b64_tr_b16 v[190:191], v7 offset:30720
ds_read_b128 v[172:175], v3 offset:58368
v_mfma_f32_16x16x32_bf16 v[104:107], v[72:75], v[56:59], v[104:107]
v_mfma_f32_16x16x32_bf16 v[108:111], v[76:79], v[56:59], v[108:111]
v_mfma_f32_16x16x32_bf16 v[124:127], v[76:79], v[60:63], v[124:127]
v_mfma_f32_16x16x32_bf16 v[120:123], v[72:75], v[60:63], v[120:123]
v_mfma_f32_16x16x32_bf16 v[116:119], v[68:71], v[60:63], v[116:119]
v_mfma_f32_16x16x32_bf16 v[112:115], v[64:67], v[60:63], v[112:115]
s_waitcnt lgkmcnt(0)
s_barrier
v_mfma_f32_16x16x32_bf16 v[96:99], v[152:155], v[144:147], v[96:99]
v_mfma_f32_16x16x32_bf16 v[100:103], v[156:159], v[144:147], v[100:103]
v_mfma_f32_16x16x32_bf16 v[104:107], v[160:163], v[144:147], v[104:107]
v_mfma_f32_16x16x32_bf16 v[108:111], v[164:167], v[144:147], v[108:111]
v_mfma_f32_16x16x32_bf16 v[124:127], v[164:167], v[148:151], v[124:127]
v_mfma_f32_16x16x32_bf16 v[120:123], v[160:163], v[148:151], v[120:123]
v_mfma_f32_16x16x32_bf16 v[116:119], v[156:159], v[148:151], v[116:119]
v_mfma_f32_16x16x32_bf16 v[112:115], v[152:155], v[148:151], v[112:115]
v_mfma_f32_16x16x32_bf16 v[96:99], v[176:179], v[168:171], v[96:99]
v_mfma_f32_16x16x32_bf16 v[100:103], v[180:183], v[168:171], v[100:103]
v_mfma_f32_16x16x32_bf16 v[104:107], v[184:187], v[168:171], v[104:107]
v_mfma_f32_16x16x32_bf16 v[108:111], v[188:191], v[168:171], v[108:111]
v_mfma_f32_16x16x32_bf16 v[124:127], v[188:191], v[172:175], v[124:127]
v_mfma_f32_16x16x32_bf16 v[120:123], v[184:187], v[172:175], v[120:123]
v_mfma_f32_16x16x32_bf16 v[116:119], v[180:183], v[172:175], v[116:119]
v_mfma_f32_16x16x32_bf16 v[112:115], v[176:179], v[172:175], v[112:115]
s_nop 3
v_cvt_pk_bf16_f32 v32, v96, v97
v_cvt_pk_bf16_f32 v33, v98, v99
v_cvt_pk_bf16_f32 v34, v100, v101
v_cvt_pk_bf16_f32 v35, v102, v103
s_add_u32 s43, s60, 0
buffer_store_dwordx4 v[32:35], v11, s[20:23], s43 offen offset:0 sc1
v_cvt_pk_bf16_f32 v36, v104, v105
v_cvt_pk_bf16_f32 v37, v106, v107
v_cvt_pk_bf16_f32 v38, v108, v109
v_cvt_pk_bf16_f32 v39, v110, v111
s_add_u32 s43, s60, 8192
buffer_store_dwordx4 v[36:39], v11, s[20:23], s43 offen offset:0 sc1
v_cvt_pk_bf16_f32 v44, v120, v121
v_cvt_pk_bf16_f32 v45, v122, v123
v_cvt_pk_bf16_f32 v46, v124, v125
v_cvt_pk_bf16_f32 v47, v126, v127
s_add_u32 s43, s60, 8192
buffer_store_dwordx4 v[44:47], v11, s[20:23], s43 offen offset:1024 sc1
v_cvt_pk_bf16_f32 v40, v112, v113
v_cvt_pk_bf16_f32 v41, v114, v115
v_cvt_pk_bf16_f32 v42, v116, v117
v_cvt_pk_bf16_f32 v43, v118, v119
s_add_u32 s43, s60, 0
buffer_store_dwordx4 v[40:43], v11, s[20:23], s43 offen offset:1024 sc1
v_mov_b32 v64, 0
v_mov_b32 v65, 0
v_mov_b32 v66, 0
v_mov_b32 v67, 0
v_mov_b32 v68, 0
v_mov_b32 v69, 0
v_mov_b32 v70, 0
v_mov_b32 v71, 0
v_dot2_f32_bf16 v64, v32, s61, v64
v_dot2_f32_bf16 v66, v32, v32, v66
v_dot2_f32_bf16 v68, v40, s61, v68
v_dot2_f32_bf16 v70, v40, v40, v70
v_dot2_f32_bf16 v65, v33, s61, v65
v_dot2_f32_bf16 v67, v33, v33, v67
v_dot2_f32_bf16 v69, v41, s61, v69
v_dot2_f32_bf16 v71, v41, v41, v71
v_dot2_f32_bf16 v64, v34, s61, v64
v_dot2_f32_bf16 v66, v34, v34, v66
v_dot2_f32_bf16 v68, v42, s61, v68
v_dot2_f32_bf16 v70, v42, v42, v70
v_dot2_f32_bf16 v65, v35, s61, v65
v_dot2_f32_bf16 v67, v35, v35, v67
v_dot2_f32_bf16 v69, v43, s61, v69
v_dot2_f32_bf16 v71, v43, v43, v71
v_dot2_f32_bf16 v64, v36, s61, v64
v_dot2_f32_bf16 v66, v36, v36, v66
v_dot2_f32_bf16 v68, v44, s61, v68
v_dot2_f32_bf16 v70, v44, v44, v70
v_dot2_f32_bf16 v65, v37, s61, v65
v_dot2_f32_bf16 v67, v37, v37, v67
v_dot2_f32_bf16 v69, v45, s61, v69
v_dot2_f32_bf16 v71, v45, v45, v71
v_dot2_f32_bf16 v64, v38, s61, v64
v_dot2_f32_bf16 v66, v38, v38, v66
v_dot2_f32_bf16 v68, v46, s61, v68
v_dot2_f32_bf16 v70, v46, v46, v70
v_dot2_f32_bf16 v65, v39, s61, v65
v_dot2_f32_bf16 v67, v39, v39, v67
v_dot2_f32_bf16 v69, v47, s61, v69
v_dot2_f32_bf16 v71, v47, v47, v71
s_nop 2
v_add_f32 v64, v64, v65
v_add_f32 v66, v66, v67
v_add_f32 v68, v68, v69
v_add_f32 v70, v70, v71
s_nop 1
v_permlane32_swap_b32 v64, v68
v_permlane32_swap_b32 v66, v70
v_add_f32 v64, v64, v68
v_add_f32 v66, v66, v70
s_nop 1
v_permlane16_swap_b32 v64, v66
v_add_f32 v64, v64, v66
buffer_store_dword v64, v9, s[24:27], 0 offen sc1
s_waitcnt vmcnt(0)
s_barrier
s_cmp_lg_u32 s36, 0
s_cbranch_scc1 Lk2end_72
s_add_u32 s7, s34, 16
s_lshl_b32 s7, s7, 7
v_mov_b32 v4, s7
v_mov_b32 v5, 1
s_mov_b64 exec, 1
buffer_atomic_add v5, v4, s[56:59], 0 offen sc1
s_mov_b64 exec, -1
s_branch Lk2end_72
Lprod_73:
s_cmp_eq_u32 s36, 7
s_cbranch_scc1 Lpf_74
s_mul_i32 s43, s34, 262144
s_add_u32 s8, s82, s43
s_addc_u32 s9, s83, 0
s_mov_b32 s10, 262144
s_mov_b32 s11, 0x20000
s_lshl_b32 s43, s35, 7
s_add_u32 s12, s68, s43
s_addc_u32 s13, s69, 0
s_mov_b32 s14, 2095232
s_mov_b32 s15, 0x20000
v_lshlrev_b32 v2, 4, v1
v_lshrrev_b32 v12, 3, v1
v_and_b32 v13, 6, v12
v_and_b32 v3, 7, v1
v_xor_b32 v3, v3, v13
v_lshlrev_b32 v3, 4, v3
v_mul_u32_u24 v12, 2048, v12
v_add_u32 v3, v3, v12
s_cmp_eq_u32 s36, 5
s_cbranch_scc1 Lp_77
s_cmp_eq_u32 s36, 6
s_cbranch_scc1 Lp_78
Lp_76:
v_add_u32 v16, 0, v2
v_add_u32 v17, 3072, v2
v_add_u32 v18, 6144, v2
v_add_u32 v19, 9216, v2
v_add_u32 v20, 12288, v2
v_add_u32 v21, 15360, v2
v_add_u32 v22, 32768, v3
v_add_u32 v23, 81920, v3
s_and_b32 s44, s36, 3
s_mul_i32 s44, s44, 17
s_bfe_u32 s43, s2, 0x30001
s_lshl_b32 s43, s43, 7
s_add_u32 s44, s44, s43
s_add_u32 s44, s44, 60
s_mul_i32 s44, s44, 7168
s_lshr_b32 s43, s2, 4
s_lshl_b32 s43, s43, 8
s_add_u32 s43, s43, s44
s_bitcmp0_b32 s2, 0
s_cselect_b32 s4, s72, s74
s_cselect_b32 s5, s73, s75
s_add_u32 s4, s4, s43
s_addc_u32 s5, s5, 0
s_load_dword s3, s[4:5], 0
s_load_dword s3, s[4:5], 64
s_load_dword s3, s[4:5], 128
s_branch Lov_5
.p2align 12
Lst_5_0:
s_branch Lst_9_0
s_nop 0
Lov_5:
s_load_dword s3, s[4:5], 192
s_load_dword s3, s[4:5], 7168
s_load_dword s3, s[4:5], 7232
s_load_dword s3, s[4:5], 7296
s_load_dword s3, s[4:5], 7360
s_load_dword s3, s[4:5], 14336
s_load_dword s3, s[4:5], 14400
s_load_dword s3, s[4:5], 14464
s_load_dword s3, s[4:5], 14528
s_load_dword s3, s[4:5], 21504
s_load_dword s3, s[4:5], 21568
s_bitcmp0_b32 s36, 1
s_cselect_b32 s44, s72, s74
s_cselect_b32 s45, s73, s75
s_mul_i32 s43, s35, 192
s_add_u32 s88, s44, s43
s_addc_u32 s89, s45, 0
s_add_u32 s88, s88, 4096
s_addc_u32 s89, s89, 0
s_mov_b32 s90, 7333056
s_mov_b32 s91, 0x20000
v_add_u32 v11, 0, v1
v_mul_u32_u24 v12, 5462, v11
v_lshrrev_b32 v12, 16, v12
v_mul_u32_u24 v13, 12, v12
v_sub_u32 v13, v11, v13
v_bfe_u32 v14, v12, 2, 1
v_cmp_gt_u32 vcc, 8, v13
v_lshlrev_b32 v15, 1, v14
v_mul_u32_u24 v12, 7168, v12
v_cndmask_b32 v14, v14, v15, vcc
v_xor_b32 v13, v13, v14
v_lshl_add_u32 v8, v13, 4, v12
v_add_u32 v11, 64, v1
v_mul_u32_u24 v12, 5462, v11
v_lshrrev_b32 v12, 16, v12
v_mul_u32_u24 v13, 12, v12
v_sub_u32 v13, v11, v13
v_bfe_u32 v14, v12, 2, 1
v_cmp_gt_u32 vcc, 8, v13
v_lshlrev_b32 v15, 1, v14
v_mul_u32_u24 v12, 7168, v12
v_cndmask_b32 v14, v14, v15, vcc
v_xor_b32 v13, v13, v14
v_lshl_add_u32 v9, v13, 4, v12
v_add_u32 v11, 128, v1
v_mul_u32_u24 v12, 5462, v11
v_lshrrev_b32 v12, 16, v12
v_mul_u32_u24 v13, 12, v12
v_sub_u32 v13, v11, v13
v_bfe_u32 v14, v12, 2, 1
v_cmp_gt_u32 vcc, 8, v13
v_lshlrev_b32 v15, 1, v14
v_mul_u32_u24 v12, 7168, v12
v_cndmask_b32 v14, v14, v15, vcc
v_xor_b32 v13, v13, v14
v_lshl_add_u32 v10, v13, 4, v12
s_and_b32 s43, s36, 1
s_mul_i32 s43, s43, 229376
v_add_u32 v8, s43, v8
v_add_u32 v9, s43, v9
v_add_u32 v10, s43, v10
s_and_b32 s43, s36, 3
s_mul_i32 s46, s43, 6144
s_add_u32 s46, s46, 16384
s_barrier
s_mov_b32 s37, 0
s_mov_b32 m0, 0
s_nop 0
buffer_load_dwordx4 v16, s[8:11], s37 offen sc1 lds
s_mov_b32 m0, 3072
s_nop 0
buffer_load_dwordx4 v17, s[8:11], s37 offen sc1 lds
s_mov_b32 m0, 6144
s_nop 0
buffer_load_dwordx4 v18, s[8:11], s37 offen sc1 lds
s_mov_b32 m0, 9216
s_nop 0
buffer_load_dwordx4 v19, s[8:11], s37 offen sc1 lds
s_mov_b32 m0, 12288
s_nop 0
buffer_load_dwordx4 v20, s[8:11], s37 offen sc1 lds
s_mov_b32 m0, 15360
s_nop 0
buffer_load_dwordx4 v21, s[8:11], s37 offen sc1 lds
s_mov_b32 s37, 16384
s_mov_b32 m0, 49152
s_nop 0
buffer_load_dwordx4 v16, s[8:11], s37 offen sc1 lds
s_mov_b32 m0, 52224
s_nop 0
buffer_load_dwordx4 v17, s[8:11], s37 offen sc1 lds
s_mov_b32 m0, 55296
s_nop 0
buffer_load_dwordx4 v18, s[8:11], s37 offen sc1 lds
s_mov_b32 m0, 58368
s_nop 0
buffer_load_dwordx4 v19, s[8:11], s37 offen sc1 lds
s_mov_b32 m0, 61440
s_nop 0
buffer_load_dwordx4 v20, s[8:11], s37 offen sc1 lds
s_mov_b32 m0, 64512
s_nop 0
buffer_load_dwordx4 v21, s[8:11], s37 offen sc1 lds
s_mov_b32 s37, 32768
s_mov_b32 m0, 98304
s_nop 0
buffer_load_dwordx4 v16, s[8:11], s37 offen sc1 lds
s_mov_b32 m0, 101376
s_nop 0
buffer_load_dwordx4 v17, s[8:11], s37 offen sc1 lds
s_mov_b32 m0, 104448
s_nop 0
buffer_load_dwordx4 v18, s[8:11], s37 offen sc1 lds
s_mov_b32 m0, 107520
s_nop 0
buffer_load_dwordx4 v19, s[8:11], s37 offen sc1 lds
s_mov_b32 m0, 110592
s_nop 0
buffer_load_dwordx4 v20, s[8:11], s37 offen sc1 lds
s_mov_b32 m0, 113664
s_nop 0
buffer_load_dwordx4 v21, s[8:11], s37 offen sc1 lds
s_mov_b32 s37, 49152
s_mov_b32 m0, 147456
s_nop 0
buffer_load_dwordx4 v16, s[8:11], s37 offen sc1 lds
s_mov_b32 m0, 150528
s_nop 0
buffer_load_dwordx4 v17, s[8:11], s37 offen sc1 lds
s_mov_b32 m0, 153600
s_nop 0
buffer_load_dwordx4 v18, s[8:11], s37 offen sc1 lds
s_mov_b32 m0, 156672
s_nop 0
buffer_load_dwordx4 v19, s[8:11], s37 offen sc1 lds
s_mov_b32 m0, 159744
s_nop 0
buffer_load_dwordx4 v20, s[8:11], s37 offen sc1 lds
s_mov_b32 m0, 162816
s_nop 0
buffer_load_dwordx4 v21, s[8:11], s37 offen sc1 lds
s_mov_b32 s37, 65536
s_mov_b32 s38, 524288
s_waitcnt vmcnt(18)
s_barrier
s_waitcnt vmcnt(12)
s_barrier
s_mov_b32 m0, 0
s_nop 0
buffer_load_dwordx4 v16, s[8:11], s37 offen sc1 lds
s_mov_b32 m0, 3072
s_nop 0
buffer_load_dwordx4 v17, s[8:11], s37 offen sc1 lds
s_mov_b32 m0, 6144
s_nop 0
buffer_load_dwordx4 v18, s[8:11], s37 offen sc1 lds
s_mov_b32 m0, 9216
s_nop 0
buffer_load_dwordx4 v19, s[8:11], s37 offen sc1 lds
s_mov_b32 m0, 12288
s_nop 0
buffer_load_dwordx4 v20, s[8:11], s37 offen sc1 lds
s_mov_b32 m0, 15360
s_nop 0
buffer_load_dwordx4 v21, s[8:11], s37 offen sc1 lds
s_mov_b32 m0, 116736
s_nop 0
buffer_load_dwordx4 v22, s[12:15], s38 offen lds
s_mov_b32 m0, 119808
s_nop 0
buffer_load_dwordx4 v23, s[12:15], s38 offen lds
s_add_u32 s37, s37, 16384
s_add_u32 s38, s38, 131072
v_lshlrev_b32 v240, 16, v128
v_and_b32 v241, 0xffff0000, v128
v_lshlrev_b32 v242, 16, v129
v_and_b32 v243, 0xffff0000, v129
v_lshlrev_b32 v244, 16, v130
v_and_b32 v245, 0xffff0000, v130
v_lshlrev_b32 v246, 16, v131
v_and_b32 v247, 0xffff0000, v131
s_load_dword s3, s[4:5], 21632
s_load_dword s3, s[4:5], 21696
s_waitcnt vmcnt(14)
s_barrier
s_mov_b32 m0, 49152
s_nop 0
buffer_load_dwordx4 v16, s[8:11], s37 offen sc1 lds
s_mov_b32 m0, 52224
s_nop 0
buffer_load_dwordx4 v17, s[8:11], s37 offen sc1 lds
s_mov_b32 m0, 55296
s_nop 0
buffer_load_dwordx4 v18, s[8:11], s37 offen sc1 lds
s_mov_b32 m0, 58368
s_nop 0
buffer_load_dwordx4 v19, s[8:11], s37 offen sc1 lds
s_mov_b32 m0, 61440
s_nop 0
buffer_load_dwordx4 v20, s[8:11], s37 offen sc1 lds
s_mov_b32 m0, 64512
s_nop 0
buffer_load_dwordx4 v21, s[8:11], s37 offen sc1 lds
s_mov_b32 m0, 124928
s_nop 0
buffer_load_dwordx4 v22, s[12:15], s38 offen lds
s_mov_b32 m0, 128000
s_nop 0
buffer_load_dwordx4 v23, s[12:15], s38 offen lds
s_add_u32 s37, s37, 16384
s_add_u32 s38, s38, 131072
v_lshlrev_b32 v24, 16, v132
v_and_b32 v25, 0xffff0000, v132
v_lshlrev_b32 v26, 16, v133
v_and_b32 v27, 0xffff0000, v133
v_lshlrev_b32 v28, 16, v134
v_and_b32 v29, 0xffff0000, v134
v_lshlrev_b32 v30, 16, v135
v_and_b32 v31, 0xffff0000, v135
v_add_f32 v240, v240, v24
v_add_f32 v241, v241, v25
v_add_f32 v242, v242, v26
v_add_f32 v243, v243, v27
v_add_f32 v244, v244, v28
v_add_f32 v245, v245, v29
v_add_f32 v246, v246, v30
v_add_f32 v247, v247, v31
s_load_dword s3, s[4:5], 28672
s_load_dword s3, s[4:5], 28736
s_waitcnt vmcnt(16)
s_barrier
s_mov_b32 m0, 98304
s_nop 0
buffer_load_dwordx4 v16, s[8:11], s37 offen sc1 lds
s_mov_b32 m0, 101376
s_nop 0
buffer_load_dwordx4 v17, s[8:11], s37 offen sc1 lds
s_mov_b32 m0, 104448
s_nop 0
buffer_load_dwordx4 v18, s[8:11], s37 offen sc1 lds
s_mov_b32 m0, 107520
s_nop 0
buffer_load_dwordx4 v19, s[8:11], s37 offen sc1 lds
s_mov_b32 m0, 110592
s_nop 0
buffer_load_dwordx4 v20, s[8:11], s37 offen sc1 lds
s_mov_b32 m0, 113664
s_nop 0
buffer_load_dwordx4 v21, s[8:11], s37 offen sc1 lds
s_mov_b32 m0, 133120
s_nop 0
buffer_load_dwordx4 v22, s[12:15], s38 offen lds
s_mov_b32 m0, 136192
s_nop 0
buffer_load_dwordx4 v23, s[12:15], s38 offen lds
s_add_u32 s37, s37, 16384
s_add_u32 s38, s38, 131072
v_lshlrev_b32 v24, 16, v136
v_and_b32 v25, 0xffff0000, v136
v_lshlrev_b32 v26, 16, v137
v_and_b32 v27, 0xffff0000, v137
v_lshlrev_b32 v28, 16, v138
v_and_b32 v29, 0xffff0000, v138
v_lshlrev_b32 v30, 16, v139
v_and_b32 v31, 0xffff0000, v139
v_add_f32 v240, v240, v24
v_add_f32 v241, v241, v25
v_add_f32 v242, v242, v26
v_add_f32 v243, v243, v27
v_add_f32 v244, v244, v28
v_add_f32 v245, v245, v29
v_add_f32 v246, v246, v30
v_add_f32 v247, v247, v31
s_load_dword s3, s[4:5], 28800
s_load_dword s3, s[4:5], 28864
s_waitcnt vmcnt(16)
s_barrier
s_mov_b32 m0, 147456
s_nop 0
buffer_load_dwordx4 v16, s[8:11], s37 offen sc1 lds
s_mov_b32 m0, 150528
s_nop 0
buffer_load_dwordx4 v17, s[8:11], s37 offen sc1 lds
s_mov_b32 m0, 153600
s_nop 0
buffer_load_dwordx4 v18, s[8:11], s37 offen sc1 lds
s_mov_b32 m0, 156672
s_nop 0
buffer_load_dwordx4 v19, s[8:11], s37 offen sc1 lds
s_mov_b32 m0, 159744
s_nop 0
buffer_load_dwordx4 v20, s[8:11], s37 offen sc1 lds
s_mov_b32 m0, 162816
s_nop 0
buffer_load_dwordx4 v21, s[8:11], s37 offen sc1 lds
s_mov_b32 m0, 141312
s_nop 0
buffer_load_dwordx4 v22, s[12:15], s38 offen lds
s_mov_b32 m0, 144384
s_nop 0
buffer_load_dwordx4 v23, s[12:15], s38 offen lds
s_add_u32 s37, s37, 16384
s_add_u32 s38, s38, 131072
v_lshlrev_b32 v24, 16, v140
v_and_b32 v25, 0xffff0000, v140
v_lshlrev_b32 v26, 16, v141
v_and_b32 v27, 0xffff0000, v141
v_lshlrev_b32 v28, 16, v142
v_and_b32 v29, 0xffff0000, v142
v_lshlrev_b32 v30, 16, v143
v_and_b32 v31, 0xffff0000, v143
v_add_f32 v240, v240, v24
v_add_f32 v241, v241, v25
v_add_f32 v242, v242, v26
v_add_f32 v243, v243, v27
v_add_f32 v244, v244, v28
v_add_f32 v245, v245, v29
v_add_f32 v246, v246, v30
v_add_f32 v247, v247, v31
s_load_dword s3, s[4:5], 35840
s_load_dword s3, s[4:5], 35904
s_waitcnt vmcnt(16)
s_barrier
s_mov_b32 m0, 0
s_nop 0
buffer_load_dwordx4 v16, s[8:11], s37 offen sc1 lds
s_mov_b32 m0, 3072
s_nop 0
buffer_load_dwordx4 v17, s[8:11], s37 offen sc1 lds
s_mov_b32 m0, 6144
s_nop 0
buffer_load_dwordx4 v18, s[8:11], s37 offen sc1 lds
s_mov_b32 m0, 9216
s_nop 0
buffer_load_dwordx4 v19, s[8:11], s37 offen sc1 lds
s_mov_b32 m0, 12288
s_nop 0
buffer_load_dwordx4 v20, s[8:11], s37 offen sc1 lds
s_mov_b32 m0, 15360
s_nop 0
buffer_load_dwordx4 v21, s[8:11], s37 offen sc1 lds
s_mov_b32 m0, 116736
s_nop 0
buffer_load_dwordx4 v22, s[12:15], s38 offen lds
s_mov_b32 m0, 119808
s_nop 0
buffer_load_dwordx4 v23, s[12:15], s38 offen lds
s_add_u32 s37, s37, 16384
s_add_u32 s38, s38, 131072
v_lshlrev_b32 v24, 16, v144
v_and_b32 v25, 0xffff0000, v144
v_lshlrev_b32 v26, 16, v145
v_and_b32 v27, 0xffff0000, v145
v_lshlrev_b32 v28, 16, v146
v_and_b32 v29, 0xffff0000, v146
v_lshlrev_b32 v30, 16, v147
v_and_b32 v31, 0xffff0000, v147
v_add_f32 v240, v240, v24
v_add_f32 v241, v241, v25
v_add_f32 v242, v242, v26
v_add_f32 v243, v243, v27
v_add_f32 v244, v244, v28
v_add_f32 v245, v245, v29
v_add_f32 v246, v246, v30
v_add_f32 v247, v247, v31
s_load_dword s3, s[4:5], 35968
s_load_dword s3, s[4:5], 36032
s_waitcnt vmcnt(16)
s_barrier
s_mov_b32 m0, 49152
s_nop 0
buffer_load_dwordx4 v16, s[8:11], s37 offen sc1 lds
s_mov_b32 m0, 52224
s_nop 0
buffer_load_dwordx4 v17, s[8:11], s37 offen sc1 lds
s_mov_b32 m0, 55296
s_nop 0
buffer_load_dwordx4 v18, s[8:11], s37 offen sc1 lds
s_mov_b32 m0, 58368
s_nop 0
buffer_load_dwordx4 v19, s[8:11], s37 offen sc1 lds
s_mov_b32 m0, 61440
s_nop 0
buffer_load_dwordx4 v20, s[8:11], s37 offen sc1 lds
s_mov_b32 m0, 64512
s_nop 0
buffer_load_dwordx4 v21, s[8:11], s37 offen sc1 lds
s_mov_b32 m0, 124928
s_nop 0
buffer_load_dwordx4 v22, s[12:15], s38 offen lds
s_mov_b32 m0, 128000
s_nop 0
buffer_load_dwordx4 v23, s[12:15], s38 offen lds
s_add_u32 s37, s37, 16384
s_add_u32 s38, s38, 131072
v_lshlrev_b32 v24, 16, v148
v_and_b32 v25, 0xffff0000, v148
v_lshlrev_b32 v26, 16, v149
v_and_b32 v27, 0xffff0000, v149
v_lshlrev_b32 v28, 16, v150
v_and_b32 v29, 0xffff0000, v150
v_lshlrev_b32 v30, 16, v151
v_and_b32 v31, 0xffff0000, v151
v_add_f32 v240, v240, v24
v_add_f32 v241, v241, v25
v_add_f32 v242, v242, v26
v_add_f32 v243, v243, v27
v_add_f32 v244, v244, v28
v_add_f32 v245, v245, v29
v_add_f32 v246, v246, v30
v_add_f32 v247, v247, v31
s_load_dword s3, s[4:5], 43008
s_load_dword s3, s[4:5], 43072
s_waitcnt vmcnt(16)
s_barrier
s_mov_b32 m0, 98304
s_nop 0
buffer_load_dwordx4 v16, s[8:11], s37 offen sc1 lds
s_mov_b32 m0, 101376
s_nop 0
buffer_load_dwordx4 v17, s[8:11], s37 offen sc1 lds
s_mov_b32 m0, 104448
s_nop 0
buffer_load_dwordx4 v18, s[8:11], s37 offen sc1 lds
s_mov_b32 m0, 107520
s_nop 0
buffer_load_dwordx4 v19, s[8:11], s37 offen sc1 lds
s_mov_b32 m0, 110592
s_nop 0
buffer_load_dwordx4 v20, s[8:11], s37 offen sc1 lds
s_mov_b32 m0, 113664
s_nop 0
buffer_load_dwordx4 v21, s[8:11], s37 offen sc1 lds
s_mov_b32 m0, 133120
s_nop 0
buffer_load_dwordx4 v22, s[12:15], s38 offen lds
s_mov_b32 m0, 136192
s_nop 0
buffer_load_dwordx4 v23, s[12:15], s38 offen lds
s_add_u32 s37, s37, 16384
s_add_u32 s38, s38, 131072
v_lshlrev_b32 v24, 16, v152
v_and_b32 v25, 0xffff0000, v152
v_lshlrev_b32 v26, 16, v153
v_and_b32 v27, 0xffff0000, v153
v_lshlrev_b32 v28, 16, v154
v_and_b32 v29, 0xffff0000, v154
v_lshlrev_b32 v30, 16, v155
v_and_b32 v31, 0xffff0000, v155
v_add_f32 v240, v240, v24
v_add_f32 v241, v241, v25
v_add_f32 v242, v242, v26
v_add_f32 v243, v243, v27
v_add_f32 v244, v244, v28
v_add_f32 v245, v245, v29
v_add_f32 v246, v246, v30
v_add_f32 v247, v247, v31
s_load_dword s3, s[4:5], 43136
s_load_dword s3, s[4:5], 43200
s_waitcnt vmcnt(16)
s_barrier
s_mov_b32 m0, 147456
s_nop 0
buffer_load_dwordx4 v16, s[8:11], s37 offen sc1 lds
s_mov_b32 m0, 150528
s_nop 0
buffer_load_dwordx4 v17, s[8:11], s37 offen sc1 lds
s_mov_b32 m0, 153600
s_nop 0
buffer_load_dwordx4 v18, s[8:11], s37 offen sc1 lds
s_mov_b32 m0, 156672
s_nop 0
buffer_load_dwordx4 v19, s[8:11], s37 offen sc1 lds
s_mov_b32 m0, 159744
s_nop 0
buffer_load_dwordx4 v20, s[8:11], s37 offen sc1 lds
s_mov_b32 m0, 162816
s_nop 0
buffer_load_dwordx4 v21, s[8:11], s37 offen sc1 lds
s_mov_b32 m0, 141312
s_nop 0
buffer_load_dwordx4 v22, s[12:15], s38 offen lds
s_mov_b32 m0, 144384
s_nop 0
buffer_load_dwordx4 v23, s[12:15], s38 offen lds
s_add_u32 s37, s37, 16384
s_add_u32 s38, s38, 131072
v_lshlrev_b32 v24, 16, v156
v_and_b32 v25, 0xffff0000, v156
v_lshlrev_b32 v26, 16, v157
v_and_b32 v27, 0xffff0000, v157
v_lshlrev_b32 v28, 16, v158
v_and_b32 v29, 0xffff0000, v158
v_lshlrev_b32 v30, 16, v159
v_and_b32 v31, 0xffff0000, v159
v_add_f32 v240, v240, v24
v_add_f32 v241, v241, v25
v_add_f32 v242, v242, v26
v_add_f32 v243, v243, v27
v_add_f32 v244, v244, v28
v_add_f32 v245, v245, v29
v_add_f32 v246, v246, v30
v_add_f32 v247, v247, v31
s_load_dword s3, s[4:5], 50176
s_load_dword s3, s[4:5], 50240
s_waitcnt vmcnt(16)
s_barrier
s_mov_b32 m0, 0
s_nop 0
buffer_load_dwordx4 v16, s[8:11], s37 offen sc1 lds
s_mov_b32 m0, 3072
s_nop 0
buffer_load_dwordx4 v17, s[8:11], s37 offen sc1 lds
s_mov_b32 m0, 6144
s_nop 0
buffer_load_dwordx4 v18, s[8:11], s37 offen sc1 lds
s_mov_b32 m0, 9216
s_nop 0
buffer_load_dwordx4 v19, s[8:11], s37 offen sc1 lds
s_mov_b32 m0, 12288
s_nop 0
buffer_load_dwordx4 v20, s[8:11], s37 offen sc1 lds
s_mov_b32 m0, 15360
s_nop 0
buffer_load_dwordx4 v21, s[8:11], s37 offen sc1 lds
s_mov_b32 m0, 116736
s_nop 0
buffer_load_dwordx4 v22, s[12:15], s38 offen lds
s_mov_b32 m0, 119808
s_nop 0
buffer_load_dwordx4 v23, s[12:15], s38 offen lds
s_add_u32 s37, s37, 16384
s_add_u32 s38, s38, 131072
s_load_dword s3, s[4:5], 50304
s_load_dword s3, s[4:5], 50368
s_waitcnt vmcnt(16)
s_barrier
s_mov_b32 m0, 49152
s_nop 0
buffer_load_dwordx4 v16, s[8:11], s37 offen sc1 lds
s_mov_b32 m0, 52224
s_nop 0
buffer_load_dwordx4 v17, s[8:11], s37 offen sc1 lds
s_mov_b32 m0, 55296
s_nop 0
buffer_load_dwordx4 v18, s[8:11], s37 offen sc1 lds
s_mov_b32 m0, 58368
s_nop 0
buffer_load_dwordx4 v19, s[8:11], s37 offen sc1 lds
s_mov_b32 m0, 61440
s_nop 0
buffer_load_dwordx4 v20, s[8:11], s37 offen sc1 lds
s_mov_b32 m0, 64512
s_nop 0
buffer_load_dwordx4 v21, s[8:11], s37 offen sc1 lds
s_mov_b32 m0, 124928
s_nop 0
buffer_load_dwordx4 v22, s[12:15], s38 offen lds
s_mov_b32 m0, 128000
s_nop 0
buffer_load_dwordx4 v23, s[12:15], s38 offen lds
s_add_u32 s37, s37, 16384
s_add_u32 s38, s38, 131072
s_load_dword s3, s[4:5], 57344
s_load_dword s3, s[4:5], 57408
s_waitcnt vmcnt(16)
s_barrier
s_mov_b32 m0, 98304
s_nop 0
buffer_load_dwordx4 v16, s[8:11], s37 offen sc1 lds
s_mov_b32 m0, 101376
s_nop 0
buffer_load_dwordx4 v17, s[8:11], s37 offen sc1 lds
s_mov_b32 m0, 104448
s_nop 0
buffer_load_dwordx4 v18, s[8:11], s37 offen sc1 lds
s_mov_b32 m0, 107520
s_nop 0
buffer_load_dwordx4 v19, s[8:11], s37 offen sc1 lds
s_mov_b32 m0, 110592
s_nop 0
buffer_load_dwordx4 v20, s[8:11], s37 offen sc1 lds
s_mov_b32 m0, 113664
s_nop 0
buffer_load_dwordx4 v21, s[8:11], s37 offen sc1 lds
s_mov_b32 m0, 133120
s_nop 0
buffer_load_dwordx4 v22, s[12:15], s38 offen lds
s_mov_b32 m0, 136192
s_nop 0
buffer_load_dwordx4 v23, s[12:15], s38 offen lds
s_add_u32 s37, s37, 16384
s_add_u32 s38, s38, 131072
s_load_dword s3, s[4:5], 57472
s_load_dword s3, s[4:5], 57536
s_waitcnt vmcnt(16)
s_barrier
s_mov_b32 m0, 147456
s_nop 0
buffer_load_dwordx4 v16, s[8:11], s37 offen sc1 lds
s_mov_b32 m0, 150528
s_nop 0
buffer_load_dwordx4 v17, s[8:11], s37 offen sc1 lds
s_mov_b32 m0, 153600
s_nop 0
buffer_load_dwordx4 v18, s[8:11], s37 offen sc1 lds
s_mov_b32 m0, 156672
s_nop 0
buffer_load_dwordx4 v19, s[8:11], s37 offen sc1 lds
s_mov_b32 m0, 159744
s_nop 0
buffer_load_dwordx4 v20, s[8:11], s37 offen sc1 lds
s_mov_b32 m0, 162816
s_nop 0
buffer_load_dwordx4 v21, s[8:11], s37 offen sc1 lds
s_mov_b32 m0, 141312
s_nop 0
buffer_load_dwordx4 v22, s[12:15], s38 offen lds
s_mov_b32 m0, 144384
s_nop 0
buffer_load_dwordx4 v23, s[12:15], s38 offen lds
s_add_u32 s37, s37, 16384
s_add_u32 s38, s38, 131072
s_load_dword s3, s[4:5], 64512
s_load_dword s3, s[4:5], 64576
s_waitcnt vmcnt(16)
s_barrier
s_nop 0
v_permlane32_swap_b32 v240, v244
v_permlane32_swap_b32 v241, v245
v_permlane32_swap_b32 v242, v246
v_permlane32_swap_b32 v243, v247
v_add_f32 v240, v240, v244
v_add_f32 v241, v241, v245
v_add_f32 v242, v242, v246
v_add_f32 v243, v243, v247
s_nop 0
v_permlane16_swap_b32 v240, v242
v_permlane16_swap_b32 v241, v243
v_add_f32 v240, v240, v242
v_add_f32 v241, v241, v243
s_load_dword s3, s[4:5], 64640
s_load_dword s3, s[4:5], 64704
s_waitcnt vmcnt(8)
s_barrier
s_add_u32 m0, s46, 0
s_mov_b32 s38, 0
buffer_load_dwordx4 v8, s[88:91], s38 offen lds
s_add_u32 m0, s46, 1024
s_mov_b32 s38, 0
buffer_load_dwordx4 v9, s[88:91], s38 offen lds
s_add_u32 m0, s46, 2048
s_mov_b32 s38, 0
buffer_load_dwordx4 v10, s[88:91], s38 offen lds
s_add_u32 m0, s46, 3072
s_mov_b32 s38, 114688
buffer_load_dwordx4 v8, s[88:91], s38 offen lds
s_branch Lov_6
.p2align 12
Lst_6_0:
s_branch Lst_10_0
s_nop 0
Lov_6:
s_add_u32 m0, s46, 4096
s_mov_b32 s38, 114688
buffer_load_dwordx4 v9, s[88:91], s38 offen lds
s_add_u32 m0, s46, 5120
s_mov_b32 s38, 114688
buffer_load_dwordx4 v10, s[88:91], s38 offen lds
s_add_u32 m0, s46, 49152
s_mov_b32 s38, 458752
buffer_load_dwordx4 v8, s[88:91], s38 offen lds
s_add_u32 m0, s46, 50176
s_mov_b32 s38, 458752
buffer_load_dwordx4 v9, s[88:91], s38 offen lds
s_add_u32 m0, s46, 51200
s_mov_b32 s38, 458752
buffer_load_dwordx4 v10, s[88:91], s38 offen lds
s_add_u32 m0, s46, 52224
s_mov_b32 s38, 573440
buffer_load_dwordx4 v8, s[88:91], s38 offen lds
s_add_u32 m0, s46, 53248
s_mov_b32 s38, 573440
buffer_load_dwordx4 v9, s[88:91], s38 offen lds
s_add_u32 m0, s46, 54272
s_mov_b32 s38, 573440
buffer_load_dwordx4 v10, s[88:91], s38 offen lds
s_load_dword s3, s[4:5], 71680
s_load_dword s3, s[4:5], 71744
s_waitcnt vmcnt(12)
s_barrier
s_load_dword s3, s[4:5], 71808
s_load_dword s3, s[4:5], 71872
s_barrier
s_load_dword s3, s[4:5], 78848
s_load_dword s3, s[4:5], 78912
s_barrier
s_branch Lk2end_72
Lp_77:
v_add_u32 v16, 1024, v2
v_add_u32 v17, 4096, v2
v_add_u32 v18, 7168, v2
v_add_u32 v19, 10240, v2
v_add_u32 v20, 13312, v2
v_add_u32 v21, 0, v3
v_add_u32 v22, 49152, v3
v_add_u32 v23, 98304, v3
s_and_b32 s44, s36, 3
s_mul_i32 s44, s44, 17
s_bfe_u32 s43, s2, 0x30001
s_lshl_b32 s43, s43, 7
s_add_u32 s44, s44, s43
s_add_u32 s44, s44, 60
s_mul_i32 s44, s44, 7168
s_lshr_b32 s43, s2, 4
s_lshl_b32 s43, s43, 8
s_add_u32 s43, s43, s44
s_bitcmp0_b32 s2, 0
s_cselect_b32 s4, s72, s74
s_cselect_b32 s5, s73, s75
s_add_u32 s4, s4, s43
s_addc_u32 s5, s5, 0
s_load_dword s3, s[4:5], 0
s_load_dword s3, s[4:5], 64
s_load_dword s3, s[4:5], 128
s_load_dword s3, s[4:5], 192
s_load_dword s3, s[4:5], 7168
s_load_dword s3, s[4:5], 7232
s_load_dword s3, s[4:5], 7296
s_load_dword s3, s[4:5], 7360
s_load_dword s3, s[4:5], 14336
s_load_dword s3, s[4:5], 14400
s_load_dword s3, s[4:5], 14464
s_load_dword s3, s[4:5], 14528
s_load_dword s3, s[4:5], 21504
s_load_dword s3, s[4:5], 21568
s_bitcmp0_b32 s36, 1
s_cselect_b32 s44, s72, s74
s_cselect_b32 s45, s73, s75
s_mul_i32 s43, s35, 192
s_add_u32 s88, s44, s43
s_addc_u32 s89, s45, 0
s_add_u32 s88, s88, 4096
s_addc_u32 s89, s89, 0
s_mov_b32 s90, 7333056
s_mov_b32 s91, 0x20000
v_add_u32 v11, 0, v1
v_mul_u32_u24 v12, 5462, v11
v_lshrrev_b32 v12, 16, v12
v_mul_u32_u24 v13, 12, v12
v_sub_u32 v13, v11, v13
v_bfe_u32 v14, v12, 2, 1
v_cmp_gt_u32 vcc, 8, v13
v_lshlrev_b32 v15, 1, v14
v_mul_u32_u24 v12, 7168, v12
v_cndmask_b32 v14, v14, v15, vcc
v_xor_b32 v13, v13, v14
v_lshl_add_u32 v8, v13, 4, v12
v_add_u32 v11, 64, v1
v_mul_u32_u24 v12, 5462, v11
v_lshrrev_b32 v12, 16, v12
v_mul_u32_u24 v13, 12, v12
v_sub_u32 v13, v11, v13
v_bfe_u32 v14, v12, 2, 1
v_cmp_gt_u32 vcc, 8, v13
v_lshlrev_b32 v15, 1, v14
v_mul_u32_u24 v12, 7168, v12
v_cndmask_b32 v14, v14, v15, vcc
v_xor_b32 v13, v13, v14
v_lshl_add_u32 v9, v13, 4, v12
v_add_u32 v11, 128, v1
v_mul_u32_u24 v12, 5462, v11
v_lshrrev_b32 v12, 16, v12
v_mul_u32_u24 v13, 12, v12
v_sub_u32 v13, v11, v13
v_bfe_u32 v14, v12, 2, 1
v_cmp_gt_u32 vcc, 8, v13
v_lshlrev_b32 v15, 1, v14
v_mul_u32_u24 v12, 7168, v12
v_cndmask_b32 v14, v14, v15, vcc
v_xor_b32 v13, v13, v14
v_lshl_add_u32 v10, v13, 4, v12
s_and_b32 s43, s36, 1
s_mul_i32 s43, s43, 229376
v_add_u32 v8, s43, v8
v_add_u32 v9, s43, v9
v_add_u32 v10, s43, v10
s_and_b32 s43, s36, 3
s_mul_i32 s46, s43, 6144
s_add_u32 s46, s46, 16384
s_barrier
s_mov_b32 s37, 0
s_mov_b32 m0, 1024
s_nop 0
buffer_load_dwordx4 v16, s[8:11], s37 offen sc1 lds
s_mov_b32 m0, 4096
s_nop 0
buffer_load_dwordx4 v17, s[8:11], s37 offen sc1 lds
s_mov_b32 m0, 7168
s_nop 0
buffer_load_dwordx4 v18, s[8:11], s37 offen sc1 lds
s_mov_b32 m0, 10240
s_nop 0
buffer_load_dwordx4 v19, s[8:11], s37 offen sc1 lds
s_mov_b32 m0, 13312
s_nop 0
buffer_load_dwordx4 v20, s[8:11], s37 offen sc1 lds
s_mov_b32 s37, 16384
s_mov_b32 m0, 50176
s_nop 0
buffer_load_dwordx4 v16, s[8:11], s37 offen sc1 lds
s_mov_b32 m0, 53248
s_nop 0
buffer_load_dwordx4 v17, s[8:11], s37 offen sc1 lds
s_mov_b32 m0, 56320
s_nop 0
buffer_load_dwordx4 v18, s[8:11], s37 offen sc1 lds
s_mov_b32 m0, 59392
s_nop 0
buffer_load_dwordx4 v19, s[8:11], s37 offen sc1 lds
s_mov_b32 m0, 62464
s_nop 0
buffer_load_dwordx4 v20, s[8:11], s37 offen sc1 lds
s_mov_b32 s37, 32768
s_mov_b32 m0, 99328
s_nop 0
buffer_load_dwordx4 v16, s[8:11], s37 offen sc1 lds
s_mov_b32 m0, 102400
s_nop 0
buffer_load_dwordx4 v17, s[8:11], s37 offen sc1 lds
s_mov_b32 m0, 105472
s_nop 0
buffer_load_dwordx4 v18, s[8:11], s37 offen sc1 lds
s_mov_b32 m0, 108544
s_nop 0
buffer_load_dwordx4 v19, s[8:11], s37 offen sc1 lds
s_mov_b32 m0, 111616
s_nop 0
buffer_load_dwordx4 v20, s[8:11], s37 offen sc1 lds
s_mov_b32 s37, 49152
s_mov_b32 m0, 148480
s_nop 0
buffer_load_dwordx4 v16, s[8:11], s37 offen sc1 lds
s_mov_b32 m0, 151552
s_nop 0
buffer_load_dwordx4 v17, s[8:11], s37 offen sc1 lds
s_mov_b32 m0, 154624
s_nop 0
buffer_load_dwordx4 v18, s[8:11], s37 offen sc1 lds
s_mov_b32 m0, 157696
s_nop 0
buffer_load_dwordx4 v19, s[8:11], s37 offen sc1 lds
s_mov_b32 m0, 160768
s_nop 0
buffer_load_dwordx4 v20, s[8:11], s37 offen sc1 lds
s_mov_b32 s37, 65536
s_mov_b32 s38, 524288
s_waitcnt vmcnt(15)
s_barrier
s_waitcnt vmcnt(10)
s_barrier
s_mov_b32 m0, 1024
s_nop 0
buffer_load_dwordx4 v16, s[8:11], s37 offen sc1 lds
s_mov_b32 m0, 4096
s_nop 0
buffer_load_dwordx4 v17, s[8:11], s37 offen sc1 lds
s_mov_b32 m0, 7168
s_nop 0
buffer_load_dwordx4 v18, s[8:11], s37 offen sc1 lds
s_mov_b32 m0, 10240
s_nop 0
buffer_load_dwordx4 v19, s[8:11], s37 offen sc1 lds
s_mov_b32 m0, 13312
s_nop 0
buffer_load_dwordx4 v20, s[8:11], s37 offen sc1 lds
s_mov_b32 m0, 114688
s_nop 0
buffer_load_dwordx4 v21, s[12:15], s38 offen lds
s_mov_b32 m0, 117760
s_nop 0
buffer_load_dwordx4 v22, s[12:15], s38 offen lds
s_mov_b32 m0, 120832
s_nop 0
buffer_load_dwordx4 v23, s[12:15], s38 offen lds
s_add_u32 s37, s37, 16384
s_add_u32 s38, s38, 131072
v_lshlrev_b32 v240, 16, v128
v_and_b32 v241, 0xffff0000, v128
v_lshlrev_b32 v242, 16, v129
v_and_b32 v243, 0xffff0000, v129
v_lshlrev_b32 v244, 16, v130
v_and_b32 v245, 0xffff0000, v130
v_lshlrev_b32 v246, 16, v131
v_and_b32 v247, 0xffff0000, v131
s_load_dword s3, s[4:5], 21632
s_load_dword s3, s[4:5], 21696
s_waitcnt vmcnt(13)
s_barrier
s_mov_b32 m0, 50176
s_nop 0
buffer_load_dwordx4 v16, s[8:11], s37 offen sc1 lds
s_mov_b32 m0, 53248
s_nop 0
buffer_load_dwordx4 v17, s[8:11], s37 offen sc1 lds
s_mov_b32 m0, 56320
s_nop 0
buffer_load_dwordx4 v18, s[8:11], s37 offen sc1 lds
s_mov_b32 m0, 59392
s_nop 0
buffer_load_dwordx4 v19, s[8:11], s37 offen sc1 lds
s_mov_b32 m0, 62464
s_nop 0
buffer_load_dwordx4 v20, s[8:11], s37 offen sc1 lds
s_mov_b32 m0, 122880
s_nop 0
buffer_load_dwordx4 v21, s[12:15], s38 offen lds
s_mov_b32 m0, 125952
s_nop 0
buffer_load_dwordx4 v22, s[12:15], s38 offen lds
s_mov_b32 m0, 129024
s_nop 0
buffer_load_dwordx4 v23, s[12:15], s38 offen lds
s_add_u32 s37, s37, 16384
s_add_u32 s38, s38, 131072
v_lshlrev_b32 v24, 16, v132
v_and_b32 v25, 0xffff0000, v132
v_lshlrev_b32 v26, 16, v133
v_and_b32 v27, 0xffff0000, v133
v_lshlrev_b32 v28, 16, v134
v_and_b32 v29, 0xffff0000, v134
v_lshlrev_b32 v30, 16, v135
v_and_b32 v31, 0xffff0000, v135
v_add_f32 v240, v240, v24
v_add_f32 v241, v241, v25
v_add_f32 v242, v242, v26
v_add_f32 v243, v243, v27
v_add_f32 v244, v244, v28
v_add_f32 v245, v245, v29
v_add_f32 v246, v246, v30
v_add_f32 v247, v247, v31
s_load_dword s3, s[4:5], 28672
s_load_dword s3, s[4:5], 28736
s_waitcnt vmcnt(16)
s_barrier
s_mov_b32 m0, 99328
s_nop 0
buffer_load_dwordx4 v16, s[8:11], s37 offen sc1 lds
s_mov_b32 m0, 102400
s_nop 0
buffer_load_dwordx4 v17, s[8:11], s37 offen sc1 lds
s_mov_b32 m0, 105472
s_nop 0
buffer_load_dwordx4 v18, s[8:11], s37 offen sc1 lds
s_mov_b32 m0, 108544
s_nop 0
buffer_load_dwordx4 v19, s[8:11], s37 offen sc1 lds
s_mov_b32 m0, 111616
s_nop 0
buffer_load_dwordx4 v20, s[8:11], s37 offen sc1 lds
s_mov_b32 m0, 131072
s_nop 0
buffer_load_dwordx4 v21, s[12:15], s38 offen lds
s_mov_b32 m0, 134144
s_nop 0
buffer_load_dwordx4 v22, s[12:15], s38 offen lds
s_mov_b32 m0, 137216
s_nop 0
buffer_load_dwordx4 v23, s[12:15], s38 offen lds
s_add_u32 s37, s37, 16384
s_add_u32 s38, s38, 131072
v_lshlrev_b32 v24, 16, v136
v_and_b32 v25, 0xffff0000, v136
v_lshlrev_b32 v26, 16, v137
v_and_b32 v27, 0xffff0000, v137
v_lshlrev_b32 v28, 16, v138
v_and_b32 v29, 0xffff0000, v138
v_lshlrev_b32 v30, 16, v139
v_and_b32 v31, 0xffff0000, v139
v_add_f32 v240, v240, v24
v_add_f32 v241, v241, v25
v_add_f32 v242, v242, v26
v_add_f32 v243, v243, v27
v_add_f32 v244, v244, v28
v_add_f32 v245, v245, v29
v_add_f32 v246, v246, v30
v_add_f32 v247, v247, v31
s_load_dword s3, s[4:5], 28800
s_load_dword s3, s[4:5], 28864
s_waitcnt vmcnt(16)
s_barrier
s_mov_b32 m0, 148480
s_nop 0
buffer_load_dwordx4 v16, s[8:11], s37 offen sc1 lds
s_mov_b32 m0, 151552
s_nop 0
buffer_load_dwordx4 v17, s[8:11], s37 offen sc1 lds
s_mov_b32 m0, 154624
s_nop 0
buffer_load_dwordx4 v18, s[8:11], s37 offen sc1 lds
s_mov_b32 m0, 157696
s_nop 0
buffer_load_dwordx4 v19, s[8:11], s37 offen sc1 lds
s_mov_b32 m0, 160768
s_nop 0
buffer_load_dwordx4 v20, s[8:11], s37 offen sc1 lds
s_mov_b32 m0, 139264
s_nop 0
buffer_load_dwordx4 v21, s[12:15], s38 offen lds
s_mov_b32 m0, 142336
s_nop 0
buffer_load_dwordx4 v22, s[12:15], s38 offen lds
s_mov_b32 m0, 145408
s_nop 0
buffer_load_dwordx4 v23, s[12:15], s38 offen lds
s_add_u32 s37, s37, 16384
s_add_u32 s38, s38, 131072
v_lshlrev_b32 v24, 16, v140
v_and_b32 v25, 0xffff0000, v140
v_lshlrev_b32 v26, 16, v141
v_and_b32 v27, 0xffff0000, v141
v_lshlrev_b32 v28, 16, v142
v_and_b32 v29, 0xffff0000, v142
v_lshlrev_b32 v30, 16, v143
v_and_b32 v31, 0xffff0000, v143
v_add_f32 v240, v240, v24
v_add_f32 v241, v241, v25
v_add_f32 v242, v242, v26
v_add_f32 v243, v243, v27
v_add_f32 v244, v244, v28
v_add_f32 v245, v245, v29
v_add_f32 v246, v246, v30
v_add_f32 v247, v247, v31
s_load_dword s3, s[4:5], 35840
s_load_dword s3, s[4:5], 35904
s_waitcnt vmcnt(16)
s_barrier
s_mov_b32 m0, 1024
s_nop 0
buffer_load_dwordx4 v16, s[8:11], s37 offen sc1 lds
s_mov_b32 m0, 4096
s_nop 0
buffer_load_dwordx4 v17, s[8:11], s37 offen sc1 lds
s_mov_b32 m0, 7168
s_nop 0
buffer_load_dwordx4 v18, s[8:11], s37 offen sc1 lds
s_mov_b32 m0, 10240
s_nop 0
buffer_load_dwordx4 v19, s[8:11], s37 offen sc1 lds
s_mov_b32 m0, 13312
s_nop 0
buffer_load_dwordx4 v20, s[8:11], s37 offen sc1 lds
s_mov_b32 m0, 114688
s_nop 0
buffer_load_dwordx4 v21, s[12:15], s38 offen lds
s_mov_b32 m0, 117760
s_nop 0
buffer_load_dwordx4 v22, s[12:15], s38 offen lds
s_mov_b32 m0, 120832
s_nop 0
buffer_load_dwordx4 v23, s[12:15], s38 offen lds
s_add_u32 s37, s37, 16384
s_add_u32 s38, s38, 131072
v_lshlrev_b32 v24, 16, v144
v_and_b32 v25, 0xffff0000, v144
v_lshlrev_b32 v26, 16, v145
v_and_b32 v27, 0xffff0000, v145
v_lshlrev_b32 v28, 16, v146
v_and_b32 v29, 0xffff0000, v146
v_lshlrev_b32 v30, 16, v147
v_and_b32 v31, 0xffff0000, v147
v_add_f32 v240, v240, v24
v_add_f32 v241, v241, v25
v_add_f32 v242, v242, v26
v_add_f32 v243, v243, v27
v_add_f32 v244, v244, v28
v_add_f32 v245, v245, v29
v_add_f32 v246, v246, v30
v_add_f32 v247, v247, v31
s_load_dword s3, s[4:5], 35968
s_load_dword s3, s[4:5], 36032
s_waitcnt vmcnt(16)
s_barrier
s_mov_b32 m0, 50176
s_nop 0
buffer_load_dwordx4 v16, s[8:11], s37 offen sc1 lds
s_mov_b32 m0, 53248
s_nop 0
buffer_load_dwordx4 v17, s[8:11], s37 offen sc1 lds
s_mov_b32 m0, 56320
s_nop 0
buffer_load_dwordx4 v18, s[8:11], s37 offen sc1 lds
s_mov_b32 m0, 59392
s_nop 0
buffer_load_dwordx4 v19, s[8:11], s37 offen sc1 lds
s_mov_b32 m0, 62464
s_nop 0
buffer_load_dwordx4 v20, s[8:11], s37 offen sc1 lds
s_mov_b32 m0, 122880
s_nop 0
buffer_load_dwordx4 v21, s[12:15], s38 offen lds
s_mov_b32 m0, 125952
s_nop 0
buffer_load_dwordx4 v22, s[12:15], s38 offen lds
s_mov_b32 m0, 129024
s_nop 0
buffer_load_dwordx4 v23, s[12:15], s38 offen lds
s_add_u32 s37, s37, 16384
s_add_u32 s38, s38, 131072
v_lshlrev_b32 v24, 16, v148
v_and_b32 v25, 0xffff0000, v148
v_lshlrev_b32 v26, 16, v149
v_and_b32 v27, 0xffff0000, v149
v_lshlrev_b32 v28, 16, v150
v_and_b32 v29, 0xffff0000, v150
v_lshlrev_b32 v30, 16, v151
v_and_b32 v31, 0xffff0000, v151
v_add_f32 v240, v240, v24
v_add_f32 v241, v241, v25
v_add_f32 v242, v242, v26
v_add_f32 v243, v243, v27
v_add_f32 v244, v244, v28
v_add_f32 v245, v245, v29
v_add_f32 v246, v246, v30
v_add_f32 v247, v247, v31
s_load_dword s3, s[4:5], 43008
s_load_dword s3, s[4:5], 43072
s_waitcnt vmcnt(16)
s_barrier
s_mov_b32 m0, 99328
s_nop 0
buffer_load_dwordx4 v16, s[8:11], s37 offen sc1 lds
s_mov_b32 m0, 102400
s_nop 0
buffer_load_dwordx4 v17, s[8:11], s37 offen sc1 lds
s_mov_b32 m0, 105472
s_nop 0
buffer_load_dwordx4 v18, s[8:11], s37 offen sc1 lds
s_mov_b32 m0, 108544
s_nop 0
buffer_load_dwordx4 v19, s[8:11], s37 offen sc1 lds
s_mov_b32 m0, 111616
s_nop 0
buffer_load_dwordx4 v20, s[8:11], s37 offen sc1 lds
s_mov_b32 m0, 131072
s_nop 0
buffer_load_dwordx4 v21, s[12:15], s38 offen lds
s_mov_b32 m0, 134144
s_nop 0
buffer_load_dwordx4 v22, s[12:15], s38 offen lds
s_mov_b32 m0, 137216
s_nop 0
buffer_load_dwordx4 v23, s[12:15], s38 offen lds
s_add_u32 s37, s37, 16384
s_add_u32 s38, s38, 131072
v_lshlrev_b32 v24, 16, v152
v_and_b32 v25, 0xffff0000, v152
v_lshlrev_b32 v26, 16, v153
v_and_b32 v27, 0xffff0000, v153
v_lshlrev_b32 v28, 16, v154
v_and_b32 v29, 0xffff0000, v154
v_lshlrev_b32 v30, 16, v155
v_and_b32 v31, 0xffff0000, v155
v_add_f32 v240, v240, v24
v_add_f32 v241, v241, v25
v_add_f32 v242, v242, v26
v_add_f32 v243, v243, v27
v_add_f32 v244, v244, v28
v_add_f32 v245, v245, v29
v_add_f32 v246, v246, v30
v_add_f32 v247, v247, v31
s_load_dword s3, s[4:5], 43136
s_load_dword s3, s[4:5], 43200
s_waitcnt vmcnt(16)
s_barrier
s_mov_b32 m0, 148480
s_nop 0
buffer_load_dwordx4 v16, s[8:11], s37 offen sc1 lds
s_mov_b32 m0, 151552
s_nop 0
buffer_load_dwordx4 v17, s[8:11], s37 offen sc1 lds
s_mov_b32 m0, 154624
s_nop 0
buffer_load_dwordx4 v18, s[8:11], s37 offen sc1 lds
s_mov_b32 m0, 157696
s_nop 0
buffer_load_dwordx4 v19, s[8:11], s37 offen sc1 lds
s_mov_b32 m0, 160768
s_nop 0
buffer_load_dwordx4 v20, s[8:11], s37 offen sc1 lds
s_mov_b32 m0, 139264
s_nop 0
buffer_load_dwordx4 v21, s[12:15], s38 offen lds
s_mov_b32 m0, 142336
s_nop 0
buffer_load_dwordx4 v22, s[12:15], s38 offen lds
s_mov_b32 m0, 145408
s_nop 0
buffer_load_dwordx4 v23, s[12:15], s38 offen lds
s_add_u32 s37, s37, 16384
s_add_u32 s38, s38, 131072
v_lshlrev_b32 v24, 16, v156
v_and_b32 v25, 0xffff0000, v156
v_lshlrev_b32 v26, 16, v157
v_and_b32 v27, 0xffff0000, v157
v_lshlrev_b32 v28, 16, v158
v_and_b32 v29, 0xffff0000, v158
v_lshlrev_b32 v30, 16, v159
v_and_b32 v31, 0xffff0000, v159
v_add_f32 v240, v240, v24
v_add_f32 v241, v241, v25
v_add_f32 v242, v242, v26
v_add_f32 v243, v243, v27
v_add_f32 v244, v244, v28
v_add_f32 v245, v245, v29
v_add_f32 v246, v246, v30
v_add_f32 v247, v247, v31
s_load_dword s3, s[4:5], 50176
s_load_dword s3, s[4:5], 50240
s_waitcnt vmcnt(16)
s_barrier
s_mov_b32 m0, 1024
s_nop 0
buffer_load_dwordx4 v16, s[8:11], s37 offen sc1 lds
s_mov_b32 m0, 4096
s_nop 0
buffer_load_dwordx4 v17, s[8:11], s37 offen sc1 lds
s_mov_b32 m0, 7168
s_nop 0
buffer_load_dwordx4 v18, s[8:11], s37 offen sc1 lds
s_mov_b32 m0, 10240
s_nop 0
buffer_load_dwordx4 v19, s[8:11], s37 offen sc1 lds
s_mov_b32 m0, 13312
s_nop 0
buffer_load_dwordx4 v20, s[8:11], s37 offen sc1 lds
s_mov_b32 m0, 114688
s_nop 0
buffer_load_dwordx4 v21, s[12:15], s38 offen lds
s_mov_b32 m0, 117760
s_nop 0
buffer_load_dwordx4 v22, s[12:15], s38 offen lds
s_mov_b32 m0, 120832
s_nop 0
buffer_load_dwordx4 v23, s[12:15], s38 offen lds
s_add_u32 s37, s37, 16384
s_add_u32 s38, s38, 131072
s_load_dword s3, s[4:5], 50304
s_load_dword s3, s[4:5], 50368
s_waitcnt vmcnt(16)
s_barrier
s_mov_b32 m0, 50176
s_nop 0
buffer_load_dwordx4 v16, s[8:11], s37 offen sc1 lds
s_mov_b32 m0, 53248
s_nop 0
buffer_load_dwordx4 v17, s[8:11], s37 offen sc1 lds
s_mov_b32 m0, 56320
s_nop 0
buffer_load_dwordx4 v18, s[8:11], s37 offen sc1 lds
s_mov_b32 m0, 59392
s_nop 0
buffer_load_dwordx4 v19, s[8:11], s37 offen sc1 lds
s_mov_b32 m0, 62464
s_nop 0
buffer_load_dwordx4 v20, s[8:11], s37 offen sc1 lds
s_mov_b32 m0, 122880
s_nop 0
buffer_load_dwordx4 v21, s[12:15], s38 offen lds
s_mov_b32 m0, 125952
s_nop 0
buffer_load_dwordx4 v22, s[12:15], s38 offen lds
s_mov_b32 m0, 129024
s_nop 0
buffer_load_dwordx4 v23, s[12:15], s38 offen lds
s_add_u32 s37, s37, 16384
s_add_u32 s38, s38, 131072
s_load_dword s3, s[4:5], 57344
s_load_dword s3, s[4:5], 57408
s_waitcnt vmcnt(16)
s_barrier
s_mov_b32 m0, 99328
s_nop 0
buffer_load_dwordx4 v16, s[8:11], s37 offen sc1 lds
s_mov_b32 m0, 102400
s_nop 0
buffer_load_dwordx4 v17, s[8:11], s37 offen sc1 lds
s_mov_b32 m0, 105472
s_nop 0
buffer_load_dwordx4 v18, s[8:11], s37 offen sc1 lds
s_mov_b32 m0, 108544
s_nop 0
buffer_load_dwordx4 v19, s[8:11], s37 offen sc1 lds
s_mov_b32 m0, 111616
s_nop 0
buffer_load_dwordx4 v20, s[8:11], s37 offen sc1 lds
s_mov_b32 m0, 131072
s_nop 0
buffer_load_dwordx4 v21, s[12:15], s38 offen lds
s_mov_b32 m0, 134144
s_nop 0
buffer_load_dwordx4 v22, s[12:15], s38 offen lds
s_mov_b32 m0, 137216
s_nop 0
buffer_load_dwordx4 v23, s[12:15], s38 offen lds
s_add_u32 s37, s37, 16384
s_add_u32 s38, s38, 131072
s_load_dword s3, s[4:5], 57472
s_load_dword s3, s[4:5], 57536
s_waitcnt vmcnt(16)
s_barrier
s_mov_b32 m0, 148480
s_nop 0
s_branch Lov_7
.p2align 12
Lst_7_0:
s_branch Lst_11_0
s_nop 0
Lov_7:
buffer_load_dwordx4 v16, s[8:11], s37 offen sc1 lds
s_mov_b32 m0, 151552
s_nop 0
buffer_load_dwordx4 v17, s[8:11], s37 offen sc1 lds
s_mov_b32 m0, 154624
s_nop 0
buffer_load_dwordx4 v18, s[8:11], s37 offen sc1 lds
s_mov_b32 m0, 157696
s_nop 0
buffer_load_dwordx4 v19, s[8:11], s37 offen sc1 lds
s_mov_b32 m0, 160768
s_nop 0
buffer_load_dwordx4 v20, s[8:11], s37 offen sc1 lds
s_mov_b32 m0, 139264
s_nop 0
buffer_load_dwordx4 v21, s[12:15], s38 offen lds
s_mov_b32 m0, 142336
s_nop 0
buffer_load_dwordx4 v22, s[12:15], s38 offen lds
s_mov_b32 m0, 145408
s_nop 0
buffer_load_dwordx4 v23, s[12:15], s38 offen lds
s_add_u32 s37, s37, 16384
s_add_u32 s38, s38, 131072
s_load_dword s3, s[4:5], 64512
s_load_dword s3, s[4:5], 64576
s_waitcnt vmcnt(16)
s_barrier
s_nop 0
v_permlane32_swap_b32 v240, v244
v_permlane32_swap_b32 v241, v245
v_permlane32_swap_b32 v242, v246
v_permlane32_swap_b32 v243, v247
v_add_f32 v240, v240, v244
v_add_f32 v241, v241, v245
v_add_f32 v242, v242, v246
v_add_f32 v243, v243, v247
s_nop 0
v_permlane16_swap_b32 v240, v242
v_permlane16_swap_b32 v241, v243
v_add_f32 v240, v240, v242
v_add_f32 v241, v241, v243
s_load_dword s3, s[4:5], 64640
s_load_dword s3, s[4:5], 64704
s_waitcnt vmcnt(8)
s_barrier
s_add_u32 m0, s46, 0
s_mov_b32 s38, 0
buffer_load_dwordx4 v8, s[88:91], s38 offen lds
s_add_u32 m0, s46, 1024
s_mov_b32 s38, 0
buffer_load_dwordx4 v9, s[88:91], s38 offen lds
s_add_u32 m0, s46, 2048
s_mov_b32 s38, 0
buffer_load_dwordx4 v10, s[88:91], s38 offen lds
s_add_u32 m0, s46, 3072
s_mov_b32 s38, 114688
buffer_load_dwordx4 v8, s[88:91], s38 offen lds
s_add_u32 m0, s46, 4096
s_mov_b32 s38, 114688
buffer_load_dwordx4 v9, s[88:91], s38 offen lds
s_add_u32 m0, s46, 5120
s_mov_b32 s38, 114688
buffer_load_dwordx4 v10, s[88:91], s38 offen lds
s_add_u32 m0, s46, 49152
s_mov_b32 s38, 458752
buffer_load_dwordx4 v8, s[88:91], s38 offen lds
s_add_u32 m0, s46, 50176
s_mov_b32 s38, 458752
buffer_load_dwordx4 v9, s[88:91], s38 offen lds
s_add_u32 m0, s46, 51200
s_mov_b32 s38, 458752
buffer_load_dwordx4 v10, s[88:91], s38 offen lds
s_add_u32 m0, s46, 52224
s_mov_b32 s38, 573440
buffer_load_dwordx4 v8, s[88:91], s38 offen lds
s_add_u32 m0, s46, 53248
s_mov_b32 s38, 573440
buffer_load_dwordx4 v9, s[88:91], s38 offen lds
s_add_u32 m0, s46, 54272
s_mov_b32 s38, 573440
buffer_load_dwordx4 v10, s[88:91], s38 offen lds
s_load_dword s3, s[4:5], 71680
s_load_dword s3, s[4:5], 71744
s_waitcnt vmcnt(12)
s_barrier
s_load_dword s3, s[4:5], 71808
s_load_dword s3, s[4:5], 71872
s_barrier
s_load_dword s3, s[4:5], 78848
s_load_dword s3, s[4:5], 78912
s_barrier
s_branch Lk2end_72
Lp_78:
v_add_u32 v16, 2048, v2
v_add_u32 v17, 5120, v2
v_add_u32 v18, 8192, v2
v_add_u32 v19, 11264, v2
v_add_u32 v20, 14336, v2
v_add_u32 v21, 16384, v3
v_add_u32 v22, 65536, v3
v_add_u32 v23, 114688, v3
s_and_b32 s44, s36, 3
s_mul_i32 s44, s44, 17
s_bfe_u32 s43, s2, 0x30001
s_lshl_b32 s43, s43, 7
s_add_u32 s44, s44, s43
s_add_u32 s44, s44, 60
s_mul_i32 s44, s44, 7168
s_lshr_b32 s43, s2, 4
s_lshl_b32 s43, s43, 8
s_add_u32 s43, s43, s44
s_bitcmp0_b32 s2, 0
s_cselect_b32 s4, s72, s74
s_cselect_b32 s5, s73, s75
s_add_u32 s4, s4, s43
s_addc_u32 s5, s5, 0
s_load_dword s3, s[4:5], 0
s_load_dword s3, s[4:5], 64
s_load_dword s3, s[4:5], 128
s_load_dword s3, s[4:5], 192
s_load_dword s3, s[4:5], 7168
s_load_dword s3, s[4:5], 7232
s_load_dword s3, s[4:5], 7296
s_load_dword s3, s[4:5], 7360
s_load_dword s3, s[4:5], 14336
s_load_dword s3, s[4:5], 14400
s_load_dword s3, s[4:5], 14464
s_load_dword s3, s[4:5], 14528
s_load_dword s3, s[4:5], 21504
s_load_dword s3, s[4:5], 21568
s_bitcmp0_b32 s36, 1
s_cselect_b32 s44, s72, s74
s_cselect_b32 s45, s73, s75
s_mul_i32 s43, s35, 192
s_add_u32 s88, s44, s43
s_addc_u32 s89, s45, 0
s_add_u32 s88, s88, 4096
s_addc_u32 s89, s89, 0
s_mov_b32 s90, 7333056
s_mov_b32 s91, 0x20000
v_add_u32 v11, 0, v1
v_mul_u32_u24 v12, 5462, v11
v_lshrrev_b32 v12, 16, v12
v_mul_u32_u24 v13, 12, v12
v_sub_u32 v13, v11, v13
v_bfe_u32 v14, v12, 2, 1
v_cmp_gt_u32 vcc, 8, v13
v_lshlrev_b32 v15, 1, v14
v_mul_u32_u24 v12, 7168, v12
v_cndmask_b32 v14, v14, v15, vcc
v_xor_b32 v13, v13, v14
v_lshl_add_u32 v8, v13, 4, v12
v_add_u32 v11, 64, v1
v_mul_u32_u24 v12, 5462, v11
v_lshrrev_b32 v12, 16, v12
v_mul_u32_u24 v13, 12, v12
v_sub_u32 v13, v11, v13
v_bfe_u32 v14, v12, 2, 1
v_cmp_gt_u32 vcc, 8, v13
v_lshlrev_b32 v15, 1, v14
v_mul_u32_u24 v12, 7168, v12
v_cndmask_b32 v14, v14, v15, vcc
v_xor_b32 v13, v13, v14
v_lshl_add_u32 v9, v13, 4, v12
v_add_u32 v11, 128, v1
v_mul_u32_u24 v12, 5462, v11
v_lshrrev_b32 v12, 16, v12
v_mul_u32_u24 v13, 12, v12
v_sub_u32 v13, v11, v13
v_bfe_u32 v14, v12, 2, 1
v_cmp_gt_u32 vcc, 8, v13
v_lshlrev_b32 v15, 1, v14
v_mul_u32_u24 v12, 7168, v12
v_cndmask_b32 v14, v14, v15, vcc
v_xor_b32 v13, v13, v14
v_lshl_add_u32 v10, v13, 4, v12
s_and_b32 s43, s36, 1
s_mul_i32 s43, s43, 229376
v_add_u32 v8, s43, v8
v_add_u32 v9, s43, v9
v_add_u32 v10, s43, v10
s_and_b32 s43, s36, 3
s_mul_i32 s46, s43, 6144
s_add_u32 s46, s46, 16384
s_barrier
s_mov_b32 s37, 0
s_mov_b32 m0, 2048
s_nop 0
buffer_load_dwordx4 v16, s[8:11], s37 offen sc1 lds
s_mov_b32 m0, 5120
s_nop 0
buffer_load_dwordx4 v17, s[8:11], s37 offen sc1 lds
s_mov_b32 m0, 8192
s_nop 0
buffer_load_dwordx4 v18, s[8:11], s37 offen sc1 lds
s_mov_b32 m0, 11264
s_nop 0
buffer_load_dwordx4 v19, s[8:11], s37 offen sc1 lds
s_mov_b32 m0, 14336
s_nop 0
buffer_load_dwordx4 v20, s[8:11], s37 offen sc1 lds
s_mov_b32 s37, 16384
s_mov_b32 m0, 51200
s_nop 0
buffer_load_dwordx4 v16, s[8:11], s37 offen sc1 lds
s_mov_b32 m0, 54272
s_nop 0
buffer_load_dwordx4 v17, s[8:11], s37 offen sc1 lds
s_mov_b32 m0, 57344
s_nop 0
buffer_load_dwordx4 v18, s[8:11], s37 offen sc1 lds
s_mov_b32 m0, 60416
s_nop 0
buffer_load_dwordx4 v19, s[8:11], s37 offen sc1 lds
s_mov_b32 m0, 63488
s_nop 0
buffer_load_dwordx4 v20, s[8:11], s37 offen sc1 lds
s_mov_b32 s37, 32768
s_mov_b32 m0, 100352
s_nop 0
buffer_load_dwordx4 v16, s[8:11], s37 offen sc1 lds
s_mov_b32 m0, 103424
s_nop 0
buffer_load_dwordx4 v17, s[8:11], s37 offen sc1 lds
s_mov_b32 m0, 106496
s_nop 0
buffer_load_dwordx4 v18, s[8:11], s37 offen sc1 lds
s_mov_b32 m0, 109568
s_nop 0
buffer_load_dwordx4 v19, s[8:11], s37 offen sc1 lds
s_mov_b32 m0, 112640
s_nop 0
buffer_load_dwordx4 v20, s[8:11], s37 offen sc1 lds
s_mov_b32 s37, 49152
s_mov_b32 m0, 149504
s_nop 0
buffer_load_dwordx4 v16, s[8:11], s37 offen sc1 lds
s_mov_b32 m0, 152576
s_nop 0
buffer_load_dwordx4 v17, s[8:11], s37 offen sc1 lds
s_mov_b32 m0, 155648
s_nop 0
buffer_load_dwordx4 v18, s[8:11], s37 offen sc1 lds
s_mov_b32 m0, 158720
s_nop 0
buffer_load_dwordx4 v19, s[8:11], s37 offen sc1 lds
s_mov_b32 m0, 161792
s_nop 0
buffer_load_dwordx4 v20, s[8:11], s37 offen sc1 lds
s_mov_b32 s37, 65536
s_mov_b32 s38, 524288
s_waitcnt vmcnt(15)
s_barrier
s_waitcnt vmcnt(10)
s_barrier
s_mov_b32 m0, 2048
s_nop 0
buffer_load_dwordx4 v16, s[8:11], s37 offen sc1 lds
s_mov_b32 m0, 5120
s_nop 0
buffer_load_dwordx4 v17, s[8:11], s37 offen sc1 lds
s_mov_b32 m0, 8192
s_nop 0
buffer_load_dwordx4 v18, s[8:11], s37 offen sc1 lds
s_mov_b32 m0, 11264
s_nop 0
buffer_load_dwordx4 v19, s[8:11], s37 offen sc1 lds
s_mov_b32 m0, 14336
s_nop 0
buffer_load_dwordx4 v20, s[8:11], s37 offen sc1 lds
s_mov_b32 m0, 115712
s_nop 0
buffer_load_dwordx4 v21, s[12:15], s38 offen lds
s_mov_b32 m0, 118784
s_nop 0
buffer_load_dwordx4 v22, s[12:15], s38 offen lds
s_mov_b32 m0, 121856
s_nop 0
buffer_load_dwordx4 v23, s[12:15], s38 offen lds
s_add_u32 s37, s37, 16384
s_add_u32 s38, s38, 131072
v_lshlrev_b32 v240, 16, v128
v_and_b32 v241, 0xffff0000, v128
v_lshlrev_b32 v242, 16, v129
v_and_b32 v243, 0xffff0000, v129
v_lshlrev_b32 v244, 16, v130
v_and_b32 v245, 0xffff0000, v130
v_lshlrev_b32 v246, 16, v131
v_and_b32 v247, 0xffff0000, v131
s_load_dword s3, s[4:5], 21632
s_load_dword s3, s[4:5], 21696
s_waitcnt vmcnt(13)
s_barrier
s_mov_b32 m0, 51200
s_nop 0
buffer_load_dwordx4 v16, s[8:11], s37 offen sc1 lds
s_mov_b32 m0, 54272
s_nop 0
buffer_load_dwordx4 v17, s[8:11], s37 offen sc1 lds
s_mov_b32 m0, 57344
s_nop 0
buffer_load_dwordx4 v18, s[8:11], s37 offen sc1 lds
s_mov_b32 m0, 60416
s_nop 0
buffer_load_dwordx4 v19, s[8:11], s37 offen sc1 lds
s_mov_b32 m0, 63488
s_nop 0
buffer_load_dwordx4 v20, s[8:11], s37 offen sc1 lds
s_mov_b32 m0, 123904
s_nop 0
buffer_load_dwordx4 v21, s[12:15], s38 offen lds
s_mov_b32 m0, 126976
s_nop 0
buffer_load_dwordx4 v22, s[12:15], s38 offen lds
s_mov_b32 m0, 130048
s_nop 0
buffer_load_dwordx4 v23, s[12:15], s38 offen lds
s_add_u32 s37, s37, 16384
s_add_u32 s38, s38, 131072
v_lshlrev_b32 v24, 16, v132
v_and_b32 v25, 0xffff0000, v132
v_lshlrev_b32 v26, 16, v133
v_and_b32 v27, 0xffff0000, v133
v_lshlrev_b32 v28, 16, v134
v_and_b32 v29, 0xffff0000, v134
v_lshlrev_b32 v30, 16, v135
v_and_b32 v31, 0xffff0000, v135
v_add_f32 v240, v240, v24
v_add_f32 v241, v241, v25
v_add_f32 v242, v242, v26
v_add_f32 v243, v243, v27
v_add_f32 v244, v244, v28
v_add_f32 v245, v245, v29
v_add_f32 v246, v246, v30
v_add_f32 v247, v247, v31
s_load_dword s3, s[4:5], 28672
s_load_dword s3, s[4:5], 28736
s_waitcnt vmcnt(16)
s_barrier
s_mov_b32 m0, 100352
s_nop 0
buffer_load_dwordx4 v16, s[8:11], s37 offen sc1 lds
s_mov_b32 m0, 103424
s_nop 0
buffer_load_dwordx4 v17, s[8:11], s37 offen sc1 lds
s_mov_b32 m0, 106496
s_nop 0
buffer_load_dwordx4 v18, s[8:11], s37 offen sc1 lds
s_mov_b32 m0, 109568
s_nop 0
buffer_load_dwordx4 v19, s[8:11], s37 offen sc1 lds
s_mov_b32 m0, 112640
s_nop 0
buffer_load_dwordx4 v20, s[8:11], s37 offen sc1 lds
s_mov_b32 m0, 132096
s_nop 0
buffer_load_dwordx4 v21, s[12:15], s38 offen lds
s_mov_b32 m0, 135168
s_nop 0
buffer_load_dwordx4 v22, s[12:15], s38 offen lds
s_mov_b32 m0, 138240
s_nop 0
buffer_load_dwordx4 v23, s[12:15], s38 offen lds
s_add_u32 s37, s37, 16384
s_add_u32 s38, s38, 131072
v_lshlrev_b32 v24, 16, v136
v_and_b32 v25, 0xffff0000, v136
v_lshlrev_b32 v26, 16, v137
v_and_b32 v27, 0xffff0000, v137
v_lshlrev_b32 v28, 16, v138
v_and_b32 v29, 0xffff0000, v138
v_lshlrev_b32 v30, 16, v139
v_and_b32 v31, 0xffff0000, v139
v_add_f32 v240, v240, v24
v_add_f32 v241, v241, v25
v_add_f32 v242, v242, v26
v_add_f32 v243, v243, v27
v_add_f32 v244, v244, v28
v_add_f32 v245, v245, v29
v_add_f32 v246, v246, v30
v_add_f32 v247, v247, v31
s_load_dword s3, s[4:5], 28800
s_load_dword s3, s[4:5], 28864
s_waitcnt vmcnt(16)
s_barrier
s_mov_b32 m0, 149504
s_nop 0
buffer_load_dwordx4 v16, s[8:11], s37 offen sc1 lds
s_mov_b32 m0, 152576
s_nop 0
buffer_load_dwordx4 v17, s[8:11], s37 offen sc1 lds
s_mov_b32 m0, 155648
s_nop 0
buffer_load_dwordx4 v18, s[8:11], s37 offen sc1 lds
s_mov_b32 m0, 158720
s_nop 0
buffer_load_dwordx4 v19, s[8:11], s37 offen sc1 lds
s_mov_b32 m0, 161792
s_nop 0
buffer_load_dwordx4 v20, s[8:11], s37 offen sc1 lds
s_mov_b32 m0, 140288
s_nop 0
buffer_load_dwordx4 v21, s[12:15], s38 offen lds
s_mov_b32 m0, 143360
s_nop 0
buffer_load_dwordx4 v22, s[12:15], s38 offen lds
s_mov_b32 m0, 146432
s_nop 0
buffer_load_dwordx4 v23, s[12:15], s38 offen lds
s_add_u32 s37, s37, 16384
s_add_u32 s38, s38, 131072
v_lshlrev_b32 v24, 16, v140
v_and_b32 v25, 0xffff0000, v140
v_lshlrev_b32 v26, 16, v141
v_and_b32 v27, 0xffff0000, v141
v_lshlrev_b32 v28, 16, v142
v_and_b32 v29, 0xffff0000, v142
v_lshlrev_b32 v30, 16, v143
v_and_b32 v31, 0xffff0000, v143
v_add_f32 v240, v240, v24
v_add_f32 v241, v241, v25
v_add_f32 v242, v242, v26
v_add_f32 v243, v243, v27
v_add_f32 v244, v244, v28
v_add_f32 v245, v245, v29
v_add_f32 v246, v246, v30
v_add_f32 v247, v247, v31
s_load_dword s3, s[4:5], 35840
s_load_dword s3, s[4:5], 35904
s_waitcnt vmcnt(16)
s_barrier
s_mov_b32 m0, 2048
s_nop 0
buffer_load_dwordx4 v16, s[8:11], s37 offen sc1 lds
s_mov_b32 m0, 5120
s_nop 0
buffer_load_dwordx4 v17, s[8:11], s37 offen sc1 lds
s_mov_b32 m0, 8192
s_nop 0
buffer_load_dwordx4 v18, s[8:11], s37 offen sc1 lds
s_mov_b32 m0, 11264
s_nop 0
buffer_load_dwordx4 v19, s[8:11], s37 offen sc1 lds
s_mov_b32 m0, 14336
s_nop 0
buffer_load_dwordx4 v20, s[8:11], s37 offen sc1 lds
s_mov_b32 m0, 115712
s_nop 0
buffer_load_dwordx4 v21, s[12:15], s38 offen lds
s_mov_b32 m0, 118784
s_nop 0
buffer_load_dwordx4 v22, s[12:15], s38 offen lds
s_mov_b32 m0, 121856
s_nop 0
buffer_load_dwordx4 v23, s[12:15], s38 offen lds
s_add_u32 s37, s37, 16384
s_add_u32 s38, s38, 131072
v_lshlrev_b32 v24, 16, v144
v_and_b32 v25, 0xffff0000, v144
v_lshlrev_b32 v26, 16, v145
v_and_b32 v27, 0xffff0000, v145
v_lshlrev_b32 v28, 16, v146
v_and_b32 v29, 0xffff0000, v146
v_lshlrev_b32 v30, 16, v147
v_and_b32 v31, 0xffff0000, v147
v_add_f32 v240, v240, v24
v_add_f32 v241, v241, v25
v_add_f32 v242, v242, v26
v_add_f32 v243, v243, v27
v_add_f32 v244, v244, v28
v_add_f32 v245, v245, v29
v_add_f32 v246, v246, v30
v_add_f32 v247, v247, v31
s_load_dword s3, s[4:5], 35968
s_load_dword s3, s[4:5], 36032
s_waitcnt vmcnt(16)
s_barrier
s_mov_b32 m0, 51200
s_nop 0
buffer_load_dwordx4 v16, s[8:11], s37 offen sc1 lds
s_mov_b32 m0, 54272
s_nop 0
buffer_load_dwordx4 v17, s[8:11], s37 offen sc1 lds
s_mov_b32 m0, 57344
s_nop 0
buffer_load_dwordx4 v18, s[8:11], s37 offen sc1 lds
s_mov_b32 m0, 60416
s_nop 0
buffer_load_dwordx4 v19, s[8:11], s37 offen sc1 lds
s_mov_b32 m0, 63488
s_nop 0
buffer_load_dwordx4 v20, s[8:11], s37 offen sc1 lds
s_mov_b32 m0, 123904
s_nop 0
buffer_load_dwordx4 v21, s[12:15], s38 offen lds
s_mov_b32 m0, 126976
s_nop 0
buffer_load_dwordx4 v22, s[12:15], s38 offen lds
s_mov_b32 m0, 130048
s_nop 0
buffer_load_dwordx4 v23, s[12:15], s38 offen lds
s_add_u32 s37, s37, 16384
s_add_u32 s38, s38, 131072
v_lshlrev_b32 v24, 16, v148
v_and_b32 v25, 0xffff0000, v148
v_lshlrev_b32 v26, 16, v149
v_and_b32 v27, 0xffff0000, v149
v_lshlrev_b32 v28, 16, v150
v_and_b32 v29, 0xffff0000, v150
v_lshlrev_b32 v30, 16, v151
v_and_b32 v31, 0xffff0000, v151
v_add_f32 v240, v240, v24
v_add_f32 v241, v241, v25
v_add_f32 v242, v242, v26
v_add_f32 v243, v243, v27
v_add_f32 v244, v244, v28
v_add_f32 v245, v245, v29
v_add_f32 v246, v246, v30
v_add_f32 v247, v247, v31
s_load_dword s3, s[4:5], 43008
s_load_dword s3, s[4:5], 43072
s_waitcnt vmcnt(16)
s_barrier
s_mov_b32 m0, 100352
s_nop 0
buffer_load_dwordx4 v16, s[8:11], s37 offen sc1 lds
s_mov_b32 m0, 103424
s_nop 0
buffer_load_dwordx4 v17, s[8:11], s37 offen sc1 lds
s_mov_b32 m0, 106496
s_nop 0
buffer_load_dwordx4 v18, s[8:11], s37 offen sc1 lds
s_mov_b32 m0, 109568
s_nop 0
buffer_load_dwordx4 v19, s[8:11], s37 offen sc1 lds
s_mov_b32 m0, 112640
s_nop 0
buffer_load_dwordx4 v20, s[8:11], s37 offen sc1 lds
s_mov_b32 m0, 132096
s_nop 0
buffer_load_dwordx4 v21, s[12:15], s38 offen lds
s_mov_b32 m0, 135168
s_nop 0
buffer_load_dwordx4 v22, s[12:15], s38 offen lds
s_mov_b32 m0, 138240
s_nop 0
buffer_load_dwordx4 v23, s[12:15], s38 offen lds
s_add_u32 s37, s37, 16384
s_add_u32 s38, s38, 131072
v_lshlrev_b32 v24, 16, v152
v_and_b32 v25, 0xffff0000, v152
v_lshlrev_b32 v26, 16, v153
v_and_b32 v27, 0xffff0000, v153
v_lshlrev_b32 v28, 16, v154
v_and_b32 v29, 0xffff0000, v154
v_lshlrev_b32 v30, 16, v155
v_and_b32 v31, 0xffff0000, v155
v_add_f32 v240, v240, v24
v_add_f32 v241, v241, v25
v_add_f32 v242, v242, v26
v_add_f32 v243, v243, v27
v_add_f32 v244, v244, v28
v_add_f32 v245, v245, v29
v_add_f32 v246, v246, v30
v_add_f32 v247, v247, v31
s_load_dword s3, s[4:5], 43136
s_load_dword s3, s[4:5], 43200
s_waitcnt vmcnt(16)
s_barrier
s_mov_b32 m0, 149504
s_nop 0
buffer_load_dwordx4 v16, s[8:11], s37 offen sc1 lds
s_mov_b32 m0, 152576
s_nop 0
buffer_load_dwordx4 v17, s[8:11], s37 offen sc1 lds
s_mov_b32 m0, 155648
s_nop 0
buffer_load_dwordx4 v18, s[8:11], s37 offen sc1 lds
s_mov_b32 m0, 158720
s_nop 0
buffer_load_dwordx4 v19, s[8:11], s37 offen sc1 lds
s_mov_b32 m0, 161792
s_nop 0
buffer_load_dwordx4 v20, s[8:11], s37 offen sc1 lds
s_mov_b32 m0, 140288
s_nop 0
buffer_load_dwordx4 v21, s[12:15], s38 offen lds
s_mov_b32 m0, 143360
s_nop 0
buffer_load_dwordx4 v22, s[12:15], s38 offen lds
s_mov_b32 m0, 146432
s_nop 0
buffer_load_dwordx4 v23, s[12:15], s38 offen lds
s_add_u32 s37, s37, 16384
s_add_u32 s38, s38, 131072
v_lshlrev_b32 v24, 16, v156
v_and_b32 v25, 0xffff0000, v156
v_lshlrev_b32 v26, 16, v157
v_and_b32 v27, 0xffff0000, v157
v_lshlrev_b32 v28, 16, v158
v_and_b32 v29, 0xffff0000, v158
v_lshlrev_b32 v30, 16, v159
v_and_b32 v31, 0xffff0000, v159
v_add_f32 v240, v240, v24
v_add_f32 v241, v241, v25
v_add_f32 v242, v242, v26
v_add_f32 v243, v243, v27
v_add_f32 v244, v244, v28
v_add_f32 v245, v245, v29
v_add_f32 v246, v246, v30
v_add_f32 v247, v247, v31
s_load_dword s3, s[4:5], 50176
s_load_dword s3, s[4:5], 50240
s_waitcnt vmcnt(16)
s_barrier
s_mov_b32 m0, 2048
s_nop 0
buffer_load_dwordx4 v16, s[8:11], s37 offen sc1 lds
s_mov_b32 m0, 5120
s_nop 0
buffer_load_dwordx4 v17, s[8:11], s37 offen sc1 lds
s_mov_b32 m0, 8192
s_nop 0
buffer_load_dwordx4 v18, s[8:11], s37 offen sc1 lds
s_mov_b32 m0, 11264
s_nop 0
buffer_load_dwordx4 v19, s[8:11], s37 offen sc1 lds
s_mov_b32 m0, 14336
s_nop 0
buffer_load_dwordx4 v20, s[8:11], s37 offen sc1 lds
s_mov_b32 m0, 115712
s_nop 0
buffer_load_dwordx4 v21, s[12:15], s38 offen lds
s_mov_b32 m0, 118784
s_nop 0
buffer_load_dwordx4 v22, s[12:15], s38 offen lds
s_mov_b32 m0, 121856
s_nop 0
buffer_load_dwordx4 v23, s[12:15], s38 offen lds
s_add_u32 s37, s37, 16384
s_add_u32 s38, s38, 131072
s_load_dword s3, s[4:5], 50304
s_load_dword s3, s[4:5], 50368
s_waitcnt vmcnt(16)
s_barrier
s_mov_b32 m0, 51200
s_nop 0
buffer_load_dwordx4 v16, s[8:11], s37 offen sc1 lds
s_mov_b32 m0, 54272
s_nop 0
buffer_load_dwordx4 v17, s[8:11], s37 offen sc1 lds
s_mov_b32 m0, 57344
s_nop 0
buffer_load_dwordx4 v18, s[8:11], s37 offen sc1 lds
s_branch Lov_8
.p2align 12
Lst_8_0:
s_branch Lst_12_0
s_nop 0
Lov_8:
s_mov_b32 m0, 60416
s_nop 0
buffer_load_dwordx4 v19, s[8:11], s37 offen sc1 lds
s_mov_b32 m0, 63488
s_nop 0
buffer_load_dwordx4 v20, s[8:11], s37 offen sc1 lds
s_mov_b32 m0, 123904
s_nop 0
buffer_load_dwordx4 v21, s[12:15], s38 offen lds
s_mov_b32 m0, 126976
s_nop 0
buffer_load_dwordx4 v22, s[12:15], s38 offen lds
s_mov_b32 m0, 130048
s_nop 0
buffer_load_dwordx4 v23, s[12:15], s38 offen lds
s_add_u32 s37, s37, 16384
s_add_u32 s38, s38, 131072
s_load_dword s3, s[4:5], 57344
s_load_dword s3, s[4:5], 57408
s_waitcnt vmcnt(16)
s_barrier
s_mov_b32 m0, 100352
s_nop 0
buffer_load_dwordx4 v16, s[8:11], s37 offen sc1 lds
s_mov_b32 m0, 103424
s_nop 0
buffer_load_dwordx4 v17, s[8:11], s37 offen sc1 lds
s_mov_b32 m0, 106496
s_nop 0
buffer_load_dwordx4 v18, s[8:11], s37 offen sc1 lds
s_mov_b32 m0, 109568
s_nop 0
buffer_load_dwordx4 v19, s[8:11], s37 offen sc1 lds
s_mov_b32 m0, 112640
s_nop 0
buffer_load_dwordx4 v20, s[8:11], s37 offen sc1 lds
s_mov_b32 m0, 132096
s_nop 0
buffer_load_dwordx4 v21, s[12:15], s38 offen lds
s_mov_b32 m0, 135168
s_nop 0
buffer_load_dwordx4 v22, s[12:15], s38 offen lds
s_mov_b32 m0, 138240
s_nop 0
buffer_load_dwordx4 v23, s[12:15], s38 offen lds
s_add_u32 s37, s37, 16384
s_add_u32 s38, s38, 131072
s_load_dword s3, s[4:5], 57472
s_load_dword s3, s[4:5], 57536
s_waitcnt vmcnt(16)
s_barrier
s_mov_b32 m0, 149504
s_nop 0
buffer_load_dwordx4 v16, s[8:11], s37 offen sc1 lds
s_mov_b32 m0, 152576
s_nop 0
buffer_load_dwordx4 v17, s[8:11], s37 offen sc1 lds
s_mov_b32 m0, 155648
s_nop 0
buffer_load_dwordx4 v18, s[8:11], s37 offen sc1 lds
s_mov_b32 m0, 158720
s_nop 0
buffer_load_dwordx4 v19, s[8:11], s37 offen sc1 lds
s_mov_b32 m0, 161792
s_nop 0
buffer_load_dwordx4 v20, s[8:11], s37 offen sc1 lds
s_mov_b32 m0, 140288
s_nop 0
buffer_load_dwordx4 v21, s[12:15], s38 offen lds
s_mov_b32 m0, 143360
s_nop 0
buffer_load_dwordx4 v22, s[12:15], s38 offen lds
s_mov_b32 m0, 146432
s_nop 0
buffer_load_dwordx4 v23, s[12:15], s38 offen lds
s_add_u32 s37, s37, 16384
s_add_u32 s38, s38, 131072
s_load_dword s3, s[4:5], 64512
s_load_dword s3, s[4:5], 64576
s_waitcnt vmcnt(16)
s_barrier
s_nop 0
v_permlane32_swap_b32 v240, v244
v_permlane32_swap_b32 v241, v245
v_permlane32_swap_b32 v242, v246
v_permlane32_swap_b32 v243, v247
v_add_f32 v240, v240, v244
v_add_f32 v241, v241, v245
v_add_f32 v242, v242, v246
v_add_f32 v243, v243, v247
s_nop 0
v_permlane16_swap_b32 v240, v242
v_permlane16_swap_b32 v241, v243
v_add_f32 v240, v240, v242
v_add_f32 v241, v241, v243
s_load_dword s3, s[4:5], 64640
s_load_dword s3, s[4:5], 64704
s_waitcnt vmcnt(8)
s_barrier
s_add_u32 m0, s46, 0
s_mov_b32 s38, 0
buffer_load_dwordx4 v8, s[88:91], s38 offen lds
s_add_u32 m0, s46, 1024
s_mov_b32 s38, 0
buffer_load_dwordx4 v9, s[88:91], s38 offen lds
s_add_u32 m0, s46, 2048
s_mov_b32 s38, 0
buffer_load_dwordx4 v10, s[88:91], s38 offen lds
s_add_u32 m0, s46, 3072
s_mov_b32 s38, 114688
buffer_load_dwordx4 v8, s[88:91], s38 offen lds
s_add_u32 m0, s46, 4096
s_mov_b32 s38, 114688
buffer_load_dwordx4 v9, s[88:91], s38 offen lds
s_add_u32 m0, s46, 5120
s_mov_b32 s38, 114688
buffer_load_dwordx4 v10, s[88:91], s38 offen lds
s_add_u32 m0, s46, 49152
s_mov_b32 s38, 458752
buffer_load_dwordx4 v8, s[88:91], s38 offen lds
s_add_u32 m0, s46, 50176
s_mov_b32 s38, 458752
buffer_load_dwordx4 v9, s[88:91], s38 offen lds
s_add_u32 m0, s46, 51200
s_mov_b32 s38, 458752
buffer_load_dwordx4 v10, s[88:91], s38 offen lds
s_add_u32 m0, s46, 52224
s_mov_b32 s38, 573440
buffer_load_dwordx4 v8, s[88:91], s38 offen lds
s_add_u32 m0, s46, 53248
s_mov_b32 s38, 573440
buffer_load_dwordx4 v9, s[88:91], s38 offen lds
s_add_u32 m0, s46, 54272
s_mov_b32 s38, 573440
buffer_load_dwordx4 v10, s[88:91], s38 offen lds
s_load_dword s3, s[4:5], 71680
s_load_dword s3, s[4:5], 71744
s_waitcnt vmcnt(12)
s_barrier
s_load_dword s3, s[4:5], 71808
s_load_dword s3, s[4:5], 71872
s_barrier
s_load_dword s3, s[4:5], 78848
s_load_dword s3, s[4:5], 78912
s_barrier
s_branch Lk2end_72
Lpf_74:
s_bitcmp0_b32 s36, 1
s_cselect_b32 s44, s72, s74
s_cselect_b32 s45, s73, s75
s_mul_i32 s43, s35, 192
s_add_u32 s88, s44, s43
s_addc_u32 s89, s45, 0
s_add_u32 s88, s88, 4096
s_addc_u32 s89, s89, 0
s_mov_b32 s90, 7333056
s_mov_b32 s91, 0x20000
v_add_u32 v11, 0, v1
v_mul_u32_u24 v12, 5462, v11
v_lshrrev_b32 v12, 16, v12
v_mul_u32_u24 v13, 12, v12
v_sub_u32 v13, v11, v13
v_bfe_u32 v14, v12, 2, 1
v_cmp_gt_u32 vcc, 8, v13
v_lshlrev_b32 v15, 1, v14
v_mul_u32_u24 v12, 7168, v12
v_cndmask_b32 v14, v14, v15, vcc
v_xor_b32 v13, v13, v14
v_lshl_add_u32 v8, v13, 4, v12
v_add_u32 v11, 64, v1
v_mul_u32_u24 v12, 5462, v11
v_lshrrev_b32 v12, 16, v12
v_mul_u32_u24 v13, 12, v12
v_sub_u32 v13, v11, v13
v_bfe_u32 v14, v12, 2, 1
v_cmp_gt_u32 vcc, 8, v13
v_lshlrev_b32 v15, 1, v14
v_mul_u32_u24 v12, 7168, v12
v_cndmask_b32 v14, v14, v15, vcc
v_xor_b32 v13, v13, v14
v_lshl_add_u32 v9, v13, 4, v12
v_add_u32 v11, 128, v1
v_mul_u32_u24 v12, 5462, v11
v_lshrrev_b32 v12, 16, v12
v_mul_u32_u24 v13, 12, v12
v_sub_u32 v13, v11, v13
v_bfe_u32 v14, v12, 2, 1
v_cmp_gt_u32 vcc, 8, v13
v_lshlrev_b32 v15, 1, v14
v_mul_u32_u24 v12, 7168, v12
v_cndmask_b32 v14, v14, v15, vcc
v_xor_b32 v13, v13, v14
v_lshl_add_u32 v10, v13, 4, v12
s_and_b32 s43, s36, 1
s_mul_i32 s43, s43, 229376
v_add_u32 v8, s43, v8
v_add_u32 v9, s43, v9
v_add_u32 v10, s43, v10
s_and_b32 s43, s36, 3
s_mul_i32 s46, s43, 6144
s_add_u32 s46, s46, 16384
s_lshl_b32 s92, s34, 7
s_add_u32 s92, s92, 28311552
s_mov_b32 s41, 0x40000
Lpoll_79:
s_load_dword s93, s[82:83], s92 glc
Lpchk_81:
s_waitcnt lgkmcnt(0)
s_cmp_eq_u32 s93, 16
s_cbranch_scc1 Lpok_80
s_sub_u32 s41, s41, 1
s_cmp_lg_u32 s41, 0
s_cbranch_scc1 Lpoll_79
Lpok_80:
s_and_b32 s44, s36, 3
s_mul_i32 s44, s44, 17
s_bfe_u32 s43, s2, 0x30001
s_lshl_b32 s43, s43, 7
s_add_u32 s44, s44, s43
s_add_u32 s44, s44, 60
s_mul_i32 s44, s44, 7168
s_lshr_b32 s43, s2, 4
s_lshl_b32 s43, s43, 8
s_add_u32 s43, s43, s44
s_bitcmp0_b32 s2, 0
s_cselect_b32 s4, s72, s74
s_cselect_b32 s5, s73, s75
s_add_u32 s4, s4, s43
s_addc_u32 s5, s5, 0
s_load_dword s3, s[4:5], 0
s_load_dword s3, s[4:5], 64
s_load_dword s3, s[4:5], 128
s_load_dword s3, s[4:5], 192
s_load_dword s3, s[4:5], 7168
s_load_dword s3, s[4:5], 7232
s_load_dword s3, s[4:5], 7296
s_load_dword s3, s[4:5], 7360
s_load_dword s3, s[4:5], 14336
s_load_dword s3, s[4:5], 14400
s_load_dword s3, s[4:5], 14464
s_load_dword s3, s[4:5], 14528
s_load_dword s3, s[4:5], 21504
s_load_dword s3, s[4:5], 21568
s_barrier
s_barrier
s_barrier
v_lshlrev_b32 v240, 16, v128
v_and_b32 v241, 0xffff0000, v128
v_lshlrev_b32 v242, 16, v129
v_and_b32 v243, 0xffff0000, v129
v_lshlrev_b32 v244, 16, v130
v_and_b32 v245, 0xffff0000, v130
v_lshlrev_b32 v246, 16, v131
v_and_b32 v247, 0xffff0000, v131
s_load_dword s3, s[4:5], 21632
s_load_dword s3, s[4:5], 21696
s_barrier
v_lshlrev_b32 v24, 16, v132
v_and_b32 v25, 0xffff0000, v132
v_lshlrev_b32 v26, 16, v133
v_and_b32 v27, 0xffff0000, v133
v_lshlrev_b32 v28, 16, v134
v_and_b32 v29, 0xffff0000, v134
v_lshlrev_b32 v30, 16, v135
v_and_b32 v31, 0xffff0000, v135
v_add_f32 v240, v240, v24
v_add_f32 v241, v241, v25
v_add_f32 v242, v242, v26
v_add_f32 v243, v243, v27
v_add_f32 v244, v244, v28
v_add_f32 v245, v245, v29
v_add_f32 v246, v246, v30
v_add_f32 v247, v247, v31
s_load_dword s3, s[4:5], 28672
s_load_dword s3, s[4:5], 28736
s_barrier
v_lshlrev_b32 v24, 16, v136
v_and_b32 v25, 0xffff0000, v136
v_lshlrev_b32 v26, 16, v137
v_and_b32 v27, 0xffff0000, v137
v_lshlrev_b32 v28, 16, v138
v_and_b32 v29, 0xffff0000, v138
v_lshlrev_b32 v30, 16, v139
v_and_b32 v31, 0xffff0000, v139
v_add_f32 v240, v240, v24
v_add_f32 v241, v241, v25
v_add_f32 v242, v242, v26
v_add_f32 v243, v243, v27
v_add_f32 v244, v244, v28
v_add_f32 v245, v245, v29
v_add_f32 v246, v246, v30
v_add_f32 v247, v247, v31
s_load_dword s3, s[4:5], 28800
s_load_dword s3, s[4:5], 28864
s_barrier
v_lshlrev_b32 v24, 16, v140
v_and_b32 v25, 0xffff0000, v140
v_lshlrev_b32 v26, 16, v141
v_and_b32 v27, 0xffff0000, v141
v_lshlrev_b32 v28, 16, v142
v_and_b32 v29, 0xffff0000, v142
v_lshlrev_b32 v30, 16, v143
v_and_b32 v31, 0xffff0000, v143
v_add_f32 v240, v240, v24
v_add_f32 v241, v241, v25
v_add_f32 v242, v242, v26
v_add_f32 v243, v243, v27
v_add_f32 v244, v244, v28
v_add_f32 v245, v245, v29
v_add_f32 v246, v246, v30
v_add_f32 v247, v247, v31
s_load_dword s3, s[4:5], 35840
s_load_dword s3, s[4:5], 35904
s_barrier
v_lshlrev_b32 v24, 16, v144
v_and_b32 v25, 0xffff0000, v144
v_lshlrev_b32 v26, 16, v145
v_and_b32 v27, 0xffff0000, v145
v_lshlrev_b32 v28, 16, v146
v_and_b32 v29, 0xffff0000, v146
v_lshlrev_b32 v30, 16, v147
v_and_b32 v31, 0xffff0000, v147
v_add_f32 v240, v240, v24
v_add_f32 v241, v241, v25
v_add_f32 v242, v242, v26
v_add_f32 v243, v243, v27
v_add_f32 v244, v244, v28
v_add_f32 v245, v245, v29
v_add_f32 v246, v246, v30
v_add_f32 v247, v247, v31
s_load_dword s3, s[4:5], 35968
s_load_dword s3, s[4:5], 36032
s_barrier
v_lshlrev_b32 v24, 16, v148
v_and_b32 v25, 0xffff0000, v148
v_lshlrev_b32 v26, 16, v149
v_and_b32 v27, 0xffff0000, v149
v_lshlrev_b32 v28, 16, v150
v_and_b32 v29, 0xffff0000, v150
v_lshlrev_b32 v30, 16, v151
v_and_b32 v31, 0xffff0000, v151
v_add_f32 v240, v240, v24
v_add_f32 v241, v241, v25
v_add_f32 v242, v242, v26
v_add_f32 v243, v243, v27
v_add_f32 v244, v244, v28
v_add_f32 v245, v245, v29
v_add_f32 v246, v246, v30
v_add_f32 v247, v247, v31
s_load_dword s3, s[4:5], 43008
s_load_dword s3, s[4:5], 43072
s_barrier
v_lshlrev_b32 v24, 16, v152
v_and_b32 v25, 0xffff0000, v152
v_lshlrev_b32 v26, 16, v153
v_and_b32 v27, 0xffff0000, v153
v_lshlrev_b32 v28, 16, v154
v_and_b32 v29, 0xffff0000, v154
v_lshlrev_b32 v30, 16, v155
v_and_b32 v31, 0xffff0000, v155
v_add_f32 v240, v240, v24
v_add_f32 v241, v241, v25
v_add_f32 v242, v242, v26
v_add_f32 v243, v243, v27
v_add_f32 v244, v244, v28
v_add_f32 v245, v245, v29
v_add_f32 v246, v246, v30
v_add_f32 v247, v247, v31
s_load_dword s3, s[4:5], 43136
s_load_dword s3, s[4:5], 43200
s_barrier
v_lshlrev_b32 v24, 16, v156
v_and_b32 v25, 0xffff0000, v156
v_lshlrev_b32 v26, 16, v157
v_and_b32 v27, 0xffff0000, v157
v_lshlrev_b32 v28, 16, v158
v_and_b32 v29, 0xffff0000, v158
v_lshlrev_b32 v30, 16, v159
v_and_b32 v31, 0xffff0000, v159
v_add_f32 v240, v240, v24
v_add_f32 v241, v241, v25
v_add_f32 v242, v242, v26
v_add_f32 v243, v243, v27
v_add_f32 v244, v244, v28
v_add_f32 v245, v245, v29
v_add_f32 v246, v246, v30
v_add_f32 v247, v247, v31
s_load_dword s3, s[4:5], 50176
s_load_dword s3, s[4:5], 50240
s_barrier
s_load_dword s3, s[4:5], 50304
s_load_dword s3, s[4:5], 50368
s_barrier
s_load_dword s3, s[4:5], 57344
s_load_dword s3, s[4:5], 57408
s_barrier
s_load_dword s3, s[4:5], 57472
s_load_dword s3, s[4:5], 57536
s_barrier
s_load_dword s3, s[4:5], 64512
s_load_dword s3, s[4:5], 64576
s_barrier
s_nop 0
v_permlane32_swap_b32 v240, v244
v_permlane32_swap_b32 v241, v245
v_permlane32_swap_b32 v242, v246
v_permlane32_swap_b32 v243, v247
v_add_f32 v240, v240, v244
v_add_f32 v241, v241, v245
v_add_f32 v242, v242, v246
v_add_f32 v243, v243, v247
s_nop 0
v_permlane16_swap_b32 v240, v242
v_permlane16_swap_b32 v241, v243
v_add_f32 v240, v240, v242
v_add_f32 v241, v241, v243
s_load_dword s3, s[4:5], 64640
s_load_dword s3, s[4:5], 64704
s_barrier
s_add_u32 m0, s46, 0
s_mov_b32 s38, 0
buffer_load_dwordx4 v8, s[88:91], s38 offen lds
s_add_u32 m0, s46, 1024
s_mov_b32 s38, 0
buffer_load_dwordx4 v9, s[88:91], s38 offen lds
s_add_u32 m0, s46, 2048
s_mov_b32 s38, 0
buffer_load_dwordx4 v10, s[88:91], s38 offen lds
s_add_u32 m0, s46, 3072
s_mov_b32 s38, 114688
buffer_load_dwordx4 v8, s[88:91], s38 offen lds
s_add_u32 m0, s46, 4096
s_mov_b32 s38, 114688
buffer_load_dwordx4 v9, s[88:91], s38 offen lds
s_add_u32 m0, s46, 5120
s_mov_b32 s38, 114688
buffer_load_dwordx4 v10, s[88:91], s38 offen lds
s_add_u32 m0, s46, 49152
s_mov_b32 s38, 458752
buffer_load_dwordx4 v8, s[88:91], s38 offen lds
s_add_u32 m0, s46, 50176
s_mov_b32 s38, 458752
buffer_load_dwordx4 v9, s[88:91], s38 offen lds
s_add_u32 m0, s46, 51200
s_mov_b32 s38, 458752
buffer_load_dwordx4 v10, s[88:91], s38 offen lds
s_add_u32 m0, s46, 52224
s_mov_b32 s38, 573440
buffer_load_dwordx4 v8, s[88:91], s38 offen lds
s_add_u32 m0, s46, 53248
s_mov_b32 s38, 573440
buffer_load_dwordx4 v9, s[88:91], s38 offen lds
s_add_u32 m0, s46, 54272
s_mov_b32 s38, 573440
buffer_load_dwordx4 v10, s[88:91], s38 offen lds
s_load_dword s3, s[4:5], 71680
s_load_dword s3, s[4:5], 71744
s_barrier
s_load_dword s3, s[4:5], 71808
s_load_dword s3, s[4:5], 71872
s_barrier
s_load_dword s3, s[4:5], 78848
s_load_dword s3, s[4:5], 78912
s_barrier
Lk2end_72:
Lk3:
s_mul_i32 s43, s34, 262144
s_add_u32 s8, s82, s43
s_addc_u32 s9, s83, 0
s_add_u32 s8, s8, 4194304
s_addc_u32 s9, s9, 0
s_mov_b32 s10, 262144
s_mov_b32 s11, 0x20000
s_mul_i32 s43, s34, 917504
s_add_u32 s24, s82, s43
s_addc_u32 s25, s83, 0
s_add_u32 s24, s24, 8388608
s_addc_u32 s25, s25, 0
s_mov_b32 s26, 917504
s_mov_b32 s27, 0x20000
s_add_u32 s84, s82, 27262976
s_addc_u32 s85, s83, 0
s_mov_b32 s86, 229376
s_mov_b32 s87, 0x20000
s_and_b32 s47, s36, 3
s_lshr_b32 s62, s47, 1
s_and_b32 s63, s47, 1
v_lshlrev_b32 v2, 4, v1
s_lshl_b32 s39, s47, 12
v_add_u32 v3, s39, v2
s_cmp_eq_u32 s62, 0
s_cselect_b32 s44, s72, s74
s_cselect_b32 s45, s73, s75
s_lshl_b32 s43, s35, 8
s_add_u32 s12, s44, s43
s_addc_u32 s13, s45, 0
s_mov_b32 s14, 7333120
s_mov_b32 s15, 0x20000
v_lshrrev_b32 v28, 4, v1
v_lshlrev_b32 v29, 1, v28
v_and_b32 v4, 15, v1
v_xor_b32 v4, v4, v29
v_lshlrev_b32 v4, 4, v4
v_mul_u32_u24 v28, 7168, v28
v_add_u32 v4, v4, v28
s_mul_i32 s43, s63, 229376
v_add_u32 v4, s43, v4
v_xor_b32 v5, 128, v4
v_add_u32 v5, 28672, v5
s_lshl_b32 s40, s47, 13
s_add_u32 s40, s40, 16384
s_lshl_b32 s43, s62, 12
v_add_u32 v9, s43, v2
v_add_u32 v10, 98304, v9
s_cmp_lt_u32 s36, 4
s_cbranch_scc1 Lgb_82
s_lshl_b32 s43, s47, 9
s_add_u32 s43, s43, 151552
v_and_b32 v28, 15, v1
v_lshl_add_u32 v28, v28, 5, s43
v_lshrrev_b32 v29, 4, v1
v_lshl_add_u32 v28, v29, 3, v28
ds_write_b64 v28, v[240:241]
s_waitcnt lgkmcnt(0)
v_lshrrev_b32 v27, 2, v1
v_bfe_u32 v28, v27, 2, 1
v_mul_u32_u24 v27, 192, v27
v_add_u32 v27, 16384, v27
v_and_b32 v29, 3, v1
v_lshl_add_u32 v12, v29, 3, v27
s_lshl_b32 s43, s63, 6
v_add_u32 v12, s43, v12
v_lshl_add_u32 v11, v28, 5, v12
v_xor_b32 v30, 1, v28
v_lshl_add_u32 v12, v30, 5, v12
v_xor_b32 v28, s63, v28
v_lshl_add_u32 v27, v28, 4, v27
v_lshrrev_b32 v28, 1, v29
v_lshl_add_u32 v27, v28, 5, v27
v_and_b32 v28, 1, v29
v_lshl_add_u32 v27, v28, 3, v27
v_add_u32 v13, 128, v27
v_add_u32 v14, 49152, v11
v_add_u32 v15, 49152, v12
v_add_u32 v16, 49152, v13
v_add_u32 v17, 98304, v11
v_add_u32 v18, 98304, v12
v_add_u32 v19, 98304, v13
v_bfe_u32 v28, v1, 3, 1
v_lshlrev_b32 v28, 6, v28
v_bfe_u32 v29, v1, 1, 2
s_lshl_b32 s43, s48, 3
s_lshl_b32 s44, s63, 2
s_add_u32 s43, s43, s44
v_add3_u32 v28, v28, v29, s43
v_mul_u32_u24 v28, 7168, v28
v_and_b32 v29, 1, v1
v_mul_u32_u24 v29, 188, v29
v_add_u32 v20, v28, v29
s_cmp_lg_u32 s36, 4
s_cbranch_scc1 Lwm_84
s_branch Lst_9_1
Lwr_129:
s_branch Lwe_83
Lwm_84:
s_cmp_lg_u32 s36, 5
s_cbranch_scc1 Lwm_85
s_branch Lst_10_1
Lwr_130:
s_branch Lwe_83
Lwm_85:
s_cmp_lg_u32 s36, 6
s_cbranch_scc1 Lwm_86
s_branch Lst_11_1
Lwr_131:
s_branch Lwe_83
Lwm_86:
s_cmp_lg_u32 s36, 7
s_cbranch_scc1 Lwm_87
s_branch Lst_12_1
Lwr_132:
s_branch Lwe_83
Lwm_87:
Lwe_83:
s_waitcnt vmcnt(0)
s_barrier
s_barrier
ds_read_b128 v[32:35], v9 offset:0
ds_read_b64_tr_b16 v[48:49], v11 offset:0
ds_read_b64_tr_b16 v[50:51], v11 offset:3072
ds_read_b64_tr_b16 v[52:53], v12 offset:0
ds_read_b64_tr_b16 v[54:55], v12 offset:3072
ds_read_b64_tr_b16 v[56:57], v13 offset:0
ds_read_b64_tr_b16 v[58:59], v13 offset:3072
ds_read_b64_tr_b16 v[60:61], v11 offset:12288
ds_read_b64_tr_b16 v[62:63], v11 offset:15360
ds_read_b64_tr_b16 v[64:65], v12 offset:12288
ds_read_b64_tr_b16 v[66:67], v12 offset:15360
ds_read_b64_tr_b16 v[68:69], v13 offset:12288
ds_read_b64_tr_b16 v[70:71], v13 offset:15360
ds_read_b128 v[36:39], v9 offset:1024
ds_read_b128 v[40:43], v9 offset:2048
ds_read_b128 v[44:47], v9 offset:3072
s_waitcnt lgkmcnt(0)
v_mfma_f32_16x16x32_bf16 v[128:131], v[48:51], v[32:35], 0
ds_read_b128 v[72:75], v9 offset:8192
v_mfma_f32_16x16x32_bf16 v[132:135], v[52:55], v[32:35], 0
ds_read_b64_tr_b16 v[88:89], v11 offset:6144
v_mfma_f32_16x16x32_bf16 v[136:139], v[56:59], v[32:35], 0
ds_read_b64_tr_b16 v[90:91], v11 offset:9216
v_mfma_f32_16x16x32_bf16 v[140:143], v[60:63], v[32:35], 0
ds_read_b64_tr_b16 v[92:93], v12 offset:6144
v_mfma_f32_16x16x32_bf16 v[144:147], v[64:67], v[32:35], 0
ds_read_b64_tr_b16 v[94:95], v12 offset:9216
v_mfma_f32_16x16x32_bf16 v[148:151], v[68:71], v[32:35], 0
ds_read_b64_tr_b16 v[96:97], v13 offset:6144
v_mfma_f32_16x16x32_bf16 v[172:175], v[68:71], v[36:39], 0
ds_read_b64_tr_b16 v[98:99], v13 offset:9216
v_mfma_f32_16x16x32_bf16 v[168:171], v[64:67], v[36:39], 0
ds_read_b64_tr_b16 v[100:101], v11 offset:18432
v_mfma_f32_16x16x32_bf16 v[164:167], v[60:63], v[36:39], 0
ds_read_b64_tr_b16 v[102:103], v11 offset:21504
v_mfma_f32_16x16x32_bf16 v[160:163], v[56:59], v[36:39], 0
ds_read_b64_tr_b16 v[104:105], v12 offset:18432
v_mfma_f32_16x16x32_bf16 v[156:159], v[52:55], v[36:39], 0
ds_read_b64_tr_b16 v[106:107], v12 offset:21504
v_mfma_f32_16x16x32_bf16 v[152:155], v[48:51], v[36:39], 0
ds_read_b64_tr_b16 v[108:109], v13 offset:18432
v_mfma_f32_16x16x32_bf16 v[176:179], v[48:51], v[40:43], 0
ds_read_b64_tr_b16 v[110:111], v13 offset:21504
v_mfma_f32_16x16x32_bf16 v[180:183], v[52:55], v[40:43], 0
ds_read_b128 v[76:79], v9 offset:9216
v_mfma_f32_16x16x32_bf16 v[184:187], v[56:59], v[40:43], 0
ds_read_b128 v[80:83], v9 offset:10240
v_mfma_f32_16x16x32_bf16 v[188:191], v[60:63], v[40:43], 0
ds_read_b128 v[84:87], v9 offset:11264
v_mfma_f32_16x16x32_bf16 v[192:195], v[64:67], v[40:43], 0
v_mfma_f32_16x16x32_bf16 v[196:199], v[68:71], v[40:43], 0
v_mfma_f32_16x16x32_bf16 v[220:223], v[68:71], v[44:47], 0
v_mfma_f32_16x16x32_bf16 v[216:219], v[64:67], v[44:47], 0
v_mfma_f32_16x16x32_bf16 v[212:215], v[60:63], v[44:47], 0
v_mfma_f32_16x16x32_bf16 v[208:211], v[56:59], v[44:47], 0
v_mfma_f32_16x16x32_bf16 v[204:207], v[52:55], v[44:47], 0
v_mfma_f32_16x16x32_bf16 v[200:203], v[48:51], v[44:47], 0
s_waitcnt lgkmcnt(0)
s_barrier
v_mfma_f32_16x16x32_bf16 v[128:131], v[88:91], v[72:75], v[128:131]
ds_read_b128 v[32:35], v9 offset:49152
v_mfma_f32_16x16x32_bf16 v[132:135], v[92:95], v[72:75], v[132:135]
ds_read_b64_tr_b16 v[48:49], v14 offset:0
v_mfma_f32_16x16x32_bf16 v[136:139], v[96:99], v[72:75], v[136:139]
ds_read_b64_tr_b16 v[50:51], v14 offset:3072
v_mfma_f32_16x16x32_bf16 v[140:143], v[100:103], v[72:75], v[140:143]
ds_read_b64_tr_b16 v[52:53], v15 offset:0
v_mfma_f32_16x16x32_bf16 v[144:147], v[104:107], v[72:75], v[144:147]
ds_read_b64_tr_b16 v[54:55], v15 offset:3072
v_mfma_f32_16x16x32_bf16 v[148:151], v[108:111], v[72:75], v[148:151]
ds_read_b64_tr_b16 v[56:57], v16 offset:0
v_mfma_f32_16x16x32_bf16 v[172:175], v[108:111], v[76:79], v[172:175]
ds_read_b64_tr_b16 v[58:59], v16 offset:3072
v_mfma_f32_16x16x32_bf16 v[168:171], v[104:107], v[76:79], v[168:171]
ds_read_b64_tr_b16 v[60:61], v14 offset:12288
v_mfma_f32_16x16x32_bf16 v[164:167], v[100:103], v[76:79], v[164:167]
ds_read_b64_tr_b16 v[62:63], v14 offset:15360
v_mfma_f32_16x16x32_bf16 v[160:163], v[96:99], v[76:79], v[160:163]
ds_read_b64_tr_b16 v[64:65], v15 offset:12288
v_mfma_f32_16x16x32_bf16 v[156:159], v[92:95], v[76:79], v[156:159]
ds_read_b64_tr_b16 v[66:67], v15 offset:15360
v_mfma_f32_16x16x32_bf16 v[152:155], v[88:91], v[76:79], v[152:155]
ds_read_b64_tr_b16 v[68:69], v16 offset:12288
v_mfma_f32_16x16x32_bf16 v[176:179], v[88:91], v[80:83], v[176:179]
ds_read_b64_tr_b16 v[70:71], v16 offset:15360
v_mfma_f32_16x16x32_bf16 v[180:183], v[92:95], v[80:83], v[180:183]
ds_read_b128 v[36:39], v9 offset:50176
v_mfma_f32_16x16x32_bf16 v[184:187], v[96:99], v[80:83], v[184:187]
ds_read_b128 v[40:43], v9 offset:51200
s_branch Lov_9
.p2align 12
Lst_9_0:
s_branch Lst_13_0
Lst_9_1:
s_branch Lst_13_1
Lov_9:
v_mfma_f32_16x16x32_bf16 v[188:191], v[100:103], v[80:83], v[188:191]
ds_read_b128 v[44:47], v9 offset:52224
v_mfma_f32_16x16x32_bf16 v[192:195], v[104:107], v[80:83], v[192:195]
v_mfma_f32_16x16x32_bf16 v[196:199], v[108:111], v[80:83], v[196:199]
v_mfma_f32_16x16x32_bf16 v[220:223], v[108:111], v[84:87], v[220:223]
v_mfma_f32_16x16x32_bf16 v[216:219], v[104:107], v[84:87], v[216:219]
v_mfma_f32_16x16x32_bf16 v[212:215], v[100:103], v[84:87], v[212:215]
v_mfma_f32_16x16x32_bf16 v[208:211], v[96:99], v[84:87], v[208:211]
v_mfma_f32_16x16x32_bf16 v[204:207], v[92:95], v[84:87], v[204:207]
v_mfma_f32_16x16x32_bf16 v[200:203], v[88:91], v[84:87], v[200:203]
s_mov_b32 s41, 4
Lk3l_88:
s_waitcnt lgkmcnt(0)
v_mfma_f32_16x16x32_bf16 v[128:131], v[48:51], v[32:35], v[128:131]
ds_read_b128 v[72:75], v9 offset:57344
v_mfma_f32_16x16x32_bf16 v[132:135], v[52:55], v[32:35], v[132:135]
ds_read_b64_tr_b16 v[88:89], v14 offset:6144
v_mfma_f32_16x16x32_bf16 v[136:139], v[56:59], v[32:35], v[136:139]
ds_read_b64_tr_b16 v[90:91], v14 offset:9216
v_mfma_f32_16x16x32_bf16 v[140:143], v[60:63], v[32:35], v[140:143]
ds_read_b64_tr_b16 v[92:93], v15 offset:6144
v_mfma_f32_16x16x32_bf16 v[144:147], v[64:67], v[32:35], v[144:147]
ds_read_b64_tr_b16 v[94:95], v15 offset:9216
v_mfma_f32_16x16x32_bf16 v[148:151], v[68:71], v[32:35], v[148:151]
ds_read_b64_tr_b16 v[96:97], v16 offset:6144
v_mfma_f32_16x16x32_bf16 v[172:175], v[68:71], v[36:39], v[172:175]
ds_read_b64_tr_b16 v[98:99], v16 offset:9216
v_mfma_f32_16x16x32_bf16 v[168:171], v[64:67], v[36:39], v[168:171]
ds_read_b64_tr_b16 v[100:101], v14 offset:18432
v_mfma_f32_16x16x32_bf16 v[164:167], v[60:63], v[36:39], v[164:167]
ds_read_b64_tr_b16 v[102:103], v14 offset:21504
v_mfma_f32_16x16x32_bf16 v[160:163], v[56:59], v[36:39], v[160:163]
ds_read_b64_tr_b16 v[104:105], v15 offset:18432
v_mfma_f32_16x16x32_bf16 v[156:159], v[52:55], v[36:39], v[156:159]
ds_read_b64_tr_b16 v[106:107], v15 offset:21504
v_mfma_f32_16x16x32_bf16 v[152:155], v[48:51], v[36:39], v[152:155]
ds_read_b64_tr_b16 v[108:109], v16 offset:18432
v_mfma_f32_16x16x32_bf16 v[176:179], v[48:51], v[40:43], v[176:179]
ds_read_b64_tr_b16 v[110:111], v16 offset:21504
v_mfma_f32_16x16x32_bf16 v[180:183], v[52:55], v[40:43], v[180:183]
ds_read_b128 v[76:79], v9 offset:58368
v_mfma_f32_16x16x32_bf16 v[184:187], v[56:59], v[40:43], v[184:187]
ds_read_b128 v[80:83], v9 offset:59392
v_mfma_f32_16x16x32_bf16 v[188:191], v[60:63], v[40:43], v[188:191]
ds_read_b128 v[84:87], v9 offset:60416
v_mfma_f32_16x16x32_bf16 v[192:195], v[64:67], v[40:43], v[192:195]
v_mfma_f32_16x16x32_bf16 v[196:199], v[68:71], v[40:43], v[196:199]
v_mfma_f32_16x16x32_bf16 v[220:223], v[68:71], v[44:47], v[220:223]
v_mfma_f32_16x16x32_bf16 v[216:219], v[64:67], v[44:47], v[216:219]
v_mfma_f32_16x16x32_bf16 v[212:215], v[60:63], v[44:47], v[212:215]
v_mfma_f32_16x16x32_bf16 v[208:211], v[56:59], v[44:47], v[208:211]
v_mfma_f32_16x16x32_bf16 v[204:207], v[52:55], v[44:47], v[204:207]
v_mfma_f32_16x16x32_bf16 v[200:203], v[48:51], v[44:47], v[200:203]
s_waitcnt lgkmcnt(0)
s_barrier
v_mfma_f32_16x16x32_bf16 v[128:131], v[88:91], v[72:75], v[128:131]
ds_read_b128 v[32:35], v10 offset:0
v_mfma_f32_16x16x32_bf16 v[132:135], v[92:95], v[72:75], v[132:135]
ds_read_b64_tr_b16 v[48:49], v17 offset:0
v_mfma_f32_16x16x32_bf16 v[136:139], v[96:99], v[72:75], v[136:139]
ds_read_b64_tr_b16 v[50:51], v17 offset:3072
v_mfma_f32_16x16x32_bf16 v[140:143], v[100:103], v[72:75], v[140:143]
ds_read_b64_tr_b16 v[52:53], v18 offset:0
v_mfma_f32_16x16x32_bf16 v[144:147], v[104:107], v[72:75], v[144:147]
ds_read_b64_tr_b16 v[54:55], v18 offset:3072
v_mfma_f32_16x16x32_bf16 v[148:151], v[108:111], v[72:75], v[148:151]
ds_read_b64_tr_b16 v[56:57], v19 offset:0
v_mfma_f32_16x16x32_bf16 v[172:175], v[108:111], v[76:79], v[172:175]
ds_read_b64_tr_b16 v[58:59], v19 offset:3072
v_mfma_f32_16x16x32_bf16 v[168:171], v[104:107], v[76:79], v[168:171]
ds_read_b64_tr_b16 v[60:61], v17 offset:12288
v_mfma_f32_16x16x32_bf16 v[164:167], v[100:103], v[76:79], v[164:167]
ds_read_b64_tr_b16 v[62:63], v17 offset:15360
v_mfma_f32_16x16x32_bf16 v[160:163], v[96:99], v[76:79], v[160:163]
ds_read_b64_tr_b16 v[64:65], v18 offset:12288
v_mfma_f32_16x16x32_bf16 v[156:159], v[92:95], v[76:79], v[156:159]
ds_read_b64_tr_b16 v[66:67], v18 offset:15360
v_mfma_f32_16x16x32_bf16 v[152:155], v[88:91], v[76:79], v[152:155]
ds_read_b64_tr_b16 v[68:69], v19 offset:12288
v_mfma_f32_16x16x32_bf16 v[176:179], v[88:91], v[80:83], v[176:179]
ds_read_b64_tr_b16 v[70:71], v19 offset:15360
v_mfma_f32_16x16x32_bf16 v[180:183], v[92:95], v[80:83], v[180:183]
ds_read_b128 v[36:39], v10 offset:1024
v_mfma_f32_16x16x32_bf16 v[184:187], v[96:99], v[80:83], v[184:187]
ds_read_b128 v[40:43], v10 offset:2048
v_mfma_f32_16x16x32_bf16 v[188:191], v[100:103], v[80:83], v[188:191]
ds_read_b128 v[44:47], v10 offset:3072
v_mfma_f32_16x16x32_bf16 v[192:195], v[104:107], v[80:83], v[192:195]
v_mfma_f32_16x16x32_bf16 v[196:199], v[108:111], v[80:83], v[196:199]
v_mfma_f32_16x16x32_bf16 v[220:223], v[108:111], v[84:87], v[220:223]
v_mfma_f32_16x16x32_bf16 v[216:219], v[104:107], v[84:87], v[216:219]
v_mfma_f32_16x16x32_bf16 v[212:215], v[100:103], v[84:87], v[212:215]
v_mfma_f32_16x16x32_bf16 v[208:211], v[96:99], v[84:87], v[208:211]
v_mfma_f32_16x16x32_bf16 v[204:207], v[92:95], v[84:87], v[204:207]
v_mfma_f32_16x16x32_bf16 v[200:203], v[88:91], v[84:87], v[200:203]
s_waitcnt lgkmcnt(0)
v_mfma_f32_16x16x32_bf16 v[128:131], v[48:51], v[32:35], v[128:131]
ds_read_b128 v[72:75], v10 offset:8192
v_mfma_f32_16x16x32_bf16 v[132:135], v[52:55], v[32:35], v[132:135]
ds_read_b64_tr_b16 v[88:89], v17 offset:6144
v_mfma_f32_16x16x32_bf16 v[136:139], v[56:59], v[32:35], v[136:139]
ds_read_b64_tr_b16 v[90:91], v17 offset:9216
v_mfma_f32_16x16x32_bf16 v[140:143], v[60:63], v[32:35], v[140:143]
ds_read_b64_tr_b16 v[92:93], v18 offset:6144
v_mfma_f32_16x16x32_bf16 v[144:147], v[64:67], v[32:35], v[144:147]
ds_read_b64_tr_b16 v[94:95], v18 offset:9216
v_mfma_f32_16x16x32_bf16 v[148:151], v[68:71], v[32:35], v[148:151]
ds_read_b64_tr_b16 v[96:97], v19 offset:6144
v_mfma_f32_16x16x32_bf16 v[172:175], v[68:71], v[36:39], v[172:175]
ds_read_b64_tr_b16 v[98:99], v19 offset:9216
v_mfma_f32_16x16x32_bf16 v[168:171], v[64:67], v[36:39], v[168:171]
ds_read_b64_tr_b16 v[100:101], v17 offset:18432
v_mfma_f32_16x16x32_bf16 v[164:167], v[60:63], v[36:39], v[164:167]
ds_read_b64_tr_b16 v[102:103], v17 offset:21504
v_mfma_f32_16x16x32_bf16 v[160:163], v[56:59], v[36:39], v[160:163]
ds_read_b64_tr_b16 v[104:105], v18 offset:18432
v_mfma_f32_16x16x32_bf16 v[156:159], v[52:55], v[36:39], v[156:159]
ds_read_b64_tr_b16 v[106:107], v18 offset:21504
v_mfma_f32_16x16x32_bf16 v[152:155], v[48:51], v[36:39], v[152:155]
ds_read_b64_tr_b16 v[108:109], v19 offset:18432
v_mfma_f32_16x16x32_bf16 v[176:179], v[48:51], v[40:43], v[176:179]
ds_read_b64_tr_b16 v[110:111], v19 offset:21504
v_mfma_f32_16x16x32_bf16 v[180:183], v[52:55], v[40:43], v[180:183]
ds_read_b128 v[76:79], v10 offset:9216
v_mfma_f32_16x16x32_bf16 v[184:187], v[56:59], v[40:43], v[184:187]
ds_read_b128 v[80:83], v10 offset:10240
v_mfma_f32_16x16x32_bf16 v[188:191], v[60:63], v[40:43], v[188:191]
ds_read_b128 v[84:87], v10 offset:11264
v_mfma_f32_16x16x32_bf16 v[192:195], v[64:67], v[40:43], v[192:195]
v_mfma_f32_16x16x32_bf16 v[196:199], v[68:71], v[40:43], v[196:199]
v_mfma_f32_16x16x32_bf16 v[220:223], v[68:71], v[44:47], v[220:223]
v_mfma_f32_16x16x32_bf16 v[216:219], v[64:67], v[44:47], v[216:219]
v_mfma_f32_16x16x32_bf16 v[212:215], v[60:63], v[44:47], v[212:215]
v_mfma_f32_16x16x32_bf16 v[208:211], v[56:59], v[44:47], v[208:211]
v_mfma_f32_16x16x32_bf16 v[204:207], v[52:55], v[44:47], v[204:207]
v_mfma_f32_16x16x32_bf16 v[200:203], v[48:51], v[44:47], v[200:203]
s_waitcnt lgkmcnt(0)
s_barrier
v_mfma_f32_16x16x32_bf16 v[128:131], v[88:91], v[72:75], v[128:131]
ds_read_b128 v[32:35], v9 offset:0
v_mfma_f32_16x16x32_bf16 v[132:135], v[92:95], v[72:75], v[132:135]
ds_read_b64_tr_b16 v[48:49], v11 offset:0
v_mfma_f32_16x16x32_bf16 v[136:139], v[96:99], v[72:75], v[136:139]
ds_read_b64_tr_b16 v[50:51], v11 offset:3072
v_mfma_f32_16x16x32_bf16 v[140:143], v[100:103], v[72:75], v[140:143]
ds_read_b64_tr_b16 v[52:53], v12 offset:0
v_mfma_f32_16x16x32_bf16 v[144:147], v[104:107], v[72:75], v[144:147]
ds_read_b64_tr_b16 v[54:55], v12 offset:3072
v_mfma_f32_16x16x32_bf16 v[148:151], v[108:111], v[72:75], v[148:151]
ds_read_b64_tr_b16 v[56:57], v13 offset:0
v_mfma_f32_16x16x32_bf16 v[172:175], v[108:111], v[76:79], v[172:175]
ds_read_b64_tr_b16 v[58:59], v13 offset:3072
v_mfma_f32_16x16x32_bf16 v[168:171], v[104:107], v[76:79], v[168:171]
ds_read_b64_tr_b16 v[60:61], v11 offset:12288
v_mfma_f32_16x16x32_bf16 v[164:167], v[100:103], v[76:79], v[164:167]
ds_read_b64_tr_b16 v[62:63], v11 offset:15360
v_mfma_f32_16x16x32_bf16 v[160:163], v[96:99], v[76:79], v[160:163]
ds_read_b64_tr_b16 v[64:65], v12 offset:12288
v_mfma_f32_16x16x32_bf16 v[156:159], v[92:95], v[76:79], v[156:159]
ds_read_b64_tr_b16 v[66:67], v12 offset:15360
v_mfma_f32_16x16x32_bf16 v[152:155], v[88:91], v[76:79], v[152:155]
ds_read_b64_tr_b16 v[68:69], v13 offset:12288
v_mfma_f32_16x16x32_bf16 v[176:179], v[88:91], v[80:83], v[176:179]
ds_read_b64_tr_b16 v[70:71], v13 offset:15360
v_mfma_f32_16x16x32_bf16 v[180:183], v[92:95], v[80:83], v[180:183]
ds_read_b128 v[36:39], v9 offset:1024
v_mfma_f32_16x16x32_bf16 v[184:187], v[96:99], v[80:83], v[184:187]
ds_read_b128 v[40:43], v9 offset:2048
v_mfma_f32_16x16x32_bf16 v[188:191], v[100:103], v[80:83], v[188:191]
ds_read_b128 v[44:47], v9 offset:3072
v_mfma_f32_16x16x32_bf16 v[192:195], v[104:107], v[80:83], v[192:195]
v_mfma_f32_16x16x32_bf16 v[196:199], v[108:111], v[80:83], v[196:199]
v_mfma_f32_16x16x32_bf16 v[220:223], v[108:111], v[84:87], v[220:223]
v_mfma_f32_16x16x32_bf16 v[216:219], v[104:107], v[84:87], v[216:219]
v_mfma_f32_16x16x32_bf16 v[212:215], v[100:103], v[84:87], v[212:215]
v_mfma_f32_16x16x32_bf16 v[208:211], v[96:99], v[84:87], v[208:211]
v_mfma_f32_16x16x32_bf16 v[204:207], v[92:95], v[84:87], v[204:207]
v_mfma_f32_16x16x32_bf16 v[200:203], v[88:91], v[84:87], v[200:203]
s_waitcnt lgkmcnt(0)
v_mfma_f32_16x16x32_bf16 v[128:131], v[48:51], v[32:35], v[128:131]
ds_read_b128 v[72:75], v9 offset:8192
v_mfma_f32_16x16x32_bf16 v[132:135], v[52:55], v[32:35], v[132:135]
ds_read_b64_tr_b16 v[88:89], v11 offset:6144
v_mfma_f32_16x16x32_bf16 v[136:139], v[56:59], v[32:35], v[136:139]
ds_read_b64_tr_b16 v[90:91], v11 offset:9216
v_mfma_f32_16x16x32_bf16 v[140:143], v[60:63], v[32:35], v[140:143]
ds_read_b64_tr_b16 v[92:93], v12 offset:6144
v_mfma_f32_16x16x32_bf16 v[144:147], v[64:67], v[32:35], v[144:147]
ds_read_b64_tr_b16 v[94:95], v12 offset:9216
v_mfma_f32_16x16x32_bf16 v[148:151], v[68:71], v[32:35], v[148:151]
ds_read_b64_tr_b16 v[96:97], v13 offset:6144
v_mfma_f32_16x16x32_bf16 v[172:175], v[68:71], v[36:39], v[172:175]
ds_read_b64_tr_b16 v[98:99], v13 offset:9216
v_mfma_f32_16x16x32_bf16 v[168:171], v[64:67], v[36:39], v[168:171]
ds_read_b64_tr_b16 v[100:101], v11 offset:18432
v_mfma_f32_16x16x32_bf16 v[164:167], v[60:63], v[36:39], v[164:167]
ds_read_b64_tr_b16 v[102:103], v11 offset:21504
v_mfma_f32_16x16x32_bf16 v[160:163], v[56:59], v[36:39], v[160:163]
ds_read_b64_tr_b16 v[104:105], v12 offset:18432
v_mfma_f32_16x16x32_bf16 v[156:159], v[52:55], v[36:39], v[156:159]
ds_read_b64_tr_b16 v[106:107], v12 offset:21504
v_mfma_f32_16x16x32_bf16 v[152:155], v[48:51], v[36:39], v[152:155]
ds_read_b64_tr_b16 v[108:109], v13 offset:18432
v_mfma_f32_16x16x32_bf16 v[176:179], v[48:51], v[40:43], v[176:179]
ds_read_b64_tr_b16 v[110:111], v13 offset:21504
v_mfma_f32_16x16x32_bf16 v[180:183], v[52:55], v[40:43], v[180:183]
ds_read_b128 v[76:79], v9 offset:9216
v_mfma_f32_16x16x32_bf16 v[184:187], v[56:59], v[40:43], v[184:187]
ds_read_b128 v[80:83], v9 offset:10240
v_mfma_f32_16x16x32_bf16 v[188:191], v[60:63], v[40:43], v[188:191]
ds_read_b128 v[84:87], v9 offset:11264
v_mfma_f32_16x16x32_bf16 v[192:195], v[64:67], v[40:43], v[192:195]
v_mfma_f32_16x16x32_bf16 v[196:199], v[68:71], v[40:43], v[196:199]
v_mfma_f32_16x16x32_bf16 v[220:223], v[68:71], v[44:47], v[220:223]
v_mfma_f32_16x16x32_bf16 v[216:219], v[64:67], v[44:47], v[216:219]
v_mfma_f32_16x16x32_bf16 v[212:215], v[60:63], v[44:47], v[212:215]
v_mfma_f32_16x16x32_bf16 v[208:211], v[56:59], v[44:47], v[208:211]
v_mfma_f32_16x16x32_bf16 v[204:207], v[52:55], v[44:47], v[204:207]
v_mfma_f32_16x16x32_bf16 v[200:203], v[48:51], v[44:47], v[200:203]
s_waitcnt lgkmcnt(0)
s_barrier
v_mfma_f32_16x16x32_bf16 v[128:131], v[88:91], v[72:75], v[128:131]
ds_read_b128 v[32:35], v9 offset:49152
v_mfma_f32_16x16x32_bf16 v[132:135], v[92:95], v[72:75], v[132:135]
ds_read_b64_tr_b16 v[48:49], v14 offset:0
v_mfma_f32_16x16x32_bf16 v[136:139], v[96:99], v[72:75], v[136:139]
ds_read_b64_tr_b16 v[50:51], v14 offset:3072
v_mfma_f32_16x16x32_bf16 v[140:143], v[100:103], v[72:75], v[140:143]
ds_read_b64_tr_b16 v[52:53], v15 offset:0
v_mfma_f32_16x16x32_bf16 v[144:147], v[104:107], v[72:75], v[144:147]
ds_read_b64_tr_b16 v[54:55], v15 offset:3072
v_mfma_f32_16x16x32_bf16 v[148:151], v[108:111], v[72:75], v[148:151]
ds_read_b64_tr_b16 v[56:57], v16 offset:0
v_mfma_f32_16x16x32_bf16 v[172:175], v[108:111], v[76:79], v[172:175]
ds_read_b64_tr_b16 v[58:59], v16 offset:3072
v_mfma_f32_16x16x32_bf16 v[168:171], v[104:107], v[76:79], v[168:171]
ds_read_b64_tr_b16 v[60:61], v14 offset:12288
v_mfma_f32_16x16x32_bf16 v[164:167], v[100:103], v[76:79], v[164:167]
ds_read_b64_tr_b16 v[62:63], v14 offset:15360
v_mfma_f32_16x16x32_bf16 v[160:163], v[96:99], v[76:79], v[160:163]
ds_read_b64_tr_b16 v[64:65], v15 offset:12288
v_mfma_f32_16x16x32_bf16 v[156:159], v[92:95], v[76:79], v[156:159]
ds_read_b64_tr_b16 v[66:67], v15 offset:15360
v_mfma_f32_16x16x32_bf16 v[152:155], v[88:91], v[76:79], v[152:155]
ds_read_b64_tr_b16 v[68:69], v16 offset:12288
v_mfma_f32_16x16x32_bf16 v[176:179], v[88:91], v[80:83], v[176:179]
ds_read_b64_tr_b16 v[70:71], v16 offset:15360
v_mfma_f32_16x16x32_bf16 v[180:183], v[92:95], v[80:83], v[180:183]
ds_read_b128 v[36:39], v9 offset:50176
v_mfma_f32_16x16x32_bf16 v[184:187], v[96:99], v[80:83], v[184:187]
ds_read_b128 v[40:43], v9 offset:51200
v_mfma_f32_16x16x32_bf16 v[188:191], v[100:103], v[80:83], v[188:191]
ds_read_b128 v[44:47], v9 offset:52224
v_mfma_f32_16x16x32_bf16 v[192:195], v[104:107], v[80:83], v[192:195]
v_mfma_f32_16x16x32_bf16 v[196:199], v[108:111], v[80:83], v[196:199]
v_mfma_f32_16x16x32_bf16 v[220:223], v[108:111], v[84:87], v[220:223]
v_mfma_f32_16x16x32_bf16 v[216:219], v[104:107], v[84:87], v[216:219]
v_mfma_f32_16x16x32_bf16 v[212:215], v[100:103], v[84:87], v[212:215]
v_mfma_f32_16x16x32_bf16 v[208:211], v[96:99], v[84:87], v[208:211]
v_mfma_f32_16x16x32_bf16 v[204:207], v[92:95], v[84:87], v[204:207]
v_mfma_f32_16x16x32_bf16 v[200:203], v[88:91], v[84:87], v[200:203]
s_sub_u32 s41, s41, 1
s_cmp_lg_u32 s41, 0
s_cbranch_scc1 Lk3l_88
s_waitcnt lgkmcnt(0)
v_mfma_f32_16x16x32_bf16 v[128:131], v[48:51], v[32:35], v[128:131]
ds_read_b128 v[72:75], v9 offset:57344
v_mfma_f32_16x16x32_bf16 v[132:135], v[52:55], v[32:35], v[132:135]
ds_read_b64_tr_b16 v[88:89], v14 offset:6144
v_mfma_f32_16x16x32_bf16 v[136:139], v[56:59], v[32:35], v[136:139]
ds_read_b64_tr_b16 v[90:91], v14 offset:9216
v_mfma_f32_16x16x32_bf16 v[140:143], v[60:63], v[32:35], v[140:143]
ds_read_b64_tr_b16 v[92:93], v15 offset:6144
v_mfma_f32_16x16x32_bf16 v[144:147], v[64:67], v[32:35], v[144:147]
ds_read_b64_tr_b16 v[94:95], v15 offset:9216
v_mfma_f32_16x16x32_bf16 v[148:151], v[68:71], v[32:35], v[148:151]
ds_read_b64_tr_b16 v[96:97], v16 offset:6144
v_mfma_f32_16x16x32_bf16 v[172:175], v[68:71], v[36:39], v[172:175]
ds_read_b64_tr_b16 v[98:99], v16 offset:9216
v_mfma_f32_16x16x32_bf16 v[168:171], v[64:67], v[36:39], v[168:171]
ds_read_b64_tr_b16 v[100:101], v14 offset:18432
v_mfma_f32_16x16x32_bf16 v[164:167], v[60:63], v[36:39], v[164:167]
ds_read_b64_tr_b16 v[102:103], v14 offset:21504
v_mfma_f32_16x16x32_bf16 v[160:163], v[56:59], v[36:39], v[160:163]
ds_read_b64_tr_b16 v[104:105], v15 offset:18432
v_mfma_f32_16x16x32_bf16 v[156:159], v[52:55], v[36:39], v[156:159]
ds_read_b64_tr_b16 v[106:107], v15 offset:21504
v_mfma_f32_16x16x32_bf16 v[152:155], v[48:51], v[36:39], v[152:155]
ds_read_b64_tr_b16 v[108:109], v16 offset:18432
v_mfma_f32_16x16x32_bf16 v[176:179], v[48:51], v[40:43], v[176:179]
ds_read_b64_tr_b16 v[110:111], v16 offset:21504
v_mfma_f32_16x16x32_bf16 v[180:183], v[52:55], v[40:43], v[180:183]
ds_read_b128 v[76:79], v9 offset:58368
v_mfma_f32_16x16x32_bf16 v[184:187], v[56:59], v[40:43], v[184:187]
ds_read_b128 v[80:83], v9 offset:59392
v_mfma_f32_16x16x32_bf16 v[188:191], v[60:63], v[40:43], v[188:191]
ds_read_b128 v[84:87], v9 offset:60416
v_mfma_f32_16x16x32_bf16 v[192:195], v[64:67], v[40:43], v[192:195]
v_mfma_f32_16x16x32_bf16 v[196:199], v[68:71], v[40:43], v[196:199]
v_mfma_f32_16x16x32_bf16 v[220:223], v[68:71], v[44:47], v[220:223]
v_mfma_f32_16x16x32_bf16 v[216:219], v[64:67], v[44:47], v[216:219]
v_mfma_f32_16x16x32_bf16 v[212:215], v[60:63], v[44:47], v[212:215]
v_mfma_f32_16x16x32_bf16 v[208:211], v[56:59], v[44:47], v[208:211]
v_mfma_f32_16x16x32_bf16 v[204:207], v[52:55], v[44:47], v[204:207]
v_mfma_f32_16x16x32_bf16 v[200:203], v[48:51], v[44:47], v[200:203]
s_waitcnt lgkmcnt(0)
s_barrier
v_mfma_f32_16x16x32_bf16 v[128:131], v[88:91], v[72:75], v[128:131]
ds_read_b128 v[32:35], v10 offset:0
v_mfma_f32_16x16x32_bf16 v[132:135], v[92:95], v[72:75], v[132:135]
ds_read_b64_tr_b16 v[48:49], v17 offset:0
v_mfma_f32_16x16x32_bf16 v[136:139], v[96:99], v[72:75], v[136:139]
ds_read_b64_tr_b16 v[50:51], v17 offset:3072
v_mfma_f32_16x16x32_bf16 v[140:143], v[100:103], v[72:75], v[140:143]
ds_read_b64_tr_b16 v[52:53], v18 offset:0
v_mfma_f32_16x16x32_bf16 v[144:147], v[104:107], v[72:75], v[144:147]
ds_read_b64_tr_b16 v[54:55], v18 offset:3072
v_mfma_f32_16x16x32_bf16 v[148:151], v[108:111], v[72:75], v[148:151]
ds_read_b64_tr_b16 v[56:57], v19 offset:0
v_mfma_f32_16x16x32_bf16 v[172:175], v[108:111], v[76:79], v[172:175]
ds_read_b64_tr_b16 v[58:59], v19 offset:3072
v_mfma_f32_16x16x32_bf16 v[168:171], v[104:107], v[76:79], v[168:171]
ds_read_b64_tr_b16 v[60:61], v17 offset:12288
v_mfma_f32_16x16x32_bf16 v[164:167], v[100:103], v[76:79], v[164:167]
ds_read_b64_tr_b16 v[62:63], v17 offset:15360
v_mfma_f32_16x16x32_bf16 v[160:163], v[96:99], v[76:79], v[160:163]
ds_read_b64_tr_b16 v[64:65], v18 offset:12288
v_mfma_f32_16x16x32_bf16 v[156:159], v[92:95], v[76:79], v[156:159]
ds_read_b64_tr_b16 v[66:67], v18 offset:15360
v_mfma_f32_16x16x32_bf16 v[152:155], v[88:91], v[76:79], v[152:155]
ds_read_b64_tr_b16 v[68:69], v19 offset:12288
v_mfma_f32_16x16x32_bf16 v[176:179], v[88:91], v[80:83], v[176:179]
ds_read_b64_tr_b16 v[70:71], v19 offset:15360
v_mfma_f32_16x16x32_bf16 v[180:183], v[92:95], v[80:83], v[180:183]
ds_read_b128 v[36:39], v10 offset:1024
v_mfma_f32_16x16x32_bf16 v[184:187], v[96:99], v[80:83], v[184:187]
ds_read_b128 v[40:43], v10 offset:2048
v_mfma_f32_16x16x32_bf16 v[188:191], v[100:103], v[80:83], v[188:191]
ds_read_b128 v[44:47], v10 offset:3072
v_mfma_f32_16x16x32_bf16 v[192:195], v[104:107], v[80:83], v[192:195]
v_mfma_f32_16x16x32_bf16 v[196:199], v[108:111], v[80:83], v[196:199]
v_mfma_f32_16x16x32_bf16 v[220:223], v[108:111], v[84:87], v[220:223]
v_mfma_f32_16x16x32_bf16 v[216:219], v[104:107], v[84:87], v[216:219]
v_mfma_f32_16x16x32_bf16 v[212:215], v[100:103], v[84:87], v[212:215]
v_mfma_f32_16x16x32_bf16 v[208:211], v[96:99], v[84:87], v[208:211]
v_mfma_f32_16x16x32_bf16 v[204:207], v[92:95], v[84:87], v[204:207]
v_mfma_f32_16x16x32_bf16 v[200:203], v[88:91], v[84:87], v[200:203]
s_waitcnt lgkmcnt(0)
v_mfma_f32_16x16x32_bf16 v[128:131], v[48:51], v[32:35], v[128:131]
ds_read_b128 v[72:75], v10 offset:8192
v_mfma_f32_16x16x32_bf16 v[132:135], v[52:55], v[32:35], v[132:135]
ds_read_b64_tr_b16 v[88:89], v17 offset:6144
v_mfma_f32_16x16x32_bf16 v[136:139], v[56:59], v[32:35], v[136:139]
ds_read_b64_tr_b16 v[90:91], v17 offset:9216
v_mfma_f32_16x16x32_bf16 v[140:143], v[60:63], v[32:35], v[140:143]
ds_read_b64_tr_b16 v[92:93], v18 offset:6144
v_mfma_f32_16x16x32_bf16 v[144:147], v[64:67], v[32:35], v[144:147]
ds_read_b64_tr_b16 v[94:95], v18 offset:9216
v_mfma_f32_16x16x32_bf16 v[148:151], v[68:71], v[32:35], v[148:151]
ds_read_b64_tr_b16 v[96:97], v19 offset:6144
v_mfma_f32_16x16x32_bf16 v[172:175], v[68:71], v[36:39], v[172:175]
ds_read_b64_tr_b16 v[98:99], v19 offset:9216
v_mfma_f32_16x16x32_bf16 v[168:171], v[64:67], v[36:39], v[168:171]
ds_read_b64_tr_b16 v[100:101], v17 offset:18432
v_mfma_f32_16x16x32_bf16 v[164:167], v[60:63], v[36:39], v[164:167]
ds_read_b64_tr_b16 v[102:103], v17 offset:21504
v_mfma_f32_16x16x32_bf16 v[160:163], v[56:59], v[36:39], v[160:163]
ds_read_b64_tr_b16 v[104:105], v18 offset:18432
v_mfma_f32_16x16x32_bf16 v[156:159], v[52:55], v[36:39], v[156:159]
ds_read_b64_tr_b16 v[106:107], v18 offset:21504
v_mfma_f32_16x16x32_bf16 v[152:155], v[48:51], v[36:39], v[152:155]
ds_read_b64_tr_b16 v[108:109], v19 offset:18432
v_mfma_f32_16x16x32_bf16 v[176:179], v[48:51], v[40:43], v[176:179]
ds_read_b64_tr_b16 v[110:111], v19 offset:21504
v_mfma_f32_16x16x32_bf16 v[180:183], v[52:55], v[40:43], v[180:183]
ds_read_b128 v[76:79], v10 offset:9216
v_mfma_f32_16x16x32_bf16 v[184:187], v[56:59], v[40:43], v[184:187]
ds_read_b128 v[80:83], v10 offset:10240
v_mfma_f32_16x16x32_bf16 v[188:191], v[60:63], v[40:43], v[188:191]
ds_read_b128 v[84:87], v10 offset:11264
v_mfma_f32_16x16x32_bf16 v[192:195], v[64:67], v[40:43], v[192:195]
v_mfma_f32_16x16x32_bf16 v[196:199], v[68:71], v[40:43], v[196:199]
v_mfma_f32_16x16x32_bf16 v[220:223], v[68:71], v[44:47], v[220:223]
v_mfma_f32_16x16x32_bf16 v[216:219], v[64:67], v[44:47], v[216:219]
v_mfma_f32_16x16x32_bf16 v[212:215], v[60:63], v[44:47], v[212:215]
v_mfma_f32_16x16x32_bf16 v[208:211], v[56:59], v[44:47], v[208:211]
v_mfma_f32_16x16x32_bf16 v[204:207], v[52:55], v[44:47], v[204:207]
v_mfma_f32_16x16x32_bf16 v[200:203], v[48:51], v[44:47], v[200:203]
s_waitcnt lgkmcnt(0)
s_barrier
v_mfma_f32_16x16x32_bf16 v[128:131], v[88:91], v[72:75], v[128:131]
ds_read_b128 v[32:35], v9 offset:0
v_mfma_f32_16x16x32_bf16 v[132:135], v[92:95], v[72:75], v[132:135]
ds_read_b64_tr_b16 v[48:49], v11 offset:0
v_mfma_f32_16x16x32_bf16 v[136:139], v[96:99], v[72:75], v[136:139]
ds_read_b64_tr_b16 v[50:51], v11 offset:3072
v_mfma_f32_16x16x32_bf16 v[140:143], v[100:103], v[72:75], v[140:143]
ds_read_b64_tr_b16 v[52:53], v12 offset:0
v_mfma_f32_16x16x32_bf16 v[144:147], v[104:107], v[72:75], v[144:147]
ds_read_b64_tr_b16 v[54:55], v12 offset:3072
v_mfma_f32_16x16x32_bf16 v[148:151], v[108:111], v[72:75], v[148:151]
ds_read_b64_tr_b16 v[56:57], v13 offset:0
v_mfma_f32_16x16x32_bf16 v[172:175], v[108:111], v[76:79], v[172:175]
ds_read_b64_tr_b16 v[58:59], v13 offset:3072
v_mfma_f32_16x16x32_bf16 v[168:171], v[104:107], v[76:79], v[168:171]
ds_read_b64_tr_b16 v[60:61], v11 offset:12288
v_mfma_f32_16x16x32_bf16 v[164:167], v[100:103], v[76:79], v[164:167]
ds_read_b64_tr_b16 v[62:63], v11 offset:15360
v_mfma_f32_16x16x32_bf16 v[160:163], v[96:99], v[76:79], v[160:163]
ds_read_b64_tr_b16 v[64:65], v12 offset:12288
v_mfma_f32_16x16x32_bf16 v[156:159], v[92:95], v[76:79], v[156:159]
ds_read_b64_tr_b16 v[66:67], v12 offset:15360
v_mfma_f32_16x16x32_bf16 v[152:155], v[88:91], v[76:79], v[152:155]
ds_read_b64_tr_b16 v[68:69], v13 offset:12288
v_mfma_f32_16x16x32_bf16 v[176:179], v[88:91], v[80:83], v[176:179]
ds_read_b64_tr_b16 v[70:71], v13 offset:15360
v_mfma_f32_16x16x32_bf16 v[180:183], v[92:95], v[80:83], v[180:183]
ds_read_b128 v[36:39], v9 offset:1024
v_mfma_f32_16x16x32_bf16 v[184:187], v[96:99], v[80:83], v[184:187]
ds_read_b128 v[40:43], v9 offset:2048
v_mfma_f32_16x16x32_bf16 v[188:191], v[100:103], v[80:83], v[188:191]
ds_read_b128 v[44:47], v9 offset:3072
v_mfma_f32_16x16x32_bf16 v[192:195], v[104:107], v[80:83], v[192:195]
v_mfma_f32_16x16x32_bf16 v[196:199], v[108:111], v[80:83], v[196:199]
v_mfma_f32_16x16x32_bf16 v[220:223], v[108:111], v[84:87], v[220:223]
v_mfma_f32_16x16x32_bf16 v[216:219], v[104:107], v[84:87], v[216:219]
v_mfma_f32_16x16x32_bf16 v[212:215], v[100:103], v[84:87], v[212:215]
v_mfma_f32_16x16x32_bf16 v[208:211], v[96:99], v[84:87], v[208:211]
v_mfma_f32_16x16x32_bf16 v[204:207], v[92:95], v[84:87], v[204:207]
v_mfma_f32_16x16x32_bf16 v[200:203], v[88:91], v[84:87], v[200:203]
s_waitcnt lgkmcnt(0)
v_mfma_f32_16x16x32_bf16 v[128:131], v[48:51], v[32:35], v[128:131]
ds_read_b128 v[72:75], v9 offset:8192
v_mfma_f32_16x16x32_bf16 v[132:135], v[52:55], v[32:35], v[132:135]
ds_read_b64_tr_b16 v[88:89], v11 offset:6144
v_mfma_f32_16x16x32_bf16 v[136:139], v[56:59], v[32:35], v[136:139]
ds_read_b64_tr_b16 v[90:91], v11 offset:9216
v_mfma_f32_16x16x32_bf16 v[140:143], v[60:63], v[32:35], v[140:143]
ds_read_b64_tr_b16 v[92:93], v12 offset:6144
v_mfma_f32_16x16x32_bf16 v[144:147], v[64:67], v[32:35], v[144:147]
ds_read_b64_tr_b16 v[94:95], v12 offset:9216
v_mfma_f32_16x16x32_bf16 v[148:151], v[68:71], v[32:35], v[148:151]
ds_read_b64_tr_b16 v[96:97], v13 offset:6144
v_mfma_f32_16x16x32_bf16 v[172:175], v[68:71], v[36:39], v[172:175]
ds_read_b64_tr_b16 v[98:99], v13 offset:9216
v_mfma_f32_16x16x32_bf16 v[168:171], v[64:67], v[36:39], v[168:171]
ds_read_b64_tr_b16 v[100:101], v11 offset:18432
v_mfma_f32_16x16x32_bf16 v[164:167], v[60:63], v[36:39], v[164:167]
ds_read_b64_tr_b16 v[102:103], v11 offset:21504
v_mfma_f32_16x16x32_bf16 v[160:163], v[56:59], v[36:39], v[160:163]
ds_read_b64_tr_b16 v[104:105], v12 offset:18432
v_mfma_f32_16x16x32_bf16 v[156:159], v[52:55], v[36:39], v[156:159]
ds_read_b64_tr_b16 v[106:107], v12 offset:21504
v_mfma_f32_16x16x32_bf16 v[152:155], v[48:51], v[36:39], v[152:155]
ds_read_b64_tr_b16 v[108:109], v13 offset:18432
v_mfma_f32_16x16x32_bf16 v[176:179], v[48:51], v[40:43], v[176:179]
ds_read_b64_tr_b16 v[110:111], v13 offset:21504
v_mfma_f32_16x16x32_bf16 v[180:183], v[52:55], v[40:43], v[180:183]
ds_read_b128 v[76:79], v9 offset:9216
v_mfma_f32_16x16x32_bf16 v[184:187], v[56:59], v[40:43], v[184:187]
ds_read_b128 v[80:83], v9 offset:10240
v_mfma_f32_16x16x32_bf16 v[188:191], v[60:63], v[40:43], v[188:191]
ds_read_b128 v[84:87], v9 offset:11264
v_mfma_f32_16x16x32_bf16 v[192:195], v[64:67], v[40:43], v[192:195]
v_mfma_f32_16x16x32_bf16 v[196:199], v[68:71], v[40:43], v[196:199]
v_mfma_f32_16x16x32_bf16 v[220:223], v[68:71], v[44:47], v[220:223]
v_mfma_f32_16x16x32_bf16 v[216:219], v[64:67], v[44:47], v[216:219]
v_mfma_f32_16x16x32_bf16 v[212:215], v[60:63], v[44:47], v[212:215]
v_mfma_f32_16x16x32_bf16 v[208:211], v[56:59], v[44:47], v[208:211]
v_mfma_f32_16x16x32_bf16 v[204:207], v[52:55], v[44:47], v[204:207]
v_mfma_f32_16x16x32_bf16 v[200:203], v[48:51], v[44:47], v[200:203]
s_waitcnt lgkmcnt(0)
s_barrier
v_mfma_f32_16x16x32_bf16 v[128:131], v[88:91], v[72:75], v[128:131]
v_mfma_f32_16x16x32_bf16 v[132:135], v[92:95], v[72:75], v[132:135]
v_mfma_f32_16x16x32_bf16 v[136:139], v[96:99], v[72:75], v[136:139]
v_mfma_f32_16x16x32_bf16 v[140:143], v[100:103], v[72:75], v[140:143]
v_mfma_f32_16x16x32_bf16 v[144:147], v[104:107], v[72:75], v[144:147]
v_mfma_f32_16x16x32_bf16 v[148:151], v[108:111], v[72:75], v[148:151]
v_mfma_f32_16x16x32_bf16 v[172:175], v[108:111], v[76:79], v[172:175]
v_mfma_f32_16x16x32_bf16 v[168:171], v[104:107], v[76:79], v[168:171]
v_mfma_f32_16x16x32_bf16 v[164:167], v[100:103], v[76:79], v[164:167]
v_mfma_f32_16x16x32_bf16 v[160:163], v[96:99], v[76:79], v[160:163]
v_mfma_f32_16x16x32_bf16 v[156:159], v[92:95], v[76:79], v[156:159]
v_mfma_f32_16x16x32_bf16 v[152:155], v[88:91], v[76:79], v[152:155]
v_mfma_f32_16x16x32_bf16 v[176:179], v[88:91], v[80:83], v[176:179]
v_mfma_f32_16x16x32_bf16 v[180:183], v[92:95], v[80:83], v[180:183]
v_mfma_f32_16x16x32_bf16 v[184:187], v[96:99], v[80:83], v[184:187]
v_mfma_f32_16x16x32_bf16 v[188:191], v[100:103], v[80:83], v[188:191]
v_mfma_f32_16x16x32_bf16 v[192:195], v[104:107], v[80:83], v[192:195]
v_mfma_f32_16x16x32_bf16 v[196:199], v[108:111], v[80:83], v[196:199]
v_mfma_f32_16x16x32_bf16 v[220:223], v[108:111], v[84:87], v[220:223]
v_mfma_f32_16x16x32_bf16 v[216:219], v[104:107], v[84:87], v[216:219]
v_mfma_f32_16x16x32_bf16 v[212:215], v[100:103], v[84:87], v[212:215]
v_mfma_f32_16x16x32_bf16 v[208:211], v[96:99], v[84:87], v[208:211]
v_mfma_f32_16x16x32_bf16 v[204:207], v[92:95], v[84:87], v[204:207]
v_mfma_f32_16x16x32_bf16 v[200:203], v[88:91], v[84:87], v[200:203]
s_mov_b32 s28, s76
s_mov_b32 s29, s77
s_mov_b32 s30, 7340032
s_mov_b32 s31, 0x20000
s_add_u32 m0, s39, 0
s_mov_b32 s37, 32768
buffer_load_dwordx4 v3, s[8:11], s37 offen sc1 lds
v_lshrrev_b32 v86, 4, v1
s_lshl_b32 s43, s63, 7
s_add_u32 s43, s43, 148992
buffer_load_dwordx4 v3, s[8:11], s37 offen offset:1024 sc1 lds
v_lshl_add_u32 v87, v86, 4, s43
v_lshrrev_b32 v88, 1, v86
v_and_b32 v86, 1, v86
s_lshl_b32 s43, s63, 5
buffer_load_dwordx4 v3, s[8:11], s37 offen offset:2048 sc1 lds
s_add_u32 s43, s43, 149248
v_lshl_add_u32 v88, v88, 6, s43
v_lshl_add_u32 v88, v86, 4, v88
v_and_b32 v86, 15, v1
buffer_load_dwordx4 v3, s[8:11], s37 offen offset:3072 sc1 lds
s_lshl_b32 s43, s62, 9
s_add_u32 s43, s43, 147456
v_lshl_add_u32 v86, v86, 3, s43
s_add_u32 m0, s40, 0
s_mov_b32 s38, 917504
buffer_load_dwordx4 v4, s[12:15], s38 offen lds
ds_read_b128 v[32:35], v87 offset:0
ds_read_b128 v[36:39], v87 offset:64
ds_read_b128 v[40:43], v88 offset:0
ds_read_b128 v[44:47], v87 offset:896
s_branch Lov_10
.p2align 12
Lst_10_0:
s_branch Lst_14_0
Lst_10_1:
s_branch Lst_14_1
Lov_10:
s_add_u32 m0, s40, 1024
s_mov_b32 s38, 917504
buffer_load_dwordx4 v5, s[12:15], s38 offen lds
ds_read_b128 v[48:51], v87 offset:960
ds_read_b128 v[52:55], v88 offset:896
ds_read_b64 v[56:57], v86 offset:0
ds_read_b64 v[58:59], v86 offset:128
s_add_u32 m0, s40, 2048
s_mov_b32 s38, 974848
buffer_load_dwordx4 v4, s[12:15], s38 offen lds
ds_read_b64 v[60:61], v86 offset:256
ds_read_b64 v[62:63], v86 offset:384
s_mul_i32 s54, s35, 24576
s_add_u32 m0, s40, 3072
s_mov_b32 s38, 974848
buffer_load_dwordx4 v5, s[12:15], s38 offen lds
s_lshl_b32 s43, s62, 12
s_add_u32 s54, s54, s43
s_add_u32 s54, s54, 524288
s_lshl_b32 s43, s63, 9
s_add_u32 m0, s40, 4096
s_mov_b32 s38, 1032192
buffer_load_dwordx4 v4, s[12:15], s38 offen lds
s_add_u32 s55, s54, s43
s_add_u32 s55, s55, 16384
s_lshl_b32 s43, s63, 13
s_add_u32 s54, s54, s43
s_add_u32 m0, s40, 5120
s_mov_b32 s38, 1032192
buffer_load_dwordx4 v5, s[12:15], s38 offen lds
v_and_b32 v84, 32, v1
v_lshlrev_b32 v84, 4, v84
v_add_u32 v84, v84, v2
s_waitcnt lgkmcnt(0)
s_add_u32 m0, s40, 6144
s_mov_b32 s38, 1089536
buffer_load_dwordx4 v4, s[12:15], s38 offen lds
s_add_u32 m0, s40, 7168
s_mov_b32 s38, 1089536
buffer_load_dwordx4 v5, s[12:15], s38 offen lds
s_and_b32 s44, s36, 3
s_mul_i32 s43, s2, 28672
s_mul_i32 s44, s44, 7168
s_add_u32 s43, s43, s44
s_add_u32 s4, s76, s43
s_addc_u32 s5, s77, 0
s_barrier
s_cmp_eq_u32 s47, 3
s_cbranch_scc0 Lw_89
v_and_b32 v30, 31, v1
v_lshlrev_b32 v30, 4, v30
v_add_u32 v31, 153600, v30
ds_read_b128 v[108:111], v31 offset:0
ds_read_b128 v[112:115], v31 offset:512
ds_read_b128 v[116:119], v31 offset:1024
ds_read_b128 v[120:123], v31 offset:1536
s_and_b32 s44, s2, 15
s_mul_i32 s44, s44, 14336
s_lshr_b32 s43, s2, 4
s_lshl_b32 s43, s43, 9
s_add_u32 s44, s44, s43
s_waitcnt lgkmcnt(0)
v_add_f32 v108, v108, v112
v_add_f32 v116, v116, v120
v_add_f32 v109, v109, v113
v_add_f32 v117, v117, v121
v_add_f32 v110, v110, v114
v_add_f32 v118, v118, v122
v_add_f32 v111, v111, v115
v_add_f32 v119, v119, v123
v_add_f32 v108, v108, v116
v_add_f32 v109, v109, v117
v_add_f32 v110, v110, v118
v_add_f32 v111, v111, v119
s_mov_b64 exec, 0xffffffff
buffer_store_dwordx4 v[108:111], v30, s[84:87], s44 offen sc1
s_mov_b64 exec, -1
Lw_89:
s_waitcnt lgkmcnt(0)
s_add_u32 m0, s39, 49152
s_mov_b32 s37, 49152
buffer_load_dwordx4 v3, s[8:11], s37 offen sc1 lds
s_load_dword s3, s[4:5], 3072
s_load_dword s3, s[4:5], 3136
s_load_dword s3, s[4:5], 3200
s_load_dword s3, s[4:5], 3264
s_load_dword s3, s[4:5], 3328
s_load_dword s3, s[4:5], 3392
buffer_load_dwordx4 v3, s[8:11], s37 offen offset:1024 sc1 lds
s_load_dword s3, s[4:5], 3456
s_load_dword s3, s[4:5], 3520
s_load_dword s3, s[4:5], 3584
s_load_dword s3, s[4:5], 3648
s_load_dword s3, s[4:5], 3712
v_mul_f32 v66, v57, v57
buffer_load_dwordx4 v3, s[8:11], s37 offen offset:2048 sc1 lds
v_mul_f32 v64, 0xc0135761, v57
v_mul_f32 v65, 0xbdd2d3e8, v57
v_mul_f32 v65, v65, v66
v_rcp_f32 v66, v66
v_mul_f32 v70, v59, v59
v_mul_f32 v68, 0xc0135761, v59
v_mul_f32 v69, 0xbdd2d3e8, v59
buffer_load_dwordx4 v3, s[8:11], s37 offen offset:3072 sc1 lds
v_mul_f32 v69, v69, v70
v_rcp_f32 v70, v70
v_fma_f32 v128, -v56, v32, v128
v_fma_f32 v129, -v56, v33, v129
v_fma_f32 v130, -v56, v34, v130
v_fma_f32 v131, -v56, v35, v131
s_add_u32 m0, s40, 49152
s_mov_b32 s38, 1376256
buffer_load_dwordx4 v4, s[12:15], s38 offen lds
v_fma_f32 v152, -v58, v32, v152
v_fma_f32 v153, -v58, v33, v153
v_fma_f32 v154, -v58, v34, v154
v_fma_f32 v155, -v58, v35, v155
v_mul_f32 v72, v128, v128
v_mul_f32 v73, v129, v129
s_add_u32 m0, s40, 50176
s_mov_b32 s38, 1376256
buffer_load_dwordx4 v5, s[12:15], s38 offen lds
v_mul_f32 v74, v130, v130
v_mul_f32 v75, v131, v131
v_mul_f32 v76, v152, v152
v_mul_f32 v77, v153, v153
v_mul_f32 v78, v154, v154
v_mul_f32 v79, v155, v155
v_fma_f32 v72, v72, v65, v64
s_add_u32 m0, s40, 51200
s_mov_b32 s38, 1433600
buffer_load_dwordx4 v4, s[12:15], s38 offen lds
v_fma_f32 v73, v73, v65, v64
v_fma_f32 v74, v74, v65, v64
v_fma_f32 v75, v75, v65, v64
v_fma_f32 v76, v76, v69, v68
v_fma_f32 v77, v77, v69, v68
v_fma_f32 v78, v78, v69, v68
s_add_u32 m0, s40, 52224
s_mov_b32 s38, 1433600
buffer_load_dwordx4 v5, s[12:15], s38 offen lds
v_fma_f32 v79, v79, v69, v68
v_mul_f32 v72, v72, v128
v_mul_f32 v73, v73, v129
v_mul_f32 v74, v74, v130
v_mul_f32 v75, v75, v131
v_mul_f32 v76, v76, v152
s_add_u32 m0, s40, 53248
s_mov_b32 s38, 1490944
buffer_load_dwordx4 v4, s[12:15], s38 offen lds
v_mul_f32 v77, v77, v153
v_mul_f32 v78, v78, v154
v_mul_f32 v79, v79, v155
v_exp_f32 v72, v72
v_exp_f32 v73, v73
v_exp_f32 v74, v74
v_exp_f32 v75, v75
s_add_u32 m0, s40, 54272
s_mov_b32 s38, 1490944
buffer_load_dwordx4 v5, s[12:15], s38 offen lds
v_exp_f32 v76, v76
v_exp_f32 v77, v77
v_exp_f32 v78, v78
v_exp_f32 v79, v79
v_fma_f32 v140, -v56, v44, v140
v_fma_f32 v141, -v56, v45, v141
s_add_u32 m0, s40, 55296
s_mov_b32 s38, 1548288
buffer_load_dwordx4 v4, s[12:15], s38 offen lds
v_fma_f32 v142, -v56, v46, v142
v_fma_f32 v143, -v56, v47, v143
v_fma_f32 v164, -v58, v44, v164
v_fma_f32 v165, -v58, v45, v165
v_fma_f32 v166, -v58, v46, v166
v_fma_f32 v167, -v58, v47, v167
v_fma_f32 v72, v72, v66, v66
s_add_u32 m0, s40, 56320
s_mov_b32 s38, 1548288
buffer_load_dwordx4 v5, s[12:15], s38 offen lds
s_mov_b32 s38, 3670016
buffer_load_dword v21, v20, s[12:15], s38 offen
s_waitcnt vmcnt(13)
s_barrier
s_add_u32 m0, s39, 98304
s_mov_b32 s37, 65536
buffer_load_dwordx4 v3, s[8:11], s37 offen sc1 lds
v_fma_f32 v73, v73, v66, v66
v_fma_f32 v74, v74, v66, v66
v_fma_f32 v75, v75, v66, v66
v_fma_f32 v76, v76, v70, v70
v_fma_f32 v77, v77, v70, v70
v_fma_f32 v78, v78, v70, v70
buffer_load_dwordx4 v3, s[8:11], s37 offen offset:1024 sc1 lds
v_fma_f32 v79, v79, v70, v70
v_rcp_f32 v72, v72
v_rcp_f32 v73, v73
v_rcp_f32 v74, v74
v_rcp_f32 v75, v75
v_rcp_f32 v76, v76
buffer_load_dwordx4 v3, s[8:11], s37 offen offset:2048 sc1 lds
v_rcp_f32 v77, v77
v_rcp_f32 v78, v78
v_rcp_f32 v79, v79
v_mul_f32 v140, v128, v140
v_mul_f32 v141, v129, v141
v_mul_f32 v142, v130, v142
buffer_load_dwordx4 v3, s[8:11], s37 offen offset:3072 sc1 lds
v_mul_f32 v143, v131, v143
v_mul_f32 v164, v152, v164
v_mul_f32 v165, v153, v165
v_mul_f32 v166, v154, v166
v_mul_f32 v167, v155, v167
v_mul_f32 v140, v140, v72
s_add_u32 m0, s40, 98304
s_mov_b32 s38, 1835008
buffer_load_dwordx4 v4, s[12:15], s38 offen lds
v_mul_f32 v141, v141, v73
v_mul_f32 v142, v142, v74
v_mul_f32 v143, v143, v75
v_mul_f32 v164, v164, v76
v_mul_f32 v165, v165, v77
v_mul_f32 v166, v166, v78
s_add_u32 m0, s40, 99328
s_mov_b32 s38, 1835008
buffer_load_dwordx4 v5, s[12:15], s38 offen lds
v_mul_f32 v167, v167, v79
v_cvt_pk_bf16_f32 v128, v140, v141
v_cvt_pk_bf16_f32 v129, v142, v143
v_cvt_pk_bf16_f32 v152, v164, v165
v_cvt_pk_bf16_f32 v153, v166, v167
v_fma_f32 v132, -v56, v36, v132
s_add_u32 m0, s40, 100352
s_mov_b32 s38, 1892352
buffer_load_dwordx4 v4, s[12:15], s38 offen lds
v_fma_f32 v133, -v56, v37, v133
v_fma_f32 v134, -v56, v38, v134
v_fma_f32 v135, -v56, v39, v135
v_fma_f32 v156, -v58, v36, v156
v_fma_f32 v157, -v58, v37, v157
v_fma_f32 v158, -v58, v38, v158
s_add_u32 m0, s40, 101376
s_mov_b32 s38, 1892352
buffer_load_dwordx4 v5, s[12:15], s38 offen lds
v_fma_f32 v159, -v58, v39, v159
v_mul_f32 v72, v132, v132
v_mul_f32 v73, v133, v133
v_mul_f32 v74, v134, v134
v_mul_f32 v75, v135, v135
v_mul_f32 v76, v156, v156
s_add_u32 m0, s40, 102400
s_mov_b32 s38, 1949696
buffer_load_dwordx4 v4, s[12:15], s38 offen lds
v_mul_f32 v77, v157, v157
v_mul_f32 v78, v158, v158
v_mul_f32 v79, v159, v159
v_fma_f32 v72, v72, v65, v64
v_fma_f32 v73, v73, v65, v64
v_fma_f32 v74, v74, v65, v64
s_add_u32 m0, s40, 103424
s_mov_b32 s38, 1949696
buffer_load_dwordx4 v5, s[12:15], s38 offen lds
v_fma_f32 v75, v75, v65, v64
v_fma_f32 v76, v76, v69, v68
v_fma_f32 v77, v77, v69, v68
v_fma_f32 v78, v78, v69, v68
v_fma_f32 v79, v79, v69, v68
v_mul_f32 v72, v72, v132
s_add_u32 m0, s40, 104448
s_mov_b32 s38, 2007040
buffer_load_dwordx4 v4, s[12:15], s38 offen lds
s_add_u32 m0, s40, 105472
s_mov_b32 s38, 2007040
buffer_load_dwordx4 v5, s[12:15], s38 offen lds
s_waitcnt vmcnt(13)
s_barrier
s_cmp_eq_u32 s47, 3
s_cbranch_scc0 Lw_90
s_lshr_b32 s43, s2, 4
s_add_u32 s43, s43, 80
s_lshl_b32 s43, s43, 7
v_mov_b32 v30, s43
v_mov_b32 v31, 1
s_mov_b64 exec, 1
buffer_atomic_add v31, v30, s[56:59], 0 offen sc1
s_mov_b64 exec, -1
Lw_90:
s_waitcnt lgkmcnt(0)
s_add_u32 m0, s39, 0
s_mov_b32 s37, 81920
buffer_load_dwordx4 v3, s[8:11], s37 offen sc1 lds
s_load_dword s3, s[4:5], 3776
s_load_dword s3, s[4:5], 3840
s_load_dword s3, s[4:5], 3904
s_load_dword s3, s[4:5], 3968
s_load_dword s3, s[4:5], 4032
s_load_dword s3, s[4:5], 4096
buffer_load_dwordx4 v3, s[8:11], s37 offen offset:1024 sc1 lds
s_load_dword s3, s[4:5], 4160
s_load_dword s3, s[4:5], 4224
s_load_dword s3, s[4:5], 4288
s_load_dword s3, s[4:5], 4352
s_load_dword s3, s[4:5], 4416
v_mul_f32 v73, v73, v133
buffer_load_dwordx4 v3, s[8:11], s37 offen offset:2048 sc1 lds
v_mul_f32 v74, v74, v134
v_mul_f32 v75, v75, v135
v_mul_f32 v76, v76, v156
v_mul_f32 v77, v77, v157
v_mul_f32 v78, v78, v158
v_mul_f32 v79, v79, v159
v_exp_f32 v72, v72
buffer_load_dwordx4 v3, s[8:11], s37 offen offset:3072 sc1 lds
v_exp_f32 v73, v73
v_exp_f32 v74, v74
v_exp_f32 v75, v75
v_exp_f32 v76, v76
v_exp_f32 v77, v77
v_exp_f32 v78, v78
s_add_u32 m0, s40, 0
s_mov_b32 s38, 2293760
buffer_load_dwordx4 v4, s[12:15], s38 offen lds
v_exp_f32 v79, v79
v_fma_f32 v144, -v56, v48, v144
v_fma_f32 v145, -v56, v49, v145
v_fma_f32 v146, -v56, v50, v146
v_fma_f32 v147, -v56, v51, v147
v_fma_f32 v168, -v58, v48, v168
v_fma_f32 v169, -v58, v49, v169
s_add_u32 m0, s40, 1024
s_mov_b32 s38, 2293760
buffer_load_dwordx4 v5, s[12:15], s38 offen lds
v_fma_f32 v170, -v58, v50, v170
v_fma_f32 v171, -v58, v51, v171
v_fma_f32 v72, v72, v66, v66
v_fma_f32 v73, v73, v66, v66
v_fma_f32 v74, v74, v66, v66
v_fma_f32 v75, v75, v66, v66
s_add_u32 m0, s40, 2048
s_mov_b32 s38, 2351104
buffer_load_dwordx4 v4, s[12:15], s38 offen lds
v_fma_f32 v76, v76, v70, v70
v_fma_f32 v77, v77, v70, v70
v_fma_f32 v78, v78, v70, v70
v_fma_f32 v79, v79, v70, v70
v_rcp_f32 v72, v72
v_rcp_f32 v73, v73
v_rcp_f32 v74, v74
s_add_u32 m0, s40, 3072
s_mov_b32 s38, 2351104
buffer_load_dwordx4 v5, s[12:15], s38 offen lds
v_rcp_f32 v75, v75
v_rcp_f32 v76, v76
v_rcp_f32 v77, v77
v_rcp_f32 v78, v78
v_rcp_f32 v79, v79
v_mul_f32 v144, v132, v144
s_add_u32 m0, s40, 4096
s_mov_b32 s38, 2408448
buffer_load_dwordx4 v4, s[12:15], s38 offen lds
v_mul_f32 v145, v133, v145
v_mul_f32 v146, v134, v146
v_mul_f32 v147, v135, v147
v_mul_f32 v168, v156, v168
v_mul_f32 v169, v157, v169
v_mul_f32 v170, v158, v170
v_mul_f32 v171, v159, v171
s_add_u32 m0, s40, 5120
s_mov_b32 s38, 2408448
buffer_load_dwordx4 v5, s[12:15], s38 offen lds
v_mul_f32 v144, v144, v72
v_mul_f32 v145, v145, v73
v_mul_f32 v146, v146, v74
v_mul_f32 v147, v147, v75
v_mul_f32 v168, v168, v76
v_mul_f32 v169, v169, v77
s_add_u32 m0, s40, 6144
s_mov_b32 s38, 2465792
buffer_load_dwordx4 v4, s[12:15], s38 offen lds
v_mul_f32 v170, v170, v78
v_mul_f32 v171, v171, v79
v_cvt_pk_bf16_f32 v130, v144, v145
v_cvt_pk_bf16_f32 v131, v146, v147
v_cvt_pk_bf16_f32 v154, v168, v169
v_cvt_pk_bf16_f32 v155, v170, v171
buffer_store_dwordx4 v[128:131], v2, s[24:27], s54 offen offset:0 sc1
s_add_u32 m0, s40, 7168
s_mov_b32 s38, 2465792
buffer_load_dwordx4 v5, s[12:15], s38 offen lds
s_mov_b32 s38, 4587520
buffer_load_dword v21, v20, s[12:15], s38 offen
s_waitcnt vmcnt(14)
s_barrier
s_add_u32 m0, s39, 49152
s_mov_b32 s37, 98304
buffer_load_dwordx4 v3, s[8:11], s37 offen sc1 lds
buffer_store_dwordx4 v[152:155], v2, s[24:27], s54 offen offset:1024 sc1
v_fma_f32 v136, -v56, v40, v136
v_fma_f32 v137, -v56, v41, v137
v_fma_f32 v138, -v56, v42, v138
v_fma_f32 v139, -v56, v43, v139
v_fma_f32 v160, -v58, v40, v160
buffer_load_dwordx4 v3, s[8:11], s37 offen offset:1024 sc1 lds
v_fma_f32 v161, -v58, v41, v161
v_fma_f32 v162, -v58, v42, v162
v_fma_f32 v163, -v58, v43, v163
v_mul_f32 v72, v136, v136
v_mul_f32 v73, v137, v137
v_mul_f32 v74, v138, v138
buffer_load_dwordx4 v3, s[8:11], s37 offen offset:2048 sc1 lds
v_mul_f32 v75, v139, v139
v_mul_f32 v76, v160, v160
v_mul_f32 v77, v161, v161
v_mul_f32 v78, v162, v162
v_mul_f32 v79, v163, v163
v_fma_f32 v72, v72, v65, v64
buffer_load_dwordx4 v3, s[8:11], s37 offen offset:3072 sc1 lds
v_fma_f32 v73, v73, v65, v64
v_fma_f32 v74, v74, v65, v64
v_fma_f32 v75, v75, v65, v64
v_fma_f32 v76, v76, v69, v68
v_fma_f32 v77, v77, v69, v68
v_fma_f32 v78, v78, v69, v68
s_add_u32 m0, s40, 49152
s_mov_b32 s38, 2752512
buffer_load_dwordx4 v4, s[12:15], s38 offen lds
v_fma_f32 v79, v79, v69, v68
v_mul_f32 v72, v72, v136
v_mul_f32 v73, v73, v137
v_mul_f32 v74, v74, v138
v_mul_f32 v75, v75, v139
v_mul_f32 v76, v76, v160
s_add_u32 m0, s40, 50176
s_mov_b32 s38, 2752512
buffer_load_dwordx4 v5, s[12:15], s38 offen lds
v_mul_f32 v77, v77, v161
v_mul_f32 v78, v78, v162
v_mul_f32 v79, v79, v163
v_exp_f32 v72, v72
v_exp_f32 v73, v73
v_exp_f32 v74, v74
s_add_u32 m0, s40, 51200
s_mov_b32 s38, 2809856
buffer_load_dwordx4 v4, s[12:15], s38 offen lds
v_exp_f32 v75, v75
v_exp_f32 v76, v76
v_exp_f32 v77, v77
v_exp_f32 v78, v78
v_exp_f32 v79, v79
v_fma_f32 v148, -v56, v52, v148
s_add_u32 m0, s40, 52224
s_mov_b32 s38, 2809856
buffer_load_dwordx4 v5, s[12:15], s38 offen lds
v_fma_f32 v149, -v56, v53, v149
v_fma_f32 v150, -v56, v54, v150
v_fma_f32 v151, -v56, v55, v151
v_fma_f32 v172, -v58, v52, v172
v_fma_f32 v173, -v58, v53, v173
v_fma_f32 v174, -v58, v54, v174
s_add_u32 m0, s40, 53248
s_mov_b32 s38, 2867200
buffer_load_dwordx4 v4, s[12:15], s38 offen lds
v_fma_f32 v175, -v58, v55, v175
v_fma_f32 v72, v72, v66, v66
v_fma_f32 v73, v73, v66, v66
v_fma_f32 v74, v74, v66, v66
v_fma_f32 v75, v75, v66, v66
v_fma_f32 v76, v76, v70, v70
s_add_u32 m0, s40, 54272
s_mov_b32 s38, 2867200
buffer_load_dwordx4 v5, s[12:15], s38 offen lds
v_fma_f32 v77, v77, v70, v70
v_fma_f32 v78, v78, v70, v70
v_fma_f32 v79, v79, v70, v70
v_rcp_f32 v72, v72
v_rcp_f32 v73, v73
v_rcp_f32 v74, v74
s_add_u32 m0, s40, 55296
s_mov_b32 s38, 2924544
buffer_load_dwordx4 v4, s[12:15], s38 offen lds
s_add_u32 m0, s40, 56320
s_mov_b32 s38, 2924544
buffer_load_dwordx4 v5, s[12:15], s38 offen lds
s_waitcnt vmcnt(14)
s_barrier
s_waitcnt lgkmcnt(0)
s_add_u32 m0, s39, 98304
s_mov_b32 s37, 114688
buffer_load_dwordx4 v3, s[8:11], s37 offen sc1 lds
s_load_dword s3, s[4:5], 4480
s_load_dword s3, s[4:5], 4544
s_load_dword s3, s[4:5], 4608
s_load_dword s3, s[4:5], 4672
s_load_dword s3, s[4:5], 4736
s_load_dword s3, s[4:5], 4800
buffer_load_dwordx4 v3, s[8:11], s37 offen offset:1024 sc1 lds
s_load_dword s3, s[4:5], 4864
s_load_dword s3, s[4:5], 4928
s_load_dword s3, s[4:5], 4992
s_load_dword s3, s[4:5], 5056
s_load_dword s3, s[4:5], 5120
v_rcp_f32 v75, v75
buffer_load_dwordx4 v3, s[8:11], s37 offen offset:2048 sc1 lds
v_rcp_f32 v76, v76
v_rcp_f32 v77, v77
v_rcp_f32 v78, v78
v_rcp_f32 v79, v79
v_mul_f32 v148, v136, v148
v_mul_f32 v149, v137, v149
v_mul_f32 v150, v138, v150
buffer_load_dwordx4 v3, s[8:11], s37 offen offset:3072 sc1 lds
v_mul_f32 v151, v139, v151
v_mul_f32 v172, v160, v172
v_mul_f32 v173, v161, v173
v_mul_f32 v174, v162, v174
v_mul_f32 v175, v163, v175
v_mul_f32 v148, v148, v72
s_add_u32 m0, s40, 98304
s_mov_b32 s38, 3211264
buffer_load_dwordx4 v4, s[12:15], s38 offen lds
v_mul_f32 v149, v149, v73
v_mul_f32 v150, v150, v74
v_mul_f32 v151, v151, v75
v_mul_f32 v172, v172, v76
v_mul_f32 v173, v173, v77
v_mul_f32 v174, v174, v78
s_add_u32 m0, s40, 99328
s_mov_b32 s38, 3211264
buffer_load_dwordx4 v5, s[12:15], s38 offen lds
v_mul_f32 v175, v175, v79
v_cvt_pk_bf16_f32 v80, v148, v149
v_cvt_pk_bf16_f32 v81, v150, v151
v_cvt_pk_bf16_f32 v82, v172, v173
v_cvt_pk_bf16_f32 v83, v174, v175
s_nop 1
v_permlane32_swap_b32 v80, v82
s_add_u32 m0, s40, 100352
s_mov_b32 s38, 3268608
buffer_load_dwordx4 v4, s[12:15], s38 offen lds
v_permlane32_swap_b32 v81, v83
buffer_store_dwordx4 v[80:83], v84, s[24:27], s55 offen offset:0 sc1
s_nop 1
v_mul_f32 v66, v61, v61
v_mul_f32 v64, 0xc0135761, v61
v_mul_f32 v65, 0xbdd2d3e8, v61
s_add_u32 m0, s40, 101376
s_mov_b32 s38, 3268608
buffer_load_dwordx4 v5, s[12:15], s38 offen lds
v_mul_f32 v65, v65, v66
v_rcp_f32 v66, v66
v_mul_f32 v70, v63, v63
v_mul_f32 v68, 0xc0135761, v63
v_mul_f32 v69, 0xbdd2d3e8, v63
v_mul_f32 v69, v69, v70
s_add_u32 m0, s40, 102400
s_mov_b32 s38, 3325952
buffer_load_dwordx4 v4, s[12:15], s38 offen lds
v_rcp_f32 v70, v70
v_fma_f32 v176, -v60, v32, v176
v_fma_f32 v177, -v60, v33, v177
v_fma_f32 v178, -v60, v34, v178
v_fma_f32 v179, -v60, v35, v179
v_fma_f32 v200, -v62, v32, v200
v_fma_f32 v201, -v62, v33, v201
s_add_u32 m0, s40, 103424
s_mov_b32 s38, 3325952
buffer_load_dwordx4 v5, s[12:15], s38 offen lds
v_fma_f32 v202, -v62, v34, v202
v_fma_f32 v203, -v62, v35, v203
v_mul_f32 v72, v176, v176
v_mul_f32 v73, v177, v177
v_mul_f32 v74, v178, v178
v_mul_f32 v75, v179, v179
s_add_u32 m0, s40, 104448
s_mov_b32 s38, 3383296
buffer_load_dwordx4 v4, s[12:15], s38 offen lds
v_mul_f32 v76, v200, v200
v_mul_f32 v77, v201, v201
v_mul_f32 v78, v202, v202
v_mul_f32 v79, v203, v203
v_fma_f32 v72, v72, v65, v64
v_fma_f32 v73, v73, v65, v64
v_fma_f32 v74, v74, v65, v64
s_add_u32 m0, s40, 105472
s_mov_b32 s38, 3383296
buffer_load_dwordx4 v5, s[12:15], s38 offen lds
s_mov_b32 s38, 5505024
buffer_load_dword v21, v20, s[12:15], s38 offen
s_waitcnt vmcnt(14)
s_barrier
s_add_u32 m0, s39, 0
s_mov_b32 s37, 131072
buffer_load_dwordx4 v3, s[8:11], s37 offen sc1 lds
v_fma_f32 v75, v75, v65, v64
v_fma_f32 v76, v76, v69, v68
v_fma_f32 v77, v77, v69, v68
v_fma_f32 v78, v78, v69, v68
v_fma_f32 v79, v79, v69, v68
v_mul_f32 v72, v72, v176
buffer_load_dwordx4 v3, s[8:11], s37 offen offset:1024 sc1 lds
v_mul_f32 v73, v73, v177
v_mul_f32 v74, v74, v178
v_mul_f32 v75, v75, v179
v_mul_f32 v76, v76, v200
v_mul_f32 v77, v77, v201
v_mul_f32 v78, v78, v202
buffer_load_dwordx4 v3, s[8:11], s37 offen offset:2048 sc1 lds
v_mul_f32 v79, v79, v203
v_exp_f32 v72, v72
v_exp_f32 v73, v73
v_exp_f32 v74, v74
v_exp_f32 v75, v75
v_exp_f32 v76, v76
buffer_load_dwordx4 v3, s[8:11], s37 offen offset:3072 sc1 lds
v_exp_f32 v77, v77
v_exp_f32 v78, v78
v_exp_f32 v79, v79
v_fma_f32 v188, -v60, v44, v188
v_fma_f32 v189, -v60, v45, v189
v_fma_f32 v190, -v60, v46, v190
s_add_u32 m0, s40, 0
s_mov_b32 s38, 3670016
buffer_load_dwordx4 v4, s[12:15], s38 offen lds
v_fma_f32 v191, -v60, v47, v191
v_fma_f32 v212, -v62, v44, v212
v_fma_f32 v213, -v62, v45, v213
v_fma_f32 v214, -v62, v46, v214
v_fma_f32 v215, -v62, v47, v215
v_fma_f32 v72, v72, v66, v66
s_add_u32 m0, s40, 1024
s_mov_b32 s38, 3670016
buffer_load_dwordx4 v5, s[12:15], s38 offen lds
v_fma_f32 v73, v73, v66, v66
v_fma_f32 v74, v74, v66, v66
v_fma_f32 v75, v75, v66, v66
v_fma_f32 v76, v76, v70, v70
s_branch Lov_11
.p2align 12
Lst_11_0:
s_branch Lst_15_0
Lst_11_1:
s_branch Lst_15_1
Lov_11:
v_fma_f32 v77, v77, v70, v70
v_fma_f32 v78, v78, v70, v70
s_add_u32 m0, s40, 2048
s_mov_b32 s38, 3727360
buffer_load_dwordx4 v4, s[12:15], s38 offen lds
v_fma_f32 v79, v79, v70, v70
v_rcp_f32 v72, v72
v_rcp_f32 v73, v73
v_rcp_f32 v74, v74
v_rcp_f32 v75, v75
v_rcp_f32 v76, v76
s_add_u32 m0, s40, 3072
s_mov_b32 s38, 3727360
buffer_load_dwordx4 v5, s[12:15], s38 offen lds
v_rcp_f32 v77, v77
v_rcp_f32 v78, v78
v_rcp_f32 v79, v79
v_mul_f32 v188, v176, v188
v_mul_f32 v189, v177, v189
v_mul_f32 v190, v178, v190
s_add_u32 m0, s40, 4096
s_mov_b32 s38, 3784704
buffer_load_dwordx4 v4, s[12:15], s38 offen lds
v_mul_f32 v191, v179, v191
v_mul_f32 v212, v200, v212
v_mul_f32 v213, v201, v213
v_mul_f32 v214, v202, v214
v_mul_f32 v215, v203, v215
v_mul_f32 v188, v188, v72
s_add_u32 m0, s40, 5120
s_mov_b32 s38, 3784704
buffer_load_dwordx4 v5, s[12:15], s38 offen lds
v_mul_f32 v189, v189, v73
v_mul_f32 v190, v190, v74
v_mul_f32 v191, v191, v75
v_mul_f32 v212, v212, v76
v_mul_f32 v213, v213, v77
v_mul_f32 v214, v214, v78
s_add_u32 m0, s40, 6144
s_mov_b32 s38, 3842048
buffer_load_dwordx4 v4, s[12:15], s38 offen lds
s_add_u32 m0, s40, 7168
s_mov_b32 s38, 3842048
buffer_load_dwordx4 v5, s[12:15], s38 offen lds
s_waitcnt vmcnt(13)
s_barrier
s_waitcnt lgkmcnt(0)
s_cmp_eq_u32 s47, 3
s_cbranch_scc0 Lw_91
s_lshl_b32 s92, s35, 7
s_add_u32 s92, s92, 28321792
s_load_dword s93, s[82:83], s92 glc
Lw_91:
s_add_u32 m0, s39, 49152
s_mov_b32 s37, 147456
buffer_load_dwordx4 v3, s[8:11], s37 offen sc1 lds
s_load_dword s3, s[4:5], 5184
s_load_dword s3, s[4:5], 5248
s_load_dword s3, s[4:5], 5312
s_load_dword s3, s[4:5], 5376
s_load_dword s3, s[4:5], 5440
s_load_dword s3, s[4:5], 5504
buffer_load_dwordx4 v3, s[8:11], s37 offen offset:1024 sc1 lds
s_load_dword s3, s[4:5], 5568
s_load_dword s3, s[4:5], 5632
s_load_dword s3, s[4:5], 5696
s_load_dword s3, s[4:5], 5760
s_load_dword s3, s[4:5], 5824
v_mul_f32 v215, v215, v79
buffer_load_dwordx4 v3, s[8:11], s37 offen offset:2048 sc1 lds
v_cvt_pk_bf16_f32 v176, v188, v189
v_cvt_pk_bf16_f32 v177, v190, v191
v_cvt_pk_bf16_f32 v200, v212, v213
v_cvt_pk_bf16_f32 v201, v214, v215
v_fma_f32 v180, -v60, v36, v180
v_fma_f32 v181, -v60, v37, v181
v_fma_f32 v182, -v60, v38, v182
buffer_load_dwordx4 v3, s[8:11], s37 offen offset:3072 sc1 lds
v_fma_f32 v183, -v60, v39, v183
v_fma_f32 v204, -v62, v36, v204
v_fma_f32 v205, -v62, v37, v205
v_fma_f32 v206, -v62, v38, v206
v_fma_f32 v207, -v62, v39, v207
v_mul_f32 v72, v180, v180
s_add_u32 m0, s40, 49152
s_mov_b32 s38, 4128768
buffer_load_dwordx4 v4, s[12:15], s38 offen lds
v_mul_f32 v73, v181, v181
v_mul_f32 v74, v182, v182
v_mul_f32 v75, v183, v183
v_mul_f32 v76, v204, v204
v_mul_f32 v77, v205, v205
v_mul_f32 v78, v206, v206
v_mul_f32 v79, v207, v207
s_add_u32 m0, s40, 50176
s_mov_b32 s38, 4128768
buffer_load_dwordx4 v5, s[12:15], s38 offen lds
v_fma_f32 v72, v72, v65, v64
v_fma_f32 v73, v73, v65, v64
v_fma_f32 v74, v74, v65, v64
v_fma_f32 v75, v75, v65, v64
v_fma_f32 v76, v76, v69, v68
v_fma_f32 v77, v77, v69, v68
s_add_u32 m0, s40, 51200
s_mov_b32 s38, 4186112
buffer_load_dwordx4 v4, s[12:15], s38 offen lds
v_fma_f32 v78, v78, v69, v68
v_fma_f32 v79, v79, v69, v68
v_mul_f32 v72, v72, v180
v_mul_f32 v73, v73, v181
v_mul_f32 v74, v74, v182
v_mul_f32 v75, v75, v183
v_mul_f32 v76, v76, v204
s_add_u32 m0, s40, 52224
s_mov_b32 s38, 4186112
buffer_load_dwordx4 v5, s[12:15], s38 offen lds
v_mul_f32 v77, v77, v205
v_mul_f32 v78, v78, v206
v_mul_f32 v79, v79, v207
v_exp_f32 v72, v72
v_exp_f32 v73, v73
v_exp_f32 v74, v74
s_add_u32 m0, s40, 53248
s_mov_b32 s38, 4243456
buffer_load_dwordx4 v4, s[12:15], s38 offen lds
v_exp_f32 v75, v75
v_exp_f32 v76, v76
v_exp_f32 v77, v77
v_exp_f32 v78, v78
v_exp_f32 v79, v79
v_fma_f32 v192, -v60, v48, v192
v_fma_f32 v193, -v60, v49, v193
s_add_u32 m0, s40, 54272
s_mov_b32 s38, 4243456
buffer_load_dwordx4 v5, s[12:15], s38 offen lds
v_fma_f32 v194, -v60, v50, v194
v_fma_f32 v195, -v60, v51, v195
v_fma_f32 v216, -v62, v48, v216
v_fma_f32 v217, -v62, v49, v217
v_fma_f32 v218, -v62, v50, v218
v_fma_f32 v219, -v62, v51, v219
s_add_u32 m0, s40, 55296
s_mov_b32 s38, 4300800
buffer_load_dwordx4 v4, s[12:15], s38 offen lds
v_fma_f32 v72, v72, v66, v66
v_fma_f32 v73, v73, v66, v66
v_fma_f32 v74, v74, v66, v66
v_fma_f32 v75, v75, v66, v66
v_fma_f32 v76, v76, v70, v70
v_fma_f32 v77, v77, v70, v70
v_fma_f32 v78, v78, v70, v70
s_add_u32 m0, s40, 56320
s_mov_b32 s38, 4300800
buffer_load_dwordx4 v5, s[12:15], s38 offen lds
s_mov_b32 s38, 6422528
buffer_load_dword v21, v20, s[12:15], s38 offen
s_waitcnt vmcnt(13)
s_barrier
s_add_u32 m0, s39, 98304
s_mov_b32 s37, 163840
buffer_load_dwordx4 v3, s[8:11], s37 offen sc1 lds
v_fma_f32 v79, v79, v70, v70
v_rcp_f32 v72, v72
v_rcp_f32 v73, v73
v_rcp_f32 v74, v74
v_rcp_f32 v75, v75
v_rcp_f32 v76, v76
buffer_load_dwordx4 v3, s[8:11], s37 offen offset:1024 sc1 lds
v_rcp_f32 v77, v77
v_rcp_f32 v78, v78
v_rcp_f32 v79, v79
v_mul_f32 v192, v180, v192
v_mul_f32 v193, v181, v193
v_mul_f32 v194, v182, v194
buffer_load_dwordx4 v3, s[8:11], s37 offen offset:2048 sc1 lds
v_mul_f32 v195, v183, v195
v_mul_f32 v216, v204, v216
v_mul_f32 v217, v205, v217
v_mul_f32 v218, v206, v218
v_mul_f32 v219, v207, v219
v_mul_f32 v192, v192, v72
buffer_load_dwordx4 v3, s[8:11], s37 offen offset:3072 sc1 lds
v_mul_f32 v193, v193, v73
v_mul_f32 v194, v194, v74
v_mul_f32 v195, v195, v75
v_mul_f32 v216, v216, v76
v_mul_f32 v217, v217, v77
v_mul_f32 v218, v218, v78
s_add_u32 m0, s40, 98304
s_mov_b32 s38, 4587520
buffer_load_dwordx4 v4, s[12:15], s38 offen lds
v_mul_f32 v219, v219, v79
v_cvt_pk_bf16_f32 v178, v192, v193
v_cvt_pk_bf16_f32 v179, v194, v195
v_cvt_pk_bf16_f32 v202, v216, v217
v_cvt_pk_bf16_f32 v203, v218, v219
buffer_store_dwordx4 v[176:179], v2, s[24:27], s54 offen offset:2048 sc1
s_add_u32 m0, s40, 99328
s_mov_b32 s38, 4587520
buffer_load_dwordx4 v5, s[12:15], s38 offen lds
buffer_store_dwordx4 v[200:203], v2, s[24:27], s54 offen offset:3072 sc1
v_fma_f32 v184, -v60, v40, v184
v_fma_f32 v185, -v60, v41, v185
v_fma_f32 v186, -v60, v42, v186
v_fma_f32 v187, -v60, v43, v187
v_fma_f32 v208, -v62, v40, v208
s_add_u32 m0, s40, 100352
s_mov_b32 s38, 4644864
buffer_load_dwordx4 v4, s[12:15], s38 offen lds
v_fma_f32 v209, -v62, v41, v209
v_fma_f32 v210, -v62, v42, v210
v_fma_f32 v211, -v62, v43, v211
v_mul_f32 v72, v184, v184
v_mul_f32 v73, v185, v185
v_mul_f32 v74, v186, v186
s_add_u32 m0, s40, 101376
s_mov_b32 s38, 4644864
buffer_load_dwordx4 v5, s[12:15], s38 offen lds
v_mul_f32 v75, v187, v187
v_mul_f32 v76, v208, v208
v_mul_f32 v77, v209, v209
v_mul_f32 v78, v210, v210
v_mul_f32 v79, v211, v211
v_fma_f32 v72, v72, v65, v64
s_add_u32 m0, s40, 102400
s_mov_b32 s38, 4702208
buffer_load_dwordx4 v4, s[12:15], s38 offen lds
v_fma_f32 v73, v73, v65, v64
v_fma_f32 v74, v74, v65, v64
v_fma_f32 v75, v75, v65, v64
v_fma_f32 v76, v76, v69, v68
v_fma_f32 v77, v77, v69, v68
v_fma_f32 v78, v78, v69, v68
s_add_u32 m0, s40, 103424
s_mov_b32 s38, 4702208
buffer_load_dwordx4 v5, s[12:15], s38 offen lds
v_fma_f32 v79, v79, v69, v68
v_mul_f32 v72, v72, v184
v_mul_f32 v73, v73, v185
v_mul_f32 v74, v74, v186
v_mul_f32 v75, v75, v187
v_mul_f32 v76, v76, v208
s_add_u32 m0, s40, 104448
s_mov_b32 s38, 4759552
buffer_load_dwordx4 v4, s[12:15], s38 offen lds
s_add_u32 m0, s40, 105472
s_mov_b32 s38, 4759552
buffer_load_dwordx4 v5, s[12:15], s38 offen lds
s_waitcnt vmcnt(15)
s_cmp_eq_u32 s47, 3
s_cbranch_scc0 Lw_92
s_mov_b32 s41, 0x40000
s_branch Lpchk_95
Lpoll_93:
s_load_dword s93, s[82:83], s92 glc
Lpchk_95:
s_waitcnt lgkmcnt(0)
s_cmp_eq_u32 s93, 16
s_cbranch_scc1 Lpok_94
s_sub_u32 s41, s41, 1
s_cmp_lg_u32 s41, 0
s_cbranch_scc1 Lpoll_93
Lpok_94:
Lw_92:
s_barrier
s_lshl_b32 s60, s35, 9
s_lshl_b32 s43, s47, 7
s_add_u32 s60, s60, s43
s_add_u32 s61, s60, 14336
s_add_u32 s52, s43, 148480
s_add_u32 s53, s52, 896
v_lshrrev_b32 v104, 3, v1
v_mul_u32_u24 v104, 28672, v104
v_and_b32 v105, 7, v1
v_lshl_add_u32 v104, v105, 4, v104
s_waitcnt lgkmcnt(0)
buffer_load_dwordx4 v[96:99], v104, s[84:87], s60 offen sc1
s_load_dword s3, s[4:5], 5888
s_load_dword s3, s[4:5], 5952
s_load_dword s3, s[4:5], 6016
s_load_dword s3, s[4:5], 6080
s_load_dword s3, s[4:5], 6144
s_load_dword s3, s[4:5], 6208
buffer_load_dwordx4 v[100:103], v104, s[84:87], s61 offen sc1
s_load_dword s3, s[4:5], 6272
s_load_dword s3, s[4:5], 6336
s_load_dword s3, s[4:5], 6400
s_load_dword s3, s[4:5], 6464
s_load_dword s3, s[4:5], 6528
v_mul_f32 v77, v77, v209
v_mul_f32 v78, v78, v210
s_add_u32 m0, s39, 0
s_mov_b32 s37, 180224
buffer_load_dwordx4 v3, s[8:11], s37 offen sc1 lds
v_mul_f32 v79, v79, v211
v_exp_f32 v72, v72
v_exp_f32 v73, v73
v_exp_f32 v74, v74
v_exp_f32 v75, v75
v_exp_f32 v76, v76
buffer_load_dwordx4 v3, s[8:11], s37 offen offset:1024 sc1 lds
v_exp_f32 v77, v77
v_exp_f32 v78, v78
v_exp_f32 v79, v79
v_fma_f32 v196, -v60, v52, v196
v_fma_f32 v197, -v60, v53, v197
v_fma_f32 v198, -v60, v54, v198
v_fma_f32 v199, -v60, v55, v199
buffer_load_dwordx4 v3, s[8:11], s37 offen offset:2048 sc1 lds
v_fma_f32 v220, -v62, v52, v220
v_fma_f32 v221, -v62, v53, v221
v_fma_f32 v222, -v62, v54, v222
v_fma_f32 v223, -v62, v55, v223
v_fma_f32 v72, v72, v66, v66
v_fma_f32 v73, v73, v66, v66
buffer_load_dwordx4 v3, s[8:11], s37 offen offset:3072 sc1 lds
v_fma_f32 v74, v74, v66, v66
v_fma_f32 v75, v75, v66, v66
v_fma_f32 v76, v76, v70, v70
v_fma_f32 v77, v77, v70, v70
v_fma_f32 v78, v78, v70, v70
v_fma_f32 v79, v79, v70, v70
v_rcp_f32 v72, v72
s_add_u32 m0, s40, 0
s_mov_b32 s38, 5046272
buffer_load_dwordx4 v4, s[12:15], s38 offen lds
v_rcp_f32 v73, v73
v_rcp_f32 v74, v74
v_rcp_f32 v75, v75
v_rcp_f32 v76, v76
v_rcp_f32 v77, v77
v_rcp_f32 v78, v78
s_add_u32 m0, s40, 1024
s_mov_b32 s38, 5046272
buffer_load_dwordx4 v5, s[12:15], s38 offen lds
v_rcp_f32 v79, v79
v_mul_f32 v196, v184, v196
v_mul_f32 v197, v185, v197
v_mul_f32 v198, v186, v198
v_mul_f32 v199, v187, v199
v_mul_f32 v220, v208, v220
v_mul_f32 v221, v209, v221
s_add_u32 m0, s40, 2048
s_mov_b32 s38, 5103616
buffer_load_dwordx4 v4, s[12:15], s38 offen lds
v_mul_f32 v222, v210, v222
v_mul_f32 v223, v211, v223
v_mul_f32 v196, v196, v72
v_mul_f32 v197, v197, v73
v_mul_f32 v198, v198, v74
v_mul_f32 v199, v199, v75
s_add_u32 m0, s40, 3072
s_mov_b32 s38, 5103616
buffer_load_dwordx4 v5, s[12:15], s38 offen lds
v_mul_f32 v220, v220, v76
v_mul_f32 v221, v221, v77
v_mul_f32 v222, v222, v78
v_mul_f32 v223, v223, v79
v_cvt_pk_bf16_f32 v80, v196, v197
v_cvt_pk_bf16_f32 v81, v198, v199
v_cvt_pk_bf16_f32 v82, v220, v221
s_add_u32 m0, s40, 4096
s_mov_b32 s38, 5160960
buffer_load_dwordx4 v4, s[12:15], s38 offen lds
v_cvt_pk_bf16_f32 v83, v222, v223
s_nop 1
v_permlane32_swap_b32 v80, v82
v_permlane32_swap_b32 v81, v83
buffer_store_dwordx4 v[80:83], v84, s[24:27], s55 offen offset:2048 sc1
s_nop 1
s_add_u32 m0, s40, 5120
s_mov_b32 s38, 5160960
buffer_load_dwordx4 v5, s[12:15], s38 offen lds
v_cmp_gt_u32 vcc, 32, v1
v_mov_b32 v104, s52
v_mov_b32 v106, s53
v_cndmask_b32 v104, v106, v104, vcc
v_lshl_add_u32 v104, v105, 4, v104
v_bfe_u32 v105, v1, 4, 1
v_lshl_add_u32 v104, v105, 2, v104
s_add_u32 m0, s40, 6144
s_mov_b32 s38, 5218304
buffer_load_dwordx4 v4, s[12:15], s38 offen lds
s_add_u32 m0, s40, 7168
s_mov_b32 s38, 5218304
buffer_load_dwordx4 v5, s[12:15], s38 offen lds
s_waitcnt vmcnt(15)
s_barrier
s_add_u32 m0, s39, 49152
s_mov_b32 s37, 196608
buffer_load_dwordx4 v3, s[8:11], s37 offen sc1 lds
buffer_load_dwordx4 v3, s[8:11], s37 offen offset:1024 sc1 lds
buffer_load_dwordx4 v3, s[8:11], s37 offen offset:2048 sc1 lds
buffer_load_dwordx4 v3, s[8:11], s37 offen offset:3072 sc1 lds
s_add_u32 m0, s40, 49152
s_mov_b32 s38, 5505024
buffer_load_dwordx4 v4, s[12:15], s38 offen lds
s_add_u32 m0, s40, 50176
s_mov_b32 s38, 5505024
buffer_load_dwordx4 v5, s[12:15], s38 offen lds
s_add_u32 m0, s40, 51200
s_mov_b32 s38, 5562368
buffer_load_dwordx4 v4, s[12:15], s38 offen lds
s_add_u32 m0, s40, 52224
s_mov_b32 s38, 5562368
buffer_load_dwordx4 v5, s[12:15], s38 offen lds
s_add_u32 m0, s40, 53248
s_mov_b32 s38, 5619712
buffer_load_dwordx4 v4, s[12:15], s38 offen lds
s_add_u32 m0, s40, 54272
s_mov_b32 s38, 5619712
buffer_load_dwordx4 v5, s[12:15], s38 offen lds
s_add_u32 m0, s40, 55296
s_mov_b32 s38, 5677056
buffer_load_dwordx4 v4, s[12:15], s38 offen lds
s_add_u32 m0, s40, 56320
s_mov_b32 s38, 5677056
buffer_load_dwordx4 v5, s[12:15], s38 offen lds
s_waitcnt vmcnt(12)
s_barrier
s_cmp_eq_u32 s47, 0
s_cbranch_scc0 Lw_96
s_add_u32 s7, s34, 32
s_lshl_b32 s7, s7, 7
v_mov_b32 v28, s7
v_mov_b32 v29, 1
s_mov_b64 exec, 1
buffer_atomic_add v29, v28, s[56:59], 0 offen sc1
s_mov_b64 exec, -1
Lw_96:
v_permlane32_swap_b32 v96, v100
v_permlane32_swap_b32 v97, v101
v_permlane32_swap_b32 v98, v102
v_permlane32_swap_b32 v99, v103
v_add_f32 v96, v96, v100
v_add_f32 v97, v97, v101
v_add_f32 v98, v98, v102
v_add_f32 v99, v99, v103
s_nop 1
v_permlane16_swap_b32 v96, v97
v_permlane16_swap_b32 v98, v99
v_add_f32 v96, v96, v97
v_add_f32 v98, v98, v99
s_nop 1
v_add_f32_dpp v96, v96, v96 row_ror:8 row_mask:0xf bank_mask:0xf
v_add_f32_dpp v98, v98, v98 row_ror:8 row_mask:0xf bank_mask:0xf
ds_write_b32 v104, v96
ds_write_b32 v104, v98 offset:8
s_waitcnt lgkmcnt(0)
s_add_u32 m0, s39, 98304
s_mov_b32 s37, 212992
buffer_load_dwordx4 v3, s[8:11], s37 offen sc1 lds
s_load_dword s3, s[4:5], 6592
s_load_dword s3, s[4:5], 6656
s_load_dword s3, s[4:5], 6720
s_load_dword s3, s[4:5], 6784
s_load_dword s3, s[4:5], 6848
buffer_load_dwordx4 v3, s[8:11], s37 offen offset:1024 sc1 lds
s_load_dword s3, s[4:5], 6912
s_load_dword s3, s[4:5], 6976
s_load_dword s3, s[4:5], 7040
s_load_dword s3, s[4:5], 7104
s_bfe_u32 s61, s35, 0x10002
s_lshr_b32 s60, s35, 3
buffer_load_dwordx4 v3, s[8:11], s37 offen offset:2048 sc1 lds
s_lshl_b32 s60, s60, 2
s_and_b32 s43, s35, 3
s_add_u32 s60, s60, s43
s_lshl_b32 s43, s60, 8
s_add_u32 s28, s76, s43
s_addc_u32 s29, s77, 0
buffer_load_dwordx4 v3, s[8:11], s37 offen offset:3072 sc1 lds
s_mov_b32 s30, 7338240
s_mov_b32 s31, 0x20000
s_mul_i32 s52, s61, 196608
s_mul_i32 s53, s61, 1572864
s_mul_i32 s90, s61, 163840
s_mul_i32 s91, s61, 1310720
s_add_u32 m0, s40, 98304
s_mov_b32 s38, 5963776
buffer_load_dwordx4 v4, s[12:15], s38 offen lds
s_lshl_b32 s51, s47, 11
s_lshl_b32 s44, s47, 15
v_lshrrev_b32 v122, 4, v1
v_lshlrev_b32 v123, 1, v122
v_and_b32 v23, 15, v1
v_xor_b32 v23, v23, v123
s_add_u32 m0, s40, 99328
s_mov_b32 s38, 5963776
buffer_load_dwordx4 v5, s[12:15], s38 offen lds
v_lshlrev_b32 v23, 4, v23
v_mul_u32_u24 v122, 2048, v122
v_add_u32 v23, v23, v122
v_add_u32 v23, s44, v23
v_xor_b32 v24, 128, v23
s_add_u32 m0, s40, 100352
s_mov_b32 s38, 6021120
buffer_load_dwordx4 v4, s[12:15], s38 offen lds
v_add_u32 v24, 8192, v24
s_lshl_b32 s43, s60, 2
s_lshl_b32 s44, s61, 1
s_add_u32 s43, s43, s44
s_add_u32 s43, s43, s63
s_lshl_b32 s43, s43, 13
s_add_u32 m0, s40, 101376
s_mov_b32 s38, 6021120
buffer_load_dwordx4 v5, s[12:15], s38 offen lds
s_lshl_b32 s44, s62, 12
s_add_u32 s50, s43, s44
v_add_u32 v6, s44, v2
v_add_u32 v7, 0x10000, v6
v_add_u32 v8, 0x20000, v6
v_lshrrev_b32 v122, 2, v1
s_add_u32 m0, s40, 102400
s_mov_b32 s38, 6078464
buffer_load_dwordx4 v4, s[12:15], s38 offen lds
v_and_b32 v123, 7, v122
v_mul_u32_u24 v122, 256, v122
v_lshl_add_u32 v122, v123, 5, v122
v_and_b32 v123, 3, v1
v_lshl_add_u32 v9, v123, 3, v122
s_lshl_b32 s43, s61, 7
s_add_u32 m0, s40, 103424
s_mov_b32 s38, 6078464
buffer_load_dwordx4 v5, s[12:15], s38 offen lds
s_lshl_b32 s44, s63, 6
s_add_u32 s43, s43, s44
v_xor_b32 v9, s43, v9
v_xor_b32 v10, 32, v9
v_xor_b32 v11, 128, v9
v_xor_b32 v12, 128, v10
s_add_u32 m0, s40, 104448
s_mov_b32 s38, 6135808
buffer_load_dwordx4 v4, s[12:15], s38 offen lds
s_add_u32 m0, s40, 105472
s_mov_b32 s38, 6135808
buffer_load_dwordx4 v5, s[12:15], s38 offen lds
s_waitcnt vmcnt(12)
s_barrier
buffer_load_dwordx4 v[160:163], v2, s[8:11], s50 offen offset:0 sc1
v_add_u32 v13, 65536, v9
v_add_u32 v14, 65536, v10
v_add_u32 v15, 65536, v11
buffer_load_dwordx4 v[164:167], v2, s[8:11], s50 offen offset:1024 sc1
v_add_u32 v16, 65536, v12
v_add_u32 v25, 131072, v9
v_add_u32 v26, 131072, v10
v_add_u32 v27, 131072, v11
buffer_load_dwordx4 v[168:171], v2, s[8:11], s50 offen offset:2048 sc1
v_add_u32 v28, 131072, v12
v_lshrrev_b32 v122, 2, v1
v_bfe_u32 v123, v122, 1, 2
buffer_load_dwordx4 v[172:175], v2, s[8:11], s50 offen offset:3072 sc1
v_mul_u32_u24 v122, 128, v122
v_lshl_add_u32 v122, v123, 5, v122
v_and_b32 v123, 3, v1
v_lshl_add_u32 v224, v123, 3, v122
s_add_u32 m0, s39, 0
s_mov_b32 s37, 229376
buffer_load_dwordx4 v3, s[8:11], s37 offen sc1 lds
v_xor_b32 v224, s44, v224
v_xor_b32 v225, 32, v224
v_add_u32 v226, 65536, v224
buffer_load_dwordx4 v3, s[8:11], s37 offen offset:1024 sc1 lds
v_add_u32 v227, 65536, v225
v_add_u32 v228, 131072, v224
v_add_u32 v229, 131072, v225
s_add_u32 s84, s82, 33554432
buffer_load_dwordx4 v3, s[8:11], s37 offen offset:2048 sc1 lds
s_addc_u32 s85, s83, 0
s_mov_b32 s86, 4194304
s_mov_b32 s87, 0x20000
s_xor_b32 s43, s2, 2
buffer_load_dwordx4 v3, s[8:11], s37 offen offset:3072 sc1 lds
s_lshl_b32 s44, s43, 2
s_add_u32 s44, s44, s47
s_lshl_b32 s45, s44, 12
s_add_u32 m0, s40, 0
s_mov_b32 s38, 6422528
buffer_load_dwordx4 v4, s[12:15], s38 offen lds
s_lshl_b32 s46, s2, 2
s_add_u32 s46, s46, s47
s_lshl_b32 s46, s46, 12
s_lshl_b32 s43, s34, 18
s_add_u32 m0, s40, 1024
s_mov_b32 s38, 6422528
buffer_load_dwordx4 v5, s[12:15], s38 offen lds
s_lshl_b32 s42, s60, 8
s_add_u32 s43, s43, s42
s_lshl_b32 s42, s61, 7
s_add_u32 m0, s40, 2048
s_mov_b32 s38, 6479872
buffer_load_dwordx4 v4, s[12:15], s38 offen lds
s_add_u32 s43, s43, s42
s_lshl_b32 s42, s63, 6
s_add_u32 s43, s43, s42
s_add_u32 s20, s78, s43
s_add_u32 m0, s40, 3072
s_mov_b32 s38, 6479872
buffer_load_dwordx4 v5, s[12:15], s38 offen lds
s_addc_u32 s21, s79, 0
s_mov_b32 s22, 260160
s_mov_b32 s23, 0x20000
s_add_u32 m0, s40, 4096
s_mov_b32 s38, 6537216
buffer_load_dwordx4 v4, s[12:15], s38 offen lds
v_and_b32 v230, 15, v1
v_lshlrev_b32 v230, 12, v230
v_bfe_u32 v231, v1, 4, 1
v_lshl_add_u32 v230, v231, 5, v230
s_add_u32 m0, s40, 5120
s_mov_b32 s38, 6537216
buffer_load_dwordx4 v5, s[12:15], s38 offen lds
v_bfe_u32 v231, v1, 5, 1
v_lshl_add_u32 v230, v231, 4, v230
s_lshl_b32 s54, s62, 17
s_add_u32 s55, s54, 65536
s_add_u32 m0, s40, 6144
s_mov_b32 s38, 6594560
buffer_load_dwordx4 v4, s[12:15], s38 offen lds
s_add_u32 m0, s40, 7168
s_mov_b32 s38, 6594560
buffer_load_dwordx4 v5, s[12:15], s38 offen lds
s_waitcnt vmcnt(16)
s_barrier
s_cmp_eq_u32 s47, 3
s_cbranch_scc0 Lw_97
s_lshl_b32 s92, s34, 7
s_add_u32 s92, s92, 28315648
s_load_dword s93, s[82:83], s92 glc
Lw_97:
s_add_u32 m0, s39, 49152
s_mov_b32 s37, 245760
buffer_load_dwordx4 v3, s[8:11], s37 offen sc1 lds
buffer_load_dwordx4 v3, s[8:11], s37 offen offset:1024 sc1 lds
buffer_load_dwordx4 v3, s[8:11], s37 offen offset:2048 sc1 lds
buffer_load_dwordx4 v3, s[8:11], s37 offen offset:3072 sc1 lds
s_add_u32 m0, s40, 49152
s_mov_b32 s38, 6881280
buffer_load_dwordx4 v4, s[12:15], s38 offen lds
s_add_u32 m0, s40, 50176
s_branch Lov_12
.p2align 12
Lst_12_0:
s_branch Lst_16_0
Lst_12_1:
s_branch Lst_16_1
Lov_12:
s_mov_b32 s38, 6881280
buffer_load_dwordx4 v5, s[12:15], s38 offen lds
s_add_u32 m0, s40, 51200
s_mov_b32 s38, 6938624
buffer_load_dwordx4 v4, s[12:15], s38 offen lds
s_add_u32 m0, s40, 52224
s_mov_b32 s38, 6938624
buffer_load_dwordx4 v5, s[12:15], s38 offen lds
s_add_u32 m0, s40, 53248
s_mov_b32 s38, 6995968
buffer_load_dwordx4 v4, s[12:15], s38 offen lds
s_add_u32 m0, s40, 54272
s_mov_b32 s38, 6995968
buffer_load_dwordx4 v5, s[12:15], s38 offen lds
s_add_u32 m0, s40, 55296
s_mov_b32 s38, 7053312
buffer_load_dwordx4 v4, s[12:15], s38 offen lds
s_add_u32 m0, s40, 56320
s_mov_b32 s38, 7053312
buffer_load_dwordx4 v5, s[12:15], s38 offen lds
s_waitcnt vmcnt(12)
s_cmp_eq_u32 s47, 3
s_cbranch_scc0 Lw_98
s_mov_b32 s41, 0x40000
s_branch Lpchk_101
Lpoll_99:
s_load_dword s93, s[82:83], s92 glc
Lpchk_101:
s_waitcnt lgkmcnt(0)
s_cmp_eq_u32 s93, 16
s_cbranch_scc1 Lpok_100
s_sub_u32 s41, s41, 1
s_cmp_lg_u32 s41, 0
s_cbranch_scc1 Lpoll_99
Lpok_100:
Lw_98:
s_barrier
s_add_u32 m0, s39, 98304
s_add_u32 s37, s52, 524288
buffer_load_dwordx4 v3, s[24:27], s37 offen sc1 lds
v_lshlrev_b32 v128, 16, v160
v_and_b32 v129, 0xffff0000, v160
v_lshlrev_b32 v130, 16, v161
v_and_b32 v131, 0xffff0000, v161
v_lshlrev_b32 v132, 16, v162
buffer_load_dwordx4 v3, s[24:27], s37 offen offset:1024 sc1 lds
v_and_b32 v133, 0xffff0000, v162
v_lshlrev_b32 v134, 16, v163
v_and_b32 v135, 0xffff0000, v163
v_lshlrev_b32 v136, 16, v164
v_and_b32 v137, 0xffff0000, v164
buffer_load_dwordx4 v3, s[24:27], s37 offen offset:2048 sc1 lds
v_lshlrev_b32 v138, 16, v165
v_and_b32 v139, 0xffff0000, v165
v_lshlrev_b32 v140, 16, v166
v_and_b32 v141, 0xffff0000, v166
v_lshlrev_b32 v142, 16, v167
v_and_b32 v143, 0xffff0000, v167
buffer_load_dwordx4 v3, s[24:27], s37 offen offset:3072 sc1 lds
v_lshlrev_b32 v144, 16, v168
v_and_b32 v145, 0xffff0000, v168
v_lshlrev_b32 v146, 16, v169
v_and_b32 v147, 0xffff0000, v169
v_lshlrev_b32 v148, 16, v170
s_add_u32 m0, s39, 114688
s_add_u32 s38, s53, 4194304
buffer_load_dwordx4 v23, s[28:31], s38 offen lds
v_and_b32 v149, 0xffff0000, v170
v_lshlrev_b32 v150, 16, v171
v_and_b32 v151, 0xffff0000, v171
v_lshlrev_b32 v152, 16, v172
v_and_b32 v153, 0xffff0000, v172
s_add_u32 m0, s39, 115712
s_add_u32 s38, s53, 4194304
buffer_load_dwordx4 v24, s[28:31], s38 offen lds
v_lshlrev_b32 v154, 16, v173
v_and_b32 v155, 0xffff0000, v173
v_lshlrev_b32 v156, 16, v174
v_and_b32 v157, 0xffff0000, v174
v_lshlrev_b32 v158, 16, v175
v_and_b32 v159, 0xffff0000, v175
s_add_u32 m0, s39, 116736
s_add_u32 s38, s53, 4210688
buffer_load_dwordx4 v23, s[28:31], s38 offen lds
s_add_u32 m0, s39, 117760
s_add_u32 s38, s53, 4210688
buffer_load_dwordx4 v24, s[28:31], s38 offen lds
s_waitcnt vmcnt(8)
s_barrier
s_add_u32 m0, s39, 131072
s_add_u32 s37, s52, 540672
buffer_load_dwordx4 v3, s[24:27], s37 offen sc1 lds
buffer_load_dwordx4 v3, s[24:27], s37 offen offset:1024 sc1 lds
buffer_load_dwordx4 v3, s[24:27], s37 offen offset:2048 sc1 lds
buffer_load_dwordx4 v3, s[24:27], s37 offen offset:3072 sc1 lds
s_add_u32 m0, s39, 0
s_add_u32 s38, s53, 4325376
buffer_load_dwordx4 v23, s[28:31], s38 offen lds
s_add_u32 m0, s39, 1024
s_add_u32 s38, s53, 4325376
buffer_load_dwordx4 v24, s[28:31], s38 offen lds
s_add_u32 m0, s39, 2048
s_add_u32 s38, s53, 4341760
buffer_load_dwordx4 v23, s[28:31], s38 offen lds
s_add_u32 m0, s39, 3072
s_add_u32 s38, s53, 4341760
buffer_load_dwordx4 v24, s[28:31], s38 offen lds
s_add_u32 m0, s39, 16384
s_add_u32 s37, s52, 557056
buffer_load_dwordx4 v3, s[24:27], s37 offen sc1 lds
buffer_load_dwordx4 v3, s[24:27], s37 offen offset:1024 sc1 lds
buffer_load_dwordx4 v3, s[24:27], s37 offen offset:2048 sc1 lds
buffer_load_dwordx4 v3, s[24:27], s37 offen offset:3072 sc1 lds
s_add_u32 m0, s39, 32768
s_add_u32 s38, s53, 4456448
buffer_load_dwordx4 v23, s[28:31], s38 offen lds
s_add_u32 m0, s39, 33792
s_add_u32 s38, s53, 4456448
buffer_load_dwordx4 v24, s[28:31], s38 offen lds
s_add_u32 m0, s39, 34816
s_add_u32 s38, s53, 4472832
buffer_load_dwordx4 v23, s[28:31], s38 offen lds
s_add_u32 m0, s39, 35840
s_add_u32 s38, s53, 4472832
buffer_load_dwordx4 v24, s[28:31], s38 offen lds
s_waitcnt vmcnt(16)
s_barrier
ds_read_b128 v[32:35], v7 offset:32768
ds_read_b64_tr_b16 v[48:49], v13 offset:49152
ds_read_b64_tr_b16 v[50:51], v13 offset:53248
ds_read_b64_tr_b16 v[52:53], v14 offset:49152
ds_read_b64_tr_b16 v[54:55], v14 offset:53248
ds_read_b64_tr_b16 v[56:57], v15 offset:49152
ds_read_b64_tr_b16 v[58:59], v15 offset:53248
ds_read_b64_tr_b16 v[60:61], v16 offset:49152
ds_read_b64_tr_b16 v[62:63], v16 offset:53248
ds_read_b128 v[36:39], v7 offset:33792
ds_read_b128 v[40:43], v7 offset:34816
ds_read_b128 v[44:47], v7 offset:35840
ds_read_b128 v[64:67], v7 offset:40960
ds_read_b64_tr_b16 v[80:81], v13 offset:57344
ds_read_b64_tr_b16 v[82:83], v13 offset:61440
ds_read_b64_tr_b16 v[84:85], v14 offset:57344
ds_read_b64_tr_b16 v[86:87], v14 offset:61440
ds_read_b64_tr_b16 v[88:89], v15 offset:57344
ds_read_b64_tr_b16 v[90:91], v15 offset:61440
ds_read_b64_tr_b16 v[92:93], v16 offset:57344
ds_read_b64_tr_b16 v[94:95], v16 offset:61440
ds_read_b128 v[68:71], v7 offset:41984
ds_read_b128 v[72:75], v7 offset:43008
ds_read_b128 v[76:79], v7 offset:44032
s_add_u32 m0, s39, 49152
s_add_u32 s37, s52, 573440
buffer_load_dwordx4 v3, s[24:27], s37 offen sc1 lds
buffer_load_dwordx4 v3, s[24:27], s37 offen offset:1024 sc1 lds
buffer_load_dwordx4 v3, s[24:27], s37 offen offset:2048 sc1 lds
buffer_load_dwordx4 v3, s[24:27], s37 offen offset:3072 sc1 lds
s_add_u32 m0, s39, 65536
s_add_u32 s38, s53, 4587520
buffer_load_dwordx4 v23, s[28:31], s38 offen lds
s_add_u32 m0, s39, 66560
s_add_u32 s38, s53, 4587520
buffer_load_dwordx4 v24, s[28:31], s38 offen lds
s_add_u32 m0, s39, 67584
s_add_u32 s38, s53, 4603904
buffer_load_dwordx4 v23, s[28:31], s38 offen lds
s_add_u32 m0, s39, 68608
s_add_u32 s38, s53, 4603904
buffer_load_dwordx4 v24, s[28:31], s38 offen lds
s_waitcnt vmcnt(16)
s_waitcnt lgkmcnt(0)
s_barrier
v_mfma_f32_16x16x32_bf16 v[128:131], v[48:51], v[32:35], v[128:131]
ds_read_b128 v[96:99], v8 offset:0
v_mfma_f32_16x16x32_bf16 v[132:135], v[52:55], v[32:35], v[132:135]
ds_read_b64_tr_b16 v[112:113], v9 offset:0
v_mfma_f32_16x16x32_bf16 v[160:163], v[56:59], v[32:35], 0
ds_read_b64_tr_b16 v[114:115], v9 offset:4096
v_mfma_f32_16x16x32_bf16 v[164:167], v[60:63], v[32:35], 0
ds_read_b64_tr_b16 v[116:117], v10 offset:0
v_mfma_f32_16x16x32_bf16 v[172:175], v[60:63], v[36:39], 0
ds_read_b64_tr_b16 v[118:119], v10 offset:4096
v_mfma_f32_16x16x32_bf16 v[168:171], v[56:59], v[36:39], 0
ds_read_b64_tr_b16 v[120:121], v11 offset:0
v_mfma_f32_16x16x32_bf16 v[140:143], v[52:55], v[36:39], v[140:143]
ds_read_b64_tr_b16 v[122:123], v11 offset:4096
v_mfma_f32_16x16x32_bf16 v[136:139], v[48:51], v[36:39], v[136:139]
ds_read_b64_tr_b16 v[124:125], v12 offset:0
v_mfma_f32_16x16x32_bf16 v[144:147], v[48:51], v[40:43], v[144:147]
ds_read_b64_tr_b16 v[126:127], v12 offset:4096
v_mfma_f32_16x16x32_bf16 v[148:151], v[52:55], v[40:43], v[148:151]
ds_read_b128 v[100:103], v8 offset:1024
v_mfma_f32_16x16x32_bf16 v[176:179], v[56:59], v[40:43], 0
ds_read_b128 v[104:107], v8 offset:2048
v_mfma_f32_16x16x32_bf16 v[180:183], v[60:63], v[40:43], 0
ds_read_b128 v[108:111], v8 offset:3072
v_mfma_f32_16x16x32_bf16 v[188:191], v[60:63], v[44:47], 0
ds_read_b128 v[192:195], v8 offset:8192
v_mfma_f32_16x16x32_bf16 v[184:187], v[56:59], v[44:47], 0
ds_read_b64_tr_b16 v[208:209], v9 offset:8192
v_mfma_f32_16x16x32_bf16 v[156:159], v[52:55], v[44:47], v[156:159]
ds_read_b64_tr_b16 v[210:211], v9 offset:12288
v_mfma_f32_16x16x32_bf16 v[152:155], v[48:51], v[44:47], v[152:155]
ds_read_b64_tr_b16 v[212:213], v10 offset:8192
v_mfma_f32_16x16x32_bf16 v[128:131], v[80:83], v[64:67], v[128:131]
ds_read_b64_tr_b16 v[214:215], v10 offset:12288
v_mfma_f32_16x16x32_bf16 v[132:135], v[84:87], v[64:67], v[132:135]
ds_read_b64_tr_b16 v[216:217], v11 offset:8192
v_mfma_f32_16x16x32_bf16 v[160:163], v[88:91], v[64:67], v[160:163]
ds_read_b64_tr_b16 v[218:219], v11 offset:12288
v_mfma_f32_16x16x32_bf16 v[164:167], v[92:95], v[64:67], v[164:167]
ds_read_b64_tr_b16 v[220:221], v12 offset:8192
v_mfma_f32_16x16x32_bf16 v[172:175], v[92:95], v[68:71], v[172:175]
ds_read_b64_tr_b16 v[222:223], v12 offset:12288
v_mfma_f32_16x16x32_bf16 v[168:171], v[88:91], v[68:71], v[168:171]
ds_read_b128 v[196:199], v8 offset:9216
v_mfma_f32_16x16x32_bf16 v[140:143], v[84:87], v[68:71], v[140:143]
ds_read_b128 v[200:203], v8 offset:10240
v_mfma_f32_16x16x32_bf16 v[136:139], v[80:83], v[68:71], v[136:139]
ds_read_b128 v[204:207], v8 offset:11264
v_mfma_f32_16x16x32_bf16 v[144:147], v[80:83], v[72:75], v[144:147]
v_mfma_f32_16x16x32_bf16 v[148:151], v[84:87], v[72:75], v[148:151]
v_mfma_f32_16x16x32_bf16 v[176:179], v[88:91], v[72:75], v[176:179]
v_mfma_f32_16x16x32_bf16 v[180:183], v[92:95], v[72:75], v[180:183]
v_mfma_f32_16x16x32_bf16 v[188:191], v[92:95], v[76:79], v[188:191]
v_mfma_f32_16x16x32_bf16 v[184:187], v[88:91], v[76:79], v[184:187]
v_mfma_f32_16x16x32_bf16 v[156:159], v[84:87], v[76:79], v[156:159]
v_mfma_f32_16x16x32_bf16 v[152:155], v[80:83], v[76:79], v[152:155]
s_waitcnt vmcnt(8)
s_waitcnt lgkmcnt(0)
s_barrier
v_mfma_f32_16x16x32_bf16 v[128:131], v[112:115], v[96:99], v[128:131]
ds_read_b128 v[32:35], v6 offset:16384
v_mfma_f32_16x16x32_bf16 v[132:135], v[116:119], v[96:99], v[132:135]
ds_read_b64_tr_b16 v[48:49], v9 offset:32768
v_mfma_f32_16x16x32_bf16 v[160:163], v[120:123], v[96:99], v[160:163]
ds_read_b64_tr_b16 v[50:51], v9 offset:36864
v_mfma_f32_16x16x32_bf16 v[164:167], v[124:127], v[96:99], v[164:167]
ds_read_b64_tr_b16 v[52:53], v10 offset:32768
v_mfma_f32_16x16x32_bf16 v[172:175], v[124:127], v[100:103], v[172:175]
ds_read_b64_tr_b16 v[54:55], v10 offset:36864
v_mfma_f32_16x16x32_bf16 v[168:171], v[120:123], v[100:103], v[168:171]
ds_read_b64_tr_b16 v[56:57], v11 offset:32768
v_mfma_f32_16x16x32_bf16 v[140:143], v[116:119], v[100:103], v[140:143]
ds_read_b64_tr_b16 v[58:59], v11 offset:36864
v_mfma_f32_16x16x32_bf16 v[136:139], v[112:115], v[100:103], v[136:139]
ds_read_b64_tr_b16 v[60:61], v12 offset:32768
v_mfma_f32_16x16x32_bf16 v[144:147], v[112:115], v[104:107], v[144:147]
ds_read_b64_tr_b16 v[62:63], v12 offset:36864
v_mfma_f32_16x16x32_bf16 v[148:151], v[116:119], v[104:107], v[148:151]
ds_read_b128 v[36:39], v6 offset:17408
v_mfma_f32_16x16x32_bf16 v[176:179], v[120:123], v[104:107], v[176:179]
ds_read_b128 v[40:43], v6 offset:18432
v_mfma_f32_16x16x32_bf16 v[180:183], v[124:127], v[104:107], v[180:183]
ds_read_b128 v[44:47], v6 offset:19456
v_mfma_f32_16x16x32_bf16 v[188:191], v[124:127], v[108:111], v[188:191]
ds_read_b128 v[64:67], v6 offset:24576
v_mfma_f32_16x16x32_bf16 v[184:187], v[120:123], v[108:111], v[184:187]
ds_read_b64_tr_b16 v[80:81], v9 offset:40960
v_mfma_f32_16x16x32_bf16 v[156:159], v[116:119], v[108:111], v[156:159]
ds_read_b64_tr_b16 v[82:83], v9 offset:45056
v_mfma_f32_16x16x32_bf16 v[152:155], v[112:115], v[108:111], v[152:155]
ds_read_b64_tr_b16 v[84:85], v10 offset:40960
v_mfma_f32_16x16x32_bf16 v[128:131], v[208:211], v[192:195], v[128:131]
ds_read_b64_tr_b16 v[86:87], v10 offset:45056
v_mfma_f32_16x16x32_bf16 v[132:135], v[212:215], v[192:195], v[132:135]
ds_read_b64_tr_b16 v[88:89], v11 offset:40960
v_mfma_f32_16x16x32_bf16 v[160:163], v[216:219], v[192:195], v[160:163]
ds_read_b64_tr_b16 v[90:91], v11 offset:45056
v_mfma_f32_16x16x32_bf16 v[164:167], v[220:223], v[192:195], v[164:167]
ds_read_b64_tr_b16 v[92:93], v12 offset:40960
v_mfma_f32_16x16x32_bf16 v[172:175], v[220:223], v[196:199], v[172:175]
ds_read_b64_tr_b16 v[94:95], v12 offset:45056
v_mfma_f32_16x16x32_bf16 v[168:171], v[216:219], v[196:199], v[168:171]
ds_read_b128 v[68:71], v6 offset:25600
v_mfma_f32_16x16x32_bf16 v[140:143], v[212:215], v[196:199], v[140:143]
ds_read_b128 v[72:75], v6 offset:26624
v_mfma_f32_16x16x32_bf16 v[136:139], v[208:211], v[196:199], v[136:139]
ds_read_b128 v[76:79], v6 offset:27648
v_mfma_f32_16x16x32_bf16 v[144:147], v[208:211], v[200:203], v[144:147]
v_mfma_f32_16x16x32_bf16 v[148:151], v[212:215], v[200:203], v[148:151]
v_mfma_f32_16x16x32_bf16 v[176:179], v[216:219], v[200:203], v[176:179]
v_mfma_f32_16x16x32_bf16 v[180:183], v[220:223], v[200:203], v[180:183]
v_mfma_f32_16x16x32_bf16 v[188:191], v[220:223], v[204:207], v[188:191]
v_mfma_f32_16x16x32_bf16 v[184:187], v[216:219], v[204:207], v[184:187]
v_mfma_f32_16x16x32_bf16 v[156:159], v[212:215], v[204:207], v[156:159]
v_mfma_f32_16x16x32_bf16 v[152:155], v[208:211], v[204:207], v[152:155]
s_waitcnt vmcnt(0)
s_waitcnt lgkmcnt(0)
s_barrier
v_mfma_f32_16x16x32_bf16 v[128:131], v[48:51], v[32:35], v[128:131]
ds_read_b128 v[96:99], v6 offset:49152
v_mfma_f32_16x16x32_bf16 v[132:135], v[52:55], v[32:35], v[132:135]
ds_read_b64_tr_b16 v[112:113], v13 offset:0
v_mfma_f32_16x16x32_bf16 v[160:163], v[56:59], v[32:35], v[160:163]
ds_read_b64_tr_b16 v[114:115], v13 offset:4096
v_mfma_f32_16x16x32_bf16 v[164:167], v[60:63], v[32:35], v[164:167]
ds_read_b64_tr_b16 v[116:117], v14 offset:0
v_mfma_f32_16x16x32_bf16 v[172:175], v[60:63], v[36:39], v[172:175]
ds_read_b64_tr_b16 v[118:119], v14 offset:4096
v_mfma_f32_16x16x32_bf16 v[168:171], v[56:59], v[36:39], v[168:171]
ds_read_b64_tr_b16 v[120:121], v15 offset:0
v_mfma_f32_16x16x32_bf16 v[140:143], v[52:55], v[36:39], v[140:143]
ds_read_b64_tr_b16 v[122:123], v15 offset:4096
v_mfma_f32_16x16x32_bf16 v[136:139], v[48:51], v[36:39], v[136:139]
ds_read_b64_tr_b16 v[124:125], v16 offset:0
v_mfma_f32_16x16x32_bf16 v[144:147], v[48:51], v[40:43], v[144:147]
ds_read_b64_tr_b16 v[126:127], v16 offset:4096
v_mfma_f32_16x16x32_bf16 v[148:151], v[52:55], v[40:43], v[148:151]
ds_read_b128 v[100:103], v6 offset:50176
v_mfma_f32_16x16x32_bf16 v[176:179], v[56:59], v[40:43], v[176:179]
ds_read_b128 v[104:107], v6 offset:51200
v_mfma_f32_16x16x32_bf16 v[180:183], v[60:63], v[40:43], v[180:183]
ds_read_b128 v[108:111], v6 offset:52224
v_mfma_f32_16x16x32_bf16 v[188:191], v[60:63], v[44:47], v[188:191]
ds_read_b128 v[192:195], v6 offset:57344
v_mfma_f32_16x16x32_bf16 v[184:187], v[56:59], v[44:47], v[184:187]
ds_read_b64_tr_b16 v[208:209], v13 offset:8192
v_mfma_f32_16x16x32_bf16 v[156:159], v[52:55], v[44:47], v[156:159]
ds_read_b64_tr_b16 v[210:211], v13 offset:12288
v_mfma_f32_16x16x32_bf16 v[152:155], v[48:51], v[44:47], v[152:155]
ds_read_b64_tr_b16 v[212:213], v14 offset:8192
v_mfma_f32_16x16x32_bf16 v[128:131], v[80:83], v[64:67], v[128:131]
ds_read_b64_tr_b16 v[214:215], v14 offset:12288
v_mfma_f32_16x16x32_bf16 v[132:135], v[84:87], v[64:67], v[132:135]
ds_read_b64_tr_b16 v[216:217], v15 offset:8192
v_mfma_f32_16x16x32_bf16 v[160:163], v[88:91], v[64:67], v[160:163]
ds_read_b64_tr_b16 v[218:219], v15 offset:12288
v_mfma_f32_16x16x32_bf16 v[164:167], v[92:95], v[64:67], v[164:167]
ds_read_b64_tr_b16 v[220:221], v16 offset:8192
v_mfma_f32_16x16x32_bf16 v[172:175], v[92:95], v[68:71], v[172:175]
ds_read_b64_tr_b16 v[222:223], v16 offset:12288
v_mfma_f32_16x16x32_bf16 v[168:171], v[88:91], v[68:71], v[168:171]
ds_read_b128 v[196:199], v6 offset:58368
v_mfma_f32_16x16x32_bf16 v[140:143], v[84:87], v[68:71], v[140:143]
ds_read_b128 v[200:203], v6 offset:59392
v_mfma_f32_16x16x32_bf16 v[136:139], v[80:83], v[68:71], v[136:139]
ds_read_b128 v[204:207], v6 offset:60416
v_mfma_f32_16x16x32_bf16 v[144:147], v[80:83], v[72:75], v[144:147]
v_mfma_f32_16x16x32_bf16 v[148:151], v[84:87], v[72:75], v[148:151]
v_mfma_f32_16x16x32_bf16 v[176:179], v[88:91], v[72:75], v[176:179]
v_mfma_f32_16x16x32_bf16 v[180:183], v[92:95], v[72:75], v[180:183]
v_mfma_f32_16x16x32_bf16 v[188:191], v[92:95], v[76:79], v[188:191]
v_mfma_f32_16x16x32_bf16 v[184:187], v[88:91], v[76:79], v[184:187]
v_mfma_f32_16x16x32_bf16 v[156:159], v[84:87], v[76:79], v[156:159]
v_mfma_f32_16x16x32_bf16 v[152:155], v[80:83], v[76:79], v[152:155]
s_waitcnt lgkmcnt(0)
s_barrier
v_mfma_f32_16x16x32_bf16 v[128:131], v[112:115], v[96:99], v[128:131]
ds_read_b128 v[32:35], v7 offset:16384
v_mfma_f32_16x16x32_bf16 v[132:135], v[116:119], v[96:99], v[132:135]
ds_read_b64_tr_b16 v[48:49], v25 offset:16384
v_mfma_f32_16x16x32_bf16 v[160:163], v[120:123], v[96:99], v[160:163]
ds_read_b64_tr_b16 v[50:51], v25 offset:20480
v_mfma_f32_16x16x32_bf16 v[164:167], v[124:127], v[96:99], v[164:167]
ds_read_b64_tr_b16 v[52:53], v26 offset:16384
v_mfma_f32_16x16x32_bf16 v[172:175], v[124:127], v[100:103], v[172:175]
ds_read_b64_tr_b16 v[54:55], v26 offset:20480
v_mfma_f32_16x16x32_bf16 v[168:171], v[120:123], v[100:103], v[168:171]
ds_read_b64_tr_b16 v[56:57], v27 offset:16384
v_mfma_f32_16x16x32_bf16 v[140:143], v[116:119], v[100:103], v[140:143]
ds_read_b64_tr_b16 v[58:59], v27 offset:20480
v_mfma_f32_16x16x32_bf16 v[136:139], v[112:115], v[100:103], v[136:139]
ds_read_b64_tr_b16 v[60:61], v28 offset:16384
v_mfma_f32_16x16x32_bf16 v[144:147], v[112:115], v[104:107], v[144:147]
ds_read_b64_tr_b16 v[62:63], v28 offset:20480
v_mfma_f32_16x16x32_bf16 v[148:151], v[116:119], v[104:107], v[148:151]
ds_read_b128 v[36:39], v7 offset:17408
v_mfma_f32_16x16x32_bf16 v[176:179], v[120:123], v[104:107], v[176:179]
ds_read_b128 v[40:43], v7 offset:18432
v_mfma_f32_16x16x32_bf16 v[180:183], v[124:127], v[104:107], v[180:183]
ds_read_b128 v[44:47], v7 offset:19456
v_mfma_f32_16x16x32_bf16 v[188:191], v[124:127], v[108:111], v[188:191]
ds_read_b128 v[64:67], v7 offset:24576
v_mfma_f32_16x16x32_bf16 v[184:187], v[120:123], v[108:111], v[184:187]
ds_read_b64_tr_b16 v[80:81], v25 offset:24576
v_mfma_f32_16x16x32_bf16 v[156:159], v[116:119], v[108:111], v[156:159]
ds_read_b64_tr_b16 v[82:83], v25 offset:28672
v_mfma_f32_16x16x32_bf16 v[152:155], v[112:115], v[108:111], v[152:155]
ds_read_b64_tr_b16 v[84:85], v26 offset:24576
v_mfma_f32_16x16x32_bf16 v[128:131], v[208:211], v[192:195], v[128:131]
ds_read_b64_tr_b16 v[86:87], v26 offset:28672
v_mfma_f32_16x16x32_bf16 v[132:135], v[212:215], v[192:195], v[132:135]
ds_read_b64_tr_b16 v[88:89], v27 offset:24576
v_mfma_f32_16x16x32_bf16 v[160:163], v[216:219], v[192:195], v[160:163]
ds_read_b64_tr_b16 v[90:91], v27 offset:28672
v_mfma_f32_16x16x32_bf16 v[164:167], v[220:223], v[192:195], v[164:167]
ds_read_b64_tr_b16 v[92:93], v28 offset:24576
v_mfma_f32_16x16x32_bf16 v[172:175], v[220:223], v[196:199], v[172:175]
ds_read_b64_tr_b16 v[94:95], v28 offset:28672
v_mfma_f32_16x16x32_bf16 v[168:171], v[216:219], v[196:199], v[168:171]
ds_read_b128 v[68:71], v7 offset:25600
v_mfma_f32_16x16x32_bf16 v[140:143], v[212:215], v[196:199], v[140:143]
ds_read_b128 v[72:75], v7 offset:26624
v_mfma_f32_16x16x32_bf16 v[136:139], v[208:211], v[196:199], v[136:139]
ds_read_b128 v[76:79], v7 offset:27648
v_mfma_f32_16x16x32_bf16 v[144:147], v[208:211], v[200:203], v[144:147]
v_mfma_f32_16x16x32_bf16 v[148:151], v[212:215], v[200:203], v[148:151]
v_mfma_f32_16x16x32_bf16 v[176:179], v[216:219], v[200:203], v[176:179]
v_mfma_f32_16x16x32_bf16 v[180:183], v[220:223], v[200:203], v[180:183]
v_mfma_f32_16x16x32_bf16 v[188:191], v[220:223], v[204:207], v[188:191]
v_mfma_f32_16x16x32_bf16 v[184:187], v[216:219], v[204:207], v[184:187]
v_mfma_f32_16x16x32_bf16 v[156:159], v[212:215], v[204:207], v[156:159]
v_mfma_f32_16x16x32_bf16 v[152:155], v[208:211], v[204:207], v[152:155]
s_waitcnt lgkmcnt(0)
s_barrier
v_mfma_f32_16x16x32_bf16 v[128:131], v[48:51], v[32:35], v[128:131]
ds_read_b128 v[96:99], v7 offset:32768
v_mfma_f32_16x16x32_bf16 v[132:135], v[52:55], v[32:35], v[132:135]
ds_read_b64_tr_b16 v[112:113], v13 offset:49152
v_mfma_f32_16x16x32_bf16 v[160:163], v[56:59], v[32:35], v[160:163]
ds_read_b64_tr_b16 v[114:115], v13 offset:53248
v_mfma_f32_16x16x32_bf16 v[164:167], v[60:63], v[32:35], v[164:167]
ds_read_b64_tr_b16 v[116:117], v14 offset:49152
v_mfma_f32_16x16x32_bf16 v[172:175], v[60:63], v[36:39], v[172:175]
ds_read_b64_tr_b16 v[118:119], v14 offset:53248
v_mfma_f32_16x16x32_bf16 v[168:171], v[56:59], v[36:39], v[168:171]
ds_read_b64_tr_b16 v[120:121], v15 offset:49152
v_mfma_f32_16x16x32_bf16 v[140:143], v[52:55], v[36:39], v[140:143]
ds_read_b64_tr_b16 v[122:123], v15 offset:53248
v_mfma_f32_16x16x32_bf16 v[136:139], v[48:51], v[36:39], v[136:139]
ds_read_b64_tr_b16 v[124:125], v16 offset:49152
v_mfma_f32_16x16x32_bf16 v[144:147], v[48:51], v[40:43], v[144:147]
ds_read_b64_tr_b16 v[126:127], v16 offset:53248
v_mfma_f32_16x16x32_bf16 v[148:151], v[52:55], v[40:43], v[148:151]
ds_read_b128 v[100:103], v7 offset:33792
v_mfma_f32_16x16x32_bf16 v[176:179], v[56:59], v[40:43], v[176:179]
ds_read_b128 v[104:107], v7 offset:34816
v_mfma_f32_16x16x32_bf16 v[180:183], v[60:63], v[40:43], v[180:183]
ds_read_b128 v[108:111], v7 offset:35840
v_mfma_f32_16x16x32_bf16 v[188:191], v[60:63], v[44:47], v[188:191]
ds_read_b128 v[192:195], v7 offset:40960
v_mfma_f32_16x16x32_bf16 v[184:187], v[56:59], v[44:47], v[184:187]
ds_read_b64_tr_b16 v[208:209], v13 offset:57344
v_mfma_f32_16x16x32_bf16 v[156:159], v[52:55], v[44:47], v[156:159]
ds_read_b64_tr_b16 v[210:211], v13 offset:61440
v_mfma_f32_16x16x32_bf16 v[152:155], v[48:51], v[44:47], v[152:155]
ds_read_b64_tr_b16 v[212:213], v14 offset:57344
v_mfma_f32_16x16x32_bf16 v[128:131], v[80:83], v[64:67], v[128:131]
ds_read_b64_tr_b16 v[214:215], v14 offset:61440
v_mfma_f32_16x16x32_bf16 v[132:135], v[84:87], v[64:67], v[132:135]
ds_read_b64_tr_b16 v[216:217], v15 offset:57344
v_mfma_f32_16x16x32_bf16 v[160:163], v[88:91], v[64:67], v[160:163]
ds_read_b64_tr_b16 v[218:219], v15 offset:61440
v_mfma_f32_16x16x32_bf16 v[164:167], v[92:95], v[64:67], v[164:167]
ds_read_b64_tr_b16 v[220:221], v16 offset:57344
v_mfma_f32_16x16x32_bf16 v[172:175], v[92:95], v[68:71], v[172:175]
ds_read_b64_tr_b16 v[222:223], v16 offset:61440
v_mfma_f32_16x16x32_bf16 v[168:171], v[88:91], v[68:71], v[168:171]
ds_read_b128 v[196:199], v7 offset:41984
v_mfma_f32_16x16x32_bf16 v[140:143], v[84:87], v[68:71], v[140:143]
ds_read_b128 v[200:203], v7 offset:43008
v_mfma_f32_16x16x32_bf16 v[136:139], v[80:83], v[68:71], v[136:139]
ds_read_b128 v[204:207], v7 offset:44032
v_mfma_f32_16x16x32_bf16 v[144:147], v[80:83], v[72:75], v[144:147]
v_mfma_f32_16x16x32_bf16 v[148:151], v[84:87], v[72:75], v[148:151]
v_mfma_f32_16x16x32_bf16 v[176:179], v[88:91], v[72:75], v[176:179]
v_mfma_f32_16x16x32_bf16 v[180:183], v[92:95], v[72:75], v[180:183]
v_mfma_f32_16x16x32_bf16 v[188:191], v[92:95], v[76:79], v[188:191]
v_mfma_f32_16x16x32_bf16 v[184:187], v[88:91], v[76:79], v[184:187]
v_mfma_f32_16x16x32_bf16 v[156:159], v[84:87], v[76:79], v[156:159]
v_mfma_f32_16x16x32_bf16 v[152:155], v[80:83], v[76:79], v[152:155]
s_waitcnt lgkmcnt(0)
s_barrier
v_mfma_f32_16x16x32_bf16 v[128:131], v[112:115], v[96:99], v[128:131]
ds_read_b128 v[32:35], v8 offset:0
v_mfma_f32_16x16x32_bf16 v[132:135], v[116:119], v[96:99], v[132:135]
ds_read_b64_tr_b16 v[48:49], v9 offset:0
v_mfma_f32_16x16x32_bf16 v[160:163], v[120:123], v[96:99], v[160:163]
ds_read_b64_tr_b16 v[50:51], v9 offset:4096
v_mfma_f32_16x16x32_bf16 v[164:167], v[124:127], v[96:99], v[164:167]
ds_read_b64_tr_b16 v[52:53], v10 offset:0
v_mfma_f32_16x16x32_bf16 v[172:175], v[124:127], v[100:103], v[172:175]
ds_read_b64_tr_b16 v[54:55], v10 offset:4096
v_mfma_f32_16x16x32_bf16 v[168:171], v[120:123], v[100:103], v[168:171]
ds_read_b64_tr_b16 v[56:57], v11 offset:0
v_mfma_f32_16x16x32_bf16 v[140:143], v[116:119], v[100:103], v[140:143]
ds_read_b64_tr_b16 v[58:59], v11 offset:4096
v_mfma_f32_16x16x32_bf16 v[136:139], v[112:115], v[100:103], v[136:139]
ds_read_b64_tr_b16 v[60:61], v12 offset:0
v_mfma_f32_16x16x32_bf16 v[144:147], v[112:115], v[104:107], v[144:147]
ds_read_b64_tr_b16 v[62:63], v12 offset:4096
v_mfma_f32_16x16x32_bf16 v[148:151], v[116:119], v[104:107], v[148:151]
ds_read_b128 v[36:39], v8 offset:1024
v_mfma_f32_16x16x32_bf16 v[176:179], v[120:123], v[104:107], v[176:179]
ds_read_b128 v[40:43], v8 offset:2048
v_mfma_f32_16x16x32_bf16 v[180:183], v[124:127], v[104:107], v[180:183]
ds_read_b128 v[44:47], v8 offset:3072
v_mfma_f32_16x16x32_bf16 v[188:191], v[124:127], v[108:111], v[188:191]
ds_read_b128 v[64:67], v8 offset:8192
v_mfma_f32_16x16x32_bf16 v[184:187], v[120:123], v[108:111], v[184:187]
ds_read_b64_tr_b16 v[80:81], v9 offset:8192
v_mfma_f32_16x16x32_bf16 v[156:159], v[116:119], v[108:111], v[156:159]
ds_read_b64_tr_b16 v[82:83], v9 offset:12288
v_mfma_f32_16x16x32_bf16 v[152:155], v[112:115], v[108:111], v[152:155]
ds_read_b64_tr_b16 v[84:85], v10 offset:8192
v_mfma_f32_16x16x32_bf16 v[128:131], v[208:211], v[192:195], v[128:131]
ds_read_b64_tr_b16 v[86:87], v10 offset:12288
v_mfma_f32_16x16x32_bf16 v[132:135], v[212:215], v[192:195], v[132:135]
ds_read_b64_tr_b16 v[88:89], v11 offset:8192
v_mfma_f32_16x16x32_bf16 v[160:163], v[216:219], v[192:195], v[160:163]
ds_read_b64_tr_b16 v[90:91], v11 offset:12288
v_mfma_f32_16x16x32_bf16 v[164:167], v[220:223], v[192:195], v[164:167]
ds_read_b64_tr_b16 v[92:93], v12 offset:8192
v_mfma_f32_16x16x32_bf16 v[172:175], v[220:223], v[196:199], v[172:175]
ds_read_b64_tr_b16 v[94:95], v12 offset:12288
v_mfma_f32_16x16x32_bf16 v[168:171], v[216:219], v[196:199], v[168:171]
ds_read_b128 v[68:71], v8 offset:9216
v_mfma_f32_16x16x32_bf16 v[140:143], v[212:215], v[196:199], v[140:143]
ds_read_b128 v[72:75], v8 offset:10240
v_mfma_f32_16x16x32_bf16 v[136:139], v[208:211], v[196:199], v[136:139]
ds_read_b128 v[76:79], v8 offset:11264
v_mfma_f32_16x16x32_bf16 v[144:147], v[208:211], v[200:203], v[144:147]
v_mfma_f32_16x16x32_bf16 v[148:151], v[212:215], v[200:203], v[148:151]
v_mfma_f32_16x16x32_bf16 v[176:179], v[216:219], v[200:203], v[176:179]
v_mfma_f32_16x16x32_bf16 v[180:183], v[220:223], v[200:203], v[180:183]
v_mfma_f32_16x16x32_bf16 v[188:191], v[220:223], v[204:207], v[188:191]
v_mfma_f32_16x16x32_bf16 v[184:187], v[216:219], v[204:207], v[184:187]
v_mfma_f32_16x16x32_bf16 v[156:159], v[212:215], v[204:207], v[156:159]
v_mfma_f32_16x16x32_bf16 v[152:155], v[208:211], v[204:207], v[152:155]
s_waitcnt lgkmcnt(0)
s_barrier
v_mfma_f32_16x16x32_bf16 v[128:131], v[48:51], v[32:35], v[128:131]
ds_read_b128 v[96:99], v6 offset:16384
v_mfma_f32_16x16x32_bf16 v[132:135], v[52:55], v[32:35], v[132:135]
ds_read_b64_tr_b16 v[112:113], v9 offset:32768
v_mfma_f32_16x16x32_bf16 v[160:163], v[56:59], v[32:35], v[160:163]
ds_read_b64_tr_b16 v[114:115], v9 offset:36864
v_mfma_f32_16x16x32_bf16 v[164:167], v[60:63], v[32:35], v[164:167]
ds_read_b64_tr_b16 v[116:117], v10 offset:32768
v_mfma_f32_16x16x32_bf16 v[172:175], v[60:63], v[36:39], v[172:175]
ds_read_b64_tr_b16 v[118:119], v10 offset:36864
v_mfma_f32_16x16x32_bf16 v[168:171], v[56:59], v[36:39], v[168:171]
ds_read_b64_tr_b16 v[120:121], v11 offset:32768
v_mfma_f32_16x16x32_bf16 v[140:143], v[52:55], v[36:39], v[140:143]
ds_read_b64_tr_b16 v[122:123], v11 offset:36864
v_mfma_f32_16x16x32_bf16 v[136:139], v[48:51], v[36:39], v[136:139]
ds_read_b64_tr_b16 v[124:125], v12 offset:32768
v_mfma_f32_16x16x32_bf16 v[144:147], v[48:51], v[40:43], v[144:147]
s_branch Lov_13
.p2align 12
Lst_13_0:
s_branch Lst_17_0
Lst_13_1:
s_branch Lst_17_1
Lov_13:
ds_read_b64_tr_b16 v[126:127], v12 offset:36864
v_mfma_f32_16x16x32_bf16 v[148:151], v[52:55], v[40:43], v[148:151]
ds_read_b128 v[100:103], v6 offset:17408
v_mfma_f32_16x16x32_bf16 v[176:179], v[56:59], v[40:43], v[176:179]
ds_read_b128 v[104:107], v6 offset:18432
v_mfma_f32_16x16x32_bf16 v[180:183], v[60:63], v[40:43], v[180:183]
ds_read_b128 v[108:111], v6 offset:19456
v_mfma_f32_16x16x32_bf16 v[188:191], v[60:63], v[44:47], v[188:191]
ds_read_b128 v[192:195], v6 offset:24576
v_mfma_f32_16x16x32_bf16 v[184:187], v[56:59], v[44:47], v[184:187]
ds_read_b64_tr_b16 v[208:209], v9 offset:40960
v_mfma_f32_16x16x32_bf16 v[156:159], v[52:55], v[44:47], v[156:159]
ds_read_b64_tr_b16 v[210:211], v9 offset:45056
v_mfma_f32_16x16x32_bf16 v[152:155], v[48:51], v[44:47], v[152:155]
ds_read_b64_tr_b16 v[212:213], v10 offset:40960
v_mfma_f32_16x16x32_bf16 v[128:131], v[80:83], v[64:67], v[128:131]
ds_read_b64_tr_b16 v[214:215], v10 offset:45056
v_mfma_f32_16x16x32_bf16 v[132:135], v[84:87], v[64:67], v[132:135]
ds_read_b64_tr_b16 v[216:217], v11 offset:40960
v_mfma_f32_16x16x32_bf16 v[160:163], v[88:91], v[64:67], v[160:163]
ds_read_b64_tr_b16 v[218:219], v11 offset:45056
v_mfma_f32_16x16x32_bf16 v[164:167], v[92:95], v[64:67], v[164:167]
ds_read_b64_tr_b16 v[220:221], v12 offset:40960
v_mfma_f32_16x16x32_bf16 v[172:175], v[92:95], v[68:71], v[172:175]
ds_read_b64_tr_b16 v[222:223], v12 offset:45056
v_mfma_f32_16x16x32_bf16 v[168:171], v[88:91], v[68:71], v[168:171]
ds_read_b128 v[196:199], v6 offset:25600
v_mfma_f32_16x16x32_bf16 v[140:143], v[84:87], v[68:71], v[140:143]
ds_read_b128 v[200:203], v6 offset:26624
v_mfma_f32_16x16x32_bf16 v[136:139], v[80:83], v[68:71], v[136:139]
ds_read_b128 v[204:207], v6 offset:27648
v_mfma_f32_16x16x32_bf16 v[144:147], v[80:83], v[72:75], v[144:147]
v_mfma_f32_16x16x32_bf16 v[148:151], v[84:87], v[72:75], v[148:151]
v_mfma_f32_16x16x32_bf16 v[176:179], v[88:91], v[72:75], v[176:179]
v_mfma_f32_16x16x32_bf16 v[180:183], v[92:95], v[72:75], v[180:183]
v_mfma_f32_16x16x32_bf16 v[188:191], v[92:95], v[76:79], v[188:191]
v_mfma_f32_16x16x32_bf16 v[184:187], v[88:91], v[76:79], v[184:187]
v_mfma_f32_16x16x32_bf16 v[156:159], v[84:87], v[76:79], v[156:159]
v_mfma_f32_16x16x32_bf16 v[152:155], v[80:83], v[76:79], v[152:155]
s_waitcnt lgkmcnt(0)
s_barrier
v_mfma_f32_16x16x32_bf16 v[128:131], v[112:115], v[96:99], v[128:131]
ds_read_b128 v[32:35], v6 offset:49152
v_mfma_f32_16x16x32_bf16 v[132:135], v[116:119], v[96:99], v[132:135]
ds_read_b64_tr_b16 v[48:49], v13 offset:0
v_mfma_f32_16x16x32_bf16 v[160:163], v[120:123], v[96:99], v[160:163]
ds_read_b64_tr_b16 v[50:51], v13 offset:4096
v_mfma_f32_16x16x32_bf16 v[164:167], v[124:127], v[96:99], v[164:167]
ds_read_b64_tr_b16 v[52:53], v14 offset:0
v_mfma_f32_16x16x32_bf16 v[172:175], v[124:127], v[100:103], v[172:175]
ds_read_b64_tr_b16 v[54:55], v14 offset:4096
v_mfma_f32_16x16x32_bf16 v[168:171], v[120:123], v[100:103], v[168:171]
ds_read_b64_tr_b16 v[56:57], v15 offset:0
v_mfma_f32_16x16x32_bf16 v[140:143], v[116:119], v[100:103], v[140:143]
ds_read_b64_tr_b16 v[58:59], v15 offset:4096
v_mfma_f32_16x16x32_bf16 v[136:139], v[112:115], v[100:103], v[136:139]
ds_read_b64_tr_b16 v[60:61], v16 offset:0
v_mfma_f32_16x16x32_bf16 v[144:147], v[112:115], v[104:107], v[144:147]
ds_read_b64_tr_b16 v[62:63], v16 offset:4096
v_mfma_f32_16x16x32_bf16 v[148:151], v[116:119], v[104:107], v[148:151]
ds_read_b128 v[36:39], v6 offset:50176
v_mfma_f32_16x16x32_bf16 v[176:179], v[120:123], v[104:107], v[176:179]
ds_read_b128 v[40:43], v6 offset:51200
v_mfma_f32_16x16x32_bf16 v[180:183], v[124:127], v[104:107], v[180:183]
ds_read_b128 v[44:47], v6 offset:52224
v_mfma_f32_16x16x32_bf16 v[188:191], v[124:127], v[108:111], v[188:191]
ds_read_b128 v[64:67], v6 offset:57344
v_mfma_f32_16x16x32_bf16 v[184:187], v[120:123], v[108:111], v[184:187]
ds_read_b64_tr_b16 v[80:81], v13 offset:8192
v_mfma_f32_16x16x32_bf16 v[156:159], v[116:119], v[108:111], v[156:159]
ds_read_b64_tr_b16 v[82:83], v13 offset:12288
v_mfma_f32_16x16x32_bf16 v[152:155], v[112:115], v[108:111], v[152:155]
ds_read_b64_tr_b16 v[84:85], v14 offset:8192
v_mfma_f32_16x16x32_bf16 v[128:131], v[208:211], v[192:195], v[128:131]
ds_read_b64_tr_b16 v[86:87], v14 offset:12288
v_mfma_f32_16x16x32_bf16 v[132:135], v[212:215], v[192:195], v[132:135]
ds_read_b64_tr_b16 v[88:89], v15 offset:8192
v_mfma_f32_16x16x32_bf16 v[160:163], v[216:219], v[192:195], v[160:163]
ds_read_b64_tr_b16 v[90:91], v15 offset:12288
v_mfma_f32_16x16x32_bf16 v[164:167], v[220:223], v[192:195], v[164:167]
ds_read_b64_tr_b16 v[92:93], v16 offset:8192
v_mfma_f32_16x16x32_bf16 v[172:175], v[220:223], v[196:199], v[172:175]
ds_read_b64_tr_b16 v[94:95], v16 offset:12288
v_mfma_f32_16x16x32_bf16 v[168:171], v[216:219], v[196:199], v[168:171]
ds_read_b128 v[68:71], v6 offset:58368
v_mfma_f32_16x16x32_bf16 v[140:143], v[212:215], v[196:199], v[140:143]
ds_read_b128 v[72:75], v6 offset:59392
v_mfma_f32_16x16x32_bf16 v[136:139], v[208:211], v[196:199], v[136:139]
ds_read_b128 v[76:79], v6 offset:60416
v_mfma_f32_16x16x32_bf16 v[144:147], v[208:211], v[200:203], v[144:147]
v_mfma_f32_16x16x32_bf16 v[148:151], v[212:215], v[200:203], v[148:151]
v_mfma_f32_16x16x32_bf16 v[176:179], v[216:219], v[200:203], v[176:179]
v_mfma_f32_16x16x32_bf16 v[180:183], v[220:223], v[200:203], v[180:183]
v_mfma_f32_16x16x32_bf16 v[188:191], v[220:223], v[204:207], v[188:191]
v_mfma_f32_16x16x32_bf16 v[184:187], v[216:219], v[204:207], v[184:187]
v_mfma_f32_16x16x32_bf16 v[156:159], v[212:215], v[204:207], v[156:159]
v_mfma_f32_16x16x32_bf16 v[152:155], v[208:211], v[204:207], v[152:155]
s_waitcnt lgkmcnt(0)
s_barrier
v_mfma_f32_16x16x32_bf16 v[128:131], v[48:51], v[32:35], v[128:131]
ds_read_b128 v[96:99], v7 offset:16384
v_mfma_f32_16x16x32_bf16 v[132:135], v[52:55], v[32:35], v[132:135]
ds_read_b64_tr_b16 v[112:113], v25 offset:16384
v_mfma_f32_16x16x32_bf16 v[160:163], v[56:59], v[32:35], v[160:163]
ds_read_b64_tr_b16 v[114:115], v25 offset:20480
v_mfma_f32_16x16x32_bf16 v[164:167], v[60:63], v[32:35], v[164:167]
ds_read_b64_tr_b16 v[116:117], v26 offset:16384
v_mfma_f32_16x16x32_bf16 v[172:175], v[60:63], v[36:39], v[172:175]
ds_read_b64_tr_b16 v[118:119], v26 offset:20480
v_mfma_f32_16x16x32_bf16 v[168:171], v[56:59], v[36:39], v[168:171]
ds_read_b64_tr_b16 v[120:121], v27 offset:16384
v_mfma_f32_16x16x32_bf16 v[140:143], v[52:55], v[36:39], v[140:143]
ds_read_b64_tr_b16 v[122:123], v27 offset:20480
v_mfma_f32_16x16x32_bf16 v[136:139], v[48:51], v[36:39], v[136:139]
ds_read_b64_tr_b16 v[124:125], v28 offset:16384
v_mfma_f32_16x16x32_bf16 v[144:147], v[48:51], v[40:43], v[144:147]
ds_read_b64_tr_b16 v[126:127], v28 offset:20480
v_mfma_f32_16x16x32_bf16 v[148:151], v[52:55], v[40:43], v[148:151]
ds_read_b128 v[100:103], v7 offset:17408
v_mfma_f32_16x16x32_bf16 v[176:179], v[56:59], v[40:43], v[176:179]
ds_read_b128 v[104:107], v7 offset:18432
v_mfma_f32_16x16x32_bf16 v[180:183], v[60:63], v[40:43], v[180:183]
ds_read_b128 v[108:111], v7 offset:19456
v_mfma_f32_16x16x32_bf16 v[188:191], v[60:63], v[44:47], v[188:191]
ds_read_b128 v[192:195], v7 offset:24576
v_mfma_f32_16x16x32_bf16 v[184:187], v[56:59], v[44:47], v[184:187]
ds_read_b64_tr_b16 v[208:209], v25 offset:24576
v_mfma_f32_16x16x32_bf16 v[156:159], v[52:55], v[44:47], v[156:159]
ds_read_b64_tr_b16 v[210:211], v25 offset:28672
v_mfma_f32_16x16x32_bf16 v[152:155], v[48:51], v[44:47], v[152:155]
ds_read_b64_tr_b16 v[212:213], v26 offset:24576
v_mfma_f32_16x16x32_bf16 v[128:131], v[80:83], v[64:67], v[128:131]
ds_read_b64_tr_b16 v[214:215], v26 offset:28672
v_mfma_f32_16x16x32_bf16 v[132:135], v[84:87], v[64:67], v[132:135]
ds_read_b64_tr_b16 v[216:217], v27 offset:24576
v_mfma_f32_16x16x32_bf16 v[160:163], v[88:91], v[64:67], v[160:163]
ds_read_b64_tr_b16 v[218:219], v27 offset:28672
v_mfma_f32_16x16x32_bf16 v[164:167], v[92:95], v[64:67], v[164:167]
ds_read_b64_tr_b16 v[220:221], v28 offset:24576
v_mfma_f32_16x16x32_bf16 v[172:175], v[92:95], v[68:71], v[172:175]
ds_read_b64_tr_b16 v[222:223], v28 offset:28672
v_mfma_f32_16x16x32_bf16 v[168:171], v[88:91], v[68:71], v[168:171]
ds_read_b128 v[196:199], v7 offset:25600
v_mfma_f32_16x16x32_bf16 v[140:143], v[84:87], v[68:71], v[140:143]
ds_read_b128 v[200:203], v7 offset:26624
v_mfma_f32_16x16x32_bf16 v[136:139], v[80:83], v[68:71], v[136:139]
ds_read_b128 v[204:207], v7 offset:27648
v_mfma_f32_16x16x32_bf16 v[144:147], v[80:83], v[72:75], v[144:147]
v_mfma_f32_16x16x32_bf16 v[148:151], v[84:87], v[72:75], v[148:151]
v_mfma_f32_16x16x32_bf16 v[176:179], v[88:91], v[72:75], v[176:179]
v_mfma_f32_16x16x32_bf16 v[180:183], v[92:95], v[72:75], v[180:183]
v_mfma_f32_16x16x32_bf16 v[188:191], v[92:95], v[76:79], v[188:191]
v_mfma_f32_16x16x32_bf16 v[184:187], v[88:91], v[76:79], v[184:187]
v_mfma_f32_16x16x32_bf16 v[156:159], v[84:87], v[76:79], v[156:159]
v_mfma_f32_16x16x32_bf16 v[152:155], v[80:83], v[76:79], v[152:155]
s_waitcnt lgkmcnt(0)
s_barrier
v_mfma_f32_16x16x32_bf16 v[128:131], v[112:115], v[96:99], v[128:131]
ds_read_b128 v[32:35], v7 offset:32768
v_mfma_f32_16x16x32_bf16 v[132:135], v[116:119], v[96:99], v[132:135]
ds_read_b64_tr_b16 v[48:49], v13 offset:49152
v_mfma_f32_16x16x32_bf16 v[160:163], v[120:123], v[96:99], v[160:163]
ds_read_b64_tr_b16 v[50:51], v13 offset:53248
v_mfma_f32_16x16x32_bf16 v[164:167], v[124:127], v[96:99], v[164:167]
ds_read_b64_tr_b16 v[52:53], v14 offset:49152
v_mfma_f32_16x16x32_bf16 v[172:175], v[124:127], v[100:103], v[172:175]
ds_read_b64_tr_b16 v[54:55], v14 offset:53248
v_mfma_f32_16x16x32_bf16 v[168:171], v[120:123], v[100:103], v[168:171]
ds_read_b64_tr_b16 v[56:57], v15 offset:49152
v_mfma_f32_16x16x32_bf16 v[140:143], v[116:119], v[100:103], v[140:143]
ds_read_b64_tr_b16 v[58:59], v15 offset:53248
v_mfma_f32_16x16x32_bf16 v[136:139], v[112:115], v[100:103], v[136:139]
ds_read_b64_tr_b16 v[60:61], v16 offset:49152
v_mfma_f32_16x16x32_bf16 v[144:147], v[112:115], v[104:107], v[144:147]
ds_read_b64_tr_b16 v[62:63], v16 offset:53248
v_mfma_f32_16x16x32_bf16 v[148:151], v[116:119], v[104:107], v[148:151]
ds_read_b128 v[36:39], v7 offset:33792
v_mfma_f32_16x16x32_bf16 v[176:179], v[120:123], v[104:107], v[176:179]
ds_read_b128 v[40:43], v7 offset:34816
v_mfma_f32_16x16x32_bf16 v[180:183], v[124:127], v[104:107], v[180:183]
ds_read_b128 v[44:47], v7 offset:35840
v_mfma_f32_16x16x32_bf16 v[188:191], v[124:127], v[108:111], v[188:191]
ds_read_b128 v[64:67], v7 offset:40960
v_mfma_f32_16x16x32_bf16 v[184:187], v[120:123], v[108:111], v[184:187]
ds_read_b64_tr_b16 v[80:81], v13 offset:57344
v_mfma_f32_16x16x32_bf16 v[156:159], v[116:119], v[108:111], v[156:159]
ds_read_b64_tr_b16 v[82:83], v13 offset:61440
v_mfma_f32_16x16x32_bf16 v[152:155], v[112:115], v[108:111], v[152:155]
ds_read_b64_tr_b16 v[84:85], v14 offset:57344
v_mfma_f32_16x16x32_bf16 v[128:131], v[208:211], v[192:195], v[128:131]
ds_read_b64_tr_b16 v[86:87], v14 offset:61440
v_mfma_f32_16x16x32_bf16 v[132:135], v[212:215], v[192:195], v[132:135]
ds_read_b64_tr_b16 v[88:89], v15 offset:57344
v_mfma_f32_16x16x32_bf16 v[160:163], v[216:219], v[192:195], v[160:163]
ds_read_b64_tr_b16 v[90:91], v15 offset:61440
v_mfma_f32_16x16x32_bf16 v[164:167], v[220:223], v[192:195], v[164:167]
ds_read_b64_tr_b16 v[92:93], v16 offset:57344
v_mfma_f32_16x16x32_bf16 v[172:175], v[220:223], v[196:199], v[172:175]
ds_read_b64_tr_b16 v[94:95], v16 offset:61440
v_mfma_f32_16x16x32_bf16 v[168:171], v[216:219], v[196:199], v[168:171]
ds_read_b128 v[68:71], v7 offset:41984
v_mfma_f32_16x16x32_bf16 v[140:143], v[212:215], v[196:199], v[140:143]
ds_read_b128 v[72:75], v7 offset:43008
v_mfma_f32_16x16x32_bf16 v[136:139], v[208:211], v[196:199], v[136:139]
ds_read_b128 v[76:79], v7 offset:44032
v_mfma_f32_16x16x32_bf16 v[144:147], v[208:211], v[200:203], v[144:147]
v_mfma_f32_16x16x32_bf16 v[148:151], v[212:215], v[200:203], v[148:151]
v_mfma_f32_16x16x32_bf16 v[176:179], v[216:219], v[200:203], v[176:179]
v_mfma_f32_16x16x32_bf16 v[180:183], v[220:223], v[200:203], v[180:183]
v_mfma_f32_16x16x32_bf16 v[188:191], v[220:223], v[204:207], v[188:191]
v_mfma_f32_16x16x32_bf16 v[184:187], v[216:219], v[204:207], v[184:187]
v_mfma_f32_16x16x32_bf16 v[156:159], v[212:215], v[204:207], v[156:159]
v_mfma_f32_16x16x32_bf16 v[152:155], v[208:211], v[204:207], v[152:155]
s_waitcnt lgkmcnt(0)
s_barrier
v_mfma_f32_16x16x32_bf16 v[128:131], v[48:51], v[32:35], v[128:131]
ds_read_b128 v[96:99], v8 offset:0
v_mfma_f32_16x16x32_bf16 v[132:135], v[52:55], v[32:35], v[132:135]
ds_read_b64_tr_b16 v[112:113], v9 offset:0
v_mfma_f32_16x16x32_bf16 v[160:163], v[56:59], v[32:35], v[160:163]
ds_read_b64_tr_b16 v[114:115], v9 offset:4096
v_mfma_f32_16x16x32_bf16 v[164:167], v[60:63], v[32:35], v[164:167]
ds_read_b64_tr_b16 v[116:117], v10 offset:0
v_mfma_f32_16x16x32_bf16 v[172:175], v[60:63], v[36:39], v[172:175]
ds_read_b64_tr_b16 v[118:119], v10 offset:4096
v_mfma_f32_16x16x32_bf16 v[168:171], v[56:59], v[36:39], v[168:171]
ds_read_b64_tr_b16 v[120:121], v11 offset:0
v_mfma_f32_16x16x32_bf16 v[140:143], v[52:55], v[36:39], v[140:143]
ds_read_b64_tr_b16 v[122:123], v11 offset:4096
v_mfma_f32_16x16x32_bf16 v[136:139], v[48:51], v[36:39], v[136:139]
ds_read_b64_tr_b16 v[124:125], v12 offset:0
v_mfma_f32_16x16x32_bf16 v[144:147], v[48:51], v[40:43], v[144:147]
ds_read_b64_tr_b16 v[126:127], v12 offset:4096
v_mfma_f32_16x16x32_bf16 v[148:151], v[52:55], v[40:43], v[148:151]
ds_read_b128 v[100:103], v8 offset:1024
v_mfma_f32_16x16x32_bf16 v[176:179], v[56:59], v[40:43], v[176:179]
ds_read_b128 v[104:107], v8 offset:2048
v_mfma_f32_16x16x32_bf16 v[180:183], v[60:63], v[40:43], v[180:183]
ds_read_b128 v[108:111], v8 offset:3072
v_mfma_f32_16x16x32_bf16 v[188:191], v[60:63], v[44:47], v[188:191]
ds_read_b128 v[192:195], v8 offset:8192
v_mfma_f32_16x16x32_bf16 v[184:187], v[56:59], v[44:47], v[184:187]
ds_read_b64_tr_b16 v[208:209], v9 offset:8192
v_mfma_f32_16x16x32_bf16 v[156:159], v[52:55], v[44:47], v[156:159]
ds_read_b64_tr_b16 v[210:211], v9 offset:12288
v_mfma_f32_16x16x32_bf16 v[152:155], v[48:51], v[44:47], v[152:155]
ds_read_b64_tr_b16 v[212:213], v10 offset:8192
v_mfma_f32_16x16x32_bf16 v[128:131], v[80:83], v[64:67], v[128:131]
ds_read_b64_tr_b16 v[214:215], v10 offset:12288
v_mfma_f32_16x16x32_bf16 v[132:135], v[84:87], v[64:67], v[132:135]
ds_read_b64_tr_b16 v[216:217], v11 offset:8192
v_mfma_f32_16x16x32_bf16 v[160:163], v[88:91], v[64:67], v[160:163]
ds_read_b64_tr_b16 v[218:219], v11 offset:12288
v_mfma_f32_16x16x32_bf16 v[164:167], v[92:95], v[64:67], v[164:167]
ds_read_b64_tr_b16 v[220:221], v12 offset:8192
v_mfma_f32_16x16x32_bf16 v[172:175], v[92:95], v[68:71], v[172:175]
ds_read_b64_tr_b16 v[222:223], v12 offset:12288
v_mfma_f32_16x16x32_bf16 v[168:171], v[88:91], v[68:71], v[168:171]
ds_read_b128 v[196:199], v8 offset:9216
v_mfma_f32_16x16x32_bf16 v[140:143], v[84:87], v[68:71], v[140:143]
ds_read_b128 v[200:203], v8 offset:10240
v_mfma_f32_16x16x32_bf16 v[136:139], v[80:83], v[68:71], v[136:139]
ds_read_b128 v[204:207], v8 offset:11264
v_mfma_f32_16x16x32_bf16 v[144:147], v[80:83], v[72:75], v[144:147]
v_mfma_f32_16x16x32_bf16 v[148:151], v[84:87], v[72:75], v[148:151]
v_mfma_f32_16x16x32_bf16 v[176:179], v[88:91], v[72:75], v[176:179]
v_mfma_f32_16x16x32_bf16 v[180:183], v[92:95], v[72:75], v[180:183]
v_mfma_f32_16x16x32_bf16 v[188:191], v[92:95], v[76:79], v[188:191]
v_mfma_f32_16x16x32_bf16 v[184:187], v[88:91], v[76:79], v[184:187]
v_mfma_f32_16x16x32_bf16 v[156:159], v[84:87], v[76:79], v[156:159]
v_mfma_f32_16x16x32_bf16 v[152:155], v[80:83], v[76:79], v[152:155]
s_waitcnt lgkmcnt(0)
s_barrier
v_mfma_f32_16x16x32_bf16 v[128:131], v[112:115], v[96:99], v[128:131]
ds_read_b128 v[32:35], v6 offset:16384
v_mfma_f32_16x16x32_bf16 v[132:135], v[116:119], v[96:99], v[132:135]
ds_read_b64_tr_b16 v[48:49], v9 offset:32768
v_mfma_f32_16x16x32_bf16 v[160:163], v[120:123], v[96:99], v[160:163]
ds_read_b64_tr_b16 v[50:51], v9 offset:36864
v_mfma_f32_16x16x32_bf16 v[164:167], v[124:127], v[96:99], v[164:167]
ds_read_b64_tr_b16 v[52:53], v10 offset:32768
v_mfma_f32_16x16x32_bf16 v[172:175], v[124:127], v[100:103], v[172:175]
ds_read_b64_tr_b16 v[54:55], v10 offset:36864
v_mfma_f32_16x16x32_bf16 v[168:171], v[120:123], v[100:103], v[168:171]
ds_read_b64_tr_b16 v[56:57], v11 offset:32768
v_mfma_f32_16x16x32_bf16 v[140:143], v[116:119], v[100:103], v[140:143]
ds_read_b64_tr_b16 v[58:59], v11 offset:36864
v_mfma_f32_16x16x32_bf16 v[136:139], v[112:115], v[100:103], v[136:139]
ds_read_b64_tr_b16 v[60:61], v12 offset:32768
v_mfma_f32_16x16x32_bf16 v[144:147], v[112:115], v[104:107], v[144:147]
ds_read_b64_tr_b16 v[62:63], v12 offset:36864
v_mfma_f32_16x16x32_bf16 v[148:151], v[116:119], v[104:107], v[148:151]
ds_read_b128 v[36:39], v6 offset:17408
v_mfma_f32_16x16x32_bf16 v[176:179], v[120:123], v[104:107], v[176:179]
ds_read_b128 v[40:43], v6 offset:18432
v_mfma_f32_16x16x32_bf16 v[180:183], v[124:127], v[104:107], v[180:183]
ds_read_b128 v[44:47], v6 offset:19456
v_mfma_f32_16x16x32_bf16 v[188:191], v[124:127], v[108:111], v[188:191]
ds_read_b128 v[64:67], v6 offset:24576
v_mfma_f32_16x16x32_bf16 v[184:187], v[120:123], v[108:111], v[184:187]
ds_read_b64_tr_b16 v[80:81], v9 offset:40960
v_mfma_f32_16x16x32_bf16 v[156:159], v[116:119], v[108:111], v[156:159]
ds_read_b64_tr_b16 v[82:83], v9 offset:45056
v_mfma_f32_16x16x32_bf16 v[152:155], v[112:115], v[108:111], v[152:155]
ds_read_b64_tr_b16 v[84:85], v10 offset:40960
v_mfma_f32_16x16x32_bf16 v[128:131], v[208:211], v[192:195], v[128:131]
ds_read_b64_tr_b16 v[86:87], v10 offset:45056
v_mfma_f32_16x16x32_bf16 v[132:135], v[212:215], v[192:195], v[132:135]
ds_read_b64_tr_b16 v[88:89], v11 offset:40960
v_mfma_f32_16x16x32_bf16 v[160:163], v[216:219], v[192:195], v[160:163]
ds_read_b64_tr_b16 v[90:91], v11 offset:45056
v_mfma_f32_16x16x32_bf16 v[164:167], v[220:223], v[192:195], v[164:167]
ds_read_b64_tr_b16 v[92:93], v12 offset:40960
v_mfma_f32_16x16x32_bf16 v[172:175], v[220:223], v[196:199], v[172:175]
ds_read_b64_tr_b16 v[94:95], v12 offset:45056
v_mfma_f32_16x16x32_bf16 v[168:171], v[216:219], v[196:199], v[168:171]
ds_read_b128 v[68:71], v6 offset:25600
v_mfma_f32_16x16x32_bf16 v[140:143], v[212:215], v[196:199], v[140:143]
ds_read_b128 v[72:75], v6 offset:26624
v_mfma_f32_16x16x32_bf16 v[136:139], v[208:211], v[196:199], v[136:139]
ds_read_b128 v[76:79], v6 offset:27648
v_mfma_f32_16x16x32_bf16 v[144:147], v[208:211], v[200:203], v[144:147]
v_mfma_f32_16x16x32_bf16 v[148:151], v[212:215], v[200:203], v[148:151]
v_mfma_f32_16x16x32_bf16 v[176:179], v[216:219], v[200:203], v[176:179]
v_mfma_f32_16x16x32_bf16 v[180:183], v[220:223], v[200:203], v[180:183]
v_mfma_f32_16x16x32_bf16 v[188:191], v[220:223], v[204:207], v[188:191]
v_mfma_f32_16x16x32_bf16 v[184:187], v[216:219], v[204:207], v[184:187]
v_mfma_f32_16x16x32_bf16 v[156:159], v[212:215], v[204:207], v[156:159]
v_mfma_f32_16x16x32_bf16 v[152:155], v[208:211], v[204:207], v[152:155]
s_waitcnt lgkmcnt(0)
s_barrier
v_mfma_f32_16x16x32_bf16 v[128:131], v[48:51], v[32:35], v[128:131]
ds_read_b128 v[96:99], v6 offset:49152
v_mfma_f32_16x16x32_bf16 v[132:135], v[52:55], v[32:35], v[132:135]
ds_read_b64_tr_b16 v[112:113], v13 offset:0
v_mfma_f32_16x16x32_bf16 v[160:163], v[56:59], v[32:35], v[160:163]
ds_read_b64_tr_b16 v[114:115], v13 offset:4096
v_mfma_f32_16x16x32_bf16 v[164:167], v[60:63], v[32:35], v[164:167]
ds_read_b64_tr_b16 v[116:117], v14 offset:0
v_mfma_f32_16x16x32_bf16 v[172:175], v[60:63], v[36:39], v[172:175]
ds_read_b64_tr_b16 v[118:119], v14 offset:4096
v_mfma_f32_16x16x32_bf16 v[168:171], v[56:59], v[36:39], v[168:171]
ds_read_b64_tr_b16 v[120:121], v15 offset:0
v_mfma_f32_16x16x32_bf16 v[140:143], v[52:55], v[36:39], v[140:143]
ds_read_b64_tr_b16 v[122:123], v15 offset:4096
v_mfma_f32_16x16x32_bf16 v[136:139], v[48:51], v[36:39], v[136:139]
ds_read_b64_tr_b16 v[124:125], v16 offset:0
v_mfma_f32_16x16x32_bf16 v[144:147], v[48:51], v[40:43], v[144:147]
ds_read_b64_tr_b16 v[126:127], v16 offset:4096
v_mfma_f32_16x16x32_bf16 v[148:151], v[52:55], v[40:43], v[148:151]
ds_read_b128 v[100:103], v6 offset:50176
v_mfma_f32_16x16x32_bf16 v[176:179], v[56:59], v[40:43], v[176:179]
ds_read_b128 v[104:107], v6 offset:51200
v_mfma_f32_16x16x32_bf16 v[180:183], v[60:63], v[40:43], v[180:183]
ds_read_b128 v[108:111], v6 offset:52224
v_mfma_f32_16x16x32_bf16 v[188:191], v[60:63], v[44:47], v[188:191]
ds_read_b128 v[192:195], v6 offset:57344
v_mfma_f32_16x16x32_bf16 v[184:187], v[56:59], v[44:47], v[184:187]
ds_read_b64_tr_b16 v[208:209], v13 offset:8192
v_mfma_f32_16x16x32_bf16 v[156:159], v[52:55], v[44:47], v[156:159]
ds_read_b64_tr_b16 v[210:211], v13 offset:12288
v_mfma_f32_16x16x32_bf16 v[152:155], v[48:51], v[44:47], v[152:155]
ds_read_b64_tr_b16 v[212:213], v14 offset:8192
v_mfma_f32_16x16x32_bf16 v[128:131], v[80:83], v[64:67], v[128:131]
ds_read_b64_tr_b16 v[214:215], v14 offset:12288
v_mfma_f32_16x16x32_bf16 v[132:135], v[84:87], v[64:67], v[132:135]
ds_read_b64_tr_b16 v[216:217], v15 offset:8192
v_mfma_f32_16x16x32_bf16 v[160:163], v[88:91], v[64:67], v[160:163]
ds_read_b64_tr_b16 v[218:219], v15 offset:12288
v_mfma_f32_16x16x32_bf16 v[164:167], v[92:95], v[64:67], v[164:167]
ds_read_b64_tr_b16 v[220:221], v16 offset:8192
v_mfma_f32_16x16x32_bf16 v[172:175], v[92:95], v[68:71], v[172:175]
ds_read_b64_tr_b16 v[222:223], v16 offset:12288
v_mfma_f32_16x16x32_bf16 v[168:171], v[88:91], v[68:71], v[168:171]
ds_read_b128 v[196:199], v6 offset:58368
v_mfma_f32_16x16x32_bf16 v[140:143], v[84:87], v[68:71], v[140:143]
ds_read_b128 v[200:203], v6 offset:59392
v_mfma_f32_16x16x32_bf16 v[136:139], v[80:83], v[68:71], v[136:139]
ds_read_b128 v[204:207], v6 offset:60416
v_mfma_f32_16x16x32_bf16 v[144:147], v[80:83], v[72:75], v[144:147]
v_mfma_f32_16x16x32_bf16 v[148:151], v[84:87], v[72:75], v[148:151]
v_mfma_f32_16x16x32_bf16 v[176:179], v[88:91], v[72:75], v[176:179]
v_mfma_f32_16x16x32_bf16 v[180:183], v[92:95], v[72:75], v[180:183]
v_mfma_f32_16x16x32_bf16 v[188:191], v[92:95], v[76:79], v[188:191]
v_mfma_f32_16x16x32_bf16 v[184:187], v[88:91], v[76:79], v[184:187]
v_mfma_f32_16x16x32_bf16 v[156:159], v[84:87], v[76:79], v[156:159]
v_mfma_f32_16x16x32_bf16 v[152:155], v[80:83], v[76:79], v[152:155]
s_waitcnt lgkmcnt(0)
s_barrier
v_mfma_f32_16x16x32_bf16 v[128:131], v[112:115], v[96:99], v[128:131]
ds_read_b128 v[32:35], v7 offset:16384
v_mfma_f32_16x16x32_bf16 v[132:135], v[116:119], v[96:99], v[132:135]
ds_read_b64_tr_b16 v[48:49], v25 offset:16384
v_mfma_f32_16x16x32_bf16 v[160:163], v[120:123], v[96:99], v[160:163]
ds_read_b64_tr_b16 v[50:51], v25 offset:20480
v_mfma_f32_16x16x32_bf16 v[164:167], v[124:127], v[96:99], v[164:167]
ds_read_b64_tr_b16 v[52:53], v26 offset:16384
v_mfma_f32_16x16x32_bf16 v[172:175], v[124:127], v[100:103], v[172:175]
ds_read_b64_tr_b16 v[54:55], v26 offset:20480
v_mfma_f32_16x16x32_bf16 v[168:171], v[120:123], v[100:103], v[168:171]
ds_read_b64_tr_b16 v[56:57], v27 offset:16384
v_mfma_f32_16x16x32_bf16 v[140:143], v[116:119], v[100:103], v[140:143]
ds_read_b64_tr_b16 v[58:59], v27 offset:20480
v_mfma_f32_16x16x32_bf16 v[136:139], v[112:115], v[100:103], v[136:139]
ds_read_b64_tr_b16 v[60:61], v28 offset:16384
v_mfma_f32_16x16x32_bf16 v[144:147], v[112:115], v[104:107], v[144:147]
ds_read_b64_tr_b16 v[62:63], v28 offset:20480
v_mfma_f32_16x16x32_bf16 v[148:151], v[116:119], v[104:107], v[148:151]
ds_read_b128 v[36:39], v7 offset:17408
v_mfma_f32_16x16x32_bf16 v[176:179], v[120:123], v[104:107], v[176:179]
ds_read_b128 v[40:43], v7 offset:18432
v_mfma_f32_16x16x32_bf16 v[180:183], v[124:127], v[104:107], v[180:183]
ds_read_b128 v[44:47], v7 offset:19456
v_mfma_f32_16x16x32_bf16 v[188:191], v[124:127], v[108:111], v[188:191]
ds_read_b128 v[64:67], v7 offset:24576
v_mfma_f32_16x16x32_bf16 v[184:187], v[120:123], v[108:111], v[184:187]
ds_read_b64_tr_b16 v[80:81], v25 offset:24576
v_mfma_f32_16x16x32_bf16 v[156:159], v[116:119], v[108:111], v[156:159]
ds_read_b64_tr_b16 v[82:83], v25 offset:28672
v_mfma_f32_16x16x32_bf16 v[152:155], v[112:115], v[108:111], v[152:155]
ds_read_b64_tr_b16 v[84:85], v26 offset:24576
v_mfma_f32_16x16x32_bf16 v[128:131], v[208:211], v[192:195], v[128:131]
ds_read_b64_tr_b16 v[86:87], v26 offset:28672
v_mfma_f32_16x16x32_bf16 v[132:135], v[212:215], v[192:195], v[132:135]
ds_read_b64_tr_b16 v[88:89], v27 offset:24576
v_mfma_f32_16x16x32_bf16 v[160:163], v[216:219], v[192:195], v[160:163]
ds_read_b64_tr_b16 v[90:91], v27 offset:28672
v_mfma_f32_16x16x32_bf16 v[164:167], v[220:223], v[192:195], v[164:167]
ds_read_b64_tr_b16 v[92:93], v28 offset:24576
v_mfma_f32_16x16x32_bf16 v[172:175], v[220:223], v[196:199], v[172:175]
ds_read_b64_tr_b16 v[94:95], v28 offset:28672
v_mfma_f32_16x16x32_bf16 v[168:171], v[216:219], v[196:199], v[168:171]
ds_read_b128 v[68:71], v7 offset:25600
v_mfma_f32_16x16x32_bf16 v[140:143], v[212:215], v[196:199], v[140:143]
ds_read_b128 v[72:75], v7 offset:26624
v_mfma_f32_16x16x32_bf16 v[136:139], v[208:211], v[196:199], v[136:139]
ds_read_b128 v[76:79], v7 offset:27648
v_mfma_f32_16x16x32_bf16 v[144:147], v[208:211], v[200:203], v[144:147]
v_mfma_f32_16x16x32_bf16 v[148:151], v[212:215], v[200:203], v[148:151]
v_mfma_f32_16x16x32_bf16 v[176:179], v[216:219], v[200:203], v[176:179]
v_mfma_f32_16x16x32_bf16 v[180:183], v[220:223], v[200:203], v[180:183]
v_mfma_f32_16x16x32_bf16 v[188:191], v[220:223], v[204:207], v[188:191]
v_mfma_f32_16x16x32_bf16 v[184:187], v[216:219], v[204:207], v[184:187]
v_mfma_f32_16x16x32_bf16 v[156:159], v[212:215], v[204:207], v[156:159]
v_mfma_f32_16x16x32_bf16 v[152:155], v[208:211], v[204:207], v[152:155]
s_waitcnt lgkmcnt(0)
s_barrier
v_mfma_f32_16x16x32_bf16 v[128:131], v[48:51], v[32:35], v[128:131]
ds_read_b128 v[96:99], v7 offset:32768
v_mfma_f32_16x16x32_bf16 v[132:135], v[52:55], v[32:35], v[132:135]
ds_read_b64_tr_b16 v[112:113], v13 offset:49152
v_mfma_f32_16x16x32_bf16 v[160:163], v[56:59], v[32:35], v[160:163]
ds_read_b64_tr_b16 v[114:115], v13 offset:53248
v_mfma_f32_16x16x32_bf16 v[164:167], v[60:63], v[32:35], v[164:167]
ds_read_b64_tr_b16 v[116:117], v14 offset:49152
v_mfma_f32_16x16x32_bf16 v[172:175], v[60:63], v[36:39], v[172:175]
ds_read_b64_tr_b16 v[118:119], v14 offset:53248
v_mfma_f32_16x16x32_bf16 v[168:171], v[56:59], v[36:39], v[168:171]
ds_read_b64_tr_b16 v[120:121], v15 offset:49152
v_mfma_f32_16x16x32_bf16 v[140:143], v[52:55], v[36:39], v[140:143]
ds_read_b64_tr_b16 v[122:123], v15 offset:53248
v_mfma_f32_16x16x32_bf16 v[136:139], v[48:51], v[36:39], v[136:139]
ds_read_b64_tr_b16 v[124:125], v16 offset:49152
v_mfma_f32_16x16x32_bf16 v[144:147], v[48:51], v[40:43], v[144:147]
ds_read_b64_tr_b16 v[126:127], v16 offset:53248
v_mfma_f32_16x16x32_bf16 v[148:151], v[52:55], v[40:43], v[148:151]
ds_read_b128 v[100:103], v7 offset:33792
v_mfma_f32_16x16x32_bf16 v[176:179], v[56:59], v[40:43], v[176:179]
ds_read_b128 v[104:107], v7 offset:34816
v_mfma_f32_16x16x32_bf16 v[180:183], v[60:63], v[40:43], v[180:183]
ds_read_b128 v[108:111], v7 offset:35840
v_mfma_f32_16x16x32_bf16 v[188:191], v[60:63], v[44:47], v[188:191]
ds_read_b128 v[192:195], v7 offset:40960
v_mfma_f32_16x16x32_bf16 v[184:187], v[56:59], v[44:47], v[184:187]
ds_read_b64_tr_b16 v[208:209], v13 offset:57344
v_mfma_f32_16x16x32_bf16 v[156:159], v[52:55], v[44:47], v[156:159]
ds_read_b64_tr_b16 v[210:211], v13 offset:61440
v_mfma_f32_16x16x32_bf16 v[152:155], v[48:51], v[44:47], v[152:155]
ds_read_b64_tr_b16 v[212:213], v14 offset:57344
v_mfma_f32_16x16x32_bf16 v[128:131], v[80:83], v[64:67], v[128:131]
ds_read_b64_tr_b16 v[214:215], v14 offset:61440
v_mfma_f32_16x16x32_bf16 v[132:135], v[84:87], v[64:67], v[132:135]
ds_read_b64_tr_b16 v[216:217], v15 offset:57344
v_mfma_f32_16x16x32_bf16 v[160:163], v[88:91], v[64:67], v[160:163]
ds_read_b64_tr_b16 v[218:219], v15 offset:61440
v_mfma_f32_16x16x32_bf16 v[164:167], v[92:95], v[64:67], v[164:167]
ds_read_b64_tr_b16 v[220:221], v16 offset:57344
v_mfma_f32_16x16x32_bf16 v[172:175], v[92:95], v[68:71], v[172:175]
ds_read_b64_tr_b16 v[222:223], v16 offset:61440
v_mfma_f32_16x16x32_bf16 v[168:171], v[88:91], v[68:71], v[168:171]
ds_read_b128 v[196:199], v7 offset:41984
v_mfma_f32_16x16x32_bf16 v[140:143], v[84:87], v[68:71], v[140:143]
ds_read_b128 v[200:203], v7 offset:43008
v_mfma_f32_16x16x32_bf16 v[136:139], v[80:83], v[68:71], v[136:139]
ds_read_b128 v[204:207], v7 offset:44032
v_mfma_f32_16x16x32_bf16 v[144:147], v[80:83], v[72:75], v[144:147]
v_mfma_f32_16x16x32_bf16 v[148:151], v[84:87], v[72:75], v[148:151]
v_mfma_f32_16x16x32_bf16 v[176:179], v[88:91], v[72:75], v[176:179]
v_mfma_f32_16x16x32_bf16 v[180:183], v[92:95], v[72:75], v[180:183]
v_mfma_f32_16x16x32_bf16 v[188:191], v[92:95], v[76:79], v[188:191]
v_mfma_f32_16x16x32_bf16 v[184:187], v[88:91], v[76:79], v[184:187]
v_mfma_f32_16x16x32_bf16 v[156:159], v[84:87], v[76:79], v[156:159]
v_mfma_f32_16x16x32_bf16 v[152:155], v[80:83], v[76:79], v[152:155]
s_waitcnt lgkmcnt(0)
s_barrier
v_mfma_f32_16x16x32_bf16 v[128:131], v[112:115], v[96:99], v[128:131]
ds_read_b128 v[32:35], v8 offset:0
v_mfma_f32_16x16x32_bf16 v[132:135], v[116:119], v[96:99], v[132:135]
ds_read_b64_tr_b16 v[48:49], v9 offset:0
v_mfma_f32_16x16x32_bf16 v[160:163], v[120:123], v[96:99], v[160:163]
ds_read_b64_tr_b16 v[50:51], v9 offset:4096
v_mfma_f32_16x16x32_bf16 v[164:167], v[124:127], v[96:99], v[164:167]
ds_read_b64_tr_b16 v[52:53], v10 offset:0
v_mfma_f32_16x16x32_bf16 v[172:175], v[124:127], v[100:103], v[172:175]
ds_read_b64_tr_b16 v[54:55], v10 offset:4096
v_mfma_f32_16x16x32_bf16 v[168:171], v[120:123], v[100:103], v[168:171]
ds_read_b64_tr_b16 v[56:57], v11 offset:0
v_mfma_f32_16x16x32_bf16 v[140:143], v[116:119], v[100:103], v[140:143]
ds_read_b64_tr_b16 v[58:59], v11 offset:4096
s_branch Lov_14
.p2align 12
Lst_14_0:
s_branch Lst_18_0
Lst_14_1:
s_branch Lst_18_1
Lov_14:
v_mfma_f32_16x16x32_bf16 v[136:139], v[112:115], v[100:103], v[136:139]
ds_read_b64_tr_b16 v[60:61], v12 offset:0
v_mfma_f32_16x16x32_bf16 v[144:147], v[112:115], v[104:107], v[144:147]
ds_read_b64_tr_b16 v[62:63], v12 offset:4096
v_mfma_f32_16x16x32_bf16 v[148:151], v[116:119], v[104:107], v[148:151]
ds_read_b128 v[36:39], v8 offset:1024
v_mfma_f32_16x16x32_bf16 v[176:179], v[120:123], v[104:107], v[176:179]
ds_read_b128 v[40:43], v8 offset:2048
v_mfma_f32_16x16x32_bf16 v[180:183], v[124:127], v[104:107], v[180:183]
ds_read_b128 v[44:47], v8 offset:3072
v_mfma_f32_16x16x32_bf16 v[188:191], v[124:127], v[108:111], v[188:191]
ds_read_b128 v[64:67], v8 offset:8192
v_mfma_f32_16x16x32_bf16 v[184:187], v[120:123], v[108:111], v[184:187]
ds_read_b64_tr_b16 v[80:81], v9 offset:8192
v_mfma_f32_16x16x32_bf16 v[156:159], v[116:119], v[108:111], v[156:159]
ds_read_b64_tr_b16 v[82:83], v9 offset:12288
v_mfma_f32_16x16x32_bf16 v[152:155], v[112:115], v[108:111], v[152:155]
ds_read_b64_tr_b16 v[84:85], v10 offset:8192
v_mfma_f32_16x16x32_bf16 v[128:131], v[208:211], v[192:195], v[128:131]
ds_read_b64_tr_b16 v[86:87], v10 offset:12288
v_mfma_f32_16x16x32_bf16 v[132:135], v[212:215], v[192:195], v[132:135]
ds_read_b64_tr_b16 v[88:89], v11 offset:8192
v_mfma_f32_16x16x32_bf16 v[160:163], v[216:219], v[192:195], v[160:163]
ds_read_b64_tr_b16 v[90:91], v11 offset:12288
v_mfma_f32_16x16x32_bf16 v[164:167], v[220:223], v[192:195], v[164:167]
ds_read_b64_tr_b16 v[92:93], v12 offset:8192
v_mfma_f32_16x16x32_bf16 v[172:175], v[220:223], v[196:199], v[172:175]
ds_read_b64_tr_b16 v[94:95], v12 offset:12288
v_mfma_f32_16x16x32_bf16 v[168:171], v[216:219], v[196:199], v[168:171]
ds_read_b128 v[68:71], v8 offset:9216
v_mfma_f32_16x16x32_bf16 v[140:143], v[212:215], v[196:199], v[140:143]
ds_read_b128 v[72:75], v8 offset:10240
v_mfma_f32_16x16x32_bf16 v[136:139], v[208:211], v[196:199], v[136:139]
ds_read_b128 v[76:79], v8 offset:11264
v_mfma_f32_16x16x32_bf16 v[144:147], v[208:211], v[200:203], v[144:147]
v_mfma_f32_16x16x32_bf16 v[148:151], v[212:215], v[200:203], v[148:151]
v_mfma_f32_16x16x32_bf16 v[176:179], v[216:219], v[200:203], v[176:179]
v_mfma_f32_16x16x32_bf16 v[180:183], v[220:223], v[200:203], v[180:183]
v_mfma_f32_16x16x32_bf16 v[188:191], v[220:223], v[204:207], v[188:191]
v_mfma_f32_16x16x32_bf16 v[184:187], v[216:219], v[204:207], v[184:187]
v_mfma_f32_16x16x32_bf16 v[156:159], v[212:215], v[204:207], v[156:159]
v_mfma_f32_16x16x32_bf16 v[152:155], v[208:211], v[204:207], v[152:155]
s_waitcnt lgkmcnt(0)
s_barrier
v_mfma_f32_16x16x32_bf16 v[128:131], v[48:51], v[32:35], v[128:131]
ds_read_b128 v[96:99], v6 offset:16384
v_mfma_f32_16x16x32_bf16 v[132:135], v[52:55], v[32:35], v[132:135]
ds_read_b64_tr_b16 v[112:113], v9 offset:32768
v_mfma_f32_16x16x32_bf16 v[160:163], v[56:59], v[32:35], v[160:163]
ds_read_b64_tr_b16 v[114:115], v9 offset:36864
v_mfma_f32_16x16x32_bf16 v[164:167], v[60:63], v[32:35], v[164:167]
ds_read_b64_tr_b16 v[116:117], v10 offset:32768
v_mfma_f32_16x16x32_bf16 v[172:175], v[60:63], v[36:39], v[172:175]
ds_read_b64_tr_b16 v[118:119], v10 offset:36864
v_mfma_f32_16x16x32_bf16 v[168:171], v[56:59], v[36:39], v[168:171]
ds_read_b64_tr_b16 v[120:121], v11 offset:32768
v_mfma_f32_16x16x32_bf16 v[140:143], v[52:55], v[36:39], v[140:143]
ds_read_b64_tr_b16 v[122:123], v11 offset:36864
v_mfma_f32_16x16x32_bf16 v[136:139], v[48:51], v[36:39], v[136:139]
ds_read_b64_tr_b16 v[124:125], v12 offset:32768
v_mfma_f32_16x16x32_bf16 v[144:147], v[48:51], v[40:43], v[144:147]
ds_read_b64_tr_b16 v[126:127], v12 offset:36864
v_mfma_f32_16x16x32_bf16 v[148:151], v[52:55], v[40:43], v[148:151]
ds_read_b128 v[100:103], v6 offset:17408
v_mfma_f32_16x16x32_bf16 v[176:179], v[56:59], v[40:43], v[176:179]
ds_read_b128 v[104:107], v6 offset:18432
v_mfma_f32_16x16x32_bf16 v[180:183], v[60:63], v[40:43], v[180:183]
ds_read_b128 v[108:111], v6 offset:19456
v_mfma_f32_16x16x32_bf16 v[188:191], v[60:63], v[44:47], v[188:191]
ds_read_b128 v[192:195], v6 offset:24576
v_mfma_f32_16x16x32_bf16 v[184:187], v[56:59], v[44:47], v[184:187]
ds_read_b64_tr_b16 v[208:209], v9 offset:40960
v_mfma_f32_16x16x32_bf16 v[156:159], v[52:55], v[44:47], v[156:159]
ds_read_b64_tr_b16 v[210:211], v9 offset:45056
v_mfma_f32_16x16x32_bf16 v[152:155], v[48:51], v[44:47], v[152:155]
ds_read_b64_tr_b16 v[212:213], v10 offset:40960
v_mfma_f32_16x16x32_bf16 v[128:131], v[80:83], v[64:67], v[128:131]
ds_read_b64_tr_b16 v[214:215], v10 offset:45056
v_mfma_f32_16x16x32_bf16 v[132:135], v[84:87], v[64:67], v[132:135]
ds_read_b64_tr_b16 v[216:217], v11 offset:40960
v_mfma_f32_16x16x32_bf16 v[160:163], v[88:91], v[64:67], v[160:163]
ds_read_b64_tr_b16 v[218:219], v11 offset:45056
v_mfma_f32_16x16x32_bf16 v[164:167], v[92:95], v[64:67], v[164:167]
ds_read_b64_tr_b16 v[220:221], v12 offset:40960
v_mfma_f32_16x16x32_bf16 v[172:175], v[92:95], v[68:71], v[172:175]
ds_read_b64_tr_b16 v[222:223], v12 offset:45056
v_mfma_f32_16x16x32_bf16 v[168:171], v[88:91], v[68:71], v[168:171]
ds_read_b128 v[196:199], v6 offset:25600
v_mfma_f32_16x16x32_bf16 v[140:143], v[84:87], v[68:71], v[140:143]
ds_read_b128 v[200:203], v6 offset:26624
v_mfma_f32_16x16x32_bf16 v[136:139], v[80:83], v[68:71], v[136:139]
ds_read_b128 v[204:207], v6 offset:27648
v_mfma_f32_16x16x32_bf16 v[144:147], v[80:83], v[72:75], v[144:147]
v_mfma_f32_16x16x32_bf16 v[148:151], v[84:87], v[72:75], v[148:151]
v_mfma_f32_16x16x32_bf16 v[176:179], v[88:91], v[72:75], v[176:179]
v_mfma_f32_16x16x32_bf16 v[180:183], v[92:95], v[72:75], v[180:183]
v_mfma_f32_16x16x32_bf16 v[188:191], v[92:95], v[76:79], v[188:191]
v_mfma_f32_16x16x32_bf16 v[184:187], v[88:91], v[76:79], v[184:187]
v_mfma_f32_16x16x32_bf16 v[156:159], v[84:87], v[76:79], v[156:159]
v_mfma_f32_16x16x32_bf16 v[152:155], v[80:83], v[76:79], v[152:155]
s_waitcnt lgkmcnt(0)
s_barrier
v_mfma_f32_16x16x32_bf16 v[128:131], v[112:115], v[96:99], v[128:131]
ds_read_b128 v[32:35], v6 offset:49152
v_mfma_f32_16x16x32_bf16 v[132:135], v[116:119], v[96:99], v[132:135]
ds_read_b64_tr_b16 v[48:49], v13 offset:0
v_mfma_f32_16x16x32_bf16 v[160:163], v[120:123], v[96:99], v[160:163]
ds_read_b64_tr_b16 v[50:51], v13 offset:4096
v_mfma_f32_16x16x32_bf16 v[164:167], v[124:127], v[96:99], v[164:167]
ds_read_b64_tr_b16 v[52:53], v14 offset:0
v_mfma_f32_16x16x32_bf16 v[172:175], v[124:127], v[100:103], v[172:175]
ds_read_b64_tr_b16 v[54:55], v14 offset:4096
v_mfma_f32_16x16x32_bf16 v[168:171], v[120:123], v[100:103], v[168:171]
ds_read_b64_tr_b16 v[56:57], v15 offset:0
v_mfma_f32_16x16x32_bf16 v[140:143], v[116:119], v[100:103], v[140:143]
ds_read_b64_tr_b16 v[58:59], v15 offset:4096
v_mfma_f32_16x16x32_bf16 v[136:139], v[112:115], v[100:103], v[136:139]
ds_read_b64_tr_b16 v[60:61], v16 offset:0
v_mfma_f32_16x16x32_bf16 v[144:147], v[112:115], v[104:107], v[144:147]
ds_read_b64_tr_b16 v[62:63], v16 offset:4096
v_mfma_f32_16x16x32_bf16 v[148:151], v[116:119], v[104:107], v[148:151]
ds_read_b128 v[36:39], v6 offset:50176
v_mfma_f32_16x16x32_bf16 v[176:179], v[120:123], v[104:107], v[176:179]
ds_read_b128 v[40:43], v6 offset:51200
v_mfma_f32_16x16x32_bf16 v[180:183], v[124:127], v[104:107], v[180:183]
ds_read_b128 v[44:47], v6 offset:52224
v_mfma_f32_16x16x32_bf16 v[188:191], v[124:127], v[108:111], v[188:191]
ds_read_b128 v[64:67], v6 offset:57344
v_mfma_f32_16x16x32_bf16 v[184:187], v[120:123], v[108:111], v[184:187]
ds_read_b64_tr_b16 v[80:81], v13 offset:8192
v_mfma_f32_16x16x32_bf16 v[156:159], v[116:119], v[108:111], v[156:159]
ds_read_b64_tr_b16 v[82:83], v13 offset:12288
v_mfma_f32_16x16x32_bf16 v[152:155], v[112:115], v[108:111], v[152:155]
ds_read_b64_tr_b16 v[84:85], v14 offset:8192
v_mfma_f32_16x16x32_bf16 v[128:131], v[208:211], v[192:195], v[128:131]
ds_read_b64_tr_b16 v[86:87], v14 offset:12288
v_mfma_f32_16x16x32_bf16 v[132:135], v[212:215], v[192:195], v[132:135]
ds_read_b64_tr_b16 v[88:89], v15 offset:8192
v_mfma_f32_16x16x32_bf16 v[160:163], v[216:219], v[192:195], v[160:163]
ds_read_b64_tr_b16 v[90:91], v15 offset:12288
v_mfma_f32_16x16x32_bf16 v[164:167], v[220:223], v[192:195], v[164:167]
ds_read_b64_tr_b16 v[92:93], v16 offset:8192
v_mfma_f32_16x16x32_bf16 v[172:175], v[220:223], v[196:199], v[172:175]
ds_read_b64_tr_b16 v[94:95], v16 offset:12288
v_mfma_f32_16x16x32_bf16 v[168:171], v[216:219], v[196:199], v[168:171]
ds_read_b128 v[68:71], v6 offset:58368
v_mfma_f32_16x16x32_bf16 v[140:143], v[212:215], v[196:199], v[140:143]
ds_read_b128 v[72:75], v6 offset:59392
v_mfma_f32_16x16x32_bf16 v[136:139], v[208:211], v[196:199], v[136:139]
ds_read_b128 v[76:79], v6 offset:60416
v_mfma_f32_16x16x32_bf16 v[144:147], v[208:211], v[200:203], v[144:147]
v_mfma_f32_16x16x32_bf16 v[148:151], v[212:215], v[200:203], v[148:151]
v_mfma_f32_16x16x32_bf16 v[176:179], v[216:219], v[200:203], v[176:179]
v_mfma_f32_16x16x32_bf16 v[180:183], v[220:223], v[200:203], v[180:183]
v_mfma_f32_16x16x32_bf16 v[188:191], v[220:223], v[204:207], v[188:191]
v_mfma_f32_16x16x32_bf16 v[184:187], v[216:219], v[204:207], v[184:187]
v_mfma_f32_16x16x32_bf16 v[156:159], v[212:215], v[204:207], v[156:159]
v_mfma_f32_16x16x32_bf16 v[152:155], v[208:211], v[204:207], v[152:155]
s_waitcnt lgkmcnt(0)
s_barrier
v_mfma_f32_16x16x32_bf16 v[128:131], v[48:51], v[32:35], v[128:131]
ds_read_b128 v[96:99], v7 offset:16384
v_mfma_f32_16x16x32_bf16 v[132:135], v[52:55], v[32:35], v[132:135]
ds_read_b64_tr_b16 v[112:113], v25 offset:16384
v_mfma_f32_16x16x32_bf16 v[160:163], v[56:59], v[32:35], v[160:163]
ds_read_b64_tr_b16 v[114:115], v25 offset:20480
v_mfma_f32_16x16x32_bf16 v[164:167], v[60:63], v[32:35], v[164:167]
ds_read_b64_tr_b16 v[116:117], v26 offset:16384
v_mfma_f32_16x16x32_bf16 v[172:175], v[60:63], v[36:39], v[172:175]
ds_read_b64_tr_b16 v[118:119], v26 offset:20480
v_mfma_f32_16x16x32_bf16 v[168:171], v[56:59], v[36:39], v[168:171]
ds_read_b64_tr_b16 v[120:121], v27 offset:16384
v_mfma_f32_16x16x32_bf16 v[140:143], v[52:55], v[36:39], v[140:143]
ds_read_b64_tr_b16 v[122:123], v27 offset:20480
v_mfma_f32_16x16x32_bf16 v[136:139], v[48:51], v[36:39], v[136:139]
ds_read_b64_tr_b16 v[124:125], v28 offset:16384
v_mfma_f32_16x16x32_bf16 v[144:147], v[48:51], v[40:43], v[144:147]
ds_read_b64_tr_b16 v[126:127], v28 offset:20480
v_mfma_f32_16x16x32_bf16 v[148:151], v[52:55], v[40:43], v[148:151]
ds_read_b128 v[100:103], v7 offset:17408
v_mfma_f32_16x16x32_bf16 v[176:179], v[56:59], v[40:43], v[176:179]
ds_read_b128 v[104:107], v7 offset:18432
v_mfma_f32_16x16x32_bf16 v[180:183], v[60:63], v[40:43], v[180:183]
ds_read_b128 v[108:111], v7 offset:19456
v_mfma_f32_16x16x32_bf16 v[188:191], v[60:63], v[44:47], v[188:191]
ds_read_b128 v[192:195], v7 offset:24576
v_mfma_f32_16x16x32_bf16 v[184:187], v[56:59], v[44:47], v[184:187]
ds_read_b64_tr_b16 v[208:209], v25 offset:24576
v_mfma_f32_16x16x32_bf16 v[156:159], v[52:55], v[44:47], v[156:159]
ds_read_b64_tr_b16 v[210:211], v25 offset:28672
v_mfma_f32_16x16x32_bf16 v[152:155], v[48:51], v[44:47], v[152:155]
ds_read_b64_tr_b16 v[212:213], v26 offset:24576
v_mfma_f32_16x16x32_bf16 v[128:131], v[80:83], v[64:67], v[128:131]
ds_read_b64_tr_b16 v[214:215], v26 offset:28672
v_mfma_f32_16x16x32_bf16 v[132:135], v[84:87], v[64:67], v[132:135]
ds_read_b64_tr_b16 v[216:217], v27 offset:24576
v_mfma_f32_16x16x32_bf16 v[160:163], v[88:91], v[64:67], v[160:163]
ds_read_b64_tr_b16 v[218:219], v27 offset:28672
v_mfma_f32_16x16x32_bf16 v[164:167], v[92:95], v[64:67], v[164:167]
ds_read_b64_tr_b16 v[220:221], v28 offset:24576
v_mfma_f32_16x16x32_bf16 v[172:175], v[92:95], v[68:71], v[172:175]
ds_read_b64_tr_b16 v[222:223], v28 offset:28672
v_mfma_f32_16x16x32_bf16 v[168:171], v[88:91], v[68:71], v[168:171]
ds_read_b128 v[196:199], v7 offset:25600
v_mfma_f32_16x16x32_bf16 v[140:143], v[84:87], v[68:71], v[140:143]
ds_read_b128 v[200:203], v7 offset:26624
v_mfma_f32_16x16x32_bf16 v[136:139], v[80:83], v[68:71], v[136:139]
ds_read_b128 v[204:207], v7 offset:27648
v_mfma_f32_16x16x32_bf16 v[144:147], v[80:83], v[72:75], v[144:147]
v_mfma_f32_16x16x32_bf16 v[148:151], v[84:87], v[72:75], v[148:151]
v_mfma_f32_16x16x32_bf16 v[176:179], v[88:91], v[72:75], v[176:179]
v_mfma_f32_16x16x32_bf16 v[180:183], v[92:95], v[72:75], v[180:183]
v_mfma_f32_16x16x32_bf16 v[188:191], v[92:95], v[76:79], v[188:191]
v_mfma_f32_16x16x32_bf16 v[184:187], v[88:91], v[76:79], v[184:187]
v_mfma_f32_16x16x32_bf16 v[156:159], v[84:87], v[76:79], v[156:159]
v_mfma_f32_16x16x32_bf16 v[152:155], v[80:83], v[76:79], v[152:155]
s_waitcnt lgkmcnt(0)
s_barrier
v_mfma_f32_16x16x32_bf16 v[128:131], v[112:115], v[96:99], v[128:131]
ds_read_b128 v[32:35], v7 offset:32768
v_mfma_f32_16x16x32_bf16 v[132:135], v[116:119], v[96:99], v[132:135]
ds_read_b64_tr_b16 v[48:49], v13 offset:49152
v_mfma_f32_16x16x32_bf16 v[160:163], v[120:123], v[96:99], v[160:163]
ds_read_b64_tr_b16 v[50:51], v13 offset:53248
v_mfma_f32_16x16x32_bf16 v[164:167], v[124:127], v[96:99], v[164:167]
ds_read_b64_tr_b16 v[52:53], v14 offset:49152
v_mfma_f32_16x16x32_bf16 v[172:175], v[124:127], v[100:103], v[172:175]
ds_read_b64_tr_b16 v[54:55], v14 offset:53248
v_mfma_f32_16x16x32_bf16 v[168:171], v[120:123], v[100:103], v[168:171]
ds_read_b64_tr_b16 v[56:57], v15 offset:49152
v_mfma_f32_16x16x32_bf16 v[140:143], v[116:119], v[100:103], v[140:143]
ds_read_b64_tr_b16 v[58:59], v15 offset:53248
v_mfma_f32_16x16x32_bf16 v[136:139], v[112:115], v[100:103], v[136:139]
ds_read_b64_tr_b16 v[60:61], v16 offset:49152
v_mfma_f32_16x16x32_bf16 v[144:147], v[112:115], v[104:107], v[144:147]
ds_read_b64_tr_b16 v[62:63], v16 offset:53248
v_mfma_f32_16x16x32_bf16 v[148:151], v[116:119], v[104:107], v[148:151]
ds_read_b128 v[36:39], v7 offset:33792
v_mfma_f32_16x16x32_bf16 v[176:179], v[120:123], v[104:107], v[176:179]
ds_read_b128 v[40:43], v7 offset:34816
v_mfma_f32_16x16x32_bf16 v[180:183], v[124:127], v[104:107], v[180:183]
ds_read_b128 v[44:47], v7 offset:35840
v_mfma_f32_16x16x32_bf16 v[188:191], v[124:127], v[108:111], v[188:191]
ds_read_b128 v[64:67], v7 offset:40960
v_mfma_f32_16x16x32_bf16 v[184:187], v[120:123], v[108:111], v[184:187]
ds_read_b64_tr_b16 v[80:81], v13 offset:57344
v_mfma_f32_16x16x32_bf16 v[156:159], v[116:119], v[108:111], v[156:159]
ds_read_b64_tr_b16 v[82:83], v13 offset:61440
v_mfma_f32_16x16x32_bf16 v[152:155], v[112:115], v[108:111], v[152:155]
ds_read_b64_tr_b16 v[84:85], v14 offset:57344
v_mfma_f32_16x16x32_bf16 v[128:131], v[208:211], v[192:195], v[128:131]
ds_read_b64_tr_b16 v[86:87], v14 offset:61440
v_mfma_f32_16x16x32_bf16 v[132:135], v[212:215], v[192:195], v[132:135]
ds_read_b64_tr_b16 v[88:89], v15 offset:57344
v_mfma_f32_16x16x32_bf16 v[160:163], v[216:219], v[192:195], v[160:163]
ds_read_b64_tr_b16 v[90:91], v15 offset:61440
v_mfma_f32_16x16x32_bf16 v[164:167], v[220:223], v[192:195], v[164:167]
ds_read_b64_tr_b16 v[92:93], v16 offset:57344
v_mfma_f32_16x16x32_bf16 v[172:175], v[220:223], v[196:199], v[172:175]
ds_read_b64_tr_b16 v[94:95], v16 offset:61440
v_mfma_f32_16x16x32_bf16 v[168:171], v[216:219], v[196:199], v[168:171]
ds_read_b128 v[68:71], v7 offset:41984
v_mfma_f32_16x16x32_bf16 v[140:143], v[212:215], v[196:199], v[140:143]
ds_read_b128 v[72:75], v7 offset:43008
v_mfma_f32_16x16x32_bf16 v[136:139], v[208:211], v[196:199], v[136:139]
ds_read_b128 v[76:79], v7 offset:44032
v_mfma_f32_16x16x32_bf16 v[144:147], v[208:211], v[200:203], v[144:147]
v_mfma_f32_16x16x32_bf16 v[148:151], v[212:215], v[200:203], v[148:151]
v_mfma_f32_16x16x32_bf16 v[176:179], v[216:219], v[200:203], v[176:179]
v_mfma_f32_16x16x32_bf16 v[180:183], v[220:223], v[200:203], v[180:183]
v_mfma_f32_16x16x32_bf16 v[188:191], v[220:223], v[204:207], v[188:191]
v_mfma_f32_16x16x32_bf16 v[184:187], v[216:219], v[204:207], v[184:187]
v_mfma_f32_16x16x32_bf16 v[156:159], v[212:215], v[204:207], v[156:159]
v_mfma_f32_16x16x32_bf16 v[152:155], v[208:211], v[204:207], v[152:155]
s_waitcnt lgkmcnt(0)
s_barrier
v_mfma_f32_16x16x32_bf16 v[128:131], v[48:51], v[32:35], v[128:131]
ds_read_b128 v[96:99], v8 offset:0
v_mfma_f32_16x16x32_bf16 v[132:135], v[52:55], v[32:35], v[132:135]
ds_read_b64_tr_b16 v[112:113], v9 offset:0
v_mfma_f32_16x16x32_bf16 v[160:163], v[56:59], v[32:35], v[160:163]
ds_read_b64_tr_b16 v[114:115], v9 offset:4096
v_mfma_f32_16x16x32_bf16 v[164:167], v[60:63], v[32:35], v[164:167]
ds_read_b64_tr_b16 v[116:117], v10 offset:0
v_mfma_f32_16x16x32_bf16 v[172:175], v[60:63], v[36:39], v[172:175]
ds_read_b64_tr_b16 v[118:119], v10 offset:4096
v_mfma_f32_16x16x32_bf16 v[168:171], v[56:59], v[36:39], v[168:171]
ds_read_b64_tr_b16 v[120:121], v11 offset:0
v_mfma_f32_16x16x32_bf16 v[140:143], v[52:55], v[36:39], v[140:143]
ds_read_b64_tr_b16 v[122:123], v11 offset:4096
v_mfma_f32_16x16x32_bf16 v[136:139], v[48:51], v[36:39], v[136:139]
ds_read_b64_tr_b16 v[124:125], v12 offset:0
v_mfma_f32_16x16x32_bf16 v[144:147], v[48:51], v[40:43], v[144:147]
ds_read_b64_tr_b16 v[126:127], v12 offset:4096
v_mfma_f32_16x16x32_bf16 v[148:151], v[52:55], v[40:43], v[148:151]
ds_read_b128 v[100:103], v8 offset:1024
v_mfma_f32_16x16x32_bf16 v[176:179], v[56:59], v[40:43], v[176:179]
ds_read_b128 v[104:107], v8 offset:2048
v_mfma_f32_16x16x32_bf16 v[180:183], v[60:63], v[40:43], v[180:183]
ds_read_b128 v[108:111], v8 offset:3072
v_mfma_f32_16x16x32_bf16 v[188:191], v[60:63], v[44:47], v[188:191]
ds_read_b128 v[192:195], v8 offset:8192
v_mfma_f32_16x16x32_bf16 v[184:187], v[56:59], v[44:47], v[184:187]
ds_read_b64_tr_b16 v[208:209], v9 offset:8192
v_mfma_f32_16x16x32_bf16 v[156:159], v[52:55], v[44:47], v[156:159]
ds_read_b64_tr_b16 v[210:211], v9 offset:12288
v_mfma_f32_16x16x32_bf16 v[152:155], v[48:51], v[44:47], v[152:155]
ds_read_b64_tr_b16 v[212:213], v10 offset:8192
v_mfma_f32_16x16x32_bf16 v[128:131], v[80:83], v[64:67], v[128:131]
ds_read_b64_tr_b16 v[214:215], v10 offset:12288
v_mfma_f32_16x16x32_bf16 v[132:135], v[84:87], v[64:67], v[132:135]
ds_read_b64_tr_b16 v[216:217], v11 offset:8192
v_mfma_f32_16x16x32_bf16 v[160:163], v[88:91], v[64:67], v[160:163]
ds_read_b64_tr_b16 v[218:219], v11 offset:12288
v_mfma_f32_16x16x32_bf16 v[164:167], v[92:95], v[64:67], v[164:167]
ds_read_b64_tr_b16 v[220:221], v12 offset:8192
v_mfma_f32_16x16x32_bf16 v[172:175], v[92:95], v[68:71], v[172:175]
ds_read_b64_tr_b16 v[222:223], v12 offset:12288
v_mfma_f32_16x16x32_bf16 v[168:171], v[88:91], v[68:71], v[168:171]
ds_read_b128 v[196:199], v8 offset:9216
v_mfma_f32_16x16x32_bf16 v[140:143], v[84:87], v[68:71], v[140:143]
ds_read_b128 v[200:203], v8 offset:10240
v_mfma_f32_16x16x32_bf16 v[136:139], v[80:83], v[68:71], v[136:139]
ds_read_b128 v[204:207], v8 offset:11264
v_mfma_f32_16x16x32_bf16 v[144:147], v[80:83], v[72:75], v[144:147]
v_mfma_f32_16x16x32_bf16 v[148:151], v[84:87], v[72:75], v[148:151]
v_mfma_f32_16x16x32_bf16 v[176:179], v[88:91], v[72:75], v[176:179]
v_mfma_f32_16x16x32_bf16 v[180:183], v[92:95], v[72:75], v[180:183]
v_mfma_f32_16x16x32_bf16 v[188:191], v[92:95], v[76:79], v[188:191]
v_mfma_f32_16x16x32_bf16 v[184:187], v[88:91], v[76:79], v[184:187]
v_mfma_f32_16x16x32_bf16 v[156:159], v[84:87], v[76:79], v[156:159]
v_mfma_f32_16x16x32_bf16 v[152:155], v[80:83], v[76:79], v[152:155]
s_waitcnt lgkmcnt(0)
s_barrier
v_mfma_f32_16x16x32_bf16 v[128:131], v[112:115], v[96:99], v[128:131]
ds_read_b128 v[32:35], v6 offset:16384
v_mfma_f32_16x16x32_bf16 v[132:135], v[116:119], v[96:99], v[132:135]
ds_read_b64_tr_b16 v[48:49], v224 offset:32768
v_mfma_f32_16x16x32_bf16 v[160:163], v[120:123], v[96:99], v[160:163]
ds_read_b64_tr_b16 v[50:51], v224 offset:34816
v_mfma_f32_16x16x32_bf16 v[164:167], v[124:127], v[96:99], v[164:167]
ds_read_b64_tr_b16 v[52:53], v225 offset:32768
v_mfma_f32_16x16x32_bf16 v[172:175], v[124:127], v[100:103], v[172:175]
ds_read_b64_tr_b16 v[54:55], v225 offset:34816
v_mfma_f32_16x16x32_bf16 v[168:171], v[120:123], v[100:103], v[168:171]
ds_read_b128 v[36:39], v6 offset:17408
v_mfma_f32_16x16x32_bf16 v[140:143], v[116:119], v[100:103], v[140:143]
ds_read_b128 v[40:43], v6 offset:18432
v_mfma_f32_16x16x32_bf16 v[136:139], v[112:115], v[100:103], v[136:139]
ds_read_b128 v[44:47], v6 offset:19456
v_mfma_f32_16x16x32_bf16 v[144:147], v[112:115], v[104:107], v[144:147]
ds_read_b128 v[64:67], v6 offset:24576
v_mfma_f32_16x16x32_bf16 v[148:151], v[116:119], v[104:107], v[148:151]
ds_read_b64_tr_b16 v[80:81], v224 offset:36864
v_mfma_f32_16x16x32_bf16 v[176:179], v[120:123], v[104:107], v[176:179]
ds_read_b64_tr_b16 v[82:83], v224 offset:38912
v_mfma_f32_16x16x32_bf16 v[180:183], v[124:127], v[104:107], v[180:183]
ds_read_b64_tr_b16 v[84:85], v225 offset:36864
v_mfma_f32_16x16x32_bf16 v[188:191], v[124:127], v[108:111], v[188:191]
ds_read_b64_tr_b16 v[86:87], v225 offset:38912
v_mfma_f32_16x16x32_bf16 v[184:187], v[120:123], v[108:111], v[184:187]
ds_read_b128 v[68:71], v6 offset:25600
v_mfma_f32_16x16x32_bf16 v[156:159], v[116:119], v[108:111], v[156:159]
ds_read_b128 v[72:75], v6 offset:26624
v_mfma_f32_16x16x32_bf16 v[152:155], v[112:115], v[108:111], v[152:155]
ds_read_b128 v[76:79], v6 offset:27648
v_mfma_f32_16x16x32_bf16 v[128:131], v[208:211], v[192:195], v[128:131]
v_mfma_f32_16x16x32_bf16 v[132:135], v[212:215], v[192:195], v[132:135]
v_mfma_f32_16x16x32_bf16 v[160:163], v[216:219], v[192:195], v[160:163]
v_mfma_f32_16x16x32_bf16 v[164:167], v[220:223], v[192:195], v[164:167]
v_mfma_f32_16x16x32_bf16 v[172:175], v[220:223], v[196:199], v[172:175]
v_mfma_f32_16x16x32_bf16 v[168:171], v[216:219], v[196:199], v[168:171]
v_mfma_f32_16x16x32_bf16 v[140:143], v[212:215], v[196:199], v[140:143]
v_mfma_f32_16x16x32_bf16 v[136:139], v[208:211], v[196:199], v[136:139]
v_mfma_f32_16x16x32_bf16 v[144:147], v[208:211], v[200:203], v[144:147]
v_mfma_f32_16x16x32_bf16 v[148:151], v[212:215], v[200:203], v[148:151]
v_mfma_f32_16x16x32_bf16 v[176:179], v[216:219], v[200:203], v[176:179]
v_mfma_f32_16x16x32_bf16 v[180:183], v[220:223], v[200:203], v[180:183]
v_mfma_f32_16x16x32_bf16 v[188:191], v[220:223], v[204:207], v[188:191]
v_mfma_f32_16x16x32_bf16 v[184:187], v[216:219], v[204:207], v[184:187]
v_mfma_f32_16x16x32_bf16 v[156:159], v[212:215], v[204:207], v[156:159]
v_mfma_f32_16x16x32_bf16 v[152:155], v[208:211], v[204:207], v[152:155]
s_waitcnt lgkmcnt(0)
s_barrier
v_mfma_f32_16x16x32_bf16 v[128:131], v[48:51], v[32:35], v[128:131]
ds_read_b128 v[96:99], v6 offset:49152
ds_read_b64_tr_b16 v[112:113], v226 offset:0
v_mfma_f32_16x16x32_bf16 v[132:135], v[52:55], v[32:35], v[132:135]
ds_read_b64_tr_b16 v[114:115], v226 offset:2048
ds_read_b64_tr_b16 v[116:117], v227 offset:0
v_mfma_f32_16x16x32_bf16 v[140:143], v[52:55], v[36:39], v[140:143]
ds_read_b64_tr_b16 v[118:119], v227 offset:2048
ds_read_b128 v[100:103], v6 offset:50176
v_mfma_f32_16x16x32_bf16 v[136:139], v[48:51], v[36:39], v[136:139]
ds_read_b128 v[104:107], v6 offset:51200
ds_read_b128 v[108:111], v6 offset:52224
v_mfma_f32_16x16x32_bf16 v[144:147], v[48:51], v[40:43], v[144:147]
ds_read_b128 v[192:195], v6 offset:57344
v_mfma_f32_16x16x32_bf16 v[148:151], v[52:55], v[40:43], v[148:151]
ds_read_b64_tr_b16 v[208:209], v226 offset:4096
v_mfma_f32_16x16x32_bf16 v[156:159], v[52:55], v[44:47], v[156:159]
ds_read_b64_tr_b16 v[210:211], v226 offset:6144
v_cvt_pk_bf16_f32 v160, v160, v161
v_cvt_pk_bf16_f32 v161, v162, v163
v_mfma_f32_16x16x32_bf16 v[152:155], v[48:51], v[44:47], v[152:155]
ds_read_b64_tr_b16 v[212:213], v227 offset:4096
v_cvt_pk_bf16_f32 v162, v164, v165
v_cvt_pk_bf16_f32 v163, v166, v167
v_mfma_f32_16x16x32_bf16 v[128:131], v[80:83], v[64:67], v[128:131]
ds_read_b64_tr_b16 v[214:215], v227 offset:6144
v_cvt_pk_bf16_f32 v164, v168, v169
v_cvt_pk_bf16_f32 v165, v170, v171
v_mfma_f32_16x16x32_bf16 v[132:135], v[84:87], v[64:67], v[132:135]
ds_read_b128 v[196:199], v6 offset:58368
v_cvt_pk_bf16_f32 v166, v172, v173
v_cvt_pk_bf16_f32 v167, v174, v175
v_mfma_f32_16x16x32_bf16 v[140:143], v[84:87], v[68:71], v[140:143]
ds_read_b128 v[200:203], v6 offset:59392
v_cvt_pk_bf16_f32 v168, v176, v177
v_cvt_pk_bf16_f32 v169, v178, v179
v_mfma_f32_16x16x32_bf16 v[136:139], v[80:83], v[68:71], v[136:139]
ds_read_b128 v[204:207], v6 offset:60416
v_cvt_pk_bf16_f32 v170, v180, v181
v_cvt_pk_bf16_f32 v171, v182, v183
v_mfma_f32_16x16x32_bf16 v[144:147], v[80:83], v[72:75], v[144:147]
v_cvt_pk_bf16_f32 v172, v184, v185
v_cvt_pk_bf16_f32 v173, v186, v187
v_mfma_f32_16x16x32_bf16 v[148:151], v[84:87], v[72:75], v[148:151]
v_cvt_pk_bf16_f32 v174, v188, v189
v_cvt_pk_bf16_f32 v175, v190, v191
v_mfma_f32_16x16x32_bf16 v[156:159], v[84:87], v[76:79], v[156:159]
v_mfma_f32_16x16x32_bf16 v[152:155], v[80:83], v[76:79], v[152:155]
buffer_store_dwordx4 v[160:163], v2, s[84:87], s45 offen offset:0 sc1
s_waitcnt lgkmcnt(0)
s_barrier
v_mfma_f32_16x16x32_bf16 v[128:131], v[112:115], v[96:99], v[128:131]
ds_read_b128 v[32:35], v7 offset:16384
ds_read_b64_tr_b16 v[48:49], v228 offset:16384
v_mfma_f32_16x16x32_bf16 v[132:135], v[116:119], v[96:99], v[132:135]
ds_read_b64_tr_b16 v[50:51], v228 offset:18432
ds_read_b64_tr_b16 v[52:53], v229 offset:16384
v_mfma_f32_16x16x32_bf16 v[140:143], v[116:119], v[100:103], v[140:143]
ds_read_b64_tr_b16 v[54:55], v229 offset:18432
ds_read_b128 v[36:39], v7 offset:17408
v_mfma_f32_16x16x32_bf16 v[136:139], v[112:115], v[100:103], v[136:139]
ds_read_b128 v[40:43], v7 offset:18432
ds_read_b128 v[44:47], v7 offset:19456
v_mfma_f32_16x16x32_bf16 v[144:147], v[112:115], v[104:107], v[144:147]
ds_read_b128 v[64:67], v7 offset:24576
v_mfma_f32_16x16x32_bf16 v[148:151], v[116:119], v[104:107], v[148:151]
ds_read_b64_tr_b16 v[80:81], v228 offset:20480
v_mfma_f32_16x16x32_bf16 v[156:159], v[116:119], v[108:111], v[156:159]
ds_read_b64_tr_b16 v[82:83], v228 offset:22528
v_mfma_f32_16x16x32_bf16 v[152:155], v[112:115], v[108:111], v[152:155]
ds_read_b64_tr_b16 v[84:85], v229 offset:20480
v_mfma_f32_16x16x32_bf16 v[128:131], v[208:211], v[192:195], v[128:131]
ds_read_b64_tr_b16 v[86:87], v229 offset:22528
buffer_store_dwordx4 v[164:167], v2, s[84:87], s45 offen offset:1024 sc1
v_mfma_f32_16x16x32_bf16 v[132:135], v[212:215], v[192:195], v[132:135]
ds_read_b128 v[68:71], v7 offset:25600
v_mfma_f32_16x16x32_bf16 v[140:143], v[212:215], v[196:199], v[140:143]
ds_read_b128 v[72:75], v7 offset:26624
v_mfma_f32_16x16x32_bf16 v[136:139], v[208:211], v[196:199], v[136:139]
ds_read_b128 v[76:79], v7 offset:27648
v_mfma_f32_16x16x32_bf16 v[144:147], v[208:211], v[200:203], v[144:147]
v_mfma_f32_16x16x32_bf16 v[148:151], v[212:215], v[200:203], v[148:151]
v_mfma_f32_16x16x32_bf16 v[156:159], v[212:215], v[204:207], v[156:159]
v_mfma_f32_16x16x32_bf16 v[152:155], v[208:211], v[204:207], v[152:155]
s_waitcnt lgkmcnt(0)
s_barrier
v_mfma_f32_16x16x32_bf16 v[128:131], v[48:51], v[32:35], v[128:131]
ds_read_b128 v[96:99], v7 offset:32768
ds_read_b64_tr_b16 v[112:113], v226 offset:49152
v_mfma_f32_16x16x32_bf16 v[132:135], v[52:55], v[32:35], v[132:135]
ds_read_b64_tr_b16 v[114:115], v226 offset:51200
ds_read_b64_tr_b16 v[116:117], v227 offset:49152
v_mfma_f32_16x16x32_bf16 v[140:143], v[52:55], v[36:39], v[140:143]
ds_read_b64_tr_b16 v[118:119], v227 offset:51200
ds_read_b128 v[100:103], v7 offset:33792
v_mfma_f32_16x16x32_bf16 v[136:139], v[48:51], v[36:39], v[136:139]
ds_read_b128 v[104:107], v7 offset:34816
ds_read_b128 v[108:111], v7 offset:35840
v_mfma_f32_16x16x32_bf16 v[144:147], v[48:51], v[40:43], v[144:147]
ds_read_b128 v[192:195], v7 offset:40960
v_mfma_f32_16x16x32_bf16 v[148:151], v[52:55], v[40:43], v[148:151]
ds_read_b64_tr_b16 v[208:209], v226 offset:53248
v_mfma_f32_16x16x32_bf16 v[156:159], v[52:55], v[44:47], v[156:159]
ds_read_b64_tr_b16 v[210:211], v226 offset:55296
v_mfma_f32_16x16x32_bf16 v[152:155], v[48:51], v[44:47], v[152:155]
ds_read_b64_tr_b16 v[212:213], v227 offset:53248
v_mfma_f32_16x16x32_bf16 v[128:131], v[80:83], v[64:67], v[128:131]
ds_read_b64_tr_b16 v[214:215], v227 offset:55296
buffer_store_dwordx4 v[168:171], v2, s[84:87], s45 offen offset:2048 sc1
v_mfma_f32_16x16x32_bf16 v[132:135], v[84:87], v[64:67], v[132:135]
ds_read_b128 v[196:199], v7 offset:41984
v_mfma_f32_16x16x32_bf16 v[140:143], v[84:87], v[68:71], v[140:143]
ds_read_b128 v[200:203], v7 offset:43008
v_mfma_f32_16x16x32_bf16 v[136:139], v[80:83], v[68:71], v[136:139]
ds_read_b128 v[204:207], v7 offset:44032
v_mfma_f32_16x16x32_bf16 v[144:147], v[80:83], v[72:75], v[144:147]
v_mfma_f32_16x16x32_bf16 v[148:151], v[84:87], v[72:75], v[148:151]
v_mfma_f32_16x16x32_bf16 v[156:159], v[84:87], v[76:79], v[156:159]
v_mfma_f32_16x16x32_bf16 v[152:155], v[80:83], v[76:79], v[152:155]
s_waitcnt lgkmcnt(0)
s_barrier
v_mfma_f32_16x16x32_bf16 v[128:131], v[112:115], v[96:99], v[128:131]
ds_read_b128 v[32:35], v8 offset:0
ds_read_b64_tr_b16 v[48:49], v224 offset:0
v_mfma_f32_16x16x32_bf16 v[132:135], v[116:119], v[96:99], v[132:135]
ds_read_b64_tr_b16 v[50:51], v224 offset:2048
ds_read_b64_tr_b16 v[52:53], v225 offset:0
v_mfma_f32_16x16x32_bf16 v[140:143], v[116:119], v[100:103], v[140:143]
ds_read_b64_tr_b16 v[54:55], v225 offset:2048
ds_read_b128 v[36:39], v8 offset:1024
v_mfma_f32_16x16x32_bf16 v[136:139], v[112:115], v[100:103], v[136:139]
ds_read_b128 v[40:43], v8 offset:2048
ds_read_b128 v[44:47], v8 offset:3072
v_mfma_f32_16x16x32_bf16 v[144:147], v[112:115], v[104:107], v[144:147]
ds_read_b128 v[64:67], v8 offset:8192
v_mfma_f32_16x16x32_bf16 v[148:151], v[116:119], v[104:107], v[148:151]
s_branch Lov_15
.p2align 12
Lst_15_0:
s_branch Lst_19_0
Lst_15_1:
s_branch Lst_19_1
Lov_15:
ds_read_b64_tr_b16 v[80:81], v224 offset:4096
v_mfma_f32_16x16x32_bf16 v[156:159], v[116:119], v[108:111], v[156:159]
ds_read_b64_tr_b16 v[82:83], v224 offset:6144
v_mfma_f32_16x16x32_bf16 v[152:155], v[112:115], v[108:111], v[152:155]
ds_read_b64_tr_b16 v[84:85], v225 offset:4096
v_mfma_f32_16x16x32_bf16 v[128:131], v[208:211], v[192:195], v[128:131]
ds_read_b64_tr_b16 v[86:87], v225 offset:6144
buffer_store_dwordx4 v[172:175], v2, s[84:87], s45 offen offset:3072 sc1
v_mfma_f32_16x16x32_bf16 v[132:135], v[212:215], v[192:195], v[132:135]
ds_read_b128 v[68:71], v8 offset:9216
v_mfma_f32_16x16x32_bf16 v[140:143], v[212:215], v[196:199], v[140:143]
ds_read_b128 v[72:75], v8 offset:10240
v_mfma_f32_16x16x32_bf16 v[136:139], v[208:211], v[196:199], v[136:139]
ds_read_b128 v[76:79], v8 offset:11264
v_mfma_f32_16x16x32_bf16 v[144:147], v[208:211], v[200:203], v[144:147]
v_mfma_f32_16x16x32_bf16 v[148:151], v[212:215], v[200:203], v[148:151]
v_mfma_f32_16x16x32_bf16 v[156:159], v[212:215], v[204:207], v[156:159]
v_mfma_f32_16x16x32_bf16 v[152:155], v[208:211], v[204:207], v[152:155]
s_waitcnt lgkmcnt(0)
s_barrier
v_mfma_f32_16x16x32_bf16 v[128:131], v[48:51], v[32:35], v[128:131]
ds_read_b128 v[96:99], v6 offset:16384
ds_read_b64_tr_b16 v[112:113], v224 offset:32768
v_mfma_f32_16x16x32_bf16 v[132:135], v[52:55], v[32:35], v[132:135]
ds_read_b64_tr_b16 v[114:115], v224 offset:34816
ds_read_b64_tr_b16 v[116:117], v225 offset:32768
v_mfma_f32_16x16x32_bf16 v[140:143], v[52:55], v[36:39], v[140:143]
ds_read_b64_tr_b16 v[118:119], v225 offset:34816
ds_read_b128 v[100:103], v6 offset:17408
v_mfma_f32_16x16x32_bf16 v[136:139], v[48:51], v[36:39], v[136:139]
ds_read_b128 v[104:107], v6 offset:18432
ds_read_b128 v[108:111], v6 offset:19456
v_mfma_f32_16x16x32_bf16 v[144:147], v[48:51], v[40:43], v[144:147]
ds_read_b128 v[192:195], v6 offset:24576
v_mfma_f32_16x16x32_bf16 v[148:151], v[52:55], v[40:43], v[148:151]
ds_read_b64_tr_b16 v[208:209], v224 offset:36864
v_mfma_f32_16x16x32_bf16 v[156:159], v[52:55], v[44:47], v[156:159]
ds_read_b64_tr_b16 v[210:211], v224 offset:38912
v_mfma_f32_16x16x32_bf16 v[152:155], v[48:51], v[44:47], v[152:155]
ds_read_b64_tr_b16 v[212:213], v225 offset:36864
v_mfma_f32_16x16x32_bf16 v[128:131], v[80:83], v[64:67], v[128:131]
ds_read_b64_tr_b16 v[214:215], v225 offset:38912
v_mfma_f32_16x16x32_bf16 v[132:135], v[84:87], v[64:67], v[132:135]
ds_read_b128 v[196:199], v6 offset:25600
v_mfma_f32_16x16x32_bf16 v[140:143], v[84:87], v[68:71], v[140:143]
ds_read_b128 v[200:203], v6 offset:26624
v_mfma_f32_16x16x32_bf16 v[136:139], v[80:83], v[68:71], v[136:139]
ds_read_b128 v[204:207], v6 offset:27648
v_mfma_f32_16x16x32_bf16 v[144:147], v[80:83], v[72:75], v[144:147]
v_mfma_f32_16x16x32_bf16 v[148:151], v[84:87], v[72:75], v[148:151]
v_mfma_f32_16x16x32_bf16 v[156:159], v[84:87], v[76:79], v[156:159]
v_mfma_f32_16x16x32_bf16 v[152:155], v[80:83], v[76:79], v[152:155]
s_waitcnt vmcnt(0)
s_waitcnt lgkmcnt(0)
s_barrier
v_mfma_f32_16x16x32_bf16 v[128:131], v[112:115], v[96:99], v[128:131]
ds_read_b128 v[32:35], v6 offset:49152
ds_read_b64_tr_b16 v[48:49], v226 offset:0
v_mfma_f32_16x16x32_bf16 v[132:135], v[116:119], v[96:99], v[132:135]
ds_read_b64_tr_b16 v[50:51], v226 offset:2048
ds_read_b64_tr_b16 v[52:53], v227 offset:0
v_mfma_f32_16x16x32_bf16 v[140:143], v[116:119], v[100:103], v[140:143]
ds_read_b64_tr_b16 v[54:55], v227 offset:2048
ds_read_b128 v[36:39], v6 offset:50176
v_mfma_f32_16x16x32_bf16 v[136:139], v[112:115], v[100:103], v[136:139]
ds_read_b128 v[40:43], v6 offset:51200
ds_read_b128 v[44:47], v6 offset:52224
v_mfma_f32_16x16x32_bf16 v[144:147], v[112:115], v[104:107], v[144:147]
ds_read_b128 v[64:67], v6 offset:57344
v_mfma_f32_16x16x32_bf16 v[148:151], v[116:119], v[104:107], v[148:151]
ds_read_b64_tr_b16 v[80:81], v226 offset:4096
v_mfma_f32_16x16x32_bf16 v[156:159], v[116:119], v[108:111], v[156:159]
ds_read_b64_tr_b16 v[82:83], v226 offset:6144
v_mfma_f32_16x16x32_bf16 v[152:155], v[112:115], v[108:111], v[152:155]
ds_read_b64_tr_b16 v[84:85], v227 offset:4096
v_mfma_f32_16x16x32_bf16 v[128:131], v[208:211], v[192:195], v[128:131]
ds_read_b64_tr_b16 v[86:87], v227 offset:6144
v_mfma_f32_16x16x32_bf16 v[132:135], v[212:215], v[192:195], v[132:135]
ds_read_b128 v[68:71], v6 offset:58368
v_mfma_f32_16x16x32_bf16 v[140:143], v[212:215], v[196:199], v[140:143]
ds_read_b128 v[72:75], v6 offset:59392
v_mfma_f32_16x16x32_bf16 v[136:139], v[208:211], v[196:199], v[136:139]
ds_read_b128 v[76:79], v6 offset:60416
v_mfma_f32_16x16x32_bf16 v[144:147], v[208:211], v[200:203], v[144:147]
v_mfma_f32_16x16x32_bf16 v[148:151], v[212:215], v[200:203], v[148:151]
v_mfma_f32_16x16x32_bf16 v[156:159], v[212:215], v[204:207], v[156:159]
v_mfma_f32_16x16x32_bf16 v[152:155], v[208:211], v[204:207], v[152:155]
s_waitcnt lgkmcnt(0)
s_barrier
v_mfma_f32_16x16x32_bf16 v[128:131], v[48:51], v[32:35], v[128:131]
ds_read_b128 v[96:99], v7 offset:16384
ds_read_b64_tr_b16 v[112:113], v228 offset:16384
v_mfma_f32_16x16x32_bf16 v[132:135], v[52:55], v[32:35], v[132:135]
ds_read_b64_tr_b16 v[114:115], v228 offset:18432
ds_read_b64_tr_b16 v[116:117], v229 offset:16384
v_mfma_f32_16x16x32_bf16 v[140:143], v[52:55], v[36:39], v[140:143]
ds_read_b64_tr_b16 v[118:119], v229 offset:18432
ds_read_b128 v[100:103], v7 offset:17408
v_mfma_f32_16x16x32_bf16 v[136:139], v[48:51], v[36:39], v[136:139]
ds_read_b128 v[104:107], v7 offset:18432
ds_read_b128 v[108:111], v7 offset:19456
v_mfma_f32_16x16x32_bf16 v[144:147], v[48:51], v[40:43], v[144:147]
ds_read_b128 v[192:195], v7 offset:24576
v_mfma_f32_16x16x32_bf16 v[148:151], v[52:55], v[40:43], v[148:151]
ds_read_b64_tr_b16 v[208:209], v228 offset:20480
v_mfma_f32_16x16x32_bf16 v[156:159], v[52:55], v[44:47], v[156:159]
ds_read_b64_tr_b16 v[210:211], v228 offset:22528
v_mfma_f32_16x16x32_bf16 v[152:155], v[48:51], v[44:47], v[152:155]
ds_read_b64_tr_b16 v[212:213], v229 offset:20480
v_mfma_f32_16x16x32_bf16 v[128:131], v[80:83], v[64:67], v[128:131]
ds_read_b64_tr_b16 v[214:215], v229 offset:22528
v_mfma_f32_16x16x32_bf16 v[132:135], v[84:87], v[64:67], v[132:135]
ds_read_b128 v[196:199], v7 offset:25600
v_mfma_f32_16x16x32_bf16 v[140:143], v[84:87], v[68:71], v[140:143]
ds_read_b128 v[200:203], v7 offset:26624
v_mfma_f32_16x16x32_bf16 v[136:139], v[80:83], v[68:71], v[136:139]
ds_read_b128 v[204:207], v7 offset:27648
v_mfma_f32_16x16x32_bf16 v[144:147], v[80:83], v[72:75], v[144:147]
v_mfma_f32_16x16x32_bf16 v[148:151], v[84:87], v[72:75], v[148:151]
v_mfma_f32_16x16x32_bf16 v[156:159], v[84:87], v[76:79], v[156:159]
v_mfma_f32_16x16x32_bf16 v[152:155], v[80:83], v[76:79], v[152:155]
s_waitcnt lgkmcnt(0)
s_barrier
v_mfma_f32_16x16x32_bf16 v[128:131], v[112:115], v[96:99], v[128:131]
ds_read_b128 v[32:35], v7 offset:32768
ds_read_b64_tr_b16 v[48:49], v226 offset:49152
v_mfma_f32_16x16x32_bf16 v[132:135], v[116:119], v[96:99], v[132:135]
ds_read_b64_tr_b16 v[50:51], v226 offset:51200
ds_read_b64_tr_b16 v[52:53], v227 offset:49152
v_mfma_f32_16x16x32_bf16 v[140:143], v[116:119], v[100:103], v[140:143]
ds_read_b64_tr_b16 v[54:55], v227 offset:51200
ds_read_b128 v[36:39], v7 offset:33792
v_mfma_f32_16x16x32_bf16 v[136:139], v[112:115], v[100:103], v[136:139]
ds_read_b128 v[40:43], v7 offset:34816
ds_read_b128 v[44:47], v7 offset:35840
v_mfma_f32_16x16x32_bf16 v[144:147], v[112:115], v[104:107], v[144:147]
ds_read_b128 v[64:67], v7 offset:40960
v_mfma_f32_16x16x32_bf16 v[148:151], v[116:119], v[104:107], v[148:151]
ds_read_b64_tr_b16 v[80:81], v226 offset:53248
v_mfma_f32_16x16x32_bf16 v[156:159], v[116:119], v[108:111], v[156:159]
ds_read_b64_tr_b16 v[82:83], v226 offset:55296
v_mfma_f32_16x16x32_bf16 v[152:155], v[112:115], v[108:111], v[152:155]
ds_read_b64_tr_b16 v[84:85], v227 offset:53248
v_mfma_f32_16x16x32_bf16 v[128:131], v[208:211], v[192:195], v[128:131]
ds_read_b64_tr_b16 v[86:87], v227 offset:55296
v_mfma_f32_16x16x32_bf16 v[132:135], v[212:215], v[192:195], v[132:135]
ds_read_b128 v[68:71], v7 offset:41984
v_mfma_f32_16x16x32_bf16 v[140:143], v[212:215], v[196:199], v[140:143]
ds_read_b128 v[72:75], v7 offset:43008
v_mfma_f32_16x16x32_bf16 v[136:139], v[208:211], v[196:199], v[136:139]
ds_read_b128 v[76:79], v7 offset:44032
v_mfma_f32_16x16x32_bf16 v[144:147], v[208:211], v[200:203], v[144:147]
v_mfma_f32_16x16x32_bf16 v[148:151], v[212:215], v[200:203], v[148:151]
v_mfma_f32_16x16x32_bf16 v[156:159], v[212:215], v[204:207], v[156:159]
v_mfma_f32_16x16x32_bf16 v[152:155], v[208:211], v[204:207], v[152:155]
s_waitcnt lgkmcnt(0)
s_barrier
buffer_load_dwordx4 v[232:235], v2, s[84:87], s46 offen offset:0 sc1
buffer_load_dwordx4 v[236:239], v2, s[84:87], s46 offen offset:1024 sc1
buffer_load_dwordx4 v[240:243], v2, s[84:87], s46 offen offset:2048 sc1
buffer_load_dwordx4 v[244:247], v2, s[84:87], s46 offen offset:3072 sc1
v_mfma_f32_16x16x32_bf16 v[128:131], v[48:51], v[32:35], v[128:131]
ds_read_b128 v[96:99], v8 offset:0
ds_read_b64_tr_b16 v[112:113], v224 offset:0
v_mfma_f32_16x16x32_bf16 v[132:135], v[52:55], v[32:35], v[132:135]
ds_read_b64_tr_b16 v[114:115], v224 offset:2048
ds_read_b64_tr_b16 v[116:117], v225 offset:0
v_mfma_f32_16x16x32_bf16 v[140:143], v[52:55], v[36:39], v[140:143]
ds_read_b64_tr_b16 v[118:119], v225 offset:2048
ds_read_b128 v[100:103], v8 offset:1024
v_mfma_f32_16x16x32_bf16 v[136:139], v[48:51], v[36:39], v[136:139]
ds_read_b128 v[104:107], v8 offset:2048
ds_read_b128 v[108:111], v8 offset:3072
v_mfma_f32_16x16x32_bf16 v[144:147], v[48:51], v[40:43], v[144:147]
ds_read_b128 v[192:195], v8 offset:8192
v_mfma_f32_16x16x32_bf16 v[148:151], v[52:55], v[40:43], v[148:151]
ds_read_b64_tr_b16 v[208:209], v224 offset:4096
v_mfma_f32_16x16x32_bf16 v[156:159], v[52:55], v[44:47], v[156:159]
ds_read_b64_tr_b16 v[210:211], v224 offset:6144
v_mfma_f32_16x16x32_bf16 v[152:155], v[48:51], v[44:47], v[152:155]
ds_read_b64_tr_b16 v[212:213], v225 offset:4096
v_mfma_f32_16x16x32_bf16 v[128:131], v[80:83], v[64:67], v[128:131]
ds_read_b64_tr_b16 v[214:215], v225 offset:6144
v_mfma_f32_16x16x32_bf16 v[132:135], v[84:87], v[64:67], v[132:135]
ds_read_b128 v[196:199], v8 offset:9216
v_mfma_f32_16x16x32_bf16 v[140:143], v[84:87], v[68:71], v[140:143]
ds_read_b128 v[200:203], v8 offset:10240
v_mfma_f32_16x16x32_bf16 v[136:139], v[80:83], v[68:71], v[136:139]
ds_read_b128 v[204:207], v8 offset:11264
v_mfma_f32_16x16x32_bf16 v[144:147], v[80:83], v[72:75], v[144:147]
v_mfma_f32_16x16x32_bf16 v[148:151], v[84:87], v[72:75], v[148:151]
v_mfma_f32_16x16x32_bf16 v[156:159], v[84:87], v[76:79], v[156:159]
v_mfma_f32_16x16x32_bf16 v[152:155], v[80:83], v[76:79], v[152:155]
s_waitcnt lgkmcnt(0)
s_barrier
v_mfma_f32_16x16x32_bf16 v[128:131], v[112:115], v[96:99], v[128:131]
ds_read_b128 v[32:35], v6 offset:16384
ds_read_b64_tr_b16 v[48:49], v224 offset:32768
v_mfma_f32_16x16x32_bf16 v[132:135], v[116:119], v[96:99], v[132:135]
ds_read_b64_tr_b16 v[50:51], v224 offset:34816
ds_read_b64_tr_b16 v[52:53], v225 offset:32768
v_mfma_f32_16x16x32_bf16 v[140:143], v[116:119], v[100:103], v[140:143]
ds_read_b64_tr_b16 v[54:55], v225 offset:34816
ds_read_b128 v[36:39], v6 offset:17408
v_mfma_f32_16x16x32_bf16 v[136:139], v[112:115], v[100:103], v[136:139]
ds_read_b128 v[40:43], v6 offset:18432
ds_read_b128 v[44:47], v6 offset:19456
v_mfma_f32_16x16x32_bf16 v[144:147], v[112:115], v[104:107], v[144:147]
ds_read_b128 v[64:67], v6 offset:24576
v_mfma_f32_16x16x32_bf16 v[148:151], v[116:119], v[104:107], v[148:151]
ds_read_b64_tr_b16 v[80:81], v224 offset:36864
v_mfma_f32_16x16x32_bf16 v[156:159], v[116:119], v[108:111], v[156:159]
ds_read_b64_tr_b16 v[82:83], v224 offset:38912
v_mfma_f32_16x16x32_bf16 v[152:155], v[112:115], v[108:111], v[152:155]
ds_read_b64_tr_b16 v[84:85], v225 offset:36864
v_mfma_f32_16x16x32_bf16 v[128:131], v[208:211], v[192:195], v[128:131]
ds_read_b64_tr_b16 v[86:87], v225 offset:38912
v_mfma_f32_16x16x32_bf16 v[132:135], v[212:215], v[192:195], v[132:135]
ds_read_b128 v[68:71], v6 offset:25600
v_mfma_f32_16x16x32_bf16 v[140:143], v[212:215], v[196:199], v[140:143]
ds_read_b128 v[72:75], v6 offset:26624
v_mfma_f32_16x16x32_bf16 v[136:139], v[208:211], v[196:199], v[136:139]
ds_read_b128 v[76:79], v6 offset:27648
v_mfma_f32_16x16x32_bf16 v[144:147], v[208:211], v[200:203], v[144:147]
v_mfma_f32_16x16x32_bf16 v[148:151], v[212:215], v[200:203], v[148:151]
v_mfma_f32_16x16x32_bf16 v[156:159], v[212:215], v[204:207], v[156:159]
v_mfma_f32_16x16x32_bf16 v[152:155], v[208:211], v[204:207], v[152:155]
s_waitcnt lgkmcnt(0)
s_barrier
v_mfma_f32_16x16x32_bf16 v[128:131], v[48:51], v[32:35], v[128:131]
ds_read_b128 v[96:99], v6 offset:49152
ds_read_b64_tr_b16 v[112:113], v226 offset:0
v_mfma_f32_16x16x32_bf16 v[132:135], v[52:55], v[32:35], v[132:135]
ds_read_b64_tr_b16 v[114:115], v226 offset:2048
ds_read_b64_tr_b16 v[116:117], v227 offset:0
v_mfma_f32_16x16x32_bf16 v[140:143], v[52:55], v[36:39], v[140:143]
ds_read_b64_tr_b16 v[118:119], v227 offset:2048
ds_read_b128 v[100:103], v6 offset:50176
v_mfma_f32_16x16x32_bf16 v[136:139], v[48:51], v[36:39], v[136:139]
ds_read_b128 v[104:107], v6 offset:51200
ds_read_b128 v[108:111], v6 offset:52224
v_mfma_f32_16x16x32_bf16 v[144:147], v[48:51], v[40:43], v[144:147]
ds_read_b128 v[192:195], v6 offset:57344
v_mfma_f32_16x16x32_bf16 v[148:151], v[52:55], v[40:43], v[148:151]
ds_read_b64_tr_b16 v[208:209], v226 offset:4096
v_mfma_f32_16x16x32_bf16 v[156:159], v[52:55], v[44:47], v[156:159]
ds_read_b64_tr_b16 v[210:211], v226 offset:6144
v_mfma_f32_16x16x32_bf16 v[152:155], v[48:51], v[44:47], v[152:155]
ds_read_b64_tr_b16 v[212:213], v227 offset:4096
v_mfma_f32_16x16x32_bf16 v[128:131], v[80:83], v[64:67], v[128:131]
ds_read_b64_tr_b16 v[214:215], v227 offset:6144
v_mfma_f32_16x16x32_bf16 v[132:135], v[84:87], v[64:67], v[132:135]
ds_read_b128 v[196:199], v6 offset:58368
v_mfma_f32_16x16x32_bf16 v[140:143], v[84:87], v[68:71], v[140:143]
ds_read_b128 v[200:203], v6 offset:59392
v_mfma_f32_16x16x32_bf16 v[136:139], v[80:83], v[68:71], v[136:139]
ds_read_b128 v[204:207], v6 offset:60416
v_mfma_f32_16x16x32_bf16 v[144:147], v[80:83], v[72:75], v[144:147]
v_mfma_f32_16x16x32_bf16 v[148:151], v[84:87], v[72:75], v[148:151]
v_mfma_f32_16x16x32_bf16 v[156:159], v[84:87], v[76:79], v[156:159]
v_mfma_f32_16x16x32_bf16 v[152:155], v[80:83], v[76:79], v[152:155]
s_waitcnt vmcnt(0)
s_waitcnt lgkmcnt(0)
s_barrier
v_mfma_f32_16x16x32_bf16 v[128:131], v[112:115], v[96:99], v[128:131]
v_lshlrev_b32 v160, 16, v232
v_and_b32 v161, 0xffff0000, v232
v_mfma_f32_16x16x32_bf16 v[132:135], v[116:119], v[96:99], v[132:135]
v_lshlrev_b32 v162, 16, v233
v_and_b32 v163, 0xffff0000, v233
v_mfma_f32_16x16x32_bf16 v[140:143], v[116:119], v[100:103], v[140:143]
v_lshlrev_b32 v164, 16, v234
v_and_b32 v165, 0xffff0000, v234
v_mfma_f32_16x16x32_bf16 v[136:139], v[112:115], v[100:103], v[136:139]
v_lshlrev_b32 v166, 16, v235
v_and_b32 v167, 0xffff0000, v235
v_mfma_f32_16x16x32_bf16 v[144:147], v[112:115], v[104:107], v[144:147]
v_lshlrev_b32 v168, 16, v236
v_and_b32 v169, 0xffff0000, v236
v_mfma_f32_16x16x32_bf16 v[148:151], v[116:119], v[104:107], v[148:151]
v_lshlrev_b32 v170, 16, v237
v_and_b32 v171, 0xffff0000, v237
v_mfma_f32_16x16x32_bf16 v[156:159], v[116:119], v[108:111], v[156:159]
v_lshlrev_b32 v172, 16, v238
v_and_b32 v173, 0xffff0000, v238
v_mfma_f32_16x16x32_bf16 v[152:155], v[112:115], v[108:111], v[152:155]
v_lshlrev_b32 v174, 16, v239
v_and_b32 v175, 0xffff0000, v239
v_mfma_f32_16x16x32_bf16 v[128:131], v[208:211], v[192:195], v[128:131]
v_lshlrev_b32 v176, 16, v240
v_and_b32 v177, 0xffff0000, v240
v_mfma_f32_16x16x32_bf16 v[132:135], v[212:215], v[192:195], v[132:135]
v_lshlrev_b32 v178, 16, v241
v_and_b32 v179, 0xffff0000, v241
v_mfma_f32_16x16x32_bf16 v[140:143], v[212:215], v[196:199], v[140:143]
v_lshlrev_b32 v180, 16, v242
v_and_b32 v181, 0xffff0000, v242
v_mfma_f32_16x16x32_bf16 v[136:139], v[208:211], v[196:199], v[136:139]
v_lshlrev_b32 v182, 16, v243
v_and_b32 v183, 0xffff0000, v243
v_mfma_f32_16x16x32_bf16 v[144:147], v[208:211], v[200:203], v[144:147]
v_lshlrev_b32 v184, 16, v244
v_and_b32 v185, 0xffff0000, v244
v_mfma_f32_16x16x32_bf16 v[148:151], v[212:215], v[200:203], v[148:151]
v_lshlrev_b32 v186, 16, v245
v_and_b32 v187, 0xffff0000, v245
v_mfma_f32_16x16x32_bf16 v[156:159], v[212:215], v[204:207], v[156:159]
v_lshlrev_b32 v188, 16, v246
v_and_b32 v189, 0xffff0000, v246
v_mfma_f32_16x16x32_bf16 v[152:155], v[208:211], v[204:207], v[152:155]
v_lshlrev_b32 v190, 16, v247
v_and_b32 v191, 0xffff0000, v247
s_nop 1
v_pk_add_f32 v[128:129], v[128:129], v[160:161]
v_pk_add_f32 v[130:131], v[130:131], v[162:163]
v_pk_add_f32 v[132:133], v[132:133], v[164:165]
v_pk_add_f32 v[134:135], v[134:135], v[166:167]
v_cvt_pk_bf16_f32 v32, v128, v129
v_cvt_pk_bf16_f32 v33, v130, v131
v_cvt_pk_bf16_f32 v34, v132, v133
v_cvt_pk_bf16_f32 v35, v134, v135
v_pk_add_f32 v[136:137], v[136:137], v[168:169]
v_pk_add_f32 v[138:139], v[138:139], v[170:171]
v_pk_add_f32 v[140:141], v[140:141], v[172:173]
v_pk_add_f32 v[142:143], v[142:143], v[174:175]
v_cvt_pk_bf16_f32 v36, v136, v137
v_cvt_pk_bf16_f32 v37, v138, v139
v_cvt_pk_bf16_f32 v38, v140, v141
v_cvt_pk_bf16_f32 v39, v142, v143
v_permlane16_swap_b32 v32, v34
v_permlane16_swap_b32 v33, v35
buffer_store_dwordx4 v[32:35], v230, s[20:23], s54 offen offset:0
v_pk_add_f32 v[144:145], v[144:145], v[176:177]
v_pk_add_f32 v[146:147], v[146:147], v[178:179]
v_pk_add_f32 v[148:149], v[148:149], v[180:181]
v_pk_add_f32 v[150:151], v[150:151], v[182:183]
v_cvt_pk_bf16_f32 v40, v144, v145
v_cvt_pk_bf16_f32 v41, v146, v147
v_cvt_pk_bf16_f32 v42, v148, v149
v_cvt_pk_bf16_f32 v43, v150, v151
v_permlane16_swap_b32 v36, v38
v_permlane16_swap_b32 v37, v39
buffer_store_dwordx4 v[36:39], v230, s[20:23], s54 offen offset:2048
v_pk_add_f32 v[152:153], v[152:153], v[184:185]
v_pk_add_f32 v[154:155], v[154:155], v[186:187]
v_pk_add_f32 v[156:157], v[156:157], v[188:189]
v_pk_add_f32 v[158:159], v[158:159], v[190:191]
v_cvt_pk_bf16_f32 v44, v152, v153
v_cvt_pk_bf16_f32 v45, v154, v155
v_cvt_pk_bf16_f32 v46, v156, v157
v_cvt_pk_bf16_f32 v47, v158, v159
v_permlane16_swap_b32 v40, v42
v_permlane16_swap_b32 v41, v43
buffer_store_dwordx4 v[40:43], v230, s[20:23], s55 offen offset:0
s_nop 1
v_permlane16_swap_b32 v44, v46
v_permlane16_swap_b32 v45, v47
buffer_store_dwordx4 v[44:47], v230, s[20:23], s55 offen offset:2048
s_branch Ldone_1
Lgb_82:
s_bitcmp0_b32 s36, 1
s_cselect_b32 s44, s72, s74
s_cselect_b32 s45, s73, s75
s_mul_i32 s43, s35, 192
s_add_u32 s16, s44, s43
s_addc_u32 s17, s45, 0
s_add_u32 s16, s16, 4096
s_addc_u32 s17, s17, 0
s_mov_b32 s18, 7333056
s_mov_b32 s19, 0x20000
v_add_u32 v28, 0, v1
v_mul_u32_u24 v29, 5462, v28
v_lshrrev_b32 v29, 16, v29
v_mul_u32_u24 v30, 12, v29
v_sub_u32 v30, v28, v30
v_bfe_u32 v31, v29, 2, 1
v_cmp_gt_u32 vcc, 8, v30
v_lshlrev_b32 v32, 1, v31
v_mul_u32_u24 v29, 7168, v29
v_cndmask_b32 v31, v31, v32, vcc
v_xor_b32 v30, v30, v31
v_lshl_add_u32 v6, v30, 4, v29
v_add_u32 v28, 64, v1
v_mul_u32_u24 v29, 5462, v28
v_lshrrev_b32 v29, 16, v29
v_mul_u32_u24 v30, 12, v29
v_sub_u32 v30, v28, v30
v_bfe_u32 v31, v29, 2, 1
v_cmp_gt_u32 vcc, 8, v30
v_lshlrev_b32 v32, 1, v31
v_mul_u32_u24 v29, 7168, v29
v_cndmask_b32 v31, v31, v32, vcc
v_xor_b32 v30, v30, v31
v_lshl_add_u32 v7, v30, 4, v29
v_add_u32 v28, 128, v1
v_mul_u32_u24 v29, 5462, v28
v_lshrrev_b32 v29, 16, v29
v_mul_u32_u24 v30, 12, v29
v_sub_u32 v30, v28, v30
v_bfe_u32 v31, v29, 2, 1
v_cmp_gt_u32 vcc, 8, v30
v_lshlrev_b32 v32, 1, v31
v_mul_u32_u24 v29, 7168, v29
v_cndmask_b32 v31, v31, v32, vcc
v_xor_b32 v30, v30, v31
v_lshl_add_u32 v8, v30, 4, v29
s_and_b32 s43, s36, 1
s_mul_i32 s43, s43, 229376
v_add_u32 v6, s43, v6
v_add_u32 v7, s43, v7
v_add_u32 v8, s43, v8
s_and_b32 s43, s36, 3
s_mul_i32 s50, s43, 6144
s_add_u32 s50, s50, 16384
s_mul_i32 s43, s34, 16384
s_add_u32 s20, s82, s43
s_addc_u32 s21, s83, 0
s_add_u32 s20, s20, 25165824
s_addc_u32 s21, s21, 0
s_mov_b32 s22, 16384
s_mov_b32 s23, 0x20000
v_bfe_u32 v28, v1, 3, 1
v_lshlrev_b32 v28, 6, v28
v_bfe_u32 v29, v1, 1, 2
s_lshl_b32 s43, s48, 3
s_lshl_b32 s44, s63, 2
s_add_u32 s43, s43, s44
v_add3_u32 v28, v28, v29, s43
v_mul_u32_u24 v28, 7168, v28
v_and_b32 v29, 1, v1
v_mul_u32_u24 v29, 188, v29
v_add_u32 v26, v28, v29
s_bitcmp0_b32 s2, 0
s_cselect_b32 s88, s72, s74
s_cselect_b32 s89, s73, s75
s_mov_b32 s90, 7340032
s_mov_b32 s91, 0x20000
s_bfe_u32 s44, s2, 0x30001
s_lshl_b32 s44, s44, 2
s_and_b32 s43, s36, 3
s_add_u32 s44, s44, s43
s_lshl_b32 s44, s44, 5
v_lshrrev_b32 v24, 4, v1
v_add_u32 v24, s44, v24
v_mul_u32_u24 v24, 7168, v24
v_and_b32 v25, 15, v1
v_lshl_add_u32 v24, v25, 4, v24
s_lshr_b32 s43, s2, 4
s_lshl_b32 s43, s43, 8
v_add_u32 v24, s43, v24
s_mov_b32 s38, 1835008
buffer_load_dword v27, v26, s[16:19], s38 offen
s_mov_b32 s38, 2752512
buffer_load_dword v27, v26, s[16:19], s38 offen
s_cmp_eq_u32 s47, 0
s_cbranch_scc0 Lw_102
s_lshl_b32 s92, s34, 7
s_add_u32 s92, s92, 28313600
s_mov_b32 s41, 0x40000
Lpoll_103:
s_load_dword s93, s[82:83], s92 glc
Lpchk_105:
s_waitcnt lgkmcnt(0)
s_cmp_eq_u32 s93, 16
s_cbranch_scc1 Lpok_104
s_sub_u32 s41, s41, 1
s_cmp_lg_u32 s41, 0
s_cbranch_scc1 Lpoll_103
Lpok_104:
Lw_102:
s_barrier
s_add_u32 m0, s39, 0
s_mov_b32 s37, 0
buffer_load_dwordx4 v3, s[8:11], s37 offen sc1 lds
buffer_load_dwordx4 v3, s[8:11], s37 offen offset:1024 sc1 lds
buffer_load_dwordx4 v3, s[8:11], s37 offen offset:2048 sc1 lds
buffer_load_dwordx4 v3, s[8:11], s37 offen offset:3072 sc1 lds
buffer_load_dwordx4 v[96:99], v3, s[20:23], 0 offen offset:0 sc1
buffer_load_dwordx4 v[100:103], v3, s[20:23], 0 offen offset:1024 sc1
buffer_load_dwordx4 v[104:107], v3, s[20:23], 0 offen offset:2048 sc1
buffer_load_dwordx4 v[108:111], v3, s[20:23], 0 offen offset:3072 sc1
s_add_u32 m0, s39, 49152
s_mov_b32 s37, 16384
buffer_load_dwordx4 v3, s[8:11], s37 offen sc1 lds
buffer_load_dwordx4 v3, s[8:11], s37 offen offset:1024 sc1 lds
buffer_load_dwordx4 v3, s[8:11], s37 offen offset:2048 sc1 lds
buffer_load_dwordx4 v3, s[8:11], s37 offen offset:3072 sc1 lds
s_add_u32 m0, s50, 98304
s_mov_b32 s38, 917504
buffer_load_dwordx4 v6, s[16:19], s38 offen lds
s_add_u32 m0, s50, 99328
s_mov_b32 s38, 917504
buffer_load_dwordx4 v7, s[16:19], s38 offen lds
s_add_u32 m0, s50, 100352
s_mov_b32 s38, 917504
buffer_load_dwordx4 v8, s[16:19], s38 offen lds
s_add_u32 m0, s50, 101376
s_mov_b32 s38, 1032192
buffer_load_dwordx4 v6, s[16:19], s38 offen lds
s_add_u32 m0, s50, 102400
s_mov_b32 s38, 1032192
buffer_load_dwordx4 v7, s[16:19], s38 offen lds
s_add_u32 m0, s50, 103424
s_mov_b32 s38, 1032192
buffer_load_dwordx4 v8, s[16:19], s38 offen lds
s_add_u32 m0, s39, 98304
s_mov_b32 s37, 32768
buffer_load_dwordx4 v3, s[8:11], s37 offen sc1 lds
buffer_load_dwordx4 v3, s[8:11], s37 offen offset:1024 sc1 lds
buffer_load_dwordx4 v3, s[8:11], s37 offen offset:2048 sc1 lds
buffer_load_dwordx4 v3, s[8:11], s37 offen offset:3072 sc1 lds
s_waitcnt vmcnt(18)
s_barrier
s_and_b32 s44, s36, 3
s_mul_i32 s44, s44, 17
s_bfe_u32 s43, s2, 0x30001
s_lshl_b32 s43, s43, 7
s_add_u32 s44, s44, s43
s_add_u32 s44, s44, 60
s_mul_i32 s44, s44, 7168
s_lshr_b32 s43, s2, 4
s_lshl_b32 s43, s43, 8
s_add_u32 s43, s43, s44
s_bitcmp0_b32 s2, 0
s_cselect_b32 s4, s72, s74
s_cselect_b32 s5, s73, s75
s_add_u32 s4, s4, s43
s_addc_u32 s5, s5, 0
s_waitcnt vmcnt(10)
s_barrier
s_cmp_eq_u32 s47, 3
s_cbranch_scc0 Lw_106
v_and_b32 v30, 31, v1
v_lshlrev_b32 v30, 4, v30
v_add_u32 v31, 151552, v30
ds_read_b128 v[112:115], v31 offset:0
ds_read_b128 v[116:119], v31 offset:512
ds_read_b128 v[120:123], v31 offset:1024
ds_read_b128 v[124:127], v31 offset:1536
s_and_b32 s44, s2, 15
s_mul_i32 s44, s44, 14336
s_lshr_b32 s43, s2, 4
s_lshl_b32 s43, s43, 9
s_add_u32 s44, s44, s43
s_add_u32 s44, s44, 8192
s_cmp_lt_u32 s2, 192
s_cselect_b32 s44, s44, 0x7fffffff
s_waitcnt lgkmcnt(0)
v_add_f32 v112, v112, v116
v_add_f32 v120, v120, v124
v_add_f32 v113, v113, v117
v_add_f32 v121, v121, v125
v_add_f32 v114, v114, v118
v_add_f32 v122, v122, v126
v_add_f32 v115, v115, v119
v_add_f32 v123, v123, v127
v_add_f32 v112, v112, v120
v_add_f32 v113, v113, v121
v_add_f32 v114, v114, v122
v_add_f32 v115, v115, v123
s_mov_b64 exec, 0xffffffff
buffer_store_dwordx4 v[112:115], v30, s[84:87], s44 offen sc1
s_mov_b64 exec, -1
Lw_106:
s_waitcnt lgkmcnt(0)
s_add_u32 m0, s39, 0
s_mov_b32 s37, 49152
buffer_load_dwordx4 v3, s[8:11], s37 offen sc1 lds
s_load_dword s3, s[4:5], 78976
s_load_dword s3, s[4:5], 79040
s_load_dword s3, s[4:5], 86016
s_load_dword s3, s[4:5], 86080
buffer_load_dwordx4 v3, s[8:11], s37 offen offset:1024 sc1 lds
s_load_dword s3, s[4:5], 86144
s_load_dword s3, s[4:5], 86208
s_load_dword s3, s[4:5], 93184
s_load_dword s3, s[4:5], 93248
buffer_load_dwordx4 v3, s[8:11], s37 offen offset:2048 sc1 lds
s_load_dword s3, s[4:5], 93312
s_load_dword s3, s[4:5], 93376
v_add_f32 v96, v96, v100
v_add_f32 v97, v97, v101
buffer_load_dwordx4 v3, s[8:11], s37 offen offset:3072 sc1 lds
v_add_f32 v98, v98, v102
v_add_f32 v99, v99, v103
v_add_f32 v104, v104, v108
v_add_f32 v105, v105, v109
s_add_u32 m0, s50, 0
s_mov_b32 s38, 1376256
buffer_load_dwordx4 v6, s[16:19], s38 offen lds
v_add_f32 v106, v106, v110
v_add_f32 v107, v107, v111
s_nop 0
v_permlane32_swap_b32 v96, v104
s_add_u32 m0, s50, 1024
s_mov_b32 s38, 1376256
buffer_load_dwordx4 v7, s[16:19], s38 offen lds
v_permlane32_swap_b32 v97, v105
v_permlane32_swap_b32 v98, v106
v_permlane32_swap_b32 v99, v107
v_add_f32 v96, v96, v104
s_branch Lov_16
.p2align 12
Lst_16_0:
s_branch Lst_20_0
Lst_16_1:
s_branch Lst_20_1
Lov_16:
s_add_u32 m0, s50, 2048
s_mov_b32 s38, 1376256
buffer_load_dwordx4 v8, s[16:19], s38 offen lds
v_add_f32 v97, v97, v105
v_add_f32 v98, v98, v106
v_add_f32 v99, v99, v107
v_mov_b32 v100, v96
s_add_u32 m0, s50, 3072
s_mov_b32 s38, 1490944
buffer_load_dwordx4 v6, s[16:19], s38 offen lds
v_mov_b32 v101, v97
v_mov_b32 v102, v98
v_mov_b32 v103, v99
s_nop 0
s_add_u32 m0, s50, 4096
s_mov_b32 s38, 1490944
buffer_load_dwordx4 v7, s[16:19], s38 offen lds
v_permlane16_swap_b32 v96, v100
v_permlane16_swap_b32 v97, v101
v_permlane16_swap_b32 v98, v102
v_permlane16_swap_b32 v99, v103
s_add_u32 m0, s50, 5120
s_mov_b32 s38, 1490944
buffer_load_dwordx4 v8, s[16:19], s38 offen lds
s_mov_b32 s38, 3670016
buffer_load_dword v27, v26, s[16:19], s38 offen
s_waitcnt vmcnt(11)
s_barrier
s_add_u32 m0, s39, 49152
s_mov_b32 s37, 65536
buffer_load_dwordx4 v3, s[8:11], s37 offen sc1 lds
v_add_f32 v96, v96, v100
v_add_f32 v97, v97, v101
v_add_f32 v98, v98, v102
buffer_load_dwordx4 v3, s[8:11], s37 offen offset:1024 sc1 lds
v_add_f32 v99, v99, v103
s_nop 0
v_add_f32_dpp v96, v96, v96 row_ror:8 row_mask:0xf bank_mask:0xf
buffer_load_dwordx4 v3, s[8:11], s37 offen offset:2048 sc1 lds
v_add_f32_dpp v97, v97, v97 row_ror:8 row_mask:0xf bank_mask:0xf
v_add_f32_dpp v98, v98, v98 row_ror:8 row_mask:0xf bank_mask:0xf
v_add_f32_dpp v99, v99, v99 row_ror:8 row_mask:0xf bank_mask:0xf
v_mul_f32 v96, 0x3a800000, v96
buffer_load_dwordx4 v3, s[8:11], s37 offen offset:3072 sc1 lds
v_mul_f32 v97, 0x3a800000, v97
v_mul_f32 v98, 0x3a800000, v98
v_mul_f32 v99, 0x3a800000, v99
s_add_u32 m0, s50, 49152
s_mov_b32 s38, 1835008
buffer_load_dwordx4 v6, s[16:19], s38 offen lds
v_fma_f32 v97, -v96, v96, v97
v_fma_f32 v99, -v98, v98, v99
v_max_f32 v97, 0, v97
s_add_u32 m0, s50, 50176
s_mov_b32 s38, 1835008
buffer_load_dwordx4 v7, s[16:19], s38 offen lds
v_max_f32 v99, 0, v99
v_add_f32 v97, 0x3727c5ac, v97
v_add_f32 v99, 0x3727c5ac, v99
v_rsq_f32 v97, v97
s_add_u32 m0, s50, 51200
s_mov_b32 s38, 1835008
buffer_load_dwordx4 v8, s[16:19], s38 offen lds
v_rsq_f32 v99, v99
v_and_b32 v100, 7, v1
s_lshl_b32 s43, s47, 8
s_add_u32 m0, s50, 52224
s_mov_b32 s38, 1949696
buffer_load_dwordx4 v6, s[16:19], s38 offen lds
s_add_u32 s43, s43, 147456
v_lshl_add_u32 v100, v100, 4, s43
v_lshrrev_b32 v101, 5, v1
v_lshl_add_u32 v100, v101, 7, v100
s_add_u32 m0, s50, 53248
s_mov_b32 s38, 1949696
buffer_load_dwordx4 v7, s[16:19], s38 offen lds
s_add_u32 m0, s50, 54272
s_mov_b32 s38, 1949696
buffer_load_dwordx4 v8, s[16:19], s38 offen lds
s_waitcnt vmcnt(11)
s_barrier
s_cmp_eq_u32 s47, 3
s_cbranch_scc0 Lw_107
s_cmp_lt_u32 s2, 192
s_cbranch_scc0 Lw_107
s_lshr_b32 s43, s2, 4
s_add_u32 s43, s43, 96
s_lshl_b32 s43, s43, 7
v_mov_b32 v30, s43
v_mov_b32 v31, 1
s_mov_b64 exec, 1
buffer_atomic_add v31, v30, s[56:59], 0 offen sc1
s_mov_b64 exec, -1
Lw_107:
ds_write_b128 v100, v[96:99]
s_waitcnt lgkmcnt(0)
s_add_u32 m0, s39, 98304
s_mov_b32 s37, 81920
buffer_load_dwordx4 v3, s[8:11], s37 offen sc1 lds
s_load_dword s3, s[4:5], 100352
buffer_load_dwordx4 v3, s[8:11], s37 offen offset:1024 sc1 lds
s_load_dword s3, s[4:5], 100416
buffer_load_dwordx4 v3, s[8:11], s37 offen offset:2048 sc1 lds
s_load_dword s3, s[4:5], 100480
buffer_load_dwordx4 v3, s[8:11], s37 offen offset:3072 sc1 lds
s_load_dword s3, s[4:5], 100544
s_add_u32 m0, s50, 98304
s_mov_b32 s38, 2293760
buffer_load_dwordx4 v6, s[16:19], s38 offen lds
s_load_dword s3, s[4:5], 107520
s_add_u32 m0, s50, 99328
s_mov_b32 s38, 2293760
buffer_load_dwordx4 v7, s[16:19], s38 offen lds
s_load_dword s3, s[4:5], 107584
s_add_u32 m0, s50, 100352
s_mov_b32 s38, 2293760
buffer_load_dwordx4 v8, s[16:19], s38 offen lds
s_load_dword s3, s[4:5], 107648
s_add_u32 m0, s50, 101376
s_mov_b32 s38, 2408448
buffer_load_dwordx4 v6, s[16:19], s38 offen lds
s_load_dword s3, s[4:5], 107712
s_add_u32 m0, s50, 102400
s_mov_b32 s38, 2408448
buffer_load_dwordx4 v7, s[16:19], s38 offen lds
s_load_dword s3, s[4:5], 114688
s_load_dword s3, s[4:5], 114752
s_add_u32 m0, s50, 103424
s_mov_b32 s38, 2408448
buffer_load_dwordx4 v8, s[16:19], s38 offen lds
s_mov_b32 s38, 4587520
buffer_load_dword v27, v26, s[16:19], s38 offen
s_waitcnt vmcnt(11)
s_barrier
s_add_u32 m0, s39, 0
s_mov_b32 s37, 98304
buffer_load_dwordx4 v3, s[8:11], s37 offen sc1 lds
v_lshrrev_b32 v28, 2, v1
v_and_b32 v29, 7, v28
buffer_load_dwordx4 v3, s[8:11], s37 offen offset:1024 sc1 lds
v_mul_u32_u24 v28, 256, v28
v_lshl_add_u32 v28, v29, 5, v28
v_and_b32 v29, 3, v1
buffer_load_dwordx4 v3, s[8:11], s37 offen offset:2048 sc1 lds
v_lshl_add_u32 v11, v29, 3, v28
s_lshl_b32 s43, s63, 7
buffer_load_dwordx4 v3, s[8:11], s37 offen offset:3072 sc1 lds
v_xor_b32 v11, s43, v11
v_add_u32 v11, 16384, v11
v_xor_b32 v12, 32, v11
s_add_u32 m0, s50, 0
s_mov_b32 s38, 2752512
buffer_load_dwordx4 v6, s[16:19], s38 offen lds
v_xor_b32 v13, 64, v11
v_xor_b32 v14, 96, v11
s_add_u32 m0, s50, 1024
s_mov_b32 s38, 2752512
buffer_load_dwordx4 v7, s[16:19], s38 offen lds
v_add_u32 v15, 49152, v11
v_add_u32 v16, 49152, v12
v_add_u32 v17, 49152, v13
s_add_u32 m0, s50, 2048
s_mov_b32 s38, 2752512
buffer_load_dwordx4 v8, s[16:19], s38 offen lds
v_add_u32 v18, 49152, v14
v_add_u32 v19, 98304, v11
s_add_u32 m0, s50, 3072
s_mov_b32 s38, 2867200
buffer_load_dwordx4 v6, s[16:19], s38 offen lds
v_add_u32 v20, 98304, v12
v_add_u32 v21, 98304, v13
v_add_u32 v22, 98304, v14
s_add_u32 m0, s50, 4096
s_mov_b32 s38, 2867200
buffer_load_dwordx4 v7, s[16:19], s38 offen lds
s_add_u32 m0, s50, 5120
s_mov_b32 s38, 2867200
buffer_load_dwordx4 v8, s[16:19], s38 offen lds
s_waitcnt vmcnt(11)
s_barrier
s_waitcnt lgkmcnt(0)
s_add_u32 m0, s39, 49152
s_mov_b32 s37, 114688
buffer_load_dwordx4 v3, s[8:11], s37 offen sc1 lds
s_load_dword s3, s[4:5], 114816
buffer_load_dwordx4 v3, s[8:11], s37 offen offset:1024 sc1 lds
s_load_dword s3, s[4:5], 114880
s_and_b32 s44, s36, 3
buffer_load_dwordx4 v3, s[8:11], s37 offen offset:2048 sc1 lds
s_mul_i32 s43, s2, 28672
s_mul_i32 s44, s44, 7168
buffer_load_dwordx4 v3, s[8:11], s37 offen offset:3072 sc1 lds
s_add_u32 s43, s43, s44
s_add_u32 s4, s76, s43
s_add_u32 m0, s50, 49152
s_mov_b32 s38, 3211264
buffer_load_dwordx4 v6, s[16:19], s38 offen lds
s_addc_u32 s5, s77, 0
s_add_u32 m0, s50, 50176
s_mov_b32 s38, 3211264
buffer_load_dwordx4 v7, s[16:19], s38 offen lds
s_load_dword s3, s[4:5], 0
s_load_dword s3, s[4:5], 64
s_add_u32 m0, s50, 51200
s_mov_b32 s38, 3211264
buffer_load_dwordx4 v8, s[16:19], s38 offen lds
s_load_dword s3, s[4:5], 128
s_load_dword s3, s[4:5], 192
s_add_u32 m0, s50, 52224
s_mov_b32 s38, 3325952
buffer_load_dwordx4 v6, s[16:19], s38 offen lds
s_load_dword s3, s[4:5], 256
s_load_dword s3, s[4:5], 320
s_add_u32 m0, s50, 53248
s_mov_b32 s38, 3325952
buffer_load_dwordx4 v7, s[16:19], s38 offen lds
s_load_dword s3, s[4:5], 384
s_load_dword s3, s[4:5], 448
s_add_u32 m0, s50, 54272
s_mov_b32 s38, 3325952
buffer_load_dwordx4 v8, s[16:19], s38 offen lds
s_mov_b32 s38, 5505024
buffer_load_dword v27, v26, s[16:19], s38 offen
s_waitcnt vmcnt(11)
s_barrier
s_add_u32 m0, s39, 98304
s_mov_b32 s37, 131072
buffer_load_dwordx4 v3, s[8:11], s37 offen sc1 lds
buffer_load_dwordx4 v3, s[8:11], s37 offen offset:1024 sc1 lds
buffer_load_dwordx4 v3, s[8:11], s37 offen offset:2048 sc1 lds
buffer_load_dwordx4 v3, s[8:11], s37 offen offset:3072 sc1 lds
s_add_u32 m0, s50, 98304
s_mov_b32 s38, 3670016
buffer_load_dwordx4 v6, s[16:19], s38 offen lds
s_add_u32 m0, s50, 99328
s_mov_b32 s38, 3670016
buffer_load_dwordx4 v7, s[16:19], s38 offen lds
s_add_u32 m0, s50, 100352
s_mov_b32 s38, 3670016
buffer_load_dwordx4 v8, s[16:19], s38 offen lds
s_add_u32 m0, s50, 101376
s_mov_b32 s38, 3784704
buffer_load_dwordx4 v6, s[16:19], s38 offen lds
s_add_u32 m0, s50, 102400
s_mov_b32 s38, 3784704
buffer_load_dwordx4 v7, s[16:19], s38 offen lds
s_add_u32 m0, s50, 103424
s_mov_b32 s38, 3784704
buffer_load_dwordx4 v8, s[16:19], s38 offen lds
s_waitcnt vmcnt(11)
s_barrier
s_waitcnt lgkmcnt(0)
s_cmp_eq_u32 s47, 3
s_cbranch_scc0 Lw_108
s_mul_i32 s60, s35, 96
s_add_u32 s61, s60, 95
s_and_b32 s60, s60, 0xff80
s_and_b32 s61, s61, 0xff80
s_add_u32 s60, s60, 28323840
s_add_u32 s61, s61, 28323840
s_load_dword s92, s[82:83], s60 glc
s_load_dword s93, s[82:83], s61 glc
Lw_108:
s_add_u32 m0, s39, 0
s_mov_b32 s37, 147456
buffer_load_dwordx4 v3, s[8:11], s37 offen sc1 lds
s_load_dword s3, s[4:5], 512
buffer_load_dwordx4 v3, s[8:11], s37 offen offset:1024 sc1 lds
s_load_dword s3, s[4:5], 576
buffer_load_dwordx4 v3, s[8:11], s37 offen offset:2048 sc1 lds
s_load_dword s3, s[4:5], 640
buffer_load_dwordx4 v3, s[8:11], s37 offen offset:3072 sc1 lds
s_load_dword s3, s[4:5], 704
s_add_u32 m0, s50, 0
s_mov_b32 s38, 4128768
buffer_load_dwordx4 v6, s[16:19], s38 offen lds
s_load_dword s3, s[4:5], 768
s_add_u32 m0, s50, 1024
s_mov_b32 s38, 4128768
buffer_load_dwordx4 v7, s[16:19], s38 offen lds
s_load_dword s3, s[4:5], 832
s_add_u32 m0, s50, 2048
s_mov_b32 s38, 4128768
buffer_load_dwordx4 v8, s[16:19], s38 offen lds
s_load_dword s3, s[4:5], 896
s_add_u32 m0, s50, 3072
s_mov_b32 s38, 4243456
buffer_load_dwordx4 v6, s[16:19], s38 offen lds
s_load_dword s3, s[4:5], 960
s_add_u32 m0, s50, 4096
s_mov_b32 s38, 4243456
buffer_load_dwordx4 v7, s[16:19], s38 offen lds
s_load_dword s3, s[4:5], 1024
s_load_dword s3, s[4:5], 1088
s_add_u32 m0, s50, 5120
s_mov_b32 s38, 4243456
buffer_load_dwordx4 v8, s[16:19], s38 offen lds
s_mov_b32 s38, 6422528
buffer_load_dword v27, v26, s[16:19], s38 offen
s_waitcnt vmcnt(11)
s_barrier
s_add_u32 m0, s39, 49152
s_mov_b32 s37, 163840
buffer_load_dwordx4 v3, s[8:11], s37 offen sc1 lds
buffer_load_dwordx4 v3, s[8:11], s37 offen offset:1024 sc1 lds
buffer_load_dwordx4 v3, s[8:11], s37 offen offset:2048 sc1 lds
buffer_load_dwordx4 v3, s[8:11], s37 offen offset:3072 sc1 lds
s_add_u32 m0, s50, 49152
s_mov_b32 s38, 4587520
buffer_load_dwordx4 v6, s[16:19], s38 offen lds
s_add_u32 m0, s50, 50176
s_mov_b32 s38, 4587520
buffer_load_dwordx4 v7, s[16:19], s38 offen lds
s_add_u32 m0, s50, 51200
s_mov_b32 s38, 4587520
buffer_load_dwordx4 v8, s[16:19], s38 offen lds
s_add_u32 m0, s50, 52224
s_mov_b32 s38, 4702208
buffer_load_dwordx4 v6, s[16:19], s38 offen lds
s_add_u32 m0, s50, 53248
s_mov_b32 s38, 4702208
buffer_load_dwordx4 v7, s[16:19], s38 offen lds
s_add_u32 m0, s50, 54272
s_mov_b32 s38, 4702208
buffer_load_dwordx4 v8, s[16:19], s38 offen lds
s_mov_b32 s38, 0
buffer_load_dwordx4 v[40:43], v24, s[88:91], s38 offen
s_mov_b32 s38, 28672
buffer_load_dwordx4 v[44:47], v24, s[88:91], s38 offen
s_mov_b32 s38, 57344
buffer_load_dwordx4 v[48:51], v24, s[88:91], s38 offen
s_mov_b32 s38, 86016
buffer_load_dwordx4 v[52:55], v24, s[88:91], s38 offen
s_mov_b32 s38, 114688
buffer_load_dwordx4 v[56:59], v24, s[88:91], s38 offen
s_mov_b32 s38, 143360
buffer_load_dwordx4 v[60:63], v24, s[88:91], s38 offen
s_mov_b32 s38, 172032
buffer_load_dwordx4 v[64:67], v24, s[88:91], s38 offen
s_mov_b32 s38, 200704
buffer_load_dwordx4 v[68:71], v24, s[88:91], s38 offen
s_waitcnt vmcnt(19)
s_cmp_eq_u32 s47, 3
s_cbranch_scc0 Lw_109
s_mov_b32 s41, 0x40000
Lcp_110:
s_waitcnt lgkmcnt(0)
s_and_b32 s92, s92, s93
s_cmp_eq_u32 s92, 16
s_cbranch_scc1 Lco_111
s_load_dword s92, s[82:83], s60 glc
s_load_dword s93, s[82:83], s61 glc
s_sub_u32 s41, s41, 1
s_cmp_lg_u32 s41, 0
s_cbranch_scc1 Lcp_110
s_waitcnt lgkmcnt(0)
Lco_111:
Lw_109:
s_barrier
s_mov_b32 s45, s47
s_cmp_ge_u32 s45, 3
s_cselect_b32 s43, 1, 0
s_mul_i32 s44, s43, 3
s_sub_u32 s45, s45, s44
s_lshl_b32 s45, s45, 7
s_mul_i32 s52, s43, 896
s_add_u32 s52, s52, s45
s_add_u32 s52, s52, 148992
s_mul_i32 s43, s43, 14336
s_add_u32 s43, s43, s45
s_mul_i32 s44, s35, 384
s_add_u32 s43, s43, s44
s_add_u32 s60, s43, 8192
s_add_u32 s45, s47, 4
s_min_u32 s45, s45, 5
s_cmp_ge_u32 s45, 3
s_cselect_b32 s43, 1, 0
s_mul_i32 s44, s43, 3
s_sub_u32 s45, s45, s44
s_lshl_b32 s45, s45, 7
s_mul_i32 s53, s43, 896
s_add_u32 s53, s53, s45
s_add_u32 s53, s53, 148992
s_mul_i32 s43, s43, 14336
s_add_u32 s43, s43, s45
s_mul_i32 s44, s35, 384
s_add_u32 s43, s43, s44
s_add_u32 s61, s43, 8192
v_lshrrev_b32 v104, 3, v1
v_mul_u32_u24 v104, 28672, v104
v_and_b32 v105, 7, v1
v_lshl_add_u32 v104, v105, 4, v104
s_waitcnt lgkmcnt(0)
buffer_load_dwordx4 v[96:99], v104, s[84:87], s60 offen sc1
s_load_dword s3, s[4:5], 1152
buffer_load_dwordx4 v[100:103], v104, s[84:87], s61 offen sc1
s_load_dword s3, s[4:5], 1216
s_load_dword s3, s[4:5], 1280
s_add_u32 m0, s39, 98304
s_mov_b32 s37, 180224
buffer_load_dwordx4 v3, s[8:11], s37 offen sc1 lds
s_load_dword s3, s[4:5], 1344
buffer_load_dwordx4 v3, s[8:11], s37 offen offset:1024 sc1 lds
s_load_dword s3, s[4:5], 1408
s_load_dword s3, s[4:5], 1472
buffer_load_dwordx4 v3, s[8:11], s37 offen offset:2048 sc1 lds
s_load_dword s3, s[4:5], 1536
buffer_load_dwordx4 v3, s[8:11], s37 offen offset:3072 sc1 lds
s_load_dword s3, s[4:5], 1600
s_load_dword s3, s[4:5], 1664
s_add_u32 m0, s50, 98304
s_mov_b32 s38, 5046272
buffer_load_dwordx4 v6, s[16:19], s38 offen lds
s_load_dword s3, s[4:5], 1728
s_add_u32 m0, s50, 99328
s_mov_b32 s38, 5046272
buffer_load_dwordx4 v7, s[16:19], s38 offen lds
v_cmp_gt_u32 vcc, 32, v1
v_mov_b32 v104, s52
s_add_u32 m0, s50, 100352
s_mov_b32 s38, 5046272
buffer_load_dwordx4 v8, s[16:19], s38 offen lds
v_mov_b32 v106, s53
s_add_u32 m0, s50, 101376
s_mov_b32 s38, 5160960
buffer_load_dwordx4 v6, s[16:19], s38 offen lds
v_cndmask_b32 v104, v106, v104, vcc
v_lshl_add_u32 v104, v105, 4, v104
s_add_u32 m0, s50, 102400
s_mov_b32 s38, 5160960
buffer_load_dwordx4 v7, s[16:19], s38 offen lds
v_bfe_u32 v105, v1, 4, 1
v_lshl_add_u32 v104, v105, 2, v104
s_add_u32 m0, s50, 103424
s_mov_b32 s38, 5160960
buffer_load_dwordx4 v8, s[16:19], s38 offen lds
s_mov_b32 s38, 0
buffer_load_dword v27, v26, s[12:15], s38 offen
s_waitcnt vmcnt(21)
s_barrier
s_add_u32 m0, s39, 0
s_mov_b32 s37, 196608
buffer_load_dwordx4 v3, s[8:11], s37 offen sc1 lds
buffer_load_dwordx4 v3, s[8:11], s37 offen offset:1024 sc1 lds
buffer_load_dwordx4 v3, s[8:11], s37 offen offset:2048 sc1 lds
buffer_load_dwordx4 v3, s[8:11], s37 offen offset:3072 sc1 lds
s_add_u32 m0, s50, 0
s_mov_b32 s38, 5505024
buffer_load_dwordx4 v6, s[16:19], s38 offen lds
s_add_u32 m0, s50, 1024
s_mov_b32 s38, 5505024
buffer_load_dwordx4 v7, s[16:19], s38 offen lds
s_add_u32 m0, s50, 2048
s_mov_b32 s38, 5505024
buffer_load_dwordx4 v8, s[16:19], s38 offen lds
s_add_u32 m0, s50, 3072
s_mov_b32 s38, 5619712
buffer_load_dwordx4 v6, s[16:19], s38 offen lds
s_add_u32 m0, s50, 4096
s_mov_b32 s38, 5619712
buffer_load_dwordx4 v7, s[16:19], s38 offen lds
s_add_u32 m0, s50, 5120
s_mov_b32 s38, 5619712
buffer_load_dwordx4 v8, s[16:19], s38 offen lds
s_waitcnt vmcnt(11)
s_barrier
v_permlane32_swap_b32 v96, v100
v_permlane32_swap_b32 v97, v101
v_permlane32_swap_b32 v98, v102
v_permlane32_swap_b32 v99, v103
v_add_f32 v96, v96, v100
v_add_f32 v97, v97, v101
v_add_f32 v98, v98, v102
v_add_f32 v99, v99, v103
s_nop 1
v_permlane16_swap_b32 v96, v97
v_permlane16_swap_b32 v98, v99
v_add_f32 v96, v96, v97
v_add_f32 v98, v98, v99
s_nop 1
v_add_f32_dpp v96, v96, v96 row_ror:8 row_mask:0xf bank_mask:0xf
v_add_f32_dpp v98, v98, v98 row_ror:8 row_mask:0xf bank_mask:0xf
ds_write_b32 v104, v96
ds_write_b32 v104, v98 offset:8
s_waitcnt lgkmcnt(0)
s_add_u32 m0, s39, 49152
s_mov_b32 s37, 212992
buffer_load_dwordx4 v3, s[8:11], s37 offen sc1 lds
s_load_dword s3, s[4:5], 1792
s_load_dword s3, s[4:5], 1856
s_load_dword s3, s[4:5], 1920
s_load_dword s3, s[4:5], 1984
buffer_load_dwordx4 v3, s[8:11], s37 offen offset:1024 sc1 lds
s_load_dword s3, s[4:5], 2048
s_load_dword s3, s[4:5], 2112
s_load_dword s3, s[4:5], 2176
s_load_dword s3, s[4:5], 2240
s_load_dword s3, s[4:5], 2304
buffer_load_dwordx4 v3, s[8:11], s37 offen offset:2048 sc1 lds
s_load_dword s3, s[4:5], 2368
v_lshlrev_b32 v72, 16, v40
v_and_b32 v73, 0xffff0000, v40
v_lshlrev_b32 v74, 16, v41
v_and_b32 v75, 0xffff0000, v41
buffer_load_dwordx4 v3, s[8:11], s37 offen offset:3072 sc1 lds
v_lshlrev_b32 v76, 16, v42
v_and_b32 v77, 0xffff0000, v42
v_lshlrev_b32 v78, 16, v43
v_and_b32 v79, 0xffff0000, v43
v_lshlrev_b32 v80, 16, v44
s_add_u32 m0, s50, 49152
s_mov_b32 s38, 5963776
buffer_load_dwordx4 v6, s[16:19], s38 offen lds
v_and_b32 v81, 0xffff0000, v44
v_lshlrev_b32 v82, 16, v45
v_and_b32 v83, 0xffff0000, v45
v_lshlrev_b32 v84, 16, v46
s_add_u32 m0, s50, 50176
s_mov_b32 s38, 5963776
buffer_load_dwordx4 v7, s[16:19], s38 offen lds
v_and_b32 v85, 0xffff0000, v46
v_lshlrev_b32 v86, 16, v47
v_and_b32 v87, 0xffff0000, v47
v_add_f32 v72, v72, v80
v_add_f32 v73, v73, v81
s_add_u32 m0, s50, 51200
s_mov_b32 s38, 5963776
buffer_load_dwordx4 v8, s[16:19], s38 offen lds
v_add_f32 v74, v74, v82
v_add_f32 v75, v75, v83
v_add_f32 v76, v76, v84
v_add_f32 v77, v77, v85
v_add_f32 v78, v78, v86
s_add_u32 m0, s50, 52224
s_mov_b32 s38, 6078464
buffer_load_dwordx4 v6, s[16:19], s38 offen lds
v_add_f32 v79, v79, v87
v_lshlrev_b32 v80, 16, v48
v_and_b32 v81, 0xffff0000, v48
v_lshlrev_b32 v82, 16, v49
v_and_b32 v83, 0xffff0000, v49
s_add_u32 m0, s50, 53248
s_mov_b32 s38, 6078464
buffer_load_dwordx4 v7, s[16:19], s38 offen lds
v_lshlrev_b32 v84, 16, v50
v_and_b32 v85, 0xffff0000, v50
v_lshlrev_b32 v86, 16, v51
v_and_b32 v87, 0xffff0000, v51
v_add_f32 v72, v72, v80
s_add_u32 m0, s50, 54272
s_mov_b32 s38, 6078464
buffer_load_dwordx4 v8, s[16:19], s38 offen lds
s_mov_b32 s38, 917504
buffer_load_dword v27, v26, s[12:15], s38 offen
s_waitcnt vmcnt(11)
s_barrier
s_add_u32 m0, s39, 98304
s_mov_b32 s37, 229376
buffer_load_dwordx4 v3, s[8:11], s37 offen sc1 lds
v_add_f32 v73, v73, v81
v_add_f32 v74, v74, v82
v_add_f32 v75, v75, v83
v_add_f32 v76, v76, v84
buffer_load_dwordx4 v3, s[8:11], s37 offen offset:1024 sc1 lds
v_add_f32 v77, v77, v85
v_add_f32 v78, v78, v86
v_add_f32 v79, v79, v87
v_lshlrev_b32 v80, 16, v52
buffer_load_dwordx4 v3, s[8:11], s37 offen offset:2048 sc1 lds
v_and_b32 v81, 0xffff0000, v52
v_lshlrev_b32 v82, 16, v53
v_and_b32 v83, 0xffff0000, v53
v_lshlrev_b32 v84, 16, v54
buffer_load_dwordx4 v3, s[8:11], s37 offen offset:3072 sc1 lds
v_and_b32 v85, 0xffff0000, v54
v_lshlrev_b32 v86, 16, v55
v_and_b32 v87, 0xffff0000, v55
v_add_f32 v72, v72, v80
v_add_f32 v73, v73, v81
s_add_u32 m0, s50, 98304
s_mov_b32 s38, 6422528
buffer_load_dwordx4 v6, s[16:19], s38 offen lds
v_add_f32 v74, v74, v82
v_add_f32 v75, v75, v83
v_add_f32 v76, v76, v84
v_add_f32 v77, v77, v85
s_add_u32 m0, s50, 99328
s_mov_b32 s38, 6422528
buffer_load_dwordx4 v7, s[16:19], s38 offen lds
v_add_f32 v78, v78, v86
v_add_f32 v79, v79, v87
v_lshlrev_b32 v80, 16, v56
v_and_b32 v81, 0xffff0000, v56
s_add_u32 m0, s50, 100352
s_mov_b32 s38, 6422528
buffer_load_dwordx4 v8, s[16:19], s38 offen lds
v_lshlrev_b32 v82, 16, v57
v_and_b32 v83, 0xffff0000, v57
v_lshlrev_b32 v84, 16, v58
v_and_b32 v85, 0xffff0000, v58
s_add_u32 m0, s50, 101376
s_mov_b32 s38, 6537216
s_branch Lov_17
.p2align 12
Lst_17_0:
s_branch Lwr_126
Lst_17_1:
s_branch Lwr_129
Lov_17:
buffer_load_dwordx4 v6, s[16:19], s38 offen lds
v_lshlrev_b32 v86, 16, v59
v_and_b32 v87, 0xffff0000, v59
v_add_f32 v72, v72, v80
v_add_f32 v73, v73, v81
v_add_f32 v74, v74, v82
s_add_u32 m0, s50, 102400
s_mov_b32 s38, 6537216
buffer_load_dwordx4 v7, s[16:19], s38 offen lds
s_add_u32 m0, s50, 103424
s_mov_b32 s38, 6537216
buffer_load_dwordx4 v8, s[16:19], s38 offen lds
s_waitcnt vmcnt(11)
s_barrier
s_waitcnt lgkmcnt(0)
s_add_u32 m0, s39, 0
s_mov_b32 s37, 245760
buffer_load_dwordx4 v3, s[8:11], s37 offen sc1 lds
s_load_dword s3, s[4:5], 2432
s_load_dword s3, s[4:5], 2496
s_load_dword s3, s[4:5], 2560
s_load_dword s3, s[4:5], 2624
buffer_load_dwordx4 v3, s[8:11], s37 offen offset:1024 sc1 lds
s_load_dword s3, s[4:5], 2688
s_load_dword s3, s[4:5], 2752
s_load_dword s3, s[4:5], 2816
s_load_dword s3, s[4:5], 2880
s_load_dword s3, s[4:5], 2944
buffer_load_dwordx4 v3, s[8:11], s37 offen offset:2048 sc1 lds
s_load_dword s3, s[4:5], 3008
v_add_f32 v75, v75, v83
v_add_f32 v76, v76, v84
v_add_f32 v77, v77, v85
v_add_f32 v78, v78, v86
buffer_load_dwordx4 v3, s[8:11], s37 offen offset:3072 sc1 lds
v_add_f32 v79, v79, v87
v_lshlrev_b32 v80, 16, v60
v_and_b32 v81, 0xffff0000, v60
v_lshlrev_b32 v82, 16, v61
v_and_b32 v83, 0xffff0000, v61
s_add_u32 m0, s50, 0
s_mov_b32 s38, 6881280
buffer_load_dwordx4 v6, s[16:19], s38 offen lds
v_lshlrev_b32 v84, 16, v62
v_and_b32 v85, 0xffff0000, v62
v_lshlrev_b32 v86, 16, v63
v_and_b32 v87, 0xffff0000, v63
s_add_u32 m0, s50, 1024
s_mov_b32 s38, 6881280
buffer_load_dwordx4 v7, s[16:19], s38 offen lds
v_add_f32 v72, v72, v80
v_add_f32 v73, v73, v81
v_add_f32 v74, v74, v82
v_add_f32 v75, v75, v83
v_add_f32 v76, v76, v84
s_add_u32 m0, s50, 2048
s_mov_b32 s38, 6881280
buffer_load_dwordx4 v8, s[16:19], s38 offen lds
v_add_f32 v77, v77, v85
v_add_f32 v78, v78, v86
v_add_f32 v79, v79, v87
v_lshlrev_b32 v80, 16, v64
v_and_b32 v81, 0xffff0000, v64
s_add_u32 m0, s50, 3072
s_mov_b32 s38, 6995968
buffer_load_dwordx4 v6, s[16:19], s38 offen lds
v_lshlrev_b32 v82, 16, v65
v_and_b32 v83, 0xffff0000, v65
v_lshlrev_b32 v84, 16, v66
v_and_b32 v85, 0xffff0000, v66
v_lshlrev_b32 v86, 16, v67
s_add_u32 m0, s50, 4096
s_mov_b32 s38, 6995968
buffer_load_dwordx4 v7, s[16:19], s38 offen lds
v_and_b32 v87, 0xffff0000, v67
v_add_f32 v72, v72, v80
v_add_f32 v73, v73, v81
v_add_f32 v74, v74, v82
v_add_f32 v75, v75, v83
s_add_u32 m0, s50, 5120
s_mov_b32 s38, 6995968
buffer_load_dwordx4 v8, s[16:19], s38 offen lds
s_mov_b32 s38, 1835008
buffer_load_dword v27, v26, s[12:15], s38 offen
s_waitcnt vmcnt(11)
s_barrier
s_add_u32 m0, s39, 49152
s_mov_b32 s37, 0
buffer_load_dwordx4 v3, s[8:11], s37 offen sc1 lds
v_add_f32 v76, v76, v84
v_add_f32 v77, v77, v85
v_add_f32 v78, v78, v86
buffer_load_dwordx4 v3, s[8:11], s37 offen offset:1024 sc1 lds
v_add_f32 v79, v79, v87
v_lshlrev_b32 v80, 16, v68
v_and_b32 v81, 0xffff0000, v68
buffer_load_dwordx4 v3, s[8:11], s37 offen offset:2048 sc1 lds
v_lshlrev_b32 v82, 16, v69
v_and_b32 v83, 0xffff0000, v69
v_lshlrev_b32 v84, 16, v70
v_and_b32 v85, 0xffff0000, v70
buffer_load_dwordx4 v3, s[8:11], s37 offen offset:3072 sc1 lds
v_lshlrev_b32 v86, 16, v71
v_and_b32 v87, 0xffff0000, v71
v_add_f32 v72, v72, v80
s_add_u32 m0, s40, 49152
s_mov_b32 s38, 0
buffer_load_dwordx4 v4, s[12:15], s38 offen lds
v_add_f32 v73, v73, v81
v_add_f32 v74, v74, v82
v_add_f32 v75, v75, v83
v_add_f32 v76, v76, v84
s_add_u32 m0, s40, 50176
s_mov_b32 s38, 0
buffer_load_dwordx4 v5, s[12:15], s38 offen lds
v_add_f32 v77, v77, v85
v_add_f32 v78, v78, v86
v_add_f32 v79, v79, v87
s_add_u32 m0, s40, 51200
s_mov_b32 s38, 57344
buffer_load_dwordx4 v4, s[12:15], s38 offen lds
s_nop 0
v_permlane32_swap_b32 v72, v76
v_permlane32_swap_b32 v73, v77
s_add_u32 m0, s40, 52224
s_mov_b32 s38, 57344
buffer_load_dwordx4 v5, s[12:15], s38 offen lds
v_permlane32_swap_b32 v74, v78
v_permlane32_swap_b32 v75, v79
v_add_f32 v72, v72, v76
v_add_f32 v73, v73, v77
s_add_u32 m0, s40, 53248
s_mov_b32 s38, 114688
buffer_load_dwordx4 v4, s[12:15], s38 offen lds
v_add_f32 v74, v74, v78
v_add_f32 v75, v75, v79
s_nop 0
s_add_u32 m0, s40, 54272
s_mov_b32 s38, 114688
buffer_load_dwordx4 v5, s[12:15], s38 offen lds
v_permlane16_swap_b32 v72, v74
v_permlane16_swap_b32 v73, v75
v_add_f32 v72, v72, v74
v_add_f32 v73, v73, v75
s_add_u32 m0, s40, 55296
s_mov_b32 s38, 172032
buffer_load_dwordx4 v4, s[12:15], s38 offen lds
s_add_u32 m0, s40, 56320
s_mov_b32 s38, 172032
buffer_load_dwordx4 v5, s[12:15], s38 offen lds
s_waitcnt vmcnt(13)
s_barrier
s_lshl_b32 s43, s47, 9
s_add_u32 s43, s43, 153600
v_and_b32 v80, 15, v1
v_lshl_add_u32 v80, v80, 5, s43
v_lshrrev_b32 v81, 4, v1
v_lshl_add_u32 v80, v81, 3, v80
ds_write_b64 v80, v[72:73]
s_waitcnt lgkmcnt(0)
s_add_u32 m0, s39, 98304
s_mov_b32 s37, 16384
buffer_load_dwordx4 v3, s[8:11], s37 offen sc1 lds
s_bfe_u32 s61, s35, 0x10002
s_lshr_b32 s60, s35, 3
buffer_load_dwordx4 v3, s[8:11], s37 offen offset:1024 sc1 lds
s_lshl_b32 s60, s60, 2
s_and_b32 s43, s35, 3
buffer_load_dwordx4 v3, s[8:11], s37 offen offset:2048 sc1 lds
s_add_u32 s60, s60, s43
s_lshl_b32 s43, s60, 8
s_add_u32 s28, s76, s43
buffer_load_dwordx4 v3, s[8:11], s37 offen offset:3072 sc1 lds
s_addc_u32 s29, s77, 0
s_mov_b32 s30, 7338240
s_add_u32 m0, s40, 98304
s_mov_b32 s38, 458752
buffer_load_dwordx4 v4, s[12:15], s38 offen lds
s_mov_b32 s31, 0x20000
s_mul_i32 s52, s61, 196608
s_add_u32 m0, s40, 99328
s_mov_b32 s38, 458752
buffer_load_dwordx4 v5, s[12:15], s38 offen lds
s_mul_i32 s53, s61, 1572864
s_mul_i32 s90, s61, 163840
s_mul_i32 s91, s61, 1310720
s_add_u32 m0, s40, 100352
s_mov_b32 s38, 516096
buffer_load_dwordx4 v4, s[12:15], s38 offen lds
s_lshl_b32 s51, s47, 11
s_lshl_b32 s44, s47, 15
s_add_u32 m0, s40, 101376
s_mov_b32 s38, 516096
buffer_load_dwordx4 v5, s[12:15], s38 offen lds
v_lshrrev_b32 v122, 4, v1
v_lshlrev_b32 v123, 1, v122
s_add_u32 m0, s40, 102400
s_mov_b32 s38, 573440
buffer_load_dwordx4 v4, s[12:15], s38 offen lds
v_and_b32 v23, 15, v1
v_xor_b32 v23, v23, v123
v_lshlrev_b32 v23, 4, v23
s_add_u32 m0, s40, 103424
s_mov_b32 s38, 573440
buffer_load_dwordx4 v5, s[12:15], s38 offen lds
v_mul_u32_u24 v122, 2048, v122
v_add_u32 v23, v23, v122
s_add_u32 m0, s40, 104448
s_mov_b32 s38, 630784
buffer_load_dwordx4 v4, s[12:15], s38 offen lds
v_add_u32 v23, s44, v23
v_xor_b32 v24, 128, v23
v_add_u32 v24, 8192, v24
s_add_u32 m0, s40, 105472
s_mov_b32 s38, 630784
buffer_load_dwordx4 v5, s[12:15], s38 offen lds
s_mov_b32 s38, 2752512
buffer_load_dword v27, v26, s[12:15], s38 offen
s_waitcnt vmcnt(13)
s_barrier
ds_read_b128 v[28:31], v9 offset:49152
ds_read_b64_tr_b16 v[44:45], v15 offset:0
ds_read_b64_tr_b16 v[46:47], v15 offset:4096
ds_read_b64_tr_b16 v[48:49], v16 offset:0
ds_read_b64_tr_b16 v[50:51], v16 offset:4096
ds_read_b64_tr_b16 v[52:53], v17 offset:0
ds_read_b64_tr_b16 v[54:55], v17 offset:4096
ds_read_b64_tr_b16 v[56:57], v18 offset:0
ds_read_b64_tr_b16 v[58:59], v18 offset:4096
ds_read_b64_tr_b16 v[60:61], v15 offset:16384
ds_read_b64_tr_b16 v[62:63], v15 offset:20480
ds_read_b64_tr_b16 v[64:65], v16 offset:16384
ds_read_b64_tr_b16 v[66:67], v16 offset:20480
ds_read_b64_tr_b16 v[68:69], v17 offset:16384
ds_read_b64_tr_b16 v[70:71], v17 offset:20480
ds_read_b64_tr_b16 v[72:73], v18 offset:16384
ds_read_b64_tr_b16 v[74:75], v18 offset:20480
ds_read_b128 v[32:35], v9 offset:50176
ds_read_b128 v[36:39], v9 offset:51200
ds_read_b128 v[40:43], v9 offset:52224
s_waitcnt lgkmcnt(0)
v_mfma_f32_16x16x32_bf16 v[124:127], v[44:47], v[28:31], 0
ds_read_b128 v[76:79], v9 offset:57344
v_mfma_f32_16x16x32_bf16 v[128:131], v[48:51], v[28:31], 0
ds_read_b64_tr_b16 v[92:93], v15 offset:8192
v_mfma_f32_16x16x32_bf16 v[132:135], v[52:55], v[28:31], 0
ds_read_b64_tr_b16 v[94:95], v15 offset:12288
v_mfma_f32_16x16x32_bf16 v[136:139], v[56:59], v[28:31], 0
ds_read_b64_tr_b16 v[96:97], v16 offset:8192
v_mfma_f32_16x16x32_bf16 v[140:143], v[60:63], v[28:31], 0
ds_read_b64_tr_b16 v[98:99], v16 offset:12288
v_mfma_f32_16x16x32_bf16 v[144:147], v[64:67], v[28:31], 0
ds_read_b64_tr_b16 v[100:101], v17 offset:8192
v_mfma_f32_16x16x32_bf16 v[148:151], v[68:71], v[28:31], 0
ds_read_b64_tr_b16 v[102:103], v17 offset:12288
v_mfma_f32_16x16x32_bf16 v[152:155], v[72:75], v[28:31], 0
ds_read_b64_tr_b16 v[104:105], v18 offset:8192
v_mfma_f32_16x16x32_bf16 v[184:187], v[72:75], v[32:35], 0
ds_read_b64_tr_b16 v[106:107], v18 offset:12288
v_mfma_f32_16x16x32_bf16 v[180:183], v[68:71], v[32:35], 0
ds_read_b64_tr_b16 v[108:109], v15 offset:24576
v_mfma_f32_16x16x32_bf16 v[176:179], v[64:67], v[32:35], 0
ds_read_b64_tr_b16 v[110:111], v15 offset:28672
v_mfma_f32_16x16x32_bf16 v[172:175], v[60:63], v[32:35], 0
ds_read_b64_tr_b16 v[112:113], v16 offset:24576
v_mfma_f32_16x16x32_bf16 v[168:171], v[56:59], v[32:35], 0
ds_read_b64_tr_b16 v[114:115], v16 offset:28672
v_mfma_f32_16x16x32_bf16 v[164:167], v[52:55], v[32:35], 0
ds_read_b64_tr_b16 v[116:117], v17 offset:24576
v_mfma_f32_16x16x32_bf16 v[160:163], v[48:51], v[32:35], 0
ds_read_b64_tr_b16 v[118:119], v17 offset:28672
v_mfma_f32_16x16x32_bf16 v[156:159], v[44:47], v[32:35], 0
ds_read_b64_tr_b16 v[120:121], v18 offset:24576
v_mfma_f32_16x16x32_bf16 v[188:191], v[44:47], v[36:39], 0
ds_read_b64_tr_b16 v[122:123], v18 offset:28672
v_mfma_f32_16x16x32_bf16 v[192:195], v[48:51], v[36:39], 0
ds_read_b128 v[80:83], v9 offset:58368
v_mfma_f32_16x16x32_bf16 v[196:199], v[52:55], v[36:39], 0
ds_read_b128 v[84:87], v9 offset:59392
v_mfma_f32_16x16x32_bf16 v[200:203], v[56:59], v[36:39], 0
ds_read_b128 v[88:91], v9 offset:60416
v_mfma_f32_16x16x32_bf16 v[204:207], v[60:63], v[36:39], 0
v_mfma_f32_16x16x32_bf16 v[208:211], v[64:67], v[36:39], 0
v_mfma_f32_16x16x32_bf16 v[212:215], v[68:71], v[36:39], 0
v_mfma_f32_16x16x32_bf16 v[216:219], v[72:75], v[36:39], 0
v_mfma_f32_16x16x32_bf16 v[248:251], v[72:75], v[40:43], 0
v_mfma_f32_16x16x32_bf16 v[244:247], v[68:71], v[40:43], 0
v_mfma_f32_16x16x32_bf16 v[240:243], v[64:67], v[40:43], 0
v_mfma_f32_16x16x32_bf16 v[236:239], v[60:63], v[40:43], 0
v_mfma_f32_16x16x32_bf16 v[232:235], v[56:59], v[40:43], 0
v_mfma_f32_16x16x32_bf16 v[228:231], v[52:55], v[40:43], 0
v_mfma_f32_16x16x32_bf16 v[224:227], v[48:51], v[40:43], 0
v_mfma_f32_16x16x32_bf16 v[220:223], v[44:47], v[40:43], 0
s_waitcnt vmcnt(0)
s_waitcnt lgkmcnt(0)
s_barrier
v_mfma_f32_16x16x32_bf16 v[124:127], v[92:95], v[76:79], v[124:127]
ds_read_b128 v[28:31], v10 offset:0
v_mfma_f32_16x16x32_bf16 v[128:131], v[96:99], v[76:79], v[128:131]
ds_read_b64_tr_b16 v[44:45], v19 offset:0
v_mfma_f32_16x16x32_bf16 v[132:135], v[100:103], v[76:79], v[132:135]
ds_read_b64_tr_b16 v[46:47], v19 offset:4096
v_mfma_f32_16x16x32_bf16 v[136:139], v[104:107], v[76:79], v[136:139]
ds_read_b64_tr_b16 v[48:49], v20 offset:0
v_mfma_f32_16x16x32_bf16 v[140:143], v[108:111], v[76:79], v[140:143]
ds_read_b64_tr_b16 v[50:51], v20 offset:4096
v_mfma_f32_16x16x32_bf16 v[144:147], v[112:115], v[76:79], v[144:147]
ds_read_b64_tr_b16 v[52:53], v21 offset:0
v_mfma_f32_16x16x32_bf16 v[148:151], v[116:119], v[76:79], v[148:151]
ds_read_b64_tr_b16 v[54:55], v21 offset:4096
v_mfma_f32_16x16x32_bf16 v[152:155], v[120:123], v[76:79], v[152:155]
ds_read_b64_tr_b16 v[56:57], v22 offset:0
v_mfma_f32_16x16x32_bf16 v[184:187], v[120:123], v[80:83], v[184:187]
ds_read_b64_tr_b16 v[58:59], v22 offset:4096
v_mfma_f32_16x16x32_bf16 v[180:183], v[116:119], v[80:83], v[180:183]
ds_read_b64_tr_b16 v[60:61], v19 offset:16384
v_mfma_f32_16x16x32_bf16 v[176:179], v[112:115], v[80:83], v[176:179]
ds_read_b64_tr_b16 v[62:63], v19 offset:20480
v_mfma_f32_16x16x32_bf16 v[172:175], v[108:111], v[80:83], v[172:175]
ds_read_b64_tr_b16 v[64:65], v20 offset:16384
v_mfma_f32_16x16x32_bf16 v[168:171], v[104:107], v[80:83], v[168:171]
ds_read_b64_tr_b16 v[66:67], v20 offset:20480
v_mfma_f32_16x16x32_bf16 v[164:167], v[100:103], v[80:83], v[164:167]
ds_read_b64_tr_b16 v[68:69], v21 offset:16384
v_mfma_f32_16x16x32_bf16 v[160:163], v[96:99], v[80:83], v[160:163]
ds_read_b64_tr_b16 v[70:71], v21 offset:20480
v_mfma_f32_16x16x32_bf16 v[156:159], v[92:95], v[80:83], v[156:159]
ds_read_b64_tr_b16 v[72:73], v22 offset:16384
v_mfma_f32_16x16x32_bf16 v[188:191], v[92:95], v[84:87], v[188:191]
ds_read_b64_tr_b16 v[74:75], v22 offset:20480
v_mfma_f32_16x16x32_bf16 v[192:195], v[96:99], v[84:87], v[192:195]
ds_read_b128 v[32:35], v10 offset:1024
v_mfma_f32_16x16x32_bf16 v[196:199], v[100:103], v[84:87], v[196:199]
ds_read_b128 v[36:39], v10 offset:2048
v_mfma_f32_16x16x32_bf16 v[200:203], v[104:107], v[84:87], v[200:203]
ds_read_b128 v[40:43], v10 offset:3072
v_mfma_f32_16x16x32_bf16 v[204:207], v[108:111], v[84:87], v[204:207]
v_mfma_f32_16x16x32_bf16 v[208:211], v[112:115], v[84:87], v[208:211]
v_mfma_f32_16x16x32_bf16 v[212:215], v[116:119], v[84:87], v[212:215]
v_mfma_f32_16x16x32_bf16 v[216:219], v[120:123], v[84:87], v[216:219]
v_mfma_f32_16x16x32_bf16 v[248:251], v[120:123], v[88:91], v[248:251]
v_mfma_f32_16x16x32_bf16 v[244:247], v[116:119], v[88:91], v[244:247]
v_mfma_f32_16x16x32_bf16 v[240:243], v[112:115], v[88:91], v[240:243]
v_mfma_f32_16x16x32_bf16 v[236:239], v[108:111], v[88:91], v[236:239]
v_mfma_f32_16x16x32_bf16 v[232:235], v[104:107], v[88:91], v[232:235]
v_mfma_f32_16x16x32_bf16 v[228:231], v[100:103], v[88:91], v[228:231]
v_mfma_f32_16x16x32_bf16 v[224:227], v[96:99], v[88:91], v[224:227]
v_mfma_f32_16x16x32_bf16 v[220:223], v[92:95], v[88:91], v[220:223]
s_mov_b32 s41, 4
Lk3l_112:
s_waitcnt lgkmcnt(0)
v_mfma_f32_16x16x32_bf16 v[124:127], v[44:47], v[28:31], v[124:127]
ds_read_b128 v[76:79], v10 offset:8192
v_mfma_f32_16x16x32_bf16 v[128:131], v[48:51], v[28:31], v[128:131]
ds_read_b64_tr_b16 v[92:93], v19 offset:8192
v_mfma_f32_16x16x32_bf16 v[132:135], v[52:55], v[28:31], v[132:135]
ds_read_b64_tr_b16 v[94:95], v19 offset:12288
v_mfma_f32_16x16x32_bf16 v[136:139], v[56:59], v[28:31], v[136:139]
ds_read_b64_tr_b16 v[96:97], v20 offset:8192
v_mfma_f32_16x16x32_bf16 v[140:143], v[60:63], v[28:31], v[140:143]
ds_read_b64_tr_b16 v[98:99], v20 offset:12288
v_mfma_f32_16x16x32_bf16 v[144:147], v[64:67], v[28:31], v[144:147]
ds_read_b64_tr_b16 v[100:101], v21 offset:8192
v_mfma_f32_16x16x32_bf16 v[148:151], v[68:71], v[28:31], v[148:151]
ds_read_b64_tr_b16 v[102:103], v21 offset:12288
v_mfma_f32_16x16x32_bf16 v[152:155], v[72:75], v[28:31], v[152:155]
ds_read_b64_tr_b16 v[104:105], v22 offset:8192
v_mfma_f32_16x16x32_bf16 v[184:187], v[72:75], v[32:35], v[184:187]
ds_read_b64_tr_b16 v[106:107], v22 offset:12288
v_mfma_f32_16x16x32_bf16 v[180:183], v[68:71], v[32:35], v[180:183]
ds_read_b64_tr_b16 v[108:109], v19 offset:24576
v_mfma_f32_16x16x32_bf16 v[176:179], v[64:67], v[32:35], v[176:179]
ds_read_b64_tr_b16 v[110:111], v19 offset:28672
v_mfma_f32_16x16x32_bf16 v[172:175], v[60:63], v[32:35], v[172:175]
ds_read_b64_tr_b16 v[112:113], v20 offset:24576
v_mfma_f32_16x16x32_bf16 v[168:171], v[56:59], v[32:35], v[168:171]
ds_read_b64_tr_b16 v[114:115], v20 offset:28672
v_mfma_f32_16x16x32_bf16 v[164:167], v[52:55], v[32:35], v[164:167]
ds_read_b64_tr_b16 v[116:117], v21 offset:24576
v_mfma_f32_16x16x32_bf16 v[160:163], v[48:51], v[32:35], v[160:163]
ds_read_b64_tr_b16 v[118:119], v21 offset:28672
v_mfma_f32_16x16x32_bf16 v[156:159], v[44:47], v[32:35], v[156:159]
ds_read_b64_tr_b16 v[120:121], v22 offset:24576
v_mfma_f32_16x16x32_bf16 v[188:191], v[44:47], v[36:39], v[188:191]
ds_read_b64_tr_b16 v[122:123], v22 offset:28672
v_mfma_f32_16x16x32_bf16 v[192:195], v[48:51], v[36:39], v[192:195]
ds_read_b128 v[80:83], v10 offset:9216
v_mfma_f32_16x16x32_bf16 v[196:199], v[52:55], v[36:39], v[196:199]
ds_read_b128 v[84:87], v10 offset:10240
v_mfma_f32_16x16x32_bf16 v[200:203], v[56:59], v[36:39], v[200:203]
ds_read_b128 v[88:91], v10 offset:11264
v_mfma_f32_16x16x32_bf16 v[204:207], v[60:63], v[36:39], v[204:207]
v_mfma_f32_16x16x32_bf16 v[208:211], v[64:67], v[36:39], v[208:211]
v_mfma_f32_16x16x32_bf16 v[212:215], v[68:71], v[36:39], v[212:215]
v_mfma_f32_16x16x32_bf16 v[216:219], v[72:75], v[36:39], v[216:219]
v_mfma_f32_16x16x32_bf16 v[248:251], v[72:75], v[40:43], v[248:251]
v_mfma_f32_16x16x32_bf16 v[244:247], v[68:71], v[40:43], v[244:247]
v_mfma_f32_16x16x32_bf16 v[240:243], v[64:67], v[40:43], v[240:243]
v_mfma_f32_16x16x32_bf16 v[236:239], v[60:63], v[40:43], v[236:239]
v_mfma_f32_16x16x32_bf16 v[232:235], v[56:59], v[40:43], v[232:235]
v_mfma_f32_16x16x32_bf16 v[228:231], v[52:55], v[40:43], v[228:231]
v_mfma_f32_16x16x32_bf16 v[224:227], v[48:51], v[40:43], v[224:227]
v_mfma_f32_16x16x32_bf16 v[220:223], v[44:47], v[40:43], v[220:223]
s_waitcnt lgkmcnt(0)
s_barrier
v_mfma_f32_16x16x32_bf16 v[124:127], v[92:95], v[76:79], v[124:127]
ds_read_b128 v[28:31], v9 offset:0
v_mfma_f32_16x16x32_bf16 v[128:131], v[96:99], v[76:79], v[128:131]
ds_read_b64_tr_b16 v[44:45], v11 offset:0
v_mfma_f32_16x16x32_bf16 v[132:135], v[100:103], v[76:79], v[132:135]
ds_read_b64_tr_b16 v[46:47], v11 offset:4096
v_mfma_f32_16x16x32_bf16 v[136:139], v[104:107], v[76:79], v[136:139]
ds_read_b64_tr_b16 v[48:49], v12 offset:0
v_mfma_f32_16x16x32_bf16 v[140:143], v[108:111], v[76:79], v[140:143]
ds_read_b64_tr_b16 v[50:51], v12 offset:4096
v_mfma_f32_16x16x32_bf16 v[144:147], v[112:115], v[76:79], v[144:147]
ds_read_b64_tr_b16 v[52:53], v13 offset:0
v_mfma_f32_16x16x32_bf16 v[148:151], v[116:119], v[76:79], v[148:151]
ds_read_b64_tr_b16 v[54:55], v13 offset:4096
v_mfma_f32_16x16x32_bf16 v[152:155], v[120:123], v[76:79], v[152:155]
ds_read_b64_tr_b16 v[56:57], v14 offset:0
v_mfma_f32_16x16x32_bf16 v[184:187], v[120:123], v[80:83], v[184:187]
ds_read_b64_tr_b16 v[58:59], v14 offset:4096
v_mfma_f32_16x16x32_bf16 v[180:183], v[116:119], v[80:83], v[180:183]
ds_read_b64_tr_b16 v[60:61], v11 offset:16384
v_mfma_f32_16x16x32_bf16 v[176:179], v[112:115], v[80:83], v[176:179]
ds_read_b64_tr_b16 v[62:63], v11 offset:20480
v_mfma_f32_16x16x32_bf16 v[172:175], v[108:111], v[80:83], v[172:175]
ds_read_b64_tr_b16 v[64:65], v12 offset:16384
v_mfma_f32_16x16x32_bf16 v[168:171], v[104:107], v[80:83], v[168:171]
ds_read_b64_tr_b16 v[66:67], v12 offset:20480
v_mfma_f32_16x16x32_bf16 v[164:167], v[100:103], v[80:83], v[164:167]
ds_read_b64_tr_b16 v[68:69], v13 offset:16384
v_mfma_f32_16x16x32_bf16 v[160:163], v[96:99], v[80:83], v[160:163]
ds_read_b64_tr_b16 v[70:71], v13 offset:20480
v_mfma_f32_16x16x32_bf16 v[156:159], v[92:95], v[80:83], v[156:159]
ds_read_b64_tr_b16 v[72:73], v14 offset:16384
v_mfma_f32_16x16x32_bf16 v[188:191], v[92:95], v[84:87], v[188:191]
ds_read_b64_tr_b16 v[74:75], v14 offset:20480
v_mfma_f32_16x16x32_bf16 v[192:195], v[96:99], v[84:87], v[192:195]
ds_read_b128 v[32:35], v9 offset:1024
v_mfma_f32_16x16x32_bf16 v[196:199], v[100:103], v[84:87], v[196:199]
ds_read_b128 v[36:39], v9 offset:2048
v_mfma_f32_16x16x32_bf16 v[200:203], v[104:107], v[84:87], v[200:203]
ds_read_b128 v[40:43], v9 offset:3072
v_mfma_f32_16x16x32_bf16 v[204:207], v[108:111], v[84:87], v[204:207]
v_mfma_f32_16x16x32_bf16 v[208:211], v[112:115], v[84:87], v[208:211]
v_mfma_f32_16x16x32_bf16 v[212:215], v[116:119], v[84:87], v[212:215]
v_mfma_f32_16x16x32_bf16 v[216:219], v[120:123], v[84:87], v[216:219]
v_mfma_f32_16x16x32_bf16 v[248:251], v[120:123], v[88:91], v[248:251]
v_mfma_f32_16x16x32_bf16 v[244:247], v[116:119], v[88:91], v[244:247]
v_mfma_f32_16x16x32_bf16 v[240:243], v[112:115], v[88:91], v[240:243]
v_mfma_f32_16x16x32_bf16 v[236:239], v[108:111], v[88:91], v[236:239]
v_mfma_f32_16x16x32_bf16 v[232:235], v[104:107], v[88:91], v[232:235]
v_mfma_f32_16x16x32_bf16 v[228:231], v[100:103], v[88:91], v[228:231]
v_mfma_f32_16x16x32_bf16 v[224:227], v[96:99], v[88:91], v[224:227]
v_mfma_f32_16x16x32_bf16 v[220:223], v[92:95], v[88:91], v[220:223]
s_waitcnt lgkmcnt(0)
v_mfma_f32_16x16x32_bf16 v[124:127], v[44:47], v[28:31], v[124:127]
ds_read_b128 v[76:79], v9 offset:8192
v_mfma_f32_16x16x32_bf16 v[128:131], v[48:51], v[28:31], v[128:131]
ds_read_b64_tr_b16 v[92:93], v11 offset:8192
v_mfma_f32_16x16x32_bf16 v[132:135], v[52:55], v[28:31], v[132:135]
ds_read_b64_tr_b16 v[94:95], v11 offset:12288
v_mfma_f32_16x16x32_bf16 v[136:139], v[56:59], v[28:31], v[136:139]
ds_read_b64_tr_b16 v[96:97], v12 offset:8192
v_mfma_f32_16x16x32_bf16 v[140:143], v[60:63], v[28:31], v[140:143]
ds_read_b64_tr_b16 v[98:99], v12 offset:12288
v_mfma_f32_16x16x32_bf16 v[144:147], v[64:67], v[28:31], v[144:147]
ds_read_b64_tr_b16 v[100:101], v13 offset:8192
v_mfma_f32_16x16x32_bf16 v[148:151], v[68:71], v[28:31], v[148:151]
ds_read_b64_tr_b16 v[102:103], v13 offset:12288
v_mfma_f32_16x16x32_bf16 v[152:155], v[72:75], v[28:31], v[152:155]
ds_read_b64_tr_b16 v[104:105], v14 offset:8192
v_mfma_f32_16x16x32_bf16 v[184:187], v[72:75], v[32:35], v[184:187]
ds_read_b64_tr_b16 v[106:107], v14 offset:12288
v_mfma_f32_16x16x32_bf16 v[180:183], v[68:71], v[32:35], v[180:183]
ds_read_b64_tr_b16 v[108:109], v11 offset:24576
v_mfma_f32_16x16x32_bf16 v[176:179], v[64:67], v[32:35], v[176:179]
ds_read_b64_tr_b16 v[110:111], v11 offset:28672
v_mfma_f32_16x16x32_bf16 v[172:175], v[60:63], v[32:35], v[172:175]
ds_read_b64_tr_b16 v[112:113], v12 offset:24576
v_mfma_f32_16x16x32_bf16 v[168:171], v[56:59], v[32:35], v[168:171]
ds_read_b64_tr_b16 v[114:115], v12 offset:28672
v_mfma_f32_16x16x32_bf16 v[164:167], v[52:55], v[32:35], v[164:167]
ds_read_b64_tr_b16 v[116:117], v13 offset:24576
v_mfma_f32_16x16x32_bf16 v[160:163], v[48:51], v[32:35], v[160:163]
ds_read_b64_tr_b16 v[118:119], v13 offset:28672
v_mfma_f32_16x16x32_bf16 v[156:159], v[44:47], v[32:35], v[156:159]
ds_read_b64_tr_b16 v[120:121], v14 offset:24576
v_mfma_f32_16x16x32_bf16 v[188:191], v[44:47], v[36:39], v[188:191]
ds_read_b64_tr_b16 v[122:123], v14 offset:28672
v_mfma_f32_16x16x32_bf16 v[192:195], v[48:51], v[36:39], v[192:195]
ds_read_b128 v[80:83], v9 offset:9216
v_mfma_f32_16x16x32_bf16 v[196:199], v[52:55], v[36:39], v[196:199]
ds_read_b128 v[84:87], v9 offset:10240
v_mfma_f32_16x16x32_bf16 v[200:203], v[56:59], v[36:39], v[200:203]
ds_read_b128 v[88:91], v9 offset:11264
v_mfma_f32_16x16x32_bf16 v[204:207], v[60:63], v[36:39], v[204:207]
v_mfma_f32_16x16x32_bf16 v[208:211], v[64:67], v[36:39], v[208:211]
v_mfma_f32_16x16x32_bf16 v[212:215], v[68:71], v[36:39], v[212:215]
v_mfma_f32_16x16x32_bf16 v[216:219], v[72:75], v[36:39], v[216:219]
v_mfma_f32_16x16x32_bf16 v[248:251], v[72:75], v[40:43], v[248:251]
v_mfma_f32_16x16x32_bf16 v[244:247], v[68:71], v[40:43], v[244:247]
v_mfma_f32_16x16x32_bf16 v[240:243], v[64:67], v[40:43], v[240:243]
v_mfma_f32_16x16x32_bf16 v[236:239], v[60:63], v[40:43], v[236:239]
v_mfma_f32_16x16x32_bf16 v[232:235], v[56:59], v[40:43], v[232:235]
v_mfma_f32_16x16x32_bf16 v[228:231], v[52:55], v[40:43], v[228:231]
v_mfma_f32_16x16x32_bf16 v[224:227], v[48:51], v[40:43], v[224:227]
v_mfma_f32_16x16x32_bf16 v[220:223], v[44:47], v[40:43], v[220:223]
s_waitcnt lgkmcnt(0)
s_barrier
v_mfma_f32_16x16x32_bf16 v[124:127], v[92:95], v[76:79], v[124:127]
ds_read_b128 v[28:31], v9 offset:49152
v_mfma_f32_16x16x32_bf16 v[128:131], v[96:99], v[76:79], v[128:131]
ds_read_b64_tr_b16 v[44:45], v15 offset:0
v_mfma_f32_16x16x32_bf16 v[132:135], v[100:103], v[76:79], v[132:135]
ds_read_b64_tr_b16 v[46:47], v15 offset:4096
v_mfma_f32_16x16x32_bf16 v[136:139], v[104:107], v[76:79], v[136:139]
ds_read_b64_tr_b16 v[48:49], v16 offset:0
v_mfma_f32_16x16x32_bf16 v[140:143], v[108:111], v[76:79], v[140:143]
ds_read_b64_tr_b16 v[50:51], v16 offset:4096
v_mfma_f32_16x16x32_bf16 v[144:147], v[112:115], v[76:79], v[144:147]
ds_read_b64_tr_b16 v[52:53], v17 offset:0
v_mfma_f32_16x16x32_bf16 v[148:151], v[116:119], v[76:79], v[148:151]
ds_read_b64_tr_b16 v[54:55], v17 offset:4096
v_mfma_f32_16x16x32_bf16 v[152:155], v[120:123], v[76:79], v[152:155]
ds_read_b64_tr_b16 v[56:57], v18 offset:0
v_mfma_f32_16x16x32_bf16 v[184:187], v[120:123], v[80:83], v[184:187]
ds_read_b64_tr_b16 v[58:59], v18 offset:4096
v_mfma_f32_16x16x32_bf16 v[180:183], v[116:119], v[80:83], v[180:183]
ds_read_b64_tr_b16 v[60:61], v15 offset:16384
v_mfma_f32_16x16x32_bf16 v[176:179], v[112:115], v[80:83], v[176:179]
ds_read_b64_tr_b16 v[62:63], v15 offset:20480
v_mfma_f32_16x16x32_bf16 v[172:175], v[108:111], v[80:83], v[172:175]
ds_read_b64_tr_b16 v[64:65], v16 offset:16384
v_mfma_f32_16x16x32_bf16 v[168:171], v[104:107], v[80:83], v[168:171]
ds_read_b64_tr_b16 v[66:67], v16 offset:20480
v_mfma_f32_16x16x32_bf16 v[164:167], v[100:103], v[80:83], v[164:167]
ds_read_b64_tr_b16 v[68:69], v17 offset:16384
v_mfma_f32_16x16x32_bf16 v[160:163], v[96:99], v[80:83], v[160:163]
ds_read_b64_tr_b16 v[70:71], v17 offset:20480
v_mfma_f32_16x16x32_bf16 v[156:159], v[92:95], v[80:83], v[156:159]
ds_read_b64_tr_b16 v[72:73], v18 offset:16384
v_mfma_f32_16x16x32_bf16 v[188:191], v[92:95], v[84:87], v[188:191]
ds_read_b64_tr_b16 v[74:75], v18 offset:20480
v_mfma_f32_16x16x32_bf16 v[192:195], v[96:99], v[84:87], v[192:195]
ds_read_b128 v[32:35], v9 offset:50176
v_mfma_f32_16x16x32_bf16 v[196:199], v[100:103], v[84:87], v[196:199]
ds_read_b128 v[36:39], v9 offset:51200
v_mfma_f32_16x16x32_bf16 v[200:203], v[104:107], v[84:87], v[200:203]
ds_read_b128 v[40:43], v9 offset:52224
v_mfma_f32_16x16x32_bf16 v[204:207], v[108:111], v[84:87], v[204:207]
v_mfma_f32_16x16x32_bf16 v[208:211], v[112:115], v[84:87], v[208:211]
v_mfma_f32_16x16x32_bf16 v[212:215], v[116:119], v[84:87], v[212:215]
v_mfma_f32_16x16x32_bf16 v[216:219], v[120:123], v[84:87], v[216:219]
v_mfma_f32_16x16x32_bf16 v[248:251], v[120:123], v[88:91], v[248:251]
v_mfma_f32_16x16x32_bf16 v[244:247], v[116:119], v[88:91], v[244:247]
v_mfma_f32_16x16x32_bf16 v[240:243], v[112:115], v[88:91], v[240:243]
v_mfma_f32_16x16x32_bf16 v[236:239], v[108:111], v[88:91], v[236:239]
v_mfma_f32_16x16x32_bf16 v[232:235], v[104:107], v[88:91], v[232:235]
v_mfma_f32_16x16x32_bf16 v[228:231], v[100:103], v[88:91], v[228:231]
v_mfma_f32_16x16x32_bf16 v[224:227], v[96:99], v[88:91], v[224:227]
s_branch Lov_18
.p2align 12
Lst_18_0:
s_branch Lwr_127
Lst_18_1:
s_branch Lwr_130
Lov_18:
v_mfma_f32_16x16x32_bf16 v[220:223], v[92:95], v[88:91], v[220:223]
s_waitcnt lgkmcnt(0)
v_mfma_f32_16x16x32_bf16 v[124:127], v[44:47], v[28:31], v[124:127]
ds_read_b128 v[76:79], v9 offset:57344
v_mfma_f32_16x16x32_bf16 v[128:131], v[48:51], v[28:31], v[128:131]
ds_read_b64_tr_b16 v[92:93], v15 offset:8192
v_mfma_f32_16x16x32_bf16 v[132:135], v[52:55], v[28:31], v[132:135]
ds_read_b64_tr_b16 v[94:95], v15 offset:12288
v_mfma_f32_16x16x32_bf16 v[136:139], v[56:59], v[28:31], v[136:139]
ds_read_b64_tr_b16 v[96:97], v16 offset:8192
v_mfma_f32_16x16x32_bf16 v[140:143], v[60:63], v[28:31], v[140:143]
ds_read_b64_tr_b16 v[98:99], v16 offset:12288
v_mfma_f32_16x16x32_bf16 v[144:147], v[64:67], v[28:31], v[144:147]
ds_read_b64_tr_b16 v[100:101], v17 offset:8192
v_mfma_f32_16x16x32_bf16 v[148:151], v[68:71], v[28:31], v[148:151]
ds_read_b64_tr_b16 v[102:103], v17 offset:12288
v_mfma_f32_16x16x32_bf16 v[152:155], v[72:75], v[28:31], v[152:155]
ds_read_b64_tr_b16 v[104:105], v18 offset:8192
v_mfma_f32_16x16x32_bf16 v[184:187], v[72:75], v[32:35], v[184:187]
ds_read_b64_tr_b16 v[106:107], v18 offset:12288
v_mfma_f32_16x16x32_bf16 v[180:183], v[68:71], v[32:35], v[180:183]
ds_read_b64_tr_b16 v[108:109], v15 offset:24576
v_mfma_f32_16x16x32_bf16 v[176:179], v[64:67], v[32:35], v[176:179]
ds_read_b64_tr_b16 v[110:111], v15 offset:28672
v_mfma_f32_16x16x32_bf16 v[172:175], v[60:63], v[32:35], v[172:175]
ds_read_b64_tr_b16 v[112:113], v16 offset:24576
v_mfma_f32_16x16x32_bf16 v[168:171], v[56:59], v[32:35], v[168:171]
ds_read_b64_tr_b16 v[114:115], v16 offset:28672
v_mfma_f32_16x16x32_bf16 v[164:167], v[52:55], v[32:35], v[164:167]
ds_read_b64_tr_b16 v[116:117], v17 offset:24576
v_mfma_f32_16x16x32_bf16 v[160:163], v[48:51], v[32:35], v[160:163]
ds_read_b64_tr_b16 v[118:119], v17 offset:28672
v_mfma_f32_16x16x32_bf16 v[156:159], v[44:47], v[32:35], v[156:159]
ds_read_b64_tr_b16 v[120:121], v18 offset:24576
v_mfma_f32_16x16x32_bf16 v[188:191], v[44:47], v[36:39], v[188:191]
ds_read_b64_tr_b16 v[122:123], v18 offset:28672
v_mfma_f32_16x16x32_bf16 v[192:195], v[48:51], v[36:39], v[192:195]
ds_read_b128 v[80:83], v9 offset:58368
v_mfma_f32_16x16x32_bf16 v[196:199], v[52:55], v[36:39], v[196:199]
ds_read_b128 v[84:87], v9 offset:59392
v_mfma_f32_16x16x32_bf16 v[200:203], v[56:59], v[36:39], v[200:203]
ds_read_b128 v[88:91], v9 offset:60416
v_mfma_f32_16x16x32_bf16 v[204:207], v[60:63], v[36:39], v[204:207]
v_mfma_f32_16x16x32_bf16 v[208:211], v[64:67], v[36:39], v[208:211]
v_mfma_f32_16x16x32_bf16 v[212:215], v[68:71], v[36:39], v[212:215]
v_mfma_f32_16x16x32_bf16 v[216:219], v[72:75], v[36:39], v[216:219]
v_mfma_f32_16x16x32_bf16 v[248:251], v[72:75], v[40:43], v[248:251]
v_mfma_f32_16x16x32_bf16 v[244:247], v[68:71], v[40:43], v[244:247]
v_mfma_f32_16x16x32_bf16 v[240:243], v[64:67], v[40:43], v[240:243]
v_mfma_f32_16x16x32_bf16 v[236:239], v[60:63], v[40:43], v[236:239]
v_mfma_f32_16x16x32_bf16 v[232:235], v[56:59], v[40:43], v[232:235]
v_mfma_f32_16x16x32_bf16 v[228:231], v[52:55], v[40:43], v[228:231]
v_mfma_f32_16x16x32_bf16 v[224:227], v[48:51], v[40:43], v[224:227]
v_mfma_f32_16x16x32_bf16 v[220:223], v[44:47], v[40:43], v[220:223]
s_waitcnt lgkmcnt(0)
s_barrier
v_mfma_f32_16x16x32_bf16 v[124:127], v[92:95], v[76:79], v[124:127]
ds_read_b128 v[28:31], v10 offset:0
v_mfma_f32_16x16x32_bf16 v[128:131], v[96:99], v[76:79], v[128:131]
ds_read_b64_tr_b16 v[44:45], v19 offset:0
v_mfma_f32_16x16x32_bf16 v[132:135], v[100:103], v[76:79], v[132:135]
ds_read_b64_tr_b16 v[46:47], v19 offset:4096
v_mfma_f32_16x16x32_bf16 v[136:139], v[104:107], v[76:79], v[136:139]
ds_read_b64_tr_b16 v[48:49], v20 offset:0
v_mfma_f32_16x16x32_bf16 v[140:143], v[108:111], v[76:79], v[140:143]
ds_read_b64_tr_b16 v[50:51], v20 offset:4096
v_mfma_f32_16x16x32_bf16 v[144:147], v[112:115], v[76:79], v[144:147]
ds_read_b64_tr_b16 v[52:53], v21 offset:0
v_mfma_f32_16x16x32_bf16 v[148:151], v[116:119], v[76:79], v[148:151]
ds_read_b64_tr_b16 v[54:55], v21 offset:4096
v_mfma_f32_16x16x32_bf16 v[152:155], v[120:123], v[76:79], v[152:155]
ds_read_b64_tr_b16 v[56:57], v22 offset:0
v_mfma_f32_16x16x32_bf16 v[184:187], v[120:123], v[80:83], v[184:187]
ds_read_b64_tr_b16 v[58:59], v22 offset:4096
v_mfma_f32_16x16x32_bf16 v[180:183], v[116:119], v[80:83], v[180:183]
ds_read_b64_tr_b16 v[60:61], v19 offset:16384
v_mfma_f32_16x16x32_bf16 v[176:179], v[112:115], v[80:83], v[176:179]
ds_read_b64_tr_b16 v[62:63], v19 offset:20480
v_mfma_f32_16x16x32_bf16 v[172:175], v[108:111], v[80:83], v[172:175]
ds_read_b64_tr_b16 v[64:65], v20 offset:16384
v_mfma_f32_16x16x32_bf16 v[168:171], v[104:107], v[80:83], v[168:171]
ds_read_b64_tr_b16 v[66:67], v20 offset:20480
v_mfma_f32_16x16x32_bf16 v[164:167], v[100:103], v[80:83], v[164:167]
ds_read_b64_tr_b16 v[68:69], v21 offset:16384
v_mfma_f32_16x16x32_bf16 v[160:163], v[96:99], v[80:83], v[160:163]
ds_read_b64_tr_b16 v[70:71], v21 offset:20480
v_mfma_f32_16x16x32_bf16 v[156:159], v[92:95], v[80:83], v[156:159]
ds_read_b64_tr_b16 v[72:73], v22 offset:16384
v_mfma_f32_16x16x32_bf16 v[188:191], v[92:95], v[84:87], v[188:191]
ds_read_b64_tr_b16 v[74:75], v22 offset:20480
v_mfma_f32_16x16x32_bf16 v[192:195], v[96:99], v[84:87], v[192:195]
ds_read_b128 v[32:35], v10 offset:1024
v_mfma_f32_16x16x32_bf16 v[196:199], v[100:103], v[84:87], v[196:199]
ds_read_b128 v[36:39], v10 offset:2048
v_mfma_f32_16x16x32_bf16 v[200:203], v[104:107], v[84:87], v[200:203]
ds_read_b128 v[40:43], v10 offset:3072
v_mfma_f32_16x16x32_bf16 v[204:207], v[108:111], v[84:87], v[204:207]
v_mfma_f32_16x16x32_bf16 v[208:211], v[112:115], v[84:87], v[208:211]
v_mfma_f32_16x16x32_bf16 v[212:215], v[116:119], v[84:87], v[212:215]
v_mfma_f32_16x16x32_bf16 v[216:219], v[120:123], v[84:87], v[216:219]
v_mfma_f32_16x16x32_bf16 v[248:251], v[120:123], v[88:91], v[248:251]
v_mfma_f32_16x16x32_bf16 v[244:247], v[116:119], v[88:91], v[244:247]
v_mfma_f32_16x16x32_bf16 v[240:243], v[112:115], v[88:91], v[240:243]
v_mfma_f32_16x16x32_bf16 v[236:239], v[108:111], v[88:91], v[236:239]
v_mfma_f32_16x16x32_bf16 v[232:235], v[104:107], v[88:91], v[232:235]
v_mfma_f32_16x16x32_bf16 v[228:231], v[100:103], v[88:91], v[228:231]
v_mfma_f32_16x16x32_bf16 v[224:227], v[96:99], v[88:91], v[224:227]
v_mfma_f32_16x16x32_bf16 v[220:223], v[92:95], v[88:91], v[220:223]
s_sub_u32 s41, s41, 1
s_cmp_lg_u32 s41, 0
s_cbranch_scc1 Lk3l_112
s_waitcnt lgkmcnt(0)
v_mfma_f32_16x16x32_bf16 v[124:127], v[44:47], v[28:31], v[124:127]
ds_read_b128 v[76:79], v10 offset:8192
v_mfma_f32_16x16x32_bf16 v[128:131], v[48:51], v[28:31], v[128:131]
ds_read_b64_tr_b16 v[92:93], v19 offset:8192
v_mfma_f32_16x16x32_bf16 v[132:135], v[52:55], v[28:31], v[132:135]
ds_read_b64_tr_b16 v[94:95], v19 offset:12288
v_mfma_f32_16x16x32_bf16 v[136:139], v[56:59], v[28:31], v[136:139]
ds_read_b64_tr_b16 v[96:97], v20 offset:8192
v_mfma_f32_16x16x32_bf16 v[140:143], v[60:63], v[28:31], v[140:143]
ds_read_b64_tr_b16 v[98:99], v20 offset:12288
v_mfma_f32_16x16x32_bf16 v[144:147], v[64:67], v[28:31], v[144:147]
ds_read_b64_tr_b16 v[100:101], v21 offset:8192
v_mfma_f32_16x16x32_bf16 v[148:151], v[68:71], v[28:31], v[148:151]
ds_read_b64_tr_b16 v[102:103], v21 offset:12288
v_mfma_f32_16x16x32_bf16 v[152:155], v[72:75], v[28:31], v[152:155]
ds_read_b64_tr_b16 v[104:105], v22 offset:8192
v_mfma_f32_16x16x32_bf16 v[184:187], v[72:75], v[32:35], v[184:187]
ds_read_b64_tr_b16 v[106:107], v22 offset:12288
v_mfma_f32_16x16x32_bf16 v[180:183], v[68:71], v[32:35], v[180:183]
ds_read_b64_tr_b16 v[108:109], v19 offset:24576
v_mfma_f32_16x16x32_bf16 v[176:179], v[64:67], v[32:35], v[176:179]
ds_read_b64_tr_b16 v[110:111], v19 offset:28672
v_mfma_f32_16x16x32_bf16 v[172:175], v[60:63], v[32:35], v[172:175]
ds_read_b64_tr_b16 v[112:113], v20 offset:24576
v_mfma_f32_16x16x32_bf16 v[168:171], v[56:59], v[32:35], v[168:171]
ds_read_b64_tr_b16 v[114:115], v20 offset:28672
v_mfma_f32_16x16x32_bf16 v[164:167], v[52:55], v[32:35], v[164:167]
ds_read_b64_tr_b16 v[116:117], v21 offset:24576
v_mfma_f32_16x16x32_bf16 v[160:163], v[48:51], v[32:35], v[160:163]
ds_read_b64_tr_b16 v[118:119], v21 offset:28672
v_mfma_f32_16x16x32_bf16 v[156:159], v[44:47], v[32:35], v[156:159]
ds_read_b64_tr_b16 v[120:121], v22 offset:24576
v_mfma_f32_16x16x32_bf16 v[188:191], v[44:47], v[36:39], v[188:191]
ds_read_b64_tr_b16 v[122:123], v22 offset:28672
v_mfma_f32_16x16x32_bf16 v[192:195], v[48:51], v[36:39], v[192:195]
ds_read_b128 v[80:83], v10 offset:9216
v_mfma_f32_16x16x32_bf16 v[196:199], v[52:55], v[36:39], v[196:199]
ds_read_b128 v[84:87], v10 offset:10240
v_mfma_f32_16x16x32_bf16 v[200:203], v[56:59], v[36:39], v[200:203]
ds_read_b128 v[88:91], v10 offset:11264
v_mfma_f32_16x16x32_bf16 v[204:207], v[60:63], v[36:39], v[204:207]
v_mfma_f32_16x16x32_bf16 v[208:211], v[64:67], v[36:39], v[208:211]
v_mfma_f32_16x16x32_bf16 v[212:215], v[68:71], v[36:39], v[212:215]
v_mfma_f32_16x16x32_bf16 v[216:219], v[72:75], v[36:39], v[216:219]
v_mfma_f32_16x16x32_bf16 v[248:251], v[72:75], v[40:43], v[248:251]
v_mfma_f32_16x16x32_bf16 v[244:247], v[68:71], v[40:43], v[244:247]
v_mfma_f32_16x16x32_bf16 v[240:243], v[64:67], v[40:43], v[240:243]
v_mfma_f32_16x16x32_bf16 v[236:239], v[60:63], v[40:43], v[236:239]
v_mfma_f32_16x16x32_bf16 v[232:235], v[56:59], v[40:43], v[232:235]
v_mfma_f32_16x16x32_bf16 v[228:231], v[52:55], v[40:43], v[228:231]
v_mfma_f32_16x16x32_bf16 v[224:227], v[48:51], v[40:43], v[224:227]
v_mfma_f32_16x16x32_bf16 v[220:223], v[44:47], v[40:43], v[220:223]
s_waitcnt lgkmcnt(0)
s_barrier
v_mfma_f32_16x16x32_bf16 v[124:127], v[92:95], v[76:79], v[124:127]
ds_read_b128 v[28:31], v9 offset:0
v_mfma_f32_16x16x32_bf16 v[128:131], v[96:99], v[76:79], v[128:131]
ds_read_b64_tr_b16 v[44:45], v11 offset:0
v_mfma_f32_16x16x32_bf16 v[132:135], v[100:103], v[76:79], v[132:135]
ds_read_b64_tr_b16 v[46:47], v11 offset:4096
v_mfma_f32_16x16x32_bf16 v[136:139], v[104:107], v[76:79], v[136:139]
ds_read_b64_tr_b16 v[48:49], v12 offset:0
v_mfma_f32_16x16x32_bf16 v[140:143], v[108:111], v[76:79], v[140:143]
ds_read_b64_tr_b16 v[50:51], v12 offset:4096
v_mfma_f32_16x16x32_bf16 v[144:147], v[112:115], v[76:79], v[144:147]
ds_read_b64_tr_b16 v[52:53], v13 offset:0
v_mfma_f32_16x16x32_bf16 v[148:151], v[116:119], v[76:79], v[148:151]
ds_read_b64_tr_b16 v[54:55], v13 offset:4096
v_mfma_f32_16x16x32_bf16 v[152:155], v[120:123], v[76:79], v[152:155]
ds_read_b64_tr_b16 v[56:57], v14 offset:0
v_mfma_f32_16x16x32_bf16 v[184:187], v[120:123], v[80:83], v[184:187]
ds_read_b64_tr_b16 v[58:59], v14 offset:4096
v_mfma_f32_16x16x32_bf16 v[180:183], v[116:119], v[80:83], v[180:183]
ds_read_b64_tr_b16 v[60:61], v11 offset:16384
v_mfma_f32_16x16x32_bf16 v[176:179], v[112:115], v[80:83], v[176:179]
ds_read_b64_tr_b16 v[62:63], v11 offset:20480
v_mfma_f32_16x16x32_bf16 v[172:175], v[108:111], v[80:83], v[172:175]
ds_read_b64_tr_b16 v[64:65], v12 offset:16384
v_mfma_f32_16x16x32_bf16 v[168:171], v[104:107], v[80:83], v[168:171]
ds_read_b64_tr_b16 v[66:67], v12 offset:20480
v_mfma_f32_16x16x32_bf16 v[164:167], v[100:103], v[80:83], v[164:167]
ds_read_b64_tr_b16 v[68:69], v13 offset:16384
v_mfma_f32_16x16x32_bf16 v[160:163], v[96:99], v[80:83], v[160:163]
ds_read_b64_tr_b16 v[70:71], v13 offset:20480
v_mfma_f32_16x16x32_bf16 v[156:159], v[92:95], v[80:83], v[156:159]
ds_read_b64_tr_b16 v[72:73], v14 offset:16384
v_mfma_f32_16x16x32_bf16 v[188:191], v[92:95], v[84:87], v[188:191]
ds_read_b64_tr_b16 v[74:75], v14 offset:20480
v_mfma_f32_16x16x32_bf16 v[192:195], v[96:99], v[84:87], v[192:195]
ds_read_b128 v[32:35], v9 offset:1024
v_mfma_f32_16x16x32_bf16 v[196:199], v[100:103], v[84:87], v[196:199]
ds_read_b128 v[36:39], v9 offset:2048
v_mfma_f32_16x16x32_bf16 v[200:203], v[104:107], v[84:87], v[200:203]
ds_read_b128 v[40:43], v9 offset:3072
v_mfma_f32_16x16x32_bf16 v[204:207], v[108:111], v[84:87], v[204:207]
v_mfma_f32_16x16x32_bf16 v[208:211], v[112:115], v[84:87], v[208:211]
v_mfma_f32_16x16x32_bf16 v[212:215], v[116:119], v[84:87], v[212:215]
v_mfma_f32_16x16x32_bf16 v[216:219], v[120:123], v[84:87], v[216:219]
v_mfma_f32_16x16x32_bf16 v[248:251], v[120:123], v[88:91], v[248:251]
v_mfma_f32_16x16x32_bf16 v[244:247], v[116:119], v[88:91], v[244:247]
v_mfma_f32_16x16x32_bf16 v[240:243], v[112:115], v[88:91], v[240:243]
v_mfma_f32_16x16x32_bf16 v[236:239], v[108:111], v[88:91], v[236:239]
v_mfma_f32_16x16x32_bf16 v[232:235], v[104:107], v[88:91], v[232:235]
v_mfma_f32_16x16x32_bf16 v[228:231], v[100:103], v[88:91], v[228:231]
v_mfma_f32_16x16x32_bf16 v[224:227], v[96:99], v[88:91], v[224:227]
v_mfma_f32_16x16x32_bf16 v[220:223], v[92:95], v[88:91], v[220:223]
s_waitcnt lgkmcnt(0)
v_mfma_f32_16x16x32_bf16 v[124:127], v[44:47], v[28:31], v[124:127]
ds_read_b128 v[76:79], v9 offset:8192
v_mfma_f32_16x16x32_bf16 v[128:131], v[48:51], v[28:31], v[128:131]
ds_read_b64_tr_b16 v[92:93], v11 offset:8192
v_mfma_f32_16x16x32_bf16 v[132:135], v[52:55], v[28:31], v[132:135]
ds_read_b64_tr_b16 v[94:95], v11 offset:12288
v_mfma_f32_16x16x32_bf16 v[136:139], v[56:59], v[28:31], v[136:139]
ds_read_b64_tr_b16 v[96:97], v12 offset:8192
v_mfma_f32_16x16x32_bf16 v[140:143], v[60:63], v[28:31], v[140:143]
ds_read_b64_tr_b16 v[98:99], v12 offset:12288
v_mfma_f32_16x16x32_bf16 v[144:147], v[64:67], v[28:31], v[144:147]
ds_read_b64_tr_b16 v[100:101], v13 offset:8192
v_mfma_f32_16x16x32_bf16 v[148:151], v[68:71], v[28:31], v[148:151]
ds_read_b64_tr_b16 v[102:103], v13 offset:12288
v_mfma_f32_16x16x32_bf16 v[152:155], v[72:75], v[28:31], v[152:155]
ds_read_b64_tr_b16 v[104:105], v14 offset:8192
v_mfma_f32_16x16x32_bf16 v[184:187], v[72:75], v[32:35], v[184:187]
ds_read_b64_tr_b16 v[106:107], v14 offset:12288
v_mfma_f32_16x16x32_bf16 v[180:183], v[68:71], v[32:35], v[180:183]
ds_read_b64_tr_b16 v[108:109], v11 offset:24576
v_mfma_f32_16x16x32_bf16 v[176:179], v[64:67], v[32:35], v[176:179]
ds_read_b64_tr_b16 v[110:111], v11 offset:28672
v_mfma_f32_16x16x32_bf16 v[172:175], v[60:63], v[32:35], v[172:175]
ds_read_b64_tr_b16 v[112:113], v12 offset:24576
v_mfma_f32_16x16x32_bf16 v[168:171], v[56:59], v[32:35], v[168:171]
ds_read_b64_tr_b16 v[114:115], v12 offset:28672
v_mfma_f32_16x16x32_bf16 v[164:167], v[52:55], v[32:35], v[164:167]
ds_read_b64_tr_b16 v[116:117], v13 offset:24576
v_mfma_f32_16x16x32_bf16 v[160:163], v[48:51], v[32:35], v[160:163]
ds_read_b64_tr_b16 v[118:119], v13 offset:28672
v_mfma_f32_16x16x32_bf16 v[156:159], v[44:47], v[32:35], v[156:159]
ds_read_b64_tr_b16 v[120:121], v14 offset:24576
v_mfma_f32_16x16x32_bf16 v[188:191], v[44:47], v[36:39], v[188:191]
ds_read_b64_tr_b16 v[122:123], v14 offset:28672
v_mfma_f32_16x16x32_bf16 v[192:195], v[48:51], v[36:39], v[192:195]
ds_read_b128 v[80:83], v9 offset:9216
v_mfma_f32_16x16x32_bf16 v[196:199], v[52:55], v[36:39], v[196:199]
ds_read_b128 v[84:87], v9 offset:10240
v_mfma_f32_16x16x32_bf16 v[200:203], v[56:59], v[36:39], v[200:203]
ds_read_b128 v[88:91], v9 offset:11264
v_mfma_f32_16x16x32_bf16 v[204:207], v[60:63], v[36:39], v[204:207]
v_mfma_f32_16x16x32_bf16 v[208:211], v[64:67], v[36:39], v[208:211]
v_mfma_f32_16x16x32_bf16 v[212:215], v[68:71], v[36:39], v[212:215]
v_mfma_f32_16x16x32_bf16 v[216:219], v[72:75], v[36:39], v[216:219]
v_mfma_f32_16x16x32_bf16 v[248:251], v[72:75], v[40:43], v[248:251]
v_mfma_f32_16x16x32_bf16 v[244:247], v[68:71], v[40:43], v[244:247]
v_mfma_f32_16x16x32_bf16 v[240:243], v[64:67], v[40:43], v[240:243]
v_mfma_f32_16x16x32_bf16 v[236:239], v[60:63], v[40:43], v[236:239]
v_mfma_f32_16x16x32_bf16 v[232:235], v[56:59], v[40:43], v[232:235]
v_mfma_f32_16x16x32_bf16 v[228:231], v[52:55], v[40:43], v[228:231]
v_mfma_f32_16x16x32_bf16 v[224:227], v[48:51], v[40:43], v[224:227]
v_mfma_f32_16x16x32_bf16 v[220:223], v[44:47], v[40:43], v[220:223]
s_waitcnt lgkmcnt(0)
s_barrier
v_mfma_f32_16x16x32_bf16 v[124:127], v[92:95], v[76:79], v[124:127]
ds_read_b128 v[28:31], v9 offset:49152
v_mfma_f32_16x16x32_bf16 v[128:131], v[96:99], v[76:79], v[128:131]
ds_read_b64_tr_b16 v[44:45], v15 offset:0
v_mfma_f32_16x16x32_bf16 v[132:135], v[100:103], v[76:79], v[132:135]
ds_read_b64_tr_b16 v[46:47], v15 offset:4096
v_mfma_f32_16x16x32_bf16 v[136:139], v[104:107], v[76:79], v[136:139]
ds_read_b64_tr_b16 v[48:49], v16 offset:0
v_mfma_f32_16x16x32_bf16 v[140:143], v[108:111], v[76:79], v[140:143]
ds_read_b64_tr_b16 v[50:51], v16 offset:4096
v_mfma_f32_16x16x32_bf16 v[144:147], v[112:115], v[76:79], v[144:147]
ds_read_b64_tr_b16 v[52:53], v17 offset:0
v_mfma_f32_16x16x32_bf16 v[148:151], v[116:119], v[76:79], v[148:151]
ds_read_b64_tr_b16 v[54:55], v17 offset:4096
v_mfma_f32_16x16x32_bf16 v[152:155], v[120:123], v[76:79], v[152:155]
ds_read_b64_tr_b16 v[56:57], v18 offset:0
v_mfma_f32_16x16x32_bf16 v[184:187], v[120:123], v[80:83], v[184:187]
ds_read_b64_tr_b16 v[58:59], v18 offset:4096
v_mfma_f32_16x16x32_bf16 v[180:183], v[116:119], v[80:83], v[180:183]
ds_read_b64_tr_b16 v[60:61], v15 offset:16384
v_mfma_f32_16x16x32_bf16 v[176:179], v[112:115], v[80:83], v[176:179]
ds_read_b64_tr_b16 v[62:63], v15 offset:20480
v_mfma_f32_16x16x32_bf16 v[172:175], v[108:111], v[80:83], v[172:175]
ds_read_b64_tr_b16 v[64:65], v16 offset:16384
v_mfma_f32_16x16x32_bf16 v[168:171], v[104:107], v[80:83], v[168:171]
ds_read_b64_tr_b16 v[66:67], v16 offset:20480
v_mfma_f32_16x16x32_bf16 v[164:167], v[100:103], v[80:83], v[164:167]
ds_read_b64_tr_b16 v[68:69], v17 offset:16384
v_mfma_f32_16x16x32_bf16 v[160:163], v[96:99], v[80:83], v[160:163]
ds_read_b64_tr_b16 v[70:71], v17 offset:20480
v_mfma_f32_16x16x32_bf16 v[156:159], v[92:95], v[80:83], v[156:159]
ds_read_b64_tr_b16 v[72:73], v18 offset:16384
v_mfma_f32_16x16x32_bf16 v[188:191], v[92:95], v[84:87], v[188:191]
ds_read_b64_tr_b16 v[74:75], v18 offset:20480
v_mfma_f32_16x16x32_bf16 v[192:195], v[96:99], v[84:87], v[192:195]
ds_read_b128 v[32:35], v9 offset:50176
v_mfma_f32_16x16x32_bf16 v[196:199], v[100:103], v[84:87], v[196:199]
ds_read_b128 v[36:39], v9 offset:51200
v_mfma_f32_16x16x32_bf16 v[200:203], v[104:107], v[84:87], v[200:203]
ds_read_b128 v[40:43], v9 offset:52224
v_mfma_f32_16x16x32_bf16 v[204:207], v[108:111], v[84:87], v[204:207]
v_mfma_f32_16x16x32_bf16 v[208:211], v[112:115], v[84:87], v[208:211]
v_mfma_f32_16x16x32_bf16 v[212:215], v[116:119], v[84:87], v[212:215]
v_mfma_f32_16x16x32_bf16 v[216:219], v[120:123], v[84:87], v[216:219]
v_mfma_f32_16x16x32_bf16 v[248:251], v[120:123], v[88:91], v[248:251]
v_mfma_f32_16x16x32_bf16 v[244:247], v[116:119], v[88:91], v[244:247]
v_mfma_f32_16x16x32_bf16 v[240:243], v[112:115], v[88:91], v[240:243]
v_mfma_f32_16x16x32_bf16 v[236:239], v[108:111], v[88:91], v[236:239]
v_mfma_f32_16x16x32_bf16 v[232:235], v[104:107], v[88:91], v[232:235]
v_mfma_f32_16x16x32_bf16 v[228:231], v[100:103], v[88:91], v[228:231]
v_mfma_f32_16x16x32_bf16 v[224:227], v[96:99], v[88:91], v[224:227]
v_mfma_f32_16x16x32_bf16 v[220:223], v[92:95], v[88:91], v[220:223]
s_waitcnt lgkmcnt(0)
v_mfma_f32_16x16x32_bf16 v[124:127], v[44:47], v[28:31], v[124:127]
ds_read_b128 v[76:79], v9 offset:57344
v_mfma_f32_16x16x32_bf16 v[128:131], v[48:51], v[28:31], v[128:131]
ds_read_b64_tr_b16 v[92:93], v15 offset:8192
v_mfma_f32_16x16x32_bf16 v[132:135], v[52:55], v[28:31], v[132:135]
ds_read_b64_tr_b16 v[94:95], v15 offset:12288
v_mfma_f32_16x16x32_bf16 v[136:139], v[56:59], v[28:31], v[136:139]
ds_read_b64_tr_b16 v[96:97], v16 offset:8192
v_mfma_f32_16x16x32_bf16 v[140:143], v[60:63], v[28:31], v[140:143]
ds_read_b64_tr_b16 v[98:99], v16 offset:12288
v_mfma_f32_16x16x32_bf16 v[144:147], v[64:67], v[28:31], v[144:147]
ds_read_b64_tr_b16 v[100:101], v17 offset:8192
v_mfma_f32_16x16x32_bf16 v[148:151], v[68:71], v[28:31], v[148:151]
ds_read_b64_tr_b16 v[102:103], v17 offset:12288
v_mfma_f32_16x16x32_bf16 v[152:155], v[72:75], v[28:31], v[152:155]
ds_read_b64_tr_b16 v[104:105], v18 offset:8192
v_mfma_f32_16x16x32_bf16 v[184:187], v[72:75], v[32:35], v[184:187]
ds_read_b64_tr_b16 v[106:107], v18 offset:12288
v_mfma_f32_16x16x32_bf16 v[180:183], v[68:71], v[32:35], v[180:183]
ds_read_b64_tr_b16 v[108:109], v15 offset:24576
v_mfma_f32_16x16x32_bf16 v[176:179], v[64:67], v[32:35], v[176:179]
ds_read_b64_tr_b16 v[110:111], v15 offset:28672
v_mfma_f32_16x16x32_bf16 v[172:175], v[60:63], v[32:35], v[172:175]
ds_read_b64_tr_b16 v[112:113], v16 offset:24576
v_mfma_f32_16x16x32_bf16 v[168:171], v[56:59], v[32:35], v[168:171]
ds_read_b64_tr_b16 v[114:115], v16 offset:28672
v_mfma_f32_16x16x32_bf16 v[164:167], v[52:55], v[32:35], v[164:167]
ds_read_b64_tr_b16 v[116:117], v17 offset:24576
v_mfma_f32_16x16x32_bf16 v[160:163], v[48:51], v[32:35], v[160:163]
ds_read_b64_tr_b16 v[118:119], v17 offset:28672
v_mfma_f32_16x16x32_bf16 v[156:159], v[44:47], v[32:35], v[156:159]
ds_read_b64_tr_b16 v[120:121], v18 offset:24576
v_mfma_f32_16x16x32_bf16 v[188:191], v[44:47], v[36:39], v[188:191]
ds_read_b64_tr_b16 v[122:123], v18 offset:28672
v_mfma_f32_16x16x32_bf16 v[192:195], v[48:51], v[36:39], v[192:195]
ds_read_b128 v[80:83], v9 offset:58368
v_mfma_f32_16x16x32_bf16 v[196:199], v[52:55], v[36:39], v[196:199]
ds_read_b128 v[84:87], v9 offset:59392
v_mfma_f32_16x16x32_bf16 v[200:203], v[56:59], v[36:39], v[200:203]
ds_read_b128 v[88:91], v9 offset:60416
v_mfma_f32_16x16x32_bf16 v[204:207], v[60:63], v[36:39], v[204:207]
v_mfma_f32_16x16x32_bf16 v[208:211], v[64:67], v[36:39], v[208:211]
v_mfma_f32_16x16x32_bf16 v[212:215], v[68:71], v[36:39], v[212:215]
v_mfma_f32_16x16x32_bf16 v[216:219], v[72:75], v[36:39], v[216:219]
v_mfma_f32_16x16x32_bf16 v[248:251], v[72:75], v[40:43], v[248:251]
v_mfma_f32_16x16x32_bf16 v[244:247], v[68:71], v[40:43], v[244:247]
v_mfma_f32_16x16x32_bf16 v[240:243], v[64:67], v[40:43], v[240:243]
v_mfma_f32_16x16x32_bf16 v[236:239], v[60:63], v[40:43], v[236:239]
v_mfma_f32_16x16x32_bf16 v[232:235], v[56:59], v[40:43], v[232:235]
v_mfma_f32_16x16x32_bf16 v[228:231], v[52:55], v[40:43], v[228:231]
v_mfma_f32_16x16x32_bf16 v[224:227], v[48:51], v[40:43], v[224:227]
v_mfma_f32_16x16x32_bf16 v[220:223], v[44:47], v[40:43], v[220:223]
s_waitcnt lgkmcnt(0)
s_barrier
v_mfma_f32_16x16x32_bf16 v[124:127], v[92:95], v[76:79], v[124:127]
v_mfma_f32_16x16x32_bf16 v[128:131], v[96:99], v[76:79], v[128:131]
v_mfma_f32_16x16x32_bf16 v[132:135], v[100:103], v[76:79], v[132:135]
v_mfma_f32_16x16x32_bf16 v[136:139], v[104:107], v[76:79], v[136:139]
v_mfma_f32_16x16x32_bf16 v[140:143], v[108:111], v[76:79], v[140:143]
v_mfma_f32_16x16x32_bf16 v[144:147], v[112:115], v[76:79], v[144:147]
v_mfma_f32_16x16x32_bf16 v[148:151], v[116:119], v[76:79], v[148:151]
v_mfma_f32_16x16x32_bf16 v[152:155], v[120:123], v[76:79], v[152:155]
v_mfma_f32_16x16x32_bf16 v[184:187], v[120:123], v[80:83], v[184:187]
v_mfma_f32_16x16x32_bf16 v[180:183], v[116:119], v[80:83], v[180:183]
v_mfma_f32_16x16x32_bf16 v[176:179], v[112:115], v[80:83], v[176:179]
v_mfma_f32_16x16x32_bf16 v[172:175], v[108:111], v[80:83], v[172:175]
v_mfma_f32_16x16x32_bf16 v[168:171], v[104:107], v[80:83], v[168:171]
v_mfma_f32_16x16x32_bf16 v[164:167], v[100:103], v[80:83], v[164:167]
v_mfma_f32_16x16x32_bf16 v[160:163], v[96:99], v[80:83], v[160:163]
v_mfma_f32_16x16x32_bf16 v[156:159], v[92:95], v[80:83], v[156:159]
v_mfma_f32_16x16x32_bf16 v[188:191], v[92:95], v[84:87], v[188:191]
v_mfma_f32_16x16x32_bf16 v[192:195], v[96:99], v[84:87], v[192:195]
v_mfma_f32_16x16x32_bf16 v[196:199], v[100:103], v[84:87], v[196:199]
v_mfma_f32_16x16x32_bf16 v[200:203], v[104:107], v[84:87], v[200:203]
v_mfma_f32_16x16x32_bf16 v[204:207], v[108:111], v[84:87], v[204:207]
v_mfma_f32_16x16x32_bf16 v[208:211], v[112:115], v[84:87], v[208:211]
v_mfma_f32_16x16x32_bf16 v[212:215], v[116:119], v[84:87], v[212:215]
v_mfma_f32_16x16x32_bf16 v[216:219], v[120:123], v[84:87], v[216:219]
v_mfma_f32_16x16x32_bf16 v[248:251], v[120:123], v[88:91], v[248:251]
v_mfma_f32_16x16x32_bf16 v[244:247], v[116:119], v[88:91], v[244:247]
v_mfma_f32_16x16x32_bf16 v[240:243], v[112:115], v[88:91], v[240:243]
v_mfma_f32_16x16x32_bf16 v[236:239], v[108:111], v[88:91], v[236:239]
v_mfma_f32_16x16x32_bf16 v[232:235], v[104:107], v[88:91], v[232:235]
v_mfma_f32_16x16x32_bf16 v[228:231], v[100:103], v[88:91], v[228:231]
v_mfma_f32_16x16x32_bf16 v[224:227], v[96:99], v[88:91], v[224:227]
v_mfma_f32_16x16x32_bf16 v[220:223], v[92:95], v[88:91], v[220:223]
v_lshrrev_b32 v84, 4, v1
s_lshl_b32 s43, s63, 8
s_add_u32 s43, s43, 148480
v_lshl_add_u32 v85, v84, 4, s43
v_and_b32 v84, 15, v1
s_lshl_b32 s43, s62, 9
s_add_u32 s43, s43, 147456
v_lshl_add_u32 v84, v84, 3, s43
ds_read_b128 v[28:31], v85 offset:0
ds_read_b128 v[32:35], v85 offset:64
ds_read_b128 v[36:39], v85 offset:128
ds_read_b128 v[40:43], v85 offset:192
ds_read_b128 v[44:47], v85 offset:896
ds_read_b128 v[48:51], v85 offset:960
ds_read_b128 v[52:55], v85 offset:1024
ds_read_b128 v[56:59], v85 offset:1088
ds_read_b64 v[60:61], v84 offset:0
ds_read_b64 v[62:63], v84 offset:128
ds_read_b64 v[64:65], v84 offset:256
ds_read_b64 v[66:67], v84 offset:384
s_lshl_b32 s54, s35, 15
s_lshl_b32 s43, s63, 14
s_add_u32 s54, s54, s43
s_lshl_b32 s43, s62, 12
s_add_u32 s54, s54, s43
s_add_u32 s55, s54, 8192
v_lshrrev_b32 v122, 3, v1
v_and_b32 v123, 6, v122
v_and_b32 v25, 7, v1
v_xor_b32 v25, v25, v123
v_lshlrev_b32 v25, 4, v25
v_mul_u32_u24 v122, 2048, v122
v_add_u32 v25, v25, v122
s_lshl_b32 s43, s61, 7
s_lshl_b32 s44, s47, 15
s_add_u32 s43, s43, s44
v_add_u32 v25, s43, v25
s_waitcnt lgkmcnt(0)
s_barrier
s_add_u32 m0, s39, 81920
s_add_u32 s37, s52, 589824
buffer_load_dwordx4 v3, s[24:27], s37 offen sc1 lds
v_mul_f32 v70, v61, v61
v_mul_f32 v68, 0xc0135761, v61
v_mul_f32 v69, 0xbdd2d3e8, v61
v_mul_f32 v69, v69, v70
v_rcp_f32 v70, v70
v_mul_f32 v74, v63, v63
v_mul_f32 v72, 0xc0135761, v63
v_mul_f32 v73, 0xbdd2d3e8, v63
buffer_load_dwordx4 v3, s[24:27], s37 offen offset:1024 sc1 lds
v_mul_f32 v73, v73, v74
v_rcp_f32 v74, v74
v_fma_f32 v124, -v60, v28, v124
v_fma_f32 v125, -v60, v29, v125
v_fma_f32 v126, -v60, v30, v126
v_fma_f32 v127, -v60, v31, v127
v_fma_f32 v156, -v62, v28, v156
v_fma_f32 v157, -v62, v29, v157
buffer_load_dwordx4 v3, s[24:27], s37 offen offset:2048 sc1 lds
v_fma_f32 v158, -v62, v30, v158
v_fma_f32 v159, -v62, v31, v159
v_mul_f32 v76, v124, v124
v_mul_f32 v77, v125, v125
v_mul_f32 v78, v126, v126
v_mul_f32 v79, v127, v127
v_mul_f32 v80, v156, v156
v_mul_f32 v81, v157, v157
buffer_load_dwordx4 v3, s[24:27], s37 offen offset:3072 sc1 lds
v_mul_f32 v82, v158, v158
v_mul_f32 v83, v159, v159
v_fma_f32 v76, v76, v69, v68
v_fma_f32 v77, v77, v69, v68
v_fma_f32 v78, v78, v69, v68
v_fma_f32 v79, v79, v69, v68
v_fma_f32 v80, v80, v73, v72
v_fma_f32 v81, v81, v73, v72
v_fma_f32 v82, v82, v73, v72
s_add_u32 m0, s39, 147456
s_add_u32 s38, s53, 4718592
buffer_load_dwordx4 v23, s[28:31], s38 offen lds
v_fma_f32 v83, v83, v73, v72
v_mul_f32 v76, v76, v124
v_mul_f32 v77, v77, v125
v_mul_f32 v78, v78, v126
v_mul_f32 v79, v79, v127
v_mul_f32 v80, v80, v156
v_mul_f32 v81, v81, v157
v_mul_f32 v82, v82, v158
s_add_u32 m0, s39, 148480
s_add_u32 s38, s53, 4718592
buffer_load_dwordx4 v24, s[28:31], s38 offen lds
v_mul_f32 v83, v83, v159
v_exp_f32 v76, v76
v_exp_f32 v77, v77
v_exp_f32 v78, v78
v_exp_f32 v79, v79
v_exp_f32 v80, v80
v_exp_f32 v81, v81
v_exp_f32 v82, v82
s_add_u32 m0, s39, 149504
s_add_u32 s38, s53, 4734976
buffer_load_dwordx4 v23, s[28:31], s38 offen lds
v_exp_f32 v83, v83
v_fma_f32 v140, -v60, v44, v140
v_fma_f32 v141, -v60, v45, v141
v_fma_f32 v142, -v60, v46, v142
v_fma_f32 v143, -v60, v47, v143
v_fma_f32 v172, -v62, v44, v172
v_fma_f32 v173, -v62, v45, v173
v_fma_f32 v174, -v62, v46, v174
v_fma_f32 v175, -v62, v47, v175
s_add_u32 m0, s39, 150528
s_add_u32 s38, s53, 4734976
buffer_load_dwordx4 v24, s[28:31], s38 offen lds
v_fma_f32 v76, v76, v70, v70
v_fma_f32 v77, v77, v70, v70
v_fma_f32 v78, v78, v70, v70
v_fma_f32 v79, v79, v70, v70
v_fma_f32 v80, v80, v74, v74
v_fma_f32 v81, v81, v74, v74
v_fma_f32 v82, v82, v74, v74
v_fma_f32 v83, v83, v74, v74
s_add_u32 m0, s39, 98304
s_add_u32 s37, s52, 606208
buffer_load_dwordx4 v3, s[24:27], s37 offen sc1 lds
v_rcp_f32 v76, v76
v_rcp_f32 v77, v77
v_rcp_f32 v78, v78
v_rcp_f32 v79, v79
v_rcp_f32 v80, v80
v_rcp_f32 v81, v81
v_rcp_f32 v82, v82
v_rcp_f32 v83, v83
buffer_load_dwordx4 v3, s[24:27], s37 offen offset:1024 sc1 lds
v_mul_f32 v140, v124, v140
s_branch Lov_19
.p2align 12
Lst_19_0:
s_branch Lwr_128
Lst_19_1:
s_branch Lwr_131
Lov_19:
v_mul_f32 v141, v125, v141
v_mul_f32 v142, v126, v142
v_mul_f32 v143, v127, v143
v_mul_f32 v172, v156, v172
v_mul_f32 v173, v157, v173
v_mul_f32 v174, v158, v174
v_mul_f32 v175, v159, v175
buffer_load_dwordx4 v3, s[24:27], s37 offen offset:2048 sc1 lds
v_mul_f32 v140, v140, v76
v_mul_f32 v141, v141, v77
v_mul_f32 v142, v142, v78
v_mul_f32 v143, v143, v79
v_mul_f32 v172, v172, v80
v_mul_f32 v173, v173, v81
v_mul_f32 v174, v174, v82
v_mul_f32 v175, v175, v83
v_cvt_pk_bf16_f32 v124, v140, v141
buffer_load_dwordx4 v3, s[24:27], s37 offen offset:3072 sc1 lds
v_cvt_pk_bf16_f32 v125, v142, v143
v_cvt_pk_bf16_f32 v156, v172, v173
v_cvt_pk_bf16_f32 v157, v174, v175
v_fma_f32 v128, -v60, v32, v128
v_fma_f32 v129, -v60, v33, v129
v_fma_f32 v130, -v60, v34, v130
v_fma_f32 v131, -v60, v35, v131
v_fma_f32 v160, -v62, v32, v160
s_add_u32 m0, s39, 114688
s_add_u32 s38, s53, 4849664
buffer_load_dwordx4 v23, s[28:31], s38 offen lds
v_fma_f32 v161, -v62, v33, v161
v_fma_f32 v162, -v62, v34, v162
v_fma_f32 v163, -v62, v35, v163
v_mul_f32 v76, v128, v128
v_mul_f32 v77, v129, v129
v_mul_f32 v78, v130, v130
v_mul_f32 v79, v131, v131
v_mul_f32 v80, v160, v160
s_add_u32 m0, s39, 115712
s_add_u32 s38, s53, 4849664
buffer_load_dwordx4 v24, s[28:31], s38 offen lds
v_mul_f32 v81, v161, v161
v_mul_f32 v82, v162, v162
v_mul_f32 v83, v163, v163
v_fma_f32 v76, v76, v69, v68
v_fma_f32 v77, v77, v69, v68
v_fma_f32 v78, v78, v69, v68
v_fma_f32 v79, v79, v69, v68
v_fma_f32 v80, v80, v73, v72
v_fma_f32 v81, v81, v73, v72
s_add_u32 m0, s39, 116736
s_add_u32 s38, s53, 4866048
buffer_load_dwordx4 v23, s[28:31], s38 offen lds
s_add_u32 m0, s39, 117760
s_add_u32 s38, s53, 4866048
buffer_load_dwordx4 v24, s[28:31], s38 offen lds
s_barrier
s_add_u32 m0, s39, 131072
s_add_u32 s37, s52, 622592
buffer_load_dwordx4 v3, s[24:27], s37 offen sc1 lds
v_fma_f32 v82, v82, v73, v72
v_fma_f32 v83, v83, v73, v72
v_mul_f32 v76, v76, v128
v_mul_f32 v77, v77, v129
v_mul_f32 v78, v78, v130
v_mul_f32 v79, v79, v131
v_mul_f32 v80, v80, v160
v_mul_f32 v81, v81, v161
v_mul_f32 v82, v82, v162
v_mul_f32 v83, v83, v163
v_exp_f32 v76, v76
v_exp_f32 v77, v77
v_exp_f32 v78, v78
v_exp_f32 v79, v79
v_exp_f32 v80, v80
v_exp_f32 v81, v81
v_exp_f32 v82, v82
v_exp_f32 v83, v83
v_fma_f32 v144, -v60, v48, v144
buffer_load_dwordx4 v3, s[24:27], s37 offen offset:1024 sc1 lds
v_fma_f32 v145, -v60, v49, v145
v_fma_f32 v146, -v60, v50, v146
v_fma_f32 v147, -v60, v51, v147
v_fma_f32 v176, -v62, v48, v176
v_fma_f32 v177, -v62, v49, v177
v_fma_f32 v178, -v62, v50, v178
v_fma_f32 v179, -v62, v51, v179
v_fma_f32 v76, v76, v70, v70
v_fma_f32 v77, v77, v70, v70
v_fma_f32 v78, v78, v70, v70
v_fma_f32 v79, v79, v70, v70
v_fma_f32 v80, v80, v74, v74
v_fma_f32 v81, v81, v74, v74
v_fma_f32 v82, v82, v74, v74
v_fma_f32 v83, v83, v74, v74
v_rcp_f32 v76, v76
v_rcp_f32 v77, v77
v_rcp_f32 v78, v78
v_rcp_f32 v79, v79
v_rcp_f32 v80, v80
buffer_load_dwordx4 v3, s[24:27], s37 offen offset:2048 sc1 lds
v_rcp_f32 v81, v81
v_rcp_f32 v82, v82
v_rcp_f32 v83, v83
v_mul_f32 v144, v128, v144
v_mul_f32 v145, v129, v145
v_mul_f32 v146, v130, v146
v_mul_f32 v147, v131, v147
v_mul_f32 v176, v160, v176
v_mul_f32 v177, v161, v177
v_mul_f32 v178, v162, v178
v_mul_f32 v179, v163, v179
v_mul_f32 v144, v144, v76
v_mul_f32 v145, v145, v77
v_mul_f32 v146, v146, v78
v_mul_f32 v147, v147, v79
v_mul_f32 v176, v176, v80
v_mul_f32 v177, v177, v81
v_mul_f32 v178, v178, v82
v_mul_f32 v179, v179, v83
buffer_load_dwordx4 v3, s[24:27], s37 offen offset:3072 sc1 lds
v_cvt_pk_bf16_f32 v126, v144, v145
v_cvt_pk_bf16_f32 v127, v146, v147
v_cvt_pk_bf16_f32 v158, v176, v177
v_cvt_pk_bf16_f32 v159, v178, v179
buffer_store_dwordx4 v[124:127], v2, s[24:27], s54 offen offset:0 sc1
buffer_store_dwordx4 v[156:159], v2, s[24:27], s54 offen offset:1024 sc1
v_fma_f32 v132, -v60, v36, v132
v_fma_f32 v133, -v60, v37, v133
v_fma_f32 v134, -v60, v38, v134
v_fma_f32 v135, -v60, v39, v135
v_fma_f32 v164, -v62, v36, v164
v_fma_f32 v165, -v62, v37, v165
v_fma_f32 v166, -v62, v38, v166
v_fma_f32 v167, -v62, v39, v167
v_mul_f32 v76, v132, v132
v_mul_f32 v77, v133, v133
v_mul_f32 v78, v134, v134
v_mul_f32 v79, v135, v135
v_mul_f32 v80, v164, v164
v_mul_f32 v81, v165, v165
s_add_u32 m0, s39, 0
s_add_u32 s38, s53, 4980736
buffer_load_dwordx4 v23, s[28:31], s38 offen lds
v_mul_f32 v82, v166, v166
v_mul_f32 v83, v167, v167
v_fma_f32 v76, v76, v69, v68
v_fma_f32 v77, v77, v69, v68
v_fma_f32 v78, v78, v69, v68
v_fma_f32 v79, v79, v69, v68
v_fma_f32 v80, v80, v73, v72
v_fma_f32 v81, v81, v73, v72
v_fma_f32 v82, v82, v73, v72
v_fma_f32 v83, v83, v73, v72
v_mul_f32 v76, v76, v132
v_mul_f32 v77, v77, v133
v_mul_f32 v78, v78, v134
v_mul_f32 v79, v79, v135
v_mul_f32 v80, v80, v164
v_mul_f32 v81, v81, v165
v_mul_f32 v82, v82, v166
v_mul_f32 v83, v83, v167
v_exp_f32 v76, v76
s_add_u32 m0, s39, 1024
s_add_u32 s38, s53, 4980736
buffer_load_dwordx4 v24, s[28:31], s38 offen lds
v_exp_f32 v77, v77
v_exp_f32 v78, v78
v_exp_f32 v79, v79
v_exp_f32 v80, v80
v_exp_f32 v81, v81
v_exp_f32 v82, v82
v_exp_f32 v83, v83
v_fma_f32 v148, -v60, v52, v148
v_fma_f32 v149, -v60, v53, v149
v_fma_f32 v150, -v60, v54, v150
v_fma_f32 v151, -v60, v55, v151
v_fma_f32 v180, -v62, v52, v180
v_fma_f32 v181, -v62, v53, v181
v_fma_f32 v182, -v62, v54, v182
v_fma_f32 v183, -v62, v55, v183
v_fma_f32 v76, v76, v70, v70
v_fma_f32 v77, v77, v70, v70
v_fma_f32 v78, v78, v70, v70
v_fma_f32 v79, v79, v70, v70
v_fma_f32 v80, v80, v74, v74
s_add_u32 m0, s39, 2048
s_add_u32 s38, s53, 4997120
buffer_load_dwordx4 v23, s[28:31], s38 offen lds
s_add_u32 m0, s39, 3072
s_add_u32 s38, s53, 4997120
buffer_load_dwordx4 v24, s[28:31], s38 offen lds
s_barrier
s_add_u32 m0, s39, 16384
s_add_u32 s37, s52, 638976
buffer_load_dwordx4 v3, s[24:27], s37 offen sc1 lds
v_fma_f32 v81, v81, v74, v74
v_fma_f32 v82, v82, v74, v74
v_fma_f32 v83, v83, v74, v74
v_rcp_f32 v76, v76
v_rcp_f32 v77, v77
v_rcp_f32 v78, v78
v_rcp_f32 v79, v79
v_rcp_f32 v80, v80
v_rcp_f32 v81, v81
v_rcp_f32 v82, v82
v_rcp_f32 v83, v83
v_mul_f32 v148, v132, v148
v_mul_f32 v149, v133, v149
v_mul_f32 v150, v134, v150
v_mul_f32 v151, v135, v151
v_mul_f32 v180, v164, v180
v_mul_f32 v181, v165, v181
v_mul_f32 v182, v166, v182
v_mul_f32 v183, v167, v183
buffer_load_dwordx4 v3, s[24:27], s37 offen offset:1024 sc1 lds
v_mul_f32 v148, v148, v76
v_mul_f32 v149, v149, v77
v_mul_f32 v150, v150, v78
v_mul_f32 v151, v151, v79
v_mul_f32 v180, v180, v80
v_mul_f32 v181, v181, v81
v_mul_f32 v182, v182, v82
v_mul_f32 v183, v183, v83
v_cvt_pk_bf16_f32 v132, v148, v149
v_cvt_pk_bf16_f32 v133, v150, v151
v_cvt_pk_bf16_f32 v164, v180, v181
v_cvt_pk_bf16_f32 v165, v182, v183
v_fma_f32 v136, -v60, v40, v136
v_fma_f32 v137, -v60, v41, v137
v_fma_f32 v138, -v60, v42, v138
v_fma_f32 v139, -v60, v43, v139
v_fma_f32 v168, -v62, v40, v168
v_fma_f32 v169, -v62, v41, v169
v_fma_f32 v170, -v62, v42, v170
v_fma_f32 v171, -v62, v43, v171
buffer_load_dwordx4 v3, s[24:27], s37 offen offset:2048 sc1 lds
v_mul_f32 v76, v136, v136
v_mul_f32 v77, v137, v137
v_mul_f32 v78, v138, v138
v_mul_f32 v79, v139, v139
v_mul_f32 v80, v168, v168
v_mul_f32 v81, v169, v169
v_mul_f32 v82, v170, v170
v_mul_f32 v83, v171, v171
v_fma_f32 v76, v76, v69, v68
v_fma_f32 v77, v77, v69, v68
v_fma_f32 v78, v78, v69, v68
v_fma_f32 v79, v79, v69, v68
v_fma_f32 v80, v80, v73, v72
v_fma_f32 v81, v81, v73, v72
v_fma_f32 v82, v82, v73, v72
v_fma_f32 v83, v83, v73, v72
v_mul_f32 v76, v76, v136
v_mul_f32 v77, v77, v137
v_mul_f32 v78, v78, v138
buffer_load_dwordx4 v3, s[24:27], s37 offen offset:3072 sc1 lds
v_mul_f32 v79, v79, v139
v_mul_f32 v80, v80, v168
v_mul_f32 v81, v81, v169
v_mul_f32 v82, v82, v170
v_mul_f32 v83, v83, v171
v_exp_f32 v76, v76
v_exp_f32 v77, v77
v_exp_f32 v78, v78
v_exp_f32 v79, v79
v_exp_f32 v80, v80
v_exp_f32 v81, v81
v_exp_f32 v82, v82
v_exp_f32 v83, v83
v_fma_f32 v152, -v60, v56, v152
v_fma_f32 v153, -v60, v57, v153
v_fma_f32 v154, -v60, v58, v154
v_fma_f32 v155, -v60, v59, v155
v_fma_f32 v184, -v62, v56, v184
v_fma_f32 v185, -v62, v57, v185
v_fma_f32 v186, -v62, v58, v186
s_add_u32 m0, s39, 32768
s_add_u32 s38, s53, 5111808
buffer_load_dwordx4 v23, s[28:31], s38 offen lds
v_fma_f32 v187, -v62, v59, v187
v_fma_f32 v76, v76, v70, v70
v_fma_f32 v77, v77, v70, v70
v_fma_f32 v78, v78, v70, v70
v_fma_f32 v79, v79, v70, v70
v_fma_f32 v80, v80, v74, v74
v_fma_f32 v81, v81, v74, v74
v_fma_f32 v82, v82, v74, v74
v_fma_f32 v83, v83, v74, v74
v_rcp_f32 v76, v76
v_rcp_f32 v77, v77
v_rcp_f32 v78, v78
v_rcp_f32 v79, v79
v_rcp_f32 v80, v80
v_rcp_f32 v81, v81
v_rcp_f32 v82, v82
v_rcp_f32 v83, v83
v_mul_f32 v152, v136, v152
v_mul_f32 v153, v137, v153
s_add_u32 m0, s39, 33792
s_add_u32 s38, s53, 5111808
buffer_load_dwordx4 v24, s[28:31], s38 offen lds
v_mul_f32 v154, v138, v154
v_mul_f32 v155, v139, v155
v_mul_f32 v184, v168, v184
v_mul_f32 v185, v169, v185
v_mul_f32 v186, v170, v186
v_mul_f32 v187, v171, v187
v_mul_f32 v152, v152, v76
v_mul_f32 v153, v153, v77
v_mul_f32 v154, v154, v78
v_mul_f32 v155, v155, v79
v_mul_f32 v184, v184, v80
v_mul_f32 v185, v185, v81
v_mul_f32 v186, v186, v82
v_mul_f32 v187, v187, v83
v_cvt_pk_bf16_f32 v134, v152, v153
v_cvt_pk_bf16_f32 v135, v154, v155
v_cvt_pk_bf16_f32 v166, v184, v185
v_cvt_pk_bf16_f32 v167, v186, v187
buffer_store_dwordx4 v[132:135], v2, s[24:27], s55 offen offset:0 sc1
buffer_store_dwordx4 v[164:167], v2, s[24:27], s55 offen offset:1024 sc1
s_add_u32 m0, s39, 34816
s_add_u32 s38, s53, 5128192
buffer_load_dwordx4 v23, s[28:31], s38 offen lds
s_add_u32 m0, s39, 35840
s_add_u32 s38, s53, 5128192
buffer_load_dwordx4 v24, s[28:31], s38 offen lds
s_waitcnt vmcnt(28)
s_barrier
s_add_u32 m0, s39, 49152
s_add_u32 s37, s52, 655360
buffer_load_dwordx4 v3, s[24:27], s37 offen sc1 lds
v_mul_f32 v70, v65, v65
v_mul_f32 v68, 0xc0135761, v65
v_mul_f32 v69, 0xbdd2d3e8, v65
v_mul_f32 v69, v69, v70
v_rcp_f32 v70, v70
v_mul_f32 v74, v67, v67
v_mul_f32 v72, 0xc0135761, v67
v_mul_f32 v73, 0xbdd2d3e8, v67
v_mul_f32 v73, v73, v74
v_rcp_f32 v74, v74
v_fma_f32 v188, -v64, v28, v188
v_fma_f32 v189, -v64, v29, v189
v_fma_f32 v190, -v64, v30, v190
v_fma_f32 v191, -v64, v31, v191
v_fma_f32 v220, -v66, v28, v220
v_fma_f32 v221, -v66, v29, v221
v_fma_f32 v222, -v66, v30, v222
v_fma_f32 v223, -v66, v31, v223
v_mul_f32 v76, v188, v188
buffer_load_dwordx4 v3, s[24:27], s37 offen offset:1024 sc1 lds
v_mul_f32 v77, v189, v189
v_mul_f32 v78, v190, v190
v_mul_f32 v79, v191, v191
v_mul_f32 v80, v220, v220
v_mul_f32 v81, v221, v221
v_mul_f32 v82, v222, v222
v_mul_f32 v83, v223, v223
v_fma_f32 v76, v76, v69, v68
v_fma_f32 v77, v77, v69, v68
v_fma_f32 v78, v78, v69, v68
v_fma_f32 v79, v79, v69, v68
v_fma_f32 v80, v80, v73, v72
v_fma_f32 v81, v81, v73, v72
v_fma_f32 v82, v82, v73, v72
v_fma_f32 v83, v83, v73, v72
v_mul_f32 v76, v76, v188
v_mul_f32 v77, v77, v189
v_mul_f32 v78, v78, v190
v_mul_f32 v79, v79, v191
buffer_load_dwordx4 v3, s[24:27], s37 offen offset:2048 sc1 lds
v_mul_f32 v80, v80, v220
v_mul_f32 v81, v81, v221
v_mul_f32 v82, v82, v222
v_mul_f32 v83, v83, v223
v_exp_f32 v76, v76
v_exp_f32 v77, v77
v_exp_f32 v78, v78
v_exp_f32 v79, v79
v_exp_f32 v80, v80
v_exp_f32 v81, v81
v_exp_f32 v82, v82
v_exp_f32 v83, v83
v_fma_f32 v204, -v64, v44, v204
v_fma_f32 v205, -v64, v45, v205
v_fma_f32 v206, -v64, v46, v206
v_fma_f32 v207, -v64, v47, v207
v_fma_f32 v236, -v66, v44, v236
v_fma_f32 v237, -v66, v45, v237
v_fma_f32 v238, -v66, v46, v238
v_fma_f32 v239, -v66, v47, v239
buffer_load_dwordx4 v3, s[24:27], s37 offen offset:3072 sc1 lds
v_fma_f32 v76, v76, v70, v70
v_fma_f32 v77, v77, v70, v70
v_fma_f32 v78, v78, v70, v70
v_fma_f32 v79, v79, v70, v70
v_fma_f32 v80, v80, v74, v74
v_fma_f32 v81, v81, v74, v74
v_fma_f32 v82, v82, v74, v74
v_fma_f32 v83, v83, v74, v74
v_rcp_f32 v76, v76
v_rcp_f32 v77, v77
v_rcp_f32 v78, v78
v_rcp_f32 v79, v79
v_rcp_f32 v80, v80
v_rcp_f32 v81, v81
v_rcp_f32 v82, v82
v_rcp_f32 v83, v83
v_mul_f32 v204, v188, v204
v_mul_f32 v205, v189, v205
v_mul_f32 v206, v190, v206
s_add_u32 m0, s39, 65536
s_add_u32 s38, s53, 5242880
buffer_load_dwordx4 v23, s[28:31], s38 offen lds
v_mul_f32 v207, v191, v207
v_mul_f32 v236, v220, v236
v_mul_f32 v237, v221, v237
v_mul_f32 v238, v222, v238
v_mul_f32 v239, v223, v239
v_mul_f32 v204, v204, v76
v_mul_f32 v205, v205, v77
v_mul_f32 v206, v206, v78
v_mul_f32 v207, v207, v79
v_mul_f32 v236, v236, v80
v_mul_f32 v237, v237, v81
v_mul_f32 v238, v238, v82
v_mul_f32 v239, v239, v83
v_cvt_pk_bf16_f32 v188, v204, v205
v_cvt_pk_bf16_f32 v189, v206, v207
v_cvt_pk_bf16_f32 v220, v236, v237
v_cvt_pk_bf16_f32 v221, v238, v239
v_fma_f32 v192, -v64, v32, v192
v_fma_f32 v193, -v64, v33, v193
s_add_u32 m0, s39, 66560
s_add_u32 s38, s53, 5242880
buffer_load_dwordx4 v24, s[28:31], s38 offen lds
v_fma_f32 v194, -v64, v34, v194
v_fma_f32 v195, -v64, v35, v195
v_fma_f32 v224, -v66, v32, v224
v_fma_f32 v225, -v66, v33, v225
v_fma_f32 v226, -v66, v34, v226
v_fma_f32 v227, -v66, v35, v227
v_mul_f32 v76, v192, v192
v_mul_f32 v77, v193, v193
v_mul_f32 v78, v194, v194
v_mul_f32 v79, v195, v195
v_mul_f32 v80, v224, v224
v_mul_f32 v81, v225, v225
v_mul_f32 v82, v226, v226
v_mul_f32 v83, v227, v227
v_fma_f32 v76, v76, v69, v68
v_fma_f32 v77, v77, v69, v68
v_fma_f32 v78, v78, v69, v68
v_fma_f32 v79, v79, v69, v68
v_fma_f32 v80, v80, v73, v72
v_fma_f32 v81, v81, v73, v72
s_add_u32 m0, s39, 67584
s_add_u32 s38, s53, 5259264
buffer_load_dwordx4 v23, s[28:31], s38 offen lds
s_add_u32 m0, s39, 68608
s_add_u32 s38, s53, 5259264
buffer_load_dwordx4 v24, s[28:31], s38 offen lds
s_waitcnt vmcnt(28)
s_barrier
s_add_u32 m0, s39, 81920
s_add_u32 s37, s52, 671744
buffer_load_dwordx4 v3, s[24:27], s37 offen sc1 lds
v_fma_f32 v82, v82, v73, v72
v_fma_f32 v83, v83, v73, v72
v_mul_f32 v76, v76, v192
v_mul_f32 v77, v77, v193
v_mul_f32 v78, v78, v194
v_mul_f32 v79, v79, v195
v_mul_f32 v80, v80, v224
v_mul_f32 v81, v81, v225
v_mul_f32 v82, v82, v226
v_mul_f32 v83, v83, v227
v_exp_f32 v76, v76
v_exp_f32 v77, v77
v_exp_f32 v78, v78
v_exp_f32 v79, v79
v_exp_f32 v80, v80
v_exp_f32 v81, v81
v_exp_f32 v82, v82
v_exp_f32 v83, v83
v_fma_f32 v208, -v64, v48, v208
buffer_load_dwordx4 v3, s[24:27], s37 offen offset:1024 sc1 lds
v_fma_f32 v209, -v64, v49, v209
v_fma_f32 v210, -v64, v50, v210
v_fma_f32 v211, -v64, v51, v211
v_fma_f32 v240, -v66, v48, v240
v_fma_f32 v241, -v66, v49, v241
v_fma_f32 v242, -v66, v50, v242
v_fma_f32 v243, -v66, v51, v243
v_fma_f32 v76, v76, v70, v70
v_fma_f32 v77, v77, v70, v70
v_fma_f32 v78, v78, v70, v70
v_fma_f32 v79, v79, v70, v70
v_fma_f32 v80, v80, v74, v74
v_fma_f32 v81, v81, v74, v74
v_fma_f32 v82, v82, v74, v74
v_fma_f32 v83, v83, v74, v74
v_rcp_f32 v76, v76
v_rcp_f32 v77, v77
v_rcp_f32 v78, v78
v_rcp_f32 v79, v79
v_rcp_f32 v80, v80
buffer_load_dwordx4 v3, s[24:27], s37 offen offset:2048 sc1 lds
v_rcp_f32 v81, v81
v_rcp_f32 v82, v82
v_rcp_f32 v83, v83
v_mul_f32 v208, v192, v208
v_mul_f32 v209, v193, v209
v_mul_f32 v210, v194, v210
v_mul_f32 v211, v195, v211
v_mul_f32 v240, v224, v240
v_mul_f32 v241, v225, v241
v_mul_f32 v242, v226, v242
v_mul_f32 v243, v227, v243
v_mul_f32 v208, v208, v76
v_mul_f32 v209, v209, v77
v_mul_f32 v210, v210, v78
v_mul_f32 v211, v211, v79
v_mul_f32 v240, v240, v80
v_mul_f32 v241, v241, v81
v_mul_f32 v242, v242, v82
v_mul_f32 v243, v243, v83
buffer_load_dwordx4 v3, s[24:27], s37 offen offset:3072 sc1 lds
v_cvt_pk_bf16_f32 v190, v208, v209
v_cvt_pk_bf16_f32 v191, v210, v211
v_cvt_pk_bf16_f32 v222, v240, v241
v_cvt_pk_bf16_f32 v223, v242, v243
buffer_store_dwordx4 v[188:191], v2, s[24:27], s54 offen offset:2048 sc1
buffer_store_dwordx4 v[220:223], v2, s[24:27], s54 offen offset:3072 sc1
v_fma_f32 v196, -v64, v36, v196
v_fma_f32 v197, -v64, v37, v197
v_fma_f32 v198, -v64, v38, v198
v_fma_f32 v199, -v64, v39, v199
v_fma_f32 v228, -v66, v36, v228
v_fma_f32 v229, -v66, v37, v229
v_fma_f32 v230, -v66, v38, v230
v_fma_f32 v231, -v66, v39, v231
v_mul_f32 v76, v196, v196
v_mul_f32 v77, v197, v197
v_mul_f32 v78, v198, v198
v_mul_f32 v79, v199, v199
v_mul_f32 v80, v228, v228
v_mul_f32 v81, v229, v229
s_add_u32 m0, s39, 147456
s_add_u32 s38, s53, 5373952
buffer_load_dwordx4 v23, s[28:31], s38 offen lds
v_mul_f32 v82, v230, v230
v_mul_f32 v83, v231, v231
v_fma_f32 v76, v76, v69, v68
v_fma_f32 v77, v77, v69, v68
v_fma_f32 v78, v78, v69, v68
v_fma_f32 v79, v79, v69, v68
v_fma_f32 v80, v80, v73, v72
v_fma_f32 v81, v81, v73, v72
v_fma_f32 v82, v82, v73, v72
v_fma_f32 v83, v83, v73, v72
v_mul_f32 v76, v76, v196
v_mul_f32 v77, v77, v197
v_mul_f32 v78, v78, v198
v_mul_f32 v79, v79, v199
v_mul_f32 v80, v80, v228
v_mul_f32 v81, v81, v229
v_mul_f32 v82, v82, v230
v_mul_f32 v83, v83, v231
v_exp_f32 v76, v76
s_add_u32 m0, s39, 148480
s_add_u32 s38, s53, 5373952
buffer_load_dwordx4 v24, s[28:31], s38 offen lds
v_exp_f32 v77, v77
v_exp_f32 v78, v78
v_exp_f32 v79, v79
v_exp_f32 v80, v80
v_exp_f32 v81, v81
v_exp_f32 v82, v82
v_exp_f32 v83, v83
v_fma_f32 v212, -v64, v52, v212
v_fma_f32 v213, -v64, v53, v213
v_fma_f32 v214, -v64, v54, v214
v_fma_f32 v215, -v64, v55, v215
v_fma_f32 v244, -v66, v52, v244
v_fma_f32 v245, -v66, v53, v245
v_fma_f32 v246, -v66, v54, v246
v_fma_f32 v247, -v66, v55, v247
v_fma_f32 v76, v76, v70, v70
v_fma_f32 v77, v77, v70, v70
v_fma_f32 v78, v78, v70, v70
v_fma_f32 v79, v79, v70, v70
v_fma_f32 v80, v80, v74, v74
s_add_u32 m0, s39, 149504
s_add_u32 s38, s53, 5390336
buffer_load_dwordx4 v23, s[28:31], s38 offen lds
s_add_u32 m0, s39, 150528
s_add_u32 s38, s53, 5390336
buffer_load_dwordx4 v24, s[28:31], s38 offen lds
s_waitcnt vmcnt(28)
s_barrier
s_add_u32 m0, s39, 98304
s_add_u32 s37, s52, 688128
buffer_load_dwordx4 v3, s[24:27], s37 offen sc1 lds
v_fma_f32 v81, v81, v74, v74
v_fma_f32 v82, v82, v74, v74
v_fma_f32 v83, v83, v74, v74
v_rcp_f32 v76, v76
v_rcp_f32 v77, v77
v_rcp_f32 v78, v78
v_rcp_f32 v79, v79
v_rcp_f32 v80, v80
v_rcp_f32 v81, v81
v_rcp_f32 v82, v82
v_rcp_f32 v83, v83
v_mul_f32 v212, v196, v212
v_mul_f32 v213, v197, v213
v_mul_f32 v214, v198, v214
v_mul_f32 v215, v199, v215
v_mul_f32 v244, v228, v244
v_mul_f32 v245, v229, v245
v_mul_f32 v246, v230, v246
v_mul_f32 v247, v231, v247
buffer_load_dwordx4 v3, s[24:27], s37 offen offset:1024 sc1 lds
v_mul_f32 v212, v212, v76
v_mul_f32 v213, v213, v77
v_mul_f32 v214, v214, v78
v_mul_f32 v215, v215, v79
v_mul_f32 v244, v244, v80
v_mul_f32 v245, v245, v81
v_mul_f32 v246, v246, v82
v_mul_f32 v247, v247, v83
v_cvt_pk_bf16_f32 v196, v212, v213
v_cvt_pk_bf16_f32 v197, v214, v215
v_cvt_pk_bf16_f32 v228, v244, v245
v_cvt_pk_bf16_f32 v229, v246, v247
v_fma_f32 v200, -v64, v40, v200
v_fma_f32 v201, -v64, v41, v201
v_fma_f32 v202, -v64, v42, v202
v_fma_f32 v203, -v64, v43, v203
v_fma_f32 v232, -v66, v40, v232
v_fma_f32 v233, -v66, v41, v233
v_fma_f32 v234, -v66, v42, v234
v_fma_f32 v235, -v66, v43, v235
buffer_load_dwordx4 v3, s[24:27], s37 offen offset:2048 sc1 lds
v_mul_f32 v76, v200, v200
v_mul_f32 v77, v201, v201
v_mul_f32 v78, v202, v202
v_mul_f32 v79, v203, v203
v_mul_f32 v80, v232, v232
v_mul_f32 v81, v233, v233
v_mul_f32 v82, v234, v234
v_mul_f32 v83, v235, v235
v_fma_f32 v76, v76, v69, v68
v_fma_f32 v77, v77, v69, v68
v_fma_f32 v78, v78, v69, v68
v_fma_f32 v79, v79, v69, v68
v_fma_f32 v80, v80, v73, v72
v_fma_f32 v81, v81, v73, v72
v_fma_f32 v82, v82, v73, v72
v_fma_f32 v83, v83, v73, v72
v_mul_f32 v76, v76, v200
v_mul_f32 v77, v77, v201
v_mul_f32 v78, v78, v202
buffer_load_dwordx4 v3, s[24:27], s37 offen offset:3072 sc1 lds
v_mul_f32 v79, v79, v203
v_mul_f32 v80, v80, v232
v_mul_f32 v81, v81, v233
v_mul_f32 v82, v82, v234
v_mul_f32 v83, v83, v235
v_exp_f32 v76, v76
v_exp_f32 v77, v77
v_exp_f32 v78, v78
v_exp_f32 v79, v79
v_exp_f32 v80, v80
v_exp_f32 v81, v81
v_exp_f32 v82, v82
v_exp_f32 v83, v83
v_fma_f32 v216, -v64, v56, v216
v_fma_f32 v217, -v64, v57, v217
s_branch Lov_20
.p2align 12
Lst_20_0:
s_branch Lwr_125
Lst_20_1:
s_branch Lwr_132
Lov_20:
v_fma_f32 v218, -v64, v58, v218
v_fma_f32 v219, -v64, v59, v219
v_fma_f32 v248, -v66, v56, v248
v_fma_f32 v249, -v66, v57, v249
v_fma_f32 v250, -v66, v58, v250
s_add_u32 m0, s39, 114688
s_add_u32 s38, s53, 5505024
buffer_load_dwordx4 v23, s[28:31], s38 offen lds
v_fma_f32 v251, -v66, v59, v251
v_fma_f32 v76, v76, v70, v70
v_fma_f32 v77, v77, v70, v70
v_fma_f32 v78, v78, v70, v70
v_fma_f32 v79, v79, v70, v70
v_fma_f32 v80, v80, v74, v74
v_fma_f32 v81, v81, v74, v74
v_fma_f32 v82, v82, v74, v74
v_fma_f32 v83, v83, v74, v74
v_rcp_f32 v76, v76
v_rcp_f32 v77, v77
v_rcp_f32 v78, v78
v_rcp_f32 v79, v79
v_rcp_f32 v80, v80
v_rcp_f32 v81, v81
v_rcp_f32 v82, v82
v_rcp_f32 v83, v83
v_mul_f32 v216, v200, v216
v_mul_f32 v217, v201, v217
s_add_u32 m0, s39, 115712
s_add_u32 s38, s53, 5505024
buffer_load_dwordx4 v24, s[28:31], s38 offen lds
v_mul_f32 v218, v202, v218
v_mul_f32 v219, v203, v219
v_mul_f32 v248, v232, v248
v_mul_f32 v249, v233, v249
v_mul_f32 v250, v234, v250
v_mul_f32 v251, v235, v251
v_mul_f32 v216, v216, v76
v_mul_f32 v217, v217, v77
v_mul_f32 v218, v218, v78
v_mul_f32 v219, v219, v79
v_mul_f32 v248, v248, v80
v_mul_f32 v249, v249, v81
v_mul_f32 v250, v250, v82
v_mul_f32 v251, v251, v83
v_cvt_pk_bf16_f32 v198, v216, v217
v_cvt_pk_bf16_f32 v199, v218, v219
v_cvt_pk_bf16_f32 v230, v248, v249
v_cvt_pk_bf16_f32 v231, v250, v251
buffer_store_dwordx4 v[196:199], v2, s[24:27], s55 offen offset:2048 sc1
buffer_store_dwordx4 v[228:231], v2, s[24:27], s55 offen offset:3072 sc1
s_add_u32 m0, s39, 116736
s_add_u32 s38, s53, 5521408
buffer_load_dwordx4 v23, s[28:31], s38 offen lds
s_add_u32 m0, s39, 117760
s_add_u32 s38, s53, 5521408
buffer_load_dwordx4 v24, s[28:31], s38 offen lds
s_waitcnt vmcnt(28)
s_barrier
s_add_u32 m0, s39, 131072
s_add_u32 s37, s52, 704512
buffer_load_dwordx4 v3, s[24:27], s37 offen sc1 lds
buffer_load_dwordx4 v3, s[24:27], s37 offen offset:1024 sc1 lds
buffer_load_dwordx4 v3, s[24:27], s37 offen offset:2048 sc1 lds
buffer_load_dwordx4 v3, s[24:27], s37 offen offset:3072 sc1 lds
s_add_u32 m0, s39, 0
s_add_u32 s38, s53, 5636096
buffer_load_dwordx4 v23, s[28:31], s38 offen lds
s_add_u32 m0, s39, 1024
s_add_u32 s38, s53, 5636096
buffer_load_dwordx4 v24, s[28:31], s38 offen lds
s_add_u32 m0, s39, 2048
s_add_u32 s38, s53, 5652480
buffer_load_dwordx4 v23, s[28:31], s38 offen lds
s_add_u32 m0, s39, 3072
s_add_u32 s38, s53, 5652480
buffer_load_dwordx4 v24, s[28:31], s38 offen lds
s_waitcnt vmcnt(10)
s_barrier
s_cmp_eq_u32 s47, 0
s_cbranch_scc0 Lw_113
s_add_u32 s7, s34, 48
s_lshl_b32 s7, s7, 7
v_mov_b32 v26, s7
v_mov_b32 v27, 1
s_mov_b64 exec, 1
buffer_atomic_add v27, v26, s[56:59], 0 offen sc1
s_mov_b64 exec, -1
Lw_113:
s_add_u32 m0, s39, 32768
s_add_u32 s38, s91, 0
buffer_load_dwordx4 v23, s[28:31], s38 offen lds
s_add_u32 m0, s39, 33792
s_add_u32 s38, s91, 0
buffer_load_dwordx4 v24, s[28:31], s38 offen lds
s_add_u32 m0, s39, 34816
s_add_u32 s38, s91, 16384
buffer_load_dwordx4 v23, s[28:31], s38 offen lds
s_add_u32 m0, s39, 35840
s_add_u32 s38, s91, 16384
buffer_load_dwordx4 v24, s[28:31], s38 offen lds
s_waitcnt vmcnt(22)
s_barrier
s_add_u32 m0, s39, 65536
s_add_u32 s38, s91, 131072
buffer_load_dwordx4 v23, s[28:31], s38 offen lds
s_add_u32 m0, s39, 66560
s_add_u32 s38, s91, 131072
buffer_load_dwordx4 v24, s[28:31], s38 offen lds
s_add_u32 m0, s39, 67584
s_add_u32 s38, s91, 147456
buffer_load_dwordx4 v23, s[28:31], s38 offen lds
s_add_u32 m0, s39, 68608
s_add_u32 s38, s91, 147456
buffer_load_dwordx4 v24, s[28:31], s38 offen lds
s_waitcnt vmcnt(16)
s_barrier
s_cmp_eq_u32 s47, 3
s_cbranch_scc0 Lw_114
s_lshl_b32 s92, s34, 7
s_add_u32 s92, s92, 28317696
s_load_dword s93, s[82:83], s92 glc
Lw_114:
s_add_u32 m0, s39, 147456
s_add_u32 s38, s91, 262144
buffer_load_dwordx4 v23, s[28:31], s38 offen lds
s_add_u32 m0, s39, 148480
s_add_u32 s38, s91, 262144
buffer_load_dwordx4 v24, s[28:31], s38 offen lds
s_add_u32 m0, s39, 149504
s_add_u32 s38, s91, 278528
buffer_load_dwordx4 v23, s[28:31], s38 offen lds
s_add_u32 m0, s39, 150528
s_add_u32 s38, s91, 278528
buffer_load_dwordx4 v24, s[28:31], s38 offen lds
s_waitcnt vmcnt(12)
s_cmp_eq_u32 s47, 3
s_cbranch_scc0 Lw_115
s_mov_b32 s41, 0x40000
s_branch Lpchk_118
Lpoll_116:
s_load_dword s93, s[82:83], s92 glc
Lpchk_118:
s_waitcnt lgkmcnt(0)
s_cmp_eq_u32 s93, 16
s_cbranch_scc1 Lpok_117
s_sub_u32 s41, s41, 1
s_cmp_lg_u32 s41, 0
s_cbranch_scc1 Lpoll_116
Lpok_117:
Lw_115:
s_barrier
s_add_u32 m0, s39, 16384
s_add_u32 s37, s90, 0
buffer_load_dwordx4 v3, s[24:27], s37 offen sc1 lds
buffer_load_dwordx4 v3, s[24:27], s37 offen offset:1024 sc1 lds
buffer_load_dwordx4 v3, s[24:27], s37 offen offset:2048 sc1 lds
buffer_load_dwordx4 v3, s[24:27], s37 offen offset:3072 sc1 lds
s_add_u32 m0, s39, 49152
s_add_u32 s37, s90, 16384
buffer_load_dwordx4 v3, s[24:27], s37 offen sc1 lds
buffer_load_dwordx4 v3, s[24:27], s37 offen offset:1024 sc1 lds
buffer_load_dwordx4 v3, s[24:27], s37 offen offset:2048 sc1 lds
buffer_load_dwordx4 v3, s[24:27], s37 offen offset:3072 sc1 lds
s_add_u32 m0, s39, 81920
s_add_u32 s37, s90, 32768
buffer_load_dwordx4 v3, s[24:27], s37 offen sc1 lds
buffer_load_dwordx4 v3, s[24:27], s37 offen offset:1024 sc1 lds
buffer_load_dwordx4 v3, s[24:27], s37 offen offset:2048 sc1 lds
buffer_load_dwordx4 v3, s[24:27], s37 offen offset:3072 sc1 lds
s_add_u32 m0, s39, 98304
s_add_u32 s37, s90, 49152
buffer_load_dwordx4 v3, s[24:27], s37 offen sc1 lds
buffer_load_dwordx4 v3, s[24:27], s37 offen offset:1024 sc1 lds
buffer_load_dwordx4 v3, s[24:27], s37 offen offset:2048 sc1 lds
buffer_load_dwordx4 v3, s[24:27], s37 offen offset:3072 sc1 lds
s_add_u32 m0, s39, 114688
s_add_u32 s38, s91, 393216
buffer_load_dwordx4 v23, s[28:31], s38 offen lds
s_add_u32 m0, s39, 115712
s_add_u32 s38, s91, 393216
buffer_load_dwordx4 v24, s[28:31], s38 offen lds
s_add_u32 m0, s39, 116736
s_add_u32 s38, s91, 409600
buffer_load_dwordx4 v23, s[28:31], s38 offen lds
s_add_u32 m0, s39, 117760
s_add_u32 s38, s91, 409600
buffer_load_dwordx4 v24, s[28:31], s38 offen lds
s_waitcnt vmcnt(16)
s_barrier
s_add_u32 m0, s39, 131072
s_add_u32 s37, s90, 65536
buffer_load_dwordx4 v3, s[24:27], s37 offen sc1 lds
buffer_load_dwordx4 v3, s[24:27], s37 offen offset:1024 sc1 lds
buffer_load_dwordx4 v3, s[24:27], s37 offen offset:2048 sc1 lds
buffer_load_dwordx4 v3, s[24:27], s37 offen offset:3072 sc1 lds
s_add_u32 m0, s39, 0
s_add_u32 s38, s91, 524288
buffer_load_dwordx4 v23, s[28:31], s38 offen lds
s_add_u32 m0, s39, 1024
s_add_u32 s38, s91, 524288
buffer_load_dwordx4 v24, s[28:31], s38 offen lds
s_add_u32 m0, s39, 2048
s_add_u32 s38, s91, 540672
buffer_load_dwordx4 v23, s[28:31], s38 offen lds
s_add_u32 m0, s39, 3072
s_add_u32 s38, s91, 540672
buffer_load_dwordx4 v24, s[28:31], s38 offen lds
s_waitcnt vmcnt(20)
s_barrier
s_add_u32 m0, s39, 16384
s_add_u32 s37, s90, 81920
buffer_load_dwordx4 v3, s[24:27], s37 offen sc1 lds
buffer_load_dwordx4 v3, s[24:27], s37 offen offset:1024 sc1 lds
buffer_load_dwordx4 v3, s[24:27], s37 offen offset:2048 sc1 lds
buffer_load_dwordx4 v3, s[24:27], s37 offen offset:3072 sc1 lds
s_add_u32 m0, s39, 32768
s_add_u32 s38, s91, 655360
buffer_load_dwordx4 v23, s[28:31], s38 offen lds
s_add_u32 m0, s39, 33792
s_add_u32 s38, s91, 655360
buffer_load_dwordx4 v24, s[28:31], s38 offen lds
s_add_u32 m0, s39, 34816
s_add_u32 s38, s91, 671744
buffer_load_dwordx4 v23, s[28:31], s38 offen lds
s_add_u32 m0, s39, 35840
s_add_u32 s38, s91, 671744
buffer_load_dwordx4 v24, s[28:31], s38 offen lds
s_waitcnt vmcnt(24)
s_barrier
s_add_u32 m0, s39, 49152
s_add_u32 s37, s90, 98304
buffer_load_dwordx4 v3, s[24:27], s37 offen sc1 lds
buffer_load_dwordx4 v3, s[24:27], s37 offen offset:1024 sc1 lds
buffer_load_dwordx4 v3, s[24:27], s37 offen offset:2048 sc1 lds
buffer_load_dwordx4 v3, s[24:27], s37 offen offset:3072 sc1 lds
s_add_u32 m0, s39, 65536
s_add_u32 s38, s91, 786432
buffer_load_dwordx4 v23, s[28:31], s38 offen lds
s_add_u32 m0, s39, 66560
s_add_u32 s38, s91, 786432
buffer_load_dwordx4 v24, s[28:31], s38 offen lds
s_add_u32 m0, s39, 67584
s_add_u32 s38, s91, 802816
buffer_load_dwordx4 v23, s[28:31], s38 offen lds
s_add_u32 m0, s39, 68608
s_add_u32 s38, s91, 802816
buffer_load_dwordx4 v24, s[28:31], s38 offen lds
s_waitcnt vmcnt(24)
s_barrier
s_add_u32 m0, s39, 81920
s_add_u32 s37, s90, 114688
buffer_load_dwordx4 v3, s[24:27], s37 offen sc1 lds
buffer_load_dwordx4 v3, s[24:27], s37 offen offset:1024 sc1 lds
buffer_load_dwordx4 v3, s[24:27], s37 offen offset:2048 sc1 lds
buffer_load_dwordx4 v3, s[24:27], s37 offen offset:3072 sc1 lds
s_add_u32 m0, s39, 147456
s_add_u32 s38, s91, 917504
buffer_load_dwordx4 v23, s[28:31], s38 offen lds
s_add_u32 m0, s39, 148480
s_add_u32 s38, s91, 917504
buffer_load_dwordx4 v24, s[28:31], s38 offen lds
s_add_u32 m0, s39, 149504
s_add_u32 s38, s91, 933888
buffer_load_dwordx4 v23, s[28:31], s38 offen lds
s_add_u32 m0, s39, 150528
s_add_u32 s38, s91, 933888
buffer_load_dwordx4 v24, s[28:31], s38 offen lds
s_waitcnt vmcnt(24)
s_barrier
s_add_u32 m0, s39, 98304
s_add_u32 s37, s90, 131072
buffer_load_dwordx4 v3, s[24:27], s37 offen sc1 lds
buffer_load_dwordx4 v3, s[24:27], s37 offen offset:1024 sc1 lds
buffer_load_dwordx4 v3, s[24:27], s37 offen offset:2048 sc1 lds
buffer_load_dwordx4 v3, s[24:27], s37 offen offset:3072 sc1 lds
s_add_u32 m0, s39, 114688
s_add_u32 s38, s91, 1048576
buffer_load_dwordx4 v23, s[28:31], s38 offen lds
s_add_u32 m0, s39, 115712
s_add_u32 s38, s91, 1048576
buffer_load_dwordx4 v24, s[28:31], s38 offen lds
s_add_u32 m0, s39, 116736
s_add_u32 s38, s91, 1064960
buffer_load_dwordx4 v23, s[28:31], s38 offen lds
s_add_u32 m0, s39, 117760
s_add_u32 s38, s91, 1064960
buffer_load_dwordx4 v24, s[28:31], s38 offen lds
s_waitcnt vmcnt(24)
s_barrier
s_add_u32 m0, s39, 131072
s_add_u32 s37, s90, 147456
buffer_load_dwordx4 v3, s[24:27], s37 offen sc1 lds
buffer_load_dwordx4 v3, s[24:27], s37 offen offset:1024 sc1 lds
buffer_load_dwordx4 v3, s[24:27], s37 offen offset:2048 sc1 lds
buffer_load_dwordx4 v3, s[24:27], s37 offen offset:3072 sc1 lds
s_add_u32 m0, s39, 0
s_add_u32 s38, s91, 1179648
buffer_load_dwordx4 v23, s[28:31], s38 offen lds
s_add_u32 m0, s39, 1024
s_add_u32 s38, s91, 1179648
buffer_load_dwordx4 v24, s[28:31], s38 offen lds
s_add_u32 m0, s39, 2048
s_add_u32 s38, s91, 1196032
buffer_load_dwordx4 v23, s[28:31], s38 offen lds
s_add_u32 m0, s39, 3072
s_add_u32 s38, s91, 1196032
buffer_load_dwordx4 v24, s[28:31], s38 offen lds
s_waitcnt vmcnt(24)
s_barrier
s_add_u32 m0, s39, 16384
s_mov_b32 s37, 327680
buffer_load_dwordx4 v3, s[24:27], s37 offen sc1 lds
buffer_load_dwordx4 v3, s[24:27], s37 offen offset:1024 sc1 lds
buffer_load_dwordx4 v3, s[24:27], s37 offen offset:2048 sc1 lds
buffer_load_dwordx4 v3, s[24:27], s37 offen offset:3072 sc1 lds
s_add_u32 m0, s51, 32768
s_mov_b32 s38, 2621440
buffer_load_dwordx4 v25, s[28:31], s38 offen lds
s_add_u32 m0, s51, 33792
s_mov_b32 s38, 2637824
buffer_load_dwordx4 v25, s[28:31], s38 offen lds
s_waitcnt vmcnt(22)
s_barrier
s_add_u32 m0, s39, 49152
s_mov_b32 s37, 344064
buffer_load_dwordx4 v3, s[24:27], s37 offen sc1 lds
buffer_load_dwordx4 v3, s[24:27], s37 offen offset:1024 sc1 lds
buffer_load_dwordx4 v3, s[24:27], s37 offen offset:2048 sc1 lds
buffer_load_dwordx4 v3, s[24:27], s37 offen offset:3072 sc1 lds
s_add_u32 m0, s51, 65536
s_mov_b32 s38, 2752512
buffer_load_dwordx4 v25, s[28:31], s38 offen lds
s_add_u32 m0, s51, 66560
s_mov_b32 s38, 2768896
buffer_load_dwordx4 v25, s[28:31], s38 offen lds
s_waitcnt vmcnt(20)
s_barrier
s_add_u32 m0, s39, 81920
s_mov_b32 s37, 360448
buffer_load_dwordx4 v3, s[24:27], s37 offen sc1 lds
buffer_load_dwordx4 v3, s[24:27], s37 offen offset:1024 sc1 lds
buffer_load_dwordx4 v3, s[24:27], s37 offen offset:2048 sc1 lds
buffer_load_dwordx4 v3, s[24:27], s37 offen offset:3072 sc1 lds
s_add_u32 m0, s51, 147456
s_mov_b32 s38, 2883584
buffer_load_dwordx4 v25, s[28:31], s38 offen lds
s_add_u32 m0, s51, 148480
s_mov_b32 s38, 2899968
buffer_load_dwordx4 v25, s[28:31], s38 offen lds
s_waitcnt vmcnt(18)
s_barrier
s_add_u32 m0, s39, 98304
s_mov_b32 s37, 376832
buffer_load_dwordx4 v3, s[24:27], s37 offen sc1 lds
buffer_load_dwordx4 v3, s[24:27], s37 offen offset:1024 sc1 lds
buffer_load_dwordx4 v3, s[24:27], s37 offen offset:2048 sc1 lds
buffer_load_dwordx4 v3, s[24:27], s37 offen offset:3072 sc1 lds
s_add_u32 m0, s51, 114688
s_mov_b32 s38, 3014656
buffer_load_dwordx4 v25, s[28:31], s38 offen lds
s_add_u32 m0, s51, 115712
s_mov_b32 s38, 3031040
buffer_load_dwordx4 v25, s[28:31], s38 offen lds
s_waitcnt vmcnt(18)
s_barrier
s_add_u32 m0, s39, 131072
s_mov_b32 s37, 393216
buffer_load_dwordx4 v3, s[24:27], s37 offen sc1 lds
buffer_load_dwordx4 v3, s[24:27], s37 offen offset:1024 sc1 lds
buffer_load_dwordx4 v3, s[24:27], s37 offen offset:2048 sc1 lds
buffer_load_dwordx4 v3, s[24:27], s37 offen offset:3072 sc1 lds
s_add_u32 m0, s51, 0
s_mov_b32 s38, 3145728
buffer_load_dwordx4 v25, s[28:31], s38 offen lds
s_add_u32 m0, s51, 1024
s_mov_b32 s38, 3162112
buffer_load_dwordx4 v25, s[28:31], s38 offen lds
s_waitcnt vmcnt(18)
s_barrier
s_add_u32 m0, s39, 16384
s_mov_b32 s37, 409600
buffer_load_dwordx4 v3, s[24:27], s37 offen sc1 lds
buffer_load_dwordx4 v3, s[24:27], s37 offen offset:1024 sc1 lds
buffer_load_dwordx4 v3, s[24:27], s37 offen offset:2048 sc1 lds
buffer_load_dwordx4 v3, s[24:27], s37 offen offset:3072 sc1 lds
s_add_u32 m0, s51, 32768
s_mov_b32 s38, 3276800
buffer_load_dwordx4 v25, s[28:31], s38 offen lds
s_add_u32 m0, s51, 33792
s_mov_b32 s38, 3293184
buffer_load_dwordx4 v25, s[28:31], s38 offen lds
s_waitcnt vmcnt(18)
s_barrier
s_add_u32 m0, s39, 49152
s_mov_b32 s37, 425984
buffer_load_dwordx4 v3, s[24:27], s37 offen sc1 lds
buffer_load_dwordx4 v3, s[24:27], s37 offen offset:1024 sc1 lds
buffer_load_dwordx4 v3, s[24:27], s37 offen offset:2048 sc1 lds
buffer_load_dwordx4 v3, s[24:27], s37 offen offset:3072 sc1 lds
s_add_u32 m0, s51, 65536
s_mov_b32 s38, 3407872
buffer_load_dwordx4 v25, s[28:31], s38 offen lds
s_add_u32 m0, s51, 66560
s_mov_b32 s38, 3424256
buffer_load_dwordx4 v25, s[28:31], s38 offen lds
s_waitcnt vmcnt(18)
s_barrier
s_add_u32 m0, s39, 81920
s_mov_b32 s37, 442368
buffer_load_dwordx4 v3, s[24:27], s37 offen sc1 lds
buffer_load_dwordx4 v3, s[24:27], s37 offen offset:1024 sc1 lds
buffer_load_dwordx4 v3, s[24:27], s37 offen offset:2048 sc1 lds
buffer_load_dwordx4 v3, s[24:27], s37 offen offset:3072 sc1 lds
s_add_u32 m0, s51, 147456
s_mov_b32 s38, 3538944
buffer_load_dwordx4 v25, s[28:31], s38 offen lds
s_add_u32 m0, s51, 148480
s_mov_b32 s38, 3555328
buffer_load_dwordx4 v25, s[28:31], s38 offen lds
s_waitcnt vmcnt(18)
s_barrier
s_add_u32 m0, s39, 98304
s_mov_b32 s37, 458752
buffer_load_dwordx4 v3, s[24:27], s37 offen sc1 lds
buffer_load_dwordx4 v3, s[24:27], s37 offen offset:1024 sc1 lds
buffer_load_dwordx4 v3, s[24:27], s37 offen offset:2048 sc1 lds
buffer_load_dwordx4 v3, s[24:27], s37 offen offset:3072 sc1 lds
s_add_u32 m0, s51, 114688
s_mov_b32 s38, 3670016
buffer_load_dwordx4 v25, s[28:31], s38 offen lds
s_add_u32 m0, s51, 115712
s_mov_b32 s38, 3686400
buffer_load_dwordx4 v25, s[28:31], s38 offen lds
s_waitcnt vmcnt(18)
s_barrier
s_add_u32 m0, s39, 131072
s_mov_b32 s37, 475136
buffer_load_dwordx4 v3, s[24:27], s37 offen sc1 lds
buffer_load_dwordx4 v3, s[24:27], s37 offen offset:1024 sc1 lds
buffer_load_dwordx4 v3, s[24:27], s37 offen offset:2048 sc1 lds
buffer_load_dwordx4 v3, s[24:27], s37 offen offset:3072 sc1 lds
s_add_u32 m0, s51, 0
s_mov_b32 s38, 3801088
buffer_load_dwordx4 v25, s[28:31], s38 offen lds
s_add_u32 m0, s51, 1024
s_mov_b32 s38, 3817472
buffer_load_dwordx4 v25, s[28:31], s38 offen lds
s_waitcnt vmcnt(18)
s_barrier
s_cmp_eq_u32 s47, 0
s_cbranch_scc0 Lw_119
s_xor_b32 s43, s2, 2
s_add_u32 s43, s43, 128
s_lshl_b32 s43, s43, 7
v_mov_b32 v26, s43
v_mov_b32 v27, 1
s_mov_b64 exec, 1
buffer_store_dword v27, v26, s[56:59], 0 offen sc1
s_mov_b64 exec, -1
Lw_119:
s_add_u32 m0, s39, 16384
s_mov_b32 s37, 491520
buffer_load_dwordx4 v3, s[24:27], s37 offen sc1 lds
buffer_load_dwordx4 v3, s[24:27], s37 offen offset:1024 sc1 lds
buffer_load_dwordx4 v3, s[24:27], s37 offen offset:2048 sc1 lds
buffer_load_dwordx4 v3, s[24:27], s37 offen offset:3072 sc1 lds
s_add_u32 m0, s51, 32768
s_mov_b32 s38, 3932160
buffer_load_dwordx4 v25, s[28:31], s38 offen lds
s_add_u32 m0, s51, 33792
s_mov_b32 s38, 3948544
buffer_load_dwordx4 v25, s[28:31], s38 offen lds
s_waitcnt vmcnt(18)
s_barrier
s_add_u32 m0, s39, 49152
s_mov_b32 s37, 507904
buffer_load_dwordx4 v3, s[24:27], s37 offen sc1 lds
buffer_load_dwordx4 v3, s[24:27], s37 offen offset:1024 sc1 lds
buffer_load_dwordx4 v3, s[24:27], s37 offen offset:2048 sc1 lds
buffer_load_dwordx4 v3, s[24:27], s37 offen offset:3072 sc1 lds
s_add_u32 m0, s51, 65536
s_mov_b32 s38, 4063232
buffer_load_dwordx4 v25, s[28:31], s38 offen lds
s_add_u32 m0, s51, 66560
s_mov_b32 s38, 4079616
buffer_load_dwordx4 v25, s[28:31], s38 offen lds
s_waitcnt vmcnt(18)
s_barrier
s_cmp_eq_u32 s47, 3
s_cbranch_scc0 Lw_120
s_lshl_b32 s92, s2, 7
s_add_u32 s92, s92, 28327936
s_load_dword s93, s[82:83], s92 glc
Lw_120:
s_waitcnt vmcnt(12)
s_cmp_eq_u32 s47, 3
s_cbranch_scc0 Lw_121
s_mov_b32 s41, 0x40000
s_branch Lpchk_124
Lpoll_122:
s_load_dword s93, s[82:83], s92 glc
Lpchk_124:
s_waitcnt lgkmcnt(0)
s_cmp_eq_u32 s93, 1
s_cbranch_scc1 Lpok_123
s_sub_u32 s41, s41, 1
s_cmp_lg_u32 s41, 0
s_cbranch_scc1 Lpoll_122
Lpok_123:
Lw_121:
s_barrier
s_waitcnt vmcnt(6)
s_barrier
s_waitcnt vmcnt(0)
s_barrier
s_barrier
s_branch Ldone_1
Ldone_1:
Lfin:
Lexit_2:
s_endpgm
.section .rodata,"a"
.p2align 6
.amdhsa_kernel sequential_preLN__sliding_local_dilated__glu_gated_geglu__prompt_kernel
  .amdhsa_next_free_vgpr 256
  .amdhsa_next_free_sgpr 100
  .amdhsa_accum_offset 256
  .amdhsa_group_segment_fixed_size 0
  .amdhsa_kernarg_size 80
  .amdhsa_user_sgpr_count 2
  .amdhsa_user_sgpr_kernarg_segment_ptr 1
  .amdhsa_system_sgpr_workgroup_id_x 1
  .amdhsa_float_denorm_mode_32 3
  .amdhsa_float_denorm_mode_16_64 3
.end_amdhsa_kernel
```

```asm
; @launch grid=(256,1,1) block=(512,1,1) lds=163840
.amdgcn_target "amdgcn-amd-amdhsa--gfx950"
.text
.globl sequential_preLN__sliding_local_dilated__glu_gated_geglu__prompt_kernel
.p2align 8
.type sequential_preLN__sliding_local_dilated__glu_gated_geglu__prompt_kernel,@function
sequential_preLN__sliding_local_dilated__glu_gated_geglu__prompt_kernel:
s_cmp_ge_u32 s2, 256
s_cbranch_scc1 Lexit_2
s_load_dwordx16 s[64:79], s[0:1], 0
s_load_dwordx4 s[80:83], s[0:1], 64
s_and_b32 s3, s2, 7
s_lshr_b32 s42, s2, 3
s_and_b32 s34, s3, 1
s_lshl_b32 s34, s34, 3
s_and_b32 s48, s42, 7
s_add_u32 s34, s34, s48
s_lshr_b32 s35, s3, 1
s_lshr_b32 s49, s42, 3
s_lshl_b32 s35, s35, 2
s_add_u32 s35, s35, s49
v_lshrrev_b32 v12, 6, v0
v_and_b32 v1, 63, v0
v_readfirstlane_b32 s36, v12
Lbeg:
s_lshl_b32 s50, s34, 7
s_sub_u32 s50, s50, 16
v_and_b32 v12, 15, v1
v_lshrrev_b32 v13, 4, v1
s_cmp_lt_u32 s36, 4
s_cbranch_scc1 Lcons_7
Lprod_3:
s_sub_u32 s47, s36, 4
s_lshl_b32 s43, s34, 7
s_lshl_b32 s44, s35, 3
s_add_u32 s63, s43, s44
s_lshl_b32 s44, s47, 1
s_add_u32 s51, s63, s44
v_lshlrev_b32 v10, 4, v1
v_lshrrev_b32 v14, 3, v1
v_and_b32 v15, 7, v1
v_lshl_add_u32 v19, v14, 6, v15
s_lshl_b32 s43, s48, 3
v_add_u32 v19, s43, v19
v_mul_u32_u24 v19, 6144, v19
s_cmp_eq_u32 s47, 3
s_cbranch_scc1 Lpf_4
v_and_b32 v16, 2, v14
v_xor_b32 v16, v15, v16
v_lshlrev_b32 v16, 4, v16
v_mul_u32_u24 v17, 6144, v14
s_lshl_b32 s43, s47, 11
v_add3_u32 v2, v17, v16, s43
v_xor_b32 v3, 64, v2
v_lshrrev_b32 v16, 1, v14
v_xor_b32 v16, v15, v16
v_lshlrev_b32 v16, 4, v16
s_lshl_b32 s43, s47, 3
s_add_u32 s43, s43, s50
v_add_u32 v17, s43, v14
s_and_b32 s44, s47, 1
s_lshl_b32 s44, s44, 6
v_add_u32 v18, 0, v17
v_max_i32 v18, 0, v18
v_lshl_add_u32 v18, v18, 11, v16
v_xor_b32 v18, s44, v18
v_mov_b32 v4, v18
v_add_u32 v18, 24, v17
v_max_i32 v18, 0, v18
v_lshl_add_u32 v18, v18, 11, v16
v_xor_b32 v18, s44, v18
v_xor_b32 v5, 64, v18
v_add_u32 v18, 48, v17
v_max_i32 v18, 0, v18
v_lshl_add_u32 v18, v18, 11, v16
v_xor_b32 v18, s44, v18
v_mov_b32 v6, v18
v_add_u32 v18, 72, v17
v_max_i32 v18, 0, v18
v_lshl_add_u32 v18, v18, 11, v16
v_xor_b32 v18, s44, v18
v_xor_b32 v7, 64, v18
v_add_u32 v18, 96, v17
v_max_i32 v18, 0, v18
v_lshl_add_u32 v18, v18, 11, v16
v_xor_b32 v18, s44, v18
v_mov_b32 v8, v18
v_add_u32 v18, 120, v17
v_max_i32 v18, 0, v18
v_lshl_add_u32 v18, v18, 11, v16
v_xor_b32 v18, s44, v18
v_xor_b32 v9, 64, v18
s_lshl_b32 s39, s47, 10
s_lshl_b32 s40, s47, 13
s_add_u32 s40, s40, 18432
s_mov_b32 s37, 0
s_mov_b32 s38, 0
s_bfm_b64 s[60:61], 56, 8
s_cmp_eq_u32 s47, 0
s_cselect_b64 s[60:61], s[60:61], -1
s_lshl_b32 s43, s35, 7
s_waitcnt lgkmcnt(0)
s_mov_b32 s8, s64
s_mov_b32 s9, s65
s_mov_b32 s10, 4194304
s_mov_b32 s11, 0x20000
s_add_u32 s12, s66, s43
s_addc_u32 s13, s67, 0
s_mov_b32 s14, 6289536
s_mov_b32 s15, 0x20000
s_add_u32 m0, s39, 0
s_mov_b64 exec, s[60:61]
buffer_load_dwordx4 v4, s[8:11], s37 offen lds
s_mov_b64 exec, -1
s_add_u32 m0, s39, 3072
s_nop 0
buffer_load_dwordx4 v5, s[8:11], s37 offen lds
s_add_u32 m0, s39, 6144
s_nop 0
buffer_load_dwordx4 v6, s[8:11], s37 offen lds
s_add_u32 m0, s39, 9216
s_nop 0
buffer_load_dwordx4 v7, s[8:11], s37 offen lds
s_add_u32 m0, s39, 12288
s_nop 0
buffer_load_dwordx4 v8, s[8:11], s37 offen lds
s_add_u32 m0, s39, 15360
s_nop 0
buffer_load_dwordx4 v9, s[8:11], s37 offen lds
s_add_u32 m0, s40, 0
s_add_u32 s43, s38, 0
buffer_load_dwordx4 v2, s[12:15], s43 offen lds
s_add_u32 m0, s40, 1024
s_add_u32 s43, s38, 49152
buffer_load_dwordx4 v3, s[12:15], s43 offen lds
s_add_u32 m0, s40, 2048
s_add_u32 s43, s38, 98304
buffer_load_dwordx4 v2, s[12:15], s43 offen lds
s_add_u32 m0, s40, 3072
s_add_u32 s43, s38, 147456
buffer_load_dwordx4 v3, s[12:15], s43 offen lds
s_add_u32 m0, s40, 4096
s_add_u32 s43, s38, 196608
buffer_load_dwordx4 v2, s[12:15], s43 offen lds
s_add_u32 m0, s40, 5120
s_add_u32 s43, s38, 245760
buffer_load_dwordx4 v3, s[12:15], s43 offen lds
s_add_u32 m0, s40, 6144
s_add_u32 s43, s38, 294912
buffer_load_dwordx4 v2, s[12:15], s43 offen lds
s_add_u32 m0, s40, 7168
s_add_u32 s43, s38, 344064
buffer_load_dwordx4 v3, s[12:15], s43 offen lds
s_add_u32 s37, s37, 128
s_add_u32 s38, s38, 393216
s_lshl_b32 s43, s47, 11
buffer_load_dword v31, v19, s[12:15], s43 offen
s_lshl_b32 s43, s51, 11
buffer_load_dwordx4 v[96:99], v10, s[8:11], s43 offen offset:0
buffer_load_dwordx4 v[100:103], v10, s[8:11], s43 offen offset:1024
buffer_load_dwordx4 v[104:107], v10, s[8:11], s43 offen offset:2048
buffer_load_dwordx4 v[108:111], v10, s[8:11], s43 offen offset:3072
s_waitcnt vmcnt(5)
s_barrier
s_add_u32 m0, s39, 43008
s_mov_b64 exec, s[60:61]
buffer_load_dwordx4 v4, s[8:11], s37 offen lds
s_mov_b64 exec, -1
s_add_u32 m0, s39, 46080
s_nop 0
buffer_load_dwordx4 v5, s[8:11], s37 offen lds
s_add_u32 m0, s39, 49152
s_nop 0
buffer_load_dwordx4 v6, s[8:11], s37 offen lds
s_add_u32 m0, s39, 52224
s_nop 0
buffer_load_dwordx4 v7, s[8:11], s37 offen lds
s_add_u32 m0, s39, 55296
s_nop 0
buffer_load_dwordx4 v8, s[8:11], s37 offen lds
s_add_u32 m0, s39, 58368
s_nop 0
buffer_load_dwordx4 v9, s[8:11], s37 offen lds
s_add_u32 m0, s40, 43008
s_add_u32 s43, s38, 0
buffer_load_dwordx4 v2, s[12:15], s43 offen lds
s_add_u32 m0, s40, 44032
s_add_u32 s43, s38, 49152
buffer_load_dwordx4 v3, s[12:15], s43 offen lds
s_add_u32 m0, s40, 45056
s_add_u32 s43, s38, 98304
buffer_load_dwordx4 v2, s[12:15], s43 offen lds
s_add_u32 m0, s40, 46080
s_add_u32 s43, s38, 147456
buffer_load_dwordx4 v3, s[12:15], s43 offen lds
s_add_u32 m0, s40, 47104
s_add_u32 s43, s38, 196608
buffer_load_dwordx4 v2, s[12:15], s43 offen lds
s_add_u32 m0, s40, 48128
s_add_u32 s43, s38, 245760
buffer_load_dwordx4 v3, s[12:15], s43 offen lds
s_add_u32 m0, s40, 49152
s_add_u32 s43, s38, 294912
buffer_load_dwordx4 v2, s[12:15], s43 offen lds
s_add_u32 m0, s40, 50176
s_add_u32 s43, s38, 344064
buffer_load_dwordx4 v3, s[12:15], s43 offen lds
s_add_u32 s37, s37, 128
s_add_u32 s38, s38, 393216
s_add_u32 m0, s39, 86016
s_mov_b64 exec, s[60:61]
buffer_load_dwordx4 v4, s[8:11], s37 offen lds
s_mov_b64 exec, -1
s_add_u32 m0, s39, 89088
s_nop 0
buffer_load_dwordx4 v5, s[8:11], s37 offen lds
s_add_u32 m0, s39, 92160
s_nop 0
buffer_load_dwordx4 v6, s[8:11], s37 offen lds
s_add_u32 m0, s39, 95232
s_nop 0
buffer_load_dwordx4 v7, s[8:11], s37 offen lds
s_add_u32 m0, s39, 98304
s_nop 0
buffer_load_dwordx4 v8, s[8:11], s37 offen lds
s_add_u32 m0, s39, 101376
s_nop 0
buffer_load_dwordx4 v9, s[8:11], s37 offen lds
s_add_u32 m0, s40, 86016
s_add_u32 s43, s38, 0
buffer_load_dwordx4 v2, s[12:15], s43 offen lds
s_add_u32 m0, s40, 87040
s_add_u32 s43, s38, 49152
buffer_load_dwordx4 v3, s[12:15], s43 offen lds
s_add_u32 m0, s40, 88064
s_add_u32 s43, s38, 98304
buffer_load_dwordx4 v2, s[12:15], s43 offen lds
s_add_u32 m0, s40, 89088
s_add_u32 s43, s38, 147456
buffer_load_dwordx4 v3, s[12:15], s43 offen lds
s_add_u32 m0, s40, 90112
s_add_u32 s43, s38, 196608
buffer_load_dwordx4 v2, s[12:15], s43 offen lds
s_add_u32 m0, s40, 91136
s_add_u32 s43, s38, 245760
buffer_load_dwordx4 v3, s[12:15], s43 offen lds
s_add_u32 m0, s40, 92160
s_add_u32 s43, s38, 294912
buffer_load_dwordx4 v2, s[12:15], s43 offen lds
s_add_u32 m0, s40, 93184
s_add_u32 s43, s38, 344064
buffer_load_dwordx4 v3, s[12:15], s43 offen lds
s_add_u32 s37, s37, 128
s_add_u32 s38, s38, 393216
s_waitcnt vmcnt(28)
s_mov_b32 s43, 0x3f803f80
v_mov_b32 v116, 0
v_mov_b32 v117, 0
v_mov_b32 v118, 0
v_mov_b32 v119, 0
v_mov_b32 v120, 0
v_mov_b32 v121, 0
v_mov_b32 v122, 0
v_mov_b32 v123, 0
v_dot2_f32_bf16 v116, v96, s43, v116
v_dot2_f32_bf16 v120, v96, v96, v120
v_dot2_f32_bf16 v118, v104, s43, v118
v_dot2_f32_bf16 v122, v104, v104, v122
v_dot2_f32_bf16 v117, v97, s43, v117
v_dot2_f32_bf16 v121, v97, v97, v121
v_dot2_f32_bf16 v119, v105, s43, v119
v_dot2_f32_bf16 v123, v105, v105, v123
v_dot2_f32_bf16 v116, v98, s43, v116
v_dot2_f32_bf16 v120, v98, v98, v120
v_dot2_f32_bf16 v118, v106, s43, v118
v_dot2_f32_bf16 v122, v106, v106, v122
v_dot2_f32_bf16 v117, v99, s43, v117
v_dot2_f32_bf16 v121, v99, v99, v121
v_dot2_f32_bf16 v119, v107, s43, v119
v_dot2_f32_bf16 v123, v107, v107, v123
v_dot2_f32_bf16 v116, v100, s43, v116
v_dot2_f32_bf16 v120, v100, v100, v120
v_dot2_f32_bf16 v118, v108, s43, v118
v_dot2_f32_bf16 v122, v108, v108, v122
v_dot2_f32_bf16 v117, v101, s43, v117
v_dot2_f32_bf16 v121, v101, v101, v121
v_dot2_f32_bf16 v119, v109, s43, v119
v_dot2_f32_bf16 v123, v109, v109, v123
v_dot2_f32_bf16 v116, v102, s43, v116
v_dot2_f32_bf16 v120, v102, v102, v120
v_dot2_f32_bf16 v118, v110, s43, v118
v_dot2_f32_bf16 v122, v110, v110, v122
v_dot2_f32_bf16 v117, v103, s43, v117
v_dot2_f32_bf16 v121, v103, v103, v121
v_dot2_f32_bf16 v119, v111, s43, v119
v_dot2_f32_bf16 v123, v111, v111, v123
s_nop 2
v_add_f32 v116, v116, v117
v_add_f32 v118, v118, v119
v_add_f32 v120, v120, v121
v_add_f32 v122, v122, v123
s_nop 1
v_permlane32_swap_b32 v116, v118
v_permlane32_swap_b32 v120, v122
v_add_f32 v116, v116, v118
v_add_f32 v120, v120, v122
s_nop 1
v_permlane16_swap_b32 v116, v120
v_add_f32 v116, v116, v120
s_nop 1
v_add_f32_dpp v116, v116, v116 row_ror:8 row_mask:0xf bank_mask:0xf
s_nop 1
v_add_f32_dpp v116, v116, v116 row_ror:4 row_mask:0xf bank_mask:0xf
s_nop 1
v_add_f32_dpp v116, v116, v116 row_ror:2 row_mask:0xf bank_mask:0xf
s_nop 1
v_add_f32_dpp v116, v116, v116 row_ror:1 row_mask:0xf bank_mask:0xf
v_mov_b32 v117, v116
s_nop 1
v_permlane16_swap_b32 v116, v117
v_mul_f32 v112, 0x3a800000, v116
v_mul_f32 v113, 0x3a800000, v117
v_fma_f32 v113, -v112, v112, v113
v_max_f32 v113, 0, v113
v_add_f32 v113, 0x3727c5ac, v113
v_rsq_f32 v113, v113
v_lshrrev_b32 v11, 5, v1
s_lshl_b32 s43, s47, 4
s_add_u32 s43, s43, 148608
v_lshl_add_u32 v11, v11, 3, s43
ds_write_b64 v11, v[112:113]
s_waitcnt lgkmcnt(0)
s_and_b32 s44, s36, 3
s_mul_i32 s44, s44, 24
s_bfe_u32 s43, s2, 0x30001
s_lshl_b32 s43, s43, 7
s_add_u32 s44, s44, s43
s_mul_i32 s44, s44, 7168
s_lshr_b32 s43, s2, 4
s_lshl_b32 s43, s43, 8
s_add_u32 s43, s43, s44
s_bitcmp0_b32 s2, 0
s_cselect_b32 s4, s72, s74
s_cselect_b32 s5, s73, s75
s_add_u32 s4, s4, s43
s_addc_u32 s5, s5, 0
s_waitcnt vmcnt(14)
s_barrier
s_add_u32 m0, s39, 0
s_mov_b64 exec, s[60:61]
buffer_load_dwordx4 v4, s[8:11], s37 offen lds
s_mov_b64 exec, -1
s_add_u32 m0, s39, 3072
s_nop 0
buffer_load_dwordx4 v5, s[8:11], s37 offen lds
s_add_u32 m0, s39, 6144
s_nop 0
buffer_load_dwordx4 v6, s[8:11], s37 offen lds
s_add_u32 m0, s39, 9216
s_nop 0
buffer_load_dwordx4 v7, s[8:11], s37 offen lds
s_add_u32 m0, s39, 12288
s_nop 0
buffer_load_dwordx4 v8, s[8:11], s37 offen lds
s_add_u32 m0, s39, 15360
s_nop 0
buffer_load_dwordx4 v9, s[8:11], s37 offen lds
s_add_u32 m0, s40, 0
s_add_u32 s43, s38, 0
buffer_load_dwordx4 v2, s[12:15], s43 offen lds
s_add_u32 m0, s40, 1024
s_add_u32 s43, s38, 49152
buffer_load_dwordx4 v3, s[12:15], s43 offen lds
s_add_u32 m0, s40, 2048
s_add_u32 s43, s38, 98304
buffer_load_dwordx4 v2, s[12:15], s43 offen lds
s_add_u32 m0, s40, 3072
s_add_u32 s43, s38, 147456
buffer_load_dwordx4 v3, s[12:15], s43 offen lds
s_add_u32 m0, s40, 4096
s_add_u32 s43, s38, 196608
buffer_load_dwordx4 v2, s[12:15], s43 offen lds
s_add_u32 m0, s40, 5120
s_add_u32 s43, s38, 245760
buffer_load_dwordx4 v3, s[12:15], s43 offen lds
s_add_u32 m0, s40, 6144
s_add_u32 s43, s38, 294912
buffer_load_dwordx4 v2, s[12:15], s43 offen lds
s_add_u32 m0, s40, 7168
s_add_u32 s43, s38, 344064
buffer_load_dwordx4 v3, s[12:15], s43 offen lds
s_add_u32 s37, s37, 128
s_add_u32 s38, s38, 393216
s_waitcnt vmcnt(14)
s_barrier
s_add_u32 m0, s39, 43008
s_mov_b64 exec, s[60:61]
buffer_load_dwordx4 v4, s[8:11], s37 offen lds
s_mov_b64 exec, -1
s_add_u32 m0, s39, 46080
s_nop 0
buffer_load_dwordx4 v5, s[8:11], s37 offen lds
s_add_u32 m0, s39, 49152
s_nop 0
buffer_load_dwordx4 v6, s[8:11], s37 offen lds
s_add_u32 m0, s39, 52224
s_nop 0
buffer_load_dwordx4 v7, s[8:11], s37 offen lds
s_add_u32 m0, s39, 55296
s_nop 0
buffer_load_dwordx4 v8, s[8:11], s37 offen lds
s_add_u32 m0, s39, 58368
s_nop 0
buffer_load_dwordx4 v9, s[8:11], s37 offen lds
s_add_u32 m0, s40, 43008
s_add_u32 s43, s38, 0
buffer_load_dwordx4 v2, s[12:15], s43 offen lds
s_add_u32 m0, s40, 44032
s_add_u32 s43, s38, 49152
buffer_load_dwordx4 v3, s[12:15], s43 offen lds
s_add_u32 m0, s40, 45056
s_add_u32 s43, s38, 98304
buffer_load_dwordx4 v2, s[12:15], s43 offen lds
s_add_u32 m0, s40, 46080
s_add_u32 s43, s38, 147456
buffer_load_dwordx4 v3, s[12:15], s43 offen lds
s_add_u32 m0, s40, 47104
s_add_u32 s43, s38, 196608
buffer_load_dwordx4 v2, s[12:15], s43 offen lds
s_add_u32 m0, s40, 48128
s_add_u32 s43, s38, 245760
buffer_load_dwordx4 v3, s[12:15], s43 offen lds
s_add_u32 m0, s40, 49152
s_add_u32 s43, s38, 294912
buffer_load_dwordx4 v2, s[12:15], s43 offen lds
s_add_u32 m0, s40, 50176
s_add_u32 s43, s38, 344064
buffer_load_dwordx4 v3, s[12:15], s43 offen lds
s_add_u32 s37, s37, 128
s_add_u32 s38, s38, 393216
s_waitcnt lgkmcnt(0)
s_load_dword s3, s[4:5], 0
s_load_dword s3, s[4:5], 64
s_load_dword s3, s[4:5], 128
s_load_dword s3, s[4:5], 192
s_load_dword s3, s[4:5], 7168
s_load_dword s3, s[4:5], 7232
s_load_dword s3, s[4:5], 7296
s_load_dword s3, s[4:5], 7360
s_load_dword s3, s[4:5], 14336
s_load_dword s3, s[4:5], 14400
s_load_dword s3, s[4:5], 14464
s_load_dword s3, s[4:5], 14528
s_load_dword s3, s[4:5], 21504
s_load_dword s3, s[4:5], 21568
s_waitcnt vmcnt(14)
s_barrier
s_add_u32 m0, s39, 86016
s_mov_b64 exec, s[60:61]
buffer_load_dwordx4 v4, s[8:11], s37 offen lds
s_mov_b64 exec, -1
s_add_u32 m0, s39, 89088
s_nop 0
buffer_load_dwordx4 v5, s[8:11], s37 offen lds
s_add_u32 m0, s39, 92160
s_nop 0
buffer_load_dwordx4 v6, s[8:11], s37 offen lds
s_add_u32 m0, s39, 95232
s_nop 0
buffer_load_dwordx4 v7, s[8:11], s37 offen lds
s_add_u32 m0, s39, 98304
s_nop 0
buffer_load_dwordx4 v8, s[8:11], s37 offen lds
s_add_u32 m0, s39, 101376
s_nop 0
buffer_load_dwordx4 v9, s[8:11], s37 offen lds
s_add_u32 m0, s40, 86016
s_add_u32 s43, s38, 0
buffer_load_dwordx4 v2, s[12:15], s43 offen lds
s_add_u32 m0, s40, 87040
s_add_u32 s43, s38, 49152
buffer_load_dwordx4 v3, s[12:15], s43 offen lds
s_add_u32 m0, s40, 88064
s_add_u32 s43, s38, 98304
buffer_load_dwordx4 v2, s[12:15], s43 offen lds
s_add_u32 m0, s40, 89088
s_add_u32 s43, s38, 147456
buffer_load_dwordx4 v3, s[12:15], s43 offen lds
s_add_u32 m0, s40, 90112
s_add_u32 s43, s38, 196608
buffer_load_dwordx4 v2, s[12:15], s43 offen lds
s_add_u32 m0, s40, 91136
s_add_u32 s43, s38, 245760
buffer_load_dwordx4 v3, s[12:15], s43 offen lds
s_add_u32 m0, s40, 92160
s_add_u32 s43, s38, 294912
buffer_load_dwordx4 v2, s[12:15], s43 offen lds
s_add_u32 m0, s40, 93184
s_add_u32 s43, s38, 344064
buffer_load_dwordx4 v3, s[12:15], s43 offen lds
s_add_u32 s37, s37, 128
s_add_u32 s38, s38, 393216
s_waitcnt vmcnt(14)
s_barrier
s_add_u32 m0, s39, 0
s_mov_b64 exec, s[60:61]
buffer_load_dwordx4 v4, s[8:11], s37 offen lds
s_mov_b64 exec, -1
s_add_u32 m0, s39, 3072
s_nop 0
buffer_load_dwordx4 v5, s[8:11], s37 offen lds
s_add_u32 m0, s39, 6144
s_nop 0
buffer_load_dwordx4 v6, s[8:11], s37 offen lds
s_add_u32 m0, s39, 9216
s_nop 0
buffer_load_dwordx4 v7, s[8:11], s37 offen lds
s_add_u32 m0, s39, 12288
s_nop 0
buffer_load_dwordx4 v8, s[8:11], s37 offen lds
s_add_u32 m0, s39, 15360
s_nop 0
buffer_load_dwordx4 v9, s[8:11], s37 offen lds
s_add_u32 m0, s40, 0
s_add_u32 s43, s38, 0
s_branch Lov_0
.p2align 12
Lst_0_0:
s_branch Lst_4_0
s_nop 0
Lov_0:
buffer_load_dwordx4 v2, s[12:15], s43 offen lds
s_add_u32 m0, s40, 1024
s_add_u32 s43, s38, 49152
buffer_load_dwordx4 v3, s[12:15], s43 offen lds
s_add_u32 m0, s40, 2048
s_add_u32 s43, s38, 98304
buffer_load_dwordx4 v2, s[12:15], s43 offen lds
s_add_u32 m0, s40, 3072
s_add_u32 s43, s38, 147456
buffer_load_dwordx4 v3, s[12:15], s43 offen lds
s_add_u32 m0, s40, 4096
s_add_u32 s43, s38, 196608
buffer_load_dwordx4 v2, s[12:15], s43 offen lds
s_add_u32 m0, s40, 5120
s_add_u32 s43, s38, 245760
buffer_load_dwordx4 v3, s[12:15], s43 offen lds
s_add_u32 m0, s40, 6144
s_add_u32 s43, s38, 294912
buffer_load_dwordx4 v2, s[12:15], s43 offen lds
s_add_u32 m0, s40, 7168
s_add_u32 s43, s38, 344064
buffer_load_dwordx4 v3, s[12:15], s43 offen lds
s_add_u32 s37, s37, 128
s_add_u32 s38, s38, 393216
s_waitcnt lgkmcnt(0)
s_load_dword s3, s[4:5], 21632
s_load_dword s3, s[4:5], 21696
s_load_dword s3, s[4:5], 28672
s_load_dword s3, s[4:5], 28736
s_load_dword s3, s[4:5], 28800
s_load_dword s3, s[4:5], 28864
s_load_dword s3, s[4:5], 35840
s_load_dword s3, s[4:5], 35904
s_load_dword s3, s[4:5], 35968
s_load_dword s3, s[4:5], 36032
s_load_dword s3, s[4:5], 43008
s_load_dword s3, s[4:5], 43072
s_load_dword s3, s[4:5], 43136
s_load_dword s3, s[4:5], 43200
s_waitcnt vmcnt(14)
s_barrier
s_add_u32 m0, s39, 43008
s_mov_b64 exec, s[60:61]
buffer_load_dwordx4 v4, s[8:11], s37 offen lds
s_mov_b64 exec, -1
s_add_u32 m0, s39, 46080
s_nop 0
buffer_load_dwordx4 v5, s[8:11], s37 offen lds
s_add_u32 m0, s39, 49152
s_nop 0
buffer_load_dwordx4 v6, s[8:11], s37 offen lds
s_add_u32 m0, s39, 52224
s_nop 0
buffer_load_dwordx4 v7, s[8:11], s37 offen lds
s_add_u32 m0, s39, 55296
s_nop 0
buffer_load_dwordx4 v8, s[8:11], s37 offen lds
s_add_u32 m0, s39, 58368
s_nop 0
buffer_load_dwordx4 v9, s[8:11], s37 offen lds
s_add_u32 m0, s40, 43008
s_add_u32 s43, s38, 0
buffer_load_dwordx4 v2, s[12:15], s43 offen lds
s_add_u32 m0, s40, 44032
s_add_u32 s43, s38, 49152
buffer_load_dwordx4 v3, s[12:15], s43 offen lds
s_add_u32 m0, s40, 45056
s_add_u32 s43, s38, 98304
buffer_load_dwordx4 v2, s[12:15], s43 offen lds
s_add_u32 m0, s40, 46080
s_add_u32 s43, s38, 147456
buffer_load_dwordx4 v3, s[12:15], s43 offen lds
s_add_u32 m0, s40, 47104
s_add_u32 s43, s38, 196608
buffer_load_dwordx4 v2, s[12:15], s43 offen lds
s_add_u32 m0, s40, 48128
s_add_u32 s43, s38, 245760
buffer_load_dwordx4 v3, s[12:15], s43 offen lds
s_add_u32 m0, s40, 49152
s_add_u32 s43, s38, 294912
buffer_load_dwordx4 v2, s[12:15], s43 offen lds
s_add_u32 m0, s40, 50176
s_add_u32 s43, s38, 344064
buffer_load_dwordx4 v3, s[12:15], s43 offen lds
s_add_u32 s37, s37, 128
s_add_u32 s38, s38, 393216
s_waitcnt vmcnt(14)
s_barrier
s_add_u32 m0, s39, 86016
s_mov_b64 exec, s[60:61]
buffer_load_dwordx4 v4, s[8:11], s37 offen lds
s_mov_b64 exec, -1
s_add_u32 m0, s39, 89088
s_nop 0
buffer_load_dwordx4 v5, s[8:11], s37 offen lds
s_add_u32 m0, s39, 92160
s_nop 0
buffer_load_dwordx4 v6, s[8:11], s37 offen lds
s_add_u32 m0, s39, 95232
s_nop 0
buffer_load_dwordx4 v7, s[8:11], s37 offen lds
s_add_u32 m0, s39, 98304
s_nop 0
buffer_load_dwordx4 v8, s[8:11], s37 offen lds
s_add_u32 m0, s39, 101376
s_nop 0
buffer_load_dwordx4 v9, s[8:11], s37 offen lds
s_add_u32 m0, s40, 86016
s_add_u32 s43, s38, 0
buffer_load_dwordx4 v2, s[12:15], s43 offen lds
s_add_u32 m0, s40, 87040
s_add_u32 s43, s38, 49152
buffer_load_dwordx4 v3, s[12:15], s43 offen lds
s_add_u32 m0, s40, 88064
s_add_u32 s43, s38, 98304
buffer_load_dwordx4 v2, s[12:15], s43 offen lds
s_add_u32 m0, s40, 89088
s_add_u32 s43, s38, 147456
buffer_load_dwordx4 v3, s[12:15], s43 offen lds
s_add_u32 m0, s40, 90112
s_add_u32 s43, s38, 196608
buffer_load_dwordx4 v2, s[12:15], s43 offen lds
s_add_u32 m0, s40, 91136
s_add_u32 s43, s38, 245760
buffer_load_dwordx4 v3, s[12:15], s43 offen lds
s_add_u32 m0, s40, 92160
s_add_u32 s43, s38, 294912
buffer_load_dwordx4 v2, s[12:15], s43 offen lds
s_add_u32 m0, s40, 93184
s_add_u32 s43, s38, 344064
buffer_load_dwordx4 v3, s[12:15], s43 offen lds
s_add_u32 s37, s37, 128
s_add_u32 s38, s38, 393216
s_waitcnt lgkmcnt(0)
s_load_dword s3, s[4:5], 50176
s_load_dword s3, s[4:5], 50240
s_load_dword s3, s[4:5], 50304
s_load_dword s3, s[4:5], 50368
s_load_dword s3, s[4:5], 57344
s_load_dword s3, s[4:5], 57408
s_load_dword s3, s[4:5], 57472
s_load_dword s3, s[4:5], 57536
s_load_dword s3, s[4:5], 64512
s_load_dword s3, s[4:5], 64576
s_load_dword s3, s[4:5], 64640
s_load_dword s3, s[4:5], 64704
s_load_dword s3, s[4:5], 71680
s_load_dword s3, s[4:5], 71744
s_waitcnt vmcnt(14)
s_barrier
s_add_u32 m0, s39, 0
s_mov_b64 exec, s[60:61]
buffer_load_dwordx4 v4, s[8:11], s37 offen lds
s_mov_b64 exec, -1
s_add_u32 m0, s39, 3072
s_nop 0
buffer_load_dwordx4 v5, s[8:11], s37 offen lds
s_add_u32 m0, s39, 6144
s_nop 0
buffer_load_dwordx4 v6, s[8:11], s37 offen lds
s_add_u32 m0, s39, 9216
s_nop 0
buffer_load_dwordx4 v7, s[8:11], s37 offen lds
s_add_u32 m0, s39, 12288
s_nop 0
buffer_load_dwordx4 v8, s[8:11], s37 offen lds
s_add_u32 m0, s39, 15360
s_nop 0
buffer_load_dwordx4 v9, s[8:11], s37 offen lds
s_add_u32 m0, s40, 0
s_add_u32 s43, s38, 0
buffer_load_dwordx4 v2, s[12:15], s43 offen lds
s_add_u32 m0, s40, 1024
s_add_u32 s43, s38, 49152
buffer_load_dwordx4 v3, s[12:15], s43 offen lds
s_add_u32 m0, s40, 2048
s_add_u32 s43, s38, 98304
buffer_load_dwordx4 v2, s[12:15], s43 offen lds
s_add_u32 m0, s40, 3072
s_add_u32 s43, s38, 147456
buffer_load_dwordx4 v3, s[12:15], s43 offen lds
s_add_u32 m0, s40, 4096
s_add_u32 s43, s38, 196608
buffer_load_dwordx4 v2, s[12:15], s43 offen lds
s_add_u32 m0, s40, 5120
s_add_u32 s43, s38, 245760
buffer_load_dwordx4 v3, s[12:15], s43 offen lds
s_add_u32 m0, s40, 6144
s_add_u32 s43, s38, 294912
buffer_load_dwordx4 v2, s[12:15], s43 offen lds
s_add_u32 m0, s40, 7168
s_add_u32 s43, s38, 344064
buffer_load_dwordx4 v3, s[12:15], s43 offen lds
s_add_u32 s37, s37, 128
s_add_u32 s38, s38, 393216
s_waitcnt vmcnt(14)
s_barrier
s_add_u32 m0, s39, 43008
s_mov_b64 exec, s[60:61]
buffer_load_dwordx4 v4, s[8:11], s37 offen lds
s_mov_b64 exec, -1
s_add_u32 m0, s39, 46080
s_nop 0
buffer_load_dwordx4 v5, s[8:11], s37 offen lds
s_add_u32 m0, s39, 49152
s_nop 0
buffer_load_dwordx4 v6, s[8:11], s37 offen lds
s_add_u32 m0, s39, 52224
s_nop 0
buffer_load_dwordx4 v7, s[8:11], s37 offen lds
s_add_u32 m0, s39, 55296
s_nop 0
buffer_load_dwordx4 v8, s[8:11], s37 offen lds
s_add_u32 m0, s39, 58368
s_nop 0
buffer_load_dwordx4 v9, s[8:11], s37 offen lds
s_add_u32 m0, s40, 43008
s_add_u32 s43, s38, 0
buffer_load_dwordx4 v2, s[12:15], s43 offen lds
s_add_u32 m0, s40, 44032
s_add_u32 s43, s38, 49152
buffer_load_dwordx4 v3, s[12:15], s43 offen lds
s_add_u32 m0, s40, 45056
s_add_u32 s43, s38, 98304
buffer_load_dwordx4 v2, s[12:15], s43 offen lds
s_add_u32 m0, s40, 46080
s_add_u32 s43, s38, 147456
buffer_load_dwordx4 v3, s[12:15], s43 offen lds
s_add_u32 m0, s40, 47104
s_add_u32 s43, s38, 196608
buffer_load_dwordx4 v2, s[12:15], s43 offen lds
s_add_u32 m0, s40, 48128
s_add_u32 s43, s38, 245760
buffer_load_dwordx4 v3, s[12:15], s43 offen lds
s_add_u32 m0, s40, 49152
s_add_u32 s43, s38, 294912
buffer_load_dwordx4 v2, s[12:15], s43 offen lds
s_add_u32 m0, s40, 50176
s_add_u32 s43, s38, 344064
buffer_load_dwordx4 v3, s[12:15], s43 offen lds
s_add_u32 s37, s37, 128
s_add_u32 s38, s38, 393216
s_waitcnt lgkmcnt(0)
s_load_dword s3, s[4:5], 71808
s_load_dword s3, s[4:5], 71872
s_load_dword s3, s[4:5], 78848
s_load_dword s3, s[4:5], 78912
s_load_dword s3, s[4:5], 78976
s_load_dword s3, s[4:5], 79040
s_load_dword s3, s[4:5], 86016
s_load_dword s3, s[4:5], 86080
s_load_dword s3, s[4:5], 86144
s_load_dword s3, s[4:5], 86208
s_load_dword s3, s[4:5], 93184
s_load_dword s3, s[4:5], 93248
s_load_dword s3, s[4:5], 93312
s_load_dword s3, s[4:5], 93376
s_waitcnt vmcnt(14)
s_barrier
s_add_u32 m0, s39, 86016
s_mov_b64 exec, s[60:61]
buffer_load_dwordx4 v4, s[8:11], s37 offen lds
s_mov_b64 exec, -1
s_add_u32 m0, s39, 89088
s_nop 0
buffer_load_dwordx4 v5, s[8:11], s37 offen lds
s_add_u32 m0, s39, 92160
s_nop 0
buffer_load_dwordx4 v6, s[8:11], s37 offen lds
s_add_u32 m0, s39, 95232
s_nop 0
buffer_load_dwordx4 v7, s[8:11], s37 offen lds
s_add_u32 m0, s39, 98304
s_nop 0
buffer_load_dwordx4 v8, s[8:11], s37 offen lds
s_add_u32 m0, s39, 101376
s_nop 0
buffer_load_dwordx4 v9, s[8:11], s37 offen lds
s_add_u32 m0, s40, 86016
s_add_u32 s43, s38, 0
buffer_load_dwordx4 v2, s[12:15], s43 offen lds
s_add_u32 m0, s40, 87040
s_add_u32 s43, s38, 49152
buffer_load_dwordx4 v3, s[12:15], s43 offen lds
s_add_u32 m0, s40, 88064
s_add_u32 s43, s38, 98304
buffer_load_dwordx4 v2, s[12:15], s43 offen lds
s_add_u32 m0, s40, 89088
s_add_u32 s43, s38, 147456
buffer_load_dwordx4 v3, s[12:15], s43 offen lds
s_add_u32 m0, s40, 90112
s_add_u32 s43, s38, 196608
buffer_load_dwordx4 v2, s[12:15], s43 offen lds
s_add_u32 m0, s40, 91136
s_add_u32 s43, s38, 245760
buffer_load_dwordx4 v3, s[12:15], s43 offen lds
s_add_u32 m0, s40, 92160
s_add_u32 s43, s38, 294912
buffer_load_dwordx4 v2, s[12:15], s43 offen lds
s_add_u32 m0, s40, 93184
s_add_u32 s43, s38, 344064
buffer_load_dwordx4 v3, s[12:15], s43 offen lds
s_add_u32 s37, s37, 128
s_add_u32 s38, s38, 393216
s_waitcnt vmcnt(14)
s_barrier
s_add_u32 m0, s39, 0
s_mov_b64 exec, s[60:61]
buffer_load_dwordx4 v4, s[8:11], s37 offen lds
s_mov_b64 exec, -1
s_add_u32 m0, s39, 3072
s_nop 0
buffer_load_dwordx4 v5, s[8:11], s37 offen lds
s_add_u32 m0, s39, 6144
s_nop 0
buffer_load_dwordx4 v6, s[8:11], s37 offen lds
s_add_u32 m0, s39, 9216
s_nop 0
buffer_load_dwordx4 v7, s[8:11], s37 offen lds
s_add_u32 m0, s39, 12288
s_nop 0
buffer_load_dwordx4 v8, s[8:11], s37 offen lds
s_add_u32 m0, s39, 15360
s_nop 0
buffer_load_dwordx4 v9, s[8:11], s37 offen lds
s_add_u32 m0, s40, 0
s_add_u32 s43, s38, 0
buffer_load_dwordx4 v2, s[12:15], s43 offen lds
s_add_u32 m0, s40, 1024
s_add_u32 s43, s38, 49152
buffer_load_dwordx4 v3, s[12:15], s43 offen lds
s_add_u32 m0, s40, 2048
s_add_u32 s43, s38, 98304
buffer_load_dwordx4 v2, s[12:15], s43 offen lds
s_add_u32 m0, s40, 3072
s_add_u32 s43, s38, 147456
buffer_load_dwordx4 v3, s[12:15], s43 offen lds
s_add_u32 m0, s40, 4096
s_add_u32 s43, s38, 196608
buffer_load_dwordx4 v2, s[12:15], s43 offen lds
s_add_u32 m0, s40, 5120
s_add_u32 s43, s38, 245760
buffer_load_dwordx4 v3, s[12:15], s43 offen lds
s_add_u32 m0, s40, 6144
s_add_u32 s43, s38, 294912
buffer_load_dwordx4 v2, s[12:15], s43 offen lds
s_add_u32 m0, s40, 7168
s_add_u32 s43, s38, 344064
buffer_load_dwordx4 v3, s[12:15], s43 offen lds
s_add_u32 s37, s37, 128
s_add_u32 s38, s38, 393216
s_waitcnt lgkmcnt(0)
s_load_dword s3, s[4:5], 100352
s_load_dword s3, s[4:5], 100416
s_load_dword s3, s[4:5], 100480
s_load_dword s3, s[4:5], 100544
s_load_dword s3, s[4:5], 107520
s_load_dword s3, s[4:5], 107584
s_load_dword s3, s[4:5], 107648
s_load_dword s3, s[4:5], 107712
s_load_dword s3, s[4:5], 114688
s_load_dword s3, s[4:5], 114752
s_load_dword s3, s[4:5], 114816
s_load_dword s3, s[4:5], 114880
s_load_dword s3, s[4:5], 121856
s_load_dword s3, s[4:5], 121920
s_waitcnt vmcnt(14)
s_barrier
s_add_u32 m0, s39, 43008
s_mov_b64 exec, s[60:61]
buffer_load_dwordx4 v4, s[8:11], s37 offen lds
s_mov_b64 exec, -1
s_add_u32 m0, s39, 46080
s_nop 0
buffer_load_dwordx4 v5, s[8:11], s37 offen lds
s_add_u32 m0, s39, 49152
s_nop 0
buffer_load_dwordx4 v6, s[8:11], s37 offen lds
s_add_u32 m0, s39, 52224
s_nop 0
buffer_load_dwordx4 v7, s[8:11], s37 offen lds
s_add_u32 m0, s39, 55296
s_nop 0
buffer_load_dwordx4 v8, s[8:11], s37 offen lds
s_add_u32 m0, s39, 58368
s_nop 0
buffer_load_dwordx4 v9, s[8:11], s37 offen lds
s_add_u32 m0, s40, 43008
s_add_u32 s43, s38, 0
buffer_load_dwordx4 v2, s[12:15], s43 offen lds
s_add_u32 m0, s40, 44032
s_add_u32 s43, s38, 49152
buffer_load_dwordx4 v3, s[12:15], s43 offen lds
s_add_u32 m0, s40, 45056
s_add_u32 s43, s38, 98304
buffer_load_dwordx4 v2, s[12:15], s43 offen lds
s_add_u32 m0, s40, 46080
s_add_u32 s43, s38, 147456
buffer_load_dwordx4 v3, s[12:15], s43 offen lds
s_add_u32 m0, s40, 47104
s_add_u32 s43, s38, 196608
buffer_load_dwordx4 v2, s[12:15], s43 offen lds
s_add_u32 m0, s40, 48128
s_add_u32 s43, s38, 245760
buffer_load_dwordx4 v3, s[12:15], s43 offen lds
s_add_u32 m0, s40, 49152
s_add_u32 s43, s38, 294912
buffer_load_dwordx4 v2, s[12:15], s43 offen lds
s_add_u32 m0, s40, 50176
s_add_u32 s43, s38, 344064
buffer_load_dwordx4 v3, s[12:15], s43 offen lds
s_add_u32 s37, s37, 128
s_add_u32 s38, s38, 393216
s_waitcnt vmcnt(14)
s_barrier
s_add_u32 m0, s39, 86016
s_mov_b64 exec, s[60:61]
buffer_load_dwordx4 v4, s[8:11], s37 offen lds
s_mov_b64 exec, -1
s_add_u32 m0, s39, 89088
s_nop 0
buffer_load_dwordx4 v5, s[8:11], s37 offen lds
s_add_u32 m0, s39, 92160
s_nop 0
buffer_load_dwordx4 v6, s[8:11], s37 offen lds
s_add_u32 m0, s39, 95232
s_nop 0
buffer_load_dwordx4 v7, s[8:11], s37 offen lds
s_add_u32 m0, s39, 98304
s_nop 0
buffer_load_dwordx4 v8, s[8:11], s37 offen lds
s_add_u32 m0, s39, 101376
s_nop 0
buffer_load_dwordx4 v9, s[8:11], s37 offen lds
s_add_u32 m0, s40, 86016
s_add_u32 s43, s38, 0
buffer_load_dwordx4 v2, s[12:15], s43 offen lds
s_add_u32 m0, s40, 87040
s_add_u32 s43, s38, 49152
buffer_load_dwordx4 v3, s[12:15], s43 offen lds
s_add_u32 m0, s40, 88064
s_add_u32 s43, s38, 98304
buffer_load_dwordx4 v2, s[12:15], s43 offen lds
s_add_u32 m0, s40, 89088
s_add_u32 s43, s38, 147456
buffer_load_dwordx4 v3, s[12:15], s43 offen lds
s_add_u32 m0, s40, 90112
s_add_u32 s43, s38, 196608
buffer_load_dwordx4 v2, s[12:15], s43 offen lds
s_add_u32 m0, s40, 91136
s_add_u32 s43, s38, 245760
buffer_load_dwordx4 v3, s[12:15], s43 offen lds
s_add_u32 m0, s40, 92160
s_add_u32 s43, s38, 294912
buffer_load_dwordx4 v2, s[12:15], s43 offen lds
s_add_u32 m0, s40, 93184
s_add_u32 s43, s38, 344064
buffer_load_dwordx4 v3, s[12:15], s43 offen lds
s_add_u32 s37, s37, 128
s_add_u32 s38, s38, 393216
s_waitcnt lgkmcnt(0)
s_load_dword s3, s[4:5], 121984
s_load_dword s3, s[4:5], 122048
s_load_dword s3, s[4:5], 129024
s_load_dword s3, s[4:5], 129088
s_load_dword s3, s[4:5], 129152
s_load_dword s3, s[4:5], 129216
s_load_dword s3, s[4:5], 136192
s_load_dword s3, s[4:5], 136256
s_load_dword s3, s[4:5], 136320
s_load_dword s3, s[4:5], 136384
s_load_dword s3, s[4:5], 143360
s_load_dword s3, s[4:5], 143424
s_load_dword s3, s[4:5], 143488
s_load_dword s3, s[4:5], 143552
s_waitcnt vmcnt(14)
s_barrier
s_add_u32 m0, s39, 0
s_mov_b64 exec, s[60:61]
buffer_load_dwordx4 v4, s[8:11], s37 offen lds
s_mov_b64 exec, -1
s_add_u32 m0, s39, 3072
s_nop 0
buffer_load_dwordx4 v5, s[8:11], s37 offen lds
s_add_u32 m0, s39, 6144
s_nop 0
buffer_load_dwordx4 v6, s[8:11], s37 offen lds
s_add_u32 m0, s39, 9216
s_nop 0
buffer_load_dwordx4 v7, s[8:11], s37 offen lds
s_add_u32 m0, s39, 12288
s_nop 0
buffer_load_dwordx4 v8, s[8:11], s37 offen lds
s_add_u32 m0, s39, 15360
s_nop 0
buffer_load_dwordx4 v9, s[8:11], s37 offen lds
s_add_u32 m0, s40, 0
s_add_u32 s43, s38, 0
buffer_load_dwordx4 v2, s[12:15], s43 offen lds
s_add_u32 m0, s40, 1024
s_add_u32 s43, s38, 49152
buffer_load_dwordx4 v3, s[12:15], s43 offen lds
s_add_u32 m0, s40, 2048
s_add_u32 s43, s38, 98304
buffer_load_dwordx4 v2, s[12:15], s43 offen lds
s_add_u32 m0, s40, 3072
s_add_u32 s43, s38, 147456
buffer_load_dwordx4 v3, s[12:15], s43 offen lds
s_add_u32 m0, s40, 4096
s_add_u32 s43, s38, 196608
buffer_load_dwordx4 v2, s[12:15], s43 offen lds
s_add_u32 m0, s40, 5120
s_add_u32 s43, s38, 245760
buffer_load_dwordx4 v3, s[12:15], s43 offen lds
s_add_u32 m0, s40, 6144
s_add_u32 s43, s38, 294912
buffer_load_dwordx4 v2, s[12:15], s43 offen lds
s_add_u32 m0, s40, 7168
s_add_u32 s43, s38, 344064
buffer_load_dwordx4 v3, s[12:15], s43 offen lds
s_add_u32 s37, s37, 128
s_add_u32 s38, s38, 393216
s_waitcnt vmcnt(14)
s_barrier
s_waitcnt lgkmcnt(0)
s_load_dword s3, s[4:5], 150528
s_load_dword s3, s[4:5], 150592
s_load_dword s3, s[4:5], 150656
s_load_dword s3, s[4:5], 150720
s_load_dword s3, s[4:5], 157696
s_load_dword s3, s[4:5], 157760
s_load_dword s3, s[4:5], 157824
s_load_dword s3, s[4:5], 157888
s_load_dword s3, s[4:5], 164864
s_load_dword s3, s[4:5], 164928
s_load_dword s3, s[4:5], 164992
s_load_dword s3, s[4:5], 165056
s_waitcnt vmcnt(0)
s_barrier
s_bitcmp0_b32 s2, 0
s_cselect_b32 s88, s72, s74
s_cselect_b32 s89, s73, s75
s_cmp_lt_u32 s2, 192
s_cselect_b32 s90, 7340032, 0
s_mov_b32 s91, 0x20000
s_bfe_u32 s44, s2, 0x30001
s_lshl_b32 s44, s44, 2
s_and_b32 s43, s36, 3
s_add_u32 s44, s44, s43
s_lshl_b32 s44, s44, 5
v_lshrrev_b32 v18, 4, v1
v_add_u32 v18, s44, v18
v_mul_u32_u24 v18, 7168, v18
v_and_b32 v19, 15, v1
v_lshl_add_u32 v18, v19, 4, v18
s_lshr_b32 s43, s2, 4
s_lshl_b32 s43, s43, 8
s_add_u32 s43, s43, 4096
v_add_u32 v18, s43, v18
s_mov_b32 s43, 0
buffer_load_dwordx4 v[128:131], v18, s[88:91], s43 offen
s_mov_b32 s43, 28672
buffer_load_dwordx4 v[132:135], v18, s[88:91], s43 offen
s_mov_b32 s43, 57344
buffer_load_dwordx4 v[136:139], v18, s[88:91], s43 offen
s_mov_b32 s43, 86016
buffer_load_dwordx4 v[140:143], v18, s[88:91], s43 offen
s_mov_b32 s43, 114688
buffer_load_dwordx4 v[144:147], v18, s[88:91], s43 offen
s_mov_b32 s43, 143360
s_branch Lov_1
.p2align 12
Lst_1_0:
s_branch Lst_5_0
s_nop 0
Lov_1:
buffer_load_dwordx4 v[148:151], v18, s[88:91], s43 offen
s_mov_b32 s43, 172032
buffer_load_dwordx4 v[152:155], v18, s[88:91], s43 offen
s_mov_b32 s43, 200704
buffer_load_dwordx4 v[156:159], v18, s[88:91], s43 offen
s_barrier
s_lshl_b32 s43, s35, 7
s_add_u32 s28, s68, s43
s_addc_u32 s29, s69, 0
s_mov_b32 s30, 2095232
s_mov_b32 s31, 0x20000
v_lshrrev_b32 v15, 3, v1
v_and_b32 v16, 6, v15
v_and_b32 v7, 7, v1
v_xor_b32 v7, v7, v16
v_lshlrev_b32 v7, 4, v7
v_mul_u32_u24 v15, 2048, v15
v_add_u32 v7, v7, v15
s_and_b32 s40, s36, 3
s_lshl_b32 s39, s40, 13
s_add_u32 s40, s40, s35
s_add_u32 s42, s40, 0
s_and_b32 s42, s42, 15
s_lshl_b32 s42, s42, 17
s_add_u32 m0, s39, 65536
s_add_u32 s43, s42, 0
buffer_load_dwordx4 v7, s[28:31], s43 offen lds
s_add_u32 m0, s39, 66560
s_add_u32 s43, s42, 16384
buffer_load_dwordx4 v7, s[28:31], s43 offen lds
s_add_u32 m0, s39, 67584
s_add_u32 s43, s42, 32768
buffer_load_dwordx4 v7, s[28:31], s43 offen lds
s_add_u32 m0, s39, 68608
s_add_u32 s43, s42, 49152
buffer_load_dwordx4 v7, s[28:31], s43 offen lds
s_add_u32 m0, s39, 69632
s_add_u32 s43, s42, 65536
buffer_load_dwordx4 v7, s[28:31], s43 offen lds
s_add_u32 m0, s39, 70656
s_add_u32 s43, s42, 81920
buffer_load_dwordx4 v7, s[28:31], s43 offen lds
s_add_u32 m0, s39, 71680
s_add_u32 s43, s42, 98304
buffer_load_dwordx4 v7, s[28:31], s43 offen lds
s_add_u32 m0, s39, 72704
s_add_u32 s43, s42, 114688
buffer_load_dwordx4 v7, s[28:31], s43 offen lds
s_branch Lats_6
Lcons_7:
s_lshl_b32 s43, s35, 7
s_waitcnt lgkmcnt(0)
s_mov_b32 s8, s64
s_mov_b32 s9, s65
s_mov_b32 s10, 4194304
s_mov_b32 s11, 0x20000
s_add_u32 s12, s66, s43
s_addc_u32 s13, s67, 0
s_mov_b32 s14, 6289536
s_mov_b32 s15, 0x20000
v_lshrrev_b32 v16, 1, v12
v_xor_b32 v15, v13, v16
v_lshlrev_b32 v15, 4, v15
v_lshl_add_u32 v2, v12, 7, v15
v_xor_b32 v3, 64, v2
v_add_u32 v4, 86016, v2
v_add_u32 v5, 86016, v3
v_lshrrev_b32 v15, 2, v12
v_and_b32 v16, 3, v1
v_lshl_add_u32 v19, v13, 3, v15
v_lshlrev_b32 v19, 7, v19
v_and_b32 v15, 2, v15
v_and_b32 v17, 1, v13
v_lshl_add_u32 v15, v17, 2, v15
v_lshrrev_b32 v17, 1, v16
s_lshl_b32 s43, s36, 1
v_add_u32 v17, s43, v17
v_xor_b32 v15, v15, v17
v_lshl_add_u32 v19, v15, 4, v19
v_and_b32 v16, 1, v16
v_lshl_add_u32 v19, v16, 3, v19
v_add_u32 v6, 18432, v19
v_add_u32 v7, 61440, v19
v_add_u32 v8, 104448, v19
v_mov_b32 v128, 0
v_mov_b32 v129, 0
v_mov_b32 v130, 0
v_mov_b32 v131, 0
v_mov_b32 v132, 0
v_mov_b32 v133, 0
v_mov_b32 v134, 0
v_mov_b32 v135, 0
v_mov_b32 v136, 0
v_mov_b32 v137, 0
v_mov_b32 v138, 0
v_mov_b32 v139, 0
v_mov_b32 v140, 0
v_mov_b32 v141, 0
v_mov_b32 v142, 0
v_mov_b32 v143, 0
v_mov_b32 v144, 0
v_mov_b32 v145, 0
v_mov_b32 v146, 0
v_mov_b32 v147, 0
v_mov_b32 v148, 0
v_mov_b32 v149, 0
v_mov_b32 v150, 0
v_mov_b32 v151, 0
v_mov_b32 v152, 0
v_mov_b32 v153, 0
v_mov_b32 v154, 0
v_mov_b32 v155, 0
v_mov_b32 v156, 0
v_mov_b32 v157, 0
v_mov_b32 v158, 0
v_mov_b32 v159, 0
v_mov_b32 v160, 0
v_mov_b32 v161, 0
v_mov_b32 v162, 0
v_mov_b32 v163, 0
v_mov_b32 v164, 0
v_mov_b32 v165, 0
v_mov_b32 v166, 0
v_mov_b32 v167, 0
v_mov_b32 v168, 0
v_mov_b32 v169, 0
v_mov_b32 v170, 0
v_mov_b32 v171, 0
v_mov_b32 v172, 0
v_mov_b32 v173, 0
v_mov_b32 v174, 0
v_mov_b32 v175, 0
v_mov_b32 v176, 0
v_mov_b32 v177, 0
v_mov_b32 v178, 0
v_mov_b32 v179, 0
v_mov_b32 v180, 0
v_mov_b32 v181, 0
v_mov_b32 v182, 0
v_mov_b32 v183, 0
v_mov_b32 v184, 0
v_mov_b32 v185, 0
v_mov_b32 v186, 0
v_mov_b32 v187, 0
v_mov_b32 v188, 0
v_mov_b32 v189, 0
v_mov_b32 v190, 0
v_mov_b32 v191, 0
v_mov_b32 v192, 0
v_mov_b32 v193, 0
v_mov_b32 v194, 0
v_mov_b32 v195, 0
v_mov_b32 v196, 0
v_mov_b32 v197, 0
v_mov_b32 v198, 0
v_mov_b32 v199, 0
v_mov_b32 v200, 0
v_mov_b32 v201, 0
v_mov_b32 v202, 0
v_mov_b32 v203, 0
v_mov_b32 v204, 0
v_mov_b32 v205, 0
v_mov_b32 v206, 0
v_mov_b32 v207, 0
v_mov_b32 v208, 0
v_mov_b32 v209, 0
v_mov_b32 v210, 0
v_mov_b32 v211, 0
v_mov_b32 v212, 0
v_mov_b32 v213, 0
v_mov_b32 v214, 0
v_mov_b32 v215, 0
v_mov_b32 v216, 0
v_mov_b32 v217, 0
v_mov_b32 v218, 0
v_mov_b32 v219, 0
v_mov_b32 v220, 0
v_mov_b32 v221, 0
v_mov_b32 v222, 0
v_mov_b32 v223, 0
v_mov_b32 v224, 0
v_mov_b32 v225, 0
v_mov_b32 v226, 0
v_mov_b32 v227, 0
v_mov_b32 v228, 0
v_mov_b32 v229, 0
v_mov_b32 v230, 0
v_mov_b32 v231, 0
v_mov_b32 v232, 0
v_mov_b32 v233, 0
v_mov_b32 v234, 0
v_mov_b32 v235, 0
s_and_b32 s43, s36, 1
s_bfe_u32 s44, s36, 0x10001
s_lshr_b32 s45, s36, 2
v_lshlrev_b32 v14, 2, v13
v_sub_u32 v14, v12, v14
v_mov_b32 v16, 0xff800000
s_or_b32 s46, s34, s45
s_cmp_lg_u32 s46, 0
s_cselect_b32 s46, 0, 0xff800000
v_subrev_u32 v15, 0, v14
v_cmp_ge_u32 vcc, 7, v15
v_add_u32 v15, 16, v15
s_nop 0
v_cndmask_b32 v248, v16, 0, vcc
v_cmp_ge_u32 vcc, 7, v15
s_nop 1
v_cndmask_b32 v244, v16, 0, vcc
v_or_b32 v240, s46, v244
v_subrev_u32 v15, 1, v14
v_cmp_ge_u32 vcc, 7, v15
v_add_u32 v15, 16, v15
s_nop 0
v_cndmask_b32 v249, v16, 0, vcc
v_cmp_ge_u32 vcc, 7, v15
s_nop 1
v_cndmask_b32 v245, v16, 0, vcc
v_or_b32 v241, s46, v245
v_subrev_u32 v15, 2, v14
v_cmp_ge_u32 vcc, 7, v15
v_add_u32 v15, 16, v15
s_nop 0
v_cndmask_b32 v250, v16, 0, vcc
v_cmp_ge_u32 vcc, 7, v15
s_nop 1
v_cndmask_b32 v246, v16, 0, vcc
v_or_b32 v242, s46, v246
v_subrev_u32 v15, 3, v14
v_cmp_ge_u32 vcc, 7, v15
v_add_u32 v15, 16, v15
s_nop 0
v_cndmask_b32 v251, v16, 0, vcc
v_cmp_ge_u32 vcc, 7, v15
s_nop 1
v_cndmask_b32 v247, v16, 0, vcc
v_or_b32 v243, s46, v247
s_lshl_b32 s46, s45, 6
s_add_u32 s46, s46, s44
s_add_u32 s46, s46, 16
v_lshl_add_u32 v14, v12, 1, s46
s_lshl_b32 s47, s43, 6
v_lshl_add_u32 v15, v13, 4, s47
v_mul_u32_u24 v20, 400, v14
v_add_u32 v20, v20, v15
v_subrev_u32 v16, 32, v14
v_max_i32 v16, 0, v16
v_mul_u32_u24 v21, 400, v16
v_add_u32 v21, v21, v15
v_lshrrev_b32 v16, 2, v12
v_lshl_add_u32 v16, v13, 2, v16
v_lshl_add_u32 v16, v16, 1, s46
v_and_b32 v17, 3, v1
v_lshl_add_u32 v17, v17, 3, s47
v_mul_u32_u24 v22, 400, v16
v_add_u32 v22, v22, v17
v_subrev_u32 v16, 32, v16
v_max_i32 v16, 0, v16
v_mul_u32_u24 v23, 400, v16
v_add_u32 v23, v23, v17
s_mul_i32 s60, s34, 262144
s_add_u32 s16, s82, s60
s_addc_u32 s17, s83, 0
s_mov_b32 s18, 262144
s_mov_b32 s19, 0x20000
s_lshl_b32 s60, s35, 14
s_lshl_b32 s43, s43, 13
s_add_u32 s60, s60, s43
s_lshl_b32 s43, s45, 12
s_add_u32 s60, s60, s43
s_lshl_b32 s43, s44, 10
s_add_u32 s60, s60, s43
v_lshlrev_b32 v24, 4, v1
s_mov_b32 s61, 0x3e8293ee
s_lshl_b32 s38, s35, 7
s_add_u32 s56, s82, 28311552
s_addc_u32 s57, s83, 0
s_mov_b32 s58, 49152
s_mov_b32 s59, 0x20000
s_cmp_lg_u32 s36, 0
s_cbranch_scc1 Lwm_9
s_branch Lst_0_0
Lwr_144:
s_branch Lwe_8
Lwm_9:
s_cmp_lg_u32 s36, 1
s_cbranch_scc1 Lwm_10
s_branch Lst_1_0
Lwr_145:
s_branch Lwe_8
Lwm_10:
s_cmp_lg_u32 s36, 2
s_cbranch_scc1 Lwm_11
s_branch Lst_2_0
Lwr_146:
s_branch Lwe_8
Lwm_11:
s_cmp_lg_u32 s36, 3
s_cbranch_scc1 Lwm_12
s_branch Lst_3_0
Lwr_147:
s_branch Lwe_8
Lwm_12:
Lwe_8:
s_barrier
ds_read_b128 v[32:35], v2 offset:0
ds_read_b64_tr_b16 v[72:73], v6 offset:8192
ds_read_b64_tr_b16 v[74:75], v6 offset:8704
ds_read_b64_tr_b16 v[76:77], v6 offset:16384
ds_read_b64_tr_b16 v[78:79], v6 offset:16896
ds_read_b64_tr_b16 v[68:69], v6 offset:0
ds_read_b64_tr_b16 v[70:71], v6 offset:512
ds_read_b128 v[36:39], v2 offset:2048
ds_read_b128 v[40:43], v2 offset:4096
ds_read_b128 v[44:47], v2 offset:6144
ds_read_b128 v[48:51], v2 offset:8192
ds_read_b128 v[52:55], v2 offset:10240
ds_read_b128 v[56:59], v2 offset:12288
ds_read_b128 v[60:63], v2 offset:14336
ds_read_b128 v[64:67], v2 offset:16384
s_mov_b32 s41, 5
Lcl_13:
s_waitcnt lgkmcnt(0)
v_mfma_f32_16x16x32_bf16 v[164:167], v[72:75], v[32:35], v[164:167]
ds_read_b128 v[80:83], v3 offset:0
v_mfma_f32_16x16x32_bf16 v[200:203], v[76:79], v[32:35], v[200:203]
ds_read_b64_tr_b16 v[120:121], v6 offset:12288
v_mfma_f32_16x16x32_bf16 v[128:131], v[68:71], v[32:35], v[128:131]
ds_read_b64_tr_b16 v[122:123], v6 offset:12800
v_mfma_f32_16x16x32_bf16 v[132:135], v[68:71], v[36:39], v[132:135]
ds_read_b64_tr_b16 v[124:125], v6 offset:20480
v_mfma_f32_16x16x32_bf16 v[204:207], v[76:79], v[36:39], v[204:207]
ds_read_b64_tr_b16 v[126:127], v6 offset:20992
v_mfma_f32_16x16x32_bf16 v[168:171], v[72:75], v[36:39], v[168:171]
ds_read_b64_tr_b16 v[116:117], v6 offset:4096
v_mfma_f32_16x16x32_bf16 v[172:175], v[72:75], v[40:43], v[172:175]
ds_read_b64_tr_b16 v[118:119], v6 offset:4608
v_mfma_f32_16x16x32_bf16 v[208:211], v[76:79], v[40:43], v[208:211]
ds_read_b128 v[84:87], v3 offset:2048
v_mfma_f32_16x16x32_bf16 v[136:139], v[68:71], v[40:43], v[136:139]
ds_read_b128 v[88:91], v3 offset:4096
v_mfma_f32_16x16x32_bf16 v[140:143], v[68:71], v[44:47], v[140:143]
ds_read_b128 v[92:95], v3 offset:6144
v_mfma_f32_16x16x32_bf16 v[212:215], v[76:79], v[44:47], v[212:215]
ds_read_b128 v[96:99], v3 offset:8192
v_mfma_f32_16x16x32_bf16 v[176:179], v[72:75], v[44:47], v[176:179]
ds_read_b128 v[100:103], v3 offset:10240
v_mfma_f32_16x16x32_bf16 v[180:183], v[72:75], v[48:51], v[180:183]
ds_read_b128 v[104:107], v3 offset:12288
v_mfma_f32_16x16x32_bf16 v[216:219], v[76:79], v[48:51], v[216:219]
ds_read_b128 v[108:111], v3 offset:14336
v_mfma_f32_16x16x32_bf16 v[144:147], v[68:71], v[48:51], v[144:147]
ds_read_b128 v[112:115], v3 offset:16384
v_mfma_f32_16x16x32_bf16 v[148:151], v[68:71], v[52:55], v[148:151]
v_mfma_f32_16x16x32_bf16 v[220:223], v[76:79], v[52:55], v[220:223]
v_mfma_f32_16x16x32_bf16 v[184:187], v[72:75], v[52:55], v[184:187]
v_mfma_f32_16x16x32_bf16 v[188:191], v[72:75], v[56:59], v[188:191]
v_mfma_f32_16x16x32_bf16 v[224:227], v[76:79], v[56:59], v[224:227]
v_mfma_f32_16x16x32_bf16 v[152:155], v[68:71], v[56:59], v[152:155]
v_mfma_f32_16x16x32_bf16 v[156:159], v[68:71], v[60:63], v[156:159]
v_mfma_f32_16x16x32_bf16 v[228:231], v[76:79], v[60:63], v[228:231]
v_mfma_f32_16x16x32_bf16 v[192:195], v[72:75], v[60:63], v[192:195]
v_mfma_f32_16x16x32_bf16 v[196:199], v[72:75], v[64:67], v[196:199]
v_mfma_f32_16x16x32_bf16 v[232:235], v[76:79], v[64:67], v[232:235]
v_mfma_f32_16x16x32_bf16 v[160:163], v[68:71], v[64:67], v[160:163]
s_waitcnt lgkmcnt(0)
s_barrier
v_mfma_f32_16x16x32_bf16 v[164:167], v[120:123], v[80:83], v[164:167]
ds_read_b128 v[32:35], v2 offset:43008
v_mfma_f32_16x16x32_bf16 v[200:203], v[124:127], v[80:83], v[200:203]
ds_read_b64_tr_b16 v[72:73], v7 offset:8192
v_mfma_f32_16x16x32_bf16 v[128:131], v[116:119], v[80:83], v[128:131]
ds_read_b64_tr_b16 v[74:75], v7 offset:8704
v_mfma_f32_16x16x32_bf16 v[132:135], v[116:119], v[84:87], v[132:135]
ds_read_b64_tr_b16 v[76:77], v7 offset:16384
v_mfma_f32_16x16x32_bf16 v[204:207], v[124:127], v[84:87], v[204:207]
ds_read_b64_tr_b16 v[78:79], v7 offset:16896
v_mfma_f32_16x16x32_bf16 v[168:171], v[120:123], v[84:87], v[168:171]
ds_read_b64_tr_b16 v[68:69], v7 offset:0
v_mfma_f32_16x16x32_bf16 v[172:175], v[120:123], v[88:91], v[172:175]
ds_read_b64_tr_b16 v[70:71], v7 offset:512
v_mfma_f32_16x16x32_bf16 v[208:211], v[124:127], v[88:91], v[208:211]
ds_read_b128 v[36:39], v2 offset:45056
v_mfma_f32_16x16x32_bf16 v[136:139], v[116:119], v[88:91], v[136:139]
ds_read_b128 v[40:43], v2 offset:47104
v_mfma_f32_16x16x32_bf16 v[140:143], v[116:119], v[92:95], v[140:143]
ds_read_b128 v[44:47], v2 offset:49152
v_mfma_f32_16x16x32_bf16 v[212:215], v[124:127], v[92:95], v[212:215]
ds_read_b128 v[48:51], v2 offset:51200
v_mfma_f32_16x16x32_bf16 v[176:179], v[120:123], v[92:95], v[176:179]
ds_read_b128 v[52:55], v2 offset:53248
v_mfma_f32_16x16x32_bf16 v[180:183], v[120:123], v[96:99], v[180:183]
ds_read_b128 v[56:59], v2 offset:55296
v_mfma_f32_16x16x32_bf16 v[216:219], v[124:127], v[96:99], v[216:219]
ds_read_b128 v[60:63], v2 offset:57344
v_mfma_f32_16x16x32_bf16 v[144:147], v[116:119], v[96:99], v[144:147]
ds_read_b128 v[64:67], v2 offset:59392
v_mfma_f32_16x16x32_bf16 v[148:151], v[116:119], v[100:103], v[148:151]
v_mfma_f32_16x16x32_bf16 v[220:223], v[124:127], v[100:103], v[220:223]
v_mfma_f32_16x16x32_bf16 v[184:187], v[120:123], v[100:103], v[184:187]
v_mfma_f32_16x16x32_bf16 v[188:191], v[120:123], v[104:107], v[188:191]
v_mfma_f32_16x16x32_bf16 v[224:227], v[124:127], v[104:107], v[224:227]
v_mfma_f32_16x16x32_bf16 v[152:155], v[116:119], v[104:107], v[152:155]
v_mfma_f32_16x16x32_bf16 v[156:159], v[116:119], v[108:111], v[156:159]
v_mfma_f32_16x16x32_bf16 v[228:231], v[124:127], v[108:111], v[228:231]
v_mfma_f32_16x16x32_bf16 v[192:195], v[120:123], v[108:111], v[192:195]
v_mfma_f32_16x16x32_bf16 v[196:199], v[120:123], v[112:115], v[196:199]
v_mfma_f32_16x16x32_bf16 v[232:235], v[124:127], v[112:115], v[232:235]
v_mfma_f32_16x16x32_bf16 v[160:163], v[116:119], v[112:115], v[160:163]
s_waitcnt lgkmcnt(0)
v_mfma_f32_16x16x32_bf16 v[164:167], v[72:75], v[32:35], v[164:167]
ds_read_b128 v[80:83], v3 offset:43008
v_mfma_f32_16x16x32_bf16 v[200:203], v[76:79], v[32:35], v[200:203]
ds_read_b64_tr_b16 v[120:121], v7 offset:12288
v_mfma_f32_16x16x32_bf16 v[128:131], v[68:71], v[32:35], v[128:131]
ds_read_b64_tr_b16 v[122:123], v7 offset:12800
v_mfma_f32_16x16x32_bf16 v[132:135], v[68:71], v[36:39], v[132:135]
ds_read_b64_tr_b16 v[124:125], v7 offset:20480
v_mfma_f32_16x16x32_bf16 v[204:207], v[76:79], v[36:39], v[204:207]
ds_read_b64_tr_b16 v[126:127], v7 offset:20992
v_mfma_f32_16x16x32_bf16 v[168:171], v[72:75], v[36:39], v[168:171]
ds_read_b64_tr_b16 v[116:117], v7 offset:4096
v_mfma_f32_16x16x32_bf16 v[172:175], v[72:75], v[40:43], v[172:175]
ds_read_b64_tr_b16 v[118:119], v7 offset:4608
v_mfma_f32_16x16x32_bf16 v[208:211], v[76:79], v[40:43], v[208:211]
ds_read_b128 v[84:87], v3 offset:45056
v_mfma_f32_16x16x32_bf16 v[136:139], v[68:71], v[40:43], v[136:139]
ds_read_b128 v[88:91], v3 offset:47104
v_mfma_f32_16x16x32_bf16 v[140:143], v[68:71], v[44:47], v[140:143]
ds_read_b128 v[92:95], v3 offset:49152
v_mfma_f32_16x16x32_bf16 v[212:215], v[76:79], v[44:47], v[212:215]
ds_read_b128 v[96:99], v3 offset:51200
v_mfma_f32_16x16x32_bf16 v[176:179], v[72:75], v[44:47], v[176:179]
ds_read_b128 v[100:103], v3 offset:53248
v_mfma_f32_16x16x32_bf16 v[180:183], v[72:75], v[48:51], v[180:183]
ds_read_b128 v[104:107], v3 offset:55296
v_mfma_f32_16x16x32_bf16 v[216:219], v[76:79], v[48:51], v[216:219]
ds_read_b128 v[108:111], v3 offset:57344
v_mfma_f32_16x16x32_bf16 v[144:147], v[68:71], v[48:51], v[144:147]
ds_read_b128 v[112:115], v3 offset:59392
v_mfma_f32_16x16x32_bf16 v[148:151], v[68:71], v[52:55], v[148:151]
v_mfma_f32_16x16x32_bf16 v[220:223], v[76:79], v[52:55], v[220:223]
v_mfma_f32_16x16x32_bf16 v[184:187], v[72:75], v[52:55], v[184:187]
v_mfma_f32_16x16x32_bf16 v[188:191], v[72:75], v[56:59], v[188:191]
v_mfma_f32_16x16x32_bf16 v[224:227], v[76:79], v[56:59], v[224:227]
v_mfma_f32_16x16x32_bf16 v[152:155], v[68:71], v[56:59], v[152:155]
v_mfma_f32_16x16x32_bf16 v[156:159], v[68:71], v[60:63], v[156:159]
v_mfma_f32_16x16x32_bf16 v[228:231], v[76:79], v[60:63], v[228:231]
v_mfma_f32_16x16x32_bf16 v[192:195], v[72:75], v[60:63], v[192:195]
v_mfma_f32_16x16x32_bf16 v[196:199], v[72:75], v[64:67], v[196:199]
v_mfma_f32_16x16x32_bf16 v[232:235], v[76:79], v[64:67], v[232:235]
v_mfma_f32_16x16x32_bf16 v[160:163], v[68:71], v[64:67], v[160:163]
s_waitcnt lgkmcnt(0)
s_barrier
v_mfma_f32_16x16x32_bf16 v[164:167], v[120:123], v[80:83], v[164:167]
ds_read_b128 v[32:35], v4 offset:0
v_mfma_f32_16x16x32_bf16 v[200:203], v[124:127], v[80:83], v[200:203]
ds_read_b64_tr_b16 v[72:73], v8 offset:8192
v_mfma_f32_16x16x32_bf16 v[128:131], v[116:119], v[80:83], v[128:131]
ds_read_b64_tr_b16 v[74:75], v8 offset:8704
v_mfma_f32_16x16x32_bf16 v[132:135], v[116:119], v[84:87], v[132:135]
ds_read_b64_tr_b16 v[76:77], v8 offset:16384
v_mfma_f32_16x16x32_bf16 v[204:207], v[124:127], v[84:87], v[204:207]
ds_read_b64_tr_b16 v[78:79], v8 offset:16896
v_mfma_f32_16x16x32_bf16 v[168:171], v[120:123], v[84:87], v[168:171]
ds_read_b64_tr_b16 v[68:69], v8 offset:0
v_mfma_f32_16x16x32_bf16 v[172:175], v[120:123], v[88:91], v[172:175]
ds_read_b64_tr_b16 v[70:71], v8 offset:512
v_mfma_f32_16x16x32_bf16 v[208:211], v[124:127], v[88:91], v[208:211]
ds_read_b128 v[36:39], v4 offset:2048
v_mfma_f32_16x16x32_bf16 v[136:139], v[116:119], v[88:91], v[136:139]
ds_read_b128 v[40:43], v4 offset:4096
v_mfma_f32_16x16x32_bf16 v[140:143], v[116:119], v[92:95], v[140:143]
ds_read_b128 v[44:47], v4 offset:6144
v_mfma_f32_16x16x32_bf16 v[212:215], v[124:127], v[92:95], v[212:215]
ds_read_b128 v[48:51], v4 offset:8192
v_mfma_f32_16x16x32_bf16 v[176:179], v[120:123], v[92:95], v[176:179]
ds_read_b128 v[52:55], v4 offset:10240
v_mfma_f32_16x16x32_bf16 v[180:183], v[120:123], v[96:99], v[180:183]
ds_read_b128 v[56:59], v4 offset:12288
v_mfma_f32_16x16x32_bf16 v[216:219], v[124:127], v[96:99], v[216:219]
ds_read_b128 v[60:63], v4 offset:14336
v_mfma_f32_16x16x32_bf16 v[144:147], v[116:119], v[96:99], v[144:147]
ds_read_b128 v[64:67], v4 offset:16384
v_mfma_f32_16x16x32_bf16 v[148:151], v[116:119], v[100:103], v[148:151]
v_mfma_f32_16x16x32_bf16 v[220:223], v[124:127], v[100:103], v[220:223]
v_mfma_f32_16x16x32_bf16 v[184:187], v[120:123], v[100:103], v[184:187]
v_mfma_f32_16x16x32_bf16 v[188:191], v[120:123], v[104:107], v[188:191]
v_mfma_f32_16x16x32_bf16 v[224:227], v[124:127], v[104:107], v[224:227]
v_mfma_f32_16x16x32_bf16 v[152:155], v[116:119], v[104:107], v[152:155]
v_mfma_f32_16x16x32_bf16 v[156:159], v[116:119], v[108:111], v[156:159]
v_mfma_f32_16x16x32_bf16 v[228:231], v[124:127], v[108:111], v[228:231]
v_mfma_f32_16x16x32_bf16 v[192:195], v[120:123], v[108:111], v[192:195]
v_mfma_f32_16x16x32_bf16 v[196:199], v[120:123], v[112:115], v[196:199]
v_mfma_f32_16x16x32_bf16 v[232:235], v[124:127], v[112:115], v[232:235]
v_mfma_f32_16x16x32_bf16 v[160:163], v[116:119], v[112:115], v[160:163]
s_waitcnt lgkmcnt(0)
v_mfma_f32_16x16x32_bf16 v[164:167], v[72:75], v[32:35], v[164:167]
ds_read_b128 v[80:83], v5 offset:0
v_mfma_f32_16x16x32_bf16 v[200:203], v[76:79], v[32:35], v[200:203]
ds_read_b64_tr_b16 v[120:121], v8 offset:12288
v_mfma_f32_16x16x32_bf16 v[128:131], v[68:71], v[32:35], v[128:131]
ds_read_b64_tr_b16 v[122:123], v8 offset:12800
v_mfma_f32_16x16x32_bf16 v[132:135], v[68:71], v[36:39], v[132:135]
ds_read_b64_tr_b16 v[124:125], v8 offset:20480
v_mfma_f32_16x16x32_bf16 v[204:207], v[76:79], v[36:39], v[204:207]
ds_read_b64_tr_b16 v[126:127], v8 offset:20992
v_mfma_f32_16x16x32_bf16 v[168:171], v[72:75], v[36:39], v[168:171]
ds_read_b64_tr_b16 v[116:117], v8 offset:4096
v_mfma_f32_16x16x32_bf16 v[172:175], v[72:75], v[40:43], v[172:175]
ds_read_b64_tr_b16 v[118:119], v8 offset:4608
v_mfma_f32_16x16x32_bf16 v[208:211], v[76:79], v[40:43], v[208:211]
ds_read_b128 v[84:87], v5 offset:2048
v_mfma_f32_16x16x32_bf16 v[136:139], v[68:71], v[40:43], v[136:139]
ds_read_b128 v[88:91], v5 offset:4096
v_mfma_f32_16x16x32_bf16 v[140:143], v[68:71], v[44:47], v[140:143]
ds_read_b128 v[92:95], v5 offset:6144
v_mfma_f32_16x16x32_bf16 v[212:215], v[76:79], v[44:47], v[212:215]
ds_read_b128 v[96:99], v5 offset:8192
v_mfma_f32_16x16x32_bf16 v[176:179], v[72:75], v[44:47], v[176:179]
ds_read_b128 v[100:103], v5 offset:10240
v_mfma_f32_16x16x32_bf16 v[180:183], v[72:75], v[48:51], v[180:183]
ds_read_b128 v[104:107], v5 offset:12288
v_mfma_f32_16x16x32_bf16 v[216:219], v[76:79], v[48:51], v[216:219]
ds_read_b128 v[108:111], v5 offset:14336
v_mfma_f32_16x16x32_bf16 v[144:147], v[68:71], v[48:51], v[144:147]
ds_read_b128 v[112:115], v5 offset:16384
v_mfma_f32_16x16x32_bf16 v[148:151], v[68:71], v[52:55], v[148:151]
v_mfma_f32_16x16x32_bf16 v[220:223], v[76:79], v[52:55], v[220:223]
v_mfma_f32_16x16x32_bf16 v[184:187], v[72:75], v[52:55], v[184:187]
v_mfma_f32_16x16x32_bf16 v[188:191], v[72:75], v[56:59], v[188:191]
v_mfma_f32_16x16x32_bf16 v[224:227], v[76:79], v[56:59], v[224:227]
v_mfma_f32_16x16x32_bf16 v[152:155], v[68:71], v[56:59], v[152:155]
v_mfma_f32_16x16x32_bf16 v[156:159], v[68:71], v[60:63], v[156:159]
v_mfma_f32_16x16x32_bf16 v[228:231], v[76:79], v[60:63], v[228:231]
v_mfma_f32_16x16x32_bf16 v[192:195], v[72:75], v[60:63], v[192:195]
v_mfma_f32_16x16x32_bf16 v[196:199], v[72:75], v[64:67], v[196:199]
v_mfma_f32_16x16x32_bf16 v[232:235], v[76:79], v[64:67], v[232:235]
v_mfma_f32_16x16x32_bf16 v[160:163], v[68:71], v[64:67], v[160:163]
s_waitcnt lgkmcnt(0)
s_barrier
v_mfma_f32_16x16x32_bf16 v[164:167], v[120:123], v[80:83], v[164:167]
ds_read_b128 v[32:35], v2 offset:0
v_mfma_f32_16x16x32_bf16 v[200:203], v[124:127], v[80:83], v[200:203]
ds_read_b64_tr_b16 v[72:73], v6 offset:8192
v_mfma_f32_16x16x32_bf16 v[128:131], v[116:119], v[80:83], v[128:131]
ds_read_b64_tr_b16 v[74:75], v6 offset:8704
v_mfma_f32_16x16x32_bf16 v[132:135], v[116:119], v[84:87], v[132:135]
ds_read_b64_tr_b16 v[76:77], v6 offset:16384
v_mfma_f32_16x16x32_bf16 v[204:207], v[124:127], v[84:87], v[204:207]
ds_read_b64_tr_b16 v[78:79], v6 offset:16896
v_mfma_f32_16x16x32_bf16 v[168:171], v[120:123], v[84:87], v[168:171]
ds_read_b64_tr_b16 v[68:69], v6 offset:0
v_mfma_f32_16x16x32_bf16 v[172:175], v[120:123], v[88:91], v[172:175]
ds_read_b64_tr_b16 v[70:71], v6 offset:512
v_mfma_f32_16x16x32_bf16 v[208:211], v[124:127], v[88:91], v[208:211]
ds_read_b128 v[36:39], v2 offset:2048
v_mfma_f32_16x16x32_bf16 v[136:139], v[116:119], v[88:91], v[136:139]
ds_read_b128 v[40:43], v2 offset:4096
v_mfma_f32_16x16x32_bf16 v[140:143], v[116:119], v[92:95], v[140:143]
ds_read_b128 v[44:47], v2 offset:6144
v_mfma_f32_16x16x32_bf16 v[212:215], v[124:127], v[92:95], v[212:215]
ds_read_b128 v[48:51], v2 offset:8192
v_mfma_f32_16x16x32_bf16 v[176:179], v[120:123], v[92:95], v[176:179]
ds_read_b128 v[52:55], v2 offset:10240
v_mfma_f32_16x16x32_bf16 v[180:183], v[120:123], v[96:99], v[180:183]
ds_read_b128 v[56:59], v2 offset:12288
v_mfma_f32_16x16x32_bf16 v[216:219], v[124:127], v[96:99], v[216:219]
ds_read_b128 v[60:63], v2 offset:14336
v_mfma_f32_16x16x32_bf16 v[144:147], v[116:119], v[96:99], v[144:147]
ds_read_b128 v[64:67], v2 offset:16384
v_mfma_f32_16x16x32_bf16 v[148:151], v[116:119], v[100:103], v[148:151]
v_mfma_f32_16x16x32_bf16 v[220:223], v[124:127], v[100:103], v[220:223]
v_mfma_f32_16x16x32_bf16 v[184:187], v[120:123], v[100:103], v[184:187]
v_mfma_f32_16x16x32_bf16 v[188:191], v[120:123], v[104:107], v[188:191]
v_mfma_f32_16x16x32_bf16 v[224:227], v[124:127], v[104:107], v[224:227]
v_mfma_f32_16x16x32_bf16 v[152:155], v[116:119], v[104:107], v[152:155]
v_mfma_f32_16x16x32_bf16 v[156:159], v[116:119], v[108:111], v[156:159]
v_mfma_f32_16x16x32_bf16 v[228:231], v[124:127], v[108:111], v[228:231]
v_mfma_f32_16x16x32_bf16 v[192:195], v[120:123], v[108:111], v[192:195]
v_mfma_f32_16x16x32_bf16 v[196:199], v[120:123], v[112:115], v[196:199]
v_mfma_f32_16x16x32_bf16 v[232:235], v[124:127], v[112:115], v[232:235]
v_mfma_f32_16x16x32_bf16 v[160:163], v[116:119], v[112:115], v[160:163]
s_sub_u32 s41, s41, 1
s_cmp_lg_u32 s41, 0
s_cbranch_scc1 Lcl_13
s_waitcnt lgkmcnt(0)
v_mfma_f32_16x16x32_bf16 v[164:167], v[72:75], v[32:35], v[164:167]
ds_read_b128 v[80:83], v3 offset:0
v_mfma_f32_16x16x32_bf16 v[200:203], v[76:79], v[32:35], v[200:203]
ds_read_b64_tr_b16 v[120:121], v6 offset:12288
v_mfma_f32_16x16x32_bf16 v[128:131], v[68:71], v[32:35], v[128:131]
ds_read_b64_tr_b16 v[122:123], v6 offset:12800
v_mfma_f32_16x16x32_bf16 v[132:135], v[68:71], v[36:39], v[132:135]
ds_read_b64_tr_b16 v[124:125], v6 offset:20480
v_mfma_f32_16x16x32_bf16 v[204:207], v[76:79], v[36:39], v[204:207]
ds_read_b64_tr_b16 v[126:127], v6 offset:20992
v_mfma_f32_16x16x32_bf16 v[168:171], v[72:75], v[36:39], v[168:171]
ds_read_b64_tr_b16 v[116:117], v6 offset:4096
v_mfma_f32_16x16x32_bf16 v[172:175], v[72:75], v[40:43], v[172:175]
ds_read_b64_tr_b16 v[118:119], v6 offset:4608
v_mfma_f32_16x16x32_bf16 v[208:211], v[76:79], v[40:43], v[208:211]
ds_read_b128 v[84:87], v3 offset:2048
v_mfma_f32_16x16x32_bf16 v[136:139], v[68:71], v[40:43], v[136:139]
ds_read_b128 v[88:91], v3 offset:4096
v_mfma_f32_16x16x32_bf16 v[140:143], v[68:71], v[44:47], v[140:143]
ds_read_b128 v[92:95], v3 offset:6144
v_mfma_f32_16x16x32_bf16 v[212:215], v[76:79], v[44:47], v[212:215]
ds_read_b128 v[96:99], v3 offset:8192
v_mfma_f32_16x16x32_bf16 v[176:179], v[72:75], v[44:47], v[176:179]
ds_read_b128 v[100:103], v3 offset:10240
v_mfma_f32_16x16x32_bf16 v[180:183], v[72:75], v[48:51], v[180:183]
ds_read_b128 v[104:107], v3 offset:12288
v_mfma_f32_16x16x32_bf16 v[216:219], v[76:79], v[48:51], v[216:219]
ds_read_b128 v[108:111], v3 offset:14336
v_mfma_f32_16x16x32_bf16 v[144:147], v[68:71], v[48:51], v[144:147]
ds_read_b128 v[112:115], v3 offset:16384
v_mfma_f32_16x16x32_bf16 v[148:151], v[68:71], v[52:55], v[148:151]
v_mfma_f32_16x16x32_bf16 v[220:223], v[76:79], v[52:55], v[220:223]
v_mfma_f32_16x16x32_bf16 v[184:187], v[72:75], v[52:55], v[184:187]
v_mfma_f32_16x16x32_bf16 v[188:191], v[72:75], v[56:59], v[188:191]
v_mfma_f32_16x16x32_bf16 v[224:227], v[76:79], v[56:59], v[224:227]
v_mfma_f32_16x16x32_bf16 v[152:155], v[68:71], v[56:59], v[152:155]
v_mfma_f32_16x16x32_bf16 v[156:159], v[68:71], v[60:63], v[156:159]
v_mfma_f32_16x16x32_bf16 v[228:231], v[76:79], v[60:63], v[228:231]
v_mfma_f32_16x16x32_bf16 v[192:195], v[72:75], v[60:63], v[192:195]
v_mfma_f32_16x16x32_bf16 v[196:199], v[72:75], v[64:67], v[196:199]
v_mfma_f32_16x16x32_bf16 v[232:235], v[76:79], v[64:67], v[232:235]
v_mfma_f32_16x16x32_bf16 v[160:163], v[68:71], v[64:67], v[160:163]
s_waitcnt lgkmcnt(0)
v_mfma_f32_16x16x32_bf16 v[164:167], v[120:123], v[80:83], v[164:167]
v_mfma_f32_16x16x32_bf16 v[200:203], v[124:127], v[80:83], v[200:203]
v_mfma_f32_16x16x32_bf16 v[128:131], v[116:119], v[80:83], v[128:131]
v_mfma_f32_16x16x32_bf16 v[132:135], v[116:119], v[84:87], v[132:135]
v_mfma_f32_16x16x32_bf16 v[204:207], v[124:127], v[84:87], v[204:207]
v_mfma_f32_16x16x32_bf16 v[168:171], v[120:123], v[84:87], v[168:171]
v_mfma_f32_16x16x32_bf16 v[172:175], v[120:123], v[88:91], v[172:175]
v_mfma_f32_16x16x32_bf16 v[208:211], v[124:127], v[88:91], v[208:211]
v_mfma_f32_16x16x32_bf16 v[136:139], v[116:119], v[88:91], v[136:139]
v_mfma_f32_16x16x32_bf16 v[140:143], v[116:119], v[92:95], v[140:143]
s_branch Lov_2
.p2align 12
Lst_2_0:
s_branch Lst_6_0
s_nop 0
Lov_2:
v_mfma_f32_16x16x32_bf16 v[212:215], v[124:127], v[92:95], v[212:215]
v_mfma_f32_16x16x32_bf16 v[176:179], v[120:123], v[92:95], v[176:179]
v_mfma_f32_16x16x32_bf16 v[180:183], v[120:123], v[96:99], v[180:183]
v_mfma_f32_16x16x32_bf16 v[216:219], v[124:127], v[96:99], v[216:219]
v_mfma_f32_16x16x32_bf16 v[144:147], v[116:119], v[96:99], v[144:147]
v_mfma_f32_16x16x32_bf16 v[148:151], v[116:119], v[100:103], v[148:151]
v_mfma_f32_16x16x32_bf16 v[220:223], v[124:127], v[100:103], v[220:223]
v_mfma_f32_16x16x32_bf16 v[184:187], v[120:123], v[100:103], v[184:187]
v_mfma_f32_16x16x32_bf16 v[188:191], v[120:123], v[104:107], v[188:191]
v_mfma_f32_16x16x32_bf16 v[224:227], v[124:127], v[104:107], v[224:227]
v_mfma_f32_16x16x32_bf16 v[152:155], v[116:119], v[104:107], v[152:155]
v_mfma_f32_16x16x32_bf16 v[156:159], v[116:119], v[108:111], v[156:159]
v_mfma_f32_16x16x32_bf16 v[228:231], v[124:127], v[108:111], v[228:231]
v_mfma_f32_16x16x32_bf16 v[192:195], v[120:123], v[108:111], v[192:195]
v_mfma_f32_16x16x32_bf16 v[196:199], v[120:123], v[112:115], v[196:199]
v_mfma_f32_16x16x32_bf16 v[232:235], v[124:127], v[112:115], v[232:235]
v_mfma_f32_16x16x32_bf16 v[160:163], v[116:119], v[112:115], v[160:163]
v_lshlrev_b32 v14, 3, v12
v_add_u32 v14, 147456, v14
v_mul_u32_u24 v15, 400, v12
v_lshl_add_u32 v15, v13, 3, v15
s_lshl_b32 s43, s36, 5
v_add_u32 v15, s43, v15
s_barrier
ds_read_b64 v[32:33], v14 offset:0
ds_read_b64 v[34:35], v14 offset:128
ds_read_b64 v[36:37], v14 offset:256
ds_read_b64 v[38:39], v14 offset:384
ds_read_b64 v[40:41], v14 offset:512
ds_read_b64 v[42:43], v14 offset:640
ds_read_b64 v[44:45], v14 offset:768
ds_read_b64 v[46:47], v14 offset:896
ds_read_b64 v[48:49], v14 offset:1024
v_mov_b32_dpp v52, v128 row_newbcast:0 row_mask:0xf bank_mask:0xf
v_mov_b32_dpp v53, v129 row_newbcast:0 row_mask:0xf bank_mask:0xf
v_mov_b32_dpp v54, v130 row_newbcast:0 row_mask:0xf bank_mask:0xf
v_mov_b32_dpp v55, v131 row_newbcast:0 row_mask:0xf bank_mask:0xf
v_mov_b32_dpp v56, v164 row_newbcast:0 row_mask:0xf bank_mask:0xf
v_mov_b32_dpp v57, v165 row_newbcast:0 row_mask:0xf bank_mask:0xf
v_mov_b32_dpp v58, v166 row_newbcast:0 row_mask:0xf bank_mask:0xf
v_mov_b32_dpp v59, v167 row_newbcast:0 row_mask:0xf bank_mask:0xf
v_mov_b32_dpp v60, v200 row_newbcast:0 row_mask:0xf bank_mask:0xf
v_mov_b32_dpp v61, v201 row_newbcast:0 row_mask:0xf bank_mask:0xf
v_mov_b32_dpp v62, v202 row_newbcast:0 row_mask:0xf bank_mask:0xf
v_mov_b32_dpp v63, v203 row_newbcast:0 row_mask:0xf bank_mask:0xf
s_waitcnt lgkmcnt(0)
v_pk_fma_f32 v[164:165], v[32:33], v[56:57], v[164:165] op_sel_hi:[0,1,1] neg_lo:[1,0,0] neg_hi:[1,0,0]
v_pk_fma_f32 v[166:167], v[32:33], v[58:59], v[166:167] op_sel_hi:[0,1,1] neg_lo:[1,0,0] neg_hi:[1,0,0]
v_pk_fma_f32 v[200:201], v[32:33], v[60:61], v[200:201] op_sel_hi:[0,1,1] neg_lo:[1,0,0] neg_hi:[1,0,0]
v_pk_fma_f32 v[202:203], v[32:33], v[62:63], v[202:203] op_sel_hi:[0,1,1] neg_lo:[1,0,0] neg_hi:[1,0,0]
v_pk_mul_f32 v[164:165], v[32:33], v[164:165] op_sel:[1,0] op_sel_hi:[1,1]
v_pk_mul_f32 v[166:167], v[32:33], v[166:167] op_sel:[1,0] op_sel_hi:[1,1]
v_pk_fma_f32 v[132:133], v[34:35], v[52:53], v[132:133] op_sel_hi:[0,1,1] neg_lo:[1,0,0] neg_hi:[1,0,0]
v_pk_fma_f32 v[134:135], v[34:35], v[54:55], v[134:135] op_sel_hi:[0,1,1] neg_lo:[1,0,0] neg_hi:[1,0,0]
v_pk_mul_f32 v[200:201], v[32:33], v[200:201] op_sel:[1,0] op_sel_hi:[1,1]
v_pk_mul_f32 v[202:203], v[32:33], v[202:203] op_sel:[1,0] op_sel_hi:[1,1]
v_cvt_pk_bf16_f32 v164, v164, v165
v_cvt_pk_bf16_f32 v165, v166, v167
ds_write_b64 v15, v[164:165] offset:128
v_pk_fma_f32 v[168:169], v[34:35], v[56:57], v[168:169] op_sel_hi:[0,1,1] neg_lo:[1,0,0] neg_hi:[1,0,0]
v_pk_fma_f32 v[170:171], v[34:35], v[58:59], v[170:171] op_sel_hi:[0,1,1] neg_lo:[1,0,0] neg_hi:[1,0,0]
v_pk_mul_f32 v[132:133], v[34:35], v[132:133] op_sel:[1,0] op_sel_hi:[1,1]
v_pk_mul_f32 v[134:135], v[34:35], v[134:135] op_sel:[1,0] op_sel_hi:[1,1]
v_cvt_pk_bf16_f32 v200, v200, v201
v_cvt_pk_bf16_f32 v201, v202, v203
ds_write_b64 v15, v[200:201] offset:256
v_pk_fma_f32 v[204:205], v[34:35], v[60:61], v[204:205] op_sel_hi:[0,1,1] neg_lo:[1,0,0] neg_hi:[1,0,0]
v_pk_fma_f32 v[206:207], v[34:35], v[62:63], v[206:207] op_sel_hi:[0,1,1] neg_lo:[1,0,0] neg_hi:[1,0,0]
v_pk_mul_f32 v[168:169], v[34:35], v[168:169] op_sel:[1,0] op_sel_hi:[1,1]
v_pk_mul_f32 v[170:171], v[34:35], v[170:171] op_sel:[1,0] op_sel_hi:[1,1]
v_cvt_pk_bf16_f32 v132, v132, v133
v_cvt_pk_bf16_f32 v133, v134, v135
ds_write_b64 v15, v[132:133] offset:6400
v_pk_fma_f32 v[136:137], v[36:37], v[52:53], v[136:137] op_sel_hi:[0,1,1] neg_lo:[1,0,0] neg_hi:[1,0,0]
v_pk_fma_f32 v[138:139], v[36:37], v[54:55], v[138:139] op_sel_hi:[0,1,1] neg_lo:[1,0,0] neg_hi:[1,0,0]
v_pk_mul_f32 v[204:205], v[34:35], v[204:205] op_sel:[1,0] op_sel_hi:[1,1]
v_pk_mul_f32 v[206:207], v[34:35], v[206:207] op_sel:[1,0] op_sel_hi:[1,1]
v_cvt_pk_bf16_f32 v168, v168, v169
v_cvt_pk_bf16_f32 v169, v170, v171
ds_write_b64 v15, v[168:169] offset:6528
v_pk_fma_f32 v[172:173], v[36:37], v[56:57], v[172:173] op_sel_hi:[0,1,1] neg_lo:[1,0,0] neg_hi:[1,0,0]
v_pk_fma_f32 v[174:175], v[36:37], v[58:59], v[174:175] op_sel_hi:[0,1,1] neg_lo:[1,0,0] neg_hi:[1,0,0]
v_pk_mul_f32 v[136:137], v[36:37], v[136:137] op_sel:[1,0] op_sel_hi:[1,1]
v_pk_mul_f32 v[138:139], v[36:37], v[138:139] op_sel:[1,0] op_sel_hi:[1,1]
v_cvt_pk_bf16_f32 v204, v204, v205
v_cvt_pk_bf16_f32 v205, v206, v207
ds_write_b64 v15, v[204:205] offset:6656
v_pk_fma_f32 v[208:209], v[36:37], v[60:61], v[208:209] op_sel_hi:[0,1,1] neg_lo:[1,0,0] neg_hi:[1,0,0]
v_pk_fma_f32 v[210:211], v[36:37], v[62:63], v[210:211] op_sel_hi:[0,1,1] neg_lo:[1,0,0] neg_hi:[1,0,0]
v_pk_mul_f32 v[172:173], v[36:37], v[172:173] op_sel:[1,0] op_sel_hi:[1,1]
v_pk_mul_f32 v[174:175], v[36:37], v[174:175] op_sel:[1,0] op_sel_hi:[1,1]
v_cvt_pk_bf16_f32 v136, v136, v137
v_cvt_pk_bf16_f32 v137, v138, v139
ds_write_b64 v15, v[136:137] offset:12800
v_pk_fma_f32 v[140:141], v[38:39], v[52:53], v[140:141] op_sel_hi:[0,1,1] neg_lo:[1,0,0] neg_hi:[1,0,0]
v_pk_fma_f32 v[142:143], v[38:39], v[54:55], v[142:143] op_sel_hi:[0,1,1] neg_lo:[1,0,0] neg_hi:[1,0,0]
v_pk_mul_f32 v[208:209], v[36:37], v[208:209] op_sel:[1,0] op_sel_hi:[1,1]
v_pk_mul_f32 v[210:211], v[36:37], v[210:211] op_sel:[1,0] op_sel_hi:[1,1]
v_cvt_pk_bf16_f32 v172, v172, v173
v_cvt_pk_bf16_f32 v173, v174, v175
ds_write_b64 v15, v[172:173] offset:12928
v_pk_fma_f32 v[176:177], v[38:39], v[56:57], v[176:177] op_sel_hi:[0,1,1] neg_lo:[1,0,0] neg_hi:[1,0,0]
v_pk_fma_f32 v[178:179], v[38:39], v[58:59], v[178:179] op_sel_hi:[0,1,1] neg_lo:[1,0,0] neg_hi:[1,0,0]
v_pk_mul_f32 v[140:141], v[38:39], v[140:141] op_sel:[1,0] op_sel_hi:[1,1]
v_pk_mul_f32 v[142:143], v[38:39], v[142:143] op_sel:[1,0] op_sel_hi:[1,1]
v_cvt_pk_bf16_f32 v208, v208, v209
v_cvt_pk_bf16_f32 v209, v210, v211
ds_write_b64 v15, v[208:209] offset:13056
v_pk_fma_f32 v[212:213], v[38:39], v[60:61], v[212:213] op_sel_hi:[0,1,1] neg_lo:[1,0,0] neg_hi:[1,0,0]
v_pk_fma_f32 v[214:215], v[38:39], v[62:63], v[214:215] op_sel_hi:[0,1,1] neg_lo:[1,0,0] neg_hi:[1,0,0]
v_pk_mul_f32 v[176:177], v[38:39], v[176:177] op_sel:[1,0] op_sel_hi:[1,1]
v_pk_mul_f32 v[178:179], v[38:39], v[178:179] op_sel:[1,0] op_sel_hi:[1,1]
v_cvt_pk_bf16_f32 v140, v140, v141
v_cvt_pk_bf16_f32 v141, v142, v143
ds_write_b64 v15, v[140:141] offset:19200
v_pk_fma_f32 v[144:145], v[40:41], v[52:53], v[144:145] op_sel_hi:[0,1,1] neg_lo:[1,0,0] neg_hi:[1,0,0]
v_pk_fma_f32 v[146:147], v[40:41], v[54:55], v[146:147] op_sel_hi:[0,1,1] neg_lo:[1,0,0] neg_hi:[1,0,0]
v_pk_mul_f32 v[212:213], v[38:39], v[212:213] op_sel:[1,0] op_sel_hi:[1,1]
v_pk_mul_f32 v[214:215], v[38:39], v[214:215] op_sel:[1,0] op_sel_hi:[1,1]
v_cvt_pk_bf16_f32 v176, v176, v177
v_cvt_pk_bf16_f32 v177, v178, v179
ds_write_b64 v15, v[176:177] offset:19328
v_pk_fma_f32 v[180:181], v[40:41], v[56:57], v[180:181] op_sel_hi:[0,1,1] neg_lo:[1,0,0] neg_hi:[1,0,0]
v_pk_fma_f32 v[182:183], v[40:41], v[58:59], v[182:183] op_sel_hi:[0,1,1] neg_lo:[1,0,0] neg_hi:[1,0,0]
v_pk_mul_f32 v[144:145], v[40:41], v[144:145] op_sel:[1,0] op_sel_hi:[1,1]
v_pk_mul_f32 v[146:147], v[40:41], v[146:147] op_sel:[1,0] op_sel_hi:[1,1]
v_cvt_pk_bf16_f32 v212, v212, v213
v_cvt_pk_bf16_f32 v213, v214, v215
ds_write_b64 v15, v[212:213] offset:19456
v_pk_fma_f32 v[216:217], v[40:41], v[60:61], v[216:217] op_sel_hi:[0,1,1] neg_lo:[1,0,0] neg_hi:[1,0,0]
v_pk_fma_f32 v[218:219], v[40:41], v[62:63], v[218:219] op_sel_hi:[0,1,1] neg_lo:[1,0,0] neg_hi:[1,0,0]
v_pk_mul_f32 v[180:181], v[40:41], v[180:181] op_sel:[1,0] op_sel_hi:[1,1]
v_pk_mul_f32 v[182:183], v[40:41], v[182:183] op_sel:[1,0] op_sel_hi:[1,1]
v_cvt_pk_bf16_f32 v144, v144, v145
v_cvt_pk_bf16_f32 v145, v146, v147
ds_write_b64 v15, v[144:145] offset:25600
v_pk_fma_f32 v[148:149], v[42:43], v[52:53], v[148:149] op_sel_hi:[0,1,1] neg_lo:[1,0,0] neg_hi:[1,0,0]
v_pk_fma_f32 v[150:151], v[42:43], v[54:55], v[150:151] op_sel_hi:[0,1,1] neg_lo:[1,0,0] neg_hi:[1,0,0]
v_pk_mul_f32 v[216:217], v[40:41], v[216:217] op_sel:[1,0] op_sel_hi:[1,1]
v_pk_mul_f32 v[218:219], v[40:41], v[218:219] op_sel:[1,0] op_sel_hi:[1,1]
v_cvt_pk_bf16_f32 v180, v180, v181
v_cvt_pk_bf16_f32 v181, v182, v183
ds_write_b64 v15, v[180:181] offset:25728
v_pk_fma_f32 v[184:185], v[42:43], v[56:57], v[184:185] op_sel_hi:[0,1,1] neg_lo:[1,0,0] neg_hi:[1,0,0]
v_pk_fma_f32 v[186:187], v[42:43], v[58:59], v[186:187] op_sel_hi:[0,1,1] neg_lo:[1,0,0] neg_hi:[1,0,0]
v_pk_mul_f32 v[148:149], v[42:43], v[148:149] op_sel:[1,0] op_sel_hi:[1,1]
v_pk_mul_f32 v[150:151], v[42:43], v[150:151] op_sel:[1,0] op_sel_hi:[1,1]
v_cvt_pk_bf16_f32 v216, v216, v217
v_cvt_pk_bf16_f32 v217, v218, v219
ds_write_b64 v15, v[216:217] offset:25856
v_pk_fma_f32 v[220:221], v[42:43], v[60:61], v[220:221] op_sel_hi:[0,1,1] neg_lo:[1,0,0] neg_hi:[1,0,0]
v_pk_fma_f32 v[222:223], v[42:43], v[62:63], v[222:223] op_sel_hi:[0,1,1] neg_lo:[1,0,0] neg_hi:[1,0,0]
v_pk_mul_f32 v[184:185], v[42:43], v[184:185] op_sel:[1,0] op_sel_hi:[1,1]
v_pk_mul_f32 v[186:187], v[42:43], v[186:187] op_sel:[1,0] op_sel_hi:[1,1]
v_cvt_pk_bf16_f32 v148, v148, v149
v_cvt_pk_bf16_f32 v149, v150, v151
ds_write_b64 v15, v[148:149] offset:32000
v_pk_fma_f32 v[152:153], v[44:45], v[52:53], v[152:153] op_sel_hi:[0,1,1] neg_lo:[1,0,0] neg_hi:[1,0,0]
v_pk_fma_f32 v[154:155], v[44:45], v[54:55], v[154:155] op_sel_hi:[0,1,1] neg_lo:[1,0,0] neg_hi:[1,0,0]
v_pk_mul_f32 v[220:221], v[42:43], v[220:221] op_sel:[1,0] op_sel_hi:[1,1]
v_pk_mul_f32 v[222:223], v[42:43], v[222:223] op_sel:[1,0] op_sel_hi:[1,1]
v_cvt_pk_bf16_f32 v184, v184, v185
v_cvt_pk_bf16_f32 v185, v186, v187
ds_write_b64 v15, v[184:185] offset:32128
v_pk_fma_f32 v[188:189], v[44:45], v[56:57], v[188:189] op_sel_hi:[0,1,1] neg_lo:[1,0,0] neg_hi:[1,0,0]
v_pk_fma_f32 v[190:191], v[44:45], v[58:59], v[190:191] op_sel_hi:[0,1,1] neg_lo:[1,0,0] neg_hi:[1,0,0]
v_pk_mul_f32 v[152:153], v[44:45], v[152:153] op_sel:[1,0] op_sel_hi:[1,1]
v_pk_mul_f32 v[154:155], v[44:45], v[154:155] op_sel:[1,0] op_sel_hi:[1,1]
v_cvt_pk_bf16_f32 v220, v220, v221
v_cvt_pk_bf16_f32 v221, v222, v223
ds_write_b64 v15, v[220:221] offset:32256
v_pk_fma_f32 v[224:225], v[44:45], v[60:61], v[224:225] op_sel_hi:[0,1,1] neg_lo:[1,0,0] neg_hi:[1,0,0]
v_pk_fma_f32 v[226:227], v[44:45], v[62:63], v[226:227] op_sel_hi:[0,1,1] neg_lo:[1,0,0] neg_hi:[1,0,0]
v_pk_mul_f32 v[188:189], v[44:45], v[188:189] op_sel:[1,0] op_sel_hi:[1,1]
v_pk_mul_f32 v[190:191], v[44:45], v[190:191] op_sel:[1,0] op_sel_hi:[1,1]
v_cvt_pk_bf16_f32 v152, v152, v153
v_cvt_pk_bf16_f32 v153, v154, v155
ds_write_b64 v15, v[152:153] offset:38400
v_pk_fma_f32 v[156:157], v[46:47], v[52:53], v[156:157] op_sel_hi:[0,1,1] neg_lo:[1,0,0] neg_hi:[1,0,0]
v_pk_fma_f32 v[158:159], v[46:47], v[54:55], v[158:159] op_sel_hi:[0,1,1] neg_lo:[1,0,0] neg_hi:[1,0,0]
v_pk_mul_f32 v[224:225], v[44:45], v[224:225] op_sel:[1,0] op_sel_hi:[1,1]
v_pk_mul_f32 v[226:227], v[44:45], v[226:227] op_sel:[1,0] op_sel_hi:[1,1]
v_cvt_pk_bf16_f32 v188, v188, v189
v_cvt_pk_bf16_f32 v189, v190, v191
ds_write_b64 v15, v[188:189] offset:38528
v_pk_fma_f32 v[192:193], v[46:47], v[56:57], v[192:193] op_sel_hi:[0,1,1] neg_lo:[1,0,0] neg_hi:[1,0,0]
v_pk_fma_f32 v[194:195], v[46:47], v[58:59], v[194:195] op_sel_hi:[0,1,1] neg_lo:[1,0,0] neg_hi:[1,0,0]
v_pk_mul_f32 v[156:157], v[46:47], v[156:157] op_sel:[1,0] op_sel_hi:[1,1]
v_pk_mul_f32 v[158:159], v[46:47], v[158:159] op_sel:[1,0] op_sel_hi:[1,1]
v_cvt_pk_bf16_f32 v224, v224, v225
v_cvt_pk_bf16_f32 v225, v226, v227
ds_write_b64 v15, v[224:225] offset:38656
v_pk_fma_f32 v[228:229], v[46:47], v[60:61], v[228:229] op_sel_hi:[0,1,1] neg_lo:[1,0,0] neg_hi:[1,0,0]
v_pk_fma_f32 v[230:231], v[46:47], v[62:63], v[230:231] op_sel_hi:[0,1,1] neg_lo:[1,0,0] neg_hi:[1,0,0]
v_pk_mul_f32 v[192:193], v[46:47], v[192:193] op_sel:[1,0] op_sel_hi:[1,1]
v_pk_mul_f32 v[194:195], v[46:47], v[194:195] op_sel:[1,0] op_sel_hi:[1,1]
v_cvt_pk_bf16_f32 v156, v156, v157
v_cvt_pk_bf16_f32 v157, v158, v159
ds_write_b64 v15, v[156:157] offset:44800
v_pk_fma_f32 v[160:161], v[48:49], v[52:53], v[160:161] op_sel_hi:[0,1,1] neg_lo:[1,0,0] neg_hi:[1,0,0]
v_pk_fma_f32 v[162:163], v[48:49], v[54:55], v[162:163] op_sel_hi:[0,1,1] neg_lo:[1,0,0] neg_hi:[1,0,0]
v_pk_mul_f32 v[228:229], v[46:47], v[228:229] op_sel:[1,0] op_sel_hi:[1,1]
v_pk_mul_f32 v[230:231], v[46:47], v[230:231] op_sel:[1,0] op_sel_hi:[1,1]
v_cvt_pk_bf16_f32 v192, v192, v193
v_cvt_pk_bf16_f32 v193, v194, v195
ds_write_b64 v15, v[192:193] offset:44928
v_pk_fma_f32 v[196:197], v[48:49], v[56:57], v[196:197] op_sel_hi:[0,1,1] neg_lo:[1,0,0] neg_hi:[1,0,0]
v_pk_fma_f32 v[198:199], v[48:49], v[58:59], v[198:199] op_sel_hi:[0,1,1] neg_lo:[1,0,0] neg_hi:[1,0,0]
v_pk_mul_f32 v[160:161], v[48:49], v[160:161] op_sel:[1,0] op_sel_hi:[1,1]
v_pk_mul_f32 v[162:163], v[48:49], v[162:163] op_sel:[1,0] op_sel_hi:[1,1]
v_cvt_pk_bf16_f32 v228, v228, v229
v_cvt_pk_bf16_f32 v229, v230, v231
ds_write_b64 v15, v[228:229] offset:45056
v_pk_fma_f32 v[232:233], v[48:49], v[60:61], v[232:233] op_sel_hi:[0,1,1] neg_lo:[1,0,0] neg_hi:[1,0,0]
v_pk_fma_f32 v[234:235], v[48:49], v[62:63], v[234:235] op_sel_hi:[0,1,1] neg_lo:[1,0,0] neg_hi:[1,0,0]
v_pk_mul_f32 v[196:197], v[48:49], v[196:197] op_sel:[1,0] op_sel_hi:[1,1]
v_pk_mul_f32 v[198:199], v[48:49], v[198:199] op_sel:[1,0] op_sel_hi:[1,1]
v_cvt_pk_bf16_f32 v160, v160, v161
v_cvt_pk_bf16_f32 v161, v162, v163
ds_write_b64 v15, v[160:161] offset:51200
v_pk_mul_f32 v[232:233], v[48:49], v[232:233] op_sel:[1,0] op_sel_hi:[1,1]
v_pk_mul_f32 v[234:235], v[48:49], v[234:235] op_sel:[1,0] op_sel_hi:[1,1]
v_cvt_pk_bf16_f32 v196, v196, v197
v_cvt_pk_bf16_f32 v197, v198, v199
ds_write_b64 v15, v[196:197] offset:51328
v_cvt_pk_bf16_f32 v232, v232, v233
v_cvt_pk_bf16_f32 v233, v234, v235
ds_write_b64 v15, v[232:233] offset:51456
s_waitcnt lgkmcnt(0)
s_branch Latt_5
Lpf_4:
s_lshl_b32 s43, s35, 7
s_waitcnt lgkmcnt(0)
s_mov_b32 s8, s64
s_mov_b32 s9, s65
s_mov_b32 s10, 4194304
s_mov_b32 s11, 0x20000
s_add_u32 s12, s66, s43
s_addc_u32 s13, s67, 0
s_mov_b32 s14, 6289536
s_mov_b32 s15, 0x20000
s_add_u32 s84, s82, 28311552
s_addc_u32 s85, s83, 0
s_mov_b32 s86, 49152
s_mov_b32 s87, 0x20000
s_mov_b32 s56, s80
s_mov_b32 s57, s81
s_mov_b32 s58, 256
s_mov_b32 s59, 0x20000
v_mov_b32 v5, 0
v_lshlrev_b32 v14, 7, v1
s_or_b32 s43, s34, s35
s_cmp_lg_u32 s43, 0
s_cbranch_scc1 Lz_14
s_movk_i32 s43, 0x2000
buffer_store_dword v5, v14, s[84:87], 0 offen sc1
s_bfm_b64 exec, 44, 0
buffer_store_dword v5, v14, s[84:87], s43 offen sc1
s_mov_b64 exec, 1
v_mov_b32 v6, 1
s_waitcnt vmcnt(0)
buffer_store_dword v6, v5, s[56:59], 0 offen sc1
s_mov_b64 exec, -1
Lz_14:
s_lshl_b32 s43, s51, 11
buffer_load_dwordx4 v[96:99], v10, s[8:11], s43 offen offset:0
buffer_load_dwordx4 v[100:103], v10, s[8:11], s43 offen offset:1024
buffer_load_dwordx4 v[104:107], v10, s[8:11], s43 offen offset:2048
buffer_load_dwordx4 v[108:111], v10, s[8:11], s43 offen offset:3072
v_min_u32 v14, 23, v1
v_lshrrev_b32 v15, 3, v14
v_mul_u32_u24 v15, 43008, v15
v_and_b32 v14, 7, v14
v_lshl_add_u32 v15, v14, 4, v15
v_mov_b32 v32, 0x3f803f80
v_mov_b32 v33, 0x3f803f80
v_mov_b32 v34, 0x3f803f80
v_mov_b32 v35, 0x3f803f80
ds_write_b128 v15, v[32:35]
s_add_u32 s20, s82, 26214400
s_addc_u32 s21, s83, 0
s_mov_b32 s22, 16384
s_mov_b32 s23, 0x20000
s_add_u32 s43, s2, 128
s_lshl_b32 s43, s43, 7
v_lshlrev_b32 v14, 2, v1
s_mov_b64 exec, 15
buffer_store_dword v5, v14, s[84:87], s43 offen sc1
s_mov_b64 exec, -1
s_lshl_b32 s52, s34, 7
s_add_u32 s52, s52, 28319744
s_sub_u32 s53, s52, 128
s_cmp_eq_u32 s34, 0
s_cselect_b32 s53, s52, s53
s_waitcnt lgkmcnt(0)
s_barrier
s_waitcnt vmcnt(1)
s_mov_b32 s43, 0x3f803f80
v_mov_b32 v116, 0
v_mov_b32 v117, 0
v_mov_b32 v118, 0
v_mov_b32 v119, 0
v_mov_b32 v120, 0
v_mov_b32 v121, 0
v_mov_b32 v122, 0
v_mov_b32 v123, 0
v_dot2_f32_bf16 v116, v96, s43, v116
v_dot2_f32_bf16 v120, v96, v96, v120
v_dot2_f32_bf16 v118, v104, s43, v118
v_dot2_f32_bf16 v122, v104, v104, v122
v_dot2_f32_bf16 v117, v97, s43, v117
v_dot2_f32_bf16 v121, v97, v97, v121
v_dot2_f32_bf16 v119, v105, s43, v119
v_dot2_f32_bf16 v123, v105, v105, v123
v_dot2_f32_bf16 v116, v98, s43, v116
v_dot2_f32_bf16 v120, v98, v98, v120
v_dot2_f32_bf16 v118, v106, s43, v118
v_dot2_f32_bf16 v122, v106, v106, v122
v_dot2_f32_bf16 v117, v99, s43, v117
v_dot2_f32_bf16 v121, v99, v99, v121
v_dot2_f32_bf16 v119, v107, s43, v119
v_dot2_f32_bf16 v123, v107, v107, v123
v_dot2_f32_bf16 v116, v100, s43, v116
v_dot2_f32_bf16 v120, v100, v100, v120
v_dot2_f32_bf16 v118, v108, s43, v118
v_dot2_f32_bf16 v122, v108, v108, v122
v_dot2_f32_bf16 v117, v101, s43, v117
v_dot2_f32_bf16 v121, v101, v101, v121
v_dot2_f32_bf16 v119, v109, s43, v119
v_dot2_f32_bf16 v123, v109, v109, v123
v_dot2_f32_bf16 v116, v102, s43, v116
v_dot2_f32_bf16 v120, v102, v102, v120
v_dot2_f32_bf16 v118, v110, s43, v118
v_dot2_f32_bf16 v122, v110, v110, v122
v_dot2_f32_bf16 v117, v103, s43, v117
v_dot2_f32_bf16 v121, v103, v103, v121
v_dot2_f32_bf16 v119, v111, s43, v119
v_dot2_f32_bf16 v123, v111, v111, v123
s_nop 2
v_add_f32 v116, v116, v117
v_add_f32 v118, v118, v119
v_add_f32 v120, v120, v121
v_add_f32 v122, v122, v123
s_nop 1
v_permlane32_swap_b32 v116, v118
v_permlane32_swap_b32 v120, v122
v_add_f32 v116, v116, v118
v_add_f32 v120, v120, v122
s_nop 1
v_permlane16_swap_b32 v116, v120
v_add_f32 v116, v116, v120
s_nop 1
v_add_f32_dpp v116, v116, v116 row_ror:8 row_mask:0xf bank_mask:0xf
s_nop 1
v_add_f32_dpp v116, v116, v116 row_ror:4 row_mask:0xf bank_mask:0xf
s_nop 1
v_add_f32_dpp v116, v116, v116 row_ror:2 row_mask:0xf bank_mask:0xf
s_nop 1
v_add_f32_dpp v116, v116, v116 row_ror:1 row_mask:0xf bank_mask:0xf
v_mov_b32 v117, v116
s_nop 1
v_permlane16_swap_b32 v116, v117
v_mul_f32 v112, 0x3a800000, v116
v_mul_f32 v113, 0x3a800000, v117
v_fma_f32 v113, -v112, v112, v113
v_max_f32 v113, 0, v113
v_add_f32 v113, 0x3727c5ac, v113
v_rsq_f32 v113, v113
v_lshrrev_b32 v11, 5, v1
s_lshl_b32 s43, s47, 4
s_add_u32 s43, s43, 148608
v_lshl_add_u32 v11, v11, 3, s43
ds_write_b64 v11, v[112:113]
s_waitcnt lgkmcnt(0)
s_mov_b32 s43, 3145728
buffer_load_dword v31, v19, s[12:15], s43 offen
s_mov_b32 s43, 3147776
buffer_load_dword v31, v19, s[12:15], s43 offen
s_mov_b32 s43, 3149824
buffer_load_dword v31, v19, s[12:15], s43 offen
s_lshl_b32 s43, s35, 7
s_add_u32 s28, s68, s43
s_addc_u32 s29, s69, 0
s_mov_b32 s30, 2095232
s_mov_b32 s31, 0x20000
v_and_b32 v29, 7, v1
v_lshrrev_b32 v30, 3, v1
v_lshl_add_u32 v29, v30, 6, v29
s_lshl_b32 s43, s48, 3
v_add_u32 v29, s43, v29
v_lshlrev_b32 v29, 11, v29
s_mov_b32 s43, 1048576
buffer_load_dword v30, v29, s[28:31], 0 offen
buffer_load_dword v30, v29, s[28:31], s43 offen
s_barrier
v_lshlrev_b32 v5, 4, v1
v_and_b32 v5, 63, v5
v_add_u32 v6, 148608, v5
ds_read_b128 v[112:115], v6
s_lshl_b32 s43, s63, 3
v_add_u32 v5, s43, v5
s_waitcnt lgkmcnt(0)
s_mov_b64 exec, 15
buffer_store_dwordx4 v[112:115], v5, s[20:23], 0 offen sc1
s_mov_b64 exec, -1
s_barrier
v_mov_b32 v4, 0
buffer_load_dword v6, v4, s[56:59], 0 offen sc1
s_mov_b32 s62, 0
s_barrier
s_cmp_eq_u32 s62, 3
s_cbranch_scc1 Lste_17
s_cmp_eq_u32 s62, 2
s_cbranch_scc1 Lst2_16
s_waitcnt lgkmcnt(0)
s_cmp_eq_u32 s62, 1
s_cbranch_scc1 Lst1_15
s_waitcnt vmcnt(0)
v_readfirstlane_b32 s54, v6
s_cmp_eq_u32 s54, 0
s_cbranch_scc0 Lrep_18
buffer_load_dword v6, v4, s[56:59], 0 offen sc1
s_branch Lste_17
Lrep_18:
s_add_u32 s7, s34, 64
s_lshl_b32 s7, s7, 7
v_mov_b32 v5, s7
v_mov_b32 v6, 1
s_mov_b64 exec, 1
buffer_atomic_add v6, v5, s[84:87], 0 offen sc1
s_mov_b64 exec, -1
s_mov_b32 s62, 1
s_load_dword s54, s[82:83], s52 glc
s_load_dword s55, s[82:83], s53 glc
s_branch Lste_17
Lst1_15:
s_and_b32 s54, s54, s55
s_cmp_eq_u32 s54, 16
s_cbranch_scc1 Lg_19
s_load_dword s54, s[82:83], s52 glc
s_load_dword s55, s[82:83], s53 glc
s_branch Lste_17
Lg_19:
v_add_u32 v5, 0, v1
v_min_u32 v5, 143, v5
v_lshlrev_b32 v20, 3, v5
v_add_u32 v5, s50, v5
v_max_i32 v5, 0, v5
v_lshlrev_b32 v5, 3, v5
buffer_load_dwordx2 v[32:33], v5, s[20:23], 0 offen sc1
v_add_u32 v5, 64, v1
v_min_u32 v5, 143, v5
v_lshlrev_b32 v21, 3, v5
v_add_u32 v5, s50, v5
v_max_i32 v5, 0, v5
v_lshlrev_b32 v5, 3, v5
buffer_load_dwordx2 v[34:35], v5, s[20:23], 0 offen sc1
v_add_u32 v5, 128, v1
v_min_u32 v5, 143, v5
v_lshlrev_b32 v22, 3, v5
v_add_u32 v5, s50, v5
v_max_i32 v5, 0, v5
v_lshlrev_b32 v5, 3, v5
buffer_load_dwordx2 v[36:37], v5, s[20:23], 0 offen sc1
s_mov_b32 s62, 2
s_branch Lste_17
Lst2_16:
s_waitcnt vmcnt(0)
v_add_u32 v20, 147456, v20
ds_write_b64 v20, v[32:33]
v_add_u32 v21, 147456, v21
ds_write_b64 v21, v[34:35]
v_add_u32 v22, 147456, v22
ds_write_b64 v22, v[36:37]
s_waitcnt lgkmcnt(0)
s_mov_b32 s62, 3
Lste_17:
s_barrier
s_cmp_eq_u32 s62, 3
s_cbranch_scc1 Lste_22
s_cmp_eq_u32 s62, 2
s_cbranch_scc1 Lst2_21
s_waitcnt lgkmcnt(0)
s_cmp_eq_u32 s62, 1
s_cbranch_scc1 Lst1_20
s_waitcnt vmcnt(0)
v_readfirstlane_b32 s54, v6
s_cmp_eq_u32 s54, 0
s_cbranch_scc0 Lrep_23
buffer_load_dword v6, v4, s[56:59], 0 offen sc1
s_branch Lste_22
Lrep_23:
s_add_u32 s7, s34, 64
s_lshl_b32 s7, s7, 7
v_mov_b32 v5, s7
v_mov_b32 v6, 1
s_mov_b64 exec, 1
buffer_atomic_add v6, v5, s[84:87], 0 offen sc1
s_mov_b64 exec, -1
s_mov_b32 s62, 1
s_load_dword s54, s[82:83], s52 glc
s_load_dword s55, s[82:83], s53 glc
s_branch Lste_22
Lst1_20:
s_and_b32 s54, s54, s55
s_cmp_eq_u32 s54, 16
s_cbranch_scc1 Lg_24
s_load_dword s54, s[82:83], s52 glc
s_load_dword s55, s[82:83], s53 glc
s_branch Lste_22
Lg_24:
v_add_u32 v5, 0, v1
v_min_u32 v5, 143, v5
v_lshlrev_b32 v20, 3, v5
v_add_u32 v5, s50, v5
v_max_i32 v5, 0, v5
v_lshlrev_b32 v5, 3, v5
buffer_load_dwordx2 v[32:33], v5, s[20:23], 0 offen sc1
v_add_u32 v5, 64, v1
v_min_u32 v5, 143, v5
v_lshlrev_b32 v21, 3, v5
v_add_u32 v5, s50, v5
v_max_i32 v5, 0, v5
v_lshlrev_b32 v5, 3, v5
buffer_load_dwordx2 v[34:35], v5, s[20:23], 0 offen sc1
v_add_u32 v5, 128, v1
v_min_u32 v5, 143, v5
v_lshlrev_b32 v22, 3, v5
v_add_u32 v5, s50, v5
v_max_i32 v5, 0, v5
v_lshlrev_b32 v5, 3, v5
buffer_load_dwordx2 v[36:37], v5, s[20:23], 0 offen sc1
s_mov_b32 s62, 2
s_branch Lste_22
Lst2_21:
s_waitcnt vmcnt(0)
v_add_u32 v20, 147456, v20
ds_write_b64 v20, v[32:33]
v_add_u32 v21, 147456, v21
ds_write_b64 v21, v[34:35]
v_add_u32 v22, 147456, v22
ds_write_b64 v22, v[36:37]
s_waitcnt lgkmcnt(0)
s_mov_b32 s62, 3
Lste_22:
s_barrier
s_cmp_eq_u32 s62, 3
s_cbranch_scc1 Lste_27
s_cmp_eq_u32 s62, 2
s_cbranch_scc1 Lst2_26
s_waitcnt lgkmcnt(0)
s_cmp_eq_u32 s62, 1
s_cbranch_scc1 Lst1_25
s_waitcnt vmcnt(0)
v_readfirstlane_b32 s54, v6
s_cmp_eq_u32 s54, 0
s_cbranch_scc0 Lrep_28
buffer_load_dword v6, v4, s[56:59], 0 offen sc1
s_branch Lste_27
Lrep_28:
s_add_u32 s7, s34, 64
s_lshl_b32 s7, s7, 7
v_mov_b32 v5, s7
v_mov_b32 v6, 1
s_mov_b64 exec, 1
buffer_atomic_add v6, v5, s[84:87], 0 offen sc1
s_mov_b64 exec, -1
s_mov_b32 s62, 1
s_load_dword s54, s[82:83], s52 glc
s_load_dword s55, s[82:83], s53 glc
s_branch Lste_27
Lst1_25:
s_and_b32 s54, s54, s55
s_cmp_eq_u32 s54, 16
s_cbranch_scc1 Lg_29
s_load_dword s54, s[82:83], s52 glc
s_load_dword s55, s[82:83], s53 glc
s_branch Lste_27
Lg_29:
v_add_u32 v5, 0, v1
v_min_u32 v5, 143, v5
v_lshlrev_b32 v20, 3, v5
v_add_u32 v5, s50, v5
v_max_i32 v5, 0, v5
v_lshlrev_b32 v5, 3, v5
buffer_load_dwordx2 v[32:33], v5, s[20:23], 0 offen sc1
v_add_u32 v5, 64, v1
v_min_u32 v5, 143, v5
v_lshlrev_b32 v21, 3, v5
v_add_u32 v5, s50, v5
v_max_i32 v5, 0, v5
v_lshlrev_b32 v5, 3, v5
buffer_load_dwordx2 v[34:35], v5, s[20:23], 0 offen sc1
v_add_u32 v5, 128, v1
v_min_u32 v5, 143, v5
v_lshlrev_b32 v22, 3, v5
v_add_u32 v5, s50, v5
v_max_i32 v5, 0, v5
v_lshlrev_b32 v5, 3, v5
buffer_load_dwordx2 v[36:37], v5, s[20:23], 0 offen sc1
s_mov_b32 s62, 2
s_branch Lste_27
Lst2_26:
s_waitcnt vmcnt(0)
v_add_u32 v20, 147456, v20
ds_write_b64 v20, v[32:33]
v_add_u32 v21, 147456, v21
ds_write_b64 v21, v[34:35]
v_add_u32 v22, 147456, v22
ds_write_b64 v22, v[36:37]
s_waitcnt lgkmcnt(0)
s_mov_b32 s62, 3
Lste_27:
s_barrier
s_cmp_eq_u32 s62, 3
s_cbranch_scc1 Lste_32
s_cmp_eq_u32 s62, 2
s_cbranch_scc1 Lst2_31
s_waitcnt lgkmcnt(0)
s_cmp_eq_u32 s62, 1
s_cbranch_scc1 Lst1_30
s_waitcnt vmcnt(0)
v_readfirstlane_b32 s54, v6
s_cmp_eq_u32 s54, 0
s_cbranch_scc0 Lrep_33
buffer_load_dword v6, v4, s[56:59], 0 offen sc1
s_branch Lste_32
Lrep_33:
s_add_u32 s7, s34, 64
s_lshl_b32 s7, s7, 7
v_mov_b32 v5, s7
v_mov_b32 v6, 1
s_mov_b64 exec, 1
buffer_atomic_add v6, v5, s[84:87], 0 offen sc1
s_mov_b64 exec, -1
s_mov_b32 s62, 1
s_load_dword s54, s[82:83], s52 glc
s_load_dword s55, s[82:83], s53 glc
s_branch Lste_32
Lst1_30:
s_and_b32 s54, s54, s55
s_cmp_eq_u32 s54, 16
s_cbranch_scc1 Lg_34
s_load_dword s54, s[82:83], s52 glc
s_load_dword s55, s[82:83], s53 glc
s_branch Lste_32
Lg_34:
v_add_u32 v5, 0, v1
v_min_u32 v5, 143, v5
v_lshlrev_b32 v20, 3, v5
v_add_u32 v5, s50, v5
v_max_i32 v5, 0, v5
v_lshlrev_b32 v5, 3, v5
buffer_load_dwordx2 v[32:33], v5, s[20:23], 0 offen sc1
v_add_u32 v5, 64, v1
v_min_u32 v5, 143, v5
v_lshlrev_b32 v21, 3, v5
v_add_u32 v5, s50, v5
v_max_i32 v5, 0, v5
v_lshlrev_b32 v5, 3, v5
buffer_load_dwordx2 v[34:35], v5, s[20:23], 0 offen sc1
s_branch Lov_3
.p2align 12
Lst_3_0:
s_branch Lwr_147
s_nop 0
Lov_3:
v_add_u32 v5, 128, v1
v_min_u32 v5, 143, v5
v_lshlrev_b32 v22, 3, v5
v_add_u32 v5, s50, v5
v_max_i32 v5, 0, v5
v_lshlrev_b32 v5, 3, v5
buffer_load_dwordx2 v[36:37], v5, s[20:23], 0 offen sc1
s_mov_b32 s62, 2
s_branch Lste_32
Lst2_31:
s_waitcnt vmcnt(0)
v_add_u32 v20, 147456, v20
ds_write_b64 v20, v[32:33]
v_add_u32 v21, 147456, v21
ds_write_b64 v21, v[34:35]
v_add_u32 v22, 147456, v22
ds_write_b64 v22, v[36:37]
s_waitcnt lgkmcnt(0)
s_mov_b32 s62, 3
Lste_32:
s_barrier
s_cmp_eq_u32 s62, 3
s_cbranch_scc1 Lste_37
s_cmp_eq_u32 s62, 2
s_cbranch_scc1 Lst2_36
s_waitcnt lgkmcnt(0)
s_cmp_eq_u32 s62, 1
s_cbranch_scc1 Lst1_35
s_waitcnt vmcnt(0)
v_readfirstlane_b32 s54, v6
s_cmp_eq_u32 s54, 0
s_cbranch_scc0 Lrep_38
buffer_load_dword v6, v4, s[56:59], 0 offen sc1
s_branch Lste_37
Lrep_38:
s_add_u32 s7, s34, 64
s_lshl_b32 s7, s7, 7
v_mov_b32 v5, s7
v_mov_b32 v6, 1
s_mov_b64 exec, 1
buffer_atomic_add v6, v5, s[84:87], 0 offen sc1
s_mov_b64 exec, -1
s_mov_b32 s62, 1
s_load_dword s54, s[82:83], s52 glc
s_load_dword s55, s[82:83], s53 glc
s_branch Lste_37
Lst1_35:
s_and_b32 s54, s54, s55
s_cmp_eq_u32 s54, 16
s_cbranch_scc1 Lg_39
s_load_dword s54, s[82:83], s52 glc
s_load_dword s55, s[82:83], s53 glc
s_branch Lste_37
Lg_39:
v_add_u32 v5, 0, v1
v_min_u32 v5, 143, v5
v_lshlrev_b32 v20, 3, v5
v_add_u32 v5, s50, v5
v_max_i32 v5, 0, v5
v_lshlrev_b32 v5, 3, v5
buffer_load_dwordx2 v[32:33], v5, s[20:23], 0 offen sc1
v_add_u32 v5, 64, v1
v_min_u32 v5, 143, v5
v_lshlrev_b32 v21, 3, v5
v_add_u32 v5, s50, v5
v_max_i32 v5, 0, v5
v_lshlrev_b32 v5, 3, v5
buffer_load_dwordx2 v[34:35], v5, s[20:23], 0 offen sc1
v_add_u32 v5, 128, v1
v_min_u32 v5, 143, v5
v_lshlrev_b32 v22, 3, v5
v_add_u32 v5, s50, v5
v_max_i32 v5, 0, v5
v_lshlrev_b32 v5, 3, v5
buffer_load_dwordx2 v[36:37], v5, s[20:23], 0 offen sc1
s_mov_b32 s62, 2
s_branch Lste_37
Lst2_36:
s_waitcnt vmcnt(0)
v_add_u32 v20, 147456, v20
ds_write_b64 v20, v[32:33]
v_add_u32 v21, 147456, v21
ds_write_b64 v21, v[34:35]
v_add_u32 v22, 147456, v22
ds_write_b64 v22, v[36:37]
s_waitcnt lgkmcnt(0)
s_mov_b32 s62, 3
Lste_37:
s_barrier
s_cmp_eq_u32 s62, 3
s_cbranch_scc1 Lste_42
s_cmp_eq_u32 s62, 2
s_cbranch_scc1 Lst2_41
s_waitcnt lgkmcnt(0)
s_cmp_eq_u32 s62, 1
s_cbranch_scc1 Lst1_40
s_waitcnt vmcnt(0)
v_readfirstlane_b32 s54, v6
s_cmp_eq_u32 s54, 0
s_cbranch_scc0 Lrep_43
buffer_load_dword v6, v4, s[56:59], 0 offen sc1
s_branch Lste_42
Lrep_43:
s_add_u32 s7, s34, 64
s_lshl_b32 s7, s7, 7
v_mov_b32 v5, s7
v_mov_b32 v6, 1
s_mov_b64 exec, 1
buffer_atomic_add v6, v5, s[84:87], 0 offen sc1
s_mov_b64 exec, -1
s_mov_b32 s62, 1
s_load_dword s54, s[82:83], s52 glc
s_load_dword s55, s[82:83], s53 glc
s_branch Lste_42
Lst1_40:
s_and_b32 s54, s54, s55
s_cmp_eq_u32 s54, 16
s_cbranch_scc1 Lg_44
s_load_dword s54, s[82:83], s52 glc
s_load_dword s55, s[82:83], s53 glc
s_branch Lste_42
Lg_44:
v_add_u32 v5, 0, v1
v_min_u32 v5, 143, v5
v_lshlrev_b32 v20, 3, v5
v_add_u32 v5, s50, v5
v_max_i32 v5, 0, v5
v_lshlrev_b32 v5, 3, v5
buffer_load_dwordx2 v[32:33], v5, s[20:23], 0 offen sc1
v_add_u32 v5, 64, v1
v_min_u32 v5, 143, v5
v_lshlrev_b32 v21, 3, v5
v_add_u32 v5, s50, v5
v_max_i32 v5, 0, v5
v_lshlrev_b32 v5, 3, v5
buffer_load_dwordx2 v[34:35], v5, s[20:23], 0 offen sc1
v_add_u32 v5, 128, v1
v_min_u32 v5, 143, v5
v_lshlrev_b32 v22, 3, v5
v_add_u32 v5, s50, v5
v_max_i32 v5, 0, v5
v_lshlrev_b32 v5, 3, v5
buffer_load_dwordx2 v[36:37], v5, s[20:23], 0 offen sc1
s_mov_b32 s62, 2
s_branch Lste_42
Lst2_41:
s_waitcnt vmcnt(0)
v_add_u32 v20, 147456, v20
ds_write_b64 v20, v[32:33]
v_add_u32 v21, 147456, v21
ds_write_b64 v21, v[34:35]
v_add_u32 v22, 147456, v22
ds_write_b64 v22, v[36:37]
s_waitcnt lgkmcnt(0)
s_mov_b32 s62, 3
Lste_42:
s_barrier
s_cmp_eq_u32 s62, 3
s_cbranch_scc1 Lste_47
s_cmp_eq_u32 s62, 2
s_cbranch_scc1 Lst2_46
s_waitcnt lgkmcnt(0)
s_cmp_eq_u32 s62, 1
s_cbranch_scc1 Lst1_45
s_waitcnt vmcnt(0)
v_readfirstlane_b32 s54, v6
s_cmp_eq_u32 s54, 0
s_cbranch_scc0 Lrep_48
buffer_load_dword v6, v4, s[56:59], 0 offen sc1
s_branch Lste_47
Lrep_48:
s_add_u32 s7, s34, 64
s_lshl_b32 s7, s7, 7
v_mov_b32 v5, s7
v_mov_b32 v6, 1
s_mov_b64 exec, 1
buffer_atomic_add v6, v5, s[84:87], 0 offen sc1
s_mov_b64 exec, -1
s_mov_b32 s62, 1
s_load_dword s54, s[82:83], s52 glc
s_load_dword s55, s[82:83], s53 glc
s_branch Lste_47
Lst1_45:
s_and_b32 s54, s54, s55
s_cmp_eq_u32 s54, 16
s_cbranch_scc1 Lg_49
s_load_dword s54, s[82:83], s52 glc
s_load_dword s55, s[82:83], s53 glc
s_branch Lste_47
Lg_49:
v_add_u32 v5, 0, v1
v_min_u32 v5, 143, v5
v_lshlrev_b32 v20, 3, v5
v_add_u32 v5, s50, v5
v_max_i32 v5, 0, v5
v_lshlrev_b32 v5, 3, v5
buffer_load_dwordx2 v[32:33], v5, s[20:23], 0 offen sc1
v_add_u32 v5, 64, v1
v_min_u32 v5, 143, v5
v_lshlrev_b32 v21, 3, v5
v_add_u32 v5, s50, v5
v_max_i32 v5, 0, v5
v_lshlrev_b32 v5, 3, v5
buffer_load_dwordx2 v[34:35], v5, s[20:23], 0 offen sc1
v_add_u32 v5, 128, v1
v_min_u32 v5, 143, v5
v_lshlrev_b32 v22, 3, v5
v_add_u32 v5, s50, v5
v_max_i32 v5, 0, v5
v_lshlrev_b32 v5, 3, v5
buffer_load_dwordx2 v[36:37], v5, s[20:23], 0 offen sc1
s_mov_b32 s62, 2
s_branch Lste_47
Lst2_46:
s_waitcnt vmcnt(0)
v_add_u32 v20, 147456, v20
ds_write_b64 v20, v[32:33]
v_add_u32 v21, 147456, v21
ds_write_b64 v21, v[34:35]
v_add_u32 v22, 147456, v22
ds_write_b64 v22, v[36:37]
s_waitcnt lgkmcnt(0)
s_mov_b32 s62, 3
Lste_47:
s_barrier
s_cmp_eq_u32 s62, 3
s_cbranch_scc1 Lste_52
s_cmp_eq_u32 s62, 2
s_cbranch_scc1 Lst2_51
s_waitcnt lgkmcnt(0)
s_cmp_eq_u32 s62, 1
s_cbranch_scc1 Lst1_50
s_waitcnt vmcnt(0)
v_readfirstlane_b32 s54, v6
s_cmp_eq_u32 s54, 0
s_cbranch_scc0 Lrep_53
buffer_load_dword v6, v4, s[56:59], 0 offen sc1
s_branch Lste_52
Lrep_53:
s_add_u32 s7, s34, 64
s_lshl_b32 s7, s7, 7
v_mov_b32 v5, s7
v_mov_b32 v6, 1
s_mov_b64 exec, 1
buffer_atomic_add v6, v5, s[84:87], 0 offen sc1
s_mov_b64 exec, -1
s_mov_b32 s62, 1
s_load_dword s54, s[82:83], s52 glc
s_load_dword s55, s[82:83], s53 glc
s_branch Lste_52
Lst1_50:
s_and_b32 s54, s54, s55
s_cmp_eq_u32 s54, 16
s_cbranch_scc1 Lg_54
s_load_dword s54, s[82:83], s52 glc
s_load_dword s55, s[82:83], s53 glc
s_branch Lste_52
Lg_54:
v_add_u32 v5, 0, v1
v_min_u32 v5, 143, v5
v_lshlrev_b32 v20, 3, v5
v_add_u32 v5, s50, v5
v_max_i32 v5, 0, v5
v_lshlrev_b32 v5, 3, v5
buffer_load_dwordx2 v[32:33], v5, s[20:23], 0 offen sc1
v_add_u32 v5, 64, v1
v_min_u32 v5, 143, v5
v_lshlrev_b32 v21, 3, v5
v_add_u32 v5, s50, v5
v_max_i32 v5, 0, v5
v_lshlrev_b32 v5, 3, v5
buffer_load_dwordx2 v[34:35], v5, s[20:23], 0 offen sc1
v_add_u32 v5, 128, v1
v_min_u32 v5, 143, v5
v_lshlrev_b32 v22, 3, v5
v_add_u32 v5, s50, v5
v_max_i32 v5, 0, v5
v_lshlrev_b32 v5, 3, v5
buffer_load_dwordx2 v[36:37], v5, s[20:23], 0 offen sc1
s_mov_b32 s62, 2
s_branch Lste_52
Lst2_51:
s_waitcnt vmcnt(0)
v_add_u32 v20, 147456, v20
ds_write_b64 v20, v[32:33]
v_add_u32 v21, 147456, v21
ds_write_b64 v21, v[34:35]
v_add_u32 v22, 147456, v22
ds_write_b64 v22, v[36:37]
s_waitcnt lgkmcnt(0)
s_mov_b32 s62, 3
Lste_52:
s_barrier
s_cmp_eq_u32 s62, 3
s_cbranch_scc1 Lste_57
s_cmp_eq_u32 s62, 2
s_cbranch_scc1 Lst2_56
s_waitcnt lgkmcnt(0)
s_cmp_eq_u32 s62, 1
s_cbranch_scc1 Lst1_55
s_waitcnt vmcnt(0)
v_readfirstlane_b32 s54, v6
s_cmp_eq_u32 s54, 0
s_cbranch_scc0 Lrep_58
buffer_load_dword v6, v4, s[56:59], 0 offen sc1
s_branch Lste_57
Lrep_58:
s_add_u32 s7, s34, 64
s_lshl_b32 s7, s7, 7
v_mov_b32 v5, s7
v_mov_b32 v6, 1
s_mov_b64 exec, 1
buffer_atomic_add v6, v5, s[84:87], 0 offen sc1
s_mov_b64 exec, -1
s_mov_b32 s62, 1
s_load_dword s54, s[82:83], s52 glc
s_load_dword s55, s[82:83], s53 glc
s_branch Lste_57
Lst1_55:
s_and_b32 s54, s54, s55
s_cmp_eq_u32 s54, 16
s_cbranch_scc1 Lg_59
s_load_dword s54, s[82:83], s52 glc
s_load_dword s55, s[82:83], s53 glc
s_branch Lste_57
Lg_59:
v_add_u32 v5, 0, v1
v_min_u32 v5, 143, v5
v_lshlrev_b32 v20, 3, v5
v_add_u32 v5, s50, v5
v_max_i32 v5, 0, v5
v_lshlrev_b32 v5, 3, v5
buffer_load_dwordx2 v[32:33], v5, s[20:23], 0 offen sc1
v_add_u32 v5, 64, v1
v_min_u32 v5, 143, v5
v_lshlrev_b32 v21, 3, v5
v_add_u32 v5, s50, v5
v_max_i32 v5, 0, v5
v_lshlrev_b32 v5, 3, v5
buffer_load_dwordx2 v[34:35], v5, s[20:23], 0 offen sc1
v_add_u32 v5, 128, v1
v_min_u32 v5, 143, v5
v_lshlrev_b32 v22, 3, v5
v_add_u32 v5, s50, v5
v_max_i32 v5, 0, v5
v_lshlrev_b32 v5, 3, v5
buffer_load_dwordx2 v[36:37], v5, s[20:23], 0 offen sc1
s_mov_b32 s62, 2
s_branch Lste_57
Lst2_56:
s_waitcnt vmcnt(0)
v_add_u32 v20, 147456, v20
ds_write_b64 v20, v[32:33]
v_add_u32 v21, 147456, v21
ds_write_b64 v21, v[34:35]
v_add_u32 v22, 147456, v22
ds_write_b64 v22, v[36:37]
s_waitcnt lgkmcnt(0)
s_mov_b32 s62, 3
Lste_57:
s_barrier
s_cmp_eq_u32 s62, 3
s_cbranch_scc1 Lste_62
s_cmp_eq_u32 s62, 2
s_cbranch_scc1 Lst2_61
s_waitcnt lgkmcnt(0)
s_cmp_eq_u32 s62, 1
s_cbranch_scc1 Lst1_60
s_waitcnt vmcnt(0)
v_readfirstlane_b32 s54, v6
s_cmp_eq_u32 s54, 0
s_cbranch_scc0 Lrep_63
buffer_load_dword v6, v4, s[56:59], 0 offen sc1
s_branch Lste_62
Lrep_63:
s_add_u32 s7, s34, 64
s_lshl_b32 s7, s7, 7
v_mov_b32 v5, s7
v_mov_b32 v6, 1
s_mov_b64 exec, 1
buffer_atomic_add v6, v5, s[84:87], 0 offen sc1
s_mov_b64 exec, -1
s_mov_b32 s62, 1
s_load_dword s54, s[82:83], s52 glc
s_load_dword s55, s[82:83], s53 glc
s_branch Lste_62
Lst1_60:
s_and_b32 s54, s54, s55
s_cmp_eq_u32 s54, 16
s_cbranch_scc1 Lg_64
s_load_dword s54, s[82:83], s52 glc
s_load_dword s55, s[82:83], s53 glc
s_branch Lste_62
Lg_64:
v_add_u32 v5, 0, v1
v_min_u32 v5, 143, v5
v_lshlrev_b32 v20, 3, v5
v_add_u32 v5, s50, v5
v_max_i32 v5, 0, v5
v_lshlrev_b32 v5, 3, v5
buffer_load_dwordx2 v[32:33], v5, s[20:23], 0 offen sc1
v_add_u32 v5, 64, v1
v_min_u32 v5, 143, v5
v_lshlrev_b32 v21, 3, v5
v_add_u32 v5, s50, v5
v_max_i32 v5, 0, v5
v_lshlrev_b32 v5, 3, v5
buffer_load_dwordx2 v[34:35], v5, s[20:23], 0 offen sc1
v_add_u32 v5, 128, v1
v_min_u32 v5, 143, v5
v_lshlrev_b32 v22, 3, v5
v_add_u32 v5, s50, v5
v_max_i32 v5, 0, v5
v_lshlrev_b32 v5, 3, v5
buffer_load_dwordx2 v[36:37], v5, s[20:23], 0 offen sc1
s_mov_b32 s62, 2
s_branch Lste_62
Lst2_61:
s_waitcnt vmcnt(0)
v_add_u32 v20, 147456, v20
ds_write_b64 v20, v[32:33]
v_add_u32 v21, 147456, v21
ds_write_b64 v21, v[34:35]
v_add_u32 v22, 147456, v22
ds_write_b64 v22, v[36:37]
s_waitcnt lgkmcnt(0)
s_mov_b32 s62, 3
Lste_62:
s_barrier
s_cmp_eq_u32 s62, 3
s_cbranch_scc1 Lste_67
s_cmp_eq_u32 s62, 2
s_cbranch_scc1 Lst2_66
s_waitcnt lgkmcnt(0)
s_cmp_eq_u32 s62, 1
s_cbranch_scc1 Lst1_65
s_waitcnt vmcnt(0)
v_readfirstlane_b32 s54, v6
s_cmp_eq_u32 s54, 0
s_cbranch_scc0 Lrep_68
buffer_load_dword v6, v4, s[56:59], 0 offen sc1
s_branch Lste_67
Lrep_68:
s_add_u32 s7, s34, 64
s_lshl_b32 s7, s7, 7
v_mov_b32 v5, s7
v_mov_b32 v6, 1
s_mov_b64 exec, 1
buffer_atomic_add v6, v5, s[84:87], 0 offen sc1
s_mov_b64 exec, -1
s_mov_b32 s62, 1
s_load_dword s54, s[82:83], s52 glc
s_load_dword s55, s[82:83], s53 glc
s_branch Lste_67
Lst1_65:
s_and_b32 s54, s54, s55
s_cmp_eq_u32 s54, 16
s_cbranch_scc1 Lg_69
s_load_dword s54, s[82:83], s52 glc
s_load_dword s55, s[82:83], s53 glc
s_branch Lste_67
Lg_69:
v_add_u32 v5, 0, v1
v_min_u32 v5, 143, v5
v_lshlrev_b32 v20, 3, v5
v_add_u32 v5, s50, v5
v_max_i32 v5, 0, v5
v_lshlrev_b32 v5, 3, v5
buffer_load_dwordx2 v[32:33], v5, s[20:23], 0 offen sc1
v_add_u32 v5, 64, v1
v_min_u32 v5, 143, v5
v_lshlrev_b32 v21, 3, v5
v_add_u32 v5, s50, v5
v_max_i32 v5, 0, v5
v_lshlrev_b32 v5, 3, v5
buffer_load_dwordx2 v[34:35], v5, s[20:23], 0 offen sc1
v_add_u32 v5, 128, v1
v_min_u32 v5, 143, v5
v_lshlrev_b32 v22, 3, v5
v_add_u32 v5, s50, v5
v_max_i32 v5, 0, v5
v_lshlrev_b32 v5, 3, v5
buffer_load_dwordx2 v[36:37], v5, s[20:23], 0 offen sc1
s_mov_b32 s62, 2
s_branch Lste_67
Lst2_66:
s_waitcnt vmcnt(0)
v_add_u32 v20, 147456, v20
ds_write_b64 v20, v[32:33]
v_add_u32 v21, 147456, v21
ds_write_b64 v21, v[34:35]
v_add_u32 v22, 147456, v22
ds_write_b64 v22, v[36:37]
s_waitcnt lgkmcnt(0)
s_mov_b32 s62, 3
Lste_67:
s_barrier
s_cmp_eq_u32 s62, 3
s_cbranch_scc1 Lste_72
s_cmp_eq_u32 s62, 2
s_cbranch_scc1 Lst2_71
s_waitcnt lgkmcnt(0)
s_cmp_eq_u32 s62, 1
s_cbranch_scc1 Lst1_70
s_waitcnt vmcnt(0)
v_readfirstlane_b32 s54, v6
s_cmp_eq_u32 s54, 0
s_cbranch_scc0 Lrep_73
buffer_load_dword v6, v4, s[56:59], 0 offen sc1
s_branch Lste_72
Lrep_73:
s_add_u32 s7, s34, 64
s_lshl_b32 s7, s7, 7
v_mov_b32 v5, s7
v_mov_b32 v6, 1
s_mov_b64 exec, 1
buffer_atomic_add v6, v5, s[84:87], 0 offen sc1
s_mov_b64 exec, -1
s_mov_b32 s62, 1
s_load_dword s54, s[82:83], s52 glc
s_load_dword s55, s[82:83], s53 glc
s_branch Lste_72
Lst1_70:
s_and_b32 s54, s54, s55
s_cmp_eq_u32 s54, 16
s_cbranch_scc1 Lg_74
s_load_dword s54, s[82:83], s52 glc
s_load_dword s55, s[82:83], s53 glc
s_branch Lste_72
Lg_74:
v_add_u32 v5, 0, v1
v_min_u32 v5, 143, v5
v_lshlrev_b32 v20, 3, v5
v_add_u32 v5, s50, v5
v_max_i32 v5, 0, v5
v_lshlrev_b32 v5, 3, v5
buffer_load_dwordx2 v[32:33], v5, s[20:23], 0 offen sc1
v_add_u32 v5, 64, v1
v_min_u32 v5, 143, v5
v_lshlrev_b32 v21, 3, v5
v_add_u32 v5, s50, v5
v_max_i32 v5, 0, v5
v_lshlrev_b32 v5, 3, v5
buffer_load_dwordx2 v[34:35], v5, s[20:23], 0 offen sc1
v_add_u32 v5, 128, v1
v_min_u32 v5, 143, v5
v_lshlrev_b32 v22, 3, v5
v_add_u32 v5, s50, v5
v_max_i32 v5, 0, v5
v_lshlrev_b32 v5, 3, v5
buffer_load_dwordx2 v[36:37], v5, s[20:23], 0 offen sc1
s_mov_b32 s62, 2
s_branch Lste_72
Lst2_71:
s_waitcnt vmcnt(0)
v_add_u32 v20, 147456, v20
ds_write_b64 v20, v[32:33]
v_add_u32 v21, 147456, v21
ds_write_b64 v21, v[34:35]
v_add_u32 v22, 147456, v22
ds_write_b64 v22, v[36:37]
s_waitcnt lgkmcnt(0)
s_mov_b32 s62, 3
Lste_72:
s_barrier
s_cmp_eq_u32 s62, 3
s_cbranch_scc1 Lste_77
s_cmp_eq_u32 s62, 2
s_cbranch_scc1 Lst2_76
s_cmp_eq_u32 s62, 1
s_cbranch_scc1 Lst1_75
s_mov_b32 s41, 0x40000
Lz0_78:
s_waitcnt vmcnt(0)
v_readfirstlane_b32 s54, v6
s_cmp_eq_u32 s54, 0
s_cbranch_scc0 Lzok_79
buffer_load_dword v6, v4, s[56:59], 0 offen sc1
s_sub_u32 s41, s41, 1
s_cmp_lg_u32 s41, 0
s_cbranch_scc1 Lz0_78
s_waitcnt lgkmcnt(0)
Lzok_79:
s_add_u32 s7, s34, 64
s_lshl_b32 s7, s7, 7
v_mov_b32 v5, s7
v_mov_b32 v6, 1
s_mov_b64 exec, 1
buffer_atomic_add v6, v5, s[84:87], 0 offen sc1
s_mov_b64 exec, -1
s_load_dword s54, s[82:83], s52 glc
s_load_dword s55, s[82:83], s53 glc
Lst1_75:
s_mov_b32 s41, 200
Lpoll_80:
s_waitcnt lgkmcnt(0)
s_and_b32 s54, s54, s55
s_cmp_eq_u32 s54, 16
s_cbranch_scc1 Lg_82
s_load_dword s54, s[82:83], s52 glc
s_load_dword s55, s[82:83], s53 glc
s_sub_u32 s41, s41, 1
s_cmp_lg_u32 s41, 0
s_cbranch_scc1 Lpoll_80
s_waitcnt lgkmcnt(0)
s_mov_b32 s41, 0
Lfb_81:
s_add_u32 s62, s50, s41
s_max_i32 s62, s62, 0
s_lshl_b32 s43, s62, 11
buffer_load_dwordx4 v[96:99], v10, s[8:11], s43 offen offset:0
buffer_load_dwordx4 v[100:103], v10, s[8:11], s43 offen offset:1024
buffer_load_dwordx4 v[104:107], v10, s[8:11], s43 offen offset:2048
buffer_load_dwordx4 v[108:111], v10, s[8:11], s43 offen offset:3072
s_waitcnt vmcnt(0)
s_mov_b32 s43, 0x3f803f80
v_mov_b32 v116, 0
v_mov_b32 v117, 0
v_mov_b32 v118, 0
v_mov_b32 v119, 0
v_mov_b32 v120, 0
v_mov_b32 v121, 0
v_mov_b32 v122, 0
v_mov_b32 v123, 0
v_dot2_f32_bf16 v116, v96, s43, v116
v_dot2_f32_bf16 v120, v96, v96, v120
v_dot2_f32_bf16 v118, v104, s43, v118
v_dot2_f32_bf16 v122, v104, v104, v122
v_dot2_f32_bf16 v117, v97, s43, v117
v_dot2_f32_bf16 v121, v97, v97, v121
v_dot2_f32_bf16 v119, v105, s43, v119
v_dot2_f32_bf16 v123, v105, v105, v123
v_dot2_f32_bf16 v116, v98, s43, v116
v_dot2_f32_bf16 v120, v98, v98, v120
v_dot2_f32_bf16 v118, v106, s43, v118
v_dot2_f32_bf16 v122, v106, v106, v122
v_dot2_f32_bf16 v117, v99, s43, v117
v_dot2_f32_bf16 v121, v99, v99, v121
v_dot2_f32_bf16 v119, v107, s43, v119
v_dot2_f32_bf16 v123, v107, v107, v123
v_dot2_f32_bf16 v116, v100, s43, v116
v_dot2_f32_bf16 v120, v100, v100, v120
v_dot2_f32_bf16 v118, v108, s43, v118
v_dot2_f32_bf16 v122, v108, v108, v122
v_dot2_f32_bf16 v117, v101, s43, v117
v_dot2_f32_bf16 v121, v101, v101, v121
v_dot2_f32_bf16 v119, v109, s43, v119
v_dot2_f32_bf16 v123, v109, v109, v123
v_dot2_f32_bf16 v116, v102, s43, v116
v_dot2_f32_bf16 v120, v102, v102, v120
v_dot2_f32_bf16 v118, v110, s43, v118
v_dot2_f32_bf16 v122, v110, v110, v122
v_dot2_f32_bf16 v117, v103, s43, v117
v_dot2_f32_bf16 v121, v103, v103, v121
v_dot2_f32_bf16 v119, v111, s43, v119
v_dot2_f32_bf16 v123, v111, v111, v123
s_nop 2
v_add_f32 v116, v116, v117
v_add_f32 v118, v118, v119
v_add_f32 v120, v120, v121
v_add_f32 v122, v122, v123
s_nop 1
v_permlane32_swap_b32 v116, v118
v_permlane32_swap_b32 v120, v122
v_add_f32 v116, v116, v118
v_add_f32 v120, v120, v122
s_nop 1
v_permlane16_swap_b32 v116, v120
v_add_f32 v116, v116, v120
s_nop 1
v_add_f32_dpp v116, v116, v116 row_ror:8 row_mask:0xf bank_mask:0xf
s_nop 1
v_add_f32_dpp v116, v116, v116 row_ror:4 row_mask:0xf bank_mask:0xf
s_nop 1
v_add_f32_dpp v116, v116, v116 row_ror:2 row_mask:0xf bank_mask:0xf
s_nop 1
v_add_f32_dpp v116, v116, v116 row_ror:1 row_mask:0xf bank_mask:0xf
v_mov_b32 v117, v116
s_nop 1
v_permlane16_swap_b32 v116, v117
v_mul_f32 v112, 0x3a800000, v116
v_mul_f32 v113, 0x3a800000, v117
v_fma_f32 v113, -v112, v112, v113
v_max_f32 v113, 0, v113
v_add_f32 v113, 0x3727c5ac, v113
v_rsq_f32 v113, v113
v_lshrrev_b32 v11, 5, v1
s_lshl_b32 s43, s41, 3
s_add_u32 s43, s43, 147456
v_lshl_add_u32 v11, v11, 3, s43
ds_write_b64 v11, v[112:113]
s_add_u32 s41, s41, 2
s_cmp_lt_u32 s41, 144
s_cbranch_scc1 Lfb_81
s_waitcnt lgkmcnt(0)
s_branch Lste_77
Lg_82:
v_add_u32 v5, 0, v1
v_min_u32 v5, 143, v5
v_lshlrev_b32 v20, 3, v5
v_add_u32 v5, s50, v5
v_max_i32 v5, 0, v5
v_lshlrev_b32 v5, 3, v5
buffer_load_dwordx2 v[32:33], v5, s[20:23], 0 offen sc1
v_add_u32 v5, 64, v1
v_min_u32 v5, 143, v5
v_lshlrev_b32 v21, 3, v5
v_add_u32 v5, s50, v5
v_max_i32 v5, 0, v5
v_lshlrev_b32 v5, 3, v5
buffer_load_dwordx2 v[34:35], v5, s[20:23], 0 offen sc1
v_add_u32 v5, 128, v1
v_min_u32 v5, 143, v5
v_lshlrev_b32 v22, 3, v5
v_add_u32 v5, s50, v5
v_max_i32 v5, 0, v5
v_lshlrev_b32 v5, 3, v5
buffer_load_dwordx2 v[36:37], v5, s[20:23], 0 offen sc1
Lst2_76:
s_waitcnt vmcnt(0)
v_add_u32 v20, 147456, v20
ds_write_b64 v20, v[32:33]
v_add_u32 v21, 147456, v21
ds_write_b64 v21, v[34:35]
v_add_u32 v22, 147456, v22
ds_write_b64 v22, v[36:37]
s_waitcnt lgkmcnt(0)
Lste_77:
s_bitcmp0_b32 s2, 0
s_cselect_b32 s88, s72, s74
s_cselect_b32 s89, s73, s75
s_cmp_lt_u32 s2, 192
s_cselect_b32 s90, 7340032, 0
s_mov_b32 s91, 0x20000
s_bfe_u32 s44, s2, 0x30001
s_lshl_b32 s44, s44, 2
s_and_b32 s43, s36, 3
s_add_u32 s44, s44, s43
s_lshl_b32 s44, s44, 5
v_lshrrev_b32 v18, 4, v1
v_add_u32 v18, s44, v18
v_mul_u32_u24 v18, 7168, v18
v_and_b32 v19, 15, v1
v_lshl_add_u32 v18, v19, 4, v18
s_lshr_b32 s43, s2, 4
s_lshl_b32 s43, s43, 8
s_add_u32 s43, s43, 4096
v_add_u32 v18, s43, v18
s_mov_b32 s43, 0
buffer_load_dwordx4 v[128:131], v18, s[88:91], s43 offen
s_mov_b32 s43, 28672
buffer_load_dwordx4 v[132:135], v18, s[88:91], s43 offen
s_mov_b32 s43, 57344
buffer_load_dwordx4 v[136:139], v18, s[88:91], s43 offen
s_mov_b32 s43, 86016
buffer_load_dwordx4 v[140:143], v18, s[88:91], s43 offen
s_mov_b32 s43, 114688
buffer_load_dwordx4 v[144:147], v18, s[88:91], s43 offen
s_mov_b32 s43, 143360
buffer_load_dwordx4 v[148:151], v18, s[88:91], s43 offen
s_mov_b32 s43, 172032
buffer_load_dwordx4 v[152:155], v18, s[88:91], s43 offen
s_mov_b32 s43, 200704
buffer_load_dwordx4 v[156:159], v18, s[88:91], s43 offen
s_barrier
s_lshl_b32 s43, s35, 7
s_add_u32 s28, s68, s43
s_addc_u32 s29, s69, 0
s_mov_b32 s30, 2095232
s_mov_b32 s31, 0x20000
v_lshrrev_b32 v15, 3, v1
v_and_b32 v16, 6, v15
v_and_b32 v7, 7, v1
v_xor_b32 v7, v7, v16
v_lshlrev_b32 v7, 4, v7
v_mul_u32_u24 v15, 2048, v15
v_add_u32 v7, v7, v15
s_and_b32 s40, s36, 3
s_lshl_b32 s39, s40, 13
s_add_u32 s40, s40, s35
s_add_u32 s42, s40, 0
s_and_b32 s42, s42, 15
s_lshl_b32 s42, s42, 17
s_add_u32 m0, s39, 65536
s_add_u32 s43, s42, 0
buffer_load_dwordx4 v7, s[28:31], s43 offen lds
s_add_u32 m0, s39, 66560
s_add_u32 s43, s42, 16384
buffer_load_dwordx4 v7, s[28:31], s43 offen lds
s_add_u32 m0, s39, 67584
s_add_u32 s43, s42, 32768
buffer_load_dwordx4 v7, s[28:31], s43 offen lds
s_add_u32 m0, s39, 68608
s_add_u32 s43, s42, 49152
buffer_load_dwordx4 v7, s[28:31], s43 offen lds
s_add_u32 m0, s39, 69632
s_add_u32 s43, s42, 65536
buffer_load_dwordx4 v7, s[28:31], s43 offen lds
s_add_u32 m0, s39, 70656
s_branch Lov_4
.p2align 12
Lst_4_0:
s_branch Lwr_144
s_nop 0
Lov_4:
s_add_u32 s43, s42, 81920
buffer_load_dwordx4 v7, s[28:31], s43 offen lds
s_add_u32 m0, s39, 71680
s_add_u32 s43, s42, 98304
buffer_load_dwordx4 v7, s[28:31], s43 offen lds
s_add_u32 m0, s39, 72704
s_add_u32 s43, s42, 114688
buffer_load_dwordx4 v7, s[28:31], s43 offen lds
Lats_6:
s_and_b32 s43, s36, 1
s_bfe_u32 s44, s36, 0x10001
s_lshr_b32 s45, s36, 2
v_lshlrev_b32 v14, 2, v13
v_sub_u32 v14, v12, v14
v_mov_b32 v16, 0xff800000
s_or_b32 s46, s34, s45
s_cmp_lg_u32 s46, 0
s_cselect_b32 s46, 0, 0xff800000
v_subrev_u32 v15, 0, v14
v_cmp_ge_u32 vcc, 7, v15
v_add_u32 v15, 16, v15
s_nop 0
v_cndmask_b32 v248, v16, 0, vcc
v_cmp_ge_u32 vcc, 7, v15
s_nop 1
v_cndmask_b32 v244, v16, 0, vcc
v_or_b32 v240, s46, v244
v_subrev_u32 v15, 1, v14
v_cmp_ge_u32 vcc, 7, v15
v_add_u32 v15, 16, v15
s_nop 0
v_cndmask_b32 v249, v16, 0, vcc
v_cmp_ge_u32 vcc, 7, v15
s_nop 1
v_cndmask_b32 v245, v16, 0, vcc
v_or_b32 v241, s46, v245
v_subrev_u32 v15, 2, v14
v_cmp_ge_u32 vcc, 7, v15
v_add_u32 v15, 16, v15
s_nop 0
v_cndmask_b32 v250, v16, 0, vcc
v_cmp_ge_u32 vcc, 7, v15
s_nop 1
v_cndmask_b32 v246, v16, 0, vcc
v_or_b32 v242, s46, v246
v_subrev_u32 v15, 3, v14
v_cmp_ge_u32 vcc, 7, v15
v_add_u32 v15, 16, v15
s_nop 0
v_cndmask_b32 v251, v16, 0, vcc
v_cmp_ge_u32 vcc, 7, v15
s_nop 1
v_cndmask_b32 v247, v16, 0, vcc
v_or_b32 v243, s46, v247
s_lshl_b32 s46, s45, 6
s_add_u32 s46, s46, s44
s_add_u32 s46, s46, 16
v_lshl_add_u32 v14, v12, 1, s46
s_lshl_b32 s47, s43, 6
v_lshl_add_u32 v15, v13, 4, s47
v_mul_u32_u24 v20, 400, v14
v_add_u32 v20, v20, v15
v_subrev_u32 v16, 32, v14
v_max_i32 v16, 0, v16
v_mul_u32_u24 v21, 400, v16
v_add_u32 v21, v21, v15
v_lshrrev_b32 v16, 2, v12
v_lshl_add_u32 v16, v13, 2, v16
v_lshl_add_u32 v16, v16, 1, s46
v_and_b32 v17, 3, v1
v_lshl_add_u32 v17, v17, 3, s47
v_mul_u32_u24 v22, 400, v16
v_add_u32 v22, v22, v17
v_subrev_u32 v16, 32, v16
v_max_i32 v16, 0, v16
v_mul_u32_u24 v23, 400, v16
v_add_u32 v23, v23, v17
s_mul_i32 s60, s34, 262144
s_add_u32 s16, s82, s60
s_addc_u32 s17, s83, 0
s_mov_b32 s18, 262144
s_mov_b32 s19, 0x20000
s_lshl_b32 s60, s35, 14
s_lshl_b32 s43, s43, 13
s_add_u32 s60, s60, s43
s_lshl_b32 s43, s45, 12
s_add_u32 s60, s60, s43
s_lshl_b32 s43, s44, 10
s_add_u32 s60, s60, s43
v_lshlrev_b32 v24, 4, v1
s_mov_b32 s61, 0x3e8293ee
s_lshl_b32 s38, s35, 7
Latt_5:
s_barrier
ds_read_b128 v[32:35], v20 offset:0
ds_read_b128 v[36:39], v20 offset:128
ds_read_b128 v[40:43], v21 offset:128
ds_read_b128 v[80:83], v20 offset:12800
ds_read_b128 v[84:87], v20 offset:12928
ds_read_b128 v[88:91], v20 offset:128
ds_read_b64_tr_b16 v[44:45], v23 offset:256
ds_read_b64_tr_b16 v[46:47], v22 offset:256
ds_read_b64_tr_b16 v[48:49], v23 offset:288
ds_read_b64_tr_b16 v[50:51], v22 offset:288
ds_read_b64_tr_b16 v[92:93], v22 offset:256
ds_read_b64_tr_b16 v[94:95], v22 offset:13056
ds_read_b64_tr_b16 v[96:97], v22 offset:288
ds_read_b64_tr_b16 v[98:99], v22 offset:13088
s_waitcnt lgkmcnt(11)
v_mfma_f32_16x16x32_bf16 v[52:55], v[40:43], v[32:35], v[240:243]
v_mfma_f32_16x16x32_bf16 v[56:59], v[36:39], v[32:35], v[248:251]
s_waitcnt lgkmcnt(8)
v_mfma_f32_16x16x32_bf16 v[100:103], v[88:91], v[80:83], v[244:247]
v_mfma_f32_16x16x32_bf16 v[104:107], v[84:87], v[80:83], v[248:251]
s_nop 4
v_max3_f32 v60, v52, v53, v54
v_max3_f32 v108, v100, v101, v102
v_max3_f32 v61, v55, v56, v57
v_max3_f32 v109, v103, v104, v105
v_max3_f32 v60, v60, v58, v59
v_max3_f32 v108, v108, v106, v107
v_max_f32 v60, v60, v61
v_max_f32 v108, v108, v109
s_nop 0
v_permlane32_swap_b32 v60, v108
v_max_f32 v60, v60, v108
v_mov_b32 v61, v60
s_nop 1
v_permlane16_swap_b32 v60, v61
v_max_f32 v60, v60, v61
v_mul_f32 v60, s61, v60
s_nop 0
v_mov_b32 v108, v60
s_nop 1
v_permlane32_swap_b32 v60, v108
v_fma_f32 v52, v52, s61, -v60
v_fma_f32 v100, v100, s61, -v108
v_fma_f32 v53, v53, s61, -v60
v_fma_f32 v101, v101, s61, -v108
v_fma_f32 v54, v54, s61, -v60
v_fma_f32 v102, v102, s61, -v108
v_fma_f32 v55, v55, s61, -v60
v_fma_f32 v103, v103, s61, -v108
v_fma_f32 v56, v56, s61, -v60
v_fma_f32 v104, v104, s61, -v108
v_fma_f32 v57, v57, s61, -v60
v_fma_f32 v105, v105, s61, -v108
v_fma_f32 v58, v58, s61, -v60
v_fma_f32 v106, v106, s61, -v108
v_fma_f32 v59, v59, s61, -v60
v_fma_f32 v107, v107, s61, -v108
v_exp_f32 v52, v52
v_exp_f32 v100, v100
v_exp_f32 v53, v53
v_exp_f32 v101, v101
v_exp_f32 v54, v54
v_exp_f32 v102, v102
v_exp_f32 v55, v55
v_exp_f32 v103, v103
v_exp_f32 v56, v56
v_exp_f32 v104, v104
v_exp_f32 v57, v57
v_exp_f32 v105, v105
v_exp_f32 v58, v58
v_exp_f32 v106, v106
v_exp_f32 v59, v59
v_exp_f32 v107, v107
v_cvt_pk_bf16_f32 v64, v52, v53
v_cvt_pk_bf16_f32 v112, v100, v101
v_cvt_pk_bf16_f32 v65, v54, v55
v_cvt_pk_bf16_f32 v113, v102, v103
v_cvt_pk_bf16_f32 v66, v56, v57
v_cvt_pk_bf16_f32 v114, v104, v105
v_cvt_pk_bf16_f32 v67, v58, v59
v_cvt_pk_bf16_f32 v115, v106, v107
v_pk_add_f32 v[52:53], v[52:53], v[54:55]
v_pk_add_f32 v[100:101], v[100:101], v[102:103]
v_pk_add_f32 v[56:57], v[56:57], v[58:59]
v_pk_add_f32 v[104:105], v[104:105], v[106:107]
s_waitcnt lgkmcnt(0)
s_waitcnt lgkmcnt(0)
v_mfma_f32_16x16x32_bf16 v[68:71], v[44:47], v[64:67], 0
v_mfma_f32_16x16x32_bf16 v[116:119], v[92:95], v[112:115], 0
v_mfma_f32_16x16x32_bf16 v[72:75], v[48:51], v[64:67], 0
v_mfma_f32_16x16x32_bf16 v[120:123], v[96:99], v[112:115], 0
v_pk_add_f32 v[52:53], v[52:53], v[56:57]
v_pk_add_f32 v[100:101], v[100:101], v[104:105]
v_add_f32 v60, v52, v53
v_add_f32 v108, v100, v101
s_nop 0
v_permlane32_swap_b32 v60, v108
v_add_f32 v60, v60, v108
v_mov_b32 v61, v60
s_nop 1
v_permlane16_swap_b32 v60, v61
v_add_f32 v60, v60, v61
v_rcp_f32 v60, v60
s_nop 0
v_mov_b32 v108, v60
s_nop 1
v_permlane32_swap_b32 v60, v108
v_pk_mul_f32 v[68:69], v[60:61], v[68:69] op_sel_hi:[0,1]
v_pk_mul_f32 v[116:117], v[108:109], v[116:117] op_sel_hi:[0,1]
v_pk_mul_f32 v[70:71], v[60:61], v[70:71] op_sel_hi:[0,1]
v_pk_mul_f32 v[118:119], v[108:109], v[118:119] op_sel_hi:[0,1]
v_pk_mul_f32 v[72:73], v[60:61], v[72:73] op_sel_hi:[0,1]
v_pk_mul_f32 v[120:121], v[108:109], v[120:121] op_sel_hi:[0,1]
v_pk_mul_f32 v[74:75], v[60:61], v[74:75] op_sel_hi:[0,1]
v_pk_mul_f32 v[122:123], v[108:109], v[122:123] op_sel_hi:[0,1]
v_cvt_pk_bf16_f32 v64, v68, v69
v_cvt_pk_bf16_f32 v112, v116, v117
v_cvt_pk_bf16_f32 v65, v70, v71
v_cvt_pk_bf16_f32 v113, v118, v119
v_cvt_pk_bf16_f32 v66, v72, v73
v_cvt_pk_bf16_f32 v114, v120, v121
v_cvt_pk_bf16_f32 v67, v74, v75
v_cvt_pk_bf16_f32 v115, v122, v123
buffer_store_dwordx4 v[64:67], v24, s[16:19], s60 offen offset:0 sc1
buffer_store_dwordx4 v[112:115], v24, s[16:19], s60 offen offset:2048 sc1
s_cmp_lt_u32 s36, 4
s_cbranch_scc1 Lc_83
s_add_u32 s56, s82, 28311552
s_addc_u32 s57, s83, 0
s_mov_b32 s58, 49152
s_mov_b32 s59, 0x20000
s_add_u32 s28, s68, s38
s_addc_u32 s29, s69, 0
s_mov_b32 s30, 2095232
s_mov_b32 s31, 0x20000
s_add_u32 s42, s40, 4
s_and_b32 s42, s42, 15
s_lshl_b32 s42, s42, 17
s_add_u32 m0, s39, 114688
s_add_u32 s43, s42, 0
buffer_load_dwordx4 v7, s[28:31], s43 offen lds
s_add_u32 m0, s39, 115712
s_add_u32 s43, s42, 16384
buffer_load_dwordx4 v7, s[28:31], s43 offen lds
s_add_u32 m0, s39, 116736
s_add_u32 s43, s42, 32768
buffer_load_dwordx4 v7, s[28:31], s43 offen lds
s_add_u32 m0, s39, 117760
s_add_u32 s43, s42, 49152
buffer_load_dwordx4 v7, s[28:31], s43 offen lds
s_add_u32 m0, s39, 118784
s_add_u32 s43, s42, 65536
buffer_load_dwordx4 v7, s[28:31], s43 offen lds
s_add_u32 m0, s39, 119808
s_add_u32 s43, s42, 81920
buffer_load_dwordx4 v7, s[28:31], s43 offen lds
s_add_u32 m0, s39, 120832
s_add_u32 s43, s42, 98304
buffer_load_dwordx4 v7, s[28:31], s43 offen lds
s_add_u32 m0, s39, 121856
s_add_u32 s43, s42, 114688
buffer_load_dwordx4 v7, s[28:31], s43 offen lds
s_waitcnt vmcnt(8)
s_branch Lo_84
Lc_83:
s_add_u32 s56, s82, 28311552
s_addc_u32 s57, s83, 0
s_mov_b32 s58, 49152
s_mov_b32 s59, 0x20000
s_waitcnt vmcnt(0)
Lo_84:
s_barrier
s_cmp_lg_u32 s36, 0
s_cbranch_scc1 Lsig_85
s_add_u32 s7, s34, 0
s_lshl_b32 s7, s7, 7
v_mov_b32 v4, s7
v_mov_b32 v5, 1
s_mov_b64 exec, 1
buffer_atomic_add v5, v4, s[56:59], 0 offen sc1
s_mov_b64 exec, -1
Lsig_85:
s_cmp_ge_u32 s36, 4
s_cbranch_scc1 Lprod_87
v_and_b32 v12, 15, v1
v_lshrrev_b32 v13, 4, v1
v_lshlrev_b32 v10, 12, v12
v_and_b32 v14, 1, v13
v_lshl_add_u32 v10, v14, 5, v10
v_lshrrev_b32 v14, 1, v13
v_lshl_add_u32 v10, v14, 4, v10
s_lshl_b32 s43, s34, 18
s_lshl_b32 s44, s36, 16
s_add_u32 s43, s43, s44
s_lshl_b32 s44, s35, 7
s_add_u32 s43, s43, s44
buffer_load_dwordx4 v[128:131], v10, s[8:11], s43 offen offset:0
buffer_load_dwordx4 v[132:135], v10, s[8:11], s43 offen offset:64
buffer_load_dwordx4 v[136:139], v10, s[8:11], s43 offen offset:2048
buffer_load_dwordx4 v[140:143], v10, s[8:11], s43 offen offset:2112
s_mul_i32 s43, s34, 262144
s_add_u32 s20, s82, s43
s_addc_u32 s21, s83, 0
s_add_u32 s20, s20, 4194304
s_addc_u32 s21, s21, 0
s_mov_b32 s22, 262144
s_mov_b32 s23, 0x20000
s_mul_i32 s43, s34, 16384
s_add_u32 s24, s82, s43
s_addc_u32 s25, s83, 0
s_add_u32 s24, s24, 25165824
s_addc_u32 s25, s25, 0
s_mov_b32 s26, 16384
s_mov_b32 s27, 0x20000
v_lshlrev_b32 v11, 4, v1
s_lshl_b32 s43, s36, 11
v_add_u32 v2, s43, v11
v_add_u32 v3, 98304, v2
v_lshrrev_b32 v14, 2, v1
v_bfe_u32 v15, v14, 1, 2
v_mul_u32_u24 v14, 128, v14
v_lshl_add_u32 v14, v15, 5, v14
v_and_b32 v15, 3, v1
v_lshl_add_u32 v4, v15, 3, v14
v_xor_b32 v5, 32, v4
v_xor_b32 v6, 64, v4
v_xor_b32 v7, 96, v4
v_add_u32 v16, 0x10000, v4
v_add_u32 v20, 0x20000, v4
v_add_u32 v17, 0x10000, v5
v_add_u32 v21, 0x20000, v5
v_add_u32 v18, 0x10000, v6
v_add_u32 v22, 0x20000, v6
v_add_u32 v19, 0x10000, v7
v_add_u32 v23, 0x20000, v7
s_lshl_b32 s44, s35, 14
s_add_u32 s60, s44, s43
v_lshrrev_b32 v14, 1, v13
v_lshlrev_b32 v14, 11, v14
v_lshl_add_u32 v14, v12, 3, v14
v_and_b32 v15, 1, v13
v_lshl_add_u32 v14, v15, 2, v14
s_lshl_b32 s43, s36, 12
s_lshl_b32 s44, s35, 7
s_add_u32 s43, s43, s44
v_add_u32 v9, s43, v14
s_mov_b32 s61, 0x3f803f80
s_waitcnt vmcnt(0)
v_permlane16_swap_b32 v128, v130
v_permlane16_swap_b32 v129, v131
v_permlane16_swap_b32 v132, v134
v_permlane16_swap_b32 v133, v135
v_permlane16_swap_b32 v136, v138
v_permlane16_swap_b32 v137, v139
v_permlane16_swap_b32 v140, v142
v_permlane16_swap_b32 v141, v143
v_lshlrev_b32 v96, 16, v128
v_and_b32 v97, 0xffff0000, v128
v_lshlrev_b32 v98, 16, v129
v_and_b32 v99, 0xffff0000, v129
v_lshlrev_b32 v100, 16, v130
v_and_b32 v101, 0xffff0000, v130
v_lshlrev_b32 v102, 16, v131
v_and_b32 v103, 0xffff0000, v131
v_lshlrev_b32 v104, 16, v132
v_and_b32 v105, 0xffff0000, v132
v_lshlrev_b32 v106, 16, v133
v_and_b32 v107, 0xffff0000, v133
v_lshlrev_b32 v108, 16, v134
v_and_b32 v109, 0xffff0000, v134
v_lshlrev_b32 v110, 16, v135
v_and_b32 v111, 0xffff0000, v135
v_lshlrev_b32 v112, 16, v136
v_and_b32 v113, 0xffff0000, v136
v_lshlrev_b32 v114, 16, v137
v_and_b32 v115, 0xffff0000, v137
v_lshlrev_b32 v116, 16, v138
v_and_b32 v117, 0xffff0000, v138
v_lshlrev_b32 v118, 16, v139
v_and_b32 v119, 0xffff0000, v139
v_lshlrev_b32 v120, 16, v140
v_and_b32 v121, 0xffff0000, v140
v_lshlrev_b32 v122, 16, v141
v_and_b32 v123, 0xffff0000, v141
v_lshlrev_b32 v124, 16, v142
v_and_b32 v125, 0xffff0000, v142
v_lshlrev_b32 v126, 16, v143
v_and_b32 v127, 0xffff0000, v143
s_barrier
ds_read_b128 v[32:35], v2 offset:0
ds_read_b64_tr_b16 v[40:41], v16 offset:0
ds_read_b64_tr_b16 v[42:43], v16 offset:2048
ds_read_b64_tr_b16 v[44:45], v17 offset:0
ds_read_b64_tr_b16 v[46:47], v17 offset:2048
ds_read_b64_tr_b16 v[48:49], v18 offset:0
ds_read_b64_tr_b16 v[50:51], v18 offset:2048
ds_read_b64_tr_b16 v[52:53], v19 offset:0
ds_read_b64_tr_b16 v[54:55], v19 offset:2048
ds_read_b128 v[36:39], v2 offset:1024
ds_read_b128 v[56:59], v2 offset:8192
ds_read_b64_tr_b16 v[64:65], v16 offset:4096
ds_read_b64_tr_b16 v[66:67], v16 offset:6144
ds_read_b64_tr_b16 v[68:69], v17 offset:4096
ds_read_b64_tr_b16 v[70:71], v17 offset:6144
ds_read_b64_tr_b16 v[72:73], v18 offset:4096
ds_read_b64_tr_b16 v[74:75], v18 offset:6144
ds_read_b64_tr_b16 v[76:77], v19 offset:4096
ds_read_b64_tr_b16 v[78:79], v19 offset:6144
ds_read_b128 v[60:63], v2 offset:9216
s_waitcnt lgkmcnt(0)
s_barrier
v_mfma_f32_16x16x32_bf16 v[96:99], v[40:43], v[32:35], v[96:99]
ds_read_b128 v[144:147], v2 offset:49152
ds_read_b64_tr_b16 v[152:153], v16 offset:8192
v_mfma_f32_16x16x32_bf16 v[100:103], v[44:47], v[32:35], v[100:103]
ds_read_b64_tr_b16 v[154:155], v16 offset:10240
ds_read_b64_tr_b16 v[156:157], v17 offset:8192
v_mfma_f32_16x16x32_bf16 v[104:107], v[48:51], v[32:35], v[104:107]
ds_read_b64_tr_b16 v[158:159], v17 offset:10240
ds_read_b64_tr_b16 v[160:161], v18 offset:8192
v_mfma_f32_16x16x32_bf16 v[108:111], v[52:55], v[32:35], v[108:111]
ds_read_b64_tr_b16 v[162:163], v18 offset:10240
ds_read_b64_tr_b16 v[164:165], v19 offset:8192
v_mfma_f32_16x16x32_bf16 v[124:127], v[52:55], v[36:39], v[124:127]
ds_read_b64_tr_b16 v[166:167], v19 offset:10240
ds_read_b128 v[148:151], v2 offset:50176
v_mfma_f32_16x16x32_bf16 v[120:123], v[48:51], v[36:39], v[120:123]
ds_read_b128 v[168:171], v2 offset:57344
ds_read_b64_tr_b16 v[176:177], v16 offset:12288
v_mfma_f32_16x16x32_bf16 v[116:119], v[44:47], v[36:39], v[116:119]
ds_read_b64_tr_b16 v[178:179], v16 offset:14336
ds_read_b64_tr_b16 v[180:181], v17 offset:12288
v_mfma_f32_16x16x32_bf16 v[112:115], v[40:43], v[36:39], v[112:115]
ds_read_b64_tr_b16 v[182:183], v17 offset:14336
ds_read_b64_tr_b16 v[184:185], v18 offset:12288
v_mfma_f32_16x16x32_bf16 v[96:99], v[64:67], v[56:59], v[96:99]
ds_read_b64_tr_b16 v[186:187], v18 offset:14336
ds_read_b64_tr_b16 v[188:189], v19 offset:12288
v_mfma_f32_16x16x32_bf16 v[100:103], v[68:71], v[56:59], v[100:103]
ds_read_b64_tr_b16 v[190:191], v19 offset:14336
ds_read_b128 v[172:175], v2 offset:58368
v_mfma_f32_16x16x32_bf16 v[104:107], v[72:75], v[56:59], v[104:107]
v_mfma_f32_16x16x32_bf16 v[108:111], v[76:79], v[56:59], v[108:111]
v_mfma_f32_16x16x32_bf16 v[124:127], v[76:79], v[60:63], v[124:127]
v_mfma_f32_16x16x32_bf16 v[120:123], v[72:75], v[60:63], v[120:123]
v_mfma_f32_16x16x32_bf16 v[116:119], v[68:71], v[60:63], v[116:119]
v_mfma_f32_16x16x32_bf16 v[112:115], v[64:67], v[60:63], v[112:115]
s_waitcnt lgkmcnt(0)
s_barrier
v_mfma_f32_16x16x32_bf16 v[96:99], v[152:155], v[144:147], v[96:99]
ds_read_b128 v[32:35], v3 offset:0
ds_read_b64_tr_b16 v[40:41], v16 offset:16384
v_mfma_f32_16x16x32_bf16 v[100:103], v[156:159], v[144:147], v[100:103]
ds_read_b64_tr_b16 v[42:43], v16 offset:18432
ds_read_b64_tr_b16 v[44:45], v17 offset:16384
v_mfma_f32_16x16x32_bf16 v[104:107], v[160:163], v[144:147], v[104:107]
ds_read_b64_tr_b16 v[46:47], v17 offset:18432
ds_read_b64_tr_b16 v[48:49], v18 offset:16384
v_mfma_f32_16x16x32_bf16 v[108:111], v[164:167], v[144:147], v[108:111]
ds_read_b64_tr_b16 v[50:51], v18 offset:18432
ds_read_b64_tr_b16 v[52:53], v19 offset:16384
v_mfma_f32_16x16x32_bf16 v[124:127], v[164:167], v[148:151], v[124:127]
ds_read_b64_tr_b16 v[54:55], v19 offset:18432
ds_read_b128 v[36:39], v3 offset:1024
v_mfma_f32_16x16x32_bf16 v[120:123], v[160:163], v[148:151], v[120:123]
ds_read_b128 v[56:59], v3 offset:8192
ds_read_b64_tr_b16 v[64:65], v16 offset:20480
v_mfma_f32_16x16x32_bf16 v[116:119], v[156:159], v[148:151], v[116:119]
ds_read_b64_tr_b16 v[66:67], v16 offset:22528
ds_read_b64_tr_b16 v[68:69], v17 offset:20480
v_mfma_f32_16x16x32_bf16 v[112:115], v[152:155], v[148:151], v[112:115]
ds_read_b64_tr_b16 v[70:71], v17 offset:22528
ds_read_b64_tr_b16 v[72:73], v18 offset:20480
v_mfma_f32_16x16x32_bf16 v[96:99], v[176:179], v[168:171], v[96:99]
ds_read_b64_tr_b16 v[74:75], v18 offset:22528
ds_read_b64_tr_b16 v[76:77], v19 offset:20480
v_mfma_f32_16x16x32_bf16 v[100:103], v[180:183], v[168:171], v[100:103]
ds_read_b64_tr_b16 v[78:79], v19 offset:22528
ds_read_b128 v[60:63], v3 offset:9216
v_mfma_f32_16x16x32_bf16 v[104:107], v[184:187], v[168:171], v[104:107]
v_mfma_f32_16x16x32_bf16 v[108:111], v[188:191], v[168:171], v[108:111]
v_mfma_f32_16x16x32_bf16 v[124:127], v[188:191], v[172:175], v[124:127]
v_mfma_f32_16x16x32_bf16 v[120:123], v[184:187], v[172:175], v[120:123]
v_mfma_f32_16x16x32_bf16 v[116:119], v[180:183], v[172:175], v[116:119]
v_mfma_f32_16x16x32_bf16 v[112:115], v[176:179], v[172:175], v[112:115]
s_waitcnt lgkmcnt(0)
s_barrier
v_mfma_f32_16x16x32_bf16 v[96:99], v[40:43], v[32:35], v[96:99]
ds_read_b128 v[144:147], v3 offset:49152
ds_read_b64_tr_b16 v[152:153], v16 offset:24576
v_mfma_f32_16x16x32_bf16 v[100:103], v[44:47], v[32:35], v[100:103]
ds_read_b64_tr_b16 v[154:155], v16 offset:26624
ds_read_b64_tr_b16 v[156:157], v17 offset:24576
v_mfma_f32_16x16x32_bf16 v[104:107], v[48:51], v[32:35], v[104:107]
ds_read_b64_tr_b16 v[158:159], v17 offset:26624
ds_read_b64_tr_b16 v[160:161], v18 offset:24576
v_mfma_f32_16x16x32_bf16 v[108:111], v[52:55], v[32:35], v[108:111]
ds_read_b64_tr_b16 v[162:163], v18 offset:26624
ds_read_b64_tr_b16 v[164:165], v19 offset:24576
v_mfma_f32_16x16x32_bf16 v[124:127], v[52:55], v[36:39], v[124:127]
ds_read_b64_tr_b16 v[166:167], v19 offset:26624
ds_read_b128 v[148:151], v3 offset:50176
v_mfma_f32_16x16x32_bf16 v[120:123], v[48:51], v[36:39], v[120:123]
ds_read_b128 v[168:171], v3 offset:57344
ds_read_b64_tr_b16 v[176:177], v16 offset:28672
v_mfma_f32_16x16x32_bf16 v[116:119], v[44:47], v[36:39], v[116:119]
ds_read_b64_tr_b16 v[178:179], v16 offset:30720
ds_read_b64_tr_b16 v[180:181], v17 offset:28672
v_mfma_f32_16x16x32_bf16 v[112:115], v[40:43], v[36:39], v[112:115]
ds_read_b64_tr_b16 v[182:183], v17 offset:30720
ds_read_b64_tr_b16 v[184:185], v18 offset:28672
v_mfma_f32_16x16x32_bf16 v[96:99], v[64:67], v[56:59], v[96:99]
ds_read_b64_tr_b16 v[186:187], v18 offset:30720
ds_read_b64_tr_b16 v[188:189], v19 offset:28672
v_mfma_f32_16x16x32_bf16 v[100:103], v[68:71], v[56:59], v[100:103]
ds_read_b64_tr_b16 v[190:191], v19 offset:30720
ds_read_b128 v[172:175], v3 offset:58368
v_mfma_f32_16x16x32_bf16 v[104:107], v[72:75], v[56:59], v[104:107]
v_mfma_f32_16x16x32_bf16 v[108:111], v[76:79], v[56:59], v[108:111]
v_mfma_f32_16x16x32_bf16 v[124:127], v[76:79], v[60:63], v[124:127]
v_mfma_f32_16x16x32_bf16 v[120:123], v[72:75], v[60:63], v[120:123]
v_mfma_f32_16x16x32_bf16 v[116:119], v[68:71], v[60:63], v[116:119]
v_mfma_f32_16x16x32_bf16 v[112:115], v[64:67], v[60:63], v[112:115]
s_waitcnt lgkmcnt(0)
s_barrier
v_mfma_f32_16x16x32_bf16 v[96:99], v[152:155], v[144:147], v[96:99]
ds_read_b128 v[32:35], v2 offset:0
ds_read_b64_tr_b16 v[40:41], v16 offset:49152
v_mfma_f32_16x16x32_bf16 v[100:103], v[156:159], v[144:147], v[100:103]
ds_read_b64_tr_b16 v[42:43], v16 offset:51200
ds_read_b64_tr_b16 v[44:45], v17 offset:49152
v_mfma_f32_16x16x32_bf16 v[104:107], v[160:163], v[144:147], v[104:107]
ds_read_b64_tr_b16 v[46:47], v17 offset:51200
ds_read_b64_tr_b16 v[48:49], v18 offset:49152
v_mfma_f32_16x16x32_bf16 v[108:111], v[164:167], v[144:147], v[108:111]
ds_read_b64_tr_b16 v[50:51], v18 offset:51200
ds_read_b64_tr_b16 v[52:53], v19 offset:49152
v_mfma_f32_16x16x32_bf16 v[124:127], v[164:167], v[148:151], v[124:127]
ds_read_b64_tr_b16 v[54:55], v19 offset:51200
ds_read_b128 v[36:39], v2 offset:1024
v_mfma_f32_16x16x32_bf16 v[120:123], v[160:163], v[148:151], v[120:123]
ds_read_b128 v[56:59], v2 offset:8192
ds_read_b64_tr_b16 v[64:65], v16 offset:53248
v_mfma_f32_16x16x32_bf16 v[116:119], v[156:159], v[148:151], v[116:119]
ds_read_b64_tr_b16 v[66:67], v16 offset:55296
ds_read_b64_tr_b16 v[68:69], v17 offset:53248
v_mfma_f32_16x16x32_bf16 v[112:115], v[152:155], v[148:151], v[112:115]
ds_read_b64_tr_b16 v[70:71], v17 offset:55296
ds_read_b64_tr_b16 v[72:73], v18 offset:53248
v_mfma_f32_16x16x32_bf16 v[96:99], v[176:179], v[168:171], v[96:99]
ds_read_b64_tr_b16 v[74:75], v18 offset:55296
ds_read_b64_tr_b16 v[76:77], v19 offset:53248
v_mfma_f32_16x16x32_bf16 v[100:103], v[180:183], v[168:171], v[100:103]
ds_read_b64_tr_b16 v[78:79], v19 offset:55296
ds_read_b128 v[60:63], v2 offset:9216
v_mfma_f32_16x16x32_bf16 v[104:107], v[184:187], v[168:171], v[104:107]
v_mfma_f32_16x16x32_bf16 v[108:111], v[188:191], v[168:171], v[108:111]
v_mfma_f32_16x16x32_bf16 v[124:127], v[188:191], v[172:175], v[124:127]
v_mfma_f32_16x16x32_bf16 v[120:123], v[184:187], v[172:175], v[120:123]
v_mfma_f32_16x16x32_bf16 v[116:119], v[180:183], v[172:175], v[116:119]
v_mfma_f32_16x16x32_bf16 v[112:115], v[176:179], v[172:175], v[112:115]
s_waitcnt lgkmcnt(0)
s_barrier
v_mfma_f32_16x16x32_bf16 v[96:99], v[40:43], v[32:35], v[96:99]
ds_read_b128 v[144:147], v2 offset:49152
ds_read_b64_tr_b16 v[152:153], v16 offset:57344
v_mfma_f32_16x16x32_bf16 v[100:103], v[44:47], v[32:35], v[100:103]
ds_read_b64_tr_b16 v[154:155], v16 offset:59392
ds_read_b64_tr_b16 v[156:157], v17 offset:57344
v_mfma_f32_16x16x32_bf16 v[104:107], v[48:51], v[32:35], v[104:107]
ds_read_b64_tr_b16 v[158:159], v17 offset:59392
ds_read_b64_tr_b16 v[160:161], v18 offset:57344
v_mfma_f32_16x16x32_bf16 v[108:111], v[52:55], v[32:35], v[108:111]
ds_read_b64_tr_b16 v[162:163], v18 offset:59392
ds_read_b64_tr_b16 v[164:165], v19 offset:57344
v_mfma_f32_16x16x32_bf16 v[124:127], v[52:55], v[36:39], v[124:127]
ds_read_b64_tr_b16 v[166:167], v19 offset:59392
ds_read_b128 v[148:151], v2 offset:50176
v_mfma_f32_16x16x32_bf16 v[120:123], v[48:51], v[36:39], v[120:123]
ds_read_b128 v[168:171], v2 offset:57344
ds_read_b64_tr_b16 v[176:177], v16 offset:61440
v_mfma_f32_16x16x32_bf16 v[116:119], v[44:47], v[36:39], v[116:119]
ds_read_b64_tr_b16 v[178:179], v16 offset:63488
ds_read_b64_tr_b16 v[180:181], v17 offset:61440
v_mfma_f32_16x16x32_bf16 v[112:115], v[40:43], v[36:39], v[112:115]
ds_read_b64_tr_b16 v[182:183], v17 offset:63488
ds_read_b64_tr_b16 v[184:185], v18 offset:61440
v_mfma_f32_16x16x32_bf16 v[96:99], v[64:67], v[56:59], v[96:99]
ds_read_b64_tr_b16 v[186:187], v18 offset:63488
ds_read_b64_tr_b16 v[188:189], v19 offset:61440
v_mfma_f32_16x16x32_bf16 v[100:103], v[68:71], v[56:59], v[100:103]
ds_read_b64_tr_b16 v[190:191], v19 offset:63488
ds_read_b128 v[172:175], v2 offset:58368
v_mfma_f32_16x16x32_bf16 v[104:107], v[72:75], v[56:59], v[104:107]
v_mfma_f32_16x16x32_bf16 v[108:111], v[76:79], v[56:59], v[108:111]
v_mfma_f32_16x16x32_bf16 v[124:127], v[76:79], v[60:63], v[124:127]
v_mfma_f32_16x16x32_bf16 v[120:123], v[72:75], v[60:63], v[120:123]
v_mfma_f32_16x16x32_bf16 v[116:119], v[68:71], v[60:63], v[116:119]
v_mfma_f32_16x16x32_bf16 v[112:115], v[64:67], v[60:63], v[112:115]
s_waitcnt lgkmcnt(0)
s_barrier
v_mfma_f32_16x16x32_bf16 v[96:99], v[152:155], v[144:147], v[96:99]
ds_read_b128 v[32:35], v3 offset:0
ds_read_b64_tr_b16 v[40:41], v20 offset:0
v_mfma_f32_16x16x32_bf16 v[100:103], v[156:159], v[144:147], v[100:103]
ds_read_b64_tr_b16 v[42:43], v20 offset:2048
ds_read_b64_tr_b16 v[44:45], v21 offset:0
v_mfma_f32_16x16x32_bf16 v[104:107], v[160:163], v[144:147], v[104:107]
ds_read_b64_tr_b16 v[46:47], v21 offset:2048
ds_read_b64_tr_b16 v[48:49], v22 offset:0
v_mfma_f32_16x16x32_bf16 v[108:111], v[164:167], v[144:147], v[108:111]
ds_read_b64_tr_b16 v[50:51], v22 offset:2048
ds_read_b64_tr_b16 v[52:53], v23 offset:0
v_mfma_f32_16x16x32_bf16 v[124:127], v[164:167], v[148:151], v[124:127]
ds_read_b64_tr_b16 v[54:55], v23 offset:2048
ds_read_b128 v[36:39], v3 offset:1024
v_mfma_f32_16x16x32_bf16 v[120:123], v[160:163], v[148:151], v[120:123]
ds_read_b128 v[56:59], v3 offset:8192
ds_read_b64_tr_b16 v[64:65], v20 offset:4096
v_mfma_f32_16x16x32_bf16 v[116:119], v[156:159], v[148:151], v[116:119]
ds_read_b64_tr_b16 v[66:67], v20 offset:6144
ds_read_b64_tr_b16 v[68:69], v21 offset:4096
v_mfma_f32_16x16x32_bf16 v[112:115], v[152:155], v[148:151], v[112:115]
s_branch Lov_5
.p2align 12
Lst_5_0:
s_branch Lwr_145
s_nop 0
Lov_5:
ds_read_b64_tr_b16 v[70:71], v21 offset:6144
ds_read_b64_tr_b16 v[72:73], v22 offset:4096
v_mfma_f32_16x16x32_bf16 v[96:99], v[176:179], v[168:171], v[96:99]
ds_read_b64_tr_b16 v[74:75], v22 offset:6144
ds_read_b64_tr_b16 v[76:77], v23 offset:4096
v_mfma_f32_16x16x32_bf16 v[100:103], v[180:183], v[168:171], v[100:103]
ds_read_b64_tr_b16 v[78:79], v23 offset:6144
ds_read_b128 v[60:63], v3 offset:9216
v_mfma_f32_16x16x32_bf16 v[104:107], v[184:187], v[168:171], v[104:107]
v_mfma_f32_16x16x32_bf16 v[108:111], v[188:191], v[168:171], v[108:111]
v_mfma_f32_16x16x32_bf16 v[124:127], v[188:191], v[172:175], v[124:127]
v_mfma_f32_16x16x32_bf16 v[120:123], v[184:187], v[172:175], v[120:123]
v_mfma_f32_16x16x32_bf16 v[116:119], v[180:183], v[172:175], v[116:119]
v_mfma_f32_16x16x32_bf16 v[112:115], v[176:179], v[172:175], v[112:115]
s_waitcnt lgkmcnt(0)
s_barrier
v_mfma_f32_16x16x32_bf16 v[96:99], v[40:43], v[32:35], v[96:99]
ds_read_b128 v[144:147], v3 offset:49152
ds_read_b64_tr_b16 v[152:153], v20 offset:8192
v_mfma_f32_16x16x32_bf16 v[100:103], v[44:47], v[32:35], v[100:103]
ds_read_b64_tr_b16 v[154:155], v20 offset:10240
ds_read_b64_tr_b16 v[156:157], v21 offset:8192
v_mfma_f32_16x16x32_bf16 v[104:107], v[48:51], v[32:35], v[104:107]
ds_read_b64_tr_b16 v[158:159], v21 offset:10240
ds_read_b64_tr_b16 v[160:161], v22 offset:8192
v_mfma_f32_16x16x32_bf16 v[108:111], v[52:55], v[32:35], v[108:111]
ds_read_b64_tr_b16 v[162:163], v22 offset:10240
ds_read_b64_tr_b16 v[164:165], v23 offset:8192
v_mfma_f32_16x16x32_bf16 v[124:127], v[52:55], v[36:39], v[124:127]
ds_read_b64_tr_b16 v[166:167], v23 offset:10240
ds_read_b128 v[148:151], v3 offset:50176
v_mfma_f32_16x16x32_bf16 v[120:123], v[48:51], v[36:39], v[120:123]
ds_read_b128 v[168:171], v3 offset:57344
ds_read_b64_tr_b16 v[176:177], v20 offset:12288
v_mfma_f32_16x16x32_bf16 v[116:119], v[44:47], v[36:39], v[116:119]
ds_read_b64_tr_b16 v[178:179], v20 offset:14336
ds_read_b64_tr_b16 v[180:181], v21 offset:12288
v_mfma_f32_16x16x32_bf16 v[112:115], v[40:43], v[36:39], v[112:115]
ds_read_b64_tr_b16 v[182:183], v21 offset:14336
ds_read_b64_tr_b16 v[184:185], v22 offset:12288
v_mfma_f32_16x16x32_bf16 v[96:99], v[64:67], v[56:59], v[96:99]
ds_read_b64_tr_b16 v[186:187], v22 offset:14336
ds_read_b64_tr_b16 v[188:189], v23 offset:12288
v_mfma_f32_16x16x32_bf16 v[100:103], v[68:71], v[56:59], v[100:103]
ds_read_b64_tr_b16 v[190:191], v23 offset:14336
ds_read_b128 v[172:175], v3 offset:58368
v_mfma_f32_16x16x32_bf16 v[104:107], v[72:75], v[56:59], v[104:107]
v_mfma_f32_16x16x32_bf16 v[108:111], v[76:79], v[56:59], v[108:111]
v_mfma_f32_16x16x32_bf16 v[124:127], v[76:79], v[60:63], v[124:127]
v_mfma_f32_16x16x32_bf16 v[120:123], v[72:75], v[60:63], v[120:123]
v_mfma_f32_16x16x32_bf16 v[116:119], v[68:71], v[60:63], v[116:119]
v_mfma_f32_16x16x32_bf16 v[112:115], v[64:67], v[60:63], v[112:115]
s_waitcnt lgkmcnt(0)
s_barrier
v_mfma_f32_16x16x32_bf16 v[96:99], v[152:155], v[144:147], v[96:99]
ds_read_b128 v[32:35], v2 offset:0
ds_read_b64_tr_b16 v[40:41], v4 offset:16384
v_mfma_f32_16x16x32_bf16 v[100:103], v[156:159], v[144:147], v[100:103]
ds_read_b64_tr_b16 v[42:43], v4 offset:18432
ds_read_b64_tr_b16 v[44:45], v5 offset:16384
v_mfma_f32_16x16x32_bf16 v[104:107], v[160:163], v[144:147], v[104:107]
ds_read_b64_tr_b16 v[46:47], v5 offset:18432
ds_read_b64_tr_b16 v[48:49], v6 offset:16384
v_mfma_f32_16x16x32_bf16 v[108:111], v[164:167], v[144:147], v[108:111]
ds_read_b64_tr_b16 v[50:51], v6 offset:18432
ds_read_b64_tr_b16 v[52:53], v7 offset:16384
v_mfma_f32_16x16x32_bf16 v[124:127], v[164:167], v[148:151], v[124:127]
ds_read_b64_tr_b16 v[54:55], v7 offset:18432
ds_read_b128 v[36:39], v2 offset:1024
v_mfma_f32_16x16x32_bf16 v[120:123], v[160:163], v[148:151], v[120:123]
ds_read_b128 v[56:59], v2 offset:8192
ds_read_b64_tr_b16 v[64:65], v4 offset:20480
v_mfma_f32_16x16x32_bf16 v[116:119], v[156:159], v[148:151], v[116:119]
ds_read_b64_tr_b16 v[66:67], v4 offset:22528
ds_read_b64_tr_b16 v[68:69], v5 offset:20480
v_mfma_f32_16x16x32_bf16 v[112:115], v[152:155], v[148:151], v[112:115]
ds_read_b64_tr_b16 v[70:71], v5 offset:22528
ds_read_b64_tr_b16 v[72:73], v6 offset:20480
v_mfma_f32_16x16x32_bf16 v[96:99], v[176:179], v[168:171], v[96:99]
ds_read_b64_tr_b16 v[74:75], v6 offset:22528
ds_read_b64_tr_b16 v[76:77], v7 offset:20480
v_mfma_f32_16x16x32_bf16 v[100:103], v[180:183], v[168:171], v[100:103]
ds_read_b64_tr_b16 v[78:79], v7 offset:22528
ds_read_b128 v[60:63], v2 offset:9216
v_mfma_f32_16x16x32_bf16 v[104:107], v[184:187], v[168:171], v[104:107]
v_mfma_f32_16x16x32_bf16 v[108:111], v[188:191], v[168:171], v[108:111]
v_mfma_f32_16x16x32_bf16 v[124:127], v[188:191], v[172:175], v[124:127]
v_mfma_f32_16x16x32_bf16 v[120:123], v[184:187], v[172:175], v[120:123]
v_mfma_f32_16x16x32_bf16 v[116:119], v[180:183], v[172:175], v[116:119]
v_mfma_f32_16x16x32_bf16 v[112:115], v[176:179], v[172:175], v[112:115]
s_waitcnt lgkmcnt(0)
s_barrier
v_mfma_f32_16x16x32_bf16 v[96:99], v[40:43], v[32:35], v[96:99]
ds_read_b128 v[144:147], v2 offset:49152
ds_read_b64_tr_b16 v[152:153], v4 offset:24576
v_mfma_f32_16x16x32_bf16 v[100:103], v[44:47], v[32:35], v[100:103]
ds_read_b64_tr_b16 v[154:155], v4 offset:26624
ds_read_b64_tr_b16 v[156:157], v5 offset:24576
v_mfma_f32_16x16x32_bf16 v[104:107], v[48:51], v[32:35], v[104:107]
ds_read_b64_tr_b16 v[158:159], v5 offset:26624
ds_read_b64_tr_b16 v[160:161], v6 offset:24576
v_mfma_f32_16x16x32_bf16 v[108:111], v[52:55], v[32:35], v[108:111]
ds_read_b64_tr_b16 v[162:163], v6 offset:26624
ds_read_b64_tr_b16 v[164:165], v7 offset:24576
v_mfma_f32_16x16x32_bf16 v[124:127], v[52:55], v[36:39], v[124:127]
ds_read_b64_tr_b16 v[166:167], v7 offset:26624
ds_read_b128 v[148:151], v2 offset:50176
v_mfma_f32_16x16x32_bf16 v[120:123], v[48:51], v[36:39], v[120:123]
ds_read_b128 v[168:171], v2 offset:57344
ds_read_b64_tr_b16 v[176:177], v4 offset:28672
v_mfma_f32_16x16x32_bf16 v[116:119], v[44:47], v[36:39], v[116:119]
ds_read_b64_tr_b16 v[178:179], v4 offset:30720
ds_read_b64_tr_b16 v[180:181], v5 offset:28672
v_mfma_f32_16x16x32_bf16 v[112:115], v[40:43], v[36:39], v[112:115]
ds_read_b64_tr_b16 v[182:183], v5 offset:30720
ds_read_b64_tr_b16 v[184:185], v6 offset:28672
v_mfma_f32_16x16x32_bf16 v[96:99], v[64:67], v[56:59], v[96:99]
ds_read_b64_tr_b16 v[186:187], v6 offset:30720
ds_read_b64_tr_b16 v[188:189], v7 offset:28672
v_mfma_f32_16x16x32_bf16 v[100:103], v[68:71], v[56:59], v[100:103]
ds_read_b64_tr_b16 v[190:191], v7 offset:30720
ds_read_b128 v[172:175], v2 offset:58368
v_mfma_f32_16x16x32_bf16 v[104:107], v[72:75], v[56:59], v[104:107]
v_mfma_f32_16x16x32_bf16 v[108:111], v[76:79], v[56:59], v[108:111]
v_mfma_f32_16x16x32_bf16 v[124:127], v[76:79], v[60:63], v[124:127]
v_mfma_f32_16x16x32_bf16 v[120:123], v[72:75], v[60:63], v[120:123]
v_mfma_f32_16x16x32_bf16 v[116:119], v[68:71], v[60:63], v[116:119]
v_mfma_f32_16x16x32_bf16 v[112:115], v[64:67], v[60:63], v[112:115]
s_waitcnt lgkmcnt(0)
s_barrier
v_mfma_f32_16x16x32_bf16 v[96:99], v[152:155], v[144:147], v[96:99]
ds_read_b128 v[32:35], v3 offset:0
ds_read_b64_tr_b16 v[40:41], v4 offset:32768
v_mfma_f32_16x16x32_bf16 v[100:103], v[156:159], v[144:147], v[100:103]
ds_read_b64_tr_b16 v[42:43], v4 offset:34816
ds_read_b64_tr_b16 v[44:45], v5 offset:32768
v_mfma_f32_16x16x32_bf16 v[104:107], v[160:163], v[144:147], v[104:107]
ds_read_b64_tr_b16 v[46:47], v5 offset:34816
ds_read_b64_tr_b16 v[48:49], v6 offset:32768
v_mfma_f32_16x16x32_bf16 v[108:111], v[164:167], v[144:147], v[108:111]
ds_read_b64_tr_b16 v[50:51], v6 offset:34816
ds_read_b64_tr_b16 v[52:53], v7 offset:32768
v_mfma_f32_16x16x32_bf16 v[124:127], v[164:167], v[148:151], v[124:127]
ds_read_b64_tr_b16 v[54:55], v7 offset:34816
ds_read_b128 v[36:39], v3 offset:1024
v_mfma_f32_16x16x32_bf16 v[120:123], v[160:163], v[148:151], v[120:123]
ds_read_b128 v[56:59], v3 offset:8192
ds_read_b64_tr_b16 v[64:65], v4 offset:36864
v_mfma_f32_16x16x32_bf16 v[116:119], v[156:159], v[148:151], v[116:119]
ds_read_b64_tr_b16 v[66:67], v4 offset:38912
ds_read_b64_tr_b16 v[68:69], v5 offset:36864
v_mfma_f32_16x16x32_bf16 v[112:115], v[152:155], v[148:151], v[112:115]
ds_read_b64_tr_b16 v[70:71], v5 offset:38912
ds_read_b64_tr_b16 v[72:73], v6 offset:36864
v_mfma_f32_16x16x32_bf16 v[96:99], v[176:179], v[168:171], v[96:99]
ds_read_b64_tr_b16 v[74:75], v6 offset:38912
ds_read_b64_tr_b16 v[76:77], v7 offset:36864
v_mfma_f32_16x16x32_bf16 v[100:103], v[180:183], v[168:171], v[100:103]
ds_read_b64_tr_b16 v[78:79], v7 offset:38912
ds_read_b128 v[60:63], v3 offset:9216
v_mfma_f32_16x16x32_bf16 v[104:107], v[184:187], v[168:171], v[104:107]
v_mfma_f32_16x16x32_bf16 v[108:111], v[188:191], v[168:171], v[108:111]
v_mfma_f32_16x16x32_bf16 v[124:127], v[188:191], v[172:175], v[124:127]
v_mfma_f32_16x16x32_bf16 v[120:123], v[184:187], v[172:175], v[120:123]
v_mfma_f32_16x16x32_bf16 v[116:119], v[180:183], v[172:175], v[116:119]
v_mfma_f32_16x16x32_bf16 v[112:115], v[176:179], v[172:175], v[112:115]
s_waitcnt lgkmcnt(0)
s_barrier
v_mfma_f32_16x16x32_bf16 v[96:99], v[40:43], v[32:35], v[96:99]
ds_read_b128 v[144:147], v3 offset:49152
ds_read_b64_tr_b16 v[152:153], v4 offset:40960
v_mfma_f32_16x16x32_bf16 v[100:103], v[44:47], v[32:35], v[100:103]
ds_read_b64_tr_b16 v[154:155], v4 offset:43008
ds_read_b64_tr_b16 v[156:157], v5 offset:40960
v_mfma_f32_16x16x32_bf16 v[104:107], v[48:51], v[32:35], v[104:107]
ds_read_b64_tr_b16 v[158:159], v5 offset:43008
ds_read_b64_tr_b16 v[160:161], v6 offset:40960
v_mfma_f32_16x16x32_bf16 v[108:111], v[52:55], v[32:35], v[108:111]
ds_read_b64_tr_b16 v[162:163], v6 offset:43008
ds_read_b64_tr_b16 v[164:165], v7 offset:40960
v_mfma_f32_16x16x32_bf16 v[124:127], v[52:55], v[36:39], v[124:127]
ds_read_b64_tr_b16 v[166:167], v7 offset:43008
ds_read_b128 v[148:151], v3 offset:50176
v_mfma_f32_16x16x32_bf16 v[120:123], v[48:51], v[36:39], v[120:123]
ds_read_b128 v[168:171], v3 offset:57344
ds_read_b64_tr_b16 v[176:177], v4 offset:45056
v_mfma_f32_16x16x32_bf16 v[116:119], v[44:47], v[36:39], v[116:119]
ds_read_b64_tr_b16 v[178:179], v4 offset:47104
ds_read_b64_tr_b16 v[180:181], v5 offset:45056
v_mfma_f32_16x16x32_bf16 v[112:115], v[40:43], v[36:39], v[112:115]
ds_read_b64_tr_b16 v[182:183], v5 offset:47104
ds_read_b64_tr_b16 v[184:185], v6 offset:45056
v_mfma_f32_16x16x32_bf16 v[96:99], v[64:67], v[56:59], v[96:99]
ds_read_b64_tr_b16 v[186:187], v6 offset:47104
ds_read_b64_tr_b16 v[188:189], v7 offset:45056
v_mfma_f32_16x16x32_bf16 v[100:103], v[68:71], v[56:59], v[100:103]
ds_read_b64_tr_b16 v[190:191], v7 offset:47104
ds_read_b128 v[172:175], v3 offset:58368
v_mfma_f32_16x16x32_bf16 v[104:107], v[72:75], v[56:59], v[104:107]
v_mfma_f32_16x16x32_bf16 v[108:111], v[76:79], v[56:59], v[108:111]
v_mfma_f32_16x16x32_bf16 v[124:127], v[76:79], v[60:63], v[124:127]
v_mfma_f32_16x16x32_bf16 v[120:123], v[72:75], v[60:63], v[120:123]
v_mfma_f32_16x16x32_bf16 v[116:119], v[68:71], v[60:63], v[116:119]
v_mfma_f32_16x16x32_bf16 v[112:115], v[64:67], v[60:63], v[112:115]
s_waitcnt lgkmcnt(0)
s_barrier
v_mfma_f32_16x16x32_bf16 v[96:99], v[152:155], v[144:147], v[96:99]
ds_read_b128 v[32:35], v2 offset:0
ds_read_b64_tr_b16 v[40:41], v16 offset:49152
v_mfma_f32_16x16x32_bf16 v[100:103], v[156:159], v[144:147], v[100:103]
ds_read_b64_tr_b16 v[42:43], v16 offset:51200
ds_read_b64_tr_b16 v[44:45], v17 offset:49152
v_mfma_f32_16x16x32_bf16 v[104:107], v[160:163], v[144:147], v[104:107]
ds_read_b64_tr_b16 v[46:47], v17 offset:51200
ds_read_b64_tr_b16 v[48:49], v18 offset:49152
v_mfma_f32_16x16x32_bf16 v[108:111], v[164:167], v[144:147], v[108:111]
ds_read_b64_tr_b16 v[50:51], v18 offset:51200
ds_read_b64_tr_b16 v[52:53], v19 offset:49152
v_mfma_f32_16x16x32_bf16 v[124:127], v[164:167], v[148:151], v[124:127]
ds_read_b64_tr_b16 v[54:55], v19 offset:51200
ds_read_b128 v[36:39], v2 offset:1024
v_mfma_f32_16x16x32_bf16 v[120:123], v[160:163], v[148:151], v[120:123]
ds_read_b128 v[56:59], v2 offset:8192
ds_read_b64_tr_b16 v[64:65], v16 offset:53248
v_mfma_f32_16x16x32_bf16 v[116:119], v[156:159], v[148:151], v[116:119]
ds_read_b64_tr_b16 v[66:67], v16 offset:55296
ds_read_b64_tr_b16 v[68:69], v17 offset:53248
v_mfma_f32_16x16x32_bf16 v[112:115], v[152:155], v[148:151], v[112:115]
ds_read_b64_tr_b16 v[70:71], v17 offset:55296
ds_read_b64_tr_b16 v[72:73], v18 offset:53248
v_mfma_f32_16x16x32_bf16 v[96:99], v[176:179], v[168:171], v[96:99]
ds_read_b64_tr_b16 v[74:75], v18 offset:55296
ds_read_b64_tr_b16 v[76:77], v19 offset:53248
v_mfma_f32_16x16x32_bf16 v[100:103], v[180:183], v[168:171], v[100:103]
ds_read_b64_tr_b16 v[78:79], v19 offset:55296
ds_read_b128 v[60:63], v2 offset:9216
v_mfma_f32_16x16x32_bf16 v[104:107], v[184:187], v[168:171], v[104:107]
v_mfma_f32_16x16x32_bf16 v[108:111], v[188:191], v[168:171], v[108:111]
v_mfma_f32_16x16x32_bf16 v[124:127], v[188:191], v[172:175], v[124:127]
v_mfma_f32_16x16x32_bf16 v[120:123], v[184:187], v[172:175], v[120:123]
v_mfma_f32_16x16x32_bf16 v[116:119], v[180:183], v[172:175], v[116:119]
v_mfma_f32_16x16x32_bf16 v[112:115], v[176:179], v[172:175], v[112:115]
s_waitcnt lgkmcnt(0)
s_barrier
v_mfma_f32_16x16x32_bf16 v[96:99], v[40:43], v[32:35], v[96:99]
ds_read_b128 v[144:147], v2 offset:49152
ds_read_b64_tr_b16 v[152:153], v16 offset:57344
v_mfma_f32_16x16x32_bf16 v[100:103], v[44:47], v[32:35], v[100:103]
ds_read_b64_tr_b16 v[154:155], v16 offset:59392
ds_read_b64_tr_b16 v[156:157], v17 offset:57344
v_mfma_f32_16x16x32_bf16 v[104:107], v[48:51], v[32:35], v[104:107]
ds_read_b64_tr_b16 v[158:159], v17 offset:59392
ds_read_b64_tr_b16 v[160:161], v18 offset:57344
v_mfma_f32_16x16x32_bf16 v[108:111], v[52:55], v[32:35], v[108:111]
ds_read_b64_tr_b16 v[162:163], v18 offset:59392
ds_read_b64_tr_b16 v[164:165], v19 offset:57344
v_mfma_f32_16x16x32_bf16 v[124:127], v[52:55], v[36:39], v[124:127]
ds_read_b64_tr_b16 v[166:167], v19 offset:59392
ds_read_b128 v[148:151], v2 offset:50176
v_mfma_f32_16x16x32_bf16 v[120:123], v[48:51], v[36:39], v[120:123]
ds_read_b128 v[168:171], v2 offset:57344
ds_read_b64_tr_b16 v[176:177], v16 offset:61440
v_mfma_f32_16x16x32_bf16 v[116:119], v[44:47], v[36:39], v[116:119]
ds_read_b64_tr_b16 v[178:179], v16 offset:63488
ds_read_b64_tr_b16 v[180:181], v17 offset:61440
v_mfma_f32_16x16x32_bf16 v[112:115], v[40:43], v[36:39], v[112:115]
ds_read_b64_tr_b16 v[182:183], v17 offset:63488
ds_read_b64_tr_b16 v[184:185], v18 offset:61440
v_mfma_f32_16x16x32_bf16 v[96:99], v[64:67], v[56:59], v[96:99]
ds_read_b64_tr_b16 v[186:187], v18 offset:63488
ds_read_b64_tr_b16 v[188:189], v19 offset:61440
v_mfma_f32_16x16x32_bf16 v[100:103], v[68:71], v[56:59], v[100:103]
ds_read_b64_tr_b16 v[190:191], v19 offset:63488
ds_read_b128 v[172:175], v2 offset:58368
v_mfma_f32_16x16x32_bf16 v[104:107], v[72:75], v[56:59], v[104:107]
v_mfma_f32_16x16x32_bf16 v[108:111], v[76:79], v[56:59], v[108:111]
v_mfma_f32_16x16x32_bf16 v[124:127], v[76:79], v[60:63], v[124:127]
v_mfma_f32_16x16x32_bf16 v[120:123], v[72:75], v[60:63], v[120:123]
v_mfma_f32_16x16x32_bf16 v[116:119], v[68:71], v[60:63], v[116:119]
v_mfma_f32_16x16x32_bf16 v[112:115], v[64:67], v[60:63], v[112:115]
s_waitcnt lgkmcnt(0)
s_barrier
v_mfma_f32_16x16x32_bf16 v[96:99], v[152:155], v[144:147], v[96:99]
ds_read_b128 v[32:35], v3 offset:0
ds_read_b64_tr_b16 v[40:41], v20 offset:0
v_mfma_f32_16x16x32_bf16 v[100:103], v[156:159], v[144:147], v[100:103]
ds_read_b64_tr_b16 v[42:43], v20 offset:2048
ds_read_b64_tr_b16 v[44:45], v21 offset:0
v_mfma_f32_16x16x32_bf16 v[104:107], v[160:163], v[144:147], v[104:107]
ds_read_b64_tr_b16 v[46:47], v21 offset:2048
ds_read_b64_tr_b16 v[48:49], v22 offset:0
v_mfma_f32_16x16x32_bf16 v[108:111], v[164:167], v[144:147], v[108:111]
ds_read_b64_tr_b16 v[50:51], v22 offset:2048
ds_read_b64_tr_b16 v[52:53], v23 offset:0
v_mfma_f32_16x16x32_bf16 v[124:127], v[164:167], v[148:151], v[124:127]
ds_read_b64_tr_b16 v[54:55], v23 offset:2048
ds_read_b128 v[36:39], v3 offset:1024
v_mfma_f32_16x16x32_bf16 v[120:123], v[160:163], v[148:151], v[120:123]
ds_read_b128 v[56:59], v3 offset:8192
ds_read_b64_tr_b16 v[64:65], v20 offset:4096
v_mfma_f32_16x16x32_bf16 v[116:119], v[156:159], v[148:151], v[116:119]
ds_read_b64_tr_b16 v[66:67], v20 offset:6144
ds_read_b64_tr_b16 v[68:69], v21 offset:4096
v_mfma_f32_16x16x32_bf16 v[112:115], v[152:155], v[148:151], v[112:115]
ds_read_b64_tr_b16 v[70:71], v21 offset:6144
ds_read_b64_tr_b16 v[72:73], v22 offset:4096
v_mfma_f32_16x16x32_bf16 v[96:99], v[176:179], v[168:171], v[96:99]
ds_read_b64_tr_b16 v[74:75], v22 offset:6144
ds_read_b64_tr_b16 v[76:77], v23 offset:4096
v_mfma_f32_16x16x32_bf16 v[100:103], v[180:183], v[168:171], v[100:103]
ds_read_b64_tr_b16 v[78:79], v23 offset:6144
ds_read_b128 v[60:63], v3 offset:9216
v_mfma_f32_16x16x32_bf16 v[104:107], v[184:187], v[168:171], v[104:107]
v_mfma_f32_16x16x32_bf16 v[108:111], v[188:191], v[168:171], v[108:111]
v_mfma_f32_16x16x32_bf16 v[124:127], v[188:191], v[172:175], v[124:127]
v_mfma_f32_16x16x32_bf16 v[120:123], v[184:187], v[172:175], v[120:123]
v_mfma_f32_16x16x32_bf16 v[116:119], v[180:183], v[172:175], v[116:119]
v_mfma_f32_16x16x32_bf16 v[112:115], v[176:179], v[172:175], v[112:115]
s_waitcnt lgkmcnt(0)
s_barrier
v_mfma_f32_16x16x32_bf16 v[96:99], v[40:43], v[32:35], v[96:99]
ds_read_b128 v[144:147], v3 offset:49152
ds_read_b64_tr_b16 v[152:153], v20 offset:8192
v_mfma_f32_16x16x32_bf16 v[100:103], v[44:47], v[32:35], v[100:103]
ds_read_b64_tr_b16 v[154:155], v20 offset:10240
ds_read_b64_tr_b16 v[156:157], v21 offset:8192
v_mfma_f32_16x16x32_bf16 v[104:107], v[48:51], v[32:35], v[104:107]
ds_read_b64_tr_b16 v[158:159], v21 offset:10240
ds_read_b64_tr_b16 v[160:161], v22 offset:8192
v_mfma_f32_16x16x32_bf16 v[108:111], v[52:55], v[32:35], v[108:111]
ds_read_b64_tr_b16 v[162:163], v22 offset:10240
ds_read_b64_tr_b16 v[164:165], v23 offset:8192
v_mfma_f32_16x16x32_bf16 v[124:127], v[52:55], v[36:39], v[124:127]
ds_read_b64_tr_b16 v[166:167], v23 offset:10240
ds_read_b128 v[148:151], v3 offset:50176
v_mfma_f32_16x16x32_bf16 v[120:123], v[48:51], v[36:39], v[120:123]
ds_read_b128 v[168:171], v3 offset:57344
ds_read_b64_tr_b16 v[176:177], v20 offset:12288
v_mfma_f32_16x16x32_bf16 v[116:119], v[44:47], v[36:39], v[116:119]
ds_read_b64_tr_b16 v[178:179], v20 offset:14336
ds_read_b64_tr_b16 v[180:181], v21 offset:12288
v_mfma_f32_16x16x32_bf16 v[112:115], v[40:43], v[36:39], v[112:115]
ds_read_b64_tr_b16 v[182:183], v21 offset:14336
ds_read_b64_tr_b16 v[184:185], v22 offset:12288
v_mfma_f32_16x16x32_bf16 v[96:99], v[64:67], v[56:59], v[96:99]
ds_read_b64_tr_b16 v[186:187], v22 offset:14336
ds_read_b64_tr_b16 v[188:189], v23 offset:12288
v_mfma_f32_16x16x32_bf16 v[100:103], v[68:71], v[56:59], v[100:103]
ds_read_b64_tr_b16 v[190:191], v23 offset:14336
ds_read_b128 v[172:175], v3 offset:58368
v_mfma_f32_16x16x32_bf16 v[104:107], v[72:75], v[56:59], v[104:107]
v_mfma_f32_16x16x32_bf16 v[108:111], v[76:79], v[56:59], v[108:111]
v_mfma_f32_16x16x32_bf16 v[124:127], v[76:79], v[60:63], v[124:127]
v_mfma_f32_16x16x32_bf16 v[120:123], v[72:75], v[60:63], v[120:123]
v_mfma_f32_16x16x32_bf16 v[116:119], v[68:71], v[60:63], v[116:119]
v_mfma_f32_16x16x32_bf16 v[112:115], v[64:67], v[60:63], v[112:115]
s_waitcnt lgkmcnt(0)
s_barrier
v_mfma_f32_16x16x32_bf16 v[96:99], v[152:155], v[144:147], v[96:99]
v_mfma_f32_16x16x32_bf16 v[100:103], v[156:159], v[144:147], v[100:103]
v_mfma_f32_16x16x32_bf16 v[104:107], v[160:163], v[144:147], v[104:107]
v_mfma_f32_16x16x32_bf16 v[108:111], v[164:167], v[144:147], v[108:111]
v_mfma_f32_16x16x32_bf16 v[124:127], v[164:167], v[148:151], v[124:127]
v_mfma_f32_16x16x32_bf16 v[120:123], v[160:163], v[148:151], v[120:123]
v_mfma_f32_16x16x32_bf16 v[116:119], v[156:159], v[148:151], v[116:119]
v_mfma_f32_16x16x32_bf16 v[112:115], v[152:155], v[148:151], v[112:115]
v_mfma_f32_16x16x32_bf16 v[96:99], v[176:179], v[168:171], v[96:99]
v_mfma_f32_16x16x32_bf16 v[100:103], v[180:183], v[168:171], v[100:103]
v_mfma_f32_16x16x32_bf16 v[104:107], v[184:187], v[168:171], v[104:107]
v_mfma_f32_16x16x32_bf16 v[108:111], v[188:191], v[168:171], v[108:111]
v_mfma_f32_16x16x32_bf16 v[124:127], v[188:191], v[172:175], v[124:127]
v_mfma_f32_16x16x32_bf16 v[120:123], v[184:187], v[172:175], v[120:123]
v_mfma_f32_16x16x32_bf16 v[116:119], v[180:183], v[172:175], v[116:119]
v_mfma_f32_16x16x32_bf16 v[112:115], v[176:179], v[172:175], v[112:115]
s_nop 3
v_cvt_pk_bf16_f32 v32, v96, v97
v_cvt_pk_bf16_f32 v33, v98, v99
v_cvt_pk_bf16_f32 v34, v100, v101
v_cvt_pk_bf16_f32 v35, v102, v103
s_add_u32 s43, s60, 0
buffer_store_dwordx4 v[32:35], v11, s[20:23], s43 offen offset:0 sc1
v_cvt_pk_bf16_f32 v36, v104, v105
v_cvt_pk_bf16_f32 v37, v106, v107
v_cvt_pk_bf16_f32 v38, v108, v109
v_cvt_pk_bf16_f32 v39, v110, v111
s_add_u32 s43, s60, 8192
buffer_store_dwordx4 v[36:39], v11, s[20:23], s43 offen offset:0 sc1
v_cvt_pk_bf16_f32 v44, v120, v121
v_cvt_pk_bf16_f32 v45, v122, v123
v_cvt_pk_bf16_f32 v46, v124, v125
v_cvt_pk_bf16_f32 v47, v126, v127
s_add_u32 s43, s60, 8192
buffer_store_dwordx4 v[44:47], v11, s[20:23], s43 offen offset:1024 sc1
v_cvt_pk_bf16_f32 v40, v112, v113
v_cvt_pk_bf16_f32 v41, v114, v115
v_cvt_pk_bf16_f32 v42, v116, v117
v_cvt_pk_bf16_f32 v43, v118, v119
s_add_u32 s43, s60, 0
buffer_store_dwordx4 v[40:43], v11, s[20:23], s43 offen offset:1024 sc1
v_mov_b32 v64, 0
v_mov_b32 v65, 0
v_mov_b32 v66, 0
v_mov_b32 v67, 0
v_mov_b32 v68, 0
v_mov_b32 v69, 0
v_mov_b32 v70, 0
v_mov_b32 v71, 0
v_dot2_f32_bf16 v64, v32, s61, v64
v_dot2_f32_bf16 v66, v32, v32, v66
v_dot2_f32_bf16 v68, v40, s61, v68
v_dot2_f32_bf16 v70, v40, v40, v70
v_dot2_f32_bf16 v65, v33, s61, v65
v_dot2_f32_bf16 v67, v33, v33, v67
v_dot2_f32_bf16 v69, v41, s61, v69
v_dot2_f32_bf16 v71, v41, v41, v71
v_dot2_f32_bf16 v64, v34, s61, v64
v_dot2_f32_bf16 v66, v34, v34, v66
v_dot2_f32_bf16 v68, v42, s61, v68
v_dot2_f32_bf16 v70, v42, v42, v70
v_dot2_f32_bf16 v65, v35, s61, v65
v_dot2_f32_bf16 v67, v35, v35, v67
v_dot2_f32_bf16 v69, v43, s61, v69
v_dot2_f32_bf16 v71, v43, v43, v71
v_dot2_f32_bf16 v64, v36, s61, v64
v_dot2_f32_bf16 v66, v36, v36, v66
v_dot2_f32_bf16 v68, v44, s61, v68
v_dot2_f32_bf16 v70, v44, v44, v70
v_dot2_f32_bf16 v65, v37, s61, v65
v_dot2_f32_bf16 v67, v37, v37, v67
v_dot2_f32_bf16 v69, v45, s61, v69
v_dot2_f32_bf16 v71, v45, v45, v71
v_dot2_f32_bf16 v64, v38, s61, v64
v_dot2_f32_bf16 v66, v38, v38, v66
v_dot2_f32_bf16 v68, v46, s61, v68
v_dot2_f32_bf16 v70, v46, v46, v70
v_dot2_f32_bf16 v65, v39, s61, v65
v_dot2_f32_bf16 v67, v39, v39, v67
v_dot2_f32_bf16 v69, v47, s61, v69
v_dot2_f32_bf16 v71, v47, v47, v71
s_nop 2
v_add_f32 v64, v64, v65
v_add_f32 v66, v66, v67
v_add_f32 v68, v68, v69
v_add_f32 v70, v70, v71
s_nop 1
v_permlane32_swap_b32 v64, v68
v_permlane32_swap_b32 v66, v70
v_add_f32 v64, v64, v68
v_add_f32 v66, v66, v70
s_nop 1
v_permlane16_swap_b32 v64, v66
v_add_f32 v64, v64, v66
buffer_store_dword v64, v9, s[24:27], 0 offen sc1
s_waitcnt vmcnt(0)
s_barrier
s_cmp_lg_u32 s36, 0
s_cbranch_scc1 Lk2end_86
s_add_u32 s7, s34, 16
s_lshl_b32 s7, s7, 7
v_mov_b32 v4, s7
v_mov_b32 v5, 1
s_mov_b64 exec, 1
buffer_atomic_add v5, v4, s[56:59], 0 offen sc1
s_mov_b64 exec, -1
s_branch Lk2end_86
Lprod_87:
s_mul_i32 s43, s34, 262144
s_add_u32 s8, s82, s43
s_addc_u32 s9, s83, 0
s_mov_b32 s10, 262144
s_mov_b32 s11, 0x20000
s_lshl_b32 s43, s35, 7
s_add_u32 s12, s68, s43
s_addc_u32 s13, s69, 0
s_mov_b32 s14, 2095232
s_mov_b32 s15, 0x20000
s_and_b32 s47, s36, 3
s_lshl_b32 s39, s47, 12
v_lshlrev_b32 v2, 4, v1
v_add_u32 v2, s39, v2
v_lshrrev_b32 v12, 3, v1
v_and_b32 v13, 6, v12
v_and_b32 v3, 7, v1
v_xor_b32 v3, v3, v13
v_lshlrev_b32 v3, 4, v3
v_mul_u32_u24 v12, 2048, v12
v_add_u32 v3, v3, v12
s_lshl_b32 s43, s47, 15
v_add_u32 v3, s43, v3
s_lshl_b32 s40, s47, 11
s_add_u32 s37, s35, 0
s_and_b32 s37, s37, 15
s_lshl_b32 s37, s37, 14
s_add_u32 m0, s39, 0
s_nop 0
buffer_load_dwordx4 v2, s[8:11], s37 offen offset:0 sc1 lds
buffer_load_dwordx4 v2, s[8:11], s37 offen offset:1024 sc1 lds
buffer_load_dwordx4 v2, s[8:11], s37 offen offset:2048 sc1 lds
buffer_load_dwordx4 v2, s[8:11], s37 offen offset:3072 sc1 lds
s_add_u32 s38, s35, 8
s_and_b32 s38, s38, 15
s_lshl_b32 s38, s38, 17
s_add_u32 m0, s40, 16384
s_nop 0
buffer_load_dwordx4 v3, s[12:15], s38 offen lds
s_add_u32 m0, s40, 17408
s_add_u32 s38, s38, 16384
buffer_load_dwordx4 v3, s[12:15], s38 offen lds
s_add_u32 s38, s35, 9
s_and_b32 s38, s38, 15
s_lshl_b32 s38, s38, 17
s_add_u32 m0, s40, 24576
s_nop 0
buffer_load_dwordx4 v3, s[12:15], s38 offen lds
s_add_u32 m0, s40, 25600
s_add_u32 s38, s38, 16384
buffer_load_dwordx4 v3, s[12:15], s38 offen lds
s_add_u32 s38, s35, 10
s_and_b32 s38, s38, 15
s_lshl_b32 s38, s38, 17
s_add_u32 m0, s40, 32768
s_nop 0
buffer_load_dwordx4 v3, s[12:15], s38 offen lds
s_add_u32 m0, s40, 33792
s_add_u32 s38, s38, 16384
buffer_load_dwordx4 v3, s[12:15], s38 offen lds
s_add_u32 s38, s35, 11
s_and_b32 s38, s38, 15
s_lshl_b32 s38, s38, 17
s_add_u32 m0, s40, 40960
s_nop 0
buffer_load_dwordx4 v3, s[12:15], s38 offen lds
s_add_u32 m0, s40, 41984
s_add_u32 s38, s38, 16384
buffer_load_dwordx4 v3, s[12:15], s38 offen lds
s_bitcmp0_b32 s36, 1
s_cselect_b32 s44, s72, s74
s_cselect_b32 s45, s73, s75
s_mul_i32 s43, s35, 192
s_add_u32 s88, s44, s43
s_addc_u32 s89, s45, 0
s_add_u32 s88, s88, 4096
s_addc_u32 s89, s89, 0
s_mov_b32 s90, 7333056
s_mov_b32 s91, 0x20000
v_add_u32 v11, 0, v1
v_mul_u32_u24 v12, 5462, v11
v_lshrrev_b32 v12, 16, v12
v_mul_u32_u24 v13, 12, v12
v_sub_u32 v13, v11, v13
v_bfe_u32 v14, v12, 2, 1
v_cmp_gt_u32 vcc, 8, v13
v_lshlrev_b32 v15, 1, v14
v_mul_u32_u24 v12, 7168, v12
v_cndmask_b32 v14, v14, v15, vcc
v_xor_b32 v13, v13, v14
v_lshl_add_u32 v8, v13, 4, v12
v_add_u32 v11, 64, v1
v_mul_u32_u24 v12, 5462, v11
v_lshrrev_b32 v12, 16, v12
v_mul_u32_u24 v13, 12, v12
v_sub_u32 v13, v11, v13
v_bfe_u32 v14, v12, 2, 1
v_cmp_gt_u32 vcc, 8, v13
v_lshlrev_b32 v15, 1, v14
v_mul_u32_u24 v12, 7168, v12
v_cndmask_b32 v14, v14, v15, vcc
v_xor_b32 v13, v13, v14
v_lshl_add_u32 v9, v13, 4, v12
s_branch Lov_6
.p2align 12
Lst_6_0:
s_branch Lwr_146
s_nop 0
Lov_6:
v_add_u32 v11, 128, v1
v_mul_u32_u24 v12, 5462, v11
v_lshrrev_b32 v12, 16, v12
v_mul_u32_u24 v13, 12, v12
v_sub_u32 v13, v11, v13
v_bfe_u32 v14, v12, 2, 1
v_cmp_gt_u32 vcc, 8, v13
v_lshlrev_b32 v15, 1, v14
v_mul_u32_u24 v12, 7168, v12
v_cndmask_b32 v14, v14, v15, vcc
v_xor_b32 v13, v13, v14
v_lshl_add_u32 v10, v13, 4, v12
s_and_b32 s43, s36, 1
s_mul_i32 s43, s43, 229376
v_add_u32 v8, s43, v8
v_add_u32 v9, s43, v9
v_add_u32 v10, s43, v10
s_and_b32 s43, s36, 3
s_mul_i32 s46, s43, 6144
s_add_u32 s46, s46, 16384
s_cmp_eq_u32 s47, 3
s_cbranch_scc0 Lw_89
s_lshl_b32 s92, s34, 7
s_add_u32 s92, s92, 28311552
s_mov_b32 s41, 0x40000
Lpoll_90:
s_load_dword s93, s[82:83], s92 glc
Lpchk_92:
s_waitcnt lgkmcnt(0)
s_cmp_eq_u32 s93, 16
s_cbranch_scc1 Lpok_91
s_sub_u32 s41, s41, 1
s_cmp_lg_u32 s41, 0
s_cbranch_scc1 Lpoll_90
Lpok_91:
Lw_89:
s_and_b32 s44, s36, 3
s_mul_i32 s44, s44, 14
s_bfe_u32 s43, s2, 0x30001
s_lshl_b32 s43, s43, 7
s_add_u32 s44, s44, s43
s_add_u32 s44, s44, 72
s_mul_i32 s44, s44, 7168
s_lshr_b32 s43, s2, 4
s_lshl_b32 s43, s43, 8
s_add_u32 s43, s43, s44
s_bitcmp0_b32 s2, 0
s_cselect_b32 s4, s72, s74
s_cselect_b32 s5, s73, s75
s_add_u32 s4, s4, s43
s_addc_u32 s5, s5, 0
s_cmp_eq_u32 s47, 3
s_cbranch_scc1 Lw_93
s_load_dword s3, s[4:5], 0
s_load_dword s3, s[4:5], 64
s_load_dword s3, s[4:5], 128
s_load_dword s3, s[4:5], 192
s_load_dword s3, s[4:5], 7168
s_load_dword s3, s[4:5], 7232
s_load_dword s3, s[4:5], 7296
s_load_dword s3, s[4:5], 7360
s_load_dword s3, s[4:5], 14336
s_load_dword s3, s[4:5], 14400
s_load_dword s3, s[4:5], 14464
s_load_dword s3, s[4:5], 14528
s_load_dword s3, s[4:5], 21504
s_load_dword s3, s[4:5], 21568
Lw_93:
s_waitcnt vmcnt(8)
s_barrier
s_add_u32 s37, s35, 1
s_and_b32 s37, s37, 15
s_lshl_b32 s37, s37, 14
s_add_u32 m0, s39, 49152
s_nop 0
buffer_load_dwordx4 v2, s[8:11], s37 offen offset:0 sc1 lds
buffer_load_dwordx4 v2, s[8:11], s37 offen offset:1024 sc1 lds
buffer_load_dwordx4 v2, s[8:11], s37 offen offset:2048 sc1 lds
buffer_load_dwordx4 v2, s[8:11], s37 offen offset:3072 sc1 lds
s_add_u32 s37, s35, 2
s_and_b32 s37, s37, 15
s_lshl_b32 s37, s37, 14
s_add_u32 m0, s39, 98304
s_nop 0
buffer_load_dwordx4 v2, s[8:11], s37 offen offset:0 sc1 lds
buffer_load_dwordx4 v2, s[8:11], s37 offen offset:1024 sc1 lds
buffer_load_dwordx4 v2, s[8:11], s37 offen offset:2048 sc1 lds
buffer_load_dwordx4 v2, s[8:11], s37 offen offset:3072 sc1 lds
s_add_u32 s37, s35, 3
s_and_b32 s37, s37, 15
s_lshl_b32 s37, s37, 14
s_add_u32 m0, s39, 147456
s_nop 0
buffer_load_dwordx4 v2, s[8:11], s37 offen offset:0 sc1 lds
buffer_load_dwordx4 v2, s[8:11], s37 offen offset:1024 sc1 lds
buffer_load_dwordx4 v2, s[8:11], s37 offen offset:2048 sc1 lds
buffer_load_dwordx4 v2, s[8:11], s37 offen offset:3072 sc1 lds
s_cmp_eq_u32 s47, 3
s_cbranch_scc0 Lw_94
s_load_dword s3, s[4:5], 0
s_load_dword s3, s[4:5], 64
s_load_dword s3, s[4:5], 128
s_load_dword s3, s[4:5], 192
s_load_dword s3, s[4:5], 7168
s_load_dword s3, s[4:5], 7232
s_load_dword s3, s[4:5], 7296
s_load_dword s3, s[4:5], 7360
s_load_dword s3, s[4:5], 14336
s_load_dword s3, s[4:5], 14400
s_load_dword s3, s[4:5], 14464
s_load_dword s3, s[4:5], 14528
s_load_dword s3, s[4:5], 21504
s_load_dword s3, s[4:5], 21568
Lw_94:
s_waitcnt vmcnt(8)
s_barrier
s_add_u32 s37, s35, 4
s_and_b32 s37, s37, 15
s_lshl_b32 s37, s37, 14
s_add_u32 m0, s39, 0
s_nop 0
buffer_load_dwordx4 v2, s[8:11], s37 offen offset:0 sc1 lds
buffer_load_dwordx4 v2, s[8:11], s37 offen offset:1024 sc1 lds
buffer_load_dwordx4 v2, s[8:11], s37 offen offset:2048 sc1 lds
buffer_load_dwordx4 v2, s[8:11], s37 offen offset:3072 sc1 lds
v_lshlrev_b32 v240, 16, v128
v_and_b32 v241, 0xffff0000, v128
v_lshlrev_b32 v242, 16, v129
v_and_b32 v243, 0xffff0000, v129
v_lshlrev_b32 v244, 16, v130
v_and_b32 v245, 0xffff0000, v130
v_lshlrev_b32 v246, 16, v131
v_and_b32 v247, 0xffff0000, v131
s_load_dword s3, s[4:5], 21632
s_load_dword s3, s[4:5], 21696
s_load_dword s3, s[4:5], 28672
s_waitcnt vmcnt(8)
s_barrier
s_add_u32 s37, s35, 5
s_and_b32 s37, s37, 15
s_lshl_b32 s37, s37, 14
s_add_u32 m0, s39, 49152
s_nop 0
buffer_load_dwordx4 v2, s[8:11], s37 offen offset:0 sc1 lds
buffer_load_dwordx4 v2, s[8:11], s37 offen offset:1024 sc1 lds
buffer_load_dwordx4 v2, s[8:11], s37 offen offset:2048 sc1 lds
buffer_load_dwordx4 v2, s[8:11], s37 offen offset:3072 sc1 lds
v_lshlrev_b32 v24, 16, v132
v_and_b32 v25, 0xffff0000, v132
v_lshlrev_b32 v26, 16, v133
v_and_b32 v27, 0xffff0000, v133
v_lshlrev_b32 v28, 16, v134
v_and_b32 v29, 0xffff0000, v134
v_lshlrev_b32 v30, 16, v135
v_and_b32 v31, 0xffff0000, v135
v_add_f32 v240, v240, v24
v_add_f32 v241, v241, v25
v_add_f32 v242, v242, v26
v_add_f32 v243, v243, v27
v_add_f32 v244, v244, v28
v_add_f32 v245, v245, v29
v_add_f32 v246, v246, v30
v_add_f32 v247, v247, v31
s_load_dword s3, s[4:5], 28736
s_load_dword s3, s[4:5], 28800
s_load_dword s3, s[4:5], 28864
s_waitcnt vmcnt(8)
s_barrier
s_add_u32 s37, s35, 6
s_and_b32 s37, s37, 15
s_lshl_b32 s37, s37, 14
s_add_u32 m0, s39, 98304
s_nop 0
buffer_load_dwordx4 v2, s[8:11], s37 offen offset:0 sc1 lds
buffer_load_dwordx4 v2, s[8:11], s37 offen offset:1024 sc1 lds
buffer_load_dwordx4 v2, s[8:11], s37 offen offset:2048 sc1 lds
buffer_load_dwordx4 v2, s[8:11], s37 offen offset:3072 sc1 lds
v_lshlrev_b32 v24, 16, v136
v_and_b32 v25, 0xffff0000, v136
v_lshlrev_b32 v26, 16, v137
v_and_b32 v27, 0xffff0000, v137
v_lshlrev_b32 v28, 16, v138
v_and_b32 v29, 0xffff0000, v138
v_lshlrev_b32 v30, 16, v139
v_and_b32 v31, 0xffff0000, v139
v_add_f32 v240, v240, v24
v_add_f32 v241, v241, v25
v_add_f32 v242, v242, v26
v_add_f32 v243, v243, v27
v_add_f32 v244, v244, v28
v_add_f32 v245, v245, v29
v_add_f32 v246, v246, v30
v_add_f32 v247, v247, v31
s_load_dword s3, s[4:5], 35840
s_load_dword s3, s[4:5], 35904
s_load_dword s3, s[4:5], 35968
s_waitcnt vmcnt(8)
s_barrier
s_add_u32 s37, s35, 7
s_and_b32 s37, s37, 15
s_lshl_b32 s37, s37, 14
s_add_u32 m0, s39, 147456
s_nop 0
buffer_load_dwordx4 v2, s[8:11], s37 offen offset:0 sc1 lds
buffer_load_dwordx4 v2, s[8:11], s37 offen offset:1024 sc1 lds
buffer_load_dwordx4 v2, s[8:11], s37 offen offset:2048 sc1 lds
buffer_load_dwordx4 v2, s[8:11], s37 offen offset:3072 sc1 lds
v_lshlrev_b32 v24, 16, v140
v_and_b32 v25, 0xffff0000, v140
v_lshlrev_b32 v26, 16, v141
v_and_b32 v27, 0xffff0000, v141
v_lshlrev_b32 v28, 16, v142
v_and_b32 v29, 0xffff0000, v142
v_lshlrev_b32 v30, 16, v143
v_and_b32 v31, 0xffff0000, v143
v_add_f32 v240, v240, v24
v_add_f32 v241, v241, v25
v_add_f32 v242, v242, v26
v_add_f32 v243, v243, v27
v_add_f32 v244, v244, v28
v_add_f32 v245, v245, v29
v_add_f32 v246, v246, v30
v_add_f32 v247, v247, v31
s_load_dword s3, s[4:5], 36032
s_load_dword s3, s[4:5], 43008
s_load_dword s3, s[4:5], 43072
s_waitcnt vmcnt(8)
s_barrier
s_add_u32 s37, s35, 8
s_and_b32 s37, s37, 15
s_lshl_b32 s37, s37, 14
s_add_u32 m0, s39, 0
s_nop 0
buffer_load_dwordx4 v2, s[8:11], s37 offen offset:0 sc1 lds
buffer_load_dwordx4 v2, s[8:11], s37 offen offset:1024 sc1 lds
buffer_load_dwordx4 v2, s[8:11], s37 offen offset:2048 sc1 lds
buffer_load_dwordx4 v2, s[8:11], s37 offen offset:3072 sc1 lds
s_add_u32 s38, s35, 12
s_and_b32 s38, s38, 15
s_lshl_b32 s38, s38, 17
s_add_u32 m0, s40, 114688
s_nop 0
buffer_load_dwordx4 v3, s[12:15], s38 offen lds
s_add_u32 m0, s40, 115712
s_add_u32 s38, s38, 16384
buffer_load_dwordx4 v3, s[12:15], s38 offen lds
v_lshlrev_b32 v24, 16, v144
v_and_b32 v25, 0xffff0000, v144
v_lshlrev_b32 v26, 16, v145
v_and_b32 v27, 0xffff0000, v145
v_lshlrev_b32 v28, 16, v146
v_and_b32 v29, 0xffff0000, v146
v_lshlrev_b32 v30, 16, v147
v_and_b32 v31, 0xffff0000, v147
v_add_f32 v240, v240, v24
v_add_f32 v241, v241, v25
v_add_f32 v242, v242, v26
v_add_f32 v243, v243, v27
v_add_f32 v244, v244, v28
v_add_f32 v245, v245, v29
v_add_f32 v246, v246, v30
v_add_f32 v247, v247, v31
s_load_dword s3, s[4:5], 43136
s_load_dword s3, s[4:5], 43200
s_load_dword s3, s[4:5], 50176
s_waitcnt vmcnt(10)
s_barrier
s_add_u32 s37, s35, 9
s_and_b32 s37, s37, 15
s_lshl_b32 s37, s37, 14
s_add_u32 m0, s39, 49152
s_nop 0
buffer_load_dwordx4 v2, s[8:11], s37 offen offset:0 sc1 lds
buffer_load_dwordx4 v2, s[8:11], s37 offen offset:1024 sc1 lds
buffer_load_dwordx4 v2, s[8:11], s37 offen offset:2048 sc1 lds
buffer_load_dwordx4 v2, s[8:11], s37 offen offset:3072 sc1 lds
s_add_u32 s38, s35, 13
s_and_b32 s38, s38, 15
s_lshl_b32 s38, s38, 17
s_add_u32 m0, s40, 122880
s_nop 0
buffer_load_dwordx4 v3, s[12:15], s38 offen lds
s_add_u32 m0, s40, 123904
s_add_u32 s38, s38, 16384
buffer_load_dwordx4 v3, s[12:15], s38 offen lds
v_lshlrev_b32 v24, 16, v148
v_and_b32 v25, 0xffff0000, v148
v_lshlrev_b32 v26, 16, v149
v_and_b32 v27, 0xffff0000, v149
v_lshlrev_b32 v28, 16, v150
v_and_b32 v29, 0xffff0000, v150
v_lshlrev_b32 v30, 16, v151
v_and_b32 v31, 0xffff0000, v151
v_add_f32 v240, v240, v24
v_add_f32 v241, v241, v25
v_add_f32 v242, v242, v26
v_add_f32 v243, v243, v27
v_add_f32 v244, v244, v28
v_add_f32 v245, v245, v29
v_add_f32 v246, v246, v30
v_add_f32 v247, v247, v31
s_load_dword s3, s[4:5], 50240
s_load_dword s3, s[4:5], 50304
s_load_dword s3, s[4:5], 50368
s_waitcnt vmcnt(12)
s_barrier
s_add_u32 s37, s35, 10
s_and_b32 s37, s37, 15
s_lshl_b32 s37, s37, 14
s_add_u32 m0, s39, 98304
s_nop 0
buffer_load_dwordx4 v2, s[8:11], s37 offen offset:0 sc1 lds
buffer_load_dwordx4 v2, s[8:11], s37 offen offset:1024 sc1 lds
buffer_load_dwordx4 v2, s[8:11], s37 offen offset:2048 sc1 lds
buffer_load_dwordx4 v2, s[8:11], s37 offen offset:3072 sc1 lds
s_add_u32 s38, s35, 14
s_and_b32 s38, s38, 15
s_lshl_b32 s38, s38, 17
s_add_u32 m0, s40, 131072
s_nop 0
buffer_load_dwordx4 v3, s[12:15], s38 offen lds
s_add_u32 m0, s40, 132096
s_add_u32 s38, s38, 16384
buffer_load_dwordx4 v3, s[12:15], s38 offen lds
v_lshlrev_b32 v24, 16, v152
v_and_b32 v25, 0xffff0000, v152
v_lshlrev_b32 v26, 16, v153
v_and_b32 v27, 0xffff0000, v153
v_lshlrev_b32 v28, 16, v154
v_and_b32 v29, 0xffff0000, v154
v_lshlrev_b32 v30, 16, v155
v_and_b32 v31, 0xffff0000, v155
v_add_f32 v240, v240, v24
v_add_f32 v241, v241, v25
v_add_f32 v242, v242, v26
v_add_f32 v243, v243, v27
v_add_f32 v244, v244, v28
v_add_f32 v245, v245, v29
v_add_f32 v246, v246, v30
v_add_f32 v247, v247, v31
s_load_dword s3, s[4:5], 57344
s_load_dword s3, s[4:5], 57408
s_load_dword s3, s[4:5], 57472
s_waitcnt vmcnt(14)
s_barrier
s_add_u32 s37, s35, 11
s_and_b32 s37, s37, 15
s_lshl_b32 s37, s37, 14
s_add_u32 m0, s39, 147456
s_nop 0
buffer_load_dwordx4 v2, s[8:11], s37 offen offset:0 sc1 lds
buffer_load_dwordx4 v2, s[8:11], s37 offen offset:1024 sc1 lds
buffer_load_dwordx4 v2, s[8:11], s37 offen offset:2048 sc1 lds
buffer_load_dwordx4 v2, s[8:11], s37 offen offset:3072 sc1 lds
s_add_u32 s38, s35, 15
s_and_b32 s38, s38, 15
s_lshl_b32 s38, s38, 17
s_add_u32 m0, s40, 139264
s_nop 0
buffer_load_dwordx4 v3, s[12:15], s38 offen lds
s_add_u32 m0, s40, 140288
s_add_u32 s38, s38, 16384
buffer_load_dwordx4 v3, s[12:15], s38 offen lds
v_lshlrev_b32 v24, 16, v156
v_and_b32 v25, 0xffff0000, v156
v_lshlrev_b32 v26, 16, v157
v_and_b32 v27, 0xffff0000, v157
v_lshlrev_b32 v28, 16, v158
v_and_b32 v29, 0xffff0000, v158
v_lshlrev_b32 v30, 16, v159
v_and_b32 v31, 0xffff0000, v159
v_add_f32 v240, v240, v24
v_add_f32 v241, v241, v25
v_add_f32 v242, v242, v26
v_add_f32 v243, v243, v27
v_add_f32 v244, v244, v28
v_add_f32 v245, v245, v29
v_add_f32 v246, v246, v30
v_add_f32 v247, v247, v31
s_load_dword s3, s[4:5], 57536
s_load_dword s3, s[4:5], 64512
s_load_dword s3, s[4:5], 64576
s_waitcnt vmcnt(14)
s_barrier
s_add_u32 s37, s35, 12
s_and_b32 s37, s37, 15
s_lshl_b32 s37, s37, 14
s_add_u32 m0, s39, 0
s_nop 0
buffer_load_dwordx4 v2, s[8:11], s37 offen offset:0 sc1 lds
buffer_load_dwordx4 v2, s[8:11], s37 offen offset:1024 sc1 lds
buffer_load_dwordx4 v2, s[8:11], s37 offen offset:2048 sc1 lds
buffer_load_dwordx4 v2, s[8:11], s37 offen offset:3072 sc1 lds
s_load_dword s3, s[4:5], 64640
s_load_dword s3, s[4:5], 64704
s_load_dword s3, s[4:5], 71680
s_waitcnt vmcnt(12)
s_barrier
s_add_u32 s37, s35, 13
s_and_b32 s37, s37, 15
s_lshl_b32 s37, s37, 14
s_add_u32 m0, s39, 49152
s_nop 0
buffer_load_dwordx4 v2, s[8:11], s37 offen offset:0 sc1 lds
buffer_load_dwordx4 v2, s[8:11], s37 offen offset:1024 sc1 lds
buffer_load_dwordx4 v2, s[8:11], s37 offen offset:2048 sc1 lds
buffer_load_dwordx4 v2, s[8:11], s37 offen offset:3072 sc1 lds
s_load_dword s3, s[4:5], 71744
s_load_dword s3, s[4:5], 71808
s_load_dword s3, s[4:5], 71872
s_waitcnt vmcnt(10)
s_barrier
s_add_u32 s37, s35, 14
s_and_b32 s37, s37, 15
s_lshl_b32 s37, s37, 14
s_add_u32 m0, s39, 98304
s_nop 0
buffer_load_dwordx4 v2, s[8:11], s37 offen offset:0 sc1 lds
buffer_load_dwordx4 v2, s[8:11], s37 offen offset:1024 sc1 lds
buffer_load_dwordx4 v2, s[8:11], s37 offen offset:2048 sc1 lds
buffer_load_dwordx4 v2, s[8:11], s37 offen offset:3072 sc1 lds
s_waitcnt vmcnt(8)
s_barrier
s_add_u32 s37, s35, 15
s_and_b32 s37, s37, 15
s_lshl_b32 s37, s37, 14
s_add_u32 m0, s39, 147456
s_nop 0
buffer_load_dwordx4 v2, s[8:11], s37 offen offset:0 sc1 lds
buffer_load_dwordx4 v2, s[8:11], s37 offen offset:1024 sc1 lds
buffer_load_dwordx4 v2, s[8:11], s37 offen offset:2048 sc1 lds
buffer_load_dwordx4 v2, s[8:11], s37 offen offset:3072 sc1 lds
s_waitcnt vmcnt(8)
s_barrier
s_nop 0
v_permlane32_swap_b32 v240, v244
v_permlane32_swap_b32 v241, v245
v_permlane32_swap_b32 v242, v246
v_permlane32_swap_b32 v243, v247
v_add_f32 v240, v240, v244
v_add_f32 v241, v241, v245
v_add_f32 v242, v242, v246
v_add_f32 v243, v243, v247
s_nop 0
v_permlane16_swap_b32 v240, v242
v_permlane16_swap_b32 v241, v243
v_add_f32 v240, v240, v242
v_add_f32 v241, v241, v243
s_waitcnt vmcnt(4)
s_barrier
s_add_u32 s38, s35, 0
s_and_b32 s38, s38, 15
s_mul_i32 s38, s38, 458752
s_add_u32 m0, s46, 0
s_nop 0
buffer_load_dwordx4 v8, s[88:91], s38 offen lds
s_add_u32 m0, s46, 1024
s_nop 0
buffer_load_dwordx4 v9, s[88:91], s38 offen lds
s_add_u32 m0, s46, 2048
s_nop 0
buffer_load_dwordx4 v10, s[88:91], s38 offen lds
s_add_u32 m0, s46, 3072
s_add_u32 s38, s38, 114688
buffer_load_dwordx4 v8, s[88:91], s38 offen lds
s_add_u32 m0, s46, 4096
s_nop 0
buffer_load_dwordx4 v9, s[88:91], s38 offen lds
s_add_u32 m0, s46, 5120
s_nop 0
buffer_load_dwordx4 v10, s[88:91], s38 offen lds
s_add_u32 s38, s35, 1
s_and_b32 s38, s38, 15
s_mul_i32 s38, s38, 458752
s_add_u32 m0, s46, 49152
s_nop 0
buffer_load_dwordx4 v8, s[88:91], s38 offen lds
s_add_u32 m0, s46, 50176
s_nop 0
buffer_load_dwordx4 v9, s[88:91], s38 offen lds
s_add_u32 m0, s46, 51200
s_nop 0
buffer_load_dwordx4 v10, s[88:91], s38 offen lds
s_add_u32 m0, s46, 52224
s_add_u32 s38, s38, 114688
buffer_load_dwordx4 v8, s[88:91], s38 offen lds
s_add_u32 m0, s46, 53248
s_nop 0
buffer_load_dwordx4 v9, s[88:91], s38 offen lds
s_add_u32 m0, s46, 54272
s_nop 0
buffer_load_dwordx4 v10, s[88:91], s38 offen lds
s_waitcnt vmcnt(12)
s_barrier
s_barrier
s_branch Lk3
Lk2end_86:
Lk3:
s_mul_i32 s43, s34, 262144
s_add_u32 s8, s82, s43
s_addc_u32 s9, s83, 0
s_add_u32 s8, s8, 4194304
s_addc_u32 s9, s9, 0
s_mov_b32 s10, 262144
s_mov_b32 s11, 0x20000
s_mul_i32 s43, s34, 917504
s_add_u32 s24, s82, s43
s_addc_u32 s25, s83, 0
s_add_u32 s24, s24, 8388608
s_addc_u32 s25, s25, 0
s_mov_b32 s26, 917504
s_mov_b32 s27, 0x20000
s_add_u32 s84, s82, 27262976
s_addc_u32 s85, s83, 0
s_mov_b32 s86, 229376
s_mov_b32 s87, 0x20000
s_and_b32 s47, s36, 3
s_lshr_b32 s62, s47, 1
s_and_b32 s63, s47, 1
v_lshlrev_b32 v2, 4, v1
s_lshl_b32 s39, s47, 12
v_add_u32 v3, s39, v2
s_cmp_eq_u32 s62, 0
s_cselect_b32 s44, s72, s74
s_cselect_b32 s45, s73, s75
s_lshl_b32 s43, s35, 8
s_add_u32 s12, s44, s43
s_addc_u32 s13, s45, 0
s_mov_b32 s14, 7333120
s_mov_b32 s15, 0x20000
v_lshrrev_b32 v28, 4, v1
v_lshlrev_b32 v29, 1, v28
v_and_b32 v4, 15, v1
v_xor_b32 v4, v4, v29
v_lshlrev_b32 v4, 4, v4
v_mul_u32_u24 v28, 7168, v28
v_add_u32 v4, v4, v28
s_mul_i32 s43, s63, 229376
v_add_u32 v4, s43, v4
v_xor_b32 v5, 128, v4
v_add_u32 v5, 28672, v5
s_lshl_b32 s40, s47, 13
s_add_u32 s40, s40, 16384
s_lshl_b32 s43, s62, 12
v_add_u32 v9, s43, v2
v_add_u32 v10, 98304, v9
s_cmp_lt_u32 s36, 4
s_cbranch_scc1 Lgb_95
s_lshl_b32 s43, s47, 9
s_add_u32 s43, s43, 151552
v_and_b32 v28, 15, v1
v_lshl_add_u32 v28, v28, 5, s43
v_lshrrev_b32 v29, 4, v1
v_lshl_add_u32 v28, v29, 3, v28
ds_write_b64 v28, v[240:241]
s_waitcnt lgkmcnt(0)
v_lshrrev_b32 v27, 2, v1
v_bfe_u32 v28, v27, 2, 1
v_mul_u32_u24 v27, 192, v27
v_add_u32 v27, 16384, v27
v_and_b32 v29, 3, v1
v_lshl_add_u32 v12, v29, 3, v27
s_lshl_b32 s43, s63, 6
v_add_u32 v12, s43, v12
v_lshl_add_u32 v11, v28, 5, v12
v_xor_b32 v30, 1, v28
v_lshl_add_u32 v12, v30, 5, v12
v_xor_b32 v28, s63, v28
v_lshl_add_u32 v27, v28, 4, v27
v_lshrrev_b32 v28, 1, v29
v_lshl_add_u32 v27, v28, 5, v27
v_and_b32 v28, 1, v29
v_lshl_add_u32 v27, v28, 3, v27
v_add_u32 v13, 128, v27
v_add_u32 v14, 49152, v11
v_add_u32 v15, 49152, v12
v_add_u32 v16, 49152, v13
v_add_u32 v17, 98304, v11
v_add_u32 v18, 98304, v12
v_add_u32 v19, 98304, v13
v_bfe_u32 v28, v1, 3, 1
v_lshlrev_b32 v28, 6, v28
v_bfe_u32 v29, v1, 1, 2
s_lshl_b32 s43, s48, 3
s_lshl_b32 s44, s63, 2
s_add_u32 s43, s43, s44
v_add3_u32 v28, v28, v29, s43
v_mul_u32_u24 v28, 7168, v28
v_and_b32 v29, 1, v1
v_mul_u32_u24 v29, 188, v29
v_add_u32 v20, v28, v29
s_cmp_lg_u32 s36, 4
s_cbranch_scc1 Lwm_97
s_branch Lst_7_0
Lwr_148:
s_branch Lwe_96
Lwm_97:
s_cmp_lg_u32 s36, 5
s_cbranch_scc1 Lwm_98
s_branch Lst_8_0
Lwr_149:
s_branch Lwe_96
Lwm_98:
s_cmp_lg_u32 s36, 6
s_cbranch_scc1 Lwm_99
s_branch Lst_9_0
Lwr_150:
s_branch Lwe_96
Lwm_99:
s_cmp_lg_u32 s36, 7
s_cbranch_scc1 Lwm_100
s_nop 0
s_branch Lwe_96
Lwm_100:
Lwe_96:
s_barrier
s_cmp_lg_u32 s36, 4
s_cbranch_scc1 Lwm_102
s_branch Lst_10_0
Lwr_152:
s_branch Lwe_101
Lwm_102:
s_cmp_lg_u32 s36, 5
s_cbranch_scc1 Lwm_103
s_branch Lst_11_0
Lwr_153:
s_branch Lwe_101
Lwm_103:
s_cmp_lg_u32 s36, 6
s_cbranch_scc1 Lwm_104
s_branch Lst_12_0
Lwr_154:
s_branch Lwe_101
Lwm_104:
s_cmp_lg_u32 s36, 7
s_cbranch_scc1 Lwm_105
s_branch Lst_13_0
Lwr_155:
s_branch Lwe_101
Lwm_105:
Lwe_101:
s_waitcnt vmcnt(0) lgkmcnt(0)
s_barrier
ds_read_b128 v[32:35], v9 offset:0
ds_read_b64_tr_b16 v[48:49], v11 offset:0
ds_read_b64_tr_b16 v[50:51], v11 offset:3072
ds_read_b64_tr_b16 v[52:53], v12 offset:0
ds_read_b64_tr_b16 v[54:55], v12 offset:3072
ds_read_b64_tr_b16 v[56:57], v13 offset:0
ds_read_b64_tr_b16 v[58:59], v13 offset:3072
ds_read_b64_tr_b16 v[60:61], v11 offset:12288
ds_read_b64_tr_b16 v[62:63], v11 offset:15360
ds_read_b64_tr_b16 v[64:65], v12 offset:12288
ds_read_b64_tr_b16 v[66:67], v12 offset:15360
ds_read_b64_tr_b16 v[68:69], v13 offset:12288
ds_read_b64_tr_b16 v[70:71], v13 offset:15360
ds_read_b128 v[36:39], v9 offset:1024
ds_read_b128 v[40:43], v9 offset:2048
ds_read_b128 v[44:47], v9 offset:3072
s_waitcnt lgkmcnt(0)
v_mfma_f32_16x16x32_bf16 v[128:131], v[48:51], v[32:35], 0
ds_read_b128 v[72:75], v9 offset:8192
v_mfma_f32_16x16x32_bf16 v[132:135], v[52:55], v[32:35], 0
ds_read_b64_tr_b16 v[88:89], v11 offset:6144
v_mfma_f32_16x16x32_bf16 v[136:139], v[56:59], v[32:35], 0
ds_read_b64_tr_b16 v[90:91], v11 offset:9216
v_mfma_f32_16x16x32_bf16 v[140:143], v[60:63], v[32:35], 0
ds_read_b64_tr_b16 v[92:93], v12 offset:6144
v_mfma_f32_16x16x32_bf16 v[144:147], v[64:67], v[32:35], 0
ds_read_b64_tr_b16 v[94:95], v12 offset:9216
v_mfma_f32_16x16x32_bf16 v[148:151], v[68:71], v[32:35], 0
ds_read_b64_tr_b16 v[96:97], v13 offset:6144
v_mfma_f32_16x16x32_bf16 v[172:175], v[68:71], v[36:39], 0
ds_read_b64_tr_b16 v[98:99], v13 offset:9216
v_mfma_f32_16x16x32_bf16 v[168:171], v[64:67], v[36:39], 0
ds_read_b64_tr_b16 v[100:101], v11 offset:18432
v_mfma_f32_16x16x32_bf16 v[164:167], v[60:63], v[36:39], 0
ds_read_b64_tr_b16 v[102:103], v11 offset:21504
v_mfma_f32_16x16x32_bf16 v[160:163], v[56:59], v[36:39], 0
ds_read_b64_tr_b16 v[104:105], v12 offset:18432
v_mfma_f32_16x16x32_bf16 v[156:159], v[52:55], v[36:39], 0
ds_read_b64_tr_b16 v[106:107], v12 offset:21504
v_mfma_f32_16x16x32_bf16 v[152:155], v[48:51], v[36:39], 0
ds_read_b64_tr_b16 v[108:109], v13 offset:18432
v_mfma_f32_16x16x32_bf16 v[176:179], v[48:51], v[40:43], 0
ds_read_b64_tr_b16 v[110:111], v13 offset:21504
v_mfma_f32_16x16x32_bf16 v[180:183], v[52:55], v[40:43], 0
ds_read_b128 v[76:79], v9 offset:9216
v_mfma_f32_16x16x32_bf16 v[184:187], v[56:59], v[40:43], 0
ds_read_b128 v[80:83], v9 offset:10240
v_mfma_f32_16x16x32_bf16 v[188:191], v[60:63], v[40:43], 0
ds_read_b128 v[84:87], v9 offset:11264
v_mfma_f32_16x16x32_bf16 v[192:195], v[64:67], v[40:43], 0
v_mfma_f32_16x16x32_bf16 v[196:199], v[68:71], v[40:43], 0
v_mfma_f32_16x16x32_bf16 v[220:223], v[68:71], v[44:47], 0
v_mfma_f32_16x16x32_bf16 v[216:219], v[64:67], v[44:47], 0
v_mfma_f32_16x16x32_bf16 v[212:215], v[60:63], v[44:47], 0
v_mfma_f32_16x16x32_bf16 v[208:211], v[56:59], v[44:47], 0
v_mfma_f32_16x16x32_bf16 v[204:207], v[52:55], v[44:47], 0
v_mfma_f32_16x16x32_bf16 v[200:203], v[48:51], v[44:47], 0
s_waitcnt lgkmcnt(0)
s_barrier
v_mfma_f32_16x16x32_bf16 v[128:131], v[88:91], v[72:75], v[128:131]
ds_read_b128 v[32:35], v9 offset:49152
v_mfma_f32_16x16x32_bf16 v[132:135], v[92:95], v[72:75], v[132:135]
ds_read_b64_tr_b16 v[48:49], v14 offset:0
v_mfma_f32_16x16x32_bf16 v[136:139], v[96:99], v[72:75], v[136:139]
ds_read_b64_tr_b16 v[50:51], v14 offset:3072
v_mfma_f32_16x16x32_bf16 v[140:143], v[100:103], v[72:75], v[140:143]
ds_read_b64_tr_b16 v[52:53], v15 offset:0
v_mfma_f32_16x16x32_bf16 v[144:147], v[104:107], v[72:75], v[144:147]
ds_read_b64_tr_b16 v[54:55], v15 offset:3072
s_branch Lov_7
.p2align 12
Lst_7_0:
s_branch Lwr_148
s_nop 0
Lov_7:
v_mfma_f32_16x16x32_bf16 v[148:151], v[108:111], v[72:75], v[148:151]
ds_read_b64_tr_b16 v[56:57], v16 offset:0
v_mfma_f32_16x16x32_bf16 v[172:175], v[108:111], v[76:79], v[172:175]
ds_read_b64_tr_b16 v[58:59], v16 offset:3072
v_mfma_f32_16x16x32_bf16 v[168:171], v[104:107], v[76:79], v[168:171]
ds_read_b64_tr_b16 v[60:61], v14 offset:12288
v_mfma_f32_16x16x32_bf16 v[164:167], v[100:103], v[76:79], v[164:167]
ds_read_b64_tr_b16 v[62:63], v14 offset:15360
v_mfma_f32_16x16x32_bf16 v[160:163], v[96:99], v[76:79], v[160:163]
ds_read_b64_tr_b16 v[64:65], v15 offset:12288
v_mfma_f32_16x16x32_bf16 v[156:159], v[92:95], v[76:79], v[156:159]
ds_read_b64_tr_b16 v[66:67], v15 offset:15360
v_mfma_f32_16x16x32_bf16 v[152:155], v[88:91], v[76:79], v[152:155]
ds_read_b64_tr_b16 v[68:69], v16 offset:12288
v_mfma_f32_16x16x32_bf16 v[176:179], v[88:91], v[80:83], v[176:179]
ds_read_b64_tr_b16 v[70:71], v16 offset:15360
v_mfma_f32_16x16x32_bf16 v[180:183], v[92:95], v[80:83], v[180:183]
ds_read_b128 v[36:39], v9 offset:50176
v_mfma_f32_16x16x32_bf16 v[184:187], v[96:99], v[80:83], v[184:187]
ds_read_b128 v[40:43], v9 offset:51200
v_mfma_f32_16x16x32_bf16 v[188:191], v[100:103], v[80:83], v[188:191]
ds_read_b128 v[44:47], v9 offset:52224
v_mfma_f32_16x16x32_bf16 v[192:195], v[104:107], v[80:83], v[192:195]
v_mfma_f32_16x16x32_bf16 v[196:199], v[108:111], v[80:83], v[196:199]
v_mfma_f32_16x16x32_bf16 v[220:223], v[108:111], v[84:87], v[220:223]
v_mfma_f32_16x16x32_bf16 v[216:219], v[104:107], v[84:87], v[216:219]
v_mfma_f32_16x16x32_bf16 v[212:215], v[100:103], v[84:87], v[212:215]
v_mfma_f32_16x16x32_bf16 v[208:211], v[96:99], v[84:87], v[208:211]
v_mfma_f32_16x16x32_bf16 v[204:207], v[92:95], v[84:87], v[204:207]
v_mfma_f32_16x16x32_bf16 v[200:203], v[88:91], v[84:87], v[200:203]
s_mov_b32 s41, 5
Lk3l_106:
s_waitcnt lgkmcnt(0)
v_mfma_f32_16x16x32_bf16 v[128:131], v[48:51], v[32:35], v[128:131]
ds_read_b128 v[72:75], v9 offset:57344
v_mfma_f32_16x16x32_bf16 v[132:135], v[52:55], v[32:35], v[132:135]
ds_read_b64_tr_b16 v[88:89], v14 offset:6144
v_mfma_f32_16x16x32_bf16 v[136:139], v[56:59], v[32:35], v[136:139]
ds_read_b64_tr_b16 v[90:91], v14 offset:9216
v_mfma_f32_16x16x32_bf16 v[140:143], v[60:63], v[32:35], v[140:143]
ds_read_b64_tr_b16 v[92:93], v15 offset:6144
v_mfma_f32_16x16x32_bf16 v[144:147], v[64:67], v[32:35], v[144:147]
ds_read_b64_tr_b16 v[94:95], v15 offset:9216
v_mfma_f32_16x16x32_bf16 v[148:151], v[68:71], v[32:35], v[148:151]
ds_read_b64_tr_b16 v[96:97], v16 offset:6144
v_mfma_f32_16x16x32_bf16 v[172:175], v[68:71], v[36:39], v[172:175]
ds_read_b64_tr_b16 v[98:99], v16 offset:9216
v_mfma_f32_16x16x32_bf16 v[168:171], v[64:67], v[36:39], v[168:171]
ds_read_b64_tr_b16 v[100:101], v14 offset:18432
v_mfma_f32_16x16x32_bf16 v[164:167], v[60:63], v[36:39], v[164:167]
ds_read_b64_tr_b16 v[102:103], v14 offset:21504
v_mfma_f32_16x16x32_bf16 v[160:163], v[56:59], v[36:39], v[160:163]
ds_read_b64_tr_b16 v[104:105], v15 offset:18432
v_mfma_f32_16x16x32_bf16 v[156:159], v[52:55], v[36:39], v[156:159]
ds_read_b64_tr_b16 v[106:107], v15 offset:21504
v_mfma_f32_16x16x32_bf16 v[152:155], v[48:51], v[36:39], v[152:155]
ds_read_b64_tr_b16 v[108:109], v16 offset:18432
v_mfma_f32_16x16x32_bf16 v[176:179], v[48:51], v[40:43], v[176:179]
ds_read_b64_tr_b16 v[110:111], v16 offset:21504
v_mfma_f32_16x16x32_bf16 v[180:183], v[52:55], v[40:43], v[180:183]
ds_read_b128 v[76:79], v9 offset:58368
v_mfma_f32_16x16x32_bf16 v[184:187], v[56:59], v[40:43], v[184:187]
ds_read_b128 v[80:83], v9 offset:59392
v_mfma_f32_16x16x32_bf16 v[188:191], v[60:63], v[40:43], v[188:191]
ds_read_b128 v[84:87], v9 offset:60416
v_mfma_f32_16x16x32_bf16 v[192:195], v[64:67], v[40:43], v[192:195]
v_mfma_f32_16x16x32_bf16 v[196:199], v[68:71], v[40:43], v[196:199]
v_mfma_f32_16x16x32_bf16 v[220:223], v[68:71], v[44:47], v[220:223]
v_mfma_f32_16x16x32_bf16 v[216:219], v[64:67], v[44:47], v[216:219]
v_mfma_f32_16x16x32_bf16 v[212:215], v[60:63], v[44:47], v[212:215]
v_mfma_f32_16x16x32_bf16 v[208:211], v[56:59], v[44:47], v[208:211]
v_mfma_f32_16x16x32_bf16 v[204:207], v[52:55], v[44:47], v[204:207]
v_mfma_f32_16x16x32_bf16 v[200:203], v[48:51], v[44:47], v[200:203]
s_waitcnt lgkmcnt(0)
s_barrier
v_mfma_f32_16x16x32_bf16 v[128:131], v[88:91], v[72:75], v[128:131]
ds_read_b128 v[32:35], v10 offset:0
v_mfma_f32_16x16x32_bf16 v[132:135], v[92:95], v[72:75], v[132:135]
ds_read_b64_tr_b16 v[48:49], v17 offset:0
v_mfma_f32_16x16x32_bf16 v[136:139], v[96:99], v[72:75], v[136:139]
ds_read_b64_tr_b16 v[50:51], v17 offset:3072
v_mfma_f32_16x16x32_bf16 v[140:143], v[100:103], v[72:75], v[140:143]
ds_read_b64_tr_b16 v[52:53], v18 offset:0
v_mfma_f32_16x16x32_bf16 v[144:147], v[104:107], v[72:75], v[144:147]
ds_read_b64_tr_b16 v[54:55], v18 offset:3072
v_mfma_f32_16x16x32_bf16 v[148:151], v[108:111], v[72:75], v[148:151]
ds_read_b64_tr_b16 v[56:57], v19 offset:0
v_mfma_f32_16x16x32_bf16 v[172:175], v[108:111], v[76:79], v[172:175]
ds_read_b64_tr_b16 v[58:59], v19 offset:3072
v_mfma_f32_16x16x32_bf16 v[168:171], v[104:107], v[76:79], v[168:171]
ds_read_b64_tr_b16 v[60:61], v17 offset:12288
v_mfma_f32_16x16x32_bf16 v[164:167], v[100:103], v[76:79], v[164:167]
ds_read_b64_tr_b16 v[62:63], v17 offset:15360
v_mfma_f32_16x16x32_bf16 v[160:163], v[96:99], v[76:79], v[160:163]
ds_read_b64_tr_b16 v[64:65], v18 offset:12288
v_mfma_f32_16x16x32_bf16 v[156:159], v[92:95], v[76:79], v[156:159]
ds_read_b64_tr_b16 v[66:67], v18 offset:15360
v_mfma_f32_16x16x32_bf16 v[152:155], v[88:91], v[76:79], v[152:155]
ds_read_b64_tr_b16 v[68:69], v19 offset:12288
v_mfma_f32_16x16x32_bf16 v[176:179], v[88:91], v[80:83], v[176:179]
ds_read_b64_tr_b16 v[70:71], v19 offset:15360
v_mfma_f32_16x16x32_bf16 v[180:183], v[92:95], v[80:83], v[180:183]
ds_read_b128 v[36:39], v10 offset:1024
v_mfma_f32_16x16x32_bf16 v[184:187], v[96:99], v[80:83], v[184:187]
ds_read_b128 v[40:43], v10 offset:2048
v_mfma_f32_16x16x32_bf16 v[188:191], v[100:103], v[80:83], v[188:191]
ds_read_b128 v[44:47], v10 offset:3072
v_mfma_f32_16x16x32_bf16 v[192:195], v[104:107], v[80:83], v[192:195]
v_mfma_f32_16x16x32_bf16 v[196:199], v[108:111], v[80:83], v[196:199]
v_mfma_f32_16x16x32_bf16 v[220:223], v[108:111], v[84:87], v[220:223]
v_mfma_f32_16x16x32_bf16 v[216:219], v[104:107], v[84:87], v[216:219]
v_mfma_f32_16x16x32_bf16 v[212:215], v[100:103], v[84:87], v[212:215]
v_mfma_f32_16x16x32_bf16 v[208:211], v[96:99], v[84:87], v[208:211]
v_mfma_f32_16x16x32_bf16 v[204:207], v[92:95], v[84:87], v[204:207]
v_mfma_f32_16x16x32_bf16 v[200:203], v[88:91], v[84:87], v[200:203]
s_waitcnt lgkmcnt(0)
v_mfma_f32_16x16x32_bf16 v[128:131], v[48:51], v[32:35], v[128:131]
ds_read_b128 v[72:75], v10 offset:8192
v_mfma_f32_16x16x32_bf16 v[132:135], v[52:55], v[32:35], v[132:135]
ds_read_b64_tr_b16 v[88:89], v17 offset:6144
v_mfma_f32_16x16x32_bf16 v[136:139], v[56:59], v[32:35], v[136:139]
ds_read_b64_tr_b16 v[90:91], v17 offset:9216
v_mfma_f32_16x16x32_bf16 v[140:143], v[60:63], v[32:35], v[140:143]
ds_read_b64_tr_b16 v[92:93], v18 offset:6144
v_mfma_f32_16x16x32_bf16 v[144:147], v[64:67], v[32:35], v[144:147]
ds_read_b64_tr_b16 v[94:95], v18 offset:9216
v_mfma_f32_16x16x32_bf16 v[148:151], v[68:71], v[32:35], v[148:151]
ds_read_b64_tr_b16 v[96:97], v19 offset:6144
v_mfma_f32_16x16x32_bf16 v[172:175], v[68:71], v[36:39], v[172:175]
ds_read_b64_tr_b16 v[98:99], v19 offset:9216
v_mfma_f32_16x16x32_bf16 v[168:171], v[64:67], v[36:39], v[168:171]
ds_read_b64_tr_b16 v[100:101], v17 offset:18432
v_mfma_f32_16x16x32_bf16 v[164:167], v[60:63], v[36:39], v[164:167]
ds_read_b64_tr_b16 v[102:103], v17 offset:21504
v_mfma_f32_16x16x32_bf16 v[160:163], v[56:59], v[36:39], v[160:163]
ds_read_b64_tr_b16 v[104:105], v18 offset:18432
v_mfma_f32_16x16x32_bf16 v[156:159], v[52:55], v[36:39], v[156:159]
ds_read_b64_tr_b16 v[106:107], v18 offset:21504
v_mfma_f32_16x16x32_bf16 v[152:155], v[48:51], v[36:39], v[152:155]
ds_read_b64_tr_b16 v[108:109], v19 offset:18432
v_mfma_f32_16x16x32_bf16 v[176:179], v[48:51], v[40:43], v[176:179]
ds_read_b64_tr_b16 v[110:111], v19 offset:21504
v_mfma_f32_16x16x32_bf16 v[180:183], v[52:55], v[40:43], v[180:183]
ds_read_b128 v[76:79], v10 offset:9216
v_mfma_f32_16x16x32_bf16 v[184:187], v[56:59], v[40:43], v[184:187]
ds_read_b128 v[80:83], v10 offset:10240
v_mfma_f32_16x16x32_bf16 v[188:191], v[60:63], v[40:43], v[188:191]
ds_read_b128 v[84:87], v10 offset:11264
v_mfma_f32_16x16x32_bf16 v[192:195], v[64:67], v[40:43], v[192:195]
v_mfma_f32_16x16x32_bf16 v[196:199], v[68:71], v[40:43], v[196:199]
v_mfma_f32_16x16x32_bf16 v[220:223], v[68:71], v[44:47], v[220:223]
v_mfma_f32_16x16x32_bf16 v[216:219], v[64:67], v[44:47], v[216:219]
v_mfma_f32_16x16x32_bf16 v[212:215], v[60:63], v[44:47], v[212:215]
v_mfma_f32_16x16x32_bf16 v[208:211], v[56:59], v[44:47], v[208:211]
v_mfma_f32_16x16x32_bf16 v[204:207], v[52:55], v[44:47], v[204:207]
v_mfma_f32_16x16x32_bf16 v[200:203], v[48:51], v[44:47], v[200:203]
s_waitcnt lgkmcnt(0)
s_barrier
v_mfma_f32_16x16x32_bf16 v[128:131], v[88:91], v[72:75], v[128:131]
ds_read_b128 v[32:35], v9 offset:0
v_mfma_f32_16x16x32_bf16 v[132:135], v[92:95], v[72:75], v[132:135]
ds_read_b64_tr_b16 v[48:49], v11 offset:0
v_mfma_f32_16x16x32_bf16 v[136:139], v[96:99], v[72:75], v[136:139]
ds_read_b64_tr_b16 v[50:51], v11 offset:3072
v_mfma_f32_16x16x32_bf16 v[140:143], v[100:103], v[72:75], v[140:143]
ds_read_b64_tr_b16 v[52:53], v12 offset:0
v_mfma_f32_16x16x32_bf16 v[144:147], v[104:107], v[72:75], v[144:147]
ds_read_b64_tr_b16 v[54:55], v12 offset:3072
v_mfma_f32_16x16x32_bf16 v[148:151], v[108:111], v[72:75], v[148:151]
ds_read_b64_tr_b16 v[56:57], v13 offset:0
v_mfma_f32_16x16x32_bf16 v[172:175], v[108:111], v[76:79], v[172:175]
ds_read_b64_tr_b16 v[58:59], v13 offset:3072
v_mfma_f32_16x16x32_bf16 v[168:171], v[104:107], v[76:79], v[168:171]
ds_read_b64_tr_b16 v[60:61], v11 offset:12288
v_mfma_f32_16x16x32_bf16 v[164:167], v[100:103], v[76:79], v[164:167]
ds_read_b64_tr_b16 v[62:63], v11 offset:15360
v_mfma_f32_16x16x32_bf16 v[160:163], v[96:99], v[76:79], v[160:163]
ds_read_b64_tr_b16 v[64:65], v12 offset:12288
v_mfma_f32_16x16x32_bf16 v[156:159], v[92:95], v[76:79], v[156:159]
ds_read_b64_tr_b16 v[66:67], v12 offset:15360
v_mfma_f32_16x16x32_bf16 v[152:155], v[88:91], v[76:79], v[152:155]
ds_read_b64_tr_b16 v[68:69], v13 offset:12288
v_mfma_f32_16x16x32_bf16 v[176:179], v[88:91], v[80:83], v[176:179]
ds_read_b64_tr_b16 v[70:71], v13 offset:15360
v_mfma_f32_16x16x32_bf16 v[180:183], v[92:95], v[80:83], v[180:183]
ds_read_b128 v[36:39], v9 offset:1024
v_mfma_f32_16x16x32_bf16 v[184:187], v[96:99], v[80:83], v[184:187]
ds_read_b128 v[40:43], v9 offset:2048
v_mfma_f32_16x16x32_bf16 v[188:191], v[100:103], v[80:83], v[188:191]
ds_read_b128 v[44:47], v9 offset:3072
v_mfma_f32_16x16x32_bf16 v[192:195], v[104:107], v[80:83], v[192:195]
v_mfma_f32_16x16x32_bf16 v[196:199], v[108:111], v[80:83], v[196:199]
v_mfma_f32_16x16x32_bf16 v[220:223], v[108:111], v[84:87], v[220:223]
v_mfma_f32_16x16x32_bf16 v[216:219], v[104:107], v[84:87], v[216:219]
v_mfma_f32_16x16x32_bf16 v[212:215], v[100:103], v[84:87], v[212:215]
v_mfma_f32_16x16x32_bf16 v[208:211], v[96:99], v[84:87], v[208:211]
v_mfma_f32_16x16x32_bf16 v[204:207], v[92:95], v[84:87], v[204:207]
v_mfma_f32_16x16x32_bf16 v[200:203], v[88:91], v[84:87], v[200:203]
s_waitcnt lgkmcnt(0)
v_mfma_f32_16x16x32_bf16 v[128:131], v[48:51], v[32:35], v[128:131]
ds_read_b128 v[72:75], v9 offset:8192
v_mfma_f32_16x16x32_bf16 v[132:135], v[52:55], v[32:35], v[132:135]
ds_read_b64_tr_b16 v[88:89], v11 offset:6144
v_mfma_f32_16x16x32_bf16 v[136:139], v[56:59], v[32:35], v[136:139]
ds_read_b64_tr_b16 v[90:91], v11 offset:9216
v_mfma_f32_16x16x32_bf16 v[140:143], v[60:63], v[32:35], v[140:143]
ds_read_b64_tr_b16 v[92:93], v12 offset:6144
v_mfma_f32_16x16x32_bf16 v[144:147], v[64:67], v[32:35], v[144:147]
ds_read_b64_tr_b16 v[94:95], v12 offset:9216
v_mfma_f32_16x16x32_bf16 v[148:151], v[68:71], v[32:35], v[148:151]
ds_read_b64_tr_b16 v[96:97], v13 offset:6144
v_mfma_f32_16x16x32_bf16 v[172:175], v[68:71], v[36:39], v[172:175]
ds_read_b64_tr_b16 v[98:99], v13 offset:9216
v_mfma_f32_16x16x32_bf16 v[168:171], v[64:67], v[36:39], v[168:171]
ds_read_b64_tr_b16 v[100:101], v11 offset:18432
v_mfma_f32_16x16x32_bf16 v[164:167], v[60:63], v[36:39], v[164:167]
ds_read_b64_tr_b16 v[102:103], v11 offset:21504
v_mfma_f32_16x16x32_bf16 v[160:163], v[56:59], v[36:39], v[160:163]
ds_read_b64_tr_b16 v[104:105], v12 offset:18432
v_mfma_f32_16x16x32_bf16 v[156:159], v[52:55], v[36:39], v[156:159]
ds_read_b64_tr_b16 v[106:107], v12 offset:21504
v_mfma_f32_16x16x32_bf16 v[152:155], v[48:51], v[36:39], v[152:155]
ds_read_b64_tr_b16 v[108:109], v13 offset:18432
v_mfma_f32_16x16x32_bf16 v[176:179], v[48:51], v[40:43], v[176:179]
ds_read_b64_tr_b16 v[110:111], v13 offset:21504
v_mfma_f32_16x16x32_bf16 v[180:183], v[52:55], v[40:43], v[180:183]
ds_read_b128 v[76:79], v9 offset:9216
v_mfma_f32_16x16x32_bf16 v[184:187], v[56:59], v[40:43], v[184:187]
ds_read_b128 v[80:83], v9 offset:10240
v_mfma_f32_16x16x32_bf16 v[188:191], v[60:63], v[40:43], v[188:191]
ds_read_b128 v[84:87], v9 offset:11264
v_mfma_f32_16x16x32_bf16 v[192:195], v[64:67], v[40:43], v[192:195]
v_mfma_f32_16x16x32_bf16 v[196:199], v[68:71], v[40:43], v[196:199]
v_mfma_f32_16x16x32_bf16 v[220:223], v[68:71], v[44:47], v[220:223]
v_mfma_f32_16x16x32_bf16 v[216:219], v[64:67], v[44:47], v[216:219]
v_mfma_f32_16x16x32_bf16 v[212:215], v[60:63], v[44:47], v[212:215]
v_mfma_f32_16x16x32_bf16 v[208:211], v[56:59], v[44:47], v[208:211]
v_mfma_f32_16x16x32_bf16 v[204:207], v[52:55], v[44:47], v[204:207]
v_mfma_f32_16x16x32_bf16 v[200:203], v[48:51], v[44:47], v[200:203]
s_waitcnt lgkmcnt(0)
s_barrier
v_mfma_f32_16x16x32_bf16 v[128:131], v[88:91], v[72:75], v[128:131]
ds_read_b128 v[32:35], v9 offset:49152
v_mfma_f32_16x16x32_bf16 v[132:135], v[92:95], v[72:75], v[132:135]
ds_read_b64_tr_b16 v[48:49], v14 offset:0
v_mfma_f32_16x16x32_bf16 v[136:139], v[96:99], v[72:75], v[136:139]
ds_read_b64_tr_b16 v[50:51], v14 offset:3072
v_mfma_f32_16x16x32_bf16 v[140:143], v[100:103], v[72:75], v[140:143]
ds_read_b64_tr_b16 v[52:53], v15 offset:0
v_mfma_f32_16x16x32_bf16 v[144:147], v[104:107], v[72:75], v[144:147]
ds_read_b64_tr_b16 v[54:55], v15 offset:3072
v_mfma_f32_16x16x32_bf16 v[148:151], v[108:111], v[72:75], v[148:151]
ds_read_b64_tr_b16 v[56:57], v16 offset:0
v_mfma_f32_16x16x32_bf16 v[172:175], v[108:111], v[76:79], v[172:175]
ds_read_b64_tr_b16 v[58:59], v16 offset:3072
v_mfma_f32_16x16x32_bf16 v[168:171], v[104:107], v[76:79], v[168:171]
ds_read_b64_tr_b16 v[60:61], v14 offset:12288
v_mfma_f32_16x16x32_bf16 v[164:167], v[100:103], v[76:79], v[164:167]
ds_read_b64_tr_b16 v[62:63], v14 offset:15360
v_mfma_f32_16x16x32_bf16 v[160:163], v[96:99], v[76:79], v[160:163]
ds_read_b64_tr_b16 v[64:65], v15 offset:12288
v_mfma_f32_16x16x32_bf16 v[156:159], v[92:95], v[76:79], v[156:159]
ds_read_b64_tr_b16 v[66:67], v15 offset:15360
v_mfma_f32_16x16x32_bf16 v[152:155], v[88:91], v[76:79], v[152:155]
ds_read_b64_tr_b16 v[68:69], v16 offset:12288
v_mfma_f32_16x16x32_bf16 v[176:179], v[88:91], v[80:83], v[176:179]
ds_read_b64_tr_b16 v[70:71], v16 offset:15360
v_mfma_f32_16x16x32_bf16 v[180:183], v[92:95], v[80:83], v[180:183]
ds_read_b128 v[36:39], v9 offset:50176
v_mfma_f32_16x16x32_bf16 v[184:187], v[96:99], v[80:83], v[184:187]
ds_read_b128 v[40:43], v9 offset:51200
v_mfma_f32_16x16x32_bf16 v[188:191], v[100:103], v[80:83], v[188:191]
ds_read_b128 v[44:47], v9 offset:52224
v_mfma_f32_16x16x32_bf16 v[192:195], v[104:107], v[80:83], v[192:195]
v_mfma_f32_16x16x32_bf16 v[196:199], v[108:111], v[80:83], v[196:199]
v_mfma_f32_16x16x32_bf16 v[220:223], v[108:111], v[84:87], v[220:223]
v_mfma_f32_16x16x32_bf16 v[216:219], v[104:107], v[84:87], v[216:219]
v_mfma_f32_16x16x32_bf16 v[212:215], v[100:103], v[84:87], v[212:215]
v_mfma_f32_16x16x32_bf16 v[208:211], v[96:99], v[84:87], v[208:211]
v_mfma_f32_16x16x32_bf16 v[204:207], v[92:95], v[84:87], v[204:207]
v_mfma_f32_16x16x32_bf16 v[200:203], v[88:91], v[84:87], v[200:203]
s_sub_u32 s41, s41, 1
s_cmp_lg_u32 s41, 0
s_cbranch_scc1 Lk3l_106
s_waitcnt lgkmcnt(0)
s_mov_b32 s28, s76
s_mov_b32 s29, s77
s_mov_b32 s30, 7340032
s_mov_b32 s31, 0x20000
s_add_u32 s37, s35, 2
s_and_b32 s37, s37, 15
s_mul_i32 s37, s37, 16384
s_add_u32 m0, s39, 0
s_nop 0
buffer_load_dwordx4 v3, s[8:11], s37 offen sc1 lds
v_lshrrev_b32 v86, 4, v1
s_lshl_b32 s43, s63, 7
s_add_u32 s43, s43, 148992
buffer_load_dwordx4 v3, s[8:11], s37 offen offset:1024 sc1 lds
v_lshl_add_u32 v87, v86, 4, s43
v_lshrrev_b32 v88, 1, v86
v_and_b32 v86, 1, v86
s_lshl_b32 s43, s63, 5
buffer_load_dwordx4 v3, s[8:11], s37 offen offset:2048 sc1 lds
s_add_u32 s43, s43, 149248
v_lshl_add_u32 v88, v88, 6, s43
v_lshl_add_u32 v88, v86, 4, v88
v_and_b32 v86, 15, v1
buffer_load_dwordx4 v3, s[8:11], s37 offen offset:3072 sc1 lds
s_lshl_b32 s43, s62, 9
s_add_u32 s43, s43, 147456
v_lshl_add_u32 v86, v86, 3, s43
s_add_u32 s38, s35, 2
s_and_b32 s38, s38, 15
s_mul_i32 s38, s38, 458752
s_add_u32 m0, s40, 0
s_nop 0
buffer_load_dwordx4 v4, s[12:15], s38 offen lds
ds_read_b128 v[32:35], v87 offset:0
ds_read_b128 v[36:39], v87 offset:64
ds_read_b128 v[40:43], v88 offset:0
ds_read_b128 v[44:47], v87 offset:896
s_add_u32 m0, s40, 1024
s_nop 0
buffer_load_dwordx4 v5, s[12:15], s38 offen lds
ds_read_b128 v[48:51], v87 offset:960
ds_read_b128 v[52:55], v88 offset:896
ds_read_b64 v[56:57], v86 offset:0
ds_read_b64 v[58:59], v86 offset:128
s_add_u32 m0, s40, 2048
s_add_u32 s38, s38, 57344
buffer_load_dwordx4 v4, s[12:15], s38 offen lds
ds_read_b64 v[60:61], v86 offset:256
ds_read_b64 v[62:63], v86 offset:384
s_mul_i32 s54, s35, 24576
s_add_u32 m0, s40, 3072
s_nop 0
buffer_load_dwordx4 v5, s[12:15], s38 offen lds
s_lshl_b32 s43, s62, 12
s_add_u32 s54, s54, s43
s_add_u32 s54, s54, 524288
s_lshl_b32 s43, s63, 9
s_add_u32 m0, s40, 4096
s_add_u32 s38, s38, 57344
buffer_load_dwordx4 v4, s[12:15], s38 offen lds
s_add_u32 s55, s54, s43
s_add_u32 s55, s55, 16384
s_lshl_b32 s43, s63, 13
s_add_u32 s54, s54, s43
s_add_u32 m0, s40, 5120
s_nop 0
buffer_load_dwordx4 v5, s[12:15], s38 offen lds
v_and_b32 v84, 32, v1
v_lshlrev_b32 v84, 4, v84
v_add_u32 v84, v84, v2
s_waitcnt lgkmcnt(0)
s_add_u32 m0, s40, 6144
s_add_u32 s38, s38, 57344
buffer_load_dwordx4 v4, s[12:15], s38 offen lds
s_add_u32 m0, s40, 7168
s_nop 0
buffer_load_dwordx4 v5, s[12:15], s38 offen lds
s_and_b32 s44, s36, 3
s_mul_i32 s43, s2, 28672
s_mul_i32 s44, s44, 7168
s_add_u32 s43, s43, s44
s_add_u32 s4, s76, s43
s_addc_u32 s5, s77, 0
s_barrier
s_cmp_eq_u32 s47, 3
s_cbranch_scc0 Lw_107
v_and_b32 v30, 31, v1
v_lshlrev_b32 v30, 4, v30
v_add_u32 v31, 153600, v30
ds_read_b128 v[108:111], v31 offset:0
ds_read_b128 v[112:115], v31 offset:512
ds_read_b128 v[116:119], v31 offset:1024
ds_read_b128 v[120:123], v31 offset:1536
s_and_b32 s44, s2, 15
s_mul_i32 s44, s44, 14336
s_lshr_b32 s43, s2, 4
s_lshl_b32 s43, s43, 9
s_add_u32 s44, s44, s43
s_waitcnt lgkmcnt(0)
v_add_f32 v108, v108, v112
v_add_f32 v116, v116, v120
v_add_f32 v109, v109, v113
v_add_f32 v117, v117, v121
v_add_f32 v110, v110, v114
v_add_f32 v118, v118, v122
v_add_f32 v111, v111, v115
v_add_f32 v119, v119, v123
v_add_f32 v108, v108, v116
v_add_f32 v109, v109, v117
v_add_f32 v110, v110, v118
v_add_f32 v111, v111, v119
s_mov_b64 exec, 0xffffffff
buffer_store_dwordx4 v[108:111], v30, s[84:87], s44 offen sc1
s_mov_b64 exec, -1
Lw_107:
s_waitcnt lgkmcnt(0)
s_add_u32 s37, s35, 3
s_and_b32 s37, s37, 15
s_mul_i32 s37, s37, 16384
s_add_u32 m0, s39, 49152
s_nop 0
buffer_load_dwordx4 v3, s[8:11], s37 offen sc1 lds
s_load_dword s3, s[4:5], 1792
s_load_dword s3, s[4:5], 1856
s_load_dword s3, s[4:5], 1920
s_load_dword s3, s[4:5], 1984
s_load_dword s3, s[4:5], 2048
s_load_dword s3, s[4:5], 2112
s_load_dword s3, s[4:5], 2176
buffer_load_dwordx4 v3, s[8:11], s37 offen offset:1024 sc1 lds
s_load_dword s3, s[4:5], 2240
s_load_dword s3, s[4:5], 2304
s_load_dword s3, s[4:5], 2368
s_load_dword s3, s[4:5], 2432
s_load_dword s3, s[4:5], 2496
s_load_dword s3, s[4:5], 2560
s_load_dword s3, s[4:5], 2624
buffer_load_dwordx4 v3, s[8:11], s37 offen offset:2048 sc1 lds
v_mul_f32 v66, v57, v57
v_mul_f32 v64, 0xc0135761, v57
v_mul_f32 v65, 0xbdd2d3e8, v57
v_mul_f32 v65, v65, v66
v_rcp_f32 v66, v66
v_mul_f32 v70, v59, v59
v_mul_f32 v68, 0xc0135761, v59
buffer_load_dwordx4 v3, s[8:11], s37 offen offset:3072 sc1 lds
v_mul_f32 v69, 0xbdd2d3e8, v59
v_mul_f32 v69, v69, v70
v_rcp_f32 v70, v70
v_fma_f32 v128, -v56, v32, v128
v_fma_f32 v129, -v56, v33, v129
v_fma_f32 v130, -v56, v34, v130
v_fma_f32 v131, -v56, v35, v131
v_fma_f32 v152, -v58, v32, v152
s_add_u32 s38, s35, 3
s_and_b32 s38, s38, 15
s_mul_i32 s38, s38, 458752
s_add_u32 m0, s40, 49152
s_nop 0
buffer_load_dwordx4 v4, s[12:15], s38 offen lds
v_fma_f32 v153, -v58, v33, v153
v_fma_f32 v154, -v58, v34, v154
v_fma_f32 v155, -v58, v35, v155
v_mul_f32 v72, v128, v128
v_mul_f32 v73, v129, v129
v_mul_f32 v74, v130, v130
v_mul_f32 v75, v131, v131
s_add_u32 m0, s40, 50176
s_nop 0
buffer_load_dwordx4 v5, s[12:15], s38 offen lds
v_mul_f32 v76, v152, v152
v_mul_f32 v77, v153, v153
v_mul_f32 v78, v154, v154
v_mul_f32 v79, v155, v155
v_fma_f32 v72, v72, v65, v64
v_fma_f32 v73, v73, v65, v64
v_fma_f32 v74, v74, v65, v64
s_add_u32 m0, s40, 51200
s_add_u32 s38, s38, 57344
buffer_load_dwordx4 v4, s[12:15], s38 offen lds
v_fma_f32 v75, v75, v65, v64
v_fma_f32 v76, v76, v69, v68
v_fma_f32 v77, v77, v69, v68
v_fma_f32 v78, v78, v69, v68
v_fma_f32 v79, v79, v69, v68
v_mul_f32 v72, v72, v128
v_mul_f32 v73, v73, v129
v_mul_f32 v74, v74, v130
s_add_u32 m0, s40, 52224
s_nop 0
buffer_load_dwordx4 v5, s[12:15], s38 offen lds
v_mul_f32 v75, v75, v131
v_mul_f32 v76, v76, v152
v_mul_f32 v77, v77, v153
v_mul_f32 v78, v78, v154
v_mul_f32 v79, v79, v155
v_exp_f32 v72, v72
v_exp_f32 v73, v73
s_add_u32 m0, s40, 53248
s_add_u32 s38, s38, 57344
buffer_load_dwordx4 v4, s[12:15], s38 offen lds
v_exp_f32 v74, v74
v_exp_f32 v75, v75
v_exp_f32 v76, v76
v_exp_f32 v77, v77
v_exp_f32 v78, v78
v_exp_f32 v79, v79
v_fma_f32 v140, -v56, v44, v140
s_add_u32 m0, s40, 54272
s_nop 0
buffer_load_dwordx4 v5, s[12:15], s38 offen lds
v_fma_f32 v141, -v56, v45, v141
v_fma_f32 v142, -v56, v46, v142
v_fma_f32 v143, -v56, v47, v143
v_fma_f32 v164, -v58, v44, v164
v_fma_f32 v165, -v58, v45, v165
v_fma_f32 v166, -v58, v46, v166
v_fma_f32 v167, -v58, v47, v167
v_fma_f32 v72, v72, v66, v66
s_add_u32 m0, s40, 55296
s_add_u32 s38, s38, 57344
buffer_load_dwordx4 v4, s[12:15], s38 offen lds
s_add_u32 m0, s40, 56320
s_nop 0
buffer_load_dwordx4 v5, s[12:15], s38 offen lds
s_waitcnt vmcnt(12)
s_barrier
s_add_u32 s37, s35, 4
s_and_b32 s37, s37, 15
s_mul_i32 s37, s37, 16384
s_add_u32 m0, s39, 98304
s_nop 0
buffer_load_dwordx4 v3, s[8:11], s37 offen sc1 lds
v_fma_f32 v73, v73, v66, v66
v_fma_f32 v74, v74, v66, v66
v_fma_f32 v75, v75, v66, v66
v_fma_f32 v76, v76, v70, v70
v_fma_f32 v77, v77, v70, v70
v_fma_f32 v78, v78, v70, v70
buffer_load_dwordx4 v3, s[8:11], s37 offen offset:1024 sc1 lds
v_fma_f32 v79, v79, v70, v70
v_rcp_f32 v72, v72
v_rcp_f32 v73, v73
v_rcp_f32 v74, v74
v_rcp_f32 v75, v75
v_rcp_f32 v76, v76
buffer_load_dwordx4 v3, s[8:11], s37 offen offset:2048 sc1 lds
v_rcp_f32 v77, v77
v_rcp_f32 v78, v78
v_rcp_f32 v79, v79
v_mul_f32 v140, v128, v140
v_mul_f32 v141, v129, v141
v_mul_f32 v142, v130, v142
buffer_load_dwordx4 v3, s[8:11], s37 offen offset:3072 sc1 lds
v_mul_f32 v143, v131, v143
v_mul_f32 v164, v152, v164
v_mul_f32 v165, v153, v165
v_mul_f32 v166, v154, v166
v_mul_f32 v167, v155, v167
v_mul_f32 v140, v140, v72
s_add_u32 s38, s35, 4
s_and_b32 s38, s38, 15
s_mul_i32 s38, s38, 458752
s_add_u32 m0, s40, 98304
s_nop 0
buffer_load_dwordx4 v4, s[12:15], s38 offen lds
v_mul_f32 v141, v141, v73
v_mul_f32 v142, v142, v74
v_mul_f32 v143, v143, v75
v_mul_f32 v164, v164, v76
v_mul_f32 v165, v165, v77
v_mul_f32 v166, v166, v78
s_add_u32 m0, s40, 99328
s_nop 0
buffer_load_dwordx4 v5, s[12:15], s38 offen lds
v_mul_f32 v167, v167, v79
v_cvt_pk_bf16_f32 v128, v140, v141
v_cvt_pk_bf16_f32 v129, v142, v143
v_cvt_pk_bf16_f32 v152, v164, v165
v_cvt_pk_bf16_f32 v153, v166, v167
v_fma_f32 v132, -v56, v36, v132
s_add_u32 m0, s40, 100352
s_add_u32 s38, s38, 57344
buffer_load_dwordx4 v4, s[12:15], s38 offen lds
v_fma_f32 v133, -v56, v37, v133
v_fma_f32 v134, -v56, v38, v134
v_fma_f32 v135, -v56, v39, v135
v_fma_f32 v156, -v58, v36, v156
v_fma_f32 v157, -v58, v37, v157
v_fma_f32 v158, -v58, v38, v158
s_add_u32 m0, s40, 101376
s_nop 0
buffer_load_dwordx4 v5, s[12:15], s38 offen lds
v_fma_f32 v159, -v58, v39, v159
v_mul_f32 v72, v132, v132
v_mul_f32 v73, v133, v133
v_mul_f32 v74, v134, v134
v_mul_f32 v75, v135, v135
v_mul_f32 v76, v156, v156
s_add_u32 m0, s40, 102400
s_add_u32 s38, s38, 57344
buffer_load_dwordx4 v4, s[12:15], s38 offen lds
v_mul_f32 v77, v157, v157
v_mul_f32 v78, v158, v158
v_mul_f32 v79, v159, v159
s_branch Lov_8
.p2align 12
Lst_8_0:
s_branch Lwr_149
s_nop 0
Lov_8:
v_fma_f32 v72, v72, v65, v64
v_fma_f32 v73, v73, v65, v64
v_fma_f32 v74, v74, v65, v64
s_add_u32 m0, s40, 103424
s_nop 0
buffer_load_dwordx4 v5, s[12:15], s38 offen lds
v_fma_f32 v75, v75, v65, v64
v_fma_f32 v76, v76, v69, v68
v_fma_f32 v77, v77, v69, v68
v_fma_f32 v78, v78, v69, v68
v_fma_f32 v79, v79, v69, v68
v_mul_f32 v72, v72, v132
s_add_u32 m0, s40, 104448
s_add_u32 s38, s38, 57344
buffer_load_dwordx4 v4, s[12:15], s38 offen lds
s_add_u32 m0, s40, 105472
s_nop 0
buffer_load_dwordx4 v5, s[12:15], s38 offen lds
s_waitcnt vmcnt(12)
s_barrier
s_cmp_eq_u32 s47, 3
s_cbranch_scc0 Lw_108
s_lshr_b32 s43, s2, 4
s_add_u32 s43, s43, 80
s_lshl_b32 s43, s43, 7
v_mov_b32 v30, s43
v_mov_b32 v31, 1
s_mov_b64 exec, 1
buffer_atomic_add v31, v30, s[56:59], 0 offen sc1
s_mov_b64 exec, -1
Lw_108:
s_waitcnt lgkmcnt(0)
s_add_u32 s37, s35, 5
s_and_b32 s37, s37, 15
s_mul_i32 s37, s37, 16384
s_add_u32 m0, s39, 0
s_nop 0
buffer_load_dwordx4 v3, s[8:11], s37 offen sc1 lds
s_load_dword s3, s[4:5], 2688
s_load_dword s3, s[4:5], 2752
s_load_dword s3, s[4:5], 2816
s_load_dword s3, s[4:5], 2880
s_load_dword s3, s[4:5], 2944
s_load_dword s3, s[4:5], 3008
s_load_dword s3, s[4:5], 3072
buffer_load_dwordx4 v3, s[8:11], s37 offen offset:1024 sc1 lds
s_load_dword s3, s[4:5], 3136
s_load_dword s3, s[4:5], 3200
s_load_dword s3, s[4:5], 3264
s_load_dword s3, s[4:5], 3328
s_load_dword s3, s[4:5], 3392
s_load_dword s3, s[4:5], 3456
s_load_dword s3, s[4:5], 3520
buffer_load_dwordx4 v3, s[8:11], s37 offen offset:2048 sc1 lds
v_mul_f32 v73, v73, v133
v_mul_f32 v74, v74, v134
v_mul_f32 v75, v75, v135
v_mul_f32 v76, v76, v156
v_mul_f32 v77, v77, v157
v_mul_f32 v78, v78, v158
v_mul_f32 v79, v79, v159
v_exp_f32 v72, v72
buffer_load_dwordx4 v3, s[8:11], s37 offen offset:3072 sc1 lds
v_exp_f32 v73, v73
v_exp_f32 v74, v74
v_exp_f32 v75, v75
v_exp_f32 v76, v76
v_exp_f32 v77, v77
v_exp_f32 v78, v78
v_exp_f32 v79, v79
s_add_u32 s38, s35, 5
s_and_b32 s38, s38, 15
s_mul_i32 s38, s38, 458752
s_add_u32 m0, s40, 0
s_nop 0
buffer_load_dwordx4 v4, s[12:15], s38 offen lds
v_fma_f32 v144, -v56, v48, v144
v_fma_f32 v145, -v56, v49, v145
v_fma_f32 v146, -v56, v50, v146
v_fma_f32 v147, -v56, v51, v147
v_fma_f32 v168, -v58, v48, v168
v_fma_f32 v169, -v58, v49, v169
v_fma_f32 v170, -v58, v50, v170
v_fma_f32 v171, -v58, v51, v171
s_add_u32 m0, s40, 1024
s_nop 0
buffer_load_dwordx4 v5, s[12:15], s38 offen lds
v_fma_f32 v72, v72, v66, v66
v_fma_f32 v73, v73, v66, v66
v_fma_f32 v74, v74, v66, v66
v_fma_f32 v75, v75, v66, v66
v_fma_f32 v76, v76, v70, v70
v_fma_f32 v77, v77, v70, v70
v_fma_f32 v78, v78, v70, v70
s_add_u32 m0, s40, 2048
s_add_u32 s38, s38, 57344
buffer_load_dwordx4 v4, s[12:15], s38 offen lds
v_fma_f32 v79, v79, v70, v70
v_rcp_f32 v72, v72
v_rcp_f32 v73, v73
v_rcp_f32 v74, v74
v_rcp_f32 v75, v75
v_rcp_f32 v76, v76
v_rcp_f32 v77, v77
s_add_u32 m0, s40, 3072
s_nop 0
buffer_load_dwordx4 v5, s[12:15], s38 offen lds
v_rcp_f32 v78, v78
v_rcp_f32 v79, v79
v_mul_f32 v144, v132, v144
v_mul_f32 v145, v133, v145
v_mul_f32 v146, v134, v146
v_mul_f32 v147, v135, v147
v_mul_f32 v168, v156, v168
v_mul_f32 v169, v157, v169
s_add_u32 m0, s40, 4096
s_add_u32 s38, s38, 57344
buffer_load_dwordx4 v4, s[12:15], s38 offen lds
v_mul_f32 v170, v158, v170
v_mul_f32 v171, v159, v171
v_mul_f32 v144, v144, v72
v_mul_f32 v145, v145, v73
v_mul_f32 v146, v146, v74
v_mul_f32 v147, v147, v75
v_mul_f32 v168, v168, v76
s_add_u32 m0, s40, 5120
s_nop 0
buffer_load_dwordx4 v5, s[12:15], s38 offen lds
v_mul_f32 v169, v169, v77
v_mul_f32 v170, v170, v78
v_mul_f32 v171, v171, v79
v_cvt_pk_bf16_f32 v130, v144, v145
v_cvt_pk_bf16_f32 v131, v146, v147
v_cvt_pk_bf16_f32 v154, v168, v169
v_cvt_pk_bf16_f32 v155, v170, v171
buffer_store_dwordx4 v[128:131], v2, s[24:27], s54 offen offset:0 sc1
s_add_u32 m0, s40, 6144
s_add_u32 s38, s38, 57344
buffer_load_dwordx4 v4, s[12:15], s38 offen lds
s_add_u32 m0, s40, 7168
s_nop 0
buffer_load_dwordx4 v5, s[12:15], s38 offen lds
s_waitcnt vmcnt(13)
s_barrier
s_add_u32 s37, s35, 6
s_and_b32 s37, s37, 15
s_mul_i32 s37, s37, 16384
s_add_u32 m0, s39, 49152
s_nop 0
buffer_load_dwordx4 v3, s[8:11], s37 offen sc1 lds
buffer_store_dwordx4 v[152:155], v2, s[24:27], s54 offen offset:1024 sc1
v_fma_f32 v136, -v56, v40, v136
v_fma_f32 v137, -v56, v41, v137
v_fma_f32 v138, -v56, v42, v138
v_fma_f32 v139, -v56, v43, v139
v_fma_f32 v160, -v58, v40, v160
buffer_load_dwordx4 v3, s[8:11], s37 offen offset:1024 sc1 lds
v_fma_f32 v161, -v58, v41, v161
v_fma_f32 v162, -v58, v42, v162
v_fma_f32 v163, -v58, v43, v163
v_mul_f32 v72, v136, v136
v_mul_f32 v73, v137, v137
v_mul_f32 v74, v138, v138
buffer_load_dwordx4 v3, s[8:11], s37 offen offset:2048 sc1 lds
v_mul_f32 v75, v139, v139
v_mul_f32 v76, v160, v160
v_mul_f32 v77, v161, v161
v_mul_f32 v78, v162, v162
v_mul_f32 v79, v163, v163
v_fma_f32 v72, v72, v65, v64
buffer_load_dwordx4 v3, s[8:11], s37 offen offset:3072 sc1 lds
v_fma_f32 v73, v73, v65, v64
v_fma_f32 v74, v74, v65, v64
v_fma_f32 v75, v75, v65, v64
v_fma_f32 v76, v76, v69, v68
v_fma_f32 v77, v77, v69, v68
v_fma_f32 v78, v78, v69, v68
s_add_u32 s38, s35, 6
s_and_b32 s38, s38, 15
s_mul_i32 s38, s38, 458752
s_add_u32 m0, s40, 49152
s_nop 0
buffer_load_dwordx4 v4, s[12:15], s38 offen lds
v_fma_f32 v79, v79, v69, v68
v_mul_f32 v72, v72, v136
v_mul_f32 v73, v73, v137
v_mul_f32 v74, v74, v138
v_mul_f32 v75, v75, v139
v_mul_f32 v76, v76, v160
s_add_u32 m0, s40, 50176
s_nop 0
buffer_load_dwordx4 v5, s[12:15], s38 offen lds
v_mul_f32 v77, v77, v161
v_mul_f32 v78, v78, v162
v_mul_f32 v79, v79, v163
v_exp_f32 v72, v72
v_exp_f32 v73, v73
v_exp_f32 v74, v74
s_add_u32 m0, s40, 51200
s_add_u32 s38, s38, 57344
buffer_load_dwordx4 v4, s[12:15], s38 offen lds
v_exp_f32 v75, v75
v_exp_f32 v76, v76
v_exp_f32 v77, v77
v_exp_f32 v78, v78
v_exp_f32 v79, v79
v_fma_f32 v148, -v56, v52, v148
s_add_u32 m0, s40, 52224
s_nop 0
buffer_load_dwordx4 v5, s[12:15], s38 offen lds
v_fma_f32 v149, -v56, v53, v149
v_fma_f32 v150, -v56, v54, v150
v_fma_f32 v151, -v56, v55, v151
v_fma_f32 v172, -v58, v52, v172
v_fma_f32 v173, -v58, v53, v173
v_fma_f32 v174, -v58, v54, v174
s_add_u32 m0, s40, 53248
s_add_u32 s38, s38, 57344
buffer_load_dwordx4 v4, s[12:15], s38 offen lds
v_fma_f32 v175, -v58, v55, v175
v_fma_f32 v72, v72, v66, v66
v_fma_f32 v73, v73, v66, v66
v_fma_f32 v74, v74, v66, v66
v_fma_f32 v75, v75, v66, v66
v_fma_f32 v76, v76, v70, v70
s_add_u32 m0, s40, 54272
s_nop 0
buffer_load_dwordx4 v5, s[12:15], s38 offen lds
v_fma_f32 v77, v77, v70, v70
v_fma_f32 v78, v78, v70, v70
v_fma_f32 v79, v79, v70, v70
v_rcp_f32 v72, v72
v_rcp_f32 v73, v73
v_rcp_f32 v74, v74
s_add_u32 m0, s40, 55296
s_add_u32 s38, s38, 57344
buffer_load_dwordx4 v4, s[12:15], s38 offen lds
s_add_u32 m0, s40, 56320
s_nop 0
buffer_load_dwordx4 v5, s[12:15], s38 offen lds
s_waitcnt vmcnt(13)
s_barrier
s_waitcnt lgkmcnt(0)
s_add_u32 s37, s35, 7
s_and_b32 s37, s37, 15
s_mul_i32 s37, s37, 16384
s_add_u32 m0, s39, 98304
s_nop 0
buffer_load_dwordx4 v3, s[8:11], s37 offen sc1 lds
s_load_dword s3, s[4:5], 3584
s_load_dword s3, s[4:5], 3648
s_load_dword s3, s[4:5], 3712
s_load_dword s3, s[4:5], 3776
s_load_dword s3, s[4:5], 3840
s_load_dword s3, s[4:5], 3904
s_load_dword s3, s[4:5], 3968
buffer_load_dwordx4 v3, s[8:11], s37 offen offset:1024 sc1 lds
s_load_dword s3, s[4:5], 4032
s_load_dword s3, s[4:5], 4096
s_load_dword s3, s[4:5], 4160
s_load_dword s3, s[4:5], 4224
s_load_dword s3, s[4:5], 4288
s_load_dword s3, s[4:5], 4352
s_load_dword s3, s[4:5], 4416
buffer_load_dwordx4 v3, s[8:11], s37 offen offset:2048 sc1 lds
v_rcp_f32 v75, v75
v_rcp_f32 v76, v76
v_rcp_f32 v77, v77
v_rcp_f32 v78, v78
v_rcp_f32 v79, v79
v_mul_f32 v148, v136, v148
v_mul_f32 v149, v137, v149
buffer_load_dwordx4 v3, s[8:11], s37 offen offset:3072 sc1 lds
v_mul_f32 v150, v138, v150
v_mul_f32 v151, v139, v151
v_mul_f32 v172, v160, v172
v_mul_f32 v173, v161, v173
v_mul_f32 v174, v162, v174
v_mul_f32 v175, v163, v175
v_mul_f32 v148, v148, v72
v_mul_f32 v149, v149, v73
s_add_u32 s38, s35, 7
s_and_b32 s38, s38, 15
s_mul_i32 s38, s38, 458752
s_add_u32 m0, s40, 98304
s_nop 0
buffer_load_dwordx4 v4, s[12:15], s38 offen lds
v_mul_f32 v150, v150, v74
v_mul_f32 v151, v151, v75
v_mul_f32 v172, v172, v76
v_mul_f32 v173, v173, v77
v_mul_f32 v174, v174, v78
v_mul_f32 v175, v175, v79
v_cvt_pk_bf16_f32 v80, v148, v149
s_add_u32 m0, s40, 99328
s_nop 0
buffer_load_dwordx4 v5, s[12:15], s38 offen lds
v_cvt_pk_bf16_f32 v81, v150, v151
v_cvt_pk_bf16_f32 v82, v172, v173
v_cvt_pk_bf16_f32 v83, v174, v175
s_nop 1
v_permlane32_swap_b32 v80, v82
v_permlane32_swap_b32 v81, v83
buffer_store_dwordx4 v[80:83], v84, s[24:27], s55 offen offset:0 sc1
s_add_u32 m0, s40, 100352
s_add_u32 s38, s38, 57344
buffer_load_dwordx4 v4, s[12:15], s38 offen lds
s_nop 1
v_mul_f32 v66, v61, v61
v_mul_f32 v64, 0xc0135761, v61
v_mul_f32 v65, 0xbdd2d3e8, v61
v_mul_f32 v65, v65, v66
v_rcp_f32 v66, v66
v_mul_f32 v70, v63, v63
v_mul_f32 v68, 0xc0135761, v63
s_add_u32 m0, s40, 101376
s_nop 0
buffer_load_dwordx4 v5, s[12:15], s38 offen lds
v_mul_f32 v69, 0xbdd2d3e8, v63
v_mul_f32 v69, v69, v70
v_rcp_f32 v70, v70
v_fma_f32 v176, -v60, v32, v176
v_fma_f32 v177, -v60, v33, v177
v_fma_f32 v178, -v60, v34, v178
v_fma_f32 v179, -v60, v35, v179
s_add_u32 m0, s40, 102400
s_add_u32 s38, s38, 57344
buffer_load_dwordx4 v4, s[12:15], s38 offen lds
v_fma_f32 v200, -v62, v32, v200
v_fma_f32 v201, -v62, v33, v201
v_fma_f32 v202, -v62, v34, v202
v_fma_f32 v203, -v62, v35, v203
v_mul_f32 v72, v176, v176
v_mul_f32 v73, v177, v177
v_mul_f32 v74, v178, v178
s_add_u32 m0, s40, 103424
s_nop 0
buffer_load_dwordx4 v5, s[12:15], s38 offen lds
v_mul_f32 v75, v179, v179
v_mul_f32 v76, v200, v200
v_mul_f32 v77, v201, v201
v_mul_f32 v78, v202, v202
v_mul_f32 v79, v203, v203
v_fma_f32 v72, v72, v65, v64
v_fma_f32 v73, v73, v65, v64
v_fma_f32 v74, v74, v65, v64
s_add_u32 m0, s40, 104448
s_add_u32 s38, s38, 57344
buffer_load_dwordx4 v4, s[12:15], s38 offen lds
s_add_u32 m0, s40, 105472
s_nop 0
buffer_load_dwordx4 v5, s[12:15], s38 offen lds
s_waitcnt vmcnt(13)
s_barrier
s_add_u32 s37, s35, 8
s_and_b32 s37, s37, 15
s_mul_i32 s37, s37, 16384
s_add_u32 m0, s39, 0
s_nop 0
buffer_load_dwordx4 v3, s[8:11], s37 offen sc1 lds
v_fma_f32 v75, v75, v65, v64
v_fma_f32 v76, v76, v69, v68
v_fma_f32 v77, v77, v69, v68
v_fma_f32 v78, v78, v69, v68
v_fma_f32 v79, v79, v69, v68
v_mul_f32 v72, v72, v176
buffer_load_dwordx4 v3, s[8:11], s37 offen offset:1024 sc1 lds
v_mul_f32 v73, v73, v177
v_mul_f32 v74, v74, v178
v_mul_f32 v75, v75, v179
v_mul_f32 v76, v76, v200
v_mul_f32 v77, v77, v201
v_mul_f32 v78, v78, v202
buffer_load_dwordx4 v3, s[8:11], s37 offen offset:2048 sc1 lds
v_mul_f32 v79, v79, v203
v_exp_f32 v72, v72
v_exp_f32 v73, v73
v_exp_f32 v74, v74
v_exp_f32 v75, v75
v_exp_f32 v76, v76
buffer_load_dwordx4 v3, s[8:11], s37 offen offset:3072 sc1 lds
v_exp_f32 v77, v77
v_exp_f32 v78, v78
v_exp_f32 v79, v79
v_fma_f32 v188, -v60, v44, v188
v_fma_f32 v189, -v60, v45, v189
v_fma_f32 v190, -v60, v46, v190
s_add_u32 s38, s35, 8
s_and_b32 s38, s38, 15
s_mul_i32 s38, s38, 458752
s_add_u32 m0, s40, 0
s_nop 0
buffer_load_dwordx4 v4, s[12:15], s38 offen lds
v_fma_f32 v191, -v60, v47, v191
v_fma_f32 v212, -v62, v44, v212
v_fma_f32 v213, -v62, v45, v213
v_fma_f32 v214, -v62, v46, v214
v_fma_f32 v215, -v62, v47, v215
v_fma_f32 v72, v72, v66, v66
s_add_u32 m0, s40, 1024
s_nop 0
buffer_load_dwordx4 v5, s[12:15], s38 offen lds
v_fma_f32 v73, v73, v66, v66
v_fma_f32 v74, v74, v66, v66
v_fma_f32 v75, v75, v66, v66
v_fma_f32 v76, v76, v70, v70
v_fma_f32 v77, v77, v70, v70
v_fma_f32 v78, v78, v70, v70
s_add_u32 m0, s40, 2048
s_add_u32 s38, s38, 57344
buffer_load_dwordx4 v4, s[12:15], s38 offen lds
v_fma_f32 v79, v79, v70, v70
v_rcp_f32 v72, v72
v_rcp_f32 v73, v73
v_rcp_f32 v74, v74
v_rcp_f32 v75, v75
v_rcp_f32 v76, v76
s_add_u32 m0, s40, 3072
s_nop 0
buffer_load_dwordx4 v5, s[12:15], s38 offen lds
v_rcp_f32 v77, v77
v_rcp_f32 v78, v78
v_rcp_f32 v79, v79
v_mul_f32 v188, v176, v188
v_mul_f32 v189, v177, v189
v_mul_f32 v190, v178, v190
s_add_u32 m0, s40, 4096
s_add_u32 s38, s38, 57344
buffer_load_dwordx4 v4, s[12:15], s38 offen lds
v_mul_f32 v191, v179, v191
v_mul_f32 v212, v200, v212
v_mul_f32 v213, v201, v213
v_mul_f32 v214, v202, v214
v_mul_f32 v215, v203, v215
v_mul_f32 v188, v188, v72
s_add_u32 m0, s40, 5120
s_nop 0
buffer_load_dwordx4 v5, s[12:15], s38 offen lds
v_mul_f32 v189, v189, v73
v_mul_f32 v190, v190, v74
v_mul_f32 v191, v191, v75
v_mul_f32 v212, v212, v76
v_mul_f32 v213, v213, v77
v_mul_f32 v214, v214, v78
s_add_u32 m0, s40, 6144
s_add_u32 s38, s38, 57344
buffer_load_dwordx4 v4, s[12:15], s38 offen lds
s_add_u32 m0, s40, 7168
s_nop 0
buffer_load_dwordx4 v5, s[12:15], s38 offen lds
s_waitcnt vmcnt(12)
s_barrier
s_waitcnt lgkmcnt(0)
s_cmp_eq_u32 s47, 3
s_cbranch_scc0 Lw_109
s_lshl_b32 s92, s35, 7
s_add_u32 s92, s92, 28321792
s_load_dword s93, s[82:83], s92 glc
Lw_109:
s_add_u32 s37, s35, 9
s_and_b32 s37, s37, 15
s_mul_i32 s37, s37, 16384
s_add_u32 m0, s39, 49152
s_nop 0
buffer_load_dwordx4 v3, s[8:11], s37 offen sc1 lds
s_load_dword s3, s[4:5], 4480
s_load_dword s3, s[4:5], 4544
s_load_dword s3, s[4:5], 4608
s_load_dword s3, s[4:5], 4672
s_load_dword s3, s[4:5], 4736
s_load_dword s3, s[4:5], 4800
s_load_dword s3, s[4:5], 4864
buffer_load_dwordx4 v3, s[8:11], s37 offen offset:1024 sc1 lds
s_load_dword s3, s[4:5], 4928
s_load_dword s3, s[4:5], 4992
s_load_dword s3, s[4:5], 5056
s_load_dword s3, s[4:5], 5120
s_load_dword s3, s[4:5], 5184
s_load_dword s3, s[4:5], 5248
s_load_dword s3, s[4:5], 5312
buffer_load_dwordx4 v3, s[8:11], s37 offen offset:2048 sc1 lds
v_mul_f32 v215, v215, v79
v_cvt_pk_bf16_f32 v176, v188, v189
v_cvt_pk_bf16_f32 v177, v190, v191
v_cvt_pk_bf16_f32 v200, v212, v213
v_cvt_pk_bf16_f32 v201, v214, v215
v_fma_f32 v180, -v60, v36, v180
v_fma_f32 v181, -v60, v37, v181
v_fma_f32 v182, -v60, v38, v182
buffer_load_dwordx4 v3, s[8:11], s37 offen offset:3072 sc1 lds
v_fma_f32 v183, -v60, v39, v183
v_fma_f32 v204, -v62, v36, v204
v_fma_f32 v205, -v62, v37, v205
v_fma_f32 v206, -v62, v38, v206
v_fma_f32 v207, -v62, v39, v207
v_mul_f32 v72, v180, v180
v_mul_f32 v73, v181, v181
s_add_u32 s38, s35, 9
s_and_b32 s38, s38, 15
s_mul_i32 s38, s38, 458752
s_add_u32 m0, s40, 49152
s_nop 0
buffer_load_dwordx4 v4, s[12:15], s38 offen lds
v_mul_f32 v74, v182, v182
v_mul_f32 v75, v183, v183
v_mul_f32 v76, v204, v204
v_mul_f32 v77, v205, v205
v_mul_f32 v78, v206, v206
v_mul_f32 v79, v207, v207
v_fma_f32 v72, v72, v65, v64
v_fma_f32 v73, v73, v65, v64
s_add_u32 m0, s40, 50176
s_nop 0
buffer_load_dwordx4 v5, s[12:15], s38 offen lds
v_fma_f32 v74, v74, v65, v64
v_fma_f32 v75, v75, v65, v64
v_fma_f32 v76, v76, v69, v68
v_fma_f32 v77, v77, v69, v68
v_fma_f32 v78, v78, v69, v68
v_fma_f32 v79, v79, v69, v68
v_mul_f32 v72, v72, v180
s_add_u32 m0, s40, 51200
s_add_u32 s38, s38, 57344
buffer_load_dwordx4 v4, s[12:15], s38 offen lds
v_mul_f32 v73, v73, v181
v_mul_f32 v74, v74, v182
v_mul_f32 v75, v75, v183
v_mul_f32 v76, v76, v204
v_mul_f32 v77, v77, v205
v_mul_f32 v78, v78, v206
v_mul_f32 v79, v79, v207
s_add_u32 m0, s40, 52224
s_nop 0
buffer_load_dwordx4 v5, s[12:15], s38 offen lds
v_exp_f32 v72, v72
v_exp_f32 v73, v73
v_exp_f32 v74, v74
v_exp_f32 v75, v75
v_exp_f32 v76, v76
v_exp_f32 v77, v77
v_exp_f32 v78, v78
v_exp_f32 v79, v79
s_add_u32 m0, s40, 53248
s_add_u32 s38, s38, 57344
buffer_load_dwordx4 v4, s[12:15], s38 offen lds
v_fma_f32 v192, -v60, v48, v192
v_fma_f32 v193, -v60, v49, v193
v_fma_f32 v194, -v60, v50, v194
v_fma_f32 v195, -v60, v51, v195
v_fma_f32 v216, -v62, v48, v216
v_fma_f32 v217, -v62, v49, v217
v_fma_f32 v218, -v62, v50, v218
s_add_u32 m0, s40, 54272
s_nop 0
buffer_load_dwordx4 v5, s[12:15], s38 offen lds
v_fma_f32 v219, -v62, v51, v219
v_fma_f32 v72, v72, v66, v66
v_fma_f32 v73, v73, v66, v66
v_fma_f32 v74, v74, v66, v66
v_fma_f32 v75, v75, v66, v66
v_fma_f32 v76, v76, v70, v70
v_fma_f32 v77, v77, v70, v70
v_fma_f32 v78, v78, v70, v70
s_add_u32 m0, s40, 55296
s_add_u32 s38, s38, 57344
buffer_load_dwordx4 v4, s[12:15], s38 offen lds
s_add_u32 m0, s40, 56320
s_nop 0
buffer_load_dwordx4 v5, s[12:15], s38 offen lds
s_waitcnt vmcnt(12)
s_barrier
s_add_u32 s37, s35, 10
s_and_b32 s37, s37, 15
s_mul_i32 s37, s37, 16384
s_add_u32 m0, s39, 98304
s_nop 0
buffer_load_dwordx4 v3, s[8:11], s37 offen sc1 lds
v_fma_f32 v79, v79, v70, v70
v_rcp_f32 v72, v72
v_rcp_f32 v73, v73
v_rcp_f32 v74, v74
v_rcp_f32 v75, v75
v_rcp_f32 v76, v76
buffer_load_dwordx4 v3, s[8:11], s37 offen offset:1024 sc1 lds
v_rcp_f32 v77, v77
v_rcp_f32 v78, v78
v_rcp_f32 v79, v79
v_mul_f32 v192, v180, v192
v_mul_f32 v193, v181, v193
v_mul_f32 v194, v182, v194
buffer_load_dwordx4 v3, s[8:11], s37 offen offset:2048 sc1 lds
v_mul_f32 v195, v183, v195
v_mul_f32 v216, v204, v216
v_mul_f32 v217, v205, v217
v_mul_f32 v218, v206, v218
v_mul_f32 v219, v207, v219
v_mul_f32 v192, v192, v72
buffer_load_dwordx4 v3, s[8:11], s37 offen offset:3072 sc1 lds
v_mul_f32 v193, v193, v73
v_mul_f32 v194, v194, v74
v_mul_f32 v195, v195, v75
v_mul_f32 v216, v216, v76
v_mul_f32 v217, v217, v77
v_mul_f32 v218, v218, v78
s_add_u32 s38, s35, 10
s_and_b32 s38, s38, 15
s_mul_i32 s38, s38, 458752
s_add_u32 m0, s40, 98304
s_nop 0
buffer_load_dwordx4 v4, s[12:15], s38 offen lds
v_mul_f32 v219, v219, v79
v_cvt_pk_bf16_f32 v178, v192, v193
v_cvt_pk_bf16_f32 v179, v194, v195
v_cvt_pk_bf16_f32 v202, v216, v217
v_cvt_pk_bf16_f32 v203, v218, v219
buffer_store_dwordx4 v[176:179], v2, s[24:27], s54 offen offset:2048 sc1
s_add_u32 m0, s40, 99328
s_nop 0
buffer_load_dwordx4 v5, s[12:15], s38 offen lds
buffer_store_dwordx4 v[200:203], v2, s[24:27], s54 offen offset:3072 sc1
v_fma_f32 v184, -v60, v40, v184
v_fma_f32 v185, -v60, v41, v185
v_fma_f32 v186, -v60, v42, v186
v_fma_f32 v187, -v60, v43, v187
v_fma_f32 v208, -v62, v40, v208
s_add_u32 m0, s40, 100352
s_add_u32 s38, s38, 57344
buffer_load_dwordx4 v4, s[12:15], s38 offen lds
v_fma_f32 v209, -v62, v41, v209
v_fma_f32 v210, -v62, v42, v210
v_fma_f32 v211, -v62, v43, v211
v_mul_f32 v72, v184, v184
v_mul_f32 v73, v185, v185
v_mul_f32 v74, v186, v186
s_add_u32 m0, s40, 101376
s_nop 0
buffer_load_dwordx4 v5, s[12:15], s38 offen lds
v_mul_f32 v75, v187, v187
v_mul_f32 v76, v208, v208
v_mul_f32 v77, v209, v209
v_mul_f32 v78, v210, v210
v_mul_f32 v79, v211, v211
v_fma_f32 v72, v72, v65, v64
s_add_u32 m0, s40, 102400
s_add_u32 s38, s38, 57344
buffer_load_dwordx4 v4, s[12:15], s38 offen lds
v_fma_f32 v73, v73, v65, v64
v_fma_f32 v74, v74, v65, v64
v_fma_f32 v75, v75, v65, v64
v_fma_f32 v76, v76, v69, v68
v_fma_f32 v77, v77, v69, v68
v_fma_f32 v78, v78, v69, v68
s_add_u32 m0, s40, 103424
s_nop 0
buffer_load_dwordx4 v5, s[12:15], s38 offen lds
v_fma_f32 v79, v79, v69, v68
v_mul_f32 v72, v72, v184
v_mul_f32 v73, v73, v185
v_mul_f32 v74, v74, v186
v_mul_f32 v75, v75, v187
v_mul_f32 v76, v76, v208
s_branch Lov_9
.p2align 12
Lst_9_0:
s_branch Lwr_150
s_nop 0
Lov_9:
s_add_u32 m0, s40, 104448
s_add_u32 s38, s38, 57344
buffer_load_dwordx4 v4, s[12:15], s38 offen lds
s_add_u32 m0, s40, 105472
s_nop 0
buffer_load_dwordx4 v5, s[12:15], s38 offen lds
s_waitcnt vmcnt(14)
s_cmp_eq_u32 s47, 3
s_cbranch_scc0 Lw_110
s_mov_b32 s41, 0x40000
s_branch Lpchk_113
Lpoll_111:
s_load_dword s93, s[82:83], s92 glc
Lpchk_113:
s_waitcnt lgkmcnt(0)
s_cmp_eq_u32 s93, 16
s_cbranch_scc1 Lpok_112
s_sub_u32 s41, s41, 1
s_cmp_lg_u32 s41, 0
s_cbranch_scc1 Lpoll_111
Lpok_112:
Lw_110:
s_barrier
s_lshl_b32 s60, s35, 9
s_lshl_b32 s43, s47, 7
s_add_u32 s60, s60, s43
s_add_u32 s61, s60, 14336
s_add_u32 s52, s43, 148480
s_add_u32 s53, s52, 896
v_lshrrev_b32 v104, 3, v1
v_mul_u32_u24 v104, 28672, v104
v_and_b32 v105, 7, v1
v_lshl_add_u32 v104, v105, 4, v104
s_waitcnt lgkmcnt(0)
buffer_load_dwordx4 v[96:99], v104, s[84:87], s60 offen sc1
s_load_dword s3, s[4:5], 5376
s_load_dword s3, s[4:5], 5440
s_load_dword s3, s[4:5], 5504
s_load_dword s3, s[4:5], 5568
s_load_dword s3, s[4:5], 5632
s_load_dword s3, s[4:5], 5696
buffer_load_dwordx4 v[100:103], v104, s[84:87], s61 offen sc1
s_load_dword s3, s[4:5], 5760
s_load_dword s3, s[4:5], 5824
s_load_dword s3, s[4:5], 5888
s_load_dword s3, s[4:5], 5952
s_load_dword s3, s[4:5], 6016
s_load_dword s3, s[4:5], 6080
s_load_dword s3, s[4:5], 6144
s_add_u32 s37, s35, 11
s_and_b32 s37, s37, 15
s_mul_i32 s37, s37, 16384
s_add_u32 m0, s39, 0
s_nop 0
buffer_load_dwordx4 v3, s[8:11], s37 offen sc1 lds
s_load_dword s3, s[4:5], 6208
v_mul_f32 v77, v77, v209
v_mul_f32 v78, v78, v210
v_mul_f32 v79, v79, v211
v_exp_f32 v72, v72
v_exp_f32 v73, v73
v_exp_f32 v74, v74
buffer_load_dwordx4 v3, s[8:11], s37 offen offset:1024 sc1 lds
v_exp_f32 v75, v75
v_exp_f32 v76, v76
v_exp_f32 v77, v77
v_exp_f32 v78, v78
v_exp_f32 v79, v79
v_fma_f32 v196, -v60, v52, v196
v_fma_f32 v197, -v60, v53, v197
buffer_load_dwordx4 v3, s[8:11], s37 offen offset:2048 sc1 lds
v_fma_f32 v198, -v60, v54, v198
v_fma_f32 v199, -v60, v55, v199
v_fma_f32 v220, -v62, v52, v220
v_fma_f32 v221, -v62, v53, v221
v_fma_f32 v222, -v62, v54, v222
v_fma_f32 v223, -v62, v55, v223
buffer_load_dwordx4 v3, s[8:11], s37 offen offset:3072 sc1 lds
v_fma_f32 v72, v72, v66, v66
v_fma_f32 v73, v73, v66, v66
v_fma_f32 v74, v74, v66, v66
v_fma_f32 v75, v75, v66, v66
v_fma_f32 v76, v76, v70, v70
v_fma_f32 v77, v77, v70, v70
v_fma_f32 v78, v78, v70, v70
s_add_u32 s38, s35, 11
s_and_b32 s38, s38, 15
s_mul_i32 s38, s38, 458752
s_add_u32 m0, s40, 0
s_nop 0
buffer_load_dwordx4 v4, s[12:15], s38 offen lds
v_fma_f32 v79, v79, v70, v70
v_rcp_f32 v72, v72
v_rcp_f32 v73, v73
v_rcp_f32 v74, v74
v_rcp_f32 v75, v75
v_rcp_f32 v76, v76
v_rcp_f32 v77, v77
s_add_u32 m0, s40, 1024
s_nop 0
buffer_load_dwordx4 v5, s[12:15], s38 offen lds
v_rcp_f32 v78, v78
v_rcp_f32 v79, v79
v_mul_f32 v196, v184, v196
v_mul_f32 v197, v185, v197
v_mul_f32 v198, v186, v198
v_mul_f32 v199, v187, v199
v_mul_f32 v220, v208, v220
s_add_u32 m0, s40, 2048
s_add_u32 s38, s38, 57344
buffer_load_dwordx4 v4, s[12:15], s38 offen lds
v_mul_f32 v221, v209, v221
v_mul_f32 v222, v210, v222
v_mul_f32 v223, v211, v223
v_mul_f32 v196, v196, v72
v_mul_f32 v197, v197, v73
v_mul_f32 v198, v198, v74
s_add_u32 m0, s40, 3072
s_nop 0
buffer_load_dwordx4 v5, s[12:15], s38 offen lds
v_mul_f32 v199, v199, v75
v_mul_f32 v220, v220, v76
v_mul_f32 v221, v221, v77
v_mul_f32 v222, v222, v78
v_mul_f32 v223, v223, v79
v_cvt_pk_bf16_f32 v80, v196, v197
v_cvt_pk_bf16_f32 v81, v198, v199
s_add_u32 m0, s40, 4096
s_add_u32 s38, s38, 57344
buffer_load_dwordx4 v4, s[12:15], s38 offen lds
v_cvt_pk_bf16_f32 v82, v220, v221
v_cvt_pk_bf16_f32 v83, v222, v223
s_nop 1
v_permlane32_swap_b32 v80, v82
v_permlane32_swap_b32 v81, v83
buffer_store_dwordx4 v[80:83], v84, s[24:27], s55 offen offset:2048 sc1
s_nop 1
s_add_u32 m0, s40, 5120
s_nop 0
buffer_load_dwordx4 v5, s[12:15], s38 offen lds
v_cmp_gt_u32 vcc, 32, v1
v_mov_b32 v104, s52
v_mov_b32 v106, s53
v_cndmask_b32 v104, v106, v104, vcc
v_lshl_add_u32 v104, v105, 4, v104
v_bfe_u32 v105, v1, 4, 1
v_lshl_add_u32 v104, v105, 2, v104
s_add_u32 m0, s40, 6144
s_add_u32 s38, s38, 57344
buffer_load_dwordx4 v4, s[12:15], s38 offen lds
s_add_u32 m0, s40, 7168
s_nop 0
buffer_load_dwordx4 v5, s[12:15], s38 offen lds
s_waitcnt vmcnt(15)
s_barrier
s_add_u32 s37, s35, 12
s_and_b32 s37, s37, 15
s_mul_i32 s37, s37, 16384
s_add_u32 m0, s39, 49152
s_nop 0
buffer_load_dwordx4 v3, s[8:11], s37 offen sc1 lds
buffer_load_dwordx4 v3, s[8:11], s37 offen offset:1024 sc1 lds
buffer_load_dwordx4 v3, s[8:11], s37 offen offset:2048 sc1 lds
buffer_load_dwordx4 v3, s[8:11], s37 offen offset:3072 sc1 lds
s_add_u32 s38, s35, 12
s_and_b32 s38, s38, 15
s_mul_i32 s38, s38, 458752
s_add_u32 m0, s40, 49152
s_nop 0
buffer_load_dwordx4 v4, s[12:15], s38 offen lds
s_add_u32 m0, s40, 50176
s_nop 0
buffer_load_dwordx4 v5, s[12:15], s38 offen lds
s_add_u32 m0, s40, 51200
s_add_u32 s38, s38, 57344
buffer_load_dwordx4 v4, s[12:15], s38 offen lds
s_add_u32 m0, s40, 52224
s_nop 0
buffer_load_dwordx4 v5, s[12:15], s38 offen lds
s_add_u32 m0, s40, 53248
s_add_u32 s38, s38, 57344
buffer_load_dwordx4 v4, s[12:15], s38 offen lds
s_add_u32 m0, s40, 54272
s_nop 0
buffer_load_dwordx4 v5, s[12:15], s38 offen lds
s_add_u32 m0, s40, 55296
s_add_u32 s38, s38, 57344
buffer_load_dwordx4 v4, s[12:15], s38 offen lds
s_add_u32 m0, s40, 56320
s_nop 0
buffer_load_dwordx4 v5, s[12:15], s38 offen lds
s_waitcnt vmcnt(12)
s_barrier
s_cmp_eq_u32 s47, 0
s_cbranch_scc0 Lw_114
s_add_u32 s7, s34, 32
s_lshl_b32 s7, s7, 7
v_mov_b32 v28, s7
v_mov_b32 v29, 1
s_mov_b64 exec, 1
buffer_atomic_add v29, v28, s[56:59], 0 offen sc1
s_mov_b64 exec, -1
Lw_114:
v_permlane32_swap_b32 v96, v100
v_permlane32_swap_b32 v97, v101
v_permlane32_swap_b32 v98, v102
v_permlane32_swap_b32 v99, v103
v_add_f32 v96, v96, v100
v_add_f32 v97, v97, v101
v_add_f32 v98, v98, v102
v_add_f32 v99, v99, v103
s_nop 1
v_permlane16_swap_b32 v96, v97
v_permlane16_swap_b32 v98, v99
v_add_f32 v96, v96, v97
v_add_f32 v98, v98, v99
s_nop 1
v_add_f32_dpp v96, v96, v96 row_ror:8 row_mask:0xf bank_mask:0xf
v_add_f32_dpp v98, v98, v98 row_ror:8 row_mask:0xf bank_mask:0xf
ds_write_b32 v104, v96
ds_write_b32 v104, v98 offset:8
s_waitcnt lgkmcnt(0)
s_add_u32 s37, s35, 13
s_and_b32 s37, s37, 15
s_mul_i32 s37, s37, 16384
s_add_u32 m0, s39, 98304
s_nop 0
buffer_load_dwordx4 v3, s[8:11], s37 offen sc1 lds
s_load_dword s3, s[4:5], 6272
s_load_dword s3, s[4:5], 6336
s_load_dword s3, s[4:5], 6400
s_load_dword s3, s[4:5], 6464
s_load_dword s3, s[4:5], 6528
s_load_dword s3, s[4:5], 6592
buffer_load_dwordx4 v3, s[8:11], s37 offen offset:1024 sc1 lds
s_load_dword s3, s[4:5], 6656
s_load_dword s3, s[4:5], 6720
s_load_dword s3, s[4:5], 6784
s_load_dword s3, s[4:5], 6848
s_load_dword s3, s[4:5], 6912
s_load_dword s3, s[4:5], 6976
buffer_load_dwordx4 v3, s[8:11], s37 offen offset:2048 sc1 lds
s_load_dword s3, s[4:5], 7040
s_load_dword s3, s[4:5], 7104
s_bfe_u32 s61, s35, 0x10002
s_lshr_b32 s60, s35, 3
s_lshl_b32 s60, s60, 2
s_and_b32 s43, s35, 3
buffer_load_dwordx4 v3, s[8:11], s37 offen offset:3072 sc1 lds
s_add_u32 s60, s60, s43
s_lshl_b32 s43, s60, 8
s_add_u32 s28, s76, s43
s_addc_u32 s29, s77, 0
s_mov_b32 s30, 7338240
s_mov_b32 s31, 0x20000
s_mul_i32 s52, s61, 196608
s_add_u32 s38, s35, 13
s_and_b32 s38, s38, 15
s_mul_i32 s38, s38, 458752
s_add_u32 m0, s40, 98304
s_nop 0
buffer_load_dwordx4 v4, s[12:15], s38 offen lds
s_mul_i32 s53, s61, 1572864
s_mul_i32 s90, s61, 163840
s_mul_i32 s91, s61, 1310720
s_lshl_b32 s51, s47, 11
s_lshl_b32 s44, s47, 15
v_lshrrev_b32 v122, 4, v1
s_add_u32 m0, s40, 99328
s_nop 0
buffer_load_dwordx4 v5, s[12:15], s38 offen lds
v_lshlrev_b32 v123, 1, v122
v_and_b32 v23, 15, v1
v_xor_b32 v23, v23, v123
v_lshlrev_b32 v23, 4, v23
v_mul_u32_u24 v122, 2048, v122
v_add_u32 v23, v23, v122
s_add_u32 m0, s40, 100352
s_add_u32 s38, s38, 57344
buffer_load_dwordx4 v4, s[12:15], s38 offen lds
v_add_u32 v23, s44, v23
v_xor_b32 v24, 128, v23
v_add_u32 v24, 8192, v24
s_lshl_b32 s43, s60, 2
s_lshl_b32 s44, s61, 1
s_add_u32 s43, s43, s44
s_add_u32 s43, s43, s63
s_add_u32 m0, s40, 101376
s_nop 0
buffer_load_dwordx4 v5, s[12:15], s38 offen lds
s_lshl_b32 s43, s43, 13
s_lshl_b32 s44, s62, 12
s_add_u32 s50, s43, s44
v_add_u32 v6, s44, v2
v_add_u32 v7, 0x10000, v6
v_add_u32 v8, 0x20000, v6
s_add_u32 m0, s40, 102400
s_add_u32 s38, s38, 57344
buffer_load_dwordx4 v4, s[12:15], s38 offen lds
v_lshrrev_b32 v122, 2, v1
v_and_b32 v123, 7, v122
v_mul_u32_u24 v122, 256, v122
v_lshl_add_u32 v122, v123, 5, v122
v_and_b32 v123, 3, v1
v_lshl_add_u32 v9, v123, 3, v122
s_add_u32 m0, s40, 103424
s_nop 0
buffer_load_dwordx4 v5, s[12:15], s38 offen lds
s_lshl_b32 s43, s61, 7
s_lshl_b32 s44, s63, 6
s_add_u32 s43, s43, s44
v_xor_b32 v9, s43, v9
v_xor_b32 v10, 32, v9
v_xor_b32 v11, 128, v9
v_xor_b32 v12, 128, v10
s_add_u32 m0, s40, 104448
s_add_u32 s38, s38, 57344
buffer_load_dwordx4 v4, s[12:15], s38 offen lds
s_add_u32 m0, s40, 105472
s_nop 0
buffer_load_dwordx4 v5, s[12:15], s38 offen lds
s_waitcnt vmcnt(12)
s_barrier
buffer_load_dwordx4 v[160:163], v2, s[8:11], s50 offen offset:0 sc1
v_add_u32 v13, 65536, v9
v_add_u32 v14, 65536, v10
v_add_u32 v15, 65536, v11
buffer_load_dwordx4 v[164:167], v2, s[8:11], s50 offen offset:1024 sc1
v_add_u32 v16, 65536, v12
v_add_u32 v25, 131072, v9
v_add_u32 v26, 131072, v10
v_add_u32 v27, 131072, v11
buffer_load_dwordx4 v[168:171], v2, s[8:11], s50 offen offset:2048 sc1
v_add_u32 v28, 131072, v12
v_lshrrev_b32 v122, 2, v1
v_bfe_u32 v123, v122, 1, 2
buffer_load_dwordx4 v[172:175], v2, s[8:11], s50 offen offset:3072 sc1
v_mul_u32_u24 v122, 128, v122
v_lshl_add_u32 v122, v123, 5, v122
v_and_b32 v123, 3, v1
v_lshl_add_u32 v224, v123, 3, v122
s_add_u32 s37, s35, 14
s_and_b32 s37, s37, 15
s_mul_i32 s37, s37, 16384
s_add_u32 m0, s39, 0
s_nop 0
buffer_load_dwordx4 v3, s[8:11], s37 offen sc1 lds
v_xor_b32 v224, s44, v224
v_xor_b32 v225, 32, v224
v_add_u32 v226, 65536, v224
buffer_load_dwordx4 v3, s[8:11], s37 offen offset:1024 sc1 lds
v_add_u32 v227, 65536, v225
v_add_u32 v228, 131072, v224
v_add_u32 v229, 131072, v225
s_add_u32 s84, s82, 33554432
buffer_load_dwordx4 v3, s[8:11], s37 offen offset:2048 sc1 lds
s_addc_u32 s85, s83, 0
s_mov_b32 s86, 4194304
s_mov_b32 s87, 0x20000
s_xor_b32 s43, s2, 2
buffer_load_dwordx4 v3, s[8:11], s37 offen offset:3072 sc1 lds
s_lshl_b32 s44, s43, 2
s_add_u32 s44, s44, s47
s_lshl_b32 s45, s44, 12
s_add_u32 s38, s35, 14
s_and_b32 s38, s38, 15
s_mul_i32 s38, s38, 458752
s_add_u32 m0, s40, 0
s_nop 0
buffer_load_dwordx4 v4, s[12:15], s38 offen lds
s_lshl_b32 s46, s2, 2
s_add_u32 s46, s46, s47
s_lshl_b32 s46, s46, 12
s_lshl_b32 s43, s34, 18
s_add_u32 m0, s40, 1024
s_nop 0
buffer_load_dwordx4 v5, s[12:15], s38 offen lds
s_lshl_b32 s42, s60, 8
s_add_u32 s43, s43, s42
s_lshl_b32 s42, s61, 7
s_add_u32 m0, s40, 2048
s_add_u32 s38, s38, 57344
buffer_load_dwordx4 v4, s[12:15], s38 offen lds
s_add_u32 s43, s43, s42
s_lshl_b32 s42, s63, 6
s_add_u32 s43, s43, s42
s_add_u32 s20, s78, s43
s_add_u32 m0, s40, 3072
s_nop 0
buffer_load_dwordx4 v5, s[12:15], s38 offen lds
s_addc_u32 s21, s79, 0
s_mov_b32 s22, 260160
s_mov_b32 s23, 0x20000
s_add_u32 m0, s40, 4096
s_add_u32 s38, s38, 57344
buffer_load_dwordx4 v4, s[12:15], s38 offen lds
v_and_b32 v230, 15, v1
v_lshlrev_b32 v230, 12, v230
v_bfe_u32 v231, v1, 4, 1
v_lshl_add_u32 v230, v231, 5, v230
s_add_u32 m0, s40, 5120
s_nop 0
buffer_load_dwordx4 v5, s[12:15], s38 offen lds
v_bfe_u32 v231, v1, 5, 1
v_lshl_add_u32 v230, v231, 4, v230
s_lshl_b32 s54, s62, 17
s_add_u32 s55, s54, 65536
s_add_u32 m0, s40, 6144
s_add_u32 s38, s38, 57344
buffer_load_dwordx4 v4, s[12:15], s38 offen lds
s_add_u32 m0, s40, 7168
s_nop 0
buffer_load_dwordx4 v5, s[12:15], s38 offen lds
s_waitcnt vmcnt(16)
s_barrier
s_cmp_eq_u32 s47, 3
s_cbranch_scc0 Lw_115
s_lshl_b32 s92, s34, 7
s_add_u32 s92, s92, 28315648
s_load_dword s93, s[82:83], s92 glc
Lw_115:
s_add_u32 s37, s35, 15
s_and_b32 s37, s37, 15
s_mul_i32 s37, s37, 16384
s_add_u32 m0, s39, 49152
s_nop 0
buffer_load_dwordx4 v3, s[8:11], s37 offen sc1 lds
buffer_load_dwordx4 v3, s[8:11], s37 offen offset:1024 sc1 lds
buffer_load_dwordx4 v3, s[8:11], s37 offen offset:2048 sc1 lds
buffer_load_dwordx4 v3, s[8:11], s37 offen offset:3072 sc1 lds
s_add_u32 s38, s35, 15
s_and_b32 s38, s38, 15
s_mul_i32 s38, s38, 458752
s_add_u32 m0, s40, 49152
s_nop 0
buffer_load_dwordx4 v4, s[12:15], s38 offen lds
s_add_u32 m0, s40, 50176
s_nop 0
buffer_load_dwordx4 v5, s[12:15], s38 offen lds
s_add_u32 m0, s40, 51200
s_add_u32 s38, s38, 57344
buffer_load_dwordx4 v4, s[12:15], s38 offen lds
s_add_u32 m0, s40, 52224
s_nop 0
buffer_load_dwordx4 v5, s[12:15], s38 offen lds
s_add_u32 m0, s40, 53248
s_add_u32 s38, s38, 57344
buffer_load_dwordx4 v4, s[12:15], s38 offen lds
s_add_u32 m0, s40, 54272
s_nop 0
buffer_load_dwordx4 v5, s[12:15], s38 offen lds
s_add_u32 m0, s40, 55296
s_add_u32 s38, s38, 57344
buffer_load_dwordx4 v4, s[12:15], s38 offen lds
s_add_u32 m0, s40, 56320
s_nop 0
buffer_load_dwordx4 v5, s[12:15], s38 offen lds
s_waitcnt vmcnt(12)
s_cmp_eq_u32 s47, 3
s_cbranch_scc0 Lw_116
s_mov_b32 s41, 0x40000
s_branch Lpchk_119
Lpoll_117:
s_load_dword s93, s[82:83], s92 glc
Lpchk_119:
s_waitcnt lgkmcnt(0)
s_cmp_eq_u32 s93, 16
s_cbranch_scc1 Lpok_118
s_sub_u32 s41, s41, 1
s_cmp_lg_u32 s41, 0
s_cbranch_scc1 Lpoll_117
Lpok_118:
Lw_116:
s_barrier
s_add_u32 m0, s39, 98304
s_add_u32 s37, s52, 524288
buffer_load_dwordx4 v3, s[24:27], s37 offen sc1 lds
v_lshlrev_b32 v128, 16, v160
v_and_b32 v129, 0xffff0000, v160
v_lshlrev_b32 v130, 16, v161
v_and_b32 v131, 0xffff0000, v161
v_lshlrev_b32 v132, 16, v162
buffer_load_dwordx4 v3, s[24:27], s37 offen offset:1024 sc1 lds
v_and_b32 v133, 0xffff0000, v162
v_lshlrev_b32 v134, 16, v163
v_and_b32 v135, 0xffff0000, v163
v_lshlrev_b32 v136, 16, v164
v_and_b32 v137, 0xffff0000, v164
buffer_load_dwordx4 v3, s[24:27], s37 offen offset:2048 sc1 lds
v_lshlrev_b32 v138, 16, v165
v_and_b32 v139, 0xffff0000, v165
v_lshlrev_b32 v140, 16, v166
v_and_b32 v141, 0xffff0000, v166
v_lshlrev_b32 v142, 16, v167
v_and_b32 v143, 0xffff0000, v167
buffer_load_dwordx4 v3, s[24:27], s37 offen offset:3072 sc1 lds
v_lshlrev_b32 v144, 16, v168
v_and_b32 v145, 0xffff0000, v168
v_lshlrev_b32 v146, 16, v169
v_and_b32 v147, 0xffff0000, v169
v_lshlrev_b32 v148, 16, v170
s_add_u32 m0, s39, 114688
s_add_u32 s38, s53, 4194304
buffer_load_dwordx4 v23, s[28:31], s38 offen lds
v_and_b32 v149, 0xffff0000, v170
v_lshlrev_b32 v150, 16, v171
v_and_b32 v151, 0xffff0000, v171
v_lshlrev_b32 v152, 16, v172
v_and_b32 v153, 0xffff0000, v172
s_add_u32 m0, s39, 115712
s_add_u32 s38, s53, 4194304
buffer_load_dwordx4 v24, s[28:31], s38 offen lds
v_lshlrev_b32 v154, 16, v173
v_and_b32 v155, 0xffff0000, v173
v_lshlrev_b32 v156, 16, v174
v_and_b32 v157, 0xffff0000, v174
v_lshlrev_b32 v158, 16, v175
v_and_b32 v159, 0xffff0000, v175
s_add_u32 m0, s39, 116736
s_add_u32 s38, s53, 4210688
buffer_load_dwordx4 v23, s[28:31], s38 offen lds
s_add_u32 m0, s39, 117760
s_add_u32 s38, s53, 4210688
buffer_load_dwordx4 v24, s[28:31], s38 offen lds
s_waitcnt vmcnt(8)
s_barrier
s_add_u32 m0, s39, 131072
s_add_u32 s37, s52, 540672
buffer_load_dwordx4 v3, s[24:27], s37 offen sc1 lds
buffer_load_dwordx4 v3, s[24:27], s37 offen offset:1024 sc1 lds
buffer_load_dwordx4 v3, s[24:27], s37 offen offset:2048 sc1 lds
buffer_load_dwordx4 v3, s[24:27], s37 offen offset:3072 sc1 lds
s_add_u32 m0, s39, 0
s_add_u32 s38, s53, 4325376
buffer_load_dwordx4 v23, s[28:31], s38 offen lds
s_add_u32 m0, s39, 1024
s_add_u32 s38, s53, 4325376
buffer_load_dwordx4 v24, s[28:31], s38 offen lds
s_add_u32 m0, s39, 2048
s_add_u32 s38, s53, 4341760
buffer_load_dwordx4 v23, s[28:31], s38 offen lds
s_add_u32 m0, s39, 3072
s_add_u32 s38, s53, 4341760
buffer_load_dwordx4 v24, s[28:31], s38 offen lds
s_add_u32 m0, s39, 16384
s_add_u32 s37, s52, 557056
buffer_load_dwordx4 v3, s[24:27], s37 offen sc1 lds
buffer_load_dwordx4 v3, s[24:27], s37 offen offset:1024 sc1 lds
buffer_load_dwordx4 v3, s[24:27], s37 offen offset:2048 sc1 lds
buffer_load_dwordx4 v3, s[24:27], s37 offen offset:3072 sc1 lds
s_add_u32 m0, s39, 32768
s_add_u32 s38, s53, 4456448
buffer_load_dwordx4 v23, s[28:31], s38 offen lds
s_add_u32 m0, s39, 33792
s_add_u32 s38, s53, 4456448
buffer_load_dwordx4 v24, s[28:31], s38 offen lds
s_add_u32 m0, s39, 34816
s_add_u32 s38, s53, 4472832
buffer_load_dwordx4 v23, s[28:31], s38 offen lds
s_add_u32 m0, s39, 35840
s_add_u32 s38, s53, 4472832
buffer_load_dwordx4 v24, s[28:31], s38 offen lds
s_waitcnt vmcnt(16)
s_barrier
ds_read_b128 v[32:35], v7 offset:32768
ds_read_b64_tr_b16 v[48:49], v13 offset:49152
ds_read_b64_tr_b16 v[50:51], v13 offset:53248
ds_read_b64_tr_b16 v[52:53], v14 offset:49152
ds_read_b64_tr_b16 v[54:55], v14 offset:53248
ds_read_b64_tr_b16 v[56:57], v15 offset:49152
ds_read_b64_tr_b16 v[58:59], v15 offset:53248
ds_read_b64_tr_b16 v[60:61], v16 offset:49152
ds_read_b64_tr_b16 v[62:63], v16 offset:53248
ds_read_b128 v[36:39], v7 offset:33792
ds_read_b128 v[40:43], v7 offset:34816
ds_read_b128 v[44:47], v7 offset:35840
ds_read_b128 v[64:67], v7 offset:40960
ds_read_b64_tr_b16 v[80:81], v13 offset:57344
ds_read_b64_tr_b16 v[82:83], v13 offset:61440
ds_read_b64_tr_b16 v[84:85], v14 offset:57344
ds_read_b64_tr_b16 v[86:87], v14 offset:61440
ds_read_b64_tr_b16 v[88:89], v15 offset:57344
ds_read_b64_tr_b16 v[90:91], v15 offset:61440
ds_read_b64_tr_b16 v[92:93], v16 offset:57344
ds_read_b64_tr_b16 v[94:95], v16 offset:61440
ds_read_b128 v[68:71], v7 offset:41984
ds_read_b128 v[72:75], v7 offset:43008
ds_read_b128 v[76:79], v7 offset:44032
s_add_u32 m0, s39, 49152
s_add_u32 s37, s52, 573440
buffer_load_dwordx4 v3, s[24:27], s37 offen sc1 lds
buffer_load_dwordx4 v3, s[24:27], s37 offen offset:1024 sc1 lds
buffer_load_dwordx4 v3, s[24:27], s37 offen offset:2048 sc1 lds
buffer_load_dwordx4 v3, s[24:27], s37 offen offset:3072 sc1 lds
s_add_u32 m0, s39, 65536
s_add_u32 s38, s53, 4587520
buffer_load_dwordx4 v23, s[28:31], s38 offen lds
s_add_u32 m0, s39, 66560
s_add_u32 s38, s53, 4587520
buffer_load_dwordx4 v24, s[28:31], s38 offen lds
s_add_u32 m0, s39, 67584
s_add_u32 s38, s53, 4603904
buffer_load_dwordx4 v23, s[28:31], s38 offen lds
s_add_u32 m0, s39, 68608
s_add_u32 s38, s53, 4603904
buffer_load_dwordx4 v24, s[28:31], s38 offen lds
s_waitcnt vmcnt(16)
s_waitcnt lgkmcnt(0)
s_barrier
v_mfma_f32_16x16x32_bf16 v[128:131], v[48:51], v[32:35], v[128:131]
ds_read_b128 v[96:99], v8 offset:0
v_mfma_f32_16x16x32_bf16 v[132:135], v[52:55], v[32:35], v[132:135]
ds_read_b64_tr_b16 v[112:113], v9 offset:0
v_mfma_f32_16x16x32_bf16 v[160:163], v[56:59], v[32:35], 0
ds_read_b64_tr_b16 v[114:115], v9 offset:4096
v_mfma_f32_16x16x32_bf16 v[164:167], v[60:63], v[32:35], 0
ds_read_b64_tr_b16 v[116:117], v10 offset:0
v_mfma_f32_16x16x32_bf16 v[172:175], v[60:63], v[36:39], 0
ds_read_b64_tr_b16 v[118:119], v10 offset:4096
v_mfma_f32_16x16x32_bf16 v[168:171], v[56:59], v[36:39], 0
ds_read_b64_tr_b16 v[120:121], v11 offset:0
v_mfma_f32_16x16x32_bf16 v[140:143], v[52:55], v[36:39], v[140:143]
ds_read_b64_tr_b16 v[122:123], v11 offset:4096
v_mfma_f32_16x16x32_bf16 v[136:139], v[48:51], v[36:39], v[136:139]
ds_read_b64_tr_b16 v[124:125], v12 offset:0
v_mfma_f32_16x16x32_bf16 v[144:147], v[48:51], v[40:43], v[144:147]
ds_read_b64_tr_b16 v[126:127], v12 offset:4096
v_mfma_f32_16x16x32_bf16 v[148:151], v[52:55], v[40:43], v[148:151]
ds_read_b128 v[100:103], v8 offset:1024
v_mfma_f32_16x16x32_bf16 v[176:179], v[56:59], v[40:43], 0
ds_read_b128 v[104:107], v8 offset:2048
v_mfma_f32_16x16x32_bf16 v[180:183], v[60:63], v[40:43], 0
ds_read_b128 v[108:111], v8 offset:3072
v_mfma_f32_16x16x32_bf16 v[188:191], v[60:63], v[44:47], 0
ds_read_b128 v[192:195], v8 offset:8192
v_mfma_f32_16x16x32_bf16 v[184:187], v[56:59], v[44:47], 0
ds_read_b64_tr_b16 v[208:209], v9 offset:8192
v_mfma_f32_16x16x32_bf16 v[156:159], v[52:55], v[44:47], v[156:159]
ds_read_b64_tr_b16 v[210:211], v9 offset:12288
v_mfma_f32_16x16x32_bf16 v[152:155], v[48:51], v[44:47], v[152:155]
s_branch Lov_10
.p2align 12
Lst_10_0:
s_branch Lst_14_0
s_nop 0
Lov_10:
ds_read_b64_tr_b16 v[212:213], v10 offset:8192
v_mfma_f32_16x16x32_bf16 v[128:131], v[80:83], v[64:67], v[128:131]
ds_read_b64_tr_b16 v[214:215], v10 offset:12288
v_mfma_f32_16x16x32_bf16 v[132:135], v[84:87], v[64:67], v[132:135]
ds_read_b64_tr_b16 v[216:217], v11 offset:8192
v_mfma_f32_16x16x32_bf16 v[160:163], v[88:91], v[64:67], v[160:163]
ds_read_b64_tr_b16 v[218:219], v11 offset:12288
v_mfma_f32_16x16x32_bf16 v[164:167], v[92:95], v[64:67], v[164:167]
ds_read_b64_tr_b16 v[220:221], v12 offset:8192
v_mfma_f32_16x16x32_bf16 v[172:175], v[92:95], v[68:71], v[172:175]
ds_read_b64_tr_b16 v[222:223], v12 offset:12288
v_mfma_f32_16x16x32_bf16 v[168:171], v[88:91], v[68:71], v[168:171]
ds_read_b128 v[196:199], v8 offset:9216
v_mfma_f32_16x16x32_bf16 v[140:143], v[84:87], v[68:71], v[140:143]
ds_read_b128 v[200:203], v8 offset:10240
v_mfma_f32_16x16x32_bf16 v[136:139], v[80:83], v[68:71], v[136:139]
ds_read_b128 v[204:207], v8 offset:11264
v_mfma_f32_16x16x32_bf16 v[144:147], v[80:83], v[72:75], v[144:147]
v_mfma_f32_16x16x32_bf16 v[148:151], v[84:87], v[72:75], v[148:151]
v_mfma_f32_16x16x32_bf16 v[176:179], v[88:91], v[72:75], v[176:179]
v_mfma_f32_16x16x32_bf16 v[180:183], v[92:95], v[72:75], v[180:183]
v_mfma_f32_16x16x32_bf16 v[188:191], v[92:95], v[76:79], v[188:191]
v_mfma_f32_16x16x32_bf16 v[184:187], v[88:91], v[76:79], v[184:187]
v_mfma_f32_16x16x32_bf16 v[156:159], v[84:87], v[76:79], v[156:159]
v_mfma_f32_16x16x32_bf16 v[152:155], v[80:83], v[76:79], v[152:155]
s_mov_b32 s41, 2
Lk4_120:
s_waitcnt vmcnt(8)
s_waitcnt lgkmcnt(0)
s_barrier
v_mfma_f32_16x16x32_bf16 v[128:131], v[112:115], v[96:99], v[128:131]
ds_read_b128 v[32:35], v6 offset:16384
v_mfma_f32_16x16x32_bf16 v[132:135], v[116:119], v[96:99], v[132:135]
ds_read_b64_tr_b16 v[48:49], v9 offset:32768
v_mfma_f32_16x16x32_bf16 v[160:163], v[120:123], v[96:99], v[160:163]
ds_read_b64_tr_b16 v[50:51], v9 offset:36864
v_mfma_f32_16x16x32_bf16 v[164:167], v[124:127], v[96:99], v[164:167]
ds_read_b64_tr_b16 v[52:53], v10 offset:32768
v_mfma_f32_16x16x32_bf16 v[172:175], v[124:127], v[100:103], v[172:175]
ds_read_b64_tr_b16 v[54:55], v10 offset:36864
v_mfma_f32_16x16x32_bf16 v[168:171], v[120:123], v[100:103], v[168:171]
ds_read_b64_tr_b16 v[56:57], v11 offset:32768
v_mfma_f32_16x16x32_bf16 v[140:143], v[116:119], v[100:103], v[140:143]
ds_read_b64_tr_b16 v[58:59], v11 offset:36864
v_mfma_f32_16x16x32_bf16 v[136:139], v[112:115], v[100:103], v[136:139]
ds_read_b64_tr_b16 v[60:61], v12 offset:32768
v_mfma_f32_16x16x32_bf16 v[144:147], v[112:115], v[104:107], v[144:147]
ds_read_b64_tr_b16 v[62:63], v12 offset:36864
v_mfma_f32_16x16x32_bf16 v[148:151], v[116:119], v[104:107], v[148:151]
ds_read_b128 v[36:39], v6 offset:17408
v_mfma_f32_16x16x32_bf16 v[176:179], v[120:123], v[104:107], v[176:179]
ds_read_b128 v[40:43], v6 offset:18432
v_mfma_f32_16x16x32_bf16 v[180:183], v[124:127], v[104:107], v[180:183]
ds_read_b128 v[44:47], v6 offset:19456
v_mfma_f32_16x16x32_bf16 v[188:191], v[124:127], v[108:111], v[188:191]
ds_read_b128 v[64:67], v6 offset:24576
v_mfma_f32_16x16x32_bf16 v[184:187], v[120:123], v[108:111], v[184:187]
ds_read_b64_tr_b16 v[80:81], v9 offset:40960
v_mfma_f32_16x16x32_bf16 v[156:159], v[116:119], v[108:111], v[156:159]
ds_read_b64_tr_b16 v[82:83], v9 offset:45056
v_mfma_f32_16x16x32_bf16 v[152:155], v[112:115], v[108:111], v[152:155]
ds_read_b64_tr_b16 v[84:85], v10 offset:40960
v_mfma_f32_16x16x32_bf16 v[128:131], v[208:211], v[192:195], v[128:131]
ds_read_b64_tr_b16 v[86:87], v10 offset:45056
v_mfma_f32_16x16x32_bf16 v[132:135], v[212:215], v[192:195], v[132:135]
ds_read_b64_tr_b16 v[88:89], v11 offset:40960
v_mfma_f32_16x16x32_bf16 v[160:163], v[216:219], v[192:195], v[160:163]
ds_read_b64_tr_b16 v[90:91], v11 offset:45056
v_mfma_f32_16x16x32_bf16 v[164:167], v[220:223], v[192:195], v[164:167]
ds_read_b64_tr_b16 v[92:93], v12 offset:40960
v_mfma_f32_16x16x32_bf16 v[172:175], v[220:223], v[196:199], v[172:175]
ds_read_b64_tr_b16 v[94:95], v12 offset:45056
v_mfma_f32_16x16x32_bf16 v[168:171], v[216:219], v[196:199], v[168:171]
ds_read_b128 v[68:71], v6 offset:25600
v_mfma_f32_16x16x32_bf16 v[140:143], v[212:215], v[196:199], v[140:143]
ds_read_b128 v[72:75], v6 offset:26624
v_mfma_f32_16x16x32_bf16 v[136:139], v[208:211], v[196:199], v[136:139]
ds_read_b128 v[76:79], v6 offset:27648
v_mfma_f32_16x16x32_bf16 v[144:147], v[208:211], v[200:203], v[144:147]
v_mfma_f32_16x16x32_bf16 v[148:151], v[212:215], v[200:203], v[148:151]
v_mfma_f32_16x16x32_bf16 v[176:179], v[216:219], v[200:203], v[176:179]
v_mfma_f32_16x16x32_bf16 v[180:183], v[220:223], v[200:203], v[180:183]
v_mfma_f32_16x16x32_bf16 v[188:191], v[220:223], v[204:207], v[188:191]
v_mfma_f32_16x16x32_bf16 v[184:187], v[216:219], v[204:207], v[184:187]
v_mfma_f32_16x16x32_bf16 v[156:159], v[212:215], v[204:207], v[156:159]
v_mfma_f32_16x16x32_bf16 v[152:155], v[208:211], v[204:207], v[152:155]
s_waitcnt vmcnt(0)
s_waitcnt lgkmcnt(0)
s_barrier
v_mfma_f32_16x16x32_bf16 v[128:131], v[48:51], v[32:35], v[128:131]
ds_read_b128 v[96:99], v6 offset:49152
v_mfma_f32_16x16x32_bf16 v[132:135], v[52:55], v[32:35], v[132:135]
ds_read_b64_tr_b16 v[112:113], v13 offset:0
v_mfma_f32_16x16x32_bf16 v[160:163], v[56:59], v[32:35], v[160:163]
ds_read_b64_tr_b16 v[114:115], v13 offset:4096
v_mfma_f32_16x16x32_bf16 v[164:167], v[60:63], v[32:35], v[164:167]
ds_read_b64_tr_b16 v[116:117], v14 offset:0
v_mfma_f32_16x16x32_bf16 v[172:175], v[60:63], v[36:39], v[172:175]
ds_read_b64_tr_b16 v[118:119], v14 offset:4096
v_mfma_f32_16x16x32_bf16 v[168:171], v[56:59], v[36:39], v[168:171]
ds_read_b64_tr_b16 v[120:121], v15 offset:0
v_mfma_f32_16x16x32_bf16 v[140:143], v[52:55], v[36:39], v[140:143]
ds_read_b64_tr_b16 v[122:123], v15 offset:4096
v_mfma_f32_16x16x32_bf16 v[136:139], v[48:51], v[36:39], v[136:139]
ds_read_b64_tr_b16 v[124:125], v16 offset:0
v_mfma_f32_16x16x32_bf16 v[144:147], v[48:51], v[40:43], v[144:147]
ds_read_b64_tr_b16 v[126:127], v16 offset:4096
v_mfma_f32_16x16x32_bf16 v[148:151], v[52:55], v[40:43], v[148:151]
ds_read_b128 v[100:103], v6 offset:50176
v_mfma_f32_16x16x32_bf16 v[176:179], v[56:59], v[40:43], v[176:179]
ds_read_b128 v[104:107], v6 offset:51200
v_mfma_f32_16x16x32_bf16 v[180:183], v[60:63], v[40:43], v[180:183]
ds_read_b128 v[108:111], v6 offset:52224
v_mfma_f32_16x16x32_bf16 v[188:191], v[60:63], v[44:47], v[188:191]
ds_read_b128 v[192:195], v6 offset:57344
v_mfma_f32_16x16x32_bf16 v[184:187], v[56:59], v[44:47], v[184:187]
ds_read_b64_tr_b16 v[208:209], v13 offset:8192
v_mfma_f32_16x16x32_bf16 v[156:159], v[52:55], v[44:47], v[156:159]
ds_read_b64_tr_b16 v[210:211], v13 offset:12288
v_mfma_f32_16x16x32_bf16 v[152:155], v[48:51], v[44:47], v[152:155]
ds_read_b64_tr_b16 v[212:213], v14 offset:8192
v_mfma_f32_16x16x32_bf16 v[128:131], v[80:83], v[64:67], v[128:131]
ds_read_b64_tr_b16 v[214:215], v14 offset:12288
v_mfma_f32_16x16x32_bf16 v[132:135], v[84:87], v[64:67], v[132:135]
ds_read_b64_tr_b16 v[216:217], v15 offset:8192
v_mfma_f32_16x16x32_bf16 v[160:163], v[88:91], v[64:67], v[160:163]
ds_read_b64_tr_b16 v[218:219], v15 offset:12288
v_mfma_f32_16x16x32_bf16 v[164:167], v[92:95], v[64:67], v[164:167]
ds_read_b64_tr_b16 v[220:221], v16 offset:8192
v_mfma_f32_16x16x32_bf16 v[172:175], v[92:95], v[68:71], v[172:175]
ds_read_b64_tr_b16 v[222:223], v16 offset:12288
v_mfma_f32_16x16x32_bf16 v[168:171], v[88:91], v[68:71], v[168:171]
ds_read_b128 v[196:199], v6 offset:58368
v_mfma_f32_16x16x32_bf16 v[140:143], v[84:87], v[68:71], v[140:143]
ds_read_b128 v[200:203], v6 offset:59392
v_mfma_f32_16x16x32_bf16 v[136:139], v[80:83], v[68:71], v[136:139]
ds_read_b128 v[204:207], v6 offset:60416
v_mfma_f32_16x16x32_bf16 v[144:147], v[80:83], v[72:75], v[144:147]
v_mfma_f32_16x16x32_bf16 v[148:151], v[84:87], v[72:75], v[148:151]
v_mfma_f32_16x16x32_bf16 v[176:179], v[88:91], v[72:75], v[176:179]
v_mfma_f32_16x16x32_bf16 v[180:183], v[92:95], v[72:75], v[180:183]
v_mfma_f32_16x16x32_bf16 v[188:191], v[92:95], v[76:79], v[188:191]
v_mfma_f32_16x16x32_bf16 v[184:187], v[88:91], v[76:79], v[184:187]
v_mfma_f32_16x16x32_bf16 v[156:159], v[84:87], v[76:79], v[156:159]
v_mfma_f32_16x16x32_bf16 v[152:155], v[80:83], v[76:79], v[152:155]
s_waitcnt lgkmcnt(0)
s_barrier
v_mfma_f32_16x16x32_bf16 v[128:131], v[112:115], v[96:99], v[128:131]
ds_read_b128 v[32:35], v7 offset:16384
v_mfma_f32_16x16x32_bf16 v[132:135], v[116:119], v[96:99], v[132:135]
ds_read_b64_tr_b16 v[48:49], v25 offset:16384
v_mfma_f32_16x16x32_bf16 v[160:163], v[120:123], v[96:99], v[160:163]
ds_read_b64_tr_b16 v[50:51], v25 offset:20480
v_mfma_f32_16x16x32_bf16 v[164:167], v[124:127], v[96:99], v[164:167]
ds_read_b64_tr_b16 v[52:53], v26 offset:16384
v_mfma_f32_16x16x32_bf16 v[172:175], v[124:127], v[100:103], v[172:175]
ds_read_b64_tr_b16 v[54:55], v26 offset:20480
v_mfma_f32_16x16x32_bf16 v[168:171], v[120:123], v[100:103], v[168:171]
ds_read_b64_tr_b16 v[56:57], v27 offset:16384
v_mfma_f32_16x16x32_bf16 v[140:143], v[116:119], v[100:103], v[140:143]
ds_read_b64_tr_b16 v[58:59], v27 offset:20480
v_mfma_f32_16x16x32_bf16 v[136:139], v[112:115], v[100:103], v[136:139]
ds_read_b64_tr_b16 v[60:61], v28 offset:16384
v_mfma_f32_16x16x32_bf16 v[144:147], v[112:115], v[104:107], v[144:147]
ds_read_b64_tr_b16 v[62:63], v28 offset:20480
v_mfma_f32_16x16x32_bf16 v[148:151], v[116:119], v[104:107], v[148:151]
ds_read_b128 v[36:39], v7 offset:17408
v_mfma_f32_16x16x32_bf16 v[176:179], v[120:123], v[104:107], v[176:179]
ds_read_b128 v[40:43], v7 offset:18432
v_mfma_f32_16x16x32_bf16 v[180:183], v[124:127], v[104:107], v[180:183]
ds_read_b128 v[44:47], v7 offset:19456
v_mfma_f32_16x16x32_bf16 v[188:191], v[124:127], v[108:111], v[188:191]
ds_read_b128 v[64:67], v7 offset:24576
v_mfma_f32_16x16x32_bf16 v[184:187], v[120:123], v[108:111], v[184:187]
ds_read_b64_tr_b16 v[80:81], v25 offset:24576
v_mfma_f32_16x16x32_bf16 v[156:159], v[116:119], v[108:111], v[156:159]
ds_read_b64_tr_b16 v[82:83], v25 offset:28672
v_mfma_f32_16x16x32_bf16 v[152:155], v[112:115], v[108:111], v[152:155]
ds_read_b64_tr_b16 v[84:85], v26 offset:24576
v_mfma_f32_16x16x32_bf16 v[128:131], v[208:211], v[192:195], v[128:131]
ds_read_b64_tr_b16 v[86:87], v26 offset:28672
v_mfma_f32_16x16x32_bf16 v[132:135], v[212:215], v[192:195], v[132:135]
ds_read_b64_tr_b16 v[88:89], v27 offset:24576
v_mfma_f32_16x16x32_bf16 v[160:163], v[216:219], v[192:195], v[160:163]
ds_read_b64_tr_b16 v[90:91], v27 offset:28672
v_mfma_f32_16x16x32_bf16 v[164:167], v[220:223], v[192:195], v[164:167]
ds_read_b64_tr_b16 v[92:93], v28 offset:24576
v_mfma_f32_16x16x32_bf16 v[172:175], v[220:223], v[196:199], v[172:175]
ds_read_b64_tr_b16 v[94:95], v28 offset:28672
v_mfma_f32_16x16x32_bf16 v[168:171], v[216:219], v[196:199], v[168:171]
ds_read_b128 v[68:71], v7 offset:25600
v_mfma_f32_16x16x32_bf16 v[140:143], v[212:215], v[196:199], v[140:143]
ds_read_b128 v[72:75], v7 offset:26624
v_mfma_f32_16x16x32_bf16 v[136:139], v[208:211], v[196:199], v[136:139]
ds_read_b128 v[76:79], v7 offset:27648
v_mfma_f32_16x16x32_bf16 v[144:147], v[208:211], v[200:203], v[144:147]
v_mfma_f32_16x16x32_bf16 v[148:151], v[212:215], v[200:203], v[148:151]
v_mfma_f32_16x16x32_bf16 v[176:179], v[216:219], v[200:203], v[176:179]
v_mfma_f32_16x16x32_bf16 v[180:183], v[220:223], v[200:203], v[180:183]
v_mfma_f32_16x16x32_bf16 v[188:191], v[220:223], v[204:207], v[188:191]
v_mfma_f32_16x16x32_bf16 v[184:187], v[216:219], v[204:207], v[184:187]
v_mfma_f32_16x16x32_bf16 v[156:159], v[212:215], v[204:207], v[156:159]
v_mfma_f32_16x16x32_bf16 v[152:155], v[208:211], v[204:207], v[152:155]
s_waitcnt lgkmcnt(0)
s_barrier
v_mfma_f32_16x16x32_bf16 v[128:131], v[48:51], v[32:35], v[128:131]
ds_read_b128 v[96:99], v7 offset:32768
v_mfma_f32_16x16x32_bf16 v[132:135], v[52:55], v[32:35], v[132:135]
ds_read_b64_tr_b16 v[112:113], v13 offset:49152
v_mfma_f32_16x16x32_bf16 v[160:163], v[56:59], v[32:35], v[160:163]
ds_read_b64_tr_b16 v[114:115], v13 offset:53248
v_mfma_f32_16x16x32_bf16 v[164:167], v[60:63], v[32:35], v[164:167]
ds_read_b64_tr_b16 v[116:117], v14 offset:49152
v_mfma_f32_16x16x32_bf16 v[172:175], v[60:63], v[36:39], v[172:175]
ds_read_b64_tr_b16 v[118:119], v14 offset:53248
v_mfma_f32_16x16x32_bf16 v[168:171], v[56:59], v[36:39], v[168:171]
ds_read_b64_tr_b16 v[120:121], v15 offset:49152
v_mfma_f32_16x16x32_bf16 v[140:143], v[52:55], v[36:39], v[140:143]
ds_read_b64_tr_b16 v[122:123], v15 offset:53248
v_mfma_f32_16x16x32_bf16 v[136:139], v[48:51], v[36:39], v[136:139]
ds_read_b64_tr_b16 v[124:125], v16 offset:49152
v_mfma_f32_16x16x32_bf16 v[144:147], v[48:51], v[40:43], v[144:147]
ds_read_b64_tr_b16 v[126:127], v16 offset:53248
v_mfma_f32_16x16x32_bf16 v[148:151], v[52:55], v[40:43], v[148:151]
ds_read_b128 v[100:103], v7 offset:33792
v_mfma_f32_16x16x32_bf16 v[176:179], v[56:59], v[40:43], v[176:179]
ds_read_b128 v[104:107], v7 offset:34816
v_mfma_f32_16x16x32_bf16 v[180:183], v[60:63], v[40:43], v[180:183]
ds_read_b128 v[108:111], v7 offset:35840
v_mfma_f32_16x16x32_bf16 v[188:191], v[60:63], v[44:47], v[188:191]
ds_read_b128 v[192:195], v7 offset:40960
v_mfma_f32_16x16x32_bf16 v[184:187], v[56:59], v[44:47], v[184:187]
ds_read_b64_tr_b16 v[208:209], v13 offset:57344
v_mfma_f32_16x16x32_bf16 v[156:159], v[52:55], v[44:47], v[156:159]
ds_read_b64_tr_b16 v[210:211], v13 offset:61440
v_mfma_f32_16x16x32_bf16 v[152:155], v[48:51], v[44:47], v[152:155]
ds_read_b64_tr_b16 v[212:213], v14 offset:57344
v_mfma_f32_16x16x32_bf16 v[128:131], v[80:83], v[64:67], v[128:131]
ds_read_b64_tr_b16 v[214:215], v14 offset:61440
v_mfma_f32_16x16x32_bf16 v[132:135], v[84:87], v[64:67], v[132:135]
ds_read_b64_tr_b16 v[216:217], v15 offset:57344
v_mfma_f32_16x16x32_bf16 v[160:163], v[88:91], v[64:67], v[160:163]
ds_read_b64_tr_b16 v[218:219], v15 offset:61440
v_mfma_f32_16x16x32_bf16 v[164:167], v[92:95], v[64:67], v[164:167]
ds_read_b64_tr_b16 v[220:221], v16 offset:57344
v_mfma_f32_16x16x32_bf16 v[172:175], v[92:95], v[68:71], v[172:175]
ds_read_b64_tr_b16 v[222:223], v16 offset:61440
v_mfma_f32_16x16x32_bf16 v[168:171], v[88:91], v[68:71], v[168:171]
ds_read_b128 v[196:199], v7 offset:41984
v_mfma_f32_16x16x32_bf16 v[140:143], v[84:87], v[68:71], v[140:143]
ds_read_b128 v[200:203], v7 offset:43008
v_mfma_f32_16x16x32_bf16 v[136:139], v[80:83], v[68:71], v[136:139]
ds_read_b128 v[204:207], v7 offset:44032
v_mfma_f32_16x16x32_bf16 v[144:147], v[80:83], v[72:75], v[144:147]
v_mfma_f32_16x16x32_bf16 v[148:151], v[84:87], v[72:75], v[148:151]
v_mfma_f32_16x16x32_bf16 v[176:179], v[88:91], v[72:75], v[176:179]
v_mfma_f32_16x16x32_bf16 v[180:183], v[92:95], v[72:75], v[180:183]
v_mfma_f32_16x16x32_bf16 v[188:191], v[92:95], v[76:79], v[188:191]
v_mfma_f32_16x16x32_bf16 v[184:187], v[88:91], v[76:79], v[184:187]
v_mfma_f32_16x16x32_bf16 v[156:159], v[84:87], v[76:79], v[156:159]
v_mfma_f32_16x16x32_bf16 v[152:155], v[80:83], v[76:79], v[152:155]
s_waitcnt lgkmcnt(0)
s_barrier
v_mfma_f32_16x16x32_bf16 v[128:131], v[112:115], v[96:99], v[128:131]
ds_read_b128 v[32:35], v8 offset:0
v_mfma_f32_16x16x32_bf16 v[132:135], v[116:119], v[96:99], v[132:135]
ds_read_b64_tr_b16 v[48:49], v9 offset:0
v_mfma_f32_16x16x32_bf16 v[160:163], v[120:123], v[96:99], v[160:163]
ds_read_b64_tr_b16 v[50:51], v9 offset:4096
v_mfma_f32_16x16x32_bf16 v[164:167], v[124:127], v[96:99], v[164:167]
ds_read_b64_tr_b16 v[52:53], v10 offset:0
v_mfma_f32_16x16x32_bf16 v[172:175], v[124:127], v[100:103], v[172:175]
ds_read_b64_tr_b16 v[54:55], v10 offset:4096
v_mfma_f32_16x16x32_bf16 v[168:171], v[120:123], v[100:103], v[168:171]
ds_read_b64_tr_b16 v[56:57], v11 offset:0
v_mfma_f32_16x16x32_bf16 v[140:143], v[116:119], v[100:103], v[140:143]
ds_read_b64_tr_b16 v[58:59], v11 offset:4096
v_mfma_f32_16x16x32_bf16 v[136:139], v[112:115], v[100:103], v[136:139]
ds_read_b64_tr_b16 v[60:61], v12 offset:0
v_mfma_f32_16x16x32_bf16 v[144:147], v[112:115], v[104:107], v[144:147]
ds_read_b64_tr_b16 v[62:63], v12 offset:4096
v_mfma_f32_16x16x32_bf16 v[148:151], v[116:119], v[104:107], v[148:151]
ds_read_b128 v[36:39], v8 offset:1024
v_mfma_f32_16x16x32_bf16 v[176:179], v[120:123], v[104:107], v[176:179]
ds_read_b128 v[40:43], v8 offset:2048
v_mfma_f32_16x16x32_bf16 v[180:183], v[124:127], v[104:107], v[180:183]
ds_read_b128 v[44:47], v8 offset:3072
v_mfma_f32_16x16x32_bf16 v[188:191], v[124:127], v[108:111], v[188:191]
ds_read_b128 v[64:67], v8 offset:8192
v_mfma_f32_16x16x32_bf16 v[184:187], v[120:123], v[108:111], v[184:187]
ds_read_b64_tr_b16 v[80:81], v9 offset:8192
v_mfma_f32_16x16x32_bf16 v[156:159], v[116:119], v[108:111], v[156:159]
ds_read_b64_tr_b16 v[82:83], v9 offset:12288
v_mfma_f32_16x16x32_bf16 v[152:155], v[112:115], v[108:111], v[152:155]
ds_read_b64_tr_b16 v[84:85], v10 offset:8192
v_mfma_f32_16x16x32_bf16 v[128:131], v[208:211], v[192:195], v[128:131]
ds_read_b64_tr_b16 v[86:87], v10 offset:12288
v_mfma_f32_16x16x32_bf16 v[132:135], v[212:215], v[192:195], v[132:135]
ds_read_b64_tr_b16 v[88:89], v11 offset:8192
v_mfma_f32_16x16x32_bf16 v[160:163], v[216:219], v[192:195], v[160:163]
ds_read_b64_tr_b16 v[90:91], v11 offset:12288
v_mfma_f32_16x16x32_bf16 v[164:167], v[220:223], v[192:195], v[164:167]
ds_read_b64_tr_b16 v[92:93], v12 offset:8192
v_mfma_f32_16x16x32_bf16 v[172:175], v[220:223], v[196:199], v[172:175]
ds_read_b64_tr_b16 v[94:95], v12 offset:12288
v_mfma_f32_16x16x32_bf16 v[168:171], v[216:219], v[196:199], v[168:171]
ds_read_b128 v[68:71], v8 offset:9216
v_mfma_f32_16x16x32_bf16 v[140:143], v[212:215], v[196:199], v[140:143]
ds_read_b128 v[72:75], v8 offset:10240
v_mfma_f32_16x16x32_bf16 v[136:139], v[208:211], v[196:199], v[136:139]
ds_read_b128 v[76:79], v8 offset:11264
v_mfma_f32_16x16x32_bf16 v[144:147], v[208:211], v[200:203], v[144:147]
v_mfma_f32_16x16x32_bf16 v[148:151], v[212:215], v[200:203], v[148:151]
v_mfma_f32_16x16x32_bf16 v[176:179], v[216:219], v[200:203], v[176:179]
v_mfma_f32_16x16x32_bf16 v[180:183], v[220:223], v[200:203], v[180:183]
v_mfma_f32_16x16x32_bf16 v[188:191], v[220:223], v[204:207], v[188:191]
v_mfma_f32_16x16x32_bf16 v[184:187], v[216:219], v[204:207], v[184:187]
v_mfma_f32_16x16x32_bf16 v[156:159], v[212:215], v[204:207], v[156:159]
v_mfma_f32_16x16x32_bf16 v[152:155], v[208:211], v[204:207], v[152:155]
s_waitcnt lgkmcnt(0)
s_barrier
v_mfma_f32_16x16x32_bf16 v[128:131], v[48:51], v[32:35], v[128:131]
ds_read_b128 v[96:99], v6 offset:16384
v_mfma_f32_16x16x32_bf16 v[132:135], v[52:55], v[32:35], v[132:135]
ds_read_b64_tr_b16 v[112:113], v9 offset:32768
v_mfma_f32_16x16x32_bf16 v[160:163], v[56:59], v[32:35], v[160:163]
ds_read_b64_tr_b16 v[114:115], v9 offset:36864
v_mfma_f32_16x16x32_bf16 v[164:167], v[60:63], v[32:35], v[164:167]
ds_read_b64_tr_b16 v[116:117], v10 offset:32768
v_mfma_f32_16x16x32_bf16 v[172:175], v[60:63], v[36:39], v[172:175]
ds_read_b64_tr_b16 v[118:119], v10 offset:36864
v_mfma_f32_16x16x32_bf16 v[168:171], v[56:59], v[36:39], v[168:171]
ds_read_b64_tr_b16 v[120:121], v11 offset:32768
v_mfma_f32_16x16x32_bf16 v[140:143], v[52:55], v[36:39], v[140:143]
ds_read_b64_tr_b16 v[122:123], v11 offset:36864
v_mfma_f32_16x16x32_bf16 v[136:139], v[48:51], v[36:39], v[136:139]
ds_read_b64_tr_b16 v[124:125], v12 offset:32768
v_mfma_f32_16x16x32_bf16 v[144:147], v[48:51], v[40:43], v[144:147]
ds_read_b64_tr_b16 v[126:127], v12 offset:36864
v_mfma_f32_16x16x32_bf16 v[148:151], v[52:55], v[40:43], v[148:151]
ds_read_b128 v[100:103], v6 offset:17408
v_mfma_f32_16x16x32_bf16 v[176:179], v[56:59], v[40:43], v[176:179]
ds_read_b128 v[104:107], v6 offset:18432
v_mfma_f32_16x16x32_bf16 v[180:183], v[60:63], v[40:43], v[180:183]
ds_read_b128 v[108:111], v6 offset:19456
v_mfma_f32_16x16x32_bf16 v[188:191], v[60:63], v[44:47], v[188:191]
ds_read_b128 v[192:195], v6 offset:24576
v_mfma_f32_16x16x32_bf16 v[184:187], v[56:59], v[44:47], v[184:187]
ds_read_b64_tr_b16 v[208:209], v9 offset:40960
v_mfma_f32_16x16x32_bf16 v[156:159], v[52:55], v[44:47], v[156:159]
ds_read_b64_tr_b16 v[210:211], v9 offset:45056
v_mfma_f32_16x16x32_bf16 v[152:155], v[48:51], v[44:47], v[152:155]
ds_read_b64_tr_b16 v[212:213], v10 offset:40960
v_mfma_f32_16x16x32_bf16 v[128:131], v[80:83], v[64:67], v[128:131]
ds_read_b64_tr_b16 v[214:215], v10 offset:45056
v_mfma_f32_16x16x32_bf16 v[132:135], v[84:87], v[64:67], v[132:135]
ds_read_b64_tr_b16 v[216:217], v11 offset:40960
v_mfma_f32_16x16x32_bf16 v[160:163], v[88:91], v[64:67], v[160:163]
ds_read_b64_tr_b16 v[218:219], v11 offset:45056
v_mfma_f32_16x16x32_bf16 v[164:167], v[92:95], v[64:67], v[164:167]
ds_read_b64_tr_b16 v[220:221], v12 offset:40960
v_mfma_f32_16x16x32_bf16 v[172:175], v[92:95], v[68:71], v[172:175]
ds_read_b64_tr_b16 v[222:223], v12 offset:45056
v_mfma_f32_16x16x32_bf16 v[168:171], v[88:91], v[68:71], v[168:171]
ds_read_b128 v[196:199], v6 offset:25600
v_mfma_f32_16x16x32_bf16 v[140:143], v[84:87], v[68:71], v[140:143]
ds_read_b128 v[200:203], v6 offset:26624
v_mfma_f32_16x16x32_bf16 v[136:139], v[80:83], v[68:71], v[136:139]
ds_read_b128 v[204:207], v6 offset:27648
v_mfma_f32_16x16x32_bf16 v[144:147], v[80:83], v[72:75], v[144:147]
v_mfma_f32_16x16x32_bf16 v[148:151], v[84:87], v[72:75], v[148:151]
v_mfma_f32_16x16x32_bf16 v[176:179], v[88:91], v[72:75], v[176:179]
v_mfma_f32_16x16x32_bf16 v[180:183], v[92:95], v[72:75], v[180:183]
v_mfma_f32_16x16x32_bf16 v[188:191], v[92:95], v[76:79], v[188:191]
v_mfma_f32_16x16x32_bf16 v[184:187], v[88:91], v[76:79], v[184:187]
v_mfma_f32_16x16x32_bf16 v[156:159], v[84:87], v[76:79], v[156:159]
v_mfma_f32_16x16x32_bf16 v[152:155], v[80:83], v[76:79], v[152:155]
s_waitcnt lgkmcnt(0)
s_barrier
v_mfma_f32_16x16x32_bf16 v[128:131], v[112:115], v[96:99], v[128:131]
ds_read_b128 v[32:35], v6 offset:49152
v_mfma_f32_16x16x32_bf16 v[132:135], v[116:119], v[96:99], v[132:135]
ds_read_b64_tr_b16 v[48:49], v13 offset:0
v_mfma_f32_16x16x32_bf16 v[160:163], v[120:123], v[96:99], v[160:163]
ds_read_b64_tr_b16 v[50:51], v13 offset:4096
v_mfma_f32_16x16x32_bf16 v[164:167], v[124:127], v[96:99], v[164:167]
ds_read_b64_tr_b16 v[52:53], v14 offset:0
v_mfma_f32_16x16x32_bf16 v[172:175], v[124:127], v[100:103], v[172:175]
ds_read_b64_tr_b16 v[54:55], v14 offset:4096
v_mfma_f32_16x16x32_bf16 v[168:171], v[120:123], v[100:103], v[168:171]
ds_read_b64_tr_b16 v[56:57], v15 offset:0
v_mfma_f32_16x16x32_bf16 v[140:143], v[116:119], v[100:103], v[140:143]
ds_read_b64_tr_b16 v[58:59], v15 offset:4096
v_mfma_f32_16x16x32_bf16 v[136:139], v[112:115], v[100:103], v[136:139]
ds_read_b64_tr_b16 v[60:61], v16 offset:0
v_mfma_f32_16x16x32_bf16 v[144:147], v[112:115], v[104:107], v[144:147]
ds_read_b64_tr_b16 v[62:63], v16 offset:4096
v_mfma_f32_16x16x32_bf16 v[148:151], v[116:119], v[104:107], v[148:151]
ds_read_b128 v[36:39], v6 offset:50176
v_mfma_f32_16x16x32_bf16 v[176:179], v[120:123], v[104:107], v[176:179]
ds_read_b128 v[40:43], v6 offset:51200
v_mfma_f32_16x16x32_bf16 v[180:183], v[124:127], v[104:107], v[180:183]
ds_read_b128 v[44:47], v6 offset:52224
v_mfma_f32_16x16x32_bf16 v[188:191], v[124:127], v[108:111], v[188:191]
ds_read_b128 v[64:67], v6 offset:57344
v_mfma_f32_16x16x32_bf16 v[184:187], v[120:123], v[108:111], v[184:187]
ds_read_b64_tr_b16 v[80:81], v13 offset:8192
v_mfma_f32_16x16x32_bf16 v[156:159], v[116:119], v[108:111], v[156:159]
ds_read_b64_tr_b16 v[82:83], v13 offset:12288
v_mfma_f32_16x16x32_bf16 v[152:155], v[112:115], v[108:111], v[152:155]
ds_read_b64_tr_b16 v[84:85], v14 offset:8192
v_mfma_f32_16x16x32_bf16 v[128:131], v[208:211], v[192:195], v[128:131]
ds_read_b64_tr_b16 v[86:87], v14 offset:12288
v_mfma_f32_16x16x32_bf16 v[132:135], v[212:215], v[192:195], v[132:135]
ds_read_b64_tr_b16 v[88:89], v15 offset:8192
v_mfma_f32_16x16x32_bf16 v[160:163], v[216:219], v[192:195], v[160:163]
ds_read_b64_tr_b16 v[90:91], v15 offset:12288
v_mfma_f32_16x16x32_bf16 v[164:167], v[220:223], v[192:195], v[164:167]
ds_read_b64_tr_b16 v[92:93], v16 offset:8192
v_mfma_f32_16x16x32_bf16 v[172:175], v[220:223], v[196:199], v[172:175]
ds_read_b64_tr_b16 v[94:95], v16 offset:12288
v_mfma_f32_16x16x32_bf16 v[168:171], v[216:219], v[196:199], v[168:171]
ds_read_b128 v[68:71], v6 offset:58368
v_mfma_f32_16x16x32_bf16 v[140:143], v[212:215], v[196:199], v[140:143]
ds_read_b128 v[72:75], v6 offset:59392
v_mfma_f32_16x16x32_bf16 v[136:139], v[208:211], v[196:199], v[136:139]
ds_read_b128 v[76:79], v6 offset:60416
v_mfma_f32_16x16x32_bf16 v[144:147], v[208:211], v[200:203], v[144:147]
v_mfma_f32_16x16x32_bf16 v[148:151], v[212:215], v[200:203], v[148:151]
v_mfma_f32_16x16x32_bf16 v[176:179], v[216:219], v[200:203], v[176:179]
v_mfma_f32_16x16x32_bf16 v[180:183], v[220:223], v[200:203], v[180:183]
v_mfma_f32_16x16x32_bf16 v[188:191], v[220:223], v[204:207], v[188:191]
v_mfma_f32_16x16x32_bf16 v[184:187], v[216:219], v[204:207], v[184:187]
v_mfma_f32_16x16x32_bf16 v[156:159], v[212:215], v[204:207], v[156:159]
v_mfma_f32_16x16x32_bf16 v[152:155], v[208:211], v[204:207], v[152:155]
s_waitcnt lgkmcnt(0)
s_barrier
v_mfma_f32_16x16x32_bf16 v[128:131], v[48:51], v[32:35], v[128:131]
ds_read_b128 v[96:99], v7 offset:16384
v_mfma_f32_16x16x32_bf16 v[132:135], v[52:55], v[32:35], v[132:135]
ds_read_b64_tr_b16 v[112:113], v25 offset:16384
v_mfma_f32_16x16x32_bf16 v[160:163], v[56:59], v[32:35], v[160:163]
ds_read_b64_tr_b16 v[114:115], v25 offset:20480
v_mfma_f32_16x16x32_bf16 v[164:167], v[60:63], v[32:35], v[164:167]
ds_read_b64_tr_b16 v[116:117], v26 offset:16384
v_mfma_f32_16x16x32_bf16 v[172:175], v[60:63], v[36:39], v[172:175]
ds_read_b64_tr_b16 v[118:119], v26 offset:20480
v_mfma_f32_16x16x32_bf16 v[168:171], v[56:59], v[36:39], v[168:171]
ds_read_b64_tr_b16 v[120:121], v27 offset:16384
v_mfma_f32_16x16x32_bf16 v[140:143], v[52:55], v[36:39], v[140:143]
ds_read_b64_tr_b16 v[122:123], v27 offset:20480
v_mfma_f32_16x16x32_bf16 v[136:139], v[48:51], v[36:39], v[136:139]
ds_read_b64_tr_b16 v[124:125], v28 offset:16384
v_mfma_f32_16x16x32_bf16 v[144:147], v[48:51], v[40:43], v[144:147]
ds_read_b64_tr_b16 v[126:127], v28 offset:20480
v_mfma_f32_16x16x32_bf16 v[148:151], v[52:55], v[40:43], v[148:151]
ds_read_b128 v[100:103], v7 offset:17408
v_mfma_f32_16x16x32_bf16 v[176:179], v[56:59], v[40:43], v[176:179]
ds_read_b128 v[104:107], v7 offset:18432
v_mfma_f32_16x16x32_bf16 v[180:183], v[60:63], v[40:43], v[180:183]
ds_read_b128 v[108:111], v7 offset:19456
v_mfma_f32_16x16x32_bf16 v[188:191], v[60:63], v[44:47], v[188:191]
ds_read_b128 v[192:195], v7 offset:24576
v_mfma_f32_16x16x32_bf16 v[184:187], v[56:59], v[44:47], v[184:187]
ds_read_b64_tr_b16 v[208:209], v25 offset:24576
v_mfma_f32_16x16x32_bf16 v[156:159], v[52:55], v[44:47], v[156:159]
ds_read_b64_tr_b16 v[210:211], v25 offset:28672
v_mfma_f32_16x16x32_bf16 v[152:155], v[48:51], v[44:47], v[152:155]
ds_read_b64_tr_b16 v[212:213], v26 offset:24576
v_mfma_f32_16x16x32_bf16 v[128:131], v[80:83], v[64:67], v[128:131]
ds_read_b64_tr_b16 v[214:215], v26 offset:28672
v_mfma_f32_16x16x32_bf16 v[132:135], v[84:87], v[64:67], v[132:135]
ds_read_b64_tr_b16 v[216:217], v27 offset:24576
v_mfma_f32_16x16x32_bf16 v[160:163], v[88:91], v[64:67], v[160:163]
ds_read_b64_tr_b16 v[218:219], v27 offset:28672
v_mfma_f32_16x16x32_bf16 v[164:167], v[92:95], v[64:67], v[164:167]
ds_read_b64_tr_b16 v[220:221], v28 offset:24576
v_mfma_f32_16x16x32_bf16 v[172:175], v[92:95], v[68:71], v[172:175]
ds_read_b64_tr_b16 v[222:223], v28 offset:28672
v_mfma_f32_16x16x32_bf16 v[168:171], v[88:91], v[68:71], v[168:171]
ds_read_b128 v[196:199], v7 offset:25600
v_mfma_f32_16x16x32_bf16 v[140:143], v[84:87], v[68:71], v[140:143]
ds_read_b128 v[200:203], v7 offset:26624
v_mfma_f32_16x16x32_bf16 v[136:139], v[80:83], v[68:71], v[136:139]
ds_read_b128 v[204:207], v7 offset:27648
v_mfma_f32_16x16x32_bf16 v[144:147], v[80:83], v[72:75], v[144:147]
v_mfma_f32_16x16x32_bf16 v[148:151], v[84:87], v[72:75], v[148:151]
v_mfma_f32_16x16x32_bf16 v[176:179], v[88:91], v[72:75], v[176:179]
v_mfma_f32_16x16x32_bf16 v[180:183], v[92:95], v[72:75], v[180:183]
v_mfma_f32_16x16x32_bf16 v[188:191], v[92:95], v[76:79], v[188:191]
v_mfma_f32_16x16x32_bf16 v[184:187], v[88:91], v[76:79], v[184:187]
v_mfma_f32_16x16x32_bf16 v[156:159], v[84:87], v[76:79], v[156:159]
v_mfma_f32_16x16x32_bf16 v[152:155], v[80:83], v[76:79], v[152:155]
s_waitcnt lgkmcnt(0)
s_barrier
v_mfma_f32_16x16x32_bf16 v[128:131], v[112:115], v[96:99], v[128:131]
ds_read_b128 v[32:35], v7 offset:32768
v_mfma_f32_16x16x32_bf16 v[132:135], v[116:119], v[96:99], v[132:135]
ds_read_b64_tr_b16 v[48:49], v13 offset:49152
v_mfma_f32_16x16x32_bf16 v[160:163], v[120:123], v[96:99], v[160:163]
ds_read_b64_tr_b16 v[50:51], v13 offset:53248
v_mfma_f32_16x16x32_bf16 v[164:167], v[124:127], v[96:99], v[164:167]
ds_read_b64_tr_b16 v[52:53], v14 offset:49152
v_mfma_f32_16x16x32_bf16 v[172:175], v[124:127], v[100:103], v[172:175]
ds_read_b64_tr_b16 v[54:55], v14 offset:53248
v_mfma_f32_16x16x32_bf16 v[168:171], v[120:123], v[100:103], v[168:171]
ds_read_b64_tr_b16 v[56:57], v15 offset:49152
v_mfma_f32_16x16x32_bf16 v[140:143], v[116:119], v[100:103], v[140:143]
ds_read_b64_tr_b16 v[58:59], v15 offset:53248
v_mfma_f32_16x16x32_bf16 v[136:139], v[112:115], v[100:103], v[136:139]
ds_read_b64_tr_b16 v[60:61], v16 offset:49152
v_mfma_f32_16x16x32_bf16 v[144:147], v[112:115], v[104:107], v[144:147]
ds_read_b64_tr_b16 v[62:63], v16 offset:53248
v_mfma_f32_16x16x32_bf16 v[148:151], v[116:119], v[104:107], v[148:151]
ds_read_b128 v[36:39], v7 offset:33792
v_mfma_f32_16x16x32_bf16 v[176:179], v[120:123], v[104:107], v[176:179]
ds_read_b128 v[40:43], v7 offset:34816
v_mfma_f32_16x16x32_bf16 v[180:183], v[124:127], v[104:107], v[180:183]
ds_read_b128 v[44:47], v7 offset:35840
v_mfma_f32_16x16x32_bf16 v[188:191], v[124:127], v[108:111], v[188:191]
ds_read_b128 v[64:67], v7 offset:40960
v_mfma_f32_16x16x32_bf16 v[184:187], v[120:123], v[108:111], v[184:187]
s_branch Lov_11
.p2align 12
Lst_11_0:
s_branch Lst_15_0
s_nop 0
Lov_11:
ds_read_b64_tr_b16 v[80:81], v13 offset:57344
v_mfma_f32_16x16x32_bf16 v[156:159], v[116:119], v[108:111], v[156:159]
ds_read_b64_tr_b16 v[82:83], v13 offset:61440
v_mfma_f32_16x16x32_bf16 v[152:155], v[112:115], v[108:111], v[152:155]
ds_read_b64_tr_b16 v[84:85], v14 offset:57344
v_mfma_f32_16x16x32_bf16 v[128:131], v[208:211], v[192:195], v[128:131]
ds_read_b64_tr_b16 v[86:87], v14 offset:61440
v_mfma_f32_16x16x32_bf16 v[132:135], v[212:215], v[192:195], v[132:135]
ds_read_b64_tr_b16 v[88:89], v15 offset:57344
v_mfma_f32_16x16x32_bf16 v[160:163], v[216:219], v[192:195], v[160:163]
ds_read_b64_tr_b16 v[90:91], v15 offset:61440
v_mfma_f32_16x16x32_bf16 v[164:167], v[220:223], v[192:195], v[164:167]
ds_read_b64_tr_b16 v[92:93], v16 offset:57344
v_mfma_f32_16x16x32_bf16 v[172:175], v[220:223], v[196:199], v[172:175]
ds_read_b64_tr_b16 v[94:95], v16 offset:61440
v_mfma_f32_16x16x32_bf16 v[168:171], v[216:219], v[196:199], v[168:171]
ds_read_b128 v[68:71], v7 offset:41984
v_mfma_f32_16x16x32_bf16 v[140:143], v[212:215], v[196:199], v[140:143]
ds_read_b128 v[72:75], v7 offset:43008
v_mfma_f32_16x16x32_bf16 v[136:139], v[208:211], v[196:199], v[136:139]
ds_read_b128 v[76:79], v7 offset:44032
v_mfma_f32_16x16x32_bf16 v[144:147], v[208:211], v[200:203], v[144:147]
v_mfma_f32_16x16x32_bf16 v[148:151], v[212:215], v[200:203], v[148:151]
v_mfma_f32_16x16x32_bf16 v[176:179], v[216:219], v[200:203], v[176:179]
v_mfma_f32_16x16x32_bf16 v[180:183], v[220:223], v[200:203], v[180:183]
v_mfma_f32_16x16x32_bf16 v[188:191], v[220:223], v[204:207], v[188:191]
v_mfma_f32_16x16x32_bf16 v[184:187], v[216:219], v[204:207], v[184:187]
v_mfma_f32_16x16x32_bf16 v[156:159], v[212:215], v[204:207], v[156:159]
v_mfma_f32_16x16x32_bf16 v[152:155], v[208:211], v[204:207], v[152:155]
s_waitcnt lgkmcnt(0)
s_barrier
v_mfma_f32_16x16x32_bf16 v[128:131], v[48:51], v[32:35], v[128:131]
ds_read_b128 v[96:99], v8 offset:0
v_mfma_f32_16x16x32_bf16 v[132:135], v[52:55], v[32:35], v[132:135]
ds_read_b64_tr_b16 v[112:113], v9 offset:0
v_mfma_f32_16x16x32_bf16 v[160:163], v[56:59], v[32:35], v[160:163]
ds_read_b64_tr_b16 v[114:115], v9 offset:4096
v_mfma_f32_16x16x32_bf16 v[164:167], v[60:63], v[32:35], v[164:167]
ds_read_b64_tr_b16 v[116:117], v10 offset:0
v_mfma_f32_16x16x32_bf16 v[172:175], v[60:63], v[36:39], v[172:175]
ds_read_b64_tr_b16 v[118:119], v10 offset:4096
v_mfma_f32_16x16x32_bf16 v[168:171], v[56:59], v[36:39], v[168:171]
ds_read_b64_tr_b16 v[120:121], v11 offset:0
v_mfma_f32_16x16x32_bf16 v[140:143], v[52:55], v[36:39], v[140:143]
ds_read_b64_tr_b16 v[122:123], v11 offset:4096
v_mfma_f32_16x16x32_bf16 v[136:139], v[48:51], v[36:39], v[136:139]
ds_read_b64_tr_b16 v[124:125], v12 offset:0
v_mfma_f32_16x16x32_bf16 v[144:147], v[48:51], v[40:43], v[144:147]
ds_read_b64_tr_b16 v[126:127], v12 offset:4096
v_mfma_f32_16x16x32_bf16 v[148:151], v[52:55], v[40:43], v[148:151]
ds_read_b128 v[100:103], v8 offset:1024
v_mfma_f32_16x16x32_bf16 v[176:179], v[56:59], v[40:43], v[176:179]
ds_read_b128 v[104:107], v8 offset:2048
v_mfma_f32_16x16x32_bf16 v[180:183], v[60:63], v[40:43], v[180:183]
ds_read_b128 v[108:111], v8 offset:3072
v_mfma_f32_16x16x32_bf16 v[188:191], v[60:63], v[44:47], v[188:191]
ds_read_b128 v[192:195], v8 offset:8192
v_mfma_f32_16x16x32_bf16 v[184:187], v[56:59], v[44:47], v[184:187]
ds_read_b64_tr_b16 v[208:209], v9 offset:8192
v_mfma_f32_16x16x32_bf16 v[156:159], v[52:55], v[44:47], v[156:159]
ds_read_b64_tr_b16 v[210:211], v9 offset:12288
v_mfma_f32_16x16x32_bf16 v[152:155], v[48:51], v[44:47], v[152:155]
ds_read_b64_tr_b16 v[212:213], v10 offset:8192
v_mfma_f32_16x16x32_bf16 v[128:131], v[80:83], v[64:67], v[128:131]
ds_read_b64_tr_b16 v[214:215], v10 offset:12288
v_mfma_f32_16x16x32_bf16 v[132:135], v[84:87], v[64:67], v[132:135]
ds_read_b64_tr_b16 v[216:217], v11 offset:8192
v_mfma_f32_16x16x32_bf16 v[160:163], v[88:91], v[64:67], v[160:163]
ds_read_b64_tr_b16 v[218:219], v11 offset:12288
v_mfma_f32_16x16x32_bf16 v[164:167], v[92:95], v[64:67], v[164:167]
ds_read_b64_tr_b16 v[220:221], v12 offset:8192
v_mfma_f32_16x16x32_bf16 v[172:175], v[92:95], v[68:71], v[172:175]
ds_read_b64_tr_b16 v[222:223], v12 offset:12288
v_mfma_f32_16x16x32_bf16 v[168:171], v[88:91], v[68:71], v[168:171]
ds_read_b128 v[196:199], v8 offset:9216
v_mfma_f32_16x16x32_bf16 v[140:143], v[84:87], v[68:71], v[140:143]
ds_read_b128 v[200:203], v8 offset:10240
v_mfma_f32_16x16x32_bf16 v[136:139], v[80:83], v[68:71], v[136:139]
ds_read_b128 v[204:207], v8 offset:11264
v_mfma_f32_16x16x32_bf16 v[144:147], v[80:83], v[72:75], v[144:147]
v_mfma_f32_16x16x32_bf16 v[148:151], v[84:87], v[72:75], v[148:151]
v_mfma_f32_16x16x32_bf16 v[176:179], v[88:91], v[72:75], v[176:179]
v_mfma_f32_16x16x32_bf16 v[180:183], v[92:95], v[72:75], v[180:183]
v_mfma_f32_16x16x32_bf16 v[188:191], v[92:95], v[76:79], v[188:191]
v_mfma_f32_16x16x32_bf16 v[184:187], v[88:91], v[76:79], v[184:187]
v_mfma_f32_16x16x32_bf16 v[156:159], v[84:87], v[76:79], v[156:159]
v_mfma_f32_16x16x32_bf16 v[152:155], v[80:83], v[76:79], v[152:155]
s_sub_u32 s41, s41, 1
s_cmp_lg_u32 s41, 0
s_cbranch_scc1 Lk4_120
s_waitcnt lgkmcnt(0)
s_barrier
v_mfma_f32_16x16x32_bf16 v[128:131], v[112:115], v[96:99], v[128:131]
ds_read_b128 v[32:35], v6 offset:16384
v_mfma_f32_16x16x32_bf16 v[132:135], v[116:119], v[96:99], v[132:135]
ds_read_b64_tr_b16 v[48:49], v224 offset:32768
v_mfma_f32_16x16x32_bf16 v[160:163], v[120:123], v[96:99], v[160:163]
ds_read_b64_tr_b16 v[50:51], v224 offset:34816
v_mfma_f32_16x16x32_bf16 v[164:167], v[124:127], v[96:99], v[164:167]
ds_read_b64_tr_b16 v[52:53], v225 offset:32768
v_mfma_f32_16x16x32_bf16 v[172:175], v[124:127], v[100:103], v[172:175]
ds_read_b64_tr_b16 v[54:55], v225 offset:34816
v_mfma_f32_16x16x32_bf16 v[168:171], v[120:123], v[100:103], v[168:171]
ds_read_b128 v[36:39], v6 offset:17408
v_mfma_f32_16x16x32_bf16 v[140:143], v[116:119], v[100:103], v[140:143]
ds_read_b128 v[40:43], v6 offset:18432
v_mfma_f32_16x16x32_bf16 v[136:139], v[112:115], v[100:103], v[136:139]
ds_read_b128 v[44:47], v6 offset:19456
v_mfma_f32_16x16x32_bf16 v[144:147], v[112:115], v[104:107], v[144:147]
ds_read_b128 v[64:67], v6 offset:24576
v_mfma_f32_16x16x32_bf16 v[148:151], v[116:119], v[104:107], v[148:151]
ds_read_b64_tr_b16 v[80:81], v224 offset:36864
v_mfma_f32_16x16x32_bf16 v[176:179], v[120:123], v[104:107], v[176:179]
ds_read_b64_tr_b16 v[82:83], v224 offset:38912
v_mfma_f32_16x16x32_bf16 v[180:183], v[124:127], v[104:107], v[180:183]
ds_read_b64_tr_b16 v[84:85], v225 offset:36864
v_mfma_f32_16x16x32_bf16 v[188:191], v[124:127], v[108:111], v[188:191]
ds_read_b64_tr_b16 v[86:87], v225 offset:38912
v_mfma_f32_16x16x32_bf16 v[184:187], v[120:123], v[108:111], v[184:187]
ds_read_b128 v[68:71], v6 offset:25600
v_mfma_f32_16x16x32_bf16 v[156:159], v[116:119], v[108:111], v[156:159]
ds_read_b128 v[72:75], v6 offset:26624
v_mfma_f32_16x16x32_bf16 v[152:155], v[112:115], v[108:111], v[152:155]
ds_read_b128 v[76:79], v6 offset:27648
v_mfma_f32_16x16x32_bf16 v[128:131], v[208:211], v[192:195], v[128:131]
v_mfma_f32_16x16x32_bf16 v[132:135], v[212:215], v[192:195], v[132:135]
v_mfma_f32_16x16x32_bf16 v[160:163], v[216:219], v[192:195], v[160:163]
v_mfma_f32_16x16x32_bf16 v[164:167], v[220:223], v[192:195], v[164:167]
v_mfma_f32_16x16x32_bf16 v[172:175], v[220:223], v[196:199], v[172:175]
v_mfma_f32_16x16x32_bf16 v[168:171], v[216:219], v[196:199], v[168:171]
v_mfma_f32_16x16x32_bf16 v[140:143], v[212:215], v[196:199], v[140:143]
v_mfma_f32_16x16x32_bf16 v[136:139], v[208:211], v[196:199], v[136:139]
v_mfma_f32_16x16x32_bf16 v[144:147], v[208:211], v[200:203], v[144:147]
v_mfma_f32_16x16x32_bf16 v[148:151], v[212:215], v[200:203], v[148:151]
v_mfma_f32_16x16x32_bf16 v[176:179], v[216:219], v[200:203], v[176:179]
v_mfma_f32_16x16x32_bf16 v[180:183], v[220:223], v[200:203], v[180:183]
v_mfma_f32_16x16x32_bf16 v[188:191], v[220:223], v[204:207], v[188:191]
v_mfma_f32_16x16x32_bf16 v[184:187], v[216:219], v[204:207], v[184:187]
v_mfma_f32_16x16x32_bf16 v[156:159], v[212:215], v[204:207], v[156:159]
v_mfma_f32_16x16x32_bf16 v[152:155], v[208:211], v[204:207], v[152:155]
s_waitcnt lgkmcnt(0)
s_barrier
v_mfma_f32_16x16x32_bf16 v[128:131], v[48:51], v[32:35], v[128:131]
ds_read_b128 v[96:99], v6 offset:49152
ds_read_b64_tr_b16 v[112:113], v226 offset:0
v_mfma_f32_16x16x32_bf16 v[132:135], v[52:55], v[32:35], v[132:135]
ds_read_b64_tr_b16 v[114:115], v226 offset:2048
ds_read_b64_tr_b16 v[116:117], v227 offset:0
v_mfma_f32_16x16x32_bf16 v[140:143], v[52:55], v[36:39], v[140:143]
ds_read_b64_tr_b16 v[118:119], v227 offset:2048
ds_read_b128 v[100:103], v6 offset:50176
v_mfma_f32_16x16x32_bf16 v[136:139], v[48:51], v[36:39], v[136:139]
ds_read_b128 v[104:107], v6 offset:51200
ds_read_b128 v[108:111], v6 offset:52224
v_mfma_f32_16x16x32_bf16 v[144:147], v[48:51], v[40:43], v[144:147]
ds_read_b128 v[192:195], v6 offset:57344
v_mfma_f32_16x16x32_bf16 v[148:151], v[52:55], v[40:43], v[148:151]
ds_read_b64_tr_b16 v[208:209], v226 offset:4096
v_mfma_f32_16x16x32_bf16 v[156:159], v[52:55], v[44:47], v[156:159]
ds_read_b64_tr_b16 v[210:211], v226 offset:6144
v_cvt_pk_bf16_f32 v160, v160, v161
v_cvt_pk_bf16_f32 v161, v162, v163
v_mfma_f32_16x16x32_bf16 v[152:155], v[48:51], v[44:47], v[152:155]
ds_read_b64_tr_b16 v[212:213], v227 offset:4096
v_cvt_pk_bf16_f32 v162, v164, v165
v_cvt_pk_bf16_f32 v163, v166, v167
v_mfma_f32_16x16x32_bf16 v[128:131], v[80:83], v[64:67], v[128:131]
ds_read_b64_tr_b16 v[214:215], v227 offset:6144
v_cvt_pk_bf16_f32 v164, v168, v169
v_cvt_pk_bf16_f32 v165, v170, v171
v_mfma_f32_16x16x32_bf16 v[132:135], v[84:87], v[64:67], v[132:135]
ds_read_b128 v[196:199], v6 offset:58368
v_cvt_pk_bf16_f32 v166, v172, v173
v_cvt_pk_bf16_f32 v167, v174, v175
v_mfma_f32_16x16x32_bf16 v[140:143], v[84:87], v[68:71], v[140:143]
ds_read_b128 v[200:203], v6 offset:59392
v_cvt_pk_bf16_f32 v168, v176, v177
v_cvt_pk_bf16_f32 v169, v178, v179
v_mfma_f32_16x16x32_bf16 v[136:139], v[80:83], v[68:71], v[136:139]
ds_read_b128 v[204:207], v6 offset:60416
v_cvt_pk_bf16_f32 v170, v180, v181
v_cvt_pk_bf16_f32 v171, v182, v183
v_mfma_f32_16x16x32_bf16 v[144:147], v[80:83], v[72:75], v[144:147]
v_cvt_pk_bf16_f32 v172, v184, v185
v_cvt_pk_bf16_f32 v173, v186, v187
v_mfma_f32_16x16x32_bf16 v[148:151], v[84:87], v[72:75], v[148:151]
v_cvt_pk_bf16_f32 v174, v188, v189
v_cvt_pk_bf16_f32 v175, v190, v191
v_mfma_f32_16x16x32_bf16 v[156:159], v[84:87], v[76:79], v[156:159]
v_mfma_f32_16x16x32_bf16 v[152:155], v[80:83], v[76:79], v[152:155]
buffer_store_dwordx4 v[160:163], v2, s[84:87], s45 offen offset:0 sc1
s_waitcnt lgkmcnt(0)
s_barrier
v_mfma_f32_16x16x32_bf16 v[128:131], v[112:115], v[96:99], v[128:131]
ds_read_b128 v[32:35], v7 offset:16384
ds_read_b64_tr_b16 v[48:49], v228 offset:16384
v_mfma_f32_16x16x32_bf16 v[132:135], v[116:119], v[96:99], v[132:135]
ds_read_b64_tr_b16 v[50:51], v228 offset:18432
ds_read_b64_tr_b16 v[52:53], v229 offset:16384
v_mfma_f32_16x16x32_bf16 v[140:143], v[116:119], v[100:103], v[140:143]
ds_read_b64_tr_b16 v[54:55], v229 offset:18432
ds_read_b128 v[36:39], v7 offset:17408
v_mfma_f32_16x16x32_bf16 v[136:139], v[112:115], v[100:103], v[136:139]
ds_read_b128 v[40:43], v7 offset:18432
ds_read_b128 v[44:47], v7 offset:19456
v_mfma_f32_16x16x32_bf16 v[144:147], v[112:115], v[104:107], v[144:147]
ds_read_b128 v[64:67], v7 offset:24576
v_mfma_f32_16x16x32_bf16 v[148:151], v[116:119], v[104:107], v[148:151]
ds_read_b64_tr_b16 v[80:81], v228 offset:20480
v_mfma_f32_16x16x32_bf16 v[156:159], v[116:119], v[108:111], v[156:159]
ds_read_b64_tr_b16 v[82:83], v228 offset:22528
v_mfma_f32_16x16x32_bf16 v[152:155], v[112:115], v[108:111], v[152:155]
ds_read_b64_tr_b16 v[84:85], v229 offset:20480
v_mfma_f32_16x16x32_bf16 v[128:131], v[208:211], v[192:195], v[128:131]
ds_read_b64_tr_b16 v[86:87], v229 offset:22528
buffer_store_dwordx4 v[164:167], v2, s[84:87], s45 offen offset:1024 sc1
v_mfma_f32_16x16x32_bf16 v[132:135], v[212:215], v[192:195], v[132:135]
ds_read_b128 v[68:71], v7 offset:25600
v_mfma_f32_16x16x32_bf16 v[140:143], v[212:215], v[196:199], v[140:143]
ds_read_b128 v[72:75], v7 offset:26624
v_mfma_f32_16x16x32_bf16 v[136:139], v[208:211], v[196:199], v[136:139]
ds_read_b128 v[76:79], v7 offset:27648
v_mfma_f32_16x16x32_bf16 v[144:147], v[208:211], v[200:203], v[144:147]
v_mfma_f32_16x16x32_bf16 v[148:151], v[212:215], v[200:203], v[148:151]
v_mfma_f32_16x16x32_bf16 v[156:159], v[212:215], v[204:207], v[156:159]
v_mfma_f32_16x16x32_bf16 v[152:155], v[208:211], v[204:207], v[152:155]
s_waitcnt lgkmcnt(0)
s_barrier
v_mfma_f32_16x16x32_bf16 v[128:131], v[48:51], v[32:35], v[128:131]
ds_read_b128 v[96:99], v7 offset:32768
ds_read_b64_tr_b16 v[112:113], v226 offset:49152
v_mfma_f32_16x16x32_bf16 v[132:135], v[52:55], v[32:35], v[132:135]
ds_read_b64_tr_b16 v[114:115], v226 offset:51200
ds_read_b64_tr_b16 v[116:117], v227 offset:49152
v_mfma_f32_16x16x32_bf16 v[140:143], v[52:55], v[36:39], v[140:143]
ds_read_b64_tr_b16 v[118:119], v227 offset:51200
ds_read_b128 v[100:103], v7 offset:33792
v_mfma_f32_16x16x32_bf16 v[136:139], v[48:51], v[36:39], v[136:139]
ds_read_b128 v[104:107], v7 offset:34816
ds_read_b128 v[108:111], v7 offset:35840
v_mfma_f32_16x16x32_bf16 v[144:147], v[48:51], v[40:43], v[144:147]
ds_read_b128 v[192:195], v7 offset:40960
v_mfma_f32_16x16x32_bf16 v[148:151], v[52:55], v[40:43], v[148:151]
ds_read_b64_tr_b16 v[208:209], v226 offset:53248
v_mfma_f32_16x16x32_bf16 v[156:159], v[52:55], v[44:47], v[156:159]
ds_read_b64_tr_b16 v[210:211], v226 offset:55296
v_mfma_f32_16x16x32_bf16 v[152:155], v[48:51], v[44:47], v[152:155]
ds_read_b64_tr_b16 v[212:213], v227 offset:53248
v_mfma_f32_16x16x32_bf16 v[128:131], v[80:83], v[64:67], v[128:131]
ds_read_b64_tr_b16 v[214:215], v227 offset:55296
buffer_store_dwordx4 v[168:171], v2, s[84:87], s45 offen offset:2048 sc1
v_mfma_f32_16x16x32_bf16 v[132:135], v[84:87], v[64:67], v[132:135]
ds_read_b128 v[196:199], v7 offset:41984
v_mfma_f32_16x16x32_bf16 v[140:143], v[84:87], v[68:71], v[140:143]
ds_read_b128 v[200:203], v7 offset:43008
v_mfma_f32_16x16x32_bf16 v[136:139], v[80:83], v[68:71], v[136:139]
ds_read_b128 v[204:207], v7 offset:44032
v_mfma_f32_16x16x32_bf16 v[144:147], v[80:83], v[72:75], v[144:147]
v_mfma_f32_16x16x32_bf16 v[148:151], v[84:87], v[72:75], v[148:151]
v_mfma_f32_16x16x32_bf16 v[156:159], v[84:87], v[76:79], v[156:159]
v_mfma_f32_16x16x32_bf16 v[152:155], v[80:83], v[76:79], v[152:155]
s_waitcnt lgkmcnt(0)
s_barrier
v_mfma_f32_16x16x32_bf16 v[128:131], v[112:115], v[96:99], v[128:131]
ds_read_b128 v[32:35], v8 offset:0
ds_read_b64_tr_b16 v[48:49], v224 offset:0
v_mfma_f32_16x16x32_bf16 v[132:135], v[116:119], v[96:99], v[132:135]
ds_read_b64_tr_b16 v[50:51], v224 offset:2048
ds_read_b64_tr_b16 v[52:53], v225 offset:0
v_mfma_f32_16x16x32_bf16 v[140:143], v[116:119], v[100:103], v[140:143]
ds_read_b64_tr_b16 v[54:55], v225 offset:2048
ds_read_b128 v[36:39], v8 offset:1024
v_mfma_f32_16x16x32_bf16 v[136:139], v[112:115], v[100:103], v[136:139]
ds_read_b128 v[40:43], v8 offset:2048
ds_read_b128 v[44:47], v8 offset:3072
v_mfma_f32_16x16x32_bf16 v[144:147], v[112:115], v[104:107], v[144:147]
ds_read_b128 v[64:67], v8 offset:8192
v_mfma_f32_16x16x32_bf16 v[148:151], v[116:119], v[104:107], v[148:151]
ds_read_b64_tr_b16 v[80:81], v224 offset:4096
v_mfma_f32_16x16x32_bf16 v[156:159], v[116:119], v[108:111], v[156:159]
ds_read_b64_tr_b16 v[82:83], v224 offset:6144
v_mfma_f32_16x16x32_bf16 v[152:155], v[112:115], v[108:111], v[152:155]
ds_read_b64_tr_b16 v[84:85], v225 offset:4096
v_mfma_f32_16x16x32_bf16 v[128:131], v[208:211], v[192:195], v[128:131]
ds_read_b64_tr_b16 v[86:87], v225 offset:6144
buffer_store_dwordx4 v[172:175], v2, s[84:87], s45 offen offset:3072 sc1
v_mfma_f32_16x16x32_bf16 v[132:135], v[212:215], v[192:195], v[132:135]
ds_read_b128 v[68:71], v8 offset:9216
v_mfma_f32_16x16x32_bf16 v[140:143], v[212:215], v[196:199], v[140:143]
ds_read_b128 v[72:75], v8 offset:10240
v_mfma_f32_16x16x32_bf16 v[136:139], v[208:211], v[196:199], v[136:139]
ds_read_b128 v[76:79], v8 offset:11264
v_mfma_f32_16x16x32_bf16 v[144:147], v[208:211], v[200:203], v[144:147]
v_mfma_f32_16x16x32_bf16 v[148:151], v[212:215], v[200:203], v[148:151]
v_mfma_f32_16x16x32_bf16 v[156:159], v[212:215], v[204:207], v[156:159]
v_mfma_f32_16x16x32_bf16 v[152:155], v[208:211], v[204:207], v[152:155]
s_waitcnt lgkmcnt(0)
s_barrier
v_mfma_f32_16x16x32_bf16 v[128:131], v[48:51], v[32:35], v[128:131]
ds_read_b128 v[96:99], v6 offset:16384
ds_read_b64_tr_b16 v[112:113], v224 offset:32768
v_mfma_f32_16x16x32_bf16 v[132:135], v[52:55], v[32:35], v[132:135]
ds_read_b64_tr_b16 v[114:115], v224 offset:34816
ds_read_b64_tr_b16 v[116:117], v225 offset:32768
v_mfma_f32_16x16x32_bf16 v[140:143], v[52:55], v[36:39], v[140:143]
ds_read_b64_tr_b16 v[118:119], v225 offset:34816
ds_read_b128 v[100:103], v6 offset:17408
v_mfma_f32_16x16x32_bf16 v[136:139], v[48:51], v[36:39], v[136:139]
ds_read_b128 v[104:107], v6 offset:18432
ds_read_b128 v[108:111], v6 offset:19456
v_mfma_f32_16x16x32_bf16 v[144:147], v[48:51], v[40:43], v[144:147]
ds_read_b128 v[192:195], v6 offset:24576
v_mfma_f32_16x16x32_bf16 v[148:151], v[52:55], v[40:43], v[148:151]
ds_read_b64_tr_b16 v[208:209], v224 offset:36864
v_mfma_f32_16x16x32_bf16 v[156:159], v[52:55], v[44:47], v[156:159]
ds_read_b64_tr_b16 v[210:211], v224 offset:38912
v_mfma_f32_16x16x32_bf16 v[152:155], v[48:51], v[44:47], v[152:155]
ds_read_b64_tr_b16 v[212:213], v225 offset:36864
v_mfma_f32_16x16x32_bf16 v[128:131], v[80:83], v[64:67], v[128:131]
ds_read_b64_tr_b16 v[214:215], v225 offset:38912
v_mfma_f32_16x16x32_bf16 v[132:135], v[84:87], v[64:67], v[132:135]
ds_read_b128 v[196:199], v6 offset:25600
v_mfma_f32_16x16x32_bf16 v[140:143], v[84:87], v[68:71], v[140:143]
ds_read_b128 v[200:203], v6 offset:26624
v_mfma_f32_16x16x32_bf16 v[136:139], v[80:83], v[68:71], v[136:139]
ds_read_b128 v[204:207], v6 offset:27648
v_mfma_f32_16x16x32_bf16 v[144:147], v[80:83], v[72:75], v[144:147]
v_mfma_f32_16x16x32_bf16 v[148:151], v[84:87], v[72:75], v[148:151]
v_mfma_f32_16x16x32_bf16 v[156:159], v[84:87], v[76:79], v[156:159]
v_mfma_f32_16x16x32_bf16 v[152:155], v[80:83], v[76:79], v[152:155]
s_waitcnt vmcnt(0)
s_waitcnt lgkmcnt(0)
s_barrier
v_mfma_f32_16x16x32_bf16 v[128:131], v[112:115], v[96:99], v[128:131]
ds_read_b128 v[32:35], v6 offset:49152
ds_read_b64_tr_b16 v[48:49], v226 offset:0
v_mfma_f32_16x16x32_bf16 v[132:135], v[116:119], v[96:99], v[132:135]
ds_read_b64_tr_b16 v[50:51], v226 offset:2048
ds_read_b64_tr_b16 v[52:53], v227 offset:0
v_mfma_f32_16x16x32_bf16 v[140:143], v[116:119], v[100:103], v[140:143]
ds_read_b64_tr_b16 v[54:55], v227 offset:2048
ds_read_b128 v[36:39], v6 offset:50176
v_mfma_f32_16x16x32_bf16 v[136:139], v[112:115], v[100:103], v[136:139]
ds_read_b128 v[40:43], v6 offset:51200
ds_read_b128 v[44:47], v6 offset:52224
v_mfma_f32_16x16x32_bf16 v[144:147], v[112:115], v[104:107], v[144:147]
ds_read_b128 v[64:67], v6 offset:57344
v_mfma_f32_16x16x32_bf16 v[148:151], v[116:119], v[104:107], v[148:151]
ds_read_b64_tr_b16 v[80:81], v226 offset:4096
v_mfma_f32_16x16x32_bf16 v[156:159], v[116:119], v[108:111], v[156:159]
ds_read_b64_tr_b16 v[82:83], v226 offset:6144
v_mfma_f32_16x16x32_bf16 v[152:155], v[112:115], v[108:111], v[152:155]
ds_read_b64_tr_b16 v[84:85], v227 offset:4096
v_mfma_f32_16x16x32_bf16 v[128:131], v[208:211], v[192:195], v[128:131]
ds_read_b64_tr_b16 v[86:87], v227 offset:6144
v_mfma_f32_16x16x32_bf16 v[132:135], v[212:215], v[192:195], v[132:135]
ds_read_b128 v[68:71], v6 offset:58368
v_mfma_f32_16x16x32_bf16 v[140:143], v[212:215], v[196:199], v[140:143]
ds_read_b128 v[72:75], v6 offset:59392
v_mfma_f32_16x16x32_bf16 v[136:139], v[208:211], v[196:199], v[136:139]
ds_read_b128 v[76:79], v6 offset:60416
v_mfma_f32_16x16x32_bf16 v[144:147], v[208:211], v[200:203], v[144:147]
v_mfma_f32_16x16x32_bf16 v[148:151], v[212:215], v[200:203], v[148:151]
v_mfma_f32_16x16x32_bf16 v[156:159], v[212:215], v[204:207], v[156:159]
v_mfma_f32_16x16x32_bf16 v[152:155], v[208:211], v[204:207], v[152:155]
s_waitcnt lgkmcnt(0)
s_barrier
v_mfma_f32_16x16x32_bf16 v[128:131], v[48:51], v[32:35], v[128:131]
ds_read_b128 v[96:99], v7 offset:16384
ds_read_b64_tr_b16 v[112:113], v228 offset:16384
v_mfma_f32_16x16x32_bf16 v[132:135], v[52:55], v[32:35], v[132:135]
ds_read_b64_tr_b16 v[114:115], v228 offset:18432
ds_read_b64_tr_b16 v[116:117], v229 offset:16384
v_mfma_f32_16x16x32_bf16 v[140:143], v[52:55], v[36:39], v[140:143]
ds_read_b64_tr_b16 v[118:119], v229 offset:18432
ds_read_b128 v[100:103], v7 offset:17408
v_mfma_f32_16x16x32_bf16 v[136:139], v[48:51], v[36:39], v[136:139]
ds_read_b128 v[104:107], v7 offset:18432
ds_read_b128 v[108:111], v7 offset:19456
v_mfma_f32_16x16x32_bf16 v[144:147], v[48:51], v[40:43], v[144:147]
ds_read_b128 v[192:195], v7 offset:24576
v_mfma_f32_16x16x32_bf16 v[148:151], v[52:55], v[40:43], v[148:151]
ds_read_b64_tr_b16 v[208:209], v228 offset:20480
v_mfma_f32_16x16x32_bf16 v[156:159], v[52:55], v[44:47], v[156:159]
ds_read_b64_tr_b16 v[210:211], v228 offset:22528
v_mfma_f32_16x16x32_bf16 v[152:155], v[48:51], v[44:47], v[152:155]
ds_read_b64_tr_b16 v[212:213], v229 offset:20480
v_mfma_f32_16x16x32_bf16 v[128:131], v[80:83], v[64:67], v[128:131]
ds_read_b64_tr_b16 v[214:215], v229 offset:22528
v_mfma_f32_16x16x32_bf16 v[132:135], v[84:87], v[64:67], v[132:135]
ds_read_b128 v[196:199], v7 offset:25600
v_mfma_f32_16x16x32_bf16 v[140:143], v[84:87], v[68:71], v[140:143]
ds_read_b128 v[200:203], v7 offset:26624
v_mfma_f32_16x16x32_bf16 v[136:139], v[80:83], v[68:71], v[136:139]
ds_read_b128 v[204:207], v7 offset:27648
v_mfma_f32_16x16x32_bf16 v[144:147], v[80:83], v[72:75], v[144:147]
v_mfma_f32_16x16x32_bf16 v[148:151], v[84:87], v[72:75], v[148:151]
v_mfma_f32_16x16x32_bf16 v[156:159], v[84:87], v[76:79], v[156:159]
v_mfma_f32_16x16x32_bf16 v[152:155], v[80:83], v[76:79], v[152:155]
s_waitcnt lgkmcnt(0)
s_barrier
v_mfma_f32_16x16x32_bf16 v[128:131], v[112:115], v[96:99], v[128:131]
ds_read_b128 v[32:35], v7 offset:32768
ds_read_b64_tr_b16 v[48:49], v226 offset:49152
v_mfma_f32_16x16x32_bf16 v[132:135], v[116:119], v[96:99], v[132:135]
ds_read_b64_tr_b16 v[50:51], v226 offset:51200
ds_read_b64_tr_b16 v[52:53], v227 offset:49152
v_mfma_f32_16x16x32_bf16 v[140:143], v[116:119], v[100:103], v[140:143]
ds_read_b64_tr_b16 v[54:55], v227 offset:51200
ds_read_b128 v[36:39], v7 offset:33792
v_mfma_f32_16x16x32_bf16 v[136:139], v[112:115], v[100:103], v[136:139]
ds_read_b128 v[40:43], v7 offset:34816
ds_read_b128 v[44:47], v7 offset:35840
v_mfma_f32_16x16x32_bf16 v[144:147], v[112:115], v[104:107], v[144:147]
ds_read_b128 v[64:67], v7 offset:40960
v_mfma_f32_16x16x32_bf16 v[148:151], v[116:119], v[104:107], v[148:151]
ds_read_b64_tr_b16 v[80:81], v226 offset:53248
v_mfma_f32_16x16x32_bf16 v[156:159], v[116:119], v[108:111], v[156:159]
ds_read_b64_tr_b16 v[82:83], v226 offset:55296
v_mfma_f32_16x16x32_bf16 v[152:155], v[112:115], v[108:111], v[152:155]
ds_read_b64_tr_b16 v[84:85], v227 offset:53248
v_mfma_f32_16x16x32_bf16 v[128:131], v[208:211], v[192:195], v[128:131]
ds_read_b64_tr_b16 v[86:87], v227 offset:55296
v_mfma_f32_16x16x32_bf16 v[132:135], v[212:215], v[192:195], v[132:135]
ds_read_b128 v[68:71], v7 offset:41984
v_mfma_f32_16x16x32_bf16 v[140:143], v[212:215], v[196:199], v[140:143]
ds_read_b128 v[72:75], v7 offset:43008
v_mfma_f32_16x16x32_bf16 v[136:139], v[208:211], v[196:199], v[136:139]
ds_read_b128 v[76:79], v7 offset:44032
v_mfma_f32_16x16x32_bf16 v[144:147], v[208:211], v[200:203], v[144:147]
v_mfma_f32_16x16x32_bf16 v[148:151], v[212:215], v[200:203], v[148:151]
v_mfma_f32_16x16x32_bf16 v[156:159], v[212:215], v[204:207], v[156:159]
v_mfma_f32_16x16x32_bf16 v[152:155], v[208:211], v[204:207], v[152:155]
s_waitcnt lgkmcnt(0)
s_barrier
buffer_load_dwordx4 v[232:235], v2, s[84:87], s46 offen offset:0 sc1
buffer_load_dwordx4 v[236:239], v2, s[84:87], s46 offen offset:1024 sc1
buffer_load_dwordx4 v[240:243], v2, s[84:87], s46 offen offset:2048 sc1
buffer_load_dwordx4 v[244:247], v2, s[84:87], s46 offen offset:3072 sc1
v_mfma_f32_16x16x32_bf16 v[128:131], v[48:51], v[32:35], v[128:131]
ds_read_b128 v[96:99], v8 offset:0
ds_read_b64_tr_b16 v[112:113], v224 offset:0
v_mfma_f32_16x16x32_bf16 v[132:135], v[52:55], v[32:35], v[132:135]
ds_read_b64_tr_b16 v[114:115], v224 offset:2048
ds_read_b64_tr_b16 v[116:117], v225 offset:0
v_mfma_f32_16x16x32_bf16 v[140:143], v[52:55], v[36:39], v[140:143]
ds_read_b64_tr_b16 v[118:119], v225 offset:2048
ds_read_b128 v[100:103], v8 offset:1024
v_mfma_f32_16x16x32_bf16 v[136:139], v[48:51], v[36:39], v[136:139]
ds_read_b128 v[104:107], v8 offset:2048
ds_read_b128 v[108:111], v8 offset:3072
v_mfma_f32_16x16x32_bf16 v[144:147], v[48:51], v[40:43], v[144:147]
ds_read_b128 v[192:195], v8 offset:8192
v_mfma_f32_16x16x32_bf16 v[148:151], v[52:55], v[40:43], v[148:151]
ds_read_b64_tr_b16 v[208:209], v224 offset:4096
v_mfma_f32_16x16x32_bf16 v[156:159], v[52:55], v[44:47], v[156:159]
ds_read_b64_tr_b16 v[210:211], v224 offset:6144
v_mfma_f32_16x16x32_bf16 v[152:155], v[48:51], v[44:47], v[152:155]
ds_read_b64_tr_b16 v[212:213], v225 offset:4096
v_mfma_f32_16x16x32_bf16 v[128:131], v[80:83], v[64:67], v[128:131]
ds_read_b64_tr_b16 v[214:215], v225 offset:6144
v_mfma_f32_16x16x32_bf16 v[132:135], v[84:87], v[64:67], v[132:135]
ds_read_b128 v[196:199], v8 offset:9216
v_mfma_f32_16x16x32_bf16 v[140:143], v[84:87], v[68:71], v[140:143]
ds_read_b128 v[200:203], v8 offset:10240
v_mfma_f32_16x16x32_bf16 v[136:139], v[80:83], v[68:71], v[136:139]
ds_read_b128 v[204:207], v8 offset:11264
v_mfma_f32_16x16x32_bf16 v[144:147], v[80:83], v[72:75], v[144:147]
v_mfma_f32_16x16x32_bf16 v[148:151], v[84:87], v[72:75], v[148:151]
v_mfma_f32_16x16x32_bf16 v[156:159], v[84:87], v[76:79], v[156:159]
v_mfma_f32_16x16x32_bf16 v[152:155], v[80:83], v[76:79], v[152:155]
s_waitcnt lgkmcnt(0)
s_barrier
v_mfma_f32_16x16x32_bf16 v[128:131], v[112:115], v[96:99], v[128:131]
ds_read_b128 v[32:35], v6 offset:16384
ds_read_b64_tr_b16 v[48:49], v224 offset:32768
v_mfma_f32_16x16x32_bf16 v[132:135], v[116:119], v[96:99], v[132:135]
ds_read_b64_tr_b16 v[50:51], v224 offset:34816
ds_read_b64_tr_b16 v[52:53], v225 offset:32768
v_mfma_f32_16x16x32_bf16 v[140:143], v[116:119], v[100:103], v[140:143]
ds_read_b64_tr_b16 v[54:55], v225 offset:34816
ds_read_b128 v[36:39], v6 offset:17408
v_mfma_f32_16x16x32_bf16 v[136:139], v[112:115], v[100:103], v[136:139]
ds_read_b128 v[40:43], v6 offset:18432
ds_read_b128 v[44:47], v6 offset:19456
v_mfma_f32_16x16x32_bf16 v[144:147], v[112:115], v[104:107], v[144:147]
ds_read_b128 v[64:67], v6 offset:24576
v_mfma_f32_16x16x32_bf16 v[148:151], v[116:119], v[104:107], v[148:151]
ds_read_b64_tr_b16 v[80:81], v224 offset:36864
v_mfma_f32_16x16x32_bf16 v[156:159], v[116:119], v[108:111], v[156:159]
ds_read_b64_tr_b16 v[82:83], v224 offset:38912
v_mfma_f32_16x16x32_bf16 v[152:155], v[112:115], v[108:111], v[152:155]
ds_read_b64_tr_b16 v[84:85], v225 offset:36864
v_mfma_f32_16x16x32_bf16 v[128:131], v[208:211], v[192:195], v[128:131]
ds_read_b64_tr_b16 v[86:87], v225 offset:38912
v_mfma_f32_16x16x32_bf16 v[132:135], v[212:215], v[192:195], v[132:135]
ds_read_b128 v[68:71], v6 offset:25600
v_mfma_f32_16x16x32_bf16 v[140:143], v[212:215], v[196:199], v[140:143]
ds_read_b128 v[72:75], v6 offset:26624
v_mfma_f32_16x16x32_bf16 v[136:139], v[208:211], v[196:199], v[136:139]
ds_read_b128 v[76:79], v6 offset:27648
v_mfma_f32_16x16x32_bf16 v[144:147], v[208:211], v[200:203], v[144:147]
v_mfma_f32_16x16x32_bf16 v[148:151], v[212:215], v[200:203], v[148:151]
v_mfma_f32_16x16x32_bf16 v[156:159], v[212:215], v[204:207], v[156:159]
v_mfma_f32_16x16x32_bf16 v[152:155], v[208:211], v[204:207], v[152:155]
s_waitcnt lgkmcnt(0)
s_barrier
v_mfma_f32_16x16x32_bf16 v[128:131], v[48:51], v[32:35], v[128:131]
ds_read_b128 v[96:99], v6 offset:49152
ds_read_b64_tr_b16 v[112:113], v226 offset:0
v_mfma_f32_16x16x32_bf16 v[132:135], v[52:55], v[32:35], v[132:135]
ds_read_b64_tr_b16 v[114:115], v226 offset:2048
ds_read_b64_tr_b16 v[116:117], v227 offset:0
v_mfma_f32_16x16x32_bf16 v[140:143], v[52:55], v[36:39], v[140:143]
ds_read_b64_tr_b16 v[118:119], v227 offset:2048
ds_read_b128 v[100:103], v6 offset:50176
v_mfma_f32_16x16x32_bf16 v[136:139], v[48:51], v[36:39], v[136:139]
ds_read_b128 v[104:107], v6 offset:51200
ds_read_b128 v[108:111], v6 offset:52224
v_mfma_f32_16x16x32_bf16 v[144:147], v[48:51], v[40:43], v[144:147]
ds_read_b128 v[192:195], v6 offset:57344
v_mfma_f32_16x16x32_bf16 v[148:151], v[52:55], v[40:43], v[148:151]
ds_read_b64_tr_b16 v[208:209], v226 offset:4096
v_mfma_f32_16x16x32_bf16 v[156:159], v[52:55], v[44:47], v[156:159]
ds_read_b64_tr_b16 v[210:211], v226 offset:6144
s_branch Lov_12
.p2align 12
Lst_12_0:
s_branch Lst_16_0
s_nop 0
Lov_12:
v_mfma_f32_16x16x32_bf16 v[152:155], v[48:51], v[44:47], v[152:155]
ds_read_b64_tr_b16 v[212:213], v227 offset:4096
v_mfma_f32_16x16x32_bf16 v[128:131], v[80:83], v[64:67], v[128:131]
ds_read_b64_tr_b16 v[214:215], v227 offset:6144
v_mfma_f32_16x16x32_bf16 v[132:135], v[84:87], v[64:67], v[132:135]
ds_read_b128 v[196:199], v6 offset:58368
v_mfma_f32_16x16x32_bf16 v[140:143], v[84:87], v[68:71], v[140:143]
ds_read_b128 v[200:203], v6 offset:59392
v_mfma_f32_16x16x32_bf16 v[136:139], v[80:83], v[68:71], v[136:139]
ds_read_b128 v[204:207], v6 offset:60416
v_mfma_f32_16x16x32_bf16 v[144:147], v[80:83], v[72:75], v[144:147]
v_mfma_f32_16x16x32_bf16 v[148:151], v[84:87], v[72:75], v[148:151]
v_mfma_f32_16x16x32_bf16 v[156:159], v[84:87], v[76:79], v[156:159]
v_mfma_f32_16x16x32_bf16 v[152:155], v[80:83], v[76:79], v[152:155]
s_waitcnt vmcnt(0)
s_waitcnt lgkmcnt(0)
s_barrier
v_mfma_f32_16x16x32_bf16 v[128:131], v[112:115], v[96:99], v[128:131]
v_lshlrev_b32 v160, 16, v232
v_and_b32 v161, 0xffff0000, v232
v_mfma_f32_16x16x32_bf16 v[132:135], v[116:119], v[96:99], v[132:135]
v_lshlrev_b32 v162, 16, v233
v_and_b32 v163, 0xffff0000, v233
v_mfma_f32_16x16x32_bf16 v[140:143], v[116:119], v[100:103], v[140:143]
v_lshlrev_b32 v164, 16, v234
v_and_b32 v165, 0xffff0000, v234
v_mfma_f32_16x16x32_bf16 v[136:139], v[112:115], v[100:103], v[136:139]
v_lshlrev_b32 v166, 16, v235
v_and_b32 v167, 0xffff0000, v235
v_mfma_f32_16x16x32_bf16 v[144:147], v[112:115], v[104:107], v[144:147]
v_lshlrev_b32 v168, 16, v236
v_and_b32 v169, 0xffff0000, v236
v_mfma_f32_16x16x32_bf16 v[148:151], v[116:119], v[104:107], v[148:151]
v_lshlrev_b32 v170, 16, v237
v_and_b32 v171, 0xffff0000, v237
v_mfma_f32_16x16x32_bf16 v[156:159], v[116:119], v[108:111], v[156:159]
v_lshlrev_b32 v172, 16, v238
v_and_b32 v173, 0xffff0000, v238
v_mfma_f32_16x16x32_bf16 v[152:155], v[112:115], v[108:111], v[152:155]
v_lshlrev_b32 v174, 16, v239
v_and_b32 v175, 0xffff0000, v239
v_mfma_f32_16x16x32_bf16 v[128:131], v[208:211], v[192:195], v[128:131]
v_lshlrev_b32 v176, 16, v240
v_and_b32 v177, 0xffff0000, v240
v_mfma_f32_16x16x32_bf16 v[132:135], v[212:215], v[192:195], v[132:135]
v_lshlrev_b32 v178, 16, v241
v_and_b32 v179, 0xffff0000, v241
v_mfma_f32_16x16x32_bf16 v[140:143], v[212:215], v[196:199], v[140:143]
v_lshlrev_b32 v180, 16, v242
v_and_b32 v181, 0xffff0000, v242
v_mfma_f32_16x16x32_bf16 v[136:139], v[208:211], v[196:199], v[136:139]
v_lshlrev_b32 v182, 16, v243
v_and_b32 v183, 0xffff0000, v243
v_mfma_f32_16x16x32_bf16 v[144:147], v[208:211], v[200:203], v[144:147]
v_lshlrev_b32 v184, 16, v244
v_and_b32 v185, 0xffff0000, v244
v_mfma_f32_16x16x32_bf16 v[148:151], v[212:215], v[200:203], v[148:151]
v_lshlrev_b32 v186, 16, v245
v_and_b32 v187, 0xffff0000, v245
v_mfma_f32_16x16x32_bf16 v[156:159], v[212:215], v[204:207], v[156:159]
v_lshlrev_b32 v188, 16, v246
v_and_b32 v189, 0xffff0000, v246
v_mfma_f32_16x16x32_bf16 v[152:155], v[208:211], v[204:207], v[152:155]
v_lshlrev_b32 v190, 16, v247
v_and_b32 v191, 0xffff0000, v247
s_nop 1
v_pk_add_f32 v[128:129], v[128:129], v[160:161]
v_pk_add_f32 v[130:131], v[130:131], v[162:163]
v_pk_add_f32 v[132:133], v[132:133], v[164:165]
v_pk_add_f32 v[134:135], v[134:135], v[166:167]
v_cvt_pk_bf16_f32 v32, v128, v129
v_cvt_pk_bf16_f32 v33, v130, v131
v_cvt_pk_bf16_f32 v34, v132, v133
v_cvt_pk_bf16_f32 v35, v134, v135
v_pk_add_f32 v[136:137], v[136:137], v[168:169]
v_pk_add_f32 v[138:139], v[138:139], v[170:171]
v_pk_add_f32 v[140:141], v[140:141], v[172:173]
v_pk_add_f32 v[142:143], v[142:143], v[174:175]
v_cvt_pk_bf16_f32 v36, v136, v137
v_cvt_pk_bf16_f32 v37, v138, v139
v_cvt_pk_bf16_f32 v38, v140, v141
v_cvt_pk_bf16_f32 v39, v142, v143
v_permlane16_swap_b32 v32, v34
v_permlane16_swap_b32 v33, v35
buffer_store_dwordx4 v[32:35], v230, s[20:23], s54 offen offset:0
v_pk_add_f32 v[144:145], v[144:145], v[176:177]
v_pk_add_f32 v[146:147], v[146:147], v[178:179]
v_pk_add_f32 v[148:149], v[148:149], v[180:181]
v_pk_add_f32 v[150:151], v[150:151], v[182:183]
v_cvt_pk_bf16_f32 v40, v144, v145
v_cvt_pk_bf16_f32 v41, v146, v147
v_cvt_pk_bf16_f32 v42, v148, v149
v_cvt_pk_bf16_f32 v43, v150, v151
v_permlane16_swap_b32 v36, v38
v_permlane16_swap_b32 v37, v39
buffer_store_dwordx4 v[36:39], v230, s[20:23], s54 offen offset:2048
v_pk_add_f32 v[152:153], v[152:153], v[184:185]
v_pk_add_f32 v[154:155], v[154:155], v[186:187]
v_pk_add_f32 v[156:157], v[156:157], v[188:189]
v_pk_add_f32 v[158:159], v[158:159], v[190:191]
v_cvt_pk_bf16_f32 v44, v152, v153
v_cvt_pk_bf16_f32 v45, v154, v155
v_cvt_pk_bf16_f32 v46, v156, v157
v_cvt_pk_bf16_f32 v47, v158, v159
v_permlane16_swap_b32 v40, v42
v_permlane16_swap_b32 v41, v43
buffer_store_dwordx4 v[40:43], v230, s[20:23], s55 offen offset:0
s_nop 1
v_permlane16_swap_b32 v44, v46
v_permlane16_swap_b32 v45, v47
buffer_store_dwordx4 v[44:47], v230, s[20:23], s55 offen offset:2048
s_branch Ldone_1
Lgb_95:
s_add_u32 s37, s35, 0
s_and_b32 s37, s37, 15
s_mul_i32 s37, s37, 16384
s_add_u32 m0, s39, 0
s_nop 0
buffer_load_dwordx4 v3, s[8:11], s37 offen sc1 lds
buffer_load_dwordx4 v3, s[8:11], s37 offen offset:1024 sc1 lds
buffer_load_dwordx4 v3, s[8:11], s37 offen offset:2048 sc1 lds
buffer_load_dwordx4 v3, s[8:11], s37 offen offset:3072 sc1 lds
s_bitcmp0_b32 s36, 1
s_cselect_b32 s44, s72, s74
s_cselect_b32 s45, s73, s75
s_mul_i32 s43, s35, 192
s_add_u32 s16, s44, s43
s_addc_u32 s17, s45, 0
s_add_u32 s16, s16, 4096
s_addc_u32 s17, s17, 0
s_mov_b32 s18, 7333056
s_mov_b32 s19, 0x20000
v_add_u32 v28, 0, v1
v_mul_u32_u24 v29, 5462, v28
v_lshrrev_b32 v29, 16, v29
v_mul_u32_u24 v30, 12, v29
v_sub_u32 v30, v28, v30
v_bfe_u32 v31, v29, 2, 1
v_cmp_gt_u32 vcc, 8, v30
v_lshlrev_b32 v32, 1, v31
v_mul_u32_u24 v29, 7168, v29
v_cndmask_b32 v31, v31, v32, vcc
v_xor_b32 v30, v30, v31
v_lshl_add_u32 v6, v30, 4, v29
v_add_u32 v28, 64, v1
v_mul_u32_u24 v29, 5462, v28
v_lshrrev_b32 v29, 16, v29
v_mul_u32_u24 v30, 12, v29
v_sub_u32 v30, v28, v30
v_bfe_u32 v31, v29, 2, 1
v_cmp_gt_u32 vcc, 8, v30
v_lshlrev_b32 v32, 1, v31
v_mul_u32_u24 v29, 7168, v29
v_cndmask_b32 v31, v31, v32, vcc
v_xor_b32 v30, v30, v31
v_lshl_add_u32 v7, v30, 4, v29
v_add_u32 v28, 128, v1
v_mul_u32_u24 v29, 5462, v28
v_lshrrev_b32 v29, 16, v29
v_mul_u32_u24 v30, 12, v29
v_sub_u32 v30, v28, v30
v_bfe_u32 v31, v29, 2, 1
v_cmp_gt_u32 vcc, 8, v30
v_lshlrev_b32 v32, 1, v31
v_mul_u32_u24 v29, 7168, v29
v_cndmask_b32 v31, v31, v32, vcc
v_xor_b32 v30, v30, v31
v_lshl_add_u32 v8, v30, 4, v29
s_and_b32 s43, s36, 1
s_mul_i32 s43, s43, 229376
v_add_u32 v6, s43, v6
v_add_u32 v7, s43, v7
v_add_u32 v8, s43, v8
s_and_b32 s43, s36, 3
s_mul_i32 s50, s43, 6144
s_add_u32 s50, s50, 16384
s_mul_i32 s43, s34, 16384
s_add_u32 s20, s82, s43
s_addc_u32 s21, s83, 0
s_add_u32 s20, s20, 25165824
s_addc_u32 s21, s21, 0
s_mov_b32 s22, 16384
s_mov_b32 s23, 0x20000
v_bfe_u32 v28, v1, 3, 1
v_lshlrev_b32 v28, 6, v28
v_bfe_u32 v29, v1, 1, 2
s_lshl_b32 s43, s48, 3
s_lshl_b32 s44, s63, 2
s_add_u32 s43, s43, s44
v_add3_u32 v28, v28, v29, s43
v_mul_u32_u24 v28, 7168, v28
v_and_b32 v29, 1, v1
v_mul_u32_u24 v29, 188, v29
v_add_u32 v26, v28, v29
v_bfe_u32 v28, v1, 3, 1
v_lshlrev_b32 v28, 14, v28
v_and_b32 v29, 7, v1
v_lshl_add_u32 v28, v29, 7, v28
s_lshl_b32 s43, s49, 12
s_lshl_b32 s44, s47, 10
s_add_u32 s43, s43, s44
v_add_u32 v23, s43, v28
s_bitcmp0_b32 s2, 0
s_cselect_b32 s88, s72, s74
s_cselect_b32 s89, s73, s75
s_mov_b32 s90, 7340032
s_mov_b32 s91, 0x20000
s_bfe_u32 s44, s2, 0x30001
s_lshl_b32 s44, s44, 2
s_and_b32 s43, s36, 3
s_add_u32 s44, s44, s43
s_lshl_b32 s44, s44, 5
v_lshrrev_b32 v24, 4, v1
v_add_u32 v24, s44, v24
v_mul_u32_u24 v24, 7168, v24
v_and_b32 v25, 15, v1
v_lshl_add_u32 v24, v25, 4, v24
s_lshr_b32 s43, s2, 4
s_lshl_b32 s43, s43, 8
v_add_u32 v24, s43, v24
s_add_u32 s38, s35, 2
s_and_b32 s38, s38, 15
s_mul_i32 s38, s38, 458752
s_add_u32 m0, s50, 98304
s_nop 0
buffer_load_dwordx4 v6, s[16:19], s38 offen lds
s_add_u32 m0, s50, 99328
s_nop 0
buffer_load_dwordx4 v7, s[16:19], s38 offen lds
s_add_u32 m0, s50, 100352
s_nop 0
buffer_load_dwordx4 v8, s[16:19], s38 offen lds
s_add_u32 m0, s50, 101376
s_add_u32 s38, s38, 114688
buffer_load_dwordx4 v6, s[16:19], s38 offen lds
s_add_u32 m0, s50, 102400
s_nop 0
buffer_load_dwordx4 v7, s[16:19], s38 offen lds
s_add_u32 m0, s50, 103424
s_nop 0
buffer_load_dwordx4 v8, s[16:19], s38 offen lds
s_cmp_eq_u32 s47, 0
s_cbranch_scc0 Lw_121
s_lshl_b32 s92, s34, 7
s_add_u32 s92, s92, 28313600
s_mov_b32 s41, 0x40000
Lpoll_122:
s_load_dword s93, s[82:83], s92 glc
Lpchk_124:
s_waitcnt lgkmcnt(0)
s_cmp_eq_u32 s93, 16
s_cbranch_scc1 Lpok_123
s_sub_u32 s41, s41, 1
s_cmp_lg_u32 s41, 0
s_cbranch_scc1 Lpoll_122
Lpok_123:
Lw_121:
s_waitcnt vmcnt(0)
s_barrier
s_add_u32 s37, s35, 1
s_and_b32 s37, s37, 15
s_mul_i32 s37, s37, 16384
s_add_u32 m0, s39, 49152
s_nop 0
buffer_load_dwordx4 v3, s[8:11], s37 offen sc1 lds
buffer_load_dwordx4 v3, s[8:11], s37 offen offset:1024 sc1 lds
buffer_load_dwordx4 v3, s[8:11], s37 offen offset:2048 sc1 lds
buffer_load_dwordx4 v3, s[8:11], s37 offen offset:3072 sc1 lds
s_add_u32 s37, s35, 2
s_and_b32 s37, s37, 15
s_mul_i32 s37, s37, 16384
s_add_u32 m0, s39, 98304
s_nop 0
buffer_load_dwordx4 v3, s[8:11], s37 offen sc1 lds
buffer_load_dwordx4 v3, s[8:11], s37 offen offset:1024 sc1 lds
buffer_load_dwordx4 v3, s[8:11], s37 offen offset:2048 sc1 lds
buffer_load_dwordx4 v3, s[8:11], s37 offen offset:3072 sc1 lds
buffer_load_dwordx4 v[96:99], v3, s[20:23], 0 offen offset:0 sc1
buffer_load_dwordx4 v[100:103], v3, s[20:23], 0 offen offset:1024 sc1
buffer_load_dwordx4 v[104:107], v3, s[20:23], 0 offen offset:2048 sc1
buffer_load_dwordx4 v[108:111], v3, s[20:23], 0 offen offset:3072 sc1
s_and_b32 s44, s36, 3
s_mul_i32 s44, s44, 14
s_bfe_u32 s43, s2, 0x30001
s_lshl_b32 s43, s43, 7
s_add_u32 s44, s44, s43
s_add_u32 s44, s44, 72
s_mul_i32 s44, s44, 7168
s_lshr_b32 s43, s2, 4
s_lshl_b32 s43, s43, 8
s_add_u32 s43, s43, s44
s_bitcmp0_b32 s2, 0
s_cselect_b32 s4, s72, s74
s_cselect_b32 s5, s73, s75
s_add_u32 s4, s4, s43
s_addc_u32 s5, s5, 0
s_waitcnt vmcnt(8)
s_barrier
s_cmp_eq_u32 s47, 3
s_cbranch_scc0 Lw_125
v_and_b32 v30, 31, v1
v_lshlrev_b32 v30, 4, v30
v_add_u32 v31, 151552, v30
ds_read_b128 v[112:115], v31 offset:0
ds_read_b128 v[116:119], v31 offset:512
ds_read_b128 v[120:123], v31 offset:1024
ds_read_b128 v[124:127], v31 offset:1536
s_and_b32 s44, s2, 15
s_mul_i32 s44, s44, 14336
s_lshr_b32 s43, s2, 4
s_lshl_b32 s43, s43, 9
s_add_u32 s44, s44, s43
s_add_u32 s44, s44, 8192
s_cmp_lt_u32 s2, 192
s_cselect_b32 s44, s44, 0x7fffffff
s_waitcnt lgkmcnt(0)
v_add_f32 v112, v112, v116
v_add_f32 v120, v120, v124
v_add_f32 v113, v113, v117
v_add_f32 v121, v121, v125
v_add_f32 v114, v114, v118
v_add_f32 v122, v122, v126
v_add_f32 v115, v115, v119
v_add_f32 v123, v123, v127
v_add_f32 v112, v112, v120
v_add_f32 v113, v113, v121
v_add_f32 v114, v114, v122
v_add_f32 v115, v115, v123
s_mov_b64 exec, 0xffffffff
buffer_store_dwordx4 v[112:115], v30, s[84:87], s44 offen sc1
s_mov_b64 exec, -1
Lw_125:
s_waitcnt lgkmcnt(0)
s_add_u32 s37, s35, 3
s_and_b32 s37, s37, 15
s_mul_i32 s37, s37, 16384
s_add_u32 m0, s39, 0
s_nop 0
buffer_load_dwordx4 v3, s[8:11], s37 offen sc1 lds
buffer_load_dwordx4 v3, s[8:11], s37 offen offset:1024 sc1 lds
s_load_dword s3, s[4:5], 78848
buffer_load_dwordx4 v3, s[8:11], s37 offen offset:2048 sc1 lds
s_load_dword s3, s[4:5], 78912
buffer_load_dwordx4 v3, s[8:11], s37 offen offset:3072 sc1 lds
s_load_dword s3, s[4:5], 78976
s_add_u32 s38, s35, 3
s_and_b32 s38, s38, 15
s_mul_i32 s38, s38, 458752
s_add_u32 m0, s50, 0
s_nop 0
buffer_load_dwordx4 v6, s[16:19], s38 offen lds
s_load_dword s3, s[4:5], 79040
s_add_u32 m0, s50, 1024
s_nop 0
buffer_load_dwordx4 v7, s[16:19], s38 offen lds
s_load_dword s3, s[4:5], 86016
s_add_u32 m0, s50, 2048
s_nop 0
buffer_load_dwordx4 v8, s[16:19], s38 offen lds
s_load_dword s3, s[4:5], 86080
s_add_u32 m0, s50, 3072
s_add_u32 s38, s38, 114688
buffer_load_dwordx4 v6, s[16:19], s38 offen lds
s_load_dword s3, s[4:5], 86144
s_add_u32 m0, s50, 4096
s_nop 0
buffer_load_dwordx4 v7, s[16:19], s38 offen lds
s_add_u32 m0, s50, 5120
s_nop 0
buffer_load_dwordx4 v8, s[16:19], s38 offen lds
s_waitcnt vmcnt(14)
s_barrier
s_add_u32 s37, s35, 4
s_and_b32 s37, s37, 15
s_mul_i32 s37, s37, 16384
s_add_u32 m0, s39, 49152
s_nop 0
buffer_load_dwordx4 v3, s[8:11], s37 offen sc1 lds
buffer_load_dwordx4 v3, s[8:11], s37 offen offset:1024 sc1 lds
buffer_load_dwordx4 v3, s[8:11], s37 offen offset:2048 sc1 lds
buffer_load_dwordx4 v3, s[8:11], s37 offen offset:3072 sc1 lds
s_add_u32 s38, s35, 4
s_and_b32 s38, s38, 15
s_mul_i32 s38, s38, 458752
s_add_u32 m0, s50, 49152
s_nop 0
buffer_load_dwordx4 v6, s[16:19], s38 offen lds
s_add_u32 m0, s50, 50176
s_nop 0
buffer_load_dwordx4 v7, s[16:19], s38 offen lds
s_add_u32 m0, s50, 51200
s_nop 0
buffer_load_dwordx4 v8, s[16:19], s38 offen lds
s_add_u32 m0, s50, 52224
s_add_u32 s38, s38, 114688
buffer_load_dwordx4 v6, s[16:19], s38 offen lds
s_add_u32 m0, s50, 53248
s_nop 0
buffer_load_dwordx4 v7, s[16:19], s38 offen lds
s_add_u32 m0, s50, 54272
s_nop 0
buffer_load_dwordx4 v8, s[16:19], s38 offen lds
s_waitcnt vmcnt(10)
s_barrier
s_cmp_eq_u32 s47, 3
s_cbranch_scc0 Lw_126
s_cmp_lt_u32 s2, 192
s_cbranch_scc0 Lw_126
s_lshr_b32 s43, s2, 4
s_add_u32 s43, s43, 96
s_lshl_b32 s43, s43, 7
v_mov_b32 v30, s43
v_mov_b32 v31, 1
s_mov_b64 exec, 1
buffer_atomic_add v31, v30, s[56:59], 0 offen sc1
s_mov_b64 exec, -1
Lw_126:
s_waitcnt lgkmcnt(0)
s_add_u32 s37, s35, 5
s_and_b32 s37, s37, 15
s_mul_i32 s37, s37, 16384
s_add_u32 m0, s39, 98304
s_nop 0
buffer_load_dwordx4 v3, s[8:11], s37 offen sc1 lds
s_load_dword s3, s[4:5], 86208
s_load_dword s3, s[4:5], 93184
s_load_dword s3, s[4:5], 93248
s_load_dword s3, s[4:5], 93312
buffer_load_dwordx4 v3, s[8:11], s37 offen offset:1024 sc1 lds
s_load_dword s3, s[4:5], 93376
s_and_b32 s44, s36, 3
s_mul_i32 s43, s2, 28672
s_mul_i32 s44, s44, 7168
s_add_u32 s43, s43, s44
buffer_load_dwordx4 v3, s[8:11], s37 offen offset:2048 sc1 lds
s_add_u32 s4, s76, s43
s_addc_u32 s5, s77, 0
s_load_dword s3, s[4:5], 0
s_load_dword s3, s[4:5], 64
v_add_f32 v96, v96, v100
buffer_load_dwordx4 v3, s[8:11], s37 offen offset:3072 sc1 lds
v_add_f32 v97, v97, v101
v_add_f32 v98, v98, v102
v_add_f32 v99, v99, v103
v_add_f32 v104, v104, v108
v_add_f32 v105, v105, v109
s_add_u32 s38, s35, 5
s_and_b32 s38, s38, 15
s_mul_i32 s38, s38, 458752
s_add_u32 m0, s50, 98304
s_nop 0
buffer_load_dwordx4 v6, s[16:19], s38 offen lds
v_add_f32 v106, v106, v110
v_add_f32 v107, v107, v111
s_nop 0
v_permlane32_swap_b32 v96, v104
v_permlane32_swap_b32 v97, v105
s_add_u32 m0, s50, 99328
s_nop 0
buffer_load_dwordx4 v7, s[16:19], s38 offen lds
v_permlane32_swap_b32 v98, v106
v_permlane32_swap_b32 v99, v107
v_add_f32 v96, v96, v104
v_add_f32 v97, v97, v105
v_add_f32 v98, v98, v106
s_add_u32 m0, s50, 100352
s_nop 0
buffer_load_dwordx4 v8, s[16:19], s38 offen lds
v_add_f32 v99, v99, v107
v_mov_b32 v100, v96
v_mov_b32 v101, v97
v_mov_b32 v102, v98
v_mov_b32 v103, v99
s_add_u32 m0, s50, 101376
s_add_u32 s38, s38, 114688
buffer_load_dwordx4 v6, s[16:19], s38 offen lds
s_nop 0
v_permlane16_swap_b32 v96, v100
v_permlane16_swap_b32 v97, v101
v_permlane16_swap_b32 v98, v102
v_permlane16_swap_b32 v99, v103
s_add_u32 m0, s50, 102400
s_nop 0
buffer_load_dwordx4 v7, s[16:19], s38 offen lds
s_add_u32 m0, s50, 103424
s_nop 0
buffer_load_dwordx4 v8, s[16:19], s38 offen lds
s_waitcnt vmcnt(10)
s_barrier
s_add_u32 s37, s35, 6
s_and_b32 s37, s37, 15
s_mul_i32 s37, s37, 16384
s_add_u32 m0, s39, 0
s_nop 0
buffer_load_dwordx4 v3, s[8:11], s37 offen sc1 lds
v_add_f32 v96, v96, v100
v_add_f32 v97, v97, v101
v_add_f32 v98, v98, v102
buffer_load_dwordx4 v3, s[8:11], s37 offen offset:1024 sc1 lds
v_add_f32 v99, v99, v103
s_nop 0
v_add_f32_dpp v96, v96, v96 row_ror:8 row_mask:0xf bank_mask:0xf
buffer_load_dwordx4 v3, s[8:11], s37 offen offset:2048 sc1 lds
v_add_f32_dpp v97, v97, v97 row_ror:8 row_mask:0xf bank_mask:0xf
v_add_f32_dpp v98, v98, v98 row_ror:8 row_mask:0xf bank_mask:0xf
v_add_f32_dpp v99, v99, v99 row_ror:8 row_mask:0xf bank_mask:0xf
v_mul_f32 v96, 0x3a800000, v96
buffer_load_dwordx4 v3, s[8:11], s37 offen offset:3072 sc1 lds
v_mul_f32 v97, 0x3a800000, v97
v_mul_f32 v98, 0x3a800000, v98
v_mul_f32 v99, 0x3a800000, v99
s_add_u32 s38, s35, 6
s_and_b32 s38, s38, 15
s_mul_i32 s38, s38, 458752
s_add_u32 m0, s50, 0
s_nop 0
buffer_load_dwordx4 v6, s[16:19], s38 offen lds
v_fma_f32 v97, -v96, v96, v97
v_fma_f32 v99, -v98, v98, v99
v_max_f32 v97, 0, v97
s_add_u32 m0, s50, 1024
s_nop 0
buffer_load_dwordx4 v7, s[16:19], s38 offen lds
v_max_f32 v99, 0, v99
v_add_f32 v97, 0x3727c5ac, v97
v_add_f32 v99, 0x3727c5ac, v99
v_rsq_f32 v97, v97
s_add_u32 m0, s50, 2048
s_nop 0
buffer_load_dwordx4 v8, s[16:19], s38 offen lds
v_rsq_f32 v99, v99
v_and_b32 v100, 7, v1
s_lshl_b32 s43, s47, 8
s_add_u32 m0, s50, 3072
s_add_u32 s38, s38, 114688
buffer_load_dwordx4 v6, s[16:19], s38 offen lds
s_add_u32 s43, s43, 147456
v_lshl_add_u32 v100, v100, 4, s43
v_lshrrev_b32 v101, 5, v1
v_lshl_add_u32 v100, v101, 7, v100
s_add_u32 m0, s50, 4096
s_nop 0
buffer_load_dwordx4 v7, s[16:19], s38 offen lds
s_add_u32 m0, s50, 5120
s_nop 0
buffer_load_dwordx4 v8, s[16:19], s38 offen lds
s_waitcnt vmcnt(10)
s_barrier
ds_write_b128 v100, v[96:99]
s_waitcnt lgkmcnt(0)
s_add_u32 s37, s35, 7
s_and_b32 s37, s37, 15
s_mul_i32 s37, s37, 16384
s_add_u32 m0, s39, 49152
s_nop 0
buffer_load_dwordx4 v3, s[8:11], s37 offen sc1 lds
buffer_load_dwordx4 v3, s[8:11], s37 offen offset:1024 sc1 lds
s_load_dword s3, s[4:5], 128
buffer_load_dwordx4 v3, s[8:11], s37 offen offset:2048 sc1 lds
s_load_dword s3, s[4:5], 192
buffer_load_dwordx4 v3, s[8:11], s37 offen offset:3072 sc1 lds
s_load_dword s3, s[4:5], 256
s_add_u32 s38, s35, 7
s_and_b32 s38, s38, 15
s_mul_i32 s38, s38, 458752
s_add_u32 m0, s50, 49152
s_nop 0
buffer_load_dwordx4 v6, s[16:19], s38 offen lds
s_load_dword s3, s[4:5], 320
s_add_u32 m0, s50, 50176
s_nop 0
buffer_load_dwordx4 v7, s[16:19], s38 offen lds
s_load_dword s3, s[4:5], 384
s_add_u32 m0, s50, 51200
s_nop 0
buffer_load_dwordx4 v8, s[16:19], s38 offen lds
s_load_dword s3, s[4:5], 448
s_add_u32 m0, s50, 52224
s_add_u32 s38, s38, 114688
buffer_load_dwordx4 v6, s[16:19], s38 offen lds
s_load_dword s3, s[4:5], 512
s_add_u32 m0, s50, 53248
s_nop 0
buffer_load_dwordx4 v7, s[16:19], s38 offen lds
s_add_u32 m0, s50, 54272
s_nop 0
buffer_load_dwordx4 v8, s[16:19], s38 offen lds
s_waitcnt vmcnt(10)
s_barrier
s_add_u32 s37, s35, 8
s_and_b32 s37, s37, 15
s_mul_i32 s37, s37, 16384
s_add_u32 m0, s39, 98304
s_nop 0
buffer_load_dwordx4 v3, s[8:11], s37 offen sc1 lds
v_lshrrev_b32 v28, 2, v1
v_and_b32 v29, 7, v28
buffer_load_dwordx4 v3, s[8:11], s37 offen offset:1024 sc1 lds
v_mul_u32_u24 v28, 256, v28
v_lshl_add_u32 v28, v29, 5, v28
v_and_b32 v29, 3, v1
buffer_load_dwordx4 v3, s[8:11], s37 offen offset:2048 sc1 lds
v_lshl_add_u32 v11, v29, 3, v28
s_lshl_b32 s43, s63, 7
buffer_load_dwordx4 v3, s[8:11], s37 offen offset:3072 sc1 lds
v_xor_b32 v11, s43, v11
v_add_u32 v11, 16384, v11
v_xor_b32 v12, 32, v11
s_add_u32 s38, s35, 8
s_and_b32 s38, s38, 15
s_mul_i32 s38, s38, 458752
s_add_u32 m0, s50, 98304
s_nop 0
buffer_load_dwordx4 v6, s[16:19], s38 offen lds
v_xor_b32 v13, 64, v11
v_xor_b32 v14, 96, v11
s_add_u32 m0, s50, 99328
s_nop 0
buffer_load_dwordx4 v7, s[16:19], s38 offen lds
v_add_u32 v15, 49152, v11
v_add_u32 v16, 49152, v12
v_add_u32 v17, 49152, v13
s_add_u32 m0, s50, 100352
s_nop 0
buffer_load_dwordx4 v8, s[16:19], s38 offen lds
v_add_u32 v18, 49152, v14
v_add_u32 v19, 98304, v11
s_add_u32 m0, s50, 101376
s_add_u32 s38, s38, 114688
buffer_load_dwordx4 v6, s[16:19], s38 offen lds
v_add_u32 v20, 98304, v12
v_add_u32 v21, 98304, v13
v_add_u32 v22, 98304, v14
s_add_u32 m0, s50, 102400
s_nop 0
buffer_load_dwordx4 v7, s[16:19], s38 offen lds
s_add_u32 m0, s50, 103424
s_nop 0
buffer_load_dwordx4 v8, s[16:19], s38 offen lds
s_waitcnt vmcnt(10)
s_barrier
s_waitcnt lgkmcnt(0)
s_cmp_eq_u32 s47, 3
s_cbranch_scc0 Lw_127
s_mul_i32 s60, s35, 96
s_add_u32 s61, s60, 95
s_and_b32 s60, s60, 0xff80
s_and_b32 s61, s61, 0xff80
s_add_u32 s60, s60, 28323840
s_add_u32 s61, s61, 28323840
s_load_dword s92, s[82:83], s60 glc
s_load_dword s93, s[82:83], s61 glc
Lw_127:
s_add_u32 s37, s35, 9
s_and_b32 s37, s37, 15
s_mul_i32 s37, s37, 16384
s_add_u32 m0, s39, 0
s_nop 0
buffer_load_dwordx4 v3, s[8:11], s37 offen sc1 lds
buffer_load_dwordx4 v3, s[8:11], s37 offen offset:1024 sc1 lds
s_load_dword s3, s[4:5], 576
buffer_load_dwordx4 v3, s[8:11], s37 offen offset:2048 sc1 lds
s_load_dword s3, s[4:5], 640
buffer_load_dwordx4 v3, s[8:11], s37 offen offset:3072 sc1 lds
s_load_dword s3, s[4:5], 704
s_add_u32 s38, s35, 9
s_and_b32 s38, s38, 15
s_mul_i32 s38, s38, 458752
s_add_u32 m0, s50, 0
s_nop 0
s_branch Lov_13
.p2align 12
Lst_13_0:
s_branch Lwr_155
s_nop 0
Lov_13:
buffer_load_dwordx4 v6, s[16:19], s38 offen lds
s_load_dword s3, s[4:5], 768
s_add_u32 m0, s50, 1024
s_nop 0
buffer_load_dwordx4 v7, s[16:19], s38 offen lds
s_load_dword s3, s[4:5], 832
s_add_u32 m0, s50, 2048
s_nop 0
buffer_load_dwordx4 v8, s[16:19], s38 offen lds
s_load_dword s3, s[4:5], 896
s_add_u32 m0, s50, 3072
s_add_u32 s38, s38, 114688
buffer_load_dwordx4 v6, s[16:19], s38 offen lds
s_load_dword s3, s[4:5], 960
s_add_u32 m0, s50, 4096
s_nop 0
buffer_load_dwordx4 v7, s[16:19], s38 offen lds
s_add_u32 m0, s50, 5120
s_nop 0
buffer_load_dwordx4 v8, s[16:19], s38 offen lds
s_waitcnt vmcnt(10)
s_barrier
s_add_u32 s37, s35, 10
s_and_b32 s37, s37, 15
s_mul_i32 s37, s37, 16384
s_add_u32 m0, s39, 49152
s_nop 0
buffer_load_dwordx4 v3, s[8:11], s37 offen sc1 lds
buffer_load_dwordx4 v3, s[8:11], s37 offen offset:1024 sc1 lds
buffer_load_dwordx4 v3, s[8:11], s37 offen offset:2048 sc1 lds
buffer_load_dwordx4 v3, s[8:11], s37 offen offset:3072 sc1 lds
s_add_u32 s38, s35, 10
s_and_b32 s38, s38, 15
s_mul_i32 s38, s38, 458752
s_add_u32 m0, s50, 49152
s_nop 0
buffer_load_dwordx4 v6, s[16:19], s38 offen lds
s_add_u32 m0, s50, 50176
s_nop 0
buffer_load_dwordx4 v7, s[16:19], s38 offen lds
s_add_u32 m0, s50, 51200
s_nop 0
buffer_load_dwordx4 v8, s[16:19], s38 offen lds
s_add_u32 m0, s50, 52224
s_add_u32 s38, s38, 114688
buffer_load_dwordx4 v6, s[16:19], s38 offen lds
s_add_u32 m0, s50, 53248
s_nop 0
buffer_load_dwordx4 v7, s[16:19], s38 offen lds
s_add_u32 m0, s50, 54272
s_nop 0
buffer_load_dwordx4 v8, s[16:19], s38 offen lds
s_mov_b32 s38, 0
buffer_load_dwordx4 v[40:43], v24, s[88:91], s38 offen
s_mov_b32 s38, 28672
buffer_load_dwordx4 v[44:47], v24, s[88:91], s38 offen
s_mov_b32 s38, 57344
buffer_load_dwordx4 v[48:51], v24, s[88:91], s38 offen
s_mov_b32 s38, 86016
buffer_load_dwordx4 v[52:55], v24, s[88:91], s38 offen
s_mov_b32 s38, 114688
buffer_load_dwordx4 v[56:59], v24, s[88:91], s38 offen
s_mov_b32 s38, 143360
buffer_load_dwordx4 v[60:63], v24, s[88:91], s38 offen
s_mov_b32 s38, 172032
buffer_load_dwordx4 v[64:67], v24, s[88:91], s38 offen
s_mov_b32 s38, 200704
buffer_load_dwordx4 v[68:71], v24, s[88:91], s38 offen
s_waitcnt vmcnt(18)
s_cmp_eq_u32 s47, 3
s_cbranch_scc0 Lw_128
s_mov_b32 s41, 0x40000
Lcp_129:
s_waitcnt lgkmcnt(0)
s_and_b32 s92, s92, s93
s_cmp_eq_u32 s92, 16
s_cbranch_scc1 Lco_130
s_load_dword s92, s[82:83], s60 glc
s_load_dword s93, s[82:83], s61 glc
s_sub_u32 s41, s41, 1
s_cmp_lg_u32 s41, 0
s_cbranch_scc1 Lcp_129
s_waitcnt lgkmcnt(0)
Lco_130:
Lw_128:
s_barrier
s_mov_b32 s45, s47
s_cmp_ge_u32 s45, 3
s_cselect_b32 s43, 1, 0
s_mul_i32 s44, s43, 3
s_sub_u32 s45, s45, s44
s_lshl_b32 s45, s45, 7
s_mul_i32 s52, s43, 896
s_add_u32 s52, s52, s45
s_add_u32 s52, s52, 148992
s_mul_i32 s43, s43, 14336
s_add_u32 s43, s43, s45
s_mul_i32 s44, s35, 384
s_add_u32 s43, s43, s44
s_add_u32 s60, s43, 8192
s_add_u32 s45, s47, 4
s_min_u32 s45, s45, 5
s_cmp_ge_u32 s45, 3
s_cselect_b32 s43, 1, 0
s_mul_i32 s44, s43, 3
s_sub_u32 s45, s45, s44
s_lshl_b32 s45, s45, 7
s_mul_i32 s53, s43, 896
s_add_u32 s53, s53, s45
s_add_u32 s53, s53, 148992
s_mul_i32 s43, s43, 14336
s_add_u32 s43, s43, s45
s_mul_i32 s44, s35, 384
s_add_u32 s43, s43, s44
s_add_u32 s61, s43, 8192
v_lshrrev_b32 v104, 3, v1
v_mul_u32_u24 v104, 28672, v104
v_and_b32 v105, 7, v1
v_lshl_add_u32 v104, v105, 4, v104
s_waitcnt lgkmcnt(0)
buffer_load_dwordx4 v[96:99], v104, s[84:87], s60 offen sc1
s_load_dword s3, s[4:5], 1024
buffer_load_dwordx4 v[100:103], v104, s[84:87], s61 offen sc1
s_load_dword s3, s[4:5], 1088
s_add_u32 s37, s35, 11
s_and_b32 s37, s37, 15
s_mul_i32 s37, s37, 16384
s_add_u32 m0, s39, 98304
s_nop 0
buffer_load_dwordx4 v3, s[8:11], s37 offen sc1 lds
s_load_dword s3, s[4:5], 1152
s_load_dword s3, s[4:5], 1216
buffer_load_dwordx4 v3, s[8:11], s37 offen offset:1024 sc1 lds
s_load_dword s3, s[4:5], 1280
buffer_load_dwordx4 v3, s[8:11], s37 offen offset:2048 sc1 lds
s_load_dword s3, s[4:5], 1344
s_load_dword s3, s[4:5], 1408
buffer_load_dwordx4 v3, s[8:11], s37 offen offset:3072 sc1 lds
v_cmp_gt_u32 vcc, 32, v1
s_add_u32 s38, s35, 11
s_and_b32 s38, s38, 15
s_mul_i32 s38, s38, 458752
s_add_u32 m0, s50, 98304
s_nop 0
buffer_load_dwordx4 v6, s[16:19], s38 offen lds
v_mov_b32 v104, s52
s_add_u32 m0, s50, 99328
s_nop 0
buffer_load_dwordx4 v7, s[16:19], s38 offen lds
v_mov_b32 v106, s53
v_cndmask_b32 v104, v106, v104, vcc
s_add_u32 m0, s50, 100352
s_nop 0
buffer_load_dwordx4 v8, s[16:19], s38 offen lds
v_lshl_add_u32 v104, v105, 4, v104
s_add_u32 m0, s50, 101376
s_add_u32 s38, s38, 114688
buffer_load_dwordx4 v6, s[16:19], s38 offen lds
v_bfe_u32 v105, v1, 4, 1
v_lshl_add_u32 v104, v105, 2, v104
s_add_u32 m0, s50, 102400
s_nop 0
buffer_load_dwordx4 v7, s[16:19], s38 offen lds
s_add_u32 m0, s50, 103424
s_nop 0
buffer_load_dwordx4 v8, s[16:19], s38 offen lds
s_waitcnt vmcnt(20)
s_barrier
s_add_u32 s37, s35, 12
s_and_b32 s37, s37, 15
s_mul_i32 s37, s37, 16384
s_add_u32 m0, s39, 0
s_nop 0
buffer_load_dwordx4 v3, s[8:11], s37 offen sc1 lds
buffer_load_dwordx4 v3, s[8:11], s37 offen offset:1024 sc1 lds
buffer_load_dwordx4 v3, s[8:11], s37 offen offset:2048 sc1 lds
buffer_load_dwordx4 v3, s[8:11], s37 offen offset:3072 sc1 lds
s_add_u32 s38, s35, 12
s_and_b32 s38, s38, 15
s_mul_i32 s38, s38, 458752
s_add_u32 m0, s50, 0
s_nop 0
buffer_load_dwordx4 v6, s[16:19], s38 offen lds
s_add_u32 m0, s50, 1024
s_nop 0
buffer_load_dwordx4 v7, s[16:19], s38 offen lds
s_add_u32 m0, s50, 2048
s_nop 0
buffer_load_dwordx4 v8, s[16:19], s38 offen lds
s_add_u32 m0, s50, 3072
s_add_u32 s38, s38, 114688
buffer_load_dwordx4 v6, s[16:19], s38 offen lds
s_add_u32 m0, s50, 4096
s_nop 0
buffer_load_dwordx4 v7, s[16:19], s38 offen lds
s_add_u32 m0, s50, 5120
s_nop 0
buffer_load_dwordx4 v8, s[16:19], s38 offen lds
s_waitcnt vmcnt(10)
s_barrier
v_permlane32_swap_b32 v96, v100
v_permlane32_swap_b32 v97, v101
v_permlane32_swap_b32 v98, v102
v_permlane32_swap_b32 v99, v103
v_add_f32 v96, v96, v100
v_add_f32 v97, v97, v101
v_add_f32 v98, v98, v102
v_add_f32 v99, v99, v103
s_nop 1
v_permlane16_swap_b32 v96, v97
v_permlane16_swap_b32 v98, v99
v_add_f32 v96, v96, v97
v_add_f32 v98, v98, v99
s_nop 1
v_add_f32_dpp v96, v96, v96 row_ror:8 row_mask:0xf bank_mask:0xf
v_add_f32_dpp v98, v98, v98 row_ror:8 row_mask:0xf bank_mask:0xf
ds_write_b32 v104, v96
ds_write_b32 v104, v98 offset:8
s_waitcnt lgkmcnt(0)
s_add_u32 s37, s35, 13
s_and_b32 s37, s37, 15
s_mul_i32 s37, s37, 16384
s_add_u32 m0, s39, 49152
s_nop 0
buffer_load_dwordx4 v3, s[8:11], s37 offen sc1 lds
s_load_dword s3, s[4:5], 1472
s_load_dword s3, s[4:5], 1536
s_load_dword s3, s[4:5], 1600
s_load_dword s3, s[4:5], 1664
buffer_load_dwordx4 v3, s[8:11], s37 offen offset:1024 sc1 lds
s_load_dword s3, s[4:5], 1728
v_lshlrev_b32 v72, 16, v40
v_and_b32 v73, 0xffff0000, v40
v_lshlrev_b32 v74, 16, v41
v_and_b32 v75, 0xffff0000, v41
buffer_load_dwordx4 v3, s[8:11], s37 offen offset:2048 sc1 lds
v_lshlrev_b32 v76, 16, v42
v_and_b32 v77, 0xffff0000, v42
v_lshlrev_b32 v78, 16, v43
v_and_b32 v79, 0xffff0000, v43
v_lshlrev_b32 v80, 16, v44
buffer_load_dwordx4 v3, s[8:11], s37 offen offset:3072 sc1 lds
v_and_b32 v81, 0xffff0000, v44
v_lshlrev_b32 v82, 16, v45
v_and_b32 v83, 0xffff0000, v45
v_lshlrev_b32 v84, 16, v46
v_and_b32 v85, 0xffff0000, v46
s_add_u32 s38, s35, 13
s_and_b32 s38, s38, 15
s_mul_i32 s38, s38, 458752
s_add_u32 m0, s50, 49152
s_nop 0
buffer_load_dwordx4 v6, s[16:19], s38 offen lds
v_lshlrev_b32 v86, 16, v47
v_and_b32 v87, 0xffff0000, v47
v_add_f32 v72, v72, v80
v_add_f32 v73, v73, v81
s_add_u32 m0, s50, 50176
s_nop 0
buffer_load_dwordx4 v7, s[16:19], s38 offen lds
v_add_f32 v74, v74, v82
v_add_f32 v75, v75, v83
v_add_f32 v76, v76, v84
v_add_f32 v77, v77, v85
v_add_f32 v78, v78, v86
s_add_u32 m0, s50, 51200
s_nop 0
buffer_load_dwordx4 v8, s[16:19], s38 offen lds
v_add_f32 v79, v79, v87
v_lshlrev_b32 v80, 16, v48
v_and_b32 v81, 0xffff0000, v48
v_lshlrev_b32 v82, 16, v49
v_and_b32 v83, 0xffff0000, v49
s_add_u32 m0, s50, 52224
s_add_u32 s38, s38, 114688
buffer_load_dwordx4 v6, s[16:19], s38 offen lds
v_lshlrev_b32 v84, 16, v50
v_and_b32 v85, 0xffff0000, v50
v_lshlrev_b32 v86, 16, v51
v_and_b32 v87, 0xffff0000, v51
v_add_f32 v72, v72, v80
s_add_u32 m0, s50, 53248
s_nop 0
buffer_load_dwordx4 v7, s[16:19], s38 offen lds
s_add_u32 m0, s50, 54272
s_nop 0
buffer_load_dwordx4 v8, s[16:19], s38 offen lds
s_waitcnt vmcnt(10)
s_barrier
s_add_u32 s37, s35, 14
s_and_b32 s37, s37, 15
s_mul_i32 s37, s37, 16384
s_add_u32 m0, s39, 98304
s_nop 0
buffer_load_dwordx4 v3, s[8:11], s37 offen sc1 lds
v_add_f32 v73, v73, v81
v_add_f32 v74, v74, v82
v_add_f32 v75, v75, v83
v_add_f32 v76, v76, v84
buffer_load_dwordx4 v3, s[8:11], s37 offen offset:1024 sc1 lds
v_add_f32 v77, v77, v85
v_add_f32 v78, v78, v86
v_add_f32 v79, v79, v87
v_lshlrev_b32 v80, 16, v52
buffer_load_dwordx4 v3, s[8:11], s37 offen offset:2048 sc1 lds
v_and_b32 v81, 0xffff0000, v52
v_lshlrev_b32 v82, 16, v53
v_and_b32 v83, 0xffff0000, v53
v_lshlrev_b32 v84, 16, v54
buffer_load_dwordx4 v3, s[8:11], s37 offen offset:3072 sc1 lds
v_and_b32 v85, 0xffff0000, v54
v_lshlrev_b32 v86, 16, v55
v_and_b32 v87, 0xffff0000, v55
v_add_f32 v72, v72, v80
v_add_f32 v73, v73, v81
s_add_u32 s38, s35, 14
s_and_b32 s38, s38, 15
s_mul_i32 s38, s38, 458752
s_add_u32 m0, s50, 98304
s_nop 0
buffer_load_dwordx4 v6, s[16:19], s38 offen lds
v_add_f32 v74, v74, v82
v_add_f32 v75, v75, v83
v_add_f32 v76, v76, v84
v_add_f32 v77, v77, v85
s_add_u32 m0, s50, 99328
s_nop 0
buffer_load_dwordx4 v7, s[16:19], s38 offen lds
v_add_f32 v78, v78, v86
v_add_f32 v79, v79, v87
v_lshlrev_b32 v80, 16, v56
v_and_b32 v81, 0xffff0000, v56
s_add_u32 m0, s50, 100352
s_nop 0
buffer_load_dwordx4 v8, s[16:19], s38 offen lds
v_lshlrev_b32 v82, 16, v57
v_and_b32 v83, 0xffff0000, v57
v_lshlrev_b32 v84, 16, v58
v_and_b32 v85, 0xffff0000, v58
s_add_u32 m0, s50, 101376
s_add_u32 s38, s38, 114688
buffer_load_dwordx4 v6, s[16:19], s38 offen lds
v_lshlrev_b32 v86, 16, v59
v_and_b32 v87, 0xffff0000, v59
v_add_f32 v72, v72, v80
v_add_f32 v73, v73, v81
v_add_f32 v74, v74, v82
s_add_u32 m0, s50, 102400
s_nop 0
buffer_load_dwordx4 v7, s[16:19], s38 offen lds
s_add_u32 m0, s50, 103424
s_nop 0
buffer_load_dwordx4 v8, s[16:19], s38 offen lds
s_waitcnt vmcnt(10)
s_barrier
s_add_u32 s37, s35, 15
s_and_b32 s37, s37, 15
s_mul_i32 s37, s37, 16384
s_add_u32 m0, s39, 0
s_nop 0
buffer_load_dwordx4 v3, s[8:11], s37 offen sc1 lds
v_add_f32 v75, v75, v83
v_add_f32 v76, v76, v84
v_add_f32 v77, v77, v85
v_add_f32 v78, v78, v86
buffer_load_dwordx4 v3, s[8:11], s37 offen offset:1024 sc1 lds
v_add_f32 v79, v79, v87
v_lshlrev_b32 v80, 16, v60
v_and_b32 v81, 0xffff0000, v60
v_lshlrev_b32 v82, 16, v61
buffer_load_dwordx4 v3, s[8:11], s37 offen offset:2048 sc1 lds
v_and_b32 v83, 0xffff0000, v61
v_lshlrev_b32 v84, 16, v62
v_and_b32 v85, 0xffff0000, v62
v_lshlrev_b32 v86, 16, v63
buffer_load_dwordx4 v3, s[8:11], s37 offen offset:3072 sc1 lds
v_and_b32 v87, 0xffff0000, v63
v_add_f32 v72, v72, v80
v_add_f32 v73, v73, v81
v_add_f32 v74, v74, v82
s_add_u32 s38, s35, 15
s_and_b32 s38, s38, 15
s_mul_i32 s38, s38, 458752
s_add_u32 m0, s50, 0
s_nop 0
buffer_load_dwordx4 v6, s[16:19], s38 offen lds
v_add_f32 v75, v75, v83
v_add_f32 v76, v76, v84
v_add_f32 v77, v77, v85
v_add_f32 v78, v78, v86
s_add_u32 m0, s50, 1024
s_nop 0
buffer_load_dwordx4 v7, s[16:19], s38 offen lds
v_add_f32 v79, v79, v87
v_lshlrev_b32 v80, 16, v64
v_and_b32 v81, 0xffff0000, v64
v_lshlrev_b32 v82, 16, v65
s_add_u32 m0, s50, 2048
s_nop 0
buffer_load_dwordx4 v8, s[16:19], s38 offen lds
v_and_b32 v83, 0xffff0000, v65
v_lshlrev_b32 v84, 16, v66
v_and_b32 v85, 0xffff0000, v66
v_lshlrev_b32 v86, 16, v67
s_add_u32 m0, s50, 3072
s_add_u32 s38, s38, 114688
buffer_load_dwordx4 v6, s[16:19], s38 offen lds
v_and_b32 v87, 0xffff0000, v67
v_add_f32 v72, v72, v80
v_add_f32 v73, v73, v81
v_add_f32 v74, v74, v82
v_add_f32 v75, v75, v83
s_add_u32 m0, s50, 4096
s_nop 0
buffer_load_dwordx4 v7, s[16:19], s38 offen lds
s_add_u32 m0, s50, 5120
s_nop 0
buffer_load_dwordx4 v8, s[16:19], s38 offen lds
s_waitcnt vmcnt(10)
s_barrier
s_add_u32 s37, s35, 0
s_and_b32 s37, s37, 15
s_mul_i32 s37, s37, 16384
s_add_u32 m0, s39, 49152
s_nop 0
buffer_load_dwordx4 v3, s[8:11], s37 offen sc1 lds
v_add_f32 v76, v76, v84
v_add_f32 v77, v77, v85
v_add_f32 v78, v78, v86
buffer_load_dwordx4 v3, s[8:11], s37 offen offset:1024 sc1 lds
v_add_f32 v79, v79, v87
v_lshlrev_b32 v80, 16, v68
v_and_b32 v81, 0xffff0000, v68
buffer_load_dwordx4 v3, s[8:11], s37 offen offset:2048 sc1 lds
v_lshlrev_b32 v82, 16, v69
v_and_b32 v83, 0xffff0000, v69
v_lshlrev_b32 v84, 16, v70
v_and_b32 v85, 0xffff0000, v70
buffer_load_dwordx4 v3, s[8:11], s37 offen offset:3072 sc1 lds
v_lshlrev_b32 v86, 16, v71
v_and_b32 v87, 0xffff0000, v71
v_add_f32 v72, v72, v80
s_add_u32 s38, s35, 0
s_and_b32 s38, s38, 15
s_mul_i32 s38, s38, 458752
s_add_u32 m0, s40, 49152
s_nop 0
buffer_load_dwordx4 v4, s[12:15], s38 offen lds
v_add_f32 v73, v73, v81
v_add_f32 v74, v74, v82
v_add_f32 v75, v75, v83
v_add_f32 v76, v76, v84
s_add_u32 m0, s40, 50176
s_nop 0
buffer_load_dwordx4 v5, s[12:15], s38 offen lds
v_add_f32 v77, v77, v85
v_add_f32 v78, v78, v86
v_add_f32 v79, v79, v87
s_add_u32 m0, s40, 51200
s_add_u32 s38, s38, 57344
buffer_load_dwordx4 v4, s[12:15], s38 offen lds
s_nop 0
v_permlane32_swap_b32 v72, v76
v_permlane32_swap_b32 v73, v77
s_add_u32 m0, s40, 52224
s_nop 0
buffer_load_dwordx4 v5, s[12:15], s38 offen lds
v_permlane32_swap_b32 v74, v78
v_permlane32_swap_b32 v75, v79
v_add_f32 v72, v72, v76
v_add_f32 v73, v73, v77
s_add_u32 m0, s40, 53248
s_add_u32 s38, s38, 57344
buffer_load_dwordx4 v4, s[12:15], s38 offen lds
v_add_f32 v74, v74, v78
v_add_f32 v75, v75, v79
s_nop 0
s_add_u32 m0, s40, 54272
s_nop 0
buffer_load_dwordx4 v5, s[12:15], s38 offen lds
v_permlane16_swap_b32 v72, v74
v_permlane16_swap_b32 v73, v75
v_add_f32 v72, v72, v74
v_add_f32 v73, v73, v75
s_add_u32 m0, s40, 55296
s_add_u32 s38, s38, 57344
buffer_load_dwordx4 v4, s[12:15], s38 offen lds
s_add_u32 m0, s40, 56320
s_nop 0
buffer_load_dwordx4 v5, s[12:15], s38 offen lds
s_waitcnt vmcnt(12)
s_barrier
s_lshl_b32 s43, s47, 9
s_add_u32 s43, s43, 153600
v_and_b32 v80, 15, v1
v_lshl_add_u32 v80, v80, 5, s43
v_lshrrev_b32 v81, 4, v1
v_lshl_add_u32 v80, v81, 3, v80
ds_write_b64 v80, v[72:73]
s_waitcnt lgkmcnt(0)
s_add_u32 s37, s35, 1
s_and_b32 s37, s37, 15
s_mul_i32 s37, s37, 16384
s_add_u32 m0, s39, 98304
s_nop 0
buffer_load_dwordx4 v3, s[8:11], s37 offen sc1 lds
s_bfe_u32 s61, s35, 0x10002
s_lshr_b32 s60, s35, 3
buffer_load_dwordx4 v3, s[8:11], s37 offen offset:1024 sc1 lds
s_lshl_b32 s60, s60, 2
s_and_b32 s43, s35, 3
s_add_u32 s60, s60, s43
buffer_load_dwordx4 v3, s[8:11], s37 offen offset:2048 sc1 lds
s_lshl_b32 s43, s60, 8
s_add_u32 s28, s76, s43
buffer_load_dwordx4 v3, s[8:11], s37 offen offset:3072 sc1 lds
s_addc_u32 s29, s77, 0
s_mov_b32 s30, 7338240
s_mov_b32 s31, 0x20000
s_add_u32 s38, s35, 1
s_and_b32 s38, s38, 15
s_mul_i32 s38, s38, 458752
s_add_u32 m0, s40, 98304
s_nop 0
buffer_load_dwordx4 v4, s[12:15], s38 offen lds
s_mul_i32 s52, s61, 196608
s_mul_i32 s53, s61, 1572864
s_mul_i32 s90, s61, 163840
s_add_u32 m0, s40, 99328
s_nop 0
buffer_load_dwordx4 v5, s[12:15], s38 offen lds
s_mul_i32 s91, s61, 1310720
s_lshl_b32 s51, s47, 11
s_add_u32 m0, s40, 100352
s_add_u32 s38, s38, 57344
buffer_load_dwordx4 v4, s[12:15], s38 offen lds
s_lshl_b32 s44, s47, 15
v_lshrrev_b32 v122, 4, v1
v_lshlrev_b32 v123, 1, v122
s_add_u32 m0, s40, 101376
s_nop 0
buffer_load_dwordx4 v5, s[12:15], s38 offen lds
v_and_b32 v23, 15, v1
v_xor_b32 v23, v23, v123
s_add_u32 m0, s40, 102400
s_add_u32 s38, s38, 57344
buffer_load_dwordx4 v4, s[12:15], s38 offen lds
v_lshlrev_b32 v23, 4, v23
v_mul_u32_u24 v122, 2048, v122
v_add_u32 v23, v23, v122
s_add_u32 m0, s40, 103424
s_nop 0
buffer_load_dwordx4 v5, s[12:15], s38 offen lds
v_add_u32 v23, s44, v23
v_xor_b32 v24, 128, v23
v_add_u32 v24, 8192, v24
s_add_u32 m0, s40, 104448
s_add_u32 s38, s38, 57344
buffer_load_dwordx4 v4, s[12:15], s38 offen lds
s_add_u32 m0, s40, 105472
s_nop 0
buffer_load_dwordx4 v5, s[12:15], s38 offen lds
s_waitcnt vmcnt(12)
s_barrier
ds_read_b128 v[28:31], v9 offset:49152
ds_read_b64_tr_b16 v[44:45], v15 offset:0
ds_read_b64_tr_b16 v[46:47], v15 offset:4096
ds_read_b64_tr_b16 v[48:49], v16 offset:0
ds_read_b64_tr_b16 v[50:51], v16 offset:4096
ds_read_b64_tr_b16 v[52:53], v17 offset:0
ds_read_b64_tr_b16 v[54:55], v17 offset:4096
ds_read_b64_tr_b16 v[56:57], v18 offset:0
ds_read_b64_tr_b16 v[58:59], v18 offset:4096
ds_read_b64_tr_b16 v[60:61], v15 offset:16384
ds_read_b64_tr_b16 v[62:63], v15 offset:20480
ds_read_b64_tr_b16 v[64:65], v16 offset:16384
ds_read_b64_tr_b16 v[66:67], v16 offset:20480
ds_read_b64_tr_b16 v[68:69], v17 offset:16384
ds_read_b64_tr_b16 v[70:71], v17 offset:20480
ds_read_b64_tr_b16 v[72:73], v18 offset:16384
ds_read_b64_tr_b16 v[74:75], v18 offset:20480
ds_read_b128 v[32:35], v9 offset:50176
ds_read_b128 v[36:39], v9 offset:51200
ds_read_b128 v[40:43], v9 offset:52224
s_waitcnt lgkmcnt(0)
v_mfma_f32_16x16x32_bf16 v[124:127], v[44:47], v[28:31], 0
ds_read_b128 v[76:79], v9 offset:57344
v_mfma_f32_16x16x32_bf16 v[128:131], v[48:51], v[28:31], 0
ds_read_b64_tr_b16 v[92:93], v15 offset:8192
v_mfma_f32_16x16x32_bf16 v[132:135], v[52:55], v[28:31], 0
ds_read_b64_tr_b16 v[94:95], v15 offset:12288
v_mfma_f32_16x16x32_bf16 v[136:139], v[56:59], v[28:31], 0
ds_read_b64_tr_b16 v[96:97], v16 offset:8192
v_mfma_f32_16x16x32_bf16 v[140:143], v[60:63], v[28:31], 0
ds_read_b64_tr_b16 v[98:99], v16 offset:12288
v_mfma_f32_16x16x32_bf16 v[144:147], v[64:67], v[28:31], 0
ds_read_b64_tr_b16 v[100:101], v17 offset:8192
v_mfma_f32_16x16x32_bf16 v[148:151], v[68:71], v[28:31], 0
ds_read_b64_tr_b16 v[102:103], v17 offset:12288
v_mfma_f32_16x16x32_bf16 v[152:155], v[72:75], v[28:31], 0
ds_read_b64_tr_b16 v[104:105], v18 offset:8192
v_mfma_f32_16x16x32_bf16 v[184:187], v[72:75], v[32:35], 0
ds_read_b64_tr_b16 v[106:107], v18 offset:12288
v_mfma_f32_16x16x32_bf16 v[180:183], v[68:71], v[32:35], 0
ds_read_b64_tr_b16 v[108:109], v15 offset:24576
v_mfma_f32_16x16x32_bf16 v[176:179], v[64:67], v[32:35], 0
ds_read_b64_tr_b16 v[110:111], v15 offset:28672
v_mfma_f32_16x16x32_bf16 v[172:175], v[60:63], v[32:35], 0
ds_read_b64_tr_b16 v[112:113], v16 offset:24576
v_mfma_f32_16x16x32_bf16 v[168:171], v[56:59], v[32:35], 0
ds_read_b64_tr_b16 v[114:115], v16 offset:28672
v_mfma_f32_16x16x32_bf16 v[164:167], v[52:55], v[32:35], 0
ds_read_b64_tr_b16 v[116:117], v17 offset:24576
v_mfma_f32_16x16x32_bf16 v[160:163], v[48:51], v[32:35], 0
ds_read_b64_tr_b16 v[118:119], v17 offset:28672
v_mfma_f32_16x16x32_bf16 v[156:159], v[44:47], v[32:35], 0
ds_read_b64_tr_b16 v[120:121], v18 offset:24576
v_mfma_f32_16x16x32_bf16 v[188:191], v[44:47], v[36:39], 0
ds_read_b64_tr_b16 v[122:123], v18 offset:28672
v_mfma_f32_16x16x32_bf16 v[192:195], v[48:51], v[36:39], 0
ds_read_b128 v[80:83], v9 offset:58368
v_mfma_f32_16x16x32_bf16 v[196:199], v[52:55], v[36:39], 0
ds_read_b128 v[84:87], v9 offset:59392
v_mfma_f32_16x16x32_bf16 v[200:203], v[56:59], v[36:39], 0
ds_read_b128 v[88:91], v9 offset:60416
v_mfma_f32_16x16x32_bf16 v[204:207], v[60:63], v[36:39], 0
v_mfma_f32_16x16x32_bf16 v[208:211], v[64:67], v[36:39], 0
v_mfma_f32_16x16x32_bf16 v[212:215], v[68:71], v[36:39], 0
v_mfma_f32_16x16x32_bf16 v[216:219], v[72:75], v[36:39], 0
v_mfma_f32_16x16x32_bf16 v[248:251], v[72:75], v[40:43], 0
v_mfma_f32_16x16x32_bf16 v[244:247], v[68:71], v[40:43], 0
v_mfma_f32_16x16x32_bf16 v[240:243], v[64:67], v[40:43], 0
v_mfma_f32_16x16x32_bf16 v[236:239], v[60:63], v[40:43], 0
v_mfma_f32_16x16x32_bf16 v[232:235], v[56:59], v[40:43], 0
v_mfma_f32_16x16x32_bf16 v[228:231], v[52:55], v[40:43], 0
v_mfma_f32_16x16x32_bf16 v[224:227], v[48:51], v[40:43], 0
v_mfma_f32_16x16x32_bf16 v[220:223], v[44:47], v[40:43], 0
s_waitcnt vmcnt(0)
s_waitcnt lgkmcnt(0)
s_barrier
v_mfma_f32_16x16x32_bf16 v[124:127], v[92:95], v[76:79], v[124:127]
ds_read_b128 v[28:31], v10 offset:0
v_mfma_f32_16x16x32_bf16 v[128:131], v[96:99], v[76:79], v[128:131]
ds_read_b64_tr_b16 v[44:45], v19 offset:0
v_mfma_f32_16x16x32_bf16 v[132:135], v[100:103], v[76:79], v[132:135]
ds_read_b64_tr_b16 v[46:47], v19 offset:4096
v_mfma_f32_16x16x32_bf16 v[136:139], v[104:107], v[76:79], v[136:139]
ds_read_b64_tr_b16 v[48:49], v20 offset:0
v_mfma_f32_16x16x32_bf16 v[140:143], v[108:111], v[76:79], v[140:143]
ds_read_b64_tr_b16 v[50:51], v20 offset:4096
v_mfma_f32_16x16x32_bf16 v[144:147], v[112:115], v[76:79], v[144:147]
ds_read_b64_tr_b16 v[52:53], v21 offset:0
v_mfma_f32_16x16x32_bf16 v[148:151], v[116:119], v[76:79], v[148:151]
ds_read_b64_tr_b16 v[54:55], v21 offset:4096
v_mfma_f32_16x16x32_bf16 v[152:155], v[120:123], v[76:79], v[152:155]
s_branch Lov_14
.p2align 12
Lst_14_0:
s_branch Lwr_152
s_nop 0
Lov_14:
ds_read_b64_tr_b16 v[56:57], v22 offset:0
v_mfma_f32_16x16x32_bf16 v[184:187], v[120:123], v[80:83], v[184:187]
ds_read_b64_tr_b16 v[58:59], v22 offset:4096
v_mfma_f32_16x16x32_bf16 v[180:183], v[116:119], v[80:83], v[180:183]
ds_read_b64_tr_b16 v[60:61], v19 offset:16384
v_mfma_f32_16x16x32_bf16 v[176:179], v[112:115], v[80:83], v[176:179]
ds_read_b64_tr_b16 v[62:63], v19 offset:20480
v_mfma_f32_16x16x32_bf16 v[172:175], v[108:111], v[80:83], v[172:175]
ds_read_b64_tr_b16 v[64:65], v20 offset:16384
v_mfma_f32_16x16x32_bf16 v[168:171], v[104:107], v[80:83], v[168:171]
ds_read_b64_tr_b16 v[66:67], v20 offset:20480
v_mfma_f32_16x16x32_bf16 v[164:167], v[100:103], v[80:83], v[164:167]
ds_read_b64_tr_b16 v[68:69], v21 offset:16384
v_mfma_f32_16x16x32_bf16 v[160:163], v[96:99], v[80:83], v[160:163]
ds_read_b64_tr_b16 v[70:71], v21 offset:20480
v_mfma_f32_16x16x32_bf16 v[156:159], v[92:95], v[80:83], v[156:159]
ds_read_b64_tr_b16 v[72:73], v22 offset:16384
v_mfma_f32_16x16x32_bf16 v[188:191], v[92:95], v[84:87], v[188:191]
ds_read_b64_tr_b16 v[74:75], v22 offset:20480
v_mfma_f32_16x16x32_bf16 v[192:195], v[96:99], v[84:87], v[192:195]
ds_read_b128 v[32:35], v10 offset:1024
v_mfma_f32_16x16x32_bf16 v[196:199], v[100:103], v[84:87], v[196:199]
ds_read_b128 v[36:39], v10 offset:2048
v_mfma_f32_16x16x32_bf16 v[200:203], v[104:107], v[84:87], v[200:203]
ds_read_b128 v[40:43], v10 offset:3072
v_mfma_f32_16x16x32_bf16 v[204:207], v[108:111], v[84:87], v[204:207]
v_mfma_f32_16x16x32_bf16 v[208:211], v[112:115], v[84:87], v[208:211]
v_mfma_f32_16x16x32_bf16 v[212:215], v[116:119], v[84:87], v[212:215]
v_mfma_f32_16x16x32_bf16 v[216:219], v[120:123], v[84:87], v[216:219]
v_mfma_f32_16x16x32_bf16 v[248:251], v[120:123], v[88:91], v[248:251]
v_mfma_f32_16x16x32_bf16 v[244:247], v[116:119], v[88:91], v[244:247]
v_mfma_f32_16x16x32_bf16 v[240:243], v[112:115], v[88:91], v[240:243]
v_mfma_f32_16x16x32_bf16 v[236:239], v[108:111], v[88:91], v[236:239]
v_mfma_f32_16x16x32_bf16 v[232:235], v[104:107], v[88:91], v[232:235]
v_mfma_f32_16x16x32_bf16 v[228:231], v[100:103], v[88:91], v[228:231]
v_mfma_f32_16x16x32_bf16 v[224:227], v[96:99], v[88:91], v[224:227]
v_mfma_f32_16x16x32_bf16 v[220:223], v[92:95], v[88:91], v[220:223]
s_mov_b32 s41, 5
Lk3l_131:
s_waitcnt lgkmcnt(0)
v_mfma_f32_16x16x32_bf16 v[124:127], v[44:47], v[28:31], v[124:127]
ds_read_b128 v[76:79], v10 offset:8192
v_mfma_f32_16x16x32_bf16 v[128:131], v[48:51], v[28:31], v[128:131]
ds_read_b64_tr_b16 v[92:93], v19 offset:8192
v_mfma_f32_16x16x32_bf16 v[132:135], v[52:55], v[28:31], v[132:135]
ds_read_b64_tr_b16 v[94:95], v19 offset:12288
v_mfma_f32_16x16x32_bf16 v[136:139], v[56:59], v[28:31], v[136:139]
ds_read_b64_tr_b16 v[96:97], v20 offset:8192
v_mfma_f32_16x16x32_bf16 v[140:143], v[60:63], v[28:31], v[140:143]
ds_read_b64_tr_b16 v[98:99], v20 offset:12288
v_mfma_f32_16x16x32_bf16 v[144:147], v[64:67], v[28:31], v[144:147]
ds_read_b64_tr_b16 v[100:101], v21 offset:8192
v_mfma_f32_16x16x32_bf16 v[148:151], v[68:71], v[28:31], v[148:151]
ds_read_b64_tr_b16 v[102:103], v21 offset:12288
v_mfma_f32_16x16x32_bf16 v[152:155], v[72:75], v[28:31], v[152:155]
ds_read_b64_tr_b16 v[104:105], v22 offset:8192
v_mfma_f32_16x16x32_bf16 v[184:187], v[72:75], v[32:35], v[184:187]
ds_read_b64_tr_b16 v[106:107], v22 offset:12288
v_mfma_f32_16x16x32_bf16 v[180:183], v[68:71], v[32:35], v[180:183]
ds_read_b64_tr_b16 v[108:109], v19 offset:24576
v_mfma_f32_16x16x32_bf16 v[176:179], v[64:67], v[32:35], v[176:179]
ds_read_b64_tr_b16 v[110:111], v19 offset:28672
v_mfma_f32_16x16x32_bf16 v[172:175], v[60:63], v[32:35], v[172:175]
ds_read_b64_tr_b16 v[112:113], v20 offset:24576
v_mfma_f32_16x16x32_bf16 v[168:171], v[56:59], v[32:35], v[168:171]
ds_read_b64_tr_b16 v[114:115], v20 offset:28672
v_mfma_f32_16x16x32_bf16 v[164:167], v[52:55], v[32:35], v[164:167]
ds_read_b64_tr_b16 v[116:117], v21 offset:24576
v_mfma_f32_16x16x32_bf16 v[160:163], v[48:51], v[32:35], v[160:163]
ds_read_b64_tr_b16 v[118:119], v21 offset:28672
v_mfma_f32_16x16x32_bf16 v[156:159], v[44:47], v[32:35], v[156:159]
ds_read_b64_tr_b16 v[120:121], v22 offset:24576
v_mfma_f32_16x16x32_bf16 v[188:191], v[44:47], v[36:39], v[188:191]
ds_read_b64_tr_b16 v[122:123], v22 offset:28672
v_mfma_f32_16x16x32_bf16 v[192:195], v[48:51], v[36:39], v[192:195]
ds_read_b128 v[80:83], v10 offset:9216
v_mfma_f32_16x16x32_bf16 v[196:199], v[52:55], v[36:39], v[196:199]
ds_read_b128 v[84:87], v10 offset:10240
v_mfma_f32_16x16x32_bf16 v[200:203], v[56:59], v[36:39], v[200:203]
ds_read_b128 v[88:91], v10 offset:11264
v_mfma_f32_16x16x32_bf16 v[204:207], v[60:63], v[36:39], v[204:207]
v_mfma_f32_16x16x32_bf16 v[208:211], v[64:67], v[36:39], v[208:211]
v_mfma_f32_16x16x32_bf16 v[212:215], v[68:71], v[36:39], v[212:215]
v_mfma_f32_16x16x32_bf16 v[216:219], v[72:75], v[36:39], v[216:219]
v_mfma_f32_16x16x32_bf16 v[248:251], v[72:75], v[40:43], v[248:251]
v_mfma_f32_16x16x32_bf16 v[244:247], v[68:71], v[40:43], v[244:247]
v_mfma_f32_16x16x32_bf16 v[240:243], v[64:67], v[40:43], v[240:243]
v_mfma_f32_16x16x32_bf16 v[236:239], v[60:63], v[40:43], v[236:239]
v_mfma_f32_16x16x32_bf16 v[232:235], v[56:59], v[40:43], v[232:235]
v_mfma_f32_16x16x32_bf16 v[228:231], v[52:55], v[40:43], v[228:231]
v_mfma_f32_16x16x32_bf16 v[224:227], v[48:51], v[40:43], v[224:227]
v_mfma_f32_16x16x32_bf16 v[220:223], v[44:47], v[40:43], v[220:223]
s_waitcnt lgkmcnt(0)
s_barrier
v_mfma_f32_16x16x32_bf16 v[124:127], v[92:95], v[76:79], v[124:127]
ds_read_b128 v[28:31], v9 offset:0
v_mfma_f32_16x16x32_bf16 v[128:131], v[96:99], v[76:79], v[128:131]
ds_read_b64_tr_b16 v[44:45], v11 offset:0
v_mfma_f32_16x16x32_bf16 v[132:135], v[100:103], v[76:79], v[132:135]
ds_read_b64_tr_b16 v[46:47], v11 offset:4096
v_mfma_f32_16x16x32_bf16 v[136:139], v[104:107], v[76:79], v[136:139]
ds_read_b64_tr_b16 v[48:49], v12 offset:0
v_mfma_f32_16x16x32_bf16 v[140:143], v[108:111], v[76:79], v[140:143]
ds_read_b64_tr_b16 v[50:51], v12 offset:4096
v_mfma_f32_16x16x32_bf16 v[144:147], v[112:115], v[76:79], v[144:147]
ds_read_b64_tr_b16 v[52:53], v13 offset:0
v_mfma_f32_16x16x32_bf16 v[148:151], v[116:119], v[76:79], v[148:151]
ds_read_b64_tr_b16 v[54:55], v13 offset:4096
v_mfma_f32_16x16x32_bf16 v[152:155], v[120:123], v[76:79], v[152:155]
ds_read_b64_tr_b16 v[56:57], v14 offset:0
v_mfma_f32_16x16x32_bf16 v[184:187], v[120:123], v[80:83], v[184:187]
ds_read_b64_tr_b16 v[58:59], v14 offset:4096
v_mfma_f32_16x16x32_bf16 v[180:183], v[116:119], v[80:83], v[180:183]
ds_read_b64_tr_b16 v[60:61], v11 offset:16384
v_mfma_f32_16x16x32_bf16 v[176:179], v[112:115], v[80:83], v[176:179]
ds_read_b64_tr_b16 v[62:63], v11 offset:20480
v_mfma_f32_16x16x32_bf16 v[172:175], v[108:111], v[80:83], v[172:175]
ds_read_b64_tr_b16 v[64:65], v12 offset:16384
v_mfma_f32_16x16x32_bf16 v[168:171], v[104:107], v[80:83], v[168:171]
ds_read_b64_tr_b16 v[66:67], v12 offset:20480
v_mfma_f32_16x16x32_bf16 v[164:167], v[100:103], v[80:83], v[164:167]
ds_read_b64_tr_b16 v[68:69], v13 offset:16384
v_mfma_f32_16x16x32_bf16 v[160:163], v[96:99], v[80:83], v[160:163]
ds_read_b64_tr_b16 v[70:71], v13 offset:20480
v_mfma_f32_16x16x32_bf16 v[156:159], v[92:95], v[80:83], v[156:159]
ds_read_b64_tr_b16 v[72:73], v14 offset:16384
v_mfma_f32_16x16x32_bf16 v[188:191], v[92:95], v[84:87], v[188:191]
ds_read_b64_tr_b16 v[74:75], v14 offset:20480
v_mfma_f32_16x16x32_bf16 v[192:195], v[96:99], v[84:87], v[192:195]
ds_read_b128 v[32:35], v9 offset:1024
v_mfma_f32_16x16x32_bf16 v[196:199], v[100:103], v[84:87], v[196:199]
ds_read_b128 v[36:39], v9 offset:2048
v_mfma_f32_16x16x32_bf16 v[200:203], v[104:107], v[84:87], v[200:203]
ds_read_b128 v[40:43], v9 offset:3072
v_mfma_f32_16x16x32_bf16 v[204:207], v[108:111], v[84:87], v[204:207]
v_mfma_f32_16x16x32_bf16 v[208:211], v[112:115], v[84:87], v[208:211]
v_mfma_f32_16x16x32_bf16 v[212:215], v[116:119], v[84:87], v[212:215]
v_mfma_f32_16x16x32_bf16 v[216:219], v[120:123], v[84:87], v[216:219]
v_mfma_f32_16x16x32_bf16 v[248:251], v[120:123], v[88:91], v[248:251]
v_mfma_f32_16x16x32_bf16 v[244:247], v[116:119], v[88:91], v[244:247]
v_mfma_f32_16x16x32_bf16 v[240:243], v[112:115], v[88:91], v[240:243]
v_mfma_f32_16x16x32_bf16 v[236:239], v[108:111], v[88:91], v[236:239]
v_mfma_f32_16x16x32_bf16 v[232:235], v[104:107], v[88:91], v[232:235]
v_mfma_f32_16x16x32_bf16 v[228:231], v[100:103], v[88:91], v[228:231]
v_mfma_f32_16x16x32_bf16 v[224:227], v[96:99], v[88:91], v[224:227]
v_mfma_f32_16x16x32_bf16 v[220:223], v[92:95], v[88:91], v[220:223]
s_waitcnt lgkmcnt(0)
v_mfma_f32_16x16x32_bf16 v[124:127], v[44:47], v[28:31], v[124:127]
ds_read_b128 v[76:79], v9 offset:8192
v_mfma_f32_16x16x32_bf16 v[128:131], v[48:51], v[28:31], v[128:131]
ds_read_b64_tr_b16 v[92:93], v11 offset:8192
v_mfma_f32_16x16x32_bf16 v[132:135], v[52:55], v[28:31], v[132:135]
ds_read_b64_tr_b16 v[94:95], v11 offset:12288
v_mfma_f32_16x16x32_bf16 v[136:139], v[56:59], v[28:31], v[136:139]
ds_read_b64_tr_b16 v[96:97], v12 offset:8192
v_mfma_f32_16x16x32_bf16 v[140:143], v[60:63], v[28:31], v[140:143]
ds_read_b64_tr_b16 v[98:99], v12 offset:12288
v_mfma_f32_16x16x32_bf16 v[144:147], v[64:67], v[28:31], v[144:147]
ds_read_b64_tr_b16 v[100:101], v13 offset:8192
v_mfma_f32_16x16x32_bf16 v[148:151], v[68:71], v[28:31], v[148:151]
ds_read_b64_tr_b16 v[102:103], v13 offset:12288
v_mfma_f32_16x16x32_bf16 v[152:155], v[72:75], v[28:31], v[152:155]
ds_read_b64_tr_b16 v[104:105], v14 offset:8192
v_mfma_f32_16x16x32_bf16 v[184:187], v[72:75], v[32:35], v[184:187]
ds_read_b64_tr_b16 v[106:107], v14 offset:12288
v_mfma_f32_16x16x32_bf16 v[180:183], v[68:71], v[32:35], v[180:183]
ds_read_b64_tr_b16 v[108:109], v11 offset:24576
v_mfma_f32_16x16x32_bf16 v[176:179], v[64:67], v[32:35], v[176:179]
ds_read_b64_tr_b16 v[110:111], v11 offset:28672
v_mfma_f32_16x16x32_bf16 v[172:175], v[60:63], v[32:35], v[172:175]
ds_read_b64_tr_b16 v[112:113], v12 offset:24576
v_mfma_f32_16x16x32_bf16 v[168:171], v[56:59], v[32:35], v[168:171]
ds_read_b64_tr_b16 v[114:115], v12 offset:28672
v_mfma_f32_16x16x32_bf16 v[164:167], v[52:55], v[32:35], v[164:167]
ds_read_b64_tr_b16 v[116:117], v13 offset:24576
v_mfma_f32_16x16x32_bf16 v[160:163], v[48:51], v[32:35], v[160:163]
ds_read_b64_tr_b16 v[118:119], v13 offset:28672
v_mfma_f32_16x16x32_bf16 v[156:159], v[44:47], v[32:35], v[156:159]
ds_read_b64_tr_b16 v[120:121], v14 offset:24576
v_mfma_f32_16x16x32_bf16 v[188:191], v[44:47], v[36:39], v[188:191]
ds_read_b64_tr_b16 v[122:123], v14 offset:28672
v_mfma_f32_16x16x32_bf16 v[192:195], v[48:51], v[36:39], v[192:195]
ds_read_b128 v[80:83], v9 offset:9216
v_mfma_f32_16x16x32_bf16 v[196:199], v[52:55], v[36:39], v[196:199]
ds_read_b128 v[84:87], v9 offset:10240
v_mfma_f32_16x16x32_bf16 v[200:203], v[56:59], v[36:39], v[200:203]
ds_read_b128 v[88:91], v9 offset:11264
v_mfma_f32_16x16x32_bf16 v[204:207], v[60:63], v[36:39], v[204:207]
v_mfma_f32_16x16x32_bf16 v[208:211], v[64:67], v[36:39], v[208:211]
v_mfma_f32_16x16x32_bf16 v[212:215], v[68:71], v[36:39], v[212:215]
v_mfma_f32_16x16x32_bf16 v[216:219], v[72:75], v[36:39], v[216:219]
v_mfma_f32_16x16x32_bf16 v[248:251], v[72:75], v[40:43], v[248:251]
v_mfma_f32_16x16x32_bf16 v[244:247], v[68:71], v[40:43], v[244:247]
v_mfma_f32_16x16x32_bf16 v[240:243], v[64:67], v[40:43], v[240:243]
v_mfma_f32_16x16x32_bf16 v[236:239], v[60:63], v[40:43], v[236:239]
v_mfma_f32_16x16x32_bf16 v[232:235], v[56:59], v[40:43], v[232:235]
v_mfma_f32_16x16x32_bf16 v[228:231], v[52:55], v[40:43], v[228:231]
v_mfma_f32_16x16x32_bf16 v[224:227], v[48:51], v[40:43], v[224:227]
v_mfma_f32_16x16x32_bf16 v[220:223], v[44:47], v[40:43], v[220:223]
s_waitcnt lgkmcnt(0)
s_barrier
v_mfma_f32_16x16x32_bf16 v[124:127], v[92:95], v[76:79], v[124:127]
ds_read_b128 v[28:31], v9 offset:49152
v_mfma_f32_16x16x32_bf16 v[128:131], v[96:99], v[76:79], v[128:131]
ds_read_b64_tr_b16 v[44:45], v15 offset:0
v_mfma_f32_16x16x32_bf16 v[132:135], v[100:103], v[76:79], v[132:135]
ds_read_b64_tr_b16 v[46:47], v15 offset:4096
v_mfma_f32_16x16x32_bf16 v[136:139], v[104:107], v[76:79], v[136:139]
ds_read_b64_tr_b16 v[48:49], v16 offset:0
v_mfma_f32_16x16x32_bf16 v[140:143], v[108:111], v[76:79], v[140:143]
ds_read_b64_tr_b16 v[50:51], v16 offset:4096
v_mfma_f32_16x16x32_bf16 v[144:147], v[112:115], v[76:79], v[144:147]
ds_read_b64_tr_b16 v[52:53], v17 offset:0
v_mfma_f32_16x16x32_bf16 v[148:151], v[116:119], v[76:79], v[148:151]
ds_read_b64_tr_b16 v[54:55], v17 offset:4096
v_mfma_f32_16x16x32_bf16 v[152:155], v[120:123], v[76:79], v[152:155]
ds_read_b64_tr_b16 v[56:57], v18 offset:0
v_mfma_f32_16x16x32_bf16 v[184:187], v[120:123], v[80:83], v[184:187]
ds_read_b64_tr_b16 v[58:59], v18 offset:4096
v_mfma_f32_16x16x32_bf16 v[180:183], v[116:119], v[80:83], v[180:183]
ds_read_b64_tr_b16 v[60:61], v15 offset:16384
v_mfma_f32_16x16x32_bf16 v[176:179], v[112:115], v[80:83], v[176:179]
ds_read_b64_tr_b16 v[62:63], v15 offset:20480
v_mfma_f32_16x16x32_bf16 v[172:175], v[108:111], v[80:83], v[172:175]
ds_read_b64_tr_b16 v[64:65], v16 offset:16384
v_mfma_f32_16x16x32_bf16 v[168:171], v[104:107], v[80:83], v[168:171]
ds_read_b64_tr_b16 v[66:67], v16 offset:20480
v_mfma_f32_16x16x32_bf16 v[164:167], v[100:103], v[80:83], v[164:167]
ds_read_b64_tr_b16 v[68:69], v17 offset:16384
v_mfma_f32_16x16x32_bf16 v[160:163], v[96:99], v[80:83], v[160:163]
ds_read_b64_tr_b16 v[70:71], v17 offset:20480
v_mfma_f32_16x16x32_bf16 v[156:159], v[92:95], v[80:83], v[156:159]
ds_read_b64_tr_b16 v[72:73], v18 offset:16384
v_mfma_f32_16x16x32_bf16 v[188:191], v[92:95], v[84:87], v[188:191]
ds_read_b64_tr_b16 v[74:75], v18 offset:20480
v_mfma_f32_16x16x32_bf16 v[192:195], v[96:99], v[84:87], v[192:195]
ds_read_b128 v[32:35], v9 offset:50176
v_mfma_f32_16x16x32_bf16 v[196:199], v[100:103], v[84:87], v[196:199]
ds_read_b128 v[36:39], v9 offset:51200
v_mfma_f32_16x16x32_bf16 v[200:203], v[104:107], v[84:87], v[200:203]
ds_read_b128 v[40:43], v9 offset:52224
v_mfma_f32_16x16x32_bf16 v[204:207], v[108:111], v[84:87], v[204:207]
v_mfma_f32_16x16x32_bf16 v[208:211], v[112:115], v[84:87], v[208:211]
v_mfma_f32_16x16x32_bf16 v[212:215], v[116:119], v[84:87], v[212:215]
v_mfma_f32_16x16x32_bf16 v[216:219], v[120:123], v[84:87], v[216:219]
v_mfma_f32_16x16x32_bf16 v[248:251], v[120:123], v[88:91], v[248:251]
v_mfma_f32_16x16x32_bf16 v[244:247], v[116:119], v[88:91], v[244:247]
v_mfma_f32_16x16x32_bf16 v[240:243], v[112:115], v[88:91], v[240:243]
v_mfma_f32_16x16x32_bf16 v[236:239], v[108:111], v[88:91], v[236:239]
v_mfma_f32_16x16x32_bf16 v[232:235], v[104:107], v[88:91], v[232:235]
v_mfma_f32_16x16x32_bf16 v[228:231], v[100:103], v[88:91], v[228:231]
v_mfma_f32_16x16x32_bf16 v[224:227], v[96:99], v[88:91], v[224:227]
v_mfma_f32_16x16x32_bf16 v[220:223], v[92:95], v[88:91], v[220:223]
s_waitcnt lgkmcnt(0)
v_mfma_f32_16x16x32_bf16 v[124:127], v[44:47], v[28:31], v[124:127]
ds_read_b128 v[76:79], v9 offset:57344
v_mfma_f32_16x16x32_bf16 v[128:131], v[48:51], v[28:31], v[128:131]
ds_read_b64_tr_b16 v[92:93], v15 offset:8192
v_mfma_f32_16x16x32_bf16 v[132:135], v[52:55], v[28:31], v[132:135]
ds_read_b64_tr_b16 v[94:95], v15 offset:12288
v_mfma_f32_16x16x32_bf16 v[136:139], v[56:59], v[28:31], v[136:139]
ds_read_b64_tr_b16 v[96:97], v16 offset:8192
v_mfma_f32_16x16x32_bf16 v[140:143], v[60:63], v[28:31], v[140:143]
ds_read_b64_tr_b16 v[98:99], v16 offset:12288
v_mfma_f32_16x16x32_bf16 v[144:147], v[64:67], v[28:31], v[144:147]
ds_read_b64_tr_b16 v[100:101], v17 offset:8192
v_mfma_f32_16x16x32_bf16 v[148:151], v[68:71], v[28:31], v[148:151]
ds_read_b64_tr_b16 v[102:103], v17 offset:12288
v_mfma_f32_16x16x32_bf16 v[152:155], v[72:75], v[28:31], v[152:155]
ds_read_b64_tr_b16 v[104:105], v18 offset:8192
v_mfma_f32_16x16x32_bf16 v[184:187], v[72:75], v[32:35], v[184:187]
ds_read_b64_tr_b16 v[106:107], v18 offset:12288
v_mfma_f32_16x16x32_bf16 v[180:183], v[68:71], v[32:35], v[180:183]
ds_read_b64_tr_b16 v[108:109], v15 offset:24576
v_mfma_f32_16x16x32_bf16 v[176:179], v[64:67], v[32:35], v[176:179]
ds_read_b64_tr_b16 v[110:111], v15 offset:28672
v_mfma_f32_16x16x32_bf16 v[172:175], v[60:63], v[32:35], v[172:175]
ds_read_b64_tr_b16 v[112:113], v16 offset:24576
v_mfma_f32_16x16x32_bf16 v[168:171], v[56:59], v[32:35], v[168:171]
ds_read_b64_tr_b16 v[114:115], v16 offset:28672
v_mfma_f32_16x16x32_bf16 v[164:167], v[52:55], v[32:35], v[164:167]
ds_read_b64_tr_b16 v[116:117], v17 offset:24576
v_mfma_f32_16x16x32_bf16 v[160:163], v[48:51], v[32:35], v[160:163]
ds_read_b64_tr_b16 v[118:119], v17 offset:28672
v_mfma_f32_16x16x32_bf16 v[156:159], v[44:47], v[32:35], v[156:159]
ds_read_b64_tr_b16 v[120:121], v18 offset:24576
v_mfma_f32_16x16x32_bf16 v[188:191], v[44:47], v[36:39], v[188:191]
ds_read_b64_tr_b16 v[122:123], v18 offset:28672
v_mfma_f32_16x16x32_bf16 v[192:195], v[48:51], v[36:39], v[192:195]
ds_read_b128 v[80:83], v9 offset:58368
v_mfma_f32_16x16x32_bf16 v[196:199], v[52:55], v[36:39], v[196:199]
ds_read_b128 v[84:87], v9 offset:59392
v_mfma_f32_16x16x32_bf16 v[200:203], v[56:59], v[36:39], v[200:203]
ds_read_b128 v[88:91], v9 offset:60416
v_mfma_f32_16x16x32_bf16 v[204:207], v[60:63], v[36:39], v[204:207]
v_mfma_f32_16x16x32_bf16 v[208:211], v[64:67], v[36:39], v[208:211]
v_mfma_f32_16x16x32_bf16 v[212:215], v[68:71], v[36:39], v[212:215]
v_mfma_f32_16x16x32_bf16 v[216:219], v[72:75], v[36:39], v[216:219]
v_mfma_f32_16x16x32_bf16 v[248:251], v[72:75], v[40:43], v[248:251]
v_mfma_f32_16x16x32_bf16 v[244:247], v[68:71], v[40:43], v[244:247]
v_mfma_f32_16x16x32_bf16 v[240:243], v[64:67], v[40:43], v[240:243]
v_mfma_f32_16x16x32_bf16 v[236:239], v[60:63], v[40:43], v[236:239]
v_mfma_f32_16x16x32_bf16 v[232:235], v[56:59], v[40:43], v[232:235]
v_mfma_f32_16x16x32_bf16 v[228:231], v[52:55], v[40:43], v[228:231]
v_mfma_f32_16x16x32_bf16 v[224:227], v[48:51], v[40:43], v[224:227]
v_mfma_f32_16x16x32_bf16 v[220:223], v[44:47], v[40:43], v[220:223]
s_waitcnt lgkmcnt(0)
s_barrier
v_mfma_f32_16x16x32_bf16 v[124:127], v[92:95], v[76:79], v[124:127]
ds_read_b128 v[28:31], v10 offset:0
v_mfma_f32_16x16x32_bf16 v[128:131], v[96:99], v[76:79], v[128:131]
ds_read_b64_tr_b16 v[44:45], v19 offset:0
v_mfma_f32_16x16x32_bf16 v[132:135], v[100:103], v[76:79], v[132:135]
ds_read_b64_tr_b16 v[46:47], v19 offset:4096
v_mfma_f32_16x16x32_bf16 v[136:139], v[104:107], v[76:79], v[136:139]
ds_read_b64_tr_b16 v[48:49], v20 offset:0
v_mfma_f32_16x16x32_bf16 v[140:143], v[108:111], v[76:79], v[140:143]
ds_read_b64_tr_b16 v[50:51], v20 offset:4096
v_mfma_f32_16x16x32_bf16 v[144:147], v[112:115], v[76:79], v[144:147]
ds_read_b64_tr_b16 v[52:53], v21 offset:0
v_mfma_f32_16x16x32_bf16 v[148:151], v[116:119], v[76:79], v[148:151]
ds_read_b64_tr_b16 v[54:55], v21 offset:4096
v_mfma_f32_16x16x32_bf16 v[152:155], v[120:123], v[76:79], v[152:155]
ds_read_b64_tr_b16 v[56:57], v22 offset:0
v_mfma_f32_16x16x32_bf16 v[184:187], v[120:123], v[80:83], v[184:187]
ds_read_b64_tr_b16 v[58:59], v22 offset:4096
v_mfma_f32_16x16x32_bf16 v[180:183], v[116:119], v[80:83], v[180:183]
ds_read_b64_tr_b16 v[60:61], v19 offset:16384
v_mfma_f32_16x16x32_bf16 v[176:179], v[112:115], v[80:83], v[176:179]
ds_read_b64_tr_b16 v[62:63], v19 offset:20480
v_mfma_f32_16x16x32_bf16 v[172:175], v[108:111], v[80:83], v[172:175]
ds_read_b64_tr_b16 v[64:65], v20 offset:16384
v_mfma_f32_16x16x32_bf16 v[168:171], v[104:107], v[80:83], v[168:171]
ds_read_b64_tr_b16 v[66:67], v20 offset:20480
v_mfma_f32_16x16x32_bf16 v[164:167], v[100:103], v[80:83], v[164:167]
ds_read_b64_tr_b16 v[68:69], v21 offset:16384
v_mfma_f32_16x16x32_bf16 v[160:163], v[96:99], v[80:83], v[160:163]
ds_read_b64_tr_b16 v[70:71], v21 offset:20480
v_mfma_f32_16x16x32_bf16 v[156:159], v[92:95], v[80:83], v[156:159]
ds_read_b64_tr_b16 v[72:73], v22 offset:16384
v_mfma_f32_16x16x32_bf16 v[188:191], v[92:95], v[84:87], v[188:191]
ds_read_b64_tr_b16 v[74:75], v22 offset:20480
v_mfma_f32_16x16x32_bf16 v[192:195], v[96:99], v[84:87], v[192:195]
ds_read_b128 v[32:35], v10 offset:1024
v_mfma_f32_16x16x32_bf16 v[196:199], v[100:103], v[84:87], v[196:199]
ds_read_b128 v[36:39], v10 offset:2048
v_mfma_f32_16x16x32_bf16 v[200:203], v[104:107], v[84:87], v[200:203]
ds_read_b128 v[40:43], v10 offset:3072
v_mfma_f32_16x16x32_bf16 v[204:207], v[108:111], v[84:87], v[204:207]
v_mfma_f32_16x16x32_bf16 v[208:211], v[112:115], v[84:87], v[208:211]
v_mfma_f32_16x16x32_bf16 v[212:215], v[116:119], v[84:87], v[212:215]
v_mfma_f32_16x16x32_bf16 v[216:219], v[120:123], v[84:87], v[216:219]
v_mfma_f32_16x16x32_bf16 v[248:251], v[120:123], v[88:91], v[248:251]
v_mfma_f32_16x16x32_bf16 v[244:247], v[116:119], v[88:91], v[244:247]
v_mfma_f32_16x16x32_bf16 v[240:243], v[112:115], v[88:91], v[240:243]
v_mfma_f32_16x16x32_bf16 v[236:239], v[108:111], v[88:91], v[236:239]
v_mfma_f32_16x16x32_bf16 v[232:235], v[104:107], v[88:91], v[232:235]
v_mfma_f32_16x16x32_bf16 v[228:231], v[100:103], v[88:91], v[228:231]
v_mfma_f32_16x16x32_bf16 v[224:227], v[96:99], v[88:91], v[224:227]
v_mfma_f32_16x16x32_bf16 v[220:223], v[92:95], v[88:91], v[220:223]
s_sub_u32 s41, s41, 1
s_cmp_lg_u32 s41, 0
s_cbranch_scc1 Lk3l_131
s_waitcnt lgkmcnt(0)
v_lshrrev_b32 v84, 4, v1
s_lshl_b32 s43, s63, 8
s_add_u32 s43, s43, 148480
v_lshl_add_u32 v85, v84, 4, s43
v_and_b32 v84, 15, v1
s_lshl_b32 s43, s62, 9
s_add_u32 s43, s43, 147456
v_lshl_add_u32 v84, v84, 3, s43
ds_read_b128 v[28:31], v85 offset:0
ds_read_b128 v[32:35], v85 offset:64
ds_read_b128 v[36:39], v85 offset:128
ds_read_b128 v[40:43], v85 offset:192
ds_read_b128 v[44:47], v85 offset:896
ds_read_b128 v[48:51], v85 offset:960
ds_read_b128 v[52:55], v85 offset:1024
ds_read_b128 v[56:59], v85 offset:1088
ds_read_b64 v[60:61], v84 offset:0
ds_read_b64 v[62:63], v84 offset:128
ds_read_b64 v[64:65], v84 offset:256
ds_read_b64 v[66:67], v84 offset:384
s_lshl_b32 s54, s35, 15
s_lshl_b32 s43, s63, 14
s_add_u32 s54, s54, s43
s_lshl_b32 s43, s62, 12
s_add_u32 s54, s54, s43
s_add_u32 s55, s54, 8192
v_lshrrev_b32 v122, 3, v1
v_and_b32 v123, 6, v122
v_and_b32 v25, 7, v1
v_xor_b32 v25, v25, v123
v_lshlrev_b32 v25, 4, v25
v_mul_u32_u24 v122, 2048, v122
v_add_u32 v25, v25, v122
s_lshl_b32 s43, s61, 7
s_lshl_b32 s44, s47, 15
s_add_u32 s43, s43, s44
v_add_u32 v25, s43, v25
s_waitcnt lgkmcnt(0)
s_barrier
s_add_u32 m0, s39, 81920
s_add_u32 s37, s52, 589824
buffer_load_dwordx4 v3, s[24:27], s37 offen sc1 lds
v_mul_f32 v70, v61, v61
v_mul_f32 v68, 0xc0135761, v61
v_mul_f32 v69, 0xbdd2d3e8, v61
v_mul_f32 v69, v69, v70
v_rcp_f32 v70, v70
v_mul_f32 v74, v63, v63
v_mul_f32 v72, 0xc0135761, v63
v_mul_f32 v73, 0xbdd2d3e8, v63
v_mul_f32 v73, v73, v74
v_rcp_f32 v74, v74
buffer_load_dwordx4 v3, s[24:27], s37 offen offset:1024 sc1 lds
v_fma_f32 v124, -v60, v28, v124
v_fma_f32 v125, -v60, v29, v125
v_fma_f32 v126, -v60, v30, v126
v_fma_f32 v127, -v60, v31, v127
v_fma_f32 v156, -v62, v28, v156
v_fma_f32 v157, -v62, v29, v157
v_fma_f32 v158, -v62, v30, v158
v_fma_f32 v159, -v62, v31, v159
v_mul_f32 v76, v124, v124
v_mul_f32 v77, v125, v125
buffer_load_dwordx4 v3, s[24:27], s37 offen offset:2048 sc1 lds
v_mul_f32 v78, v126, v126
v_mul_f32 v79, v127, v127
v_mul_f32 v80, v156, v156
v_mul_f32 v81, v157, v157
v_mul_f32 v82, v158, v158
v_mul_f32 v83, v159, v159
v_fma_f32 v76, v76, v69, v68
v_fma_f32 v77, v77, v69, v68
v_fma_f32 v78, v78, v69, v68
v_fma_f32 v79, v79, v69, v68
buffer_load_dwordx4 v3, s[24:27], s37 offen offset:3072 sc1 lds
v_fma_f32 v80, v80, v73, v72
v_fma_f32 v81, v81, v73, v72
v_fma_f32 v82, v82, v73, v72
v_fma_f32 v83, v83, v73, v72
v_mul_f32 v76, v76, v124
v_mul_f32 v77, v77, v125
v_mul_f32 v78, v78, v126
v_mul_f32 v79, v79, v127
v_mul_f32 v80, v80, v156
v_mul_f32 v81, v81, v157
s_add_u32 m0, s39, 147456
s_add_u32 s38, s53, 4718592
buffer_load_dwordx4 v23, s[28:31], s38 offen lds
v_mul_f32 v82, v82, v158
v_mul_f32 v83, v83, v159
v_exp_f32 v76, v76
v_exp_f32 v77, v77
v_exp_f32 v78, v78
v_exp_f32 v79, v79
v_exp_f32 v80, v80
v_exp_f32 v81, v81
v_exp_f32 v82, v82
v_exp_f32 v83, v83
s_add_u32 m0, s39, 148480
s_add_u32 s38, s53, 4718592
buffer_load_dwordx4 v24, s[28:31], s38 offen lds
v_fma_f32 v140, -v60, v44, v140
v_fma_f32 v141, -v60, v45, v141
v_fma_f32 v142, -v60, v46, v142
v_fma_f32 v143, -v60, v47, v143
v_fma_f32 v172, -v62, v44, v172
v_fma_f32 v173, -v62, v45, v173
v_fma_f32 v174, -v62, v46, v174
v_fma_f32 v175, -v62, v47, v175
v_fma_f32 v76, v76, v70, v70
v_fma_f32 v77, v77, v70, v70
s_add_u32 m0, s39, 149504
s_add_u32 s38, s53, 4734976
buffer_load_dwordx4 v23, s[28:31], s38 offen lds
v_fma_f32 v78, v78, v70, v70
v_fma_f32 v79, v79, v70, v70
v_fma_f32 v80, v80, v74, v74
v_fma_f32 v81, v81, v74, v74
v_fma_f32 v82, v82, v74, v74
v_fma_f32 v83, v83, v74, v74
v_rcp_f32 v76, v76
v_rcp_f32 v77, v77
v_rcp_f32 v78, v78
v_rcp_f32 v79, v79
s_add_u32 m0, s39, 150528
s_add_u32 s38, s53, 4734976
buffer_load_dwordx4 v24, s[28:31], s38 offen lds
v_rcp_f32 v80, v80
v_rcp_f32 v81, v81
v_rcp_f32 v82, v82
v_rcp_f32 v83, v83
v_mul_f32 v140, v124, v140
v_mul_f32 v141, v125, v141
v_mul_f32 v142, v126, v142
v_mul_f32 v143, v127, v143
v_mul_f32 v172, v156, v172
v_mul_f32 v173, v157, v173
s_add_u32 m0, s39, 98304
s_add_u32 s37, s52, 606208
buffer_load_dwordx4 v3, s[24:27], s37 offen sc1 lds
v_mul_f32 v174, v158, v174
v_mul_f32 v175, v159, v175
v_mul_f32 v140, v140, v76
v_mul_f32 v141, v141, v77
v_mul_f32 v142, v142, v78
v_mul_f32 v143, v143, v79
v_mul_f32 v172, v172, v80
v_mul_f32 v173, v173, v81
v_mul_f32 v174, v174, v82
v_mul_f32 v175, v175, v83
buffer_load_dwordx4 v3, s[24:27], s37 offen offset:1024 sc1 lds
v_cvt_pk_bf16_f32 v124, v140, v141
v_cvt_pk_bf16_f32 v125, v142, v143
v_cvt_pk_bf16_f32 v156, v172, v173
v_cvt_pk_bf16_f32 v157, v174, v175
v_fma_f32 v128, -v60, v32, v128
v_fma_f32 v129, -v60, v33, v129
v_fma_f32 v130, -v60, v34, v130
v_fma_f32 v131, -v60, v35, v131
v_fma_f32 v160, -v62, v32, v160
v_fma_f32 v161, -v62, v33, v161
buffer_load_dwordx4 v3, s[24:27], s37 offen offset:2048 sc1 lds
v_fma_f32 v162, -v62, v34, v162
v_fma_f32 v163, -v62, v35, v163
v_mul_f32 v76, v128, v128
v_mul_f32 v77, v129, v129
v_mul_f32 v78, v130, v130
v_mul_f32 v79, v131, v131
v_mul_f32 v80, v160, v160
v_mul_f32 v81, v161, v161
v_mul_f32 v82, v162, v162
v_mul_f32 v83, v163, v163
buffer_load_dwordx4 v3, s[24:27], s37 offen offset:3072 sc1 lds
v_fma_f32 v76, v76, v69, v68
v_fma_f32 v77, v77, v69, v68
v_fma_f32 v78, v78, v69, v68
v_fma_f32 v79, v79, v69, v68
v_fma_f32 v80, v80, v73, v72
v_fma_f32 v81, v81, v73, v72
v_fma_f32 v82, v82, v73, v72
v_fma_f32 v83, v83, v73, v72
v_mul_f32 v76, v76, v128
v_mul_f32 v77, v77, v129
s_add_u32 m0, s39, 114688
s_add_u32 s38, s53, 4849664
buffer_load_dwordx4 v23, s[28:31], s38 offen lds
v_mul_f32 v78, v78, v130
v_mul_f32 v79, v79, v131
v_mul_f32 v80, v80, v160
v_mul_f32 v81, v81, v161
v_mul_f32 v82, v82, v162
v_mul_f32 v83, v83, v163
v_exp_f32 v76, v76
v_exp_f32 v77, v77
v_exp_f32 v78, v78
v_exp_f32 v79, v79
s_add_u32 m0, s39, 115712
s_add_u32 s38, s53, 4849664
buffer_load_dwordx4 v24, s[28:31], s38 offen lds
v_exp_f32 v80, v80
v_exp_f32 v81, v81
v_exp_f32 v82, v82
v_exp_f32 v83, v83
v_fma_f32 v144, -v60, v48, v144
s_branch Lov_15
.p2align 12
Lst_15_0:
s_branch Lwr_153
s_nop 0
Lov_15:
v_fma_f32 v145, -v60, v49, v145
v_fma_f32 v146, -v60, v50, v146
v_fma_f32 v147, -v60, v51, v147
v_fma_f32 v176, -v62, v48, v176
v_fma_f32 v177, -v62, v49, v177
s_add_u32 m0, s39, 116736
s_add_u32 s38, s53, 4866048
buffer_load_dwordx4 v23, s[28:31], s38 offen lds
s_add_u32 m0, s39, 117760
s_add_u32 s38, s53, 4866048
buffer_load_dwordx4 v24, s[28:31], s38 offen lds
s_barrier
s_add_u32 m0, s39, 131072
s_add_u32 s37, s52, 622592
buffer_load_dwordx4 v3, s[24:27], s37 offen sc1 lds
v_fma_f32 v178, -v62, v50, v178
v_fma_f32 v179, -v62, v51, v179
v_fma_f32 v76, v76, v70, v70
v_fma_f32 v77, v77, v70, v70
v_fma_f32 v78, v78, v70, v70
v_fma_f32 v79, v79, v70, v70
v_fma_f32 v80, v80, v74, v74
v_fma_f32 v81, v81, v74, v74
v_fma_f32 v82, v82, v74, v74
v_fma_f32 v83, v83, v74, v74
v_rcp_f32 v76, v76
v_rcp_f32 v77, v77
v_rcp_f32 v78, v78
v_rcp_f32 v79, v79
v_rcp_f32 v80, v80
v_rcp_f32 v81, v81
v_rcp_f32 v82, v82
v_rcp_f32 v83, v83
v_mul_f32 v144, v128, v144
v_mul_f32 v145, v129, v145
v_mul_f32 v146, v130, v146
v_mul_f32 v147, v131, v147
v_mul_f32 v176, v160, v176
buffer_load_dwordx4 v3, s[24:27], s37 offen offset:1024 sc1 lds
v_mul_f32 v177, v161, v177
v_mul_f32 v178, v162, v178
v_mul_f32 v179, v163, v179
v_mul_f32 v144, v144, v76
v_mul_f32 v145, v145, v77
v_mul_f32 v146, v146, v78
v_mul_f32 v147, v147, v79
v_mul_f32 v176, v176, v80
v_mul_f32 v177, v177, v81
v_mul_f32 v178, v178, v82
v_mul_f32 v179, v179, v83
v_cvt_pk_bf16_f32 v126, v144, v145
v_cvt_pk_bf16_f32 v127, v146, v147
v_cvt_pk_bf16_f32 v158, v176, v177
v_cvt_pk_bf16_f32 v159, v178, v179
buffer_store_dwordx4 v[124:127], v2, s[24:27], s54 offen offset:0 sc1
buffer_store_dwordx4 v[156:159], v2, s[24:27], s54 offen offset:1024 sc1
v_fma_f32 v132, -v60, v36, v132
v_fma_f32 v133, -v60, v37, v133
v_fma_f32 v134, -v60, v38, v134
v_fma_f32 v135, -v60, v39, v135
v_fma_f32 v164, -v62, v36, v164
v_fma_f32 v165, -v62, v37, v165
buffer_load_dwordx4 v3, s[24:27], s37 offen offset:2048 sc1 lds
v_fma_f32 v166, -v62, v38, v166
v_fma_f32 v167, -v62, v39, v167
v_mul_f32 v76, v132, v132
v_mul_f32 v77, v133, v133
v_mul_f32 v78, v134, v134
v_mul_f32 v79, v135, v135
v_mul_f32 v80, v164, v164
v_mul_f32 v81, v165, v165
v_mul_f32 v82, v166, v166
v_mul_f32 v83, v167, v167
v_fma_f32 v76, v76, v69, v68
v_fma_f32 v77, v77, v69, v68
v_fma_f32 v78, v78, v69, v68
v_fma_f32 v79, v79, v69, v68
v_fma_f32 v80, v80, v73, v72
v_fma_f32 v81, v81, v73, v72
v_fma_f32 v82, v82, v73, v72
v_fma_f32 v83, v83, v73, v72
v_mul_f32 v76, v76, v132
v_mul_f32 v77, v77, v133
v_mul_f32 v78, v78, v134
v_mul_f32 v79, v79, v135
v_mul_f32 v80, v80, v164
v_mul_f32 v81, v81, v165
buffer_load_dwordx4 v3, s[24:27], s37 offen offset:3072 sc1 lds
v_mul_f32 v82, v82, v166
v_mul_f32 v83, v83, v167
v_exp_f32 v76, v76
v_exp_f32 v77, v77
v_exp_f32 v78, v78
v_exp_f32 v79, v79
v_exp_f32 v80, v80
v_exp_f32 v81, v81
v_exp_f32 v82, v82
v_exp_f32 v83, v83
v_fma_f32 v148, -v60, v52, v148
v_fma_f32 v149, -v60, v53, v149
v_fma_f32 v150, -v60, v54, v150
v_fma_f32 v151, -v60, v55, v151
v_fma_f32 v180, -v62, v52, v180
v_fma_f32 v181, -v62, v53, v181
v_fma_f32 v182, -v62, v54, v182
v_fma_f32 v183, -v62, v55, v183
v_fma_f32 v76, v76, v70, v70
v_fma_f32 v77, v77, v70, v70
v_fma_f32 v78, v78, v70, v70
v_fma_f32 v79, v79, v70, v70
v_fma_f32 v80, v80, v74, v74
s_add_u32 m0, s39, 0
s_add_u32 s38, s53, 4980736
buffer_load_dwordx4 v23, s[28:31], s38 offen lds
v_fma_f32 v81, v81, v74, v74
v_fma_f32 v82, v82, v74, v74
v_fma_f32 v83, v83, v74, v74
v_rcp_f32 v76, v76
v_rcp_f32 v77, v77
v_rcp_f32 v78, v78
v_rcp_f32 v79, v79
v_rcp_f32 v80, v80
v_rcp_f32 v81, v81
v_rcp_f32 v82, v82
v_rcp_f32 v83, v83
v_mul_f32 v148, v132, v148
v_mul_f32 v149, v133, v149
v_mul_f32 v150, v134, v150
v_mul_f32 v151, v135, v151
v_mul_f32 v180, v164, v180
v_mul_f32 v181, v165, v181
v_mul_f32 v182, v166, v182
v_mul_f32 v183, v167, v183
v_mul_f32 v148, v148, v76
v_mul_f32 v149, v149, v77
v_mul_f32 v150, v150, v78
v_mul_f32 v151, v151, v79
s_add_u32 m0, s39, 1024
s_add_u32 s38, s53, 4980736
buffer_load_dwordx4 v24, s[28:31], s38 offen lds
v_mul_f32 v180, v180, v80
v_mul_f32 v181, v181, v81
v_mul_f32 v182, v182, v82
v_mul_f32 v183, v183, v83
v_cvt_pk_bf16_f32 v132, v148, v149
v_cvt_pk_bf16_f32 v133, v150, v151
v_cvt_pk_bf16_f32 v164, v180, v181
v_cvt_pk_bf16_f32 v165, v182, v183
v_fma_f32 v136, -v60, v40, v136
v_fma_f32 v137, -v60, v41, v137
v_fma_f32 v138, -v60, v42, v138
v_fma_f32 v139, -v60, v43, v139
v_fma_f32 v168, -v62, v40, v168
v_fma_f32 v169, -v62, v41, v169
v_fma_f32 v170, -v62, v42, v170
v_fma_f32 v171, -v62, v43, v171
v_mul_f32 v76, v136, v136
v_mul_f32 v77, v137, v137
v_mul_f32 v78, v138, v138
v_mul_f32 v79, v139, v139
v_mul_f32 v80, v168, v168
v_mul_f32 v81, v169, v169
v_mul_f32 v82, v170, v170
v_mul_f32 v83, v171, v171
s_add_u32 m0, s39, 2048
s_add_u32 s38, s53, 4997120
buffer_load_dwordx4 v23, s[28:31], s38 offen lds
s_add_u32 m0, s39, 3072
s_add_u32 s38, s53, 4997120
buffer_load_dwordx4 v24, s[28:31], s38 offen lds
s_barrier
s_add_u32 m0, s39, 16384
s_add_u32 s37, s52, 638976
buffer_load_dwordx4 v3, s[24:27], s37 offen sc1 lds
v_fma_f32 v76, v76, v69, v68
v_fma_f32 v77, v77, v69, v68
v_fma_f32 v78, v78, v69, v68
v_fma_f32 v79, v79, v69, v68
v_fma_f32 v80, v80, v73, v72
v_fma_f32 v81, v81, v73, v72
v_fma_f32 v82, v82, v73, v72
v_fma_f32 v83, v83, v73, v72
v_mul_f32 v76, v76, v136
v_mul_f32 v77, v77, v137
v_mul_f32 v78, v78, v138
v_mul_f32 v79, v79, v139
v_mul_f32 v80, v80, v168
v_mul_f32 v81, v81, v169
v_mul_f32 v82, v82, v170
v_mul_f32 v83, v83, v171
v_exp_f32 v76, v76
v_exp_f32 v77, v77
v_exp_f32 v78, v78
v_exp_f32 v79, v79
v_exp_f32 v80, v80
v_exp_f32 v81, v81
v_exp_f32 v82, v82
buffer_load_dwordx4 v3, s[24:27], s37 offen offset:1024 sc1 lds
v_exp_f32 v83, v83
v_fma_f32 v152, -v60, v56, v152
v_fma_f32 v153, -v60, v57, v153
v_fma_f32 v154, -v60, v58, v154
v_fma_f32 v155, -v60, v59, v155
v_fma_f32 v184, -v62, v56, v184
v_fma_f32 v185, -v62, v57, v185
v_fma_f32 v186, -v62, v58, v186
v_fma_f32 v187, -v62, v59, v187
v_fma_f32 v76, v76, v70, v70
v_fma_f32 v77, v77, v70, v70
v_fma_f32 v78, v78, v70, v70
v_fma_f32 v79, v79, v70, v70
v_fma_f32 v80, v80, v74, v74
v_fma_f32 v81, v81, v74, v74
v_fma_f32 v82, v82, v74, v74
v_fma_f32 v83, v83, v74, v74
v_rcp_f32 v76, v76
v_rcp_f32 v77, v77
v_rcp_f32 v78, v78
v_rcp_f32 v79, v79
v_rcp_f32 v80, v80
v_rcp_f32 v81, v81
buffer_load_dwordx4 v3, s[24:27], s37 offen offset:2048 sc1 lds
v_rcp_f32 v82, v82
v_rcp_f32 v83, v83
v_mul_f32 v152, v136, v152
v_mul_f32 v153, v137, v153
v_mul_f32 v154, v138, v154
v_mul_f32 v155, v139, v155
v_mul_f32 v184, v168, v184
v_mul_f32 v185, v169, v185
v_mul_f32 v186, v170, v186
v_mul_f32 v187, v171, v187
v_mul_f32 v152, v152, v76
v_mul_f32 v153, v153, v77
v_mul_f32 v154, v154, v78
v_mul_f32 v155, v155, v79
v_mul_f32 v184, v184, v80
v_mul_f32 v185, v185, v81
v_mul_f32 v186, v186, v82
v_mul_f32 v187, v187, v83
v_cvt_pk_bf16_f32 v134, v152, v153
v_cvt_pk_bf16_f32 v135, v154, v155
v_cvt_pk_bf16_f32 v166, v184, v185
v_cvt_pk_bf16_f32 v167, v186, v187
buffer_store_dwordx4 v[132:135], v2, s[24:27], s55 offen offset:0 sc1
buffer_store_dwordx4 v[164:167], v2, s[24:27], s55 offen offset:1024 sc1
buffer_load_dwordx4 v3, s[24:27], s37 offen offset:3072 sc1 lds
v_mul_f32 v70, v65, v65
v_mul_f32 v68, 0xc0135761, v65
v_mul_f32 v69, 0xbdd2d3e8, v65
v_mul_f32 v69, v69, v70
v_rcp_f32 v70, v70
v_mul_f32 v74, v67, v67
v_mul_f32 v72, 0xc0135761, v67
v_mul_f32 v73, 0xbdd2d3e8, v67
v_mul_f32 v73, v73, v74
v_rcp_f32 v74, v74
v_fma_f32 v188, -v64, v28, v188
v_fma_f32 v189, -v64, v29, v189
v_fma_f32 v190, -v64, v30, v190
v_fma_f32 v191, -v64, v31, v191
v_fma_f32 v220, -v66, v28, v220
v_fma_f32 v221, -v66, v29, v221
v_fma_f32 v222, -v66, v30, v222
v_fma_f32 v223, -v66, v31, v223
v_mul_f32 v76, v188, v188
v_mul_f32 v77, v189, v189
v_mul_f32 v78, v190, v190
v_mul_f32 v79, v191, v191
v_mul_f32 v80, v220, v220
s_add_u32 m0, s39, 32768
s_add_u32 s38, s53, 5111808
buffer_load_dwordx4 v23, s[28:31], s38 offen lds
v_mul_f32 v81, v221, v221
v_mul_f32 v82, v222, v222
v_mul_f32 v83, v223, v223
v_fma_f32 v76, v76, v69, v68
v_fma_f32 v77, v77, v69, v68
v_fma_f32 v78, v78, v69, v68
v_fma_f32 v79, v79, v69, v68
v_fma_f32 v80, v80, v73, v72
v_fma_f32 v81, v81, v73, v72
v_fma_f32 v82, v82, v73, v72
v_fma_f32 v83, v83, v73, v72
v_mul_f32 v76, v76, v188
v_mul_f32 v77, v77, v189
v_mul_f32 v78, v78, v190
v_mul_f32 v79, v79, v191
v_mul_f32 v80, v80, v220
v_mul_f32 v81, v81, v221
v_mul_f32 v82, v82, v222
v_mul_f32 v83, v83, v223
v_exp_f32 v76, v76
v_exp_f32 v77, v77
v_exp_f32 v78, v78
v_exp_f32 v79, v79
s_add_u32 m0, s39, 33792
s_add_u32 s38, s53, 5111808
buffer_load_dwordx4 v24, s[28:31], s38 offen lds
v_exp_f32 v80, v80
v_exp_f32 v81, v81
v_exp_f32 v82, v82
v_exp_f32 v83, v83
v_fma_f32 v204, -v64, v44, v204
v_fma_f32 v205, -v64, v45, v205
v_fma_f32 v206, -v64, v46, v206
v_fma_f32 v207, -v64, v47, v207
v_fma_f32 v236, -v66, v44, v236
v_fma_f32 v237, -v66, v45, v237
v_fma_f32 v238, -v66, v46, v238
v_fma_f32 v239, -v66, v47, v239
v_fma_f32 v76, v76, v70, v70
v_fma_f32 v77, v77, v70, v70
v_fma_f32 v78, v78, v70, v70
v_fma_f32 v79, v79, v70, v70
v_fma_f32 v80, v80, v74, v74
v_fma_f32 v81, v81, v74, v74
v_fma_f32 v82, v82, v74, v74
v_fma_f32 v83, v83, v74, v74
v_rcp_f32 v76, v76
v_rcp_f32 v77, v77
v_rcp_f32 v78, v78
v_rcp_f32 v79, v79
s_add_u32 m0, s39, 34816
s_add_u32 s38, s53, 5128192
buffer_load_dwordx4 v23, s[28:31], s38 offen lds
s_add_u32 m0, s39, 35840
s_add_u32 s38, s53, 5128192
buffer_load_dwordx4 v24, s[28:31], s38 offen lds
s_waitcnt vmcnt(28)
s_barrier
s_add_u32 m0, s39, 49152
s_add_u32 s37, s52, 655360
buffer_load_dwordx4 v3, s[24:27], s37 offen sc1 lds
v_rcp_f32 v80, v80
v_rcp_f32 v81, v81
v_rcp_f32 v82, v82
v_rcp_f32 v83, v83
v_mul_f32 v204, v188, v204
v_mul_f32 v205, v189, v205
v_mul_f32 v206, v190, v206
v_mul_f32 v207, v191, v207
v_mul_f32 v236, v220, v236
v_mul_f32 v237, v221, v237
v_mul_f32 v238, v222, v238
v_mul_f32 v239, v223, v239
v_mul_f32 v204, v204, v76
v_mul_f32 v205, v205, v77
v_mul_f32 v206, v206, v78
v_mul_f32 v207, v207, v79
v_mul_f32 v236, v236, v80
v_mul_f32 v237, v237, v81
v_mul_f32 v238, v238, v82
v_mul_f32 v239, v239, v83
v_cvt_pk_bf16_f32 v188, v204, v205
v_cvt_pk_bf16_f32 v189, v206, v207
v_cvt_pk_bf16_f32 v220, v236, v237
buffer_load_dwordx4 v3, s[24:27], s37 offen offset:1024 sc1 lds
v_cvt_pk_bf16_f32 v221, v238, v239
v_fma_f32 v192, -v64, v32, v192
v_fma_f32 v193, -v64, v33, v193
v_fma_f32 v194, -v64, v34, v194
v_fma_f32 v195, -v64, v35, v195
v_fma_f32 v224, -v66, v32, v224
v_fma_f32 v225, -v66, v33, v225
v_fma_f32 v226, -v66, v34, v226
v_fma_f32 v227, -v66, v35, v227
v_mul_f32 v76, v192, v192
v_mul_f32 v77, v193, v193
v_mul_f32 v78, v194, v194
v_mul_f32 v79, v195, v195
v_mul_f32 v80, v224, v224
v_mul_f32 v81, v225, v225
v_mul_f32 v82, v226, v226
v_mul_f32 v83, v227, v227
v_fma_f32 v76, v76, v69, v68
v_fma_f32 v77, v77, v69, v68
v_fma_f32 v78, v78, v69, v68
v_fma_f32 v79, v79, v69, v68
v_fma_f32 v80, v80, v73, v72
v_fma_f32 v81, v81, v73, v72
buffer_load_dwordx4 v3, s[24:27], s37 offen offset:2048 sc1 lds
v_fma_f32 v82, v82, v73, v72
v_fma_f32 v83, v83, v73, v72
v_mul_f32 v76, v76, v192
v_mul_f32 v77, v77, v193
v_mul_f32 v78, v78, v194
v_mul_f32 v79, v79, v195
v_mul_f32 v80, v80, v224
v_mul_f32 v81, v81, v225
v_mul_f32 v82, v82, v226
v_mul_f32 v83, v83, v227
v_exp_f32 v76, v76
v_exp_f32 v77, v77
v_exp_f32 v78, v78
v_exp_f32 v79, v79
v_exp_f32 v80, v80
v_exp_f32 v81, v81
v_exp_f32 v82, v82
v_exp_f32 v83, v83
v_fma_f32 v208, -v64, v48, v208
v_fma_f32 v209, -v64, v49, v209
v_fma_f32 v210, -v64, v50, v210
v_fma_f32 v211, -v64, v51, v211
v_fma_f32 v240, -v66, v48, v240
v_fma_f32 v241, -v66, v49, v241
buffer_load_dwordx4 v3, s[24:27], s37 offen offset:3072 sc1 lds
v_fma_f32 v242, -v66, v50, v242
v_fma_f32 v243, -v66, v51, v243
v_fma_f32 v76, v76, v70, v70
v_fma_f32 v77, v77, v70, v70
v_fma_f32 v78, v78, v70, v70
v_fma_f32 v79, v79, v70, v70
v_fma_f32 v80, v80, v74, v74
v_fma_f32 v81, v81, v74, v74
v_fma_f32 v82, v82, v74, v74
v_fma_f32 v83, v83, v74, v74
v_rcp_f32 v76, v76
v_rcp_f32 v77, v77
v_rcp_f32 v78, v78
v_rcp_f32 v79, v79
v_rcp_f32 v80, v80
v_rcp_f32 v81, v81
v_rcp_f32 v82, v82
v_rcp_f32 v83, v83
v_mul_f32 v208, v192, v208
v_mul_f32 v209, v193, v209
v_mul_f32 v210, v194, v210
v_mul_f32 v211, v195, v211
v_mul_f32 v240, v224, v240
s_add_u32 m0, s39, 65536
s_add_u32 s38, s53, 5242880
buffer_load_dwordx4 v23, s[28:31], s38 offen lds
v_mul_f32 v241, v225, v241
v_mul_f32 v242, v226, v242
v_mul_f32 v243, v227, v243
v_mul_f32 v208, v208, v76
v_mul_f32 v209, v209, v77
v_mul_f32 v210, v210, v78
v_mul_f32 v211, v211, v79
v_mul_f32 v240, v240, v80
v_mul_f32 v241, v241, v81
v_mul_f32 v242, v242, v82
v_mul_f32 v243, v243, v83
v_cvt_pk_bf16_f32 v190, v208, v209
v_cvt_pk_bf16_f32 v191, v210, v211
v_cvt_pk_bf16_f32 v222, v240, v241
v_cvt_pk_bf16_f32 v223, v242, v243
buffer_store_dwordx4 v[188:191], v2, s[24:27], s54 offen offset:2048 sc1
buffer_store_dwordx4 v[220:223], v2, s[24:27], s54 offen offset:3072 sc1
v_fma_f32 v196, -v64, v36, v196
v_fma_f32 v197, -v64, v37, v197
v_fma_f32 v198, -v64, v38, v198
v_fma_f32 v199, -v64, v39, v199
v_fma_f32 v228, -v66, v36, v228
v_fma_f32 v229, -v66, v37, v229
s_add_u32 m0, s39, 66560
s_add_u32 s38, s53, 5242880
buffer_load_dwordx4 v24, s[28:31], s38 offen lds
v_fma_f32 v230, -v66, v38, v230
v_fma_f32 v231, -v66, v39, v231
v_mul_f32 v76, v196, v196
v_mul_f32 v77, v197, v197
v_mul_f32 v78, v198, v198
v_mul_f32 v79, v199, v199
v_mul_f32 v80, v228, v228
v_mul_f32 v81, v229, v229
v_mul_f32 v82, v230, v230
v_mul_f32 v83, v231, v231
v_fma_f32 v76, v76, v69, v68
v_fma_f32 v77, v77, v69, v68
v_fma_f32 v78, v78, v69, v68
v_fma_f32 v79, v79, v69, v68
v_fma_f32 v80, v80, v73, v72
v_fma_f32 v81, v81, v73, v72
v_fma_f32 v82, v82, v73, v72
v_fma_f32 v83, v83, v73, v72
v_mul_f32 v76, v76, v196
v_mul_f32 v77, v77, v197
v_mul_f32 v78, v78, v198
v_mul_f32 v79, v79, v199
v_mul_f32 v80, v80, v228
v_mul_f32 v81, v81, v229
s_add_u32 m0, s39, 67584
s_add_u32 s38, s53, 5259264
buffer_load_dwordx4 v23, s[28:31], s38 offen lds
s_add_u32 m0, s39, 68608
s_add_u32 s38, s53, 5259264
buffer_load_dwordx4 v24, s[28:31], s38 offen lds
s_waitcnt vmcnt(30)
s_barrier
s_add_u32 m0, s39, 81920
s_add_u32 s37, s52, 671744
buffer_load_dwordx4 v3, s[24:27], s37 offen sc1 lds
v_mul_f32 v82, v82, v230
v_mul_f32 v83, v83, v231
v_exp_f32 v76, v76
v_exp_f32 v77, v77
v_exp_f32 v78, v78
v_exp_f32 v79, v79
v_exp_f32 v80, v80
v_exp_f32 v81, v81
v_exp_f32 v82, v82
v_exp_f32 v83, v83
v_fma_f32 v212, -v64, v52, v212
v_fma_f32 v213, -v64, v53, v213
v_fma_f32 v214, -v64, v54, v214
v_fma_f32 v215, -v64, v55, v215
v_fma_f32 v244, -v66, v52, v244
v_fma_f32 v245, -v66, v53, v245
v_fma_f32 v246, -v66, v54, v246
v_fma_f32 v247, -v66, v55, v247
v_fma_f32 v76, v76, v70, v70
v_fma_f32 v77, v77, v70, v70
v_fma_f32 v78, v78, v70, v70
v_fma_f32 v79, v79, v70, v70
v_fma_f32 v80, v80, v74, v74
buffer_load_dwordx4 v3, s[24:27], s37 offen offset:1024 sc1 lds
v_fma_f32 v81, v81, v74, v74
v_fma_f32 v82, v82, v74, v74
v_fma_f32 v83, v83, v74, v74
v_rcp_f32 v76, v76
v_rcp_f32 v77, v77
v_rcp_f32 v78, v78
v_rcp_f32 v79, v79
v_rcp_f32 v80, v80
v_rcp_f32 v81, v81
v_rcp_f32 v82, v82
v_rcp_f32 v83, v83
v_mul_f32 v212, v196, v212
v_mul_f32 v213, v197, v213
v_mul_f32 v214, v198, v214
v_mul_f32 v215, v199, v215
v_mul_f32 v244, v228, v244
v_mul_f32 v245, v229, v245
v_mul_f32 v246, v230, v246
v_mul_f32 v247, v231, v247
v_mul_f32 v212, v212, v76
v_mul_f32 v213, v213, v77
v_mul_f32 v214, v214, v78
v_mul_f32 v215, v215, v79
buffer_load_dwordx4 v3, s[24:27], s37 offen offset:2048 sc1 lds
v_mul_f32 v244, v244, v80
v_mul_f32 v245, v245, v81
v_mul_f32 v246, v246, v82
v_mul_f32 v247, v247, v83
v_cvt_pk_bf16_f32 v196, v212, v213
v_cvt_pk_bf16_f32 v197, v214, v215
v_cvt_pk_bf16_f32 v228, v244, v245
v_cvt_pk_bf16_f32 v229, v246, v247
v_fma_f32 v200, -v64, v40, v200
v_fma_f32 v201, -v64, v41, v201
v_fma_f32 v202, -v64, v42, v202
v_fma_f32 v203, -v64, v43, v203
v_fma_f32 v232, -v66, v40, v232
v_fma_f32 v233, -v66, v41, v233
v_fma_f32 v234, -v66, v42, v234
v_fma_f32 v235, -v66, v43, v235
v_mul_f32 v76, v200, v200
v_mul_f32 v77, v201, v201
v_mul_f32 v78, v202, v202
v_mul_f32 v79, v203, v203
v_mul_f32 v80, v232, v232
v_mul_f32 v81, v233, v233
v_mul_f32 v82, v234, v234
v_mul_f32 v83, v235, v235
buffer_load_dwordx4 v3, s[24:27], s37 offen offset:3072 sc1 lds
v_fma_f32 v76, v76, v69, v68
v_fma_f32 v77, v77, v69, v68
v_fma_f32 v78, v78, v69, v68
v_fma_f32 v79, v79, v69, v68
v_fma_f32 v80, v80, v73, v72
v_fma_f32 v81, v81, v73, v72
v_fma_f32 v82, v82, v73, v72
v_fma_f32 v83, v83, v73, v72
v_mul_f32 v76, v76, v200
v_mul_f32 v77, v77, v201
v_mul_f32 v78, v78, v202
v_mul_f32 v79, v79, v203
v_mul_f32 v80, v80, v232
v_mul_f32 v81, v81, v233
v_mul_f32 v82, v82, v234
v_mul_f32 v83, v83, v235
v_exp_f32 v76, v76
v_exp_f32 v77, v77
v_exp_f32 v78, v78
v_exp_f32 v79, v79
v_exp_f32 v80, v80
v_exp_f32 v81, v81
v_exp_f32 v82, v82
s_add_u32 m0, s39, 147456
s_add_u32 s38, s53, 5373952
buffer_load_dwordx4 v23, s[28:31], s38 offen lds
v_exp_f32 v83, v83
v_fma_f32 v216, -v64, v56, v216
v_fma_f32 v217, -v64, v57, v217
v_fma_f32 v218, -v64, v58, v218
v_fma_f32 v219, -v64, v59, v219
v_fma_f32 v248, -v66, v56, v248
v_fma_f32 v249, -v66, v57, v249
v_fma_f32 v250, -v66, v58, v250
v_fma_f32 v251, -v66, v59, v251
v_fma_f32 v76, v76, v70, v70
v_fma_f32 v77, v77, v70, v70
v_fma_f32 v78, v78, v70, v70
v_fma_f32 v79, v79, v70, v70
v_fma_f32 v80, v80, v74, v74
v_fma_f32 v81, v81, v74, v74
v_fma_f32 v82, v82, v74, v74
v_fma_f32 v83, v83, v74, v74
v_rcp_f32 v76, v76
v_rcp_f32 v77, v77
v_rcp_f32 v78, v78
v_rcp_f32 v79, v79
v_rcp_f32 v80, v80
v_rcp_f32 v81, v81
s_add_u32 m0, s39, 148480
s_add_u32 s38, s53, 5373952
buffer_load_dwordx4 v24, s[28:31], s38 offen lds
v_rcp_f32 v82, v82
v_rcp_f32 v83, v83
v_mul_f32 v216, v200, v216
v_mul_f32 v217, v201, v217
v_mul_f32 v218, v202, v218
v_mul_f32 v219, v203, v219
v_mul_f32 v248, v232, v248
v_mul_f32 v249, v233, v249
v_mul_f32 v250, v234, v250
v_mul_f32 v251, v235, v251
v_mul_f32 v216, v216, v76
v_mul_f32 v217, v217, v77
v_mul_f32 v218, v218, v78
v_mul_f32 v219, v219, v79
v_mul_f32 v248, v248, v80
v_mul_f32 v249, v249, v81
v_mul_f32 v250, v250, v82
v_mul_f32 v251, v251, v83
v_cvt_pk_bf16_f32 v198, v216, v217
v_cvt_pk_bf16_f32 v199, v218, v219
v_cvt_pk_bf16_f32 v230, v248, v249
v_cvt_pk_bf16_f32 v231, v250, v251
buffer_store_dwordx4 v[196:199], v2, s[24:27], s55 offen offset:2048 sc1
buffer_store_dwordx4 v[228:231], v2, s[24:27], s55 offen offset:3072 sc1
s_add_u32 m0, s39, 149504
s_add_u32 s38, s53, 5390336
buffer_load_dwordx4 v23, s[28:31], s38 offen lds
s_add_u32 m0, s39, 150528
s_add_u32 s38, s53, 5390336
buffer_load_dwordx4 v24, s[28:31], s38 offen lds
s_waitcnt vmcnt(30)
s_barrier
s_add_u32 m0, s39, 98304
s_add_u32 s37, s52, 688128
buffer_load_dwordx4 v3, s[24:27], s37 offen sc1 lds
buffer_load_dwordx4 v3, s[24:27], s37 offen offset:1024 sc1 lds
buffer_load_dwordx4 v3, s[24:27], s37 offen offset:2048 sc1 lds
buffer_load_dwordx4 v3, s[24:27], s37 offen offset:3072 sc1 lds
s_add_u32 m0, s39, 114688
s_add_u32 s38, s53, 5505024
buffer_load_dwordx4 v23, s[28:31], s38 offen lds
s_add_u32 m0, s39, 115712
s_add_u32 s38, s53, 5505024
buffer_load_dwordx4 v24, s[28:31], s38 offen lds
s_add_u32 m0, s39, 116736
s_add_u32 s38, s53, 5521408
buffer_load_dwordx4 v23, s[28:31], s38 offen lds
s_add_u32 m0, s39, 117760
s_add_u32 s38, s53, 5521408
buffer_load_dwordx4 v24, s[28:31], s38 offen lds
s_waitcnt vmcnt(10)
s_barrier
s_cmp_eq_u32 s47, 0
s_cbranch_scc0 Lw_132
s_add_u32 s7, s34, 48
s_lshl_b32 s7, s7, 7
v_mov_b32 v26, s7
v_mov_b32 v27, 1
s_mov_b64 exec, 1
s_branch Lov_16
.p2align 12
Lst_16_0:
s_branch Lwr_154
s_nop 0
Lov_16:
buffer_atomic_add v27, v26, s[56:59], 0 offen sc1
s_mov_b64 exec, -1
Lw_132:
s_add_u32 m0, s39, 131072
s_add_u32 s37, s52, 704512
buffer_load_dwordx4 v3, s[24:27], s37 offen sc1 lds
buffer_load_dwordx4 v3, s[24:27], s37 offen offset:1024 sc1 lds
buffer_load_dwordx4 v3, s[24:27], s37 offen offset:2048 sc1 lds
buffer_load_dwordx4 v3, s[24:27], s37 offen offset:3072 sc1 lds
s_add_u32 m0, s39, 0
s_add_u32 s38, s53, 5636096
buffer_load_dwordx4 v23, s[28:31], s38 offen lds
s_add_u32 m0, s39, 1024
s_add_u32 s38, s53, 5636096
buffer_load_dwordx4 v24, s[28:31], s38 offen lds
s_add_u32 m0, s39, 2048
s_add_u32 s38, s53, 5652480
buffer_load_dwordx4 v23, s[28:31], s38 offen lds
s_add_u32 m0, s39, 3072
s_add_u32 s38, s53, 5652480
buffer_load_dwordx4 v24, s[28:31], s38 offen lds
s_waitcnt vmcnt(26)
s_barrier
s_add_u32 m0, s39, 32768
s_add_u32 s38, s91, 0
buffer_load_dwordx4 v23, s[28:31], s38 offen lds
s_add_u32 m0, s39, 33792
s_add_u32 s38, s91, 0
buffer_load_dwordx4 v24, s[28:31], s38 offen lds
s_add_u32 m0, s39, 34816
s_add_u32 s38, s91, 16384
buffer_load_dwordx4 v23, s[28:31], s38 offen lds
s_add_u32 m0, s39, 35840
s_add_u32 s38, s91, 16384
buffer_load_dwordx4 v24, s[28:31], s38 offen lds
s_waitcnt vmcnt(20)
s_barrier
s_add_u32 m0, s39, 65536
s_add_u32 s38, s91, 131072
buffer_load_dwordx4 v23, s[28:31], s38 offen lds
s_add_u32 m0, s39, 66560
s_add_u32 s38, s91, 131072
buffer_load_dwordx4 v24, s[28:31], s38 offen lds
s_add_u32 m0, s39, 67584
s_add_u32 s38, s91, 147456
buffer_load_dwordx4 v23, s[28:31], s38 offen lds
s_add_u32 m0, s39, 68608
s_add_u32 s38, s91, 147456
buffer_load_dwordx4 v24, s[28:31], s38 offen lds
s_waitcnt vmcnt(16)
s_barrier
s_cmp_eq_u32 s47, 3
s_cbranch_scc0 Lw_133
s_lshl_b32 s92, s34, 7
s_add_u32 s92, s92, 28317696
s_load_dword s93, s[82:83], s92 glc
Lw_133:
s_add_u32 m0, s39, 147456
s_add_u32 s38, s91, 262144
buffer_load_dwordx4 v23, s[28:31], s38 offen lds
s_add_u32 m0, s39, 148480
s_add_u32 s38, s91, 262144
buffer_load_dwordx4 v24, s[28:31], s38 offen lds
s_add_u32 m0, s39, 149504
s_add_u32 s38, s91, 278528
buffer_load_dwordx4 v23, s[28:31], s38 offen lds
s_add_u32 m0, s39, 150528
s_add_u32 s38, s91, 278528
buffer_load_dwordx4 v24, s[28:31], s38 offen lds
s_waitcnt vmcnt(12)
s_cmp_eq_u32 s47, 3
s_cbranch_scc0 Lw_134
s_mov_b32 s41, 0x40000
s_branch Lpchk_137
Lpoll_135:
s_load_dword s93, s[82:83], s92 glc
Lpchk_137:
s_waitcnt lgkmcnt(0)
s_cmp_eq_u32 s93, 16
s_cbranch_scc1 Lpok_136
s_sub_u32 s41, s41, 1
s_cmp_lg_u32 s41, 0
s_cbranch_scc1 Lpoll_135
Lpok_136:
Lw_134:
s_barrier
s_add_u32 m0, s39, 16384
s_add_u32 s37, s90, 0
buffer_load_dwordx4 v3, s[24:27], s37 offen sc1 lds
buffer_load_dwordx4 v3, s[24:27], s37 offen offset:1024 sc1 lds
buffer_load_dwordx4 v3, s[24:27], s37 offen offset:2048 sc1 lds
buffer_load_dwordx4 v3, s[24:27], s37 offen offset:3072 sc1 lds
s_add_u32 m0, s39, 49152
s_add_u32 s37, s90, 16384
buffer_load_dwordx4 v3, s[24:27], s37 offen sc1 lds
buffer_load_dwordx4 v3, s[24:27], s37 offen offset:1024 sc1 lds
buffer_load_dwordx4 v3, s[24:27], s37 offen offset:2048 sc1 lds
buffer_load_dwordx4 v3, s[24:27], s37 offen offset:3072 sc1 lds
s_add_u32 m0, s39, 81920
s_add_u32 s37, s90, 32768
buffer_load_dwordx4 v3, s[24:27], s37 offen sc1 lds
buffer_load_dwordx4 v3, s[24:27], s37 offen offset:1024 sc1 lds
buffer_load_dwordx4 v3, s[24:27], s37 offen offset:2048 sc1 lds
buffer_load_dwordx4 v3, s[24:27], s37 offen offset:3072 sc1 lds
s_add_u32 m0, s39, 98304
s_add_u32 s37, s90, 49152
buffer_load_dwordx4 v3, s[24:27], s37 offen sc1 lds
buffer_load_dwordx4 v3, s[24:27], s37 offen offset:1024 sc1 lds
buffer_load_dwordx4 v3, s[24:27], s37 offen offset:2048 sc1 lds
buffer_load_dwordx4 v3, s[24:27], s37 offen offset:3072 sc1 lds
s_add_u32 m0, s39, 114688
s_add_u32 s38, s91, 393216
buffer_load_dwordx4 v23, s[28:31], s38 offen lds
s_add_u32 m0, s39, 115712
s_add_u32 s38, s91, 393216
buffer_load_dwordx4 v24, s[28:31], s38 offen lds
s_add_u32 m0, s39, 116736
s_add_u32 s38, s91, 409600
buffer_load_dwordx4 v23, s[28:31], s38 offen lds
s_add_u32 m0, s39, 117760
s_add_u32 s38, s91, 409600
buffer_load_dwordx4 v24, s[28:31], s38 offen lds
s_waitcnt vmcnt(16)
s_barrier
s_add_u32 m0, s39, 131072
s_add_u32 s37, s90, 65536
buffer_load_dwordx4 v3, s[24:27], s37 offen sc1 lds
buffer_load_dwordx4 v3, s[24:27], s37 offen offset:1024 sc1 lds
buffer_load_dwordx4 v3, s[24:27], s37 offen offset:2048 sc1 lds
buffer_load_dwordx4 v3, s[24:27], s37 offen offset:3072 sc1 lds
s_add_u32 m0, s39, 0
s_add_u32 s38, s91, 524288
buffer_load_dwordx4 v23, s[28:31], s38 offen lds
s_add_u32 m0, s39, 1024
s_add_u32 s38, s91, 524288
buffer_load_dwordx4 v24, s[28:31], s38 offen lds
s_add_u32 m0, s39, 2048
s_add_u32 s38, s91, 540672
buffer_load_dwordx4 v23, s[28:31], s38 offen lds
s_add_u32 m0, s39, 3072
s_add_u32 s38, s91, 540672
buffer_load_dwordx4 v24, s[28:31], s38 offen lds
s_waitcnt vmcnt(20)
s_barrier
s_add_u32 m0, s39, 16384
s_add_u32 s37, s90, 81920
buffer_load_dwordx4 v3, s[24:27], s37 offen sc1 lds
buffer_load_dwordx4 v3, s[24:27], s37 offen offset:1024 sc1 lds
buffer_load_dwordx4 v3, s[24:27], s37 offen offset:2048 sc1 lds
buffer_load_dwordx4 v3, s[24:27], s37 offen offset:3072 sc1 lds
s_add_u32 m0, s39, 32768
s_add_u32 s38, s91, 655360
buffer_load_dwordx4 v23, s[28:31], s38 offen lds
s_add_u32 m0, s39, 33792
s_add_u32 s38, s91, 655360
buffer_load_dwordx4 v24, s[28:31], s38 offen lds
s_add_u32 m0, s39, 34816
s_add_u32 s38, s91, 671744
buffer_load_dwordx4 v23, s[28:31], s38 offen lds
s_add_u32 m0, s39, 35840
s_add_u32 s38, s91, 671744
buffer_load_dwordx4 v24, s[28:31], s38 offen lds
s_waitcnt vmcnt(24)
s_barrier
s_add_u32 m0, s39, 49152
s_add_u32 s37, s90, 98304
buffer_load_dwordx4 v3, s[24:27], s37 offen sc1 lds
buffer_load_dwordx4 v3, s[24:27], s37 offen offset:1024 sc1 lds
buffer_load_dwordx4 v3, s[24:27], s37 offen offset:2048 sc1 lds
buffer_load_dwordx4 v3, s[24:27], s37 offen offset:3072 sc1 lds
s_add_u32 m0, s39, 65536
s_add_u32 s38, s91, 786432
buffer_load_dwordx4 v23, s[28:31], s38 offen lds
s_add_u32 m0, s39, 66560
s_add_u32 s38, s91, 786432
buffer_load_dwordx4 v24, s[28:31], s38 offen lds
s_add_u32 m0, s39, 67584
s_add_u32 s38, s91, 802816
buffer_load_dwordx4 v23, s[28:31], s38 offen lds
s_add_u32 m0, s39, 68608
s_add_u32 s38, s91, 802816
buffer_load_dwordx4 v24, s[28:31], s38 offen lds
s_waitcnt vmcnt(24)
s_barrier
s_add_u32 m0, s39, 81920
s_add_u32 s37, s90, 114688
buffer_load_dwordx4 v3, s[24:27], s37 offen sc1 lds
buffer_load_dwordx4 v3, s[24:27], s37 offen offset:1024 sc1 lds
buffer_load_dwordx4 v3, s[24:27], s37 offen offset:2048 sc1 lds
buffer_load_dwordx4 v3, s[24:27], s37 offen offset:3072 sc1 lds
s_add_u32 m0, s39, 147456
s_add_u32 s38, s91, 917504
buffer_load_dwordx4 v23, s[28:31], s38 offen lds
s_add_u32 m0, s39, 148480
s_add_u32 s38, s91, 917504
buffer_load_dwordx4 v24, s[28:31], s38 offen lds
s_add_u32 m0, s39, 149504
s_add_u32 s38, s91, 933888
buffer_load_dwordx4 v23, s[28:31], s38 offen lds
s_add_u32 m0, s39, 150528
s_add_u32 s38, s91, 933888
buffer_load_dwordx4 v24, s[28:31], s38 offen lds
s_waitcnt vmcnt(24)
s_barrier
s_add_u32 m0, s39, 98304
s_add_u32 s37, s90, 131072
buffer_load_dwordx4 v3, s[24:27], s37 offen sc1 lds
buffer_load_dwordx4 v3, s[24:27], s37 offen offset:1024 sc1 lds
buffer_load_dwordx4 v3, s[24:27], s37 offen offset:2048 sc1 lds
buffer_load_dwordx4 v3, s[24:27], s37 offen offset:3072 sc1 lds
s_add_u32 m0, s39, 114688
s_add_u32 s38, s91, 1048576
buffer_load_dwordx4 v23, s[28:31], s38 offen lds
s_add_u32 m0, s39, 115712
s_add_u32 s38, s91, 1048576
buffer_load_dwordx4 v24, s[28:31], s38 offen lds
s_add_u32 m0, s39, 116736
s_add_u32 s38, s91, 1064960
buffer_load_dwordx4 v23, s[28:31], s38 offen lds
s_add_u32 m0, s39, 117760
s_add_u32 s38, s91, 1064960
buffer_load_dwordx4 v24, s[28:31], s38 offen lds
s_waitcnt vmcnt(24)
s_barrier
s_add_u32 m0, s39, 131072
s_add_u32 s37, s90, 147456
buffer_load_dwordx4 v3, s[24:27], s37 offen sc1 lds
buffer_load_dwordx4 v3, s[24:27], s37 offen offset:1024 sc1 lds
buffer_load_dwordx4 v3, s[24:27], s37 offen offset:2048 sc1 lds
buffer_load_dwordx4 v3, s[24:27], s37 offen offset:3072 sc1 lds
s_add_u32 m0, s39, 0
s_add_u32 s38, s91, 1179648
buffer_load_dwordx4 v23, s[28:31], s38 offen lds
s_add_u32 m0, s39, 1024
s_add_u32 s38, s91, 1179648
buffer_load_dwordx4 v24, s[28:31], s38 offen lds
s_add_u32 m0, s39, 2048
s_add_u32 s38, s91, 1196032
buffer_load_dwordx4 v23, s[28:31], s38 offen lds
s_add_u32 m0, s39, 3072
s_add_u32 s38, s91, 1196032
buffer_load_dwordx4 v24, s[28:31], s38 offen lds
s_waitcnt vmcnt(24)
s_barrier
s_add_u32 m0, s39, 16384
s_mov_b32 s37, 327680
buffer_load_dwordx4 v3, s[24:27], s37 offen sc1 lds
buffer_load_dwordx4 v3, s[24:27], s37 offen offset:1024 sc1 lds
buffer_load_dwordx4 v3, s[24:27], s37 offen offset:2048 sc1 lds
buffer_load_dwordx4 v3, s[24:27], s37 offen offset:3072 sc1 lds
s_add_u32 m0, s51, 32768
s_mov_b32 s38, 2621440
buffer_load_dwordx4 v25, s[28:31], s38 offen lds
s_add_u32 m0, s51, 33792
s_mov_b32 s38, 2637824
buffer_load_dwordx4 v25, s[28:31], s38 offen lds
s_waitcnt vmcnt(22)
s_barrier
s_add_u32 m0, s39, 49152
s_mov_b32 s37, 344064
buffer_load_dwordx4 v3, s[24:27], s37 offen sc1 lds
buffer_load_dwordx4 v3, s[24:27], s37 offen offset:1024 sc1 lds
buffer_load_dwordx4 v3, s[24:27], s37 offen offset:2048 sc1 lds
buffer_load_dwordx4 v3, s[24:27], s37 offen offset:3072 sc1 lds
s_add_u32 m0, s51, 65536
s_mov_b32 s38, 2752512
buffer_load_dwordx4 v25, s[28:31], s38 offen lds
s_add_u32 m0, s51, 66560
s_mov_b32 s38, 2768896
buffer_load_dwordx4 v25, s[28:31], s38 offen lds
s_waitcnt vmcnt(20)
s_barrier
s_add_u32 m0, s39, 81920
s_mov_b32 s37, 360448
buffer_load_dwordx4 v3, s[24:27], s37 offen sc1 lds
buffer_load_dwordx4 v3, s[24:27], s37 offen offset:1024 sc1 lds
buffer_load_dwordx4 v3, s[24:27], s37 offen offset:2048 sc1 lds
buffer_load_dwordx4 v3, s[24:27], s37 offen offset:3072 sc1 lds
s_add_u32 m0, s51, 147456
s_mov_b32 s38, 2883584
buffer_load_dwordx4 v25, s[28:31], s38 offen lds
s_add_u32 m0, s51, 148480
s_mov_b32 s38, 2899968
buffer_load_dwordx4 v25, s[28:31], s38 offen lds
s_waitcnt vmcnt(18)
s_barrier
s_add_u32 m0, s39, 98304
s_mov_b32 s37, 376832
buffer_load_dwordx4 v3, s[24:27], s37 offen sc1 lds
buffer_load_dwordx4 v3, s[24:27], s37 offen offset:1024 sc1 lds
buffer_load_dwordx4 v3, s[24:27], s37 offen offset:2048 sc1 lds
buffer_load_dwordx4 v3, s[24:27], s37 offen offset:3072 sc1 lds
s_add_u32 m0, s51, 114688
s_mov_b32 s38, 3014656
buffer_load_dwordx4 v25, s[28:31], s38 offen lds
s_add_u32 m0, s51, 115712
s_mov_b32 s38, 3031040
buffer_load_dwordx4 v25, s[28:31], s38 offen lds
s_waitcnt vmcnt(18)
s_barrier
s_add_u32 m0, s39, 131072
s_mov_b32 s37, 393216
buffer_load_dwordx4 v3, s[24:27], s37 offen sc1 lds
buffer_load_dwordx4 v3, s[24:27], s37 offen offset:1024 sc1 lds
buffer_load_dwordx4 v3, s[24:27], s37 offen offset:2048 sc1 lds
buffer_load_dwordx4 v3, s[24:27], s37 offen offset:3072 sc1 lds
s_add_u32 m0, s51, 0
s_mov_b32 s38, 3145728
buffer_load_dwordx4 v25, s[28:31], s38 offen lds
s_add_u32 m0, s51, 1024
s_mov_b32 s38, 3162112
buffer_load_dwordx4 v25, s[28:31], s38 offen lds
s_waitcnt vmcnt(18)
s_barrier
s_add_u32 m0, s39, 16384
s_mov_b32 s37, 409600
buffer_load_dwordx4 v3, s[24:27], s37 offen sc1 lds
buffer_load_dwordx4 v3, s[24:27], s37 offen offset:1024 sc1 lds
buffer_load_dwordx4 v3, s[24:27], s37 offen offset:2048 sc1 lds
buffer_load_dwordx4 v3, s[24:27], s37 offen offset:3072 sc1 lds
s_add_u32 m0, s51, 32768
s_mov_b32 s38, 3276800
buffer_load_dwordx4 v25, s[28:31], s38 offen lds
s_add_u32 m0, s51, 33792
s_mov_b32 s38, 3293184
buffer_load_dwordx4 v25, s[28:31], s38 offen lds
s_waitcnt vmcnt(18)
s_barrier
s_add_u32 m0, s39, 49152
s_mov_b32 s37, 425984
buffer_load_dwordx4 v3, s[24:27], s37 offen sc1 lds
buffer_load_dwordx4 v3, s[24:27], s37 offen offset:1024 sc1 lds
buffer_load_dwordx4 v3, s[24:27], s37 offen offset:2048 sc1 lds
buffer_load_dwordx4 v3, s[24:27], s37 offen offset:3072 sc1 lds
s_add_u32 m0, s51, 65536
s_mov_b32 s38, 3407872
buffer_load_dwordx4 v25, s[28:31], s38 offen lds
s_add_u32 m0, s51, 66560
s_mov_b32 s38, 3424256
buffer_load_dwordx4 v25, s[28:31], s38 offen lds
s_waitcnt vmcnt(18)
s_barrier
s_add_u32 m0, s39, 81920
s_mov_b32 s37, 442368
buffer_load_dwordx4 v3, s[24:27], s37 offen sc1 lds
buffer_load_dwordx4 v3, s[24:27], s37 offen offset:1024 sc1 lds
buffer_load_dwordx4 v3, s[24:27], s37 offen offset:2048 sc1 lds
buffer_load_dwordx4 v3, s[24:27], s37 offen offset:3072 sc1 lds
s_add_u32 m0, s51, 147456
s_mov_b32 s38, 3538944
buffer_load_dwordx4 v25, s[28:31], s38 offen lds
s_add_u32 m0, s51, 148480
s_mov_b32 s38, 3555328
buffer_load_dwordx4 v25, s[28:31], s38 offen lds
s_waitcnt vmcnt(18)
s_barrier
s_add_u32 m0, s39, 98304
s_mov_b32 s37, 458752
buffer_load_dwordx4 v3, s[24:27], s37 offen sc1 lds
buffer_load_dwordx4 v3, s[24:27], s37 offen offset:1024 sc1 lds
buffer_load_dwordx4 v3, s[24:27], s37 offen offset:2048 sc1 lds
buffer_load_dwordx4 v3, s[24:27], s37 offen offset:3072 sc1 lds
s_add_u32 m0, s51, 114688
s_mov_b32 s38, 3670016
buffer_load_dwordx4 v25, s[28:31], s38 offen lds
s_add_u32 m0, s51, 115712
s_mov_b32 s38, 3686400
buffer_load_dwordx4 v25, s[28:31], s38 offen lds
s_waitcnt vmcnt(18)
s_barrier
s_add_u32 m0, s39, 131072
s_mov_b32 s37, 475136
buffer_load_dwordx4 v3, s[24:27], s37 offen sc1 lds
buffer_load_dwordx4 v3, s[24:27], s37 offen offset:1024 sc1 lds
buffer_load_dwordx4 v3, s[24:27], s37 offen offset:2048 sc1 lds
buffer_load_dwordx4 v3, s[24:27], s37 offen offset:3072 sc1 lds
s_add_u32 m0, s51, 0
s_mov_b32 s38, 3801088
buffer_load_dwordx4 v25, s[28:31], s38 offen lds
s_add_u32 m0, s51, 1024
s_mov_b32 s38, 3817472
buffer_load_dwordx4 v25, s[28:31], s38 offen lds
s_waitcnt vmcnt(18)
s_barrier
s_cmp_eq_u32 s47, 0
s_cbranch_scc0 Lw_138
s_xor_b32 s43, s2, 2
s_add_u32 s43, s43, 128
s_lshl_b32 s43, s43, 7
v_mov_b32 v26, s43
v_mov_b32 v27, 1
s_mov_b64 exec, 1
buffer_store_dword v27, v26, s[56:59], 0 offen sc1
s_mov_b64 exec, -1
Lw_138:
s_add_u32 m0, s39, 16384
s_mov_b32 s37, 491520
buffer_load_dwordx4 v3, s[24:27], s37 offen sc1 lds
buffer_load_dwordx4 v3, s[24:27], s37 offen offset:1024 sc1 lds
buffer_load_dwordx4 v3, s[24:27], s37 offen offset:2048 sc1 lds
buffer_load_dwordx4 v3, s[24:27], s37 offen offset:3072 sc1 lds
s_add_u32 m0, s51, 32768
s_mov_b32 s38, 3932160
buffer_load_dwordx4 v25, s[28:31], s38 offen lds
s_add_u32 m0, s51, 33792
s_mov_b32 s38, 3948544
buffer_load_dwordx4 v25, s[28:31], s38 offen lds
s_waitcnt vmcnt(18)
s_barrier
s_add_u32 m0, s39, 49152
s_mov_b32 s37, 507904
buffer_load_dwordx4 v3, s[24:27], s37 offen sc1 lds
buffer_load_dwordx4 v3, s[24:27], s37 offen offset:1024 sc1 lds
buffer_load_dwordx4 v3, s[24:27], s37 offen offset:2048 sc1 lds
buffer_load_dwordx4 v3, s[24:27], s37 offen offset:3072 sc1 lds
s_add_u32 m0, s51, 65536
s_mov_b32 s38, 4063232
buffer_load_dwordx4 v25, s[28:31], s38 offen lds
s_add_u32 m0, s51, 66560
s_mov_b32 s38, 4079616
buffer_load_dwordx4 v25, s[28:31], s38 offen lds
s_waitcnt vmcnt(18)
s_barrier
s_cmp_eq_u32 s47, 3
s_cbranch_scc0 Lw_139
s_lshl_b32 s92, s2, 7
s_add_u32 s92, s92, 28327936
s_load_dword s93, s[82:83], s92 glc
Lw_139:
s_waitcnt vmcnt(12)
s_cmp_eq_u32 s47, 3
s_cbranch_scc0 Lw_140
s_mov_b32 s41, 0x40000
s_branch Lpchk_143
Lpoll_141:
s_load_dword s93, s[82:83], s92 glc
Lpchk_143:
s_waitcnt lgkmcnt(0)
s_cmp_eq_u32 s93, 1
s_cbranch_scc1 Lpok_142
s_sub_u32 s41, s41, 1
s_cmp_lg_u32 s41, 0
s_cbranch_scc1 Lpoll_141
Lpok_142:
Lw_140:
s_barrier
s_waitcnt vmcnt(6)
s_barrier
s_waitcnt vmcnt(0)
s_barrier
s_barrier
s_branch Ldone_1
Ldone_1:
Lfin:
Lexit_2:
s_endpgm
.section .rodata,"a"
.p2align 6
.amdhsa_kernel sequential_preLN__sliding_local_dilated__glu_gated_geglu__prompt_kernel
  .amdhsa_next_free_vgpr 256
  .amdhsa_next_free_sgpr 100
  .amdhsa_accum_offset 256
  .amdhsa_group_segment_fixed_size 0
  .amdhsa_kernarg_size 80
  .amdhsa_user_sgpr_count 2
  .amdhsa_user_sgpr_kernarg_segment_ptr 1
  .amdhsa_system_sgpr_workgroup_id_x 1
  .amdhsa_float_denorm_mode_32 3
  .amdhsa_float_denorm_mode_16_64 3
.end_amdhsa_kernel
```

```asm
; @launch grid=(256,1,1) block=(512,1,1) lds=163840
.amdgcn_target "amdgcn-amd-amdhsa--gfx950"
.text
.globl sequential_preLN__sliding_local_dilated__glu_gated_geglu__prompt_kernel
.p2align 8
.type sequential_preLN__sliding_local_dilated__glu_gated_geglu__prompt_kernel,@function
sequential_preLN__sliding_local_dilated__glu_gated_geglu__prompt_kernel:
s_cmp_ge_u32 s2, 256
s_cbranch_scc1 Lexit_2
s_load_dwordx16 s[64:79], s[0:1], 0
s_load_dwordx4 s[80:83], s[0:1], 64
s_and_b32 s3, s2, 7
s_lshr_b32 s42, s2, 3
s_and_b32 s34, s3, 1
s_lshl_b32 s34, s34, 3
s_and_b32 s48, s42, 7
s_add_u32 s34, s34, s48
s_lshr_b32 s35, s3, 1
s_lshr_b32 s49, s42, 3
s_lshl_b32 s35, s35, 2
s_add_u32 s35, s35, s49
v_lshrrev_b32 v12, 6, v0
v_and_b32 v1, 63, v0
v_readfirstlane_b32 s36, v12
Lbeg:
s_lshl_b32 s50, s34, 7
s_sub_u32 s50, s50, 16
v_and_b32 v12, 15, v1
v_lshrrev_b32 v13, 4, v1
s_cmp_lt_u32 s36, 4
s_cbranch_scc1 Lcons_7
Lprod_3:
s_sub_u32 s47, s36, 4
s_lshl_b32 s43, s34, 7
s_lshl_b32 s44, s35, 3
s_add_u32 s63, s43, s44
s_lshl_b32 s44, s47, 1
s_add_u32 s51, s63, s44
v_lshlrev_b32 v10, 4, v1
v_lshrrev_b32 v14, 3, v1
v_and_b32 v15, 7, v1
v_lshl_add_u32 v19, v14, 6, v15
s_lshl_b32 s43, s48, 3
v_add_u32 v19, s43, v19
v_mul_u32_u24 v19, 6144, v19
s_cmp_eq_u32 s47, 3
s_cbranch_scc1 Lpf_4
v_and_b32 v16, 2, v14
v_xor_b32 v16, v15, v16
v_lshlrev_b32 v16, 4, v16
v_mul_u32_u24 v17, 6144, v14
s_lshl_b32 s43, s47, 11
v_add3_u32 v2, v17, v16, s43
v_xor_b32 v3, 64, v2
v_lshrrev_b32 v16, 1, v14
v_xor_b32 v16, v15, v16
v_lshlrev_b32 v16, 4, v16
s_lshl_b32 s43, s47, 3
s_add_u32 s43, s43, s50
v_add_u32 v17, s43, v14
s_and_b32 s44, s47, 1
s_lshl_b32 s44, s44, 6
v_add_u32 v18, 0, v17
v_max_i32 v18, 0, v18
v_lshl_add_u32 v18, v18, 11, v16
v_xor_b32 v18, s44, v18
v_mov_b32 v4, v18
v_add_u32 v18, 24, v17
v_max_i32 v18, 0, v18
v_lshl_add_u32 v18, v18, 11, v16
v_xor_b32 v18, s44, v18
v_xor_b32 v5, 64, v18
v_add_u32 v18, 48, v17
v_max_i32 v18, 0, v18
v_lshl_add_u32 v18, v18, 11, v16
v_xor_b32 v18, s44, v18
v_mov_b32 v6, v18
v_add_u32 v18, 72, v17
v_max_i32 v18, 0, v18
v_lshl_add_u32 v18, v18, 11, v16
v_xor_b32 v18, s44, v18
v_xor_b32 v7, 64, v18
v_add_u32 v18, 96, v17
v_max_i32 v18, 0, v18
v_lshl_add_u32 v18, v18, 11, v16
v_xor_b32 v18, s44, v18
v_mov_b32 v8, v18
v_add_u32 v18, 120, v17
v_max_i32 v18, 0, v18
v_lshl_add_u32 v18, v18, 11, v16
v_xor_b32 v18, s44, v18
v_xor_b32 v9, 64, v18
s_lshl_b32 s39, s47, 10
s_lshl_b32 s40, s47, 13
s_add_u32 s40, s40, 18432
s_mov_b32 s37, 0
s_mov_b32 s38, 0
s_bfm_b64 s[60:61], 56, 8
s_cmp_eq_u32 s47, 0
s_cselect_b64 s[60:61], s[60:61], -1
s_lshl_b32 s43, s35, 7
s_waitcnt lgkmcnt(0)
s_mov_b32 s8, s64
s_mov_b32 s9, s65
s_mov_b32 s10, 4194304
s_mov_b32 s11, 0x20000
s_add_u32 s12, s66, s43
s_addc_u32 s13, s67, 0
s_mov_b32 s14, 6289536
s_mov_b32 s15, 0x20000
s_add_u32 m0, s39, 0
s_mov_b64 exec, s[60:61]
buffer_load_dwordx4 v4, s[8:11], s37 offen lds
s_mov_b64 exec, -1
s_add_u32 m0, s39, 3072
s_nop 0
buffer_load_dwordx4 v5, s[8:11], s37 offen lds
s_add_u32 m0, s39, 6144
s_nop 0
buffer_load_dwordx4 v6, s[8:11], s37 offen lds
s_add_u32 m0, s39, 9216
s_nop 0
buffer_load_dwordx4 v7, s[8:11], s37 offen lds
s_add_u32 m0, s39, 12288
s_nop 0
buffer_load_dwordx4 v8, s[8:11], s37 offen lds
s_add_u32 m0, s39, 15360
s_nop 0
buffer_load_dwordx4 v9, s[8:11], s37 offen lds
s_add_u32 m0, s40, 0
s_add_u32 s43, s38, 0
buffer_load_dwordx4 v2, s[12:15], s43 offen lds
s_add_u32 m0, s40, 1024
s_add_u32 s43, s38, 49152
buffer_load_dwordx4 v3, s[12:15], s43 offen lds
s_add_u32 m0, s40, 2048
s_add_u32 s43, s38, 98304
buffer_load_dwordx4 v2, s[12:15], s43 offen lds
s_add_u32 m0, s40, 3072
s_add_u32 s43, s38, 147456
buffer_load_dwordx4 v3, s[12:15], s43 offen lds
s_add_u32 m0, s40, 4096
s_add_u32 s43, s38, 196608
buffer_load_dwordx4 v2, s[12:15], s43 offen lds
s_add_u32 m0, s40, 5120
s_add_u32 s43, s38, 245760
buffer_load_dwordx4 v3, s[12:15], s43 offen lds
s_add_u32 m0, s40, 6144
s_add_u32 s43, s38, 294912
buffer_load_dwordx4 v2, s[12:15], s43 offen lds
s_add_u32 m0, s40, 7168
s_add_u32 s43, s38, 344064
buffer_load_dwordx4 v3, s[12:15], s43 offen lds
s_add_u32 s37, s37, 128
s_add_u32 s38, s38, 393216
s_mov_b32 s28, s66
s_mov_b32 s29, s67
s_mov_b32 s30, 6291456
s_mov_b32 s31, 0x20000
s_mul_i32 s43, s2, 4608
s_add_u32 s43, s43, 393216
v_lshlrev_b32 v30, 7, v1
s_mul_i32 s44, s47, 1536
s_add_u32 s43, s43, s44
s_bfm_b64 exec, 12, 0
buffer_load_dword v31, v30, s[28:31], s43 offen
s_mov_b64 exec, -1
s_lshl_b32 s43, s51, 11
buffer_load_dwordx4 v[96:99], v10, s[8:11], s43 offen offset:0
buffer_load_dwordx4 v[100:103], v10, s[8:11], s43 offen offset:1024
buffer_load_dwordx4 v[104:107], v10, s[8:11], s43 offen offset:2048
buffer_load_dwordx4 v[108:111], v10, s[8:11], s43 offen offset:3072
s_add_u32 m0, s39, 43008
s_mov_b64 exec, s[60:61]
buffer_load_dwordx4 v4, s[8:11], s37 offen lds
s_mov_b64 exec, -1
s_add_u32 m0, s39, 46080
s_nop 0
buffer_load_dwordx4 v5, s[8:11], s37 offen lds
s_add_u32 m0, s39, 49152
s_nop 0
buffer_load_dwordx4 v6, s[8:11], s37 offen lds
s_add_u32 m0, s39, 52224
s_nop 0
buffer_load_dwordx4 v7, s[8:11], s37 offen lds
s_add_u32 m0, s39, 55296
s_nop 0
buffer_load_dwordx4 v8, s[8:11], s37 offen lds
s_add_u32 m0, s39, 58368
s_nop 0
buffer_load_dwordx4 v9, s[8:11], s37 offen lds
s_add_u32 m0, s40, 43008
s_add_u32 s43, s38, 0
buffer_load_dwordx4 v2, s[12:15], s43 offen lds
s_add_u32 m0, s40, 44032
s_add_u32 s43, s38, 49152
buffer_load_dwordx4 v3, s[12:15], s43 offen lds
s_add_u32 m0, s40, 45056
s_add_u32 s43, s38, 98304
buffer_load_dwordx4 v2, s[12:15], s43 offen lds
s_add_u32 m0, s40, 46080
s_add_u32 s43, s38, 147456
buffer_load_dwordx4 v3, s[12:15], s43 offen lds
s_add_u32 m0, s40, 47104
s_add_u32 s43, s38, 196608
buffer_load_dwordx4 v2, s[12:15], s43 offen lds
s_add_u32 m0, s40, 48128
s_add_u32 s43, s38, 245760
buffer_load_dwordx4 v3, s[12:15], s43 offen lds
s_add_u32 m0, s40, 49152
s_add_u32 s43, s38, 294912
buffer_load_dwordx4 v2, s[12:15], s43 offen lds
s_add_u32 m0, s40, 50176
s_add_u32 s43, s38, 344064
buffer_load_dwordx4 v3, s[12:15], s43 offen lds
s_add_u32 s37, s37, 128
s_add_u32 s38, s38, 393216
s_waitcnt vmcnt(19)
s_barrier
s_add_u32 m0, s39, 86016
s_mov_b64 exec, s[60:61]
buffer_load_dwordx4 v4, s[8:11], s37 offen lds
s_mov_b64 exec, -1
s_add_u32 m0, s39, 89088
s_nop 0
buffer_load_dwordx4 v5, s[8:11], s37 offen lds
s_add_u32 m0, s39, 92160
s_nop 0
buffer_load_dwordx4 v6, s[8:11], s37 offen lds
s_add_u32 m0, s39, 95232
s_nop 0
buffer_load_dwordx4 v7, s[8:11], s37 offen lds
s_add_u32 m0, s39, 98304
s_nop 0
buffer_load_dwordx4 v8, s[8:11], s37 offen lds
s_add_u32 m0, s39, 101376
s_nop 0
buffer_load_dwordx4 v9, s[8:11], s37 offen lds
s_add_u32 m0, s40, 86016
s_add_u32 s43, s38, 0
buffer_load_dwordx4 v2, s[12:15], s43 offen lds
s_add_u32 m0, s40, 87040
s_add_u32 s43, s38, 49152
buffer_load_dwordx4 v3, s[12:15], s43 offen lds
s_add_u32 m0, s40, 88064
s_add_u32 s43, s38, 98304
buffer_load_dwordx4 v2, s[12:15], s43 offen lds
s_add_u32 m0, s40, 89088
s_add_u32 s43, s38, 147456
buffer_load_dwordx4 v3, s[12:15], s43 offen lds
s_add_u32 m0, s40, 90112
s_add_u32 s43, s38, 196608
buffer_load_dwordx4 v2, s[12:15], s43 offen lds
s_add_u32 m0, s40, 91136
s_add_u32 s43, s38, 245760
buffer_load_dwordx4 v3, s[12:15], s43 offen lds
s_add_u32 m0, s40, 92160
s_add_u32 s43, s38, 294912
buffer_load_dwordx4 v2, s[12:15], s43 offen lds
s_add_u32 m0, s40, 93184
s_add_u32 s43, s38, 344064
buffer_load_dwordx4 v3, s[12:15], s43 offen lds
s_add_u32 s37, s37, 128
s_add_u32 s38, s38, 393216
s_waitcnt vmcnt(28)
s_mov_b32 s43, 0x3f803f80
v_mov_b32 v116, 0
v_mov_b32 v117, 0
v_mov_b32 v118, 0
v_mov_b32 v119, 0
v_mov_b32 v120, 0
v_mov_b32 v121, 0
v_mov_b32 v122, 0
v_mov_b32 v123, 0
v_dot2_f32_bf16 v116, v96, s43, v116
v_dot2_f32_bf16 v120, v96, v96, v120
v_dot2_f32_bf16 v118, v104, s43, v118
v_dot2_f32_bf16 v122, v104, v104, v122
v_dot2_f32_bf16 v117, v97, s43, v117
v_dot2_f32_bf16 v121, v97, v97, v121
v_dot2_f32_bf16 v119, v105, s43, v119
v_dot2_f32_bf16 v123, v105, v105, v123
v_dot2_f32_bf16 v116, v98, s43, v116
v_dot2_f32_bf16 v120, v98, v98, v120
v_dot2_f32_bf16 v118, v106, s43, v118
v_dot2_f32_bf16 v122, v106, v106, v122
v_dot2_f32_bf16 v117, v99, s43, v117
v_dot2_f32_bf16 v121, v99, v99, v121
v_dot2_f32_bf16 v119, v107, s43, v119
v_dot2_f32_bf16 v123, v107, v107, v123
v_dot2_f32_bf16 v116, v100, s43, v116
v_dot2_f32_bf16 v120, v100, v100, v120
v_dot2_f32_bf16 v118, v108, s43, v118
v_dot2_f32_bf16 v122, v108, v108, v122
v_dot2_f32_bf16 v117, v101, s43, v117
v_dot2_f32_bf16 v121, v101, v101, v121
v_dot2_f32_bf16 v119, v109, s43, v119
v_dot2_f32_bf16 v123, v109, v109, v123
v_dot2_f32_bf16 v116, v102, s43, v116
v_dot2_f32_bf16 v120, v102, v102, v120
v_dot2_f32_bf16 v118, v110, s43, v118
v_dot2_f32_bf16 v122, v110, v110, v122
v_dot2_f32_bf16 v117, v103, s43, v117
v_dot2_f32_bf16 v121, v103, v103, v121
v_dot2_f32_bf16 v119, v111, s43, v119
v_dot2_f32_bf16 v123, v111, v111, v123
s_nop 2
v_add_f32 v116, v116, v117
v_add_f32 v118, v118, v119
v_add_f32 v120, v120, v121
v_add_f32 v122, v122, v123
s_nop 1
v_permlane32_swap_b32 v116, v118
v_permlane32_swap_b32 v120, v122
v_add_f32 v116, v116, v118
v_add_f32 v120, v120, v122
s_nop 1
v_permlane16_swap_b32 v116, v120
v_add_f32 v116, v116, v120
s_nop 1
v_add_f32_dpp v116, v116, v116 row_ror:8 row_mask:0xf bank_mask:0xf
s_nop 1
v_add_f32_dpp v116, v116, v116 row_ror:4 row_mask:0xf bank_mask:0xf
s_nop 1
v_add_f32_dpp v116, v116, v116 row_ror:2 row_mask:0xf bank_mask:0xf
s_nop 1
v_add_f32_dpp v116, v116, v116 row_ror:1 row_mask:0xf bank_mask:0xf
v_mov_b32 v117, v116
s_nop 1
v_permlane16_swap_b32 v116, v117
v_mul_f32 v112, 0x3a800000, v116
v_mul_f32 v113, 0x3a800000, v117
v_fma_f32 v113, -v112, v112, v113
v_max_f32 v113, 0, v113
v_add_f32 v113, 0x3727c5ac, v113
v_rsq_f32 v113, v113
v_lshrrev_b32 v11, 5, v1
s_lshl_b32 s43, s47, 4
s_add_u32 s43, s43, 148608
v_lshl_add_u32 v11, v11, 3, s43
ds_write_b64 v11, v[112:113]
s_waitcnt lgkmcnt(0)
s_and_b32 s44, s36, 3
s_mul_i32 s44, s44, 24
s_bfe_u32 s43, s2, 0x30001
s_lshl_b32 s43, s43, 7
s_add_u32 s44, s44, s43
s_mul_i32 s44, s44, 7168
s_lshr_b32 s43, s2, 4
s_lshl_b32 s43, s43, 8
s_add_u32 s43, s43, s44
s_bitcmp0_b32 s2, 0
s_cselect_b32 s4, s72, s74
s_cselect_b32 s5, s73, s75
s_add_u32 s4, s4, s43
s_addc_u32 s5, s5, 0
s_waitcnt vmcnt(14)
s_barrier
s_add_u32 m0, s39, 0
s_mov_b64 exec, s[60:61]
buffer_load_dwordx4 v4, s[8:11], s37 offen lds
s_mov_b64 exec, -1
s_add_u32 m0, s39, 3072
s_nop 0
buffer_load_dwordx4 v5, s[8:11], s37 offen lds
s_add_u32 m0, s39, 6144
s_nop 0
buffer_load_dwordx4 v6, s[8:11], s37 offen lds
s_add_u32 m0, s39, 9216
s_nop 0
buffer_load_dwordx4 v7, s[8:11], s37 offen lds
s_add_u32 m0, s39, 12288
s_nop 0
buffer_load_dwordx4 v8, s[8:11], s37 offen lds
s_add_u32 m0, s39, 15360
s_nop 0
buffer_load_dwordx4 v9, s[8:11], s37 offen lds
s_add_u32 m0, s40, 0
s_add_u32 s43, s38, 0
buffer_load_dwordx4 v2, s[12:15], s43 offen lds
s_add_u32 m0, s40, 1024
s_add_u32 s43, s38, 49152
buffer_load_dwordx4 v3, s[12:15], s43 offen lds
s_add_u32 m0, s40, 2048
s_add_u32 s43, s38, 98304
buffer_load_dwordx4 v2, s[12:15], s43 offen lds
s_add_u32 m0, s40, 3072
s_add_u32 s43, s38, 147456
buffer_load_dwordx4 v3, s[12:15], s43 offen lds
s_add_u32 m0, s40, 4096
s_add_u32 s43, s38, 196608
buffer_load_dwordx4 v2, s[12:15], s43 offen lds
s_add_u32 m0, s40, 5120
s_add_u32 s43, s38, 245760
buffer_load_dwordx4 v3, s[12:15], s43 offen lds
s_add_u32 m0, s40, 6144
s_add_u32 s43, s38, 294912
buffer_load_dwordx4 v2, s[12:15], s43 offen lds
s_add_u32 m0, s40, 7168
s_add_u32 s43, s38, 344064
buffer_load_dwordx4 v3, s[12:15], s43 offen lds
s_add_u32 s37, s37, 128
s_add_u32 s38, s38, 393216
s_waitcnt vmcnt(14)
s_barrier
s_add_u32 m0, s39, 43008
s_mov_b64 exec, s[60:61]
buffer_load_dwordx4 v4, s[8:11], s37 offen lds
s_mov_b64 exec, -1
s_add_u32 m0, s39, 46080
s_nop 0
buffer_load_dwordx4 v5, s[8:11], s37 offen lds
s_add_u32 m0, s39, 49152
s_nop 0
buffer_load_dwordx4 v6, s[8:11], s37 offen lds
s_add_u32 m0, s39, 52224
s_nop 0
buffer_load_dwordx4 v7, s[8:11], s37 offen lds
s_add_u32 m0, s39, 55296
s_nop 0
buffer_load_dwordx4 v8, s[8:11], s37 offen lds
s_add_u32 m0, s39, 58368
s_nop 0
buffer_load_dwordx4 v9, s[8:11], s37 offen lds
s_add_u32 m0, s40, 43008
s_add_u32 s43, s38, 0
buffer_load_dwordx4 v2, s[12:15], s43 offen lds
s_add_u32 m0, s40, 44032
s_add_u32 s43, s38, 49152
buffer_load_dwordx4 v3, s[12:15], s43 offen lds
s_add_u32 m0, s40, 45056
s_add_u32 s43, s38, 98304
buffer_load_dwordx4 v2, s[12:15], s43 offen lds
s_add_u32 m0, s40, 46080
s_add_u32 s43, s38, 147456
buffer_load_dwordx4 v3, s[12:15], s43 offen lds
s_add_u32 m0, s40, 47104
s_add_u32 s43, s38, 196608
buffer_load_dwordx4 v2, s[12:15], s43 offen lds
s_add_u32 m0, s40, 48128
s_add_u32 s43, s38, 245760
buffer_load_dwordx4 v3, s[12:15], s43 offen lds
s_add_u32 m0, s40, 49152
s_add_u32 s43, s38, 294912
buffer_load_dwordx4 v2, s[12:15], s43 offen lds
s_add_u32 m0, s40, 50176
s_add_u32 s43, s38, 344064
buffer_load_dwordx4 v3, s[12:15], s43 offen lds
s_add_u32 s37, s37, 128
s_add_u32 s38, s38, 393216
s_waitcnt lgkmcnt(0)
s_load_dword s3, s[4:5], 0
s_load_dword s3, s[4:5], 64
s_load_dword s3, s[4:5], 128
s_load_dword s3, s[4:5], 192
s_load_dword s3, s[4:5], 7168
s_load_dword s3, s[4:5], 7232
s_load_dword s3, s[4:5], 7296
s_load_dword s3, s[4:5], 7360
s_load_dword s3, s[4:5], 14336
s_load_dword s3, s[4:5], 14400
s_load_dword s3, s[4:5], 14464
s_load_dword s3, s[4:5], 14528
s_load_dword s3, s[4:5], 21504
s_load_dword s3, s[4:5], 21568
s_waitcnt vmcnt(14)
s_barrier
s_add_u32 m0, s39, 86016
s_mov_b64 exec, s[60:61]
buffer_load_dwordx4 v4, s[8:11], s37 offen lds
s_mov_b64 exec, -1
s_add_u32 m0, s39, 89088
s_nop 0
buffer_load_dwordx4 v5, s[8:11], s37 offen lds
s_add_u32 m0, s39, 92160
s_nop 0
buffer_load_dwordx4 v6, s[8:11], s37 offen lds
s_add_u32 m0, s39, 95232
s_nop 0
buffer_load_dwordx4 v7, s[8:11], s37 offen lds
s_add_u32 m0, s39, 98304
s_nop 0
buffer_load_dwordx4 v8, s[8:11], s37 offen lds
s_add_u32 m0, s39, 101376
s_nop 0
buffer_load_dwordx4 v9, s[8:11], s37 offen lds
s_add_u32 m0, s40, 86016
s_add_u32 s43, s38, 0
buffer_load_dwordx4 v2, s[12:15], s43 offen lds
s_add_u32 m0, s40, 87040
s_add_u32 s43, s38, 49152
buffer_load_dwordx4 v3, s[12:15], s43 offen lds
s_add_u32 m0, s40, 88064
s_add_u32 s43, s38, 98304
buffer_load_dwordx4 v2, s[12:15], s43 offen lds
s_add_u32 m0, s40, 89088
s_add_u32 s43, s38, 147456
buffer_load_dwordx4 v3, s[12:15], s43 offen lds
s_add_u32 m0, s40, 90112
s_add_u32 s43, s38, 196608
buffer_load_dwordx4 v2, s[12:15], s43 offen lds
s_add_u32 m0, s40, 91136
s_add_u32 s43, s38, 245760
buffer_load_dwordx4 v3, s[12:15], s43 offen lds
s_add_u32 m0, s40, 92160
s_add_u32 s43, s38, 294912
buffer_load_dwordx4 v2, s[12:15], s43 offen lds
s_add_u32 m0, s40, 93184
s_add_u32 s43, s38, 344064
buffer_load_dwordx4 v3, s[12:15], s43 offen lds
s_add_u32 s37, s37, 128
s_add_u32 s38, s38, 393216
s_waitcnt vmcnt(14)
s_barrier
s_add_u32 m0, s39, 0
s_mov_b64 exec, s[60:61]
buffer_load_dwordx4 v4, s[8:11], s37 offen lds
s_mov_b64 exec, -1
s_add_u32 m0, s39, 3072
s_nop 0
buffer_load_dwordx4 v5, s[8:11], s37 offen lds
s_add_u32 m0, s39, 6144
s_nop 0
buffer_load_dwordx4 v6, s[8:11], s37 offen lds
s_add_u32 m0, s39, 9216
s_branch Lov_0
.p2align 12
Lst_0_0:
s_branch Lwr_139
s_nop 0
s_nop 0
Lov_0:
s_nop 0
buffer_load_dwordx4 v7, s[8:11], s37 offen lds
s_add_u32 m0, s39, 12288
s_nop 0
buffer_load_dwordx4 v8, s[8:11], s37 offen lds
s_add_u32 m0, s39, 15360
s_nop 0
buffer_load_dwordx4 v9, s[8:11], s37 offen lds
s_add_u32 m0, s40, 0
s_add_u32 s43, s38, 0
buffer_load_dwordx4 v2, s[12:15], s43 offen lds
s_add_u32 m0, s40, 1024
s_add_u32 s43, s38, 49152
buffer_load_dwordx4 v3, s[12:15], s43 offen lds
s_add_u32 m0, s40, 2048
s_add_u32 s43, s38, 98304
buffer_load_dwordx4 v2, s[12:15], s43 offen lds
s_add_u32 m0, s40, 3072
s_add_u32 s43, s38, 147456
buffer_load_dwordx4 v3, s[12:15], s43 offen lds
s_add_u32 m0, s40, 4096
s_add_u32 s43, s38, 196608
buffer_load_dwordx4 v2, s[12:15], s43 offen lds
s_add_u32 m0, s40, 5120
s_add_u32 s43, s38, 245760
buffer_load_dwordx4 v3, s[12:15], s43 offen lds
s_add_u32 m0, s40, 6144
s_add_u32 s43, s38, 294912
buffer_load_dwordx4 v2, s[12:15], s43 offen lds
s_add_u32 m0, s40, 7168
s_add_u32 s43, s38, 344064
buffer_load_dwordx4 v3, s[12:15], s43 offen lds
s_add_u32 s37, s37, 128
s_add_u32 s38, s38, 393216
s_waitcnt lgkmcnt(0)
s_load_dword s3, s[4:5], 21632
s_load_dword s3, s[4:5], 21696
s_load_dword s3, s[4:5], 28672
s_load_dword s3, s[4:5], 28736
s_load_dword s3, s[4:5], 28800
s_load_dword s3, s[4:5], 28864
s_load_dword s3, s[4:5], 35840
s_load_dword s3, s[4:5], 35904
s_load_dword s3, s[4:5], 35968
s_load_dword s3, s[4:5], 36032
s_load_dword s3, s[4:5], 43008
s_load_dword s3, s[4:5], 43072
s_load_dword s3, s[4:5], 43136
s_load_dword s3, s[4:5], 43200
s_waitcnt vmcnt(14)
s_barrier
s_add_u32 m0, s39, 43008
s_mov_b64 exec, s[60:61]
buffer_load_dwordx4 v4, s[8:11], s37 offen lds
s_mov_b64 exec, -1
s_add_u32 m0, s39, 46080
s_nop 0
buffer_load_dwordx4 v5, s[8:11], s37 offen lds
s_add_u32 m0, s39, 49152
s_nop 0
buffer_load_dwordx4 v6, s[8:11], s37 offen lds
s_add_u32 m0, s39, 52224
s_nop 0
buffer_load_dwordx4 v7, s[8:11], s37 offen lds
s_add_u32 m0, s39, 55296
s_nop 0
buffer_load_dwordx4 v8, s[8:11], s37 offen lds
s_add_u32 m0, s39, 58368
s_nop 0
buffer_load_dwordx4 v9, s[8:11], s37 offen lds
s_add_u32 m0, s40, 43008
s_add_u32 s43, s38, 0
buffer_load_dwordx4 v2, s[12:15], s43 offen lds
s_add_u32 m0, s40, 44032
s_add_u32 s43, s38, 49152
buffer_load_dwordx4 v3, s[12:15], s43 offen lds
s_add_u32 m0, s40, 45056
s_add_u32 s43, s38, 98304
buffer_load_dwordx4 v2, s[12:15], s43 offen lds
s_add_u32 m0, s40, 46080
s_add_u32 s43, s38, 147456
buffer_load_dwordx4 v3, s[12:15], s43 offen lds
s_add_u32 m0, s40, 47104
s_add_u32 s43, s38, 196608
buffer_load_dwordx4 v2, s[12:15], s43 offen lds
s_add_u32 m0, s40, 48128
s_add_u32 s43, s38, 245760
buffer_load_dwordx4 v3, s[12:15], s43 offen lds
s_add_u32 m0, s40, 49152
s_add_u32 s43, s38, 294912
buffer_load_dwordx4 v2, s[12:15], s43 offen lds
s_add_u32 m0, s40, 50176
s_add_u32 s43, s38, 344064
buffer_load_dwordx4 v3, s[12:15], s43 offen lds
s_add_u32 s37, s37, 128
s_add_u32 s38, s38, 393216
s_waitcnt vmcnt(14)
s_barrier
s_add_u32 m0, s39, 86016
s_mov_b64 exec, s[60:61]
buffer_load_dwordx4 v4, s[8:11], s37 offen lds
s_mov_b64 exec, -1
s_add_u32 m0, s39, 89088
s_nop 0
buffer_load_dwordx4 v5, s[8:11], s37 offen lds
s_add_u32 m0, s39, 92160
s_nop 0
buffer_load_dwordx4 v6, s[8:11], s37 offen lds
s_add_u32 m0, s39, 95232
s_nop 0
buffer_load_dwordx4 v7, s[8:11], s37 offen lds
s_add_u32 m0, s39, 98304
s_nop 0
buffer_load_dwordx4 v8, s[8:11], s37 offen lds
s_add_u32 m0, s39, 101376
s_nop 0
buffer_load_dwordx4 v9, s[8:11], s37 offen lds
s_add_u32 m0, s40, 86016
s_add_u32 s43, s38, 0
buffer_load_dwordx4 v2, s[12:15], s43 offen lds
s_add_u32 m0, s40, 87040
s_add_u32 s43, s38, 49152
buffer_load_dwordx4 v3, s[12:15], s43 offen lds
s_add_u32 m0, s40, 88064
s_add_u32 s43, s38, 98304
buffer_load_dwordx4 v2, s[12:15], s43 offen lds
s_add_u32 m0, s40, 89088
s_add_u32 s43, s38, 147456
buffer_load_dwordx4 v3, s[12:15], s43 offen lds
s_add_u32 m0, s40, 90112
s_add_u32 s43, s38, 196608
buffer_load_dwordx4 v2, s[12:15], s43 offen lds
s_add_u32 m0, s40, 91136
s_add_u32 s43, s38, 245760
buffer_load_dwordx4 v3, s[12:15], s43 offen lds
s_add_u32 m0, s40, 92160
s_add_u32 s43, s38, 294912
buffer_load_dwordx4 v2, s[12:15], s43 offen lds
s_add_u32 m0, s40, 93184
s_add_u32 s43, s38, 344064
buffer_load_dwordx4 v3, s[12:15], s43 offen lds
s_add_u32 s37, s37, 128
s_add_u32 s38, s38, 393216
s_waitcnt lgkmcnt(0)
s_load_dword s3, s[4:5], 50176
s_load_dword s3, s[4:5], 50240
s_load_dword s3, s[4:5], 50304
s_load_dword s3, s[4:5], 50368
s_load_dword s3, s[4:5], 57344
s_load_dword s3, s[4:5], 57408
s_load_dword s3, s[4:5], 57472
s_load_dword s3, s[4:5], 57536
s_load_dword s3, s[4:5], 64512
s_load_dword s3, s[4:5], 64576
s_load_dword s3, s[4:5], 64640
s_load_dword s3, s[4:5], 64704
s_load_dword s3, s[4:5], 71680
s_load_dword s3, s[4:5], 71744
s_waitcnt vmcnt(14)
s_barrier
s_add_u32 m0, s39, 0
s_mov_b64 exec, s[60:61]
buffer_load_dwordx4 v4, s[8:11], s37 offen lds
s_mov_b64 exec, -1
s_add_u32 m0, s39, 3072
s_nop 0
buffer_load_dwordx4 v5, s[8:11], s37 offen lds
s_add_u32 m0, s39, 6144
s_nop 0
buffer_load_dwordx4 v6, s[8:11], s37 offen lds
s_add_u32 m0, s39, 9216
s_nop 0
buffer_load_dwordx4 v7, s[8:11], s37 offen lds
s_add_u32 m0, s39, 12288
s_nop 0
buffer_load_dwordx4 v8, s[8:11], s37 offen lds
s_add_u32 m0, s39, 15360
s_nop 0
buffer_load_dwordx4 v9, s[8:11], s37 offen lds
s_add_u32 m0, s40, 0
s_add_u32 s43, s38, 0
buffer_load_dwordx4 v2, s[12:15], s43 offen lds
s_add_u32 m0, s40, 1024
s_add_u32 s43, s38, 49152
buffer_load_dwordx4 v3, s[12:15], s43 offen lds
s_add_u32 m0, s40, 2048
s_add_u32 s43, s38, 98304
buffer_load_dwordx4 v2, s[12:15], s43 offen lds
s_add_u32 m0, s40, 3072
s_add_u32 s43, s38, 147456
buffer_load_dwordx4 v3, s[12:15], s43 offen lds
s_add_u32 m0, s40, 4096
s_add_u32 s43, s38, 196608
buffer_load_dwordx4 v2, s[12:15], s43 offen lds
s_add_u32 m0, s40, 5120
s_add_u32 s43, s38, 245760
buffer_load_dwordx4 v3, s[12:15], s43 offen lds
s_add_u32 m0, s40, 6144
s_add_u32 s43, s38, 294912
buffer_load_dwordx4 v2, s[12:15], s43 offen lds
s_add_u32 m0, s40, 7168
s_add_u32 s43, s38, 344064
buffer_load_dwordx4 v3, s[12:15], s43 offen lds
s_add_u32 s37, s37, 128
s_add_u32 s38, s38, 393216
s_waitcnt vmcnt(14)
s_barrier
s_add_u32 m0, s39, 43008
s_mov_b64 exec, s[60:61]
buffer_load_dwordx4 v4, s[8:11], s37 offen lds
s_mov_b64 exec, -1
s_add_u32 m0, s39, 46080
s_nop 0
buffer_load_dwordx4 v5, s[8:11], s37 offen lds
s_add_u32 m0, s39, 49152
s_nop 0
buffer_load_dwordx4 v6, s[8:11], s37 offen lds
s_add_u32 m0, s39, 52224
s_nop 0
buffer_load_dwordx4 v7, s[8:11], s37 offen lds
s_add_u32 m0, s39, 55296
s_nop 0
buffer_load_dwordx4 v8, s[8:11], s37 offen lds
s_add_u32 m0, s39, 58368
s_nop 0
buffer_load_dwordx4 v9, s[8:11], s37 offen lds
s_add_u32 m0, s40, 43008
s_add_u32 s43, s38, 0
buffer_load_dwordx4 v2, s[12:15], s43 offen lds
s_add_u32 m0, s40, 44032
s_add_u32 s43, s38, 49152
buffer_load_dwordx4 v3, s[12:15], s43 offen lds
s_add_u32 m0, s40, 45056
s_add_u32 s43, s38, 98304
buffer_load_dwordx4 v2, s[12:15], s43 offen lds
s_add_u32 m0, s40, 46080
s_add_u32 s43, s38, 147456
buffer_load_dwordx4 v3, s[12:15], s43 offen lds
s_add_u32 m0, s40, 47104
s_add_u32 s43, s38, 196608
buffer_load_dwordx4 v2, s[12:15], s43 offen lds
s_add_u32 m0, s40, 48128
s_add_u32 s43, s38, 245760
buffer_load_dwordx4 v3, s[12:15], s43 offen lds
s_add_u32 m0, s40, 49152
s_add_u32 s43, s38, 294912
buffer_load_dwordx4 v2, s[12:15], s43 offen lds
s_add_u32 m0, s40, 50176
s_add_u32 s43, s38, 344064
buffer_load_dwordx4 v3, s[12:15], s43 offen lds
s_add_u32 s37, s37, 128
s_add_u32 s38, s38, 393216
s_waitcnt lgkmcnt(0)
s_load_dword s3, s[4:5], 71808
s_load_dword s3, s[4:5], 71872
s_load_dword s3, s[4:5], 78848
s_load_dword s3, s[4:5], 78912
s_load_dword s3, s[4:5], 78976
s_load_dword s3, s[4:5], 79040
s_load_dword s3, s[4:5], 86016
s_load_dword s3, s[4:5], 86080
s_load_dword s3, s[4:5], 86144
s_load_dword s3, s[4:5], 86208
s_load_dword s3, s[4:5], 93184
s_load_dword s3, s[4:5], 93248
s_load_dword s3, s[4:5], 93312
s_load_dword s3, s[4:5], 93376
s_waitcnt vmcnt(14)
s_barrier
s_add_u32 m0, s39, 86016
s_mov_b64 exec, s[60:61]
buffer_load_dwordx4 v4, s[8:11], s37 offen lds
s_mov_b64 exec, -1
s_add_u32 m0, s39, 89088
s_nop 0
buffer_load_dwordx4 v5, s[8:11], s37 offen lds
s_add_u32 m0, s39, 92160
s_nop 0
buffer_load_dwordx4 v6, s[8:11], s37 offen lds
s_add_u32 m0, s39, 95232
s_nop 0
buffer_load_dwordx4 v7, s[8:11], s37 offen lds
s_add_u32 m0, s39, 98304
s_nop 0
buffer_load_dwordx4 v8, s[8:11], s37 offen lds
s_add_u32 m0, s39, 101376
s_nop 0
buffer_load_dwordx4 v9, s[8:11], s37 offen lds
s_add_u32 m0, s40, 86016
s_add_u32 s43, s38, 0
buffer_load_dwordx4 v2, s[12:15], s43 offen lds
s_add_u32 m0, s40, 87040
s_add_u32 s43, s38, 49152
buffer_load_dwordx4 v3, s[12:15], s43 offen lds
s_add_u32 m0, s40, 88064
s_add_u32 s43, s38, 98304
buffer_load_dwordx4 v2, s[12:15], s43 offen lds
s_add_u32 m0, s40, 89088
s_add_u32 s43, s38, 147456
buffer_load_dwordx4 v3, s[12:15], s43 offen lds
s_add_u32 m0, s40, 90112
s_add_u32 s43, s38, 196608
buffer_load_dwordx4 v2, s[12:15], s43 offen lds
s_add_u32 m0, s40, 91136
s_add_u32 s43, s38, 245760
buffer_load_dwordx4 v3, s[12:15], s43 offen lds
s_add_u32 m0, s40, 92160
s_add_u32 s43, s38, 294912
buffer_load_dwordx4 v2, s[12:15], s43 offen lds
s_add_u32 m0, s40, 93184
s_add_u32 s43, s38, 344064
buffer_load_dwordx4 v3, s[12:15], s43 offen lds
s_add_u32 s37, s37, 128
s_add_u32 s38, s38, 393216
s_waitcnt vmcnt(14)
s_barrier
s_add_u32 m0, s39, 0
s_mov_b64 exec, s[60:61]
buffer_load_dwordx4 v4, s[8:11], s37 offen lds
s_mov_b64 exec, -1
s_add_u32 m0, s39, 3072
s_nop 0
buffer_load_dwordx4 v5, s[8:11], s37 offen lds
s_add_u32 m0, s39, 6144
s_nop 0
buffer_load_dwordx4 v6, s[8:11], s37 offen lds
s_add_u32 m0, s39, 9216
s_nop 0
buffer_load_dwordx4 v7, s[8:11], s37 offen lds
s_add_u32 m0, s39, 12288
s_nop 0
buffer_load_dwordx4 v8, s[8:11], s37 offen lds
s_add_u32 m0, s39, 15360
s_nop 0
buffer_load_dwordx4 v9, s[8:11], s37 offen lds
s_add_u32 m0, s40, 0
s_add_u32 s43, s38, 0
buffer_load_dwordx4 v2, s[12:15], s43 offen lds
s_add_u32 m0, s40, 1024
s_add_u32 s43, s38, 49152
buffer_load_dwordx4 v3, s[12:15], s43 offen lds
s_add_u32 m0, s40, 2048
s_add_u32 s43, s38, 98304
buffer_load_dwordx4 v2, s[12:15], s43 offen lds
s_add_u32 m0, s40, 3072
s_add_u32 s43, s38, 147456
buffer_load_dwordx4 v3, s[12:15], s43 offen lds
s_add_u32 m0, s40, 4096
s_add_u32 s43, s38, 196608
buffer_load_dwordx4 v2, s[12:15], s43 offen lds
s_add_u32 m0, s40, 5120
s_add_u32 s43, s38, 245760
buffer_load_dwordx4 v3, s[12:15], s43 offen lds
s_add_u32 m0, s40, 6144
s_add_u32 s43, s38, 294912
buffer_load_dwordx4 v2, s[12:15], s43 offen lds
s_add_u32 m0, s40, 7168
s_add_u32 s43, s38, 344064
buffer_load_dwordx4 v3, s[12:15], s43 offen lds
s_add_u32 s37, s37, 128
s_add_u32 s38, s38, 393216
s_waitcnt lgkmcnt(0)
s_load_dword s3, s[4:5], 100352
s_load_dword s3, s[4:5], 100416
s_load_dword s3, s[4:5], 100480
s_load_dword s3, s[4:5], 100544
s_load_dword s3, s[4:5], 107520
s_load_dword s3, s[4:5], 107584
s_load_dword s3, s[4:5], 107648
s_load_dword s3, s[4:5], 107712
s_load_dword s3, s[4:5], 114688
s_load_dword s3, s[4:5], 114752
s_load_dword s3, s[4:5], 114816
s_load_dword s3, s[4:5], 114880
s_load_dword s3, s[4:5], 121856
s_load_dword s3, s[4:5], 121920
s_waitcnt vmcnt(14)
s_barrier
s_add_u32 m0, s39, 43008
s_mov_b64 exec, s[60:61]
buffer_load_dwordx4 v4, s[8:11], s37 offen lds
s_mov_b64 exec, -1
s_add_u32 m0, s39, 46080
s_nop 0
buffer_load_dwordx4 v5, s[8:11], s37 offen lds
s_add_u32 m0, s39, 49152
s_nop 0
buffer_load_dwordx4 v6, s[8:11], s37 offen lds
s_add_u32 m0, s39, 52224
s_nop 0
buffer_load_dwordx4 v7, s[8:11], s37 offen lds
s_add_u32 m0, s39, 55296
s_nop 0
buffer_load_dwordx4 v8, s[8:11], s37 offen lds
s_add_u32 m0, s39, 58368
s_nop 0
buffer_load_dwordx4 v9, s[8:11], s37 offen lds
s_add_u32 m0, s40, 43008
s_add_u32 s43, s38, 0
buffer_load_dwordx4 v2, s[12:15], s43 offen lds
s_add_u32 m0, s40, 44032
s_add_u32 s43, s38, 49152
buffer_load_dwordx4 v3, s[12:15], s43 offen lds
s_add_u32 m0, s40, 45056
s_add_u32 s43, s38, 98304
buffer_load_dwordx4 v2, s[12:15], s43 offen lds
s_add_u32 m0, s40, 46080
s_add_u32 s43, s38, 147456
buffer_load_dwordx4 v3, s[12:15], s43 offen lds
s_add_u32 m0, s40, 47104
s_add_u32 s43, s38, 196608
buffer_load_dwordx4 v2, s[12:15], s43 offen lds
s_add_u32 m0, s40, 48128
s_add_u32 s43, s38, 245760
buffer_load_dwordx4 v3, s[12:15], s43 offen lds
s_add_u32 m0, s40, 49152
s_add_u32 s43, s38, 294912
buffer_load_dwordx4 v2, s[12:15], s43 offen lds
s_add_u32 m0, s40, 50176
s_add_u32 s43, s38, 344064
buffer_load_dwordx4 v3, s[12:15], s43 offen lds
s_add_u32 s37, s37, 128
s_add_u32 s38, s38, 393216
s_waitcnt vmcnt(14)
s_barrier
s_add_u32 m0, s39, 86016
s_mov_b64 exec, s[60:61]
buffer_load_dwordx4 v4, s[8:11], s37 offen lds
s_mov_b64 exec, -1
s_add_u32 m0, s39, 89088
s_nop 0
buffer_load_dwordx4 v5, s[8:11], s37 offen lds
s_add_u32 m0, s39, 92160
s_nop 0
buffer_load_dwordx4 v6, s[8:11], s37 offen lds
s_add_u32 m0, s39, 95232
s_nop 0
buffer_load_dwordx4 v7, s[8:11], s37 offen lds
s_add_u32 m0, s39, 98304
s_nop 0
buffer_load_dwordx4 v8, s[8:11], s37 offen lds
s_add_u32 m0, s39, 101376
s_nop 0
buffer_load_dwordx4 v9, s[8:11], s37 offen lds
s_add_u32 m0, s40, 86016
s_add_u32 s43, s38, 0
buffer_load_dwordx4 v2, s[12:15], s43 offen lds
s_add_u32 m0, s40, 87040
s_add_u32 s43, s38, 49152
buffer_load_dwordx4 v3, s[12:15], s43 offen lds
s_add_u32 m0, s40, 88064
s_add_u32 s43, s38, 98304
buffer_load_dwordx4 v2, s[12:15], s43 offen lds
s_add_u32 m0, s40, 89088
s_add_u32 s43, s38, 147456
buffer_load_dwordx4 v3, s[12:15], s43 offen lds
s_add_u32 m0, s40, 90112
s_add_u32 s43, s38, 196608
buffer_load_dwordx4 v2, s[12:15], s43 offen lds
s_add_u32 m0, s40, 91136
s_add_u32 s43, s38, 245760
buffer_load_dwordx4 v3, s[12:15], s43 offen lds
s_add_u32 m0, s40, 92160
s_add_u32 s43, s38, 294912
buffer_load_dwordx4 v2, s[12:15], s43 offen lds
s_add_u32 m0, s40, 93184
s_add_u32 s43, s38, 344064
buffer_load_dwordx4 v3, s[12:15], s43 offen lds
s_add_u32 s37, s37, 128
s_add_u32 s38, s38, 393216
s_waitcnt lgkmcnt(0)
s_load_dword s3, s[4:5], 121984
s_load_dword s3, s[4:5], 122048
s_load_dword s3, s[4:5], 129024
s_load_dword s3, s[4:5], 129088
s_load_dword s3, s[4:5], 129152
s_load_dword s3, s[4:5], 129216
s_load_dword s3, s[4:5], 136192
s_load_dword s3, s[4:5], 136256
s_load_dword s3, s[4:5], 136320
s_load_dword s3, s[4:5], 136384
s_load_dword s3, s[4:5], 143360
s_load_dword s3, s[4:5], 143424
s_load_dword s3, s[4:5], 143488
s_load_dword s3, s[4:5], 143552
s_waitcnt vmcnt(14)
s_barrier
s_add_u32 m0, s39, 0
s_mov_b64 exec, s[60:61]
buffer_load_dwordx4 v4, s[8:11], s37 offen lds
s_mov_b64 exec, -1
s_add_u32 m0, s39, 3072
s_nop 0
buffer_load_dwordx4 v5, s[8:11], s37 offen lds
s_add_u32 m0, s39, 6144
s_nop 0
buffer_load_dwordx4 v6, s[8:11], s37 offen lds
s_add_u32 m0, s39, 9216
s_nop 0
buffer_load_dwordx4 v7, s[8:11], s37 offen lds
s_add_u32 m0, s39, 12288
s_nop 0
buffer_load_dwordx4 v8, s[8:11], s37 offen lds
s_add_u32 m0, s39, 15360
s_nop 0
buffer_load_dwordx4 v9, s[8:11], s37 offen lds
s_add_u32 m0, s40, 0
s_add_u32 s43, s38, 0
buffer_load_dwordx4 v2, s[12:15], s43 offen lds
s_add_u32 m0, s40, 1024
s_add_u32 s43, s38, 49152
buffer_load_dwordx4 v3, s[12:15], s43 offen lds
s_add_u32 m0, s40, 2048
s_add_u32 s43, s38, 98304
buffer_load_dwordx4 v2, s[12:15], s43 offen lds
s_add_u32 m0, s40, 3072
s_add_u32 s43, s38, 147456
buffer_load_dwordx4 v3, s[12:15], s43 offen lds
s_add_u32 m0, s40, 4096
s_add_u32 s43, s38, 196608
buffer_load_dwordx4 v2, s[12:15], s43 offen lds
s_add_u32 m0, s40, 5120
s_add_u32 s43, s38, 245760
buffer_load_dwordx4 v3, s[12:15], s43 offen lds
s_add_u32 m0, s40, 6144
s_add_u32 s43, s38, 294912
buffer_load_dwordx4 v2, s[12:15], s43 offen lds
s_add_u32 m0, s40, 7168
s_add_u32 s43, s38, 344064
buffer_load_dwordx4 v3, s[12:15], s43 offen lds
s_add_u32 s37, s37, 128
s_add_u32 s38, s38, 393216
s_waitcnt vmcnt(14)
s_barrier
s_waitcnt lgkmcnt(0)
s_load_dword s3, s[4:5], 150528
s_load_dword s3, s[4:5], 150592
s_load_dword s3, s[4:5], 150656
s_load_dword s3, s[4:5], 150720
s_load_dword s3, s[4:5], 157696
s_load_dword s3, s[4:5], 157760
s_load_dword s3, s[4:5], 157824
s_load_dword s3, s[4:5], 157888
s_load_dword s3, s[4:5], 164864
s_load_dword s3, s[4:5], 164928
s_load_dword s3, s[4:5], 164992
s_load_dword s3, s[4:5], 165056
s_waitcnt vmcnt(0)
s_barrier
s_bitcmp0_b32 s2, 0
s_cselect_b32 s88, s72, s74
s_cselect_b32 s89, s73, s75
s_cmp_lt_u32 s2, 192
s_cselect_b32 s90, 7340032, 0
s_mov_b32 s91, 0x20000
s_bfe_u32 s44, s2, 0x30001
s_lshl_b32 s44, s44, 2
s_and_b32 s43, s36, 3
s_add_u32 s44, s44, s43
s_lshl_b32 s44, s44, 5
v_lshrrev_b32 v18, 4, v1
v_add_u32 v18, s44, v18
v_mul_u32_u24 v18, 7168, v18
v_and_b32 v19, 15, v1
v_lshl_add_u32 v18, v19, 4, v18
s_lshr_b32 s43, s2, 4
s_lshl_b32 s43, s43, 8
s_add_u32 s43, s43, 4096
v_add_u32 v18, s43, v18
s_mov_b32 s43, 0
buffer_load_dwordx4 v[128:131], v18, s[88:91], s43 offen
s_mov_b32 s43, 28672
s_branch Lov_1
.p2align 12
Lst_1_0:
s_branch Lwr_140
s_nop 0
s_nop 0
Lov_1:
buffer_load_dwordx4 v[132:135], v18, s[88:91], s43 offen
s_mov_b32 s43, 57344
buffer_load_dwordx4 v[136:139], v18, s[88:91], s43 offen
s_mov_b32 s43, 86016
buffer_load_dwordx4 v[140:143], v18, s[88:91], s43 offen
s_mov_b32 s43, 114688
buffer_load_dwordx4 v[144:147], v18, s[88:91], s43 offen
s_mov_b32 s43, 143360
buffer_load_dwordx4 v[148:151], v18, s[88:91], s43 offen
s_mov_b32 s43, 172032
buffer_load_dwordx4 v[152:155], v18, s[88:91], s43 offen
s_mov_b32 s43, 200704
buffer_load_dwordx4 v[156:159], v18, s[88:91], s43 offen
s_barrier
s_lshl_b32 s43, s35, 7
s_add_u32 s28, s68, s43
s_addc_u32 s29, s69, 0
s_mov_b32 s30, 2095232
s_mov_b32 s31, 0x20000
v_lshrrev_b32 v15, 3, v1
v_and_b32 v16, 6, v15
v_and_b32 v7, 7, v1
v_xor_b32 v7, v7, v16
v_lshlrev_b32 v7, 4, v7
v_mul_u32_u24 v15, 2048, v15
v_add_u32 v7, v7, v15
s_and_b32 s40, s36, 3
s_lshl_b32 s39, s40, 13
s_add_u32 s40, s40, s35
s_add_u32 s42, s40, 0
s_and_b32 s42, s42, 15
s_lshl_b32 s42, s42, 17
s_add_u32 m0, s39, 65536
s_add_u32 s43, s42, 0
buffer_load_dwordx4 v7, s[28:31], s43 offen lds
s_add_u32 m0, s39, 66560
s_add_u32 s43, s42, 16384
buffer_load_dwordx4 v7, s[28:31], s43 offen lds
s_add_u32 m0, s39, 67584
s_add_u32 s43, s42, 32768
buffer_load_dwordx4 v7, s[28:31], s43 offen lds
s_add_u32 m0, s39, 68608
s_add_u32 s43, s42, 49152
buffer_load_dwordx4 v7, s[28:31], s43 offen lds
s_add_u32 m0, s39, 69632
s_add_u32 s43, s42, 65536
buffer_load_dwordx4 v7, s[28:31], s43 offen lds
s_add_u32 m0, s39, 70656
s_add_u32 s43, s42, 81920
buffer_load_dwordx4 v7, s[28:31], s43 offen lds
s_add_u32 m0, s39, 71680
s_add_u32 s43, s42, 98304
buffer_load_dwordx4 v7, s[28:31], s43 offen lds
s_add_u32 m0, s39, 72704
s_add_u32 s43, s42, 114688
buffer_load_dwordx4 v7, s[28:31], s43 offen lds
s_branch Lats_6
Lcons_7:
s_lshl_b32 s43, s35, 7
s_waitcnt lgkmcnt(0)
s_mov_b32 s8, s64
s_mov_b32 s9, s65
s_mov_b32 s10, 4194304
s_mov_b32 s11, 0x20000
s_add_u32 s12, s66, s43
s_addc_u32 s13, s67, 0
s_mov_b32 s14, 6289536
s_mov_b32 s15, 0x20000
v_lshrrev_b32 v16, 1, v12
v_xor_b32 v15, v13, v16
v_lshlrev_b32 v15, 4, v15
v_lshl_add_u32 v2, v12, 7, v15
v_xor_b32 v3, 64, v2
v_add_u32 v4, 86016, v2
v_add_u32 v5, 86016, v3
v_lshrrev_b32 v15, 2, v12
v_and_b32 v16, 3, v1
v_lshl_add_u32 v19, v13, 3, v15
v_lshlrev_b32 v19, 7, v19
v_and_b32 v15, 2, v15
v_and_b32 v17, 1, v13
v_lshl_add_u32 v15, v17, 2, v15
v_lshrrev_b32 v17, 1, v16
s_lshl_b32 s43, s36, 1
v_add_u32 v17, s43, v17
v_xor_b32 v15, v15, v17
v_lshl_add_u32 v19, v15, 4, v19
v_and_b32 v16, 1, v16
v_lshl_add_u32 v19, v16, 3, v19
v_add_u32 v6, 18432, v19
v_add_u32 v7, 61440, v19
v_add_u32 v8, 104448, v19
s_and_b32 s43, s36, 1
s_bfe_u32 s44, s36, 0x10001
s_lshr_b32 s45, s36, 2
v_lshlrev_b32 v14, 2, v13
v_sub_u32 v14, v12, v14
v_mov_b32 v16, 0xff800000
s_or_b32 s46, s34, s45
s_cmp_lg_u32 s46, 0
s_cselect_b32 s46, 0, 0xff800000
v_subrev_u32 v15, 0, v14
v_cmp_ge_u32 vcc, 7, v15
v_add_u32 v15, 16, v15
s_nop 0
v_cndmask_b32 v248, v16, 0, vcc
v_cmp_ge_u32 vcc, 7, v15
s_nop 1
v_cndmask_b32 v244, v16, 0, vcc
v_or_b32 v240, s46, v244
v_subrev_u32 v15, 1, v14
v_cmp_ge_u32 vcc, 7, v15
v_add_u32 v15, 16, v15
s_nop 0
v_cndmask_b32 v249, v16, 0, vcc
v_cmp_ge_u32 vcc, 7, v15
s_nop 1
v_cndmask_b32 v245, v16, 0, vcc
v_or_b32 v241, s46, v245
v_subrev_u32 v15, 2, v14
v_cmp_ge_u32 vcc, 7, v15
v_add_u32 v15, 16, v15
s_nop 0
v_cndmask_b32 v250, v16, 0, vcc
v_cmp_ge_u32 vcc, 7, v15
s_nop 1
v_cndmask_b32 v246, v16, 0, vcc
v_or_b32 v242, s46, v246
v_subrev_u32 v15, 3, v14
v_cmp_ge_u32 vcc, 7, v15
v_add_u32 v15, 16, v15
s_nop 0
v_cndmask_b32 v251, v16, 0, vcc
v_cmp_ge_u32 vcc, 7, v15
s_nop 1
v_cndmask_b32 v247, v16, 0, vcc
v_or_b32 v243, s46, v247
s_lshl_b32 s46, s45, 6
s_add_u32 s46, s46, s44
s_add_u32 s46, s46, 16
v_lshl_add_u32 v14, v12, 1, s46
s_lshl_b32 s47, s43, 6
v_lshl_add_u32 v15, v13, 4, s47
v_mul_u32_u24 v20, 400, v14
v_add_u32 v20, v20, v15
v_subrev_u32 v16, 32, v14
v_max_i32 v16, 0, v16
v_mul_u32_u24 v21, 400, v16
v_add_u32 v21, v21, v15
v_lshrrev_b32 v16, 2, v12
v_lshl_add_u32 v16, v13, 2, v16
v_lshl_add_u32 v16, v16, 1, s46
v_and_b32 v17, 3, v1
v_lshl_add_u32 v17, v17, 3, s47
v_mul_u32_u24 v22, 400, v16
v_add_u32 v22, v22, v17
v_subrev_u32 v16, 32, v16
v_max_i32 v16, 0, v16
v_mul_u32_u24 v23, 400, v16
v_add_u32 v23, v23, v17
s_mul_i32 s60, s34, 262144
s_add_u32 s16, s82, s60
s_addc_u32 s17, s83, 0
s_mov_b32 s18, 262144
s_mov_b32 s19, 0x20000
s_lshl_b32 s60, s35, 14
s_lshl_b32 s43, s43, 13
s_add_u32 s60, s60, s43
s_lshl_b32 s43, s45, 12
s_add_u32 s60, s60, s43
s_lshl_b32 s43, s44, 10
s_add_u32 s60, s60, s43
v_lshlrev_b32 v24, 4, v1
s_mov_b32 s61, 0x3e8293ee
s_lshl_b32 s38, s35, 7
s_add_u32 s56, s82, 28311552
s_addc_u32 s57, s83, 0
s_mov_b32 s58, 49152
s_mov_b32 s59, 0x20000
s_barrier
ds_read_b128 v[32:35], v2 offset:0
ds_read_b64_tr_b16 v[72:73], v6 offset:8192
ds_read_b64_tr_b16 v[74:75], v6 offset:8704
ds_read_b64_tr_b16 v[76:77], v6 offset:16384
ds_read_b64_tr_b16 v[78:79], v6 offset:16896
ds_read_b64_tr_b16 v[68:69], v6 offset:0
ds_read_b64_tr_b16 v[70:71], v6 offset:512
ds_read_b128 v[36:39], v2 offset:2048
ds_read_b128 v[40:43], v2 offset:4096
ds_read_b128 v[44:47], v2 offset:6144
ds_read_b128 v[48:51], v2 offset:8192
ds_read_b128 v[52:55], v2 offset:10240
ds_read_b128 v[56:59], v2 offset:12288
ds_read_b128 v[60:63], v2 offset:14336
ds_read_b128 v[64:67], v2 offset:16384
s_waitcnt lgkmcnt(0)
v_mfma_f32_16x16x32_bf16 v[164:167], v[72:75], v[32:35], 0
ds_read_b128 v[80:83], v3 offset:0
v_mfma_f32_16x16x32_bf16 v[200:203], v[76:79], v[32:35], 0
ds_read_b64_tr_b16 v[120:121], v6 offset:12288
v_mfma_f32_16x16x32_bf16 v[128:131], v[68:71], v[32:35], 0
ds_read_b64_tr_b16 v[122:123], v6 offset:12800
v_mfma_f32_16x16x32_bf16 v[132:135], v[68:71], v[36:39], 0
ds_read_b64_tr_b16 v[124:125], v6 offset:20480
v_mfma_f32_16x16x32_bf16 v[204:207], v[76:79], v[36:39], 0
ds_read_b64_tr_b16 v[126:127], v6 offset:20992
v_mfma_f32_16x16x32_bf16 v[168:171], v[72:75], v[36:39], 0
ds_read_b64_tr_b16 v[116:117], v6 offset:4096
v_mfma_f32_16x16x32_bf16 v[172:175], v[72:75], v[40:43], 0
ds_read_b64_tr_b16 v[118:119], v6 offset:4608
v_mfma_f32_16x16x32_bf16 v[208:211], v[76:79], v[40:43], 0
ds_read_b128 v[84:87], v3 offset:2048
v_mfma_f32_16x16x32_bf16 v[136:139], v[68:71], v[40:43], 0
ds_read_b128 v[88:91], v3 offset:4096
v_mfma_f32_16x16x32_bf16 v[140:143], v[68:71], v[44:47], 0
ds_read_b128 v[92:95], v3 offset:6144
v_mfma_f32_16x16x32_bf16 v[212:215], v[76:79], v[44:47], 0
ds_read_b128 v[96:99], v3 offset:8192
v_mfma_f32_16x16x32_bf16 v[176:179], v[72:75], v[44:47], 0
ds_read_b128 v[100:103], v3 offset:10240
v_mfma_f32_16x16x32_bf16 v[180:183], v[72:75], v[48:51], 0
ds_read_b128 v[104:107], v3 offset:12288
v_mfma_f32_16x16x32_bf16 v[216:219], v[76:79], v[48:51], 0
ds_read_b128 v[108:111], v3 offset:14336
v_mfma_f32_16x16x32_bf16 v[144:147], v[68:71], v[48:51], 0
ds_read_b128 v[112:115], v3 offset:16384
v_mfma_f32_16x16x32_bf16 v[148:151], v[68:71], v[52:55], 0
v_mfma_f32_16x16x32_bf16 v[220:223], v[76:79], v[52:55], 0
v_mfma_f32_16x16x32_bf16 v[184:187], v[72:75], v[52:55], 0
v_mfma_f32_16x16x32_bf16 v[188:191], v[72:75], v[56:59], 0
v_mfma_f32_16x16x32_bf16 v[224:227], v[76:79], v[56:59], 0
v_mfma_f32_16x16x32_bf16 v[152:155], v[68:71], v[56:59], 0
v_mfma_f32_16x16x32_bf16 v[156:159], v[68:71], v[60:63], 0
v_mfma_f32_16x16x32_bf16 v[228:231], v[76:79], v[60:63], 0
v_mfma_f32_16x16x32_bf16 v[192:195], v[72:75], v[60:63], 0
v_mfma_f32_16x16x32_bf16 v[196:199], v[72:75], v[64:67], 0
v_mfma_f32_16x16x32_bf16 v[232:235], v[76:79], v[64:67], 0
v_mfma_f32_16x16x32_bf16 v[160:163], v[68:71], v[64:67], 0
s_waitcnt lgkmcnt(0)
s_barrier
v_mfma_f32_16x16x32_bf16 v[164:167], v[120:123], v[80:83], v[164:167]
ds_read_b128 v[32:35], v2 offset:43008
v_mfma_f32_16x16x32_bf16 v[200:203], v[124:127], v[80:83], v[200:203]
ds_read_b64_tr_b16 v[72:73], v7 offset:8192
v_mfma_f32_16x16x32_bf16 v[128:131], v[116:119], v[80:83], v[128:131]
ds_read_b64_tr_b16 v[74:75], v7 offset:8704
v_mfma_f32_16x16x32_bf16 v[132:135], v[116:119], v[84:87], v[132:135]
ds_read_b64_tr_b16 v[76:77], v7 offset:16384
v_mfma_f32_16x16x32_bf16 v[204:207], v[124:127], v[84:87], v[204:207]
ds_read_b64_tr_b16 v[78:79], v7 offset:16896
v_mfma_f32_16x16x32_bf16 v[168:171], v[120:123], v[84:87], v[168:171]
ds_read_b64_tr_b16 v[68:69], v7 offset:0
v_mfma_f32_16x16x32_bf16 v[172:175], v[120:123], v[88:91], v[172:175]
ds_read_b64_tr_b16 v[70:71], v7 offset:512
v_mfma_f32_16x16x32_bf16 v[208:211], v[124:127], v[88:91], v[208:211]
ds_read_b128 v[36:39], v2 offset:45056
v_mfma_f32_16x16x32_bf16 v[136:139], v[116:119], v[88:91], v[136:139]
ds_read_b128 v[40:43], v2 offset:47104
v_mfma_f32_16x16x32_bf16 v[140:143], v[116:119], v[92:95], v[140:143]
ds_read_b128 v[44:47], v2 offset:49152
v_mfma_f32_16x16x32_bf16 v[212:215], v[124:127], v[92:95], v[212:215]
ds_read_b128 v[48:51], v2 offset:51200
v_mfma_f32_16x16x32_bf16 v[176:179], v[120:123], v[92:95], v[176:179]
ds_read_b128 v[52:55], v2 offset:53248
v_mfma_f32_16x16x32_bf16 v[180:183], v[120:123], v[96:99], v[180:183]
ds_read_b128 v[56:59], v2 offset:55296
v_mfma_f32_16x16x32_bf16 v[216:219], v[124:127], v[96:99], v[216:219]
ds_read_b128 v[60:63], v2 offset:57344
v_mfma_f32_16x16x32_bf16 v[144:147], v[116:119], v[96:99], v[144:147]
ds_read_b128 v[64:67], v2 offset:59392
v_mfma_f32_16x16x32_bf16 v[148:151], v[116:119], v[100:103], v[148:151]
v_mfma_f32_16x16x32_bf16 v[220:223], v[124:127], v[100:103], v[220:223]
v_mfma_f32_16x16x32_bf16 v[184:187], v[120:123], v[100:103], v[184:187]
v_mfma_f32_16x16x32_bf16 v[188:191], v[120:123], v[104:107], v[188:191]
v_mfma_f32_16x16x32_bf16 v[224:227], v[124:127], v[104:107], v[224:227]
v_mfma_f32_16x16x32_bf16 v[152:155], v[116:119], v[104:107], v[152:155]
v_mfma_f32_16x16x32_bf16 v[156:159], v[116:119], v[108:111], v[156:159]
v_mfma_f32_16x16x32_bf16 v[228:231], v[124:127], v[108:111], v[228:231]
v_mfma_f32_16x16x32_bf16 v[192:195], v[120:123], v[108:111], v[192:195]
v_mfma_f32_16x16x32_bf16 v[196:199], v[120:123], v[112:115], v[196:199]
v_mfma_f32_16x16x32_bf16 v[232:235], v[124:127], v[112:115], v[232:235]
v_mfma_f32_16x16x32_bf16 v[160:163], v[116:119], v[112:115], v[160:163]
s_waitcnt lgkmcnt(0)
v_mfma_f32_16x16x32_bf16 v[164:167], v[72:75], v[32:35], v[164:167]
ds_read_b128 v[80:83], v3 offset:43008
v_mfma_f32_16x16x32_bf16 v[200:203], v[76:79], v[32:35], v[200:203]
ds_read_b64_tr_b16 v[120:121], v7 offset:12288
v_mfma_f32_16x16x32_bf16 v[128:131], v[68:71], v[32:35], v[128:131]
ds_read_b64_tr_b16 v[122:123], v7 offset:12800
v_mfma_f32_16x16x32_bf16 v[132:135], v[68:71], v[36:39], v[132:135]
ds_read_b64_tr_b16 v[124:125], v7 offset:20480
v_mfma_f32_16x16x32_bf16 v[204:207], v[76:79], v[36:39], v[204:207]
ds_read_b64_tr_b16 v[126:127], v7 offset:20992
v_mfma_f32_16x16x32_bf16 v[168:171], v[72:75], v[36:39], v[168:171]
ds_read_b64_tr_b16 v[116:117], v7 offset:4096
v_mfma_f32_16x16x32_bf16 v[172:175], v[72:75], v[40:43], v[172:175]
ds_read_b64_tr_b16 v[118:119], v7 offset:4608
v_mfma_f32_16x16x32_bf16 v[208:211], v[76:79], v[40:43], v[208:211]
ds_read_b128 v[84:87], v3 offset:45056
v_mfma_f32_16x16x32_bf16 v[136:139], v[68:71], v[40:43], v[136:139]
ds_read_b128 v[88:91], v3 offset:47104
v_mfma_f32_16x16x32_bf16 v[140:143], v[68:71], v[44:47], v[140:143]
ds_read_b128 v[92:95], v3 offset:49152
v_mfma_f32_16x16x32_bf16 v[212:215], v[76:79], v[44:47], v[212:215]
ds_read_b128 v[96:99], v3 offset:51200
v_mfma_f32_16x16x32_bf16 v[176:179], v[72:75], v[44:47], v[176:179]
ds_read_b128 v[100:103], v3 offset:53248
v_mfma_f32_16x16x32_bf16 v[180:183], v[72:75], v[48:51], v[180:183]
ds_read_b128 v[104:107], v3 offset:55296
v_mfma_f32_16x16x32_bf16 v[216:219], v[76:79], v[48:51], v[216:219]
ds_read_b128 v[108:111], v3 offset:57344
v_mfma_f32_16x16x32_bf16 v[144:147], v[68:71], v[48:51], v[144:147]
ds_read_b128 v[112:115], v3 offset:59392
v_mfma_f32_16x16x32_bf16 v[148:151], v[68:71], v[52:55], v[148:151]
v_mfma_f32_16x16x32_bf16 v[220:223], v[76:79], v[52:55], v[220:223]
v_mfma_f32_16x16x32_bf16 v[184:187], v[72:75], v[52:55], v[184:187]
v_mfma_f32_16x16x32_bf16 v[188:191], v[72:75], v[56:59], v[188:191]
v_mfma_f32_16x16x32_bf16 v[224:227], v[76:79], v[56:59], v[224:227]
v_mfma_f32_16x16x32_bf16 v[152:155], v[68:71], v[56:59], v[152:155]
v_mfma_f32_16x16x32_bf16 v[156:159], v[68:71], v[60:63], v[156:159]
v_mfma_f32_16x16x32_bf16 v[228:231], v[76:79], v[60:63], v[228:231]
v_mfma_f32_16x16x32_bf16 v[192:195], v[72:75], v[60:63], v[192:195]
v_mfma_f32_16x16x32_bf16 v[196:199], v[72:75], v[64:67], v[196:199]
v_mfma_f32_16x16x32_bf16 v[232:235], v[76:79], v[64:67], v[232:235]
v_mfma_f32_16x16x32_bf16 v[160:163], v[68:71], v[64:67], v[160:163]
s_waitcnt lgkmcnt(0)
s_barrier
v_mfma_f32_16x16x32_bf16 v[164:167], v[120:123], v[80:83], v[164:167]
ds_read_b128 v[32:35], v4 offset:0
v_mfma_f32_16x16x32_bf16 v[200:203], v[124:127], v[80:83], v[200:203]
ds_read_b64_tr_b16 v[72:73], v8 offset:8192
v_mfma_f32_16x16x32_bf16 v[128:131], v[116:119], v[80:83], v[128:131]
ds_read_b64_tr_b16 v[74:75], v8 offset:8704
v_mfma_f32_16x16x32_bf16 v[132:135], v[116:119], v[84:87], v[132:135]
ds_read_b64_tr_b16 v[76:77], v8 offset:16384
v_mfma_f32_16x16x32_bf16 v[204:207], v[124:127], v[84:87], v[204:207]
ds_read_b64_tr_b16 v[78:79], v8 offset:16896
v_mfma_f32_16x16x32_bf16 v[168:171], v[120:123], v[84:87], v[168:171]
ds_read_b64_tr_b16 v[68:69], v8 offset:0
v_mfma_f32_16x16x32_bf16 v[172:175], v[120:123], v[88:91], v[172:175]
ds_read_b64_tr_b16 v[70:71], v8 offset:512
v_mfma_f32_16x16x32_bf16 v[208:211], v[124:127], v[88:91], v[208:211]
ds_read_b128 v[36:39], v4 offset:2048
v_mfma_f32_16x16x32_bf16 v[136:139], v[116:119], v[88:91], v[136:139]
ds_read_b128 v[40:43], v4 offset:4096
v_mfma_f32_16x16x32_bf16 v[140:143], v[116:119], v[92:95], v[140:143]
ds_read_b128 v[44:47], v4 offset:6144
v_mfma_f32_16x16x32_bf16 v[212:215], v[124:127], v[92:95], v[212:215]
ds_read_b128 v[48:51], v4 offset:8192
v_mfma_f32_16x16x32_bf16 v[176:179], v[120:123], v[92:95], v[176:179]
ds_read_b128 v[52:55], v4 offset:10240
v_mfma_f32_16x16x32_bf16 v[180:183], v[120:123], v[96:99], v[180:183]
ds_read_b128 v[56:59], v4 offset:12288
v_mfma_f32_16x16x32_bf16 v[216:219], v[124:127], v[96:99], v[216:219]
ds_read_b128 v[60:63], v4 offset:14336
v_mfma_f32_16x16x32_bf16 v[144:147], v[116:119], v[96:99], v[144:147]
ds_read_b128 v[64:67], v4 offset:16384
v_mfma_f32_16x16x32_bf16 v[148:151], v[116:119], v[100:103], v[148:151]
v_mfma_f32_16x16x32_bf16 v[220:223], v[124:127], v[100:103], v[220:223]
v_mfma_f32_16x16x32_bf16 v[184:187], v[120:123], v[100:103], v[184:187]
v_mfma_f32_16x16x32_bf16 v[188:191], v[120:123], v[104:107], v[188:191]
v_mfma_f32_16x16x32_bf16 v[224:227], v[124:127], v[104:107], v[224:227]
v_mfma_f32_16x16x32_bf16 v[152:155], v[116:119], v[104:107], v[152:155]
v_mfma_f32_16x16x32_bf16 v[156:159], v[116:119], v[108:111], v[156:159]
v_mfma_f32_16x16x32_bf16 v[228:231], v[124:127], v[108:111], v[228:231]
v_mfma_f32_16x16x32_bf16 v[192:195], v[120:123], v[108:111], v[192:195]
v_mfma_f32_16x16x32_bf16 v[196:199], v[120:123], v[112:115], v[196:199]
v_mfma_f32_16x16x32_bf16 v[232:235], v[124:127], v[112:115], v[232:235]
v_mfma_f32_16x16x32_bf16 v[160:163], v[116:119], v[112:115], v[160:163]
s_waitcnt lgkmcnt(0)
v_mfma_f32_16x16x32_bf16 v[164:167], v[72:75], v[32:35], v[164:167]
ds_read_b128 v[80:83], v5 offset:0
v_mfma_f32_16x16x32_bf16 v[200:203], v[76:79], v[32:35], v[200:203]
ds_read_b64_tr_b16 v[120:121], v8 offset:12288
v_mfma_f32_16x16x32_bf16 v[128:131], v[68:71], v[32:35], v[128:131]
ds_read_b64_tr_b16 v[122:123], v8 offset:12800
v_mfma_f32_16x16x32_bf16 v[132:135], v[68:71], v[36:39], v[132:135]
ds_read_b64_tr_b16 v[124:125], v8 offset:20480
v_mfma_f32_16x16x32_bf16 v[204:207], v[76:79], v[36:39], v[204:207]
ds_read_b64_tr_b16 v[126:127], v8 offset:20992
v_mfma_f32_16x16x32_bf16 v[168:171], v[72:75], v[36:39], v[168:171]
ds_read_b64_tr_b16 v[116:117], v8 offset:4096
v_mfma_f32_16x16x32_bf16 v[172:175], v[72:75], v[40:43], v[172:175]
ds_read_b64_tr_b16 v[118:119], v8 offset:4608
v_mfma_f32_16x16x32_bf16 v[208:211], v[76:79], v[40:43], v[208:211]
ds_read_b128 v[84:87], v5 offset:2048
v_mfma_f32_16x16x32_bf16 v[136:139], v[68:71], v[40:43], v[136:139]
ds_read_b128 v[88:91], v5 offset:4096
v_mfma_f32_16x16x32_bf16 v[140:143], v[68:71], v[44:47], v[140:143]
ds_read_b128 v[92:95], v5 offset:6144
v_mfma_f32_16x16x32_bf16 v[212:215], v[76:79], v[44:47], v[212:215]
ds_read_b128 v[96:99], v5 offset:8192
v_mfma_f32_16x16x32_bf16 v[176:179], v[72:75], v[44:47], v[176:179]
ds_read_b128 v[100:103], v5 offset:10240
v_mfma_f32_16x16x32_bf16 v[180:183], v[72:75], v[48:51], v[180:183]
ds_read_b128 v[104:107], v5 offset:12288
v_mfma_f32_16x16x32_bf16 v[216:219], v[76:79], v[48:51], v[216:219]
ds_read_b128 v[108:111], v5 offset:14336
v_mfma_f32_16x16x32_bf16 v[144:147], v[68:71], v[48:51], v[144:147]
ds_read_b128 v[112:115], v5 offset:16384
v_mfma_f32_16x16x32_bf16 v[148:151], v[68:71], v[52:55], v[148:151]
v_mfma_f32_16x16x32_bf16 v[220:223], v[76:79], v[52:55], v[220:223]
v_mfma_f32_16x16x32_bf16 v[184:187], v[72:75], v[52:55], v[184:187]
v_mfma_f32_16x16x32_bf16 v[188:191], v[72:75], v[56:59], v[188:191]
v_mfma_f32_16x16x32_bf16 v[224:227], v[76:79], v[56:59], v[224:227]
v_mfma_f32_16x16x32_bf16 v[152:155], v[68:71], v[56:59], v[152:155]
v_mfma_f32_16x16x32_bf16 v[156:159], v[68:71], v[60:63], v[156:159]
v_mfma_f32_16x16x32_bf16 v[228:231], v[76:79], v[60:63], v[228:231]
v_mfma_f32_16x16x32_bf16 v[192:195], v[72:75], v[60:63], v[192:195]
v_mfma_f32_16x16x32_bf16 v[196:199], v[72:75], v[64:67], v[196:199]
v_mfma_f32_16x16x32_bf16 v[232:235], v[76:79], v[64:67], v[232:235]
v_mfma_f32_16x16x32_bf16 v[160:163], v[68:71], v[64:67], v[160:163]
s_waitcnt lgkmcnt(0)
s_barrier
v_mfma_f32_16x16x32_bf16 v[164:167], v[120:123], v[80:83], v[164:167]
ds_read_b128 v[32:35], v2 offset:0
v_mfma_f32_16x16x32_bf16 v[200:203], v[124:127], v[80:83], v[200:203]
ds_read_b64_tr_b16 v[72:73], v6 offset:8192
v_mfma_f32_16x16x32_bf16 v[128:131], v[116:119], v[80:83], v[128:131]
ds_read_b64_tr_b16 v[74:75], v6 offset:8704
v_mfma_f32_16x16x32_bf16 v[132:135], v[116:119], v[84:87], v[132:135]
ds_read_b64_tr_b16 v[76:77], v6 offset:16384
v_mfma_f32_16x16x32_bf16 v[204:207], v[124:127], v[84:87], v[204:207]
ds_read_b64_tr_b16 v[78:79], v6 offset:16896
v_mfma_f32_16x16x32_bf16 v[168:171], v[120:123], v[84:87], v[168:171]
ds_read_b64_tr_b16 v[68:69], v6 offset:0
v_mfma_f32_16x16x32_bf16 v[172:175], v[120:123], v[88:91], v[172:175]
ds_read_b64_tr_b16 v[70:71], v6 offset:512
v_mfma_f32_16x16x32_bf16 v[208:211], v[124:127], v[88:91], v[208:211]
ds_read_b128 v[36:39], v2 offset:2048
v_mfma_f32_16x16x32_bf16 v[136:139], v[116:119], v[88:91], v[136:139]
ds_read_b128 v[40:43], v2 offset:4096
v_mfma_f32_16x16x32_bf16 v[140:143], v[116:119], v[92:95], v[140:143]
ds_read_b128 v[44:47], v2 offset:6144
v_mfma_f32_16x16x32_bf16 v[212:215], v[124:127], v[92:95], v[212:215]
ds_read_b128 v[48:51], v2 offset:8192
v_mfma_f32_16x16x32_bf16 v[176:179], v[120:123], v[92:95], v[176:179]
ds_read_b128 v[52:55], v2 offset:10240
v_mfma_f32_16x16x32_bf16 v[180:183], v[120:123], v[96:99], v[180:183]
ds_read_b128 v[56:59], v2 offset:12288
v_mfma_f32_16x16x32_bf16 v[216:219], v[124:127], v[96:99], v[216:219]
ds_read_b128 v[60:63], v2 offset:14336
v_mfma_f32_16x16x32_bf16 v[144:147], v[116:119], v[96:99], v[144:147]
ds_read_b128 v[64:67], v2 offset:16384
v_mfma_f32_16x16x32_bf16 v[148:151], v[116:119], v[100:103], v[148:151]
v_mfma_f32_16x16x32_bf16 v[220:223], v[124:127], v[100:103], v[220:223]
v_mfma_f32_16x16x32_bf16 v[184:187], v[120:123], v[100:103], v[184:187]
v_mfma_f32_16x16x32_bf16 v[188:191], v[120:123], v[104:107], v[188:191]
v_mfma_f32_16x16x32_bf16 v[224:227], v[124:127], v[104:107], v[224:227]
v_mfma_f32_16x16x32_bf16 v[152:155], v[116:119], v[104:107], v[152:155]
v_mfma_f32_16x16x32_bf16 v[156:159], v[116:119], v[108:111], v[156:159]
v_mfma_f32_16x16x32_bf16 v[228:231], v[124:127], v[108:111], v[228:231]
v_mfma_f32_16x16x32_bf16 v[192:195], v[120:123], v[108:111], v[192:195]
v_mfma_f32_16x16x32_bf16 v[196:199], v[120:123], v[112:115], v[196:199]
v_mfma_f32_16x16x32_bf16 v[232:235], v[124:127], v[112:115], v[232:235]
v_mfma_f32_16x16x32_bf16 v[160:163], v[116:119], v[112:115], v[160:163]
s_mov_b32 s41, 4
Lcl_8:
s_waitcnt lgkmcnt(0)
v_mfma_f32_16x16x32_bf16 v[164:167], v[72:75], v[32:35], v[164:167]
ds_read_b128 v[80:83], v3 offset:0
v_mfma_f32_16x16x32_bf16 v[200:203], v[76:79], v[32:35], v[200:203]
ds_read_b64_tr_b16 v[120:121], v6 offset:12288
v_mfma_f32_16x16x32_bf16 v[128:131], v[68:71], v[32:35], v[128:131]
ds_read_b64_tr_b16 v[122:123], v6 offset:12800
v_mfma_f32_16x16x32_bf16 v[132:135], v[68:71], v[36:39], v[132:135]
ds_read_b64_tr_b16 v[124:125], v6 offset:20480
v_mfma_f32_16x16x32_bf16 v[204:207], v[76:79], v[36:39], v[204:207]
ds_read_b64_tr_b16 v[126:127], v6 offset:20992
v_mfma_f32_16x16x32_bf16 v[168:171], v[72:75], v[36:39], v[168:171]
ds_read_b64_tr_b16 v[116:117], v6 offset:4096
v_mfma_f32_16x16x32_bf16 v[172:175], v[72:75], v[40:43], v[172:175]
ds_read_b64_tr_b16 v[118:119], v6 offset:4608
v_mfma_f32_16x16x32_bf16 v[208:211], v[76:79], v[40:43], v[208:211]
ds_read_b128 v[84:87], v3 offset:2048
v_mfma_f32_16x16x32_bf16 v[136:139], v[68:71], v[40:43], v[136:139]
ds_read_b128 v[88:91], v3 offset:4096
v_mfma_f32_16x16x32_bf16 v[140:143], v[68:71], v[44:47], v[140:143]
ds_read_b128 v[92:95], v3 offset:6144
v_mfma_f32_16x16x32_bf16 v[212:215], v[76:79], v[44:47], v[212:215]
ds_read_b128 v[96:99], v3 offset:8192
v_mfma_f32_16x16x32_bf16 v[176:179], v[72:75], v[44:47], v[176:179]
ds_read_b128 v[100:103], v3 offset:10240
v_mfma_f32_16x16x32_bf16 v[180:183], v[72:75], v[48:51], v[180:183]
ds_read_b128 v[104:107], v3 offset:12288
v_mfma_f32_16x16x32_bf16 v[216:219], v[76:79], v[48:51], v[216:219]
ds_read_b128 v[108:111], v3 offset:14336
v_mfma_f32_16x16x32_bf16 v[144:147], v[68:71], v[48:51], v[144:147]
ds_read_b128 v[112:115], v3 offset:16384
v_mfma_f32_16x16x32_bf16 v[148:151], v[68:71], v[52:55], v[148:151]
v_mfma_f32_16x16x32_bf16 v[220:223], v[76:79], v[52:55], v[220:223]
v_mfma_f32_16x16x32_bf16 v[184:187], v[72:75], v[52:55], v[184:187]
v_mfma_f32_16x16x32_bf16 v[188:191], v[72:75], v[56:59], v[188:191]
v_mfma_f32_16x16x32_bf16 v[224:227], v[76:79], v[56:59], v[224:227]
v_mfma_f32_16x16x32_bf16 v[152:155], v[68:71], v[56:59], v[152:155]
v_mfma_f32_16x16x32_bf16 v[156:159], v[68:71], v[60:63], v[156:159]
v_mfma_f32_16x16x32_bf16 v[228:231], v[76:79], v[60:63], v[228:231]
v_mfma_f32_16x16x32_bf16 v[192:195], v[72:75], v[60:63], v[192:195]
v_mfma_f32_16x16x32_bf16 v[196:199], v[72:75], v[64:67], v[196:199]
v_mfma_f32_16x16x32_bf16 v[232:235], v[76:79], v[64:67], v[232:235]
v_mfma_f32_16x16x32_bf16 v[160:163], v[68:71], v[64:67], v[160:163]
s_waitcnt lgkmcnt(0)
s_barrier
v_mfma_f32_16x16x32_bf16 v[164:167], v[120:123], v[80:83], v[164:167]
ds_read_b128 v[32:35], v2 offset:43008
v_mfma_f32_16x16x32_bf16 v[200:203], v[124:127], v[80:83], v[200:203]
ds_read_b64_tr_b16 v[72:73], v7 offset:8192
v_mfma_f32_16x16x32_bf16 v[128:131], v[116:119], v[80:83], v[128:131]
ds_read_b64_tr_b16 v[74:75], v7 offset:8704
v_mfma_f32_16x16x32_bf16 v[132:135], v[116:119], v[84:87], v[132:135]
ds_read_b64_tr_b16 v[76:77], v7 offset:16384
v_mfma_f32_16x16x32_bf16 v[204:207], v[124:127], v[84:87], v[204:207]
ds_read_b64_tr_b16 v[78:79], v7 offset:16896
v_mfma_f32_16x16x32_bf16 v[168:171], v[120:123], v[84:87], v[168:171]
ds_read_b64_tr_b16 v[68:69], v7 offset:0
v_mfma_f32_16x16x32_bf16 v[172:175], v[120:123], v[88:91], v[172:175]
ds_read_b64_tr_b16 v[70:71], v7 offset:512
v_mfma_f32_16x16x32_bf16 v[208:211], v[124:127], v[88:91], v[208:211]
ds_read_b128 v[36:39], v2 offset:45056
v_mfma_f32_16x16x32_bf16 v[136:139], v[116:119], v[88:91], v[136:139]
ds_read_b128 v[40:43], v2 offset:47104
v_mfma_f32_16x16x32_bf16 v[140:143], v[116:119], v[92:95], v[140:143]
ds_read_b128 v[44:47], v2 offset:49152
v_mfma_f32_16x16x32_bf16 v[212:215], v[124:127], v[92:95], v[212:215]
ds_read_b128 v[48:51], v2 offset:51200
v_mfma_f32_16x16x32_bf16 v[176:179], v[120:123], v[92:95], v[176:179]
ds_read_b128 v[52:55], v2 offset:53248
v_mfma_f32_16x16x32_bf16 v[180:183], v[120:123], v[96:99], v[180:183]
ds_read_b128 v[56:59], v2 offset:55296
v_mfma_f32_16x16x32_bf16 v[216:219], v[124:127], v[96:99], v[216:219]
ds_read_b128 v[60:63], v2 offset:57344
v_mfma_f32_16x16x32_bf16 v[144:147], v[116:119], v[96:99], v[144:147]
ds_read_b128 v[64:67], v2 offset:59392
v_mfma_f32_16x16x32_bf16 v[148:151], v[116:119], v[100:103], v[148:151]
v_mfma_f32_16x16x32_bf16 v[220:223], v[124:127], v[100:103], v[220:223]
v_mfma_f32_16x16x32_bf16 v[184:187], v[120:123], v[100:103], v[184:187]
v_mfma_f32_16x16x32_bf16 v[188:191], v[120:123], v[104:107], v[188:191]
v_mfma_f32_16x16x32_bf16 v[224:227], v[124:127], v[104:107], v[224:227]
v_mfma_f32_16x16x32_bf16 v[152:155], v[116:119], v[104:107], v[152:155]
v_mfma_f32_16x16x32_bf16 v[156:159], v[116:119], v[108:111], v[156:159]
v_mfma_f32_16x16x32_bf16 v[228:231], v[124:127], v[108:111], v[228:231]
v_mfma_f32_16x16x32_bf16 v[192:195], v[120:123], v[108:111], v[192:195]
v_mfma_f32_16x16x32_bf16 v[196:199], v[120:123], v[112:115], v[196:199]
v_mfma_f32_16x16x32_bf16 v[232:235], v[124:127], v[112:115], v[232:235]
v_mfma_f32_16x16x32_bf16 v[160:163], v[116:119], v[112:115], v[160:163]
s_waitcnt lgkmcnt(0)
v_mfma_f32_16x16x32_bf16 v[164:167], v[72:75], v[32:35], v[164:167]
ds_read_b128 v[80:83], v3 offset:43008
v_mfma_f32_16x16x32_bf16 v[200:203], v[76:79], v[32:35], v[200:203]
ds_read_b64_tr_b16 v[120:121], v7 offset:12288
v_mfma_f32_16x16x32_bf16 v[128:131], v[68:71], v[32:35], v[128:131]
ds_read_b64_tr_b16 v[122:123], v7 offset:12800
v_mfma_f32_16x16x32_bf16 v[132:135], v[68:71], v[36:39], v[132:135]
ds_read_b64_tr_b16 v[124:125], v7 offset:20480
v_mfma_f32_16x16x32_bf16 v[204:207], v[76:79], v[36:39], v[204:207]
ds_read_b64_tr_b16 v[126:127], v7 offset:20992
v_mfma_f32_16x16x32_bf16 v[168:171], v[72:75], v[36:39], v[168:171]
ds_read_b64_tr_b16 v[116:117], v7 offset:4096
v_mfma_f32_16x16x32_bf16 v[172:175], v[72:75], v[40:43], v[172:175]
ds_read_b64_tr_b16 v[118:119], v7 offset:4608
v_mfma_f32_16x16x32_bf16 v[208:211], v[76:79], v[40:43], v[208:211]
ds_read_b128 v[84:87], v3 offset:45056
v_mfma_f32_16x16x32_bf16 v[136:139], v[68:71], v[40:43], v[136:139]
ds_read_b128 v[88:91], v3 offset:47104
v_mfma_f32_16x16x32_bf16 v[140:143], v[68:71], v[44:47], v[140:143]
ds_read_b128 v[92:95], v3 offset:49152
v_mfma_f32_16x16x32_bf16 v[212:215], v[76:79], v[44:47], v[212:215]
ds_read_b128 v[96:99], v3 offset:51200
s_branch Lov_2
.p2align 12
Lst_2_0:
s_branch Lwr_141
s_nop 0
s_nop 0
Lov_2:
v_mfma_f32_16x16x32_bf16 v[176:179], v[72:75], v[44:47], v[176:179]
ds_read_b128 v[100:103], v3 offset:53248
v_mfma_f32_16x16x32_bf16 v[180:183], v[72:75], v[48:51], v[180:183]
ds_read_b128 v[104:107], v3 offset:55296
v_mfma_f32_16x16x32_bf16 v[216:219], v[76:79], v[48:51], v[216:219]
ds_read_b128 v[108:111], v3 offset:57344
v_mfma_f32_16x16x32_bf16 v[144:147], v[68:71], v[48:51], v[144:147]
ds_read_b128 v[112:115], v3 offset:59392
v_mfma_f32_16x16x32_bf16 v[148:151], v[68:71], v[52:55], v[148:151]
v_mfma_f32_16x16x32_bf16 v[220:223], v[76:79], v[52:55], v[220:223]
v_mfma_f32_16x16x32_bf16 v[184:187], v[72:75], v[52:55], v[184:187]
v_mfma_f32_16x16x32_bf16 v[188:191], v[72:75], v[56:59], v[188:191]
v_mfma_f32_16x16x32_bf16 v[224:227], v[76:79], v[56:59], v[224:227]
v_mfma_f32_16x16x32_bf16 v[152:155], v[68:71], v[56:59], v[152:155]
v_mfma_f32_16x16x32_bf16 v[156:159], v[68:71], v[60:63], v[156:159]
v_mfma_f32_16x16x32_bf16 v[228:231], v[76:79], v[60:63], v[228:231]
v_mfma_f32_16x16x32_bf16 v[192:195], v[72:75], v[60:63], v[192:195]
v_mfma_f32_16x16x32_bf16 v[196:199], v[72:75], v[64:67], v[196:199]
v_mfma_f32_16x16x32_bf16 v[232:235], v[76:79], v[64:67], v[232:235]
v_mfma_f32_16x16x32_bf16 v[160:163], v[68:71], v[64:67], v[160:163]
s_waitcnt lgkmcnt(0)
s_barrier
v_mfma_f32_16x16x32_bf16 v[164:167], v[120:123], v[80:83], v[164:167]
ds_read_b128 v[32:35], v4 offset:0
v_mfma_f32_16x16x32_bf16 v[200:203], v[124:127], v[80:83], v[200:203]
ds_read_b64_tr_b16 v[72:73], v8 offset:8192
v_mfma_f32_16x16x32_bf16 v[128:131], v[116:119], v[80:83], v[128:131]
ds_read_b64_tr_b16 v[74:75], v8 offset:8704
v_mfma_f32_16x16x32_bf16 v[132:135], v[116:119], v[84:87], v[132:135]
ds_read_b64_tr_b16 v[76:77], v8 offset:16384
v_mfma_f32_16x16x32_bf16 v[204:207], v[124:127], v[84:87], v[204:207]
ds_read_b64_tr_b16 v[78:79], v8 offset:16896
v_mfma_f32_16x16x32_bf16 v[168:171], v[120:123], v[84:87], v[168:171]
ds_read_b64_tr_b16 v[68:69], v8 offset:0
v_mfma_f32_16x16x32_bf16 v[172:175], v[120:123], v[88:91], v[172:175]
ds_read_b64_tr_b16 v[70:71], v8 offset:512
v_mfma_f32_16x16x32_bf16 v[208:211], v[124:127], v[88:91], v[208:211]
ds_read_b128 v[36:39], v4 offset:2048
v_mfma_f32_16x16x32_bf16 v[136:139], v[116:119], v[88:91], v[136:139]
ds_read_b128 v[40:43], v4 offset:4096
v_mfma_f32_16x16x32_bf16 v[140:143], v[116:119], v[92:95], v[140:143]
ds_read_b128 v[44:47], v4 offset:6144
v_mfma_f32_16x16x32_bf16 v[212:215], v[124:127], v[92:95], v[212:215]
ds_read_b128 v[48:51], v4 offset:8192
v_mfma_f32_16x16x32_bf16 v[176:179], v[120:123], v[92:95], v[176:179]
ds_read_b128 v[52:55], v4 offset:10240
v_mfma_f32_16x16x32_bf16 v[180:183], v[120:123], v[96:99], v[180:183]
ds_read_b128 v[56:59], v4 offset:12288
v_mfma_f32_16x16x32_bf16 v[216:219], v[124:127], v[96:99], v[216:219]
ds_read_b128 v[60:63], v4 offset:14336
v_mfma_f32_16x16x32_bf16 v[144:147], v[116:119], v[96:99], v[144:147]
ds_read_b128 v[64:67], v4 offset:16384
v_mfma_f32_16x16x32_bf16 v[148:151], v[116:119], v[100:103], v[148:151]
v_mfma_f32_16x16x32_bf16 v[220:223], v[124:127], v[100:103], v[220:223]
v_mfma_f32_16x16x32_bf16 v[184:187], v[120:123], v[100:103], v[184:187]
v_mfma_f32_16x16x32_bf16 v[188:191], v[120:123], v[104:107], v[188:191]
v_mfma_f32_16x16x32_bf16 v[224:227], v[124:127], v[104:107], v[224:227]
v_mfma_f32_16x16x32_bf16 v[152:155], v[116:119], v[104:107], v[152:155]
v_mfma_f32_16x16x32_bf16 v[156:159], v[116:119], v[108:111], v[156:159]
v_mfma_f32_16x16x32_bf16 v[228:231], v[124:127], v[108:111], v[228:231]
v_mfma_f32_16x16x32_bf16 v[192:195], v[120:123], v[108:111], v[192:195]
v_mfma_f32_16x16x32_bf16 v[196:199], v[120:123], v[112:115], v[196:199]
v_mfma_f32_16x16x32_bf16 v[232:235], v[124:127], v[112:115], v[232:235]
v_mfma_f32_16x16x32_bf16 v[160:163], v[116:119], v[112:115], v[160:163]
s_waitcnt lgkmcnt(0)
v_mfma_f32_16x16x32_bf16 v[164:167], v[72:75], v[32:35], v[164:167]
ds_read_b128 v[80:83], v5 offset:0
v_mfma_f32_16x16x32_bf16 v[200:203], v[76:79], v[32:35], v[200:203]
ds_read_b64_tr_b16 v[120:121], v8 offset:12288
v_mfma_f32_16x16x32_bf16 v[128:131], v[68:71], v[32:35], v[128:131]
ds_read_b64_tr_b16 v[122:123], v8 offset:12800
v_mfma_f32_16x16x32_bf16 v[132:135], v[68:71], v[36:39], v[132:135]
ds_read_b64_tr_b16 v[124:125], v8 offset:20480
v_mfma_f32_16x16x32_bf16 v[204:207], v[76:79], v[36:39], v[204:207]
ds_read_b64_tr_b16 v[126:127], v8 offset:20992
v_mfma_f32_16x16x32_bf16 v[168:171], v[72:75], v[36:39], v[168:171]
ds_read_b64_tr_b16 v[116:117], v8 offset:4096
v_mfma_f32_16x16x32_bf16 v[172:175], v[72:75], v[40:43], v[172:175]
ds_read_b64_tr_b16 v[118:119], v8 offset:4608
v_mfma_f32_16x16x32_bf16 v[208:211], v[76:79], v[40:43], v[208:211]
ds_read_b128 v[84:87], v5 offset:2048
v_mfma_f32_16x16x32_bf16 v[136:139], v[68:71], v[40:43], v[136:139]
ds_read_b128 v[88:91], v5 offset:4096
v_mfma_f32_16x16x32_bf16 v[140:143], v[68:71], v[44:47], v[140:143]
ds_read_b128 v[92:95], v5 offset:6144
v_mfma_f32_16x16x32_bf16 v[212:215], v[76:79], v[44:47], v[212:215]
ds_read_b128 v[96:99], v5 offset:8192
v_mfma_f32_16x16x32_bf16 v[176:179], v[72:75], v[44:47], v[176:179]
ds_read_b128 v[100:103], v5 offset:10240
v_mfma_f32_16x16x32_bf16 v[180:183], v[72:75], v[48:51], v[180:183]
ds_read_b128 v[104:107], v5 offset:12288
v_mfma_f32_16x16x32_bf16 v[216:219], v[76:79], v[48:51], v[216:219]
ds_read_b128 v[108:111], v5 offset:14336
v_mfma_f32_16x16x32_bf16 v[144:147], v[68:71], v[48:51], v[144:147]
ds_read_b128 v[112:115], v5 offset:16384
v_mfma_f32_16x16x32_bf16 v[148:151], v[68:71], v[52:55], v[148:151]
v_mfma_f32_16x16x32_bf16 v[220:223], v[76:79], v[52:55], v[220:223]
v_mfma_f32_16x16x32_bf16 v[184:187], v[72:75], v[52:55], v[184:187]
v_mfma_f32_16x16x32_bf16 v[188:191], v[72:75], v[56:59], v[188:191]
v_mfma_f32_16x16x32_bf16 v[224:227], v[76:79], v[56:59], v[224:227]
v_mfma_f32_16x16x32_bf16 v[152:155], v[68:71], v[56:59], v[152:155]
v_mfma_f32_16x16x32_bf16 v[156:159], v[68:71], v[60:63], v[156:159]
v_mfma_f32_16x16x32_bf16 v[228:231], v[76:79], v[60:63], v[228:231]
v_mfma_f32_16x16x32_bf16 v[192:195], v[72:75], v[60:63], v[192:195]
v_mfma_f32_16x16x32_bf16 v[196:199], v[72:75], v[64:67], v[196:199]
v_mfma_f32_16x16x32_bf16 v[232:235], v[76:79], v[64:67], v[232:235]
v_mfma_f32_16x16x32_bf16 v[160:163], v[68:71], v[64:67], v[160:163]
s_waitcnt lgkmcnt(0)
s_barrier
v_mfma_f32_16x16x32_bf16 v[164:167], v[120:123], v[80:83], v[164:167]
ds_read_b128 v[32:35], v2 offset:0
v_mfma_f32_16x16x32_bf16 v[200:203], v[124:127], v[80:83], v[200:203]
ds_read_b64_tr_b16 v[72:73], v6 offset:8192
v_mfma_f32_16x16x32_bf16 v[128:131], v[116:119], v[80:83], v[128:131]
ds_read_b64_tr_b16 v[74:75], v6 offset:8704
v_mfma_f32_16x16x32_bf16 v[132:135], v[116:119], v[84:87], v[132:135]
ds_read_b64_tr_b16 v[76:77], v6 offset:16384
v_mfma_f32_16x16x32_bf16 v[204:207], v[124:127], v[84:87], v[204:207]
ds_read_b64_tr_b16 v[78:79], v6 offset:16896
v_mfma_f32_16x16x32_bf16 v[168:171], v[120:123], v[84:87], v[168:171]
ds_read_b64_tr_b16 v[68:69], v6 offset:0
v_mfma_f32_16x16x32_bf16 v[172:175], v[120:123], v[88:91], v[172:175]
ds_read_b64_tr_b16 v[70:71], v6 offset:512
v_mfma_f32_16x16x32_bf16 v[208:211], v[124:127], v[88:91], v[208:211]
ds_read_b128 v[36:39], v2 offset:2048
v_mfma_f32_16x16x32_bf16 v[136:139], v[116:119], v[88:91], v[136:139]
ds_read_b128 v[40:43], v2 offset:4096
v_mfma_f32_16x16x32_bf16 v[140:143], v[116:119], v[92:95], v[140:143]
ds_read_b128 v[44:47], v2 offset:6144
v_mfma_f32_16x16x32_bf16 v[212:215], v[124:127], v[92:95], v[212:215]
ds_read_b128 v[48:51], v2 offset:8192
v_mfma_f32_16x16x32_bf16 v[176:179], v[120:123], v[92:95], v[176:179]
ds_read_b128 v[52:55], v2 offset:10240
v_mfma_f32_16x16x32_bf16 v[180:183], v[120:123], v[96:99], v[180:183]
ds_read_b128 v[56:59], v2 offset:12288
v_mfma_f32_16x16x32_bf16 v[216:219], v[124:127], v[96:99], v[216:219]
ds_read_b128 v[60:63], v2 offset:14336
v_mfma_f32_16x16x32_bf16 v[144:147], v[116:119], v[96:99], v[144:147]
ds_read_b128 v[64:67], v2 offset:16384
v_mfma_f32_16x16x32_bf16 v[148:151], v[116:119], v[100:103], v[148:151]
v_mfma_f32_16x16x32_bf16 v[220:223], v[124:127], v[100:103], v[220:223]
v_mfma_f32_16x16x32_bf16 v[184:187], v[120:123], v[100:103], v[184:187]
v_mfma_f32_16x16x32_bf16 v[188:191], v[120:123], v[104:107], v[188:191]
v_mfma_f32_16x16x32_bf16 v[224:227], v[124:127], v[104:107], v[224:227]
v_mfma_f32_16x16x32_bf16 v[152:155], v[116:119], v[104:107], v[152:155]
v_mfma_f32_16x16x32_bf16 v[156:159], v[116:119], v[108:111], v[156:159]
v_mfma_f32_16x16x32_bf16 v[228:231], v[124:127], v[108:111], v[228:231]
v_mfma_f32_16x16x32_bf16 v[192:195], v[120:123], v[108:111], v[192:195]
v_mfma_f32_16x16x32_bf16 v[196:199], v[120:123], v[112:115], v[196:199]
v_mfma_f32_16x16x32_bf16 v[232:235], v[124:127], v[112:115], v[232:235]
v_mfma_f32_16x16x32_bf16 v[160:163], v[116:119], v[112:115], v[160:163]
s_sub_u32 s41, s41, 1
s_cmp_lg_u32 s41, 0
s_cbranch_scc1 Lcl_8
s_waitcnt lgkmcnt(0)
v_mfma_f32_16x16x32_bf16 v[164:167], v[72:75], v[32:35], v[164:167]
ds_read_b128 v[80:83], v3 offset:0
v_mfma_f32_16x16x32_bf16 v[200:203], v[76:79], v[32:35], v[200:203]
ds_read_b64_tr_b16 v[120:121], v6 offset:12288
v_mfma_f32_16x16x32_bf16 v[128:131], v[68:71], v[32:35], v[128:131]
ds_read_b64_tr_b16 v[122:123], v6 offset:12800
v_mfma_f32_16x16x32_bf16 v[132:135], v[68:71], v[36:39], v[132:135]
ds_read_b64_tr_b16 v[124:125], v6 offset:20480
v_mfma_f32_16x16x32_bf16 v[204:207], v[76:79], v[36:39], v[204:207]
ds_read_b64_tr_b16 v[126:127], v6 offset:20992
v_mfma_f32_16x16x32_bf16 v[168:171], v[72:75], v[36:39], v[168:171]
ds_read_b64_tr_b16 v[116:117], v6 offset:4096
v_mfma_f32_16x16x32_bf16 v[172:175], v[72:75], v[40:43], v[172:175]
ds_read_b64_tr_b16 v[118:119], v6 offset:4608
v_mfma_f32_16x16x32_bf16 v[208:211], v[76:79], v[40:43], v[208:211]
ds_read_b128 v[84:87], v3 offset:2048
v_mfma_f32_16x16x32_bf16 v[136:139], v[68:71], v[40:43], v[136:139]
ds_read_b128 v[88:91], v3 offset:4096
v_mfma_f32_16x16x32_bf16 v[140:143], v[68:71], v[44:47], v[140:143]
ds_read_b128 v[92:95], v3 offset:6144
v_mfma_f32_16x16x32_bf16 v[212:215], v[76:79], v[44:47], v[212:215]
ds_read_b128 v[96:99], v3 offset:8192
v_mfma_f32_16x16x32_bf16 v[176:179], v[72:75], v[44:47], v[176:179]
ds_read_b128 v[100:103], v3 offset:10240
v_mfma_f32_16x16x32_bf16 v[180:183], v[72:75], v[48:51], v[180:183]
ds_read_b128 v[104:107], v3 offset:12288
v_mfma_f32_16x16x32_bf16 v[216:219], v[76:79], v[48:51], v[216:219]
ds_read_b128 v[108:111], v3 offset:14336
v_mfma_f32_16x16x32_bf16 v[144:147], v[68:71], v[48:51], v[144:147]
ds_read_b128 v[112:115], v3 offset:16384
v_mfma_f32_16x16x32_bf16 v[148:151], v[68:71], v[52:55], v[148:151]
v_mfma_f32_16x16x32_bf16 v[220:223], v[76:79], v[52:55], v[220:223]
v_mfma_f32_16x16x32_bf16 v[184:187], v[72:75], v[52:55], v[184:187]
v_mfma_f32_16x16x32_bf16 v[188:191], v[72:75], v[56:59], v[188:191]
v_mfma_f32_16x16x32_bf16 v[224:227], v[76:79], v[56:59], v[224:227]
v_mfma_f32_16x16x32_bf16 v[152:155], v[68:71], v[56:59], v[152:155]
v_mfma_f32_16x16x32_bf16 v[156:159], v[68:71], v[60:63], v[156:159]
v_mfma_f32_16x16x32_bf16 v[228:231], v[76:79], v[60:63], v[228:231]
v_mfma_f32_16x16x32_bf16 v[192:195], v[72:75], v[60:63], v[192:195]
v_mfma_f32_16x16x32_bf16 v[196:199], v[72:75], v[64:67], v[196:199]
v_mfma_f32_16x16x32_bf16 v[232:235], v[76:79], v[64:67], v[232:235]
v_mfma_f32_16x16x32_bf16 v[160:163], v[68:71], v[64:67], v[160:163]
s_waitcnt lgkmcnt(0)
v_mfma_f32_16x16x32_bf16 v[164:167], v[120:123], v[80:83], v[164:167]
v_mfma_f32_16x16x32_bf16 v[200:203], v[124:127], v[80:83], v[200:203]
v_mfma_f32_16x16x32_bf16 v[128:131], v[116:119], v[80:83], v[128:131]
v_mfma_f32_16x16x32_bf16 v[132:135], v[116:119], v[84:87], v[132:135]
v_mfma_f32_16x16x32_bf16 v[204:207], v[124:127], v[84:87], v[204:207]
v_mfma_f32_16x16x32_bf16 v[168:171], v[120:123], v[84:87], v[168:171]
v_mfma_f32_16x16x32_bf16 v[172:175], v[120:123], v[88:91], v[172:175]
v_mfma_f32_16x16x32_bf16 v[208:211], v[124:127], v[88:91], v[208:211]
v_mfma_f32_16x16x32_bf16 v[136:139], v[116:119], v[88:91], v[136:139]
v_mfma_f32_16x16x32_bf16 v[140:143], v[116:119], v[92:95], v[140:143]
v_mfma_f32_16x16x32_bf16 v[212:215], v[124:127], v[92:95], v[212:215]
v_mfma_f32_16x16x32_bf16 v[176:179], v[120:123], v[92:95], v[176:179]
v_mfma_f32_16x16x32_bf16 v[180:183], v[120:123], v[96:99], v[180:183]
v_mfma_f32_16x16x32_bf16 v[216:219], v[124:127], v[96:99], v[216:219]
v_mfma_f32_16x16x32_bf16 v[144:147], v[116:119], v[96:99], v[144:147]
v_mfma_f32_16x16x32_bf16 v[148:151], v[116:119], v[100:103], v[148:151]
v_mfma_f32_16x16x32_bf16 v[220:223], v[124:127], v[100:103], v[220:223]
v_mfma_f32_16x16x32_bf16 v[184:187], v[120:123], v[100:103], v[184:187]
v_mfma_f32_16x16x32_bf16 v[188:191], v[120:123], v[104:107], v[188:191]
v_mfma_f32_16x16x32_bf16 v[224:227], v[124:127], v[104:107], v[224:227]
v_mfma_f32_16x16x32_bf16 v[152:155], v[116:119], v[104:107], v[152:155]
v_mfma_f32_16x16x32_bf16 v[156:159], v[116:119], v[108:111], v[156:159]
v_mfma_f32_16x16x32_bf16 v[228:231], v[124:127], v[108:111], v[228:231]
v_mfma_f32_16x16x32_bf16 v[192:195], v[120:123], v[108:111], v[192:195]
v_mfma_f32_16x16x32_bf16 v[196:199], v[120:123], v[112:115], v[196:199]
v_mfma_f32_16x16x32_bf16 v[232:235], v[124:127], v[112:115], v[232:235]
v_mfma_f32_16x16x32_bf16 v[160:163], v[116:119], v[112:115], v[160:163]
v_lshlrev_b32 v14, 3, v12
v_add_u32 v14, 147456, v14
v_mul_u32_u24 v15, 400, v12
v_lshl_add_u32 v15, v13, 3, v15
s_lshl_b32 s43, s36, 5
v_add_u32 v15, s43, v15
s_barrier
ds_read_b64 v[32:33], v14 offset:0
ds_read_b64 v[34:35], v14 offset:128
ds_read_b64 v[36:37], v14 offset:256
ds_read_b64 v[38:39], v14 offset:384
ds_read_b64 v[40:41], v14 offset:512
ds_read_b64 v[42:43], v14 offset:640
ds_read_b64 v[44:45], v14 offset:768
ds_read_b64 v[46:47], v14 offset:896
ds_read_b64 v[48:49], v14 offset:1024
v_mov_b32_dpp v52, v128 row_newbcast:0 row_mask:0xf bank_mask:0xf
v_mov_b32_dpp v53, v129 row_newbcast:0 row_mask:0xf bank_mask:0xf
v_mov_b32_dpp v54, v130 row_newbcast:0 row_mask:0xf bank_mask:0xf
v_mov_b32_dpp v55, v131 row_newbcast:0 row_mask:0xf bank_mask:0xf
v_mov_b32_dpp v56, v164 row_newbcast:0 row_mask:0xf bank_mask:0xf
v_mov_b32_dpp v57, v165 row_newbcast:0 row_mask:0xf bank_mask:0xf
v_mov_b32_dpp v58, v166 row_newbcast:0 row_mask:0xf bank_mask:0xf
v_mov_b32_dpp v59, v167 row_newbcast:0 row_mask:0xf bank_mask:0xf
v_mov_b32_dpp v60, v200 row_newbcast:0 row_mask:0xf bank_mask:0xf
v_mov_b32_dpp v61, v201 row_newbcast:0 row_mask:0xf bank_mask:0xf
v_mov_b32_dpp v62, v202 row_newbcast:0 row_mask:0xf bank_mask:0xf
v_mov_b32_dpp v63, v203 row_newbcast:0 row_mask:0xf bank_mask:0xf
s_waitcnt lgkmcnt(0)
v_pk_fma_f32 v[164:165], v[32:33], v[56:57], v[164:165] op_sel_hi:[0,1,1] neg_lo:[1,0,0] neg_hi:[1,0,0]
v_pk_fma_f32 v[166:167], v[32:33], v[58:59], v[166:167] op_sel_hi:[0,1,1] neg_lo:[1,0,0] neg_hi:[1,0,0]
v_pk_fma_f32 v[200:201], v[32:33], v[60:61], v[200:201] op_sel_hi:[0,1,1] neg_lo:[1,0,0] neg_hi:[1,0,0]
v_pk_fma_f32 v[202:203], v[32:33], v[62:63], v[202:203] op_sel_hi:[0,1,1] neg_lo:[1,0,0] neg_hi:[1,0,0]
v_pk_mul_f32 v[164:165], v[32:33], v[164:165] op_sel:[1,0] op_sel_hi:[1,1]
v_pk_mul_f32 v[166:167], v[32:33], v[166:167] op_sel:[1,0] op_sel_hi:[1,1]
v_pk_fma_f32 v[132:133], v[34:35], v[52:53], v[132:133] op_sel_hi:[0,1,1] neg_lo:[1,0,0] neg_hi:[1,0,0]
v_pk_fma_f32 v[134:135], v[34:35], v[54:55], v[134:135] op_sel_hi:[0,1,1] neg_lo:[1,0,0] neg_hi:[1,0,0]
v_pk_mul_f32 v[200:201], v[32:33], v[200:201] op_sel:[1,0] op_sel_hi:[1,1]
v_pk_mul_f32 v[202:203], v[32:33], v[202:203] op_sel:[1,0] op_sel_hi:[1,1]
v_cvt_pk_bf16_f32 v164, v164, v165
v_cvt_pk_bf16_f32 v165, v166, v167
ds_write_b64 v15, v[164:165] offset:128
v_pk_fma_f32 v[168:169], v[34:35], v[56:57], v[168:169] op_sel_hi:[0,1,1] neg_lo:[1,0,0] neg_hi:[1,0,0]
v_pk_fma_f32 v[170:171], v[34:35], v[58:59], v[170:171] op_sel_hi:[0,1,1] neg_lo:[1,0,0] neg_hi:[1,0,0]
v_pk_mul_f32 v[132:133], v[34:35], v[132:133] op_sel:[1,0] op_sel_hi:[1,1]
v_pk_mul_f32 v[134:135], v[34:35], v[134:135] op_sel:[1,0] op_sel_hi:[1,1]
v_cvt_pk_bf16_f32 v200, v200, v201
v_cvt_pk_bf16_f32 v201, v202, v203
ds_write_b64 v15, v[200:201] offset:256
v_pk_fma_f32 v[204:205], v[34:35], v[60:61], v[204:205] op_sel_hi:[0,1,1] neg_lo:[1,0,0] neg_hi:[1,0,0]
v_pk_fma_f32 v[206:207], v[34:35], v[62:63], v[206:207] op_sel_hi:[0,1,1] neg_lo:[1,0,0] neg_hi:[1,0,0]
v_pk_mul_f32 v[168:169], v[34:35], v[168:169] op_sel:[1,0] op_sel_hi:[1,1]
v_pk_mul_f32 v[170:171], v[34:35], v[170:171] op_sel:[1,0] op_sel_hi:[1,1]
v_cvt_pk_bf16_f32 v132, v132, v133
v_cvt_pk_bf16_f32 v133, v134, v135
ds_write_b64 v15, v[132:133] offset:6400
v_pk_fma_f32 v[136:137], v[36:37], v[52:53], v[136:137] op_sel_hi:[0,1,1] neg_lo:[1,0,0] neg_hi:[1,0,0]
v_pk_fma_f32 v[138:139], v[36:37], v[54:55], v[138:139] op_sel_hi:[0,1,1] neg_lo:[1,0,0] neg_hi:[1,0,0]
v_pk_mul_f32 v[204:205], v[34:35], v[204:205] op_sel:[1,0] op_sel_hi:[1,1]
v_pk_mul_f32 v[206:207], v[34:35], v[206:207] op_sel:[1,0] op_sel_hi:[1,1]
v_cvt_pk_bf16_f32 v168, v168, v169
v_cvt_pk_bf16_f32 v169, v170, v171
ds_write_b64 v15, v[168:169] offset:6528
v_pk_fma_f32 v[172:173], v[36:37], v[56:57], v[172:173] op_sel_hi:[0,1,1] neg_lo:[1,0,0] neg_hi:[1,0,0]
v_pk_fma_f32 v[174:175], v[36:37], v[58:59], v[174:175] op_sel_hi:[0,1,1] neg_lo:[1,0,0] neg_hi:[1,0,0]
v_pk_mul_f32 v[136:137], v[36:37], v[136:137] op_sel:[1,0] op_sel_hi:[1,1]
v_pk_mul_f32 v[138:139], v[36:37], v[138:139] op_sel:[1,0] op_sel_hi:[1,1]
v_cvt_pk_bf16_f32 v204, v204, v205
v_cvt_pk_bf16_f32 v205, v206, v207
ds_write_b64 v15, v[204:205] offset:6656
v_pk_fma_f32 v[208:209], v[36:37], v[60:61], v[208:209] op_sel_hi:[0,1,1] neg_lo:[1,0,0] neg_hi:[1,0,0]
v_pk_fma_f32 v[210:211], v[36:37], v[62:63], v[210:211] op_sel_hi:[0,1,1] neg_lo:[1,0,0] neg_hi:[1,0,0]
v_pk_mul_f32 v[172:173], v[36:37], v[172:173] op_sel:[1,0] op_sel_hi:[1,1]
v_pk_mul_f32 v[174:175], v[36:37], v[174:175] op_sel:[1,0] op_sel_hi:[1,1]
v_cvt_pk_bf16_f32 v136, v136, v137
v_cvt_pk_bf16_f32 v137, v138, v139
ds_write_b64 v15, v[136:137] offset:12800
v_pk_fma_f32 v[140:141], v[38:39], v[52:53], v[140:141] op_sel_hi:[0,1,1] neg_lo:[1,0,0] neg_hi:[1,0,0]
v_pk_fma_f32 v[142:143], v[38:39], v[54:55], v[142:143] op_sel_hi:[0,1,1] neg_lo:[1,0,0] neg_hi:[1,0,0]
v_pk_mul_f32 v[208:209], v[36:37], v[208:209] op_sel:[1,0] op_sel_hi:[1,1]
v_pk_mul_f32 v[210:211], v[36:37], v[210:211] op_sel:[1,0] op_sel_hi:[1,1]
v_cvt_pk_bf16_f32 v172, v172, v173
v_cvt_pk_bf16_f32 v173, v174, v175
ds_write_b64 v15, v[172:173] offset:12928
v_pk_fma_f32 v[176:177], v[38:39], v[56:57], v[176:177] op_sel_hi:[0,1,1] neg_lo:[1,0,0] neg_hi:[1,0,0]
v_pk_fma_f32 v[178:179], v[38:39], v[58:59], v[178:179] op_sel_hi:[0,1,1] neg_lo:[1,0,0] neg_hi:[1,0,0]
v_pk_mul_f32 v[140:141], v[38:39], v[140:141] op_sel:[1,0] op_sel_hi:[1,1]
v_pk_mul_f32 v[142:143], v[38:39], v[142:143] op_sel:[1,0] op_sel_hi:[1,1]
v_cvt_pk_bf16_f32 v208, v208, v209
v_cvt_pk_bf16_f32 v209, v210, v211
ds_write_b64 v15, v[208:209] offset:13056
v_pk_fma_f32 v[212:213], v[38:39], v[60:61], v[212:213] op_sel_hi:[0,1,1] neg_lo:[1,0,0] neg_hi:[1,0,0]
v_pk_fma_f32 v[214:215], v[38:39], v[62:63], v[214:215] op_sel_hi:[0,1,1] neg_lo:[1,0,0] neg_hi:[1,0,0]
v_pk_mul_f32 v[176:177], v[38:39], v[176:177] op_sel:[1,0] op_sel_hi:[1,1]
v_pk_mul_f32 v[178:179], v[38:39], v[178:179] op_sel:[1,0] op_sel_hi:[1,1]
v_cvt_pk_bf16_f32 v140, v140, v141
v_cvt_pk_bf16_f32 v141, v142, v143
ds_write_b64 v15, v[140:141] offset:19200
v_pk_fma_f32 v[144:145], v[40:41], v[52:53], v[144:145] op_sel_hi:[0,1,1] neg_lo:[1,0,0] neg_hi:[1,0,0]
v_pk_fma_f32 v[146:147], v[40:41], v[54:55], v[146:147] op_sel_hi:[0,1,1] neg_lo:[1,0,0] neg_hi:[1,0,0]
v_pk_mul_f32 v[212:213], v[38:39], v[212:213] op_sel:[1,0] op_sel_hi:[1,1]
v_pk_mul_f32 v[214:215], v[38:39], v[214:215] op_sel:[1,0] op_sel_hi:[1,1]
v_cvt_pk_bf16_f32 v176, v176, v177
v_cvt_pk_bf16_f32 v177, v178, v179
ds_write_b64 v15, v[176:177] offset:19328
v_pk_fma_f32 v[180:181], v[40:41], v[56:57], v[180:181] op_sel_hi:[0,1,1] neg_lo:[1,0,0] neg_hi:[1,0,0]
v_pk_fma_f32 v[182:183], v[40:41], v[58:59], v[182:183] op_sel_hi:[0,1,1] neg_lo:[1,0,0] neg_hi:[1,0,0]
v_pk_mul_f32 v[144:145], v[40:41], v[144:145] op_sel:[1,0] op_sel_hi:[1,1]
v_pk_mul_f32 v[146:147], v[40:41], v[146:147] op_sel:[1,0] op_sel_hi:[1,1]
v_cvt_pk_bf16_f32 v212, v212, v213
v_cvt_pk_bf16_f32 v213, v214, v215
ds_write_b64 v15, v[212:213] offset:19456
v_pk_fma_f32 v[216:217], v[40:41], v[60:61], v[216:217] op_sel_hi:[0,1,1] neg_lo:[1,0,0] neg_hi:[1,0,0]
v_pk_fma_f32 v[218:219], v[40:41], v[62:63], v[218:219] op_sel_hi:[0,1,1] neg_lo:[1,0,0] neg_hi:[1,0,0]
v_pk_mul_f32 v[180:181], v[40:41], v[180:181] op_sel:[1,0] op_sel_hi:[1,1]
v_pk_mul_f32 v[182:183], v[40:41], v[182:183] op_sel:[1,0] op_sel_hi:[1,1]
v_cvt_pk_bf16_f32 v144, v144, v145
v_cvt_pk_bf16_f32 v145, v146, v147
ds_write_b64 v15, v[144:145] offset:25600
v_pk_fma_f32 v[148:149], v[42:43], v[52:53], v[148:149] op_sel_hi:[0,1,1] neg_lo:[1,0,0] neg_hi:[1,0,0]
v_pk_fma_f32 v[150:151], v[42:43], v[54:55], v[150:151] op_sel_hi:[0,1,1] neg_lo:[1,0,0] neg_hi:[1,0,0]
v_pk_mul_f32 v[216:217], v[40:41], v[216:217] op_sel:[1,0] op_sel_hi:[1,1]
v_pk_mul_f32 v[218:219], v[40:41], v[218:219] op_sel:[1,0] op_sel_hi:[1,1]
v_cvt_pk_bf16_f32 v180, v180, v181
v_cvt_pk_bf16_f32 v181, v182, v183
ds_write_b64 v15, v[180:181] offset:25728
v_pk_fma_f32 v[184:185], v[42:43], v[56:57], v[184:185] op_sel_hi:[0,1,1] neg_lo:[1,0,0] neg_hi:[1,0,0]
v_pk_fma_f32 v[186:187], v[42:43], v[58:59], v[186:187] op_sel_hi:[0,1,1] neg_lo:[1,0,0] neg_hi:[1,0,0]
v_pk_mul_f32 v[148:149], v[42:43], v[148:149] op_sel:[1,0] op_sel_hi:[1,1]
v_pk_mul_f32 v[150:151], v[42:43], v[150:151] op_sel:[1,0] op_sel_hi:[1,1]
v_cvt_pk_bf16_f32 v216, v216, v217
v_cvt_pk_bf16_f32 v217, v218, v219
ds_write_b64 v15, v[216:217] offset:25856
v_pk_fma_f32 v[220:221], v[42:43], v[60:61], v[220:221] op_sel_hi:[0,1,1] neg_lo:[1,0,0] neg_hi:[1,0,0]
v_pk_fma_f32 v[222:223], v[42:43], v[62:63], v[222:223] op_sel_hi:[0,1,1] neg_lo:[1,0,0] neg_hi:[1,0,0]
v_pk_mul_f32 v[184:185], v[42:43], v[184:185] op_sel:[1,0] op_sel_hi:[1,1]
v_pk_mul_f32 v[186:187], v[42:43], v[186:187] op_sel:[1,0] op_sel_hi:[1,1]
v_cvt_pk_bf16_f32 v148, v148, v149
v_cvt_pk_bf16_f32 v149, v150, v151
ds_write_b64 v15, v[148:149] offset:32000
v_pk_fma_f32 v[152:153], v[44:45], v[52:53], v[152:153] op_sel_hi:[0,1,1] neg_lo:[1,0,0] neg_hi:[1,0,0]
v_pk_fma_f32 v[154:155], v[44:45], v[54:55], v[154:155] op_sel_hi:[0,1,1] neg_lo:[1,0,0] neg_hi:[1,0,0]
v_pk_mul_f32 v[220:221], v[42:43], v[220:221] op_sel:[1,0] op_sel_hi:[1,1]
v_pk_mul_f32 v[222:223], v[42:43], v[222:223] op_sel:[1,0] op_sel_hi:[1,1]
v_cvt_pk_bf16_f32 v184, v184, v185
v_cvt_pk_bf16_f32 v185, v186, v187
ds_write_b64 v15, v[184:185] offset:32128
v_pk_fma_f32 v[188:189], v[44:45], v[56:57], v[188:189] op_sel_hi:[0,1,1] neg_lo:[1,0,0] neg_hi:[1,0,0]
v_pk_fma_f32 v[190:191], v[44:45], v[58:59], v[190:191] op_sel_hi:[0,1,1] neg_lo:[1,0,0] neg_hi:[1,0,0]
v_pk_mul_f32 v[152:153], v[44:45], v[152:153] op_sel:[1,0] op_sel_hi:[1,1]
v_pk_mul_f32 v[154:155], v[44:45], v[154:155] op_sel:[1,0] op_sel_hi:[1,1]
v_cvt_pk_bf16_f32 v220, v220, v221
v_cvt_pk_bf16_f32 v221, v222, v223
ds_write_b64 v15, v[220:221] offset:32256
v_pk_fma_f32 v[224:225], v[44:45], v[60:61], v[224:225] op_sel_hi:[0,1,1] neg_lo:[1,0,0] neg_hi:[1,0,0]
v_pk_fma_f32 v[226:227], v[44:45], v[62:63], v[226:227] op_sel_hi:[0,1,1] neg_lo:[1,0,0] neg_hi:[1,0,0]
v_pk_mul_f32 v[188:189], v[44:45], v[188:189] op_sel:[1,0] op_sel_hi:[1,1]
v_pk_mul_f32 v[190:191], v[44:45], v[190:191] op_sel:[1,0] op_sel_hi:[1,1]
v_cvt_pk_bf16_f32 v152, v152, v153
v_cvt_pk_bf16_f32 v153, v154, v155
ds_write_b64 v15, v[152:153] offset:38400
v_pk_fma_f32 v[156:157], v[46:47], v[52:53], v[156:157] op_sel_hi:[0,1,1] neg_lo:[1,0,0] neg_hi:[1,0,0]
v_pk_fma_f32 v[158:159], v[46:47], v[54:55], v[158:159] op_sel_hi:[0,1,1] neg_lo:[1,0,0] neg_hi:[1,0,0]
v_pk_mul_f32 v[224:225], v[44:45], v[224:225] op_sel:[1,0] op_sel_hi:[1,1]
v_pk_mul_f32 v[226:227], v[44:45], v[226:227] op_sel:[1,0] op_sel_hi:[1,1]
v_cvt_pk_bf16_f32 v188, v188, v189
v_cvt_pk_bf16_f32 v189, v190, v191
ds_write_b64 v15, v[188:189] offset:38528
v_pk_fma_f32 v[192:193], v[46:47], v[56:57], v[192:193] op_sel_hi:[0,1,1] neg_lo:[1,0,0] neg_hi:[1,0,0]
v_pk_fma_f32 v[194:195], v[46:47], v[58:59], v[194:195] op_sel_hi:[0,1,1] neg_lo:[1,0,0] neg_hi:[1,0,0]
v_pk_mul_f32 v[156:157], v[46:47], v[156:157] op_sel:[1,0] op_sel_hi:[1,1]
v_pk_mul_f32 v[158:159], v[46:47], v[158:159] op_sel:[1,0] op_sel_hi:[1,1]
v_cvt_pk_bf16_f32 v224, v224, v225
v_cvt_pk_bf16_f32 v225, v226, v227
ds_write_b64 v15, v[224:225] offset:38656
v_pk_fma_f32 v[228:229], v[46:47], v[60:61], v[228:229] op_sel_hi:[0,1,1] neg_lo:[1,0,0] neg_hi:[1,0,0]
v_pk_fma_f32 v[230:231], v[46:47], v[62:63], v[230:231] op_sel_hi:[0,1,1] neg_lo:[1,0,0] neg_hi:[1,0,0]
v_pk_mul_f32 v[192:193], v[46:47], v[192:193] op_sel:[1,0] op_sel_hi:[1,1]
v_pk_mul_f32 v[194:195], v[46:47], v[194:195] op_sel:[1,0] op_sel_hi:[1,1]
v_cvt_pk_bf16_f32 v156, v156, v157
v_cvt_pk_bf16_f32 v157, v158, v159
ds_write_b64 v15, v[156:157] offset:44800
v_pk_fma_f32 v[160:161], v[48:49], v[52:53], v[160:161] op_sel_hi:[0,1,1] neg_lo:[1,0,0] neg_hi:[1,0,0]
v_pk_fma_f32 v[162:163], v[48:49], v[54:55], v[162:163] op_sel_hi:[0,1,1] neg_lo:[1,0,0] neg_hi:[1,0,0]
v_pk_mul_f32 v[228:229], v[46:47], v[228:229] op_sel:[1,0] op_sel_hi:[1,1]
v_pk_mul_f32 v[230:231], v[46:47], v[230:231] op_sel:[1,0] op_sel_hi:[1,1]
v_cvt_pk_bf16_f32 v192, v192, v193
v_cvt_pk_bf16_f32 v193, v194, v195
ds_write_b64 v15, v[192:193] offset:44928
v_pk_fma_f32 v[196:197], v[48:49], v[56:57], v[196:197] op_sel_hi:[0,1,1] neg_lo:[1,0,0] neg_hi:[1,0,0]
v_pk_fma_f32 v[198:199], v[48:49], v[58:59], v[198:199] op_sel_hi:[0,1,1] neg_lo:[1,0,0] neg_hi:[1,0,0]
v_pk_mul_f32 v[160:161], v[48:49], v[160:161] op_sel:[1,0] op_sel_hi:[1,1]
v_pk_mul_f32 v[162:163], v[48:49], v[162:163] op_sel:[1,0] op_sel_hi:[1,1]
v_cvt_pk_bf16_f32 v228, v228, v229
v_cvt_pk_bf16_f32 v229, v230, v231
ds_write_b64 v15, v[228:229] offset:45056
v_pk_fma_f32 v[232:233], v[48:49], v[60:61], v[232:233] op_sel_hi:[0,1,1] neg_lo:[1,0,0] neg_hi:[1,0,0]
v_pk_fma_f32 v[234:235], v[48:49], v[62:63], v[234:235] op_sel_hi:[0,1,1] neg_lo:[1,0,0] neg_hi:[1,0,0]
v_pk_mul_f32 v[196:197], v[48:49], v[196:197] op_sel:[1,0] op_sel_hi:[1,1]
v_pk_mul_f32 v[198:199], v[48:49], v[198:199] op_sel:[1,0] op_sel_hi:[1,1]
v_cvt_pk_bf16_f32 v160, v160, v161
v_cvt_pk_bf16_f32 v161, v162, v163
ds_write_b64 v15, v[160:161] offset:51200
v_pk_mul_f32 v[232:233], v[48:49], v[232:233] op_sel:[1,0] op_sel_hi:[1,1]
v_pk_mul_f32 v[234:235], v[48:49], v[234:235] op_sel:[1,0] op_sel_hi:[1,1]
v_cvt_pk_bf16_f32 v196, v196, v197
v_cvt_pk_bf16_f32 v197, v198, v199
ds_write_b64 v15, v[196:197] offset:51328
v_cvt_pk_bf16_f32 v232, v232, v233
v_cvt_pk_bf16_f32 v233, v234, v235
ds_write_b64 v15, v[232:233] offset:51456
s_waitcnt lgkmcnt(0)
s_branch Latt_5
Lpf_4:
s_lshl_b32 s43, s35, 7
s_waitcnt lgkmcnt(0)
s_mov_b32 s8, s64
s_mov_b32 s9, s65
s_mov_b32 s10, 4194304
s_mov_b32 s11, 0x20000
s_add_u32 s12, s66, s43
s_addc_u32 s13, s67, 0
s_mov_b32 s14, 6289536
s_mov_b32 s15, 0x20000
s_add_u32 s84, s82, 28311552
s_addc_u32 s85, s83, 0
s_mov_b32 s86, 49152
s_mov_b32 s87, 0x20000
s_mov_b32 s56, s80
s_mov_b32 s57, s81
s_mov_b32 s58, 256
s_mov_b32 s59, 0x20000
v_mov_b32 v5, 0
v_lshlrev_b32 v14, 7, v1
s_or_b32 s43, s34, s35
s_cmp_lg_u32 s43, 0
s_cbranch_scc1 Lz_9
s_movk_i32 s43, 0x2000
buffer_store_dword v5, v14, s[84:87], 0 offen sc1
s_bfm_b64 exec, 44, 0
buffer_store_dword v5, v14, s[84:87], s43 offen sc1
s_mov_b64 exec, 1
v_mov_b32 v6, 1
s_waitcnt vmcnt(0)
buffer_store_dword v6, v5, s[56:59], 0 offen sc1
s_mov_b64 exec, -1
Lz_9:
s_lshl_b32 s43, s51, 11
buffer_load_dwordx4 v[96:99], v10, s[8:11], s43 offen offset:0
buffer_load_dwordx4 v[100:103], v10, s[8:11], s43 offen offset:1024
buffer_load_dwordx4 v[104:107], v10, s[8:11], s43 offen offset:2048
buffer_load_dwordx4 v[108:111], v10, s[8:11], s43 offen offset:3072
v_min_u32 v14, 23, v1
v_lshrrev_b32 v15, 3, v14
v_mul_u32_u24 v15, 43008, v15
v_and_b32 v14, 7, v14
v_lshl_add_u32 v15, v14, 4, v15
v_mov_b32 v32, 0x3f803f80
v_mov_b32 v33, 0x3f803f80
v_mov_b32 v34, 0x3f803f80
v_mov_b32 v35, 0x3f803f80
ds_write_b128 v15, v[32:35]
s_add_u32 s20, s82, 26214400
s_addc_u32 s21, s83, 0
s_mov_b32 s22, 16384
s_mov_b32 s23, 0x20000
s_add_u32 s43, s2, 128
s_lshl_b32 s43, s43, 7
v_lshlrev_b32 v14, 2, v1
s_mov_b64 exec, 15
buffer_store_dword v5, v14, s[84:87], s43 offen sc1
s_mov_b64 exec, -1
s_lshl_b32 s52, s34, 7
s_add_u32 s52, s52, 28319744
s_sub_u32 s53, s52, 128
s_cmp_eq_u32 s34, 0
s_cselect_b32 s53, s52, s53
s_waitcnt lgkmcnt(0)
s_barrier
s_waitcnt vmcnt(1)
s_mov_b32 s43, 0x3f803f80
v_mov_b32 v116, 0
v_mov_b32 v117, 0
v_mov_b32 v118, 0
v_mov_b32 v119, 0
v_mov_b32 v120, 0
v_mov_b32 v121, 0
v_mov_b32 v122, 0
v_mov_b32 v123, 0
v_dot2_f32_bf16 v116, v96, s43, v116
v_dot2_f32_bf16 v120, v96, v96, v120
v_dot2_f32_bf16 v118, v104, s43, v118
v_dot2_f32_bf16 v122, v104, v104, v122
v_dot2_f32_bf16 v117, v97, s43, v117
v_dot2_f32_bf16 v121, v97, v97, v121
v_dot2_f32_bf16 v119, v105, s43, v119
v_dot2_f32_bf16 v123, v105, v105, v123
v_dot2_f32_bf16 v116, v98, s43, v116
v_dot2_f32_bf16 v120, v98, v98, v120
v_dot2_f32_bf16 v118, v106, s43, v118
v_dot2_f32_bf16 v122, v106, v106, v122
v_dot2_f32_bf16 v117, v99, s43, v117
v_dot2_f32_bf16 v121, v99, v99, v121
v_dot2_f32_bf16 v119, v107, s43, v119
v_dot2_f32_bf16 v123, v107, v107, v123
v_dot2_f32_bf16 v116, v100, s43, v116
v_dot2_f32_bf16 v120, v100, v100, v120
v_dot2_f32_bf16 v118, v108, s43, v118
v_dot2_f32_bf16 v122, v108, v108, v122
v_dot2_f32_bf16 v117, v101, s43, v117
v_dot2_f32_bf16 v121, v101, v101, v121
v_dot2_f32_bf16 v119, v109, s43, v119
v_dot2_f32_bf16 v123, v109, v109, v123
v_dot2_f32_bf16 v116, v102, s43, v116
v_dot2_f32_bf16 v120, v102, v102, v120
v_dot2_f32_bf16 v118, v110, s43, v118
v_dot2_f32_bf16 v122, v110, v110, v122
s_branch Lov_3
.p2align 12
Lst_3_0:
s_branch Lwr_142
s_nop 0
s_nop 0
Lov_3:
v_dot2_f32_bf16 v117, v103, s43, v117
v_dot2_f32_bf16 v121, v103, v103, v121
v_dot2_f32_bf16 v119, v111, s43, v119
v_dot2_f32_bf16 v123, v111, v111, v123
s_nop 2
v_add_f32 v116, v116, v117
v_add_f32 v118, v118, v119
v_add_f32 v120, v120, v121
v_add_f32 v122, v122, v123
s_nop 1
v_permlane32_swap_b32 v116, v118
v_permlane32_swap_b32 v120, v122
v_add_f32 v116, v116, v118
v_add_f32 v120, v120, v122
s_nop 1
v_permlane16_swap_b32 v116, v120
v_add_f32 v116, v116, v120
s_nop 1
v_add_f32_dpp v116, v116, v116 row_ror:8 row_mask:0xf bank_mask:0xf
s_nop 1
v_add_f32_dpp v116, v116, v116 row_ror:4 row_mask:0xf bank_mask:0xf
s_nop 1
v_add_f32_dpp v116, v116, v116 row_ror:2 row_mask:0xf bank_mask:0xf
s_nop 1
v_add_f32_dpp v116, v116, v116 row_ror:1 row_mask:0xf bank_mask:0xf
v_mov_b32 v117, v116
s_nop 1
v_permlane16_swap_b32 v116, v117
v_mul_f32 v112, 0x3a800000, v116
v_mul_f32 v113, 0x3a800000, v117
v_fma_f32 v113, -v112, v112, v113
v_max_f32 v113, 0, v113
v_add_f32 v113, 0x3727c5ac, v113
v_rsq_f32 v113, v113
v_lshrrev_b32 v11, 5, v1
s_lshl_b32 s43, s47, 4
s_add_u32 s43, s43, 148608
v_lshl_add_u32 v11, v11, 3, s43
ds_write_b64 v11, v[112:113]
s_waitcnt lgkmcnt(0)
s_mov_b32 s28, s66
s_mov_b32 s29, s67
s_mov_b32 s30, 6291456
s_mov_b32 s31, 0x20000
s_mul_i32 s43, s2, 9216
s_add_u32 s43, s43, 1572864
v_lshlrev_b32 v30, 7, v1
buffer_load_dword v31, v30, s[28:31], s43 offen
s_add_u32 s43, s43, 8192
s_bfm_b64 exec, 8, 0
buffer_load_dword v31, v30, s[28:31], s43 offen
s_mov_b64 exec, -1
s_branch Lst_0_0
Lwr_139:
s_barrier
v_lshlrev_b32 v5, 4, v1
v_and_b32 v5, 63, v5
v_add_u32 v6, 148608, v5
ds_read_b128 v[112:115], v6
s_lshl_b32 s43, s63, 3
v_add_u32 v5, s43, v5
s_waitcnt lgkmcnt(0)
s_mov_b64 exec, 15
buffer_store_dwordx4 v[112:115], v5, s[20:23], 0 offen sc1
s_mov_b64 exec, -1
v_mov_b32 v4, 0
buffer_load_dword v6, v4, s[56:59], 0 offen sc1
s_mov_b32 s62, 0
s_branch Lst_1_0
Lwr_140:
s_barrier
s_mov_b32 s28, s66
s_mov_b32 s29, s67
s_mov_b32 s30, 6291456
s_mov_b32 s31, 0x20000
s_mul_i32 s43, s2, 9216
s_add_u32 s43, s43, 3932160
v_lshlrev_b32 v30, 7, v1
buffer_load_dword v31, v30, s[28:31], s43 offen
s_add_u32 s43, s43, 8192
s_bfm_b64 exec, 8, 0
buffer_load_dword v31, v30, s[28:31], s43 offen
s_mov_b64 exec, -1
s_lshl_b32 s43, s35, 7
s_add_u32 s28, s68, s43
s_addc_u32 s29, s69, 0
s_mov_b32 s30, 2095232
s_mov_b32 s31, 0x20000
v_and_b32 v29, 7, v1
v_lshrrev_b32 v30, 3, v1
v_lshl_add_u32 v29, v30, 6, v29
s_lshl_b32 s43, s48, 3
v_add_u32 v29, s43, v29
v_lshlrev_b32 v29, 11, v29
s_mov_b32 s43, 1048576
s_mov_b32 s28, s68
s_mov_b32 s29, s69
s_mov_b32 s30, 2097152
s_mov_b32 s31, 0x20000
s_lshl_b32 s43, s2, 13
v_lshlrev_b32 v29, 7, v1
buffer_load_dword v30, v29, s[28:31], s43 offen
s_branch Lst_2_0
Lwr_141:
s_barrier
s_branch Lst_3_0
Lwr_142:
s_barrier
s_cmp_eq_u32 s62, 3
s_cbranch_scc1 Lste_12
s_cmp_eq_u32 s62, 2
s_cbranch_scc1 Lst2_11
s_waitcnt lgkmcnt(0)
s_cmp_eq_u32 s62, 1
s_cbranch_scc1 Lst1_10
s_waitcnt vmcnt(3)
v_readfirstlane_b32 s54, v6
s_cmp_eq_u32 s54, 0
s_cbranch_scc0 Lrep_13
buffer_load_dword v6, v4, s[56:59], 0 offen sc1
s_branch Lste_12
Lrep_13:
s_add_u32 s7, s34, 64
s_lshl_b32 s7, s7, 7
v_mov_b32 v5, s7
v_mov_b32 v6, 1
s_mov_b64 exec, 1
buffer_atomic_add v6, v5, s[84:87], 0 offen sc1
s_mov_b64 exec, -1
s_mov_b32 s62, 1
s_load_dword s54, s[82:83], s52 glc
s_load_dword s55, s[82:83], s53 glc
s_branch Lste_12
Lst1_10:
s_and_b32 s54, s54, s55
s_cmp_eq_u32 s54, 16
s_cbranch_scc1 Lg_14
s_load_dword s54, s[82:83], s52 glc
s_load_dword s55, s[82:83], s53 glc
s_branch Lste_12
Lg_14:
v_add_u32 v5, 0, v1
v_min_u32 v5, 143, v5
v_lshlrev_b32 v20, 3, v5
v_add_u32 v5, s50, v5
v_max_i32 v5, 0, v5
v_lshlrev_b32 v5, 3, v5
buffer_load_dwordx2 v[32:33], v5, s[20:23], 0 offen sc1
v_add_u32 v5, 64, v1
v_min_u32 v5, 143, v5
v_lshlrev_b32 v21, 3, v5
v_add_u32 v5, s50, v5
v_max_i32 v5, 0, v5
v_lshlrev_b32 v5, 3, v5
buffer_load_dwordx2 v[34:35], v5, s[20:23], 0 offen sc1
v_add_u32 v5, 128, v1
v_min_u32 v5, 143, v5
v_lshlrev_b32 v22, 3, v5
v_add_u32 v5, s50, v5
v_max_i32 v5, 0, v5
v_lshlrev_b32 v5, 3, v5
buffer_load_dwordx2 v[36:37], v5, s[20:23], 0 offen sc1
s_mov_b32 s62, 2
s_branch Lste_12
Lst2_11:
s_waitcnt vmcnt(0)
v_add_u32 v20, 147456, v20
ds_write_b64 v20, v[32:33]
v_add_u32 v21, 147456, v21
ds_write_b64 v21, v[34:35]
v_add_u32 v22, 147456, v22
ds_write_b64 v22, v[36:37]
s_waitcnt lgkmcnt(0)
s_mov_b32 s62, 3
Lste_12:
s_branch Lst_4_0
Lwr_143:
s_barrier
s_cmp_eq_u32 s62, 3
s_cbranch_scc1 Lste_17
s_cmp_eq_u32 s62, 2
s_cbranch_scc1 Lst2_16
s_waitcnt lgkmcnt(0)
s_cmp_eq_u32 s62, 1
s_cbranch_scc1 Lst1_15
s_waitcnt vmcnt(0)
v_readfirstlane_b32 s54, v6
s_cmp_eq_u32 s54, 0
s_cbranch_scc0 Lrep_18
buffer_load_dword v6, v4, s[56:59], 0 offen sc1
s_branch Lste_17
Lrep_18:
s_add_u32 s7, s34, 64
s_lshl_b32 s7, s7, 7
v_mov_b32 v5, s7
v_mov_b32 v6, 1
s_mov_b64 exec, 1
buffer_atomic_add v6, v5, s[84:87], 0 offen sc1
s_mov_b64 exec, -1
s_mov_b32 s62, 1
s_load_dword s54, s[82:83], s52 glc
s_load_dword s55, s[82:83], s53 glc
s_branch Lste_17
Lst1_15:
s_and_b32 s54, s54, s55
s_cmp_eq_u32 s54, 16
s_cbranch_scc1 Lg_19
s_load_dword s54, s[82:83], s52 glc
s_load_dword s55, s[82:83], s53 glc
s_branch Lste_17
Lg_19:
v_add_u32 v5, 0, v1
v_min_u32 v5, 143, v5
v_lshlrev_b32 v20, 3, v5
v_add_u32 v5, s50, v5
v_max_i32 v5, 0, v5
v_lshlrev_b32 v5, 3, v5
buffer_load_dwordx2 v[32:33], v5, s[20:23], 0 offen sc1
v_add_u32 v5, 64, v1
v_min_u32 v5, 143, v5
v_lshlrev_b32 v21, 3, v5
v_add_u32 v5, s50, v5
v_max_i32 v5, 0, v5
v_lshlrev_b32 v5, 3, v5
buffer_load_dwordx2 v[34:35], v5, s[20:23], 0 offen sc1
v_add_u32 v5, 128, v1
v_min_u32 v5, 143, v5
v_lshlrev_b32 v22, 3, v5
v_add_u32 v5, s50, v5
v_max_i32 v5, 0, v5
v_lshlrev_b32 v5, 3, v5
buffer_load_dwordx2 v[36:37], v5, s[20:23], 0 offen sc1
s_mov_b32 s62, 2
s_branch Lste_17
Lst2_16:
s_waitcnt vmcnt(0)
v_add_u32 v20, 147456, v20
ds_write_b64 v20, v[32:33]
v_add_u32 v21, 147456, v21
ds_write_b64 v21, v[34:35]
v_add_u32 v22, 147456, v22
ds_write_b64 v22, v[36:37]
s_waitcnt lgkmcnt(0)
s_mov_b32 s62, 3
Lste_17:
s_branch Lst_5_0
Lwr_144:
s_barrier
s_cmp_eq_u32 s62, 3
s_cbranch_scc1 Lste_22
s_cmp_eq_u32 s62, 2
s_cbranch_scc1 Lst2_21
s_waitcnt lgkmcnt(0)
s_cmp_eq_u32 s62, 1
s_cbranch_scc1 Lst1_20
s_waitcnt vmcnt(0)
v_readfirstlane_b32 s54, v6
s_cmp_eq_u32 s54, 0
s_cbranch_scc0 Lrep_23
buffer_load_dword v6, v4, s[56:59], 0 offen sc1
s_branch Lste_22
Lrep_23:
s_add_u32 s7, s34, 64
s_lshl_b32 s7, s7, 7
v_mov_b32 v5, s7
v_mov_b32 v6, 1
s_mov_b64 exec, 1
buffer_atomic_add v6, v5, s[84:87], 0 offen sc1
s_mov_b64 exec, -1
s_mov_b32 s62, 1
s_load_dword s54, s[82:83], s52 glc
s_load_dword s55, s[82:83], s53 glc
s_branch Lste_22
Lst1_20:
s_and_b32 s54, s54, s55
s_cmp_eq_u32 s54, 16
s_cbranch_scc1 Lg_24
s_load_dword s54, s[82:83], s52 glc
s_load_dword s55, s[82:83], s53 glc
s_branch Lste_22
Lg_24:
v_add_u32 v5, 0, v1
v_min_u32 v5, 143, v5
v_lshlrev_b32 v20, 3, v5
v_add_u32 v5, s50, v5
v_max_i32 v5, 0, v5
v_lshlrev_b32 v5, 3, v5
buffer_load_dwordx2 v[32:33], v5, s[20:23], 0 offen sc1
v_add_u32 v5, 64, v1
v_min_u32 v5, 143, v5
v_lshlrev_b32 v21, 3, v5
v_add_u32 v5, s50, v5
v_max_i32 v5, 0, v5
v_lshlrev_b32 v5, 3, v5
buffer_load_dwordx2 v[34:35], v5, s[20:23], 0 offen sc1
v_add_u32 v5, 128, v1
v_min_u32 v5, 143, v5
v_lshlrev_b32 v22, 3, v5
v_add_u32 v5, s50, v5
v_max_i32 v5, 0, v5
v_lshlrev_b32 v5, 3, v5
buffer_load_dwordx2 v[36:37], v5, s[20:23], 0 offen sc1
s_mov_b32 s62, 2
s_branch Lste_22
Lst2_21:
s_waitcnt vmcnt(0)
v_add_u32 v20, 147456, v20
ds_write_b64 v20, v[32:33]
v_add_u32 v21, 147456, v21
ds_write_b64 v21, v[34:35]
v_add_u32 v22, 147456, v22
ds_write_b64 v22, v[36:37]
s_waitcnt lgkmcnt(0)
s_mov_b32 s62, 3
Lste_22:
s_branch Lst_6_0
Lwr_145:
s_barrier
s_cmp_eq_u32 s62, 3
s_cbranch_scc1 Lste_27
s_cmp_eq_u32 s62, 2
s_cbranch_scc1 Lst2_26
s_waitcnt lgkmcnt(0)
s_cmp_eq_u32 s62, 1
s_cbranch_scc1 Lst1_25
s_waitcnt vmcnt(0)
v_readfirstlane_b32 s54, v6
s_cmp_eq_u32 s54, 0
s_cbranch_scc0 Lrep_28
buffer_load_dword v6, v4, s[56:59], 0 offen sc1
s_branch Lste_27
Lrep_28:
s_add_u32 s7, s34, 64
s_lshl_b32 s7, s7, 7
v_mov_b32 v5, s7
v_mov_b32 v6, 1
s_mov_b64 exec, 1
buffer_atomic_add v6, v5, s[84:87], 0 offen sc1
s_mov_b64 exec, -1
s_mov_b32 s62, 1
s_load_dword s54, s[82:83], s52 glc
s_load_dword s55, s[82:83], s53 glc
s_branch Lste_27
Lst1_25:
s_and_b32 s54, s54, s55
s_cmp_eq_u32 s54, 16
s_cbranch_scc1 Lg_29
s_load_dword s54, s[82:83], s52 glc
s_load_dword s55, s[82:83], s53 glc
s_branch Lste_27
Lg_29:
v_add_u32 v5, 0, v1
v_min_u32 v5, 143, v5
v_lshlrev_b32 v20, 3, v5
v_add_u32 v5, s50, v5
v_max_i32 v5, 0, v5
v_lshlrev_b32 v5, 3, v5
buffer_load_dwordx2 v[32:33], v5, s[20:23], 0 offen sc1
v_add_u32 v5, 64, v1
v_min_u32 v5, 143, v5
v_lshlrev_b32 v21, 3, v5
v_add_u32 v5, s50, v5
v_max_i32 v5, 0, v5
v_lshlrev_b32 v5, 3, v5
buffer_load_dwordx2 v[34:35], v5, s[20:23], 0 offen sc1
v_add_u32 v5, 128, v1
v_min_u32 v5, 143, v5
v_lshlrev_b32 v22, 3, v5
v_add_u32 v5, s50, v5
v_max_i32 v5, 0, v5
v_lshlrev_b32 v5, 3, v5
buffer_load_dwordx2 v[36:37], v5, s[20:23], 0 offen sc1
s_mov_b32 s62, 2
s_branch Lste_27
Lst2_26:
s_waitcnt vmcnt(0)
v_add_u32 v20, 147456, v20
ds_write_b64 v20, v[32:33]
v_add_u32 v21, 147456, v21
ds_write_b64 v21, v[34:35]
v_add_u32 v22, 147456, v22
ds_write_b64 v22, v[36:37]
s_waitcnt lgkmcnt(0)
s_mov_b32 s62, 3
Lste_27:
s_branch Lst_7_0
Lwr_146:
s_barrier
s_cmp_eq_u32 s62, 3
s_cbranch_scc1 Lste_32
s_cmp_eq_u32 s62, 2
s_cbranch_scc1 Lst2_31
s_waitcnt lgkmcnt(0)
s_cmp_eq_u32 s62, 1
s_cbranch_scc1 Lst1_30
s_waitcnt vmcnt(0)
v_readfirstlane_b32 s54, v6
s_cmp_eq_u32 s54, 0
s_cbranch_scc0 Lrep_33
buffer_load_dword v6, v4, s[56:59], 0 offen sc1
s_branch Lste_32
Lrep_33:
s_add_u32 s7, s34, 64
s_lshl_b32 s7, s7, 7
v_mov_b32 v5, s7
v_mov_b32 v6, 1
s_mov_b64 exec, 1
buffer_atomic_add v6, v5, s[84:87], 0 offen sc1
s_mov_b64 exec, -1
s_mov_b32 s62, 1
s_load_dword s54, s[82:83], s52 glc
s_load_dword s55, s[82:83], s53 glc
s_branch Lste_32
Lst1_30:
s_and_b32 s54, s54, s55
s_cmp_eq_u32 s54, 16
s_cbranch_scc1 Lg_34
s_load_dword s54, s[82:83], s52 glc
s_load_dword s55, s[82:83], s53 glc
s_branch Lste_32
Lg_34:
v_add_u32 v5, 0, v1
v_min_u32 v5, 143, v5
v_lshlrev_b32 v20, 3, v5
v_add_u32 v5, s50, v5
v_max_i32 v5, 0, v5
v_lshlrev_b32 v5, 3, v5
buffer_load_dwordx2 v[32:33], v5, s[20:23], 0 offen sc1
v_add_u32 v5, 64, v1
v_min_u32 v5, 143, v5
v_lshlrev_b32 v21, 3, v5
v_add_u32 v5, s50, v5
v_max_i32 v5, 0, v5
v_lshlrev_b32 v5, 3, v5
buffer_load_dwordx2 v[34:35], v5, s[20:23], 0 offen sc1
v_add_u32 v5, 128, v1
v_min_u32 v5, 143, v5
v_lshlrev_b32 v22, 3, v5
v_add_u32 v5, s50, v5
v_max_i32 v5, 0, v5
v_lshlrev_b32 v5, 3, v5
buffer_load_dwordx2 v[36:37], v5, s[20:23], 0 offen sc1
s_mov_b32 s62, 2
s_branch Lste_32
Lst2_31:
s_waitcnt vmcnt(0)
v_add_u32 v20, 147456, v20
ds_write_b64 v20, v[32:33]
v_add_u32 v21, 147456, v21
ds_write_b64 v21, v[34:35]
v_add_u32 v22, 147456, v22
ds_write_b64 v22, v[36:37]
s_waitcnt lgkmcnt(0)
s_mov_b32 s62, 3
Lste_32:
s_branch Lst_8_0
Lwr_147:
s_barrier
s_cmp_eq_u32 s62, 3
s_cbranch_scc1 Lste_37
s_cmp_eq_u32 s62, 2
s_cbranch_scc1 Lst2_36
s_waitcnt lgkmcnt(0)
s_cmp_eq_u32 s62, 1
s_cbranch_scc1 Lst1_35
s_waitcnt vmcnt(0)
v_readfirstlane_b32 s54, v6
s_cmp_eq_u32 s54, 0
s_cbranch_scc0 Lrep_38
buffer_load_dword v6, v4, s[56:59], 0 offen sc1
s_branch Lste_37
Lrep_38:
s_add_u32 s7, s34, 64
s_lshl_b32 s7, s7, 7
v_mov_b32 v5, s7
v_mov_b32 v6, 1
s_mov_b64 exec, 1
buffer_atomic_add v6, v5, s[84:87], 0 offen sc1
s_mov_b64 exec, -1
s_mov_b32 s62, 1
s_load_dword s54, s[82:83], s52 glc
s_load_dword s55, s[82:83], s53 glc
s_branch Lste_37
Lst1_35:
s_and_b32 s54, s54, s55
s_cmp_eq_u32 s54, 16
s_cbranch_scc1 Lg_39
s_load_dword s54, s[82:83], s52 glc
s_load_dword s55, s[82:83], s53 glc
s_branch Lste_37
Lg_39:
v_add_u32 v5, 0, v1
v_min_u32 v5, 143, v5
v_lshlrev_b32 v20, 3, v5
v_add_u32 v5, s50, v5
v_max_i32 v5, 0, v5
v_lshlrev_b32 v5, 3, v5
buffer_load_dwordx2 v[32:33], v5, s[20:23], 0 offen sc1
v_add_u32 v5, 64, v1
v_min_u32 v5, 143, v5
v_lshlrev_b32 v21, 3, v5
v_add_u32 v5, s50, v5
v_max_i32 v5, 0, v5
v_lshlrev_b32 v5, 3, v5
buffer_load_dwordx2 v[34:35], v5, s[20:23], 0 offen sc1
v_add_u32 v5, 128, v1
v_min_u32 v5, 143, v5
v_lshlrev_b32 v22, 3, v5
v_add_u32 v5, s50, v5
v_max_i32 v5, 0, v5
v_lshlrev_b32 v5, 3, v5
buffer_load_dwordx2 v[36:37], v5, s[20:23], 0 offen sc1
s_mov_b32 s62, 2
s_branch Lste_37
Lst2_36:
s_waitcnt vmcnt(0)
v_add_u32 v20, 147456, v20
ds_write_b64 v20, v[32:33]
v_add_u32 v21, 147456, v21
ds_write_b64 v21, v[34:35]
v_add_u32 v22, 147456, v22
ds_write_b64 v22, v[36:37]
s_waitcnt lgkmcnt(0)
s_mov_b32 s62, 3
Lste_37:
s_branch Lst_9_0
Lwr_148:
s_barrier
s_cmp_eq_u32 s62, 3
s_cbranch_scc1 Lste_42
s_cmp_eq_u32 s62, 2
s_cbranch_scc1 Lst2_41
s_waitcnt lgkmcnt(0)
s_cmp_eq_u32 s62, 1
s_cbranch_scc1 Lst1_40
s_waitcnt vmcnt(0)
v_readfirstlane_b32 s54, v6
s_cmp_eq_u32 s54, 0
s_cbranch_scc0 Lrep_43
buffer_load_dword v6, v4, s[56:59], 0 offen sc1
s_branch Lste_42
Lrep_43:
s_add_u32 s7, s34, 64
s_lshl_b32 s7, s7, 7
v_mov_b32 v5, s7
v_mov_b32 v6, 1
s_mov_b64 exec, 1
buffer_atomic_add v6, v5, s[84:87], 0 offen sc1
s_mov_b64 exec, -1
s_mov_b32 s62, 1
s_load_dword s54, s[82:83], s52 glc
s_load_dword s55, s[82:83], s53 glc
s_branch Lste_42
Lst1_40:
s_and_b32 s54, s54, s55
s_cmp_eq_u32 s54, 16
s_cbranch_scc1 Lg_44
s_load_dword s54, s[82:83], s52 glc
s_load_dword s55, s[82:83], s53 glc
s_branch Lste_42
Lg_44:
v_add_u32 v5, 0, v1
v_min_u32 v5, 143, v5
v_lshlrev_b32 v20, 3, v5
v_add_u32 v5, s50, v5
v_max_i32 v5, 0, v5
v_lshlrev_b32 v5, 3, v5
buffer_load_dwordx2 v[32:33], v5, s[20:23], 0 offen sc1
v_add_u32 v5, 64, v1
v_min_u32 v5, 143, v5
v_lshlrev_b32 v21, 3, v5
v_add_u32 v5, s50, v5
v_max_i32 v5, 0, v5
v_lshlrev_b32 v5, 3, v5
buffer_load_dwordx2 v[34:35], v5, s[20:23], 0 offen sc1
v_add_u32 v5, 128, v1
v_min_u32 v5, 143, v5
v_lshlrev_b32 v22, 3, v5
v_add_u32 v5, s50, v5
v_max_i32 v5, 0, v5
v_lshlrev_b32 v5, 3, v5
buffer_load_dwordx2 v[36:37], v5, s[20:23], 0 offen sc1
s_mov_b32 s62, 2
s_branch Lste_42
Lst2_41:
s_waitcnt vmcnt(0)
v_add_u32 v20, 147456, v20
ds_write_b64 v20, v[32:33]
v_add_u32 v21, 147456, v21
ds_write_b64 v21, v[34:35]
v_add_u32 v22, 147456, v22
ds_write_b64 v22, v[36:37]
s_waitcnt lgkmcnt(0)
s_mov_b32 s62, 3
Lste_42:
s_branch Lst_10_0
Lwr_149:
s_barrier
s_cmp_eq_u32 s62, 3
s_cbranch_scc1 Lste_47
s_cmp_eq_u32 s62, 2
s_cbranch_scc1 Lst2_46
s_waitcnt lgkmcnt(0)
s_cmp_eq_u32 s62, 1
s_cbranch_scc1 Lst1_45
s_waitcnt vmcnt(0)
v_readfirstlane_b32 s54, v6
s_cmp_eq_u32 s54, 0
s_cbranch_scc0 Lrep_48
buffer_load_dword v6, v4, s[56:59], 0 offen sc1
s_branch Lste_47
Lrep_48:
s_add_u32 s7, s34, 64
s_lshl_b32 s7, s7, 7
v_mov_b32 v5, s7
v_mov_b32 v6, 1
s_mov_b64 exec, 1
buffer_atomic_add v6, v5, s[84:87], 0 offen sc1
s_mov_b64 exec, -1
s_mov_b32 s62, 1
s_load_dword s54, s[82:83], s52 glc
s_load_dword s55, s[82:83], s53 glc
s_branch Lste_47
Lst1_45:
s_and_b32 s54, s54, s55
s_cmp_eq_u32 s54, 16
s_cbranch_scc1 Lg_49
s_load_dword s54, s[82:83], s52 glc
s_load_dword s55, s[82:83], s53 glc
s_branch Lste_47
Lg_49:
v_add_u32 v5, 0, v1
v_min_u32 v5, 143, v5
v_lshlrev_b32 v20, 3, v5
v_add_u32 v5, s50, v5
v_max_i32 v5, 0, v5
v_lshlrev_b32 v5, 3, v5
buffer_load_dwordx2 v[32:33], v5, s[20:23], 0 offen sc1
v_add_u32 v5, 64, v1
v_min_u32 v5, 143, v5
v_lshlrev_b32 v21, 3, v5
v_add_u32 v5, s50, v5
v_max_i32 v5, 0, v5
v_lshlrev_b32 v5, 3, v5
buffer_load_dwordx2 v[34:35], v5, s[20:23], 0 offen sc1
v_add_u32 v5, 128, v1
v_min_u32 v5, 143, v5
v_lshlrev_b32 v22, 3, v5
v_add_u32 v5, s50, v5
v_max_i32 v5, 0, v5
v_lshlrev_b32 v5, 3, v5
buffer_load_dwordx2 v[36:37], v5, s[20:23], 0 offen sc1
s_mov_b32 s62, 2
s_branch Lste_47
Lst2_46:
s_waitcnt vmcnt(0)
v_add_u32 v20, 147456, v20
ds_write_b64 v20, v[32:33]
v_add_u32 v21, 147456, v21
ds_write_b64 v21, v[34:35]
v_add_u32 v22, 147456, v22
ds_write_b64 v22, v[36:37]
s_waitcnt lgkmcnt(0)
s_mov_b32 s62, 3
Lste_47:
s_branch Lst_11_0
Lwr_150:
s_barrier
s_cmp_eq_u32 s62, 3
s_cbranch_scc1 Lste_52
s_cmp_eq_u32 s62, 2
s_cbranch_scc1 Lst2_51
s_waitcnt lgkmcnt(0)
s_cmp_eq_u32 s62, 1
s_cbranch_scc1 Lst1_50
s_waitcnt vmcnt(0)
v_readfirstlane_b32 s54, v6
s_cmp_eq_u32 s54, 0
s_cbranch_scc0 Lrep_53
buffer_load_dword v6, v4, s[56:59], 0 offen sc1
s_branch Lste_52
Lrep_53:
s_add_u32 s7, s34, 64
s_lshl_b32 s7, s7, 7
v_mov_b32 v5, s7
v_mov_b32 v6, 1
s_mov_b64 exec, 1
buffer_atomic_add v6, v5, s[84:87], 0 offen sc1
s_mov_b64 exec, -1
s_mov_b32 s62, 1
s_load_dword s54, s[82:83], s52 glc
s_load_dword s55, s[82:83], s53 glc
s_branch Lste_52
Lst1_50:
s_and_b32 s54, s54, s55
s_cmp_eq_u32 s54, 16
s_cbranch_scc1 Lg_54
s_load_dword s54, s[82:83], s52 glc
s_load_dword s55, s[82:83], s53 glc
s_branch Lste_52
Lg_54:
v_add_u32 v5, 0, v1
v_min_u32 v5, 143, v5
v_lshlrev_b32 v20, 3, v5
v_add_u32 v5, s50, v5
v_max_i32 v5, 0, v5
v_lshlrev_b32 v5, 3, v5
buffer_load_dwordx2 v[32:33], v5, s[20:23], 0 offen sc1
v_add_u32 v5, 64, v1
v_min_u32 v5, 143, v5
v_lshlrev_b32 v21, 3, v5
v_add_u32 v5, s50, v5
v_max_i32 v5, 0, v5
v_lshlrev_b32 v5, 3, v5
buffer_load_dwordx2 v[34:35], v5, s[20:23], 0 offen sc1
v_add_u32 v5, 128, v1
v_min_u32 v5, 143, v5
v_lshlrev_b32 v22, 3, v5
v_add_u32 v5, s50, v5
v_max_i32 v5, 0, v5
v_lshlrev_b32 v5, 3, v5
buffer_load_dwordx2 v[36:37], v5, s[20:23], 0 offen sc1
s_mov_b32 s62, 2
s_branch Lste_52
Lst2_51:
s_waitcnt vmcnt(0)
v_add_u32 v20, 147456, v20
ds_write_b64 v20, v[32:33]
v_add_u32 v21, 147456, v21
ds_write_b64 v21, v[34:35]
v_add_u32 v22, 147456, v22
ds_write_b64 v22, v[36:37]
s_waitcnt lgkmcnt(0)
s_mov_b32 s62, 3
Lste_52:
s_branch Lst_12_0
Lwr_151:
s_barrier
s_cmp_eq_u32 s62, 3
s_cbranch_scc1 Lste_57
s_cmp_eq_u32 s62, 2
s_cbranch_scc1 Lst2_56
s_waitcnt lgkmcnt(0)
s_cmp_eq_u32 s62, 1
s_cbranch_scc1 Lst1_55
s_waitcnt vmcnt(0)
v_readfirstlane_b32 s54, v6
s_cmp_eq_u32 s54, 0
s_cbranch_scc0 Lrep_58
buffer_load_dword v6, v4, s[56:59], 0 offen sc1
s_branch Lste_57
Lrep_58:
s_add_u32 s7, s34, 64
s_lshl_b32 s7, s7, 7
v_mov_b32 v5, s7
v_mov_b32 v6, 1
s_mov_b64 exec, 1
buffer_atomic_add v6, v5, s[84:87], 0 offen sc1
s_mov_b64 exec, -1
s_mov_b32 s62, 1
s_load_dword s54, s[82:83], s52 glc
s_load_dword s55, s[82:83], s53 glc
s_branch Lste_57
Lst1_55:
s_and_b32 s54, s54, s55
s_cmp_eq_u32 s54, 16
s_cbranch_scc1 Lg_59
s_load_dword s54, s[82:83], s52 glc
s_load_dword s55, s[82:83], s53 glc
s_branch Lste_57
Lg_59:
v_add_u32 v5, 0, v1
v_min_u32 v5, 143, v5
v_lshlrev_b32 v20, 3, v5
v_add_u32 v5, s50, v5
v_max_i32 v5, 0, v5
v_lshlrev_b32 v5, 3, v5
buffer_load_dwordx2 v[32:33], v5, s[20:23], 0 offen sc1
v_add_u32 v5, 64, v1
v_min_u32 v5, 143, v5
v_lshlrev_b32 v21, 3, v5
v_add_u32 v5, s50, v5
v_max_i32 v5, 0, v5
v_lshlrev_b32 v5, 3, v5
buffer_load_dwordx2 v[34:35], v5, s[20:23], 0 offen sc1
v_add_u32 v5, 128, v1
v_min_u32 v5, 143, v5
v_lshlrev_b32 v22, 3, v5
v_add_u32 v5, s50, v5
v_max_i32 v5, 0, v5
v_lshlrev_b32 v5, 3, v5
buffer_load_dwordx2 v[36:37], v5, s[20:23], 0 offen sc1
s_mov_b32 s62, 2
s_branch Lste_57
Lst2_56:
s_waitcnt vmcnt(0)
v_add_u32 v20, 147456, v20
ds_write_b64 v20, v[32:33]
v_add_u32 v21, 147456, v21
ds_write_b64 v21, v[34:35]
v_add_u32 v22, 147456, v22
ds_write_b64 v22, v[36:37]
s_waitcnt lgkmcnt(0)
s_mov_b32 s62, 3
Lste_57:
s_branch Lst_13_0
Lwr_152:
s_barrier
s_cmp_eq_u32 s62, 3
s_cbranch_scc1 Lste_62
s_cmp_eq_u32 s62, 2
s_cbranch_scc1 Lst2_61
s_waitcnt lgkmcnt(0)
s_cmp_eq_u32 s62, 1
s_cbranch_scc1 Lst1_60
s_waitcnt vmcnt(0)
v_readfirstlane_b32 s54, v6
s_cmp_eq_u32 s54, 0
s_cbranch_scc0 Lrep_63
buffer_load_dword v6, v4, s[56:59], 0 offen sc1
s_branch Lste_62
Lrep_63:
s_add_u32 s7, s34, 64
s_lshl_b32 s7, s7, 7
v_mov_b32 v5, s7
v_mov_b32 v6, 1
s_mov_b64 exec, 1
buffer_atomic_add v6, v5, s[84:87], 0 offen sc1
s_mov_b64 exec, -1
s_mov_b32 s62, 1
s_load_dword s54, s[82:83], s52 glc
s_load_dword s55, s[82:83], s53 glc
s_branch Lste_62
Lst1_60:
s_and_b32 s54, s54, s55
s_cmp_eq_u32 s54, 16
s_cbranch_scc1 Lg_64
s_load_dword s54, s[82:83], s52 glc
s_load_dword s55, s[82:83], s53 glc
s_branch Lste_62
Lg_64:
v_add_u32 v5, 0, v1
v_min_u32 v5, 143, v5
v_lshlrev_b32 v20, 3, v5
v_add_u32 v5, s50, v5
v_max_i32 v5, 0, v5
v_lshlrev_b32 v5, 3, v5
buffer_load_dwordx2 v[32:33], v5, s[20:23], 0 offen sc1
v_add_u32 v5, 64, v1
s_branch Lov_4
.p2align 12
Lst_4_0:
s_branch Lwr_143
s_nop 0
s_nop 0
Lov_4:
v_min_u32 v5, 143, v5
v_lshlrev_b32 v21, 3, v5
v_add_u32 v5, s50, v5
v_max_i32 v5, 0, v5
v_lshlrev_b32 v5, 3, v5
buffer_load_dwordx2 v[34:35], v5, s[20:23], 0 offen sc1
v_add_u32 v5, 128, v1
v_min_u32 v5, 143, v5
v_lshlrev_b32 v22, 3, v5
v_add_u32 v5, s50, v5
v_max_i32 v5, 0, v5
v_lshlrev_b32 v5, 3, v5
buffer_load_dwordx2 v[36:37], v5, s[20:23], 0 offen sc1
s_mov_b32 s62, 2
s_branch Lste_62
Lst2_61:
s_waitcnt vmcnt(0)
v_add_u32 v20, 147456, v20
ds_write_b64 v20, v[32:33]
v_add_u32 v21, 147456, v21
ds_write_b64 v21, v[34:35]
v_add_u32 v22, 147456, v22
ds_write_b64 v22, v[36:37]
s_waitcnt lgkmcnt(0)
s_mov_b32 s62, 3
Lste_62:
s_branch Lst_14_0
Lwr_153:
s_barrier
s_cmp_eq_u32 s62, 3
s_cbranch_scc1 Lste_67
s_cmp_eq_u32 s62, 2
s_cbranch_scc1 Lst2_66
s_cmp_eq_u32 s62, 1
s_cbranch_scc1 Lst1_65
s_mov_b32 s41, 0x40000
Lz0_68:
s_waitcnt vmcnt(0)
v_readfirstlane_b32 s54, v6
s_cmp_eq_u32 s54, 0
s_cbranch_scc0 Lzok_69
buffer_load_dword v6, v4, s[56:59], 0 offen sc1
s_sub_u32 s41, s41, 1
s_cmp_lg_u32 s41, 0
s_cbranch_scc1 Lz0_68
s_waitcnt lgkmcnt(0)
Lzok_69:
s_add_u32 s7, s34, 64
s_lshl_b32 s7, s7, 7
v_mov_b32 v5, s7
v_mov_b32 v6, 1
s_mov_b64 exec, 1
buffer_atomic_add v6, v5, s[84:87], 0 offen sc1
s_mov_b64 exec, -1
s_load_dword s54, s[82:83], s52 glc
s_load_dword s55, s[82:83], s53 glc
Lst1_65:
s_mov_b32 s41, 200
Lpoll_70:
s_waitcnt lgkmcnt(0)
s_and_b32 s54, s54, s55
s_cmp_eq_u32 s54, 16
s_cbranch_scc1 Lg_72
s_load_dword s54, s[82:83], s52 glc
s_load_dword s55, s[82:83], s53 glc
s_sub_u32 s41, s41, 1
s_cmp_lg_u32 s41, 0
s_cbranch_scc1 Lpoll_70
s_waitcnt lgkmcnt(0)
s_mov_b32 s41, 0
Lfb_71:
s_add_u32 s62, s50, s41
s_max_i32 s62, s62, 0
s_lshl_b32 s43, s62, 11
buffer_load_dwordx4 v[96:99], v10, s[8:11], s43 offen offset:0
buffer_load_dwordx4 v[100:103], v10, s[8:11], s43 offen offset:1024
buffer_load_dwordx4 v[104:107], v10, s[8:11], s43 offen offset:2048
buffer_load_dwordx4 v[108:111], v10, s[8:11], s43 offen offset:3072
s_waitcnt vmcnt(0)
s_mov_b32 s43, 0x3f803f80
v_mov_b32 v116, 0
v_mov_b32 v117, 0
v_mov_b32 v118, 0
v_mov_b32 v119, 0
v_mov_b32 v120, 0
v_mov_b32 v121, 0
v_mov_b32 v122, 0
v_mov_b32 v123, 0
v_dot2_f32_bf16 v116, v96, s43, v116
v_dot2_f32_bf16 v120, v96, v96, v120
v_dot2_f32_bf16 v118, v104, s43, v118
v_dot2_f32_bf16 v122, v104, v104, v122
v_dot2_f32_bf16 v117, v97, s43, v117
v_dot2_f32_bf16 v121, v97, v97, v121
v_dot2_f32_bf16 v119, v105, s43, v119
v_dot2_f32_bf16 v123, v105, v105, v123
v_dot2_f32_bf16 v116, v98, s43, v116
v_dot2_f32_bf16 v120, v98, v98, v120
v_dot2_f32_bf16 v118, v106, s43, v118
v_dot2_f32_bf16 v122, v106, v106, v122
v_dot2_f32_bf16 v117, v99, s43, v117
v_dot2_f32_bf16 v121, v99, v99, v121
v_dot2_f32_bf16 v119, v107, s43, v119
v_dot2_f32_bf16 v123, v107, v107, v123
v_dot2_f32_bf16 v116, v100, s43, v116
v_dot2_f32_bf16 v120, v100, v100, v120
v_dot2_f32_bf16 v118, v108, s43, v118
v_dot2_f32_bf16 v122, v108, v108, v122
v_dot2_f32_bf16 v117, v101, s43, v117
v_dot2_f32_bf16 v121, v101, v101, v121
v_dot2_f32_bf16 v119, v109, s43, v119
v_dot2_f32_bf16 v123, v109, v109, v123
v_dot2_f32_bf16 v116, v102, s43, v116
v_dot2_f32_bf16 v120, v102, v102, v120
v_dot2_f32_bf16 v118, v110, s43, v118
v_dot2_f32_bf16 v122, v110, v110, v122
v_dot2_f32_bf16 v117, v103, s43, v117
v_dot2_f32_bf16 v121, v103, v103, v121
v_dot2_f32_bf16 v119, v111, s43, v119
v_dot2_f32_bf16 v123, v111, v111, v123
s_nop 2
v_add_f32 v116, v116, v117
v_add_f32 v118, v118, v119
v_add_f32 v120, v120, v121
v_add_f32 v122, v122, v123
s_nop 1
v_permlane32_swap_b32 v116, v118
v_permlane32_swap_b32 v120, v122
v_add_f32 v116, v116, v118
v_add_f32 v120, v120, v122
s_nop 1
v_permlane16_swap_b32 v116, v120
v_add_f32 v116, v116, v120
s_nop 1
v_add_f32_dpp v116, v116, v116 row_ror:8 row_mask:0xf bank_mask:0xf
s_nop 1
v_add_f32_dpp v116, v116, v116 row_ror:4 row_mask:0xf bank_mask:0xf
s_nop 1
v_add_f32_dpp v116, v116, v116 row_ror:2 row_mask:0xf bank_mask:0xf
s_nop 1
v_add_f32_dpp v116, v116, v116 row_ror:1 row_mask:0xf bank_mask:0xf
v_mov_b32 v117, v116
s_nop 1
v_permlane16_swap_b32 v116, v117
v_mul_f32 v112, 0x3a800000, v116
v_mul_f32 v113, 0x3a800000, v117
v_fma_f32 v113, -v112, v112, v113
v_max_f32 v113, 0, v113
v_add_f32 v113, 0x3727c5ac, v113
v_rsq_f32 v113, v113
v_lshrrev_b32 v11, 5, v1
s_lshl_b32 s43, s41, 3
s_add_u32 s43, s43, 147456
v_lshl_add_u32 v11, v11, 3, s43
ds_write_b64 v11, v[112:113]
s_add_u32 s41, s41, 2
s_cmp_lt_u32 s41, 144
s_cbranch_scc1 Lfb_71
s_waitcnt lgkmcnt(0)
s_branch Lste_67
Lg_72:
v_add_u32 v5, 0, v1
v_min_u32 v5, 143, v5
v_lshlrev_b32 v20, 3, v5
v_add_u32 v5, s50, v5
v_max_i32 v5, 0, v5
v_lshlrev_b32 v5, 3, v5
buffer_load_dwordx2 v[32:33], v5, s[20:23], 0 offen sc1
v_add_u32 v5, 64, v1
v_min_u32 v5, 143, v5
v_lshlrev_b32 v21, 3, v5
v_add_u32 v5, s50, v5
v_max_i32 v5, 0, v5
v_lshlrev_b32 v5, 3, v5
buffer_load_dwordx2 v[34:35], v5, s[20:23], 0 offen sc1
v_add_u32 v5, 128, v1
v_min_u32 v5, 143, v5
v_lshlrev_b32 v22, 3, v5
v_add_u32 v5, s50, v5
v_max_i32 v5, 0, v5
v_lshlrev_b32 v5, 3, v5
buffer_load_dwordx2 v[36:37], v5, s[20:23], 0 offen sc1
Lst2_66:
s_waitcnt vmcnt(0)
v_add_u32 v20, 147456, v20
ds_write_b64 v20, v[32:33]
v_add_u32 v21, 147456, v21
ds_write_b64 v21, v[34:35]
v_add_u32 v22, 147456, v22
ds_write_b64 v22, v[36:37]
s_waitcnt lgkmcnt(0)
Lste_67:
s_bitcmp0_b32 s2, 0
s_cselect_b32 s88, s72, s74
s_cselect_b32 s89, s73, s75
s_cmp_lt_u32 s2, 192
s_cselect_b32 s90, 7340032, 0
s_mov_b32 s91, 0x20000
s_bfe_u32 s44, s2, 0x30001
s_lshl_b32 s44, s44, 2
s_and_b32 s43, s36, 3
s_add_u32 s44, s44, s43
s_lshl_b32 s44, s44, 5
v_lshrrev_b32 v18, 4, v1
v_add_u32 v18, s44, v18
v_mul_u32_u24 v18, 7168, v18
v_and_b32 v19, 15, v1
v_lshl_add_u32 v18, v19, 4, v18
s_lshr_b32 s43, s2, 4
s_lshl_b32 s43, s43, 8
s_add_u32 s43, s43, 4096
v_add_u32 v18, s43, v18
s_mov_b32 s43, 0
buffer_load_dwordx4 v[128:131], v18, s[88:91], s43 offen
s_mov_b32 s43, 28672
buffer_load_dwordx4 v[132:135], v18, s[88:91], s43 offen
s_mov_b32 s43, 57344
buffer_load_dwordx4 v[136:139], v18, s[88:91], s43 offen
s_mov_b32 s43, 86016
buffer_load_dwordx4 v[140:143], v18, s[88:91], s43 offen
s_mov_b32 s43, 114688
buffer_load_dwordx4 v[144:147], v18, s[88:91], s43 offen
s_mov_b32 s43, 143360
buffer_load_dwordx4 v[148:151], v18, s[88:91], s43 offen
s_mov_b32 s43, 172032
buffer_load_dwordx4 v[152:155], v18, s[88:91], s43 offen
s_mov_b32 s43, 200704
buffer_load_dwordx4 v[156:159], v18, s[88:91], s43 offen
s_barrier
s_lshl_b32 s43, s35, 7
s_add_u32 s28, s68, s43
s_addc_u32 s29, s69, 0
s_mov_b32 s30, 2095232
s_mov_b32 s31, 0x20000
v_lshrrev_b32 v15, 3, v1
v_and_b32 v16, 6, v15
v_and_b32 v7, 7, v1
v_xor_b32 v7, v7, v16
v_lshlrev_b32 v7, 4, v7
v_mul_u32_u24 v15, 2048, v15
v_add_u32 v7, v7, v15
s_and_b32 s40, s36, 3
s_lshl_b32 s39, s40, 13
s_add_u32 s40, s40, s35
s_add_u32 s42, s40, 0
s_and_b32 s42, s42, 15
s_lshl_b32 s42, s42, 17
s_add_u32 m0, s39, 65536
s_add_u32 s43, s42, 0
buffer_load_dwordx4 v7, s[28:31], s43 offen lds
s_add_u32 m0, s39, 66560
s_add_u32 s43, s42, 16384
buffer_load_dwordx4 v7, s[28:31], s43 offen lds
s_add_u32 m0, s39, 67584
s_add_u32 s43, s42, 32768
buffer_load_dwordx4 v7, s[28:31], s43 offen lds
s_add_u32 m0, s39, 68608
s_add_u32 s43, s42, 49152
buffer_load_dwordx4 v7, s[28:31], s43 offen lds
s_add_u32 m0, s39, 69632
s_add_u32 s43, s42, 65536
buffer_load_dwordx4 v7, s[28:31], s43 offen lds
s_add_u32 m0, s39, 70656
s_add_u32 s43, s42, 81920
buffer_load_dwordx4 v7, s[28:31], s43 offen lds
s_add_u32 m0, s39, 71680
s_add_u32 s43, s42, 98304
buffer_load_dwordx4 v7, s[28:31], s43 offen lds
s_add_u32 m0, s39, 72704
s_add_u32 s43, s42, 114688
buffer_load_dwordx4 v7, s[28:31], s43 offen lds
Lats_6:
s_and_b32 s43, s36, 1
s_bfe_u32 s44, s36, 0x10001
s_lshr_b32 s45, s36, 2
v_lshlrev_b32 v14, 2, v13
v_sub_u32 v14, v12, v14
v_mov_b32 v16, 0xff800000
s_or_b32 s46, s34, s45
s_cmp_lg_u32 s46, 0
s_cselect_b32 s46, 0, 0xff800000
v_subrev_u32 v15, 0, v14
v_cmp_ge_u32 vcc, 7, v15
v_add_u32 v15, 16, v15
s_nop 0
v_cndmask_b32 v248, v16, 0, vcc
v_cmp_ge_u32 vcc, 7, v15
s_nop 1
v_cndmask_b32 v244, v16, 0, vcc
v_or_b32 v240, s46, v244
v_subrev_u32 v15, 1, v14
v_cmp_ge_u32 vcc, 7, v15
v_add_u32 v15, 16, v15
s_nop 0
v_cndmask_b32 v249, v16, 0, vcc
v_cmp_ge_u32 vcc, 7, v15
s_nop 1
v_cndmask_b32 v245, v16, 0, vcc
v_or_b32 v241, s46, v245
v_subrev_u32 v15, 2, v14
v_cmp_ge_u32 vcc, 7, v15
v_add_u32 v15, 16, v15
s_nop 0
v_cndmask_b32 v250, v16, 0, vcc
v_cmp_ge_u32 vcc, 7, v15
s_nop 1
v_cndmask_b32 v246, v16, 0, vcc
v_or_b32 v242, s46, v246
v_subrev_u32 v15, 3, v14
v_cmp_ge_u32 vcc, 7, v15
v_add_u32 v15, 16, v15
s_nop 0
v_cndmask_b32 v251, v16, 0, vcc
v_cmp_ge_u32 vcc, 7, v15
s_nop 1
v_cndmask_b32 v247, v16, 0, vcc
v_or_b32 v243, s46, v247
s_lshl_b32 s46, s45, 6
s_add_u32 s46, s46, s44
s_add_u32 s46, s46, 16
v_lshl_add_u32 v14, v12, 1, s46
s_lshl_b32 s47, s43, 6
v_lshl_add_u32 v15, v13, 4, s47
v_mul_u32_u24 v20, 400, v14
v_add_u32 v20, v20, v15
v_subrev_u32 v16, 32, v14
v_max_i32 v16, 0, v16
v_mul_u32_u24 v21, 400, v16
v_add_u32 v21, v21, v15
v_lshrrev_b32 v16, 2, v12
v_lshl_add_u32 v16, v13, 2, v16
v_lshl_add_u32 v16, v16, 1, s46
v_and_b32 v17, 3, v1
v_lshl_add_u32 v17, v17, 3, s47
v_mul_u32_u24 v22, 400, v16
v_add_u32 v22, v22, v17
v_subrev_u32 v16, 32, v16
v_max_i32 v16, 0, v16
v_mul_u32_u24 v23, 400, v16
v_add_u32 v23, v23, v17
s_mul_i32 s60, s34, 262144
s_add_u32 s16, s82, s60
s_addc_u32 s17, s83, 0
s_mov_b32 s18, 262144
s_mov_b32 s19, 0x20000
s_lshl_b32 s60, s35, 14
s_lshl_b32 s43, s43, 13
s_add_u32 s60, s60, s43
s_lshl_b32 s43, s45, 12
s_add_u32 s60, s60, s43
s_lshl_b32 s43, s44, 10
s_add_u32 s60, s60, s43
v_lshlrev_b32 v24, 4, v1
s_mov_b32 s61, 0x3e8293ee
s_lshl_b32 s38, s35, 7
Latt_5:
s_barrier
ds_read_b128 v[32:35], v20 offset:0
ds_read_b128 v[36:39], v20 offset:128
ds_read_b128 v[40:43], v21 offset:128
ds_read_b128 v[80:83], v20 offset:12800
ds_read_b128 v[84:87], v20 offset:12928
ds_read_b128 v[88:91], v20 offset:128
ds_read_b64_tr_b16 v[44:45], v23 offset:256
ds_read_b64_tr_b16 v[46:47], v22 offset:256
ds_read_b64_tr_b16 v[48:49], v23 offset:288
ds_read_b64_tr_b16 v[50:51], v22 offset:288
ds_read_b64_tr_b16 v[92:93], v22 offset:256
ds_read_b64_tr_b16 v[94:95], v22 offset:13056
ds_read_b64_tr_b16 v[96:97], v22 offset:288
ds_read_b64_tr_b16 v[98:99], v22 offset:13088
s_waitcnt lgkmcnt(11)
v_mfma_f32_16x16x32_bf16 v[52:55], v[40:43], v[32:35], v[240:243]
v_mfma_f32_16x16x32_bf16 v[56:59], v[36:39], v[32:35], v[248:251]
s_waitcnt lgkmcnt(8)
v_mfma_f32_16x16x32_bf16 v[100:103], v[88:91], v[80:83], v[244:247]
v_mfma_f32_16x16x32_bf16 v[104:107], v[84:87], v[80:83], v[248:251]
s_nop 4
v_max3_f32 v60, v52, v53, v54
v_max3_f32 v108, v100, v101, v102
v_max3_f32 v61, v55, v56, v57
v_max3_f32 v109, v103, v104, v105
v_max3_f32 v60, v60, v58, v59
v_max3_f32 v108, v108, v106, v107
v_max_f32 v60, v60, v61
v_max_f32 v108, v108, v109
s_nop 0
v_permlane32_swap_b32 v60, v108
v_max_f32 v60, v60, v108
v_mov_b32 v61, v60
s_nop 1
v_permlane16_swap_b32 v60, v61
v_max_f32 v60, v60, v61
v_mul_f32 v60, s61, v60
s_nop 0
v_mov_b32 v108, v60
s_nop 1
v_permlane32_swap_b32 v60, v108
v_fma_f32 v52, v52, s61, -v60
v_fma_f32 v100, v100, s61, -v108
v_fma_f32 v53, v53, s61, -v60
v_fma_f32 v101, v101, s61, -v108
v_fma_f32 v54, v54, s61, -v60
v_fma_f32 v102, v102, s61, -v108
v_fma_f32 v55, v55, s61, -v60
v_fma_f32 v103, v103, s61, -v108
v_fma_f32 v56, v56, s61, -v60
v_fma_f32 v104, v104, s61, -v108
v_fma_f32 v57, v57, s61, -v60
v_fma_f32 v105, v105, s61, -v108
v_fma_f32 v58, v58, s61, -v60
v_fma_f32 v106, v106, s61, -v108
v_fma_f32 v59, v59, s61, -v60
v_fma_f32 v107, v107, s61, -v108
v_exp_f32 v52, v52
v_exp_f32 v100, v100
v_exp_f32 v53, v53
v_exp_f32 v101, v101
v_exp_f32 v54, v54
v_exp_f32 v102, v102
v_exp_f32 v55, v55
v_exp_f32 v103, v103
v_exp_f32 v56, v56
v_exp_f32 v104, v104
v_exp_f32 v57, v57
v_exp_f32 v105, v105
v_exp_f32 v58, v58
v_exp_f32 v106, v106
v_exp_f32 v59, v59
v_exp_f32 v107, v107
v_cvt_pk_bf16_f32 v64, v52, v53
v_cvt_pk_bf16_f32 v112, v100, v101
v_cvt_pk_bf16_f32 v65, v54, v55
v_cvt_pk_bf16_f32 v113, v102, v103
v_cvt_pk_bf16_f32 v66, v56, v57
v_cvt_pk_bf16_f32 v114, v104, v105
v_cvt_pk_bf16_f32 v67, v58, v59
v_cvt_pk_bf16_f32 v115, v106, v107
v_pk_add_f32 v[52:53], v[52:53], v[54:55]
v_pk_add_f32 v[100:101], v[100:101], v[102:103]
v_pk_add_f32 v[56:57], v[56:57], v[58:59]
v_pk_add_f32 v[104:105], v[104:105], v[106:107]
s_waitcnt lgkmcnt(0)
s_waitcnt lgkmcnt(0)
v_mfma_f32_16x16x32_bf16 v[68:71], v[44:47], v[64:67], 0
v_mfma_f32_16x16x32_bf16 v[116:119], v[92:95], v[112:115], 0
v_mfma_f32_16x16x32_bf16 v[72:75], v[48:51], v[64:67], 0
v_mfma_f32_16x16x32_bf16 v[120:123], v[96:99], v[112:115], 0
v_pk_add_f32 v[52:53], v[52:53], v[56:57]
v_pk_add_f32 v[100:101], v[100:101], v[104:105]
v_add_f32 v60, v52, v53
v_add_f32 v108, v100, v101
s_nop 0
v_permlane32_swap_b32 v60, v108
v_add_f32 v60, v60, v108
v_mov_b32 v61, v60
s_nop 1
v_permlane16_swap_b32 v60, v61
v_add_f32 v60, v60, v61
v_rcp_f32 v60, v60
s_nop 0
v_mov_b32 v108, v60
s_nop 1
v_permlane32_swap_b32 v60, v108
v_pk_mul_f32 v[68:69], v[60:61], v[68:69] op_sel_hi:[0,1]
v_pk_mul_f32 v[116:117], v[108:109], v[116:117] op_sel_hi:[0,1]
v_pk_mul_f32 v[70:71], v[60:61], v[70:71] op_sel_hi:[0,1]
v_pk_mul_f32 v[118:119], v[108:109], v[118:119] op_sel_hi:[0,1]
v_pk_mul_f32 v[72:73], v[60:61], v[72:73] op_sel_hi:[0,1]
v_pk_mul_f32 v[120:121], v[108:109], v[120:121] op_sel_hi:[0,1]
v_pk_mul_f32 v[74:75], v[60:61], v[74:75] op_sel_hi:[0,1]
v_pk_mul_f32 v[122:123], v[108:109], v[122:123] op_sel_hi:[0,1]
v_cvt_pk_bf16_f32 v64, v68, v69
v_cvt_pk_bf16_f32 v112, v116, v117
v_cvt_pk_bf16_f32 v65, v70, v71
v_cvt_pk_bf16_f32 v113, v118, v119
v_cvt_pk_bf16_f32 v66, v72, v73
v_cvt_pk_bf16_f32 v114, v120, v121
v_cvt_pk_bf16_f32 v67, v74, v75
v_cvt_pk_bf16_f32 v115, v122, v123
buffer_store_dwordx4 v[64:67], v24, s[16:19], s60 offen offset:0 sc1
buffer_store_dwordx4 v[112:115], v24, s[16:19], s60 offen offset:2048 sc1
s_cmp_lt_u32 s36, 4
s_cbranch_scc1 Lc_73
s_add_u32 s56, s82, 28311552
s_addc_u32 s57, s83, 0
s_mov_b32 s58, 49152
s_mov_b32 s59, 0x20000
s_add_u32 s28, s68, s38
s_addc_u32 s29, s69, 0
s_mov_b32 s30, 2095232
s_mov_b32 s31, 0x20000
s_add_u32 s42, s40, 4
s_and_b32 s42, s42, 15
s_lshl_b32 s42, s42, 17
s_add_u32 m0, s39, 114688
s_add_u32 s43, s42, 0
buffer_load_dwordx4 v7, s[28:31], s43 offen lds
s_add_u32 m0, s39, 115712
s_add_u32 s43, s42, 16384
buffer_load_dwordx4 v7, s[28:31], s43 offen lds
s_add_u32 m0, s39, 116736
s_add_u32 s43, s42, 32768
buffer_load_dwordx4 v7, s[28:31], s43 offen lds
s_add_u32 m0, s39, 117760
s_add_u32 s43, s42, 49152
buffer_load_dwordx4 v7, s[28:31], s43 offen lds
s_add_u32 m0, s39, 118784
s_add_u32 s43, s42, 65536
buffer_load_dwordx4 v7, s[28:31], s43 offen lds
s_add_u32 m0, s39, 119808
s_add_u32 s43, s42, 81920
buffer_load_dwordx4 v7, s[28:31], s43 offen lds
s_add_u32 m0, s39, 120832
s_add_u32 s43, s42, 98304
buffer_load_dwordx4 v7, s[28:31], s43 offen lds
s_add_u32 m0, s39, 121856
s_add_u32 s43, s42, 114688
buffer_load_dwordx4 v7, s[28:31], s43 offen lds
s_waitcnt vmcnt(8)
s_branch Lo_74
Lc_73:
s_add_u32 s56, s82, 28311552
s_addc_u32 s57, s83, 0
s_mov_b32 s58, 49152
s_mov_b32 s59, 0x20000
s_waitcnt vmcnt(0)
Lo_74:
s_barrier
s_cmp_lg_u32 s36, 0
s_cbranch_scc1 Lsig_75
s_add_u32 s7, s34, 0
s_lshl_b32 s7, s7, 7
v_mov_b32 v4, s7
v_mov_b32 v5, 1
s_mov_b64 exec, 1
buffer_atomic_add v5, v4, s[56:59], 0 offen sc1
s_mov_b64 exec, -1
Lsig_75:
s_cmp_ge_u32 s36, 4
s_cbranch_scc1 Lprod_77
v_and_b32 v12, 15, v1
v_lshrrev_b32 v13, 4, v1
v_lshlrev_b32 v10, 12, v12
v_and_b32 v14, 1, v13
v_lshl_add_u32 v10, v14, 5, v10
v_lshrrev_b32 v14, 1, v13
v_lshl_add_u32 v10, v14, 4, v10
s_lshl_b32 s43, s34, 18
s_lshl_b32 s44, s36, 16
s_add_u32 s43, s43, s44
s_lshl_b32 s44, s35, 7
s_add_u32 s43, s43, s44
buffer_load_dwordx4 v[128:131], v10, s[8:11], s43 offen offset:0
buffer_load_dwordx4 v[132:135], v10, s[8:11], s43 offen offset:64
buffer_load_dwordx4 v[136:139], v10, s[8:11], s43 offen offset:2048
buffer_load_dwordx4 v[140:143], v10, s[8:11], s43 offen offset:2112
s_mul_i32 s43, s34, 262144
s_add_u32 s20, s82, s43
s_addc_u32 s21, s83, 0
s_add_u32 s20, s20, 4194304
s_addc_u32 s21, s21, 0
s_mov_b32 s22, 262144
s_mov_b32 s23, 0x20000
s_mul_i32 s43, s34, 16384
s_add_u32 s24, s82, s43
s_addc_u32 s25, s83, 0
s_add_u32 s24, s24, 25165824
s_addc_u32 s25, s25, 0
s_mov_b32 s26, 16384
s_mov_b32 s27, 0x20000
v_lshlrev_b32 v11, 4, v1
s_lshl_b32 s43, s36, 11
v_add_u32 v2, s43, v11
v_add_u32 v3, 98304, v2
v_lshrrev_b32 v14, 2, v1
v_bfe_u32 v15, v14, 1, 2
v_mul_u32_u24 v14, 128, v14
v_lshl_add_u32 v14, v15, 5, v14
v_and_b32 v15, 3, v1
v_lshl_add_u32 v4, v15, 3, v14
v_xor_b32 v5, 32, v4
v_xor_b32 v6, 64, v4
v_xor_b32 v7, 96, v4
v_add_u32 v16, 0x10000, v4
v_add_u32 v20, 0x20000, v4
v_add_u32 v17, 0x10000, v5
v_add_u32 v21, 0x20000, v5
v_add_u32 v18, 0x10000, v6
v_add_u32 v22, 0x20000, v6
v_add_u32 v19, 0x10000, v7
v_add_u32 v23, 0x20000, v7
s_lshl_b32 s44, s35, 14
s_add_u32 s60, s44, s43
v_lshrrev_b32 v14, 1, v13
v_lshlrev_b32 v14, 11, v14
v_lshl_add_u32 v14, v12, 3, v14
v_and_b32 v15, 1, v13
v_lshl_add_u32 v14, v15, 2, v14
s_lshl_b32 s43, s36, 12
s_lshl_b32 s44, s35, 7
s_add_u32 s43, s43, s44
v_add_u32 v9, s43, v14
s_mov_b32 s61, 0x3f803f80
s_waitcnt vmcnt(0)
v_permlane16_swap_b32 v128, v130
v_permlane16_swap_b32 v129, v131
v_permlane16_swap_b32 v132, v134
v_permlane16_swap_b32 v133, v135
v_permlane16_swap_b32 v136, v138
v_permlane16_swap_b32 v137, v139
v_permlane16_swap_b32 v140, v142
v_permlane16_swap_b32 v141, v143
v_lshlrev_b32 v96, 16, v128
v_and_b32 v97, 0xffff0000, v128
v_lshlrev_b32 v98, 16, v129
v_and_b32 v99, 0xffff0000, v129
v_lshlrev_b32 v100, 16, v130
v_and_b32 v101, 0xffff0000, v130
v_lshlrev_b32 v102, 16, v131
v_and_b32 v103, 0xffff0000, v131
v_lshlrev_b32 v104, 16, v132
v_and_b32 v105, 0xffff0000, v132
v_lshlrev_b32 v106, 16, v133
v_and_b32 v107, 0xffff0000, v133
v_lshlrev_b32 v108, 16, v134
v_and_b32 v109, 0xffff0000, v134
v_lshlrev_b32 v110, 16, v135
v_and_b32 v111, 0xffff0000, v135
v_lshlrev_b32 v112, 16, v136
v_and_b32 v113, 0xffff0000, v136
v_lshlrev_b32 v114, 16, v137
v_and_b32 v115, 0xffff0000, v137
v_lshlrev_b32 v116, 16, v138
v_and_b32 v117, 0xffff0000, v138
v_lshlrev_b32 v118, 16, v139
v_and_b32 v119, 0xffff0000, v139
v_lshlrev_b32 v120, 16, v140
v_and_b32 v121, 0xffff0000, v140
v_lshlrev_b32 v122, 16, v141
v_and_b32 v123, 0xffff0000, v141
v_lshlrev_b32 v124, 16, v142
v_and_b32 v125, 0xffff0000, v142
v_lshlrev_b32 v126, 16, v143
v_and_b32 v127, 0xffff0000, v143
s_bitcmp0_b32 s36, 1
s_cselect_b32 s44, s72, s74
s_cselect_b32 s45, s73, s75
s_mul_i32 s43, s35, 192
s_add_u32 s16, s44, s43
s_addc_u32 s17, s45, 0
s_add_u32 s16, s16, 4096
s_addc_u32 s17, s17, 0
s_mov_b32 s18, 7333056
s_mov_b32 s19, 0x20000
v_add_u32 v196, 0, v1
v_mul_u32_u24 v197, 5462, v196
v_lshrrev_b32 v197, 16, v197
v_mul_u32_u24 v198, 12, v197
v_sub_u32 v198, v196, v198
v_bfe_u32 v199, v197, 2, 1
v_cmp_gt_u32 vcc, 8, v198
v_lshlrev_b32 v200, 1, v199
v_mul_u32_u24 v197, 7168, v197
v_cndmask_b32 v199, v199, v200, vcc
v_xor_b32 v198, v198, v199
v_lshl_add_u32 v192, v198, 4, v197
v_add_u32 v196, 64, v1
v_mul_u32_u24 v197, 5462, v196
v_lshrrev_b32 v197, 16, v197
v_mul_u32_u24 v198, 12, v197
v_sub_u32 v198, v196, v198
v_bfe_u32 v199, v197, 2, 1
v_cmp_gt_u32 vcc, 8, v198
v_lshlrev_b32 v200, 1, v199
v_mul_u32_u24 v197, 7168, v197
v_cndmask_b32 v199, v199, v200, vcc
v_xor_b32 v198, v198, v199
v_lshl_add_u32 v193, v198, 4, v197
v_add_u32 v196, 128, v1
v_mul_u32_u24 v197, 5462, v196
v_lshrrev_b32 v197, 16, v197
v_mul_u32_u24 v198, 12, v197
v_sub_u32 v198, v196, v198
v_bfe_u32 v199, v197, 2, 1
v_cmp_gt_u32 vcc, 8, v198
v_lshlrev_b32 v200, 1, v199
v_mul_u32_u24 v197, 7168, v197
v_cndmask_b32 v199, v199, v200, vcc
v_xor_b32 v198, v198, v199
v_lshl_add_u32 v194, v198, 4, v197
s_and_b32 s43, s36, 1
s_mul_i32 s43, s43, 229376
v_add_u32 v192, s43, v192
v_add_u32 v193, s43, v193
v_add_u32 v194, s43, v194
s_and_b32 s43, s36, 3
s_mul_i32 s50, s43, 6144
s_add_u32 s50, s50, 16384
s_bitcmp0_b32 s2, 0
s_cselect_b32 s88, s72, s74
s_cselect_b32 s89, s73, s75
s_mov_b32 s90, 7340032
s_mov_b32 s91, 0x20000
s_bfe_u32 s44, s2, 0x30001
s_branch Lov_5
.p2align 12
Lst_5_0:
s_branch Lwr_144
s_nop 0
s_nop 0
Lov_5:
s_lshl_b32 s44, s44, 2
s_and_b32 s43, s36, 3
s_add_u32 s44, s44, s43
s_lshl_b32 s44, s44, 5
v_lshrrev_b32 v195, 4, v1
v_add_u32 v195, s44, v195
v_mul_u32_u24 v195, 7168, v195
v_and_b32 v196, 15, v1
v_lshl_add_u32 v195, v196, 4, v195
s_lshr_b32 s43, s2, 4
s_lshl_b32 s43, s43, 8
v_add_u32 v195, s43, v195
s_cmp_lg_u32 s36, 0
s_cbranch_scc1 Lwm_80
s_nop 0
s_branch Lwe_79
Lwm_80:
s_cmp_lg_u32 s36, 1
s_cbranch_scc1 Lwm_81
s_nop 0
s_branch Lwe_79
Lwm_81:
s_cmp_lg_u32 s36, 2
s_cbranch_scc1 Lwm_82
s_nop 0
s_branch Lwe_79
Lwm_82:
s_cmp_lg_u32 s36, 3
s_cbranch_scc1 Lwm_83
s_nop 0
s_branch Lwe_79
Lwm_83:
Lwe_79:
s_barrier
ds_read_b128 v[32:35], v2 offset:0
ds_read_b64_tr_b16 v[40:41], v16 offset:0
ds_read_b64_tr_b16 v[42:43], v16 offset:2048
ds_read_b64_tr_b16 v[44:45], v17 offset:0
ds_read_b64_tr_b16 v[46:47], v17 offset:2048
ds_read_b64_tr_b16 v[48:49], v18 offset:0
ds_read_b64_tr_b16 v[50:51], v18 offset:2048
ds_read_b64_tr_b16 v[52:53], v19 offset:0
ds_read_b64_tr_b16 v[54:55], v19 offset:2048
ds_read_b128 v[36:39], v2 offset:1024
ds_read_b128 v[56:59], v2 offset:8192
ds_read_b64_tr_b16 v[64:65], v16 offset:4096
ds_read_b64_tr_b16 v[66:67], v16 offset:6144
ds_read_b64_tr_b16 v[68:69], v17 offset:4096
ds_read_b64_tr_b16 v[70:71], v17 offset:6144
ds_read_b64_tr_b16 v[72:73], v18 offset:4096
ds_read_b64_tr_b16 v[74:75], v18 offset:6144
ds_read_b64_tr_b16 v[76:77], v19 offset:4096
ds_read_b64_tr_b16 v[78:79], v19 offset:6144
ds_read_b128 v[60:63], v2 offset:9216
s_waitcnt lgkmcnt(0)
s_barrier
v_mfma_f32_16x16x32_bf16 v[96:99], v[40:43], v[32:35], v[96:99]
ds_read_b128 v[144:147], v2 offset:49152
ds_read_b64_tr_b16 v[152:153], v16 offset:8192
v_mfma_f32_16x16x32_bf16 v[100:103], v[44:47], v[32:35], v[100:103]
ds_read_b64_tr_b16 v[154:155], v16 offset:10240
ds_read_b64_tr_b16 v[156:157], v17 offset:8192
v_mfma_f32_16x16x32_bf16 v[104:107], v[48:51], v[32:35], v[104:107]
ds_read_b64_tr_b16 v[158:159], v17 offset:10240
ds_read_b64_tr_b16 v[160:161], v18 offset:8192
v_mfma_f32_16x16x32_bf16 v[108:111], v[52:55], v[32:35], v[108:111]
ds_read_b64_tr_b16 v[162:163], v18 offset:10240
ds_read_b64_tr_b16 v[164:165], v19 offset:8192
v_mfma_f32_16x16x32_bf16 v[124:127], v[52:55], v[36:39], v[124:127]
ds_read_b64_tr_b16 v[166:167], v19 offset:10240
ds_read_b128 v[148:151], v2 offset:50176
v_mfma_f32_16x16x32_bf16 v[120:123], v[48:51], v[36:39], v[120:123]
ds_read_b128 v[168:171], v2 offset:57344
ds_read_b64_tr_b16 v[176:177], v16 offset:12288
v_mfma_f32_16x16x32_bf16 v[116:119], v[44:47], v[36:39], v[116:119]
ds_read_b64_tr_b16 v[178:179], v16 offset:14336
ds_read_b64_tr_b16 v[180:181], v17 offset:12288
v_mfma_f32_16x16x32_bf16 v[112:115], v[40:43], v[36:39], v[112:115]
ds_read_b64_tr_b16 v[182:183], v17 offset:14336
ds_read_b64_tr_b16 v[184:185], v18 offset:12288
v_mfma_f32_16x16x32_bf16 v[96:99], v[64:67], v[56:59], v[96:99]
ds_read_b64_tr_b16 v[186:187], v18 offset:14336
ds_read_b64_tr_b16 v[188:189], v19 offset:12288
v_mfma_f32_16x16x32_bf16 v[100:103], v[68:71], v[56:59], v[100:103]
ds_read_b64_tr_b16 v[190:191], v19 offset:14336
ds_read_b128 v[172:175], v2 offset:58368
v_mfma_f32_16x16x32_bf16 v[104:107], v[72:75], v[56:59], v[104:107]
v_mfma_f32_16x16x32_bf16 v[108:111], v[76:79], v[56:59], v[108:111]
v_mfma_f32_16x16x32_bf16 v[124:127], v[76:79], v[60:63], v[124:127]
v_mfma_f32_16x16x32_bf16 v[120:123], v[72:75], v[60:63], v[120:123]
v_mfma_f32_16x16x32_bf16 v[116:119], v[68:71], v[60:63], v[116:119]
v_mfma_f32_16x16x32_bf16 v[112:115], v[64:67], v[60:63], v[112:115]
s_waitcnt lgkmcnt(0)
s_barrier
v_mfma_f32_16x16x32_bf16 v[96:99], v[152:155], v[144:147], v[96:99]
ds_read_b128 v[32:35], v3 offset:0
ds_read_b64_tr_b16 v[40:41], v16 offset:16384
v_mfma_f32_16x16x32_bf16 v[100:103], v[156:159], v[144:147], v[100:103]
ds_read_b64_tr_b16 v[42:43], v16 offset:18432
ds_read_b64_tr_b16 v[44:45], v17 offset:16384
v_mfma_f32_16x16x32_bf16 v[104:107], v[160:163], v[144:147], v[104:107]
ds_read_b64_tr_b16 v[46:47], v17 offset:18432
ds_read_b64_tr_b16 v[48:49], v18 offset:16384
v_mfma_f32_16x16x32_bf16 v[108:111], v[164:167], v[144:147], v[108:111]
ds_read_b64_tr_b16 v[50:51], v18 offset:18432
ds_read_b64_tr_b16 v[52:53], v19 offset:16384
v_mfma_f32_16x16x32_bf16 v[124:127], v[164:167], v[148:151], v[124:127]
ds_read_b64_tr_b16 v[54:55], v19 offset:18432
ds_read_b128 v[36:39], v3 offset:1024
v_mfma_f32_16x16x32_bf16 v[120:123], v[160:163], v[148:151], v[120:123]
ds_read_b128 v[56:59], v3 offset:8192
ds_read_b64_tr_b16 v[64:65], v16 offset:20480
v_mfma_f32_16x16x32_bf16 v[116:119], v[156:159], v[148:151], v[116:119]
ds_read_b64_tr_b16 v[66:67], v16 offset:22528
ds_read_b64_tr_b16 v[68:69], v17 offset:20480
v_mfma_f32_16x16x32_bf16 v[112:115], v[152:155], v[148:151], v[112:115]
ds_read_b64_tr_b16 v[70:71], v17 offset:22528
ds_read_b64_tr_b16 v[72:73], v18 offset:20480
v_mfma_f32_16x16x32_bf16 v[96:99], v[176:179], v[168:171], v[96:99]
ds_read_b64_tr_b16 v[74:75], v18 offset:22528
ds_read_b64_tr_b16 v[76:77], v19 offset:20480
v_mfma_f32_16x16x32_bf16 v[100:103], v[180:183], v[168:171], v[100:103]
ds_read_b64_tr_b16 v[78:79], v19 offset:22528
ds_read_b128 v[60:63], v3 offset:9216
v_mfma_f32_16x16x32_bf16 v[104:107], v[184:187], v[168:171], v[104:107]
v_mfma_f32_16x16x32_bf16 v[108:111], v[188:191], v[168:171], v[108:111]
v_mfma_f32_16x16x32_bf16 v[124:127], v[188:191], v[172:175], v[124:127]
v_mfma_f32_16x16x32_bf16 v[120:123], v[184:187], v[172:175], v[120:123]
v_mfma_f32_16x16x32_bf16 v[116:119], v[180:183], v[172:175], v[116:119]
v_mfma_f32_16x16x32_bf16 v[112:115], v[176:179], v[172:175], v[112:115]
s_waitcnt lgkmcnt(0)
s_barrier
v_mfma_f32_16x16x32_bf16 v[96:99], v[40:43], v[32:35], v[96:99]
ds_read_b128 v[144:147], v3 offset:49152
ds_read_b64_tr_b16 v[152:153], v16 offset:24576
v_mfma_f32_16x16x32_bf16 v[100:103], v[44:47], v[32:35], v[100:103]
ds_read_b64_tr_b16 v[154:155], v16 offset:26624
ds_read_b64_tr_b16 v[156:157], v17 offset:24576
v_mfma_f32_16x16x32_bf16 v[104:107], v[48:51], v[32:35], v[104:107]
ds_read_b64_tr_b16 v[158:159], v17 offset:26624
ds_read_b64_tr_b16 v[160:161], v18 offset:24576
v_mfma_f32_16x16x32_bf16 v[108:111], v[52:55], v[32:35], v[108:111]
ds_read_b64_tr_b16 v[162:163], v18 offset:26624
ds_read_b64_tr_b16 v[164:165], v19 offset:24576
v_mfma_f32_16x16x32_bf16 v[124:127], v[52:55], v[36:39], v[124:127]
ds_read_b64_tr_b16 v[166:167], v19 offset:26624
ds_read_b128 v[148:151], v3 offset:50176
v_mfma_f32_16x16x32_bf16 v[120:123], v[48:51], v[36:39], v[120:123]
ds_read_b128 v[168:171], v3 offset:57344
ds_read_b64_tr_b16 v[176:177], v16 offset:28672
v_mfma_f32_16x16x32_bf16 v[116:119], v[44:47], v[36:39], v[116:119]
ds_read_b64_tr_b16 v[178:179], v16 offset:30720
ds_read_b64_tr_b16 v[180:181], v17 offset:28672
v_mfma_f32_16x16x32_bf16 v[112:115], v[40:43], v[36:39], v[112:115]
ds_read_b64_tr_b16 v[182:183], v17 offset:30720
ds_read_b64_tr_b16 v[184:185], v18 offset:28672
v_mfma_f32_16x16x32_bf16 v[96:99], v[64:67], v[56:59], v[96:99]
ds_read_b64_tr_b16 v[186:187], v18 offset:30720
ds_read_b64_tr_b16 v[188:189], v19 offset:28672
v_mfma_f32_16x16x32_bf16 v[100:103], v[68:71], v[56:59], v[100:103]
ds_read_b64_tr_b16 v[190:191], v19 offset:30720
ds_read_b128 v[172:175], v3 offset:58368
v_mfma_f32_16x16x32_bf16 v[104:107], v[72:75], v[56:59], v[104:107]
v_mfma_f32_16x16x32_bf16 v[108:111], v[76:79], v[56:59], v[108:111]
v_mfma_f32_16x16x32_bf16 v[124:127], v[76:79], v[60:63], v[124:127]
v_mfma_f32_16x16x32_bf16 v[120:123], v[72:75], v[60:63], v[120:123]
v_mfma_f32_16x16x32_bf16 v[116:119], v[68:71], v[60:63], v[116:119]
v_mfma_f32_16x16x32_bf16 v[112:115], v[64:67], v[60:63], v[112:115]
s_waitcnt lgkmcnt(0)
s_barrier
v_mfma_f32_16x16x32_bf16 v[96:99], v[152:155], v[144:147], v[96:99]
ds_read_b128 v[32:35], v2 offset:0
ds_read_b64_tr_b16 v[40:41], v16 offset:49152
v_mfma_f32_16x16x32_bf16 v[100:103], v[156:159], v[144:147], v[100:103]
ds_read_b64_tr_b16 v[42:43], v16 offset:51200
ds_read_b64_tr_b16 v[44:45], v17 offset:49152
v_mfma_f32_16x16x32_bf16 v[104:107], v[160:163], v[144:147], v[104:107]
ds_read_b64_tr_b16 v[46:47], v17 offset:51200
ds_read_b64_tr_b16 v[48:49], v18 offset:49152
v_mfma_f32_16x16x32_bf16 v[108:111], v[164:167], v[144:147], v[108:111]
ds_read_b64_tr_b16 v[50:51], v18 offset:51200
ds_read_b64_tr_b16 v[52:53], v19 offset:49152
v_mfma_f32_16x16x32_bf16 v[124:127], v[164:167], v[148:151], v[124:127]
ds_read_b64_tr_b16 v[54:55], v19 offset:51200
ds_read_b128 v[36:39], v2 offset:1024
v_mfma_f32_16x16x32_bf16 v[120:123], v[160:163], v[148:151], v[120:123]
ds_read_b128 v[56:59], v2 offset:8192
ds_read_b64_tr_b16 v[64:65], v16 offset:53248
v_mfma_f32_16x16x32_bf16 v[116:119], v[156:159], v[148:151], v[116:119]
ds_read_b64_tr_b16 v[66:67], v16 offset:55296
ds_read_b64_tr_b16 v[68:69], v17 offset:53248
v_mfma_f32_16x16x32_bf16 v[112:115], v[152:155], v[148:151], v[112:115]
ds_read_b64_tr_b16 v[70:71], v17 offset:55296
ds_read_b64_tr_b16 v[72:73], v18 offset:53248
v_mfma_f32_16x16x32_bf16 v[96:99], v[176:179], v[168:171], v[96:99]
ds_read_b64_tr_b16 v[74:75], v18 offset:55296
ds_read_b64_tr_b16 v[76:77], v19 offset:53248
v_mfma_f32_16x16x32_bf16 v[100:103], v[180:183], v[168:171], v[100:103]
ds_read_b64_tr_b16 v[78:79], v19 offset:55296
ds_read_b128 v[60:63], v2 offset:9216
v_mfma_f32_16x16x32_bf16 v[104:107], v[184:187], v[168:171], v[104:107]
v_mfma_f32_16x16x32_bf16 v[108:111], v[188:191], v[168:171], v[108:111]
v_mfma_f32_16x16x32_bf16 v[124:127], v[188:191], v[172:175], v[124:127]
v_mfma_f32_16x16x32_bf16 v[120:123], v[184:187], v[172:175], v[120:123]
v_mfma_f32_16x16x32_bf16 v[116:119], v[180:183], v[172:175], v[116:119]
v_mfma_f32_16x16x32_bf16 v[112:115], v[176:179], v[172:175], v[112:115]
s_waitcnt lgkmcnt(0)
s_barrier
v_mfma_f32_16x16x32_bf16 v[96:99], v[40:43], v[32:35], v[96:99]
ds_read_b128 v[144:147], v2 offset:49152
ds_read_b64_tr_b16 v[152:153], v16 offset:57344
v_mfma_f32_16x16x32_bf16 v[100:103], v[44:47], v[32:35], v[100:103]
ds_read_b64_tr_b16 v[154:155], v16 offset:59392
ds_read_b64_tr_b16 v[156:157], v17 offset:57344
v_mfma_f32_16x16x32_bf16 v[104:107], v[48:51], v[32:35], v[104:107]
ds_read_b64_tr_b16 v[158:159], v17 offset:59392
ds_read_b64_tr_b16 v[160:161], v18 offset:57344
v_mfma_f32_16x16x32_bf16 v[108:111], v[52:55], v[32:35], v[108:111]
ds_read_b64_tr_b16 v[162:163], v18 offset:59392
ds_read_b64_tr_b16 v[164:165], v19 offset:57344
v_mfma_f32_16x16x32_bf16 v[124:127], v[52:55], v[36:39], v[124:127]
ds_read_b64_tr_b16 v[166:167], v19 offset:59392
ds_read_b128 v[148:151], v2 offset:50176
v_mfma_f32_16x16x32_bf16 v[120:123], v[48:51], v[36:39], v[120:123]
ds_read_b128 v[168:171], v2 offset:57344
ds_read_b64_tr_b16 v[176:177], v16 offset:61440
v_mfma_f32_16x16x32_bf16 v[116:119], v[44:47], v[36:39], v[116:119]
ds_read_b64_tr_b16 v[178:179], v16 offset:63488
ds_read_b64_tr_b16 v[180:181], v17 offset:61440
v_mfma_f32_16x16x32_bf16 v[112:115], v[40:43], v[36:39], v[112:115]
ds_read_b64_tr_b16 v[182:183], v17 offset:63488
ds_read_b64_tr_b16 v[184:185], v18 offset:61440
v_mfma_f32_16x16x32_bf16 v[96:99], v[64:67], v[56:59], v[96:99]
ds_read_b64_tr_b16 v[186:187], v18 offset:63488
ds_read_b64_tr_b16 v[188:189], v19 offset:61440
v_mfma_f32_16x16x32_bf16 v[100:103], v[68:71], v[56:59], v[100:103]
ds_read_b64_tr_b16 v[190:191], v19 offset:63488
ds_read_b128 v[172:175], v2 offset:58368
v_mfma_f32_16x16x32_bf16 v[104:107], v[72:75], v[56:59], v[104:107]
v_mfma_f32_16x16x32_bf16 v[108:111], v[76:79], v[56:59], v[108:111]
v_mfma_f32_16x16x32_bf16 v[124:127], v[76:79], v[60:63], v[124:127]
v_mfma_f32_16x16x32_bf16 v[120:123], v[72:75], v[60:63], v[120:123]
v_mfma_f32_16x16x32_bf16 v[116:119], v[68:71], v[60:63], v[116:119]
v_mfma_f32_16x16x32_bf16 v[112:115], v[64:67], v[60:63], v[112:115]
s_waitcnt lgkmcnt(0)
s_barrier
v_mfma_f32_16x16x32_bf16 v[96:99], v[152:155], v[144:147], v[96:99]
ds_read_b128 v[32:35], v3 offset:0
ds_read_b64_tr_b16 v[40:41], v20 offset:0
v_mfma_f32_16x16x32_bf16 v[100:103], v[156:159], v[144:147], v[100:103]
ds_read_b64_tr_b16 v[42:43], v20 offset:2048
ds_read_b64_tr_b16 v[44:45], v21 offset:0
v_mfma_f32_16x16x32_bf16 v[104:107], v[160:163], v[144:147], v[104:107]
ds_read_b64_tr_b16 v[46:47], v21 offset:2048
ds_read_b64_tr_b16 v[48:49], v22 offset:0
v_mfma_f32_16x16x32_bf16 v[108:111], v[164:167], v[144:147], v[108:111]
ds_read_b64_tr_b16 v[50:51], v22 offset:2048
ds_read_b64_tr_b16 v[52:53], v23 offset:0
v_mfma_f32_16x16x32_bf16 v[124:127], v[164:167], v[148:151], v[124:127]
ds_read_b64_tr_b16 v[54:55], v23 offset:2048
ds_read_b128 v[36:39], v3 offset:1024
v_mfma_f32_16x16x32_bf16 v[120:123], v[160:163], v[148:151], v[120:123]
ds_read_b128 v[56:59], v3 offset:8192
ds_read_b64_tr_b16 v[64:65], v20 offset:4096
v_mfma_f32_16x16x32_bf16 v[116:119], v[156:159], v[148:151], v[116:119]
ds_read_b64_tr_b16 v[66:67], v20 offset:6144
ds_read_b64_tr_b16 v[68:69], v21 offset:4096
v_mfma_f32_16x16x32_bf16 v[112:115], v[152:155], v[148:151], v[112:115]
ds_read_b64_tr_b16 v[70:71], v21 offset:6144
ds_read_b64_tr_b16 v[72:73], v22 offset:4096
v_mfma_f32_16x16x32_bf16 v[96:99], v[176:179], v[168:171], v[96:99]
ds_read_b64_tr_b16 v[74:75], v22 offset:6144
ds_read_b64_tr_b16 v[76:77], v23 offset:4096
v_mfma_f32_16x16x32_bf16 v[100:103], v[180:183], v[168:171], v[100:103]
ds_read_b64_tr_b16 v[78:79], v23 offset:6144
ds_read_b128 v[60:63], v3 offset:9216
v_mfma_f32_16x16x32_bf16 v[104:107], v[184:187], v[168:171], v[104:107]
v_mfma_f32_16x16x32_bf16 v[108:111], v[188:191], v[168:171], v[108:111]
v_mfma_f32_16x16x32_bf16 v[124:127], v[188:191], v[172:175], v[124:127]
v_mfma_f32_16x16x32_bf16 v[120:123], v[184:187], v[172:175], v[120:123]
v_mfma_f32_16x16x32_bf16 v[116:119], v[180:183], v[172:175], v[116:119]
v_mfma_f32_16x16x32_bf16 v[112:115], v[176:179], v[172:175], v[112:115]
s_waitcnt lgkmcnt(0)
s_barrier
v_mfma_f32_16x16x32_bf16 v[96:99], v[40:43], v[32:35], v[96:99]
ds_read_b128 v[144:147], v3 offset:49152
ds_read_b64_tr_b16 v[152:153], v20 offset:8192
v_mfma_f32_16x16x32_bf16 v[100:103], v[44:47], v[32:35], v[100:103]
ds_read_b64_tr_b16 v[154:155], v20 offset:10240
ds_read_b64_tr_b16 v[156:157], v21 offset:8192
v_mfma_f32_16x16x32_bf16 v[104:107], v[48:51], v[32:35], v[104:107]
ds_read_b64_tr_b16 v[158:159], v21 offset:10240
ds_read_b64_tr_b16 v[160:161], v22 offset:8192
v_mfma_f32_16x16x32_bf16 v[108:111], v[52:55], v[32:35], v[108:111]
ds_read_b64_tr_b16 v[162:163], v22 offset:10240
ds_read_b64_tr_b16 v[164:165], v23 offset:8192
v_mfma_f32_16x16x32_bf16 v[124:127], v[52:55], v[36:39], v[124:127]
ds_read_b64_tr_b16 v[166:167], v23 offset:10240
ds_read_b128 v[148:151], v3 offset:50176
v_mfma_f32_16x16x32_bf16 v[120:123], v[48:51], v[36:39], v[120:123]
ds_read_b128 v[168:171], v3 offset:57344
ds_read_b64_tr_b16 v[176:177], v20 offset:12288
v_mfma_f32_16x16x32_bf16 v[116:119], v[44:47], v[36:39], v[116:119]
ds_read_b64_tr_b16 v[178:179], v20 offset:14336
ds_read_b64_tr_b16 v[180:181], v21 offset:12288
v_mfma_f32_16x16x32_bf16 v[112:115], v[40:43], v[36:39], v[112:115]
ds_read_b64_tr_b16 v[182:183], v21 offset:14336
ds_read_b64_tr_b16 v[184:185], v22 offset:12288
v_mfma_f32_16x16x32_bf16 v[96:99], v[64:67], v[56:59], v[96:99]
ds_read_b64_tr_b16 v[186:187], v22 offset:14336
ds_read_b64_tr_b16 v[188:189], v23 offset:12288
v_mfma_f32_16x16x32_bf16 v[100:103], v[68:71], v[56:59], v[100:103]
ds_read_b64_tr_b16 v[190:191], v23 offset:14336
ds_read_b128 v[172:175], v3 offset:58368
v_mfma_f32_16x16x32_bf16 v[104:107], v[72:75], v[56:59], v[104:107]
v_mfma_f32_16x16x32_bf16 v[108:111], v[76:79], v[56:59], v[108:111]
v_mfma_f32_16x16x32_bf16 v[124:127], v[76:79], v[60:63], v[124:127]
v_mfma_f32_16x16x32_bf16 v[120:123], v[72:75], v[60:63], v[120:123]
v_mfma_f32_16x16x32_bf16 v[116:119], v[68:71], v[60:63], v[116:119]
v_mfma_f32_16x16x32_bf16 v[112:115], v[64:67], v[60:63], v[112:115]
s_waitcnt lgkmcnt(0)
s_barrier
v_mfma_f32_16x16x32_bf16 v[96:99], v[152:155], v[144:147], v[96:99]
ds_read_b128 v[32:35], v2 offset:0
ds_read_b64_tr_b16 v[40:41], v4 offset:16384
v_mfma_f32_16x16x32_bf16 v[100:103], v[156:159], v[144:147], v[100:103]
ds_read_b64_tr_b16 v[42:43], v4 offset:18432
ds_read_b64_tr_b16 v[44:45], v5 offset:16384
v_mfma_f32_16x16x32_bf16 v[104:107], v[160:163], v[144:147], v[104:107]
ds_read_b64_tr_b16 v[46:47], v5 offset:18432
ds_read_b64_tr_b16 v[48:49], v6 offset:16384
v_mfma_f32_16x16x32_bf16 v[108:111], v[164:167], v[144:147], v[108:111]
ds_read_b64_tr_b16 v[50:51], v6 offset:18432
ds_read_b64_tr_b16 v[52:53], v7 offset:16384
v_mfma_f32_16x16x32_bf16 v[124:127], v[164:167], v[148:151], v[124:127]
ds_read_b64_tr_b16 v[54:55], v7 offset:18432
ds_read_b128 v[36:39], v2 offset:1024
v_mfma_f32_16x16x32_bf16 v[120:123], v[160:163], v[148:151], v[120:123]
ds_read_b128 v[56:59], v2 offset:8192
ds_read_b64_tr_b16 v[64:65], v4 offset:20480
v_mfma_f32_16x16x32_bf16 v[116:119], v[156:159], v[148:151], v[116:119]
ds_read_b64_tr_b16 v[66:67], v4 offset:22528
ds_read_b64_tr_b16 v[68:69], v5 offset:20480
v_mfma_f32_16x16x32_bf16 v[112:115], v[152:155], v[148:151], v[112:115]
ds_read_b64_tr_b16 v[70:71], v5 offset:22528
ds_read_b64_tr_b16 v[72:73], v6 offset:20480
v_mfma_f32_16x16x32_bf16 v[96:99], v[176:179], v[168:171], v[96:99]
ds_read_b64_tr_b16 v[74:75], v6 offset:22528
ds_read_b64_tr_b16 v[76:77], v7 offset:20480
v_mfma_f32_16x16x32_bf16 v[100:103], v[180:183], v[168:171], v[100:103]
ds_read_b64_tr_b16 v[78:79], v7 offset:22528
ds_read_b128 v[60:63], v2 offset:9216
v_mfma_f32_16x16x32_bf16 v[104:107], v[184:187], v[168:171], v[104:107]
v_mfma_f32_16x16x32_bf16 v[108:111], v[188:191], v[168:171], v[108:111]
v_mfma_f32_16x16x32_bf16 v[124:127], v[188:191], v[172:175], v[124:127]
v_mfma_f32_16x16x32_bf16 v[120:123], v[184:187], v[172:175], v[120:123]
v_mfma_f32_16x16x32_bf16 v[116:119], v[180:183], v[172:175], v[116:119]
v_mfma_f32_16x16x32_bf16 v[112:115], v[176:179], v[172:175], v[112:115]
s_waitcnt lgkmcnt(0)
s_barrier
v_mfma_f32_16x16x32_bf16 v[96:99], v[40:43], v[32:35], v[96:99]
ds_read_b128 v[144:147], v2 offset:49152
ds_read_b64_tr_b16 v[152:153], v4 offset:24576
v_mfma_f32_16x16x32_bf16 v[100:103], v[44:47], v[32:35], v[100:103]
ds_read_b64_tr_b16 v[154:155], v4 offset:26624
ds_read_b64_tr_b16 v[156:157], v5 offset:24576
v_mfma_f32_16x16x32_bf16 v[104:107], v[48:51], v[32:35], v[104:107]
ds_read_b64_tr_b16 v[158:159], v5 offset:26624
ds_read_b64_tr_b16 v[160:161], v6 offset:24576
v_mfma_f32_16x16x32_bf16 v[108:111], v[52:55], v[32:35], v[108:111]
ds_read_b64_tr_b16 v[162:163], v6 offset:26624
ds_read_b64_tr_b16 v[164:165], v7 offset:24576
v_mfma_f32_16x16x32_bf16 v[124:127], v[52:55], v[36:39], v[124:127]
ds_read_b64_tr_b16 v[166:167], v7 offset:26624
ds_read_b128 v[148:151], v2 offset:50176
v_mfma_f32_16x16x32_bf16 v[120:123], v[48:51], v[36:39], v[120:123]
ds_read_b128 v[168:171], v2 offset:57344
ds_read_b64_tr_b16 v[176:177], v4 offset:28672
v_mfma_f32_16x16x32_bf16 v[116:119], v[44:47], v[36:39], v[116:119]
ds_read_b64_tr_b16 v[178:179], v4 offset:30720
ds_read_b64_tr_b16 v[180:181], v5 offset:28672
v_mfma_f32_16x16x32_bf16 v[112:115], v[40:43], v[36:39], v[112:115]
ds_read_b64_tr_b16 v[182:183], v5 offset:30720
ds_read_b64_tr_b16 v[184:185], v6 offset:28672
v_mfma_f32_16x16x32_bf16 v[96:99], v[64:67], v[56:59], v[96:99]
ds_read_b64_tr_b16 v[186:187], v6 offset:30720
ds_read_b64_tr_b16 v[188:189], v7 offset:28672
v_mfma_f32_16x16x32_bf16 v[100:103], v[68:71], v[56:59], v[100:103]
ds_read_b64_tr_b16 v[190:191], v7 offset:30720
ds_read_b128 v[172:175], v2 offset:58368
v_mfma_f32_16x16x32_bf16 v[104:107], v[72:75], v[56:59], v[104:107]
v_mfma_f32_16x16x32_bf16 v[108:111], v[76:79], v[56:59], v[108:111]
v_mfma_f32_16x16x32_bf16 v[124:127], v[76:79], v[60:63], v[124:127]
v_mfma_f32_16x16x32_bf16 v[120:123], v[72:75], v[60:63], v[120:123]
v_mfma_f32_16x16x32_bf16 v[116:119], v[68:71], v[60:63], v[116:119]
v_mfma_f32_16x16x32_bf16 v[112:115], v[64:67], v[60:63], v[112:115]
s_waitcnt lgkmcnt(0)
s_barrier
v_mfma_f32_16x16x32_bf16 v[96:99], v[152:155], v[144:147], v[96:99]
ds_read_b128 v[32:35], v3 offset:0
ds_read_b64_tr_b16 v[40:41], v4 offset:32768
v_mfma_f32_16x16x32_bf16 v[100:103], v[156:159], v[144:147], v[100:103]
ds_read_b64_tr_b16 v[42:43], v4 offset:34816
ds_read_b64_tr_b16 v[44:45], v5 offset:32768
v_mfma_f32_16x16x32_bf16 v[104:107], v[160:163], v[144:147], v[104:107]
ds_read_b64_tr_b16 v[46:47], v5 offset:34816
ds_read_b64_tr_b16 v[48:49], v6 offset:32768
v_mfma_f32_16x16x32_bf16 v[108:111], v[164:167], v[144:147], v[108:111]
ds_read_b64_tr_b16 v[50:51], v6 offset:34816
ds_read_b64_tr_b16 v[52:53], v7 offset:32768
v_mfma_f32_16x16x32_bf16 v[124:127], v[164:167], v[148:151], v[124:127]
ds_read_b64_tr_b16 v[54:55], v7 offset:34816
ds_read_b128 v[36:39], v3 offset:1024
v_mfma_f32_16x16x32_bf16 v[120:123], v[160:163], v[148:151], v[120:123]
ds_read_b128 v[56:59], v3 offset:8192
ds_read_b64_tr_b16 v[64:65], v4 offset:36864
v_mfma_f32_16x16x32_bf16 v[116:119], v[156:159], v[148:151], v[116:119]
ds_read_b64_tr_b16 v[66:67], v4 offset:38912
ds_read_b64_tr_b16 v[68:69], v5 offset:36864
v_mfma_f32_16x16x32_bf16 v[112:115], v[152:155], v[148:151], v[112:115]
ds_read_b64_tr_b16 v[70:71], v5 offset:38912
ds_read_b64_tr_b16 v[72:73], v6 offset:36864
v_mfma_f32_16x16x32_bf16 v[96:99], v[176:179], v[168:171], v[96:99]
ds_read_b64_tr_b16 v[74:75], v6 offset:38912
ds_read_b64_tr_b16 v[76:77], v7 offset:36864
v_mfma_f32_16x16x32_bf16 v[100:103], v[180:183], v[168:171], v[100:103]
ds_read_b64_tr_b16 v[78:79], v7 offset:38912
ds_read_b128 v[60:63], v3 offset:9216
v_mfma_f32_16x16x32_bf16 v[104:107], v[184:187], v[168:171], v[104:107]
v_mfma_f32_16x16x32_bf16 v[108:111], v[188:191], v[168:171], v[108:111]
v_mfma_f32_16x16x32_bf16 v[124:127], v[188:191], v[172:175], v[124:127]
v_mfma_f32_16x16x32_bf16 v[120:123], v[184:187], v[172:175], v[120:123]
v_mfma_f32_16x16x32_bf16 v[116:119], v[180:183], v[172:175], v[116:119]
v_mfma_f32_16x16x32_bf16 v[112:115], v[176:179], v[172:175], v[112:115]
s_waitcnt lgkmcnt(0)
s_barrier
v_mfma_f32_16x16x32_bf16 v[96:99], v[40:43], v[32:35], v[96:99]
ds_read_b128 v[144:147], v3 offset:49152
ds_read_b64_tr_b16 v[152:153], v4 offset:40960
v_mfma_f32_16x16x32_bf16 v[100:103], v[44:47], v[32:35], v[100:103]
ds_read_b64_tr_b16 v[154:155], v4 offset:43008
ds_read_b64_tr_b16 v[156:157], v5 offset:40960
v_mfma_f32_16x16x32_bf16 v[104:107], v[48:51], v[32:35], v[104:107]
ds_read_b64_tr_b16 v[158:159], v5 offset:43008
ds_read_b64_tr_b16 v[160:161], v6 offset:40960
v_mfma_f32_16x16x32_bf16 v[108:111], v[52:55], v[32:35], v[108:111]
ds_read_b64_tr_b16 v[162:163], v6 offset:43008
ds_read_b64_tr_b16 v[164:165], v7 offset:40960
v_mfma_f32_16x16x32_bf16 v[124:127], v[52:55], v[36:39], v[124:127]
ds_read_b64_tr_b16 v[166:167], v7 offset:43008
ds_read_b128 v[148:151], v3 offset:50176
v_mfma_f32_16x16x32_bf16 v[120:123], v[48:51], v[36:39], v[120:123]
ds_read_b128 v[168:171], v3 offset:57344
ds_read_b64_tr_b16 v[176:177], v4 offset:45056
v_mfma_f32_16x16x32_bf16 v[116:119], v[44:47], v[36:39], v[116:119]
ds_read_b64_tr_b16 v[178:179], v4 offset:47104
ds_read_b64_tr_b16 v[180:181], v5 offset:45056
v_mfma_f32_16x16x32_bf16 v[112:115], v[40:43], v[36:39], v[112:115]
ds_read_b64_tr_b16 v[182:183], v5 offset:47104
ds_read_b64_tr_b16 v[184:185], v6 offset:45056
v_mfma_f32_16x16x32_bf16 v[96:99], v[64:67], v[56:59], v[96:99]
ds_read_b64_tr_b16 v[186:187], v6 offset:47104
ds_read_b64_tr_b16 v[188:189], v7 offset:45056
v_mfma_f32_16x16x32_bf16 v[100:103], v[68:71], v[56:59], v[100:103]
ds_read_b64_tr_b16 v[190:191], v7 offset:47104
ds_read_b128 v[172:175], v3 offset:58368
v_mfma_f32_16x16x32_bf16 v[104:107], v[72:75], v[56:59], v[104:107]
v_mfma_f32_16x16x32_bf16 v[108:111], v[76:79], v[56:59], v[108:111]
v_mfma_f32_16x16x32_bf16 v[124:127], v[76:79], v[60:63], v[124:127]
v_mfma_f32_16x16x32_bf16 v[120:123], v[72:75], v[60:63], v[120:123]
v_mfma_f32_16x16x32_bf16 v[116:119], v[68:71], v[60:63], v[116:119]
v_mfma_f32_16x16x32_bf16 v[112:115], v[64:67], v[60:63], v[112:115]
s_waitcnt lgkmcnt(0)
s_barrier
v_mfma_f32_16x16x32_bf16 v[96:99], v[152:155], v[144:147], v[96:99]
ds_read_b128 v[32:35], v2 offset:0
ds_read_b64_tr_b16 v[40:41], v16 offset:49152
v_mfma_f32_16x16x32_bf16 v[100:103], v[156:159], v[144:147], v[100:103]
ds_read_b64_tr_b16 v[42:43], v16 offset:51200
ds_read_b64_tr_b16 v[44:45], v17 offset:49152
v_mfma_f32_16x16x32_bf16 v[104:107], v[160:163], v[144:147], v[104:107]
ds_read_b64_tr_b16 v[46:47], v17 offset:51200
ds_read_b64_tr_b16 v[48:49], v18 offset:49152
v_mfma_f32_16x16x32_bf16 v[108:111], v[164:167], v[144:147], v[108:111]
ds_read_b64_tr_b16 v[50:51], v18 offset:51200
ds_read_b64_tr_b16 v[52:53], v19 offset:49152
v_mfma_f32_16x16x32_bf16 v[124:127], v[164:167], v[148:151], v[124:127]
ds_read_b64_tr_b16 v[54:55], v19 offset:51200
ds_read_b128 v[36:39], v2 offset:1024
v_mfma_f32_16x16x32_bf16 v[120:123], v[160:163], v[148:151], v[120:123]
ds_read_b128 v[56:59], v2 offset:8192
ds_read_b64_tr_b16 v[64:65], v16 offset:53248
v_mfma_f32_16x16x32_bf16 v[116:119], v[156:159], v[148:151], v[116:119]
ds_read_b64_tr_b16 v[66:67], v16 offset:55296
ds_read_b64_tr_b16 v[68:69], v17 offset:53248
v_mfma_f32_16x16x32_bf16 v[112:115], v[152:155], v[148:151], v[112:115]
ds_read_b64_tr_b16 v[70:71], v17 offset:55296
ds_read_b64_tr_b16 v[72:73], v18 offset:53248
v_mfma_f32_16x16x32_bf16 v[96:99], v[176:179], v[168:171], v[96:99]
ds_read_b64_tr_b16 v[74:75], v18 offset:55296
ds_read_b64_tr_b16 v[76:77], v19 offset:53248
v_mfma_f32_16x16x32_bf16 v[100:103], v[180:183], v[168:171], v[100:103]
ds_read_b64_tr_b16 v[78:79], v19 offset:55296
ds_read_b128 v[60:63], v2 offset:9216
v_mfma_f32_16x16x32_bf16 v[104:107], v[184:187], v[168:171], v[104:107]
v_mfma_f32_16x16x32_bf16 v[108:111], v[188:191], v[168:171], v[108:111]
v_mfma_f32_16x16x32_bf16 v[124:127], v[188:191], v[172:175], v[124:127]
v_mfma_f32_16x16x32_bf16 v[120:123], v[184:187], v[172:175], v[120:123]
v_mfma_f32_16x16x32_bf16 v[116:119], v[180:183], v[172:175], v[116:119]
v_mfma_f32_16x16x32_bf16 v[112:115], v[176:179], v[172:175], v[112:115]
s_waitcnt lgkmcnt(0)
s_barrier
v_mfma_f32_16x16x32_bf16 v[96:99], v[40:43], v[32:35], v[96:99]
ds_read_b128 v[144:147], v2 offset:49152
ds_read_b64_tr_b16 v[152:153], v16 offset:57344
v_mfma_f32_16x16x32_bf16 v[100:103], v[44:47], v[32:35], v[100:103]
ds_read_b64_tr_b16 v[154:155], v16 offset:59392
ds_read_b64_tr_b16 v[156:157], v17 offset:57344
v_mfma_f32_16x16x32_bf16 v[104:107], v[48:51], v[32:35], v[104:107]
ds_read_b64_tr_b16 v[158:159], v17 offset:59392
ds_read_b64_tr_b16 v[160:161], v18 offset:57344
v_mfma_f32_16x16x32_bf16 v[108:111], v[52:55], v[32:35], v[108:111]
ds_read_b64_tr_b16 v[162:163], v18 offset:59392
ds_read_b64_tr_b16 v[164:165], v19 offset:57344
v_mfma_f32_16x16x32_bf16 v[124:127], v[52:55], v[36:39], v[124:127]
ds_read_b64_tr_b16 v[166:167], v19 offset:59392
ds_read_b128 v[148:151], v2 offset:50176
v_mfma_f32_16x16x32_bf16 v[120:123], v[48:51], v[36:39], v[120:123]
ds_read_b128 v[168:171], v2 offset:57344
ds_read_b64_tr_b16 v[176:177], v16 offset:61440
v_mfma_f32_16x16x32_bf16 v[116:119], v[44:47], v[36:39], v[116:119]
ds_read_b64_tr_b16 v[178:179], v16 offset:63488
ds_read_b64_tr_b16 v[180:181], v17 offset:61440
v_mfma_f32_16x16x32_bf16 v[112:115], v[40:43], v[36:39], v[112:115]
ds_read_b64_tr_b16 v[182:183], v17 offset:63488
ds_read_b64_tr_b16 v[184:185], v18 offset:61440
v_mfma_f32_16x16x32_bf16 v[96:99], v[64:67], v[56:59], v[96:99]
ds_read_b64_tr_b16 v[186:187], v18 offset:63488
ds_read_b64_tr_b16 v[188:189], v19 offset:61440
v_mfma_f32_16x16x32_bf16 v[100:103], v[68:71], v[56:59], v[100:103]
ds_read_b64_tr_b16 v[190:191], v19 offset:63488
s_branch Lov_6
.p2align 12
Lst_6_0:
s_branch Lwr_145
s_nop 0
s_nop 0
Lov_6:
ds_read_b128 v[172:175], v2 offset:58368
v_mfma_f32_16x16x32_bf16 v[104:107], v[72:75], v[56:59], v[104:107]
v_mfma_f32_16x16x32_bf16 v[108:111], v[76:79], v[56:59], v[108:111]
v_mfma_f32_16x16x32_bf16 v[124:127], v[76:79], v[60:63], v[124:127]
v_mfma_f32_16x16x32_bf16 v[120:123], v[72:75], v[60:63], v[120:123]
v_mfma_f32_16x16x32_bf16 v[116:119], v[68:71], v[60:63], v[116:119]
v_mfma_f32_16x16x32_bf16 v[112:115], v[64:67], v[60:63], v[112:115]
s_waitcnt lgkmcnt(0)
s_barrier
v_mfma_f32_16x16x32_bf16 v[96:99], v[152:155], v[144:147], v[96:99]
ds_read_b128 v[32:35], v3 offset:0
ds_read_b64_tr_b16 v[40:41], v20 offset:0
v_mfma_f32_16x16x32_bf16 v[100:103], v[156:159], v[144:147], v[100:103]
ds_read_b64_tr_b16 v[42:43], v20 offset:2048
ds_read_b64_tr_b16 v[44:45], v21 offset:0
v_mfma_f32_16x16x32_bf16 v[104:107], v[160:163], v[144:147], v[104:107]
ds_read_b64_tr_b16 v[46:47], v21 offset:2048
ds_read_b64_tr_b16 v[48:49], v22 offset:0
v_mfma_f32_16x16x32_bf16 v[108:111], v[164:167], v[144:147], v[108:111]
ds_read_b64_tr_b16 v[50:51], v22 offset:2048
ds_read_b64_tr_b16 v[52:53], v23 offset:0
v_mfma_f32_16x16x32_bf16 v[124:127], v[164:167], v[148:151], v[124:127]
ds_read_b64_tr_b16 v[54:55], v23 offset:2048
ds_read_b128 v[36:39], v3 offset:1024
v_mfma_f32_16x16x32_bf16 v[120:123], v[160:163], v[148:151], v[120:123]
ds_read_b128 v[56:59], v3 offset:8192
ds_read_b64_tr_b16 v[64:65], v20 offset:4096
v_mfma_f32_16x16x32_bf16 v[116:119], v[156:159], v[148:151], v[116:119]
ds_read_b64_tr_b16 v[66:67], v20 offset:6144
ds_read_b64_tr_b16 v[68:69], v21 offset:4096
v_mfma_f32_16x16x32_bf16 v[112:115], v[152:155], v[148:151], v[112:115]
ds_read_b64_tr_b16 v[70:71], v21 offset:6144
ds_read_b64_tr_b16 v[72:73], v22 offset:4096
v_mfma_f32_16x16x32_bf16 v[96:99], v[176:179], v[168:171], v[96:99]
ds_read_b64_tr_b16 v[74:75], v22 offset:6144
ds_read_b64_tr_b16 v[76:77], v23 offset:4096
v_mfma_f32_16x16x32_bf16 v[100:103], v[180:183], v[168:171], v[100:103]
ds_read_b64_tr_b16 v[78:79], v23 offset:6144
ds_read_b128 v[60:63], v3 offset:9216
v_mfma_f32_16x16x32_bf16 v[104:107], v[184:187], v[168:171], v[104:107]
v_mfma_f32_16x16x32_bf16 v[108:111], v[188:191], v[168:171], v[108:111]
v_mfma_f32_16x16x32_bf16 v[124:127], v[188:191], v[172:175], v[124:127]
v_mfma_f32_16x16x32_bf16 v[120:123], v[184:187], v[172:175], v[120:123]
v_mfma_f32_16x16x32_bf16 v[116:119], v[180:183], v[172:175], v[116:119]
v_mfma_f32_16x16x32_bf16 v[112:115], v[176:179], v[172:175], v[112:115]
s_waitcnt lgkmcnt(0)
s_barrier
v_mfma_f32_16x16x32_bf16 v[96:99], v[40:43], v[32:35], v[96:99]
ds_read_b128 v[144:147], v3 offset:49152
ds_read_b64_tr_b16 v[152:153], v20 offset:8192
v_mfma_f32_16x16x32_bf16 v[100:103], v[44:47], v[32:35], v[100:103]
ds_read_b64_tr_b16 v[154:155], v20 offset:10240
ds_read_b64_tr_b16 v[156:157], v21 offset:8192
v_mfma_f32_16x16x32_bf16 v[104:107], v[48:51], v[32:35], v[104:107]
ds_read_b64_tr_b16 v[158:159], v21 offset:10240
ds_read_b64_tr_b16 v[160:161], v22 offset:8192
v_mfma_f32_16x16x32_bf16 v[108:111], v[52:55], v[32:35], v[108:111]
ds_read_b64_tr_b16 v[162:163], v22 offset:10240
ds_read_b64_tr_b16 v[164:165], v23 offset:8192
v_mfma_f32_16x16x32_bf16 v[124:127], v[52:55], v[36:39], v[124:127]
ds_read_b64_tr_b16 v[166:167], v23 offset:10240
ds_read_b128 v[148:151], v3 offset:50176
v_mfma_f32_16x16x32_bf16 v[120:123], v[48:51], v[36:39], v[120:123]
ds_read_b128 v[168:171], v3 offset:57344
ds_read_b64_tr_b16 v[176:177], v20 offset:12288
v_mfma_f32_16x16x32_bf16 v[116:119], v[44:47], v[36:39], v[116:119]
ds_read_b64_tr_b16 v[178:179], v20 offset:14336
ds_read_b64_tr_b16 v[180:181], v21 offset:12288
v_mfma_f32_16x16x32_bf16 v[112:115], v[40:43], v[36:39], v[112:115]
ds_read_b64_tr_b16 v[182:183], v21 offset:14336
ds_read_b64_tr_b16 v[184:185], v22 offset:12288
v_mfma_f32_16x16x32_bf16 v[96:99], v[64:67], v[56:59], v[96:99]
ds_read_b64_tr_b16 v[186:187], v22 offset:14336
ds_read_b64_tr_b16 v[188:189], v23 offset:12288
v_mfma_f32_16x16x32_bf16 v[100:103], v[68:71], v[56:59], v[100:103]
ds_read_b64_tr_b16 v[190:191], v23 offset:14336
ds_read_b128 v[172:175], v3 offset:58368
v_mfma_f32_16x16x32_bf16 v[104:107], v[72:75], v[56:59], v[104:107]
v_mfma_f32_16x16x32_bf16 v[108:111], v[76:79], v[56:59], v[108:111]
v_mfma_f32_16x16x32_bf16 v[124:127], v[76:79], v[60:63], v[124:127]
v_mfma_f32_16x16x32_bf16 v[120:123], v[72:75], v[60:63], v[120:123]
v_mfma_f32_16x16x32_bf16 v[116:119], v[68:71], v[60:63], v[116:119]
v_mfma_f32_16x16x32_bf16 v[112:115], v[64:67], v[60:63], v[112:115]
s_waitcnt lgkmcnt(0)
s_barrier
v_mfma_f32_16x16x32_bf16 v[96:99], v[152:155], v[144:147], v[96:99]
v_mfma_f32_16x16x32_bf16 v[100:103], v[156:159], v[144:147], v[100:103]
v_mfma_f32_16x16x32_bf16 v[104:107], v[160:163], v[144:147], v[104:107]
v_mfma_f32_16x16x32_bf16 v[108:111], v[164:167], v[144:147], v[108:111]
v_mfma_f32_16x16x32_bf16 v[124:127], v[164:167], v[148:151], v[124:127]
v_mfma_f32_16x16x32_bf16 v[120:123], v[160:163], v[148:151], v[120:123]
v_mfma_f32_16x16x32_bf16 v[116:119], v[156:159], v[148:151], v[116:119]
v_mfma_f32_16x16x32_bf16 v[112:115], v[152:155], v[148:151], v[112:115]
v_mfma_f32_16x16x32_bf16 v[96:99], v[176:179], v[168:171], v[96:99]
v_mfma_f32_16x16x32_bf16 v[100:103], v[180:183], v[168:171], v[100:103]
v_mfma_f32_16x16x32_bf16 v[104:107], v[184:187], v[168:171], v[104:107]
v_mfma_f32_16x16x32_bf16 v[108:111], v[188:191], v[168:171], v[108:111]
v_mfma_f32_16x16x32_bf16 v[124:127], v[188:191], v[172:175], v[124:127]
v_mfma_f32_16x16x32_bf16 v[120:123], v[184:187], v[172:175], v[120:123]
v_mfma_f32_16x16x32_bf16 v[116:119], v[180:183], v[172:175], v[116:119]
v_mfma_f32_16x16x32_bf16 v[112:115], v[176:179], v[172:175], v[112:115]
s_nop 3
v_cvt_pk_bf16_f32 v32, v96, v97
v_cvt_pk_bf16_f32 v33, v98, v99
v_cvt_pk_bf16_f32 v34, v100, v101
v_cvt_pk_bf16_f32 v35, v102, v103
s_add_u32 s43, s60, 0
buffer_store_dwordx4 v[32:35], v11, s[20:23], s43 offen offset:0 sc1
v_cvt_pk_bf16_f32 v36, v104, v105
v_cvt_pk_bf16_f32 v37, v106, v107
v_cvt_pk_bf16_f32 v38, v108, v109
v_cvt_pk_bf16_f32 v39, v110, v111
s_add_u32 s43, s60, 8192
buffer_store_dwordx4 v[36:39], v11, s[20:23], s43 offen offset:0 sc1
v_cvt_pk_bf16_f32 v44, v120, v121
v_cvt_pk_bf16_f32 v45, v122, v123
v_cvt_pk_bf16_f32 v46, v124, v125
v_cvt_pk_bf16_f32 v47, v126, v127
s_add_u32 s43, s60, 8192
buffer_store_dwordx4 v[44:47], v11, s[20:23], s43 offen offset:1024 sc1
v_cvt_pk_bf16_f32 v40, v112, v113
v_cvt_pk_bf16_f32 v41, v114, v115
v_cvt_pk_bf16_f32 v42, v116, v117
v_cvt_pk_bf16_f32 v43, v118, v119
s_add_u32 s43, s60, 0
buffer_store_dwordx4 v[40:43], v11, s[20:23], s43 offen offset:1024 sc1
v_mov_b32 v64, 0
v_mov_b32 v65, 0
v_mov_b32 v66, 0
v_mov_b32 v67, 0
v_mov_b32 v68, 0
v_mov_b32 v69, 0
v_mov_b32 v70, 0
v_mov_b32 v71, 0
v_dot2_f32_bf16 v64, v32, s61, v64
v_dot2_f32_bf16 v66, v32, v32, v66
v_dot2_f32_bf16 v68, v40, s61, v68
v_dot2_f32_bf16 v70, v40, v40, v70
v_dot2_f32_bf16 v65, v33, s61, v65
v_dot2_f32_bf16 v67, v33, v33, v67
v_dot2_f32_bf16 v69, v41, s61, v69
v_dot2_f32_bf16 v71, v41, v41, v71
v_dot2_f32_bf16 v64, v34, s61, v64
v_dot2_f32_bf16 v66, v34, v34, v66
v_dot2_f32_bf16 v68, v42, s61, v68
v_dot2_f32_bf16 v70, v42, v42, v70
v_dot2_f32_bf16 v65, v35, s61, v65
v_dot2_f32_bf16 v67, v35, v35, v67
v_dot2_f32_bf16 v69, v43, s61, v69
v_dot2_f32_bf16 v71, v43, v43, v71
v_dot2_f32_bf16 v64, v36, s61, v64
v_dot2_f32_bf16 v66, v36, v36, v66
v_dot2_f32_bf16 v68, v44, s61, v68
v_dot2_f32_bf16 v70, v44, v44, v70
v_dot2_f32_bf16 v65, v37, s61, v65
v_dot2_f32_bf16 v67, v37, v37, v67
v_dot2_f32_bf16 v69, v45, s61, v69
v_dot2_f32_bf16 v71, v45, v45, v71
v_dot2_f32_bf16 v64, v38, s61, v64
v_dot2_f32_bf16 v66, v38, v38, v66
v_dot2_f32_bf16 v68, v46, s61, v68
v_dot2_f32_bf16 v70, v46, v46, v70
v_dot2_f32_bf16 v65, v39, s61, v65
v_dot2_f32_bf16 v67, v39, v39, v67
v_dot2_f32_bf16 v69, v47, s61, v69
v_dot2_f32_bf16 v71, v47, v47, v71
s_nop 2
v_add_f32 v64, v64, v65
v_add_f32 v66, v66, v67
v_add_f32 v68, v68, v69
v_add_f32 v70, v70, v71
s_nop 1
v_permlane32_swap_b32 v64, v68
v_permlane32_swap_b32 v66, v70
v_add_f32 v64, v64, v68
v_add_f32 v66, v66, v70
s_nop 1
v_permlane16_swap_b32 v64, v66
v_add_f32 v64, v64, v66
buffer_store_dword v64, v9, s[24:27], 0 offen sc1
s_waitcnt vmcnt(0)
s_barrier
s_cmp_lg_u32 s36, 0
s_cbranch_scc1 Lk2end_76
s_add_u32 s7, s34, 16
s_lshl_b32 s7, s7, 7
v_mov_b32 v4, s7
v_mov_b32 v5, 1
s_mov_b64 exec, 1
buffer_atomic_add v5, v4, s[56:59], 0 offen sc1
s_mov_b64 exec, -1
s_branch Lk2end_76
Lprod_77:
s_mul_i32 s43, s34, 262144
s_add_u32 s8, s82, s43
s_addc_u32 s9, s83, 0
s_mov_b32 s10, 262144
s_mov_b32 s11, 0x20000
s_lshl_b32 s43, s35, 7
s_add_u32 s12, s68, s43
s_addc_u32 s13, s69, 0
s_mov_b32 s14, 2095232
s_mov_b32 s15, 0x20000
s_and_b32 s47, s36, 3
s_lshl_b32 s39, s47, 12
v_lshlrev_b32 v2, 4, v1
v_add_u32 v2, s39, v2
v_lshrrev_b32 v12, 3, v1
v_and_b32 v13, 6, v12
v_and_b32 v3, 7, v1
v_xor_b32 v3, v3, v13
v_lshlrev_b32 v3, 4, v3
v_mul_u32_u24 v12, 2048, v12
v_add_u32 v3, v3, v12
s_lshl_b32 s43, s47, 15
v_add_u32 v3, s43, v3
s_lshl_b32 s40, s47, 11
s_add_u32 s37, s35, 0
s_and_b32 s37, s37, 15
s_lshl_b32 s37, s37, 14
s_add_u32 m0, s39, 0
s_nop 0
buffer_load_dwordx4 v2, s[8:11], s37 offen offset:0 sc1 lds
buffer_load_dwordx4 v2, s[8:11], s37 offen offset:1024 sc1 lds
buffer_load_dwordx4 v2, s[8:11], s37 offen offset:2048 sc1 lds
buffer_load_dwordx4 v2, s[8:11], s37 offen offset:3072 sc1 lds
s_add_u32 s38, s35, 8
s_and_b32 s38, s38, 15
s_lshl_b32 s38, s38, 17
s_add_u32 m0, s40, 16384
s_nop 0
buffer_load_dwordx4 v3, s[12:15], s38 offen lds
s_add_u32 m0, s40, 17408
s_add_u32 s38, s38, 16384
buffer_load_dwordx4 v3, s[12:15], s38 offen lds
s_add_u32 s38, s35, 9
s_and_b32 s38, s38, 15
s_lshl_b32 s38, s38, 17
s_add_u32 m0, s40, 24576
s_nop 0
buffer_load_dwordx4 v3, s[12:15], s38 offen lds
s_add_u32 m0, s40, 25600
s_add_u32 s38, s38, 16384
buffer_load_dwordx4 v3, s[12:15], s38 offen lds
s_add_u32 s38, s35, 10
s_and_b32 s38, s38, 15
s_lshl_b32 s38, s38, 17
s_add_u32 m0, s40, 32768
s_nop 0
buffer_load_dwordx4 v3, s[12:15], s38 offen lds
s_add_u32 m0, s40, 33792
s_add_u32 s38, s38, 16384
buffer_load_dwordx4 v3, s[12:15], s38 offen lds
s_add_u32 s38, s35, 11
s_and_b32 s38, s38, 15
s_lshl_b32 s38, s38, 17
s_add_u32 m0, s40, 40960
s_nop 0
buffer_load_dwordx4 v3, s[12:15], s38 offen lds
s_add_u32 m0, s40, 41984
s_add_u32 s38, s38, 16384
buffer_load_dwordx4 v3, s[12:15], s38 offen lds
s_bitcmp0_b32 s36, 1
s_cselect_b32 s44, s72, s74
s_cselect_b32 s45, s73, s75
s_mul_i32 s43, s35, 192
s_add_u32 s88, s44, s43
s_addc_u32 s89, s45, 0
s_add_u32 s88, s88, 4096
s_addc_u32 s89, s89, 0
s_mov_b32 s90, 7333056
s_mov_b32 s91, 0x20000
v_add_u32 v11, 0, v1
v_mul_u32_u24 v12, 5462, v11
v_lshrrev_b32 v12, 16, v12
v_mul_u32_u24 v13, 12, v12
v_sub_u32 v13, v11, v13
v_bfe_u32 v14, v12, 2, 1
v_cmp_gt_u32 vcc, 8, v13
v_lshlrev_b32 v15, 1, v14
v_mul_u32_u24 v12, 7168, v12
v_cndmask_b32 v14, v14, v15, vcc
v_xor_b32 v13, v13, v14
v_lshl_add_u32 v8, v13, 4, v12
v_add_u32 v11, 64, v1
v_mul_u32_u24 v12, 5462, v11
v_lshrrev_b32 v12, 16, v12
v_mul_u32_u24 v13, 12, v12
v_sub_u32 v13, v11, v13
v_bfe_u32 v14, v12, 2, 1
v_cmp_gt_u32 vcc, 8, v13
v_lshlrev_b32 v15, 1, v14
v_mul_u32_u24 v12, 7168, v12
v_cndmask_b32 v14, v14, v15, vcc
v_xor_b32 v13, v13, v14
v_lshl_add_u32 v9, v13, 4, v12
v_add_u32 v11, 128, v1
v_mul_u32_u24 v12, 5462, v11
v_lshrrev_b32 v12, 16, v12
v_mul_u32_u24 v13, 12, v12
v_sub_u32 v13, v11, v13
v_bfe_u32 v14, v12, 2, 1
v_cmp_gt_u32 vcc, 8, v13
v_lshlrev_b32 v15, 1, v14
v_mul_u32_u24 v12, 7168, v12
v_cndmask_b32 v14, v14, v15, vcc
v_xor_b32 v13, v13, v14
v_lshl_add_u32 v10, v13, 4, v12
s_and_b32 s43, s36, 1
s_mul_i32 s43, s43, 229376
v_add_u32 v8, s43, v8
v_add_u32 v9, s43, v9
v_add_u32 v10, s43, v10
s_and_b32 s43, s36, 3
s_mul_i32 s46, s43, 6144
s_add_u32 s46, s46, 16384
s_cmp_eq_u32 s47, 3
s_cbranch_scc0 Lw_84
s_lshl_b32 s92, s34, 7
s_add_u32 s92, s92, 28311552
s_mov_b32 s41, 0x40000
Lpoll_85:
s_load_dword s93, s[82:83], s92 glc
Lpchk_87:
s_waitcnt lgkmcnt(0)
s_cmp_eq_u32 s93, 16
s_cbranch_scc1 Lpok_86
s_sub_u32 s41, s41, 1
s_cmp_lg_u32 s41, 0
s_cbranch_scc1 Lpoll_85
Lpok_86:
Lw_84:
s_and_b32 s44, s36, 3
s_mul_i32 s44, s44, 14
s_bfe_u32 s43, s2, 0x30001
s_lshl_b32 s43, s43, 7
s_add_u32 s44, s44, s43
s_add_u32 s44, s44, 72
s_mul_i32 s44, s44, 7168
s_lshr_b32 s43, s2, 4
s_lshl_b32 s43, s43, 8
s_add_u32 s43, s43, s44
s_bitcmp0_b32 s2, 0
s_cselect_b32 s4, s72, s74
s_cselect_b32 s5, s73, s75
s_add_u32 s4, s4, s43
s_addc_u32 s5, s5, 0
s_cmp_eq_u32 s47, 3
s_cbranch_scc1 Lw_88
s_load_dword s3, s[4:5], 0
s_load_dword s3, s[4:5], 64
s_load_dword s3, s[4:5], 128
s_load_dword s3, s[4:5], 192
s_load_dword s3, s[4:5], 7168
s_load_dword s3, s[4:5], 7232
s_load_dword s3, s[4:5], 7296
s_load_dword s3, s[4:5], 7360
s_load_dword s3, s[4:5], 14336
s_load_dword s3, s[4:5], 14400
s_load_dword s3, s[4:5], 14464
s_load_dword s3, s[4:5], 14528
s_load_dword s3, s[4:5], 21504
s_load_dword s3, s[4:5], 21568
Lw_88:
s_waitcnt vmcnt(8)
s_barrier
s_add_u32 s37, s35, 1
s_and_b32 s37, s37, 15
s_lshl_b32 s37, s37, 14
s_add_u32 m0, s39, 49152
s_nop 0
buffer_load_dwordx4 v2, s[8:11], s37 offen offset:0 sc1 lds
buffer_load_dwordx4 v2, s[8:11], s37 offen offset:1024 sc1 lds
buffer_load_dwordx4 v2, s[8:11], s37 offen offset:2048 sc1 lds
buffer_load_dwordx4 v2, s[8:11], s37 offen offset:3072 sc1 lds
s_add_u32 s37, s35, 2
s_and_b32 s37, s37, 15
s_lshl_b32 s37, s37, 14
s_add_u32 m0, s39, 98304
s_nop 0
buffer_load_dwordx4 v2, s[8:11], s37 offen offset:0 sc1 lds
buffer_load_dwordx4 v2, s[8:11], s37 offen offset:1024 sc1 lds
buffer_load_dwordx4 v2, s[8:11], s37 offen offset:2048 sc1 lds
buffer_load_dwordx4 v2, s[8:11], s37 offen offset:3072 sc1 lds
s_add_u32 s37, s35, 3
s_and_b32 s37, s37, 15
s_lshl_b32 s37, s37, 14
s_add_u32 m0, s39, 147456
s_nop 0
buffer_load_dwordx4 v2, s[8:11], s37 offen offset:0 sc1 lds
buffer_load_dwordx4 v2, s[8:11], s37 offen offset:1024 sc1 lds
buffer_load_dwordx4 v2, s[8:11], s37 offen offset:2048 sc1 lds
buffer_load_dwordx4 v2, s[8:11], s37 offen offset:3072 sc1 lds
s_cmp_eq_u32 s47, 3
s_cbranch_scc0 Lw_89
s_load_dword s3, s[4:5], 0
s_load_dword s3, s[4:5], 64
s_load_dword s3, s[4:5], 128
s_load_dword s3, s[4:5], 192
s_load_dword s3, s[4:5], 7168
s_load_dword s3, s[4:5], 7232
s_load_dword s3, s[4:5], 7296
s_load_dword s3, s[4:5], 7360
s_load_dword s3, s[4:5], 14336
s_load_dword s3, s[4:5], 14400
s_load_dword s3, s[4:5], 14464
s_load_dword s3, s[4:5], 14528
s_load_dword s3, s[4:5], 21504
s_load_dword s3, s[4:5], 21568
Lw_89:
s_waitcnt vmcnt(8)
s_barrier
s_add_u32 s37, s35, 4
s_and_b32 s37, s37, 15
s_lshl_b32 s37, s37, 14
s_add_u32 m0, s39, 0
s_nop 0
buffer_load_dwordx4 v2, s[8:11], s37 offen offset:0 sc1 lds
buffer_load_dwordx4 v2, s[8:11], s37 offen offset:1024 sc1 lds
buffer_load_dwordx4 v2, s[8:11], s37 offen offset:2048 sc1 lds
buffer_load_dwordx4 v2, s[8:11], s37 offen offset:3072 sc1 lds
v_lshlrev_b32 v240, 16, v128
v_and_b32 v241, 0xffff0000, v128
v_lshlrev_b32 v242, 16, v129
v_and_b32 v243, 0xffff0000, v129
v_lshlrev_b32 v244, 16, v130
v_and_b32 v245, 0xffff0000, v130
v_lshlrev_b32 v246, 16, v131
v_and_b32 v247, 0xffff0000, v131
s_load_dword s3, s[4:5], 21632
s_load_dword s3, s[4:5], 21696
s_load_dword s3, s[4:5], 28672
s_waitcnt vmcnt(8)
s_barrier
s_add_u32 s37, s35, 5
s_and_b32 s37, s37, 15
s_lshl_b32 s37, s37, 14
s_add_u32 m0, s39, 49152
s_nop 0
buffer_load_dwordx4 v2, s[8:11], s37 offen offset:0 sc1 lds
buffer_load_dwordx4 v2, s[8:11], s37 offen offset:1024 sc1 lds
buffer_load_dwordx4 v2, s[8:11], s37 offen offset:2048 sc1 lds
buffer_load_dwordx4 v2, s[8:11], s37 offen offset:3072 sc1 lds
v_lshlrev_b32 v24, 16, v132
v_and_b32 v25, 0xffff0000, v132
v_lshlrev_b32 v26, 16, v133
v_and_b32 v27, 0xffff0000, v133
v_lshlrev_b32 v28, 16, v134
v_and_b32 v29, 0xffff0000, v134
v_lshlrev_b32 v30, 16, v135
v_and_b32 v31, 0xffff0000, v135
v_add_f32 v240, v240, v24
v_add_f32 v241, v241, v25
v_add_f32 v242, v242, v26
v_add_f32 v243, v243, v27
v_add_f32 v244, v244, v28
v_add_f32 v245, v245, v29
v_add_f32 v246, v246, v30
v_add_f32 v247, v247, v31
s_load_dword s3, s[4:5], 28736
s_load_dword s3, s[4:5], 28800
s_load_dword s3, s[4:5], 28864
s_waitcnt vmcnt(8)
s_barrier
s_add_u32 s37, s35, 6
s_and_b32 s37, s37, 15
s_lshl_b32 s37, s37, 14
s_add_u32 m0, s39, 98304
s_nop 0
buffer_load_dwordx4 v2, s[8:11], s37 offen offset:0 sc1 lds
buffer_load_dwordx4 v2, s[8:11], s37 offen offset:1024 sc1 lds
buffer_load_dwordx4 v2, s[8:11], s37 offen offset:2048 sc1 lds
buffer_load_dwordx4 v2, s[8:11], s37 offen offset:3072 sc1 lds
v_lshlrev_b32 v24, 16, v136
v_and_b32 v25, 0xffff0000, v136
v_lshlrev_b32 v26, 16, v137
v_and_b32 v27, 0xffff0000, v137
v_lshlrev_b32 v28, 16, v138
v_and_b32 v29, 0xffff0000, v138
v_lshlrev_b32 v30, 16, v139
v_and_b32 v31, 0xffff0000, v139
v_add_f32 v240, v240, v24
v_add_f32 v241, v241, v25
v_add_f32 v242, v242, v26
v_add_f32 v243, v243, v27
v_add_f32 v244, v244, v28
v_add_f32 v245, v245, v29
v_add_f32 v246, v246, v30
v_add_f32 v247, v247, v31
s_load_dword s3, s[4:5], 35840
s_load_dword s3, s[4:5], 35904
s_load_dword s3, s[4:5], 35968
s_waitcnt vmcnt(8)
s_barrier
s_add_u32 s37, s35, 7
s_and_b32 s37, s37, 15
s_lshl_b32 s37, s37, 14
s_add_u32 m0, s39, 147456
s_nop 0
buffer_load_dwordx4 v2, s[8:11], s37 offen offset:0 sc1 lds
buffer_load_dwordx4 v2, s[8:11], s37 offen offset:1024 sc1 lds
buffer_load_dwordx4 v2, s[8:11], s37 offen offset:2048 sc1 lds
buffer_load_dwordx4 v2, s[8:11], s37 offen offset:3072 sc1 lds
v_lshlrev_b32 v24, 16, v140
v_and_b32 v25, 0xffff0000, v140
v_lshlrev_b32 v26, 16, v141
v_and_b32 v27, 0xffff0000, v141
v_lshlrev_b32 v28, 16, v142
v_and_b32 v29, 0xffff0000, v142
v_lshlrev_b32 v30, 16, v143
v_and_b32 v31, 0xffff0000, v143
v_add_f32 v240, v240, v24
v_add_f32 v241, v241, v25
v_add_f32 v242, v242, v26
v_add_f32 v243, v243, v27
v_add_f32 v244, v244, v28
v_add_f32 v245, v245, v29
v_add_f32 v246, v246, v30
v_add_f32 v247, v247, v31
s_load_dword s3, s[4:5], 36032
s_load_dword s3, s[4:5], 43008
s_load_dword s3, s[4:5], 43072
s_waitcnt vmcnt(8)
s_barrier
s_add_u32 s37, s35, 8
s_and_b32 s37, s37, 15
s_lshl_b32 s37, s37, 14
s_add_u32 m0, s39, 0
s_nop 0
buffer_load_dwordx4 v2, s[8:11], s37 offen offset:0 sc1 lds
buffer_load_dwordx4 v2, s[8:11], s37 offen offset:1024 sc1 lds
buffer_load_dwordx4 v2, s[8:11], s37 offen offset:2048 sc1 lds
buffer_load_dwordx4 v2, s[8:11], s37 offen offset:3072 sc1 lds
s_add_u32 s38, s35, 12
s_and_b32 s38, s38, 15
s_lshl_b32 s38, s38, 17
s_add_u32 m0, s40, 114688
s_nop 0
buffer_load_dwordx4 v3, s[12:15], s38 offen lds
s_add_u32 m0, s40, 115712
s_add_u32 s38, s38, 16384
buffer_load_dwordx4 v3, s[12:15], s38 offen lds
v_lshlrev_b32 v24, 16, v144
v_and_b32 v25, 0xffff0000, v144
v_lshlrev_b32 v26, 16, v145
v_and_b32 v27, 0xffff0000, v145
v_lshlrev_b32 v28, 16, v146
v_and_b32 v29, 0xffff0000, v146
v_lshlrev_b32 v30, 16, v147
v_and_b32 v31, 0xffff0000, v147
v_add_f32 v240, v240, v24
v_add_f32 v241, v241, v25
v_add_f32 v242, v242, v26
v_add_f32 v243, v243, v27
v_add_f32 v244, v244, v28
v_add_f32 v245, v245, v29
v_add_f32 v246, v246, v30
v_add_f32 v247, v247, v31
s_load_dword s3, s[4:5], 43136
s_load_dword s3, s[4:5], 43200
s_load_dword s3, s[4:5], 50176
s_waitcnt vmcnt(10)
s_barrier
s_add_u32 s37, s35, 9
s_and_b32 s37, s37, 15
s_lshl_b32 s37, s37, 14
s_add_u32 m0, s39, 49152
s_nop 0
buffer_load_dwordx4 v2, s[8:11], s37 offen offset:0 sc1 lds
buffer_load_dwordx4 v2, s[8:11], s37 offen offset:1024 sc1 lds
buffer_load_dwordx4 v2, s[8:11], s37 offen offset:2048 sc1 lds
buffer_load_dwordx4 v2, s[8:11], s37 offen offset:3072 sc1 lds
s_add_u32 s38, s35, 13
s_and_b32 s38, s38, 15
s_lshl_b32 s38, s38, 17
s_add_u32 m0, s40, 122880
s_nop 0
buffer_load_dwordx4 v3, s[12:15], s38 offen lds
s_add_u32 m0, s40, 123904
s_add_u32 s38, s38, 16384
buffer_load_dwordx4 v3, s[12:15], s38 offen lds
v_lshlrev_b32 v24, 16, v148
v_and_b32 v25, 0xffff0000, v148
v_lshlrev_b32 v26, 16, v149
v_and_b32 v27, 0xffff0000, v149
v_lshlrev_b32 v28, 16, v150
v_and_b32 v29, 0xffff0000, v150
v_lshlrev_b32 v30, 16, v151
v_and_b32 v31, 0xffff0000, v151
v_add_f32 v240, v240, v24
v_add_f32 v241, v241, v25
v_add_f32 v242, v242, v26
v_add_f32 v243, v243, v27
v_add_f32 v244, v244, v28
v_add_f32 v245, v245, v29
v_add_f32 v246, v246, v30
v_add_f32 v247, v247, v31
s_load_dword s3, s[4:5], 50240
s_load_dword s3, s[4:5], 50304
s_load_dword s3, s[4:5], 50368
s_waitcnt vmcnt(12)
s_barrier
s_add_u32 s37, s35, 10
s_and_b32 s37, s37, 15
s_lshl_b32 s37, s37, 14
s_add_u32 m0, s39, 98304
s_nop 0
buffer_load_dwordx4 v2, s[8:11], s37 offen offset:0 sc1 lds
buffer_load_dwordx4 v2, s[8:11], s37 offen offset:1024 sc1 lds
buffer_load_dwordx4 v2, s[8:11], s37 offen offset:2048 sc1 lds
buffer_load_dwordx4 v2, s[8:11], s37 offen offset:3072 sc1 lds
s_add_u32 s38, s35, 14
s_and_b32 s38, s38, 15
s_lshl_b32 s38, s38, 17
s_add_u32 m0, s40, 131072
s_nop 0
buffer_load_dwordx4 v3, s[12:15], s38 offen lds
s_add_u32 m0, s40, 132096
s_add_u32 s38, s38, 16384
buffer_load_dwordx4 v3, s[12:15], s38 offen lds
v_lshlrev_b32 v24, 16, v152
v_and_b32 v25, 0xffff0000, v152
v_lshlrev_b32 v26, 16, v153
v_and_b32 v27, 0xffff0000, v153
v_lshlrev_b32 v28, 16, v154
v_and_b32 v29, 0xffff0000, v154
v_lshlrev_b32 v30, 16, v155
v_and_b32 v31, 0xffff0000, v155
v_add_f32 v240, v240, v24
v_add_f32 v241, v241, v25
v_add_f32 v242, v242, v26
v_add_f32 v243, v243, v27
v_add_f32 v244, v244, v28
v_add_f32 v245, v245, v29
v_add_f32 v246, v246, v30
v_add_f32 v247, v247, v31
s_load_dword s3, s[4:5], 57344
s_load_dword s3, s[4:5], 57408
s_load_dword s3, s[4:5], 57472
s_waitcnt vmcnt(14)
s_barrier
s_add_u32 s37, s35, 11
s_and_b32 s37, s37, 15
s_lshl_b32 s37, s37, 14
s_add_u32 m0, s39, 147456
s_nop 0
buffer_load_dwordx4 v2, s[8:11], s37 offen offset:0 sc1 lds
buffer_load_dwordx4 v2, s[8:11], s37 offen offset:1024 sc1 lds
buffer_load_dwordx4 v2, s[8:11], s37 offen offset:2048 sc1 lds
buffer_load_dwordx4 v2, s[8:11], s37 offen offset:3072 sc1 lds
s_add_u32 s38, s35, 15
s_and_b32 s38, s38, 15
s_lshl_b32 s38, s38, 17
s_add_u32 m0, s40, 139264
s_nop 0
buffer_load_dwordx4 v3, s[12:15], s38 offen lds
s_add_u32 m0, s40, 140288
s_add_u32 s38, s38, 16384
buffer_load_dwordx4 v3, s[12:15], s38 offen lds
v_lshlrev_b32 v24, 16, v156
v_and_b32 v25, 0xffff0000, v156
v_lshlrev_b32 v26, 16, v157
v_and_b32 v27, 0xffff0000, v157
v_lshlrev_b32 v28, 16, v158
v_and_b32 v29, 0xffff0000, v158
v_lshlrev_b32 v30, 16, v159
s_branch Lov_7
.p2align 12
Lst_7_0:
s_branch Lwr_146
s_nop 0
s_nop 0
Lov_7:
v_and_b32 v31, 0xffff0000, v159
v_add_f32 v240, v240, v24
v_add_f32 v241, v241, v25
v_add_f32 v242, v242, v26
v_add_f32 v243, v243, v27
v_add_f32 v244, v244, v28
v_add_f32 v245, v245, v29
v_add_f32 v246, v246, v30
v_add_f32 v247, v247, v31
s_load_dword s3, s[4:5], 57536
s_load_dword s3, s[4:5], 64512
s_load_dword s3, s[4:5], 64576
s_waitcnt vmcnt(14)
s_barrier
s_add_u32 s37, s35, 12
s_and_b32 s37, s37, 15
s_lshl_b32 s37, s37, 14
s_add_u32 m0, s39, 0
s_nop 0
buffer_load_dwordx4 v2, s[8:11], s37 offen offset:0 sc1 lds
buffer_load_dwordx4 v2, s[8:11], s37 offen offset:1024 sc1 lds
buffer_load_dwordx4 v2, s[8:11], s37 offen offset:2048 sc1 lds
buffer_load_dwordx4 v2, s[8:11], s37 offen offset:3072 sc1 lds
s_load_dword s3, s[4:5], 64640
s_load_dword s3, s[4:5], 64704
s_load_dword s3, s[4:5], 71680
s_waitcnt vmcnt(12)
s_barrier
s_add_u32 s37, s35, 13
s_and_b32 s37, s37, 15
s_lshl_b32 s37, s37, 14
s_add_u32 m0, s39, 49152
s_nop 0
buffer_load_dwordx4 v2, s[8:11], s37 offen offset:0 sc1 lds
buffer_load_dwordx4 v2, s[8:11], s37 offen offset:1024 sc1 lds
buffer_load_dwordx4 v2, s[8:11], s37 offen offset:2048 sc1 lds
buffer_load_dwordx4 v2, s[8:11], s37 offen offset:3072 sc1 lds
s_load_dword s3, s[4:5], 71744
s_load_dword s3, s[4:5], 71808
s_load_dword s3, s[4:5], 71872
s_waitcnt vmcnt(10)
s_barrier
s_add_u32 s37, s35, 14
s_and_b32 s37, s37, 15
s_lshl_b32 s37, s37, 14
s_add_u32 m0, s39, 98304
s_nop 0
buffer_load_dwordx4 v2, s[8:11], s37 offen offset:0 sc1 lds
buffer_load_dwordx4 v2, s[8:11], s37 offen offset:1024 sc1 lds
buffer_load_dwordx4 v2, s[8:11], s37 offen offset:2048 sc1 lds
buffer_load_dwordx4 v2, s[8:11], s37 offen offset:3072 sc1 lds
s_waitcnt vmcnt(8)
s_barrier
s_add_u32 s37, s35, 15
s_and_b32 s37, s37, 15
s_lshl_b32 s37, s37, 14
s_add_u32 m0, s39, 147456
s_nop 0
buffer_load_dwordx4 v2, s[8:11], s37 offen offset:0 sc1 lds
buffer_load_dwordx4 v2, s[8:11], s37 offen offset:1024 sc1 lds
buffer_load_dwordx4 v2, s[8:11], s37 offen offset:2048 sc1 lds
buffer_load_dwordx4 v2, s[8:11], s37 offen offset:3072 sc1 lds
s_waitcnt vmcnt(8)
s_barrier
s_nop 0
v_permlane32_swap_b32 v240, v244
v_permlane32_swap_b32 v241, v245
v_permlane32_swap_b32 v242, v246
v_permlane32_swap_b32 v243, v247
v_add_f32 v240, v240, v244
v_add_f32 v241, v241, v245
v_add_f32 v242, v242, v246
v_add_f32 v243, v243, v247
s_nop 0
v_permlane16_swap_b32 v240, v242
v_permlane16_swap_b32 v241, v243
v_add_f32 v240, v240, v242
v_add_f32 v241, v241, v243
s_waitcnt vmcnt(4)
s_barrier
s_add_u32 s38, s35, 0
s_and_b32 s38, s38, 15
s_mul_i32 s38, s38, 458752
s_add_u32 m0, s46, 0
s_nop 0
buffer_load_dwordx4 v8, s[88:91], s38 offen lds
s_add_u32 m0, s46, 1024
s_nop 0
buffer_load_dwordx4 v9, s[88:91], s38 offen lds
s_add_u32 m0, s46, 2048
s_nop 0
buffer_load_dwordx4 v10, s[88:91], s38 offen lds
s_add_u32 m0, s46, 3072
s_add_u32 s38, s38, 114688
buffer_load_dwordx4 v8, s[88:91], s38 offen lds
s_add_u32 m0, s46, 4096
s_nop 0
buffer_load_dwordx4 v9, s[88:91], s38 offen lds
s_add_u32 m0, s46, 5120
s_nop 0
buffer_load_dwordx4 v10, s[88:91], s38 offen lds
s_add_u32 s38, s35, 1
s_and_b32 s38, s38, 15
s_mul_i32 s38, s38, 458752
s_add_u32 m0, s46, 49152
s_nop 0
buffer_load_dwordx4 v8, s[88:91], s38 offen lds
s_add_u32 m0, s46, 50176
s_nop 0
buffer_load_dwordx4 v9, s[88:91], s38 offen lds
s_add_u32 m0, s46, 51200
s_nop 0
buffer_load_dwordx4 v10, s[88:91], s38 offen lds
s_add_u32 m0, s46, 52224
s_add_u32 s38, s38, 114688
buffer_load_dwordx4 v8, s[88:91], s38 offen lds
s_add_u32 m0, s46, 53248
s_nop 0
buffer_load_dwordx4 v9, s[88:91], s38 offen lds
s_add_u32 m0, s46, 54272
s_nop 0
buffer_load_dwordx4 v10, s[88:91], s38 offen lds
s_waitcnt vmcnt(12)
s_barrier
s_barrier
s_branch Lk3a
Lk2end_76:
Lk3:
s_branch Lgb_90
Lk3a:
s_mul_i32 s43, s34, 262144
s_add_u32 s8, s82, s43
s_addc_u32 s9, s83, 0
s_add_u32 s8, s8, 4194304
s_addc_u32 s9, s9, 0
s_mov_b32 s10, 262144
s_mov_b32 s11, 0x20000
s_mul_i32 s43, s34, 917504
s_add_u32 s24, s82, s43
s_addc_u32 s25, s83, 0
s_add_u32 s24, s24, 8388608
s_addc_u32 s25, s25, 0
s_mov_b32 s26, 917504
s_mov_b32 s27, 0x20000
s_add_u32 s84, s82, 27262976
s_addc_u32 s85, s83, 0
s_mov_b32 s86, 229376
s_mov_b32 s87, 0x20000
s_and_b32 s47, s36, 3
s_lshr_b32 s62, s47, 1
s_and_b32 s63, s47, 1
v_lshlrev_b32 v2, 4, v1
s_lshl_b32 s39, s47, 12
v_add_u32 v3, s39, v2
s_cmp_eq_u32 s62, 0
s_cselect_b32 s44, s72, s74
s_cselect_b32 s45, s73, s75
s_lshl_b32 s43, s35, 8
s_add_u32 s12, s44, s43
s_addc_u32 s13, s45, 0
s_mov_b32 s14, 7333120
s_mov_b32 s15, 0x20000
v_lshrrev_b32 v28, 4, v1
v_lshlrev_b32 v29, 1, v28
v_and_b32 v4, 15, v1
v_xor_b32 v4, v4, v29
v_lshlrev_b32 v4, 4, v4
v_mul_u32_u24 v28, 7168, v28
v_add_u32 v4, v4, v28
s_mul_i32 s43, s63, 229376
v_add_u32 v4, s43, v4
v_xor_b32 v5, 128, v4
v_add_u32 v5, 28672, v5
s_lshl_b32 s40, s47, 13
s_add_u32 s40, s40, 16384
s_lshl_b32 s43, s62, 12
v_add_u32 v9, s43, v2
v_add_u32 v10, 98304, v9
s_lshl_b32 s43, s47, 9
s_add_u32 s43, s43, 151552
v_and_b32 v28, 15, v1
v_lshl_add_u32 v28, v28, 5, s43
v_lshrrev_b32 v29, 4, v1
v_lshl_add_u32 v28, v29, 3, v28
ds_write_b64 v28, v[240:241]
s_waitcnt lgkmcnt(0)
v_lshrrev_b32 v27, 2, v1
v_bfe_u32 v28, v27, 2, 1
v_mul_u32_u24 v27, 192, v27
v_add_u32 v27, 16384, v27
v_and_b32 v29, 3, v1
v_lshl_add_u32 v12, v29, 3, v27
s_lshl_b32 s43, s63, 6
v_add_u32 v12, s43, v12
v_lshl_add_u32 v11, v28, 5, v12
v_xor_b32 v30, 1, v28
v_lshl_add_u32 v12, v30, 5, v12
v_xor_b32 v28, s63, v28
v_lshl_add_u32 v27, v28, 4, v27
v_lshrrev_b32 v28, 1, v29
v_lshl_add_u32 v27, v28, 5, v27
v_and_b32 v28, 1, v29
v_lshl_add_u32 v27, v28, 3, v27
v_add_u32 v13, 128, v27
v_add_u32 v14, 49152, v11
v_add_u32 v15, 49152, v12
v_add_u32 v16, 49152, v13
v_add_u32 v17, 98304, v11
v_add_u32 v18, 98304, v12
v_add_u32 v19, 98304, v13
v_bfe_u32 v28, v1, 3, 1
v_lshlrev_b32 v28, 6, v28
v_bfe_u32 v29, v1, 1, 2
s_lshl_b32 s43, s48, 3
s_lshl_b32 s44, s63, 2
s_add_u32 s43, s43, s44
v_add3_u32 v28, v28, v29, s43
v_mul_u32_u24 v28, 7168, v28
v_and_b32 v29, 1, v1
v_mul_u32_u24 v29, 188, v29
v_add_u32 v20, v28, v29
s_cmp_lg_u32 s36, 4
s_cbranch_scc1 Lwm_92
s_branch Lst_8_1
Lwr_158:
s_branch Lwe_91
Lwm_92:
s_cmp_lg_u32 s36, 5
s_cbranch_scc1 Lwm_93
s_branch Lst_9_1
Lwr_159:
s_branch Lwe_91
Lwm_93:
s_cmp_lg_u32 s36, 6
s_cbranch_scc1 Lwm_94
s_branch Lst_10_1
Lwr_160:
s_branch Lwe_91
Lwm_94:
s_cmp_lg_u32 s36, 7
s_cbranch_scc1 Lwm_95
s_nop 0
s_branch Lwe_91
Lwm_95:
Lwe_91:
s_barrier
s_cmp_lg_u32 s36, 4
s_cbranch_scc1 Lwm_97
s_branch Lst_11_1
Lwr_162:
s_branch Lwe_96
Lwm_97:
s_cmp_lg_u32 s36, 5
s_cbranch_scc1 Lwm_98
s_branch Lst_12_1
Lwr_163:
s_branch Lwe_96
Lwm_98:
s_cmp_lg_u32 s36, 6
s_cbranch_scc1 Lwm_99
s_branch Lst_13_1
Lwr_164:
s_branch Lwe_96
Lwm_99:
s_cmp_lg_u32 s36, 7
s_cbranch_scc1 Lwm_100
s_branch Lst_14_1
Lwr_165:
s_branch Lwe_96
Lwm_100:
Lwe_96:
s_waitcnt vmcnt(0) lgkmcnt(0)
s_barrier
ds_read_b128 v[32:35], v9 offset:0
ds_read_b64_tr_b16 v[48:49], v11 offset:0
ds_read_b64_tr_b16 v[50:51], v11 offset:3072
ds_read_b64_tr_b16 v[52:53], v12 offset:0
ds_read_b64_tr_b16 v[54:55], v12 offset:3072
ds_read_b64_tr_b16 v[56:57], v13 offset:0
ds_read_b64_tr_b16 v[58:59], v13 offset:3072
ds_read_b64_tr_b16 v[60:61], v11 offset:12288
ds_read_b64_tr_b16 v[62:63], v11 offset:15360
ds_read_b64_tr_b16 v[64:65], v12 offset:12288
ds_read_b64_tr_b16 v[66:67], v12 offset:15360
ds_read_b64_tr_b16 v[68:69], v13 offset:12288
ds_read_b64_tr_b16 v[70:71], v13 offset:15360
ds_read_b128 v[36:39], v9 offset:1024
ds_read_b128 v[40:43], v9 offset:2048
ds_read_b128 v[44:47], v9 offset:3072
s_waitcnt lgkmcnt(0)
v_mfma_f32_16x16x32_bf16 v[128:131], v[48:51], v[32:35], 0
ds_read_b128 v[72:75], v9 offset:8192
v_mfma_f32_16x16x32_bf16 v[132:135], v[52:55], v[32:35], 0
ds_read_b64_tr_b16 v[88:89], v11 offset:6144
v_mfma_f32_16x16x32_bf16 v[136:139], v[56:59], v[32:35], 0
ds_read_b64_tr_b16 v[90:91], v11 offset:9216
v_mfma_f32_16x16x32_bf16 v[140:143], v[60:63], v[32:35], 0
ds_read_b64_tr_b16 v[92:93], v12 offset:6144
v_mfma_f32_16x16x32_bf16 v[144:147], v[64:67], v[32:35], 0
ds_read_b64_tr_b16 v[94:95], v12 offset:9216
v_mfma_f32_16x16x32_bf16 v[148:151], v[68:71], v[32:35], 0
ds_read_b64_tr_b16 v[96:97], v13 offset:6144
v_mfma_f32_16x16x32_bf16 v[172:175], v[68:71], v[36:39], 0
ds_read_b64_tr_b16 v[98:99], v13 offset:9216
v_mfma_f32_16x16x32_bf16 v[168:171], v[64:67], v[36:39], 0
ds_read_b64_tr_b16 v[100:101], v11 offset:18432
v_mfma_f32_16x16x32_bf16 v[164:167], v[60:63], v[36:39], 0
ds_read_b64_tr_b16 v[102:103], v11 offset:21504
v_mfma_f32_16x16x32_bf16 v[160:163], v[56:59], v[36:39], 0
ds_read_b64_tr_b16 v[104:105], v12 offset:18432
v_mfma_f32_16x16x32_bf16 v[156:159], v[52:55], v[36:39], 0
ds_read_b64_tr_b16 v[106:107], v12 offset:21504
v_mfma_f32_16x16x32_bf16 v[152:155], v[48:51], v[36:39], 0
ds_read_b64_tr_b16 v[108:109], v13 offset:18432
v_mfma_f32_16x16x32_bf16 v[176:179], v[48:51], v[40:43], 0
ds_read_b64_tr_b16 v[110:111], v13 offset:21504
v_mfma_f32_16x16x32_bf16 v[180:183], v[52:55], v[40:43], 0
ds_read_b128 v[76:79], v9 offset:9216
v_mfma_f32_16x16x32_bf16 v[184:187], v[56:59], v[40:43], 0
ds_read_b128 v[80:83], v9 offset:10240
v_mfma_f32_16x16x32_bf16 v[188:191], v[60:63], v[40:43], 0
ds_read_b128 v[84:87], v9 offset:11264
v_mfma_f32_16x16x32_bf16 v[192:195], v[64:67], v[40:43], 0
v_mfma_f32_16x16x32_bf16 v[196:199], v[68:71], v[40:43], 0
v_mfma_f32_16x16x32_bf16 v[220:223], v[68:71], v[44:47], 0
v_mfma_f32_16x16x32_bf16 v[216:219], v[64:67], v[44:47], 0
v_mfma_f32_16x16x32_bf16 v[212:215], v[60:63], v[44:47], 0
v_mfma_f32_16x16x32_bf16 v[208:211], v[56:59], v[44:47], 0
v_mfma_f32_16x16x32_bf16 v[204:207], v[52:55], v[44:47], 0
v_mfma_f32_16x16x32_bf16 v[200:203], v[48:51], v[44:47], 0
s_waitcnt lgkmcnt(0)
s_barrier
v_mfma_f32_16x16x32_bf16 v[128:131], v[88:91], v[72:75], v[128:131]
ds_read_b128 v[32:35], v9 offset:49152
v_mfma_f32_16x16x32_bf16 v[132:135], v[92:95], v[72:75], v[132:135]
ds_read_b64_tr_b16 v[48:49], v14 offset:0
v_mfma_f32_16x16x32_bf16 v[136:139], v[96:99], v[72:75], v[136:139]
ds_read_b64_tr_b16 v[50:51], v14 offset:3072
v_mfma_f32_16x16x32_bf16 v[140:143], v[100:103], v[72:75], v[140:143]
ds_read_b64_tr_b16 v[52:53], v15 offset:0
v_mfma_f32_16x16x32_bf16 v[144:147], v[104:107], v[72:75], v[144:147]
ds_read_b64_tr_b16 v[54:55], v15 offset:3072
v_mfma_f32_16x16x32_bf16 v[148:151], v[108:111], v[72:75], v[148:151]
ds_read_b64_tr_b16 v[56:57], v16 offset:0
v_mfma_f32_16x16x32_bf16 v[172:175], v[108:111], v[76:79], v[172:175]
ds_read_b64_tr_b16 v[58:59], v16 offset:3072
v_mfma_f32_16x16x32_bf16 v[168:171], v[104:107], v[76:79], v[168:171]
ds_read_b64_tr_b16 v[60:61], v14 offset:12288
v_mfma_f32_16x16x32_bf16 v[164:167], v[100:103], v[76:79], v[164:167]
ds_read_b64_tr_b16 v[62:63], v14 offset:15360
v_mfma_f32_16x16x32_bf16 v[160:163], v[96:99], v[76:79], v[160:163]
ds_read_b64_tr_b16 v[64:65], v15 offset:12288
v_mfma_f32_16x16x32_bf16 v[156:159], v[92:95], v[76:79], v[156:159]
ds_read_b64_tr_b16 v[66:67], v15 offset:15360
v_mfma_f32_16x16x32_bf16 v[152:155], v[88:91], v[76:79], v[152:155]
ds_read_b64_tr_b16 v[68:69], v16 offset:12288
v_mfma_f32_16x16x32_bf16 v[176:179], v[88:91], v[80:83], v[176:179]
ds_read_b64_tr_b16 v[70:71], v16 offset:15360
v_mfma_f32_16x16x32_bf16 v[180:183], v[92:95], v[80:83], v[180:183]
ds_read_b128 v[36:39], v9 offset:50176
v_mfma_f32_16x16x32_bf16 v[184:187], v[96:99], v[80:83], v[184:187]
ds_read_b128 v[40:43], v9 offset:51200
v_mfma_f32_16x16x32_bf16 v[188:191], v[100:103], v[80:83], v[188:191]
ds_read_b128 v[44:47], v9 offset:52224
v_mfma_f32_16x16x32_bf16 v[192:195], v[104:107], v[80:83], v[192:195]
v_mfma_f32_16x16x32_bf16 v[196:199], v[108:111], v[80:83], v[196:199]
v_mfma_f32_16x16x32_bf16 v[220:223], v[108:111], v[84:87], v[220:223]
v_mfma_f32_16x16x32_bf16 v[216:219], v[104:107], v[84:87], v[216:219]
v_mfma_f32_16x16x32_bf16 v[212:215], v[100:103], v[84:87], v[212:215]
v_mfma_f32_16x16x32_bf16 v[208:211], v[96:99], v[84:87], v[208:211]
v_mfma_f32_16x16x32_bf16 v[204:207], v[92:95], v[84:87], v[204:207]
v_mfma_f32_16x16x32_bf16 v[200:203], v[88:91], v[84:87], v[200:203]
s_mov_b32 s41, 5
Lk3l_101:
s_waitcnt lgkmcnt(0)
v_mfma_f32_16x16x32_bf16 v[128:131], v[48:51], v[32:35], v[128:131]
ds_read_b128 v[72:75], v9 offset:57344
v_mfma_f32_16x16x32_bf16 v[132:135], v[52:55], v[32:35], v[132:135]
ds_read_b64_tr_b16 v[88:89], v14 offset:6144
v_mfma_f32_16x16x32_bf16 v[136:139], v[56:59], v[32:35], v[136:139]
ds_read_b64_tr_b16 v[90:91], v14 offset:9216
v_mfma_f32_16x16x32_bf16 v[140:143], v[60:63], v[32:35], v[140:143]
ds_read_b64_tr_b16 v[92:93], v15 offset:6144
v_mfma_f32_16x16x32_bf16 v[144:147], v[64:67], v[32:35], v[144:147]
ds_read_b64_tr_b16 v[94:95], v15 offset:9216
v_mfma_f32_16x16x32_bf16 v[148:151], v[68:71], v[32:35], v[148:151]
ds_read_b64_tr_b16 v[96:97], v16 offset:6144
v_mfma_f32_16x16x32_bf16 v[172:175], v[68:71], v[36:39], v[172:175]
ds_read_b64_tr_b16 v[98:99], v16 offset:9216
v_mfma_f32_16x16x32_bf16 v[168:171], v[64:67], v[36:39], v[168:171]
ds_read_b64_tr_b16 v[100:101], v14 offset:18432
v_mfma_f32_16x16x32_bf16 v[164:167], v[60:63], v[36:39], v[164:167]
ds_read_b64_tr_b16 v[102:103], v14 offset:21504
v_mfma_f32_16x16x32_bf16 v[160:163], v[56:59], v[36:39], v[160:163]
ds_read_b64_tr_b16 v[104:105], v15 offset:18432
v_mfma_f32_16x16x32_bf16 v[156:159], v[52:55], v[36:39], v[156:159]
ds_read_b64_tr_b16 v[106:107], v15 offset:21504
v_mfma_f32_16x16x32_bf16 v[152:155], v[48:51], v[36:39], v[152:155]
ds_read_b64_tr_b16 v[108:109], v16 offset:18432
v_mfma_f32_16x16x32_bf16 v[176:179], v[48:51], v[40:43], v[176:179]
ds_read_b64_tr_b16 v[110:111], v16 offset:21504
v_mfma_f32_16x16x32_bf16 v[180:183], v[52:55], v[40:43], v[180:183]
ds_read_b128 v[76:79], v9 offset:58368
v_mfma_f32_16x16x32_bf16 v[184:187], v[56:59], v[40:43], v[184:187]
ds_read_b128 v[80:83], v9 offset:59392
v_mfma_f32_16x16x32_bf16 v[188:191], v[60:63], v[40:43], v[188:191]
ds_read_b128 v[84:87], v9 offset:60416
v_mfma_f32_16x16x32_bf16 v[192:195], v[64:67], v[40:43], v[192:195]
v_mfma_f32_16x16x32_bf16 v[196:199], v[68:71], v[40:43], v[196:199]
v_mfma_f32_16x16x32_bf16 v[220:223], v[68:71], v[44:47], v[220:223]
v_mfma_f32_16x16x32_bf16 v[216:219], v[64:67], v[44:47], v[216:219]
v_mfma_f32_16x16x32_bf16 v[212:215], v[60:63], v[44:47], v[212:215]
v_mfma_f32_16x16x32_bf16 v[208:211], v[56:59], v[44:47], v[208:211]
v_mfma_f32_16x16x32_bf16 v[204:207], v[52:55], v[44:47], v[204:207]
v_mfma_f32_16x16x32_bf16 v[200:203], v[48:51], v[44:47], v[200:203]
s_waitcnt lgkmcnt(0)
s_barrier
v_mfma_f32_16x16x32_bf16 v[128:131], v[88:91], v[72:75], v[128:131]
ds_read_b128 v[32:35], v10 offset:0
v_mfma_f32_16x16x32_bf16 v[132:135], v[92:95], v[72:75], v[132:135]
ds_read_b64_tr_b16 v[48:49], v17 offset:0
v_mfma_f32_16x16x32_bf16 v[136:139], v[96:99], v[72:75], v[136:139]
ds_read_b64_tr_b16 v[50:51], v17 offset:3072
v_mfma_f32_16x16x32_bf16 v[140:143], v[100:103], v[72:75], v[140:143]
ds_read_b64_tr_b16 v[52:53], v18 offset:0
v_mfma_f32_16x16x32_bf16 v[144:147], v[104:107], v[72:75], v[144:147]
ds_read_b64_tr_b16 v[54:55], v18 offset:3072
v_mfma_f32_16x16x32_bf16 v[148:151], v[108:111], v[72:75], v[148:151]
ds_read_b64_tr_b16 v[56:57], v19 offset:0
v_mfma_f32_16x16x32_bf16 v[172:175], v[108:111], v[76:79], v[172:175]
ds_read_b64_tr_b16 v[58:59], v19 offset:3072
v_mfma_f32_16x16x32_bf16 v[168:171], v[104:107], v[76:79], v[168:171]
ds_read_b64_tr_b16 v[60:61], v17 offset:12288
v_mfma_f32_16x16x32_bf16 v[164:167], v[100:103], v[76:79], v[164:167]
ds_read_b64_tr_b16 v[62:63], v17 offset:15360
v_mfma_f32_16x16x32_bf16 v[160:163], v[96:99], v[76:79], v[160:163]
ds_read_b64_tr_b16 v[64:65], v18 offset:12288
v_mfma_f32_16x16x32_bf16 v[156:159], v[92:95], v[76:79], v[156:159]
ds_read_b64_tr_b16 v[66:67], v18 offset:15360
v_mfma_f32_16x16x32_bf16 v[152:155], v[88:91], v[76:79], v[152:155]
ds_read_b64_tr_b16 v[68:69], v19 offset:12288
v_mfma_f32_16x16x32_bf16 v[176:179], v[88:91], v[80:83], v[176:179]
ds_read_b64_tr_b16 v[70:71], v19 offset:15360
v_mfma_f32_16x16x32_bf16 v[180:183], v[92:95], v[80:83], v[180:183]
ds_read_b128 v[36:39], v10 offset:1024
v_mfma_f32_16x16x32_bf16 v[184:187], v[96:99], v[80:83], v[184:187]
ds_read_b128 v[40:43], v10 offset:2048
v_mfma_f32_16x16x32_bf16 v[188:191], v[100:103], v[80:83], v[188:191]
ds_read_b128 v[44:47], v10 offset:3072
v_mfma_f32_16x16x32_bf16 v[192:195], v[104:107], v[80:83], v[192:195]
v_mfma_f32_16x16x32_bf16 v[196:199], v[108:111], v[80:83], v[196:199]
v_mfma_f32_16x16x32_bf16 v[220:223], v[108:111], v[84:87], v[220:223]
v_mfma_f32_16x16x32_bf16 v[216:219], v[104:107], v[84:87], v[216:219]
v_mfma_f32_16x16x32_bf16 v[212:215], v[100:103], v[84:87], v[212:215]
v_mfma_f32_16x16x32_bf16 v[208:211], v[96:99], v[84:87], v[208:211]
v_mfma_f32_16x16x32_bf16 v[204:207], v[92:95], v[84:87], v[204:207]
v_mfma_f32_16x16x32_bf16 v[200:203], v[88:91], v[84:87], v[200:203]
s_waitcnt lgkmcnt(0)
v_mfma_f32_16x16x32_bf16 v[128:131], v[48:51], v[32:35], v[128:131]
ds_read_b128 v[72:75], v10 offset:8192
v_mfma_f32_16x16x32_bf16 v[132:135], v[52:55], v[32:35], v[132:135]
ds_read_b64_tr_b16 v[88:89], v17 offset:6144
v_mfma_f32_16x16x32_bf16 v[136:139], v[56:59], v[32:35], v[136:139]
ds_read_b64_tr_b16 v[90:91], v17 offset:9216
v_mfma_f32_16x16x32_bf16 v[140:143], v[60:63], v[32:35], v[140:143]
ds_read_b64_tr_b16 v[92:93], v18 offset:6144
v_mfma_f32_16x16x32_bf16 v[144:147], v[64:67], v[32:35], v[144:147]
ds_read_b64_tr_b16 v[94:95], v18 offset:9216
v_mfma_f32_16x16x32_bf16 v[148:151], v[68:71], v[32:35], v[148:151]
ds_read_b64_tr_b16 v[96:97], v19 offset:6144
v_mfma_f32_16x16x32_bf16 v[172:175], v[68:71], v[36:39], v[172:175]
ds_read_b64_tr_b16 v[98:99], v19 offset:9216
v_mfma_f32_16x16x32_bf16 v[168:171], v[64:67], v[36:39], v[168:171]
ds_read_b64_tr_b16 v[100:101], v17 offset:18432
v_mfma_f32_16x16x32_bf16 v[164:167], v[60:63], v[36:39], v[164:167]
ds_read_b64_tr_b16 v[102:103], v17 offset:21504
v_mfma_f32_16x16x32_bf16 v[160:163], v[56:59], v[36:39], v[160:163]
ds_read_b64_tr_b16 v[104:105], v18 offset:18432
v_mfma_f32_16x16x32_bf16 v[156:159], v[52:55], v[36:39], v[156:159]
ds_read_b64_tr_b16 v[106:107], v18 offset:21504
v_mfma_f32_16x16x32_bf16 v[152:155], v[48:51], v[36:39], v[152:155]
ds_read_b64_tr_b16 v[108:109], v19 offset:18432
v_mfma_f32_16x16x32_bf16 v[176:179], v[48:51], v[40:43], v[176:179]
ds_read_b64_tr_b16 v[110:111], v19 offset:21504
v_mfma_f32_16x16x32_bf16 v[180:183], v[52:55], v[40:43], v[180:183]
ds_read_b128 v[76:79], v10 offset:9216
v_mfma_f32_16x16x32_bf16 v[184:187], v[56:59], v[40:43], v[184:187]
ds_read_b128 v[80:83], v10 offset:10240
v_mfma_f32_16x16x32_bf16 v[188:191], v[60:63], v[40:43], v[188:191]
ds_read_b128 v[84:87], v10 offset:11264
v_mfma_f32_16x16x32_bf16 v[192:195], v[64:67], v[40:43], v[192:195]
v_mfma_f32_16x16x32_bf16 v[196:199], v[68:71], v[40:43], v[196:199]
v_mfma_f32_16x16x32_bf16 v[220:223], v[68:71], v[44:47], v[220:223]
v_mfma_f32_16x16x32_bf16 v[216:219], v[64:67], v[44:47], v[216:219]
v_mfma_f32_16x16x32_bf16 v[212:215], v[60:63], v[44:47], v[212:215]
v_mfma_f32_16x16x32_bf16 v[208:211], v[56:59], v[44:47], v[208:211]
v_mfma_f32_16x16x32_bf16 v[204:207], v[52:55], v[44:47], v[204:207]
v_mfma_f32_16x16x32_bf16 v[200:203], v[48:51], v[44:47], v[200:203]
s_waitcnt lgkmcnt(0)
s_barrier
v_mfma_f32_16x16x32_bf16 v[128:131], v[88:91], v[72:75], v[128:131]
ds_read_b128 v[32:35], v9 offset:0
v_mfma_f32_16x16x32_bf16 v[132:135], v[92:95], v[72:75], v[132:135]
ds_read_b64_tr_b16 v[48:49], v11 offset:0
v_mfma_f32_16x16x32_bf16 v[136:139], v[96:99], v[72:75], v[136:139]
ds_read_b64_tr_b16 v[50:51], v11 offset:3072
v_mfma_f32_16x16x32_bf16 v[140:143], v[100:103], v[72:75], v[140:143]
ds_read_b64_tr_b16 v[52:53], v12 offset:0
v_mfma_f32_16x16x32_bf16 v[144:147], v[104:107], v[72:75], v[144:147]
ds_read_b64_tr_b16 v[54:55], v12 offset:3072
v_mfma_f32_16x16x32_bf16 v[148:151], v[108:111], v[72:75], v[148:151]
ds_read_b64_tr_b16 v[56:57], v13 offset:0
v_mfma_f32_16x16x32_bf16 v[172:175], v[108:111], v[76:79], v[172:175]
ds_read_b64_tr_b16 v[58:59], v13 offset:3072
v_mfma_f32_16x16x32_bf16 v[168:171], v[104:107], v[76:79], v[168:171]
ds_read_b64_tr_b16 v[60:61], v11 offset:12288
v_mfma_f32_16x16x32_bf16 v[164:167], v[100:103], v[76:79], v[164:167]
ds_read_b64_tr_b16 v[62:63], v11 offset:15360
v_mfma_f32_16x16x32_bf16 v[160:163], v[96:99], v[76:79], v[160:163]
ds_read_b64_tr_b16 v[64:65], v12 offset:12288
v_mfma_f32_16x16x32_bf16 v[156:159], v[92:95], v[76:79], v[156:159]
ds_read_b64_tr_b16 v[66:67], v12 offset:15360
v_mfma_f32_16x16x32_bf16 v[152:155], v[88:91], v[76:79], v[152:155]
ds_read_b64_tr_b16 v[68:69], v13 offset:12288
v_mfma_f32_16x16x32_bf16 v[176:179], v[88:91], v[80:83], v[176:179]
ds_read_b64_tr_b16 v[70:71], v13 offset:15360
v_mfma_f32_16x16x32_bf16 v[180:183], v[92:95], v[80:83], v[180:183]
ds_read_b128 v[36:39], v9 offset:1024
v_mfma_f32_16x16x32_bf16 v[184:187], v[96:99], v[80:83], v[184:187]
ds_read_b128 v[40:43], v9 offset:2048
v_mfma_f32_16x16x32_bf16 v[188:191], v[100:103], v[80:83], v[188:191]
ds_read_b128 v[44:47], v9 offset:3072
v_mfma_f32_16x16x32_bf16 v[192:195], v[104:107], v[80:83], v[192:195]
v_mfma_f32_16x16x32_bf16 v[196:199], v[108:111], v[80:83], v[196:199]
v_mfma_f32_16x16x32_bf16 v[220:223], v[108:111], v[84:87], v[220:223]
v_mfma_f32_16x16x32_bf16 v[216:219], v[104:107], v[84:87], v[216:219]
v_mfma_f32_16x16x32_bf16 v[212:215], v[100:103], v[84:87], v[212:215]
v_mfma_f32_16x16x32_bf16 v[208:211], v[96:99], v[84:87], v[208:211]
v_mfma_f32_16x16x32_bf16 v[204:207], v[92:95], v[84:87], v[204:207]
v_mfma_f32_16x16x32_bf16 v[200:203], v[88:91], v[84:87], v[200:203]
s_waitcnt lgkmcnt(0)
v_mfma_f32_16x16x32_bf16 v[128:131], v[48:51], v[32:35], v[128:131]
ds_read_b128 v[72:75], v9 offset:8192
v_mfma_f32_16x16x32_bf16 v[132:135], v[52:55], v[32:35], v[132:135]
ds_read_b64_tr_b16 v[88:89], v11 offset:6144
v_mfma_f32_16x16x32_bf16 v[136:139], v[56:59], v[32:35], v[136:139]
ds_read_b64_tr_b16 v[90:91], v11 offset:9216
v_mfma_f32_16x16x32_bf16 v[140:143], v[60:63], v[32:35], v[140:143]
ds_read_b64_tr_b16 v[92:93], v12 offset:6144
v_mfma_f32_16x16x32_bf16 v[144:147], v[64:67], v[32:35], v[144:147]
ds_read_b64_tr_b16 v[94:95], v12 offset:9216
v_mfma_f32_16x16x32_bf16 v[148:151], v[68:71], v[32:35], v[148:151]
ds_read_b64_tr_b16 v[96:97], v13 offset:6144
v_mfma_f32_16x16x32_bf16 v[172:175], v[68:71], v[36:39], v[172:175]
ds_read_b64_tr_b16 v[98:99], v13 offset:9216
v_mfma_f32_16x16x32_bf16 v[168:171], v[64:67], v[36:39], v[168:171]
ds_read_b64_tr_b16 v[100:101], v11 offset:18432
v_mfma_f32_16x16x32_bf16 v[164:167], v[60:63], v[36:39], v[164:167]
ds_read_b64_tr_b16 v[102:103], v11 offset:21504
v_mfma_f32_16x16x32_bf16 v[160:163], v[56:59], v[36:39], v[160:163]
ds_read_b64_tr_b16 v[104:105], v12 offset:18432
v_mfma_f32_16x16x32_bf16 v[156:159], v[52:55], v[36:39], v[156:159]
ds_read_b64_tr_b16 v[106:107], v12 offset:21504
v_mfma_f32_16x16x32_bf16 v[152:155], v[48:51], v[36:39], v[152:155]
ds_read_b64_tr_b16 v[108:109], v13 offset:18432
v_mfma_f32_16x16x32_bf16 v[176:179], v[48:51], v[40:43], v[176:179]
ds_read_b64_tr_b16 v[110:111], v13 offset:21504
v_mfma_f32_16x16x32_bf16 v[180:183], v[52:55], v[40:43], v[180:183]
ds_read_b128 v[76:79], v9 offset:9216
v_mfma_f32_16x16x32_bf16 v[184:187], v[56:59], v[40:43], v[184:187]
ds_read_b128 v[80:83], v9 offset:10240
v_mfma_f32_16x16x32_bf16 v[188:191], v[60:63], v[40:43], v[188:191]
ds_read_b128 v[84:87], v9 offset:11264
v_mfma_f32_16x16x32_bf16 v[192:195], v[64:67], v[40:43], v[192:195]
v_mfma_f32_16x16x32_bf16 v[196:199], v[68:71], v[40:43], v[196:199]
v_mfma_f32_16x16x32_bf16 v[220:223], v[68:71], v[44:47], v[220:223]
v_mfma_f32_16x16x32_bf16 v[216:219], v[64:67], v[44:47], v[216:219]
v_mfma_f32_16x16x32_bf16 v[212:215], v[60:63], v[44:47], v[212:215]
v_mfma_f32_16x16x32_bf16 v[208:211], v[56:59], v[44:47], v[208:211]
v_mfma_f32_16x16x32_bf16 v[204:207], v[52:55], v[44:47], v[204:207]
v_mfma_f32_16x16x32_bf16 v[200:203], v[48:51], v[44:47], v[200:203]
s_waitcnt lgkmcnt(0)
s_barrier
v_mfma_f32_16x16x32_bf16 v[128:131], v[88:91], v[72:75], v[128:131]
ds_read_b128 v[32:35], v9 offset:49152
v_mfma_f32_16x16x32_bf16 v[132:135], v[92:95], v[72:75], v[132:135]
ds_read_b64_tr_b16 v[48:49], v14 offset:0
v_mfma_f32_16x16x32_bf16 v[136:139], v[96:99], v[72:75], v[136:139]
ds_read_b64_tr_b16 v[50:51], v14 offset:3072
v_mfma_f32_16x16x32_bf16 v[140:143], v[100:103], v[72:75], v[140:143]
ds_read_b64_tr_b16 v[52:53], v15 offset:0
v_mfma_f32_16x16x32_bf16 v[144:147], v[104:107], v[72:75], v[144:147]
ds_read_b64_tr_b16 v[54:55], v15 offset:3072
v_mfma_f32_16x16x32_bf16 v[148:151], v[108:111], v[72:75], v[148:151]
ds_read_b64_tr_b16 v[56:57], v16 offset:0
v_mfma_f32_16x16x32_bf16 v[172:175], v[108:111], v[76:79], v[172:175]
ds_read_b64_tr_b16 v[58:59], v16 offset:3072
v_mfma_f32_16x16x32_bf16 v[168:171], v[104:107], v[76:79], v[168:171]
ds_read_b64_tr_b16 v[60:61], v14 offset:12288
v_mfma_f32_16x16x32_bf16 v[164:167], v[100:103], v[76:79], v[164:167]
ds_read_b64_tr_b16 v[62:63], v14 offset:15360
v_mfma_f32_16x16x32_bf16 v[160:163], v[96:99], v[76:79], v[160:163]
ds_read_b64_tr_b16 v[64:65], v15 offset:12288
v_mfma_f32_16x16x32_bf16 v[156:159], v[92:95], v[76:79], v[156:159]
ds_read_b64_tr_b16 v[66:67], v15 offset:15360
v_mfma_f32_16x16x32_bf16 v[152:155], v[88:91], v[76:79], v[152:155]
ds_read_b64_tr_b16 v[68:69], v16 offset:12288
v_mfma_f32_16x16x32_bf16 v[176:179], v[88:91], v[80:83], v[176:179]
ds_read_b64_tr_b16 v[70:71], v16 offset:15360
v_mfma_f32_16x16x32_bf16 v[180:183], v[92:95], v[80:83], v[180:183]
ds_read_b128 v[36:39], v9 offset:50176
v_mfma_f32_16x16x32_bf16 v[184:187], v[96:99], v[80:83], v[184:187]
ds_read_b128 v[40:43], v9 offset:51200
v_mfma_f32_16x16x32_bf16 v[188:191], v[100:103], v[80:83], v[188:191]
s_branch Lov_8
.p2align 12
Lst_8_0:
s_branch Lwr_147
Lst_8_1:
s_branch Lwr_158
s_nop 0
Lov_8:
ds_read_b128 v[44:47], v9 offset:52224
v_mfma_f32_16x16x32_bf16 v[192:195], v[104:107], v[80:83], v[192:195]
v_mfma_f32_16x16x32_bf16 v[196:199], v[108:111], v[80:83], v[196:199]
v_mfma_f32_16x16x32_bf16 v[220:223], v[108:111], v[84:87], v[220:223]
v_mfma_f32_16x16x32_bf16 v[216:219], v[104:107], v[84:87], v[216:219]
v_mfma_f32_16x16x32_bf16 v[212:215], v[100:103], v[84:87], v[212:215]
v_mfma_f32_16x16x32_bf16 v[208:211], v[96:99], v[84:87], v[208:211]
v_mfma_f32_16x16x32_bf16 v[204:207], v[92:95], v[84:87], v[204:207]
v_mfma_f32_16x16x32_bf16 v[200:203], v[88:91], v[84:87], v[200:203]
s_sub_u32 s41, s41, 1
s_cmp_lg_u32 s41, 0
s_cbranch_scc1 Lk3l_101
s_waitcnt lgkmcnt(0)
s_mov_b32 s28, s76
s_mov_b32 s29, s77
s_mov_b32 s30, 7340032
s_mov_b32 s31, 0x20000
s_add_u32 s37, s35, 2
s_and_b32 s37, s37, 15
s_mul_i32 s37, s37, 16384
s_add_u32 m0, s39, 0
s_nop 0
buffer_load_dwordx4 v3, s[8:11], s37 offen sc1 lds
v_lshrrev_b32 v86, 4, v1
s_lshl_b32 s43, s63, 7
s_add_u32 s43, s43, 148992
buffer_load_dwordx4 v3, s[8:11], s37 offen offset:1024 sc1 lds
v_lshl_add_u32 v87, v86, 4, s43
v_lshrrev_b32 v88, 1, v86
v_and_b32 v86, 1, v86
s_lshl_b32 s43, s63, 5
buffer_load_dwordx4 v3, s[8:11], s37 offen offset:2048 sc1 lds
s_add_u32 s43, s43, 149248
v_lshl_add_u32 v88, v88, 6, s43
v_lshl_add_u32 v88, v86, 4, v88
v_and_b32 v86, 15, v1
buffer_load_dwordx4 v3, s[8:11], s37 offen offset:3072 sc1 lds
s_lshl_b32 s43, s62, 9
s_add_u32 s43, s43, 147456
v_lshl_add_u32 v86, v86, 3, s43
s_add_u32 s38, s35, 2
s_and_b32 s38, s38, 15
s_mul_i32 s38, s38, 458752
s_add_u32 m0, s40, 0
s_nop 0
buffer_load_dwordx4 v4, s[12:15], s38 offen lds
ds_read_b128 v[32:35], v87 offset:0
ds_read_b128 v[36:39], v87 offset:64
ds_read_b128 v[40:43], v88 offset:0
ds_read_b128 v[44:47], v87 offset:896
s_add_u32 m0, s40, 1024
s_nop 0
buffer_load_dwordx4 v5, s[12:15], s38 offen lds
ds_read_b128 v[48:51], v87 offset:960
ds_read_b128 v[52:55], v88 offset:896
ds_read_b64 v[56:57], v86 offset:0
ds_read_b64 v[58:59], v86 offset:128
s_add_u32 m0, s40, 2048
s_add_u32 s38, s38, 57344
buffer_load_dwordx4 v4, s[12:15], s38 offen lds
ds_read_b64 v[60:61], v86 offset:256
ds_read_b64 v[62:63], v86 offset:384
s_mul_i32 s54, s35, 24576
s_add_u32 m0, s40, 3072
s_nop 0
buffer_load_dwordx4 v5, s[12:15], s38 offen lds
s_lshl_b32 s43, s62, 12
s_add_u32 s54, s54, s43
s_add_u32 s54, s54, 524288
s_lshl_b32 s43, s63, 9
s_add_u32 m0, s40, 4096
s_add_u32 s38, s38, 57344
buffer_load_dwordx4 v4, s[12:15], s38 offen lds
s_add_u32 s55, s54, s43
s_add_u32 s55, s55, 16384
s_lshl_b32 s43, s63, 13
s_add_u32 s54, s54, s43
s_add_u32 m0, s40, 5120
s_nop 0
buffer_load_dwordx4 v5, s[12:15], s38 offen lds
v_and_b32 v84, 32, v1
v_lshlrev_b32 v84, 4, v84
v_add_u32 v84, v84, v2
s_waitcnt lgkmcnt(0)
s_add_u32 m0, s40, 6144
s_add_u32 s38, s38, 57344
buffer_load_dwordx4 v4, s[12:15], s38 offen lds
s_add_u32 m0, s40, 7168
s_nop 0
buffer_load_dwordx4 v5, s[12:15], s38 offen lds
s_and_b32 s44, s36, 3
s_mul_i32 s43, s2, 28672
s_mul_i32 s44, s44, 7168
s_add_u32 s43, s43, s44
s_add_u32 s4, s76, s43
s_addc_u32 s5, s77, 0
s_barrier
s_cmp_eq_u32 s47, 3
s_cbranch_scc0 Lw_102
v_and_b32 v30, 31, v1
v_lshlrev_b32 v30, 4, v30
v_add_u32 v31, 153600, v30
ds_read_b128 v[108:111], v31 offset:0
ds_read_b128 v[112:115], v31 offset:512
ds_read_b128 v[116:119], v31 offset:1024
ds_read_b128 v[120:123], v31 offset:1536
s_and_b32 s44, s2, 15
s_mul_i32 s44, s44, 14336
s_lshr_b32 s43, s2, 4
s_lshl_b32 s43, s43, 9
s_add_u32 s44, s44, s43
s_waitcnt lgkmcnt(0)
v_add_f32 v108, v108, v112
v_add_f32 v116, v116, v120
v_add_f32 v109, v109, v113
v_add_f32 v117, v117, v121
v_add_f32 v110, v110, v114
v_add_f32 v118, v118, v122
v_add_f32 v111, v111, v115
v_add_f32 v119, v119, v123
v_add_f32 v108, v108, v116
v_add_f32 v109, v109, v117
v_add_f32 v110, v110, v118
v_add_f32 v111, v111, v119
s_mov_b64 exec, 0xffffffff
buffer_store_dwordx4 v[108:111], v30, s[84:87], s44 offen sc1
s_mov_b64 exec, -1
Lw_102:
s_waitcnt lgkmcnt(0)
s_add_u32 s37, s35, 3
s_and_b32 s37, s37, 15
s_mul_i32 s37, s37, 16384
s_add_u32 m0, s39, 49152
s_nop 0
buffer_load_dwordx4 v3, s[8:11], s37 offen sc1 lds
s_load_dword s3, s[4:5], 1792
s_load_dword s3, s[4:5], 1856
s_load_dword s3, s[4:5], 1920
s_load_dword s3, s[4:5], 1984
s_load_dword s3, s[4:5], 2048
s_load_dword s3, s[4:5], 2112
s_load_dword s3, s[4:5], 2176
buffer_load_dwordx4 v3, s[8:11], s37 offen offset:1024 sc1 lds
s_load_dword s3, s[4:5], 2240
s_load_dword s3, s[4:5], 2304
s_load_dword s3, s[4:5], 2368
s_load_dword s3, s[4:5], 2432
s_load_dword s3, s[4:5], 2496
s_load_dword s3, s[4:5], 2560
s_load_dword s3, s[4:5], 2624
buffer_load_dwordx4 v3, s[8:11], s37 offen offset:2048 sc1 lds
v_mul_f32 v66, v57, v57
v_mul_f32 v64, 0xc0135761, v57
v_mul_f32 v65, 0xbdd2d3e8, v57
v_mul_f32 v65, v65, v66
v_rcp_f32 v66, v66
v_mul_f32 v70, v59, v59
v_mul_f32 v68, 0xc0135761, v59
buffer_load_dwordx4 v3, s[8:11], s37 offen offset:3072 sc1 lds
v_mul_f32 v69, 0xbdd2d3e8, v59
v_mul_f32 v69, v69, v70
v_rcp_f32 v70, v70
v_fma_f32 v128, -v56, v32, v128
v_fma_f32 v129, -v56, v33, v129
v_fma_f32 v130, -v56, v34, v130
v_fma_f32 v131, -v56, v35, v131
v_fma_f32 v152, -v58, v32, v152
s_add_u32 s38, s35, 3
s_and_b32 s38, s38, 15
s_mul_i32 s38, s38, 458752
s_add_u32 m0, s40, 49152
s_nop 0
buffer_load_dwordx4 v4, s[12:15], s38 offen lds
v_fma_f32 v153, -v58, v33, v153
v_fma_f32 v154, -v58, v34, v154
v_fma_f32 v155, -v58, v35, v155
v_mul_f32 v72, v128, v128
v_mul_f32 v73, v129, v129
v_mul_f32 v74, v130, v130
v_mul_f32 v75, v131, v131
s_add_u32 m0, s40, 50176
s_nop 0
buffer_load_dwordx4 v5, s[12:15], s38 offen lds
v_mul_f32 v76, v152, v152
v_mul_f32 v77, v153, v153
v_mul_f32 v78, v154, v154
v_mul_f32 v79, v155, v155
v_fma_f32 v72, v72, v65, v64
v_fma_f32 v73, v73, v65, v64
v_fma_f32 v74, v74, v65, v64
s_add_u32 m0, s40, 51200
s_add_u32 s38, s38, 57344
buffer_load_dwordx4 v4, s[12:15], s38 offen lds
v_fma_f32 v75, v75, v65, v64
v_fma_f32 v76, v76, v69, v68
v_fma_f32 v77, v77, v69, v68
v_fma_f32 v78, v78, v69, v68
v_fma_f32 v79, v79, v69, v68
v_mul_f32 v72, v72, v128
v_mul_f32 v73, v73, v129
v_mul_f32 v74, v74, v130
s_add_u32 m0, s40, 52224
s_nop 0
buffer_load_dwordx4 v5, s[12:15], s38 offen lds
v_mul_f32 v75, v75, v131
v_mul_f32 v76, v76, v152
v_mul_f32 v77, v77, v153
v_mul_f32 v78, v78, v154
v_mul_f32 v79, v79, v155
v_exp_f32 v72, v72
v_exp_f32 v73, v73
s_add_u32 m0, s40, 53248
s_add_u32 s38, s38, 57344
buffer_load_dwordx4 v4, s[12:15], s38 offen lds
v_exp_f32 v74, v74
v_exp_f32 v75, v75
v_exp_f32 v76, v76
v_exp_f32 v77, v77
v_exp_f32 v78, v78
v_exp_f32 v79, v79
v_fma_f32 v140, -v56, v44, v140
s_add_u32 m0, s40, 54272
s_nop 0
buffer_load_dwordx4 v5, s[12:15], s38 offen lds
v_fma_f32 v141, -v56, v45, v141
v_fma_f32 v142, -v56, v46, v142
v_fma_f32 v143, -v56, v47, v143
v_fma_f32 v164, -v58, v44, v164
v_fma_f32 v165, -v58, v45, v165
v_fma_f32 v166, -v58, v46, v166
v_fma_f32 v167, -v58, v47, v167
v_fma_f32 v72, v72, v66, v66
s_add_u32 m0, s40, 55296
s_add_u32 s38, s38, 57344
buffer_load_dwordx4 v4, s[12:15], s38 offen lds
s_add_u32 m0, s40, 56320
s_nop 0
buffer_load_dwordx4 v5, s[12:15], s38 offen lds
s_waitcnt vmcnt(12)
s_barrier
s_add_u32 s37, s35, 4
s_and_b32 s37, s37, 15
s_mul_i32 s37, s37, 16384
s_add_u32 m0, s39, 98304
s_nop 0
buffer_load_dwordx4 v3, s[8:11], s37 offen sc1 lds
v_fma_f32 v73, v73, v66, v66
v_fma_f32 v74, v74, v66, v66
v_fma_f32 v75, v75, v66, v66
v_fma_f32 v76, v76, v70, v70
v_fma_f32 v77, v77, v70, v70
v_fma_f32 v78, v78, v70, v70
buffer_load_dwordx4 v3, s[8:11], s37 offen offset:1024 sc1 lds
v_fma_f32 v79, v79, v70, v70
v_rcp_f32 v72, v72
v_rcp_f32 v73, v73
v_rcp_f32 v74, v74
v_rcp_f32 v75, v75
v_rcp_f32 v76, v76
buffer_load_dwordx4 v3, s[8:11], s37 offen offset:2048 sc1 lds
v_rcp_f32 v77, v77
v_rcp_f32 v78, v78
v_rcp_f32 v79, v79
v_mul_f32 v140, v128, v140
v_mul_f32 v141, v129, v141
v_mul_f32 v142, v130, v142
buffer_load_dwordx4 v3, s[8:11], s37 offen offset:3072 sc1 lds
v_mul_f32 v143, v131, v143
v_mul_f32 v164, v152, v164
v_mul_f32 v165, v153, v165
v_mul_f32 v166, v154, v166
v_mul_f32 v167, v155, v167
v_mul_f32 v140, v140, v72
s_add_u32 s38, s35, 4
s_and_b32 s38, s38, 15
s_mul_i32 s38, s38, 458752
s_add_u32 m0, s40, 98304
s_nop 0
buffer_load_dwordx4 v4, s[12:15], s38 offen lds
v_mul_f32 v141, v141, v73
v_mul_f32 v142, v142, v74
v_mul_f32 v143, v143, v75
v_mul_f32 v164, v164, v76
v_mul_f32 v165, v165, v77
v_mul_f32 v166, v166, v78
s_add_u32 m0, s40, 99328
s_nop 0
buffer_load_dwordx4 v5, s[12:15], s38 offen lds
v_mul_f32 v167, v167, v79
v_cvt_pk_bf16_f32 v128, v140, v141
v_cvt_pk_bf16_f32 v129, v142, v143
v_cvt_pk_bf16_f32 v152, v164, v165
v_cvt_pk_bf16_f32 v153, v166, v167
v_fma_f32 v132, -v56, v36, v132
s_add_u32 m0, s40, 100352
s_add_u32 s38, s38, 57344
buffer_load_dwordx4 v4, s[12:15], s38 offen lds
v_fma_f32 v133, -v56, v37, v133
v_fma_f32 v134, -v56, v38, v134
v_fma_f32 v135, -v56, v39, v135
v_fma_f32 v156, -v58, v36, v156
v_fma_f32 v157, -v58, v37, v157
v_fma_f32 v158, -v58, v38, v158
s_add_u32 m0, s40, 101376
s_nop 0
buffer_load_dwordx4 v5, s[12:15], s38 offen lds
v_fma_f32 v159, -v58, v39, v159
v_mul_f32 v72, v132, v132
v_mul_f32 v73, v133, v133
v_mul_f32 v74, v134, v134
v_mul_f32 v75, v135, v135
v_mul_f32 v76, v156, v156
s_add_u32 m0, s40, 102400
s_add_u32 s38, s38, 57344
buffer_load_dwordx4 v4, s[12:15], s38 offen lds
v_mul_f32 v77, v157, v157
v_mul_f32 v78, v158, v158
v_mul_f32 v79, v159, v159
v_fma_f32 v72, v72, v65, v64
v_fma_f32 v73, v73, v65, v64
v_fma_f32 v74, v74, v65, v64
s_add_u32 m0, s40, 103424
s_nop 0
buffer_load_dwordx4 v5, s[12:15], s38 offen lds
v_fma_f32 v75, v75, v65, v64
v_fma_f32 v76, v76, v69, v68
v_fma_f32 v77, v77, v69, v68
v_fma_f32 v78, v78, v69, v68
v_fma_f32 v79, v79, v69, v68
v_mul_f32 v72, v72, v132
s_add_u32 m0, s40, 104448
s_add_u32 s38, s38, 57344
buffer_load_dwordx4 v4, s[12:15], s38 offen lds
s_add_u32 m0, s40, 105472
s_nop 0
buffer_load_dwordx4 v5, s[12:15], s38 offen lds
s_waitcnt vmcnt(12)
s_barrier
s_cmp_eq_u32 s47, 3
s_cbranch_scc0 Lw_103
s_lshr_b32 s43, s2, 4
s_add_u32 s43, s43, 80
s_lshl_b32 s43, s43, 7
v_mov_b32 v30, s43
v_mov_b32 v31, 1
s_mov_b64 exec, 1
buffer_atomic_add v31, v30, s[56:59], 0 offen sc1
s_mov_b64 exec, -1
Lw_103:
s_waitcnt lgkmcnt(0)
s_add_u32 s37, s35, 5
s_and_b32 s37, s37, 15
s_mul_i32 s37, s37, 16384
s_add_u32 m0, s39, 0
s_nop 0
buffer_load_dwordx4 v3, s[8:11], s37 offen sc1 lds
s_load_dword s3, s[4:5], 2688
s_load_dword s3, s[4:5], 2752
s_load_dword s3, s[4:5], 2816
s_load_dword s3, s[4:5], 2880
s_load_dword s3, s[4:5], 2944
s_load_dword s3, s[4:5], 3008
s_load_dword s3, s[4:5], 3072
buffer_load_dwordx4 v3, s[8:11], s37 offen offset:1024 sc1 lds
s_load_dword s3, s[4:5], 3136
s_load_dword s3, s[4:5], 3200
s_load_dword s3, s[4:5], 3264
s_load_dword s3, s[4:5], 3328
s_load_dword s3, s[4:5], 3392
s_load_dword s3, s[4:5], 3456
s_load_dword s3, s[4:5], 3520
buffer_load_dwordx4 v3, s[8:11], s37 offen offset:2048 sc1 lds
v_mul_f32 v73, v73, v133
v_mul_f32 v74, v74, v134
v_mul_f32 v75, v75, v135
v_mul_f32 v76, v76, v156
v_mul_f32 v77, v77, v157
v_mul_f32 v78, v78, v158
v_mul_f32 v79, v79, v159
v_exp_f32 v72, v72
buffer_load_dwordx4 v3, s[8:11], s37 offen offset:3072 sc1 lds
v_exp_f32 v73, v73
v_exp_f32 v74, v74
v_exp_f32 v75, v75
v_exp_f32 v76, v76
v_exp_f32 v77, v77
v_exp_f32 v78, v78
v_exp_f32 v79, v79
s_add_u32 s38, s35, 5
s_and_b32 s38, s38, 15
s_mul_i32 s38, s38, 458752
s_add_u32 m0, s40, 0
s_nop 0
buffer_load_dwordx4 v4, s[12:15], s38 offen lds
v_fma_f32 v144, -v56, v48, v144
v_fma_f32 v145, -v56, v49, v145
v_fma_f32 v146, -v56, v50, v146
v_fma_f32 v147, -v56, v51, v147
v_fma_f32 v168, -v58, v48, v168
v_fma_f32 v169, -v58, v49, v169
v_fma_f32 v170, -v58, v50, v170
v_fma_f32 v171, -v58, v51, v171
s_add_u32 m0, s40, 1024
s_nop 0
buffer_load_dwordx4 v5, s[12:15], s38 offen lds
v_fma_f32 v72, v72, v66, v66
v_fma_f32 v73, v73, v66, v66
v_fma_f32 v74, v74, v66, v66
v_fma_f32 v75, v75, v66, v66
v_fma_f32 v76, v76, v70, v70
v_fma_f32 v77, v77, v70, v70
v_fma_f32 v78, v78, v70, v70
s_add_u32 m0, s40, 2048
s_add_u32 s38, s38, 57344
buffer_load_dwordx4 v4, s[12:15], s38 offen lds
v_fma_f32 v79, v79, v70, v70
v_rcp_f32 v72, v72
v_rcp_f32 v73, v73
v_rcp_f32 v74, v74
v_rcp_f32 v75, v75
v_rcp_f32 v76, v76
v_rcp_f32 v77, v77
s_add_u32 m0, s40, 3072
s_nop 0
buffer_load_dwordx4 v5, s[12:15], s38 offen lds
v_rcp_f32 v78, v78
v_rcp_f32 v79, v79
v_mul_f32 v144, v132, v144
v_mul_f32 v145, v133, v145
v_mul_f32 v146, v134, v146
v_mul_f32 v147, v135, v147
v_mul_f32 v168, v156, v168
v_mul_f32 v169, v157, v169
s_add_u32 m0, s40, 4096
s_add_u32 s38, s38, 57344
buffer_load_dwordx4 v4, s[12:15], s38 offen lds
v_mul_f32 v170, v158, v170
v_mul_f32 v171, v159, v171
v_mul_f32 v144, v144, v72
v_mul_f32 v145, v145, v73
v_mul_f32 v146, v146, v74
v_mul_f32 v147, v147, v75
v_mul_f32 v168, v168, v76
s_add_u32 m0, s40, 5120
s_nop 0
buffer_load_dwordx4 v5, s[12:15], s38 offen lds
v_mul_f32 v169, v169, v77
v_mul_f32 v170, v170, v78
v_mul_f32 v171, v171, v79
v_cvt_pk_bf16_f32 v130, v144, v145
v_cvt_pk_bf16_f32 v131, v146, v147
v_cvt_pk_bf16_f32 v154, v168, v169
v_cvt_pk_bf16_f32 v155, v170, v171
buffer_store_dwordx4 v[128:131], v2, s[24:27], s54 offen offset:0 sc1
s_add_u32 m0, s40, 6144
s_add_u32 s38, s38, 57344
buffer_load_dwordx4 v4, s[12:15], s38 offen lds
s_add_u32 m0, s40, 7168
s_nop 0
buffer_load_dwordx4 v5, s[12:15], s38 offen lds
s_waitcnt vmcnt(13)
s_barrier
s_add_u32 s37, s35, 6
s_and_b32 s37, s37, 15
s_mul_i32 s37, s37, 16384
s_add_u32 m0, s39, 49152
s_nop 0
buffer_load_dwordx4 v3, s[8:11], s37 offen sc1 lds
buffer_store_dwordx4 v[152:155], v2, s[24:27], s54 offen offset:1024 sc1
v_fma_f32 v136, -v56, v40, v136
v_fma_f32 v137, -v56, v41, v137
v_fma_f32 v138, -v56, v42, v138
v_fma_f32 v139, -v56, v43, v139
v_fma_f32 v160, -v58, v40, v160
buffer_load_dwordx4 v3, s[8:11], s37 offen offset:1024 sc1 lds
v_fma_f32 v161, -v58, v41, v161
v_fma_f32 v162, -v58, v42, v162
v_fma_f32 v163, -v58, v43, v163
v_mul_f32 v72, v136, v136
v_mul_f32 v73, v137, v137
v_mul_f32 v74, v138, v138
buffer_load_dwordx4 v3, s[8:11], s37 offen offset:2048 sc1 lds
v_mul_f32 v75, v139, v139
v_mul_f32 v76, v160, v160
v_mul_f32 v77, v161, v161
v_mul_f32 v78, v162, v162
v_mul_f32 v79, v163, v163
v_fma_f32 v72, v72, v65, v64
buffer_load_dwordx4 v3, s[8:11], s37 offen offset:3072 sc1 lds
v_fma_f32 v73, v73, v65, v64
v_fma_f32 v74, v74, v65, v64
v_fma_f32 v75, v75, v65, v64
v_fma_f32 v76, v76, v69, v68
v_fma_f32 v77, v77, v69, v68
v_fma_f32 v78, v78, v69, v68
s_add_u32 s38, s35, 6
s_and_b32 s38, s38, 15
s_mul_i32 s38, s38, 458752
s_add_u32 m0, s40, 49152
s_nop 0
buffer_load_dwordx4 v4, s[12:15], s38 offen lds
v_fma_f32 v79, v79, v69, v68
v_mul_f32 v72, v72, v136
v_mul_f32 v73, v73, v137
v_mul_f32 v74, v74, v138
v_mul_f32 v75, v75, v139
v_mul_f32 v76, v76, v160
s_add_u32 m0, s40, 50176
s_nop 0
buffer_load_dwordx4 v5, s[12:15], s38 offen lds
v_mul_f32 v77, v77, v161
v_mul_f32 v78, v78, v162
v_mul_f32 v79, v79, v163
v_exp_f32 v72, v72
v_exp_f32 v73, v73
v_exp_f32 v74, v74
s_add_u32 m0, s40, 51200
s_add_u32 s38, s38, 57344
buffer_load_dwordx4 v4, s[12:15], s38 offen lds
v_exp_f32 v75, v75
v_exp_f32 v76, v76
v_exp_f32 v77, v77
v_exp_f32 v78, v78
v_exp_f32 v79, v79
v_fma_f32 v148, -v56, v52, v148
s_add_u32 m0, s40, 52224
s_nop 0
buffer_load_dwordx4 v5, s[12:15], s38 offen lds
v_fma_f32 v149, -v56, v53, v149
v_fma_f32 v150, -v56, v54, v150
v_fma_f32 v151, -v56, v55, v151
v_fma_f32 v172, -v58, v52, v172
v_fma_f32 v173, -v58, v53, v173
v_fma_f32 v174, -v58, v54, v174
s_add_u32 m0, s40, 53248
s_add_u32 s38, s38, 57344
buffer_load_dwordx4 v4, s[12:15], s38 offen lds
v_fma_f32 v175, -v58, v55, v175
v_fma_f32 v72, v72, v66, v66
v_fma_f32 v73, v73, v66, v66
v_fma_f32 v74, v74, v66, v66
v_fma_f32 v75, v75, v66, v66
v_fma_f32 v76, v76, v70, v70
s_add_u32 m0, s40, 54272
s_nop 0
buffer_load_dwordx4 v5, s[12:15], s38 offen lds
v_fma_f32 v77, v77, v70, v70
v_fma_f32 v78, v78, v70, v70
v_fma_f32 v79, v79, v70, v70
v_rcp_f32 v72, v72
v_rcp_f32 v73, v73
v_rcp_f32 v74, v74
s_add_u32 m0, s40, 55296
s_add_u32 s38, s38, 57344
buffer_load_dwordx4 v4, s[12:15], s38 offen lds
s_add_u32 m0, s40, 56320
s_nop 0
buffer_load_dwordx4 v5, s[12:15], s38 offen lds
s_waitcnt vmcnt(13)
s_barrier
s_waitcnt lgkmcnt(0)
s_add_u32 s37, s35, 7
s_and_b32 s37, s37, 15
s_mul_i32 s37, s37, 16384
s_add_u32 m0, s39, 98304
s_nop 0
buffer_load_dwordx4 v3, s[8:11], s37 offen sc1 lds
s_load_dword s3, s[4:5], 3584
s_load_dword s3, s[4:5], 3648
s_load_dword s3, s[4:5], 3712
s_load_dword s3, s[4:5], 3776
s_load_dword s3, s[4:5], 3840
s_load_dword s3, s[4:5], 3904
s_load_dword s3, s[4:5], 3968
buffer_load_dwordx4 v3, s[8:11], s37 offen offset:1024 sc1 lds
s_load_dword s3, s[4:5], 4032
s_load_dword s3, s[4:5], 4096
s_load_dword s3, s[4:5], 4160
s_load_dword s3, s[4:5], 4224
s_load_dword s3, s[4:5], 4288
s_load_dword s3, s[4:5], 4352
s_load_dword s3, s[4:5], 4416
buffer_load_dwordx4 v3, s[8:11], s37 offen offset:2048 sc1 lds
v_rcp_f32 v75, v75
v_rcp_f32 v76, v76
v_rcp_f32 v77, v77
v_rcp_f32 v78, v78
v_rcp_f32 v79, v79
v_mul_f32 v148, v136, v148
v_mul_f32 v149, v137, v149
buffer_load_dwordx4 v3, s[8:11], s37 offen offset:3072 sc1 lds
v_mul_f32 v150, v138, v150
v_mul_f32 v151, v139, v151
v_mul_f32 v172, v160, v172
v_mul_f32 v173, v161, v173
v_mul_f32 v174, v162, v174
v_mul_f32 v175, v163, v175
v_mul_f32 v148, v148, v72
v_mul_f32 v149, v149, v73
s_add_u32 s38, s35, 7
s_and_b32 s38, s38, 15
s_mul_i32 s38, s38, 458752
s_add_u32 m0, s40, 98304
s_nop 0
buffer_load_dwordx4 v4, s[12:15], s38 offen lds
v_mul_f32 v150, v150, v74
v_mul_f32 v151, v151, v75
v_mul_f32 v172, v172, v76
v_mul_f32 v173, v173, v77
v_mul_f32 v174, v174, v78
v_mul_f32 v175, v175, v79
v_cvt_pk_bf16_f32 v80, v148, v149
s_add_u32 m0, s40, 99328
s_nop 0
buffer_load_dwordx4 v5, s[12:15], s38 offen lds
v_cvt_pk_bf16_f32 v81, v150, v151
v_cvt_pk_bf16_f32 v82, v172, v173
v_cvt_pk_bf16_f32 v83, v174, v175
s_nop 1
v_permlane32_swap_b32 v80, v82
v_permlane32_swap_b32 v81, v83
buffer_store_dwordx4 v[80:83], v84, s[24:27], s55 offen offset:0 sc1
s_add_u32 m0, s40, 100352
s_add_u32 s38, s38, 57344
buffer_load_dwordx4 v4, s[12:15], s38 offen lds
s_nop 1
v_mul_f32 v66, v61, v61
v_mul_f32 v64, 0xc0135761, v61
v_mul_f32 v65, 0xbdd2d3e8, v61
v_mul_f32 v65, v65, v66
v_rcp_f32 v66, v66
v_mul_f32 v70, v63, v63
v_mul_f32 v68, 0xc0135761, v63
s_add_u32 m0, s40, 101376
s_nop 0
buffer_load_dwordx4 v5, s[12:15], s38 offen lds
v_mul_f32 v69, 0xbdd2d3e8, v63
v_mul_f32 v69, v69, v70
v_rcp_f32 v70, v70
v_fma_f32 v176, -v60, v32, v176
v_fma_f32 v177, -v60, v33, v177
v_fma_f32 v178, -v60, v34, v178
v_fma_f32 v179, -v60, v35, v179
s_add_u32 m0, s40, 102400
s_add_u32 s38, s38, 57344
buffer_load_dwordx4 v4, s[12:15], s38 offen lds
v_fma_f32 v200, -v62, v32, v200
v_fma_f32 v201, -v62, v33, v201
v_fma_f32 v202, -v62, v34, v202
v_fma_f32 v203, -v62, v35, v203
v_mul_f32 v72, v176, v176
v_mul_f32 v73, v177, v177
v_mul_f32 v74, v178, v178
s_add_u32 m0, s40, 103424
s_nop 0
buffer_load_dwordx4 v5, s[12:15], s38 offen lds
v_mul_f32 v75, v179, v179
v_mul_f32 v76, v200, v200
v_mul_f32 v77, v201, v201
v_mul_f32 v78, v202, v202
v_mul_f32 v79, v203, v203
v_fma_f32 v72, v72, v65, v64
s_branch Lov_9
.p2align 12
Lst_9_0:
s_branch Lwr_148
Lst_9_1:
s_branch Lwr_159
s_nop 0
Lov_9:
v_fma_f32 v73, v73, v65, v64
v_fma_f32 v74, v74, v65, v64
s_add_u32 m0, s40, 104448
s_add_u32 s38, s38, 57344
buffer_load_dwordx4 v4, s[12:15], s38 offen lds
s_add_u32 m0, s40, 105472
s_nop 0
buffer_load_dwordx4 v5, s[12:15], s38 offen lds
s_waitcnt vmcnt(13)
s_barrier
s_add_u32 s37, s35, 8
s_and_b32 s37, s37, 15
s_mul_i32 s37, s37, 16384
s_add_u32 m0, s39, 0
s_nop 0
buffer_load_dwordx4 v3, s[8:11], s37 offen sc1 lds
v_fma_f32 v75, v75, v65, v64
v_fma_f32 v76, v76, v69, v68
v_fma_f32 v77, v77, v69, v68
v_fma_f32 v78, v78, v69, v68
v_fma_f32 v79, v79, v69, v68
v_mul_f32 v72, v72, v176
buffer_load_dwordx4 v3, s[8:11], s37 offen offset:1024 sc1 lds
v_mul_f32 v73, v73, v177
v_mul_f32 v74, v74, v178
v_mul_f32 v75, v75, v179
v_mul_f32 v76, v76, v200
v_mul_f32 v77, v77, v201
v_mul_f32 v78, v78, v202
buffer_load_dwordx4 v3, s[8:11], s37 offen offset:2048 sc1 lds
v_mul_f32 v79, v79, v203
v_exp_f32 v72, v72
v_exp_f32 v73, v73
v_exp_f32 v74, v74
v_exp_f32 v75, v75
v_exp_f32 v76, v76
buffer_load_dwordx4 v3, s[8:11], s37 offen offset:3072 sc1 lds
v_exp_f32 v77, v77
v_exp_f32 v78, v78
v_exp_f32 v79, v79
v_fma_f32 v188, -v60, v44, v188
v_fma_f32 v189, -v60, v45, v189
v_fma_f32 v190, -v60, v46, v190
s_add_u32 s38, s35, 8
s_and_b32 s38, s38, 15
s_mul_i32 s38, s38, 458752
s_add_u32 m0, s40, 0
s_nop 0
buffer_load_dwordx4 v4, s[12:15], s38 offen lds
v_fma_f32 v191, -v60, v47, v191
v_fma_f32 v212, -v62, v44, v212
v_fma_f32 v213, -v62, v45, v213
v_fma_f32 v214, -v62, v46, v214
v_fma_f32 v215, -v62, v47, v215
v_fma_f32 v72, v72, v66, v66
s_add_u32 m0, s40, 1024
s_nop 0
buffer_load_dwordx4 v5, s[12:15], s38 offen lds
v_fma_f32 v73, v73, v66, v66
v_fma_f32 v74, v74, v66, v66
v_fma_f32 v75, v75, v66, v66
v_fma_f32 v76, v76, v70, v70
v_fma_f32 v77, v77, v70, v70
v_fma_f32 v78, v78, v70, v70
s_add_u32 m0, s40, 2048
s_add_u32 s38, s38, 57344
buffer_load_dwordx4 v4, s[12:15], s38 offen lds
v_fma_f32 v79, v79, v70, v70
v_rcp_f32 v72, v72
v_rcp_f32 v73, v73
v_rcp_f32 v74, v74
v_rcp_f32 v75, v75
v_rcp_f32 v76, v76
s_add_u32 m0, s40, 3072
s_nop 0
buffer_load_dwordx4 v5, s[12:15], s38 offen lds
v_rcp_f32 v77, v77
v_rcp_f32 v78, v78
v_rcp_f32 v79, v79
v_mul_f32 v188, v176, v188
v_mul_f32 v189, v177, v189
v_mul_f32 v190, v178, v190
s_add_u32 m0, s40, 4096
s_add_u32 s38, s38, 57344
buffer_load_dwordx4 v4, s[12:15], s38 offen lds
v_mul_f32 v191, v179, v191
v_mul_f32 v212, v200, v212
v_mul_f32 v213, v201, v213
v_mul_f32 v214, v202, v214
v_mul_f32 v215, v203, v215
v_mul_f32 v188, v188, v72
s_add_u32 m0, s40, 5120
s_nop 0
buffer_load_dwordx4 v5, s[12:15], s38 offen lds
v_mul_f32 v189, v189, v73
v_mul_f32 v190, v190, v74
v_mul_f32 v191, v191, v75
v_mul_f32 v212, v212, v76
v_mul_f32 v213, v213, v77
v_mul_f32 v214, v214, v78
s_add_u32 m0, s40, 6144
s_add_u32 s38, s38, 57344
buffer_load_dwordx4 v4, s[12:15], s38 offen lds
s_add_u32 m0, s40, 7168
s_nop 0
buffer_load_dwordx4 v5, s[12:15], s38 offen lds
s_waitcnt vmcnt(12)
s_barrier
s_waitcnt lgkmcnt(0)
s_cmp_eq_u32 s47, 3
s_cbranch_scc0 Lw_104
s_lshl_b32 s92, s35, 7
s_add_u32 s92, s92, 28321792
s_load_dword s93, s[82:83], s92 glc
Lw_104:
s_add_u32 s37, s35, 9
s_and_b32 s37, s37, 15
s_mul_i32 s37, s37, 16384
s_add_u32 m0, s39, 49152
s_nop 0
buffer_load_dwordx4 v3, s[8:11], s37 offen sc1 lds
s_load_dword s3, s[4:5], 4480
s_load_dword s3, s[4:5], 4544
s_load_dword s3, s[4:5], 4608
s_load_dword s3, s[4:5], 4672
s_load_dword s3, s[4:5], 4736
s_load_dword s3, s[4:5], 4800
s_load_dword s3, s[4:5], 4864
buffer_load_dwordx4 v3, s[8:11], s37 offen offset:1024 sc1 lds
s_load_dword s3, s[4:5], 4928
s_load_dword s3, s[4:5], 4992
s_load_dword s3, s[4:5], 5056
s_load_dword s3, s[4:5], 5120
s_load_dword s3, s[4:5], 5184
s_load_dword s3, s[4:5], 5248
s_load_dword s3, s[4:5], 5312
buffer_load_dwordx4 v3, s[8:11], s37 offen offset:2048 sc1 lds
v_mul_f32 v215, v215, v79
v_cvt_pk_bf16_f32 v176, v188, v189
v_cvt_pk_bf16_f32 v177, v190, v191
v_cvt_pk_bf16_f32 v200, v212, v213
v_cvt_pk_bf16_f32 v201, v214, v215
v_fma_f32 v180, -v60, v36, v180
v_fma_f32 v181, -v60, v37, v181
v_fma_f32 v182, -v60, v38, v182
buffer_load_dwordx4 v3, s[8:11], s37 offen offset:3072 sc1 lds
v_fma_f32 v183, -v60, v39, v183
v_fma_f32 v204, -v62, v36, v204
v_fma_f32 v205, -v62, v37, v205
v_fma_f32 v206, -v62, v38, v206
v_fma_f32 v207, -v62, v39, v207
v_mul_f32 v72, v180, v180
v_mul_f32 v73, v181, v181
s_add_u32 s38, s35, 9
s_and_b32 s38, s38, 15
s_mul_i32 s38, s38, 458752
s_add_u32 m0, s40, 49152
s_nop 0
buffer_load_dwordx4 v4, s[12:15], s38 offen lds
v_mul_f32 v74, v182, v182
v_mul_f32 v75, v183, v183
v_mul_f32 v76, v204, v204
v_mul_f32 v77, v205, v205
v_mul_f32 v78, v206, v206
v_mul_f32 v79, v207, v207
v_fma_f32 v72, v72, v65, v64
v_fma_f32 v73, v73, v65, v64
s_add_u32 m0, s40, 50176
s_nop 0
buffer_load_dwordx4 v5, s[12:15], s38 offen lds
v_fma_f32 v74, v74, v65, v64
v_fma_f32 v75, v75, v65, v64
v_fma_f32 v76, v76, v69, v68
v_fma_f32 v77, v77, v69, v68
v_fma_f32 v78, v78, v69, v68
v_fma_f32 v79, v79, v69, v68
v_mul_f32 v72, v72, v180
s_add_u32 m0, s40, 51200
s_add_u32 s38, s38, 57344
buffer_load_dwordx4 v4, s[12:15], s38 offen lds
v_mul_f32 v73, v73, v181
v_mul_f32 v74, v74, v182
v_mul_f32 v75, v75, v183
v_mul_f32 v76, v76, v204
v_mul_f32 v77, v77, v205
v_mul_f32 v78, v78, v206
v_mul_f32 v79, v79, v207
s_add_u32 m0, s40, 52224
s_nop 0
buffer_load_dwordx4 v5, s[12:15], s38 offen lds
v_exp_f32 v72, v72
v_exp_f32 v73, v73
v_exp_f32 v74, v74
v_exp_f32 v75, v75
v_exp_f32 v76, v76
v_exp_f32 v77, v77
v_exp_f32 v78, v78
v_exp_f32 v79, v79
s_add_u32 m0, s40, 53248
s_add_u32 s38, s38, 57344
buffer_load_dwordx4 v4, s[12:15], s38 offen lds
v_fma_f32 v192, -v60, v48, v192
v_fma_f32 v193, -v60, v49, v193
v_fma_f32 v194, -v60, v50, v194
v_fma_f32 v195, -v60, v51, v195
v_fma_f32 v216, -v62, v48, v216
v_fma_f32 v217, -v62, v49, v217
v_fma_f32 v218, -v62, v50, v218
s_add_u32 m0, s40, 54272
s_nop 0
buffer_load_dwordx4 v5, s[12:15], s38 offen lds
v_fma_f32 v219, -v62, v51, v219
v_fma_f32 v72, v72, v66, v66
v_fma_f32 v73, v73, v66, v66
v_fma_f32 v74, v74, v66, v66
v_fma_f32 v75, v75, v66, v66
v_fma_f32 v76, v76, v70, v70
v_fma_f32 v77, v77, v70, v70
v_fma_f32 v78, v78, v70, v70
s_add_u32 m0, s40, 55296
s_add_u32 s38, s38, 57344
buffer_load_dwordx4 v4, s[12:15], s38 offen lds
s_add_u32 m0, s40, 56320
s_nop 0
buffer_load_dwordx4 v5, s[12:15], s38 offen lds
s_waitcnt vmcnt(12)
s_barrier
s_add_u32 s37, s35, 10
s_and_b32 s37, s37, 15
s_mul_i32 s37, s37, 16384
s_add_u32 m0, s39, 98304
s_nop 0
buffer_load_dwordx4 v3, s[8:11], s37 offen sc1 lds
v_fma_f32 v79, v79, v70, v70
v_rcp_f32 v72, v72
v_rcp_f32 v73, v73
v_rcp_f32 v74, v74
v_rcp_f32 v75, v75
v_rcp_f32 v76, v76
buffer_load_dwordx4 v3, s[8:11], s37 offen offset:1024 sc1 lds
v_rcp_f32 v77, v77
v_rcp_f32 v78, v78
v_rcp_f32 v79, v79
v_mul_f32 v192, v180, v192
v_mul_f32 v193, v181, v193
v_mul_f32 v194, v182, v194
buffer_load_dwordx4 v3, s[8:11], s37 offen offset:2048 sc1 lds
v_mul_f32 v195, v183, v195
v_mul_f32 v216, v204, v216
v_mul_f32 v217, v205, v217
v_mul_f32 v218, v206, v218
v_mul_f32 v219, v207, v219
v_mul_f32 v192, v192, v72
buffer_load_dwordx4 v3, s[8:11], s37 offen offset:3072 sc1 lds
v_mul_f32 v193, v193, v73
v_mul_f32 v194, v194, v74
v_mul_f32 v195, v195, v75
v_mul_f32 v216, v216, v76
v_mul_f32 v217, v217, v77
v_mul_f32 v218, v218, v78
s_add_u32 s38, s35, 10
s_and_b32 s38, s38, 15
s_mul_i32 s38, s38, 458752
s_add_u32 m0, s40, 98304
s_nop 0
buffer_load_dwordx4 v4, s[12:15], s38 offen lds
v_mul_f32 v219, v219, v79
v_cvt_pk_bf16_f32 v178, v192, v193
v_cvt_pk_bf16_f32 v179, v194, v195
v_cvt_pk_bf16_f32 v202, v216, v217
v_cvt_pk_bf16_f32 v203, v218, v219
buffer_store_dwordx4 v[176:179], v2, s[24:27], s54 offen offset:2048 sc1
s_add_u32 m0, s40, 99328
s_nop 0
buffer_load_dwordx4 v5, s[12:15], s38 offen lds
buffer_store_dwordx4 v[200:203], v2, s[24:27], s54 offen offset:3072 sc1
v_fma_f32 v184, -v60, v40, v184
v_fma_f32 v185, -v60, v41, v185
v_fma_f32 v186, -v60, v42, v186
v_fma_f32 v187, -v60, v43, v187
v_fma_f32 v208, -v62, v40, v208
s_add_u32 m0, s40, 100352
s_add_u32 s38, s38, 57344
buffer_load_dwordx4 v4, s[12:15], s38 offen lds
v_fma_f32 v209, -v62, v41, v209
v_fma_f32 v210, -v62, v42, v210
v_fma_f32 v211, -v62, v43, v211
v_mul_f32 v72, v184, v184
v_mul_f32 v73, v185, v185
v_mul_f32 v74, v186, v186
s_add_u32 m0, s40, 101376
s_nop 0
buffer_load_dwordx4 v5, s[12:15], s38 offen lds
v_mul_f32 v75, v187, v187
v_mul_f32 v76, v208, v208
v_mul_f32 v77, v209, v209
v_mul_f32 v78, v210, v210
v_mul_f32 v79, v211, v211
v_fma_f32 v72, v72, v65, v64
s_add_u32 m0, s40, 102400
s_add_u32 s38, s38, 57344
buffer_load_dwordx4 v4, s[12:15], s38 offen lds
v_fma_f32 v73, v73, v65, v64
v_fma_f32 v74, v74, v65, v64
v_fma_f32 v75, v75, v65, v64
v_fma_f32 v76, v76, v69, v68
v_fma_f32 v77, v77, v69, v68
v_fma_f32 v78, v78, v69, v68
s_add_u32 m0, s40, 103424
s_nop 0
buffer_load_dwordx4 v5, s[12:15], s38 offen lds
v_fma_f32 v79, v79, v69, v68
v_mul_f32 v72, v72, v184
v_mul_f32 v73, v73, v185
v_mul_f32 v74, v74, v186
v_mul_f32 v75, v75, v187
v_mul_f32 v76, v76, v208
s_add_u32 m0, s40, 104448
s_add_u32 s38, s38, 57344
buffer_load_dwordx4 v4, s[12:15], s38 offen lds
s_add_u32 m0, s40, 105472
s_nop 0
buffer_load_dwordx4 v5, s[12:15], s38 offen lds
s_waitcnt vmcnt(14)
s_cmp_eq_u32 s47, 3
s_cbranch_scc0 Lw_105
s_mov_b32 s41, 0x40000
s_branch Lpchk_108
Lpoll_106:
s_load_dword s93, s[82:83], s92 glc
Lpchk_108:
s_waitcnt lgkmcnt(0)
s_cmp_eq_u32 s93, 16
s_cbranch_scc1 Lpok_107
s_sub_u32 s41, s41, 1
s_cmp_lg_u32 s41, 0
s_cbranch_scc1 Lpoll_106
Lpok_107:
Lw_105:
s_barrier
s_lshl_b32 s60, s35, 9
s_lshl_b32 s43, s47, 7
s_add_u32 s60, s60, s43
s_add_u32 s61, s60, 14336
s_add_u32 s52, s43, 148480
s_add_u32 s53, s52, 896
v_lshrrev_b32 v104, 3, v1
v_mul_u32_u24 v104, 28672, v104
v_and_b32 v105, 7, v1
v_lshl_add_u32 v104, v105, 4, v104
s_waitcnt lgkmcnt(0)
buffer_load_dwordx4 v[96:99], v104, s[84:87], s60 offen sc1
s_load_dword s3, s[4:5], 5376
s_load_dword s3, s[4:5], 5440
s_load_dword s3, s[4:5], 5504
s_load_dword s3, s[4:5], 5568
s_load_dword s3, s[4:5], 5632
s_load_dword s3, s[4:5], 5696
buffer_load_dwordx4 v[100:103], v104, s[84:87], s61 offen sc1
s_load_dword s3, s[4:5], 5760
s_load_dword s3, s[4:5], 5824
s_load_dword s3, s[4:5], 5888
s_load_dword s3, s[4:5], 5952
s_load_dword s3, s[4:5], 6016
s_load_dword s3, s[4:5], 6080
s_load_dword s3, s[4:5], 6144
s_add_u32 s37, s35, 11
s_and_b32 s37, s37, 15
s_mul_i32 s37, s37, 16384
s_add_u32 m0, s39, 0
s_nop 0
buffer_load_dwordx4 v3, s[8:11], s37 offen sc1 lds
s_load_dword s3, s[4:5], 6208
v_mul_f32 v77, v77, v209
v_mul_f32 v78, v78, v210
v_mul_f32 v79, v79, v211
v_exp_f32 v72, v72
v_exp_f32 v73, v73
v_exp_f32 v74, v74
buffer_load_dwordx4 v3, s[8:11], s37 offen offset:1024 sc1 lds
v_exp_f32 v75, v75
v_exp_f32 v76, v76
v_exp_f32 v77, v77
v_exp_f32 v78, v78
v_exp_f32 v79, v79
v_fma_f32 v196, -v60, v52, v196
v_fma_f32 v197, -v60, v53, v197
buffer_load_dwordx4 v3, s[8:11], s37 offen offset:2048 sc1 lds
v_fma_f32 v198, -v60, v54, v198
v_fma_f32 v199, -v60, v55, v199
v_fma_f32 v220, -v62, v52, v220
v_fma_f32 v221, -v62, v53, v221
v_fma_f32 v222, -v62, v54, v222
v_fma_f32 v223, -v62, v55, v223
buffer_load_dwordx4 v3, s[8:11], s37 offen offset:3072 sc1 lds
v_fma_f32 v72, v72, v66, v66
v_fma_f32 v73, v73, v66, v66
v_fma_f32 v74, v74, v66, v66
v_fma_f32 v75, v75, v66, v66
v_fma_f32 v76, v76, v70, v70
v_fma_f32 v77, v77, v70, v70
v_fma_f32 v78, v78, v70, v70
s_add_u32 s38, s35, 11
s_and_b32 s38, s38, 15
s_mul_i32 s38, s38, 458752
s_add_u32 m0, s40, 0
s_nop 0
buffer_load_dwordx4 v4, s[12:15], s38 offen lds
v_fma_f32 v79, v79, v70, v70
v_rcp_f32 v72, v72
v_rcp_f32 v73, v73
v_rcp_f32 v74, v74
v_rcp_f32 v75, v75
v_rcp_f32 v76, v76
v_rcp_f32 v77, v77
s_add_u32 m0, s40, 1024
s_nop 0
buffer_load_dwordx4 v5, s[12:15], s38 offen lds
v_rcp_f32 v78, v78
v_rcp_f32 v79, v79
v_mul_f32 v196, v184, v196
v_mul_f32 v197, v185, v197
v_mul_f32 v198, v186, v198
v_mul_f32 v199, v187, v199
v_mul_f32 v220, v208, v220
s_add_u32 m0, s40, 2048
s_add_u32 s38, s38, 57344
buffer_load_dwordx4 v4, s[12:15], s38 offen lds
v_mul_f32 v221, v209, v221
v_mul_f32 v222, v210, v222
v_mul_f32 v223, v211, v223
v_mul_f32 v196, v196, v72
v_mul_f32 v197, v197, v73
v_mul_f32 v198, v198, v74
s_add_u32 m0, s40, 3072
s_nop 0
buffer_load_dwordx4 v5, s[12:15], s38 offen lds
v_mul_f32 v199, v199, v75
v_mul_f32 v220, v220, v76
v_mul_f32 v221, v221, v77
v_mul_f32 v222, v222, v78
v_mul_f32 v223, v223, v79
v_cvt_pk_bf16_f32 v80, v196, v197
v_cvt_pk_bf16_f32 v81, v198, v199
s_add_u32 m0, s40, 4096
s_add_u32 s38, s38, 57344
buffer_load_dwordx4 v4, s[12:15], s38 offen lds
v_cvt_pk_bf16_f32 v82, v220, v221
v_cvt_pk_bf16_f32 v83, v222, v223
s_nop 1
v_permlane32_swap_b32 v80, v82
v_permlane32_swap_b32 v81, v83
buffer_store_dwordx4 v[80:83], v84, s[24:27], s55 offen offset:2048 sc1
s_nop 1
s_add_u32 m0, s40, 5120
s_nop 0
buffer_load_dwordx4 v5, s[12:15], s38 offen lds
v_cmp_gt_u32 vcc, 32, v1
v_mov_b32 v104, s52
v_mov_b32 v106, s53
v_cndmask_b32 v104, v106, v104, vcc
v_lshl_add_u32 v104, v105, 4, v104
v_bfe_u32 v105, v1, 4, 1
v_lshl_add_u32 v104, v105, 2, v104
s_add_u32 m0, s40, 6144
s_add_u32 s38, s38, 57344
buffer_load_dwordx4 v4, s[12:15], s38 offen lds
s_add_u32 m0, s40, 7168
s_nop 0
buffer_load_dwordx4 v5, s[12:15], s38 offen lds
s_waitcnt vmcnt(15)
s_barrier
s_add_u32 s37, s35, 12
s_and_b32 s37, s37, 15
s_mul_i32 s37, s37, 16384
s_add_u32 m0, s39, 49152
s_nop 0
buffer_load_dwordx4 v3, s[8:11], s37 offen sc1 lds
buffer_load_dwordx4 v3, s[8:11], s37 offen offset:1024 sc1 lds
buffer_load_dwordx4 v3, s[8:11], s37 offen offset:2048 sc1 lds
buffer_load_dwordx4 v3, s[8:11], s37 offen offset:3072 sc1 lds
s_add_u32 s38, s35, 12
s_and_b32 s38, s38, 15
s_mul_i32 s38, s38, 458752
s_add_u32 m0, s40, 49152
s_nop 0
buffer_load_dwordx4 v4, s[12:15], s38 offen lds
s_add_u32 m0, s40, 50176
s_nop 0
buffer_load_dwordx4 v5, s[12:15], s38 offen lds
s_add_u32 m0, s40, 51200
s_add_u32 s38, s38, 57344
buffer_load_dwordx4 v4, s[12:15], s38 offen lds
s_add_u32 m0, s40, 52224
s_nop 0
buffer_load_dwordx4 v5, s[12:15], s38 offen lds
s_add_u32 m0, s40, 53248
s_add_u32 s38, s38, 57344
buffer_load_dwordx4 v4, s[12:15], s38 offen lds
s_add_u32 m0, s40, 54272
s_nop 0
buffer_load_dwordx4 v5, s[12:15], s38 offen lds
s_add_u32 m0, s40, 55296
s_add_u32 s38, s38, 57344
buffer_load_dwordx4 v4, s[12:15], s38 offen lds
s_add_u32 m0, s40, 56320
s_nop 0
buffer_load_dwordx4 v5, s[12:15], s38 offen lds
s_waitcnt vmcnt(12)
s_barrier
s_cmp_eq_u32 s47, 0
s_cbranch_scc0 Lw_109
s_add_u32 s7, s34, 32
s_lshl_b32 s7, s7, 7
v_mov_b32 v28, s7
v_mov_b32 v29, 1
s_mov_b64 exec, 1
buffer_atomic_add v29, v28, s[56:59], 0 offen sc1
s_mov_b64 exec, -1
Lw_109:
v_permlane32_swap_b32 v96, v100
v_permlane32_swap_b32 v97, v101
v_permlane32_swap_b32 v98, v102
v_permlane32_swap_b32 v99, v103
v_add_f32 v96, v96, v100
v_add_f32 v97, v97, v101
v_add_f32 v98, v98, v102
v_add_f32 v99, v99, v103
s_nop 1
v_permlane16_swap_b32 v96, v97
v_permlane16_swap_b32 v98, v99
v_add_f32 v96, v96, v97
v_add_f32 v98, v98, v99
s_nop 1
v_add_f32_dpp v96, v96, v96 row_ror:8 row_mask:0xf bank_mask:0xf
v_add_f32_dpp v98, v98, v98 row_ror:8 row_mask:0xf bank_mask:0xf
ds_write_b32 v104, v96
ds_write_b32 v104, v98 offset:8
s_waitcnt lgkmcnt(0)
s_add_u32 s37, s35, 13
s_and_b32 s37, s37, 15
s_mul_i32 s37, s37, 16384
s_add_u32 m0, s39, 98304
s_nop 0
buffer_load_dwordx4 v3, s[8:11], s37 offen sc1 lds
s_load_dword s3, s[4:5], 6272
s_load_dword s3, s[4:5], 6336
s_load_dword s3, s[4:5], 6400
s_load_dword s3, s[4:5], 6464
s_load_dword s3, s[4:5], 6528
s_load_dword s3, s[4:5], 6592
buffer_load_dwordx4 v3, s[8:11], s37 offen offset:1024 sc1 lds
s_load_dword s3, s[4:5], 6656
s_load_dword s3, s[4:5], 6720
s_load_dword s3, s[4:5], 6784
s_load_dword s3, s[4:5], 6848
s_load_dword s3, s[4:5], 6912
s_load_dword s3, s[4:5], 6976
buffer_load_dwordx4 v3, s[8:11], s37 offen offset:2048 sc1 lds
s_load_dword s3, s[4:5], 7040
s_load_dword s3, s[4:5], 7104
s_bfe_u32 s61, s35, 0x10002
s_lshr_b32 s60, s35, 3
s_lshl_b32 s60, s60, 2
s_and_b32 s43, s35, 3
buffer_load_dwordx4 v3, s[8:11], s37 offen offset:3072 sc1 lds
s_add_u32 s60, s60, s43
s_lshl_b32 s43, s60, 8
s_add_u32 s28, s76, s43
s_addc_u32 s29, s77, 0
s_mov_b32 s30, 7338240
s_mov_b32 s31, 0x20000
s_mul_i32 s52, s61, 196608
s_add_u32 s38, s35, 13
s_and_b32 s38, s38, 15
s_mul_i32 s38, s38, 458752
s_add_u32 m0, s40, 98304
s_nop 0
buffer_load_dwordx4 v4, s[12:15], s38 offen lds
s_mul_i32 s53, s61, 1572864
s_mul_i32 s90, s61, 163840
s_mul_i32 s91, s61, 1310720
s_lshl_b32 s51, s47, 11
s_lshl_b32 s44, s47, 15
v_lshrrev_b32 v122, 4, v1
s_add_u32 m0, s40, 99328
s_nop 0
buffer_load_dwordx4 v5, s[12:15], s38 offen lds
v_lshlrev_b32 v123, 1, v122
v_and_b32 v23, 15, v1
v_xor_b32 v23, v23, v123
v_lshlrev_b32 v23, 4, v23
v_mul_u32_u24 v122, 2048, v122
v_add_u32 v23, v23, v122
s_add_u32 m0, s40, 100352
s_add_u32 s38, s38, 57344
buffer_load_dwordx4 v4, s[12:15], s38 offen lds
v_add_u32 v23, s44, v23
v_xor_b32 v24, 128, v23
v_add_u32 v24, 8192, v24
s_lshl_b32 s43, s60, 2
s_lshl_b32 s44, s61, 1
s_add_u32 s43, s43, s44
s_add_u32 s43, s43, s63
s_add_u32 m0, s40, 101376
s_nop 0
buffer_load_dwordx4 v5, s[12:15], s38 offen lds
s_lshl_b32 s43, s43, 13
s_lshl_b32 s44, s62, 12
s_add_u32 s50, s43, s44
v_add_u32 v6, s44, v2
v_add_u32 v7, 0x10000, v6
v_add_u32 v8, 0x20000, v6
s_add_u32 m0, s40, 102400
s_add_u32 s38, s38, 57344
buffer_load_dwordx4 v4, s[12:15], s38 offen lds
v_lshrrev_b32 v122, 2, v1
v_and_b32 v123, 7, v122
v_mul_u32_u24 v122, 256, v122
v_lshl_add_u32 v122, v123, 5, v122
v_and_b32 v123, 3, v1
v_lshl_add_u32 v9, v123, 3, v122
s_add_u32 m0, s40, 103424
s_nop 0
buffer_load_dwordx4 v5, s[12:15], s38 offen lds
s_lshl_b32 s43, s61, 7
s_lshl_b32 s44, s63, 6
s_add_u32 s43, s43, s44
v_xor_b32 v9, s43, v9
v_xor_b32 v10, 32, v9
v_xor_b32 v11, 128, v9
v_xor_b32 v12, 128, v10
s_add_u32 m0, s40, 104448
s_add_u32 s38, s38, 57344
buffer_load_dwordx4 v4, s[12:15], s38 offen lds
s_add_u32 m0, s40, 105472
s_nop 0
buffer_load_dwordx4 v5, s[12:15], s38 offen lds
s_waitcnt vmcnt(12)
s_barrier
buffer_load_dwordx4 v[160:163], v2, s[8:11], s50 offen offset:0 sc1
v_add_u32 v13, 65536, v9
v_add_u32 v14, 65536, v10
v_add_u32 v15, 65536, v11
buffer_load_dwordx4 v[164:167], v2, s[8:11], s50 offen offset:1024 sc1
v_add_u32 v16, 65536, v12
v_add_u32 v25, 131072, v9
v_add_u32 v26, 131072, v10
v_add_u32 v27, 131072, v11
buffer_load_dwordx4 v[168:171], v2, s[8:11], s50 offen offset:2048 sc1
v_add_u32 v28, 131072, v12
v_lshrrev_b32 v122, 2, v1
v_bfe_u32 v123, v122, 1, 2
buffer_load_dwordx4 v[172:175], v2, s[8:11], s50 offen offset:3072 sc1
v_mul_u32_u24 v122, 128, v122
v_lshl_add_u32 v122, v123, 5, v122
v_and_b32 v123, 3, v1
v_lshl_add_u32 v224, v123, 3, v122
s_add_u32 s37, s35, 14
s_and_b32 s37, s37, 15
s_mul_i32 s37, s37, 16384
s_add_u32 m0, s39, 0
s_nop 0
buffer_load_dwordx4 v3, s[8:11], s37 offen sc1 lds
v_xor_b32 v224, s44, v224
v_xor_b32 v225, 32, v224
v_add_u32 v226, 65536, v224
buffer_load_dwordx4 v3, s[8:11], s37 offen offset:1024 sc1 lds
s_branch Lov_10
.p2align 12
Lst_10_0:
s_branch Lwr_149
Lst_10_1:
s_branch Lwr_160
s_nop 0
Lov_10:
v_add_u32 v227, 65536, v225
v_add_u32 v228, 131072, v224
v_add_u32 v229, 131072, v225
s_add_u32 s84, s82, 33554432
buffer_load_dwordx4 v3, s[8:11], s37 offen offset:2048 sc1 lds
s_addc_u32 s85, s83, 0
s_mov_b32 s86, 4194304
s_mov_b32 s87, 0x20000
s_xor_b32 s43, s2, 2
buffer_load_dwordx4 v3, s[8:11], s37 offen offset:3072 sc1 lds
s_lshl_b32 s44, s43, 2
s_add_u32 s44, s44, s47
s_lshl_b32 s45, s44, 12
s_add_u32 s38, s35, 14
s_and_b32 s38, s38, 15
s_mul_i32 s38, s38, 458752
s_add_u32 m0, s40, 0
s_nop 0
buffer_load_dwordx4 v4, s[12:15], s38 offen lds
s_lshl_b32 s46, s2, 2
s_add_u32 s46, s46, s47
s_lshl_b32 s46, s46, 12
s_lshl_b32 s43, s34, 18
s_add_u32 m0, s40, 1024
s_nop 0
buffer_load_dwordx4 v5, s[12:15], s38 offen lds
s_lshl_b32 s42, s60, 8
s_add_u32 s43, s43, s42
s_lshl_b32 s42, s61, 7
s_add_u32 m0, s40, 2048
s_add_u32 s38, s38, 57344
buffer_load_dwordx4 v4, s[12:15], s38 offen lds
s_add_u32 s43, s43, s42
s_lshl_b32 s42, s63, 6
s_add_u32 s43, s43, s42
s_add_u32 s20, s78, s43
s_add_u32 m0, s40, 3072
s_nop 0
buffer_load_dwordx4 v5, s[12:15], s38 offen lds
s_addc_u32 s21, s79, 0
s_mov_b32 s22, 260160
s_mov_b32 s23, 0x20000
s_add_u32 m0, s40, 4096
s_add_u32 s38, s38, 57344
buffer_load_dwordx4 v4, s[12:15], s38 offen lds
v_and_b32 v230, 15, v1
v_lshlrev_b32 v230, 12, v230
v_bfe_u32 v231, v1, 4, 1
v_lshl_add_u32 v230, v231, 5, v230
s_add_u32 m0, s40, 5120
s_nop 0
buffer_load_dwordx4 v5, s[12:15], s38 offen lds
v_bfe_u32 v231, v1, 5, 1
v_lshl_add_u32 v230, v231, 4, v230
s_lshl_b32 s54, s62, 17
s_add_u32 s55, s54, 65536
s_add_u32 m0, s40, 6144
s_add_u32 s38, s38, 57344
buffer_load_dwordx4 v4, s[12:15], s38 offen lds
s_add_u32 m0, s40, 7168
s_nop 0
buffer_load_dwordx4 v5, s[12:15], s38 offen lds
s_waitcnt vmcnt(16)
s_barrier
s_cmp_eq_u32 s47, 3
s_cbranch_scc0 Lw_110
s_lshl_b32 s92, s34, 7
s_add_u32 s92, s92, 28315648
s_load_dword s93, s[82:83], s92 glc
Lw_110:
s_add_u32 s37, s35, 15
s_and_b32 s37, s37, 15
s_mul_i32 s37, s37, 16384
s_add_u32 m0, s39, 49152
s_nop 0
buffer_load_dwordx4 v3, s[8:11], s37 offen sc1 lds
buffer_load_dwordx4 v3, s[8:11], s37 offen offset:1024 sc1 lds
buffer_load_dwordx4 v3, s[8:11], s37 offen offset:2048 sc1 lds
buffer_load_dwordx4 v3, s[8:11], s37 offen offset:3072 sc1 lds
s_add_u32 s38, s35, 15
s_and_b32 s38, s38, 15
s_mul_i32 s38, s38, 458752
s_add_u32 m0, s40, 49152
s_nop 0
buffer_load_dwordx4 v4, s[12:15], s38 offen lds
s_add_u32 m0, s40, 50176
s_nop 0
buffer_load_dwordx4 v5, s[12:15], s38 offen lds
s_add_u32 m0, s40, 51200
s_add_u32 s38, s38, 57344
buffer_load_dwordx4 v4, s[12:15], s38 offen lds
s_add_u32 m0, s40, 52224
s_nop 0
buffer_load_dwordx4 v5, s[12:15], s38 offen lds
s_add_u32 m0, s40, 53248
s_add_u32 s38, s38, 57344
buffer_load_dwordx4 v4, s[12:15], s38 offen lds
s_add_u32 m0, s40, 54272
s_nop 0
buffer_load_dwordx4 v5, s[12:15], s38 offen lds
s_add_u32 m0, s40, 55296
s_add_u32 s38, s38, 57344
buffer_load_dwordx4 v4, s[12:15], s38 offen lds
s_add_u32 m0, s40, 56320
s_nop 0
buffer_load_dwordx4 v5, s[12:15], s38 offen lds
s_waitcnt vmcnt(12)
s_cmp_eq_u32 s47, 3
s_cbranch_scc0 Lw_111
s_mov_b32 s41, 0x40000
s_branch Lpchk_114
Lpoll_112:
s_load_dword s93, s[82:83], s92 glc
Lpchk_114:
s_waitcnt lgkmcnt(0)
s_cmp_eq_u32 s93, 16
s_cbranch_scc1 Lpok_113
s_sub_u32 s41, s41, 1
s_cmp_lg_u32 s41, 0
s_cbranch_scc1 Lpoll_112
Lpok_113:
Lw_111:
s_barrier
s_add_u32 m0, s39, 98304
s_add_u32 s37, s52, 524288
buffer_load_dwordx4 v3, s[24:27], s37 offen sc1 lds
v_lshlrev_b32 v128, 16, v160
v_and_b32 v129, 0xffff0000, v160
v_lshlrev_b32 v130, 16, v161
v_and_b32 v131, 0xffff0000, v161
v_lshlrev_b32 v132, 16, v162
buffer_load_dwordx4 v3, s[24:27], s37 offen offset:1024 sc1 lds
v_and_b32 v133, 0xffff0000, v162
v_lshlrev_b32 v134, 16, v163
v_and_b32 v135, 0xffff0000, v163
v_lshlrev_b32 v136, 16, v164
v_and_b32 v137, 0xffff0000, v164
buffer_load_dwordx4 v3, s[24:27], s37 offen offset:2048 sc1 lds
v_lshlrev_b32 v138, 16, v165
v_and_b32 v139, 0xffff0000, v165
v_lshlrev_b32 v140, 16, v166
v_and_b32 v141, 0xffff0000, v166
v_lshlrev_b32 v142, 16, v167
v_and_b32 v143, 0xffff0000, v167
buffer_load_dwordx4 v3, s[24:27], s37 offen offset:3072 sc1 lds
v_lshlrev_b32 v144, 16, v168
v_and_b32 v145, 0xffff0000, v168
v_lshlrev_b32 v146, 16, v169
v_and_b32 v147, 0xffff0000, v169
v_lshlrev_b32 v148, 16, v170
s_add_u32 m0, s39, 114688
s_add_u32 s38, s53, 4194304
buffer_load_dwordx4 v23, s[28:31], s38 offen lds
v_and_b32 v149, 0xffff0000, v170
v_lshlrev_b32 v150, 16, v171
v_and_b32 v151, 0xffff0000, v171
v_lshlrev_b32 v152, 16, v172
v_and_b32 v153, 0xffff0000, v172
s_add_u32 m0, s39, 115712
s_add_u32 s38, s53, 4194304
buffer_load_dwordx4 v24, s[28:31], s38 offen lds
v_lshlrev_b32 v154, 16, v173
v_and_b32 v155, 0xffff0000, v173
v_lshlrev_b32 v156, 16, v174
v_and_b32 v157, 0xffff0000, v174
v_lshlrev_b32 v158, 16, v175
v_and_b32 v159, 0xffff0000, v175
s_add_u32 m0, s39, 116736
s_add_u32 s38, s53, 4210688
buffer_load_dwordx4 v23, s[28:31], s38 offen lds
s_add_u32 m0, s39, 117760
s_add_u32 s38, s53, 4210688
buffer_load_dwordx4 v24, s[28:31], s38 offen lds
s_waitcnt vmcnt(8)
s_barrier
s_add_u32 m0, s39, 131072
s_add_u32 s37, s52, 540672
buffer_load_dwordx4 v3, s[24:27], s37 offen sc1 lds
buffer_load_dwordx4 v3, s[24:27], s37 offen offset:1024 sc1 lds
buffer_load_dwordx4 v3, s[24:27], s37 offen offset:2048 sc1 lds
buffer_load_dwordx4 v3, s[24:27], s37 offen offset:3072 sc1 lds
s_add_u32 m0, s39, 0
s_add_u32 s38, s53, 4325376
buffer_load_dwordx4 v23, s[28:31], s38 offen lds
s_add_u32 m0, s39, 1024
s_add_u32 s38, s53, 4325376
buffer_load_dwordx4 v24, s[28:31], s38 offen lds
s_add_u32 m0, s39, 2048
s_add_u32 s38, s53, 4341760
buffer_load_dwordx4 v23, s[28:31], s38 offen lds
s_add_u32 m0, s39, 3072
s_add_u32 s38, s53, 4341760
buffer_load_dwordx4 v24, s[28:31], s38 offen lds
s_add_u32 m0, s39, 16384
s_add_u32 s37, s52, 557056
buffer_load_dwordx4 v3, s[24:27], s37 offen sc1 lds
buffer_load_dwordx4 v3, s[24:27], s37 offen offset:1024 sc1 lds
buffer_load_dwordx4 v3, s[24:27], s37 offen offset:2048 sc1 lds
buffer_load_dwordx4 v3, s[24:27], s37 offen offset:3072 sc1 lds
s_add_u32 m0, s39, 32768
s_add_u32 s38, s53, 4456448
buffer_load_dwordx4 v23, s[28:31], s38 offen lds
s_add_u32 m0, s39, 33792
s_add_u32 s38, s53, 4456448
buffer_load_dwordx4 v24, s[28:31], s38 offen lds
s_add_u32 m0, s39, 34816
s_add_u32 s38, s53, 4472832
buffer_load_dwordx4 v23, s[28:31], s38 offen lds
s_add_u32 m0, s39, 35840
s_add_u32 s38, s53, 4472832
buffer_load_dwordx4 v24, s[28:31], s38 offen lds
s_waitcnt vmcnt(16)
s_barrier
ds_read_b128 v[32:35], v7 offset:32768
ds_read_b64_tr_b16 v[48:49], v13 offset:49152
ds_read_b64_tr_b16 v[50:51], v13 offset:53248
ds_read_b64_tr_b16 v[52:53], v14 offset:49152
ds_read_b64_tr_b16 v[54:55], v14 offset:53248
ds_read_b64_tr_b16 v[56:57], v15 offset:49152
ds_read_b64_tr_b16 v[58:59], v15 offset:53248
ds_read_b64_tr_b16 v[60:61], v16 offset:49152
ds_read_b64_tr_b16 v[62:63], v16 offset:53248
ds_read_b128 v[36:39], v7 offset:33792
ds_read_b128 v[40:43], v7 offset:34816
ds_read_b128 v[44:47], v7 offset:35840
ds_read_b128 v[64:67], v7 offset:40960
ds_read_b64_tr_b16 v[80:81], v13 offset:57344
ds_read_b64_tr_b16 v[82:83], v13 offset:61440
ds_read_b64_tr_b16 v[84:85], v14 offset:57344
ds_read_b64_tr_b16 v[86:87], v14 offset:61440
ds_read_b64_tr_b16 v[88:89], v15 offset:57344
ds_read_b64_tr_b16 v[90:91], v15 offset:61440
ds_read_b64_tr_b16 v[92:93], v16 offset:57344
ds_read_b64_tr_b16 v[94:95], v16 offset:61440
ds_read_b128 v[68:71], v7 offset:41984
ds_read_b128 v[72:75], v7 offset:43008
ds_read_b128 v[76:79], v7 offset:44032
s_add_u32 m0, s39, 49152
s_add_u32 s37, s52, 573440
buffer_load_dwordx4 v3, s[24:27], s37 offen sc1 lds
buffer_load_dwordx4 v3, s[24:27], s37 offen offset:1024 sc1 lds
buffer_load_dwordx4 v3, s[24:27], s37 offen offset:2048 sc1 lds
buffer_load_dwordx4 v3, s[24:27], s37 offen offset:3072 sc1 lds
s_add_u32 m0, s39, 65536
s_add_u32 s38, s53, 4587520
buffer_load_dwordx4 v23, s[28:31], s38 offen lds
s_add_u32 m0, s39, 66560
s_add_u32 s38, s53, 4587520
buffer_load_dwordx4 v24, s[28:31], s38 offen lds
s_add_u32 m0, s39, 67584
s_add_u32 s38, s53, 4603904
buffer_load_dwordx4 v23, s[28:31], s38 offen lds
s_add_u32 m0, s39, 68608
s_add_u32 s38, s53, 4603904
buffer_load_dwordx4 v24, s[28:31], s38 offen lds
s_waitcnt vmcnt(16)
s_waitcnt lgkmcnt(0)
s_barrier
v_mfma_f32_16x16x32_bf16 v[128:131], v[48:51], v[32:35], v[128:131]
ds_read_b128 v[96:99], v8 offset:0
v_mfma_f32_16x16x32_bf16 v[132:135], v[52:55], v[32:35], v[132:135]
ds_read_b64_tr_b16 v[112:113], v9 offset:0
v_mfma_f32_16x16x32_bf16 v[160:163], v[56:59], v[32:35], 0
ds_read_b64_tr_b16 v[114:115], v9 offset:4096
v_mfma_f32_16x16x32_bf16 v[164:167], v[60:63], v[32:35], 0
ds_read_b64_tr_b16 v[116:117], v10 offset:0
v_mfma_f32_16x16x32_bf16 v[172:175], v[60:63], v[36:39], 0
ds_read_b64_tr_b16 v[118:119], v10 offset:4096
v_mfma_f32_16x16x32_bf16 v[168:171], v[56:59], v[36:39], 0
ds_read_b64_tr_b16 v[120:121], v11 offset:0
v_mfma_f32_16x16x32_bf16 v[140:143], v[52:55], v[36:39], v[140:143]
ds_read_b64_tr_b16 v[122:123], v11 offset:4096
v_mfma_f32_16x16x32_bf16 v[136:139], v[48:51], v[36:39], v[136:139]
ds_read_b64_tr_b16 v[124:125], v12 offset:0
v_mfma_f32_16x16x32_bf16 v[144:147], v[48:51], v[40:43], v[144:147]
ds_read_b64_tr_b16 v[126:127], v12 offset:4096
v_mfma_f32_16x16x32_bf16 v[148:151], v[52:55], v[40:43], v[148:151]
ds_read_b128 v[100:103], v8 offset:1024
v_mfma_f32_16x16x32_bf16 v[176:179], v[56:59], v[40:43], 0
ds_read_b128 v[104:107], v8 offset:2048
v_mfma_f32_16x16x32_bf16 v[180:183], v[60:63], v[40:43], 0
ds_read_b128 v[108:111], v8 offset:3072
v_mfma_f32_16x16x32_bf16 v[188:191], v[60:63], v[44:47], 0
ds_read_b128 v[192:195], v8 offset:8192
v_mfma_f32_16x16x32_bf16 v[184:187], v[56:59], v[44:47], 0
ds_read_b64_tr_b16 v[208:209], v9 offset:8192
v_mfma_f32_16x16x32_bf16 v[156:159], v[52:55], v[44:47], v[156:159]
ds_read_b64_tr_b16 v[210:211], v9 offset:12288
v_mfma_f32_16x16x32_bf16 v[152:155], v[48:51], v[44:47], v[152:155]
ds_read_b64_tr_b16 v[212:213], v10 offset:8192
v_mfma_f32_16x16x32_bf16 v[128:131], v[80:83], v[64:67], v[128:131]
ds_read_b64_tr_b16 v[214:215], v10 offset:12288
v_mfma_f32_16x16x32_bf16 v[132:135], v[84:87], v[64:67], v[132:135]
ds_read_b64_tr_b16 v[216:217], v11 offset:8192
v_mfma_f32_16x16x32_bf16 v[160:163], v[88:91], v[64:67], v[160:163]
ds_read_b64_tr_b16 v[218:219], v11 offset:12288
v_mfma_f32_16x16x32_bf16 v[164:167], v[92:95], v[64:67], v[164:167]
ds_read_b64_tr_b16 v[220:221], v12 offset:8192
v_mfma_f32_16x16x32_bf16 v[172:175], v[92:95], v[68:71], v[172:175]
ds_read_b64_tr_b16 v[222:223], v12 offset:12288
v_mfma_f32_16x16x32_bf16 v[168:171], v[88:91], v[68:71], v[168:171]
ds_read_b128 v[196:199], v8 offset:9216
v_mfma_f32_16x16x32_bf16 v[140:143], v[84:87], v[68:71], v[140:143]
ds_read_b128 v[200:203], v8 offset:10240
v_mfma_f32_16x16x32_bf16 v[136:139], v[80:83], v[68:71], v[136:139]
ds_read_b128 v[204:207], v8 offset:11264
v_mfma_f32_16x16x32_bf16 v[144:147], v[80:83], v[72:75], v[144:147]
v_mfma_f32_16x16x32_bf16 v[148:151], v[84:87], v[72:75], v[148:151]
v_mfma_f32_16x16x32_bf16 v[176:179], v[88:91], v[72:75], v[176:179]
v_mfma_f32_16x16x32_bf16 v[180:183], v[92:95], v[72:75], v[180:183]
v_mfma_f32_16x16x32_bf16 v[188:191], v[92:95], v[76:79], v[188:191]
v_mfma_f32_16x16x32_bf16 v[184:187], v[88:91], v[76:79], v[184:187]
v_mfma_f32_16x16x32_bf16 v[156:159], v[84:87], v[76:79], v[156:159]
v_mfma_f32_16x16x32_bf16 v[152:155], v[80:83], v[76:79], v[152:155]
s_mov_b32 s41, 2
Lk4_115:
s_waitcnt vmcnt(8)
s_waitcnt lgkmcnt(0)
s_barrier
v_mfma_f32_16x16x32_bf16 v[128:131], v[112:115], v[96:99], v[128:131]
ds_read_b128 v[32:35], v6 offset:16384
v_mfma_f32_16x16x32_bf16 v[132:135], v[116:119], v[96:99], v[132:135]
ds_read_b64_tr_b16 v[48:49], v9 offset:32768
v_mfma_f32_16x16x32_bf16 v[160:163], v[120:123], v[96:99], v[160:163]
ds_read_b64_tr_b16 v[50:51], v9 offset:36864
v_mfma_f32_16x16x32_bf16 v[164:167], v[124:127], v[96:99], v[164:167]
ds_read_b64_tr_b16 v[52:53], v10 offset:32768
v_mfma_f32_16x16x32_bf16 v[172:175], v[124:127], v[100:103], v[172:175]
ds_read_b64_tr_b16 v[54:55], v10 offset:36864
v_mfma_f32_16x16x32_bf16 v[168:171], v[120:123], v[100:103], v[168:171]
ds_read_b64_tr_b16 v[56:57], v11 offset:32768
v_mfma_f32_16x16x32_bf16 v[140:143], v[116:119], v[100:103], v[140:143]
ds_read_b64_tr_b16 v[58:59], v11 offset:36864
v_mfma_f32_16x16x32_bf16 v[136:139], v[112:115], v[100:103], v[136:139]
ds_read_b64_tr_b16 v[60:61], v12 offset:32768
v_mfma_f32_16x16x32_bf16 v[144:147], v[112:115], v[104:107], v[144:147]
ds_read_b64_tr_b16 v[62:63], v12 offset:36864
v_mfma_f32_16x16x32_bf16 v[148:151], v[116:119], v[104:107], v[148:151]
ds_read_b128 v[36:39], v6 offset:17408
v_mfma_f32_16x16x32_bf16 v[176:179], v[120:123], v[104:107], v[176:179]
ds_read_b128 v[40:43], v6 offset:18432
v_mfma_f32_16x16x32_bf16 v[180:183], v[124:127], v[104:107], v[180:183]
ds_read_b128 v[44:47], v6 offset:19456
v_mfma_f32_16x16x32_bf16 v[188:191], v[124:127], v[108:111], v[188:191]
ds_read_b128 v[64:67], v6 offset:24576
v_mfma_f32_16x16x32_bf16 v[184:187], v[120:123], v[108:111], v[184:187]
ds_read_b64_tr_b16 v[80:81], v9 offset:40960
v_mfma_f32_16x16x32_bf16 v[156:159], v[116:119], v[108:111], v[156:159]
ds_read_b64_tr_b16 v[82:83], v9 offset:45056
v_mfma_f32_16x16x32_bf16 v[152:155], v[112:115], v[108:111], v[152:155]
ds_read_b64_tr_b16 v[84:85], v10 offset:40960
v_mfma_f32_16x16x32_bf16 v[128:131], v[208:211], v[192:195], v[128:131]
ds_read_b64_tr_b16 v[86:87], v10 offset:45056
v_mfma_f32_16x16x32_bf16 v[132:135], v[212:215], v[192:195], v[132:135]
ds_read_b64_tr_b16 v[88:89], v11 offset:40960
v_mfma_f32_16x16x32_bf16 v[160:163], v[216:219], v[192:195], v[160:163]
ds_read_b64_tr_b16 v[90:91], v11 offset:45056
v_mfma_f32_16x16x32_bf16 v[164:167], v[220:223], v[192:195], v[164:167]
ds_read_b64_tr_b16 v[92:93], v12 offset:40960
v_mfma_f32_16x16x32_bf16 v[172:175], v[220:223], v[196:199], v[172:175]
ds_read_b64_tr_b16 v[94:95], v12 offset:45056
v_mfma_f32_16x16x32_bf16 v[168:171], v[216:219], v[196:199], v[168:171]
ds_read_b128 v[68:71], v6 offset:25600
v_mfma_f32_16x16x32_bf16 v[140:143], v[212:215], v[196:199], v[140:143]
ds_read_b128 v[72:75], v6 offset:26624
v_mfma_f32_16x16x32_bf16 v[136:139], v[208:211], v[196:199], v[136:139]
ds_read_b128 v[76:79], v6 offset:27648
v_mfma_f32_16x16x32_bf16 v[144:147], v[208:211], v[200:203], v[144:147]
v_mfma_f32_16x16x32_bf16 v[148:151], v[212:215], v[200:203], v[148:151]
v_mfma_f32_16x16x32_bf16 v[176:179], v[216:219], v[200:203], v[176:179]
v_mfma_f32_16x16x32_bf16 v[180:183], v[220:223], v[200:203], v[180:183]
v_mfma_f32_16x16x32_bf16 v[188:191], v[220:223], v[204:207], v[188:191]
v_mfma_f32_16x16x32_bf16 v[184:187], v[216:219], v[204:207], v[184:187]
v_mfma_f32_16x16x32_bf16 v[156:159], v[212:215], v[204:207], v[156:159]
v_mfma_f32_16x16x32_bf16 v[152:155], v[208:211], v[204:207], v[152:155]
s_waitcnt vmcnt(0)
s_waitcnt lgkmcnt(0)
s_barrier
v_mfma_f32_16x16x32_bf16 v[128:131], v[48:51], v[32:35], v[128:131]
ds_read_b128 v[96:99], v6 offset:49152
v_mfma_f32_16x16x32_bf16 v[132:135], v[52:55], v[32:35], v[132:135]
ds_read_b64_tr_b16 v[112:113], v13 offset:0
v_mfma_f32_16x16x32_bf16 v[160:163], v[56:59], v[32:35], v[160:163]
ds_read_b64_tr_b16 v[114:115], v13 offset:4096
v_mfma_f32_16x16x32_bf16 v[164:167], v[60:63], v[32:35], v[164:167]
ds_read_b64_tr_b16 v[116:117], v14 offset:0
v_mfma_f32_16x16x32_bf16 v[172:175], v[60:63], v[36:39], v[172:175]
ds_read_b64_tr_b16 v[118:119], v14 offset:4096
v_mfma_f32_16x16x32_bf16 v[168:171], v[56:59], v[36:39], v[168:171]
ds_read_b64_tr_b16 v[120:121], v15 offset:0
v_mfma_f32_16x16x32_bf16 v[140:143], v[52:55], v[36:39], v[140:143]
ds_read_b64_tr_b16 v[122:123], v15 offset:4096
v_mfma_f32_16x16x32_bf16 v[136:139], v[48:51], v[36:39], v[136:139]
ds_read_b64_tr_b16 v[124:125], v16 offset:0
v_mfma_f32_16x16x32_bf16 v[144:147], v[48:51], v[40:43], v[144:147]
ds_read_b64_tr_b16 v[126:127], v16 offset:4096
v_mfma_f32_16x16x32_bf16 v[148:151], v[52:55], v[40:43], v[148:151]
ds_read_b128 v[100:103], v6 offset:50176
v_mfma_f32_16x16x32_bf16 v[176:179], v[56:59], v[40:43], v[176:179]
ds_read_b128 v[104:107], v6 offset:51200
v_mfma_f32_16x16x32_bf16 v[180:183], v[60:63], v[40:43], v[180:183]
ds_read_b128 v[108:111], v6 offset:52224
v_mfma_f32_16x16x32_bf16 v[188:191], v[60:63], v[44:47], v[188:191]
ds_read_b128 v[192:195], v6 offset:57344
v_mfma_f32_16x16x32_bf16 v[184:187], v[56:59], v[44:47], v[184:187]
ds_read_b64_tr_b16 v[208:209], v13 offset:8192
v_mfma_f32_16x16x32_bf16 v[156:159], v[52:55], v[44:47], v[156:159]
ds_read_b64_tr_b16 v[210:211], v13 offset:12288
v_mfma_f32_16x16x32_bf16 v[152:155], v[48:51], v[44:47], v[152:155]
ds_read_b64_tr_b16 v[212:213], v14 offset:8192
v_mfma_f32_16x16x32_bf16 v[128:131], v[80:83], v[64:67], v[128:131]
ds_read_b64_tr_b16 v[214:215], v14 offset:12288
v_mfma_f32_16x16x32_bf16 v[132:135], v[84:87], v[64:67], v[132:135]
ds_read_b64_tr_b16 v[216:217], v15 offset:8192
v_mfma_f32_16x16x32_bf16 v[160:163], v[88:91], v[64:67], v[160:163]
ds_read_b64_tr_b16 v[218:219], v15 offset:12288
v_mfma_f32_16x16x32_bf16 v[164:167], v[92:95], v[64:67], v[164:167]
ds_read_b64_tr_b16 v[220:221], v16 offset:8192
v_mfma_f32_16x16x32_bf16 v[172:175], v[92:95], v[68:71], v[172:175]
ds_read_b64_tr_b16 v[222:223], v16 offset:12288
v_mfma_f32_16x16x32_bf16 v[168:171], v[88:91], v[68:71], v[168:171]
ds_read_b128 v[196:199], v6 offset:58368
v_mfma_f32_16x16x32_bf16 v[140:143], v[84:87], v[68:71], v[140:143]
ds_read_b128 v[200:203], v6 offset:59392
v_mfma_f32_16x16x32_bf16 v[136:139], v[80:83], v[68:71], v[136:139]
ds_read_b128 v[204:207], v6 offset:60416
v_mfma_f32_16x16x32_bf16 v[144:147], v[80:83], v[72:75], v[144:147]
v_mfma_f32_16x16x32_bf16 v[148:151], v[84:87], v[72:75], v[148:151]
v_mfma_f32_16x16x32_bf16 v[176:179], v[88:91], v[72:75], v[176:179]
v_mfma_f32_16x16x32_bf16 v[180:183], v[92:95], v[72:75], v[180:183]
v_mfma_f32_16x16x32_bf16 v[188:191], v[92:95], v[76:79], v[188:191]
v_mfma_f32_16x16x32_bf16 v[184:187], v[88:91], v[76:79], v[184:187]
v_mfma_f32_16x16x32_bf16 v[156:159], v[84:87], v[76:79], v[156:159]
v_mfma_f32_16x16x32_bf16 v[152:155], v[80:83], v[76:79], v[152:155]
s_waitcnt lgkmcnt(0)
s_barrier
v_mfma_f32_16x16x32_bf16 v[128:131], v[112:115], v[96:99], v[128:131]
ds_read_b128 v[32:35], v7 offset:16384
v_mfma_f32_16x16x32_bf16 v[132:135], v[116:119], v[96:99], v[132:135]
ds_read_b64_tr_b16 v[48:49], v25 offset:16384
v_mfma_f32_16x16x32_bf16 v[160:163], v[120:123], v[96:99], v[160:163]
ds_read_b64_tr_b16 v[50:51], v25 offset:20480
v_mfma_f32_16x16x32_bf16 v[164:167], v[124:127], v[96:99], v[164:167]
ds_read_b64_tr_b16 v[52:53], v26 offset:16384
v_mfma_f32_16x16x32_bf16 v[172:175], v[124:127], v[100:103], v[172:175]
ds_read_b64_tr_b16 v[54:55], v26 offset:20480
v_mfma_f32_16x16x32_bf16 v[168:171], v[120:123], v[100:103], v[168:171]
ds_read_b64_tr_b16 v[56:57], v27 offset:16384
v_mfma_f32_16x16x32_bf16 v[140:143], v[116:119], v[100:103], v[140:143]
ds_read_b64_tr_b16 v[58:59], v27 offset:20480
v_mfma_f32_16x16x32_bf16 v[136:139], v[112:115], v[100:103], v[136:139]
ds_read_b64_tr_b16 v[60:61], v28 offset:16384
v_mfma_f32_16x16x32_bf16 v[144:147], v[112:115], v[104:107], v[144:147]
ds_read_b64_tr_b16 v[62:63], v28 offset:20480
v_mfma_f32_16x16x32_bf16 v[148:151], v[116:119], v[104:107], v[148:151]
ds_read_b128 v[36:39], v7 offset:17408
v_mfma_f32_16x16x32_bf16 v[176:179], v[120:123], v[104:107], v[176:179]
ds_read_b128 v[40:43], v7 offset:18432
v_mfma_f32_16x16x32_bf16 v[180:183], v[124:127], v[104:107], v[180:183]
ds_read_b128 v[44:47], v7 offset:19456
v_mfma_f32_16x16x32_bf16 v[188:191], v[124:127], v[108:111], v[188:191]
ds_read_b128 v[64:67], v7 offset:24576
v_mfma_f32_16x16x32_bf16 v[184:187], v[120:123], v[108:111], v[184:187]
ds_read_b64_tr_b16 v[80:81], v25 offset:24576
v_mfma_f32_16x16x32_bf16 v[156:159], v[116:119], v[108:111], v[156:159]
ds_read_b64_tr_b16 v[82:83], v25 offset:28672
v_mfma_f32_16x16x32_bf16 v[152:155], v[112:115], v[108:111], v[152:155]
ds_read_b64_tr_b16 v[84:85], v26 offset:24576
v_mfma_f32_16x16x32_bf16 v[128:131], v[208:211], v[192:195], v[128:131]
ds_read_b64_tr_b16 v[86:87], v26 offset:28672
v_mfma_f32_16x16x32_bf16 v[132:135], v[212:215], v[192:195], v[132:135]
ds_read_b64_tr_b16 v[88:89], v27 offset:24576
v_mfma_f32_16x16x32_bf16 v[160:163], v[216:219], v[192:195], v[160:163]
ds_read_b64_tr_b16 v[90:91], v27 offset:28672
v_mfma_f32_16x16x32_bf16 v[164:167], v[220:223], v[192:195], v[164:167]
ds_read_b64_tr_b16 v[92:93], v28 offset:24576
v_mfma_f32_16x16x32_bf16 v[172:175], v[220:223], v[196:199], v[172:175]
ds_read_b64_tr_b16 v[94:95], v28 offset:28672
v_mfma_f32_16x16x32_bf16 v[168:171], v[216:219], v[196:199], v[168:171]
ds_read_b128 v[68:71], v7 offset:25600
v_mfma_f32_16x16x32_bf16 v[140:143], v[212:215], v[196:199], v[140:143]
ds_read_b128 v[72:75], v7 offset:26624
v_mfma_f32_16x16x32_bf16 v[136:139], v[208:211], v[196:199], v[136:139]
ds_read_b128 v[76:79], v7 offset:27648
v_mfma_f32_16x16x32_bf16 v[144:147], v[208:211], v[200:203], v[144:147]
v_mfma_f32_16x16x32_bf16 v[148:151], v[212:215], v[200:203], v[148:151]
v_mfma_f32_16x16x32_bf16 v[176:179], v[216:219], v[200:203], v[176:179]
v_mfma_f32_16x16x32_bf16 v[180:183], v[220:223], v[200:203], v[180:183]
v_mfma_f32_16x16x32_bf16 v[188:191], v[220:223], v[204:207], v[188:191]
v_mfma_f32_16x16x32_bf16 v[184:187], v[216:219], v[204:207], v[184:187]
v_mfma_f32_16x16x32_bf16 v[156:159], v[212:215], v[204:207], v[156:159]
v_mfma_f32_16x16x32_bf16 v[152:155], v[208:211], v[204:207], v[152:155]
s_waitcnt lgkmcnt(0)
s_barrier
v_mfma_f32_16x16x32_bf16 v[128:131], v[48:51], v[32:35], v[128:131]
ds_read_b128 v[96:99], v7 offset:32768
v_mfma_f32_16x16x32_bf16 v[132:135], v[52:55], v[32:35], v[132:135]
ds_read_b64_tr_b16 v[112:113], v13 offset:49152
v_mfma_f32_16x16x32_bf16 v[160:163], v[56:59], v[32:35], v[160:163]
ds_read_b64_tr_b16 v[114:115], v13 offset:53248
v_mfma_f32_16x16x32_bf16 v[164:167], v[60:63], v[32:35], v[164:167]
ds_read_b64_tr_b16 v[116:117], v14 offset:49152
v_mfma_f32_16x16x32_bf16 v[172:175], v[60:63], v[36:39], v[172:175]
ds_read_b64_tr_b16 v[118:119], v14 offset:53248
v_mfma_f32_16x16x32_bf16 v[168:171], v[56:59], v[36:39], v[168:171]
ds_read_b64_tr_b16 v[120:121], v15 offset:49152
v_mfma_f32_16x16x32_bf16 v[140:143], v[52:55], v[36:39], v[140:143]
ds_read_b64_tr_b16 v[122:123], v15 offset:53248
v_mfma_f32_16x16x32_bf16 v[136:139], v[48:51], v[36:39], v[136:139]
ds_read_b64_tr_b16 v[124:125], v16 offset:49152
v_mfma_f32_16x16x32_bf16 v[144:147], v[48:51], v[40:43], v[144:147]
ds_read_b64_tr_b16 v[126:127], v16 offset:53248
v_mfma_f32_16x16x32_bf16 v[148:151], v[52:55], v[40:43], v[148:151]
ds_read_b128 v[100:103], v7 offset:33792
v_mfma_f32_16x16x32_bf16 v[176:179], v[56:59], v[40:43], v[176:179]
ds_read_b128 v[104:107], v7 offset:34816
v_mfma_f32_16x16x32_bf16 v[180:183], v[60:63], v[40:43], v[180:183]
ds_read_b128 v[108:111], v7 offset:35840
v_mfma_f32_16x16x32_bf16 v[188:191], v[60:63], v[44:47], v[188:191]
ds_read_b128 v[192:195], v7 offset:40960
v_mfma_f32_16x16x32_bf16 v[184:187], v[56:59], v[44:47], v[184:187]
ds_read_b64_tr_b16 v[208:209], v13 offset:57344
v_mfma_f32_16x16x32_bf16 v[156:159], v[52:55], v[44:47], v[156:159]
ds_read_b64_tr_b16 v[210:211], v13 offset:61440
v_mfma_f32_16x16x32_bf16 v[152:155], v[48:51], v[44:47], v[152:155]
ds_read_b64_tr_b16 v[212:213], v14 offset:57344
v_mfma_f32_16x16x32_bf16 v[128:131], v[80:83], v[64:67], v[128:131]
ds_read_b64_tr_b16 v[214:215], v14 offset:61440
v_mfma_f32_16x16x32_bf16 v[132:135], v[84:87], v[64:67], v[132:135]
ds_read_b64_tr_b16 v[216:217], v15 offset:57344
v_mfma_f32_16x16x32_bf16 v[160:163], v[88:91], v[64:67], v[160:163]
ds_read_b64_tr_b16 v[218:219], v15 offset:61440
v_mfma_f32_16x16x32_bf16 v[164:167], v[92:95], v[64:67], v[164:167]
ds_read_b64_tr_b16 v[220:221], v16 offset:57344
v_mfma_f32_16x16x32_bf16 v[172:175], v[92:95], v[68:71], v[172:175]
ds_read_b64_tr_b16 v[222:223], v16 offset:61440
v_mfma_f32_16x16x32_bf16 v[168:171], v[88:91], v[68:71], v[168:171]
ds_read_b128 v[196:199], v7 offset:41984
v_mfma_f32_16x16x32_bf16 v[140:143], v[84:87], v[68:71], v[140:143]
ds_read_b128 v[200:203], v7 offset:43008
v_mfma_f32_16x16x32_bf16 v[136:139], v[80:83], v[68:71], v[136:139]
ds_read_b128 v[204:207], v7 offset:44032
v_mfma_f32_16x16x32_bf16 v[144:147], v[80:83], v[72:75], v[144:147]
v_mfma_f32_16x16x32_bf16 v[148:151], v[84:87], v[72:75], v[148:151]
v_mfma_f32_16x16x32_bf16 v[176:179], v[88:91], v[72:75], v[176:179]
v_mfma_f32_16x16x32_bf16 v[180:183], v[92:95], v[72:75], v[180:183]
v_mfma_f32_16x16x32_bf16 v[188:191], v[92:95], v[76:79], v[188:191]
v_mfma_f32_16x16x32_bf16 v[184:187], v[88:91], v[76:79], v[184:187]
v_mfma_f32_16x16x32_bf16 v[156:159], v[84:87], v[76:79], v[156:159]
v_mfma_f32_16x16x32_bf16 v[152:155], v[80:83], v[76:79], v[152:155]
s_waitcnt lgkmcnt(0)
s_barrier
v_mfma_f32_16x16x32_bf16 v[128:131], v[112:115], v[96:99], v[128:131]
ds_read_b128 v[32:35], v8 offset:0
v_mfma_f32_16x16x32_bf16 v[132:135], v[116:119], v[96:99], v[132:135]
ds_read_b64_tr_b16 v[48:49], v9 offset:0
v_mfma_f32_16x16x32_bf16 v[160:163], v[120:123], v[96:99], v[160:163]
ds_read_b64_tr_b16 v[50:51], v9 offset:4096
v_mfma_f32_16x16x32_bf16 v[164:167], v[124:127], v[96:99], v[164:167]
ds_read_b64_tr_b16 v[52:53], v10 offset:0
v_mfma_f32_16x16x32_bf16 v[172:175], v[124:127], v[100:103], v[172:175]
s_branch Lov_11
.p2align 12
Lst_11_0:
s_branch Lwr_150
Lst_11_1:
s_branch Lst_15_0
s_nop 0
Lov_11:
ds_read_b64_tr_b16 v[54:55], v10 offset:4096
v_mfma_f32_16x16x32_bf16 v[168:171], v[120:123], v[100:103], v[168:171]
ds_read_b64_tr_b16 v[56:57], v11 offset:0
v_mfma_f32_16x16x32_bf16 v[140:143], v[116:119], v[100:103], v[140:143]
ds_read_b64_tr_b16 v[58:59], v11 offset:4096
v_mfma_f32_16x16x32_bf16 v[136:139], v[112:115], v[100:103], v[136:139]
ds_read_b64_tr_b16 v[60:61], v12 offset:0
v_mfma_f32_16x16x32_bf16 v[144:147], v[112:115], v[104:107], v[144:147]
ds_read_b64_tr_b16 v[62:63], v12 offset:4096
v_mfma_f32_16x16x32_bf16 v[148:151], v[116:119], v[104:107], v[148:151]
ds_read_b128 v[36:39], v8 offset:1024
v_mfma_f32_16x16x32_bf16 v[176:179], v[120:123], v[104:107], v[176:179]
ds_read_b128 v[40:43], v8 offset:2048
v_mfma_f32_16x16x32_bf16 v[180:183], v[124:127], v[104:107], v[180:183]
ds_read_b128 v[44:47], v8 offset:3072
v_mfma_f32_16x16x32_bf16 v[188:191], v[124:127], v[108:111], v[188:191]
ds_read_b128 v[64:67], v8 offset:8192
v_mfma_f32_16x16x32_bf16 v[184:187], v[120:123], v[108:111], v[184:187]
ds_read_b64_tr_b16 v[80:81], v9 offset:8192
v_mfma_f32_16x16x32_bf16 v[156:159], v[116:119], v[108:111], v[156:159]
ds_read_b64_tr_b16 v[82:83], v9 offset:12288
v_mfma_f32_16x16x32_bf16 v[152:155], v[112:115], v[108:111], v[152:155]
ds_read_b64_tr_b16 v[84:85], v10 offset:8192
v_mfma_f32_16x16x32_bf16 v[128:131], v[208:211], v[192:195], v[128:131]
ds_read_b64_tr_b16 v[86:87], v10 offset:12288
v_mfma_f32_16x16x32_bf16 v[132:135], v[212:215], v[192:195], v[132:135]
ds_read_b64_tr_b16 v[88:89], v11 offset:8192
v_mfma_f32_16x16x32_bf16 v[160:163], v[216:219], v[192:195], v[160:163]
ds_read_b64_tr_b16 v[90:91], v11 offset:12288
v_mfma_f32_16x16x32_bf16 v[164:167], v[220:223], v[192:195], v[164:167]
ds_read_b64_tr_b16 v[92:93], v12 offset:8192
v_mfma_f32_16x16x32_bf16 v[172:175], v[220:223], v[196:199], v[172:175]
ds_read_b64_tr_b16 v[94:95], v12 offset:12288
v_mfma_f32_16x16x32_bf16 v[168:171], v[216:219], v[196:199], v[168:171]
ds_read_b128 v[68:71], v8 offset:9216
v_mfma_f32_16x16x32_bf16 v[140:143], v[212:215], v[196:199], v[140:143]
ds_read_b128 v[72:75], v8 offset:10240
v_mfma_f32_16x16x32_bf16 v[136:139], v[208:211], v[196:199], v[136:139]
ds_read_b128 v[76:79], v8 offset:11264
v_mfma_f32_16x16x32_bf16 v[144:147], v[208:211], v[200:203], v[144:147]
v_mfma_f32_16x16x32_bf16 v[148:151], v[212:215], v[200:203], v[148:151]
v_mfma_f32_16x16x32_bf16 v[176:179], v[216:219], v[200:203], v[176:179]
v_mfma_f32_16x16x32_bf16 v[180:183], v[220:223], v[200:203], v[180:183]
v_mfma_f32_16x16x32_bf16 v[188:191], v[220:223], v[204:207], v[188:191]
v_mfma_f32_16x16x32_bf16 v[184:187], v[216:219], v[204:207], v[184:187]
v_mfma_f32_16x16x32_bf16 v[156:159], v[212:215], v[204:207], v[156:159]
v_mfma_f32_16x16x32_bf16 v[152:155], v[208:211], v[204:207], v[152:155]
s_waitcnt lgkmcnt(0)
s_barrier
v_mfma_f32_16x16x32_bf16 v[128:131], v[48:51], v[32:35], v[128:131]
ds_read_b128 v[96:99], v6 offset:16384
v_mfma_f32_16x16x32_bf16 v[132:135], v[52:55], v[32:35], v[132:135]
ds_read_b64_tr_b16 v[112:113], v9 offset:32768
v_mfma_f32_16x16x32_bf16 v[160:163], v[56:59], v[32:35], v[160:163]
ds_read_b64_tr_b16 v[114:115], v9 offset:36864
v_mfma_f32_16x16x32_bf16 v[164:167], v[60:63], v[32:35], v[164:167]
ds_read_b64_tr_b16 v[116:117], v10 offset:32768
v_mfma_f32_16x16x32_bf16 v[172:175], v[60:63], v[36:39], v[172:175]
ds_read_b64_tr_b16 v[118:119], v10 offset:36864
v_mfma_f32_16x16x32_bf16 v[168:171], v[56:59], v[36:39], v[168:171]
ds_read_b64_tr_b16 v[120:121], v11 offset:32768
v_mfma_f32_16x16x32_bf16 v[140:143], v[52:55], v[36:39], v[140:143]
ds_read_b64_tr_b16 v[122:123], v11 offset:36864
v_mfma_f32_16x16x32_bf16 v[136:139], v[48:51], v[36:39], v[136:139]
ds_read_b64_tr_b16 v[124:125], v12 offset:32768
v_mfma_f32_16x16x32_bf16 v[144:147], v[48:51], v[40:43], v[144:147]
ds_read_b64_tr_b16 v[126:127], v12 offset:36864
v_mfma_f32_16x16x32_bf16 v[148:151], v[52:55], v[40:43], v[148:151]
ds_read_b128 v[100:103], v6 offset:17408
v_mfma_f32_16x16x32_bf16 v[176:179], v[56:59], v[40:43], v[176:179]
ds_read_b128 v[104:107], v6 offset:18432
v_mfma_f32_16x16x32_bf16 v[180:183], v[60:63], v[40:43], v[180:183]
ds_read_b128 v[108:111], v6 offset:19456
v_mfma_f32_16x16x32_bf16 v[188:191], v[60:63], v[44:47], v[188:191]
ds_read_b128 v[192:195], v6 offset:24576
v_mfma_f32_16x16x32_bf16 v[184:187], v[56:59], v[44:47], v[184:187]
ds_read_b64_tr_b16 v[208:209], v9 offset:40960
v_mfma_f32_16x16x32_bf16 v[156:159], v[52:55], v[44:47], v[156:159]
ds_read_b64_tr_b16 v[210:211], v9 offset:45056
v_mfma_f32_16x16x32_bf16 v[152:155], v[48:51], v[44:47], v[152:155]
ds_read_b64_tr_b16 v[212:213], v10 offset:40960
v_mfma_f32_16x16x32_bf16 v[128:131], v[80:83], v[64:67], v[128:131]
ds_read_b64_tr_b16 v[214:215], v10 offset:45056
v_mfma_f32_16x16x32_bf16 v[132:135], v[84:87], v[64:67], v[132:135]
ds_read_b64_tr_b16 v[216:217], v11 offset:40960
v_mfma_f32_16x16x32_bf16 v[160:163], v[88:91], v[64:67], v[160:163]
ds_read_b64_tr_b16 v[218:219], v11 offset:45056
v_mfma_f32_16x16x32_bf16 v[164:167], v[92:95], v[64:67], v[164:167]
ds_read_b64_tr_b16 v[220:221], v12 offset:40960
v_mfma_f32_16x16x32_bf16 v[172:175], v[92:95], v[68:71], v[172:175]
ds_read_b64_tr_b16 v[222:223], v12 offset:45056
v_mfma_f32_16x16x32_bf16 v[168:171], v[88:91], v[68:71], v[168:171]
ds_read_b128 v[196:199], v6 offset:25600
v_mfma_f32_16x16x32_bf16 v[140:143], v[84:87], v[68:71], v[140:143]
ds_read_b128 v[200:203], v6 offset:26624
v_mfma_f32_16x16x32_bf16 v[136:139], v[80:83], v[68:71], v[136:139]
ds_read_b128 v[204:207], v6 offset:27648
v_mfma_f32_16x16x32_bf16 v[144:147], v[80:83], v[72:75], v[144:147]
v_mfma_f32_16x16x32_bf16 v[148:151], v[84:87], v[72:75], v[148:151]
v_mfma_f32_16x16x32_bf16 v[176:179], v[88:91], v[72:75], v[176:179]
v_mfma_f32_16x16x32_bf16 v[180:183], v[92:95], v[72:75], v[180:183]
v_mfma_f32_16x16x32_bf16 v[188:191], v[92:95], v[76:79], v[188:191]
v_mfma_f32_16x16x32_bf16 v[184:187], v[88:91], v[76:79], v[184:187]
v_mfma_f32_16x16x32_bf16 v[156:159], v[84:87], v[76:79], v[156:159]
v_mfma_f32_16x16x32_bf16 v[152:155], v[80:83], v[76:79], v[152:155]
s_waitcnt lgkmcnt(0)
s_barrier
v_mfma_f32_16x16x32_bf16 v[128:131], v[112:115], v[96:99], v[128:131]
ds_read_b128 v[32:35], v6 offset:49152
v_mfma_f32_16x16x32_bf16 v[132:135], v[116:119], v[96:99], v[132:135]
ds_read_b64_tr_b16 v[48:49], v13 offset:0
v_mfma_f32_16x16x32_bf16 v[160:163], v[120:123], v[96:99], v[160:163]
ds_read_b64_tr_b16 v[50:51], v13 offset:4096
v_mfma_f32_16x16x32_bf16 v[164:167], v[124:127], v[96:99], v[164:167]
ds_read_b64_tr_b16 v[52:53], v14 offset:0
v_mfma_f32_16x16x32_bf16 v[172:175], v[124:127], v[100:103], v[172:175]
ds_read_b64_tr_b16 v[54:55], v14 offset:4096
v_mfma_f32_16x16x32_bf16 v[168:171], v[120:123], v[100:103], v[168:171]
ds_read_b64_tr_b16 v[56:57], v15 offset:0
v_mfma_f32_16x16x32_bf16 v[140:143], v[116:119], v[100:103], v[140:143]
ds_read_b64_tr_b16 v[58:59], v15 offset:4096
v_mfma_f32_16x16x32_bf16 v[136:139], v[112:115], v[100:103], v[136:139]
ds_read_b64_tr_b16 v[60:61], v16 offset:0
v_mfma_f32_16x16x32_bf16 v[144:147], v[112:115], v[104:107], v[144:147]
ds_read_b64_tr_b16 v[62:63], v16 offset:4096
v_mfma_f32_16x16x32_bf16 v[148:151], v[116:119], v[104:107], v[148:151]
ds_read_b128 v[36:39], v6 offset:50176
v_mfma_f32_16x16x32_bf16 v[176:179], v[120:123], v[104:107], v[176:179]
ds_read_b128 v[40:43], v6 offset:51200
v_mfma_f32_16x16x32_bf16 v[180:183], v[124:127], v[104:107], v[180:183]
ds_read_b128 v[44:47], v6 offset:52224
v_mfma_f32_16x16x32_bf16 v[188:191], v[124:127], v[108:111], v[188:191]
ds_read_b128 v[64:67], v6 offset:57344
v_mfma_f32_16x16x32_bf16 v[184:187], v[120:123], v[108:111], v[184:187]
ds_read_b64_tr_b16 v[80:81], v13 offset:8192
v_mfma_f32_16x16x32_bf16 v[156:159], v[116:119], v[108:111], v[156:159]
ds_read_b64_tr_b16 v[82:83], v13 offset:12288
v_mfma_f32_16x16x32_bf16 v[152:155], v[112:115], v[108:111], v[152:155]
ds_read_b64_tr_b16 v[84:85], v14 offset:8192
v_mfma_f32_16x16x32_bf16 v[128:131], v[208:211], v[192:195], v[128:131]
ds_read_b64_tr_b16 v[86:87], v14 offset:12288
v_mfma_f32_16x16x32_bf16 v[132:135], v[212:215], v[192:195], v[132:135]
ds_read_b64_tr_b16 v[88:89], v15 offset:8192
v_mfma_f32_16x16x32_bf16 v[160:163], v[216:219], v[192:195], v[160:163]
ds_read_b64_tr_b16 v[90:91], v15 offset:12288
v_mfma_f32_16x16x32_bf16 v[164:167], v[220:223], v[192:195], v[164:167]
ds_read_b64_tr_b16 v[92:93], v16 offset:8192
v_mfma_f32_16x16x32_bf16 v[172:175], v[220:223], v[196:199], v[172:175]
ds_read_b64_tr_b16 v[94:95], v16 offset:12288
v_mfma_f32_16x16x32_bf16 v[168:171], v[216:219], v[196:199], v[168:171]
ds_read_b128 v[68:71], v6 offset:58368
v_mfma_f32_16x16x32_bf16 v[140:143], v[212:215], v[196:199], v[140:143]
ds_read_b128 v[72:75], v6 offset:59392
v_mfma_f32_16x16x32_bf16 v[136:139], v[208:211], v[196:199], v[136:139]
ds_read_b128 v[76:79], v6 offset:60416
v_mfma_f32_16x16x32_bf16 v[144:147], v[208:211], v[200:203], v[144:147]
v_mfma_f32_16x16x32_bf16 v[148:151], v[212:215], v[200:203], v[148:151]
v_mfma_f32_16x16x32_bf16 v[176:179], v[216:219], v[200:203], v[176:179]
v_mfma_f32_16x16x32_bf16 v[180:183], v[220:223], v[200:203], v[180:183]
v_mfma_f32_16x16x32_bf16 v[188:191], v[220:223], v[204:207], v[188:191]
v_mfma_f32_16x16x32_bf16 v[184:187], v[216:219], v[204:207], v[184:187]
v_mfma_f32_16x16x32_bf16 v[156:159], v[212:215], v[204:207], v[156:159]
v_mfma_f32_16x16x32_bf16 v[152:155], v[208:211], v[204:207], v[152:155]
s_waitcnt lgkmcnt(0)
s_barrier
v_mfma_f32_16x16x32_bf16 v[128:131], v[48:51], v[32:35], v[128:131]
ds_read_b128 v[96:99], v7 offset:16384
v_mfma_f32_16x16x32_bf16 v[132:135], v[52:55], v[32:35], v[132:135]
ds_read_b64_tr_b16 v[112:113], v25 offset:16384
v_mfma_f32_16x16x32_bf16 v[160:163], v[56:59], v[32:35], v[160:163]
ds_read_b64_tr_b16 v[114:115], v25 offset:20480
v_mfma_f32_16x16x32_bf16 v[164:167], v[60:63], v[32:35], v[164:167]
ds_read_b64_tr_b16 v[116:117], v26 offset:16384
v_mfma_f32_16x16x32_bf16 v[172:175], v[60:63], v[36:39], v[172:175]
ds_read_b64_tr_b16 v[118:119], v26 offset:20480
v_mfma_f32_16x16x32_bf16 v[168:171], v[56:59], v[36:39], v[168:171]
ds_read_b64_tr_b16 v[120:121], v27 offset:16384
v_mfma_f32_16x16x32_bf16 v[140:143], v[52:55], v[36:39], v[140:143]
ds_read_b64_tr_b16 v[122:123], v27 offset:20480
v_mfma_f32_16x16x32_bf16 v[136:139], v[48:51], v[36:39], v[136:139]
ds_read_b64_tr_b16 v[124:125], v28 offset:16384
v_mfma_f32_16x16x32_bf16 v[144:147], v[48:51], v[40:43], v[144:147]
ds_read_b64_tr_b16 v[126:127], v28 offset:20480
v_mfma_f32_16x16x32_bf16 v[148:151], v[52:55], v[40:43], v[148:151]
ds_read_b128 v[100:103], v7 offset:17408
v_mfma_f32_16x16x32_bf16 v[176:179], v[56:59], v[40:43], v[176:179]
ds_read_b128 v[104:107], v7 offset:18432
v_mfma_f32_16x16x32_bf16 v[180:183], v[60:63], v[40:43], v[180:183]
ds_read_b128 v[108:111], v7 offset:19456
v_mfma_f32_16x16x32_bf16 v[188:191], v[60:63], v[44:47], v[188:191]
ds_read_b128 v[192:195], v7 offset:24576
v_mfma_f32_16x16x32_bf16 v[184:187], v[56:59], v[44:47], v[184:187]
ds_read_b64_tr_b16 v[208:209], v25 offset:24576
v_mfma_f32_16x16x32_bf16 v[156:159], v[52:55], v[44:47], v[156:159]
ds_read_b64_tr_b16 v[210:211], v25 offset:28672
v_mfma_f32_16x16x32_bf16 v[152:155], v[48:51], v[44:47], v[152:155]
ds_read_b64_tr_b16 v[212:213], v26 offset:24576
v_mfma_f32_16x16x32_bf16 v[128:131], v[80:83], v[64:67], v[128:131]
ds_read_b64_tr_b16 v[214:215], v26 offset:28672
v_mfma_f32_16x16x32_bf16 v[132:135], v[84:87], v[64:67], v[132:135]
ds_read_b64_tr_b16 v[216:217], v27 offset:24576
v_mfma_f32_16x16x32_bf16 v[160:163], v[88:91], v[64:67], v[160:163]
ds_read_b64_tr_b16 v[218:219], v27 offset:28672
v_mfma_f32_16x16x32_bf16 v[164:167], v[92:95], v[64:67], v[164:167]
ds_read_b64_tr_b16 v[220:221], v28 offset:24576
v_mfma_f32_16x16x32_bf16 v[172:175], v[92:95], v[68:71], v[172:175]
ds_read_b64_tr_b16 v[222:223], v28 offset:28672
v_mfma_f32_16x16x32_bf16 v[168:171], v[88:91], v[68:71], v[168:171]
ds_read_b128 v[196:199], v7 offset:25600
v_mfma_f32_16x16x32_bf16 v[140:143], v[84:87], v[68:71], v[140:143]
ds_read_b128 v[200:203], v7 offset:26624
v_mfma_f32_16x16x32_bf16 v[136:139], v[80:83], v[68:71], v[136:139]
ds_read_b128 v[204:207], v7 offset:27648
v_mfma_f32_16x16x32_bf16 v[144:147], v[80:83], v[72:75], v[144:147]
v_mfma_f32_16x16x32_bf16 v[148:151], v[84:87], v[72:75], v[148:151]
v_mfma_f32_16x16x32_bf16 v[176:179], v[88:91], v[72:75], v[176:179]
v_mfma_f32_16x16x32_bf16 v[180:183], v[92:95], v[72:75], v[180:183]
v_mfma_f32_16x16x32_bf16 v[188:191], v[92:95], v[76:79], v[188:191]
v_mfma_f32_16x16x32_bf16 v[184:187], v[88:91], v[76:79], v[184:187]
v_mfma_f32_16x16x32_bf16 v[156:159], v[84:87], v[76:79], v[156:159]
v_mfma_f32_16x16x32_bf16 v[152:155], v[80:83], v[76:79], v[152:155]
s_waitcnt lgkmcnt(0)
s_barrier
v_mfma_f32_16x16x32_bf16 v[128:131], v[112:115], v[96:99], v[128:131]
ds_read_b128 v[32:35], v7 offset:32768
v_mfma_f32_16x16x32_bf16 v[132:135], v[116:119], v[96:99], v[132:135]
ds_read_b64_tr_b16 v[48:49], v13 offset:49152
v_mfma_f32_16x16x32_bf16 v[160:163], v[120:123], v[96:99], v[160:163]
ds_read_b64_tr_b16 v[50:51], v13 offset:53248
v_mfma_f32_16x16x32_bf16 v[164:167], v[124:127], v[96:99], v[164:167]
ds_read_b64_tr_b16 v[52:53], v14 offset:49152
v_mfma_f32_16x16x32_bf16 v[172:175], v[124:127], v[100:103], v[172:175]
ds_read_b64_tr_b16 v[54:55], v14 offset:53248
v_mfma_f32_16x16x32_bf16 v[168:171], v[120:123], v[100:103], v[168:171]
ds_read_b64_tr_b16 v[56:57], v15 offset:49152
v_mfma_f32_16x16x32_bf16 v[140:143], v[116:119], v[100:103], v[140:143]
ds_read_b64_tr_b16 v[58:59], v15 offset:53248
v_mfma_f32_16x16x32_bf16 v[136:139], v[112:115], v[100:103], v[136:139]
ds_read_b64_tr_b16 v[60:61], v16 offset:49152
v_mfma_f32_16x16x32_bf16 v[144:147], v[112:115], v[104:107], v[144:147]
ds_read_b64_tr_b16 v[62:63], v16 offset:53248
v_mfma_f32_16x16x32_bf16 v[148:151], v[116:119], v[104:107], v[148:151]
ds_read_b128 v[36:39], v7 offset:33792
v_mfma_f32_16x16x32_bf16 v[176:179], v[120:123], v[104:107], v[176:179]
ds_read_b128 v[40:43], v7 offset:34816
v_mfma_f32_16x16x32_bf16 v[180:183], v[124:127], v[104:107], v[180:183]
ds_read_b128 v[44:47], v7 offset:35840
v_mfma_f32_16x16x32_bf16 v[188:191], v[124:127], v[108:111], v[188:191]
ds_read_b128 v[64:67], v7 offset:40960
v_mfma_f32_16x16x32_bf16 v[184:187], v[120:123], v[108:111], v[184:187]
ds_read_b64_tr_b16 v[80:81], v13 offset:57344
v_mfma_f32_16x16x32_bf16 v[156:159], v[116:119], v[108:111], v[156:159]
ds_read_b64_tr_b16 v[82:83], v13 offset:61440
v_mfma_f32_16x16x32_bf16 v[152:155], v[112:115], v[108:111], v[152:155]
ds_read_b64_tr_b16 v[84:85], v14 offset:57344
v_mfma_f32_16x16x32_bf16 v[128:131], v[208:211], v[192:195], v[128:131]
ds_read_b64_tr_b16 v[86:87], v14 offset:61440
v_mfma_f32_16x16x32_bf16 v[132:135], v[212:215], v[192:195], v[132:135]
ds_read_b64_tr_b16 v[88:89], v15 offset:57344
v_mfma_f32_16x16x32_bf16 v[160:163], v[216:219], v[192:195], v[160:163]
ds_read_b64_tr_b16 v[90:91], v15 offset:61440
v_mfma_f32_16x16x32_bf16 v[164:167], v[220:223], v[192:195], v[164:167]
ds_read_b64_tr_b16 v[92:93], v16 offset:57344
v_mfma_f32_16x16x32_bf16 v[172:175], v[220:223], v[196:199], v[172:175]
ds_read_b64_tr_b16 v[94:95], v16 offset:61440
v_mfma_f32_16x16x32_bf16 v[168:171], v[216:219], v[196:199], v[168:171]
ds_read_b128 v[68:71], v7 offset:41984
v_mfma_f32_16x16x32_bf16 v[140:143], v[212:215], v[196:199], v[140:143]
ds_read_b128 v[72:75], v7 offset:43008
v_mfma_f32_16x16x32_bf16 v[136:139], v[208:211], v[196:199], v[136:139]
ds_read_b128 v[76:79], v7 offset:44032
v_mfma_f32_16x16x32_bf16 v[144:147], v[208:211], v[200:203], v[144:147]
v_mfma_f32_16x16x32_bf16 v[148:151], v[212:215], v[200:203], v[148:151]
v_mfma_f32_16x16x32_bf16 v[176:179], v[216:219], v[200:203], v[176:179]
v_mfma_f32_16x16x32_bf16 v[180:183], v[220:223], v[200:203], v[180:183]
v_mfma_f32_16x16x32_bf16 v[188:191], v[220:223], v[204:207], v[188:191]
v_mfma_f32_16x16x32_bf16 v[184:187], v[216:219], v[204:207], v[184:187]
v_mfma_f32_16x16x32_bf16 v[156:159], v[212:215], v[204:207], v[156:159]
v_mfma_f32_16x16x32_bf16 v[152:155], v[208:211], v[204:207], v[152:155]
s_waitcnt lgkmcnt(0)
s_barrier
v_mfma_f32_16x16x32_bf16 v[128:131], v[48:51], v[32:35], v[128:131]
ds_read_b128 v[96:99], v8 offset:0
v_mfma_f32_16x16x32_bf16 v[132:135], v[52:55], v[32:35], v[132:135]
ds_read_b64_tr_b16 v[112:113], v9 offset:0
v_mfma_f32_16x16x32_bf16 v[160:163], v[56:59], v[32:35], v[160:163]
ds_read_b64_tr_b16 v[114:115], v9 offset:4096
v_mfma_f32_16x16x32_bf16 v[164:167], v[60:63], v[32:35], v[164:167]
ds_read_b64_tr_b16 v[116:117], v10 offset:0
v_mfma_f32_16x16x32_bf16 v[172:175], v[60:63], v[36:39], v[172:175]
ds_read_b64_tr_b16 v[118:119], v10 offset:4096
v_mfma_f32_16x16x32_bf16 v[168:171], v[56:59], v[36:39], v[168:171]
ds_read_b64_tr_b16 v[120:121], v11 offset:0
v_mfma_f32_16x16x32_bf16 v[140:143], v[52:55], v[36:39], v[140:143]
ds_read_b64_tr_b16 v[122:123], v11 offset:4096
v_mfma_f32_16x16x32_bf16 v[136:139], v[48:51], v[36:39], v[136:139]
ds_read_b64_tr_b16 v[124:125], v12 offset:0
v_mfma_f32_16x16x32_bf16 v[144:147], v[48:51], v[40:43], v[144:147]
ds_read_b64_tr_b16 v[126:127], v12 offset:4096
v_mfma_f32_16x16x32_bf16 v[148:151], v[52:55], v[40:43], v[148:151]
ds_read_b128 v[100:103], v8 offset:1024
v_mfma_f32_16x16x32_bf16 v[176:179], v[56:59], v[40:43], v[176:179]
ds_read_b128 v[104:107], v8 offset:2048
v_mfma_f32_16x16x32_bf16 v[180:183], v[60:63], v[40:43], v[180:183]
ds_read_b128 v[108:111], v8 offset:3072
v_mfma_f32_16x16x32_bf16 v[188:191], v[60:63], v[44:47], v[188:191]
ds_read_b128 v[192:195], v8 offset:8192
v_mfma_f32_16x16x32_bf16 v[184:187], v[56:59], v[44:47], v[184:187]
ds_read_b64_tr_b16 v[208:209], v9 offset:8192
v_mfma_f32_16x16x32_bf16 v[156:159], v[52:55], v[44:47], v[156:159]
ds_read_b64_tr_b16 v[210:211], v9 offset:12288
v_mfma_f32_16x16x32_bf16 v[152:155], v[48:51], v[44:47], v[152:155]
ds_read_b64_tr_b16 v[212:213], v10 offset:8192
v_mfma_f32_16x16x32_bf16 v[128:131], v[80:83], v[64:67], v[128:131]
ds_read_b64_tr_b16 v[214:215], v10 offset:12288
v_mfma_f32_16x16x32_bf16 v[132:135], v[84:87], v[64:67], v[132:135]
ds_read_b64_tr_b16 v[216:217], v11 offset:8192
v_mfma_f32_16x16x32_bf16 v[160:163], v[88:91], v[64:67], v[160:163]
ds_read_b64_tr_b16 v[218:219], v11 offset:12288
v_mfma_f32_16x16x32_bf16 v[164:167], v[92:95], v[64:67], v[164:167]
ds_read_b64_tr_b16 v[220:221], v12 offset:8192
v_mfma_f32_16x16x32_bf16 v[172:175], v[92:95], v[68:71], v[172:175]
ds_read_b64_tr_b16 v[222:223], v12 offset:12288
v_mfma_f32_16x16x32_bf16 v[168:171], v[88:91], v[68:71], v[168:171]
ds_read_b128 v[196:199], v8 offset:9216
v_mfma_f32_16x16x32_bf16 v[140:143], v[84:87], v[68:71], v[140:143]
ds_read_b128 v[200:203], v8 offset:10240
v_mfma_f32_16x16x32_bf16 v[136:139], v[80:83], v[68:71], v[136:139]
ds_read_b128 v[204:207], v8 offset:11264
v_mfma_f32_16x16x32_bf16 v[144:147], v[80:83], v[72:75], v[144:147]
v_mfma_f32_16x16x32_bf16 v[148:151], v[84:87], v[72:75], v[148:151]
v_mfma_f32_16x16x32_bf16 v[176:179], v[88:91], v[72:75], v[176:179]
v_mfma_f32_16x16x32_bf16 v[180:183], v[92:95], v[72:75], v[180:183]
v_mfma_f32_16x16x32_bf16 v[188:191], v[92:95], v[76:79], v[188:191]
v_mfma_f32_16x16x32_bf16 v[184:187], v[88:91], v[76:79], v[184:187]
v_mfma_f32_16x16x32_bf16 v[156:159], v[84:87], v[76:79], v[156:159]
v_mfma_f32_16x16x32_bf16 v[152:155], v[80:83], v[76:79], v[152:155]
s_sub_u32 s41, s41, 1
s_cmp_lg_u32 s41, 0
s_cbranch_scc1 Lk4_115
s_waitcnt lgkmcnt(0)
s_barrier
v_mfma_f32_16x16x32_bf16 v[128:131], v[112:115], v[96:99], v[128:131]
ds_read_b128 v[32:35], v6 offset:16384
v_mfma_f32_16x16x32_bf16 v[132:135], v[116:119], v[96:99], v[132:135]
ds_read_b64_tr_b16 v[48:49], v224 offset:32768
v_mfma_f32_16x16x32_bf16 v[160:163], v[120:123], v[96:99], v[160:163]
ds_read_b64_tr_b16 v[50:51], v224 offset:34816
v_mfma_f32_16x16x32_bf16 v[164:167], v[124:127], v[96:99], v[164:167]
ds_read_b64_tr_b16 v[52:53], v225 offset:32768
v_mfma_f32_16x16x32_bf16 v[172:175], v[124:127], v[100:103], v[172:175]
ds_read_b64_tr_b16 v[54:55], v225 offset:34816
v_mfma_f32_16x16x32_bf16 v[168:171], v[120:123], v[100:103], v[168:171]
ds_read_b128 v[36:39], v6 offset:17408
v_mfma_f32_16x16x32_bf16 v[140:143], v[116:119], v[100:103], v[140:143]
ds_read_b128 v[40:43], v6 offset:18432
v_mfma_f32_16x16x32_bf16 v[136:139], v[112:115], v[100:103], v[136:139]
ds_read_b128 v[44:47], v6 offset:19456
v_mfma_f32_16x16x32_bf16 v[144:147], v[112:115], v[104:107], v[144:147]
ds_read_b128 v[64:67], v6 offset:24576
v_mfma_f32_16x16x32_bf16 v[148:151], v[116:119], v[104:107], v[148:151]
ds_read_b64_tr_b16 v[80:81], v224 offset:36864
v_mfma_f32_16x16x32_bf16 v[176:179], v[120:123], v[104:107], v[176:179]
ds_read_b64_tr_b16 v[82:83], v224 offset:38912
v_mfma_f32_16x16x32_bf16 v[180:183], v[124:127], v[104:107], v[180:183]
ds_read_b64_tr_b16 v[84:85], v225 offset:36864
v_mfma_f32_16x16x32_bf16 v[188:191], v[124:127], v[108:111], v[188:191]
ds_read_b64_tr_b16 v[86:87], v225 offset:38912
v_mfma_f32_16x16x32_bf16 v[184:187], v[120:123], v[108:111], v[184:187]
ds_read_b128 v[68:71], v6 offset:25600
v_mfma_f32_16x16x32_bf16 v[156:159], v[116:119], v[108:111], v[156:159]
ds_read_b128 v[72:75], v6 offset:26624
v_mfma_f32_16x16x32_bf16 v[152:155], v[112:115], v[108:111], v[152:155]
ds_read_b128 v[76:79], v6 offset:27648
v_mfma_f32_16x16x32_bf16 v[128:131], v[208:211], v[192:195], v[128:131]
v_mfma_f32_16x16x32_bf16 v[132:135], v[212:215], v[192:195], v[132:135]
v_mfma_f32_16x16x32_bf16 v[160:163], v[216:219], v[192:195], v[160:163]
v_mfma_f32_16x16x32_bf16 v[164:167], v[220:223], v[192:195], v[164:167]
v_mfma_f32_16x16x32_bf16 v[172:175], v[220:223], v[196:199], v[172:175]
v_mfma_f32_16x16x32_bf16 v[168:171], v[216:219], v[196:199], v[168:171]
v_mfma_f32_16x16x32_bf16 v[140:143], v[212:215], v[196:199], v[140:143]
v_mfma_f32_16x16x32_bf16 v[136:139], v[208:211], v[196:199], v[136:139]
v_mfma_f32_16x16x32_bf16 v[144:147], v[208:211], v[200:203], v[144:147]
v_mfma_f32_16x16x32_bf16 v[148:151], v[212:215], v[200:203], v[148:151]
v_mfma_f32_16x16x32_bf16 v[176:179], v[216:219], v[200:203], v[176:179]
v_mfma_f32_16x16x32_bf16 v[180:183], v[220:223], v[200:203], v[180:183]
v_mfma_f32_16x16x32_bf16 v[188:191], v[220:223], v[204:207], v[188:191]
v_mfma_f32_16x16x32_bf16 v[184:187], v[216:219], v[204:207], v[184:187]
v_mfma_f32_16x16x32_bf16 v[156:159], v[212:215], v[204:207], v[156:159]
v_mfma_f32_16x16x32_bf16 v[152:155], v[208:211], v[204:207], v[152:155]
s_waitcnt lgkmcnt(0)
s_barrier
v_mfma_f32_16x16x32_bf16 v[128:131], v[48:51], v[32:35], v[128:131]
ds_read_b128 v[96:99], v6 offset:49152
ds_read_b64_tr_b16 v[112:113], v226 offset:0
v_mfma_f32_16x16x32_bf16 v[132:135], v[52:55], v[32:35], v[132:135]
ds_read_b64_tr_b16 v[114:115], v226 offset:2048
ds_read_b64_tr_b16 v[116:117], v227 offset:0
v_mfma_f32_16x16x32_bf16 v[140:143], v[52:55], v[36:39], v[140:143]
ds_read_b64_tr_b16 v[118:119], v227 offset:2048
ds_read_b128 v[100:103], v6 offset:50176
v_mfma_f32_16x16x32_bf16 v[136:139], v[48:51], v[36:39], v[136:139]
ds_read_b128 v[104:107], v6 offset:51200
ds_read_b128 v[108:111], v6 offset:52224
v_mfma_f32_16x16x32_bf16 v[144:147], v[48:51], v[40:43], v[144:147]
ds_read_b128 v[192:195], v6 offset:57344
v_mfma_f32_16x16x32_bf16 v[148:151], v[52:55], v[40:43], v[148:151]
ds_read_b64_tr_b16 v[208:209], v226 offset:4096
v_mfma_f32_16x16x32_bf16 v[156:159], v[52:55], v[44:47], v[156:159]
ds_read_b64_tr_b16 v[210:211], v226 offset:6144
v_cvt_pk_bf16_f32 v160, v160, v161
v_cvt_pk_bf16_f32 v161, v162, v163
v_mfma_f32_16x16x32_bf16 v[152:155], v[48:51], v[44:47], v[152:155]
ds_read_b64_tr_b16 v[212:213], v227 offset:4096
v_cvt_pk_bf16_f32 v162, v164, v165
v_cvt_pk_bf16_f32 v163, v166, v167
v_mfma_f32_16x16x32_bf16 v[128:131], v[80:83], v[64:67], v[128:131]
ds_read_b64_tr_b16 v[214:215], v227 offset:6144
v_cvt_pk_bf16_f32 v164, v168, v169
v_cvt_pk_bf16_f32 v165, v170, v171
v_mfma_f32_16x16x32_bf16 v[132:135], v[84:87], v[64:67], v[132:135]
ds_read_b128 v[196:199], v6 offset:58368
v_cvt_pk_bf16_f32 v166, v172, v173
v_cvt_pk_bf16_f32 v167, v174, v175
v_mfma_f32_16x16x32_bf16 v[140:143], v[84:87], v[68:71], v[140:143]
ds_read_b128 v[200:203], v6 offset:59392
v_cvt_pk_bf16_f32 v168, v176, v177
v_cvt_pk_bf16_f32 v169, v178, v179
v_mfma_f32_16x16x32_bf16 v[136:139], v[80:83], v[68:71], v[136:139]
ds_read_b128 v[204:207], v6 offset:60416
v_cvt_pk_bf16_f32 v170, v180, v181
v_cvt_pk_bf16_f32 v171, v182, v183
v_mfma_f32_16x16x32_bf16 v[144:147], v[80:83], v[72:75], v[144:147]
v_cvt_pk_bf16_f32 v172, v184, v185
v_cvt_pk_bf16_f32 v173, v186, v187
v_mfma_f32_16x16x32_bf16 v[148:151], v[84:87], v[72:75], v[148:151]
v_cvt_pk_bf16_f32 v174, v188, v189
v_cvt_pk_bf16_f32 v175, v190, v191
v_mfma_f32_16x16x32_bf16 v[156:159], v[84:87], v[76:79], v[156:159]
v_mfma_f32_16x16x32_bf16 v[152:155], v[80:83], v[76:79], v[152:155]
buffer_store_dwordx4 v[160:163], v2, s[84:87], s45 offen offset:0 sc1
s_waitcnt lgkmcnt(0)
s_barrier
v_mfma_f32_16x16x32_bf16 v[128:131], v[112:115], v[96:99], v[128:131]
ds_read_b128 v[32:35], v7 offset:16384
ds_read_b64_tr_b16 v[48:49], v228 offset:16384
v_mfma_f32_16x16x32_bf16 v[132:135], v[116:119], v[96:99], v[132:135]
ds_read_b64_tr_b16 v[50:51], v228 offset:18432
ds_read_b64_tr_b16 v[52:53], v229 offset:16384
v_mfma_f32_16x16x32_bf16 v[140:143], v[116:119], v[100:103], v[140:143]
ds_read_b64_tr_b16 v[54:55], v229 offset:18432
ds_read_b128 v[36:39], v7 offset:17408
v_mfma_f32_16x16x32_bf16 v[136:139], v[112:115], v[100:103], v[136:139]
ds_read_b128 v[40:43], v7 offset:18432
ds_read_b128 v[44:47], v7 offset:19456
v_mfma_f32_16x16x32_bf16 v[144:147], v[112:115], v[104:107], v[144:147]
ds_read_b128 v[64:67], v7 offset:24576
v_mfma_f32_16x16x32_bf16 v[148:151], v[116:119], v[104:107], v[148:151]
ds_read_b64_tr_b16 v[80:81], v228 offset:20480
v_mfma_f32_16x16x32_bf16 v[156:159], v[116:119], v[108:111], v[156:159]
ds_read_b64_tr_b16 v[82:83], v228 offset:22528
v_mfma_f32_16x16x32_bf16 v[152:155], v[112:115], v[108:111], v[152:155]
ds_read_b64_tr_b16 v[84:85], v229 offset:20480
v_mfma_f32_16x16x32_bf16 v[128:131], v[208:211], v[192:195], v[128:131]
ds_read_b64_tr_b16 v[86:87], v229 offset:22528
buffer_store_dwordx4 v[164:167], v2, s[84:87], s45 offen offset:1024 sc1
v_mfma_f32_16x16x32_bf16 v[132:135], v[212:215], v[192:195], v[132:135]
ds_read_b128 v[68:71], v7 offset:25600
v_mfma_f32_16x16x32_bf16 v[140:143], v[212:215], v[196:199], v[140:143]
ds_read_b128 v[72:75], v7 offset:26624
v_mfma_f32_16x16x32_bf16 v[136:139], v[208:211], v[196:199], v[136:139]
ds_read_b128 v[76:79], v7 offset:27648
v_mfma_f32_16x16x32_bf16 v[144:147], v[208:211], v[200:203], v[144:147]
v_mfma_f32_16x16x32_bf16 v[148:151], v[212:215], v[200:203], v[148:151]
v_mfma_f32_16x16x32_bf16 v[156:159], v[212:215], v[204:207], v[156:159]
v_mfma_f32_16x16x32_bf16 v[152:155], v[208:211], v[204:207], v[152:155]
s_waitcnt lgkmcnt(0)
s_barrier
v_mfma_f32_16x16x32_bf16 v[128:131], v[48:51], v[32:35], v[128:131]
ds_read_b128 v[96:99], v7 offset:32768
ds_read_b64_tr_b16 v[112:113], v226 offset:49152
v_mfma_f32_16x16x32_bf16 v[132:135], v[52:55], v[32:35], v[132:135]
ds_read_b64_tr_b16 v[114:115], v226 offset:51200
ds_read_b64_tr_b16 v[116:117], v227 offset:49152
v_mfma_f32_16x16x32_bf16 v[140:143], v[52:55], v[36:39], v[140:143]
ds_read_b64_tr_b16 v[118:119], v227 offset:51200
ds_read_b128 v[100:103], v7 offset:33792
v_mfma_f32_16x16x32_bf16 v[136:139], v[48:51], v[36:39], v[136:139]
ds_read_b128 v[104:107], v7 offset:34816
ds_read_b128 v[108:111], v7 offset:35840
v_mfma_f32_16x16x32_bf16 v[144:147], v[48:51], v[40:43], v[144:147]
ds_read_b128 v[192:195], v7 offset:40960
v_mfma_f32_16x16x32_bf16 v[148:151], v[52:55], v[40:43], v[148:151]
ds_read_b64_tr_b16 v[208:209], v226 offset:53248
v_mfma_f32_16x16x32_bf16 v[156:159], v[52:55], v[44:47], v[156:159]
ds_read_b64_tr_b16 v[210:211], v226 offset:55296
v_mfma_f32_16x16x32_bf16 v[152:155], v[48:51], v[44:47], v[152:155]
ds_read_b64_tr_b16 v[212:213], v227 offset:53248
v_mfma_f32_16x16x32_bf16 v[128:131], v[80:83], v[64:67], v[128:131]
ds_read_b64_tr_b16 v[214:215], v227 offset:55296
buffer_store_dwordx4 v[168:171], v2, s[84:87], s45 offen offset:2048 sc1
v_mfma_f32_16x16x32_bf16 v[132:135], v[84:87], v[64:67], v[132:135]
ds_read_b128 v[196:199], v7 offset:41984
v_mfma_f32_16x16x32_bf16 v[140:143], v[84:87], v[68:71], v[140:143]
ds_read_b128 v[200:203], v7 offset:43008
v_mfma_f32_16x16x32_bf16 v[136:139], v[80:83], v[68:71], v[136:139]
ds_read_b128 v[204:207], v7 offset:44032
v_mfma_f32_16x16x32_bf16 v[144:147], v[80:83], v[72:75], v[144:147]
v_mfma_f32_16x16x32_bf16 v[148:151], v[84:87], v[72:75], v[148:151]
v_mfma_f32_16x16x32_bf16 v[156:159], v[84:87], v[76:79], v[156:159]
v_mfma_f32_16x16x32_bf16 v[152:155], v[80:83], v[76:79], v[152:155]
s_waitcnt lgkmcnt(0)
s_barrier
v_mfma_f32_16x16x32_bf16 v[128:131], v[112:115], v[96:99], v[128:131]
ds_read_b128 v[32:35], v8 offset:0
ds_read_b64_tr_b16 v[48:49], v224 offset:0
v_mfma_f32_16x16x32_bf16 v[132:135], v[116:119], v[96:99], v[132:135]
ds_read_b64_tr_b16 v[50:51], v224 offset:2048
ds_read_b64_tr_b16 v[52:53], v225 offset:0
v_mfma_f32_16x16x32_bf16 v[140:143], v[116:119], v[100:103], v[140:143]
ds_read_b64_tr_b16 v[54:55], v225 offset:2048
s_branch Lov_12
.p2align 12
Lst_12_0:
s_branch Lwr_151
Lst_12_1:
s_branch Lst_16_0
s_nop 0
Lov_12:
ds_read_b128 v[36:39], v8 offset:1024
v_mfma_f32_16x16x32_bf16 v[136:139], v[112:115], v[100:103], v[136:139]
ds_read_b128 v[40:43], v8 offset:2048
ds_read_b128 v[44:47], v8 offset:3072
v_mfma_f32_16x16x32_bf16 v[144:147], v[112:115], v[104:107], v[144:147]
ds_read_b128 v[64:67], v8 offset:8192
v_mfma_f32_16x16x32_bf16 v[148:151], v[116:119], v[104:107], v[148:151]
ds_read_b64_tr_b16 v[80:81], v224 offset:4096
v_mfma_f32_16x16x32_bf16 v[156:159], v[116:119], v[108:111], v[156:159]
ds_read_b64_tr_b16 v[82:83], v224 offset:6144
v_mfma_f32_16x16x32_bf16 v[152:155], v[112:115], v[108:111], v[152:155]
ds_read_b64_tr_b16 v[84:85], v225 offset:4096
v_mfma_f32_16x16x32_bf16 v[128:131], v[208:211], v[192:195], v[128:131]
ds_read_b64_tr_b16 v[86:87], v225 offset:6144
buffer_store_dwordx4 v[172:175], v2, s[84:87], s45 offen offset:3072 sc1
v_mfma_f32_16x16x32_bf16 v[132:135], v[212:215], v[192:195], v[132:135]
ds_read_b128 v[68:71], v8 offset:9216
v_mfma_f32_16x16x32_bf16 v[140:143], v[212:215], v[196:199], v[140:143]
ds_read_b128 v[72:75], v8 offset:10240
v_mfma_f32_16x16x32_bf16 v[136:139], v[208:211], v[196:199], v[136:139]
ds_read_b128 v[76:79], v8 offset:11264
v_mfma_f32_16x16x32_bf16 v[144:147], v[208:211], v[200:203], v[144:147]
v_mfma_f32_16x16x32_bf16 v[148:151], v[212:215], v[200:203], v[148:151]
v_mfma_f32_16x16x32_bf16 v[156:159], v[212:215], v[204:207], v[156:159]
v_mfma_f32_16x16x32_bf16 v[152:155], v[208:211], v[204:207], v[152:155]
s_waitcnt lgkmcnt(0)
s_barrier
v_mfma_f32_16x16x32_bf16 v[128:131], v[48:51], v[32:35], v[128:131]
ds_read_b128 v[96:99], v6 offset:16384
ds_read_b64_tr_b16 v[112:113], v224 offset:32768
v_mfma_f32_16x16x32_bf16 v[132:135], v[52:55], v[32:35], v[132:135]
ds_read_b64_tr_b16 v[114:115], v224 offset:34816
ds_read_b64_tr_b16 v[116:117], v225 offset:32768
v_mfma_f32_16x16x32_bf16 v[140:143], v[52:55], v[36:39], v[140:143]
ds_read_b64_tr_b16 v[118:119], v225 offset:34816
ds_read_b128 v[100:103], v6 offset:17408
v_mfma_f32_16x16x32_bf16 v[136:139], v[48:51], v[36:39], v[136:139]
ds_read_b128 v[104:107], v6 offset:18432
ds_read_b128 v[108:111], v6 offset:19456
v_mfma_f32_16x16x32_bf16 v[144:147], v[48:51], v[40:43], v[144:147]
ds_read_b128 v[192:195], v6 offset:24576
v_mfma_f32_16x16x32_bf16 v[148:151], v[52:55], v[40:43], v[148:151]
ds_read_b64_tr_b16 v[208:209], v224 offset:36864
v_mfma_f32_16x16x32_bf16 v[156:159], v[52:55], v[44:47], v[156:159]
ds_read_b64_tr_b16 v[210:211], v224 offset:38912
v_mfma_f32_16x16x32_bf16 v[152:155], v[48:51], v[44:47], v[152:155]
ds_read_b64_tr_b16 v[212:213], v225 offset:36864
v_mfma_f32_16x16x32_bf16 v[128:131], v[80:83], v[64:67], v[128:131]
ds_read_b64_tr_b16 v[214:215], v225 offset:38912
v_mfma_f32_16x16x32_bf16 v[132:135], v[84:87], v[64:67], v[132:135]
ds_read_b128 v[196:199], v6 offset:25600
v_mfma_f32_16x16x32_bf16 v[140:143], v[84:87], v[68:71], v[140:143]
ds_read_b128 v[200:203], v6 offset:26624
v_mfma_f32_16x16x32_bf16 v[136:139], v[80:83], v[68:71], v[136:139]
ds_read_b128 v[204:207], v6 offset:27648
v_mfma_f32_16x16x32_bf16 v[144:147], v[80:83], v[72:75], v[144:147]
v_mfma_f32_16x16x32_bf16 v[148:151], v[84:87], v[72:75], v[148:151]
v_mfma_f32_16x16x32_bf16 v[156:159], v[84:87], v[76:79], v[156:159]
v_mfma_f32_16x16x32_bf16 v[152:155], v[80:83], v[76:79], v[152:155]
s_waitcnt vmcnt(0)
s_waitcnt lgkmcnt(0)
s_barrier
v_mfma_f32_16x16x32_bf16 v[128:131], v[112:115], v[96:99], v[128:131]
ds_read_b128 v[32:35], v6 offset:49152
ds_read_b64_tr_b16 v[48:49], v226 offset:0
v_mfma_f32_16x16x32_bf16 v[132:135], v[116:119], v[96:99], v[132:135]
ds_read_b64_tr_b16 v[50:51], v226 offset:2048
ds_read_b64_tr_b16 v[52:53], v227 offset:0
v_mfma_f32_16x16x32_bf16 v[140:143], v[116:119], v[100:103], v[140:143]
ds_read_b64_tr_b16 v[54:55], v227 offset:2048
ds_read_b128 v[36:39], v6 offset:50176
v_mfma_f32_16x16x32_bf16 v[136:139], v[112:115], v[100:103], v[136:139]
ds_read_b128 v[40:43], v6 offset:51200
ds_read_b128 v[44:47], v6 offset:52224
v_mfma_f32_16x16x32_bf16 v[144:147], v[112:115], v[104:107], v[144:147]
ds_read_b128 v[64:67], v6 offset:57344
v_mfma_f32_16x16x32_bf16 v[148:151], v[116:119], v[104:107], v[148:151]
ds_read_b64_tr_b16 v[80:81], v226 offset:4096
v_mfma_f32_16x16x32_bf16 v[156:159], v[116:119], v[108:111], v[156:159]
ds_read_b64_tr_b16 v[82:83], v226 offset:6144
v_mfma_f32_16x16x32_bf16 v[152:155], v[112:115], v[108:111], v[152:155]
ds_read_b64_tr_b16 v[84:85], v227 offset:4096
v_mfma_f32_16x16x32_bf16 v[128:131], v[208:211], v[192:195], v[128:131]
ds_read_b64_tr_b16 v[86:87], v227 offset:6144
v_mfma_f32_16x16x32_bf16 v[132:135], v[212:215], v[192:195], v[132:135]
ds_read_b128 v[68:71], v6 offset:58368
v_mfma_f32_16x16x32_bf16 v[140:143], v[212:215], v[196:199], v[140:143]
ds_read_b128 v[72:75], v6 offset:59392
v_mfma_f32_16x16x32_bf16 v[136:139], v[208:211], v[196:199], v[136:139]
ds_read_b128 v[76:79], v6 offset:60416
v_mfma_f32_16x16x32_bf16 v[144:147], v[208:211], v[200:203], v[144:147]
v_mfma_f32_16x16x32_bf16 v[148:151], v[212:215], v[200:203], v[148:151]
v_mfma_f32_16x16x32_bf16 v[156:159], v[212:215], v[204:207], v[156:159]
v_mfma_f32_16x16x32_bf16 v[152:155], v[208:211], v[204:207], v[152:155]
s_waitcnt lgkmcnt(0)
s_barrier
v_mfma_f32_16x16x32_bf16 v[128:131], v[48:51], v[32:35], v[128:131]
ds_read_b128 v[96:99], v7 offset:16384
ds_read_b64_tr_b16 v[112:113], v228 offset:16384
v_mfma_f32_16x16x32_bf16 v[132:135], v[52:55], v[32:35], v[132:135]
ds_read_b64_tr_b16 v[114:115], v228 offset:18432
ds_read_b64_tr_b16 v[116:117], v229 offset:16384
v_mfma_f32_16x16x32_bf16 v[140:143], v[52:55], v[36:39], v[140:143]
ds_read_b64_tr_b16 v[118:119], v229 offset:18432
ds_read_b128 v[100:103], v7 offset:17408
v_mfma_f32_16x16x32_bf16 v[136:139], v[48:51], v[36:39], v[136:139]
ds_read_b128 v[104:107], v7 offset:18432
ds_read_b128 v[108:111], v7 offset:19456
v_mfma_f32_16x16x32_bf16 v[144:147], v[48:51], v[40:43], v[144:147]
ds_read_b128 v[192:195], v7 offset:24576
v_mfma_f32_16x16x32_bf16 v[148:151], v[52:55], v[40:43], v[148:151]
ds_read_b64_tr_b16 v[208:209], v228 offset:20480
v_mfma_f32_16x16x32_bf16 v[156:159], v[52:55], v[44:47], v[156:159]
ds_read_b64_tr_b16 v[210:211], v228 offset:22528
v_mfma_f32_16x16x32_bf16 v[152:155], v[48:51], v[44:47], v[152:155]
ds_read_b64_tr_b16 v[212:213], v229 offset:20480
v_mfma_f32_16x16x32_bf16 v[128:131], v[80:83], v[64:67], v[128:131]
ds_read_b64_tr_b16 v[214:215], v229 offset:22528
v_mfma_f32_16x16x32_bf16 v[132:135], v[84:87], v[64:67], v[132:135]
ds_read_b128 v[196:199], v7 offset:25600
v_mfma_f32_16x16x32_bf16 v[140:143], v[84:87], v[68:71], v[140:143]
ds_read_b128 v[200:203], v7 offset:26624
v_mfma_f32_16x16x32_bf16 v[136:139], v[80:83], v[68:71], v[136:139]
ds_read_b128 v[204:207], v7 offset:27648
v_mfma_f32_16x16x32_bf16 v[144:147], v[80:83], v[72:75], v[144:147]
v_mfma_f32_16x16x32_bf16 v[148:151], v[84:87], v[72:75], v[148:151]
v_mfma_f32_16x16x32_bf16 v[156:159], v[84:87], v[76:79], v[156:159]
v_mfma_f32_16x16x32_bf16 v[152:155], v[80:83], v[76:79], v[152:155]
s_waitcnt lgkmcnt(0)
s_barrier
v_mfma_f32_16x16x32_bf16 v[128:131], v[112:115], v[96:99], v[128:131]
ds_read_b128 v[32:35], v7 offset:32768
ds_read_b64_tr_b16 v[48:49], v226 offset:49152
v_mfma_f32_16x16x32_bf16 v[132:135], v[116:119], v[96:99], v[132:135]
ds_read_b64_tr_b16 v[50:51], v226 offset:51200
ds_read_b64_tr_b16 v[52:53], v227 offset:49152
v_mfma_f32_16x16x32_bf16 v[140:143], v[116:119], v[100:103], v[140:143]
ds_read_b64_tr_b16 v[54:55], v227 offset:51200
ds_read_b128 v[36:39], v7 offset:33792
v_mfma_f32_16x16x32_bf16 v[136:139], v[112:115], v[100:103], v[136:139]
ds_read_b128 v[40:43], v7 offset:34816
ds_read_b128 v[44:47], v7 offset:35840
v_mfma_f32_16x16x32_bf16 v[144:147], v[112:115], v[104:107], v[144:147]
ds_read_b128 v[64:67], v7 offset:40960
v_mfma_f32_16x16x32_bf16 v[148:151], v[116:119], v[104:107], v[148:151]
ds_read_b64_tr_b16 v[80:81], v226 offset:53248
v_mfma_f32_16x16x32_bf16 v[156:159], v[116:119], v[108:111], v[156:159]
ds_read_b64_tr_b16 v[82:83], v226 offset:55296
v_mfma_f32_16x16x32_bf16 v[152:155], v[112:115], v[108:111], v[152:155]
ds_read_b64_tr_b16 v[84:85], v227 offset:53248
v_mfma_f32_16x16x32_bf16 v[128:131], v[208:211], v[192:195], v[128:131]
ds_read_b64_tr_b16 v[86:87], v227 offset:55296
v_mfma_f32_16x16x32_bf16 v[132:135], v[212:215], v[192:195], v[132:135]
ds_read_b128 v[68:71], v7 offset:41984
v_mfma_f32_16x16x32_bf16 v[140:143], v[212:215], v[196:199], v[140:143]
ds_read_b128 v[72:75], v7 offset:43008
v_mfma_f32_16x16x32_bf16 v[136:139], v[208:211], v[196:199], v[136:139]
ds_read_b128 v[76:79], v7 offset:44032
v_mfma_f32_16x16x32_bf16 v[144:147], v[208:211], v[200:203], v[144:147]
v_mfma_f32_16x16x32_bf16 v[148:151], v[212:215], v[200:203], v[148:151]
v_mfma_f32_16x16x32_bf16 v[156:159], v[212:215], v[204:207], v[156:159]
v_mfma_f32_16x16x32_bf16 v[152:155], v[208:211], v[204:207], v[152:155]
s_waitcnt lgkmcnt(0)
s_barrier
buffer_load_dwordx4 v[232:235], v2, s[84:87], s46 offen offset:0 sc1
buffer_load_dwordx4 v[236:239], v2, s[84:87], s46 offen offset:1024 sc1
buffer_load_dwordx4 v[240:243], v2, s[84:87], s46 offen offset:2048 sc1
buffer_load_dwordx4 v[244:247], v2, s[84:87], s46 offen offset:3072 sc1
v_mfma_f32_16x16x32_bf16 v[128:131], v[48:51], v[32:35], v[128:131]
ds_read_b128 v[96:99], v8 offset:0
ds_read_b64_tr_b16 v[112:113], v224 offset:0
v_mfma_f32_16x16x32_bf16 v[132:135], v[52:55], v[32:35], v[132:135]
ds_read_b64_tr_b16 v[114:115], v224 offset:2048
ds_read_b64_tr_b16 v[116:117], v225 offset:0
v_mfma_f32_16x16x32_bf16 v[140:143], v[52:55], v[36:39], v[140:143]
ds_read_b64_tr_b16 v[118:119], v225 offset:2048
ds_read_b128 v[100:103], v8 offset:1024
v_mfma_f32_16x16x32_bf16 v[136:139], v[48:51], v[36:39], v[136:139]
ds_read_b128 v[104:107], v8 offset:2048
ds_read_b128 v[108:111], v8 offset:3072
v_mfma_f32_16x16x32_bf16 v[144:147], v[48:51], v[40:43], v[144:147]
ds_read_b128 v[192:195], v8 offset:8192
v_mfma_f32_16x16x32_bf16 v[148:151], v[52:55], v[40:43], v[148:151]
ds_read_b64_tr_b16 v[208:209], v224 offset:4096
v_mfma_f32_16x16x32_bf16 v[156:159], v[52:55], v[44:47], v[156:159]
ds_read_b64_tr_b16 v[210:211], v224 offset:6144
v_mfma_f32_16x16x32_bf16 v[152:155], v[48:51], v[44:47], v[152:155]
ds_read_b64_tr_b16 v[212:213], v225 offset:4096
v_mfma_f32_16x16x32_bf16 v[128:131], v[80:83], v[64:67], v[128:131]
ds_read_b64_tr_b16 v[214:215], v225 offset:6144
v_mfma_f32_16x16x32_bf16 v[132:135], v[84:87], v[64:67], v[132:135]
ds_read_b128 v[196:199], v8 offset:9216
v_mfma_f32_16x16x32_bf16 v[140:143], v[84:87], v[68:71], v[140:143]
ds_read_b128 v[200:203], v8 offset:10240
v_mfma_f32_16x16x32_bf16 v[136:139], v[80:83], v[68:71], v[136:139]
ds_read_b128 v[204:207], v8 offset:11264
v_mfma_f32_16x16x32_bf16 v[144:147], v[80:83], v[72:75], v[144:147]
v_mfma_f32_16x16x32_bf16 v[148:151], v[84:87], v[72:75], v[148:151]
v_mfma_f32_16x16x32_bf16 v[156:159], v[84:87], v[76:79], v[156:159]
v_mfma_f32_16x16x32_bf16 v[152:155], v[80:83], v[76:79], v[152:155]
s_waitcnt lgkmcnt(0)
s_barrier
v_mfma_f32_16x16x32_bf16 v[128:131], v[112:115], v[96:99], v[128:131]
ds_read_b128 v[32:35], v6 offset:16384
ds_read_b64_tr_b16 v[48:49], v224 offset:32768
v_mfma_f32_16x16x32_bf16 v[132:135], v[116:119], v[96:99], v[132:135]
ds_read_b64_tr_b16 v[50:51], v224 offset:34816
ds_read_b64_tr_b16 v[52:53], v225 offset:32768
v_mfma_f32_16x16x32_bf16 v[140:143], v[116:119], v[100:103], v[140:143]
ds_read_b64_tr_b16 v[54:55], v225 offset:34816
ds_read_b128 v[36:39], v6 offset:17408
v_mfma_f32_16x16x32_bf16 v[136:139], v[112:115], v[100:103], v[136:139]
ds_read_b128 v[40:43], v6 offset:18432
ds_read_b128 v[44:47], v6 offset:19456
v_mfma_f32_16x16x32_bf16 v[144:147], v[112:115], v[104:107], v[144:147]
ds_read_b128 v[64:67], v6 offset:24576
v_mfma_f32_16x16x32_bf16 v[148:151], v[116:119], v[104:107], v[148:151]
ds_read_b64_tr_b16 v[80:81], v224 offset:36864
v_mfma_f32_16x16x32_bf16 v[156:159], v[116:119], v[108:111], v[156:159]
ds_read_b64_tr_b16 v[82:83], v224 offset:38912
v_mfma_f32_16x16x32_bf16 v[152:155], v[112:115], v[108:111], v[152:155]
ds_read_b64_tr_b16 v[84:85], v225 offset:36864
v_mfma_f32_16x16x32_bf16 v[128:131], v[208:211], v[192:195], v[128:131]
ds_read_b64_tr_b16 v[86:87], v225 offset:38912
v_mfma_f32_16x16x32_bf16 v[132:135], v[212:215], v[192:195], v[132:135]
ds_read_b128 v[68:71], v6 offset:25600
v_mfma_f32_16x16x32_bf16 v[140:143], v[212:215], v[196:199], v[140:143]
ds_read_b128 v[72:75], v6 offset:26624
v_mfma_f32_16x16x32_bf16 v[136:139], v[208:211], v[196:199], v[136:139]
ds_read_b128 v[76:79], v6 offset:27648
v_mfma_f32_16x16x32_bf16 v[144:147], v[208:211], v[200:203], v[144:147]
v_mfma_f32_16x16x32_bf16 v[148:151], v[212:215], v[200:203], v[148:151]
v_mfma_f32_16x16x32_bf16 v[156:159], v[212:215], v[204:207], v[156:159]
v_mfma_f32_16x16x32_bf16 v[152:155], v[208:211], v[204:207], v[152:155]
s_waitcnt lgkmcnt(0)
s_barrier
v_mfma_f32_16x16x32_bf16 v[128:131], v[48:51], v[32:35], v[128:131]
ds_read_b128 v[96:99], v6 offset:49152
ds_read_b64_tr_b16 v[112:113], v226 offset:0
v_mfma_f32_16x16x32_bf16 v[132:135], v[52:55], v[32:35], v[132:135]
ds_read_b64_tr_b16 v[114:115], v226 offset:2048
ds_read_b64_tr_b16 v[116:117], v227 offset:0
v_mfma_f32_16x16x32_bf16 v[140:143], v[52:55], v[36:39], v[140:143]
ds_read_b64_tr_b16 v[118:119], v227 offset:2048
ds_read_b128 v[100:103], v6 offset:50176
v_mfma_f32_16x16x32_bf16 v[136:139], v[48:51], v[36:39], v[136:139]
ds_read_b128 v[104:107], v6 offset:51200
ds_read_b128 v[108:111], v6 offset:52224
v_mfma_f32_16x16x32_bf16 v[144:147], v[48:51], v[40:43], v[144:147]
ds_read_b128 v[192:195], v6 offset:57344
v_mfma_f32_16x16x32_bf16 v[148:151], v[52:55], v[40:43], v[148:151]
ds_read_b64_tr_b16 v[208:209], v226 offset:4096
v_mfma_f32_16x16x32_bf16 v[156:159], v[52:55], v[44:47], v[156:159]
ds_read_b64_tr_b16 v[210:211], v226 offset:6144
v_mfma_f32_16x16x32_bf16 v[152:155], v[48:51], v[44:47], v[152:155]
ds_read_b64_tr_b16 v[212:213], v227 offset:4096
v_mfma_f32_16x16x32_bf16 v[128:131], v[80:83], v[64:67], v[128:131]
ds_read_b64_tr_b16 v[214:215], v227 offset:6144
v_mfma_f32_16x16x32_bf16 v[132:135], v[84:87], v[64:67], v[132:135]
ds_read_b128 v[196:199], v6 offset:58368
v_mfma_f32_16x16x32_bf16 v[140:143], v[84:87], v[68:71], v[140:143]
ds_read_b128 v[200:203], v6 offset:59392
v_mfma_f32_16x16x32_bf16 v[136:139], v[80:83], v[68:71], v[136:139]
ds_read_b128 v[204:207], v6 offset:60416
v_mfma_f32_16x16x32_bf16 v[144:147], v[80:83], v[72:75], v[144:147]
v_mfma_f32_16x16x32_bf16 v[148:151], v[84:87], v[72:75], v[148:151]
v_mfma_f32_16x16x32_bf16 v[156:159], v[84:87], v[76:79], v[156:159]
v_mfma_f32_16x16x32_bf16 v[152:155], v[80:83], v[76:79], v[152:155]
s_waitcnt vmcnt(0)
s_waitcnt lgkmcnt(0)
s_barrier
v_mfma_f32_16x16x32_bf16 v[128:131], v[112:115], v[96:99], v[128:131]
v_lshlrev_b32 v160, 16, v232
v_and_b32 v161, 0xffff0000, v232
v_mfma_f32_16x16x32_bf16 v[132:135], v[116:119], v[96:99], v[132:135]
v_lshlrev_b32 v162, 16, v233
v_and_b32 v163, 0xffff0000, v233
v_mfma_f32_16x16x32_bf16 v[140:143], v[116:119], v[100:103], v[140:143]
v_lshlrev_b32 v164, 16, v234
v_and_b32 v165, 0xffff0000, v234
v_mfma_f32_16x16x32_bf16 v[136:139], v[112:115], v[100:103], v[136:139]
v_lshlrev_b32 v166, 16, v235
v_and_b32 v167, 0xffff0000, v235
v_mfma_f32_16x16x32_bf16 v[144:147], v[112:115], v[104:107], v[144:147]
v_lshlrev_b32 v168, 16, v236
v_and_b32 v169, 0xffff0000, v236
v_mfma_f32_16x16x32_bf16 v[148:151], v[116:119], v[104:107], v[148:151]
v_lshlrev_b32 v170, 16, v237
v_and_b32 v171, 0xffff0000, v237
v_mfma_f32_16x16x32_bf16 v[156:159], v[116:119], v[108:111], v[156:159]
v_lshlrev_b32 v172, 16, v238
v_and_b32 v173, 0xffff0000, v238
v_mfma_f32_16x16x32_bf16 v[152:155], v[112:115], v[108:111], v[152:155]
v_lshlrev_b32 v174, 16, v239
v_and_b32 v175, 0xffff0000, v239
v_mfma_f32_16x16x32_bf16 v[128:131], v[208:211], v[192:195], v[128:131]
v_lshlrev_b32 v176, 16, v240
v_and_b32 v177, 0xffff0000, v240
v_mfma_f32_16x16x32_bf16 v[132:135], v[212:215], v[192:195], v[132:135]
v_lshlrev_b32 v178, 16, v241
v_and_b32 v179, 0xffff0000, v241
v_mfma_f32_16x16x32_bf16 v[140:143], v[212:215], v[196:199], v[140:143]
v_lshlrev_b32 v180, 16, v242
v_and_b32 v181, 0xffff0000, v242
v_mfma_f32_16x16x32_bf16 v[136:139], v[208:211], v[196:199], v[136:139]
v_lshlrev_b32 v182, 16, v243
v_and_b32 v183, 0xffff0000, v243
v_mfma_f32_16x16x32_bf16 v[144:147], v[208:211], v[200:203], v[144:147]
v_lshlrev_b32 v184, 16, v244
v_and_b32 v185, 0xffff0000, v244
v_mfma_f32_16x16x32_bf16 v[148:151], v[212:215], v[200:203], v[148:151]
v_lshlrev_b32 v186, 16, v245
v_and_b32 v187, 0xffff0000, v245
v_mfma_f32_16x16x32_bf16 v[156:159], v[212:215], v[204:207], v[156:159]
v_lshlrev_b32 v188, 16, v246
v_and_b32 v189, 0xffff0000, v246
v_mfma_f32_16x16x32_bf16 v[152:155], v[208:211], v[204:207], v[152:155]
v_lshlrev_b32 v190, 16, v247
v_and_b32 v191, 0xffff0000, v247
s_nop 1
v_pk_add_f32 v[128:129], v[128:129], v[160:161]
v_pk_add_f32 v[130:131], v[130:131], v[162:163]
v_pk_add_f32 v[132:133], v[132:133], v[164:165]
v_pk_add_f32 v[134:135], v[134:135], v[166:167]
v_cvt_pk_bf16_f32 v32, v128, v129
v_cvt_pk_bf16_f32 v33, v130, v131
v_cvt_pk_bf16_f32 v34, v132, v133
v_cvt_pk_bf16_f32 v35, v134, v135
v_pk_add_f32 v[136:137], v[136:137], v[168:169]
v_pk_add_f32 v[138:139], v[138:139], v[170:171]
v_pk_add_f32 v[140:141], v[140:141], v[172:173]
v_pk_add_f32 v[142:143], v[142:143], v[174:175]
v_cvt_pk_bf16_f32 v36, v136, v137
v_cvt_pk_bf16_f32 v37, v138, v139
v_cvt_pk_bf16_f32 v38, v140, v141
v_cvt_pk_bf16_f32 v39, v142, v143
v_permlane16_swap_b32 v32, v34
v_permlane16_swap_b32 v33, v35
buffer_store_dwordx4 v[32:35], v230, s[20:23], s54 offen offset:0
v_pk_add_f32 v[144:145], v[144:145], v[176:177]
v_pk_add_f32 v[146:147], v[146:147], v[178:179]
v_pk_add_f32 v[148:149], v[148:149], v[180:181]
v_pk_add_f32 v[150:151], v[150:151], v[182:183]
v_cvt_pk_bf16_f32 v40, v144, v145
v_cvt_pk_bf16_f32 v41, v146, v147
v_cvt_pk_bf16_f32 v42, v148, v149
v_cvt_pk_bf16_f32 v43, v150, v151
v_permlane16_swap_b32 v36, v38
v_permlane16_swap_b32 v37, v39
buffer_store_dwordx4 v[36:39], v230, s[20:23], s54 offen offset:2048
v_pk_add_f32 v[152:153], v[152:153], v[184:185]
v_pk_add_f32 v[154:155], v[154:155], v[186:187]
v_pk_add_f32 v[156:157], v[156:157], v[188:189]
v_pk_add_f32 v[158:159], v[158:159], v[190:191]
v_cvt_pk_bf16_f32 v44, v152, v153
v_cvt_pk_bf16_f32 v45, v154, v155
v_cvt_pk_bf16_f32 v46, v156, v157
v_cvt_pk_bf16_f32 v47, v158, v159
v_permlane16_swap_b32 v40, v42
v_permlane16_swap_b32 v41, v43
buffer_store_dwordx4 v[40:43], v230, s[20:23], s55 offen offset:0
s_nop 1
v_permlane16_swap_b32 v44, v46
v_permlane16_swap_b32 v45, v47
buffer_store_dwordx4 v[44:47], v230, s[20:23], s55 offen offset:2048
s_branch Ldone_1
Lgb_90:
s_mul_i32 s43, s34, 262144
s_add_u32 s8, s82, s43
s_addc_u32 s9, s83, 0
s_add_u32 s8, s8, 4194304
s_addc_u32 s9, s9, 0
s_mov_b32 s10, 262144
s_mov_b32 s11, 0x20000
s_lshl_b32 s39, s36, 12
v_lshlrev_b32 v2, 4, v1
v_add_u32 v3, s39, v2
s_add_u32 s37, s35, 0
s_and_b32 s37, s37, 15
s_mul_i32 s37, s37, 16384
s_add_u32 m0, s39, 0
s_nop 0
buffer_load_dwordx4 v3, s[8:11], s37 offen sc1 lds
buffer_load_dwordx4 v3, s[8:11], s37 offen offset:1024 sc1 lds
buffer_load_dwordx4 v3, s[8:11], s37 offen offset:2048 sc1 lds
buffer_load_dwordx4 v3, s[8:11], s37 offen offset:3072 sc1 lds
s_mul_i32 s43, s34, 262144
s_add_u32 s8, s82, s43
s_addc_u32 s9, s83, 0
s_add_u32 s8, s8, 4194304
s_addc_u32 s9, s9, 0
s_mov_b32 s10, 262144
s_mov_b32 s11, 0x20000
s_mul_i32 s43, s34, 917504
s_add_u32 s24, s82, s43
s_addc_u32 s25, s83, 0
s_add_u32 s24, s24, 8388608
s_addc_u32 s25, s25, 0
s_mov_b32 s26, 917504
s_mov_b32 s27, 0x20000
s_add_u32 s84, s82, 27262976
s_addc_u32 s85, s83, 0
s_mov_b32 s86, 229376
s_mov_b32 s87, 0x20000
s_and_b32 s47, s36, 3
s_lshr_b32 s62, s47, 1
s_and_b32 s63, s47, 1
v_lshlrev_b32 v2, 4, v1
s_lshl_b32 s39, s47, 12
v_add_u32 v3, s39, v2
s_cmp_eq_u32 s62, 0
s_cselect_b32 s44, s72, s74
s_cselect_b32 s45, s73, s75
s_lshl_b32 s43, s35, 8
s_add_u32 s12, s44, s43
s_addc_u32 s13, s45, 0
s_mov_b32 s14, 7333120
s_mov_b32 s15, 0x20000
v_lshrrev_b32 v28, 4, v1
v_lshlrev_b32 v29, 1, v28
v_and_b32 v4, 15, v1
v_xor_b32 v4, v4, v29
v_lshlrev_b32 v4, 4, v4
v_mul_u32_u24 v28, 7168, v28
v_add_u32 v4, v4, v28
s_mul_i32 s43, s63, 229376
v_add_u32 v4, s43, v4
v_xor_b32 v5, 128, v4
v_add_u32 v5, 28672, v5
s_lshl_b32 s40, s47, 13
s_add_u32 s40, s40, 16384
s_lshl_b32 s43, s62, 12
v_add_u32 v9, s43, v2
v_add_u32 v10, 98304, v9
v_mov_b32 v6, v192
v_mov_b32 v7, v193
v_mov_b32 v8, v194
v_mov_b32 v24, v195
s_mul_i32 s43, s34, 16384
s_add_u32 s20, s82, s43
s_addc_u32 s21, s83, 0
s_add_u32 s20, s20, 25165824
s_addc_u32 s21, s21, 0
s_mov_b32 s22, 16384
s_mov_b32 s23, 0x20000
s_add_u32 s38, s35, 2
s_and_b32 s38, s38, 15
s_mul_i32 s38, s38, 458752
s_add_u32 m0, s50, 98304
s_nop 0
buffer_load_dwordx4 v6, s[16:19], s38 offen lds
s_add_u32 m0, s50, 99328
s_nop 0
buffer_load_dwordx4 v7, s[16:19], s38 offen lds
s_add_u32 m0, s50, 100352
s_nop 0
buffer_load_dwordx4 v8, s[16:19], s38 offen lds
s_add_u32 m0, s50, 101376
s_add_u32 s38, s38, 114688
buffer_load_dwordx4 v6, s[16:19], s38 offen lds
s_add_u32 m0, s50, 102400
s_nop 0
buffer_load_dwordx4 v7, s[16:19], s38 offen lds
s_add_u32 m0, s50, 103424
s_nop 0
buffer_load_dwordx4 v8, s[16:19], s38 offen lds
s_cmp_eq_u32 s47, 1
s_cbranch_scc0 Lw_116
s_lshl_b32 s92, s34, 7
s_add_u32 s92, s92, 28313600
s_mov_b32 s41, 0x40000
Lpoll_117:
s_load_dword s93, s[82:83], s92 glc
Lpchk_119:
s_waitcnt lgkmcnt(0)
s_cmp_eq_u32 s93, 16
s_cbranch_scc1 Lpok_118
s_sub_u32 s41, s41, 1
s_cmp_lg_u32 s41, 0
s_cbranch_scc1 Lpoll_117
Lpok_118:
Lw_116:
s_waitcnt vmcnt(0)
s_barrier
s_add_u32 s37, s35, 1
s_and_b32 s37, s37, 15
s_mul_i32 s37, s37, 16384
s_add_u32 m0, s39, 49152
s_nop 0
buffer_load_dwordx4 v3, s[8:11], s37 offen sc1 lds
buffer_load_dwordx4 v3, s[8:11], s37 offen offset:1024 sc1 lds
buffer_load_dwordx4 v3, s[8:11], s37 offen offset:2048 sc1 lds
buffer_load_dwordx4 v3, s[8:11], s37 offen offset:3072 sc1 lds
s_add_u32 s37, s35, 2
s_and_b32 s37, s37, 15
s_mul_i32 s37, s37, 16384
s_add_u32 m0, s39, 98304
s_nop 0
buffer_load_dwordx4 v3, s[8:11], s37 offen sc1 lds
buffer_load_dwordx4 v3, s[8:11], s37 offen offset:1024 sc1 lds
buffer_load_dwordx4 v3, s[8:11], s37 offen offset:2048 sc1 lds
buffer_load_dwordx4 v3, s[8:11], s37 offen offset:3072 sc1 lds
buffer_load_dwordx4 v[96:99], v3, s[20:23], 0 offen offset:0 sc1
buffer_load_dwordx4 v[100:103], v3, s[20:23], 0 offen offset:1024 sc1
buffer_load_dwordx4 v[104:107], v3, s[20:23], 0 offen offset:2048 sc1
buffer_load_dwordx4 v[108:111], v3, s[20:23], 0 offen offset:3072 sc1
s_and_b32 s44, s36, 3
s_mul_i32 s44, s44, 14
s_bfe_u32 s43, s2, 0x30001
s_lshl_b32 s43, s43, 7
s_add_u32 s44, s44, s43
s_add_u32 s44, s44, 72
s_mul_i32 s44, s44, 7168
s_lshr_b32 s43, s2, 4
s_lshl_b32 s43, s43, 8
s_add_u32 s43, s43, s44
s_bitcmp0_b32 s2, 0
s_cselect_b32 s4, s72, s74
s_cselect_b32 s5, s73, s75
s_add_u32 s4, s4, s43
s_addc_u32 s5, s5, 0
s_waitcnt vmcnt(8)
s_barrier
s_cmp_eq_u32 s47, 3
s_cbranch_scc0 Lw_120
v_and_b32 v30, 31, v1
v_lshlrev_b32 v30, 4, v30
v_add_u32 v31, 151552, v30
ds_read_b128 v[112:115], v31 offset:0
ds_read_b128 v[116:119], v31 offset:512
ds_read_b128 v[120:123], v31 offset:1024
ds_read_b128 v[124:127], v31 offset:1536
s_and_b32 s44, s2, 15
s_mul_i32 s44, s44, 14336
s_lshr_b32 s43, s2, 4
s_lshl_b32 s43, s43, 9
s_add_u32 s44, s44, s43
s_add_u32 s44, s44, 8192
s_cmp_lt_u32 s2, 192
s_cselect_b32 s44, s44, 0x7fffffff
s_waitcnt lgkmcnt(0)
v_add_f32 v112, v112, v116
v_add_f32 v120, v120, v124
v_add_f32 v113, v113, v117
v_add_f32 v121, v121, v125
v_add_f32 v114, v114, v118
v_add_f32 v122, v122, v126
v_add_f32 v115, v115, v119
v_add_f32 v123, v123, v127
v_add_f32 v112, v112, v120
v_add_f32 v113, v113, v121
v_add_f32 v114, v114, v122
v_add_f32 v115, v115, v123
s_mov_b64 exec, 0xffffffff
buffer_store_dwordx4 v[112:115], v30, s[84:87], s44 offen sc1
s_mov_b64 exec, -1
Lw_120:
s_waitcnt lgkmcnt(0)
s_add_u32 s37, s35, 3
s_and_b32 s37, s37, 15
s_mul_i32 s37, s37, 16384
s_add_u32 m0, s39, 0
s_nop 0
buffer_load_dwordx4 v3, s[8:11], s37 offen sc1 lds
buffer_load_dwordx4 v3, s[8:11], s37 offen offset:1024 sc1 lds
s_load_dword s3, s[4:5], 78848
buffer_load_dwordx4 v3, s[8:11], s37 offen offset:2048 sc1 lds
s_load_dword s3, s[4:5], 78912
buffer_load_dwordx4 v3, s[8:11], s37 offen offset:3072 sc1 lds
s_load_dword s3, s[4:5], 78976
s_add_u32 s38, s35, 3
s_and_b32 s38, s38, 15
s_mul_i32 s38, s38, 458752
s_add_u32 m0, s50, 0
s_nop 0
buffer_load_dwordx4 v6, s[16:19], s38 offen lds
s_load_dword s3, s[4:5], 79040
s_add_u32 m0, s50, 1024
s_nop 0
buffer_load_dwordx4 v7, s[16:19], s38 offen lds
s_load_dword s3, s[4:5], 86016
s_add_u32 m0, s50, 2048
s_nop 0
buffer_load_dwordx4 v8, s[16:19], s38 offen lds
s_load_dword s3, s[4:5], 86080
s_add_u32 m0, s50, 3072
s_add_u32 s38, s38, 114688
buffer_load_dwordx4 v6, s[16:19], s38 offen lds
s_load_dword s3, s[4:5], 86144
s_add_u32 m0, s50, 4096
s_nop 0
buffer_load_dwordx4 v7, s[16:19], s38 offen lds
s_add_u32 m0, s50, 5120
s_nop 0
buffer_load_dwordx4 v8, s[16:19], s38 offen lds
s_waitcnt vmcnt(14)
s_barrier
s_add_u32 s37, s35, 4
s_and_b32 s37, s37, 15
s_mul_i32 s37, s37, 16384
s_branch Lov_13
.p2align 12
Lst_13_0:
s_branch Lwr_152
Lst_13_1:
s_branch Lst_17_0
s_nop 0
Lov_13:
s_add_u32 m0, s39, 49152
s_nop 0
buffer_load_dwordx4 v3, s[8:11], s37 offen sc1 lds
buffer_load_dwordx4 v3, s[8:11], s37 offen offset:1024 sc1 lds
buffer_load_dwordx4 v3, s[8:11], s37 offen offset:2048 sc1 lds
buffer_load_dwordx4 v3, s[8:11], s37 offen offset:3072 sc1 lds
s_add_u32 s38, s35, 4
s_and_b32 s38, s38, 15
s_mul_i32 s38, s38, 458752
s_add_u32 m0, s50, 49152
s_nop 0
buffer_load_dwordx4 v6, s[16:19], s38 offen lds
s_add_u32 m0, s50, 50176
s_nop 0
buffer_load_dwordx4 v7, s[16:19], s38 offen lds
s_add_u32 m0, s50, 51200
s_nop 0
buffer_load_dwordx4 v8, s[16:19], s38 offen lds
s_add_u32 m0, s50, 52224
s_add_u32 s38, s38, 114688
buffer_load_dwordx4 v6, s[16:19], s38 offen lds
s_add_u32 m0, s50, 53248
s_nop 0
buffer_load_dwordx4 v7, s[16:19], s38 offen lds
s_add_u32 m0, s50, 54272
s_nop 0
buffer_load_dwordx4 v8, s[16:19], s38 offen lds
s_waitcnt vmcnt(10)
s_barrier
s_cmp_eq_u32 s47, 3
s_cbranch_scc0 Lw_121
s_cmp_lt_u32 s2, 192
s_cbranch_scc0 Lw_121
s_lshr_b32 s43, s2, 4
s_add_u32 s43, s43, 96
s_lshl_b32 s43, s43, 7
v_mov_b32 v30, s43
v_mov_b32 v31, 1
s_mov_b64 exec, 1
buffer_atomic_add v31, v30, s[56:59], 0 offen sc1
s_mov_b64 exec, -1
Lw_121:
s_waitcnt lgkmcnt(0)
s_add_u32 s37, s35, 5
s_and_b32 s37, s37, 15
s_mul_i32 s37, s37, 16384
s_add_u32 m0, s39, 98304
s_nop 0
buffer_load_dwordx4 v3, s[8:11], s37 offen sc1 lds
s_load_dword s3, s[4:5], 86208
s_load_dword s3, s[4:5], 93184
s_load_dword s3, s[4:5], 93248
s_load_dword s3, s[4:5], 93312
buffer_load_dwordx4 v3, s[8:11], s37 offen offset:1024 sc1 lds
s_load_dword s3, s[4:5], 93376
s_and_b32 s44, s36, 3
s_mul_i32 s43, s2, 28672
s_mul_i32 s44, s44, 7168
s_add_u32 s43, s43, s44
buffer_load_dwordx4 v3, s[8:11], s37 offen offset:2048 sc1 lds
s_add_u32 s4, s76, s43
s_addc_u32 s5, s77, 0
s_load_dword s3, s[4:5], 0
s_load_dword s3, s[4:5], 64
v_add_f32 v96, v96, v100
buffer_load_dwordx4 v3, s[8:11], s37 offen offset:3072 sc1 lds
v_add_f32 v97, v97, v101
v_add_f32 v98, v98, v102
v_add_f32 v99, v99, v103
v_add_f32 v104, v104, v108
v_add_f32 v105, v105, v109
s_add_u32 s38, s35, 5
s_and_b32 s38, s38, 15
s_mul_i32 s38, s38, 458752
s_add_u32 m0, s50, 98304
s_nop 0
buffer_load_dwordx4 v6, s[16:19], s38 offen lds
v_add_f32 v106, v106, v110
v_add_f32 v107, v107, v111
s_nop 0
v_permlane32_swap_b32 v96, v104
v_permlane32_swap_b32 v97, v105
s_add_u32 m0, s50, 99328
s_nop 0
buffer_load_dwordx4 v7, s[16:19], s38 offen lds
v_permlane32_swap_b32 v98, v106
v_permlane32_swap_b32 v99, v107
v_add_f32 v96, v96, v104
v_add_f32 v97, v97, v105
v_add_f32 v98, v98, v106
s_add_u32 m0, s50, 100352
s_nop 0
buffer_load_dwordx4 v8, s[16:19], s38 offen lds
v_add_f32 v99, v99, v107
v_mov_b32 v100, v96
v_mov_b32 v101, v97
v_mov_b32 v102, v98
v_mov_b32 v103, v99
s_add_u32 m0, s50, 101376
s_add_u32 s38, s38, 114688
buffer_load_dwordx4 v6, s[16:19], s38 offen lds
s_nop 0
v_permlane16_swap_b32 v96, v100
v_permlane16_swap_b32 v97, v101
v_permlane16_swap_b32 v98, v102
v_permlane16_swap_b32 v99, v103
s_add_u32 m0, s50, 102400
s_nop 0
buffer_load_dwordx4 v7, s[16:19], s38 offen lds
s_add_u32 m0, s50, 103424
s_nop 0
buffer_load_dwordx4 v8, s[16:19], s38 offen lds
s_waitcnt vmcnt(10)
s_barrier
s_add_u32 s37, s35, 6
s_and_b32 s37, s37, 15
s_mul_i32 s37, s37, 16384
s_add_u32 m0, s39, 0
s_nop 0
buffer_load_dwordx4 v3, s[8:11], s37 offen sc1 lds
v_add_f32 v96, v96, v100
v_add_f32 v97, v97, v101
v_add_f32 v98, v98, v102
buffer_load_dwordx4 v3, s[8:11], s37 offen offset:1024 sc1 lds
v_add_f32 v99, v99, v103
s_nop 0
v_add_f32_dpp v96, v96, v96 row_ror:8 row_mask:0xf bank_mask:0xf
buffer_load_dwordx4 v3, s[8:11], s37 offen offset:2048 sc1 lds
v_add_f32_dpp v97, v97, v97 row_ror:8 row_mask:0xf bank_mask:0xf
v_add_f32_dpp v98, v98, v98 row_ror:8 row_mask:0xf bank_mask:0xf
v_add_f32_dpp v99, v99, v99 row_ror:8 row_mask:0xf bank_mask:0xf
v_mul_f32 v96, 0x3a800000, v96
buffer_load_dwordx4 v3, s[8:11], s37 offen offset:3072 sc1 lds
v_mul_f32 v97, 0x3a800000, v97
v_mul_f32 v98, 0x3a800000, v98
v_mul_f32 v99, 0x3a800000, v99
s_add_u32 s38, s35, 6
s_and_b32 s38, s38, 15
s_mul_i32 s38, s38, 458752
s_add_u32 m0, s50, 0
s_nop 0
buffer_load_dwordx4 v6, s[16:19], s38 offen lds
v_fma_f32 v97, -v96, v96, v97
v_fma_f32 v99, -v98, v98, v99
v_max_f32 v97, 0, v97
s_add_u32 m0, s50, 1024
s_nop 0
buffer_load_dwordx4 v7, s[16:19], s38 offen lds
v_max_f32 v99, 0, v99
v_add_f32 v97, 0x3727c5ac, v97
v_add_f32 v99, 0x3727c5ac, v99
v_rsq_f32 v97, v97
s_add_u32 m0, s50, 2048
s_nop 0
buffer_load_dwordx4 v8, s[16:19], s38 offen lds
v_rsq_f32 v99, v99
v_and_b32 v100, 7, v1
s_lshl_b32 s43, s47, 8
s_add_u32 m0, s50, 3072
s_add_u32 s38, s38, 114688
buffer_load_dwordx4 v6, s[16:19], s38 offen lds
s_add_u32 s43, s43, 147456
v_lshl_add_u32 v100, v100, 4, s43
v_lshrrev_b32 v101, 5, v1
v_lshl_add_u32 v100, v101, 7, v100
s_add_u32 m0, s50, 4096
s_nop 0
buffer_load_dwordx4 v7, s[16:19], s38 offen lds
s_add_u32 m0, s50, 5120
s_nop 0
buffer_load_dwordx4 v8, s[16:19], s38 offen lds
s_waitcnt vmcnt(10)
s_barrier
ds_write_b128 v100, v[96:99]
s_waitcnt lgkmcnt(0)
s_add_u32 s37, s35, 7
s_and_b32 s37, s37, 15
s_mul_i32 s37, s37, 16384
s_add_u32 m0, s39, 49152
s_nop 0
buffer_load_dwordx4 v3, s[8:11], s37 offen sc1 lds
buffer_load_dwordx4 v3, s[8:11], s37 offen offset:1024 sc1 lds
s_load_dword s3, s[4:5], 128
buffer_load_dwordx4 v3, s[8:11], s37 offen offset:2048 sc1 lds
s_load_dword s3, s[4:5], 192
buffer_load_dwordx4 v3, s[8:11], s37 offen offset:3072 sc1 lds
s_load_dword s3, s[4:5], 256
s_add_u32 s38, s35, 7
s_and_b32 s38, s38, 15
s_mul_i32 s38, s38, 458752
s_add_u32 m0, s50, 49152
s_nop 0
buffer_load_dwordx4 v6, s[16:19], s38 offen lds
s_load_dword s3, s[4:5], 320
s_add_u32 m0, s50, 50176
s_nop 0
buffer_load_dwordx4 v7, s[16:19], s38 offen lds
s_load_dword s3, s[4:5], 384
s_add_u32 m0, s50, 51200
s_nop 0
buffer_load_dwordx4 v8, s[16:19], s38 offen lds
s_load_dword s3, s[4:5], 448
s_add_u32 m0, s50, 52224
s_add_u32 s38, s38, 114688
buffer_load_dwordx4 v6, s[16:19], s38 offen lds
s_load_dword s3, s[4:5], 512
s_add_u32 m0, s50, 53248
s_nop 0
buffer_load_dwordx4 v7, s[16:19], s38 offen lds
s_add_u32 m0, s50, 54272
s_nop 0
buffer_load_dwordx4 v8, s[16:19], s38 offen lds
s_waitcnt vmcnt(10)
s_barrier
s_add_u32 s37, s35, 8
s_and_b32 s37, s37, 15
s_mul_i32 s37, s37, 16384
s_add_u32 m0, s39, 98304
s_nop 0
buffer_load_dwordx4 v3, s[8:11], s37 offen sc1 lds
v_lshrrev_b32 v28, 2, v1
v_and_b32 v29, 7, v28
buffer_load_dwordx4 v3, s[8:11], s37 offen offset:1024 sc1 lds
v_mul_u32_u24 v28, 256, v28
v_lshl_add_u32 v28, v29, 5, v28
v_and_b32 v29, 3, v1
buffer_load_dwordx4 v3, s[8:11], s37 offen offset:2048 sc1 lds
v_lshl_add_u32 v11, v29, 3, v28
s_lshl_b32 s43, s63, 7
buffer_load_dwordx4 v3, s[8:11], s37 offen offset:3072 sc1 lds
v_xor_b32 v11, s43, v11
v_add_u32 v11, 16384, v11
v_xor_b32 v12, 32, v11
s_add_u32 s38, s35, 8
s_and_b32 s38, s38, 15
s_mul_i32 s38, s38, 458752
s_add_u32 m0, s50, 98304
s_nop 0
buffer_load_dwordx4 v6, s[16:19], s38 offen lds
v_xor_b32 v13, 64, v11
v_xor_b32 v14, 96, v11
s_add_u32 m0, s50, 99328
s_nop 0
buffer_load_dwordx4 v7, s[16:19], s38 offen lds
v_add_u32 v15, 49152, v11
v_add_u32 v16, 49152, v12
v_add_u32 v17, 49152, v13
s_add_u32 m0, s50, 100352
s_nop 0
buffer_load_dwordx4 v8, s[16:19], s38 offen lds
v_add_u32 v18, 49152, v14
v_add_u32 v19, 98304, v11
s_add_u32 m0, s50, 101376
s_add_u32 s38, s38, 114688
buffer_load_dwordx4 v6, s[16:19], s38 offen lds
v_add_u32 v20, 98304, v12
v_add_u32 v21, 98304, v13
v_add_u32 v22, 98304, v14
s_add_u32 m0, s50, 102400
s_nop 0
buffer_load_dwordx4 v7, s[16:19], s38 offen lds
s_add_u32 m0, s50, 103424
s_nop 0
buffer_load_dwordx4 v8, s[16:19], s38 offen lds
s_waitcnt vmcnt(10)
s_barrier
s_waitcnt lgkmcnt(0)
s_cmp_eq_u32 s47, 3
s_cbranch_scc0 Lw_122
s_mul_i32 s60, s35, 96
s_add_u32 s61, s60, 95
s_and_b32 s60, s60, 0xff80
s_and_b32 s61, s61, 0xff80
s_add_u32 s60, s60, 28323840
s_add_u32 s61, s61, 28323840
s_load_dword s92, s[82:83], s60 glc
s_load_dword s93, s[82:83], s61 glc
Lw_122:
s_add_u32 s37, s35, 9
s_and_b32 s37, s37, 15
s_mul_i32 s37, s37, 16384
s_add_u32 m0, s39, 0
s_nop 0
buffer_load_dwordx4 v3, s[8:11], s37 offen sc1 lds
buffer_load_dwordx4 v3, s[8:11], s37 offen offset:1024 sc1 lds
s_load_dword s3, s[4:5], 576
buffer_load_dwordx4 v3, s[8:11], s37 offen offset:2048 sc1 lds
s_load_dword s3, s[4:5], 640
buffer_load_dwordx4 v3, s[8:11], s37 offen offset:3072 sc1 lds
s_load_dword s3, s[4:5], 704
s_add_u32 s38, s35, 9
s_and_b32 s38, s38, 15
s_mul_i32 s38, s38, 458752
s_add_u32 m0, s50, 0
s_nop 0
buffer_load_dwordx4 v6, s[16:19], s38 offen lds
s_load_dword s3, s[4:5], 768
s_add_u32 m0, s50, 1024
s_nop 0
buffer_load_dwordx4 v7, s[16:19], s38 offen lds
s_load_dword s3, s[4:5], 832
s_add_u32 m0, s50, 2048
s_nop 0
buffer_load_dwordx4 v8, s[16:19], s38 offen lds
s_load_dword s3, s[4:5], 896
s_add_u32 m0, s50, 3072
s_add_u32 s38, s38, 114688
buffer_load_dwordx4 v6, s[16:19], s38 offen lds
s_load_dword s3, s[4:5], 960
s_add_u32 m0, s50, 4096
s_nop 0
buffer_load_dwordx4 v7, s[16:19], s38 offen lds
s_add_u32 m0, s50, 5120
s_nop 0
buffer_load_dwordx4 v8, s[16:19], s38 offen lds
s_waitcnt vmcnt(10)
s_barrier
s_add_u32 s37, s35, 10
s_and_b32 s37, s37, 15
s_mul_i32 s37, s37, 16384
s_add_u32 m0, s39, 49152
s_nop 0
buffer_load_dwordx4 v3, s[8:11], s37 offen sc1 lds
buffer_load_dwordx4 v3, s[8:11], s37 offen offset:1024 sc1 lds
buffer_load_dwordx4 v3, s[8:11], s37 offen offset:2048 sc1 lds
buffer_load_dwordx4 v3, s[8:11], s37 offen offset:3072 sc1 lds
s_add_u32 s38, s35, 10
s_and_b32 s38, s38, 15
s_mul_i32 s38, s38, 458752
s_add_u32 m0, s50, 49152
s_nop 0
buffer_load_dwordx4 v6, s[16:19], s38 offen lds
s_add_u32 m0, s50, 50176
s_nop 0
buffer_load_dwordx4 v7, s[16:19], s38 offen lds
s_add_u32 m0, s50, 51200
s_nop 0
buffer_load_dwordx4 v8, s[16:19], s38 offen lds
s_add_u32 m0, s50, 52224
s_add_u32 s38, s38, 114688
buffer_load_dwordx4 v6, s[16:19], s38 offen lds
s_add_u32 m0, s50, 53248
s_nop 0
buffer_load_dwordx4 v7, s[16:19], s38 offen lds
s_add_u32 m0, s50, 54272
s_nop 0
buffer_load_dwordx4 v8, s[16:19], s38 offen lds
s_mov_b32 s38, 0
buffer_load_dwordx4 v[40:43], v24, s[88:91], s38 offen
s_mov_b32 s38, 28672
buffer_load_dwordx4 v[44:47], v24, s[88:91], s38 offen
s_mov_b32 s38, 57344
buffer_load_dwordx4 v[48:51], v24, s[88:91], s38 offen
s_mov_b32 s38, 86016
buffer_load_dwordx4 v[52:55], v24, s[88:91], s38 offen
s_mov_b32 s38, 114688
buffer_load_dwordx4 v[56:59], v24, s[88:91], s38 offen
s_mov_b32 s38, 143360
buffer_load_dwordx4 v[60:63], v24, s[88:91], s38 offen
s_mov_b32 s38, 172032
buffer_load_dwordx4 v[64:67], v24, s[88:91], s38 offen
s_mov_b32 s38, 200704
buffer_load_dwordx4 v[68:71], v24, s[88:91], s38 offen
s_waitcnt vmcnt(18)
s_cmp_eq_u32 s47, 3
s_cbranch_scc0 Lw_123
s_mov_b32 s41, 0x40000
Lcp_124:
s_waitcnt lgkmcnt(0)
s_and_b32 s92, s92, s93
s_cmp_eq_u32 s92, 16
s_cbranch_scc1 Lco_125
s_load_dword s92, s[82:83], s60 glc
s_load_dword s93, s[82:83], s61 glc
s_sub_u32 s41, s41, 1
s_cmp_lg_u32 s41, 0
s_cbranch_scc1 Lcp_124
s_waitcnt lgkmcnt(0)
Lco_125:
Lw_123:
s_barrier
s_mov_b32 s45, s47
s_cmp_ge_u32 s45, 3
s_cselect_b32 s43, 1, 0
s_mul_i32 s44, s43, 3
s_sub_u32 s45, s45, s44
s_lshl_b32 s45, s45, 7
s_mul_i32 s52, s43, 896
s_add_u32 s52, s52, s45
s_add_u32 s52, s52, 148992
s_mul_i32 s43, s43, 14336
s_add_u32 s43, s43, s45
s_mul_i32 s44, s35, 384
s_add_u32 s43, s43, s44
s_add_u32 s60, s43, 8192
s_add_u32 s45, s47, 4
s_min_u32 s45, s45, 5
s_cmp_ge_u32 s45, 3
s_cselect_b32 s43, 1, 0
s_mul_i32 s44, s43, 3
s_sub_u32 s45, s45, s44
s_lshl_b32 s45, s45, 7
s_mul_i32 s53, s43, 896
s_add_u32 s53, s53, s45
s_add_u32 s53, s53, 148992
s_mul_i32 s43, s43, 14336
s_add_u32 s43, s43, s45
s_mul_i32 s44, s35, 384
s_add_u32 s43, s43, s44
s_add_u32 s61, s43, 8192
v_lshrrev_b32 v104, 3, v1
v_mul_u32_u24 v104, 28672, v104
v_and_b32 v105, 7, v1
v_lshl_add_u32 v104, v105, 4, v104
s_waitcnt lgkmcnt(0)
buffer_load_dwordx4 v[96:99], v104, s[84:87], s60 offen sc1
s_load_dword s3, s[4:5], 1024
buffer_load_dwordx4 v[100:103], v104, s[84:87], s61 offen sc1
s_load_dword s3, s[4:5], 1088
s_add_u32 s37, s35, 11
s_and_b32 s37, s37, 15
s_mul_i32 s37, s37, 16384
s_add_u32 m0, s39, 98304
s_nop 0
buffer_load_dwordx4 v3, s[8:11], s37 offen sc1 lds
s_load_dword s3, s[4:5], 1152
s_load_dword s3, s[4:5], 1216
buffer_load_dwordx4 v3, s[8:11], s37 offen offset:1024 sc1 lds
s_load_dword s3, s[4:5], 1280
buffer_load_dwordx4 v3, s[8:11], s37 offen offset:2048 sc1 lds
s_load_dword s3, s[4:5], 1344
s_load_dword s3, s[4:5], 1408
buffer_load_dwordx4 v3, s[8:11], s37 offen offset:3072 sc1 lds
v_cmp_gt_u32 vcc, 32, v1
s_add_u32 s38, s35, 11
s_and_b32 s38, s38, 15
s_mul_i32 s38, s38, 458752
s_add_u32 m0, s50, 98304
s_nop 0
buffer_load_dwordx4 v6, s[16:19], s38 offen lds
v_mov_b32 v104, s52
s_add_u32 m0, s50, 99328
s_nop 0
buffer_load_dwordx4 v7, s[16:19], s38 offen lds
v_mov_b32 v106, s53
v_cndmask_b32 v104, v106, v104, vcc
s_add_u32 m0, s50, 100352
s_nop 0
buffer_load_dwordx4 v8, s[16:19], s38 offen lds
v_lshl_add_u32 v104, v105, 4, v104
s_add_u32 m0, s50, 101376
s_add_u32 s38, s38, 114688
buffer_load_dwordx4 v6, s[16:19], s38 offen lds
v_bfe_u32 v105, v1, 4, 1
v_lshl_add_u32 v104, v105, 2, v104
s_add_u32 m0, s50, 102400
s_nop 0
buffer_load_dwordx4 v7, s[16:19], s38 offen lds
s_add_u32 m0, s50, 103424
s_nop 0
buffer_load_dwordx4 v8, s[16:19], s38 offen lds
s_waitcnt vmcnt(20)
s_barrier
s_add_u32 s37, s35, 12
s_and_b32 s37, s37, 15
s_mul_i32 s37, s37, 16384
s_add_u32 m0, s39, 0
s_nop 0
buffer_load_dwordx4 v3, s[8:11], s37 offen sc1 lds
buffer_load_dwordx4 v3, s[8:11], s37 offen offset:1024 sc1 lds
buffer_load_dwordx4 v3, s[8:11], s37 offen offset:2048 sc1 lds
buffer_load_dwordx4 v3, s[8:11], s37 offen offset:3072 sc1 lds
s_add_u32 s38, s35, 12
s_and_b32 s38, s38, 15
s_mul_i32 s38, s38, 458752
s_add_u32 m0, s50, 0
s_nop 0
buffer_load_dwordx4 v6, s[16:19], s38 offen lds
s_add_u32 m0, s50, 1024
s_nop 0
buffer_load_dwordx4 v7, s[16:19], s38 offen lds
s_add_u32 m0, s50, 2048
s_nop 0
buffer_load_dwordx4 v8, s[16:19], s38 offen lds
s_add_u32 m0, s50, 3072
s_add_u32 s38, s38, 114688
buffer_load_dwordx4 v6, s[16:19], s38 offen lds
s_add_u32 m0, s50, 4096
s_nop 0
buffer_load_dwordx4 v7, s[16:19], s38 offen lds
s_add_u32 m0, s50, 5120
s_nop 0
buffer_load_dwordx4 v8, s[16:19], s38 offen lds
s_waitcnt vmcnt(10)
s_barrier
v_permlane32_swap_b32 v96, v100
v_permlane32_swap_b32 v97, v101
v_permlane32_swap_b32 v98, v102
v_permlane32_swap_b32 v99, v103
v_add_f32 v96, v96, v100
v_add_f32 v97, v97, v101
v_add_f32 v98, v98, v102
v_add_f32 v99, v99, v103
s_nop 1
v_permlane16_swap_b32 v96, v97
v_permlane16_swap_b32 v98, v99
v_add_f32 v96, v96, v97
v_add_f32 v98, v98, v99
s_nop 1
v_add_f32_dpp v96, v96, v96 row_ror:8 row_mask:0xf bank_mask:0xf
v_add_f32_dpp v98, v98, v98 row_ror:8 row_mask:0xf bank_mask:0xf
ds_write_b32 v104, v96
ds_write_b32 v104, v98 offset:8
s_waitcnt lgkmcnt(0)
s_add_u32 s37, s35, 13
s_and_b32 s37, s37, 15
s_mul_i32 s37, s37, 16384
s_add_u32 m0, s39, 49152
s_nop 0
buffer_load_dwordx4 v3, s[8:11], s37 offen sc1 lds
s_load_dword s3, s[4:5], 1472
s_load_dword s3, s[4:5], 1536
s_load_dword s3, s[4:5], 1600
s_load_dword s3, s[4:5], 1664
buffer_load_dwordx4 v3, s[8:11], s37 offen offset:1024 sc1 lds
s_load_dword s3, s[4:5], 1728
v_lshlrev_b32 v72, 16, v40
v_and_b32 v73, 0xffff0000, v40
v_lshlrev_b32 v74, 16, v41
v_and_b32 v75, 0xffff0000, v41
buffer_load_dwordx4 v3, s[8:11], s37 offen offset:2048 sc1 lds
v_lshlrev_b32 v76, 16, v42
v_and_b32 v77, 0xffff0000, v42
v_lshlrev_b32 v78, 16, v43
v_and_b32 v79, 0xffff0000, v43
v_lshlrev_b32 v80, 16, v44
buffer_load_dwordx4 v3, s[8:11], s37 offen offset:3072 sc1 lds
v_and_b32 v81, 0xffff0000, v44
v_lshlrev_b32 v82, 16, v45
v_and_b32 v83, 0xffff0000, v45
v_lshlrev_b32 v84, 16, v46
v_and_b32 v85, 0xffff0000, v46
s_add_u32 s38, s35, 13
s_and_b32 s38, s38, 15
s_mul_i32 s38, s38, 458752
s_add_u32 m0, s50, 49152
s_nop 0
buffer_load_dwordx4 v6, s[16:19], s38 offen lds
v_lshlrev_b32 v86, 16, v47
v_and_b32 v87, 0xffff0000, v47
v_add_f32 v72, v72, v80
v_add_f32 v73, v73, v81
s_add_u32 m0, s50, 50176
s_nop 0
buffer_load_dwordx4 v7, s[16:19], s38 offen lds
v_add_f32 v74, v74, v82
v_add_f32 v75, v75, v83
v_add_f32 v76, v76, v84
v_add_f32 v77, v77, v85
v_add_f32 v78, v78, v86
s_add_u32 m0, s50, 51200
s_nop 0
buffer_load_dwordx4 v8, s[16:19], s38 offen lds
v_add_f32 v79, v79, v87
v_lshlrev_b32 v80, 16, v48
v_and_b32 v81, 0xffff0000, v48
v_lshlrev_b32 v82, 16, v49
v_and_b32 v83, 0xffff0000, v49
s_add_u32 m0, s50, 52224
s_add_u32 s38, s38, 114688
buffer_load_dwordx4 v6, s[16:19], s38 offen lds
v_lshlrev_b32 v84, 16, v50
v_and_b32 v85, 0xffff0000, v50
v_lshlrev_b32 v86, 16, v51
v_and_b32 v87, 0xffff0000, v51
v_add_f32 v72, v72, v80
s_add_u32 m0, s50, 53248
s_nop 0
buffer_load_dwordx4 v7, s[16:19], s38 offen lds
s_add_u32 m0, s50, 54272
s_nop 0
buffer_load_dwordx4 v8, s[16:19], s38 offen lds
s_waitcnt vmcnt(10)
s_barrier
s_add_u32 s37, s35, 14
s_and_b32 s37, s37, 15
s_mul_i32 s37, s37, 16384
s_add_u32 m0, s39, 98304
s_nop 0
buffer_load_dwordx4 v3, s[8:11], s37 offen sc1 lds
v_add_f32 v73, v73, v81
v_add_f32 v74, v74, v82
v_add_f32 v75, v75, v83
v_add_f32 v76, v76, v84
buffer_load_dwordx4 v3, s[8:11], s37 offen offset:1024 sc1 lds
v_add_f32 v77, v77, v85
v_add_f32 v78, v78, v86
v_add_f32 v79, v79, v87
v_lshlrev_b32 v80, 16, v52
buffer_load_dwordx4 v3, s[8:11], s37 offen offset:2048 sc1 lds
v_and_b32 v81, 0xffff0000, v52
v_lshlrev_b32 v82, 16, v53
v_and_b32 v83, 0xffff0000, v53
v_lshlrev_b32 v84, 16, v54
buffer_load_dwordx4 v3, s[8:11], s37 offen offset:3072 sc1 lds
v_and_b32 v85, 0xffff0000, v54
v_lshlrev_b32 v86, 16, v55
v_and_b32 v87, 0xffff0000, v55
v_add_f32 v72, v72, v80
v_add_f32 v73, v73, v81
s_add_u32 s38, s35, 14
s_and_b32 s38, s38, 15
s_mul_i32 s38, s38, 458752
s_add_u32 m0, s50, 98304
s_nop 0
buffer_load_dwordx4 v6, s[16:19], s38 offen lds
v_add_f32 v74, v74, v82
v_add_f32 v75, v75, v83
v_add_f32 v76, v76, v84
v_add_f32 v77, v77, v85
s_add_u32 m0, s50, 99328
s_nop 0
buffer_load_dwordx4 v7, s[16:19], s38 offen lds
v_add_f32 v78, v78, v86
v_add_f32 v79, v79, v87
v_lshlrev_b32 v80, 16, v56
v_and_b32 v81, 0xffff0000, v56
s_add_u32 m0, s50, 100352
s_nop 0
buffer_load_dwordx4 v8, s[16:19], s38 offen lds
v_lshlrev_b32 v82, 16, v57
v_and_b32 v83, 0xffff0000, v57
v_lshlrev_b32 v84, 16, v58
v_and_b32 v85, 0xffff0000, v58
s_add_u32 m0, s50, 101376
s_add_u32 s38, s38, 114688
buffer_load_dwordx4 v6, s[16:19], s38 offen lds
v_lshlrev_b32 v86, 16, v59
v_and_b32 v87, 0xffff0000, v59
v_add_f32 v72, v72, v80
v_add_f32 v73, v73, v81
v_add_f32 v74, v74, v82
s_add_u32 m0, s50, 102400
s_nop 0
buffer_load_dwordx4 v7, s[16:19], s38 offen lds
s_add_u32 m0, s50, 103424
s_nop 0
buffer_load_dwordx4 v8, s[16:19], s38 offen lds
s_waitcnt vmcnt(10)
s_barrier
s_add_u32 s37, s35, 15
s_and_b32 s37, s37, 15
s_mul_i32 s37, s37, 16384
s_add_u32 m0, s39, 0
s_nop 0
buffer_load_dwordx4 v3, s[8:11], s37 offen sc1 lds
v_add_f32 v75, v75, v83
v_add_f32 v76, v76, v84
v_add_f32 v77, v77, v85
v_add_f32 v78, v78, v86
buffer_load_dwordx4 v3, s[8:11], s37 offen offset:1024 sc1 lds
v_add_f32 v79, v79, v87
v_lshlrev_b32 v80, 16, v60
v_and_b32 v81, 0xffff0000, v60
v_lshlrev_b32 v82, 16, v61
buffer_load_dwordx4 v3, s[8:11], s37 offen offset:2048 sc1 lds
v_and_b32 v83, 0xffff0000, v61
v_lshlrev_b32 v84, 16, v62
v_and_b32 v85, 0xffff0000, v62
v_lshlrev_b32 v86, 16, v63
s_branch Lov_14
.p2align 12
Lst_14_0:
s_branch Lwr_153
Lst_14_1:
s_branch Lwr_165
s_nop 0
Lov_14:
buffer_load_dwordx4 v3, s[8:11], s37 offen offset:3072 sc1 lds
v_and_b32 v87, 0xffff0000, v63
v_add_f32 v72, v72, v80
v_add_f32 v73, v73, v81
v_add_f32 v74, v74, v82
s_add_u32 s38, s35, 15
s_and_b32 s38, s38, 15
s_mul_i32 s38, s38, 458752
s_add_u32 m0, s50, 0
s_nop 0
buffer_load_dwordx4 v6, s[16:19], s38 offen lds
v_add_f32 v75, v75, v83
v_add_f32 v76, v76, v84
v_add_f32 v77, v77, v85
v_add_f32 v78, v78, v86
s_add_u32 m0, s50, 1024
s_nop 0
buffer_load_dwordx4 v7, s[16:19], s38 offen lds
v_add_f32 v79, v79, v87
v_lshlrev_b32 v80, 16, v64
v_and_b32 v81, 0xffff0000, v64
v_lshlrev_b32 v82, 16, v65
s_add_u32 m0, s50, 2048
s_nop 0
buffer_load_dwordx4 v8, s[16:19], s38 offen lds
v_and_b32 v83, 0xffff0000, v65
v_lshlrev_b32 v84, 16, v66
v_and_b32 v85, 0xffff0000, v66
v_lshlrev_b32 v86, 16, v67
s_add_u32 m0, s50, 3072
s_add_u32 s38, s38, 114688
buffer_load_dwordx4 v6, s[16:19], s38 offen lds
v_and_b32 v87, 0xffff0000, v67
v_add_f32 v72, v72, v80
v_add_f32 v73, v73, v81
v_add_f32 v74, v74, v82
v_add_f32 v75, v75, v83
s_add_u32 m0, s50, 4096
s_nop 0
buffer_load_dwordx4 v7, s[16:19], s38 offen lds
s_add_u32 m0, s50, 5120
s_nop 0
buffer_load_dwordx4 v8, s[16:19], s38 offen lds
s_waitcnt vmcnt(10)
s_barrier
s_add_u32 s37, s35, 0
s_and_b32 s37, s37, 15
s_mul_i32 s37, s37, 16384
s_add_u32 m0, s39, 49152
s_nop 0
buffer_load_dwordx4 v3, s[8:11], s37 offen sc1 lds
v_add_f32 v76, v76, v84
v_add_f32 v77, v77, v85
v_add_f32 v78, v78, v86
buffer_load_dwordx4 v3, s[8:11], s37 offen offset:1024 sc1 lds
v_add_f32 v79, v79, v87
v_lshlrev_b32 v80, 16, v68
v_and_b32 v81, 0xffff0000, v68
buffer_load_dwordx4 v3, s[8:11], s37 offen offset:2048 sc1 lds
v_lshlrev_b32 v82, 16, v69
v_and_b32 v83, 0xffff0000, v69
v_lshlrev_b32 v84, 16, v70
v_and_b32 v85, 0xffff0000, v70
buffer_load_dwordx4 v3, s[8:11], s37 offen offset:3072 sc1 lds
v_lshlrev_b32 v86, 16, v71
v_and_b32 v87, 0xffff0000, v71
v_add_f32 v72, v72, v80
s_add_u32 s38, s35, 0
s_and_b32 s38, s38, 15
s_mul_i32 s38, s38, 458752
s_add_u32 m0, s40, 49152
s_nop 0
buffer_load_dwordx4 v4, s[12:15], s38 offen lds
v_add_f32 v73, v73, v81
v_add_f32 v74, v74, v82
v_add_f32 v75, v75, v83
v_add_f32 v76, v76, v84
s_add_u32 m0, s40, 50176
s_nop 0
buffer_load_dwordx4 v5, s[12:15], s38 offen lds
v_add_f32 v77, v77, v85
v_add_f32 v78, v78, v86
v_add_f32 v79, v79, v87
s_add_u32 m0, s40, 51200
s_add_u32 s38, s38, 57344
buffer_load_dwordx4 v4, s[12:15], s38 offen lds
s_nop 0
v_permlane32_swap_b32 v72, v76
v_permlane32_swap_b32 v73, v77
s_add_u32 m0, s40, 52224
s_nop 0
buffer_load_dwordx4 v5, s[12:15], s38 offen lds
v_permlane32_swap_b32 v74, v78
v_permlane32_swap_b32 v75, v79
v_add_f32 v72, v72, v76
v_add_f32 v73, v73, v77
s_add_u32 m0, s40, 53248
s_add_u32 s38, s38, 57344
buffer_load_dwordx4 v4, s[12:15], s38 offen lds
v_add_f32 v74, v74, v78
v_add_f32 v75, v75, v79
s_nop 0
s_add_u32 m0, s40, 54272
s_nop 0
buffer_load_dwordx4 v5, s[12:15], s38 offen lds
v_permlane16_swap_b32 v72, v74
v_permlane16_swap_b32 v73, v75
v_add_f32 v72, v72, v74
v_add_f32 v73, v73, v75
s_add_u32 m0, s40, 55296
s_add_u32 s38, s38, 57344
buffer_load_dwordx4 v4, s[12:15], s38 offen lds
s_add_u32 m0, s40, 56320
s_nop 0
buffer_load_dwordx4 v5, s[12:15], s38 offen lds
s_waitcnt vmcnt(12)
s_barrier
s_lshl_b32 s43, s47, 9
s_add_u32 s43, s43, 153600
v_and_b32 v80, 15, v1
v_lshl_add_u32 v80, v80, 5, s43
v_lshrrev_b32 v81, 4, v1
v_lshl_add_u32 v80, v81, 3, v80
ds_write_b64 v80, v[72:73]
s_waitcnt lgkmcnt(0)
s_add_u32 s37, s35, 1
s_and_b32 s37, s37, 15
s_mul_i32 s37, s37, 16384
s_add_u32 m0, s39, 98304
s_nop 0
buffer_load_dwordx4 v3, s[8:11], s37 offen sc1 lds
s_bfe_u32 s61, s35, 0x10002
s_lshr_b32 s60, s35, 3
buffer_load_dwordx4 v3, s[8:11], s37 offen offset:1024 sc1 lds
s_lshl_b32 s60, s60, 2
s_and_b32 s43, s35, 3
s_add_u32 s60, s60, s43
buffer_load_dwordx4 v3, s[8:11], s37 offen offset:2048 sc1 lds
s_lshl_b32 s43, s60, 8
s_add_u32 s28, s76, s43
buffer_load_dwordx4 v3, s[8:11], s37 offen offset:3072 sc1 lds
s_addc_u32 s29, s77, 0
s_mov_b32 s30, 7338240
s_mov_b32 s31, 0x20000
s_add_u32 s38, s35, 1
s_and_b32 s38, s38, 15
s_mul_i32 s38, s38, 458752
s_add_u32 m0, s40, 98304
s_nop 0
buffer_load_dwordx4 v4, s[12:15], s38 offen lds
s_mul_i32 s52, s61, 196608
s_mul_i32 s53, s61, 1572864
s_mul_i32 s90, s61, 163840
s_add_u32 m0, s40, 99328
s_nop 0
buffer_load_dwordx4 v5, s[12:15], s38 offen lds
s_mul_i32 s91, s61, 1310720
s_lshl_b32 s51, s47, 11
s_add_u32 m0, s40, 100352
s_add_u32 s38, s38, 57344
buffer_load_dwordx4 v4, s[12:15], s38 offen lds
s_lshl_b32 s44, s47, 15
v_lshrrev_b32 v122, 4, v1
v_lshlrev_b32 v123, 1, v122
s_add_u32 m0, s40, 101376
s_nop 0
buffer_load_dwordx4 v5, s[12:15], s38 offen lds
v_and_b32 v23, 15, v1
v_xor_b32 v23, v23, v123
s_add_u32 m0, s40, 102400
s_add_u32 s38, s38, 57344
buffer_load_dwordx4 v4, s[12:15], s38 offen lds
v_lshlrev_b32 v23, 4, v23
v_mul_u32_u24 v122, 2048, v122
v_add_u32 v23, v23, v122
s_add_u32 m0, s40, 103424
s_nop 0
buffer_load_dwordx4 v5, s[12:15], s38 offen lds
v_add_u32 v23, s44, v23
v_xor_b32 v24, 128, v23
v_add_u32 v24, 8192, v24
s_add_u32 m0, s40, 104448
s_add_u32 s38, s38, 57344
buffer_load_dwordx4 v4, s[12:15], s38 offen lds
s_add_u32 m0, s40, 105472
s_nop 0
buffer_load_dwordx4 v5, s[12:15], s38 offen lds
s_waitcnt vmcnt(12)
s_barrier
ds_read_b128 v[28:31], v9 offset:49152
ds_read_b64_tr_b16 v[44:45], v15 offset:0
ds_read_b64_tr_b16 v[46:47], v15 offset:4096
ds_read_b64_tr_b16 v[48:49], v16 offset:0
ds_read_b64_tr_b16 v[50:51], v16 offset:4096
ds_read_b64_tr_b16 v[52:53], v17 offset:0
ds_read_b64_tr_b16 v[54:55], v17 offset:4096
ds_read_b64_tr_b16 v[56:57], v18 offset:0
ds_read_b64_tr_b16 v[58:59], v18 offset:4096
ds_read_b64_tr_b16 v[60:61], v15 offset:16384
ds_read_b64_tr_b16 v[62:63], v15 offset:20480
ds_read_b64_tr_b16 v[64:65], v16 offset:16384
ds_read_b64_tr_b16 v[66:67], v16 offset:20480
ds_read_b64_tr_b16 v[68:69], v17 offset:16384
ds_read_b64_tr_b16 v[70:71], v17 offset:20480
ds_read_b64_tr_b16 v[72:73], v18 offset:16384
ds_read_b64_tr_b16 v[74:75], v18 offset:20480
ds_read_b128 v[32:35], v9 offset:50176
ds_read_b128 v[36:39], v9 offset:51200
ds_read_b128 v[40:43], v9 offset:52224
s_waitcnt lgkmcnt(0)
v_mfma_f32_16x16x32_bf16 v[124:127], v[44:47], v[28:31], 0
ds_read_b128 v[76:79], v9 offset:57344
v_mfma_f32_16x16x32_bf16 v[128:131], v[48:51], v[28:31], 0
ds_read_b64_tr_b16 v[92:93], v15 offset:8192
v_mfma_f32_16x16x32_bf16 v[132:135], v[52:55], v[28:31], 0
ds_read_b64_tr_b16 v[94:95], v15 offset:12288
v_mfma_f32_16x16x32_bf16 v[136:139], v[56:59], v[28:31], 0
ds_read_b64_tr_b16 v[96:97], v16 offset:8192
v_mfma_f32_16x16x32_bf16 v[140:143], v[60:63], v[28:31], 0
ds_read_b64_tr_b16 v[98:99], v16 offset:12288
v_mfma_f32_16x16x32_bf16 v[144:147], v[64:67], v[28:31], 0
ds_read_b64_tr_b16 v[100:101], v17 offset:8192
v_mfma_f32_16x16x32_bf16 v[148:151], v[68:71], v[28:31], 0
ds_read_b64_tr_b16 v[102:103], v17 offset:12288
v_mfma_f32_16x16x32_bf16 v[152:155], v[72:75], v[28:31], 0
ds_read_b64_tr_b16 v[104:105], v18 offset:8192
v_mfma_f32_16x16x32_bf16 v[184:187], v[72:75], v[32:35], 0
ds_read_b64_tr_b16 v[106:107], v18 offset:12288
v_mfma_f32_16x16x32_bf16 v[180:183], v[68:71], v[32:35], 0
ds_read_b64_tr_b16 v[108:109], v15 offset:24576
v_mfma_f32_16x16x32_bf16 v[176:179], v[64:67], v[32:35], 0
ds_read_b64_tr_b16 v[110:111], v15 offset:28672
v_mfma_f32_16x16x32_bf16 v[172:175], v[60:63], v[32:35], 0
ds_read_b64_tr_b16 v[112:113], v16 offset:24576
v_mfma_f32_16x16x32_bf16 v[168:171], v[56:59], v[32:35], 0
ds_read_b64_tr_b16 v[114:115], v16 offset:28672
v_mfma_f32_16x16x32_bf16 v[164:167], v[52:55], v[32:35], 0
ds_read_b64_tr_b16 v[116:117], v17 offset:24576
v_mfma_f32_16x16x32_bf16 v[160:163], v[48:51], v[32:35], 0
ds_read_b64_tr_b16 v[118:119], v17 offset:28672
v_mfma_f32_16x16x32_bf16 v[156:159], v[44:47], v[32:35], 0
ds_read_b64_tr_b16 v[120:121], v18 offset:24576
v_mfma_f32_16x16x32_bf16 v[188:191], v[44:47], v[36:39], 0
ds_read_b64_tr_b16 v[122:123], v18 offset:28672
v_mfma_f32_16x16x32_bf16 v[192:195], v[48:51], v[36:39], 0
ds_read_b128 v[80:83], v9 offset:58368
v_mfma_f32_16x16x32_bf16 v[196:199], v[52:55], v[36:39], 0
ds_read_b128 v[84:87], v9 offset:59392
v_mfma_f32_16x16x32_bf16 v[200:203], v[56:59], v[36:39], 0
ds_read_b128 v[88:91], v9 offset:60416
v_mfma_f32_16x16x32_bf16 v[204:207], v[60:63], v[36:39], 0
v_mfma_f32_16x16x32_bf16 v[208:211], v[64:67], v[36:39], 0
v_mfma_f32_16x16x32_bf16 v[212:215], v[68:71], v[36:39], 0
v_mfma_f32_16x16x32_bf16 v[216:219], v[72:75], v[36:39], 0
v_mfma_f32_16x16x32_bf16 v[248:251], v[72:75], v[40:43], 0
v_mfma_f32_16x16x32_bf16 v[244:247], v[68:71], v[40:43], 0
v_mfma_f32_16x16x32_bf16 v[240:243], v[64:67], v[40:43], 0
v_mfma_f32_16x16x32_bf16 v[236:239], v[60:63], v[40:43], 0
v_mfma_f32_16x16x32_bf16 v[232:235], v[56:59], v[40:43], 0
v_mfma_f32_16x16x32_bf16 v[228:231], v[52:55], v[40:43], 0
v_mfma_f32_16x16x32_bf16 v[224:227], v[48:51], v[40:43], 0
v_mfma_f32_16x16x32_bf16 v[220:223], v[44:47], v[40:43], 0
s_waitcnt vmcnt(0)
s_waitcnt lgkmcnt(0)
s_barrier
v_mfma_f32_16x16x32_bf16 v[124:127], v[92:95], v[76:79], v[124:127]
ds_read_b128 v[28:31], v10 offset:0
v_mfma_f32_16x16x32_bf16 v[128:131], v[96:99], v[76:79], v[128:131]
ds_read_b64_tr_b16 v[44:45], v19 offset:0
v_mfma_f32_16x16x32_bf16 v[132:135], v[100:103], v[76:79], v[132:135]
ds_read_b64_tr_b16 v[46:47], v19 offset:4096
v_mfma_f32_16x16x32_bf16 v[136:139], v[104:107], v[76:79], v[136:139]
ds_read_b64_tr_b16 v[48:49], v20 offset:0
v_mfma_f32_16x16x32_bf16 v[140:143], v[108:111], v[76:79], v[140:143]
ds_read_b64_tr_b16 v[50:51], v20 offset:4096
v_mfma_f32_16x16x32_bf16 v[144:147], v[112:115], v[76:79], v[144:147]
ds_read_b64_tr_b16 v[52:53], v21 offset:0
v_mfma_f32_16x16x32_bf16 v[148:151], v[116:119], v[76:79], v[148:151]
ds_read_b64_tr_b16 v[54:55], v21 offset:4096
v_mfma_f32_16x16x32_bf16 v[152:155], v[120:123], v[76:79], v[152:155]
ds_read_b64_tr_b16 v[56:57], v22 offset:0
v_mfma_f32_16x16x32_bf16 v[184:187], v[120:123], v[80:83], v[184:187]
ds_read_b64_tr_b16 v[58:59], v22 offset:4096
v_mfma_f32_16x16x32_bf16 v[180:183], v[116:119], v[80:83], v[180:183]
ds_read_b64_tr_b16 v[60:61], v19 offset:16384
v_mfma_f32_16x16x32_bf16 v[176:179], v[112:115], v[80:83], v[176:179]
ds_read_b64_tr_b16 v[62:63], v19 offset:20480
v_mfma_f32_16x16x32_bf16 v[172:175], v[108:111], v[80:83], v[172:175]
ds_read_b64_tr_b16 v[64:65], v20 offset:16384
v_mfma_f32_16x16x32_bf16 v[168:171], v[104:107], v[80:83], v[168:171]
ds_read_b64_tr_b16 v[66:67], v20 offset:20480
v_mfma_f32_16x16x32_bf16 v[164:167], v[100:103], v[80:83], v[164:167]
ds_read_b64_tr_b16 v[68:69], v21 offset:16384
v_mfma_f32_16x16x32_bf16 v[160:163], v[96:99], v[80:83], v[160:163]
ds_read_b64_tr_b16 v[70:71], v21 offset:20480
v_mfma_f32_16x16x32_bf16 v[156:159], v[92:95], v[80:83], v[156:159]
ds_read_b64_tr_b16 v[72:73], v22 offset:16384
v_mfma_f32_16x16x32_bf16 v[188:191], v[92:95], v[84:87], v[188:191]
ds_read_b64_tr_b16 v[74:75], v22 offset:20480
v_mfma_f32_16x16x32_bf16 v[192:195], v[96:99], v[84:87], v[192:195]
ds_read_b128 v[32:35], v10 offset:1024
v_mfma_f32_16x16x32_bf16 v[196:199], v[100:103], v[84:87], v[196:199]
ds_read_b128 v[36:39], v10 offset:2048
v_mfma_f32_16x16x32_bf16 v[200:203], v[104:107], v[84:87], v[200:203]
ds_read_b128 v[40:43], v10 offset:3072
v_mfma_f32_16x16x32_bf16 v[204:207], v[108:111], v[84:87], v[204:207]
v_mfma_f32_16x16x32_bf16 v[208:211], v[112:115], v[84:87], v[208:211]
v_mfma_f32_16x16x32_bf16 v[212:215], v[116:119], v[84:87], v[212:215]
v_mfma_f32_16x16x32_bf16 v[216:219], v[120:123], v[84:87], v[216:219]
v_mfma_f32_16x16x32_bf16 v[248:251], v[120:123], v[88:91], v[248:251]
v_mfma_f32_16x16x32_bf16 v[244:247], v[116:119], v[88:91], v[244:247]
v_mfma_f32_16x16x32_bf16 v[240:243], v[112:115], v[88:91], v[240:243]
v_mfma_f32_16x16x32_bf16 v[236:239], v[108:111], v[88:91], v[236:239]
v_mfma_f32_16x16x32_bf16 v[232:235], v[104:107], v[88:91], v[232:235]
v_mfma_f32_16x16x32_bf16 v[228:231], v[100:103], v[88:91], v[228:231]
v_mfma_f32_16x16x32_bf16 v[224:227], v[96:99], v[88:91], v[224:227]
v_mfma_f32_16x16x32_bf16 v[220:223], v[92:95], v[88:91], v[220:223]
s_mov_b32 s41, 5
Lk3l_126:
s_waitcnt lgkmcnt(0)
v_mfma_f32_16x16x32_bf16 v[124:127], v[44:47], v[28:31], v[124:127]
ds_read_b128 v[76:79], v10 offset:8192
v_mfma_f32_16x16x32_bf16 v[128:131], v[48:51], v[28:31], v[128:131]
ds_read_b64_tr_b16 v[92:93], v19 offset:8192
v_mfma_f32_16x16x32_bf16 v[132:135], v[52:55], v[28:31], v[132:135]
ds_read_b64_tr_b16 v[94:95], v19 offset:12288
v_mfma_f32_16x16x32_bf16 v[136:139], v[56:59], v[28:31], v[136:139]
ds_read_b64_tr_b16 v[96:97], v20 offset:8192
v_mfma_f32_16x16x32_bf16 v[140:143], v[60:63], v[28:31], v[140:143]
ds_read_b64_tr_b16 v[98:99], v20 offset:12288
v_mfma_f32_16x16x32_bf16 v[144:147], v[64:67], v[28:31], v[144:147]
ds_read_b64_tr_b16 v[100:101], v21 offset:8192
v_mfma_f32_16x16x32_bf16 v[148:151], v[68:71], v[28:31], v[148:151]
ds_read_b64_tr_b16 v[102:103], v21 offset:12288
v_mfma_f32_16x16x32_bf16 v[152:155], v[72:75], v[28:31], v[152:155]
ds_read_b64_tr_b16 v[104:105], v22 offset:8192
v_mfma_f32_16x16x32_bf16 v[184:187], v[72:75], v[32:35], v[184:187]
ds_read_b64_tr_b16 v[106:107], v22 offset:12288
v_mfma_f32_16x16x32_bf16 v[180:183], v[68:71], v[32:35], v[180:183]
ds_read_b64_tr_b16 v[108:109], v19 offset:24576
v_mfma_f32_16x16x32_bf16 v[176:179], v[64:67], v[32:35], v[176:179]
ds_read_b64_tr_b16 v[110:111], v19 offset:28672
v_mfma_f32_16x16x32_bf16 v[172:175], v[60:63], v[32:35], v[172:175]
ds_read_b64_tr_b16 v[112:113], v20 offset:24576
v_mfma_f32_16x16x32_bf16 v[168:171], v[56:59], v[32:35], v[168:171]
ds_read_b64_tr_b16 v[114:115], v20 offset:28672
v_mfma_f32_16x16x32_bf16 v[164:167], v[52:55], v[32:35], v[164:167]
ds_read_b64_tr_b16 v[116:117], v21 offset:24576
v_mfma_f32_16x16x32_bf16 v[160:163], v[48:51], v[32:35], v[160:163]
ds_read_b64_tr_b16 v[118:119], v21 offset:28672
v_mfma_f32_16x16x32_bf16 v[156:159], v[44:47], v[32:35], v[156:159]
ds_read_b64_tr_b16 v[120:121], v22 offset:24576
v_mfma_f32_16x16x32_bf16 v[188:191], v[44:47], v[36:39], v[188:191]
ds_read_b64_tr_b16 v[122:123], v22 offset:28672
v_mfma_f32_16x16x32_bf16 v[192:195], v[48:51], v[36:39], v[192:195]
ds_read_b128 v[80:83], v10 offset:9216
v_mfma_f32_16x16x32_bf16 v[196:199], v[52:55], v[36:39], v[196:199]
ds_read_b128 v[84:87], v10 offset:10240
v_mfma_f32_16x16x32_bf16 v[200:203], v[56:59], v[36:39], v[200:203]
ds_read_b128 v[88:91], v10 offset:11264
v_mfma_f32_16x16x32_bf16 v[204:207], v[60:63], v[36:39], v[204:207]
v_mfma_f32_16x16x32_bf16 v[208:211], v[64:67], v[36:39], v[208:211]
v_mfma_f32_16x16x32_bf16 v[212:215], v[68:71], v[36:39], v[212:215]
v_mfma_f32_16x16x32_bf16 v[216:219], v[72:75], v[36:39], v[216:219]
v_mfma_f32_16x16x32_bf16 v[248:251], v[72:75], v[40:43], v[248:251]
v_mfma_f32_16x16x32_bf16 v[244:247], v[68:71], v[40:43], v[244:247]
v_mfma_f32_16x16x32_bf16 v[240:243], v[64:67], v[40:43], v[240:243]
v_mfma_f32_16x16x32_bf16 v[236:239], v[60:63], v[40:43], v[236:239]
v_mfma_f32_16x16x32_bf16 v[232:235], v[56:59], v[40:43], v[232:235]
v_mfma_f32_16x16x32_bf16 v[228:231], v[52:55], v[40:43], v[228:231]
v_mfma_f32_16x16x32_bf16 v[224:227], v[48:51], v[40:43], v[224:227]
v_mfma_f32_16x16x32_bf16 v[220:223], v[44:47], v[40:43], v[220:223]
s_waitcnt lgkmcnt(0)
s_barrier
v_mfma_f32_16x16x32_bf16 v[124:127], v[92:95], v[76:79], v[124:127]
ds_read_b128 v[28:31], v9 offset:0
v_mfma_f32_16x16x32_bf16 v[128:131], v[96:99], v[76:79], v[128:131]
ds_read_b64_tr_b16 v[44:45], v11 offset:0
v_mfma_f32_16x16x32_bf16 v[132:135], v[100:103], v[76:79], v[132:135]
ds_read_b64_tr_b16 v[46:47], v11 offset:4096
v_mfma_f32_16x16x32_bf16 v[136:139], v[104:107], v[76:79], v[136:139]
ds_read_b64_tr_b16 v[48:49], v12 offset:0
v_mfma_f32_16x16x32_bf16 v[140:143], v[108:111], v[76:79], v[140:143]
ds_read_b64_tr_b16 v[50:51], v12 offset:4096
v_mfma_f32_16x16x32_bf16 v[144:147], v[112:115], v[76:79], v[144:147]
ds_read_b64_tr_b16 v[52:53], v13 offset:0
v_mfma_f32_16x16x32_bf16 v[148:151], v[116:119], v[76:79], v[148:151]
ds_read_b64_tr_b16 v[54:55], v13 offset:4096
v_mfma_f32_16x16x32_bf16 v[152:155], v[120:123], v[76:79], v[152:155]
ds_read_b64_tr_b16 v[56:57], v14 offset:0
v_mfma_f32_16x16x32_bf16 v[184:187], v[120:123], v[80:83], v[184:187]
ds_read_b64_tr_b16 v[58:59], v14 offset:4096
v_mfma_f32_16x16x32_bf16 v[180:183], v[116:119], v[80:83], v[180:183]
ds_read_b64_tr_b16 v[60:61], v11 offset:16384
v_mfma_f32_16x16x32_bf16 v[176:179], v[112:115], v[80:83], v[176:179]
ds_read_b64_tr_b16 v[62:63], v11 offset:20480
v_mfma_f32_16x16x32_bf16 v[172:175], v[108:111], v[80:83], v[172:175]
ds_read_b64_tr_b16 v[64:65], v12 offset:16384
v_mfma_f32_16x16x32_bf16 v[168:171], v[104:107], v[80:83], v[168:171]
ds_read_b64_tr_b16 v[66:67], v12 offset:20480
v_mfma_f32_16x16x32_bf16 v[164:167], v[100:103], v[80:83], v[164:167]
ds_read_b64_tr_b16 v[68:69], v13 offset:16384
v_mfma_f32_16x16x32_bf16 v[160:163], v[96:99], v[80:83], v[160:163]
ds_read_b64_tr_b16 v[70:71], v13 offset:20480
v_mfma_f32_16x16x32_bf16 v[156:159], v[92:95], v[80:83], v[156:159]
ds_read_b64_tr_b16 v[72:73], v14 offset:16384
v_mfma_f32_16x16x32_bf16 v[188:191], v[92:95], v[84:87], v[188:191]
ds_read_b64_tr_b16 v[74:75], v14 offset:20480
v_mfma_f32_16x16x32_bf16 v[192:195], v[96:99], v[84:87], v[192:195]
ds_read_b128 v[32:35], v9 offset:1024
v_mfma_f32_16x16x32_bf16 v[196:199], v[100:103], v[84:87], v[196:199]
ds_read_b128 v[36:39], v9 offset:2048
v_mfma_f32_16x16x32_bf16 v[200:203], v[104:107], v[84:87], v[200:203]
ds_read_b128 v[40:43], v9 offset:3072
v_mfma_f32_16x16x32_bf16 v[204:207], v[108:111], v[84:87], v[204:207]
v_mfma_f32_16x16x32_bf16 v[208:211], v[112:115], v[84:87], v[208:211]
v_mfma_f32_16x16x32_bf16 v[212:215], v[116:119], v[84:87], v[212:215]
v_mfma_f32_16x16x32_bf16 v[216:219], v[120:123], v[84:87], v[216:219]
v_mfma_f32_16x16x32_bf16 v[248:251], v[120:123], v[88:91], v[248:251]
v_mfma_f32_16x16x32_bf16 v[244:247], v[116:119], v[88:91], v[244:247]
v_mfma_f32_16x16x32_bf16 v[240:243], v[112:115], v[88:91], v[240:243]
v_mfma_f32_16x16x32_bf16 v[236:239], v[108:111], v[88:91], v[236:239]
v_mfma_f32_16x16x32_bf16 v[232:235], v[104:107], v[88:91], v[232:235]
v_mfma_f32_16x16x32_bf16 v[228:231], v[100:103], v[88:91], v[228:231]
v_mfma_f32_16x16x32_bf16 v[224:227], v[96:99], v[88:91], v[224:227]
v_mfma_f32_16x16x32_bf16 v[220:223], v[92:95], v[88:91], v[220:223]
s_waitcnt lgkmcnt(0)
v_mfma_f32_16x16x32_bf16 v[124:127], v[44:47], v[28:31], v[124:127]
ds_read_b128 v[76:79], v9 offset:8192
v_mfma_f32_16x16x32_bf16 v[128:131], v[48:51], v[28:31], v[128:131]
ds_read_b64_tr_b16 v[92:93], v11 offset:8192
v_mfma_f32_16x16x32_bf16 v[132:135], v[52:55], v[28:31], v[132:135]
ds_read_b64_tr_b16 v[94:95], v11 offset:12288
v_mfma_f32_16x16x32_bf16 v[136:139], v[56:59], v[28:31], v[136:139]
ds_read_b64_tr_b16 v[96:97], v12 offset:8192
v_mfma_f32_16x16x32_bf16 v[140:143], v[60:63], v[28:31], v[140:143]
ds_read_b64_tr_b16 v[98:99], v12 offset:12288
v_mfma_f32_16x16x32_bf16 v[144:147], v[64:67], v[28:31], v[144:147]
ds_read_b64_tr_b16 v[100:101], v13 offset:8192
v_mfma_f32_16x16x32_bf16 v[148:151], v[68:71], v[28:31], v[148:151]
ds_read_b64_tr_b16 v[102:103], v13 offset:12288
v_mfma_f32_16x16x32_bf16 v[152:155], v[72:75], v[28:31], v[152:155]
ds_read_b64_tr_b16 v[104:105], v14 offset:8192
v_mfma_f32_16x16x32_bf16 v[184:187], v[72:75], v[32:35], v[184:187]
ds_read_b64_tr_b16 v[106:107], v14 offset:12288
v_mfma_f32_16x16x32_bf16 v[180:183], v[68:71], v[32:35], v[180:183]
ds_read_b64_tr_b16 v[108:109], v11 offset:24576
v_mfma_f32_16x16x32_bf16 v[176:179], v[64:67], v[32:35], v[176:179]
ds_read_b64_tr_b16 v[110:111], v11 offset:28672
v_mfma_f32_16x16x32_bf16 v[172:175], v[60:63], v[32:35], v[172:175]
ds_read_b64_tr_b16 v[112:113], v12 offset:24576
v_mfma_f32_16x16x32_bf16 v[168:171], v[56:59], v[32:35], v[168:171]
ds_read_b64_tr_b16 v[114:115], v12 offset:28672
v_mfma_f32_16x16x32_bf16 v[164:167], v[52:55], v[32:35], v[164:167]
ds_read_b64_tr_b16 v[116:117], v13 offset:24576
v_mfma_f32_16x16x32_bf16 v[160:163], v[48:51], v[32:35], v[160:163]
ds_read_b64_tr_b16 v[118:119], v13 offset:28672
v_mfma_f32_16x16x32_bf16 v[156:159], v[44:47], v[32:35], v[156:159]
ds_read_b64_tr_b16 v[120:121], v14 offset:24576
v_mfma_f32_16x16x32_bf16 v[188:191], v[44:47], v[36:39], v[188:191]
ds_read_b64_tr_b16 v[122:123], v14 offset:28672
v_mfma_f32_16x16x32_bf16 v[192:195], v[48:51], v[36:39], v[192:195]
ds_read_b128 v[80:83], v9 offset:9216
v_mfma_f32_16x16x32_bf16 v[196:199], v[52:55], v[36:39], v[196:199]
ds_read_b128 v[84:87], v9 offset:10240
v_mfma_f32_16x16x32_bf16 v[200:203], v[56:59], v[36:39], v[200:203]
ds_read_b128 v[88:91], v9 offset:11264
v_mfma_f32_16x16x32_bf16 v[204:207], v[60:63], v[36:39], v[204:207]
v_mfma_f32_16x16x32_bf16 v[208:211], v[64:67], v[36:39], v[208:211]
v_mfma_f32_16x16x32_bf16 v[212:215], v[68:71], v[36:39], v[212:215]
v_mfma_f32_16x16x32_bf16 v[216:219], v[72:75], v[36:39], v[216:219]
v_mfma_f32_16x16x32_bf16 v[248:251], v[72:75], v[40:43], v[248:251]
v_mfma_f32_16x16x32_bf16 v[244:247], v[68:71], v[40:43], v[244:247]
v_mfma_f32_16x16x32_bf16 v[240:243], v[64:67], v[40:43], v[240:243]
v_mfma_f32_16x16x32_bf16 v[236:239], v[60:63], v[40:43], v[236:239]
v_mfma_f32_16x16x32_bf16 v[232:235], v[56:59], v[40:43], v[232:235]
v_mfma_f32_16x16x32_bf16 v[228:231], v[52:55], v[40:43], v[228:231]
v_mfma_f32_16x16x32_bf16 v[224:227], v[48:51], v[40:43], v[224:227]
v_mfma_f32_16x16x32_bf16 v[220:223], v[44:47], v[40:43], v[220:223]
s_waitcnt lgkmcnt(0)
s_barrier
v_mfma_f32_16x16x32_bf16 v[124:127], v[92:95], v[76:79], v[124:127]
ds_read_b128 v[28:31], v9 offset:49152
v_mfma_f32_16x16x32_bf16 v[128:131], v[96:99], v[76:79], v[128:131]
ds_read_b64_tr_b16 v[44:45], v15 offset:0
v_mfma_f32_16x16x32_bf16 v[132:135], v[100:103], v[76:79], v[132:135]
ds_read_b64_tr_b16 v[46:47], v15 offset:4096
v_mfma_f32_16x16x32_bf16 v[136:139], v[104:107], v[76:79], v[136:139]
ds_read_b64_tr_b16 v[48:49], v16 offset:0
v_mfma_f32_16x16x32_bf16 v[140:143], v[108:111], v[76:79], v[140:143]
ds_read_b64_tr_b16 v[50:51], v16 offset:4096
v_mfma_f32_16x16x32_bf16 v[144:147], v[112:115], v[76:79], v[144:147]
ds_read_b64_tr_b16 v[52:53], v17 offset:0
v_mfma_f32_16x16x32_bf16 v[148:151], v[116:119], v[76:79], v[148:151]
ds_read_b64_tr_b16 v[54:55], v17 offset:4096
v_mfma_f32_16x16x32_bf16 v[152:155], v[120:123], v[76:79], v[152:155]
ds_read_b64_tr_b16 v[56:57], v18 offset:0
v_mfma_f32_16x16x32_bf16 v[184:187], v[120:123], v[80:83], v[184:187]
ds_read_b64_tr_b16 v[58:59], v18 offset:4096
v_mfma_f32_16x16x32_bf16 v[180:183], v[116:119], v[80:83], v[180:183]
ds_read_b64_tr_b16 v[60:61], v15 offset:16384
v_mfma_f32_16x16x32_bf16 v[176:179], v[112:115], v[80:83], v[176:179]
ds_read_b64_tr_b16 v[62:63], v15 offset:20480
v_mfma_f32_16x16x32_bf16 v[172:175], v[108:111], v[80:83], v[172:175]
ds_read_b64_tr_b16 v[64:65], v16 offset:16384
v_mfma_f32_16x16x32_bf16 v[168:171], v[104:107], v[80:83], v[168:171]
ds_read_b64_tr_b16 v[66:67], v16 offset:20480
v_mfma_f32_16x16x32_bf16 v[164:167], v[100:103], v[80:83], v[164:167]
ds_read_b64_tr_b16 v[68:69], v17 offset:16384
v_mfma_f32_16x16x32_bf16 v[160:163], v[96:99], v[80:83], v[160:163]
ds_read_b64_tr_b16 v[70:71], v17 offset:20480
v_mfma_f32_16x16x32_bf16 v[156:159], v[92:95], v[80:83], v[156:159]
ds_read_b64_tr_b16 v[72:73], v18 offset:16384
v_mfma_f32_16x16x32_bf16 v[188:191], v[92:95], v[84:87], v[188:191]
ds_read_b64_tr_b16 v[74:75], v18 offset:20480
v_mfma_f32_16x16x32_bf16 v[192:195], v[96:99], v[84:87], v[192:195]
ds_read_b128 v[32:35], v9 offset:50176
v_mfma_f32_16x16x32_bf16 v[196:199], v[100:103], v[84:87], v[196:199]
ds_read_b128 v[36:39], v9 offset:51200
v_mfma_f32_16x16x32_bf16 v[200:203], v[104:107], v[84:87], v[200:203]
ds_read_b128 v[40:43], v9 offset:52224
v_mfma_f32_16x16x32_bf16 v[204:207], v[108:111], v[84:87], v[204:207]
v_mfma_f32_16x16x32_bf16 v[208:211], v[112:115], v[84:87], v[208:211]
v_mfma_f32_16x16x32_bf16 v[212:215], v[116:119], v[84:87], v[212:215]
v_mfma_f32_16x16x32_bf16 v[216:219], v[120:123], v[84:87], v[216:219]
v_mfma_f32_16x16x32_bf16 v[248:251], v[120:123], v[88:91], v[248:251]
v_mfma_f32_16x16x32_bf16 v[244:247], v[116:119], v[88:91], v[244:247]
v_mfma_f32_16x16x32_bf16 v[240:243], v[112:115], v[88:91], v[240:243]
v_mfma_f32_16x16x32_bf16 v[236:239], v[108:111], v[88:91], v[236:239]
v_mfma_f32_16x16x32_bf16 v[232:235], v[104:107], v[88:91], v[232:235]
v_mfma_f32_16x16x32_bf16 v[228:231], v[100:103], v[88:91], v[228:231]
v_mfma_f32_16x16x32_bf16 v[224:227], v[96:99], v[88:91], v[224:227]
v_mfma_f32_16x16x32_bf16 v[220:223], v[92:95], v[88:91], v[220:223]
s_waitcnt lgkmcnt(0)
v_mfma_f32_16x16x32_bf16 v[124:127], v[44:47], v[28:31], v[124:127]
ds_read_b128 v[76:79], v9 offset:57344
v_mfma_f32_16x16x32_bf16 v[128:131], v[48:51], v[28:31], v[128:131]
ds_read_b64_tr_b16 v[92:93], v15 offset:8192
v_mfma_f32_16x16x32_bf16 v[132:135], v[52:55], v[28:31], v[132:135]
ds_read_b64_tr_b16 v[94:95], v15 offset:12288
v_mfma_f32_16x16x32_bf16 v[136:139], v[56:59], v[28:31], v[136:139]
ds_read_b64_tr_b16 v[96:97], v16 offset:8192
v_mfma_f32_16x16x32_bf16 v[140:143], v[60:63], v[28:31], v[140:143]
ds_read_b64_tr_b16 v[98:99], v16 offset:12288
v_mfma_f32_16x16x32_bf16 v[144:147], v[64:67], v[28:31], v[144:147]
ds_read_b64_tr_b16 v[100:101], v17 offset:8192
v_mfma_f32_16x16x32_bf16 v[148:151], v[68:71], v[28:31], v[148:151]
ds_read_b64_tr_b16 v[102:103], v17 offset:12288
v_mfma_f32_16x16x32_bf16 v[152:155], v[72:75], v[28:31], v[152:155]
ds_read_b64_tr_b16 v[104:105], v18 offset:8192
v_mfma_f32_16x16x32_bf16 v[184:187], v[72:75], v[32:35], v[184:187]
ds_read_b64_tr_b16 v[106:107], v18 offset:12288
v_mfma_f32_16x16x32_bf16 v[180:183], v[68:71], v[32:35], v[180:183]
ds_read_b64_tr_b16 v[108:109], v15 offset:24576
v_mfma_f32_16x16x32_bf16 v[176:179], v[64:67], v[32:35], v[176:179]
ds_read_b64_tr_b16 v[110:111], v15 offset:28672
v_mfma_f32_16x16x32_bf16 v[172:175], v[60:63], v[32:35], v[172:175]
ds_read_b64_tr_b16 v[112:113], v16 offset:24576
v_mfma_f32_16x16x32_bf16 v[168:171], v[56:59], v[32:35], v[168:171]
ds_read_b64_tr_b16 v[114:115], v16 offset:28672
v_mfma_f32_16x16x32_bf16 v[164:167], v[52:55], v[32:35], v[164:167]
ds_read_b64_tr_b16 v[116:117], v17 offset:24576
v_mfma_f32_16x16x32_bf16 v[160:163], v[48:51], v[32:35], v[160:163]
ds_read_b64_tr_b16 v[118:119], v17 offset:28672
v_mfma_f32_16x16x32_bf16 v[156:159], v[44:47], v[32:35], v[156:159]
ds_read_b64_tr_b16 v[120:121], v18 offset:24576
v_mfma_f32_16x16x32_bf16 v[188:191], v[44:47], v[36:39], v[188:191]
s_branch Lov_15
.p2align 12
Lst_15_0:
s_branch Lwr_162
s_nop 0
s_nop 0
Lov_15:
ds_read_b64_tr_b16 v[122:123], v18 offset:28672
v_mfma_f32_16x16x32_bf16 v[192:195], v[48:51], v[36:39], v[192:195]
ds_read_b128 v[80:83], v9 offset:58368
v_mfma_f32_16x16x32_bf16 v[196:199], v[52:55], v[36:39], v[196:199]
ds_read_b128 v[84:87], v9 offset:59392
v_mfma_f32_16x16x32_bf16 v[200:203], v[56:59], v[36:39], v[200:203]
ds_read_b128 v[88:91], v9 offset:60416
v_mfma_f32_16x16x32_bf16 v[204:207], v[60:63], v[36:39], v[204:207]
v_mfma_f32_16x16x32_bf16 v[208:211], v[64:67], v[36:39], v[208:211]
v_mfma_f32_16x16x32_bf16 v[212:215], v[68:71], v[36:39], v[212:215]
v_mfma_f32_16x16x32_bf16 v[216:219], v[72:75], v[36:39], v[216:219]
v_mfma_f32_16x16x32_bf16 v[248:251], v[72:75], v[40:43], v[248:251]
v_mfma_f32_16x16x32_bf16 v[244:247], v[68:71], v[40:43], v[244:247]
v_mfma_f32_16x16x32_bf16 v[240:243], v[64:67], v[40:43], v[240:243]
v_mfma_f32_16x16x32_bf16 v[236:239], v[60:63], v[40:43], v[236:239]
v_mfma_f32_16x16x32_bf16 v[232:235], v[56:59], v[40:43], v[232:235]
v_mfma_f32_16x16x32_bf16 v[228:231], v[52:55], v[40:43], v[228:231]
v_mfma_f32_16x16x32_bf16 v[224:227], v[48:51], v[40:43], v[224:227]
v_mfma_f32_16x16x32_bf16 v[220:223], v[44:47], v[40:43], v[220:223]
s_waitcnt lgkmcnt(0)
s_barrier
v_mfma_f32_16x16x32_bf16 v[124:127], v[92:95], v[76:79], v[124:127]
ds_read_b128 v[28:31], v10 offset:0
v_mfma_f32_16x16x32_bf16 v[128:131], v[96:99], v[76:79], v[128:131]
ds_read_b64_tr_b16 v[44:45], v19 offset:0
v_mfma_f32_16x16x32_bf16 v[132:135], v[100:103], v[76:79], v[132:135]
ds_read_b64_tr_b16 v[46:47], v19 offset:4096
v_mfma_f32_16x16x32_bf16 v[136:139], v[104:107], v[76:79], v[136:139]
ds_read_b64_tr_b16 v[48:49], v20 offset:0
v_mfma_f32_16x16x32_bf16 v[140:143], v[108:111], v[76:79], v[140:143]
ds_read_b64_tr_b16 v[50:51], v20 offset:4096
v_mfma_f32_16x16x32_bf16 v[144:147], v[112:115], v[76:79], v[144:147]
ds_read_b64_tr_b16 v[52:53], v21 offset:0
v_mfma_f32_16x16x32_bf16 v[148:151], v[116:119], v[76:79], v[148:151]
ds_read_b64_tr_b16 v[54:55], v21 offset:4096
v_mfma_f32_16x16x32_bf16 v[152:155], v[120:123], v[76:79], v[152:155]
ds_read_b64_tr_b16 v[56:57], v22 offset:0
v_mfma_f32_16x16x32_bf16 v[184:187], v[120:123], v[80:83], v[184:187]
ds_read_b64_tr_b16 v[58:59], v22 offset:4096
v_mfma_f32_16x16x32_bf16 v[180:183], v[116:119], v[80:83], v[180:183]
ds_read_b64_tr_b16 v[60:61], v19 offset:16384
v_mfma_f32_16x16x32_bf16 v[176:179], v[112:115], v[80:83], v[176:179]
ds_read_b64_tr_b16 v[62:63], v19 offset:20480
v_mfma_f32_16x16x32_bf16 v[172:175], v[108:111], v[80:83], v[172:175]
ds_read_b64_tr_b16 v[64:65], v20 offset:16384
v_mfma_f32_16x16x32_bf16 v[168:171], v[104:107], v[80:83], v[168:171]
ds_read_b64_tr_b16 v[66:67], v20 offset:20480
v_mfma_f32_16x16x32_bf16 v[164:167], v[100:103], v[80:83], v[164:167]
ds_read_b64_tr_b16 v[68:69], v21 offset:16384
v_mfma_f32_16x16x32_bf16 v[160:163], v[96:99], v[80:83], v[160:163]
ds_read_b64_tr_b16 v[70:71], v21 offset:20480
v_mfma_f32_16x16x32_bf16 v[156:159], v[92:95], v[80:83], v[156:159]
ds_read_b64_tr_b16 v[72:73], v22 offset:16384
v_mfma_f32_16x16x32_bf16 v[188:191], v[92:95], v[84:87], v[188:191]
ds_read_b64_tr_b16 v[74:75], v22 offset:20480
v_mfma_f32_16x16x32_bf16 v[192:195], v[96:99], v[84:87], v[192:195]
ds_read_b128 v[32:35], v10 offset:1024
v_mfma_f32_16x16x32_bf16 v[196:199], v[100:103], v[84:87], v[196:199]
ds_read_b128 v[36:39], v10 offset:2048
v_mfma_f32_16x16x32_bf16 v[200:203], v[104:107], v[84:87], v[200:203]
ds_read_b128 v[40:43], v10 offset:3072
v_mfma_f32_16x16x32_bf16 v[204:207], v[108:111], v[84:87], v[204:207]
v_mfma_f32_16x16x32_bf16 v[208:211], v[112:115], v[84:87], v[208:211]
v_mfma_f32_16x16x32_bf16 v[212:215], v[116:119], v[84:87], v[212:215]
v_mfma_f32_16x16x32_bf16 v[216:219], v[120:123], v[84:87], v[216:219]
v_mfma_f32_16x16x32_bf16 v[248:251], v[120:123], v[88:91], v[248:251]
v_mfma_f32_16x16x32_bf16 v[244:247], v[116:119], v[88:91], v[244:247]
v_mfma_f32_16x16x32_bf16 v[240:243], v[112:115], v[88:91], v[240:243]
v_mfma_f32_16x16x32_bf16 v[236:239], v[108:111], v[88:91], v[236:239]
v_mfma_f32_16x16x32_bf16 v[232:235], v[104:107], v[88:91], v[232:235]
v_mfma_f32_16x16x32_bf16 v[228:231], v[100:103], v[88:91], v[228:231]
v_mfma_f32_16x16x32_bf16 v[224:227], v[96:99], v[88:91], v[224:227]
v_mfma_f32_16x16x32_bf16 v[220:223], v[92:95], v[88:91], v[220:223]
s_sub_u32 s41, s41, 1
s_cmp_lg_u32 s41, 0
s_cbranch_scc1 Lk3l_126
s_waitcnt lgkmcnt(0)
v_lshrrev_b32 v84, 4, v1
s_lshl_b32 s43, s63, 8
s_add_u32 s43, s43, 148480
v_lshl_add_u32 v85, v84, 4, s43
v_and_b32 v84, 15, v1
s_lshl_b32 s43, s62, 9
s_add_u32 s43, s43, 147456
v_lshl_add_u32 v84, v84, 3, s43
ds_read_b128 v[28:31], v85 offset:0
ds_read_b128 v[32:35], v85 offset:64
ds_read_b128 v[36:39], v85 offset:128
ds_read_b128 v[40:43], v85 offset:192
ds_read_b128 v[44:47], v85 offset:896
ds_read_b128 v[48:51], v85 offset:960
ds_read_b128 v[52:55], v85 offset:1024
ds_read_b128 v[56:59], v85 offset:1088
ds_read_b64 v[60:61], v84 offset:0
ds_read_b64 v[62:63], v84 offset:128
ds_read_b64 v[64:65], v84 offset:256
ds_read_b64 v[66:67], v84 offset:384
s_lshl_b32 s54, s35, 15
s_lshl_b32 s43, s63, 14
s_add_u32 s54, s54, s43
s_lshl_b32 s43, s62, 12
s_add_u32 s54, s54, s43
s_add_u32 s55, s54, 8192
v_lshrrev_b32 v122, 3, v1
v_and_b32 v123, 6, v122
v_and_b32 v25, 7, v1
v_xor_b32 v25, v25, v123
v_lshlrev_b32 v25, 4, v25
v_mul_u32_u24 v122, 2048, v122
v_add_u32 v25, v25, v122
s_lshl_b32 s43, s61, 7
s_lshl_b32 s44, s47, 15
s_add_u32 s43, s43, s44
v_add_u32 v25, s43, v25
s_waitcnt lgkmcnt(0)
s_barrier
s_add_u32 m0, s39, 81920
s_add_u32 s37, s52, 589824
buffer_load_dwordx4 v3, s[24:27], s37 offen sc1 lds
v_mul_f32 v70, v61, v61
v_mul_f32 v68, 0xc0135761, v61
v_mul_f32 v69, 0xbdd2d3e8, v61
v_mul_f32 v69, v69, v70
v_rcp_f32 v70, v70
v_mul_f32 v74, v63, v63
v_mul_f32 v72, 0xc0135761, v63
v_mul_f32 v73, 0xbdd2d3e8, v63
v_mul_f32 v73, v73, v74
v_rcp_f32 v74, v74
buffer_load_dwordx4 v3, s[24:27], s37 offen offset:1024 sc1 lds
v_fma_f32 v124, -v60, v28, v124
v_fma_f32 v125, -v60, v29, v125
v_fma_f32 v126, -v60, v30, v126
v_fma_f32 v127, -v60, v31, v127
v_fma_f32 v156, -v62, v28, v156
v_fma_f32 v157, -v62, v29, v157
v_fma_f32 v158, -v62, v30, v158
v_fma_f32 v159, -v62, v31, v159
v_mul_f32 v76, v124, v124
v_mul_f32 v77, v125, v125
buffer_load_dwordx4 v3, s[24:27], s37 offen offset:2048 sc1 lds
v_mul_f32 v78, v126, v126
v_mul_f32 v79, v127, v127
v_mul_f32 v80, v156, v156
v_mul_f32 v81, v157, v157
v_mul_f32 v82, v158, v158
v_mul_f32 v83, v159, v159
v_fma_f32 v76, v76, v69, v68
v_fma_f32 v77, v77, v69, v68
v_fma_f32 v78, v78, v69, v68
v_fma_f32 v79, v79, v69, v68
buffer_load_dwordx4 v3, s[24:27], s37 offen offset:3072 sc1 lds
v_fma_f32 v80, v80, v73, v72
v_fma_f32 v81, v81, v73, v72
v_fma_f32 v82, v82, v73, v72
v_fma_f32 v83, v83, v73, v72
v_mul_f32 v76, v76, v124
v_mul_f32 v77, v77, v125
v_mul_f32 v78, v78, v126
v_mul_f32 v79, v79, v127
v_mul_f32 v80, v80, v156
v_mul_f32 v81, v81, v157
s_add_u32 m0, s39, 147456
s_add_u32 s38, s53, 4718592
buffer_load_dwordx4 v23, s[28:31], s38 offen lds
v_mul_f32 v82, v82, v158
v_mul_f32 v83, v83, v159
v_exp_f32 v76, v76
v_exp_f32 v77, v77
v_exp_f32 v78, v78
v_exp_f32 v79, v79
v_exp_f32 v80, v80
v_exp_f32 v81, v81
v_exp_f32 v82, v82
v_exp_f32 v83, v83
s_add_u32 m0, s39, 148480
s_add_u32 s38, s53, 4718592
buffer_load_dwordx4 v24, s[28:31], s38 offen lds
v_fma_f32 v140, -v60, v44, v140
v_fma_f32 v141, -v60, v45, v141
v_fma_f32 v142, -v60, v46, v142
v_fma_f32 v143, -v60, v47, v143
v_fma_f32 v172, -v62, v44, v172
v_fma_f32 v173, -v62, v45, v173
v_fma_f32 v174, -v62, v46, v174
v_fma_f32 v175, -v62, v47, v175
v_fma_f32 v76, v76, v70, v70
v_fma_f32 v77, v77, v70, v70
s_add_u32 m0, s39, 149504
s_add_u32 s38, s53, 4734976
buffer_load_dwordx4 v23, s[28:31], s38 offen lds
v_fma_f32 v78, v78, v70, v70
v_fma_f32 v79, v79, v70, v70
v_fma_f32 v80, v80, v74, v74
v_fma_f32 v81, v81, v74, v74
v_fma_f32 v82, v82, v74, v74
v_fma_f32 v83, v83, v74, v74
v_rcp_f32 v76, v76
v_rcp_f32 v77, v77
v_rcp_f32 v78, v78
v_rcp_f32 v79, v79
s_add_u32 m0, s39, 150528
s_add_u32 s38, s53, 4734976
buffer_load_dwordx4 v24, s[28:31], s38 offen lds
v_rcp_f32 v80, v80
v_rcp_f32 v81, v81
v_rcp_f32 v82, v82
v_rcp_f32 v83, v83
v_mul_f32 v140, v124, v140
v_mul_f32 v141, v125, v141
v_mul_f32 v142, v126, v142
v_mul_f32 v143, v127, v143
v_mul_f32 v172, v156, v172
v_mul_f32 v173, v157, v173
s_add_u32 m0, s39, 98304
s_add_u32 s37, s52, 606208
buffer_load_dwordx4 v3, s[24:27], s37 offen sc1 lds
v_mul_f32 v174, v158, v174
v_mul_f32 v175, v159, v175
v_mul_f32 v140, v140, v76
v_mul_f32 v141, v141, v77
v_mul_f32 v142, v142, v78
v_mul_f32 v143, v143, v79
v_mul_f32 v172, v172, v80
v_mul_f32 v173, v173, v81
v_mul_f32 v174, v174, v82
v_mul_f32 v175, v175, v83
buffer_load_dwordx4 v3, s[24:27], s37 offen offset:1024 sc1 lds
v_cvt_pk_bf16_f32 v124, v140, v141
v_cvt_pk_bf16_f32 v125, v142, v143
v_cvt_pk_bf16_f32 v156, v172, v173
v_cvt_pk_bf16_f32 v157, v174, v175
v_fma_f32 v128, -v60, v32, v128
v_fma_f32 v129, -v60, v33, v129
v_fma_f32 v130, -v60, v34, v130
v_fma_f32 v131, -v60, v35, v131
v_fma_f32 v160, -v62, v32, v160
v_fma_f32 v161, -v62, v33, v161
buffer_load_dwordx4 v3, s[24:27], s37 offen offset:2048 sc1 lds
v_fma_f32 v162, -v62, v34, v162
v_fma_f32 v163, -v62, v35, v163
v_mul_f32 v76, v128, v128
v_mul_f32 v77, v129, v129
v_mul_f32 v78, v130, v130
v_mul_f32 v79, v131, v131
v_mul_f32 v80, v160, v160
v_mul_f32 v81, v161, v161
v_mul_f32 v82, v162, v162
v_mul_f32 v83, v163, v163
buffer_load_dwordx4 v3, s[24:27], s37 offen offset:3072 sc1 lds
v_fma_f32 v76, v76, v69, v68
v_fma_f32 v77, v77, v69, v68
v_fma_f32 v78, v78, v69, v68
v_fma_f32 v79, v79, v69, v68
v_fma_f32 v80, v80, v73, v72
v_fma_f32 v81, v81, v73, v72
v_fma_f32 v82, v82, v73, v72
v_fma_f32 v83, v83, v73, v72
v_mul_f32 v76, v76, v128
v_mul_f32 v77, v77, v129
s_add_u32 m0, s39, 114688
s_add_u32 s38, s53, 4849664
buffer_load_dwordx4 v23, s[28:31], s38 offen lds
v_mul_f32 v78, v78, v130
v_mul_f32 v79, v79, v131
v_mul_f32 v80, v80, v160
v_mul_f32 v81, v81, v161
v_mul_f32 v82, v82, v162
v_mul_f32 v83, v83, v163
v_exp_f32 v76, v76
v_exp_f32 v77, v77
v_exp_f32 v78, v78
v_exp_f32 v79, v79
s_add_u32 m0, s39, 115712
s_add_u32 s38, s53, 4849664
buffer_load_dwordx4 v24, s[28:31], s38 offen lds
v_exp_f32 v80, v80
v_exp_f32 v81, v81
v_exp_f32 v82, v82
v_exp_f32 v83, v83
v_fma_f32 v144, -v60, v48, v144
v_fma_f32 v145, -v60, v49, v145
v_fma_f32 v146, -v60, v50, v146
v_fma_f32 v147, -v60, v51, v147
v_fma_f32 v176, -v62, v48, v176
v_fma_f32 v177, -v62, v49, v177
s_add_u32 m0, s39, 116736
s_add_u32 s38, s53, 4866048
buffer_load_dwordx4 v23, s[28:31], s38 offen lds
s_add_u32 m0, s39, 117760
s_add_u32 s38, s53, 4866048
buffer_load_dwordx4 v24, s[28:31], s38 offen lds
s_barrier
s_add_u32 m0, s39, 131072
s_add_u32 s37, s52, 622592
buffer_load_dwordx4 v3, s[24:27], s37 offen sc1 lds
v_fma_f32 v178, -v62, v50, v178
v_fma_f32 v179, -v62, v51, v179
v_fma_f32 v76, v76, v70, v70
v_fma_f32 v77, v77, v70, v70
v_fma_f32 v78, v78, v70, v70
v_fma_f32 v79, v79, v70, v70
v_fma_f32 v80, v80, v74, v74
v_fma_f32 v81, v81, v74, v74
v_fma_f32 v82, v82, v74, v74
v_fma_f32 v83, v83, v74, v74
v_rcp_f32 v76, v76
v_rcp_f32 v77, v77
v_rcp_f32 v78, v78
v_rcp_f32 v79, v79
v_rcp_f32 v80, v80
v_rcp_f32 v81, v81
v_rcp_f32 v82, v82
v_rcp_f32 v83, v83
v_mul_f32 v144, v128, v144
v_mul_f32 v145, v129, v145
v_mul_f32 v146, v130, v146
v_mul_f32 v147, v131, v147
v_mul_f32 v176, v160, v176
buffer_load_dwordx4 v3, s[24:27], s37 offen offset:1024 sc1 lds
v_mul_f32 v177, v161, v177
v_mul_f32 v178, v162, v178
v_mul_f32 v179, v163, v179
v_mul_f32 v144, v144, v76
v_mul_f32 v145, v145, v77
v_mul_f32 v146, v146, v78
v_mul_f32 v147, v147, v79
v_mul_f32 v176, v176, v80
v_mul_f32 v177, v177, v81
v_mul_f32 v178, v178, v82
v_mul_f32 v179, v179, v83
v_cvt_pk_bf16_f32 v126, v144, v145
v_cvt_pk_bf16_f32 v127, v146, v147
v_cvt_pk_bf16_f32 v158, v176, v177
v_cvt_pk_bf16_f32 v159, v178, v179
buffer_store_dwordx4 v[124:127], v2, s[24:27], s54 offen offset:0 sc1
buffer_store_dwordx4 v[156:159], v2, s[24:27], s54 offen offset:1024 sc1
v_fma_f32 v132, -v60, v36, v132
v_fma_f32 v133, -v60, v37, v133
v_fma_f32 v134, -v60, v38, v134
v_fma_f32 v135, -v60, v39, v135
v_fma_f32 v164, -v62, v36, v164
v_fma_f32 v165, -v62, v37, v165
buffer_load_dwordx4 v3, s[24:27], s37 offen offset:2048 sc1 lds
v_fma_f32 v166, -v62, v38, v166
v_fma_f32 v167, -v62, v39, v167
v_mul_f32 v76, v132, v132
v_mul_f32 v77, v133, v133
v_mul_f32 v78, v134, v134
v_mul_f32 v79, v135, v135
v_mul_f32 v80, v164, v164
v_mul_f32 v81, v165, v165
v_mul_f32 v82, v166, v166
v_mul_f32 v83, v167, v167
v_fma_f32 v76, v76, v69, v68
v_fma_f32 v77, v77, v69, v68
v_fma_f32 v78, v78, v69, v68
v_fma_f32 v79, v79, v69, v68
v_fma_f32 v80, v80, v73, v72
v_fma_f32 v81, v81, v73, v72
v_fma_f32 v82, v82, v73, v72
v_fma_f32 v83, v83, v73, v72
v_mul_f32 v76, v76, v132
v_mul_f32 v77, v77, v133
v_mul_f32 v78, v78, v134
v_mul_f32 v79, v79, v135
v_mul_f32 v80, v80, v164
v_mul_f32 v81, v81, v165
buffer_load_dwordx4 v3, s[24:27], s37 offen offset:3072 sc1 lds
v_mul_f32 v82, v82, v166
v_mul_f32 v83, v83, v167
v_exp_f32 v76, v76
v_exp_f32 v77, v77
v_exp_f32 v78, v78
v_exp_f32 v79, v79
v_exp_f32 v80, v80
v_exp_f32 v81, v81
v_exp_f32 v82, v82
v_exp_f32 v83, v83
v_fma_f32 v148, -v60, v52, v148
v_fma_f32 v149, -v60, v53, v149
v_fma_f32 v150, -v60, v54, v150
v_fma_f32 v151, -v60, v55, v151
v_fma_f32 v180, -v62, v52, v180
v_fma_f32 v181, -v62, v53, v181
v_fma_f32 v182, -v62, v54, v182
v_fma_f32 v183, -v62, v55, v183
v_fma_f32 v76, v76, v70, v70
v_fma_f32 v77, v77, v70, v70
v_fma_f32 v78, v78, v70, v70
v_fma_f32 v79, v79, v70, v70
v_fma_f32 v80, v80, v74, v74
s_add_u32 m0, s39, 0
s_add_u32 s38, s53, 4980736
buffer_load_dwordx4 v23, s[28:31], s38 offen lds
v_fma_f32 v81, v81, v74, v74
v_fma_f32 v82, v82, v74, v74
v_fma_f32 v83, v83, v74, v74
v_rcp_f32 v76, v76
v_rcp_f32 v77, v77
v_rcp_f32 v78, v78
v_rcp_f32 v79, v79
v_rcp_f32 v80, v80
v_rcp_f32 v81, v81
v_rcp_f32 v82, v82
v_rcp_f32 v83, v83
v_mul_f32 v148, v132, v148
v_mul_f32 v149, v133, v149
v_mul_f32 v150, v134, v150
v_mul_f32 v151, v135, v151
v_mul_f32 v180, v164, v180
v_mul_f32 v181, v165, v181
v_mul_f32 v182, v166, v182
v_mul_f32 v183, v167, v183
v_mul_f32 v148, v148, v76
v_mul_f32 v149, v149, v77
v_mul_f32 v150, v150, v78
v_mul_f32 v151, v151, v79
s_add_u32 m0, s39, 1024
s_add_u32 s38, s53, 4980736
buffer_load_dwordx4 v24, s[28:31], s38 offen lds
v_mul_f32 v180, v180, v80
v_mul_f32 v181, v181, v81
v_mul_f32 v182, v182, v82
v_mul_f32 v183, v183, v83
v_cvt_pk_bf16_f32 v132, v148, v149
v_cvt_pk_bf16_f32 v133, v150, v151
v_cvt_pk_bf16_f32 v164, v180, v181
v_cvt_pk_bf16_f32 v165, v182, v183
v_fma_f32 v136, -v60, v40, v136
v_fma_f32 v137, -v60, v41, v137
v_fma_f32 v138, -v60, v42, v138
v_fma_f32 v139, -v60, v43, v139
v_fma_f32 v168, -v62, v40, v168
v_fma_f32 v169, -v62, v41, v169
v_fma_f32 v170, -v62, v42, v170
v_fma_f32 v171, -v62, v43, v171
v_mul_f32 v76, v136, v136
v_mul_f32 v77, v137, v137
v_mul_f32 v78, v138, v138
v_mul_f32 v79, v139, v139
v_mul_f32 v80, v168, v168
v_mul_f32 v81, v169, v169
v_mul_f32 v82, v170, v170
v_mul_f32 v83, v171, v171
s_add_u32 m0, s39, 2048
s_add_u32 s38, s53, 4997120
buffer_load_dwordx4 v23, s[28:31], s38 offen lds
s_add_u32 m0, s39, 3072
s_add_u32 s38, s53, 4997120
buffer_load_dwordx4 v24, s[28:31], s38 offen lds
s_barrier
s_add_u32 m0, s39, 16384
s_add_u32 s37, s52, 638976
buffer_load_dwordx4 v3, s[24:27], s37 offen sc1 lds
v_fma_f32 v76, v76, v69, v68
v_fma_f32 v77, v77, v69, v68
v_fma_f32 v78, v78, v69, v68
v_fma_f32 v79, v79, v69, v68
v_fma_f32 v80, v80, v73, v72
v_fma_f32 v81, v81, v73, v72
v_fma_f32 v82, v82, v73, v72
v_fma_f32 v83, v83, v73, v72
v_mul_f32 v76, v76, v136
v_mul_f32 v77, v77, v137
v_mul_f32 v78, v78, v138
v_mul_f32 v79, v79, v139
v_mul_f32 v80, v80, v168
v_mul_f32 v81, v81, v169
v_mul_f32 v82, v82, v170
v_mul_f32 v83, v83, v171
v_exp_f32 v76, v76
v_exp_f32 v77, v77
v_exp_f32 v78, v78
v_exp_f32 v79, v79
v_exp_f32 v80, v80
v_exp_f32 v81, v81
v_exp_f32 v82, v82
buffer_load_dwordx4 v3, s[24:27], s37 offen offset:1024 sc1 lds
v_exp_f32 v83, v83
v_fma_f32 v152, -v60, v56, v152
v_fma_f32 v153, -v60, v57, v153
v_fma_f32 v154, -v60, v58, v154
v_fma_f32 v155, -v60, v59, v155
v_fma_f32 v184, -v62, v56, v184
v_fma_f32 v185, -v62, v57, v185
v_fma_f32 v186, -v62, v58, v186
v_fma_f32 v187, -v62, v59, v187
v_fma_f32 v76, v76, v70, v70
v_fma_f32 v77, v77, v70, v70
v_fma_f32 v78, v78, v70, v70
v_fma_f32 v79, v79, v70, v70
v_fma_f32 v80, v80, v74, v74
v_fma_f32 v81, v81, v74, v74
v_fma_f32 v82, v82, v74, v74
v_fma_f32 v83, v83, v74, v74
v_rcp_f32 v76, v76
v_rcp_f32 v77, v77
v_rcp_f32 v78, v78
v_rcp_f32 v79, v79
v_rcp_f32 v80, v80
v_rcp_f32 v81, v81
buffer_load_dwordx4 v3, s[24:27], s37 offen offset:2048 sc1 lds
v_rcp_f32 v82, v82
v_rcp_f32 v83, v83
v_mul_f32 v152, v136, v152
v_mul_f32 v153, v137, v153
v_mul_f32 v154, v138, v154
v_mul_f32 v155, v139, v155
v_mul_f32 v184, v168, v184
v_mul_f32 v185, v169, v185
v_mul_f32 v186, v170, v186
v_mul_f32 v187, v171, v187
v_mul_f32 v152, v152, v76
v_mul_f32 v153, v153, v77
v_mul_f32 v154, v154, v78
v_mul_f32 v155, v155, v79
v_mul_f32 v184, v184, v80
v_mul_f32 v185, v185, v81
v_mul_f32 v186, v186, v82
v_mul_f32 v187, v187, v83
v_cvt_pk_bf16_f32 v134, v152, v153
v_cvt_pk_bf16_f32 v135, v154, v155
v_cvt_pk_bf16_f32 v166, v184, v185
v_cvt_pk_bf16_f32 v167, v186, v187
buffer_store_dwordx4 v[132:135], v2, s[24:27], s55 offen offset:0 sc1
buffer_store_dwordx4 v[164:167], v2, s[24:27], s55 offen offset:1024 sc1
buffer_load_dwordx4 v3, s[24:27], s37 offen offset:3072 sc1 lds
v_mul_f32 v70, v65, v65
v_mul_f32 v68, 0xc0135761, v65
v_mul_f32 v69, 0xbdd2d3e8, v65
v_mul_f32 v69, v69, v70
v_rcp_f32 v70, v70
v_mul_f32 v74, v67, v67
v_mul_f32 v72, 0xc0135761, v67
v_mul_f32 v73, 0xbdd2d3e8, v67
v_mul_f32 v73, v73, v74
v_rcp_f32 v74, v74
v_fma_f32 v188, -v64, v28, v188
v_fma_f32 v189, -v64, v29, v189
v_fma_f32 v190, -v64, v30, v190
v_fma_f32 v191, -v64, v31, v191
v_fma_f32 v220, -v66, v28, v220
v_fma_f32 v221, -v66, v29, v221
v_fma_f32 v222, -v66, v30, v222
v_fma_f32 v223, -v66, v31, v223
v_mul_f32 v76, v188, v188
v_mul_f32 v77, v189, v189
v_mul_f32 v78, v190, v190
v_mul_f32 v79, v191, v191
v_mul_f32 v80, v220, v220
s_add_u32 m0, s39, 32768
s_add_u32 s38, s53, 5111808
buffer_load_dwordx4 v23, s[28:31], s38 offen lds
v_mul_f32 v81, v221, v221
v_mul_f32 v82, v222, v222
v_mul_f32 v83, v223, v223
v_fma_f32 v76, v76, v69, v68
v_fma_f32 v77, v77, v69, v68
v_fma_f32 v78, v78, v69, v68
v_fma_f32 v79, v79, v69, v68
v_fma_f32 v80, v80, v73, v72
v_fma_f32 v81, v81, v73, v72
v_fma_f32 v82, v82, v73, v72
v_fma_f32 v83, v83, v73, v72
v_mul_f32 v76, v76, v188
v_mul_f32 v77, v77, v189
v_mul_f32 v78, v78, v190
v_mul_f32 v79, v79, v191
v_mul_f32 v80, v80, v220
v_mul_f32 v81, v81, v221
v_mul_f32 v82, v82, v222
v_mul_f32 v83, v83, v223
v_exp_f32 v76, v76
v_exp_f32 v77, v77
v_exp_f32 v78, v78
v_exp_f32 v79, v79
s_add_u32 m0, s39, 33792
s_add_u32 s38, s53, 5111808
buffer_load_dwordx4 v24, s[28:31], s38 offen lds
v_exp_f32 v80, v80
v_exp_f32 v81, v81
v_exp_f32 v82, v82
v_exp_f32 v83, v83
v_fma_f32 v204, -v64, v44, v204
v_fma_f32 v205, -v64, v45, v205
v_fma_f32 v206, -v64, v46, v206
v_fma_f32 v207, -v64, v47, v207
v_fma_f32 v236, -v66, v44, v236
v_fma_f32 v237, -v66, v45, v237
v_fma_f32 v238, -v66, v46, v238
v_fma_f32 v239, -v66, v47, v239
v_fma_f32 v76, v76, v70, v70
v_fma_f32 v77, v77, v70, v70
v_fma_f32 v78, v78, v70, v70
v_fma_f32 v79, v79, v70, v70
v_fma_f32 v80, v80, v74, v74
v_fma_f32 v81, v81, v74, v74
v_fma_f32 v82, v82, v74, v74
v_fma_f32 v83, v83, v74, v74
v_rcp_f32 v76, v76
v_rcp_f32 v77, v77
v_rcp_f32 v78, v78
v_rcp_f32 v79, v79
s_add_u32 m0, s39, 34816
s_add_u32 s38, s53, 5128192
buffer_load_dwordx4 v23, s[28:31], s38 offen lds
s_add_u32 m0, s39, 35840
s_add_u32 s38, s53, 5128192
buffer_load_dwordx4 v24, s[28:31], s38 offen lds
s_waitcnt vmcnt(28)
s_barrier
s_add_u32 m0, s39, 49152
s_add_u32 s37, s52, 655360
buffer_load_dwordx4 v3, s[24:27], s37 offen sc1 lds
v_rcp_f32 v80, v80
v_rcp_f32 v81, v81
v_rcp_f32 v82, v82
v_rcp_f32 v83, v83
v_mul_f32 v204, v188, v204
v_mul_f32 v205, v189, v205
v_mul_f32 v206, v190, v206
v_mul_f32 v207, v191, v207
v_mul_f32 v236, v220, v236
v_mul_f32 v237, v221, v237
v_mul_f32 v238, v222, v238
v_mul_f32 v239, v223, v239
v_mul_f32 v204, v204, v76
v_mul_f32 v205, v205, v77
v_mul_f32 v206, v206, v78
v_mul_f32 v207, v207, v79
v_mul_f32 v236, v236, v80
v_mul_f32 v237, v237, v81
v_mul_f32 v238, v238, v82
v_mul_f32 v239, v239, v83
v_cvt_pk_bf16_f32 v188, v204, v205
v_cvt_pk_bf16_f32 v189, v206, v207
v_cvt_pk_bf16_f32 v220, v236, v237
buffer_load_dwordx4 v3, s[24:27], s37 offen offset:1024 sc1 lds
v_cvt_pk_bf16_f32 v221, v238, v239
v_fma_f32 v192, -v64, v32, v192
v_fma_f32 v193, -v64, v33, v193
v_fma_f32 v194, -v64, v34, v194
v_fma_f32 v195, -v64, v35, v195
v_fma_f32 v224, -v66, v32, v224
v_fma_f32 v225, -v66, v33, v225
v_fma_f32 v226, -v66, v34, v226
v_fma_f32 v227, -v66, v35, v227
v_mul_f32 v76, v192, v192
v_mul_f32 v77, v193, v193
v_mul_f32 v78, v194, v194
v_mul_f32 v79, v195, v195
v_mul_f32 v80, v224, v224
v_mul_f32 v81, v225, v225
v_mul_f32 v82, v226, v226
v_mul_f32 v83, v227, v227
s_branch Lov_16
.p2align 12
Lst_16_0:
s_branch Lwr_163
s_nop 0
s_nop 0
Lov_16:
v_fma_f32 v76, v76, v69, v68
v_fma_f32 v77, v77, v69, v68
v_fma_f32 v78, v78, v69, v68
v_fma_f32 v79, v79, v69, v68
v_fma_f32 v80, v80, v73, v72
v_fma_f32 v81, v81, v73, v72
buffer_load_dwordx4 v3, s[24:27], s37 offen offset:2048 sc1 lds
v_fma_f32 v82, v82, v73, v72
v_fma_f32 v83, v83, v73, v72
v_mul_f32 v76, v76, v192
v_mul_f32 v77, v77, v193
v_mul_f32 v78, v78, v194
v_mul_f32 v79, v79, v195
v_mul_f32 v80, v80, v224
v_mul_f32 v81, v81, v225
v_mul_f32 v82, v82, v226
v_mul_f32 v83, v83, v227
v_exp_f32 v76, v76
v_exp_f32 v77, v77
v_exp_f32 v78, v78
v_exp_f32 v79, v79
v_exp_f32 v80, v80
v_exp_f32 v81, v81
v_exp_f32 v82, v82
v_exp_f32 v83, v83
v_fma_f32 v208, -v64, v48, v208
v_fma_f32 v209, -v64, v49, v209
v_fma_f32 v210, -v64, v50, v210
v_fma_f32 v211, -v64, v51, v211
v_fma_f32 v240, -v66, v48, v240
v_fma_f32 v241, -v66, v49, v241
buffer_load_dwordx4 v3, s[24:27], s37 offen offset:3072 sc1 lds
v_fma_f32 v242, -v66, v50, v242
v_fma_f32 v243, -v66, v51, v243
v_fma_f32 v76, v76, v70, v70
v_fma_f32 v77, v77, v70, v70
v_fma_f32 v78, v78, v70, v70
v_fma_f32 v79, v79, v70, v70
v_fma_f32 v80, v80, v74, v74
v_fma_f32 v81, v81, v74, v74
v_fma_f32 v82, v82, v74, v74
v_fma_f32 v83, v83, v74, v74
v_rcp_f32 v76, v76
v_rcp_f32 v77, v77
v_rcp_f32 v78, v78
v_rcp_f32 v79, v79
v_rcp_f32 v80, v80
v_rcp_f32 v81, v81
v_rcp_f32 v82, v82
v_rcp_f32 v83, v83
v_mul_f32 v208, v192, v208
v_mul_f32 v209, v193, v209
v_mul_f32 v210, v194, v210
v_mul_f32 v211, v195, v211
v_mul_f32 v240, v224, v240
s_add_u32 m0, s39, 65536
s_add_u32 s38, s53, 5242880
buffer_load_dwordx4 v23, s[28:31], s38 offen lds
v_mul_f32 v241, v225, v241
v_mul_f32 v242, v226, v242
v_mul_f32 v243, v227, v243
v_mul_f32 v208, v208, v76
v_mul_f32 v209, v209, v77
v_mul_f32 v210, v210, v78
v_mul_f32 v211, v211, v79
v_mul_f32 v240, v240, v80
v_mul_f32 v241, v241, v81
v_mul_f32 v242, v242, v82
v_mul_f32 v243, v243, v83
v_cvt_pk_bf16_f32 v190, v208, v209
v_cvt_pk_bf16_f32 v191, v210, v211
v_cvt_pk_bf16_f32 v222, v240, v241
v_cvt_pk_bf16_f32 v223, v242, v243
buffer_store_dwordx4 v[188:191], v2, s[24:27], s54 offen offset:2048 sc1
buffer_store_dwordx4 v[220:223], v2, s[24:27], s54 offen offset:3072 sc1
v_fma_f32 v196, -v64, v36, v196
v_fma_f32 v197, -v64, v37, v197
v_fma_f32 v198, -v64, v38, v198
v_fma_f32 v199, -v64, v39, v199
v_fma_f32 v228, -v66, v36, v228
v_fma_f32 v229, -v66, v37, v229
s_add_u32 m0, s39, 66560
s_add_u32 s38, s53, 5242880
buffer_load_dwordx4 v24, s[28:31], s38 offen lds
v_fma_f32 v230, -v66, v38, v230
v_fma_f32 v231, -v66, v39, v231
v_mul_f32 v76, v196, v196
v_mul_f32 v77, v197, v197
v_mul_f32 v78, v198, v198
v_mul_f32 v79, v199, v199
v_mul_f32 v80, v228, v228
v_mul_f32 v81, v229, v229
v_mul_f32 v82, v230, v230
v_mul_f32 v83, v231, v231
v_fma_f32 v76, v76, v69, v68
v_fma_f32 v77, v77, v69, v68
v_fma_f32 v78, v78, v69, v68
v_fma_f32 v79, v79, v69, v68
v_fma_f32 v80, v80, v73, v72
v_fma_f32 v81, v81, v73, v72
v_fma_f32 v82, v82, v73, v72
v_fma_f32 v83, v83, v73, v72
v_mul_f32 v76, v76, v196
v_mul_f32 v77, v77, v197
v_mul_f32 v78, v78, v198
v_mul_f32 v79, v79, v199
v_mul_f32 v80, v80, v228
v_mul_f32 v81, v81, v229
s_add_u32 m0, s39, 67584
s_add_u32 s38, s53, 5259264
buffer_load_dwordx4 v23, s[28:31], s38 offen lds
s_add_u32 m0, s39, 68608
s_add_u32 s38, s53, 5259264
buffer_load_dwordx4 v24, s[28:31], s38 offen lds
s_waitcnt vmcnt(30)
s_barrier
s_add_u32 m0, s39, 81920
s_add_u32 s37, s52, 671744
buffer_load_dwordx4 v3, s[24:27], s37 offen sc1 lds
v_mul_f32 v82, v82, v230
v_mul_f32 v83, v83, v231
v_exp_f32 v76, v76
v_exp_f32 v77, v77
v_exp_f32 v78, v78
v_exp_f32 v79, v79
v_exp_f32 v80, v80
v_exp_f32 v81, v81
v_exp_f32 v82, v82
v_exp_f32 v83, v83
v_fma_f32 v212, -v64, v52, v212
v_fma_f32 v213, -v64, v53, v213
v_fma_f32 v214, -v64, v54, v214
v_fma_f32 v215, -v64, v55, v215
v_fma_f32 v244, -v66, v52, v244
v_fma_f32 v245, -v66, v53, v245
v_fma_f32 v246, -v66, v54, v246
v_fma_f32 v247, -v66, v55, v247
v_fma_f32 v76, v76, v70, v70
v_fma_f32 v77, v77, v70, v70
v_fma_f32 v78, v78, v70, v70
v_fma_f32 v79, v79, v70, v70
v_fma_f32 v80, v80, v74, v74
buffer_load_dwordx4 v3, s[24:27], s37 offen offset:1024 sc1 lds
v_fma_f32 v81, v81, v74, v74
v_fma_f32 v82, v82, v74, v74
v_fma_f32 v83, v83, v74, v74
v_rcp_f32 v76, v76
v_rcp_f32 v77, v77
v_rcp_f32 v78, v78
v_rcp_f32 v79, v79
v_rcp_f32 v80, v80
v_rcp_f32 v81, v81
v_rcp_f32 v82, v82
v_rcp_f32 v83, v83
v_mul_f32 v212, v196, v212
v_mul_f32 v213, v197, v213
v_mul_f32 v214, v198, v214
v_mul_f32 v215, v199, v215
v_mul_f32 v244, v228, v244
v_mul_f32 v245, v229, v245
v_mul_f32 v246, v230, v246
v_mul_f32 v247, v231, v247
v_mul_f32 v212, v212, v76
v_mul_f32 v213, v213, v77
v_mul_f32 v214, v214, v78
v_mul_f32 v215, v215, v79
buffer_load_dwordx4 v3, s[24:27], s37 offen offset:2048 sc1 lds
v_mul_f32 v244, v244, v80
v_mul_f32 v245, v245, v81
v_mul_f32 v246, v246, v82
v_mul_f32 v247, v247, v83
v_cvt_pk_bf16_f32 v196, v212, v213
v_cvt_pk_bf16_f32 v197, v214, v215
v_cvt_pk_bf16_f32 v228, v244, v245
v_cvt_pk_bf16_f32 v229, v246, v247
v_fma_f32 v200, -v64, v40, v200
v_fma_f32 v201, -v64, v41, v201
v_fma_f32 v202, -v64, v42, v202
v_fma_f32 v203, -v64, v43, v203
v_fma_f32 v232, -v66, v40, v232
v_fma_f32 v233, -v66, v41, v233
v_fma_f32 v234, -v66, v42, v234
v_fma_f32 v235, -v66, v43, v235
v_mul_f32 v76, v200, v200
v_mul_f32 v77, v201, v201
v_mul_f32 v78, v202, v202
v_mul_f32 v79, v203, v203
v_mul_f32 v80, v232, v232
v_mul_f32 v81, v233, v233
v_mul_f32 v82, v234, v234
v_mul_f32 v83, v235, v235
buffer_load_dwordx4 v3, s[24:27], s37 offen offset:3072 sc1 lds
v_fma_f32 v76, v76, v69, v68
v_fma_f32 v77, v77, v69, v68
v_fma_f32 v78, v78, v69, v68
v_fma_f32 v79, v79, v69, v68
v_fma_f32 v80, v80, v73, v72
v_fma_f32 v81, v81, v73, v72
v_fma_f32 v82, v82, v73, v72
v_fma_f32 v83, v83, v73, v72
v_mul_f32 v76, v76, v200
v_mul_f32 v77, v77, v201
v_mul_f32 v78, v78, v202
v_mul_f32 v79, v79, v203
v_mul_f32 v80, v80, v232
v_mul_f32 v81, v81, v233
v_mul_f32 v82, v82, v234
v_mul_f32 v83, v83, v235
v_exp_f32 v76, v76
v_exp_f32 v77, v77
v_exp_f32 v78, v78
v_exp_f32 v79, v79
v_exp_f32 v80, v80
v_exp_f32 v81, v81
v_exp_f32 v82, v82
s_add_u32 m0, s39, 147456
s_add_u32 s38, s53, 5373952
buffer_load_dwordx4 v23, s[28:31], s38 offen lds
v_exp_f32 v83, v83
v_fma_f32 v216, -v64, v56, v216
v_fma_f32 v217, -v64, v57, v217
v_fma_f32 v218, -v64, v58, v218
v_fma_f32 v219, -v64, v59, v219
v_fma_f32 v248, -v66, v56, v248
v_fma_f32 v249, -v66, v57, v249
v_fma_f32 v250, -v66, v58, v250
v_fma_f32 v251, -v66, v59, v251
v_fma_f32 v76, v76, v70, v70
v_fma_f32 v77, v77, v70, v70
v_fma_f32 v78, v78, v70, v70
v_fma_f32 v79, v79, v70, v70
v_fma_f32 v80, v80, v74, v74
v_fma_f32 v81, v81, v74, v74
v_fma_f32 v82, v82, v74, v74
v_fma_f32 v83, v83, v74, v74
v_rcp_f32 v76, v76
v_rcp_f32 v77, v77
v_rcp_f32 v78, v78
v_rcp_f32 v79, v79
v_rcp_f32 v80, v80
v_rcp_f32 v81, v81
s_add_u32 m0, s39, 148480
s_add_u32 s38, s53, 5373952
buffer_load_dwordx4 v24, s[28:31], s38 offen lds
v_rcp_f32 v82, v82
v_rcp_f32 v83, v83
v_mul_f32 v216, v200, v216
v_mul_f32 v217, v201, v217
v_mul_f32 v218, v202, v218
v_mul_f32 v219, v203, v219
v_mul_f32 v248, v232, v248
v_mul_f32 v249, v233, v249
v_mul_f32 v250, v234, v250
v_mul_f32 v251, v235, v251
v_mul_f32 v216, v216, v76
v_mul_f32 v217, v217, v77
v_mul_f32 v218, v218, v78
v_mul_f32 v219, v219, v79
v_mul_f32 v248, v248, v80
v_mul_f32 v249, v249, v81
v_mul_f32 v250, v250, v82
v_mul_f32 v251, v251, v83
v_cvt_pk_bf16_f32 v198, v216, v217
v_cvt_pk_bf16_f32 v199, v218, v219
v_cvt_pk_bf16_f32 v230, v248, v249
v_cvt_pk_bf16_f32 v231, v250, v251
buffer_store_dwordx4 v[196:199], v2, s[24:27], s55 offen offset:2048 sc1
buffer_store_dwordx4 v[228:231], v2, s[24:27], s55 offen offset:3072 sc1
s_add_u32 m0, s39, 149504
s_add_u32 s38, s53, 5390336
buffer_load_dwordx4 v23, s[28:31], s38 offen lds
s_add_u32 m0, s39, 150528
s_add_u32 s38, s53, 5390336
buffer_load_dwordx4 v24, s[28:31], s38 offen lds
s_waitcnt vmcnt(30)
s_barrier
s_add_u32 m0, s39, 98304
s_add_u32 s37, s52, 688128
buffer_load_dwordx4 v3, s[24:27], s37 offen sc1 lds
buffer_load_dwordx4 v3, s[24:27], s37 offen offset:1024 sc1 lds
buffer_load_dwordx4 v3, s[24:27], s37 offen offset:2048 sc1 lds
buffer_load_dwordx4 v3, s[24:27], s37 offen offset:3072 sc1 lds
s_add_u32 m0, s39, 114688
s_add_u32 s38, s53, 5505024
buffer_load_dwordx4 v23, s[28:31], s38 offen lds
s_add_u32 m0, s39, 115712
s_add_u32 s38, s53, 5505024
buffer_load_dwordx4 v24, s[28:31], s38 offen lds
s_add_u32 m0, s39, 116736
s_add_u32 s38, s53, 5521408
buffer_load_dwordx4 v23, s[28:31], s38 offen lds
s_add_u32 m0, s39, 117760
s_add_u32 s38, s53, 5521408
buffer_load_dwordx4 v24, s[28:31], s38 offen lds
s_waitcnt vmcnt(10)
s_barrier
s_cmp_eq_u32 s47, 0
s_cbranch_scc0 Lw_127
s_add_u32 s7, s34, 48
s_lshl_b32 s7, s7, 7
v_mov_b32 v26, s7
v_mov_b32 v27, 1
s_mov_b64 exec, 1
buffer_atomic_add v27, v26, s[56:59], 0 offen sc1
s_mov_b64 exec, -1
Lw_127:
s_add_u32 m0, s39, 131072
s_add_u32 s37, s52, 704512
buffer_load_dwordx4 v3, s[24:27], s37 offen sc1 lds
buffer_load_dwordx4 v3, s[24:27], s37 offen offset:1024 sc1 lds
buffer_load_dwordx4 v3, s[24:27], s37 offen offset:2048 sc1 lds
buffer_load_dwordx4 v3, s[24:27], s37 offen offset:3072 sc1 lds
s_add_u32 m0, s39, 0
s_add_u32 s38, s53, 5636096
buffer_load_dwordx4 v23, s[28:31], s38 offen lds
s_add_u32 m0, s39, 1024
s_add_u32 s38, s53, 5636096
buffer_load_dwordx4 v24, s[28:31], s38 offen lds
s_add_u32 m0, s39, 2048
s_add_u32 s38, s53, 5652480
buffer_load_dwordx4 v23, s[28:31], s38 offen lds
s_add_u32 m0, s39, 3072
s_add_u32 s38, s53, 5652480
buffer_load_dwordx4 v24, s[28:31], s38 offen lds
s_waitcnt vmcnt(26)
s_barrier
s_add_u32 m0, s39, 32768
s_add_u32 s38, s91, 0
buffer_load_dwordx4 v23, s[28:31], s38 offen lds
s_add_u32 m0, s39, 33792
s_add_u32 s38, s91, 0
buffer_load_dwordx4 v24, s[28:31], s38 offen lds
s_add_u32 m0, s39, 34816
s_add_u32 s38, s91, 16384
buffer_load_dwordx4 v23, s[28:31], s38 offen lds
s_add_u32 m0, s39, 35840
s_add_u32 s38, s91, 16384
buffer_load_dwordx4 v24, s[28:31], s38 offen lds
s_waitcnt vmcnt(20)
s_barrier
s_add_u32 m0, s39, 65536
s_add_u32 s38, s91, 131072
buffer_load_dwordx4 v23, s[28:31], s38 offen lds
s_add_u32 m0, s39, 66560
s_add_u32 s38, s91, 131072
buffer_load_dwordx4 v24, s[28:31], s38 offen lds
s_add_u32 m0, s39, 67584
s_add_u32 s38, s91, 147456
buffer_load_dwordx4 v23, s[28:31], s38 offen lds
s_add_u32 m0, s39, 68608
s_add_u32 s38, s91, 147456
buffer_load_dwordx4 v24, s[28:31], s38 offen lds
s_waitcnt vmcnt(16)
s_barrier
s_cmp_eq_u32 s47, 3
s_cbranch_scc0 Lw_128
s_lshl_b32 s92, s34, 7
s_add_u32 s92, s92, 28317696
s_load_dword s93, s[82:83], s92 glc
Lw_128:
s_add_u32 m0, s39, 147456
s_add_u32 s38, s91, 262144
buffer_load_dwordx4 v23, s[28:31], s38 offen lds
s_add_u32 m0, s39, 148480
s_add_u32 s38, s91, 262144
buffer_load_dwordx4 v24, s[28:31], s38 offen lds
s_add_u32 m0, s39, 149504
s_add_u32 s38, s91, 278528
buffer_load_dwordx4 v23, s[28:31], s38 offen lds
s_add_u32 m0, s39, 150528
s_add_u32 s38, s91, 278528
buffer_load_dwordx4 v24, s[28:31], s38 offen lds
s_waitcnt vmcnt(12)
s_cmp_eq_u32 s47, 3
s_cbranch_scc0 Lw_129
s_mov_b32 s41, 0x40000
s_branch Lpchk_132
Lpoll_130:
s_load_dword s93, s[82:83], s92 glc
Lpchk_132:
s_waitcnt lgkmcnt(0)
s_cmp_eq_u32 s93, 16
s_cbranch_scc1 Lpok_131
s_sub_u32 s41, s41, 1
s_cmp_lg_u32 s41, 0
s_cbranch_scc1 Lpoll_130
Lpok_131:
Lw_129:
s_barrier
s_add_u32 m0, s39, 16384
s_add_u32 s37, s90, 0
buffer_load_dwordx4 v3, s[24:27], s37 offen sc1 lds
buffer_load_dwordx4 v3, s[24:27], s37 offen offset:1024 sc1 lds
buffer_load_dwordx4 v3, s[24:27], s37 offen offset:2048 sc1 lds
buffer_load_dwordx4 v3, s[24:27], s37 offen offset:3072 sc1 lds
s_add_u32 m0, s39, 49152
s_add_u32 s37, s90, 16384
buffer_load_dwordx4 v3, s[24:27], s37 offen sc1 lds
buffer_load_dwordx4 v3, s[24:27], s37 offen offset:1024 sc1 lds
buffer_load_dwordx4 v3, s[24:27], s37 offen offset:2048 sc1 lds
buffer_load_dwordx4 v3, s[24:27], s37 offen offset:3072 sc1 lds
s_add_u32 m0, s39, 81920
s_add_u32 s37, s90, 32768
buffer_load_dwordx4 v3, s[24:27], s37 offen sc1 lds
buffer_load_dwordx4 v3, s[24:27], s37 offen offset:1024 sc1 lds
buffer_load_dwordx4 v3, s[24:27], s37 offen offset:2048 sc1 lds
buffer_load_dwordx4 v3, s[24:27], s37 offen offset:3072 sc1 lds
s_add_u32 m0, s39, 98304
s_add_u32 s37, s90, 49152
buffer_load_dwordx4 v3, s[24:27], s37 offen sc1 lds
buffer_load_dwordx4 v3, s[24:27], s37 offen offset:1024 sc1 lds
buffer_load_dwordx4 v3, s[24:27], s37 offen offset:2048 sc1 lds
buffer_load_dwordx4 v3, s[24:27], s37 offen offset:3072 sc1 lds
s_add_u32 m0, s39, 114688
s_add_u32 s38, s91, 393216
buffer_load_dwordx4 v23, s[28:31], s38 offen lds
s_add_u32 m0, s39, 115712
s_add_u32 s38, s91, 393216
buffer_load_dwordx4 v24, s[28:31], s38 offen lds
s_add_u32 m0, s39, 116736
s_add_u32 s38, s91, 409600
buffer_load_dwordx4 v23, s[28:31], s38 offen lds
s_add_u32 m0, s39, 117760
s_add_u32 s38, s91, 409600
buffer_load_dwordx4 v24, s[28:31], s38 offen lds
s_waitcnt vmcnt(16)
s_barrier
s_add_u32 m0, s39, 131072
s_add_u32 s37, s90, 65536
buffer_load_dwordx4 v3, s[24:27], s37 offen sc1 lds
buffer_load_dwordx4 v3, s[24:27], s37 offen offset:1024 sc1 lds
buffer_load_dwordx4 v3, s[24:27], s37 offen offset:2048 sc1 lds
buffer_load_dwordx4 v3, s[24:27], s37 offen offset:3072 sc1 lds
s_add_u32 m0, s39, 0
s_add_u32 s38, s91, 524288
buffer_load_dwordx4 v23, s[28:31], s38 offen lds
s_add_u32 m0, s39, 1024
s_add_u32 s38, s91, 524288
buffer_load_dwordx4 v24, s[28:31], s38 offen lds
s_add_u32 m0, s39, 2048
s_add_u32 s38, s91, 540672
buffer_load_dwordx4 v23, s[28:31], s38 offen lds
s_add_u32 m0, s39, 3072
s_add_u32 s38, s91, 540672
buffer_load_dwordx4 v24, s[28:31], s38 offen lds
s_waitcnt vmcnt(20)
s_barrier
s_add_u32 m0, s39, 16384
s_add_u32 s37, s90, 81920
buffer_load_dwordx4 v3, s[24:27], s37 offen sc1 lds
buffer_load_dwordx4 v3, s[24:27], s37 offen offset:1024 sc1 lds
buffer_load_dwordx4 v3, s[24:27], s37 offen offset:2048 sc1 lds
buffer_load_dwordx4 v3, s[24:27], s37 offen offset:3072 sc1 lds
s_add_u32 m0, s39, 32768
s_add_u32 s38, s91, 655360
buffer_load_dwordx4 v23, s[28:31], s38 offen lds
s_add_u32 m0, s39, 33792
s_add_u32 s38, s91, 655360
buffer_load_dwordx4 v24, s[28:31], s38 offen lds
s_add_u32 m0, s39, 34816
s_add_u32 s38, s91, 671744
buffer_load_dwordx4 v23, s[28:31], s38 offen lds
s_add_u32 m0, s39, 35840
s_add_u32 s38, s91, 671744
buffer_load_dwordx4 v24, s[28:31], s38 offen lds
s_waitcnt vmcnt(24)
s_barrier
s_add_u32 m0, s39, 49152
s_add_u32 s37, s90, 98304
buffer_load_dwordx4 v3, s[24:27], s37 offen sc1 lds
buffer_load_dwordx4 v3, s[24:27], s37 offen offset:1024 sc1 lds
buffer_load_dwordx4 v3, s[24:27], s37 offen offset:2048 sc1 lds
buffer_load_dwordx4 v3, s[24:27], s37 offen offset:3072 sc1 lds
s_add_u32 m0, s39, 65536
s_add_u32 s38, s91, 786432
buffer_load_dwordx4 v23, s[28:31], s38 offen lds
s_add_u32 m0, s39, 66560
s_add_u32 s38, s91, 786432
buffer_load_dwordx4 v24, s[28:31], s38 offen lds
s_add_u32 m0, s39, 67584
s_add_u32 s38, s91, 802816
buffer_load_dwordx4 v23, s[28:31], s38 offen lds
s_add_u32 m0, s39, 68608
s_add_u32 s38, s91, 802816
buffer_load_dwordx4 v24, s[28:31], s38 offen lds
s_waitcnt vmcnt(24)
s_barrier
s_add_u32 m0, s39, 81920
s_add_u32 s37, s90, 114688
buffer_load_dwordx4 v3, s[24:27], s37 offen sc1 lds
buffer_load_dwordx4 v3, s[24:27], s37 offen offset:1024 sc1 lds
buffer_load_dwordx4 v3, s[24:27], s37 offen offset:2048 sc1 lds
buffer_load_dwordx4 v3, s[24:27], s37 offen offset:3072 sc1 lds
s_add_u32 m0, s39, 147456
s_add_u32 s38, s91, 917504
buffer_load_dwordx4 v23, s[28:31], s38 offen lds
s_add_u32 m0, s39, 148480
s_add_u32 s38, s91, 917504
buffer_load_dwordx4 v24, s[28:31], s38 offen lds
s_add_u32 m0, s39, 149504
s_add_u32 s38, s91, 933888
buffer_load_dwordx4 v23, s[28:31], s38 offen lds
s_add_u32 m0, s39, 150528
s_add_u32 s38, s91, 933888
buffer_load_dwordx4 v24, s[28:31], s38 offen lds
s_waitcnt vmcnt(24)
s_barrier
s_add_u32 m0, s39, 98304
s_add_u32 s37, s90, 131072
buffer_load_dwordx4 v3, s[24:27], s37 offen sc1 lds
buffer_load_dwordx4 v3, s[24:27], s37 offen offset:1024 sc1 lds
buffer_load_dwordx4 v3, s[24:27], s37 offen offset:2048 sc1 lds
buffer_load_dwordx4 v3, s[24:27], s37 offen offset:3072 sc1 lds
s_add_u32 m0, s39, 114688
s_add_u32 s38, s91, 1048576
buffer_load_dwordx4 v23, s[28:31], s38 offen lds
s_add_u32 m0, s39, 115712
s_add_u32 s38, s91, 1048576
buffer_load_dwordx4 v24, s[28:31], s38 offen lds
s_add_u32 m0, s39, 116736
s_add_u32 s38, s91, 1064960
buffer_load_dwordx4 v23, s[28:31], s38 offen lds
s_add_u32 m0, s39, 117760
s_add_u32 s38, s91, 1064960
buffer_load_dwordx4 v24, s[28:31], s38 offen lds
s_waitcnt vmcnt(24)
s_barrier
s_add_u32 m0, s39, 131072
s_add_u32 s37, s90, 147456
buffer_load_dwordx4 v3, s[24:27], s37 offen sc1 lds
buffer_load_dwordx4 v3, s[24:27], s37 offen offset:1024 sc1 lds
buffer_load_dwordx4 v3, s[24:27], s37 offen offset:2048 sc1 lds
buffer_load_dwordx4 v3, s[24:27], s37 offen offset:3072 sc1 lds
s_add_u32 m0, s39, 0
s_add_u32 s38, s91, 1179648
buffer_load_dwordx4 v23, s[28:31], s38 offen lds
s_add_u32 m0, s39, 1024
s_add_u32 s38, s91, 1179648
buffer_load_dwordx4 v24, s[28:31], s38 offen lds
s_add_u32 m0, s39, 2048
s_add_u32 s38, s91, 1196032
buffer_load_dwordx4 v23, s[28:31], s38 offen lds
s_add_u32 m0, s39, 3072
s_add_u32 s38, s91, 1196032
buffer_load_dwordx4 v24, s[28:31], s38 offen lds
s_waitcnt vmcnt(24)
s_barrier
s_add_u32 m0, s39, 16384
s_mov_b32 s37, 327680
buffer_load_dwordx4 v3, s[24:27], s37 offen sc1 lds
buffer_load_dwordx4 v3, s[24:27], s37 offen offset:1024 sc1 lds
buffer_load_dwordx4 v3, s[24:27], s37 offen offset:2048 sc1 lds
buffer_load_dwordx4 v3, s[24:27], s37 offen offset:3072 sc1 lds
s_add_u32 m0, s51, 32768
s_mov_b32 s38, 2621440
buffer_load_dwordx4 v25, s[28:31], s38 offen lds
s_add_u32 m0, s51, 33792
s_mov_b32 s38, 2637824
buffer_load_dwordx4 v25, s[28:31], s38 offen lds
s_waitcnt vmcnt(22)
s_barrier
s_add_u32 m0, s39, 49152
s_mov_b32 s37, 344064
buffer_load_dwordx4 v3, s[24:27], s37 offen sc1 lds
buffer_load_dwordx4 v3, s[24:27], s37 offen offset:1024 sc1 lds
buffer_load_dwordx4 v3, s[24:27], s37 offen offset:2048 sc1 lds
buffer_load_dwordx4 v3, s[24:27], s37 offen offset:3072 sc1 lds
s_add_u32 m0, s51, 65536
s_mov_b32 s38, 2752512
buffer_load_dwordx4 v25, s[28:31], s38 offen lds
s_add_u32 m0, s51, 66560
s_mov_b32 s38, 2768896
buffer_load_dwordx4 v25, s[28:31], s38 offen lds
s_waitcnt vmcnt(20)
s_barrier
s_add_u32 m0, s39, 81920
s_mov_b32 s37, 360448
buffer_load_dwordx4 v3, s[24:27], s37 offen sc1 lds
buffer_load_dwordx4 v3, s[24:27], s37 offen offset:1024 sc1 lds
buffer_load_dwordx4 v3, s[24:27], s37 offen offset:2048 sc1 lds
buffer_load_dwordx4 v3, s[24:27], s37 offen offset:3072 sc1 lds
s_add_u32 m0, s51, 147456
s_mov_b32 s38, 2883584
buffer_load_dwordx4 v25, s[28:31], s38 offen lds
s_add_u32 m0, s51, 148480
s_mov_b32 s38, 2899968
buffer_load_dwordx4 v25, s[28:31], s38 offen lds
s_waitcnt vmcnt(18)
s_barrier
s_add_u32 m0, s39, 98304
s_mov_b32 s37, 376832
buffer_load_dwordx4 v3, s[24:27], s37 offen sc1 lds
buffer_load_dwordx4 v3, s[24:27], s37 offen offset:1024 sc1 lds
buffer_load_dwordx4 v3, s[24:27], s37 offen offset:2048 sc1 lds
buffer_load_dwordx4 v3, s[24:27], s37 offen offset:3072 sc1 lds
s_add_u32 m0, s51, 114688
s_mov_b32 s38, 3014656
buffer_load_dwordx4 v25, s[28:31], s38 offen lds
s_add_u32 m0, s51, 115712
s_mov_b32 s38, 3031040
buffer_load_dwordx4 v25, s[28:31], s38 offen lds
s_waitcnt vmcnt(18)
s_barrier
s_add_u32 m0, s39, 131072
s_mov_b32 s37, 393216
buffer_load_dwordx4 v3, s[24:27], s37 offen sc1 lds
buffer_load_dwordx4 v3, s[24:27], s37 offen offset:1024 sc1 lds
buffer_load_dwordx4 v3, s[24:27], s37 offen offset:2048 sc1 lds
buffer_load_dwordx4 v3, s[24:27], s37 offen offset:3072 sc1 lds
s_add_u32 m0, s51, 0
s_mov_b32 s38, 3145728
buffer_load_dwordx4 v25, s[28:31], s38 offen lds
s_add_u32 m0, s51, 1024
s_mov_b32 s38, 3162112
buffer_load_dwordx4 v25, s[28:31], s38 offen lds
s_waitcnt vmcnt(18)
s_branch Lov_17
.p2align 12
Lst_17_0:
s_branch Lwr_164
s_nop 0
s_nop 0
Lov_17:
s_barrier
s_add_u32 m0, s39, 16384
s_mov_b32 s37, 409600
buffer_load_dwordx4 v3, s[24:27], s37 offen sc1 lds
buffer_load_dwordx4 v3, s[24:27], s37 offen offset:1024 sc1 lds
buffer_load_dwordx4 v3, s[24:27], s37 offen offset:2048 sc1 lds
buffer_load_dwordx4 v3, s[24:27], s37 offen offset:3072 sc1 lds
s_add_u32 m0, s51, 32768
s_mov_b32 s38, 3276800
buffer_load_dwordx4 v25, s[28:31], s38 offen lds
s_add_u32 m0, s51, 33792
s_mov_b32 s38, 3293184
buffer_load_dwordx4 v25, s[28:31], s38 offen lds
s_waitcnt vmcnt(18)
s_barrier
s_add_u32 m0, s39, 49152
s_mov_b32 s37, 425984
buffer_load_dwordx4 v3, s[24:27], s37 offen sc1 lds
buffer_load_dwordx4 v3, s[24:27], s37 offen offset:1024 sc1 lds
buffer_load_dwordx4 v3, s[24:27], s37 offen offset:2048 sc1 lds
buffer_load_dwordx4 v3, s[24:27], s37 offen offset:3072 sc1 lds
s_add_u32 m0, s51, 65536
s_mov_b32 s38, 3407872
buffer_load_dwordx4 v25, s[28:31], s38 offen lds
s_add_u32 m0, s51, 66560
s_mov_b32 s38, 3424256
buffer_load_dwordx4 v25, s[28:31], s38 offen lds
s_waitcnt vmcnt(18)
s_barrier
s_add_u32 m0, s39, 81920
s_mov_b32 s37, 442368
buffer_load_dwordx4 v3, s[24:27], s37 offen sc1 lds
buffer_load_dwordx4 v3, s[24:27], s37 offen offset:1024 sc1 lds
buffer_load_dwordx4 v3, s[24:27], s37 offen offset:2048 sc1 lds
buffer_load_dwordx4 v3, s[24:27], s37 offen offset:3072 sc1 lds
s_add_u32 m0, s51, 147456
s_mov_b32 s38, 3538944
buffer_load_dwordx4 v25, s[28:31], s38 offen lds
s_add_u32 m0, s51, 148480
s_mov_b32 s38, 3555328
buffer_load_dwordx4 v25, s[28:31], s38 offen lds
s_waitcnt vmcnt(18)
s_barrier
s_add_u32 m0, s39, 98304
s_mov_b32 s37, 458752
buffer_load_dwordx4 v3, s[24:27], s37 offen sc1 lds
buffer_load_dwordx4 v3, s[24:27], s37 offen offset:1024 sc1 lds
buffer_load_dwordx4 v3, s[24:27], s37 offen offset:2048 sc1 lds
buffer_load_dwordx4 v3, s[24:27], s37 offen offset:3072 sc1 lds
s_add_u32 m0, s51, 114688
s_mov_b32 s38, 3670016
buffer_load_dwordx4 v25, s[28:31], s38 offen lds
s_add_u32 m0, s51, 115712
s_mov_b32 s38, 3686400
buffer_load_dwordx4 v25, s[28:31], s38 offen lds
s_waitcnt vmcnt(18)
s_barrier
s_add_u32 m0, s39, 131072
s_mov_b32 s37, 475136
buffer_load_dwordx4 v3, s[24:27], s37 offen sc1 lds
buffer_load_dwordx4 v3, s[24:27], s37 offen offset:1024 sc1 lds
buffer_load_dwordx4 v3, s[24:27], s37 offen offset:2048 sc1 lds
buffer_load_dwordx4 v3, s[24:27], s37 offen offset:3072 sc1 lds
s_add_u32 m0, s51, 0
s_mov_b32 s38, 3801088
buffer_load_dwordx4 v25, s[28:31], s38 offen lds
s_add_u32 m0, s51, 1024
s_mov_b32 s38, 3817472
buffer_load_dwordx4 v25, s[28:31], s38 offen lds
s_waitcnt vmcnt(18)
s_barrier
s_cmp_eq_u32 s47, 0
s_cbranch_scc0 Lw_133
s_xor_b32 s43, s2, 2
s_add_u32 s43, s43, 128
s_lshl_b32 s43, s43, 7
v_mov_b32 v26, s43
v_mov_b32 v27, 1
s_mov_b64 exec, 1
buffer_store_dword v27, v26, s[56:59], 0 offen sc1
s_mov_b64 exec, -1
Lw_133:
s_add_u32 m0, s39, 16384
s_mov_b32 s37, 491520
buffer_load_dwordx4 v3, s[24:27], s37 offen sc1 lds
buffer_load_dwordx4 v3, s[24:27], s37 offen offset:1024 sc1 lds
buffer_load_dwordx4 v3, s[24:27], s37 offen offset:2048 sc1 lds
buffer_load_dwordx4 v3, s[24:27], s37 offen offset:3072 sc1 lds
s_add_u32 m0, s51, 32768
s_mov_b32 s38, 3932160
buffer_load_dwordx4 v25, s[28:31], s38 offen lds
s_add_u32 m0, s51, 33792
s_mov_b32 s38, 3948544
buffer_load_dwordx4 v25, s[28:31], s38 offen lds
s_waitcnt vmcnt(18)
s_barrier
s_add_u32 m0, s39, 49152
s_mov_b32 s37, 507904
buffer_load_dwordx4 v3, s[24:27], s37 offen sc1 lds
buffer_load_dwordx4 v3, s[24:27], s37 offen offset:1024 sc1 lds
buffer_load_dwordx4 v3, s[24:27], s37 offen offset:2048 sc1 lds
buffer_load_dwordx4 v3, s[24:27], s37 offen offset:3072 sc1 lds
s_add_u32 m0, s51, 65536
s_mov_b32 s38, 4063232
buffer_load_dwordx4 v25, s[28:31], s38 offen lds
s_add_u32 m0, s51, 66560
s_mov_b32 s38, 4079616
buffer_load_dwordx4 v25, s[28:31], s38 offen lds
s_waitcnt vmcnt(18)
s_barrier
s_cmp_eq_u32 s47, 3
s_cbranch_scc0 Lw_134
s_lshl_b32 s92, s2, 7
s_add_u32 s92, s92, 28327936
s_load_dword s93, s[82:83], s92 glc
Lw_134:
s_waitcnt vmcnt(12)
s_cmp_eq_u32 s47, 3
s_cbranch_scc0 Lw_135
s_mov_b32 s41, 0x40000
s_branch Lpchk_138
Lpoll_136:
s_load_dword s93, s[82:83], s92 glc
Lpchk_138:
s_waitcnt lgkmcnt(0)
s_cmp_eq_u32 s93, 1
s_cbranch_scc1 Lpok_137
s_sub_u32 s41, s41, 1
s_cmp_lg_u32 s41, 0
s_cbranch_scc1 Lpoll_136
Lpok_137:
Lw_135:
s_barrier
s_waitcnt vmcnt(6)
s_barrier
s_waitcnt vmcnt(0)
s_barrier
s_barrier
s_branch Ldone_1
Ldone_1:
Lfin:
Lexit_2:
s_endpgm
.section .rodata,"a"
.p2align 6
.amdhsa_kernel sequential_preLN__sliding_local_dilated__glu_gated_geglu__prompt_kernel
  .amdhsa_next_free_vgpr 256
  .amdhsa_next_free_sgpr 100
  .amdhsa_accum_offset 256
  .amdhsa_group_segment_fixed_size 0
  .amdhsa_kernarg_size 80
  .amdhsa_user_sgpr_count 2
  .amdhsa_user_sgpr_kernarg_segment_ptr 1
  .amdhsa_system_sgpr_workgroup_id_x 1
  .amdhsa_float_denorm_mode_32 3
  .amdhsa_float_denorm_mode_16_64 3
.end_amdhsa_kernel
```

```asm
; @launch grid=(256,1,1) block=(512,1,1) lds=163840
.amdgcn_target "amdgcn-amd-amdhsa--gfx950"
.text
.globl sequential_preLN__sliding_local_dilated__glu_gated_geglu__prompt_kernel
.p2align 8
.type sequential_preLN__sliding_local_dilated__glu_gated_geglu__prompt_kernel,@function
sequential_preLN__sliding_local_dilated__glu_gated_geglu__prompt_kernel:
s_cmp_ge_u32 s2, 256
s_cbranch_scc1 Lexit_2
s_load_dwordx16 s[64:79], s[0:1], 0
s_load_dwordx4 s[80:83], s[0:1], 64
s_and_b32 s3, s2, 7
s_lshr_b32 s42, s2, 3
s_and_b32 s34, s3, 1
s_lshl_b32 s34, s34, 3
s_and_b32 s48, s42, 7
s_add_u32 s34, s34, s48
s_lshr_b32 s35, s3, 1
s_lshr_b32 s49, s42, 3
s_lshl_b32 s35, s35, 2
s_add_u32 s35, s35, s49
v_lshrrev_b32 v12, 6, v0
v_and_b32 v1, 63, v0
v_readfirstlane_b32 s36, v12
Lbeg:
s_lshl_b32 s50, s34, 7
s_sub_u32 s50, s50, 16
v_and_b32 v12, 15, v1
v_lshrrev_b32 v13, 4, v1
s_cmp_lt_u32 s36, 4
s_cbranch_scc1 Lcons_7
Lprod_3:
s_sub_u32 s47, s36, 4
s_lshl_b32 s43, s34, 7
s_lshl_b32 s44, s35, 3
s_add_u32 s63, s43, s44
s_lshl_b32 s44, s47, 1
s_add_u32 s51, s63, s44
v_lshlrev_b32 v10, 4, v1
v_lshrrev_b32 v14, 3, v1
v_and_b32 v15, 7, v1
v_lshl_add_u32 v19, v14, 6, v15
s_lshl_b32 s43, s48, 3
v_add_u32 v19, s43, v19
v_mul_u32_u24 v19, 6144, v19
s_cmp_eq_u32 s47, 3
s_cbranch_scc1 Lpf_4
v_and_b32 v16, 2, v14
v_xor_b32 v16, v15, v16
v_lshlrev_b32 v16, 4, v16
v_mul_u32_u24 v17, 6144, v14
s_lshl_b32 s43, s47, 11
v_add3_u32 v2, v17, v16, s43
v_xor_b32 v3, 64, v2
v_lshrrev_b32 v16, 1, v14
v_xor_b32 v16, v15, v16
v_lshlrev_b32 v16, 4, v16
s_lshl_b32 s43, s47, 3
s_add_u32 s43, s43, s50
v_add_u32 v17, s43, v14
s_and_b32 s44, s47, 1
s_lshl_b32 s44, s44, 6
v_add_u32 v18, 0, v17
v_max_i32 v18, 0, v18
v_lshl_add_u32 v18, v18, 11, v16
v_xor_b32 v18, s44, v18
v_mov_b32 v4, v18
v_add_u32 v18, 24, v17
v_max_i32 v18, 0, v18
v_lshl_add_u32 v18, v18, 11, v16
v_xor_b32 v18, s44, v18
v_xor_b32 v5, 64, v18
v_add_u32 v18, 48, v17
v_max_i32 v18, 0, v18
v_lshl_add_u32 v18, v18, 11, v16
v_xor_b32 v18, s44, v18
v_mov_b32 v6, v18
v_add_u32 v18, 72, v17
v_max_i32 v18, 0, v18
v_lshl_add_u32 v18, v18, 11, v16
v_xor_b32 v18, s44, v18
v_xor_b32 v7, 64, v18
v_add_u32 v18, 96, v17
v_max_i32 v18, 0, v18
v_lshl_add_u32 v18, v18, 11, v16
v_xor_b32 v18, s44, v18
v_mov_b32 v8, v18
v_add_u32 v18, 120, v17
v_max_i32 v18, 0, v18
v_lshl_add_u32 v18, v18, 11, v16
v_xor_b32 v18, s44, v18
v_xor_b32 v9, 64, v18
s_lshl_b32 s39, s47, 10
s_lshl_b32 s40, s47, 13
s_add_u32 s40, s40, 18432
s_mov_b32 s37, 0
s_mov_b32 s38, 0
s_bfm_b64 s[60:61], 56, 8
s_cmp_eq_u32 s47, 0
s_cselect_b64 s[60:61], s[60:61], -1
s_lshl_b32 s43, s35, 7
s_waitcnt lgkmcnt(0)
s_mov_b32 s8, s64
s_mov_b32 s9, s65
s_mov_b32 s10, 4194304
s_mov_b32 s11, 0x20000
s_add_u32 s12, s66, s43
s_addc_u32 s13, s67, 0
s_mov_b32 s14, 6289536
s_mov_b32 s15, 0x20000
s_add_u32 m0, s39, 0
s_mov_b64 exec, s[60:61]
buffer_load_dwordx4 v4, s[8:11], s37 offen lds
s_mov_b64 exec, -1
s_add_u32 m0, s39, 3072
s_nop 0
buffer_load_dwordx4 v5, s[8:11], s37 offen lds
s_add_u32 m0, s39, 6144
s_nop 0
buffer_load_dwordx4 v6, s[8:11], s37 offen lds
s_add_u32 m0, s39, 9216
s_nop 0
buffer_load_dwordx4 v7, s[8:11], s37 offen lds
s_add_u32 m0, s39, 12288
s_nop 0
buffer_load_dwordx4 v8, s[8:11], s37 offen lds
s_add_u32 m0, s39, 15360
s_nop 0
buffer_load_dwordx4 v9, s[8:11], s37 offen lds
s_add_u32 m0, s40, 0
s_add_u32 s43, s38, 0
buffer_load_dwordx4 v2, s[12:15], s43 offen lds
s_add_u32 m0, s40, 1024
s_add_u32 s43, s38, 49152
buffer_load_dwordx4 v3, s[12:15], s43 offen lds
s_add_u32 m0, s40, 2048
s_add_u32 s43, s38, 98304
buffer_load_dwordx4 v2, s[12:15], s43 offen lds
s_add_u32 m0, s40, 3072
s_add_u32 s43, s38, 147456
buffer_load_dwordx4 v3, s[12:15], s43 offen lds
s_add_u32 m0, s40, 4096
s_add_u32 s43, s38, 196608
buffer_load_dwordx4 v2, s[12:15], s43 offen lds
s_add_u32 m0, s40, 5120
s_add_u32 s43, s38, 245760
buffer_load_dwordx4 v3, s[12:15], s43 offen lds
s_add_u32 m0, s40, 6144
s_add_u32 s43, s38, 294912
buffer_load_dwordx4 v2, s[12:15], s43 offen lds
s_add_u32 m0, s40, 7168
s_add_u32 s43, s38, 344064
buffer_load_dwordx4 v3, s[12:15], s43 offen lds
s_add_u32 s37, s37, 128
s_add_u32 s38, s38, 393216
s_mov_b32 s28, s66
s_mov_b32 s29, s67
s_mov_b32 s30, 6291456
s_mov_b32 s31, 0x20000
s_mul_i32 s43, s2, 4608
s_add_u32 s43, s43, 393216
v_lshlrev_b32 v30, 7, v1
s_mul_i32 s44, s47, 1536
s_add_u32 s43, s43, s44
s_bfm_b64 exec, 12, 0
buffer_load_dword v31, v30, s[28:31], s43 offen
s_mov_b64 exec, -1
s_lshl_b32 s43, s51, 11
buffer_load_dwordx4 v[96:99], v10, s[8:11], s43 offen offset:0
buffer_load_dwordx4 v[100:103], v10, s[8:11], s43 offen offset:1024
buffer_load_dwordx4 v[104:107], v10, s[8:11], s43 offen offset:2048
buffer_load_dwordx4 v[108:111], v10, s[8:11], s43 offen offset:3072
s_add_u32 m0, s39, 43008
s_mov_b64 exec, s[60:61]
buffer_load_dwordx4 v4, s[8:11], s37 offen lds
s_mov_b64 exec, -1
s_add_u32 m0, s39, 46080
s_nop 0
buffer_load_dwordx4 v5, s[8:11], s37 offen lds
s_add_u32 m0, s39, 49152
s_nop 0
buffer_load_dwordx4 v6, s[8:11], s37 offen lds
s_add_u32 m0, s39, 52224
s_nop 0
buffer_load_dwordx4 v7, s[8:11], s37 offen lds
s_add_u32 m0, s39, 55296
s_nop 0
buffer_load_dwordx4 v8, s[8:11], s37 offen lds
s_add_u32 m0, s39, 58368
s_nop 0
buffer_load_dwordx4 v9, s[8:11], s37 offen lds
s_add_u32 m0, s40, 43008
s_add_u32 s43, s38, 0
buffer_load_dwordx4 v2, s[12:15], s43 offen lds
s_add_u32 m0, s40, 44032
s_add_u32 s43, s38, 49152
buffer_load_dwordx4 v3, s[12:15], s43 offen lds
s_add_u32 m0, s40, 45056
s_add_u32 s43, s38, 98304
buffer_load_dwordx4 v2, s[12:15], s43 offen lds
s_add_u32 m0, s40, 46080
s_add_u32 s43, s38, 147456
buffer_load_dwordx4 v3, s[12:15], s43 offen lds
s_add_u32 m0, s40, 47104
s_add_u32 s43, s38, 196608
buffer_load_dwordx4 v2, s[12:15], s43 offen lds
s_add_u32 m0, s40, 48128
s_add_u32 s43, s38, 245760
buffer_load_dwordx4 v3, s[12:15], s43 offen lds
s_add_u32 m0, s40, 49152
s_add_u32 s43, s38, 294912
buffer_load_dwordx4 v2, s[12:15], s43 offen lds
s_add_u32 m0, s40, 50176
s_add_u32 s43, s38, 344064
buffer_load_dwordx4 v3, s[12:15], s43 offen lds
s_add_u32 s37, s37, 128
s_add_u32 s38, s38, 393216
s_waitcnt vmcnt(19)
s_barrier
s_add_u32 m0, s39, 86016
s_mov_b64 exec, s[60:61]
buffer_load_dwordx4 v4, s[8:11], s37 offen lds
s_mov_b64 exec, -1
s_add_u32 m0, s39, 89088
s_nop 0
buffer_load_dwordx4 v5, s[8:11], s37 offen lds
s_add_u32 m0, s39, 92160
s_nop 0
buffer_load_dwordx4 v6, s[8:11], s37 offen lds
s_add_u32 m0, s39, 95232
s_nop 0
buffer_load_dwordx4 v7, s[8:11], s37 offen lds
s_add_u32 m0, s39, 98304
s_nop 0
buffer_load_dwordx4 v8, s[8:11], s37 offen lds
s_add_u32 m0, s39, 101376
s_nop 0
buffer_load_dwordx4 v9, s[8:11], s37 offen lds
s_add_u32 m0, s40, 86016
s_add_u32 s43, s38, 0
buffer_load_dwordx4 v2, s[12:15], s43 offen lds
s_add_u32 m0, s40, 87040
s_add_u32 s43, s38, 49152
buffer_load_dwordx4 v3, s[12:15], s43 offen lds
s_add_u32 m0, s40, 88064
s_add_u32 s43, s38, 98304
buffer_load_dwordx4 v2, s[12:15], s43 offen lds
s_add_u32 m0, s40, 89088
s_add_u32 s43, s38, 147456
buffer_load_dwordx4 v3, s[12:15], s43 offen lds
s_add_u32 m0, s40, 90112
s_add_u32 s43, s38, 196608
buffer_load_dwordx4 v2, s[12:15], s43 offen lds
s_add_u32 m0, s40, 91136
s_add_u32 s43, s38, 245760
buffer_load_dwordx4 v3, s[12:15], s43 offen lds
s_add_u32 m0, s40, 92160
s_add_u32 s43, s38, 294912
buffer_load_dwordx4 v2, s[12:15], s43 offen lds
s_add_u32 m0, s40, 93184
s_add_u32 s43, s38, 344064
buffer_load_dwordx4 v3, s[12:15], s43 offen lds
s_add_u32 s37, s37, 128
s_add_u32 s38, s38, 393216
s_waitcnt vmcnt(28)
s_mov_b32 s43, 0x3f803f80
v_mov_b32 v116, 0
v_mov_b32 v117, 0
v_mov_b32 v118, 0
v_mov_b32 v119, 0
v_mov_b32 v120, 0
v_mov_b32 v121, 0
v_mov_b32 v122, 0
v_mov_b32 v123, 0
v_dot2_f32_bf16 v116, v96, s43, v116
v_dot2_f32_bf16 v120, v96, v96, v120
v_dot2_f32_bf16 v118, v104, s43, v118
v_dot2_f32_bf16 v122, v104, v104, v122
v_dot2_f32_bf16 v117, v97, s43, v117
v_dot2_f32_bf16 v121, v97, v97, v121
v_dot2_f32_bf16 v119, v105, s43, v119
v_dot2_f32_bf16 v123, v105, v105, v123
v_dot2_f32_bf16 v116, v98, s43, v116
v_dot2_f32_bf16 v120, v98, v98, v120
v_dot2_f32_bf16 v118, v106, s43, v118
v_dot2_f32_bf16 v122, v106, v106, v122
v_dot2_f32_bf16 v117, v99, s43, v117
v_dot2_f32_bf16 v121, v99, v99, v121
v_dot2_f32_bf16 v119, v107, s43, v119
v_dot2_f32_bf16 v123, v107, v107, v123
v_dot2_f32_bf16 v116, v100, s43, v116
v_dot2_f32_bf16 v120, v100, v100, v120
v_dot2_f32_bf16 v118, v108, s43, v118
v_dot2_f32_bf16 v122, v108, v108, v122
v_dot2_f32_bf16 v117, v101, s43, v117
v_dot2_f32_bf16 v121, v101, v101, v121
v_dot2_f32_bf16 v119, v109, s43, v119
v_dot2_f32_bf16 v123, v109, v109, v123
v_dot2_f32_bf16 v116, v102, s43, v116
v_dot2_f32_bf16 v120, v102, v102, v120
v_dot2_f32_bf16 v118, v110, s43, v118
v_dot2_f32_bf16 v122, v110, v110, v122
v_dot2_f32_bf16 v117, v103, s43, v117
v_dot2_f32_bf16 v121, v103, v103, v121
v_dot2_f32_bf16 v119, v111, s43, v119
v_dot2_f32_bf16 v123, v111, v111, v123
s_nop 2
v_add_f32 v116, v116, v117
v_add_f32 v118, v118, v119
v_add_f32 v120, v120, v121
v_add_f32 v122, v122, v123
s_nop 1
v_permlane32_swap_b32 v116, v118
v_permlane32_swap_b32 v120, v122
v_add_f32 v116, v116, v118
v_add_f32 v120, v120, v122
s_nop 1
v_permlane16_swap_b32 v116, v120
v_add_f32 v116, v116, v120
s_nop 1
v_add_f32_dpp v116, v116, v116 row_ror:8 row_mask:0xf bank_mask:0xf
s_nop 1
v_add_f32_dpp v116, v116, v116 row_ror:4 row_mask:0xf bank_mask:0xf
s_nop 1
v_add_f32_dpp v116, v116, v116 row_ror:2 row_mask:0xf bank_mask:0xf
s_nop 1
v_add_f32_dpp v116, v116, v116 row_ror:1 row_mask:0xf bank_mask:0xf
v_mov_b32 v117, v116
s_nop 1
v_permlane16_swap_b32 v116, v117
v_mul_f32 v112, 0x3a800000, v116
v_mul_f32 v113, 0x3a800000, v117
v_fma_f32 v113, -v112, v112, v113
v_max_f32 v113, 0, v113
v_add_f32 v113, 0x3727c5ac, v113
v_rsq_f32 v113, v113
v_lshrrev_b32 v11, 5, v1
s_lshl_b32 s43, s47, 4
s_add_u32 s43, s43, 148608
v_lshl_add_u32 v11, v11, 3, s43
ds_write_b64 v11, v[112:113]
s_waitcnt lgkmcnt(0)
s_and_b32 s44, s36, 3
s_mul_i32 s44, s44, 24
s_bfe_u32 s43, s2, 0x30001
s_lshl_b32 s43, s43, 7
s_add_u32 s44, s44, s43
s_mul_i32 s44, s44, 7168
s_lshr_b32 s43, s2, 4
s_lshl_b32 s43, s43, 8
s_add_u32 s43, s43, s44
s_bitcmp0_b32 s2, 0
s_cselect_b32 s4, s72, s74
s_cselect_b32 s5, s73, s75
s_add_u32 s4, s4, s43
s_addc_u32 s5, s5, 0
s_waitcnt vmcnt(14)
s_barrier
s_add_u32 m0, s39, 0
s_mov_b64 exec, s[60:61]
buffer_load_dwordx4 v4, s[8:11], s37 offen lds
s_mov_b64 exec, -1
s_add_u32 m0, s39, 3072
s_nop 0
buffer_load_dwordx4 v5, s[8:11], s37 offen lds
s_add_u32 m0, s39, 6144
s_nop 0
buffer_load_dwordx4 v6, s[8:11], s37 offen lds
s_add_u32 m0, s39, 9216
s_nop 0
buffer_load_dwordx4 v7, s[8:11], s37 offen lds
s_add_u32 m0, s39, 12288
s_nop 0
buffer_load_dwordx4 v8, s[8:11], s37 offen lds
s_add_u32 m0, s39, 15360
s_nop 0
buffer_load_dwordx4 v9, s[8:11], s37 offen lds
s_add_u32 m0, s40, 0
s_add_u32 s43, s38, 0
buffer_load_dwordx4 v2, s[12:15], s43 offen lds
s_add_u32 m0, s40, 1024
s_add_u32 s43, s38, 49152
buffer_load_dwordx4 v3, s[12:15], s43 offen lds
s_add_u32 m0, s40, 2048
s_add_u32 s43, s38, 98304
buffer_load_dwordx4 v2, s[12:15], s43 offen lds
s_add_u32 m0, s40, 3072
s_add_u32 s43, s38, 147456
buffer_load_dwordx4 v3, s[12:15], s43 offen lds
s_add_u32 m0, s40, 4096
s_add_u32 s43, s38, 196608
buffer_load_dwordx4 v2, s[12:15], s43 offen lds
s_add_u32 m0, s40, 5120
s_add_u32 s43, s38, 245760
buffer_load_dwordx4 v3, s[12:15], s43 offen lds
s_add_u32 m0, s40, 6144
s_add_u32 s43, s38, 294912
buffer_load_dwordx4 v2, s[12:15], s43 offen lds
s_add_u32 m0, s40, 7168
s_add_u32 s43, s38, 344064
buffer_load_dwordx4 v3, s[12:15], s43 offen lds
s_add_u32 s37, s37, 128
s_add_u32 s38, s38, 393216
s_waitcnt vmcnt(14)
s_barrier
s_add_u32 m0, s39, 43008
s_mov_b64 exec, s[60:61]
buffer_load_dwordx4 v4, s[8:11], s37 offen lds
s_mov_b64 exec, -1
s_add_u32 m0, s39, 46080
s_nop 0
buffer_load_dwordx4 v5, s[8:11], s37 offen lds
s_add_u32 m0, s39, 49152
s_nop 0
buffer_load_dwordx4 v6, s[8:11], s37 offen lds
s_add_u32 m0, s39, 52224
s_nop 0
buffer_load_dwordx4 v7, s[8:11], s37 offen lds
s_add_u32 m0, s39, 55296
s_nop 0
buffer_load_dwordx4 v8, s[8:11], s37 offen lds
s_add_u32 m0, s39, 58368
s_nop 0
buffer_load_dwordx4 v9, s[8:11], s37 offen lds
s_add_u32 m0, s40, 43008
s_add_u32 s43, s38, 0
buffer_load_dwordx4 v2, s[12:15], s43 offen lds
s_add_u32 m0, s40, 44032
s_add_u32 s43, s38, 49152
buffer_load_dwordx4 v3, s[12:15], s43 offen lds
s_add_u32 m0, s40, 45056
s_add_u32 s43, s38, 98304
buffer_load_dwordx4 v2, s[12:15], s43 offen lds
s_add_u32 m0, s40, 46080
s_add_u32 s43, s38, 147456
buffer_load_dwordx4 v3, s[12:15], s43 offen lds
s_add_u32 m0, s40, 47104
s_add_u32 s43, s38, 196608
buffer_load_dwordx4 v2, s[12:15], s43 offen lds
s_add_u32 m0, s40, 48128
s_add_u32 s43, s38, 245760
buffer_load_dwordx4 v3, s[12:15], s43 offen lds
s_add_u32 m0, s40, 49152
s_add_u32 s43, s38, 294912
buffer_load_dwordx4 v2, s[12:15], s43 offen lds
s_add_u32 m0, s40, 50176
s_add_u32 s43, s38, 344064
buffer_load_dwordx4 v3, s[12:15], s43 offen lds
s_add_u32 s37, s37, 128
s_add_u32 s38, s38, 393216
s_waitcnt lgkmcnt(0)
s_load_dword s3, s[4:5], 0
s_load_dword s3, s[4:5], 64
s_load_dword s3, s[4:5], 128
s_load_dword s3, s[4:5], 192
s_load_dword s3, s[4:5], 7168
s_load_dword s3, s[4:5], 7232
s_load_dword s3, s[4:5], 7296
s_load_dword s3, s[4:5], 7360
s_load_dword s3, s[4:5], 14336
s_load_dword s3, s[4:5], 14400
s_load_dword s3, s[4:5], 14464
s_load_dword s3, s[4:5], 14528
s_load_dword s3, s[4:5], 21504
s_load_dword s3, s[4:5], 21568
s_waitcnt vmcnt(14)
s_barrier
s_add_u32 m0, s39, 86016
s_mov_b64 exec, s[60:61]
buffer_load_dwordx4 v4, s[8:11], s37 offen lds
s_mov_b64 exec, -1
s_add_u32 m0, s39, 89088
s_nop 0
buffer_load_dwordx4 v5, s[8:11], s37 offen lds
s_add_u32 m0, s39, 92160
s_nop 0
buffer_load_dwordx4 v6, s[8:11], s37 offen lds
s_add_u32 m0, s39, 95232
s_nop 0
buffer_load_dwordx4 v7, s[8:11], s37 offen lds
s_add_u32 m0, s39, 98304
s_nop 0
buffer_load_dwordx4 v8, s[8:11], s37 offen lds
s_add_u32 m0, s39, 101376
s_nop 0
buffer_load_dwordx4 v9, s[8:11], s37 offen lds
s_add_u32 m0, s40, 86016
s_add_u32 s43, s38, 0
buffer_load_dwordx4 v2, s[12:15], s43 offen lds
s_add_u32 m0, s40, 87040
s_add_u32 s43, s38, 49152
buffer_load_dwordx4 v3, s[12:15], s43 offen lds
s_add_u32 m0, s40, 88064
s_add_u32 s43, s38, 98304
buffer_load_dwordx4 v2, s[12:15], s43 offen lds
s_add_u32 m0, s40, 89088
s_add_u32 s43, s38, 147456
buffer_load_dwordx4 v3, s[12:15], s43 offen lds
s_add_u32 m0, s40, 90112
s_add_u32 s43, s38, 196608
buffer_load_dwordx4 v2, s[12:15], s43 offen lds
s_add_u32 m0, s40, 91136
s_add_u32 s43, s38, 245760
buffer_load_dwordx4 v3, s[12:15], s43 offen lds
s_add_u32 m0, s40, 92160
s_add_u32 s43, s38, 294912
buffer_load_dwordx4 v2, s[12:15], s43 offen lds
s_add_u32 m0, s40, 93184
s_add_u32 s43, s38, 344064
buffer_load_dwordx4 v3, s[12:15], s43 offen lds
s_add_u32 s37, s37, 128
s_add_u32 s38, s38, 393216
s_waitcnt vmcnt(14)
s_barrier
s_add_u32 m0, s39, 0
s_mov_b64 exec, s[60:61]
buffer_load_dwordx4 v4, s[8:11], s37 offen lds
s_mov_b64 exec, -1
s_add_u32 m0, s39, 3072
s_nop 0
buffer_load_dwordx4 v5, s[8:11], s37 offen lds
s_add_u32 m0, s39, 6144
s_nop 0
buffer_load_dwordx4 v6, s[8:11], s37 offen lds
s_add_u32 m0, s39, 9216
s_branch Lov_0
.p2align 12
Lst_0_0:
s_branch Lwr_140
s_nop 0
s_nop 0
Lov_0:
s_nop 0
buffer_load_dwordx4 v7, s[8:11], s37 offen lds
s_add_u32 m0, s39, 12288
s_nop 0
buffer_load_dwordx4 v8, s[8:11], s37 offen lds
s_add_u32 m0, s39, 15360
s_nop 0
buffer_load_dwordx4 v9, s[8:11], s37 offen lds
s_add_u32 m0, s40, 0
s_add_u32 s43, s38, 0
buffer_load_dwordx4 v2, s[12:15], s43 offen lds
s_add_u32 m0, s40, 1024
s_add_u32 s43, s38, 49152
buffer_load_dwordx4 v3, s[12:15], s43 offen lds
s_add_u32 m0, s40, 2048
s_add_u32 s43, s38, 98304
buffer_load_dwordx4 v2, s[12:15], s43 offen lds
s_add_u32 m0, s40, 3072
s_add_u32 s43, s38, 147456
buffer_load_dwordx4 v3, s[12:15], s43 offen lds
s_add_u32 m0, s40, 4096
s_add_u32 s43, s38, 196608
buffer_load_dwordx4 v2, s[12:15], s43 offen lds
s_add_u32 m0, s40, 5120
s_add_u32 s43, s38, 245760
buffer_load_dwordx4 v3, s[12:15], s43 offen lds
s_add_u32 m0, s40, 6144
s_add_u32 s43, s38, 294912
buffer_load_dwordx4 v2, s[12:15], s43 offen lds
s_add_u32 m0, s40, 7168
s_add_u32 s43, s38, 344064
buffer_load_dwordx4 v3, s[12:15], s43 offen lds
s_add_u32 s37, s37, 128
s_add_u32 s38, s38, 393216
s_waitcnt lgkmcnt(0)
s_load_dword s3, s[4:5], 21632
s_load_dword s3, s[4:5], 21696
s_load_dword s3, s[4:5], 28672
s_load_dword s3, s[4:5], 28736
s_load_dword s3, s[4:5], 28800
s_load_dword s3, s[4:5], 28864
s_load_dword s3, s[4:5], 35840
s_load_dword s3, s[4:5], 35904
s_load_dword s3, s[4:5], 35968
s_load_dword s3, s[4:5], 36032
s_load_dword s3, s[4:5], 43008
s_load_dword s3, s[4:5], 43072
s_load_dword s3, s[4:5], 43136
s_load_dword s3, s[4:5], 43200
s_waitcnt vmcnt(14)
s_barrier
s_add_u32 m0, s39, 43008
s_mov_b64 exec, s[60:61]
buffer_load_dwordx4 v4, s[8:11], s37 offen lds
s_mov_b64 exec, -1
s_add_u32 m0, s39, 46080
s_nop 0
buffer_load_dwordx4 v5, s[8:11], s37 offen lds
s_add_u32 m0, s39, 49152
s_nop 0
buffer_load_dwordx4 v6, s[8:11], s37 offen lds
s_add_u32 m0, s39, 52224
s_nop 0
buffer_load_dwordx4 v7, s[8:11], s37 offen lds
s_add_u32 m0, s39, 55296
s_nop 0
buffer_load_dwordx4 v8, s[8:11], s37 offen lds
s_add_u32 m0, s39, 58368
s_nop 0
buffer_load_dwordx4 v9, s[8:11], s37 offen lds
s_add_u32 m0, s40, 43008
s_add_u32 s43, s38, 0
buffer_load_dwordx4 v2, s[12:15], s43 offen lds
s_add_u32 m0, s40, 44032
s_add_u32 s43, s38, 49152
buffer_load_dwordx4 v3, s[12:15], s43 offen lds
s_add_u32 m0, s40, 45056
s_add_u32 s43, s38, 98304
buffer_load_dwordx4 v2, s[12:15], s43 offen lds
s_add_u32 m0, s40, 46080
s_add_u32 s43, s38, 147456
buffer_load_dwordx4 v3, s[12:15], s43 offen lds
s_add_u32 m0, s40, 47104
s_add_u32 s43, s38, 196608
buffer_load_dwordx4 v2, s[12:15], s43 offen lds
s_add_u32 m0, s40, 48128
s_add_u32 s43, s38, 245760
buffer_load_dwordx4 v3, s[12:15], s43 offen lds
s_add_u32 m0, s40, 49152
s_add_u32 s43, s38, 294912
buffer_load_dwordx4 v2, s[12:15], s43 offen lds
s_add_u32 m0, s40, 50176
s_add_u32 s43, s38, 344064
buffer_load_dwordx4 v3, s[12:15], s43 offen lds
s_add_u32 s37, s37, 128
s_add_u32 s38, s38, 393216
s_waitcnt vmcnt(14)
s_barrier
s_add_u32 m0, s39, 86016
s_mov_b64 exec, s[60:61]
buffer_load_dwordx4 v4, s[8:11], s37 offen lds
s_mov_b64 exec, -1
s_add_u32 m0, s39, 89088
s_nop 0
buffer_load_dwordx4 v5, s[8:11], s37 offen lds
s_add_u32 m0, s39, 92160
s_nop 0
buffer_load_dwordx4 v6, s[8:11], s37 offen lds
s_add_u32 m0, s39, 95232
s_nop 0
buffer_load_dwordx4 v7, s[8:11], s37 offen lds
s_add_u32 m0, s39, 98304
s_nop 0
buffer_load_dwordx4 v8, s[8:11], s37 offen lds
s_add_u32 m0, s39, 101376
s_nop 0
buffer_load_dwordx4 v9, s[8:11], s37 offen lds
s_add_u32 m0, s40, 86016
s_add_u32 s43, s38, 0
buffer_load_dwordx4 v2, s[12:15], s43 offen lds
s_add_u32 m0, s40, 87040
s_add_u32 s43, s38, 49152
buffer_load_dwordx4 v3, s[12:15], s43 offen lds
s_add_u32 m0, s40, 88064
s_add_u32 s43, s38, 98304
buffer_load_dwordx4 v2, s[12:15], s43 offen lds
s_add_u32 m0, s40, 89088
s_add_u32 s43, s38, 147456
buffer_load_dwordx4 v3, s[12:15], s43 offen lds
s_add_u32 m0, s40, 90112
s_add_u32 s43, s38, 196608
buffer_load_dwordx4 v2, s[12:15], s43 offen lds
s_add_u32 m0, s40, 91136
s_add_u32 s43, s38, 245760
buffer_load_dwordx4 v3, s[12:15], s43 offen lds
s_add_u32 m0, s40, 92160
s_add_u32 s43, s38, 294912
buffer_load_dwordx4 v2, s[12:15], s43 offen lds
s_add_u32 m0, s40, 93184
s_add_u32 s43, s38, 344064
buffer_load_dwordx4 v3, s[12:15], s43 offen lds
s_add_u32 s37, s37, 128
s_add_u32 s38, s38, 393216
s_waitcnt lgkmcnt(0)
s_load_dword s3, s[4:5], 50176
s_load_dword s3, s[4:5], 50240
s_load_dword s3, s[4:5], 50304
s_load_dword s3, s[4:5], 50368
s_load_dword s3, s[4:5], 57344
s_load_dword s3, s[4:5], 57408
s_load_dword s3, s[4:5], 57472
s_load_dword s3, s[4:5], 57536
s_load_dword s3, s[4:5], 64512
s_load_dword s3, s[4:5], 64576
s_load_dword s3, s[4:5], 64640
s_load_dword s3, s[4:5], 64704
s_load_dword s3, s[4:5], 71680
s_load_dword s3, s[4:5], 71744
s_waitcnt vmcnt(14)
s_barrier
s_add_u32 m0, s39, 0
s_mov_b64 exec, s[60:61]
buffer_load_dwordx4 v4, s[8:11], s37 offen lds
s_mov_b64 exec, -1
s_add_u32 m0, s39, 3072
s_nop 0
buffer_load_dwordx4 v5, s[8:11], s37 offen lds
s_add_u32 m0, s39, 6144
s_nop 0
buffer_load_dwordx4 v6, s[8:11], s37 offen lds
s_add_u32 m0, s39, 9216
s_nop 0
buffer_load_dwordx4 v7, s[8:11], s37 offen lds
s_add_u32 m0, s39, 12288
s_nop 0
buffer_load_dwordx4 v8, s[8:11], s37 offen lds
s_add_u32 m0, s39, 15360
s_nop 0
buffer_load_dwordx4 v9, s[8:11], s37 offen lds
s_add_u32 m0, s40, 0
s_add_u32 s43, s38, 0
buffer_load_dwordx4 v2, s[12:15], s43 offen lds
s_add_u32 m0, s40, 1024
s_add_u32 s43, s38, 49152
buffer_load_dwordx4 v3, s[12:15], s43 offen lds
s_add_u32 m0, s40, 2048
s_add_u32 s43, s38, 98304
buffer_load_dwordx4 v2, s[12:15], s43 offen lds
s_add_u32 m0, s40, 3072
s_add_u32 s43, s38, 147456
buffer_load_dwordx4 v3, s[12:15], s43 offen lds
s_add_u32 m0, s40, 4096
s_add_u32 s43, s38, 196608
buffer_load_dwordx4 v2, s[12:15], s43 offen lds
s_add_u32 m0, s40, 5120
s_add_u32 s43, s38, 245760
buffer_load_dwordx4 v3, s[12:15], s43 offen lds
s_add_u32 m0, s40, 6144
s_add_u32 s43, s38, 294912
buffer_load_dwordx4 v2, s[12:15], s43 offen lds
s_add_u32 m0, s40, 7168
s_add_u32 s43, s38, 344064
buffer_load_dwordx4 v3, s[12:15], s43 offen lds
s_add_u32 s37, s37, 128
s_add_u32 s38, s38, 393216
s_waitcnt vmcnt(14)
s_barrier
s_add_u32 m0, s39, 43008
s_mov_b64 exec, s[60:61]
buffer_load_dwordx4 v4, s[8:11], s37 offen lds
s_mov_b64 exec, -1
s_add_u32 m0, s39, 46080
s_nop 0
buffer_load_dwordx4 v5, s[8:11], s37 offen lds
s_add_u32 m0, s39, 49152
s_nop 0
buffer_load_dwordx4 v6, s[8:11], s37 offen lds
s_add_u32 m0, s39, 52224
s_nop 0
buffer_load_dwordx4 v7, s[8:11], s37 offen lds
s_add_u32 m0, s39, 55296
s_nop 0
buffer_load_dwordx4 v8, s[8:11], s37 offen lds
s_add_u32 m0, s39, 58368
s_nop 0
buffer_load_dwordx4 v9, s[8:11], s37 offen lds
s_add_u32 m0, s40, 43008
s_add_u32 s43, s38, 0
buffer_load_dwordx4 v2, s[12:15], s43 offen lds
s_add_u32 m0, s40, 44032
s_add_u32 s43, s38, 49152
buffer_load_dwordx4 v3, s[12:15], s43 offen lds
s_add_u32 m0, s40, 45056
s_add_u32 s43, s38, 98304
buffer_load_dwordx4 v2, s[12:15], s43 offen lds
s_add_u32 m0, s40, 46080
s_add_u32 s43, s38, 147456
buffer_load_dwordx4 v3, s[12:15], s43 offen lds
s_add_u32 m0, s40, 47104
s_add_u32 s43, s38, 196608
buffer_load_dwordx4 v2, s[12:15], s43 offen lds
s_add_u32 m0, s40, 48128
s_add_u32 s43, s38, 245760
buffer_load_dwordx4 v3, s[12:15], s43 offen lds
s_add_u32 m0, s40, 49152
s_add_u32 s43, s38, 294912
buffer_load_dwordx4 v2, s[12:15], s43 offen lds
s_add_u32 m0, s40, 50176
s_add_u32 s43, s38, 344064
buffer_load_dwordx4 v3, s[12:15], s43 offen lds
s_add_u32 s37, s37, 128
s_add_u32 s38, s38, 393216
s_waitcnt lgkmcnt(0)
s_load_dword s3, s[4:5], 71808
s_load_dword s3, s[4:5], 71872
s_load_dword s3, s[4:5], 78848
s_load_dword s3, s[4:5], 78912
s_load_dword s3, s[4:5], 78976
s_load_dword s3, s[4:5], 79040
s_load_dword s3, s[4:5], 86016
s_load_dword s3, s[4:5], 86080
s_load_dword s3, s[4:5], 86144
s_load_dword s3, s[4:5], 86208
s_load_dword s3, s[4:5], 93184
s_load_dword s3, s[4:5], 93248
s_load_dword s3, s[4:5], 93312
s_load_dword s3, s[4:5], 93376
s_waitcnt vmcnt(14)
s_barrier
s_add_u32 m0, s39, 86016
s_mov_b64 exec, s[60:61]
buffer_load_dwordx4 v4, s[8:11], s37 offen lds
s_mov_b64 exec, -1
s_add_u32 m0, s39, 89088
s_nop 0
buffer_load_dwordx4 v5, s[8:11], s37 offen lds
s_add_u32 m0, s39, 92160
s_nop 0
buffer_load_dwordx4 v6, s[8:11], s37 offen lds
s_add_u32 m0, s39, 95232
s_nop 0
buffer_load_dwordx4 v7, s[8:11], s37 offen lds
s_add_u32 m0, s39, 98304
s_nop 0
buffer_load_dwordx4 v8, s[8:11], s37 offen lds
s_add_u32 m0, s39, 101376
s_nop 0
buffer_load_dwordx4 v9, s[8:11], s37 offen lds
s_add_u32 m0, s40, 86016
s_add_u32 s43, s38, 0
buffer_load_dwordx4 v2, s[12:15], s43 offen lds
s_add_u32 m0, s40, 87040
s_add_u32 s43, s38, 49152
buffer_load_dwordx4 v3, s[12:15], s43 offen lds
s_add_u32 m0, s40, 88064
s_add_u32 s43, s38, 98304
buffer_load_dwordx4 v2, s[12:15], s43 offen lds
s_add_u32 m0, s40, 89088
s_add_u32 s43, s38, 147456
buffer_load_dwordx4 v3, s[12:15], s43 offen lds
s_add_u32 m0, s40, 90112
s_add_u32 s43, s38, 196608
buffer_load_dwordx4 v2, s[12:15], s43 offen lds
s_add_u32 m0, s40, 91136
s_add_u32 s43, s38, 245760
buffer_load_dwordx4 v3, s[12:15], s43 offen lds
s_add_u32 m0, s40, 92160
s_add_u32 s43, s38, 294912
buffer_load_dwordx4 v2, s[12:15], s43 offen lds
s_add_u32 m0, s40, 93184
s_add_u32 s43, s38, 344064
buffer_load_dwordx4 v3, s[12:15], s43 offen lds
s_add_u32 s37, s37, 128
s_add_u32 s38, s38, 393216
s_waitcnt vmcnt(14)
s_barrier
s_add_u32 m0, s39, 0
s_mov_b64 exec, s[60:61]
buffer_load_dwordx4 v4, s[8:11], s37 offen lds
s_mov_b64 exec, -1
s_add_u32 m0, s39, 3072
s_nop 0
buffer_load_dwordx4 v5, s[8:11], s37 offen lds
s_add_u32 m0, s39, 6144
s_nop 0
buffer_load_dwordx4 v6, s[8:11], s37 offen lds
s_add_u32 m0, s39, 9216
s_nop 0
buffer_load_dwordx4 v7, s[8:11], s37 offen lds
s_add_u32 m0, s39, 12288
s_nop 0
buffer_load_dwordx4 v8, s[8:11], s37 offen lds
s_add_u32 m0, s39, 15360
s_nop 0
buffer_load_dwordx4 v9, s[8:11], s37 offen lds
s_add_u32 m0, s40, 0
s_add_u32 s43, s38, 0
buffer_load_dwordx4 v2, s[12:15], s43 offen lds
s_add_u32 m0, s40, 1024
s_add_u32 s43, s38, 49152
buffer_load_dwordx4 v3, s[12:15], s43 offen lds
s_add_u32 m0, s40, 2048
s_add_u32 s43, s38, 98304
buffer_load_dwordx4 v2, s[12:15], s43 offen lds
s_add_u32 m0, s40, 3072
s_add_u32 s43, s38, 147456
buffer_load_dwordx4 v3, s[12:15], s43 offen lds
s_add_u32 m0, s40, 4096
s_add_u32 s43, s38, 196608
buffer_load_dwordx4 v2, s[12:15], s43 offen lds
s_add_u32 m0, s40, 5120
s_add_u32 s43, s38, 245760
buffer_load_dwordx4 v3, s[12:15], s43 offen lds
s_add_u32 m0, s40, 6144
s_add_u32 s43, s38, 294912
buffer_load_dwordx4 v2, s[12:15], s43 offen lds
s_add_u32 m0, s40, 7168
s_add_u32 s43, s38, 344064
buffer_load_dwordx4 v3, s[12:15], s43 offen lds
s_add_u32 s37, s37, 128
s_add_u32 s38, s38, 393216
s_waitcnt lgkmcnt(0)
s_load_dword s3, s[4:5], 100352
s_load_dword s3, s[4:5], 100416
s_load_dword s3, s[4:5], 100480
s_load_dword s3, s[4:5], 100544
s_load_dword s3, s[4:5], 107520
s_load_dword s3, s[4:5], 107584
s_load_dword s3, s[4:5], 107648
s_load_dword s3, s[4:5], 107712
s_load_dword s3, s[4:5], 114688
s_load_dword s3, s[4:5], 114752
s_load_dword s3, s[4:5], 114816
s_load_dword s3, s[4:5], 114880
s_load_dword s3, s[4:5], 121856
s_load_dword s3, s[4:5], 121920
s_waitcnt vmcnt(14)
s_barrier
s_add_u32 m0, s39, 43008
s_mov_b64 exec, s[60:61]
buffer_load_dwordx4 v4, s[8:11], s37 offen lds
s_mov_b64 exec, -1
s_add_u32 m0, s39, 46080
s_nop 0
buffer_load_dwordx4 v5, s[8:11], s37 offen lds
s_add_u32 m0, s39, 49152
s_nop 0
buffer_load_dwordx4 v6, s[8:11], s37 offen lds
s_add_u32 m0, s39, 52224
s_nop 0
buffer_load_dwordx4 v7, s[8:11], s37 offen lds
s_add_u32 m0, s39, 55296
s_nop 0
buffer_load_dwordx4 v8, s[8:11], s37 offen lds
s_add_u32 m0, s39, 58368
s_nop 0
buffer_load_dwordx4 v9, s[8:11], s37 offen lds
s_add_u32 m0, s40, 43008
s_add_u32 s43, s38, 0
buffer_load_dwordx4 v2, s[12:15], s43 offen lds
s_add_u32 m0, s40, 44032
s_add_u32 s43, s38, 49152
buffer_load_dwordx4 v3, s[12:15], s43 offen lds
s_add_u32 m0, s40, 45056
s_add_u32 s43, s38, 98304
buffer_load_dwordx4 v2, s[12:15], s43 offen lds
s_add_u32 m0, s40, 46080
s_add_u32 s43, s38, 147456
buffer_load_dwordx4 v3, s[12:15], s43 offen lds
s_add_u32 m0, s40, 47104
s_add_u32 s43, s38, 196608
buffer_load_dwordx4 v2, s[12:15], s43 offen lds
s_add_u32 m0, s40, 48128
s_add_u32 s43, s38, 245760
buffer_load_dwordx4 v3, s[12:15], s43 offen lds
s_add_u32 m0, s40, 49152
s_add_u32 s43, s38, 294912
buffer_load_dwordx4 v2, s[12:15], s43 offen lds
s_add_u32 m0, s40, 50176
s_add_u32 s43, s38, 344064
buffer_load_dwordx4 v3, s[12:15], s43 offen lds
s_add_u32 s37, s37, 128
s_add_u32 s38, s38, 393216
s_waitcnt vmcnt(14)
s_barrier
s_add_u32 m0, s39, 86016
s_mov_b64 exec, s[60:61]
buffer_load_dwordx4 v4, s[8:11], s37 offen lds
s_mov_b64 exec, -1
s_add_u32 m0, s39, 89088
s_nop 0
buffer_load_dwordx4 v5, s[8:11], s37 offen lds
s_add_u32 m0, s39, 92160
s_nop 0
buffer_load_dwordx4 v6, s[8:11], s37 offen lds
s_add_u32 m0, s39, 95232
s_nop 0
buffer_load_dwordx4 v7, s[8:11], s37 offen lds
s_add_u32 m0, s39, 98304
s_nop 0
buffer_load_dwordx4 v8, s[8:11], s37 offen lds
s_add_u32 m0, s39, 101376
s_nop 0
buffer_load_dwordx4 v9, s[8:11], s37 offen lds
s_add_u32 m0, s40, 86016
s_add_u32 s43, s38, 0
buffer_load_dwordx4 v2, s[12:15], s43 offen lds
s_add_u32 m0, s40, 87040
s_add_u32 s43, s38, 49152
buffer_load_dwordx4 v3, s[12:15], s43 offen lds
s_add_u32 m0, s40, 88064
s_add_u32 s43, s38, 98304
buffer_load_dwordx4 v2, s[12:15], s43 offen lds
s_add_u32 m0, s40, 89088
s_add_u32 s43, s38, 147456
buffer_load_dwordx4 v3, s[12:15], s43 offen lds
s_add_u32 m0, s40, 90112
s_add_u32 s43, s38, 196608
buffer_load_dwordx4 v2, s[12:15], s43 offen lds
s_add_u32 m0, s40, 91136
s_add_u32 s43, s38, 245760
buffer_load_dwordx4 v3, s[12:15], s43 offen lds
s_add_u32 m0, s40, 92160
s_add_u32 s43, s38, 294912
buffer_load_dwordx4 v2, s[12:15], s43 offen lds
s_add_u32 m0, s40, 93184
s_add_u32 s43, s38, 344064
buffer_load_dwordx4 v3, s[12:15], s43 offen lds
s_add_u32 s37, s37, 128
s_add_u32 s38, s38, 393216
s_waitcnt lgkmcnt(0)
s_load_dword s3, s[4:5], 121984
s_load_dword s3, s[4:5], 122048
s_load_dword s3, s[4:5], 129024
s_load_dword s3, s[4:5], 129088
s_load_dword s3, s[4:5], 129152
s_load_dword s3, s[4:5], 129216
s_load_dword s3, s[4:5], 136192
s_load_dword s3, s[4:5], 136256
s_load_dword s3, s[4:5], 136320
s_load_dword s3, s[4:5], 136384
s_load_dword s3, s[4:5], 143360
s_load_dword s3, s[4:5], 143424
s_load_dword s3, s[4:5], 143488
s_load_dword s3, s[4:5], 143552
s_waitcnt vmcnt(14)
s_barrier
s_add_u32 m0, s39, 0
s_mov_b64 exec, s[60:61]
buffer_load_dwordx4 v4, s[8:11], s37 offen lds
s_mov_b64 exec, -1
s_add_u32 m0, s39, 3072
s_nop 0
buffer_load_dwordx4 v5, s[8:11], s37 offen lds
s_add_u32 m0, s39, 6144
s_nop 0
buffer_load_dwordx4 v6, s[8:11], s37 offen lds
s_add_u32 m0, s39, 9216
s_nop 0
buffer_load_dwordx4 v7, s[8:11], s37 offen lds
s_add_u32 m0, s39, 12288
s_nop 0
buffer_load_dwordx4 v8, s[8:11], s37 offen lds
s_add_u32 m0, s39, 15360
s_nop 0
buffer_load_dwordx4 v9, s[8:11], s37 offen lds
s_add_u32 m0, s40, 0
s_add_u32 s43, s38, 0
buffer_load_dwordx4 v2, s[12:15], s43 offen lds
s_add_u32 m0, s40, 1024
s_add_u32 s43, s38, 49152
buffer_load_dwordx4 v3, s[12:15], s43 offen lds
s_add_u32 m0, s40, 2048
s_add_u32 s43, s38, 98304
buffer_load_dwordx4 v2, s[12:15], s43 offen lds
s_add_u32 m0, s40, 3072
s_add_u32 s43, s38, 147456
buffer_load_dwordx4 v3, s[12:15], s43 offen lds
s_add_u32 m0, s40, 4096
s_add_u32 s43, s38, 196608
buffer_load_dwordx4 v2, s[12:15], s43 offen lds
s_add_u32 m0, s40, 5120
s_add_u32 s43, s38, 245760
buffer_load_dwordx4 v3, s[12:15], s43 offen lds
s_add_u32 m0, s40, 6144
s_add_u32 s43, s38, 294912
buffer_load_dwordx4 v2, s[12:15], s43 offen lds
s_add_u32 m0, s40, 7168
s_add_u32 s43, s38, 344064
buffer_load_dwordx4 v3, s[12:15], s43 offen lds
s_add_u32 s37, s37, 128
s_add_u32 s38, s38, 393216
s_waitcnt vmcnt(14)
s_barrier
s_waitcnt lgkmcnt(0)
s_load_dword s3, s[4:5], 150528
s_load_dword s3, s[4:5], 150592
s_load_dword s3, s[4:5], 150656
s_load_dword s3, s[4:5], 150720
s_load_dword s3, s[4:5], 157696
s_load_dword s3, s[4:5], 157760
s_load_dword s3, s[4:5], 157824
s_load_dword s3, s[4:5], 157888
s_load_dword s3, s[4:5], 164864
s_load_dword s3, s[4:5], 164928
s_load_dword s3, s[4:5], 164992
s_load_dword s3, s[4:5], 165056
s_waitcnt vmcnt(0)
s_barrier
s_bitcmp0_b32 s2, 0
s_cselect_b32 s88, s72, s74
s_cselect_b32 s89, s73, s75
s_cmp_lt_u32 s2, 192
s_cselect_b32 s90, 7340032, 0
s_mov_b32 s91, 0x20000
s_bfe_u32 s44, s2, 0x30001
s_lshl_b32 s44, s44, 2
s_and_b32 s43, s36, 3
s_add_u32 s44, s44, s43
s_lshl_b32 s44, s44, 5
v_lshrrev_b32 v18, 4, v1
v_add_u32 v18, s44, v18
v_mul_u32_u24 v18, 7168, v18
v_and_b32 v19, 15, v1
v_lshl_add_u32 v18, v19, 4, v18
s_lshr_b32 s43, s2, 4
s_lshl_b32 s43, s43, 8
s_add_u32 s43, s43, 4096
v_add_u32 v18, s43, v18
s_mov_b32 s43, 0
buffer_load_dwordx4 v[128:131], v18, s[88:91], s43 offen
s_mov_b32 s43, 28672
s_branch Lov_1
.p2align 12
Lst_1_0:
s_branch Lwr_141
s_nop 0
s_nop 0
Lov_1:
buffer_load_dwordx4 v[132:135], v18, s[88:91], s43 offen
s_mov_b32 s43, 57344
buffer_load_dwordx4 v[136:139], v18, s[88:91], s43 offen
s_mov_b32 s43, 86016
buffer_load_dwordx4 v[140:143], v18, s[88:91], s43 offen
s_mov_b32 s43, 114688
buffer_load_dwordx4 v[144:147], v18, s[88:91], s43 offen
s_mov_b32 s43, 143360
buffer_load_dwordx4 v[148:151], v18, s[88:91], s43 offen
s_mov_b32 s43, 172032
buffer_load_dwordx4 v[152:155], v18, s[88:91], s43 offen
s_mov_b32 s43, 200704
buffer_load_dwordx4 v[156:159], v18, s[88:91], s43 offen
s_barrier
s_lshl_b32 s43, s35, 7
s_add_u32 s28, s68, s43
s_addc_u32 s29, s69, 0
s_mov_b32 s30, 2095232
s_mov_b32 s31, 0x20000
v_lshrrev_b32 v15, 3, v1
v_and_b32 v16, 6, v15
v_and_b32 v7, 7, v1
v_xor_b32 v7, v7, v16
v_lshlrev_b32 v7, 4, v7
v_mul_u32_u24 v15, 2048, v15
v_add_u32 v7, v7, v15
s_and_b32 s40, s36, 3
s_lshl_b32 s39, s40, 13
s_add_u32 s40, s40, s35
s_add_u32 s42, s40, 0
s_and_b32 s42, s42, 15
s_lshl_b32 s42, s42, 17
s_add_u32 m0, s39, 65536
s_add_u32 s43, s42, 0
buffer_load_dwordx4 v7, s[28:31], s43 offen lds
s_add_u32 m0, s39, 66560
s_add_u32 s43, s42, 16384
buffer_load_dwordx4 v7, s[28:31], s43 offen lds
s_add_u32 m0, s39, 67584
s_add_u32 s43, s42, 32768
buffer_load_dwordx4 v7, s[28:31], s43 offen lds
s_add_u32 m0, s39, 68608
s_add_u32 s43, s42, 49152
buffer_load_dwordx4 v7, s[28:31], s43 offen lds
s_add_u32 m0, s39, 69632
s_add_u32 s43, s42, 65536
buffer_load_dwordx4 v7, s[28:31], s43 offen lds
s_add_u32 m0, s39, 70656
s_add_u32 s43, s42, 81920
buffer_load_dwordx4 v7, s[28:31], s43 offen lds
s_add_u32 m0, s39, 71680
s_add_u32 s43, s42, 98304
buffer_load_dwordx4 v7, s[28:31], s43 offen lds
s_add_u32 m0, s39, 72704
s_add_u32 s43, s42, 114688
buffer_load_dwordx4 v7, s[28:31], s43 offen lds
s_branch Lats_6
Lcons_7:
s_lshl_b32 s43, s35, 7
s_waitcnt lgkmcnt(0)
s_mov_b32 s8, s64
s_mov_b32 s9, s65
s_mov_b32 s10, 4194304
s_mov_b32 s11, 0x20000
s_add_u32 s12, s66, s43
s_addc_u32 s13, s67, 0
s_mov_b32 s14, 6289536
s_mov_b32 s15, 0x20000
s_lshr_b32 s43, s2, 3
s_lshl_b32 s43, s43, 2
s_add_u32 s43, s43, s36
s_sub_u32 s44, s43, 0
s_and_b32 s44, s44, 127
s_cmp_lt_u32 s44, 7
s_cbranch_scc0 Lt_8
s_lshl_b32 s44, s44, 20
s_min_u32 s44, s44, 6291392
s_load_dword s3, s[66:67], s44
Lt_8:
s_sub_u32 s44, s43, 7
s_and_b32 s44, s44, 127
s_cmp_lt_u32 s44, 5
s_cbranch_scc0 Lt_9
s_lshl_b32 s44, s44, 20
s_min_u32 s44, s44, 4194240
s_load_dword s3, s[64:65], s44
Lt_9:
s_sub_u32 s44, s43, 12
s_and_b32 s44, s44, 127
s_cmp_lt_u32 s44, 1
s_cbranch_scc0 Lt_10
s_lshl_b32 s44, s44, 20
s_min_u32 s44, s44, 0
s_load_dword s3, s[80:81], s44
Lt_10:
s_sub_u32 s44, s43, 13
s_and_b32 s44, s44, 127
s_cmp_lt_u32 s44, 24
s_cbranch_scc0 Lt_11
s_lshl_b32 s44, s44, 20
s_min_u32 s44, s44, 24117184
s_load_dword s3, s[82:83], s44
Lt_11:
s_sub_u32 s44, s43, 37
s_and_b32 s44, s44, 127
s_cmp_lt_u32 s44, 8
s_cbranch_scc0 Lt_12
s_lshl_b32 s44, s44, 20
s_min_u32 s44, s44, 7339968
s_load_dword s3, s[72:73], s44
Lt_12:
s_sub_u32 s44, s43, 45
s_and_b32 s44, s44, 127
s_cmp_lt_u32 s44, 8
s_cbranch_scc0 Lt_13
s_lshl_b32 s44, s44, 20
s_min_u32 s44, s44, 7339968
s_load_dword s3, s[74:75], s44
Lt_13:
s_sub_u32 s44, s43, 53
s_and_b32 s44, s44, 127
s_cmp_lt_u32 s44, 3
s_cbranch_scc0 Lt_14
s_lshl_b32 s44, s44, 20
s_min_u32 s44, s44, 2097088
s_load_dword s3, s[68:69], s44
Lt_14:
s_sub_u32 s44, s43, 56
s_and_b32 s44, s44, 127
s_cmp_lt_u32 s44, 5
s_cbranch_scc0 Lt_15
s_lshl_b32 s44, s44, 20
s_min_u32 s44, s44, 4194240
s_add_u32 s44, s44, 25165824
s_load_dword s3, s[82:83], s44
Lt_15:
s_sub_u32 s44, s43, 61
s_and_b32 s44, s44, 127
s_cmp_lt_u32 s44, 8
s_cbranch_scc0 Lt_16
s_lshl_b32 s44, s44, 20
s_min_u32 s44, s44, 7339968
s_load_dword s3, s[76:77], s44
Lt_16:
s_sub_u32 s44, s43, 69
s_and_b32 s44, s44, 127
s_cmp_lt_u32 s44, 5
s_cbranch_scc0 Lt_17
s_lshl_b32 s44, s44, 20
s_min_u32 s44, s44, 4194240
s_add_u32 s44, s44, 33554432
s_load_dword s3, s[82:83], s44
Lt_17:
s_sub_u32 s44, s43, 74
s_and_b32 s44, s44, 127
s_cmp_lt_u32 s44, 5
s_cbranch_scc0 Lt_18
s_lshl_b32 s44, s44, 20
s_min_u32 s44, s44, 4194240
s_load_dword s3, s[78:79], s44
Lt_18:
v_lshrrev_b32 v16, 1, v12
v_xor_b32 v15, v13, v16
v_lshlrev_b32 v15, 4, v15
v_lshl_add_u32 v2, v12, 7, v15
v_xor_b32 v3, 64, v2
v_add_u32 v4, 86016, v2
v_add_u32 v5, 86016, v3
v_lshrrev_b32 v15, 2, v12
v_and_b32 v16, 3, v1
v_lshl_add_u32 v19, v13, 3, v15
v_lshlrev_b32 v19, 7, v19
v_and_b32 v15, 2, v15
v_and_b32 v17, 1, v13
v_lshl_add_u32 v15, v17, 2, v15
v_lshrrev_b32 v17, 1, v16
s_lshl_b32 s43, s36, 1
v_add_u32 v17, s43, v17
v_xor_b32 v15, v15, v17
v_lshl_add_u32 v19, v15, 4, v19
v_and_b32 v16, 1, v16
v_lshl_add_u32 v19, v16, 3, v19
v_add_u32 v6, 18432, v19
v_add_u32 v7, 61440, v19
v_add_u32 v8, 104448, v19
s_and_b32 s43, s36, 1
s_bfe_u32 s44, s36, 0x10001
s_lshr_b32 s45, s36, 2
v_lshlrev_b32 v14, 2, v13
v_sub_u32 v14, v12, v14
v_mov_b32 v16, 0xff800000
s_or_b32 s46, s34, s45
s_cmp_lg_u32 s46, 0
s_cselect_b32 s46, 0, 0xff800000
v_subrev_u32 v15, 0, v14
v_cmp_ge_u32 vcc, 7, v15
v_add_u32 v15, 16, v15
s_nop 0
v_cndmask_b32 v248, v16, 0, vcc
v_cmp_ge_u32 vcc, 7, v15
s_nop 1
v_cndmask_b32 v244, v16, 0, vcc
v_or_b32 v240, s46, v244
v_subrev_u32 v15, 1, v14
v_cmp_ge_u32 vcc, 7, v15
v_add_u32 v15, 16, v15
s_nop 0
v_cndmask_b32 v249, v16, 0, vcc
v_cmp_ge_u32 vcc, 7, v15
s_nop 1
v_cndmask_b32 v245, v16, 0, vcc
v_or_b32 v241, s46, v245
v_subrev_u32 v15, 2, v14
v_cmp_ge_u32 vcc, 7, v15
v_add_u32 v15, 16, v15
s_nop 0
v_cndmask_b32 v250, v16, 0, vcc
v_cmp_ge_u32 vcc, 7, v15
s_nop 1
v_cndmask_b32 v246, v16, 0, vcc
v_or_b32 v242, s46, v246
v_subrev_u32 v15, 3, v14
v_cmp_ge_u32 vcc, 7, v15
v_add_u32 v15, 16, v15
s_nop 0
v_cndmask_b32 v251, v16, 0, vcc
v_cmp_ge_u32 vcc, 7, v15
s_nop 1
v_cndmask_b32 v247, v16, 0, vcc
v_or_b32 v243, s46, v247
s_lshl_b32 s46, s45, 6
s_add_u32 s46, s46, s44
s_add_u32 s46, s46, 16
v_lshl_add_u32 v14, v12, 1, s46
s_lshl_b32 s47, s43, 6
v_lshl_add_u32 v15, v13, 4, s47
v_mul_u32_u24 v20, 400, v14
v_add_u32 v20, v20, v15
v_subrev_u32 v16, 32, v14
v_max_i32 v16, 0, v16
v_mul_u32_u24 v21, 400, v16
v_add_u32 v21, v21, v15
v_lshrrev_b32 v16, 2, v12
v_lshl_add_u32 v16, v13, 2, v16
v_lshl_add_u32 v16, v16, 1, s46
v_and_b32 v17, 3, v1
v_lshl_add_u32 v17, v17, 3, s47
v_mul_u32_u24 v22, 400, v16
v_add_u32 v22, v22, v17
v_subrev_u32 v16, 32, v16
v_max_i32 v16, 0, v16
v_mul_u32_u24 v23, 400, v16
v_add_u32 v23, v23, v17
s_mul_i32 s60, s34, 262144
s_add_u32 s16, s82, s60
s_addc_u32 s17, s83, 0
s_mov_b32 s18, 262144
s_mov_b32 s19, 0x20000
s_lshl_b32 s60, s35, 14
s_lshl_b32 s43, s43, 13
s_add_u32 s60, s60, s43
s_lshl_b32 s43, s45, 12
s_add_u32 s60, s60, s43
s_lshl_b32 s43, s44, 10
s_add_u32 s60, s60, s43
v_lshlrev_b32 v24, 4, v1
s_mov_b32 s61, 0x3e8293ee
s_lshl_b32 s38, s35, 7
s_add_u32 s56, s82, 28311552
s_addc_u32 s57, s83, 0
s_mov_b32 s58, 49152
s_mov_b32 s59, 0x20000
s_barrier
ds_read_b128 v[32:35], v2 offset:0
ds_read_b64_tr_b16 v[72:73], v6 offset:8192
ds_read_b64_tr_b16 v[74:75], v6 offset:8704
ds_read_b64_tr_b16 v[76:77], v6 offset:16384
ds_read_b64_tr_b16 v[78:79], v6 offset:16896
ds_read_b64_tr_b16 v[68:69], v6 offset:0
ds_read_b64_tr_b16 v[70:71], v6 offset:512
ds_read_b128 v[36:39], v2 offset:2048
ds_read_b128 v[40:43], v2 offset:4096
ds_read_b128 v[44:47], v2 offset:6144
ds_read_b128 v[48:51], v2 offset:8192
ds_read_b128 v[52:55], v2 offset:10240
ds_read_b128 v[56:59], v2 offset:12288
ds_read_b128 v[60:63], v2 offset:14336
ds_read_b128 v[64:67], v2 offset:16384
s_waitcnt lgkmcnt(0)
v_mfma_f32_16x16x32_bf16 v[164:167], v[72:75], v[32:35], 0
ds_read_b128 v[80:83], v3 offset:0
v_mfma_f32_16x16x32_bf16 v[200:203], v[76:79], v[32:35], 0
ds_read_b64_tr_b16 v[120:121], v6 offset:12288
v_mfma_f32_16x16x32_bf16 v[128:131], v[68:71], v[32:35], 0
ds_read_b64_tr_b16 v[122:123], v6 offset:12800
v_mfma_f32_16x16x32_bf16 v[132:135], v[68:71], v[36:39], 0
ds_read_b64_tr_b16 v[124:125], v6 offset:20480
v_mfma_f32_16x16x32_bf16 v[204:207], v[76:79], v[36:39], 0
ds_read_b64_tr_b16 v[126:127], v6 offset:20992
v_mfma_f32_16x16x32_bf16 v[168:171], v[72:75], v[36:39], 0
ds_read_b64_tr_b16 v[116:117], v6 offset:4096
v_mfma_f32_16x16x32_bf16 v[172:175], v[72:75], v[40:43], 0
ds_read_b64_tr_b16 v[118:119], v6 offset:4608
v_mfma_f32_16x16x32_bf16 v[208:211], v[76:79], v[40:43], 0
ds_read_b128 v[84:87], v3 offset:2048
v_mfma_f32_16x16x32_bf16 v[136:139], v[68:71], v[40:43], 0
ds_read_b128 v[88:91], v3 offset:4096
v_mfma_f32_16x16x32_bf16 v[140:143], v[68:71], v[44:47], 0
ds_read_b128 v[92:95], v3 offset:6144
v_mfma_f32_16x16x32_bf16 v[212:215], v[76:79], v[44:47], 0
ds_read_b128 v[96:99], v3 offset:8192
v_mfma_f32_16x16x32_bf16 v[176:179], v[72:75], v[44:47], 0
ds_read_b128 v[100:103], v3 offset:10240
v_mfma_f32_16x16x32_bf16 v[180:183], v[72:75], v[48:51], 0
ds_read_b128 v[104:107], v3 offset:12288
v_mfma_f32_16x16x32_bf16 v[216:219], v[76:79], v[48:51], 0
ds_read_b128 v[108:111], v3 offset:14336
v_mfma_f32_16x16x32_bf16 v[144:147], v[68:71], v[48:51], 0
ds_read_b128 v[112:115], v3 offset:16384
v_mfma_f32_16x16x32_bf16 v[148:151], v[68:71], v[52:55], 0
v_mfma_f32_16x16x32_bf16 v[220:223], v[76:79], v[52:55], 0
v_mfma_f32_16x16x32_bf16 v[184:187], v[72:75], v[52:55], 0
v_mfma_f32_16x16x32_bf16 v[188:191], v[72:75], v[56:59], 0
v_mfma_f32_16x16x32_bf16 v[224:227], v[76:79], v[56:59], 0
v_mfma_f32_16x16x32_bf16 v[152:155], v[68:71], v[56:59], 0
v_mfma_f32_16x16x32_bf16 v[156:159], v[68:71], v[60:63], 0
v_mfma_f32_16x16x32_bf16 v[228:231], v[76:79], v[60:63], 0
v_mfma_f32_16x16x32_bf16 v[192:195], v[72:75], v[60:63], 0
v_mfma_f32_16x16x32_bf16 v[196:199], v[72:75], v[64:67], 0
v_mfma_f32_16x16x32_bf16 v[232:235], v[76:79], v[64:67], 0
v_mfma_f32_16x16x32_bf16 v[160:163], v[68:71], v[64:67], 0
s_waitcnt lgkmcnt(0)
s_barrier
v_mfma_f32_16x16x32_bf16 v[164:167], v[120:123], v[80:83], v[164:167]
ds_read_b128 v[32:35], v2 offset:43008
v_mfma_f32_16x16x32_bf16 v[200:203], v[124:127], v[80:83], v[200:203]
ds_read_b64_tr_b16 v[72:73], v7 offset:8192
v_mfma_f32_16x16x32_bf16 v[128:131], v[116:119], v[80:83], v[128:131]
ds_read_b64_tr_b16 v[74:75], v7 offset:8704
v_mfma_f32_16x16x32_bf16 v[132:135], v[116:119], v[84:87], v[132:135]
ds_read_b64_tr_b16 v[76:77], v7 offset:16384
v_mfma_f32_16x16x32_bf16 v[204:207], v[124:127], v[84:87], v[204:207]
ds_read_b64_tr_b16 v[78:79], v7 offset:16896
v_mfma_f32_16x16x32_bf16 v[168:171], v[120:123], v[84:87], v[168:171]
ds_read_b64_tr_b16 v[68:69], v7 offset:0
v_mfma_f32_16x16x32_bf16 v[172:175], v[120:123], v[88:91], v[172:175]
ds_read_b64_tr_b16 v[70:71], v7 offset:512
v_mfma_f32_16x16x32_bf16 v[208:211], v[124:127], v[88:91], v[208:211]
ds_read_b128 v[36:39], v2 offset:45056
v_mfma_f32_16x16x32_bf16 v[136:139], v[116:119], v[88:91], v[136:139]
ds_read_b128 v[40:43], v2 offset:47104
v_mfma_f32_16x16x32_bf16 v[140:143], v[116:119], v[92:95], v[140:143]
ds_read_b128 v[44:47], v2 offset:49152
v_mfma_f32_16x16x32_bf16 v[212:215], v[124:127], v[92:95], v[212:215]
ds_read_b128 v[48:51], v2 offset:51200
v_mfma_f32_16x16x32_bf16 v[176:179], v[120:123], v[92:95], v[176:179]
ds_read_b128 v[52:55], v2 offset:53248
v_mfma_f32_16x16x32_bf16 v[180:183], v[120:123], v[96:99], v[180:183]
ds_read_b128 v[56:59], v2 offset:55296
v_mfma_f32_16x16x32_bf16 v[216:219], v[124:127], v[96:99], v[216:219]
ds_read_b128 v[60:63], v2 offset:57344
v_mfma_f32_16x16x32_bf16 v[144:147], v[116:119], v[96:99], v[144:147]
ds_read_b128 v[64:67], v2 offset:59392
v_mfma_f32_16x16x32_bf16 v[148:151], v[116:119], v[100:103], v[148:151]
v_mfma_f32_16x16x32_bf16 v[220:223], v[124:127], v[100:103], v[220:223]
v_mfma_f32_16x16x32_bf16 v[184:187], v[120:123], v[100:103], v[184:187]
v_mfma_f32_16x16x32_bf16 v[188:191], v[120:123], v[104:107], v[188:191]
v_mfma_f32_16x16x32_bf16 v[224:227], v[124:127], v[104:107], v[224:227]
v_mfma_f32_16x16x32_bf16 v[152:155], v[116:119], v[104:107], v[152:155]
v_mfma_f32_16x16x32_bf16 v[156:159], v[116:119], v[108:111], v[156:159]
v_mfma_f32_16x16x32_bf16 v[228:231], v[124:127], v[108:111], v[228:231]
v_mfma_f32_16x16x32_bf16 v[192:195], v[120:123], v[108:111], v[192:195]
v_mfma_f32_16x16x32_bf16 v[196:199], v[120:123], v[112:115], v[196:199]
v_mfma_f32_16x16x32_bf16 v[232:235], v[124:127], v[112:115], v[232:235]
v_mfma_f32_16x16x32_bf16 v[160:163], v[116:119], v[112:115], v[160:163]
s_waitcnt lgkmcnt(0)
v_mfma_f32_16x16x32_bf16 v[164:167], v[72:75], v[32:35], v[164:167]
ds_read_b128 v[80:83], v3 offset:43008
v_mfma_f32_16x16x32_bf16 v[200:203], v[76:79], v[32:35], v[200:203]
ds_read_b64_tr_b16 v[120:121], v7 offset:12288
v_mfma_f32_16x16x32_bf16 v[128:131], v[68:71], v[32:35], v[128:131]
ds_read_b64_tr_b16 v[122:123], v7 offset:12800
v_mfma_f32_16x16x32_bf16 v[132:135], v[68:71], v[36:39], v[132:135]
ds_read_b64_tr_b16 v[124:125], v7 offset:20480
v_mfma_f32_16x16x32_bf16 v[204:207], v[76:79], v[36:39], v[204:207]
ds_read_b64_tr_b16 v[126:127], v7 offset:20992
v_mfma_f32_16x16x32_bf16 v[168:171], v[72:75], v[36:39], v[168:171]
ds_read_b64_tr_b16 v[116:117], v7 offset:4096
v_mfma_f32_16x16x32_bf16 v[172:175], v[72:75], v[40:43], v[172:175]
ds_read_b64_tr_b16 v[118:119], v7 offset:4608
v_mfma_f32_16x16x32_bf16 v[208:211], v[76:79], v[40:43], v[208:211]
ds_read_b128 v[84:87], v3 offset:45056
v_mfma_f32_16x16x32_bf16 v[136:139], v[68:71], v[40:43], v[136:139]
ds_read_b128 v[88:91], v3 offset:47104
v_mfma_f32_16x16x32_bf16 v[140:143], v[68:71], v[44:47], v[140:143]
ds_read_b128 v[92:95], v3 offset:49152
v_mfma_f32_16x16x32_bf16 v[212:215], v[76:79], v[44:47], v[212:215]
ds_read_b128 v[96:99], v3 offset:51200
v_mfma_f32_16x16x32_bf16 v[176:179], v[72:75], v[44:47], v[176:179]
ds_read_b128 v[100:103], v3 offset:53248
v_mfma_f32_16x16x32_bf16 v[180:183], v[72:75], v[48:51], v[180:183]
ds_read_b128 v[104:107], v3 offset:55296
v_mfma_f32_16x16x32_bf16 v[216:219], v[76:79], v[48:51], v[216:219]
ds_read_b128 v[108:111], v3 offset:57344
v_mfma_f32_16x16x32_bf16 v[144:147], v[68:71], v[48:51], v[144:147]
ds_read_b128 v[112:115], v3 offset:59392
v_mfma_f32_16x16x32_bf16 v[148:151], v[68:71], v[52:55], v[148:151]
v_mfma_f32_16x16x32_bf16 v[220:223], v[76:79], v[52:55], v[220:223]
v_mfma_f32_16x16x32_bf16 v[184:187], v[72:75], v[52:55], v[184:187]
v_mfma_f32_16x16x32_bf16 v[188:191], v[72:75], v[56:59], v[188:191]
v_mfma_f32_16x16x32_bf16 v[224:227], v[76:79], v[56:59], v[224:227]
v_mfma_f32_16x16x32_bf16 v[152:155], v[68:71], v[56:59], v[152:155]
v_mfma_f32_16x16x32_bf16 v[156:159], v[68:71], v[60:63], v[156:159]
v_mfma_f32_16x16x32_bf16 v[228:231], v[76:79], v[60:63], v[228:231]
v_mfma_f32_16x16x32_bf16 v[192:195], v[72:75], v[60:63], v[192:195]
v_mfma_f32_16x16x32_bf16 v[196:199], v[72:75], v[64:67], v[196:199]
v_mfma_f32_16x16x32_bf16 v[232:235], v[76:79], v[64:67], v[232:235]
v_mfma_f32_16x16x32_bf16 v[160:163], v[68:71], v[64:67], v[160:163]
s_waitcnt lgkmcnt(0)
s_barrier
v_mfma_f32_16x16x32_bf16 v[164:167], v[120:123], v[80:83], v[164:167]
ds_read_b128 v[32:35], v4 offset:0
v_mfma_f32_16x16x32_bf16 v[200:203], v[124:127], v[80:83], v[200:203]
ds_read_b64_tr_b16 v[72:73], v8 offset:8192
v_mfma_f32_16x16x32_bf16 v[128:131], v[116:119], v[80:83], v[128:131]
ds_read_b64_tr_b16 v[74:75], v8 offset:8704
v_mfma_f32_16x16x32_bf16 v[132:135], v[116:119], v[84:87], v[132:135]
ds_read_b64_tr_b16 v[76:77], v8 offset:16384
v_mfma_f32_16x16x32_bf16 v[204:207], v[124:127], v[84:87], v[204:207]
ds_read_b64_tr_b16 v[78:79], v8 offset:16896
v_mfma_f32_16x16x32_bf16 v[168:171], v[120:123], v[84:87], v[168:171]
ds_read_b64_tr_b16 v[68:69], v8 offset:0
v_mfma_f32_16x16x32_bf16 v[172:175], v[120:123], v[88:91], v[172:175]
ds_read_b64_tr_b16 v[70:71], v8 offset:512
v_mfma_f32_16x16x32_bf16 v[208:211], v[124:127], v[88:91], v[208:211]
ds_read_b128 v[36:39], v4 offset:2048
v_mfma_f32_16x16x32_bf16 v[136:139], v[116:119], v[88:91], v[136:139]
ds_read_b128 v[40:43], v4 offset:4096
v_mfma_f32_16x16x32_bf16 v[140:143], v[116:119], v[92:95], v[140:143]
ds_read_b128 v[44:47], v4 offset:6144
v_mfma_f32_16x16x32_bf16 v[212:215], v[124:127], v[92:95], v[212:215]
ds_read_b128 v[48:51], v4 offset:8192
v_mfma_f32_16x16x32_bf16 v[176:179], v[120:123], v[92:95], v[176:179]
ds_read_b128 v[52:55], v4 offset:10240
v_mfma_f32_16x16x32_bf16 v[180:183], v[120:123], v[96:99], v[180:183]
ds_read_b128 v[56:59], v4 offset:12288
v_mfma_f32_16x16x32_bf16 v[216:219], v[124:127], v[96:99], v[216:219]
ds_read_b128 v[60:63], v4 offset:14336
v_mfma_f32_16x16x32_bf16 v[144:147], v[116:119], v[96:99], v[144:147]
ds_read_b128 v[64:67], v4 offset:16384
v_mfma_f32_16x16x32_bf16 v[148:151], v[116:119], v[100:103], v[148:151]
v_mfma_f32_16x16x32_bf16 v[220:223], v[124:127], v[100:103], v[220:223]
v_mfma_f32_16x16x32_bf16 v[184:187], v[120:123], v[100:103], v[184:187]
v_mfma_f32_16x16x32_bf16 v[188:191], v[120:123], v[104:107], v[188:191]
v_mfma_f32_16x16x32_bf16 v[224:227], v[124:127], v[104:107], v[224:227]
v_mfma_f32_16x16x32_bf16 v[152:155], v[116:119], v[104:107], v[152:155]
v_mfma_f32_16x16x32_bf16 v[156:159], v[116:119], v[108:111], v[156:159]
v_mfma_f32_16x16x32_bf16 v[228:231], v[124:127], v[108:111], v[228:231]
v_mfma_f32_16x16x32_bf16 v[192:195], v[120:123], v[108:111], v[192:195]
v_mfma_f32_16x16x32_bf16 v[196:199], v[120:123], v[112:115], v[196:199]
v_mfma_f32_16x16x32_bf16 v[232:235], v[124:127], v[112:115], v[232:235]
v_mfma_f32_16x16x32_bf16 v[160:163], v[116:119], v[112:115], v[160:163]
s_waitcnt lgkmcnt(0)
v_mfma_f32_16x16x32_bf16 v[164:167], v[72:75], v[32:35], v[164:167]
ds_read_b128 v[80:83], v5 offset:0
v_mfma_f32_16x16x32_bf16 v[200:203], v[76:79], v[32:35], v[200:203]
ds_read_b64_tr_b16 v[120:121], v8 offset:12288
v_mfma_f32_16x16x32_bf16 v[128:131], v[68:71], v[32:35], v[128:131]
ds_read_b64_tr_b16 v[122:123], v8 offset:12800
v_mfma_f32_16x16x32_bf16 v[132:135], v[68:71], v[36:39], v[132:135]
ds_read_b64_tr_b16 v[124:125], v8 offset:20480
v_mfma_f32_16x16x32_bf16 v[204:207], v[76:79], v[36:39], v[204:207]
ds_read_b64_tr_b16 v[126:127], v8 offset:20992
v_mfma_f32_16x16x32_bf16 v[168:171], v[72:75], v[36:39], v[168:171]
ds_read_b64_tr_b16 v[116:117], v8 offset:4096
v_mfma_f32_16x16x32_bf16 v[172:175], v[72:75], v[40:43], v[172:175]
ds_read_b64_tr_b16 v[118:119], v8 offset:4608
v_mfma_f32_16x16x32_bf16 v[208:211], v[76:79], v[40:43], v[208:211]
ds_read_b128 v[84:87], v5 offset:2048
v_mfma_f32_16x16x32_bf16 v[136:139], v[68:71], v[40:43], v[136:139]
ds_read_b128 v[88:91], v5 offset:4096
v_mfma_f32_16x16x32_bf16 v[140:143], v[68:71], v[44:47], v[140:143]
ds_read_b128 v[92:95], v5 offset:6144
v_mfma_f32_16x16x32_bf16 v[212:215], v[76:79], v[44:47], v[212:215]
ds_read_b128 v[96:99], v5 offset:8192
v_mfma_f32_16x16x32_bf16 v[176:179], v[72:75], v[44:47], v[176:179]
ds_read_b128 v[100:103], v5 offset:10240
v_mfma_f32_16x16x32_bf16 v[180:183], v[72:75], v[48:51], v[180:183]
ds_read_b128 v[104:107], v5 offset:12288
v_mfma_f32_16x16x32_bf16 v[216:219], v[76:79], v[48:51], v[216:219]
ds_read_b128 v[108:111], v5 offset:14336
v_mfma_f32_16x16x32_bf16 v[144:147], v[68:71], v[48:51], v[144:147]
ds_read_b128 v[112:115], v5 offset:16384
v_mfma_f32_16x16x32_bf16 v[148:151], v[68:71], v[52:55], v[148:151]
v_mfma_f32_16x16x32_bf16 v[220:223], v[76:79], v[52:55], v[220:223]
v_mfma_f32_16x16x32_bf16 v[184:187], v[72:75], v[52:55], v[184:187]
v_mfma_f32_16x16x32_bf16 v[188:191], v[72:75], v[56:59], v[188:191]
v_mfma_f32_16x16x32_bf16 v[224:227], v[76:79], v[56:59], v[224:227]
v_mfma_f32_16x16x32_bf16 v[152:155], v[68:71], v[56:59], v[152:155]
v_mfma_f32_16x16x32_bf16 v[156:159], v[68:71], v[60:63], v[156:159]
v_mfma_f32_16x16x32_bf16 v[228:231], v[76:79], v[60:63], v[228:231]
v_mfma_f32_16x16x32_bf16 v[192:195], v[72:75], v[60:63], v[192:195]
v_mfma_f32_16x16x32_bf16 v[196:199], v[72:75], v[64:67], v[196:199]
v_mfma_f32_16x16x32_bf16 v[232:235], v[76:79], v[64:67], v[232:235]
v_mfma_f32_16x16x32_bf16 v[160:163], v[68:71], v[64:67], v[160:163]
s_waitcnt lgkmcnt(0)
s_barrier
v_mfma_f32_16x16x32_bf16 v[164:167], v[120:123], v[80:83], v[164:167]
ds_read_b128 v[32:35], v2 offset:0
v_mfma_f32_16x16x32_bf16 v[200:203], v[124:127], v[80:83], v[200:203]
ds_read_b64_tr_b16 v[72:73], v6 offset:8192
v_mfma_f32_16x16x32_bf16 v[128:131], v[116:119], v[80:83], v[128:131]
ds_read_b64_tr_b16 v[74:75], v6 offset:8704
v_mfma_f32_16x16x32_bf16 v[132:135], v[116:119], v[84:87], v[132:135]
ds_read_b64_tr_b16 v[76:77], v6 offset:16384
v_mfma_f32_16x16x32_bf16 v[204:207], v[124:127], v[84:87], v[204:207]
ds_read_b64_tr_b16 v[78:79], v6 offset:16896
v_mfma_f32_16x16x32_bf16 v[168:171], v[120:123], v[84:87], v[168:171]
ds_read_b64_tr_b16 v[68:69], v6 offset:0
v_mfma_f32_16x16x32_bf16 v[172:175], v[120:123], v[88:91], v[172:175]
ds_read_b64_tr_b16 v[70:71], v6 offset:512
v_mfma_f32_16x16x32_bf16 v[208:211], v[124:127], v[88:91], v[208:211]
ds_read_b128 v[36:39], v2 offset:2048
v_mfma_f32_16x16x32_bf16 v[136:139], v[116:119], v[88:91], v[136:139]
ds_read_b128 v[40:43], v2 offset:4096
v_mfma_f32_16x16x32_bf16 v[140:143], v[116:119], v[92:95], v[140:143]
ds_read_b128 v[44:47], v2 offset:6144
v_mfma_f32_16x16x32_bf16 v[212:215], v[124:127], v[92:95], v[212:215]
ds_read_b128 v[48:51], v2 offset:8192
v_mfma_f32_16x16x32_bf16 v[176:179], v[120:123], v[92:95], v[176:179]
ds_read_b128 v[52:55], v2 offset:10240
v_mfma_f32_16x16x32_bf16 v[180:183], v[120:123], v[96:99], v[180:183]
ds_read_b128 v[56:59], v2 offset:12288
v_mfma_f32_16x16x32_bf16 v[216:219], v[124:127], v[96:99], v[216:219]
ds_read_b128 v[60:63], v2 offset:14336
v_mfma_f32_16x16x32_bf16 v[144:147], v[116:119], v[96:99], v[144:147]
ds_read_b128 v[64:67], v2 offset:16384
v_mfma_f32_16x16x32_bf16 v[148:151], v[116:119], v[100:103], v[148:151]
v_mfma_f32_16x16x32_bf16 v[220:223], v[124:127], v[100:103], v[220:223]
v_mfma_f32_16x16x32_bf16 v[184:187], v[120:123], v[100:103], v[184:187]
v_mfma_f32_16x16x32_bf16 v[188:191], v[120:123], v[104:107], v[188:191]
v_mfma_f32_16x16x32_bf16 v[224:227], v[124:127], v[104:107], v[224:227]
v_mfma_f32_16x16x32_bf16 v[152:155], v[116:119], v[104:107], v[152:155]
v_mfma_f32_16x16x32_bf16 v[156:159], v[116:119], v[108:111], v[156:159]
v_mfma_f32_16x16x32_bf16 v[228:231], v[124:127], v[108:111], v[228:231]
v_mfma_f32_16x16x32_bf16 v[192:195], v[120:123], v[108:111], v[192:195]
v_mfma_f32_16x16x32_bf16 v[196:199], v[120:123], v[112:115], v[196:199]
v_mfma_f32_16x16x32_bf16 v[232:235], v[124:127], v[112:115], v[232:235]
v_mfma_f32_16x16x32_bf16 v[160:163], v[116:119], v[112:115], v[160:163]
s_mov_b32 s41, 4
Lcl_19:
s_waitcnt lgkmcnt(0)
v_mfma_f32_16x16x32_bf16 v[164:167], v[72:75], v[32:35], v[164:167]
ds_read_b128 v[80:83], v3 offset:0
v_mfma_f32_16x16x32_bf16 v[200:203], v[76:79], v[32:35], v[200:203]
ds_read_b64_tr_b16 v[120:121], v6 offset:12288
v_mfma_f32_16x16x32_bf16 v[128:131], v[68:71], v[32:35], v[128:131]
ds_read_b64_tr_b16 v[122:123], v6 offset:12800
v_mfma_f32_16x16x32_bf16 v[132:135], v[68:71], v[36:39], v[132:135]
ds_read_b64_tr_b16 v[124:125], v6 offset:20480
v_mfma_f32_16x16x32_bf16 v[204:207], v[76:79], v[36:39], v[204:207]
ds_read_b64_tr_b16 v[126:127], v6 offset:20992
v_mfma_f32_16x16x32_bf16 v[168:171], v[72:75], v[36:39], v[168:171]
ds_read_b64_tr_b16 v[116:117], v6 offset:4096
v_mfma_f32_16x16x32_bf16 v[172:175], v[72:75], v[40:43], v[172:175]
ds_read_b64_tr_b16 v[118:119], v6 offset:4608
v_mfma_f32_16x16x32_bf16 v[208:211], v[76:79], v[40:43], v[208:211]
ds_read_b128 v[84:87], v3 offset:2048
v_mfma_f32_16x16x32_bf16 v[136:139], v[68:71], v[40:43], v[136:139]
ds_read_b128 v[88:91], v3 offset:4096
v_mfma_f32_16x16x32_bf16 v[140:143], v[68:71], v[44:47], v[140:143]
ds_read_b128 v[92:95], v3 offset:6144
v_mfma_f32_16x16x32_bf16 v[212:215], v[76:79], v[44:47], v[212:215]
ds_read_b128 v[96:99], v3 offset:8192
v_mfma_f32_16x16x32_bf16 v[176:179], v[72:75], v[44:47], v[176:179]
ds_read_b128 v[100:103], v3 offset:10240
v_mfma_f32_16x16x32_bf16 v[180:183], v[72:75], v[48:51], v[180:183]
ds_read_b128 v[104:107], v3 offset:12288
v_mfma_f32_16x16x32_bf16 v[216:219], v[76:79], v[48:51], v[216:219]
ds_read_b128 v[108:111], v3 offset:14336
v_mfma_f32_16x16x32_bf16 v[144:147], v[68:71], v[48:51], v[144:147]
ds_read_b128 v[112:115], v3 offset:16384
v_mfma_f32_16x16x32_bf16 v[148:151], v[68:71], v[52:55], v[148:151]
v_mfma_f32_16x16x32_bf16 v[220:223], v[76:79], v[52:55], v[220:223]
v_mfma_f32_16x16x32_bf16 v[184:187], v[72:75], v[52:55], v[184:187]
v_mfma_f32_16x16x32_bf16 v[188:191], v[72:75], v[56:59], v[188:191]
v_mfma_f32_16x16x32_bf16 v[224:227], v[76:79], v[56:59], v[224:227]
v_mfma_f32_16x16x32_bf16 v[152:155], v[68:71], v[56:59], v[152:155]
v_mfma_f32_16x16x32_bf16 v[156:159], v[68:71], v[60:63], v[156:159]
v_mfma_f32_16x16x32_bf16 v[228:231], v[76:79], v[60:63], v[228:231]
v_mfma_f32_16x16x32_bf16 v[192:195], v[72:75], v[60:63], v[192:195]
v_mfma_f32_16x16x32_bf16 v[196:199], v[72:75], v[64:67], v[196:199]
v_mfma_f32_16x16x32_bf16 v[232:235], v[76:79], v[64:67], v[232:235]
v_mfma_f32_16x16x32_bf16 v[160:163], v[68:71], v[64:67], v[160:163]
s_waitcnt lgkmcnt(0)
s_barrier
v_mfma_f32_16x16x32_bf16 v[164:167], v[120:123], v[80:83], v[164:167]
ds_read_b128 v[32:35], v2 offset:43008
v_mfma_f32_16x16x32_bf16 v[200:203], v[124:127], v[80:83], v[200:203]
ds_read_b64_tr_b16 v[72:73], v7 offset:8192
v_mfma_f32_16x16x32_bf16 v[128:131], v[116:119], v[80:83], v[128:131]
ds_read_b64_tr_b16 v[74:75], v7 offset:8704
s_branch Lov_2
.p2align 12
Lst_2_0:
s_branch Lwr_142
s_nop 0
s_nop 0
Lov_2:
v_mfma_f32_16x16x32_bf16 v[132:135], v[116:119], v[84:87], v[132:135]
ds_read_b64_tr_b16 v[76:77], v7 offset:16384
v_mfma_f32_16x16x32_bf16 v[204:207], v[124:127], v[84:87], v[204:207]
ds_read_b64_tr_b16 v[78:79], v7 offset:16896
v_mfma_f32_16x16x32_bf16 v[168:171], v[120:123], v[84:87], v[168:171]
ds_read_b64_tr_b16 v[68:69], v7 offset:0
v_mfma_f32_16x16x32_bf16 v[172:175], v[120:123], v[88:91], v[172:175]
ds_read_b64_tr_b16 v[70:71], v7 offset:512
v_mfma_f32_16x16x32_bf16 v[208:211], v[124:127], v[88:91], v[208:211]
ds_read_b128 v[36:39], v2 offset:45056
v_mfma_f32_16x16x32_bf16 v[136:139], v[116:119], v[88:91], v[136:139]
ds_read_b128 v[40:43], v2 offset:47104
v_mfma_f32_16x16x32_bf16 v[140:143], v[116:119], v[92:95], v[140:143]
ds_read_b128 v[44:47], v2 offset:49152
v_mfma_f32_16x16x32_bf16 v[212:215], v[124:127], v[92:95], v[212:215]
ds_read_b128 v[48:51], v2 offset:51200
v_mfma_f32_16x16x32_bf16 v[176:179], v[120:123], v[92:95], v[176:179]
ds_read_b128 v[52:55], v2 offset:53248
v_mfma_f32_16x16x32_bf16 v[180:183], v[120:123], v[96:99], v[180:183]
ds_read_b128 v[56:59], v2 offset:55296
v_mfma_f32_16x16x32_bf16 v[216:219], v[124:127], v[96:99], v[216:219]
ds_read_b128 v[60:63], v2 offset:57344
v_mfma_f32_16x16x32_bf16 v[144:147], v[116:119], v[96:99], v[144:147]
ds_read_b128 v[64:67], v2 offset:59392
v_mfma_f32_16x16x32_bf16 v[148:151], v[116:119], v[100:103], v[148:151]
v_mfma_f32_16x16x32_bf16 v[220:223], v[124:127], v[100:103], v[220:223]
v_mfma_f32_16x16x32_bf16 v[184:187], v[120:123], v[100:103], v[184:187]
v_mfma_f32_16x16x32_bf16 v[188:191], v[120:123], v[104:107], v[188:191]
v_mfma_f32_16x16x32_bf16 v[224:227], v[124:127], v[104:107], v[224:227]
v_mfma_f32_16x16x32_bf16 v[152:155], v[116:119], v[104:107], v[152:155]
v_mfma_f32_16x16x32_bf16 v[156:159], v[116:119], v[108:111], v[156:159]
v_mfma_f32_16x16x32_bf16 v[228:231], v[124:127], v[108:111], v[228:231]
v_mfma_f32_16x16x32_bf16 v[192:195], v[120:123], v[108:111], v[192:195]
v_mfma_f32_16x16x32_bf16 v[196:199], v[120:123], v[112:115], v[196:199]
v_mfma_f32_16x16x32_bf16 v[232:235], v[124:127], v[112:115], v[232:235]
v_mfma_f32_16x16x32_bf16 v[160:163], v[116:119], v[112:115], v[160:163]
s_waitcnt lgkmcnt(0)
v_mfma_f32_16x16x32_bf16 v[164:167], v[72:75], v[32:35], v[164:167]
ds_read_b128 v[80:83], v3 offset:43008
v_mfma_f32_16x16x32_bf16 v[200:203], v[76:79], v[32:35], v[200:203]
ds_read_b64_tr_b16 v[120:121], v7 offset:12288
v_mfma_f32_16x16x32_bf16 v[128:131], v[68:71], v[32:35], v[128:131]
ds_read_b64_tr_b16 v[122:123], v7 offset:12800
v_mfma_f32_16x16x32_bf16 v[132:135], v[68:71], v[36:39], v[132:135]
ds_read_b64_tr_b16 v[124:125], v7 offset:20480
v_mfma_f32_16x16x32_bf16 v[204:207], v[76:79], v[36:39], v[204:207]
ds_read_b64_tr_b16 v[126:127], v7 offset:20992
v_mfma_f32_16x16x32_bf16 v[168:171], v[72:75], v[36:39], v[168:171]
ds_read_b64_tr_b16 v[116:117], v7 offset:4096
v_mfma_f32_16x16x32_bf16 v[172:175], v[72:75], v[40:43], v[172:175]
ds_read_b64_tr_b16 v[118:119], v7 offset:4608
v_mfma_f32_16x16x32_bf16 v[208:211], v[76:79], v[40:43], v[208:211]
ds_read_b128 v[84:87], v3 offset:45056
v_mfma_f32_16x16x32_bf16 v[136:139], v[68:71], v[40:43], v[136:139]
ds_read_b128 v[88:91], v3 offset:47104
v_mfma_f32_16x16x32_bf16 v[140:143], v[68:71], v[44:47], v[140:143]
ds_read_b128 v[92:95], v3 offset:49152
v_mfma_f32_16x16x32_bf16 v[212:215], v[76:79], v[44:47], v[212:215]
ds_read_b128 v[96:99], v3 offset:51200
v_mfma_f32_16x16x32_bf16 v[176:179], v[72:75], v[44:47], v[176:179]
ds_read_b128 v[100:103], v3 offset:53248
v_mfma_f32_16x16x32_bf16 v[180:183], v[72:75], v[48:51], v[180:183]
ds_read_b128 v[104:107], v3 offset:55296
v_mfma_f32_16x16x32_bf16 v[216:219], v[76:79], v[48:51], v[216:219]
ds_read_b128 v[108:111], v3 offset:57344
v_mfma_f32_16x16x32_bf16 v[144:147], v[68:71], v[48:51], v[144:147]
ds_read_b128 v[112:115], v3 offset:59392
v_mfma_f32_16x16x32_bf16 v[148:151], v[68:71], v[52:55], v[148:151]
v_mfma_f32_16x16x32_bf16 v[220:223], v[76:79], v[52:55], v[220:223]
v_mfma_f32_16x16x32_bf16 v[184:187], v[72:75], v[52:55], v[184:187]
v_mfma_f32_16x16x32_bf16 v[188:191], v[72:75], v[56:59], v[188:191]
v_mfma_f32_16x16x32_bf16 v[224:227], v[76:79], v[56:59], v[224:227]
v_mfma_f32_16x16x32_bf16 v[152:155], v[68:71], v[56:59], v[152:155]
v_mfma_f32_16x16x32_bf16 v[156:159], v[68:71], v[60:63], v[156:159]
v_mfma_f32_16x16x32_bf16 v[228:231], v[76:79], v[60:63], v[228:231]
v_mfma_f32_16x16x32_bf16 v[192:195], v[72:75], v[60:63], v[192:195]
v_mfma_f32_16x16x32_bf16 v[196:199], v[72:75], v[64:67], v[196:199]
v_mfma_f32_16x16x32_bf16 v[232:235], v[76:79], v[64:67], v[232:235]
v_mfma_f32_16x16x32_bf16 v[160:163], v[68:71], v[64:67], v[160:163]
s_waitcnt lgkmcnt(0)
s_barrier
v_mfma_f32_16x16x32_bf16 v[164:167], v[120:123], v[80:83], v[164:167]
ds_read_b128 v[32:35], v4 offset:0
v_mfma_f32_16x16x32_bf16 v[200:203], v[124:127], v[80:83], v[200:203]
ds_read_b64_tr_b16 v[72:73], v8 offset:8192
v_mfma_f32_16x16x32_bf16 v[128:131], v[116:119], v[80:83], v[128:131]
ds_read_b64_tr_b16 v[74:75], v8 offset:8704
v_mfma_f32_16x16x32_bf16 v[132:135], v[116:119], v[84:87], v[132:135]
ds_read_b64_tr_b16 v[76:77], v8 offset:16384
v_mfma_f32_16x16x32_bf16 v[204:207], v[124:127], v[84:87], v[204:207]
ds_read_b64_tr_b16 v[78:79], v8 offset:16896
v_mfma_f32_16x16x32_bf16 v[168:171], v[120:123], v[84:87], v[168:171]
ds_read_b64_tr_b16 v[68:69], v8 offset:0
v_mfma_f32_16x16x32_bf16 v[172:175], v[120:123], v[88:91], v[172:175]
ds_read_b64_tr_b16 v[70:71], v8 offset:512
v_mfma_f32_16x16x32_bf16 v[208:211], v[124:127], v[88:91], v[208:211]
ds_read_b128 v[36:39], v4 offset:2048
v_mfma_f32_16x16x32_bf16 v[136:139], v[116:119], v[88:91], v[136:139]
ds_read_b128 v[40:43], v4 offset:4096
v_mfma_f32_16x16x32_bf16 v[140:143], v[116:119], v[92:95], v[140:143]
ds_read_b128 v[44:47], v4 offset:6144
v_mfma_f32_16x16x32_bf16 v[212:215], v[124:127], v[92:95], v[212:215]
ds_read_b128 v[48:51], v4 offset:8192
v_mfma_f32_16x16x32_bf16 v[176:179], v[120:123], v[92:95], v[176:179]
ds_read_b128 v[52:55], v4 offset:10240
v_mfma_f32_16x16x32_bf16 v[180:183], v[120:123], v[96:99], v[180:183]
ds_read_b128 v[56:59], v4 offset:12288
v_mfma_f32_16x16x32_bf16 v[216:219], v[124:127], v[96:99], v[216:219]
ds_read_b128 v[60:63], v4 offset:14336
v_mfma_f32_16x16x32_bf16 v[144:147], v[116:119], v[96:99], v[144:147]
ds_read_b128 v[64:67], v4 offset:16384
v_mfma_f32_16x16x32_bf16 v[148:151], v[116:119], v[100:103], v[148:151]
v_mfma_f32_16x16x32_bf16 v[220:223], v[124:127], v[100:103], v[220:223]
v_mfma_f32_16x16x32_bf16 v[184:187], v[120:123], v[100:103], v[184:187]
v_mfma_f32_16x16x32_bf16 v[188:191], v[120:123], v[104:107], v[188:191]
v_mfma_f32_16x16x32_bf16 v[224:227], v[124:127], v[104:107], v[224:227]
v_mfma_f32_16x16x32_bf16 v[152:155], v[116:119], v[104:107], v[152:155]
v_mfma_f32_16x16x32_bf16 v[156:159], v[116:119], v[108:111], v[156:159]
v_mfma_f32_16x16x32_bf16 v[228:231], v[124:127], v[108:111], v[228:231]
v_mfma_f32_16x16x32_bf16 v[192:195], v[120:123], v[108:111], v[192:195]
v_mfma_f32_16x16x32_bf16 v[196:199], v[120:123], v[112:115], v[196:199]
v_mfma_f32_16x16x32_bf16 v[232:235], v[124:127], v[112:115], v[232:235]
v_mfma_f32_16x16x32_bf16 v[160:163], v[116:119], v[112:115], v[160:163]
s_waitcnt lgkmcnt(0)
v_mfma_f32_16x16x32_bf16 v[164:167], v[72:75], v[32:35], v[164:167]
ds_read_b128 v[80:83], v5 offset:0
v_mfma_f32_16x16x32_bf16 v[200:203], v[76:79], v[32:35], v[200:203]
ds_read_b64_tr_b16 v[120:121], v8 offset:12288
v_mfma_f32_16x16x32_bf16 v[128:131], v[68:71], v[32:35], v[128:131]
ds_read_b64_tr_b16 v[122:123], v8 offset:12800
v_mfma_f32_16x16x32_bf16 v[132:135], v[68:71], v[36:39], v[132:135]
ds_read_b64_tr_b16 v[124:125], v8 offset:20480
v_mfma_f32_16x16x32_bf16 v[204:207], v[76:79], v[36:39], v[204:207]
ds_read_b64_tr_b16 v[126:127], v8 offset:20992
v_mfma_f32_16x16x32_bf16 v[168:171], v[72:75], v[36:39], v[168:171]
ds_read_b64_tr_b16 v[116:117], v8 offset:4096
v_mfma_f32_16x16x32_bf16 v[172:175], v[72:75], v[40:43], v[172:175]
ds_read_b64_tr_b16 v[118:119], v8 offset:4608
v_mfma_f32_16x16x32_bf16 v[208:211], v[76:79], v[40:43], v[208:211]
ds_read_b128 v[84:87], v5 offset:2048
v_mfma_f32_16x16x32_bf16 v[136:139], v[68:71], v[40:43], v[136:139]
ds_read_b128 v[88:91], v5 offset:4096
v_mfma_f32_16x16x32_bf16 v[140:143], v[68:71], v[44:47], v[140:143]
ds_read_b128 v[92:95], v5 offset:6144
v_mfma_f32_16x16x32_bf16 v[212:215], v[76:79], v[44:47], v[212:215]
ds_read_b128 v[96:99], v5 offset:8192
v_mfma_f32_16x16x32_bf16 v[176:179], v[72:75], v[44:47], v[176:179]
ds_read_b128 v[100:103], v5 offset:10240
v_mfma_f32_16x16x32_bf16 v[180:183], v[72:75], v[48:51], v[180:183]
ds_read_b128 v[104:107], v5 offset:12288
v_mfma_f32_16x16x32_bf16 v[216:219], v[76:79], v[48:51], v[216:219]
ds_read_b128 v[108:111], v5 offset:14336
v_mfma_f32_16x16x32_bf16 v[144:147], v[68:71], v[48:51], v[144:147]
ds_read_b128 v[112:115], v5 offset:16384
v_mfma_f32_16x16x32_bf16 v[148:151], v[68:71], v[52:55], v[148:151]
v_mfma_f32_16x16x32_bf16 v[220:223], v[76:79], v[52:55], v[220:223]
v_mfma_f32_16x16x32_bf16 v[184:187], v[72:75], v[52:55], v[184:187]
v_mfma_f32_16x16x32_bf16 v[188:191], v[72:75], v[56:59], v[188:191]
v_mfma_f32_16x16x32_bf16 v[224:227], v[76:79], v[56:59], v[224:227]
v_mfma_f32_16x16x32_bf16 v[152:155], v[68:71], v[56:59], v[152:155]
v_mfma_f32_16x16x32_bf16 v[156:159], v[68:71], v[60:63], v[156:159]
v_mfma_f32_16x16x32_bf16 v[228:231], v[76:79], v[60:63], v[228:231]
v_mfma_f32_16x16x32_bf16 v[192:195], v[72:75], v[60:63], v[192:195]
v_mfma_f32_16x16x32_bf16 v[196:199], v[72:75], v[64:67], v[196:199]
v_mfma_f32_16x16x32_bf16 v[232:235], v[76:79], v[64:67], v[232:235]
v_mfma_f32_16x16x32_bf16 v[160:163], v[68:71], v[64:67], v[160:163]
s_waitcnt lgkmcnt(0)
s_barrier
v_mfma_f32_16x16x32_bf16 v[164:167], v[120:123], v[80:83], v[164:167]
ds_read_b128 v[32:35], v2 offset:0
v_mfma_f32_16x16x32_bf16 v[200:203], v[124:127], v[80:83], v[200:203]
ds_read_b64_tr_b16 v[72:73], v6 offset:8192
v_mfma_f32_16x16x32_bf16 v[128:131], v[116:119], v[80:83], v[128:131]
ds_read_b64_tr_b16 v[74:75], v6 offset:8704
v_mfma_f32_16x16x32_bf16 v[132:135], v[116:119], v[84:87], v[132:135]
ds_read_b64_tr_b16 v[76:77], v6 offset:16384
v_mfma_f32_16x16x32_bf16 v[204:207], v[124:127], v[84:87], v[204:207]
ds_read_b64_tr_b16 v[78:79], v6 offset:16896
v_mfma_f32_16x16x32_bf16 v[168:171], v[120:123], v[84:87], v[168:171]
ds_read_b64_tr_b16 v[68:69], v6 offset:0
v_mfma_f32_16x16x32_bf16 v[172:175], v[120:123], v[88:91], v[172:175]
ds_read_b64_tr_b16 v[70:71], v6 offset:512
v_mfma_f32_16x16x32_bf16 v[208:211], v[124:127], v[88:91], v[208:211]
ds_read_b128 v[36:39], v2 offset:2048
v_mfma_f32_16x16x32_bf16 v[136:139], v[116:119], v[88:91], v[136:139]
ds_read_b128 v[40:43], v2 offset:4096
v_mfma_f32_16x16x32_bf16 v[140:143], v[116:119], v[92:95], v[140:143]
ds_read_b128 v[44:47], v2 offset:6144
v_mfma_f32_16x16x32_bf16 v[212:215], v[124:127], v[92:95], v[212:215]
ds_read_b128 v[48:51], v2 offset:8192
v_mfma_f32_16x16x32_bf16 v[176:179], v[120:123], v[92:95], v[176:179]
ds_read_b128 v[52:55], v2 offset:10240
v_mfma_f32_16x16x32_bf16 v[180:183], v[120:123], v[96:99], v[180:183]
ds_read_b128 v[56:59], v2 offset:12288
v_mfma_f32_16x16x32_bf16 v[216:219], v[124:127], v[96:99], v[216:219]
ds_read_b128 v[60:63], v2 offset:14336
v_mfma_f32_16x16x32_bf16 v[144:147], v[116:119], v[96:99], v[144:147]
ds_read_b128 v[64:67], v2 offset:16384
v_mfma_f32_16x16x32_bf16 v[148:151], v[116:119], v[100:103], v[148:151]
v_mfma_f32_16x16x32_bf16 v[220:223], v[124:127], v[100:103], v[220:223]
v_mfma_f32_16x16x32_bf16 v[184:187], v[120:123], v[100:103], v[184:187]
v_mfma_f32_16x16x32_bf16 v[188:191], v[120:123], v[104:107], v[188:191]
v_mfma_f32_16x16x32_bf16 v[224:227], v[124:127], v[104:107], v[224:227]
v_mfma_f32_16x16x32_bf16 v[152:155], v[116:119], v[104:107], v[152:155]
v_mfma_f32_16x16x32_bf16 v[156:159], v[116:119], v[108:111], v[156:159]
v_mfma_f32_16x16x32_bf16 v[228:231], v[124:127], v[108:111], v[228:231]
v_mfma_f32_16x16x32_bf16 v[192:195], v[120:123], v[108:111], v[192:195]
v_mfma_f32_16x16x32_bf16 v[196:199], v[120:123], v[112:115], v[196:199]
v_mfma_f32_16x16x32_bf16 v[232:235], v[124:127], v[112:115], v[232:235]
v_mfma_f32_16x16x32_bf16 v[160:163], v[116:119], v[112:115], v[160:163]
s_sub_u32 s41, s41, 1
s_cmp_lg_u32 s41, 0
s_cbranch_scc1 Lcl_19
s_waitcnt lgkmcnt(0)
v_mfma_f32_16x16x32_bf16 v[164:167], v[72:75], v[32:35], v[164:167]
ds_read_b128 v[80:83], v3 offset:0
v_mfma_f32_16x16x32_bf16 v[200:203], v[76:79], v[32:35], v[200:203]
ds_read_b64_tr_b16 v[120:121], v6 offset:12288
v_mfma_f32_16x16x32_bf16 v[128:131], v[68:71], v[32:35], v[128:131]
ds_read_b64_tr_b16 v[122:123], v6 offset:12800
v_mfma_f32_16x16x32_bf16 v[132:135], v[68:71], v[36:39], v[132:135]
ds_read_b64_tr_b16 v[124:125], v6 offset:20480
v_mfma_f32_16x16x32_bf16 v[204:207], v[76:79], v[36:39], v[204:207]
ds_read_b64_tr_b16 v[126:127], v6 offset:20992
v_mfma_f32_16x16x32_bf16 v[168:171], v[72:75], v[36:39], v[168:171]
ds_read_b64_tr_b16 v[116:117], v6 offset:4096
v_mfma_f32_16x16x32_bf16 v[172:175], v[72:75], v[40:43], v[172:175]
ds_read_b64_tr_b16 v[118:119], v6 offset:4608
v_mfma_f32_16x16x32_bf16 v[208:211], v[76:79], v[40:43], v[208:211]
ds_read_b128 v[84:87], v3 offset:2048
v_mfma_f32_16x16x32_bf16 v[136:139], v[68:71], v[40:43], v[136:139]
ds_read_b128 v[88:91], v3 offset:4096
v_mfma_f32_16x16x32_bf16 v[140:143], v[68:71], v[44:47], v[140:143]
ds_read_b128 v[92:95], v3 offset:6144
v_mfma_f32_16x16x32_bf16 v[212:215], v[76:79], v[44:47], v[212:215]
ds_read_b128 v[96:99], v3 offset:8192
v_mfma_f32_16x16x32_bf16 v[176:179], v[72:75], v[44:47], v[176:179]
ds_read_b128 v[100:103], v3 offset:10240
v_mfma_f32_16x16x32_bf16 v[180:183], v[72:75], v[48:51], v[180:183]
ds_read_b128 v[104:107], v3 offset:12288
v_mfma_f32_16x16x32_bf16 v[216:219], v[76:79], v[48:51], v[216:219]
ds_read_b128 v[108:111], v3 offset:14336
v_mfma_f32_16x16x32_bf16 v[144:147], v[68:71], v[48:51], v[144:147]
ds_read_b128 v[112:115], v3 offset:16384
v_mfma_f32_16x16x32_bf16 v[148:151], v[68:71], v[52:55], v[148:151]
v_mfma_f32_16x16x32_bf16 v[220:223], v[76:79], v[52:55], v[220:223]
v_mfma_f32_16x16x32_bf16 v[184:187], v[72:75], v[52:55], v[184:187]
v_mfma_f32_16x16x32_bf16 v[188:191], v[72:75], v[56:59], v[188:191]
v_mfma_f32_16x16x32_bf16 v[224:227], v[76:79], v[56:59], v[224:227]
v_mfma_f32_16x16x32_bf16 v[152:155], v[68:71], v[56:59], v[152:155]
v_mfma_f32_16x16x32_bf16 v[156:159], v[68:71], v[60:63], v[156:159]
v_mfma_f32_16x16x32_bf16 v[228:231], v[76:79], v[60:63], v[228:231]
v_mfma_f32_16x16x32_bf16 v[192:195], v[72:75], v[60:63], v[192:195]
v_mfma_f32_16x16x32_bf16 v[196:199], v[72:75], v[64:67], v[196:199]
v_mfma_f32_16x16x32_bf16 v[232:235], v[76:79], v[64:67], v[232:235]
v_mfma_f32_16x16x32_bf16 v[160:163], v[68:71], v[64:67], v[160:163]
s_waitcnt lgkmcnt(0)
v_mfma_f32_16x16x32_bf16 v[164:167], v[120:123], v[80:83], v[164:167]
v_mfma_f32_16x16x32_bf16 v[200:203], v[124:127], v[80:83], v[200:203]
v_mfma_f32_16x16x32_bf16 v[128:131], v[116:119], v[80:83], v[128:131]
v_mfma_f32_16x16x32_bf16 v[132:135], v[116:119], v[84:87], v[132:135]
v_mfma_f32_16x16x32_bf16 v[204:207], v[124:127], v[84:87], v[204:207]
v_mfma_f32_16x16x32_bf16 v[168:171], v[120:123], v[84:87], v[168:171]
v_mfma_f32_16x16x32_bf16 v[172:175], v[120:123], v[88:91], v[172:175]
v_mfma_f32_16x16x32_bf16 v[208:211], v[124:127], v[88:91], v[208:211]
v_mfma_f32_16x16x32_bf16 v[136:139], v[116:119], v[88:91], v[136:139]
v_mfma_f32_16x16x32_bf16 v[140:143], v[116:119], v[92:95], v[140:143]
v_mfma_f32_16x16x32_bf16 v[212:215], v[124:127], v[92:95], v[212:215]
v_mfma_f32_16x16x32_bf16 v[176:179], v[120:123], v[92:95], v[176:179]
v_mfma_f32_16x16x32_bf16 v[180:183], v[120:123], v[96:99], v[180:183]
v_mfma_f32_16x16x32_bf16 v[216:219], v[124:127], v[96:99], v[216:219]
v_mfma_f32_16x16x32_bf16 v[144:147], v[116:119], v[96:99], v[144:147]
v_mfma_f32_16x16x32_bf16 v[148:151], v[116:119], v[100:103], v[148:151]
v_mfma_f32_16x16x32_bf16 v[220:223], v[124:127], v[100:103], v[220:223]
v_mfma_f32_16x16x32_bf16 v[184:187], v[120:123], v[100:103], v[184:187]
v_mfma_f32_16x16x32_bf16 v[188:191], v[120:123], v[104:107], v[188:191]
v_mfma_f32_16x16x32_bf16 v[224:227], v[124:127], v[104:107], v[224:227]
v_mfma_f32_16x16x32_bf16 v[152:155], v[116:119], v[104:107], v[152:155]
v_mfma_f32_16x16x32_bf16 v[156:159], v[116:119], v[108:111], v[156:159]
v_mfma_f32_16x16x32_bf16 v[228:231], v[124:127], v[108:111], v[228:231]
v_mfma_f32_16x16x32_bf16 v[192:195], v[120:123], v[108:111], v[192:195]
v_mfma_f32_16x16x32_bf16 v[196:199], v[120:123], v[112:115], v[196:199]
v_mfma_f32_16x16x32_bf16 v[232:235], v[124:127], v[112:115], v[232:235]
v_mfma_f32_16x16x32_bf16 v[160:163], v[116:119], v[112:115], v[160:163]
v_lshlrev_b32 v14, 3, v12
v_add_u32 v14, 147456, v14
v_mul_u32_u24 v15, 400, v12
v_lshl_add_u32 v15, v13, 3, v15
s_lshl_b32 s43, s36, 5
v_add_u32 v15, s43, v15
s_barrier
ds_read_b64 v[32:33], v14 offset:0
ds_read_b64 v[34:35], v14 offset:128
ds_read_b64 v[36:37], v14 offset:256
ds_read_b64 v[38:39], v14 offset:384
ds_read_b64 v[40:41], v14 offset:512
ds_read_b64 v[42:43], v14 offset:640
ds_read_b64 v[44:45], v14 offset:768
ds_read_b64 v[46:47], v14 offset:896
ds_read_b64 v[48:49], v14 offset:1024
v_mov_b32_dpp v52, v128 row_newbcast:0 row_mask:0xf bank_mask:0xf
v_mov_b32_dpp v53, v129 row_newbcast:0 row_mask:0xf bank_mask:0xf
v_mov_b32_dpp v54, v130 row_newbcast:0 row_mask:0xf bank_mask:0xf
v_mov_b32_dpp v55, v131 row_newbcast:0 row_mask:0xf bank_mask:0xf
v_mov_b32_dpp v56, v164 row_newbcast:0 row_mask:0xf bank_mask:0xf
v_mov_b32_dpp v57, v165 row_newbcast:0 row_mask:0xf bank_mask:0xf
v_mov_b32_dpp v58, v166 row_newbcast:0 row_mask:0xf bank_mask:0xf
v_mov_b32_dpp v59, v167 row_newbcast:0 row_mask:0xf bank_mask:0xf
v_mov_b32_dpp v60, v200 row_newbcast:0 row_mask:0xf bank_mask:0xf
v_mov_b32_dpp v61, v201 row_newbcast:0 row_mask:0xf bank_mask:0xf
v_mov_b32_dpp v62, v202 row_newbcast:0 row_mask:0xf bank_mask:0xf
v_mov_b32_dpp v63, v203 row_newbcast:0 row_mask:0xf bank_mask:0xf
s_waitcnt lgkmcnt(0)
v_pk_fma_f32 v[164:165], v[32:33], v[56:57], v[164:165] op_sel_hi:[0,1,1] neg_lo:[1,0,0] neg_hi:[1,0,0]
v_pk_fma_f32 v[166:167], v[32:33], v[58:59], v[166:167] op_sel_hi:[0,1,1] neg_lo:[1,0,0] neg_hi:[1,0,0]
v_pk_fma_f32 v[200:201], v[32:33], v[60:61], v[200:201] op_sel_hi:[0,1,1] neg_lo:[1,0,0] neg_hi:[1,0,0]
v_pk_fma_f32 v[202:203], v[32:33], v[62:63], v[202:203] op_sel_hi:[0,1,1] neg_lo:[1,0,0] neg_hi:[1,0,0]
v_pk_mul_f32 v[164:165], v[32:33], v[164:165] op_sel:[1,0] op_sel_hi:[1,1]
v_pk_mul_f32 v[166:167], v[32:33], v[166:167] op_sel:[1,0] op_sel_hi:[1,1]
v_pk_fma_f32 v[132:133], v[34:35], v[52:53], v[132:133] op_sel_hi:[0,1,1] neg_lo:[1,0,0] neg_hi:[1,0,0]
v_pk_fma_f32 v[134:135], v[34:35], v[54:55], v[134:135] op_sel_hi:[0,1,1] neg_lo:[1,0,0] neg_hi:[1,0,0]
v_pk_mul_f32 v[200:201], v[32:33], v[200:201] op_sel:[1,0] op_sel_hi:[1,1]
v_pk_mul_f32 v[202:203], v[32:33], v[202:203] op_sel:[1,0] op_sel_hi:[1,1]
v_cvt_pk_bf16_f32 v164, v164, v165
v_cvt_pk_bf16_f32 v165, v166, v167
ds_write_b64 v15, v[164:165] offset:128
v_pk_fma_f32 v[168:169], v[34:35], v[56:57], v[168:169] op_sel_hi:[0,1,1] neg_lo:[1,0,0] neg_hi:[1,0,0]
v_pk_fma_f32 v[170:171], v[34:35], v[58:59], v[170:171] op_sel_hi:[0,1,1] neg_lo:[1,0,0] neg_hi:[1,0,0]
v_pk_mul_f32 v[132:133], v[34:35], v[132:133] op_sel:[1,0] op_sel_hi:[1,1]
v_pk_mul_f32 v[134:135], v[34:35], v[134:135] op_sel:[1,0] op_sel_hi:[1,1]
v_cvt_pk_bf16_f32 v200, v200, v201
v_cvt_pk_bf16_f32 v201, v202, v203
ds_write_b64 v15, v[200:201] offset:256
v_pk_fma_f32 v[204:205], v[34:35], v[60:61], v[204:205] op_sel_hi:[0,1,1] neg_lo:[1,0,0] neg_hi:[1,0,0]
v_pk_fma_f32 v[206:207], v[34:35], v[62:63], v[206:207] op_sel_hi:[0,1,1] neg_lo:[1,0,0] neg_hi:[1,0,0]
v_pk_mul_f32 v[168:169], v[34:35], v[168:169] op_sel:[1,0] op_sel_hi:[1,1]
v_pk_mul_f32 v[170:171], v[34:35], v[170:171] op_sel:[1,0] op_sel_hi:[1,1]
v_cvt_pk_bf16_f32 v132, v132, v133
v_cvt_pk_bf16_f32 v133, v134, v135
ds_write_b64 v15, v[132:133] offset:6400
v_pk_fma_f32 v[136:137], v[36:37], v[52:53], v[136:137] op_sel_hi:[0,1,1] neg_lo:[1,0,0] neg_hi:[1,0,0]
v_pk_fma_f32 v[138:139], v[36:37], v[54:55], v[138:139] op_sel_hi:[0,1,1] neg_lo:[1,0,0] neg_hi:[1,0,0]
v_pk_mul_f32 v[204:205], v[34:35], v[204:205] op_sel:[1,0] op_sel_hi:[1,1]
v_pk_mul_f32 v[206:207], v[34:35], v[206:207] op_sel:[1,0] op_sel_hi:[1,1]
v_cvt_pk_bf16_f32 v168, v168, v169
v_cvt_pk_bf16_f32 v169, v170, v171
ds_write_b64 v15, v[168:169] offset:6528
v_pk_fma_f32 v[172:173], v[36:37], v[56:57], v[172:173] op_sel_hi:[0,1,1] neg_lo:[1,0,0] neg_hi:[1,0,0]
v_pk_fma_f32 v[174:175], v[36:37], v[58:59], v[174:175] op_sel_hi:[0,1,1] neg_lo:[1,0,0] neg_hi:[1,0,0]
v_pk_mul_f32 v[136:137], v[36:37], v[136:137] op_sel:[1,0] op_sel_hi:[1,1]
v_pk_mul_f32 v[138:139], v[36:37], v[138:139] op_sel:[1,0] op_sel_hi:[1,1]
v_cvt_pk_bf16_f32 v204, v204, v205
v_cvt_pk_bf16_f32 v205, v206, v207
ds_write_b64 v15, v[204:205] offset:6656
v_pk_fma_f32 v[208:209], v[36:37], v[60:61], v[208:209] op_sel_hi:[0,1,1] neg_lo:[1,0,0] neg_hi:[1,0,0]
v_pk_fma_f32 v[210:211], v[36:37], v[62:63], v[210:211] op_sel_hi:[0,1,1] neg_lo:[1,0,0] neg_hi:[1,0,0]
v_pk_mul_f32 v[172:173], v[36:37], v[172:173] op_sel:[1,0] op_sel_hi:[1,1]
v_pk_mul_f32 v[174:175], v[36:37], v[174:175] op_sel:[1,0] op_sel_hi:[1,1]
v_cvt_pk_bf16_f32 v136, v136, v137
v_cvt_pk_bf16_f32 v137, v138, v139
ds_write_b64 v15, v[136:137] offset:12800
v_pk_fma_f32 v[140:141], v[38:39], v[52:53], v[140:141] op_sel_hi:[0,1,1] neg_lo:[1,0,0] neg_hi:[1,0,0]
v_pk_fma_f32 v[142:143], v[38:39], v[54:55], v[142:143] op_sel_hi:[0,1,1] neg_lo:[1,0,0] neg_hi:[1,0,0]
v_pk_mul_f32 v[208:209], v[36:37], v[208:209] op_sel:[1,0] op_sel_hi:[1,1]
v_pk_mul_f32 v[210:211], v[36:37], v[210:211] op_sel:[1,0] op_sel_hi:[1,1]
v_cvt_pk_bf16_f32 v172, v172, v173
v_cvt_pk_bf16_f32 v173, v174, v175
ds_write_b64 v15, v[172:173] offset:12928
v_pk_fma_f32 v[176:177], v[38:39], v[56:57], v[176:177] op_sel_hi:[0,1,1] neg_lo:[1,0,0] neg_hi:[1,0,0]
v_pk_fma_f32 v[178:179], v[38:39], v[58:59], v[178:179] op_sel_hi:[0,1,1] neg_lo:[1,0,0] neg_hi:[1,0,0]
v_pk_mul_f32 v[140:141], v[38:39], v[140:141] op_sel:[1,0] op_sel_hi:[1,1]
v_pk_mul_f32 v[142:143], v[38:39], v[142:143] op_sel:[1,0] op_sel_hi:[1,1]
v_cvt_pk_bf16_f32 v208, v208, v209
v_cvt_pk_bf16_f32 v209, v210, v211
ds_write_b64 v15, v[208:209] offset:13056
v_pk_fma_f32 v[212:213], v[38:39], v[60:61], v[212:213] op_sel_hi:[0,1,1] neg_lo:[1,0,0] neg_hi:[1,0,0]
v_pk_fma_f32 v[214:215], v[38:39], v[62:63], v[214:215] op_sel_hi:[0,1,1] neg_lo:[1,0,0] neg_hi:[1,0,0]
v_pk_mul_f32 v[176:177], v[38:39], v[176:177] op_sel:[1,0] op_sel_hi:[1,1]
v_pk_mul_f32 v[178:179], v[38:39], v[178:179] op_sel:[1,0] op_sel_hi:[1,1]
v_cvt_pk_bf16_f32 v140, v140, v141
v_cvt_pk_bf16_f32 v141, v142, v143
ds_write_b64 v15, v[140:141] offset:19200
v_pk_fma_f32 v[144:145], v[40:41], v[52:53], v[144:145] op_sel_hi:[0,1,1] neg_lo:[1,0,0] neg_hi:[1,0,0]
v_pk_fma_f32 v[146:147], v[40:41], v[54:55], v[146:147] op_sel_hi:[0,1,1] neg_lo:[1,0,0] neg_hi:[1,0,0]
v_pk_mul_f32 v[212:213], v[38:39], v[212:213] op_sel:[1,0] op_sel_hi:[1,1]
v_pk_mul_f32 v[214:215], v[38:39], v[214:215] op_sel:[1,0] op_sel_hi:[1,1]
v_cvt_pk_bf16_f32 v176, v176, v177
v_cvt_pk_bf16_f32 v177, v178, v179
ds_write_b64 v15, v[176:177] offset:19328
v_pk_fma_f32 v[180:181], v[40:41], v[56:57], v[180:181] op_sel_hi:[0,1,1] neg_lo:[1,0,0] neg_hi:[1,0,0]
v_pk_fma_f32 v[182:183], v[40:41], v[58:59], v[182:183] op_sel_hi:[0,1,1] neg_lo:[1,0,0] neg_hi:[1,0,0]
v_pk_mul_f32 v[144:145], v[40:41], v[144:145] op_sel:[1,0] op_sel_hi:[1,1]
v_pk_mul_f32 v[146:147], v[40:41], v[146:147] op_sel:[1,0] op_sel_hi:[1,1]
v_cvt_pk_bf16_f32 v212, v212, v213
v_cvt_pk_bf16_f32 v213, v214, v215
ds_write_b64 v15, v[212:213] offset:19456
v_pk_fma_f32 v[216:217], v[40:41], v[60:61], v[216:217] op_sel_hi:[0,1,1] neg_lo:[1,0,0] neg_hi:[1,0,0]
v_pk_fma_f32 v[218:219], v[40:41], v[62:63], v[218:219] op_sel_hi:[0,1,1] neg_lo:[1,0,0] neg_hi:[1,0,0]
v_pk_mul_f32 v[180:181], v[40:41], v[180:181] op_sel:[1,0] op_sel_hi:[1,1]
v_pk_mul_f32 v[182:183], v[40:41], v[182:183] op_sel:[1,0] op_sel_hi:[1,1]
v_cvt_pk_bf16_f32 v144, v144, v145
v_cvt_pk_bf16_f32 v145, v146, v147
ds_write_b64 v15, v[144:145] offset:25600
v_pk_fma_f32 v[148:149], v[42:43], v[52:53], v[148:149] op_sel_hi:[0,1,1] neg_lo:[1,0,0] neg_hi:[1,0,0]
v_pk_fma_f32 v[150:151], v[42:43], v[54:55], v[150:151] op_sel_hi:[0,1,1] neg_lo:[1,0,0] neg_hi:[1,0,0]
v_pk_mul_f32 v[216:217], v[40:41], v[216:217] op_sel:[1,0] op_sel_hi:[1,1]
v_pk_mul_f32 v[218:219], v[40:41], v[218:219] op_sel:[1,0] op_sel_hi:[1,1]
v_cvt_pk_bf16_f32 v180, v180, v181
v_cvt_pk_bf16_f32 v181, v182, v183
ds_write_b64 v15, v[180:181] offset:25728
v_pk_fma_f32 v[184:185], v[42:43], v[56:57], v[184:185] op_sel_hi:[0,1,1] neg_lo:[1,0,0] neg_hi:[1,0,0]
v_pk_fma_f32 v[186:187], v[42:43], v[58:59], v[186:187] op_sel_hi:[0,1,1] neg_lo:[1,0,0] neg_hi:[1,0,0]
v_pk_mul_f32 v[148:149], v[42:43], v[148:149] op_sel:[1,0] op_sel_hi:[1,1]
v_pk_mul_f32 v[150:151], v[42:43], v[150:151] op_sel:[1,0] op_sel_hi:[1,1]
v_cvt_pk_bf16_f32 v216, v216, v217
v_cvt_pk_bf16_f32 v217, v218, v219
ds_write_b64 v15, v[216:217] offset:25856
v_pk_fma_f32 v[220:221], v[42:43], v[60:61], v[220:221] op_sel_hi:[0,1,1] neg_lo:[1,0,0] neg_hi:[1,0,0]
v_pk_fma_f32 v[222:223], v[42:43], v[62:63], v[222:223] op_sel_hi:[0,1,1] neg_lo:[1,0,0] neg_hi:[1,0,0]
v_pk_mul_f32 v[184:185], v[42:43], v[184:185] op_sel:[1,0] op_sel_hi:[1,1]
v_pk_mul_f32 v[186:187], v[42:43], v[186:187] op_sel:[1,0] op_sel_hi:[1,1]
v_cvt_pk_bf16_f32 v148, v148, v149
v_cvt_pk_bf16_f32 v149, v150, v151
ds_write_b64 v15, v[148:149] offset:32000
v_pk_fma_f32 v[152:153], v[44:45], v[52:53], v[152:153] op_sel_hi:[0,1,1] neg_lo:[1,0,0] neg_hi:[1,0,0]
v_pk_fma_f32 v[154:155], v[44:45], v[54:55], v[154:155] op_sel_hi:[0,1,1] neg_lo:[1,0,0] neg_hi:[1,0,0]
v_pk_mul_f32 v[220:221], v[42:43], v[220:221] op_sel:[1,0] op_sel_hi:[1,1]
v_pk_mul_f32 v[222:223], v[42:43], v[222:223] op_sel:[1,0] op_sel_hi:[1,1]
v_cvt_pk_bf16_f32 v184, v184, v185
v_cvt_pk_bf16_f32 v185, v186, v187
ds_write_b64 v15, v[184:185] offset:32128
v_pk_fma_f32 v[188:189], v[44:45], v[56:57], v[188:189] op_sel_hi:[0,1,1] neg_lo:[1,0,0] neg_hi:[1,0,0]
v_pk_fma_f32 v[190:191], v[44:45], v[58:59], v[190:191] op_sel_hi:[0,1,1] neg_lo:[1,0,0] neg_hi:[1,0,0]
v_pk_mul_f32 v[152:153], v[44:45], v[152:153] op_sel:[1,0] op_sel_hi:[1,1]
v_pk_mul_f32 v[154:155], v[44:45], v[154:155] op_sel:[1,0] op_sel_hi:[1,1]
v_cvt_pk_bf16_f32 v220, v220, v221
v_cvt_pk_bf16_f32 v221, v222, v223
ds_write_b64 v15, v[220:221] offset:32256
v_pk_fma_f32 v[224:225], v[44:45], v[60:61], v[224:225] op_sel_hi:[0,1,1] neg_lo:[1,0,0] neg_hi:[1,0,0]
v_pk_fma_f32 v[226:227], v[44:45], v[62:63], v[226:227] op_sel_hi:[0,1,1] neg_lo:[1,0,0] neg_hi:[1,0,0]
v_pk_mul_f32 v[188:189], v[44:45], v[188:189] op_sel:[1,0] op_sel_hi:[1,1]
v_pk_mul_f32 v[190:191], v[44:45], v[190:191] op_sel:[1,0] op_sel_hi:[1,1]
v_cvt_pk_bf16_f32 v152, v152, v153
v_cvt_pk_bf16_f32 v153, v154, v155
ds_write_b64 v15, v[152:153] offset:38400
v_pk_fma_f32 v[156:157], v[46:47], v[52:53], v[156:157] op_sel_hi:[0,1,1] neg_lo:[1,0,0] neg_hi:[1,0,0]
v_pk_fma_f32 v[158:159], v[46:47], v[54:55], v[158:159] op_sel_hi:[0,1,1] neg_lo:[1,0,0] neg_hi:[1,0,0]
v_pk_mul_f32 v[224:225], v[44:45], v[224:225] op_sel:[1,0] op_sel_hi:[1,1]
v_pk_mul_f32 v[226:227], v[44:45], v[226:227] op_sel:[1,0] op_sel_hi:[1,1]
v_cvt_pk_bf16_f32 v188, v188, v189
v_cvt_pk_bf16_f32 v189, v190, v191
ds_write_b64 v15, v[188:189] offset:38528
v_pk_fma_f32 v[192:193], v[46:47], v[56:57], v[192:193] op_sel_hi:[0,1,1] neg_lo:[1,0,0] neg_hi:[1,0,0]
v_pk_fma_f32 v[194:195], v[46:47], v[58:59], v[194:195] op_sel_hi:[0,1,1] neg_lo:[1,0,0] neg_hi:[1,0,0]
v_pk_mul_f32 v[156:157], v[46:47], v[156:157] op_sel:[1,0] op_sel_hi:[1,1]
v_pk_mul_f32 v[158:159], v[46:47], v[158:159] op_sel:[1,0] op_sel_hi:[1,1]
v_cvt_pk_bf16_f32 v224, v224, v225
v_cvt_pk_bf16_f32 v225, v226, v227
ds_write_b64 v15, v[224:225] offset:38656
v_pk_fma_f32 v[228:229], v[46:47], v[60:61], v[228:229] op_sel_hi:[0,1,1] neg_lo:[1,0,0] neg_hi:[1,0,0]
v_pk_fma_f32 v[230:231], v[46:47], v[62:63], v[230:231] op_sel_hi:[0,1,1] neg_lo:[1,0,0] neg_hi:[1,0,0]
v_pk_mul_f32 v[192:193], v[46:47], v[192:193] op_sel:[1,0] op_sel_hi:[1,1]
v_pk_mul_f32 v[194:195], v[46:47], v[194:195] op_sel:[1,0] op_sel_hi:[1,1]
v_cvt_pk_bf16_f32 v156, v156, v157
v_cvt_pk_bf16_f32 v157, v158, v159
ds_write_b64 v15, v[156:157] offset:44800
v_pk_fma_f32 v[160:161], v[48:49], v[52:53], v[160:161] op_sel_hi:[0,1,1] neg_lo:[1,0,0] neg_hi:[1,0,0]
v_pk_fma_f32 v[162:163], v[48:49], v[54:55], v[162:163] op_sel_hi:[0,1,1] neg_lo:[1,0,0] neg_hi:[1,0,0]
v_pk_mul_f32 v[228:229], v[46:47], v[228:229] op_sel:[1,0] op_sel_hi:[1,1]
v_pk_mul_f32 v[230:231], v[46:47], v[230:231] op_sel:[1,0] op_sel_hi:[1,1]
v_cvt_pk_bf16_f32 v192, v192, v193
v_cvt_pk_bf16_f32 v193, v194, v195
ds_write_b64 v15, v[192:193] offset:44928
v_pk_fma_f32 v[196:197], v[48:49], v[56:57], v[196:197] op_sel_hi:[0,1,1] neg_lo:[1,0,0] neg_hi:[1,0,0]
v_pk_fma_f32 v[198:199], v[48:49], v[58:59], v[198:199] op_sel_hi:[0,1,1] neg_lo:[1,0,0] neg_hi:[1,0,0]
v_pk_mul_f32 v[160:161], v[48:49], v[160:161] op_sel:[1,0] op_sel_hi:[1,1]
v_pk_mul_f32 v[162:163], v[48:49], v[162:163] op_sel:[1,0] op_sel_hi:[1,1]
v_cvt_pk_bf16_f32 v228, v228, v229
v_cvt_pk_bf16_f32 v229, v230, v231
ds_write_b64 v15, v[228:229] offset:45056
v_pk_fma_f32 v[232:233], v[48:49], v[60:61], v[232:233] op_sel_hi:[0,1,1] neg_lo:[1,0,0] neg_hi:[1,0,0]
v_pk_fma_f32 v[234:235], v[48:49], v[62:63], v[234:235] op_sel_hi:[0,1,1] neg_lo:[1,0,0] neg_hi:[1,0,0]
v_pk_mul_f32 v[196:197], v[48:49], v[196:197] op_sel:[1,0] op_sel_hi:[1,1]
v_pk_mul_f32 v[198:199], v[48:49], v[198:199] op_sel:[1,0] op_sel_hi:[1,1]
v_cvt_pk_bf16_f32 v160, v160, v161
v_cvt_pk_bf16_f32 v161, v162, v163
ds_write_b64 v15, v[160:161] offset:51200
v_pk_mul_f32 v[232:233], v[48:49], v[232:233] op_sel:[1,0] op_sel_hi:[1,1]
v_pk_mul_f32 v[234:235], v[48:49], v[234:235] op_sel:[1,0] op_sel_hi:[1,1]
v_cvt_pk_bf16_f32 v196, v196, v197
v_cvt_pk_bf16_f32 v197, v198, v199
ds_write_b64 v15, v[196:197] offset:51328
v_cvt_pk_bf16_f32 v232, v232, v233
v_cvt_pk_bf16_f32 v233, v234, v235
ds_write_b64 v15, v[232:233] offset:51456
s_waitcnt lgkmcnt(0)
s_branch Latt_5
Lpf_4:
s_lshl_b32 s43, s35, 7
s_waitcnt lgkmcnt(0)
s_mov_b32 s8, s64
s_mov_b32 s9, s65
s_mov_b32 s10, 4194304
s_mov_b32 s11, 0x20000
s_add_u32 s12, s66, s43
s_addc_u32 s13, s67, 0
s_mov_b32 s14, 6289536
s_mov_b32 s15, 0x20000
s_add_u32 s84, s82, 28311552
s_addc_u32 s85, s83, 0
s_mov_b32 s86, 49152
s_mov_b32 s87, 0x20000
s_mov_b32 s56, s80
s_mov_b32 s57, s81
s_mov_b32 s58, 256
s_mov_b32 s59, 0x20000
v_mov_b32 v5, 0
v_lshlrev_b32 v14, 7, v1
s_or_b32 s43, s34, s35
s_cmp_lg_u32 s43, 0
s_cbranch_scc1 Lz_20
s_movk_i32 s43, 0x2000
buffer_store_dword v5, v14, s[84:87], 0 offen sc1
s_bfm_b64 exec, 44, 0
buffer_store_dword v5, v14, s[84:87], s43 offen sc1
s_mov_b64 exec, 1
v_mov_b32 v6, 1
s_waitcnt vmcnt(0)
buffer_store_dword v6, v5, s[56:59], 0 offen sc1
s_mov_b64 exec, -1
Lz_20:
s_branch Lov_3
.p2align 12
Lst_3_0:
s_branch Lwr_143
s_nop 0
s_nop 0
Lov_3:
s_lshl_b32 s43, s51, 11
buffer_load_dwordx4 v[96:99], v10, s[8:11], s43 offen offset:0
buffer_load_dwordx4 v[100:103], v10, s[8:11], s43 offen offset:1024
buffer_load_dwordx4 v[104:107], v10, s[8:11], s43 offen offset:2048
buffer_load_dwordx4 v[108:111], v10, s[8:11], s43 offen offset:3072
v_min_u32 v14, 23, v1
v_lshrrev_b32 v15, 3, v14
v_mul_u32_u24 v15, 43008, v15
v_and_b32 v14, 7, v14
v_lshl_add_u32 v15, v14, 4, v15
v_mov_b32 v32, 0x3f803f80
v_mov_b32 v33, 0x3f803f80
v_mov_b32 v34, 0x3f803f80
v_mov_b32 v35, 0x3f803f80
ds_write_b128 v15, v[32:35]
s_add_u32 s20, s82, 26214400
s_addc_u32 s21, s83, 0
s_mov_b32 s22, 16384
s_mov_b32 s23, 0x20000
s_add_u32 s43, s2, 128
s_lshl_b32 s43, s43, 7
v_lshlrev_b32 v14, 2, v1
s_mov_b64 exec, 15
buffer_store_dword v5, v14, s[84:87], s43 offen sc1
s_mov_b64 exec, -1
s_lshl_b32 s52, s34, 7
s_add_u32 s52, s52, 28319744
s_sub_u32 s53, s52, 128
s_cmp_eq_u32 s34, 0
s_cselect_b32 s53, s52, s53
s_waitcnt lgkmcnt(0)
s_barrier
s_waitcnt vmcnt(1)
s_mov_b32 s43, 0x3f803f80
v_mov_b32 v116, 0
v_mov_b32 v117, 0
v_mov_b32 v118, 0
v_mov_b32 v119, 0
v_mov_b32 v120, 0
v_mov_b32 v121, 0
v_mov_b32 v122, 0
v_mov_b32 v123, 0
v_dot2_f32_bf16 v116, v96, s43, v116
v_dot2_f32_bf16 v120, v96, v96, v120
v_dot2_f32_bf16 v118, v104, s43, v118
v_dot2_f32_bf16 v122, v104, v104, v122
v_dot2_f32_bf16 v117, v97, s43, v117
v_dot2_f32_bf16 v121, v97, v97, v121
v_dot2_f32_bf16 v119, v105, s43, v119
v_dot2_f32_bf16 v123, v105, v105, v123
v_dot2_f32_bf16 v116, v98, s43, v116
v_dot2_f32_bf16 v120, v98, v98, v120
v_dot2_f32_bf16 v118, v106, s43, v118
v_dot2_f32_bf16 v122, v106, v106, v122
v_dot2_f32_bf16 v117, v99, s43, v117
v_dot2_f32_bf16 v121, v99, v99, v121
v_dot2_f32_bf16 v119, v107, s43, v119
v_dot2_f32_bf16 v123, v107, v107, v123
v_dot2_f32_bf16 v116, v100, s43, v116
v_dot2_f32_bf16 v120, v100, v100, v120
v_dot2_f32_bf16 v118, v108, s43, v118
v_dot2_f32_bf16 v122, v108, v108, v122
v_dot2_f32_bf16 v117, v101, s43, v117
v_dot2_f32_bf16 v121, v101, v101, v121
v_dot2_f32_bf16 v119, v109, s43, v119
v_dot2_f32_bf16 v123, v109, v109, v123
v_dot2_f32_bf16 v116, v102, s43, v116
v_dot2_f32_bf16 v120, v102, v102, v120
v_dot2_f32_bf16 v118, v110, s43, v118
v_dot2_f32_bf16 v122, v110, v110, v122
v_dot2_f32_bf16 v117, v103, s43, v117
v_dot2_f32_bf16 v121, v103, v103, v121
v_dot2_f32_bf16 v119, v111, s43, v119
v_dot2_f32_bf16 v123, v111, v111, v123
s_nop 2
v_add_f32 v116, v116, v117
v_add_f32 v118, v118, v119
v_add_f32 v120, v120, v121
v_add_f32 v122, v122, v123
s_nop 1
v_permlane32_swap_b32 v116, v118
v_permlane32_swap_b32 v120, v122
v_add_f32 v116, v116, v118
v_add_f32 v120, v120, v122
s_nop 1
v_permlane16_swap_b32 v116, v120
v_add_f32 v116, v116, v120
s_nop 1
v_add_f32_dpp v116, v116, v116 row_ror:8 row_mask:0xf bank_mask:0xf
s_nop 1
v_add_f32_dpp v116, v116, v116 row_ror:4 row_mask:0xf bank_mask:0xf
s_nop 1
v_add_f32_dpp v116, v116, v116 row_ror:2 row_mask:0xf bank_mask:0xf
s_nop 1
v_add_f32_dpp v116, v116, v116 row_ror:1 row_mask:0xf bank_mask:0xf
v_mov_b32 v117, v116
s_nop 1
v_permlane16_swap_b32 v116, v117
v_mul_f32 v112, 0x3a800000, v116
v_mul_f32 v113, 0x3a800000, v117
v_fma_f32 v113, -v112, v112, v113
v_max_f32 v113, 0, v113
v_add_f32 v113, 0x3727c5ac, v113
v_rsq_f32 v113, v113
v_lshrrev_b32 v11, 5, v1
s_lshl_b32 s43, s47, 4
s_add_u32 s43, s43, 148608
v_lshl_add_u32 v11, v11, 3, s43
ds_write_b64 v11, v[112:113]
s_waitcnt lgkmcnt(0)
s_mov_b32 s28, s66
s_mov_b32 s29, s67
s_mov_b32 s30, 6291456
s_mov_b32 s31, 0x20000
s_mul_i32 s43, s2, 9216
s_add_u32 s43, s43, 1572864
v_lshlrev_b32 v30, 7, v1
buffer_load_dword v31, v30, s[28:31], s43 offen
s_add_u32 s43, s43, 8192
s_bfm_b64 exec, 8, 0
buffer_load_dword v31, v30, s[28:31], s43 offen
s_mov_b64 exec, -1
s_branch Lst_0_0
Lwr_140:
s_barrier
v_lshlrev_b32 v5, 4, v1
v_and_b32 v5, 63, v5
v_add_u32 v6, 148608, v5
ds_read_b128 v[112:115], v6
s_lshl_b32 s43, s63, 3
v_add_u32 v5, s43, v5
s_waitcnt lgkmcnt(0)
s_mov_b64 exec, 15
buffer_store_dwordx4 v[112:115], v5, s[20:23], 0 offen sc1
s_mov_b64 exec, -1
v_mov_b32 v4, 0
buffer_load_dword v6, v4, s[56:59], 0 offen sc1
s_mov_b32 s62, 0
s_branch Lst_1_0
Lwr_141:
s_barrier
s_mov_b32 s28, s66
s_mov_b32 s29, s67
s_mov_b32 s30, 6291456
s_mov_b32 s31, 0x20000
s_mul_i32 s43, s2, 9216
s_add_u32 s43, s43, 3932160
v_lshlrev_b32 v30, 7, v1
buffer_load_dword v31, v30, s[28:31], s43 offen
s_add_u32 s43, s43, 8192
s_bfm_b64 exec, 8, 0
buffer_load_dword v31, v30, s[28:31], s43 offen
s_mov_b64 exec, -1
s_lshl_b32 s43, s35, 7
s_add_u32 s28, s68, s43
s_addc_u32 s29, s69, 0
s_mov_b32 s30, 2095232
s_mov_b32 s31, 0x20000
v_and_b32 v29, 7, v1
v_lshrrev_b32 v30, 3, v1
v_lshl_add_u32 v29, v30, 6, v29
s_lshl_b32 s43, s48, 3
v_add_u32 v29, s43, v29
v_lshlrev_b32 v29, 11, v29
s_mov_b32 s43, 1048576
s_mov_b32 s28, s68
s_mov_b32 s29, s69
s_mov_b32 s30, 2097152
s_mov_b32 s31, 0x20000
s_lshl_b32 s43, s2, 13
v_lshlrev_b32 v29, 7, v1
buffer_load_dword v30, v29, s[28:31], s43 offen
s_branch Lst_2_0
Lwr_142:
s_barrier
s_branch Lst_3_0
Lwr_143:
s_barrier
s_branch Lst_4_0
Lwr_144:
s_barrier
s_branch Lst_5_0
Lwr_145:
s_barrier
s_cmp_eq_u32 s62, 3
s_cbranch_scc1 Lste_23
s_cmp_eq_u32 s62, 2
s_cbranch_scc1 Lst2_22
s_waitcnt lgkmcnt(0)
s_cmp_eq_u32 s62, 1
s_cbranch_scc1 Lst1_21
s_waitcnt vmcnt(3)
v_readfirstlane_b32 s54, v6
s_cmp_eq_u32 s54, 0
s_cbranch_scc0 Lrep_24
buffer_load_dword v6, v4, s[56:59], 0 offen sc1
s_branch Lste_23
Lrep_24:
s_add_u32 s7, s34, 64
s_lshl_b32 s7, s7, 7
v_mov_b32 v5, s7
v_mov_b32 v6, 1
s_mov_b64 exec, 1
buffer_atomic_add v6, v5, s[84:87], 0 offen sc1
s_mov_b64 exec, -1
s_mov_b32 s62, 1
s_load_dword s54, s[82:83], s52 glc
s_load_dword s55, s[82:83], s53 glc
s_branch Lste_23
Lst1_21:
s_and_b32 s54, s54, s55
s_cmp_eq_u32 s54, 16
s_cbranch_scc1 Lg_25
s_load_dword s54, s[82:83], s52 glc
s_load_dword s55, s[82:83], s53 glc
s_branch Lste_23
Lg_25:
v_add_u32 v5, 0, v1
v_min_u32 v5, 143, v5
v_lshlrev_b32 v20, 3, v5
v_add_u32 v5, s50, v5
v_max_i32 v5, 0, v5
v_lshlrev_b32 v5, 3, v5
buffer_load_dwordx2 v[32:33], v5, s[20:23], 0 offen sc1
v_add_u32 v5, 64, v1
v_min_u32 v5, 143, v5
v_lshlrev_b32 v21, 3, v5
v_add_u32 v5, s50, v5
v_max_i32 v5, 0, v5
v_lshlrev_b32 v5, 3, v5
buffer_load_dwordx2 v[34:35], v5, s[20:23], 0 offen sc1
v_add_u32 v5, 128, v1
v_min_u32 v5, 143, v5
v_lshlrev_b32 v22, 3, v5
v_add_u32 v5, s50, v5
v_max_i32 v5, 0, v5
v_lshlrev_b32 v5, 3, v5
buffer_load_dwordx2 v[36:37], v5, s[20:23], 0 offen sc1
s_mov_b32 s62, 2
s_branch Lste_23
Lst2_22:
s_waitcnt vmcnt(0)
v_add_u32 v20, 147456, v20
ds_write_b64 v20, v[32:33]
v_add_u32 v21, 147456, v21
ds_write_b64 v21, v[34:35]
v_add_u32 v22, 147456, v22
ds_write_b64 v22, v[36:37]
s_waitcnt lgkmcnt(0)
s_mov_b32 s62, 3
Lste_23:
s_branch Lst_6_0
Lwr_146:
s_barrier
s_cmp_eq_u32 s62, 3
s_cbranch_scc1 Lste_28
s_cmp_eq_u32 s62, 2
s_cbranch_scc1 Lst2_27
s_waitcnt lgkmcnt(0)
s_cmp_eq_u32 s62, 1
s_cbranch_scc1 Lst1_26
s_waitcnt vmcnt(0)
v_readfirstlane_b32 s54, v6
s_cmp_eq_u32 s54, 0
s_cbranch_scc0 Lrep_29
buffer_load_dword v6, v4, s[56:59], 0 offen sc1
s_branch Lste_28
Lrep_29:
s_add_u32 s7, s34, 64
s_lshl_b32 s7, s7, 7
v_mov_b32 v5, s7
v_mov_b32 v6, 1
s_mov_b64 exec, 1
buffer_atomic_add v6, v5, s[84:87], 0 offen sc1
s_mov_b64 exec, -1
s_mov_b32 s62, 1
s_load_dword s54, s[82:83], s52 glc
s_load_dword s55, s[82:83], s53 glc
s_branch Lste_28
Lst1_26:
s_and_b32 s54, s54, s55
s_cmp_eq_u32 s54, 16
s_cbranch_scc1 Lg_30
s_load_dword s54, s[82:83], s52 glc
s_load_dword s55, s[82:83], s53 glc
s_branch Lste_28
Lg_30:
v_add_u32 v5, 0, v1
v_min_u32 v5, 143, v5
v_lshlrev_b32 v20, 3, v5
v_add_u32 v5, s50, v5
v_max_i32 v5, 0, v5
v_lshlrev_b32 v5, 3, v5
buffer_load_dwordx2 v[32:33], v5, s[20:23], 0 offen sc1
v_add_u32 v5, 64, v1
v_min_u32 v5, 143, v5
v_lshlrev_b32 v21, 3, v5
v_add_u32 v5, s50, v5
v_max_i32 v5, 0, v5
v_lshlrev_b32 v5, 3, v5
buffer_load_dwordx2 v[34:35], v5, s[20:23], 0 offen sc1
v_add_u32 v5, 128, v1
v_min_u32 v5, 143, v5
v_lshlrev_b32 v22, 3, v5
v_add_u32 v5, s50, v5
v_max_i32 v5, 0, v5
v_lshlrev_b32 v5, 3, v5
buffer_load_dwordx2 v[36:37], v5, s[20:23], 0 offen sc1
s_mov_b32 s62, 2
s_branch Lste_28
Lst2_27:
s_waitcnt vmcnt(0)
v_add_u32 v20, 147456, v20
ds_write_b64 v20, v[32:33]
v_add_u32 v21, 147456, v21
ds_write_b64 v21, v[34:35]
v_add_u32 v22, 147456, v22
ds_write_b64 v22, v[36:37]
s_waitcnt lgkmcnt(0)
s_mov_b32 s62, 3
Lste_28:
s_branch Lst_7_0
Lwr_147:
s_barrier
s_cmp_eq_u32 s62, 3
s_cbranch_scc1 Lste_33
s_cmp_eq_u32 s62, 2
s_cbranch_scc1 Lst2_32
s_waitcnt lgkmcnt(0)
s_cmp_eq_u32 s62, 1
s_cbranch_scc1 Lst1_31
s_waitcnt vmcnt(0)
v_readfirstlane_b32 s54, v6
s_cmp_eq_u32 s54, 0
s_cbranch_scc0 Lrep_34
buffer_load_dword v6, v4, s[56:59], 0 offen sc1
s_branch Lste_33
Lrep_34:
s_add_u32 s7, s34, 64
s_lshl_b32 s7, s7, 7
v_mov_b32 v5, s7
v_mov_b32 v6, 1
s_mov_b64 exec, 1
buffer_atomic_add v6, v5, s[84:87], 0 offen sc1
s_mov_b64 exec, -1
s_mov_b32 s62, 1
s_load_dword s54, s[82:83], s52 glc
s_load_dword s55, s[82:83], s53 glc
s_branch Lste_33
Lst1_31:
s_and_b32 s54, s54, s55
s_cmp_eq_u32 s54, 16
s_cbranch_scc1 Lg_35
s_load_dword s54, s[82:83], s52 glc
s_load_dword s55, s[82:83], s53 glc
s_branch Lste_33
Lg_35:
v_add_u32 v5, 0, v1
v_min_u32 v5, 143, v5
v_lshlrev_b32 v20, 3, v5
v_add_u32 v5, s50, v5
v_max_i32 v5, 0, v5
v_lshlrev_b32 v5, 3, v5
buffer_load_dwordx2 v[32:33], v5, s[20:23], 0 offen sc1
v_add_u32 v5, 64, v1
v_min_u32 v5, 143, v5
v_lshlrev_b32 v21, 3, v5
v_add_u32 v5, s50, v5
v_max_i32 v5, 0, v5
v_lshlrev_b32 v5, 3, v5
buffer_load_dwordx2 v[34:35], v5, s[20:23], 0 offen sc1
v_add_u32 v5, 128, v1
v_min_u32 v5, 143, v5
v_lshlrev_b32 v22, 3, v5
v_add_u32 v5, s50, v5
v_max_i32 v5, 0, v5
v_lshlrev_b32 v5, 3, v5
buffer_load_dwordx2 v[36:37], v5, s[20:23], 0 offen sc1
s_mov_b32 s62, 2
s_branch Lste_33
Lst2_32:
s_waitcnt vmcnt(0)
v_add_u32 v20, 147456, v20
ds_write_b64 v20, v[32:33]
v_add_u32 v21, 147456, v21
ds_write_b64 v21, v[34:35]
v_add_u32 v22, 147456, v22
ds_write_b64 v22, v[36:37]
s_waitcnt lgkmcnt(0)
s_mov_b32 s62, 3
Lste_33:
s_branch Lst_8_0
Lwr_148:
s_barrier
s_cmp_eq_u32 s62, 3
s_cbranch_scc1 Lste_38
s_cmp_eq_u32 s62, 2
s_cbranch_scc1 Lst2_37
s_waitcnt lgkmcnt(0)
s_cmp_eq_u32 s62, 1
s_cbranch_scc1 Lst1_36
s_waitcnt vmcnt(0)
v_readfirstlane_b32 s54, v6
s_cmp_eq_u32 s54, 0
s_cbranch_scc0 Lrep_39
buffer_load_dword v6, v4, s[56:59], 0 offen sc1
s_branch Lste_38
Lrep_39:
s_add_u32 s7, s34, 64
s_lshl_b32 s7, s7, 7
v_mov_b32 v5, s7
v_mov_b32 v6, 1
s_mov_b64 exec, 1
buffer_atomic_add v6, v5, s[84:87], 0 offen sc1
s_mov_b64 exec, -1
s_mov_b32 s62, 1
s_load_dword s54, s[82:83], s52 glc
s_load_dword s55, s[82:83], s53 glc
s_branch Lste_38
Lst1_36:
s_and_b32 s54, s54, s55
s_cmp_eq_u32 s54, 16
s_cbranch_scc1 Lg_40
s_load_dword s54, s[82:83], s52 glc
s_load_dword s55, s[82:83], s53 glc
s_branch Lste_38
Lg_40:
v_add_u32 v5, 0, v1
v_min_u32 v5, 143, v5
v_lshlrev_b32 v20, 3, v5
v_add_u32 v5, s50, v5
v_max_i32 v5, 0, v5
v_lshlrev_b32 v5, 3, v5
buffer_load_dwordx2 v[32:33], v5, s[20:23], 0 offen sc1
v_add_u32 v5, 64, v1
v_min_u32 v5, 143, v5
v_lshlrev_b32 v21, 3, v5
v_add_u32 v5, s50, v5
v_max_i32 v5, 0, v5
v_lshlrev_b32 v5, 3, v5
buffer_load_dwordx2 v[34:35], v5, s[20:23], 0 offen sc1
v_add_u32 v5, 128, v1
v_min_u32 v5, 143, v5
v_lshlrev_b32 v22, 3, v5
v_add_u32 v5, s50, v5
v_max_i32 v5, 0, v5
v_lshlrev_b32 v5, 3, v5
buffer_load_dwordx2 v[36:37], v5, s[20:23], 0 offen sc1
s_mov_b32 s62, 2
s_branch Lste_38
Lst2_37:
s_waitcnt vmcnt(0)
v_add_u32 v20, 147456, v20
ds_write_b64 v20, v[32:33]
v_add_u32 v21, 147456, v21
ds_write_b64 v21, v[34:35]
v_add_u32 v22, 147456, v22
ds_write_b64 v22, v[36:37]
s_waitcnt lgkmcnt(0)
s_mov_b32 s62, 3
Lste_38:
s_branch Lst_9_0
Lwr_149:
s_barrier
s_cmp_eq_u32 s62, 3
s_cbranch_scc1 Lste_43
s_cmp_eq_u32 s62, 2
s_cbranch_scc1 Lst2_42
s_waitcnt lgkmcnt(0)
s_cmp_eq_u32 s62, 1
s_cbranch_scc1 Lst1_41
s_waitcnt vmcnt(0)
v_readfirstlane_b32 s54, v6
s_cmp_eq_u32 s54, 0
s_cbranch_scc0 Lrep_44
buffer_load_dword v6, v4, s[56:59], 0 offen sc1
s_branch Lste_43
Lrep_44:
s_add_u32 s7, s34, 64
s_lshl_b32 s7, s7, 7
v_mov_b32 v5, s7
v_mov_b32 v6, 1
s_mov_b64 exec, 1
buffer_atomic_add v6, v5, s[84:87], 0 offen sc1
s_mov_b64 exec, -1
s_mov_b32 s62, 1
s_load_dword s54, s[82:83], s52 glc
s_load_dword s55, s[82:83], s53 glc
s_branch Lste_43
Lst1_41:
s_and_b32 s54, s54, s55
s_cmp_eq_u32 s54, 16
s_cbranch_scc1 Lg_45
s_load_dword s54, s[82:83], s52 glc
s_load_dword s55, s[82:83], s53 glc
s_branch Lste_43
Lg_45:
v_add_u32 v5, 0, v1
v_min_u32 v5, 143, v5
v_lshlrev_b32 v20, 3, v5
v_add_u32 v5, s50, v5
v_max_i32 v5, 0, v5
v_lshlrev_b32 v5, 3, v5
buffer_load_dwordx2 v[32:33], v5, s[20:23], 0 offen sc1
v_add_u32 v5, 64, v1
v_min_u32 v5, 143, v5
v_lshlrev_b32 v21, 3, v5
v_add_u32 v5, s50, v5
v_max_i32 v5, 0, v5
v_lshlrev_b32 v5, 3, v5
buffer_load_dwordx2 v[34:35], v5, s[20:23], 0 offen sc1
v_add_u32 v5, 128, v1
v_min_u32 v5, 143, v5
v_lshlrev_b32 v22, 3, v5
v_add_u32 v5, s50, v5
v_max_i32 v5, 0, v5
v_lshlrev_b32 v5, 3, v5
buffer_load_dwordx2 v[36:37], v5, s[20:23], 0 offen sc1
s_mov_b32 s62, 2
s_branch Lste_43
Lst2_42:
s_waitcnt vmcnt(0)
v_add_u32 v20, 147456, v20
ds_write_b64 v20, v[32:33]
v_add_u32 v21, 147456, v21
ds_write_b64 v21, v[34:35]
v_add_u32 v22, 147456, v22
ds_write_b64 v22, v[36:37]
s_waitcnt lgkmcnt(0)
s_mov_b32 s62, 3
Lste_43:
s_branch Lst_10_0
Lwr_150:
s_barrier
s_cmp_eq_u32 s62, 3
s_cbranch_scc1 Lste_48
s_cmp_eq_u32 s62, 2
s_cbranch_scc1 Lst2_47
s_waitcnt lgkmcnt(0)
s_cmp_eq_u32 s62, 1
s_cbranch_scc1 Lst1_46
s_waitcnt vmcnt(0)
v_readfirstlane_b32 s54, v6
s_cmp_eq_u32 s54, 0
s_cbranch_scc0 Lrep_49
buffer_load_dword v6, v4, s[56:59], 0 offen sc1
s_branch Lste_48
Lrep_49:
s_add_u32 s7, s34, 64
s_lshl_b32 s7, s7, 7
v_mov_b32 v5, s7
v_mov_b32 v6, 1
s_mov_b64 exec, 1
buffer_atomic_add v6, v5, s[84:87], 0 offen sc1
s_mov_b64 exec, -1
s_mov_b32 s62, 1
s_load_dword s54, s[82:83], s52 glc
s_load_dword s55, s[82:83], s53 glc
s_branch Lste_48
Lst1_46:
s_and_b32 s54, s54, s55
s_cmp_eq_u32 s54, 16
s_cbranch_scc1 Lg_50
s_load_dword s54, s[82:83], s52 glc
s_load_dword s55, s[82:83], s53 glc
s_branch Lste_48
Lg_50:
v_add_u32 v5, 0, v1
v_min_u32 v5, 143, v5
v_lshlrev_b32 v20, 3, v5
v_add_u32 v5, s50, v5
v_max_i32 v5, 0, v5
v_lshlrev_b32 v5, 3, v5
buffer_load_dwordx2 v[32:33], v5, s[20:23], 0 offen sc1
v_add_u32 v5, 64, v1
v_min_u32 v5, 143, v5
v_lshlrev_b32 v21, 3, v5
v_add_u32 v5, s50, v5
v_max_i32 v5, 0, v5
v_lshlrev_b32 v5, 3, v5
buffer_load_dwordx2 v[34:35], v5, s[20:23], 0 offen sc1
v_add_u32 v5, 128, v1
v_min_u32 v5, 143, v5
v_lshlrev_b32 v22, 3, v5
v_add_u32 v5, s50, v5
v_max_i32 v5, 0, v5
v_lshlrev_b32 v5, 3, v5
buffer_load_dwordx2 v[36:37], v5, s[20:23], 0 offen sc1
s_mov_b32 s62, 2
s_branch Lste_48
Lst2_47:
s_waitcnt vmcnt(0)
v_add_u32 v20, 147456, v20
ds_write_b64 v20, v[32:33]
v_add_u32 v21, 147456, v21
ds_write_b64 v21, v[34:35]
v_add_u32 v22, 147456, v22
ds_write_b64 v22, v[36:37]
s_waitcnt lgkmcnt(0)
s_mov_b32 s62, 3
Lste_48:
s_branch Lst_11_0
Lwr_151:
s_barrier
s_cmp_eq_u32 s62, 3
s_cbranch_scc1 Lste_53
s_cmp_eq_u32 s62, 2
s_cbranch_scc1 Lst2_52
s_waitcnt lgkmcnt(0)
s_cmp_eq_u32 s62, 1
s_cbranch_scc1 Lst1_51
s_waitcnt vmcnt(0)
v_readfirstlane_b32 s54, v6
s_cmp_eq_u32 s54, 0
s_cbranch_scc0 Lrep_54
buffer_load_dword v6, v4, s[56:59], 0 offen sc1
s_branch Lste_53
Lrep_54:
s_add_u32 s7, s34, 64
s_lshl_b32 s7, s7, 7
v_mov_b32 v5, s7
v_mov_b32 v6, 1
s_mov_b64 exec, 1
buffer_atomic_add v6, v5, s[84:87], 0 offen sc1
s_mov_b64 exec, -1
s_mov_b32 s62, 1
s_load_dword s54, s[82:83], s52 glc
s_load_dword s55, s[82:83], s53 glc
s_branch Lste_53
Lst1_51:
s_and_b32 s54, s54, s55
s_cmp_eq_u32 s54, 16
s_cbranch_scc1 Lg_55
s_load_dword s54, s[82:83], s52 glc
s_load_dword s55, s[82:83], s53 glc
s_branch Lste_53
Lg_55:
v_add_u32 v5, 0, v1
v_min_u32 v5, 143, v5
v_lshlrev_b32 v20, 3, v5
v_add_u32 v5, s50, v5
v_max_i32 v5, 0, v5
v_lshlrev_b32 v5, 3, v5
buffer_load_dwordx2 v[32:33], v5, s[20:23], 0 offen sc1
v_add_u32 v5, 64, v1
v_min_u32 v5, 143, v5
v_lshlrev_b32 v21, 3, v5
v_add_u32 v5, s50, v5
v_max_i32 v5, 0, v5
v_lshlrev_b32 v5, 3, v5
buffer_load_dwordx2 v[34:35], v5, s[20:23], 0 offen sc1
v_add_u32 v5, 128, v1
v_min_u32 v5, 143, v5
v_lshlrev_b32 v22, 3, v5
v_add_u32 v5, s50, v5
v_max_i32 v5, 0, v5
v_lshlrev_b32 v5, 3, v5
buffer_load_dwordx2 v[36:37], v5, s[20:23], 0 offen sc1
s_mov_b32 s62, 2
s_branch Lste_53
Lst2_52:
s_waitcnt vmcnt(0)
v_add_u32 v20, 147456, v20
ds_write_b64 v20, v[32:33]
v_add_u32 v21, 147456, v21
ds_write_b64 v21, v[34:35]
v_add_u32 v22, 147456, v22
ds_write_b64 v22, v[36:37]
s_waitcnt lgkmcnt(0)
s_mov_b32 s62, 3
Lste_53:
s_branch Lst_12_0
Lwr_152:
s_barrier
s_cmp_eq_u32 s62, 3
s_cbranch_scc1 Lste_58
s_cmp_eq_u32 s62, 2
s_cbranch_scc1 Lst2_57
s_waitcnt lgkmcnt(0)
s_cmp_eq_u32 s62, 1
s_cbranch_scc1 Lst1_56
s_waitcnt vmcnt(0)
v_readfirstlane_b32 s54, v6
s_cmp_eq_u32 s54, 0
s_cbranch_scc0 Lrep_59
buffer_load_dword v6, v4, s[56:59], 0 offen sc1
s_branch Lste_58
Lrep_59:
s_add_u32 s7, s34, 64
s_lshl_b32 s7, s7, 7
v_mov_b32 v5, s7
v_mov_b32 v6, 1
s_mov_b64 exec, 1
buffer_atomic_add v6, v5, s[84:87], 0 offen sc1
s_mov_b64 exec, -1
s_mov_b32 s62, 1
s_load_dword s54, s[82:83], s52 glc
s_load_dword s55, s[82:83], s53 glc
s_branch Lste_58
Lst1_56:
s_and_b32 s54, s54, s55
s_cmp_eq_u32 s54, 16
s_cbranch_scc1 Lg_60
s_load_dword s54, s[82:83], s52 glc
s_load_dword s55, s[82:83], s53 glc
s_branch Lste_58
Lg_60:
v_add_u32 v5, 0, v1
v_min_u32 v5, 143, v5
v_lshlrev_b32 v20, 3, v5
v_add_u32 v5, s50, v5
v_max_i32 v5, 0, v5
v_lshlrev_b32 v5, 3, v5
buffer_load_dwordx2 v[32:33], v5, s[20:23], 0 offen sc1
v_add_u32 v5, 64, v1
v_min_u32 v5, 143, v5
v_lshlrev_b32 v21, 3, v5
v_add_u32 v5, s50, v5
v_max_i32 v5, 0, v5
v_lshlrev_b32 v5, 3, v5
buffer_load_dwordx2 v[34:35], v5, s[20:23], 0 offen sc1
v_add_u32 v5, 128, v1
v_min_u32 v5, 143, v5
v_lshlrev_b32 v22, 3, v5
v_add_u32 v5, s50, v5
v_max_i32 v5, 0, v5
v_lshlrev_b32 v5, 3, v5
buffer_load_dwordx2 v[36:37], v5, s[20:23], 0 offen sc1
s_mov_b32 s62, 2
s_branch Lste_58
Lst2_57:
s_waitcnt vmcnt(0)
v_add_u32 v20, 147456, v20
ds_write_b64 v20, v[32:33]
v_add_u32 v21, 147456, v21
ds_write_b64 v21, v[34:35]
v_add_u32 v22, 147456, v22
ds_write_b64 v22, v[36:37]
s_waitcnt lgkmcnt(0)
s_mov_b32 s62, 3
Lste_58:
s_branch Lst_13_0
Lwr_153:
s_barrier
s_cmp_eq_u32 s62, 3
s_cbranch_scc1 Lste_63
s_cmp_eq_u32 s62, 2
s_cbranch_scc1 Lst2_62
s_waitcnt lgkmcnt(0)
s_cmp_eq_u32 s62, 1
s_cbranch_scc1 Lst1_61
s_waitcnt vmcnt(0)
v_readfirstlane_b32 s54, v6
s_cmp_eq_u32 s54, 0
s_cbranch_scc0 Lrep_64
buffer_load_dword v6, v4, s[56:59], 0 offen sc1
s_branch Lste_63
Lrep_64:
s_add_u32 s7, s34, 64
s_lshl_b32 s7, s7, 7
v_mov_b32 v5, s7
v_mov_b32 v6, 1
s_mov_b64 exec, 1
buffer_atomic_add v6, v5, s[84:87], 0 offen sc1
s_mov_b64 exec, -1
s_mov_b32 s62, 1
s_load_dword s54, s[82:83], s52 glc
s_load_dword s55, s[82:83], s53 glc
s_branch Lste_63
Lst1_61:
s_and_b32 s54, s54, s55
s_cmp_eq_u32 s54, 16
s_cbranch_scc1 Lg_65
s_load_dword s54, s[82:83], s52 glc
s_load_dword s55, s[82:83], s53 glc
s_branch Lste_63
Lg_65:
v_add_u32 v5, 0, v1
v_min_u32 v5, 143, v5
v_lshlrev_b32 v20, 3, v5
v_add_u32 v5, s50, v5
v_max_i32 v5, 0, v5
v_lshlrev_b32 v5, 3, v5
buffer_load_dwordx2 v[32:33], v5, s[20:23], 0 offen sc1
v_add_u32 v5, 64, v1
v_min_u32 v5, 143, v5
v_lshlrev_b32 v21, 3, v5
v_add_u32 v5, s50, v5
v_max_i32 v5, 0, v5
v_lshlrev_b32 v5, 3, v5
buffer_load_dwordx2 v[34:35], v5, s[20:23], 0 offen sc1
v_add_u32 v5, 128, v1
v_min_u32 v5, 143, v5
v_lshlrev_b32 v22, 3, v5
v_add_u32 v5, s50, v5
v_max_i32 v5, 0, v5
v_lshlrev_b32 v5, 3, v5
buffer_load_dwordx2 v[36:37], v5, s[20:23], 0 offen sc1
s_mov_b32 s62, 2
s_branch Lste_63
Lst2_62:
s_waitcnt vmcnt(0)
v_add_u32 v20, 147456, v20
ds_write_b64 v20, v[32:33]
v_add_u32 v21, 147456, v21
ds_write_b64 v21, v[34:35]
v_add_u32 v22, 147456, v22
ds_write_b64 v22, v[36:37]
s_waitcnt lgkmcnt(0)
s_mov_b32 s62, 3
Lste_63:
s_branch Lst_14_0
Lwr_154:
s_barrier
s_cmp_eq_u32 s62, 3
s_cbranch_scc1 Lste_68
s_cmp_eq_u32 s62, 2
s_cbranch_scc1 Lst2_67
s_cmp_eq_u32 s62, 1
s_cbranch_scc1 Lst1_66
s_mov_b32 s41, 0x40000
Lz0_69:
s_branch Lov_4
.p2align 12
Lst_4_0:
s_branch Lwr_144
s_nop 0
s_nop 0
Lov_4:
s_waitcnt vmcnt(0)
v_readfirstlane_b32 s54, v6
s_cmp_eq_u32 s54, 0
s_cbranch_scc0 Lzok_70
buffer_load_dword v6, v4, s[56:59], 0 offen sc1
s_sub_u32 s41, s41, 1
s_cmp_lg_u32 s41, 0
s_cbranch_scc1 Lz0_69
s_waitcnt lgkmcnt(0)
Lzok_70:
s_add_u32 s7, s34, 64
s_lshl_b32 s7, s7, 7
v_mov_b32 v5, s7
v_mov_b32 v6, 1
s_mov_b64 exec, 1
buffer_atomic_add v6, v5, s[84:87], 0 offen sc1
s_mov_b64 exec, -1
s_load_dword s54, s[82:83], s52 glc
s_load_dword s55, s[82:83], s53 glc
Lst1_66:
s_mov_b32 s41, 200
Lpoll_71:
s_waitcnt lgkmcnt(0)
s_and_b32 s54, s54, s55
s_cmp_eq_u32 s54, 16
s_cbranch_scc1 Lg_73
s_load_dword s54, s[82:83], s52 glc
s_load_dword s55, s[82:83], s53 glc
s_sub_u32 s41, s41, 1
s_cmp_lg_u32 s41, 0
s_cbranch_scc1 Lpoll_71
s_waitcnt lgkmcnt(0)
s_mov_b32 s41, 0
Lfb_72:
s_add_u32 s62, s50, s41
s_max_i32 s62, s62, 0
s_lshl_b32 s43, s62, 11
buffer_load_dwordx4 v[96:99], v10, s[8:11], s43 offen offset:0
buffer_load_dwordx4 v[100:103], v10, s[8:11], s43 offen offset:1024
buffer_load_dwordx4 v[104:107], v10, s[8:11], s43 offen offset:2048
buffer_load_dwordx4 v[108:111], v10, s[8:11], s43 offen offset:3072
s_waitcnt vmcnt(0)
s_mov_b32 s43, 0x3f803f80
v_mov_b32 v116, 0
v_mov_b32 v117, 0
v_mov_b32 v118, 0
v_mov_b32 v119, 0
v_mov_b32 v120, 0
v_mov_b32 v121, 0
v_mov_b32 v122, 0
v_mov_b32 v123, 0
v_dot2_f32_bf16 v116, v96, s43, v116
v_dot2_f32_bf16 v120, v96, v96, v120
v_dot2_f32_bf16 v118, v104, s43, v118
v_dot2_f32_bf16 v122, v104, v104, v122
v_dot2_f32_bf16 v117, v97, s43, v117
v_dot2_f32_bf16 v121, v97, v97, v121
v_dot2_f32_bf16 v119, v105, s43, v119
v_dot2_f32_bf16 v123, v105, v105, v123
v_dot2_f32_bf16 v116, v98, s43, v116
v_dot2_f32_bf16 v120, v98, v98, v120
v_dot2_f32_bf16 v118, v106, s43, v118
v_dot2_f32_bf16 v122, v106, v106, v122
v_dot2_f32_bf16 v117, v99, s43, v117
v_dot2_f32_bf16 v121, v99, v99, v121
v_dot2_f32_bf16 v119, v107, s43, v119
v_dot2_f32_bf16 v123, v107, v107, v123
v_dot2_f32_bf16 v116, v100, s43, v116
v_dot2_f32_bf16 v120, v100, v100, v120
v_dot2_f32_bf16 v118, v108, s43, v118
v_dot2_f32_bf16 v122, v108, v108, v122
v_dot2_f32_bf16 v117, v101, s43, v117
v_dot2_f32_bf16 v121, v101, v101, v121
v_dot2_f32_bf16 v119, v109, s43, v119
v_dot2_f32_bf16 v123, v109, v109, v123
v_dot2_f32_bf16 v116, v102, s43, v116
v_dot2_f32_bf16 v120, v102, v102, v120
v_dot2_f32_bf16 v118, v110, s43, v118
v_dot2_f32_bf16 v122, v110, v110, v122
v_dot2_f32_bf16 v117, v103, s43, v117
v_dot2_f32_bf16 v121, v103, v103, v121
v_dot2_f32_bf16 v119, v111, s43, v119
v_dot2_f32_bf16 v123, v111, v111, v123
s_nop 2
v_add_f32 v116, v116, v117
v_add_f32 v118, v118, v119
v_add_f32 v120, v120, v121
v_add_f32 v122, v122, v123
s_nop 1
v_permlane32_swap_b32 v116, v118
v_permlane32_swap_b32 v120, v122
v_add_f32 v116, v116, v118
v_add_f32 v120, v120, v122
s_nop 1
v_permlane16_swap_b32 v116, v120
v_add_f32 v116, v116, v120
s_nop 1
v_add_f32_dpp v116, v116, v116 row_ror:8 row_mask:0xf bank_mask:0xf
s_nop 1
v_add_f32_dpp v116, v116, v116 row_ror:4 row_mask:0xf bank_mask:0xf
s_nop 1
v_add_f32_dpp v116, v116, v116 row_ror:2 row_mask:0xf bank_mask:0xf
s_nop 1
v_add_f32_dpp v116, v116, v116 row_ror:1 row_mask:0xf bank_mask:0xf
v_mov_b32 v117, v116
s_nop 1
v_permlane16_swap_b32 v116, v117
v_mul_f32 v112, 0x3a800000, v116
v_mul_f32 v113, 0x3a800000, v117
v_fma_f32 v113, -v112, v112, v113
v_max_f32 v113, 0, v113
v_add_f32 v113, 0x3727c5ac, v113
v_rsq_f32 v113, v113
v_lshrrev_b32 v11, 5, v1
s_lshl_b32 s43, s41, 3
s_add_u32 s43, s43, 147456
v_lshl_add_u32 v11, v11, 3, s43
ds_write_b64 v11, v[112:113]
s_add_u32 s41, s41, 2
s_cmp_lt_u32 s41, 144
s_cbranch_scc1 Lfb_72
s_waitcnt lgkmcnt(0)
s_branch Lste_68
Lg_73:
v_add_u32 v5, 0, v1
v_min_u32 v5, 143, v5
v_lshlrev_b32 v20, 3, v5
v_add_u32 v5, s50, v5
v_max_i32 v5, 0, v5
v_lshlrev_b32 v5, 3, v5
buffer_load_dwordx2 v[32:33], v5, s[20:23], 0 offen sc1
v_add_u32 v5, 64, v1
v_min_u32 v5, 143, v5
v_lshlrev_b32 v21, 3, v5
v_add_u32 v5, s50, v5
v_max_i32 v5, 0, v5
v_lshlrev_b32 v5, 3, v5
buffer_load_dwordx2 v[34:35], v5, s[20:23], 0 offen sc1
v_add_u32 v5, 128, v1
v_min_u32 v5, 143, v5
v_lshlrev_b32 v22, 3, v5
v_add_u32 v5, s50, v5
v_max_i32 v5, 0, v5
v_lshlrev_b32 v5, 3, v5
buffer_load_dwordx2 v[36:37], v5, s[20:23], 0 offen sc1
Lst2_67:
s_waitcnt vmcnt(0)
v_add_u32 v20, 147456, v20
ds_write_b64 v20, v[32:33]
v_add_u32 v21, 147456, v21
ds_write_b64 v21, v[34:35]
v_add_u32 v22, 147456, v22
ds_write_b64 v22, v[36:37]
s_waitcnt lgkmcnt(0)
Lste_68:
s_bitcmp0_b32 s2, 0
s_cselect_b32 s88, s72, s74
s_cselect_b32 s89, s73, s75
s_cmp_lt_u32 s2, 192
s_cselect_b32 s90, 7340032, 0
s_mov_b32 s91, 0x20000
s_bfe_u32 s44, s2, 0x30001
s_lshl_b32 s44, s44, 2
s_and_b32 s43, s36, 3
s_add_u32 s44, s44, s43
s_lshl_b32 s44, s44, 5
v_lshrrev_b32 v18, 4, v1
v_add_u32 v18, s44, v18
v_mul_u32_u24 v18, 7168, v18
v_and_b32 v19, 15, v1
v_lshl_add_u32 v18, v19, 4, v18
s_lshr_b32 s43, s2, 4
s_lshl_b32 s43, s43, 8
s_add_u32 s43, s43, 4096
v_add_u32 v18, s43, v18
s_mov_b32 s43, 0
buffer_load_dwordx4 v[128:131], v18, s[88:91], s43 offen
s_mov_b32 s43, 28672
buffer_load_dwordx4 v[132:135], v18, s[88:91], s43 offen
s_mov_b32 s43, 57344
buffer_load_dwordx4 v[136:139], v18, s[88:91], s43 offen
s_mov_b32 s43, 86016
buffer_load_dwordx4 v[140:143], v18, s[88:91], s43 offen
s_mov_b32 s43, 114688
buffer_load_dwordx4 v[144:147], v18, s[88:91], s43 offen
s_mov_b32 s43, 143360
buffer_load_dwordx4 v[148:151], v18, s[88:91], s43 offen
s_mov_b32 s43, 172032
buffer_load_dwordx4 v[152:155], v18, s[88:91], s43 offen
s_mov_b32 s43, 200704
buffer_load_dwordx4 v[156:159], v18, s[88:91], s43 offen
s_barrier
s_lshl_b32 s43, s35, 7
s_add_u32 s28, s68, s43
s_addc_u32 s29, s69, 0
s_mov_b32 s30, 2095232
s_mov_b32 s31, 0x20000
v_lshrrev_b32 v15, 3, v1
v_and_b32 v16, 6, v15
v_and_b32 v7, 7, v1
v_xor_b32 v7, v7, v16
v_lshlrev_b32 v7, 4, v7
v_mul_u32_u24 v15, 2048, v15
v_add_u32 v7, v7, v15
s_and_b32 s40, s36, 3
s_lshl_b32 s39, s40, 13
s_add_u32 s40, s40, s35
s_add_u32 s42, s40, 0
s_and_b32 s42, s42, 15
s_lshl_b32 s42, s42, 17
s_add_u32 m0, s39, 65536
s_add_u32 s43, s42, 0
buffer_load_dwordx4 v7, s[28:31], s43 offen lds
s_add_u32 m0, s39, 66560
s_add_u32 s43, s42, 16384
buffer_load_dwordx4 v7, s[28:31], s43 offen lds
s_add_u32 m0, s39, 67584
s_add_u32 s43, s42, 32768
buffer_load_dwordx4 v7, s[28:31], s43 offen lds
s_add_u32 m0, s39, 68608
s_add_u32 s43, s42, 49152
buffer_load_dwordx4 v7, s[28:31], s43 offen lds
s_add_u32 m0, s39, 69632
s_add_u32 s43, s42, 65536
buffer_load_dwordx4 v7, s[28:31], s43 offen lds
s_add_u32 m0, s39, 70656
s_add_u32 s43, s42, 81920
buffer_load_dwordx4 v7, s[28:31], s43 offen lds
s_add_u32 m0, s39, 71680
s_add_u32 s43, s42, 98304
buffer_load_dwordx4 v7, s[28:31], s43 offen lds
s_add_u32 m0, s39, 72704
s_add_u32 s43, s42, 114688
buffer_load_dwordx4 v7, s[28:31], s43 offen lds
Lats_6:
s_and_b32 s43, s36, 1
s_bfe_u32 s44, s36, 0x10001
s_lshr_b32 s45, s36, 2
v_lshlrev_b32 v14, 2, v13
v_sub_u32 v14, v12, v14
v_mov_b32 v16, 0xff800000
s_or_b32 s46, s34, s45
s_cmp_lg_u32 s46, 0
s_cselect_b32 s46, 0, 0xff800000
v_subrev_u32 v15, 0, v14
v_cmp_ge_u32 vcc, 7, v15
v_add_u32 v15, 16, v15
s_nop 0
v_cndmask_b32 v248, v16, 0, vcc
v_cmp_ge_u32 vcc, 7, v15
s_nop 1
v_cndmask_b32 v244, v16, 0, vcc
v_or_b32 v240, s46, v244
v_subrev_u32 v15, 1, v14
v_cmp_ge_u32 vcc, 7, v15
v_add_u32 v15, 16, v15
s_nop 0
v_cndmask_b32 v249, v16, 0, vcc
v_cmp_ge_u32 vcc, 7, v15
s_nop 1
v_cndmask_b32 v245, v16, 0, vcc
v_or_b32 v241, s46, v245
v_subrev_u32 v15, 2, v14
v_cmp_ge_u32 vcc, 7, v15
v_add_u32 v15, 16, v15
s_nop 0
v_cndmask_b32 v250, v16, 0, vcc
v_cmp_ge_u32 vcc, 7, v15
s_nop 1
v_cndmask_b32 v246, v16, 0, vcc
v_or_b32 v242, s46, v246
v_subrev_u32 v15, 3, v14
v_cmp_ge_u32 vcc, 7, v15
v_add_u32 v15, 16, v15
s_nop 0
v_cndmask_b32 v251, v16, 0, vcc
v_cmp_ge_u32 vcc, 7, v15
s_nop 1
v_cndmask_b32 v247, v16, 0, vcc
v_or_b32 v243, s46, v247
s_lshl_b32 s46, s45, 6
s_add_u32 s46, s46, s44
s_add_u32 s46, s46, 16
v_lshl_add_u32 v14, v12, 1, s46
s_lshl_b32 s47, s43, 6
v_lshl_add_u32 v15, v13, 4, s47
v_mul_u32_u24 v20, 400, v14
v_add_u32 v20, v20, v15
v_subrev_u32 v16, 32, v14
v_max_i32 v16, 0, v16
v_mul_u32_u24 v21, 400, v16
v_add_u32 v21, v21, v15
v_lshrrev_b32 v16, 2, v12
v_lshl_add_u32 v16, v13, 2, v16
v_lshl_add_u32 v16, v16, 1, s46
v_and_b32 v17, 3, v1
v_lshl_add_u32 v17, v17, 3, s47
v_mul_u32_u24 v22, 400, v16
v_add_u32 v22, v22, v17
v_subrev_u32 v16, 32, v16
v_max_i32 v16, 0, v16
v_mul_u32_u24 v23, 400, v16
v_add_u32 v23, v23, v17
s_mul_i32 s60, s34, 262144
s_add_u32 s16, s82, s60
s_addc_u32 s17, s83, 0
s_mov_b32 s18, 262144
s_mov_b32 s19, 0x20000
s_lshl_b32 s60, s35, 14
s_lshl_b32 s43, s43, 13
s_add_u32 s60, s60, s43
s_lshl_b32 s43, s45, 12
s_add_u32 s60, s60, s43
s_lshl_b32 s43, s44, 10
s_add_u32 s60, s60, s43
v_lshlrev_b32 v24, 4, v1
s_mov_b32 s61, 0x3e8293ee
s_lshl_b32 s38, s35, 7
Latt_5:
s_barrier
ds_read_b128 v[32:35], v20 offset:0
ds_read_b128 v[36:39], v20 offset:128
ds_read_b128 v[40:43], v21 offset:128
ds_read_b128 v[80:83], v20 offset:12800
ds_read_b128 v[84:87], v20 offset:12928
ds_read_b128 v[88:91], v20 offset:128
ds_read_b64_tr_b16 v[44:45], v23 offset:256
ds_read_b64_tr_b16 v[46:47], v22 offset:256
ds_read_b64_tr_b16 v[48:49], v23 offset:288
ds_read_b64_tr_b16 v[50:51], v22 offset:288
ds_read_b64_tr_b16 v[92:93], v22 offset:256
ds_read_b64_tr_b16 v[94:95], v22 offset:13056
ds_read_b64_tr_b16 v[96:97], v22 offset:288
ds_read_b64_tr_b16 v[98:99], v22 offset:13088
s_waitcnt lgkmcnt(11)
v_mfma_f32_16x16x32_bf16 v[52:55], v[40:43], v[32:35], v[240:243]
v_mfma_f32_16x16x32_bf16 v[56:59], v[36:39], v[32:35], v[248:251]
s_waitcnt lgkmcnt(8)
v_mfma_f32_16x16x32_bf16 v[100:103], v[88:91], v[80:83], v[244:247]
v_mfma_f32_16x16x32_bf16 v[104:107], v[84:87], v[80:83], v[248:251]
s_nop 4
v_max3_f32 v60, v52, v53, v54
v_max3_f32 v108, v100, v101, v102
v_max3_f32 v61, v55, v56, v57
v_max3_f32 v109, v103, v104, v105
v_max3_f32 v60, v60, v58, v59
v_max3_f32 v108, v108, v106, v107
v_max_f32 v60, v60, v61
v_max_f32 v108, v108, v109
s_nop 0
v_permlane32_swap_b32 v60, v108
v_max_f32 v60, v60, v108
v_mov_b32 v61, v60
s_nop 1
v_permlane16_swap_b32 v60, v61
v_max_f32 v60, v60, v61
v_mul_f32 v60, s61, v60
s_nop 0
v_mov_b32 v108, v60
s_nop 1
v_permlane32_swap_b32 v60, v108
v_fma_f32 v52, v52, s61, -v60
v_fma_f32 v100, v100, s61, -v108
v_fma_f32 v53, v53, s61, -v60
v_fma_f32 v101, v101, s61, -v108
v_fma_f32 v54, v54, s61, -v60
v_fma_f32 v102, v102, s61, -v108
v_fma_f32 v55, v55, s61, -v60
v_fma_f32 v103, v103, s61, -v108
v_fma_f32 v56, v56, s61, -v60
v_fma_f32 v104, v104, s61, -v108
v_fma_f32 v57, v57, s61, -v60
v_fma_f32 v105, v105, s61, -v108
v_fma_f32 v58, v58, s61, -v60
v_fma_f32 v106, v106, s61, -v108
v_fma_f32 v59, v59, s61, -v60
v_fma_f32 v107, v107, s61, -v108
v_exp_f32 v52, v52
v_exp_f32 v100, v100
v_exp_f32 v53, v53
v_exp_f32 v101, v101
v_exp_f32 v54, v54
v_exp_f32 v102, v102
v_exp_f32 v55, v55
v_exp_f32 v103, v103
v_exp_f32 v56, v56
v_exp_f32 v104, v104
v_exp_f32 v57, v57
v_exp_f32 v105, v105
v_exp_f32 v58, v58
v_exp_f32 v106, v106
v_exp_f32 v59, v59
v_exp_f32 v107, v107
v_cvt_pk_bf16_f32 v64, v52, v53
v_cvt_pk_bf16_f32 v112, v100, v101
v_cvt_pk_bf16_f32 v65, v54, v55
v_cvt_pk_bf16_f32 v113, v102, v103
v_cvt_pk_bf16_f32 v66, v56, v57
v_cvt_pk_bf16_f32 v114, v104, v105
v_cvt_pk_bf16_f32 v67, v58, v59
v_cvt_pk_bf16_f32 v115, v106, v107
v_pk_add_f32 v[52:53], v[52:53], v[54:55]
v_pk_add_f32 v[100:101], v[100:101], v[102:103]
v_pk_add_f32 v[56:57], v[56:57], v[58:59]
v_pk_add_f32 v[104:105], v[104:105], v[106:107]
s_waitcnt lgkmcnt(0)
s_waitcnt lgkmcnt(0)
v_mfma_f32_16x16x32_bf16 v[68:71], v[44:47], v[64:67], 0
v_mfma_f32_16x16x32_bf16 v[116:119], v[92:95], v[112:115], 0
v_mfma_f32_16x16x32_bf16 v[72:75], v[48:51], v[64:67], 0
v_mfma_f32_16x16x32_bf16 v[120:123], v[96:99], v[112:115], 0
v_pk_add_f32 v[52:53], v[52:53], v[56:57]
v_pk_add_f32 v[100:101], v[100:101], v[104:105]
v_add_f32 v60, v52, v53
v_add_f32 v108, v100, v101
s_nop 0
v_permlane32_swap_b32 v60, v108
v_add_f32 v60, v60, v108
v_mov_b32 v61, v60
s_nop 1
v_permlane16_swap_b32 v60, v61
v_add_f32 v60, v60, v61
v_rcp_f32 v60, v60
s_nop 0
v_mov_b32 v108, v60
s_nop 1
v_permlane32_swap_b32 v60, v108
v_pk_mul_f32 v[68:69], v[60:61], v[68:69] op_sel_hi:[0,1]
v_pk_mul_f32 v[116:117], v[108:109], v[116:117] op_sel_hi:[0,1]
v_pk_mul_f32 v[70:71], v[60:61], v[70:71] op_sel_hi:[0,1]
v_pk_mul_f32 v[118:119], v[108:109], v[118:119] op_sel_hi:[0,1]
v_pk_mul_f32 v[72:73], v[60:61], v[72:73] op_sel_hi:[0,1]
v_pk_mul_f32 v[120:121], v[108:109], v[120:121] op_sel_hi:[0,1]
v_pk_mul_f32 v[74:75], v[60:61], v[74:75] op_sel_hi:[0,1]
v_pk_mul_f32 v[122:123], v[108:109], v[122:123] op_sel_hi:[0,1]
v_cvt_pk_bf16_f32 v64, v68, v69
v_cvt_pk_bf16_f32 v112, v116, v117
v_cvt_pk_bf16_f32 v65, v70, v71
v_cvt_pk_bf16_f32 v113, v118, v119
v_cvt_pk_bf16_f32 v66, v72, v73
v_cvt_pk_bf16_f32 v114, v120, v121
v_cvt_pk_bf16_f32 v67, v74, v75
v_cvt_pk_bf16_f32 v115, v122, v123
buffer_store_dwordx4 v[64:67], v24, s[16:19], s60 offen offset:0 sc1
buffer_store_dwordx4 v[112:115], v24, s[16:19], s60 offen offset:2048 sc1
s_cmp_lt_u32 s36, 4
s_cbranch_scc1 Lc_74
s_add_u32 s56, s82, 28311552
s_addc_u32 s57, s83, 0
s_mov_b32 s58, 49152
s_mov_b32 s59, 0x20000
s_add_u32 s28, s68, s38
s_addc_u32 s29, s69, 0
s_mov_b32 s30, 2095232
s_mov_b32 s31, 0x20000
s_add_u32 s42, s40, 4
s_and_b32 s42, s42, 15
s_lshl_b32 s42, s42, 17
s_add_u32 m0, s39, 114688
s_add_u32 s43, s42, 0
buffer_load_dwordx4 v7, s[28:31], s43 offen lds
s_add_u32 m0, s39, 115712
s_add_u32 s43, s42, 16384
buffer_load_dwordx4 v7, s[28:31], s43 offen lds
s_add_u32 m0, s39, 116736
s_add_u32 s43, s42, 32768
buffer_load_dwordx4 v7, s[28:31], s43 offen lds
s_add_u32 m0, s39, 117760
s_add_u32 s43, s42, 49152
buffer_load_dwordx4 v7, s[28:31], s43 offen lds
s_add_u32 m0, s39, 118784
s_add_u32 s43, s42, 65536
buffer_load_dwordx4 v7, s[28:31], s43 offen lds
s_add_u32 m0, s39, 119808
s_add_u32 s43, s42, 81920
buffer_load_dwordx4 v7, s[28:31], s43 offen lds
s_add_u32 m0, s39, 120832
s_add_u32 s43, s42, 98304
buffer_load_dwordx4 v7, s[28:31], s43 offen lds
s_add_u32 m0, s39, 121856
s_add_u32 s43, s42, 114688
buffer_load_dwordx4 v7, s[28:31], s43 offen lds
s_waitcnt vmcnt(8)
s_branch Lo_75
Lc_74:
s_add_u32 s56, s82, 28311552
s_addc_u32 s57, s83, 0
s_mov_b32 s58, 49152
s_mov_b32 s59, 0x20000
s_waitcnt vmcnt(0)
Lo_75:
s_barrier
s_cmp_lg_u32 s36, 0
s_cbranch_scc1 Lsig_76
s_add_u32 s7, s34, 0
s_lshl_b32 s7, s7, 7
v_mov_b32 v4, s7
v_mov_b32 v5, 1
s_mov_b64 exec, 1
buffer_atomic_add v5, v4, s[56:59], 0 offen sc1
s_mov_b64 exec, -1
Lsig_76:
s_cmp_ge_u32 s36, 4
s_cbranch_scc1 Lprod_78
v_and_b32 v12, 15, v1
v_lshrrev_b32 v13, 4, v1
v_lshlrev_b32 v10, 12, v12
v_and_b32 v14, 1, v13
v_lshl_add_u32 v10, v14, 5, v10
v_lshrrev_b32 v14, 1, v13
v_lshl_add_u32 v10, v14, 4, v10
s_lshl_b32 s43, s34, 18
s_lshl_b32 s44, s36, 16
s_add_u32 s43, s43, s44
s_lshl_b32 s44, s35, 7
s_add_u32 s43, s43, s44
buffer_load_dwordx4 v[128:131], v10, s[8:11], s43 offen offset:0
buffer_load_dwordx4 v[132:135], v10, s[8:11], s43 offen offset:64
buffer_load_dwordx4 v[136:139], v10, s[8:11], s43 offen offset:2048
buffer_load_dwordx4 v[140:143], v10, s[8:11], s43 offen offset:2112
s_mul_i32 s43, s34, 262144
s_add_u32 s20, s82, s43
s_addc_u32 s21, s83, 0
s_add_u32 s20, s20, 4194304
s_addc_u32 s21, s21, 0
s_mov_b32 s22, 262144
s_mov_b32 s23, 0x20000
s_mul_i32 s43, s34, 16384
s_add_u32 s24, s82, s43
s_addc_u32 s25, s83, 0
s_add_u32 s24, s24, 25165824
s_addc_u32 s25, s25, 0
s_mov_b32 s26, 16384
s_mov_b32 s27, 0x20000
v_lshlrev_b32 v11, 4, v1
s_lshl_b32 s43, s36, 11
v_add_u32 v2, s43, v11
v_add_u32 v3, 98304, v2
v_lshrrev_b32 v14, 2, v1
v_bfe_u32 v15, v14, 1, 2
v_mul_u32_u24 v14, 128, v14
v_lshl_add_u32 v14, v15, 5, v14
v_and_b32 v15, 3, v1
v_lshl_add_u32 v4, v15, 3, v14
v_xor_b32 v5, 32, v4
v_xor_b32 v6, 64, v4
v_xor_b32 v7, 96, v4
v_add_u32 v16, 0x10000, v4
v_add_u32 v20, 0x20000, v4
v_add_u32 v17, 0x10000, v5
v_add_u32 v21, 0x20000, v5
v_add_u32 v18, 0x10000, v6
v_add_u32 v22, 0x20000, v6
v_add_u32 v19, 0x10000, v7
v_add_u32 v23, 0x20000, v7
s_lshl_b32 s44, s35, 14
s_add_u32 s60, s44, s43
v_lshrrev_b32 v14, 1, v13
v_lshlrev_b32 v14, 11, v14
v_lshl_add_u32 v14, v12, 3, v14
v_and_b32 v15, 1, v13
v_lshl_add_u32 v14, v15, 2, v14
s_lshl_b32 s43, s36, 12
s_lshl_b32 s44, s35, 7
s_add_u32 s43, s43, s44
v_add_u32 v9, s43, v14
s_mov_b32 s61, 0x3f803f80
s_waitcnt vmcnt(0)
v_permlane16_swap_b32 v128, v130
v_permlane16_swap_b32 v129, v131
v_permlane16_swap_b32 v132, v134
v_permlane16_swap_b32 v133, v135
v_permlane16_swap_b32 v136, v138
v_permlane16_swap_b32 v137, v139
v_permlane16_swap_b32 v140, v142
v_permlane16_swap_b32 v141, v143
v_lshlrev_b32 v96, 16, v128
v_and_b32 v97, 0xffff0000, v128
v_lshlrev_b32 v98, 16, v129
v_and_b32 v99, 0xffff0000, v129
v_lshlrev_b32 v100, 16, v130
v_and_b32 v101, 0xffff0000, v130
v_lshlrev_b32 v102, 16, v131
v_and_b32 v103, 0xffff0000, v131
v_lshlrev_b32 v104, 16, v132
v_and_b32 v105, 0xffff0000, v132
v_lshlrev_b32 v106, 16, v133
v_and_b32 v107, 0xffff0000, v133
v_lshlrev_b32 v108, 16, v134
v_and_b32 v109, 0xffff0000, v134
v_lshlrev_b32 v110, 16, v135
v_and_b32 v111, 0xffff0000, v135
v_lshlrev_b32 v112, 16, v136
v_and_b32 v113, 0xffff0000, v136
v_lshlrev_b32 v114, 16, v137
v_and_b32 v115, 0xffff0000, v137
v_lshlrev_b32 v116, 16, v138
v_and_b32 v117, 0xffff0000, v138
v_lshlrev_b32 v118, 16, v139
v_and_b32 v119, 0xffff0000, v139
v_lshlrev_b32 v120, 16, v140
v_and_b32 v121, 0xffff0000, v140
v_lshlrev_b32 v122, 16, v141
v_and_b32 v123, 0xffff0000, v141
v_lshlrev_b32 v124, 16, v142
v_and_b32 v125, 0xffff0000, v142
v_lshlrev_b32 v126, 16, v143
v_and_b32 v127, 0xffff0000, v143
s_bitcmp0_b32 s36, 1
s_cselect_b32 s44, s72, s74
s_cselect_b32 s45, s73, s75
s_mul_i32 s43, s35, 192
s_add_u32 s16, s44, s43
s_addc_u32 s17, s45, 0
s_add_u32 s16, s16, 4096
s_addc_u32 s17, s17, 0
s_mov_b32 s18, 7333056
s_mov_b32 s19, 0x20000
v_add_u32 v196, 0, v1
v_mul_u32_u24 v197, 5462, v196
v_lshrrev_b32 v197, 16, v197
v_mul_u32_u24 v198, 12, v197
v_sub_u32 v198, v196, v198
v_bfe_u32 v199, v197, 2, 1
v_cmp_gt_u32 vcc, 8, v198
v_lshlrev_b32 v200, 1, v199
v_mul_u32_u24 v197, 7168, v197
v_cndmask_b32 v199, v199, v200, vcc
v_xor_b32 v198, v198, v199
v_lshl_add_u32 v192, v198, 4, v197
v_add_u32 v196, 64, v1
v_mul_u32_u24 v197, 5462, v196
v_lshrrev_b32 v197, 16, v197
v_mul_u32_u24 v198, 12, v197
v_sub_u32 v198, v196, v198
v_bfe_u32 v199, v197, 2, 1
v_cmp_gt_u32 vcc, 8, v198
v_lshlrev_b32 v200, 1, v199
v_mul_u32_u24 v197, 7168, v197
v_cndmask_b32 v199, v199, v200, vcc
v_xor_b32 v198, v198, v199
v_lshl_add_u32 v193, v198, 4, v197
v_add_u32 v196, 128, v1
v_mul_u32_u24 v197, 5462, v196
v_lshrrev_b32 v197, 16, v197
v_mul_u32_u24 v198, 12, v197
v_sub_u32 v198, v196, v198
v_bfe_u32 v199, v197, 2, 1
v_cmp_gt_u32 vcc, 8, v198
v_lshlrev_b32 v200, 1, v199
v_mul_u32_u24 v197, 7168, v197
v_cndmask_b32 v199, v199, v200, vcc
v_xor_b32 v198, v198, v199
v_lshl_add_u32 v194, v198, 4, v197
s_and_b32 s43, s36, 1
s_mul_i32 s43, s43, 229376
v_add_u32 v192, s43, v192
v_add_u32 v193, s43, v193
v_add_u32 v194, s43, v194
s_and_b32 s43, s36, 3
s_mul_i32 s50, s43, 6144
s_add_u32 s50, s50, 16384
s_bitcmp0_b32 s2, 0
s_cselect_b32 s88, s72, s74
s_cselect_b32 s89, s73, s75
s_mov_b32 s90, 7340032
s_mov_b32 s91, 0x20000
s_bfe_u32 s44, s2, 0x30001
s_lshl_b32 s44, s44, 2
s_and_b32 s43, s36, 3
s_add_u32 s44, s44, s43
s_lshl_b32 s44, s44, 5
v_lshrrev_b32 v195, 4, v1
v_add_u32 v195, s44, v195
v_mul_u32_u24 v195, 7168, v195
v_and_b32 v196, 15, v1
v_lshl_add_u32 v195, v196, 4, v195
s_lshr_b32 s43, s2, 4
s_lshl_b32 s43, s43, 8
v_add_u32 v195, s43, v195
s_cmp_lg_u32 s36, 0
s_cbranch_scc1 Lwm_81
s_nop 0
s_branch Lwe_80
Lwm_81:
s_cmp_lg_u32 s36, 1
s_cbranch_scc1 Lwm_82
s_nop 0
s_branch Lwe_80
Lwm_82:
s_cmp_lg_u32 s36, 2
s_cbranch_scc1 Lwm_83
s_nop 0
s_branch Lwe_80
Lwm_83:
s_cmp_lg_u32 s36, 3
s_cbranch_scc1 Lwm_84
s_nop 0
s_branch Lwe_80
Lwm_84:
Lwe_80:
s_barrier
ds_read_b128 v[32:35], v2 offset:0
ds_read_b64_tr_b16 v[40:41], v16 offset:0
ds_read_b64_tr_b16 v[42:43], v16 offset:2048
ds_read_b64_tr_b16 v[44:45], v17 offset:0
ds_read_b64_tr_b16 v[46:47], v17 offset:2048
ds_read_b64_tr_b16 v[48:49], v18 offset:0
ds_read_b64_tr_b16 v[50:51], v18 offset:2048
s_branch Lov_5
.p2align 12
Lst_5_0:
s_branch Lwr_145
s_nop 0
s_nop 0
Lov_5:
ds_read_b64_tr_b16 v[52:53], v19 offset:0
ds_read_b64_tr_b16 v[54:55], v19 offset:2048
ds_read_b128 v[36:39], v2 offset:1024
ds_read_b128 v[56:59], v2 offset:8192
ds_read_b64_tr_b16 v[64:65], v16 offset:4096
ds_read_b64_tr_b16 v[66:67], v16 offset:6144
ds_read_b64_tr_b16 v[68:69], v17 offset:4096
ds_read_b64_tr_b16 v[70:71], v17 offset:6144
ds_read_b64_tr_b16 v[72:73], v18 offset:4096
ds_read_b64_tr_b16 v[74:75], v18 offset:6144
ds_read_b64_tr_b16 v[76:77], v19 offset:4096
ds_read_b64_tr_b16 v[78:79], v19 offset:6144
ds_read_b128 v[60:63], v2 offset:9216
s_waitcnt lgkmcnt(0)
s_barrier
v_mfma_f32_16x16x32_bf16 v[96:99], v[40:43], v[32:35], v[96:99]
ds_read_b128 v[144:147], v2 offset:49152
ds_read_b64_tr_b16 v[152:153], v16 offset:8192
v_mfma_f32_16x16x32_bf16 v[100:103], v[44:47], v[32:35], v[100:103]
ds_read_b64_tr_b16 v[154:155], v16 offset:10240
ds_read_b64_tr_b16 v[156:157], v17 offset:8192
v_mfma_f32_16x16x32_bf16 v[104:107], v[48:51], v[32:35], v[104:107]
ds_read_b64_tr_b16 v[158:159], v17 offset:10240
ds_read_b64_tr_b16 v[160:161], v18 offset:8192
v_mfma_f32_16x16x32_bf16 v[108:111], v[52:55], v[32:35], v[108:111]
ds_read_b64_tr_b16 v[162:163], v18 offset:10240
ds_read_b64_tr_b16 v[164:165], v19 offset:8192
v_mfma_f32_16x16x32_bf16 v[124:127], v[52:55], v[36:39], v[124:127]
ds_read_b64_tr_b16 v[166:167], v19 offset:10240
ds_read_b128 v[148:151], v2 offset:50176
v_mfma_f32_16x16x32_bf16 v[120:123], v[48:51], v[36:39], v[120:123]
ds_read_b128 v[168:171], v2 offset:57344
ds_read_b64_tr_b16 v[176:177], v16 offset:12288
v_mfma_f32_16x16x32_bf16 v[116:119], v[44:47], v[36:39], v[116:119]
ds_read_b64_tr_b16 v[178:179], v16 offset:14336
ds_read_b64_tr_b16 v[180:181], v17 offset:12288
v_mfma_f32_16x16x32_bf16 v[112:115], v[40:43], v[36:39], v[112:115]
ds_read_b64_tr_b16 v[182:183], v17 offset:14336
ds_read_b64_tr_b16 v[184:185], v18 offset:12288
v_mfma_f32_16x16x32_bf16 v[96:99], v[64:67], v[56:59], v[96:99]
ds_read_b64_tr_b16 v[186:187], v18 offset:14336
ds_read_b64_tr_b16 v[188:189], v19 offset:12288
v_mfma_f32_16x16x32_bf16 v[100:103], v[68:71], v[56:59], v[100:103]
ds_read_b64_tr_b16 v[190:191], v19 offset:14336
ds_read_b128 v[172:175], v2 offset:58368
v_mfma_f32_16x16x32_bf16 v[104:107], v[72:75], v[56:59], v[104:107]
v_mfma_f32_16x16x32_bf16 v[108:111], v[76:79], v[56:59], v[108:111]
v_mfma_f32_16x16x32_bf16 v[124:127], v[76:79], v[60:63], v[124:127]
v_mfma_f32_16x16x32_bf16 v[120:123], v[72:75], v[60:63], v[120:123]
v_mfma_f32_16x16x32_bf16 v[116:119], v[68:71], v[60:63], v[116:119]
v_mfma_f32_16x16x32_bf16 v[112:115], v[64:67], v[60:63], v[112:115]
s_waitcnt lgkmcnt(0)
s_barrier
v_mfma_f32_16x16x32_bf16 v[96:99], v[152:155], v[144:147], v[96:99]
ds_read_b128 v[32:35], v3 offset:0
ds_read_b64_tr_b16 v[40:41], v16 offset:16384
v_mfma_f32_16x16x32_bf16 v[100:103], v[156:159], v[144:147], v[100:103]
ds_read_b64_tr_b16 v[42:43], v16 offset:18432
ds_read_b64_tr_b16 v[44:45], v17 offset:16384
v_mfma_f32_16x16x32_bf16 v[104:107], v[160:163], v[144:147], v[104:107]
ds_read_b64_tr_b16 v[46:47], v17 offset:18432
ds_read_b64_tr_b16 v[48:49], v18 offset:16384
v_mfma_f32_16x16x32_bf16 v[108:111], v[164:167], v[144:147], v[108:111]
ds_read_b64_tr_b16 v[50:51], v18 offset:18432
ds_read_b64_tr_b16 v[52:53], v19 offset:16384
v_mfma_f32_16x16x32_bf16 v[124:127], v[164:167], v[148:151], v[124:127]
ds_read_b64_tr_b16 v[54:55], v19 offset:18432
ds_read_b128 v[36:39], v3 offset:1024
v_mfma_f32_16x16x32_bf16 v[120:123], v[160:163], v[148:151], v[120:123]
ds_read_b128 v[56:59], v3 offset:8192
ds_read_b64_tr_b16 v[64:65], v16 offset:20480
v_mfma_f32_16x16x32_bf16 v[116:119], v[156:159], v[148:151], v[116:119]
ds_read_b64_tr_b16 v[66:67], v16 offset:22528
ds_read_b64_tr_b16 v[68:69], v17 offset:20480
v_mfma_f32_16x16x32_bf16 v[112:115], v[152:155], v[148:151], v[112:115]
ds_read_b64_tr_b16 v[70:71], v17 offset:22528
ds_read_b64_tr_b16 v[72:73], v18 offset:20480
v_mfma_f32_16x16x32_bf16 v[96:99], v[176:179], v[168:171], v[96:99]
ds_read_b64_tr_b16 v[74:75], v18 offset:22528
ds_read_b64_tr_b16 v[76:77], v19 offset:20480
v_mfma_f32_16x16x32_bf16 v[100:103], v[180:183], v[168:171], v[100:103]
ds_read_b64_tr_b16 v[78:79], v19 offset:22528
ds_read_b128 v[60:63], v3 offset:9216
v_mfma_f32_16x16x32_bf16 v[104:107], v[184:187], v[168:171], v[104:107]
v_mfma_f32_16x16x32_bf16 v[108:111], v[188:191], v[168:171], v[108:111]
v_mfma_f32_16x16x32_bf16 v[124:127], v[188:191], v[172:175], v[124:127]
v_mfma_f32_16x16x32_bf16 v[120:123], v[184:187], v[172:175], v[120:123]
v_mfma_f32_16x16x32_bf16 v[116:119], v[180:183], v[172:175], v[116:119]
v_mfma_f32_16x16x32_bf16 v[112:115], v[176:179], v[172:175], v[112:115]
s_waitcnt lgkmcnt(0)
s_barrier
v_mfma_f32_16x16x32_bf16 v[96:99], v[40:43], v[32:35], v[96:99]
ds_read_b128 v[144:147], v3 offset:49152
ds_read_b64_tr_b16 v[152:153], v16 offset:24576
v_mfma_f32_16x16x32_bf16 v[100:103], v[44:47], v[32:35], v[100:103]
ds_read_b64_tr_b16 v[154:155], v16 offset:26624
ds_read_b64_tr_b16 v[156:157], v17 offset:24576
v_mfma_f32_16x16x32_bf16 v[104:107], v[48:51], v[32:35], v[104:107]
ds_read_b64_tr_b16 v[158:159], v17 offset:26624
ds_read_b64_tr_b16 v[160:161], v18 offset:24576
v_mfma_f32_16x16x32_bf16 v[108:111], v[52:55], v[32:35], v[108:111]
ds_read_b64_tr_b16 v[162:163], v18 offset:26624
ds_read_b64_tr_b16 v[164:165], v19 offset:24576
v_mfma_f32_16x16x32_bf16 v[124:127], v[52:55], v[36:39], v[124:127]
ds_read_b64_tr_b16 v[166:167], v19 offset:26624
ds_read_b128 v[148:151], v3 offset:50176
v_mfma_f32_16x16x32_bf16 v[120:123], v[48:51], v[36:39], v[120:123]
ds_read_b128 v[168:171], v3 offset:57344
ds_read_b64_tr_b16 v[176:177], v16 offset:28672
v_mfma_f32_16x16x32_bf16 v[116:119], v[44:47], v[36:39], v[116:119]
ds_read_b64_tr_b16 v[178:179], v16 offset:30720
ds_read_b64_tr_b16 v[180:181], v17 offset:28672
v_mfma_f32_16x16x32_bf16 v[112:115], v[40:43], v[36:39], v[112:115]
ds_read_b64_tr_b16 v[182:183], v17 offset:30720
ds_read_b64_tr_b16 v[184:185], v18 offset:28672
v_mfma_f32_16x16x32_bf16 v[96:99], v[64:67], v[56:59], v[96:99]
ds_read_b64_tr_b16 v[186:187], v18 offset:30720
ds_read_b64_tr_b16 v[188:189], v19 offset:28672
v_mfma_f32_16x16x32_bf16 v[100:103], v[68:71], v[56:59], v[100:103]
ds_read_b64_tr_b16 v[190:191], v19 offset:30720
ds_read_b128 v[172:175], v3 offset:58368
v_mfma_f32_16x16x32_bf16 v[104:107], v[72:75], v[56:59], v[104:107]
v_mfma_f32_16x16x32_bf16 v[108:111], v[76:79], v[56:59], v[108:111]
v_mfma_f32_16x16x32_bf16 v[124:127], v[76:79], v[60:63], v[124:127]
v_mfma_f32_16x16x32_bf16 v[120:123], v[72:75], v[60:63], v[120:123]
v_mfma_f32_16x16x32_bf16 v[116:119], v[68:71], v[60:63], v[116:119]
v_mfma_f32_16x16x32_bf16 v[112:115], v[64:67], v[60:63], v[112:115]
s_waitcnt lgkmcnt(0)
s_barrier
v_mfma_f32_16x16x32_bf16 v[96:99], v[152:155], v[144:147], v[96:99]
ds_read_b128 v[32:35], v2 offset:0
ds_read_b64_tr_b16 v[40:41], v16 offset:49152
v_mfma_f32_16x16x32_bf16 v[100:103], v[156:159], v[144:147], v[100:103]
ds_read_b64_tr_b16 v[42:43], v16 offset:51200
ds_read_b64_tr_b16 v[44:45], v17 offset:49152
v_mfma_f32_16x16x32_bf16 v[104:107], v[160:163], v[144:147], v[104:107]
ds_read_b64_tr_b16 v[46:47], v17 offset:51200
ds_read_b64_tr_b16 v[48:49], v18 offset:49152
v_mfma_f32_16x16x32_bf16 v[108:111], v[164:167], v[144:147], v[108:111]
ds_read_b64_tr_b16 v[50:51], v18 offset:51200
ds_read_b64_tr_b16 v[52:53], v19 offset:49152
v_mfma_f32_16x16x32_bf16 v[124:127], v[164:167], v[148:151], v[124:127]
ds_read_b64_tr_b16 v[54:55], v19 offset:51200
ds_read_b128 v[36:39], v2 offset:1024
v_mfma_f32_16x16x32_bf16 v[120:123], v[160:163], v[148:151], v[120:123]
ds_read_b128 v[56:59], v2 offset:8192
ds_read_b64_tr_b16 v[64:65], v16 offset:53248
v_mfma_f32_16x16x32_bf16 v[116:119], v[156:159], v[148:151], v[116:119]
ds_read_b64_tr_b16 v[66:67], v16 offset:55296
ds_read_b64_tr_b16 v[68:69], v17 offset:53248
v_mfma_f32_16x16x32_bf16 v[112:115], v[152:155], v[148:151], v[112:115]
ds_read_b64_tr_b16 v[70:71], v17 offset:55296
ds_read_b64_tr_b16 v[72:73], v18 offset:53248
v_mfma_f32_16x16x32_bf16 v[96:99], v[176:179], v[168:171], v[96:99]
ds_read_b64_tr_b16 v[74:75], v18 offset:55296
ds_read_b64_tr_b16 v[76:77], v19 offset:53248
v_mfma_f32_16x16x32_bf16 v[100:103], v[180:183], v[168:171], v[100:103]
ds_read_b64_tr_b16 v[78:79], v19 offset:55296
ds_read_b128 v[60:63], v2 offset:9216
v_mfma_f32_16x16x32_bf16 v[104:107], v[184:187], v[168:171], v[104:107]
v_mfma_f32_16x16x32_bf16 v[108:111], v[188:191], v[168:171], v[108:111]
v_mfma_f32_16x16x32_bf16 v[124:127], v[188:191], v[172:175], v[124:127]
v_mfma_f32_16x16x32_bf16 v[120:123], v[184:187], v[172:175], v[120:123]
v_mfma_f32_16x16x32_bf16 v[116:119], v[180:183], v[172:175], v[116:119]
v_mfma_f32_16x16x32_bf16 v[112:115], v[176:179], v[172:175], v[112:115]
s_waitcnt lgkmcnt(0)
s_barrier
v_mfma_f32_16x16x32_bf16 v[96:99], v[40:43], v[32:35], v[96:99]
ds_read_b128 v[144:147], v2 offset:49152
ds_read_b64_tr_b16 v[152:153], v16 offset:57344
v_mfma_f32_16x16x32_bf16 v[100:103], v[44:47], v[32:35], v[100:103]
ds_read_b64_tr_b16 v[154:155], v16 offset:59392
ds_read_b64_tr_b16 v[156:157], v17 offset:57344
v_mfma_f32_16x16x32_bf16 v[104:107], v[48:51], v[32:35], v[104:107]
ds_read_b64_tr_b16 v[158:159], v17 offset:59392
ds_read_b64_tr_b16 v[160:161], v18 offset:57344
v_mfma_f32_16x16x32_bf16 v[108:111], v[52:55], v[32:35], v[108:111]
ds_read_b64_tr_b16 v[162:163], v18 offset:59392
ds_read_b64_tr_b16 v[164:165], v19 offset:57344
v_mfma_f32_16x16x32_bf16 v[124:127], v[52:55], v[36:39], v[124:127]
ds_read_b64_tr_b16 v[166:167], v19 offset:59392
ds_read_b128 v[148:151], v2 offset:50176
v_mfma_f32_16x16x32_bf16 v[120:123], v[48:51], v[36:39], v[120:123]
ds_read_b128 v[168:171], v2 offset:57344
ds_read_b64_tr_b16 v[176:177], v16 offset:61440
v_mfma_f32_16x16x32_bf16 v[116:119], v[44:47], v[36:39], v[116:119]
ds_read_b64_tr_b16 v[178:179], v16 offset:63488
ds_read_b64_tr_b16 v[180:181], v17 offset:61440
v_mfma_f32_16x16x32_bf16 v[112:115], v[40:43], v[36:39], v[112:115]
ds_read_b64_tr_b16 v[182:183], v17 offset:63488
ds_read_b64_tr_b16 v[184:185], v18 offset:61440
v_mfma_f32_16x16x32_bf16 v[96:99], v[64:67], v[56:59], v[96:99]
ds_read_b64_tr_b16 v[186:187], v18 offset:63488
ds_read_b64_tr_b16 v[188:189], v19 offset:61440
v_mfma_f32_16x16x32_bf16 v[100:103], v[68:71], v[56:59], v[100:103]
ds_read_b64_tr_b16 v[190:191], v19 offset:63488
ds_read_b128 v[172:175], v2 offset:58368
v_mfma_f32_16x16x32_bf16 v[104:107], v[72:75], v[56:59], v[104:107]
v_mfma_f32_16x16x32_bf16 v[108:111], v[76:79], v[56:59], v[108:111]
v_mfma_f32_16x16x32_bf16 v[124:127], v[76:79], v[60:63], v[124:127]
v_mfma_f32_16x16x32_bf16 v[120:123], v[72:75], v[60:63], v[120:123]
v_mfma_f32_16x16x32_bf16 v[116:119], v[68:71], v[60:63], v[116:119]
v_mfma_f32_16x16x32_bf16 v[112:115], v[64:67], v[60:63], v[112:115]
s_waitcnt lgkmcnt(0)
s_barrier
v_mfma_f32_16x16x32_bf16 v[96:99], v[152:155], v[144:147], v[96:99]
ds_read_b128 v[32:35], v3 offset:0
ds_read_b64_tr_b16 v[40:41], v20 offset:0
v_mfma_f32_16x16x32_bf16 v[100:103], v[156:159], v[144:147], v[100:103]
ds_read_b64_tr_b16 v[42:43], v20 offset:2048
ds_read_b64_tr_b16 v[44:45], v21 offset:0
v_mfma_f32_16x16x32_bf16 v[104:107], v[160:163], v[144:147], v[104:107]
ds_read_b64_tr_b16 v[46:47], v21 offset:2048
ds_read_b64_tr_b16 v[48:49], v22 offset:0
v_mfma_f32_16x16x32_bf16 v[108:111], v[164:167], v[144:147], v[108:111]
ds_read_b64_tr_b16 v[50:51], v22 offset:2048
ds_read_b64_tr_b16 v[52:53], v23 offset:0
v_mfma_f32_16x16x32_bf16 v[124:127], v[164:167], v[148:151], v[124:127]
ds_read_b64_tr_b16 v[54:55], v23 offset:2048
ds_read_b128 v[36:39], v3 offset:1024
v_mfma_f32_16x16x32_bf16 v[120:123], v[160:163], v[148:151], v[120:123]
ds_read_b128 v[56:59], v3 offset:8192
ds_read_b64_tr_b16 v[64:65], v20 offset:4096
v_mfma_f32_16x16x32_bf16 v[116:119], v[156:159], v[148:151], v[116:119]
ds_read_b64_tr_b16 v[66:67], v20 offset:6144
ds_read_b64_tr_b16 v[68:69], v21 offset:4096
v_mfma_f32_16x16x32_bf16 v[112:115], v[152:155], v[148:151], v[112:115]
ds_read_b64_tr_b16 v[70:71], v21 offset:6144
ds_read_b64_tr_b16 v[72:73], v22 offset:4096
v_mfma_f32_16x16x32_bf16 v[96:99], v[176:179], v[168:171], v[96:99]
ds_read_b64_tr_b16 v[74:75], v22 offset:6144
ds_read_b64_tr_b16 v[76:77], v23 offset:4096
v_mfma_f32_16x16x32_bf16 v[100:103], v[180:183], v[168:171], v[100:103]
ds_read_b64_tr_b16 v[78:79], v23 offset:6144
ds_read_b128 v[60:63], v3 offset:9216
v_mfma_f32_16x16x32_bf16 v[104:107], v[184:187], v[168:171], v[104:107]
v_mfma_f32_16x16x32_bf16 v[108:111], v[188:191], v[168:171], v[108:111]
v_mfma_f32_16x16x32_bf16 v[124:127], v[188:191], v[172:175], v[124:127]
v_mfma_f32_16x16x32_bf16 v[120:123], v[184:187], v[172:175], v[120:123]
v_mfma_f32_16x16x32_bf16 v[116:119], v[180:183], v[172:175], v[116:119]
v_mfma_f32_16x16x32_bf16 v[112:115], v[176:179], v[172:175], v[112:115]
s_waitcnt lgkmcnt(0)
s_barrier
v_mfma_f32_16x16x32_bf16 v[96:99], v[40:43], v[32:35], v[96:99]
ds_read_b128 v[144:147], v3 offset:49152
ds_read_b64_tr_b16 v[152:153], v20 offset:8192
v_mfma_f32_16x16x32_bf16 v[100:103], v[44:47], v[32:35], v[100:103]
ds_read_b64_tr_b16 v[154:155], v20 offset:10240
ds_read_b64_tr_b16 v[156:157], v21 offset:8192
v_mfma_f32_16x16x32_bf16 v[104:107], v[48:51], v[32:35], v[104:107]
ds_read_b64_tr_b16 v[158:159], v21 offset:10240
ds_read_b64_tr_b16 v[160:161], v22 offset:8192
v_mfma_f32_16x16x32_bf16 v[108:111], v[52:55], v[32:35], v[108:111]
ds_read_b64_tr_b16 v[162:163], v22 offset:10240
ds_read_b64_tr_b16 v[164:165], v23 offset:8192
v_mfma_f32_16x16x32_bf16 v[124:127], v[52:55], v[36:39], v[124:127]
ds_read_b64_tr_b16 v[166:167], v23 offset:10240
ds_read_b128 v[148:151], v3 offset:50176
v_mfma_f32_16x16x32_bf16 v[120:123], v[48:51], v[36:39], v[120:123]
ds_read_b128 v[168:171], v3 offset:57344
ds_read_b64_tr_b16 v[176:177], v20 offset:12288
v_mfma_f32_16x16x32_bf16 v[116:119], v[44:47], v[36:39], v[116:119]
ds_read_b64_tr_b16 v[178:179], v20 offset:14336
ds_read_b64_tr_b16 v[180:181], v21 offset:12288
v_mfma_f32_16x16x32_bf16 v[112:115], v[40:43], v[36:39], v[112:115]
ds_read_b64_tr_b16 v[182:183], v21 offset:14336
ds_read_b64_tr_b16 v[184:185], v22 offset:12288
v_mfma_f32_16x16x32_bf16 v[96:99], v[64:67], v[56:59], v[96:99]
ds_read_b64_tr_b16 v[186:187], v22 offset:14336
ds_read_b64_tr_b16 v[188:189], v23 offset:12288
v_mfma_f32_16x16x32_bf16 v[100:103], v[68:71], v[56:59], v[100:103]
ds_read_b64_tr_b16 v[190:191], v23 offset:14336
ds_read_b128 v[172:175], v3 offset:58368
v_mfma_f32_16x16x32_bf16 v[104:107], v[72:75], v[56:59], v[104:107]
v_mfma_f32_16x16x32_bf16 v[108:111], v[76:79], v[56:59], v[108:111]
v_mfma_f32_16x16x32_bf16 v[124:127], v[76:79], v[60:63], v[124:127]
v_mfma_f32_16x16x32_bf16 v[120:123], v[72:75], v[60:63], v[120:123]
v_mfma_f32_16x16x32_bf16 v[116:119], v[68:71], v[60:63], v[116:119]
v_mfma_f32_16x16x32_bf16 v[112:115], v[64:67], v[60:63], v[112:115]
s_waitcnt lgkmcnt(0)
s_barrier
v_mfma_f32_16x16x32_bf16 v[96:99], v[152:155], v[144:147], v[96:99]
ds_read_b128 v[32:35], v2 offset:0
ds_read_b64_tr_b16 v[40:41], v4 offset:16384
v_mfma_f32_16x16x32_bf16 v[100:103], v[156:159], v[144:147], v[100:103]
ds_read_b64_tr_b16 v[42:43], v4 offset:18432
ds_read_b64_tr_b16 v[44:45], v5 offset:16384
v_mfma_f32_16x16x32_bf16 v[104:107], v[160:163], v[144:147], v[104:107]
ds_read_b64_tr_b16 v[46:47], v5 offset:18432
ds_read_b64_tr_b16 v[48:49], v6 offset:16384
v_mfma_f32_16x16x32_bf16 v[108:111], v[164:167], v[144:147], v[108:111]
ds_read_b64_tr_b16 v[50:51], v6 offset:18432
ds_read_b64_tr_b16 v[52:53], v7 offset:16384
v_mfma_f32_16x16x32_bf16 v[124:127], v[164:167], v[148:151], v[124:127]
ds_read_b64_tr_b16 v[54:55], v7 offset:18432
ds_read_b128 v[36:39], v2 offset:1024
v_mfma_f32_16x16x32_bf16 v[120:123], v[160:163], v[148:151], v[120:123]
ds_read_b128 v[56:59], v2 offset:8192
ds_read_b64_tr_b16 v[64:65], v4 offset:20480
v_mfma_f32_16x16x32_bf16 v[116:119], v[156:159], v[148:151], v[116:119]
ds_read_b64_tr_b16 v[66:67], v4 offset:22528
ds_read_b64_tr_b16 v[68:69], v5 offset:20480
v_mfma_f32_16x16x32_bf16 v[112:115], v[152:155], v[148:151], v[112:115]
ds_read_b64_tr_b16 v[70:71], v5 offset:22528
ds_read_b64_tr_b16 v[72:73], v6 offset:20480
v_mfma_f32_16x16x32_bf16 v[96:99], v[176:179], v[168:171], v[96:99]
ds_read_b64_tr_b16 v[74:75], v6 offset:22528
ds_read_b64_tr_b16 v[76:77], v7 offset:20480
v_mfma_f32_16x16x32_bf16 v[100:103], v[180:183], v[168:171], v[100:103]
ds_read_b64_tr_b16 v[78:79], v7 offset:22528
ds_read_b128 v[60:63], v2 offset:9216
v_mfma_f32_16x16x32_bf16 v[104:107], v[184:187], v[168:171], v[104:107]
v_mfma_f32_16x16x32_bf16 v[108:111], v[188:191], v[168:171], v[108:111]
v_mfma_f32_16x16x32_bf16 v[124:127], v[188:191], v[172:175], v[124:127]
v_mfma_f32_16x16x32_bf16 v[120:123], v[184:187], v[172:175], v[120:123]
v_mfma_f32_16x16x32_bf16 v[116:119], v[180:183], v[172:175], v[116:119]
v_mfma_f32_16x16x32_bf16 v[112:115], v[176:179], v[172:175], v[112:115]
s_waitcnt lgkmcnt(0)
s_barrier
v_mfma_f32_16x16x32_bf16 v[96:99], v[40:43], v[32:35], v[96:99]
ds_read_b128 v[144:147], v2 offset:49152
ds_read_b64_tr_b16 v[152:153], v4 offset:24576
v_mfma_f32_16x16x32_bf16 v[100:103], v[44:47], v[32:35], v[100:103]
ds_read_b64_tr_b16 v[154:155], v4 offset:26624
ds_read_b64_tr_b16 v[156:157], v5 offset:24576
v_mfma_f32_16x16x32_bf16 v[104:107], v[48:51], v[32:35], v[104:107]
ds_read_b64_tr_b16 v[158:159], v5 offset:26624
ds_read_b64_tr_b16 v[160:161], v6 offset:24576
v_mfma_f32_16x16x32_bf16 v[108:111], v[52:55], v[32:35], v[108:111]
ds_read_b64_tr_b16 v[162:163], v6 offset:26624
ds_read_b64_tr_b16 v[164:165], v7 offset:24576
v_mfma_f32_16x16x32_bf16 v[124:127], v[52:55], v[36:39], v[124:127]
ds_read_b64_tr_b16 v[166:167], v7 offset:26624
ds_read_b128 v[148:151], v2 offset:50176
v_mfma_f32_16x16x32_bf16 v[120:123], v[48:51], v[36:39], v[120:123]
ds_read_b128 v[168:171], v2 offset:57344
ds_read_b64_tr_b16 v[176:177], v4 offset:28672
v_mfma_f32_16x16x32_bf16 v[116:119], v[44:47], v[36:39], v[116:119]
ds_read_b64_tr_b16 v[178:179], v4 offset:30720
ds_read_b64_tr_b16 v[180:181], v5 offset:28672
v_mfma_f32_16x16x32_bf16 v[112:115], v[40:43], v[36:39], v[112:115]
ds_read_b64_tr_b16 v[182:183], v5 offset:30720
ds_read_b64_tr_b16 v[184:185], v6 offset:28672
v_mfma_f32_16x16x32_bf16 v[96:99], v[64:67], v[56:59], v[96:99]
ds_read_b64_tr_b16 v[186:187], v6 offset:30720
ds_read_b64_tr_b16 v[188:189], v7 offset:28672
v_mfma_f32_16x16x32_bf16 v[100:103], v[68:71], v[56:59], v[100:103]
ds_read_b64_tr_b16 v[190:191], v7 offset:30720
ds_read_b128 v[172:175], v2 offset:58368
v_mfma_f32_16x16x32_bf16 v[104:107], v[72:75], v[56:59], v[104:107]
v_mfma_f32_16x16x32_bf16 v[108:111], v[76:79], v[56:59], v[108:111]
v_mfma_f32_16x16x32_bf16 v[124:127], v[76:79], v[60:63], v[124:127]
v_mfma_f32_16x16x32_bf16 v[120:123], v[72:75], v[60:63], v[120:123]
v_mfma_f32_16x16x32_bf16 v[116:119], v[68:71], v[60:63], v[116:119]
v_mfma_f32_16x16x32_bf16 v[112:115], v[64:67], v[60:63], v[112:115]
s_waitcnt lgkmcnt(0)
s_barrier
v_mfma_f32_16x16x32_bf16 v[96:99], v[152:155], v[144:147], v[96:99]
ds_read_b128 v[32:35], v3 offset:0
ds_read_b64_tr_b16 v[40:41], v4 offset:32768
v_mfma_f32_16x16x32_bf16 v[100:103], v[156:159], v[144:147], v[100:103]
ds_read_b64_tr_b16 v[42:43], v4 offset:34816
ds_read_b64_tr_b16 v[44:45], v5 offset:32768
v_mfma_f32_16x16x32_bf16 v[104:107], v[160:163], v[144:147], v[104:107]
ds_read_b64_tr_b16 v[46:47], v5 offset:34816
ds_read_b64_tr_b16 v[48:49], v6 offset:32768
v_mfma_f32_16x16x32_bf16 v[108:111], v[164:167], v[144:147], v[108:111]
ds_read_b64_tr_b16 v[50:51], v6 offset:34816
ds_read_b64_tr_b16 v[52:53], v7 offset:32768
v_mfma_f32_16x16x32_bf16 v[124:127], v[164:167], v[148:151], v[124:127]
ds_read_b64_tr_b16 v[54:55], v7 offset:34816
ds_read_b128 v[36:39], v3 offset:1024
v_mfma_f32_16x16x32_bf16 v[120:123], v[160:163], v[148:151], v[120:123]
ds_read_b128 v[56:59], v3 offset:8192
ds_read_b64_tr_b16 v[64:65], v4 offset:36864
v_mfma_f32_16x16x32_bf16 v[116:119], v[156:159], v[148:151], v[116:119]
ds_read_b64_tr_b16 v[66:67], v4 offset:38912
ds_read_b64_tr_b16 v[68:69], v5 offset:36864
v_mfma_f32_16x16x32_bf16 v[112:115], v[152:155], v[148:151], v[112:115]
ds_read_b64_tr_b16 v[70:71], v5 offset:38912
ds_read_b64_tr_b16 v[72:73], v6 offset:36864
v_mfma_f32_16x16x32_bf16 v[96:99], v[176:179], v[168:171], v[96:99]
ds_read_b64_tr_b16 v[74:75], v6 offset:38912
ds_read_b64_tr_b16 v[76:77], v7 offset:36864
v_mfma_f32_16x16x32_bf16 v[100:103], v[180:183], v[168:171], v[100:103]
ds_read_b64_tr_b16 v[78:79], v7 offset:38912
ds_read_b128 v[60:63], v3 offset:9216
v_mfma_f32_16x16x32_bf16 v[104:107], v[184:187], v[168:171], v[104:107]
v_mfma_f32_16x16x32_bf16 v[108:111], v[188:191], v[168:171], v[108:111]
v_mfma_f32_16x16x32_bf16 v[124:127], v[188:191], v[172:175], v[124:127]
v_mfma_f32_16x16x32_bf16 v[120:123], v[184:187], v[172:175], v[120:123]
v_mfma_f32_16x16x32_bf16 v[116:119], v[180:183], v[172:175], v[116:119]
v_mfma_f32_16x16x32_bf16 v[112:115], v[176:179], v[172:175], v[112:115]
s_waitcnt lgkmcnt(0)
s_barrier
v_mfma_f32_16x16x32_bf16 v[96:99], v[40:43], v[32:35], v[96:99]
ds_read_b128 v[144:147], v3 offset:49152
ds_read_b64_tr_b16 v[152:153], v4 offset:40960
v_mfma_f32_16x16x32_bf16 v[100:103], v[44:47], v[32:35], v[100:103]
ds_read_b64_tr_b16 v[154:155], v4 offset:43008
ds_read_b64_tr_b16 v[156:157], v5 offset:40960
v_mfma_f32_16x16x32_bf16 v[104:107], v[48:51], v[32:35], v[104:107]
ds_read_b64_tr_b16 v[158:159], v5 offset:43008
ds_read_b64_tr_b16 v[160:161], v6 offset:40960
v_mfma_f32_16x16x32_bf16 v[108:111], v[52:55], v[32:35], v[108:111]
ds_read_b64_tr_b16 v[162:163], v6 offset:43008
ds_read_b64_tr_b16 v[164:165], v7 offset:40960
v_mfma_f32_16x16x32_bf16 v[124:127], v[52:55], v[36:39], v[124:127]
ds_read_b64_tr_b16 v[166:167], v7 offset:43008
ds_read_b128 v[148:151], v3 offset:50176
v_mfma_f32_16x16x32_bf16 v[120:123], v[48:51], v[36:39], v[120:123]
ds_read_b128 v[168:171], v3 offset:57344
ds_read_b64_tr_b16 v[176:177], v4 offset:45056
v_mfma_f32_16x16x32_bf16 v[116:119], v[44:47], v[36:39], v[116:119]
ds_read_b64_tr_b16 v[178:179], v4 offset:47104
ds_read_b64_tr_b16 v[180:181], v5 offset:45056
v_mfma_f32_16x16x32_bf16 v[112:115], v[40:43], v[36:39], v[112:115]
ds_read_b64_tr_b16 v[182:183], v5 offset:47104
ds_read_b64_tr_b16 v[184:185], v6 offset:45056
v_mfma_f32_16x16x32_bf16 v[96:99], v[64:67], v[56:59], v[96:99]
ds_read_b64_tr_b16 v[186:187], v6 offset:47104
ds_read_b64_tr_b16 v[188:189], v7 offset:45056
v_mfma_f32_16x16x32_bf16 v[100:103], v[68:71], v[56:59], v[100:103]
ds_read_b64_tr_b16 v[190:191], v7 offset:47104
ds_read_b128 v[172:175], v3 offset:58368
v_mfma_f32_16x16x32_bf16 v[104:107], v[72:75], v[56:59], v[104:107]
v_mfma_f32_16x16x32_bf16 v[108:111], v[76:79], v[56:59], v[108:111]
v_mfma_f32_16x16x32_bf16 v[124:127], v[76:79], v[60:63], v[124:127]
v_mfma_f32_16x16x32_bf16 v[120:123], v[72:75], v[60:63], v[120:123]
v_mfma_f32_16x16x32_bf16 v[116:119], v[68:71], v[60:63], v[116:119]
v_mfma_f32_16x16x32_bf16 v[112:115], v[64:67], v[60:63], v[112:115]
s_waitcnt lgkmcnt(0)
s_barrier
v_mfma_f32_16x16x32_bf16 v[96:99], v[152:155], v[144:147], v[96:99]
ds_read_b128 v[32:35], v2 offset:0
ds_read_b64_tr_b16 v[40:41], v16 offset:49152
v_mfma_f32_16x16x32_bf16 v[100:103], v[156:159], v[144:147], v[100:103]
ds_read_b64_tr_b16 v[42:43], v16 offset:51200
ds_read_b64_tr_b16 v[44:45], v17 offset:49152
v_mfma_f32_16x16x32_bf16 v[104:107], v[160:163], v[144:147], v[104:107]
ds_read_b64_tr_b16 v[46:47], v17 offset:51200
ds_read_b64_tr_b16 v[48:49], v18 offset:49152
v_mfma_f32_16x16x32_bf16 v[108:111], v[164:167], v[144:147], v[108:111]
ds_read_b64_tr_b16 v[50:51], v18 offset:51200
ds_read_b64_tr_b16 v[52:53], v19 offset:49152
v_mfma_f32_16x16x32_bf16 v[124:127], v[164:167], v[148:151], v[124:127]
ds_read_b64_tr_b16 v[54:55], v19 offset:51200
ds_read_b128 v[36:39], v2 offset:1024
v_mfma_f32_16x16x32_bf16 v[120:123], v[160:163], v[148:151], v[120:123]
ds_read_b128 v[56:59], v2 offset:8192
ds_read_b64_tr_b16 v[64:65], v16 offset:53248
v_mfma_f32_16x16x32_bf16 v[116:119], v[156:159], v[148:151], v[116:119]
ds_read_b64_tr_b16 v[66:67], v16 offset:55296
ds_read_b64_tr_b16 v[68:69], v17 offset:53248
v_mfma_f32_16x16x32_bf16 v[112:115], v[152:155], v[148:151], v[112:115]
ds_read_b64_tr_b16 v[70:71], v17 offset:55296
ds_read_b64_tr_b16 v[72:73], v18 offset:53248
v_mfma_f32_16x16x32_bf16 v[96:99], v[176:179], v[168:171], v[96:99]
ds_read_b64_tr_b16 v[74:75], v18 offset:55296
ds_read_b64_tr_b16 v[76:77], v19 offset:53248
v_mfma_f32_16x16x32_bf16 v[100:103], v[180:183], v[168:171], v[100:103]
ds_read_b64_tr_b16 v[78:79], v19 offset:55296
ds_read_b128 v[60:63], v2 offset:9216
v_mfma_f32_16x16x32_bf16 v[104:107], v[184:187], v[168:171], v[104:107]
v_mfma_f32_16x16x32_bf16 v[108:111], v[188:191], v[168:171], v[108:111]
v_mfma_f32_16x16x32_bf16 v[124:127], v[188:191], v[172:175], v[124:127]
v_mfma_f32_16x16x32_bf16 v[120:123], v[184:187], v[172:175], v[120:123]
v_mfma_f32_16x16x32_bf16 v[116:119], v[180:183], v[172:175], v[116:119]
v_mfma_f32_16x16x32_bf16 v[112:115], v[176:179], v[172:175], v[112:115]
s_waitcnt lgkmcnt(0)
s_barrier
v_mfma_f32_16x16x32_bf16 v[96:99], v[40:43], v[32:35], v[96:99]
ds_read_b128 v[144:147], v2 offset:49152
ds_read_b64_tr_b16 v[152:153], v16 offset:57344
v_mfma_f32_16x16x32_bf16 v[100:103], v[44:47], v[32:35], v[100:103]
ds_read_b64_tr_b16 v[154:155], v16 offset:59392
ds_read_b64_tr_b16 v[156:157], v17 offset:57344
v_mfma_f32_16x16x32_bf16 v[104:107], v[48:51], v[32:35], v[104:107]
ds_read_b64_tr_b16 v[158:159], v17 offset:59392
ds_read_b64_tr_b16 v[160:161], v18 offset:57344
v_mfma_f32_16x16x32_bf16 v[108:111], v[52:55], v[32:35], v[108:111]
ds_read_b64_tr_b16 v[162:163], v18 offset:59392
ds_read_b64_tr_b16 v[164:165], v19 offset:57344
v_mfma_f32_16x16x32_bf16 v[124:127], v[52:55], v[36:39], v[124:127]
ds_read_b64_tr_b16 v[166:167], v19 offset:59392
ds_read_b128 v[148:151], v2 offset:50176
v_mfma_f32_16x16x32_bf16 v[120:123], v[48:51], v[36:39], v[120:123]
ds_read_b128 v[168:171], v2 offset:57344
ds_read_b64_tr_b16 v[176:177], v16 offset:61440
v_mfma_f32_16x16x32_bf16 v[116:119], v[44:47], v[36:39], v[116:119]
ds_read_b64_tr_b16 v[178:179], v16 offset:63488
ds_read_b64_tr_b16 v[180:181], v17 offset:61440
v_mfma_f32_16x16x32_bf16 v[112:115], v[40:43], v[36:39], v[112:115]
ds_read_b64_tr_b16 v[182:183], v17 offset:63488
ds_read_b64_tr_b16 v[184:185], v18 offset:61440
v_mfma_f32_16x16x32_bf16 v[96:99], v[64:67], v[56:59], v[96:99]
ds_read_b64_tr_b16 v[186:187], v18 offset:63488
ds_read_b64_tr_b16 v[188:189], v19 offset:61440
v_mfma_f32_16x16x32_bf16 v[100:103], v[68:71], v[56:59], v[100:103]
ds_read_b64_tr_b16 v[190:191], v19 offset:63488
ds_read_b128 v[172:175], v2 offset:58368
v_mfma_f32_16x16x32_bf16 v[104:107], v[72:75], v[56:59], v[104:107]
v_mfma_f32_16x16x32_bf16 v[108:111], v[76:79], v[56:59], v[108:111]
v_mfma_f32_16x16x32_bf16 v[124:127], v[76:79], v[60:63], v[124:127]
v_mfma_f32_16x16x32_bf16 v[120:123], v[72:75], v[60:63], v[120:123]
v_mfma_f32_16x16x32_bf16 v[116:119], v[68:71], v[60:63], v[116:119]
v_mfma_f32_16x16x32_bf16 v[112:115], v[64:67], v[60:63], v[112:115]
s_waitcnt lgkmcnt(0)
s_barrier
v_mfma_f32_16x16x32_bf16 v[96:99], v[152:155], v[144:147], v[96:99]
ds_read_b128 v[32:35], v3 offset:0
ds_read_b64_tr_b16 v[40:41], v20 offset:0
v_mfma_f32_16x16x32_bf16 v[100:103], v[156:159], v[144:147], v[100:103]
ds_read_b64_tr_b16 v[42:43], v20 offset:2048
ds_read_b64_tr_b16 v[44:45], v21 offset:0
v_mfma_f32_16x16x32_bf16 v[104:107], v[160:163], v[144:147], v[104:107]
ds_read_b64_tr_b16 v[46:47], v21 offset:2048
ds_read_b64_tr_b16 v[48:49], v22 offset:0
v_mfma_f32_16x16x32_bf16 v[108:111], v[164:167], v[144:147], v[108:111]
ds_read_b64_tr_b16 v[50:51], v22 offset:2048
ds_read_b64_tr_b16 v[52:53], v23 offset:0
v_mfma_f32_16x16x32_bf16 v[124:127], v[164:167], v[148:151], v[124:127]
ds_read_b64_tr_b16 v[54:55], v23 offset:2048
ds_read_b128 v[36:39], v3 offset:1024
s_branch Lov_6
.p2align 12
Lst_6_0:
s_branch Lwr_146
s_nop 0
s_nop 0
Lov_6:
v_mfma_f32_16x16x32_bf16 v[120:123], v[160:163], v[148:151], v[120:123]
ds_read_b128 v[56:59], v3 offset:8192
ds_read_b64_tr_b16 v[64:65], v20 offset:4096
v_mfma_f32_16x16x32_bf16 v[116:119], v[156:159], v[148:151], v[116:119]
ds_read_b64_tr_b16 v[66:67], v20 offset:6144
ds_read_b64_tr_b16 v[68:69], v21 offset:4096
v_mfma_f32_16x16x32_bf16 v[112:115], v[152:155], v[148:151], v[112:115]
ds_read_b64_tr_b16 v[70:71], v21 offset:6144
ds_read_b64_tr_b16 v[72:73], v22 offset:4096
v_mfma_f32_16x16x32_bf16 v[96:99], v[176:179], v[168:171], v[96:99]
ds_read_b64_tr_b16 v[74:75], v22 offset:6144
ds_read_b64_tr_b16 v[76:77], v23 offset:4096
v_mfma_f32_16x16x32_bf16 v[100:103], v[180:183], v[168:171], v[100:103]
ds_read_b64_tr_b16 v[78:79], v23 offset:6144
ds_read_b128 v[60:63], v3 offset:9216
v_mfma_f32_16x16x32_bf16 v[104:107], v[184:187], v[168:171], v[104:107]
v_mfma_f32_16x16x32_bf16 v[108:111], v[188:191], v[168:171], v[108:111]
v_mfma_f32_16x16x32_bf16 v[124:127], v[188:191], v[172:175], v[124:127]
v_mfma_f32_16x16x32_bf16 v[120:123], v[184:187], v[172:175], v[120:123]
v_mfma_f32_16x16x32_bf16 v[116:119], v[180:183], v[172:175], v[116:119]
v_mfma_f32_16x16x32_bf16 v[112:115], v[176:179], v[172:175], v[112:115]
s_waitcnt lgkmcnt(0)
s_barrier
v_mfma_f32_16x16x32_bf16 v[96:99], v[40:43], v[32:35], v[96:99]
ds_read_b128 v[144:147], v3 offset:49152
ds_read_b64_tr_b16 v[152:153], v20 offset:8192
v_mfma_f32_16x16x32_bf16 v[100:103], v[44:47], v[32:35], v[100:103]
ds_read_b64_tr_b16 v[154:155], v20 offset:10240
ds_read_b64_tr_b16 v[156:157], v21 offset:8192
v_mfma_f32_16x16x32_bf16 v[104:107], v[48:51], v[32:35], v[104:107]
ds_read_b64_tr_b16 v[158:159], v21 offset:10240
ds_read_b64_tr_b16 v[160:161], v22 offset:8192
v_mfma_f32_16x16x32_bf16 v[108:111], v[52:55], v[32:35], v[108:111]
ds_read_b64_tr_b16 v[162:163], v22 offset:10240
ds_read_b64_tr_b16 v[164:165], v23 offset:8192
v_mfma_f32_16x16x32_bf16 v[124:127], v[52:55], v[36:39], v[124:127]
ds_read_b64_tr_b16 v[166:167], v23 offset:10240
ds_read_b128 v[148:151], v3 offset:50176
v_mfma_f32_16x16x32_bf16 v[120:123], v[48:51], v[36:39], v[120:123]
ds_read_b128 v[168:171], v3 offset:57344
ds_read_b64_tr_b16 v[176:177], v20 offset:12288
v_mfma_f32_16x16x32_bf16 v[116:119], v[44:47], v[36:39], v[116:119]
ds_read_b64_tr_b16 v[178:179], v20 offset:14336
ds_read_b64_tr_b16 v[180:181], v21 offset:12288
v_mfma_f32_16x16x32_bf16 v[112:115], v[40:43], v[36:39], v[112:115]
ds_read_b64_tr_b16 v[182:183], v21 offset:14336
ds_read_b64_tr_b16 v[184:185], v22 offset:12288
v_mfma_f32_16x16x32_bf16 v[96:99], v[64:67], v[56:59], v[96:99]
ds_read_b64_tr_b16 v[186:187], v22 offset:14336
ds_read_b64_tr_b16 v[188:189], v23 offset:12288
v_mfma_f32_16x16x32_bf16 v[100:103], v[68:71], v[56:59], v[100:103]
ds_read_b64_tr_b16 v[190:191], v23 offset:14336
ds_read_b128 v[172:175], v3 offset:58368
v_mfma_f32_16x16x32_bf16 v[104:107], v[72:75], v[56:59], v[104:107]
v_mfma_f32_16x16x32_bf16 v[108:111], v[76:79], v[56:59], v[108:111]
v_mfma_f32_16x16x32_bf16 v[124:127], v[76:79], v[60:63], v[124:127]
v_mfma_f32_16x16x32_bf16 v[120:123], v[72:75], v[60:63], v[120:123]
v_mfma_f32_16x16x32_bf16 v[116:119], v[68:71], v[60:63], v[116:119]
v_mfma_f32_16x16x32_bf16 v[112:115], v[64:67], v[60:63], v[112:115]
s_waitcnt lgkmcnt(0)
s_barrier
v_mfma_f32_16x16x32_bf16 v[96:99], v[152:155], v[144:147], v[96:99]
v_mfma_f32_16x16x32_bf16 v[100:103], v[156:159], v[144:147], v[100:103]
v_mfma_f32_16x16x32_bf16 v[104:107], v[160:163], v[144:147], v[104:107]
v_mfma_f32_16x16x32_bf16 v[108:111], v[164:167], v[144:147], v[108:111]
v_mfma_f32_16x16x32_bf16 v[124:127], v[164:167], v[148:151], v[124:127]
v_mfma_f32_16x16x32_bf16 v[120:123], v[160:163], v[148:151], v[120:123]
v_mfma_f32_16x16x32_bf16 v[116:119], v[156:159], v[148:151], v[116:119]
v_mfma_f32_16x16x32_bf16 v[112:115], v[152:155], v[148:151], v[112:115]
v_mfma_f32_16x16x32_bf16 v[96:99], v[176:179], v[168:171], v[96:99]
v_mfma_f32_16x16x32_bf16 v[100:103], v[180:183], v[168:171], v[100:103]
v_mfma_f32_16x16x32_bf16 v[104:107], v[184:187], v[168:171], v[104:107]
v_mfma_f32_16x16x32_bf16 v[108:111], v[188:191], v[168:171], v[108:111]
v_mfma_f32_16x16x32_bf16 v[124:127], v[188:191], v[172:175], v[124:127]
v_mfma_f32_16x16x32_bf16 v[120:123], v[184:187], v[172:175], v[120:123]
v_mfma_f32_16x16x32_bf16 v[116:119], v[180:183], v[172:175], v[116:119]
v_mfma_f32_16x16x32_bf16 v[112:115], v[176:179], v[172:175], v[112:115]
s_nop 3
v_cvt_pk_bf16_f32 v32, v96, v97
v_cvt_pk_bf16_f32 v33, v98, v99
v_cvt_pk_bf16_f32 v34, v100, v101
v_cvt_pk_bf16_f32 v35, v102, v103
s_add_u32 s43, s60, 0
buffer_store_dwordx4 v[32:35], v11, s[20:23], s43 offen offset:0 sc1
v_cvt_pk_bf16_f32 v36, v104, v105
v_cvt_pk_bf16_f32 v37, v106, v107
v_cvt_pk_bf16_f32 v38, v108, v109
v_cvt_pk_bf16_f32 v39, v110, v111
s_add_u32 s43, s60, 8192
buffer_store_dwordx4 v[36:39], v11, s[20:23], s43 offen offset:0 sc1
v_cvt_pk_bf16_f32 v44, v120, v121
v_cvt_pk_bf16_f32 v45, v122, v123
v_cvt_pk_bf16_f32 v46, v124, v125
v_cvt_pk_bf16_f32 v47, v126, v127
s_add_u32 s43, s60, 8192
buffer_store_dwordx4 v[44:47], v11, s[20:23], s43 offen offset:1024 sc1
v_cvt_pk_bf16_f32 v40, v112, v113
v_cvt_pk_bf16_f32 v41, v114, v115
v_cvt_pk_bf16_f32 v42, v116, v117
v_cvt_pk_bf16_f32 v43, v118, v119
s_add_u32 s43, s60, 0
buffer_store_dwordx4 v[40:43], v11, s[20:23], s43 offen offset:1024 sc1
v_mov_b32 v64, 0
v_mov_b32 v65, 0
v_mov_b32 v66, 0
v_mov_b32 v67, 0
v_mov_b32 v68, 0
v_mov_b32 v69, 0
v_mov_b32 v70, 0
v_mov_b32 v71, 0
v_dot2_f32_bf16 v64, v32, s61, v64
v_dot2_f32_bf16 v66, v32, v32, v66
v_dot2_f32_bf16 v68, v40, s61, v68
v_dot2_f32_bf16 v70, v40, v40, v70
v_dot2_f32_bf16 v65, v33, s61, v65
v_dot2_f32_bf16 v67, v33, v33, v67
v_dot2_f32_bf16 v69, v41, s61, v69
v_dot2_f32_bf16 v71, v41, v41, v71
v_dot2_f32_bf16 v64, v34, s61, v64
v_dot2_f32_bf16 v66, v34, v34, v66
v_dot2_f32_bf16 v68, v42, s61, v68
v_dot2_f32_bf16 v70, v42, v42, v70
v_dot2_f32_bf16 v65, v35, s61, v65
v_dot2_f32_bf16 v67, v35, v35, v67
v_dot2_f32_bf16 v69, v43, s61, v69
v_dot2_f32_bf16 v71, v43, v43, v71
v_dot2_f32_bf16 v64, v36, s61, v64
v_dot2_f32_bf16 v66, v36, v36, v66
v_dot2_f32_bf16 v68, v44, s61, v68
v_dot2_f32_bf16 v70, v44, v44, v70
v_dot2_f32_bf16 v65, v37, s61, v65
v_dot2_f32_bf16 v67, v37, v37, v67
v_dot2_f32_bf16 v69, v45, s61, v69
v_dot2_f32_bf16 v71, v45, v45, v71
v_dot2_f32_bf16 v64, v38, s61, v64
v_dot2_f32_bf16 v66, v38, v38, v66
v_dot2_f32_bf16 v68, v46, s61, v68
v_dot2_f32_bf16 v70, v46, v46, v70
v_dot2_f32_bf16 v65, v39, s61, v65
v_dot2_f32_bf16 v67, v39, v39, v67
v_dot2_f32_bf16 v69, v47, s61, v69
v_dot2_f32_bf16 v71, v47, v47, v71
s_nop 2
v_add_f32 v64, v64, v65
v_add_f32 v66, v66, v67
v_add_f32 v68, v68, v69
v_add_f32 v70, v70, v71
s_nop 1
v_permlane32_swap_b32 v64, v68
v_permlane32_swap_b32 v66, v70
v_add_f32 v64, v64, v68
v_add_f32 v66, v66, v70
s_nop 1
v_permlane16_swap_b32 v64, v66
v_add_f32 v64, v64, v66
buffer_store_dword v64, v9, s[24:27], 0 offen sc1
s_waitcnt vmcnt(0)
s_barrier
s_cmp_lg_u32 s36, 0
s_cbranch_scc1 Lk2end_77
s_add_u32 s7, s34, 16
s_lshl_b32 s7, s7, 7
v_mov_b32 v4, s7
v_mov_b32 v5, 1
s_mov_b64 exec, 1
buffer_atomic_add v5, v4, s[56:59], 0 offen sc1
s_mov_b64 exec, -1
s_branch Lk2end_77
Lprod_78:
s_mul_i32 s43, s34, 262144
s_add_u32 s8, s82, s43
s_addc_u32 s9, s83, 0
s_mov_b32 s10, 262144
s_mov_b32 s11, 0x20000
s_lshl_b32 s43, s35, 7
s_add_u32 s12, s68, s43
s_addc_u32 s13, s69, 0
s_mov_b32 s14, 2095232
s_mov_b32 s15, 0x20000
s_and_b32 s47, s36, 3
s_lshl_b32 s39, s47, 12
v_lshlrev_b32 v2, 4, v1
v_add_u32 v2, s39, v2
v_lshrrev_b32 v12, 3, v1
v_and_b32 v13, 6, v12
v_and_b32 v3, 7, v1
v_xor_b32 v3, v3, v13
v_lshlrev_b32 v3, 4, v3
v_mul_u32_u24 v12, 2048, v12
v_add_u32 v3, v3, v12
s_lshl_b32 s43, s47, 15
v_add_u32 v3, s43, v3
s_lshl_b32 s40, s47, 11
s_add_u32 s37, s35, 0
s_and_b32 s37, s37, 15
s_lshl_b32 s37, s37, 14
s_add_u32 m0, s39, 0
s_nop 0
buffer_load_dwordx4 v2, s[8:11], s37 offen offset:0 sc1 lds
buffer_load_dwordx4 v2, s[8:11], s37 offen offset:1024 sc1 lds
buffer_load_dwordx4 v2, s[8:11], s37 offen offset:2048 sc1 lds
buffer_load_dwordx4 v2, s[8:11], s37 offen offset:3072 sc1 lds
s_add_u32 s38, s35, 8
s_and_b32 s38, s38, 15
s_lshl_b32 s38, s38, 17
s_add_u32 m0, s40, 16384
s_nop 0
buffer_load_dwordx4 v3, s[12:15], s38 offen lds
s_add_u32 m0, s40, 17408
s_add_u32 s38, s38, 16384
buffer_load_dwordx4 v3, s[12:15], s38 offen lds
s_add_u32 s38, s35, 9
s_and_b32 s38, s38, 15
s_lshl_b32 s38, s38, 17
s_add_u32 m0, s40, 24576
s_nop 0
buffer_load_dwordx4 v3, s[12:15], s38 offen lds
s_add_u32 m0, s40, 25600
s_add_u32 s38, s38, 16384
buffer_load_dwordx4 v3, s[12:15], s38 offen lds
s_add_u32 s38, s35, 10
s_and_b32 s38, s38, 15
s_lshl_b32 s38, s38, 17
s_add_u32 m0, s40, 32768
s_nop 0
buffer_load_dwordx4 v3, s[12:15], s38 offen lds
s_add_u32 m0, s40, 33792
s_add_u32 s38, s38, 16384
buffer_load_dwordx4 v3, s[12:15], s38 offen lds
s_add_u32 s38, s35, 11
s_and_b32 s38, s38, 15
s_lshl_b32 s38, s38, 17
s_add_u32 m0, s40, 40960
s_nop 0
buffer_load_dwordx4 v3, s[12:15], s38 offen lds
s_add_u32 m0, s40, 41984
s_add_u32 s38, s38, 16384
buffer_load_dwordx4 v3, s[12:15], s38 offen lds
s_bitcmp0_b32 s36, 1
s_cselect_b32 s44, s72, s74
s_cselect_b32 s45, s73, s75
s_mul_i32 s43, s35, 192
s_add_u32 s88, s44, s43
s_addc_u32 s89, s45, 0
s_add_u32 s88, s88, 4096
s_addc_u32 s89, s89, 0
s_mov_b32 s90, 7333056
s_mov_b32 s91, 0x20000
v_add_u32 v11, 0, v1
v_mul_u32_u24 v12, 5462, v11
v_lshrrev_b32 v12, 16, v12
v_mul_u32_u24 v13, 12, v12
v_sub_u32 v13, v11, v13
v_bfe_u32 v14, v12, 2, 1
v_cmp_gt_u32 vcc, 8, v13
v_lshlrev_b32 v15, 1, v14
v_mul_u32_u24 v12, 7168, v12
v_cndmask_b32 v14, v14, v15, vcc
v_xor_b32 v13, v13, v14
v_lshl_add_u32 v8, v13, 4, v12
v_add_u32 v11, 64, v1
v_mul_u32_u24 v12, 5462, v11
v_lshrrev_b32 v12, 16, v12
v_mul_u32_u24 v13, 12, v12
v_sub_u32 v13, v11, v13
v_bfe_u32 v14, v12, 2, 1
v_cmp_gt_u32 vcc, 8, v13
v_lshlrev_b32 v15, 1, v14
v_mul_u32_u24 v12, 7168, v12
v_cndmask_b32 v14, v14, v15, vcc
v_xor_b32 v13, v13, v14
v_lshl_add_u32 v9, v13, 4, v12
v_add_u32 v11, 128, v1
v_mul_u32_u24 v12, 5462, v11
v_lshrrev_b32 v12, 16, v12
v_mul_u32_u24 v13, 12, v12
v_sub_u32 v13, v11, v13
v_bfe_u32 v14, v12, 2, 1
v_cmp_gt_u32 vcc, 8, v13
v_lshlrev_b32 v15, 1, v14
v_mul_u32_u24 v12, 7168, v12
v_cndmask_b32 v14, v14, v15, vcc
v_xor_b32 v13, v13, v14
v_lshl_add_u32 v10, v13, 4, v12
s_and_b32 s43, s36, 1
s_mul_i32 s43, s43, 229376
v_add_u32 v8, s43, v8
v_add_u32 v9, s43, v9
v_add_u32 v10, s43, v10
s_and_b32 s43, s36, 3
s_mul_i32 s46, s43, 6144
s_add_u32 s46, s46, 16384
s_cmp_eq_u32 s47, 3
s_cbranch_scc0 Lw_85
s_lshl_b32 s92, s34, 7
s_add_u32 s92, s92, 28311552
s_mov_b32 s41, 0x40000
Lpoll_86:
s_load_dword s93, s[82:83], s92 glc
Lpchk_88:
s_waitcnt lgkmcnt(0)
s_cmp_eq_u32 s93, 16
s_cbranch_scc1 Lpok_87
s_sub_u32 s41, s41, 1
s_cmp_lg_u32 s41, 0
s_cbranch_scc1 Lpoll_86
Lpok_87:
Lw_85:
s_and_b32 s44, s36, 3
s_mul_i32 s44, s44, 14
s_bfe_u32 s43, s2, 0x30001
s_lshl_b32 s43, s43, 7
s_add_u32 s44, s44, s43
s_add_u32 s44, s44, 72
s_mul_i32 s44, s44, 7168
s_lshr_b32 s43, s2, 4
s_lshl_b32 s43, s43, 8
s_add_u32 s43, s43, s44
s_bitcmp0_b32 s2, 0
s_cselect_b32 s4, s72, s74
s_cselect_b32 s5, s73, s75
s_add_u32 s4, s4, s43
s_addc_u32 s5, s5, 0
s_cmp_eq_u32 s47, 3
s_cbranch_scc1 Lw_89
s_load_dword s3, s[4:5], 0
s_load_dword s3, s[4:5], 64
s_load_dword s3, s[4:5], 128
s_load_dword s3, s[4:5], 192
s_load_dword s3, s[4:5], 7168
s_load_dword s3, s[4:5], 7232
s_load_dword s3, s[4:5], 7296
s_load_dword s3, s[4:5], 7360
s_load_dword s3, s[4:5], 14336
s_load_dword s3, s[4:5], 14400
s_load_dword s3, s[4:5], 14464
s_load_dword s3, s[4:5], 14528
s_load_dword s3, s[4:5], 21504
s_load_dword s3, s[4:5], 21568
Lw_89:
s_waitcnt vmcnt(8)
s_barrier
s_add_u32 s37, s35, 1
s_and_b32 s37, s37, 15
s_lshl_b32 s37, s37, 14
s_add_u32 m0, s39, 49152
s_nop 0
buffer_load_dwordx4 v2, s[8:11], s37 offen offset:0 sc1 lds
buffer_load_dwordx4 v2, s[8:11], s37 offen offset:1024 sc1 lds
buffer_load_dwordx4 v2, s[8:11], s37 offen offset:2048 sc1 lds
buffer_load_dwordx4 v2, s[8:11], s37 offen offset:3072 sc1 lds
s_add_u32 s37, s35, 2
s_and_b32 s37, s37, 15
s_lshl_b32 s37, s37, 14
s_add_u32 m0, s39, 98304
s_nop 0
buffer_load_dwordx4 v2, s[8:11], s37 offen offset:0 sc1 lds
buffer_load_dwordx4 v2, s[8:11], s37 offen offset:1024 sc1 lds
buffer_load_dwordx4 v2, s[8:11], s37 offen offset:2048 sc1 lds
buffer_load_dwordx4 v2, s[8:11], s37 offen offset:3072 sc1 lds
s_add_u32 s37, s35, 3
s_and_b32 s37, s37, 15
s_lshl_b32 s37, s37, 14
s_add_u32 m0, s39, 147456
s_nop 0
buffer_load_dwordx4 v2, s[8:11], s37 offen offset:0 sc1 lds
buffer_load_dwordx4 v2, s[8:11], s37 offen offset:1024 sc1 lds
buffer_load_dwordx4 v2, s[8:11], s37 offen offset:2048 sc1 lds
buffer_load_dwordx4 v2, s[8:11], s37 offen offset:3072 sc1 lds
s_cmp_eq_u32 s47, 3
s_cbranch_scc0 Lw_90
s_load_dword s3, s[4:5], 0
s_load_dword s3, s[4:5], 64
s_load_dword s3, s[4:5], 128
s_load_dword s3, s[4:5], 192
s_load_dword s3, s[4:5], 7168
s_load_dword s3, s[4:5], 7232
s_load_dword s3, s[4:5], 7296
s_load_dword s3, s[4:5], 7360
s_load_dword s3, s[4:5], 14336
s_load_dword s3, s[4:5], 14400
s_load_dword s3, s[4:5], 14464
s_load_dword s3, s[4:5], 14528
s_load_dword s3, s[4:5], 21504
s_load_dword s3, s[4:5], 21568
Lw_90:
s_waitcnt vmcnt(8)
s_barrier
s_add_u32 s37, s35, 4
s_and_b32 s37, s37, 15
s_lshl_b32 s37, s37, 14
s_add_u32 m0, s39, 0
s_nop 0
buffer_load_dwordx4 v2, s[8:11], s37 offen offset:0 sc1 lds
buffer_load_dwordx4 v2, s[8:11], s37 offen offset:1024 sc1 lds
buffer_load_dwordx4 v2, s[8:11], s37 offen offset:2048 sc1 lds
buffer_load_dwordx4 v2, s[8:11], s37 offen offset:3072 sc1 lds
v_lshlrev_b32 v240, 16, v128
v_and_b32 v241, 0xffff0000, v128
v_lshlrev_b32 v242, 16, v129
v_and_b32 v243, 0xffff0000, v129
v_lshlrev_b32 v244, 16, v130
v_and_b32 v245, 0xffff0000, v130
v_lshlrev_b32 v246, 16, v131
v_and_b32 v247, 0xffff0000, v131
s_load_dword s3, s[4:5], 21632
s_load_dword s3, s[4:5], 21696
s_load_dword s3, s[4:5], 28672
s_waitcnt vmcnt(8)
s_barrier
s_add_u32 s37, s35, 5
s_and_b32 s37, s37, 15
s_lshl_b32 s37, s37, 14
s_add_u32 m0, s39, 49152
s_nop 0
buffer_load_dwordx4 v2, s[8:11], s37 offen offset:0 sc1 lds
buffer_load_dwordx4 v2, s[8:11], s37 offen offset:1024 sc1 lds
buffer_load_dwordx4 v2, s[8:11], s37 offen offset:2048 sc1 lds
buffer_load_dwordx4 v2, s[8:11], s37 offen offset:3072 sc1 lds
v_lshlrev_b32 v24, 16, v132
v_and_b32 v25, 0xffff0000, v132
v_lshlrev_b32 v26, 16, v133
v_and_b32 v27, 0xffff0000, v133
v_lshlrev_b32 v28, 16, v134
v_and_b32 v29, 0xffff0000, v134
v_lshlrev_b32 v30, 16, v135
v_and_b32 v31, 0xffff0000, v135
v_add_f32 v240, v240, v24
v_add_f32 v241, v241, v25
v_add_f32 v242, v242, v26
v_add_f32 v243, v243, v27
v_add_f32 v244, v244, v28
v_add_f32 v245, v245, v29
v_add_f32 v246, v246, v30
v_add_f32 v247, v247, v31
s_load_dword s3, s[4:5], 28736
s_load_dword s3, s[4:5], 28800
s_load_dword s3, s[4:5], 28864
s_waitcnt vmcnt(8)
s_barrier
s_add_u32 s37, s35, 6
s_and_b32 s37, s37, 15
s_lshl_b32 s37, s37, 14
s_add_u32 m0, s39, 98304
s_nop 0
buffer_load_dwordx4 v2, s[8:11], s37 offen offset:0 sc1 lds
buffer_load_dwordx4 v2, s[8:11], s37 offen offset:1024 sc1 lds
buffer_load_dwordx4 v2, s[8:11], s37 offen offset:2048 sc1 lds
buffer_load_dwordx4 v2, s[8:11], s37 offen offset:3072 sc1 lds
v_lshlrev_b32 v24, 16, v136
v_and_b32 v25, 0xffff0000, v136
v_lshlrev_b32 v26, 16, v137
v_and_b32 v27, 0xffff0000, v137
v_lshlrev_b32 v28, 16, v138
v_and_b32 v29, 0xffff0000, v138
v_lshlrev_b32 v30, 16, v139
v_and_b32 v31, 0xffff0000, v139
v_add_f32 v240, v240, v24
v_add_f32 v241, v241, v25
v_add_f32 v242, v242, v26
v_add_f32 v243, v243, v27
v_add_f32 v244, v244, v28
v_add_f32 v245, v245, v29
v_add_f32 v246, v246, v30
v_add_f32 v247, v247, v31
s_load_dword s3, s[4:5], 35840
s_load_dword s3, s[4:5], 35904
s_load_dword s3, s[4:5], 35968
s_waitcnt vmcnt(8)
s_barrier
s_add_u32 s37, s35, 7
s_and_b32 s37, s37, 15
s_lshl_b32 s37, s37, 14
s_add_u32 m0, s39, 147456
s_nop 0
buffer_load_dwordx4 v2, s[8:11], s37 offen offset:0 sc1 lds
buffer_load_dwordx4 v2, s[8:11], s37 offen offset:1024 sc1 lds
buffer_load_dwordx4 v2, s[8:11], s37 offen offset:2048 sc1 lds
buffer_load_dwordx4 v2, s[8:11], s37 offen offset:3072 sc1 lds
v_lshlrev_b32 v24, 16, v140
v_and_b32 v25, 0xffff0000, v140
v_lshlrev_b32 v26, 16, v141
v_and_b32 v27, 0xffff0000, v141
v_lshlrev_b32 v28, 16, v142
v_and_b32 v29, 0xffff0000, v142
v_lshlrev_b32 v30, 16, v143
v_and_b32 v31, 0xffff0000, v143
v_add_f32 v240, v240, v24
v_add_f32 v241, v241, v25
v_add_f32 v242, v242, v26
v_add_f32 v243, v243, v27
v_add_f32 v244, v244, v28
v_add_f32 v245, v245, v29
v_add_f32 v246, v246, v30
v_add_f32 v247, v247, v31
s_load_dword s3, s[4:5], 36032
s_load_dword s3, s[4:5], 43008
s_load_dword s3, s[4:5], 43072
s_waitcnt vmcnt(8)
s_barrier
s_add_u32 s37, s35, 8
s_and_b32 s37, s37, 15
s_lshl_b32 s37, s37, 14
s_add_u32 m0, s39, 0
s_nop 0
buffer_load_dwordx4 v2, s[8:11], s37 offen offset:0 sc1 lds
buffer_load_dwordx4 v2, s[8:11], s37 offen offset:1024 sc1 lds
buffer_load_dwordx4 v2, s[8:11], s37 offen offset:2048 sc1 lds
buffer_load_dwordx4 v2, s[8:11], s37 offen offset:3072 sc1 lds
s_add_u32 s38, s35, 12
s_and_b32 s38, s38, 15
s_lshl_b32 s38, s38, 17
s_add_u32 m0, s40, 114688
s_nop 0
buffer_load_dwordx4 v3, s[12:15], s38 offen lds
s_add_u32 m0, s40, 115712
s_add_u32 s38, s38, 16384
buffer_load_dwordx4 v3, s[12:15], s38 offen lds
v_lshlrev_b32 v24, 16, v144
v_and_b32 v25, 0xffff0000, v144
v_lshlrev_b32 v26, 16, v145
v_and_b32 v27, 0xffff0000, v145
v_lshlrev_b32 v28, 16, v146
v_and_b32 v29, 0xffff0000, v146
v_lshlrev_b32 v30, 16, v147
v_and_b32 v31, 0xffff0000, v147
v_add_f32 v240, v240, v24
v_add_f32 v241, v241, v25
v_add_f32 v242, v242, v26
v_add_f32 v243, v243, v27
v_add_f32 v244, v244, v28
v_add_f32 v245, v245, v29
v_add_f32 v246, v246, v30
v_add_f32 v247, v247, v31
s_load_dword s3, s[4:5], 43136
s_load_dword s3, s[4:5], 43200
s_load_dword s3, s[4:5], 50176
s_waitcnt vmcnt(10)
s_barrier
s_add_u32 s37, s35, 9
s_and_b32 s37, s37, 15
s_lshl_b32 s37, s37, 14
s_add_u32 m0, s39, 49152
s_nop 0
buffer_load_dwordx4 v2, s[8:11], s37 offen offset:0 sc1 lds
buffer_load_dwordx4 v2, s[8:11], s37 offen offset:1024 sc1 lds
buffer_load_dwordx4 v2, s[8:11], s37 offen offset:2048 sc1 lds
buffer_load_dwordx4 v2, s[8:11], s37 offen offset:3072 sc1 lds
s_add_u32 s38, s35, 13
s_and_b32 s38, s38, 15
s_lshl_b32 s38, s38, 17
s_add_u32 m0, s40, 122880
s_nop 0
buffer_load_dwordx4 v3, s[12:15], s38 offen lds
s_add_u32 m0, s40, 123904
s_add_u32 s38, s38, 16384
buffer_load_dwordx4 v3, s[12:15], s38 offen lds
v_lshlrev_b32 v24, 16, v148
v_and_b32 v25, 0xffff0000, v148
v_lshlrev_b32 v26, 16, v149
v_and_b32 v27, 0xffff0000, v149
v_lshlrev_b32 v28, 16, v150
v_and_b32 v29, 0xffff0000, v150
v_lshlrev_b32 v30, 16, v151
v_and_b32 v31, 0xffff0000, v151
v_add_f32 v240, v240, v24
v_add_f32 v241, v241, v25
v_add_f32 v242, v242, v26
v_add_f32 v243, v243, v27
v_add_f32 v244, v244, v28
v_add_f32 v245, v245, v29
v_add_f32 v246, v246, v30
v_add_f32 v247, v247, v31
s_load_dword s3, s[4:5], 50240
s_load_dword s3, s[4:5], 50304
s_load_dword s3, s[4:5], 50368
s_waitcnt vmcnt(12)
s_barrier
s_add_u32 s37, s35, 10
s_and_b32 s37, s37, 15
s_lshl_b32 s37, s37, 14
s_add_u32 m0, s39, 98304
s_nop 0
buffer_load_dwordx4 v2, s[8:11], s37 offen offset:0 sc1 lds
buffer_load_dwordx4 v2, s[8:11], s37 offen offset:1024 sc1 lds
buffer_load_dwordx4 v2, s[8:11], s37 offen offset:2048 sc1 lds
buffer_load_dwordx4 v2, s[8:11], s37 offen offset:3072 sc1 lds
s_add_u32 s38, s35, 14
s_and_b32 s38, s38, 15
s_lshl_b32 s38, s38, 17
s_add_u32 m0, s40, 131072
s_nop 0
buffer_load_dwordx4 v3, s[12:15], s38 offen lds
s_add_u32 m0, s40, 132096
s_add_u32 s38, s38, 16384
buffer_load_dwordx4 v3, s[12:15], s38 offen lds
v_lshlrev_b32 v24, 16, v152
v_and_b32 v25, 0xffff0000, v152
v_lshlrev_b32 v26, 16, v153
v_and_b32 v27, 0xffff0000, v153
v_lshlrev_b32 v28, 16, v154
v_and_b32 v29, 0xffff0000, v154
v_lshlrev_b32 v30, 16, v155
v_and_b32 v31, 0xffff0000, v155
v_add_f32 v240, v240, v24
v_add_f32 v241, v241, v25
v_add_f32 v242, v242, v26
v_add_f32 v243, v243, v27
v_add_f32 v244, v244, v28
v_add_f32 v245, v245, v29
v_add_f32 v246, v246, v30
v_add_f32 v247, v247, v31
s_load_dword s3, s[4:5], 57344
s_load_dword s3, s[4:5], 57408
s_load_dword s3, s[4:5], 57472
s_waitcnt vmcnt(14)
s_barrier
s_add_u32 s37, s35, 11
s_and_b32 s37, s37, 15
s_lshl_b32 s37, s37, 14
s_add_u32 m0, s39, 147456
s_nop 0
buffer_load_dwordx4 v2, s[8:11], s37 offen offset:0 sc1 lds
buffer_load_dwordx4 v2, s[8:11], s37 offen offset:1024 sc1 lds
buffer_load_dwordx4 v2, s[8:11], s37 offen offset:2048 sc1 lds
buffer_load_dwordx4 v2, s[8:11], s37 offen offset:3072 sc1 lds
s_add_u32 s38, s35, 15
s_and_b32 s38, s38, 15
s_lshl_b32 s38, s38, 17
s_add_u32 m0, s40, 139264
s_nop 0
buffer_load_dwordx4 v3, s[12:15], s38 offen lds
s_add_u32 m0, s40, 140288
s_add_u32 s38, s38, 16384
buffer_load_dwordx4 v3, s[12:15], s38 offen lds
v_lshlrev_b32 v24, 16, v156
v_and_b32 v25, 0xffff0000, v156
v_lshlrev_b32 v26, 16, v157
v_and_b32 v27, 0xffff0000, v157
v_lshlrev_b32 v28, 16, v158
v_and_b32 v29, 0xffff0000, v158
v_lshlrev_b32 v30, 16, v159
v_and_b32 v31, 0xffff0000, v159
v_add_f32 v240, v240, v24
v_add_f32 v241, v241, v25
v_add_f32 v242, v242, v26
v_add_f32 v243, v243, v27
v_add_f32 v244, v244, v28
v_add_f32 v245, v245, v29
v_add_f32 v246, v246, v30
v_add_f32 v247, v247, v31
s_load_dword s3, s[4:5], 57536
s_load_dword s3, s[4:5], 64512
s_load_dword s3, s[4:5], 64576
s_waitcnt vmcnt(14)
s_barrier
s_add_u32 s37, s35, 12
s_and_b32 s37, s37, 15
s_lshl_b32 s37, s37, 14
s_add_u32 m0, s39, 0
s_nop 0
buffer_load_dwordx4 v2, s[8:11], s37 offen offset:0 sc1 lds
buffer_load_dwordx4 v2, s[8:11], s37 offen offset:1024 sc1 lds
buffer_load_dwordx4 v2, s[8:11], s37 offen offset:2048 sc1 lds
buffer_load_dwordx4 v2, s[8:11], s37 offen offset:3072 sc1 lds
s_load_dword s3, s[4:5], 64640
s_load_dword s3, s[4:5], 64704
s_load_dword s3, s[4:5], 71680
s_waitcnt vmcnt(12)
s_barrier
s_add_u32 s37, s35, 13
s_and_b32 s37, s37, 15
s_lshl_b32 s37, s37, 14
s_add_u32 m0, s39, 49152
s_nop 0
buffer_load_dwordx4 v2, s[8:11], s37 offen offset:0 sc1 lds
s_branch Lov_7
.p2align 12
Lst_7_0:
s_branch Lwr_147
s_nop 0
s_nop 0
Lov_7:
buffer_load_dwordx4 v2, s[8:11], s37 offen offset:1024 sc1 lds
buffer_load_dwordx4 v2, s[8:11], s37 offen offset:2048 sc1 lds
buffer_load_dwordx4 v2, s[8:11], s37 offen offset:3072 sc1 lds
s_load_dword s3, s[4:5], 71744
s_load_dword s3, s[4:5], 71808
s_load_dword s3, s[4:5], 71872
s_waitcnt vmcnt(10)
s_barrier
s_add_u32 s37, s35, 14
s_and_b32 s37, s37, 15
s_lshl_b32 s37, s37, 14
s_add_u32 m0, s39, 98304
s_nop 0
buffer_load_dwordx4 v2, s[8:11], s37 offen offset:0 sc1 lds
buffer_load_dwordx4 v2, s[8:11], s37 offen offset:1024 sc1 lds
buffer_load_dwordx4 v2, s[8:11], s37 offen offset:2048 sc1 lds
buffer_load_dwordx4 v2, s[8:11], s37 offen offset:3072 sc1 lds
s_waitcnt vmcnt(8)
s_barrier
s_add_u32 s37, s35, 15
s_and_b32 s37, s37, 15
s_lshl_b32 s37, s37, 14
s_add_u32 m0, s39, 147456
s_nop 0
buffer_load_dwordx4 v2, s[8:11], s37 offen offset:0 sc1 lds
buffer_load_dwordx4 v2, s[8:11], s37 offen offset:1024 sc1 lds
buffer_load_dwordx4 v2, s[8:11], s37 offen offset:2048 sc1 lds
buffer_load_dwordx4 v2, s[8:11], s37 offen offset:3072 sc1 lds
s_waitcnt vmcnt(8)
s_barrier
s_nop 0
v_permlane32_swap_b32 v240, v244
v_permlane32_swap_b32 v241, v245
v_permlane32_swap_b32 v242, v246
v_permlane32_swap_b32 v243, v247
v_add_f32 v240, v240, v244
v_add_f32 v241, v241, v245
v_add_f32 v242, v242, v246
v_add_f32 v243, v243, v247
s_nop 0
v_permlane16_swap_b32 v240, v242
v_permlane16_swap_b32 v241, v243
v_add_f32 v240, v240, v242
v_add_f32 v241, v241, v243
s_waitcnt vmcnt(4)
s_barrier
s_add_u32 s38, s35, 0
s_and_b32 s38, s38, 15
s_mul_i32 s38, s38, 458752
s_add_u32 m0, s46, 0
s_nop 0
buffer_load_dwordx4 v8, s[88:91], s38 offen lds
s_add_u32 m0, s46, 1024
s_nop 0
buffer_load_dwordx4 v9, s[88:91], s38 offen lds
s_add_u32 m0, s46, 2048
s_nop 0
buffer_load_dwordx4 v10, s[88:91], s38 offen lds
s_add_u32 m0, s46, 3072
s_add_u32 s38, s38, 114688
buffer_load_dwordx4 v8, s[88:91], s38 offen lds
s_add_u32 m0, s46, 4096
s_nop 0
buffer_load_dwordx4 v9, s[88:91], s38 offen lds
s_add_u32 m0, s46, 5120
s_nop 0
buffer_load_dwordx4 v10, s[88:91], s38 offen lds
s_add_u32 s38, s35, 1
s_and_b32 s38, s38, 15
s_mul_i32 s38, s38, 458752
s_add_u32 m0, s46, 49152
s_nop 0
buffer_load_dwordx4 v8, s[88:91], s38 offen lds
s_add_u32 m0, s46, 50176
s_nop 0
buffer_load_dwordx4 v9, s[88:91], s38 offen lds
s_add_u32 m0, s46, 51200
s_nop 0
buffer_load_dwordx4 v10, s[88:91], s38 offen lds
s_add_u32 m0, s46, 52224
s_add_u32 s38, s38, 114688
buffer_load_dwordx4 v8, s[88:91], s38 offen lds
s_add_u32 m0, s46, 53248
s_nop 0
buffer_load_dwordx4 v9, s[88:91], s38 offen lds
s_add_u32 m0, s46, 54272
s_nop 0
buffer_load_dwordx4 v10, s[88:91], s38 offen lds
s_waitcnt vmcnt(12)
s_barrier
s_barrier
s_branch Lk3a
Lk2end_77:
Lk3:
s_branch Lgb_91
Lk3a:
s_mul_i32 s43, s34, 262144
s_add_u32 s8, s82, s43
s_addc_u32 s9, s83, 0
s_add_u32 s8, s8, 4194304
s_addc_u32 s9, s9, 0
s_mov_b32 s10, 262144
s_mov_b32 s11, 0x20000
s_mul_i32 s43, s34, 917504
s_add_u32 s24, s82, s43
s_addc_u32 s25, s83, 0
s_add_u32 s24, s24, 8388608
s_addc_u32 s25, s25, 0
s_mov_b32 s26, 917504
s_mov_b32 s27, 0x20000
s_add_u32 s84, s82, 27262976
s_addc_u32 s85, s83, 0
s_mov_b32 s86, 229376
s_mov_b32 s87, 0x20000
s_and_b32 s47, s36, 3
s_lshr_b32 s62, s47, 1
s_and_b32 s63, s47, 1
v_lshlrev_b32 v2, 4, v1
s_lshl_b32 s39, s47, 12
v_add_u32 v3, s39, v2
s_cmp_eq_u32 s62, 0
s_cselect_b32 s44, s72, s74
s_cselect_b32 s45, s73, s75
s_lshl_b32 s43, s35, 8
s_add_u32 s12, s44, s43
s_addc_u32 s13, s45, 0
s_mov_b32 s14, 7333120
s_mov_b32 s15, 0x20000
v_lshrrev_b32 v28, 4, v1
v_lshlrev_b32 v29, 1, v28
v_and_b32 v4, 15, v1
v_xor_b32 v4, v4, v29
v_lshlrev_b32 v4, 4, v4
v_mul_u32_u24 v28, 7168, v28
v_add_u32 v4, v4, v28
s_mul_i32 s43, s63, 229376
v_add_u32 v4, s43, v4
v_xor_b32 v5, 128, v4
v_add_u32 v5, 28672, v5
s_lshl_b32 s40, s47, 13
s_add_u32 s40, s40, 16384
s_lshl_b32 s43, s62, 12
v_add_u32 v9, s43, v2
v_add_u32 v10, 98304, v9
s_lshl_b32 s43, s47, 9
s_add_u32 s43, s43, 151552
v_and_b32 v28, 15, v1
v_lshl_add_u32 v28, v28, 5, s43
v_lshrrev_b32 v29, 4, v1
v_lshl_add_u32 v28, v29, 3, v28
ds_write_b64 v28, v[240:241]
s_waitcnt lgkmcnt(0)
v_lshrrev_b32 v27, 2, v1
v_bfe_u32 v28, v27, 2, 1
v_mul_u32_u24 v27, 192, v27
v_add_u32 v27, 16384, v27
v_and_b32 v29, 3, v1
v_lshl_add_u32 v12, v29, 3, v27
s_lshl_b32 s43, s63, 6
v_add_u32 v12, s43, v12
v_lshl_add_u32 v11, v28, 5, v12
v_xor_b32 v30, 1, v28
v_lshl_add_u32 v12, v30, 5, v12
v_xor_b32 v28, s63, v28
v_lshl_add_u32 v27, v28, 4, v27
v_lshrrev_b32 v28, 1, v29
v_lshl_add_u32 v27, v28, 5, v27
v_and_b32 v28, 1, v29
v_lshl_add_u32 v27, v28, 3, v27
v_add_u32 v13, 128, v27
v_add_u32 v14, 49152, v11
v_add_u32 v15, 49152, v12
v_add_u32 v16, 49152, v13
v_add_u32 v17, 98304, v11
v_add_u32 v18, 98304, v12
v_add_u32 v19, 98304, v13
v_bfe_u32 v28, v1, 3, 1
v_lshlrev_b32 v28, 6, v28
v_bfe_u32 v29, v1, 1, 2
s_lshl_b32 s43, s48, 3
s_lshl_b32 s44, s63, 2
s_add_u32 s43, s43, s44
v_add3_u32 v28, v28, v29, s43
v_mul_u32_u24 v28, 7168, v28
v_and_b32 v29, 1, v1
v_mul_u32_u24 v29, 188, v29
v_add_u32 v20, v28, v29
s_cmp_lg_u32 s36, 4
s_cbranch_scc1 Lwm_93
s_branch Lst_8_1
Lwr_159:
s_branch Lwe_92
Lwm_93:
s_cmp_lg_u32 s36, 5
s_cbranch_scc1 Lwm_94
s_branch Lst_9_1
Lwr_160:
s_branch Lwe_92
Lwm_94:
s_cmp_lg_u32 s36, 6
s_cbranch_scc1 Lwm_95
s_branch Lst_10_1
Lwr_161:
s_branch Lwe_92
Lwm_95:
s_cmp_lg_u32 s36, 7
s_cbranch_scc1 Lwm_96
s_nop 0
s_branch Lwe_92
Lwm_96:
Lwe_92:
s_barrier
s_cmp_lg_u32 s36, 4
s_cbranch_scc1 Lwm_98
s_branch Lst_11_1
Lwr_163:
s_branch Lwe_97
Lwm_98:
s_cmp_lg_u32 s36, 5
s_cbranch_scc1 Lwm_99
s_branch Lst_12_1
Lwr_164:
s_branch Lwe_97
Lwm_99:
s_cmp_lg_u32 s36, 6
s_cbranch_scc1 Lwm_100
s_branch Lst_13_1
Lwr_165:
s_branch Lwe_97
Lwm_100:
s_cmp_lg_u32 s36, 7
s_cbranch_scc1 Lwm_101
s_branch Lst_14_1
Lwr_166:
s_branch Lwe_97
Lwm_101:
Lwe_97:
s_waitcnt vmcnt(0) lgkmcnt(0)
s_barrier
ds_read_b128 v[32:35], v9 offset:0
ds_read_b64_tr_b16 v[48:49], v11 offset:0
ds_read_b64_tr_b16 v[50:51], v11 offset:3072
ds_read_b64_tr_b16 v[52:53], v12 offset:0
ds_read_b64_tr_b16 v[54:55], v12 offset:3072
ds_read_b64_tr_b16 v[56:57], v13 offset:0
ds_read_b64_tr_b16 v[58:59], v13 offset:3072
ds_read_b64_tr_b16 v[60:61], v11 offset:12288
ds_read_b64_tr_b16 v[62:63], v11 offset:15360
ds_read_b64_tr_b16 v[64:65], v12 offset:12288
ds_read_b64_tr_b16 v[66:67], v12 offset:15360
ds_read_b64_tr_b16 v[68:69], v13 offset:12288
ds_read_b64_tr_b16 v[70:71], v13 offset:15360
ds_read_b128 v[36:39], v9 offset:1024
ds_read_b128 v[40:43], v9 offset:2048
ds_read_b128 v[44:47], v9 offset:3072
s_waitcnt lgkmcnt(0)
v_mfma_f32_16x16x32_bf16 v[128:131], v[48:51], v[32:35], 0
ds_read_b128 v[72:75], v9 offset:8192
v_mfma_f32_16x16x32_bf16 v[132:135], v[52:55], v[32:35], 0
ds_read_b64_tr_b16 v[88:89], v11 offset:6144
v_mfma_f32_16x16x32_bf16 v[136:139], v[56:59], v[32:35], 0
ds_read_b64_tr_b16 v[90:91], v11 offset:9216
v_mfma_f32_16x16x32_bf16 v[140:143], v[60:63], v[32:35], 0
ds_read_b64_tr_b16 v[92:93], v12 offset:6144
v_mfma_f32_16x16x32_bf16 v[144:147], v[64:67], v[32:35], 0
ds_read_b64_tr_b16 v[94:95], v12 offset:9216
v_mfma_f32_16x16x32_bf16 v[148:151], v[68:71], v[32:35], 0
ds_read_b64_tr_b16 v[96:97], v13 offset:6144
v_mfma_f32_16x16x32_bf16 v[172:175], v[68:71], v[36:39], 0
ds_read_b64_tr_b16 v[98:99], v13 offset:9216
v_mfma_f32_16x16x32_bf16 v[168:171], v[64:67], v[36:39], 0
ds_read_b64_tr_b16 v[100:101], v11 offset:18432
v_mfma_f32_16x16x32_bf16 v[164:167], v[60:63], v[36:39], 0
ds_read_b64_tr_b16 v[102:103], v11 offset:21504
v_mfma_f32_16x16x32_bf16 v[160:163], v[56:59], v[36:39], 0
ds_read_b64_tr_b16 v[104:105], v12 offset:18432
v_mfma_f32_16x16x32_bf16 v[156:159], v[52:55], v[36:39], 0
ds_read_b64_tr_b16 v[106:107], v12 offset:21504
v_mfma_f32_16x16x32_bf16 v[152:155], v[48:51], v[36:39], 0
ds_read_b64_tr_b16 v[108:109], v13 offset:18432
v_mfma_f32_16x16x32_bf16 v[176:179], v[48:51], v[40:43], 0
ds_read_b64_tr_b16 v[110:111], v13 offset:21504
v_mfma_f32_16x16x32_bf16 v[180:183], v[52:55], v[40:43], 0
ds_read_b128 v[76:79], v9 offset:9216
v_mfma_f32_16x16x32_bf16 v[184:187], v[56:59], v[40:43], 0
ds_read_b128 v[80:83], v9 offset:10240
v_mfma_f32_16x16x32_bf16 v[188:191], v[60:63], v[40:43], 0
ds_read_b128 v[84:87], v9 offset:11264
v_mfma_f32_16x16x32_bf16 v[192:195], v[64:67], v[40:43], 0
v_mfma_f32_16x16x32_bf16 v[196:199], v[68:71], v[40:43], 0
v_mfma_f32_16x16x32_bf16 v[220:223], v[68:71], v[44:47], 0
v_mfma_f32_16x16x32_bf16 v[216:219], v[64:67], v[44:47], 0
v_mfma_f32_16x16x32_bf16 v[212:215], v[60:63], v[44:47], 0
v_mfma_f32_16x16x32_bf16 v[208:211], v[56:59], v[44:47], 0
v_mfma_f32_16x16x32_bf16 v[204:207], v[52:55], v[44:47], 0
v_mfma_f32_16x16x32_bf16 v[200:203], v[48:51], v[44:47], 0
s_waitcnt lgkmcnt(0)
s_barrier
v_mfma_f32_16x16x32_bf16 v[128:131], v[88:91], v[72:75], v[128:131]
ds_read_b128 v[32:35], v9 offset:49152
v_mfma_f32_16x16x32_bf16 v[132:135], v[92:95], v[72:75], v[132:135]
ds_read_b64_tr_b16 v[48:49], v14 offset:0
v_mfma_f32_16x16x32_bf16 v[136:139], v[96:99], v[72:75], v[136:139]
ds_read_b64_tr_b16 v[50:51], v14 offset:3072
v_mfma_f32_16x16x32_bf16 v[140:143], v[100:103], v[72:75], v[140:143]
ds_read_b64_tr_b16 v[52:53], v15 offset:0
v_mfma_f32_16x16x32_bf16 v[144:147], v[104:107], v[72:75], v[144:147]
ds_read_b64_tr_b16 v[54:55], v15 offset:3072
v_mfma_f32_16x16x32_bf16 v[148:151], v[108:111], v[72:75], v[148:151]
ds_read_b64_tr_b16 v[56:57], v16 offset:0
v_mfma_f32_16x16x32_bf16 v[172:175], v[108:111], v[76:79], v[172:175]
ds_read_b64_tr_b16 v[58:59], v16 offset:3072
v_mfma_f32_16x16x32_bf16 v[168:171], v[104:107], v[76:79], v[168:171]
ds_read_b64_tr_b16 v[60:61], v14 offset:12288
v_mfma_f32_16x16x32_bf16 v[164:167], v[100:103], v[76:79], v[164:167]
ds_read_b64_tr_b16 v[62:63], v14 offset:15360
v_mfma_f32_16x16x32_bf16 v[160:163], v[96:99], v[76:79], v[160:163]
ds_read_b64_tr_b16 v[64:65], v15 offset:12288
v_mfma_f32_16x16x32_bf16 v[156:159], v[92:95], v[76:79], v[156:159]
ds_read_b64_tr_b16 v[66:67], v15 offset:15360
v_mfma_f32_16x16x32_bf16 v[152:155], v[88:91], v[76:79], v[152:155]
ds_read_b64_tr_b16 v[68:69], v16 offset:12288
v_mfma_f32_16x16x32_bf16 v[176:179], v[88:91], v[80:83], v[176:179]
ds_read_b64_tr_b16 v[70:71], v16 offset:15360
v_mfma_f32_16x16x32_bf16 v[180:183], v[92:95], v[80:83], v[180:183]
ds_read_b128 v[36:39], v9 offset:50176
v_mfma_f32_16x16x32_bf16 v[184:187], v[96:99], v[80:83], v[184:187]
ds_read_b128 v[40:43], v9 offset:51200
v_mfma_f32_16x16x32_bf16 v[188:191], v[100:103], v[80:83], v[188:191]
ds_read_b128 v[44:47], v9 offset:52224
v_mfma_f32_16x16x32_bf16 v[192:195], v[104:107], v[80:83], v[192:195]
v_mfma_f32_16x16x32_bf16 v[196:199], v[108:111], v[80:83], v[196:199]
v_mfma_f32_16x16x32_bf16 v[220:223], v[108:111], v[84:87], v[220:223]
v_mfma_f32_16x16x32_bf16 v[216:219], v[104:107], v[84:87], v[216:219]
v_mfma_f32_16x16x32_bf16 v[212:215], v[100:103], v[84:87], v[212:215]
v_mfma_f32_16x16x32_bf16 v[208:211], v[96:99], v[84:87], v[208:211]
v_mfma_f32_16x16x32_bf16 v[204:207], v[92:95], v[84:87], v[204:207]
v_mfma_f32_16x16x32_bf16 v[200:203], v[88:91], v[84:87], v[200:203]
s_mov_b32 s41, 5
Lk3l_102:
s_waitcnt lgkmcnt(0)
v_mfma_f32_16x16x32_bf16 v[128:131], v[48:51], v[32:35], v[128:131]
ds_read_b128 v[72:75], v9 offset:57344
v_mfma_f32_16x16x32_bf16 v[132:135], v[52:55], v[32:35], v[132:135]
ds_read_b64_tr_b16 v[88:89], v14 offset:6144
v_mfma_f32_16x16x32_bf16 v[136:139], v[56:59], v[32:35], v[136:139]
ds_read_b64_tr_b16 v[90:91], v14 offset:9216
v_mfma_f32_16x16x32_bf16 v[140:143], v[60:63], v[32:35], v[140:143]
ds_read_b64_tr_b16 v[92:93], v15 offset:6144
v_mfma_f32_16x16x32_bf16 v[144:147], v[64:67], v[32:35], v[144:147]
ds_read_b64_tr_b16 v[94:95], v15 offset:9216
v_mfma_f32_16x16x32_bf16 v[148:151], v[68:71], v[32:35], v[148:151]
ds_read_b64_tr_b16 v[96:97], v16 offset:6144
v_mfma_f32_16x16x32_bf16 v[172:175], v[68:71], v[36:39], v[172:175]
ds_read_b64_tr_b16 v[98:99], v16 offset:9216
v_mfma_f32_16x16x32_bf16 v[168:171], v[64:67], v[36:39], v[168:171]
ds_read_b64_tr_b16 v[100:101], v14 offset:18432
v_mfma_f32_16x16x32_bf16 v[164:167], v[60:63], v[36:39], v[164:167]
ds_read_b64_tr_b16 v[102:103], v14 offset:21504
v_mfma_f32_16x16x32_bf16 v[160:163], v[56:59], v[36:39], v[160:163]
ds_read_b64_tr_b16 v[104:105], v15 offset:18432
v_mfma_f32_16x16x32_bf16 v[156:159], v[52:55], v[36:39], v[156:159]
ds_read_b64_tr_b16 v[106:107], v15 offset:21504
v_mfma_f32_16x16x32_bf16 v[152:155], v[48:51], v[36:39], v[152:155]
ds_read_b64_tr_b16 v[108:109], v16 offset:18432
v_mfma_f32_16x16x32_bf16 v[176:179], v[48:51], v[40:43], v[176:179]
ds_read_b64_tr_b16 v[110:111], v16 offset:21504
v_mfma_f32_16x16x32_bf16 v[180:183], v[52:55], v[40:43], v[180:183]
ds_read_b128 v[76:79], v9 offset:58368
v_mfma_f32_16x16x32_bf16 v[184:187], v[56:59], v[40:43], v[184:187]
ds_read_b128 v[80:83], v9 offset:59392
v_mfma_f32_16x16x32_bf16 v[188:191], v[60:63], v[40:43], v[188:191]
ds_read_b128 v[84:87], v9 offset:60416
v_mfma_f32_16x16x32_bf16 v[192:195], v[64:67], v[40:43], v[192:195]
v_mfma_f32_16x16x32_bf16 v[196:199], v[68:71], v[40:43], v[196:199]
v_mfma_f32_16x16x32_bf16 v[220:223], v[68:71], v[44:47], v[220:223]
v_mfma_f32_16x16x32_bf16 v[216:219], v[64:67], v[44:47], v[216:219]
v_mfma_f32_16x16x32_bf16 v[212:215], v[60:63], v[44:47], v[212:215]
v_mfma_f32_16x16x32_bf16 v[208:211], v[56:59], v[44:47], v[208:211]
v_mfma_f32_16x16x32_bf16 v[204:207], v[52:55], v[44:47], v[204:207]
v_mfma_f32_16x16x32_bf16 v[200:203], v[48:51], v[44:47], v[200:203]
s_waitcnt lgkmcnt(0)
s_barrier
v_mfma_f32_16x16x32_bf16 v[128:131], v[88:91], v[72:75], v[128:131]
ds_read_b128 v[32:35], v10 offset:0
v_mfma_f32_16x16x32_bf16 v[132:135], v[92:95], v[72:75], v[132:135]
ds_read_b64_tr_b16 v[48:49], v17 offset:0
v_mfma_f32_16x16x32_bf16 v[136:139], v[96:99], v[72:75], v[136:139]
ds_read_b64_tr_b16 v[50:51], v17 offset:3072
v_mfma_f32_16x16x32_bf16 v[140:143], v[100:103], v[72:75], v[140:143]
ds_read_b64_tr_b16 v[52:53], v18 offset:0
v_mfma_f32_16x16x32_bf16 v[144:147], v[104:107], v[72:75], v[144:147]
ds_read_b64_tr_b16 v[54:55], v18 offset:3072
v_mfma_f32_16x16x32_bf16 v[148:151], v[108:111], v[72:75], v[148:151]
ds_read_b64_tr_b16 v[56:57], v19 offset:0
v_mfma_f32_16x16x32_bf16 v[172:175], v[108:111], v[76:79], v[172:175]
ds_read_b64_tr_b16 v[58:59], v19 offset:3072
v_mfma_f32_16x16x32_bf16 v[168:171], v[104:107], v[76:79], v[168:171]
ds_read_b64_tr_b16 v[60:61], v17 offset:12288
v_mfma_f32_16x16x32_bf16 v[164:167], v[100:103], v[76:79], v[164:167]
ds_read_b64_tr_b16 v[62:63], v17 offset:15360
v_mfma_f32_16x16x32_bf16 v[160:163], v[96:99], v[76:79], v[160:163]
ds_read_b64_tr_b16 v[64:65], v18 offset:12288
v_mfma_f32_16x16x32_bf16 v[156:159], v[92:95], v[76:79], v[156:159]
ds_read_b64_tr_b16 v[66:67], v18 offset:15360
v_mfma_f32_16x16x32_bf16 v[152:155], v[88:91], v[76:79], v[152:155]
ds_read_b64_tr_b16 v[68:69], v19 offset:12288
v_mfma_f32_16x16x32_bf16 v[176:179], v[88:91], v[80:83], v[176:179]
ds_read_b64_tr_b16 v[70:71], v19 offset:15360
v_mfma_f32_16x16x32_bf16 v[180:183], v[92:95], v[80:83], v[180:183]
ds_read_b128 v[36:39], v10 offset:1024
v_mfma_f32_16x16x32_bf16 v[184:187], v[96:99], v[80:83], v[184:187]
ds_read_b128 v[40:43], v10 offset:2048
v_mfma_f32_16x16x32_bf16 v[188:191], v[100:103], v[80:83], v[188:191]
ds_read_b128 v[44:47], v10 offset:3072
v_mfma_f32_16x16x32_bf16 v[192:195], v[104:107], v[80:83], v[192:195]
v_mfma_f32_16x16x32_bf16 v[196:199], v[108:111], v[80:83], v[196:199]
v_mfma_f32_16x16x32_bf16 v[220:223], v[108:111], v[84:87], v[220:223]
v_mfma_f32_16x16x32_bf16 v[216:219], v[104:107], v[84:87], v[216:219]
v_mfma_f32_16x16x32_bf16 v[212:215], v[100:103], v[84:87], v[212:215]
v_mfma_f32_16x16x32_bf16 v[208:211], v[96:99], v[84:87], v[208:211]
v_mfma_f32_16x16x32_bf16 v[204:207], v[92:95], v[84:87], v[204:207]
v_mfma_f32_16x16x32_bf16 v[200:203], v[88:91], v[84:87], v[200:203]
s_waitcnt lgkmcnt(0)
v_mfma_f32_16x16x32_bf16 v[128:131], v[48:51], v[32:35], v[128:131]
ds_read_b128 v[72:75], v10 offset:8192
v_mfma_f32_16x16x32_bf16 v[132:135], v[52:55], v[32:35], v[132:135]
ds_read_b64_tr_b16 v[88:89], v17 offset:6144
v_mfma_f32_16x16x32_bf16 v[136:139], v[56:59], v[32:35], v[136:139]
ds_read_b64_tr_b16 v[90:91], v17 offset:9216
v_mfma_f32_16x16x32_bf16 v[140:143], v[60:63], v[32:35], v[140:143]
ds_read_b64_tr_b16 v[92:93], v18 offset:6144
v_mfma_f32_16x16x32_bf16 v[144:147], v[64:67], v[32:35], v[144:147]
ds_read_b64_tr_b16 v[94:95], v18 offset:9216
v_mfma_f32_16x16x32_bf16 v[148:151], v[68:71], v[32:35], v[148:151]
ds_read_b64_tr_b16 v[96:97], v19 offset:6144
v_mfma_f32_16x16x32_bf16 v[172:175], v[68:71], v[36:39], v[172:175]
ds_read_b64_tr_b16 v[98:99], v19 offset:9216
v_mfma_f32_16x16x32_bf16 v[168:171], v[64:67], v[36:39], v[168:171]
ds_read_b64_tr_b16 v[100:101], v17 offset:18432
v_mfma_f32_16x16x32_bf16 v[164:167], v[60:63], v[36:39], v[164:167]
ds_read_b64_tr_b16 v[102:103], v17 offset:21504
v_mfma_f32_16x16x32_bf16 v[160:163], v[56:59], v[36:39], v[160:163]
ds_read_b64_tr_b16 v[104:105], v18 offset:18432
v_mfma_f32_16x16x32_bf16 v[156:159], v[52:55], v[36:39], v[156:159]
ds_read_b64_tr_b16 v[106:107], v18 offset:21504
v_mfma_f32_16x16x32_bf16 v[152:155], v[48:51], v[36:39], v[152:155]
ds_read_b64_tr_b16 v[108:109], v19 offset:18432
v_mfma_f32_16x16x32_bf16 v[176:179], v[48:51], v[40:43], v[176:179]
ds_read_b64_tr_b16 v[110:111], v19 offset:21504
v_mfma_f32_16x16x32_bf16 v[180:183], v[52:55], v[40:43], v[180:183]
ds_read_b128 v[76:79], v10 offset:9216
v_mfma_f32_16x16x32_bf16 v[184:187], v[56:59], v[40:43], v[184:187]
ds_read_b128 v[80:83], v10 offset:10240
v_mfma_f32_16x16x32_bf16 v[188:191], v[60:63], v[40:43], v[188:191]
ds_read_b128 v[84:87], v10 offset:11264
v_mfma_f32_16x16x32_bf16 v[192:195], v[64:67], v[40:43], v[192:195]
v_mfma_f32_16x16x32_bf16 v[196:199], v[68:71], v[40:43], v[196:199]
v_mfma_f32_16x16x32_bf16 v[220:223], v[68:71], v[44:47], v[220:223]
v_mfma_f32_16x16x32_bf16 v[216:219], v[64:67], v[44:47], v[216:219]
v_mfma_f32_16x16x32_bf16 v[212:215], v[60:63], v[44:47], v[212:215]
v_mfma_f32_16x16x32_bf16 v[208:211], v[56:59], v[44:47], v[208:211]
v_mfma_f32_16x16x32_bf16 v[204:207], v[52:55], v[44:47], v[204:207]
v_mfma_f32_16x16x32_bf16 v[200:203], v[48:51], v[44:47], v[200:203]
s_waitcnt lgkmcnt(0)
s_barrier
v_mfma_f32_16x16x32_bf16 v[128:131], v[88:91], v[72:75], v[128:131]
ds_read_b128 v[32:35], v9 offset:0
v_mfma_f32_16x16x32_bf16 v[132:135], v[92:95], v[72:75], v[132:135]
ds_read_b64_tr_b16 v[48:49], v11 offset:0
v_mfma_f32_16x16x32_bf16 v[136:139], v[96:99], v[72:75], v[136:139]
ds_read_b64_tr_b16 v[50:51], v11 offset:3072
v_mfma_f32_16x16x32_bf16 v[140:143], v[100:103], v[72:75], v[140:143]
ds_read_b64_tr_b16 v[52:53], v12 offset:0
v_mfma_f32_16x16x32_bf16 v[144:147], v[104:107], v[72:75], v[144:147]
ds_read_b64_tr_b16 v[54:55], v12 offset:3072
v_mfma_f32_16x16x32_bf16 v[148:151], v[108:111], v[72:75], v[148:151]
ds_read_b64_tr_b16 v[56:57], v13 offset:0
v_mfma_f32_16x16x32_bf16 v[172:175], v[108:111], v[76:79], v[172:175]
ds_read_b64_tr_b16 v[58:59], v13 offset:3072
v_mfma_f32_16x16x32_bf16 v[168:171], v[104:107], v[76:79], v[168:171]
ds_read_b64_tr_b16 v[60:61], v11 offset:12288
v_mfma_f32_16x16x32_bf16 v[164:167], v[100:103], v[76:79], v[164:167]
ds_read_b64_tr_b16 v[62:63], v11 offset:15360
v_mfma_f32_16x16x32_bf16 v[160:163], v[96:99], v[76:79], v[160:163]
ds_read_b64_tr_b16 v[64:65], v12 offset:12288
v_mfma_f32_16x16x32_bf16 v[156:159], v[92:95], v[76:79], v[156:159]
ds_read_b64_tr_b16 v[66:67], v12 offset:15360
v_mfma_f32_16x16x32_bf16 v[152:155], v[88:91], v[76:79], v[152:155]
ds_read_b64_tr_b16 v[68:69], v13 offset:12288
v_mfma_f32_16x16x32_bf16 v[176:179], v[88:91], v[80:83], v[176:179]
ds_read_b64_tr_b16 v[70:71], v13 offset:15360
v_mfma_f32_16x16x32_bf16 v[180:183], v[92:95], v[80:83], v[180:183]
ds_read_b128 v[36:39], v9 offset:1024
v_mfma_f32_16x16x32_bf16 v[184:187], v[96:99], v[80:83], v[184:187]
ds_read_b128 v[40:43], v9 offset:2048
v_mfma_f32_16x16x32_bf16 v[188:191], v[100:103], v[80:83], v[188:191]
ds_read_b128 v[44:47], v9 offset:3072
v_mfma_f32_16x16x32_bf16 v[192:195], v[104:107], v[80:83], v[192:195]
v_mfma_f32_16x16x32_bf16 v[196:199], v[108:111], v[80:83], v[196:199]
v_mfma_f32_16x16x32_bf16 v[220:223], v[108:111], v[84:87], v[220:223]
v_mfma_f32_16x16x32_bf16 v[216:219], v[104:107], v[84:87], v[216:219]
v_mfma_f32_16x16x32_bf16 v[212:215], v[100:103], v[84:87], v[212:215]
v_mfma_f32_16x16x32_bf16 v[208:211], v[96:99], v[84:87], v[208:211]
v_mfma_f32_16x16x32_bf16 v[204:207], v[92:95], v[84:87], v[204:207]
v_mfma_f32_16x16x32_bf16 v[200:203], v[88:91], v[84:87], v[200:203]
s_waitcnt lgkmcnt(0)
v_mfma_f32_16x16x32_bf16 v[128:131], v[48:51], v[32:35], v[128:131]
ds_read_b128 v[72:75], v9 offset:8192
v_mfma_f32_16x16x32_bf16 v[132:135], v[52:55], v[32:35], v[132:135]
ds_read_b64_tr_b16 v[88:89], v11 offset:6144
v_mfma_f32_16x16x32_bf16 v[136:139], v[56:59], v[32:35], v[136:139]
ds_read_b64_tr_b16 v[90:91], v11 offset:9216
v_mfma_f32_16x16x32_bf16 v[140:143], v[60:63], v[32:35], v[140:143]
ds_read_b64_tr_b16 v[92:93], v12 offset:6144
v_mfma_f32_16x16x32_bf16 v[144:147], v[64:67], v[32:35], v[144:147]
ds_read_b64_tr_b16 v[94:95], v12 offset:9216
v_mfma_f32_16x16x32_bf16 v[148:151], v[68:71], v[32:35], v[148:151]
ds_read_b64_tr_b16 v[96:97], v13 offset:6144
v_mfma_f32_16x16x32_bf16 v[172:175], v[68:71], v[36:39], v[172:175]
ds_read_b64_tr_b16 v[98:99], v13 offset:9216
v_mfma_f32_16x16x32_bf16 v[168:171], v[64:67], v[36:39], v[168:171]
ds_read_b64_tr_b16 v[100:101], v11 offset:18432
v_mfma_f32_16x16x32_bf16 v[164:167], v[60:63], v[36:39], v[164:167]
ds_read_b64_tr_b16 v[102:103], v11 offset:21504
v_mfma_f32_16x16x32_bf16 v[160:163], v[56:59], v[36:39], v[160:163]
ds_read_b64_tr_b16 v[104:105], v12 offset:18432
v_mfma_f32_16x16x32_bf16 v[156:159], v[52:55], v[36:39], v[156:159]
ds_read_b64_tr_b16 v[106:107], v12 offset:21504
v_mfma_f32_16x16x32_bf16 v[152:155], v[48:51], v[36:39], v[152:155]
ds_read_b64_tr_b16 v[108:109], v13 offset:18432
v_mfma_f32_16x16x32_bf16 v[176:179], v[48:51], v[40:43], v[176:179]
ds_read_b64_tr_b16 v[110:111], v13 offset:21504
v_mfma_f32_16x16x32_bf16 v[180:183], v[52:55], v[40:43], v[180:183]
ds_read_b128 v[76:79], v9 offset:9216
v_mfma_f32_16x16x32_bf16 v[184:187], v[56:59], v[40:43], v[184:187]
ds_read_b128 v[80:83], v9 offset:10240
v_mfma_f32_16x16x32_bf16 v[188:191], v[60:63], v[40:43], v[188:191]
ds_read_b128 v[84:87], v9 offset:11264
v_mfma_f32_16x16x32_bf16 v[192:195], v[64:67], v[40:43], v[192:195]
v_mfma_f32_16x16x32_bf16 v[196:199], v[68:71], v[40:43], v[196:199]
v_mfma_f32_16x16x32_bf16 v[220:223], v[68:71], v[44:47], v[220:223]
v_mfma_f32_16x16x32_bf16 v[216:219], v[64:67], v[44:47], v[216:219]
v_mfma_f32_16x16x32_bf16 v[212:215], v[60:63], v[44:47], v[212:215]
v_mfma_f32_16x16x32_bf16 v[208:211], v[56:59], v[44:47], v[208:211]
v_mfma_f32_16x16x32_bf16 v[204:207], v[52:55], v[44:47], v[204:207]
v_mfma_f32_16x16x32_bf16 v[200:203], v[48:51], v[44:47], v[200:203]
s_waitcnt lgkmcnt(0)
s_barrier
v_mfma_f32_16x16x32_bf16 v[128:131], v[88:91], v[72:75], v[128:131]
ds_read_b128 v[32:35], v9 offset:49152
v_mfma_f32_16x16x32_bf16 v[132:135], v[92:95], v[72:75], v[132:135]
ds_read_b64_tr_b16 v[48:49], v14 offset:0
v_mfma_f32_16x16x32_bf16 v[136:139], v[96:99], v[72:75], v[136:139]
ds_read_b64_tr_b16 v[50:51], v14 offset:3072
v_mfma_f32_16x16x32_bf16 v[140:143], v[100:103], v[72:75], v[140:143]
ds_read_b64_tr_b16 v[52:53], v15 offset:0
v_mfma_f32_16x16x32_bf16 v[144:147], v[104:107], v[72:75], v[144:147]
ds_read_b64_tr_b16 v[54:55], v15 offset:3072
v_mfma_f32_16x16x32_bf16 v[148:151], v[108:111], v[72:75], v[148:151]
ds_read_b64_tr_b16 v[56:57], v16 offset:0
v_mfma_f32_16x16x32_bf16 v[172:175], v[108:111], v[76:79], v[172:175]
ds_read_b64_tr_b16 v[58:59], v16 offset:3072
v_mfma_f32_16x16x32_bf16 v[168:171], v[104:107], v[76:79], v[168:171]
ds_read_b64_tr_b16 v[60:61], v14 offset:12288
v_mfma_f32_16x16x32_bf16 v[164:167], v[100:103], v[76:79], v[164:167]
ds_read_b64_tr_b16 v[62:63], v14 offset:15360
v_mfma_f32_16x16x32_bf16 v[160:163], v[96:99], v[76:79], v[160:163]
ds_read_b64_tr_b16 v[64:65], v15 offset:12288
v_mfma_f32_16x16x32_bf16 v[156:159], v[92:95], v[76:79], v[156:159]
ds_read_b64_tr_b16 v[66:67], v15 offset:15360
v_mfma_f32_16x16x32_bf16 v[152:155], v[88:91], v[76:79], v[152:155]
ds_read_b64_tr_b16 v[68:69], v16 offset:12288
v_mfma_f32_16x16x32_bf16 v[176:179], v[88:91], v[80:83], v[176:179]
ds_read_b64_tr_b16 v[70:71], v16 offset:15360
v_mfma_f32_16x16x32_bf16 v[180:183], v[92:95], v[80:83], v[180:183]
ds_read_b128 v[36:39], v9 offset:50176
v_mfma_f32_16x16x32_bf16 v[184:187], v[96:99], v[80:83], v[184:187]
ds_read_b128 v[40:43], v9 offset:51200
v_mfma_f32_16x16x32_bf16 v[188:191], v[100:103], v[80:83], v[188:191]
ds_read_b128 v[44:47], v9 offset:52224
v_mfma_f32_16x16x32_bf16 v[192:195], v[104:107], v[80:83], v[192:195]
v_mfma_f32_16x16x32_bf16 v[196:199], v[108:111], v[80:83], v[196:199]
v_mfma_f32_16x16x32_bf16 v[220:223], v[108:111], v[84:87], v[220:223]
v_mfma_f32_16x16x32_bf16 v[216:219], v[104:107], v[84:87], v[216:219]
v_mfma_f32_16x16x32_bf16 v[212:215], v[100:103], v[84:87], v[212:215]
v_mfma_f32_16x16x32_bf16 v[208:211], v[96:99], v[84:87], v[208:211]
v_mfma_f32_16x16x32_bf16 v[204:207], v[92:95], v[84:87], v[204:207]
v_mfma_f32_16x16x32_bf16 v[200:203], v[88:91], v[84:87], v[200:203]
s_sub_u32 s41, s41, 1
s_cmp_lg_u32 s41, 0
s_cbranch_scc1 Lk3l_102
s_waitcnt lgkmcnt(0)
s_mov_b32 s28, s76
s_mov_b32 s29, s77
s_mov_b32 s30, 7340032
s_mov_b32 s31, 0x20000
s_add_u32 s37, s35, 2
s_and_b32 s37, s37, 15
s_mul_i32 s37, s37, 16384
s_add_u32 m0, s39, 0
s_nop 0
buffer_load_dwordx4 v3, s[8:11], s37 offen sc1 lds
v_lshrrev_b32 v86, 4, v1
s_lshl_b32 s43, s63, 7
s_add_u32 s43, s43, 148992
buffer_load_dwordx4 v3, s[8:11], s37 offen offset:1024 sc1 lds
v_lshl_add_u32 v87, v86, 4, s43
v_lshrrev_b32 v88, 1, v86
v_and_b32 v86, 1, v86
s_lshl_b32 s43, s63, 5
s_branch Lov_8
.p2align 12
Lst_8_0:
s_branch Lwr_148
Lst_8_1:
s_branch Lwr_159
s_nop 0
Lov_8:
buffer_load_dwordx4 v3, s[8:11], s37 offen offset:2048 sc1 lds
s_add_u32 s43, s43, 149248
v_lshl_add_u32 v88, v88, 6, s43
v_lshl_add_u32 v88, v86, 4, v88
v_and_b32 v86, 15, v1
buffer_load_dwordx4 v3, s[8:11], s37 offen offset:3072 sc1 lds
s_lshl_b32 s43, s62, 9
s_add_u32 s43, s43, 147456
v_lshl_add_u32 v86, v86, 3, s43
s_add_u32 s38, s35, 2
s_and_b32 s38, s38, 15
s_mul_i32 s38, s38, 458752
s_add_u32 m0, s40, 0
s_nop 0
buffer_load_dwordx4 v4, s[12:15], s38 offen lds
ds_read_b128 v[32:35], v87 offset:0
ds_read_b128 v[36:39], v87 offset:64
ds_read_b128 v[40:43], v88 offset:0
ds_read_b128 v[44:47], v87 offset:896
s_add_u32 m0, s40, 1024
s_nop 0
buffer_load_dwordx4 v5, s[12:15], s38 offen lds
ds_read_b128 v[48:51], v87 offset:960
ds_read_b128 v[52:55], v88 offset:896
ds_read_b64 v[56:57], v86 offset:0
ds_read_b64 v[58:59], v86 offset:128
s_add_u32 m0, s40, 2048
s_add_u32 s38, s38, 57344
buffer_load_dwordx4 v4, s[12:15], s38 offen lds
ds_read_b64 v[60:61], v86 offset:256
ds_read_b64 v[62:63], v86 offset:384
s_mul_i32 s54, s35, 24576
s_add_u32 m0, s40, 3072
s_nop 0
buffer_load_dwordx4 v5, s[12:15], s38 offen lds
s_lshl_b32 s43, s62, 12
s_add_u32 s54, s54, s43
s_add_u32 s54, s54, 524288
s_lshl_b32 s43, s63, 9
s_add_u32 m0, s40, 4096
s_add_u32 s38, s38, 57344
buffer_load_dwordx4 v4, s[12:15], s38 offen lds
s_add_u32 s55, s54, s43
s_add_u32 s55, s55, 16384
s_lshl_b32 s43, s63, 13
s_add_u32 s54, s54, s43
s_add_u32 m0, s40, 5120
s_nop 0
buffer_load_dwordx4 v5, s[12:15], s38 offen lds
v_and_b32 v84, 32, v1
v_lshlrev_b32 v84, 4, v84
v_add_u32 v84, v84, v2
s_waitcnt lgkmcnt(0)
s_add_u32 m0, s40, 6144
s_add_u32 s38, s38, 57344
buffer_load_dwordx4 v4, s[12:15], s38 offen lds
s_add_u32 m0, s40, 7168
s_nop 0
buffer_load_dwordx4 v5, s[12:15], s38 offen lds
s_and_b32 s44, s36, 3
s_mul_i32 s43, s2, 28672
s_mul_i32 s44, s44, 7168
s_add_u32 s43, s43, s44
s_add_u32 s4, s76, s43
s_addc_u32 s5, s77, 0
s_barrier
s_cmp_eq_u32 s47, 3
s_cbranch_scc0 Lw_103
v_and_b32 v30, 31, v1
v_lshlrev_b32 v30, 4, v30
v_add_u32 v31, 153600, v30
ds_read_b128 v[108:111], v31 offset:0
ds_read_b128 v[112:115], v31 offset:512
ds_read_b128 v[116:119], v31 offset:1024
ds_read_b128 v[120:123], v31 offset:1536
s_and_b32 s44, s2, 15
s_mul_i32 s44, s44, 14336
s_lshr_b32 s43, s2, 4
s_lshl_b32 s43, s43, 9
s_add_u32 s44, s44, s43
s_waitcnt lgkmcnt(0)
v_add_f32 v108, v108, v112
v_add_f32 v116, v116, v120
v_add_f32 v109, v109, v113
v_add_f32 v117, v117, v121
v_add_f32 v110, v110, v114
v_add_f32 v118, v118, v122
v_add_f32 v111, v111, v115
v_add_f32 v119, v119, v123
v_add_f32 v108, v108, v116
v_add_f32 v109, v109, v117
v_add_f32 v110, v110, v118
v_add_f32 v111, v111, v119
s_mov_b64 exec, 0xffffffff
buffer_store_dwordx4 v[108:111], v30, s[84:87], s44 offen sc1
s_mov_b64 exec, -1
Lw_103:
s_waitcnt lgkmcnt(0)
s_add_u32 s37, s35, 3
s_and_b32 s37, s37, 15
s_mul_i32 s37, s37, 16384
s_add_u32 m0, s39, 49152
s_nop 0
buffer_load_dwordx4 v3, s[8:11], s37 offen sc1 lds
s_load_dword s3, s[4:5], 1792
s_load_dword s3, s[4:5], 1856
s_load_dword s3, s[4:5], 1920
s_load_dword s3, s[4:5], 1984
s_load_dword s3, s[4:5], 2048
s_load_dword s3, s[4:5], 2112
s_load_dword s3, s[4:5], 2176
buffer_load_dwordx4 v3, s[8:11], s37 offen offset:1024 sc1 lds
s_load_dword s3, s[4:5], 2240
s_load_dword s3, s[4:5], 2304
s_load_dword s3, s[4:5], 2368
s_load_dword s3, s[4:5], 2432
s_load_dword s3, s[4:5], 2496
s_load_dword s3, s[4:5], 2560
s_load_dword s3, s[4:5], 2624
buffer_load_dwordx4 v3, s[8:11], s37 offen offset:2048 sc1 lds
v_mul_f32 v66, v57, v57
v_mul_f32 v64, 0xc0135761, v57
v_mul_f32 v65, 0xbdd2d3e8, v57
v_mul_f32 v65, v65, v66
v_rcp_f32 v66, v66
v_mul_f32 v70, v59, v59
v_mul_f32 v68, 0xc0135761, v59
buffer_load_dwordx4 v3, s[8:11], s37 offen offset:3072 sc1 lds
v_mul_f32 v69, 0xbdd2d3e8, v59
v_mul_f32 v69, v69, v70
v_rcp_f32 v70, v70
v_fma_f32 v128, -v56, v32, v128
v_fma_f32 v129, -v56, v33, v129
v_fma_f32 v130, -v56, v34, v130
v_fma_f32 v131, -v56, v35, v131
v_fma_f32 v152, -v58, v32, v152
s_add_u32 s38, s35, 3
s_and_b32 s38, s38, 15
s_mul_i32 s38, s38, 458752
s_add_u32 m0, s40, 49152
s_nop 0
buffer_load_dwordx4 v4, s[12:15], s38 offen lds
v_fma_f32 v153, -v58, v33, v153
v_fma_f32 v154, -v58, v34, v154
v_fma_f32 v155, -v58, v35, v155
v_mul_f32 v72, v128, v128
v_mul_f32 v73, v129, v129
v_mul_f32 v74, v130, v130
v_mul_f32 v75, v131, v131
s_add_u32 m0, s40, 50176
s_nop 0
buffer_load_dwordx4 v5, s[12:15], s38 offen lds
v_mul_f32 v76, v152, v152
v_mul_f32 v77, v153, v153
v_mul_f32 v78, v154, v154
v_mul_f32 v79, v155, v155
v_fma_f32 v72, v72, v65, v64
v_fma_f32 v73, v73, v65, v64
v_fma_f32 v74, v74, v65, v64
s_add_u32 m0, s40, 51200
s_add_u32 s38, s38, 57344
buffer_load_dwordx4 v4, s[12:15], s38 offen lds
v_fma_f32 v75, v75, v65, v64
v_fma_f32 v76, v76, v69, v68
v_fma_f32 v77, v77, v69, v68
v_fma_f32 v78, v78, v69, v68
v_fma_f32 v79, v79, v69, v68
v_mul_f32 v72, v72, v128
v_mul_f32 v73, v73, v129
v_mul_f32 v74, v74, v130
s_add_u32 m0, s40, 52224
s_nop 0
buffer_load_dwordx4 v5, s[12:15], s38 offen lds
v_mul_f32 v75, v75, v131
v_mul_f32 v76, v76, v152
v_mul_f32 v77, v77, v153
v_mul_f32 v78, v78, v154
v_mul_f32 v79, v79, v155
v_exp_f32 v72, v72
v_exp_f32 v73, v73
s_add_u32 m0, s40, 53248
s_add_u32 s38, s38, 57344
buffer_load_dwordx4 v4, s[12:15], s38 offen lds
v_exp_f32 v74, v74
v_exp_f32 v75, v75
v_exp_f32 v76, v76
v_exp_f32 v77, v77
v_exp_f32 v78, v78
v_exp_f32 v79, v79
v_fma_f32 v140, -v56, v44, v140
s_add_u32 m0, s40, 54272
s_nop 0
buffer_load_dwordx4 v5, s[12:15], s38 offen lds
v_fma_f32 v141, -v56, v45, v141
v_fma_f32 v142, -v56, v46, v142
v_fma_f32 v143, -v56, v47, v143
v_fma_f32 v164, -v58, v44, v164
v_fma_f32 v165, -v58, v45, v165
v_fma_f32 v166, -v58, v46, v166
v_fma_f32 v167, -v58, v47, v167
v_fma_f32 v72, v72, v66, v66
s_add_u32 m0, s40, 55296
s_add_u32 s38, s38, 57344
buffer_load_dwordx4 v4, s[12:15], s38 offen lds
s_add_u32 m0, s40, 56320
s_nop 0
buffer_load_dwordx4 v5, s[12:15], s38 offen lds
s_waitcnt vmcnt(12)
s_barrier
s_add_u32 s37, s35, 4
s_and_b32 s37, s37, 15
s_mul_i32 s37, s37, 16384
s_add_u32 m0, s39, 98304
s_nop 0
buffer_load_dwordx4 v3, s[8:11], s37 offen sc1 lds
v_fma_f32 v73, v73, v66, v66
v_fma_f32 v74, v74, v66, v66
v_fma_f32 v75, v75, v66, v66
v_fma_f32 v76, v76, v70, v70
v_fma_f32 v77, v77, v70, v70
v_fma_f32 v78, v78, v70, v70
buffer_load_dwordx4 v3, s[8:11], s37 offen offset:1024 sc1 lds
v_fma_f32 v79, v79, v70, v70
v_rcp_f32 v72, v72
v_rcp_f32 v73, v73
v_rcp_f32 v74, v74
v_rcp_f32 v75, v75
v_rcp_f32 v76, v76
buffer_load_dwordx4 v3, s[8:11], s37 offen offset:2048 sc1 lds
v_rcp_f32 v77, v77
v_rcp_f32 v78, v78
v_rcp_f32 v79, v79
v_mul_f32 v140, v128, v140
v_mul_f32 v141, v129, v141
v_mul_f32 v142, v130, v142
buffer_load_dwordx4 v3, s[8:11], s37 offen offset:3072 sc1 lds
v_mul_f32 v143, v131, v143
v_mul_f32 v164, v152, v164
v_mul_f32 v165, v153, v165
v_mul_f32 v166, v154, v166
v_mul_f32 v167, v155, v167
v_mul_f32 v140, v140, v72
s_add_u32 s38, s35, 4
s_and_b32 s38, s38, 15
s_mul_i32 s38, s38, 458752
s_add_u32 m0, s40, 98304
s_nop 0
buffer_load_dwordx4 v4, s[12:15], s38 offen lds
v_mul_f32 v141, v141, v73
v_mul_f32 v142, v142, v74
v_mul_f32 v143, v143, v75
v_mul_f32 v164, v164, v76
v_mul_f32 v165, v165, v77
v_mul_f32 v166, v166, v78
s_add_u32 m0, s40, 99328
s_nop 0
buffer_load_dwordx4 v5, s[12:15], s38 offen lds
v_mul_f32 v167, v167, v79
v_cvt_pk_bf16_f32 v128, v140, v141
v_cvt_pk_bf16_f32 v129, v142, v143
v_cvt_pk_bf16_f32 v152, v164, v165
v_cvt_pk_bf16_f32 v153, v166, v167
v_fma_f32 v132, -v56, v36, v132
s_add_u32 m0, s40, 100352
s_add_u32 s38, s38, 57344
buffer_load_dwordx4 v4, s[12:15], s38 offen lds
v_fma_f32 v133, -v56, v37, v133
v_fma_f32 v134, -v56, v38, v134
v_fma_f32 v135, -v56, v39, v135
v_fma_f32 v156, -v58, v36, v156
v_fma_f32 v157, -v58, v37, v157
v_fma_f32 v158, -v58, v38, v158
s_add_u32 m0, s40, 101376
s_nop 0
buffer_load_dwordx4 v5, s[12:15], s38 offen lds
v_fma_f32 v159, -v58, v39, v159
v_mul_f32 v72, v132, v132
v_mul_f32 v73, v133, v133
v_mul_f32 v74, v134, v134
v_mul_f32 v75, v135, v135
v_mul_f32 v76, v156, v156
s_add_u32 m0, s40, 102400
s_add_u32 s38, s38, 57344
buffer_load_dwordx4 v4, s[12:15], s38 offen lds
v_mul_f32 v77, v157, v157
v_mul_f32 v78, v158, v158
v_mul_f32 v79, v159, v159
v_fma_f32 v72, v72, v65, v64
v_fma_f32 v73, v73, v65, v64
v_fma_f32 v74, v74, v65, v64
s_add_u32 m0, s40, 103424
s_nop 0
buffer_load_dwordx4 v5, s[12:15], s38 offen lds
v_fma_f32 v75, v75, v65, v64
v_fma_f32 v76, v76, v69, v68
v_fma_f32 v77, v77, v69, v68
v_fma_f32 v78, v78, v69, v68
v_fma_f32 v79, v79, v69, v68
v_mul_f32 v72, v72, v132
s_add_u32 m0, s40, 104448
s_add_u32 s38, s38, 57344
buffer_load_dwordx4 v4, s[12:15], s38 offen lds
s_add_u32 m0, s40, 105472
s_nop 0
buffer_load_dwordx4 v5, s[12:15], s38 offen lds
s_waitcnt vmcnt(12)
s_barrier
s_cmp_eq_u32 s47, 3
s_cbranch_scc0 Lw_104
s_lshr_b32 s43, s2, 4
s_add_u32 s43, s43, 80
s_lshl_b32 s43, s43, 7
v_mov_b32 v30, s43
v_mov_b32 v31, 1
s_mov_b64 exec, 1
buffer_atomic_add v31, v30, s[56:59], 0 offen sc1
s_mov_b64 exec, -1
Lw_104:
s_waitcnt lgkmcnt(0)
s_add_u32 s37, s35, 5
s_and_b32 s37, s37, 15
s_mul_i32 s37, s37, 16384
s_add_u32 m0, s39, 0
s_nop 0
buffer_load_dwordx4 v3, s[8:11], s37 offen sc1 lds
s_load_dword s3, s[4:5], 2688
s_load_dword s3, s[4:5], 2752
s_load_dword s3, s[4:5], 2816
s_load_dword s3, s[4:5], 2880
s_load_dword s3, s[4:5], 2944
s_load_dword s3, s[4:5], 3008
s_load_dword s3, s[4:5], 3072
buffer_load_dwordx4 v3, s[8:11], s37 offen offset:1024 sc1 lds
s_load_dword s3, s[4:5], 3136
s_load_dword s3, s[4:5], 3200
s_load_dword s3, s[4:5], 3264
s_load_dword s3, s[4:5], 3328
s_load_dword s3, s[4:5], 3392
s_load_dword s3, s[4:5], 3456
s_load_dword s3, s[4:5], 3520
buffer_load_dwordx4 v3, s[8:11], s37 offen offset:2048 sc1 lds
v_mul_f32 v73, v73, v133
v_mul_f32 v74, v74, v134
v_mul_f32 v75, v75, v135
v_mul_f32 v76, v76, v156
v_mul_f32 v77, v77, v157
v_mul_f32 v78, v78, v158
v_mul_f32 v79, v79, v159
v_exp_f32 v72, v72
buffer_load_dwordx4 v3, s[8:11], s37 offen offset:3072 sc1 lds
v_exp_f32 v73, v73
v_exp_f32 v74, v74
v_exp_f32 v75, v75
v_exp_f32 v76, v76
v_exp_f32 v77, v77
v_exp_f32 v78, v78
v_exp_f32 v79, v79
s_add_u32 s38, s35, 5
s_and_b32 s38, s38, 15
s_mul_i32 s38, s38, 458752
s_add_u32 m0, s40, 0
s_nop 0
buffer_load_dwordx4 v4, s[12:15], s38 offen lds
v_fma_f32 v144, -v56, v48, v144
v_fma_f32 v145, -v56, v49, v145
v_fma_f32 v146, -v56, v50, v146
v_fma_f32 v147, -v56, v51, v147
v_fma_f32 v168, -v58, v48, v168
v_fma_f32 v169, -v58, v49, v169
v_fma_f32 v170, -v58, v50, v170
v_fma_f32 v171, -v58, v51, v171
s_add_u32 m0, s40, 1024
s_nop 0
buffer_load_dwordx4 v5, s[12:15], s38 offen lds
v_fma_f32 v72, v72, v66, v66
v_fma_f32 v73, v73, v66, v66
v_fma_f32 v74, v74, v66, v66
v_fma_f32 v75, v75, v66, v66
v_fma_f32 v76, v76, v70, v70
v_fma_f32 v77, v77, v70, v70
v_fma_f32 v78, v78, v70, v70
s_add_u32 m0, s40, 2048
s_add_u32 s38, s38, 57344
buffer_load_dwordx4 v4, s[12:15], s38 offen lds
v_fma_f32 v79, v79, v70, v70
v_rcp_f32 v72, v72
v_rcp_f32 v73, v73
v_rcp_f32 v74, v74
v_rcp_f32 v75, v75
v_rcp_f32 v76, v76
v_rcp_f32 v77, v77
s_add_u32 m0, s40, 3072
s_nop 0
buffer_load_dwordx4 v5, s[12:15], s38 offen lds
v_rcp_f32 v78, v78
v_rcp_f32 v79, v79
v_mul_f32 v144, v132, v144
v_mul_f32 v145, v133, v145
v_mul_f32 v146, v134, v146
v_mul_f32 v147, v135, v147
v_mul_f32 v168, v156, v168
v_mul_f32 v169, v157, v169
s_add_u32 m0, s40, 4096
s_add_u32 s38, s38, 57344
buffer_load_dwordx4 v4, s[12:15], s38 offen lds
v_mul_f32 v170, v158, v170
v_mul_f32 v171, v159, v171
v_mul_f32 v144, v144, v72
v_mul_f32 v145, v145, v73
v_mul_f32 v146, v146, v74
v_mul_f32 v147, v147, v75
v_mul_f32 v168, v168, v76
s_add_u32 m0, s40, 5120
s_nop 0
buffer_load_dwordx4 v5, s[12:15], s38 offen lds
v_mul_f32 v169, v169, v77
v_mul_f32 v170, v170, v78
v_mul_f32 v171, v171, v79
v_cvt_pk_bf16_f32 v130, v144, v145
v_cvt_pk_bf16_f32 v131, v146, v147
v_cvt_pk_bf16_f32 v154, v168, v169
v_cvt_pk_bf16_f32 v155, v170, v171
buffer_store_dwordx4 v[128:131], v2, s[24:27], s54 offen offset:0 sc1
s_add_u32 m0, s40, 6144
s_add_u32 s38, s38, 57344
buffer_load_dwordx4 v4, s[12:15], s38 offen lds
s_add_u32 m0, s40, 7168
s_nop 0
buffer_load_dwordx4 v5, s[12:15], s38 offen lds
s_waitcnt vmcnt(13)
s_barrier
s_add_u32 s37, s35, 6
s_and_b32 s37, s37, 15
s_mul_i32 s37, s37, 16384
s_add_u32 m0, s39, 49152
s_nop 0
buffer_load_dwordx4 v3, s[8:11], s37 offen sc1 lds
buffer_store_dwordx4 v[152:155], v2, s[24:27], s54 offen offset:1024 sc1
v_fma_f32 v136, -v56, v40, v136
v_fma_f32 v137, -v56, v41, v137
v_fma_f32 v138, -v56, v42, v138
v_fma_f32 v139, -v56, v43, v139
v_fma_f32 v160, -v58, v40, v160
buffer_load_dwordx4 v3, s[8:11], s37 offen offset:1024 sc1 lds
v_fma_f32 v161, -v58, v41, v161
v_fma_f32 v162, -v58, v42, v162
v_fma_f32 v163, -v58, v43, v163
v_mul_f32 v72, v136, v136
v_mul_f32 v73, v137, v137
v_mul_f32 v74, v138, v138
buffer_load_dwordx4 v3, s[8:11], s37 offen offset:2048 sc1 lds
v_mul_f32 v75, v139, v139
v_mul_f32 v76, v160, v160
v_mul_f32 v77, v161, v161
v_mul_f32 v78, v162, v162
v_mul_f32 v79, v163, v163
v_fma_f32 v72, v72, v65, v64
buffer_load_dwordx4 v3, s[8:11], s37 offen offset:3072 sc1 lds
v_fma_f32 v73, v73, v65, v64
v_fma_f32 v74, v74, v65, v64
v_fma_f32 v75, v75, v65, v64
v_fma_f32 v76, v76, v69, v68
v_fma_f32 v77, v77, v69, v68
v_fma_f32 v78, v78, v69, v68
s_add_u32 s38, s35, 6
s_and_b32 s38, s38, 15
s_mul_i32 s38, s38, 458752
s_add_u32 m0, s40, 49152
s_nop 0
buffer_load_dwordx4 v4, s[12:15], s38 offen lds
v_fma_f32 v79, v79, v69, v68
v_mul_f32 v72, v72, v136
v_mul_f32 v73, v73, v137
v_mul_f32 v74, v74, v138
v_mul_f32 v75, v75, v139
v_mul_f32 v76, v76, v160
s_add_u32 m0, s40, 50176
s_nop 0
buffer_load_dwordx4 v5, s[12:15], s38 offen lds
v_mul_f32 v77, v77, v161
v_mul_f32 v78, v78, v162
v_mul_f32 v79, v79, v163
v_exp_f32 v72, v72
v_exp_f32 v73, v73
v_exp_f32 v74, v74
s_add_u32 m0, s40, 51200
s_add_u32 s38, s38, 57344
buffer_load_dwordx4 v4, s[12:15], s38 offen lds
v_exp_f32 v75, v75
v_exp_f32 v76, v76
v_exp_f32 v77, v77
v_exp_f32 v78, v78
v_exp_f32 v79, v79
v_fma_f32 v148, -v56, v52, v148
s_add_u32 m0, s40, 52224
s_nop 0
buffer_load_dwordx4 v5, s[12:15], s38 offen lds
v_fma_f32 v149, -v56, v53, v149
v_fma_f32 v150, -v56, v54, v150
v_fma_f32 v151, -v56, v55, v151
v_fma_f32 v172, -v58, v52, v172
v_fma_f32 v173, -v58, v53, v173
v_fma_f32 v174, -v58, v54, v174
s_add_u32 m0, s40, 53248
s_add_u32 s38, s38, 57344
buffer_load_dwordx4 v4, s[12:15], s38 offen lds
v_fma_f32 v175, -v58, v55, v175
v_fma_f32 v72, v72, v66, v66
v_fma_f32 v73, v73, v66, v66
v_fma_f32 v74, v74, v66, v66
v_fma_f32 v75, v75, v66, v66
v_fma_f32 v76, v76, v70, v70
s_add_u32 m0, s40, 54272
s_nop 0
buffer_load_dwordx4 v5, s[12:15], s38 offen lds
v_fma_f32 v77, v77, v70, v70
v_fma_f32 v78, v78, v70, v70
v_fma_f32 v79, v79, v70, v70
v_rcp_f32 v72, v72
v_rcp_f32 v73, v73
v_rcp_f32 v74, v74
s_add_u32 m0, s40, 55296
s_add_u32 s38, s38, 57344
buffer_load_dwordx4 v4, s[12:15], s38 offen lds
s_add_u32 m0, s40, 56320
s_nop 0
buffer_load_dwordx4 v5, s[12:15], s38 offen lds
s_waitcnt vmcnt(13)
s_barrier
s_waitcnt lgkmcnt(0)
s_add_u32 s37, s35, 7
s_and_b32 s37, s37, 15
s_mul_i32 s37, s37, 16384
s_add_u32 m0, s39, 98304
s_nop 0
buffer_load_dwordx4 v3, s[8:11], s37 offen sc1 lds
s_load_dword s3, s[4:5], 3584
s_load_dword s3, s[4:5], 3648
s_load_dword s3, s[4:5], 3712
s_load_dword s3, s[4:5], 3776
s_load_dword s3, s[4:5], 3840
s_load_dword s3, s[4:5], 3904
s_load_dword s3, s[4:5], 3968
buffer_load_dwordx4 v3, s[8:11], s37 offen offset:1024 sc1 lds
s_load_dword s3, s[4:5], 4032
s_load_dword s3, s[4:5], 4096
s_load_dword s3, s[4:5], 4160
s_load_dword s3, s[4:5], 4224
s_load_dword s3, s[4:5], 4288
s_load_dword s3, s[4:5], 4352
s_load_dword s3, s[4:5], 4416
buffer_load_dwordx4 v3, s[8:11], s37 offen offset:2048 sc1 lds
v_rcp_f32 v75, v75
v_rcp_f32 v76, v76
v_rcp_f32 v77, v77
v_rcp_f32 v78, v78
v_rcp_f32 v79, v79
v_mul_f32 v148, v136, v148
v_mul_f32 v149, v137, v149
buffer_load_dwordx4 v3, s[8:11], s37 offen offset:3072 sc1 lds
v_mul_f32 v150, v138, v150
v_mul_f32 v151, v139, v151
v_mul_f32 v172, v160, v172
v_mul_f32 v173, v161, v173
v_mul_f32 v174, v162, v174
v_mul_f32 v175, v163, v175
v_mul_f32 v148, v148, v72
v_mul_f32 v149, v149, v73
s_add_u32 s38, s35, 7
s_and_b32 s38, s38, 15
s_mul_i32 s38, s38, 458752
s_add_u32 m0, s40, 98304
s_nop 0
buffer_load_dwordx4 v4, s[12:15], s38 offen lds
v_mul_f32 v150, v150, v74
v_mul_f32 v151, v151, v75
v_mul_f32 v172, v172, v76
v_mul_f32 v173, v173, v77
v_mul_f32 v174, v174, v78
v_mul_f32 v175, v175, v79
v_cvt_pk_bf16_f32 v80, v148, v149
s_add_u32 m0, s40, 99328
s_nop 0
buffer_load_dwordx4 v5, s[12:15], s38 offen lds
v_cvt_pk_bf16_f32 v81, v150, v151
v_cvt_pk_bf16_f32 v82, v172, v173
v_cvt_pk_bf16_f32 v83, v174, v175
s_nop 1
v_permlane32_swap_b32 v80, v82
v_permlane32_swap_b32 v81, v83
buffer_store_dwordx4 v[80:83], v84, s[24:27], s55 offen offset:0 sc1
s_add_u32 m0, s40, 100352
s_add_u32 s38, s38, 57344
buffer_load_dwordx4 v4, s[12:15], s38 offen lds
s_nop 1
v_mul_f32 v66, v61, v61
v_mul_f32 v64, 0xc0135761, v61
v_mul_f32 v65, 0xbdd2d3e8, v61
v_mul_f32 v65, v65, v66
v_rcp_f32 v66, v66
v_mul_f32 v70, v63, v63
v_mul_f32 v68, 0xc0135761, v63
s_add_u32 m0, s40, 101376
s_nop 0
buffer_load_dwordx4 v5, s[12:15], s38 offen lds
v_mul_f32 v69, 0xbdd2d3e8, v63
v_mul_f32 v69, v69, v70
v_rcp_f32 v70, v70
v_fma_f32 v176, -v60, v32, v176
v_fma_f32 v177, -v60, v33, v177
v_fma_f32 v178, -v60, v34, v178
v_fma_f32 v179, -v60, v35, v179
s_add_u32 m0, s40, 102400
s_add_u32 s38, s38, 57344
buffer_load_dwordx4 v4, s[12:15], s38 offen lds
v_fma_f32 v200, -v62, v32, v200
v_fma_f32 v201, -v62, v33, v201
v_fma_f32 v202, -v62, v34, v202
v_fma_f32 v203, -v62, v35, v203
v_mul_f32 v72, v176, v176
v_mul_f32 v73, v177, v177
v_mul_f32 v74, v178, v178
s_add_u32 m0, s40, 103424
s_nop 0
buffer_load_dwordx4 v5, s[12:15], s38 offen lds
v_mul_f32 v75, v179, v179
v_mul_f32 v76, v200, v200
v_mul_f32 v77, v201, v201
v_mul_f32 v78, v202, v202
v_mul_f32 v79, v203, v203
v_fma_f32 v72, v72, v65, v64
v_fma_f32 v73, v73, v65, v64
v_fma_f32 v74, v74, v65, v64
s_add_u32 m0, s40, 104448
s_add_u32 s38, s38, 57344
buffer_load_dwordx4 v4, s[12:15], s38 offen lds
s_add_u32 m0, s40, 105472
s_nop 0
buffer_load_dwordx4 v5, s[12:15], s38 offen lds
s_waitcnt vmcnt(13)
s_barrier
s_add_u32 s37, s35, 8
s_and_b32 s37, s37, 15
s_mul_i32 s37, s37, 16384
s_add_u32 m0, s39, 0
s_nop 0
buffer_load_dwordx4 v3, s[8:11], s37 offen sc1 lds
v_fma_f32 v75, v75, v65, v64
v_fma_f32 v76, v76, v69, v68
v_fma_f32 v77, v77, v69, v68
v_fma_f32 v78, v78, v69, v68
v_fma_f32 v79, v79, v69, v68
v_mul_f32 v72, v72, v176
buffer_load_dwordx4 v3, s[8:11], s37 offen offset:1024 sc1 lds
v_mul_f32 v73, v73, v177
v_mul_f32 v74, v74, v178
v_mul_f32 v75, v75, v179
v_mul_f32 v76, v76, v200
v_mul_f32 v77, v77, v201
v_mul_f32 v78, v78, v202
buffer_load_dwordx4 v3, s[8:11], s37 offen offset:2048 sc1 lds
v_mul_f32 v79, v79, v203
s_branch Lov_9
.p2align 12
Lst_9_0:
s_branch Lwr_149
Lst_9_1:
s_branch Lwr_160
s_nop 0
Lov_9:
v_exp_f32 v72, v72
v_exp_f32 v73, v73
v_exp_f32 v74, v74
v_exp_f32 v75, v75
v_exp_f32 v76, v76
buffer_load_dwordx4 v3, s[8:11], s37 offen offset:3072 sc1 lds
v_exp_f32 v77, v77
v_exp_f32 v78, v78
v_exp_f32 v79, v79
v_fma_f32 v188, -v60, v44, v188
v_fma_f32 v189, -v60, v45, v189
v_fma_f32 v190, -v60, v46, v190
s_add_u32 s38, s35, 8
s_and_b32 s38, s38, 15
s_mul_i32 s38, s38, 458752
s_add_u32 m0, s40, 0
s_nop 0
buffer_load_dwordx4 v4, s[12:15], s38 offen lds
v_fma_f32 v191, -v60, v47, v191
v_fma_f32 v212, -v62, v44, v212
v_fma_f32 v213, -v62, v45, v213
v_fma_f32 v214, -v62, v46, v214
v_fma_f32 v215, -v62, v47, v215
v_fma_f32 v72, v72, v66, v66
s_add_u32 m0, s40, 1024
s_nop 0
buffer_load_dwordx4 v5, s[12:15], s38 offen lds
v_fma_f32 v73, v73, v66, v66
v_fma_f32 v74, v74, v66, v66
v_fma_f32 v75, v75, v66, v66
v_fma_f32 v76, v76, v70, v70
v_fma_f32 v77, v77, v70, v70
v_fma_f32 v78, v78, v70, v70
s_add_u32 m0, s40, 2048
s_add_u32 s38, s38, 57344
buffer_load_dwordx4 v4, s[12:15], s38 offen lds
v_fma_f32 v79, v79, v70, v70
v_rcp_f32 v72, v72
v_rcp_f32 v73, v73
v_rcp_f32 v74, v74
v_rcp_f32 v75, v75
v_rcp_f32 v76, v76
s_add_u32 m0, s40, 3072
s_nop 0
buffer_load_dwordx4 v5, s[12:15], s38 offen lds
v_rcp_f32 v77, v77
v_rcp_f32 v78, v78
v_rcp_f32 v79, v79
v_mul_f32 v188, v176, v188
v_mul_f32 v189, v177, v189
v_mul_f32 v190, v178, v190
s_add_u32 m0, s40, 4096
s_add_u32 s38, s38, 57344
buffer_load_dwordx4 v4, s[12:15], s38 offen lds
v_mul_f32 v191, v179, v191
v_mul_f32 v212, v200, v212
v_mul_f32 v213, v201, v213
v_mul_f32 v214, v202, v214
v_mul_f32 v215, v203, v215
v_mul_f32 v188, v188, v72
s_add_u32 m0, s40, 5120
s_nop 0
buffer_load_dwordx4 v5, s[12:15], s38 offen lds
v_mul_f32 v189, v189, v73
v_mul_f32 v190, v190, v74
v_mul_f32 v191, v191, v75
v_mul_f32 v212, v212, v76
v_mul_f32 v213, v213, v77
v_mul_f32 v214, v214, v78
s_add_u32 m0, s40, 6144
s_add_u32 s38, s38, 57344
buffer_load_dwordx4 v4, s[12:15], s38 offen lds
s_add_u32 m0, s40, 7168
s_nop 0
buffer_load_dwordx4 v5, s[12:15], s38 offen lds
s_waitcnt vmcnt(12)
s_barrier
s_waitcnt lgkmcnt(0)
s_cmp_eq_u32 s47, 3
s_cbranch_scc0 Lw_105
s_lshl_b32 s92, s35, 7
s_add_u32 s92, s92, 28321792
s_load_dword s93, s[82:83], s92 glc
Lw_105:
s_add_u32 s37, s35, 9
s_and_b32 s37, s37, 15
s_mul_i32 s37, s37, 16384
s_add_u32 m0, s39, 49152
s_nop 0
buffer_load_dwordx4 v3, s[8:11], s37 offen sc1 lds
s_load_dword s3, s[4:5], 4480
s_load_dword s3, s[4:5], 4544
s_load_dword s3, s[4:5], 4608
s_load_dword s3, s[4:5], 4672
s_load_dword s3, s[4:5], 4736
s_load_dword s3, s[4:5], 4800
s_load_dword s3, s[4:5], 4864
buffer_load_dwordx4 v3, s[8:11], s37 offen offset:1024 sc1 lds
s_load_dword s3, s[4:5], 4928
s_load_dword s3, s[4:5], 4992
s_load_dword s3, s[4:5], 5056
s_load_dword s3, s[4:5], 5120
s_load_dword s3, s[4:5], 5184
s_load_dword s3, s[4:5], 5248
s_load_dword s3, s[4:5], 5312
buffer_load_dwordx4 v3, s[8:11], s37 offen offset:2048 sc1 lds
v_mul_f32 v215, v215, v79
v_cvt_pk_bf16_f32 v176, v188, v189
v_cvt_pk_bf16_f32 v177, v190, v191
v_cvt_pk_bf16_f32 v200, v212, v213
v_cvt_pk_bf16_f32 v201, v214, v215
v_fma_f32 v180, -v60, v36, v180
v_fma_f32 v181, -v60, v37, v181
v_fma_f32 v182, -v60, v38, v182
buffer_load_dwordx4 v3, s[8:11], s37 offen offset:3072 sc1 lds
v_fma_f32 v183, -v60, v39, v183
v_fma_f32 v204, -v62, v36, v204
v_fma_f32 v205, -v62, v37, v205
v_fma_f32 v206, -v62, v38, v206
v_fma_f32 v207, -v62, v39, v207
v_mul_f32 v72, v180, v180
v_mul_f32 v73, v181, v181
s_add_u32 s38, s35, 9
s_and_b32 s38, s38, 15
s_mul_i32 s38, s38, 458752
s_add_u32 m0, s40, 49152
s_nop 0
buffer_load_dwordx4 v4, s[12:15], s38 offen lds
v_mul_f32 v74, v182, v182
v_mul_f32 v75, v183, v183
v_mul_f32 v76, v204, v204
v_mul_f32 v77, v205, v205
v_mul_f32 v78, v206, v206
v_mul_f32 v79, v207, v207
v_fma_f32 v72, v72, v65, v64
v_fma_f32 v73, v73, v65, v64
s_add_u32 m0, s40, 50176
s_nop 0
buffer_load_dwordx4 v5, s[12:15], s38 offen lds
v_fma_f32 v74, v74, v65, v64
v_fma_f32 v75, v75, v65, v64
v_fma_f32 v76, v76, v69, v68
v_fma_f32 v77, v77, v69, v68
v_fma_f32 v78, v78, v69, v68
v_fma_f32 v79, v79, v69, v68
v_mul_f32 v72, v72, v180
s_add_u32 m0, s40, 51200
s_add_u32 s38, s38, 57344
buffer_load_dwordx4 v4, s[12:15], s38 offen lds
v_mul_f32 v73, v73, v181
v_mul_f32 v74, v74, v182
v_mul_f32 v75, v75, v183
v_mul_f32 v76, v76, v204
v_mul_f32 v77, v77, v205
v_mul_f32 v78, v78, v206
v_mul_f32 v79, v79, v207
s_add_u32 m0, s40, 52224
s_nop 0
buffer_load_dwordx4 v5, s[12:15], s38 offen lds
v_exp_f32 v72, v72
v_exp_f32 v73, v73
v_exp_f32 v74, v74
v_exp_f32 v75, v75
v_exp_f32 v76, v76
v_exp_f32 v77, v77
v_exp_f32 v78, v78
v_exp_f32 v79, v79
s_add_u32 m0, s40, 53248
s_add_u32 s38, s38, 57344
buffer_load_dwordx4 v4, s[12:15], s38 offen lds
v_fma_f32 v192, -v60, v48, v192
v_fma_f32 v193, -v60, v49, v193
v_fma_f32 v194, -v60, v50, v194
v_fma_f32 v195, -v60, v51, v195
v_fma_f32 v216, -v62, v48, v216
v_fma_f32 v217, -v62, v49, v217
v_fma_f32 v218, -v62, v50, v218
s_add_u32 m0, s40, 54272
s_nop 0
buffer_load_dwordx4 v5, s[12:15], s38 offen lds
v_fma_f32 v219, -v62, v51, v219
v_fma_f32 v72, v72, v66, v66
v_fma_f32 v73, v73, v66, v66
v_fma_f32 v74, v74, v66, v66
v_fma_f32 v75, v75, v66, v66
v_fma_f32 v76, v76, v70, v70
v_fma_f32 v77, v77, v70, v70
v_fma_f32 v78, v78, v70, v70
s_add_u32 m0, s40, 55296
s_add_u32 s38, s38, 57344
buffer_load_dwordx4 v4, s[12:15], s38 offen lds
s_add_u32 m0, s40, 56320
s_nop 0
buffer_load_dwordx4 v5, s[12:15], s38 offen lds
s_waitcnt vmcnt(12)
s_barrier
s_add_u32 s37, s35, 10
s_and_b32 s37, s37, 15
s_mul_i32 s37, s37, 16384
s_add_u32 m0, s39, 98304
s_nop 0
buffer_load_dwordx4 v3, s[8:11], s37 offen sc1 lds
v_fma_f32 v79, v79, v70, v70
v_rcp_f32 v72, v72
v_rcp_f32 v73, v73
v_rcp_f32 v74, v74
v_rcp_f32 v75, v75
v_rcp_f32 v76, v76
buffer_load_dwordx4 v3, s[8:11], s37 offen offset:1024 sc1 lds
v_rcp_f32 v77, v77
v_rcp_f32 v78, v78
v_rcp_f32 v79, v79
v_mul_f32 v192, v180, v192
v_mul_f32 v193, v181, v193
v_mul_f32 v194, v182, v194
buffer_load_dwordx4 v3, s[8:11], s37 offen offset:2048 sc1 lds
v_mul_f32 v195, v183, v195
v_mul_f32 v216, v204, v216
v_mul_f32 v217, v205, v217
v_mul_f32 v218, v206, v218
v_mul_f32 v219, v207, v219
v_mul_f32 v192, v192, v72
buffer_load_dwordx4 v3, s[8:11], s37 offen offset:3072 sc1 lds
v_mul_f32 v193, v193, v73
v_mul_f32 v194, v194, v74
v_mul_f32 v195, v195, v75
v_mul_f32 v216, v216, v76
v_mul_f32 v217, v217, v77
v_mul_f32 v218, v218, v78
s_add_u32 s38, s35, 10
s_and_b32 s38, s38, 15
s_mul_i32 s38, s38, 458752
s_add_u32 m0, s40, 98304
s_nop 0
buffer_load_dwordx4 v4, s[12:15], s38 offen lds
v_mul_f32 v219, v219, v79
v_cvt_pk_bf16_f32 v178, v192, v193
v_cvt_pk_bf16_f32 v179, v194, v195
v_cvt_pk_bf16_f32 v202, v216, v217
v_cvt_pk_bf16_f32 v203, v218, v219
buffer_store_dwordx4 v[176:179], v2, s[24:27], s54 offen offset:2048 sc1
s_add_u32 m0, s40, 99328
s_nop 0
buffer_load_dwordx4 v5, s[12:15], s38 offen lds
buffer_store_dwordx4 v[200:203], v2, s[24:27], s54 offen offset:3072 sc1
v_fma_f32 v184, -v60, v40, v184
v_fma_f32 v185, -v60, v41, v185
v_fma_f32 v186, -v60, v42, v186
v_fma_f32 v187, -v60, v43, v187
v_fma_f32 v208, -v62, v40, v208
s_add_u32 m0, s40, 100352
s_add_u32 s38, s38, 57344
buffer_load_dwordx4 v4, s[12:15], s38 offen lds
v_fma_f32 v209, -v62, v41, v209
v_fma_f32 v210, -v62, v42, v210
v_fma_f32 v211, -v62, v43, v211
v_mul_f32 v72, v184, v184
v_mul_f32 v73, v185, v185
v_mul_f32 v74, v186, v186
s_add_u32 m0, s40, 101376
s_nop 0
buffer_load_dwordx4 v5, s[12:15], s38 offen lds
v_mul_f32 v75, v187, v187
v_mul_f32 v76, v208, v208
v_mul_f32 v77, v209, v209
v_mul_f32 v78, v210, v210
v_mul_f32 v79, v211, v211
v_fma_f32 v72, v72, v65, v64
s_add_u32 m0, s40, 102400
s_add_u32 s38, s38, 57344
buffer_load_dwordx4 v4, s[12:15], s38 offen lds
v_fma_f32 v73, v73, v65, v64
v_fma_f32 v74, v74, v65, v64
v_fma_f32 v75, v75, v65, v64
v_fma_f32 v76, v76, v69, v68
v_fma_f32 v77, v77, v69, v68
v_fma_f32 v78, v78, v69, v68
s_add_u32 m0, s40, 103424
s_nop 0
buffer_load_dwordx4 v5, s[12:15], s38 offen lds
v_fma_f32 v79, v79, v69, v68
v_mul_f32 v72, v72, v184
v_mul_f32 v73, v73, v185
v_mul_f32 v74, v74, v186
v_mul_f32 v75, v75, v187
v_mul_f32 v76, v76, v208
s_add_u32 m0, s40, 104448
s_add_u32 s38, s38, 57344
buffer_load_dwordx4 v4, s[12:15], s38 offen lds
s_add_u32 m0, s40, 105472
s_nop 0
buffer_load_dwordx4 v5, s[12:15], s38 offen lds
s_waitcnt vmcnt(14)
s_cmp_eq_u32 s47, 3
s_cbranch_scc0 Lw_106
s_mov_b32 s41, 0x40000
s_branch Lpchk_109
Lpoll_107:
s_load_dword s93, s[82:83], s92 glc
Lpchk_109:
s_waitcnt lgkmcnt(0)
s_cmp_eq_u32 s93, 16
s_cbranch_scc1 Lpok_108
s_sub_u32 s41, s41, 1
s_cmp_lg_u32 s41, 0
s_cbranch_scc1 Lpoll_107
Lpok_108:
Lw_106:
s_barrier
s_lshl_b32 s60, s35, 9
s_lshl_b32 s43, s47, 7
s_add_u32 s60, s60, s43
s_add_u32 s61, s60, 14336
s_add_u32 s52, s43, 148480
s_add_u32 s53, s52, 896
v_lshrrev_b32 v104, 3, v1
v_mul_u32_u24 v104, 28672, v104
v_and_b32 v105, 7, v1
v_lshl_add_u32 v104, v105, 4, v104
s_waitcnt lgkmcnt(0)
buffer_load_dwordx4 v[96:99], v104, s[84:87], s60 offen sc1
s_load_dword s3, s[4:5], 5376
s_load_dword s3, s[4:5], 5440
s_load_dword s3, s[4:5], 5504
s_load_dword s3, s[4:5], 5568
s_load_dword s3, s[4:5], 5632
s_load_dword s3, s[4:5], 5696
buffer_load_dwordx4 v[100:103], v104, s[84:87], s61 offen sc1
s_load_dword s3, s[4:5], 5760
s_load_dword s3, s[4:5], 5824
s_load_dword s3, s[4:5], 5888
s_load_dword s3, s[4:5], 5952
s_load_dword s3, s[4:5], 6016
s_load_dword s3, s[4:5], 6080
s_load_dword s3, s[4:5], 6144
s_add_u32 s37, s35, 11
s_and_b32 s37, s37, 15
s_mul_i32 s37, s37, 16384
s_add_u32 m0, s39, 0
s_nop 0
buffer_load_dwordx4 v3, s[8:11], s37 offen sc1 lds
s_load_dword s3, s[4:5], 6208
v_mul_f32 v77, v77, v209
v_mul_f32 v78, v78, v210
v_mul_f32 v79, v79, v211
v_exp_f32 v72, v72
v_exp_f32 v73, v73
v_exp_f32 v74, v74
buffer_load_dwordx4 v3, s[8:11], s37 offen offset:1024 sc1 lds
v_exp_f32 v75, v75
v_exp_f32 v76, v76
v_exp_f32 v77, v77
v_exp_f32 v78, v78
v_exp_f32 v79, v79
v_fma_f32 v196, -v60, v52, v196
v_fma_f32 v197, -v60, v53, v197
buffer_load_dwordx4 v3, s[8:11], s37 offen offset:2048 sc1 lds
v_fma_f32 v198, -v60, v54, v198
v_fma_f32 v199, -v60, v55, v199
v_fma_f32 v220, -v62, v52, v220
v_fma_f32 v221, -v62, v53, v221
v_fma_f32 v222, -v62, v54, v222
v_fma_f32 v223, -v62, v55, v223
buffer_load_dwordx4 v3, s[8:11], s37 offen offset:3072 sc1 lds
v_fma_f32 v72, v72, v66, v66
v_fma_f32 v73, v73, v66, v66
v_fma_f32 v74, v74, v66, v66
v_fma_f32 v75, v75, v66, v66
v_fma_f32 v76, v76, v70, v70
v_fma_f32 v77, v77, v70, v70
v_fma_f32 v78, v78, v70, v70
s_add_u32 s38, s35, 11
s_and_b32 s38, s38, 15
s_mul_i32 s38, s38, 458752
s_add_u32 m0, s40, 0
s_nop 0
buffer_load_dwordx4 v4, s[12:15], s38 offen lds
v_fma_f32 v79, v79, v70, v70
v_rcp_f32 v72, v72
v_rcp_f32 v73, v73
v_rcp_f32 v74, v74
v_rcp_f32 v75, v75
v_rcp_f32 v76, v76
v_rcp_f32 v77, v77
s_add_u32 m0, s40, 1024
s_nop 0
buffer_load_dwordx4 v5, s[12:15], s38 offen lds
v_rcp_f32 v78, v78
v_rcp_f32 v79, v79
v_mul_f32 v196, v184, v196
v_mul_f32 v197, v185, v197
v_mul_f32 v198, v186, v198
v_mul_f32 v199, v187, v199
v_mul_f32 v220, v208, v220
s_add_u32 m0, s40, 2048
s_add_u32 s38, s38, 57344
buffer_load_dwordx4 v4, s[12:15], s38 offen lds
v_mul_f32 v221, v209, v221
v_mul_f32 v222, v210, v222
v_mul_f32 v223, v211, v223
v_mul_f32 v196, v196, v72
v_mul_f32 v197, v197, v73
v_mul_f32 v198, v198, v74
s_add_u32 m0, s40, 3072
s_nop 0
buffer_load_dwordx4 v5, s[12:15], s38 offen lds
v_mul_f32 v199, v199, v75
v_mul_f32 v220, v220, v76
v_mul_f32 v221, v221, v77
v_mul_f32 v222, v222, v78
v_mul_f32 v223, v223, v79
v_cvt_pk_bf16_f32 v80, v196, v197
v_cvt_pk_bf16_f32 v81, v198, v199
s_add_u32 m0, s40, 4096
s_add_u32 s38, s38, 57344
buffer_load_dwordx4 v4, s[12:15], s38 offen lds
v_cvt_pk_bf16_f32 v82, v220, v221
v_cvt_pk_bf16_f32 v83, v222, v223
s_nop 1
v_permlane32_swap_b32 v80, v82
v_permlane32_swap_b32 v81, v83
buffer_store_dwordx4 v[80:83], v84, s[24:27], s55 offen offset:2048 sc1
s_nop 1
s_add_u32 m0, s40, 5120
s_nop 0
buffer_load_dwordx4 v5, s[12:15], s38 offen lds
v_cmp_gt_u32 vcc, 32, v1
v_mov_b32 v104, s52
v_mov_b32 v106, s53
v_cndmask_b32 v104, v106, v104, vcc
v_lshl_add_u32 v104, v105, 4, v104
v_bfe_u32 v105, v1, 4, 1
v_lshl_add_u32 v104, v105, 2, v104
s_add_u32 m0, s40, 6144
s_add_u32 s38, s38, 57344
buffer_load_dwordx4 v4, s[12:15], s38 offen lds
s_add_u32 m0, s40, 7168
s_nop 0
buffer_load_dwordx4 v5, s[12:15], s38 offen lds
s_waitcnt vmcnt(15)
s_barrier
s_add_u32 s37, s35, 12
s_and_b32 s37, s37, 15
s_mul_i32 s37, s37, 16384
s_add_u32 m0, s39, 49152
s_nop 0
buffer_load_dwordx4 v3, s[8:11], s37 offen sc1 lds
buffer_load_dwordx4 v3, s[8:11], s37 offen offset:1024 sc1 lds
buffer_load_dwordx4 v3, s[8:11], s37 offen offset:2048 sc1 lds
buffer_load_dwordx4 v3, s[8:11], s37 offen offset:3072 sc1 lds
s_add_u32 s38, s35, 12
s_and_b32 s38, s38, 15
s_mul_i32 s38, s38, 458752
s_add_u32 m0, s40, 49152
s_nop 0
buffer_load_dwordx4 v4, s[12:15], s38 offen lds
s_add_u32 m0, s40, 50176
s_nop 0
buffer_load_dwordx4 v5, s[12:15], s38 offen lds
s_add_u32 m0, s40, 51200
s_add_u32 s38, s38, 57344
buffer_load_dwordx4 v4, s[12:15], s38 offen lds
s_add_u32 m0, s40, 52224
s_nop 0
buffer_load_dwordx4 v5, s[12:15], s38 offen lds
s_add_u32 m0, s40, 53248
s_add_u32 s38, s38, 57344
buffer_load_dwordx4 v4, s[12:15], s38 offen lds
s_add_u32 m0, s40, 54272
s_nop 0
buffer_load_dwordx4 v5, s[12:15], s38 offen lds
s_add_u32 m0, s40, 55296
s_add_u32 s38, s38, 57344
buffer_load_dwordx4 v4, s[12:15], s38 offen lds
s_add_u32 m0, s40, 56320
s_nop 0
buffer_load_dwordx4 v5, s[12:15], s38 offen lds
s_waitcnt vmcnt(12)
s_barrier
s_cmp_eq_u32 s47, 0
s_cbranch_scc0 Lw_110
s_add_u32 s7, s34, 32
s_lshl_b32 s7, s7, 7
v_mov_b32 v28, s7
v_mov_b32 v29, 1
s_mov_b64 exec, 1
buffer_atomic_add v29, v28, s[56:59], 0 offen sc1
s_mov_b64 exec, -1
Lw_110:
v_permlane32_swap_b32 v96, v100
v_permlane32_swap_b32 v97, v101
v_permlane32_swap_b32 v98, v102
v_permlane32_swap_b32 v99, v103
v_add_f32 v96, v96, v100
v_add_f32 v97, v97, v101
v_add_f32 v98, v98, v102
v_add_f32 v99, v99, v103
s_nop 1
v_permlane16_swap_b32 v96, v97
v_permlane16_swap_b32 v98, v99
v_add_f32 v96, v96, v97
v_add_f32 v98, v98, v99
s_nop 1
v_add_f32_dpp v96, v96, v96 row_ror:8 row_mask:0xf bank_mask:0xf
v_add_f32_dpp v98, v98, v98 row_ror:8 row_mask:0xf bank_mask:0xf
ds_write_b32 v104, v96
ds_write_b32 v104, v98 offset:8
s_waitcnt lgkmcnt(0)
s_add_u32 s37, s35, 13
s_and_b32 s37, s37, 15
s_mul_i32 s37, s37, 16384
s_add_u32 m0, s39, 98304
s_nop 0
buffer_load_dwordx4 v3, s[8:11], s37 offen sc1 lds
s_load_dword s3, s[4:5], 6272
s_load_dword s3, s[4:5], 6336
s_load_dword s3, s[4:5], 6400
s_load_dword s3, s[4:5], 6464
s_load_dword s3, s[4:5], 6528
s_load_dword s3, s[4:5], 6592
buffer_load_dwordx4 v3, s[8:11], s37 offen offset:1024 sc1 lds
s_load_dword s3, s[4:5], 6656
s_load_dword s3, s[4:5], 6720
s_load_dword s3, s[4:5], 6784
s_load_dword s3, s[4:5], 6848
s_load_dword s3, s[4:5], 6912
s_load_dword s3, s[4:5], 6976
buffer_load_dwordx4 v3, s[8:11], s37 offen offset:2048 sc1 lds
s_load_dword s3, s[4:5], 7040
s_load_dword s3, s[4:5], 7104
s_bfe_u32 s61, s35, 0x10002
s_lshr_b32 s60, s35, 3
s_lshl_b32 s60, s60, 2
s_and_b32 s43, s35, 3
buffer_load_dwordx4 v3, s[8:11], s37 offen offset:3072 sc1 lds
s_add_u32 s60, s60, s43
s_lshl_b32 s43, s60, 8
s_add_u32 s28, s76, s43
s_addc_u32 s29, s77, 0
s_mov_b32 s30, 7338240
s_mov_b32 s31, 0x20000
s_mul_i32 s52, s61, 196608
s_add_u32 s38, s35, 13
s_and_b32 s38, s38, 15
s_mul_i32 s38, s38, 458752
s_add_u32 m0, s40, 98304
s_nop 0
buffer_load_dwordx4 v4, s[12:15], s38 offen lds
s_mul_i32 s53, s61, 1572864
s_mul_i32 s90, s61, 163840
s_mul_i32 s91, s61, 1310720
s_lshl_b32 s51, s47, 11
s_lshl_b32 s44, s47, 15
v_lshrrev_b32 v122, 4, v1
s_add_u32 m0, s40, 99328
s_nop 0
buffer_load_dwordx4 v5, s[12:15], s38 offen lds
v_lshlrev_b32 v123, 1, v122
v_and_b32 v23, 15, v1
v_xor_b32 v23, v23, v123
v_lshlrev_b32 v23, 4, v23
v_mul_u32_u24 v122, 2048, v122
v_add_u32 v23, v23, v122
s_add_u32 m0, s40, 100352
s_add_u32 s38, s38, 57344
buffer_load_dwordx4 v4, s[12:15], s38 offen lds
v_add_u32 v23, s44, v23
v_xor_b32 v24, 128, v23
v_add_u32 v24, 8192, v24
s_lshl_b32 s43, s60, 2
s_lshl_b32 s44, s61, 1
s_add_u32 s43, s43, s44
s_add_u32 s43, s43, s63
s_add_u32 m0, s40, 101376
s_nop 0
buffer_load_dwordx4 v5, s[12:15], s38 offen lds
s_lshl_b32 s43, s43, 13
s_lshl_b32 s44, s62, 12
s_add_u32 s50, s43, s44
v_add_u32 v6, s44, v2
v_add_u32 v7, 0x10000, v6
v_add_u32 v8, 0x20000, v6
s_add_u32 m0, s40, 102400
s_add_u32 s38, s38, 57344
buffer_load_dwordx4 v4, s[12:15], s38 offen lds
v_lshrrev_b32 v122, 2, v1
v_and_b32 v123, 7, v122
v_mul_u32_u24 v122, 256, v122
v_lshl_add_u32 v122, v123, 5, v122
v_and_b32 v123, 3, v1
v_lshl_add_u32 v9, v123, 3, v122
s_add_u32 m0, s40, 103424
s_nop 0
buffer_load_dwordx4 v5, s[12:15], s38 offen lds
s_lshl_b32 s43, s61, 7
s_lshl_b32 s44, s63, 6
s_add_u32 s43, s43, s44
v_xor_b32 v9, s43, v9
v_xor_b32 v10, 32, v9
v_xor_b32 v11, 128, v9
v_xor_b32 v12, 128, v10
s_add_u32 m0, s40, 104448
s_add_u32 s38, s38, 57344
buffer_load_dwordx4 v4, s[12:15], s38 offen lds
s_add_u32 m0, s40, 105472
s_nop 0
buffer_load_dwordx4 v5, s[12:15], s38 offen lds
s_waitcnt vmcnt(12)
s_barrier
buffer_load_dwordx4 v[160:163], v2, s[8:11], s50 offen offset:0 sc1
v_add_u32 v13, 65536, v9
v_add_u32 v14, 65536, v10
v_add_u32 v15, 65536, v11
buffer_load_dwordx4 v[164:167], v2, s[8:11], s50 offen offset:1024 sc1
v_add_u32 v16, 65536, v12
v_add_u32 v25, 131072, v9
v_add_u32 v26, 131072, v10
v_add_u32 v27, 131072, v11
buffer_load_dwordx4 v[168:171], v2, s[8:11], s50 offen offset:2048 sc1
v_add_u32 v28, 131072, v12
v_lshrrev_b32 v122, 2, v1
v_bfe_u32 v123, v122, 1, 2
buffer_load_dwordx4 v[172:175], v2, s[8:11], s50 offen offset:3072 sc1
v_mul_u32_u24 v122, 128, v122
v_lshl_add_u32 v122, v123, 5, v122
v_and_b32 v123, 3, v1
v_lshl_add_u32 v224, v123, 3, v122
s_add_u32 s37, s35, 14
s_and_b32 s37, s37, 15
s_mul_i32 s37, s37, 16384
s_add_u32 m0, s39, 0
s_nop 0
buffer_load_dwordx4 v3, s[8:11], s37 offen sc1 lds
v_xor_b32 v224, s44, v224
v_xor_b32 v225, 32, v224
v_add_u32 v226, 65536, v224
buffer_load_dwordx4 v3, s[8:11], s37 offen offset:1024 sc1 lds
v_add_u32 v227, 65536, v225
v_add_u32 v228, 131072, v224
v_add_u32 v229, 131072, v225
s_add_u32 s84, s82, 33554432
buffer_load_dwordx4 v3, s[8:11], s37 offen offset:2048 sc1 lds
s_addc_u32 s85, s83, 0
s_mov_b32 s86, 4194304
s_mov_b32 s87, 0x20000
s_xor_b32 s43, s2, 2
buffer_load_dwordx4 v3, s[8:11], s37 offen offset:3072 sc1 lds
s_lshl_b32 s44, s43, 2
s_add_u32 s44, s44, s47
s_lshl_b32 s45, s44, 12
s_add_u32 s38, s35, 14
s_and_b32 s38, s38, 15
s_mul_i32 s38, s38, 458752
s_add_u32 m0, s40, 0
s_nop 0
buffer_load_dwordx4 v4, s[12:15], s38 offen lds
s_lshl_b32 s46, s2, 2
s_add_u32 s46, s46, s47
s_lshl_b32 s46, s46, 12
s_lshl_b32 s43, s34, 18
s_add_u32 m0, s40, 1024
s_nop 0
buffer_load_dwordx4 v5, s[12:15], s38 offen lds
s_lshl_b32 s42, s60, 8
s_add_u32 s43, s43, s42
s_lshl_b32 s42, s61, 7
s_add_u32 m0, s40, 2048
s_add_u32 s38, s38, 57344
buffer_load_dwordx4 v4, s[12:15], s38 offen lds
s_add_u32 s43, s43, s42
s_branch Lov_10
.p2align 12
Lst_10_0:
s_branch Lwr_150
Lst_10_1:
s_branch Lwr_161
s_nop 0
Lov_10:
s_lshl_b32 s42, s63, 6
s_add_u32 s43, s43, s42
s_add_u32 s20, s78, s43
s_add_u32 m0, s40, 3072
s_nop 0
buffer_load_dwordx4 v5, s[12:15], s38 offen lds
s_addc_u32 s21, s79, 0
s_mov_b32 s22, 260160
s_mov_b32 s23, 0x20000
s_add_u32 m0, s40, 4096
s_add_u32 s38, s38, 57344
buffer_load_dwordx4 v4, s[12:15], s38 offen lds
v_and_b32 v230, 15, v1
v_lshlrev_b32 v230, 12, v230
v_bfe_u32 v231, v1, 4, 1
v_lshl_add_u32 v230, v231, 5, v230
s_add_u32 m0, s40, 5120
s_nop 0
buffer_load_dwordx4 v5, s[12:15], s38 offen lds
v_bfe_u32 v231, v1, 5, 1
v_lshl_add_u32 v230, v231, 4, v230
s_lshl_b32 s54, s62, 17
s_add_u32 s55, s54, 65536
s_add_u32 m0, s40, 6144
s_add_u32 s38, s38, 57344
buffer_load_dwordx4 v4, s[12:15], s38 offen lds
s_add_u32 m0, s40, 7168
s_nop 0
buffer_load_dwordx4 v5, s[12:15], s38 offen lds
s_waitcnt vmcnt(16)
s_barrier
s_cmp_eq_u32 s47, 3
s_cbranch_scc0 Lw_111
s_lshl_b32 s92, s34, 7
s_add_u32 s92, s92, 28315648
s_load_dword s93, s[82:83], s92 glc
Lw_111:
s_add_u32 s37, s35, 15
s_and_b32 s37, s37, 15
s_mul_i32 s37, s37, 16384
s_add_u32 m0, s39, 49152
s_nop 0
buffer_load_dwordx4 v3, s[8:11], s37 offen sc1 lds
buffer_load_dwordx4 v3, s[8:11], s37 offen offset:1024 sc1 lds
buffer_load_dwordx4 v3, s[8:11], s37 offen offset:2048 sc1 lds
buffer_load_dwordx4 v3, s[8:11], s37 offen offset:3072 sc1 lds
s_add_u32 s38, s35, 15
s_and_b32 s38, s38, 15
s_mul_i32 s38, s38, 458752
s_add_u32 m0, s40, 49152
s_nop 0
buffer_load_dwordx4 v4, s[12:15], s38 offen lds
s_add_u32 m0, s40, 50176
s_nop 0
buffer_load_dwordx4 v5, s[12:15], s38 offen lds
s_add_u32 m0, s40, 51200
s_add_u32 s38, s38, 57344
buffer_load_dwordx4 v4, s[12:15], s38 offen lds
s_add_u32 m0, s40, 52224
s_nop 0
buffer_load_dwordx4 v5, s[12:15], s38 offen lds
s_add_u32 m0, s40, 53248
s_add_u32 s38, s38, 57344
buffer_load_dwordx4 v4, s[12:15], s38 offen lds
s_add_u32 m0, s40, 54272
s_nop 0
buffer_load_dwordx4 v5, s[12:15], s38 offen lds
s_add_u32 m0, s40, 55296
s_add_u32 s38, s38, 57344
buffer_load_dwordx4 v4, s[12:15], s38 offen lds
s_add_u32 m0, s40, 56320
s_nop 0
buffer_load_dwordx4 v5, s[12:15], s38 offen lds
s_waitcnt vmcnt(12)
s_cmp_eq_u32 s47, 3
s_cbranch_scc0 Lw_112
s_mov_b32 s41, 0x40000
s_branch Lpchk_115
Lpoll_113:
s_load_dword s93, s[82:83], s92 glc
Lpchk_115:
s_waitcnt lgkmcnt(0)
s_cmp_eq_u32 s93, 16
s_cbranch_scc1 Lpok_114
s_sub_u32 s41, s41, 1
s_cmp_lg_u32 s41, 0
s_cbranch_scc1 Lpoll_113
Lpok_114:
Lw_112:
s_barrier
s_add_u32 m0, s39, 98304
s_add_u32 s37, s52, 524288
buffer_load_dwordx4 v3, s[24:27], s37 offen sc1 lds
v_lshlrev_b32 v128, 16, v160
v_and_b32 v129, 0xffff0000, v160
v_lshlrev_b32 v130, 16, v161
v_and_b32 v131, 0xffff0000, v161
v_lshlrev_b32 v132, 16, v162
buffer_load_dwordx4 v3, s[24:27], s37 offen offset:1024 sc1 lds
v_and_b32 v133, 0xffff0000, v162
v_lshlrev_b32 v134, 16, v163
v_and_b32 v135, 0xffff0000, v163
v_lshlrev_b32 v136, 16, v164
v_and_b32 v137, 0xffff0000, v164
buffer_load_dwordx4 v3, s[24:27], s37 offen offset:2048 sc1 lds
v_lshlrev_b32 v138, 16, v165
v_and_b32 v139, 0xffff0000, v165
v_lshlrev_b32 v140, 16, v166
v_and_b32 v141, 0xffff0000, v166
v_lshlrev_b32 v142, 16, v167
v_and_b32 v143, 0xffff0000, v167
buffer_load_dwordx4 v3, s[24:27], s37 offen offset:3072 sc1 lds
v_lshlrev_b32 v144, 16, v168
v_and_b32 v145, 0xffff0000, v168
v_lshlrev_b32 v146, 16, v169
v_and_b32 v147, 0xffff0000, v169
v_lshlrev_b32 v148, 16, v170
s_add_u32 m0, s39, 114688
s_add_u32 s38, s53, 4194304
buffer_load_dwordx4 v23, s[28:31], s38 offen lds
v_and_b32 v149, 0xffff0000, v170
v_lshlrev_b32 v150, 16, v171
v_and_b32 v151, 0xffff0000, v171
v_lshlrev_b32 v152, 16, v172
v_and_b32 v153, 0xffff0000, v172
s_add_u32 m0, s39, 115712
s_add_u32 s38, s53, 4194304
buffer_load_dwordx4 v24, s[28:31], s38 offen lds
v_lshlrev_b32 v154, 16, v173
v_and_b32 v155, 0xffff0000, v173
v_lshlrev_b32 v156, 16, v174
v_and_b32 v157, 0xffff0000, v174
v_lshlrev_b32 v158, 16, v175
v_and_b32 v159, 0xffff0000, v175
s_add_u32 m0, s39, 116736
s_add_u32 s38, s53, 4210688
buffer_load_dwordx4 v23, s[28:31], s38 offen lds
s_add_u32 m0, s39, 117760
s_add_u32 s38, s53, 4210688
buffer_load_dwordx4 v24, s[28:31], s38 offen lds
s_waitcnt vmcnt(8)
s_barrier
s_add_u32 m0, s39, 131072
s_add_u32 s37, s52, 540672
buffer_load_dwordx4 v3, s[24:27], s37 offen sc1 lds
buffer_load_dwordx4 v3, s[24:27], s37 offen offset:1024 sc1 lds
buffer_load_dwordx4 v3, s[24:27], s37 offen offset:2048 sc1 lds
buffer_load_dwordx4 v3, s[24:27], s37 offen offset:3072 sc1 lds
s_add_u32 m0, s39, 0
s_add_u32 s38, s53, 4325376
buffer_load_dwordx4 v23, s[28:31], s38 offen lds
s_add_u32 m0, s39, 1024
s_add_u32 s38, s53, 4325376
buffer_load_dwordx4 v24, s[28:31], s38 offen lds
s_add_u32 m0, s39, 2048
s_add_u32 s38, s53, 4341760
buffer_load_dwordx4 v23, s[28:31], s38 offen lds
s_add_u32 m0, s39, 3072
s_add_u32 s38, s53, 4341760
buffer_load_dwordx4 v24, s[28:31], s38 offen lds
s_add_u32 m0, s39, 16384
s_add_u32 s37, s52, 557056
buffer_load_dwordx4 v3, s[24:27], s37 offen sc1 lds
buffer_load_dwordx4 v3, s[24:27], s37 offen offset:1024 sc1 lds
buffer_load_dwordx4 v3, s[24:27], s37 offen offset:2048 sc1 lds
buffer_load_dwordx4 v3, s[24:27], s37 offen offset:3072 sc1 lds
s_add_u32 m0, s39, 32768
s_add_u32 s38, s53, 4456448
buffer_load_dwordx4 v23, s[28:31], s38 offen lds
s_add_u32 m0, s39, 33792
s_add_u32 s38, s53, 4456448
buffer_load_dwordx4 v24, s[28:31], s38 offen lds
s_add_u32 m0, s39, 34816
s_add_u32 s38, s53, 4472832
buffer_load_dwordx4 v23, s[28:31], s38 offen lds
s_add_u32 m0, s39, 35840
s_add_u32 s38, s53, 4472832
buffer_load_dwordx4 v24, s[28:31], s38 offen lds
s_waitcnt vmcnt(16)
s_barrier
ds_read_b128 v[32:35], v7 offset:32768
ds_read_b64_tr_b16 v[48:49], v13 offset:49152
ds_read_b64_tr_b16 v[50:51], v13 offset:53248
ds_read_b64_tr_b16 v[52:53], v14 offset:49152
ds_read_b64_tr_b16 v[54:55], v14 offset:53248
ds_read_b64_tr_b16 v[56:57], v15 offset:49152
ds_read_b64_tr_b16 v[58:59], v15 offset:53248
ds_read_b64_tr_b16 v[60:61], v16 offset:49152
ds_read_b64_tr_b16 v[62:63], v16 offset:53248
ds_read_b128 v[36:39], v7 offset:33792
ds_read_b128 v[40:43], v7 offset:34816
ds_read_b128 v[44:47], v7 offset:35840
ds_read_b128 v[64:67], v7 offset:40960
ds_read_b64_tr_b16 v[80:81], v13 offset:57344
ds_read_b64_tr_b16 v[82:83], v13 offset:61440
ds_read_b64_tr_b16 v[84:85], v14 offset:57344
ds_read_b64_tr_b16 v[86:87], v14 offset:61440
ds_read_b64_tr_b16 v[88:89], v15 offset:57344
ds_read_b64_tr_b16 v[90:91], v15 offset:61440
ds_read_b64_tr_b16 v[92:93], v16 offset:57344
ds_read_b64_tr_b16 v[94:95], v16 offset:61440
ds_read_b128 v[68:71], v7 offset:41984
ds_read_b128 v[72:75], v7 offset:43008
ds_read_b128 v[76:79], v7 offset:44032
s_add_u32 m0, s39, 49152
s_add_u32 s37, s52, 573440
buffer_load_dwordx4 v3, s[24:27], s37 offen sc1 lds
buffer_load_dwordx4 v3, s[24:27], s37 offen offset:1024 sc1 lds
buffer_load_dwordx4 v3, s[24:27], s37 offen offset:2048 sc1 lds
buffer_load_dwordx4 v3, s[24:27], s37 offen offset:3072 sc1 lds
s_add_u32 m0, s39, 65536
s_add_u32 s38, s53, 4587520
buffer_load_dwordx4 v23, s[28:31], s38 offen lds
s_add_u32 m0, s39, 66560
s_add_u32 s38, s53, 4587520
buffer_load_dwordx4 v24, s[28:31], s38 offen lds
s_add_u32 m0, s39, 67584
s_add_u32 s38, s53, 4603904
buffer_load_dwordx4 v23, s[28:31], s38 offen lds
s_add_u32 m0, s39, 68608
s_add_u32 s38, s53, 4603904
buffer_load_dwordx4 v24, s[28:31], s38 offen lds
s_waitcnt vmcnt(16)
s_waitcnt lgkmcnt(0)
s_barrier
v_mfma_f32_16x16x32_bf16 v[128:131], v[48:51], v[32:35], v[128:131]
ds_read_b128 v[96:99], v8 offset:0
v_mfma_f32_16x16x32_bf16 v[132:135], v[52:55], v[32:35], v[132:135]
ds_read_b64_tr_b16 v[112:113], v9 offset:0
v_mfma_f32_16x16x32_bf16 v[160:163], v[56:59], v[32:35], 0
ds_read_b64_tr_b16 v[114:115], v9 offset:4096
v_mfma_f32_16x16x32_bf16 v[164:167], v[60:63], v[32:35], 0
ds_read_b64_tr_b16 v[116:117], v10 offset:0
v_mfma_f32_16x16x32_bf16 v[172:175], v[60:63], v[36:39], 0
ds_read_b64_tr_b16 v[118:119], v10 offset:4096
v_mfma_f32_16x16x32_bf16 v[168:171], v[56:59], v[36:39], 0
ds_read_b64_tr_b16 v[120:121], v11 offset:0
v_mfma_f32_16x16x32_bf16 v[140:143], v[52:55], v[36:39], v[140:143]
ds_read_b64_tr_b16 v[122:123], v11 offset:4096
v_mfma_f32_16x16x32_bf16 v[136:139], v[48:51], v[36:39], v[136:139]
ds_read_b64_tr_b16 v[124:125], v12 offset:0
v_mfma_f32_16x16x32_bf16 v[144:147], v[48:51], v[40:43], v[144:147]
ds_read_b64_tr_b16 v[126:127], v12 offset:4096
v_mfma_f32_16x16x32_bf16 v[148:151], v[52:55], v[40:43], v[148:151]
ds_read_b128 v[100:103], v8 offset:1024
v_mfma_f32_16x16x32_bf16 v[176:179], v[56:59], v[40:43], 0
ds_read_b128 v[104:107], v8 offset:2048
v_mfma_f32_16x16x32_bf16 v[180:183], v[60:63], v[40:43], 0
ds_read_b128 v[108:111], v8 offset:3072
v_mfma_f32_16x16x32_bf16 v[188:191], v[60:63], v[44:47], 0
ds_read_b128 v[192:195], v8 offset:8192
v_mfma_f32_16x16x32_bf16 v[184:187], v[56:59], v[44:47], 0
ds_read_b64_tr_b16 v[208:209], v9 offset:8192
v_mfma_f32_16x16x32_bf16 v[156:159], v[52:55], v[44:47], v[156:159]
ds_read_b64_tr_b16 v[210:211], v9 offset:12288
v_mfma_f32_16x16x32_bf16 v[152:155], v[48:51], v[44:47], v[152:155]
ds_read_b64_tr_b16 v[212:213], v10 offset:8192
v_mfma_f32_16x16x32_bf16 v[128:131], v[80:83], v[64:67], v[128:131]
ds_read_b64_tr_b16 v[214:215], v10 offset:12288
v_mfma_f32_16x16x32_bf16 v[132:135], v[84:87], v[64:67], v[132:135]
ds_read_b64_tr_b16 v[216:217], v11 offset:8192
v_mfma_f32_16x16x32_bf16 v[160:163], v[88:91], v[64:67], v[160:163]
ds_read_b64_tr_b16 v[218:219], v11 offset:12288
v_mfma_f32_16x16x32_bf16 v[164:167], v[92:95], v[64:67], v[164:167]
ds_read_b64_tr_b16 v[220:221], v12 offset:8192
v_mfma_f32_16x16x32_bf16 v[172:175], v[92:95], v[68:71], v[172:175]
ds_read_b64_tr_b16 v[222:223], v12 offset:12288
v_mfma_f32_16x16x32_bf16 v[168:171], v[88:91], v[68:71], v[168:171]
ds_read_b128 v[196:199], v8 offset:9216
v_mfma_f32_16x16x32_bf16 v[140:143], v[84:87], v[68:71], v[140:143]
ds_read_b128 v[200:203], v8 offset:10240
v_mfma_f32_16x16x32_bf16 v[136:139], v[80:83], v[68:71], v[136:139]
ds_read_b128 v[204:207], v8 offset:11264
v_mfma_f32_16x16x32_bf16 v[144:147], v[80:83], v[72:75], v[144:147]
v_mfma_f32_16x16x32_bf16 v[148:151], v[84:87], v[72:75], v[148:151]
v_mfma_f32_16x16x32_bf16 v[176:179], v[88:91], v[72:75], v[176:179]
v_mfma_f32_16x16x32_bf16 v[180:183], v[92:95], v[72:75], v[180:183]
v_mfma_f32_16x16x32_bf16 v[188:191], v[92:95], v[76:79], v[188:191]
v_mfma_f32_16x16x32_bf16 v[184:187], v[88:91], v[76:79], v[184:187]
v_mfma_f32_16x16x32_bf16 v[156:159], v[84:87], v[76:79], v[156:159]
v_mfma_f32_16x16x32_bf16 v[152:155], v[80:83], v[76:79], v[152:155]
s_mov_b32 s41, 2
Lk4_116:
s_waitcnt vmcnt(8)
s_waitcnt lgkmcnt(0)
s_barrier
v_mfma_f32_16x16x32_bf16 v[128:131], v[112:115], v[96:99], v[128:131]
ds_read_b128 v[32:35], v6 offset:16384
v_mfma_f32_16x16x32_bf16 v[132:135], v[116:119], v[96:99], v[132:135]
ds_read_b64_tr_b16 v[48:49], v9 offset:32768
v_mfma_f32_16x16x32_bf16 v[160:163], v[120:123], v[96:99], v[160:163]
ds_read_b64_tr_b16 v[50:51], v9 offset:36864
v_mfma_f32_16x16x32_bf16 v[164:167], v[124:127], v[96:99], v[164:167]
ds_read_b64_tr_b16 v[52:53], v10 offset:32768
v_mfma_f32_16x16x32_bf16 v[172:175], v[124:127], v[100:103], v[172:175]
ds_read_b64_tr_b16 v[54:55], v10 offset:36864
v_mfma_f32_16x16x32_bf16 v[168:171], v[120:123], v[100:103], v[168:171]
ds_read_b64_tr_b16 v[56:57], v11 offset:32768
v_mfma_f32_16x16x32_bf16 v[140:143], v[116:119], v[100:103], v[140:143]
ds_read_b64_tr_b16 v[58:59], v11 offset:36864
v_mfma_f32_16x16x32_bf16 v[136:139], v[112:115], v[100:103], v[136:139]
ds_read_b64_tr_b16 v[60:61], v12 offset:32768
v_mfma_f32_16x16x32_bf16 v[144:147], v[112:115], v[104:107], v[144:147]
ds_read_b64_tr_b16 v[62:63], v12 offset:36864
v_mfma_f32_16x16x32_bf16 v[148:151], v[116:119], v[104:107], v[148:151]
ds_read_b128 v[36:39], v6 offset:17408
v_mfma_f32_16x16x32_bf16 v[176:179], v[120:123], v[104:107], v[176:179]
ds_read_b128 v[40:43], v6 offset:18432
v_mfma_f32_16x16x32_bf16 v[180:183], v[124:127], v[104:107], v[180:183]
ds_read_b128 v[44:47], v6 offset:19456
v_mfma_f32_16x16x32_bf16 v[188:191], v[124:127], v[108:111], v[188:191]
ds_read_b128 v[64:67], v6 offset:24576
v_mfma_f32_16x16x32_bf16 v[184:187], v[120:123], v[108:111], v[184:187]
ds_read_b64_tr_b16 v[80:81], v9 offset:40960
v_mfma_f32_16x16x32_bf16 v[156:159], v[116:119], v[108:111], v[156:159]
ds_read_b64_tr_b16 v[82:83], v9 offset:45056
v_mfma_f32_16x16x32_bf16 v[152:155], v[112:115], v[108:111], v[152:155]
ds_read_b64_tr_b16 v[84:85], v10 offset:40960
v_mfma_f32_16x16x32_bf16 v[128:131], v[208:211], v[192:195], v[128:131]
ds_read_b64_tr_b16 v[86:87], v10 offset:45056
v_mfma_f32_16x16x32_bf16 v[132:135], v[212:215], v[192:195], v[132:135]
ds_read_b64_tr_b16 v[88:89], v11 offset:40960
v_mfma_f32_16x16x32_bf16 v[160:163], v[216:219], v[192:195], v[160:163]
ds_read_b64_tr_b16 v[90:91], v11 offset:45056
v_mfma_f32_16x16x32_bf16 v[164:167], v[220:223], v[192:195], v[164:167]
ds_read_b64_tr_b16 v[92:93], v12 offset:40960
v_mfma_f32_16x16x32_bf16 v[172:175], v[220:223], v[196:199], v[172:175]
ds_read_b64_tr_b16 v[94:95], v12 offset:45056
v_mfma_f32_16x16x32_bf16 v[168:171], v[216:219], v[196:199], v[168:171]
ds_read_b128 v[68:71], v6 offset:25600
v_mfma_f32_16x16x32_bf16 v[140:143], v[212:215], v[196:199], v[140:143]
ds_read_b128 v[72:75], v6 offset:26624
v_mfma_f32_16x16x32_bf16 v[136:139], v[208:211], v[196:199], v[136:139]
ds_read_b128 v[76:79], v6 offset:27648
v_mfma_f32_16x16x32_bf16 v[144:147], v[208:211], v[200:203], v[144:147]
v_mfma_f32_16x16x32_bf16 v[148:151], v[212:215], v[200:203], v[148:151]
v_mfma_f32_16x16x32_bf16 v[176:179], v[216:219], v[200:203], v[176:179]
v_mfma_f32_16x16x32_bf16 v[180:183], v[220:223], v[200:203], v[180:183]
v_mfma_f32_16x16x32_bf16 v[188:191], v[220:223], v[204:207], v[188:191]
v_mfma_f32_16x16x32_bf16 v[184:187], v[216:219], v[204:207], v[184:187]
v_mfma_f32_16x16x32_bf16 v[156:159], v[212:215], v[204:207], v[156:159]
v_mfma_f32_16x16x32_bf16 v[152:155], v[208:211], v[204:207], v[152:155]
s_waitcnt vmcnt(0)
s_waitcnt lgkmcnt(0)
s_barrier
v_mfma_f32_16x16x32_bf16 v[128:131], v[48:51], v[32:35], v[128:131]
ds_read_b128 v[96:99], v6 offset:49152
v_mfma_f32_16x16x32_bf16 v[132:135], v[52:55], v[32:35], v[132:135]
ds_read_b64_tr_b16 v[112:113], v13 offset:0
v_mfma_f32_16x16x32_bf16 v[160:163], v[56:59], v[32:35], v[160:163]
ds_read_b64_tr_b16 v[114:115], v13 offset:4096
v_mfma_f32_16x16x32_bf16 v[164:167], v[60:63], v[32:35], v[164:167]
ds_read_b64_tr_b16 v[116:117], v14 offset:0
v_mfma_f32_16x16x32_bf16 v[172:175], v[60:63], v[36:39], v[172:175]
ds_read_b64_tr_b16 v[118:119], v14 offset:4096
v_mfma_f32_16x16x32_bf16 v[168:171], v[56:59], v[36:39], v[168:171]
ds_read_b64_tr_b16 v[120:121], v15 offset:0
v_mfma_f32_16x16x32_bf16 v[140:143], v[52:55], v[36:39], v[140:143]
ds_read_b64_tr_b16 v[122:123], v15 offset:4096
v_mfma_f32_16x16x32_bf16 v[136:139], v[48:51], v[36:39], v[136:139]
ds_read_b64_tr_b16 v[124:125], v16 offset:0
v_mfma_f32_16x16x32_bf16 v[144:147], v[48:51], v[40:43], v[144:147]
ds_read_b64_tr_b16 v[126:127], v16 offset:4096
v_mfma_f32_16x16x32_bf16 v[148:151], v[52:55], v[40:43], v[148:151]
ds_read_b128 v[100:103], v6 offset:50176
v_mfma_f32_16x16x32_bf16 v[176:179], v[56:59], v[40:43], v[176:179]
ds_read_b128 v[104:107], v6 offset:51200
v_mfma_f32_16x16x32_bf16 v[180:183], v[60:63], v[40:43], v[180:183]
ds_read_b128 v[108:111], v6 offset:52224
v_mfma_f32_16x16x32_bf16 v[188:191], v[60:63], v[44:47], v[188:191]
ds_read_b128 v[192:195], v6 offset:57344
v_mfma_f32_16x16x32_bf16 v[184:187], v[56:59], v[44:47], v[184:187]
ds_read_b64_tr_b16 v[208:209], v13 offset:8192
v_mfma_f32_16x16x32_bf16 v[156:159], v[52:55], v[44:47], v[156:159]
ds_read_b64_tr_b16 v[210:211], v13 offset:12288
v_mfma_f32_16x16x32_bf16 v[152:155], v[48:51], v[44:47], v[152:155]
ds_read_b64_tr_b16 v[212:213], v14 offset:8192
v_mfma_f32_16x16x32_bf16 v[128:131], v[80:83], v[64:67], v[128:131]
ds_read_b64_tr_b16 v[214:215], v14 offset:12288
v_mfma_f32_16x16x32_bf16 v[132:135], v[84:87], v[64:67], v[132:135]
ds_read_b64_tr_b16 v[216:217], v15 offset:8192
v_mfma_f32_16x16x32_bf16 v[160:163], v[88:91], v[64:67], v[160:163]
ds_read_b64_tr_b16 v[218:219], v15 offset:12288
v_mfma_f32_16x16x32_bf16 v[164:167], v[92:95], v[64:67], v[164:167]
ds_read_b64_tr_b16 v[220:221], v16 offset:8192
v_mfma_f32_16x16x32_bf16 v[172:175], v[92:95], v[68:71], v[172:175]
ds_read_b64_tr_b16 v[222:223], v16 offset:12288
v_mfma_f32_16x16x32_bf16 v[168:171], v[88:91], v[68:71], v[168:171]
ds_read_b128 v[196:199], v6 offset:58368
v_mfma_f32_16x16x32_bf16 v[140:143], v[84:87], v[68:71], v[140:143]
ds_read_b128 v[200:203], v6 offset:59392
v_mfma_f32_16x16x32_bf16 v[136:139], v[80:83], v[68:71], v[136:139]
ds_read_b128 v[204:207], v6 offset:60416
v_mfma_f32_16x16x32_bf16 v[144:147], v[80:83], v[72:75], v[144:147]
v_mfma_f32_16x16x32_bf16 v[148:151], v[84:87], v[72:75], v[148:151]
v_mfma_f32_16x16x32_bf16 v[176:179], v[88:91], v[72:75], v[176:179]
v_mfma_f32_16x16x32_bf16 v[180:183], v[92:95], v[72:75], v[180:183]
v_mfma_f32_16x16x32_bf16 v[188:191], v[92:95], v[76:79], v[188:191]
v_mfma_f32_16x16x32_bf16 v[184:187], v[88:91], v[76:79], v[184:187]
v_mfma_f32_16x16x32_bf16 v[156:159], v[84:87], v[76:79], v[156:159]
v_mfma_f32_16x16x32_bf16 v[152:155], v[80:83], v[76:79], v[152:155]
s_waitcnt lgkmcnt(0)
s_barrier
v_mfma_f32_16x16x32_bf16 v[128:131], v[112:115], v[96:99], v[128:131]
ds_read_b128 v[32:35], v7 offset:16384
v_mfma_f32_16x16x32_bf16 v[132:135], v[116:119], v[96:99], v[132:135]
ds_read_b64_tr_b16 v[48:49], v25 offset:16384
v_mfma_f32_16x16x32_bf16 v[160:163], v[120:123], v[96:99], v[160:163]
ds_read_b64_tr_b16 v[50:51], v25 offset:20480
v_mfma_f32_16x16x32_bf16 v[164:167], v[124:127], v[96:99], v[164:167]
ds_read_b64_tr_b16 v[52:53], v26 offset:16384
v_mfma_f32_16x16x32_bf16 v[172:175], v[124:127], v[100:103], v[172:175]
ds_read_b64_tr_b16 v[54:55], v26 offset:20480
v_mfma_f32_16x16x32_bf16 v[168:171], v[120:123], v[100:103], v[168:171]
ds_read_b64_tr_b16 v[56:57], v27 offset:16384
v_mfma_f32_16x16x32_bf16 v[140:143], v[116:119], v[100:103], v[140:143]
ds_read_b64_tr_b16 v[58:59], v27 offset:20480
v_mfma_f32_16x16x32_bf16 v[136:139], v[112:115], v[100:103], v[136:139]
ds_read_b64_tr_b16 v[60:61], v28 offset:16384
v_mfma_f32_16x16x32_bf16 v[144:147], v[112:115], v[104:107], v[144:147]
ds_read_b64_tr_b16 v[62:63], v28 offset:20480
v_mfma_f32_16x16x32_bf16 v[148:151], v[116:119], v[104:107], v[148:151]
ds_read_b128 v[36:39], v7 offset:17408
v_mfma_f32_16x16x32_bf16 v[176:179], v[120:123], v[104:107], v[176:179]
ds_read_b128 v[40:43], v7 offset:18432
v_mfma_f32_16x16x32_bf16 v[180:183], v[124:127], v[104:107], v[180:183]
ds_read_b128 v[44:47], v7 offset:19456
v_mfma_f32_16x16x32_bf16 v[188:191], v[124:127], v[108:111], v[188:191]
ds_read_b128 v[64:67], v7 offset:24576
v_mfma_f32_16x16x32_bf16 v[184:187], v[120:123], v[108:111], v[184:187]
ds_read_b64_tr_b16 v[80:81], v25 offset:24576
v_mfma_f32_16x16x32_bf16 v[156:159], v[116:119], v[108:111], v[156:159]
ds_read_b64_tr_b16 v[82:83], v25 offset:28672
v_mfma_f32_16x16x32_bf16 v[152:155], v[112:115], v[108:111], v[152:155]
ds_read_b64_tr_b16 v[84:85], v26 offset:24576
v_mfma_f32_16x16x32_bf16 v[128:131], v[208:211], v[192:195], v[128:131]
ds_read_b64_tr_b16 v[86:87], v26 offset:28672
v_mfma_f32_16x16x32_bf16 v[132:135], v[212:215], v[192:195], v[132:135]
ds_read_b64_tr_b16 v[88:89], v27 offset:24576
v_mfma_f32_16x16x32_bf16 v[160:163], v[216:219], v[192:195], v[160:163]
ds_read_b64_tr_b16 v[90:91], v27 offset:28672
v_mfma_f32_16x16x32_bf16 v[164:167], v[220:223], v[192:195], v[164:167]
ds_read_b64_tr_b16 v[92:93], v28 offset:24576
v_mfma_f32_16x16x32_bf16 v[172:175], v[220:223], v[196:199], v[172:175]
ds_read_b64_tr_b16 v[94:95], v28 offset:28672
v_mfma_f32_16x16x32_bf16 v[168:171], v[216:219], v[196:199], v[168:171]
ds_read_b128 v[68:71], v7 offset:25600
v_mfma_f32_16x16x32_bf16 v[140:143], v[212:215], v[196:199], v[140:143]
ds_read_b128 v[72:75], v7 offset:26624
v_mfma_f32_16x16x32_bf16 v[136:139], v[208:211], v[196:199], v[136:139]
ds_read_b128 v[76:79], v7 offset:27648
v_mfma_f32_16x16x32_bf16 v[144:147], v[208:211], v[200:203], v[144:147]
v_mfma_f32_16x16x32_bf16 v[148:151], v[212:215], v[200:203], v[148:151]
v_mfma_f32_16x16x32_bf16 v[176:179], v[216:219], v[200:203], v[176:179]
v_mfma_f32_16x16x32_bf16 v[180:183], v[220:223], v[200:203], v[180:183]
v_mfma_f32_16x16x32_bf16 v[188:191], v[220:223], v[204:207], v[188:191]
v_mfma_f32_16x16x32_bf16 v[184:187], v[216:219], v[204:207], v[184:187]
v_mfma_f32_16x16x32_bf16 v[156:159], v[212:215], v[204:207], v[156:159]
v_mfma_f32_16x16x32_bf16 v[152:155], v[208:211], v[204:207], v[152:155]
s_waitcnt lgkmcnt(0)
s_barrier
v_mfma_f32_16x16x32_bf16 v[128:131], v[48:51], v[32:35], v[128:131]
ds_read_b128 v[96:99], v7 offset:32768
v_mfma_f32_16x16x32_bf16 v[132:135], v[52:55], v[32:35], v[132:135]
ds_read_b64_tr_b16 v[112:113], v13 offset:49152
v_mfma_f32_16x16x32_bf16 v[160:163], v[56:59], v[32:35], v[160:163]
ds_read_b64_tr_b16 v[114:115], v13 offset:53248
v_mfma_f32_16x16x32_bf16 v[164:167], v[60:63], v[32:35], v[164:167]
ds_read_b64_tr_b16 v[116:117], v14 offset:49152
v_mfma_f32_16x16x32_bf16 v[172:175], v[60:63], v[36:39], v[172:175]
ds_read_b64_tr_b16 v[118:119], v14 offset:53248
v_mfma_f32_16x16x32_bf16 v[168:171], v[56:59], v[36:39], v[168:171]
ds_read_b64_tr_b16 v[120:121], v15 offset:49152
v_mfma_f32_16x16x32_bf16 v[140:143], v[52:55], v[36:39], v[140:143]
ds_read_b64_tr_b16 v[122:123], v15 offset:53248
v_mfma_f32_16x16x32_bf16 v[136:139], v[48:51], v[36:39], v[136:139]
ds_read_b64_tr_b16 v[124:125], v16 offset:49152
v_mfma_f32_16x16x32_bf16 v[144:147], v[48:51], v[40:43], v[144:147]
ds_read_b64_tr_b16 v[126:127], v16 offset:53248
v_mfma_f32_16x16x32_bf16 v[148:151], v[52:55], v[40:43], v[148:151]
ds_read_b128 v[100:103], v7 offset:33792
v_mfma_f32_16x16x32_bf16 v[176:179], v[56:59], v[40:43], v[176:179]
ds_read_b128 v[104:107], v7 offset:34816
v_mfma_f32_16x16x32_bf16 v[180:183], v[60:63], v[40:43], v[180:183]
ds_read_b128 v[108:111], v7 offset:35840
v_mfma_f32_16x16x32_bf16 v[188:191], v[60:63], v[44:47], v[188:191]
ds_read_b128 v[192:195], v7 offset:40960
v_mfma_f32_16x16x32_bf16 v[184:187], v[56:59], v[44:47], v[184:187]
ds_read_b64_tr_b16 v[208:209], v13 offset:57344
v_mfma_f32_16x16x32_bf16 v[156:159], v[52:55], v[44:47], v[156:159]
ds_read_b64_tr_b16 v[210:211], v13 offset:61440
v_mfma_f32_16x16x32_bf16 v[152:155], v[48:51], v[44:47], v[152:155]
ds_read_b64_tr_b16 v[212:213], v14 offset:57344
v_mfma_f32_16x16x32_bf16 v[128:131], v[80:83], v[64:67], v[128:131]
ds_read_b64_tr_b16 v[214:215], v14 offset:61440
v_mfma_f32_16x16x32_bf16 v[132:135], v[84:87], v[64:67], v[132:135]
ds_read_b64_tr_b16 v[216:217], v15 offset:57344
v_mfma_f32_16x16x32_bf16 v[160:163], v[88:91], v[64:67], v[160:163]
ds_read_b64_tr_b16 v[218:219], v15 offset:61440
v_mfma_f32_16x16x32_bf16 v[164:167], v[92:95], v[64:67], v[164:167]
ds_read_b64_tr_b16 v[220:221], v16 offset:57344
v_mfma_f32_16x16x32_bf16 v[172:175], v[92:95], v[68:71], v[172:175]
ds_read_b64_tr_b16 v[222:223], v16 offset:61440
v_mfma_f32_16x16x32_bf16 v[168:171], v[88:91], v[68:71], v[168:171]
ds_read_b128 v[196:199], v7 offset:41984
v_mfma_f32_16x16x32_bf16 v[140:143], v[84:87], v[68:71], v[140:143]
ds_read_b128 v[200:203], v7 offset:43008
v_mfma_f32_16x16x32_bf16 v[136:139], v[80:83], v[68:71], v[136:139]
ds_read_b128 v[204:207], v7 offset:44032
v_mfma_f32_16x16x32_bf16 v[144:147], v[80:83], v[72:75], v[144:147]
v_mfma_f32_16x16x32_bf16 v[148:151], v[84:87], v[72:75], v[148:151]
v_mfma_f32_16x16x32_bf16 v[176:179], v[88:91], v[72:75], v[176:179]
v_mfma_f32_16x16x32_bf16 v[180:183], v[92:95], v[72:75], v[180:183]
v_mfma_f32_16x16x32_bf16 v[188:191], v[92:95], v[76:79], v[188:191]
v_mfma_f32_16x16x32_bf16 v[184:187], v[88:91], v[76:79], v[184:187]
v_mfma_f32_16x16x32_bf16 v[156:159], v[84:87], v[76:79], v[156:159]
v_mfma_f32_16x16x32_bf16 v[152:155], v[80:83], v[76:79], v[152:155]
s_waitcnt lgkmcnt(0)
s_barrier
v_mfma_f32_16x16x32_bf16 v[128:131], v[112:115], v[96:99], v[128:131]
ds_read_b128 v[32:35], v8 offset:0
v_mfma_f32_16x16x32_bf16 v[132:135], v[116:119], v[96:99], v[132:135]
ds_read_b64_tr_b16 v[48:49], v9 offset:0
v_mfma_f32_16x16x32_bf16 v[160:163], v[120:123], v[96:99], v[160:163]
ds_read_b64_tr_b16 v[50:51], v9 offset:4096
v_mfma_f32_16x16x32_bf16 v[164:167], v[124:127], v[96:99], v[164:167]
ds_read_b64_tr_b16 v[52:53], v10 offset:0
v_mfma_f32_16x16x32_bf16 v[172:175], v[124:127], v[100:103], v[172:175]
ds_read_b64_tr_b16 v[54:55], v10 offset:4096
v_mfma_f32_16x16x32_bf16 v[168:171], v[120:123], v[100:103], v[168:171]
ds_read_b64_tr_b16 v[56:57], v11 offset:0
v_mfma_f32_16x16x32_bf16 v[140:143], v[116:119], v[100:103], v[140:143]
ds_read_b64_tr_b16 v[58:59], v11 offset:4096
v_mfma_f32_16x16x32_bf16 v[136:139], v[112:115], v[100:103], v[136:139]
ds_read_b64_tr_b16 v[60:61], v12 offset:0
v_mfma_f32_16x16x32_bf16 v[144:147], v[112:115], v[104:107], v[144:147]
ds_read_b64_tr_b16 v[62:63], v12 offset:4096
v_mfma_f32_16x16x32_bf16 v[148:151], v[116:119], v[104:107], v[148:151]
ds_read_b128 v[36:39], v8 offset:1024
v_mfma_f32_16x16x32_bf16 v[176:179], v[120:123], v[104:107], v[176:179]
ds_read_b128 v[40:43], v8 offset:2048
v_mfma_f32_16x16x32_bf16 v[180:183], v[124:127], v[104:107], v[180:183]
ds_read_b128 v[44:47], v8 offset:3072
v_mfma_f32_16x16x32_bf16 v[188:191], v[124:127], v[108:111], v[188:191]
ds_read_b128 v[64:67], v8 offset:8192
v_mfma_f32_16x16x32_bf16 v[184:187], v[120:123], v[108:111], v[184:187]
ds_read_b64_tr_b16 v[80:81], v9 offset:8192
v_mfma_f32_16x16x32_bf16 v[156:159], v[116:119], v[108:111], v[156:159]
ds_read_b64_tr_b16 v[82:83], v9 offset:12288
v_mfma_f32_16x16x32_bf16 v[152:155], v[112:115], v[108:111], v[152:155]
ds_read_b64_tr_b16 v[84:85], v10 offset:8192
v_mfma_f32_16x16x32_bf16 v[128:131], v[208:211], v[192:195], v[128:131]
s_branch Lov_11
.p2align 12
Lst_11_0:
s_branch Lwr_151
Lst_11_1:
s_branch Lst_15_0
s_nop 0
Lov_11:
ds_read_b64_tr_b16 v[86:87], v10 offset:12288
v_mfma_f32_16x16x32_bf16 v[132:135], v[212:215], v[192:195], v[132:135]
ds_read_b64_tr_b16 v[88:89], v11 offset:8192
v_mfma_f32_16x16x32_bf16 v[160:163], v[216:219], v[192:195], v[160:163]
ds_read_b64_tr_b16 v[90:91], v11 offset:12288
v_mfma_f32_16x16x32_bf16 v[164:167], v[220:223], v[192:195], v[164:167]
ds_read_b64_tr_b16 v[92:93], v12 offset:8192
v_mfma_f32_16x16x32_bf16 v[172:175], v[220:223], v[196:199], v[172:175]
ds_read_b64_tr_b16 v[94:95], v12 offset:12288
v_mfma_f32_16x16x32_bf16 v[168:171], v[216:219], v[196:199], v[168:171]
ds_read_b128 v[68:71], v8 offset:9216
v_mfma_f32_16x16x32_bf16 v[140:143], v[212:215], v[196:199], v[140:143]
ds_read_b128 v[72:75], v8 offset:10240
v_mfma_f32_16x16x32_bf16 v[136:139], v[208:211], v[196:199], v[136:139]
ds_read_b128 v[76:79], v8 offset:11264
v_mfma_f32_16x16x32_bf16 v[144:147], v[208:211], v[200:203], v[144:147]
v_mfma_f32_16x16x32_bf16 v[148:151], v[212:215], v[200:203], v[148:151]
v_mfma_f32_16x16x32_bf16 v[176:179], v[216:219], v[200:203], v[176:179]
v_mfma_f32_16x16x32_bf16 v[180:183], v[220:223], v[200:203], v[180:183]
v_mfma_f32_16x16x32_bf16 v[188:191], v[220:223], v[204:207], v[188:191]
v_mfma_f32_16x16x32_bf16 v[184:187], v[216:219], v[204:207], v[184:187]
v_mfma_f32_16x16x32_bf16 v[156:159], v[212:215], v[204:207], v[156:159]
v_mfma_f32_16x16x32_bf16 v[152:155], v[208:211], v[204:207], v[152:155]
s_waitcnt lgkmcnt(0)
s_barrier
v_mfma_f32_16x16x32_bf16 v[128:131], v[48:51], v[32:35], v[128:131]
ds_read_b128 v[96:99], v6 offset:16384
v_mfma_f32_16x16x32_bf16 v[132:135], v[52:55], v[32:35], v[132:135]
ds_read_b64_tr_b16 v[112:113], v9 offset:32768
v_mfma_f32_16x16x32_bf16 v[160:163], v[56:59], v[32:35], v[160:163]
ds_read_b64_tr_b16 v[114:115], v9 offset:36864
v_mfma_f32_16x16x32_bf16 v[164:167], v[60:63], v[32:35], v[164:167]
ds_read_b64_tr_b16 v[116:117], v10 offset:32768
v_mfma_f32_16x16x32_bf16 v[172:175], v[60:63], v[36:39], v[172:175]
ds_read_b64_tr_b16 v[118:119], v10 offset:36864
v_mfma_f32_16x16x32_bf16 v[168:171], v[56:59], v[36:39], v[168:171]
ds_read_b64_tr_b16 v[120:121], v11 offset:32768
v_mfma_f32_16x16x32_bf16 v[140:143], v[52:55], v[36:39], v[140:143]
ds_read_b64_tr_b16 v[122:123], v11 offset:36864
v_mfma_f32_16x16x32_bf16 v[136:139], v[48:51], v[36:39], v[136:139]
ds_read_b64_tr_b16 v[124:125], v12 offset:32768
v_mfma_f32_16x16x32_bf16 v[144:147], v[48:51], v[40:43], v[144:147]
ds_read_b64_tr_b16 v[126:127], v12 offset:36864
v_mfma_f32_16x16x32_bf16 v[148:151], v[52:55], v[40:43], v[148:151]
ds_read_b128 v[100:103], v6 offset:17408
v_mfma_f32_16x16x32_bf16 v[176:179], v[56:59], v[40:43], v[176:179]
ds_read_b128 v[104:107], v6 offset:18432
v_mfma_f32_16x16x32_bf16 v[180:183], v[60:63], v[40:43], v[180:183]
ds_read_b128 v[108:111], v6 offset:19456
v_mfma_f32_16x16x32_bf16 v[188:191], v[60:63], v[44:47], v[188:191]
ds_read_b128 v[192:195], v6 offset:24576
v_mfma_f32_16x16x32_bf16 v[184:187], v[56:59], v[44:47], v[184:187]
ds_read_b64_tr_b16 v[208:209], v9 offset:40960
v_mfma_f32_16x16x32_bf16 v[156:159], v[52:55], v[44:47], v[156:159]
ds_read_b64_tr_b16 v[210:211], v9 offset:45056
v_mfma_f32_16x16x32_bf16 v[152:155], v[48:51], v[44:47], v[152:155]
ds_read_b64_tr_b16 v[212:213], v10 offset:40960
v_mfma_f32_16x16x32_bf16 v[128:131], v[80:83], v[64:67], v[128:131]
ds_read_b64_tr_b16 v[214:215], v10 offset:45056
v_mfma_f32_16x16x32_bf16 v[132:135], v[84:87], v[64:67], v[132:135]
ds_read_b64_tr_b16 v[216:217], v11 offset:40960
v_mfma_f32_16x16x32_bf16 v[160:163], v[88:91], v[64:67], v[160:163]
ds_read_b64_tr_b16 v[218:219], v11 offset:45056
v_mfma_f32_16x16x32_bf16 v[164:167], v[92:95], v[64:67], v[164:167]
ds_read_b64_tr_b16 v[220:221], v12 offset:40960
v_mfma_f32_16x16x32_bf16 v[172:175], v[92:95], v[68:71], v[172:175]
ds_read_b64_tr_b16 v[222:223], v12 offset:45056
v_mfma_f32_16x16x32_bf16 v[168:171], v[88:91], v[68:71], v[168:171]
ds_read_b128 v[196:199], v6 offset:25600
v_mfma_f32_16x16x32_bf16 v[140:143], v[84:87], v[68:71], v[140:143]
ds_read_b128 v[200:203], v6 offset:26624
v_mfma_f32_16x16x32_bf16 v[136:139], v[80:83], v[68:71], v[136:139]
ds_read_b128 v[204:207], v6 offset:27648
v_mfma_f32_16x16x32_bf16 v[144:147], v[80:83], v[72:75], v[144:147]
v_mfma_f32_16x16x32_bf16 v[148:151], v[84:87], v[72:75], v[148:151]
v_mfma_f32_16x16x32_bf16 v[176:179], v[88:91], v[72:75], v[176:179]
v_mfma_f32_16x16x32_bf16 v[180:183], v[92:95], v[72:75], v[180:183]
v_mfma_f32_16x16x32_bf16 v[188:191], v[92:95], v[76:79], v[188:191]
v_mfma_f32_16x16x32_bf16 v[184:187], v[88:91], v[76:79], v[184:187]
v_mfma_f32_16x16x32_bf16 v[156:159], v[84:87], v[76:79], v[156:159]
v_mfma_f32_16x16x32_bf16 v[152:155], v[80:83], v[76:79], v[152:155]
s_waitcnt lgkmcnt(0)
s_barrier
v_mfma_f32_16x16x32_bf16 v[128:131], v[112:115], v[96:99], v[128:131]
ds_read_b128 v[32:35], v6 offset:49152
v_mfma_f32_16x16x32_bf16 v[132:135], v[116:119], v[96:99], v[132:135]
ds_read_b64_tr_b16 v[48:49], v13 offset:0
v_mfma_f32_16x16x32_bf16 v[160:163], v[120:123], v[96:99], v[160:163]
ds_read_b64_tr_b16 v[50:51], v13 offset:4096
v_mfma_f32_16x16x32_bf16 v[164:167], v[124:127], v[96:99], v[164:167]
ds_read_b64_tr_b16 v[52:53], v14 offset:0
v_mfma_f32_16x16x32_bf16 v[172:175], v[124:127], v[100:103], v[172:175]
ds_read_b64_tr_b16 v[54:55], v14 offset:4096
v_mfma_f32_16x16x32_bf16 v[168:171], v[120:123], v[100:103], v[168:171]
ds_read_b64_tr_b16 v[56:57], v15 offset:0
v_mfma_f32_16x16x32_bf16 v[140:143], v[116:119], v[100:103], v[140:143]
ds_read_b64_tr_b16 v[58:59], v15 offset:4096
v_mfma_f32_16x16x32_bf16 v[136:139], v[112:115], v[100:103], v[136:139]
ds_read_b64_tr_b16 v[60:61], v16 offset:0
v_mfma_f32_16x16x32_bf16 v[144:147], v[112:115], v[104:107], v[144:147]
ds_read_b64_tr_b16 v[62:63], v16 offset:4096
v_mfma_f32_16x16x32_bf16 v[148:151], v[116:119], v[104:107], v[148:151]
ds_read_b128 v[36:39], v6 offset:50176
v_mfma_f32_16x16x32_bf16 v[176:179], v[120:123], v[104:107], v[176:179]
ds_read_b128 v[40:43], v6 offset:51200
v_mfma_f32_16x16x32_bf16 v[180:183], v[124:127], v[104:107], v[180:183]
ds_read_b128 v[44:47], v6 offset:52224
v_mfma_f32_16x16x32_bf16 v[188:191], v[124:127], v[108:111], v[188:191]
ds_read_b128 v[64:67], v6 offset:57344
v_mfma_f32_16x16x32_bf16 v[184:187], v[120:123], v[108:111], v[184:187]
ds_read_b64_tr_b16 v[80:81], v13 offset:8192
v_mfma_f32_16x16x32_bf16 v[156:159], v[116:119], v[108:111], v[156:159]
ds_read_b64_tr_b16 v[82:83], v13 offset:12288
v_mfma_f32_16x16x32_bf16 v[152:155], v[112:115], v[108:111], v[152:155]
ds_read_b64_tr_b16 v[84:85], v14 offset:8192
v_mfma_f32_16x16x32_bf16 v[128:131], v[208:211], v[192:195], v[128:131]
ds_read_b64_tr_b16 v[86:87], v14 offset:12288
v_mfma_f32_16x16x32_bf16 v[132:135], v[212:215], v[192:195], v[132:135]
ds_read_b64_tr_b16 v[88:89], v15 offset:8192
v_mfma_f32_16x16x32_bf16 v[160:163], v[216:219], v[192:195], v[160:163]
ds_read_b64_tr_b16 v[90:91], v15 offset:12288
v_mfma_f32_16x16x32_bf16 v[164:167], v[220:223], v[192:195], v[164:167]
ds_read_b64_tr_b16 v[92:93], v16 offset:8192
v_mfma_f32_16x16x32_bf16 v[172:175], v[220:223], v[196:199], v[172:175]
ds_read_b64_tr_b16 v[94:95], v16 offset:12288
v_mfma_f32_16x16x32_bf16 v[168:171], v[216:219], v[196:199], v[168:171]
ds_read_b128 v[68:71], v6 offset:58368
v_mfma_f32_16x16x32_bf16 v[140:143], v[212:215], v[196:199], v[140:143]
ds_read_b128 v[72:75], v6 offset:59392
v_mfma_f32_16x16x32_bf16 v[136:139], v[208:211], v[196:199], v[136:139]
ds_read_b128 v[76:79], v6 offset:60416
v_mfma_f32_16x16x32_bf16 v[144:147], v[208:211], v[200:203], v[144:147]
v_mfma_f32_16x16x32_bf16 v[148:151], v[212:215], v[200:203], v[148:151]
v_mfma_f32_16x16x32_bf16 v[176:179], v[216:219], v[200:203], v[176:179]
v_mfma_f32_16x16x32_bf16 v[180:183], v[220:223], v[200:203], v[180:183]
v_mfma_f32_16x16x32_bf16 v[188:191], v[220:223], v[204:207], v[188:191]
v_mfma_f32_16x16x32_bf16 v[184:187], v[216:219], v[204:207], v[184:187]
v_mfma_f32_16x16x32_bf16 v[156:159], v[212:215], v[204:207], v[156:159]
v_mfma_f32_16x16x32_bf16 v[152:155], v[208:211], v[204:207], v[152:155]
s_waitcnt lgkmcnt(0)
s_barrier
v_mfma_f32_16x16x32_bf16 v[128:131], v[48:51], v[32:35], v[128:131]
ds_read_b128 v[96:99], v7 offset:16384
v_mfma_f32_16x16x32_bf16 v[132:135], v[52:55], v[32:35], v[132:135]
ds_read_b64_tr_b16 v[112:113], v25 offset:16384
v_mfma_f32_16x16x32_bf16 v[160:163], v[56:59], v[32:35], v[160:163]
ds_read_b64_tr_b16 v[114:115], v25 offset:20480
v_mfma_f32_16x16x32_bf16 v[164:167], v[60:63], v[32:35], v[164:167]
ds_read_b64_tr_b16 v[116:117], v26 offset:16384
v_mfma_f32_16x16x32_bf16 v[172:175], v[60:63], v[36:39], v[172:175]
ds_read_b64_tr_b16 v[118:119], v26 offset:20480
v_mfma_f32_16x16x32_bf16 v[168:171], v[56:59], v[36:39], v[168:171]
ds_read_b64_tr_b16 v[120:121], v27 offset:16384
v_mfma_f32_16x16x32_bf16 v[140:143], v[52:55], v[36:39], v[140:143]
ds_read_b64_tr_b16 v[122:123], v27 offset:20480
v_mfma_f32_16x16x32_bf16 v[136:139], v[48:51], v[36:39], v[136:139]
ds_read_b64_tr_b16 v[124:125], v28 offset:16384
v_mfma_f32_16x16x32_bf16 v[144:147], v[48:51], v[40:43], v[144:147]
ds_read_b64_tr_b16 v[126:127], v28 offset:20480
v_mfma_f32_16x16x32_bf16 v[148:151], v[52:55], v[40:43], v[148:151]
ds_read_b128 v[100:103], v7 offset:17408
v_mfma_f32_16x16x32_bf16 v[176:179], v[56:59], v[40:43], v[176:179]
ds_read_b128 v[104:107], v7 offset:18432
v_mfma_f32_16x16x32_bf16 v[180:183], v[60:63], v[40:43], v[180:183]
ds_read_b128 v[108:111], v7 offset:19456
v_mfma_f32_16x16x32_bf16 v[188:191], v[60:63], v[44:47], v[188:191]
ds_read_b128 v[192:195], v7 offset:24576
v_mfma_f32_16x16x32_bf16 v[184:187], v[56:59], v[44:47], v[184:187]
ds_read_b64_tr_b16 v[208:209], v25 offset:24576
v_mfma_f32_16x16x32_bf16 v[156:159], v[52:55], v[44:47], v[156:159]
ds_read_b64_tr_b16 v[210:211], v25 offset:28672
v_mfma_f32_16x16x32_bf16 v[152:155], v[48:51], v[44:47], v[152:155]
ds_read_b64_tr_b16 v[212:213], v26 offset:24576
v_mfma_f32_16x16x32_bf16 v[128:131], v[80:83], v[64:67], v[128:131]
ds_read_b64_tr_b16 v[214:215], v26 offset:28672
v_mfma_f32_16x16x32_bf16 v[132:135], v[84:87], v[64:67], v[132:135]
ds_read_b64_tr_b16 v[216:217], v27 offset:24576
v_mfma_f32_16x16x32_bf16 v[160:163], v[88:91], v[64:67], v[160:163]
ds_read_b64_tr_b16 v[218:219], v27 offset:28672
v_mfma_f32_16x16x32_bf16 v[164:167], v[92:95], v[64:67], v[164:167]
ds_read_b64_tr_b16 v[220:221], v28 offset:24576
v_mfma_f32_16x16x32_bf16 v[172:175], v[92:95], v[68:71], v[172:175]
ds_read_b64_tr_b16 v[222:223], v28 offset:28672
v_mfma_f32_16x16x32_bf16 v[168:171], v[88:91], v[68:71], v[168:171]
ds_read_b128 v[196:199], v7 offset:25600
v_mfma_f32_16x16x32_bf16 v[140:143], v[84:87], v[68:71], v[140:143]
ds_read_b128 v[200:203], v7 offset:26624
v_mfma_f32_16x16x32_bf16 v[136:139], v[80:83], v[68:71], v[136:139]
ds_read_b128 v[204:207], v7 offset:27648
v_mfma_f32_16x16x32_bf16 v[144:147], v[80:83], v[72:75], v[144:147]
v_mfma_f32_16x16x32_bf16 v[148:151], v[84:87], v[72:75], v[148:151]
v_mfma_f32_16x16x32_bf16 v[176:179], v[88:91], v[72:75], v[176:179]
v_mfma_f32_16x16x32_bf16 v[180:183], v[92:95], v[72:75], v[180:183]
v_mfma_f32_16x16x32_bf16 v[188:191], v[92:95], v[76:79], v[188:191]
v_mfma_f32_16x16x32_bf16 v[184:187], v[88:91], v[76:79], v[184:187]
v_mfma_f32_16x16x32_bf16 v[156:159], v[84:87], v[76:79], v[156:159]
v_mfma_f32_16x16x32_bf16 v[152:155], v[80:83], v[76:79], v[152:155]
s_waitcnt lgkmcnt(0)
s_barrier
v_mfma_f32_16x16x32_bf16 v[128:131], v[112:115], v[96:99], v[128:131]
ds_read_b128 v[32:35], v7 offset:32768
v_mfma_f32_16x16x32_bf16 v[132:135], v[116:119], v[96:99], v[132:135]
ds_read_b64_tr_b16 v[48:49], v13 offset:49152
v_mfma_f32_16x16x32_bf16 v[160:163], v[120:123], v[96:99], v[160:163]
ds_read_b64_tr_b16 v[50:51], v13 offset:53248
v_mfma_f32_16x16x32_bf16 v[164:167], v[124:127], v[96:99], v[164:167]
ds_read_b64_tr_b16 v[52:53], v14 offset:49152
v_mfma_f32_16x16x32_bf16 v[172:175], v[124:127], v[100:103], v[172:175]
ds_read_b64_tr_b16 v[54:55], v14 offset:53248
v_mfma_f32_16x16x32_bf16 v[168:171], v[120:123], v[100:103], v[168:171]
ds_read_b64_tr_b16 v[56:57], v15 offset:49152
v_mfma_f32_16x16x32_bf16 v[140:143], v[116:119], v[100:103], v[140:143]
ds_read_b64_tr_b16 v[58:59], v15 offset:53248
v_mfma_f32_16x16x32_bf16 v[136:139], v[112:115], v[100:103], v[136:139]
ds_read_b64_tr_b16 v[60:61], v16 offset:49152
v_mfma_f32_16x16x32_bf16 v[144:147], v[112:115], v[104:107], v[144:147]
ds_read_b64_tr_b16 v[62:63], v16 offset:53248
v_mfma_f32_16x16x32_bf16 v[148:151], v[116:119], v[104:107], v[148:151]
ds_read_b128 v[36:39], v7 offset:33792
v_mfma_f32_16x16x32_bf16 v[176:179], v[120:123], v[104:107], v[176:179]
ds_read_b128 v[40:43], v7 offset:34816
v_mfma_f32_16x16x32_bf16 v[180:183], v[124:127], v[104:107], v[180:183]
ds_read_b128 v[44:47], v7 offset:35840
v_mfma_f32_16x16x32_bf16 v[188:191], v[124:127], v[108:111], v[188:191]
ds_read_b128 v[64:67], v7 offset:40960
v_mfma_f32_16x16x32_bf16 v[184:187], v[120:123], v[108:111], v[184:187]
ds_read_b64_tr_b16 v[80:81], v13 offset:57344
v_mfma_f32_16x16x32_bf16 v[156:159], v[116:119], v[108:111], v[156:159]
ds_read_b64_tr_b16 v[82:83], v13 offset:61440
v_mfma_f32_16x16x32_bf16 v[152:155], v[112:115], v[108:111], v[152:155]
ds_read_b64_tr_b16 v[84:85], v14 offset:57344
v_mfma_f32_16x16x32_bf16 v[128:131], v[208:211], v[192:195], v[128:131]
ds_read_b64_tr_b16 v[86:87], v14 offset:61440
v_mfma_f32_16x16x32_bf16 v[132:135], v[212:215], v[192:195], v[132:135]
ds_read_b64_tr_b16 v[88:89], v15 offset:57344
v_mfma_f32_16x16x32_bf16 v[160:163], v[216:219], v[192:195], v[160:163]
ds_read_b64_tr_b16 v[90:91], v15 offset:61440
v_mfma_f32_16x16x32_bf16 v[164:167], v[220:223], v[192:195], v[164:167]
ds_read_b64_tr_b16 v[92:93], v16 offset:57344
v_mfma_f32_16x16x32_bf16 v[172:175], v[220:223], v[196:199], v[172:175]
ds_read_b64_tr_b16 v[94:95], v16 offset:61440
v_mfma_f32_16x16x32_bf16 v[168:171], v[216:219], v[196:199], v[168:171]
ds_read_b128 v[68:71], v7 offset:41984
v_mfma_f32_16x16x32_bf16 v[140:143], v[212:215], v[196:199], v[140:143]
ds_read_b128 v[72:75], v7 offset:43008
v_mfma_f32_16x16x32_bf16 v[136:139], v[208:211], v[196:199], v[136:139]
ds_read_b128 v[76:79], v7 offset:44032
v_mfma_f32_16x16x32_bf16 v[144:147], v[208:211], v[200:203], v[144:147]
v_mfma_f32_16x16x32_bf16 v[148:151], v[212:215], v[200:203], v[148:151]
v_mfma_f32_16x16x32_bf16 v[176:179], v[216:219], v[200:203], v[176:179]
v_mfma_f32_16x16x32_bf16 v[180:183], v[220:223], v[200:203], v[180:183]
v_mfma_f32_16x16x32_bf16 v[188:191], v[220:223], v[204:207], v[188:191]
v_mfma_f32_16x16x32_bf16 v[184:187], v[216:219], v[204:207], v[184:187]
v_mfma_f32_16x16x32_bf16 v[156:159], v[212:215], v[204:207], v[156:159]
v_mfma_f32_16x16x32_bf16 v[152:155], v[208:211], v[204:207], v[152:155]
s_waitcnt lgkmcnt(0)
s_barrier
v_mfma_f32_16x16x32_bf16 v[128:131], v[48:51], v[32:35], v[128:131]
ds_read_b128 v[96:99], v8 offset:0
v_mfma_f32_16x16x32_bf16 v[132:135], v[52:55], v[32:35], v[132:135]
ds_read_b64_tr_b16 v[112:113], v9 offset:0
v_mfma_f32_16x16x32_bf16 v[160:163], v[56:59], v[32:35], v[160:163]
ds_read_b64_tr_b16 v[114:115], v9 offset:4096
v_mfma_f32_16x16x32_bf16 v[164:167], v[60:63], v[32:35], v[164:167]
ds_read_b64_tr_b16 v[116:117], v10 offset:0
v_mfma_f32_16x16x32_bf16 v[172:175], v[60:63], v[36:39], v[172:175]
ds_read_b64_tr_b16 v[118:119], v10 offset:4096
v_mfma_f32_16x16x32_bf16 v[168:171], v[56:59], v[36:39], v[168:171]
ds_read_b64_tr_b16 v[120:121], v11 offset:0
v_mfma_f32_16x16x32_bf16 v[140:143], v[52:55], v[36:39], v[140:143]
ds_read_b64_tr_b16 v[122:123], v11 offset:4096
v_mfma_f32_16x16x32_bf16 v[136:139], v[48:51], v[36:39], v[136:139]
ds_read_b64_tr_b16 v[124:125], v12 offset:0
v_mfma_f32_16x16x32_bf16 v[144:147], v[48:51], v[40:43], v[144:147]
ds_read_b64_tr_b16 v[126:127], v12 offset:4096
v_mfma_f32_16x16x32_bf16 v[148:151], v[52:55], v[40:43], v[148:151]
ds_read_b128 v[100:103], v8 offset:1024
v_mfma_f32_16x16x32_bf16 v[176:179], v[56:59], v[40:43], v[176:179]
ds_read_b128 v[104:107], v8 offset:2048
v_mfma_f32_16x16x32_bf16 v[180:183], v[60:63], v[40:43], v[180:183]
ds_read_b128 v[108:111], v8 offset:3072
v_mfma_f32_16x16x32_bf16 v[188:191], v[60:63], v[44:47], v[188:191]
ds_read_b128 v[192:195], v8 offset:8192
v_mfma_f32_16x16x32_bf16 v[184:187], v[56:59], v[44:47], v[184:187]
ds_read_b64_tr_b16 v[208:209], v9 offset:8192
v_mfma_f32_16x16x32_bf16 v[156:159], v[52:55], v[44:47], v[156:159]
ds_read_b64_tr_b16 v[210:211], v9 offset:12288
v_mfma_f32_16x16x32_bf16 v[152:155], v[48:51], v[44:47], v[152:155]
ds_read_b64_tr_b16 v[212:213], v10 offset:8192
v_mfma_f32_16x16x32_bf16 v[128:131], v[80:83], v[64:67], v[128:131]
ds_read_b64_tr_b16 v[214:215], v10 offset:12288
v_mfma_f32_16x16x32_bf16 v[132:135], v[84:87], v[64:67], v[132:135]
ds_read_b64_tr_b16 v[216:217], v11 offset:8192
v_mfma_f32_16x16x32_bf16 v[160:163], v[88:91], v[64:67], v[160:163]
ds_read_b64_tr_b16 v[218:219], v11 offset:12288
v_mfma_f32_16x16x32_bf16 v[164:167], v[92:95], v[64:67], v[164:167]
ds_read_b64_tr_b16 v[220:221], v12 offset:8192
v_mfma_f32_16x16x32_bf16 v[172:175], v[92:95], v[68:71], v[172:175]
ds_read_b64_tr_b16 v[222:223], v12 offset:12288
v_mfma_f32_16x16x32_bf16 v[168:171], v[88:91], v[68:71], v[168:171]
ds_read_b128 v[196:199], v8 offset:9216
v_mfma_f32_16x16x32_bf16 v[140:143], v[84:87], v[68:71], v[140:143]
ds_read_b128 v[200:203], v8 offset:10240
v_mfma_f32_16x16x32_bf16 v[136:139], v[80:83], v[68:71], v[136:139]
ds_read_b128 v[204:207], v8 offset:11264
v_mfma_f32_16x16x32_bf16 v[144:147], v[80:83], v[72:75], v[144:147]
v_mfma_f32_16x16x32_bf16 v[148:151], v[84:87], v[72:75], v[148:151]
v_mfma_f32_16x16x32_bf16 v[176:179], v[88:91], v[72:75], v[176:179]
v_mfma_f32_16x16x32_bf16 v[180:183], v[92:95], v[72:75], v[180:183]
v_mfma_f32_16x16x32_bf16 v[188:191], v[92:95], v[76:79], v[188:191]
v_mfma_f32_16x16x32_bf16 v[184:187], v[88:91], v[76:79], v[184:187]
v_mfma_f32_16x16x32_bf16 v[156:159], v[84:87], v[76:79], v[156:159]
v_mfma_f32_16x16x32_bf16 v[152:155], v[80:83], v[76:79], v[152:155]
s_sub_u32 s41, s41, 1
s_cmp_lg_u32 s41, 0
s_cbranch_scc1 Lk4_116
s_waitcnt lgkmcnt(0)
s_barrier
v_mfma_f32_16x16x32_bf16 v[128:131], v[112:115], v[96:99], v[128:131]
ds_read_b128 v[32:35], v6 offset:16384
v_mfma_f32_16x16x32_bf16 v[132:135], v[116:119], v[96:99], v[132:135]
ds_read_b64_tr_b16 v[48:49], v224 offset:32768
v_mfma_f32_16x16x32_bf16 v[160:163], v[120:123], v[96:99], v[160:163]
ds_read_b64_tr_b16 v[50:51], v224 offset:34816
v_mfma_f32_16x16x32_bf16 v[164:167], v[124:127], v[96:99], v[164:167]
ds_read_b64_tr_b16 v[52:53], v225 offset:32768
v_mfma_f32_16x16x32_bf16 v[172:175], v[124:127], v[100:103], v[172:175]
ds_read_b64_tr_b16 v[54:55], v225 offset:34816
v_mfma_f32_16x16x32_bf16 v[168:171], v[120:123], v[100:103], v[168:171]
ds_read_b128 v[36:39], v6 offset:17408
v_mfma_f32_16x16x32_bf16 v[140:143], v[116:119], v[100:103], v[140:143]
ds_read_b128 v[40:43], v6 offset:18432
v_mfma_f32_16x16x32_bf16 v[136:139], v[112:115], v[100:103], v[136:139]
ds_read_b128 v[44:47], v6 offset:19456
v_mfma_f32_16x16x32_bf16 v[144:147], v[112:115], v[104:107], v[144:147]
ds_read_b128 v[64:67], v6 offset:24576
v_mfma_f32_16x16x32_bf16 v[148:151], v[116:119], v[104:107], v[148:151]
ds_read_b64_tr_b16 v[80:81], v224 offset:36864
v_mfma_f32_16x16x32_bf16 v[176:179], v[120:123], v[104:107], v[176:179]
ds_read_b64_tr_b16 v[82:83], v224 offset:38912
v_mfma_f32_16x16x32_bf16 v[180:183], v[124:127], v[104:107], v[180:183]
ds_read_b64_tr_b16 v[84:85], v225 offset:36864
v_mfma_f32_16x16x32_bf16 v[188:191], v[124:127], v[108:111], v[188:191]
ds_read_b64_tr_b16 v[86:87], v225 offset:38912
v_mfma_f32_16x16x32_bf16 v[184:187], v[120:123], v[108:111], v[184:187]
ds_read_b128 v[68:71], v6 offset:25600
v_mfma_f32_16x16x32_bf16 v[156:159], v[116:119], v[108:111], v[156:159]
ds_read_b128 v[72:75], v6 offset:26624
v_mfma_f32_16x16x32_bf16 v[152:155], v[112:115], v[108:111], v[152:155]
ds_read_b128 v[76:79], v6 offset:27648
v_mfma_f32_16x16x32_bf16 v[128:131], v[208:211], v[192:195], v[128:131]
v_mfma_f32_16x16x32_bf16 v[132:135], v[212:215], v[192:195], v[132:135]
v_mfma_f32_16x16x32_bf16 v[160:163], v[216:219], v[192:195], v[160:163]
v_mfma_f32_16x16x32_bf16 v[164:167], v[220:223], v[192:195], v[164:167]
v_mfma_f32_16x16x32_bf16 v[172:175], v[220:223], v[196:199], v[172:175]
v_mfma_f32_16x16x32_bf16 v[168:171], v[216:219], v[196:199], v[168:171]
v_mfma_f32_16x16x32_bf16 v[140:143], v[212:215], v[196:199], v[140:143]
v_mfma_f32_16x16x32_bf16 v[136:139], v[208:211], v[196:199], v[136:139]
v_mfma_f32_16x16x32_bf16 v[144:147], v[208:211], v[200:203], v[144:147]
v_mfma_f32_16x16x32_bf16 v[148:151], v[212:215], v[200:203], v[148:151]
v_mfma_f32_16x16x32_bf16 v[176:179], v[216:219], v[200:203], v[176:179]
v_mfma_f32_16x16x32_bf16 v[180:183], v[220:223], v[200:203], v[180:183]
v_mfma_f32_16x16x32_bf16 v[188:191], v[220:223], v[204:207], v[188:191]
v_mfma_f32_16x16x32_bf16 v[184:187], v[216:219], v[204:207], v[184:187]
v_mfma_f32_16x16x32_bf16 v[156:159], v[212:215], v[204:207], v[156:159]
v_mfma_f32_16x16x32_bf16 v[152:155], v[208:211], v[204:207], v[152:155]
s_waitcnt lgkmcnt(0)
s_barrier
v_mfma_f32_16x16x32_bf16 v[128:131], v[48:51], v[32:35], v[128:131]
ds_read_b128 v[96:99], v6 offset:49152
ds_read_b64_tr_b16 v[112:113], v226 offset:0
v_mfma_f32_16x16x32_bf16 v[132:135], v[52:55], v[32:35], v[132:135]
ds_read_b64_tr_b16 v[114:115], v226 offset:2048
ds_read_b64_tr_b16 v[116:117], v227 offset:0
v_mfma_f32_16x16x32_bf16 v[140:143], v[52:55], v[36:39], v[140:143]
ds_read_b64_tr_b16 v[118:119], v227 offset:2048
ds_read_b128 v[100:103], v6 offset:50176
v_mfma_f32_16x16x32_bf16 v[136:139], v[48:51], v[36:39], v[136:139]
ds_read_b128 v[104:107], v6 offset:51200
ds_read_b128 v[108:111], v6 offset:52224
v_mfma_f32_16x16x32_bf16 v[144:147], v[48:51], v[40:43], v[144:147]
ds_read_b128 v[192:195], v6 offset:57344
v_mfma_f32_16x16x32_bf16 v[148:151], v[52:55], v[40:43], v[148:151]
ds_read_b64_tr_b16 v[208:209], v226 offset:4096
v_mfma_f32_16x16x32_bf16 v[156:159], v[52:55], v[44:47], v[156:159]
ds_read_b64_tr_b16 v[210:211], v226 offset:6144
v_cvt_pk_bf16_f32 v160, v160, v161
v_cvt_pk_bf16_f32 v161, v162, v163
v_mfma_f32_16x16x32_bf16 v[152:155], v[48:51], v[44:47], v[152:155]
ds_read_b64_tr_b16 v[212:213], v227 offset:4096
v_cvt_pk_bf16_f32 v162, v164, v165
v_cvt_pk_bf16_f32 v163, v166, v167
v_mfma_f32_16x16x32_bf16 v[128:131], v[80:83], v[64:67], v[128:131]
ds_read_b64_tr_b16 v[214:215], v227 offset:6144
v_cvt_pk_bf16_f32 v164, v168, v169
v_cvt_pk_bf16_f32 v165, v170, v171
v_mfma_f32_16x16x32_bf16 v[132:135], v[84:87], v[64:67], v[132:135]
ds_read_b128 v[196:199], v6 offset:58368
v_cvt_pk_bf16_f32 v166, v172, v173
v_cvt_pk_bf16_f32 v167, v174, v175
v_mfma_f32_16x16x32_bf16 v[140:143], v[84:87], v[68:71], v[140:143]
ds_read_b128 v[200:203], v6 offset:59392
v_cvt_pk_bf16_f32 v168, v176, v177
v_cvt_pk_bf16_f32 v169, v178, v179
v_mfma_f32_16x16x32_bf16 v[136:139], v[80:83], v[68:71], v[136:139]
ds_read_b128 v[204:207], v6 offset:60416
v_cvt_pk_bf16_f32 v170, v180, v181
v_cvt_pk_bf16_f32 v171, v182, v183
v_mfma_f32_16x16x32_bf16 v[144:147], v[80:83], v[72:75], v[144:147]
v_cvt_pk_bf16_f32 v172, v184, v185
v_cvt_pk_bf16_f32 v173, v186, v187
v_mfma_f32_16x16x32_bf16 v[148:151], v[84:87], v[72:75], v[148:151]
v_cvt_pk_bf16_f32 v174, v188, v189
v_cvt_pk_bf16_f32 v175, v190, v191
v_mfma_f32_16x16x32_bf16 v[156:159], v[84:87], v[76:79], v[156:159]
v_mfma_f32_16x16x32_bf16 v[152:155], v[80:83], v[76:79], v[152:155]
buffer_store_dwordx4 v[160:163], v2, s[84:87], s45 offen offset:0 sc1
s_waitcnt lgkmcnt(0)
s_barrier
v_mfma_f32_16x16x32_bf16 v[128:131], v[112:115], v[96:99], v[128:131]
ds_read_b128 v[32:35], v7 offset:16384
ds_read_b64_tr_b16 v[48:49], v228 offset:16384
v_mfma_f32_16x16x32_bf16 v[132:135], v[116:119], v[96:99], v[132:135]
ds_read_b64_tr_b16 v[50:51], v228 offset:18432
ds_read_b64_tr_b16 v[52:53], v229 offset:16384
v_mfma_f32_16x16x32_bf16 v[140:143], v[116:119], v[100:103], v[140:143]
ds_read_b64_tr_b16 v[54:55], v229 offset:18432
ds_read_b128 v[36:39], v7 offset:17408
v_mfma_f32_16x16x32_bf16 v[136:139], v[112:115], v[100:103], v[136:139]
ds_read_b128 v[40:43], v7 offset:18432
ds_read_b128 v[44:47], v7 offset:19456
v_mfma_f32_16x16x32_bf16 v[144:147], v[112:115], v[104:107], v[144:147]
ds_read_b128 v[64:67], v7 offset:24576
v_mfma_f32_16x16x32_bf16 v[148:151], v[116:119], v[104:107], v[148:151]
ds_read_b64_tr_b16 v[80:81], v228 offset:20480
v_mfma_f32_16x16x32_bf16 v[156:159], v[116:119], v[108:111], v[156:159]
ds_read_b64_tr_b16 v[82:83], v228 offset:22528
v_mfma_f32_16x16x32_bf16 v[152:155], v[112:115], v[108:111], v[152:155]
ds_read_b64_tr_b16 v[84:85], v229 offset:20480
v_mfma_f32_16x16x32_bf16 v[128:131], v[208:211], v[192:195], v[128:131]
ds_read_b64_tr_b16 v[86:87], v229 offset:22528
buffer_store_dwordx4 v[164:167], v2, s[84:87], s45 offen offset:1024 sc1
v_mfma_f32_16x16x32_bf16 v[132:135], v[212:215], v[192:195], v[132:135]
ds_read_b128 v[68:71], v7 offset:25600
v_mfma_f32_16x16x32_bf16 v[140:143], v[212:215], v[196:199], v[140:143]
ds_read_b128 v[72:75], v7 offset:26624
v_mfma_f32_16x16x32_bf16 v[136:139], v[208:211], v[196:199], v[136:139]
ds_read_b128 v[76:79], v7 offset:27648
v_mfma_f32_16x16x32_bf16 v[144:147], v[208:211], v[200:203], v[144:147]
v_mfma_f32_16x16x32_bf16 v[148:151], v[212:215], v[200:203], v[148:151]
v_mfma_f32_16x16x32_bf16 v[156:159], v[212:215], v[204:207], v[156:159]
v_mfma_f32_16x16x32_bf16 v[152:155], v[208:211], v[204:207], v[152:155]
s_waitcnt lgkmcnt(0)
s_barrier
v_mfma_f32_16x16x32_bf16 v[128:131], v[48:51], v[32:35], v[128:131]
ds_read_b128 v[96:99], v7 offset:32768
ds_read_b64_tr_b16 v[112:113], v226 offset:49152
v_mfma_f32_16x16x32_bf16 v[132:135], v[52:55], v[32:35], v[132:135]
ds_read_b64_tr_b16 v[114:115], v226 offset:51200
ds_read_b64_tr_b16 v[116:117], v227 offset:49152
v_mfma_f32_16x16x32_bf16 v[140:143], v[52:55], v[36:39], v[140:143]
ds_read_b64_tr_b16 v[118:119], v227 offset:51200
ds_read_b128 v[100:103], v7 offset:33792
v_mfma_f32_16x16x32_bf16 v[136:139], v[48:51], v[36:39], v[136:139]
ds_read_b128 v[104:107], v7 offset:34816
ds_read_b128 v[108:111], v7 offset:35840
v_mfma_f32_16x16x32_bf16 v[144:147], v[48:51], v[40:43], v[144:147]
ds_read_b128 v[192:195], v7 offset:40960
v_mfma_f32_16x16x32_bf16 v[148:151], v[52:55], v[40:43], v[148:151]
ds_read_b64_tr_b16 v[208:209], v226 offset:53248
v_mfma_f32_16x16x32_bf16 v[156:159], v[52:55], v[44:47], v[156:159]
ds_read_b64_tr_b16 v[210:211], v226 offset:55296
v_mfma_f32_16x16x32_bf16 v[152:155], v[48:51], v[44:47], v[152:155]
ds_read_b64_tr_b16 v[212:213], v227 offset:53248
v_mfma_f32_16x16x32_bf16 v[128:131], v[80:83], v[64:67], v[128:131]
ds_read_b64_tr_b16 v[214:215], v227 offset:55296
buffer_store_dwordx4 v[168:171], v2, s[84:87], s45 offen offset:2048 sc1
v_mfma_f32_16x16x32_bf16 v[132:135], v[84:87], v[64:67], v[132:135]
ds_read_b128 v[196:199], v7 offset:41984
v_mfma_f32_16x16x32_bf16 v[140:143], v[84:87], v[68:71], v[140:143]
ds_read_b128 v[200:203], v7 offset:43008
v_mfma_f32_16x16x32_bf16 v[136:139], v[80:83], v[68:71], v[136:139]
ds_read_b128 v[204:207], v7 offset:44032
v_mfma_f32_16x16x32_bf16 v[144:147], v[80:83], v[72:75], v[144:147]
v_mfma_f32_16x16x32_bf16 v[148:151], v[84:87], v[72:75], v[148:151]
v_mfma_f32_16x16x32_bf16 v[156:159], v[84:87], v[76:79], v[156:159]
v_mfma_f32_16x16x32_bf16 v[152:155], v[80:83], v[76:79], v[152:155]
s_waitcnt lgkmcnt(0)
s_barrier
v_mfma_f32_16x16x32_bf16 v[128:131], v[112:115], v[96:99], v[128:131]
ds_read_b128 v[32:35], v8 offset:0
ds_read_b64_tr_b16 v[48:49], v224 offset:0
v_mfma_f32_16x16x32_bf16 v[132:135], v[116:119], v[96:99], v[132:135]
ds_read_b64_tr_b16 v[50:51], v224 offset:2048
ds_read_b64_tr_b16 v[52:53], v225 offset:0
v_mfma_f32_16x16x32_bf16 v[140:143], v[116:119], v[100:103], v[140:143]
ds_read_b64_tr_b16 v[54:55], v225 offset:2048
ds_read_b128 v[36:39], v8 offset:1024
v_mfma_f32_16x16x32_bf16 v[136:139], v[112:115], v[100:103], v[136:139]
ds_read_b128 v[40:43], v8 offset:2048
ds_read_b128 v[44:47], v8 offset:3072
v_mfma_f32_16x16x32_bf16 v[144:147], v[112:115], v[104:107], v[144:147]
ds_read_b128 v[64:67], v8 offset:8192
v_mfma_f32_16x16x32_bf16 v[148:151], v[116:119], v[104:107], v[148:151]
ds_read_b64_tr_b16 v[80:81], v224 offset:4096
v_mfma_f32_16x16x32_bf16 v[156:159], v[116:119], v[108:111], v[156:159]
ds_read_b64_tr_b16 v[82:83], v224 offset:6144
v_mfma_f32_16x16x32_bf16 v[152:155], v[112:115], v[108:111], v[152:155]
ds_read_b64_tr_b16 v[84:85], v225 offset:4096
v_mfma_f32_16x16x32_bf16 v[128:131], v[208:211], v[192:195], v[128:131]
ds_read_b64_tr_b16 v[86:87], v225 offset:6144
buffer_store_dwordx4 v[172:175], v2, s[84:87], s45 offen offset:3072 sc1
v_mfma_f32_16x16x32_bf16 v[132:135], v[212:215], v[192:195], v[132:135]
ds_read_b128 v[68:71], v8 offset:9216
v_mfma_f32_16x16x32_bf16 v[140:143], v[212:215], v[196:199], v[140:143]
ds_read_b128 v[72:75], v8 offset:10240
v_mfma_f32_16x16x32_bf16 v[136:139], v[208:211], v[196:199], v[136:139]
ds_read_b128 v[76:79], v8 offset:11264
v_mfma_f32_16x16x32_bf16 v[144:147], v[208:211], v[200:203], v[144:147]
v_mfma_f32_16x16x32_bf16 v[148:151], v[212:215], v[200:203], v[148:151]
v_mfma_f32_16x16x32_bf16 v[156:159], v[212:215], v[204:207], v[156:159]
s_branch Lov_12
.p2align 12
Lst_12_0:
s_branch Lwr_152
Lst_12_1:
s_branch Lst_16_0
s_nop 0
Lov_12:
v_mfma_f32_16x16x32_bf16 v[152:155], v[208:211], v[204:207], v[152:155]
s_waitcnt lgkmcnt(0)
s_barrier
v_mfma_f32_16x16x32_bf16 v[128:131], v[48:51], v[32:35], v[128:131]
ds_read_b128 v[96:99], v6 offset:16384
ds_read_b64_tr_b16 v[112:113], v224 offset:32768
v_mfma_f32_16x16x32_bf16 v[132:135], v[52:55], v[32:35], v[132:135]
ds_read_b64_tr_b16 v[114:115], v224 offset:34816
ds_read_b64_tr_b16 v[116:117], v225 offset:32768
v_mfma_f32_16x16x32_bf16 v[140:143], v[52:55], v[36:39], v[140:143]
ds_read_b64_tr_b16 v[118:119], v225 offset:34816
ds_read_b128 v[100:103], v6 offset:17408
v_mfma_f32_16x16x32_bf16 v[136:139], v[48:51], v[36:39], v[136:139]
ds_read_b128 v[104:107], v6 offset:18432
ds_read_b128 v[108:111], v6 offset:19456
v_mfma_f32_16x16x32_bf16 v[144:147], v[48:51], v[40:43], v[144:147]
ds_read_b128 v[192:195], v6 offset:24576
v_mfma_f32_16x16x32_bf16 v[148:151], v[52:55], v[40:43], v[148:151]
ds_read_b64_tr_b16 v[208:209], v224 offset:36864
v_mfma_f32_16x16x32_bf16 v[156:159], v[52:55], v[44:47], v[156:159]
ds_read_b64_tr_b16 v[210:211], v224 offset:38912
v_mfma_f32_16x16x32_bf16 v[152:155], v[48:51], v[44:47], v[152:155]
ds_read_b64_tr_b16 v[212:213], v225 offset:36864
v_mfma_f32_16x16x32_bf16 v[128:131], v[80:83], v[64:67], v[128:131]
ds_read_b64_tr_b16 v[214:215], v225 offset:38912
v_mfma_f32_16x16x32_bf16 v[132:135], v[84:87], v[64:67], v[132:135]
ds_read_b128 v[196:199], v6 offset:25600
v_mfma_f32_16x16x32_bf16 v[140:143], v[84:87], v[68:71], v[140:143]
ds_read_b128 v[200:203], v6 offset:26624
v_mfma_f32_16x16x32_bf16 v[136:139], v[80:83], v[68:71], v[136:139]
ds_read_b128 v[204:207], v6 offset:27648
v_mfma_f32_16x16x32_bf16 v[144:147], v[80:83], v[72:75], v[144:147]
v_mfma_f32_16x16x32_bf16 v[148:151], v[84:87], v[72:75], v[148:151]
v_mfma_f32_16x16x32_bf16 v[156:159], v[84:87], v[76:79], v[156:159]
v_mfma_f32_16x16x32_bf16 v[152:155], v[80:83], v[76:79], v[152:155]
s_waitcnt vmcnt(0)
s_waitcnt lgkmcnt(0)
s_barrier
v_mfma_f32_16x16x32_bf16 v[128:131], v[112:115], v[96:99], v[128:131]
ds_read_b128 v[32:35], v6 offset:49152
ds_read_b64_tr_b16 v[48:49], v226 offset:0
v_mfma_f32_16x16x32_bf16 v[132:135], v[116:119], v[96:99], v[132:135]
ds_read_b64_tr_b16 v[50:51], v226 offset:2048
ds_read_b64_tr_b16 v[52:53], v227 offset:0
v_mfma_f32_16x16x32_bf16 v[140:143], v[116:119], v[100:103], v[140:143]
ds_read_b64_tr_b16 v[54:55], v227 offset:2048
ds_read_b128 v[36:39], v6 offset:50176
v_mfma_f32_16x16x32_bf16 v[136:139], v[112:115], v[100:103], v[136:139]
ds_read_b128 v[40:43], v6 offset:51200
ds_read_b128 v[44:47], v6 offset:52224
v_mfma_f32_16x16x32_bf16 v[144:147], v[112:115], v[104:107], v[144:147]
ds_read_b128 v[64:67], v6 offset:57344
v_mfma_f32_16x16x32_bf16 v[148:151], v[116:119], v[104:107], v[148:151]
ds_read_b64_tr_b16 v[80:81], v226 offset:4096
v_mfma_f32_16x16x32_bf16 v[156:159], v[116:119], v[108:111], v[156:159]
ds_read_b64_tr_b16 v[82:83], v226 offset:6144
v_mfma_f32_16x16x32_bf16 v[152:155], v[112:115], v[108:111], v[152:155]
ds_read_b64_tr_b16 v[84:85], v227 offset:4096
v_mfma_f32_16x16x32_bf16 v[128:131], v[208:211], v[192:195], v[128:131]
ds_read_b64_tr_b16 v[86:87], v227 offset:6144
v_mfma_f32_16x16x32_bf16 v[132:135], v[212:215], v[192:195], v[132:135]
ds_read_b128 v[68:71], v6 offset:58368
v_mfma_f32_16x16x32_bf16 v[140:143], v[212:215], v[196:199], v[140:143]
ds_read_b128 v[72:75], v6 offset:59392
v_mfma_f32_16x16x32_bf16 v[136:139], v[208:211], v[196:199], v[136:139]
ds_read_b128 v[76:79], v6 offset:60416
v_mfma_f32_16x16x32_bf16 v[144:147], v[208:211], v[200:203], v[144:147]
v_mfma_f32_16x16x32_bf16 v[148:151], v[212:215], v[200:203], v[148:151]
v_mfma_f32_16x16x32_bf16 v[156:159], v[212:215], v[204:207], v[156:159]
v_mfma_f32_16x16x32_bf16 v[152:155], v[208:211], v[204:207], v[152:155]
s_waitcnt lgkmcnt(0)
s_barrier
v_mfma_f32_16x16x32_bf16 v[128:131], v[48:51], v[32:35], v[128:131]
ds_read_b128 v[96:99], v7 offset:16384
ds_read_b64_tr_b16 v[112:113], v228 offset:16384
v_mfma_f32_16x16x32_bf16 v[132:135], v[52:55], v[32:35], v[132:135]
ds_read_b64_tr_b16 v[114:115], v228 offset:18432
ds_read_b64_tr_b16 v[116:117], v229 offset:16384
v_mfma_f32_16x16x32_bf16 v[140:143], v[52:55], v[36:39], v[140:143]
ds_read_b64_tr_b16 v[118:119], v229 offset:18432
ds_read_b128 v[100:103], v7 offset:17408
v_mfma_f32_16x16x32_bf16 v[136:139], v[48:51], v[36:39], v[136:139]
ds_read_b128 v[104:107], v7 offset:18432
ds_read_b128 v[108:111], v7 offset:19456
v_mfma_f32_16x16x32_bf16 v[144:147], v[48:51], v[40:43], v[144:147]
ds_read_b128 v[192:195], v7 offset:24576
v_mfma_f32_16x16x32_bf16 v[148:151], v[52:55], v[40:43], v[148:151]
ds_read_b64_tr_b16 v[208:209], v228 offset:20480
v_mfma_f32_16x16x32_bf16 v[156:159], v[52:55], v[44:47], v[156:159]
ds_read_b64_tr_b16 v[210:211], v228 offset:22528
v_mfma_f32_16x16x32_bf16 v[152:155], v[48:51], v[44:47], v[152:155]
ds_read_b64_tr_b16 v[212:213], v229 offset:20480
v_mfma_f32_16x16x32_bf16 v[128:131], v[80:83], v[64:67], v[128:131]
ds_read_b64_tr_b16 v[214:215], v229 offset:22528
v_mfma_f32_16x16x32_bf16 v[132:135], v[84:87], v[64:67], v[132:135]
ds_read_b128 v[196:199], v7 offset:25600
v_mfma_f32_16x16x32_bf16 v[140:143], v[84:87], v[68:71], v[140:143]
ds_read_b128 v[200:203], v7 offset:26624
v_mfma_f32_16x16x32_bf16 v[136:139], v[80:83], v[68:71], v[136:139]
ds_read_b128 v[204:207], v7 offset:27648
v_mfma_f32_16x16x32_bf16 v[144:147], v[80:83], v[72:75], v[144:147]
v_mfma_f32_16x16x32_bf16 v[148:151], v[84:87], v[72:75], v[148:151]
v_mfma_f32_16x16x32_bf16 v[156:159], v[84:87], v[76:79], v[156:159]
v_mfma_f32_16x16x32_bf16 v[152:155], v[80:83], v[76:79], v[152:155]
s_waitcnt lgkmcnt(0)
s_barrier
v_mfma_f32_16x16x32_bf16 v[128:131], v[112:115], v[96:99], v[128:131]
ds_read_b128 v[32:35], v7 offset:32768
ds_read_b64_tr_b16 v[48:49], v226 offset:49152
v_mfma_f32_16x16x32_bf16 v[132:135], v[116:119], v[96:99], v[132:135]
ds_read_b64_tr_b16 v[50:51], v226 offset:51200
ds_read_b64_tr_b16 v[52:53], v227 offset:49152
v_mfma_f32_16x16x32_bf16 v[140:143], v[116:119], v[100:103], v[140:143]
ds_read_b64_tr_b16 v[54:55], v227 offset:51200
ds_read_b128 v[36:39], v7 offset:33792
v_mfma_f32_16x16x32_bf16 v[136:139], v[112:115], v[100:103], v[136:139]
ds_read_b128 v[40:43], v7 offset:34816
ds_read_b128 v[44:47], v7 offset:35840
v_mfma_f32_16x16x32_bf16 v[144:147], v[112:115], v[104:107], v[144:147]
ds_read_b128 v[64:67], v7 offset:40960
v_mfma_f32_16x16x32_bf16 v[148:151], v[116:119], v[104:107], v[148:151]
ds_read_b64_tr_b16 v[80:81], v226 offset:53248
v_mfma_f32_16x16x32_bf16 v[156:159], v[116:119], v[108:111], v[156:159]
ds_read_b64_tr_b16 v[82:83], v226 offset:55296
v_mfma_f32_16x16x32_bf16 v[152:155], v[112:115], v[108:111], v[152:155]
ds_read_b64_tr_b16 v[84:85], v227 offset:53248
v_mfma_f32_16x16x32_bf16 v[128:131], v[208:211], v[192:195], v[128:131]
ds_read_b64_tr_b16 v[86:87], v227 offset:55296
v_mfma_f32_16x16x32_bf16 v[132:135], v[212:215], v[192:195], v[132:135]
ds_read_b128 v[68:71], v7 offset:41984
v_mfma_f32_16x16x32_bf16 v[140:143], v[212:215], v[196:199], v[140:143]
ds_read_b128 v[72:75], v7 offset:43008
v_mfma_f32_16x16x32_bf16 v[136:139], v[208:211], v[196:199], v[136:139]
ds_read_b128 v[76:79], v7 offset:44032
v_mfma_f32_16x16x32_bf16 v[144:147], v[208:211], v[200:203], v[144:147]
v_mfma_f32_16x16x32_bf16 v[148:151], v[212:215], v[200:203], v[148:151]
v_mfma_f32_16x16x32_bf16 v[156:159], v[212:215], v[204:207], v[156:159]
v_mfma_f32_16x16x32_bf16 v[152:155], v[208:211], v[204:207], v[152:155]
s_waitcnt lgkmcnt(0)
s_barrier
buffer_load_dwordx4 v[232:235], v2, s[84:87], s46 offen offset:0 sc1
buffer_load_dwordx4 v[236:239], v2, s[84:87], s46 offen offset:1024 sc1
buffer_load_dwordx4 v[240:243], v2, s[84:87], s46 offen offset:2048 sc1
buffer_load_dwordx4 v[244:247], v2, s[84:87], s46 offen offset:3072 sc1
v_mfma_f32_16x16x32_bf16 v[128:131], v[48:51], v[32:35], v[128:131]
ds_read_b128 v[96:99], v8 offset:0
ds_read_b64_tr_b16 v[112:113], v224 offset:0
v_mfma_f32_16x16x32_bf16 v[132:135], v[52:55], v[32:35], v[132:135]
ds_read_b64_tr_b16 v[114:115], v224 offset:2048
ds_read_b64_tr_b16 v[116:117], v225 offset:0
v_mfma_f32_16x16x32_bf16 v[140:143], v[52:55], v[36:39], v[140:143]
ds_read_b64_tr_b16 v[118:119], v225 offset:2048
ds_read_b128 v[100:103], v8 offset:1024
v_mfma_f32_16x16x32_bf16 v[136:139], v[48:51], v[36:39], v[136:139]
ds_read_b128 v[104:107], v8 offset:2048
ds_read_b128 v[108:111], v8 offset:3072
v_mfma_f32_16x16x32_bf16 v[144:147], v[48:51], v[40:43], v[144:147]
ds_read_b128 v[192:195], v8 offset:8192
v_mfma_f32_16x16x32_bf16 v[148:151], v[52:55], v[40:43], v[148:151]
ds_read_b64_tr_b16 v[208:209], v224 offset:4096
v_mfma_f32_16x16x32_bf16 v[156:159], v[52:55], v[44:47], v[156:159]
ds_read_b64_tr_b16 v[210:211], v224 offset:6144
v_mfma_f32_16x16x32_bf16 v[152:155], v[48:51], v[44:47], v[152:155]
ds_read_b64_tr_b16 v[212:213], v225 offset:4096
v_mfma_f32_16x16x32_bf16 v[128:131], v[80:83], v[64:67], v[128:131]
ds_read_b64_tr_b16 v[214:215], v225 offset:6144
v_mfma_f32_16x16x32_bf16 v[132:135], v[84:87], v[64:67], v[132:135]
ds_read_b128 v[196:199], v8 offset:9216
v_mfma_f32_16x16x32_bf16 v[140:143], v[84:87], v[68:71], v[140:143]
ds_read_b128 v[200:203], v8 offset:10240
v_mfma_f32_16x16x32_bf16 v[136:139], v[80:83], v[68:71], v[136:139]
ds_read_b128 v[204:207], v8 offset:11264
v_mfma_f32_16x16x32_bf16 v[144:147], v[80:83], v[72:75], v[144:147]
v_mfma_f32_16x16x32_bf16 v[148:151], v[84:87], v[72:75], v[148:151]
v_mfma_f32_16x16x32_bf16 v[156:159], v[84:87], v[76:79], v[156:159]
v_mfma_f32_16x16x32_bf16 v[152:155], v[80:83], v[76:79], v[152:155]
s_waitcnt lgkmcnt(0)
s_barrier
v_mfma_f32_16x16x32_bf16 v[128:131], v[112:115], v[96:99], v[128:131]
ds_read_b128 v[32:35], v6 offset:16384
ds_read_b64_tr_b16 v[48:49], v224 offset:32768
v_mfma_f32_16x16x32_bf16 v[132:135], v[116:119], v[96:99], v[132:135]
ds_read_b64_tr_b16 v[50:51], v224 offset:34816
ds_read_b64_tr_b16 v[52:53], v225 offset:32768
v_mfma_f32_16x16x32_bf16 v[140:143], v[116:119], v[100:103], v[140:143]
ds_read_b64_tr_b16 v[54:55], v225 offset:34816
ds_read_b128 v[36:39], v6 offset:17408
v_mfma_f32_16x16x32_bf16 v[136:139], v[112:115], v[100:103], v[136:139]
ds_read_b128 v[40:43], v6 offset:18432
ds_read_b128 v[44:47], v6 offset:19456
v_mfma_f32_16x16x32_bf16 v[144:147], v[112:115], v[104:107], v[144:147]
ds_read_b128 v[64:67], v6 offset:24576
v_mfma_f32_16x16x32_bf16 v[148:151], v[116:119], v[104:107], v[148:151]
ds_read_b64_tr_b16 v[80:81], v224 offset:36864
v_mfma_f32_16x16x32_bf16 v[156:159], v[116:119], v[108:111], v[156:159]
ds_read_b64_tr_b16 v[82:83], v224 offset:38912
v_mfma_f32_16x16x32_bf16 v[152:155], v[112:115], v[108:111], v[152:155]
ds_read_b64_tr_b16 v[84:85], v225 offset:36864
v_mfma_f32_16x16x32_bf16 v[128:131], v[208:211], v[192:195], v[128:131]
ds_read_b64_tr_b16 v[86:87], v225 offset:38912
v_mfma_f32_16x16x32_bf16 v[132:135], v[212:215], v[192:195], v[132:135]
ds_read_b128 v[68:71], v6 offset:25600
v_mfma_f32_16x16x32_bf16 v[140:143], v[212:215], v[196:199], v[140:143]
ds_read_b128 v[72:75], v6 offset:26624
v_mfma_f32_16x16x32_bf16 v[136:139], v[208:211], v[196:199], v[136:139]
ds_read_b128 v[76:79], v6 offset:27648
v_mfma_f32_16x16x32_bf16 v[144:147], v[208:211], v[200:203], v[144:147]
v_mfma_f32_16x16x32_bf16 v[148:151], v[212:215], v[200:203], v[148:151]
v_mfma_f32_16x16x32_bf16 v[156:159], v[212:215], v[204:207], v[156:159]
v_mfma_f32_16x16x32_bf16 v[152:155], v[208:211], v[204:207], v[152:155]
s_waitcnt lgkmcnt(0)
s_barrier
v_mfma_f32_16x16x32_bf16 v[128:131], v[48:51], v[32:35], v[128:131]
ds_read_b128 v[96:99], v6 offset:49152
ds_read_b64_tr_b16 v[112:113], v226 offset:0
v_mfma_f32_16x16x32_bf16 v[132:135], v[52:55], v[32:35], v[132:135]
ds_read_b64_tr_b16 v[114:115], v226 offset:2048
ds_read_b64_tr_b16 v[116:117], v227 offset:0
v_mfma_f32_16x16x32_bf16 v[140:143], v[52:55], v[36:39], v[140:143]
ds_read_b64_tr_b16 v[118:119], v227 offset:2048
ds_read_b128 v[100:103], v6 offset:50176
v_mfma_f32_16x16x32_bf16 v[136:139], v[48:51], v[36:39], v[136:139]
ds_read_b128 v[104:107], v6 offset:51200
ds_read_b128 v[108:111], v6 offset:52224
v_mfma_f32_16x16x32_bf16 v[144:147], v[48:51], v[40:43], v[144:147]
ds_read_b128 v[192:195], v6 offset:57344
v_mfma_f32_16x16x32_bf16 v[148:151], v[52:55], v[40:43], v[148:151]
ds_read_b64_tr_b16 v[208:209], v226 offset:4096
v_mfma_f32_16x16x32_bf16 v[156:159], v[52:55], v[44:47], v[156:159]
ds_read_b64_tr_b16 v[210:211], v226 offset:6144
v_mfma_f32_16x16x32_bf16 v[152:155], v[48:51], v[44:47], v[152:155]
ds_read_b64_tr_b16 v[212:213], v227 offset:4096
v_mfma_f32_16x16x32_bf16 v[128:131], v[80:83], v[64:67], v[128:131]
ds_read_b64_tr_b16 v[214:215], v227 offset:6144
v_mfma_f32_16x16x32_bf16 v[132:135], v[84:87], v[64:67], v[132:135]
ds_read_b128 v[196:199], v6 offset:58368
v_mfma_f32_16x16x32_bf16 v[140:143], v[84:87], v[68:71], v[140:143]
ds_read_b128 v[200:203], v6 offset:59392
v_mfma_f32_16x16x32_bf16 v[136:139], v[80:83], v[68:71], v[136:139]
ds_read_b128 v[204:207], v6 offset:60416
v_mfma_f32_16x16x32_bf16 v[144:147], v[80:83], v[72:75], v[144:147]
v_mfma_f32_16x16x32_bf16 v[148:151], v[84:87], v[72:75], v[148:151]
v_mfma_f32_16x16x32_bf16 v[156:159], v[84:87], v[76:79], v[156:159]
v_mfma_f32_16x16x32_bf16 v[152:155], v[80:83], v[76:79], v[152:155]
s_waitcnt vmcnt(0)
s_waitcnt lgkmcnt(0)
s_barrier
v_mfma_f32_16x16x32_bf16 v[128:131], v[112:115], v[96:99], v[128:131]
v_lshlrev_b32 v160, 16, v232
v_and_b32 v161, 0xffff0000, v232
v_mfma_f32_16x16x32_bf16 v[132:135], v[116:119], v[96:99], v[132:135]
v_lshlrev_b32 v162, 16, v233
v_and_b32 v163, 0xffff0000, v233
v_mfma_f32_16x16x32_bf16 v[140:143], v[116:119], v[100:103], v[140:143]
v_lshlrev_b32 v164, 16, v234
v_and_b32 v165, 0xffff0000, v234
v_mfma_f32_16x16x32_bf16 v[136:139], v[112:115], v[100:103], v[136:139]
v_lshlrev_b32 v166, 16, v235
v_and_b32 v167, 0xffff0000, v235
v_mfma_f32_16x16x32_bf16 v[144:147], v[112:115], v[104:107], v[144:147]
v_lshlrev_b32 v168, 16, v236
v_and_b32 v169, 0xffff0000, v236
v_mfma_f32_16x16x32_bf16 v[148:151], v[116:119], v[104:107], v[148:151]
v_lshlrev_b32 v170, 16, v237
v_and_b32 v171, 0xffff0000, v237
v_mfma_f32_16x16x32_bf16 v[156:159], v[116:119], v[108:111], v[156:159]
v_lshlrev_b32 v172, 16, v238
v_and_b32 v173, 0xffff0000, v238
v_mfma_f32_16x16x32_bf16 v[152:155], v[112:115], v[108:111], v[152:155]
v_lshlrev_b32 v174, 16, v239
v_and_b32 v175, 0xffff0000, v239
v_mfma_f32_16x16x32_bf16 v[128:131], v[208:211], v[192:195], v[128:131]
v_lshlrev_b32 v176, 16, v240
v_and_b32 v177, 0xffff0000, v240
v_mfma_f32_16x16x32_bf16 v[132:135], v[212:215], v[192:195], v[132:135]
v_lshlrev_b32 v178, 16, v241
v_and_b32 v179, 0xffff0000, v241
v_mfma_f32_16x16x32_bf16 v[140:143], v[212:215], v[196:199], v[140:143]
v_lshlrev_b32 v180, 16, v242
v_and_b32 v181, 0xffff0000, v242
v_mfma_f32_16x16x32_bf16 v[136:139], v[208:211], v[196:199], v[136:139]
v_lshlrev_b32 v182, 16, v243
v_and_b32 v183, 0xffff0000, v243
v_mfma_f32_16x16x32_bf16 v[144:147], v[208:211], v[200:203], v[144:147]
v_lshlrev_b32 v184, 16, v244
v_and_b32 v185, 0xffff0000, v244
v_mfma_f32_16x16x32_bf16 v[148:151], v[212:215], v[200:203], v[148:151]
v_lshlrev_b32 v186, 16, v245
v_and_b32 v187, 0xffff0000, v245
v_mfma_f32_16x16x32_bf16 v[156:159], v[212:215], v[204:207], v[156:159]
v_lshlrev_b32 v188, 16, v246
v_and_b32 v189, 0xffff0000, v246
v_mfma_f32_16x16x32_bf16 v[152:155], v[208:211], v[204:207], v[152:155]
v_lshlrev_b32 v190, 16, v247
v_and_b32 v191, 0xffff0000, v247
s_nop 1
v_pk_add_f32 v[128:129], v[128:129], v[160:161]
v_pk_add_f32 v[130:131], v[130:131], v[162:163]
v_pk_add_f32 v[132:133], v[132:133], v[164:165]
v_pk_add_f32 v[134:135], v[134:135], v[166:167]
v_cvt_pk_bf16_f32 v32, v128, v129
v_cvt_pk_bf16_f32 v33, v130, v131
v_cvt_pk_bf16_f32 v34, v132, v133
v_cvt_pk_bf16_f32 v35, v134, v135
v_pk_add_f32 v[136:137], v[136:137], v[168:169]
v_pk_add_f32 v[138:139], v[138:139], v[170:171]
v_pk_add_f32 v[140:141], v[140:141], v[172:173]
v_pk_add_f32 v[142:143], v[142:143], v[174:175]
v_cvt_pk_bf16_f32 v36, v136, v137
v_cvt_pk_bf16_f32 v37, v138, v139
v_cvt_pk_bf16_f32 v38, v140, v141
v_cvt_pk_bf16_f32 v39, v142, v143
v_permlane16_swap_b32 v32, v34
v_permlane16_swap_b32 v33, v35
buffer_store_dwordx4 v[32:35], v230, s[20:23], s54 offen offset:0 nt
v_pk_add_f32 v[144:145], v[144:145], v[176:177]
v_pk_add_f32 v[146:147], v[146:147], v[178:179]
v_pk_add_f32 v[148:149], v[148:149], v[180:181]
v_pk_add_f32 v[150:151], v[150:151], v[182:183]
v_cvt_pk_bf16_f32 v40, v144, v145
v_cvt_pk_bf16_f32 v41, v146, v147
v_cvt_pk_bf16_f32 v42, v148, v149
v_cvt_pk_bf16_f32 v43, v150, v151
v_permlane16_swap_b32 v36, v38
v_permlane16_swap_b32 v37, v39
buffer_store_dwordx4 v[36:39], v230, s[20:23], s54 offen offset:2048 nt
v_pk_add_f32 v[152:153], v[152:153], v[184:185]
v_pk_add_f32 v[154:155], v[154:155], v[186:187]
v_pk_add_f32 v[156:157], v[156:157], v[188:189]
v_pk_add_f32 v[158:159], v[158:159], v[190:191]
v_cvt_pk_bf16_f32 v44, v152, v153
v_cvt_pk_bf16_f32 v45, v154, v155
v_cvt_pk_bf16_f32 v46, v156, v157
v_cvt_pk_bf16_f32 v47, v158, v159
v_permlane16_swap_b32 v40, v42
v_permlane16_swap_b32 v41, v43
buffer_store_dwordx4 v[40:43], v230, s[20:23], s55 offen offset:0 nt
s_nop 1
v_permlane16_swap_b32 v44, v46
v_permlane16_swap_b32 v45, v47
buffer_store_dwordx4 v[44:47], v230, s[20:23], s55 offen offset:2048 nt
s_branch Ldone_1
Lgb_91:
s_mul_i32 s43, s34, 262144
s_add_u32 s8, s82, s43
s_addc_u32 s9, s83, 0
s_add_u32 s8, s8, 4194304
s_addc_u32 s9, s9, 0
s_mov_b32 s10, 262144
s_mov_b32 s11, 0x20000
s_lshl_b32 s39, s36, 12
v_lshlrev_b32 v2, 4, v1
v_add_u32 v3, s39, v2
s_add_u32 s37, s35, 0
s_and_b32 s37, s37, 15
s_mul_i32 s37, s37, 16384
s_add_u32 m0, s39, 0
s_nop 0
buffer_load_dwordx4 v3, s[8:11], s37 offen sc1 lds
buffer_load_dwordx4 v3, s[8:11], s37 offen offset:1024 sc1 lds
buffer_load_dwordx4 v3, s[8:11], s37 offen offset:2048 sc1 lds
buffer_load_dwordx4 v3, s[8:11], s37 offen offset:3072 sc1 lds
s_mul_i32 s43, s34, 262144
s_add_u32 s8, s82, s43
s_addc_u32 s9, s83, 0
s_add_u32 s8, s8, 4194304
s_addc_u32 s9, s9, 0
s_mov_b32 s10, 262144
s_mov_b32 s11, 0x20000
s_mul_i32 s43, s34, 917504
s_add_u32 s24, s82, s43
s_addc_u32 s25, s83, 0
s_add_u32 s24, s24, 8388608
s_addc_u32 s25, s25, 0
s_mov_b32 s26, 917504
s_mov_b32 s27, 0x20000
s_add_u32 s84, s82, 27262976
s_addc_u32 s85, s83, 0
s_mov_b32 s86, 229376
s_mov_b32 s87, 0x20000
s_and_b32 s47, s36, 3
s_lshr_b32 s62, s47, 1
s_and_b32 s63, s47, 1
v_lshlrev_b32 v2, 4, v1
s_lshl_b32 s39, s47, 12
v_add_u32 v3, s39, v2
s_cmp_eq_u32 s62, 0
s_cselect_b32 s44, s72, s74
s_cselect_b32 s45, s73, s75
s_lshl_b32 s43, s35, 8
s_add_u32 s12, s44, s43
s_addc_u32 s13, s45, 0
s_mov_b32 s14, 7333120
s_mov_b32 s15, 0x20000
v_lshrrev_b32 v28, 4, v1
v_lshlrev_b32 v29, 1, v28
v_and_b32 v4, 15, v1
v_xor_b32 v4, v4, v29
v_lshlrev_b32 v4, 4, v4
v_mul_u32_u24 v28, 7168, v28
v_add_u32 v4, v4, v28
s_mul_i32 s43, s63, 229376
v_add_u32 v4, s43, v4
v_xor_b32 v5, 128, v4
v_add_u32 v5, 28672, v5
s_lshl_b32 s40, s47, 13
s_add_u32 s40, s40, 16384
s_lshl_b32 s43, s62, 12
v_add_u32 v9, s43, v2
v_add_u32 v10, 98304, v9
v_mov_b32 v6, v192
v_mov_b32 v7, v193
v_mov_b32 v8, v194
v_mov_b32 v24, v195
s_mul_i32 s43, s34, 16384
s_add_u32 s20, s82, s43
s_addc_u32 s21, s83, 0
s_add_u32 s20, s20, 25165824
s_addc_u32 s21, s21, 0
s_mov_b32 s22, 16384
s_mov_b32 s23, 0x20000
s_add_u32 s38, s35, 2
s_and_b32 s38, s38, 15
s_mul_i32 s38, s38, 458752
s_add_u32 m0, s50, 98304
s_nop 0
buffer_load_dwordx4 v6, s[16:19], s38 offen lds
s_add_u32 m0, s50, 99328
s_nop 0
buffer_load_dwordx4 v7, s[16:19], s38 offen lds
s_add_u32 m0, s50, 100352
s_nop 0
buffer_load_dwordx4 v8, s[16:19], s38 offen lds
s_add_u32 m0, s50, 101376
s_add_u32 s38, s38, 114688
buffer_load_dwordx4 v6, s[16:19], s38 offen lds
s_add_u32 m0, s50, 102400
s_nop 0
buffer_load_dwordx4 v7, s[16:19], s38 offen lds
s_add_u32 m0, s50, 103424
s_nop 0
buffer_load_dwordx4 v8, s[16:19], s38 offen lds
s_cmp_eq_u32 s47, 1
s_cbranch_scc0 Lw_117
s_lshl_b32 s92, s34, 7
s_add_u32 s92, s92, 28313600
s_mov_b32 s41, 0x40000
Lpoll_118:
s_load_dword s93, s[82:83], s92 glc
Lpchk_120:
s_waitcnt lgkmcnt(0)
s_cmp_eq_u32 s93, 16
s_cbranch_scc1 Lpok_119
s_sub_u32 s41, s41, 1
s_cmp_lg_u32 s41, 0
s_cbranch_scc1 Lpoll_118
Lpok_119:
Lw_117:
s_waitcnt vmcnt(0)
s_barrier
s_add_u32 s37, s35, 1
s_and_b32 s37, s37, 15
s_mul_i32 s37, s37, 16384
s_add_u32 m0, s39, 49152
s_nop 0
buffer_load_dwordx4 v3, s[8:11], s37 offen sc1 lds
buffer_load_dwordx4 v3, s[8:11], s37 offen offset:1024 sc1 lds
buffer_load_dwordx4 v3, s[8:11], s37 offen offset:2048 sc1 lds
buffer_load_dwordx4 v3, s[8:11], s37 offen offset:3072 sc1 lds
s_add_u32 s37, s35, 2
s_and_b32 s37, s37, 15
s_mul_i32 s37, s37, 16384
s_add_u32 m0, s39, 98304
s_nop 0
buffer_load_dwordx4 v3, s[8:11], s37 offen sc1 lds
buffer_load_dwordx4 v3, s[8:11], s37 offen offset:1024 sc1 lds
buffer_load_dwordx4 v3, s[8:11], s37 offen offset:2048 sc1 lds
buffer_load_dwordx4 v3, s[8:11], s37 offen offset:3072 sc1 lds
buffer_load_dwordx4 v[96:99], v3, s[20:23], 0 offen offset:0 sc1
buffer_load_dwordx4 v[100:103], v3, s[20:23], 0 offen offset:1024 sc1
buffer_load_dwordx4 v[104:107], v3, s[20:23], 0 offen offset:2048 sc1
buffer_load_dwordx4 v[108:111], v3, s[20:23], 0 offen offset:3072 sc1
s_and_b32 s44, s36, 3
s_mul_i32 s44, s44, 14
s_bfe_u32 s43, s2, 0x30001
s_lshl_b32 s43, s43, 7
s_add_u32 s44, s44, s43
s_add_u32 s44, s44, 72
s_mul_i32 s44, s44, 7168
s_lshr_b32 s43, s2, 4
s_lshl_b32 s43, s43, 8
s_add_u32 s43, s43, s44
s_bitcmp0_b32 s2, 0
s_cselect_b32 s4, s72, s74
s_cselect_b32 s5, s73, s75
s_add_u32 s4, s4, s43
s_addc_u32 s5, s5, 0
s_waitcnt vmcnt(8)
s_barrier
s_cmp_eq_u32 s47, 3
s_cbranch_scc0 Lw_121
v_and_b32 v30, 31, v1
v_lshlrev_b32 v30, 4, v30
v_add_u32 v31, 151552, v30
ds_read_b128 v[112:115], v31 offset:0
ds_read_b128 v[116:119], v31 offset:512
ds_read_b128 v[120:123], v31 offset:1024
ds_read_b128 v[124:127], v31 offset:1536
s_and_b32 s44, s2, 15
s_mul_i32 s44, s44, 14336
s_lshr_b32 s43, s2, 4
s_lshl_b32 s43, s43, 9
s_add_u32 s44, s44, s43
s_add_u32 s44, s44, 8192
s_cmp_lt_u32 s2, 192
s_cselect_b32 s44, s44, 0x7fffffff
s_waitcnt lgkmcnt(0)
v_add_f32 v112, v112, v116
v_add_f32 v120, v120, v124
v_add_f32 v113, v113, v117
v_add_f32 v121, v121, v125
v_add_f32 v114, v114, v118
v_add_f32 v122, v122, v126
v_add_f32 v115, v115, v119
v_add_f32 v123, v123, v127
v_add_f32 v112, v112, v120
v_add_f32 v113, v113, v121
v_add_f32 v114, v114, v122
v_add_f32 v115, v115, v123
s_mov_b64 exec, 0xffffffff
buffer_store_dwordx4 v[112:115], v30, s[84:87], s44 offen sc1
s_mov_b64 exec, -1
Lw_121:
s_waitcnt lgkmcnt(0)
s_add_u32 s37, s35, 3
s_and_b32 s37, s37, 15
s_mul_i32 s37, s37, 16384
s_add_u32 m0, s39, 0
s_nop 0
buffer_load_dwordx4 v3, s[8:11], s37 offen sc1 lds
buffer_load_dwordx4 v3, s[8:11], s37 offen offset:1024 sc1 lds
s_load_dword s3, s[4:5], 78848
buffer_load_dwordx4 v3, s[8:11], s37 offen offset:2048 sc1 lds
s_load_dword s3, s[4:5], 78912
buffer_load_dwordx4 v3, s[8:11], s37 offen offset:3072 sc1 lds
s_load_dword s3, s[4:5], 78976
s_add_u32 s38, s35, 3
s_and_b32 s38, s38, 15
s_mul_i32 s38, s38, 458752
s_add_u32 m0, s50, 0
s_nop 0
buffer_load_dwordx4 v6, s[16:19], s38 offen lds
s_load_dword s3, s[4:5], 79040
s_add_u32 m0, s50, 1024
s_nop 0
buffer_load_dwordx4 v7, s[16:19], s38 offen lds
s_load_dword s3, s[4:5], 86016
s_add_u32 m0, s50, 2048
s_nop 0
buffer_load_dwordx4 v8, s[16:19], s38 offen lds
s_load_dword s3, s[4:5], 86080
s_add_u32 m0, s50, 3072
s_add_u32 s38, s38, 114688
buffer_load_dwordx4 v6, s[16:19], s38 offen lds
s_load_dword s3, s[4:5], 86144
s_add_u32 m0, s50, 4096
s_nop 0
buffer_load_dwordx4 v7, s[16:19], s38 offen lds
s_add_u32 m0, s50, 5120
s_nop 0
buffer_load_dwordx4 v8, s[16:19], s38 offen lds
s_waitcnt vmcnt(14)
s_barrier
s_add_u32 s37, s35, 4
s_and_b32 s37, s37, 15
s_mul_i32 s37, s37, 16384
s_add_u32 m0, s39, 49152
s_nop 0
buffer_load_dwordx4 v3, s[8:11], s37 offen sc1 lds
buffer_load_dwordx4 v3, s[8:11], s37 offen offset:1024 sc1 lds
buffer_load_dwordx4 v3, s[8:11], s37 offen offset:2048 sc1 lds
buffer_load_dwordx4 v3, s[8:11], s37 offen offset:3072 sc1 lds
s_add_u32 s38, s35, 4
s_and_b32 s38, s38, 15
s_mul_i32 s38, s38, 458752
s_add_u32 m0, s50, 49152
s_nop 0
buffer_load_dwordx4 v6, s[16:19], s38 offen lds
s_add_u32 m0, s50, 50176
s_nop 0
buffer_load_dwordx4 v7, s[16:19], s38 offen lds
s_add_u32 m0, s50, 51200
s_nop 0
buffer_load_dwordx4 v8, s[16:19], s38 offen lds
s_add_u32 m0, s50, 52224
s_add_u32 s38, s38, 114688
buffer_load_dwordx4 v6, s[16:19], s38 offen lds
s_add_u32 m0, s50, 53248
s_nop 0
buffer_load_dwordx4 v7, s[16:19], s38 offen lds
s_add_u32 m0, s50, 54272
s_nop 0
buffer_load_dwordx4 v8, s[16:19], s38 offen lds
s_waitcnt vmcnt(10)
s_barrier
s_branch Lov_13
.p2align 12
Lst_13_0:
s_branch Lwr_153
Lst_13_1:
s_branch Lst_17_0
s_nop 0
Lov_13:
s_cmp_eq_u32 s47, 3
s_cbranch_scc0 Lw_122
s_cmp_lt_u32 s2, 192
s_cbranch_scc0 Lw_122
s_lshr_b32 s43, s2, 4
s_add_u32 s43, s43, 96
s_lshl_b32 s43, s43, 7
v_mov_b32 v30, s43
v_mov_b32 v31, 1
s_mov_b64 exec, 1
buffer_atomic_add v31, v30, s[56:59], 0 offen sc1
s_mov_b64 exec, -1
Lw_122:
s_waitcnt lgkmcnt(0)
s_add_u32 s37, s35, 5
s_and_b32 s37, s37, 15
s_mul_i32 s37, s37, 16384
s_add_u32 m0, s39, 98304
s_nop 0
buffer_load_dwordx4 v3, s[8:11], s37 offen sc1 lds
s_load_dword s3, s[4:5], 86208
s_load_dword s3, s[4:5], 93184
s_load_dword s3, s[4:5], 93248
s_load_dword s3, s[4:5], 93312
buffer_load_dwordx4 v3, s[8:11], s37 offen offset:1024 sc1 lds
s_load_dword s3, s[4:5], 93376
s_and_b32 s44, s36, 3
s_mul_i32 s43, s2, 28672
s_mul_i32 s44, s44, 7168
s_add_u32 s43, s43, s44
buffer_load_dwordx4 v3, s[8:11], s37 offen offset:2048 sc1 lds
s_add_u32 s4, s76, s43
s_addc_u32 s5, s77, 0
s_load_dword s3, s[4:5], 0
s_load_dword s3, s[4:5], 64
v_add_f32 v96, v96, v100
buffer_load_dwordx4 v3, s[8:11], s37 offen offset:3072 sc1 lds
v_add_f32 v97, v97, v101
v_add_f32 v98, v98, v102
v_add_f32 v99, v99, v103
v_add_f32 v104, v104, v108
v_add_f32 v105, v105, v109
s_add_u32 s38, s35, 5
s_and_b32 s38, s38, 15
s_mul_i32 s38, s38, 458752
s_add_u32 m0, s50, 98304
s_nop 0
buffer_load_dwordx4 v6, s[16:19], s38 offen lds
v_add_f32 v106, v106, v110
v_add_f32 v107, v107, v111
s_nop 0
v_permlane32_swap_b32 v96, v104
v_permlane32_swap_b32 v97, v105
s_add_u32 m0, s50, 99328
s_nop 0
buffer_load_dwordx4 v7, s[16:19], s38 offen lds
v_permlane32_swap_b32 v98, v106
v_permlane32_swap_b32 v99, v107
v_add_f32 v96, v96, v104
v_add_f32 v97, v97, v105
v_add_f32 v98, v98, v106
s_add_u32 m0, s50, 100352
s_nop 0
buffer_load_dwordx4 v8, s[16:19], s38 offen lds
v_add_f32 v99, v99, v107
v_mov_b32 v100, v96
v_mov_b32 v101, v97
v_mov_b32 v102, v98
v_mov_b32 v103, v99
s_add_u32 m0, s50, 101376
s_add_u32 s38, s38, 114688
buffer_load_dwordx4 v6, s[16:19], s38 offen lds
s_nop 0
v_permlane16_swap_b32 v96, v100
v_permlane16_swap_b32 v97, v101
v_permlane16_swap_b32 v98, v102
v_permlane16_swap_b32 v99, v103
s_add_u32 m0, s50, 102400
s_nop 0
buffer_load_dwordx4 v7, s[16:19], s38 offen lds
s_add_u32 m0, s50, 103424
s_nop 0
buffer_load_dwordx4 v8, s[16:19], s38 offen lds
s_waitcnt vmcnt(10)
s_barrier
s_add_u32 s37, s35, 6
s_and_b32 s37, s37, 15
s_mul_i32 s37, s37, 16384
s_add_u32 m0, s39, 0
s_nop 0
buffer_load_dwordx4 v3, s[8:11], s37 offen sc1 lds
v_add_f32 v96, v96, v100
v_add_f32 v97, v97, v101
v_add_f32 v98, v98, v102
buffer_load_dwordx4 v3, s[8:11], s37 offen offset:1024 sc1 lds
v_add_f32 v99, v99, v103
s_nop 0
v_add_f32_dpp v96, v96, v96 row_ror:8 row_mask:0xf bank_mask:0xf
buffer_load_dwordx4 v3, s[8:11], s37 offen offset:2048 sc1 lds
v_add_f32_dpp v97, v97, v97 row_ror:8 row_mask:0xf bank_mask:0xf
v_add_f32_dpp v98, v98, v98 row_ror:8 row_mask:0xf bank_mask:0xf
v_add_f32_dpp v99, v99, v99 row_ror:8 row_mask:0xf bank_mask:0xf
v_mul_f32 v96, 0x3a800000, v96
buffer_load_dwordx4 v3, s[8:11], s37 offen offset:3072 sc1 lds
v_mul_f32 v97, 0x3a800000, v97
v_mul_f32 v98, 0x3a800000, v98
v_mul_f32 v99, 0x3a800000, v99
s_add_u32 s38, s35, 6
s_and_b32 s38, s38, 15
s_mul_i32 s38, s38, 458752
s_add_u32 m0, s50, 0
s_nop 0
buffer_load_dwordx4 v6, s[16:19], s38 offen lds
v_fma_f32 v97, -v96, v96, v97
v_fma_f32 v99, -v98, v98, v99
v_max_f32 v97, 0, v97
s_add_u32 m0, s50, 1024
s_nop 0
buffer_load_dwordx4 v7, s[16:19], s38 offen lds
v_max_f32 v99, 0, v99
v_add_f32 v97, 0x3727c5ac, v97
v_add_f32 v99, 0x3727c5ac, v99
v_rsq_f32 v97, v97
s_add_u32 m0, s50, 2048
s_nop 0
buffer_load_dwordx4 v8, s[16:19], s38 offen lds
v_rsq_f32 v99, v99
v_and_b32 v100, 7, v1
s_lshl_b32 s43, s47, 8
s_add_u32 m0, s50, 3072
s_add_u32 s38, s38, 114688
buffer_load_dwordx4 v6, s[16:19], s38 offen lds
s_add_u32 s43, s43, 147456
v_lshl_add_u32 v100, v100, 4, s43
v_lshrrev_b32 v101, 5, v1
v_lshl_add_u32 v100, v101, 7, v100
s_add_u32 m0, s50, 4096
s_nop 0
buffer_load_dwordx4 v7, s[16:19], s38 offen lds
s_add_u32 m0, s50, 5120
s_nop 0
buffer_load_dwordx4 v8, s[16:19], s38 offen lds
s_waitcnt vmcnt(10)
s_barrier
ds_write_b128 v100, v[96:99]
s_waitcnt lgkmcnt(0)
s_add_u32 s37, s35, 7
s_and_b32 s37, s37, 15
s_mul_i32 s37, s37, 16384
s_add_u32 m0, s39, 49152
s_nop 0
buffer_load_dwordx4 v3, s[8:11], s37 offen sc1 lds
buffer_load_dwordx4 v3, s[8:11], s37 offen offset:1024 sc1 lds
s_load_dword s3, s[4:5], 128
buffer_load_dwordx4 v3, s[8:11], s37 offen offset:2048 sc1 lds
s_load_dword s3, s[4:5], 192
buffer_load_dwordx4 v3, s[8:11], s37 offen offset:3072 sc1 lds
s_load_dword s3, s[4:5], 256
s_add_u32 s38, s35, 7
s_and_b32 s38, s38, 15
s_mul_i32 s38, s38, 458752
s_add_u32 m0, s50, 49152
s_nop 0
buffer_load_dwordx4 v6, s[16:19], s38 offen lds
s_load_dword s3, s[4:5], 320
s_add_u32 m0, s50, 50176
s_nop 0
buffer_load_dwordx4 v7, s[16:19], s38 offen lds
s_load_dword s3, s[4:5], 384
s_add_u32 m0, s50, 51200
s_nop 0
buffer_load_dwordx4 v8, s[16:19], s38 offen lds
s_load_dword s3, s[4:5], 448
s_add_u32 m0, s50, 52224
s_add_u32 s38, s38, 114688
buffer_load_dwordx4 v6, s[16:19], s38 offen lds
s_load_dword s3, s[4:5], 512
s_add_u32 m0, s50, 53248
s_nop 0
buffer_load_dwordx4 v7, s[16:19], s38 offen lds
s_add_u32 m0, s50, 54272
s_nop 0
buffer_load_dwordx4 v8, s[16:19], s38 offen lds
s_waitcnt vmcnt(10)
s_barrier
s_add_u32 s37, s35, 8
s_and_b32 s37, s37, 15
s_mul_i32 s37, s37, 16384
s_add_u32 m0, s39, 98304
s_nop 0
buffer_load_dwordx4 v3, s[8:11], s37 offen sc1 lds
v_lshrrev_b32 v28, 2, v1
v_and_b32 v29, 7, v28
buffer_load_dwordx4 v3, s[8:11], s37 offen offset:1024 sc1 lds
v_mul_u32_u24 v28, 256, v28
v_lshl_add_u32 v28, v29, 5, v28
v_and_b32 v29, 3, v1
buffer_load_dwordx4 v3, s[8:11], s37 offen offset:2048 sc1 lds
v_lshl_add_u32 v11, v29, 3, v28
s_lshl_b32 s43, s63, 7
buffer_load_dwordx4 v3, s[8:11], s37 offen offset:3072 sc1 lds
v_xor_b32 v11, s43, v11
v_add_u32 v11, 16384, v11
v_xor_b32 v12, 32, v11
s_add_u32 s38, s35, 8
s_and_b32 s38, s38, 15
s_mul_i32 s38, s38, 458752
s_add_u32 m0, s50, 98304
s_nop 0
buffer_load_dwordx4 v6, s[16:19], s38 offen lds
v_xor_b32 v13, 64, v11
v_xor_b32 v14, 96, v11
s_add_u32 m0, s50, 99328
s_nop 0
buffer_load_dwordx4 v7, s[16:19], s38 offen lds
v_add_u32 v15, 49152, v11
v_add_u32 v16, 49152, v12
v_add_u32 v17, 49152, v13
s_add_u32 m0, s50, 100352
s_nop 0
buffer_load_dwordx4 v8, s[16:19], s38 offen lds
v_add_u32 v18, 49152, v14
v_add_u32 v19, 98304, v11
s_add_u32 m0, s50, 101376
s_add_u32 s38, s38, 114688
buffer_load_dwordx4 v6, s[16:19], s38 offen lds
v_add_u32 v20, 98304, v12
v_add_u32 v21, 98304, v13
v_add_u32 v22, 98304, v14
s_add_u32 m0, s50, 102400
s_nop 0
buffer_load_dwordx4 v7, s[16:19], s38 offen lds
s_add_u32 m0, s50, 103424
s_nop 0
buffer_load_dwordx4 v8, s[16:19], s38 offen lds
s_waitcnt vmcnt(10)
s_barrier
s_waitcnt lgkmcnt(0)
s_cmp_eq_u32 s47, 3
s_cbranch_scc0 Lw_123
s_mul_i32 s60, s35, 96
s_add_u32 s61, s60, 95
s_and_b32 s60, s60, 0xff80
s_and_b32 s61, s61, 0xff80
s_add_u32 s60, s60, 28323840
s_add_u32 s61, s61, 28323840
s_load_dword s92, s[82:83], s60 glc
s_load_dword s93, s[82:83], s61 glc
Lw_123:
s_add_u32 s37, s35, 9
s_and_b32 s37, s37, 15
s_mul_i32 s37, s37, 16384
s_add_u32 m0, s39, 0
s_nop 0
buffer_load_dwordx4 v3, s[8:11], s37 offen sc1 lds
buffer_load_dwordx4 v3, s[8:11], s37 offen offset:1024 sc1 lds
s_load_dword s3, s[4:5], 576
buffer_load_dwordx4 v3, s[8:11], s37 offen offset:2048 sc1 lds
s_load_dword s3, s[4:5], 640
buffer_load_dwordx4 v3, s[8:11], s37 offen offset:3072 sc1 lds
s_load_dword s3, s[4:5], 704
s_add_u32 s38, s35, 9
s_and_b32 s38, s38, 15
s_mul_i32 s38, s38, 458752
s_add_u32 m0, s50, 0
s_nop 0
buffer_load_dwordx4 v6, s[16:19], s38 offen lds
s_load_dword s3, s[4:5], 768
s_add_u32 m0, s50, 1024
s_nop 0
buffer_load_dwordx4 v7, s[16:19], s38 offen lds
s_load_dword s3, s[4:5], 832
s_add_u32 m0, s50, 2048
s_nop 0
buffer_load_dwordx4 v8, s[16:19], s38 offen lds
s_load_dword s3, s[4:5], 896
s_add_u32 m0, s50, 3072
s_add_u32 s38, s38, 114688
buffer_load_dwordx4 v6, s[16:19], s38 offen lds
s_load_dword s3, s[4:5], 960
s_add_u32 m0, s50, 4096
s_nop 0
buffer_load_dwordx4 v7, s[16:19], s38 offen lds
s_add_u32 m0, s50, 5120
s_nop 0
buffer_load_dwordx4 v8, s[16:19], s38 offen lds
s_waitcnt vmcnt(10)
s_barrier
s_add_u32 s37, s35, 10
s_and_b32 s37, s37, 15
s_mul_i32 s37, s37, 16384
s_add_u32 m0, s39, 49152
s_nop 0
buffer_load_dwordx4 v3, s[8:11], s37 offen sc1 lds
buffer_load_dwordx4 v3, s[8:11], s37 offen offset:1024 sc1 lds
buffer_load_dwordx4 v3, s[8:11], s37 offen offset:2048 sc1 lds
buffer_load_dwordx4 v3, s[8:11], s37 offen offset:3072 sc1 lds
s_add_u32 s38, s35, 10
s_and_b32 s38, s38, 15
s_mul_i32 s38, s38, 458752
s_add_u32 m0, s50, 49152
s_nop 0
buffer_load_dwordx4 v6, s[16:19], s38 offen lds
s_add_u32 m0, s50, 50176
s_nop 0
buffer_load_dwordx4 v7, s[16:19], s38 offen lds
s_add_u32 m0, s50, 51200
s_nop 0
buffer_load_dwordx4 v8, s[16:19], s38 offen lds
s_add_u32 m0, s50, 52224
s_add_u32 s38, s38, 114688
buffer_load_dwordx4 v6, s[16:19], s38 offen lds
s_add_u32 m0, s50, 53248
s_nop 0
buffer_load_dwordx4 v7, s[16:19], s38 offen lds
s_add_u32 m0, s50, 54272
s_nop 0
buffer_load_dwordx4 v8, s[16:19], s38 offen lds
s_mov_b32 s38, 0
buffer_load_dwordx4 v[40:43], v24, s[88:91], s38 offen
s_mov_b32 s38, 28672
buffer_load_dwordx4 v[44:47], v24, s[88:91], s38 offen
s_mov_b32 s38, 57344
buffer_load_dwordx4 v[48:51], v24, s[88:91], s38 offen
s_mov_b32 s38, 86016
buffer_load_dwordx4 v[52:55], v24, s[88:91], s38 offen
s_mov_b32 s38, 114688
buffer_load_dwordx4 v[56:59], v24, s[88:91], s38 offen
s_mov_b32 s38, 143360
buffer_load_dwordx4 v[60:63], v24, s[88:91], s38 offen
s_mov_b32 s38, 172032
buffer_load_dwordx4 v[64:67], v24, s[88:91], s38 offen
s_mov_b32 s38, 200704
buffer_load_dwordx4 v[68:71], v24, s[88:91], s38 offen
s_waitcnt vmcnt(18)
s_cmp_eq_u32 s47, 3
s_cbranch_scc0 Lw_124
s_mov_b32 s41, 0x40000
Lcp_125:
s_waitcnt lgkmcnt(0)
s_and_b32 s92, s92, s93
s_cmp_eq_u32 s92, 16
s_cbranch_scc1 Lco_126
s_load_dword s92, s[82:83], s60 glc
s_load_dword s93, s[82:83], s61 glc
s_sub_u32 s41, s41, 1
s_cmp_lg_u32 s41, 0
s_cbranch_scc1 Lcp_125
s_waitcnt lgkmcnt(0)
Lco_126:
Lw_124:
s_barrier
s_mov_b32 s45, s47
s_cmp_ge_u32 s45, 3
s_cselect_b32 s43, 1, 0
s_mul_i32 s44, s43, 3
s_sub_u32 s45, s45, s44
s_lshl_b32 s45, s45, 7
s_mul_i32 s52, s43, 896
s_add_u32 s52, s52, s45
s_add_u32 s52, s52, 148992
s_mul_i32 s43, s43, 14336
s_add_u32 s43, s43, s45
s_mul_i32 s44, s35, 384
s_add_u32 s43, s43, s44
s_add_u32 s60, s43, 8192
s_add_u32 s45, s47, 4
s_min_u32 s45, s45, 5
s_cmp_ge_u32 s45, 3
s_cselect_b32 s43, 1, 0
s_mul_i32 s44, s43, 3
s_sub_u32 s45, s45, s44
s_lshl_b32 s45, s45, 7
s_mul_i32 s53, s43, 896
s_add_u32 s53, s53, s45
s_add_u32 s53, s53, 148992
s_mul_i32 s43, s43, 14336
s_add_u32 s43, s43, s45
s_mul_i32 s44, s35, 384
s_add_u32 s43, s43, s44
s_add_u32 s61, s43, 8192
v_lshrrev_b32 v104, 3, v1
v_mul_u32_u24 v104, 28672, v104
v_and_b32 v105, 7, v1
v_lshl_add_u32 v104, v105, 4, v104
s_waitcnt lgkmcnt(0)
buffer_load_dwordx4 v[96:99], v104, s[84:87], s60 offen sc1
s_load_dword s3, s[4:5], 1024
buffer_load_dwordx4 v[100:103], v104, s[84:87], s61 offen sc1
s_load_dword s3, s[4:5], 1088
s_add_u32 s37, s35, 11
s_and_b32 s37, s37, 15
s_mul_i32 s37, s37, 16384
s_add_u32 m0, s39, 98304
s_nop 0
buffer_load_dwordx4 v3, s[8:11], s37 offen sc1 lds
s_load_dword s3, s[4:5], 1152
s_load_dword s3, s[4:5], 1216
buffer_load_dwordx4 v3, s[8:11], s37 offen offset:1024 sc1 lds
s_load_dword s3, s[4:5], 1280
buffer_load_dwordx4 v3, s[8:11], s37 offen offset:2048 sc1 lds
s_load_dword s3, s[4:5], 1344
s_load_dword s3, s[4:5], 1408
buffer_load_dwordx4 v3, s[8:11], s37 offen offset:3072 sc1 lds
v_cmp_gt_u32 vcc, 32, v1
s_add_u32 s38, s35, 11
s_and_b32 s38, s38, 15
s_mul_i32 s38, s38, 458752
s_add_u32 m0, s50, 98304
s_nop 0
buffer_load_dwordx4 v6, s[16:19], s38 offen lds
v_mov_b32 v104, s52
s_add_u32 m0, s50, 99328
s_nop 0
buffer_load_dwordx4 v7, s[16:19], s38 offen lds
v_mov_b32 v106, s53
v_cndmask_b32 v104, v106, v104, vcc
s_add_u32 m0, s50, 100352
s_nop 0
buffer_load_dwordx4 v8, s[16:19], s38 offen lds
v_lshl_add_u32 v104, v105, 4, v104
s_add_u32 m0, s50, 101376
s_add_u32 s38, s38, 114688
buffer_load_dwordx4 v6, s[16:19], s38 offen lds
v_bfe_u32 v105, v1, 4, 1
v_lshl_add_u32 v104, v105, 2, v104
s_add_u32 m0, s50, 102400
s_nop 0
buffer_load_dwordx4 v7, s[16:19], s38 offen lds
s_add_u32 m0, s50, 103424
s_nop 0
buffer_load_dwordx4 v8, s[16:19], s38 offen lds
s_waitcnt vmcnt(20)
s_barrier
s_add_u32 s37, s35, 12
s_and_b32 s37, s37, 15
s_mul_i32 s37, s37, 16384
s_add_u32 m0, s39, 0
s_nop 0
buffer_load_dwordx4 v3, s[8:11], s37 offen sc1 lds
buffer_load_dwordx4 v3, s[8:11], s37 offen offset:1024 sc1 lds
buffer_load_dwordx4 v3, s[8:11], s37 offen offset:2048 sc1 lds
buffer_load_dwordx4 v3, s[8:11], s37 offen offset:3072 sc1 lds
s_add_u32 s38, s35, 12
s_and_b32 s38, s38, 15
s_mul_i32 s38, s38, 458752
s_add_u32 m0, s50, 0
s_nop 0
buffer_load_dwordx4 v6, s[16:19], s38 offen lds
s_add_u32 m0, s50, 1024
s_nop 0
buffer_load_dwordx4 v7, s[16:19], s38 offen lds
s_add_u32 m0, s50, 2048
s_nop 0
buffer_load_dwordx4 v8, s[16:19], s38 offen lds
s_add_u32 m0, s50, 3072
s_add_u32 s38, s38, 114688
buffer_load_dwordx4 v6, s[16:19], s38 offen lds
s_add_u32 m0, s50, 4096
s_nop 0
buffer_load_dwordx4 v7, s[16:19], s38 offen lds
s_add_u32 m0, s50, 5120
s_nop 0
buffer_load_dwordx4 v8, s[16:19], s38 offen lds
s_waitcnt vmcnt(10)
s_barrier
v_permlane32_swap_b32 v96, v100
v_permlane32_swap_b32 v97, v101
v_permlane32_swap_b32 v98, v102
v_permlane32_swap_b32 v99, v103
v_add_f32 v96, v96, v100
v_add_f32 v97, v97, v101
v_add_f32 v98, v98, v102
v_add_f32 v99, v99, v103
s_nop 1
v_permlane16_swap_b32 v96, v97
v_permlane16_swap_b32 v98, v99
v_add_f32 v96, v96, v97
v_add_f32 v98, v98, v99
s_nop 1
v_add_f32_dpp v96, v96, v96 row_ror:8 row_mask:0xf bank_mask:0xf
v_add_f32_dpp v98, v98, v98 row_ror:8 row_mask:0xf bank_mask:0xf
ds_write_b32 v104, v96
ds_write_b32 v104, v98 offset:8
s_waitcnt lgkmcnt(0)
s_add_u32 s37, s35, 13
s_and_b32 s37, s37, 15
s_mul_i32 s37, s37, 16384
s_add_u32 m0, s39, 49152
s_nop 0
buffer_load_dwordx4 v3, s[8:11], s37 offen sc1 lds
s_load_dword s3, s[4:5], 1472
s_load_dword s3, s[4:5], 1536
s_load_dword s3, s[4:5], 1600
s_load_dword s3, s[4:5], 1664
buffer_load_dwordx4 v3, s[8:11], s37 offen offset:1024 sc1 lds
s_load_dword s3, s[4:5], 1728
v_lshlrev_b32 v72, 16, v40
v_and_b32 v73, 0xffff0000, v40
v_lshlrev_b32 v74, 16, v41
v_and_b32 v75, 0xffff0000, v41
buffer_load_dwordx4 v3, s[8:11], s37 offen offset:2048 sc1 lds
v_lshlrev_b32 v76, 16, v42
v_and_b32 v77, 0xffff0000, v42
v_lshlrev_b32 v78, 16, v43
v_and_b32 v79, 0xffff0000, v43
v_lshlrev_b32 v80, 16, v44
buffer_load_dwordx4 v3, s[8:11], s37 offen offset:3072 sc1 lds
v_and_b32 v81, 0xffff0000, v44
v_lshlrev_b32 v82, 16, v45
v_and_b32 v83, 0xffff0000, v45
v_lshlrev_b32 v84, 16, v46
v_and_b32 v85, 0xffff0000, v46
s_add_u32 s38, s35, 13
s_and_b32 s38, s38, 15
s_mul_i32 s38, s38, 458752
s_add_u32 m0, s50, 49152
s_nop 0
buffer_load_dwordx4 v6, s[16:19], s38 offen lds
v_lshlrev_b32 v86, 16, v47
v_and_b32 v87, 0xffff0000, v47
v_add_f32 v72, v72, v80
v_add_f32 v73, v73, v81
s_add_u32 m0, s50, 50176
s_nop 0
buffer_load_dwordx4 v7, s[16:19], s38 offen lds
v_add_f32 v74, v74, v82
v_add_f32 v75, v75, v83
v_add_f32 v76, v76, v84
v_add_f32 v77, v77, v85
v_add_f32 v78, v78, v86
s_add_u32 m0, s50, 51200
s_nop 0
buffer_load_dwordx4 v8, s[16:19], s38 offen lds
v_add_f32 v79, v79, v87
v_lshlrev_b32 v80, 16, v48
v_and_b32 v81, 0xffff0000, v48
v_lshlrev_b32 v82, 16, v49
v_and_b32 v83, 0xffff0000, v49
s_add_u32 m0, s50, 52224
s_add_u32 s38, s38, 114688
buffer_load_dwordx4 v6, s[16:19], s38 offen lds
v_lshlrev_b32 v84, 16, v50
v_and_b32 v85, 0xffff0000, v50
v_lshlrev_b32 v86, 16, v51
v_and_b32 v87, 0xffff0000, v51
v_add_f32 v72, v72, v80
s_add_u32 m0, s50, 53248
s_nop 0
buffer_load_dwordx4 v7, s[16:19], s38 offen lds
s_add_u32 m0, s50, 54272
s_nop 0
buffer_load_dwordx4 v8, s[16:19], s38 offen lds
s_waitcnt vmcnt(10)
s_barrier
s_add_u32 s37, s35, 14
s_and_b32 s37, s37, 15
s_mul_i32 s37, s37, 16384
s_add_u32 m0, s39, 98304
s_nop 0
buffer_load_dwordx4 v3, s[8:11], s37 offen sc1 lds
v_add_f32 v73, v73, v81
v_add_f32 v74, v74, v82
v_add_f32 v75, v75, v83
v_add_f32 v76, v76, v84
buffer_load_dwordx4 v3, s[8:11], s37 offen offset:1024 sc1 lds
v_add_f32 v77, v77, v85
v_add_f32 v78, v78, v86
v_add_f32 v79, v79, v87
v_lshlrev_b32 v80, 16, v52
buffer_load_dwordx4 v3, s[8:11], s37 offen offset:2048 sc1 lds
v_and_b32 v81, 0xffff0000, v52
v_lshlrev_b32 v82, 16, v53
v_and_b32 v83, 0xffff0000, v53
v_lshlrev_b32 v84, 16, v54
buffer_load_dwordx4 v3, s[8:11], s37 offen offset:3072 sc1 lds
v_and_b32 v85, 0xffff0000, v54
v_lshlrev_b32 v86, 16, v55
v_and_b32 v87, 0xffff0000, v55
v_add_f32 v72, v72, v80
v_add_f32 v73, v73, v81
s_add_u32 s38, s35, 14
s_and_b32 s38, s38, 15
s_mul_i32 s38, s38, 458752
s_add_u32 m0, s50, 98304
s_nop 0
buffer_load_dwordx4 v6, s[16:19], s38 offen lds
v_add_f32 v74, v74, v82
v_add_f32 v75, v75, v83
v_add_f32 v76, v76, v84
v_add_f32 v77, v77, v85
s_add_u32 m0, s50, 99328
s_nop 0
buffer_load_dwordx4 v7, s[16:19], s38 offen lds
v_add_f32 v78, v78, v86
v_add_f32 v79, v79, v87
v_lshlrev_b32 v80, 16, v56
v_and_b32 v81, 0xffff0000, v56
s_add_u32 m0, s50, 100352
s_nop 0
buffer_load_dwordx4 v8, s[16:19], s38 offen lds
v_lshlrev_b32 v82, 16, v57
v_and_b32 v83, 0xffff0000, v57
v_lshlrev_b32 v84, 16, v58
v_and_b32 v85, 0xffff0000, v58
s_add_u32 m0, s50, 101376
s_add_u32 s38, s38, 114688
buffer_load_dwordx4 v6, s[16:19], s38 offen lds
v_lshlrev_b32 v86, 16, v59
v_and_b32 v87, 0xffff0000, v59
v_add_f32 v72, v72, v80
v_add_f32 v73, v73, v81
v_add_f32 v74, v74, v82
s_add_u32 m0, s50, 102400
s_nop 0
buffer_load_dwordx4 v7, s[16:19], s38 offen lds
s_add_u32 m0, s50, 103424
s_nop 0
buffer_load_dwordx4 v8, s[16:19], s38 offen lds
s_waitcnt vmcnt(10)
s_barrier
s_add_u32 s37, s35, 15
s_and_b32 s37, s37, 15
s_mul_i32 s37, s37, 16384
s_add_u32 m0, s39, 0
s_nop 0
buffer_load_dwordx4 v3, s[8:11], s37 offen sc1 lds
v_add_f32 v75, v75, v83
v_add_f32 v76, v76, v84
v_add_f32 v77, v77, v85
v_add_f32 v78, v78, v86
buffer_load_dwordx4 v3, s[8:11], s37 offen offset:1024 sc1 lds
v_add_f32 v79, v79, v87
v_lshlrev_b32 v80, 16, v60
v_and_b32 v81, 0xffff0000, v60
v_lshlrev_b32 v82, 16, v61
buffer_load_dwordx4 v3, s[8:11], s37 offen offset:2048 sc1 lds
v_and_b32 v83, 0xffff0000, v61
v_lshlrev_b32 v84, 16, v62
v_and_b32 v85, 0xffff0000, v62
v_lshlrev_b32 v86, 16, v63
buffer_load_dwordx4 v3, s[8:11], s37 offen offset:3072 sc1 lds
v_and_b32 v87, 0xffff0000, v63
v_add_f32 v72, v72, v80
v_add_f32 v73, v73, v81
v_add_f32 v74, v74, v82
s_add_u32 s38, s35, 15
s_and_b32 s38, s38, 15
s_mul_i32 s38, s38, 458752
s_add_u32 m0, s50, 0
s_nop 0
buffer_load_dwordx4 v6, s[16:19], s38 offen lds
v_add_f32 v75, v75, v83
v_add_f32 v76, v76, v84
v_add_f32 v77, v77, v85
v_add_f32 v78, v78, v86
s_add_u32 m0, s50, 1024
s_nop 0
buffer_load_dwordx4 v7, s[16:19], s38 offen lds
v_add_f32 v79, v79, v87
v_lshlrev_b32 v80, 16, v64
v_and_b32 v81, 0xffff0000, v64
v_lshlrev_b32 v82, 16, v65
s_add_u32 m0, s50, 2048
s_nop 0
buffer_load_dwordx4 v8, s[16:19], s38 offen lds
v_and_b32 v83, 0xffff0000, v65
v_lshlrev_b32 v84, 16, v66
v_and_b32 v85, 0xffff0000, v66
v_lshlrev_b32 v86, 16, v67
s_add_u32 m0, s50, 3072
s_add_u32 s38, s38, 114688
buffer_load_dwordx4 v6, s[16:19], s38 offen lds
v_and_b32 v87, 0xffff0000, v67
v_add_f32 v72, v72, v80
s_branch Lov_14
.p2align 12
Lst_14_0:
s_branch Lwr_154
Lst_14_1:
s_branch Lwr_166
s_nop 0
Lov_14:
v_add_f32 v73, v73, v81
v_add_f32 v74, v74, v82
v_add_f32 v75, v75, v83
s_add_u32 m0, s50, 4096
s_nop 0
buffer_load_dwordx4 v7, s[16:19], s38 offen lds
s_add_u32 m0, s50, 5120
s_nop 0
buffer_load_dwordx4 v8, s[16:19], s38 offen lds
s_waitcnt vmcnt(10)
s_barrier
s_add_u32 s37, s35, 0
s_and_b32 s37, s37, 15
s_mul_i32 s37, s37, 16384
s_add_u32 m0, s39, 49152
s_nop 0
buffer_load_dwordx4 v3, s[8:11], s37 offen sc1 lds
v_add_f32 v76, v76, v84
v_add_f32 v77, v77, v85
v_add_f32 v78, v78, v86
buffer_load_dwordx4 v3, s[8:11], s37 offen offset:1024 sc1 lds
v_add_f32 v79, v79, v87
v_lshlrev_b32 v80, 16, v68
v_and_b32 v81, 0xffff0000, v68
buffer_load_dwordx4 v3, s[8:11], s37 offen offset:2048 sc1 lds
v_lshlrev_b32 v82, 16, v69
v_and_b32 v83, 0xffff0000, v69
v_lshlrev_b32 v84, 16, v70
v_and_b32 v85, 0xffff0000, v70
buffer_load_dwordx4 v3, s[8:11], s37 offen offset:3072 sc1 lds
v_lshlrev_b32 v86, 16, v71
v_and_b32 v87, 0xffff0000, v71
v_add_f32 v72, v72, v80
s_add_u32 s38, s35, 0
s_and_b32 s38, s38, 15
s_mul_i32 s38, s38, 458752
s_add_u32 m0, s40, 49152
s_nop 0
buffer_load_dwordx4 v4, s[12:15], s38 offen lds
v_add_f32 v73, v73, v81
v_add_f32 v74, v74, v82
v_add_f32 v75, v75, v83
v_add_f32 v76, v76, v84
s_add_u32 m0, s40, 50176
s_nop 0
buffer_load_dwordx4 v5, s[12:15], s38 offen lds
v_add_f32 v77, v77, v85
v_add_f32 v78, v78, v86
v_add_f32 v79, v79, v87
s_add_u32 m0, s40, 51200
s_add_u32 s38, s38, 57344
buffer_load_dwordx4 v4, s[12:15], s38 offen lds
s_nop 0
v_permlane32_swap_b32 v72, v76
v_permlane32_swap_b32 v73, v77
s_add_u32 m0, s40, 52224
s_nop 0
buffer_load_dwordx4 v5, s[12:15], s38 offen lds
v_permlane32_swap_b32 v74, v78
v_permlane32_swap_b32 v75, v79
v_add_f32 v72, v72, v76
v_add_f32 v73, v73, v77
s_add_u32 m0, s40, 53248
s_add_u32 s38, s38, 57344
buffer_load_dwordx4 v4, s[12:15], s38 offen lds
v_add_f32 v74, v74, v78
v_add_f32 v75, v75, v79
s_nop 0
s_add_u32 m0, s40, 54272
s_nop 0
buffer_load_dwordx4 v5, s[12:15], s38 offen lds
v_permlane16_swap_b32 v72, v74
v_permlane16_swap_b32 v73, v75
v_add_f32 v72, v72, v74
v_add_f32 v73, v73, v75
s_add_u32 m0, s40, 55296
s_add_u32 s38, s38, 57344
buffer_load_dwordx4 v4, s[12:15], s38 offen lds
s_add_u32 m0, s40, 56320
s_nop 0
buffer_load_dwordx4 v5, s[12:15], s38 offen lds
s_waitcnt vmcnt(12)
s_barrier
s_lshl_b32 s43, s47, 9
s_add_u32 s43, s43, 153600
v_and_b32 v80, 15, v1
v_lshl_add_u32 v80, v80, 5, s43
v_lshrrev_b32 v81, 4, v1
v_lshl_add_u32 v80, v81, 3, v80
ds_write_b64 v80, v[72:73]
s_waitcnt lgkmcnt(0)
s_add_u32 s37, s35, 1
s_and_b32 s37, s37, 15
s_mul_i32 s37, s37, 16384
s_add_u32 m0, s39, 98304
s_nop 0
buffer_load_dwordx4 v3, s[8:11], s37 offen sc1 lds
s_bfe_u32 s61, s35, 0x10002
s_lshr_b32 s60, s35, 3
buffer_load_dwordx4 v3, s[8:11], s37 offen offset:1024 sc1 lds
s_lshl_b32 s60, s60, 2
s_and_b32 s43, s35, 3
s_add_u32 s60, s60, s43
buffer_load_dwordx4 v3, s[8:11], s37 offen offset:2048 sc1 lds
s_lshl_b32 s43, s60, 8
s_add_u32 s28, s76, s43
buffer_load_dwordx4 v3, s[8:11], s37 offen offset:3072 sc1 lds
s_addc_u32 s29, s77, 0
s_mov_b32 s30, 7338240
s_mov_b32 s31, 0x20000
s_add_u32 s38, s35, 1
s_and_b32 s38, s38, 15
s_mul_i32 s38, s38, 458752
s_add_u32 m0, s40, 98304
s_nop 0
buffer_load_dwordx4 v4, s[12:15], s38 offen lds
s_mul_i32 s52, s61, 196608
s_mul_i32 s53, s61, 1572864
s_mul_i32 s90, s61, 163840
s_add_u32 m0, s40, 99328
s_nop 0
buffer_load_dwordx4 v5, s[12:15], s38 offen lds
s_mul_i32 s91, s61, 1310720
s_lshl_b32 s51, s47, 11
s_add_u32 m0, s40, 100352
s_add_u32 s38, s38, 57344
buffer_load_dwordx4 v4, s[12:15], s38 offen lds
s_lshl_b32 s44, s47, 15
v_lshrrev_b32 v122, 4, v1
v_lshlrev_b32 v123, 1, v122
s_add_u32 m0, s40, 101376
s_nop 0
buffer_load_dwordx4 v5, s[12:15], s38 offen lds
v_and_b32 v23, 15, v1
v_xor_b32 v23, v23, v123
s_add_u32 m0, s40, 102400
s_add_u32 s38, s38, 57344
buffer_load_dwordx4 v4, s[12:15], s38 offen lds
v_lshlrev_b32 v23, 4, v23
v_mul_u32_u24 v122, 2048, v122
v_add_u32 v23, v23, v122
s_add_u32 m0, s40, 103424
s_nop 0
buffer_load_dwordx4 v5, s[12:15], s38 offen lds
v_add_u32 v23, s44, v23
v_xor_b32 v24, 128, v23
v_add_u32 v24, 8192, v24
s_add_u32 m0, s40, 104448
s_add_u32 s38, s38, 57344
buffer_load_dwordx4 v4, s[12:15], s38 offen lds
s_add_u32 m0, s40, 105472
s_nop 0
buffer_load_dwordx4 v5, s[12:15], s38 offen lds
s_waitcnt vmcnt(12)
s_barrier
ds_read_b128 v[28:31], v9 offset:49152
ds_read_b64_tr_b16 v[44:45], v15 offset:0
ds_read_b64_tr_b16 v[46:47], v15 offset:4096
ds_read_b64_tr_b16 v[48:49], v16 offset:0
ds_read_b64_tr_b16 v[50:51], v16 offset:4096
ds_read_b64_tr_b16 v[52:53], v17 offset:0
ds_read_b64_tr_b16 v[54:55], v17 offset:4096
ds_read_b64_tr_b16 v[56:57], v18 offset:0
ds_read_b64_tr_b16 v[58:59], v18 offset:4096
ds_read_b64_tr_b16 v[60:61], v15 offset:16384
ds_read_b64_tr_b16 v[62:63], v15 offset:20480
ds_read_b64_tr_b16 v[64:65], v16 offset:16384
ds_read_b64_tr_b16 v[66:67], v16 offset:20480
ds_read_b64_tr_b16 v[68:69], v17 offset:16384
ds_read_b64_tr_b16 v[70:71], v17 offset:20480
ds_read_b64_tr_b16 v[72:73], v18 offset:16384
ds_read_b64_tr_b16 v[74:75], v18 offset:20480
ds_read_b128 v[32:35], v9 offset:50176
ds_read_b128 v[36:39], v9 offset:51200
ds_read_b128 v[40:43], v9 offset:52224
s_waitcnt lgkmcnt(0)
v_mfma_f32_16x16x32_bf16 v[124:127], v[44:47], v[28:31], 0
ds_read_b128 v[76:79], v9 offset:57344
v_mfma_f32_16x16x32_bf16 v[128:131], v[48:51], v[28:31], 0
ds_read_b64_tr_b16 v[92:93], v15 offset:8192
v_mfma_f32_16x16x32_bf16 v[132:135], v[52:55], v[28:31], 0
ds_read_b64_tr_b16 v[94:95], v15 offset:12288
v_mfma_f32_16x16x32_bf16 v[136:139], v[56:59], v[28:31], 0
ds_read_b64_tr_b16 v[96:97], v16 offset:8192
v_mfma_f32_16x16x32_bf16 v[140:143], v[60:63], v[28:31], 0
ds_read_b64_tr_b16 v[98:99], v16 offset:12288
v_mfma_f32_16x16x32_bf16 v[144:147], v[64:67], v[28:31], 0
ds_read_b64_tr_b16 v[100:101], v17 offset:8192
v_mfma_f32_16x16x32_bf16 v[148:151], v[68:71], v[28:31], 0
ds_read_b64_tr_b16 v[102:103], v17 offset:12288
v_mfma_f32_16x16x32_bf16 v[152:155], v[72:75], v[28:31], 0
ds_read_b64_tr_b16 v[104:105], v18 offset:8192
v_mfma_f32_16x16x32_bf16 v[184:187], v[72:75], v[32:35], 0
ds_read_b64_tr_b16 v[106:107], v18 offset:12288
v_mfma_f32_16x16x32_bf16 v[180:183], v[68:71], v[32:35], 0
ds_read_b64_tr_b16 v[108:109], v15 offset:24576
v_mfma_f32_16x16x32_bf16 v[176:179], v[64:67], v[32:35], 0
ds_read_b64_tr_b16 v[110:111], v15 offset:28672
v_mfma_f32_16x16x32_bf16 v[172:175], v[60:63], v[32:35], 0
ds_read_b64_tr_b16 v[112:113], v16 offset:24576
v_mfma_f32_16x16x32_bf16 v[168:171], v[56:59], v[32:35], 0
ds_read_b64_tr_b16 v[114:115], v16 offset:28672
v_mfma_f32_16x16x32_bf16 v[164:167], v[52:55], v[32:35], 0
ds_read_b64_tr_b16 v[116:117], v17 offset:24576
v_mfma_f32_16x16x32_bf16 v[160:163], v[48:51], v[32:35], 0
ds_read_b64_tr_b16 v[118:119], v17 offset:28672
v_mfma_f32_16x16x32_bf16 v[156:159], v[44:47], v[32:35], 0
ds_read_b64_tr_b16 v[120:121], v18 offset:24576
v_mfma_f32_16x16x32_bf16 v[188:191], v[44:47], v[36:39], 0
ds_read_b64_tr_b16 v[122:123], v18 offset:28672
v_mfma_f32_16x16x32_bf16 v[192:195], v[48:51], v[36:39], 0
ds_read_b128 v[80:83], v9 offset:58368
v_mfma_f32_16x16x32_bf16 v[196:199], v[52:55], v[36:39], 0
ds_read_b128 v[84:87], v9 offset:59392
v_mfma_f32_16x16x32_bf16 v[200:203], v[56:59], v[36:39], 0
ds_read_b128 v[88:91], v9 offset:60416
v_mfma_f32_16x16x32_bf16 v[204:207], v[60:63], v[36:39], 0
v_mfma_f32_16x16x32_bf16 v[208:211], v[64:67], v[36:39], 0
v_mfma_f32_16x16x32_bf16 v[212:215], v[68:71], v[36:39], 0
v_mfma_f32_16x16x32_bf16 v[216:219], v[72:75], v[36:39], 0
v_mfma_f32_16x16x32_bf16 v[248:251], v[72:75], v[40:43], 0
v_mfma_f32_16x16x32_bf16 v[244:247], v[68:71], v[40:43], 0
v_mfma_f32_16x16x32_bf16 v[240:243], v[64:67], v[40:43], 0
v_mfma_f32_16x16x32_bf16 v[236:239], v[60:63], v[40:43], 0
v_mfma_f32_16x16x32_bf16 v[232:235], v[56:59], v[40:43], 0
v_mfma_f32_16x16x32_bf16 v[228:231], v[52:55], v[40:43], 0
v_mfma_f32_16x16x32_bf16 v[224:227], v[48:51], v[40:43], 0
v_mfma_f32_16x16x32_bf16 v[220:223], v[44:47], v[40:43], 0
s_waitcnt vmcnt(0)
s_waitcnt lgkmcnt(0)
s_barrier
v_mfma_f32_16x16x32_bf16 v[124:127], v[92:95], v[76:79], v[124:127]
ds_read_b128 v[28:31], v10 offset:0
v_mfma_f32_16x16x32_bf16 v[128:131], v[96:99], v[76:79], v[128:131]
ds_read_b64_tr_b16 v[44:45], v19 offset:0
v_mfma_f32_16x16x32_bf16 v[132:135], v[100:103], v[76:79], v[132:135]
ds_read_b64_tr_b16 v[46:47], v19 offset:4096
v_mfma_f32_16x16x32_bf16 v[136:139], v[104:107], v[76:79], v[136:139]
ds_read_b64_tr_b16 v[48:49], v20 offset:0
v_mfma_f32_16x16x32_bf16 v[140:143], v[108:111], v[76:79], v[140:143]
ds_read_b64_tr_b16 v[50:51], v20 offset:4096
v_mfma_f32_16x16x32_bf16 v[144:147], v[112:115], v[76:79], v[144:147]
ds_read_b64_tr_b16 v[52:53], v21 offset:0
v_mfma_f32_16x16x32_bf16 v[148:151], v[116:119], v[76:79], v[148:151]
ds_read_b64_tr_b16 v[54:55], v21 offset:4096
v_mfma_f32_16x16x32_bf16 v[152:155], v[120:123], v[76:79], v[152:155]
ds_read_b64_tr_b16 v[56:57], v22 offset:0
v_mfma_f32_16x16x32_bf16 v[184:187], v[120:123], v[80:83], v[184:187]
ds_read_b64_tr_b16 v[58:59], v22 offset:4096
v_mfma_f32_16x16x32_bf16 v[180:183], v[116:119], v[80:83], v[180:183]
ds_read_b64_tr_b16 v[60:61], v19 offset:16384
v_mfma_f32_16x16x32_bf16 v[176:179], v[112:115], v[80:83], v[176:179]
ds_read_b64_tr_b16 v[62:63], v19 offset:20480
v_mfma_f32_16x16x32_bf16 v[172:175], v[108:111], v[80:83], v[172:175]
ds_read_b64_tr_b16 v[64:65], v20 offset:16384
v_mfma_f32_16x16x32_bf16 v[168:171], v[104:107], v[80:83], v[168:171]
ds_read_b64_tr_b16 v[66:67], v20 offset:20480
v_mfma_f32_16x16x32_bf16 v[164:167], v[100:103], v[80:83], v[164:167]
ds_read_b64_tr_b16 v[68:69], v21 offset:16384
v_mfma_f32_16x16x32_bf16 v[160:163], v[96:99], v[80:83], v[160:163]
ds_read_b64_tr_b16 v[70:71], v21 offset:20480
v_mfma_f32_16x16x32_bf16 v[156:159], v[92:95], v[80:83], v[156:159]
ds_read_b64_tr_b16 v[72:73], v22 offset:16384
v_mfma_f32_16x16x32_bf16 v[188:191], v[92:95], v[84:87], v[188:191]
ds_read_b64_tr_b16 v[74:75], v22 offset:20480
v_mfma_f32_16x16x32_bf16 v[192:195], v[96:99], v[84:87], v[192:195]
ds_read_b128 v[32:35], v10 offset:1024
v_mfma_f32_16x16x32_bf16 v[196:199], v[100:103], v[84:87], v[196:199]
ds_read_b128 v[36:39], v10 offset:2048
v_mfma_f32_16x16x32_bf16 v[200:203], v[104:107], v[84:87], v[200:203]
ds_read_b128 v[40:43], v10 offset:3072
v_mfma_f32_16x16x32_bf16 v[204:207], v[108:111], v[84:87], v[204:207]
v_mfma_f32_16x16x32_bf16 v[208:211], v[112:115], v[84:87], v[208:211]
v_mfma_f32_16x16x32_bf16 v[212:215], v[116:119], v[84:87], v[212:215]
v_mfma_f32_16x16x32_bf16 v[216:219], v[120:123], v[84:87], v[216:219]
v_mfma_f32_16x16x32_bf16 v[248:251], v[120:123], v[88:91], v[248:251]
v_mfma_f32_16x16x32_bf16 v[244:247], v[116:119], v[88:91], v[244:247]
v_mfma_f32_16x16x32_bf16 v[240:243], v[112:115], v[88:91], v[240:243]
v_mfma_f32_16x16x32_bf16 v[236:239], v[108:111], v[88:91], v[236:239]
v_mfma_f32_16x16x32_bf16 v[232:235], v[104:107], v[88:91], v[232:235]
v_mfma_f32_16x16x32_bf16 v[228:231], v[100:103], v[88:91], v[228:231]
v_mfma_f32_16x16x32_bf16 v[224:227], v[96:99], v[88:91], v[224:227]
v_mfma_f32_16x16x32_bf16 v[220:223], v[92:95], v[88:91], v[220:223]
s_mov_b32 s41, 5
Lk3l_127:
s_waitcnt lgkmcnt(0)
v_mfma_f32_16x16x32_bf16 v[124:127], v[44:47], v[28:31], v[124:127]
ds_read_b128 v[76:79], v10 offset:8192
v_mfma_f32_16x16x32_bf16 v[128:131], v[48:51], v[28:31], v[128:131]
ds_read_b64_tr_b16 v[92:93], v19 offset:8192
v_mfma_f32_16x16x32_bf16 v[132:135], v[52:55], v[28:31], v[132:135]
ds_read_b64_tr_b16 v[94:95], v19 offset:12288
v_mfma_f32_16x16x32_bf16 v[136:139], v[56:59], v[28:31], v[136:139]
ds_read_b64_tr_b16 v[96:97], v20 offset:8192
v_mfma_f32_16x16x32_bf16 v[140:143], v[60:63], v[28:31], v[140:143]
ds_read_b64_tr_b16 v[98:99], v20 offset:12288
v_mfma_f32_16x16x32_bf16 v[144:147], v[64:67], v[28:31], v[144:147]
ds_read_b64_tr_b16 v[100:101], v21 offset:8192
v_mfma_f32_16x16x32_bf16 v[148:151], v[68:71], v[28:31], v[148:151]
ds_read_b64_tr_b16 v[102:103], v21 offset:12288
v_mfma_f32_16x16x32_bf16 v[152:155], v[72:75], v[28:31], v[152:155]
ds_read_b64_tr_b16 v[104:105], v22 offset:8192
v_mfma_f32_16x16x32_bf16 v[184:187], v[72:75], v[32:35], v[184:187]
ds_read_b64_tr_b16 v[106:107], v22 offset:12288
v_mfma_f32_16x16x32_bf16 v[180:183], v[68:71], v[32:35], v[180:183]
ds_read_b64_tr_b16 v[108:109], v19 offset:24576
v_mfma_f32_16x16x32_bf16 v[176:179], v[64:67], v[32:35], v[176:179]
ds_read_b64_tr_b16 v[110:111], v19 offset:28672
v_mfma_f32_16x16x32_bf16 v[172:175], v[60:63], v[32:35], v[172:175]
ds_read_b64_tr_b16 v[112:113], v20 offset:24576
v_mfma_f32_16x16x32_bf16 v[168:171], v[56:59], v[32:35], v[168:171]
ds_read_b64_tr_b16 v[114:115], v20 offset:28672
v_mfma_f32_16x16x32_bf16 v[164:167], v[52:55], v[32:35], v[164:167]
ds_read_b64_tr_b16 v[116:117], v21 offset:24576
v_mfma_f32_16x16x32_bf16 v[160:163], v[48:51], v[32:35], v[160:163]
ds_read_b64_tr_b16 v[118:119], v21 offset:28672
v_mfma_f32_16x16x32_bf16 v[156:159], v[44:47], v[32:35], v[156:159]
ds_read_b64_tr_b16 v[120:121], v22 offset:24576
v_mfma_f32_16x16x32_bf16 v[188:191], v[44:47], v[36:39], v[188:191]
ds_read_b64_tr_b16 v[122:123], v22 offset:28672
v_mfma_f32_16x16x32_bf16 v[192:195], v[48:51], v[36:39], v[192:195]
ds_read_b128 v[80:83], v10 offset:9216
v_mfma_f32_16x16x32_bf16 v[196:199], v[52:55], v[36:39], v[196:199]
ds_read_b128 v[84:87], v10 offset:10240
v_mfma_f32_16x16x32_bf16 v[200:203], v[56:59], v[36:39], v[200:203]
ds_read_b128 v[88:91], v10 offset:11264
v_mfma_f32_16x16x32_bf16 v[204:207], v[60:63], v[36:39], v[204:207]
v_mfma_f32_16x16x32_bf16 v[208:211], v[64:67], v[36:39], v[208:211]
v_mfma_f32_16x16x32_bf16 v[212:215], v[68:71], v[36:39], v[212:215]
v_mfma_f32_16x16x32_bf16 v[216:219], v[72:75], v[36:39], v[216:219]
v_mfma_f32_16x16x32_bf16 v[248:251], v[72:75], v[40:43], v[248:251]
v_mfma_f32_16x16x32_bf16 v[244:247], v[68:71], v[40:43], v[244:247]
v_mfma_f32_16x16x32_bf16 v[240:243], v[64:67], v[40:43], v[240:243]
v_mfma_f32_16x16x32_bf16 v[236:239], v[60:63], v[40:43], v[236:239]
v_mfma_f32_16x16x32_bf16 v[232:235], v[56:59], v[40:43], v[232:235]
v_mfma_f32_16x16x32_bf16 v[228:231], v[52:55], v[40:43], v[228:231]
v_mfma_f32_16x16x32_bf16 v[224:227], v[48:51], v[40:43], v[224:227]
v_mfma_f32_16x16x32_bf16 v[220:223], v[44:47], v[40:43], v[220:223]
s_waitcnt lgkmcnt(0)
s_barrier
v_mfma_f32_16x16x32_bf16 v[124:127], v[92:95], v[76:79], v[124:127]
ds_read_b128 v[28:31], v9 offset:0
v_mfma_f32_16x16x32_bf16 v[128:131], v[96:99], v[76:79], v[128:131]
ds_read_b64_tr_b16 v[44:45], v11 offset:0
v_mfma_f32_16x16x32_bf16 v[132:135], v[100:103], v[76:79], v[132:135]
ds_read_b64_tr_b16 v[46:47], v11 offset:4096
v_mfma_f32_16x16x32_bf16 v[136:139], v[104:107], v[76:79], v[136:139]
ds_read_b64_tr_b16 v[48:49], v12 offset:0
v_mfma_f32_16x16x32_bf16 v[140:143], v[108:111], v[76:79], v[140:143]
ds_read_b64_tr_b16 v[50:51], v12 offset:4096
v_mfma_f32_16x16x32_bf16 v[144:147], v[112:115], v[76:79], v[144:147]
ds_read_b64_tr_b16 v[52:53], v13 offset:0
v_mfma_f32_16x16x32_bf16 v[148:151], v[116:119], v[76:79], v[148:151]
ds_read_b64_tr_b16 v[54:55], v13 offset:4096
v_mfma_f32_16x16x32_bf16 v[152:155], v[120:123], v[76:79], v[152:155]
ds_read_b64_tr_b16 v[56:57], v14 offset:0
v_mfma_f32_16x16x32_bf16 v[184:187], v[120:123], v[80:83], v[184:187]
ds_read_b64_tr_b16 v[58:59], v14 offset:4096
v_mfma_f32_16x16x32_bf16 v[180:183], v[116:119], v[80:83], v[180:183]
ds_read_b64_tr_b16 v[60:61], v11 offset:16384
v_mfma_f32_16x16x32_bf16 v[176:179], v[112:115], v[80:83], v[176:179]
ds_read_b64_tr_b16 v[62:63], v11 offset:20480
v_mfma_f32_16x16x32_bf16 v[172:175], v[108:111], v[80:83], v[172:175]
ds_read_b64_tr_b16 v[64:65], v12 offset:16384
v_mfma_f32_16x16x32_bf16 v[168:171], v[104:107], v[80:83], v[168:171]
ds_read_b64_tr_b16 v[66:67], v12 offset:20480
v_mfma_f32_16x16x32_bf16 v[164:167], v[100:103], v[80:83], v[164:167]
ds_read_b64_tr_b16 v[68:69], v13 offset:16384
v_mfma_f32_16x16x32_bf16 v[160:163], v[96:99], v[80:83], v[160:163]
ds_read_b64_tr_b16 v[70:71], v13 offset:20480
v_mfma_f32_16x16x32_bf16 v[156:159], v[92:95], v[80:83], v[156:159]
ds_read_b64_tr_b16 v[72:73], v14 offset:16384
v_mfma_f32_16x16x32_bf16 v[188:191], v[92:95], v[84:87], v[188:191]
ds_read_b64_tr_b16 v[74:75], v14 offset:20480
v_mfma_f32_16x16x32_bf16 v[192:195], v[96:99], v[84:87], v[192:195]
ds_read_b128 v[32:35], v9 offset:1024
v_mfma_f32_16x16x32_bf16 v[196:199], v[100:103], v[84:87], v[196:199]
ds_read_b128 v[36:39], v9 offset:2048
v_mfma_f32_16x16x32_bf16 v[200:203], v[104:107], v[84:87], v[200:203]
ds_read_b128 v[40:43], v9 offset:3072
v_mfma_f32_16x16x32_bf16 v[204:207], v[108:111], v[84:87], v[204:207]
v_mfma_f32_16x16x32_bf16 v[208:211], v[112:115], v[84:87], v[208:211]
v_mfma_f32_16x16x32_bf16 v[212:215], v[116:119], v[84:87], v[212:215]
v_mfma_f32_16x16x32_bf16 v[216:219], v[120:123], v[84:87], v[216:219]
v_mfma_f32_16x16x32_bf16 v[248:251], v[120:123], v[88:91], v[248:251]
v_mfma_f32_16x16x32_bf16 v[244:247], v[116:119], v[88:91], v[244:247]
v_mfma_f32_16x16x32_bf16 v[240:243], v[112:115], v[88:91], v[240:243]
v_mfma_f32_16x16x32_bf16 v[236:239], v[108:111], v[88:91], v[236:239]
v_mfma_f32_16x16x32_bf16 v[232:235], v[104:107], v[88:91], v[232:235]
v_mfma_f32_16x16x32_bf16 v[228:231], v[100:103], v[88:91], v[228:231]
v_mfma_f32_16x16x32_bf16 v[224:227], v[96:99], v[88:91], v[224:227]
v_mfma_f32_16x16x32_bf16 v[220:223], v[92:95], v[88:91], v[220:223]
s_waitcnt lgkmcnt(0)
v_mfma_f32_16x16x32_bf16 v[124:127], v[44:47], v[28:31], v[124:127]
ds_read_b128 v[76:79], v9 offset:8192
v_mfma_f32_16x16x32_bf16 v[128:131], v[48:51], v[28:31], v[128:131]
ds_read_b64_tr_b16 v[92:93], v11 offset:8192
v_mfma_f32_16x16x32_bf16 v[132:135], v[52:55], v[28:31], v[132:135]
ds_read_b64_tr_b16 v[94:95], v11 offset:12288
v_mfma_f32_16x16x32_bf16 v[136:139], v[56:59], v[28:31], v[136:139]
ds_read_b64_tr_b16 v[96:97], v12 offset:8192
v_mfma_f32_16x16x32_bf16 v[140:143], v[60:63], v[28:31], v[140:143]
ds_read_b64_tr_b16 v[98:99], v12 offset:12288
v_mfma_f32_16x16x32_bf16 v[144:147], v[64:67], v[28:31], v[144:147]
ds_read_b64_tr_b16 v[100:101], v13 offset:8192
v_mfma_f32_16x16x32_bf16 v[148:151], v[68:71], v[28:31], v[148:151]
ds_read_b64_tr_b16 v[102:103], v13 offset:12288
v_mfma_f32_16x16x32_bf16 v[152:155], v[72:75], v[28:31], v[152:155]
ds_read_b64_tr_b16 v[104:105], v14 offset:8192
v_mfma_f32_16x16x32_bf16 v[184:187], v[72:75], v[32:35], v[184:187]
ds_read_b64_tr_b16 v[106:107], v14 offset:12288
v_mfma_f32_16x16x32_bf16 v[180:183], v[68:71], v[32:35], v[180:183]
ds_read_b64_tr_b16 v[108:109], v11 offset:24576
v_mfma_f32_16x16x32_bf16 v[176:179], v[64:67], v[32:35], v[176:179]
ds_read_b64_tr_b16 v[110:111], v11 offset:28672
v_mfma_f32_16x16x32_bf16 v[172:175], v[60:63], v[32:35], v[172:175]
ds_read_b64_tr_b16 v[112:113], v12 offset:24576
v_mfma_f32_16x16x32_bf16 v[168:171], v[56:59], v[32:35], v[168:171]
ds_read_b64_tr_b16 v[114:115], v12 offset:28672
v_mfma_f32_16x16x32_bf16 v[164:167], v[52:55], v[32:35], v[164:167]
ds_read_b64_tr_b16 v[116:117], v13 offset:24576
v_mfma_f32_16x16x32_bf16 v[160:163], v[48:51], v[32:35], v[160:163]
ds_read_b64_tr_b16 v[118:119], v13 offset:28672
v_mfma_f32_16x16x32_bf16 v[156:159], v[44:47], v[32:35], v[156:159]
ds_read_b64_tr_b16 v[120:121], v14 offset:24576
v_mfma_f32_16x16x32_bf16 v[188:191], v[44:47], v[36:39], v[188:191]
ds_read_b64_tr_b16 v[122:123], v14 offset:28672
v_mfma_f32_16x16x32_bf16 v[192:195], v[48:51], v[36:39], v[192:195]
ds_read_b128 v[80:83], v9 offset:9216
v_mfma_f32_16x16x32_bf16 v[196:199], v[52:55], v[36:39], v[196:199]
ds_read_b128 v[84:87], v9 offset:10240
v_mfma_f32_16x16x32_bf16 v[200:203], v[56:59], v[36:39], v[200:203]
ds_read_b128 v[88:91], v9 offset:11264
v_mfma_f32_16x16x32_bf16 v[204:207], v[60:63], v[36:39], v[204:207]
v_mfma_f32_16x16x32_bf16 v[208:211], v[64:67], v[36:39], v[208:211]
v_mfma_f32_16x16x32_bf16 v[212:215], v[68:71], v[36:39], v[212:215]
v_mfma_f32_16x16x32_bf16 v[216:219], v[72:75], v[36:39], v[216:219]
v_mfma_f32_16x16x32_bf16 v[248:251], v[72:75], v[40:43], v[248:251]
v_mfma_f32_16x16x32_bf16 v[244:247], v[68:71], v[40:43], v[244:247]
v_mfma_f32_16x16x32_bf16 v[240:243], v[64:67], v[40:43], v[240:243]
v_mfma_f32_16x16x32_bf16 v[236:239], v[60:63], v[40:43], v[236:239]
v_mfma_f32_16x16x32_bf16 v[232:235], v[56:59], v[40:43], v[232:235]
v_mfma_f32_16x16x32_bf16 v[228:231], v[52:55], v[40:43], v[228:231]
v_mfma_f32_16x16x32_bf16 v[224:227], v[48:51], v[40:43], v[224:227]
v_mfma_f32_16x16x32_bf16 v[220:223], v[44:47], v[40:43], v[220:223]
s_waitcnt lgkmcnt(0)
s_barrier
v_mfma_f32_16x16x32_bf16 v[124:127], v[92:95], v[76:79], v[124:127]
ds_read_b128 v[28:31], v9 offset:49152
v_mfma_f32_16x16x32_bf16 v[128:131], v[96:99], v[76:79], v[128:131]
ds_read_b64_tr_b16 v[44:45], v15 offset:0
v_mfma_f32_16x16x32_bf16 v[132:135], v[100:103], v[76:79], v[132:135]
ds_read_b64_tr_b16 v[46:47], v15 offset:4096
v_mfma_f32_16x16x32_bf16 v[136:139], v[104:107], v[76:79], v[136:139]
ds_read_b64_tr_b16 v[48:49], v16 offset:0
v_mfma_f32_16x16x32_bf16 v[140:143], v[108:111], v[76:79], v[140:143]
ds_read_b64_tr_b16 v[50:51], v16 offset:4096
v_mfma_f32_16x16x32_bf16 v[144:147], v[112:115], v[76:79], v[144:147]
ds_read_b64_tr_b16 v[52:53], v17 offset:0
v_mfma_f32_16x16x32_bf16 v[148:151], v[116:119], v[76:79], v[148:151]
ds_read_b64_tr_b16 v[54:55], v17 offset:4096
v_mfma_f32_16x16x32_bf16 v[152:155], v[120:123], v[76:79], v[152:155]
ds_read_b64_tr_b16 v[56:57], v18 offset:0
v_mfma_f32_16x16x32_bf16 v[184:187], v[120:123], v[80:83], v[184:187]
ds_read_b64_tr_b16 v[58:59], v18 offset:4096
v_mfma_f32_16x16x32_bf16 v[180:183], v[116:119], v[80:83], v[180:183]
ds_read_b64_tr_b16 v[60:61], v15 offset:16384
v_mfma_f32_16x16x32_bf16 v[176:179], v[112:115], v[80:83], v[176:179]
ds_read_b64_tr_b16 v[62:63], v15 offset:20480
v_mfma_f32_16x16x32_bf16 v[172:175], v[108:111], v[80:83], v[172:175]
ds_read_b64_tr_b16 v[64:65], v16 offset:16384
v_mfma_f32_16x16x32_bf16 v[168:171], v[104:107], v[80:83], v[168:171]
ds_read_b64_tr_b16 v[66:67], v16 offset:20480
v_mfma_f32_16x16x32_bf16 v[164:167], v[100:103], v[80:83], v[164:167]
ds_read_b64_tr_b16 v[68:69], v17 offset:16384
v_mfma_f32_16x16x32_bf16 v[160:163], v[96:99], v[80:83], v[160:163]
ds_read_b64_tr_b16 v[70:71], v17 offset:20480
v_mfma_f32_16x16x32_bf16 v[156:159], v[92:95], v[80:83], v[156:159]
ds_read_b64_tr_b16 v[72:73], v18 offset:16384
v_mfma_f32_16x16x32_bf16 v[188:191], v[92:95], v[84:87], v[188:191]
ds_read_b64_tr_b16 v[74:75], v18 offset:20480
v_mfma_f32_16x16x32_bf16 v[192:195], v[96:99], v[84:87], v[192:195]
ds_read_b128 v[32:35], v9 offset:50176
v_mfma_f32_16x16x32_bf16 v[196:199], v[100:103], v[84:87], v[196:199]
ds_read_b128 v[36:39], v9 offset:51200
v_mfma_f32_16x16x32_bf16 v[200:203], v[104:107], v[84:87], v[200:203]
ds_read_b128 v[40:43], v9 offset:52224
v_mfma_f32_16x16x32_bf16 v[204:207], v[108:111], v[84:87], v[204:207]
v_mfma_f32_16x16x32_bf16 v[208:211], v[112:115], v[84:87], v[208:211]
v_mfma_f32_16x16x32_bf16 v[212:215], v[116:119], v[84:87], v[212:215]
v_mfma_f32_16x16x32_bf16 v[216:219], v[120:123], v[84:87], v[216:219]
v_mfma_f32_16x16x32_bf16 v[248:251], v[120:123], v[88:91], v[248:251]
v_mfma_f32_16x16x32_bf16 v[244:247], v[116:119], v[88:91], v[244:247]
v_mfma_f32_16x16x32_bf16 v[240:243], v[112:115], v[88:91], v[240:243]
v_mfma_f32_16x16x32_bf16 v[236:239], v[108:111], v[88:91], v[236:239]
v_mfma_f32_16x16x32_bf16 v[232:235], v[104:107], v[88:91], v[232:235]
v_mfma_f32_16x16x32_bf16 v[228:231], v[100:103], v[88:91], v[228:231]
v_mfma_f32_16x16x32_bf16 v[224:227], v[96:99], v[88:91], v[224:227]
v_mfma_f32_16x16x32_bf16 v[220:223], v[92:95], v[88:91], v[220:223]
s_waitcnt lgkmcnt(0)
v_mfma_f32_16x16x32_bf16 v[124:127], v[44:47], v[28:31], v[124:127]
ds_read_b128 v[76:79], v9 offset:57344
v_mfma_f32_16x16x32_bf16 v[128:131], v[48:51], v[28:31], v[128:131]
ds_read_b64_tr_b16 v[92:93], v15 offset:8192
v_mfma_f32_16x16x32_bf16 v[132:135], v[52:55], v[28:31], v[132:135]
ds_read_b64_tr_b16 v[94:95], v15 offset:12288
v_mfma_f32_16x16x32_bf16 v[136:139], v[56:59], v[28:31], v[136:139]
ds_read_b64_tr_b16 v[96:97], v16 offset:8192
v_mfma_f32_16x16x32_bf16 v[140:143], v[60:63], v[28:31], v[140:143]
ds_read_b64_tr_b16 v[98:99], v16 offset:12288
v_mfma_f32_16x16x32_bf16 v[144:147], v[64:67], v[28:31], v[144:147]
ds_read_b64_tr_b16 v[100:101], v17 offset:8192
v_mfma_f32_16x16x32_bf16 v[148:151], v[68:71], v[28:31], v[148:151]
ds_read_b64_tr_b16 v[102:103], v17 offset:12288
v_mfma_f32_16x16x32_bf16 v[152:155], v[72:75], v[28:31], v[152:155]
ds_read_b64_tr_b16 v[104:105], v18 offset:8192
v_mfma_f32_16x16x32_bf16 v[184:187], v[72:75], v[32:35], v[184:187]
ds_read_b64_tr_b16 v[106:107], v18 offset:12288
v_mfma_f32_16x16x32_bf16 v[180:183], v[68:71], v[32:35], v[180:183]
ds_read_b64_tr_b16 v[108:109], v15 offset:24576
v_mfma_f32_16x16x32_bf16 v[176:179], v[64:67], v[32:35], v[176:179]
ds_read_b64_tr_b16 v[110:111], v15 offset:28672
v_mfma_f32_16x16x32_bf16 v[172:175], v[60:63], v[32:35], v[172:175]
ds_read_b64_tr_b16 v[112:113], v16 offset:24576
v_mfma_f32_16x16x32_bf16 v[168:171], v[56:59], v[32:35], v[168:171]
ds_read_b64_tr_b16 v[114:115], v16 offset:28672
v_mfma_f32_16x16x32_bf16 v[164:167], v[52:55], v[32:35], v[164:167]
ds_read_b64_tr_b16 v[116:117], v17 offset:24576
v_mfma_f32_16x16x32_bf16 v[160:163], v[48:51], v[32:35], v[160:163]
ds_read_b64_tr_b16 v[118:119], v17 offset:28672
v_mfma_f32_16x16x32_bf16 v[156:159], v[44:47], v[32:35], v[156:159]
ds_read_b64_tr_b16 v[120:121], v18 offset:24576
v_mfma_f32_16x16x32_bf16 v[188:191], v[44:47], v[36:39], v[188:191]
ds_read_b64_tr_b16 v[122:123], v18 offset:28672
v_mfma_f32_16x16x32_bf16 v[192:195], v[48:51], v[36:39], v[192:195]
ds_read_b128 v[80:83], v9 offset:58368
v_mfma_f32_16x16x32_bf16 v[196:199], v[52:55], v[36:39], v[196:199]
ds_read_b128 v[84:87], v9 offset:59392
v_mfma_f32_16x16x32_bf16 v[200:203], v[56:59], v[36:39], v[200:203]
ds_read_b128 v[88:91], v9 offset:60416
v_mfma_f32_16x16x32_bf16 v[204:207], v[60:63], v[36:39], v[204:207]
v_mfma_f32_16x16x32_bf16 v[208:211], v[64:67], v[36:39], v[208:211]
v_mfma_f32_16x16x32_bf16 v[212:215], v[68:71], v[36:39], v[212:215]
v_mfma_f32_16x16x32_bf16 v[216:219], v[72:75], v[36:39], v[216:219]
v_mfma_f32_16x16x32_bf16 v[248:251], v[72:75], v[40:43], v[248:251]
v_mfma_f32_16x16x32_bf16 v[244:247], v[68:71], v[40:43], v[244:247]
v_mfma_f32_16x16x32_bf16 v[240:243], v[64:67], v[40:43], v[240:243]
v_mfma_f32_16x16x32_bf16 v[236:239], v[60:63], v[40:43], v[236:239]
v_mfma_f32_16x16x32_bf16 v[232:235], v[56:59], v[40:43], v[232:235]
v_mfma_f32_16x16x32_bf16 v[228:231], v[52:55], v[40:43], v[228:231]
v_mfma_f32_16x16x32_bf16 v[224:227], v[48:51], v[40:43], v[224:227]
v_mfma_f32_16x16x32_bf16 v[220:223], v[44:47], v[40:43], v[220:223]
s_waitcnt lgkmcnt(0)
s_barrier
v_mfma_f32_16x16x32_bf16 v[124:127], v[92:95], v[76:79], v[124:127]
ds_read_b128 v[28:31], v10 offset:0
v_mfma_f32_16x16x32_bf16 v[128:131], v[96:99], v[76:79], v[128:131]
ds_read_b64_tr_b16 v[44:45], v19 offset:0
s_branch Lov_15
.p2align 12
Lst_15_0:
s_branch Lwr_163
s_nop 0
s_nop 0
Lov_15:
v_mfma_f32_16x16x32_bf16 v[132:135], v[100:103], v[76:79], v[132:135]
ds_read_b64_tr_b16 v[46:47], v19 offset:4096
v_mfma_f32_16x16x32_bf16 v[136:139], v[104:107], v[76:79], v[136:139]
ds_read_b64_tr_b16 v[48:49], v20 offset:0
v_mfma_f32_16x16x32_bf16 v[140:143], v[108:111], v[76:79], v[140:143]
ds_read_b64_tr_b16 v[50:51], v20 offset:4096
v_mfma_f32_16x16x32_bf16 v[144:147], v[112:115], v[76:79], v[144:147]
ds_read_b64_tr_b16 v[52:53], v21 offset:0
v_mfma_f32_16x16x32_bf16 v[148:151], v[116:119], v[76:79], v[148:151]
ds_read_b64_tr_b16 v[54:55], v21 offset:4096
v_mfma_f32_16x16x32_bf16 v[152:155], v[120:123], v[76:79], v[152:155]
ds_read_b64_tr_b16 v[56:57], v22 offset:0
v_mfma_f32_16x16x32_bf16 v[184:187], v[120:123], v[80:83], v[184:187]
ds_read_b64_tr_b16 v[58:59], v22 offset:4096
v_mfma_f32_16x16x32_bf16 v[180:183], v[116:119], v[80:83], v[180:183]
ds_read_b64_tr_b16 v[60:61], v19 offset:16384
v_mfma_f32_16x16x32_bf16 v[176:179], v[112:115], v[80:83], v[176:179]
ds_read_b64_tr_b16 v[62:63], v19 offset:20480
v_mfma_f32_16x16x32_bf16 v[172:175], v[108:111], v[80:83], v[172:175]
ds_read_b64_tr_b16 v[64:65], v20 offset:16384
v_mfma_f32_16x16x32_bf16 v[168:171], v[104:107], v[80:83], v[168:171]
ds_read_b64_tr_b16 v[66:67], v20 offset:20480
v_mfma_f32_16x16x32_bf16 v[164:167], v[100:103], v[80:83], v[164:167]
ds_read_b64_tr_b16 v[68:69], v21 offset:16384
v_mfma_f32_16x16x32_bf16 v[160:163], v[96:99], v[80:83], v[160:163]
ds_read_b64_tr_b16 v[70:71], v21 offset:20480
v_mfma_f32_16x16x32_bf16 v[156:159], v[92:95], v[80:83], v[156:159]
ds_read_b64_tr_b16 v[72:73], v22 offset:16384
v_mfma_f32_16x16x32_bf16 v[188:191], v[92:95], v[84:87], v[188:191]
ds_read_b64_tr_b16 v[74:75], v22 offset:20480
v_mfma_f32_16x16x32_bf16 v[192:195], v[96:99], v[84:87], v[192:195]
ds_read_b128 v[32:35], v10 offset:1024
v_mfma_f32_16x16x32_bf16 v[196:199], v[100:103], v[84:87], v[196:199]
ds_read_b128 v[36:39], v10 offset:2048
v_mfma_f32_16x16x32_bf16 v[200:203], v[104:107], v[84:87], v[200:203]
ds_read_b128 v[40:43], v10 offset:3072
v_mfma_f32_16x16x32_bf16 v[204:207], v[108:111], v[84:87], v[204:207]
v_mfma_f32_16x16x32_bf16 v[208:211], v[112:115], v[84:87], v[208:211]
v_mfma_f32_16x16x32_bf16 v[212:215], v[116:119], v[84:87], v[212:215]
v_mfma_f32_16x16x32_bf16 v[216:219], v[120:123], v[84:87], v[216:219]
v_mfma_f32_16x16x32_bf16 v[248:251], v[120:123], v[88:91], v[248:251]
v_mfma_f32_16x16x32_bf16 v[244:247], v[116:119], v[88:91], v[244:247]
v_mfma_f32_16x16x32_bf16 v[240:243], v[112:115], v[88:91], v[240:243]
v_mfma_f32_16x16x32_bf16 v[236:239], v[108:111], v[88:91], v[236:239]
v_mfma_f32_16x16x32_bf16 v[232:235], v[104:107], v[88:91], v[232:235]
v_mfma_f32_16x16x32_bf16 v[228:231], v[100:103], v[88:91], v[228:231]
v_mfma_f32_16x16x32_bf16 v[224:227], v[96:99], v[88:91], v[224:227]
v_mfma_f32_16x16x32_bf16 v[220:223], v[92:95], v[88:91], v[220:223]
s_sub_u32 s41, s41, 1
s_cmp_lg_u32 s41, 0
s_cbranch_scc1 Lk3l_127
s_waitcnt lgkmcnt(0)
v_lshrrev_b32 v84, 4, v1
s_lshl_b32 s43, s63, 8
s_add_u32 s43, s43, 148480
v_lshl_add_u32 v85, v84, 4, s43
v_and_b32 v84, 15, v1
s_lshl_b32 s43, s62, 9
s_add_u32 s43, s43, 147456
v_lshl_add_u32 v84, v84, 3, s43
ds_read_b128 v[28:31], v85 offset:0
ds_read_b128 v[32:35], v85 offset:64
ds_read_b128 v[36:39], v85 offset:128
ds_read_b128 v[40:43], v85 offset:192
ds_read_b128 v[44:47], v85 offset:896
ds_read_b128 v[48:51], v85 offset:960
ds_read_b128 v[52:55], v85 offset:1024
ds_read_b128 v[56:59], v85 offset:1088
ds_read_b64 v[60:61], v84 offset:0
ds_read_b64 v[62:63], v84 offset:128
ds_read_b64 v[64:65], v84 offset:256
ds_read_b64 v[66:67], v84 offset:384
s_lshl_b32 s54, s35, 15
s_lshl_b32 s43, s63, 14
s_add_u32 s54, s54, s43
s_lshl_b32 s43, s62, 12
s_add_u32 s54, s54, s43
s_add_u32 s55, s54, 8192
v_lshrrev_b32 v122, 3, v1
v_and_b32 v123, 6, v122
v_and_b32 v25, 7, v1
v_xor_b32 v25, v25, v123
v_lshlrev_b32 v25, 4, v25
v_mul_u32_u24 v122, 2048, v122
v_add_u32 v25, v25, v122
s_lshl_b32 s43, s61, 7
s_lshl_b32 s44, s47, 15
s_add_u32 s43, s43, s44
v_add_u32 v25, s43, v25
s_waitcnt lgkmcnt(0)
s_barrier
s_add_u32 m0, s39, 81920
s_add_u32 s37, s52, 589824
buffer_load_dwordx4 v3, s[24:27], s37 offen sc1 lds
v_mul_f32 v70, v61, v61
v_mul_f32 v68, 0xc0135761, v61
v_mul_f32 v69, 0xbdd2d3e8, v61
v_mul_f32 v69, v69, v70
v_rcp_f32 v70, v70
v_mul_f32 v74, v63, v63
v_mul_f32 v72, 0xc0135761, v63
v_mul_f32 v73, 0xbdd2d3e8, v63
v_mul_f32 v73, v73, v74
v_rcp_f32 v74, v74
buffer_load_dwordx4 v3, s[24:27], s37 offen offset:1024 sc1 lds
v_fma_f32 v124, -v60, v28, v124
v_fma_f32 v125, -v60, v29, v125
v_fma_f32 v126, -v60, v30, v126
v_fma_f32 v127, -v60, v31, v127
v_fma_f32 v156, -v62, v28, v156
v_fma_f32 v157, -v62, v29, v157
v_fma_f32 v158, -v62, v30, v158
v_fma_f32 v159, -v62, v31, v159
v_mul_f32 v76, v124, v124
v_mul_f32 v77, v125, v125
buffer_load_dwordx4 v3, s[24:27], s37 offen offset:2048 sc1 lds
v_mul_f32 v78, v126, v126
v_mul_f32 v79, v127, v127
v_mul_f32 v80, v156, v156
v_mul_f32 v81, v157, v157
v_mul_f32 v82, v158, v158
v_mul_f32 v83, v159, v159
v_fma_f32 v76, v76, v69, v68
v_fma_f32 v77, v77, v69, v68
v_fma_f32 v78, v78, v69, v68
v_fma_f32 v79, v79, v69, v68
buffer_load_dwordx4 v3, s[24:27], s37 offen offset:3072 sc1 lds
v_fma_f32 v80, v80, v73, v72
v_fma_f32 v81, v81, v73, v72
v_fma_f32 v82, v82, v73, v72
v_fma_f32 v83, v83, v73, v72
v_mul_f32 v76, v76, v124
v_mul_f32 v77, v77, v125
v_mul_f32 v78, v78, v126
v_mul_f32 v79, v79, v127
v_mul_f32 v80, v80, v156
v_mul_f32 v81, v81, v157
s_add_u32 m0, s39, 147456
s_add_u32 s38, s53, 4718592
buffer_load_dwordx4 v23, s[28:31], s38 offen lds
v_mul_f32 v82, v82, v158
v_mul_f32 v83, v83, v159
v_exp_f32 v76, v76
v_exp_f32 v77, v77
v_exp_f32 v78, v78
v_exp_f32 v79, v79
v_exp_f32 v80, v80
v_exp_f32 v81, v81
v_exp_f32 v82, v82
v_exp_f32 v83, v83
s_add_u32 m0, s39, 148480
s_add_u32 s38, s53, 4718592
buffer_load_dwordx4 v24, s[28:31], s38 offen lds
v_fma_f32 v140, -v60, v44, v140
v_fma_f32 v141, -v60, v45, v141
v_fma_f32 v142, -v60, v46, v142
v_fma_f32 v143, -v60, v47, v143
v_fma_f32 v172, -v62, v44, v172
v_fma_f32 v173, -v62, v45, v173
v_fma_f32 v174, -v62, v46, v174
v_fma_f32 v175, -v62, v47, v175
v_fma_f32 v76, v76, v70, v70
v_fma_f32 v77, v77, v70, v70
s_add_u32 m0, s39, 149504
s_add_u32 s38, s53, 4734976
buffer_load_dwordx4 v23, s[28:31], s38 offen lds
v_fma_f32 v78, v78, v70, v70
v_fma_f32 v79, v79, v70, v70
v_fma_f32 v80, v80, v74, v74
v_fma_f32 v81, v81, v74, v74
v_fma_f32 v82, v82, v74, v74
v_fma_f32 v83, v83, v74, v74
v_rcp_f32 v76, v76
v_rcp_f32 v77, v77
v_rcp_f32 v78, v78
v_rcp_f32 v79, v79
s_add_u32 m0, s39, 150528
s_add_u32 s38, s53, 4734976
buffer_load_dwordx4 v24, s[28:31], s38 offen lds
v_rcp_f32 v80, v80
v_rcp_f32 v81, v81
v_rcp_f32 v82, v82
v_rcp_f32 v83, v83
v_mul_f32 v140, v124, v140
v_mul_f32 v141, v125, v141
v_mul_f32 v142, v126, v142
v_mul_f32 v143, v127, v143
v_mul_f32 v172, v156, v172
v_mul_f32 v173, v157, v173
s_add_u32 m0, s39, 98304
s_add_u32 s37, s52, 606208
buffer_load_dwordx4 v3, s[24:27], s37 offen sc1 lds
v_mul_f32 v174, v158, v174
v_mul_f32 v175, v159, v175
v_mul_f32 v140, v140, v76
v_mul_f32 v141, v141, v77
v_mul_f32 v142, v142, v78
v_mul_f32 v143, v143, v79
v_mul_f32 v172, v172, v80
v_mul_f32 v173, v173, v81
v_mul_f32 v174, v174, v82
v_mul_f32 v175, v175, v83
buffer_load_dwordx4 v3, s[24:27], s37 offen offset:1024 sc1 lds
v_cvt_pk_bf16_f32 v124, v140, v141
v_cvt_pk_bf16_f32 v125, v142, v143
v_cvt_pk_bf16_f32 v156, v172, v173
v_cvt_pk_bf16_f32 v157, v174, v175
v_fma_f32 v128, -v60, v32, v128
v_fma_f32 v129, -v60, v33, v129
v_fma_f32 v130, -v60, v34, v130
v_fma_f32 v131, -v60, v35, v131
v_fma_f32 v160, -v62, v32, v160
v_fma_f32 v161, -v62, v33, v161
buffer_load_dwordx4 v3, s[24:27], s37 offen offset:2048 sc1 lds
v_fma_f32 v162, -v62, v34, v162
v_fma_f32 v163, -v62, v35, v163
v_mul_f32 v76, v128, v128
v_mul_f32 v77, v129, v129
v_mul_f32 v78, v130, v130
v_mul_f32 v79, v131, v131
v_mul_f32 v80, v160, v160
v_mul_f32 v81, v161, v161
v_mul_f32 v82, v162, v162
v_mul_f32 v83, v163, v163
buffer_load_dwordx4 v3, s[24:27], s37 offen offset:3072 sc1 lds
v_fma_f32 v76, v76, v69, v68
v_fma_f32 v77, v77, v69, v68
v_fma_f32 v78, v78, v69, v68
v_fma_f32 v79, v79, v69, v68
v_fma_f32 v80, v80, v73, v72
v_fma_f32 v81, v81, v73, v72
v_fma_f32 v82, v82, v73, v72
v_fma_f32 v83, v83, v73, v72
v_mul_f32 v76, v76, v128
v_mul_f32 v77, v77, v129
s_add_u32 m0, s39, 114688
s_add_u32 s38, s53, 4849664
buffer_load_dwordx4 v23, s[28:31], s38 offen lds
v_mul_f32 v78, v78, v130
v_mul_f32 v79, v79, v131
v_mul_f32 v80, v80, v160
v_mul_f32 v81, v81, v161
v_mul_f32 v82, v82, v162
v_mul_f32 v83, v83, v163
v_exp_f32 v76, v76
v_exp_f32 v77, v77
v_exp_f32 v78, v78
v_exp_f32 v79, v79
s_add_u32 m0, s39, 115712
s_add_u32 s38, s53, 4849664
buffer_load_dwordx4 v24, s[28:31], s38 offen lds
v_exp_f32 v80, v80
v_exp_f32 v81, v81
v_exp_f32 v82, v82
v_exp_f32 v83, v83
v_fma_f32 v144, -v60, v48, v144
v_fma_f32 v145, -v60, v49, v145
v_fma_f32 v146, -v60, v50, v146
v_fma_f32 v147, -v60, v51, v147
v_fma_f32 v176, -v62, v48, v176
v_fma_f32 v177, -v62, v49, v177
s_add_u32 m0, s39, 116736
s_add_u32 s38, s53, 4866048
buffer_load_dwordx4 v23, s[28:31], s38 offen lds
s_add_u32 m0, s39, 117760
s_add_u32 s38, s53, 4866048
buffer_load_dwordx4 v24, s[28:31], s38 offen lds
s_barrier
s_add_u32 m0, s39, 131072
s_add_u32 s37, s52, 622592
buffer_load_dwordx4 v3, s[24:27], s37 offen sc1 lds
v_fma_f32 v178, -v62, v50, v178
v_fma_f32 v179, -v62, v51, v179
v_fma_f32 v76, v76, v70, v70
v_fma_f32 v77, v77, v70, v70
v_fma_f32 v78, v78, v70, v70
v_fma_f32 v79, v79, v70, v70
v_fma_f32 v80, v80, v74, v74
v_fma_f32 v81, v81, v74, v74
v_fma_f32 v82, v82, v74, v74
v_fma_f32 v83, v83, v74, v74
v_rcp_f32 v76, v76
v_rcp_f32 v77, v77
v_rcp_f32 v78, v78
v_rcp_f32 v79, v79
v_rcp_f32 v80, v80
v_rcp_f32 v81, v81
v_rcp_f32 v82, v82
v_rcp_f32 v83, v83
v_mul_f32 v144, v128, v144
v_mul_f32 v145, v129, v145
v_mul_f32 v146, v130, v146
v_mul_f32 v147, v131, v147
v_mul_f32 v176, v160, v176
buffer_load_dwordx4 v3, s[24:27], s37 offen offset:1024 sc1 lds
v_mul_f32 v177, v161, v177
v_mul_f32 v178, v162, v178
v_mul_f32 v179, v163, v179
v_mul_f32 v144, v144, v76
v_mul_f32 v145, v145, v77
v_mul_f32 v146, v146, v78
v_mul_f32 v147, v147, v79
v_mul_f32 v176, v176, v80
v_mul_f32 v177, v177, v81
v_mul_f32 v178, v178, v82
v_mul_f32 v179, v179, v83
v_cvt_pk_bf16_f32 v126, v144, v145
v_cvt_pk_bf16_f32 v127, v146, v147
v_cvt_pk_bf16_f32 v158, v176, v177
v_cvt_pk_bf16_f32 v159, v178, v179
buffer_store_dwordx4 v[124:127], v2, s[24:27], s54 offen offset:0 sc1
buffer_store_dwordx4 v[156:159], v2, s[24:27], s54 offen offset:1024 sc1
v_fma_f32 v132, -v60, v36, v132
v_fma_f32 v133, -v60, v37, v133
v_fma_f32 v134, -v60, v38, v134
v_fma_f32 v135, -v60, v39, v135
v_fma_f32 v164, -v62, v36, v164
v_fma_f32 v165, -v62, v37, v165
buffer_load_dwordx4 v3, s[24:27], s37 offen offset:2048 sc1 lds
v_fma_f32 v166, -v62, v38, v166
v_fma_f32 v167, -v62, v39, v167
v_mul_f32 v76, v132, v132
v_mul_f32 v77, v133, v133
v_mul_f32 v78, v134, v134
v_mul_f32 v79, v135, v135
v_mul_f32 v80, v164, v164
v_mul_f32 v81, v165, v165
v_mul_f32 v82, v166, v166
v_mul_f32 v83, v167, v167
v_fma_f32 v76, v76, v69, v68
v_fma_f32 v77, v77, v69, v68
v_fma_f32 v78, v78, v69, v68
v_fma_f32 v79, v79, v69, v68
v_fma_f32 v80, v80, v73, v72
v_fma_f32 v81, v81, v73, v72
v_fma_f32 v82, v82, v73, v72
v_fma_f32 v83, v83, v73, v72
v_mul_f32 v76, v76, v132
v_mul_f32 v77, v77, v133
v_mul_f32 v78, v78, v134
v_mul_f32 v79, v79, v135
v_mul_f32 v80, v80, v164
v_mul_f32 v81, v81, v165
buffer_load_dwordx4 v3, s[24:27], s37 offen offset:3072 sc1 lds
v_mul_f32 v82, v82, v166
v_mul_f32 v83, v83, v167
v_exp_f32 v76, v76
v_exp_f32 v77, v77
v_exp_f32 v78, v78
v_exp_f32 v79, v79
v_exp_f32 v80, v80
v_exp_f32 v81, v81
v_exp_f32 v82, v82
v_exp_f32 v83, v83
v_fma_f32 v148, -v60, v52, v148
v_fma_f32 v149, -v60, v53, v149
v_fma_f32 v150, -v60, v54, v150
v_fma_f32 v151, -v60, v55, v151
v_fma_f32 v180, -v62, v52, v180
v_fma_f32 v181, -v62, v53, v181
v_fma_f32 v182, -v62, v54, v182
v_fma_f32 v183, -v62, v55, v183
v_fma_f32 v76, v76, v70, v70
v_fma_f32 v77, v77, v70, v70
v_fma_f32 v78, v78, v70, v70
v_fma_f32 v79, v79, v70, v70
v_fma_f32 v80, v80, v74, v74
s_add_u32 m0, s39, 0
s_add_u32 s38, s53, 4980736
buffer_load_dwordx4 v23, s[28:31], s38 offen lds
v_fma_f32 v81, v81, v74, v74
v_fma_f32 v82, v82, v74, v74
v_fma_f32 v83, v83, v74, v74
v_rcp_f32 v76, v76
v_rcp_f32 v77, v77
v_rcp_f32 v78, v78
v_rcp_f32 v79, v79
v_rcp_f32 v80, v80
v_rcp_f32 v81, v81
v_rcp_f32 v82, v82
v_rcp_f32 v83, v83
v_mul_f32 v148, v132, v148
v_mul_f32 v149, v133, v149
v_mul_f32 v150, v134, v150
v_mul_f32 v151, v135, v151
v_mul_f32 v180, v164, v180
v_mul_f32 v181, v165, v181
v_mul_f32 v182, v166, v182
v_mul_f32 v183, v167, v183
v_mul_f32 v148, v148, v76
v_mul_f32 v149, v149, v77
v_mul_f32 v150, v150, v78
v_mul_f32 v151, v151, v79
s_add_u32 m0, s39, 1024
s_add_u32 s38, s53, 4980736
buffer_load_dwordx4 v24, s[28:31], s38 offen lds
v_mul_f32 v180, v180, v80
v_mul_f32 v181, v181, v81
v_mul_f32 v182, v182, v82
v_mul_f32 v183, v183, v83
v_cvt_pk_bf16_f32 v132, v148, v149
v_cvt_pk_bf16_f32 v133, v150, v151
v_cvt_pk_bf16_f32 v164, v180, v181
v_cvt_pk_bf16_f32 v165, v182, v183
v_fma_f32 v136, -v60, v40, v136
v_fma_f32 v137, -v60, v41, v137
v_fma_f32 v138, -v60, v42, v138
v_fma_f32 v139, -v60, v43, v139
v_fma_f32 v168, -v62, v40, v168
v_fma_f32 v169, -v62, v41, v169
v_fma_f32 v170, -v62, v42, v170
v_fma_f32 v171, -v62, v43, v171
v_mul_f32 v76, v136, v136
v_mul_f32 v77, v137, v137
v_mul_f32 v78, v138, v138
v_mul_f32 v79, v139, v139
v_mul_f32 v80, v168, v168
v_mul_f32 v81, v169, v169
v_mul_f32 v82, v170, v170
v_mul_f32 v83, v171, v171
s_add_u32 m0, s39, 2048
s_add_u32 s38, s53, 4997120
buffer_load_dwordx4 v23, s[28:31], s38 offen lds
s_add_u32 m0, s39, 3072
s_add_u32 s38, s53, 4997120
buffer_load_dwordx4 v24, s[28:31], s38 offen lds
s_barrier
s_add_u32 m0, s39, 16384
s_add_u32 s37, s52, 638976
buffer_load_dwordx4 v3, s[24:27], s37 offen sc1 lds
v_fma_f32 v76, v76, v69, v68
v_fma_f32 v77, v77, v69, v68
v_fma_f32 v78, v78, v69, v68
v_fma_f32 v79, v79, v69, v68
v_fma_f32 v80, v80, v73, v72
v_fma_f32 v81, v81, v73, v72
v_fma_f32 v82, v82, v73, v72
v_fma_f32 v83, v83, v73, v72
v_mul_f32 v76, v76, v136
v_mul_f32 v77, v77, v137
v_mul_f32 v78, v78, v138
v_mul_f32 v79, v79, v139
v_mul_f32 v80, v80, v168
v_mul_f32 v81, v81, v169
v_mul_f32 v82, v82, v170
v_mul_f32 v83, v83, v171
v_exp_f32 v76, v76
v_exp_f32 v77, v77
v_exp_f32 v78, v78
v_exp_f32 v79, v79
v_exp_f32 v80, v80
v_exp_f32 v81, v81
v_exp_f32 v82, v82
buffer_load_dwordx4 v3, s[24:27], s37 offen offset:1024 sc1 lds
v_exp_f32 v83, v83
v_fma_f32 v152, -v60, v56, v152
v_fma_f32 v153, -v60, v57, v153
v_fma_f32 v154, -v60, v58, v154
v_fma_f32 v155, -v60, v59, v155
v_fma_f32 v184, -v62, v56, v184
v_fma_f32 v185, -v62, v57, v185
v_fma_f32 v186, -v62, v58, v186
v_fma_f32 v187, -v62, v59, v187
v_fma_f32 v76, v76, v70, v70
v_fma_f32 v77, v77, v70, v70
v_fma_f32 v78, v78, v70, v70
v_fma_f32 v79, v79, v70, v70
v_fma_f32 v80, v80, v74, v74
v_fma_f32 v81, v81, v74, v74
v_fma_f32 v82, v82, v74, v74
v_fma_f32 v83, v83, v74, v74
v_rcp_f32 v76, v76
v_rcp_f32 v77, v77
v_rcp_f32 v78, v78
v_rcp_f32 v79, v79
v_rcp_f32 v80, v80
v_rcp_f32 v81, v81
buffer_load_dwordx4 v3, s[24:27], s37 offen offset:2048 sc1 lds
v_rcp_f32 v82, v82
v_rcp_f32 v83, v83
v_mul_f32 v152, v136, v152
v_mul_f32 v153, v137, v153
v_mul_f32 v154, v138, v154
v_mul_f32 v155, v139, v155
v_mul_f32 v184, v168, v184
v_mul_f32 v185, v169, v185
v_mul_f32 v186, v170, v186
v_mul_f32 v187, v171, v187
v_mul_f32 v152, v152, v76
v_mul_f32 v153, v153, v77
v_mul_f32 v154, v154, v78
v_mul_f32 v155, v155, v79
v_mul_f32 v184, v184, v80
v_mul_f32 v185, v185, v81
v_mul_f32 v186, v186, v82
v_mul_f32 v187, v187, v83
v_cvt_pk_bf16_f32 v134, v152, v153
v_cvt_pk_bf16_f32 v135, v154, v155
v_cvt_pk_bf16_f32 v166, v184, v185
v_cvt_pk_bf16_f32 v167, v186, v187
buffer_store_dwordx4 v[132:135], v2, s[24:27], s55 offen offset:0 sc1
buffer_store_dwordx4 v[164:167], v2, s[24:27], s55 offen offset:1024 sc1
buffer_load_dwordx4 v3, s[24:27], s37 offen offset:3072 sc1 lds
v_mul_f32 v70, v65, v65
v_mul_f32 v68, 0xc0135761, v65
v_mul_f32 v69, 0xbdd2d3e8, v65
v_mul_f32 v69, v69, v70
v_rcp_f32 v70, v70
v_mul_f32 v74, v67, v67
v_mul_f32 v72, 0xc0135761, v67
v_mul_f32 v73, 0xbdd2d3e8, v67
v_mul_f32 v73, v73, v74
v_rcp_f32 v74, v74
v_fma_f32 v188, -v64, v28, v188
v_fma_f32 v189, -v64, v29, v189
v_fma_f32 v190, -v64, v30, v190
v_fma_f32 v191, -v64, v31, v191
v_fma_f32 v220, -v66, v28, v220
v_fma_f32 v221, -v66, v29, v221
v_fma_f32 v222, -v66, v30, v222
v_fma_f32 v223, -v66, v31, v223
v_mul_f32 v76, v188, v188
v_mul_f32 v77, v189, v189
v_mul_f32 v78, v190, v190
v_mul_f32 v79, v191, v191
v_mul_f32 v80, v220, v220
s_add_u32 m0, s39, 32768
s_add_u32 s38, s53, 5111808
buffer_load_dwordx4 v23, s[28:31], s38 offen lds
v_mul_f32 v81, v221, v221
v_mul_f32 v82, v222, v222
v_mul_f32 v83, v223, v223
v_fma_f32 v76, v76, v69, v68
v_fma_f32 v77, v77, v69, v68
v_fma_f32 v78, v78, v69, v68
v_fma_f32 v79, v79, v69, v68
v_fma_f32 v80, v80, v73, v72
v_fma_f32 v81, v81, v73, v72
v_fma_f32 v82, v82, v73, v72
v_fma_f32 v83, v83, v73, v72
v_mul_f32 v76, v76, v188
v_mul_f32 v77, v77, v189
v_mul_f32 v78, v78, v190
v_mul_f32 v79, v79, v191
v_mul_f32 v80, v80, v220
v_mul_f32 v81, v81, v221
v_mul_f32 v82, v82, v222
v_mul_f32 v83, v83, v223
v_exp_f32 v76, v76
v_exp_f32 v77, v77
v_exp_f32 v78, v78
v_exp_f32 v79, v79
s_add_u32 m0, s39, 33792
s_add_u32 s38, s53, 5111808
buffer_load_dwordx4 v24, s[28:31], s38 offen lds
v_exp_f32 v80, v80
v_exp_f32 v81, v81
v_exp_f32 v82, v82
v_exp_f32 v83, v83
v_fma_f32 v204, -v64, v44, v204
v_fma_f32 v205, -v64, v45, v205
v_fma_f32 v206, -v64, v46, v206
v_fma_f32 v207, -v64, v47, v207
v_fma_f32 v236, -v66, v44, v236
v_fma_f32 v237, -v66, v45, v237
v_fma_f32 v238, -v66, v46, v238
v_fma_f32 v239, -v66, v47, v239
v_fma_f32 v76, v76, v70, v70
v_fma_f32 v77, v77, v70, v70
v_fma_f32 v78, v78, v70, v70
v_fma_f32 v79, v79, v70, v70
v_fma_f32 v80, v80, v74, v74
v_fma_f32 v81, v81, v74, v74
v_fma_f32 v82, v82, v74, v74
v_fma_f32 v83, v83, v74, v74
v_rcp_f32 v76, v76
v_rcp_f32 v77, v77
v_rcp_f32 v78, v78
v_rcp_f32 v79, v79
s_add_u32 m0, s39, 34816
s_add_u32 s38, s53, 5128192
buffer_load_dwordx4 v23, s[28:31], s38 offen lds
s_add_u32 m0, s39, 35840
s_add_u32 s38, s53, 5128192
buffer_load_dwordx4 v24, s[28:31], s38 offen lds
s_waitcnt vmcnt(28)
s_barrier
s_add_u32 m0, s39, 49152
s_add_u32 s37, s52, 655360
buffer_load_dwordx4 v3, s[24:27], s37 offen sc1 lds
v_rcp_f32 v80, v80
v_rcp_f32 v81, v81
v_rcp_f32 v82, v82
v_rcp_f32 v83, v83
v_mul_f32 v204, v188, v204
v_mul_f32 v205, v189, v205
v_mul_f32 v206, v190, v206
v_mul_f32 v207, v191, v207
v_mul_f32 v236, v220, v236
v_mul_f32 v237, v221, v237
v_mul_f32 v238, v222, v238
v_mul_f32 v239, v223, v239
v_mul_f32 v204, v204, v76
v_mul_f32 v205, v205, v77
v_mul_f32 v206, v206, v78
v_mul_f32 v207, v207, v79
v_mul_f32 v236, v236, v80
v_mul_f32 v237, v237, v81
v_mul_f32 v238, v238, v82
v_mul_f32 v239, v239, v83
v_cvt_pk_bf16_f32 v188, v204, v205
v_cvt_pk_bf16_f32 v189, v206, v207
v_cvt_pk_bf16_f32 v220, v236, v237
buffer_load_dwordx4 v3, s[24:27], s37 offen offset:1024 sc1 lds
v_cvt_pk_bf16_f32 v221, v238, v239
v_fma_f32 v192, -v64, v32, v192
v_fma_f32 v193, -v64, v33, v193
v_fma_f32 v194, -v64, v34, v194
v_fma_f32 v195, -v64, v35, v195
v_fma_f32 v224, -v66, v32, v224
v_fma_f32 v225, -v66, v33, v225
v_fma_f32 v226, -v66, v34, v226
v_fma_f32 v227, -v66, v35, v227
v_mul_f32 v76, v192, v192
v_mul_f32 v77, v193, v193
v_mul_f32 v78, v194, v194
v_mul_f32 v79, v195, v195
v_mul_f32 v80, v224, v224
v_mul_f32 v81, v225, v225
v_mul_f32 v82, v226, v226
v_mul_f32 v83, v227, v227
v_fma_f32 v76, v76, v69, v68
v_fma_f32 v77, v77, v69, v68
v_fma_f32 v78, v78, v69, v68
v_fma_f32 v79, v79, v69, v68
v_fma_f32 v80, v80, v73, v72
v_fma_f32 v81, v81, v73, v72
buffer_load_dwordx4 v3, s[24:27], s37 offen offset:2048 sc1 lds
v_fma_f32 v82, v82, v73, v72
v_fma_f32 v83, v83, v73, v72
v_mul_f32 v76, v76, v192
v_mul_f32 v77, v77, v193
v_mul_f32 v78, v78, v194
v_mul_f32 v79, v79, v195
v_mul_f32 v80, v80, v224
v_mul_f32 v81, v81, v225
v_mul_f32 v82, v82, v226
v_mul_f32 v83, v83, v227
v_exp_f32 v76, v76
v_exp_f32 v77, v77
v_exp_f32 v78, v78
v_exp_f32 v79, v79
v_exp_f32 v80, v80
v_exp_f32 v81, v81
v_exp_f32 v82, v82
v_exp_f32 v83, v83
v_fma_f32 v208, -v64, v48, v208
v_fma_f32 v209, -v64, v49, v209
v_fma_f32 v210, -v64, v50, v210
v_fma_f32 v211, -v64, v51, v211
v_fma_f32 v240, -v66, v48, v240
v_fma_f32 v241, -v66, v49, v241
buffer_load_dwordx4 v3, s[24:27], s37 offen offset:3072 sc1 lds
s_branch Lov_16
.p2align 12
Lst_16_0:
s_branch Lwr_164
s_nop 0
s_nop 0
Lov_16:
v_fma_f32 v242, -v66, v50, v242
v_fma_f32 v243, -v66, v51, v243
v_fma_f32 v76, v76, v70, v70
v_fma_f32 v77, v77, v70, v70
v_fma_f32 v78, v78, v70, v70
v_fma_f32 v79, v79, v70, v70
v_fma_f32 v80, v80, v74, v74
v_fma_f32 v81, v81, v74, v74
v_fma_f32 v82, v82, v74, v74
v_fma_f32 v83, v83, v74, v74
v_rcp_f32 v76, v76
v_rcp_f32 v77, v77
v_rcp_f32 v78, v78
v_rcp_f32 v79, v79
v_rcp_f32 v80, v80
v_rcp_f32 v81, v81
v_rcp_f32 v82, v82
v_rcp_f32 v83, v83
v_mul_f32 v208, v192, v208
v_mul_f32 v209, v193, v209
v_mul_f32 v210, v194, v210
v_mul_f32 v211, v195, v211
v_mul_f32 v240, v224, v240
s_add_u32 m0, s39, 65536
s_add_u32 s38, s53, 5242880
buffer_load_dwordx4 v23, s[28:31], s38 offen lds
v_mul_f32 v241, v225, v241
v_mul_f32 v242, v226, v242
v_mul_f32 v243, v227, v243
v_mul_f32 v208, v208, v76
v_mul_f32 v209, v209, v77
v_mul_f32 v210, v210, v78
v_mul_f32 v211, v211, v79
v_mul_f32 v240, v240, v80
v_mul_f32 v241, v241, v81
v_mul_f32 v242, v242, v82
v_mul_f32 v243, v243, v83
v_cvt_pk_bf16_f32 v190, v208, v209
v_cvt_pk_bf16_f32 v191, v210, v211
v_cvt_pk_bf16_f32 v222, v240, v241
v_cvt_pk_bf16_f32 v223, v242, v243
buffer_store_dwordx4 v[188:191], v2, s[24:27], s54 offen offset:2048 sc1
buffer_store_dwordx4 v[220:223], v2, s[24:27], s54 offen offset:3072 sc1
v_fma_f32 v196, -v64, v36, v196
v_fma_f32 v197, -v64, v37, v197
v_fma_f32 v198, -v64, v38, v198
v_fma_f32 v199, -v64, v39, v199
v_fma_f32 v228, -v66, v36, v228
v_fma_f32 v229, -v66, v37, v229
s_add_u32 m0, s39, 66560
s_add_u32 s38, s53, 5242880
buffer_load_dwordx4 v24, s[28:31], s38 offen lds
v_fma_f32 v230, -v66, v38, v230
v_fma_f32 v231, -v66, v39, v231
v_mul_f32 v76, v196, v196
v_mul_f32 v77, v197, v197
v_mul_f32 v78, v198, v198
v_mul_f32 v79, v199, v199
v_mul_f32 v80, v228, v228
v_mul_f32 v81, v229, v229
v_mul_f32 v82, v230, v230
v_mul_f32 v83, v231, v231
v_fma_f32 v76, v76, v69, v68
v_fma_f32 v77, v77, v69, v68
v_fma_f32 v78, v78, v69, v68
v_fma_f32 v79, v79, v69, v68
v_fma_f32 v80, v80, v73, v72
v_fma_f32 v81, v81, v73, v72
v_fma_f32 v82, v82, v73, v72
v_fma_f32 v83, v83, v73, v72
v_mul_f32 v76, v76, v196
v_mul_f32 v77, v77, v197
v_mul_f32 v78, v78, v198
v_mul_f32 v79, v79, v199
v_mul_f32 v80, v80, v228
v_mul_f32 v81, v81, v229
s_add_u32 m0, s39, 67584
s_add_u32 s38, s53, 5259264
buffer_load_dwordx4 v23, s[28:31], s38 offen lds
s_add_u32 m0, s39, 68608
s_add_u32 s38, s53, 5259264
buffer_load_dwordx4 v24, s[28:31], s38 offen lds
s_waitcnt vmcnt(30)
s_barrier
s_add_u32 m0, s39, 81920
s_add_u32 s37, s52, 671744
buffer_load_dwordx4 v3, s[24:27], s37 offen sc1 lds
v_mul_f32 v82, v82, v230
v_mul_f32 v83, v83, v231
v_exp_f32 v76, v76
v_exp_f32 v77, v77
v_exp_f32 v78, v78
v_exp_f32 v79, v79
v_exp_f32 v80, v80
v_exp_f32 v81, v81
v_exp_f32 v82, v82
v_exp_f32 v83, v83
v_fma_f32 v212, -v64, v52, v212
v_fma_f32 v213, -v64, v53, v213
v_fma_f32 v214, -v64, v54, v214
v_fma_f32 v215, -v64, v55, v215
v_fma_f32 v244, -v66, v52, v244
v_fma_f32 v245, -v66, v53, v245
v_fma_f32 v246, -v66, v54, v246
v_fma_f32 v247, -v66, v55, v247
v_fma_f32 v76, v76, v70, v70
v_fma_f32 v77, v77, v70, v70
v_fma_f32 v78, v78, v70, v70
v_fma_f32 v79, v79, v70, v70
v_fma_f32 v80, v80, v74, v74
buffer_load_dwordx4 v3, s[24:27], s37 offen offset:1024 sc1 lds
v_fma_f32 v81, v81, v74, v74
v_fma_f32 v82, v82, v74, v74
v_fma_f32 v83, v83, v74, v74
v_rcp_f32 v76, v76
v_rcp_f32 v77, v77
v_rcp_f32 v78, v78
v_rcp_f32 v79, v79
v_rcp_f32 v80, v80
v_rcp_f32 v81, v81
v_rcp_f32 v82, v82
v_rcp_f32 v83, v83
v_mul_f32 v212, v196, v212
v_mul_f32 v213, v197, v213
v_mul_f32 v214, v198, v214
v_mul_f32 v215, v199, v215
v_mul_f32 v244, v228, v244
v_mul_f32 v245, v229, v245
v_mul_f32 v246, v230, v246
v_mul_f32 v247, v231, v247
v_mul_f32 v212, v212, v76
v_mul_f32 v213, v213, v77
v_mul_f32 v214, v214, v78
v_mul_f32 v215, v215, v79
buffer_load_dwordx4 v3, s[24:27], s37 offen offset:2048 sc1 lds
v_mul_f32 v244, v244, v80
v_mul_f32 v245, v245, v81
v_mul_f32 v246, v246, v82
v_mul_f32 v247, v247, v83
v_cvt_pk_bf16_f32 v196, v212, v213
v_cvt_pk_bf16_f32 v197, v214, v215
v_cvt_pk_bf16_f32 v228, v244, v245
v_cvt_pk_bf16_f32 v229, v246, v247
v_fma_f32 v200, -v64, v40, v200
v_fma_f32 v201, -v64, v41, v201
v_fma_f32 v202, -v64, v42, v202
v_fma_f32 v203, -v64, v43, v203
v_fma_f32 v232, -v66, v40, v232
v_fma_f32 v233, -v66, v41, v233
v_fma_f32 v234, -v66, v42, v234
v_fma_f32 v235, -v66, v43, v235
v_mul_f32 v76, v200, v200
v_mul_f32 v77, v201, v201
v_mul_f32 v78, v202, v202
v_mul_f32 v79, v203, v203
v_mul_f32 v80, v232, v232
v_mul_f32 v81, v233, v233
v_mul_f32 v82, v234, v234
v_mul_f32 v83, v235, v235
buffer_load_dwordx4 v3, s[24:27], s37 offen offset:3072 sc1 lds
v_fma_f32 v76, v76, v69, v68
v_fma_f32 v77, v77, v69, v68
v_fma_f32 v78, v78, v69, v68
v_fma_f32 v79, v79, v69, v68
v_fma_f32 v80, v80, v73, v72
v_fma_f32 v81, v81, v73, v72
v_fma_f32 v82, v82, v73, v72
v_fma_f32 v83, v83, v73, v72
v_mul_f32 v76, v76, v200
v_mul_f32 v77, v77, v201
v_mul_f32 v78, v78, v202
v_mul_f32 v79, v79, v203
v_mul_f32 v80, v80, v232
v_mul_f32 v81, v81, v233
v_mul_f32 v82, v82, v234
v_mul_f32 v83, v83, v235
v_exp_f32 v76, v76
v_exp_f32 v77, v77
v_exp_f32 v78, v78
v_exp_f32 v79, v79
v_exp_f32 v80, v80
v_exp_f32 v81, v81
v_exp_f32 v82, v82
s_add_u32 m0, s39, 147456
s_add_u32 s38, s53, 5373952
buffer_load_dwordx4 v23, s[28:31], s38 offen lds
v_exp_f32 v83, v83
v_fma_f32 v216, -v64, v56, v216
v_fma_f32 v217, -v64, v57, v217
v_fma_f32 v218, -v64, v58, v218
v_fma_f32 v219, -v64, v59, v219
v_fma_f32 v248, -v66, v56, v248
v_fma_f32 v249, -v66, v57, v249
v_fma_f32 v250, -v66, v58, v250
v_fma_f32 v251, -v66, v59, v251
v_fma_f32 v76, v76, v70, v70
v_fma_f32 v77, v77, v70, v70
v_fma_f32 v78, v78, v70, v70
v_fma_f32 v79, v79, v70, v70
v_fma_f32 v80, v80, v74, v74
v_fma_f32 v81, v81, v74, v74
v_fma_f32 v82, v82, v74, v74
v_fma_f32 v83, v83, v74, v74
v_rcp_f32 v76, v76
v_rcp_f32 v77, v77
v_rcp_f32 v78, v78
v_rcp_f32 v79, v79
v_rcp_f32 v80, v80
v_rcp_f32 v81, v81
s_add_u32 m0, s39, 148480
s_add_u32 s38, s53, 5373952
buffer_load_dwordx4 v24, s[28:31], s38 offen lds
v_rcp_f32 v82, v82
v_rcp_f32 v83, v83
v_mul_f32 v216, v200, v216
v_mul_f32 v217, v201, v217
v_mul_f32 v218, v202, v218
v_mul_f32 v219, v203, v219
v_mul_f32 v248, v232, v248
v_mul_f32 v249, v233, v249
v_mul_f32 v250, v234, v250
v_mul_f32 v251, v235, v251
v_mul_f32 v216, v216, v76
v_mul_f32 v217, v217, v77
v_mul_f32 v218, v218, v78
v_mul_f32 v219, v219, v79
v_mul_f32 v248, v248, v80
v_mul_f32 v249, v249, v81
v_mul_f32 v250, v250, v82
v_mul_f32 v251, v251, v83
v_cvt_pk_bf16_f32 v198, v216, v217
v_cvt_pk_bf16_f32 v199, v218, v219
v_cvt_pk_bf16_f32 v230, v248, v249
v_cvt_pk_bf16_f32 v231, v250, v251
buffer_store_dwordx4 v[196:199], v2, s[24:27], s55 offen offset:2048 sc1
buffer_store_dwordx4 v[228:231], v2, s[24:27], s55 offen offset:3072 sc1
s_add_u32 m0, s39, 149504
s_add_u32 s38, s53, 5390336
buffer_load_dwordx4 v23, s[28:31], s38 offen lds
s_add_u32 m0, s39, 150528
s_add_u32 s38, s53, 5390336
buffer_load_dwordx4 v24, s[28:31], s38 offen lds
s_waitcnt vmcnt(30)
s_barrier
s_add_u32 m0, s39, 98304
s_add_u32 s37, s52, 688128
buffer_load_dwordx4 v3, s[24:27], s37 offen sc1 lds
buffer_load_dwordx4 v3, s[24:27], s37 offen offset:1024 sc1 lds
buffer_load_dwordx4 v3, s[24:27], s37 offen offset:2048 sc1 lds
buffer_load_dwordx4 v3, s[24:27], s37 offen offset:3072 sc1 lds
s_add_u32 m0, s39, 114688
s_add_u32 s38, s53, 5505024
buffer_load_dwordx4 v23, s[28:31], s38 offen lds
s_add_u32 m0, s39, 115712
s_add_u32 s38, s53, 5505024
buffer_load_dwordx4 v24, s[28:31], s38 offen lds
s_add_u32 m0, s39, 116736
s_add_u32 s38, s53, 5521408
buffer_load_dwordx4 v23, s[28:31], s38 offen lds
s_add_u32 m0, s39, 117760
s_add_u32 s38, s53, 5521408
buffer_load_dwordx4 v24, s[28:31], s38 offen lds
s_waitcnt vmcnt(10)
s_barrier
s_cmp_eq_u32 s47, 0
s_cbranch_scc0 Lw_128
s_add_u32 s7, s34, 48
s_lshl_b32 s7, s7, 7
v_mov_b32 v26, s7
v_mov_b32 v27, 1
s_mov_b64 exec, 1
buffer_atomic_add v27, v26, s[56:59], 0 offen sc1
s_mov_b64 exec, -1
Lw_128:
s_add_u32 m0, s39, 131072
s_add_u32 s37, s52, 704512
buffer_load_dwordx4 v3, s[24:27], s37 offen sc1 lds
buffer_load_dwordx4 v3, s[24:27], s37 offen offset:1024 sc1 lds
buffer_load_dwordx4 v3, s[24:27], s37 offen offset:2048 sc1 lds
buffer_load_dwordx4 v3, s[24:27], s37 offen offset:3072 sc1 lds
s_add_u32 m0, s39, 0
s_add_u32 s38, s53, 5636096
buffer_load_dwordx4 v23, s[28:31], s38 offen lds
s_add_u32 m0, s39, 1024
s_add_u32 s38, s53, 5636096
buffer_load_dwordx4 v24, s[28:31], s38 offen lds
s_add_u32 m0, s39, 2048
s_add_u32 s38, s53, 5652480
buffer_load_dwordx4 v23, s[28:31], s38 offen lds
s_add_u32 m0, s39, 3072
s_add_u32 s38, s53, 5652480
buffer_load_dwordx4 v24, s[28:31], s38 offen lds
s_waitcnt vmcnt(26)
s_barrier
s_add_u32 m0, s39, 32768
s_add_u32 s38, s91, 0
buffer_load_dwordx4 v23, s[28:31], s38 offen lds
s_add_u32 m0, s39, 33792
s_add_u32 s38, s91, 0
buffer_load_dwordx4 v24, s[28:31], s38 offen lds
s_add_u32 m0, s39, 34816
s_add_u32 s38, s91, 16384
buffer_load_dwordx4 v23, s[28:31], s38 offen lds
s_add_u32 m0, s39, 35840
s_add_u32 s38, s91, 16384
buffer_load_dwordx4 v24, s[28:31], s38 offen lds
s_waitcnt vmcnt(20)
s_barrier
s_add_u32 m0, s39, 65536
s_add_u32 s38, s91, 131072
buffer_load_dwordx4 v23, s[28:31], s38 offen lds
s_add_u32 m0, s39, 66560
s_add_u32 s38, s91, 131072
buffer_load_dwordx4 v24, s[28:31], s38 offen lds
s_add_u32 m0, s39, 67584
s_add_u32 s38, s91, 147456
buffer_load_dwordx4 v23, s[28:31], s38 offen lds
s_add_u32 m0, s39, 68608
s_add_u32 s38, s91, 147456
buffer_load_dwordx4 v24, s[28:31], s38 offen lds
s_waitcnt vmcnt(16)
s_barrier
s_cmp_eq_u32 s47, 3
s_cbranch_scc0 Lw_129
s_lshl_b32 s92, s34, 7
s_add_u32 s92, s92, 28317696
s_load_dword s93, s[82:83], s92 glc
Lw_129:
s_add_u32 m0, s39, 147456
s_add_u32 s38, s91, 262144
buffer_load_dwordx4 v23, s[28:31], s38 offen lds
s_add_u32 m0, s39, 148480
s_add_u32 s38, s91, 262144
buffer_load_dwordx4 v24, s[28:31], s38 offen lds
s_add_u32 m0, s39, 149504
s_add_u32 s38, s91, 278528
buffer_load_dwordx4 v23, s[28:31], s38 offen lds
s_add_u32 m0, s39, 150528
s_add_u32 s38, s91, 278528
buffer_load_dwordx4 v24, s[28:31], s38 offen lds
s_waitcnt vmcnt(12)
s_cmp_eq_u32 s47, 3
s_cbranch_scc0 Lw_130
s_mov_b32 s41, 0x40000
s_branch Lpchk_133
Lpoll_131:
s_load_dword s93, s[82:83], s92 glc
Lpchk_133:
s_waitcnt lgkmcnt(0)
s_cmp_eq_u32 s93, 16
s_cbranch_scc1 Lpok_132
s_sub_u32 s41, s41, 1
s_cmp_lg_u32 s41, 0
s_cbranch_scc1 Lpoll_131
Lpok_132:
Lw_130:
s_barrier
s_add_u32 m0, s39, 16384
s_add_u32 s37, s90, 0
buffer_load_dwordx4 v3, s[24:27], s37 offen sc1 lds
buffer_load_dwordx4 v3, s[24:27], s37 offen offset:1024 sc1 lds
buffer_load_dwordx4 v3, s[24:27], s37 offen offset:2048 sc1 lds
buffer_load_dwordx4 v3, s[24:27], s37 offen offset:3072 sc1 lds
s_add_u32 m0, s39, 49152
s_add_u32 s37, s90, 16384
buffer_load_dwordx4 v3, s[24:27], s37 offen sc1 lds
buffer_load_dwordx4 v3, s[24:27], s37 offen offset:1024 sc1 lds
buffer_load_dwordx4 v3, s[24:27], s37 offen offset:2048 sc1 lds
buffer_load_dwordx4 v3, s[24:27], s37 offen offset:3072 sc1 lds
s_add_u32 m0, s39, 81920
s_add_u32 s37, s90, 32768
buffer_load_dwordx4 v3, s[24:27], s37 offen sc1 lds
buffer_load_dwordx4 v3, s[24:27], s37 offen offset:1024 sc1 lds
buffer_load_dwordx4 v3, s[24:27], s37 offen offset:2048 sc1 lds
buffer_load_dwordx4 v3, s[24:27], s37 offen offset:3072 sc1 lds
s_add_u32 m0, s39, 98304
s_add_u32 s37, s90, 49152
buffer_load_dwordx4 v3, s[24:27], s37 offen sc1 lds
buffer_load_dwordx4 v3, s[24:27], s37 offen offset:1024 sc1 lds
buffer_load_dwordx4 v3, s[24:27], s37 offen offset:2048 sc1 lds
buffer_load_dwordx4 v3, s[24:27], s37 offen offset:3072 sc1 lds
s_add_u32 m0, s39, 114688
s_add_u32 s38, s91, 393216
buffer_load_dwordx4 v23, s[28:31], s38 offen lds
s_add_u32 m0, s39, 115712
s_add_u32 s38, s91, 393216
buffer_load_dwordx4 v24, s[28:31], s38 offen lds
s_add_u32 m0, s39, 116736
s_add_u32 s38, s91, 409600
buffer_load_dwordx4 v23, s[28:31], s38 offen lds
s_add_u32 m0, s39, 117760
s_add_u32 s38, s91, 409600
buffer_load_dwordx4 v24, s[28:31], s38 offen lds
s_waitcnt vmcnt(16)
s_barrier
s_add_u32 m0, s39, 131072
s_add_u32 s37, s90, 65536
buffer_load_dwordx4 v3, s[24:27], s37 offen sc1 lds
buffer_load_dwordx4 v3, s[24:27], s37 offen offset:1024 sc1 lds
buffer_load_dwordx4 v3, s[24:27], s37 offen offset:2048 sc1 lds
buffer_load_dwordx4 v3, s[24:27], s37 offen offset:3072 sc1 lds
s_add_u32 m0, s39, 0
s_add_u32 s38, s91, 524288
buffer_load_dwordx4 v23, s[28:31], s38 offen lds
s_add_u32 m0, s39, 1024
s_add_u32 s38, s91, 524288
buffer_load_dwordx4 v24, s[28:31], s38 offen lds
s_add_u32 m0, s39, 2048
s_add_u32 s38, s91, 540672
buffer_load_dwordx4 v23, s[28:31], s38 offen lds
s_add_u32 m0, s39, 3072
s_add_u32 s38, s91, 540672
buffer_load_dwordx4 v24, s[28:31], s38 offen lds
s_waitcnt vmcnt(20)
s_barrier
s_add_u32 m0, s39, 16384
s_add_u32 s37, s90, 81920
buffer_load_dwordx4 v3, s[24:27], s37 offen sc1 lds
buffer_load_dwordx4 v3, s[24:27], s37 offen offset:1024 sc1 lds
buffer_load_dwordx4 v3, s[24:27], s37 offen offset:2048 sc1 lds
buffer_load_dwordx4 v3, s[24:27], s37 offen offset:3072 sc1 lds
s_add_u32 m0, s39, 32768
s_add_u32 s38, s91, 655360
buffer_load_dwordx4 v23, s[28:31], s38 offen lds
s_add_u32 m0, s39, 33792
s_add_u32 s38, s91, 655360
buffer_load_dwordx4 v24, s[28:31], s38 offen lds
s_add_u32 m0, s39, 34816
s_add_u32 s38, s91, 671744
buffer_load_dwordx4 v23, s[28:31], s38 offen lds
s_add_u32 m0, s39, 35840
s_add_u32 s38, s91, 671744
buffer_load_dwordx4 v24, s[28:31], s38 offen lds
s_waitcnt vmcnt(24)
s_barrier
s_add_u32 m0, s39, 49152
s_add_u32 s37, s90, 98304
buffer_load_dwordx4 v3, s[24:27], s37 offen sc1 lds
buffer_load_dwordx4 v3, s[24:27], s37 offen offset:1024 sc1 lds
buffer_load_dwordx4 v3, s[24:27], s37 offen offset:2048 sc1 lds
buffer_load_dwordx4 v3, s[24:27], s37 offen offset:3072 sc1 lds
s_add_u32 m0, s39, 65536
s_add_u32 s38, s91, 786432
buffer_load_dwordx4 v23, s[28:31], s38 offen lds
s_add_u32 m0, s39, 66560
s_add_u32 s38, s91, 786432
buffer_load_dwordx4 v24, s[28:31], s38 offen lds
s_add_u32 m0, s39, 67584
s_add_u32 s38, s91, 802816
buffer_load_dwordx4 v23, s[28:31], s38 offen lds
s_add_u32 m0, s39, 68608
s_add_u32 s38, s91, 802816
buffer_load_dwordx4 v24, s[28:31], s38 offen lds
s_waitcnt vmcnt(24)
s_barrier
s_add_u32 m0, s39, 81920
s_add_u32 s37, s90, 114688
buffer_load_dwordx4 v3, s[24:27], s37 offen sc1 lds
buffer_load_dwordx4 v3, s[24:27], s37 offen offset:1024 sc1 lds
buffer_load_dwordx4 v3, s[24:27], s37 offen offset:2048 sc1 lds
buffer_load_dwordx4 v3, s[24:27], s37 offen offset:3072 sc1 lds
s_add_u32 m0, s39, 147456
s_add_u32 s38, s91, 917504
buffer_load_dwordx4 v23, s[28:31], s38 offen lds
s_add_u32 m0, s39, 148480
s_add_u32 s38, s91, 917504
buffer_load_dwordx4 v24, s[28:31], s38 offen lds
s_add_u32 m0, s39, 149504
s_add_u32 s38, s91, 933888
buffer_load_dwordx4 v23, s[28:31], s38 offen lds
s_add_u32 m0, s39, 150528
s_add_u32 s38, s91, 933888
buffer_load_dwordx4 v24, s[28:31], s38 offen lds
s_waitcnt vmcnt(24)
s_barrier
s_add_u32 m0, s39, 98304
s_add_u32 s37, s90, 131072
buffer_load_dwordx4 v3, s[24:27], s37 offen sc1 lds
buffer_load_dwordx4 v3, s[24:27], s37 offen offset:1024 sc1 lds
buffer_load_dwordx4 v3, s[24:27], s37 offen offset:2048 sc1 lds
buffer_load_dwordx4 v3, s[24:27], s37 offen offset:3072 sc1 lds
s_add_u32 m0, s39, 114688
s_add_u32 s38, s91, 1048576
buffer_load_dwordx4 v23, s[28:31], s38 offen lds
s_add_u32 m0, s39, 115712
s_add_u32 s38, s91, 1048576
buffer_load_dwordx4 v24, s[28:31], s38 offen lds
s_add_u32 m0, s39, 116736
s_add_u32 s38, s91, 1064960
buffer_load_dwordx4 v23, s[28:31], s38 offen lds
s_add_u32 m0, s39, 117760
s_add_u32 s38, s91, 1064960
buffer_load_dwordx4 v24, s[28:31], s38 offen lds
s_waitcnt vmcnt(24)
s_barrier
s_add_u32 m0, s39, 131072
s_add_u32 s37, s90, 147456
buffer_load_dwordx4 v3, s[24:27], s37 offen sc1 lds
buffer_load_dwordx4 v3, s[24:27], s37 offen offset:1024 sc1 lds
buffer_load_dwordx4 v3, s[24:27], s37 offen offset:2048 sc1 lds
buffer_load_dwordx4 v3, s[24:27], s37 offen offset:3072 sc1 lds
s_add_u32 m0, s39, 0
s_add_u32 s38, s91, 1179648
buffer_load_dwordx4 v23, s[28:31], s38 offen lds
s_add_u32 m0, s39, 1024
s_add_u32 s38, s91, 1179648
buffer_load_dwordx4 v24, s[28:31], s38 offen lds
s_add_u32 m0, s39, 2048
s_add_u32 s38, s91, 1196032
buffer_load_dwordx4 v23, s[28:31], s38 offen lds
s_add_u32 m0, s39, 3072
s_add_u32 s38, s91, 1196032
buffer_load_dwordx4 v24, s[28:31], s38 offen lds
s_waitcnt vmcnt(24)
s_barrier
s_add_u32 m0, s39, 16384
s_mov_b32 s37, 327680
buffer_load_dwordx4 v3, s[24:27], s37 offen sc1 lds
buffer_load_dwordx4 v3, s[24:27], s37 offen offset:1024 sc1 lds
buffer_load_dwordx4 v3, s[24:27], s37 offen offset:2048 sc1 lds
buffer_load_dwordx4 v3, s[24:27], s37 offen offset:3072 sc1 lds
s_add_u32 m0, s51, 32768
s_mov_b32 s38, 2621440
buffer_load_dwordx4 v25, s[28:31], s38 offen lds
s_add_u32 m0, s51, 33792
s_mov_b32 s38, 2637824
buffer_load_dwordx4 v25, s[28:31], s38 offen lds
s_waitcnt vmcnt(22)
s_barrier
s_add_u32 m0, s39, 49152
s_mov_b32 s37, 344064
buffer_load_dwordx4 v3, s[24:27], s37 offen sc1 lds
buffer_load_dwordx4 v3, s[24:27], s37 offen offset:1024 sc1 lds
buffer_load_dwordx4 v3, s[24:27], s37 offen offset:2048 sc1 lds
buffer_load_dwordx4 v3, s[24:27], s37 offen offset:3072 sc1 lds
s_add_u32 m0, s51, 65536
s_mov_b32 s38, 2752512
buffer_load_dwordx4 v25, s[28:31], s38 offen lds
s_add_u32 m0, s51, 66560
s_mov_b32 s38, 2768896
buffer_load_dwordx4 v25, s[28:31], s38 offen lds
s_waitcnt vmcnt(20)
s_barrier
s_add_u32 m0, s39, 81920
s_mov_b32 s37, 360448
buffer_load_dwordx4 v3, s[24:27], s37 offen sc1 lds
buffer_load_dwordx4 v3, s[24:27], s37 offen offset:1024 sc1 lds
buffer_load_dwordx4 v3, s[24:27], s37 offen offset:2048 sc1 lds
buffer_load_dwordx4 v3, s[24:27], s37 offen offset:3072 sc1 lds
s_add_u32 m0, s51, 147456
s_mov_b32 s38, 2883584
buffer_load_dwordx4 v25, s[28:31], s38 offen lds
s_add_u32 m0, s51, 148480
s_mov_b32 s38, 2899968
buffer_load_dwordx4 v25, s[28:31], s38 offen lds
s_waitcnt vmcnt(18)
s_barrier
s_add_u32 m0, s39, 98304
s_mov_b32 s37, 376832
buffer_load_dwordx4 v3, s[24:27], s37 offen sc1 lds
buffer_load_dwordx4 v3, s[24:27], s37 offen offset:1024 sc1 lds
buffer_load_dwordx4 v3, s[24:27], s37 offen offset:2048 sc1 lds
buffer_load_dwordx4 v3, s[24:27], s37 offen offset:3072 sc1 lds
s_add_u32 m0, s51, 114688
s_mov_b32 s38, 3014656
buffer_load_dwordx4 v25, s[28:31], s38 offen lds
s_add_u32 m0, s51, 115712
s_mov_b32 s38, 3031040
buffer_load_dwordx4 v25, s[28:31], s38 offen lds
s_waitcnt vmcnt(18)
s_barrier
s_add_u32 m0, s39, 131072
s_mov_b32 s37, 393216
buffer_load_dwordx4 v3, s[24:27], s37 offen sc1 lds
buffer_load_dwordx4 v3, s[24:27], s37 offen offset:1024 sc1 lds
buffer_load_dwordx4 v3, s[24:27], s37 offen offset:2048 sc1 lds
buffer_load_dwordx4 v3, s[24:27], s37 offen offset:3072 sc1 lds
s_add_u32 m0, s51, 0
s_mov_b32 s38, 3145728
buffer_load_dwordx4 v25, s[28:31], s38 offen lds
s_add_u32 m0, s51, 1024
s_mov_b32 s38, 3162112
buffer_load_dwordx4 v25, s[28:31], s38 offen lds
s_waitcnt vmcnt(18)
s_barrier
s_add_u32 m0, s39, 16384
s_mov_b32 s37, 409600
buffer_load_dwordx4 v3, s[24:27], s37 offen sc1 lds
buffer_load_dwordx4 v3, s[24:27], s37 offen offset:1024 sc1 lds
buffer_load_dwordx4 v3, s[24:27], s37 offen offset:2048 sc1 lds
buffer_load_dwordx4 v3, s[24:27], s37 offen offset:3072 sc1 lds
s_add_u32 m0, s51, 32768
s_mov_b32 s38, 3276800
buffer_load_dwordx4 v25, s[28:31], s38 offen lds
s_add_u32 m0, s51, 33792
s_mov_b32 s38, 3293184
buffer_load_dwordx4 v25, s[28:31], s38 offen lds
s_waitcnt vmcnt(18)
s_barrier
s_add_u32 m0, s39, 49152
s_mov_b32 s37, 425984
buffer_load_dwordx4 v3, s[24:27], s37 offen sc1 lds
buffer_load_dwordx4 v3, s[24:27], s37 offen offset:1024 sc1 lds
buffer_load_dwordx4 v3, s[24:27], s37 offen offset:2048 sc1 lds
buffer_load_dwordx4 v3, s[24:27], s37 offen offset:3072 sc1 lds
s_add_u32 m0, s51, 65536
s_mov_b32 s38, 3407872
buffer_load_dwordx4 v25, s[28:31], s38 offen lds
s_add_u32 m0, s51, 66560
s_branch Lov_17
.p2align 12
Lst_17_0:
s_branch Lwr_165
s_nop 0
s_nop 0
Lov_17:
s_mov_b32 s38, 3424256
buffer_load_dwordx4 v25, s[28:31], s38 offen lds
s_waitcnt vmcnt(18)
s_barrier
s_add_u32 m0, s39, 81920
s_mov_b32 s37, 442368
buffer_load_dwordx4 v3, s[24:27], s37 offen sc1 lds
buffer_load_dwordx4 v3, s[24:27], s37 offen offset:1024 sc1 lds
buffer_load_dwordx4 v3, s[24:27], s37 offen offset:2048 sc1 lds
buffer_load_dwordx4 v3, s[24:27], s37 offen offset:3072 sc1 lds
s_add_u32 m0, s51, 147456
s_mov_b32 s38, 3538944
buffer_load_dwordx4 v25, s[28:31], s38 offen lds
s_add_u32 m0, s51, 148480
s_mov_b32 s38, 3555328
buffer_load_dwordx4 v25, s[28:31], s38 offen lds
s_waitcnt vmcnt(18)
s_barrier
s_add_u32 m0, s39, 98304
s_mov_b32 s37, 458752
buffer_load_dwordx4 v3, s[24:27], s37 offen sc1 lds
buffer_load_dwordx4 v3, s[24:27], s37 offen offset:1024 sc1 lds
buffer_load_dwordx4 v3, s[24:27], s37 offen offset:2048 sc1 lds
buffer_load_dwordx4 v3, s[24:27], s37 offen offset:3072 sc1 lds
s_add_u32 m0, s51, 114688
s_mov_b32 s38, 3670016
buffer_load_dwordx4 v25, s[28:31], s38 offen lds
s_add_u32 m0, s51, 115712
s_mov_b32 s38, 3686400
buffer_load_dwordx4 v25, s[28:31], s38 offen lds
s_waitcnt vmcnt(18)
s_barrier
s_add_u32 m0, s39, 131072
s_mov_b32 s37, 475136
buffer_load_dwordx4 v3, s[24:27], s37 offen sc1 lds
buffer_load_dwordx4 v3, s[24:27], s37 offen offset:1024 sc1 lds
buffer_load_dwordx4 v3, s[24:27], s37 offen offset:2048 sc1 lds
buffer_load_dwordx4 v3, s[24:27], s37 offen offset:3072 sc1 lds
s_add_u32 m0, s51, 0
s_mov_b32 s38, 3801088
buffer_load_dwordx4 v25, s[28:31], s38 offen lds
s_add_u32 m0, s51, 1024
s_mov_b32 s38, 3817472
buffer_load_dwordx4 v25, s[28:31], s38 offen lds
s_waitcnt vmcnt(18)
s_barrier
s_cmp_eq_u32 s47, 0
s_cbranch_scc0 Lw_134
s_xor_b32 s43, s2, 2
s_add_u32 s43, s43, 128
s_lshl_b32 s43, s43, 7
v_mov_b32 v26, s43
v_mov_b32 v27, 1
s_mov_b64 exec, 1
buffer_store_dword v27, v26, s[56:59], 0 offen sc1
s_mov_b64 exec, -1
Lw_134:
s_add_u32 m0, s39, 16384
s_mov_b32 s37, 491520
buffer_load_dwordx4 v3, s[24:27], s37 offen sc1 lds
buffer_load_dwordx4 v3, s[24:27], s37 offen offset:1024 sc1 lds
buffer_load_dwordx4 v3, s[24:27], s37 offen offset:2048 sc1 lds
buffer_load_dwordx4 v3, s[24:27], s37 offen offset:3072 sc1 lds
s_add_u32 m0, s51, 32768
s_mov_b32 s38, 3932160
buffer_load_dwordx4 v25, s[28:31], s38 offen lds
s_add_u32 m0, s51, 33792
s_mov_b32 s38, 3948544
buffer_load_dwordx4 v25, s[28:31], s38 offen lds
s_waitcnt vmcnt(18)
s_barrier
s_add_u32 m0, s39, 49152
s_mov_b32 s37, 507904
buffer_load_dwordx4 v3, s[24:27], s37 offen sc1 lds
buffer_load_dwordx4 v3, s[24:27], s37 offen offset:1024 sc1 lds
buffer_load_dwordx4 v3, s[24:27], s37 offen offset:2048 sc1 lds
buffer_load_dwordx4 v3, s[24:27], s37 offen offset:3072 sc1 lds
s_add_u32 m0, s51, 65536
s_mov_b32 s38, 4063232
buffer_load_dwordx4 v25, s[28:31], s38 offen lds
s_add_u32 m0, s51, 66560
s_mov_b32 s38, 4079616
buffer_load_dwordx4 v25, s[28:31], s38 offen lds
s_waitcnt vmcnt(18)
s_barrier
s_cmp_eq_u32 s47, 3
s_cbranch_scc0 Lw_135
s_lshl_b32 s92, s2, 7
s_add_u32 s92, s92, 28327936
s_load_dword s93, s[82:83], s92 glc
Lw_135:
s_waitcnt vmcnt(12)
s_cmp_eq_u32 s47, 3
s_cbranch_scc0 Lw_136
s_mov_b32 s41, 0x40000
s_branch Lpchk_139
Lpoll_137:
s_load_dword s93, s[82:83], s92 glc
Lpchk_139:
s_waitcnt lgkmcnt(0)
s_cmp_eq_u32 s93, 1
s_cbranch_scc1 Lpok_138
s_sub_u32 s41, s41, 1
s_cmp_lg_u32 s41, 0
s_cbranch_scc1 Lpoll_137
Lpok_138:
Lw_136:
s_barrier
s_waitcnt vmcnt(6)
s_barrier
s_waitcnt vmcnt(0)
s_barrier
s_barrier
s_branch Ldone_1
Ldone_1:
Lfin:
Lexit_2:
s_endpgm
.section .rodata,"a"
.p2align 6
.amdhsa_kernel sequential_preLN__sliding_local_dilated__glu_gated_geglu__prompt_kernel
  .amdhsa_next_free_vgpr 256
  .amdhsa_next_free_sgpr 100
  .amdhsa_accum_offset 256
  .amdhsa_group_segment_fixed_size 0
  .amdhsa_kernarg_size 80
  .amdhsa_user_sgpr_count 2
  .amdhsa_user_sgpr_kernarg_segment_ptr 1
  .amdhsa_system_sgpr_workgroup_id_x 1
  .amdhsa_float_denorm_mode_32 3
  .amdhsa_float_denorm_mode_16_64 3
.end_amdhsa_kernel
```

```asm
; @launch grid=(256,1,1) block=(512,1,1) lds=163840
.amdgcn_target "amdgcn-amd-amdhsa--gfx950"
.text
.globl sequential_preLN__sliding_local_dilated__glu_gated_geglu__prompt_kernel
.p2align 8
.type sequential_preLN__sliding_local_dilated__glu_gated_geglu__prompt_kernel,@function
sequential_preLN__sliding_local_dilated__glu_gated_geglu__prompt_kernel:
s_cmp_ge_u32 s2, 256
s_cbranch_scc1 Lexit_2
s_load_dwordx16 s[64:79], s[0:1], 0
s_load_dwordx4 s[80:83], s[0:1], 64
s_and_b32 s3, s2, 7
s_lshr_b32 s42, s2, 3
s_and_b32 s34, s3, 1
s_lshl_b32 s34, s34, 3
s_and_b32 s48, s42, 7
s_add_u32 s34, s34, s48
s_lshr_b32 s35, s3, 1
s_lshr_b32 s49, s42, 3
s_lshl_b32 s35, s35, 2
s_add_u32 s35, s35, s49
v_lshrrev_b32 v12, 6, v0
v_and_b32 v1, 63, v0
v_readfirstlane_b32 s36, v12
Lbeg:
s_lshl_b32 s50, s34, 7
s_sub_u32 s50, s50, 16
v_and_b32 v12, 15, v1
v_lshrrev_b32 v13, 4, v1
s_cmp_lt_u32 s36, 4
s_cbranch_scc1 Lcons_7
Lprod_3:
s_sub_u32 s47, s36, 4
s_lshl_b32 s43, s34, 7
s_lshl_b32 s44, s35, 3
s_add_u32 s63, s43, s44
s_lshl_b32 s44, s47, 1
s_add_u32 s51, s63, s44
v_lshlrev_b32 v10, 4, v1
v_lshrrev_b32 v14, 3, v1
v_and_b32 v15, 7, v1
v_lshl_add_u32 v19, v14, 6, v15
s_lshl_b32 s43, s48, 3
v_add_u32 v19, s43, v19
v_mul_u32_u24 v19, 6144, v19
s_cmp_eq_u32 s47, 3
s_cbranch_scc1 Lpf_4
v_and_b32 v16, 2, v14
v_xor_b32 v16, v15, v16
v_lshlrev_b32 v16, 4, v16
v_mul_u32_u24 v17, 6144, v14
s_lshl_b32 s43, s47, 11
v_add3_u32 v2, v17, v16, s43
v_xor_b32 v3, 64, v2
v_lshrrev_b32 v16, 1, v14
v_xor_b32 v16, v15, v16
v_lshlrev_b32 v16, 4, v16
s_lshl_b32 s43, s47, 3
s_add_u32 s43, s43, s50
v_add_u32 v17, s43, v14
s_and_b32 s44, s47, 1
s_lshl_b32 s44, s44, 6
v_add_u32 v18, 0, v17
v_max_i32 v18, 0, v18
v_lshl_add_u32 v18, v18, 11, v16
v_xor_b32 v18, s44, v18
v_mov_b32 v4, v18
v_add_u32 v18, 24, v17
v_max_i32 v18, 0, v18
v_lshl_add_u32 v18, v18, 11, v16
v_xor_b32 v18, s44, v18
v_xor_b32 v5, 64, v18
v_add_u32 v18, 48, v17
v_max_i32 v18, 0, v18
v_lshl_add_u32 v18, v18, 11, v16
v_xor_b32 v18, s44, v18
v_mov_b32 v6, v18
v_add_u32 v18, 72, v17
v_max_i32 v18, 0, v18
v_lshl_add_u32 v18, v18, 11, v16
v_xor_b32 v18, s44, v18
v_xor_b32 v7, 64, v18
v_add_u32 v18, 96, v17
v_max_i32 v18, 0, v18
v_lshl_add_u32 v18, v18, 11, v16
v_xor_b32 v18, s44, v18
v_mov_b32 v8, v18
v_add_u32 v18, 120, v17
v_max_i32 v18, 0, v18
v_lshl_add_u32 v18, v18, 11, v16
v_xor_b32 v18, s44, v18
v_xor_b32 v9, 64, v18
s_lshl_b32 s39, s47, 10
s_lshl_b32 s40, s47, 13
s_add_u32 s40, s40, 18432
s_mov_b32 s37, 0
s_mov_b32 s38, 0
s_bfm_b64 s[60:61], 56, 8
s_cmp_eq_u32 s47, 0
s_cselect_b64 s[60:61], s[60:61], -1
s_lshl_b32 s43, s35, 7
s_waitcnt lgkmcnt(0)
s_mov_b32 s8, s64
s_mov_b32 s9, s65
s_mov_b32 s10, 4194304
s_mov_b32 s11, 0x20000
s_add_u32 s12, s66, s43
s_addc_u32 s13, s67, 0
s_mov_b32 s14, 6289536
s_mov_b32 s15, 0x20000
s_add_u32 m0, s39, 0
s_mov_b64 exec, s[60:61]
buffer_load_dwordx4 v4, s[8:11], s37 offen lds
s_mov_b64 exec, -1
s_add_u32 m0, s39, 3072
s_nop 0
buffer_load_dwordx4 v5, s[8:11], s37 offen lds
s_add_u32 m0, s39, 6144
s_nop 0
buffer_load_dwordx4 v6, s[8:11], s37 offen lds
s_add_u32 m0, s39, 9216
s_nop 0
buffer_load_dwordx4 v7, s[8:11], s37 offen lds
s_add_u32 m0, s39, 12288
s_nop 0
buffer_load_dwordx4 v8, s[8:11], s37 offen lds
s_add_u32 m0, s39, 15360
s_nop 0
buffer_load_dwordx4 v9, s[8:11], s37 offen lds
s_add_u32 m0, s40, 0
s_add_u32 s43, s38, 0
buffer_load_dwordx4 v2, s[12:15], s43 offen lds
s_add_u32 m0, s40, 1024
s_add_u32 s43, s38, 49152
buffer_load_dwordx4 v3, s[12:15], s43 offen lds
s_add_u32 m0, s40, 2048
s_add_u32 s43, s38, 98304
buffer_load_dwordx4 v2, s[12:15], s43 offen lds
s_add_u32 m0, s40, 3072
s_add_u32 s43, s38, 147456
buffer_load_dwordx4 v3, s[12:15], s43 offen lds
s_add_u32 m0, s40, 4096
s_add_u32 s43, s38, 196608
buffer_load_dwordx4 v2, s[12:15], s43 offen lds
s_add_u32 m0, s40, 5120
s_add_u32 s43, s38, 245760
buffer_load_dwordx4 v3, s[12:15], s43 offen lds
s_add_u32 m0, s40, 6144
s_add_u32 s43, s38, 294912
buffer_load_dwordx4 v2, s[12:15], s43 offen lds
s_add_u32 m0, s40, 7168
s_add_u32 s43, s38, 344064
buffer_load_dwordx4 v3, s[12:15], s43 offen lds
s_add_u32 s37, s37, 128
s_add_u32 s38, s38, 393216
s_mov_b32 s28, s66
s_mov_b32 s29, s67
s_mov_b32 s30, 6291456
s_mov_b32 s31, 0x20000
s_mul_i32 s43, s2, 4608
s_add_u32 s43, s43, 393216
v_lshlrev_b32 v30, 7, v1
s_mul_i32 s44, s47, 1536
s_add_u32 s43, s43, s44
s_bfm_b64 exec, 12, 0
buffer_load_dword v31, v30, s[28:31], s43 offen
s_mov_b64 exec, -1
s_lshl_b32 s43, s51, 11
buffer_load_dwordx4 v[96:99], v10, s[8:11], s43 offen offset:0
buffer_load_dwordx4 v[100:103], v10, s[8:11], s43 offen offset:1024
buffer_load_dwordx4 v[104:107], v10, s[8:11], s43 offen offset:2048
buffer_load_dwordx4 v[108:111], v10, s[8:11], s43 offen offset:3072
s_add_u32 m0, s39, 43008
s_mov_b64 exec, s[60:61]
buffer_load_dwordx4 v4, s[8:11], s37 offen lds
s_mov_b64 exec, -1
s_add_u32 m0, s39, 46080
s_nop 0
buffer_load_dwordx4 v5, s[8:11], s37 offen lds
s_add_u32 m0, s39, 49152
s_nop 0
buffer_load_dwordx4 v6, s[8:11], s37 offen lds
s_add_u32 m0, s39, 52224
s_nop 0
buffer_load_dwordx4 v7, s[8:11], s37 offen lds
s_add_u32 m0, s39, 55296
s_nop 0
buffer_load_dwordx4 v8, s[8:11], s37 offen lds
s_add_u32 m0, s39, 58368
s_nop 0
buffer_load_dwordx4 v9, s[8:11], s37 offen lds
s_add_u32 m0, s40, 43008
s_add_u32 s43, s38, 0
buffer_load_dwordx4 v2, s[12:15], s43 offen lds
s_add_u32 m0, s40, 44032
s_add_u32 s43, s38, 49152
buffer_load_dwordx4 v3, s[12:15], s43 offen lds
s_add_u32 m0, s40, 45056
s_add_u32 s43, s38, 98304
buffer_load_dwordx4 v2, s[12:15], s43 offen lds
s_add_u32 m0, s40, 46080
s_add_u32 s43, s38, 147456
buffer_load_dwordx4 v3, s[12:15], s43 offen lds
s_add_u32 m0, s40, 47104
s_add_u32 s43, s38, 196608
buffer_load_dwordx4 v2, s[12:15], s43 offen lds
s_add_u32 m0, s40, 48128
s_add_u32 s43, s38, 245760
buffer_load_dwordx4 v3, s[12:15], s43 offen lds
s_add_u32 m0, s40, 49152
s_add_u32 s43, s38, 294912
buffer_load_dwordx4 v2, s[12:15], s43 offen lds
s_add_u32 m0, s40, 50176
s_add_u32 s43, s38, 344064
buffer_load_dwordx4 v3, s[12:15], s43 offen lds
s_add_u32 s37, s37, 128
s_add_u32 s38, s38, 393216
s_waitcnt vmcnt(19)
s_barrier
s_add_u32 m0, s39, 86016
s_mov_b64 exec, s[60:61]
buffer_load_dwordx4 v4, s[8:11], s37 offen lds
s_mov_b64 exec, -1
s_add_u32 m0, s39, 89088
s_nop 0
buffer_load_dwordx4 v5, s[8:11], s37 offen lds
s_add_u32 m0, s39, 92160
s_nop 0
buffer_load_dwordx4 v6, s[8:11], s37 offen lds
s_add_u32 m0, s39, 95232
s_nop 0
buffer_load_dwordx4 v7, s[8:11], s37 offen lds
s_add_u32 m0, s39, 98304
s_nop 0
buffer_load_dwordx4 v8, s[8:11], s37 offen lds
s_add_u32 m0, s39, 101376
s_nop 0
buffer_load_dwordx4 v9, s[8:11], s37 offen lds
s_add_u32 m0, s40, 86016
s_add_u32 s43, s38, 0
buffer_load_dwordx4 v2, s[12:15], s43 offen lds
s_add_u32 m0, s40, 87040
s_add_u32 s43, s38, 49152
buffer_load_dwordx4 v3, s[12:15], s43 offen lds
s_add_u32 m0, s40, 88064
s_add_u32 s43, s38, 98304
buffer_load_dwordx4 v2, s[12:15], s43 offen lds
s_add_u32 m0, s40, 89088
s_add_u32 s43, s38, 147456
buffer_load_dwordx4 v3, s[12:15], s43 offen lds
s_add_u32 m0, s40, 90112
s_add_u32 s43, s38, 196608
buffer_load_dwordx4 v2, s[12:15], s43 offen lds
s_add_u32 m0, s40, 91136
s_add_u32 s43, s38, 245760
buffer_load_dwordx4 v3, s[12:15], s43 offen lds
s_add_u32 m0, s40, 92160
s_add_u32 s43, s38, 294912
buffer_load_dwordx4 v2, s[12:15], s43 offen lds
s_add_u32 m0, s40, 93184
s_add_u32 s43, s38, 344064
buffer_load_dwordx4 v3, s[12:15], s43 offen lds
s_add_u32 s37, s37, 128
s_add_u32 s38, s38, 393216
s_waitcnt vmcnt(28)
s_mov_b32 s43, 0x3f803f80
v_mov_b32 v116, 0
v_mov_b32 v117, 0
v_mov_b32 v118, 0
v_mov_b32 v119, 0
v_mov_b32 v120, 0
v_mov_b32 v121, 0
v_mov_b32 v122, 0
v_mov_b32 v123, 0
v_dot2_f32_bf16 v116, v96, s43, v116
v_dot2_f32_bf16 v120, v96, v96, v120
v_dot2_f32_bf16 v118, v104, s43, v118
v_dot2_f32_bf16 v122, v104, v104, v122
v_dot2_f32_bf16 v117, v97, s43, v117
v_dot2_f32_bf16 v121, v97, v97, v121
v_dot2_f32_bf16 v119, v105, s43, v119
v_dot2_f32_bf16 v123, v105, v105, v123
v_dot2_f32_bf16 v116, v98, s43, v116
v_dot2_f32_bf16 v120, v98, v98, v120
v_dot2_f32_bf16 v118, v106, s43, v118
v_dot2_f32_bf16 v122, v106, v106, v122
v_dot2_f32_bf16 v117, v99, s43, v117
v_dot2_f32_bf16 v121, v99, v99, v121
v_dot2_f32_bf16 v119, v107, s43, v119
v_dot2_f32_bf16 v123, v107, v107, v123
v_dot2_f32_bf16 v116, v100, s43, v116
v_dot2_f32_bf16 v120, v100, v100, v120
v_dot2_f32_bf16 v118, v108, s43, v118
v_dot2_f32_bf16 v122, v108, v108, v122
v_dot2_f32_bf16 v117, v101, s43, v117
v_dot2_f32_bf16 v121, v101, v101, v121
v_dot2_f32_bf16 v119, v109, s43, v119
v_dot2_f32_bf16 v123, v109, v109, v123
v_dot2_f32_bf16 v116, v102, s43, v116
v_dot2_f32_bf16 v120, v102, v102, v120
v_dot2_f32_bf16 v118, v110, s43, v118
v_dot2_f32_bf16 v122, v110, v110, v122
v_dot2_f32_bf16 v117, v103, s43, v117
v_dot2_f32_bf16 v121, v103, v103, v121
v_dot2_f32_bf16 v119, v111, s43, v119
v_dot2_f32_bf16 v123, v111, v111, v123
s_nop 2
v_add_f32 v116, v116, v117
v_add_f32 v118, v118, v119
v_add_f32 v120, v120, v121
v_add_f32 v122, v122, v123
s_nop 1
v_permlane32_swap_b32 v116, v118
v_permlane32_swap_b32 v120, v122
v_add_f32 v116, v116, v118
v_add_f32 v120, v120, v122
s_nop 1
v_permlane16_swap_b32 v116, v120
v_add_f32 v116, v116, v120
s_nop 1
v_add_f32_dpp v116, v116, v116 row_ror:8 row_mask:0xf bank_mask:0xf
s_nop 1
v_add_f32_dpp v116, v116, v116 row_ror:4 row_mask:0xf bank_mask:0xf
s_nop 1
v_add_f32_dpp v116, v116, v116 row_ror:2 row_mask:0xf bank_mask:0xf
s_nop 1
v_add_f32_dpp v116, v116, v116 row_ror:1 row_mask:0xf bank_mask:0xf
v_mov_b32 v117, v116
s_nop 1
v_permlane16_swap_b32 v116, v117
v_mul_f32 v112, 0x3a800000, v116
v_mul_f32 v113, 0x3a800000, v117
v_fma_f32 v113, -v112, v112, v113
v_max_f32 v113, 0, v113
v_add_f32 v113, 0x3727c5ac, v113
v_rsq_f32 v113, v113
v_lshrrev_b32 v11, 5, v1
s_lshl_b32 s43, s47, 4
s_add_u32 s43, s43, 148608
v_lshl_add_u32 v11, v11, 3, s43
ds_write_b64 v11, v[112:113]
s_waitcnt lgkmcnt(0)
s_and_b32 s44, s36, 3
s_mul_i32 s44, s44, 24
s_bfe_u32 s43, s2, 0x30001
s_lshl_b32 s43, s43, 7
s_add_u32 s44, s44, s43
s_mul_i32 s44, s44, 7168
s_lshr_b32 s43, s2, 4
s_lshl_b32 s43, s43, 8
s_add_u32 s43, s43, s44
s_bitcmp0_b32 s2, 0
s_cselect_b32 s4, s72, s74
s_cselect_b32 s5, s73, s75
s_add_u32 s4, s4, s43
s_addc_u32 s5, s5, 0
s_waitcnt vmcnt(14)
s_barrier
s_add_u32 m0, s39, 0
s_mov_b64 exec, s[60:61]
buffer_load_dwordx4 v4, s[8:11], s37 offen lds
s_mov_b64 exec, -1
s_add_u32 m0, s39, 3072
s_nop 0
buffer_load_dwordx4 v5, s[8:11], s37 offen lds
s_add_u32 m0, s39, 6144
s_nop 0
buffer_load_dwordx4 v6, s[8:11], s37 offen lds
s_add_u32 m0, s39, 9216
s_nop 0
buffer_load_dwordx4 v7, s[8:11], s37 offen lds
s_add_u32 m0, s39, 12288
s_nop 0
buffer_load_dwordx4 v8, s[8:11], s37 offen lds
s_add_u32 m0, s39, 15360
s_nop 0
buffer_load_dwordx4 v9, s[8:11], s37 offen lds
s_add_u32 m0, s40, 0
s_add_u32 s43, s38, 0
buffer_load_dwordx4 v2, s[12:15], s43 offen lds
s_add_u32 m0, s40, 1024
s_add_u32 s43, s38, 49152
buffer_load_dwordx4 v3, s[12:15], s43 offen lds
s_add_u32 m0, s40, 2048
s_add_u32 s43, s38, 98304
buffer_load_dwordx4 v2, s[12:15], s43 offen lds
s_add_u32 m0, s40, 3072
s_add_u32 s43, s38, 147456
buffer_load_dwordx4 v3, s[12:15], s43 offen lds
s_add_u32 m0, s40, 4096
s_add_u32 s43, s38, 196608
buffer_load_dwordx4 v2, s[12:15], s43 offen lds
s_add_u32 m0, s40, 5120
s_add_u32 s43, s38, 245760
buffer_load_dwordx4 v3, s[12:15], s43 offen lds
s_add_u32 m0, s40, 6144
s_add_u32 s43, s38, 294912
buffer_load_dwordx4 v2, s[12:15], s43 offen lds
s_add_u32 m0, s40, 7168
s_add_u32 s43, s38, 344064
buffer_load_dwordx4 v3, s[12:15], s43 offen lds
s_add_u32 s37, s37, 128
s_add_u32 s38, s38, 393216
s_waitcnt vmcnt(14)
s_barrier
s_add_u32 m0, s39, 43008
s_mov_b64 exec, s[60:61]
buffer_load_dwordx4 v4, s[8:11], s37 offen lds
s_mov_b64 exec, -1
s_add_u32 m0, s39, 46080
s_nop 0
buffer_load_dwordx4 v5, s[8:11], s37 offen lds
s_add_u32 m0, s39, 49152
s_nop 0
buffer_load_dwordx4 v6, s[8:11], s37 offen lds
s_add_u32 m0, s39, 52224
s_nop 0
buffer_load_dwordx4 v7, s[8:11], s37 offen lds
s_add_u32 m0, s39, 55296
s_nop 0
buffer_load_dwordx4 v8, s[8:11], s37 offen lds
s_add_u32 m0, s39, 58368
s_nop 0
buffer_load_dwordx4 v9, s[8:11], s37 offen lds
s_add_u32 m0, s40, 43008
s_add_u32 s43, s38, 0
buffer_load_dwordx4 v2, s[12:15], s43 offen lds
s_add_u32 m0, s40, 44032
s_add_u32 s43, s38, 49152
buffer_load_dwordx4 v3, s[12:15], s43 offen lds
s_add_u32 m0, s40, 45056
s_add_u32 s43, s38, 98304
buffer_load_dwordx4 v2, s[12:15], s43 offen lds
s_add_u32 m0, s40, 46080
s_add_u32 s43, s38, 147456
buffer_load_dwordx4 v3, s[12:15], s43 offen lds
s_add_u32 m0, s40, 47104
s_add_u32 s43, s38, 196608
buffer_load_dwordx4 v2, s[12:15], s43 offen lds
s_add_u32 m0, s40, 48128
s_add_u32 s43, s38, 245760
buffer_load_dwordx4 v3, s[12:15], s43 offen lds
s_add_u32 m0, s40, 49152
s_add_u32 s43, s38, 294912
buffer_load_dwordx4 v2, s[12:15], s43 offen lds
s_add_u32 m0, s40, 50176
s_add_u32 s43, s38, 344064
buffer_load_dwordx4 v3, s[12:15], s43 offen lds
s_add_u32 s37, s37, 128
s_add_u32 s38, s38, 393216
s_waitcnt lgkmcnt(0)
s_load_dword s3, s[4:5], 0
s_load_dword s3, s[4:5], 64
s_load_dword s3, s[4:5], 128
s_load_dword s3, s[4:5], 192
s_load_dword s3, s[4:5], 7168
s_load_dword s3, s[4:5], 7232
s_load_dword s3, s[4:5], 7296
s_load_dword s3, s[4:5], 7360
s_load_dword s3, s[4:5], 14336
s_load_dword s3, s[4:5], 14400
s_load_dword s3, s[4:5], 14464
s_load_dword s3, s[4:5], 14528
s_load_dword s3, s[4:5], 21504
s_load_dword s3, s[4:5], 21568
s_waitcnt vmcnt(14)
s_barrier
s_add_u32 m0, s39, 86016
s_mov_b64 exec, s[60:61]
buffer_load_dwordx4 v4, s[8:11], s37 offen lds
s_mov_b64 exec, -1
s_add_u32 m0, s39, 89088
s_nop 0
buffer_load_dwordx4 v5, s[8:11], s37 offen lds
s_add_u32 m0, s39, 92160
s_nop 0
buffer_load_dwordx4 v6, s[8:11], s37 offen lds
s_add_u32 m0, s39, 95232
s_nop 0
buffer_load_dwordx4 v7, s[8:11], s37 offen lds
s_add_u32 m0, s39, 98304
s_nop 0
buffer_load_dwordx4 v8, s[8:11], s37 offen lds
s_add_u32 m0, s39, 101376
s_nop 0
buffer_load_dwordx4 v9, s[8:11], s37 offen lds
s_add_u32 m0, s40, 86016
s_add_u32 s43, s38, 0
buffer_load_dwordx4 v2, s[12:15], s43 offen lds
s_add_u32 m0, s40, 87040
s_add_u32 s43, s38, 49152
buffer_load_dwordx4 v3, s[12:15], s43 offen lds
s_add_u32 m0, s40, 88064
s_add_u32 s43, s38, 98304
buffer_load_dwordx4 v2, s[12:15], s43 offen lds
s_add_u32 m0, s40, 89088
s_add_u32 s43, s38, 147456
buffer_load_dwordx4 v3, s[12:15], s43 offen lds
s_add_u32 m0, s40, 90112
s_add_u32 s43, s38, 196608
buffer_load_dwordx4 v2, s[12:15], s43 offen lds
s_add_u32 m0, s40, 91136
s_add_u32 s43, s38, 245760
buffer_load_dwordx4 v3, s[12:15], s43 offen lds
s_add_u32 m0, s40, 92160
s_add_u32 s43, s38, 294912
buffer_load_dwordx4 v2, s[12:15], s43 offen lds
s_add_u32 m0, s40, 93184
s_add_u32 s43, s38, 344064
buffer_load_dwordx4 v3, s[12:15], s43 offen lds
s_add_u32 s37, s37, 128
s_add_u32 s38, s38, 393216
s_waitcnt vmcnt(14)
s_barrier
s_add_u32 m0, s39, 0
s_mov_b64 exec, s[60:61]
buffer_load_dwordx4 v4, s[8:11], s37 offen lds
s_mov_b64 exec, -1
s_add_u32 m0, s39, 3072
s_nop 0
buffer_load_dwordx4 v5, s[8:11], s37 offen lds
s_add_u32 m0, s39, 6144
s_nop 0
buffer_load_dwordx4 v6, s[8:11], s37 offen lds
s_add_u32 m0, s39, 9216
s_branch Lov_0
.p2align 12
Lst_0_0:
s_branch Lwr_140
s_nop 0
s_nop 0
Lov_0:
s_nop 0
buffer_load_dwordx4 v7, s[8:11], s37 offen lds
s_add_u32 m0, s39, 12288
s_nop 0
buffer_load_dwordx4 v8, s[8:11], s37 offen lds
s_add_u32 m0, s39, 15360
s_nop 0
buffer_load_dwordx4 v9, s[8:11], s37 offen lds
s_add_u32 m0, s40, 0
s_add_u32 s43, s38, 0
buffer_load_dwordx4 v2, s[12:15], s43 offen lds
s_add_u32 m0, s40, 1024
s_add_u32 s43, s38, 49152
buffer_load_dwordx4 v3, s[12:15], s43 offen lds
s_add_u32 m0, s40, 2048
s_add_u32 s43, s38, 98304
buffer_load_dwordx4 v2, s[12:15], s43 offen lds
s_add_u32 m0, s40, 3072
s_add_u32 s43, s38, 147456
buffer_load_dwordx4 v3, s[12:15], s43 offen lds
s_add_u32 m0, s40, 4096
s_add_u32 s43, s38, 196608
buffer_load_dwordx4 v2, s[12:15], s43 offen lds
s_add_u32 m0, s40, 5120
s_add_u32 s43, s38, 245760
buffer_load_dwordx4 v3, s[12:15], s43 offen lds
s_add_u32 m0, s40, 6144
s_add_u32 s43, s38, 294912
buffer_load_dwordx4 v2, s[12:15], s43 offen lds
s_add_u32 m0, s40, 7168
s_add_u32 s43, s38, 344064
buffer_load_dwordx4 v3, s[12:15], s43 offen lds
s_add_u32 s37, s37, 128
s_add_u32 s38, s38, 393216
s_waitcnt lgkmcnt(0)
s_load_dword s3, s[4:5], 21632
s_load_dword s3, s[4:5], 21696
s_load_dword s3, s[4:5], 28672
s_load_dword s3, s[4:5], 28736
s_load_dword s3, s[4:5], 28800
s_load_dword s3, s[4:5], 28864
s_load_dword s3, s[4:5], 35840
s_load_dword s3, s[4:5], 35904
s_load_dword s3, s[4:5], 35968
s_load_dword s3, s[4:5], 36032
s_load_dword s3, s[4:5], 43008
s_load_dword s3, s[4:5], 43072
s_load_dword s3, s[4:5], 43136
s_load_dword s3, s[4:5], 43200
s_waitcnt vmcnt(14)
s_barrier
s_add_u32 m0, s39, 43008
s_mov_b64 exec, s[60:61]
buffer_load_dwordx4 v4, s[8:11], s37 offen lds
s_mov_b64 exec, -1
s_add_u32 m0, s39, 46080
s_nop 0
buffer_load_dwordx4 v5, s[8:11], s37 offen lds
s_add_u32 m0, s39, 49152
s_nop 0
buffer_load_dwordx4 v6, s[8:11], s37 offen lds
s_add_u32 m0, s39, 52224
s_nop 0
buffer_load_dwordx4 v7, s[8:11], s37 offen lds
s_add_u32 m0, s39, 55296
s_nop 0
buffer_load_dwordx4 v8, s[8:11], s37 offen lds
s_add_u32 m0, s39, 58368
s_nop 0
buffer_load_dwordx4 v9, s[8:11], s37 offen lds
s_add_u32 m0, s40, 43008
s_add_u32 s43, s38, 0
buffer_load_dwordx4 v2, s[12:15], s43 offen lds
s_add_u32 m0, s40, 44032
s_add_u32 s43, s38, 49152
buffer_load_dwordx4 v3, s[12:15], s43 offen lds
s_add_u32 m0, s40, 45056
s_add_u32 s43, s38, 98304
buffer_load_dwordx4 v2, s[12:15], s43 offen lds
s_add_u32 m0, s40, 46080
s_add_u32 s43, s38, 147456
buffer_load_dwordx4 v3, s[12:15], s43 offen lds
s_add_u32 m0, s40, 47104
s_add_u32 s43, s38, 196608
buffer_load_dwordx4 v2, s[12:15], s43 offen lds
s_add_u32 m0, s40, 48128
s_add_u32 s43, s38, 245760
buffer_load_dwordx4 v3, s[12:15], s43 offen lds
s_add_u32 m0, s40, 49152
s_add_u32 s43, s38, 294912
buffer_load_dwordx4 v2, s[12:15], s43 offen lds
s_add_u32 m0, s40, 50176
s_add_u32 s43, s38, 344064
buffer_load_dwordx4 v3, s[12:15], s43 offen lds
s_add_u32 s37, s37, 128
s_add_u32 s38, s38, 393216
s_waitcnt vmcnt(14)
s_barrier
s_add_u32 m0, s39, 86016
s_mov_b64 exec, s[60:61]
buffer_load_dwordx4 v4, s[8:11], s37 offen lds
s_mov_b64 exec, -1
s_add_u32 m0, s39, 89088
s_nop 0
buffer_load_dwordx4 v5, s[8:11], s37 offen lds
s_add_u32 m0, s39, 92160
s_nop 0
buffer_load_dwordx4 v6, s[8:11], s37 offen lds
s_add_u32 m0, s39, 95232
s_nop 0
buffer_load_dwordx4 v7, s[8:11], s37 offen lds
s_add_u32 m0, s39, 98304
s_nop 0
buffer_load_dwordx4 v8, s[8:11], s37 offen lds
s_add_u32 m0, s39, 101376
s_nop 0
buffer_load_dwordx4 v9, s[8:11], s37 offen lds
s_add_u32 m0, s40, 86016
s_add_u32 s43, s38, 0
buffer_load_dwordx4 v2, s[12:15], s43 offen lds
s_add_u32 m0, s40, 87040
s_add_u32 s43, s38, 49152
buffer_load_dwordx4 v3, s[12:15], s43 offen lds
s_add_u32 m0, s40, 88064
s_add_u32 s43, s38, 98304
buffer_load_dwordx4 v2, s[12:15], s43 offen lds
s_add_u32 m0, s40, 89088
s_add_u32 s43, s38, 147456
buffer_load_dwordx4 v3, s[12:15], s43 offen lds
s_add_u32 m0, s40, 90112
s_add_u32 s43, s38, 196608
buffer_load_dwordx4 v2, s[12:15], s43 offen lds
s_add_u32 m0, s40, 91136
s_add_u32 s43, s38, 245760
buffer_load_dwordx4 v3, s[12:15], s43 offen lds
s_add_u32 m0, s40, 92160
s_add_u32 s43, s38, 294912
buffer_load_dwordx4 v2, s[12:15], s43 offen lds
s_add_u32 m0, s40, 93184
s_add_u32 s43, s38, 344064
buffer_load_dwordx4 v3, s[12:15], s43 offen lds
s_add_u32 s37, s37, 128
s_add_u32 s38, s38, 393216
s_waitcnt lgkmcnt(0)
s_load_dword s3, s[4:5], 50176
s_load_dword s3, s[4:5], 50240
s_load_dword s3, s[4:5], 50304
s_load_dword s3, s[4:5], 50368
s_load_dword s3, s[4:5], 57344
s_load_dword s3, s[4:5], 57408
s_load_dword s3, s[4:5], 57472
s_load_dword s3, s[4:5], 57536
s_load_dword s3, s[4:5], 64512
s_load_dword s3, s[4:5], 64576
s_load_dword s3, s[4:5], 64640
s_load_dword s3, s[4:5], 64704
s_load_dword s3, s[4:5], 71680
s_load_dword s3, s[4:5], 71744
s_waitcnt vmcnt(14)
s_barrier
s_add_u32 m0, s39, 0
s_mov_b64 exec, s[60:61]
buffer_load_dwordx4 v4, s[8:11], s37 offen lds
s_mov_b64 exec, -1
s_add_u32 m0, s39, 3072
s_nop 0
buffer_load_dwordx4 v5, s[8:11], s37 offen lds
s_add_u32 m0, s39, 6144
s_nop 0
buffer_load_dwordx4 v6, s[8:11], s37 offen lds
s_add_u32 m0, s39, 9216
s_nop 0
buffer_load_dwordx4 v7, s[8:11], s37 offen lds
s_add_u32 m0, s39, 12288
s_nop 0
buffer_load_dwordx4 v8, s[8:11], s37 offen lds
s_add_u32 m0, s39, 15360
s_nop 0
buffer_load_dwordx4 v9, s[8:11], s37 offen lds
s_add_u32 m0, s40, 0
s_add_u32 s43, s38, 0
buffer_load_dwordx4 v2, s[12:15], s43 offen lds
s_add_u32 m0, s40, 1024
s_add_u32 s43, s38, 49152
buffer_load_dwordx4 v3, s[12:15], s43 offen lds
s_add_u32 m0, s40, 2048
s_add_u32 s43, s38, 98304
buffer_load_dwordx4 v2, s[12:15], s43 offen lds
s_add_u32 m0, s40, 3072
s_add_u32 s43, s38, 147456
buffer_load_dwordx4 v3, s[12:15], s43 offen lds
s_add_u32 m0, s40, 4096
s_add_u32 s43, s38, 196608
buffer_load_dwordx4 v2, s[12:15], s43 offen lds
s_add_u32 m0, s40, 5120
s_add_u32 s43, s38, 245760
buffer_load_dwordx4 v3, s[12:15], s43 offen lds
s_add_u32 m0, s40, 6144
s_add_u32 s43, s38, 294912
buffer_load_dwordx4 v2, s[12:15], s43 offen lds
s_add_u32 m0, s40, 7168
s_add_u32 s43, s38, 344064
buffer_load_dwordx4 v3, s[12:15], s43 offen lds
s_add_u32 s37, s37, 128
s_add_u32 s38, s38, 393216
s_waitcnt vmcnt(14)
s_barrier
s_add_u32 m0, s39, 43008
s_mov_b64 exec, s[60:61]
buffer_load_dwordx4 v4, s[8:11], s37 offen lds
s_mov_b64 exec, -1
s_add_u32 m0, s39, 46080
s_nop 0
buffer_load_dwordx4 v5, s[8:11], s37 offen lds
s_add_u32 m0, s39, 49152
s_nop 0
buffer_load_dwordx4 v6, s[8:11], s37 offen lds
s_add_u32 m0, s39, 52224
s_nop 0
buffer_load_dwordx4 v7, s[8:11], s37 offen lds
s_add_u32 m0, s39, 55296
s_nop 0
buffer_load_dwordx4 v8, s[8:11], s37 offen lds
s_add_u32 m0, s39, 58368
s_nop 0
buffer_load_dwordx4 v9, s[8:11], s37 offen lds
s_add_u32 m0, s40, 43008
s_add_u32 s43, s38, 0
buffer_load_dwordx4 v2, s[12:15], s43 offen lds
s_add_u32 m0, s40, 44032
s_add_u32 s43, s38, 49152
buffer_load_dwordx4 v3, s[12:15], s43 offen lds
s_add_u32 m0, s40, 45056
s_add_u32 s43, s38, 98304
buffer_load_dwordx4 v2, s[12:15], s43 offen lds
s_add_u32 m0, s40, 46080
s_add_u32 s43, s38, 147456
buffer_load_dwordx4 v3, s[12:15], s43 offen lds
s_add_u32 m0, s40, 47104
s_add_u32 s43, s38, 196608
buffer_load_dwordx4 v2, s[12:15], s43 offen lds
s_add_u32 m0, s40, 48128
s_add_u32 s43, s38, 245760
buffer_load_dwordx4 v3, s[12:15], s43 offen lds
s_add_u32 m0, s40, 49152
s_add_u32 s43, s38, 294912
buffer_load_dwordx4 v2, s[12:15], s43 offen lds
s_add_u32 m0, s40, 50176
s_add_u32 s43, s38, 344064
buffer_load_dwordx4 v3, s[12:15], s43 offen lds
s_add_u32 s37, s37, 128
s_add_u32 s38, s38, 393216
s_waitcnt lgkmcnt(0)
s_load_dword s3, s[4:5], 71808
s_load_dword s3, s[4:5], 71872
s_load_dword s3, s[4:5], 78848
s_load_dword s3, s[4:5], 78912
s_load_dword s3, s[4:5], 78976
s_load_dword s3, s[4:5], 79040
s_load_dword s3, s[4:5], 86016
s_load_dword s3, s[4:5], 86080
s_load_dword s3, s[4:5], 86144
s_load_dword s3, s[4:5], 86208
s_load_dword s3, s[4:5], 93184
s_load_dword s3, s[4:5], 93248
s_load_dword s3, s[4:5], 93312
s_load_dword s3, s[4:5], 93376
s_waitcnt vmcnt(14)
s_barrier
s_add_u32 m0, s39, 86016
s_mov_b64 exec, s[60:61]
buffer_load_dwordx4 v4, s[8:11], s37 offen lds
s_mov_b64 exec, -1
s_add_u32 m0, s39, 89088
s_nop 0
buffer_load_dwordx4 v5, s[8:11], s37 offen lds
s_add_u32 m0, s39, 92160
s_nop 0
buffer_load_dwordx4 v6, s[8:11], s37 offen lds
s_add_u32 m0, s39, 95232
s_nop 0
buffer_load_dwordx4 v7, s[8:11], s37 offen lds
s_add_u32 m0, s39, 98304
s_nop 0
buffer_load_dwordx4 v8, s[8:11], s37 offen lds
s_add_u32 m0, s39, 101376
s_nop 0
buffer_load_dwordx4 v9, s[8:11], s37 offen lds
s_add_u32 m0, s40, 86016
s_add_u32 s43, s38, 0
buffer_load_dwordx4 v2, s[12:15], s43 offen lds
s_add_u32 m0, s40, 87040
s_add_u32 s43, s38, 49152
buffer_load_dwordx4 v3, s[12:15], s43 offen lds
s_add_u32 m0, s40, 88064
s_add_u32 s43, s38, 98304
buffer_load_dwordx4 v2, s[12:15], s43 offen lds
s_add_u32 m0, s40, 89088
s_add_u32 s43, s38, 147456
buffer_load_dwordx4 v3, s[12:15], s43 offen lds
s_add_u32 m0, s40, 90112
s_add_u32 s43, s38, 196608
buffer_load_dwordx4 v2, s[12:15], s43 offen lds
s_add_u32 m0, s40, 91136
s_add_u32 s43, s38, 245760
buffer_load_dwordx4 v3, s[12:15], s43 offen lds
s_add_u32 m0, s40, 92160
s_add_u32 s43, s38, 294912
buffer_load_dwordx4 v2, s[12:15], s43 offen lds
s_add_u32 m0, s40, 93184
s_add_u32 s43, s38, 344064
buffer_load_dwordx4 v3, s[12:15], s43 offen lds
s_add_u32 s37, s37, 128
s_add_u32 s38, s38, 393216
s_waitcnt vmcnt(14)
s_barrier
s_add_u32 m0, s39, 0
s_mov_b64 exec, s[60:61]
buffer_load_dwordx4 v4, s[8:11], s37 offen lds
s_mov_b64 exec, -1
s_add_u32 m0, s39, 3072
s_nop 0
buffer_load_dwordx4 v5, s[8:11], s37 offen lds
s_add_u32 m0, s39, 6144
s_nop 0
buffer_load_dwordx4 v6, s[8:11], s37 offen lds
s_add_u32 m0, s39, 9216
s_nop 0
buffer_load_dwordx4 v7, s[8:11], s37 offen lds
s_add_u32 m0, s39, 12288
s_nop 0
buffer_load_dwordx4 v8, s[8:11], s37 offen lds
s_add_u32 m0, s39, 15360
s_nop 0
buffer_load_dwordx4 v9, s[8:11], s37 offen lds
s_add_u32 m0, s40, 0
s_add_u32 s43, s38, 0
buffer_load_dwordx4 v2, s[12:15], s43 offen lds
s_add_u32 m0, s40, 1024
s_add_u32 s43, s38, 49152
buffer_load_dwordx4 v3, s[12:15], s43 offen lds
s_add_u32 m0, s40, 2048
s_add_u32 s43, s38, 98304
buffer_load_dwordx4 v2, s[12:15], s43 offen lds
s_add_u32 m0, s40, 3072
s_add_u32 s43, s38, 147456
buffer_load_dwordx4 v3, s[12:15], s43 offen lds
s_add_u32 m0, s40, 4096
s_add_u32 s43, s38, 196608
buffer_load_dwordx4 v2, s[12:15], s43 offen lds
s_add_u32 m0, s40, 5120
s_add_u32 s43, s38, 245760
buffer_load_dwordx4 v3, s[12:15], s43 offen lds
s_add_u32 m0, s40, 6144
s_add_u32 s43, s38, 294912
buffer_load_dwordx4 v2, s[12:15], s43 offen lds
s_add_u32 m0, s40, 7168
s_add_u32 s43, s38, 344064
buffer_load_dwordx4 v3, s[12:15], s43 offen lds
s_add_u32 s37, s37, 128
s_add_u32 s38, s38, 393216
s_waitcnt lgkmcnt(0)
s_load_dword s3, s[4:5], 100352
s_load_dword s3, s[4:5], 100416
s_load_dword s3, s[4:5], 100480
s_load_dword s3, s[4:5], 100544
s_load_dword s3, s[4:5], 107520
s_load_dword s3, s[4:5], 107584
s_load_dword s3, s[4:5], 107648
s_load_dword s3, s[4:5], 107712
s_load_dword s3, s[4:5], 114688
s_load_dword s3, s[4:5], 114752
s_load_dword s3, s[4:5], 114816
s_load_dword s3, s[4:5], 114880
s_load_dword s3, s[4:5], 121856
s_load_dword s3, s[4:5], 121920
s_waitcnt vmcnt(14)
s_barrier
s_add_u32 m0, s39, 43008
s_mov_b64 exec, s[60:61]
buffer_load_dwordx4 v4, s[8:11], s37 offen lds
s_mov_b64 exec, -1
s_add_u32 m0, s39, 46080
s_nop 0
buffer_load_dwordx4 v5, s[8:11], s37 offen lds
s_add_u32 m0, s39, 49152
s_nop 0
buffer_load_dwordx4 v6, s[8:11], s37 offen lds
s_add_u32 m0, s39, 52224
s_nop 0
buffer_load_dwordx4 v7, s[8:11], s37 offen lds
s_add_u32 m0, s39, 55296
s_nop 0
buffer_load_dwordx4 v8, s[8:11], s37 offen lds
s_add_u32 m0, s39, 58368
s_nop 0
buffer_load_dwordx4 v9, s[8:11], s37 offen lds
s_add_u32 m0, s40, 43008
s_add_u32 s43, s38, 0
buffer_load_dwordx4 v2, s[12:15], s43 offen lds
s_add_u32 m0, s40, 44032
s_add_u32 s43, s38, 49152
buffer_load_dwordx4 v3, s[12:15], s43 offen lds
s_add_u32 m0, s40, 45056
s_add_u32 s43, s38, 98304
buffer_load_dwordx4 v2, s[12:15], s43 offen lds
s_add_u32 m0, s40, 46080
s_add_u32 s43, s38, 147456
buffer_load_dwordx4 v3, s[12:15], s43 offen lds
s_add_u32 m0, s40, 47104
s_add_u32 s43, s38, 196608
buffer_load_dwordx4 v2, s[12:15], s43 offen lds
s_add_u32 m0, s40, 48128
s_add_u32 s43, s38, 245760
buffer_load_dwordx4 v3, s[12:15], s43 offen lds
s_add_u32 m0, s40, 49152
s_add_u32 s43, s38, 294912
buffer_load_dwordx4 v2, s[12:15], s43 offen lds
s_add_u32 m0, s40, 50176
s_add_u32 s43, s38, 344064
buffer_load_dwordx4 v3, s[12:15], s43 offen lds
s_add_u32 s37, s37, 128
s_add_u32 s38, s38, 393216
s_waitcnt vmcnt(14)
s_barrier
s_add_u32 m0, s39, 86016
s_mov_b64 exec, s[60:61]
buffer_load_dwordx4 v4, s[8:11], s37 offen lds
s_mov_b64 exec, -1
s_add_u32 m0, s39, 89088
s_nop 0
buffer_load_dwordx4 v5, s[8:11], s37 offen lds
s_add_u32 m0, s39, 92160
s_nop 0
buffer_load_dwordx4 v6, s[8:11], s37 offen lds
s_add_u32 m0, s39, 95232
s_nop 0
buffer_load_dwordx4 v7, s[8:11], s37 offen lds
s_add_u32 m0, s39, 98304
s_nop 0
buffer_load_dwordx4 v8, s[8:11], s37 offen lds
s_add_u32 m0, s39, 101376
s_nop 0
buffer_load_dwordx4 v9, s[8:11], s37 offen lds
s_add_u32 m0, s40, 86016
s_add_u32 s43, s38, 0
buffer_load_dwordx4 v2, s[12:15], s43 offen lds
s_add_u32 m0, s40, 87040
s_add_u32 s43, s38, 49152
buffer_load_dwordx4 v3, s[12:15], s43 offen lds
s_add_u32 m0, s40, 88064
s_add_u32 s43, s38, 98304
buffer_load_dwordx4 v2, s[12:15], s43 offen lds
s_add_u32 m0, s40, 89088
s_add_u32 s43, s38, 147456
buffer_load_dwordx4 v3, s[12:15], s43 offen lds
s_add_u32 m0, s40, 90112
s_add_u32 s43, s38, 196608
buffer_load_dwordx4 v2, s[12:15], s43 offen lds
s_add_u32 m0, s40, 91136
s_add_u32 s43, s38, 245760
buffer_load_dwordx4 v3, s[12:15], s43 offen lds
s_add_u32 m0, s40, 92160
s_add_u32 s43, s38, 294912
buffer_load_dwordx4 v2, s[12:15], s43 offen lds
s_add_u32 m0, s40, 93184
s_add_u32 s43, s38, 344064
buffer_load_dwordx4 v3, s[12:15], s43 offen lds
s_add_u32 s37, s37, 128
s_add_u32 s38, s38, 393216
s_waitcnt lgkmcnt(0)
s_load_dword s3, s[4:5], 121984
s_load_dword s3, s[4:5], 122048
s_load_dword s3, s[4:5], 129024
s_load_dword s3, s[4:5], 129088
s_load_dword s3, s[4:5], 129152
s_load_dword s3, s[4:5], 129216
s_load_dword s3, s[4:5], 136192
s_load_dword s3, s[4:5], 136256
s_load_dword s3, s[4:5], 136320
s_load_dword s3, s[4:5], 136384
s_load_dword s3, s[4:5], 143360
s_load_dword s3, s[4:5], 143424
s_load_dword s3, s[4:5], 143488
s_load_dword s3, s[4:5], 143552
s_waitcnt vmcnt(14)
s_barrier
s_add_u32 m0, s39, 0
s_mov_b64 exec, s[60:61]
buffer_load_dwordx4 v4, s[8:11], s37 offen lds
s_mov_b64 exec, -1
s_add_u32 m0, s39, 3072
s_nop 0
buffer_load_dwordx4 v5, s[8:11], s37 offen lds
s_add_u32 m0, s39, 6144
s_nop 0
buffer_load_dwordx4 v6, s[8:11], s37 offen lds
s_add_u32 m0, s39, 9216
s_nop 0
buffer_load_dwordx4 v7, s[8:11], s37 offen lds
s_add_u32 m0, s39, 12288
s_nop 0
buffer_load_dwordx4 v8, s[8:11], s37 offen lds
s_add_u32 m0, s39, 15360
s_nop 0
buffer_load_dwordx4 v9, s[8:11], s37 offen lds
s_add_u32 m0, s40, 0
s_add_u32 s43, s38, 0
buffer_load_dwordx4 v2, s[12:15], s43 offen lds
s_add_u32 m0, s40, 1024
s_add_u32 s43, s38, 49152
buffer_load_dwordx4 v3, s[12:15], s43 offen lds
s_add_u32 m0, s40, 2048
s_add_u32 s43, s38, 98304
buffer_load_dwordx4 v2, s[12:15], s43 offen lds
s_add_u32 m0, s40, 3072
s_add_u32 s43, s38, 147456
buffer_load_dwordx4 v3, s[12:15], s43 offen lds
s_add_u32 m0, s40, 4096
s_add_u32 s43, s38, 196608
buffer_load_dwordx4 v2, s[12:15], s43 offen lds
s_add_u32 m0, s40, 5120
s_add_u32 s43, s38, 245760
buffer_load_dwordx4 v3, s[12:15], s43 offen lds
s_add_u32 m0, s40, 6144
s_add_u32 s43, s38, 294912
buffer_load_dwordx4 v2, s[12:15], s43 offen lds
s_add_u32 m0, s40, 7168
s_add_u32 s43, s38, 344064
buffer_load_dwordx4 v3, s[12:15], s43 offen lds
s_add_u32 s37, s37, 128
s_add_u32 s38, s38, 393216
s_waitcnt vmcnt(14)
s_barrier
s_waitcnt lgkmcnt(0)
s_load_dword s3, s[4:5], 150528
s_load_dword s3, s[4:5], 150592
s_load_dword s3, s[4:5], 150656
s_load_dword s3, s[4:5], 150720
s_load_dword s3, s[4:5], 157696
s_load_dword s3, s[4:5], 157760
s_load_dword s3, s[4:5], 157824
s_load_dword s3, s[4:5], 157888
s_load_dword s3, s[4:5], 164864
s_load_dword s3, s[4:5], 164928
s_load_dword s3, s[4:5], 164992
s_load_dword s3, s[4:5], 165056
s_waitcnt vmcnt(0)
s_barrier
s_bitcmp0_b32 s2, 0
s_cselect_b32 s88, s72, s74
s_cselect_b32 s89, s73, s75
s_cmp_lt_u32 s2, 192
s_cselect_b32 s90, 7340032, 0
s_mov_b32 s91, 0x20000
s_bfe_u32 s44, s2, 0x30001
s_lshl_b32 s44, s44, 2
s_and_b32 s43, s36, 3
s_add_u32 s44, s44, s43
s_lshl_b32 s44, s44, 5
v_lshrrev_b32 v18, 4, v1
v_add_u32 v18, s44, v18
v_mul_u32_u24 v18, 7168, v18
v_and_b32 v19, 15, v1
v_lshl_add_u32 v18, v19, 4, v18
s_lshr_b32 s43, s2, 4
s_lshl_b32 s43, s43, 8
s_add_u32 s43, s43, 4096
v_add_u32 v18, s43, v18
s_mov_b32 s43, 0
buffer_load_dwordx4 v[128:131], v18, s[88:91], s43 offen
s_mov_b32 s43, 28672
s_branch Lov_1
.p2align 12
Lst_1_0:
s_branch Lwr_141
s_nop 0
s_nop 0
Lov_1:
buffer_load_dwordx4 v[132:135], v18, s[88:91], s43 offen
s_mov_b32 s43, 57344
buffer_load_dwordx4 v[136:139], v18, s[88:91], s43 offen
s_mov_b32 s43, 86016
buffer_load_dwordx4 v[140:143], v18, s[88:91], s43 offen
s_mov_b32 s43, 114688
buffer_load_dwordx4 v[144:147], v18, s[88:91], s43 offen
s_mov_b32 s43, 143360
buffer_load_dwordx4 v[148:151], v18, s[88:91], s43 offen
s_mov_b32 s43, 172032
buffer_load_dwordx4 v[152:155], v18, s[88:91], s43 offen
s_mov_b32 s43, 200704
buffer_load_dwordx4 v[156:159], v18, s[88:91], s43 offen
s_barrier
s_lshl_b32 s43, s35, 7
s_add_u32 s28, s68, s43
s_addc_u32 s29, s69, 0
s_mov_b32 s30, 2095232
s_mov_b32 s31, 0x20000
v_lshrrev_b32 v15, 3, v1
v_and_b32 v16, 6, v15
v_and_b32 v7, 7, v1
v_xor_b32 v7, v7, v16
v_lshlrev_b32 v7, 4, v7
v_mul_u32_u24 v15, 2048, v15
v_add_u32 v7, v7, v15
s_and_b32 s40, s36, 3
s_lshl_b32 s39, s40, 13
s_add_u32 s40, s40, s35
s_add_u32 s42, s40, 0
s_and_b32 s42, s42, 15
s_lshl_b32 s42, s42, 17
s_add_u32 m0, s39, 65536
s_add_u32 s43, s42, 0
buffer_load_dwordx4 v7, s[28:31], s43 offen lds
s_add_u32 m0, s39, 66560
s_add_u32 s43, s42, 16384
buffer_load_dwordx4 v7, s[28:31], s43 offen lds
s_add_u32 m0, s39, 67584
s_add_u32 s43, s42, 32768
buffer_load_dwordx4 v7, s[28:31], s43 offen lds
s_add_u32 m0, s39, 68608
s_add_u32 s43, s42, 49152
buffer_load_dwordx4 v7, s[28:31], s43 offen lds
s_add_u32 m0, s39, 69632
s_add_u32 s43, s42, 65536
buffer_load_dwordx4 v7, s[28:31], s43 offen lds
s_add_u32 m0, s39, 70656
s_add_u32 s43, s42, 81920
buffer_load_dwordx4 v7, s[28:31], s43 offen lds
s_add_u32 m0, s39, 71680
s_add_u32 s43, s42, 98304
buffer_load_dwordx4 v7, s[28:31], s43 offen lds
s_add_u32 m0, s39, 72704
s_add_u32 s43, s42, 114688
buffer_load_dwordx4 v7, s[28:31], s43 offen lds
s_branch Lats_6
Lcons_7:
s_lshl_b32 s43, s35, 7
s_waitcnt lgkmcnt(0)
s_mov_b32 s8, s64
s_mov_b32 s9, s65
s_mov_b32 s10, 4194304
s_mov_b32 s11, 0x20000
s_add_u32 s12, s66, s43
s_addc_u32 s13, s67, 0
s_mov_b32 s14, 6289536
s_mov_b32 s15, 0x20000
s_lshr_b32 s43, s2, 3
s_lshl_b32 s43, s43, 2
s_add_u32 s43, s43, s36
s_sub_u32 s44, s43, 0
s_and_b32 s44, s44, 127
s_cmp_lt_u32 s44, 7
s_cbranch_scc0 Lt_8
s_lshl_b32 s44, s44, 20
s_min_u32 s44, s44, 6291392
s_load_dword s3, s[66:67], s44
Lt_8:
s_sub_u32 s44, s43, 7
s_and_b32 s44, s44, 127
s_cmp_lt_u32 s44, 5
s_cbranch_scc0 Lt_9
s_lshl_b32 s44, s44, 20
s_min_u32 s44, s44, 4194240
s_load_dword s3, s[64:65], s44
Lt_9:
s_sub_u32 s44, s43, 12
s_and_b32 s44, s44, 127
s_cmp_lt_u32 s44, 1
s_cbranch_scc0 Lt_10
s_lshl_b32 s44, s44, 20
s_min_u32 s44, s44, 0
s_load_dword s3, s[80:81], s44 glc
Lt_10:
s_sub_u32 s44, s43, 13
s_and_b32 s44, s44, 127
s_cmp_lt_u32 s44, 24
s_cbranch_scc0 Lt_11
s_lshl_b32 s44, s44, 20
s_min_u32 s44, s44, 24117184
s_load_dword s3, s[82:83], s44 glc
Lt_11:
s_sub_u32 s44, s43, 37
s_and_b32 s44, s44, 127
s_cmp_lt_u32 s44, 8
s_cbranch_scc0 Lt_12
s_lshl_b32 s44, s44, 20
s_min_u32 s44, s44, 7339968
s_load_dword s3, s[72:73], s44
Lt_12:
s_sub_u32 s44, s43, 45
s_and_b32 s44, s44, 127
s_cmp_lt_u32 s44, 8
s_cbranch_scc0 Lt_13
s_lshl_b32 s44, s44, 20
s_min_u32 s44, s44, 7339968
s_load_dword s3, s[74:75], s44
Lt_13:
s_sub_u32 s44, s43, 53
s_and_b32 s44, s44, 127
s_cmp_lt_u32 s44, 3
s_cbranch_scc0 Lt_14
s_lshl_b32 s44, s44, 20
s_min_u32 s44, s44, 2097088
s_load_dword s3, s[68:69], s44
Lt_14:
s_sub_u32 s44, s43, 56
s_and_b32 s44, s44, 127
s_cmp_lt_u32 s44, 5
s_cbranch_scc0 Lt_15
s_lshl_b32 s44, s44, 20
s_min_u32 s44, s44, 4194240
s_add_u32 s44, s44, 25165824
s_load_dword s3, s[82:83], s44 glc
Lt_15:
s_sub_u32 s44, s43, 61
s_and_b32 s44, s44, 127
s_cmp_lt_u32 s44, 8
s_cbranch_scc0 Lt_16
s_lshl_b32 s44, s44, 20
s_min_u32 s44, s44, 7339968
s_load_dword s3, s[76:77], s44
Lt_16:
s_sub_u32 s44, s43, 69
s_and_b32 s44, s44, 127
s_cmp_lt_u32 s44, 5
s_cbranch_scc0 Lt_17
s_lshl_b32 s44, s44, 20
s_min_u32 s44, s44, 4194240
s_add_u32 s44, s44, 33554432
s_load_dword s3, s[82:83], s44 glc
Lt_17:
s_sub_u32 s44, s43, 74
s_and_b32 s44, s44, 127
s_cmp_lt_u32 s44, 5
s_cbranch_scc0 Lt_18
s_lshl_b32 s44, s44, 20
s_min_u32 s44, s44, 4194240
s_load_dword s3, s[78:79], s44 glc
Lt_18:
v_lshrrev_b32 v16, 1, v12
v_xor_b32 v15, v13, v16
v_lshlrev_b32 v15, 4, v15
v_lshl_add_u32 v2, v12, 7, v15
v_xor_b32 v3, 64, v2
v_add_u32 v4, 86016, v2
v_add_u32 v5, 86016, v3
v_lshrrev_b32 v15, 2, v12
v_and_b32 v16, 3, v1
v_lshl_add_u32 v19, v13, 3, v15
v_lshlrev_b32 v19, 7, v19
v_and_b32 v15, 2, v15
v_and_b32 v17, 1, v13
v_lshl_add_u32 v15, v17, 2, v15
v_lshrrev_b32 v17, 1, v16
s_lshl_b32 s43, s36, 1
v_add_u32 v17, s43, v17
v_xor_b32 v15, v15, v17
v_lshl_add_u32 v19, v15, 4, v19
v_and_b32 v16, 1, v16
v_lshl_add_u32 v19, v16, 3, v19
v_add_u32 v6, 18432, v19
v_add_u32 v7, 61440, v19
v_add_u32 v8, 104448, v19
s_and_b32 s43, s36, 1
s_bfe_u32 s44, s36, 0x10001
s_lshr_b32 s45, s36, 2
v_lshlrev_b32 v14, 2, v13
v_sub_u32 v14, v12, v14
v_mov_b32 v16, 0xff800000
s_or_b32 s46, s34, s45
s_cmp_lg_u32 s46, 0
s_cselect_b32 s46, 0, 0xff800000
v_subrev_u32 v15, 0, v14
v_cmp_ge_u32 vcc, 7, v15
v_add_u32 v15, 16, v15
s_nop 0
v_cndmask_b32 v248, v16, 0, vcc
v_cmp_ge_u32 vcc, 7, v15
s_nop 1
v_cndmask_b32 v244, v16, 0, vcc
v_or_b32 v240, s46, v244
v_subrev_u32 v15, 1, v14
v_cmp_ge_u32 vcc, 7, v15
v_add_u32 v15, 16, v15
s_nop 0
v_cndmask_b32 v249, v16, 0, vcc
v_cmp_ge_u32 vcc, 7, v15
s_nop 1
v_cndmask_b32 v245, v16, 0, vcc
v_or_b32 v241, s46, v245
v_subrev_u32 v15, 2, v14
v_cmp_ge_u32 vcc, 7, v15
v_add_u32 v15, 16, v15
s_nop 0
v_cndmask_b32 v250, v16, 0, vcc
v_cmp_ge_u32 vcc, 7, v15
s_nop 1
v_cndmask_b32 v246, v16, 0, vcc
v_or_b32 v242, s46, v246
v_subrev_u32 v15, 3, v14
v_cmp_ge_u32 vcc, 7, v15
v_add_u32 v15, 16, v15
s_nop 0
v_cndmask_b32 v251, v16, 0, vcc
v_cmp_ge_u32 vcc, 7, v15
s_nop 1
v_cndmask_b32 v247, v16, 0, vcc
v_or_b32 v243, s46, v247
s_lshl_b32 s46, s45, 6
s_add_u32 s46, s46, s44
s_add_u32 s46, s46, 16
v_lshl_add_u32 v14, v12, 1, s46
s_lshl_b32 s47, s43, 6
v_lshl_add_u32 v15, v13, 4, s47
v_mul_u32_u24 v20, 400, v14
v_add_u32 v20, v20, v15
v_subrev_u32 v16, 32, v14
v_max_i32 v16, 0, v16
v_mul_u32_u24 v21, 400, v16
v_add_u32 v21, v21, v15
v_lshrrev_b32 v16, 2, v12
v_lshl_add_u32 v16, v13, 2, v16
v_lshl_add_u32 v16, v16, 1, s46
v_and_b32 v17, 3, v1
v_lshl_add_u32 v17, v17, 3, s47
v_mul_u32_u24 v22, 400, v16
v_add_u32 v22, v22, v17
v_subrev_u32 v16, 32, v16
v_max_i32 v16, 0, v16
v_mul_u32_u24 v23, 400, v16
v_add_u32 v23, v23, v17
s_mul_i32 s60, s34, 262144
s_add_u32 s16, s82, s60
s_addc_u32 s17, s83, 0
s_mov_b32 s18, 262144
s_mov_b32 s19, 0x20000
s_lshl_b32 s60, s35, 14
s_lshl_b32 s43, s43, 13
s_add_u32 s60, s60, s43
s_lshl_b32 s43, s45, 12
s_add_u32 s60, s60, s43
s_lshl_b32 s43, s44, 10
s_add_u32 s60, s60, s43
v_lshlrev_b32 v24, 4, v1
s_mov_b32 s61, 0x3e8293ee
s_lshl_b32 s38, s35, 7
s_add_u32 s56, s82, 28311552
s_addc_u32 s57, s83, 0
s_mov_b32 s58, 49152
s_mov_b32 s59, 0x20000
s_barrier
ds_read_b128 v[32:35], v2 offset:0
ds_read_b64_tr_b16 v[72:73], v6 offset:8192
ds_read_b64_tr_b16 v[74:75], v6 offset:8704
ds_read_b64_tr_b16 v[76:77], v6 offset:16384
ds_read_b64_tr_b16 v[78:79], v6 offset:16896
ds_read_b64_tr_b16 v[68:69], v6 offset:0
ds_read_b64_tr_b16 v[70:71], v6 offset:512
ds_read_b128 v[36:39], v2 offset:2048
ds_read_b128 v[40:43], v2 offset:4096
ds_read_b128 v[44:47], v2 offset:6144
ds_read_b128 v[48:51], v2 offset:8192
ds_read_b128 v[52:55], v2 offset:10240
ds_read_b128 v[56:59], v2 offset:12288
ds_read_b128 v[60:63], v2 offset:14336
ds_read_b128 v[64:67], v2 offset:16384
s_waitcnt lgkmcnt(0)
v_mfma_f32_16x16x32_bf16 v[164:167], v[72:75], v[32:35], 0
ds_read_b128 v[80:83], v3 offset:0
v_mfma_f32_16x16x32_bf16 v[200:203], v[76:79], v[32:35], 0
ds_read_b64_tr_b16 v[120:121], v6 offset:12288
v_mfma_f32_16x16x32_bf16 v[128:131], v[68:71], v[32:35], 0
ds_read_b64_tr_b16 v[122:123], v6 offset:12800
v_mfma_f32_16x16x32_bf16 v[132:135], v[68:71], v[36:39], 0
ds_read_b64_tr_b16 v[124:125], v6 offset:20480
v_mfma_f32_16x16x32_bf16 v[204:207], v[76:79], v[36:39], 0
ds_read_b64_tr_b16 v[126:127], v6 offset:20992
v_mfma_f32_16x16x32_bf16 v[168:171], v[72:75], v[36:39], 0
ds_read_b64_tr_b16 v[116:117], v6 offset:4096
v_mfma_f32_16x16x32_bf16 v[172:175], v[72:75], v[40:43], 0
ds_read_b64_tr_b16 v[118:119], v6 offset:4608
v_mfma_f32_16x16x32_bf16 v[208:211], v[76:79], v[40:43], 0
ds_read_b128 v[84:87], v3 offset:2048
v_mfma_f32_16x16x32_bf16 v[136:139], v[68:71], v[40:43], 0
ds_read_b128 v[88:91], v3 offset:4096
v_mfma_f32_16x16x32_bf16 v[140:143], v[68:71], v[44:47], 0
ds_read_b128 v[92:95], v3 offset:6144
v_mfma_f32_16x16x32_bf16 v[212:215], v[76:79], v[44:47], 0
ds_read_b128 v[96:99], v3 offset:8192
v_mfma_f32_16x16x32_bf16 v[176:179], v[72:75], v[44:47], 0
ds_read_b128 v[100:103], v3 offset:10240
v_mfma_f32_16x16x32_bf16 v[180:183], v[72:75], v[48:51], 0
ds_read_b128 v[104:107], v3 offset:12288
v_mfma_f32_16x16x32_bf16 v[216:219], v[76:79], v[48:51], 0
ds_read_b128 v[108:111], v3 offset:14336
v_mfma_f32_16x16x32_bf16 v[144:147], v[68:71], v[48:51], 0
ds_read_b128 v[112:115], v3 offset:16384
v_mfma_f32_16x16x32_bf16 v[148:151], v[68:71], v[52:55], 0
v_mfma_f32_16x16x32_bf16 v[220:223], v[76:79], v[52:55], 0
v_mfma_f32_16x16x32_bf16 v[184:187], v[72:75], v[52:55], 0
v_mfma_f32_16x16x32_bf16 v[188:191], v[72:75], v[56:59], 0
v_mfma_f32_16x16x32_bf16 v[224:227], v[76:79], v[56:59], 0
v_mfma_f32_16x16x32_bf16 v[152:155], v[68:71], v[56:59], 0
v_mfma_f32_16x16x32_bf16 v[156:159], v[68:71], v[60:63], 0
v_mfma_f32_16x16x32_bf16 v[228:231], v[76:79], v[60:63], 0
v_mfma_f32_16x16x32_bf16 v[192:195], v[72:75], v[60:63], 0
v_mfma_f32_16x16x32_bf16 v[196:199], v[72:75], v[64:67], 0
v_mfma_f32_16x16x32_bf16 v[232:235], v[76:79], v[64:67], 0
v_mfma_f32_16x16x32_bf16 v[160:163], v[68:71], v[64:67], 0
s_waitcnt lgkmcnt(0)
s_barrier
v_mfma_f32_16x16x32_bf16 v[164:167], v[120:123], v[80:83], v[164:167]
ds_read_b128 v[32:35], v2 offset:43008
v_mfma_f32_16x16x32_bf16 v[200:203], v[124:127], v[80:83], v[200:203]
ds_read_b64_tr_b16 v[72:73], v7 offset:8192
v_mfma_f32_16x16x32_bf16 v[128:131], v[116:119], v[80:83], v[128:131]
ds_read_b64_tr_b16 v[74:75], v7 offset:8704
v_mfma_f32_16x16x32_bf16 v[132:135], v[116:119], v[84:87], v[132:135]
ds_read_b64_tr_b16 v[76:77], v7 offset:16384
v_mfma_f32_16x16x32_bf16 v[204:207], v[124:127], v[84:87], v[204:207]
ds_read_b64_tr_b16 v[78:79], v7 offset:16896
v_mfma_f32_16x16x32_bf16 v[168:171], v[120:123], v[84:87], v[168:171]
ds_read_b64_tr_b16 v[68:69], v7 offset:0
v_mfma_f32_16x16x32_bf16 v[172:175], v[120:123], v[88:91], v[172:175]
ds_read_b64_tr_b16 v[70:71], v7 offset:512
v_mfma_f32_16x16x32_bf16 v[208:211], v[124:127], v[88:91], v[208:211]
ds_read_b128 v[36:39], v2 offset:45056
v_mfma_f32_16x16x32_bf16 v[136:139], v[116:119], v[88:91], v[136:139]
ds_read_b128 v[40:43], v2 offset:47104
v_mfma_f32_16x16x32_bf16 v[140:143], v[116:119], v[92:95], v[140:143]
ds_read_b128 v[44:47], v2 offset:49152
v_mfma_f32_16x16x32_bf16 v[212:215], v[124:127], v[92:95], v[212:215]
ds_read_b128 v[48:51], v2 offset:51200
v_mfma_f32_16x16x32_bf16 v[176:179], v[120:123], v[92:95], v[176:179]
ds_read_b128 v[52:55], v2 offset:53248
v_mfma_f32_16x16x32_bf16 v[180:183], v[120:123], v[96:99], v[180:183]
ds_read_b128 v[56:59], v2 offset:55296
v_mfma_f32_16x16x32_bf16 v[216:219], v[124:127], v[96:99], v[216:219]
ds_read_b128 v[60:63], v2 offset:57344
v_mfma_f32_16x16x32_bf16 v[144:147], v[116:119], v[96:99], v[144:147]
ds_read_b128 v[64:67], v2 offset:59392
v_mfma_f32_16x16x32_bf16 v[148:151], v[116:119], v[100:103], v[148:151]
v_mfma_f32_16x16x32_bf16 v[220:223], v[124:127], v[100:103], v[220:223]
v_mfma_f32_16x16x32_bf16 v[184:187], v[120:123], v[100:103], v[184:187]
v_mfma_f32_16x16x32_bf16 v[188:191], v[120:123], v[104:107], v[188:191]
v_mfma_f32_16x16x32_bf16 v[224:227], v[124:127], v[104:107], v[224:227]
v_mfma_f32_16x16x32_bf16 v[152:155], v[116:119], v[104:107], v[152:155]
v_mfma_f32_16x16x32_bf16 v[156:159], v[116:119], v[108:111], v[156:159]
v_mfma_f32_16x16x32_bf16 v[228:231], v[124:127], v[108:111], v[228:231]
v_mfma_f32_16x16x32_bf16 v[192:195], v[120:123], v[108:111], v[192:195]
v_mfma_f32_16x16x32_bf16 v[196:199], v[120:123], v[112:115], v[196:199]
v_mfma_f32_16x16x32_bf16 v[232:235], v[124:127], v[112:115], v[232:235]
v_mfma_f32_16x16x32_bf16 v[160:163], v[116:119], v[112:115], v[160:163]
s_waitcnt lgkmcnt(0)
v_mfma_f32_16x16x32_bf16 v[164:167], v[72:75], v[32:35], v[164:167]
ds_read_b128 v[80:83], v3 offset:43008
v_mfma_f32_16x16x32_bf16 v[200:203], v[76:79], v[32:35], v[200:203]
ds_read_b64_tr_b16 v[120:121], v7 offset:12288
v_mfma_f32_16x16x32_bf16 v[128:131], v[68:71], v[32:35], v[128:131]
ds_read_b64_tr_b16 v[122:123], v7 offset:12800
v_mfma_f32_16x16x32_bf16 v[132:135], v[68:71], v[36:39], v[132:135]
ds_read_b64_tr_b16 v[124:125], v7 offset:20480
v_mfma_f32_16x16x32_bf16 v[204:207], v[76:79], v[36:39], v[204:207]
ds_read_b64_tr_b16 v[126:127], v7 offset:20992
v_mfma_f32_16x16x32_bf16 v[168:171], v[72:75], v[36:39], v[168:171]
ds_read_b64_tr_b16 v[116:117], v7 offset:4096
v_mfma_f32_16x16x32_bf16 v[172:175], v[72:75], v[40:43], v[172:175]
ds_read_b64_tr_b16 v[118:119], v7 offset:4608
v_mfma_f32_16x16x32_bf16 v[208:211], v[76:79], v[40:43], v[208:211]
ds_read_b128 v[84:87], v3 offset:45056
v_mfma_f32_16x16x32_bf16 v[136:139], v[68:71], v[40:43], v[136:139]
ds_read_b128 v[88:91], v3 offset:47104
v_mfma_f32_16x16x32_bf16 v[140:143], v[68:71], v[44:47], v[140:143]
ds_read_b128 v[92:95], v3 offset:49152
v_mfma_f32_16x16x32_bf16 v[212:215], v[76:79], v[44:47], v[212:215]
ds_read_b128 v[96:99], v3 offset:51200
v_mfma_f32_16x16x32_bf16 v[176:179], v[72:75], v[44:47], v[176:179]
ds_read_b128 v[100:103], v3 offset:53248
v_mfma_f32_16x16x32_bf16 v[180:183], v[72:75], v[48:51], v[180:183]
ds_read_b128 v[104:107], v3 offset:55296
v_mfma_f32_16x16x32_bf16 v[216:219], v[76:79], v[48:51], v[216:219]
ds_read_b128 v[108:111], v3 offset:57344
v_mfma_f32_16x16x32_bf16 v[144:147], v[68:71], v[48:51], v[144:147]
ds_read_b128 v[112:115], v3 offset:59392
v_mfma_f32_16x16x32_bf16 v[148:151], v[68:71], v[52:55], v[148:151]
v_mfma_f32_16x16x32_bf16 v[220:223], v[76:79], v[52:55], v[220:223]
v_mfma_f32_16x16x32_bf16 v[184:187], v[72:75], v[52:55], v[184:187]
v_mfma_f32_16x16x32_bf16 v[188:191], v[72:75], v[56:59], v[188:191]
v_mfma_f32_16x16x32_bf16 v[224:227], v[76:79], v[56:59], v[224:227]
v_mfma_f32_16x16x32_bf16 v[152:155], v[68:71], v[56:59], v[152:155]
v_mfma_f32_16x16x32_bf16 v[156:159], v[68:71], v[60:63], v[156:159]
v_mfma_f32_16x16x32_bf16 v[228:231], v[76:79], v[60:63], v[228:231]
v_mfma_f32_16x16x32_bf16 v[192:195], v[72:75], v[60:63], v[192:195]
v_mfma_f32_16x16x32_bf16 v[196:199], v[72:75], v[64:67], v[196:199]
v_mfma_f32_16x16x32_bf16 v[232:235], v[76:79], v[64:67], v[232:235]
v_mfma_f32_16x16x32_bf16 v[160:163], v[68:71], v[64:67], v[160:163]
s_waitcnt lgkmcnt(0)
s_barrier
v_mfma_f32_16x16x32_bf16 v[164:167], v[120:123], v[80:83], v[164:167]
ds_read_b128 v[32:35], v4 offset:0
v_mfma_f32_16x16x32_bf16 v[200:203], v[124:127], v[80:83], v[200:203]
ds_read_b64_tr_b16 v[72:73], v8 offset:8192
v_mfma_f32_16x16x32_bf16 v[128:131], v[116:119], v[80:83], v[128:131]
ds_read_b64_tr_b16 v[74:75], v8 offset:8704
v_mfma_f32_16x16x32_bf16 v[132:135], v[116:119], v[84:87], v[132:135]
ds_read_b64_tr_b16 v[76:77], v8 offset:16384
v_mfma_f32_16x16x32_bf16 v[204:207], v[124:127], v[84:87], v[204:207]
ds_read_b64_tr_b16 v[78:79], v8 offset:16896
v_mfma_f32_16x16x32_bf16 v[168:171], v[120:123], v[84:87], v[168:171]
ds_read_b64_tr_b16 v[68:69], v8 offset:0
v_mfma_f32_16x16x32_bf16 v[172:175], v[120:123], v[88:91], v[172:175]
ds_read_b64_tr_b16 v[70:71], v8 offset:512
v_mfma_f32_16x16x32_bf16 v[208:211], v[124:127], v[88:91], v[208:211]
ds_read_b128 v[36:39], v4 offset:2048
v_mfma_f32_16x16x32_bf16 v[136:139], v[116:119], v[88:91], v[136:139]
ds_read_b128 v[40:43], v4 offset:4096
v_mfma_f32_16x16x32_bf16 v[140:143], v[116:119], v[92:95], v[140:143]
ds_read_b128 v[44:47], v4 offset:6144
v_mfma_f32_16x16x32_bf16 v[212:215], v[124:127], v[92:95], v[212:215]
ds_read_b128 v[48:51], v4 offset:8192
v_mfma_f32_16x16x32_bf16 v[176:179], v[120:123], v[92:95], v[176:179]
ds_read_b128 v[52:55], v4 offset:10240
v_mfma_f32_16x16x32_bf16 v[180:183], v[120:123], v[96:99], v[180:183]
ds_read_b128 v[56:59], v4 offset:12288
v_mfma_f32_16x16x32_bf16 v[216:219], v[124:127], v[96:99], v[216:219]
ds_read_b128 v[60:63], v4 offset:14336
v_mfma_f32_16x16x32_bf16 v[144:147], v[116:119], v[96:99], v[144:147]
ds_read_b128 v[64:67], v4 offset:16384
v_mfma_f32_16x16x32_bf16 v[148:151], v[116:119], v[100:103], v[148:151]
v_mfma_f32_16x16x32_bf16 v[220:223], v[124:127], v[100:103], v[220:223]
v_mfma_f32_16x16x32_bf16 v[184:187], v[120:123], v[100:103], v[184:187]
v_mfma_f32_16x16x32_bf16 v[188:191], v[120:123], v[104:107], v[188:191]
v_mfma_f32_16x16x32_bf16 v[224:227], v[124:127], v[104:107], v[224:227]
v_mfma_f32_16x16x32_bf16 v[152:155], v[116:119], v[104:107], v[152:155]
v_mfma_f32_16x16x32_bf16 v[156:159], v[116:119], v[108:111], v[156:159]
v_mfma_f32_16x16x32_bf16 v[228:231], v[124:127], v[108:111], v[228:231]
v_mfma_f32_16x16x32_bf16 v[192:195], v[120:123], v[108:111], v[192:195]
v_mfma_f32_16x16x32_bf16 v[196:199], v[120:123], v[112:115], v[196:199]
v_mfma_f32_16x16x32_bf16 v[232:235], v[124:127], v[112:115], v[232:235]
v_mfma_f32_16x16x32_bf16 v[160:163], v[116:119], v[112:115], v[160:163]
s_waitcnt lgkmcnt(0)
v_mfma_f32_16x16x32_bf16 v[164:167], v[72:75], v[32:35], v[164:167]
ds_read_b128 v[80:83], v5 offset:0
v_mfma_f32_16x16x32_bf16 v[200:203], v[76:79], v[32:35], v[200:203]
ds_read_b64_tr_b16 v[120:121], v8 offset:12288
v_mfma_f32_16x16x32_bf16 v[128:131], v[68:71], v[32:35], v[128:131]
ds_read_b64_tr_b16 v[122:123], v8 offset:12800
v_mfma_f32_16x16x32_bf16 v[132:135], v[68:71], v[36:39], v[132:135]
ds_read_b64_tr_b16 v[124:125], v8 offset:20480
v_mfma_f32_16x16x32_bf16 v[204:207], v[76:79], v[36:39], v[204:207]
ds_read_b64_tr_b16 v[126:127], v8 offset:20992
v_mfma_f32_16x16x32_bf16 v[168:171], v[72:75], v[36:39], v[168:171]
ds_read_b64_tr_b16 v[116:117], v8 offset:4096
v_mfma_f32_16x16x32_bf16 v[172:175], v[72:75], v[40:43], v[172:175]
ds_read_b64_tr_b16 v[118:119], v8 offset:4608
v_mfma_f32_16x16x32_bf16 v[208:211], v[76:79], v[40:43], v[208:211]
ds_read_b128 v[84:87], v5 offset:2048
v_mfma_f32_16x16x32_bf16 v[136:139], v[68:71], v[40:43], v[136:139]
ds_read_b128 v[88:91], v5 offset:4096
v_mfma_f32_16x16x32_bf16 v[140:143], v[68:71], v[44:47], v[140:143]
ds_read_b128 v[92:95], v5 offset:6144
v_mfma_f32_16x16x32_bf16 v[212:215], v[76:79], v[44:47], v[212:215]
ds_read_b128 v[96:99], v5 offset:8192
v_mfma_f32_16x16x32_bf16 v[176:179], v[72:75], v[44:47], v[176:179]
ds_read_b128 v[100:103], v5 offset:10240
v_mfma_f32_16x16x32_bf16 v[180:183], v[72:75], v[48:51], v[180:183]
ds_read_b128 v[104:107], v5 offset:12288
v_mfma_f32_16x16x32_bf16 v[216:219], v[76:79], v[48:51], v[216:219]
ds_read_b128 v[108:111], v5 offset:14336
v_mfma_f32_16x16x32_bf16 v[144:147], v[68:71], v[48:51], v[144:147]
ds_read_b128 v[112:115], v5 offset:16384
v_mfma_f32_16x16x32_bf16 v[148:151], v[68:71], v[52:55], v[148:151]
v_mfma_f32_16x16x32_bf16 v[220:223], v[76:79], v[52:55], v[220:223]
v_mfma_f32_16x16x32_bf16 v[184:187], v[72:75], v[52:55], v[184:187]
v_mfma_f32_16x16x32_bf16 v[188:191], v[72:75], v[56:59], v[188:191]
v_mfma_f32_16x16x32_bf16 v[224:227], v[76:79], v[56:59], v[224:227]
v_mfma_f32_16x16x32_bf16 v[152:155], v[68:71], v[56:59], v[152:155]
v_mfma_f32_16x16x32_bf16 v[156:159], v[68:71], v[60:63], v[156:159]
v_mfma_f32_16x16x32_bf16 v[228:231], v[76:79], v[60:63], v[228:231]
v_mfma_f32_16x16x32_bf16 v[192:195], v[72:75], v[60:63], v[192:195]
v_mfma_f32_16x16x32_bf16 v[196:199], v[72:75], v[64:67], v[196:199]
v_mfma_f32_16x16x32_bf16 v[232:235], v[76:79], v[64:67], v[232:235]
v_mfma_f32_16x16x32_bf16 v[160:163], v[68:71], v[64:67], v[160:163]
s_waitcnt lgkmcnt(0)
s_barrier
v_mfma_f32_16x16x32_bf16 v[164:167], v[120:123], v[80:83], v[164:167]
ds_read_b128 v[32:35], v2 offset:0
v_mfma_f32_16x16x32_bf16 v[200:203], v[124:127], v[80:83], v[200:203]
ds_read_b64_tr_b16 v[72:73], v6 offset:8192
v_mfma_f32_16x16x32_bf16 v[128:131], v[116:119], v[80:83], v[128:131]
ds_read_b64_tr_b16 v[74:75], v6 offset:8704
v_mfma_f32_16x16x32_bf16 v[132:135], v[116:119], v[84:87], v[132:135]
ds_read_b64_tr_b16 v[76:77], v6 offset:16384
v_mfma_f32_16x16x32_bf16 v[204:207], v[124:127], v[84:87], v[204:207]
ds_read_b64_tr_b16 v[78:79], v6 offset:16896
v_mfma_f32_16x16x32_bf16 v[168:171], v[120:123], v[84:87], v[168:171]
ds_read_b64_tr_b16 v[68:69], v6 offset:0
v_mfma_f32_16x16x32_bf16 v[172:175], v[120:123], v[88:91], v[172:175]
ds_read_b64_tr_b16 v[70:71], v6 offset:512
v_mfma_f32_16x16x32_bf16 v[208:211], v[124:127], v[88:91], v[208:211]
ds_read_b128 v[36:39], v2 offset:2048
v_mfma_f32_16x16x32_bf16 v[136:139], v[116:119], v[88:91], v[136:139]
ds_read_b128 v[40:43], v2 offset:4096
v_mfma_f32_16x16x32_bf16 v[140:143], v[116:119], v[92:95], v[140:143]
ds_read_b128 v[44:47], v2 offset:6144
v_mfma_f32_16x16x32_bf16 v[212:215], v[124:127], v[92:95], v[212:215]
ds_read_b128 v[48:51], v2 offset:8192
v_mfma_f32_16x16x32_bf16 v[176:179], v[120:123], v[92:95], v[176:179]
ds_read_b128 v[52:55], v2 offset:10240
v_mfma_f32_16x16x32_bf16 v[180:183], v[120:123], v[96:99], v[180:183]
ds_read_b128 v[56:59], v2 offset:12288
v_mfma_f32_16x16x32_bf16 v[216:219], v[124:127], v[96:99], v[216:219]
ds_read_b128 v[60:63], v2 offset:14336
v_mfma_f32_16x16x32_bf16 v[144:147], v[116:119], v[96:99], v[144:147]
ds_read_b128 v[64:67], v2 offset:16384
v_mfma_f32_16x16x32_bf16 v[148:151], v[116:119], v[100:103], v[148:151]
v_mfma_f32_16x16x32_bf16 v[220:223], v[124:127], v[100:103], v[220:223]
v_mfma_f32_16x16x32_bf16 v[184:187], v[120:123], v[100:103], v[184:187]
v_mfma_f32_16x16x32_bf16 v[188:191], v[120:123], v[104:107], v[188:191]
v_mfma_f32_16x16x32_bf16 v[224:227], v[124:127], v[104:107], v[224:227]
v_mfma_f32_16x16x32_bf16 v[152:155], v[116:119], v[104:107], v[152:155]
v_mfma_f32_16x16x32_bf16 v[156:159], v[116:119], v[108:111], v[156:159]
v_mfma_f32_16x16x32_bf16 v[228:231], v[124:127], v[108:111], v[228:231]
v_mfma_f32_16x16x32_bf16 v[192:195], v[120:123], v[108:111], v[192:195]
v_mfma_f32_16x16x32_bf16 v[196:199], v[120:123], v[112:115], v[196:199]
v_mfma_f32_16x16x32_bf16 v[232:235], v[124:127], v[112:115], v[232:235]
v_mfma_f32_16x16x32_bf16 v[160:163], v[116:119], v[112:115], v[160:163]
s_mov_b32 s41, 4
Lcl_19:
s_waitcnt lgkmcnt(0)
v_mfma_f32_16x16x32_bf16 v[164:167], v[72:75], v[32:35], v[164:167]
ds_read_b128 v[80:83], v3 offset:0
v_mfma_f32_16x16x32_bf16 v[200:203], v[76:79], v[32:35], v[200:203]
ds_read_b64_tr_b16 v[120:121], v6 offset:12288
v_mfma_f32_16x16x32_bf16 v[128:131], v[68:71], v[32:35], v[128:131]
ds_read_b64_tr_b16 v[122:123], v6 offset:12800
v_mfma_f32_16x16x32_bf16 v[132:135], v[68:71], v[36:39], v[132:135]
ds_read_b64_tr_b16 v[124:125], v6 offset:20480
v_mfma_f32_16x16x32_bf16 v[204:207], v[76:79], v[36:39], v[204:207]
ds_read_b64_tr_b16 v[126:127], v6 offset:20992
v_mfma_f32_16x16x32_bf16 v[168:171], v[72:75], v[36:39], v[168:171]
ds_read_b64_tr_b16 v[116:117], v6 offset:4096
v_mfma_f32_16x16x32_bf16 v[172:175], v[72:75], v[40:43], v[172:175]
ds_read_b64_tr_b16 v[118:119], v6 offset:4608
v_mfma_f32_16x16x32_bf16 v[208:211], v[76:79], v[40:43], v[208:211]
ds_read_b128 v[84:87], v3 offset:2048
v_mfma_f32_16x16x32_bf16 v[136:139], v[68:71], v[40:43], v[136:139]
ds_read_b128 v[88:91], v3 offset:4096
v_mfma_f32_16x16x32_bf16 v[140:143], v[68:71], v[44:47], v[140:143]
ds_read_b128 v[92:95], v3 offset:6144
v_mfma_f32_16x16x32_bf16 v[212:215], v[76:79], v[44:47], v[212:215]
ds_read_b128 v[96:99], v3 offset:8192
v_mfma_f32_16x16x32_bf16 v[176:179], v[72:75], v[44:47], v[176:179]
ds_read_b128 v[100:103], v3 offset:10240
v_mfma_f32_16x16x32_bf16 v[180:183], v[72:75], v[48:51], v[180:183]
ds_read_b128 v[104:107], v3 offset:12288
v_mfma_f32_16x16x32_bf16 v[216:219], v[76:79], v[48:51], v[216:219]
ds_read_b128 v[108:111], v3 offset:14336
v_mfma_f32_16x16x32_bf16 v[144:147], v[68:71], v[48:51], v[144:147]
ds_read_b128 v[112:115], v3 offset:16384
v_mfma_f32_16x16x32_bf16 v[148:151], v[68:71], v[52:55], v[148:151]
v_mfma_f32_16x16x32_bf16 v[220:223], v[76:79], v[52:55], v[220:223]
v_mfma_f32_16x16x32_bf16 v[184:187], v[72:75], v[52:55], v[184:187]
v_mfma_f32_16x16x32_bf16 v[188:191], v[72:75], v[56:59], v[188:191]
v_mfma_f32_16x16x32_bf16 v[224:227], v[76:79], v[56:59], v[224:227]
v_mfma_f32_16x16x32_bf16 v[152:155], v[68:71], v[56:59], v[152:155]
v_mfma_f32_16x16x32_bf16 v[156:159], v[68:71], v[60:63], v[156:159]
v_mfma_f32_16x16x32_bf16 v[228:231], v[76:79], v[60:63], v[228:231]
v_mfma_f32_16x16x32_bf16 v[192:195], v[72:75], v[60:63], v[192:195]
v_mfma_f32_16x16x32_bf16 v[196:199], v[72:75], v[64:67], v[196:199]
v_mfma_f32_16x16x32_bf16 v[232:235], v[76:79], v[64:67], v[232:235]
v_mfma_f32_16x16x32_bf16 v[160:163], v[68:71], v[64:67], v[160:163]
s_waitcnt lgkmcnt(0)
s_barrier
v_mfma_f32_16x16x32_bf16 v[164:167], v[120:123], v[80:83], v[164:167]
ds_read_b128 v[32:35], v2 offset:43008
v_mfma_f32_16x16x32_bf16 v[200:203], v[124:127], v[80:83], v[200:203]
ds_read_b64_tr_b16 v[72:73], v7 offset:8192
v_mfma_f32_16x16x32_bf16 v[128:131], v[116:119], v[80:83], v[128:131]
ds_read_b64_tr_b16 v[74:75], v7 offset:8704
s_branch Lov_2
.p2align 12
Lst_2_0:
s_branch Lwr_142
s_nop 0
s_nop 0
Lov_2:
v_mfma_f32_16x16x32_bf16 v[132:135], v[116:119], v[84:87], v[132:135]
ds_read_b64_tr_b16 v[76:77], v7 offset:16384
v_mfma_f32_16x16x32_bf16 v[204:207], v[124:127], v[84:87], v[204:207]
ds_read_b64_tr_b16 v[78:79], v7 offset:16896
v_mfma_f32_16x16x32_bf16 v[168:171], v[120:123], v[84:87], v[168:171]
ds_read_b64_tr_b16 v[68:69], v7 offset:0
v_mfma_f32_16x16x32_bf16 v[172:175], v[120:123], v[88:91], v[172:175]
ds_read_b64_tr_b16 v[70:71], v7 offset:512
v_mfma_f32_16x16x32_bf16 v[208:211], v[124:127], v[88:91], v[208:211]
ds_read_b128 v[36:39], v2 offset:45056
v_mfma_f32_16x16x32_bf16 v[136:139], v[116:119], v[88:91], v[136:139]
ds_read_b128 v[40:43], v2 offset:47104
v_mfma_f32_16x16x32_bf16 v[140:143], v[116:119], v[92:95], v[140:143]
ds_read_b128 v[44:47], v2 offset:49152
v_mfma_f32_16x16x32_bf16 v[212:215], v[124:127], v[92:95], v[212:215]
ds_read_b128 v[48:51], v2 offset:51200
v_mfma_f32_16x16x32_bf16 v[176:179], v[120:123], v[92:95], v[176:179]
ds_read_b128 v[52:55], v2 offset:53248
v_mfma_f32_16x16x32_bf16 v[180:183], v[120:123], v[96:99], v[180:183]
ds_read_b128 v[56:59], v2 offset:55296
v_mfma_f32_16x16x32_bf16 v[216:219], v[124:127], v[96:99], v[216:219]
ds_read_b128 v[60:63], v2 offset:57344
v_mfma_f32_16x16x32_bf16 v[144:147], v[116:119], v[96:99], v[144:147]
ds_read_b128 v[64:67], v2 offset:59392
v_mfma_f32_16x16x32_bf16 v[148:151], v[116:119], v[100:103], v[148:151]
v_mfma_f32_16x16x32_bf16 v[220:223], v[124:127], v[100:103], v[220:223]
v_mfma_f32_16x16x32_bf16 v[184:187], v[120:123], v[100:103], v[184:187]
v_mfma_f32_16x16x32_bf16 v[188:191], v[120:123], v[104:107], v[188:191]
v_mfma_f32_16x16x32_bf16 v[224:227], v[124:127], v[104:107], v[224:227]
v_mfma_f32_16x16x32_bf16 v[152:155], v[116:119], v[104:107], v[152:155]
v_mfma_f32_16x16x32_bf16 v[156:159], v[116:119], v[108:111], v[156:159]
v_mfma_f32_16x16x32_bf16 v[228:231], v[124:127], v[108:111], v[228:231]
v_mfma_f32_16x16x32_bf16 v[192:195], v[120:123], v[108:111], v[192:195]
v_mfma_f32_16x16x32_bf16 v[196:199], v[120:123], v[112:115], v[196:199]
v_mfma_f32_16x16x32_bf16 v[232:235], v[124:127], v[112:115], v[232:235]
v_mfma_f32_16x16x32_bf16 v[160:163], v[116:119], v[112:115], v[160:163]
s_waitcnt lgkmcnt(0)
v_mfma_f32_16x16x32_bf16 v[164:167], v[72:75], v[32:35], v[164:167]
ds_read_b128 v[80:83], v3 offset:43008
v_mfma_f32_16x16x32_bf16 v[200:203], v[76:79], v[32:35], v[200:203]
ds_read_b64_tr_b16 v[120:121], v7 offset:12288
v_mfma_f32_16x16x32_bf16 v[128:131], v[68:71], v[32:35], v[128:131]
ds_read_b64_tr_b16 v[122:123], v7 offset:12800
v_mfma_f32_16x16x32_bf16 v[132:135], v[68:71], v[36:39], v[132:135]
ds_read_b64_tr_b16 v[124:125], v7 offset:20480
v_mfma_f32_16x16x32_bf16 v[204:207], v[76:79], v[36:39], v[204:207]
ds_read_b64_tr_b16 v[126:127], v7 offset:20992
v_mfma_f32_16x16x32_bf16 v[168:171], v[72:75], v[36:39], v[168:171]
ds_read_b64_tr_b16 v[116:117], v7 offset:4096
v_mfma_f32_16x16x32_bf16 v[172:175], v[72:75], v[40:43], v[172:175]
ds_read_b64_tr_b16 v[118:119], v7 offset:4608
v_mfma_f32_16x16x32_bf16 v[208:211], v[76:79], v[40:43], v[208:211]
ds_read_b128 v[84:87], v3 offset:45056
v_mfma_f32_16x16x32_bf16 v[136:139], v[68:71], v[40:43], v[136:139]
ds_read_b128 v[88:91], v3 offset:47104
v_mfma_f32_16x16x32_bf16 v[140:143], v[68:71], v[44:47], v[140:143]
ds_read_b128 v[92:95], v3 offset:49152
v_mfma_f32_16x16x32_bf16 v[212:215], v[76:79], v[44:47], v[212:215]
ds_read_b128 v[96:99], v3 offset:51200
v_mfma_f32_16x16x32_bf16 v[176:179], v[72:75], v[44:47], v[176:179]
ds_read_b128 v[100:103], v3 offset:53248
v_mfma_f32_16x16x32_bf16 v[180:183], v[72:75], v[48:51], v[180:183]
ds_read_b128 v[104:107], v3 offset:55296
v_mfma_f32_16x16x32_bf16 v[216:219], v[76:79], v[48:51], v[216:219]
ds_read_b128 v[108:111], v3 offset:57344
v_mfma_f32_16x16x32_bf16 v[144:147], v[68:71], v[48:51], v[144:147]
ds_read_b128 v[112:115], v3 offset:59392
v_mfma_f32_16x16x32_bf16 v[148:151], v[68:71], v[52:55], v[148:151]
v_mfma_f32_16x16x32_bf16 v[220:223], v[76:79], v[52:55], v[220:223]
v_mfma_f32_16x16x32_bf16 v[184:187], v[72:75], v[52:55], v[184:187]
v_mfma_f32_16x16x32_bf16 v[188:191], v[72:75], v[56:59], v[188:191]
v_mfma_f32_16x16x32_bf16 v[224:227], v[76:79], v[56:59], v[224:227]
v_mfma_f32_16x16x32_bf16 v[152:155], v[68:71], v[56:59], v[152:155]
v_mfma_f32_16x16x32_bf16 v[156:159], v[68:71], v[60:63], v[156:159]
v_mfma_f32_16x16x32_bf16 v[228:231], v[76:79], v[60:63], v[228:231]
v_mfma_f32_16x16x32_bf16 v[192:195], v[72:75], v[60:63], v[192:195]
v_mfma_f32_16x16x32_bf16 v[196:199], v[72:75], v[64:67], v[196:199]
v_mfma_f32_16x16x32_bf16 v[232:235], v[76:79], v[64:67], v[232:235]
v_mfma_f32_16x16x32_bf16 v[160:163], v[68:71], v[64:67], v[160:163]
s_waitcnt lgkmcnt(0)
s_barrier
v_mfma_f32_16x16x32_bf16 v[164:167], v[120:123], v[80:83], v[164:167]
ds_read_b128 v[32:35], v4 offset:0
v_mfma_f32_16x16x32_bf16 v[200:203], v[124:127], v[80:83], v[200:203]
ds_read_b64_tr_b16 v[72:73], v8 offset:8192
v_mfma_f32_16x16x32_bf16 v[128:131], v[116:119], v[80:83], v[128:131]
ds_read_b64_tr_b16 v[74:75], v8 offset:8704
v_mfma_f32_16x16x32_bf16 v[132:135], v[116:119], v[84:87], v[132:135]
ds_read_b64_tr_b16 v[76:77], v8 offset:16384
v_mfma_f32_16x16x32_bf16 v[204:207], v[124:127], v[84:87], v[204:207]
ds_read_b64_tr_b16 v[78:79], v8 offset:16896
v_mfma_f32_16x16x32_bf16 v[168:171], v[120:123], v[84:87], v[168:171]
ds_read_b64_tr_b16 v[68:69], v8 offset:0
v_mfma_f32_16x16x32_bf16 v[172:175], v[120:123], v[88:91], v[172:175]
ds_read_b64_tr_b16 v[70:71], v8 offset:512
v_mfma_f32_16x16x32_bf16 v[208:211], v[124:127], v[88:91], v[208:211]
ds_read_b128 v[36:39], v4 offset:2048
v_mfma_f32_16x16x32_bf16 v[136:139], v[116:119], v[88:91], v[136:139]
ds_read_b128 v[40:43], v4 offset:4096
v_mfma_f32_16x16x32_bf16 v[140:143], v[116:119], v[92:95], v[140:143]
ds_read_b128 v[44:47], v4 offset:6144
v_mfma_f32_16x16x32_bf16 v[212:215], v[124:127], v[92:95], v[212:215]
ds_read_b128 v[48:51], v4 offset:8192
v_mfma_f32_16x16x32_bf16 v[176:179], v[120:123], v[92:95], v[176:179]
ds_read_b128 v[52:55], v4 offset:10240
v_mfma_f32_16x16x32_bf16 v[180:183], v[120:123], v[96:99], v[180:183]
ds_read_b128 v[56:59], v4 offset:12288
v_mfma_f32_16x16x32_bf16 v[216:219], v[124:127], v[96:99], v[216:219]
ds_read_b128 v[60:63], v4 offset:14336
v_mfma_f32_16x16x32_bf16 v[144:147], v[116:119], v[96:99], v[144:147]
ds_read_b128 v[64:67], v4 offset:16384
v_mfma_f32_16x16x32_bf16 v[148:151], v[116:119], v[100:103], v[148:151]
v_mfma_f32_16x16x32_bf16 v[220:223], v[124:127], v[100:103], v[220:223]
v_mfma_f32_16x16x32_bf16 v[184:187], v[120:123], v[100:103], v[184:187]
v_mfma_f32_16x16x32_bf16 v[188:191], v[120:123], v[104:107], v[188:191]
v_mfma_f32_16x16x32_bf16 v[224:227], v[124:127], v[104:107], v[224:227]
v_mfma_f32_16x16x32_bf16 v[152:155], v[116:119], v[104:107], v[152:155]
v_mfma_f32_16x16x32_bf16 v[156:159], v[116:119], v[108:111], v[156:159]
v_mfma_f32_16x16x32_bf16 v[228:231], v[124:127], v[108:111], v[228:231]
v_mfma_f32_16x16x32_bf16 v[192:195], v[120:123], v[108:111], v[192:195]
v_mfma_f32_16x16x32_bf16 v[196:199], v[120:123], v[112:115], v[196:199]
v_mfma_f32_16x16x32_bf16 v[232:235], v[124:127], v[112:115], v[232:235]
v_mfma_f32_16x16x32_bf16 v[160:163], v[116:119], v[112:115], v[160:163]
s_waitcnt lgkmcnt(0)
v_mfma_f32_16x16x32_bf16 v[164:167], v[72:75], v[32:35], v[164:167]
ds_read_b128 v[80:83], v5 offset:0
v_mfma_f32_16x16x32_bf16 v[200:203], v[76:79], v[32:35], v[200:203]
ds_read_b64_tr_b16 v[120:121], v8 offset:12288
v_mfma_f32_16x16x32_bf16 v[128:131], v[68:71], v[32:35], v[128:131]
ds_read_b64_tr_b16 v[122:123], v8 offset:12800
v_mfma_f32_16x16x32_bf16 v[132:135], v[68:71], v[36:39], v[132:135]
ds_read_b64_tr_b16 v[124:125], v8 offset:20480
v_mfma_f32_16x16x32_bf16 v[204:207], v[76:79], v[36:39], v[204:207]
ds_read_b64_tr_b16 v[126:127], v8 offset:20992
v_mfma_f32_16x16x32_bf16 v[168:171], v[72:75], v[36:39], v[168:171]
ds_read_b64_tr_b16 v[116:117], v8 offset:4096
v_mfma_f32_16x16x32_bf16 v[172:175], v[72:75], v[40:43], v[172:175]
ds_read_b64_tr_b16 v[118:119], v8 offset:4608
v_mfma_f32_16x16x32_bf16 v[208:211], v[76:79], v[40:43], v[208:211]
ds_read_b128 v[84:87], v5 offset:2048
v_mfma_f32_16x16x32_bf16 v[136:139], v[68:71], v[40:43], v[136:139]
ds_read_b128 v[88:91], v5 offset:4096
v_mfma_f32_16x16x32_bf16 v[140:143], v[68:71], v[44:47], v[140:143]
ds_read_b128 v[92:95], v5 offset:6144
v_mfma_f32_16x16x32_bf16 v[212:215], v[76:79], v[44:47], v[212:215]
ds_read_b128 v[96:99], v5 offset:8192
v_mfma_f32_16x16x32_bf16 v[176:179], v[72:75], v[44:47], v[176:179]
ds_read_b128 v[100:103], v5 offset:10240
v_mfma_f32_16x16x32_bf16 v[180:183], v[72:75], v[48:51], v[180:183]
ds_read_b128 v[104:107], v5 offset:12288
v_mfma_f32_16x16x32_bf16 v[216:219], v[76:79], v[48:51], v[216:219]
ds_read_b128 v[108:111], v5 offset:14336
v_mfma_f32_16x16x32_bf16 v[144:147], v[68:71], v[48:51], v[144:147]
ds_read_b128 v[112:115], v5 offset:16384
v_mfma_f32_16x16x32_bf16 v[148:151], v[68:71], v[52:55], v[148:151]
v_mfma_f32_16x16x32_bf16 v[220:223], v[76:79], v[52:55], v[220:223]
v_mfma_f32_16x16x32_bf16 v[184:187], v[72:75], v[52:55], v[184:187]
v_mfma_f32_16x16x32_bf16 v[188:191], v[72:75], v[56:59], v[188:191]
v_mfma_f32_16x16x32_bf16 v[224:227], v[76:79], v[56:59], v[224:227]
v_mfma_f32_16x16x32_bf16 v[152:155], v[68:71], v[56:59], v[152:155]
v_mfma_f32_16x16x32_bf16 v[156:159], v[68:71], v[60:63], v[156:159]
v_mfma_f32_16x16x32_bf16 v[228:231], v[76:79], v[60:63], v[228:231]
v_mfma_f32_16x16x32_bf16 v[192:195], v[72:75], v[60:63], v[192:195]
v_mfma_f32_16x16x32_bf16 v[196:199], v[72:75], v[64:67], v[196:199]
v_mfma_f32_16x16x32_bf16 v[232:235], v[76:79], v[64:67], v[232:235]
v_mfma_f32_16x16x32_bf16 v[160:163], v[68:71], v[64:67], v[160:163]
s_waitcnt lgkmcnt(0)
s_barrier
v_mfma_f32_16x16x32_bf16 v[164:167], v[120:123], v[80:83], v[164:167]
ds_read_b128 v[32:35], v2 offset:0
v_mfma_f32_16x16x32_bf16 v[200:203], v[124:127], v[80:83], v[200:203]
ds_read_b64_tr_b16 v[72:73], v6 offset:8192
v_mfma_f32_16x16x32_bf16 v[128:131], v[116:119], v[80:83], v[128:131]
ds_read_b64_tr_b16 v[74:75], v6 offset:8704
v_mfma_f32_16x16x32_bf16 v[132:135], v[116:119], v[84:87], v[132:135]
ds_read_b64_tr_b16 v[76:77], v6 offset:16384
v_mfma_f32_16x16x32_bf16 v[204:207], v[124:127], v[84:87], v[204:207]
ds_read_b64_tr_b16 v[78:79], v6 offset:16896
v_mfma_f32_16x16x32_bf16 v[168:171], v[120:123], v[84:87], v[168:171]
ds_read_b64_tr_b16 v[68:69], v6 offset:0
v_mfma_f32_16x16x32_bf16 v[172:175], v[120:123], v[88:91], v[172:175]
ds_read_b64_tr_b16 v[70:71], v6 offset:512
v_mfma_f32_16x16x32_bf16 v[208:211], v[124:127], v[88:91], v[208:211]
ds_read_b128 v[36:39], v2 offset:2048
v_mfma_f32_16x16x32_bf16 v[136:139], v[116:119], v[88:91], v[136:139]
ds_read_b128 v[40:43], v2 offset:4096
v_mfma_f32_16x16x32_bf16 v[140:143], v[116:119], v[92:95], v[140:143]
ds_read_b128 v[44:47], v2 offset:6144
v_mfma_f32_16x16x32_bf16 v[212:215], v[124:127], v[92:95], v[212:215]
ds_read_b128 v[48:51], v2 offset:8192
v_mfma_f32_16x16x32_bf16 v[176:179], v[120:123], v[92:95], v[176:179]
ds_read_b128 v[52:55], v2 offset:10240
v_mfma_f32_16x16x32_bf16 v[180:183], v[120:123], v[96:99], v[180:183]
ds_read_b128 v[56:59], v2 offset:12288
v_mfma_f32_16x16x32_bf16 v[216:219], v[124:127], v[96:99], v[216:219]
ds_read_b128 v[60:63], v2 offset:14336
v_mfma_f32_16x16x32_bf16 v[144:147], v[116:119], v[96:99], v[144:147]
ds_read_b128 v[64:67], v2 offset:16384
v_mfma_f32_16x16x32_bf16 v[148:151], v[116:119], v[100:103], v[148:151]
v_mfma_f32_16x16x32_bf16 v[220:223], v[124:127], v[100:103], v[220:223]
v_mfma_f32_16x16x32_bf16 v[184:187], v[120:123], v[100:103], v[184:187]
v_mfma_f32_16x16x32_bf16 v[188:191], v[120:123], v[104:107], v[188:191]
v_mfma_f32_16x16x32_bf16 v[224:227], v[124:127], v[104:107], v[224:227]
v_mfma_f32_16x16x32_bf16 v[152:155], v[116:119], v[104:107], v[152:155]
v_mfma_f32_16x16x32_bf16 v[156:159], v[116:119], v[108:111], v[156:159]
v_mfma_f32_16x16x32_bf16 v[228:231], v[124:127], v[108:111], v[228:231]
v_mfma_f32_16x16x32_bf16 v[192:195], v[120:123], v[108:111], v[192:195]
v_mfma_f32_16x16x32_bf16 v[196:199], v[120:123], v[112:115], v[196:199]
v_mfma_f32_16x16x32_bf16 v[232:235], v[124:127], v[112:115], v[232:235]
v_mfma_f32_16x16x32_bf16 v[160:163], v[116:119], v[112:115], v[160:163]
s_sub_u32 s41, s41, 1
s_cmp_lg_u32 s41, 0
s_cbranch_scc1 Lcl_19
s_waitcnt lgkmcnt(0)
v_mfma_f32_16x16x32_bf16 v[164:167], v[72:75], v[32:35], v[164:167]
ds_read_b128 v[80:83], v3 offset:0
v_mfma_f32_16x16x32_bf16 v[200:203], v[76:79], v[32:35], v[200:203]
ds_read_b64_tr_b16 v[120:121], v6 offset:12288
v_mfma_f32_16x16x32_bf16 v[128:131], v[68:71], v[32:35], v[128:131]
ds_read_b64_tr_b16 v[122:123], v6 offset:12800
v_mfma_f32_16x16x32_bf16 v[132:135], v[68:71], v[36:39], v[132:135]
ds_read_b64_tr_b16 v[124:125], v6 offset:20480
v_mfma_f32_16x16x32_bf16 v[204:207], v[76:79], v[36:39], v[204:207]
ds_read_b64_tr_b16 v[126:127], v6 offset:20992
v_mfma_f32_16x16x32_bf16 v[168:171], v[72:75], v[36:39], v[168:171]
ds_read_b64_tr_b16 v[116:117], v6 offset:4096
v_mfma_f32_16x16x32_bf16 v[172:175], v[72:75], v[40:43], v[172:175]
ds_read_b64_tr_b16 v[118:119], v6 offset:4608
v_mfma_f32_16x16x32_bf16 v[208:211], v[76:79], v[40:43], v[208:211]
ds_read_b128 v[84:87], v3 offset:2048
v_mfma_f32_16x16x32_bf16 v[136:139], v[68:71], v[40:43], v[136:139]
ds_read_b128 v[88:91], v3 offset:4096
v_mfma_f32_16x16x32_bf16 v[140:143], v[68:71], v[44:47], v[140:143]
ds_read_b128 v[92:95], v3 offset:6144
v_mfma_f32_16x16x32_bf16 v[212:215], v[76:79], v[44:47], v[212:215]
ds_read_b128 v[96:99], v3 offset:8192
v_mfma_f32_16x16x32_bf16 v[176:179], v[72:75], v[44:47], v[176:179]
ds_read_b128 v[100:103], v3 offset:10240
v_mfma_f32_16x16x32_bf16 v[180:183], v[72:75], v[48:51], v[180:183]
ds_read_b128 v[104:107], v3 offset:12288
v_mfma_f32_16x16x32_bf16 v[216:219], v[76:79], v[48:51], v[216:219]
ds_read_b128 v[108:111], v3 offset:14336
v_mfma_f32_16x16x32_bf16 v[144:147], v[68:71], v[48:51], v[144:147]
ds_read_b128 v[112:115], v3 offset:16384
v_mfma_f32_16x16x32_bf16 v[148:151], v[68:71], v[52:55], v[148:151]
v_mfma_f32_16x16x32_bf16 v[220:223], v[76:79], v[52:55], v[220:223]
v_mfma_f32_16x16x32_bf16 v[184:187], v[72:75], v[52:55], v[184:187]
v_mfma_f32_16x16x32_bf16 v[188:191], v[72:75], v[56:59], v[188:191]
v_mfma_f32_16x16x32_bf16 v[224:227], v[76:79], v[56:59], v[224:227]
v_mfma_f32_16x16x32_bf16 v[152:155], v[68:71], v[56:59], v[152:155]
v_mfma_f32_16x16x32_bf16 v[156:159], v[68:71], v[60:63], v[156:159]
v_mfma_f32_16x16x32_bf16 v[228:231], v[76:79], v[60:63], v[228:231]
v_mfma_f32_16x16x32_bf16 v[192:195], v[72:75], v[60:63], v[192:195]
v_mfma_f32_16x16x32_bf16 v[196:199], v[72:75], v[64:67], v[196:199]
v_mfma_f32_16x16x32_bf16 v[232:235], v[76:79], v[64:67], v[232:235]
v_mfma_f32_16x16x32_bf16 v[160:163], v[68:71], v[64:67], v[160:163]
s_waitcnt lgkmcnt(0)
v_mfma_f32_16x16x32_bf16 v[164:167], v[120:123], v[80:83], v[164:167]
v_mfma_f32_16x16x32_bf16 v[200:203], v[124:127], v[80:83], v[200:203]
v_mfma_f32_16x16x32_bf16 v[128:131], v[116:119], v[80:83], v[128:131]
v_mfma_f32_16x16x32_bf16 v[132:135], v[116:119], v[84:87], v[132:135]
v_mfma_f32_16x16x32_bf16 v[204:207], v[124:127], v[84:87], v[204:207]
v_mfma_f32_16x16x32_bf16 v[168:171], v[120:123], v[84:87], v[168:171]
v_mfma_f32_16x16x32_bf16 v[172:175], v[120:123], v[88:91], v[172:175]
v_mfma_f32_16x16x32_bf16 v[208:211], v[124:127], v[88:91], v[208:211]
v_mfma_f32_16x16x32_bf16 v[136:139], v[116:119], v[88:91], v[136:139]
v_mfma_f32_16x16x32_bf16 v[140:143], v[116:119], v[92:95], v[140:143]
v_mfma_f32_16x16x32_bf16 v[212:215], v[124:127], v[92:95], v[212:215]
v_mfma_f32_16x16x32_bf16 v[176:179], v[120:123], v[92:95], v[176:179]
v_mfma_f32_16x16x32_bf16 v[180:183], v[120:123], v[96:99], v[180:183]
v_mfma_f32_16x16x32_bf16 v[216:219], v[124:127], v[96:99], v[216:219]
v_mfma_f32_16x16x32_bf16 v[144:147], v[116:119], v[96:99], v[144:147]
v_mfma_f32_16x16x32_bf16 v[148:151], v[116:119], v[100:103], v[148:151]
v_mfma_f32_16x16x32_bf16 v[220:223], v[124:127], v[100:103], v[220:223]
v_mfma_f32_16x16x32_bf16 v[184:187], v[120:123], v[100:103], v[184:187]
v_mfma_f32_16x16x32_bf16 v[188:191], v[120:123], v[104:107], v[188:191]
v_mfma_f32_16x16x32_bf16 v[224:227], v[124:127], v[104:107], v[224:227]
v_mfma_f32_16x16x32_bf16 v[152:155], v[116:119], v[104:107], v[152:155]
v_mfma_f32_16x16x32_bf16 v[156:159], v[116:119], v[108:111], v[156:159]
v_mfma_f32_16x16x32_bf16 v[228:231], v[124:127], v[108:111], v[228:231]
v_mfma_f32_16x16x32_bf16 v[192:195], v[120:123], v[108:111], v[192:195]
v_mfma_f32_16x16x32_bf16 v[196:199], v[120:123], v[112:115], v[196:199]
v_mfma_f32_16x16x32_bf16 v[232:235], v[124:127], v[112:115], v[232:235]
v_mfma_f32_16x16x32_bf16 v[160:163], v[116:119], v[112:115], v[160:163]
v_lshlrev_b32 v14, 3, v12
v_add_u32 v14, 147456, v14
v_mul_u32_u24 v15, 400, v12
v_lshl_add_u32 v15, v13, 3, v15
s_lshl_b32 s43, s36, 5
v_add_u32 v15, s43, v15
s_barrier
ds_read_b64 v[32:33], v14 offset:0
ds_read_b64 v[34:35], v14 offset:128
ds_read_b64 v[36:37], v14 offset:256
ds_read_b64 v[38:39], v14 offset:384
ds_read_b64 v[40:41], v14 offset:512
ds_read_b64 v[42:43], v14 offset:640
ds_read_b64 v[44:45], v14 offset:768
ds_read_b64 v[46:47], v14 offset:896
ds_read_b64 v[48:49], v14 offset:1024
v_mov_b32_dpp v52, v128 row_newbcast:0 row_mask:0xf bank_mask:0xf
v_mov_b32_dpp v53, v129 row_newbcast:0 row_mask:0xf bank_mask:0xf
v_mov_b32_dpp v54, v130 row_newbcast:0 row_mask:0xf bank_mask:0xf
v_mov_b32_dpp v55, v131 row_newbcast:0 row_mask:0xf bank_mask:0xf
v_mov_b32_dpp v56, v164 row_newbcast:0 row_mask:0xf bank_mask:0xf
v_mov_b32_dpp v57, v165 row_newbcast:0 row_mask:0xf bank_mask:0xf
v_mov_b32_dpp v58, v166 row_newbcast:0 row_mask:0xf bank_mask:0xf
v_mov_b32_dpp v59, v167 row_newbcast:0 row_mask:0xf bank_mask:0xf
v_mov_b32_dpp v60, v200 row_newbcast:0 row_mask:0xf bank_mask:0xf
v_mov_b32_dpp v61, v201 row_newbcast:0 row_mask:0xf bank_mask:0xf
v_mov_b32_dpp v62, v202 row_newbcast:0 row_mask:0xf bank_mask:0xf
v_mov_b32_dpp v63, v203 row_newbcast:0 row_mask:0xf bank_mask:0xf
s_waitcnt lgkmcnt(0)
v_pk_fma_f32 v[164:165], v[32:33], v[56:57], v[164:165] op_sel_hi:[0,1,1] neg_lo:[1,0,0] neg_hi:[1,0,0]
v_pk_fma_f32 v[166:167], v[32:33], v[58:59], v[166:167] op_sel_hi:[0,1,1] neg_lo:[1,0,0] neg_hi:[1,0,0]
v_pk_fma_f32 v[200:201], v[32:33], v[60:61], v[200:201] op_sel_hi:[0,1,1] neg_lo:[1,0,0] neg_hi:[1,0,0]
v_pk_fma_f32 v[202:203], v[32:33], v[62:63], v[202:203] op_sel_hi:[0,1,1] neg_lo:[1,0,0] neg_hi:[1,0,0]
v_pk_mul_f32 v[164:165], v[32:33], v[164:165] op_sel:[1,0] op_sel_hi:[1,1]
v_pk_mul_f32 v[166:167], v[32:33], v[166:167] op_sel:[1,0] op_sel_hi:[1,1]
v_pk_fma_f32 v[132:133], v[34:35], v[52:53], v[132:133] op_sel_hi:[0,1,1] neg_lo:[1,0,0] neg_hi:[1,0,0]
v_pk_fma_f32 v[134:135], v[34:35], v[54:55], v[134:135] op_sel_hi:[0,1,1] neg_lo:[1,0,0] neg_hi:[1,0,0]
v_pk_mul_f32 v[200:201], v[32:33], v[200:201] op_sel:[1,0] op_sel_hi:[1,1]
v_pk_mul_f32 v[202:203], v[32:33], v[202:203] op_sel:[1,0] op_sel_hi:[1,1]
v_cvt_pk_bf16_f32 v164, v164, v165
v_cvt_pk_bf16_f32 v165, v166, v167
ds_write_b64 v15, v[164:165] offset:128
v_pk_fma_f32 v[168:169], v[34:35], v[56:57], v[168:169] op_sel_hi:[0,1,1] neg_lo:[1,0,0] neg_hi:[1,0,0]
v_pk_fma_f32 v[170:171], v[34:35], v[58:59], v[170:171] op_sel_hi:[0,1,1] neg_lo:[1,0,0] neg_hi:[1,0,0]
v_pk_mul_f32 v[132:133], v[34:35], v[132:133] op_sel:[1,0] op_sel_hi:[1,1]
v_pk_mul_f32 v[134:135], v[34:35], v[134:135] op_sel:[1,0] op_sel_hi:[1,1]
v_cvt_pk_bf16_f32 v200, v200, v201
v_cvt_pk_bf16_f32 v201, v202, v203
ds_write_b64 v15, v[200:201] offset:256
v_pk_fma_f32 v[204:205], v[34:35], v[60:61], v[204:205] op_sel_hi:[0,1,1] neg_lo:[1,0,0] neg_hi:[1,0,0]
v_pk_fma_f32 v[206:207], v[34:35], v[62:63], v[206:207] op_sel_hi:[0,1,1] neg_lo:[1,0,0] neg_hi:[1,0,0]
v_pk_mul_f32 v[168:169], v[34:35], v[168:169] op_sel:[1,0] op_sel_hi:[1,1]
v_pk_mul_f32 v[170:171], v[34:35], v[170:171] op_sel:[1,0] op_sel_hi:[1,1]
v_cvt_pk_bf16_f32 v132, v132, v133
v_cvt_pk_bf16_f32 v133, v134, v135
ds_write_b64 v15, v[132:133] offset:6400
v_pk_fma_f32 v[136:137], v[36:37], v[52:53], v[136:137] op_sel_hi:[0,1,1] neg_lo:[1,0,0] neg_hi:[1,0,0]
v_pk_fma_f32 v[138:139], v[36:37], v[54:55], v[138:139] op_sel_hi:[0,1,1] neg_lo:[1,0,0] neg_hi:[1,0,0]
v_pk_mul_f32 v[204:205], v[34:35], v[204:205] op_sel:[1,0] op_sel_hi:[1,1]
v_pk_mul_f32 v[206:207], v[34:35], v[206:207] op_sel:[1,0] op_sel_hi:[1,1]
v_cvt_pk_bf16_f32 v168, v168, v169
v_cvt_pk_bf16_f32 v169, v170, v171
ds_write_b64 v15, v[168:169] offset:6528
v_pk_fma_f32 v[172:173], v[36:37], v[56:57], v[172:173] op_sel_hi:[0,1,1] neg_lo:[1,0,0] neg_hi:[1,0,0]
v_pk_fma_f32 v[174:175], v[36:37], v[58:59], v[174:175] op_sel_hi:[0,1,1] neg_lo:[1,0,0] neg_hi:[1,0,0]
v_pk_mul_f32 v[136:137], v[36:37], v[136:137] op_sel:[1,0] op_sel_hi:[1,1]
v_pk_mul_f32 v[138:139], v[36:37], v[138:139] op_sel:[1,0] op_sel_hi:[1,1]
v_cvt_pk_bf16_f32 v204, v204, v205
v_cvt_pk_bf16_f32 v205, v206, v207
ds_write_b64 v15, v[204:205] offset:6656
v_pk_fma_f32 v[208:209], v[36:37], v[60:61], v[208:209] op_sel_hi:[0,1,1] neg_lo:[1,0,0] neg_hi:[1,0,0]
v_pk_fma_f32 v[210:211], v[36:37], v[62:63], v[210:211] op_sel_hi:[0,1,1] neg_lo:[1,0,0] neg_hi:[1,0,0]
v_pk_mul_f32 v[172:173], v[36:37], v[172:173] op_sel:[1,0] op_sel_hi:[1,1]
v_pk_mul_f32 v[174:175], v[36:37], v[174:175] op_sel:[1,0] op_sel_hi:[1,1]
v_cvt_pk_bf16_f32 v136, v136, v137
v_cvt_pk_bf16_f32 v137, v138, v139
ds_write_b64 v15, v[136:137] offset:12800
v_pk_fma_f32 v[140:141], v[38:39], v[52:53], v[140:141] op_sel_hi:[0,1,1] neg_lo:[1,0,0] neg_hi:[1,0,0]
v_pk_fma_f32 v[142:143], v[38:39], v[54:55], v[142:143] op_sel_hi:[0,1,1] neg_lo:[1,0,0] neg_hi:[1,0,0]
v_pk_mul_f32 v[208:209], v[36:37], v[208:209] op_sel:[1,0] op_sel_hi:[1,1]
v_pk_mul_f32 v[210:211], v[36:37], v[210:211] op_sel:[1,0] op_sel_hi:[1,1]
v_cvt_pk_bf16_f32 v172, v172, v173
v_cvt_pk_bf16_f32 v173, v174, v175
ds_write_b64 v15, v[172:173] offset:12928
v_pk_fma_f32 v[176:177], v[38:39], v[56:57], v[176:177] op_sel_hi:[0,1,1] neg_lo:[1,0,0] neg_hi:[1,0,0]
v_pk_fma_f32 v[178:179], v[38:39], v[58:59], v[178:179] op_sel_hi:[0,1,1] neg_lo:[1,0,0] neg_hi:[1,0,0]
v_pk_mul_f32 v[140:141], v[38:39], v[140:141] op_sel:[1,0] op_sel_hi:[1,1]
v_pk_mul_f32 v[142:143], v[38:39], v[142:143] op_sel:[1,0] op_sel_hi:[1,1]
v_cvt_pk_bf16_f32 v208, v208, v209
v_cvt_pk_bf16_f32 v209, v210, v211
ds_write_b64 v15, v[208:209] offset:13056
v_pk_fma_f32 v[212:213], v[38:39], v[60:61], v[212:213] op_sel_hi:[0,1,1] neg_lo:[1,0,0] neg_hi:[1,0,0]
v_pk_fma_f32 v[214:215], v[38:39], v[62:63], v[214:215] op_sel_hi:[0,1,1] neg_lo:[1,0,0] neg_hi:[1,0,0]
v_pk_mul_f32 v[176:177], v[38:39], v[176:177] op_sel:[1,0] op_sel_hi:[1,1]
v_pk_mul_f32 v[178:179], v[38:39], v[178:179] op_sel:[1,0] op_sel_hi:[1,1]
v_cvt_pk_bf16_f32 v140, v140, v141
v_cvt_pk_bf16_f32 v141, v142, v143
ds_write_b64 v15, v[140:141] offset:19200
v_pk_fma_f32 v[144:145], v[40:41], v[52:53], v[144:145] op_sel_hi:[0,1,1] neg_lo:[1,0,0] neg_hi:[1,0,0]
v_pk_fma_f32 v[146:147], v[40:41], v[54:55], v[146:147] op_sel_hi:[0,1,1] neg_lo:[1,0,0] neg_hi:[1,0,0]
v_pk_mul_f32 v[212:213], v[38:39], v[212:213] op_sel:[1,0] op_sel_hi:[1,1]
v_pk_mul_f32 v[214:215], v[38:39], v[214:215] op_sel:[1,0] op_sel_hi:[1,1]
v_cvt_pk_bf16_f32 v176, v176, v177
v_cvt_pk_bf16_f32 v177, v178, v179
ds_write_b64 v15, v[176:177] offset:19328
v_pk_fma_f32 v[180:181], v[40:41], v[56:57], v[180:181] op_sel_hi:[0,1,1] neg_lo:[1,0,0] neg_hi:[1,0,0]
v_pk_fma_f32 v[182:183], v[40:41], v[58:59], v[182:183] op_sel_hi:[0,1,1] neg_lo:[1,0,0] neg_hi:[1,0,0]
v_pk_mul_f32 v[144:145], v[40:41], v[144:145] op_sel:[1,0] op_sel_hi:[1,1]
v_pk_mul_f32 v[146:147], v[40:41], v[146:147] op_sel:[1,0] op_sel_hi:[1,1]
v_cvt_pk_bf16_f32 v212, v212, v213
v_cvt_pk_bf16_f32 v213, v214, v215
ds_write_b64 v15, v[212:213] offset:19456
v_pk_fma_f32 v[216:217], v[40:41], v[60:61], v[216:217] op_sel_hi:[0,1,1] neg_lo:[1,0,0] neg_hi:[1,0,0]
v_pk_fma_f32 v[218:219], v[40:41], v[62:63], v[218:219] op_sel_hi:[0,1,1] neg_lo:[1,0,0] neg_hi:[1,0,0]
v_pk_mul_f32 v[180:181], v[40:41], v[180:181] op_sel:[1,0] op_sel_hi:[1,1]
v_pk_mul_f32 v[182:183], v[40:41], v[182:183] op_sel:[1,0] op_sel_hi:[1,1]
v_cvt_pk_bf16_f32 v144, v144, v145
v_cvt_pk_bf16_f32 v145, v146, v147
ds_write_b64 v15, v[144:145] offset:25600
v_pk_fma_f32 v[148:149], v[42:43], v[52:53], v[148:149] op_sel_hi:[0,1,1] neg_lo:[1,0,0] neg_hi:[1,0,0]
v_pk_fma_f32 v[150:151], v[42:43], v[54:55], v[150:151] op_sel_hi:[0,1,1] neg_lo:[1,0,0] neg_hi:[1,0,0]
v_pk_mul_f32 v[216:217], v[40:41], v[216:217] op_sel:[1,0] op_sel_hi:[1,1]
v_pk_mul_f32 v[218:219], v[40:41], v[218:219] op_sel:[1,0] op_sel_hi:[1,1]
v_cvt_pk_bf16_f32 v180, v180, v181
v_cvt_pk_bf16_f32 v181, v182, v183
ds_write_b64 v15, v[180:181] offset:25728
v_pk_fma_f32 v[184:185], v[42:43], v[56:57], v[184:185] op_sel_hi:[0,1,1] neg_lo:[1,0,0] neg_hi:[1,0,0]
v_pk_fma_f32 v[186:187], v[42:43], v[58:59], v[186:187] op_sel_hi:[0,1,1] neg_lo:[1,0,0] neg_hi:[1,0,0]
v_pk_mul_f32 v[148:149], v[42:43], v[148:149] op_sel:[1,0] op_sel_hi:[1,1]
v_pk_mul_f32 v[150:151], v[42:43], v[150:151] op_sel:[1,0] op_sel_hi:[1,1]
v_cvt_pk_bf16_f32 v216, v216, v217
v_cvt_pk_bf16_f32 v217, v218, v219
ds_write_b64 v15, v[216:217] offset:25856
v_pk_fma_f32 v[220:221], v[42:43], v[60:61], v[220:221] op_sel_hi:[0,1,1] neg_lo:[1,0,0] neg_hi:[1,0,0]
v_pk_fma_f32 v[222:223], v[42:43], v[62:63], v[222:223] op_sel_hi:[0,1,1] neg_lo:[1,0,0] neg_hi:[1,0,0]
v_pk_mul_f32 v[184:185], v[42:43], v[184:185] op_sel:[1,0] op_sel_hi:[1,1]
v_pk_mul_f32 v[186:187], v[42:43], v[186:187] op_sel:[1,0] op_sel_hi:[1,1]
v_cvt_pk_bf16_f32 v148, v148, v149
v_cvt_pk_bf16_f32 v149, v150, v151
ds_write_b64 v15, v[148:149] offset:32000
v_pk_fma_f32 v[152:153], v[44:45], v[52:53], v[152:153] op_sel_hi:[0,1,1] neg_lo:[1,0,0] neg_hi:[1,0,0]
v_pk_fma_f32 v[154:155], v[44:45], v[54:55], v[154:155] op_sel_hi:[0,1,1] neg_lo:[1,0,0] neg_hi:[1,0,0]
v_pk_mul_f32 v[220:221], v[42:43], v[220:221] op_sel:[1,0] op_sel_hi:[1,1]
v_pk_mul_f32 v[222:223], v[42:43], v[222:223] op_sel:[1,0] op_sel_hi:[1,1]
v_cvt_pk_bf16_f32 v184, v184, v185
v_cvt_pk_bf16_f32 v185, v186, v187
ds_write_b64 v15, v[184:185] offset:32128
v_pk_fma_f32 v[188:189], v[44:45], v[56:57], v[188:189] op_sel_hi:[0,1,1] neg_lo:[1,0,0] neg_hi:[1,0,0]
v_pk_fma_f32 v[190:191], v[44:45], v[58:59], v[190:191] op_sel_hi:[0,1,1] neg_lo:[1,0,0] neg_hi:[1,0,0]
v_pk_mul_f32 v[152:153], v[44:45], v[152:153] op_sel:[1,0] op_sel_hi:[1,1]
v_pk_mul_f32 v[154:155], v[44:45], v[154:155] op_sel:[1,0] op_sel_hi:[1,1]
v_cvt_pk_bf16_f32 v220, v220, v221
v_cvt_pk_bf16_f32 v221, v222, v223
ds_write_b64 v15, v[220:221] offset:32256
v_pk_fma_f32 v[224:225], v[44:45], v[60:61], v[224:225] op_sel_hi:[0,1,1] neg_lo:[1,0,0] neg_hi:[1,0,0]
v_pk_fma_f32 v[226:227], v[44:45], v[62:63], v[226:227] op_sel_hi:[0,1,1] neg_lo:[1,0,0] neg_hi:[1,0,0]
v_pk_mul_f32 v[188:189], v[44:45], v[188:189] op_sel:[1,0] op_sel_hi:[1,1]
v_pk_mul_f32 v[190:191], v[44:45], v[190:191] op_sel:[1,0] op_sel_hi:[1,1]
v_cvt_pk_bf16_f32 v152, v152, v153
v_cvt_pk_bf16_f32 v153, v154, v155
ds_write_b64 v15, v[152:153] offset:38400
v_pk_fma_f32 v[156:157], v[46:47], v[52:53], v[156:157] op_sel_hi:[0,1,1] neg_lo:[1,0,0] neg_hi:[1,0,0]
v_pk_fma_f32 v[158:159], v[46:47], v[54:55], v[158:159] op_sel_hi:[0,1,1] neg_lo:[1,0,0] neg_hi:[1,0,0]
v_pk_mul_f32 v[224:225], v[44:45], v[224:225] op_sel:[1,0] op_sel_hi:[1,1]
v_pk_mul_f32 v[226:227], v[44:45], v[226:227] op_sel:[1,0] op_sel_hi:[1,1]
v_cvt_pk_bf16_f32 v188, v188, v189
v_cvt_pk_bf16_f32 v189, v190, v191
ds_write_b64 v15, v[188:189] offset:38528
v_pk_fma_f32 v[192:193], v[46:47], v[56:57], v[192:193] op_sel_hi:[0,1,1] neg_lo:[1,0,0] neg_hi:[1,0,0]
v_pk_fma_f32 v[194:195], v[46:47], v[58:59], v[194:195] op_sel_hi:[0,1,1] neg_lo:[1,0,0] neg_hi:[1,0,0]
v_pk_mul_f32 v[156:157], v[46:47], v[156:157] op_sel:[1,0] op_sel_hi:[1,1]
v_pk_mul_f32 v[158:159], v[46:47], v[158:159] op_sel:[1,0] op_sel_hi:[1,1]
v_cvt_pk_bf16_f32 v224, v224, v225
v_cvt_pk_bf16_f32 v225, v226, v227
ds_write_b64 v15, v[224:225] offset:38656
v_pk_fma_f32 v[228:229], v[46:47], v[60:61], v[228:229] op_sel_hi:[0,1,1] neg_lo:[1,0,0] neg_hi:[1,0,0]
v_pk_fma_f32 v[230:231], v[46:47], v[62:63], v[230:231] op_sel_hi:[0,1,1] neg_lo:[1,0,0] neg_hi:[1,0,0]
v_pk_mul_f32 v[192:193], v[46:47], v[192:193] op_sel:[1,0] op_sel_hi:[1,1]
v_pk_mul_f32 v[194:195], v[46:47], v[194:195] op_sel:[1,0] op_sel_hi:[1,1]
v_cvt_pk_bf16_f32 v156, v156, v157
v_cvt_pk_bf16_f32 v157, v158, v159
ds_write_b64 v15, v[156:157] offset:44800
v_pk_fma_f32 v[160:161], v[48:49], v[52:53], v[160:161] op_sel_hi:[0,1,1] neg_lo:[1,0,0] neg_hi:[1,0,0]
v_pk_fma_f32 v[162:163], v[48:49], v[54:55], v[162:163] op_sel_hi:[0,1,1] neg_lo:[1,0,0] neg_hi:[1,0,0]
v_pk_mul_f32 v[228:229], v[46:47], v[228:229] op_sel:[1,0] op_sel_hi:[1,1]
v_pk_mul_f32 v[230:231], v[46:47], v[230:231] op_sel:[1,0] op_sel_hi:[1,1]
v_cvt_pk_bf16_f32 v192, v192, v193
v_cvt_pk_bf16_f32 v193, v194, v195
ds_write_b64 v15, v[192:193] offset:44928
v_pk_fma_f32 v[196:197], v[48:49], v[56:57], v[196:197] op_sel_hi:[0,1,1] neg_lo:[1,0,0] neg_hi:[1,0,0]
v_pk_fma_f32 v[198:199], v[48:49], v[58:59], v[198:199] op_sel_hi:[0,1,1] neg_lo:[1,0,0] neg_hi:[1,0,0]
v_pk_mul_f32 v[160:161], v[48:49], v[160:161] op_sel:[1,0] op_sel_hi:[1,1]
v_pk_mul_f32 v[162:163], v[48:49], v[162:163] op_sel:[1,0] op_sel_hi:[1,1]
v_cvt_pk_bf16_f32 v228, v228, v229
v_cvt_pk_bf16_f32 v229, v230, v231
ds_write_b64 v15, v[228:229] offset:45056
v_pk_fma_f32 v[232:233], v[48:49], v[60:61], v[232:233] op_sel_hi:[0,1,1] neg_lo:[1,0,0] neg_hi:[1,0,0]
v_pk_fma_f32 v[234:235], v[48:49], v[62:63], v[234:235] op_sel_hi:[0,1,1] neg_lo:[1,0,0] neg_hi:[1,0,0]
v_pk_mul_f32 v[196:197], v[48:49], v[196:197] op_sel:[1,0] op_sel_hi:[1,1]
v_pk_mul_f32 v[198:199], v[48:49], v[198:199] op_sel:[1,0] op_sel_hi:[1,1]
v_cvt_pk_bf16_f32 v160, v160, v161
v_cvt_pk_bf16_f32 v161, v162, v163
ds_write_b64 v15, v[160:161] offset:51200
v_pk_mul_f32 v[232:233], v[48:49], v[232:233] op_sel:[1,0] op_sel_hi:[1,1]
v_pk_mul_f32 v[234:235], v[48:49], v[234:235] op_sel:[1,0] op_sel_hi:[1,1]
v_cvt_pk_bf16_f32 v196, v196, v197
v_cvt_pk_bf16_f32 v197, v198, v199
ds_write_b64 v15, v[196:197] offset:51328
v_cvt_pk_bf16_f32 v232, v232, v233
v_cvt_pk_bf16_f32 v233, v234, v235
ds_write_b64 v15, v[232:233] offset:51456
s_waitcnt lgkmcnt(0)
s_branch Latt_5
Lpf_4:
s_lshl_b32 s43, s35, 7
s_waitcnt lgkmcnt(0)
s_mov_b32 s8, s64
s_mov_b32 s9, s65
s_mov_b32 s10, 4194304
s_mov_b32 s11, 0x20000
s_add_u32 s12, s66, s43
s_addc_u32 s13, s67, 0
s_mov_b32 s14, 6289536
s_mov_b32 s15, 0x20000
s_add_u32 s84, s82, 28311552
s_addc_u32 s85, s83, 0
s_mov_b32 s86, 49152
s_mov_b32 s87, 0x20000
s_mov_b32 s56, s80
s_mov_b32 s57, s81
s_mov_b32 s58, 256
s_mov_b32 s59, 0x20000
v_mov_b32 v5, 0
v_lshlrev_b32 v14, 7, v1
s_or_b32 s43, s34, s35
s_cmp_lg_u32 s43, 0
s_cbranch_scc1 Lz_20
s_movk_i32 s43, 0x2000
buffer_store_dword v5, v14, s[84:87], 0 offen sc1
s_bfm_b64 exec, 44, 0
buffer_store_dword v5, v14, s[84:87], s43 offen sc1
s_mov_b64 exec, 1
v_mov_b32 v6, 1
s_waitcnt vmcnt(0)
buffer_store_dword v6, v5, s[56:59], 0 offen sc1
s_mov_b64 exec, -1
Lz_20:
s_branch Lov_3
.p2align 12
Lst_3_0:
s_branch Lwr_143
s_nop 0
s_nop 0
Lov_3:
s_lshl_b32 s43, s51, 11
buffer_load_dwordx4 v[96:99], v10, s[8:11], s43 offen offset:0
buffer_load_dwordx4 v[100:103], v10, s[8:11], s43 offen offset:1024
buffer_load_dwordx4 v[104:107], v10, s[8:11], s43 offen offset:2048
buffer_load_dwordx4 v[108:111], v10, s[8:11], s43 offen offset:3072
v_min_u32 v14, 23, v1
v_lshrrev_b32 v15, 3, v14
v_mul_u32_u24 v15, 43008, v15
v_and_b32 v14, 7, v14
v_lshl_add_u32 v15, v14, 4, v15
v_mov_b32 v32, 0x3f803f80
v_mov_b32 v33, 0x3f803f80
v_mov_b32 v34, 0x3f803f80
v_mov_b32 v35, 0x3f803f80
ds_write_b128 v15, v[32:35]
s_add_u32 s20, s82, 26214400
s_addc_u32 s21, s83, 0
s_mov_b32 s22, 16384
s_mov_b32 s23, 0x20000
s_add_u32 s43, s2, 128
s_lshl_b32 s43, s43, 7
v_lshlrev_b32 v14, 2, v1
s_mov_b64 exec, 15
buffer_store_dword v5, v14, s[84:87], s43 offen sc1
s_mov_b64 exec, -1
s_lshl_b32 s52, s34, 7
s_add_u32 s52, s52, 28319744
s_sub_u32 s53, s52, 128
s_cmp_eq_u32 s34, 0
s_cselect_b32 s53, s52, s53
s_waitcnt lgkmcnt(0)
s_barrier
s_waitcnt vmcnt(1)
s_mov_b32 s43, 0x3f803f80
v_mov_b32 v116, 0
v_mov_b32 v117, 0
v_mov_b32 v118, 0
v_mov_b32 v119, 0
v_mov_b32 v120, 0
v_mov_b32 v121, 0
v_mov_b32 v122, 0
v_mov_b32 v123, 0
v_dot2_f32_bf16 v116, v96, s43, v116
v_dot2_f32_bf16 v120, v96, v96, v120
v_dot2_f32_bf16 v118, v104, s43, v118
v_dot2_f32_bf16 v122, v104, v104, v122
v_dot2_f32_bf16 v117, v97, s43, v117
v_dot2_f32_bf16 v121, v97, v97, v121
v_dot2_f32_bf16 v119, v105, s43, v119
v_dot2_f32_bf16 v123, v105, v105, v123
v_dot2_f32_bf16 v116, v98, s43, v116
v_dot2_f32_bf16 v120, v98, v98, v120
v_dot2_f32_bf16 v118, v106, s43, v118
v_dot2_f32_bf16 v122, v106, v106, v122
v_dot2_f32_bf16 v117, v99, s43, v117
v_dot2_f32_bf16 v121, v99, v99, v121
v_dot2_f32_bf16 v119, v107, s43, v119
v_dot2_f32_bf16 v123, v107, v107, v123
v_dot2_f32_bf16 v116, v100, s43, v116
v_dot2_f32_bf16 v120, v100, v100, v120
v_dot2_f32_bf16 v118, v108, s43, v118
v_dot2_f32_bf16 v122, v108, v108, v122
v_dot2_f32_bf16 v117, v101, s43, v117
v_dot2_f32_bf16 v121, v101, v101, v121
v_dot2_f32_bf16 v119, v109, s43, v119
v_dot2_f32_bf16 v123, v109, v109, v123
v_dot2_f32_bf16 v116, v102, s43, v116
v_dot2_f32_bf16 v120, v102, v102, v120
v_dot2_f32_bf16 v118, v110, s43, v118
v_dot2_f32_bf16 v122, v110, v110, v122
v_dot2_f32_bf16 v117, v103, s43, v117
v_dot2_f32_bf16 v121, v103, v103, v121
v_dot2_f32_bf16 v119, v111, s43, v119
v_dot2_f32_bf16 v123, v111, v111, v123
s_nop 2
v_add_f32 v116, v116, v117
v_add_f32 v118, v118, v119
v_add_f32 v120, v120, v121
v_add_f32 v122, v122, v123
s_nop 1
v_permlane32_swap_b32 v116, v118
v_permlane32_swap_b32 v120, v122
v_add_f32 v116, v116, v118
v_add_f32 v120, v120, v122
s_nop 1
v_permlane16_swap_b32 v116, v120
v_add_f32 v116, v116, v120
s_nop 1
v_add_f32_dpp v116, v116, v116 row_ror:8 row_mask:0xf bank_mask:0xf
s_nop 1
v_add_f32_dpp v116, v116, v116 row_ror:4 row_mask:0xf bank_mask:0xf
s_nop 1
v_add_f32_dpp v116, v116, v116 row_ror:2 row_mask:0xf bank_mask:0xf
s_nop 1
v_add_f32_dpp v116, v116, v116 row_ror:1 row_mask:0xf bank_mask:0xf
v_mov_b32 v117, v116
s_nop 1
v_permlane16_swap_b32 v116, v117
v_mul_f32 v112, 0x3a800000, v116
v_mul_f32 v113, 0x3a800000, v117
v_fma_f32 v113, -v112, v112, v113
v_max_f32 v113, 0, v113
v_add_f32 v113, 0x3727c5ac, v113
v_rsq_f32 v113, v113
v_lshrrev_b32 v11, 5, v1
s_lshl_b32 s43, s47, 4
s_add_u32 s43, s43, 148608
v_lshl_add_u32 v11, v11, 3, s43
ds_write_b64 v11, v[112:113]
s_waitcnt lgkmcnt(0)
s_mov_b32 s28, s66
s_mov_b32 s29, s67
s_mov_b32 s30, 6291456
s_mov_b32 s31, 0x20000
s_mul_i32 s43, s2, 9216
s_add_u32 s43, s43, 1572864
v_lshlrev_b32 v30, 7, v1
buffer_load_dword v31, v30, s[28:31], s43 offen
s_add_u32 s43, s43, 8192
s_bfm_b64 exec, 8, 0
buffer_load_dword v31, v30, s[28:31], s43 offen
s_mov_b64 exec, -1
s_branch Lst_0_0
Lwr_140:
s_barrier
v_lshlrev_b32 v5, 4, v1
v_and_b32 v5, 63, v5
v_add_u32 v6, 148608, v5
ds_read_b128 v[112:115], v6
s_lshl_b32 s43, s63, 3
v_add_u32 v5, s43, v5
s_waitcnt lgkmcnt(0)
s_mov_b64 exec, 15
buffer_store_dwordx4 v[112:115], v5, s[20:23], 0 offen sc1
s_mov_b64 exec, -1
v_mov_b32 v4, 0
buffer_load_dword v6, v4, s[56:59], 0 offen sc1
s_mov_b32 s62, 0
s_branch Lst_1_0
Lwr_141:
s_barrier
s_mov_b32 s28, s66
s_mov_b32 s29, s67
s_mov_b32 s30, 6291456
s_mov_b32 s31, 0x20000
s_mul_i32 s43, s2, 9216
s_add_u32 s43, s43, 3932160
v_lshlrev_b32 v30, 7, v1
buffer_load_dword v31, v30, s[28:31], s43 offen
s_add_u32 s43, s43, 8192
s_bfm_b64 exec, 8, 0
buffer_load_dword v31, v30, s[28:31], s43 offen
s_mov_b64 exec, -1
s_lshl_b32 s43, s35, 7
s_add_u32 s28, s68, s43
s_addc_u32 s29, s69, 0
s_mov_b32 s30, 2095232
s_mov_b32 s31, 0x20000
v_and_b32 v29, 7, v1
v_lshrrev_b32 v30, 3, v1
v_lshl_add_u32 v29, v30, 6, v29
s_lshl_b32 s43, s48, 3
v_add_u32 v29, s43, v29
v_lshlrev_b32 v29, 11, v29
s_mov_b32 s43, 1048576
s_mov_b32 s28, s68
s_mov_b32 s29, s69
s_mov_b32 s30, 2097152
s_mov_b32 s31, 0x20000
s_lshl_b32 s43, s2, 13
v_lshlrev_b32 v29, 7, v1
buffer_load_dword v30, v29, s[28:31], s43 offen
s_branch Lst_2_0
Lwr_142:
s_barrier
s_branch Lst_3_0
Lwr_143:
s_barrier
s_branch Lst_4_0
Lwr_144:
s_barrier
s_branch Lst_5_0
Lwr_145:
s_barrier
s_cmp_eq_u32 s62, 3
s_cbranch_scc1 Lste_23
s_cmp_eq_u32 s62, 2
s_cbranch_scc1 Lst2_22
s_waitcnt lgkmcnt(0)
s_cmp_eq_u32 s62, 1
s_cbranch_scc1 Lst1_21
s_waitcnt vmcnt(3)
v_readfirstlane_b32 s54, v6
s_cmp_eq_u32 s54, 0
s_cbranch_scc0 Lrep_24
buffer_load_dword v6, v4, s[56:59], 0 offen sc1
s_branch Lste_23
Lrep_24:
s_add_u32 s7, s34, 64
s_lshl_b32 s7, s7, 7
v_mov_b32 v5, s7
v_mov_b32 v6, 1
s_mov_b64 exec, 1
buffer_atomic_add v6, v5, s[84:87], 0 offen sc1
s_mov_b64 exec, -1
s_mov_b32 s62, 1
s_load_dword s54, s[82:83], s52 glc
s_load_dword s55, s[82:83], s53 glc
s_branch Lste_23
Lst1_21:
s_and_b32 s54, s54, s55
s_cmp_eq_u32 s54, 16
s_cbranch_scc1 Lg_25
s_load_dword s54, s[82:83], s52 glc
s_load_dword s55, s[82:83], s53 glc
s_branch Lste_23
Lg_25:
v_add_u32 v5, 0, v1
v_min_u32 v5, 143, v5
v_lshlrev_b32 v20, 3, v5
v_add_u32 v5, s50, v5
v_max_i32 v5, 0, v5
v_lshlrev_b32 v5, 3, v5
buffer_load_dwordx2 v[32:33], v5, s[20:23], 0 offen sc1
v_add_u32 v5, 64, v1
v_min_u32 v5, 143, v5
v_lshlrev_b32 v21, 3, v5
v_add_u32 v5, s50, v5
v_max_i32 v5, 0, v5
v_lshlrev_b32 v5, 3, v5
buffer_load_dwordx2 v[34:35], v5, s[20:23], 0 offen sc1
v_add_u32 v5, 128, v1
v_min_u32 v5, 143, v5
v_lshlrev_b32 v22, 3, v5
v_add_u32 v5, s50, v5
v_max_i32 v5, 0, v5
v_lshlrev_b32 v5, 3, v5
buffer_load_dwordx2 v[36:37], v5, s[20:23], 0 offen sc1
s_mov_b32 s62, 2
s_branch Lste_23
Lst2_22:
s_waitcnt vmcnt(0)
v_add_u32 v20, 147456, v20
ds_write_b64 v20, v[32:33]
v_add_u32 v21, 147456, v21
ds_write_b64 v21, v[34:35]
v_add_u32 v22, 147456, v22
ds_write_b64 v22, v[36:37]
s_waitcnt lgkmcnt(0)
s_mov_b32 s62, 3
Lste_23:
s_branch Lst_6_0
Lwr_146:
s_barrier
s_cmp_eq_u32 s62, 3
s_cbranch_scc1 Lste_28
s_cmp_eq_u32 s62, 2
s_cbranch_scc1 Lst2_27
s_waitcnt lgkmcnt(0)
s_cmp_eq_u32 s62, 1
s_cbranch_scc1 Lst1_26
s_waitcnt vmcnt(0)
v_readfirstlane_b32 s54, v6
s_cmp_eq_u32 s54, 0
s_cbranch_scc0 Lrep_29
buffer_load_dword v6, v4, s[56:59], 0 offen sc1
s_branch Lste_28
Lrep_29:
s_add_u32 s7, s34, 64
s_lshl_b32 s7, s7, 7
v_mov_b32 v5, s7
v_mov_b32 v6, 1
s_mov_b64 exec, 1
buffer_atomic_add v6, v5, s[84:87], 0 offen sc1
s_mov_b64 exec, -1
s_mov_b32 s62, 1
s_load_dword s54, s[82:83], s52 glc
s_load_dword s55, s[82:83], s53 glc
s_branch Lste_28
Lst1_26:
s_and_b32 s54, s54, s55
s_cmp_eq_u32 s54, 16
s_cbranch_scc1 Lg_30
s_load_dword s54, s[82:83], s52 glc
s_load_dword s55, s[82:83], s53 glc
s_branch Lste_28
Lg_30:
v_add_u32 v5, 0, v1
v_min_u32 v5, 143, v5
v_lshlrev_b32 v20, 3, v5
v_add_u32 v5, s50, v5
v_max_i32 v5, 0, v5
v_lshlrev_b32 v5, 3, v5
buffer_load_dwordx2 v[32:33], v5, s[20:23], 0 offen sc1
v_add_u32 v5, 64, v1
v_min_u32 v5, 143, v5
v_lshlrev_b32 v21, 3, v5
v_add_u32 v5, s50, v5
v_max_i32 v5, 0, v5
v_lshlrev_b32 v5, 3, v5
buffer_load_dwordx2 v[34:35], v5, s[20:23], 0 offen sc1
v_add_u32 v5, 128, v1
v_min_u32 v5, 143, v5
v_lshlrev_b32 v22, 3, v5
v_add_u32 v5, s50, v5
v_max_i32 v5, 0, v5
v_lshlrev_b32 v5, 3, v5
buffer_load_dwordx2 v[36:37], v5, s[20:23], 0 offen sc1
s_mov_b32 s62, 2
s_branch Lste_28
Lst2_27:
s_waitcnt vmcnt(0)
v_add_u32 v20, 147456, v20
ds_write_b64 v20, v[32:33]
v_add_u32 v21, 147456, v21
ds_write_b64 v21, v[34:35]
v_add_u32 v22, 147456, v22
ds_write_b64 v22, v[36:37]
s_waitcnt lgkmcnt(0)
s_mov_b32 s62, 3
Lste_28:
s_branch Lst_7_0
Lwr_147:
s_barrier
s_cmp_eq_u32 s62, 3
s_cbranch_scc1 Lste_33
s_cmp_eq_u32 s62, 2
s_cbranch_scc1 Lst2_32
s_waitcnt lgkmcnt(0)
s_cmp_eq_u32 s62, 1
s_cbranch_scc1 Lst1_31
s_waitcnt vmcnt(0)
v_readfirstlane_b32 s54, v6
s_cmp_eq_u32 s54, 0
s_cbranch_scc0 Lrep_34
buffer_load_dword v6, v4, s[56:59], 0 offen sc1
s_branch Lste_33
Lrep_34:
s_add_u32 s7, s34, 64
s_lshl_b32 s7, s7, 7
v_mov_b32 v5, s7
v_mov_b32 v6, 1
s_mov_b64 exec, 1
buffer_atomic_add v6, v5, s[84:87], 0 offen sc1
s_mov_b64 exec, -1
s_mov_b32 s62, 1
s_load_dword s54, s[82:83], s52 glc
s_load_dword s55, s[82:83], s53 glc
s_branch Lste_33
Lst1_31:
s_and_b32 s54, s54, s55
s_cmp_eq_u32 s54, 16
s_cbranch_scc1 Lg_35
s_load_dword s54, s[82:83], s52 glc
s_load_dword s55, s[82:83], s53 glc
s_branch Lste_33
Lg_35:
v_add_u32 v5, 0, v1
v_min_u32 v5, 143, v5
v_lshlrev_b32 v20, 3, v5
v_add_u32 v5, s50, v5
v_max_i32 v5, 0, v5
v_lshlrev_b32 v5, 3, v5
buffer_load_dwordx2 v[32:33], v5, s[20:23], 0 offen sc1
v_add_u32 v5, 64, v1
v_min_u32 v5, 143, v5
v_lshlrev_b32 v21, 3, v5
v_add_u32 v5, s50, v5
v_max_i32 v5, 0, v5
v_lshlrev_b32 v5, 3, v5
buffer_load_dwordx2 v[34:35], v5, s[20:23], 0 offen sc1
v_add_u32 v5, 128, v1
v_min_u32 v5, 143, v5
v_lshlrev_b32 v22, 3, v5
v_add_u32 v5, s50, v5
v_max_i32 v5, 0, v5
v_lshlrev_b32 v5, 3, v5
buffer_load_dwordx2 v[36:37], v5, s[20:23], 0 offen sc1
s_mov_b32 s62, 2
s_branch Lste_33
Lst2_32:
s_waitcnt vmcnt(0)
v_add_u32 v20, 147456, v20
ds_write_b64 v20, v[32:33]
v_add_u32 v21, 147456, v21
ds_write_b64 v21, v[34:35]
v_add_u32 v22, 147456, v22
ds_write_b64 v22, v[36:37]
s_waitcnt lgkmcnt(0)
s_mov_b32 s62, 3
Lste_33:
s_branch Lst_8_0
Lwr_148:
s_barrier
s_cmp_eq_u32 s62, 3
s_cbranch_scc1 Lste_38
s_cmp_eq_u32 s62, 2
s_cbranch_scc1 Lst2_37
s_waitcnt lgkmcnt(0)
s_cmp_eq_u32 s62, 1
s_cbranch_scc1 Lst1_36
s_waitcnt vmcnt(0)
v_readfirstlane_b32 s54, v6
s_cmp_eq_u32 s54, 0
s_cbranch_scc0 Lrep_39
buffer_load_dword v6, v4, s[56:59], 0 offen sc1
s_branch Lste_38
Lrep_39:
s_add_u32 s7, s34, 64
s_lshl_b32 s7, s7, 7
v_mov_b32 v5, s7
v_mov_b32 v6, 1
s_mov_b64 exec, 1
buffer_atomic_add v6, v5, s[84:87], 0 offen sc1
s_mov_b64 exec, -1
s_mov_b32 s62, 1
s_load_dword s54, s[82:83], s52 glc
s_load_dword s55, s[82:83], s53 glc
s_branch Lste_38
Lst1_36:
s_and_b32 s54, s54, s55
s_cmp_eq_u32 s54, 16
s_cbranch_scc1 Lg_40
s_load_dword s54, s[82:83], s52 glc
s_load_dword s55, s[82:83], s53 glc
s_branch Lste_38
Lg_40:
v_add_u32 v5, 0, v1
v_min_u32 v5, 143, v5
v_lshlrev_b32 v20, 3, v5
v_add_u32 v5, s50, v5
v_max_i32 v5, 0, v5
v_lshlrev_b32 v5, 3, v5
buffer_load_dwordx2 v[32:33], v5, s[20:23], 0 offen sc1
v_add_u32 v5, 64, v1
v_min_u32 v5, 143, v5
v_lshlrev_b32 v21, 3, v5
v_add_u32 v5, s50, v5
v_max_i32 v5, 0, v5
v_lshlrev_b32 v5, 3, v5
buffer_load_dwordx2 v[34:35], v5, s[20:23], 0 offen sc1
v_add_u32 v5, 128, v1
v_min_u32 v5, 143, v5
v_lshlrev_b32 v22, 3, v5
v_add_u32 v5, s50, v5
v_max_i32 v5, 0, v5
v_lshlrev_b32 v5, 3, v5
buffer_load_dwordx2 v[36:37], v5, s[20:23], 0 offen sc1
s_mov_b32 s62, 2
s_branch Lste_38
Lst2_37:
s_waitcnt vmcnt(0)
v_add_u32 v20, 147456, v20
ds_write_b64 v20, v[32:33]
v_add_u32 v21, 147456, v21
ds_write_b64 v21, v[34:35]
v_add_u32 v22, 147456, v22
ds_write_b64 v22, v[36:37]
s_waitcnt lgkmcnt(0)
s_mov_b32 s62, 3
Lste_38:
s_branch Lst_9_0
Lwr_149:
s_barrier
s_cmp_eq_u32 s62, 3
s_cbranch_scc1 Lste_43
s_cmp_eq_u32 s62, 2
s_cbranch_scc1 Lst2_42
s_waitcnt lgkmcnt(0)
s_cmp_eq_u32 s62, 1
s_cbranch_scc1 Lst1_41
s_waitcnt vmcnt(0)
v_readfirstlane_b32 s54, v6
s_cmp_eq_u32 s54, 0
s_cbranch_scc0 Lrep_44
buffer_load_dword v6, v4, s[56:59], 0 offen sc1
s_branch Lste_43
Lrep_44:
s_add_u32 s7, s34, 64
s_lshl_b32 s7, s7, 7
v_mov_b32 v5, s7
v_mov_b32 v6, 1
s_mov_b64 exec, 1
buffer_atomic_add v6, v5, s[84:87], 0 offen sc1
s_mov_b64 exec, -1
s_mov_b32 s62, 1
s_load_dword s54, s[82:83], s52 glc
s_load_dword s55, s[82:83], s53 glc
s_branch Lste_43
Lst1_41:
s_and_b32 s54, s54, s55
s_cmp_eq_u32 s54, 16
s_cbranch_scc1 Lg_45
s_load_dword s54, s[82:83], s52 glc
s_load_dword s55, s[82:83], s53 glc
s_branch Lste_43
Lg_45:
v_add_u32 v5, 0, v1
v_min_u32 v5, 143, v5
v_lshlrev_b32 v20, 3, v5
v_add_u32 v5, s50, v5
v_max_i32 v5, 0, v5
v_lshlrev_b32 v5, 3, v5
buffer_load_dwordx2 v[32:33], v5, s[20:23], 0 offen sc1
v_add_u32 v5, 64, v1
v_min_u32 v5, 143, v5
v_lshlrev_b32 v21, 3, v5
v_add_u32 v5, s50, v5
v_max_i32 v5, 0, v5
v_lshlrev_b32 v5, 3, v5
buffer_load_dwordx2 v[34:35], v5, s[20:23], 0 offen sc1
v_add_u32 v5, 128, v1
v_min_u32 v5, 143, v5
v_lshlrev_b32 v22, 3, v5
v_add_u32 v5, s50, v5
v_max_i32 v5, 0, v5
v_lshlrev_b32 v5, 3, v5
buffer_load_dwordx2 v[36:37], v5, s[20:23], 0 offen sc1
s_mov_b32 s62, 2
s_branch Lste_43
Lst2_42:
s_waitcnt vmcnt(0)
v_add_u32 v20, 147456, v20
ds_write_b64 v20, v[32:33]
v_add_u32 v21, 147456, v21
ds_write_b64 v21, v[34:35]
v_add_u32 v22, 147456, v22
ds_write_b64 v22, v[36:37]
s_waitcnt lgkmcnt(0)
s_mov_b32 s62, 3
Lste_43:
s_branch Lst_10_0
Lwr_150:
s_barrier
s_cmp_eq_u32 s62, 3
s_cbranch_scc1 Lste_48
s_cmp_eq_u32 s62, 2
s_cbranch_scc1 Lst2_47
s_waitcnt lgkmcnt(0)
s_cmp_eq_u32 s62, 1
s_cbranch_scc1 Lst1_46
s_waitcnt vmcnt(0)
v_readfirstlane_b32 s54, v6
s_cmp_eq_u32 s54, 0
s_cbranch_scc0 Lrep_49
buffer_load_dword v6, v4, s[56:59], 0 offen sc1
s_branch Lste_48
Lrep_49:
s_add_u32 s7, s34, 64
s_lshl_b32 s7, s7, 7
v_mov_b32 v5, s7
v_mov_b32 v6, 1
s_mov_b64 exec, 1
buffer_atomic_add v6, v5, s[84:87], 0 offen sc1
s_mov_b64 exec, -1
s_mov_b32 s62, 1
s_load_dword s54, s[82:83], s52 glc
s_load_dword s55, s[82:83], s53 glc
s_branch Lste_48
Lst1_46:
s_and_b32 s54, s54, s55
s_cmp_eq_u32 s54, 16
s_cbranch_scc1 Lg_50
s_load_dword s54, s[82:83], s52 glc
s_load_dword s55, s[82:83], s53 glc
s_branch Lste_48
Lg_50:
v_add_u32 v5, 0, v1
v_min_u32 v5, 143, v5
v_lshlrev_b32 v20, 3, v5
v_add_u32 v5, s50, v5
v_max_i32 v5, 0, v5
v_lshlrev_b32 v5, 3, v5
buffer_load_dwordx2 v[32:33], v5, s[20:23], 0 offen sc1
v_add_u32 v5, 64, v1
v_min_u32 v5, 143, v5
v_lshlrev_b32 v21, 3, v5
v_add_u32 v5, s50, v5
v_max_i32 v5, 0, v5
v_lshlrev_b32 v5, 3, v5
buffer_load_dwordx2 v[34:35], v5, s[20:23], 0 offen sc1
v_add_u32 v5, 128, v1
v_min_u32 v5, 143, v5
v_lshlrev_b32 v22, 3, v5
v_add_u32 v5, s50, v5
v_max_i32 v5, 0, v5
v_lshlrev_b32 v5, 3, v5
buffer_load_dwordx2 v[36:37], v5, s[20:23], 0 offen sc1
s_mov_b32 s62, 2
s_branch Lste_48
Lst2_47:
s_waitcnt vmcnt(0)
v_add_u32 v20, 147456, v20
ds_write_b64 v20, v[32:33]
v_add_u32 v21, 147456, v21
ds_write_b64 v21, v[34:35]
v_add_u32 v22, 147456, v22
ds_write_b64 v22, v[36:37]
s_waitcnt lgkmcnt(0)
s_mov_b32 s62, 3
Lste_48:
s_branch Lst_11_0
Lwr_151:
s_barrier
s_cmp_eq_u32 s62, 3
s_cbranch_scc1 Lste_53
s_cmp_eq_u32 s62, 2
s_cbranch_scc1 Lst2_52
s_waitcnt lgkmcnt(0)
s_cmp_eq_u32 s62, 1
s_cbranch_scc1 Lst1_51
s_waitcnt vmcnt(0)
v_readfirstlane_b32 s54, v6
s_cmp_eq_u32 s54, 0
s_cbranch_scc0 Lrep_54
buffer_load_dword v6, v4, s[56:59], 0 offen sc1
s_branch Lste_53
Lrep_54:
s_add_u32 s7, s34, 64
s_lshl_b32 s7, s7, 7
v_mov_b32 v5, s7
v_mov_b32 v6, 1
s_mov_b64 exec, 1
buffer_atomic_add v6, v5, s[84:87], 0 offen sc1
s_mov_b64 exec, -1
s_mov_b32 s62, 1
s_load_dword s54, s[82:83], s52 glc
s_load_dword s55, s[82:83], s53 glc
s_branch Lste_53
Lst1_51:
s_and_b32 s54, s54, s55
s_cmp_eq_u32 s54, 16
s_cbranch_scc1 Lg_55
s_load_dword s54, s[82:83], s52 glc
s_load_dword s55, s[82:83], s53 glc
s_branch Lste_53
Lg_55:
v_add_u32 v5, 0, v1
v_min_u32 v5, 143, v5
v_lshlrev_b32 v20, 3, v5
v_add_u32 v5, s50, v5
v_max_i32 v5, 0, v5
v_lshlrev_b32 v5, 3, v5
buffer_load_dwordx2 v[32:33], v5, s[20:23], 0 offen sc1
v_add_u32 v5, 64, v1
v_min_u32 v5, 143, v5
v_lshlrev_b32 v21, 3, v5
v_add_u32 v5, s50, v5
v_max_i32 v5, 0, v5
v_lshlrev_b32 v5, 3, v5
buffer_load_dwordx2 v[34:35], v5, s[20:23], 0 offen sc1
v_add_u32 v5, 128, v1
v_min_u32 v5, 143, v5
v_lshlrev_b32 v22, 3, v5
v_add_u32 v5, s50, v5
v_max_i32 v5, 0, v5
v_lshlrev_b32 v5, 3, v5
buffer_load_dwordx2 v[36:37], v5, s[20:23], 0 offen sc1
s_mov_b32 s62, 2
s_branch Lste_53
Lst2_52:
s_waitcnt vmcnt(0)
v_add_u32 v20, 147456, v20
ds_write_b64 v20, v[32:33]
v_add_u32 v21, 147456, v21
ds_write_b64 v21, v[34:35]
v_add_u32 v22, 147456, v22
ds_write_b64 v22, v[36:37]
s_waitcnt lgkmcnt(0)
s_mov_b32 s62, 3
Lste_53:
s_branch Lst_12_0
Lwr_152:
s_barrier
s_cmp_eq_u32 s62, 3
s_cbranch_scc1 Lste_58
s_cmp_eq_u32 s62, 2
s_cbranch_scc1 Lst2_57
s_waitcnt lgkmcnt(0)
s_cmp_eq_u32 s62, 1
s_cbranch_scc1 Lst1_56
s_waitcnt vmcnt(0)
v_readfirstlane_b32 s54, v6
s_cmp_eq_u32 s54, 0
s_cbranch_scc0 Lrep_59
buffer_load_dword v6, v4, s[56:59], 0 offen sc1
s_branch Lste_58
Lrep_59:
s_add_u32 s7, s34, 64
s_lshl_b32 s7, s7, 7
v_mov_b32 v5, s7
v_mov_b32 v6, 1
s_mov_b64 exec, 1
buffer_atomic_add v6, v5, s[84:87], 0 offen sc1
s_mov_b64 exec, -1
s_mov_b32 s62, 1
s_load_dword s54, s[82:83], s52 glc
s_load_dword s55, s[82:83], s53 glc
s_branch Lste_58
Lst1_56:
s_and_b32 s54, s54, s55
s_cmp_eq_u32 s54, 16
s_cbranch_scc1 Lg_60
s_load_dword s54, s[82:83], s52 glc
s_load_dword s55, s[82:83], s53 glc
s_branch Lste_58
Lg_60:
v_add_u32 v5, 0, v1
v_min_u32 v5, 143, v5
v_lshlrev_b32 v20, 3, v5
v_add_u32 v5, s50, v5
v_max_i32 v5, 0, v5
v_lshlrev_b32 v5, 3, v5
buffer_load_dwordx2 v[32:33], v5, s[20:23], 0 offen sc1
v_add_u32 v5, 64, v1
v_min_u32 v5, 143, v5
v_lshlrev_b32 v21, 3, v5
v_add_u32 v5, s50, v5
v_max_i32 v5, 0, v5
v_lshlrev_b32 v5, 3, v5
buffer_load_dwordx2 v[34:35], v5, s[20:23], 0 offen sc1
v_add_u32 v5, 128, v1
v_min_u32 v5, 143, v5
v_lshlrev_b32 v22, 3, v5
v_add_u32 v5, s50, v5
v_max_i32 v5, 0, v5
v_lshlrev_b32 v5, 3, v5
buffer_load_dwordx2 v[36:37], v5, s[20:23], 0 offen sc1
s_mov_b32 s62, 2
s_branch Lste_58
Lst2_57:
s_waitcnt vmcnt(0)
v_add_u32 v20, 147456, v20
ds_write_b64 v20, v[32:33]
v_add_u32 v21, 147456, v21
ds_write_b64 v21, v[34:35]
v_add_u32 v22, 147456, v22
ds_write_b64 v22, v[36:37]
s_waitcnt lgkmcnt(0)
s_mov_b32 s62, 3
Lste_58:
s_branch Lst_13_0
Lwr_153:
s_barrier
s_cmp_eq_u32 s62, 3
s_cbranch_scc1 Lste_63
s_cmp_eq_u32 s62, 2
s_cbranch_scc1 Lst2_62
s_waitcnt lgkmcnt(0)
s_cmp_eq_u32 s62, 1
s_cbranch_scc1 Lst1_61
s_waitcnt vmcnt(0)
v_readfirstlane_b32 s54, v6
s_cmp_eq_u32 s54, 0
s_cbranch_scc0 Lrep_64
buffer_load_dword v6, v4, s[56:59], 0 offen sc1
s_branch Lste_63
Lrep_64:
s_add_u32 s7, s34, 64
s_lshl_b32 s7, s7, 7
v_mov_b32 v5, s7
v_mov_b32 v6, 1
s_mov_b64 exec, 1
buffer_atomic_add v6, v5, s[84:87], 0 offen sc1
s_mov_b64 exec, -1
s_mov_b32 s62, 1
s_load_dword s54, s[82:83], s52 glc
s_load_dword s55, s[82:83], s53 glc
s_branch Lste_63
Lst1_61:
s_and_b32 s54, s54, s55
s_cmp_eq_u32 s54, 16
s_cbranch_scc1 Lg_65
s_load_dword s54, s[82:83], s52 glc
s_load_dword s55, s[82:83], s53 glc
s_branch Lste_63
Lg_65:
v_add_u32 v5, 0, v1
v_min_u32 v5, 143, v5
v_lshlrev_b32 v20, 3, v5
v_add_u32 v5, s50, v5
v_max_i32 v5, 0, v5
v_lshlrev_b32 v5, 3, v5
buffer_load_dwordx2 v[32:33], v5, s[20:23], 0 offen sc1
v_add_u32 v5, 64, v1
v_min_u32 v5, 143, v5
v_lshlrev_b32 v21, 3, v5
v_add_u32 v5, s50, v5
v_max_i32 v5, 0, v5
v_lshlrev_b32 v5, 3, v5
buffer_load_dwordx2 v[34:35], v5, s[20:23], 0 offen sc1
v_add_u32 v5, 128, v1
v_min_u32 v5, 143, v5
v_lshlrev_b32 v22, 3, v5
v_add_u32 v5, s50, v5
v_max_i32 v5, 0, v5
v_lshlrev_b32 v5, 3, v5
buffer_load_dwordx2 v[36:37], v5, s[20:23], 0 offen sc1
s_mov_b32 s62, 2
s_branch Lste_63
Lst2_62:
s_waitcnt vmcnt(0)
v_add_u32 v20, 147456, v20
ds_write_b64 v20, v[32:33]
v_add_u32 v21, 147456, v21
ds_write_b64 v21, v[34:35]
v_add_u32 v22, 147456, v22
ds_write_b64 v22, v[36:37]
s_waitcnt lgkmcnt(0)
s_mov_b32 s62, 3
Lste_63:
s_branch Lst_14_0
Lwr_154:
s_barrier
s_cmp_eq_u32 s62, 3
s_cbranch_scc1 Lste_68
s_cmp_eq_u32 s62, 2
s_cbranch_scc1 Lst2_67
s_cmp_eq_u32 s62, 1
s_cbranch_scc1 Lst1_66
s_mov_b32 s41, 0x40000
Lz0_69:
s_branch Lov_4
.p2align 12
Lst_4_0:
s_branch Lwr_144
s_nop 0
s_nop 0
Lov_4:
s_waitcnt vmcnt(0)
v_readfirstlane_b32 s54, v6
s_cmp_eq_u32 s54, 0
s_cbranch_scc0 Lzok_70
buffer_load_dword v6, v4, s[56:59], 0 offen sc1
s_sub_u32 s41, s41, 1
s_cmp_lg_u32 s41, 0
s_cbranch_scc1 Lz0_69
s_waitcnt lgkmcnt(0)
Lzok_70:
s_add_u32 s7, s34, 64
s_lshl_b32 s7, s7, 7
v_mov_b32 v5, s7
v_mov_b32 v6, 1
s_mov_b64 exec, 1
buffer_atomic_add v6, v5, s[84:87], 0 offen sc1
s_mov_b64 exec, -1
s_load_dword s54, s[82:83], s52 glc
s_load_dword s55, s[82:83], s53 glc
Lst1_66:
s_mov_b32 s41, 200
Lpoll_71:
s_waitcnt lgkmcnt(0)
s_and_b32 s54, s54, s55
s_cmp_eq_u32 s54, 16
s_cbranch_scc1 Lg_73
s_load_dword s54, s[82:83], s52 glc
s_load_dword s55, s[82:83], s53 glc
s_sub_u32 s41, s41, 1
s_cmp_lg_u32 s41, 0
s_cbranch_scc1 Lpoll_71
s_waitcnt lgkmcnt(0)
s_mov_b32 s41, 0
Lfb_72:
s_add_u32 s62, s50, s41
s_max_i32 s62, s62, 0
s_lshl_b32 s43, s62, 11
buffer_load_dwordx4 v[96:99], v10, s[8:11], s43 offen offset:0
buffer_load_dwordx4 v[100:103], v10, s[8:11], s43 offen offset:1024
buffer_load_dwordx4 v[104:107], v10, s[8:11], s43 offen offset:2048
buffer_load_dwordx4 v[108:111], v10, s[8:11], s43 offen offset:3072
s_waitcnt vmcnt(0)
s_mov_b32 s43, 0x3f803f80
v_mov_b32 v116, 0
v_mov_b32 v117, 0
v_mov_b32 v118, 0
v_mov_b32 v119, 0
v_mov_b32 v120, 0
v_mov_b32 v121, 0
v_mov_b32 v122, 0
v_mov_b32 v123, 0
v_dot2_f32_bf16 v116, v96, s43, v116
v_dot2_f32_bf16 v120, v96, v96, v120
v_dot2_f32_bf16 v118, v104, s43, v118
v_dot2_f32_bf16 v122, v104, v104, v122
v_dot2_f32_bf16 v117, v97, s43, v117
v_dot2_f32_bf16 v121, v97, v97, v121
v_dot2_f32_bf16 v119, v105, s43, v119
v_dot2_f32_bf16 v123, v105, v105, v123
v_dot2_f32_bf16 v116, v98, s43, v116
v_dot2_f32_bf16 v120, v98, v98, v120
v_dot2_f32_bf16 v118, v106, s43, v118
v_dot2_f32_bf16 v122, v106, v106, v122
v_dot2_f32_bf16 v117, v99, s43, v117
v_dot2_f32_bf16 v121, v99, v99, v121
v_dot2_f32_bf16 v119, v107, s43, v119
v_dot2_f32_bf16 v123, v107, v107, v123
v_dot2_f32_bf16 v116, v100, s43, v116
v_dot2_f32_bf16 v120, v100, v100, v120
v_dot2_f32_bf16 v118, v108, s43, v118
v_dot2_f32_bf16 v122, v108, v108, v122
v_dot2_f32_bf16 v117, v101, s43, v117
v_dot2_f32_bf16 v121, v101, v101, v121
v_dot2_f32_bf16 v119, v109, s43, v119
v_dot2_f32_bf16 v123, v109, v109, v123
v_dot2_f32_bf16 v116, v102, s43, v116
v_dot2_f32_bf16 v120, v102, v102, v120
v_dot2_f32_bf16 v118, v110, s43, v118
v_dot2_f32_bf16 v122, v110, v110, v122
v_dot2_f32_bf16 v117, v103, s43, v117
v_dot2_f32_bf16 v121, v103, v103, v121
v_dot2_f32_bf16 v119, v111, s43, v119
v_dot2_f32_bf16 v123, v111, v111, v123
s_nop 2
v_add_f32 v116, v116, v117
v_add_f32 v118, v118, v119
v_add_f32 v120, v120, v121
v_add_f32 v122, v122, v123
s_nop 1
v_permlane32_swap_b32 v116, v118
v_permlane32_swap_b32 v120, v122
v_add_f32 v116, v116, v118
v_add_f32 v120, v120, v122
s_nop 1
v_permlane16_swap_b32 v116, v120
v_add_f32 v116, v116, v120
s_nop 1
v_add_f32_dpp v116, v116, v116 row_ror:8 row_mask:0xf bank_mask:0xf
s_nop 1
v_add_f32_dpp v116, v116, v116 row_ror:4 row_mask:0xf bank_mask:0xf
s_nop 1
v_add_f32_dpp v116, v116, v116 row_ror:2 row_mask:0xf bank_mask:0xf
s_nop 1
v_add_f32_dpp v116, v116, v116 row_ror:1 row_mask:0xf bank_mask:0xf
v_mov_b32 v117, v116
s_nop 1
v_permlane16_swap_b32 v116, v117
v_mul_f32 v112, 0x3a800000, v116
v_mul_f32 v113, 0x3a800000, v117
v_fma_f32 v113, -v112, v112, v113
v_max_f32 v113, 0, v113
v_add_f32 v113, 0x3727c5ac, v113
v_rsq_f32 v113, v113
v_lshrrev_b32 v11, 5, v1
s_lshl_b32 s43, s41, 3
s_add_u32 s43, s43, 147456
v_lshl_add_u32 v11, v11, 3, s43
ds_write_b64 v11, v[112:113]
s_add_u32 s41, s41, 2
s_cmp_lt_u32 s41, 144
s_cbranch_scc1 Lfb_72
s_waitcnt lgkmcnt(0)
s_branch Lste_68
Lg_73:
v_add_u32 v5, 0, v1
v_min_u32 v5, 143, v5
v_lshlrev_b32 v20, 3, v5
v_add_u32 v5, s50, v5
v_max_i32 v5, 0, v5
v_lshlrev_b32 v5, 3, v5
buffer_load_dwordx2 v[32:33], v5, s[20:23], 0 offen sc1
v_add_u32 v5, 64, v1
v_min_u32 v5, 143, v5
v_lshlrev_b32 v21, 3, v5
v_add_u32 v5, s50, v5
v_max_i32 v5, 0, v5
v_lshlrev_b32 v5, 3, v5
buffer_load_dwordx2 v[34:35], v5, s[20:23], 0 offen sc1
v_add_u32 v5, 128, v1
v_min_u32 v5, 143, v5
v_lshlrev_b32 v22, 3, v5
v_add_u32 v5, s50, v5
v_max_i32 v5, 0, v5
v_lshlrev_b32 v5, 3, v5
buffer_load_dwordx2 v[36:37], v5, s[20:23], 0 offen sc1
Lst2_67:
s_waitcnt vmcnt(0)
v_add_u32 v20, 147456, v20
ds_write_b64 v20, v[32:33]
v_add_u32 v21, 147456, v21
ds_write_b64 v21, v[34:35]
v_add_u32 v22, 147456, v22
ds_write_b64 v22, v[36:37]
s_waitcnt lgkmcnt(0)
Lste_68:
s_bitcmp0_b32 s2, 0
s_cselect_b32 s88, s72, s74
s_cselect_b32 s89, s73, s75
s_cmp_lt_u32 s2, 192
s_cselect_b32 s90, 7340032, 0
s_mov_b32 s91, 0x20000
s_bfe_u32 s44, s2, 0x30001
s_lshl_b32 s44, s44, 2
s_and_b32 s43, s36, 3
s_add_u32 s44, s44, s43
s_lshl_b32 s44, s44, 5
v_lshrrev_b32 v18, 4, v1
v_add_u32 v18, s44, v18
v_mul_u32_u24 v18, 7168, v18
v_and_b32 v19, 15, v1
v_lshl_add_u32 v18, v19, 4, v18
s_lshr_b32 s43, s2, 4
s_lshl_b32 s43, s43, 8
s_add_u32 s43, s43, 4096
v_add_u32 v18, s43, v18
s_mov_b32 s43, 0
buffer_load_dwordx4 v[128:131], v18, s[88:91], s43 offen
s_mov_b32 s43, 28672
buffer_load_dwordx4 v[132:135], v18, s[88:91], s43 offen
s_mov_b32 s43, 57344
buffer_load_dwordx4 v[136:139], v18, s[88:91], s43 offen
s_mov_b32 s43, 86016
buffer_load_dwordx4 v[140:143], v18, s[88:91], s43 offen
s_mov_b32 s43, 114688
buffer_load_dwordx4 v[144:147], v18, s[88:91], s43 offen
s_mov_b32 s43, 143360
buffer_load_dwordx4 v[148:151], v18, s[88:91], s43 offen
s_mov_b32 s43, 172032
buffer_load_dwordx4 v[152:155], v18, s[88:91], s43 offen
s_mov_b32 s43, 200704
buffer_load_dwordx4 v[156:159], v18, s[88:91], s43 offen
s_barrier
s_lshl_b32 s43, s35, 7
s_add_u32 s28, s68, s43
s_addc_u32 s29, s69, 0
s_mov_b32 s30, 2095232
s_mov_b32 s31, 0x20000
v_lshrrev_b32 v15, 3, v1
v_and_b32 v16, 6, v15
v_and_b32 v7, 7, v1
v_xor_b32 v7, v7, v16
v_lshlrev_b32 v7, 4, v7
v_mul_u32_u24 v15, 2048, v15
v_add_u32 v7, v7, v15
s_and_b32 s40, s36, 3
s_lshl_b32 s39, s40, 13
s_add_u32 s40, s40, s35
s_add_u32 s42, s40, 0
s_and_b32 s42, s42, 15
s_lshl_b32 s42, s42, 17
s_add_u32 m0, s39, 65536
s_add_u32 s43, s42, 0
buffer_load_dwordx4 v7, s[28:31], s43 offen lds
s_add_u32 m0, s39, 66560
s_add_u32 s43, s42, 16384
buffer_load_dwordx4 v7, s[28:31], s43 offen lds
s_add_u32 m0, s39, 67584
s_add_u32 s43, s42, 32768
buffer_load_dwordx4 v7, s[28:31], s43 offen lds
s_add_u32 m0, s39, 68608
s_add_u32 s43, s42, 49152
buffer_load_dwordx4 v7, s[28:31], s43 offen lds
s_add_u32 m0, s39, 69632
s_add_u32 s43, s42, 65536
buffer_load_dwordx4 v7, s[28:31], s43 offen lds
s_add_u32 m0, s39, 70656
s_add_u32 s43, s42, 81920
buffer_load_dwordx4 v7, s[28:31], s43 offen lds
s_add_u32 m0, s39, 71680
s_add_u32 s43, s42, 98304
buffer_load_dwordx4 v7, s[28:31], s43 offen lds
s_add_u32 m0, s39, 72704
s_add_u32 s43, s42, 114688
buffer_load_dwordx4 v7, s[28:31], s43 offen lds
Lats_6:
s_and_b32 s43, s36, 1
s_bfe_u32 s44, s36, 0x10001
s_lshr_b32 s45, s36, 2
v_lshlrev_b32 v14, 2, v13
v_sub_u32 v14, v12, v14
v_mov_b32 v16, 0xff800000
s_or_b32 s46, s34, s45
s_cmp_lg_u32 s46, 0
s_cselect_b32 s46, 0, 0xff800000
v_subrev_u32 v15, 0, v14
v_cmp_ge_u32 vcc, 7, v15
v_add_u32 v15, 16, v15
s_nop 0
v_cndmask_b32 v248, v16, 0, vcc
v_cmp_ge_u32 vcc, 7, v15
s_nop 1
v_cndmask_b32 v244, v16, 0, vcc
v_or_b32 v240, s46, v244
v_subrev_u32 v15, 1, v14
v_cmp_ge_u32 vcc, 7, v15
v_add_u32 v15, 16, v15
s_nop 0
v_cndmask_b32 v249, v16, 0, vcc
v_cmp_ge_u32 vcc, 7, v15
s_nop 1
v_cndmask_b32 v245, v16, 0, vcc
v_or_b32 v241, s46, v245
v_subrev_u32 v15, 2, v14
v_cmp_ge_u32 vcc, 7, v15
v_add_u32 v15, 16, v15
s_nop 0
v_cndmask_b32 v250, v16, 0, vcc
v_cmp_ge_u32 vcc, 7, v15
s_nop 1
v_cndmask_b32 v246, v16, 0, vcc
v_or_b32 v242, s46, v246
v_subrev_u32 v15, 3, v14
v_cmp_ge_u32 vcc, 7, v15
v_add_u32 v15, 16, v15
s_nop 0
v_cndmask_b32 v251, v16, 0, vcc
v_cmp_ge_u32 vcc, 7, v15
s_nop 1
v_cndmask_b32 v247, v16, 0, vcc
v_or_b32 v243, s46, v247
s_lshl_b32 s46, s45, 6
s_add_u32 s46, s46, s44
s_add_u32 s46, s46, 16
v_lshl_add_u32 v14, v12, 1, s46
s_lshl_b32 s47, s43, 6
v_lshl_add_u32 v15, v13, 4, s47
v_mul_u32_u24 v20, 400, v14
v_add_u32 v20, v20, v15
v_subrev_u32 v16, 32, v14
v_max_i32 v16, 0, v16
v_mul_u32_u24 v21, 400, v16
v_add_u32 v21, v21, v15
v_lshrrev_b32 v16, 2, v12
v_lshl_add_u32 v16, v13, 2, v16
v_lshl_add_u32 v16, v16, 1, s46
v_and_b32 v17, 3, v1
v_lshl_add_u32 v17, v17, 3, s47
v_mul_u32_u24 v22, 400, v16
v_add_u32 v22, v22, v17
v_subrev_u32 v16, 32, v16
v_max_i32 v16, 0, v16
v_mul_u32_u24 v23, 400, v16
v_add_u32 v23, v23, v17
s_mul_i32 s60, s34, 262144
s_add_u32 s16, s82, s60
s_addc_u32 s17, s83, 0
s_mov_b32 s18, 262144
s_mov_b32 s19, 0x20000
s_lshl_b32 s60, s35, 14
s_lshl_b32 s43, s43, 13
s_add_u32 s60, s60, s43
s_lshl_b32 s43, s45, 12
s_add_u32 s60, s60, s43
s_lshl_b32 s43, s44, 10
s_add_u32 s60, s60, s43
v_lshlrev_b32 v24, 4, v1
s_mov_b32 s61, 0x3e8293ee
s_lshl_b32 s38, s35, 7
Latt_5:
s_barrier
ds_read_b128 v[32:35], v20 offset:0
ds_read_b128 v[36:39], v20 offset:128
ds_read_b128 v[40:43], v21 offset:128
ds_read_b128 v[80:83], v20 offset:12800
ds_read_b128 v[84:87], v20 offset:12928
ds_read_b128 v[88:91], v20 offset:128
ds_read_b64_tr_b16 v[44:45], v23 offset:256
ds_read_b64_tr_b16 v[46:47], v22 offset:256
ds_read_b64_tr_b16 v[48:49], v23 offset:288
ds_read_b64_tr_b16 v[50:51], v22 offset:288
ds_read_b64_tr_b16 v[92:93], v22 offset:256
ds_read_b64_tr_b16 v[94:95], v22 offset:13056
ds_read_b64_tr_b16 v[96:97], v22 offset:288
ds_read_b64_tr_b16 v[98:99], v22 offset:13088
s_waitcnt lgkmcnt(11)
v_mfma_f32_16x16x32_bf16 v[52:55], v[40:43], v[32:35], v[240:243]
v_mfma_f32_16x16x32_bf16 v[56:59], v[36:39], v[32:35], v[248:251]
s_waitcnt lgkmcnt(8)
v_mfma_f32_16x16x32_bf16 v[100:103], v[88:91], v[80:83], v[244:247]
v_mfma_f32_16x16x32_bf16 v[104:107], v[84:87], v[80:83], v[248:251]
s_nop 4
v_max3_f32 v60, v52, v53, v54
v_max3_f32 v108, v100, v101, v102
v_max3_f32 v61, v55, v56, v57
v_max3_f32 v109, v103, v104, v105
v_max3_f32 v60, v60, v58, v59
v_max3_f32 v108, v108, v106, v107
v_max_f32 v60, v60, v61
v_max_f32 v108, v108, v109
s_nop 0
v_permlane32_swap_b32 v60, v108
v_max_f32 v60, v60, v108
v_mov_b32 v61, v60
s_nop 1
v_permlane16_swap_b32 v60, v61
v_max_f32 v60, v60, v61
v_mul_f32 v60, s61, v60
s_nop 0
v_mov_b32 v108, v60
s_nop 1
v_permlane32_swap_b32 v60, v108
v_fma_f32 v52, v52, s61, -v60
v_fma_f32 v100, v100, s61, -v108
v_fma_f32 v53, v53, s61, -v60
v_fma_f32 v101, v101, s61, -v108
v_fma_f32 v54, v54, s61, -v60
v_fma_f32 v102, v102, s61, -v108
v_fma_f32 v55, v55, s61, -v60
v_fma_f32 v103, v103, s61, -v108
v_fma_f32 v56, v56, s61, -v60
v_fma_f32 v104, v104, s61, -v108
v_fma_f32 v57, v57, s61, -v60
v_fma_f32 v105, v105, s61, -v108
v_fma_f32 v58, v58, s61, -v60
v_fma_f32 v106, v106, s61, -v108
v_fma_f32 v59, v59, s61, -v60
v_fma_f32 v107, v107, s61, -v108
v_exp_f32 v52, v52
v_exp_f32 v100, v100
v_exp_f32 v53, v53
v_exp_f32 v101, v101
v_exp_f32 v54, v54
v_exp_f32 v102, v102
v_exp_f32 v55, v55
v_exp_f32 v103, v103
v_exp_f32 v56, v56
v_exp_f32 v104, v104
v_exp_f32 v57, v57
v_exp_f32 v105, v105
v_exp_f32 v58, v58
v_exp_f32 v106, v106
v_exp_f32 v59, v59
v_exp_f32 v107, v107
v_cvt_pk_bf16_f32 v64, v52, v53
v_cvt_pk_bf16_f32 v112, v100, v101
v_cvt_pk_bf16_f32 v65, v54, v55
v_cvt_pk_bf16_f32 v113, v102, v103
v_cvt_pk_bf16_f32 v66, v56, v57
v_cvt_pk_bf16_f32 v114, v104, v105
v_cvt_pk_bf16_f32 v67, v58, v59
v_cvt_pk_bf16_f32 v115, v106, v107
v_pk_add_f32 v[52:53], v[52:53], v[54:55]
v_pk_add_f32 v[100:101], v[100:101], v[102:103]
v_pk_add_f32 v[56:57], v[56:57], v[58:59]
v_pk_add_f32 v[104:105], v[104:105], v[106:107]
s_waitcnt lgkmcnt(0)
s_waitcnt lgkmcnt(0)
v_mfma_f32_16x16x32_bf16 v[68:71], v[44:47], v[64:67], 0
v_mfma_f32_16x16x32_bf16 v[116:119], v[92:95], v[112:115], 0
v_mfma_f32_16x16x32_bf16 v[72:75], v[48:51], v[64:67], 0
v_mfma_f32_16x16x32_bf16 v[120:123], v[96:99], v[112:115], 0
v_pk_add_f32 v[52:53], v[52:53], v[56:57]
v_pk_add_f32 v[100:101], v[100:101], v[104:105]
v_add_f32 v60, v52, v53
v_add_f32 v108, v100, v101
s_nop 0
v_permlane32_swap_b32 v60, v108
v_add_f32 v60, v60, v108
v_mov_b32 v61, v60
s_nop 1
v_permlane16_swap_b32 v60, v61
v_add_f32 v60, v60, v61
v_rcp_f32 v60, v60
s_nop 0
v_mov_b32 v108, v60
s_nop 1
v_permlane32_swap_b32 v60, v108
v_pk_mul_f32 v[68:69], v[60:61], v[68:69] op_sel_hi:[0,1]
v_pk_mul_f32 v[116:117], v[108:109], v[116:117] op_sel_hi:[0,1]
v_pk_mul_f32 v[70:71], v[60:61], v[70:71] op_sel_hi:[0,1]
v_pk_mul_f32 v[118:119], v[108:109], v[118:119] op_sel_hi:[0,1]
v_pk_mul_f32 v[72:73], v[60:61], v[72:73] op_sel_hi:[0,1]
v_pk_mul_f32 v[120:121], v[108:109], v[120:121] op_sel_hi:[0,1]
v_pk_mul_f32 v[74:75], v[60:61], v[74:75] op_sel_hi:[0,1]
v_pk_mul_f32 v[122:123], v[108:109], v[122:123] op_sel_hi:[0,1]
v_cvt_pk_bf16_f32 v64, v68, v69
v_cvt_pk_bf16_f32 v112, v116, v117
v_cvt_pk_bf16_f32 v65, v70, v71
v_cvt_pk_bf16_f32 v113, v118, v119
v_cvt_pk_bf16_f32 v66, v72, v73
v_cvt_pk_bf16_f32 v114, v120, v121
v_cvt_pk_bf16_f32 v67, v74, v75
v_cvt_pk_bf16_f32 v115, v122, v123
buffer_store_dwordx4 v[64:67], v24, s[16:19], s60 offen offset:0 sc1
buffer_store_dwordx4 v[112:115], v24, s[16:19], s60 offen offset:2048 sc1
s_cmp_lt_u32 s36, 4
s_cbranch_scc1 Lc_74
s_add_u32 s56, s82, 28311552
s_addc_u32 s57, s83, 0
s_mov_b32 s58, 49152
s_mov_b32 s59, 0x20000
s_add_u32 s28, s68, s38
s_addc_u32 s29, s69, 0
s_mov_b32 s30, 2095232
s_mov_b32 s31, 0x20000
s_add_u32 s42, s40, 4
s_and_b32 s42, s42, 15
s_lshl_b32 s42, s42, 17
s_add_u32 m0, s39, 114688
s_add_u32 s43, s42, 0
buffer_load_dwordx4 v7, s[28:31], s43 offen lds
s_add_u32 m0, s39, 115712
s_add_u32 s43, s42, 16384
buffer_load_dwordx4 v7, s[28:31], s43 offen lds
s_add_u32 m0, s39, 116736
s_add_u32 s43, s42, 32768
buffer_load_dwordx4 v7, s[28:31], s43 offen lds
s_add_u32 m0, s39, 117760
s_add_u32 s43, s42, 49152
buffer_load_dwordx4 v7, s[28:31], s43 offen lds
s_add_u32 m0, s39, 118784
s_add_u32 s43, s42, 65536
buffer_load_dwordx4 v7, s[28:31], s43 offen lds
s_add_u32 m0, s39, 119808
s_add_u32 s43, s42, 81920
buffer_load_dwordx4 v7, s[28:31], s43 offen lds
s_add_u32 m0, s39, 120832
s_add_u32 s43, s42, 98304
buffer_load_dwordx4 v7, s[28:31], s43 offen lds
s_add_u32 m0, s39, 121856
s_add_u32 s43, s42, 114688
buffer_load_dwordx4 v7, s[28:31], s43 offen lds
s_waitcnt vmcnt(8)
s_branch Lo_75
Lc_74:
s_add_u32 s56, s82, 28311552
s_addc_u32 s57, s83, 0
s_mov_b32 s58, 49152
s_mov_b32 s59, 0x20000
s_waitcnt vmcnt(0)
Lo_75:
s_barrier
s_cmp_lg_u32 s36, 0
s_cbranch_scc1 Lsig_76
s_add_u32 s7, s34, 0
s_lshl_b32 s7, s7, 7
v_mov_b32 v4, s7
v_mov_b32 v5, 1
s_mov_b64 exec, 1
buffer_atomic_add v5, v4, s[56:59], 0 offen sc1
s_mov_b64 exec, -1
Lsig_76:
s_cmp_ge_u32 s36, 4
s_cbranch_scc1 Lprod_78
v_and_b32 v12, 15, v1
v_lshrrev_b32 v13, 4, v1
v_lshlrev_b32 v10, 12, v12
v_and_b32 v14, 1, v13
v_lshl_add_u32 v10, v14, 5, v10
v_lshrrev_b32 v14, 1, v13
v_lshl_add_u32 v10, v14, 4, v10
s_lshl_b32 s43, s34, 18
s_lshl_b32 s44, s36, 16
s_add_u32 s43, s43, s44
s_lshl_b32 s44, s35, 7
s_add_u32 s43, s43, s44
buffer_load_dwordx4 v[128:131], v10, s[8:11], s43 offen offset:0
buffer_load_dwordx4 v[132:135], v10, s[8:11], s43 offen offset:64
buffer_load_dwordx4 v[136:139], v10, s[8:11], s43 offen offset:2048
buffer_load_dwordx4 v[140:143], v10, s[8:11], s43 offen offset:2112
s_mul_i32 s43, s34, 262144
s_add_u32 s20, s82, s43
s_addc_u32 s21, s83, 0
s_add_u32 s20, s20, 4194304
s_addc_u32 s21, s21, 0
s_mov_b32 s22, 262144
s_mov_b32 s23, 0x20000
s_mul_i32 s43, s34, 16384
s_add_u32 s24, s82, s43
s_addc_u32 s25, s83, 0
s_add_u32 s24, s24, 25165824
s_addc_u32 s25, s25, 0
s_mov_b32 s26, 16384
s_mov_b32 s27, 0x20000
v_lshlrev_b32 v11, 4, v1
s_lshl_b32 s43, s36, 11
v_add_u32 v2, s43, v11
v_add_u32 v3, 98304, v2
v_lshrrev_b32 v14, 2, v1
v_bfe_u32 v15, v14, 1, 2
v_mul_u32_u24 v14, 128, v14
v_lshl_add_u32 v14, v15, 5, v14
v_and_b32 v15, 3, v1
v_lshl_add_u32 v4, v15, 3, v14
v_xor_b32 v5, 32, v4
v_xor_b32 v6, 64, v4
v_xor_b32 v7, 96, v4
v_add_u32 v16, 0x10000, v4
v_add_u32 v20, 0x20000, v4
v_add_u32 v17, 0x10000, v5
v_add_u32 v21, 0x20000, v5
v_add_u32 v18, 0x10000, v6
v_add_u32 v22, 0x20000, v6
v_add_u32 v19, 0x10000, v7
v_add_u32 v23, 0x20000, v7
s_lshl_b32 s44, s35, 14
s_add_u32 s60, s44, s43
v_lshrrev_b32 v14, 1, v13
v_lshlrev_b32 v14, 11, v14
v_lshl_add_u32 v14, v12, 3, v14
v_and_b32 v15, 1, v13
v_lshl_add_u32 v14, v15, 2, v14
s_lshl_b32 s43, s36, 12
s_lshl_b32 s44, s35, 7
s_add_u32 s43, s43, s44
v_add_u32 v9, s43, v14
s_mov_b32 s61, 0x3f803f80
s_waitcnt vmcnt(0)
v_permlane16_swap_b32 v128, v130
v_permlane16_swap_b32 v129, v131
v_permlane16_swap_b32 v132, v134
v_permlane16_swap_b32 v133, v135
v_permlane16_swap_b32 v136, v138
v_permlane16_swap_b32 v137, v139
v_permlane16_swap_b32 v140, v142
v_permlane16_swap_b32 v141, v143
v_lshlrev_b32 v96, 16, v128
v_and_b32 v97, 0xffff0000, v128
v_lshlrev_b32 v98, 16, v129
v_and_b32 v99, 0xffff0000, v129
v_lshlrev_b32 v100, 16, v130
v_and_b32 v101, 0xffff0000, v130
v_lshlrev_b32 v102, 16, v131
v_and_b32 v103, 0xffff0000, v131
v_lshlrev_b32 v104, 16, v132
v_and_b32 v105, 0xffff0000, v132
v_lshlrev_b32 v106, 16, v133
v_and_b32 v107, 0xffff0000, v133
v_lshlrev_b32 v108, 16, v134
v_and_b32 v109, 0xffff0000, v134
v_lshlrev_b32 v110, 16, v135
v_and_b32 v111, 0xffff0000, v135
v_lshlrev_b32 v112, 16, v136
v_and_b32 v113, 0xffff0000, v136
v_lshlrev_b32 v114, 16, v137
v_and_b32 v115, 0xffff0000, v137
v_lshlrev_b32 v116, 16, v138
v_and_b32 v117, 0xffff0000, v138
v_lshlrev_b32 v118, 16, v139
v_and_b32 v119, 0xffff0000, v139
v_lshlrev_b32 v120, 16, v140
v_and_b32 v121, 0xffff0000, v140
v_lshlrev_b32 v122, 16, v141
v_and_b32 v123, 0xffff0000, v141
v_lshlrev_b32 v124, 16, v142
v_and_b32 v125, 0xffff0000, v142
v_lshlrev_b32 v126, 16, v143
v_and_b32 v127, 0xffff0000, v143
s_bitcmp0_b32 s36, 1
s_cselect_b32 s44, s72, s74
s_cselect_b32 s45, s73, s75
s_mul_i32 s43, s35, 192
s_add_u32 s16, s44, s43
s_addc_u32 s17, s45, 0
s_add_u32 s16, s16, 4096
s_addc_u32 s17, s17, 0
s_mov_b32 s18, 7333056
s_mov_b32 s19, 0x20000
v_add_u32 v196, 0, v1
v_mul_u32_u24 v197, 5462, v196
v_lshrrev_b32 v197, 16, v197
v_mul_u32_u24 v198, 12, v197
v_sub_u32 v198, v196, v198
v_bfe_u32 v199, v197, 2, 1
v_cmp_gt_u32 vcc, 8, v198
v_lshlrev_b32 v200, 1, v199
v_mul_u32_u24 v197, 7168, v197
v_cndmask_b32 v199, v199, v200, vcc
v_xor_b32 v198, v198, v199
v_lshl_add_u32 v192, v198, 4, v197
v_add_u32 v196, 64, v1
v_mul_u32_u24 v197, 5462, v196
v_lshrrev_b32 v197, 16, v197
v_mul_u32_u24 v198, 12, v197
v_sub_u32 v198, v196, v198
v_bfe_u32 v199, v197, 2, 1
v_cmp_gt_u32 vcc, 8, v198
v_lshlrev_b32 v200, 1, v199
v_mul_u32_u24 v197, 7168, v197
v_cndmask_b32 v199, v199, v200, vcc
v_xor_b32 v198, v198, v199
v_lshl_add_u32 v193, v198, 4, v197
v_add_u32 v196, 128, v1
v_mul_u32_u24 v197, 5462, v196
v_lshrrev_b32 v197, 16, v197
v_mul_u32_u24 v198, 12, v197
v_sub_u32 v198, v196, v198
v_bfe_u32 v199, v197, 2, 1
v_cmp_gt_u32 vcc, 8, v198
v_lshlrev_b32 v200, 1, v199
v_mul_u32_u24 v197, 7168, v197
v_cndmask_b32 v199, v199, v200, vcc
v_xor_b32 v198, v198, v199
v_lshl_add_u32 v194, v198, 4, v197
s_and_b32 s43, s36, 1
s_mul_i32 s43, s43, 229376
v_add_u32 v192, s43, v192
v_add_u32 v193, s43, v193
v_add_u32 v194, s43, v194
s_and_b32 s43, s36, 3
s_mul_i32 s50, s43, 6144
s_add_u32 s50, s50, 16384
s_bitcmp0_b32 s2, 0
s_cselect_b32 s88, s72, s74
s_cselect_b32 s89, s73, s75
s_mov_b32 s90, 7340032
s_mov_b32 s91, 0x20000
s_bfe_u32 s44, s2, 0x30001
s_lshl_b32 s44, s44, 2
s_and_b32 s43, s36, 3
s_add_u32 s44, s44, s43
s_lshl_b32 s44, s44, 5
v_lshrrev_b32 v195, 4, v1
v_add_u32 v195, s44, v195
v_mul_u32_u24 v195, 7168, v195
v_and_b32 v196, 15, v1
v_lshl_add_u32 v195, v196, 4, v195
s_lshr_b32 s43, s2, 4
s_lshl_b32 s43, s43, 8
v_add_u32 v195, s43, v195
s_cmp_lg_u32 s36, 0
s_cbranch_scc1 Lwm_81
s_nop 0
s_branch Lwe_80
Lwm_81:
s_cmp_lg_u32 s36, 1
s_cbranch_scc1 Lwm_82
s_nop 0
s_branch Lwe_80
Lwm_82:
s_cmp_lg_u32 s36, 2
s_cbranch_scc1 Lwm_83
s_nop 0
s_branch Lwe_80
Lwm_83:
s_cmp_lg_u32 s36, 3
s_cbranch_scc1 Lwm_84
s_nop 0
s_branch Lwe_80
Lwm_84:
Lwe_80:
s_barrier
ds_read_b128 v[32:35], v2 offset:0
ds_read_b64_tr_b16 v[40:41], v16 offset:0
ds_read_b64_tr_b16 v[42:43], v16 offset:2048
ds_read_b64_tr_b16 v[44:45], v17 offset:0
ds_read_b64_tr_b16 v[46:47], v17 offset:2048
ds_read_b64_tr_b16 v[48:49], v18 offset:0
ds_read_b64_tr_b16 v[50:51], v18 offset:2048
s_branch Lov_5
.p2align 12
Lst_5_0:
s_branch Lwr_145
s_nop 0
s_nop 0
Lov_5:
ds_read_b64_tr_b16 v[52:53], v19 offset:0
ds_read_b64_tr_b16 v[54:55], v19 offset:2048
ds_read_b128 v[36:39], v2 offset:1024
ds_read_b128 v[56:59], v2 offset:8192
ds_read_b64_tr_b16 v[64:65], v16 offset:4096
ds_read_b64_tr_b16 v[66:67], v16 offset:6144
ds_read_b64_tr_b16 v[68:69], v17 offset:4096
ds_read_b64_tr_b16 v[70:71], v17 offset:6144
ds_read_b64_tr_b16 v[72:73], v18 offset:4096
ds_read_b64_tr_b16 v[74:75], v18 offset:6144
ds_read_b64_tr_b16 v[76:77], v19 offset:4096
ds_read_b64_tr_b16 v[78:79], v19 offset:6144
ds_read_b128 v[60:63], v2 offset:9216
s_waitcnt lgkmcnt(0)
s_barrier
v_mfma_f32_16x16x32_bf16 v[96:99], v[40:43], v[32:35], v[96:99]
ds_read_b128 v[144:147], v2 offset:49152
ds_read_b64_tr_b16 v[152:153], v16 offset:8192
v_mfma_f32_16x16x32_bf16 v[100:103], v[44:47], v[32:35], v[100:103]
ds_read_b64_tr_b16 v[154:155], v16 offset:10240
ds_read_b64_tr_b16 v[156:157], v17 offset:8192
v_mfma_f32_16x16x32_bf16 v[104:107], v[48:51], v[32:35], v[104:107]
ds_read_b64_tr_b16 v[158:159], v17 offset:10240
ds_read_b64_tr_b16 v[160:161], v18 offset:8192
v_mfma_f32_16x16x32_bf16 v[108:111], v[52:55], v[32:35], v[108:111]
ds_read_b64_tr_b16 v[162:163], v18 offset:10240
ds_read_b64_tr_b16 v[164:165], v19 offset:8192
v_mfma_f32_16x16x32_bf16 v[124:127], v[52:55], v[36:39], v[124:127]
ds_read_b64_tr_b16 v[166:167], v19 offset:10240
ds_read_b128 v[148:151], v2 offset:50176
v_mfma_f32_16x16x32_bf16 v[120:123], v[48:51], v[36:39], v[120:123]
ds_read_b128 v[168:171], v2 offset:57344
ds_read_b64_tr_b16 v[176:177], v16 offset:12288
v_mfma_f32_16x16x32_bf16 v[116:119], v[44:47], v[36:39], v[116:119]
ds_read_b64_tr_b16 v[178:179], v16 offset:14336
ds_read_b64_tr_b16 v[180:181], v17 offset:12288
v_mfma_f32_16x16x32_bf16 v[112:115], v[40:43], v[36:39], v[112:115]
ds_read_b64_tr_b16 v[182:183], v17 offset:14336
ds_read_b64_tr_b16 v[184:185], v18 offset:12288
v_mfma_f32_16x16x32_bf16 v[96:99], v[64:67], v[56:59], v[96:99]
ds_read_b64_tr_b16 v[186:187], v18 offset:14336
ds_read_b64_tr_b16 v[188:189], v19 offset:12288
v_mfma_f32_16x16x32_bf16 v[100:103], v[68:71], v[56:59], v[100:103]
ds_read_b64_tr_b16 v[190:191], v19 offset:14336
ds_read_b128 v[172:175], v2 offset:58368
v_mfma_f32_16x16x32_bf16 v[104:107], v[72:75], v[56:59], v[104:107]
v_mfma_f32_16x16x32_bf16 v[108:111], v[76:79], v[56:59], v[108:111]
v_mfma_f32_16x16x32_bf16 v[124:127], v[76:79], v[60:63], v[124:127]
v_mfma_f32_16x16x32_bf16 v[120:123], v[72:75], v[60:63], v[120:123]
v_mfma_f32_16x16x32_bf16 v[116:119], v[68:71], v[60:63], v[116:119]
v_mfma_f32_16x16x32_bf16 v[112:115], v[64:67], v[60:63], v[112:115]
s_waitcnt lgkmcnt(0)
s_barrier
v_mfma_f32_16x16x32_bf16 v[96:99], v[152:155], v[144:147], v[96:99]
ds_read_b128 v[32:35], v3 offset:0
ds_read_b64_tr_b16 v[40:41], v16 offset:16384
v_mfma_f32_16x16x32_bf16 v[100:103], v[156:159], v[144:147], v[100:103]
ds_read_b64_tr_b16 v[42:43], v16 offset:18432
ds_read_b64_tr_b16 v[44:45], v17 offset:16384
v_mfma_f32_16x16x32_bf16 v[104:107], v[160:163], v[144:147], v[104:107]
ds_read_b64_tr_b16 v[46:47], v17 offset:18432
ds_read_b64_tr_b16 v[48:49], v18 offset:16384
v_mfma_f32_16x16x32_bf16 v[108:111], v[164:167], v[144:147], v[108:111]
ds_read_b64_tr_b16 v[50:51], v18 offset:18432
ds_read_b64_tr_b16 v[52:53], v19 offset:16384
v_mfma_f32_16x16x32_bf16 v[124:127], v[164:167], v[148:151], v[124:127]
ds_read_b64_tr_b16 v[54:55], v19 offset:18432
ds_read_b128 v[36:39], v3 offset:1024
v_mfma_f32_16x16x32_bf16 v[120:123], v[160:163], v[148:151], v[120:123]
ds_read_b128 v[56:59], v3 offset:8192
ds_read_b64_tr_b16 v[64:65], v16 offset:20480
v_mfma_f32_16x16x32_bf16 v[116:119], v[156:159], v[148:151], v[116:119]
ds_read_b64_tr_b16 v[66:67], v16 offset:22528
ds_read_b64_tr_b16 v[68:69], v17 offset:20480
v_mfma_f32_16x16x32_bf16 v[112:115], v[152:155], v[148:151], v[112:115]
ds_read_b64_tr_b16 v[70:71], v17 offset:22528
ds_read_b64_tr_b16 v[72:73], v18 offset:20480
v_mfma_f32_16x16x32_bf16 v[96:99], v[176:179], v[168:171], v[96:99]
ds_read_b64_tr_b16 v[74:75], v18 offset:22528
ds_read_b64_tr_b16 v[76:77], v19 offset:20480
v_mfma_f32_16x16x32_bf16 v[100:103], v[180:183], v[168:171], v[100:103]
ds_read_b64_tr_b16 v[78:79], v19 offset:22528
ds_read_b128 v[60:63], v3 offset:9216
v_mfma_f32_16x16x32_bf16 v[104:107], v[184:187], v[168:171], v[104:107]
v_mfma_f32_16x16x32_bf16 v[108:111], v[188:191], v[168:171], v[108:111]
v_mfma_f32_16x16x32_bf16 v[124:127], v[188:191], v[172:175], v[124:127]
v_mfma_f32_16x16x32_bf16 v[120:123], v[184:187], v[172:175], v[120:123]
v_mfma_f32_16x16x32_bf16 v[116:119], v[180:183], v[172:175], v[116:119]
v_mfma_f32_16x16x32_bf16 v[112:115], v[176:179], v[172:175], v[112:115]
s_waitcnt lgkmcnt(0)
s_barrier
v_mfma_f32_16x16x32_bf16 v[96:99], v[40:43], v[32:35], v[96:99]
ds_read_b128 v[144:147], v3 offset:49152
ds_read_b64_tr_b16 v[152:153], v16 offset:24576
v_mfma_f32_16x16x32_bf16 v[100:103], v[44:47], v[32:35], v[100:103]
ds_read_b64_tr_b16 v[154:155], v16 offset:26624
ds_read_b64_tr_b16 v[156:157], v17 offset:24576
v_mfma_f32_16x16x32_bf16 v[104:107], v[48:51], v[32:35], v[104:107]
ds_read_b64_tr_b16 v[158:159], v17 offset:26624
ds_read_b64_tr_b16 v[160:161], v18 offset:24576
v_mfma_f32_16x16x32_bf16 v[108:111], v[52:55], v[32:35], v[108:111]
ds_read_b64_tr_b16 v[162:163], v18 offset:26624
ds_read_b64_tr_b16 v[164:165], v19 offset:24576
v_mfma_f32_16x16x32_bf16 v[124:127], v[52:55], v[36:39], v[124:127]
ds_read_b64_tr_b16 v[166:167], v19 offset:26624
ds_read_b128 v[148:151], v3 offset:50176
v_mfma_f32_16x16x32_bf16 v[120:123], v[48:51], v[36:39], v[120:123]
ds_read_b128 v[168:171], v3 offset:57344
ds_read_b64_tr_b16 v[176:177], v16 offset:28672
v_mfma_f32_16x16x32_bf16 v[116:119], v[44:47], v[36:39], v[116:119]
ds_read_b64_tr_b16 v[178:179], v16 offset:30720
ds_read_b64_tr_b16 v[180:181], v17 offset:28672
v_mfma_f32_16x16x32_bf16 v[112:115], v[40:43], v[36:39], v[112:115]
ds_read_b64_tr_b16 v[182:183], v17 offset:30720
ds_read_b64_tr_b16 v[184:185], v18 offset:28672
v_mfma_f32_16x16x32_bf16 v[96:99], v[64:67], v[56:59], v[96:99]
ds_read_b64_tr_b16 v[186:187], v18 offset:30720
ds_read_b64_tr_b16 v[188:189], v19 offset:28672
v_mfma_f32_16x16x32_bf16 v[100:103], v[68:71], v[56:59], v[100:103]
ds_read_b64_tr_b16 v[190:191], v19 offset:30720
ds_read_b128 v[172:175], v3 offset:58368
v_mfma_f32_16x16x32_bf16 v[104:107], v[72:75], v[56:59], v[104:107]
v_mfma_f32_16x16x32_bf16 v[108:111], v[76:79], v[56:59], v[108:111]
v_mfma_f32_16x16x32_bf16 v[124:127], v[76:79], v[60:63], v[124:127]
v_mfma_f32_16x16x32_bf16 v[120:123], v[72:75], v[60:63], v[120:123]
v_mfma_f32_16x16x32_bf16 v[116:119], v[68:71], v[60:63], v[116:119]
v_mfma_f32_16x16x32_bf16 v[112:115], v[64:67], v[60:63], v[112:115]
s_waitcnt lgkmcnt(0)
s_barrier
v_mfma_f32_16x16x32_bf16 v[96:99], v[152:155], v[144:147], v[96:99]
ds_read_b128 v[32:35], v2 offset:0
ds_read_b64_tr_b16 v[40:41], v16 offset:49152
v_mfma_f32_16x16x32_bf16 v[100:103], v[156:159], v[144:147], v[100:103]
ds_read_b64_tr_b16 v[42:43], v16 offset:51200
ds_read_b64_tr_b16 v[44:45], v17 offset:49152
v_mfma_f32_16x16x32_bf16 v[104:107], v[160:163], v[144:147], v[104:107]
ds_read_b64_tr_b16 v[46:47], v17 offset:51200
ds_read_b64_tr_b16 v[48:49], v18 offset:49152
v_mfma_f32_16x16x32_bf16 v[108:111], v[164:167], v[144:147], v[108:111]
ds_read_b64_tr_b16 v[50:51], v18 offset:51200
ds_read_b64_tr_b16 v[52:53], v19 offset:49152
v_mfma_f32_16x16x32_bf16 v[124:127], v[164:167], v[148:151], v[124:127]
ds_read_b64_tr_b16 v[54:55], v19 offset:51200
ds_read_b128 v[36:39], v2 offset:1024
v_mfma_f32_16x16x32_bf16 v[120:123], v[160:163], v[148:151], v[120:123]
ds_read_b128 v[56:59], v2 offset:8192
ds_read_b64_tr_b16 v[64:65], v16 offset:53248
v_mfma_f32_16x16x32_bf16 v[116:119], v[156:159], v[148:151], v[116:119]
ds_read_b64_tr_b16 v[66:67], v16 offset:55296
ds_read_b64_tr_b16 v[68:69], v17 offset:53248
v_mfma_f32_16x16x32_bf16 v[112:115], v[152:155], v[148:151], v[112:115]
ds_read_b64_tr_b16 v[70:71], v17 offset:55296
ds_read_b64_tr_b16 v[72:73], v18 offset:53248
v_mfma_f32_16x16x32_bf16 v[96:99], v[176:179], v[168:171], v[96:99]
ds_read_b64_tr_b16 v[74:75], v18 offset:55296
ds_read_b64_tr_b16 v[76:77], v19 offset:53248
v_mfma_f32_16x16x32_bf16 v[100:103], v[180:183], v[168:171], v[100:103]
ds_read_b64_tr_b16 v[78:79], v19 offset:55296
ds_read_b128 v[60:63], v2 offset:9216
v_mfma_f32_16x16x32_bf16 v[104:107], v[184:187], v[168:171], v[104:107]
v_mfma_f32_16x16x32_bf16 v[108:111], v[188:191], v[168:171], v[108:111]
v_mfma_f32_16x16x32_bf16 v[124:127], v[188:191], v[172:175], v[124:127]
v_mfma_f32_16x16x32_bf16 v[120:123], v[184:187], v[172:175], v[120:123]
v_mfma_f32_16x16x32_bf16 v[116:119], v[180:183], v[172:175], v[116:119]
v_mfma_f32_16x16x32_bf16 v[112:115], v[176:179], v[172:175], v[112:115]
s_waitcnt lgkmcnt(0)
s_barrier
v_mfma_f32_16x16x32_bf16 v[96:99], v[40:43], v[32:35], v[96:99]
ds_read_b128 v[144:147], v2 offset:49152
ds_read_b64_tr_b16 v[152:153], v16 offset:57344
v_mfma_f32_16x16x32_bf16 v[100:103], v[44:47], v[32:35], v[100:103]
ds_read_b64_tr_b16 v[154:155], v16 offset:59392
ds_read_b64_tr_b16 v[156:157], v17 offset:57344
v_mfma_f32_16x16x32_bf16 v[104:107], v[48:51], v[32:35], v[104:107]
ds_read_b64_tr_b16 v[158:159], v17 offset:59392
ds_read_b64_tr_b16 v[160:161], v18 offset:57344
v_mfma_f32_16x16x32_bf16 v[108:111], v[52:55], v[32:35], v[108:111]
ds_read_b64_tr_b16 v[162:163], v18 offset:59392
ds_read_b64_tr_b16 v[164:165], v19 offset:57344
v_mfma_f32_16x16x32_bf16 v[124:127], v[52:55], v[36:39], v[124:127]
ds_read_b64_tr_b16 v[166:167], v19 offset:59392
ds_read_b128 v[148:151], v2 offset:50176
v_mfma_f32_16x16x32_bf16 v[120:123], v[48:51], v[36:39], v[120:123]
ds_read_b128 v[168:171], v2 offset:57344
ds_read_b64_tr_b16 v[176:177], v16 offset:61440
v_mfma_f32_16x16x32_bf16 v[116:119], v[44:47], v[36:39], v[116:119]
ds_read_b64_tr_b16 v[178:179], v16 offset:63488
ds_read_b64_tr_b16 v[180:181], v17 offset:61440
v_mfma_f32_16x16x32_bf16 v[112:115], v[40:43], v[36:39], v[112:115]
ds_read_b64_tr_b16 v[182:183], v17 offset:63488
ds_read_b64_tr_b16 v[184:185], v18 offset:61440
v_mfma_f32_16x16x32_bf16 v[96:99], v[64:67], v[56:59], v[96:99]
ds_read_b64_tr_b16 v[186:187], v18 offset:63488
ds_read_b64_tr_b16 v[188:189], v19 offset:61440
v_mfma_f32_16x16x32_bf16 v[100:103], v[68:71], v[56:59], v[100:103]
ds_read_b64_tr_b16 v[190:191], v19 offset:63488
ds_read_b128 v[172:175], v2 offset:58368
v_mfma_f32_16x16x32_bf16 v[104:107], v[72:75], v[56:59], v[104:107]
v_mfma_f32_16x16x32_bf16 v[108:111], v[76:79], v[56:59], v[108:111]
v_mfma_f32_16x16x32_bf16 v[124:127], v[76:79], v[60:63], v[124:127]
v_mfma_f32_16x16x32_bf16 v[120:123], v[72:75], v[60:63], v[120:123]
v_mfma_f32_16x16x32_bf16 v[116:119], v[68:71], v[60:63], v[116:119]
v_mfma_f32_16x16x32_bf16 v[112:115], v[64:67], v[60:63], v[112:115]
s_waitcnt lgkmcnt(0)
s_barrier
v_mfma_f32_16x16x32_bf16 v[96:99], v[152:155], v[144:147], v[96:99]
ds_read_b128 v[32:35], v3 offset:0
ds_read_b64_tr_b16 v[40:41], v20 offset:0
v_mfma_f32_16x16x32_bf16 v[100:103], v[156:159], v[144:147], v[100:103]
ds_read_b64_tr_b16 v[42:43], v20 offset:2048
ds_read_b64_tr_b16 v[44:45], v21 offset:0
v_mfma_f32_16x16x32_bf16 v[104:107], v[160:163], v[144:147], v[104:107]
ds_read_b64_tr_b16 v[46:47], v21 offset:2048
ds_read_b64_tr_b16 v[48:49], v22 offset:0
v_mfma_f32_16x16x32_bf16 v[108:111], v[164:167], v[144:147], v[108:111]
ds_read_b64_tr_b16 v[50:51], v22 offset:2048
ds_read_b64_tr_b16 v[52:53], v23 offset:0
v_mfma_f32_16x16x32_bf16 v[124:127], v[164:167], v[148:151], v[124:127]
ds_read_b64_tr_b16 v[54:55], v23 offset:2048
ds_read_b128 v[36:39], v3 offset:1024
v_mfma_f32_16x16x32_bf16 v[120:123], v[160:163], v[148:151], v[120:123]
ds_read_b128 v[56:59], v3 offset:8192
ds_read_b64_tr_b16 v[64:65], v20 offset:4096
v_mfma_f32_16x16x32_bf16 v[116:119], v[156:159], v[148:151], v[116:119]
ds_read_b64_tr_b16 v[66:67], v20 offset:6144
ds_read_b64_tr_b16 v[68:69], v21 offset:4096
v_mfma_f32_16x16x32_bf16 v[112:115], v[152:155], v[148:151], v[112:115]
ds_read_b64_tr_b16 v[70:71], v21 offset:6144
ds_read_b64_tr_b16 v[72:73], v22 offset:4096
v_mfma_f32_16x16x32_bf16 v[96:99], v[176:179], v[168:171], v[96:99]
ds_read_b64_tr_b16 v[74:75], v22 offset:6144
ds_read_b64_tr_b16 v[76:77], v23 offset:4096
v_mfma_f32_16x16x32_bf16 v[100:103], v[180:183], v[168:171], v[100:103]
ds_read_b64_tr_b16 v[78:79], v23 offset:6144
ds_read_b128 v[60:63], v3 offset:9216
v_mfma_f32_16x16x32_bf16 v[104:107], v[184:187], v[168:171], v[104:107]
v_mfma_f32_16x16x32_bf16 v[108:111], v[188:191], v[168:171], v[108:111]
v_mfma_f32_16x16x32_bf16 v[124:127], v[188:191], v[172:175], v[124:127]
v_mfma_f32_16x16x32_bf16 v[120:123], v[184:187], v[172:175], v[120:123]
v_mfma_f32_16x16x32_bf16 v[116:119], v[180:183], v[172:175], v[116:119]
v_mfma_f32_16x16x32_bf16 v[112:115], v[176:179], v[172:175], v[112:115]
s_waitcnt lgkmcnt(0)
s_barrier
v_mfma_f32_16x16x32_bf16 v[96:99], v[40:43], v[32:35], v[96:99]
ds_read_b128 v[144:147], v3 offset:49152
ds_read_b64_tr_b16 v[152:153], v20 offset:8192
v_mfma_f32_16x16x32_bf16 v[100:103], v[44:47], v[32:35], v[100:103]
ds_read_b64_tr_b16 v[154:155], v20 offset:10240
ds_read_b64_tr_b16 v[156:157], v21 offset:8192
v_mfma_f32_16x16x32_bf16 v[104:107], v[48:51], v[32:35], v[104:107]
ds_read_b64_tr_b16 v[158:159], v21 offset:10240
ds_read_b64_tr_b16 v[160:161], v22 offset:8192
v_mfma_f32_16x16x32_bf16 v[108:111], v[52:55], v[32:35], v[108:111]
ds_read_b64_tr_b16 v[162:163], v22 offset:10240
ds_read_b64_tr_b16 v[164:165], v23 offset:8192
v_mfma_f32_16x16x32_bf16 v[124:127], v[52:55], v[36:39], v[124:127]
ds_read_b64_tr_b16 v[166:167], v23 offset:10240
ds_read_b128 v[148:151], v3 offset:50176
v_mfma_f32_16x16x32_bf16 v[120:123], v[48:51], v[36:39], v[120:123]
ds_read_b128 v[168:171], v3 offset:57344
ds_read_b64_tr_b16 v[176:177], v20 offset:12288
v_mfma_f32_16x16x32_bf16 v[116:119], v[44:47], v[36:39], v[116:119]
ds_read_b64_tr_b16 v[178:179], v20 offset:14336
ds_read_b64_tr_b16 v[180:181], v21 offset:12288
v_mfma_f32_16x16x32_bf16 v[112:115], v[40:43], v[36:39], v[112:115]
ds_read_b64_tr_b16 v[182:183], v21 offset:14336
ds_read_b64_tr_b16 v[184:185], v22 offset:12288
v_mfma_f32_16x16x32_bf16 v[96:99], v[64:67], v[56:59], v[96:99]
ds_read_b64_tr_b16 v[186:187], v22 offset:14336
ds_read_b64_tr_b16 v[188:189], v23 offset:12288
v_mfma_f32_16x16x32_bf16 v[100:103], v[68:71], v[56:59], v[100:103]
ds_read_b64_tr_b16 v[190:191], v23 offset:14336
ds_read_b128 v[172:175], v3 offset:58368
v_mfma_f32_16x16x32_bf16 v[104:107], v[72:75], v[56:59], v[104:107]
v_mfma_f32_16x16x32_bf16 v[108:111], v[76:79], v[56:59], v[108:111]
v_mfma_f32_16x16x32_bf16 v[124:127], v[76:79], v[60:63], v[124:127]
v_mfma_f32_16x16x32_bf16 v[120:123], v[72:75], v[60:63], v[120:123]
v_mfma_f32_16x16x32_bf16 v[116:119], v[68:71], v[60:63], v[116:119]
v_mfma_f32_16x16x32_bf16 v[112:115], v[64:67], v[60:63], v[112:115]
s_waitcnt lgkmcnt(0)
s_barrier
v_mfma_f32_16x16x32_bf16 v[96:99], v[152:155], v[144:147], v[96:99]
ds_read_b128 v[32:35], v2 offset:0
ds_read_b64_tr_b16 v[40:41], v4 offset:16384
v_mfma_f32_16x16x32_bf16 v[100:103], v[156:159], v[144:147], v[100:103]
ds_read_b64_tr_b16 v[42:43], v4 offset:18432
ds_read_b64_tr_b16 v[44:45], v5 offset:16384
v_mfma_f32_16x16x32_bf16 v[104:107], v[160:163], v[144:147], v[104:107]
ds_read_b64_tr_b16 v[46:47], v5 offset:18432
ds_read_b64_tr_b16 v[48:49], v6 offset:16384
v_mfma_f32_16x16x32_bf16 v[108:111], v[164:167], v[144:147], v[108:111]
ds_read_b64_tr_b16 v[50:51], v6 offset:18432
ds_read_b64_tr_b16 v[52:53], v7 offset:16384
v_mfma_f32_16x16x32_bf16 v[124:127], v[164:167], v[148:151], v[124:127]
ds_read_b64_tr_b16 v[54:55], v7 offset:18432
ds_read_b128 v[36:39], v2 offset:1024
v_mfma_f32_16x16x32_bf16 v[120:123], v[160:163], v[148:151], v[120:123]
ds_read_b128 v[56:59], v2 offset:8192
ds_read_b64_tr_b16 v[64:65], v4 offset:20480
v_mfma_f32_16x16x32_bf16 v[116:119], v[156:159], v[148:151], v[116:119]
ds_read_b64_tr_b16 v[66:67], v4 offset:22528
ds_read_b64_tr_b16 v[68:69], v5 offset:20480
v_mfma_f32_16x16x32_bf16 v[112:115], v[152:155], v[148:151], v[112:115]
ds_read_b64_tr_b16 v[70:71], v5 offset:22528
ds_read_b64_tr_b16 v[72:73], v6 offset:20480
v_mfma_f32_16x16x32_bf16 v[96:99], v[176:179], v[168:171], v[96:99]
ds_read_b64_tr_b16 v[74:75], v6 offset:22528
ds_read_b64_tr_b16 v[76:77], v7 offset:20480
v_mfma_f32_16x16x32_bf16 v[100:103], v[180:183], v[168:171], v[100:103]
ds_read_b64_tr_b16 v[78:79], v7 offset:22528
ds_read_b128 v[60:63], v2 offset:9216
v_mfma_f32_16x16x32_bf16 v[104:107], v[184:187], v[168:171], v[104:107]
v_mfma_f32_16x16x32_bf16 v[108:111], v[188:191], v[168:171], v[108:111]
v_mfma_f32_16x16x32_bf16 v[124:127], v[188:191], v[172:175], v[124:127]
v_mfma_f32_16x16x32_bf16 v[120:123], v[184:187], v[172:175], v[120:123]
v_mfma_f32_16x16x32_bf16 v[116:119], v[180:183], v[172:175], v[116:119]
v_mfma_f32_16x16x32_bf16 v[112:115], v[176:179], v[172:175], v[112:115]
s_waitcnt lgkmcnt(0)
s_barrier
v_mfma_f32_16x16x32_bf16 v[96:99], v[40:43], v[32:35], v[96:99]
ds_read_b128 v[144:147], v2 offset:49152
ds_read_b64_tr_b16 v[152:153], v4 offset:24576
v_mfma_f32_16x16x32_bf16 v[100:103], v[44:47], v[32:35], v[100:103]
ds_read_b64_tr_b16 v[154:155], v4 offset:26624
ds_read_b64_tr_b16 v[156:157], v5 offset:24576
v_mfma_f32_16x16x32_bf16 v[104:107], v[48:51], v[32:35], v[104:107]
ds_read_b64_tr_b16 v[158:159], v5 offset:26624
ds_read_b64_tr_b16 v[160:161], v6 offset:24576
v_mfma_f32_16x16x32_bf16 v[108:111], v[52:55], v[32:35], v[108:111]
ds_read_b64_tr_b16 v[162:163], v6 offset:26624
ds_read_b64_tr_b16 v[164:165], v7 offset:24576
v_mfma_f32_16x16x32_bf16 v[124:127], v[52:55], v[36:39], v[124:127]
ds_read_b64_tr_b16 v[166:167], v7 offset:26624
ds_read_b128 v[148:151], v2 offset:50176
v_mfma_f32_16x16x32_bf16 v[120:123], v[48:51], v[36:39], v[120:123]
ds_read_b128 v[168:171], v2 offset:57344
ds_read_b64_tr_b16 v[176:177], v4 offset:28672
v_mfma_f32_16x16x32_bf16 v[116:119], v[44:47], v[36:39], v[116:119]
ds_read_b64_tr_b16 v[178:179], v4 offset:30720
ds_read_b64_tr_b16 v[180:181], v5 offset:28672
v_mfma_f32_16x16x32_bf16 v[112:115], v[40:43], v[36:39], v[112:115]
ds_read_b64_tr_b16 v[182:183], v5 offset:30720
ds_read_b64_tr_b16 v[184:185], v6 offset:28672
v_mfma_f32_16x16x32_bf16 v[96:99], v[64:67], v[56:59], v[96:99]
ds_read_b64_tr_b16 v[186:187], v6 offset:30720
ds_read_b64_tr_b16 v[188:189], v7 offset:28672
v_mfma_f32_16x16x32_bf16 v[100:103], v[68:71], v[56:59], v[100:103]
ds_read_b64_tr_b16 v[190:191], v7 offset:30720
ds_read_b128 v[172:175], v2 offset:58368
v_mfma_f32_16x16x32_bf16 v[104:107], v[72:75], v[56:59], v[104:107]
v_mfma_f32_16x16x32_bf16 v[108:111], v[76:79], v[56:59], v[108:111]
v_mfma_f32_16x16x32_bf16 v[124:127], v[76:79], v[60:63], v[124:127]
v_mfma_f32_16x16x32_bf16 v[120:123], v[72:75], v[60:63], v[120:123]
v_mfma_f32_16x16x32_bf16 v[116:119], v[68:71], v[60:63], v[116:119]
v_mfma_f32_16x16x32_bf16 v[112:115], v[64:67], v[60:63], v[112:115]
s_waitcnt lgkmcnt(0)
s_barrier
v_mfma_f32_16x16x32_bf16 v[96:99], v[152:155], v[144:147], v[96:99]
ds_read_b128 v[32:35], v3 offset:0
ds_read_b64_tr_b16 v[40:41], v4 offset:32768
v_mfma_f32_16x16x32_bf16 v[100:103], v[156:159], v[144:147], v[100:103]
ds_read_b64_tr_b16 v[42:43], v4 offset:34816
ds_read_b64_tr_b16 v[44:45], v5 offset:32768
v_mfma_f32_16x16x32_bf16 v[104:107], v[160:163], v[144:147], v[104:107]
ds_read_b64_tr_b16 v[46:47], v5 offset:34816
ds_read_b64_tr_b16 v[48:49], v6 offset:32768
v_mfma_f32_16x16x32_bf16 v[108:111], v[164:167], v[144:147], v[108:111]
ds_read_b64_tr_b16 v[50:51], v6 offset:34816
ds_read_b64_tr_b16 v[52:53], v7 offset:32768
v_mfma_f32_16x16x32_bf16 v[124:127], v[164:167], v[148:151], v[124:127]
ds_read_b64_tr_b16 v[54:55], v7 offset:34816
ds_read_b128 v[36:39], v3 offset:1024
v_mfma_f32_16x16x32_bf16 v[120:123], v[160:163], v[148:151], v[120:123]
ds_read_b128 v[56:59], v3 offset:8192
ds_read_b64_tr_b16 v[64:65], v4 offset:36864
v_mfma_f32_16x16x32_bf16 v[116:119], v[156:159], v[148:151], v[116:119]
ds_read_b64_tr_b16 v[66:67], v4 offset:38912
ds_read_b64_tr_b16 v[68:69], v5 offset:36864
v_mfma_f32_16x16x32_bf16 v[112:115], v[152:155], v[148:151], v[112:115]
ds_read_b64_tr_b16 v[70:71], v5 offset:38912
ds_read_b64_tr_b16 v[72:73], v6 offset:36864
v_mfma_f32_16x16x32_bf16 v[96:99], v[176:179], v[168:171], v[96:99]
ds_read_b64_tr_b16 v[74:75], v6 offset:38912
ds_read_b64_tr_b16 v[76:77], v7 offset:36864
v_mfma_f32_16x16x32_bf16 v[100:103], v[180:183], v[168:171], v[100:103]
ds_read_b64_tr_b16 v[78:79], v7 offset:38912
ds_read_b128 v[60:63], v3 offset:9216
v_mfma_f32_16x16x32_bf16 v[104:107], v[184:187], v[168:171], v[104:107]
v_mfma_f32_16x16x32_bf16 v[108:111], v[188:191], v[168:171], v[108:111]
v_mfma_f32_16x16x32_bf16 v[124:127], v[188:191], v[172:175], v[124:127]
v_mfma_f32_16x16x32_bf16 v[120:123], v[184:187], v[172:175], v[120:123]
v_mfma_f32_16x16x32_bf16 v[116:119], v[180:183], v[172:175], v[116:119]
v_mfma_f32_16x16x32_bf16 v[112:115], v[176:179], v[172:175], v[112:115]
s_waitcnt lgkmcnt(0)
s_barrier
v_mfma_f32_16x16x32_bf16 v[96:99], v[40:43], v[32:35], v[96:99]
ds_read_b128 v[144:147], v3 offset:49152
ds_read_b64_tr_b16 v[152:153], v4 offset:40960
v_mfma_f32_16x16x32_bf16 v[100:103], v[44:47], v[32:35], v[100:103]
ds_read_b64_tr_b16 v[154:155], v4 offset:43008
ds_read_b64_tr_b16 v[156:157], v5 offset:40960
v_mfma_f32_16x16x32_bf16 v[104:107], v[48:51], v[32:35], v[104:107]
ds_read_b64_tr_b16 v[158:159], v5 offset:43008
ds_read_b64_tr_b16 v[160:161], v6 offset:40960
v_mfma_f32_16x16x32_bf16 v[108:111], v[52:55], v[32:35], v[108:111]
ds_read_b64_tr_b16 v[162:163], v6 offset:43008
ds_read_b64_tr_b16 v[164:165], v7 offset:40960
v_mfma_f32_16x16x32_bf16 v[124:127], v[52:55], v[36:39], v[124:127]
ds_read_b64_tr_b16 v[166:167], v7 offset:43008
ds_read_b128 v[148:151], v3 offset:50176
v_mfma_f32_16x16x32_bf16 v[120:123], v[48:51], v[36:39], v[120:123]
ds_read_b128 v[168:171], v3 offset:57344
ds_read_b64_tr_b16 v[176:177], v4 offset:45056
v_mfma_f32_16x16x32_bf16 v[116:119], v[44:47], v[36:39], v[116:119]
ds_read_b64_tr_b16 v[178:179], v4 offset:47104
ds_read_b64_tr_b16 v[180:181], v5 offset:45056
v_mfma_f32_16x16x32_bf16 v[112:115], v[40:43], v[36:39], v[112:115]
ds_read_b64_tr_b16 v[182:183], v5 offset:47104
ds_read_b64_tr_b16 v[184:185], v6 offset:45056
v_mfma_f32_16x16x32_bf16 v[96:99], v[64:67], v[56:59], v[96:99]
ds_read_b64_tr_b16 v[186:187], v6 offset:47104
ds_read_b64_tr_b16 v[188:189], v7 offset:45056
v_mfma_f32_16x16x32_bf16 v[100:103], v[68:71], v[56:59], v[100:103]
ds_read_b64_tr_b16 v[190:191], v7 offset:47104
ds_read_b128 v[172:175], v3 offset:58368
v_mfma_f32_16x16x32_bf16 v[104:107], v[72:75], v[56:59], v[104:107]
v_mfma_f32_16x16x32_bf16 v[108:111], v[76:79], v[56:59], v[108:111]
v_mfma_f32_16x16x32_bf16 v[124:127], v[76:79], v[60:63], v[124:127]
v_mfma_f32_16x16x32_bf16 v[120:123], v[72:75], v[60:63], v[120:123]
v_mfma_f32_16x16x32_bf16 v[116:119], v[68:71], v[60:63], v[116:119]
v_mfma_f32_16x16x32_bf16 v[112:115], v[64:67], v[60:63], v[112:115]
s_waitcnt lgkmcnt(0)
s_barrier
v_mfma_f32_16x16x32_bf16 v[96:99], v[152:155], v[144:147], v[96:99]
ds_read_b128 v[32:35], v2 offset:0
ds_read_b64_tr_b16 v[40:41], v16 offset:49152
v_mfma_f32_16x16x32_bf16 v[100:103], v[156:159], v[144:147], v[100:103]
ds_read_b64_tr_b16 v[42:43], v16 offset:51200
ds_read_b64_tr_b16 v[44:45], v17 offset:49152
v_mfma_f32_16x16x32_bf16 v[104:107], v[160:163], v[144:147], v[104:107]
ds_read_b64_tr_b16 v[46:47], v17 offset:51200
ds_read_b64_tr_b16 v[48:49], v18 offset:49152
v_mfma_f32_16x16x32_bf16 v[108:111], v[164:167], v[144:147], v[108:111]
ds_read_b64_tr_b16 v[50:51], v18 offset:51200
ds_read_b64_tr_b16 v[52:53], v19 offset:49152
v_mfma_f32_16x16x32_bf16 v[124:127], v[164:167], v[148:151], v[124:127]
ds_read_b64_tr_b16 v[54:55], v19 offset:51200
ds_read_b128 v[36:39], v2 offset:1024
v_mfma_f32_16x16x32_bf16 v[120:123], v[160:163], v[148:151], v[120:123]
ds_read_b128 v[56:59], v2 offset:8192
ds_read_b64_tr_b16 v[64:65], v16 offset:53248
v_mfma_f32_16x16x32_bf16 v[116:119], v[156:159], v[148:151], v[116:119]
ds_read_b64_tr_b16 v[66:67], v16 offset:55296
ds_read_b64_tr_b16 v[68:69], v17 offset:53248
v_mfma_f32_16x16x32_bf16 v[112:115], v[152:155], v[148:151], v[112:115]
ds_read_b64_tr_b16 v[70:71], v17 offset:55296
ds_read_b64_tr_b16 v[72:73], v18 offset:53248
v_mfma_f32_16x16x32_bf16 v[96:99], v[176:179], v[168:171], v[96:99]
ds_read_b64_tr_b16 v[74:75], v18 offset:55296
ds_read_b64_tr_b16 v[76:77], v19 offset:53248
v_mfma_f32_16x16x32_bf16 v[100:103], v[180:183], v[168:171], v[100:103]
ds_read_b64_tr_b16 v[78:79], v19 offset:55296
ds_read_b128 v[60:63], v2 offset:9216
v_mfma_f32_16x16x32_bf16 v[104:107], v[184:187], v[168:171], v[104:107]
v_mfma_f32_16x16x32_bf16 v[108:111], v[188:191], v[168:171], v[108:111]
v_mfma_f32_16x16x32_bf16 v[124:127], v[188:191], v[172:175], v[124:127]
v_mfma_f32_16x16x32_bf16 v[120:123], v[184:187], v[172:175], v[120:123]
v_mfma_f32_16x16x32_bf16 v[116:119], v[180:183], v[172:175], v[116:119]
v_mfma_f32_16x16x32_bf16 v[112:115], v[176:179], v[172:175], v[112:115]
s_waitcnt lgkmcnt(0)
s_barrier
v_mfma_f32_16x16x32_bf16 v[96:99], v[40:43], v[32:35], v[96:99]
ds_read_b128 v[144:147], v2 offset:49152
ds_read_b64_tr_b16 v[152:153], v16 offset:57344
v_mfma_f32_16x16x32_bf16 v[100:103], v[44:47], v[32:35], v[100:103]
ds_read_b64_tr_b16 v[154:155], v16 offset:59392
ds_read_b64_tr_b16 v[156:157], v17 offset:57344
v_mfma_f32_16x16x32_bf16 v[104:107], v[48:51], v[32:35], v[104:107]
ds_read_b64_tr_b16 v[158:159], v17 offset:59392
ds_read_b64_tr_b16 v[160:161], v18 offset:57344
v_mfma_f32_16x16x32_bf16 v[108:111], v[52:55], v[32:35], v[108:111]
ds_read_b64_tr_b16 v[162:163], v18 offset:59392
ds_read_b64_tr_b16 v[164:165], v19 offset:57344
v_mfma_f32_16x16x32_bf16 v[124:127], v[52:55], v[36:39], v[124:127]
ds_read_b64_tr_b16 v[166:167], v19 offset:59392
ds_read_b128 v[148:151], v2 offset:50176
v_mfma_f32_16x16x32_bf16 v[120:123], v[48:51], v[36:39], v[120:123]
ds_read_b128 v[168:171], v2 offset:57344
ds_read_b64_tr_b16 v[176:177], v16 offset:61440
v_mfma_f32_16x16x32_bf16 v[116:119], v[44:47], v[36:39], v[116:119]
ds_read_b64_tr_b16 v[178:179], v16 offset:63488
ds_read_b64_tr_b16 v[180:181], v17 offset:61440
v_mfma_f32_16x16x32_bf16 v[112:115], v[40:43], v[36:39], v[112:115]
ds_read_b64_tr_b16 v[182:183], v17 offset:63488
ds_read_b64_tr_b16 v[184:185], v18 offset:61440
v_mfma_f32_16x16x32_bf16 v[96:99], v[64:67], v[56:59], v[96:99]
ds_read_b64_tr_b16 v[186:187], v18 offset:63488
ds_read_b64_tr_b16 v[188:189], v19 offset:61440
v_mfma_f32_16x16x32_bf16 v[100:103], v[68:71], v[56:59], v[100:103]
ds_read_b64_tr_b16 v[190:191], v19 offset:63488
ds_read_b128 v[172:175], v2 offset:58368
v_mfma_f32_16x16x32_bf16 v[104:107], v[72:75], v[56:59], v[104:107]
v_mfma_f32_16x16x32_bf16 v[108:111], v[76:79], v[56:59], v[108:111]
v_mfma_f32_16x16x32_bf16 v[124:127], v[76:79], v[60:63], v[124:127]
v_mfma_f32_16x16x32_bf16 v[120:123], v[72:75], v[60:63], v[120:123]
v_mfma_f32_16x16x32_bf16 v[116:119], v[68:71], v[60:63], v[116:119]
v_mfma_f32_16x16x32_bf16 v[112:115], v[64:67], v[60:63], v[112:115]
s_waitcnt lgkmcnt(0)
s_barrier
v_mfma_f32_16x16x32_bf16 v[96:99], v[152:155], v[144:147], v[96:99]
ds_read_b128 v[32:35], v3 offset:0
ds_read_b64_tr_b16 v[40:41], v20 offset:0
v_mfma_f32_16x16x32_bf16 v[100:103], v[156:159], v[144:147], v[100:103]
ds_read_b64_tr_b16 v[42:43], v20 offset:2048
ds_read_b64_tr_b16 v[44:45], v21 offset:0
v_mfma_f32_16x16x32_bf16 v[104:107], v[160:163], v[144:147], v[104:107]
ds_read_b64_tr_b16 v[46:47], v21 offset:2048
ds_read_b64_tr_b16 v[48:49], v22 offset:0
v_mfma_f32_16x16x32_bf16 v[108:111], v[164:167], v[144:147], v[108:111]
ds_read_b64_tr_b16 v[50:51], v22 offset:2048
ds_read_b64_tr_b16 v[52:53], v23 offset:0
v_mfma_f32_16x16x32_bf16 v[124:127], v[164:167], v[148:151], v[124:127]
ds_read_b64_tr_b16 v[54:55], v23 offset:2048
ds_read_b128 v[36:39], v3 offset:1024
s_branch Lov_6
.p2align 12
Lst_6_0:
s_branch Lwr_146
s_nop 0
s_nop 0
Lov_6:
v_mfma_f32_16x16x32_bf16 v[120:123], v[160:163], v[148:151], v[120:123]
ds_read_b128 v[56:59], v3 offset:8192
ds_read_b64_tr_b16 v[64:65], v20 offset:4096
v_mfma_f32_16x16x32_bf16 v[116:119], v[156:159], v[148:151], v[116:119]
ds_read_b64_tr_b16 v[66:67], v20 offset:6144
ds_read_b64_tr_b16 v[68:69], v21 offset:4096
v_mfma_f32_16x16x32_bf16 v[112:115], v[152:155], v[148:151], v[112:115]
ds_read_b64_tr_b16 v[70:71], v21 offset:6144
ds_read_b64_tr_b16 v[72:73], v22 offset:4096
v_mfma_f32_16x16x32_bf16 v[96:99], v[176:179], v[168:171], v[96:99]
ds_read_b64_tr_b16 v[74:75], v22 offset:6144
ds_read_b64_tr_b16 v[76:77], v23 offset:4096
v_mfma_f32_16x16x32_bf16 v[100:103], v[180:183], v[168:171], v[100:103]
ds_read_b64_tr_b16 v[78:79], v23 offset:6144
ds_read_b128 v[60:63], v3 offset:9216
v_mfma_f32_16x16x32_bf16 v[104:107], v[184:187], v[168:171], v[104:107]
v_mfma_f32_16x16x32_bf16 v[108:111], v[188:191], v[168:171], v[108:111]
v_mfma_f32_16x16x32_bf16 v[124:127], v[188:191], v[172:175], v[124:127]
v_mfma_f32_16x16x32_bf16 v[120:123], v[184:187], v[172:175], v[120:123]
v_mfma_f32_16x16x32_bf16 v[116:119], v[180:183], v[172:175], v[116:119]
v_mfma_f32_16x16x32_bf16 v[112:115], v[176:179], v[172:175], v[112:115]
s_waitcnt lgkmcnt(0)
s_barrier
v_mfma_f32_16x16x32_bf16 v[96:99], v[40:43], v[32:35], v[96:99]
ds_read_b128 v[144:147], v3 offset:49152
ds_read_b64_tr_b16 v[152:153], v20 offset:8192
v_mfma_f32_16x16x32_bf16 v[100:103], v[44:47], v[32:35], v[100:103]
ds_read_b64_tr_b16 v[154:155], v20 offset:10240
ds_read_b64_tr_b16 v[156:157], v21 offset:8192
v_mfma_f32_16x16x32_bf16 v[104:107], v[48:51], v[32:35], v[104:107]
ds_read_b64_tr_b16 v[158:159], v21 offset:10240
ds_read_b64_tr_b16 v[160:161], v22 offset:8192
v_mfma_f32_16x16x32_bf16 v[108:111], v[52:55], v[32:35], v[108:111]
ds_read_b64_tr_b16 v[162:163], v22 offset:10240
ds_read_b64_tr_b16 v[164:165], v23 offset:8192
v_mfma_f32_16x16x32_bf16 v[124:127], v[52:55], v[36:39], v[124:127]
ds_read_b64_tr_b16 v[166:167], v23 offset:10240
ds_read_b128 v[148:151], v3 offset:50176
v_mfma_f32_16x16x32_bf16 v[120:123], v[48:51], v[36:39], v[120:123]
ds_read_b128 v[168:171], v3 offset:57344
ds_read_b64_tr_b16 v[176:177], v20 offset:12288
v_mfma_f32_16x16x32_bf16 v[116:119], v[44:47], v[36:39], v[116:119]
ds_read_b64_tr_b16 v[178:179], v20 offset:14336
ds_read_b64_tr_b16 v[180:181], v21 offset:12288
v_mfma_f32_16x16x32_bf16 v[112:115], v[40:43], v[36:39], v[112:115]
ds_read_b64_tr_b16 v[182:183], v21 offset:14336
ds_read_b64_tr_b16 v[184:185], v22 offset:12288
v_mfma_f32_16x16x32_bf16 v[96:99], v[64:67], v[56:59], v[96:99]
ds_read_b64_tr_b16 v[186:187], v22 offset:14336
ds_read_b64_tr_b16 v[188:189], v23 offset:12288
v_mfma_f32_16x16x32_bf16 v[100:103], v[68:71], v[56:59], v[100:103]
ds_read_b64_tr_b16 v[190:191], v23 offset:14336
ds_read_b128 v[172:175], v3 offset:58368
v_mfma_f32_16x16x32_bf16 v[104:107], v[72:75], v[56:59], v[104:107]
v_mfma_f32_16x16x32_bf16 v[108:111], v[76:79], v[56:59], v[108:111]
v_mfma_f32_16x16x32_bf16 v[124:127], v[76:79], v[60:63], v[124:127]
v_mfma_f32_16x16x32_bf16 v[120:123], v[72:75], v[60:63], v[120:123]
v_mfma_f32_16x16x32_bf16 v[116:119], v[68:71], v[60:63], v[116:119]
v_mfma_f32_16x16x32_bf16 v[112:115], v[64:67], v[60:63], v[112:115]
s_waitcnt lgkmcnt(0)
s_barrier
v_mfma_f32_16x16x32_bf16 v[96:99], v[152:155], v[144:147], v[96:99]
v_mfma_f32_16x16x32_bf16 v[100:103], v[156:159], v[144:147], v[100:103]
v_mfma_f32_16x16x32_bf16 v[104:107], v[160:163], v[144:147], v[104:107]
v_mfma_f32_16x16x32_bf16 v[108:111], v[164:167], v[144:147], v[108:111]
v_mfma_f32_16x16x32_bf16 v[124:127], v[164:167], v[148:151], v[124:127]
v_mfma_f32_16x16x32_bf16 v[120:123], v[160:163], v[148:151], v[120:123]
v_mfma_f32_16x16x32_bf16 v[116:119], v[156:159], v[148:151], v[116:119]
v_mfma_f32_16x16x32_bf16 v[112:115], v[152:155], v[148:151], v[112:115]
v_mfma_f32_16x16x32_bf16 v[96:99], v[176:179], v[168:171], v[96:99]
v_mfma_f32_16x16x32_bf16 v[100:103], v[180:183], v[168:171], v[100:103]
v_mfma_f32_16x16x32_bf16 v[104:107], v[184:187], v[168:171], v[104:107]
v_mfma_f32_16x16x32_bf16 v[108:111], v[188:191], v[168:171], v[108:111]
v_mfma_f32_16x16x32_bf16 v[124:127], v[188:191], v[172:175], v[124:127]
v_mfma_f32_16x16x32_bf16 v[120:123], v[184:187], v[172:175], v[120:123]
v_mfma_f32_16x16x32_bf16 v[116:119], v[180:183], v[172:175], v[116:119]
v_mfma_f32_16x16x32_bf16 v[112:115], v[176:179], v[172:175], v[112:115]
s_nop 3
v_cvt_pk_bf16_f32 v32, v96, v97
v_cvt_pk_bf16_f32 v33, v98, v99
v_cvt_pk_bf16_f32 v34, v100, v101
v_cvt_pk_bf16_f32 v35, v102, v103
s_add_u32 s43, s60, 0
buffer_store_dwordx4 v[32:35], v11, s[20:23], s43 offen offset:0 sc1
v_cvt_pk_bf16_f32 v36, v104, v105
v_cvt_pk_bf16_f32 v37, v106, v107
v_cvt_pk_bf16_f32 v38, v108, v109
v_cvt_pk_bf16_f32 v39, v110, v111
s_add_u32 s43, s60, 8192
buffer_store_dwordx4 v[36:39], v11, s[20:23], s43 offen offset:0 sc1
v_cvt_pk_bf16_f32 v44, v120, v121
v_cvt_pk_bf16_f32 v45, v122, v123
v_cvt_pk_bf16_f32 v46, v124, v125
v_cvt_pk_bf16_f32 v47, v126, v127
s_add_u32 s43, s60, 8192
buffer_store_dwordx4 v[44:47], v11, s[20:23], s43 offen offset:1024 sc1
v_cvt_pk_bf16_f32 v40, v112, v113
v_cvt_pk_bf16_f32 v41, v114, v115
v_cvt_pk_bf16_f32 v42, v116, v117
v_cvt_pk_bf16_f32 v43, v118, v119
s_add_u32 s43, s60, 0
buffer_store_dwordx4 v[40:43], v11, s[20:23], s43 offen offset:1024 sc1
v_mov_b32 v64, 0
v_mov_b32 v65, 0
v_mov_b32 v66, 0
v_mov_b32 v67, 0
v_mov_b32 v68, 0
v_mov_b32 v69, 0
v_mov_b32 v70, 0
v_mov_b32 v71, 0
v_dot2_f32_bf16 v64, v32, s61, v64
v_dot2_f32_bf16 v66, v32, v32, v66
v_dot2_f32_bf16 v68, v40, s61, v68
v_dot2_f32_bf16 v70, v40, v40, v70
v_dot2_f32_bf16 v65, v33, s61, v65
v_dot2_f32_bf16 v67, v33, v33, v67
v_dot2_f32_bf16 v69, v41, s61, v69
v_dot2_f32_bf16 v71, v41, v41, v71
v_dot2_f32_bf16 v64, v34, s61, v64
v_dot2_f32_bf16 v66, v34, v34, v66
v_dot2_f32_bf16 v68, v42, s61, v68
v_dot2_f32_bf16 v70, v42, v42, v70
v_dot2_f32_bf16 v65, v35, s61, v65
v_dot2_f32_bf16 v67, v35, v35, v67
v_dot2_f32_bf16 v69, v43, s61, v69
v_dot2_f32_bf16 v71, v43, v43, v71
v_dot2_f32_bf16 v64, v36, s61, v64
v_dot2_f32_bf16 v66, v36, v36, v66
v_dot2_f32_bf16 v68, v44, s61, v68
v_dot2_f32_bf16 v70, v44, v44, v70
v_dot2_f32_bf16 v65, v37, s61, v65
v_dot2_f32_bf16 v67, v37, v37, v67
v_dot2_f32_bf16 v69, v45, s61, v69
v_dot2_f32_bf16 v71, v45, v45, v71
v_dot2_f32_bf16 v64, v38, s61, v64
v_dot2_f32_bf16 v66, v38, v38, v66
v_dot2_f32_bf16 v68, v46, s61, v68
v_dot2_f32_bf16 v70, v46, v46, v70
v_dot2_f32_bf16 v65, v39, s61, v65
v_dot2_f32_bf16 v67, v39, v39, v67
v_dot2_f32_bf16 v69, v47, s61, v69
v_dot2_f32_bf16 v71, v47, v47, v71
s_nop 2
v_add_f32 v64, v64, v65
v_add_f32 v66, v66, v67
v_add_f32 v68, v68, v69
v_add_f32 v70, v70, v71
s_nop 1
v_permlane32_swap_b32 v64, v68
v_permlane32_swap_b32 v66, v70
v_add_f32 v64, v64, v68
v_add_f32 v66, v66, v70
s_nop 1
v_permlane16_swap_b32 v64, v66
v_add_f32 v64, v64, v66
buffer_store_dword v64, v9, s[24:27], 0 offen sc1
s_waitcnt vmcnt(0)
s_barrier
s_cmp_lg_u32 s36, 0
s_cbranch_scc1 Lk2end_77
s_add_u32 s7, s34, 16
s_lshl_b32 s7, s7, 7
v_mov_b32 v4, s7
v_mov_b32 v5, 1
s_mov_b64 exec, 1
buffer_atomic_add v5, v4, s[56:59], 0 offen sc1
s_mov_b64 exec, -1
s_branch Lk2end_77
Lprod_78:
s_mul_i32 s43, s34, 262144
s_add_u32 s8, s82, s43
s_addc_u32 s9, s83, 0
s_mov_b32 s10, 262144
s_mov_b32 s11, 0x20000
s_lshl_b32 s43, s35, 7
s_add_u32 s12, s68, s43
s_addc_u32 s13, s69, 0
s_mov_b32 s14, 2095232
s_mov_b32 s15, 0x20000
s_and_b32 s47, s36, 3
s_lshl_b32 s39, s47, 12
v_lshlrev_b32 v2, 4, v1
v_add_u32 v2, s39, v2
v_lshrrev_b32 v12, 3, v1
v_and_b32 v13, 6, v12
v_and_b32 v3, 7, v1
v_xor_b32 v3, v3, v13
v_lshlrev_b32 v3, 4, v3
v_mul_u32_u24 v12, 2048, v12
v_add_u32 v3, v3, v12
s_lshl_b32 s43, s47, 15
v_add_u32 v3, s43, v3
s_lshl_b32 s40, s47, 11
s_add_u32 s37, s35, 0
s_and_b32 s37, s37, 15
s_lshl_b32 s37, s37, 14
s_add_u32 m0, s39, 0
s_nop 0
buffer_load_dwordx4 v2, s[8:11], s37 offen offset:0 sc1 lds
buffer_load_dwordx4 v2, s[8:11], s37 offen offset:1024 sc1 lds
buffer_load_dwordx4 v2, s[8:11], s37 offen offset:2048 sc1 lds
buffer_load_dwordx4 v2, s[8:11], s37 offen offset:3072 sc1 lds
s_add_u32 s38, s35, 8
s_and_b32 s38, s38, 15
s_lshl_b32 s38, s38, 17
s_add_u32 m0, s40, 16384
s_nop 0
buffer_load_dwordx4 v3, s[12:15], s38 offen lds
s_add_u32 m0, s40, 17408
s_add_u32 s38, s38, 16384
buffer_load_dwordx4 v3, s[12:15], s38 offen lds
s_add_u32 s38, s35, 9
s_and_b32 s38, s38, 15
s_lshl_b32 s38, s38, 17
s_add_u32 m0, s40, 24576
s_nop 0
buffer_load_dwordx4 v3, s[12:15], s38 offen lds
s_add_u32 m0, s40, 25600
s_add_u32 s38, s38, 16384
buffer_load_dwordx4 v3, s[12:15], s38 offen lds
s_add_u32 s38, s35, 10
s_and_b32 s38, s38, 15
s_lshl_b32 s38, s38, 17
s_add_u32 m0, s40, 32768
s_nop 0
buffer_load_dwordx4 v3, s[12:15], s38 offen lds
s_add_u32 m0, s40, 33792
s_add_u32 s38, s38, 16384
buffer_load_dwordx4 v3, s[12:15], s38 offen lds
s_add_u32 s38, s35, 11
s_and_b32 s38, s38, 15
s_lshl_b32 s38, s38, 17
s_add_u32 m0, s40, 40960
s_nop 0
buffer_load_dwordx4 v3, s[12:15], s38 offen lds
s_add_u32 m0, s40, 41984
s_add_u32 s38, s38, 16384
buffer_load_dwordx4 v3, s[12:15], s38 offen lds
s_bitcmp0_b32 s36, 1
s_cselect_b32 s44, s72, s74
s_cselect_b32 s45, s73, s75
s_mul_i32 s43, s35, 192
s_add_u32 s88, s44, s43
s_addc_u32 s89, s45, 0
s_add_u32 s88, s88, 4096
s_addc_u32 s89, s89, 0
s_mov_b32 s90, 7333056
s_mov_b32 s91, 0x20000
v_add_u32 v11, 0, v1
v_mul_u32_u24 v12, 5462, v11
v_lshrrev_b32 v12, 16, v12
v_mul_u32_u24 v13, 12, v12
v_sub_u32 v13, v11, v13
v_bfe_u32 v14, v12, 2, 1
v_cmp_gt_u32 vcc, 8, v13
v_lshlrev_b32 v15, 1, v14
v_mul_u32_u24 v12, 7168, v12
v_cndmask_b32 v14, v14, v15, vcc
v_xor_b32 v13, v13, v14
v_lshl_add_u32 v8, v13, 4, v12
v_add_u32 v11, 64, v1
v_mul_u32_u24 v12, 5462, v11
v_lshrrev_b32 v12, 16, v12
v_mul_u32_u24 v13, 12, v12
v_sub_u32 v13, v11, v13
v_bfe_u32 v14, v12, 2, 1
v_cmp_gt_u32 vcc, 8, v13
v_lshlrev_b32 v15, 1, v14
v_mul_u32_u24 v12, 7168, v12
v_cndmask_b32 v14, v14, v15, vcc
v_xor_b32 v13, v13, v14
v_lshl_add_u32 v9, v13, 4, v12
v_add_u32 v11, 128, v1
v_mul_u32_u24 v12, 5462, v11
v_lshrrev_b32 v12, 16, v12
v_mul_u32_u24 v13, 12, v12
v_sub_u32 v13, v11, v13
v_bfe_u32 v14, v12, 2, 1
v_cmp_gt_u32 vcc, 8, v13
v_lshlrev_b32 v15, 1, v14
v_mul_u32_u24 v12, 7168, v12
v_cndmask_b32 v14, v14, v15, vcc
v_xor_b32 v13, v13, v14
v_lshl_add_u32 v10, v13, 4, v12
s_and_b32 s43, s36, 1
s_mul_i32 s43, s43, 229376
v_add_u32 v8, s43, v8
v_add_u32 v9, s43, v9
v_add_u32 v10, s43, v10
s_and_b32 s43, s36, 3
s_mul_i32 s46, s43, 6144
s_add_u32 s46, s46, 16384
s_cmp_eq_u32 s47, 3
s_cbranch_scc0 Lw_85
s_lshl_b32 s92, s34, 7
s_add_u32 s92, s92, 28311552
s_mov_b32 s41, 0x40000
Lpoll_86:
s_load_dword s93, s[82:83], s92 glc
Lpchk_88:
s_waitcnt lgkmcnt(0)
s_cmp_eq_u32 s93, 16
s_cbranch_scc1 Lpok_87
s_sub_u32 s41, s41, 1
s_cmp_lg_u32 s41, 0
s_cbranch_scc1 Lpoll_86
Lpok_87:
Lw_85:
s_and_b32 s44, s36, 3
s_mul_i32 s44, s44, 14
s_bfe_u32 s43, s2, 0x30001
s_lshl_b32 s43, s43, 7
s_add_u32 s44, s44, s43
s_add_u32 s44, s44, 72
s_mul_i32 s44, s44, 7168
s_lshr_b32 s43, s2, 4
s_lshl_b32 s43, s43, 8
s_add_u32 s43, s43, s44
s_bitcmp0_b32 s2, 0
s_cselect_b32 s4, s72, s74
s_cselect_b32 s5, s73, s75
s_add_u32 s4, s4, s43
s_addc_u32 s5, s5, 0
s_cmp_eq_u32 s47, 3
s_cbranch_scc1 Lw_89
s_load_dword s3, s[4:5], 0
s_load_dword s3, s[4:5], 64
s_load_dword s3, s[4:5], 128
s_load_dword s3, s[4:5], 192
s_load_dword s3, s[4:5], 7168
s_load_dword s3, s[4:5], 7232
s_load_dword s3, s[4:5], 7296
s_load_dword s3, s[4:5], 7360
s_load_dword s3, s[4:5], 14336
s_load_dword s3, s[4:5], 14400
s_load_dword s3, s[4:5], 14464
s_load_dword s3, s[4:5], 14528
s_load_dword s3, s[4:5], 21504
s_load_dword s3, s[4:5], 21568
Lw_89:
s_waitcnt vmcnt(8)
s_barrier
s_add_u32 s37, s35, 1
s_and_b32 s37, s37, 15
s_lshl_b32 s37, s37, 14
s_add_u32 m0, s39, 49152
s_nop 0
buffer_load_dwordx4 v2, s[8:11], s37 offen offset:0 sc1 lds
buffer_load_dwordx4 v2, s[8:11], s37 offen offset:1024 sc1 lds
buffer_load_dwordx4 v2, s[8:11], s37 offen offset:2048 sc1 lds
buffer_load_dwordx4 v2, s[8:11], s37 offen offset:3072 sc1 lds
s_add_u32 s37, s35, 2
s_and_b32 s37, s37, 15
s_lshl_b32 s37, s37, 14
s_add_u32 m0, s39, 98304
s_nop 0
buffer_load_dwordx4 v2, s[8:11], s37 offen offset:0 sc1 lds
buffer_load_dwordx4 v2, s[8:11], s37 offen offset:1024 sc1 lds
buffer_load_dwordx4 v2, s[8:11], s37 offen offset:2048 sc1 lds
buffer_load_dwordx4 v2, s[8:11], s37 offen offset:3072 sc1 lds
s_add_u32 s37, s35, 3
s_and_b32 s37, s37, 15
s_lshl_b32 s37, s37, 14
s_add_u32 m0, s39, 147456
s_nop 0
buffer_load_dwordx4 v2, s[8:11], s37 offen offset:0 sc1 lds
buffer_load_dwordx4 v2, s[8:11], s37 offen offset:1024 sc1 lds
buffer_load_dwordx4 v2, s[8:11], s37 offen offset:2048 sc1 lds
buffer_load_dwordx4 v2, s[8:11], s37 offen offset:3072 sc1 lds
s_cmp_eq_u32 s47, 3
s_cbranch_scc0 Lw_90
s_load_dword s3, s[4:5], 0
s_load_dword s3, s[4:5], 64
s_load_dword s3, s[4:5], 128
s_load_dword s3, s[4:5], 192
s_load_dword s3, s[4:5], 7168
s_load_dword s3, s[4:5], 7232
s_load_dword s3, s[4:5], 7296
s_load_dword s3, s[4:5], 7360
s_load_dword s3, s[4:5], 14336
s_load_dword s3, s[4:5], 14400
s_load_dword s3, s[4:5], 14464
s_load_dword s3, s[4:5], 14528
s_load_dword s3, s[4:5], 21504
s_load_dword s3, s[4:5], 21568
Lw_90:
s_waitcnt vmcnt(8)
s_barrier
s_add_u32 s37, s35, 4
s_and_b32 s37, s37, 15
s_lshl_b32 s37, s37, 14
s_add_u32 m0, s39, 0
s_nop 0
buffer_load_dwordx4 v2, s[8:11], s37 offen offset:0 sc1 lds
buffer_load_dwordx4 v2, s[8:11], s37 offen offset:1024 sc1 lds
buffer_load_dwordx4 v2, s[8:11], s37 offen offset:2048 sc1 lds
buffer_load_dwordx4 v2, s[8:11], s37 offen offset:3072 sc1 lds
v_lshlrev_b32 v240, 16, v128
v_and_b32 v241, 0xffff0000, v128
v_lshlrev_b32 v242, 16, v129
v_and_b32 v243, 0xffff0000, v129
v_lshlrev_b32 v244, 16, v130
v_and_b32 v245, 0xffff0000, v130
v_lshlrev_b32 v246, 16, v131
v_and_b32 v247, 0xffff0000, v131
s_load_dword s3, s[4:5], 21632
s_load_dword s3, s[4:5], 21696
s_load_dword s3, s[4:5], 28672
s_waitcnt vmcnt(8)
s_barrier
s_add_u32 s37, s35, 5
s_and_b32 s37, s37, 15
s_lshl_b32 s37, s37, 14
s_add_u32 m0, s39, 49152
s_nop 0
buffer_load_dwordx4 v2, s[8:11], s37 offen offset:0 sc1 lds
buffer_load_dwordx4 v2, s[8:11], s37 offen offset:1024 sc1 lds
buffer_load_dwordx4 v2, s[8:11], s37 offen offset:2048 sc1 lds
buffer_load_dwordx4 v2, s[8:11], s37 offen offset:3072 sc1 lds
v_lshlrev_b32 v24, 16, v132
v_and_b32 v25, 0xffff0000, v132
v_lshlrev_b32 v26, 16, v133
v_and_b32 v27, 0xffff0000, v133
v_lshlrev_b32 v28, 16, v134
v_and_b32 v29, 0xffff0000, v134
v_lshlrev_b32 v30, 16, v135
v_and_b32 v31, 0xffff0000, v135
v_add_f32 v240, v240, v24
v_add_f32 v241, v241, v25
v_add_f32 v242, v242, v26
v_add_f32 v243, v243, v27
v_add_f32 v244, v244, v28
v_add_f32 v245, v245, v29
v_add_f32 v246, v246, v30
v_add_f32 v247, v247, v31
s_load_dword s3, s[4:5], 28736
s_load_dword s3, s[4:5], 28800
s_load_dword s3, s[4:5], 28864
s_waitcnt vmcnt(8)
s_barrier
s_add_u32 s37, s35, 6
s_and_b32 s37, s37, 15
s_lshl_b32 s37, s37, 14
s_add_u32 m0, s39, 98304
s_nop 0
buffer_load_dwordx4 v2, s[8:11], s37 offen offset:0 sc1 lds
buffer_load_dwordx4 v2, s[8:11], s37 offen offset:1024 sc1 lds
buffer_load_dwordx4 v2, s[8:11], s37 offen offset:2048 sc1 lds
buffer_load_dwordx4 v2, s[8:11], s37 offen offset:3072 sc1 lds
v_lshlrev_b32 v24, 16, v136
v_and_b32 v25, 0xffff0000, v136
v_lshlrev_b32 v26, 16, v137
v_and_b32 v27, 0xffff0000, v137
v_lshlrev_b32 v28, 16, v138
v_and_b32 v29, 0xffff0000, v138
v_lshlrev_b32 v30, 16, v139
v_and_b32 v31, 0xffff0000, v139
v_add_f32 v240, v240, v24
v_add_f32 v241, v241, v25
v_add_f32 v242, v242, v26
v_add_f32 v243, v243, v27
v_add_f32 v244, v244, v28
v_add_f32 v245, v245, v29
v_add_f32 v246, v246, v30
v_add_f32 v247, v247, v31
s_load_dword s3, s[4:5], 35840
s_load_dword s3, s[4:5], 35904
s_load_dword s3, s[4:5], 35968
s_waitcnt vmcnt(8)
s_barrier
s_add_u32 s37, s35, 7
s_and_b32 s37, s37, 15
s_lshl_b32 s37, s37, 14
s_add_u32 m0, s39, 147456
s_nop 0
buffer_load_dwordx4 v2, s[8:11], s37 offen offset:0 sc1 lds
buffer_load_dwordx4 v2, s[8:11], s37 offen offset:1024 sc1 lds
buffer_load_dwordx4 v2, s[8:11], s37 offen offset:2048 sc1 lds
buffer_load_dwordx4 v2, s[8:11], s37 offen offset:3072 sc1 lds
v_lshlrev_b32 v24, 16, v140
v_and_b32 v25, 0xffff0000, v140
v_lshlrev_b32 v26, 16, v141
v_and_b32 v27, 0xffff0000, v141
v_lshlrev_b32 v28, 16, v142
v_and_b32 v29, 0xffff0000, v142
v_lshlrev_b32 v30, 16, v143
v_and_b32 v31, 0xffff0000, v143
v_add_f32 v240, v240, v24
v_add_f32 v241, v241, v25
v_add_f32 v242, v242, v26
v_add_f32 v243, v243, v27
v_add_f32 v244, v244, v28
v_add_f32 v245, v245, v29
v_add_f32 v246, v246, v30
v_add_f32 v247, v247, v31
s_load_dword s3, s[4:5], 36032
s_load_dword s3, s[4:5], 43008
s_load_dword s3, s[4:5], 43072
s_waitcnt vmcnt(8)
s_barrier
s_add_u32 s37, s35, 8
s_and_b32 s37, s37, 15
s_lshl_b32 s37, s37, 14
s_add_u32 m0, s39, 0
s_nop 0
buffer_load_dwordx4 v2, s[8:11], s37 offen offset:0 sc1 lds
buffer_load_dwordx4 v2, s[8:11], s37 offen offset:1024 sc1 lds
buffer_load_dwordx4 v2, s[8:11], s37 offen offset:2048 sc1 lds
buffer_load_dwordx4 v2, s[8:11], s37 offen offset:3072 sc1 lds
s_add_u32 s38, s35, 12
s_and_b32 s38, s38, 15
s_lshl_b32 s38, s38, 17
s_add_u32 m0, s40, 114688
s_nop 0
buffer_load_dwordx4 v3, s[12:15], s38 offen lds
s_add_u32 m0, s40, 115712
s_add_u32 s38, s38, 16384
buffer_load_dwordx4 v3, s[12:15], s38 offen lds
v_lshlrev_b32 v24, 16, v144
v_and_b32 v25, 0xffff0000, v144
v_lshlrev_b32 v26, 16, v145
v_and_b32 v27, 0xffff0000, v145
v_lshlrev_b32 v28, 16, v146
v_and_b32 v29, 0xffff0000, v146
v_lshlrev_b32 v30, 16, v147
v_and_b32 v31, 0xffff0000, v147
v_add_f32 v240, v240, v24
v_add_f32 v241, v241, v25
v_add_f32 v242, v242, v26
v_add_f32 v243, v243, v27
v_add_f32 v244, v244, v28
v_add_f32 v245, v245, v29
v_add_f32 v246, v246, v30
v_add_f32 v247, v247, v31
s_load_dword s3, s[4:5], 43136
s_load_dword s3, s[4:5], 43200
s_load_dword s3, s[4:5], 50176
s_waitcnt vmcnt(10)
s_barrier
s_add_u32 s37, s35, 9
s_and_b32 s37, s37, 15
s_lshl_b32 s37, s37, 14
s_add_u32 m0, s39, 49152
s_nop 0
buffer_load_dwordx4 v2, s[8:11], s37 offen offset:0 sc1 lds
buffer_load_dwordx4 v2, s[8:11], s37 offen offset:1024 sc1 lds
buffer_load_dwordx4 v2, s[8:11], s37 offen offset:2048 sc1 lds
buffer_load_dwordx4 v2, s[8:11], s37 offen offset:3072 sc1 lds
s_add_u32 s38, s35, 13
s_and_b32 s38, s38, 15
s_lshl_b32 s38, s38, 17
s_add_u32 m0, s40, 122880
s_nop 0
buffer_load_dwordx4 v3, s[12:15], s38 offen lds
s_add_u32 m0, s40, 123904
s_add_u32 s38, s38, 16384
buffer_load_dwordx4 v3, s[12:15], s38 offen lds
v_lshlrev_b32 v24, 16, v148
v_and_b32 v25, 0xffff0000, v148
v_lshlrev_b32 v26, 16, v149
v_and_b32 v27, 0xffff0000, v149
v_lshlrev_b32 v28, 16, v150
v_and_b32 v29, 0xffff0000, v150
v_lshlrev_b32 v30, 16, v151
v_and_b32 v31, 0xffff0000, v151
v_add_f32 v240, v240, v24
v_add_f32 v241, v241, v25
v_add_f32 v242, v242, v26
v_add_f32 v243, v243, v27
v_add_f32 v244, v244, v28
v_add_f32 v245, v245, v29
v_add_f32 v246, v246, v30
v_add_f32 v247, v247, v31
s_load_dword s3, s[4:5], 50240
s_load_dword s3, s[4:5], 50304
s_load_dword s3, s[4:5], 50368
s_waitcnt vmcnt(12)
s_barrier
s_add_u32 s37, s35, 10
s_and_b32 s37, s37, 15
s_lshl_b32 s37, s37, 14
s_add_u32 m0, s39, 98304
s_nop 0
buffer_load_dwordx4 v2, s[8:11], s37 offen offset:0 sc1 lds
buffer_load_dwordx4 v2, s[8:11], s37 offen offset:1024 sc1 lds
buffer_load_dwordx4 v2, s[8:11], s37 offen offset:2048 sc1 lds
buffer_load_dwordx4 v2, s[8:11], s37 offen offset:3072 sc1 lds
s_add_u32 s38, s35, 14
s_and_b32 s38, s38, 15
s_lshl_b32 s38, s38, 17
s_add_u32 m0, s40, 131072
s_nop 0
buffer_load_dwordx4 v3, s[12:15], s38 offen lds
s_add_u32 m0, s40, 132096
s_add_u32 s38, s38, 16384
buffer_load_dwordx4 v3, s[12:15], s38 offen lds
v_lshlrev_b32 v24, 16, v152
v_and_b32 v25, 0xffff0000, v152
v_lshlrev_b32 v26, 16, v153
v_and_b32 v27, 0xffff0000, v153
v_lshlrev_b32 v28, 16, v154
v_and_b32 v29, 0xffff0000, v154
v_lshlrev_b32 v30, 16, v155
v_and_b32 v31, 0xffff0000, v155
v_add_f32 v240, v240, v24
v_add_f32 v241, v241, v25
v_add_f32 v242, v242, v26
v_add_f32 v243, v243, v27
v_add_f32 v244, v244, v28
v_add_f32 v245, v245, v29
v_add_f32 v246, v246, v30
v_add_f32 v247, v247, v31
s_load_dword s3, s[4:5], 57344
s_load_dword s3, s[4:5], 57408
s_load_dword s3, s[4:5], 57472
s_waitcnt vmcnt(14)
s_barrier
s_add_u32 s37, s35, 11
s_and_b32 s37, s37, 15
s_lshl_b32 s37, s37, 14
s_add_u32 m0, s39, 147456
s_nop 0
buffer_load_dwordx4 v2, s[8:11], s37 offen offset:0 sc1 lds
buffer_load_dwordx4 v2, s[8:11], s37 offen offset:1024 sc1 lds
buffer_load_dwordx4 v2, s[8:11], s37 offen offset:2048 sc1 lds
buffer_load_dwordx4 v2, s[8:11], s37 offen offset:3072 sc1 lds
s_add_u32 s38, s35, 15
s_and_b32 s38, s38, 15
s_lshl_b32 s38, s38, 17
s_add_u32 m0, s40, 139264
s_nop 0
buffer_load_dwordx4 v3, s[12:15], s38 offen lds
s_add_u32 m0, s40, 140288
s_add_u32 s38, s38, 16384
buffer_load_dwordx4 v3, s[12:15], s38 offen lds
v_lshlrev_b32 v24, 16, v156
v_and_b32 v25, 0xffff0000, v156
v_lshlrev_b32 v26, 16, v157
v_and_b32 v27, 0xffff0000, v157
v_lshlrev_b32 v28, 16, v158
v_and_b32 v29, 0xffff0000, v158
v_lshlrev_b32 v30, 16, v159
v_and_b32 v31, 0xffff0000, v159
v_add_f32 v240, v240, v24
v_add_f32 v241, v241, v25
v_add_f32 v242, v242, v26
v_add_f32 v243, v243, v27
v_add_f32 v244, v244, v28
v_add_f32 v245, v245, v29
v_add_f32 v246, v246, v30
v_add_f32 v247, v247, v31
s_load_dword s3, s[4:5], 57536
s_load_dword s3, s[4:5], 64512
s_load_dword s3, s[4:5], 64576
s_waitcnt vmcnt(14)
s_barrier
s_add_u32 s37, s35, 12
s_and_b32 s37, s37, 15
s_lshl_b32 s37, s37, 14
s_add_u32 m0, s39, 0
s_nop 0
buffer_load_dwordx4 v2, s[8:11], s37 offen offset:0 sc1 lds
buffer_load_dwordx4 v2, s[8:11], s37 offen offset:1024 sc1 lds
buffer_load_dwordx4 v2, s[8:11], s37 offen offset:2048 sc1 lds
buffer_load_dwordx4 v2, s[8:11], s37 offen offset:3072 sc1 lds
s_load_dword s3, s[4:5], 64640
s_load_dword s3, s[4:5], 64704
s_load_dword s3, s[4:5], 71680
s_waitcnt vmcnt(12)
s_barrier
s_add_u32 s37, s35, 13
s_and_b32 s37, s37, 15
s_lshl_b32 s37, s37, 14
s_add_u32 m0, s39, 49152
s_nop 0
buffer_load_dwordx4 v2, s[8:11], s37 offen offset:0 sc1 lds
s_branch Lov_7
.p2align 12
Lst_7_0:
s_branch Lwr_147
s_nop 0
s_nop 0
Lov_7:
buffer_load_dwordx4 v2, s[8:11], s37 offen offset:1024 sc1 lds
buffer_load_dwordx4 v2, s[8:11], s37 offen offset:2048 sc1 lds
buffer_load_dwordx4 v2, s[8:11], s37 offen offset:3072 sc1 lds
s_load_dword s3, s[4:5], 71744
s_load_dword s3, s[4:5], 71808
s_load_dword s3, s[4:5], 71872
s_waitcnt vmcnt(10)
s_barrier
s_add_u32 s37, s35, 14
s_and_b32 s37, s37, 15
s_lshl_b32 s37, s37, 14
s_add_u32 m0, s39, 98304
s_nop 0
buffer_load_dwordx4 v2, s[8:11], s37 offen offset:0 sc1 lds
buffer_load_dwordx4 v2, s[8:11], s37 offen offset:1024 sc1 lds
buffer_load_dwordx4 v2, s[8:11], s37 offen offset:2048 sc1 lds
buffer_load_dwordx4 v2, s[8:11], s37 offen offset:3072 sc1 lds
s_waitcnt vmcnt(8)
s_barrier
s_add_u32 s37, s35, 15
s_and_b32 s37, s37, 15
s_lshl_b32 s37, s37, 14
s_add_u32 m0, s39, 147456
s_nop 0
buffer_load_dwordx4 v2, s[8:11], s37 offen offset:0 sc1 lds
buffer_load_dwordx4 v2, s[8:11], s37 offen offset:1024 sc1 lds
buffer_load_dwordx4 v2, s[8:11], s37 offen offset:2048 sc1 lds
buffer_load_dwordx4 v2, s[8:11], s37 offen offset:3072 sc1 lds
s_waitcnt vmcnt(8)
s_barrier
s_nop 0
v_permlane32_swap_b32 v240, v244
v_permlane32_swap_b32 v241, v245
v_permlane32_swap_b32 v242, v246
v_permlane32_swap_b32 v243, v247
v_add_f32 v240, v240, v244
v_add_f32 v241, v241, v245
v_add_f32 v242, v242, v246
v_add_f32 v243, v243, v247
s_nop 0
v_permlane16_swap_b32 v240, v242
v_permlane16_swap_b32 v241, v243
v_add_f32 v240, v240, v242
v_add_f32 v241, v241, v243
s_waitcnt vmcnt(4)
s_barrier
s_add_u32 s38, s35, 0
s_and_b32 s38, s38, 15
s_mul_i32 s38, s38, 458752
s_add_u32 m0, s46, 0
s_nop 0
buffer_load_dwordx4 v8, s[88:91], s38 offen lds
s_add_u32 m0, s46, 1024
s_nop 0
buffer_load_dwordx4 v9, s[88:91], s38 offen lds
s_add_u32 m0, s46, 2048
s_nop 0
buffer_load_dwordx4 v10, s[88:91], s38 offen lds
s_add_u32 m0, s46, 3072
s_add_u32 s38, s38, 114688
buffer_load_dwordx4 v8, s[88:91], s38 offen lds
s_add_u32 m0, s46, 4096
s_nop 0
buffer_load_dwordx4 v9, s[88:91], s38 offen lds
s_add_u32 m0, s46, 5120
s_nop 0
buffer_load_dwordx4 v10, s[88:91], s38 offen lds
s_add_u32 s38, s35, 1
s_and_b32 s38, s38, 15
s_mul_i32 s38, s38, 458752
s_add_u32 m0, s46, 49152
s_nop 0
buffer_load_dwordx4 v8, s[88:91], s38 offen lds
s_add_u32 m0, s46, 50176
s_nop 0
buffer_load_dwordx4 v9, s[88:91], s38 offen lds
s_add_u32 m0, s46, 51200
s_nop 0
buffer_load_dwordx4 v10, s[88:91], s38 offen lds
s_add_u32 m0, s46, 52224
s_add_u32 s38, s38, 114688
buffer_load_dwordx4 v8, s[88:91], s38 offen lds
s_add_u32 m0, s46, 53248
s_nop 0
buffer_load_dwordx4 v9, s[88:91], s38 offen lds
s_add_u32 m0, s46, 54272
s_nop 0
buffer_load_dwordx4 v10, s[88:91], s38 offen lds
s_waitcnt vmcnt(12)
s_barrier
s_barrier
s_branch Lk3a
Lk2end_77:
Lk3:
s_branch Lgb_91
Lk3a:
s_mul_i32 s43, s34, 262144
s_add_u32 s8, s82, s43
s_addc_u32 s9, s83, 0
s_add_u32 s8, s8, 4194304
s_addc_u32 s9, s9, 0
s_mov_b32 s10, 262144
s_mov_b32 s11, 0x20000
s_mul_i32 s43, s34, 917504
s_add_u32 s24, s82, s43
s_addc_u32 s25, s83, 0
s_add_u32 s24, s24, 8388608
s_addc_u32 s25, s25, 0
s_mov_b32 s26, 917504
s_mov_b32 s27, 0x20000
s_add_u32 s84, s82, 27262976
s_addc_u32 s85, s83, 0
s_mov_b32 s86, 229376
s_mov_b32 s87, 0x20000
s_and_b32 s47, s36, 3
s_lshr_b32 s62, s47, 1
s_and_b32 s63, s47, 1
v_lshlrev_b32 v2, 4, v1
s_lshl_b32 s39, s47, 12
v_add_u32 v3, s39, v2
s_cmp_eq_u32 s62, 0
s_cselect_b32 s44, s72, s74
s_cselect_b32 s45, s73, s75
s_lshl_b32 s43, s35, 8
s_add_u32 s12, s44, s43
s_addc_u32 s13, s45, 0
s_mov_b32 s14, 7333120
s_mov_b32 s15, 0x20000
v_lshrrev_b32 v28, 4, v1
v_lshlrev_b32 v29, 1, v28
v_and_b32 v4, 15, v1
v_xor_b32 v4, v4, v29
v_lshlrev_b32 v4, 4, v4
v_mul_u32_u24 v28, 7168, v28
v_add_u32 v4, v4, v28
s_mul_i32 s43, s63, 229376
v_add_u32 v4, s43, v4
v_xor_b32 v5, 128, v4
v_add_u32 v5, 28672, v5
s_lshl_b32 s40, s47, 13
s_add_u32 s40, s40, 16384
s_lshl_b32 s43, s62, 12
v_add_u32 v9, s43, v2
v_add_u32 v10, 98304, v9
s_lshl_b32 s43, s47, 9
s_add_u32 s43, s43, 151552
v_and_b32 v28, 15, v1
v_lshl_add_u32 v28, v28, 5, s43
v_lshrrev_b32 v29, 4, v1
v_lshl_add_u32 v28, v29, 3, v28
ds_write_b64 v28, v[240:241]
s_waitcnt lgkmcnt(0)
v_lshrrev_b32 v27, 2, v1
v_bfe_u32 v28, v27, 2, 1
v_mul_u32_u24 v27, 192, v27
v_add_u32 v27, 16384, v27
v_and_b32 v29, 3, v1
v_lshl_add_u32 v12, v29, 3, v27
s_lshl_b32 s43, s63, 6
v_add_u32 v12, s43, v12
v_lshl_add_u32 v11, v28, 5, v12
v_xor_b32 v30, 1, v28
v_lshl_add_u32 v12, v30, 5, v12
v_xor_b32 v28, s63, v28
v_lshl_add_u32 v27, v28, 4, v27
v_lshrrev_b32 v28, 1, v29
v_lshl_add_u32 v27, v28, 5, v27
v_and_b32 v28, 1, v29
v_lshl_add_u32 v27, v28, 3, v27
v_add_u32 v13, 128, v27
v_add_u32 v14, 49152, v11
v_add_u32 v15, 49152, v12
v_add_u32 v16, 49152, v13
v_add_u32 v17, 98304, v11
v_add_u32 v18, 98304, v12
v_add_u32 v19, 98304, v13
v_bfe_u32 v28, v1, 3, 1
v_lshlrev_b32 v28, 6, v28
v_bfe_u32 v29, v1, 1, 2
s_lshl_b32 s43, s48, 3
s_lshl_b32 s44, s63, 2
s_add_u32 s43, s43, s44
v_add3_u32 v28, v28, v29, s43
v_mul_u32_u24 v28, 7168, v28
v_and_b32 v29, 1, v1
v_mul_u32_u24 v29, 188, v29
v_add_u32 v20, v28, v29
s_cmp_lg_u32 s36, 4
s_cbranch_scc1 Lwm_93
s_branch Lst_8_1
Lwr_159:
s_branch Lwe_92
Lwm_93:
s_cmp_lg_u32 s36, 5
s_cbranch_scc1 Lwm_94
s_branch Lst_9_1
Lwr_160:
s_branch Lwe_92
Lwm_94:
s_cmp_lg_u32 s36, 6
s_cbranch_scc1 Lwm_95
s_branch Lst_10_1
Lwr_161:
s_branch Lwe_92
Lwm_95:
s_cmp_lg_u32 s36, 7
s_cbranch_scc1 Lwm_96
s_nop 0
s_branch Lwe_92
Lwm_96:
Lwe_92:
s_barrier
s_cmp_lg_u32 s36, 4
s_cbranch_scc1 Lwm_98
s_branch Lst_11_1
Lwr_163:
s_branch Lwe_97
Lwm_98:
s_cmp_lg_u32 s36, 5
s_cbranch_scc1 Lwm_99
s_branch Lst_12_1
Lwr_164:
s_branch Lwe_97
Lwm_99:
s_cmp_lg_u32 s36, 6
s_cbranch_scc1 Lwm_100
s_branch Lst_13_1
Lwr_165:
s_branch Lwe_97
Lwm_100:
s_cmp_lg_u32 s36, 7
s_cbranch_scc1 Lwm_101
s_branch Lst_14_1
Lwr_166:
s_branch Lwe_97
Lwm_101:
Lwe_97:
s_waitcnt vmcnt(0) lgkmcnt(0)
s_barrier
ds_read_b128 v[32:35], v9 offset:0
ds_read_b64_tr_b16 v[48:49], v11 offset:0
ds_read_b64_tr_b16 v[50:51], v11 offset:3072
ds_read_b64_tr_b16 v[52:53], v12 offset:0
ds_read_b64_tr_b16 v[54:55], v12 offset:3072
ds_read_b64_tr_b16 v[56:57], v13 offset:0
ds_read_b64_tr_b16 v[58:59], v13 offset:3072
ds_read_b64_tr_b16 v[60:61], v11 offset:12288
ds_read_b64_tr_b16 v[62:63], v11 offset:15360
ds_read_b64_tr_b16 v[64:65], v12 offset:12288
ds_read_b64_tr_b16 v[66:67], v12 offset:15360
ds_read_b64_tr_b16 v[68:69], v13 offset:12288
ds_read_b64_tr_b16 v[70:71], v13 offset:15360
ds_read_b128 v[36:39], v9 offset:1024
ds_read_b128 v[40:43], v9 offset:2048
ds_read_b128 v[44:47], v9 offset:3072
s_waitcnt lgkmcnt(0)
v_mfma_f32_16x16x32_bf16 v[128:131], v[48:51], v[32:35], 0
ds_read_b128 v[72:75], v9 offset:8192
v_mfma_f32_16x16x32_bf16 v[132:135], v[52:55], v[32:35], 0
ds_read_b64_tr_b16 v[88:89], v11 offset:6144
v_mfma_f32_16x16x32_bf16 v[136:139], v[56:59], v[32:35], 0
ds_read_b64_tr_b16 v[90:91], v11 offset:9216
v_mfma_f32_16x16x32_bf16 v[140:143], v[60:63], v[32:35], 0
ds_read_b64_tr_b16 v[92:93], v12 offset:6144
v_mfma_f32_16x16x32_bf16 v[144:147], v[64:67], v[32:35], 0
ds_read_b64_tr_b16 v[94:95], v12 offset:9216
v_mfma_f32_16x16x32_bf16 v[148:151], v[68:71], v[32:35], 0
ds_read_b64_tr_b16 v[96:97], v13 offset:6144
v_mfma_f32_16x16x32_bf16 v[172:175], v[68:71], v[36:39], 0
ds_read_b64_tr_b16 v[98:99], v13 offset:9216
v_mfma_f32_16x16x32_bf16 v[168:171], v[64:67], v[36:39], 0
ds_read_b64_tr_b16 v[100:101], v11 offset:18432
v_mfma_f32_16x16x32_bf16 v[164:167], v[60:63], v[36:39], 0
ds_read_b64_tr_b16 v[102:103], v11 offset:21504
v_mfma_f32_16x16x32_bf16 v[160:163], v[56:59], v[36:39], 0
ds_read_b64_tr_b16 v[104:105], v12 offset:18432
v_mfma_f32_16x16x32_bf16 v[156:159], v[52:55], v[36:39], 0
ds_read_b64_tr_b16 v[106:107], v12 offset:21504
v_mfma_f32_16x16x32_bf16 v[152:155], v[48:51], v[36:39], 0
ds_read_b64_tr_b16 v[108:109], v13 offset:18432
v_mfma_f32_16x16x32_bf16 v[176:179], v[48:51], v[40:43], 0
ds_read_b64_tr_b16 v[110:111], v13 offset:21504
v_mfma_f32_16x16x32_bf16 v[180:183], v[52:55], v[40:43], 0
ds_read_b128 v[76:79], v9 offset:9216
v_mfma_f32_16x16x32_bf16 v[184:187], v[56:59], v[40:43], 0
ds_read_b128 v[80:83], v9 offset:10240
v_mfma_f32_16x16x32_bf16 v[188:191], v[60:63], v[40:43], 0
ds_read_b128 v[84:87], v9 offset:11264
v_mfma_f32_16x16x32_bf16 v[192:195], v[64:67], v[40:43], 0
v_mfma_f32_16x16x32_bf16 v[196:199], v[68:71], v[40:43], 0
v_mfma_f32_16x16x32_bf16 v[220:223], v[68:71], v[44:47], 0
v_mfma_f32_16x16x32_bf16 v[216:219], v[64:67], v[44:47], 0
v_mfma_f32_16x16x32_bf16 v[212:215], v[60:63], v[44:47], 0
v_mfma_f32_16x16x32_bf16 v[208:211], v[56:59], v[44:47], 0
v_mfma_f32_16x16x32_bf16 v[204:207], v[52:55], v[44:47], 0
v_mfma_f32_16x16x32_bf16 v[200:203], v[48:51], v[44:47], 0
s_waitcnt lgkmcnt(0)
s_barrier
v_mfma_f32_16x16x32_bf16 v[128:131], v[88:91], v[72:75], v[128:131]
ds_read_b128 v[32:35], v9 offset:49152
v_mfma_f32_16x16x32_bf16 v[132:135], v[92:95], v[72:75], v[132:135]
ds_read_b64_tr_b16 v[48:49], v14 offset:0
v_mfma_f32_16x16x32_bf16 v[136:139], v[96:99], v[72:75], v[136:139]
ds_read_b64_tr_b16 v[50:51], v14 offset:3072
v_mfma_f32_16x16x32_bf16 v[140:143], v[100:103], v[72:75], v[140:143]
ds_read_b64_tr_b16 v[52:53], v15 offset:0
v_mfma_f32_16x16x32_bf16 v[144:147], v[104:107], v[72:75], v[144:147]
ds_read_b64_tr_b16 v[54:55], v15 offset:3072
v_mfma_f32_16x16x32_bf16 v[148:151], v[108:111], v[72:75], v[148:151]
ds_read_b64_tr_b16 v[56:57], v16 offset:0
v_mfma_f32_16x16x32_bf16 v[172:175], v[108:111], v[76:79], v[172:175]
ds_read_b64_tr_b16 v[58:59], v16 offset:3072
v_mfma_f32_16x16x32_bf16 v[168:171], v[104:107], v[76:79], v[168:171]
ds_read_b64_tr_b16 v[60:61], v14 offset:12288
v_mfma_f32_16x16x32_bf16 v[164:167], v[100:103], v[76:79], v[164:167]
ds_read_b64_tr_b16 v[62:63], v14 offset:15360
v_mfma_f32_16x16x32_bf16 v[160:163], v[96:99], v[76:79], v[160:163]
ds_read_b64_tr_b16 v[64:65], v15 offset:12288
v_mfma_f32_16x16x32_bf16 v[156:159], v[92:95], v[76:79], v[156:159]
ds_read_b64_tr_b16 v[66:67], v15 offset:15360
v_mfma_f32_16x16x32_bf16 v[152:155], v[88:91], v[76:79], v[152:155]
ds_read_b64_tr_b16 v[68:69], v16 offset:12288
v_mfma_f32_16x16x32_bf16 v[176:179], v[88:91], v[80:83], v[176:179]
ds_read_b64_tr_b16 v[70:71], v16 offset:15360
v_mfma_f32_16x16x32_bf16 v[180:183], v[92:95], v[80:83], v[180:183]
ds_read_b128 v[36:39], v9 offset:50176
v_mfma_f32_16x16x32_bf16 v[184:187], v[96:99], v[80:83], v[184:187]
ds_read_b128 v[40:43], v9 offset:51200
v_mfma_f32_16x16x32_bf16 v[188:191], v[100:103], v[80:83], v[188:191]
ds_read_b128 v[44:47], v9 offset:52224
v_mfma_f32_16x16x32_bf16 v[192:195], v[104:107], v[80:83], v[192:195]
v_mfma_f32_16x16x32_bf16 v[196:199], v[108:111], v[80:83], v[196:199]
v_mfma_f32_16x16x32_bf16 v[220:223], v[108:111], v[84:87], v[220:223]
v_mfma_f32_16x16x32_bf16 v[216:219], v[104:107], v[84:87], v[216:219]
v_mfma_f32_16x16x32_bf16 v[212:215], v[100:103], v[84:87], v[212:215]
v_mfma_f32_16x16x32_bf16 v[208:211], v[96:99], v[84:87], v[208:211]
v_mfma_f32_16x16x32_bf16 v[204:207], v[92:95], v[84:87], v[204:207]
v_mfma_f32_16x16x32_bf16 v[200:203], v[88:91], v[84:87], v[200:203]
s_mov_b32 s41, 5
Lk3l_102:
s_waitcnt lgkmcnt(0)
v_mfma_f32_16x16x32_bf16 v[128:131], v[48:51], v[32:35], v[128:131]
ds_read_b128 v[72:75], v9 offset:57344
v_mfma_f32_16x16x32_bf16 v[132:135], v[52:55], v[32:35], v[132:135]
ds_read_b64_tr_b16 v[88:89], v14 offset:6144
v_mfma_f32_16x16x32_bf16 v[136:139], v[56:59], v[32:35], v[136:139]
ds_read_b64_tr_b16 v[90:91], v14 offset:9216
v_mfma_f32_16x16x32_bf16 v[140:143], v[60:63], v[32:35], v[140:143]
ds_read_b64_tr_b16 v[92:93], v15 offset:6144
v_mfma_f32_16x16x32_bf16 v[144:147], v[64:67], v[32:35], v[144:147]
ds_read_b64_tr_b16 v[94:95], v15 offset:9216
v_mfma_f32_16x16x32_bf16 v[148:151], v[68:71], v[32:35], v[148:151]
ds_read_b64_tr_b16 v[96:97], v16 offset:6144
v_mfma_f32_16x16x32_bf16 v[172:175], v[68:71], v[36:39], v[172:175]
ds_read_b64_tr_b16 v[98:99], v16 offset:9216
v_mfma_f32_16x16x32_bf16 v[168:171], v[64:67], v[36:39], v[168:171]
ds_read_b64_tr_b16 v[100:101], v14 offset:18432
v_mfma_f32_16x16x32_bf16 v[164:167], v[60:63], v[36:39], v[164:167]
ds_read_b64_tr_b16 v[102:103], v14 offset:21504
v_mfma_f32_16x16x32_bf16 v[160:163], v[56:59], v[36:39], v[160:163]
ds_read_b64_tr_b16 v[104:105], v15 offset:18432
v_mfma_f32_16x16x32_bf16 v[156:159], v[52:55], v[36:39], v[156:159]
ds_read_b64_tr_b16 v[106:107], v15 offset:21504
v_mfma_f32_16x16x32_bf16 v[152:155], v[48:51], v[36:39], v[152:155]
ds_read_b64_tr_b16 v[108:109], v16 offset:18432
v_mfma_f32_16x16x32_bf16 v[176:179], v[48:51], v[40:43], v[176:179]
ds_read_b64_tr_b16 v[110:111], v16 offset:21504
v_mfma_f32_16x16x32_bf16 v[180:183], v[52:55], v[40:43], v[180:183]
ds_read_b128 v[76:79], v9 offset:58368
v_mfma_f32_16x16x32_bf16 v[184:187], v[56:59], v[40:43], v[184:187]
ds_read_b128 v[80:83], v9 offset:59392
v_mfma_f32_16x16x32_bf16 v[188:191], v[60:63], v[40:43], v[188:191]
ds_read_b128 v[84:87], v9 offset:60416
v_mfma_f32_16x16x32_bf16 v[192:195], v[64:67], v[40:43], v[192:195]
v_mfma_f32_16x16x32_bf16 v[196:199], v[68:71], v[40:43], v[196:199]
v_mfma_f32_16x16x32_bf16 v[220:223], v[68:71], v[44:47], v[220:223]
v_mfma_f32_16x16x32_bf16 v[216:219], v[64:67], v[44:47], v[216:219]
v_mfma_f32_16x16x32_bf16 v[212:215], v[60:63], v[44:47], v[212:215]
v_mfma_f32_16x16x32_bf16 v[208:211], v[56:59], v[44:47], v[208:211]
v_mfma_f32_16x16x32_bf16 v[204:207], v[52:55], v[44:47], v[204:207]
v_mfma_f32_16x16x32_bf16 v[200:203], v[48:51], v[44:47], v[200:203]
s_waitcnt lgkmcnt(0)
s_barrier
v_mfma_f32_16x16x32_bf16 v[128:131], v[88:91], v[72:75], v[128:131]
ds_read_b128 v[32:35], v10 offset:0
v_mfma_f32_16x16x32_bf16 v[132:135], v[92:95], v[72:75], v[132:135]
ds_read_b64_tr_b16 v[48:49], v17 offset:0
v_mfma_f32_16x16x32_bf16 v[136:139], v[96:99], v[72:75], v[136:139]
ds_read_b64_tr_b16 v[50:51], v17 offset:3072
v_mfma_f32_16x16x32_bf16 v[140:143], v[100:103], v[72:75], v[140:143]
ds_read_b64_tr_b16 v[52:53], v18 offset:0
v_mfma_f32_16x16x32_bf16 v[144:147], v[104:107], v[72:75], v[144:147]
ds_read_b64_tr_b16 v[54:55], v18 offset:3072
v_mfma_f32_16x16x32_bf16 v[148:151], v[108:111], v[72:75], v[148:151]
ds_read_b64_tr_b16 v[56:57], v19 offset:0
v_mfma_f32_16x16x32_bf16 v[172:175], v[108:111], v[76:79], v[172:175]
ds_read_b64_tr_b16 v[58:59], v19 offset:3072
v_mfma_f32_16x16x32_bf16 v[168:171], v[104:107], v[76:79], v[168:171]
ds_read_b64_tr_b16 v[60:61], v17 offset:12288
v_mfma_f32_16x16x32_bf16 v[164:167], v[100:103], v[76:79], v[164:167]
ds_read_b64_tr_b16 v[62:63], v17 offset:15360
v_mfma_f32_16x16x32_bf16 v[160:163], v[96:99], v[76:79], v[160:163]
ds_read_b64_tr_b16 v[64:65], v18 offset:12288
v_mfma_f32_16x16x32_bf16 v[156:159], v[92:95], v[76:79], v[156:159]
ds_read_b64_tr_b16 v[66:67], v18 offset:15360
v_mfma_f32_16x16x32_bf16 v[152:155], v[88:91], v[76:79], v[152:155]
ds_read_b64_tr_b16 v[68:69], v19 offset:12288
v_mfma_f32_16x16x32_bf16 v[176:179], v[88:91], v[80:83], v[176:179]
ds_read_b64_tr_b16 v[70:71], v19 offset:15360
v_mfma_f32_16x16x32_bf16 v[180:183], v[92:95], v[80:83], v[180:183]
ds_read_b128 v[36:39], v10 offset:1024
v_mfma_f32_16x16x32_bf16 v[184:187], v[96:99], v[80:83], v[184:187]
ds_read_b128 v[40:43], v10 offset:2048
v_mfma_f32_16x16x32_bf16 v[188:191], v[100:103], v[80:83], v[188:191]
ds_read_b128 v[44:47], v10 offset:3072
v_mfma_f32_16x16x32_bf16 v[192:195], v[104:107], v[80:83], v[192:195]
v_mfma_f32_16x16x32_bf16 v[196:199], v[108:111], v[80:83], v[196:199]
v_mfma_f32_16x16x32_bf16 v[220:223], v[108:111], v[84:87], v[220:223]
v_mfma_f32_16x16x32_bf16 v[216:219], v[104:107], v[84:87], v[216:219]
v_mfma_f32_16x16x32_bf16 v[212:215], v[100:103], v[84:87], v[212:215]
v_mfma_f32_16x16x32_bf16 v[208:211], v[96:99], v[84:87], v[208:211]
v_mfma_f32_16x16x32_bf16 v[204:207], v[92:95], v[84:87], v[204:207]
v_mfma_f32_16x16x32_bf16 v[200:203], v[88:91], v[84:87], v[200:203]
s_waitcnt lgkmcnt(0)
v_mfma_f32_16x16x32_bf16 v[128:131], v[48:51], v[32:35], v[128:131]
ds_read_b128 v[72:75], v10 offset:8192
v_mfma_f32_16x16x32_bf16 v[132:135], v[52:55], v[32:35], v[132:135]
ds_read_b64_tr_b16 v[88:89], v17 offset:6144
v_mfma_f32_16x16x32_bf16 v[136:139], v[56:59], v[32:35], v[136:139]
ds_read_b64_tr_b16 v[90:91], v17 offset:9216
v_mfma_f32_16x16x32_bf16 v[140:143], v[60:63], v[32:35], v[140:143]
ds_read_b64_tr_b16 v[92:93], v18 offset:6144
v_mfma_f32_16x16x32_bf16 v[144:147], v[64:67], v[32:35], v[144:147]
ds_read_b64_tr_b16 v[94:95], v18 offset:9216
v_mfma_f32_16x16x32_bf16 v[148:151], v[68:71], v[32:35], v[148:151]
ds_read_b64_tr_b16 v[96:97], v19 offset:6144
v_mfma_f32_16x16x32_bf16 v[172:175], v[68:71], v[36:39], v[172:175]
ds_read_b64_tr_b16 v[98:99], v19 offset:9216
v_mfma_f32_16x16x32_bf16 v[168:171], v[64:67], v[36:39], v[168:171]
ds_read_b64_tr_b16 v[100:101], v17 offset:18432
v_mfma_f32_16x16x32_bf16 v[164:167], v[60:63], v[36:39], v[164:167]
ds_read_b64_tr_b16 v[102:103], v17 offset:21504
v_mfma_f32_16x16x32_bf16 v[160:163], v[56:59], v[36:39], v[160:163]
ds_read_b64_tr_b16 v[104:105], v18 offset:18432
v_mfma_f32_16x16x32_bf16 v[156:159], v[52:55], v[36:39], v[156:159]
ds_read_b64_tr_b16 v[106:107], v18 offset:21504
v_mfma_f32_16x16x32_bf16 v[152:155], v[48:51], v[36:39], v[152:155]
ds_read_b64_tr_b16 v[108:109], v19 offset:18432
v_mfma_f32_16x16x32_bf16 v[176:179], v[48:51], v[40:43], v[176:179]
ds_read_b64_tr_b16 v[110:111], v19 offset:21504
v_mfma_f32_16x16x32_bf16 v[180:183], v[52:55], v[40:43], v[180:183]
ds_read_b128 v[76:79], v10 offset:9216
v_mfma_f32_16x16x32_bf16 v[184:187], v[56:59], v[40:43], v[184:187]
ds_read_b128 v[80:83], v10 offset:10240
v_mfma_f32_16x16x32_bf16 v[188:191], v[60:63], v[40:43], v[188:191]
ds_read_b128 v[84:87], v10 offset:11264
v_mfma_f32_16x16x32_bf16 v[192:195], v[64:67], v[40:43], v[192:195]
v_mfma_f32_16x16x32_bf16 v[196:199], v[68:71], v[40:43], v[196:199]
v_mfma_f32_16x16x32_bf16 v[220:223], v[68:71], v[44:47], v[220:223]
v_mfma_f32_16x16x32_bf16 v[216:219], v[64:67], v[44:47], v[216:219]
v_mfma_f32_16x16x32_bf16 v[212:215], v[60:63], v[44:47], v[212:215]
v_mfma_f32_16x16x32_bf16 v[208:211], v[56:59], v[44:47], v[208:211]
v_mfma_f32_16x16x32_bf16 v[204:207], v[52:55], v[44:47], v[204:207]
v_mfma_f32_16x16x32_bf16 v[200:203], v[48:51], v[44:47], v[200:203]
s_waitcnt lgkmcnt(0)
s_barrier
v_mfma_f32_16x16x32_bf16 v[128:131], v[88:91], v[72:75], v[128:131]
ds_read_b128 v[32:35], v9 offset:0
v_mfma_f32_16x16x32_bf16 v[132:135], v[92:95], v[72:75], v[132:135]
ds_read_b64_tr_b16 v[48:49], v11 offset:0
v_mfma_f32_16x16x32_bf16 v[136:139], v[96:99], v[72:75], v[136:139]
ds_read_b64_tr_b16 v[50:51], v11 offset:3072
v_mfma_f32_16x16x32_bf16 v[140:143], v[100:103], v[72:75], v[140:143]
ds_read_b64_tr_b16 v[52:53], v12 offset:0
v_mfma_f32_16x16x32_bf16 v[144:147], v[104:107], v[72:75], v[144:147]
ds_read_b64_tr_b16 v[54:55], v12 offset:3072
v_mfma_f32_16x16x32_bf16 v[148:151], v[108:111], v[72:75], v[148:151]
ds_read_b64_tr_b16 v[56:57], v13 offset:0
v_mfma_f32_16x16x32_bf16 v[172:175], v[108:111], v[76:79], v[172:175]
ds_read_b64_tr_b16 v[58:59], v13 offset:3072
v_mfma_f32_16x16x32_bf16 v[168:171], v[104:107], v[76:79], v[168:171]
ds_read_b64_tr_b16 v[60:61], v11 offset:12288
v_mfma_f32_16x16x32_bf16 v[164:167], v[100:103], v[76:79], v[164:167]
ds_read_b64_tr_b16 v[62:63], v11 offset:15360
v_mfma_f32_16x16x32_bf16 v[160:163], v[96:99], v[76:79], v[160:163]
ds_read_b64_tr_b16 v[64:65], v12 offset:12288
v_mfma_f32_16x16x32_bf16 v[156:159], v[92:95], v[76:79], v[156:159]
ds_read_b64_tr_b16 v[66:67], v12 offset:15360
v_mfma_f32_16x16x32_bf16 v[152:155], v[88:91], v[76:79], v[152:155]
ds_read_b64_tr_b16 v[68:69], v13 offset:12288
v_mfma_f32_16x16x32_bf16 v[176:179], v[88:91], v[80:83], v[176:179]
ds_read_b64_tr_b16 v[70:71], v13 offset:15360
v_mfma_f32_16x16x32_bf16 v[180:183], v[92:95], v[80:83], v[180:183]
ds_read_b128 v[36:39], v9 offset:1024
v_mfma_f32_16x16x32_bf16 v[184:187], v[96:99], v[80:83], v[184:187]
ds_read_b128 v[40:43], v9 offset:2048
v_mfma_f32_16x16x32_bf16 v[188:191], v[100:103], v[80:83], v[188:191]
ds_read_b128 v[44:47], v9 offset:3072
v_mfma_f32_16x16x32_bf16 v[192:195], v[104:107], v[80:83], v[192:195]
v_mfma_f32_16x16x32_bf16 v[196:199], v[108:111], v[80:83], v[196:199]
v_mfma_f32_16x16x32_bf16 v[220:223], v[108:111], v[84:87], v[220:223]
v_mfma_f32_16x16x32_bf16 v[216:219], v[104:107], v[84:87], v[216:219]
v_mfma_f32_16x16x32_bf16 v[212:215], v[100:103], v[84:87], v[212:215]
v_mfma_f32_16x16x32_bf16 v[208:211], v[96:99], v[84:87], v[208:211]
v_mfma_f32_16x16x32_bf16 v[204:207], v[92:95], v[84:87], v[204:207]
v_mfma_f32_16x16x32_bf16 v[200:203], v[88:91], v[84:87], v[200:203]
s_waitcnt lgkmcnt(0)
v_mfma_f32_16x16x32_bf16 v[128:131], v[48:51], v[32:35], v[128:131]
ds_read_b128 v[72:75], v9 offset:8192
v_mfma_f32_16x16x32_bf16 v[132:135], v[52:55], v[32:35], v[132:135]
ds_read_b64_tr_b16 v[88:89], v11 offset:6144
v_mfma_f32_16x16x32_bf16 v[136:139], v[56:59], v[32:35], v[136:139]
ds_read_b64_tr_b16 v[90:91], v11 offset:9216
v_mfma_f32_16x16x32_bf16 v[140:143], v[60:63], v[32:35], v[140:143]
ds_read_b64_tr_b16 v[92:93], v12 offset:6144
v_mfma_f32_16x16x32_bf16 v[144:147], v[64:67], v[32:35], v[144:147]
ds_read_b64_tr_b16 v[94:95], v12 offset:9216
v_mfma_f32_16x16x32_bf16 v[148:151], v[68:71], v[32:35], v[148:151]
ds_read_b64_tr_b16 v[96:97], v13 offset:6144
v_mfma_f32_16x16x32_bf16 v[172:175], v[68:71], v[36:39], v[172:175]
ds_read_b64_tr_b16 v[98:99], v13 offset:9216
v_mfma_f32_16x16x32_bf16 v[168:171], v[64:67], v[36:39], v[168:171]
ds_read_b64_tr_b16 v[100:101], v11 offset:18432
v_mfma_f32_16x16x32_bf16 v[164:167], v[60:63], v[36:39], v[164:167]
ds_read_b64_tr_b16 v[102:103], v11 offset:21504
v_mfma_f32_16x16x32_bf16 v[160:163], v[56:59], v[36:39], v[160:163]
ds_read_b64_tr_b16 v[104:105], v12 offset:18432
v_mfma_f32_16x16x32_bf16 v[156:159], v[52:55], v[36:39], v[156:159]
ds_read_b64_tr_b16 v[106:107], v12 offset:21504
v_mfma_f32_16x16x32_bf16 v[152:155], v[48:51], v[36:39], v[152:155]
ds_read_b64_tr_b16 v[108:109], v13 offset:18432
v_mfma_f32_16x16x32_bf16 v[176:179], v[48:51], v[40:43], v[176:179]
ds_read_b64_tr_b16 v[110:111], v13 offset:21504
v_mfma_f32_16x16x32_bf16 v[180:183], v[52:55], v[40:43], v[180:183]
ds_read_b128 v[76:79], v9 offset:9216
v_mfma_f32_16x16x32_bf16 v[184:187], v[56:59], v[40:43], v[184:187]
ds_read_b128 v[80:83], v9 offset:10240
v_mfma_f32_16x16x32_bf16 v[188:191], v[60:63], v[40:43], v[188:191]
ds_read_b128 v[84:87], v9 offset:11264
v_mfma_f32_16x16x32_bf16 v[192:195], v[64:67], v[40:43], v[192:195]
v_mfma_f32_16x16x32_bf16 v[196:199], v[68:71], v[40:43], v[196:199]
v_mfma_f32_16x16x32_bf16 v[220:223], v[68:71], v[44:47], v[220:223]
v_mfma_f32_16x16x32_bf16 v[216:219], v[64:67], v[44:47], v[216:219]
v_mfma_f32_16x16x32_bf16 v[212:215], v[60:63], v[44:47], v[212:215]
v_mfma_f32_16x16x32_bf16 v[208:211], v[56:59], v[44:47], v[208:211]
v_mfma_f32_16x16x32_bf16 v[204:207], v[52:55], v[44:47], v[204:207]
v_mfma_f32_16x16x32_bf16 v[200:203], v[48:51], v[44:47], v[200:203]
s_waitcnt lgkmcnt(0)
s_barrier
v_mfma_f32_16x16x32_bf16 v[128:131], v[88:91], v[72:75], v[128:131]
ds_read_b128 v[32:35], v9 offset:49152
v_mfma_f32_16x16x32_bf16 v[132:135], v[92:95], v[72:75], v[132:135]
ds_read_b64_tr_b16 v[48:49], v14 offset:0
v_mfma_f32_16x16x32_bf16 v[136:139], v[96:99], v[72:75], v[136:139]
ds_read_b64_tr_b16 v[50:51], v14 offset:3072
v_mfma_f32_16x16x32_bf16 v[140:143], v[100:103], v[72:75], v[140:143]
ds_read_b64_tr_b16 v[52:53], v15 offset:0
v_mfma_f32_16x16x32_bf16 v[144:147], v[104:107], v[72:75], v[144:147]
ds_read_b64_tr_b16 v[54:55], v15 offset:3072
v_mfma_f32_16x16x32_bf16 v[148:151], v[108:111], v[72:75], v[148:151]
ds_read_b64_tr_b16 v[56:57], v16 offset:0
v_mfma_f32_16x16x32_bf16 v[172:175], v[108:111], v[76:79], v[172:175]
ds_read_b64_tr_b16 v[58:59], v16 offset:3072
v_mfma_f32_16x16x32_bf16 v[168:171], v[104:107], v[76:79], v[168:171]
ds_read_b64_tr_b16 v[60:61], v14 offset:12288
v_mfma_f32_16x16x32_bf16 v[164:167], v[100:103], v[76:79], v[164:167]
ds_read_b64_tr_b16 v[62:63], v14 offset:15360
v_mfma_f32_16x16x32_bf16 v[160:163], v[96:99], v[76:79], v[160:163]
ds_read_b64_tr_b16 v[64:65], v15 offset:12288
v_mfma_f32_16x16x32_bf16 v[156:159], v[92:95], v[76:79], v[156:159]
ds_read_b64_tr_b16 v[66:67], v15 offset:15360
v_mfma_f32_16x16x32_bf16 v[152:155], v[88:91], v[76:79], v[152:155]
ds_read_b64_tr_b16 v[68:69], v16 offset:12288
v_mfma_f32_16x16x32_bf16 v[176:179], v[88:91], v[80:83], v[176:179]
ds_read_b64_tr_b16 v[70:71], v16 offset:15360
v_mfma_f32_16x16x32_bf16 v[180:183], v[92:95], v[80:83], v[180:183]
ds_read_b128 v[36:39], v9 offset:50176
v_mfma_f32_16x16x32_bf16 v[184:187], v[96:99], v[80:83], v[184:187]
ds_read_b128 v[40:43], v9 offset:51200
v_mfma_f32_16x16x32_bf16 v[188:191], v[100:103], v[80:83], v[188:191]
ds_read_b128 v[44:47], v9 offset:52224
v_mfma_f32_16x16x32_bf16 v[192:195], v[104:107], v[80:83], v[192:195]
v_mfma_f32_16x16x32_bf16 v[196:199], v[108:111], v[80:83], v[196:199]
v_mfma_f32_16x16x32_bf16 v[220:223], v[108:111], v[84:87], v[220:223]
v_mfma_f32_16x16x32_bf16 v[216:219], v[104:107], v[84:87], v[216:219]
v_mfma_f32_16x16x32_bf16 v[212:215], v[100:103], v[84:87], v[212:215]
v_mfma_f32_16x16x32_bf16 v[208:211], v[96:99], v[84:87], v[208:211]
v_mfma_f32_16x16x32_bf16 v[204:207], v[92:95], v[84:87], v[204:207]
v_mfma_f32_16x16x32_bf16 v[200:203], v[88:91], v[84:87], v[200:203]
s_sub_u32 s41, s41, 1
s_cmp_lg_u32 s41, 0
s_cbranch_scc1 Lk3l_102
s_waitcnt lgkmcnt(0)
s_mov_b32 s28, s76
s_mov_b32 s29, s77
s_mov_b32 s30, 7340032
s_mov_b32 s31, 0x20000
s_add_u32 s37, s35, 2
s_and_b32 s37, s37, 15
s_mul_i32 s37, s37, 16384
s_add_u32 m0, s39, 0
s_nop 0
buffer_load_dwordx4 v3, s[8:11], s37 offen sc1 lds
v_lshrrev_b32 v86, 4, v1
s_lshl_b32 s43, s63, 7
s_add_u32 s43, s43, 148992
buffer_load_dwordx4 v3, s[8:11], s37 offen offset:1024 sc1 lds
v_lshl_add_u32 v87, v86, 4, s43
v_lshrrev_b32 v88, 1, v86
v_and_b32 v86, 1, v86
s_lshl_b32 s43, s63, 5
s_branch Lov_8
.p2align 12
Lst_8_0:
s_branch Lwr_148
Lst_8_1:
s_branch Lwr_159
s_nop 0
Lov_8:
buffer_load_dwordx4 v3, s[8:11], s37 offen offset:2048 sc1 lds
s_add_u32 s43, s43, 149248
v_lshl_add_u32 v88, v88, 6, s43
v_lshl_add_u32 v88, v86, 4, v88
v_and_b32 v86, 15, v1
buffer_load_dwordx4 v3, s[8:11], s37 offen offset:3072 sc1 lds
s_lshl_b32 s43, s62, 9
s_add_u32 s43, s43, 147456
v_lshl_add_u32 v86, v86, 3, s43
s_add_u32 s38, s35, 2
s_and_b32 s38, s38, 15
s_mul_i32 s38, s38, 458752
s_add_u32 m0, s40, 0
s_nop 0
buffer_load_dwordx4 v4, s[12:15], s38 offen lds
ds_read_b128 v[32:35], v87 offset:0
ds_read_b128 v[36:39], v87 offset:64
ds_read_b128 v[40:43], v88 offset:0
ds_read_b128 v[44:47], v87 offset:896
s_add_u32 m0, s40, 1024
s_nop 0
buffer_load_dwordx4 v5, s[12:15], s38 offen lds
ds_read_b128 v[48:51], v87 offset:960
ds_read_b128 v[52:55], v88 offset:896
ds_read_b64 v[56:57], v86 offset:0
ds_read_b64 v[58:59], v86 offset:128
s_add_u32 m0, s40, 2048
s_add_u32 s38, s38, 57344
buffer_load_dwordx4 v4, s[12:15], s38 offen lds
ds_read_b64 v[60:61], v86 offset:256
ds_read_b64 v[62:63], v86 offset:384
s_mul_i32 s54, s35, 24576
s_add_u32 m0, s40, 3072
s_nop 0
buffer_load_dwordx4 v5, s[12:15], s38 offen lds
s_lshl_b32 s43, s62, 12
s_add_u32 s54, s54, s43
s_add_u32 s54, s54, 524288
s_lshl_b32 s43, s63, 9
s_add_u32 m0, s40, 4096
s_add_u32 s38, s38, 57344
buffer_load_dwordx4 v4, s[12:15], s38 offen lds
s_add_u32 s55, s54, s43
s_add_u32 s55, s55, 16384
s_lshl_b32 s43, s63, 13
s_add_u32 s54, s54, s43
s_add_u32 m0, s40, 5120
s_nop 0
buffer_load_dwordx4 v5, s[12:15], s38 offen lds
v_and_b32 v84, 32, v1
v_lshlrev_b32 v84, 4, v84
v_add_u32 v84, v84, v2
s_waitcnt lgkmcnt(0)
s_add_u32 m0, s40, 6144
s_add_u32 s38, s38, 57344
buffer_load_dwordx4 v4, s[12:15], s38 offen lds
s_add_u32 m0, s40, 7168
s_nop 0
buffer_load_dwordx4 v5, s[12:15], s38 offen lds
s_and_b32 s44, s36, 3
s_mul_i32 s43, s2, 28672
s_mul_i32 s44, s44, 7168
s_add_u32 s43, s43, s44
s_add_u32 s4, s76, s43
s_addc_u32 s5, s77, 0
s_barrier
s_cmp_eq_u32 s47, 3
s_cbranch_scc0 Lw_103
v_and_b32 v30, 31, v1
v_lshlrev_b32 v30, 4, v30
v_add_u32 v31, 153600, v30
ds_read_b128 v[108:111], v31 offset:0
ds_read_b128 v[112:115], v31 offset:512
ds_read_b128 v[116:119], v31 offset:1024
ds_read_b128 v[120:123], v31 offset:1536
s_and_b32 s44, s2, 15
s_mul_i32 s44, s44, 14336
s_lshr_b32 s43, s2, 4
s_lshl_b32 s43, s43, 9
s_add_u32 s44, s44, s43
s_waitcnt lgkmcnt(0)
v_add_f32 v108, v108, v112
v_add_f32 v116, v116, v120
v_add_f32 v109, v109, v113
v_add_f32 v117, v117, v121
v_add_f32 v110, v110, v114
v_add_f32 v118, v118, v122
v_add_f32 v111, v111, v115
v_add_f32 v119, v119, v123
v_add_f32 v108, v108, v116
v_add_f32 v109, v109, v117
v_add_f32 v110, v110, v118
v_add_f32 v111, v111, v119
s_mov_b64 exec, 0xffffffff
buffer_store_dwordx4 v[108:111], v30, s[84:87], s44 offen sc1
s_mov_b64 exec, -1
Lw_103:
s_waitcnt lgkmcnt(0)
s_add_u32 s37, s35, 3
s_and_b32 s37, s37, 15
s_mul_i32 s37, s37, 16384
s_add_u32 m0, s39, 49152
s_nop 0
buffer_load_dwordx4 v3, s[8:11], s37 offen sc1 lds
s_load_dword s3, s[4:5], 1792
s_load_dword s3, s[4:5], 1856
s_load_dword s3, s[4:5], 1920
s_load_dword s3, s[4:5], 1984
s_load_dword s3, s[4:5], 2048
s_load_dword s3, s[4:5], 2112
s_load_dword s3, s[4:5], 2176
buffer_load_dwordx4 v3, s[8:11], s37 offen offset:1024 sc1 lds
s_load_dword s3, s[4:5], 2240
s_load_dword s3, s[4:5], 2304
s_load_dword s3, s[4:5], 2368
s_load_dword s3, s[4:5], 2432
s_load_dword s3, s[4:5], 2496
s_load_dword s3, s[4:5], 2560
s_load_dword s3, s[4:5], 2624
buffer_load_dwordx4 v3, s[8:11], s37 offen offset:2048 sc1 lds
v_mul_f32 v66, v57, v57
v_mul_f32 v64, 0xc0135761, v57
v_mul_f32 v65, 0xbdd2d3e8, v57
v_mul_f32 v65, v65, v66
v_rcp_f32 v66, v66
v_mul_f32 v70, v59, v59
v_mul_f32 v68, 0xc0135761, v59
buffer_load_dwordx4 v3, s[8:11], s37 offen offset:3072 sc1 lds
v_mul_f32 v69, 0xbdd2d3e8, v59
v_mul_f32 v69, v69, v70
v_rcp_f32 v70, v70
v_fma_f32 v128, -v56, v32, v128
v_fma_f32 v129, -v56, v33, v129
v_fma_f32 v130, -v56, v34, v130
v_fma_f32 v131, -v56, v35, v131
v_fma_f32 v152, -v58, v32, v152
s_add_u32 s38, s35, 3
s_and_b32 s38, s38, 15
s_mul_i32 s38, s38, 458752
s_add_u32 m0, s40, 49152
s_nop 0
buffer_load_dwordx4 v4, s[12:15], s38 offen lds
v_fma_f32 v153, -v58, v33, v153
v_fma_f32 v154, -v58, v34, v154
v_fma_f32 v155, -v58, v35, v155
v_mul_f32 v72, v128, v128
v_mul_f32 v73, v129, v129
v_mul_f32 v74, v130, v130
v_mul_f32 v75, v131, v131
s_add_u32 m0, s40, 50176
s_nop 0
buffer_load_dwordx4 v5, s[12:15], s38 offen lds
v_mul_f32 v76, v152, v152
v_mul_f32 v77, v153, v153
v_mul_f32 v78, v154, v154
v_mul_f32 v79, v155, v155
v_fma_f32 v72, v72, v65, v64
v_fma_f32 v73, v73, v65, v64
v_fma_f32 v74, v74, v65, v64
s_add_u32 m0, s40, 51200
s_add_u32 s38, s38, 57344
buffer_load_dwordx4 v4, s[12:15], s38 offen lds
v_fma_f32 v75, v75, v65, v64
v_fma_f32 v76, v76, v69, v68
v_fma_f32 v77, v77, v69, v68
v_fma_f32 v78, v78, v69, v68
v_fma_f32 v79, v79, v69, v68
v_mul_f32 v72, v72, v128
v_mul_f32 v73, v73, v129
v_mul_f32 v74, v74, v130
s_add_u32 m0, s40, 52224
s_nop 0
buffer_load_dwordx4 v5, s[12:15], s38 offen lds
v_mul_f32 v75, v75, v131
v_mul_f32 v76, v76, v152
v_mul_f32 v77, v77, v153
v_mul_f32 v78, v78, v154
v_mul_f32 v79, v79, v155
v_exp_f32 v72, v72
v_exp_f32 v73, v73
s_add_u32 m0, s40, 53248
s_add_u32 s38, s38, 57344
buffer_load_dwordx4 v4, s[12:15], s38 offen lds
v_exp_f32 v74, v74
v_exp_f32 v75, v75
v_exp_f32 v76, v76
v_exp_f32 v77, v77
v_exp_f32 v78, v78
v_exp_f32 v79, v79
v_fma_f32 v140, -v56, v44, v140
s_add_u32 m0, s40, 54272
s_nop 0
buffer_load_dwordx4 v5, s[12:15], s38 offen lds
v_fma_f32 v141, -v56, v45, v141
v_fma_f32 v142, -v56, v46, v142
v_fma_f32 v143, -v56, v47, v143
v_fma_f32 v164, -v58, v44, v164
v_fma_f32 v165, -v58, v45, v165
v_fma_f32 v166, -v58, v46, v166
v_fma_f32 v167, -v58, v47, v167
v_fma_f32 v72, v72, v66, v66
s_add_u32 m0, s40, 55296
s_add_u32 s38, s38, 57344
buffer_load_dwordx4 v4, s[12:15], s38 offen lds
s_add_u32 m0, s40, 56320
s_nop 0
buffer_load_dwordx4 v5, s[12:15], s38 offen lds
s_waitcnt vmcnt(12)
s_barrier
s_add_u32 s37, s35, 4
s_and_b32 s37, s37, 15
s_mul_i32 s37, s37, 16384
s_add_u32 m0, s39, 98304
s_nop 0
buffer_load_dwordx4 v3, s[8:11], s37 offen sc1 lds
v_fma_f32 v73, v73, v66, v66
v_fma_f32 v74, v74, v66, v66
v_fma_f32 v75, v75, v66, v66
v_fma_f32 v76, v76, v70, v70
v_fma_f32 v77, v77, v70, v70
v_fma_f32 v78, v78, v70, v70
buffer_load_dwordx4 v3, s[8:11], s37 offen offset:1024 sc1 lds
v_fma_f32 v79, v79, v70, v70
v_rcp_f32 v72, v72
v_rcp_f32 v73, v73
v_rcp_f32 v74, v74
v_rcp_f32 v75, v75
v_rcp_f32 v76, v76
buffer_load_dwordx4 v3, s[8:11], s37 offen offset:2048 sc1 lds
v_rcp_f32 v77, v77
v_rcp_f32 v78, v78
v_rcp_f32 v79, v79
v_mul_f32 v140, v128, v140
v_mul_f32 v141, v129, v141
v_mul_f32 v142, v130, v142
buffer_load_dwordx4 v3, s[8:11], s37 offen offset:3072 sc1 lds
v_mul_f32 v143, v131, v143
v_mul_f32 v164, v152, v164
v_mul_f32 v165, v153, v165
v_mul_f32 v166, v154, v166
v_mul_f32 v167, v155, v167
v_mul_f32 v140, v140, v72
s_add_u32 s38, s35, 4
s_and_b32 s38, s38, 15
s_mul_i32 s38, s38, 458752
s_add_u32 m0, s40, 98304
s_nop 0
buffer_load_dwordx4 v4, s[12:15], s38 offen lds
v_mul_f32 v141, v141, v73
v_mul_f32 v142, v142, v74
v_mul_f32 v143, v143, v75
v_mul_f32 v164, v164, v76
v_mul_f32 v165, v165, v77
v_mul_f32 v166, v166, v78
s_add_u32 m0, s40, 99328
s_nop 0
buffer_load_dwordx4 v5, s[12:15], s38 offen lds
v_mul_f32 v167, v167, v79
v_cvt_pk_bf16_f32 v128, v140, v141
v_cvt_pk_bf16_f32 v129, v142, v143
v_cvt_pk_bf16_f32 v152, v164, v165
v_cvt_pk_bf16_f32 v153, v166, v167
v_fma_f32 v132, -v56, v36, v132
s_add_u32 m0, s40, 100352
s_add_u32 s38, s38, 57344
buffer_load_dwordx4 v4, s[12:15], s38 offen lds
v_fma_f32 v133, -v56, v37, v133
v_fma_f32 v134, -v56, v38, v134
v_fma_f32 v135, -v56, v39, v135
v_fma_f32 v156, -v58, v36, v156
v_fma_f32 v157, -v58, v37, v157
v_fma_f32 v158, -v58, v38, v158
s_add_u32 m0, s40, 101376
s_nop 0
buffer_load_dwordx4 v5, s[12:15], s38 offen lds
v_fma_f32 v159, -v58, v39, v159
v_mul_f32 v72, v132, v132
v_mul_f32 v73, v133, v133
v_mul_f32 v74, v134, v134
v_mul_f32 v75, v135, v135
v_mul_f32 v76, v156, v156
s_add_u32 m0, s40, 102400
s_add_u32 s38, s38, 57344
buffer_load_dwordx4 v4, s[12:15], s38 offen lds
v_mul_f32 v77, v157, v157
v_mul_f32 v78, v158, v158
v_mul_f32 v79, v159, v159
v_fma_f32 v72, v72, v65, v64
v_fma_f32 v73, v73, v65, v64
v_fma_f32 v74, v74, v65, v64
s_add_u32 m0, s40, 103424
s_nop 0
buffer_load_dwordx4 v5, s[12:15], s38 offen lds
v_fma_f32 v75, v75, v65, v64
v_fma_f32 v76, v76, v69, v68
v_fma_f32 v77, v77, v69, v68
v_fma_f32 v78, v78, v69, v68
v_fma_f32 v79, v79, v69, v68
v_mul_f32 v72, v72, v132
s_add_u32 m0, s40, 104448
s_add_u32 s38, s38, 57344
buffer_load_dwordx4 v4, s[12:15], s38 offen lds
s_add_u32 m0, s40, 105472
s_nop 0
buffer_load_dwordx4 v5, s[12:15], s38 offen lds
s_waitcnt vmcnt(12)
s_barrier
s_cmp_eq_u32 s47, 3
s_cbranch_scc0 Lw_104
s_lshr_b32 s43, s2, 4
s_add_u32 s43, s43, 80
s_lshl_b32 s43, s43, 7
v_mov_b32 v30, s43
v_mov_b32 v31, 1
s_mov_b64 exec, 1
buffer_atomic_add v31, v30, s[56:59], 0 offen sc1
s_mov_b64 exec, -1
Lw_104:
s_waitcnt lgkmcnt(0)
s_add_u32 s37, s35, 5
s_and_b32 s37, s37, 15
s_mul_i32 s37, s37, 16384
s_add_u32 m0, s39, 0
s_nop 0
buffer_load_dwordx4 v3, s[8:11], s37 offen sc1 lds
s_load_dword s3, s[4:5], 2688
s_load_dword s3, s[4:5], 2752
s_load_dword s3, s[4:5], 2816
s_load_dword s3, s[4:5], 2880
s_load_dword s3, s[4:5], 2944
s_load_dword s3, s[4:5], 3008
s_load_dword s3, s[4:5], 3072
buffer_load_dwordx4 v3, s[8:11], s37 offen offset:1024 sc1 lds
s_load_dword s3, s[4:5], 3136
s_load_dword s3, s[4:5], 3200
s_load_dword s3, s[4:5], 3264
s_load_dword s3, s[4:5], 3328
s_load_dword s3, s[4:5], 3392
s_load_dword s3, s[4:5], 3456
s_load_dword s3, s[4:5], 3520
buffer_load_dwordx4 v3, s[8:11], s37 offen offset:2048 sc1 lds
v_mul_f32 v73, v73, v133
v_mul_f32 v74, v74, v134
v_mul_f32 v75, v75, v135
v_mul_f32 v76, v76, v156
v_mul_f32 v77, v77, v157
v_mul_f32 v78, v78, v158
v_mul_f32 v79, v79, v159
v_exp_f32 v72, v72
buffer_load_dwordx4 v3, s[8:11], s37 offen offset:3072 sc1 lds
v_exp_f32 v73, v73
v_exp_f32 v74, v74
v_exp_f32 v75, v75
v_exp_f32 v76, v76
v_exp_f32 v77, v77
v_exp_f32 v78, v78
v_exp_f32 v79, v79
s_add_u32 s38, s35, 5
s_and_b32 s38, s38, 15
s_mul_i32 s38, s38, 458752
s_add_u32 m0, s40, 0
s_nop 0
buffer_load_dwordx4 v4, s[12:15], s38 offen lds
v_fma_f32 v144, -v56, v48, v144
v_fma_f32 v145, -v56, v49, v145
v_fma_f32 v146, -v56, v50, v146
v_fma_f32 v147, -v56, v51, v147
v_fma_f32 v168, -v58, v48, v168
v_fma_f32 v169, -v58, v49, v169
v_fma_f32 v170, -v58, v50, v170
v_fma_f32 v171, -v58, v51, v171
s_add_u32 m0, s40, 1024
s_nop 0
buffer_load_dwordx4 v5, s[12:15], s38 offen lds
v_fma_f32 v72, v72, v66, v66
v_fma_f32 v73, v73, v66, v66
v_fma_f32 v74, v74, v66, v66
v_fma_f32 v75, v75, v66, v66
v_fma_f32 v76, v76, v70, v70
v_fma_f32 v77, v77, v70, v70
v_fma_f32 v78, v78, v70, v70
s_add_u32 m0, s40, 2048
s_add_u32 s38, s38, 57344
buffer_load_dwordx4 v4, s[12:15], s38 offen lds
v_fma_f32 v79, v79, v70, v70
v_rcp_f32 v72, v72
v_rcp_f32 v73, v73
v_rcp_f32 v74, v74
v_rcp_f32 v75, v75
v_rcp_f32 v76, v76
v_rcp_f32 v77, v77
s_add_u32 m0, s40, 3072
s_nop 0
buffer_load_dwordx4 v5, s[12:15], s38 offen lds
v_rcp_f32 v78, v78
v_rcp_f32 v79, v79
v_mul_f32 v144, v132, v144
v_mul_f32 v145, v133, v145
v_mul_f32 v146, v134, v146
v_mul_f32 v147, v135, v147
v_mul_f32 v168, v156, v168
v_mul_f32 v169, v157, v169
s_add_u32 m0, s40, 4096
s_add_u32 s38, s38, 57344
buffer_load_dwordx4 v4, s[12:15], s38 offen lds
v_mul_f32 v170, v158, v170
v_mul_f32 v171, v159, v171
v_mul_f32 v144, v144, v72
v_mul_f32 v145, v145, v73
v_mul_f32 v146, v146, v74
v_mul_f32 v147, v147, v75
v_mul_f32 v168, v168, v76
s_add_u32 m0, s40, 5120
s_nop 0
buffer_load_dwordx4 v5, s[12:15], s38 offen lds
v_mul_f32 v169, v169, v77
v_mul_f32 v170, v170, v78
v_mul_f32 v171, v171, v79
v_cvt_pk_bf16_f32 v130, v144, v145
v_cvt_pk_bf16_f32 v131, v146, v147
v_cvt_pk_bf16_f32 v154, v168, v169
v_cvt_pk_bf16_f32 v155, v170, v171
buffer_store_dwordx4 v[128:131], v2, s[24:27], s54 offen offset:0 sc1
s_add_u32 m0, s40, 6144
s_add_u32 s38, s38, 57344
buffer_load_dwordx4 v4, s[12:15], s38 offen lds
s_add_u32 m0, s40, 7168
s_nop 0
buffer_load_dwordx4 v5, s[12:15], s38 offen lds
s_waitcnt vmcnt(13)
s_barrier
s_add_u32 s37, s35, 6
s_and_b32 s37, s37, 15
s_mul_i32 s37, s37, 16384
s_add_u32 m0, s39, 49152
s_nop 0
buffer_load_dwordx4 v3, s[8:11], s37 offen sc1 lds
buffer_store_dwordx4 v[152:155], v2, s[24:27], s54 offen offset:1024 sc1
v_fma_f32 v136, -v56, v40, v136
v_fma_f32 v137, -v56, v41, v137
v_fma_f32 v138, -v56, v42, v138
v_fma_f32 v139, -v56, v43, v139
v_fma_f32 v160, -v58, v40, v160
buffer_load_dwordx4 v3, s[8:11], s37 offen offset:1024 sc1 lds
v_fma_f32 v161, -v58, v41, v161
v_fma_f32 v162, -v58, v42, v162
v_fma_f32 v163, -v58, v43, v163
v_mul_f32 v72, v136, v136
v_mul_f32 v73, v137, v137
v_mul_f32 v74, v138, v138
buffer_load_dwordx4 v3, s[8:11], s37 offen offset:2048 sc1 lds
v_mul_f32 v75, v139, v139
v_mul_f32 v76, v160, v160
v_mul_f32 v77, v161, v161
v_mul_f32 v78, v162, v162
v_mul_f32 v79, v163, v163
v_fma_f32 v72, v72, v65, v64
buffer_load_dwordx4 v3, s[8:11], s37 offen offset:3072 sc1 lds
v_fma_f32 v73, v73, v65, v64
v_fma_f32 v74, v74, v65, v64
v_fma_f32 v75, v75, v65, v64
v_fma_f32 v76, v76, v69, v68
v_fma_f32 v77, v77, v69, v68
v_fma_f32 v78, v78, v69, v68
s_add_u32 s38, s35, 6
s_and_b32 s38, s38, 15
s_mul_i32 s38, s38, 458752
s_add_u32 m0, s40, 49152
s_nop 0
buffer_load_dwordx4 v4, s[12:15], s38 offen lds
v_fma_f32 v79, v79, v69, v68
v_mul_f32 v72, v72, v136
v_mul_f32 v73, v73, v137
v_mul_f32 v74, v74, v138
v_mul_f32 v75, v75, v139
v_mul_f32 v76, v76, v160
s_add_u32 m0, s40, 50176
s_nop 0
buffer_load_dwordx4 v5, s[12:15], s38 offen lds
v_mul_f32 v77, v77, v161
v_mul_f32 v78, v78, v162
v_mul_f32 v79, v79, v163
v_exp_f32 v72, v72
v_exp_f32 v73, v73
v_exp_f32 v74, v74
s_add_u32 m0, s40, 51200
s_add_u32 s38, s38, 57344
buffer_load_dwordx4 v4, s[12:15], s38 offen lds
v_exp_f32 v75, v75
v_exp_f32 v76, v76
v_exp_f32 v77, v77
v_exp_f32 v78, v78
v_exp_f32 v79, v79
v_fma_f32 v148, -v56, v52, v148
s_add_u32 m0, s40, 52224
s_nop 0
buffer_load_dwordx4 v5, s[12:15], s38 offen lds
v_fma_f32 v149, -v56, v53, v149
v_fma_f32 v150, -v56, v54, v150
v_fma_f32 v151, -v56, v55, v151
v_fma_f32 v172, -v58, v52, v172
v_fma_f32 v173, -v58, v53, v173
v_fma_f32 v174, -v58, v54, v174
s_add_u32 m0, s40, 53248
s_add_u32 s38, s38, 57344
buffer_load_dwordx4 v4, s[12:15], s38 offen lds
v_fma_f32 v175, -v58, v55, v175
v_fma_f32 v72, v72, v66, v66
v_fma_f32 v73, v73, v66, v66
v_fma_f32 v74, v74, v66, v66
v_fma_f32 v75, v75, v66, v66
v_fma_f32 v76, v76, v70, v70
s_add_u32 m0, s40, 54272
s_nop 0
buffer_load_dwordx4 v5, s[12:15], s38 offen lds
v_fma_f32 v77, v77, v70, v70
v_fma_f32 v78, v78, v70, v70
v_fma_f32 v79, v79, v70, v70
v_rcp_f32 v72, v72
v_rcp_f32 v73, v73
v_rcp_f32 v74, v74
s_add_u32 m0, s40, 55296
s_add_u32 s38, s38, 57344
buffer_load_dwordx4 v4, s[12:15], s38 offen lds
s_add_u32 m0, s40, 56320
s_nop 0
buffer_load_dwordx4 v5, s[12:15], s38 offen lds
s_waitcnt vmcnt(13)
s_barrier
s_waitcnt lgkmcnt(0)
s_add_u32 s37, s35, 7
s_and_b32 s37, s37, 15
s_mul_i32 s37, s37, 16384
s_add_u32 m0, s39, 98304
s_nop 0
buffer_load_dwordx4 v3, s[8:11], s37 offen sc1 lds
s_load_dword s3, s[4:5], 3584
s_load_dword s3, s[4:5], 3648
s_load_dword s3, s[4:5], 3712
s_load_dword s3, s[4:5], 3776
s_load_dword s3, s[4:5], 3840
s_load_dword s3, s[4:5], 3904
s_load_dword s3, s[4:5], 3968
buffer_load_dwordx4 v3, s[8:11], s37 offen offset:1024 sc1 lds
s_load_dword s3, s[4:5], 4032
s_load_dword s3, s[4:5], 4096
s_load_dword s3, s[4:5], 4160
s_load_dword s3, s[4:5], 4224
s_load_dword s3, s[4:5], 4288
s_load_dword s3, s[4:5], 4352
s_load_dword s3, s[4:5], 4416
buffer_load_dwordx4 v3, s[8:11], s37 offen offset:2048 sc1 lds
v_rcp_f32 v75, v75
v_rcp_f32 v76, v76
v_rcp_f32 v77, v77
v_rcp_f32 v78, v78
v_rcp_f32 v79, v79
v_mul_f32 v148, v136, v148
v_mul_f32 v149, v137, v149
buffer_load_dwordx4 v3, s[8:11], s37 offen offset:3072 sc1 lds
v_mul_f32 v150, v138, v150
v_mul_f32 v151, v139, v151
v_mul_f32 v172, v160, v172
v_mul_f32 v173, v161, v173
v_mul_f32 v174, v162, v174
v_mul_f32 v175, v163, v175
v_mul_f32 v148, v148, v72
v_mul_f32 v149, v149, v73
s_add_u32 s38, s35, 7
s_and_b32 s38, s38, 15
s_mul_i32 s38, s38, 458752
s_add_u32 m0, s40, 98304
s_nop 0
buffer_load_dwordx4 v4, s[12:15], s38 offen lds
v_mul_f32 v150, v150, v74
v_mul_f32 v151, v151, v75
v_mul_f32 v172, v172, v76
v_mul_f32 v173, v173, v77
v_mul_f32 v174, v174, v78
v_mul_f32 v175, v175, v79
v_cvt_pk_bf16_f32 v80, v148, v149
s_add_u32 m0, s40, 99328
s_nop 0
buffer_load_dwordx4 v5, s[12:15], s38 offen lds
v_cvt_pk_bf16_f32 v81, v150, v151
v_cvt_pk_bf16_f32 v82, v172, v173
v_cvt_pk_bf16_f32 v83, v174, v175
s_nop 1
v_permlane32_swap_b32 v80, v82
v_permlane32_swap_b32 v81, v83
buffer_store_dwordx4 v[80:83], v84, s[24:27], s55 offen offset:0 sc1
s_add_u32 m0, s40, 100352
s_add_u32 s38, s38, 57344
buffer_load_dwordx4 v4, s[12:15], s38 offen lds
s_nop 1
v_mul_f32 v66, v61, v61
v_mul_f32 v64, 0xc0135761, v61
v_mul_f32 v65, 0xbdd2d3e8, v61
v_mul_f32 v65, v65, v66
v_rcp_f32 v66, v66
v_mul_f32 v70, v63, v63
v_mul_f32 v68, 0xc0135761, v63
s_add_u32 m0, s40, 101376
s_nop 0
buffer_load_dwordx4 v5, s[12:15], s38 offen lds
v_mul_f32 v69, 0xbdd2d3e8, v63
v_mul_f32 v69, v69, v70
v_rcp_f32 v70, v70
v_fma_f32 v176, -v60, v32, v176
v_fma_f32 v177, -v60, v33, v177
v_fma_f32 v178, -v60, v34, v178
v_fma_f32 v179, -v60, v35, v179
s_add_u32 m0, s40, 102400
s_add_u32 s38, s38, 57344
buffer_load_dwordx4 v4, s[12:15], s38 offen lds
v_fma_f32 v200, -v62, v32, v200
v_fma_f32 v201, -v62, v33, v201
v_fma_f32 v202, -v62, v34, v202
v_fma_f32 v203, -v62, v35, v203
v_mul_f32 v72, v176, v176
v_mul_f32 v73, v177, v177
v_mul_f32 v74, v178, v178
s_add_u32 m0, s40, 103424
s_nop 0
buffer_load_dwordx4 v5, s[12:15], s38 offen lds
v_mul_f32 v75, v179, v179
v_mul_f32 v76, v200, v200
v_mul_f32 v77, v201, v201
v_mul_f32 v78, v202, v202
v_mul_f32 v79, v203, v203
v_fma_f32 v72, v72, v65, v64
v_fma_f32 v73, v73, v65, v64
v_fma_f32 v74, v74, v65, v64
s_add_u32 m0, s40, 104448
s_add_u32 s38, s38, 57344
buffer_load_dwordx4 v4, s[12:15], s38 offen lds
s_add_u32 m0, s40, 105472
s_nop 0
buffer_load_dwordx4 v5, s[12:15], s38 offen lds
s_waitcnt vmcnt(13)
s_barrier
s_add_u32 s37, s35, 8
s_and_b32 s37, s37, 15
s_mul_i32 s37, s37, 16384
s_add_u32 m0, s39, 0
s_nop 0
buffer_load_dwordx4 v3, s[8:11], s37 offen sc1 lds
v_fma_f32 v75, v75, v65, v64
v_fma_f32 v76, v76, v69, v68
v_fma_f32 v77, v77, v69, v68
v_fma_f32 v78, v78, v69, v68
v_fma_f32 v79, v79, v69, v68
v_mul_f32 v72, v72, v176
buffer_load_dwordx4 v3, s[8:11], s37 offen offset:1024 sc1 lds
v_mul_f32 v73, v73, v177
v_mul_f32 v74, v74, v178
v_mul_f32 v75, v75, v179
v_mul_f32 v76, v76, v200
v_mul_f32 v77, v77, v201
v_mul_f32 v78, v78, v202
buffer_load_dwordx4 v3, s[8:11], s37 offen offset:2048 sc1 lds
v_mul_f32 v79, v79, v203
s_branch Lov_9
.p2align 12
Lst_9_0:
s_branch Lwr_149
Lst_9_1:
s_branch Lwr_160
s_nop 0
Lov_9:
v_exp_f32 v72, v72
v_exp_f32 v73, v73
v_exp_f32 v74, v74
v_exp_f32 v75, v75
v_exp_f32 v76, v76
buffer_load_dwordx4 v3, s[8:11], s37 offen offset:3072 sc1 lds
v_exp_f32 v77, v77
v_exp_f32 v78, v78
v_exp_f32 v79, v79
v_fma_f32 v188, -v60, v44, v188
v_fma_f32 v189, -v60, v45, v189
v_fma_f32 v190, -v60, v46, v190
s_add_u32 s38, s35, 8
s_and_b32 s38, s38, 15
s_mul_i32 s38, s38, 458752
s_add_u32 m0, s40, 0
s_nop 0
buffer_load_dwordx4 v4, s[12:15], s38 offen lds
v_fma_f32 v191, -v60, v47, v191
v_fma_f32 v212, -v62, v44, v212
v_fma_f32 v213, -v62, v45, v213
v_fma_f32 v214, -v62, v46, v214
v_fma_f32 v215, -v62, v47, v215
v_fma_f32 v72, v72, v66, v66
s_add_u32 m0, s40, 1024
s_nop 0
buffer_load_dwordx4 v5, s[12:15], s38 offen lds
v_fma_f32 v73, v73, v66, v66
v_fma_f32 v74, v74, v66, v66
v_fma_f32 v75, v75, v66, v66
v_fma_f32 v76, v76, v70, v70
v_fma_f32 v77, v77, v70, v70
v_fma_f32 v78, v78, v70, v70
s_add_u32 m0, s40, 2048
s_add_u32 s38, s38, 57344
buffer_load_dwordx4 v4, s[12:15], s38 offen lds
v_fma_f32 v79, v79, v70, v70
v_rcp_f32 v72, v72
v_rcp_f32 v73, v73
v_rcp_f32 v74, v74
v_rcp_f32 v75, v75
v_rcp_f32 v76, v76
s_add_u32 m0, s40, 3072
s_nop 0
buffer_load_dwordx4 v5, s[12:15], s38 offen lds
v_rcp_f32 v77, v77
v_rcp_f32 v78, v78
v_rcp_f32 v79, v79
v_mul_f32 v188, v176, v188
v_mul_f32 v189, v177, v189
v_mul_f32 v190, v178, v190
s_add_u32 m0, s40, 4096
s_add_u32 s38, s38, 57344
buffer_load_dwordx4 v4, s[12:15], s38 offen lds
v_mul_f32 v191, v179, v191
v_mul_f32 v212, v200, v212
v_mul_f32 v213, v201, v213
v_mul_f32 v214, v202, v214
v_mul_f32 v215, v203, v215
v_mul_f32 v188, v188, v72
s_add_u32 m0, s40, 5120
s_nop 0
buffer_load_dwordx4 v5, s[12:15], s38 offen lds
v_mul_f32 v189, v189, v73
v_mul_f32 v190, v190, v74
v_mul_f32 v191, v191, v75
v_mul_f32 v212, v212, v76
v_mul_f32 v213, v213, v77
v_mul_f32 v214, v214, v78
s_add_u32 m0, s40, 6144
s_add_u32 s38, s38, 57344
buffer_load_dwordx4 v4, s[12:15], s38 offen lds
s_add_u32 m0, s40, 7168
s_nop 0
buffer_load_dwordx4 v5, s[12:15], s38 offen lds
s_waitcnt vmcnt(12)
s_barrier
s_waitcnt lgkmcnt(0)
s_cmp_eq_u32 s47, 3
s_cbranch_scc0 Lw_105
s_lshl_b32 s92, s35, 7
s_add_u32 s92, s92, 28321792
s_load_dword s93, s[82:83], s92 glc
Lw_105:
s_add_u32 s37, s35, 9
s_and_b32 s37, s37, 15
s_mul_i32 s37, s37, 16384
s_add_u32 m0, s39, 49152
s_nop 0
buffer_load_dwordx4 v3, s[8:11], s37 offen sc1 lds
s_load_dword s3, s[4:5], 4480
s_load_dword s3, s[4:5], 4544
s_load_dword s3, s[4:5], 4608
s_load_dword s3, s[4:5], 4672
s_load_dword s3, s[4:5], 4736
s_load_dword s3, s[4:5], 4800
s_load_dword s3, s[4:5], 4864
buffer_load_dwordx4 v3, s[8:11], s37 offen offset:1024 sc1 lds
s_load_dword s3, s[4:5], 4928
s_load_dword s3, s[4:5], 4992
s_load_dword s3, s[4:5], 5056
s_load_dword s3, s[4:5], 5120
s_load_dword s3, s[4:5], 5184
s_load_dword s3, s[4:5], 5248
s_load_dword s3, s[4:5], 5312
buffer_load_dwordx4 v3, s[8:11], s37 offen offset:2048 sc1 lds
v_mul_f32 v215, v215, v79
v_cvt_pk_bf16_f32 v176, v188, v189
v_cvt_pk_bf16_f32 v177, v190, v191
v_cvt_pk_bf16_f32 v200, v212, v213
v_cvt_pk_bf16_f32 v201, v214, v215
v_fma_f32 v180, -v60, v36, v180
v_fma_f32 v181, -v60, v37, v181
v_fma_f32 v182, -v60, v38, v182
buffer_load_dwordx4 v3, s[8:11], s37 offen offset:3072 sc1 lds
v_fma_f32 v183, -v60, v39, v183
v_fma_f32 v204, -v62, v36, v204
v_fma_f32 v205, -v62, v37, v205
v_fma_f32 v206, -v62, v38, v206
v_fma_f32 v207, -v62, v39, v207
v_mul_f32 v72, v180, v180
v_mul_f32 v73, v181, v181
s_add_u32 s38, s35, 9
s_and_b32 s38, s38, 15
s_mul_i32 s38, s38, 458752
s_add_u32 m0, s40, 49152
s_nop 0
buffer_load_dwordx4 v4, s[12:15], s38 offen lds
v_mul_f32 v74, v182, v182
v_mul_f32 v75, v183, v183
v_mul_f32 v76, v204, v204
v_mul_f32 v77, v205, v205
v_mul_f32 v78, v206, v206
v_mul_f32 v79, v207, v207
v_fma_f32 v72, v72, v65, v64
v_fma_f32 v73, v73, v65, v64
s_add_u32 m0, s40, 50176
s_nop 0
buffer_load_dwordx4 v5, s[12:15], s38 offen lds
v_fma_f32 v74, v74, v65, v64
v_fma_f32 v75, v75, v65, v64
v_fma_f32 v76, v76, v69, v68
v_fma_f32 v77, v77, v69, v68
v_fma_f32 v78, v78, v69, v68
v_fma_f32 v79, v79, v69, v68
v_mul_f32 v72, v72, v180
s_add_u32 m0, s40, 51200
s_add_u32 s38, s38, 57344
buffer_load_dwordx4 v4, s[12:15], s38 offen lds
v_mul_f32 v73, v73, v181
v_mul_f32 v74, v74, v182
v_mul_f32 v75, v75, v183
v_mul_f32 v76, v76, v204
v_mul_f32 v77, v77, v205
v_mul_f32 v78, v78, v206
v_mul_f32 v79, v79, v207
s_add_u32 m0, s40, 52224
s_nop 0
buffer_load_dwordx4 v5, s[12:15], s38 offen lds
v_exp_f32 v72, v72
v_exp_f32 v73, v73
v_exp_f32 v74, v74
v_exp_f32 v75, v75
v_exp_f32 v76, v76
v_exp_f32 v77, v77
v_exp_f32 v78, v78
v_exp_f32 v79, v79
s_add_u32 m0, s40, 53248
s_add_u32 s38, s38, 57344
buffer_load_dwordx4 v4, s[12:15], s38 offen lds
v_fma_f32 v192, -v60, v48, v192
v_fma_f32 v193, -v60, v49, v193
v_fma_f32 v194, -v60, v50, v194
v_fma_f32 v195, -v60, v51, v195
v_fma_f32 v216, -v62, v48, v216
v_fma_f32 v217, -v62, v49, v217
v_fma_f32 v218, -v62, v50, v218
s_add_u32 m0, s40, 54272
s_nop 0
buffer_load_dwordx4 v5, s[12:15], s38 offen lds
v_fma_f32 v219, -v62, v51, v219
v_fma_f32 v72, v72, v66, v66
v_fma_f32 v73, v73, v66, v66
v_fma_f32 v74, v74, v66, v66
v_fma_f32 v75, v75, v66, v66
v_fma_f32 v76, v76, v70, v70
v_fma_f32 v77, v77, v70, v70
v_fma_f32 v78, v78, v70, v70
s_add_u32 m0, s40, 55296
s_add_u32 s38, s38, 57344
buffer_load_dwordx4 v4, s[12:15], s38 offen lds
s_add_u32 m0, s40, 56320
s_nop 0
buffer_load_dwordx4 v5, s[12:15], s38 offen lds
s_waitcnt vmcnt(12)
s_barrier
s_add_u32 s37, s35, 10
s_and_b32 s37, s37, 15
s_mul_i32 s37, s37, 16384
s_add_u32 m0, s39, 98304
s_nop 0
buffer_load_dwordx4 v3, s[8:11], s37 offen sc1 lds
v_fma_f32 v79, v79, v70, v70
v_rcp_f32 v72, v72
v_rcp_f32 v73, v73
v_rcp_f32 v74, v74
v_rcp_f32 v75, v75
v_rcp_f32 v76, v76
buffer_load_dwordx4 v3, s[8:11], s37 offen offset:1024 sc1 lds
v_rcp_f32 v77, v77
v_rcp_f32 v78, v78
v_rcp_f32 v79, v79
v_mul_f32 v192, v180, v192
v_mul_f32 v193, v181, v193
v_mul_f32 v194, v182, v194
buffer_load_dwordx4 v3, s[8:11], s37 offen offset:2048 sc1 lds
v_mul_f32 v195, v183, v195
v_mul_f32 v216, v204, v216
v_mul_f32 v217, v205, v217
v_mul_f32 v218, v206, v218
v_mul_f32 v219, v207, v219
v_mul_f32 v192, v192, v72
buffer_load_dwordx4 v3, s[8:11], s37 offen offset:3072 sc1 lds
v_mul_f32 v193, v193, v73
v_mul_f32 v194, v194, v74
v_mul_f32 v195, v195, v75
v_mul_f32 v216, v216, v76
v_mul_f32 v217, v217, v77
v_mul_f32 v218, v218, v78
s_add_u32 s38, s35, 10
s_and_b32 s38, s38, 15
s_mul_i32 s38, s38, 458752
s_add_u32 m0, s40, 98304
s_nop 0
buffer_load_dwordx4 v4, s[12:15], s38 offen lds
v_mul_f32 v219, v219, v79
v_cvt_pk_bf16_f32 v178, v192, v193
v_cvt_pk_bf16_f32 v179, v194, v195
v_cvt_pk_bf16_f32 v202, v216, v217
v_cvt_pk_bf16_f32 v203, v218, v219
buffer_store_dwordx4 v[176:179], v2, s[24:27], s54 offen offset:2048 sc1
s_add_u32 m0, s40, 99328
s_nop 0
buffer_load_dwordx4 v5, s[12:15], s38 offen lds
buffer_store_dwordx4 v[200:203], v2, s[24:27], s54 offen offset:3072 sc1
v_fma_f32 v184, -v60, v40, v184
v_fma_f32 v185, -v60, v41, v185
v_fma_f32 v186, -v60, v42, v186
v_fma_f32 v187, -v60, v43, v187
v_fma_f32 v208, -v62, v40, v208
s_add_u32 m0, s40, 100352
s_add_u32 s38, s38, 57344
buffer_load_dwordx4 v4, s[12:15], s38 offen lds
v_fma_f32 v209, -v62, v41, v209
v_fma_f32 v210, -v62, v42, v210
v_fma_f32 v211, -v62, v43, v211
v_mul_f32 v72, v184, v184
v_mul_f32 v73, v185, v185
v_mul_f32 v74, v186, v186
s_add_u32 m0, s40, 101376
s_nop 0
buffer_load_dwordx4 v5, s[12:15], s38 offen lds
v_mul_f32 v75, v187, v187
v_mul_f32 v76, v208, v208
v_mul_f32 v77, v209, v209
v_mul_f32 v78, v210, v210
v_mul_f32 v79, v211, v211
v_fma_f32 v72, v72, v65, v64
s_add_u32 m0, s40, 102400
s_add_u32 s38, s38, 57344
buffer_load_dwordx4 v4, s[12:15], s38 offen lds
v_fma_f32 v73, v73, v65, v64
v_fma_f32 v74, v74, v65, v64
v_fma_f32 v75, v75, v65, v64
v_fma_f32 v76, v76, v69, v68
v_fma_f32 v77, v77, v69, v68
v_fma_f32 v78, v78, v69, v68
s_add_u32 m0, s40, 103424
s_nop 0
buffer_load_dwordx4 v5, s[12:15], s38 offen lds
v_fma_f32 v79, v79, v69, v68
v_mul_f32 v72, v72, v184
v_mul_f32 v73, v73, v185
v_mul_f32 v74, v74, v186
v_mul_f32 v75, v75, v187
v_mul_f32 v76, v76, v208
s_add_u32 m0, s40, 104448
s_add_u32 s38, s38, 57344
buffer_load_dwordx4 v4, s[12:15], s38 offen lds
s_add_u32 m0, s40, 105472
s_nop 0
buffer_load_dwordx4 v5, s[12:15], s38 offen lds
s_waitcnt vmcnt(14)
s_cmp_eq_u32 s47, 3
s_cbranch_scc0 Lw_106
s_mov_b32 s41, 0x40000
s_branch Lpchk_109
Lpoll_107:
s_load_dword s93, s[82:83], s92 glc
Lpchk_109:
s_waitcnt lgkmcnt(0)
s_cmp_eq_u32 s93, 16
s_cbranch_scc1 Lpok_108
s_sub_u32 s41, s41, 1
s_cmp_lg_u32 s41, 0
s_cbranch_scc1 Lpoll_107
Lpok_108:
Lw_106:
s_barrier
s_lshl_b32 s60, s35, 9
s_lshl_b32 s43, s47, 7
s_add_u32 s60, s60, s43
s_add_u32 s61, s60, 14336
s_add_u32 s52, s43, 148480
s_add_u32 s53, s52, 896
v_lshrrev_b32 v104, 3, v1
v_mul_u32_u24 v104, 28672, v104
v_and_b32 v105, 7, v1
v_lshl_add_u32 v104, v105, 4, v104
s_waitcnt lgkmcnt(0)
buffer_load_dwordx4 v[96:99], v104, s[84:87], s60 offen sc1
s_load_dword s3, s[4:5], 5376
s_load_dword s3, s[4:5], 5440
s_load_dword s3, s[4:5], 5504
s_load_dword s3, s[4:5], 5568
s_load_dword s3, s[4:5], 5632
s_load_dword s3, s[4:5], 5696
buffer_load_dwordx4 v[100:103], v104, s[84:87], s61 offen sc1
s_load_dword s3, s[4:5], 5760
s_load_dword s3, s[4:5], 5824
s_load_dword s3, s[4:5], 5888
s_load_dword s3, s[4:5], 5952
s_load_dword s3, s[4:5], 6016
s_load_dword s3, s[4:5], 6080
s_load_dword s3, s[4:5], 6144
s_add_u32 s37, s35, 11
s_and_b32 s37, s37, 15
s_mul_i32 s37, s37, 16384
s_add_u32 m0, s39, 0
s_nop 0
buffer_load_dwordx4 v3, s[8:11], s37 offen sc1 lds
s_load_dword s3, s[4:5], 6208
v_mul_f32 v77, v77, v209
v_mul_f32 v78, v78, v210
v_mul_f32 v79, v79, v211
v_exp_f32 v72, v72
v_exp_f32 v73, v73
v_exp_f32 v74, v74
buffer_load_dwordx4 v3, s[8:11], s37 offen offset:1024 sc1 lds
v_exp_f32 v75, v75
v_exp_f32 v76, v76
v_exp_f32 v77, v77
v_exp_f32 v78, v78
v_exp_f32 v79, v79
v_fma_f32 v196, -v60, v52, v196
v_fma_f32 v197, -v60, v53, v197
buffer_load_dwordx4 v3, s[8:11], s37 offen offset:2048 sc1 lds
v_fma_f32 v198, -v60, v54, v198
v_fma_f32 v199, -v60, v55, v199
v_fma_f32 v220, -v62, v52, v220
v_fma_f32 v221, -v62, v53, v221
v_fma_f32 v222, -v62, v54, v222
v_fma_f32 v223, -v62, v55, v223
buffer_load_dwordx4 v3, s[8:11], s37 offen offset:3072 sc1 lds
v_fma_f32 v72, v72, v66, v66
v_fma_f32 v73, v73, v66, v66
v_fma_f32 v74, v74, v66, v66
v_fma_f32 v75, v75, v66, v66
v_fma_f32 v76, v76, v70, v70
v_fma_f32 v77, v77, v70, v70
v_fma_f32 v78, v78, v70, v70
s_add_u32 s38, s35, 11
s_and_b32 s38, s38, 15
s_mul_i32 s38, s38, 458752
s_add_u32 m0, s40, 0
s_nop 0
buffer_load_dwordx4 v4, s[12:15], s38 offen lds
v_fma_f32 v79, v79, v70, v70
v_rcp_f32 v72, v72
v_rcp_f32 v73, v73
v_rcp_f32 v74, v74
v_rcp_f32 v75, v75
v_rcp_f32 v76, v76
v_rcp_f32 v77, v77
s_add_u32 m0, s40, 1024
s_nop 0
buffer_load_dwordx4 v5, s[12:15], s38 offen lds
v_rcp_f32 v78, v78
v_rcp_f32 v79, v79
v_mul_f32 v196, v184, v196
v_mul_f32 v197, v185, v197
v_mul_f32 v198, v186, v198
v_mul_f32 v199, v187, v199
v_mul_f32 v220, v208, v220
s_add_u32 m0, s40, 2048
s_add_u32 s38, s38, 57344
buffer_load_dwordx4 v4, s[12:15], s38 offen lds
v_mul_f32 v221, v209, v221
v_mul_f32 v222, v210, v222
v_mul_f32 v223, v211, v223
v_mul_f32 v196, v196, v72
v_mul_f32 v197, v197, v73
v_mul_f32 v198, v198, v74
s_add_u32 m0, s40, 3072
s_nop 0
buffer_load_dwordx4 v5, s[12:15], s38 offen lds
v_mul_f32 v199, v199, v75
v_mul_f32 v220, v220, v76
v_mul_f32 v221, v221, v77
v_mul_f32 v222, v222, v78
v_mul_f32 v223, v223, v79
v_cvt_pk_bf16_f32 v80, v196, v197
v_cvt_pk_bf16_f32 v81, v198, v199
s_add_u32 m0, s40, 4096
s_add_u32 s38, s38, 57344
buffer_load_dwordx4 v4, s[12:15], s38 offen lds
v_cvt_pk_bf16_f32 v82, v220, v221
v_cvt_pk_bf16_f32 v83, v222, v223
s_nop 1
v_permlane32_swap_b32 v80, v82
v_permlane32_swap_b32 v81, v83
buffer_store_dwordx4 v[80:83], v84, s[24:27], s55 offen offset:2048 sc1
s_nop 1
s_add_u32 m0, s40, 5120
s_nop 0
buffer_load_dwordx4 v5, s[12:15], s38 offen lds
v_cmp_gt_u32 vcc, 32, v1
v_mov_b32 v104, s52
v_mov_b32 v106, s53
v_cndmask_b32 v104, v106, v104, vcc
v_lshl_add_u32 v104, v105, 4, v104
v_bfe_u32 v105, v1, 4, 1
v_lshl_add_u32 v104, v105, 2, v104
s_add_u32 m0, s40, 6144
s_add_u32 s38, s38, 57344
buffer_load_dwordx4 v4, s[12:15], s38 offen lds
s_add_u32 m0, s40, 7168
s_nop 0
buffer_load_dwordx4 v5, s[12:15], s38 offen lds
s_waitcnt vmcnt(15)
s_barrier
s_add_u32 s37, s35, 12
s_and_b32 s37, s37, 15
s_mul_i32 s37, s37, 16384
s_add_u32 m0, s39, 49152
s_nop 0
buffer_load_dwordx4 v3, s[8:11], s37 offen sc1 lds
buffer_load_dwordx4 v3, s[8:11], s37 offen offset:1024 sc1 lds
buffer_load_dwordx4 v3, s[8:11], s37 offen offset:2048 sc1 lds
buffer_load_dwordx4 v3, s[8:11], s37 offen offset:3072 sc1 lds
s_add_u32 s38, s35, 12
s_and_b32 s38, s38, 15
s_mul_i32 s38, s38, 458752
s_add_u32 m0, s40, 49152
s_nop 0
buffer_load_dwordx4 v4, s[12:15], s38 offen lds
s_add_u32 m0, s40, 50176
s_nop 0
buffer_load_dwordx4 v5, s[12:15], s38 offen lds
s_add_u32 m0, s40, 51200
s_add_u32 s38, s38, 57344
buffer_load_dwordx4 v4, s[12:15], s38 offen lds
s_add_u32 m0, s40, 52224
s_nop 0
buffer_load_dwordx4 v5, s[12:15], s38 offen lds
s_add_u32 m0, s40, 53248
s_add_u32 s38, s38, 57344
buffer_load_dwordx4 v4, s[12:15], s38 offen lds
s_add_u32 m0, s40, 54272
s_nop 0
buffer_load_dwordx4 v5, s[12:15], s38 offen lds
s_add_u32 m0, s40, 55296
s_add_u32 s38, s38, 57344
buffer_load_dwordx4 v4, s[12:15], s38 offen lds
s_add_u32 m0, s40, 56320
s_nop 0
buffer_load_dwordx4 v5, s[12:15], s38 offen lds
s_waitcnt vmcnt(12)
s_barrier
s_cmp_eq_u32 s47, 0
s_cbranch_scc0 Lw_110
s_add_u32 s7, s34, 32
s_lshl_b32 s7, s7, 7
v_mov_b32 v28, s7
v_mov_b32 v29, 1
s_mov_b64 exec, 1
buffer_atomic_add v29, v28, s[56:59], 0 offen sc1
s_mov_b64 exec, -1
Lw_110:
v_permlane32_swap_b32 v96, v100
v_permlane32_swap_b32 v97, v101
v_permlane32_swap_b32 v98, v102
v_permlane32_swap_b32 v99, v103
v_add_f32 v96, v96, v100
v_add_f32 v97, v97, v101
v_add_f32 v98, v98, v102
v_add_f32 v99, v99, v103
s_nop 1
v_permlane16_swap_b32 v96, v97
v_permlane16_swap_b32 v98, v99
v_add_f32 v96, v96, v97
v_add_f32 v98, v98, v99
s_nop 1
v_add_f32_dpp v96, v96, v96 row_ror:8 row_mask:0xf bank_mask:0xf
v_add_f32_dpp v98, v98, v98 row_ror:8 row_mask:0xf bank_mask:0xf
ds_write_b32 v104, v96
ds_write_b32 v104, v98 offset:8
s_waitcnt lgkmcnt(0)
s_add_u32 s37, s35, 13
s_and_b32 s37, s37, 15
s_mul_i32 s37, s37, 16384
s_add_u32 m0, s39, 98304
s_nop 0
buffer_load_dwordx4 v3, s[8:11], s37 offen sc1 lds
s_load_dword s3, s[4:5], 6272
s_load_dword s3, s[4:5], 6336
s_load_dword s3, s[4:5], 6400
s_load_dword s3, s[4:5], 6464
s_load_dword s3, s[4:5], 6528
s_load_dword s3, s[4:5], 6592
buffer_load_dwordx4 v3, s[8:11], s37 offen offset:1024 sc1 lds
s_load_dword s3, s[4:5], 6656
s_load_dword s3, s[4:5], 6720
s_load_dword s3, s[4:5], 6784
s_load_dword s3, s[4:5], 6848
s_load_dword s3, s[4:5], 6912
s_load_dword s3, s[4:5], 6976
buffer_load_dwordx4 v3, s[8:11], s37 offen offset:2048 sc1 lds
s_load_dword s3, s[4:5], 7040
s_load_dword s3, s[4:5], 7104
s_bfe_u32 s61, s35, 0x10002
s_lshr_b32 s60, s35, 3
s_lshl_b32 s60, s60, 2
s_and_b32 s43, s35, 3
buffer_load_dwordx4 v3, s[8:11], s37 offen offset:3072 sc1 lds
s_add_u32 s60, s60, s43
s_lshl_b32 s43, s60, 8
s_add_u32 s28, s76, s43
s_addc_u32 s29, s77, 0
s_mov_b32 s30, 7338240
s_mov_b32 s31, 0x20000
s_mul_i32 s52, s61, 196608
s_add_u32 s38, s35, 13
s_and_b32 s38, s38, 15
s_mul_i32 s38, s38, 458752
s_add_u32 m0, s40, 98304
s_nop 0
buffer_load_dwordx4 v4, s[12:15], s38 offen lds
s_mul_i32 s53, s61, 1572864
s_mul_i32 s90, s61, 163840
s_mul_i32 s91, s61, 1310720
s_lshl_b32 s51, s47, 11
s_lshl_b32 s44, s47, 15
v_lshrrev_b32 v122, 4, v1
s_add_u32 m0, s40, 99328
s_nop 0
buffer_load_dwordx4 v5, s[12:15], s38 offen lds
v_lshlrev_b32 v123, 1, v122
v_and_b32 v23, 15, v1
v_xor_b32 v23, v23, v123
v_lshlrev_b32 v23, 4, v23
v_mul_u32_u24 v122, 2048, v122
v_add_u32 v23, v23, v122
s_add_u32 m0, s40, 100352
s_add_u32 s38, s38, 57344
buffer_load_dwordx4 v4, s[12:15], s38 offen lds
v_add_u32 v23, s44, v23
v_xor_b32 v24, 128, v23
v_add_u32 v24, 8192, v24
s_lshl_b32 s43, s60, 2
s_lshl_b32 s44, s61, 1
s_add_u32 s43, s43, s44
s_add_u32 s43, s43, s63
s_add_u32 m0, s40, 101376
s_nop 0
buffer_load_dwordx4 v5, s[12:15], s38 offen lds
s_lshl_b32 s43, s43, 13
s_lshl_b32 s44, s62, 12
s_add_u32 s50, s43, s44
v_add_u32 v6, s44, v2
v_add_u32 v7, 0x10000, v6
v_add_u32 v8, 0x20000, v6
s_add_u32 m0, s40, 102400
s_add_u32 s38, s38, 57344
buffer_load_dwordx4 v4, s[12:15], s38 offen lds
v_lshrrev_b32 v122, 2, v1
v_and_b32 v123, 7, v122
v_mul_u32_u24 v122, 256, v122
v_lshl_add_u32 v122, v123, 5, v122
v_and_b32 v123, 3, v1
v_lshl_add_u32 v9, v123, 3, v122
s_add_u32 m0, s40, 103424
s_nop 0
buffer_load_dwordx4 v5, s[12:15], s38 offen lds
s_lshl_b32 s43, s61, 7
s_lshl_b32 s44, s63, 6
s_add_u32 s43, s43, s44
v_xor_b32 v9, s43, v9
v_xor_b32 v10, 32, v9
v_xor_b32 v11, 128, v9
v_xor_b32 v12, 128, v10
s_add_u32 m0, s40, 104448
s_add_u32 s38, s38, 57344
buffer_load_dwordx4 v4, s[12:15], s38 offen lds
s_add_u32 m0, s40, 105472
s_nop 0
buffer_load_dwordx4 v5, s[12:15], s38 offen lds
s_waitcnt vmcnt(12)
s_barrier
buffer_load_dwordx4 v[160:163], v2, s[8:11], s50 offen offset:0 sc1
v_add_u32 v13, 65536, v9
v_add_u32 v14, 65536, v10
v_add_u32 v15, 65536, v11
buffer_load_dwordx4 v[164:167], v2, s[8:11], s50 offen offset:1024 sc1
v_add_u32 v16, 65536, v12
v_add_u32 v25, 131072, v9
v_add_u32 v26, 131072, v10
v_add_u32 v27, 131072, v11
buffer_load_dwordx4 v[168:171], v2, s[8:11], s50 offen offset:2048 sc1
v_add_u32 v28, 131072, v12
v_lshrrev_b32 v122, 2, v1
v_bfe_u32 v123, v122, 1, 2
buffer_load_dwordx4 v[172:175], v2, s[8:11], s50 offen offset:3072 sc1
v_mul_u32_u24 v122, 128, v122
v_lshl_add_u32 v122, v123, 5, v122
v_and_b32 v123, 3, v1
v_lshl_add_u32 v224, v123, 3, v122
s_add_u32 s37, s35, 14
s_and_b32 s37, s37, 15
s_mul_i32 s37, s37, 16384
s_add_u32 m0, s39, 0
s_nop 0
buffer_load_dwordx4 v3, s[8:11], s37 offen sc1 lds
v_xor_b32 v224, s44, v224
v_xor_b32 v225, 32, v224
v_add_u32 v226, 65536, v224
buffer_load_dwordx4 v3, s[8:11], s37 offen offset:1024 sc1 lds
v_add_u32 v227, 65536, v225
v_add_u32 v228, 131072, v224
v_add_u32 v229, 131072, v225
s_add_u32 s84, s82, 33554432
buffer_load_dwordx4 v3, s[8:11], s37 offen offset:2048 sc1 lds
s_addc_u32 s85, s83, 0
s_mov_b32 s86, 4194304
s_mov_b32 s87, 0x20000
s_xor_b32 s43, s2, 2
buffer_load_dwordx4 v3, s[8:11], s37 offen offset:3072 sc1 lds
s_lshl_b32 s44, s43, 2
s_add_u32 s44, s44, s47
s_lshl_b32 s45, s44, 12
s_add_u32 s38, s35, 14
s_and_b32 s38, s38, 15
s_mul_i32 s38, s38, 458752
s_add_u32 m0, s40, 0
s_nop 0
buffer_load_dwordx4 v4, s[12:15], s38 offen lds
s_lshl_b32 s46, s2, 2
s_add_u32 s46, s46, s47
s_lshl_b32 s46, s46, 12
s_lshl_b32 s43, s34, 18
s_add_u32 m0, s40, 1024
s_nop 0
buffer_load_dwordx4 v5, s[12:15], s38 offen lds
s_lshl_b32 s42, s60, 8
s_add_u32 s43, s43, s42
s_lshl_b32 s42, s61, 7
s_add_u32 m0, s40, 2048
s_add_u32 s38, s38, 57344
buffer_load_dwordx4 v4, s[12:15], s38 offen lds
s_add_u32 s43, s43, s42
s_branch Lov_10
.p2align 12
Lst_10_0:
s_branch Lwr_150
Lst_10_1:
s_branch Lwr_161
s_nop 0
Lov_10:
s_lshl_b32 s42, s63, 6
s_add_u32 s43, s43, s42
s_add_u32 s20, s78, s43
s_add_u32 m0, s40, 3072
s_nop 0
buffer_load_dwordx4 v5, s[12:15], s38 offen lds
s_addc_u32 s21, s79, 0
s_mov_b32 s22, 260160
s_mov_b32 s23, 0x20000
s_add_u32 m0, s40, 4096
s_add_u32 s38, s38, 57344
buffer_load_dwordx4 v4, s[12:15], s38 offen lds
v_and_b32 v230, 15, v1
v_lshlrev_b32 v230, 12, v230
v_bfe_u32 v231, v1, 4, 1
v_lshl_add_u32 v230, v231, 5, v230
s_add_u32 m0, s40, 5120
s_nop 0
buffer_load_dwordx4 v5, s[12:15], s38 offen lds
v_bfe_u32 v231, v1, 5, 1
v_lshl_add_u32 v230, v231, 4, v230
s_lshl_b32 s54, s62, 17
s_add_u32 s55, s54, 65536
s_add_u32 m0, s40, 6144
s_add_u32 s38, s38, 57344
buffer_load_dwordx4 v4, s[12:15], s38 offen lds
s_add_u32 m0, s40, 7168
s_nop 0
buffer_load_dwordx4 v5, s[12:15], s38 offen lds
s_waitcnt vmcnt(16)
s_barrier
s_cmp_eq_u32 s47, 3
s_cbranch_scc0 Lw_111
s_lshl_b32 s92, s34, 7
s_add_u32 s92, s92, 28315648
s_load_dword s93, s[82:83], s92 glc
Lw_111:
s_add_u32 s37, s35, 15
s_and_b32 s37, s37, 15
s_mul_i32 s37, s37, 16384
s_add_u32 m0, s39, 49152
s_nop 0
buffer_load_dwordx4 v3, s[8:11], s37 offen sc1 lds
buffer_load_dwordx4 v3, s[8:11], s37 offen offset:1024 sc1 lds
buffer_load_dwordx4 v3, s[8:11], s37 offen offset:2048 sc1 lds
buffer_load_dwordx4 v3, s[8:11], s37 offen offset:3072 sc1 lds
s_add_u32 s38, s35, 15
s_and_b32 s38, s38, 15
s_mul_i32 s38, s38, 458752
s_add_u32 m0, s40, 49152
s_nop 0
buffer_load_dwordx4 v4, s[12:15], s38 offen lds
s_add_u32 m0, s40, 50176
s_nop 0
buffer_load_dwordx4 v5, s[12:15], s38 offen lds
s_add_u32 m0, s40, 51200
s_add_u32 s38, s38, 57344
buffer_load_dwordx4 v4, s[12:15], s38 offen lds
s_add_u32 m0, s40, 52224
s_nop 0
buffer_load_dwordx4 v5, s[12:15], s38 offen lds
s_add_u32 m0, s40, 53248
s_add_u32 s38, s38, 57344
buffer_load_dwordx4 v4, s[12:15], s38 offen lds
s_add_u32 m0, s40, 54272
s_nop 0
buffer_load_dwordx4 v5, s[12:15], s38 offen lds
s_add_u32 m0, s40, 55296
s_add_u32 s38, s38, 57344
buffer_load_dwordx4 v4, s[12:15], s38 offen lds
s_add_u32 m0, s40, 56320
s_nop 0
buffer_load_dwordx4 v5, s[12:15], s38 offen lds
s_waitcnt vmcnt(12)
s_cmp_eq_u32 s47, 3
s_cbranch_scc0 Lw_112
s_mov_b32 s41, 0x40000
s_branch Lpchk_115
Lpoll_113:
s_load_dword s93, s[82:83], s92 glc
Lpchk_115:
s_waitcnt lgkmcnt(0)
s_cmp_eq_u32 s93, 16
s_cbranch_scc1 Lpok_114
s_sub_u32 s41, s41, 1
s_cmp_lg_u32 s41, 0
s_cbranch_scc1 Lpoll_113
Lpok_114:
Lw_112:
s_barrier
s_add_u32 m0, s39, 98304
s_add_u32 s37, s52, 524288
buffer_load_dwordx4 v3, s[24:27], s37 offen sc1 lds
v_lshlrev_b32 v128, 16, v160
v_and_b32 v129, 0xffff0000, v160
v_lshlrev_b32 v130, 16, v161
v_and_b32 v131, 0xffff0000, v161
v_lshlrev_b32 v132, 16, v162
buffer_load_dwordx4 v3, s[24:27], s37 offen offset:1024 sc1 lds
v_and_b32 v133, 0xffff0000, v162
v_lshlrev_b32 v134, 16, v163
v_and_b32 v135, 0xffff0000, v163
v_lshlrev_b32 v136, 16, v164
v_and_b32 v137, 0xffff0000, v164
buffer_load_dwordx4 v3, s[24:27], s37 offen offset:2048 sc1 lds
v_lshlrev_b32 v138, 16, v165
v_and_b32 v139, 0xffff0000, v165
v_lshlrev_b32 v140, 16, v166
v_and_b32 v141, 0xffff0000, v166
v_lshlrev_b32 v142, 16, v167
v_and_b32 v143, 0xffff0000, v167
buffer_load_dwordx4 v3, s[24:27], s37 offen offset:3072 sc1 lds
v_lshlrev_b32 v144, 16, v168
v_and_b32 v145, 0xffff0000, v168
v_lshlrev_b32 v146, 16, v169
v_and_b32 v147, 0xffff0000, v169
v_lshlrev_b32 v148, 16, v170
s_add_u32 m0, s39, 114688
s_add_u32 s38, s53, 4194304
buffer_load_dwordx4 v23, s[28:31], s38 offen lds
v_and_b32 v149, 0xffff0000, v170
v_lshlrev_b32 v150, 16, v171
v_and_b32 v151, 0xffff0000, v171
v_lshlrev_b32 v152, 16, v172
v_and_b32 v153, 0xffff0000, v172
s_add_u32 m0, s39, 115712
s_add_u32 s38, s53, 4194304
buffer_load_dwordx4 v24, s[28:31], s38 offen lds
v_lshlrev_b32 v154, 16, v173
v_and_b32 v155, 0xffff0000, v173
v_lshlrev_b32 v156, 16, v174
v_and_b32 v157, 0xffff0000, v174
v_lshlrev_b32 v158, 16, v175
v_and_b32 v159, 0xffff0000, v175
s_add_u32 m0, s39, 116736
s_add_u32 s38, s53, 4210688
buffer_load_dwordx4 v23, s[28:31], s38 offen lds
s_add_u32 m0, s39, 117760
s_add_u32 s38, s53, 4210688
buffer_load_dwordx4 v24, s[28:31], s38 offen lds
s_waitcnt vmcnt(8)
s_barrier
s_add_u32 m0, s39, 131072
s_add_u32 s37, s52, 540672
buffer_load_dwordx4 v3, s[24:27], s37 offen sc1 lds
buffer_load_dwordx4 v3, s[24:27], s37 offen offset:1024 sc1 lds
buffer_load_dwordx4 v3, s[24:27], s37 offen offset:2048 sc1 lds
buffer_load_dwordx4 v3, s[24:27], s37 offen offset:3072 sc1 lds
s_add_u32 m0, s39, 0
s_add_u32 s38, s53, 4325376
buffer_load_dwordx4 v23, s[28:31], s38 offen lds
s_add_u32 m0, s39, 1024
s_add_u32 s38, s53, 4325376
buffer_load_dwordx4 v24, s[28:31], s38 offen lds
s_add_u32 m0, s39, 2048
s_add_u32 s38, s53, 4341760
buffer_load_dwordx4 v23, s[28:31], s38 offen lds
s_add_u32 m0, s39, 3072
s_add_u32 s38, s53, 4341760
buffer_load_dwordx4 v24, s[28:31], s38 offen lds
s_add_u32 m0, s39, 16384
s_add_u32 s37, s52, 557056
buffer_load_dwordx4 v3, s[24:27], s37 offen sc1 lds
buffer_load_dwordx4 v3, s[24:27], s37 offen offset:1024 sc1 lds
buffer_load_dwordx4 v3, s[24:27], s37 offen offset:2048 sc1 lds
buffer_load_dwordx4 v3, s[24:27], s37 offen offset:3072 sc1 lds
s_add_u32 m0, s39, 32768
s_add_u32 s38, s53, 4456448
buffer_load_dwordx4 v23, s[28:31], s38 offen lds
s_add_u32 m0, s39, 33792
s_add_u32 s38, s53, 4456448
buffer_load_dwordx4 v24, s[28:31], s38 offen lds
s_add_u32 m0, s39, 34816
s_add_u32 s38, s53, 4472832
buffer_load_dwordx4 v23, s[28:31], s38 offen lds
s_add_u32 m0, s39, 35840
s_add_u32 s38, s53, 4472832
buffer_load_dwordx4 v24, s[28:31], s38 offen lds
s_waitcnt vmcnt(16)
s_barrier
ds_read_b128 v[32:35], v7 offset:32768
ds_read_b64_tr_b16 v[48:49], v13 offset:49152
ds_read_b64_tr_b16 v[50:51], v13 offset:53248
ds_read_b64_tr_b16 v[52:53], v14 offset:49152
ds_read_b64_tr_b16 v[54:55], v14 offset:53248
ds_read_b64_tr_b16 v[56:57], v15 offset:49152
ds_read_b64_tr_b16 v[58:59], v15 offset:53248
ds_read_b64_tr_b16 v[60:61], v16 offset:49152
ds_read_b64_tr_b16 v[62:63], v16 offset:53248
ds_read_b128 v[36:39], v7 offset:33792
ds_read_b128 v[40:43], v7 offset:34816
ds_read_b128 v[44:47], v7 offset:35840
ds_read_b128 v[64:67], v7 offset:40960
ds_read_b64_tr_b16 v[80:81], v13 offset:57344
ds_read_b64_tr_b16 v[82:83], v13 offset:61440
ds_read_b64_tr_b16 v[84:85], v14 offset:57344
ds_read_b64_tr_b16 v[86:87], v14 offset:61440
ds_read_b64_tr_b16 v[88:89], v15 offset:57344
ds_read_b64_tr_b16 v[90:91], v15 offset:61440
ds_read_b64_tr_b16 v[92:93], v16 offset:57344
ds_read_b64_tr_b16 v[94:95], v16 offset:61440
ds_read_b128 v[68:71], v7 offset:41984
ds_read_b128 v[72:75], v7 offset:43008
ds_read_b128 v[76:79], v7 offset:44032
s_add_u32 m0, s39, 49152
s_add_u32 s37, s52, 573440
buffer_load_dwordx4 v3, s[24:27], s37 offen sc1 lds
buffer_load_dwordx4 v3, s[24:27], s37 offen offset:1024 sc1 lds
buffer_load_dwordx4 v3, s[24:27], s37 offen offset:2048 sc1 lds
buffer_load_dwordx4 v3, s[24:27], s37 offen offset:3072 sc1 lds
s_add_u32 m0, s39, 65536
s_add_u32 s38, s53, 4587520
buffer_load_dwordx4 v23, s[28:31], s38 offen lds
s_add_u32 m0, s39, 66560
s_add_u32 s38, s53, 4587520
buffer_load_dwordx4 v24, s[28:31], s38 offen lds
s_add_u32 m0, s39, 67584
s_add_u32 s38, s53, 4603904
buffer_load_dwordx4 v23, s[28:31], s38 offen lds
s_add_u32 m0, s39, 68608
s_add_u32 s38, s53, 4603904
buffer_load_dwordx4 v24, s[28:31], s38 offen lds
s_waitcnt vmcnt(16)
s_waitcnt lgkmcnt(0)
s_barrier
v_mfma_f32_16x16x32_bf16 v[128:131], v[48:51], v[32:35], v[128:131]
ds_read_b128 v[96:99], v8 offset:0
v_mfma_f32_16x16x32_bf16 v[132:135], v[52:55], v[32:35], v[132:135]
ds_read_b64_tr_b16 v[112:113], v9 offset:0
v_mfma_f32_16x16x32_bf16 v[160:163], v[56:59], v[32:35], 0
ds_read_b64_tr_b16 v[114:115], v9 offset:4096
v_mfma_f32_16x16x32_bf16 v[164:167], v[60:63], v[32:35], 0
ds_read_b64_tr_b16 v[116:117], v10 offset:0
v_mfma_f32_16x16x32_bf16 v[172:175], v[60:63], v[36:39], 0
ds_read_b64_tr_b16 v[118:119], v10 offset:4096
v_mfma_f32_16x16x32_bf16 v[168:171], v[56:59], v[36:39], 0
ds_read_b64_tr_b16 v[120:121], v11 offset:0
v_mfma_f32_16x16x32_bf16 v[140:143], v[52:55], v[36:39], v[140:143]
ds_read_b64_tr_b16 v[122:123], v11 offset:4096
v_mfma_f32_16x16x32_bf16 v[136:139], v[48:51], v[36:39], v[136:139]
ds_read_b64_tr_b16 v[124:125], v12 offset:0
v_mfma_f32_16x16x32_bf16 v[144:147], v[48:51], v[40:43], v[144:147]
ds_read_b64_tr_b16 v[126:127], v12 offset:4096
v_mfma_f32_16x16x32_bf16 v[148:151], v[52:55], v[40:43], v[148:151]
ds_read_b128 v[100:103], v8 offset:1024
v_mfma_f32_16x16x32_bf16 v[176:179], v[56:59], v[40:43], 0
ds_read_b128 v[104:107], v8 offset:2048
v_mfma_f32_16x16x32_bf16 v[180:183], v[60:63], v[40:43], 0
ds_read_b128 v[108:111], v8 offset:3072
v_mfma_f32_16x16x32_bf16 v[188:191], v[60:63], v[44:47], 0
ds_read_b128 v[192:195], v8 offset:8192
v_mfma_f32_16x16x32_bf16 v[184:187], v[56:59], v[44:47], 0
ds_read_b64_tr_b16 v[208:209], v9 offset:8192
v_mfma_f32_16x16x32_bf16 v[156:159], v[52:55], v[44:47], v[156:159]
ds_read_b64_tr_b16 v[210:211], v9 offset:12288
v_mfma_f32_16x16x32_bf16 v[152:155], v[48:51], v[44:47], v[152:155]
ds_read_b64_tr_b16 v[212:213], v10 offset:8192
v_mfma_f32_16x16x32_bf16 v[128:131], v[80:83], v[64:67], v[128:131]
ds_read_b64_tr_b16 v[214:215], v10 offset:12288
v_mfma_f32_16x16x32_bf16 v[132:135], v[84:87], v[64:67], v[132:135]
ds_read_b64_tr_b16 v[216:217], v11 offset:8192
v_mfma_f32_16x16x32_bf16 v[160:163], v[88:91], v[64:67], v[160:163]
ds_read_b64_tr_b16 v[218:219], v11 offset:12288
v_mfma_f32_16x16x32_bf16 v[164:167], v[92:95], v[64:67], v[164:167]
ds_read_b64_tr_b16 v[220:221], v12 offset:8192
v_mfma_f32_16x16x32_bf16 v[172:175], v[92:95], v[68:71], v[172:175]
ds_read_b64_tr_b16 v[222:223], v12 offset:12288
v_mfma_f32_16x16x32_bf16 v[168:171], v[88:91], v[68:71], v[168:171]
ds_read_b128 v[196:199], v8 offset:9216
v_mfma_f32_16x16x32_bf16 v[140:143], v[84:87], v[68:71], v[140:143]
ds_read_b128 v[200:203], v8 offset:10240
v_mfma_f32_16x16x32_bf16 v[136:139], v[80:83], v[68:71], v[136:139]
ds_read_b128 v[204:207], v8 offset:11264
v_mfma_f32_16x16x32_bf16 v[144:147], v[80:83], v[72:75], v[144:147]
v_mfma_f32_16x16x32_bf16 v[148:151], v[84:87], v[72:75], v[148:151]
v_mfma_f32_16x16x32_bf16 v[176:179], v[88:91], v[72:75], v[176:179]
v_mfma_f32_16x16x32_bf16 v[180:183], v[92:95], v[72:75], v[180:183]
v_mfma_f32_16x16x32_bf16 v[188:191], v[92:95], v[76:79], v[188:191]
v_mfma_f32_16x16x32_bf16 v[184:187], v[88:91], v[76:79], v[184:187]
v_mfma_f32_16x16x32_bf16 v[156:159], v[84:87], v[76:79], v[156:159]
v_mfma_f32_16x16x32_bf16 v[152:155], v[80:83], v[76:79], v[152:155]
s_mov_b32 s41, 2
Lk4_116:
s_waitcnt vmcnt(8)
s_waitcnt lgkmcnt(0)
s_barrier
v_mfma_f32_16x16x32_bf16 v[128:131], v[112:115], v[96:99], v[128:131]
ds_read_b128 v[32:35], v6 offset:16384
v_mfma_f32_16x16x32_bf16 v[132:135], v[116:119], v[96:99], v[132:135]
ds_read_b64_tr_b16 v[48:49], v9 offset:32768
v_mfma_f32_16x16x32_bf16 v[160:163], v[120:123], v[96:99], v[160:163]
ds_read_b64_tr_b16 v[50:51], v9 offset:36864
v_mfma_f32_16x16x32_bf16 v[164:167], v[124:127], v[96:99], v[164:167]
ds_read_b64_tr_b16 v[52:53], v10 offset:32768
v_mfma_f32_16x16x32_bf16 v[172:175], v[124:127], v[100:103], v[172:175]
ds_read_b64_tr_b16 v[54:55], v10 offset:36864
v_mfma_f32_16x16x32_bf16 v[168:171], v[120:123], v[100:103], v[168:171]
ds_read_b64_tr_b16 v[56:57], v11 offset:32768
v_mfma_f32_16x16x32_bf16 v[140:143], v[116:119], v[100:103], v[140:143]
ds_read_b64_tr_b16 v[58:59], v11 offset:36864
v_mfma_f32_16x16x32_bf16 v[136:139], v[112:115], v[100:103], v[136:139]
ds_read_b64_tr_b16 v[60:61], v12 offset:32768
v_mfma_f32_16x16x32_bf16 v[144:147], v[112:115], v[104:107], v[144:147]
ds_read_b64_tr_b16 v[62:63], v12 offset:36864
v_mfma_f32_16x16x32_bf16 v[148:151], v[116:119], v[104:107], v[148:151]
ds_read_b128 v[36:39], v6 offset:17408
v_mfma_f32_16x16x32_bf16 v[176:179], v[120:123], v[104:107], v[176:179]
ds_read_b128 v[40:43], v6 offset:18432
v_mfma_f32_16x16x32_bf16 v[180:183], v[124:127], v[104:107], v[180:183]
ds_read_b128 v[44:47], v6 offset:19456
v_mfma_f32_16x16x32_bf16 v[188:191], v[124:127], v[108:111], v[188:191]
ds_read_b128 v[64:67], v6 offset:24576
v_mfma_f32_16x16x32_bf16 v[184:187], v[120:123], v[108:111], v[184:187]
ds_read_b64_tr_b16 v[80:81], v9 offset:40960
v_mfma_f32_16x16x32_bf16 v[156:159], v[116:119], v[108:111], v[156:159]
ds_read_b64_tr_b16 v[82:83], v9 offset:45056
v_mfma_f32_16x16x32_bf16 v[152:155], v[112:115], v[108:111], v[152:155]
ds_read_b64_tr_b16 v[84:85], v10 offset:40960
v_mfma_f32_16x16x32_bf16 v[128:131], v[208:211], v[192:195], v[128:131]
ds_read_b64_tr_b16 v[86:87], v10 offset:45056
v_mfma_f32_16x16x32_bf16 v[132:135], v[212:215], v[192:195], v[132:135]
ds_read_b64_tr_b16 v[88:89], v11 offset:40960
v_mfma_f32_16x16x32_bf16 v[160:163], v[216:219], v[192:195], v[160:163]
ds_read_b64_tr_b16 v[90:91], v11 offset:45056
v_mfma_f32_16x16x32_bf16 v[164:167], v[220:223], v[192:195], v[164:167]
ds_read_b64_tr_b16 v[92:93], v12 offset:40960
v_mfma_f32_16x16x32_bf16 v[172:175], v[220:223], v[196:199], v[172:175]
ds_read_b64_tr_b16 v[94:95], v12 offset:45056
v_mfma_f32_16x16x32_bf16 v[168:171], v[216:219], v[196:199], v[168:171]
ds_read_b128 v[68:71], v6 offset:25600
v_mfma_f32_16x16x32_bf16 v[140:143], v[212:215], v[196:199], v[140:143]
ds_read_b128 v[72:75], v6 offset:26624
v_mfma_f32_16x16x32_bf16 v[136:139], v[208:211], v[196:199], v[136:139]
ds_read_b128 v[76:79], v6 offset:27648
v_mfma_f32_16x16x32_bf16 v[144:147], v[208:211], v[200:203], v[144:147]
v_mfma_f32_16x16x32_bf16 v[148:151], v[212:215], v[200:203], v[148:151]
v_mfma_f32_16x16x32_bf16 v[176:179], v[216:219], v[200:203], v[176:179]
v_mfma_f32_16x16x32_bf16 v[180:183], v[220:223], v[200:203], v[180:183]
v_mfma_f32_16x16x32_bf16 v[188:191], v[220:223], v[204:207], v[188:191]
v_mfma_f32_16x16x32_bf16 v[184:187], v[216:219], v[204:207], v[184:187]
v_mfma_f32_16x16x32_bf16 v[156:159], v[212:215], v[204:207], v[156:159]
v_mfma_f32_16x16x32_bf16 v[152:155], v[208:211], v[204:207], v[152:155]
s_waitcnt vmcnt(0)
s_waitcnt lgkmcnt(0)
s_barrier
v_mfma_f32_16x16x32_bf16 v[128:131], v[48:51], v[32:35], v[128:131]
ds_read_b128 v[96:99], v6 offset:49152
v_mfma_f32_16x16x32_bf16 v[132:135], v[52:55], v[32:35], v[132:135]
ds_read_b64_tr_b16 v[112:113], v13 offset:0
v_mfma_f32_16x16x32_bf16 v[160:163], v[56:59], v[32:35], v[160:163]
ds_read_b64_tr_b16 v[114:115], v13 offset:4096
v_mfma_f32_16x16x32_bf16 v[164:167], v[60:63], v[32:35], v[164:167]
ds_read_b64_tr_b16 v[116:117], v14 offset:0
v_mfma_f32_16x16x32_bf16 v[172:175], v[60:63], v[36:39], v[172:175]
ds_read_b64_tr_b16 v[118:119], v14 offset:4096
v_mfma_f32_16x16x32_bf16 v[168:171], v[56:59], v[36:39], v[168:171]
ds_read_b64_tr_b16 v[120:121], v15 offset:0
v_mfma_f32_16x16x32_bf16 v[140:143], v[52:55], v[36:39], v[140:143]
ds_read_b64_tr_b16 v[122:123], v15 offset:4096
v_mfma_f32_16x16x32_bf16 v[136:139], v[48:51], v[36:39], v[136:139]
ds_read_b64_tr_b16 v[124:125], v16 offset:0
v_mfma_f32_16x16x32_bf16 v[144:147], v[48:51], v[40:43], v[144:147]
ds_read_b64_tr_b16 v[126:127], v16 offset:4096
v_mfma_f32_16x16x32_bf16 v[148:151], v[52:55], v[40:43], v[148:151]
ds_read_b128 v[100:103], v6 offset:50176
v_mfma_f32_16x16x32_bf16 v[176:179], v[56:59], v[40:43], v[176:179]
ds_read_b128 v[104:107], v6 offset:51200
v_mfma_f32_16x16x32_bf16 v[180:183], v[60:63], v[40:43], v[180:183]
ds_read_b128 v[108:111], v6 offset:52224
v_mfma_f32_16x16x32_bf16 v[188:191], v[60:63], v[44:47], v[188:191]
ds_read_b128 v[192:195], v6 offset:57344
v_mfma_f32_16x16x32_bf16 v[184:187], v[56:59], v[44:47], v[184:187]
ds_read_b64_tr_b16 v[208:209], v13 offset:8192
v_mfma_f32_16x16x32_bf16 v[156:159], v[52:55], v[44:47], v[156:159]
ds_read_b64_tr_b16 v[210:211], v13 offset:12288
v_mfma_f32_16x16x32_bf16 v[152:155], v[48:51], v[44:47], v[152:155]
ds_read_b64_tr_b16 v[212:213], v14 offset:8192
v_mfma_f32_16x16x32_bf16 v[128:131], v[80:83], v[64:67], v[128:131]
ds_read_b64_tr_b16 v[214:215], v14 offset:12288
v_mfma_f32_16x16x32_bf16 v[132:135], v[84:87], v[64:67], v[132:135]
ds_read_b64_tr_b16 v[216:217], v15 offset:8192
v_mfma_f32_16x16x32_bf16 v[160:163], v[88:91], v[64:67], v[160:163]
ds_read_b64_tr_b16 v[218:219], v15 offset:12288
v_mfma_f32_16x16x32_bf16 v[164:167], v[92:95], v[64:67], v[164:167]
ds_read_b64_tr_b16 v[220:221], v16 offset:8192
v_mfma_f32_16x16x32_bf16 v[172:175], v[92:95], v[68:71], v[172:175]
ds_read_b64_tr_b16 v[222:223], v16 offset:12288
v_mfma_f32_16x16x32_bf16 v[168:171], v[88:91], v[68:71], v[168:171]
ds_read_b128 v[196:199], v6 offset:58368
v_mfma_f32_16x16x32_bf16 v[140:143], v[84:87], v[68:71], v[140:143]
ds_read_b128 v[200:203], v6 offset:59392
v_mfma_f32_16x16x32_bf16 v[136:139], v[80:83], v[68:71], v[136:139]
ds_read_b128 v[204:207], v6 offset:60416
v_mfma_f32_16x16x32_bf16 v[144:147], v[80:83], v[72:75], v[144:147]
v_mfma_f32_16x16x32_bf16 v[148:151], v[84:87], v[72:75], v[148:151]
v_mfma_f32_16x16x32_bf16 v[176:179], v[88:91], v[72:75], v[176:179]
v_mfma_f32_16x16x32_bf16 v[180:183], v[92:95], v[72:75], v[180:183]
v_mfma_f32_16x16x32_bf16 v[188:191], v[92:95], v[76:79], v[188:191]
v_mfma_f32_16x16x32_bf16 v[184:187], v[88:91], v[76:79], v[184:187]
v_mfma_f32_16x16x32_bf16 v[156:159], v[84:87], v[76:79], v[156:159]
v_mfma_f32_16x16x32_bf16 v[152:155], v[80:83], v[76:79], v[152:155]
s_waitcnt lgkmcnt(0)
s_barrier
v_mfma_f32_16x16x32_bf16 v[128:131], v[112:115], v[96:99], v[128:131]
ds_read_b128 v[32:35], v7 offset:16384
v_mfma_f32_16x16x32_bf16 v[132:135], v[116:119], v[96:99], v[132:135]
ds_read_b64_tr_b16 v[48:49], v25 offset:16384
v_mfma_f32_16x16x32_bf16 v[160:163], v[120:123], v[96:99], v[160:163]
ds_read_b64_tr_b16 v[50:51], v25 offset:20480
v_mfma_f32_16x16x32_bf16 v[164:167], v[124:127], v[96:99], v[164:167]
ds_read_b64_tr_b16 v[52:53], v26 offset:16384
v_mfma_f32_16x16x32_bf16 v[172:175], v[124:127], v[100:103], v[172:175]
ds_read_b64_tr_b16 v[54:55], v26 offset:20480
v_mfma_f32_16x16x32_bf16 v[168:171], v[120:123], v[100:103], v[168:171]
ds_read_b64_tr_b16 v[56:57], v27 offset:16384
v_mfma_f32_16x16x32_bf16 v[140:143], v[116:119], v[100:103], v[140:143]
ds_read_b64_tr_b16 v[58:59], v27 offset:20480
v_mfma_f32_16x16x32_bf16 v[136:139], v[112:115], v[100:103], v[136:139]
ds_read_b64_tr_b16 v[60:61], v28 offset:16384
v_mfma_f32_16x16x32_bf16 v[144:147], v[112:115], v[104:107], v[144:147]
ds_read_b64_tr_b16 v[62:63], v28 offset:20480
v_mfma_f32_16x16x32_bf16 v[148:151], v[116:119], v[104:107], v[148:151]
ds_read_b128 v[36:39], v7 offset:17408
v_mfma_f32_16x16x32_bf16 v[176:179], v[120:123], v[104:107], v[176:179]
ds_read_b128 v[40:43], v7 offset:18432
v_mfma_f32_16x16x32_bf16 v[180:183], v[124:127], v[104:107], v[180:183]
ds_read_b128 v[44:47], v7 offset:19456
v_mfma_f32_16x16x32_bf16 v[188:191], v[124:127], v[108:111], v[188:191]
ds_read_b128 v[64:67], v7 offset:24576
v_mfma_f32_16x16x32_bf16 v[184:187], v[120:123], v[108:111], v[184:187]
ds_read_b64_tr_b16 v[80:81], v25 offset:24576
v_mfma_f32_16x16x32_bf16 v[156:159], v[116:119], v[108:111], v[156:159]
ds_read_b64_tr_b16 v[82:83], v25 offset:28672
v_mfma_f32_16x16x32_bf16 v[152:155], v[112:115], v[108:111], v[152:155]
ds_read_b64_tr_b16 v[84:85], v26 offset:24576
v_mfma_f32_16x16x32_bf16 v[128:131], v[208:211], v[192:195], v[128:131]
ds_read_b64_tr_b16 v[86:87], v26 offset:28672
v_mfma_f32_16x16x32_bf16 v[132:135], v[212:215], v[192:195], v[132:135]
ds_read_b64_tr_b16 v[88:89], v27 offset:24576
v_mfma_f32_16x16x32_bf16 v[160:163], v[216:219], v[192:195], v[160:163]
ds_read_b64_tr_b16 v[90:91], v27 offset:28672
v_mfma_f32_16x16x32_bf16 v[164:167], v[220:223], v[192:195], v[164:167]
ds_read_b64_tr_b16 v[92:93], v28 offset:24576
v_mfma_f32_16x16x32_bf16 v[172:175], v[220:223], v[196:199], v[172:175]
ds_read_b64_tr_b16 v[94:95], v28 offset:28672
v_mfma_f32_16x16x32_bf16 v[168:171], v[216:219], v[196:199], v[168:171]
ds_read_b128 v[68:71], v7 offset:25600
v_mfma_f32_16x16x32_bf16 v[140:143], v[212:215], v[196:199], v[140:143]
ds_read_b128 v[72:75], v7 offset:26624
v_mfma_f32_16x16x32_bf16 v[136:139], v[208:211], v[196:199], v[136:139]
ds_read_b128 v[76:79], v7 offset:27648
v_mfma_f32_16x16x32_bf16 v[144:147], v[208:211], v[200:203], v[144:147]
v_mfma_f32_16x16x32_bf16 v[148:151], v[212:215], v[200:203], v[148:151]
v_mfma_f32_16x16x32_bf16 v[176:179], v[216:219], v[200:203], v[176:179]
v_mfma_f32_16x16x32_bf16 v[180:183], v[220:223], v[200:203], v[180:183]
v_mfma_f32_16x16x32_bf16 v[188:191], v[220:223], v[204:207], v[188:191]
v_mfma_f32_16x16x32_bf16 v[184:187], v[216:219], v[204:207], v[184:187]
v_mfma_f32_16x16x32_bf16 v[156:159], v[212:215], v[204:207], v[156:159]
v_mfma_f32_16x16x32_bf16 v[152:155], v[208:211], v[204:207], v[152:155]
s_waitcnt lgkmcnt(0)
s_barrier
v_mfma_f32_16x16x32_bf16 v[128:131], v[48:51], v[32:35], v[128:131]
ds_read_b128 v[96:99], v7 offset:32768
v_mfma_f32_16x16x32_bf16 v[132:135], v[52:55], v[32:35], v[132:135]
ds_read_b64_tr_b16 v[112:113], v13 offset:49152
v_mfma_f32_16x16x32_bf16 v[160:163], v[56:59], v[32:35], v[160:163]
ds_read_b64_tr_b16 v[114:115], v13 offset:53248
v_mfma_f32_16x16x32_bf16 v[164:167], v[60:63], v[32:35], v[164:167]
ds_read_b64_tr_b16 v[116:117], v14 offset:49152
v_mfma_f32_16x16x32_bf16 v[172:175], v[60:63], v[36:39], v[172:175]
ds_read_b64_tr_b16 v[118:119], v14 offset:53248
v_mfma_f32_16x16x32_bf16 v[168:171], v[56:59], v[36:39], v[168:171]
ds_read_b64_tr_b16 v[120:121], v15 offset:49152
v_mfma_f32_16x16x32_bf16 v[140:143], v[52:55], v[36:39], v[140:143]
ds_read_b64_tr_b16 v[122:123], v15 offset:53248
v_mfma_f32_16x16x32_bf16 v[136:139], v[48:51], v[36:39], v[136:139]
ds_read_b64_tr_b16 v[124:125], v16 offset:49152
v_mfma_f32_16x16x32_bf16 v[144:147], v[48:51], v[40:43], v[144:147]
ds_read_b64_tr_b16 v[126:127], v16 offset:53248
v_mfma_f32_16x16x32_bf16 v[148:151], v[52:55], v[40:43], v[148:151]
ds_read_b128 v[100:103], v7 offset:33792
v_mfma_f32_16x16x32_bf16 v[176:179], v[56:59], v[40:43], v[176:179]
ds_read_b128 v[104:107], v7 offset:34816
v_mfma_f32_16x16x32_bf16 v[180:183], v[60:63], v[40:43], v[180:183]
ds_read_b128 v[108:111], v7 offset:35840
v_mfma_f32_16x16x32_bf16 v[188:191], v[60:63], v[44:47], v[188:191]
ds_read_b128 v[192:195], v7 offset:40960
v_mfma_f32_16x16x32_bf16 v[184:187], v[56:59], v[44:47], v[184:187]
ds_read_b64_tr_b16 v[208:209], v13 offset:57344
v_mfma_f32_16x16x32_bf16 v[156:159], v[52:55], v[44:47], v[156:159]
ds_read_b64_tr_b16 v[210:211], v13 offset:61440
v_mfma_f32_16x16x32_bf16 v[152:155], v[48:51], v[44:47], v[152:155]
ds_read_b64_tr_b16 v[212:213], v14 offset:57344
v_mfma_f32_16x16x32_bf16 v[128:131], v[80:83], v[64:67], v[128:131]
ds_read_b64_tr_b16 v[214:215], v14 offset:61440
v_mfma_f32_16x16x32_bf16 v[132:135], v[84:87], v[64:67], v[132:135]
ds_read_b64_tr_b16 v[216:217], v15 offset:57344
v_mfma_f32_16x16x32_bf16 v[160:163], v[88:91], v[64:67], v[160:163]
ds_read_b64_tr_b16 v[218:219], v15 offset:61440
v_mfma_f32_16x16x32_bf16 v[164:167], v[92:95], v[64:67], v[164:167]
ds_read_b64_tr_b16 v[220:221], v16 offset:57344
v_mfma_f32_16x16x32_bf16 v[172:175], v[92:95], v[68:71], v[172:175]
ds_read_b64_tr_b16 v[222:223], v16 offset:61440
v_mfma_f32_16x16x32_bf16 v[168:171], v[88:91], v[68:71], v[168:171]
ds_read_b128 v[196:199], v7 offset:41984
v_mfma_f32_16x16x32_bf16 v[140:143], v[84:87], v[68:71], v[140:143]
ds_read_b128 v[200:203], v7 offset:43008
v_mfma_f32_16x16x32_bf16 v[136:139], v[80:83], v[68:71], v[136:139]
ds_read_b128 v[204:207], v7 offset:44032
v_mfma_f32_16x16x32_bf16 v[144:147], v[80:83], v[72:75], v[144:147]
v_mfma_f32_16x16x32_bf16 v[148:151], v[84:87], v[72:75], v[148:151]
v_mfma_f32_16x16x32_bf16 v[176:179], v[88:91], v[72:75], v[176:179]
v_mfma_f32_16x16x32_bf16 v[180:183], v[92:95], v[72:75], v[180:183]
v_mfma_f32_16x16x32_bf16 v[188:191], v[92:95], v[76:79], v[188:191]
v_mfma_f32_16x16x32_bf16 v[184:187], v[88:91], v[76:79], v[184:187]
v_mfma_f32_16x16x32_bf16 v[156:159], v[84:87], v[76:79], v[156:159]
v_mfma_f32_16x16x32_bf16 v[152:155], v[80:83], v[76:79], v[152:155]
s_waitcnt lgkmcnt(0)
s_barrier
v_mfma_f32_16x16x32_bf16 v[128:131], v[112:115], v[96:99], v[128:131]
ds_read_b128 v[32:35], v8 offset:0
v_mfma_f32_16x16x32_bf16 v[132:135], v[116:119], v[96:99], v[132:135]
ds_read_b64_tr_b16 v[48:49], v9 offset:0
v_mfma_f32_16x16x32_bf16 v[160:163], v[120:123], v[96:99], v[160:163]
ds_read_b64_tr_b16 v[50:51], v9 offset:4096
v_mfma_f32_16x16x32_bf16 v[164:167], v[124:127], v[96:99], v[164:167]
ds_read_b64_tr_b16 v[52:53], v10 offset:0
v_mfma_f32_16x16x32_bf16 v[172:175], v[124:127], v[100:103], v[172:175]
ds_read_b64_tr_b16 v[54:55], v10 offset:4096
v_mfma_f32_16x16x32_bf16 v[168:171], v[120:123], v[100:103], v[168:171]
ds_read_b64_tr_b16 v[56:57], v11 offset:0
v_mfma_f32_16x16x32_bf16 v[140:143], v[116:119], v[100:103], v[140:143]
ds_read_b64_tr_b16 v[58:59], v11 offset:4096
v_mfma_f32_16x16x32_bf16 v[136:139], v[112:115], v[100:103], v[136:139]
ds_read_b64_tr_b16 v[60:61], v12 offset:0
v_mfma_f32_16x16x32_bf16 v[144:147], v[112:115], v[104:107], v[144:147]
ds_read_b64_tr_b16 v[62:63], v12 offset:4096
v_mfma_f32_16x16x32_bf16 v[148:151], v[116:119], v[104:107], v[148:151]
ds_read_b128 v[36:39], v8 offset:1024
v_mfma_f32_16x16x32_bf16 v[176:179], v[120:123], v[104:107], v[176:179]
ds_read_b128 v[40:43], v8 offset:2048
v_mfma_f32_16x16x32_bf16 v[180:183], v[124:127], v[104:107], v[180:183]
ds_read_b128 v[44:47], v8 offset:3072
v_mfma_f32_16x16x32_bf16 v[188:191], v[124:127], v[108:111], v[188:191]
ds_read_b128 v[64:67], v8 offset:8192
v_mfma_f32_16x16x32_bf16 v[184:187], v[120:123], v[108:111], v[184:187]
ds_read_b64_tr_b16 v[80:81], v9 offset:8192
v_mfma_f32_16x16x32_bf16 v[156:159], v[116:119], v[108:111], v[156:159]
ds_read_b64_tr_b16 v[82:83], v9 offset:12288
v_mfma_f32_16x16x32_bf16 v[152:155], v[112:115], v[108:111], v[152:155]
ds_read_b64_tr_b16 v[84:85], v10 offset:8192
v_mfma_f32_16x16x32_bf16 v[128:131], v[208:211], v[192:195], v[128:131]
s_branch Lov_11
.p2align 12
Lst_11_0:
s_branch Lwr_151
Lst_11_1:
s_branch Lst_15_0
s_nop 0
Lov_11:
ds_read_b64_tr_b16 v[86:87], v10 offset:12288
v_mfma_f32_16x16x32_bf16 v[132:135], v[212:215], v[192:195], v[132:135]
ds_read_b64_tr_b16 v[88:89], v11 offset:8192
v_mfma_f32_16x16x32_bf16 v[160:163], v[216:219], v[192:195], v[160:163]
ds_read_b64_tr_b16 v[90:91], v11 offset:12288
v_mfma_f32_16x16x32_bf16 v[164:167], v[220:223], v[192:195], v[164:167]
ds_read_b64_tr_b16 v[92:93], v12 offset:8192
v_mfma_f32_16x16x32_bf16 v[172:175], v[220:223], v[196:199], v[172:175]
ds_read_b64_tr_b16 v[94:95], v12 offset:12288
v_mfma_f32_16x16x32_bf16 v[168:171], v[216:219], v[196:199], v[168:171]
ds_read_b128 v[68:71], v8 offset:9216
v_mfma_f32_16x16x32_bf16 v[140:143], v[212:215], v[196:199], v[140:143]
ds_read_b128 v[72:75], v8 offset:10240
v_mfma_f32_16x16x32_bf16 v[136:139], v[208:211], v[196:199], v[136:139]
ds_read_b128 v[76:79], v8 offset:11264
v_mfma_f32_16x16x32_bf16 v[144:147], v[208:211], v[200:203], v[144:147]
v_mfma_f32_16x16x32_bf16 v[148:151], v[212:215], v[200:203], v[148:151]
v_mfma_f32_16x16x32_bf16 v[176:179], v[216:219], v[200:203], v[176:179]
v_mfma_f32_16x16x32_bf16 v[180:183], v[220:223], v[200:203], v[180:183]
v_mfma_f32_16x16x32_bf16 v[188:191], v[220:223], v[204:207], v[188:191]
v_mfma_f32_16x16x32_bf16 v[184:187], v[216:219], v[204:207], v[184:187]
v_mfma_f32_16x16x32_bf16 v[156:159], v[212:215], v[204:207], v[156:159]
v_mfma_f32_16x16x32_bf16 v[152:155], v[208:211], v[204:207], v[152:155]
s_waitcnt lgkmcnt(0)
s_barrier
v_mfma_f32_16x16x32_bf16 v[128:131], v[48:51], v[32:35], v[128:131]
ds_read_b128 v[96:99], v6 offset:16384
v_mfma_f32_16x16x32_bf16 v[132:135], v[52:55], v[32:35], v[132:135]
ds_read_b64_tr_b16 v[112:113], v9 offset:32768
v_mfma_f32_16x16x32_bf16 v[160:163], v[56:59], v[32:35], v[160:163]
ds_read_b64_tr_b16 v[114:115], v9 offset:36864
v_mfma_f32_16x16x32_bf16 v[164:167], v[60:63], v[32:35], v[164:167]
ds_read_b64_tr_b16 v[116:117], v10 offset:32768
v_mfma_f32_16x16x32_bf16 v[172:175], v[60:63], v[36:39], v[172:175]
ds_read_b64_tr_b16 v[118:119], v10 offset:36864
v_mfma_f32_16x16x32_bf16 v[168:171], v[56:59], v[36:39], v[168:171]
ds_read_b64_tr_b16 v[120:121], v11 offset:32768
v_mfma_f32_16x16x32_bf16 v[140:143], v[52:55], v[36:39], v[140:143]
ds_read_b64_tr_b16 v[122:123], v11 offset:36864
v_mfma_f32_16x16x32_bf16 v[136:139], v[48:51], v[36:39], v[136:139]
ds_read_b64_tr_b16 v[124:125], v12 offset:32768
v_mfma_f32_16x16x32_bf16 v[144:147], v[48:51], v[40:43], v[144:147]
ds_read_b64_tr_b16 v[126:127], v12 offset:36864
v_mfma_f32_16x16x32_bf16 v[148:151], v[52:55], v[40:43], v[148:151]
ds_read_b128 v[100:103], v6 offset:17408
v_mfma_f32_16x16x32_bf16 v[176:179], v[56:59], v[40:43], v[176:179]
ds_read_b128 v[104:107], v6 offset:18432
v_mfma_f32_16x16x32_bf16 v[180:183], v[60:63], v[40:43], v[180:183]
ds_read_b128 v[108:111], v6 offset:19456
v_mfma_f32_16x16x32_bf16 v[188:191], v[60:63], v[44:47], v[188:191]
ds_read_b128 v[192:195], v6 offset:24576
v_mfma_f32_16x16x32_bf16 v[184:187], v[56:59], v[44:47], v[184:187]
ds_read_b64_tr_b16 v[208:209], v9 offset:40960
v_mfma_f32_16x16x32_bf16 v[156:159], v[52:55], v[44:47], v[156:159]
ds_read_b64_tr_b16 v[210:211], v9 offset:45056
v_mfma_f32_16x16x32_bf16 v[152:155], v[48:51], v[44:47], v[152:155]
ds_read_b64_tr_b16 v[212:213], v10 offset:40960
v_mfma_f32_16x16x32_bf16 v[128:131], v[80:83], v[64:67], v[128:131]
ds_read_b64_tr_b16 v[214:215], v10 offset:45056
v_mfma_f32_16x16x32_bf16 v[132:135], v[84:87], v[64:67], v[132:135]
ds_read_b64_tr_b16 v[216:217], v11 offset:40960
v_mfma_f32_16x16x32_bf16 v[160:163], v[88:91], v[64:67], v[160:163]
ds_read_b64_tr_b16 v[218:219], v11 offset:45056
v_mfma_f32_16x16x32_bf16 v[164:167], v[92:95], v[64:67], v[164:167]
ds_read_b64_tr_b16 v[220:221], v12 offset:40960
v_mfma_f32_16x16x32_bf16 v[172:175], v[92:95], v[68:71], v[172:175]
ds_read_b64_tr_b16 v[222:223], v12 offset:45056
v_mfma_f32_16x16x32_bf16 v[168:171], v[88:91], v[68:71], v[168:171]
ds_read_b128 v[196:199], v6 offset:25600
v_mfma_f32_16x16x32_bf16 v[140:143], v[84:87], v[68:71], v[140:143]
ds_read_b128 v[200:203], v6 offset:26624
v_mfma_f32_16x16x32_bf16 v[136:139], v[80:83], v[68:71], v[136:139]
ds_read_b128 v[204:207], v6 offset:27648
v_mfma_f32_16x16x32_bf16 v[144:147], v[80:83], v[72:75], v[144:147]
v_mfma_f32_16x16x32_bf16 v[148:151], v[84:87], v[72:75], v[148:151]
v_mfma_f32_16x16x32_bf16 v[176:179], v[88:91], v[72:75], v[176:179]
v_mfma_f32_16x16x32_bf16 v[180:183], v[92:95], v[72:75], v[180:183]
v_mfma_f32_16x16x32_bf16 v[188:191], v[92:95], v[76:79], v[188:191]
v_mfma_f32_16x16x32_bf16 v[184:187], v[88:91], v[76:79], v[184:187]
v_mfma_f32_16x16x32_bf16 v[156:159], v[84:87], v[76:79], v[156:159]
v_mfma_f32_16x16x32_bf16 v[152:155], v[80:83], v[76:79], v[152:155]
s_waitcnt lgkmcnt(0)
s_barrier
v_mfma_f32_16x16x32_bf16 v[128:131], v[112:115], v[96:99], v[128:131]
ds_read_b128 v[32:35], v6 offset:49152
v_mfma_f32_16x16x32_bf16 v[132:135], v[116:119], v[96:99], v[132:135]
ds_read_b64_tr_b16 v[48:49], v13 offset:0
v_mfma_f32_16x16x32_bf16 v[160:163], v[120:123], v[96:99], v[160:163]
ds_read_b64_tr_b16 v[50:51], v13 offset:4096
v_mfma_f32_16x16x32_bf16 v[164:167], v[124:127], v[96:99], v[164:167]
ds_read_b64_tr_b16 v[52:53], v14 offset:0
v_mfma_f32_16x16x32_bf16 v[172:175], v[124:127], v[100:103], v[172:175]
ds_read_b64_tr_b16 v[54:55], v14 offset:4096
v_mfma_f32_16x16x32_bf16 v[168:171], v[120:123], v[100:103], v[168:171]
ds_read_b64_tr_b16 v[56:57], v15 offset:0
v_mfma_f32_16x16x32_bf16 v[140:143], v[116:119], v[100:103], v[140:143]
ds_read_b64_tr_b16 v[58:59], v15 offset:4096
v_mfma_f32_16x16x32_bf16 v[136:139], v[112:115], v[100:103], v[136:139]
ds_read_b64_tr_b16 v[60:61], v16 offset:0
v_mfma_f32_16x16x32_bf16 v[144:147], v[112:115], v[104:107], v[144:147]
ds_read_b64_tr_b16 v[62:63], v16 offset:4096
v_mfma_f32_16x16x32_bf16 v[148:151], v[116:119], v[104:107], v[148:151]
ds_read_b128 v[36:39], v6 offset:50176
v_mfma_f32_16x16x32_bf16 v[176:179], v[120:123], v[104:107], v[176:179]
ds_read_b128 v[40:43], v6 offset:51200
v_mfma_f32_16x16x32_bf16 v[180:183], v[124:127], v[104:107], v[180:183]
ds_read_b128 v[44:47], v6 offset:52224
v_mfma_f32_16x16x32_bf16 v[188:191], v[124:127], v[108:111], v[188:191]
ds_read_b128 v[64:67], v6 offset:57344
v_mfma_f32_16x16x32_bf16 v[184:187], v[120:123], v[108:111], v[184:187]
ds_read_b64_tr_b16 v[80:81], v13 offset:8192
v_mfma_f32_16x16x32_bf16 v[156:159], v[116:119], v[108:111], v[156:159]
ds_read_b64_tr_b16 v[82:83], v13 offset:12288
v_mfma_f32_16x16x32_bf16 v[152:155], v[112:115], v[108:111], v[152:155]
ds_read_b64_tr_b16 v[84:85], v14 offset:8192
v_mfma_f32_16x16x32_bf16 v[128:131], v[208:211], v[192:195], v[128:131]
ds_read_b64_tr_b16 v[86:87], v14 offset:12288
v_mfma_f32_16x16x32_bf16 v[132:135], v[212:215], v[192:195], v[132:135]
ds_read_b64_tr_b16 v[88:89], v15 offset:8192
v_mfma_f32_16x16x32_bf16 v[160:163], v[216:219], v[192:195], v[160:163]
ds_read_b64_tr_b16 v[90:91], v15 offset:12288
v_mfma_f32_16x16x32_bf16 v[164:167], v[220:223], v[192:195], v[164:167]
ds_read_b64_tr_b16 v[92:93], v16 offset:8192
v_mfma_f32_16x16x32_bf16 v[172:175], v[220:223], v[196:199], v[172:175]
ds_read_b64_tr_b16 v[94:95], v16 offset:12288
v_mfma_f32_16x16x32_bf16 v[168:171], v[216:219], v[196:199], v[168:171]
ds_read_b128 v[68:71], v6 offset:58368
v_mfma_f32_16x16x32_bf16 v[140:143], v[212:215], v[196:199], v[140:143]
ds_read_b128 v[72:75], v6 offset:59392
v_mfma_f32_16x16x32_bf16 v[136:139], v[208:211], v[196:199], v[136:139]
ds_read_b128 v[76:79], v6 offset:60416
v_mfma_f32_16x16x32_bf16 v[144:147], v[208:211], v[200:203], v[144:147]
v_mfma_f32_16x16x32_bf16 v[148:151], v[212:215], v[200:203], v[148:151]
v_mfma_f32_16x16x32_bf16 v[176:179], v[216:219], v[200:203], v[176:179]
v_mfma_f32_16x16x32_bf16 v[180:183], v[220:223], v[200:203], v[180:183]
v_mfma_f32_16x16x32_bf16 v[188:191], v[220:223], v[204:207], v[188:191]
v_mfma_f32_16x16x32_bf16 v[184:187], v[216:219], v[204:207], v[184:187]
v_mfma_f32_16x16x32_bf16 v[156:159], v[212:215], v[204:207], v[156:159]
v_mfma_f32_16x16x32_bf16 v[152:155], v[208:211], v[204:207], v[152:155]
s_waitcnt lgkmcnt(0)
s_barrier
v_mfma_f32_16x16x32_bf16 v[128:131], v[48:51], v[32:35], v[128:131]
ds_read_b128 v[96:99], v7 offset:16384
v_mfma_f32_16x16x32_bf16 v[132:135], v[52:55], v[32:35], v[132:135]
ds_read_b64_tr_b16 v[112:113], v25 offset:16384
v_mfma_f32_16x16x32_bf16 v[160:163], v[56:59], v[32:35], v[160:163]
ds_read_b64_tr_b16 v[114:115], v25 offset:20480
v_mfma_f32_16x16x32_bf16 v[164:167], v[60:63], v[32:35], v[164:167]
ds_read_b64_tr_b16 v[116:117], v26 offset:16384
v_mfma_f32_16x16x32_bf16 v[172:175], v[60:63], v[36:39], v[172:175]
ds_read_b64_tr_b16 v[118:119], v26 offset:20480
v_mfma_f32_16x16x32_bf16 v[168:171], v[56:59], v[36:39], v[168:171]
ds_read_b64_tr_b16 v[120:121], v27 offset:16384
v_mfma_f32_16x16x32_bf16 v[140:143], v[52:55], v[36:39], v[140:143]
ds_read_b64_tr_b16 v[122:123], v27 offset:20480
v_mfma_f32_16x16x32_bf16 v[136:139], v[48:51], v[36:39], v[136:139]
ds_read_b64_tr_b16 v[124:125], v28 offset:16384
v_mfma_f32_16x16x32_bf16 v[144:147], v[48:51], v[40:43], v[144:147]
ds_read_b64_tr_b16 v[126:127], v28 offset:20480
v_mfma_f32_16x16x32_bf16 v[148:151], v[52:55], v[40:43], v[148:151]
ds_read_b128 v[100:103], v7 offset:17408
v_mfma_f32_16x16x32_bf16 v[176:179], v[56:59], v[40:43], v[176:179]
ds_read_b128 v[104:107], v7 offset:18432
v_mfma_f32_16x16x32_bf16 v[180:183], v[60:63], v[40:43], v[180:183]
ds_read_b128 v[108:111], v7 offset:19456
v_mfma_f32_16x16x32_bf16 v[188:191], v[60:63], v[44:47], v[188:191]
ds_read_b128 v[192:195], v7 offset:24576
v_mfma_f32_16x16x32_bf16 v[184:187], v[56:59], v[44:47], v[184:187]
ds_read_b64_tr_b16 v[208:209], v25 offset:24576
v_mfma_f32_16x16x32_bf16 v[156:159], v[52:55], v[44:47], v[156:159]
ds_read_b64_tr_b16 v[210:211], v25 offset:28672
v_mfma_f32_16x16x32_bf16 v[152:155], v[48:51], v[44:47], v[152:155]
ds_read_b64_tr_b16 v[212:213], v26 offset:24576
v_mfma_f32_16x16x32_bf16 v[128:131], v[80:83], v[64:67], v[128:131]
ds_read_b64_tr_b16 v[214:215], v26 offset:28672
v_mfma_f32_16x16x32_bf16 v[132:135], v[84:87], v[64:67], v[132:135]
ds_read_b64_tr_b16 v[216:217], v27 offset:24576
v_mfma_f32_16x16x32_bf16 v[160:163], v[88:91], v[64:67], v[160:163]
ds_read_b64_tr_b16 v[218:219], v27 offset:28672
v_mfma_f32_16x16x32_bf16 v[164:167], v[92:95], v[64:67], v[164:167]
ds_read_b64_tr_b16 v[220:221], v28 offset:24576
v_mfma_f32_16x16x32_bf16 v[172:175], v[92:95], v[68:71], v[172:175]
ds_read_b64_tr_b16 v[222:223], v28 offset:28672
v_mfma_f32_16x16x32_bf16 v[168:171], v[88:91], v[68:71], v[168:171]
ds_read_b128 v[196:199], v7 offset:25600
v_mfma_f32_16x16x32_bf16 v[140:143], v[84:87], v[68:71], v[140:143]
ds_read_b128 v[200:203], v7 offset:26624
v_mfma_f32_16x16x32_bf16 v[136:139], v[80:83], v[68:71], v[136:139]
ds_read_b128 v[204:207], v7 offset:27648
v_mfma_f32_16x16x32_bf16 v[144:147], v[80:83], v[72:75], v[144:147]
v_mfma_f32_16x16x32_bf16 v[148:151], v[84:87], v[72:75], v[148:151]
v_mfma_f32_16x16x32_bf16 v[176:179], v[88:91], v[72:75], v[176:179]
v_mfma_f32_16x16x32_bf16 v[180:183], v[92:95], v[72:75], v[180:183]
v_mfma_f32_16x16x32_bf16 v[188:191], v[92:95], v[76:79], v[188:191]
v_mfma_f32_16x16x32_bf16 v[184:187], v[88:91], v[76:79], v[184:187]
v_mfma_f32_16x16x32_bf16 v[156:159], v[84:87], v[76:79], v[156:159]
v_mfma_f32_16x16x32_bf16 v[152:155], v[80:83], v[76:79], v[152:155]
s_waitcnt lgkmcnt(0)
s_barrier
v_mfma_f32_16x16x32_bf16 v[128:131], v[112:115], v[96:99], v[128:131]
ds_read_b128 v[32:35], v7 offset:32768
v_mfma_f32_16x16x32_bf16 v[132:135], v[116:119], v[96:99], v[132:135]
ds_read_b64_tr_b16 v[48:49], v13 offset:49152
v_mfma_f32_16x16x32_bf16 v[160:163], v[120:123], v[96:99], v[160:163]
ds_read_b64_tr_b16 v[50:51], v13 offset:53248
v_mfma_f32_16x16x32_bf16 v[164:167], v[124:127], v[96:99], v[164:167]
ds_read_b64_tr_b16 v[52:53], v14 offset:49152
v_mfma_f32_16x16x32_bf16 v[172:175], v[124:127], v[100:103], v[172:175]
ds_read_b64_tr_b16 v[54:55], v14 offset:53248
v_mfma_f32_16x16x32_bf16 v[168:171], v[120:123], v[100:103], v[168:171]
ds_read_b64_tr_b16 v[56:57], v15 offset:49152
v_mfma_f32_16x16x32_bf16 v[140:143], v[116:119], v[100:103], v[140:143]
ds_read_b64_tr_b16 v[58:59], v15 offset:53248
v_mfma_f32_16x16x32_bf16 v[136:139], v[112:115], v[100:103], v[136:139]
ds_read_b64_tr_b16 v[60:61], v16 offset:49152
v_mfma_f32_16x16x32_bf16 v[144:147], v[112:115], v[104:107], v[144:147]
ds_read_b64_tr_b16 v[62:63], v16 offset:53248
v_mfma_f32_16x16x32_bf16 v[148:151], v[116:119], v[104:107], v[148:151]
ds_read_b128 v[36:39], v7 offset:33792
v_mfma_f32_16x16x32_bf16 v[176:179], v[120:123], v[104:107], v[176:179]
ds_read_b128 v[40:43], v7 offset:34816
v_mfma_f32_16x16x32_bf16 v[180:183], v[124:127], v[104:107], v[180:183]
ds_read_b128 v[44:47], v7 offset:35840
v_mfma_f32_16x16x32_bf16 v[188:191], v[124:127], v[108:111], v[188:191]
ds_read_b128 v[64:67], v7 offset:40960
v_mfma_f32_16x16x32_bf16 v[184:187], v[120:123], v[108:111], v[184:187]
ds_read_b64_tr_b16 v[80:81], v13 offset:57344
v_mfma_f32_16x16x32_bf16 v[156:159], v[116:119], v[108:111], v[156:159]
ds_read_b64_tr_b16 v[82:83], v13 offset:61440
v_mfma_f32_16x16x32_bf16 v[152:155], v[112:115], v[108:111], v[152:155]
ds_read_b64_tr_b16 v[84:85], v14 offset:57344
v_mfma_f32_16x16x32_bf16 v[128:131], v[208:211], v[192:195], v[128:131]
ds_read_b64_tr_b16 v[86:87], v14 offset:61440
v_mfma_f32_16x16x32_bf16 v[132:135], v[212:215], v[192:195], v[132:135]
ds_read_b64_tr_b16 v[88:89], v15 offset:57344
v_mfma_f32_16x16x32_bf16 v[160:163], v[216:219], v[192:195], v[160:163]
ds_read_b64_tr_b16 v[90:91], v15 offset:61440
v_mfma_f32_16x16x32_bf16 v[164:167], v[220:223], v[192:195], v[164:167]
ds_read_b64_tr_b16 v[92:93], v16 offset:57344
v_mfma_f32_16x16x32_bf16 v[172:175], v[220:223], v[196:199], v[172:175]
ds_read_b64_tr_b16 v[94:95], v16 offset:61440
v_mfma_f32_16x16x32_bf16 v[168:171], v[216:219], v[196:199], v[168:171]
ds_read_b128 v[68:71], v7 offset:41984
v_mfma_f32_16x16x32_bf16 v[140:143], v[212:215], v[196:199], v[140:143]
ds_read_b128 v[72:75], v7 offset:43008
v_mfma_f32_16x16x32_bf16 v[136:139], v[208:211], v[196:199], v[136:139]
ds_read_b128 v[76:79], v7 offset:44032
v_mfma_f32_16x16x32_bf16 v[144:147], v[208:211], v[200:203], v[144:147]
v_mfma_f32_16x16x32_bf16 v[148:151], v[212:215], v[200:203], v[148:151]
v_mfma_f32_16x16x32_bf16 v[176:179], v[216:219], v[200:203], v[176:179]
v_mfma_f32_16x16x32_bf16 v[180:183], v[220:223], v[200:203], v[180:183]
v_mfma_f32_16x16x32_bf16 v[188:191], v[220:223], v[204:207], v[188:191]
v_mfma_f32_16x16x32_bf16 v[184:187], v[216:219], v[204:207], v[184:187]
v_mfma_f32_16x16x32_bf16 v[156:159], v[212:215], v[204:207], v[156:159]
v_mfma_f32_16x16x32_bf16 v[152:155], v[208:211], v[204:207], v[152:155]
s_waitcnt lgkmcnt(0)
s_barrier
v_mfma_f32_16x16x32_bf16 v[128:131], v[48:51], v[32:35], v[128:131]
ds_read_b128 v[96:99], v8 offset:0
v_mfma_f32_16x16x32_bf16 v[132:135], v[52:55], v[32:35], v[132:135]
ds_read_b64_tr_b16 v[112:113], v9 offset:0
v_mfma_f32_16x16x32_bf16 v[160:163], v[56:59], v[32:35], v[160:163]
ds_read_b64_tr_b16 v[114:115], v9 offset:4096
v_mfma_f32_16x16x32_bf16 v[164:167], v[60:63], v[32:35], v[164:167]
ds_read_b64_tr_b16 v[116:117], v10 offset:0
v_mfma_f32_16x16x32_bf16 v[172:175], v[60:63], v[36:39], v[172:175]
ds_read_b64_tr_b16 v[118:119], v10 offset:4096
v_mfma_f32_16x16x32_bf16 v[168:171], v[56:59], v[36:39], v[168:171]
ds_read_b64_tr_b16 v[120:121], v11 offset:0
v_mfma_f32_16x16x32_bf16 v[140:143], v[52:55], v[36:39], v[140:143]
ds_read_b64_tr_b16 v[122:123], v11 offset:4096
v_mfma_f32_16x16x32_bf16 v[136:139], v[48:51], v[36:39], v[136:139]
ds_read_b64_tr_b16 v[124:125], v12 offset:0
v_mfma_f32_16x16x32_bf16 v[144:147], v[48:51], v[40:43], v[144:147]
ds_read_b64_tr_b16 v[126:127], v12 offset:4096
v_mfma_f32_16x16x32_bf16 v[148:151], v[52:55], v[40:43], v[148:151]
ds_read_b128 v[100:103], v8 offset:1024
v_mfma_f32_16x16x32_bf16 v[176:179], v[56:59], v[40:43], v[176:179]
ds_read_b128 v[104:107], v8 offset:2048
v_mfma_f32_16x16x32_bf16 v[180:183], v[60:63], v[40:43], v[180:183]
ds_read_b128 v[108:111], v8 offset:3072
v_mfma_f32_16x16x32_bf16 v[188:191], v[60:63], v[44:47], v[188:191]
ds_read_b128 v[192:195], v8 offset:8192
v_mfma_f32_16x16x32_bf16 v[184:187], v[56:59], v[44:47], v[184:187]
ds_read_b64_tr_b16 v[208:209], v9 offset:8192
v_mfma_f32_16x16x32_bf16 v[156:159], v[52:55], v[44:47], v[156:159]
ds_read_b64_tr_b16 v[210:211], v9 offset:12288
v_mfma_f32_16x16x32_bf16 v[152:155], v[48:51], v[44:47], v[152:155]
ds_read_b64_tr_b16 v[212:213], v10 offset:8192
v_mfma_f32_16x16x32_bf16 v[128:131], v[80:83], v[64:67], v[128:131]
ds_read_b64_tr_b16 v[214:215], v10 offset:12288
v_mfma_f32_16x16x32_bf16 v[132:135], v[84:87], v[64:67], v[132:135]
ds_read_b64_tr_b16 v[216:217], v11 offset:8192
v_mfma_f32_16x16x32_bf16 v[160:163], v[88:91], v[64:67], v[160:163]
ds_read_b64_tr_b16 v[218:219], v11 offset:12288
v_mfma_f32_16x16x32_bf16 v[164:167], v[92:95], v[64:67], v[164:167]
ds_read_b64_tr_b16 v[220:221], v12 offset:8192
v_mfma_f32_16x16x32_bf16 v[172:175], v[92:95], v[68:71], v[172:175]
ds_read_b64_tr_b16 v[222:223], v12 offset:12288
v_mfma_f32_16x16x32_bf16 v[168:171], v[88:91], v[68:71], v[168:171]
ds_read_b128 v[196:199], v8 offset:9216
v_mfma_f32_16x16x32_bf16 v[140:143], v[84:87], v[68:71], v[140:143]
ds_read_b128 v[200:203], v8 offset:10240
v_mfma_f32_16x16x32_bf16 v[136:139], v[80:83], v[68:71], v[136:139]
ds_read_b128 v[204:207], v8 offset:11264
v_mfma_f32_16x16x32_bf16 v[144:147], v[80:83], v[72:75], v[144:147]
v_mfma_f32_16x16x32_bf16 v[148:151], v[84:87], v[72:75], v[148:151]
v_mfma_f32_16x16x32_bf16 v[176:179], v[88:91], v[72:75], v[176:179]
v_mfma_f32_16x16x32_bf16 v[180:183], v[92:95], v[72:75], v[180:183]
v_mfma_f32_16x16x32_bf16 v[188:191], v[92:95], v[76:79], v[188:191]
v_mfma_f32_16x16x32_bf16 v[184:187], v[88:91], v[76:79], v[184:187]
v_mfma_f32_16x16x32_bf16 v[156:159], v[84:87], v[76:79], v[156:159]
v_mfma_f32_16x16x32_bf16 v[152:155], v[80:83], v[76:79], v[152:155]
s_sub_u32 s41, s41, 1
s_cmp_lg_u32 s41, 0
s_cbranch_scc1 Lk4_116
s_waitcnt lgkmcnt(0)
s_barrier
v_mfma_f32_16x16x32_bf16 v[128:131], v[112:115], v[96:99], v[128:131]
ds_read_b128 v[32:35], v6 offset:16384
v_mfma_f32_16x16x32_bf16 v[132:135], v[116:119], v[96:99], v[132:135]
ds_read_b64_tr_b16 v[48:49], v224 offset:32768
v_mfma_f32_16x16x32_bf16 v[160:163], v[120:123], v[96:99], v[160:163]
ds_read_b64_tr_b16 v[50:51], v224 offset:34816
v_mfma_f32_16x16x32_bf16 v[164:167], v[124:127], v[96:99], v[164:167]
ds_read_b64_tr_b16 v[52:53], v225 offset:32768
v_mfma_f32_16x16x32_bf16 v[172:175], v[124:127], v[100:103], v[172:175]
ds_read_b64_tr_b16 v[54:55], v225 offset:34816
v_mfma_f32_16x16x32_bf16 v[168:171], v[120:123], v[100:103], v[168:171]
ds_read_b128 v[36:39], v6 offset:17408
v_mfma_f32_16x16x32_bf16 v[140:143], v[116:119], v[100:103], v[140:143]
ds_read_b128 v[40:43], v6 offset:18432
v_mfma_f32_16x16x32_bf16 v[136:139], v[112:115], v[100:103], v[136:139]
ds_read_b128 v[44:47], v6 offset:19456
v_mfma_f32_16x16x32_bf16 v[144:147], v[112:115], v[104:107], v[144:147]
ds_read_b128 v[64:67], v6 offset:24576
v_mfma_f32_16x16x32_bf16 v[148:151], v[116:119], v[104:107], v[148:151]
ds_read_b64_tr_b16 v[80:81], v224 offset:36864
v_mfma_f32_16x16x32_bf16 v[176:179], v[120:123], v[104:107], v[176:179]
ds_read_b64_tr_b16 v[82:83], v224 offset:38912
v_mfma_f32_16x16x32_bf16 v[180:183], v[124:127], v[104:107], v[180:183]
ds_read_b64_tr_b16 v[84:85], v225 offset:36864
v_mfma_f32_16x16x32_bf16 v[188:191], v[124:127], v[108:111], v[188:191]
ds_read_b64_tr_b16 v[86:87], v225 offset:38912
v_mfma_f32_16x16x32_bf16 v[184:187], v[120:123], v[108:111], v[184:187]
ds_read_b128 v[68:71], v6 offset:25600
v_mfma_f32_16x16x32_bf16 v[156:159], v[116:119], v[108:111], v[156:159]
ds_read_b128 v[72:75], v6 offset:26624
v_mfma_f32_16x16x32_bf16 v[152:155], v[112:115], v[108:111], v[152:155]
ds_read_b128 v[76:79], v6 offset:27648
v_mfma_f32_16x16x32_bf16 v[128:131], v[208:211], v[192:195], v[128:131]
v_mfma_f32_16x16x32_bf16 v[132:135], v[212:215], v[192:195], v[132:135]
v_mfma_f32_16x16x32_bf16 v[160:163], v[216:219], v[192:195], v[160:163]
v_mfma_f32_16x16x32_bf16 v[164:167], v[220:223], v[192:195], v[164:167]
v_mfma_f32_16x16x32_bf16 v[172:175], v[220:223], v[196:199], v[172:175]
v_mfma_f32_16x16x32_bf16 v[168:171], v[216:219], v[196:199], v[168:171]
v_mfma_f32_16x16x32_bf16 v[140:143], v[212:215], v[196:199], v[140:143]
v_mfma_f32_16x16x32_bf16 v[136:139], v[208:211], v[196:199], v[136:139]
v_mfma_f32_16x16x32_bf16 v[144:147], v[208:211], v[200:203], v[144:147]
v_mfma_f32_16x16x32_bf16 v[148:151], v[212:215], v[200:203], v[148:151]
v_mfma_f32_16x16x32_bf16 v[176:179], v[216:219], v[200:203], v[176:179]
v_mfma_f32_16x16x32_bf16 v[180:183], v[220:223], v[200:203], v[180:183]
v_mfma_f32_16x16x32_bf16 v[188:191], v[220:223], v[204:207], v[188:191]
v_mfma_f32_16x16x32_bf16 v[184:187], v[216:219], v[204:207], v[184:187]
v_mfma_f32_16x16x32_bf16 v[156:159], v[212:215], v[204:207], v[156:159]
v_mfma_f32_16x16x32_bf16 v[152:155], v[208:211], v[204:207], v[152:155]
s_waitcnt lgkmcnt(0)
s_barrier
v_mfma_f32_16x16x32_bf16 v[128:131], v[48:51], v[32:35], v[128:131]
ds_read_b128 v[96:99], v6 offset:49152
ds_read_b64_tr_b16 v[112:113], v226 offset:0
v_mfma_f32_16x16x32_bf16 v[132:135], v[52:55], v[32:35], v[132:135]
ds_read_b64_tr_b16 v[114:115], v226 offset:2048
ds_read_b64_tr_b16 v[116:117], v227 offset:0
v_mfma_f32_16x16x32_bf16 v[140:143], v[52:55], v[36:39], v[140:143]
ds_read_b64_tr_b16 v[118:119], v227 offset:2048
ds_read_b128 v[100:103], v6 offset:50176
v_mfma_f32_16x16x32_bf16 v[136:139], v[48:51], v[36:39], v[136:139]
ds_read_b128 v[104:107], v6 offset:51200
ds_read_b128 v[108:111], v6 offset:52224
v_mfma_f32_16x16x32_bf16 v[144:147], v[48:51], v[40:43], v[144:147]
ds_read_b128 v[192:195], v6 offset:57344
v_mfma_f32_16x16x32_bf16 v[148:151], v[52:55], v[40:43], v[148:151]
ds_read_b64_tr_b16 v[208:209], v226 offset:4096
v_mfma_f32_16x16x32_bf16 v[156:159], v[52:55], v[44:47], v[156:159]
ds_read_b64_tr_b16 v[210:211], v226 offset:6144
v_cvt_pk_bf16_f32 v160, v160, v161
v_cvt_pk_bf16_f32 v161, v162, v163
v_mfma_f32_16x16x32_bf16 v[152:155], v[48:51], v[44:47], v[152:155]
ds_read_b64_tr_b16 v[212:213], v227 offset:4096
v_cvt_pk_bf16_f32 v162, v164, v165
v_cvt_pk_bf16_f32 v163, v166, v167
v_mfma_f32_16x16x32_bf16 v[128:131], v[80:83], v[64:67], v[128:131]
ds_read_b64_tr_b16 v[214:215], v227 offset:6144
v_cvt_pk_bf16_f32 v164, v168, v169
v_cvt_pk_bf16_f32 v165, v170, v171
v_mfma_f32_16x16x32_bf16 v[132:135], v[84:87], v[64:67], v[132:135]
ds_read_b128 v[196:199], v6 offset:58368
v_cvt_pk_bf16_f32 v166, v172, v173
v_cvt_pk_bf16_f32 v167, v174, v175
v_mfma_f32_16x16x32_bf16 v[140:143], v[84:87], v[68:71], v[140:143]
ds_read_b128 v[200:203], v6 offset:59392
v_cvt_pk_bf16_f32 v168, v176, v177
v_cvt_pk_bf16_f32 v169, v178, v179
v_mfma_f32_16x16x32_bf16 v[136:139], v[80:83], v[68:71], v[136:139]
ds_read_b128 v[204:207], v6 offset:60416
v_cvt_pk_bf16_f32 v170, v180, v181
v_cvt_pk_bf16_f32 v171, v182, v183
v_mfma_f32_16x16x32_bf16 v[144:147], v[80:83], v[72:75], v[144:147]
v_cvt_pk_bf16_f32 v172, v184, v185
v_cvt_pk_bf16_f32 v173, v186, v187
v_mfma_f32_16x16x32_bf16 v[148:151], v[84:87], v[72:75], v[148:151]
v_cvt_pk_bf16_f32 v174, v188, v189
v_cvt_pk_bf16_f32 v175, v190, v191
v_mfma_f32_16x16x32_bf16 v[156:159], v[84:87], v[76:79], v[156:159]
v_mfma_f32_16x16x32_bf16 v[152:155], v[80:83], v[76:79], v[152:155]
buffer_store_dwordx4 v[160:163], v2, s[84:87], s45 offen offset:0 sc1
s_waitcnt lgkmcnt(0)
s_barrier
v_mfma_f32_16x16x32_bf16 v[128:131], v[112:115], v[96:99], v[128:131]
ds_read_b128 v[32:35], v7 offset:16384
ds_read_b64_tr_b16 v[48:49], v228 offset:16384
v_mfma_f32_16x16x32_bf16 v[132:135], v[116:119], v[96:99], v[132:135]
ds_read_b64_tr_b16 v[50:51], v228 offset:18432
ds_read_b64_tr_b16 v[52:53], v229 offset:16384
v_mfma_f32_16x16x32_bf16 v[140:143], v[116:119], v[100:103], v[140:143]
ds_read_b64_tr_b16 v[54:55], v229 offset:18432
ds_read_b128 v[36:39], v7 offset:17408
v_mfma_f32_16x16x32_bf16 v[136:139], v[112:115], v[100:103], v[136:139]
ds_read_b128 v[40:43], v7 offset:18432
ds_read_b128 v[44:47], v7 offset:19456
v_mfma_f32_16x16x32_bf16 v[144:147], v[112:115], v[104:107], v[144:147]
ds_read_b128 v[64:67], v7 offset:24576
v_mfma_f32_16x16x32_bf16 v[148:151], v[116:119], v[104:107], v[148:151]
ds_read_b64_tr_b16 v[80:81], v228 offset:20480
v_mfma_f32_16x16x32_bf16 v[156:159], v[116:119], v[108:111], v[156:159]
ds_read_b64_tr_b16 v[82:83], v228 offset:22528
v_mfma_f32_16x16x32_bf16 v[152:155], v[112:115], v[108:111], v[152:155]
ds_read_b64_tr_b16 v[84:85], v229 offset:20480
v_mfma_f32_16x16x32_bf16 v[128:131], v[208:211], v[192:195], v[128:131]
ds_read_b64_tr_b16 v[86:87], v229 offset:22528
buffer_store_dwordx4 v[164:167], v2, s[84:87], s45 offen offset:1024 sc1
v_mfma_f32_16x16x32_bf16 v[132:135], v[212:215], v[192:195], v[132:135]
ds_read_b128 v[68:71], v7 offset:25600
v_mfma_f32_16x16x32_bf16 v[140:143], v[212:215], v[196:199], v[140:143]
ds_read_b128 v[72:75], v7 offset:26624
v_mfma_f32_16x16x32_bf16 v[136:139], v[208:211], v[196:199], v[136:139]
ds_read_b128 v[76:79], v7 offset:27648
v_mfma_f32_16x16x32_bf16 v[144:147], v[208:211], v[200:203], v[144:147]
v_mfma_f32_16x16x32_bf16 v[148:151], v[212:215], v[200:203], v[148:151]
v_mfma_f32_16x16x32_bf16 v[156:159], v[212:215], v[204:207], v[156:159]
v_mfma_f32_16x16x32_bf16 v[152:155], v[208:211], v[204:207], v[152:155]
s_waitcnt lgkmcnt(0)
s_barrier
v_mfma_f32_16x16x32_bf16 v[128:131], v[48:51], v[32:35], v[128:131]
ds_read_b128 v[96:99], v7 offset:32768
ds_read_b64_tr_b16 v[112:113], v226 offset:49152
v_mfma_f32_16x16x32_bf16 v[132:135], v[52:55], v[32:35], v[132:135]
ds_read_b64_tr_b16 v[114:115], v226 offset:51200
ds_read_b64_tr_b16 v[116:117], v227 offset:49152
v_mfma_f32_16x16x32_bf16 v[140:143], v[52:55], v[36:39], v[140:143]
ds_read_b64_tr_b16 v[118:119], v227 offset:51200
ds_read_b128 v[100:103], v7 offset:33792
v_mfma_f32_16x16x32_bf16 v[136:139], v[48:51], v[36:39], v[136:139]
ds_read_b128 v[104:107], v7 offset:34816
ds_read_b128 v[108:111], v7 offset:35840
v_mfma_f32_16x16x32_bf16 v[144:147], v[48:51], v[40:43], v[144:147]
ds_read_b128 v[192:195], v7 offset:40960
v_mfma_f32_16x16x32_bf16 v[148:151], v[52:55], v[40:43], v[148:151]
ds_read_b64_tr_b16 v[208:209], v226 offset:53248
v_mfma_f32_16x16x32_bf16 v[156:159], v[52:55], v[44:47], v[156:159]
ds_read_b64_tr_b16 v[210:211], v226 offset:55296
v_mfma_f32_16x16x32_bf16 v[152:155], v[48:51], v[44:47], v[152:155]
ds_read_b64_tr_b16 v[212:213], v227 offset:53248
v_mfma_f32_16x16x32_bf16 v[128:131], v[80:83], v[64:67], v[128:131]
ds_read_b64_tr_b16 v[214:215], v227 offset:55296
buffer_store_dwordx4 v[168:171], v2, s[84:87], s45 offen offset:2048 sc1
v_mfma_f32_16x16x32_bf16 v[132:135], v[84:87], v[64:67], v[132:135]
ds_read_b128 v[196:199], v7 offset:41984
v_mfma_f32_16x16x32_bf16 v[140:143], v[84:87], v[68:71], v[140:143]
ds_read_b128 v[200:203], v7 offset:43008
v_mfma_f32_16x16x32_bf16 v[136:139], v[80:83], v[68:71], v[136:139]
ds_read_b128 v[204:207], v7 offset:44032
v_mfma_f32_16x16x32_bf16 v[144:147], v[80:83], v[72:75], v[144:147]
v_mfma_f32_16x16x32_bf16 v[148:151], v[84:87], v[72:75], v[148:151]
v_mfma_f32_16x16x32_bf16 v[156:159], v[84:87], v[76:79], v[156:159]
v_mfma_f32_16x16x32_bf16 v[152:155], v[80:83], v[76:79], v[152:155]
s_waitcnt lgkmcnt(0)
s_barrier
v_mfma_f32_16x16x32_bf16 v[128:131], v[112:115], v[96:99], v[128:131]
ds_read_b128 v[32:35], v8 offset:0
ds_read_b64_tr_b16 v[48:49], v224 offset:0
v_mfma_f32_16x16x32_bf16 v[132:135], v[116:119], v[96:99], v[132:135]
ds_read_b64_tr_b16 v[50:51], v224 offset:2048
ds_read_b64_tr_b16 v[52:53], v225 offset:0
v_mfma_f32_16x16x32_bf16 v[140:143], v[116:119], v[100:103], v[140:143]
ds_read_b64_tr_b16 v[54:55], v225 offset:2048
ds_read_b128 v[36:39], v8 offset:1024
v_mfma_f32_16x16x32_bf16 v[136:139], v[112:115], v[100:103], v[136:139]
ds_read_b128 v[40:43], v8 offset:2048
ds_read_b128 v[44:47], v8 offset:3072
v_mfma_f32_16x16x32_bf16 v[144:147], v[112:115], v[104:107], v[144:147]
ds_read_b128 v[64:67], v8 offset:8192
v_mfma_f32_16x16x32_bf16 v[148:151], v[116:119], v[104:107], v[148:151]
ds_read_b64_tr_b16 v[80:81], v224 offset:4096
v_mfma_f32_16x16x32_bf16 v[156:159], v[116:119], v[108:111], v[156:159]
ds_read_b64_tr_b16 v[82:83], v224 offset:6144
v_mfma_f32_16x16x32_bf16 v[152:155], v[112:115], v[108:111], v[152:155]
ds_read_b64_tr_b16 v[84:85], v225 offset:4096
v_mfma_f32_16x16x32_bf16 v[128:131], v[208:211], v[192:195], v[128:131]
ds_read_b64_tr_b16 v[86:87], v225 offset:6144
buffer_store_dwordx4 v[172:175], v2, s[84:87], s45 offen offset:3072 sc1
v_mfma_f32_16x16x32_bf16 v[132:135], v[212:215], v[192:195], v[132:135]
ds_read_b128 v[68:71], v8 offset:9216
v_mfma_f32_16x16x32_bf16 v[140:143], v[212:215], v[196:199], v[140:143]
ds_read_b128 v[72:75], v8 offset:10240
v_mfma_f32_16x16x32_bf16 v[136:139], v[208:211], v[196:199], v[136:139]
ds_read_b128 v[76:79], v8 offset:11264
v_mfma_f32_16x16x32_bf16 v[144:147], v[208:211], v[200:203], v[144:147]
v_mfma_f32_16x16x32_bf16 v[148:151], v[212:215], v[200:203], v[148:151]
v_mfma_f32_16x16x32_bf16 v[156:159], v[212:215], v[204:207], v[156:159]
s_branch Lov_12
.p2align 12
Lst_12_0:
s_branch Lwr_152
Lst_12_1:
s_branch Lst_16_0
s_nop 0
Lov_12:
v_mfma_f32_16x16x32_bf16 v[152:155], v[208:211], v[204:207], v[152:155]
s_waitcnt lgkmcnt(0)
s_barrier
v_mfma_f32_16x16x32_bf16 v[128:131], v[48:51], v[32:35], v[128:131]
ds_read_b128 v[96:99], v6 offset:16384
ds_read_b64_tr_b16 v[112:113], v224 offset:32768
v_mfma_f32_16x16x32_bf16 v[132:135], v[52:55], v[32:35], v[132:135]
ds_read_b64_tr_b16 v[114:115], v224 offset:34816
ds_read_b64_tr_b16 v[116:117], v225 offset:32768
v_mfma_f32_16x16x32_bf16 v[140:143], v[52:55], v[36:39], v[140:143]
ds_read_b64_tr_b16 v[118:119], v225 offset:34816
ds_read_b128 v[100:103], v6 offset:17408
v_mfma_f32_16x16x32_bf16 v[136:139], v[48:51], v[36:39], v[136:139]
ds_read_b128 v[104:107], v6 offset:18432
ds_read_b128 v[108:111], v6 offset:19456
v_mfma_f32_16x16x32_bf16 v[144:147], v[48:51], v[40:43], v[144:147]
ds_read_b128 v[192:195], v6 offset:24576
v_mfma_f32_16x16x32_bf16 v[148:151], v[52:55], v[40:43], v[148:151]
ds_read_b64_tr_b16 v[208:209], v224 offset:36864
v_mfma_f32_16x16x32_bf16 v[156:159], v[52:55], v[44:47], v[156:159]
ds_read_b64_tr_b16 v[210:211], v224 offset:38912
v_mfma_f32_16x16x32_bf16 v[152:155], v[48:51], v[44:47], v[152:155]
ds_read_b64_tr_b16 v[212:213], v225 offset:36864
v_mfma_f32_16x16x32_bf16 v[128:131], v[80:83], v[64:67], v[128:131]
ds_read_b64_tr_b16 v[214:215], v225 offset:38912
v_mfma_f32_16x16x32_bf16 v[132:135], v[84:87], v[64:67], v[132:135]
ds_read_b128 v[196:199], v6 offset:25600
v_mfma_f32_16x16x32_bf16 v[140:143], v[84:87], v[68:71], v[140:143]
ds_read_b128 v[200:203], v6 offset:26624
v_mfma_f32_16x16x32_bf16 v[136:139], v[80:83], v[68:71], v[136:139]
ds_read_b128 v[204:207], v6 offset:27648
v_mfma_f32_16x16x32_bf16 v[144:147], v[80:83], v[72:75], v[144:147]
v_mfma_f32_16x16x32_bf16 v[148:151], v[84:87], v[72:75], v[148:151]
v_mfma_f32_16x16x32_bf16 v[156:159], v[84:87], v[76:79], v[156:159]
v_mfma_f32_16x16x32_bf16 v[152:155], v[80:83], v[76:79], v[152:155]
s_waitcnt vmcnt(0)
s_waitcnt lgkmcnt(0)
s_barrier
v_mfma_f32_16x16x32_bf16 v[128:131], v[112:115], v[96:99], v[128:131]
ds_read_b128 v[32:35], v6 offset:49152
ds_read_b64_tr_b16 v[48:49], v226 offset:0
v_mfma_f32_16x16x32_bf16 v[132:135], v[116:119], v[96:99], v[132:135]
ds_read_b64_tr_b16 v[50:51], v226 offset:2048
ds_read_b64_tr_b16 v[52:53], v227 offset:0
v_mfma_f32_16x16x32_bf16 v[140:143], v[116:119], v[100:103], v[140:143]
ds_read_b64_tr_b16 v[54:55], v227 offset:2048
ds_read_b128 v[36:39], v6 offset:50176
v_mfma_f32_16x16x32_bf16 v[136:139], v[112:115], v[100:103], v[136:139]
ds_read_b128 v[40:43], v6 offset:51200
ds_read_b128 v[44:47], v6 offset:52224
v_mfma_f32_16x16x32_bf16 v[144:147], v[112:115], v[104:107], v[144:147]
ds_read_b128 v[64:67], v6 offset:57344
v_mfma_f32_16x16x32_bf16 v[148:151], v[116:119], v[104:107], v[148:151]
ds_read_b64_tr_b16 v[80:81], v226 offset:4096
v_mfma_f32_16x16x32_bf16 v[156:159], v[116:119], v[108:111], v[156:159]
ds_read_b64_tr_b16 v[82:83], v226 offset:6144
v_mfma_f32_16x16x32_bf16 v[152:155], v[112:115], v[108:111], v[152:155]
ds_read_b64_tr_b16 v[84:85], v227 offset:4096
v_mfma_f32_16x16x32_bf16 v[128:131], v[208:211], v[192:195], v[128:131]
ds_read_b64_tr_b16 v[86:87], v227 offset:6144
v_mfma_f32_16x16x32_bf16 v[132:135], v[212:215], v[192:195], v[132:135]
ds_read_b128 v[68:71], v6 offset:58368
v_mfma_f32_16x16x32_bf16 v[140:143], v[212:215], v[196:199], v[140:143]
ds_read_b128 v[72:75], v6 offset:59392
v_mfma_f32_16x16x32_bf16 v[136:139], v[208:211], v[196:199], v[136:139]
ds_read_b128 v[76:79], v6 offset:60416
v_mfma_f32_16x16x32_bf16 v[144:147], v[208:211], v[200:203], v[144:147]
v_mfma_f32_16x16x32_bf16 v[148:151], v[212:215], v[200:203], v[148:151]
v_mfma_f32_16x16x32_bf16 v[156:159], v[212:215], v[204:207], v[156:159]
v_mfma_f32_16x16x32_bf16 v[152:155], v[208:211], v[204:207], v[152:155]
s_waitcnt lgkmcnt(0)
s_barrier
v_mfma_f32_16x16x32_bf16 v[128:131], v[48:51], v[32:35], v[128:131]
ds_read_b128 v[96:99], v7 offset:16384
ds_read_b64_tr_b16 v[112:113], v228 offset:16384
v_mfma_f32_16x16x32_bf16 v[132:135], v[52:55], v[32:35], v[132:135]
ds_read_b64_tr_b16 v[114:115], v228 offset:18432
ds_read_b64_tr_b16 v[116:117], v229 offset:16384
v_mfma_f32_16x16x32_bf16 v[140:143], v[52:55], v[36:39], v[140:143]
ds_read_b64_tr_b16 v[118:119], v229 offset:18432
ds_read_b128 v[100:103], v7 offset:17408
v_mfma_f32_16x16x32_bf16 v[136:139], v[48:51], v[36:39], v[136:139]
ds_read_b128 v[104:107], v7 offset:18432
ds_read_b128 v[108:111], v7 offset:19456
v_mfma_f32_16x16x32_bf16 v[144:147], v[48:51], v[40:43], v[144:147]
ds_read_b128 v[192:195], v7 offset:24576
v_mfma_f32_16x16x32_bf16 v[148:151], v[52:55], v[40:43], v[148:151]
ds_read_b64_tr_b16 v[208:209], v228 offset:20480
v_mfma_f32_16x16x32_bf16 v[156:159], v[52:55], v[44:47], v[156:159]
ds_read_b64_tr_b16 v[210:211], v228 offset:22528
v_mfma_f32_16x16x32_bf16 v[152:155], v[48:51], v[44:47], v[152:155]
ds_read_b64_tr_b16 v[212:213], v229 offset:20480
v_mfma_f32_16x16x32_bf16 v[128:131], v[80:83], v[64:67], v[128:131]
ds_read_b64_tr_b16 v[214:215], v229 offset:22528
v_mfma_f32_16x16x32_bf16 v[132:135], v[84:87], v[64:67], v[132:135]
ds_read_b128 v[196:199], v7 offset:25600
v_mfma_f32_16x16x32_bf16 v[140:143], v[84:87], v[68:71], v[140:143]
ds_read_b128 v[200:203], v7 offset:26624
v_mfma_f32_16x16x32_bf16 v[136:139], v[80:83], v[68:71], v[136:139]
ds_read_b128 v[204:207], v7 offset:27648
v_mfma_f32_16x16x32_bf16 v[144:147], v[80:83], v[72:75], v[144:147]
v_mfma_f32_16x16x32_bf16 v[148:151], v[84:87], v[72:75], v[148:151]
v_mfma_f32_16x16x32_bf16 v[156:159], v[84:87], v[76:79], v[156:159]
v_mfma_f32_16x16x32_bf16 v[152:155], v[80:83], v[76:79], v[152:155]
s_waitcnt lgkmcnt(0)
s_barrier
v_mfma_f32_16x16x32_bf16 v[128:131], v[112:115], v[96:99], v[128:131]
ds_read_b128 v[32:35], v7 offset:32768
ds_read_b64_tr_b16 v[48:49], v226 offset:49152
v_mfma_f32_16x16x32_bf16 v[132:135], v[116:119], v[96:99], v[132:135]
ds_read_b64_tr_b16 v[50:51], v226 offset:51200
ds_read_b64_tr_b16 v[52:53], v227 offset:49152
v_mfma_f32_16x16x32_bf16 v[140:143], v[116:119], v[100:103], v[140:143]
ds_read_b64_tr_b16 v[54:55], v227 offset:51200
ds_read_b128 v[36:39], v7 offset:33792
v_mfma_f32_16x16x32_bf16 v[136:139], v[112:115], v[100:103], v[136:139]
ds_read_b128 v[40:43], v7 offset:34816
ds_read_b128 v[44:47], v7 offset:35840
v_mfma_f32_16x16x32_bf16 v[144:147], v[112:115], v[104:107], v[144:147]
ds_read_b128 v[64:67], v7 offset:40960
v_mfma_f32_16x16x32_bf16 v[148:151], v[116:119], v[104:107], v[148:151]
ds_read_b64_tr_b16 v[80:81], v226 offset:53248
v_mfma_f32_16x16x32_bf16 v[156:159], v[116:119], v[108:111], v[156:159]
ds_read_b64_tr_b16 v[82:83], v226 offset:55296
v_mfma_f32_16x16x32_bf16 v[152:155], v[112:115], v[108:111], v[152:155]
ds_read_b64_tr_b16 v[84:85], v227 offset:53248
v_mfma_f32_16x16x32_bf16 v[128:131], v[208:211], v[192:195], v[128:131]
ds_read_b64_tr_b16 v[86:87], v227 offset:55296
v_mfma_f32_16x16x32_bf16 v[132:135], v[212:215], v[192:195], v[132:135]
ds_read_b128 v[68:71], v7 offset:41984
v_mfma_f32_16x16x32_bf16 v[140:143], v[212:215], v[196:199], v[140:143]
ds_read_b128 v[72:75], v7 offset:43008
v_mfma_f32_16x16x32_bf16 v[136:139], v[208:211], v[196:199], v[136:139]
ds_read_b128 v[76:79], v7 offset:44032
v_mfma_f32_16x16x32_bf16 v[144:147], v[208:211], v[200:203], v[144:147]
v_mfma_f32_16x16x32_bf16 v[148:151], v[212:215], v[200:203], v[148:151]
v_mfma_f32_16x16x32_bf16 v[156:159], v[212:215], v[204:207], v[156:159]
v_mfma_f32_16x16x32_bf16 v[152:155], v[208:211], v[204:207], v[152:155]
s_waitcnt lgkmcnt(0)
s_barrier
buffer_load_dwordx4 v[232:235], v2, s[84:87], s46 offen offset:0 sc1
buffer_load_dwordx4 v[236:239], v2, s[84:87], s46 offen offset:1024 sc1
buffer_load_dwordx4 v[240:243], v2, s[84:87], s46 offen offset:2048 sc1
buffer_load_dwordx4 v[244:247], v2, s[84:87], s46 offen offset:3072 sc1
v_mfma_f32_16x16x32_bf16 v[128:131], v[48:51], v[32:35], v[128:131]
ds_read_b128 v[96:99], v8 offset:0
ds_read_b64_tr_b16 v[112:113], v224 offset:0
v_mfma_f32_16x16x32_bf16 v[132:135], v[52:55], v[32:35], v[132:135]
ds_read_b64_tr_b16 v[114:115], v224 offset:2048
ds_read_b64_tr_b16 v[116:117], v225 offset:0
v_mfma_f32_16x16x32_bf16 v[140:143], v[52:55], v[36:39], v[140:143]
ds_read_b64_tr_b16 v[118:119], v225 offset:2048
ds_read_b128 v[100:103], v8 offset:1024
v_mfma_f32_16x16x32_bf16 v[136:139], v[48:51], v[36:39], v[136:139]
ds_read_b128 v[104:107], v8 offset:2048
ds_read_b128 v[108:111], v8 offset:3072
v_mfma_f32_16x16x32_bf16 v[144:147], v[48:51], v[40:43], v[144:147]
ds_read_b128 v[192:195], v8 offset:8192
v_mfma_f32_16x16x32_bf16 v[148:151], v[52:55], v[40:43], v[148:151]
ds_read_b64_tr_b16 v[208:209], v224 offset:4096
v_mfma_f32_16x16x32_bf16 v[156:159], v[52:55], v[44:47], v[156:159]
ds_read_b64_tr_b16 v[210:211], v224 offset:6144
v_mfma_f32_16x16x32_bf16 v[152:155], v[48:51], v[44:47], v[152:155]
ds_read_b64_tr_b16 v[212:213], v225 offset:4096
v_mfma_f32_16x16x32_bf16 v[128:131], v[80:83], v[64:67], v[128:131]
ds_read_b64_tr_b16 v[214:215], v225 offset:6144
v_mfma_f32_16x16x32_bf16 v[132:135], v[84:87], v[64:67], v[132:135]
ds_read_b128 v[196:199], v8 offset:9216
v_mfma_f32_16x16x32_bf16 v[140:143], v[84:87], v[68:71], v[140:143]
ds_read_b128 v[200:203], v8 offset:10240
v_mfma_f32_16x16x32_bf16 v[136:139], v[80:83], v[68:71], v[136:139]
ds_read_b128 v[204:207], v8 offset:11264
v_mfma_f32_16x16x32_bf16 v[144:147], v[80:83], v[72:75], v[144:147]
v_mfma_f32_16x16x32_bf16 v[148:151], v[84:87], v[72:75], v[148:151]
v_mfma_f32_16x16x32_bf16 v[156:159], v[84:87], v[76:79], v[156:159]
v_mfma_f32_16x16x32_bf16 v[152:155], v[80:83], v[76:79], v[152:155]
s_waitcnt lgkmcnt(0)
s_barrier
v_mfma_f32_16x16x32_bf16 v[128:131], v[112:115], v[96:99], v[128:131]
ds_read_b128 v[32:35], v6 offset:16384
ds_read_b64_tr_b16 v[48:49], v224 offset:32768
v_mfma_f32_16x16x32_bf16 v[132:135], v[116:119], v[96:99], v[132:135]
ds_read_b64_tr_b16 v[50:51], v224 offset:34816
ds_read_b64_tr_b16 v[52:53], v225 offset:32768
v_mfma_f32_16x16x32_bf16 v[140:143], v[116:119], v[100:103], v[140:143]
ds_read_b64_tr_b16 v[54:55], v225 offset:34816
ds_read_b128 v[36:39], v6 offset:17408
v_mfma_f32_16x16x32_bf16 v[136:139], v[112:115], v[100:103], v[136:139]
ds_read_b128 v[40:43], v6 offset:18432
ds_read_b128 v[44:47], v6 offset:19456
v_mfma_f32_16x16x32_bf16 v[144:147], v[112:115], v[104:107], v[144:147]
ds_read_b128 v[64:67], v6 offset:24576
v_mfma_f32_16x16x32_bf16 v[148:151], v[116:119], v[104:107], v[148:151]
ds_read_b64_tr_b16 v[80:81], v224 offset:36864
v_mfma_f32_16x16x32_bf16 v[156:159], v[116:119], v[108:111], v[156:159]
ds_read_b64_tr_b16 v[82:83], v224 offset:38912
v_mfma_f32_16x16x32_bf16 v[152:155], v[112:115], v[108:111], v[152:155]
ds_read_b64_tr_b16 v[84:85], v225 offset:36864
v_mfma_f32_16x16x32_bf16 v[128:131], v[208:211], v[192:195], v[128:131]
ds_read_b64_tr_b16 v[86:87], v225 offset:38912
v_mfma_f32_16x16x32_bf16 v[132:135], v[212:215], v[192:195], v[132:135]
ds_read_b128 v[68:71], v6 offset:25600
v_mfma_f32_16x16x32_bf16 v[140:143], v[212:215], v[196:199], v[140:143]
ds_read_b128 v[72:75], v6 offset:26624
v_mfma_f32_16x16x32_bf16 v[136:139], v[208:211], v[196:199], v[136:139]
ds_read_b128 v[76:79], v6 offset:27648
v_mfma_f32_16x16x32_bf16 v[144:147], v[208:211], v[200:203], v[144:147]
v_mfma_f32_16x16x32_bf16 v[148:151], v[212:215], v[200:203], v[148:151]
v_mfma_f32_16x16x32_bf16 v[156:159], v[212:215], v[204:207], v[156:159]
v_mfma_f32_16x16x32_bf16 v[152:155], v[208:211], v[204:207], v[152:155]
s_waitcnt lgkmcnt(0)
s_barrier
v_mfma_f32_16x16x32_bf16 v[128:131], v[48:51], v[32:35], v[128:131]
ds_read_b128 v[96:99], v6 offset:49152
ds_read_b64_tr_b16 v[112:113], v226 offset:0
v_mfma_f32_16x16x32_bf16 v[132:135], v[52:55], v[32:35], v[132:135]
ds_read_b64_tr_b16 v[114:115], v226 offset:2048
ds_read_b64_tr_b16 v[116:117], v227 offset:0
v_mfma_f32_16x16x32_bf16 v[140:143], v[52:55], v[36:39], v[140:143]
ds_read_b64_tr_b16 v[118:119], v227 offset:2048
ds_read_b128 v[100:103], v6 offset:50176
v_mfma_f32_16x16x32_bf16 v[136:139], v[48:51], v[36:39], v[136:139]
ds_read_b128 v[104:107], v6 offset:51200
ds_read_b128 v[108:111], v6 offset:52224
v_mfma_f32_16x16x32_bf16 v[144:147], v[48:51], v[40:43], v[144:147]
ds_read_b128 v[192:195], v6 offset:57344
v_mfma_f32_16x16x32_bf16 v[148:151], v[52:55], v[40:43], v[148:151]
ds_read_b64_tr_b16 v[208:209], v226 offset:4096
v_mfma_f32_16x16x32_bf16 v[156:159], v[52:55], v[44:47], v[156:159]
ds_read_b64_tr_b16 v[210:211], v226 offset:6144
v_mfma_f32_16x16x32_bf16 v[152:155], v[48:51], v[44:47], v[152:155]
ds_read_b64_tr_b16 v[212:213], v227 offset:4096
v_mfma_f32_16x16x32_bf16 v[128:131], v[80:83], v[64:67], v[128:131]
ds_read_b64_tr_b16 v[214:215], v227 offset:6144
v_mfma_f32_16x16x32_bf16 v[132:135], v[84:87], v[64:67], v[132:135]
ds_read_b128 v[196:199], v6 offset:58368
v_mfma_f32_16x16x32_bf16 v[140:143], v[84:87], v[68:71], v[140:143]
ds_read_b128 v[200:203], v6 offset:59392
v_mfma_f32_16x16x32_bf16 v[136:139], v[80:83], v[68:71], v[136:139]
ds_read_b128 v[204:207], v6 offset:60416
v_mfma_f32_16x16x32_bf16 v[144:147], v[80:83], v[72:75], v[144:147]
v_mfma_f32_16x16x32_bf16 v[148:151], v[84:87], v[72:75], v[148:151]
v_mfma_f32_16x16x32_bf16 v[156:159], v[84:87], v[76:79], v[156:159]
v_mfma_f32_16x16x32_bf16 v[152:155], v[80:83], v[76:79], v[152:155]
s_waitcnt vmcnt(0)
s_waitcnt lgkmcnt(0)
s_barrier
v_mfma_f32_16x16x32_bf16 v[128:131], v[112:115], v[96:99], v[128:131]
v_lshlrev_b32 v160, 16, v232
v_and_b32 v161, 0xffff0000, v232
v_mfma_f32_16x16x32_bf16 v[132:135], v[116:119], v[96:99], v[132:135]
v_lshlrev_b32 v162, 16, v233
v_and_b32 v163, 0xffff0000, v233
v_mfma_f32_16x16x32_bf16 v[140:143], v[116:119], v[100:103], v[140:143]
v_lshlrev_b32 v164, 16, v234
v_and_b32 v165, 0xffff0000, v234
v_mfma_f32_16x16x32_bf16 v[136:139], v[112:115], v[100:103], v[136:139]
v_lshlrev_b32 v166, 16, v235
v_and_b32 v167, 0xffff0000, v235
v_mfma_f32_16x16x32_bf16 v[144:147], v[112:115], v[104:107], v[144:147]
v_lshlrev_b32 v168, 16, v236
v_and_b32 v169, 0xffff0000, v236
v_mfma_f32_16x16x32_bf16 v[148:151], v[116:119], v[104:107], v[148:151]
v_lshlrev_b32 v170, 16, v237
v_and_b32 v171, 0xffff0000, v237
v_mfma_f32_16x16x32_bf16 v[156:159], v[116:119], v[108:111], v[156:159]
v_lshlrev_b32 v172, 16, v238
v_and_b32 v173, 0xffff0000, v238
v_mfma_f32_16x16x32_bf16 v[152:155], v[112:115], v[108:111], v[152:155]
v_lshlrev_b32 v174, 16, v239
v_and_b32 v175, 0xffff0000, v239
v_mfma_f32_16x16x32_bf16 v[128:131], v[208:211], v[192:195], v[128:131]
v_lshlrev_b32 v176, 16, v240
v_and_b32 v177, 0xffff0000, v240
v_mfma_f32_16x16x32_bf16 v[132:135], v[212:215], v[192:195], v[132:135]
v_lshlrev_b32 v178, 16, v241
v_and_b32 v179, 0xffff0000, v241
v_mfma_f32_16x16x32_bf16 v[140:143], v[212:215], v[196:199], v[140:143]
v_lshlrev_b32 v180, 16, v242
v_and_b32 v181, 0xffff0000, v242
v_mfma_f32_16x16x32_bf16 v[136:139], v[208:211], v[196:199], v[136:139]
v_lshlrev_b32 v182, 16, v243
v_and_b32 v183, 0xffff0000, v243
v_mfma_f32_16x16x32_bf16 v[144:147], v[208:211], v[200:203], v[144:147]
v_lshlrev_b32 v184, 16, v244
v_and_b32 v185, 0xffff0000, v244
v_mfma_f32_16x16x32_bf16 v[148:151], v[212:215], v[200:203], v[148:151]
v_lshlrev_b32 v186, 16, v245
v_and_b32 v187, 0xffff0000, v245
v_mfma_f32_16x16x32_bf16 v[156:159], v[212:215], v[204:207], v[156:159]
v_lshlrev_b32 v188, 16, v246
v_and_b32 v189, 0xffff0000, v246
v_mfma_f32_16x16x32_bf16 v[152:155], v[208:211], v[204:207], v[152:155]
v_lshlrev_b32 v190, 16, v247
v_and_b32 v191, 0xffff0000, v247
s_nop 1
v_pk_add_f32 v[128:129], v[128:129], v[160:161]
v_pk_add_f32 v[130:131], v[130:131], v[162:163]
v_pk_add_f32 v[132:133], v[132:133], v[164:165]
v_pk_add_f32 v[134:135], v[134:135], v[166:167]
v_cvt_pk_bf16_f32 v32, v128, v129
v_cvt_pk_bf16_f32 v33, v130, v131
v_cvt_pk_bf16_f32 v34, v132, v133
v_cvt_pk_bf16_f32 v35, v134, v135
v_pk_add_f32 v[136:137], v[136:137], v[168:169]
v_pk_add_f32 v[138:139], v[138:139], v[170:171]
v_pk_add_f32 v[140:141], v[140:141], v[172:173]
v_pk_add_f32 v[142:143], v[142:143], v[174:175]
v_cvt_pk_bf16_f32 v36, v136, v137
v_cvt_pk_bf16_f32 v37, v138, v139
v_cvt_pk_bf16_f32 v38, v140, v141
v_cvt_pk_bf16_f32 v39, v142, v143
v_permlane16_swap_b32 v32, v34
v_permlane16_swap_b32 v33, v35
buffer_store_dwordx4 v[32:35], v230, s[20:23], s54 offen offset:0 nt
v_pk_add_f32 v[144:145], v[144:145], v[176:177]
v_pk_add_f32 v[146:147], v[146:147], v[178:179]
v_pk_add_f32 v[148:149], v[148:149], v[180:181]
v_pk_add_f32 v[150:151], v[150:151], v[182:183]
v_cvt_pk_bf16_f32 v40, v144, v145
v_cvt_pk_bf16_f32 v41, v146, v147
v_cvt_pk_bf16_f32 v42, v148, v149
v_cvt_pk_bf16_f32 v43, v150, v151
v_permlane16_swap_b32 v36, v38
v_permlane16_swap_b32 v37, v39
buffer_store_dwordx4 v[36:39], v230, s[20:23], s54 offen offset:2048 nt
v_pk_add_f32 v[152:153], v[152:153], v[184:185]
v_pk_add_f32 v[154:155], v[154:155], v[186:187]
v_pk_add_f32 v[156:157], v[156:157], v[188:189]
v_pk_add_f32 v[158:159], v[158:159], v[190:191]
v_cvt_pk_bf16_f32 v44, v152, v153
v_cvt_pk_bf16_f32 v45, v154, v155
v_cvt_pk_bf16_f32 v46, v156, v157
v_cvt_pk_bf16_f32 v47, v158, v159
v_permlane16_swap_b32 v40, v42
v_permlane16_swap_b32 v41, v43
buffer_store_dwordx4 v[40:43], v230, s[20:23], s55 offen offset:0 nt
s_nop 1
v_permlane16_swap_b32 v44, v46
v_permlane16_swap_b32 v45, v47
buffer_store_dwordx4 v[44:47], v230, s[20:23], s55 offen offset:2048 nt
s_branch Ldone_1
Lgb_91:
s_mul_i32 s43, s34, 262144
s_add_u32 s8, s82, s43
s_addc_u32 s9, s83, 0
s_add_u32 s8, s8, 4194304
s_addc_u32 s9, s9, 0
s_mov_b32 s10, 262144
s_mov_b32 s11, 0x20000
s_lshl_b32 s39, s36, 12
v_lshlrev_b32 v2, 4, v1
v_add_u32 v3, s39, v2
s_add_u32 s37, s35, 0
s_and_b32 s37, s37, 15
s_mul_i32 s37, s37, 16384
s_add_u32 m0, s39, 0
s_nop 0
buffer_load_dwordx4 v3, s[8:11], s37 offen sc1 lds
buffer_load_dwordx4 v3, s[8:11], s37 offen offset:1024 sc1 lds
buffer_load_dwordx4 v3, s[8:11], s37 offen offset:2048 sc1 lds
buffer_load_dwordx4 v3, s[8:11], s37 offen offset:3072 sc1 lds
s_mul_i32 s43, s34, 262144
s_add_u32 s8, s82, s43
s_addc_u32 s9, s83, 0
s_add_u32 s8, s8, 4194304
s_addc_u32 s9, s9, 0
s_mov_b32 s10, 262144
s_mov_b32 s11, 0x20000
s_mul_i32 s43, s34, 917504
s_add_u32 s24, s82, s43
s_addc_u32 s25, s83, 0
s_add_u32 s24, s24, 8388608
s_addc_u32 s25, s25, 0
s_mov_b32 s26, 917504
s_mov_b32 s27, 0x20000
s_add_u32 s84, s82, 27262976
s_addc_u32 s85, s83, 0
s_mov_b32 s86, 229376
s_mov_b32 s87, 0x20000
s_and_b32 s47, s36, 3
s_lshr_b32 s62, s47, 1
s_and_b32 s63, s47, 1
v_lshlrev_b32 v2, 4, v1
s_lshl_b32 s39, s47, 12
v_add_u32 v3, s39, v2
s_cmp_eq_u32 s62, 0
s_cselect_b32 s44, s72, s74
s_cselect_b32 s45, s73, s75
s_lshl_b32 s43, s35, 8
s_add_u32 s12, s44, s43
s_addc_u32 s13, s45, 0
s_mov_b32 s14, 7333120
s_mov_b32 s15, 0x20000
v_lshrrev_b32 v28, 4, v1
v_lshlrev_b32 v29, 1, v28
v_and_b32 v4, 15, v1
v_xor_b32 v4, v4, v29
v_lshlrev_b32 v4, 4, v4
v_mul_u32_u24 v28, 7168, v28
v_add_u32 v4, v4, v28
s_mul_i32 s43, s63, 229376
v_add_u32 v4, s43, v4
v_xor_b32 v5, 128, v4
v_add_u32 v5, 28672, v5
s_lshl_b32 s40, s47, 13
s_add_u32 s40, s40, 16384
s_lshl_b32 s43, s62, 12
v_add_u32 v9, s43, v2
v_add_u32 v10, 98304, v9
v_mov_b32 v6, v192
v_mov_b32 v7, v193
v_mov_b32 v8, v194
v_mov_b32 v24, v195
s_mul_i32 s43, s34, 16384
s_add_u32 s20, s82, s43
s_addc_u32 s21, s83, 0
s_add_u32 s20, s20, 25165824
s_addc_u32 s21, s21, 0
s_mov_b32 s22, 16384
s_mov_b32 s23, 0x20000
s_add_u32 s38, s35, 2
s_and_b32 s38, s38, 15
s_mul_i32 s38, s38, 458752
s_add_u32 m0, s50, 98304
s_nop 0
buffer_load_dwordx4 v6, s[16:19], s38 offen lds
s_add_u32 m0, s50, 99328
s_nop 0
buffer_load_dwordx4 v7, s[16:19], s38 offen lds
s_add_u32 m0, s50, 100352
s_nop 0
buffer_load_dwordx4 v8, s[16:19], s38 offen lds
s_add_u32 m0, s50, 101376
s_add_u32 s38, s38, 114688
buffer_load_dwordx4 v6, s[16:19], s38 offen lds
s_add_u32 m0, s50, 102400
s_nop 0
buffer_load_dwordx4 v7, s[16:19], s38 offen lds
s_add_u32 m0, s50, 103424
s_nop 0
buffer_load_dwordx4 v8, s[16:19], s38 offen lds
s_cmp_eq_u32 s47, 1
s_cbranch_scc0 Lw_117
s_lshl_b32 s92, s34, 7
s_add_u32 s92, s92, 28313600
s_mov_b32 s41, 0x40000
Lpoll_118:
s_load_dword s93, s[82:83], s92 glc
Lpchk_120:
s_waitcnt lgkmcnt(0)
s_cmp_eq_u32 s93, 16
s_cbranch_scc1 Lpok_119
s_sub_u32 s41, s41, 1
s_cmp_lg_u32 s41, 0
s_cbranch_scc1 Lpoll_118
Lpok_119:
Lw_117:
s_waitcnt vmcnt(0)
s_barrier
s_add_u32 s37, s35, 1
s_and_b32 s37, s37, 15
s_mul_i32 s37, s37, 16384
s_add_u32 m0, s39, 49152
s_nop 0
buffer_load_dwordx4 v3, s[8:11], s37 offen sc1 lds
buffer_load_dwordx4 v3, s[8:11], s37 offen offset:1024 sc1 lds
buffer_load_dwordx4 v3, s[8:11], s37 offen offset:2048 sc1 lds
buffer_load_dwordx4 v3, s[8:11], s37 offen offset:3072 sc1 lds
s_add_u32 s37, s35, 2
s_and_b32 s37, s37, 15
s_mul_i32 s37, s37, 16384
s_add_u32 m0, s39, 98304
s_nop 0
buffer_load_dwordx4 v3, s[8:11], s37 offen sc1 lds
buffer_load_dwordx4 v3, s[8:11], s37 offen offset:1024 sc1 lds
buffer_load_dwordx4 v3, s[8:11], s37 offen offset:2048 sc1 lds
buffer_load_dwordx4 v3, s[8:11], s37 offen offset:3072 sc1 lds
buffer_load_dwordx4 v[96:99], v3, s[20:23], 0 offen offset:0 sc1
buffer_load_dwordx4 v[100:103], v3, s[20:23], 0 offen offset:1024 sc1
buffer_load_dwordx4 v[104:107], v3, s[20:23], 0 offen offset:2048 sc1
buffer_load_dwordx4 v[108:111], v3, s[20:23], 0 offen offset:3072 sc1
s_and_b32 s44, s36, 3
s_mul_i32 s44, s44, 14
s_bfe_u32 s43, s2, 0x30001
s_lshl_b32 s43, s43, 7
s_add_u32 s44, s44, s43
s_add_u32 s44, s44, 72
s_mul_i32 s44, s44, 7168
s_lshr_b32 s43, s2, 4
s_lshl_b32 s43, s43, 8
s_add_u32 s43, s43, s44
s_bitcmp0_b32 s2, 0
s_cselect_b32 s4, s72, s74
s_cselect_b32 s5, s73, s75
s_add_u32 s4, s4, s43
s_addc_u32 s5, s5, 0
s_waitcnt vmcnt(8)
s_barrier
s_cmp_eq_u32 s47, 3
s_cbranch_scc0 Lw_121
v_and_b32 v30, 31, v1
v_lshlrev_b32 v30, 4, v30
v_add_u32 v31, 151552, v30
ds_read_b128 v[112:115], v31 offset:0
ds_read_b128 v[116:119], v31 offset:512
ds_read_b128 v[120:123], v31 offset:1024
ds_read_b128 v[124:127], v31 offset:1536
s_and_b32 s44, s2, 15
s_mul_i32 s44, s44, 14336
s_lshr_b32 s43, s2, 4
s_lshl_b32 s43, s43, 9
s_add_u32 s44, s44, s43
s_add_u32 s44, s44, 8192
s_cmp_lt_u32 s2, 192
s_cselect_b32 s44, s44, 0x7fffffff
s_waitcnt lgkmcnt(0)
v_add_f32 v112, v112, v116
v_add_f32 v120, v120, v124
v_add_f32 v113, v113, v117
v_add_f32 v121, v121, v125
v_add_f32 v114, v114, v118
v_add_f32 v122, v122, v126
v_add_f32 v115, v115, v119
v_add_f32 v123, v123, v127
v_add_f32 v112, v112, v120
v_add_f32 v113, v113, v121
v_add_f32 v114, v114, v122
v_add_f32 v115, v115, v123
s_mov_b64 exec, 0xffffffff
buffer_store_dwordx4 v[112:115], v30, s[84:87], s44 offen sc1
s_mov_b64 exec, -1
Lw_121:
s_waitcnt lgkmcnt(0)
s_add_u32 s37, s35, 3
s_and_b32 s37, s37, 15
s_mul_i32 s37, s37, 16384
s_add_u32 m0, s39, 0
s_nop 0
buffer_load_dwordx4 v3, s[8:11], s37 offen sc1 lds
buffer_load_dwordx4 v3, s[8:11], s37 offen offset:1024 sc1 lds
s_load_dword s3, s[4:5], 78848
buffer_load_dwordx4 v3, s[8:11], s37 offen offset:2048 sc1 lds
s_load_dword s3, s[4:5], 78912
buffer_load_dwordx4 v3, s[8:11], s37 offen offset:3072 sc1 lds
s_load_dword s3, s[4:5], 78976
s_add_u32 s38, s35, 3
s_and_b32 s38, s38, 15
s_mul_i32 s38, s38, 458752
s_add_u32 m0, s50, 0
s_nop 0
buffer_load_dwordx4 v6, s[16:19], s38 offen lds
s_load_dword s3, s[4:5], 79040
s_add_u32 m0, s50, 1024
s_nop 0
buffer_load_dwordx4 v7, s[16:19], s38 offen lds
s_load_dword s3, s[4:5], 86016
s_add_u32 m0, s50, 2048
s_nop 0
buffer_load_dwordx4 v8, s[16:19], s38 offen lds
s_load_dword s3, s[4:5], 86080
s_add_u32 m0, s50, 3072
s_add_u32 s38, s38, 114688
buffer_load_dwordx4 v6, s[16:19], s38 offen lds
s_load_dword s3, s[4:5], 86144
s_add_u32 m0, s50, 4096
s_nop 0
buffer_load_dwordx4 v7, s[16:19], s38 offen lds
s_add_u32 m0, s50, 5120
s_nop 0
buffer_load_dwordx4 v8, s[16:19], s38 offen lds
s_waitcnt vmcnt(14)
s_barrier
s_add_u32 s37, s35, 4
s_and_b32 s37, s37, 15
s_mul_i32 s37, s37, 16384
s_add_u32 m0, s39, 49152
s_nop 0
buffer_load_dwordx4 v3, s[8:11], s37 offen sc1 lds
buffer_load_dwordx4 v3, s[8:11], s37 offen offset:1024 sc1 lds
buffer_load_dwordx4 v3, s[8:11], s37 offen offset:2048 sc1 lds
buffer_load_dwordx4 v3, s[8:11], s37 offen offset:3072 sc1 lds
s_add_u32 s38, s35, 4
s_and_b32 s38, s38, 15
s_mul_i32 s38, s38, 458752
s_add_u32 m0, s50, 49152
s_nop 0
buffer_load_dwordx4 v6, s[16:19], s38 offen lds
s_add_u32 m0, s50, 50176
s_nop 0
buffer_load_dwordx4 v7, s[16:19], s38 offen lds
s_add_u32 m0, s50, 51200
s_nop 0
buffer_load_dwordx4 v8, s[16:19], s38 offen lds
s_add_u32 m0, s50, 52224
s_add_u32 s38, s38, 114688
buffer_load_dwordx4 v6, s[16:19], s38 offen lds
s_add_u32 m0, s50, 53248
s_nop 0
buffer_load_dwordx4 v7, s[16:19], s38 offen lds
s_add_u32 m0, s50, 54272
s_nop 0
buffer_load_dwordx4 v8, s[16:19], s38 offen lds
s_waitcnt vmcnt(10)
s_barrier
s_branch Lov_13
.p2align 12
Lst_13_0:
s_branch Lwr_153
Lst_13_1:
s_branch Lst_17_0
s_nop 0
Lov_13:
s_cmp_eq_u32 s47, 3
s_cbranch_scc0 Lw_122
s_cmp_lt_u32 s2, 192
s_cbranch_scc0 Lw_122
s_lshr_b32 s43, s2, 4
s_add_u32 s43, s43, 96
s_lshl_b32 s43, s43, 7
v_mov_b32 v30, s43
v_mov_b32 v31, 1
s_mov_b64 exec, 1
buffer_atomic_add v31, v30, s[56:59], 0 offen sc1
s_mov_b64 exec, -1
Lw_122:
s_waitcnt lgkmcnt(0)
s_add_u32 s37, s35, 5
s_and_b32 s37, s37, 15
s_mul_i32 s37, s37, 16384
s_add_u32 m0, s39, 98304
s_nop 0
buffer_load_dwordx4 v3, s[8:11], s37 offen sc1 lds
s_load_dword s3, s[4:5], 86208
s_load_dword s3, s[4:5], 93184
s_load_dword s3, s[4:5], 93248
s_load_dword s3, s[4:5], 93312
buffer_load_dwordx4 v3, s[8:11], s37 offen offset:1024 sc1 lds
s_load_dword s3, s[4:5], 93376
s_and_b32 s44, s36, 3
s_mul_i32 s43, s2, 28672
s_mul_i32 s44, s44, 7168
s_add_u32 s43, s43, s44
buffer_load_dwordx4 v3, s[8:11], s37 offen offset:2048 sc1 lds
s_add_u32 s4, s76, s43
s_addc_u32 s5, s77, 0
s_load_dword s3, s[4:5], 0
s_load_dword s3, s[4:5], 64
v_add_f32 v96, v96, v100
buffer_load_dwordx4 v3, s[8:11], s37 offen offset:3072 sc1 lds
v_add_f32 v97, v97, v101
v_add_f32 v98, v98, v102
v_add_f32 v99, v99, v103
v_add_f32 v104, v104, v108
v_add_f32 v105, v105, v109
s_add_u32 s38, s35, 5
s_and_b32 s38, s38, 15
s_mul_i32 s38, s38, 458752
s_add_u32 m0, s50, 98304
s_nop 0
buffer_load_dwordx4 v6, s[16:19], s38 offen lds
v_add_f32 v106, v106, v110
v_add_f32 v107, v107, v111
s_nop 0
v_permlane32_swap_b32 v96, v104
v_permlane32_swap_b32 v97, v105
s_add_u32 m0, s50, 99328
s_nop 0
buffer_load_dwordx4 v7, s[16:19], s38 offen lds
v_permlane32_swap_b32 v98, v106
v_permlane32_swap_b32 v99, v107
v_add_f32 v96, v96, v104
v_add_f32 v97, v97, v105
v_add_f32 v98, v98, v106
s_add_u32 m0, s50, 100352
s_nop 0
buffer_load_dwordx4 v8, s[16:19], s38 offen lds
v_add_f32 v99, v99, v107
v_mov_b32 v100, v96
v_mov_b32 v101, v97
v_mov_b32 v102, v98
v_mov_b32 v103, v99
s_add_u32 m0, s50, 101376
s_add_u32 s38, s38, 114688
buffer_load_dwordx4 v6, s[16:19], s38 offen lds
s_nop 0
v_permlane16_swap_b32 v96, v100
v_permlane16_swap_b32 v97, v101
v_permlane16_swap_b32 v98, v102
v_permlane16_swap_b32 v99, v103
s_add_u32 m0, s50, 102400
s_nop 0
buffer_load_dwordx4 v7, s[16:19], s38 offen lds
s_add_u32 m0, s50, 103424
s_nop 0
buffer_load_dwordx4 v8, s[16:19], s38 offen lds
s_waitcnt vmcnt(10)
s_barrier
s_add_u32 s37, s35, 6
s_and_b32 s37, s37, 15
s_mul_i32 s37, s37, 16384
s_add_u32 m0, s39, 0
s_nop 0
buffer_load_dwordx4 v3, s[8:11], s37 offen sc1 lds
v_add_f32 v96, v96, v100
v_add_f32 v97, v97, v101
v_add_f32 v98, v98, v102
buffer_load_dwordx4 v3, s[8:11], s37 offen offset:1024 sc1 lds
v_add_f32 v99, v99, v103
s_nop 0
v_add_f32_dpp v96, v96, v96 row_ror:8 row_mask:0xf bank_mask:0xf
buffer_load_dwordx4 v3, s[8:11], s37 offen offset:2048 sc1 lds
v_add_f32_dpp v97, v97, v97 row_ror:8 row_mask:0xf bank_mask:0xf
v_add_f32_dpp v98, v98, v98 row_ror:8 row_mask:0xf bank_mask:0xf
v_add_f32_dpp v99, v99, v99 row_ror:8 row_mask:0xf bank_mask:0xf
v_mul_f32 v96, 0x3a800000, v96
buffer_load_dwordx4 v3, s[8:11], s37 offen offset:3072 sc1 lds
v_mul_f32 v97, 0x3a800000, v97
v_mul_f32 v98, 0x3a800000, v98
v_mul_f32 v99, 0x3a800000, v99
s_add_u32 s38, s35, 6
s_and_b32 s38, s38, 15
s_mul_i32 s38, s38, 458752
s_add_u32 m0, s50, 0
s_nop 0
buffer_load_dwordx4 v6, s[16:19], s38 offen lds
v_fma_f32 v97, -v96, v96, v97
v_fma_f32 v99, -v98, v98, v99
v_max_f32 v97, 0, v97
s_add_u32 m0, s50, 1024
s_nop 0
buffer_load_dwordx4 v7, s[16:19], s38 offen lds
v_max_f32 v99, 0, v99
v_add_f32 v97, 0x3727c5ac, v97
v_add_f32 v99, 0x3727c5ac, v99
v_rsq_f32 v97, v97
s_add_u32 m0, s50, 2048
s_nop 0
buffer_load_dwordx4 v8, s[16:19], s38 offen lds
v_rsq_f32 v99, v99
v_and_b32 v100, 7, v1
s_lshl_b32 s43, s47, 8
s_add_u32 m0, s50, 3072
s_add_u32 s38, s38, 114688
buffer_load_dwordx4 v6, s[16:19], s38 offen lds
s_add_u32 s43, s43, 147456
v_lshl_add_u32 v100, v100, 4, s43
v_lshrrev_b32 v101, 5, v1
v_lshl_add_u32 v100, v101, 7, v100
s_add_u32 m0, s50, 4096
s_nop 0
buffer_load_dwordx4 v7, s[16:19], s38 offen lds
s_add_u32 m0, s50, 5120
s_nop 0
buffer_load_dwordx4 v8, s[16:19], s38 offen lds
s_waitcnt vmcnt(10)
s_barrier
ds_write_b128 v100, v[96:99]
s_waitcnt lgkmcnt(0)
s_add_u32 s37, s35, 7
s_and_b32 s37, s37, 15
s_mul_i32 s37, s37, 16384
s_add_u32 m0, s39, 49152
s_nop 0
buffer_load_dwordx4 v3, s[8:11], s37 offen sc1 lds
buffer_load_dwordx4 v3, s[8:11], s37 offen offset:1024 sc1 lds
s_load_dword s3, s[4:5], 128
buffer_load_dwordx4 v3, s[8:11], s37 offen offset:2048 sc1 lds
s_load_dword s3, s[4:5], 192
buffer_load_dwordx4 v3, s[8:11], s37 offen offset:3072 sc1 lds
s_load_dword s3, s[4:5], 256
s_add_u32 s38, s35, 7
s_and_b32 s38, s38, 15
s_mul_i32 s38, s38, 458752
s_add_u32 m0, s50, 49152
s_nop 0
buffer_load_dwordx4 v6, s[16:19], s38 offen lds
s_load_dword s3, s[4:5], 320
s_add_u32 m0, s50, 50176
s_nop 0
buffer_load_dwordx4 v7, s[16:19], s38 offen lds
s_load_dword s3, s[4:5], 384
s_add_u32 m0, s50, 51200
s_nop 0
buffer_load_dwordx4 v8, s[16:19], s38 offen lds
s_load_dword s3, s[4:5], 448
s_add_u32 m0, s50, 52224
s_add_u32 s38, s38, 114688
buffer_load_dwordx4 v6, s[16:19], s38 offen lds
s_load_dword s3, s[4:5], 512
s_add_u32 m0, s50, 53248
s_nop 0
buffer_load_dwordx4 v7, s[16:19], s38 offen lds
s_add_u32 m0, s50, 54272
s_nop 0
buffer_load_dwordx4 v8, s[16:19], s38 offen lds
s_waitcnt vmcnt(10)
s_barrier
s_add_u32 s37, s35, 8
s_and_b32 s37, s37, 15
s_mul_i32 s37, s37, 16384
s_add_u32 m0, s39, 98304
s_nop 0
buffer_load_dwordx4 v3, s[8:11], s37 offen sc1 lds
v_lshrrev_b32 v28, 2, v1
v_and_b32 v29, 7, v28
buffer_load_dwordx4 v3, s[8:11], s37 offen offset:1024 sc1 lds
v_mul_u32_u24 v28, 256, v28
v_lshl_add_u32 v28, v29, 5, v28
v_and_b32 v29, 3, v1
buffer_load_dwordx4 v3, s[8:11], s37 offen offset:2048 sc1 lds
v_lshl_add_u32 v11, v29, 3, v28
s_lshl_b32 s43, s63, 7
buffer_load_dwordx4 v3, s[8:11], s37 offen offset:3072 sc1 lds
v_xor_b32 v11, s43, v11
v_add_u32 v11, 16384, v11
v_xor_b32 v12, 32, v11
s_add_u32 s38, s35, 8
s_and_b32 s38, s38, 15
s_mul_i32 s38, s38, 458752
s_add_u32 m0, s50, 98304
s_nop 0
buffer_load_dwordx4 v6, s[16:19], s38 offen lds
v_xor_b32 v13, 64, v11
v_xor_b32 v14, 96, v11
s_add_u32 m0, s50, 99328
s_nop 0
buffer_load_dwordx4 v7, s[16:19], s38 offen lds
v_add_u32 v15, 49152, v11
v_add_u32 v16, 49152, v12
v_add_u32 v17, 49152, v13
s_add_u32 m0, s50, 100352
s_nop 0
buffer_load_dwordx4 v8, s[16:19], s38 offen lds
v_add_u32 v18, 49152, v14
v_add_u32 v19, 98304, v11
s_add_u32 m0, s50, 101376
s_add_u32 s38, s38, 114688
buffer_load_dwordx4 v6, s[16:19], s38 offen lds
v_add_u32 v20, 98304, v12
v_add_u32 v21, 98304, v13
v_add_u32 v22, 98304, v14
s_add_u32 m0, s50, 102400
s_nop 0
buffer_load_dwordx4 v7, s[16:19], s38 offen lds
s_add_u32 m0, s50, 103424
s_nop 0
buffer_load_dwordx4 v8, s[16:19], s38 offen lds
s_waitcnt vmcnt(10)
s_barrier
s_waitcnt lgkmcnt(0)
s_cmp_eq_u32 s47, 3
s_cbranch_scc0 Lw_123
s_mul_i32 s60, s35, 96
s_add_u32 s61, s60, 95
s_and_b32 s60, s60, 0xff80
s_and_b32 s61, s61, 0xff80
s_add_u32 s60, s60, 28323840
s_add_u32 s61, s61, 28323840
s_load_dword s92, s[82:83], s60 glc
s_load_dword s93, s[82:83], s61 glc
Lw_123:
s_add_u32 s37, s35, 9
s_and_b32 s37, s37, 15
s_mul_i32 s37, s37, 16384
s_add_u32 m0, s39, 0
s_nop 0
buffer_load_dwordx4 v3, s[8:11], s37 offen sc1 lds
buffer_load_dwordx4 v3, s[8:11], s37 offen offset:1024 sc1 lds
s_load_dword s3, s[4:5], 576
buffer_load_dwordx4 v3, s[8:11], s37 offen offset:2048 sc1 lds
s_load_dword s3, s[4:5], 640
buffer_load_dwordx4 v3, s[8:11], s37 offen offset:3072 sc1 lds
s_load_dword s3, s[4:5], 704
s_add_u32 s38, s35, 9
s_and_b32 s38, s38, 15
s_mul_i32 s38, s38, 458752
s_add_u32 m0, s50, 0
s_nop 0
buffer_load_dwordx4 v6, s[16:19], s38 offen lds
s_load_dword s3, s[4:5], 768
s_add_u32 m0, s50, 1024
s_nop 0
buffer_load_dwordx4 v7, s[16:19], s38 offen lds
s_load_dword s3, s[4:5], 832
s_add_u32 m0, s50, 2048
s_nop 0
buffer_load_dwordx4 v8, s[16:19], s38 offen lds
s_load_dword s3, s[4:5], 896
s_add_u32 m0, s50, 3072
s_add_u32 s38, s38, 114688
buffer_load_dwordx4 v6, s[16:19], s38 offen lds
s_load_dword s3, s[4:5], 960
s_add_u32 m0, s50, 4096
s_nop 0
buffer_load_dwordx4 v7, s[16:19], s38 offen lds
s_add_u32 m0, s50, 5120
s_nop 0
buffer_load_dwordx4 v8, s[16:19], s38 offen lds
s_waitcnt vmcnt(10)
s_barrier
s_add_u32 s37, s35, 10
s_and_b32 s37, s37, 15
s_mul_i32 s37, s37, 16384
s_add_u32 m0, s39, 49152
s_nop 0
buffer_load_dwordx4 v3, s[8:11], s37 offen sc1 lds
buffer_load_dwordx4 v3, s[8:11], s37 offen offset:1024 sc1 lds
buffer_load_dwordx4 v3, s[8:11], s37 offen offset:2048 sc1 lds
buffer_load_dwordx4 v3, s[8:11], s37 offen offset:3072 sc1 lds
s_add_u32 s38, s35, 10
s_and_b32 s38, s38, 15
s_mul_i32 s38, s38, 458752
s_add_u32 m0, s50, 49152
s_nop 0
buffer_load_dwordx4 v6, s[16:19], s38 offen lds
s_add_u32 m0, s50, 50176
s_nop 0
buffer_load_dwordx4 v7, s[16:19], s38 offen lds
s_add_u32 m0, s50, 51200
s_nop 0
buffer_load_dwordx4 v8, s[16:19], s38 offen lds
s_add_u32 m0, s50, 52224
s_add_u32 s38, s38, 114688
buffer_load_dwordx4 v6, s[16:19], s38 offen lds
s_add_u32 m0, s50, 53248
s_nop 0
buffer_load_dwordx4 v7, s[16:19], s38 offen lds
s_add_u32 m0, s50, 54272
s_nop 0
buffer_load_dwordx4 v8, s[16:19], s38 offen lds
s_mov_b32 s38, 0
buffer_load_dwordx4 v[40:43], v24, s[88:91], s38 offen
s_mov_b32 s38, 28672
buffer_load_dwordx4 v[44:47], v24, s[88:91], s38 offen
s_mov_b32 s38, 57344
buffer_load_dwordx4 v[48:51], v24, s[88:91], s38 offen
s_mov_b32 s38, 86016
buffer_load_dwordx4 v[52:55], v24, s[88:91], s38 offen
s_mov_b32 s38, 114688
buffer_load_dwordx4 v[56:59], v24, s[88:91], s38 offen
s_mov_b32 s38, 143360
buffer_load_dwordx4 v[60:63], v24, s[88:91], s38 offen
s_mov_b32 s38, 172032
buffer_load_dwordx4 v[64:67], v24, s[88:91], s38 offen
s_mov_b32 s38, 200704
buffer_load_dwordx4 v[68:71], v24, s[88:91], s38 offen
s_waitcnt vmcnt(18)
s_cmp_eq_u32 s47, 3
s_cbranch_scc0 Lw_124
s_mov_b32 s41, 0x40000
Lcp_125:
s_waitcnt lgkmcnt(0)
s_and_b32 s92, s92, s93
s_cmp_eq_u32 s92, 16
s_cbranch_scc1 Lco_126
s_load_dword s92, s[82:83], s60 glc
s_load_dword s93, s[82:83], s61 glc
s_sub_u32 s41, s41, 1
s_cmp_lg_u32 s41, 0
s_cbranch_scc1 Lcp_125
s_waitcnt lgkmcnt(0)
Lco_126:
Lw_124:
s_barrier
s_mov_b32 s45, s47
s_cmp_ge_u32 s45, 3
s_cselect_b32 s43, 1, 0
s_mul_i32 s44, s43, 3
s_sub_u32 s45, s45, s44
s_lshl_b32 s45, s45, 7
s_mul_i32 s52, s43, 896
s_add_u32 s52, s52, s45
s_add_u32 s52, s52, 148992
s_mul_i32 s43, s43, 14336
s_add_u32 s43, s43, s45
s_mul_i32 s44, s35, 384
s_add_u32 s43, s43, s44
s_add_u32 s60, s43, 8192
s_add_u32 s45, s47, 4
s_min_u32 s45, s45, 5
s_cmp_ge_u32 s45, 3
s_cselect_b32 s43, 1, 0
s_mul_i32 s44, s43, 3
s_sub_u32 s45, s45, s44
s_lshl_b32 s45, s45, 7
s_mul_i32 s53, s43, 896
s_add_u32 s53, s53, s45
s_add_u32 s53, s53, 148992
s_mul_i32 s43, s43, 14336
s_add_u32 s43, s43, s45
s_mul_i32 s44, s35, 384
s_add_u32 s43, s43, s44
s_add_u32 s61, s43, 8192
v_lshrrev_b32 v104, 3, v1
v_mul_u32_u24 v104, 28672, v104
v_and_b32 v105, 7, v1
v_lshl_add_u32 v104, v105, 4, v104
s_waitcnt lgkmcnt(0)
buffer_load_dwordx4 v[96:99], v104, s[84:87], s60 offen sc1
s_load_dword s3, s[4:5], 1024
buffer_load_dwordx4 v[100:103], v104, s[84:87], s61 offen sc1
s_load_dword s3, s[4:5], 1088
s_add_u32 s37, s35, 11
s_and_b32 s37, s37, 15
s_mul_i32 s37, s37, 16384
s_add_u32 m0, s39, 98304
s_nop 0
buffer_load_dwordx4 v3, s[8:11], s37 offen sc1 lds
s_load_dword s3, s[4:5], 1152
s_load_dword s3, s[4:5], 1216
buffer_load_dwordx4 v3, s[8:11], s37 offen offset:1024 sc1 lds
s_load_dword s3, s[4:5], 1280
buffer_load_dwordx4 v3, s[8:11], s37 offen offset:2048 sc1 lds
s_load_dword s3, s[4:5], 1344
s_load_dword s3, s[4:5], 1408
buffer_load_dwordx4 v3, s[8:11], s37 offen offset:3072 sc1 lds
v_cmp_gt_u32 vcc, 32, v1
s_add_u32 s38, s35, 11
s_and_b32 s38, s38, 15
s_mul_i32 s38, s38, 458752
s_add_u32 m0, s50, 98304
s_nop 0
buffer_load_dwordx4 v6, s[16:19], s38 offen lds
v_mov_b32 v104, s52
s_add_u32 m0, s50, 99328
s_nop 0
buffer_load_dwordx4 v7, s[16:19], s38 offen lds
v_mov_b32 v106, s53
v_cndmask_b32 v104, v106, v104, vcc
s_add_u32 m0, s50, 100352
s_nop 0
buffer_load_dwordx4 v8, s[16:19], s38 offen lds
v_lshl_add_u32 v104, v105, 4, v104
s_add_u32 m0, s50, 101376
s_add_u32 s38, s38, 114688
buffer_load_dwordx4 v6, s[16:19], s38 offen lds
v_bfe_u32 v105, v1, 4, 1
v_lshl_add_u32 v104, v105, 2, v104
s_add_u32 m0, s50, 102400
s_nop 0
buffer_load_dwordx4 v7, s[16:19], s38 offen lds
s_add_u32 m0, s50, 103424
s_nop 0
buffer_load_dwordx4 v8, s[16:19], s38 offen lds
s_waitcnt vmcnt(20)
s_barrier
s_add_u32 s37, s35, 12
s_and_b32 s37, s37, 15
s_mul_i32 s37, s37, 16384
s_add_u32 m0, s39, 0
s_nop 0
buffer_load_dwordx4 v3, s[8:11], s37 offen sc1 lds
buffer_load_dwordx4 v3, s[8:11], s37 offen offset:1024 sc1 lds
buffer_load_dwordx4 v3, s[8:11], s37 offen offset:2048 sc1 lds
buffer_load_dwordx4 v3, s[8:11], s37 offen offset:3072 sc1 lds
s_add_u32 s38, s35, 12
s_and_b32 s38, s38, 15
s_mul_i32 s38, s38, 458752
s_add_u32 m0, s50, 0
s_nop 0
buffer_load_dwordx4 v6, s[16:19], s38 offen lds
s_add_u32 m0, s50, 1024
s_nop 0
buffer_load_dwordx4 v7, s[16:19], s38 offen lds
s_add_u32 m0, s50, 2048
s_nop 0
buffer_load_dwordx4 v8, s[16:19], s38 offen lds
s_add_u32 m0, s50, 3072
s_add_u32 s38, s38, 114688
buffer_load_dwordx4 v6, s[16:19], s38 offen lds
s_add_u32 m0, s50, 4096
s_nop 0
buffer_load_dwordx4 v7, s[16:19], s38 offen lds
s_add_u32 m0, s50, 5120
s_nop 0
buffer_load_dwordx4 v8, s[16:19], s38 offen lds
s_waitcnt vmcnt(10)
s_barrier
v_permlane32_swap_b32 v96, v100
v_permlane32_swap_b32 v97, v101
v_permlane32_swap_b32 v98, v102
v_permlane32_swap_b32 v99, v103
v_add_f32 v96, v96, v100
v_add_f32 v97, v97, v101
v_add_f32 v98, v98, v102
v_add_f32 v99, v99, v103
s_nop 1
v_permlane16_swap_b32 v96, v97
v_permlane16_swap_b32 v98, v99
v_add_f32 v96, v96, v97
v_add_f32 v98, v98, v99
s_nop 1
v_add_f32_dpp v96, v96, v96 row_ror:8 row_mask:0xf bank_mask:0xf
v_add_f32_dpp v98, v98, v98 row_ror:8 row_mask:0xf bank_mask:0xf
ds_write_b32 v104, v96
ds_write_b32 v104, v98 offset:8
s_waitcnt lgkmcnt(0)
s_add_u32 s37, s35, 13
s_and_b32 s37, s37, 15
s_mul_i32 s37, s37, 16384
s_add_u32 m0, s39, 49152
s_nop 0
buffer_load_dwordx4 v3, s[8:11], s37 offen sc1 lds
s_load_dword s3, s[4:5], 1472
s_load_dword s3, s[4:5], 1536
s_load_dword s3, s[4:5], 1600
s_load_dword s3, s[4:5], 1664
buffer_load_dwordx4 v3, s[8:11], s37 offen offset:1024 sc1 lds
s_load_dword s3, s[4:5], 1728
v_lshlrev_b32 v72, 16, v40
v_and_b32 v73, 0xffff0000, v40
v_lshlrev_b32 v74, 16, v41
v_and_b32 v75, 0xffff0000, v41
buffer_load_dwordx4 v3, s[8:11], s37 offen offset:2048 sc1 lds
v_lshlrev_b32 v76, 16, v42
v_and_b32 v77, 0xffff0000, v42
v_lshlrev_b32 v78, 16, v43
v_and_b32 v79, 0xffff0000, v43
v_lshlrev_b32 v80, 16, v44
buffer_load_dwordx4 v3, s[8:11], s37 offen offset:3072 sc1 lds
v_and_b32 v81, 0xffff0000, v44
v_lshlrev_b32 v82, 16, v45
v_and_b32 v83, 0xffff0000, v45
v_lshlrev_b32 v84, 16, v46
v_and_b32 v85, 0xffff0000, v46
s_add_u32 s38, s35, 13
s_and_b32 s38, s38, 15
s_mul_i32 s38, s38, 458752
s_add_u32 m0, s50, 49152
s_nop 0
buffer_load_dwordx4 v6, s[16:19], s38 offen lds
v_lshlrev_b32 v86, 16, v47
v_and_b32 v87, 0xffff0000, v47
v_add_f32 v72, v72, v80
v_add_f32 v73, v73, v81
s_add_u32 m0, s50, 50176
s_nop 0
buffer_load_dwordx4 v7, s[16:19], s38 offen lds
v_add_f32 v74, v74, v82
v_add_f32 v75, v75, v83
v_add_f32 v76, v76, v84
v_add_f32 v77, v77, v85
v_add_f32 v78, v78, v86
s_add_u32 m0, s50, 51200
s_nop 0
buffer_load_dwordx4 v8, s[16:19], s38 offen lds
v_add_f32 v79, v79, v87
v_lshlrev_b32 v80, 16, v48
v_and_b32 v81, 0xffff0000, v48
v_lshlrev_b32 v82, 16, v49
v_and_b32 v83, 0xffff0000, v49
s_add_u32 m0, s50, 52224
s_add_u32 s38, s38, 114688
buffer_load_dwordx4 v6, s[16:19], s38 offen lds
v_lshlrev_b32 v84, 16, v50
v_and_b32 v85, 0xffff0000, v50
v_lshlrev_b32 v86, 16, v51
v_and_b32 v87, 0xffff0000, v51
v_add_f32 v72, v72, v80
s_add_u32 m0, s50, 53248
s_nop 0
buffer_load_dwordx4 v7, s[16:19], s38 offen lds
s_add_u32 m0, s50, 54272
s_nop 0
buffer_load_dwordx4 v8, s[16:19], s38 offen lds
s_waitcnt vmcnt(10)
s_barrier
s_add_u32 s37, s35, 14
s_and_b32 s37, s37, 15
s_mul_i32 s37, s37, 16384
s_add_u32 m0, s39, 98304
s_nop 0
buffer_load_dwordx4 v3, s[8:11], s37 offen sc1 lds
v_add_f32 v73, v73, v81
v_add_f32 v74, v74, v82
v_add_f32 v75, v75, v83
v_add_f32 v76, v76, v84
buffer_load_dwordx4 v3, s[8:11], s37 offen offset:1024 sc1 lds
v_add_f32 v77, v77, v85
v_add_f32 v78, v78, v86
v_add_f32 v79, v79, v87
v_lshlrev_b32 v80, 16, v52
buffer_load_dwordx4 v3, s[8:11], s37 offen offset:2048 sc1 lds
v_and_b32 v81, 0xffff0000, v52
v_lshlrev_b32 v82, 16, v53
v_and_b32 v83, 0xffff0000, v53
v_lshlrev_b32 v84, 16, v54
buffer_load_dwordx4 v3, s[8:11], s37 offen offset:3072 sc1 lds
v_and_b32 v85, 0xffff0000, v54
v_lshlrev_b32 v86, 16, v55
v_and_b32 v87, 0xffff0000, v55
v_add_f32 v72, v72, v80
v_add_f32 v73, v73, v81
s_add_u32 s38, s35, 14
s_and_b32 s38, s38, 15
s_mul_i32 s38, s38, 458752
s_add_u32 m0, s50, 98304
s_nop 0
buffer_load_dwordx4 v6, s[16:19], s38 offen lds
v_add_f32 v74, v74, v82
v_add_f32 v75, v75, v83
v_add_f32 v76, v76, v84
v_add_f32 v77, v77, v85
s_add_u32 m0, s50, 99328
s_nop 0
buffer_load_dwordx4 v7, s[16:19], s38 offen lds
v_add_f32 v78, v78, v86
v_add_f32 v79, v79, v87
v_lshlrev_b32 v80, 16, v56
v_and_b32 v81, 0xffff0000, v56
s_add_u32 m0, s50, 100352
s_nop 0
buffer_load_dwordx4 v8, s[16:19], s38 offen lds
v_lshlrev_b32 v82, 16, v57
v_and_b32 v83, 0xffff0000, v57
v_lshlrev_b32 v84, 16, v58
v_and_b32 v85, 0xffff0000, v58
s_add_u32 m0, s50, 101376
s_add_u32 s38, s38, 114688
buffer_load_dwordx4 v6, s[16:19], s38 offen lds
v_lshlrev_b32 v86, 16, v59
v_and_b32 v87, 0xffff0000, v59
v_add_f32 v72, v72, v80
v_add_f32 v73, v73, v81
v_add_f32 v74, v74, v82
s_add_u32 m0, s50, 102400
s_nop 0
buffer_load_dwordx4 v7, s[16:19], s38 offen lds
s_add_u32 m0, s50, 103424
s_nop 0
buffer_load_dwordx4 v8, s[16:19], s38 offen lds
s_waitcnt vmcnt(10)
s_barrier
s_add_u32 s37, s35, 15
s_and_b32 s37, s37, 15
s_mul_i32 s37, s37, 16384
s_add_u32 m0, s39, 0
s_nop 0
buffer_load_dwordx4 v3, s[8:11], s37 offen sc1 lds
v_add_f32 v75, v75, v83
v_add_f32 v76, v76, v84
v_add_f32 v77, v77, v85
v_add_f32 v78, v78, v86
buffer_load_dwordx4 v3, s[8:11], s37 offen offset:1024 sc1 lds
v_add_f32 v79, v79, v87
v_lshlrev_b32 v80, 16, v60
v_and_b32 v81, 0xffff0000, v60
v_lshlrev_b32 v82, 16, v61
buffer_load_dwordx4 v3, s[8:11], s37 offen offset:2048 sc1 lds
v_and_b32 v83, 0xffff0000, v61
v_lshlrev_b32 v84, 16, v62
v_and_b32 v85, 0xffff0000, v62
v_lshlrev_b32 v86, 16, v63
buffer_load_dwordx4 v3, s[8:11], s37 offen offset:3072 sc1 lds
v_and_b32 v87, 0xffff0000, v63
v_add_f32 v72, v72, v80
v_add_f32 v73, v73, v81
v_add_f32 v74, v74, v82
s_add_u32 s38, s35, 15
s_and_b32 s38, s38, 15
s_mul_i32 s38, s38, 458752
s_add_u32 m0, s50, 0
s_nop 0
buffer_load_dwordx4 v6, s[16:19], s38 offen lds
v_add_f32 v75, v75, v83
v_add_f32 v76, v76, v84
v_add_f32 v77, v77, v85
v_add_f32 v78, v78, v86
s_add_u32 m0, s50, 1024
s_nop 0
buffer_load_dwordx4 v7, s[16:19], s38 offen lds
v_add_f32 v79, v79, v87
v_lshlrev_b32 v80, 16, v64
v_and_b32 v81, 0xffff0000, v64
v_lshlrev_b32 v82, 16, v65
s_add_u32 m0, s50, 2048
s_nop 0
buffer_load_dwordx4 v8, s[16:19], s38 offen lds
v_and_b32 v83, 0xffff0000, v65
v_lshlrev_b32 v84, 16, v66
v_and_b32 v85, 0xffff0000, v66
v_lshlrev_b32 v86, 16, v67
s_add_u32 m0, s50, 3072
s_add_u32 s38, s38, 114688
buffer_load_dwordx4 v6, s[16:19], s38 offen lds
v_and_b32 v87, 0xffff0000, v67
v_add_f32 v72, v72, v80
s_branch Lov_14
.p2align 12
Lst_14_0:
s_branch Lwr_154
Lst_14_1:
s_branch Lwr_166
s_nop 0
Lov_14:
v_add_f32 v73, v73, v81
v_add_f32 v74, v74, v82
v_add_f32 v75, v75, v83
s_add_u32 m0, s50, 4096
s_nop 0
buffer_load_dwordx4 v7, s[16:19], s38 offen lds
s_add_u32 m0, s50, 5120
s_nop 0
buffer_load_dwordx4 v8, s[16:19], s38 offen lds
s_waitcnt vmcnt(10)
s_barrier
s_add_u32 s37, s35, 0
s_and_b32 s37, s37, 15
s_mul_i32 s37, s37, 16384
s_add_u32 m0, s39, 49152
s_nop 0
buffer_load_dwordx4 v3, s[8:11], s37 offen sc1 lds
v_add_f32 v76, v76, v84
v_add_f32 v77, v77, v85
v_add_f32 v78, v78, v86
buffer_load_dwordx4 v3, s[8:11], s37 offen offset:1024 sc1 lds
v_add_f32 v79, v79, v87
v_lshlrev_b32 v80, 16, v68
v_and_b32 v81, 0xffff0000, v68
buffer_load_dwordx4 v3, s[8:11], s37 offen offset:2048 sc1 lds
v_lshlrev_b32 v82, 16, v69
v_and_b32 v83, 0xffff0000, v69
v_lshlrev_b32 v84, 16, v70
v_and_b32 v85, 0xffff0000, v70
buffer_load_dwordx4 v3, s[8:11], s37 offen offset:3072 sc1 lds
v_lshlrev_b32 v86, 16, v71
v_and_b32 v87, 0xffff0000, v71
v_add_f32 v72, v72, v80
s_add_u32 s38, s35, 0
s_and_b32 s38, s38, 15
s_mul_i32 s38, s38, 458752
s_add_u32 m0, s40, 49152
s_nop 0
buffer_load_dwordx4 v4, s[12:15], s38 offen lds
v_add_f32 v73, v73, v81
v_add_f32 v74, v74, v82
v_add_f32 v75, v75, v83
v_add_f32 v76, v76, v84
s_add_u32 m0, s40, 50176
s_nop 0
buffer_load_dwordx4 v5, s[12:15], s38 offen lds
v_add_f32 v77, v77, v85
v_add_f32 v78, v78, v86
v_add_f32 v79, v79, v87
s_add_u32 m0, s40, 51200
s_add_u32 s38, s38, 57344
buffer_load_dwordx4 v4, s[12:15], s38 offen lds
s_nop 0
v_permlane32_swap_b32 v72, v76
v_permlane32_swap_b32 v73, v77
s_add_u32 m0, s40, 52224
s_nop 0
buffer_load_dwordx4 v5, s[12:15], s38 offen lds
v_permlane32_swap_b32 v74, v78
v_permlane32_swap_b32 v75, v79
v_add_f32 v72, v72, v76
v_add_f32 v73, v73, v77
s_add_u32 m0, s40, 53248
s_add_u32 s38, s38, 57344
buffer_load_dwordx4 v4, s[12:15], s38 offen lds
v_add_f32 v74, v74, v78
v_add_f32 v75, v75, v79
s_nop 0
s_add_u32 m0, s40, 54272
s_nop 0
buffer_load_dwordx4 v5, s[12:15], s38 offen lds
v_permlane16_swap_b32 v72, v74
v_permlane16_swap_b32 v73, v75
v_add_f32 v72, v72, v74
v_add_f32 v73, v73, v75
s_add_u32 m0, s40, 55296
s_add_u32 s38, s38, 57344
buffer_load_dwordx4 v4, s[12:15], s38 offen lds
s_add_u32 m0, s40, 56320
s_nop 0
buffer_load_dwordx4 v5, s[12:15], s38 offen lds
s_waitcnt vmcnt(12)
s_barrier
s_lshl_b32 s43, s47, 9
s_add_u32 s43, s43, 153600
v_and_b32 v80, 15, v1
v_lshl_add_u32 v80, v80, 5, s43
v_lshrrev_b32 v81, 4, v1
v_lshl_add_u32 v80, v81, 3, v80
ds_write_b64 v80, v[72:73]
s_waitcnt lgkmcnt(0)
s_add_u32 s37, s35, 1
s_and_b32 s37, s37, 15
s_mul_i32 s37, s37, 16384
s_add_u32 m0, s39, 98304
s_nop 0
buffer_load_dwordx4 v3, s[8:11], s37 offen sc1 lds
s_bfe_u32 s61, s35, 0x10002
s_lshr_b32 s60, s35, 3
buffer_load_dwordx4 v3, s[8:11], s37 offen offset:1024 sc1 lds
s_lshl_b32 s60, s60, 2
s_and_b32 s43, s35, 3
s_add_u32 s60, s60, s43
buffer_load_dwordx4 v3, s[8:11], s37 offen offset:2048 sc1 lds
s_lshl_b32 s43, s60, 8
s_add_u32 s28, s76, s43
buffer_load_dwordx4 v3, s[8:11], s37 offen offset:3072 sc1 lds
s_addc_u32 s29, s77, 0
s_mov_b32 s30, 7338240
s_mov_b32 s31, 0x20000
s_add_u32 s38, s35, 1
s_and_b32 s38, s38, 15
s_mul_i32 s38, s38, 458752
s_add_u32 m0, s40, 98304
s_nop 0
buffer_load_dwordx4 v4, s[12:15], s38 offen lds
s_mul_i32 s52, s61, 196608
s_mul_i32 s53, s61, 1572864
s_mul_i32 s90, s61, 163840
s_add_u32 m0, s40, 99328
s_nop 0
buffer_load_dwordx4 v5, s[12:15], s38 offen lds
s_mul_i32 s91, s61, 1310720
s_lshl_b32 s51, s47, 11
s_add_u32 m0, s40, 100352
s_add_u32 s38, s38, 57344
buffer_load_dwordx4 v4, s[12:15], s38 offen lds
s_lshl_b32 s44, s47, 15
v_lshrrev_b32 v122, 4, v1
v_lshlrev_b32 v123, 1, v122
s_add_u32 m0, s40, 101376
s_nop 0
buffer_load_dwordx4 v5, s[12:15], s38 offen lds
v_and_b32 v23, 15, v1
v_xor_b32 v23, v23, v123
s_add_u32 m0, s40, 102400
s_add_u32 s38, s38, 57344
buffer_load_dwordx4 v4, s[12:15], s38 offen lds
v_lshlrev_b32 v23, 4, v23
v_mul_u32_u24 v122, 2048, v122
v_add_u32 v23, v23, v122
s_add_u32 m0, s40, 103424
s_nop 0
buffer_load_dwordx4 v5, s[12:15], s38 offen lds
v_add_u32 v23, s44, v23
v_xor_b32 v24, 128, v23
v_add_u32 v24, 8192, v24
s_add_u32 m0, s40, 104448
s_add_u32 s38, s38, 57344
buffer_load_dwordx4 v4, s[12:15], s38 offen lds
s_add_u32 m0, s40, 105472
s_nop 0
buffer_load_dwordx4 v5, s[12:15], s38 offen lds
s_waitcnt vmcnt(12)
s_barrier
ds_read_b128 v[28:31], v9 offset:49152
ds_read_b64_tr_b16 v[44:45], v15 offset:0
ds_read_b64_tr_b16 v[46:47], v15 offset:4096
ds_read_b64_tr_b16 v[48:49], v16 offset:0
ds_read_b64_tr_b16 v[50:51], v16 offset:4096
ds_read_b64_tr_b16 v[52:53], v17 offset:0
ds_read_b64_tr_b16 v[54:55], v17 offset:4096
ds_read_b64_tr_b16 v[56:57], v18 offset:0
ds_read_b64_tr_b16 v[58:59], v18 offset:4096
ds_read_b64_tr_b16 v[60:61], v15 offset:16384
ds_read_b64_tr_b16 v[62:63], v15 offset:20480
ds_read_b64_tr_b16 v[64:65], v16 offset:16384
ds_read_b64_tr_b16 v[66:67], v16 offset:20480
ds_read_b64_tr_b16 v[68:69], v17 offset:16384
ds_read_b64_tr_b16 v[70:71], v17 offset:20480
ds_read_b64_tr_b16 v[72:73], v18 offset:16384
ds_read_b64_tr_b16 v[74:75], v18 offset:20480
ds_read_b128 v[32:35], v9 offset:50176
ds_read_b128 v[36:39], v9 offset:51200
ds_read_b128 v[40:43], v9 offset:52224
s_waitcnt lgkmcnt(0)
v_mfma_f32_16x16x32_bf16 v[124:127], v[44:47], v[28:31], 0
ds_read_b128 v[76:79], v9 offset:57344
v_mfma_f32_16x16x32_bf16 v[128:131], v[48:51], v[28:31], 0
ds_read_b64_tr_b16 v[92:93], v15 offset:8192
v_mfma_f32_16x16x32_bf16 v[132:135], v[52:55], v[28:31], 0
ds_read_b64_tr_b16 v[94:95], v15 offset:12288
v_mfma_f32_16x16x32_bf16 v[136:139], v[56:59], v[28:31], 0
ds_read_b64_tr_b16 v[96:97], v16 offset:8192
v_mfma_f32_16x16x32_bf16 v[140:143], v[60:63], v[28:31], 0
ds_read_b64_tr_b16 v[98:99], v16 offset:12288
v_mfma_f32_16x16x32_bf16 v[144:147], v[64:67], v[28:31], 0
ds_read_b64_tr_b16 v[100:101], v17 offset:8192
v_mfma_f32_16x16x32_bf16 v[148:151], v[68:71], v[28:31], 0
ds_read_b64_tr_b16 v[102:103], v17 offset:12288
v_mfma_f32_16x16x32_bf16 v[152:155], v[72:75], v[28:31], 0
ds_read_b64_tr_b16 v[104:105], v18 offset:8192
v_mfma_f32_16x16x32_bf16 v[184:187], v[72:75], v[32:35], 0
ds_read_b64_tr_b16 v[106:107], v18 offset:12288
v_mfma_f32_16x16x32_bf16 v[180:183], v[68:71], v[32:35], 0
ds_read_b64_tr_b16 v[108:109], v15 offset:24576
v_mfma_f32_16x16x32_bf16 v[176:179], v[64:67], v[32:35], 0
ds_read_b64_tr_b16 v[110:111], v15 offset:28672
v_mfma_f32_16x16x32_bf16 v[172:175], v[60:63], v[32:35], 0
ds_read_b64_tr_b16 v[112:113], v16 offset:24576
v_mfma_f32_16x16x32_bf16 v[168:171], v[56:59], v[32:35], 0
ds_read_b64_tr_b16 v[114:115], v16 offset:28672
v_mfma_f32_16x16x32_bf16 v[164:167], v[52:55], v[32:35], 0
ds_read_b64_tr_b16 v[116:117], v17 offset:24576
v_mfma_f32_16x16x32_bf16 v[160:163], v[48:51], v[32:35], 0
ds_read_b64_tr_b16 v[118:119], v17 offset:28672
v_mfma_f32_16x16x32_bf16 v[156:159], v[44:47], v[32:35], 0
ds_read_b64_tr_b16 v[120:121], v18 offset:24576
v_mfma_f32_16x16x32_bf16 v[188:191], v[44:47], v[36:39], 0
ds_read_b64_tr_b16 v[122:123], v18 offset:28672
v_mfma_f32_16x16x32_bf16 v[192:195], v[48:51], v[36:39], 0
ds_read_b128 v[80:83], v9 offset:58368
v_mfma_f32_16x16x32_bf16 v[196:199], v[52:55], v[36:39], 0
ds_read_b128 v[84:87], v9 offset:59392
v_mfma_f32_16x16x32_bf16 v[200:203], v[56:59], v[36:39], 0
ds_read_b128 v[88:91], v9 offset:60416
v_mfma_f32_16x16x32_bf16 v[204:207], v[60:63], v[36:39], 0
v_mfma_f32_16x16x32_bf16 v[208:211], v[64:67], v[36:39], 0
v_mfma_f32_16x16x32_bf16 v[212:215], v[68:71], v[36:39], 0
v_mfma_f32_16x16x32_bf16 v[216:219], v[72:75], v[36:39], 0
v_mfma_f32_16x16x32_bf16 v[248:251], v[72:75], v[40:43], 0
v_mfma_f32_16x16x32_bf16 v[244:247], v[68:71], v[40:43], 0
v_mfma_f32_16x16x32_bf16 v[240:243], v[64:67], v[40:43], 0
v_mfma_f32_16x16x32_bf16 v[236:239], v[60:63], v[40:43], 0
v_mfma_f32_16x16x32_bf16 v[232:235], v[56:59], v[40:43], 0
v_mfma_f32_16x16x32_bf16 v[228:231], v[52:55], v[40:43], 0
v_mfma_f32_16x16x32_bf16 v[224:227], v[48:51], v[40:43], 0
v_mfma_f32_16x16x32_bf16 v[220:223], v[44:47], v[40:43], 0
s_waitcnt vmcnt(0)
s_waitcnt lgkmcnt(0)
s_barrier
v_mfma_f32_16x16x32_bf16 v[124:127], v[92:95], v[76:79], v[124:127]
ds_read_b128 v[28:31], v10 offset:0
v_mfma_f32_16x16x32_bf16 v[128:131], v[96:99], v[76:79], v[128:131]
ds_read_b64_tr_b16 v[44:45], v19 offset:0
v_mfma_f32_16x16x32_bf16 v[132:135], v[100:103], v[76:79], v[132:135]
ds_read_b64_tr_b16 v[46:47], v19 offset:4096
v_mfma_f32_16x16x32_bf16 v[136:139], v[104:107], v[76:79], v[136:139]
ds_read_b64_tr_b16 v[48:49], v20 offset:0
v_mfma_f32_16x16x32_bf16 v[140:143], v[108:111], v[76:79], v[140:143]
ds_read_b64_tr_b16 v[50:51], v20 offset:4096
v_mfma_f32_16x16x32_bf16 v[144:147], v[112:115], v[76:79], v[144:147]
ds_read_b64_tr_b16 v[52:53], v21 offset:0
v_mfma_f32_16x16x32_bf16 v[148:151], v[116:119], v[76:79], v[148:151]
ds_read_b64_tr_b16 v[54:55], v21 offset:4096
v_mfma_f32_16x16x32_bf16 v[152:155], v[120:123], v[76:79], v[152:155]
ds_read_b64_tr_b16 v[56:57], v22 offset:0
v_mfma_f32_16x16x32_bf16 v[184:187], v[120:123], v[80:83], v[184:187]
ds_read_b64_tr_b16 v[58:59], v22 offset:4096
v_mfma_f32_16x16x32_bf16 v[180:183], v[116:119], v[80:83], v[180:183]
ds_read_b64_tr_b16 v[60:61], v19 offset:16384
v_mfma_f32_16x16x32_bf16 v[176:179], v[112:115], v[80:83], v[176:179]
ds_read_b64_tr_b16 v[62:63], v19 offset:20480
v_mfma_f32_16x16x32_bf16 v[172:175], v[108:111], v[80:83], v[172:175]
ds_read_b64_tr_b16 v[64:65], v20 offset:16384
v_mfma_f32_16x16x32_bf16 v[168:171], v[104:107], v[80:83], v[168:171]
ds_read_b64_tr_b16 v[66:67], v20 offset:20480
v_mfma_f32_16x16x32_bf16 v[164:167], v[100:103], v[80:83], v[164:167]
ds_read_b64_tr_b16 v[68:69], v21 offset:16384
v_mfma_f32_16x16x32_bf16 v[160:163], v[96:99], v[80:83], v[160:163]
ds_read_b64_tr_b16 v[70:71], v21 offset:20480
v_mfma_f32_16x16x32_bf16 v[156:159], v[92:95], v[80:83], v[156:159]
ds_read_b64_tr_b16 v[72:73], v22 offset:16384
v_mfma_f32_16x16x32_bf16 v[188:191], v[92:95], v[84:87], v[188:191]
ds_read_b64_tr_b16 v[74:75], v22 offset:20480
v_mfma_f32_16x16x32_bf16 v[192:195], v[96:99], v[84:87], v[192:195]
ds_read_b128 v[32:35], v10 offset:1024
v_mfma_f32_16x16x32_bf16 v[196:199], v[100:103], v[84:87], v[196:199]
ds_read_b128 v[36:39], v10 offset:2048
v_mfma_f32_16x16x32_bf16 v[200:203], v[104:107], v[84:87], v[200:203]
ds_read_b128 v[40:43], v10 offset:3072
v_mfma_f32_16x16x32_bf16 v[204:207], v[108:111], v[84:87], v[204:207]
v_mfma_f32_16x16x32_bf16 v[208:211], v[112:115], v[84:87], v[208:211]
v_mfma_f32_16x16x32_bf16 v[212:215], v[116:119], v[84:87], v[212:215]
v_mfma_f32_16x16x32_bf16 v[216:219], v[120:123], v[84:87], v[216:219]
v_mfma_f32_16x16x32_bf16 v[248:251], v[120:123], v[88:91], v[248:251]
v_mfma_f32_16x16x32_bf16 v[244:247], v[116:119], v[88:91], v[244:247]
v_mfma_f32_16x16x32_bf16 v[240:243], v[112:115], v[88:91], v[240:243]
v_mfma_f32_16x16x32_bf16 v[236:239], v[108:111], v[88:91], v[236:239]
v_mfma_f32_16x16x32_bf16 v[232:235], v[104:107], v[88:91], v[232:235]
v_mfma_f32_16x16x32_bf16 v[228:231], v[100:103], v[88:91], v[228:231]
v_mfma_f32_16x16x32_bf16 v[224:227], v[96:99], v[88:91], v[224:227]
v_mfma_f32_16x16x32_bf16 v[220:223], v[92:95], v[88:91], v[220:223]
s_mov_b32 s41, 5
Lk3l_127:
s_waitcnt lgkmcnt(0)
v_mfma_f32_16x16x32_bf16 v[124:127], v[44:47], v[28:31], v[124:127]
ds_read_b128 v[76:79], v10 offset:8192
v_mfma_f32_16x16x32_bf16 v[128:131], v[48:51], v[28:31], v[128:131]
ds_read_b64_tr_b16 v[92:93], v19 offset:8192
v_mfma_f32_16x16x32_bf16 v[132:135], v[52:55], v[28:31], v[132:135]
ds_read_b64_tr_b16 v[94:95], v19 offset:12288
v_mfma_f32_16x16x32_bf16 v[136:139], v[56:59], v[28:31], v[136:139]
ds_read_b64_tr_b16 v[96:97], v20 offset:8192
v_mfma_f32_16x16x32_bf16 v[140:143], v[60:63], v[28:31], v[140:143]
ds_read_b64_tr_b16 v[98:99], v20 offset:12288
v_mfma_f32_16x16x32_bf16 v[144:147], v[64:67], v[28:31], v[144:147]
ds_read_b64_tr_b16 v[100:101], v21 offset:8192
v_mfma_f32_16x16x32_bf16 v[148:151], v[68:71], v[28:31], v[148:151]
ds_read_b64_tr_b16 v[102:103], v21 offset:12288
v_mfma_f32_16x16x32_bf16 v[152:155], v[72:75], v[28:31], v[152:155]
ds_read_b64_tr_b16 v[104:105], v22 offset:8192
v_mfma_f32_16x16x32_bf16 v[184:187], v[72:75], v[32:35], v[184:187]
ds_read_b64_tr_b16 v[106:107], v22 offset:12288
v_mfma_f32_16x16x32_bf16 v[180:183], v[68:71], v[32:35], v[180:183]
ds_read_b64_tr_b16 v[108:109], v19 offset:24576
v_mfma_f32_16x16x32_bf16 v[176:179], v[64:67], v[32:35], v[176:179]
ds_read_b64_tr_b16 v[110:111], v19 offset:28672
v_mfma_f32_16x16x32_bf16 v[172:175], v[60:63], v[32:35], v[172:175]
ds_read_b64_tr_b16 v[112:113], v20 offset:24576
v_mfma_f32_16x16x32_bf16 v[168:171], v[56:59], v[32:35], v[168:171]
ds_read_b64_tr_b16 v[114:115], v20 offset:28672
v_mfma_f32_16x16x32_bf16 v[164:167], v[52:55], v[32:35], v[164:167]
ds_read_b64_tr_b16 v[116:117], v21 offset:24576
v_mfma_f32_16x16x32_bf16 v[160:163], v[48:51], v[32:35], v[160:163]
ds_read_b64_tr_b16 v[118:119], v21 offset:28672
v_mfma_f32_16x16x32_bf16 v[156:159], v[44:47], v[32:35], v[156:159]
ds_read_b64_tr_b16 v[120:121], v22 offset:24576
v_mfma_f32_16x16x32_bf16 v[188:191], v[44:47], v[36:39], v[188:191]
ds_read_b64_tr_b16 v[122:123], v22 offset:28672
v_mfma_f32_16x16x32_bf16 v[192:195], v[48:51], v[36:39], v[192:195]
ds_read_b128 v[80:83], v10 offset:9216
v_mfma_f32_16x16x32_bf16 v[196:199], v[52:55], v[36:39], v[196:199]
ds_read_b128 v[84:87], v10 offset:10240
v_mfma_f32_16x16x32_bf16 v[200:203], v[56:59], v[36:39], v[200:203]
ds_read_b128 v[88:91], v10 offset:11264
v_mfma_f32_16x16x32_bf16 v[204:207], v[60:63], v[36:39], v[204:207]
v_mfma_f32_16x16x32_bf16 v[208:211], v[64:67], v[36:39], v[208:211]
v_mfma_f32_16x16x32_bf16 v[212:215], v[68:71], v[36:39], v[212:215]
v_mfma_f32_16x16x32_bf16 v[216:219], v[72:75], v[36:39], v[216:219]
v_mfma_f32_16x16x32_bf16 v[248:251], v[72:75], v[40:43], v[248:251]
v_mfma_f32_16x16x32_bf16 v[244:247], v[68:71], v[40:43], v[244:247]
v_mfma_f32_16x16x32_bf16 v[240:243], v[64:67], v[40:43], v[240:243]
v_mfma_f32_16x16x32_bf16 v[236:239], v[60:63], v[40:43], v[236:239]
v_mfma_f32_16x16x32_bf16 v[232:235], v[56:59], v[40:43], v[232:235]
v_mfma_f32_16x16x32_bf16 v[228:231], v[52:55], v[40:43], v[228:231]
v_mfma_f32_16x16x32_bf16 v[224:227], v[48:51], v[40:43], v[224:227]
v_mfma_f32_16x16x32_bf16 v[220:223], v[44:47], v[40:43], v[220:223]
s_waitcnt lgkmcnt(0)
s_barrier
v_mfma_f32_16x16x32_bf16 v[124:127], v[92:95], v[76:79], v[124:127]
ds_read_b128 v[28:31], v9 offset:0
v_mfma_f32_16x16x32_bf16 v[128:131], v[96:99], v[76:79], v[128:131]
ds_read_b64_tr_b16 v[44:45], v11 offset:0
v_mfma_f32_16x16x32_bf16 v[132:135], v[100:103], v[76:79], v[132:135]
ds_read_b64_tr_b16 v[46:47], v11 offset:4096
v_mfma_f32_16x16x32_bf16 v[136:139], v[104:107], v[76:79], v[136:139]
ds_read_b64_tr_b16 v[48:49], v12 offset:0
v_mfma_f32_16x16x32_bf16 v[140:143], v[108:111], v[76:79], v[140:143]
ds_read_b64_tr_b16 v[50:51], v12 offset:4096
v_mfma_f32_16x16x32_bf16 v[144:147], v[112:115], v[76:79], v[144:147]
ds_read_b64_tr_b16 v[52:53], v13 offset:0
v_mfma_f32_16x16x32_bf16 v[148:151], v[116:119], v[76:79], v[148:151]
ds_read_b64_tr_b16 v[54:55], v13 offset:4096
v_mfma_f32_16x16x32_bf16 v[152:155], v[120:123], v[76:79], v[152:155]
ds_read_b64_tr_b16 v[56:57], v14 offset:0
v_mfma_f32_16x16x32_bf16 v[184:187], v[120:123], v[80:83], v[184:187]
ds_read_b64_tr_b16 v[58:59], v14 offset:4096
v_mfma_f32_16x16x32_bf16 v[180:183], v[116:119], v[80:83], v[180:183]
ds_read_b64_tr_b16 v[60:61], v11 offset:16384
v_mfma_f32_16x16x32_bf16 v[176:179], v[112:115], v[80:83], v[176:179]
ds_read_b64_tr_b16 v[62:63], v11 offset:20480
v_mfma_f32_16x16x32_bf16 v[172:175], v[108:111], v[80:83], v[172:175]
ds_read_b64_tr_b16 v[64:65], v12 offset:16384
v_mfma_f32_16x16x32_bf16 v[168:171], v[104:107], v[80:83], v[168:171]
ds_read_b64_tr_b16 v[66:67], v12 offset:20480
v_mfma_f32_16x16x32_bf16 v[164:167], v[100:103], v[80:83], v[164:167]
ds_read_b64_tr_b16 v[68:69], v13 offset:16384
v_mfma_f32_16x16x32_bf16 v[160:163], v[96:99], v[80:83], v[160:163]
ds_read_b64_tr_b16 v[70:71], v13 offset:20480
v_mfma_f32_16x16x32_bf16 v[156:159], v[92:95], v[80:83], v[156:159]
ds_read_b64_tr_b16 v[72:73], v14 offset:16384
v_mfma_f32_16x16x32_bf16 v[188:191], v[92:95], v[84:87], v[188:191]
ds_read_b64_tr_b16 v[74:75], v14 offset:20480
v_mfma_f32_16x16x32_bf16 v[192:195], v[96:99], v[84:87], v[192:195]
ds_read_b128 v[32:35], v9 offset:1024
v_mfma_f32_16x16x32_bf16 v[196:199], v[100:103], v[84:87], v[196:199]
ds_read_b128 v[36:39], v9 offset:2048
v_mfma_f32_16x16x32_bf16 v[200:203], v[104:107], v[84:87], v[200:203]
ds_read_b128 v[40:43], v9 offset:3072
v_mfma_f32_16x16x32_bf16 v[204:207], v[108:111], v[84:87], v[204:207]
v_mfma_f32_16x16x32_bf16 v[208:211], v[112:115], v[84:87], v[208:211]
v_mfma_f32_16x16x32_bf16 v[212:215], v[116:119], v[84:87], v[212:215]
v_mfma_f32_16x16x32_bf16 v[216:219], v[120:123], v[84:87], v[216:219]
v_mfma_f32_16x16x32_bf16 v[248:251], v[120:123], v[88:91], v[248:251]
v_mfma_f32_16x16x32_bf16 v[244:247], v[116:119], v[88:91], v[244:247]
v_mfma_f32_16x16x32_bf16 v[240:243], v[112:115], v[88:91], v[240:243]
v_mfma_f32_16x16x32_bf16 v[236:239], v[108:111], v[88:91], v[236:239]
v_mfma_f32_16x16x32_bf16 v[232:235], v[104:107], v[88:91], v[232:235]
v_mfma_f32_16x16x32_bf16 v[228:231], v[100:103], v[88:91], v[228:231]
v_mfma_f32_16x16x32_bf16 v[224:227], v[96:99], v[88:91], v[224:227]
v_mfma_f32_16x16x32_bf16 v[220:223], v[92:95], v[88:91], v[220:223]
s_waitcnt lgkmcnt(0)
v_mfma_f32_16x16x32_bf16 v[124:127], v[44:47], v[28:31], v[124:127]
ds_read_b128 v[76:79], v9 offset:8192
v_mfma_f32_16x16x32_bf16 v[128:131], v[48:51], v[28:31], v[128:131]
ds_read_b64_tr_b16 v[92:93], v11 offset:8192
v_mfma_f32_16x16x32_bf16 v[132:135], v[52:55], v[28:31], v[132:135]
ds_read_b64_tr_b16 v[94:95], v11 offset:12288
v_mfma_f32_16x16x32_bf16 v[136:139], v[56:59], v[28:31], v[136:139]
ds_read_b64_tr_b16 v[96:97], v12 offset:8192
v_mfma_f32_16x16x32_bf16 v[140:143], v[60:63], v[28:31], v[140:143]
ds_read_b64_tr_b16 v[98:99], v12 offset:12288
v_mfma_f32_16x16x32_bf16 v[144:147], v[64:67], v[28:31], v[144:147]
ds_read_b64_tr_b16 v[100:101], v13 offset:8192
v_mfma_f32_16x16x32_bf16 v[148:151], v[68:71], v[28:31], v[148:151]
ds_read_b64_tr_b16 v[102:103], v13 offset:12288
v_mfma_f32_16x16x32_bf16 v[152:155], v[72:75], v[28:31], v[152:155]
ds_read_b64_tr_b16 v[104:105], v14 offset:8192
v_mfma_f32_16x16x32_bf16 v[184:187], v[72:75], v[32:35], v[184:187]
ds_read_b64_tr_b16 v[106:107], v14 offset:12288
v_mfma_f32_16x16x32_bf16 v[180:183], v[68:71], v[32:35], v[180:183]
ds_read_b64_tr_b16 v[108:109], v11 offset:24576
v_mfma_f32_16x16x32_bf16 v[176:179], v[64:67], v[32:35], v[176:179]
ds_read_b64_tr_b16 v[110:111], v11 offset:28672
v_mfma_f32_16x16x32_bf16 v[172:175], v[60:63], v[32:35], v[172:175]
ds_read_b64_tr_b16 v[112:113], v12 offset:24576
v_mfma_f32_16x16x32_bf16 v[168:171], v[56:59], v[32:35], v[168:171]
ds_read_b64_tr_b16 v[114:115], v12 offset:28672
v_mfma_f32_16x16x32_bf16 v[164:167], v[52:55], v[32:35], v[164:167]
ds_read_b64_tr_b16 v[116:117], v13 offset:24576
v_mfma_f32_16x16x32_bf16 v[160:163], v[48:51], v[32:35], v[160:163]
ds_read_b64_tr_b16 v[118:119], v13 offset:28672
v_mfma_f32_16x16x32_bf16 v[156:159], v[44:47], v[32:35], v[156:159]
ds_read_b64_tr_b16 v[120:121], v14 offset:24576
v_mfma_f32_16x16x32_bf16 v[188:191], v[44:47], v[36:39], v[188:191]
ds_read_b64_tr_b16 v[122:123], v14 offset:28672
v_mfma_f32_16x16x32_bf16 v[192:195], v[48:51], v[36:39], v[192:195]
ds_read_b128 v[80:83], v9 offset:9216
v_mfma_f32_16x16x32_bf16 v[196:199], v[52:55], v[36:39], v[196:199]
ds_read_b128 v[84:87], v9 offset:10240
v_mfma_f32_16x16x32_bf16 v[200:203], v[56:59], v[36:39], v[200:203]
ds_read_b128 v[88:91], v9 offset:11264
v_mfma_f32_16x16x32_bf16 v[204:207], v[60:63], v[36:39], v[204:207]
v_mfma_f32_16x16x32_bf16 v[208:211], v[64:67], v[36:39], v[208:211]
v_mfma_f32_16x16x32_bf16 v[212:215], v[68:71], v[36:39], v[212:215]
v_mfma_f32_16x16x32_bf16 v[216:219], v[72:75], v[36:39], v[216:219]
v_mfma_f32_16x16x32_bf16 v[248:251], v[72:75], v[40:43], v[248:251]
v_mfma_f32_16x16x32_bf16 v[244:247], v[68:71], v[40:43], v[244:247]
v_mfma_f32_16x16x32_bf16 v[240:243], v[64:67], v[40:43], v[240:243]
v_mfma_f32_16x16x32_bf16 v[236:239], v[60:63], v[40:43], v[236:239]
v_mfma_f32_16x16x32_bf16 v[232:235], v[56:59], v[40:43], v[232:235]
v_mfma_f32_16x16x32_bf16 v[228:231], v[52:55], v[40:43], v[228:231]
v_mfma_f32_16x16x32_bf16 v[224:227], v[48:51], v[40:43], v[224:227]
v_mfma_f32_16x16x32_bf16 v[220:223], v[44:47], v[40:43], v[220:223]
s_waitcnt lgkmcnt(0)
s_barrier
v_mfma_f32_16x16x32_bf16 v[124:127], v[92:95], v[76:79], v[124:127]
ds_read_b128 v[28:31], v9 offset:49152
v_mfma_f32_16x16x32_bf16 v[128:131], v[96:99], v[76:79], v[128:131]
ds_read_b64_tr_b16 v[44:45], v15 offset:0
v_mfma_f32_16x16x32_bf16 v[132:135], v[100:103], v[76:79], v[132:135]
ds_read_b64_tr_b16 v[46:47], v15 offset:4096
v_mfma_f32_16x16x32_bf16 v[136:139], v[104:107], v[76:79], v[136:139]
ds_read_b64_tr_b16 v[48:49], v16 offset:0
v_mfma_f32_16x16x32_bf16 v[140:143], v[108:111], v[76:79], v[140:143]
ds_read_b64_tr_b16 v[50:51], v16 offset:4096
v_mfma_f32_16x16x32_bf16 v[144:147], v[112:115], v[76:79], v[144:147]
ds_read_b64_tr_b16 v[52:53], v17 offset:0
v_mfma_f32_16x16x32_bf16 v[148:151], v[116:119], v[76:79], v[148:151]
ds_read_b64_tr_b16 v[54:55], v17 offset:4096
v_mfma_f32_16x16x32_bf16 v[152:155], v[120:123], v[76:79], v[152:155]
ds_read_b64_tr_b16 v[56:57], v18 offset:0
v_mfma_f32_16x16x32_bf16 v[184:187], v[120:123], v[80:83], v[184:187]
ds_read_b64_tr_b16 v[58:59], v18 offset:4096
v_mfma_f32_16x16x32_bf16 v[180:183], v[116:119], v[80:83], v[180:183]
ds_read_b64_tr_b16 v[60:61], v15 offset:16384
v_mfma_f32_16x16x32_bf16 v[176:179], v[112:115], v[80:83], v[176:179]
ds_read_b64_tr_b16 v[62:63], v15 offset:20480
v_mfma_f32_16x16x32_bf16 v[172:175], v[108:111], v[80:83], v[172:175]
ds_read_b64_tr_b16 v[64:65], v16 offset:16384
v_mfma_f32_16x16x32_bf16 v[168:171], v[104:107], v[80:83], v[168:171]
ds_read_b64_tr_b16 v[66:67], v16 offset:20480
v_mfma_f32_16x16x32_bf16 v[164:167], v[100:103], v[80:83], v[164:167]
ds_read_b64_tr_b16 v[68:69], v17 offset:16384
v_mfma_f32_16x16x32_bf16 v[160:163], v[96:99], v[80:83], v[160:163]
ds_read_b64_tr_b16 v[70:71], v17 offset:20480
v_mfma_f32_16x16x32_bf16 v[156:159], v[92:95], v[80:83], v[156:159]
ds_read_b64_tr_b16 v[72:73], v18 offset:16384
v_mfma_f32_16x16x32_bf16 v[188:191], v[92:95], v[84:87], v[188:191]
ds_read_b64_tr_b16 v[74:75], v18 offset:20480
v_mfma_f32_16x16x32_bf16 v[192:195], v[96:99], v[84:87], v[192:195]
ds_read_b128 v[32:35], v9 offset:50176
v_mfma_f32_16x16x32_bf16 v[196:199], v[100:103], v[84:87], v[196:199]
ds_read_b128 v[36:39], v9 offset:51200
v_mfma_f32_16x16x32_bf16 v[200:203], v[104:107], v[84:87], v[200:203]
ds_read_b128 v[40:43], v9 offset:52224
v_mfma_f32_16x16x32_bf16 v[204:207], v[108:111], v[84:87], v[204:207]
v_mfma_f32_16x16x32_bf16 v[208:211], v[112:115], v[84:87], v[208:211]
v_mfma_f32_16x16x32_bf16 v[212:215], v[116:119], v[84:87], v[212:215]
v_mfma_f32_16x16x32_bf16 v[216:219], v[120:123], v[84:87], v[216:219]
v_mfma_f32_16x16x32_bf16 v[248:251], v[120:123], v[88:91], v[248:251]
v_mfma_f32_16x16x32_bf16 v[244:247], v[116:119], v[88:91], v[244:247]
v_mfma_f32_16x16x32_bf16 v[240:243], v[112:115], v[88:91], v[240:243]
v_mfma_f32_16x16x32_bf16 v[236:239], v[108:111], v[88:91], v[236:239]
v_mfma_f32_16x16x32_bf16 v[232:235], v[104:107], v[88:91], v[232:235]
v_mfma_f32_16x16x32_bf16 v[228:231], v[100:103], v[88:91], v[228:231]
v_mfma_f32_16x16x32_bf16 v[224:227], v[96:99], v[88:91], v[224:227]
v_mfma_f32_16x16x32_bf16 v[220:223], v[92:95], v[88:91], v[220:223]
s_waitcnt lgkmcnt(0)
v_mfma_f32_16x16x32_bf16 v[124:127], v[44:47], v[28:31], v[124:127]
ds_read_b128 v[76:79], v9 offset:57344
v_mfma_f32_16x16x32_bf16 v[128:131], v[48:51], v[28:31], v[128:131]
ds_read_b64_tr_b16 v[92:93], v15 offset:8192
v_mfma_f32_16x16x32_bf16 v[132:135], v[52:55], v[28:31], v[132:135]
ds_read_b64_tr_b16 v[94:95], v15 offset:12288
v_mfma_f32_16x16x32_bf16 v[136:139], v[56:59], v[28:31], v[136:139]
ds_read_b64_tr_b16 v[96:97], v16 offset:8192
v_mfma_f32_16x16x32_bf16 v[140:143], v[60:63], v[28:31], v[140:143]
ds_read_b64_tr_b16 v[98:99], v16 offset:12288
v_mfma_f32_16x16x32_bf16 v[144:147], v[64:67], v[28:31], v[144:147]
ds_read_b64_tr_b16 v[100:101], v17 offset:8192
v_mfma_f32_16x16x32_bf16 v[148:151], v[68:71], v[28:31], v[148:151]
ds_read_b64_tr_b16 v[102:103], v17 offset:12288
v_mfma_f32_16x16x32_bf16 v[152:155], v[72:75], v[28:31], v[152:155]
ds_read_b64_tr_b16 v[104:105], v18 offset:8192
v_mfma_f32_16x16x32_bf16 v[184:187], v[72:75], v[32:35], v[184:187]
ds_read_b64_tr_b16 v[106:107], v18 offset:12288
v_mfma_f32_16x16x32_bf16 v[180:183], v[68:71], v[32:35], v[180:183]
ds_read_b64_tr_b16 v[108:109], v15 offset:24576
v_mfma_f32_16x16x32_bf16 v[176:179], v[64:67], v[32:35], v[176:179]
ds_read_b64_tr_b16 v[110:111], v15 offset:28672
v_mfma_f32_16x16x32_bf16 v[172:175], v[60:63], v[32:35], v[172:175]
ds_read_b64_tr_b16 v[112:113], v16 offset:24576
v_mfma_f32_16x16x32_bf16 v[168:171], v[56:59], v[32:35], v[168:171]
ds_read_b64_tr_b16 v[114:115], v16 offset:28672
v_mfma_f32_16x16x32_bf16 v[164:167], v[52:55], v[32:35], v[164:167]
ds_read_b64_tr_b16 v[116:117], v17 offset:24576
v_mfma_f32_16x16x32_bf16 v[160:163], v[48:51], v[32:35], v[160:163]
ds_read_b64_tr_b16 v[118:119], v17 offset:28672
v_mfma_f32_16x16x32_bf16 v[156:159], v[44:47], v[32:35], v[156:159]
ds_read_b64_tr_b16 v[120:121], v18 offset:24576
v_mfma_f32_16x16x32_bf16 v[188:191], v[44:47], v[36:39], v[188:191]
ds_read_b64_tr_b16 v[122:123], v18 offset:28672
v_mfma_f32_16x16x32_bf16 v[192:195], v[48:51], v[36:39], v[192:195]
ds_read_b128 v[80:83], v9 offset:58368
v_mfma_f32_16x16x32_bf16 v[196:199], v[52:55], v[36:39], v[196:199]
ds_read_b128 v[84:87], v9 offset:59392
v_mfma_f32_16x16x32_bf16 v[200:203], v[56:59], v[36:39], v[200:203]
ds_read_b128 v[88:91], v9 offset:60416
v_mfma_f32_16x16x32_bf16 v[204:207], v[60:63], v[36:39], v[204:207]
v_mfma_f32_16x16x32_bf16 v[208:211], v[64:67], v[36:39], v[208:211]
v_mfma_f32_16x16x32_bf16 v[212:215], v[68:71], v[36:39], v[212:215]
v_mfma_f32_16x16x32_bf16 v[216:219], v[72:75], v[36:39], v[216:219]
v_mfma_f32_16x16x32_bf16 v[248:251], v[72:75], v[40:43], v[248:251]
v_mfma_f32_16x16x32_bf16 v[244:247], v[68:71], v[40:43], v[244:247]
v_mfma_f32_16x16x32_bf16 v[240:243], v[64:67], v[40:43], v[240:243]
v_mfma_f32_16x16x32_bf16 v[236:239], v[60:63], v[40:43], v[236:239]
v_mfma_f32_16x16x32_bf16 v[232:235], v[56:59], v[40:43], v[232:235]
v_mfma_f32_16x16x32_bf16 v[228:231], v[52:55], v[40:43], v[228:231]
v_mfma_f32_16x16x32_bf16 v[224:227], v[48:51], v[40:43], v[224:227]
v_mfma_f32_16x16x32_bf16 v[220:223], v[44:47], v[40:43], v[220:223]
s_waitcnt lgkmcnt(0)
s_barrier
v_mfma_f32_16x16x32_bf16 v[124:127], v[92:95], v[76:79], v[124:127]
ds_read_b128 v[28:31], v10 offset:0
v_mfma_f32_16x16x32_bf16 v[128:131], v[96:99], v[76:79], v[128:131]
ds_read_b64_tr_b16 v[44:45], v19 offset:0
s_branch Lov_15
.p2align 12
Lst_15_0:
s_branch Lwr_163
s_nop 0
s_nop 0
Lov_15:
v_mfma_f32_16x16x32_bf16 v[132:135], v[100:103], v[76:79], v[132:135]
ds_read_b64_tr_b16 v[46:47], v19 offset:4096
v_mfma_f32_16x16x32_bf16 v[136:139], v[104:107], v[76:79], v[136:139]
ds_read_b64_tr_b16 v[48:49], v20 offset:0
v_mfma_f32_16x16x32_bf16 v[140:143], v[108:111], v[76:79], v[140:143]
ds_read_b64_tr_b16 v[50:51], v20 offset:4096
v_mfma_f32_16x16x32_bf16 v[144:147], v[112:115], v[76:79], v[144:147]
ds_read_b64_tr_b16 v[52:53], v21 offset:0
v_mfma_f32_16x16x32_bf16 v[148:151], v[116:119], v[76:79], v[148:151]
ds_read_b64_tr_b16 v[54:55], v21 offset:4096
v_mfma_f32_16x16x32_bf16 v[152:155], v[120:123], v[76:79], v[152:155]
ds_read_b64_tr_b16 v[56:57], v22 offset:0
v_mfma_f32_16x16x32_bf16 v[184:187], v[120:123], v[80:83], v[184:187]
ds_read_b64_tr_b16 v[58:59], v22 offset:4096
v_mfma_f32_16x16x32_bf16 v[180:183], v[116:119], v[80:83], v[180:183]
ds_read_b64_tr_b16 v[60:61], v19 offset:16384
v_mfma_f32_16x16x32_bf16 v[176:179], v[112:115], v[80:83], v[176:179]
ds_read_b64_tr_b16 v[62:63], v19 offset:20480
v_mfma_f32_16x16x32_bf16 v[172:175], v[108:111], v[80:83], v[172:175]
ds_read_b64_tr_b16 v[64:65], v20 offset:16384
v_mfma_f32_16x16x32_bf16 v[168:171], v[104:107], v[80:83], v[168:171]
ds_read_b64_tr_b16 v[66:67], v20 offset:20480
v_mfma_f32_16x16x32_bf16 v[164:167], v[100:103], v[80:83], v[164:167]
ds_read_b64_tr_b16 v[68:69], v21 offset:16384
v_mfma_f32_16x16x32_bf16 v[160:163], v[96:99], v[80:83], v[160:163]
ds_read_b64_tr_b16 v[70:71], v21 offset:20480
v_mfma_f32_16x16x32_bf16 v[156:159], v[92:95], v[80:83], v[156:159]
ds_read_b64_tr_b16 v[72:73], v22 offset:16384
v_mfma_f32_16x16x32_bf16 v[188:191], v[92:95], v[84:87], v[188:191]
ds_read_b64_tr_b16 v[74:75], v22 offset:20480
v_mfma_f32_16x16x32_bf16 v[192:195], v[96:99], v[84:87], v[192:195]
ds_read_b128 v[32:35], v10 offset:1024
v_mfma_f32_16x16x32_bf16 v[196:199], v[100:103], v[84:87], v[196:199]
ds_read_b128 v[36:39], v10 offset:2048
v_mfma_f32_16x16x32_bf16 v[200:203], v[104:107], v[84:87], v[200:203]
ds_read_b128 v[40:43], v10 offset:3072
v_mfma_f32_16x16x32_bf16 v[204:207], v[108:111], v[84:87], v[204:207]
v_mfma_f32_16x16x32_bf16 v[208:211], v[112:115], v[84:87], v[208:211]
v_mfma_f32_16x16x32_bf16 v[212:215], v[116:119], v[84:87], v[212:215]
v_mfma_f32_16x16x32_bf16 v[216:219], v[120:123], v[84:87], v[216:219]
v_mfma_f32_16x16x32_bf16 v[248:251], v[120:123], v[88:91], v[248:251]
v_mfma_f32_16x16x32_bf16 v[244:247], v[116:119], v[88:91], v[244:247]
v_mfma_f32_16x16x32_bf16 v[240:243], v[112:115], v[88:91], v[240:243]
v_mfma_f32_16x16x32_bf16 v[236:239], v[108:111], v[88:91], v[236:239]
v_mfma_f32_16x16x32_bf16 v[232:235], v[104:107], v[88:91], v[232:235]
v_mfma_f32_16x16x32_bf16 v[228:231], v[100:103], v[88:91], v[228:231]
v_mfma_f32_16x16x32_bf16 v[224:227], v[96:99], v[88:91], v[224:227]
v_mfma_f32_16x16x32_bf16 v[220:223], v[92:95], v[88:91], v[220:223]
s_sub_u32 s41, s41, 1
s_cmp_lg_u32 s41, 0
s_cbranch_scc1 Lk3l_127
s_waitcnt lgkmcnt(0)
v_lshrrev_b32 v84, 4, v1
s_lshl_b32 s43, s63, 8
s_add_u32 s43, s43, 148480
v_lshl_add_u32 v85, v84, 4, s43
v_and_b32 v84, 15, v1
s_lshl_b32 s43, s62, 9
s_add_u32 s43, s43, 147456
v_lshl_add_u32 v84, v84, 3, s43
ds_read_b128 v[28:31], v85 offset:0
ds_read_b128 v[32:35], v85 offset:64
ds_read_b128 v[36:39], v85 offset:128
ds_read_b128 v[40:43], v85 offset:192
ds_read_b128 v[44:47], v85 offset:896
ds_read_b128 v[48:51], v85 offset:960
ds_read_b128 v[52:55], v85 offset:1024
ds_read_b128 v[56:59], v85 offset:1088
ds_read_b64 v[60:61], v84 offset:0
ds_read_b64 v[62:63], v84 offset:128
ds_read_b64 v[64:65], v84 offset:256
ds_read_b64 v[66:67], v84 offset:384
s_lshl_b32 s54, s35, 15
s_lshl_b32 s43, s63, 14
s_add_u32 s54, s54, s43
s_lshl_b32 s43, s62, 12
s_add_u32 s54, s54, s43
s_add_u32 s55, s54, 8192
v_lshrrev_b32 v122, 3, v1
v_and_b32 v123, 6, v122
v_and_b32 v25, 7, v1
v_xor_b32 v25, v25, v123
v_lshlrev_b32 v25, 4, v25
v_mul_u32_u24 v122, 2048, v122
v_add_u32 v25, v25, v122
s_lshl_b32 s43, s61, 7
s_lshl_b32 s44, s47, 15
s_add_u32 s43, s43, s44
v_add_u32 v25, s43, v25
s_waitcnt lgkmcnt(0)
s_barrier
s_add_u32 m0, s39, 81920
s_add_u32 s37, s52, 589824
buffer_load_dwordx4 v3, s[24:27], s37 offen sc1 lds
v_mul_f32 v70, v61, v61
v_mul_f32 v68, 0xc0135761, v61
v_mul_f32 v69, 0xbdd2d3e8, v61
v_mul_f32 v69, v69, v70
v_rcp_f32 v70, v70
v_mul_f32 v74, v63, v63
v_mul_f32 v72, 0xc0135761, v63
v_mul_f32 v73, 0xbdd2d3e8, v63
v_mul_f32 v73, v73, v74
v_rcp_f32 v74, v74
buffer_load_dwordx4 v3, s[24:27], s37 offen offset:1024 sc1 lds
v_fma_f32 v124, -v60, v28, v124
v_fma_f32 v125, -v60, v29, v125
v_fma_f32 v126, -v60, v30, v126
v_fma_f32 v127, -v60, v31, v127
v_fma_f32 v156, -v62, v28, v156
v_fma_f32 v157, -v62, v29, v157
v_fma_f32 v158, -v62, v30, v158
v_fma_f32 v159, -v62, v31, v159
v_mul_f32 v76, v124, v124
v_mul_f32 v77, v125, v125
buffer_load_dwordx4 v3, s[24:27], s37 offen offset:2048 sc1 lds
v_mul_f32 v78, v126, v126
v_mul_f32 v79, v127, v127
v_mul_f32 v80, v156, v156
v_mul_f32 v81, v157, v157
v_mul_f32 v82, v158, v158
v_mul_f32 v83, v159, v159
v_fma_f32 v76, v76, v69, v68
v_fma_f32 v77, v77, v69, v68
v_fma_f32 v78, v78, v69, v68
v_fma_f32 v79, v79, v69, v68
buffer_load_dwordx4 v3, s[24:27], s37 offen offset:3072 sc1 lds
v_fma_f32 v80, v80, v73, v72
v_fma_f32 v81, v81, v73, v72
v_fma_f32 v82, v82, v73, v72
v_fma_f32 v83, v83, v73, v72
v_mul_f32 v76, v76, v124
v_mul_f32 v77, v77, v125
v_mul_f32 v78, v78, v126
v_mul_f32 v79, v79, v127
v_mul_f32 v80, v80, v156
v_mul_f32 v81, v81, v157
s_add_u32 m0, s39, 147456
s_add_u32 s38, s53, 4718592
buffer_load_dwordx4 v23, s[28:31], s38 offen lds
v_mul_f32 v82, v82, v158
v_mul_f32 v83, v83, v159
v_exp_f32 v76, v76
v_exp_f32 v77, v77
v_exp_f32 v78, v78
v_exp_f32 v79, v79
v_exp_f32 v80, v80
v_exp_f32 v81, v81
v_exp_f32 v82, v82
v_exp_f32 v83, v83
s_add_u32 m0, s39, 148480
s_add_u32 s38, s53, 4718592
buffer_load_dwordx4 v24, s[28:31], s38 offen lds
v_fma_f32 v140, -v60, v44, v140
v_fma_f32 v141, -v60, v45, v141
v_fma_f32 v142, -v60, v46, v142
v_fma_f32 v143, -v60, v47, v143
v_fma_f32 v172, -v62, v44, v172
v_fma_f32 v173, -v62, v45, v173
v_fma_f32 v174, -v62, v46, v174
v_fma_f32 v175, -v62, v47, v175
v_fma_f32 v76, v76, v70, v70
v_fma_f32 v77, v77, v70, v70
s_add_u32 m0, s39, 149504
s_add_u32 s38, s53, 4734976
buffer_load_dwordx4 v23, s[28:31], s38 offen lds
v_fma_f32 v78, v78, v70, v70
v_fma_f32 v79, v79, v70, v70
v_fma_f32 v80, v80, v74, v74
v_fma_f32 v81, v81, v74, v74
v_fma_f32 v82, v82, v74, v74
v_fma_f32 v83, v83, v74, v74
v_rcp_f32 v76, v76
v_rcp_f32 v77, v77
v_rcp_f32 v78, v78
v_rcp_f32 v79, v79
s_add_u32 m0, s39, 150528
s_add_u32 s38, s53, 4734976
buffer_load_dwordx4 v24, s[28:31], s38 offen lds
v_rcp_f32 v80, v80
v_rcp_f32 v81, v81
v_rcp_f32 v82, v82
v_rcp_f32 v83, v83
v_mul_f32 v140, v124, v140
v_mul_f32 v141, v125, v141
v_mul_f32 v142, v126, v142
v_mul_f32 v143, v127, v143
v_mul_f32 v172, v156, v172
v_mul_f32 v173, v157, v173
s_add_u32 m0, s39, 98304
s_add_u32 s37, s52, 606208
buffer_load_dwordx4 v3, s[24:27], s37 offen sc1 lds
v_mul_f32 v174, v158, v174
v_mul_f32 v175, v159, v175
v_mul_f32 v140, v140, v76
v_mul_f32 v141, v141, v77
v_mul_f32 v142, v142, v78
v_mul_f32 v143, v143, v79
v_mul_f32 v172, v172, v80
v_mul_f32 v173, v173, v81
v_mul_f32 v174, v174, v82
v_mul_f32 v175, v175, v83
buffer_load_dwordx4 v3, s[24:27], s37 offen offset:1024 sc1 lds
v_cvt_pk_bf16_f32 v124, v140, v141
v_cvt_pk_bf16_f32 v125, v142, v143
v_cvt_pk_bf16_f32 v156, v172, v173
v_cvt_pk_bf16_f32 v157, v174, v175
v_fma_f32 v128, -v60, v32, v128
v_fma_f32 v129, -v60, v33, v129
v_fma_f32 v130, -v60, v34, v130
v_fma_f32 v131, -v60, v35, v131
v_fma_f32 v160, -v62, v32, v160
v_fma_f32 v161, -v62, v33, v161
buffer_load_dwordx4 v3, s[24:27], s37 offen offset:2048 sc1 lds
v_fma_f32 v162, -v62, v34, v162
v_fma_f32 v163, -v62, v35, v163
v_mul_f32 v76, v128, v128
v_mul_f32 v77, v129, v129
v_mul_f32 v78, v130, v130
v_mul_f32 v79, v131, v131
v_mul_f32 v80, v160, v160
v_mul_f32 v81, v161, v161
v_mul_f32 v82, v162, v162
v_mul_f32 v83, v163, v163
buffer_load_dwordx4 v3, s[24:27], s37 offen offset:3072 sc1 lds
v_fma_f32 v76, v76, v69, v68
v_fma_f32 v77, v77, v69, v68
v_fma_f32 v78, v78, v69, v68
v_fma_f32 v79, v79, v69, v68
v_fma_f32 v80, v80, v73, v72
v_fma_f32 v81, v81, v73, v72
v_fma_f32 v82, v82, v73, v72
v_fma_f32 v83, v83, v73, v72
v_mul_f32 v76, v76, v128
v_mul_f32 v77, v77, v129
s_add_u32 m0, s39, 114688
s_add_u32 s38, s53, 4849664
buffer_load_dwordx4 v23, s[28:31], s38 offen lds
v_mul_f32 v78, v78, v130
v_mul_f32 v79, v79, v131
v_mul_f32 v80, v80, v160
v_mul_f32 v81, v81, v161
v_mul_f32 v82, v82, v162
v_mul_f32 v83, v83, v163
v_exp_f32 v76, v76
v_exp_f32 v77, v77
v_exp_f32 v78, v78
v_exp_f32 v79, v79
s_add_u32 m0, s39, 115712
s_add_u32 s38, s53, 4849664
buffer_load_dwordx4 v24, s[28:31], s38 offen lds
v_exp_f32 v80, v80
v_exp_f32 v81, v81
v_exp_f32 v82, v82
v_exp_f32 v83, v83
v_fma_f32 v144, -v60, v48, v144
v_fma_f32 v145, -v60, v49, v145
v_fma_f32 v146, -v60, v50, v146
v_fma_f32 v147, -v60, v51, v147
v_fma_f32 v176, -v62, v48, v176
v_fma_f32 v177, -v62, v49, v177
s_add_u32 m0, s39, 116736
s_add_u32 s38, s53, 4866048
buffer_load_dwordx4 v23, s[28:31], s38 offen lds
s_add_u32 m0, s39, 117760
s_add_u32 s38, s53, 4866048
buffer_load_dwordx4 v24, s[28:31], s38 offen lds
s_barrier
s_add_u32 m0, s39, 131072
s_add_u32 s37, s52, 622592
buffer_load_dwordx4 v3, s[24:27], s37 offen sc1 lds
v_fma_f32 v178, -v62, v50, v178
v_fma_f32 v179, -v62, v51, v179
v_fma_f32 v76, v76, v70, v70
v_fma_f32 v77, v77, v70, v70
v_fma_f32 v78, v78, v70, v70
v_fma_f32 v79, v79, v70, v70
v_fma_f32 v80, v80, v74, v74
v_fma_f32 v81, v81, v74, v74
v_fma_f32 v82, v82, v74, v74
v_fma_f32 v83, v83, v74, v74
v_rcp_f32 v76, v76
v_rcp_f32 v77, v77
v_rcp_f32 v78, v78
v_rcp_f32 v79, v79
v_rcp_f32 v80, v80
v_rcp_f32 v81, v81
v_rcp_f32 v82, v82
v_rcp_f32 v83, v83
v_mul_f32 v144, v128, v144
v_mul_f32 v145, v129, v145
v_mul_f32 v146, v130, v146
v_mul_f32 v147, v131, v147
v_mul_f32 v176, v160, v176
buffer_load_dwordx4 v3, s[24:27], s37 offen offset:1024 sc1 lds
v_mul_f32 v177, v161, v177
v_mul_f32 v178, v162, v178
v_mul_f32 v179, v163, v179
v_mul_f32 v144, v144, v76
v_mul_f32 v145, v145, v77
v_mul_f32 v146, v146, v78
v_mul_f32 v147, v147, v79
v_mul_f32 v176, v176, v80
v_mul_f32 v177, v177, v81
v_mul_f32 v178, v178, v82
v_mul_f32 v179, v179, v83
v_cvt_pk_bf16_f32 v126, v144, v145
v_cvt_pk_bf16_f32 v127, v146, v147
v_cvt_pk_bf16_f32 v158, v176, v177
v_cvt_pk_bf16_f32 v159, v178, v179
buffer_store_dwordx4 v[124:127], v2, s[24:27], s54 offen offset:0 sc1
buffer_store_dwordx4 v[156:159], v2, s[24:27], s54 offen offset:1024 sc1
v_fma_f32 v132, -v60, v36, v132
v_fma_f32 v133, -v60, v37, v133
v_fma_f32 v134, -v60, v38, v134
v_fma_f32 v135, -v60, v39, v135
v_fma_f32 v164, -v62, v36, v164
v_fma_f32 v165, -v62, v37, v165
buffer_load_dwordx4 v3, s[24:27], s37 offen offset:2048 sc1 lds
v_fma_f32 v166, -v62, v38, v166
v_fma_f32 v167, -v62, v39, v167
v_mul_f32 v76, v132, v132
v_mul_f32 v77, v133, v133
v_mul_f32 v78, v134, v134
v_mul_f32 v79, v135, v135
v_mul_f32 v80, v164, v164
v_mul_f32 v81, v165, v165
v_mul_f32 v82, v166, v166
v_mul_f32 v83, v167, v167
v_fma_f32 v76, v76, v69, v68
v_fma_f32 v77, v77, v69, v68
v_fma_f32 v78, v78, v69, v68
v_fma_f32 v79, v79, v69, v68
v_fma_f32 v80, v80, v73, v72
v_fma_f32 v81, v81, v73, v72
v_fma_f32 v82, v82, v73, v72
v_fma_f32 v83, v83, v73, v72
v_mul_f32 v76, v76, v132
v_mul_f32 v77, v77, v133
v_mul_f32 v78, v78, v134
v_mul_f32 v79, v79, v135
v_mul_f32 v80, v80, v164
v_mul_f32 v81, v81, v165
buffer_load_dwordx4 v3, s[24:27], s37 offen offset:3072 sc1 lds
v_mul_f32 v82, v82, v166
v_mul_f32 v83, v83, v167
v_exp_f32 v76, v76
v_exp_f32 v77, v77
v_exp_f32 v78, v78
v_exp_f32 v79, v79
v_exp_f32 v80, v80
v_exp_f32 v81, v81
v_exp_f32 v82, v82
v_exp_f32 v83, v83
v_fma_f32 v148, -v60, v52, v148
v_fma_f32 v149, -v60, v53, v149
v_fma_f32 v150, -v60, v54, v150
v_fma_f32 v151, -v60, v55, v151
v_fma_f32 v180, -v62, v52, v180
v_fma_f32 v181, -v62, v53, v181
v_fma_f32 v182, -v62, v54, v182
v_fma_f32 v183, -v62, v55, v183
v_fma_f32 v76, v76, v70, v70
v_fma_f32 v77, v77, v70, v70
v_fma_f32 v78, v78, v70, v70
v_fma_f32 v79, v79, v70, v70
v_fma_f32 v80, v80, v74, v74
s_add_u32 m0, s39, 0
s_add_u32 s38, s53, 4980736
buffer_load_dwordx4 v23, s[28:31], s38 offen lds
v_fma_f32 v81, v81, v74, v74
v_fma_f32 v82, v82, v74, v74
v_fma_f32 v83, v83, v74, v74
v_rcp_f32 v76, v76
v_rcp_f32 v77, v77
v_rcp_f32 v78, v78
v_rcp_f32 v79, v79
v_rcp_f32 v80, v80
v_rcp_f32 v81, v81
v_rcp_f32 v82, v82
v_rcp_f32 v83, v83
v_mul_f32 v148, v132, v148
v_mul_f32 v149, v133, v149
v_mul_f32 v150, v134, v150
v_mul_f32 v151, v135, v151
v_mul_f32 v180, v164, v180
v_mul_f32 v181, v165, v181
v_mul_f32 v182, v166, v182
v_mul_f32 v183, v167, v183
v_mul_f32 v148, v148, v76
v_mul_f32 v149, v149, v77
v_mul_f32 v150, v150, v78
v_mul_f32 v151, v151, v79
s_add_u32 m0, s39, 1024
s_add_u32 s38, s53, 4980736
buffer_load_dwordx4 v24, s[28:31], s38 offen lds
v_mul_f32 v180, v180, v80
v_mul_f32 v181, v181, v81
v_mul_f32 v182, v182, v82
v_mul_f32 v183, v183, v83
v_cvt_pk_bf16_f32 v132, v148, v149
v_cvt_pk_bf16_f32 v133, v150, v151
v_cvt_pk_bf16_f32 v164, v180, v181
v_cvt_pk_bf16_f32 v165, v182, v183
v_fma_f32 v136, -v60, v40, v136
v_fma_f32 v137, -v60, v41, v137
v_fma_f32 v138, -v60, v42, v138
v_fma_f32 v139, -v60, v43, v139
v_fma_f32 v168, -v62, v40, v168
v_fma_f32 v169, -v62, v41, v169
v_fma_f32 v170, -v62, v42, v170
v_fma_f32 v171, -v62, v43, v171
v_mul_f32 v76, v136, v136
v_mul_f32 v77, v137, v137
v_mul_f32 v78, v138, v138
v_mul_f32 v79, v139, v139
v_mul_f32 v80, v168, v168
v_mul_f32 v81, v169, v169
v_mul_f32 v82, v170, v170
v_mul_f32 v83, v171, v171
s_add_u32 m0, s39, 2048
s_add_u32 s38, s53, 4997120
buffer_load_dwordx4 v23, s[28:31], s38 offen lds
s_add_u32 m0, s39, 3072
s_add_u32 s38, s53, 4997120
buffer_load_dwordx4 v24, s[28:31], s38 offen lds
s_barrier
s_add_u32 m0, s39, 16384
s_add_u32 s37, s52, 638976
buffer_load_dwordx4 v3, s[24:27], s37 offen sc1 lds
v_fma_f32 v76, v76, v69, v68
v_fma_f32 v77, v77, v69, v68
v_fma_f32 v78, v78, v69, v68
v_fma_f32 v79, v79, v69, v68
v_fma_f32 v80, v80, v73, v72
v_fma_f32 v81, v81, v73, v72
v_fma_f32 v82, v82, v73, v72
v_fma_f32 v83, v83, v73, v72
v_mul_f32 v76, v76, v136
v_mul_f32 v77, v77, v137
v_mul_f32 v78, v78, v138
v_mul_f32 v79, v79, v139
v_mul_f32 v80, v80, v168
v_mul_f32 v81, v81, v169
v_mul_f32 v82, v82, v170
v_mul_f32 v83, v83, v171
v_exp_f32 v76, v76
v_exp_f32 v77, v77
v_exp_f32 v78, v78
v_exp_f32 v79, v79
v_exp_f32 v80, v80
v_exp_f32 v81, v81
v_exp_f32 v82, v82
buffer_load_dwordx4 v3, s[24:27], s37 offen offset:1024 sc1 lds
v_exp_f32 v83, v83
v_fma_f32 v152, -v60, v56, v152
v_fma_f32 v153, -v60, v57, v153
v_fma_f32 v154, -v60, v58, v154
v_fma_f32 v155, -v60, v59, v155
v_fma_f32 v184, -v62, v56, v184
v_fma_f32 v185, -v62, v57, v185
v_fma_f32 v186, -v62, v58, v186
v_fma_f32 v187, -v62, v59, v187
v_fma_f32 v76, v76, v70, v70
v_fma_f32 v77, v77, v70, v70
v_fma_f32 v78, v78, v70, v70
v_fma_f32 v79, v79, v70, v70
v_fma_f32 v80, v80, v74, v74
v_fma_f32 v81, v81, v74, v74
v_fma_f32 v82, v82, v74, v74
v_fma_f32 v83, v83, v74, v74
v_rcp_f32 v76, v76
v_rcp_f32 v77, v77
v_rcp_f32 v78, v78
v_rcp_f32 v79, v79
v_rcp_f32 v80, v80
v_rcp_f32 v81, v81
buffer_load_dwordx4 v3, s[24:27], s37 offen offset:2048 sc1 lds
v_rcp_f32 v82, v82
v_rcp_f32 v83, v83
v_mul_f32 v152, v136, v152
v_mul_f32 v153, v137, v153
v_mul_f32 v154, v138, v154
v_mul_f32 v155, v139, v155
v_mul_f32 v184, v168, v184
v_mul_f32 v185, v169, v185
v_mul_f32 v186, v170, v186
v_mul_f32 v187, v171, v187
v_mul_f32 v152, v152, v76
v_mul_f32 v153, v153, v77
v_mul_f32 v154, v154, v78
v_mul_f32 v155, v155, v79
v_mul_f32 v184, v184, v80
v_mul_f32 v185, v185, v81
v_mul_f32 v186, v186, v82
v_mul_f32 v187, v187, v83
v_cvt_pk_bf16_f32 v134, v152, v153
v_cvt_pk_bf16_f32 v135, v154, v155
v_cvt_pk_bf16_f32 v166, v184, v185
v_cvt_pk_bf16_f32 v167, v186, v187
buffer_store_dwordx4 v[132:135], v2, s[24:27], s55 offen offset:0 sc1
buffer_store_dwordx4 v[164:167], v2, s[24:27], s55 offen offset:1024 sc1
buffer_load_dwordx4 v3, s[24:27], s37 offen offset:3072 sc1 lds
v_mul_f32 v70, v65, v65
v_mul_f32 v68, 0xc0135761, v65
v_mul_f32 v69, 0xbdd2d3e8, v65
v_mul_f32 v69, v69, v70
v_rcp_f32 v70, v70
v_mul_f32 v74, v67, v67
v_mul_f32 v72, 0xc0135761, v67
v_mul_f32 v73, 0xbdd2d3e8, v67
v_mul_f32 v73, v73, v74
v_rcp_f32 v74, v74
v_fma_f32 v188, -v64, v28, v188
v_fma_f32 v189, -v64, v29, v189
v_fma_f32 v190, -v64, v30, v190
v_fma_f32 v191, -v64, v31, v191
v_fma_f32 v220, -v66, v28, v220
v_fma_f32 v221, -v66, v29, v221
v_fma_f32 v222, -v66, v30, v222
v_fma_f32 v223, -v66, v31, v223
v_mul_f32 v76, v188, v188
v_mul_f32 v77, v189, v189
v_mul_f32 v78, v190, v190
v_mul_f32 v79, v191, v191
v_mul_f32 v80, v220, v220
s_add_u32 m0, s39, 32768
s_add_u32 s38, s53, 5111808
buffer_load_dwordx4 v23, s[28:31], s38 offen lds
v_mul_f32 v81, v221, v221
v_mul_f32 v82, v222, v222
v_mul_f32 v83, v223, v223
v_fma_f32 v76, v76, v69, v68
v_fma_f32 v77, v77, v69, v68
v_fma_f32 v78, v78, v69, v68
v_fma_f32 v79, v79, v69, v68
v_fma_f32 v80, v80, v73, v72
v_fma_f32 v81, v81, v73, v72
v_fma_f32 v82, v82, v73, v72
v_fma_f32 v83, v83, v73, v72
v_mul_f32 v76, v76, v188
v_mul_f32 v77, v77, v189
v_mul_f32 v78, v78, v190
v_mul_f32 v79, v79, v191
v_mul_f32 v80, v80, v220
v_mul_f32 v81, v81, v221
v_mul_f32 v82, v82, v222
v_mul_f32 v83, v83, v223
v_exp_f32 v76, v76
v_exp_f32 v77, v77
v_exp_f32 v78, v78
v_exp_f32 v79, v79
s_add_u32 m0, s39, 33792
s_add_u32 s38, s53, 5111808
buffer_load_dwordx4 v24, s[28:31], s38 offen lds
v_exp_f32 v80, v80
v_exp_f32 v81, v81
v_exp_f32 v82, v82
v_exp_f32 v83, v83
v_fma_f32 v204, -v64, v44, v204
v_fma_f32 v205, -v64, v45, v205
v_fma_f32 v206, -v64, v46, v206
v_fma_f32 v207, -v64, v47, v207
v_fma_f32 v236, -v66, v44, v236
v_fma_f32 v237, -v66, v45, v237
v_fma_f32 v238, -v66, v46, v238
v_fma_f32 v239, -v66, v47, v239
v_fma_f32 v76, v76, v70, v70
v_fma_f32 v77, v77, v70, v70
v_fma_f32 v78, v78, v70, v70
v_fma_f32 v79, v79, v70, v70
v_fma_f32 v80, v80, v74, v74
v_fma_f32 v81, v81, v74, v74
v_fma_f32 v82, v82, v74, v74
v_fma_f32 v83, v83, v74, v74
v_rcp_f32 v76, v76
v_rcp_f32 v77, v77
v_rcp_f32 v78, v78
v_rcp_f32 v79, v79
s_add_u32 m0, s39, 34816
s_add_u32 s38, s53, 5128192
buffer_load_dwordx4 v23, s[28:31], s38 offen lds
s_add_u32 m0, s39, 35840
s_add_u32 s38, s53, 5128192
buffer_load_dwordx4 v24, s[28:31], s38 offen lds
s_waitcnt vmcnt(28)
s_barrier
s_add_u32 m0, s39, 49152
s_add_u32 s37, s52, 655360
buffer_load_dwordx4 v3, s[24:27], s37 offen sc1 lds
v_rcp_f32 v80, v80
v_rcp_f32 v81, v81
v_rcp_f32 v82, v82
v_rcp_f32 v83, v83
v_mul_f32 v204, v188, v204
v_mul_f32 v205, v189, v205
v_mul_f32 v206, v190, v206
v_mul_f32 v207, v191, v207
v_mul_f32 v236, v220, v236
v_mul_f32 v237, v221, v237
v_mul_f32 v238, v222, v238
v_mul_f32 v239, v223, v239
v_mul_f32 v204, v204, v76
v_mul_f32 v205, v205, v77
v_mul_f32 v206, v206, v78
v_mul_f32 v207, v207, v79
v_mul_f32 v236, v236, v80
v_mul_f32 v237, v237, v81
v_mul_f32 v238, v238, v82
v_mul_f32 v239, v239, v83
v_cvt_pk_bf16_f32 v188, v204, v205
v_cvt_pk_bf16_f32 v189, v206, v207
v_cvt_pk_bf16_f32 v220, v236, v237
buffer_load_dwordx4 v3, s[24:27], s37 offen offset:1024 sc1 lds
v_cvt_pk_bf16_f32 v221, v238, v239
v_fma_f32 v192, -v64, v32, v192
v_fma_f32 v193, -v64, v33, v193
v_fma_f32 v194, -v64, v34, v194
v_fma_f32 v195, -v64, v35, v195
v_fma_f32 v224, -v66, v32, v224
v_fma_f32 v225, -v66, v33, v225
v_fma_f32 v226, -v66, v34, v226
v_fma_f32 v227, -v66, v35, v227
v_mul_f32 v76, v192, v192
v_mul_f32 v77, v193, v193
v_mul_f32 v78, v194, v194
v_mul_f32 v79, v195, v195
v_mul_f32 v80, v224, v224
v_mul_f32 v81, v225, v225
v_mul_f32 v82, v226, v226
v_mul_f32 v83, v227, v227
v_fma_f32 v76, v76, v69, v68
v_fma_f32 v77, v77, v69, v68
v_fma_f32 v78, v78, v69, v68
v_fma_f32 v79, v79, v69, v68
v_fma_f32 v80, v80, v73, v72
v_fma_f32 v81, v81, v73, v72
buffer_load_dwordx4 v3, s[24:27], s37 offen offset:2048 sc1 lds
v_fma_f32 v82, v82, v73, v72
v_fma_f32 v83, v83, v73, v72
v_mul_f32 v76, v76, v192
v_mul_f32 v77, v77, v193
v_mul_f32 v78, v78, v194
v_mul_f32 v79, v79, v195
v_mul_f32 v80, v80, v224
v_mul_f32 v81, v81, v225
v_mul_f32 v82, v82, v226
v_mul_f32 v83, v83, v227
v_exp_f32 v76, v76
v_exp_f32 v77, v77
v_exp_f32 v78, v78
v_exp_f32 v79, v79
v_exp_f32 v80, v80
v_exp_f32 v81, v81
v_exp_f32 v82, v82
v_exp_f32 v83, v83
v_fma_f32 v208, -v64, v48, v208
v_fma_f32 v209, -v64, v49, v209
v_fma_f32 v210, -v64, v50, v210
v_fma_f32 v211, -v64, v51, v211
v_fma_f32 v240, -v66, v48, v240
v_fma_f32 v241, -v66, v49, v241
buffer_load_dwordx4 v3, s[24:27], s37 offen offset:3072 sc1 lds
s_branch Lov_16
.p2align 12
Lst_16_0:
s_branch Lwr_164
s_nop 0
s_nop 0
Lov_16:
v_fma_f32 v242, -v66, v50, v242
v_fma_f32 v243, -v66, v51, v243
v_fma_f32 v76, v76, v70, v70
v_fma_f32 v77, v77, v70, v70
v_fma_f32 v78, v78, v70, v70
v_fma_f32 v79, v79, v70, v70
v_fma_f32 v80, v80, v74, v74
v_fma_f32 v81, v81, v74, v74
v_fma_f32 v82, v82, v74, v74
v_fma_f32 v83, v83, v74, v74
v_rcp_f32 v76, v76
v_rcp_f32 v77, v77
v_rcp_f32 v78, v78
v_rcp_f32 v79, v79
v_rcp_f32 v80, v80
v_rcp_f32 v81, v81
v_rcp_f32 v82, v82
v_rcp_f32 v83, v83
v_mul_f32 v208, v192, v208
v_mul_f32 v209, v193, v209
v_mul_f32 v210, v194, v210
v_mul_f32 v211, v195, v211
v_mul_f32 v240, v224, v240
s_add_u32 m0, s39, 65536
s_add_u32 s38, s53, 5242880
buffer_load_dwordx4 v23, s[28:31], s38 offen lds
v_mul_f32 v241, v225, v241
v_mul_f32 v242, v226, v242
v_mul_f32 v243, v227, v243
v_mul_f32 v208, v208, v76
v_mul_f32 v209, v209, v77
v_mul_f32 v210, v210, v78
v_mul_f32 v211, v211, v79
v_mul_f32 v240, v240, v80
v_mul_f32 v241, v241, v81
v_mul_f32 v242, v242, v82
v_mul_f32 v243, v243, v83
v_cvt_pk_bf16_f32 v190, v208, v209
v_cvt_pk_bf16_f32 v191, v210, v211
v_cvt_pk_bf16_f32 v222, v240, v241
v_cvt_pk_bf16_f32 v223, v242, v243
buffer_store_dwordx4 v[188:191], v2, s[24:27], s54 offen offset:2048 sc1
buffer_store_dwordx4 v[220:223], v2, s[24:27], s54 offen offset:3072 sc1
v_fma_f32 v196, -v64, v36, v196
v_fma_f32 v197, -v64, v37, v197
v_fma_f32 v198, -v64, v38, v198
v_fma_f32 v199, -v64, v39, v199
v_fma_f32 v228, -v66, v36, v228
v_fma_f32 v229, -v66, v37, v229
s_add_u32 m0, s39, 66560
s_add_u32 s38, s53, 5242880
buffer_load_dwordx4 v24, s[28:31], s38 offen lds
v_fma_f32 v230, -v66, v38, v230
v_fma_f32 v231, -v66, v39, v231
v_mul_f32 v76, v196, v196
v_mul_f32 v77, v197, v197
v_mul_f32 v78, v198, v198
v_mul_f32 v79, v199, v199
v_mul_f32 v80, v228, v228
v_mul_f32 v81, v229, v229
v_mul_f32 v82, v230, v230
v_mul_f32 v83, v231, v231
v_fma_f32 v76, v76, v69, v68
v_fma_f32 v77, v77, v69, v68
v_fma_f32 v78, v78, v69, v68
v_fma_f32 v79, v79, v69, v68
v_fma_f32 v80, v80, v73, v72
v_fma_f32 v81, v81, v73, v72
v_fma_f32 v82, v82, v73, v72
v_fma_f32 v83, v83, v73, v72
v_mul_f32 v76, v76, v196
v_mul_f32 v77, v77, v197
v_mul_f32 v78, v78, v198
v_mul_f32 v79, v79, v199
v_mul_f32 v80, v80, v228
v_mul_f32 v81, v81, v229
s_add_u32 m0, s39, 67584
s_add_u32 s38, s53, 5259264
buffer_load_dwordx4 v23, s[28:31], s38 offen lds
s_add_u32 m0, s39, 68608
s_add_u32 s38, s53, 5259264
buffer_load_dwordx4 v24, s[28:31], s38 offen lds
s_waitcnt vmcnt(30)
s_barrier
s_add_u32 m0, s39, 81920
s_add_u32 s37, s52, 671744
buffer_load_dwordx4 v3, s[24:27], s37 offen sc1 lds
v_mul_f32 v82, v82, v230
v_mul_f32 v83, v83, v231
v_exp_f32 v76, v76
v_exp_f32 v77, v77
v_exp_f32 v78, v78
v_exp_f32 v79, v79
v_exp_f32 v80, v80
v_exp_f32 v81, v81
v_exp_f32 v82, v82
v_exp_f32 v83, v83
v_fma_f32 v212, -v64, v52, v212
v_fma_f32 v213, -v64, v53, v213
v_fma_f32 v214, -v64, v54, v214
v_fma_f32 v215, -v64, v55, v215
v_fma_f32 v244, -v66, v52, v244
v_fma_f32 v245, -v66, v53, v245
v_fma_f32 v246, -v66, v54, v246
v_fma_f32 v247, -v66, v55, v247
v_fma_f32 v76, v76, v70, v70
v_fma_f32 v77, v77, v70, v70
v_fma_f32 v78, v78, v70, v70
v_fma_f32 v79, v79, v70, v70
v_fma_f32 v80, v80, v74, v74
buffer_load_dwordx4 v3, s[24:27], s37 offen offset:1024 sc1 lds
v_fma_f32 v81, v81, v74, v74
v_fma_f32 v82, v82, v74, v74
v_fma_f32 v83, v83, v74, v74
v_rcp_f32 v76, v76
v_rcp_f32 v77, v77
v_rcp_f32 v78, v78
v_rcp_f32 v79, v79
v_rcp_f32 v80, v80
v_rcp_f32 v81, v81
v_rcp_f32 v82, v82
v_rcp_f32 v83, v83
v_mul_f32 v212, v196, v212
v_mul_f32 v213, v197, v213
v_mul_f32 v214, v198, v214
v_mul_f32 v215, v199, v215
v_mul_f32 v244, v228, v244
v_mul_f32 v245, v229, v245
v_mul_f32 v246, v230, v246
v_mul_f32 v247, v231, v247
v_mul_f32 v212, v212, v76
v_mul_f32 v213, v213, v77
v_mul_f32 v214, v214, v78
v_mul_f32 v215, v215, v79
buffer_load_dwordx4 v3, s[24:27], s37 offen offset:2048 sc1 lds
v_mul_f32 v244, v244, v80
v_mul_f32 v245, v245, v81
v_mul_f32 v246, v246, v82
v_mul_f32 v247, v247, v83
v_cvt_pk_bf16_f32 v196, v212, v213
v_cvt_pk_bf16_f32 v197, v214, v215
v_cvt_pk_bf16_f32 v228, v244, v245
v_cvt_pk_bf16_f32 v229, v246, v247
v_fma_f32 v200, -v64, v40, v200
v_fma_f32 v201, -v64, v41, v201
v_fma_f32 v202, -v64, v42, v202
v_fma_f32 v203, -v64, v43, v203
v_fma_f32 v232, -v66, v40, v232
v_fma_f32 v233, -v66, v41, v233
v_fma_f32 v234, -v66, v42, v234
v_fma_f32 v235, -v66, v43, v235
v_mul_f32 v76, v200, v200
v_mul_f32 v77, v201, v201
v_mul_f32 v78, v202, v202
v_mul_f32 v79, v203, v203
v_mul_f32 v80, v232, v232
v_mul_f32 v81, v233, v233
v_mul_f32 v82, v234, v234
v_mul_f32 v83, v235, v235
buffer_load_dwordx4 v3, s[24:27], s37 offen offset:3072 sc1 lds
v_fma_f32 v76, v76, v69, v68
v_fma_f32 v77, v77, v69, v68
v_fma_f32 v78, v78, v69, v68
v_fma_f32 v79, v79, v69, v68
v_fma_f32 v80, v80, v73, v72
v_fma_f32 v81, v81, v73, v72
v_fma_f32 v82, v82, v73, v72
v_fma_f32 v83, v83, v73, v72
v_mul_f32 v76, v76, v200
v_mul_f32 v77, v77, v201
v_mul_f32 v78, v78, v202
v_mul_f32 v79, v79, v203
v_mul_f32 v80, v80, v232
v_mul_f32 v81, v81, v233
v_mul_f32 v82, v82, v234
v_mul_f32 v83, v83, v235
v_exp_f32 v76, v76
v_exp_f32 v77, v77
v_exp_f32 v78, v78
v_exp_f32 v79, v79
v_exp_f32 v80, v80
v_exp_f32 v81, v81
v_exp_f32 v82, v82
s_add_u32 m0, s39, 147456
s_add_u32 s38, s53, 5373952
buffer_load_dwordx4 v23, s[28:31], s38 offen lds
v_exp_f32 v83, v83
v_fma_f32 v216, -v64, v56, v216
v_fma_f32 v217, -v64, v57, v217
v_fma_f32 v218, -v64, v58, v218
v_fma_f32 v219, -v64, v59, v219
v_fma_f32 v248, -v66, v56, v248
v_fma_f32 v249, -v66, v57, v249
v_fma_f32 v250, -v66, v58, v250
v_fma_f32 v251, -v66, v59, v251
v_fma_f32 v76, v76, v70, v70
v_fma_f32 v77, v77, v70, v70
v_fma_f32 v78, v78, v70, v70
v_fma_f32 v79, v79, v70, v70
v_fma_f32 v80, v80, v74, v74
v_fma_f32 v81, v81, v74, v74
v_fma_f32 v82, v82, v74, v74
v_fma_f32 v83, v83, v74, v74
v_rcp_f32 v76, v76
v_rcp_f32 v77, v77
v_rcp_f32 v78, v78
v_rcp_f32 v79, v79
v_rcp_f32 v80, v80
v_rcp_f32 v81, v81
s_add_u32 m0, s39, 148480
s_add_u32 s38, s53, 5373952
buffer_load_dwordx4 v24, s[28:31], s38 offen lds
v_rcp_f32 v82, v82
v_rcp_f32 v83, v83
v_mul_f32 v216, v200, v216
v_mul_f32 v217, v201, v217
v_mul_f32 v218, v202, v218
v_mul_f32 v219, v203, v219
v_mul_f32 v248, v232, v248
v_mul_f32 v249, v233, v249
v_mul_f32 v250, v234, v250
v_mul_f32 v251, v235, v251
v_mul_f32 v216, v216, v76
v_mul_f32 v217, v217, v77
v_mul_f32 v218, v218, v78
v_mul_f32 v219, v219, v79
v_mul_f32 v248, v248, v80
v_mul_f32 v249, v249, v81
v_mul_f32 v250, v250, v82
v_mul_f32 v251, v251, v83
v_cvt_pk_bf16_f32 v198, v216, v217
v_cvt_pk_bf16_f32 v199, v218, v219
v_cvt_pk_bf16_f32 v230, v248, v249
v_cvt_pk_bf16_f32 v231, v250, v251
buffer_store_dwordx4 v[196:199], v2, s[24:27], s55 offen offset:2048 sc1
buffer_store_dwordx4 v[228:231], v2, s[24:27], s55 offen offset:3072 sc1
s_add_u32 m0, s39, 149504
s_add_u32 s38, s53, 5390336
buffer_load_dwordx4 v23, s[28:31], s38 offen lds
s_add_u32 m0, s39, 150528
s_add_u32 s38, s53, 5390336
buffer_load_dwordx4 v24, s[28:31], s38 offen lds
s_waitcnt vmcnt(30)
s_barrier
s_add_u32 m0, s39, 98304
s_add_u32 s37, s52, 688128
buffer_load_dwordx4 v3, s[24:27], s37 offen sc1 lds
buffer_load_dwordx4 v3, s[24:27], s37 offen offset:1024 sc1 lds
buffer_load_dwordx4 v3, s[24:27], s37 offen offset:2048 sc1 lds
buffer_load_dwordx4 v3, s[24:27], s37 offen offset:3072 sc1 lds
s_add_u32 m0, s39, 114688
s_add_u32 s38, s53, 5505024
buffer_load_dwordx4 v23, s[28:31], s38 offen lds
s_add_u32 m0, s39, 115712
s_add_u32 s38, s53, 5505024
buffer_load_dwordx4 v24, s[28:31], s38 offen lds
s_add_u32 m0, s39, 116736
s_add_u32 s38, s53, 5521408
buffer_load_dwordx4 v23, s[28:31], s38 offen lds
s_add_u32 m0, s39, 117760
s_add_u32 s38, s53, 5521408
buffer_load_dwordx4 v24, s[28:31], s38 offen lds
s_waitcnt vmcnt(10)
s_barrier
s_cmp_eq_u32 s47, 0
s_cbranch_scc0 Lw_128
s_add_u32 s7, s34, 48
s_lshl_b32 s7, s7, 7
v_mov_b32 v26, s7
v_mov_b32 v27, 1
s_mov_b64 exec, 1
buffer_atomic_add v27, v26, s[56:59], 0 offen sc1
s_mov_b64 exec, -1
Lw_128:
s_add_u32 m0, s39, 131072
s_add_u32 s37, s52, 704512
buffer_load_dwordx4 v3, s[24:27], s37 offen sc1 lds
buffer_load_dwordx4 v3, s[24:27], s37 offen offset:1024 sc1 lds
buffer_load_dwordx4 v3, s[24:27], s37 offen offset:2048 sc1 lds
buffer_load_dwordx4 v3, s[24:27], s37 offen offset:3072 sc1 lds
s_add_u32 m0, s39, 0
s_add_u32 s38, s53, 5636096
buffer_load_dwordx4 v23, s[28:31], s38 offen lds
s_add_u32 m0, s39, 1024
s_add_u32 s38, s53, 5636096
buffer_load_dwordx4 v24, s[28:31], s38 offen lds
s_add_u32 m0, s39, 2048
s_add_u32 s38, s53, 5652480
buffer_load_dwordx4 v23, s[28:31], s38 offen lds
s_add_u32 m0, s39, 3072
s_add_u32 s38, s53, 5652480
buffer_load_dwordx4 v24, s[28:31], s38 offen lds
s_waitcnt vmcnt(26)
s_barrier
s_add_u32 m0, s39, 32768
s_add_u32 s38, s91, 0
buffer_load_dwordx4 v23, s[28:31], s38 offen lds
s_add_u32 m0, s39, 33792
s_add_u32 s38, s91, 0
buffer_load_dwordx4 v24, s[28:31], s38 offen lds
s_add_u32 m0, s39, 34816
s_add_u32 s38, s91, 16384
buffer_load_dwordx4 v23, s[28:31], s38 offen lds
s_add_u32 m0, s39, 35840
s_add_u32 s38, s91, 16384
buffer_load_dwordx4 v24, s[28:31], s38 offen lds
s_waitcnt vmcnt(20)
s_barrier
s_add_u32 m0, s39, 65536
s_add_u32 s38, s91, 131072
buffer_load_dwordx4 v23, s[28:31], s38 offen lds
s_add_u32 m0, s39, 66560
s_add_u32 s38, s91, 131072
buffer_load_dwordx4 v24, s[28:31], s38 offen lds
s_add_u32 m0, s39, 67584
s_add_u32 s38, s91, 147456
buffer_load_dwordx4 v23, s[28:31], s38 offen lds
s_add_u32 m0, s39, 68608
s_add_u32 s38, s91, 147456
buffer_load_dwordx4 v24, s[28:31], s38 offen lds
s_waitcnt vmcnt(16)
s_barrier
s_cmp_eq_u32 s47, 3
s_cbranch_scc0 Lw_129
s_lshl_b32 s92, s34, 7
s_add_u32 s92, s92, 28317696
s_load_dword s93, s[82:83], s92 glc
Lw_129:
s_add_u32 m0, s39, 147456
s_add_u32 s38, s91, 262144
buffer_load_dwordx4 v23, s[28:31], s38 offen lds
s_add_u32 m0, s39, 148480
s_add_u32 s38, s91, 262144
buffer_load_dwordx4 v24, s[28:31], s38 offen lds
s_add_u32 m0, s39, 149504
s_add_u32 s38, s91, 278528
buffer_load_dwordx4 v23, s[28:31], s38 offen lds
s_add_u32 m0, s39, 150528
s_add_u32 s38, s91, 278528
buffer_load_dwordx4 v24, s[28:31], s38 offen lds
s_waitcnt vmcnt(12)
s_cmp_eq_u32 s47, 3
s_cbranch_scc0 Lw_130
s_mov_b32 s41, 0x40000
s_branch Lpchk_133
Lpoll_131:
s_load_dword s93, s[82:83], s92 glc
Lpchk_133:
s_waitcnt lgkmcnt(0)
s_cmp_eq_u32 s93, 16
s_cbranch_scc1 Lpok_132
s_sub_u32 s41, s41, 1
s_cmp_lg_u32 s41, 0
s_cbranch_scc1 Lpoll_131
Lpok_132:
Lw_130:
s_barrier
s_add_u32 m0, s39, 16384
s_add_u32 s37, s90, 0
buffer_load_dwordx4 v3, s[24:27], s37 offen sc1 lds
buffer_load_dwordx4 v3, s[24:27], s37 offen offset:1024 sc1 lds
buffer_load_dwordx4 v3, s[24:27], s37 offen offset:2048 sc1 lds
buffer_load_dwordx4 v3, s[24:27], s37 offen offset:3072 sc1 lds
s_add_u32 m0, s39, 49152
s_add_u32 s37, s90, 16384
buffer_load_dwordx4 v3, s[24:27], s37 offen sc1 lds
buffer_load_dwordx4 v3, s[24:27], s37 offen offset:1024 sc1 lds
buffer_load_dwordx4 v3, s[24:27], s37 offen offset:2048 sc1 lds
buffer_load_dwordx4 v3, s[24:27], s37 offen offset:3072 sc1 lds
s_add_u32 m0, s39, 81920
s_add_u32 s37, s90, 32768
buffer_load_dwordx4 v3, s[24:27], s37 offen sc1 lds
buffer_load_dwordx4 v3, s[24:27], s37 offen offset:1024 sc1 lds
buffer_load_dwordx4 v3, s[24:27], s37 offen offset:2048 sc1 lds
buffer_load_dwordx4 v3, s[24:27], s37 offen offset:3072 sc1 lds
s_add_u32 m0, s39, 98304
s_add_u32 s37, s90, 49152
buffer_load_dwordx4 v3, s[24:27], s37 offen sc1 lds
buffer_load_dwordx4 v3, s[24:27], s37 offen offset:1024 sc1 lds
buffer_load_dwordx4 v3, s[24:27], s37 offen offset:2048 sc1 lds
buffer_load_dwordx4 v3, s[24:27], s37 offen offset:3072 sc1 lds
s_add_u32 m0, s39, 114688
s_add_u32 s38, s91, 393216
buffer_load_dwordx4 v23, s[28:31], s38 offen lds
s_add_u32 m0, s39, 115712
s_add_u32 s38, s91, 393216
buffer_load_dwordx4 v24, s[28:31], s38 offen lds
s_add_u32 m0, s39, 116736
s_add_u32 s38, s91, 409600
buffer_load_dwordx4 v23, s[28:31], s38 offen lds
s_add_u32 m0, s39, 117760
s_add_u32 s38, s91, 409600
buffer_load_dwordx4 v24, s[28:31], s38 offen lds
s_waitcnt vmcnt(16)
s_barrier
s_add_u32 m0, s39, 131072
s_add_u32 s37, s90, 65536
buffer_load_dwordx4 v3, s[24:27], s37 offen sc1 lds
buffer_load_dwordx4 v3, s[24:27], s37 offen offset:1024 sc1 lds
buffer_load_dwordx4 v3, s[24:27], s37 offen offset:2048 sc1 lds
buffer_load_dwordx4 v3, s[24:27], s37 offen offset:3072 sc1 lds
s_add_u32 m0, s39, 0
s_add_u32 s38, s91, 524288
buffer_load_dwordx4 v23, s[28:31], s38 offen lds
s_add_u32 m0, s39, 1024
s_add_u32 s38, s91, 524288
buffer_load_dwordx4 v24, s[28:31], s38 offen lds
s_add_u32 m0, s39, 2048
s_add_u32 s38, s91, 540672
buffer_load_dwordx4 v23, s[28:31], s38 offen lds
s_add_u32 m0, s39, 3072
s_add_u32 s38, s91, 540672
buffer_load_dwordx4 v24, s[28:31], s38 offen lds
s_waitcnt vmcnt(20)
s_barrier
s_add_u32 m0, s39, 16384
s_add_u32 s37, s90, 81920
buffer_load_dwordx4 v3, s[24:27], s37 offen sc1 lds
buffer_load_dwordx4 v3, s[24:27], s37 offen offset:1024 sc1 lds
buffer_load_dwordx4 v3, s[24:27], s37 offen offset:2048 sc1 lds
buffer_load_dwordx4 v3, s[24:27], s37 offen offset:3072 sc1 lds
s_add_u32 m0, s39, 32768
s_add_u32 s38, s91, 655360
buffer_load_dwordx4 v23, s[28:31], s38 offen lds
s_add_u32 m0, s39, 33792
s_add_u32 s38, s91, 655360
buffer_load_dwordx4 v24, s[28:31], s38 offen lds
s_add_u32 m0, s39, 34816
s_add_u32 s38, s91, 671744
buffer_load_dwordx4 v23, s[28:31], s38 offen lds
s_add_u32 m0, s39, 35840
s_add_u32 s38, s91, 671744
buffer_load_dwordx4 v24, s[28:31], s38 offen lds
s_waitcnt vmcnt(24)
s_barrier
s_add_u32 m0, s39, 49152
s_add_u32 s37, s90, 98304
buffer_load_dwordx4 v3, s[24:27], s37 offen sc1 lds
buffer_load_dwordx4 v3, s[24:27], s37 offen offset:1024 sc1 lds
buffer_load_dwordx4 v3, s[24:27], s37 offen offset:2048 sc1 lds
buffer_load_dwordx4 v3, s[24:27], s37 offen offset:3072 sc1 lds
s_add_u32 m0, s39, 65536
s_add_u32 s38, s91, 786432
buffer_load_dwordx4 v23, s[28:31], s38 offen lds
s_add_u32 m0, s39, 66560
s_add_u32 s38, s91, 786432
buffer_load_dwordx4 v24, s[28:31], s38 offen lds
s_add_u32 m0, s39, 67584
s_add_u32 s38, s91, 802816
buffer_load_dwordx4 v23, s[28:31], s38 offen lds
s_add_u32 m0, s39, 68608
s_add_u32 s38, s91, 802816
buffer_load_dwordx4 v24, s[28:31], s38 offen lds
s_waitcnt vmcnt(24)
s_barrier
s_add_u32 m0, s39, 81920
s_add_u32 s37, s90, 114688
buffer_load_dwordx4 v3, s[24:27], s37 offen sc1 lds
buffer_load_dwordx4 v3, s[24:27], s37 offen offset:1024 sc1 lds
buffer_load_dwordx4 v3, s[24:27], s37 offen offset:2048 sc1 lds
buffer_load_dwordx4 v3, s[24:27], s37 offen offset:3072 sc1 lds
s_add_u32 m0, s39, 147456
s_add_u32 s38, s91, 917504
buffer_load_dwordx4 v23, s[28:31], s38 offen lds
s_add_u32 m0, s39, 148480
s_add_u32 s38, s91, 917504
buffer_load_dwordx4 v24, s[28:31], s38 offen lds
s_add_u32 m0, s39, 149504
s_add_u32 s38, s91, 933888
buffer_load_dwordx4 v23, s[28:31], s38 offen lds
s_add_u32 m0, s39, 150528
s_add_u32 s38, s91, 933888
buffer_load_dwordx4 v24, s[28:31], s38 offen lds
s_waitcnt vmcnt(24)
s_barrier
s_add_u32 m0, s39, 98304
s_add_u32 s37, s90, 131072
buffer_load_dwordx4 v3, s[24:27], s37 offen sc1 lds
buffer_load_dwordx4 v3, s[24:27], s37 offen offset:1024 sc1 lds
buffer_load_dwordx4 v3, s[24:27], s37 offen offset:2048 sc1 lds
buffer_load_dwordx4 v3, s[24:27], s37 offen offset:3072 sc1 lds
s_add_u32 m0, s39, 114688
s_add_u32 s38, s91, 1048576
buffer_load_dwordx4 v23, s[28:31], s38 offen lds
s_add_u32 m0, s39, 115712
s_add_u32 s38, s91, 1048576
buffer_load_dwordx4 v24, s[28:31], s38 offen lds
s_add_u32 m0, s39, 116736
s_add_u32 s38, s91, 1064960
buffer_load_dwordx4 v23, s[28:31], s38 offen lds
s_add_u32 m0, s39, 117760
s_add_u32 s38, s91, 1064960
buffer_load_dwordx4 v24, s[28:31], s38 offen lds
s_waitcnt vmcnt(24)
s_barrier
s_add_u32 m0, s39, 131072
s_add_u32 s37, s90, 147456
buffer_load_dwordx4 v3, s[24:27], s37 offen sc1 lds
buffer_load_dwordx4 v3, s[24:27], s37 offen offset:1024 sc1 lds
buffer_load_dwordx4 v3, s[24:27], s37 offen offset:2048 sc1 lds
buffer_load_dwordx4 v3, s[24:27], s37 offen offset:3072 sc1 lds
s_add_u32 m0, s39, 0
s_add_u32 s38, s91, 1179648
buffer_load_dwordx4 v23, s[28:31], s38 offen lds
s_add_u32 m0, s39, 1024
s_add_u32 s38, s91, 1179648
buffer_load_dwordx4 v24, s[28:31], s38 offen lds
s_add_u32 m0, s39, 2048
s_add_u32 s38, s91, 1196032
buffer_load_dwordx4 v23, s[28:31], s38 offen lds
s_add_u32 m0, s39, 3072
s_add_u32 s38, s91, 1196032
buffer_load_dwordx4 v24, s[28:31], s38 offen lds
s_waitcnt vmcnt(24)
s_barrier
s_add_u32 m0, s39, 16384
s_mov_b32 s37, 327680
buffer_load_dwordx4 v3, s[24:27], s37 offen sc1 lds
buffer_load_dwordx4 v3, s[24:27], s37 offen offset:1024 sc1 lds
buffer_load_dwordx4 v3, s[24:27], s37 offen offset:2048 sc1 lds
buffer_load_dwordx4 v3, s[24:27], s37 offen offset:3072 sc1 lds
s_add_u32 m0, s51, 32768
s_mov_b32 s38, 2621440
buffer_load_dwordx4 v25, s[28:31], s38 offen lds
s_add_u32 m0, s51, 33792
s_mov_b32 s38, 2637824
buffer_load_dwordx4 v25, s[28:31], s38 offen lds
s_waitcnt vmcnt(22)
s_barrier
s_add_u32 m0, s39, 49152
s_mov_b32 s37, 344064
buffer_load_dwordx4 v3, s[24:27], s37 offen sc1 lds
buffer_load_dwordx4 v3, s[24:27], s37 offen offset:1024 sc1 lds
buffer_load_dwordx4 v3, s[24:27], s37 offen offset:2048 sc1 lds
buffer_load_dwordx4 v3, s[24:27], s37 offen offset:3072 sc1 lds
s_add_u32 m0, s51, 65536
s_mov_b32 s38, 2752512
buffer_load_dwordx4 v25, s[28:31], s38 offen lds
s_add_u32 m0, s51, 66560
s_mov_b32 s38, 2768896
buffer_load_dwordx4 v25, s[28:31], s38 offen lds
s_waitcnt vmcnt(20)
s_barrier
s_add_u32 m0, s39, 81920
s_mov_b32 s37, 360448
buffer_load_dwordx4 v3, s[24:27], s37 offen sc1 lds
buffer_load_dwordx4 v3, s[24:27], s37 offen offset:1024 sc1 lds
buffer_load_dwordx4 v3, s[24:27], s37 offen offset:2048 sc1 lds
buffer_load_dwordx4 v3, s[24:27], s37 offen offset:3072 sc1 lds
s_add_u32 m0, s51, 147456
s_mov_b32 s38, 2883584
buffer_load_dwordx4 v25, s[28:31], s38 offen lds
s_add_u32 m0, s51, 148480
s_mov_b32 s38, 2899968
buffer_load_dwordx4 v25, s[28:31], s38 offen lds
s_waitcnt vmcnt(18)
s_barrier
s_add_u32 m0, s39, 98304
s_mov_b32 s37, 376832
buffer_load_dwordx4 v3, s[24:27], s37 offen sc1 lds
buffer_load_dwordx4 v3, s[24:27], s37 offen offset:1024 sc1 lds
buffer_load_dwordx4 v3, s[24:27], s37 offen offset:2048 sc1 lds
buffer_load_dwordx4 v3, s[24:27], s37 offen offset:3072 sc1 lds
s_add_u32 m0, s51, 114688
s_mov_b32 s38, 3014656
buffer_load_dwordx4 v25, s[28:31], s38 offen lds
s_add_u32 m0, s51, 115712
s_mov_b32 s38, 3031040
buffer_load_dwordx4 v25, s[28:31], s38 offen lds
s_waitcnt vmcnt(18)
s_barrier
s_add_u32 m0, s39, 131072
s_mov_b32 s37, 393216
buffer_load_dwordx4 v3, s[24:27], s37 offen sc1 lds
buffer_load_dwordx4 v3, s[24:27], s37 offen offset:1024 sc1 lds
buffer_load_dwordx4 v3, s[24:27], s37 offen offset:2048 sc1 lds
buffer_load_dwordx4 v3, s[24:27], s37 offen offset:3072 sc1 lds
s_add_u32 m0, s51, 0
s_mov_b32 s38, 3145728
buffer_load_dwordx4 v25, s[28:31], s38 offen lds
s_add_u32 m0, s51, 1024
s_mov_b32 s38, 3162112
buffer_load_dwordx4 v25, s[28:31], s38 offen lds
s_waitcnt vmcnt(18)
s_barrier
s_add_u32 m0, s39, 16384
s_mov_b32 s37, 409600
buffer_load_dwordx4 v3, s[24:27], s37 offen sc1 lds
buffer_load_dwordx4 v3, s[24:27], s37 offen offset:1024 sc1 lds
buffer_load_dwordx4 v3, s[24:27], s37 offen offset:2048 sc1 lds
buffer_load_dwordx4 v3, s[24:27], s37 offen offset:3072 sc1 lds
s_add_u32 m0, s51, 32768
s_mov_b32 s38, 3276800
buffer_load_dwordx4 v25, s[28:31], s38 offen lds
s_add_u32 m0, s51, 33792
s_mov_b32 s38, 3293184
buffer_load_dwordx4 v25, s[28:31], s38 offen lds
s_waitcnt vmcnt(18)
s_barrier
s_add_u32 m0, s39, 49152
s_mov_b32 s37, 425984
buffer_load_dwordx4 v3, s[24:27], s37 offen sc1 lds
buffer_load_dwordx4 v3, s[24:27], s37 offen offset:1024 sc1 lds
buffer_load_dwordx4 v3, s[24:27], s37 offen offset:2048 sc1 lds
buffer_load_dwordx4 v3, s[24:27], s37 offen offset:3072 sc1 lds
s_add_u32 m0, s51, 65536
s_mov_b32 s38, 3407872
buffer_load_dwordx4 v25, s[28:31], s38 offen lds
s_add_u32 m0, s51, 66560
s_branch Lov_17
.p2align 12
Lst_17_0:
s_branch Lwr_165
s_nop 0
s_nop 0
Lov_17:
s_mov_b32 s38, 3424256
buffer_load_dwordx4 v25, s[28:31], s38 offen lds
s_waitcnt vmcnt(18)
s_barrier
s_add_u32 m0, s39, 81920
s_mov_b32 s37, 442368
buffer_load_dwordx4 v3, s[24:27], s37 offen sc1 lds
buffer_load_dwordx4 v3, s[24:27], s37 offen offset:1024 sc1 lds
buffer_load_dwordx4 v3, s[24:27], s37 offen offset:2048 sc1 lds
buffer_load_dwordx4 v3, s[24:27], s37 offen offset:3072 sc1 lds
s_add_u32 m0, s51, 147456
s_mov_b32 s38, 3538944
buffer_load_dwordx4 v25, s[28:31], s38 offen lds
s_add_u32 m0, s51, 148480
s_mov_b32 s38, 3555328
buffer_load_dwordx4 v25, s[28:31], s38 offen lds
s_waitcnt vmcnt(18)
s_barrier
s_add_u32 m0, s39, 98304
s_mov_b32 s37, 458752
buffer_load_dwordx4 v3, s[24:27], s37 offen sc1 lds
buffer_load_dwordx4 v3, s[24:27], s37 offen offset:1024 sc1 lds
buffer_load_dwordx4 v3, s[24:27], s37 offen offset:2048 sc1 lds
buffer_load_dwordx4 v3, s[24:27], s37 offen offset:3072 sc1 lds
s_add_u32 m0, s51, 114688
s_mov_b32 s38, 3670016
buffer_load_dwordx4 v25, s[28:31], s38 offen lds
s_add_u32 m0, s51, 115712
s_mov_b32 s38, 3686400
buffer_load_dwordx4 v25, s[28:31], s38 offen lds
s_waitcnt vmcnt(18)
s_barrier
s_add_u32 m0, s39, 131072
s_mov_b32 s37, 475136
buffer_load_dwordx4 v3, s[24:27], s37 offen sc1 lds
buffer_load_dwordx4 v3, s[24:27], s37 offen offset:1024 sc1 lds
buffer_load_dwordx4 v3, s[24:27], s37 offen offset:2048 sc1 lds
buffer_load_dwordx4 v3, s[24:27], s37 offen offset:3072 sc1 lds
s_add_u32 m0, s51, 0
s_mov_b32 s38, 3801088
buffer_load_dwordx4 v25, s[28:31], s38 offen lds
s_add_u32 m0, s51, 1024
s_mov_b32 s38, 3817472
buffer_load_dwordx4 v25, s[28:31], s38 offen lds
s_waitcnt vmcnt(18)
s_barrier
s_cmp_eq_u32 s47, 0
s_cbranch_scc0 Lw_134
s_xor_b32 s43, s2, 2
s_add_u32 s43, s43, 128
s_lshl_b32 s43, s43, 7
v_mov_b32 v26, s43
v_mov_b32 v27, 1
s_mov_b64 exec, 1
buffer_store_dword v27, v26, s[56:59], 0 offen sc1
s_mov_b64 exec, -1
Lw_134:
s_add_u32 m0, s39, 16384
s_mov_b32 s37, 491520
buffer_load_dwordx4 v3, s[24:27], s37 offen sc1 lds
buffer_load_dwordx4 v3, s[24:27], s37 offen offset:1024 sc1 lds
buffer_load_dwordx4 v3, s[24:27], s37 offen offset:2048 sc1 lds
buffer_load_dwordx4 v3, s[24:27], s37 offen offset:3072 sc1 lds
s_add_u32 m0, s51, 32768
s_mov_b32 s38, 3932160
buffer_load_dwordx4 v25, s[28:31], s38 offen lds
s_add_u32 m0, s51, 33792
s_mov_b32 s38, 3948544
buffer_load_dwordx4 v25, s[28:31], s38 offen lds
s_waitcnt vmcnt(18)
s_barrier
s_add_u32 m0, s39, 49152
s_mov_b32 s37, 507904
buffer_load_dwordx4 v3, s[24:27], s37 offen sc1 lds
buffer_load_dwordx4 v3, s[24:27], s37 offen offset:1024 sc1 lds
buffer_load_dwordx4 v3, s[24:27], s37 offen offset:2048 sc1 lds
buffer_load_dwordx4 v3, s[24:27], s37 offen offset:3072 sc1 lds
s_add_u32 m0, s51, 65536
s_mov_b32 s38, 4063232
buffer_load_dwordx4 v25, s[28:31], s38 offen lds
s_add_u32 m0, s51, 66560
s_mov_b32 s38, 4079616
buffer_load_dwordx4 v25, s[28:31], s38 offen lds
s_waitcnt vmcnt(18)
s_barrier
s_cmp_eq_u32 s47, 3
s_cbranch_scc0 Lw_135
s_lshl_b32 s92, s2, 7
s_add_u32 s92, s92, 28327936
s_load_dword s93, s[82:83], s92 glc
Lw_135:
s_waitcnt vmcnt(12)
s_cmp_eq_u32 s47, 3
s_cbranch_scc0 Lw_136
s_mov_b32 s41, 0x40000
s_branch Lpchk_139
Lpoll_137:
s_load_dword s93, s[82:83], s92 glc
Lpchk_139:
s_waitcnt lgkmcnt(0)
s_cmp_eq_u32 s93, 1
s_cbranch_scc1 Lpok_138
s_sub_u32 s41, s41, 1
s_cmp_lg_u32 s41, 0
s_cbranch_scc1 Lpoll_137
Lpok_138:
Lw_136:
s_barrier
s_waitcnt vmcnt(6)
s_barrier
s_waitcnt vmcnt(0)
s_barrier
s_barrier
s_branch Ldone_1
Ldone_1:
Lfin:
Lexit_2:
s_endpgm
.section .rodata,"a"
.p2align 6
.amdhsa_kernel sequential_preLN__sliding_local_dilated__glu_gated_geglu__prompt_kernel
  .amdhsa_next_free_vgpr 256
  .amdhsa_next_free_sgpr 100
  .amdhsa_accum_offset 256
  .amdhsa_group_segment_fixed_size 0
  .amdhsa_kernarg_size 80
  .amdhsa_user_sgpr_count 2
  .amdhsa_user_sgpr_kernarg_segment_ptr 1
  .amdhsa_system_sgpr_workgroup_id_x 1
  .amdhsa_float_denorm_mode_32 3
  .amdhsa_float_denorm_mode_16_64 3
.end_amdhsa_kernel
```

```asm
; @launch grid=(256,1,1) block=(512,1,1) lds=163840
.amdgcn_target "amdgcn-amd-amdhsa--gfx950"
.text
.globl sequential_preLN__sliding_local_dilated__glu_gated_geglu__prompt_kernel
.p2align 8
.type sequential_preLN__sliding_local_dilated__glu_gated_geglu__prompt_kernel,@function
sequential_preLN__sliding_local_dilated__glu_gated_geglu__prompt_kernel:
s_cmp_ge_u32 s2, 256
s_cbranch_scc1 Lexit_2
s_load_dwordx16 s[64:79], s[0:1], 0
s_load_dwordx4 s[80:83], s[0:1], 64
s_and_b32 s3, s2, 7
s_lshr_b32 s42, s2, 3
s_and_b32 s34, s3, 1
s_lshl_b32 s34, s34, 3
s_and_b32 s48, s42, 7
s_add_u32 s34, s34, s48
s_lshr_b32 s35, s3, 1
s_lshr_b32 s49, s42, 3
s_lshl_b32 s35, s35, 2
s_add_u32 s35, s35, s49
v_lshrrev_b32 v12, 6, v0
v_and_b32 v1, 63, v0
v_readfirstlane_b32 s36, v12
Lbeg:
s_lshl_b32 s50, s34, 7
s_sub_u32 s50, s50, 16
v_and_b32 v12, 15, v1
v_lshrrev_b32 v13, 4, v1
s_cmp_lt_u32 s36, 4
s_cbranch_scc1 Lcons_7
Lprod_3:
s_sub_u32 s47, s36, 4
s_lshl_b32 s43, s34, 7
s_lshl_b32 s44, s35, 3
s_add_u32 s63, s43, s44
s_lshl_b32 s44, s47, 1
s_add_u32 s51, s63, s44
v_lshlrev_b32 v10, 4, v1
s_and_b32 s43, s2, 7
s_lshr_b32 s44, s43, 2
s_lshl_b32 s44, s44, 1
s_and_b32 s45, s43, 1
s_add_u32 s44, s44, s45
s_lshr_b32 s45, s2, 3
s_lshl_b32 s45, s45, 2
s_add_u32 s44, s44, s45
s_add_u32 s44, s44, 96
s_bitcmp1_b32 s43, 1
s_cselect_b32 s44, s44, 0x10000
s_cmp_lt_u32 s2, 192
s_cselect_b32 s33, s2, s44
v_lshrrev_b32 v14, 3, v1
v_and_b32 v15, 7, v1
v_lshl_add_u32 v19, v14, 6, v15
s_lshl_b32 s43, s48, 3
v_add_u32 v19, s43, v19
v_mul_u32_u24 v19, 6144, v19
s_cmp_eq_u32 s47, 3
s_cbranch_scc1 Lpf_4
v_and_b32 v16, 2, v14
v_xor_b32 v16, v15, v16
v_lshlrev_b32 v16, 4, v16
v_mul_u32_u24 v17, 6144, v14
s_lshl_b32 s43, s47, 11
v_add3_u32 v2, v17, v16, s43
v_xor_b32 v3, 64, v2
v_lshrrev_b32 v16, 1, v14
v_xor_b32 v16, v15, v16
v_lshlrev_b32 v16, 4, v16
s_lshl_b32 s43, s47, 3
s_add_u32 s43, s43, s50
v_add_u32 v17, s43, v14
s_and_b32 s44, s47, 1
s_lshl_b32 s44, s44, 6
v_add_u32 v18, 0, v17
v_max_i32 v18, 0, v18
v_lshl_add_u32 v18, v18, 11, v16
v_xor_b32 v18, s44, v18
v_mov_b32 v4, v18
v_add_u32 v18, 24, v17
v_max_i32 v18, 0, v18
v_lshl_add_u32 v18, v18, 11, v16
v_xor_b32 v18, s44, v18
v_xor_b32 v5, 64, v18
v_add_u32 v18, 48, v17
v_max_i32 v18, 0, v18
v_lshl_add_u32 v18, v18, 11, v16
v_xor_b32 v18, s44, v18
v_mov_b32 v6, v18
v_add_u32 v18, 72, v17
v_max_i32 v18, 0, v18
v_lshl_add_u32 v18, v18, 11, v16
v_xor_b32 v18, s44, v18
v_xor_b32 v7, 64, v18
v_add_u32 v18, 96, v17
v_max_i32 v18, 0, v18
v_lshl_add_u32 v18, v18, 11, v16
v_xor_b32 v18, s44, v18
v_mov_b32 v8, v18
v_add_u32 v18, 120, v17
v_max_i32 v18, 0, v18
v_lshl_add_u32 v18, v18, 11, v16
v_xor_b32 v18, s44, v18
v_xor_b32 v9, 64, v18
s_lshl_b32 s39, s47, 10
s_lshl_b32 s40, s47, 13
s_add_u32 s40, s40, 18432
s_mov_b32 s37, 0
s_mov_b32 s38, 0
s_bfm_b64 s[60:61], 56, 8
s_cmp_eq_u32 s47, 0
s_cselect_b64 s[60:61], s[60:61], -1
s_lshl_b32 s43, s35, 7
s_waitcnt lgkmcnt(0)
s_mov_b32 s8, s64
s_mov_b32 s9, s65
s_mov_b32 s10, 4194304
s_mov_b32 s11, 0x20000
s_add_u32 s12, s66, s43
s_addc_u32 s13, s67, 0
s_mov_b32 s14, 6289536
s_mov_b32 s15, 0x20000
s_add_u32 m0, s39, 0
s_mov_b64 exec, s[60:61]
buffer_load_dwordx4 v4, s[8:11], s37 offen lds
s_mov_b64 exec, -1
s_add_u32 m0, s39, 3072
s_nop 0
buffer_load_dwordx4 v5, s[8:11], s37 offen lds
s_add_u32 m0, s39, 6144
s_nop 0
buffer_load_dwordx4 v6, s[8:11], s37 offen lds
s_add_u32 m0, s39, 9216
s_nop 0
buffer_load_dwordx4 v7, s[8:11], s37 offen lds
s_add_u32 m0, s39, 12288
s_nop 0
buffer_load_dwordx4 v8, s[8:11], s37 offen lds
s_add_u32 m0, s39, 15360
s_nop 0
buffer_load_dwordx4 v9, s[8:11], s37 offen lds
s_add_u32 m0, s40, 0
s_add_u32 s43, s38, 0
buffer_load_dwordx4 v2, s[12:15], s43 offen lds
s_add_u32 m0, s40, 1024
s_add_u32 s43, s38, 49152
buffer_load_dwordx4 v3, s[12:15], s43 offen lds
s_add_u32 m0, s40, 2048
s_add_u32 s43, s38, 98304
buffer_load_dwordx4 v2, s[12:15], s43 offen lds
s_add_u32 m0, s40, 3072
s_add_u32 s43, s38, 147456
buffer_load_dwordx4 v3, s[12:15], s43 offen lds
s_add_u32 m0, s40, 4096
s_add_u32 s43, s38, 196608
buffer_load_dwordx4 v2, s[12:15], s43 offen lds
s_add_u32 m0, s40, 5120
s_add_u32 s43, s38, 245760
buffer_load_dwordx4 v3, s[12:15], s43 offen lds
s_add_u32 m0, s40, 6144
s_add_u32 s43, s38, 294912
buffer_load_dwordx4 v2, s[12:15], s43 offen lds
s_add_u32 m0, s40, 7168
s_add_u32 s43, s38, 344064
buffer_load_dwordx4 v3, s[12:15], s43 offen lds
s_add_u32 s37, s37, 128
s_add_u32 s38, s38, 393216
s_mov_b32 s28, s66
s_mov_b32 s29, s67
s_mov_b32 s30, 6291456
s_mov_b32 s31, 0x20000
s_mul_i32 s43, s33, 5376
s_add_u32 s43, s43, 393216
v_lshlrev_b32 v30, 7, v1
s_mul_i32 s44, s47, 1792
s_add_u32 s43, s43, s44
s_bfm_b64 exec, 14, 0
buffer_load_dword v31, v30, s[28:31], s43 offen
s_mov_b64 exec, -1
s_lshl_b32 s43, s51, 11
buffer_load_dwordx4 v[96:99], v10, s[8:11], s43 offen offset:0
buffer_load_dwordx4 v[100:103], v10, s[8:11], s43 offen offset:1024
buffer_load_dwordx4 v[104:107], v10, s[8:11], s43 offen offset:2048
buffer_load_dwordx4 v[108:111], v10, s[8:11], s43 offen offset:3072
s_add_u32 m0, s39, 43008
s_mov_b64 exec, s[60:61]
buffer_load_dwordx4 v4, s[8:11], s37 offen lds
s_mov_b64 exec, -1
s_add_u32 m0, s39, 46080
s_nop 0
buffer_load_dwordx4 v5, s[8:11], s37 offen lds
s_add_u32 m0, s39, 49152
s_nop 0
buffer_load_dwordx4 v6, s[8:11], s37 offen lds
s_add_u32 m0, s39, 52224
s_nop 0
buffer_load_dwordx4 v7, s[8:11], s37 offen lds
s_add_u32 m0, s39, 55296
s_nop 0
buffer_load_dwordx4 v8, s[8:11], s37 offen lds
s_add_u32 m0, s39, 58368
s_nop 0
buffer_load_dwordx4 v9, s[8:11], s37 offen lds
s_add_u32 m0, s40, 43008
s_add_u32 s43, s38, 0
buffer_load_dwordx4 v2, s[12:15], s43 offen lds
s_add_u32 m0, s40, 44032
s_add_u32 s43, s38, 49152
buffer_load_dwordx4 v3, s[12:15], s43 offen lds
s_add_u32 m0, s40, 45056
s_add_u32 s43, s38, 98304
buffer_load_dwordx4 v2, s[12:15], s43 offen lds
s_add_u32 m0, s40, 46080
s_add_u32 s43, s38, 147456
buffer_load_dwordx4 v3, s[12:15], s43 offen lds
s_add_u32 m0, s40, 47104
s_add_u32 s43, s38, 196608
buffer_load_dwordx4 v2, s[12:15], s43 offen lds
s_add_u32 m0, s40, 48128
s_add_u32 s43, s38, 245760
buffer_load_dwordx4 v3, s[12:15], s43 offen lds
s_add_u32 m0, s40, 49152
s_add_u32 s43, s38, 294912
buffer_load_dwordx4 v2, s[12:15], s43 offen lds
s_add_u32 m0, s40, 50176
s_add_u32 s43, s38, 344064
buffer_load_dwordx4 v3, s[12:15], s43 offen lds
s_add_u32 s37, s37, 128
s_add_u32 s38, s38, 393216
s_waitcnt vmcnt(19)
s_barrier
s_add_u32 m0, s39, 86016
s_mov_b64 exec, s[60:61]
buffer_load_dwordx4 v4, s[8:11], s37 offen lds
s_mov_b64 exec, -1
s_add_u32 m0, s39, 89088
s_nop 0
buffer_load_dwordx4 v5, s[8:11], s37 offen lds
s_add_u32 m0, s39, 92160
s_nop 0
buffer_load_dwordx4 v6, s[8:11], s37 offen lds
s_add_u32 m0, s39, 95232
s_nop 0
buffer_load_dwordx4 v7, s[8:11], s37 offen lds
s_add_u32 m0, s39, 98304
s_nop 0
buffer_load_dwordx4 v8, s[8:11], s37 offen lds
s_add_u32 m0, s39, 101376
s_nop 0
buffer_load_dwordx4 v9, s[8:11], s37 offen lds
s_add_u32 m0, s40, 86016
s_add_u32 s43, s38, 0
buffer_load_dwordx4 v2, s[12:15], s43 offen lds
s_add_u32 m0, s40, 87040
s_add_u32 s43, s38, 49152
buffer_load_dwordx4 v3, s[12:15], s43 offen lds
s_add_u32 m0, s40, 88064
s_add_u32 s43, s38, 98304
buffer_load_dwordx4 v2, s[12:15], s43 offen lds
s_add_u32 m0, s40, 89088
s_add_u32 s43, s38, 147456
buffer_load_dwordx4 v3, s[12:15], s43 offen lds
s_add_u32 m0, s40, 90112
s_add_u32 s43, s38, 196608
buffer_load_dwordx4 v2, s[12:15], s43 offen lds
s_add_u32 m0, s40, 91136
s_add_u32 s43, s38, 245760
buffer_load_dwordx4 v3, s[12:15], s43 offen lds
s_add_u32 m0, s40, 92160
s_add_u32 s43, s38, 294912
buffer_load_dwordx4 v2, s[12:15], s43 offen lds
s_add_u32 m0, s40, 93184
s_add_u32 s43, s38, 344064
buffer_load_dwordx4 v3, s[12:15], s43 offen lds
s_add_u32 s37, s37, 128
s_add_u32 s38, s38, 393216
s_waitcnt vmcnt(28)
s_mov_b32 s43, 0x3f803f80
v_mov_b32 v116, 0
v_mov_b32 v117, 0
v_mov_b32 v118, 0
v_mov_b32 v119, 0
v_mov_b32 v120, 0
v_mov_b32 v121, 0
v_mov_b32 v122, 0
v_mov_b32 v123, 0
v_dot2_f32_bf16 v116, v96, s43, v116
v_dot2_f32_bf16 v120, v96, v96, v120
v_dot2_f32_bf16 v118, v104, s43, v118
v_dot2_f32_bf16 v122, v104, v104, v122
v_dot2_f32_bf16 v117, v97, s43, v117
v_dot2_f32_bf16 v121, v97, v97, v121
v_dot2_f32_bf16 v119, v105, s43, v119
v_dot2_f32_bf16 v123, v105, v105, v123
v_dot2_f32_bf16 v116, v98, s43, v116
v_dot2_f32_bf16 v120, v98, v98, v120
v_dot2_f32_bf16 v118, v106, s43, v118
v_dot2_f32_bf16 v122, v106, v106, v122
v_dot2_f32_bf16 v117, v99, s43, v117
v_dot2_f32_bf16 v121, v99, v99, v121
v_dot2_f32_bf16 v119, v107, s43, v119
v_dot2_f32_bf16 v123, v107, v107, v123
v_dot2_f32_bf16 v116, v100, s43, v116
v_dot2_f32_bf16 v120, v100, v100, v120
v_dot2_f32_bf16 v118, v108, s43, v118
v_dot2_f32_bf16 v122, v108, v108, v122
v_dot2_f32_bf16 v117, v101, s43, v117
v_dot2_f32_bf16 v121, v101, v101, v121
v_dot2_f32_bf16 v119, v109, s43, v119
v_dot2_f32_bf16 v123, v109, v109, v123
v_dot2_f32_bf16 v116, v102, s43, v116
v_dot2_f32_bf16 v120, v102, v102, v120
v_dot2_f32_bf16 v118, v110, s43, v118
v_dot2_f32_bf16 v122, v110, v110, v122
v_dot2_f32_bf16 v117, v103, s43, v117
v_dot2_f32_bf16 v121, v103, v103, v121
v_dot2_f32_bf16 v119, v111, s43, v119
v_dot2_f32_bf16 v123, v111, v111, v123
s_nop 2
v_add_f32 v116, v116, v117
v_add_f32 v118, v118, v119
v_add_f32 v120, v120, v121
v_add_f32 v122, v122, v123
s_nop 1
v_permlane32_swap_b32 v116, v118
v_permlane32_swap_b32 v120, v122
v_add_f32 v116, v116, v118
v_add_f32 v120, v120, v122
s_nop 1
v_permlane16_swap_b32 v116, v120
v_add_f32 v116, v116, v120
s_nop 1
v_add_f32_dpp v116, v116, v116 row_ror:8 row_mask:0xf bank_mask:0xf
s_nop 1
v_add_f32_dpp v116, v116, v116 row_ror:4 row_mask:0xf bank_mask:0xf
s_nop 1
v_add_f32_dpp v116, v116, v116 row_ror:2 row_mask:0xf bank_mask:0xf
s_nop 1
v_add_f32_dpp v116, v116, v116 row_ror:1 row_mask:0xf bank_mask:0xf
v_mov_b32 v117, v116
s_nop 1
v_permlane16_swap_b32 v116, v117
v_mul_f32 v112, 0x3a800000, v116
v_mul_f32 v113, 0x3a800000, v117
v_fma_f32 v113, -v112, v112, v113
v_max_f32 v113, 0, v113
v_add_f32 v113, 0x3727c5ac, v113
v_rsq_f32 v113, v113
v_lshrrev_b32 v11, 5, v1
s_lshl_b32 s43, s47, 4
s_add_u32 s43, s43, 148608
v_lshl_add_u32 v11, v11, 3, s43
ds_write_b64 v11, v[112:113]
s_waitcnt lgkmcnt(0)
s_and_b32 s44, s36, 3
s_mul_i32 s44, s44, 24
s_bfe_u32 s43, s2, 0x30001
s_lshl_b32 s43, s43, 7
s_add_u32 s44, s44, s43
s_mul_i32 s44, s44, 7168
s_lshr_b32 s43, s2, 4
s_lshl_b32 s43, s43, 8
s_add_u32 s43, s43, s44
s_bitcmp0_b32 s2, 0
s_cselect_b32 s4, s72, s74
s_cselect_b32 s5, s73, s75
s_add_u32 s4, s4, s43
s_addc_u32 s5, s5, 0
s_waitcnt vmcnt(14)
s_barrier
s_add_u32 m0, s39, 0
s_mov_b64 exec, s[60:61]
buffer_load_dwordx4 v4, s[8:11], s37 offen lds
s_mov_b64 exec, -1
s_add_u32 m0, s39, 3072
s_nop 0
buffer_load_dwordx4 v5, s[8:11], s37 offen lds
s_add_u32 m0, s39, 6144
s_nop 0
buffer_load_dwordx4 v6, s[8:11], s37 offen lds
s_add_u32 m0, s39, 9216
s_nop 0
buffer_load_dwordx4 v7, s[8:11], s37 offen lds
s_add_u32 m0, s39, 12288
s_nop 0
buffer_load_dwordx4 v8, s[8:11], s37 offen lds
s_add_u32 m0, s39, 15360
s_nop 0
buffer_load_dwordx4 v9, s[8:11], s37 offen lds
s_add_u32 m0, s40, 0
s_add_u32 s43, s38, 0
buffer_load_dwordx4 v2, s[12:15], s43 offen lds
s_add_u32 m0, s40, 1024
s_add_u32 s43, s38, 49152
buffer_load_dwordx4 v3, s[12:15], s43 offen lds
s_add_u32 m0, s40, 2048
s_add_u32 s43, s38, 98304
buffer_load_dwordx4 v2, s[12:15], s43 offen lds
s_add_u32 m0, s40, 3072
s_add_u32 s43, s38, 147456
buffer_load_dwordx4 v3, s[12:15], s43 offen lds
s_add_u32 m0, s40, 4096
s_add_u32 s43, s38, 196608
buffer_load_dwordx4 v2, s[12:15], s43 offen lds
s_add_u32 m0, s40, 5120
s_add_u32 s43, s38, 245760
buffer_load_dwordx4 v3, s[12:15], s43 offen lds
s_add_u32 m0, s40, 6144
s_add_u32 s43, s38, 294912
buffer_load_dwordx4 v2, s[12:15], s43 offen lds
s_add_u32 m0, s40, 7168
s_add_u32 s43, s38, 344064
buffer_load_dwordx4 v3, s[12:15], s43 offen lds
s_add_u32 s37, s37, 128
s_add_u32 s38, s38, 393216
s_waitcnt vmcnt(14)
s_barrier
s_add_u32 m0, s39, 43008
s_mov_b64 exec, s[60:61]
buffer_load_dwordx4 v4, s[8:11], s37 offen lds
s_mov_b64 exec, -1
s_add_u32 m0, s39, 46080
s_nop 0
buffer_load_dwordx4 v5, s[8:11], s37 offen lds
s_add_u32 m0, s39, 49152
s_nop 0
buffer_load_dwordx4 v6, s[8:11], s37 offen lds
s_add_u32 m0, s39, 52224
s_nop 0
buffer_load_dwordx4 v7, s[8:11], s37 offen lds
s_add_u32 m0, s39, 55296
s_nop 0
buffer_load_dwordx4 v8, s[8:11], s37 offen lds
s_add_u32 m0, s39, 58368
s_nop 0
buffer_load_dwordx4 v9, s[8:11], s37 offen lds
s_add_u32 m0, s40, 43008
s_add_u32 s43, s38, 0
buffer_load_dwordx4 v2, s[12:15], s43 offen lds
s_add_u32 m0, s40, 44032
s_add_u32 s43, s38, 49152
buffer_load_dwordx4 v3, s[12:15], s43 offen lds
s_add_u32 m0, s40, 45056
s_add_u32 s43, s38, 98304
buffer_load_dwordx4 v2, s[12:15], s43 offen lds
s_add_u32 m0, s40, 46080
s_add_u32 s43, s38, 147456
buffer_load_dwordx4 v3, s[12:15], s43 offen lds
s_add_u32 m0, s40, 47104
s_add_u32 s43, s38, 196608
buffer_load_dwordx4 v2, s[12:15], s43 offen lds
s_add_u32 m0, s40, 48128
s_add_u32 s43, s38, 245760
buffer_load_dwordx4 v3, s[12:15], s43 offen lds
s_add_u32 m0, s40, 49152
s_add_u32 s43, s38, 294912
buffer_load_dwordx4 v2, s[12:15], s43 offen lds
s_add_u32 m0, s40, 50176
s_add_u32 s43, s38, 344064
buffer_load_dwordx4 v3, s[12:15], s43 offen lds
s_add_u32 s37, s37, 128
s_add_u32 s38, s38, 393216
s_load_dword s3, s[4:5], 0
s_load_dword s3, s[4:5], 64
s_load_dword s3, s[4:5], 128
s_waitcnt vmcnt(14)
s_barrier
s_add_u32 m0, s39, 86016
s_mov_b64 exec, s[60:61]
buffer_load_dwordx4 v4, s[8:11], s37 offen lds
s_mov_b64 exec, -1
s_add_u32 m0, s39, 89088
s_nop 0
buffer_load_dwordx4 v5, s[8:11], s37 offen lds
s_add_u32 m0, s39, 92160
s_nop 0
buffer_load_dwordx4 v6, s[8:11], s37 offen lds
s_add_u32 m0, s39, 95232
s_nop 0
buffer_load_dwordx4 v7, s[8:11], s37 offen lds
s_add_u32 m0, s39, 98304
s_nop 0
buffer_load_dwordx4 v8, s[8:11], s37 offen lds
s_add_u32 m0, s39, 101376
s_nop 0
buffer_load_dwordx4 v9, s[8:11], s37 offen lds
s_add_u32 m0, s40, 86016
s_add_u32 s43, s38, 0
buffer_load_dwordx4 v2, s[12:15], s43 offen lds
s_add_u32 m0, s40, 87040
s_add_u32 s43, s38, 49152
buffer_load_dwordx4 v3, s[12:15], s43 offen lds
s_add_u32 m0, s40, 88064
s_add_u32 s43, s38, 98304
buffer_load_dwordx4 v2, s[12:15], s43 offen lds
s_add_u32 m0, s40, 89088
s_add_u32 s43, s38, 147456
buffer_load_dwordx4 v3, s[12:15], s43 offen lds
s_add_u32 m0, s40, 90112
s_add_u32 s43, s38, 196608
buffer_load_dwordx4 v2, s[12:15], s43 offen lds
s_add_u32 m0, s40, 91136
s_add_u32 s43, s38, 245760
buffer_load_dwordx4 v3, s[12:15], s43 offen lds
s_add_u32 m0, s40, 92160
s_add_u32 s43, s38, 294912
buffer_load_dwordx4 v2, s[12:15], s43 offen lds
s_add_u32 m0, s40, 93184
s_add_u32 s43, s38, 344064
buffer_load_dwordx4 v3, s[12:15], s43 offen lds
s_add_u32 s37, s37, 128
s_add_u32 s38, s38, 393216
s_load_dword s3, s[4:5], 192
s_load_dword s3, s[4:5], 7168
s_load_dword s3, s[4:5], 7232
s_load_dword s3, s[4:5], 7296
s_waitcnt vmcnt(14)
s_barrier
s_add_u32 m0, s39, 0
s_mov_b64 exec, s[60:61]
buffer_load_dwordx4 v4, s[8:11], s37 offen lds
s_mov_b64 exec, -1
s_add_u32 m0, s39, 3072
s_nop 0
buffer_load_dwordx4 v5, s[8:11], s37 offen lds
s_add_u32 m0, s39, 6144
s_nop 0
buffer_load_dwordx4 v6, s[8:11], s37 offen lds
s_branch Lov_0
.p2align 12
Lst_0_0:
s_branch Lwr_167
s_nop 0
s_nop 0
Lov_0:
s_add_u32 m0, s39, 9216
s_nop 0
buffer_load_dwordx4 v7, s[8:11], s37 offen lds
s_add_u32 m0, s39, 12288
s_nop 0
buffer_load_dwordx4 v8, s[8:11], s37 offen lds
s_add_u32 m0, s39, 15360
s_nop 0
buffer_load_dwordx4 v9, s[8:11], s37 offen lds
s_add_u32 m0, s40, 0
s_add_u32 s43, s38, 0
buffer_load_dwordx4 v2, s[12:15], s43 offen lds
s_add_u32 m0, s40, 1024
s_add_u32 s43, s38, 49152
buffer_load_dwordx4 v3, s[12:15], s43 offen lds
s_add_u32 m0, s40, 2048
s_add_u32 s43, s38, 98304
buffer_load_dwordx4 v2, s[12:15], s43 offen lds
s_add_u32 m0, s40, 3072
s_add_u32 s43, s38, 147456
buffer_load_dwordx4 v3, s[12:15], s43 offen lds
s_add_u32 m0, s40, 4096
s_add_u32 s43, s38, 196608
buffer_load_dwordx4 v2, s[12:15], s43 offen lds
s_add_u32 m0, s40, 5120
s_add_u32 s43, s38, 245760
buffer_load_dwordx4 v3, s[12:15], s43 offen lds
s_add_u32 m0, s40, 6144
s_add_u32 s43, s38, 294912
buffer_load_dwordx4 v2, s[12:15], s43 offen lds
s_add_u32 m0, s40, 7168
s_add_u32 s43, s38, 344064
buffer_load_dwordx4 v3, s[12:15], s43 offen lds
s_add_u32 s37, s37, 128
s_add_u32 s38, s38, 393216
s_load_dword s3, s[4:5], 7360
s_load_dword s3, s[4:5], 14336
s_load_dword s3, s[4:5], 14400
s_load_dword s3, s[4:5], 14464
s_load_dword s3, s[4:5], 14528
s_waitcnt vmcnt(14)
s_barrier
s_add_u32 m0, s39, 43008
s_mov_b64 exec, s[60:61]
buffer_load_dwordx4 v4, s[8:11], s37 offen lds
s_mov_b64 exec, -1
s_add_u32 m0, s39, 46080
s_nop 0
buffer_load_dwordx4 v5, s[8:11], s37 offen lds
s_add_u32 m0, s39, 49152
s_nop 0
buffer_load_dwordx4 v6, s[8:11], s37 offen lds
s_add_u32 m0, s39, 52224
s_nop 0
buffer_load_dwordx4 v7, s[8:11], s37 offen lds
s_add_u32 m0, s39, 55296
s_nop 0
buffer_load_dwordx4 v8, s[8:11], s37 offen lds
s_add_u32 m0, s39, 58368
s_nop 0
buffer_load_dwordx4 v9, s[8:11], s37 offen lds
s_add_u32 m0, s40, 43008
s_add_u32 s43, s38, 0
buffer_load_dwordx4 v2, s[12:15], s43 offen lds
s_add_u32 m0, s40, 44032
s_add_u32 s43, s38, 49152
buffer_load_dwordx4 v3, s[12:15], s43 offen lds
s_add_u32 m0, s40, 45056
s_add_u32 s43, s38, 98304
buffer_load_dwordx4 v2, s[12:15], s43 offen lds
s_add_u32 m0, s40, 46080
s_add_u32 s43, s38, 147456
buffer_load_dwordx4 v3, s[12:15], s43 offen lds
s_add_u32 m0, s40, 47104
s_add_u32 s43, s38, 196608
buffer_load_dwordx4 v2, s[12:15], s43 offen lds
s_add_u32 m0, s40, 48128
s_add_u32 s43, s38, 245760
buffer_load_dwordx4 v3, s[12:15], s43 offen lds
s_add_u32 m0, s40, 49152
s_add_u32 s43, s38, 294912
buffer_load_dwordx4 v2, s[12:15], s43 offen lds
s_add_u32 m0, s40, 50176
s_add_u32 s43, s38, 344064
buffer_load_dwordx4 v3, s[12:15], s43 offen lds
s_add_u32 s37, s37, 128
s_add_u32 s38, s38, 393216
s_load_dword s3, s[4:5], 21504
s_load_dword s3, s[4:5], 21568
s_load_dword s3, s[4:5], 21632
s_load_dword s3, s[4:5], 21696
s_load_dword s3, s[4:5], 28672
s_load_dword s3, s[4:5], 28736
s_waitcnt vmcnt(14)
s_barrier
s_add_u32 m0, s39, 86016
s_mov_b64 exec, s[60:61]
buffer_load_dwordx4 v4, s[8:11], s37 offen lds
s_mov_b64 exec, -1
s_add_u32 m0, s39, 89088
s_nop 0
buffer_load_dwordx4 v5, s[8:11], s37 offen lds
s_add_u32 m0, s39, 92160
s_nop 0
buffer_load_dwordx4 v6, s[8:11], s37 offen lds
s_add_u32 m0, s39, 95232
s_nop 0
buffer_load_dwordx4 v7, s[8:11], s37 offen lds
s_add_u32 m0, s39, 98304
s_nop 0
buffer_load_dwordx4 v8, s[8:11], s37 offen lds
s_add_u32 m0, s39, 101376
s_nop 0
buffer_load_dwordx4 v9, s[8:11], s37 offen lds
s_add_u32 m0, s40, 86016
s_add_u32 s43, s38, 0
buffer_load_dwordx4 v2, s[12:15], s43 offen lds
s_add_u32 m0, s40, 87040
s_add_u32 s43, s38, 49152
buffer_load_dwordx4 v3, s[12:15], s43 offen lds
s_add_u32 m0, s40, 88064
s_add_u32 s43, s38, 98304
buffer_load_dwordx4 v2, s[12:15], s43 offen lds
s_add_u32 m0, s40, 89088
s_add_u32 s43, s38, 147456
buffer_load_dwordx4 v3, s[12:15], s43 offen lds
s_add_u32 m0, s40, 90112
s_add_u32 s43, s38, 196608
buffer_load_dwordx4 v2, s[12:15], s43 offen lds
s_add_u32 m0, s40, 91136
s_add_u32 s43, s38, 245760
buffer_load_dwordx4 v3, s[12:15], s43 offen lds
s_add_u32 m0, s40, 92160
s_add_u32 s43, s38, 294912
buffer_load_dwordx4 v2, s[12:15], s43 offen lds
s_add_u32 m0, s40, 93184
s_add_u32 s43, s38, 344064
buffer_load_dwordx4 v3, s[12:15], s43 offen lds
s_add_u32 s37, s37, 128
s_add_u32 s38, s38, 393216
s_load_dword s3, s[4:5], 28800
s_load_dword s3, s[4:5], 28864
s_load_dword s3, s[4:5], 35840
s_load_dword s3, s[4:5], 35904
s_load_dword s3, s[4:5], 35968
s_load_dword s3, s[4:5], 36032
s_load_dword s3, s[4:5], 43008
s_waitcnt vmcnt(14)
s_barrier
s_add_u32 m0, s39, 0
s_mov_b64 exec, s[60:61]
buffer_load_dwordx4 v4, s[8:11], s37 offen lds
s_mov_b64 exec, -1
s_add_u32 m0, s39, 3072
s_nop 0
buffer_load_dwordx4 v5, s[8:11], s37 offen lds
s_add_u32 m0, s39, 6144
s_nop 0
buffer_load_dwordx4 v6, s[8:11], s37 offen lds
s_add_u32 m0, s39, 9216
s_nop 0
buffer_load_dwordx4 v7, s[8:11], s37 offen lds
s_add_u32 m0, s39, 12288
s_nop 0
buffer_load_dwordx4 v8, s[8:11], s37 offen lds
s_add_u32 m0, s39, 15360
s_nop 0
buffer_load_dwordx4 v9, s[8:11], s37 offen lds
s_add_u32 m0, s40, 0
s_add_u32 s43, s38, 0
buffer_load_dwordx4 v2, s[12:15], s43 offen lds
s_add_u32 m0, s40, 1024
s_add_u32 s43, s38, 49152
buffer_load_dwordx4 v3, s[12:15], s43 offen lds
s_add_u32 m0, s40, 2048
s_add_u32 s43, s38, 98304
buffer_load_dwordx4 v2, s[12:15], s43 offen lds
s_add_u32 m0, s40, 3072
s_add_u32 s43, s38, 147456
buffer_load_dwordx4 v3, s[12:15], s43 offen lds
s_add_u32 m0, s40, 4096
s_add_u32 s43, s38, 196608
buffer_load_dwordx4 v2, s[12:15], s43 offen lds
s_add_u32 m0, s40, 5120
s_add_u32 s43, s38, 245760
buffer_load_dwordx4 v3, s[12:15], s43 offen lds
s_add_u32 m0, s40, 6144
s_add_u32 s43, s38, 294912
buffer_load_dwordx4 v2, s[12:15], s43 offen lds
s_add_u32 m0, s40, 7168
s_add_u32 s43, s38, 344064
buffer_load_dwordx4 v3, s[12:15], s43 offen lds
s_add_u32 s37, s37, 128
s_add_u32 s38, s38, 393216
s_load_dword s3, s[4:5], 43072
s_load_dword s3, s[4:5], 43136
s_load_dword s3, s[4:5], 43200
s_load_dword s3, s[4:5], 50176
s_load_dword s3, s[4:5], 50240
s_load_dword s3, s[4:5], 50304
s_load_dword s3, s[4:5], 50368
s_load_dword s3, s[4:5], 57344
s_waitcnt vmcnt(14)
s_barrier
s_add_u32 m0, s39, 43008
s_mov_b64 exec, s[60:61]
buffer_load_dwordx4 v4, s[8:11], s37 offen lds
s_mov_b64 exec, -1
s_add_u32 m0, s39, 46080
s_nop 0
buffer_load_dwordx4 v5, s[8:11], s37 offen lds
s_add_u32 m0, s39, 49152
s_nop 0
buffer_load_dwordx4 v6, s[8:11], s37 offen lds
s_add_u32 m0, s39, 52224
s_nop 0
buffer_load_dwordx4 v7, s[8:11], s37 offen lds
s_add_u32 m0, s39, 55296
s_nop 0
buffer_load_dwordx4 v8, s[8:11], s37 offen lds
s_add_u32 m0, s39, 58368
s_nop 0
buffer_load_dwordx4 v9, s[8:11], s37 offen lds
s_add_u32 m0, s40, 43008
s_add_u32 s43, s38, 0
buffer_load_dwordx4 v2, s[12:15], s43 offen lds
s_add_u32 m0, s40, 44032
s_add_u32 s43, s38, 49152
buffer_load_dwordx4 v3, s[12:15], s43 offen lds
s_add_u32 m0, s40, 45056
s_add_u32 s43, s38, 98304
buffer_load_dwordx4 v2, s[12:15], s43 offen lds
s_add_u32 m0, s40, 46080
s_add_u32 s43, s38, 147456
buffer_load_dwordx4 v3, s[12:15], s43 offen lds
s_add_u32 m0, s40, 47104
s_add_u32 s43, s38, 196608
buffer_load_dwordx4 v2, s[12:15], s43 offen lds
s_add_u32 m0, s40, 48128
s_add_u32 s43, s38, 245760
buffer_load_dwordx4 v3, s[12:15], s43 offen lds
s_add_u32 m0, s40, 49152
s_add_u32 s43, s38, 294912
buffer_load_dwordx4 v2, s[12:15], s43 offen lds
s_add_u32 m0, s40, 50176
s_add_u32 s43, s38, 344064
buffer_load_dwordx4 v3, s[12:15], s43 offen lds
s_add_u32 s37, s37, 128
s_add_u32 s38, s38, 393216
s_load_dword s3, s[4:5], 57408
s_load_dword s3, s[4:5], 57472
s_load_dword s3, s[4:5], 57536
s_load_dword s3, s[4:5], 64512
s_load_dword s3, s[4:5], 64576
s_load_dword s3, s[4:5], 64640
s_load_dword s3, s[4:5], 64704
s_load_dword s3, s[4:5], 71680
s_load_dword s3, s[4:5], 71744
s_waitcnt vmcnt(14)
s_barrier
s_add_u32 m0, s39, 86016
s_mov_b64 exec, s[60:61]
buffer_load_dwordx4 v4, s[8:11], s37 offen lds
s_mov_b64 exec, -1
s_add_u32 m0, s39, 89088
s_nop 0
buffer_load_dwordx4 v5, s[8:11], s37 offen lds
s_add_u32 m0, s39, 92160
s_nop 0
buffer_load_dwordx4 v6, s[8:11], s37 offen lds
s_add_u32 m0, s39, 95232
s_nop 0
buffer_load_dwordx4 v7, s[8:11], s37 offen lds
s_add_u32 m0, s39, 98304
s_nop 0
buffer_load_dwordx4 v8, s[8:11], s37 offen lds
s_add_u32 m0, s39, 101376
s_nop 0
buffer_load_dwordx4 v9, s[8:11], s37 offen lds
s_add_u32 m0, s40, 86016
s_add_u32 s43, s38, 0
buffer_load_dwordx4 v2, s[12:15], s43 offen lds
s_add_u32 m0, s40, 87040
s_add_u32 s43, s38, 49152
buffer_load_dwordx4 v3, s[12:15], s43 offen lds
s_add_u32 m0, s40, 88064
s_add_u32 s43, s38, 98304
buffer_load_dwordx4 v2, s[12:15], s43 offen lds
s_add_u32 m0, s40, 89088
s_add_u32 s43, s38, 147456
buffer_load_dwordx4 v3, s[12:15], s43 offen lds
s_add_u32 m0, s40, 90112
s_add_u32 s43, s38, 196608
buffer_load_dwordx4 v2, s[12:15], s43 offen lds
s_add_u32 m0, s40, 91136
s_add_u32 s43, s38, 245760
buffer_load_dwordx4 v3, s[12:15], s43 offen lds
s_add_u32 m0, s40, 92160
s_add_u32 s43, s38, 294912
buffer_load_dwordx4 v2, s[12:15], s43 offen lds
s_add_u32 m0, s40, 93184
s_add_u32 s43, s38, 344064
buffer_load_dwordx4 v3, s[12:15], s43 offen lds
s_add_u32 s37, s37, 128
s_add_u32 s38, s38, 393216
s_load_dword s3, s[4:5], 71808
s_load_dword s3, s[4:5], 71872
s_load_dword s3, s[4:5], 78848
s_load_dword s3, s[4:5], 78912
s_load_dword s3, s[4:5], 78976
s_load_dword s3, s[4:5], 79040
s_load_dword s3, s[4:5], 86016
s_load_dword s3, s[4:5], 86080
s_load_dword s3, s[4:5], 86144
s_waitcnt vmcnt(14)
s_barrier
s_add_u32 m0, s39, 0
s_mov_b64 exec, s[60:61]
buffer_load_dwordx4 v4, s[8:11], s37 offen lds
s_mov_b64 exec, -1
s_add_u32 m0, s39, 3072
s_nop 0
buffer_load_dwordx4 v5, s[8:11], s37 offen lds
s_add_u32 m0, s39, 6144
s_nop 0
buffer_load_dwordx4 v6, s[8:11], s37 offen lds
s_add_u32 m0, s39, 9216
s_nop 0
buffer_load_dwordx4 v7, s[8:11], s37 offen lds
s_add_u32 m0, s39, 12288
s_nop 0
buffer_load_dwordx4 v8, s[8:11], s37 offen lds
s_add_u32 m0, s39, 15360
s_nop 0
buffer_load_dwordx4 v9, s[8:11], s37 offen lds
s_add_u32 m0, s40, 0
s_add_u32 s43, s38, 0
buffer_load_dwordx4 v2, s[12:15], s43 offen lds
s_add_u32 m0, s40, 1024
s_add_u32 s43, s38, 49152
buffer_load_dwordx4 v3, s[12:15], s43 offen lds
s_add_u32 m0, s40, 2048
s_add_u32 s43, s38, 98304
buffer_load_dwordx4 v2, s[12:15], s43 offen lds
s_add_u32 m0, s40, 3072
s_add_u32 s43, s38, 147456
buffer_load_dwordx4 v3, s[12:15], s43 offen lds
s_add_u32 m0, s40, 4096
s_add_u32 s43, s38, 196608
buffer_load_dwordx4 v2, s[12:15], s43 offen lds
s_add_u32 m0, s40, 5120
s_add_u32 s43, s38, 245760
buffer_load_dwordx4 v3, s[12:15], s43 offen lds
s_add_u32 m0, s40, 6144
s_add_u32 s43, s38, 294912
buffer_load_dwordx4 v2, s[12:15], s43 offen lds
s_add_u32 m0, s40, 7168
s_add_u32 s43, s38, 344064
buffer_load_dwordx4 v3, s[12:15], s43 offen lds
s_add_u32 s37, s37, 128
s_add_u32 s38, s38, 393216
s_load_dword s3, s[4:5], 86208
s_load_dword s3, s[4:5], 93184
s_load_dword s3, s[4:5], 93248
s_load_dword s3, s[4:5], 93312
s_load_dword s3, s[4:5], 93376
s_load_dword s3, s[4:5], 100352
s_load_dword s3, s[4:5], 100416
s_load_dword s3, s[4:5], 100480
s_load_dword s3, s[4:5], 100544
s_waitcnt vmcnt(14)
s_barrier
s_add_u32 m0, s39, 43008
s_mov_b64 exec, s[60:61]
buffer_load_dwordx4 v4, s[8:11], s37 offen lds
s_mov_b64 exec, -1
s_add_u32 m0, s39, 46080
s_nop 0
buffer_load_dwordx4 v5, s[8:11], s37 offen lds
s_add_u32 m0, s39, 49152
s_nop 0
buffer_load_dwordx4 v6, s[8:11], s37 offen lds
s_add_u32 m0, s39, 52224
s_nop 0
buffer_load_dwordx4 v7, s[8:11], s37 offen lds
s_add_u32 m0, s39, 55296
s_nop 0
buffer_load_dwordx4 v8, s[8:11], s37 offen lds
s_add_u32 m0, s39, 58368
s_nop 0
buffer_load_dwordx4 v9, s[8:11], s37 offen lds
s_add_u32 m0, s40, 43008
s_add_u32 s43, s38, 0
buffer_load_dwordx4 v2, s[12:15], s43 offen lds
s_add_u32 m0, s40, 44032
s_add_u32 s43, s38, 49152
buffer_load_dwordx4 v3, s[12:15], s43 offen lds
s_add_u32 m0, s40, 45056
s_add_u32 s43, s38, 98304
buffer_load_dwordx4 v2, s[12:15], s43 offen lds
s_add_u32 m0, s40, 46080
s_add_u32 s43, s38, 147456
buffer_load_dwordx4 v3, s[12:15], s43 offen lds
s_add_u32 m0, s40, 47104
s_add_u32 s43, s38, 196608
buffer_load_dwordx4 v2, s[12:15], s43 offen lds
s_add_u32 m0, s40, 48128
s_add_u32 s43, s38, 245760
buffer_load_dwordx4 v3, s[12:15], s43 offen lds
s_add_u32 m0, s40, 49152
s_add_u32 s43, s38, 294912
buffer_load_dwordx4 v2, s[12:15], s43 offen lds
s_add_u32 m0, s40, 50176
s_add_u32 s43, s38, 344064
buffer_load_dwordx4 v3, s[12:15], s43 offen lds
s_add_u32 s37, s37, 128
s_add_u32 s38, s38, 393216
s_load_dword s3, s[4:5], 107520
s_load_dword s3, s[4:5], 107584
s_load_dword s3, s[4:5], 107648
s_load_dword s3, s[4:5], 107712
s_load_dword s3, s[4:5], 114688
s_load_dword s3, s[4:5], 114752
s_load_dword s3, s[4:5], 114816
s_load_dword s3, s[4:5], 114880
s_load_dword s3, s[4:5], 121856
s_waitcnt vmcnt(14)
s_barrier
s_add_u32 m0, s39, 86016
s_mov_b64 exec, s[60:61]
buffer_load_dwordx4 v4, s[8:11], s37 offen lds
s_mov_b64 exec, -1
s_add_u32 m0, s39, 89088
s_nop 0
buffer_load_dwordx4 v5, s[8:11], s37 offen lds
s_add_u32 m0, s39, 92160
s_nop 0
buffer_load_dwordx4 v6, s[8:11], s37 offen lds
s_add_u32 m0, s39, 95232
s_nop 0
buffer_load_dwordx4 v7, s[8:11], s37 offen lds
s_add_u32 m0, s39, 98304
s_nop 0
buffer_load_dwordx4 v8, s[8:11], s37 offen lds
s_add_u32 m0, s39, 101376
s_nop 0
buffer_load_dwordx4 v9, s[8:11], s37 offen lds
s_add_u32 m0, s40, 86016
s_add_u32 s43, s38, 0
buffer_load_dwordx4 v2, s[12:15], s43 offen lds
s_add_u32 m0, s40, 87040
s_add_u32 s43, s38, 49152
buffer_load_dwordx4 v3, s[12:15], s43 offen lds
s_add_u32 m0, s40, 88064
s_add_u32 s43, s38, 98304
buffer_load_dwordx4 v2, s[12:15], s43 offen lds
s_add_u32 m0, s40, 89088
s_add_u32 s43, s38, 147456
buffer_load_dwordx4 v3, s[12:15], s43 offen lds
s_add_u32 m0, s40, 90112
s_add_u32 s43, s38, 196608
buffer_load_dwordx4 v2, s[12:15], s43 offen lds
s_add_u32 m0, s40, 91136
s_add_u32 s43, s38, 245760
buffer_load_dwordx4 v3, s[12:15], s43 offen lds
s_add_u32 m0, s40, 92160
s_add_u32 s43, s38, 294912
buffer_load_dwordx4 v2, s[12:15], s43 offen lds
s_add_u32 m0, s40, 93184
s_add_u32 s43, s38, 344064
buffer_load_dwordx4 v3, s[12:15], s43 offen lds
s_add_u32 s37, s37, 128
s_add_u32 s38, s38, 393216
s_load_dword s3, s[4:5], 121920
s_load_dword s3, s[4:5], 121984
s_load_dword s3, s[4:5], 122048
s_load_dword s3, s[4:5], 129024
s_load_dword s3, s[4:5], 129088
s_load_dword s3, s[4:5], 129152
s_load_dword s3, s[4:5], 129216
s_load_dword s3, s[4:5], 136192
s_load_dword s3, s[4:5], 136256
s_waitcnt vmcnt(14)
s_barrier
s_add_u32 m0, s39, 0
s_mov_b64 exec, s[60:61]
buffer_load_dwordx4 v4, s[8:11], s37 offen lds
s_mov_b64 exec, -1
s_add_u32 m0, s39, 3072
s_nop 0
buffer_load_dwordx4 v5, s[8:11], s37 offen lds
s_add_u32 m0, s39, 6144
s_nop 0
buffer_load_dwordx4 v6, s[8:11], s37 offen lds
s_add_u32 m0, s39, 9216
s_nop 0
buffer_load_dwordx4 v7, s[8:11], s37 offen lds
s_add_u32 m0, s39, 12288
s_nop 0
buffer_load_dwordx4 v8, s[8:11], s37 offen lds
s_add_u32 m0, s39, 15360
s_nop 0
buffer_load_dwordx4 v9, s[8:11], s37 offen lds
s_add_u32 m0, s40, 0
s_add_u32 s43, s38, 0
buffer_load_dwordx4 v2, s[12:15], s43 offen lds
s_add_u32 m0, s40, 1024
s_add_u32 s43, s38, 49152
buffer_load_dwordx4 v3, s[12:15], s43 offen lds
s_add_u32 m0, s40, 2048
s_add_u32 s43, s38, 98304
buffer_load_dwordx4 v2, s[12:15], s43 offen lds
s_add_u32 m0, s40, 3072
s_add_u32 s43, s38, 147456
buffer_load_dwordx4 v3, s[12:15], s43 offen lds
s_add_u32 m0, s40, 4096
s_add_u32 s43, s38, 196608
buffer_load_dwordx4 v2, s[12:15], s43 offen lds
s_add_u32 m0, s40, 5120
s_add_u32 s43, s38, 245760
buffer_load_dwordx4 v3, s[12:15], s43 offen lds
s_add_u32 m0, s40, 6144
s_add_u32 s43, s38, 294912
buffer_load_dwordx4 v2, s[12:15], s43 offen lds
s_add_u32 m0, s40, 7168
s_add_u32 s43, s38, 344064
buffer_load_dwordx4 v3, s[12:15], s43 offen lds
s_add_u32 s37, s37, 128
s_add_u32 s38, s38, 393216
s_load_dword s3, s[4:5], 136320
s_load_dword s3, s[4:5], 136384
s_load_dword s3, s[4:5], 143360
s_load_dword s3, s[4:5], 143424
s_load_dword s3, s[4:5], 143488
s_load_dword s3, s[4:5], 143552
s_load_dword s3, s[4:5], 150528
s_load_dword s3, s[4:5], 150592
s_load_dword s3, s[4:5], 150656
s_waitcnt vmcnt(14)
s_barrier
s_load_dword s3, s[4:5], 150720
s_load_dword s3, s[4:5], 157696
s_load_dword s3, s[4:5], 157760
s_load_dword s3, s[4:5], 157824
s_load_dword s3, s[4:5], 157888
s_load_dword s3, s[4:5], 164864
s_load_dword s3, s[4:5], 164928
s_load_dword s3, s[4:5], 164992
s_load_dword s3, s[4:5], 165056
s_waitcnt vmcnt(0)
s_barrier
s_bitcmp0_b32 s2, 0
s_cselect_b32 s88, s72, s74
s_cselect_b32 s89, s73, s75
s_cmp_lt_u32 s2, 192
s_cselect_b32 s90, 7340032, 0
s_mov_b32 s91, 0x20000
s_bfe_u32 s44, s2, 0x30001
s_lshl_b32 s44, s44, 2
s_and_b32 s43, s36, 3
s_add_u32 s44, s44, s43
s_lshl_b32 s44, s44, 5
v_lshrrev_b32 v18, 4, v1
v_add_u32 v18, s44, v18
v_mul_u32_u24 v18, 7168, v18
v_and_b32 v19, 15, v1
v_lshl_add_u32 v18, v19, 4, v18
s_lshr_b32 s43, s2, 4
s_branch Lov_1
.p2align 12
Lst_1_0:
s_branch Lwr_168
s_nop 0
s_nop 0
Lov_1:
s_lshl_b32 s43, s43, 8
s_add_u32 s43, s43, 4096
v_add_u32 v18, s43, v18
s_mov_b32 s43, 0
buffer_load_dwordx4 v[128:131], v18, s[88:91], s43 offen
s_mov_b32 s43, 28672
buffer_load_dwordx4 v[132:135], v18, s[88:91], s43 offen
s_mov_b32 s43, 57344
buffer_load_dwordx4 v[136:139], v18, s[88:91], s43 offen
s_mov_b32 s43, 86016
buffer_load_dwordx4 v[140:143], v18, s[88:91], s43 offen
s_mov_b32 s43, 114688
buffer_load_dwordx4 v[144:147], v18, s[88:91], s43 offen
s_mov_b32 s43, 143360
buffer_load_dwordx4 v[148:151], v18, s[88:91], s43 offen
s_mov_b32 s43, 172032
buffer_load_dwordx4 v[152:155], v18, s[88:91], s43 offen
s_mov_b32 s43, 200704
buffer_load_dwordx4 v[156:159], v18, s[88:91], s43 offen
s_barrier
s_lshl_b32 s43, s35, 7
s_add_u32 s28, s68, s43
s_addc_u32 s29, s69, 0
s_mov_b32 s30, 2095232
s_mov_b32 s31, 0x20000
v_lshrrev_b32 v15, 3, v1
v_and_b32 v16, 6, v15
v_and_b32 v7, 7, v1
v_xor_b32 v7, v7, v16
v_lshlrev_b32 v7, 4, v7
v_mul_u32_u24 v15, 2048, v15
v_add_u32 v7, v7, v15
s_and_b32 s40, s36, 3
s_lshl_b32 s39, s40, 13
s_add_u32 s40, s40, s35
s_add_u32 s42, s40, 0
s_and_b32 s42, s42, 15
s_lshl_b32 s42, s42, 17
s_add_u32 m0, s39, 65536
s_add_u32 s43, s42, 0
buffer_load_dwordx4 v7, s[28:31], s43 offen lds
s_add_u32 m0, s39, 66560
s_add_u32 s43, s42, 16384
buffer_load_dwordx4 v7, s[28:31], s43 offen lds
s_add_u32 m0, s39, 67584
s_add_u32 s43, s42, 32768
buffer_load_dwordx4 v7, s[28:31], s43 offen lds
s_add_u32 m0, s39, 68608
s_add_u32 s43, s42, 49152
buffer_load_dwordx4 v7, s[28:31], s43 offen lds
s_add_u32 m0, s39, 69632
s_add_u32 s43, s42, 65536
buffer_load_dwordx4 v7, s[28:31], s43 offen lds
s_add_u32 m0, s39, 70656
s_add_u32 s43, s42, 81920
buffer_load_dwordx4 v7, s[28:31], s43 offen lds
s_add_u32 m0, s39, 71680
s_add_u32 s43, s42, 98304
buffer_load_dwordx4 v7, s[28:31], s43 offen lds
s_add_u32 m0, s39, 72704
s_add_u32 s43, s42, 114688
buffer_load_dwordx4 v7, s[28:31], s43 offen lds
s_branch Lats_6
Lcons_7:
s_lshl_b32 s43, s35, 7
s_waitcnt lgkmcnt(0)
s_mov_b32 s8, s64
s_mov_b32 s9, s65
s_mov_b32 s10, 4194304
s_mov_b32 s11, 0x20000
s_add_u32 s12, s66, s43
s_addc_u32 s13, s67, 0
s_mov_b32 s14, 6289536
s_mov_b32 s15, 0x20000
s_lshr_b32 s43, s2, 3
s_lshl_b32 s43, s43, 2
s_add_u32 s43, s43, s36
s_sub_u32 s44, s43, 0
s_and_b32 s44, s44, 127
s_cmp_lt_u32 s44, 7
s_cbranch_scc0 Lt_8
s_lshl_b32 s44, s44, 20
s_min_u32 s44, s44, 6291392
s_load_dword s3, s[66:67], s44
Lt_8:
s_sub_u32 s44, s43, 7
s_and_b32 s44, s44, 127
s_cmp_lt_u32 s44, 5
s_cbranch_scc0 Lt_9
s_lshl_b32 s44, s44, 20
s_min_u32 s44, s44, 4194240
s_load_dword s3, s[64:65], s44
Lt_9:
s_sub_u32 s44, s43, 12
s_and_b32 s44, s44, 127
s_cmp_lt_u32 s44, 1
s_cbranch_scc0 Lt_10
s_lshl_b32 s44, s44, 20
s_min_u32 s44, s44, 0
s_load_dword s3, s[80:81], s44 glc
Lt_10:
s_sub_u32 s44, s43, 13
s_and_b32 s44, s44, 127
s_cmp_lt_u32 s44, 24
s_cbranch_scc0 Lt_11
s_lshl_b32 s44, s44, 20
s_min_u32 s44, s44, 24117184
s_load_dword s3, s[82:83], s44 glc
Lt_11:
s_sub_u32 s44, s43, 37
s_and_b32 s44, s44, 127
s_cmp_lt_u32 s44, 8
s_cbranch_scc0 Lt_12
s_lshl_b32 s44, s44, 20
s_min_u32 s44, s44, 7339968
s_load_dword s3, s[72:73], s44
Lt_12:
s_sub_u32 s44, s43, 45
s_and_b32 s44, s44, 127
s_cmp_lt_u32 s44, 8
s_cbranch_scc0 Lt_13
s_lshl_b32 s44, s44, 20
s_min_u32 s44, s44, 7339968
s_load_dword s3, s[74:75], s44
Lt_13:
s_sub_u32 s44, s43, 53
s_and_b32 s44, s44, 127
s_cmp_lt_u32 s44, 3
s_cbranch_scc0 Lt_14
s_lshl_b32 s44, s44, 20
s_min_u32 s44, s44, 2097088
s_load_dword s3, s[68:69], s44
Lt_14:
s_sub_u32 s44, s43, 56
s_and_b32 s44, s44, 127
s_cmp_lt_u32 s44, 5
s_cbranch_scc0 Lt_15
s_lshl_b32 s44, s44, 20
s_min_u32 s44, s44, 4194240
s_add_u32 s44, s44, 25165824
s_load_dword s3, s[82:83], s44 glc
Lt_15:
s_sub_u32 s44, s43, 61
s_and_b32 s44, s44, 127
s_cmp_lt_u32 s44, 8
s_cbranch_scc0 Lt_16
s_lshl_b32 s44, s44, 20
s_min_u32 s44, s44, 7339968
s_load_dword s3, s[76:77], s44
Lt_16:
s_sub_u32 s44, s43, 69
s_and_b32 s44, s44, 127
s_cmp_lt_u32 s44, 5
s_cbranch_scc0 Lt_17
s_lshl_b32 s44, s44, 20
s_min_u32 s44, s44, 4194240
s_add_u32 s44, s44, 33554432
s_load_dword s3, s[82:83], s44 glc
Lt_17:
s_sub_u32 s44, s43, 74
s_and_b32 s44, s44, 127
s_cmp_lt_u32 s44, 5
s_cbranch_scc0 Lt_18
s_lshl_b32 s44, s44, 20
s_min_u32 s44, s44, 4194240
s_load_dword s3, s[78:79], s44 glc
Lt_18:
v_lshrrev_b32 v16, 1, v12
v_xor_b32 v15, v13, v16
v_lshlrev_b32 v15, 4, v15
v_lshl_add_u32 v2, v12, 7, v15
v_xor_b32 v3, 64, v2
v_add_u32 v4, 86016, v2
v_add_u32 v5, 86016, v3
v_lshrrev_b32 v15, 2, v12
v_and_b32 v16, 3, v1
v_lshl_add_u32 v19, v13, 3, v15
v_lshlrev_b32 v19, 7, v19
v_and_b32 v15, 2, v15
v_and_b32 v17, 1, v13
v_lshl_add_u32 v15, v17, 2, v15
v_lshrrev_b32 v17, 1, v16
s_lshl_b32 s43, s36, 1
v_add_u32 v17, s43, v17
v_xor_b32 v15, v15, v17
v_lshl_add_u32 v19, v15, 4, v19
v_and_b32 v16, 1, v16
v_lshl_add_u32 v19, v16, 3, v19
v_add_u32 v6, 18432, v19
v_add_u32 v7, 61440, v19
v_add_u32 v8, 104448, v19
s_and_b32 s43, s36, 1
s_bfe_u32 s44, s36, 0x10001
s_lshr_b32 s45, s36, 2
v_lshlrev_b32 v14, 2, v13
v_sub_u32 v14, v12, v14
v_mov_b32 v16, 0xff800000
s_or_b32 s46, s34, s45
s_cmp_lg_u32 s46, 0
s_cselect_b32 s46, 0, 0xff800000
v_subrev_u32 v15, 0, v14
v_cmp_ge_u32 vcc, 7, v15
v_add_u32 v15, 16, v15
s_nop 0
v_cndmask_b32 v248, v16, 0, vcc
v_cmp_ge_u32 vcc, 7, v15
s_nop 1
v_cndmask_b32 v244, v16, 0, vcc
v_or_b32 v240, s46, v244
v_subrev_u32 v15, 1, v14
v_cmp_ge_u32 vcc, 7, v15
v_add_u32 v15, 16, v15
s_nop 0
v_cndmask_b32 v249, v16, 0, vcc
v_cmp_ge_u32 vcc, 7, v15
s_nop 1
v_cndmask_b32 v245, v16, 0, vcc
v_or_b32 v241, s46, v245
v_subrev_u32 v15, 2, v14
v_cmp_ge_u32 vcc, 7, v15
v_add_u32 v15, 16, v15
s_nop 0
v_cndmask_b32 v250, v16, 0, vcc
v_cmp_ge_u32 vcc, 7, v15
s_nop 1
v_cndmask_b32 v246, v16, 0, vcc
v_or_b32 v242, s46, v246
v_subrev_u32 v15, 3, v14
v_cmp_ge_u32 vcc, 7, v15
v_add_u32 v15, 16, v15
s_nop 0
v_cndmask_b32 v251, v16, 0, vcc
v_cmp_ge_u32 vcc, 7, v15
s_nop 1
v_cndmask_b32 v247, v16, 0, vcc
v_or_b32 v243, s46, v247
s_lshl_b32 s46, s45, 6
s_add_u32 s46, s46, s44
s_add_u32 s46, s46, 16
v_lshl_add_u32 v14, v12, 1, s46
s_lshl_b32 s47, s43, 6
v_lshl_add_u32 v15, v13, 4, s47
v_mul_u32_u24 v20, 400, v14
v_add_u32 v20, v20, v15
v_subrev_u32 v16, 32, v14
v_max_i32 v16, 0, v16
v_mul_u32_u24 v21, 400, v16
v_add_u32 v21, v21, v15
v_lshrrev_b32 v16, 2, v12
v_lshl_add_u32 v16, v13, 2, v16
v_lshl_add_u32 v16, v16, 1, s46
v_and_b32 v17, 3, v1
v_lshl_add_u32 v17, v17, 3, s47
v_mul_u32_u24 v22, 400, v16
v_add_u32 v22, v22, v17
v_subrev_u32 v16, 32, v16
v_max_i32 v16, 0, v16
v_mul_u32_u24 v23, 400, v16
v_add_u32 v23, v23, v17
s_mul_i32 s60, s34, 262144
s_add_u32 s16, s82, s60
s_addc_u32 s17, s83, 0
s_mov_b32 s18, 262144
s_mov_b32 s19, 0x20000
s_lshl_b32 s60, s35, 14
s_lshl_b32 s43, s43, 13
s_add_u32 s60, s60, s43
s_lshl_b32 s43, s45, 12
s_add_u32 s60, s60, s43
s_lshl_b32 s43, s44, 10
s_add_u32 s60, s60, s43
v_lshlrev_b32 v24, 4, v1
s_mov_b32 s61, 0x3e8293ee
s_lshl_b32 s38, s35, 7
s_add_u32 s56, s82, 28311552
s_addc_u32 s57, s83, 0
s_mov_b32 s58, 114688
s_mov_b32 s59, 0x20000
s_barrier
ds_read_b128 v[32:35], v2 offset:0
ds_read_b64_tr_b16 v[72:73], v6 offset:8192
ds_read_b64_tr_b16 v[74:75], v6 offset:8704
ds_read_b64_tr_b16 v[76:77], v6 offset:16384
ds_read_b64_tr_b16 v[78:79], v6 offset:16896
ds_read_b64_tr_b16 v[68:69], v6 offset:0
ds_read_b64_tr_b16 v[70:71], v6 offset:512
ds_read_b128 v[36:39], v2 offset:2048
ds_read_b128 v[40:43], v2 offset:4096
ds_read_b128 v[44:47], v2 offset:6144
ds_read_b128 v[48:51], v2 offset:8192
ds_read_b128 v[52:55], v2 offset:10240
ds_read_b128 v[56:59], v2 offset:12288
ds_read_b128 v[60:63], v2 offset:14336
ds_read_b128 v[64:67], v2 offset:16384
s_waitcnt lgkmcnt(0)
v_mfma_f32_16x16x32_bf16 v[164:167], v[72:75], v[32:35], 0
ds_read_b128 v[80:83], v3 offset:0
v_mfma_f32_16x16x32_bf16 v[200:203], v[76:79], v[32:35], 0
ds_read_b64_tr_b16 v[120:121], v6 offset:12288
v_mfma_f32_16x16x32_bf16 v[128:131], v[68:71], v[32:35], 0
ds_read_b64_tr_b16 v[122:123], v6 offset:12800
v_mfma_f32_16x16x32_bf16 v[132:135], v[68:71], v[36:39], 0
ds_read_b64_tr_b16 v[124:125], v6 offset:20480
v_mfma_f32_16x16x32_bf16 v[204:207], v[76:79], v[36:39], 0
ds_read_b64_tr_b16 v[126:127], v6 offset:20992
v_mfma_f32_16x16x32_bf16 v[168:171], v[72:75], v[36:39], 0
ds_read_b64_tr_b16 v[116:117], v6 offset:4096
v_mfma_f32_16x16x32_bf16 v[172:175], v[72:75], v[40:43], 0
ds_read_b64_tr_b16 v[118:119], v6 offset:4608
v_mfma_f32_16x16x32_bf16 v[208:211], v[76:79], v[40:43], 0
ds_read_b128 v[84:87], v3 offset:2048
v_mfma_f32_16x16x32_bf16 v[136:139], v[68:71], v[40:43], 0
ds_read_b128 v[88:91], v3 offset:4096
v_mfma_f32_16x16x32_bf16 v[140:143], v[68:71], v[44:47], 0
ds_read_b128 v[92:95], v3 offset:6144
v_mfma_f32_16x16x32_bf16 v[212:215], v[76:79], v[44:47], 0
ds_read_b128 v[96:99], v3 offset:8192
v_mfma_f32_16x16x32_bf16 v[176:179], v[72:75], v[44:47], 0
ds_read_b128 v[100:103], v3 offset:10240
v_mfma_f32_16x16x32_bf16 v[180:183], v[72:75], v[48:51], 0
ds_read_b128 v[104:107], v3 offset:12288
v_mfma_f32_16x16x32_bf16 v[216:219], v[76:79], v[48:51], 0
ds_read_b128 v[108:111], v3 offset:14336
v_mfma_f32_16x16x32_bf16 v[144:147], v[68:71], v[48:51], 0
ds_read_b128 v[112:115], v3 offset:16384
v_mfma_f32_16x16x32_bf16 v[148:151], v[68:71], v[52:55], 0
v_mfma_f32_16x16x32_bf16 v[220:223], v[76:79], v[52:55], 0
v_mfma_f32_16x16x32_bf16 v[184:187], v[72:75], v[52:55], 0
v_mfma_f32_16x16x32_bf16 v[188:191], v[72:75], v[56:59], 0
v_mfma_f32_16x16x32_bf16 v[224:227], v[76:79], v[56:59], 0
v_mfma_f32_16x16x32_bf16 v[152:155], v[68:71], v[56:59], 0
v_mfma_f32_16x16x32_bf16 v[156:159], v[68:71], v[60:63], 0
v_mfma_f32_16x16x32_bf16 v[228:231], v[76:79], v[60:63], 0
v_mfma_f32_16x16x32_bf16 v[192:195], v[72:75], v[60:63], 0
v_mfma_f32_16x16x32_bf16 v[196:199], v[72:75], v[64:67], 0
v_mfma_f32_16x16x32_bf16 v[232:235], v[76:79], v[64:67], 0
v_mfma_f32_16x16x32_bf16 v[160:163], v[68:71], v[64:67], 0
s_waitcnt lgkmcnt(0)
s_barrier
v_mfma_f32_16x16x32_bf16 v[164:167], v[120:123], v[80:83], v[164:167]
ds_read_b128 v[32:35], v2 offset:43008
v_mfma_f32_16x16x32_bf16 v[200:203], v[124:127], v[80:83], v[200:203]
ds_read_b64_tr_b16 v[72:73], v7 offset:8192
v_mfma_f32_16x16x32_bf16 v[128:131], v[116:119], v[80:83], v[128:131]
ds_read_b64_tr_b16 v[74:75], v7 offset:8704
v_mfma_f32_16x16x32_bf16 v[132:135], v[116:119], v[84:87], v[132:135]
ds_read_b64_tr_b16 v[76:77], v7 offset:16384
v_mfma_f32_16x16x32_bf16 v[204:207], v[124:127], v[84:87], v[204:207]
ds_read_b64_tr_b16 v[78:79], v7 offset:16896
v_mfma_f32_16x16x32_bf16 v[168:171], v[120:123], v[84:87], v[168:171]
ds_read_b64_tr_b16 v[68:69], v7 offset:0
v_mfma_f32_16x16x32_bf16 v[172:175], v[120:123], v[88:91], v[172:175]
ds_read_b64_tr_b16 v[70:71], v7 offset:512
v_mfma_f32_16x16x32_bf16 v[208:211], v[124:127], v[88:91], v[208:211]
ds_read_b128 v[36:39], v2 offset:45056
v_mfma_f32_16x16x32_bf16 v[136:139], v[116:119], v[88:91], v[136:139]
ds_read_b128 v[40:43], v2 offset:47104
v_mfma_f32_16x16x32_bf16 v[140:143], v[116:119], v[92:95], v[140:143]
ds_read_b128 v[44:47], v2 offset:49152
v_mfma_f32_16x16x32_bf16 v[212:215], v[124:127], v[92:95], v[212:215]
ds_read_b128 v[48:51], v2 offset:51200
v_mfma_f32_16x16x32_bf16 v[176:179], v[120:123], v[92:95], v[176:179]
ds_read_b128 v[52:55], v2 offset:53248
v_mfma_f32_16x16x32_bf16 v[180:183], v[120:123], v[96:99], v[180:183]
ds_read_b128 v[56:59], v2 offset:55296
v_mfma_f32_16x16x32_bf16 v[216:219], v[124:127], v[96:99], v[216:219]
ds_read_b128 v[60:63], v2 offset:57344
v_mfma_f32_16x16x32_bf16 v[144:147], v[116:119], v[96:99], v[144:147]
ds_read_b128 v[64:67], v2 offset:59392
v_mfma_f32_16x16x32_bf16 v[148:151], v[116:119], v[100:103], v[148:151]
v_mfma_f32_16x16x32_bf16 v[220:223], v[124:127], v[100:103], v[220:223]
v_mfma_f32_16x16x32_bf16 v[184:187], v[120:123], v[100:103], v[184:187]
v_mfma_f32_16x16x32_bf16 v[188:191], v[120:123], v[104:107], v[188:191]
v_mfma_f32_16x16x32_bf16 v[224:227], v[124:127], v[104:107], v[224:227]
v_mfma_f32_16x16x32_bf16 v[152:155], v[116:119], v[104:107], v[152:155]
v_mfma_f32_16x16x32_bf16 v[156:159], v[116:119], v[108:111], v[156:159]
v_mfma_f32_16x16x32_bf16 v[228:231], v[124:127], v[108:111], v[228:231]
v_mfma_f32_16x16x32_bf16 v[192:195], v[120:123], v[108:111], v[192:195]
v_mfma_f32_16x16x32_bf16 v[196:199], v[120:123], v[112:115], v[196:199]
v_mfma_f32_16x16x32_bf16 v[232:235], v[124:127], v[112:115], v[232:235]
v_mfma_f32_16x16x32_bf16 v[160:163], v[116:119], v[112:115], v[160:163]
s_waitcnt lgkmcnt(0)
v_mfma_f32_16x16x32_bf16 v[164:167], v[72:75], v[32:35], v[164:167]
ds_read_b128 v[80:83], v3 offset:43008
v_mfma_f32_16x16x32_bf16 v[200:203], v[76:79], v[32:35], v[200:203]
ds_read_b64_tr_b16 v[120:121], v7 offset:12288
v_mfma_f32_16x16x32_bf16 v[128:131], v[68:71], v[32:35], v[128:131]
ds_read_b64_tr_b16 v[122:123], v7 offset:12800
v_mfma_f32_16x16x32_bf16 v[132:135], v[68:71], v[36:39], v[132:135]
ds_read_b64_tr_b16 v[124:125], v7 offset:20480
v_mfma_f32_16x16x32_bf16 v[204:207], v[76:79], v[36:39], v[204:207]
ds_read_b64_tr_b16 v[126:127], v7 offset:20992
v_mfma_f32_16x16x32_bf16 v[168:171], v[72:75], v[36:39], v[168:171]
ds_read_b64_tr_b16 v[116:117], v7 offset:4096
v_mfma_f32_16x16x32_bf16 v[172:175], v[72:75], v[40:43], v[172:175]
ds_read_b64_tr_b16 v[118:119], v7 offset:4608
v_mfma_f32_16x16x32_bf16 v[208:211], v[76:79], v[40:43], v[208:211]
ds_read_b128 v[84:87], v3 offset:45056
v_mfma_f32_16x16x32_bf16 v[136:139], v[68:71], v[40:43], v[136:139]
ds_read_b128 v[88:91], v3 offset:47104
v_mfma_f32_16x16x32_bf16 v[140:143], v[68:71], v[44:47], v[140:143]
ds_read_b128 v[92:95], v3 offset:49152
v_mfma_f32_16x16x32_bf16 v[212:215], v[76:79], v[44:47], v[212:215]
ds_read_b128 v[96:99], v3 offset:51200
v_mfma_f32_16x16x32_bf16 v[176:179], v[72:75], v[44:47], v[176:179]
ds_read_b128 v[100:103], v3 offset:53248
v_mfma_f32_16x16x32_bf16 v[180:183], v[72:75], v[48:51], v[180:183]
ds_read_b128 v[104:107], v3 offset:55296
v_mfma_f32_16x16x32_bf16 v[216:219], v[76:79], v[48:51], v[216:219]
ds_read_b128 v[108:111], v3 offset:57344
v_mfma_f32_16x16x32_bf16 v[144:147], v[68:71], v[48:51], v[144:147]
ds_read_b128 v[112:115], v3 offset:59392
v_mfma_f32_16x16x32_bf16 v[148:151], v[68:71], v[52:55], v[148:151]
v_mfma_f32_16x16x32_bf16 v[220:223], v[76:79], v[52:55], v[220:223]
v_mfma_f32_16x16x32_bf16 v[184:187], v[72:75], v[52:55], v[184:187]
v_mfma_f32_16x16x32_bf16 v[188:191], v[72:75], v[56:59], v[188:191]
v_mfma_f32_16x16x32_bf16 v[224:227], v[76:79], v[56:59], v[224:227]
v_mfma_f32_16x16x32_bf16 v[152:155], v[68:71], v[56:59], v[152:155]
v_mfma_f32_16x16x32_bf16 v[156:159], v[68:71], v[60:63], v[156:159]
v_mfma_f32_16x16x32_bf16 v[228:231], v[76:79], v[60:63], v[228:231]
v_mfma_f32_16x16x32_bf16 v[192:195], v[72:75], v[60:63], v[192:195]
v_mfma_f32_16x16x32_bf16 v[196:199], v[72:75], v[64:67], v[196:199]
v_mfma_f32_16x16x32_bf16 v[232:235], v[76:79], v[64:67], v[232:235]
v_mfma_f32_16x16x32_bf16 v[160:163], v[68:71], v[64:67], v[160:163]
s_waitcnt lgkmcnt(0)
s_barrier
v_mfma_f32_16x16x32_bf16 v[164:167], v[120:123], v[80:83], v[164:167]
ds_read_b128 v[32:35], v4 offset:0
v_mfma_f32_16x16x32_bf16 v[200:203], v[124:127], v[80:83], v[200:203]
ds_read_b64_tr_b16 v[72:73], v8 offset:8192
v_mfma_f32_16x16x32_bf16 v[128:131], v[116:119], v[80:83], v[128:131]
ds_read_b64_tr_b16 v[74:75], v8 offset:8704
v_mfma_f32_16x16x32_bf16 v[132:135], v[116:119], v[84:87], v[132:135]
ds_read_b64_tr_b16 v[76:77], v8 offset:16384
v_mfma_f32_16x16x32_bf16 v[204:207], v[124:127], v[84:87], v[204:207]
ds_read_b64_tr_b16 v[78:79], v8 offset:16896
v_mfma_f32_16x16x32_bf16 v[168:171], v[120:123], v[84:87], v[168:171]
ds_read_b64_tr_b16 v[68:69], v8 offset:0
v_mfma_f32_16x16x32_bf16 v[172:175], v[120:123], v[88:91], v[172:175]
ds_read_b64_tr_b16 v[70:71], v8 offset:512
v_mfma_f32_16x16x32_bf16 v[208:211], v[124:127], v[88:91], v[208:211]
ds_read_b128 v[36:39], v4 offset:2048
v_mfma_f32_16x16x32_bf16 v[136:139], v[116:119], v[88:91], v[136:139]
ds_read_b128 v[40:43], v4 offset:4096
v_mfma_f32_16x16x32_bf16 v[140:143], v[116:119], v[92:95], v[140:143]
ds_read_b128 v[44:47], v4 offset:6144
v_mfma_f32_16x16x32_bf16 v[212:215], v[124:127], v[92:95], v[212:215]
ds_read_b128 v[48:51], v4 offset:8192
v_mfma_f32_16x16x32_bf16 v[176:179], v[120:123], v[92:95], v[176:179]
ds_read_b128 v[52:55], v4 offset:10240
v_mfma_f32_16x16x32_bf16 v[180:183], v[120:123], v[96:99], v[180:183]
ds_read_b128 v[56:59], v4 offset:12288
v_mfma_f32_16x16x32_bf16 v[216:219], v[124:127], v[96:99], v[216:219]
ds_read_b128 v[60:63], v4 offset:14336
v_mfma_f32_16x16x32_bf16 v[144:147], v[116:119], v[96:99], v[144:147]
ds_read_b128 v[64:67], v4 offset:16384
v_mfma_f32_16x16x32_bf16 v[148:151], v[116:119], v[100:103], v[148:151]
v_mfma_f32_16x16x32_bf16 v[220:223], v[124:127], v[100:103], v[220:223]
v_mfma_f32_16x16x32_bf16 v[184:187], v[120:123], v[100:103], v[184:187]
v_mfma_f32_16x16x32_bf16 v[188:191], v[120:123], v[104:107], v[188:191]
v_mfma_f32_16x16x32_bf16 v[224:227], v[124:127], v[104:107], v[224:227]
v_mfma_f32_16x16x32_bf16 v[152:155], v[116:119], v[104:107], v[152:155]
v_mfma_f32_16x16x32_bf16 v[156:159], v[116:119], v[108:111], v[156:159]
v_mfma_f32_16x16x32_bf16 v[228:231], v[124:127], v[108:111], v[228:231]
v_mfma_f32_16x16x32_bf16 v[192:195], v[120:123], v[108:111], v[192:195]
v_mfma_f32_16x16x32_bf16 v[196:199], v[120:123], v[112:115], v[196:199]
v_mfma_f32_16x16x32_bf16 v[232:235], v[124:127], v[112:115], v[232:235]
v_mfma_f32_16x16x32_bf16 v[160:163], v[116:119], v[112:115], v[160:163]
s_waitcnt lgkmcnt(0)
v_mfma_f32_16x16x32_bf16 v[164:167], v[72:75], v[32:35], v[164:167]
ds_read_b128 v[80:83], v5 offset:0
v_mfma_f32_16x16x32_bf16 v[200:203], v[76:79], v[32:35], v[200:203]
ds_read_b64_tr_b16 v[120:121], v8 offset:12288
v_mfma_f32_16x16x32_bf16 v[128:131], v[68:71], v[32:35], v[128:131]
ds_read_b64_tr_b16 v[122:123], v8 offset:12800
v_mfma_f32_16x16x32_bf16 v[132:135], v[68:71], v[36:39], v[132:135]
ds_read_b64_tr_b16 v[124:125], v8 offset:20480
v_mfma_f32_16x16x32_bf16 v[204:207], v[76:79], v[36:39], v[204:207]
ds_read_b64_tr_b16 v[126:127], v8 offset:20992
v_mfma_f32_16x16x32_bf16 v[168:171], v[72:75], v[36:39], v[168:171]
ds_read_b64_tr_b16 v[116:117], v8 offset:4096
v_mfma_f32_16x16x32_bf16 v[172:175], v[72:75], v[40:43], v[172:175]
ds_read_b64_tr_b16 v[118:119], v8 offset:4608
v_mfma_f32_16x16x32_bf16 v[208:211], v[76:79], v[40:43], v[208:211]
ds_read_b128 v[84:87], v5 offset:2048
v_mfma_f32_16x16x32_bf16 v[136:139], v[68:71], v[40:43], v[136:139]
ds_read_b128 v[88:91], v5 offset:4096
v_mfma_f32_16x16x32_bf16 v[140:143], v[68:71], v[44:47], v[140:143]
ds_read_b128 v[92:95], v5 offset:6144
v_mfma_f32_16x16x32_bf16 v[212:215], v[76:79], v[44:47], v[212:215]
ds_read_b128 v[96:99], v5 offset:8192
v_mfma_f32_16x16x32_bf16 v[176:179], v[72:75], v[44:47], v[176:179]
ds_read_b128 v[100:103], v5 offset:10240
v_mfma_f32_16x16x32_bf16 v[180:183], v[72:75], v[48:51], v[180:183]
ds_read_b128 v[104:107], v5 offset:12288
v_mfma_f32_16x16x32_bf16 v[216:219], v[76:79], v[48:51], v[216:219]
ds_read_b128 v[108:111], v5 offset:14336
v_mfma_f32_16x16x32_bf16 v[144:147], v[68:71], v[48:51], v[144:147]
ds_read_b128 v[112:115], v5 offset:16384
v_mfma_f32_16x16x32_bf16 v[148:151], v[68:71], v[52:55], v[148:151]
v_mfma_f32_16x16x32_bf16 v[220:223], v[76:79], v[52:55], v[220:223]
v_mfma_f32_16x16x32_bf16 v[184:187], v[72:75], v[52:55], v[184:187]
v_mfma_f32_16x16x32_bf16 v[188:191], v[72:75], v[56:59], v[188:191]
v_mfma_f32_16x16x32_bf16 v[224:227], v[76:79], v[56:59], v[224:227]
v_mfma_f32_16x16x32_bf16 v[152:155], v[68:71], v[56:59], v[152:155]
v_mfma_f32_16x16x32_bf16 v[156:159], v[68:71], v[60:63], v[156:159]
v_mfma_f32_16x16x32_bf16 v[228:231], v[76:79], v[60:63], v[228:231]
v_mfma_f32_16x16x32_bf16 v[192:195], v[72:75], v[60:63], v[192:195]
v_mfma_f32_16x16x32_bf16 v[196:199], v[72:75], v[64:67], v[196:199]
v_mfma_f32_16x16x32_bf16 v[232:235], v[76:79], v[64:67], v[232:235]
v_mfma_f32_16x16x32_bf16 v[160:163], v[68:71], v[64:67], v[160:163]
s_waitcnt lgkmcnt(0)
s_barrier
v_mfma_f32_16x16x32_bf16 v[164:167], v[120:123], v[80:83], v[164:167]
ds_read_b128 v[32:35], v2 offset:0
v_mfma_f32_16x16x32_bf16 v[200:203], v[124:127], v[80:83], v[200:203]
ds_read_b64_tr_b16 v[72:73], v6 offset:8192
v_mfma_f32_16x16x32_bf16 v[128:131], v[116:119], v[80:83], v[128:131]
ds_read_b64_tr_b16 v[74:75], v6 offset:8704
v_mfma_f32_16x16x32_bf16 v[132:135], v[116:119], v[84:87], v[132:135]
ds_read_b64_tr_b16 v[76:77], v6 offset:16384
v_mfma_f32_16x16x32_bf16 v[204:207], v[124:127], v[84:87], v[204:207]
ds_read_b64_tr_b16 v[78:79], v6 offset:16896
v_mfma_f32_16x16x32_bf16 v[168:171], v[120:123], v[84:87], v[168:171]
ds_read_b64_tr_b16 v[68:69], v6 offset:0
v_mfma_f32_16x16x32_bf16 v[172:175], v[120:123], v[88:91], v[172:175]
ds_read_b64_tr_b16 v[70:71], v6 offset:512
v_mfma_f32_16x16x32_bf16 v[208:211], v[124:127], v[88:91], v[208:211]
ds_read_b128 v[36:39], v2 offset:2048
v_mfma_f32_16x16x32_bf16 v[136:139], v[116:119], v[88:91], v[136:139]
ds_read_b128 v[40:43], v2 offset:4096
v_mfma_f32_16x16x32_bf16 v[140:143], v[116:119], v[92:95], v[140:143]
ds_read_b128 v[44:47], v2 offset:6144
v_mfma_f32_16x16x32_bf16 v[212:215], v[124:127], v[92:95], v[212:215]
ds_read_b128 v[48:51], v2 offset:8192
v_mfma_f32_16x16x32_bf16 v[176:179], v[120:123], v[92:95], v[176:179]
ds_read_b128 v[52:55], v2 offset:10240
v_mfma_f32_16x16x32_bf16 v[180:183], v[120:123], v[96:99], v[180:183]
ds_read_b128 v[56:59], v2 offset:12288
v_mfma_f32_16x16x32_bf16 v[216:219], v[124:127], v[96:99], v[216:219]
ds_read_b128 v[60:63], v2 offset:14336
v_mfma_f32_16x16x32_bf16 v[144:147], v[116:119], v[96:99], v[144:147]
ds_read_b128 v[64:67], v2 offset:16384
v_mfma_f32_16x16x32_bf16 v[148:151], v[116:119], v[100:103], v[148:151]
v_mfma_f32_16x16x32_bf16 v[220:223], v[124:127], v[100:103], v[220:223]
v_mfma_f32_16x16x32_bf16 v[184:187], v[120:123], v[100:103], v[184:187]
v_mfma_f32_16x16x32_bf16 v[188:191], v[120:123], v[104:107], v[188:191]
v_mfma_f32_16x16x32_bf16 v[224:227], v[124:127], v[104:107], v[224:227]
v_mfma_f32_16x16x32_bf16 v[152:155], v[116:119], v[104:107], v[152:155]
v_mfma_f32_16x16x32_bf16 v[156:159], v[116:119], v[108:111], v[156:159]
v_mfma_f32_16x16x32_bf16 v[228:231], v[124:127], v[108:111], v[228:231]
v_mfma_f32_16x16x32_bf16 v[192:195], v[120:123], v[108:111], v[192:195]
v_mfma_f32_16x16x32_bf16 v[196:199], v[120:123], v[112:115], v[196:199]
v_mfma_f32_16x16x32_bf16 v[232:235], v[124:127], v[112:115], v[232:235]
v_mfma_f32_16x16x32_bf16 v[160:163], v[116:119], v[112:115], v[160:163]
s_mov_b32 s41, 4
Lcl_19:
s_waitcnt lgkmcnt(0)
v_mfma_f32_16x16x32_bf16 v[164:167], v[72:75], v[32:35], v[164:167]
ds_read_b128 v[80:83], v3 offset:0
v_mfma_f32_16x16x32_bf16 v[200:203], v[76:79], v[32:35], v[200:203]
ds_read_b64_tr_b16 v[120:121], v6 offset:12288
v_mfma_f32_16x16x32_bf16 v[128:131], v[68:71], v[32:35], v[128:131]
ds_read_b64_tr_b16 v[122:123], v6 offset:12800
v_mfma_f32_16x16x32_bf16 v[132:135], v[68:71], v[36:39], v[132:135]
ds_read_b64_tr_b16 v[124:125], v6 offset:20480
v_mfma_f32_16x16x32_bf16 v[204:207], v[76:79], v[36:39], v[204:207]
ds_read_b64_tr_b16 v[126:127], v6 offset:20992
v_mfma_f32_16x16x32_bf16 v[168:171], v[72:75], v[36:39], v[168:171]
ds_read_b64_tr_b16 v[116:117], v6 offset:4096
v_mfma_f32_16x16x32_bf16 v[172:175], v[72:75], v[40:43], v[172:175]
ds_read_b64_tr_b16 v[118:119], v6 offset:4608
v_mfma_f32_16x16x32_bf16 v[208:211], v[76:79], v[40:43], v[208:211]
ds_read_b128 v[84:87], v3 offset:2048
v_mfma_f32_16x16x32_bf16 v[136:139], v[68:71], v[40:43], v[136:139]
ds_read_b128 v[88:91], v3 offset:4096
v_mfma_f32_16x16x32_bf16 v[140:143], v[68:71], v[44:47], v[140:143]
ds_read_b128 v[92:95], v3 offset:6144
v_mfma_f32_16x16x32_bf16 v[212:215], v[76:79], v[44:47], v[212:215]
ds_read_b128 v[96:99], v3 offset:8192
v_mfma_f32_16x16x32_bf16 v[176:179], v[72:75], v[44:47], v[176:179]
ds_read_b128 v[100:103], v3 offset:10240
v_mfma_f32_16x16x32_bf16 v[180:183], v[72:75], v[48:51], v[180:183]
ds_read_b128 v[104:107], v3 offset:12288
v_mfma_f32_16x16x32_bf16 v[216:219], v[76:79], v[48:51], v[216:219]
ds_read_b128 v[108:111], v3 offset:14336
v_mfma_f32_16x16x32_bf16 v[144:147], v[68:71], v[48:51], v[144:147]
ds_read_b128 v[112:115], v3 offset:16384
v_mfma_f32_16x16x32_bf16 v[148:151], v[68:71], v[52:55], v[148:151]
v_mfma_f32_16x16x32_bf16 v[220:223], v[76:79], v[52:55], v[220:223]
v_mfma_f32_16x16x32_bf16 v[184:187], v[72:75], v[52:55], v[184:187]
v_mfma_f32_16x16x32_bf16 v[188:191], v[72:75], v[56:59], v[188:191]
v_mfma_f32_16x16x32_bf16 v[224:227], v[76:79], v[56:59], v[224:227]
v_mfma_f32_16x16x32_bf16 v[152:155], v[68:71], v[56:59], v[152:155]
v_mfma_f32_16x16x32_bf16 v[156:159], v[68:71], v[60:63], v[156:159]
v_mfma_f32_16x16x32_bf16 v[228:231], v[76:79], v[60:63], v[228:231]
v_mfma_f32_16x16x32_bf16 v[192:195], v[72:75], v[60:63], v[192:195]
v_mfma_f32_16x16x32_bf16 v[196:199], v[72:75], v[64:67], v[196:199]
v_mfma_f32_16x16x32_bf16 v[232:235], v[76:79], v[64:67], v[232:235]
v_mfma_f32_16x16x32_bf16 v[160:163], v[68:71], v[64:67], v[160:163]
s_waitcnt lgkmcnt(0)
s_barrier
v_mfma_f32_16x16x32_bf16 v[164:167], v[120:123], v[80:83], v[164:167]
s_branch Lov_2
.p2align 12
Lst_2_0:
s_branch Lwr_169
s_nop 0
s_nop 0
Lov_2:
ds_read_b128 v[32:35], v2 offset:43008
v_mfma_f32_16x16x32_bf16 v[200:203], v[124:127], v[80:83], v[200:203]
ds_read_b64_tr_b16 v[72:73], v7 offset:8192
v_mfma_f32_16x16x32_bf16 v[128:131], v[116:119], v[80:83], v[128:131]
ds_read_b64_tr_b16 v[74:75], v7 offset:8704
v_mfma_f32_16x16x32_bf16 v[132:135], v[116:119], v[84:87], v[132:135]
ds_read_b64_tr_b16 v[76:77], v7 offset:16384
v_mfma_f32_16x16x32_bf16 v[204:207], v[124:127], v[84:87], v[204:207]
ds_read_b64_tr_b16 v[78:79], v7 offset:16896
v_mfma_f32_16x16x32_bf16 v[168:171], v[120:123], v[84:87], v[168:171]
ds_read_b64_tr_b16 v[68:69], v7 offset:0
v_mfma_f32_16x16x32_bf16 v[172:175], v[120:123], v[88:91], v[172:175]
ds_read_b64_tr_b16 v[70:71], v7 offset:512
v_mfma_f32_16x16x32_bf16 v[208:211], v[124:127], v[88:91], v[208:211]
ds_read_b128 v[36:39], v2 offset:45056
v_mfma_f32_16x16x32_bf16 v[136:139], v[116:119], v[88:91], v[136:139]
ds_read_b128 v[40:43], v2 offset:47104
v_mfma_f32_16x16x32_bf16 v[140:143], v[116:119], v[92:95], v[140:143]
ds_read_b128 v[44:47], v2 offset:49152
v_mfma_f32_16x16x32_bf16 v[212:215], v[124:127], v[92:95], v[212:215]
ds_read_b128 v[48:51], v2 offset:51200
v_mfma_f32_16x16x32_bf16 v[176:179], v[120:123], v[92:95], v[176:179]
ds_read_b128 v[52:55], v2 offset:53248
v_mfma_f32_16x16x32_bf16 v[180:183], v[120:123], v[96:99], v[180:183]
ds_read_b128 v[56:59], v2 offset:55296
v_mfma_f32_16x16x32_bf16 v[216:219], v[124:127], v[96:99], v[216:219]
ds_read_b128 v[60:63], v2 offset:57344
v_mfma_f32_16x16x32_bf16 v[144:147], v[116:119], v[96:99], v[144:147]
ds_read_b128 v[64:67], v2 offset:59392
v_mfma_f32_16x16x32_bf16 v[148:151], v[116:119], v[100:103], v[148:151]
v_mfma_f32_16x16x32_bf16 v[220:223], v[124:127], v[100:103], v[220:223]
v_mfma_f32_16x16x32_bf16 v[184:187], v[120:123], v[100:103], v[184:187]
v_mfma_f32_16x16x32_bf16 v[188:191], v[120:123], v[104:107], v[188:191]
v_mfma_f32_16x16x32_bf16 v[224:227], v[124:127], v[104:107], v[224:227]
v_mfma_f32_16x16x32_bf16 v[152:155], v[116:119], v[104:107], v[152:155]
v_mfma_f32_16x16x32_bf16 v[156:159], v[116:119], v[108:111], v[156:159]
v_mfma_f32_16x16x32_bf16 v[228:231], v[124:127], v[108:111], v[228:231]
v_mfma_f32_16x16x32_bf16 v[192:195], v[120:123], v[108:111], v[192:195]
v_mfma_f32_16x16x32_bf16 v[196:199], v[120:123], v[112:115], v[196:199]
v_mfma_f32_16x16x32_bf16 v[232:235], v[124:127], v[112:115], v[232:235]
v_mfma_f32_16x16x32_bf16 v[160:163], v[116:119], v[112:115], v[160:163]
s_waitcnt lgkmcnt(0)
v_mfma_f32_16x16x32_bf16 v[164:167], v[72:75], v[32:35], v[164:167]
ds_read_b128 v[80:83], v3 offset:43008
v_mfma_f32_16x16x32_bf16 v[200:203], v[76:79], v[32:35], v[200:203]
ds_read_b64_tr_b16 v[120:121], v7 offset:12288
v_mfma_f32_16x16x32_bf16 v[128:131], v[68:71], v[32:35], v[128:131]
ds_read_b64_tr_b16 v[122:123], v7 offset:12800
v_mfma_f32_16x16x32_bf16 v[132:135], v[68:71], v[36:39], v[132:135]
ds_read_b64_tr_b16 v[124:125], v7 offset:20480
v_mfma_f32_16x16x32_bf16 v[204:207], v[76:79], v[36:39], v[204:207]
ds_read_b64_tr_b16 v[126:127], v7 offset:20992
v_mfma_f32_16x16x32_bf16 v[168:171], v[72:75], v[36:39], v[168:171]
ds_read_b64_tr_b16 v[116:117], v7 offset:4096
v_mfma_f32_16x16x32_bf16 v[172:175], v[72:75], v[40:43], v[172:175]
ds_read_b64_tr_b16 v[118:119], v7 offset:4608
v_mfma_f32_16x16x32_bf16 v[208:211], v[76:79], v[40:43], v[208:211]
ds_read_b128 v[84:87], v3 offset:45056
v_mfma_f32_16x16x32_bf16 v[136:139], v[68:71], v[40:43], v[136:139]
ds_read_b128 v[88:91], v3 offset:47104
v_mfma_f32_16x16x32_bf16 v[140:143], v[68:71], v[44:47], v[140:143]
ds_read_b128 v[92:95], v3 offset:49152
v_mfma_f32_16x16x32_bf16 v[212:215], v[76:79], v[44:47], v[212:215]
ds_read_b128 v[96:99], v3 offset:51200
v_mfma_f32_16x16x32_bf16 v[176:179], v[72:75], v[44:47], v[176:179]
ds_read_b128 v[100:103], v3 offset:53248
v_mfma_f32_16x16x32_bf16 v[180:183], v[72:75], v[48:51], v[180:183]
ds_read_b128 v[104:107], v3 offset:55296
v_mfma_f32_16x16x32_bf16 v[216:219], v[76:79], v[48:51], v[216:219]
ds_read_b128 v[108:111], v3 offset:57344
v_mfma_f32_16x16x32_bf16 v[144:147], v[68:71], v[48:51], v[144:147]
ds_read_b128 v[112:115], v3 offset:59392
v_mfma_f32_16x16x32_bf16 v[148:151], v[68:71], v[52:55], v[148:151]
v_mfma_f32_16x16x32_bf16 v[220:223], v[76:79], v[52:55], v[220:223]
v_mfma_f32_16x16x32_bf16 v[184:187], v[72:75], v[52:55], v[184:187]
v_mfma_f32_16x16x32_bf16 v[188:191], v[72:75], v[56:59], v[188:191]
v_mfma_f32_16x16x32_bf16 v[224:227], v[76:79], v[56:59], v[224:227]
v_mfma_f32_16x16x32_bf16 v[152:155], v[68:71], v[56:59], v[152:155]
v_mfma_f32_16x16x32_bf16 v[156:159], v[68:71], v[60:63], v[156:159]
v_mfma_f32_16x16x32_bf16 v[228:231], v[76:79], v[60:63], v[228:231]
v_mfma_f32_16x16x32_bf16 v[192:195], v[72:75], v[60:63], v[192:195]
v_mfma_f32_16x16x32_bf16 v[196:199], v[72:75], v[64:67], v[196:199]
v_mfma_f32_16x16x32_bf16 v[232:235], v[76:79], v[64:67], v[232:235]
v_mfma_f32_16x16x32_bf16 v[160:163], v[68:71], v[64:67], v[160:163]
s_waitcnt lgkmcnt(0)
s_barrier
v_mfma_f32_16x16x32_bf16 v[164:167], v[120:123], v[80:83], v[164:167]
ds_read_b128 v[32:35], v4 offset:0
v_mfma_f32_16x16x32_bf16 v[200:203], v[124:127], v[80:83], v[200:203]
ds_read_b64_tr_b16 v[72:73], v8 offset:8192
v_mfma_f32_16x16x32_bf16 v[128:131], v[116:119], v[80:83], v[128:131]
ds_read_b64_tr_b16 v[74:75], v8 offset:8704
v_mfma_f32_16x16x32_bf16 v[132:135], v[116:119], v[84:87], v[132:135]
ds_read_b64_tr_b16 v[76:77], v8 offset:16384
v_mfma_f32_16x16x32_bf16 v[204:207], v[124:127], v[84:87], v[204:207]
ds_read_b64_tr_b16 v[78:79], v8 offset:16896
v_mfma_f32_16x16x32_bf16 v[168:171], v[120:123], v[84:87], v[168:171]
ds_read_b64_tr_b16 v[68:69], v8 offset:0
v_mfma_f32_16x16x32_bf16 v[172:175], v[120:123], v[88:91], v[172:175]
ds_read_b64_tr_b16 v[70:71], v8 offset:512
v_mfma_f32_16x16x32_bf16 v[208:211], v[124:127], v[88:91], v[208:211]
ds_read_b128 v[36:39], v4 offset:2048
v_mfma_f32_16x16x32_bf16 v[136:139], v[116:119], v[88:91], v[136:139]
ds_read_b128 v[40:43], v4 offset:4096
v_mfma_f32_16x16x32_bf16 v[140:143], v[116:119], v[92:95], v[140:143]
ds_read_b128 v[44:47], v4 offset:6144
v_mfma_f32_16x16x32_bf16 v[212:215], v[124:127], v[92:95], v[212:215]
ds_read_b128 v[48:51], v4 offset:8192
v_mfma_f32_16x16x32_bf16 v[176:179], v[120:123], v[92:95], v[176:179]
ds_read_b128 v[52:55], v4 offset:10240
v_mfma_f32_16x16x32_bf16 v[180:183], v[120:123], v[96:99], v[180:183]
ds_read_b128 v[56:59], v4 offset:12288
v_mfma_f32_16x16x32_bf16 v[216:219], v[124:127], v[96:99], v[216:219]
ds_read_b128 v[60:63], v4 offset:14336
v_mfma_f32_16x16x32_bf16 v[144:147], v[116:119], v[96:99], v[144:147]
ds_read_b128 v[64:67], v4 offset:16384
v_mfma_f32_16x16x32_bf16 v[148:151], v[116:119], v[100:103], v[148:151]
v_mfma_f32_16x16x32_bf16 v[220:223], v[124:127], v[100:103], v[220:223]
v_mfma_f32_16x16x32_bf16 v[184:187], v[120:123], v[100:103], v[184:187]
v_mfma_f32_16x16x32_bf16 v[188:191], v[120:123], v[104:107], v[188:191]
v_mfma_f32_16x16x32_bf16 v[224:227], v[124:127], v[104:107], v[224:227]
v_mfma_f32_16x16x32_bf16 v[152:155], v[116:119], v[104:107], v[152:155]
v_mfma_f32_16x16x32_bf16 v[156:159], v[116:119], v[108:111], v[156:159]
v_mfma_f32_16x16x32_bf16 v[228:231], v[124:127], v[108:111], v[228:231]
v_mfma_f32_16x16x32_bf16 v[192:195], v[120:123], v[108:111], v[192:195]
v_mfma_f32_16x16x32_bf16 v[196:199], v[120:123], v[112:115], v[196:199]
v_mfma_f32_16x16x32_bf16 v[232:235], v[124:127], v[112:115], v[232:235]
v_mfma_f32_16x16x32_bf16 v[160:163], v[116:119], v[112:115], v[160:163]
s_waitcnt lgkmcnt(0)
v_mfma_f32_16x16x32_bf16 v[164:167], v[72:75], v[32:35], v[164:167]
ds_read_b128 v[80:83], v5 offset:0
v_mfma_f32_16x16x32_bf16 v[200:203], v[76:79], v[32:35], v[200:203]
ds_read_b64_tr_b16 v[120:121], v8 offset:12288
v_mfma_f32_16x16x32_bf16 v[128:131], v[68:71], v[32:35], v[128:131]
ds_read_b64_tr_b16 v[122:123], v8 offset:12800
v_mfma_f32_16x16x32_bf16 v[132:135], v[68:71], v[36:39], v[132:135]
ds_read_b64_tr_b16 v[124:125], v8 offset:20480
v_mfma_f32_16x16x32_bf16 v[204:207], v[76:79], v[36:39], v[204:207]
ds_read_b64_tr_b16 v[126:127], v8 offset:20992
v_mfma_f32_16x16x32_bf16 v[168:171], v[72:75], v[36:39], v[168:171]
ds_read_b64_tr_b16 v[116:117], v8 offset:4096
v_mfma_f32_16x16x32_bf16 v[172:175], v[72:75], v[40:43], v[172:175]
ds_read_b64_tr_b16 v[118:119], v8 offset:4608
v_mfma_f32_16x16x32_bf16 v[208:211], v[76:79], v[40:43], v[208:211]
ds_read_b128 v[84:87], v5 offset:2048
v_mfma_f32_16x16x32_bf16 v[136:139], v[68:71], v[40:43], v[136:139]
ds_read_b128 v[88:91], v5 offset:4096
v_mfma_f32_16x16x32_bf16 v[140:143], v[68:71], v[44:47], v[140:143]
ds_read_b128 v[92:95], v5 offset:6144
v_mfma_f32_16x16x32_bf16 v[212:215], v[76:79], v[44:47], v[212:215]
ds_read_b128 v[96:99], v5 offset:8192
v_mfma_f32_16x16x32_bf16 v[176:179], v[72:75], v[44:47], v[176:179]
ds_read_b128 v[100:103], v5 offset:10240
v_mfma_f32_16x16x32_bf16 v[180:183], v[72:75], v[48:51], v[180:183]
ds_read_b128 v[104:107], v5 offset:12288
v_mfma_f32_16x16x32_bf16 v[216:219], v[76:79], v[48:51], v[216:219]
ds_read_b128 v[108:111], v5 offset:14336
v_mfma_f32_16x16x32_bf16 v[144:147], v[68:71], v[48:51], v[144:147]
ds_read_b128 v[112:115], v5 offset:16384
v_mfma_f32_16x16x32_bf16 v[148:151], v[68:71], v[52:55], v[148:151]
v_mfma_f32_16x16x32_bf16 v[220:223], v[76:79], v[52:55], v[220:223]
v_mfma_f32_16x16x32_bf16 v[184:187], v[72:75], v[52:55], v[184:187]
v_mfma_f32_16x16x32_bf16 v[188:191], v[72:75], v[56:59], v[188:191]
v_mfma_f32_16x16x32_bf16 v[224:227], v[76:79], v[56:59], v[224:227]
v_mfma_f32_16x16x32_bf16 v[152:155], v[68:71], v[56:59], v[152:155]
v_mfma_f32_16x16x32_bf16 v[156:159], v[68:71], v[60:63], v[156:159]
v_mfma_f32_16x16x32_bf16 v[228:231], v[76:79], v[60:63], v[228:231]
v_mfma_f32_16x16x32_bf16 v[192:195], v[72:75], v[60:63], v[192:195]
v_mfma_f32_16x16x32_bf16 v[196:199], v[72:75], v[64:67], v[196:199]
v_mfma_f32_16x16x32_bf16 v[232:235], v[76:79], v[64:67], v[232:235]
v_mfma_f32_16x16x32_bf16 v[160:163], v[68:71], v[64:67], v[160:163]
s_waitcnt lgkmcnt(0)
s_barrier
v_mfma_f32_16x16x32_bf16 v[164:167], v[120:123], v[80:83], v[164:167]
ds_read_b128 v[32:35], v2 offset:0
v_mfma_f32_16x16x32_bf16 v[200:203], v[124:127], v[80:83], v[200:203]
ds_read_b64_tr_b16 v[72:73], v6 offset:8192
v_mfma_f32_16x16x32_bf16 v[128:131], v[116:119], v[80:83], v[128:131]
ds_read_b64_tr_b16 v[74:75], v6 offset:8704
v_mfma_f32_16x16x32_bf16 v[132:135], v[116:119], v[84:87], v[132:135]
ds_read_b64_tr_b16 v[76:77], v6 offset:16384
v_mfma_f32_16x16x32_bf16 v[204:207], v[124:127], v[84:87], v[204:207]
ds_read_b64_tr_b16 v[78:79], v6 offset:16896
v_mfma_f32_16x16x32_bf16 v[168:171], v[120:123], v[84:87], v[168:171]
ds_read_b64_tr_b16 v[68:69], v6 offset:0
v_mfma_f32_16x16x32_bf16 v[172:175], v[120:123], v[88:91], v[172:175]
ds_read_b64_tr_b16 v[70:71], v6 offset:512
v_mfma_f32_16x16x32_bf16 v[208:211], v[124:127], v[88:91], v[208:211]
ds_read_b128 v[36:39], v2 offset:2048
v_mfma_f32_16x16x32_bf16 v[136:139], v[116:119], v[88:91], v[136:139]
ds_read_b128 v[40:43], v2 offset:4096
v_mfma_f32_16x16x32_bf16 v[140:143], v[116:119], v[92:95], v[140:143]
ds_read_b128 v[44:47], v2 offset:6144
v_mfma_f32_16x16x32_bf16 v[212:215], v[124:127], v[92:95], v[212:215]
ds_read_b128 v[48:51], v2 offset:8192
v_mfma_f32_16x16x32_bf16 v[176:179], v[120:123], v[92:95], v[176:179]
ds_read_b128 v[52:55], v2 offset:10240
v_mfma_f32_16x16x32_bf16 v[180:183], v[120:123], v[96:99], v[180:183]
ds_read_b128 v[56:59], v2 offset:12288
v_mfma_f32_16x16x32_bf16 v[216:219], v[124:127], v[96:99], v[216:219]
ds_read_b128 v[60:63], v2 offset:14336
v_mfma_f32_16x16x32_bf16 v[144:147], v[116:119], v[96:99], v[144:147]
ds_read_b128 v[64:67], v2 offset:16384
v_mfma_f32_16x16x32_bf16 v[148:151], v[116:119], v[100:103], v[148:151]
v_mfma_f32_16x16x32_bf16 v[220:223], v[124:127], v[100:103], v[220:223]
v_mfma_f32_16x16x32_bf16 v[184:187], v[120:123], v[100:103], v[184:187]
v_mfma_f32_16x16x32_bf16 v[188:191], v[120:123], v[104:107], v[188:191]
v_mfma_f32_16x16x32_bf16 v[224:227], v[124:127], v[104:107], v[224:227]
v_mfma_f32_16x16x32_bf16 v[152:155], v[116:119], v[104:107], v[152:155]
v_mfma_f32_16x16x32_bf16 v[156:159], v[116:119], v[108:111], v[156:159]
v_mfma_f32_16x16x32_bf16 v[228:231], v[124:127], v[108:111], v[228:231]
v_mfma_f32_16x16x32_bf16 v[192:195], v[120:123], v[108:111], v[192:195]
v_mfma_f32_16x16x32_bf16 v[196:199], v[120:123], v[112:115], v[196:199]
v_mfma_f32_16x16x32_bf16 v[232:235], v[124:127], v[112:115], v[232:235]
v_mfma_f32_16x16x32_bf16 v[160:163], v[116:119], v[112:115], v[160:163]
s_sub_u32 s41, s41, 1
s_cmp_lg_u32 s41, 0
s_cbranch_scc1 Lcl_19
s_waitcnt lgkmcnt(0)
v_mfma_f32_16x16x32_bf16 v[164:167], v[72:75], v[32:35], v[164:167]
ds_read_b128 v[80:83], v3 offset:0
v_mfma_f32_16x16x32_bf16 v[200:203], v[76:79], v[32:35], v[200:203]
ds_read_b64_tr_b16 v[120:121], v6 offset:12288
v_mfma_f32_16x16x32_bf16 v[128:131], v[68:71], v[32:35], v[128:131]
ds_read_b64_tr_b16 v[122:123], v6 offset:12800
v_mfma_f32_16x16x32_bf16 v[132:135], v[68:71], v[36:39], v[132:135]
ds_read_b64_tr_b16 v[124:125], v6 offset:20480
v_mfma_f32_16x16x32_bf16 v[204:207], v[76:79], v[36:39], v[204:207]
ds_read_b64_tr_b16 v[126:127], v6 offset:20992
v_mfma_f32_16x16x32_bf16 v[168:171], v[72:75], v[36:39], v[168:171]
ds_read_b64_tr_b16 v[116:117], v6 offset:4096
v_mfma_f32_16x16x32_bf16 v[172:175], v[72:75], v[40:43], v[172:175]
ds_read_b64_tr_b16 v[118:119], v6 offset:4608
v_mfma_f32_16x16x32_bf16 v[208:211], v[76:79], v[40:43], v[208:211]
ds_read_b128 v[84:87], v3 offset:2048
v_mfma_f32_16x16x32_bf16 v[136:139], v[68:71], v[40:43], v[136:139]
ds_read_b128 v[88:91], v3 offset:4096
v_mfma_f32_16x16x32_bf16 v[140:143], v[68:71], v[44:47], v[140:143]
ds_read_b128 v[92:95], v3 offset:6144
v_mfma_f32_16x16x32_bf16 v[212:215], v[76:79], v[44:47], v[212:215]
ds_read_b128 v[96:99], v3 offset:8192
v_mfma_f32_16x16x32_bf16 v[176:179], v[72:75], v[44:47], v[176:179]
ds_read_b128 v[100:103], v3 offset:10240
v_mfma_f32_16x16x32_bf16 v[180:183], v[72:75], v[48:51], v[180:183]
ds_read_b128 v[104:107], v3 offset:12288
v_mfma_f32_16x16x32_bf16 v[216:219], v[76:79], v[48:51], v[216:219]
ds_read_b128 v[108:111], v3 offset:14336
v_mfma_f32_16x16x32_bf16 v[144:147], v[68:71], v[48:51], v[144:147]
ds_read_b128 v[112:115], v3 offset:16384
v_mfma_f32_16x16x32_bf16 v[148:151], v[68:71], v[52:55], v[148:151]
v_mfma_f32_16x16x32_bf16 v[220:223], v[76:79], v[52:55], v[220:223]
v_mfma_f32_16x16x32_bf16 v[184:187], v[72:75], v[52:55], v[184:187]
v_mfma_f32_16x16x32_bf16 v[188:191], v[72:75], v[56:59], v[188:191]
v_mfma_f32_16x16x32_bf16 v[224:227], v[76:79], v[56:59], v[224:227]
v_mfma_f32_16x16x32_bf16 v[152:155], v[68:71], v[56:59], v[152:155]
v_mfma_f32_16x16x32_bf16 v[156:159], v[68:71], v[60:63], v[156:159]
v_mfma_f32_16x16x32_bf16 v[228:231], v[76:79], v[60:63], v[228:231]
v_mfma_f32_16x16x32_bf16 v[192:195], v[72:75], v[60:63], v[192:195]
v_mfma_f32_16x16x32_bf16 v[196:199], v[72:75], v[64:67], v[196:199]
v_mfma_f32_16x16x32_bf16 v[232:235], v[76:79], v[64:67], v[232:235]
v_mfma_f32_16x16x32_bf16 v[160:163], v[68:71], v[64:67], v[160:163]
s_waitcnt lgkmcnt(0)
v_mfma_f32_16x16x32_bf16 v[164:167], v[120:123], v[80:83], v[164:167]
v_mfma_f32_16x16x32_bf16 v[200:203], v[124:127], v[80:83], v[200:203]
v_mfma_f32_16x16x32_bf16 v[128:131], v[116:119], v[80:83], v[128:131]
v_mfma_f32_16x16x32_bf16 v[132:135], v[116:119], v[84:87], v[132:135]
v_mfma_f32_16x16x32_bf16 v[204:207], v[124:127], v[84:87], v[204:207]
v_mfma_f32_16x16x32_bf16 v[168:171], v[120:123], v[84:87], v[168:171]
v_mfma_f32_16x16x32_bf16 v[172:175], v[120:123], v[88:91], v[172:175]
v_mfma_f32_16x16x32_bf16 v[208:211], v[124:127], v[88:91], v[208:211]
v_mfma_f32_16x16x32_bf16 v[136:139], v[116:119], v[88:91], v[136:139]
v_mfma_f32_16x16x32_bf16 v[140:143], v[116:119], v[92:95], v[140:143]
v_mfma_f32_16x16x32_bf16 v[212:215], v[124:127], v[92:95], v[212:215]
v_mfma_f32_16x16x32_bf16 v[176:179], v[120:123], v[92:95], v[176:179]
v_mfma_f32_16x16x32_bf16 v[180:183], v[120:123], v[96:99], v[180:183]
v_mfma_f32_16x16x32_bf16 v[216:219], v[124:127], v[96:99], v[216:219]
v_mfma_f32_16x16x32_bf16 v[144:147], v[116:119], v[96:99], v[144:147]
v_mfma_f32_16x16x32_bf16 v[148:151], v[116:119], v[100:103], v[148:151]
v_mfma_f32_16x16x32_bf16 v[220:223], v[124:127], v[100:103], v[220:223]
v_mfma_f32_16x16x32_bf16 v[184:187], v[120:123], v[100:103], v[184:187]
v_mfma_f32_16x16x32_bf16 v[188:191], v[120:123], v[104:107], v[188:191]
v_mfma_f32_16x16x32_bf16 v[224:227], v[124:127], v[104:107], v[224:227]
v_mfma_f32_16x16x32_bf16 v[152:155], v[116:119], v[104:107], v[152:155]
v_mfma_f32_16x16x32_bf16 v[156:159], v[116:119], v[108:111], v[156:159]
v_mfma_f32_16x16x32_bf16 v[228:231], v[124:127], v[108:111], v[228:231]
v_mfma_f32_16x16x32_bf16 v[192:195], v[120:123], v[108:111], v[192:195]
v_mfma_f32_16x16x32_bf16 v[196:199], v[120:123], v[112:115], v[196:199]
v_mfma_f32_16x16x32_bf16 v[232:235], v[124:127], v[112:115], v[232:235]
v_mfma_f32_16x16x32_bf16 v[160:163], v[116:119], v[112:115], v[160:163]
v_lshlrev_b32 v14, 3, v12
v_add_u32 v14, 147456, v14
v_mul_u32_u24 v15, 400, v12
v_lshl_add_u32 v15, v13, 3, v15
s_lshl_b32 s43, s36, 5
v_add_u32 v15, s43, v15
s_barrier
ds_read_b64 v[32:33], v14 offset:0
ds_read_b64 v[34:35], v14 offset:128
ds_read_b64 v[36:37], v14 offset:256
ds_read_b64 v[38:39], v14 offset:384
ds_read_b64 v[40:41], v14 offset:512
ds_read_b64 v[42:43], v14 offset:640
ds_read_b64 v[44:45], v14 offset:768
ds_read_b64 v[46:47], v14 offset:896
ds_read_b64 v[48:49], v14 offset:1024
v_mov_b32_dpp v52, v128 row_newbcast:0 row_mask:0xf bank_mask:0xf
v_mov_b32_dpp v53, v129 row_newbcast:0 row_mask:0xf bank_mask:0xf
v_mov_b32_dpp v54, v130 row_newbcast:0 row_mask:0xf bank_mask:0xf
v_mov_b32_dpp v55, v131 row_newbcast:0 row_mask:0xf bank_mask:0xf
v_mov_b32_dpp v56, v164 row_newbcast:0 row_mask:0xf bank_mask:0xf
v_mov_b32_dpp v57, v165 row_newbcast:0 row_mask:0xf bank_mask:0xf
v_mov_b32_dpp v58, v166 row_newbcast:0 row_mask:0xf bank_mask:0xf
v_mov_b32_dpp v59, v167 row_newbcast:0 row_mask:0xf bank_mask:0xf
v_mov_b32_dpp v60, v200 row_newbcast:0 row_mask:0xf bank_mask:0xf
v_mov_b32_dpp v61, v201 row_newbcast:0 row_mask:0xf bank_mask:0xf
v_mov_b32_dpp v62, v202 row_newbcast:0 row_mask:0xf bank_mask:0xf
v_mov_b32_dpp v63, v203 row_newbcast:0 row_mask:0xf bank_mask:0xf
s_waitcnt lgkmcnt(0)
v_pk_fma_f32 v[164:165], v[32:33], v[56:57], v[164:165] op_sel_hi:[0,1,1] neg_lo:[1,0,0] neg_hi:[1,0,0]
v_pk_fma_f32 v[166:167], v[32:33], v[58:59], v[166:167] op_sel_hi:[0,1,1] neg_lo:[1,0,0] neg_hi:[1,0,0]
v_pk_fma_f32 v[200:201], v[32:33], v[60:61], v[200:201] op_sel_hi:[0,1,1] neg_lo:[1,0,0] neg_hi:[1,0,0]
v_pk_fma_f32 v[202:203], v[32:33], v[62:63], v[202:203] op_sel_hi:[0,1,1] neg_lo:[1,0,0] neg_hi:[1,0,0]
v_pk_mul_f32 v[164:165], v[32:33], v[164:165] op_sel:[1,0] op_sel_hi:[1,1]
v_pk_mul_f32 v[166:167], v[32:33], v[166:167] op_sel:[1,0] op_sel_hi:[1,1]
v_pk_fma_f32 v[132:133], v[34:35], v[52:53], v[132:133] op_sel_hi:[0,1,1] neg_lo:[1,0,0] neg_hi:[1,0,0]
v_pk_fma_f32 v[134:135], v[34:35], v[54:55], v[134:135] op_sel_hi:[0,1,1] neg_lo:[1,0,0] neg_hi:[1,0,0]
v_pk_mul_f32 v[200:201], v[32:33], v[200:201] op_sel:[1,0] op_sel_hi:[1,1]
v_pk_mul_f32 v[202:203], v[32:33], v[202:203] op_sel:[1,0] op_sel_hi:[1,1]
v_cvt_pk_bf16_f32 v164, v164, v165
v_cvt_pk_bf16_f32 v165, v166, v167
ds_write_b64 v15, v[164:165] offset:128
v_pk_fma_f32 v[168:169], v[34:35], v[56:57], v[168:169] op_sel_hi:[0,1,1] neg_lo:[1,0,0] neg_hi:[1,0,0]
v_pk_fma_f32 v[170:171], v[34:35], v[58:59], v[170:171] op_sel_hi:[0,1,1] neg_lo:[1,0,0] neg_hi:[1,0,0]
v_pk_mul_f32 v[132:133], v[34:35], v[132:133] op_sel:[1,0] op_sel_hi:[1,1]
v_pk_mul_f32 v[134:135], v[34:35], v[134:135] op_sel:[1,0] op_sel_hi:[1,1]
v_cvt_pk_bf16_f32 v200, v200, v201
v_cvt_pk_bf16_f32 v201, v202, v203
ds_write_b64 v15, v[200:201] offset:256
v_pk_fma_f32 v[204:205], v[34:35], v[60:61], v[204:205] op_sel_hi:[0,1,1] neg_lo:[1,0,0] neg_hi:[1,0,0]
v_pk_fma_f32 v[206:207], v[34:35], v[62:63], v[206:207] op_sel_hi:[0,1,1] neg_lo:[1,0,0] neg_hi:[1,0,0]
v_pk_mul_f32 v[168:169], v[34:35], v[168:169] op_sel:[1,0] op_sel_hi:[1,1]
v_pk_mul_f32 v[170:171], v[34:35], v[170:171] op_sel:[1,0] op_sel_hi:[1,1]
v_cvt_pk_bf16_f32 v132, v132, v133
v_cvt_pk_bf16_f32 v133, v134, v135
ds_write_b64 v15, v[132:133] offset:6400
v_pk_fma_f32 v[136:137], v[36:37], v[52:53], v[136:137] op_sel_hi:[0,1,1] neg_lo:[1,0,0] neg_hi:[1,0,0]
v_pk_fma_f32 v[138:139], v[36:37], v[54:55], v[138:139] op_sel_hi:[0,1,1] neg_lo:[1,0,0] neg_hi:[1,0,0]
v_pk_mul_f32 v[204:205], v[34:35], v[204:205] op_sel:[1,0] op_sel_hi:[1,1]
v_pk_mul_f32 v[206:207], v[34:35], v[206:207] op_sel:[1,0] op_sel_hi:[1,1]
v_cvt_pk_bf16_f32 v168, v168, v169
v_cvt_pk_bf16_f32 v169, v170, v171
ds_write_b64 v15, v[168:169] offset:6528
v_pk_fma_f32 v[172:173], v[36:37], v[56:57], v[172:173] op_sel_hi:[0,1,1] neg_lo:[1,0,0] neg_hi:[1,0,0]
v_pk_fma_f32 v[174:175], v[36:37], v[58:59], v[174:175] op_sel_hi:[0,1,1] neg_lo:[1,0,0] neg_hi:[1,0,0]
v_pk_mul_f32 v[136:137], v[36:37], v[136:137] op_sel:[1,0] op_sel_hi:[1,1]
v_pk_mul_f32 v[138:139], v[36:37], v[138:139] op_sel:[1,0] op_sel_hi:[1,1]
v_cvt_pk_bf16_f32 v204, v204, v205
v_cvt_pk_bf16_f32 v205, v206, v207
ds_write_b64 v15, v[204:205] offset:6656
v_pk_fma_f32 v[208:209], v[36:37], v[60:61], v[208:209] op_sel_hi:[0,1,1] neg_lo:[1,0,0] neg_hi:[1,0,0]
v_pk_fma_f32 v[210:211], v[36:37], v[62:63], v[210:211] op_sel_hi:[0,1,1] neg_lo:[1,0,0] neg_hi:[1,0,0]
v_pk_mul_f32 v[172:173], v[36:37], v[172:173] op_sel:[1,0] op_sel_hi:[1,1]
v_pk_mul_f32 v[174:175], v[36:37], v[174:175] op_sel:[1,0] op_sel_hi:[1,1]
v_cvt_pk_bf16_f32 v136, v136, v137
v_cvt_pk_bf16_f32 v137, v138, v139
ds_write_b64 v15, v[136:137] offset:12800
v_pk_fma_f32 v[140:141], v[38:39], v[52:53], v[140:141] op_sel_hi:[0,1,1] neg_lo:[1,0,0] neg_hi:[1,0,0]
v_pk_fma_f32 v[142:143], v[38:39], v[54:55], v[142:143] op_sel_hi:[0,1,1] neg_lo:[1,0,0] neg_hi:[1,0,0]
v_pk_mul_f32 v[208:209], v[36:37], v[208:209] op_sel:[1,0] op_sel_hi:[1,1]
v_pk_mul_f32 v[210:211], v[36:37], v[210:211] op_sel:[1,0] op_sel_hi:[1,1]
v_cvt_pk_bf16_f32 v172, v172, v173
v_cvt_pk_bf16_f32 v173, v174, v175
ds_write_b64 v15, v[172:173] offset:12928
v_pk_fma_f32 v[176:177], v[38:39], v[56:57], v[176:177] op_sel_hi:[0,1,1] neg_lo:[1,0,0] neg_hi:[1,0,0]
v_pk_fma_f32 v[178:179], v[38:39], v[58:59], v[178:179] op_sel_hi:[0,1,1] neg_lo:[1,0,0] neg_hi:[1,0,0]
v_pk_mul_f32 v[140:141], v[38:39], v[140:141] op_sel:[1,0] op_sel_hi:[1,1]
v_pk_mul_f32 v[142:143], v[38:39], v[142:143] op_sel:[1,0] op_sel_hi:[1,1]
v_cvt_pk_bf16_f32 v208, v208, v209
v_cvt_pk_bf16_f32 v209, v210, v211
ds_write_b64 v15, v[208:209] offset:13056
v_pk_fma_f32 v[212:213], v[38:39], v[60:61], v[212:213] op_sel_hi:[0,1,1] neg_lo:[1,0,0] neg_hi:[1,0,0]
v_pk_fma_f32 v[214:215], v[38:39], v[62:63], v[214:215] op_sel_hi:[0,1,1] neg_lo:[1,0,0] neg_hi:[1,0,0]
v_pk_mul_f32 v[176:177], v[38:39], v[176:177] op_sel:[1,0] op_sel_hi:[1,1]
v_pk_mul_f32 v[178:179], v[38:39], v[178:179] op_sel:[1,0] op_sel_hi:[1,1]
v_cvt_pk_bf16_f32 v140, v140, v141
v_cvt_pk_bf16_f32 v141, v142, v143
ds_write_b64 v15, v[140:141] offset:19200
v_pk_fma_f32 v[144:145], v[40:41], v[52:53], v[144:145] op_sel_hi:[0,1,1] neg_lo:[1,0,0] neg_hi:[1,0,0]
v_pk_fma_f32 v[146:147], v[40:41], v[54:55], v[146:147] op_sel_hi:[0,1,1] neg_lo:[1,0,0] neg_hi:[1,0,0]
v_pk_mul_f32 v[212:213], v[38:39], v[212:213] op_sel:[1,0] op_sel_hi:[1,1]
v_pk_mul_f32 v[214:215], v[38:39], v[214:215] op_sel:[1,0] op_sel_hi:[1,1]
v_cvt_pk_bf16_f32 v176, v176, v177
v_cvt_pk_bf16_f32 v177, v178, v179
ds_write_b64 v15, v[176:177] offset:19328
v_pk_fma_f32 v[180:181], v[40:41], v[56:57], v[180:181] op_sel_hi:[0,1,1] neg_lo:[1,0,0] neg_hi:[1,0,0]
v_pk_fma_f32 v[182:183], v[40:41], v[58:59], v[182:183] op_sel_hi:[0,1,1] neg_lo:[1,0,0] neg_hi:[1,0,0]
v_pk_mul_f32 v[144:145], v[40:41], v[144:145] op_sel:[1,0] op_sel_hi:[1,1]
v_pk_mul_f32 v[146:147], v[40:41], v[146:147] op_sel:[1,0] op_sel_hi:[1,1]
v_cvt_pk_bf16_f32 v212, v212, v213
v_cvt_pk_bf16_f32 v213, v214, v215
ds_write_b64 v15, v[212:213] offset:19456
v_pk_fma_f32 v[216:217], v[40:41], v[60:61], v[216:217] op_sel_hi:[0,1,1] neg_lo:[1,0,0] neg_hi:[1,0,0]
v_pk_fma_f32 v[218:219], v[40:41], v[62:63], v[218:219] op_sel_hi:[0,1,1] neg_lo:[1,0,0] neg_hi:[1,0,0]
v_pk_mul_f32 v[180:181], v[40:41], v[180:181] op_sel:[1,0] op_sel_hi:[1,1]
v_pk_mul_f32 v[182:183], v[40:41], v[182:183] op_sel:[1,0] op_sel_hi:[1,1]
v_cvt_pk_bf16_f32 v144, v144, v145
v_cvt_pk_bf16_f32 v145, v146, v147
ds_write_b64 v15, v[144:145] offset:25600
v_pk_fma_f32 v[148:149], v[42:43], v[52:53], v[148:149] op_sel_hi:[0,1,1] neg_lo:[1,0,0] neg_hi:[1,0,0]
v_pk_fma_f32 v[150:151], v[42:43], v[54:55], v[150:151] op_sel_hi:[0,1,1] neg_lo:[1,0,0] neg_hi:[1,0,0]
v_pk_mul_f32 v[216:217], v[40:41], v[216:217] op_sel:[1,0] op_sel_hi:[1,1]
v_pk_mul_f32 v[218:219], v[40:41], v[218:219] op_sel:[1,0] op_sel_hi:[1,1]
v_cvt_pk_bf16_f32 v180, v180, v181
v_cvt_pk_bf16_f32 v181, v182, v183
ds_write_b64 v15, v[180:181] offset:25728
v_pk_fma_f32 v[184:185], v[42:43], v[56:57], v[184:185] op_sel_hi:[0,1,1] neg_lo:[1,0,0] neg_hi:[1,0,0]
v_pk_fma_f32 v[186:187], v[42:43], v[58:59], v[186:187] op_sel_hi:[0,1,1] neg_lo:[1,0,0] neg_hi:[1,0,0]
v_pk_mul_f32 v[148:149], v[42:43], v[148:149] op_sel:[1,0] op_sel_hi:[1,1]
v_pk_mul_f32 v[150:151], v[42:43], v[150:151] op_sel:[1,0] op_sel_hi:[1,1]
v_cvt_pk_bf16_f32 v216, v216, v217
v_cvt_pk_bf16_f32 v217, v218, v219
ds_write_b64 v15, v[216:217] offset:25856
v_pk_fma_f32 v[220:221], v[42:43], v[60:61], v[220:221] op_sel_hi:[0,1,1] neg_lo:[1,0,0] neg_hi:[1,0,0]
v_pk_fma_f32 v[222:223], v[42:43], v[62:63], v[222:223] op_sel_hi:[0,1,1] neg_lo:[1,0,0] neg_hi:[1,0,0]
v_pk_mul_f32 v[184:185], v[42:43], v[184:185] op_sel:[1,0] op_sel_hi:[1,1]
v_pk_mul_f32 v[186:187], v[42:43], v[186:187] op_sel:[1,0] op_sel_hi:[1,1]
v_cvt_pk_bf16_f32 v148, v148, v149
v_cvt_pk_bf16_f32 v149, v150, v151
ds_write_b64 v15, v[148:149] offset:32000
v_pk_fma_f32 v[152:153], v[44:45], v[52:53], v[152:153] op_sel_hi:[0,1,1] neg_lo:[1,0,0] neg_hi:[1,0,0]
v_pk_fma_f32 v[154:155], v[44:45], v[54:55], v[154:155] op_sel_hi:[0,1,1] neg_lo:[1,0,0] neg_hi:[1,0,0]
v_pk_mul_f32 v[220:221], v[42:43], v[220:221] op_sel:[1,0] op_sel_hi:[1,1]
v_pk_mul_f32 v[222:223], v[42:43], v[222:223] op_sel:[1,0] op_sel_hi:[1,1]
v_cvt_pk_bf16_f32 v184, v184, v185
v_cvt_pk_bf16_f32 v185, v186, v187
ds_write_b64 v15, v[184:185] offset:32128
v_pk_fma_f32 v[188:189], v[44:45], v[56:57], v[188:189] op_sel_hi:[0,1,1] neg_lo:[1,0,0] neg_hi:[1,0,0]
v_pk_fma_f32 v[190:191], v[44:45], v[58:59], v[190:191] op_sel_hi:[0,1,1] neg_lo:[1,0,0] neg_hi:[1,0,0]
v_pk_mul_f32 v[152:153], v[44:45], v[152:153] op_sel:[1,0] op_sel_hi:[1,1]
v_pk_mul_f32 v[154:155], v[44:45], v[154:155] op_sel:[1,0] op_sel_hi:[1,1]
v_cvt_pk_bf16_f32 v220, v220, v221
v_cvt_pk_bf16_f32 v221, v222, v223
ds_write_b64 v15, v[220:221] offset:32256
v_pk_fma_f32 v[224:225], v[44:45], v[60:61], v[224:225] op_sel_hi:[0,1,1] neg_lo:[1,0,0] neg_hi:[1,0,0]
v_pk_fma_f32 v[226:227], v[44:45], v[62:63], v[226:227] op_sel_hi:[0,1,1] neg_lo:[1,0,0] neg_hi:[1,0,0]
v_pk_mul_f32 v[188:189], v[44:45], v[188:189] op_sel:[1,0] op_sel_hi:[1,1]
v_pk_mul_f32 v[190:191], v[44:45], v[190:191] op_sel:[1,0] op_sel_hi:[1,1]
v_cvt_pk_bf16_f32 v152, v152, v153
v_cvt_pk_bf16_f32 v153, v154, v155
ds_write_b64 v15, v[152:153] offset:38400
v_pk_fma_f32 v[156:157], v[46:47], v[52:53], v[156:157] op_sel_hi:[0,1,1] neg_lo:[1,0,0] neg_hi:[1,0,0]
v_pk_fma_f32 v[158:159], v[46:47], v[54:55], v[158:159] op_sel_hi:[0,1,1] neg_lo:[1,0,0] neg_hi:[1,0,0]
v_pk_mul_f32 v[224:225], v[44:45], v[224:225] op_sel:[1,0] op_sel_hi:[1,1]
v_pk_mul_f32 v[226:227], v[44:45], v[226:227] op_sel:[1,0] op_sel_hi:[1,1]
v_cvt_pk_bf16_f32 v188, v188, v189
v_cvt_pk_bf16_f32 v189, v190, v191
ds_write_b64 v15, v[188:189] offset:38528
v_pk_fma_f32 v[192:193], v[46:47], v[56:57], v[192:193] op_sel_hi:[0,1,1] neg_lo:[1,0,0] neg_hi:[1,0,0]
v_pk_fma_f32 v[194:195], v[46:47], v[58:59], v[194:195] op_sel_hi:[0,1,1] neg_lo:[1,0,0] neg_hi:[1,0,0]
v_pk_mul_f32 v[156:157], v[46:47], v[156:157] op_sel:[1,0] op_sel_hi:[1,1]
v_pk_mul_f32 v[158:159], v[46:47], v[158:159] op_sel:[1,0] op_sel_hi:[1,1]
v_cvt_pk_bf16_f32 v224, v224, v225
v_cvt_pk_bf16_f32 v225, v226, v227
ds_write_b64 v15, v[224:225] offset:38656
v_pk_fma_f32 v[228:229], v[46:47], v[60:61], v[228:229] op_sel_hi:[0,1,1] neg_lo:[1,0,0] neg_hi:[1,0,0]
v_pk_fma_f32 v[230:231], v[46:47], v[62:63], v[230:231] op_sel_hi:[0,1,1] neg_lo:[1,0,0] neg_hi:[1,0,0]
v_pk_mul_f32 v[192:193], v[46:47], v[192:193] op_sel:[1,0] op_sel_hi:[1,1]
v_pk_mul_f32 v[194:195], v[46:47], v[194:195] op_sel:[1,0] op_sel_hi:[1,1]
v_cvt_pk_bf16_f32 v156, v156, v157
v_cvt_pk_bf16_f32 v157, v158, v159
ds_write_b64 v15, v[156:157] offset:44800
v_pk_fma_f32 v[160:161], v[48:49], v[52:53], v[160:161] op_sel_hi:[0,1,1] neg_lo:[1,0,0] neg_hi:[1,0,0]
v_pk_fma_f32 v[162:163], v[48:49], v[54:55], v[162:163] op_sel_hi:[0,1,1] neg_lo:[1,0,0] neg_hi:[1,0,0]
v_pk_mul_f32 v[228:229], v[46:47], v[228:229] op_sel:[1,0] op_sel_hi:[1,1]
v_pk_mul_f32 v[230:231], v[46:47], v[230:231] op_sel:[1,0] op_sel_hi:[1,1]
v_cvt_pk_bf16_f32 v192, v192, v193
v_cvt_pk_bf16_f32 v193, v194, v195
ds_write_b64 v15, v[192:193] offset:44928
v_pk_fma_f32 v[196:197], v[48:49], v[56:57], v[196:197] op_sel_hi:[0,1,1] neg_lo:[1,0,0] neg_hi:[1,0,0]
v_pk_fma_f32 v[198:199], v[48:49], v[58:59], v[198:199] op_sel_hi:[0,1,1] neg_lo:[1,0,0] neg_hi:[1,0,0]
v_pk_mul_f32 v[160:161], v[48:49], v[160:161] op_sel:[1,0] op_sel_hi:[1,1]
v_pk_mul_f32 v[162:163], v[48:49], v[162:163] op_sel:[1,0] op_sel_hi:[1,1]
v_cvt_pk_bf16_f32 v228, v228, v229
v_cvt_pk_bf16_f32 v229, v230, v231
ds_write_b64 v15, v[228:229] offset:45056
v_pk_fma_f32 v[232:233], v[48:49], v[60:61], v[232:233] op_sel_hi:[0,1,1] neg_lo:[1,0,0] neg_hi:[1,0,0]
v_pk_fma_f32 v[234:235], v[48:49], v[62:63], v[234:235] op_sel_hi:[0,1,1] neg_lo:[1,0,0] neg_hi:[1,0,0]
v_pk_mul_f32 v[196:197], v[48:49], v[196:197] op_sel:[1,0] op_sel_hi:[1,1]
v_pk_mul_f32 v[198:199], v[48:49], v[198:199] op_sel:[1,0] op_sel_hi:[1,1]
v_cvt_pk_bf16_f32 v160, v160, v161
v_cvt_pk_bf16_f32 v161, v162, v163
ds_write_b64 v15, v[160:161] offset:51200
v_pk_mul_f32 v[232:233], v[48:49], v[232:233] op_sel:[1,0] op_sel_hi:[1,1]
v_pk_mul_f32 v[234:235], v[48:49], v[234:235] op_sel:[1,0] op_sel_hi:[1,1]
v_cvt_pk_bf16_f32 v196, v196, v197
v_cvt_pk_bf16_f32 v197, v198, v199
ds_write_b64 v15, v[196:197] offset:51328
v_cvt_pk_bf16_f32 v232, v232, v233
v_cvt_pk_bf16_f32 v233, v234, v235
ds_write_b64 v15, v[232:233] offset:51456
s_waitcnt lgkmcnt(0)
s_branch Latt_5
Lpf_4:
s_lshl_b32 s43, s35, 7
s_waitcnt lgkmcnt(0)
s_mov_b32 s8, s64
s_mov_b32 s9, s65
s_mov_b32 s10, 4194304
s_mov_b32 s11, 0x20000
s_add_u32 s12, s66, s43
s_addc_u32 s13, s67, 0
s_mov_b32 s14, 6289536
s_mov_b32 s15, 0x20000
s_add_u32 s84, s82, 28311552
s_addc_u32 s85, s83, 0
s_mov_b32 s86, 114688
s_mov_b32 s87, 0x20000
s_mov_b32 s56, s80
s_mov_b32 s57, s81
s_mov_b32 s58, 256
s_mov_b32 s59, 0x20000
v_mov_b32 v5, 0
v_lshlrev_b32 v14, 7, v1
s_or_b32 s43, s34, s35
s_cmp_lg_u32 s43, 0
s_cbranch_scc1 Lz_20
s_movk_i32 s43, 0x2000
s_branch Lov_3
.p2align 12
Lst_3_0:
s_branch Lwr_170
s_nop 0
s_nop 0
Lov_3:
buffer_store_dword v5, v14, s[84:87], 0 offen sc1
s_bfm_b64 exec, 44, 0
buffer_store_dword v5, v14, s[84:87], s43 offen sc1
s_mov_b64 exec, 1
v_mov_b32 v6, 1
s_waitcnt vmcnt(0)
buffer_store_dword v6, v5, s[56:59], 0 offen sc1
s_mov_b64 exec, -1
Lz_20:
s_lshl_b32 s43, s51, 11
buffer_load_dwordx4 v[96:99], v10, s[8:11], s43 offen offset:0
buffer_load_dwordx4 v[100:103], v10, s[8:11], s43 offen offset:1024
buffer_load_dwordx4 v[104:107], v10, s[8:11], s43 offen offset:2048
buffer_load_dwordx4 v[108:111], v10, s[8:11], s43 offen offset:3072
v_min_u32 v14, 23, v1
v_lshrrev_b32 v15, 3, v14
v_mul_u32_u24 v15, 43008, v15
v_and_b32 v14, 7, v14
v_lshl_add_u32 v15, v14, 4, v15
v_mov_b32 v32, 0x3f803f80
v_mov_b32 v33, 0x3f803f80
v_mov_b32 v34, 0x3f803f80
v_mov_b32 v35, 0x3f803f80
ds_write_b128 v15, v[32:35]
s_add_u32 s20, s82, 26214400
s_addc_u32 s21, s83, 0
s_mov_b32 s22, 16384
s_mov_b32 s23, 0x20000
s_add_u32 s43, s2, 128
s_lshl_b32 s43, s43, 7
v_lshlrev_b32 v14, 2, v1
s_mov_b64 exec, 15
buffer_store_dword v5, v14, s[84:87], s43 offen sc1
s_mov_b64 exec, -1
s_lshl_b32 s43, s34, 4
s_add_u32 s43, s43, s35
s_lshl_b32 s43, s43, 8
s_add_u32 s43, s43, 49152
v_lshlrev_b32 v14, 7, v1
s_mov_b64 exec, 3
buffer_store_dword v5, v14, s[84:87], s43 offen sc1
s_mov_b64 exec, -1
s_lshl_b32 s52, s34, 7
s_add_u32 s52, s52, 28319744
s_sub_u32 s53, s52, 128
s_cmp_eq_u32 s34, 0
s_cselect_b32 s53, s52, s53
s_waitcnt lgkmcnt(0)
s_barrier
s_waitcnt vmcnt(2)
s_mov_b32 s43, 0x3f803f80
v_mov_b32 v116, 0
v_mov_b32 v117, 0
v_mov_b32 v118, 0
v_mov_b32 v119, 0
v_mov_b32 v120, 0
v_mov_b32 v121, 0
v_mov_b32 v122, 0
v_mov_b32 v123, 0
v_dot2_f32_bf16 v116, v96, s43, v116
v_dot2_f32_bf16 v120, v96, v96, v120
v_dot2_f32_bf16 v118, v104, s43, v118
v_dot2_f32_bf16 v122, v104, v104, v122
v_dot2_f32_bf16 v117, v97, s43, v117
v_dot2_f32_bf16 v121, v97, v97, v121
v_dot2_f32_bf16 v119, v105, s43, v119
v_dot2_f32_bf16 v123, v105, v105, v123
v_dot2_f32_bf16 v116, v98, s43, v116
v_dot2_f32_bf16 v120, v98, v98, v120
v_dot2_f32_bf16 v118, v106, s43, v118
v_dot2_f32_bf16 v122, v106, v106, v122
v_dot2_f32_bf16 v117, v99, s43, v117
v_dot2_f32_bf16 v121, v99, v99, v121
v_dot2_f32_bf16 v119, v107, s43, v119
v_dot2_f32_bf16 v123, v107, v107, v123
v_dot2_f32_bf16 v116, v100, s43, v116
v_dot2_f32_bf16 v120, v100, v100, v120
v_dot2_f32_bf16 v118, v108, s43, v118
v_dot2_f32_bf16 v122, v108, v108, v122
v_dot2_f32_bf16 v117, v101, s43, v117
v_dot2_f32_bf16 v121, v101, v101, v121
v_dot2_f32_bf16 v119, v109, s43, v119
v_dot2_f32_bf16 v123, v109, v109, v123
v_dot2_f32_bf16 v116, v102, s43, v116
v_dot2_f32_bf16 v120, v102, v102, v120
v_dot2_f32_bf16 v118, v110, s43, v118
v_dot2_f32_bf16 v122, v110, v110, v122
v_dot2_f32_bf16 v117, v103, s43, v117
v_dot2_f32_bf16 v121, v103, v103, v121
v_dot2_f32_bf16 v119, v111, s43, v119
v_dot2_f32_bf16 v123, v111, v111, v123
s_nop 2
v_add_f32 v116, v116, v117
v_add_f32 v118, v118, v119
v_add_f32 v120, v120, v121
v_add_f32 v122, v122, v123
s_nop 1
v_permlane32_swap_b32 v116, v118
v_permlane32_swap_b32 v120, v122
v_add_f32 v116, v116, v118
v_add_f32 v120, v120, v122
s_nop 1
v_permlane16_swap_b32 v116, v120
v_add_f32 v116, v116, v120
s_nop 1
v_add_f32_dpp v116, v116, v116 row_ror:8 row_mask:0xf bank_mask:0xf
s_nop 1
v_add_f32_dpp v116, v116, v116 row_ror:4 row_mask:0xf bank_mask:0xf
s_nop 1
v_add_f32_dpp v116, v116, v116 row_ror:2 row_mask:0xf bank_mask:0xf
s_nop 1
v_add_f32_dpp v116, v116, v116 row_ror:1 row_mask:0xf bank_mask:0xf
v_mov_b32 v117, v116
s_nop 1
v_permlane16_swap_b32 v116, v117
v_mul_f32 v112, 0x3a800000, v116
v_mul_f32 v113, 0x3a800000, v117
v_fma_f32 v113, -v112, v112, v113
v_max_f32 v113, 0, v113
v_add_f32 v113, 0x3727c5ac, v113
v_rsq_f32 v113, v113
v_lshrrev_b32 v11, 5, v1
s_lshl_b32 s43, s47, 4
s_add_u32 s43, s43, 148608
v_lshl_add_u32 v11, v11, 3, s43
ds_write_b64 v11, v[112:113]
s_waitcnt lgkmcnt(0)
s_mov_b32 s28, s66
s_mov_b32 s29, s67
s_mov_b32 s30, 6291456
s_mov_b32 s31, 0x20000
s_mul_i32 s43, s33, 10624
s_add_u32 s43, s43, 1572864
v_lshlrev_b32 v30, 7, v1
buffer_load_dword v31, v30, s[28:31], s43 offen
s_add_u32 s43, s43, 8192
s_bfm_b64 exec, 19, 0
buffer_load_dword v31, v30, s[28:31], s43 offen
s_mov_b64 exec, -1
s_branch Lst_0_0
Lwr_167:
s_barrier
v_lshlrev_b32 v5, 4, v1
v_and_b32 v5, 63, v5
v_add_u32 v6, 148608, v5
ds_read_b128 v[112:115], v6
s_lshl_b32 s43, s63, 3
v_add_u32 v5, s43, v5
s_waitcnt lgkmcnt(0)
s_mov_b64 exec, 15
buffer_store_dwordx4 v[112:115], v5, s[20:23], 0 offen sc1
s_mov_b64 exec, -1
v_mov_b32 v4, 0
buffer_load_dword v6, v4, s[56:59], 0 offen sc1
s_mov_b32 s62, 0
s_branch Lst_1_0
Lwr_168:
s_barrier
s_mov_b32 s28, s66
s_mov_b32 s29, s67
s_mov_b32 s30, 6291456
s_mov_b32 s31, 0x20000
s_mul_i32 s43, s33, 10624
s_add_u32 s43, s43, 3932160
v_lshlrev_b32 v30, 7, v1
buffer_load_dword v31, v30, s[28:31], s43 offen
s_add_u32 s43, s43, 8192
s_bfm_b64 exec, 19, 0
buffer_load_dword v31, v30, s[28:31], s43 offen
s_mov_b64 exec, -1
s_lshl_b32 s43, s35, 7
s_add_u32 s28, s68, s43
s_addc_u32 s29, s69, 0
s_mov_b32 s30, 2095232
s_mov_b32 s31, 0x20000
v_and_b32 v29, 7, v1
v_lshrrev_b32 v30, 3, v1
v_lshl_add_u32 v29, v30, 6, v29
s_lshl_b32 s43, s48, 3
v_add_u32 v29, s43, v29
v_lshlrev_b32 v29, 11, v29
s_mov_b32 s43, 1048576
s_mov_b32 s28, s68
s_mov_b32 s29, s69
s_mov_b32 s30, 2097152
s_mov_b32 s31, 0x20000
s_mul_i32 s43, s33, 9472
v_lshlrev_b32 v30, 7, v1
buffer_load_dword v31, v30, s[28:31], s43 offen
s_add_u32 s43, s43, 8192
s_bfm_b64 exec, 10, 0
buffer_load_dword v31, v30, s[28:31], s43 offen
s_mov_b64 exec, -1
s_branch Lst_2_0
Lwr_169:
s_barrier
s_cmp_eq_u32 s62, 3
s_cbranch_scc1 Lste_24
s_cmp_eq_u32 s62, 2
s_cbranch_scc1 Lst2_22
s_cmp_ge_u32 s62, 4
s_cbranch_scc1 Lst4_23
s_cmp_eq_u32 s62, 1
s_cbranch_scc1 Lst1_21
s_waitcnt vmcnt(4)
v_readfirstlane_b32 s54, v6
s_cmp_eq_u32 s54, 0
s_cbranch_scc0 Lrep_25
buffer_load_dword v6, v4, s[56:59], 0 offen sc1
s_branch Lste_24
Lrep_25:
s_add_u32 s7, s34, 64
s_lshl_b32 s7, s7, 7
v_mov_b32 v5, s7
v_mov_b32 v6, 1
s_mov_b64 exec, 1
buffer_atomic_add v6, v5, s[84:87], 0 offen sc1
s_mov_b64 exec, -1
s_mov_b32 s62, 1
s_mov_b32 s54, 0
s_mov_b32 s55, 0
s_branch Lste_24
Lst1_21:
s_and_b32 s43, s54, s55
s_cmp_eq_u32 s43, 16
s_cbranch_scc1 Lg_26
s_load_dword s54, s[82:83], s52 glc
s_load_dword s55, s[82:83], s53 glc
s_branch Lste_24
Lg_26:
v_add_u32 v5, 0, v1
v_min_u32 v5, 143, v5
v_lshlrev_b32 v20, 3, v5
v_add_u32 v5, s50, v5
v_max_i32 v5, 0, v5
v_lshlrev_b32 v5, 3, v5
buffer_load_dwordx2 v[32:33], v5, s[20:23], 0 offen sc1
v_add_u32 v5, 64, v1
v_min_u32 v5, 143, v5
v_lshlrev_b32 v21, 3, v5
v_add_u32 v5, s50, v5
v_max_i32 v5, 0, v5
v_lshlrev_b32 v5, 3, v5
buffer_load_dwordx2 v[34:35], v5, s[20:23], 0 offen sc1
v_add_u32 v5, 128, v1
v_min_u32 v5, 143, v5
v_lshlrev_b32 v22, 3, v5
v_add_u32 v5, s50, v5
v_max_i32 v5, 0, v5
v_lshlrev_b32 v5, 3, v5
buffer_load_dwordx2 v[36:37], v5, s[20:23], 0 offen sc1
s_mov_b32 s62, 4
s_branch Lste_24
Lst4_23:
s_mov_b32 s62, 2
s_branch Lste_24
Lst2_22:
s_waitcnt vmcnt(0)
v_add_u32 v20, 147456, v20
ds_write_b64 v20, v[32:33]
v_add_u32 v21, 147456, v21
ds_write_b64 v21, v[34:35]
v_add_u32 v22, 147456, v22
ds_write_b64 v22, v[36:37]
s_waitcnt lgkmcnt(0)
s_mov_b32 s62, 3
Lste_24:
s_branch Lst_3_0
Lwr_170:
s_barrier
s_cmp_eq_u32 s62, 3
s_cbranch_scc1 Lste_30
s_cmp_eq_u32 s62, 2
s_cbranch_scc1 Lst2_28
s_cmp_ge_u32 s62, 4
s_cbranch_scc1 Lst4_29
s_cmp_eq_u32 s62, 1
s_cbranch_scc1 Lst1_27
s_waitcnt vmcnt(0)
v_readfirstlane_b32 s54, v6
s_cmp_eq_u32 s54, 0
s_cbranch_scc0 Lrep_31
buffer_load_dword v6, v4, s[56:59], 0 offen sc1
s_branch Lste_30
Lrep_31:
s_add_u32 s7, s34, 64
s_lshl_b32 s7, s7, 7
v_mov_b32 v5, s7
v_mov_b32 v6, 1
s_mov_b64 exec, 1
buffer_atomic_add v6, v5, s[84:87], 0 offen sc1
s_mov_b64 exec, -1
s_mov_b32 s62, 1
s_mov_b32 s54, 0
s_mov_b32 s55, 0
s_branch Lste_30
Lst1_27:
s_and_b32 s43, s54, s55
s_cmp_eq_u32 s43, 16
s_cbranch_scc1 Lg_32
s_load_dword s54, s[82:83], s52 glc
s_load_dword s55, s[82:83], s53 glc
s_branch Lste_30
Lg_32:
v_add_u32 v5, 0, v1
v_min_u32 v5, 143, v5
v_lshlrev_b32 v20, 3, v5
v_add_u32 v5, s50, v5
v_max_i32 v5, 0, v5
v_lshlrev_b32 v5, 3, v5
buffer_load_dwordx2 v[32:33], v5, s[20:23], 0 offen sc1
v_add_u32 v5, 64, v1
v_min_u32 v5, 143, v5
v_lshlrev_b32 v21, 3, v5
v_add_u32 v5, s50, v5
v_max_i32 v5, 0, v5
v_lshlrev_b32 v5, 3, v5
buffer_load_dwordx2 v[34:35], v5, s[20:23], 0 offen sc1
v_add_u32 v5, 128, v1
v_min_u32 v5, 143, v5
v_lshlrev_b32 v22, 3, v5
v_add_u32 v5, s50, v5
v_max_i32 v5, 0, v5
v_lshlrev_b32 v5, 3, v5
buffer_load_dwordx2 v[36:37], v5, s[20:23], 0 offen sc1
s_mov_b32 s62, 4
s_branch Lste_30
Lst4_29:
s_mov_b32 s62, 2
s_branch Lste_30
Lst2_28:
s_waitcnt vmcnt(0)
v_add_u32 v20, 147456, v20
ds_write_b64 v20, v[32:33]
v_add_u32 v21, 147456, v21
ds_write_b64 v21, v[34:35]
v_add_u32 v22, 147456, v22
ds_write_b64 v22, v[36:37]
s_waitcnt lgkmcnt(0)
s_mov_b32 s62, 3
Lste_30:
s_branch Lst_4_0
Lwr_171:
s_barrier
s_cmp_eq_u32 s62, 3
s_cbranch_scc1 Lste_36
s_cmp_eq_u32 s62, 2
s_cbranch_scc1 Lst2_34
s_cmp_ge_u32 s62, 4
s_cbranch_scc1 Lst4_35
s_cmp_eq_u32 s62, 1
s_cbranch_scc1 Lst1_33
s_waitcnt vmcnt(0)
v_readfirstlane_b32 s54, v6
s_cmp_eq_u32 s54, 0
s_cbranch_scc0 Lrep_37
buffer_load_dword v6, v4, s[56:59], 0 offen sc1
s_branch Lste_36
Lrep_37:
s_add_u32 s7, s34, 64
s_lshl_b32 s7, s7, 7
v_mov_b32 v5, s7
v_mov_b32 v6, 1
s_mov_b64 exec, 1
buffer_atomic_add v6, v5, s[84:87], 0 offen sc1
s_mov_b64 exec, -1
s_mov_b32 s62, 1
s_mov_b32 s54, 0
s_mov_b32 s55, 0
s_branch Lste_36
Lst1_33:
s_and_b32 s43, s54, s55
s_cmp_eq_u32 s43, 16
s_cbranch_scc1 Lg_38
s_load_dword s54, s[82:83], s52 glc
s_load_dword s55, s[82:83], s53 glc
s_branch Lste_36
Lg_38:
v_add_u32 v5, 0, v1
v_min_u32 v5, 143, v5
v_lshlrev_b32 v20, 3, v5
v_add_u32 v5, s50, v5
v_max_i32 v5, 0, v5
v_lshlrev_b32 v5, 3, v5
buffer_load_dwordx2 v[32:33], v5, s[20:23], 0 offen sc1
v_add_u32 v5, 64, v1
v_min_u32 v5, 143, v5
v_lshlrev_b32 v21, 3, v5
v_add_u32 v5, s50, v5
v_max_i32 v5, 0, v5
v_lshlrev_b32 v5, 3, v5
buffer_load_dwordx2 v[34:35], v5, s[20:23], 0 offen sc1
v_add_u32 v5, 128, v1
v_min_u32 v5, 143, v5
v_lshlrev_b32 v22, 3, v5
v_add_u32 v5, s50, v5
v_max_i32 v5, 0, v5
v_lshlrev_b32 v5, 3, v5
buffer_load_dwordx2 v[36:37], v5, s[20:23], 0 offen sc1
s_mov_b32 s62, 4
s_branch Lste_36
Lst4_35:
s_mov_b32 s62, 2
s_branch Lste_36
Lst2_34:
s_waitcnt vmcnt(0)
v_add_u32 v20, 147456, v20
ds_write_b64 v20, v[32:33]
v_add_u32 v21, 147456, v21
ds_write_b64 v21, v[34:35]
v_add_u32 v22, 147456, v22
ds_write_b64 v22, v[36:37]
s_waitcnt lgkmcnt(0)
s_mov_b32 s62, 3
Lste_36:
s_branch Lst_5_0
Lwr_172:
s_barrier
s_cmp_eq_u32 s62, 3
s_cbranch_scc1 Lste_42
s_cmp_eq_u32 s62, 2
s_cbranch_scc1 Lst2_40
s_cmp_ge_u32 s62, 4
s_cbranch_scc1 Lst4_41
s_cmp_eq_u32 s62, 1
s_cbranch_scc1 Lst1_39
s_waitcnt vmcnt(0)
v_readfirstlane_b32 s54, v6
s_cmp_eq_u32 s54, 0
s_cbranch_scc0 Lrep_43
buffer_load_dword v6, v4, s[56:59], 0 offen sc1
s_branch Lste_42
Lrep_43:
s_add_u32 s7, s34, 64
s_lshl_b32 s7, s7, 7
v_mov_b32 v5, s7
v_mov_b32 v6, 1
s_mov_b64 exec, 1
buffer_atomic_add v6, v5, s[84:87], 0 offen sc1
s_mov_b64 exec, -1
s_mov_b32 s62, 1
s_mov_b32 s54, 0
s_mov_b32 s55, 0
s_branch Lste_42
Lst1_39:
s_and_b32 s43, s54, s55
s_cmp_eq_u32 s43, 16
s_cbranch_scc1 Lg_44
s_load_dword s54, s[82:83], s52 glc
s_load_dword s55, s[82:83], s53 glc
s_branch Lste_42
Lg_44:
v_add_u32 v5, 0, v1
v_min_u32 v5, 143, v5
v_lshlrev_b32 v20, 3, v5
v_add_u32 v5, s50, v5
v_max_i32 v5, 0, v5
v_lshlrev_b32 v5, 3, v5
buffer_load_dwordx2 v[32:33], v5, s[20:23], 0 offen sc1
v_add_u32 v5, 64, v1
v_min_u32 v5, 143, v5
v_lshlrev_b32 v21, 3, v5
v_add_u32 v5, s50, v5
v_max_i32 v5, 0, v5
v_lshlrev_b32 v5, 3, v5
buffer_load_dwordx2 v[34:35], v5, s[20:23], 0 offen sc1
v_add_u32 v5, 128, v1
v_min_u32 v5, 143, v5
v_lshlrev_b32 v22, 3, v5
v_add_u32 v5, s50, v5
v_max_i32 v5, 0, v5
v_lshlrev_b32 v5, 3, v5
buffer_load_dwordx2 v[36:37], v5, s[20:23], 0 offen sc1
s_mov_b32 s62, 4
s_branch Lste_42
Lst4_41:
s_mov_b32 s62, 2
s_branch Lste_42
Lst2_40:
s_waitcnt vmcnt(0)
v_add_u32 v20, 147456, v20
ds_write_b64 v20, v[32:33]
v_add_u32 v21, 147456, v21
ds_write_b64 v21, v[34:35]
v_add_u32 v22, 147456, v22
ds_write_b64 v22, v[36:37]
s_waitcnt lgkmcnt(0)
s_mov_b32 s62, 3
Lste_42:
s_branch Lst_6_0
Lwr_173:
s_barrier
s_cmp_eq_u32 s62, 3
s_cbranch_scc1 Lste_48
s_cmp_eq_u32 s62, 2
s_cbranch_scc1 Lst2_46
s_cmp_ge_u32 s62, 4
s_cbranch_scc1 Lst4_47
s_cmp_eq_u32 s62, 1
s_cbranch_scc1 Lst1_45
s_waitcnt vmcnt(0)
v_readfirstlane_b32 s54, v6
s_cmp_eq_u32 s54, 0
s_cbranch_scc0 Lrep_49
buffer_load_dword v6, v4, s[56:59], 0 offen sc1
s_branch Lste_48
Lrep_49:
s_add_u32 s7, s34, 64
s_lshl_b32 s7, s7, 7
v_mov_b32 v5, s7
v_mov_b32 v6, 1
s_mov_b64 exec, 1
buffer_atomic_add v6, v5, s[84:87], 0 offen sc1
s_mov_b64 exec, -1
s_mov_b32 s62, 1
s_mov_b32 s54, 0
s_mov_b32 s55, 0
s_branch Lste_48
Lst1_45:
s_and_b32 s43, s54, s55
s_cmp_eq_u32 s43, 16
s_cbranch_scc1 Lg_50
s_load_dword s54, s[82:83], s52 glc
s_load_dword s55, s[82:83], s53 glc
s_branch Lste_48
Lg_50:
v_add_u32 v5, 0, v1
v_min_u32 v5, 143, v5
v_lshlrev_b32 v20, 3, v5
v_add_u32 v5, s50, v5
v_max_i32 v5, 0, v5
v_lshlrev_b32 v5, 3, v5
buffer_load_dwordx2 v[32:33], v5, s[20:23], 0 offen sc1
v_add_u32 v5, 64, v1
v_min_u32 v5, 143, v5
v_lshlrev_b32 v21, 3, v5
v_add_u32 v5, s50, v5
v_max_i32 v5, 0, v5
v_lshlrev_b32 v5, 3, v5
buffer_load_dwordx2 v[34:35], v5, s[20:23], 0 offen sc1
v_add_u32 v5, 128, v1
v_min_u32 v5, 143, v5
v_lshlrev_b32 v22, 3, v5
v_add_u32 v5, s50, v5
v_max_i32 v5, 0, v5
v_lshlrev_b32 v5, 3, v5
buffer_load_dwordx2 v[36:37], v5, s[20:23], 0 offen sc1
s_mov_b32 s62, 4
s_branch Lste_48
Lst4_47:
s_mov_b32 s62, 2
s_branch Lste_48
Lst2_46:
s_waitcnt vmcnt(0)
v_add_u32 v20, 147456, v20
ds_write_b64 v20, v[32:33]
v_add_u32 v21, 147456, v21
ds_write_b64 v21, v[34:35]
v_add_u32 v22, 147456, v22
ds_write_b64 v22, v[36:37]
s_waitcnt lgkmcnt(0)
s_mov_b32 s62, 3
Lste_48:
s_branch Lst_7_0
Lwr_174:
s_barrier
s_cmp_eq_u32 s62, 3
s_cbranch_scc1 Lste_54
s_cmp_eq_u32 s62, 2
s_cbranch_scc1 Lst2_52
s_cmp_ge_u32 s62, 4
s_cbranch_scc1 Lst4_53
s_cmp_eq_u32 s62, 1
s_cbranch_scc1 Lst1_51
s_waitcnt vmcnt(0)
v_readfirstlane_b32 s54, v6
s_cmp_eq_u32 s54, 0
s_cbranch_scc0 Lrep_55
buffer_load_dword v6, v4, s[56:59], 0 offen sc1
s_branch Lste_54
Lrep_55:
s_add_u32 s7, s34, 64
s_lshl_b32 s7, s7, 7
v_mov_b32 v5, s7
v_mov_b32 v6, 1
s_mov_b64 exec, 1
buffer_atomic_add v6, v5, s[84:87], 0 offen sc1
s_mov_b64 exec, -1
s_mov_b32 s62, 1
s_mov_b32 s54, 0
s_mov_b32 s55, 0
s_branch Lste_54
Lst1_51:
s_and_b32 s43, s54, s55
s_cmp_eq_u32 s43, 16
s_cbranch_scc1 Lg_56
s_load_dword s54, s[82:83], s52 glc
s_load_dword s55, s[82:83], s53 glc
s_branch Lste_54
Lg_56:
v_add_u32 v5, 0, v1
v_min_u32 v5, 143, v5
v_lshlrev_b32 v20, 3, v5
v_add_u32 v5, s50, v5
v_max_i32 v5, 0, v5
v_lshlrev_b32 v5, 3, v5
buffer_load_dwordx2 v[32:33], v5, s[20:23], 0 offen sc1
v_add_u32 v5, 64, v1
v_min_u32 v5, 143, v5
v_lshlrev_b32 v21, 3, v5
v_add_u32 v5, s50, v5
v_max_i32 v5, 0, v5
v_lshlrev_b32 v5, 3, v5
buffer_load_dwordx2 v[34:35], v5, s[20:23], 0 offen sc1
v_add_u32 v5, 128, v1
v_min_u32 v5, 143, v5
v_lshlrev_b32 v22, 3, v5
v_add_u32 v5, s50, v5
v_max_i32 v5, 0, v5
v_lshlrev_b32 v5, 3, v5
buffer_load_dwordx2 v[36:37], v5, s[20:23], 0 offen sc1
s_mov_b32 s62, 4
s_branch Lste_54
Lst4_53:
s_mov_b32 s62, 2
s_branch Lste_54
Lst2_52:
s_waitcnt vmcnt(0)
v_add_u32 v20, 147456, v20
ds_write_b64 v20, v[32:33]
v_add_u32 v21, 147456, v21
ds_write_b64 v21, v[34:35]
v_add_u32 v22, 147456, v22
ds_write_b64 v22, v[36:37]
s_waitcnt lgkmcnt(0)
s_mov_b32 s62, 3
Lste_54:
s_branch Lst_8_0
Lwr_175:
s_barrier
s_cmp_eq_u32 s62, 3
s_cbranch_scc1 Lste_60
s_cmp_eq_u32 s62, 2
s_cbranch_scc1 Lst2_58
s_cmp_ge_u32 s62, 4
s_cbranch_scc1 Lst4_59
s_cmp_eq_u32 s62, 1
s_cbranch_scc1 Lst1_57
s_waitcnt vmcnt(0)
v_readfirstlane_b32 s54, v6
s_cmp_eq_u32 s54, 0
s_cbranch_scc0 Lrep_61
buffer_load_dword v6, v4, s[56:59], 0 offen sc1
s_branch Lste_60
Lrep_61:
s_add_u32 s7, s34, 64
s_lshl_b32 s7, s7, 7
v_mov_b32 v5, s7
v_mov_b32 v6, 1
s_mov_b64 exec, 1
buffer_atomic_add v6, v5, s[84:87], 0 offen sc1
s_mov_b64 exec, -1
s_mov_b32 s62, 1
s_mov_b32 s54, 0
s_mov_b32 s55, 0
s_branch Lste_60
Lst1_57:
s_and_b32 s43, s54, s55
s_cmp_eq_u32 s43, 16
s_cbranch_scc1 Lg_62
s_load_dword s54, s[82:83], s52 glc
s_load_dword s55, s[82:83], s53 glc
s_branch Lste_60
Lg_62:
v_add_u32 v5, 0, v1
v_min_u32 v5, 143, v5
v_lshlrev_b32 v20, 3, v5
v_add_u32 v5, s50, v5
v_max_i32 v5, 0, v5
v_lshlrev_b32 v5, 3, v5
buffer_load_dwordx2 v[32:33], v5, s[20:23], 0 offen sc1
v_add_u32 v5, 64, v1
v_min_u32 v5, 143, v5
v_lshlrev_b32 v21, 3, v5
v_add_u32 v5, s50, v5
v_max_i32 v5, 0, v5
v_lshlrev_b32 v5, 3, v5
buffer_load_dwordx2 v[34:35], v5, s[20:23], 0 offen sc1
v_add_u32 v5, 128, v1
v_min_u32 v5, 143, v5
v_lshlrev_b32 v22, 3, v5
v_add_u32 v5, s50, v5
v_max_i32 v5, 0, v5
v_lshlrev_b32 v5, 3, v5
buffer_load_dwordx2 v[36:37], v5, s[20:23], 0 offen sc1
s_mov_b32 s62, 4
s_branch Lste_60
Lst4_59:
s_mov_b32 s62, 2
s_branch Lste_60
Lst2_58:
s_waitcnt vmcnt(0)
v_add_u32 v20, 147456, v20
ds_write_b64 v20, v[32:33]
v_add_u32 v21, 147456, v21
ds_write_b64 v21, v[34:35]
v_add_u32 v22, 147456, v22
ds_write_b64 v22, v[36:37]
s_waitcnt lgkmcnt(0)
s_mov_b32 s62, 3
Lste_60:
s_branch Lst_9_0
Lwr_176:
s_barrier
s_cmp_eq_u32 s62, 3
s_cbranch_scc1 Lste_66
s_cmp_eq_u32 s62, 2
s_cbranch_scc1 Lst2_64
s_cmp_ge_u32 s62, 4
s_cbranch_scc1 Lst4_65
s_cmp_eq_u32 s62, 1
s_cbranch_scc1 Lst1_63
s_waitcnt vmcnt(0)
v_readfirstlane_b32 s54, v6
s_cmp_eq_u32 s54, 0
s_cbranch_scc0 Lrep_67
buffer_load_dword v6, v4, s[56:59], 0 offen sc1
s_branch Lste_66
Lrep_67:
s_add_u32 s7, s34, 64
s_lshl_b32 s7, s7, 7
v_mov_b32 v5, s7
v_mov_b32 v6, 1
s_mov_b64 exec, 1
buffer_atomic_add v6, v5, s[84:87], 0 offen sc1
s_mov_b64 exec, -1
s_mov_b32 s62, 1
s_mov_b32 s54, 0
s_mov_b32 s55, 0
s_branch Lste_66
Lst1_63:
s_and_b32 s43, s54, s55
s_cmp_eq_u32 s43, 16
s_cbranch_scc1 Lg_68
s_load_dword s54, s[82:83], s52 glc
s_load_dword s55, s[82:83], s53 glc
s_branch Lste_66
Lg_68:
v_add_u32 v5, 0, v1
v_min_u32 v5, 143, v5
v_lshlrev_b32 v20, 3, v5
v_add_u32 v5, s50, v5
v_max_i32 v5, 0, v5
v_lshlrev_b32 v5, 3, v5
buffer_load_dwordx2 v[32:33], v5, s[20:23], 0 offen sc1
v_add_u32 v5, 64, v1
v_min_u32 v5, 143, v5
v_lshlrev_b32 v21, 3, v5
v_add_u32 v5, s50, v5
v_max_i32 v5, 0, v5
v_lshlrev_b32 v5, 3, v5
buffer_load_dwordx2 v[34:35], v5, s[20:23], 0 offen sc1
v_add_u32 v5, 128, v1
v_min_u32 v5, 143, v5
v_lshlrev_b32 v22, 3, v5
v_add_u32 v5, s50, v5
v_max_i32 v5, 0, v5
v_lshlrev_b32 v5, 3, v5
buffer_load_dwordx2 v[36:37], v5, s[20:23], 0 offen sc1
s_mov_b32 s62, 4
s_branch Lste_66
Lst4_65:
s_mov_b32 s62, 2
s_branch Lste_66
Lst2_64:
s_waitcnt vmcnt(0)
v_add_u32 v20, 147456, v20
ds_write_b64 v20, v[32:33]
v_add_u32 v21, 147456, v21
ds_write_b64 v21, v[34:35]
v_add_u32 v22, 147456, v22
ds_write_b64 v22, v[36:37]
s_waitcnt lgkmcnt(0)
s_mov_b32 s62, 3
Lste_66:
s_branch Lst_10_0
Lwr_177:
s_barrier
s_cmp_eq_u32 s62, 3
s_cbranch_scc1 Lste_72
s_cmp_eq_u32 s62, 2
s_cbranch_scc1 Lst2_70
s_cmp_ge_u32 s62, 4
s_cbranch_scc1 Lst4_71
s_cmp_eq_u32 s62, 1
s_cbranch_scc1 Lst1_69
s_waitcnt vmcnt(0)
v_readfirstlane_b32 s54, v6
s_cmp_eq_u32 s54, 0
s_cbranch_scc0 Lrep_73
buffer_load_dword v6, v4, s[56:59], 0 offen sc1
s_branch Lste_72
Lrep_73:
s_add_u32 s7, s34, 64
s_lshl_b32 s7, s7, 7
v_mov_b32 v5, s7
v_mov_b32 v6, 1
s_mov_b64 exec, 1
buffer_atomic_add v6, v5, s[84:87], 0 offen sc1
s_mov_b64 exec, -1
s_mov_b32 s62, 1
s_mov_b32 s54, 0
s_mov_b32 s55, 0
s_branch Lste_72
Lst1_69:
s_and_b32 s43, s54, s55
s_cmp_eq_u32 s43, 16
s_cbranch_scc1 Lg_74
s_load_dword s54, s[82:83], s52 glc
s_load_dword s55, s[82:83], s53 glc
s_branch Lste_72
Lg_74:
v_add_u32 v5, 0, v1
v_min_u32 v5, 143, v5
v_lshlrev_b32 v20, 3, v5
v_add_u32 v5, s50, v5
v_max_i32 v5, 0, v5
v_lshlrev_b32 v5, 3, v5
buffer_load_dwordx2 v[32:33], v5, s[20:23], 0 offen sc1
v_add_u32 v5, 64, v1
v_min_u32 v5, 143, v5
v_lshlrev_b32 v21, 3, v5
v_add_u32 v5, s50, v5
v_max_i32 v5, 0, v5
v_lshlrev_b32 v5, 3, v5
buffer_load_dwordx2 v[34:35], v5, s[20:23], 0 offen sc1
v_add_u32 v5, 128, v1
v_min_u32 v5, 143, v5
v_lshlrev_b32 v22, 3, v5
v_add_u32 v5, s50, v5
v_max_i32 v5, 0, v5
v_lshlrev_b32 v5, 3, v5
s_branch Lov_4
.p2align 12
Lst_4_0:
s_branch Lwr_171
s_nop 0
s_nop 0
Lov_4:
buffer_load_dwordx2 v[36:37], v5, s[20:23], 0 offen sc1
s_mov_b32 s62, 4
s_branch Lste_72
Lst4_71:
s_mov_b32 s62, 2
s_branch Lste_72
Lst2_70:
s_waitcnt vmcnt(0)
v_add_u32 v20, 147456, v20
ds_write_b64 v20, v[32:33]
v_add_u32 v21, 147456, v21
ds_write_b64 v21, v[34:35]
v_add_u32 v22, 147456, v22
ds_write_b64 v22, v[36:37]
s_waitcnt lgkmcnt(0)
s_mov_b32 s62, 3
Lste_72:
s_branch Lst_11_0
Lwr_178:
s_barrier
s_cmp_eq_u32 s62, 3
s_cbranch_scc1 Lste_78
s_cmp_eq_u32 s62, 2
s_cbranch_scc1 Lst2_76
s_cmp_ge_u32 s62, 4
s_cbranch_scc1 Lst4_77
s_cmp_eq_u32 s62, 1
s_cbranch_scc1 Lst1_75
s_waitcnt vmcnt(0)
v_readfirstlane_b32 s54, v6
s_cmp_eq_u32 s54, 0
s_cbranch_scc0 Lrep_79
buffer_load_dword v6, v4, s[56:59], 0 offen sc1
s_branch Lste_78
Lrep_79:
s_add_u32 s7, s34, 64
s_lshl_b32 s7, s7, 7
v_mov_b32 v5, s7
v_mov_b32 v6, 1
s_mov_b64 exec, 1
buffer_atomic_add v6, v5, s[84:87], 0 offen sc1
s_mov_b64 exec, -1
s_mov_b32 s62, 1
s_mov_b32 s54, 0
s_mov_b32 s55, 0
s_branch Lste_78
Lst1_75:
s_and_b32 s43, s54, s55
s_cmp_eq_u32 s43, 16
s_cbranch_scc1 Lg_80
s_load_dword s54, s[82:83], s52 glc
s_load_dword s55, s[82:83], s53 glc
s_branch Lste_78
Lg_80:
v_add_u32 v5, 0, v1
v_min_u32 v5, 143, v5
v_lshlrev_b32 v20, 3, v5
v_add_u32 v5, s50, v5
v_max_i32 v5, 0, v5
v_lshlrev_b32 v5, 3, v5
buffer_load_dwordx2 v[32:33], v5, s[20:23], 0 offen sc1
v_add_u32 v5, 64, v1
v_min_u32 v5, 143, v5
v_lshlrev_b32 v21, 3, v5
v_add_u32 v5, s50, v5
v_max_i32 v5, 0, v5
v_lshlrev_b32 v5, 3, v5
buffer_load_dwordx2 v[34:35], v5, s[20:23], 0 offen sc1
v_add_u32 v5, 128, v1
v_min_u32 v5, 143, v5
v_lshlrev_b32 v22, 3, v5
v_add_u32 v5, s50, v5
v_max_i32 v5, 0, v5
v_lshlrev_b32 v5, 3, v5
buffer_load_dwordx2 v[36:37], v5, s[20:23], 0 offen sc1
s_mov_b32 s62, 4
s_branch Lste_78
Lst4_77:
s_mov_b32 s62, 2
s_branch Lste_78
Lst2_76:
s_waitcnt vmcnt(0)
v_add_u32 v20, 147456, v20
ds_write_b64 v20, v[32:33]
v_add_u32 v21, 147456, v21
ds_write_b64 v21, v[34:35]
v_add_u32 v22, 147456, v22
ds_write_b64 v22, v[36:37]
s_waitcnt lgkmcnt(0)
s_mov_b32 s62, 3
Lste_78:
s_branch Lst_12_0
Lwr_179:
s_barrier
s_cmp_eq_u32 s62, 3
s_cbranch_scc1 Lste_84
s_cmp_eq_u32 s62, 2
s_cbranch_scc1 Lst2_82
s_cmp_ge_u32 s62, 4
s_cbranch_scc1 Lst4_83
s_cmp_eq_u32 s62, 1
s_cbranch_scc1 Lst1_81
s_waitcnt vmcnt(0)
v_readfirstlane_b32 s54, v6
s_cmp_eq_u32 s54, 0
s_cbranch_scc0 Lrep_85
buffer_load_dword v6, v4, s[56:59], 0 offen sc1
s_branch Lste_84
Lrep_85:
s_add_u32 s7, s34, 64
s_lshl_b32 s7, s7, 7
v_mov_b32 v5, s7
v_mov_b32 v6, 1
s_mov_b64 exec, 1
buffer_atomic_add v6, v5, s[84:87], 0 offen sc1
s_mov_b64 exec, -1
s_mov_b32 s62, 1
s_mov_b32 s54, 0
s_mov_b32 s55, 0
s_branch Lste_84
Lst1_81:
s_and_b32 s43, s54, s55
s_cmp_eq_u32 s43, 16
s_cbranch_scc1 Lg_86
s_load_dword s54, s[82:83], s52 glc
s_load_dword s55, s[82:83], s53 glc
s_branch Lste_84
Lg_86:
v_add_u32 v5, 0, v1
v_min_u32 v5, 143, v5
v_lshlrev_b32 v20, 3, v5
v_add_u32 v5, s50, v5
v_max_i32 v5, 0, v5
v_lshlrev_b32 v5, 3, v5
buffer_load_dwordx2 v[32:33], v5, s[20:23], 0 offen sc1
v_add_u32 v5, 64, v1
v_min_u32 v5, 143, v5
v_lshlrev_b32 v21, 3, v5
v_add_u32 v5, s50, v5
v_max_i32 v5, 0, v5
v_lshlrev_b32 v5, 3, v5
buffer_load_dwordx2 v[34:35], v5, s[20:23], 0 offen sc1
v_add_u32 v5, 128, v1
v_min_u32 v5, 143, v5
v_lshlrev_b32 v22, 3, v5
v_add_u32 v5, s50, v5
v_max_i32 v5, 0, v5
v_lshlrev_b32 v5, 3, v5
buffer_load_dwordx2 v[36:37], v5, s[20:23], 0 offen sc1
s_mov_b32 s62, 4
s_branch Lste_84
Lst4_83:
s_mov_b32 s62, 2
s_branch Lste_84
Lst2_82:
s_waitcnt vmcnt(0)
v_add_u32 v20, 147456, v20
ds_write_b64 v20, v[32:33]
v_add_u32 v21, 147456, v21
ds_write_b64 v21, v[34:35]
v_add_u32 v22, 147456, v22
ds_write_b64 v22, v[36:37]
s_waitcnt lgkmcnt(0)
s_mov_b32 s62, 3
Lste_84:
s_branch Lst_13_0
Lwr_180:
s_barrier
s_cmp_eq_u32 s62, 3
s_cbranch_scc1 Lste_90
s_cmp_eq_u32 s62, 2
s_cbranch_scc1 Lst2_88
s_cmp_ge_u32 s62, 4
s_cbranch_scc1 Lst4_89
s_cmp_eq_u32 s62, 1
s_cbranch_scc1 Lst1_87
s_waitcnt vmcnt(0)
v_readfirstlane_b32 s54, v6
s_cmp_eq_u32 s54, 0
s_cbranch_scc0 Lrep_91
buffer_load_dword v6, v4, s[56:59], 0 offen sc1
s_branch Lste_90
Lrep_91:
s_add_u32 s7, s34, 64
s_lshl_b32 s7, s7, 7
v_mov_b32 v5, s7
v_mov_b32 v6, 1
s_mov_b64 exec, 1
buffer_atomic_add v6, v5, s[84:87], 0 offen sc1
s_mov_b64 exec, -1
s_mov_b32 s62, 1
s_mov_b32 s54, 0
s_mov_b32 s55, 0
s_branch Lste_90
Lst1_87:
s_and_b32 s43, s54, s55
s_cmp_eq_u32 s43, 16
s_cbranch_scc1 Lg_92
s_load_dword s54, s[82:83], s52 glc
s_load_dword s55, s[82:83], s53 glc
s_branch Lste_90
Lg_92:
v_add_u32 v5, 0, v1
v_min_u32 v5, 143, v5
v_lshlrev_b32 v20, 3, v5
v_add_u32 v5, s50, v5
v_max_i32 v5, 0, v5
v_lshlrev_b32 v5, 3, v5
buffer_load_dwordx2 v[32:33], v5, s[20:23], 0 offen sc1
v_add_u32 v5, 64, v1
v_min_u32 v5, 143, v5
v_lshlrev_b32 v21, 3, v5
v_add_u32 v5, s50, v5
v_max_i32 v5, 0, v5
v_lshlrev_b32 v5, 3, v5
buffer_load_dwordx2 v[34:35], v5, s[20:23], 0 offen sc1
v_add_u32 v5, 128, v1
v_min_u32 v5, 143, v5
v_lshlrev_b32 v22, 3, v5
v_add_u32 v5, s50, v5
v_max_i32 v5, 0, v5
v_lshlrev_b32 v5, 3, v5
buffer_load_dwordx2 v[36:37], v5, s[20:23], 0 offen sc1
s_mov_b32 s62, 4
s_branch Lste_90
Lst4_89:
s_mov_b32 s62, 2
s_branch Lste_90
Lst2_88:
s_waitcnt vmcnt(0)
v_add_u32 v20, 147456, v20
ds_write_b64 v20, v[32:33]
v_add_u32 v21, 147456, v21
ds_write_b64 v21, v[34:35]
v_add_u32 v22, 147456, v22
ds_write_b64 v22, v[36:37]
s_waitcnt lgkmcnt(0)
s_mov_b32 s62, 3
Lste_90:
s_branch Lst_14_0
Lwr_181:
s_barrier
s_cmp_eq_u32 s62, 3
s_cbranch_scc1 Lste_95
s_cmp_ge_u32 s62, 5
s_cbranch_scc1 Lg_100
s_cmp_ge_u32 s62, 2
s_cbranch_scc1 Lst2_94
s_cmp_eq_u32 s62, 1
s_cbranch_scc1 Lst1_93
s_mov_b32 s41, 0x40000
Lz0_96:
s_waitcnt vmcnt(0)
v_readfirstlane_b32 s54, v6
s_cmp_eq_u32 s54, 0
s_cbranch_scc0 Lzok_97
buffer_load_dword v6, v4, s[56:59], 0 offen sc1
s_sub_u32 s41, s41, 1
s_cmp_lg_u32 s41, 0
s_cbranch_scc1 Lz0_96
s_waitcnt lgkmcnt(0)
Lzok_97:
s_add_u32 s7, s34, 64
s_lshl_b32 s7, s7, 7
v_mov_b32 v5, s7
v_mov_b32 v6, 1
s_mov_b64 exec, 1
buffer_atomic_add v6, v5, s[84:87], 0 offen sc1
s_mov_b64 exec, -1
Lst1_93:
s_load_dword s54, s[82:83], s52 glc
s_load_dword s55, s[82:83], s53 glc
s_mov_b32 s41, 200
Lpoll_98:
s_waitcnt lgkmcnt(0)
s_and_b32 s54, s54, s55
s_cmp_eq_u32 s54, 16
s_cbranch_scc1 Lg_100
s_load_dword s54, s[82:83], s52 glc
s_load_dword s55, s[82:83], s53 glc
s_sub_u32 s41, s41, 1
s_cmp_lg_u32 s41, 0
s_cbranch_scc1 Lpoll_98
s_waitcnt lgkmcnt(0)
s_mov_b32 s41, 0
Lfb_99:
s_add_u32 s62, s50, s41
s_max_i32 s62, s62, 0
s_lshl_b32 s43, s62, 11
buffer_load_dwordx4 v[96:99], v10, s[8:11], s43 offen offset:0
buffer_load_dwordx4 v[100:103], v10, s[8:11], s43 offen offset:1024
buffer_load_dwordx4 v[104:107], v10, s[8:11], s43 offen offset:2048
buffer_load_dwordx4 v[108:111], v10, s[8:11], s43 offen offset:3072
s_waitcnt vmcnt(0)
s_mov_b32 s43, 0x3f803f80
v_mov_b32 v116, 0
v_mov_b32 v117, 0
v_mov_b32 v118, 0
v_mov_b32 v119, 0
v_mov_b32 v120, 0
v_mov_b32 v121, 0
v_mov_b32 v122, 0
v_mov_b32 v123, 0
v_dot2_f32_bf16 v116, v96, s43, v116
v_dot2_f32_bf16 v120, v96, v96, v120
v_dot2_f32_bf16 v118, v104, s43, v118
v_dot2_f32_bf16 v122, v104, v104, v122
v_dot2_f32_bf16 v117, v97, s43, v117
v_dot2_f32_bf16 v121, v97, v97, v121
v_dot2_f32_bf16 v119, v105, s43, v119
v_dot2_f32_bf16 v123, v105, v105, v123
v_dot2_f32_bf16 v116, v98, s43, v116
v_dot2_f32_bf16 v120, v98, v98, v120
v_dot2_f32_bf16 v118, v106, s43, v118
v_dot2_f32_bf16 v122, v106, v106, v122
v_dot2_f32_bf16 v117, v99, s43, v117
v_dot2_f32_bf16 v121, v99, v99, v121
v_dot2_f32_bf16 v119, v107, s43, v119
v_dot2_f32_bf16 v123, v107, v107, v123
v_dot2_f32_bf16 v116, v100, s43, v116
v_dot2_f32_bf16 v120, v100, v100, v120
v_dot2_f32_bf16 v118, v108, s43, v118
v_dot2_f32_bf16 v122, v108, v108, v122
v_dot2_f32_bf16 v117, v101, s43, v117
v_dot2_f32_bf16 v121, v101, v101, v121
v_dot2_f32_bf16 v119, v109, s43, v119
v_dot2_f32_bf16 v123, v109, v109, v123
v_dot2_f32_bf16 v116, v102, s43, v116
v_dot2_f32_bf16 v120, v102, v102, v120
v_dot2_f32_bf16 v118, v110, s43, v118
v_dot2_f32_bf16 v122, v110, v110, v122
v_dot2_f32_bf16 v117, v103, s43, v117
v_dot2_f32_bf16 v121, v103, v103, v121
v_dot2_f32_bf16 v119, v111, s43, v119
v_dot2_f32_bf16 v123, v111, v111, v123
s_nop 2
v_add_f32 v116, v116, v117
v_add_f32 v118, v118, v119
v_add_f32 v120, v120, v121
v_add_f32 v122, v122, v123
s_nop 1
v_permlane32_swap_b32 v116, v118
v_permlane32_swap_b32 v120, v122
v_add_f32 v116, v116, v118
v_add_f32 v120, v120, v122
s_nop 1
v_permlane16_swap_b32 v116, v120
v_add_f32 v116, v116, v120
s_nop 1
v_add_f32_dpp v116, v116, v116 row_ror:8 row_mask:0xf bank_mask:0xf
s_nop 1
v_add_f32_dpp v116, v116, v116 row_ror:4 row_mask:0xf bank_mask:0xf
s_nop 1
v_add_f32_dpp v116, v116, v116 row_ror:2 row_mask:0xf bank_mask:0xf
s_nop 1
v_add_f32_dpp v116, v116, v116 row_ror:1 row_mask:0xf bank_mask:0xf
v_mov_b32 v117, v116
s_nop 1
v_permlane16_swap_b32 v116, v117
v_mul_f32 v112, 0x3a800000, v116
v_mul_f32 v113, 0x3a800000, v117
v_fma_f32 v113, -v112, v112, v113
v_max_f32 v113, 0, v113
v_add_f32 v113, 0x3727c5ac, v113
v_rsq_f32 v113, v113
v_lshrrev_b32 v11, 5, v1
s_lshl_b32 s43, s41, 3
s_add_u32 s43, s43, 147456
v_lshl_add_u32 v11, v11, 3, s43
ds_write_b64 v11, v[112:113]
s_add_u32 s41, s41, 2
s_cmp_lt_u32 s41, 144
s_cbranch_scc1 Lfb_99
s_waitcnt lgkmcnt(0)
s_branch Lste_95
Lg_100:
v_add_u32 v5, 0, v1
v_min_u32 v5, 143, v5
v_lshlrev_b32 v20, 3, v5
v_add_u32 v5, s50, v5
v_max_i32 v5, 0, v5
v_lshlrev_b32 v5, 3, v5
buffer_load_dwordx2 v[32:33], v5, s[20:23], 0 offen sc1
v_add_u32 v5, 64, v1
v_min_u32 v5, 143, v5
v_lshlrev_b32 v21, 3, v5
v_add_u32 v5, s50, v5
v_max_i32 v5, 0, v5
v_lshlrev_b32 v5, 3, v5
buffer_load_dwordx2 v[34:35], v5, s[20:23], 0 offen sc1
v_add_u32 v5, 128, v1
v_min_u32 v5, 143, v5
v_lshlrev_b32 v22, 3, v5
v_add_u32 v5, s50, v5
v_max_i32 v5, 0, v5
v_lshlrev_b32 v5, 3, v5
buffer_load_dwordx2 v[36:37], v5, s[20:23], 0 offen sc1
Lst2_94:
s_waitcnt vmcnt(0)
v_add_u32 v20, 147456, v20
ds_write_b64 v20, v[32:33]
v_add_u32 v21, 147456, v21
ds_write_b64 v21, v[34:35]
v_add_u32 v22, 147456, v22
ds_write_b64 v22, v[36:37]
s_waitcnt lgkmcnt(0)
Lste_95:
s_bitcmp0_b32 s2, 0
s_cselect_b32 s88, s72, s74
s_cselect_b32 s89, s73, s75
s_cmp_lt_u32 s2, 192
s_cselect_b32 s90, 7340032, 0
s_mov_b32 s91, 0x20000
s_bfe_u32 s44, s2, 0x30001
s_lshl_b32 s44, s44, 2
s_and_b32 s43, s36, 3
s_add_u32 s44, s44, s43
s_lshl_b32 s44, s44, 5
v_lshrrev_b32 v18, 4, v1
v_add_u32 v18, s44, v18
v_mul_u32_u24 v18, 7168, v18
v_and_b32 v19, 15, v1
v_lshl_add_u32 v18, v19, 4, v18
s_lshr_b32 s43, s2, 4
s_lshl_b32 s43, s43, 8
s_add_u32 s43, s43, 4096
v_add_u32 v18, s43, v18
s_mov_b32 s43, 0
buffer_load_dwordx4 v[128:131], v18, s[88:91], s43 offen
s_mov_b32 s43, 28672
buffer_load_dwordx4 v[132:135], v18, s[88:91], s43 offen
s_mov_b32 s43, 57344
buffer_load_dwordx4 v[136:139], v18, s[88:91], s43 offen
s_mov_b32 s43, 86016
buffer_load_dwordx4 v[140:143], v18, s[88:91], s43 offen
s_mov_b32 s43, 114688
buffer_load_dwordx4 v[144:147], v18, s[88:91], s43 offen
s_mov_b32 s43, 143360
buffer_load_dwordx4 v[148:151], v18, s[88:91], s43 offen
s_mov_b32 s43, 172032
buffer_load_dwordx4 v[152:155], v18, s[88:91], s43 offen
s_mov_b32 s43, 200704
buffer_load_dwordx4 v[156:159], v18, s[88:91], s43 offen
s_barrier
s_lshl_b32 s43, s35, 7
s_add_u32 s28, s68, s43
s_addc_u32 s29, s69, 0
s_mov_b32 s30, 2095232
s_mov_b32 s31, 0x20000
v_lshrrev_b32 v15, 3, v1
v_and_b32 v16, 6, v15
v_and_b32 v7, 7, v1
v_xor_b32 v7, v7, v16
v_lshlrev_b32 v7, 4, v7
v_mul_u32_u24 v15, 2048, v15
v_add_u32 v7, v7, v15
s_and_b32 s40, s36, 3
s_lshl_b32 s39, s40, 13
s_add_u32 s40, s40, s35
s_add_u32 s42, s40, 0
s_and_b32 s42, s42, 15
s_lshl_b32 s42, s42, 17
s_add_u32 m0, s39, 65536
s_add_u32 s43, s42, 0
buffer_load_dwordx4 v7, s[28:31], s43 offen lds
s_add_u32 m0, s39, 66560
s_add_u32 s43, s42, 16384
buffer_load_dwordx4 v7, s[28:31], s43 offen lds
s_add_u32 m0, s39, 67584
s_add_u32 s43, s42, 32768
buffer_load_dwordx4 v7, s[28:31], s43 offen lds
s_add_u32 m0, s39, 68608
s_add_u32 s43, s42, 49152
buffer_load_dwordx4 v7, s[28:31], s43 offen lds
s_add_u32 m0, s39, 69632
s_add_u32 s43, s42, 65536
buffer_load_dwordx4 v7, s[28:31], s43 offen lds
s_add_u32 m0, s39, 70656
s_add_u32 s43, s42, 81920
buffer_load_dwordx4 v7, s[28:31], s43 offen lds
s_add_u32 m0, s39, 71680
s_add_u32 s43, s42, 98304
buffer_load_dwordx4 v7, s[28:31], s43 offen lds
s_add_u32 m0, s39, 72704
s_add_u32 s43, s42, 114688
buffer_load_dwordx4 v7, s[28:31], s43 offen lds
Lats_6:
s_and_b32 s43, s36, 1
s_bfe_u32 s44, s36, 0x10001
s_lshr_b32 s45, s36, 2
v_lshlrev_b32 v14, 2, v13
v_sub_u32 v14, v12, v14
v_mov_b32 v16, 0xff800000
s_or_b32 s46, s34, s45
s_cmp_lg_u32 s46, 0
s_cselect_b32 s46, 0, 0xff800000
v_subrev_u32 v15, 0, v14
v_cmp_ge_u32 vcc, 7, v15
v_add_u32 v15, 16, v15
s_nop 0
v_cndmask_b32 v248, v16, 0, vcc
v_cmp_ge_u32 vcc, 7, v15
s_nop 1
v_cndmask_b32 v244, v16, 0, vcc
v_or_b32 v240, s46, v244
v_subrev_u32 v15, 1, v14
v_cmp_ge_u32 vcc, 7, v15
v_add_u32 v15, 16, v15
s_nop 0
v_cndmask_b32 v249, v16, 0, vcc
v_cmp_ge_u32 vcc, 7, v15
s_nop 1
v_cndmask_b32 v245, v16, 0, vcc
v_or_b32 v241, s46, v245
v_subrev_u32 v15, 2, v14
v_cmp_ge_u32 vcc, 7, v15
v_add_u32 v15, 16, v15
s_nop 0
v_cndmask_b32 v250, v16, 0, vcc
v_cmp_ge_u32 vcc, 7, v15
s_nop 1
v_cndmask_b32 v246, v16, 0, vcc
v_or_b32 v242, s46, v246
v_subrev_u32 v15, 3, v14
v_cmp_ge_u32 vcc, 7, v15
v_add_u32 v15, 16, v15
s_nop 0
v_cndmask_b32 v251, v16, 0, vcc
v_cmp_ge_u32 vcc, 7, v15
s_nop 1
v_cndmask_b32 v247, v16, 0, vcc
v_or_b32 v243, s46, v247
s_lshl_b32 s46, s45, 6
s_add_u32 s46, s46, s44
s_add_u32 s46, s46, 16
v_lshl_add_u32 v14, v12, 1, s46
s_lshl_b32 s47, s43, 6
v_lshl_add_u32 v15, v13, 4, s47
v_mul_u32_u24 v20, 400, v14
v_add_u32 v20, v20, v15
v_subrev_u32 v16, 32, v14
v_max_i32 v16, 0, v16
v_mul_u32_u24 v21, 400, v16
v_add_u32 v21, v21, v15
v_lshrrev_b32 v16, 2, v12
v_lshl_add_u32 v16, v13, 2, v16
v_lshl_add_u32 v16, v16, 1, s46
v_and_b32 v17, 3, v1
v_lshl_add_u32 v17, v17, 3, s47
v_mul_u32_u24 v22, 400, v16
v_add_u32 v22, v22, v17
v_subrev_u32 v16, 32, v16
v_max_i32 v16, 0, v16
v_mul_u32_u24 v23, 400, v16
v_add_u32 v23, v23, v17
s_mul_i32 s60, s34, 262144
s_add_u32 s16, s82, s60
s_addc_u32 s17, s83, 0
s_mov_b32 s18, 262144
s_mov_b32 s19, 0x20000
s_lshl_b32 s60, s35, 14
s_lshl_b32 s43, s43, 13
s_add_u32 s60, s60, s43
s_lshl_b32 s43, s45, 12
s_add_u32 s60, s60, s43
s_lshl_b32 s43, s44, 10
s_add_u32 s60, s60, s43
v_lshlrev_b32 v24, 4, v1
s_mov_b32 s61, 0x3e8293ee
s_lshl_b32 s38, s35, 7
Latt_5:
s_barrier
ds_read_b128 v[32:35], v20 offset:0
ds_read_b128 v[36:39], v20 offset:128
ds_read_b128 v[40:43], v21 offset:128
ds_read_b128 v[80:83], v20 offset:12800
ds_read_b128 v[84:87], v20 offset:12928
ds_read_b128 v[88:91], v20 offset:128
ds_read_b64_tr_b16 v[44:45], v23 offset:256
ds_read_b64_tr_b16 v[46:47], v22 offset:256
ds_read_b64_tr_b16 v[48:49], v23 offset:288
ds_read_b64_tr_b16 v[50:51], v22 offset:288
ds_read_b64_tr_b16 v[92:93], v22 offset:256
ds_read_b64_tr_b16 v[94:95], v22 offset:13056
ds_read_b64_tr_b16 v[96:97], v22 offset:288
ds_read_b64_tr_b16 v[98:99], v22 offset:13088
s_waitcnt lgkmcnt(11)
v_mfma_f32_16x16x32_bf16 v[52:55], v[40:43], v[32:35], v[240:243]
v_mfma_f32_16x16x32_bf16 v[56:59], v[36:39], v[32:35], v[248:251]
s_waitcnt lgkmcnt(8)
v_mfma_f32_16x16x32_bf16 v[100:103], v[88:91], v[80:83], v[244:247]
v_mfma_f32_16x16x32_bf16 v[104:107], v[84:87], v[80:83], v[248:251]
s_nop 4
v_max3_f32 v60, v52, v53, v54
v_max3_f32 v108, v100, v101, v102
v_max3_f32 v61, v55, v56, v57
v_max3_f32 v109, v103, v104, v105
v_max3_f32 v60, v60, v58, v59
v_max3_f32 v108, v108, v106, v107
v_max_f32 v60, v60, v61
v_max_f32 v108, v108, v109
s_nop 0
v_permlane32_swap_b32 v60, v108
v_max_f32 v60, v60, v108
v_mov_b32 v61, v60
s_nop 1
v_permlane16_swap_b32 v60, v61
v_max_f32 v60, v60, v61
v_mul_f32 v60, s61, v60
s_nop 0
v_mov_b32 v108, v60
s_nop 1
v_permlane32_swap_b32 v60, v108
v_fma_f32 v52, v52, s61, -v60
v_fma_f32 v100, v100, s61, -v108
v_fma_f32 v53, v53, s61, -v60
v_fma_f32 v101, v101, s61, -v108
v_fma_f32 v54, v54, s61, -v60
v_fma_f32 v102, v102, s61, -v108
v_fma_f32 v55, v55, s61, -v60
v_fma_f32 v103, v103, s61, -v108
v_fma_f32 v56, v56, s61, -v60
v_fma_f32 v104, v104, s61, -v108
v_fma_f32 v57, v57, s61, -v60
v_fma_f32 v105, v105, s61, -v108
v_fma_f32 v58, v58, s61, -v60
v_fma_f32 v106, v106, s61, -v108
v_fma_f32 v59, v59, s61, -v60
v_fma_f32 v107, v107, s61, -v108
v_exp_f32 v52, v52
v_exp_f32 v100, v100
v_exp_f32 v53, v53
v_exp_f32 v101, v101
v_exp_f32 v54, v54
v_exp_f32 v102, v102
v_exp_f32 v55, v55
v_exp_f32 v103, v103
v_exp_f32 v56, v56
v_exp_f32 v104, v104
v_exp_f32 v57, v57
v_exp_f32 v105, v105
v_exp_f32 v58, v58
v_exp_f32 v106, v106
v_exp_f32 v59, v59
v_exp_f32 v107, v107
v_cvt_pk_bf16_f32 v64, v52, v53
v_cvt_pk_bf16_f32 v112, v100, v101
v_cvt_pk_bf16_f32 v65, v54, v55
v_cvt_pk_bf16_f32 v113, v102, v103
v_cvt_pk_bf16_f32 v66, v56, v57
v_cvt_pk_bf16_f32 v114, v104, v105
v_cvt_pk_bf16_f32 v67, v58, v59
v_cvt_pk_bf16_f32 v115, v106, v107
v_pk_add_f32 v[52:53], v[52:53], v[54:55]
v_pk_add_f32 v[100:101], v[100:101], v[102:103]
v_pk_add_f32 v[56:57], v[56:57], v[58:59]
v_pk_add_f32 v[104:105], v[104:105], v[106:107]
s_waitcnt lgkmcnt(0)
s_waitcnt lgkmcnt(0)
v_mfma_f32_16x16x32_bf16 v[68:71], v[44:47], v[64:67], 0
v_mfma_f32_16x16x32_bf16 v[116:119], v[92:95], v[112:115], 0
v_mfma_f32_16x16x32_bf16 v[72:75], v[48:51], v[64:67], 0
v_mfma_f32_16x16x32_bf16 v[120:123], v[96:99], v[112:115], 0
v_pk_add_f32 v[52:53], v[52:53], v[56:57]
v_pk_add_f32 v[100:101], v[100:101], v[104:105]
v_add_f32 v60, v52, v53
v_add_f32 v108, v100, v101
s_nop 0
v_permlane32_swap_b32 v60, v108
v_add_f32 v60, v60, v108
v_mov_b32 v61, v60
s_nop 1
v_permlane16_swap_b32 v60, v61
v_add_f32 v60, v60, v61
v_rcp_f32 v60, v60
s_nop 0
v_mov_b32 v108, v60
s_nop 1
v_permlane32_swap_b32 v60, v108
v_pk_mul_f32 v[68:69], v[60:61], v[68:69] op_sel_hi:[0,1]
v_pk_mul_f32 v[116:117], v[108:109], v[116:117] op_sel_hi:[0,1]
v_pk_mul_f32 v[70:71], v[60:61], v[70:71] op_sel_hi:[0,1]
v_pk_mul_f32 v[118:119], v[108:109], v[118:119] op_sel_hi:[0,1]
v_pk_mul_f32 v[72:73], v[60:61], v[72:73] op_sel_hi:[0,1]
v_pk_mul_f32 v[120:121], v[108:109], v[120:121] op_sel_hi:[0,1]
v_pk_mul_f32 v[74:75], v[60:61], v[74:75] op_sel_hi:[0,1]
v_pk_mul_f32 v[122:123], v[108:109], v[122:123] op_sel_hi:[0,1]
v_cvt_pk_bf16_f32 v64, v68, v69
v_cvt_pk_bf16_f32 v112, v116, v117
v_cvt_pk_bf16_f32 v65, v70, v71
v_cvt_pk_bf16_f32 v113, v118, v119
v_cvt_pk_bf16_f32 v66, v72, v73
v_cvt_pk_bf16_f32 v114, v120, v121
v_cvt_pk_bf16_f32 v67, v74, v75
v_cvt_pk_bf16_f32 v115, v122, v123
buffer_store_dwordx4 v[64:67], v24, s[16:19], s60 offen offset:0 sc1
buffer_store_dwordx4 v[112:115], v24, s[16:19], s60 offen offset:2048 sc1
s_add_u32 s56, s82, 28311552
s_addc_u32 s57, s83, 0
s_mov_b32 s58, 114688
s_mov_b32 s59, 0x20000
s_lshl_b32 s7, s34, 12
s_add_u32 s7, s7, 49152
v_lshl_add_u32 v26, v1, 8, s7
v_mov_b32 v27, 1
s_cmp_ge_u32 s36, 4
s_cbranch_scc1 Lh_102
s_waitcnt vmcnt(0)
s_branch Lo_101
Lh_102:
s_waitcnt vmcnt(0)
Lo_101:
s_cmp_lg_u32 s36, 0
s_barrier
s_cbranch_scc1 Lsig_103
s_mov_b64 exec, 0xffff
buffer_atomic_add v27, v26, s[56:59], 0 offen sc1
s_mov_b64 exec, -1
Lsig_103:
s_cmp_ge_u32 s36, 4
s_cbranch_scc1 Lprod_105
v_and_b32 v12, 15, v1
v_lshrrev_b32 v13, 4, v1
v_lshlrev_b32 v10, 12, v12
v_and_b32 v14, 1, v13
v_lshl_add_u32 v10, v14, 5, v10
v_lshrrev_b32 v14, 1, v13
v_lshl_add_u32 v10, v14, 4, v10
s_lshl_b32 s43, s34, 18
s_lshl_b32 s44, s36, 16
s_add_u32 s43, s43, s44
s_lshl_b32 s44, s35, 7
s_add_u32 s43, s43, s44
buffer_load_dwordx4 v[128:131], v10, s[8:11], s43 offen offset:0
buffer_load_dwordx4 v[132:135], v10, s[8:11], s43 offen offset:64
buffer_load_dwordx4 v[136:139], v10, s[8:11], s43 offen offset:2048
buffer_load_dwordx4 v[140:143], v10, s[8:11], s43 offen offset:2112
v_and_b32 v12, 15, v1
v_lshrrev_b32 v13, 4, v1
s_mul_i32 s43, s34, 262144
s_add_u32 s20, s82, s43
s_addc_u32 s21, s83, 0
s_add_u32 s20, s20, 4194304
s_addc_u32 s21, s21, 0
s_mov_b32 s22, 262144
s_mov_b32 s23, 0x20000
s_mul_i32 s43, s34, 16384
s_add_u32 s24, s82, s43
s_addc_u32 s25, s83, 0
s_add_u32 s24, s24, 25165824
s_addc_u32 s25, s25, 0
s_mov_b32 s26, 16384
s_mov_b32 s27, 0x20000
v_lshlrev_b32 v11, 4, v1
s_lshl_b32 s43, s36, 11
v_add_u32 v2, s43, v11
v_add_u32 v3, 98304, v2
v_lshrrev_b32 v14, 2, v1
v_bfe_u32 v15, v14, 1, 2
s_branch Lov_5
.p2align 12
Lst_5_0:
s_branch Lwr_172
s_nop 0
s_nop 0
Lov_5:
v_mul_u32_u24 v14, 128, v14
v_lshl_add_u32 v14, v15, 5, v14
v_and_b32 v15, 3, v1
v_lshl_add_u32 v4, v15, 3, v14
v_xor_b32 v5, 32, v4
v_xor_b32 v6, 64, v4
v_xor_b32 v7, 96, v4
v_add_u32 v16, 0x10000, v4
v_add_u32 v20, 0x20000, v4
v_add_u32 v17, 0x10000, v5
v_add_u32 v21, 0x20000, v5
v_add_u32 v18, 0x10000, v6
v_add_u32 v22, 0x20000, v6
v_add_u32 v19, 0x10000, v7
v_add_u32 v23, 0x20000, v7
s_lshl_b32 s44, s35, 14
s_add_u32 s60, s44, s43
v_lshrrev_b32 v14, 1, v13
v_lshlrev_b32 v14, 11, v14
v_lshl_add_u32 v14, v12, 3, v14
v_and_b32 v15, 1, v13
v_lshl_add_u32 v14, v15, 2, v14
s_lshl_b32 s43, s36, 12
s_lshl_b32 s44, s35, 7
s_add_u32 s43, s43, s44
v_add_u32 v9, s43, v14
s_mov_b32 s61, 0x3f803f80
s_waitcnt vmcnt(0)
v_permlane16_swap_b32 v128, v130
v_permlane16_swap_b32 v129, v131
v_permlane16_swap_b32 v132, v134
v_permlane16_swap_b32 v133, v135
v_permlane16_swap_b32 v136, v138
v_permlane16_swap_b32 v137, v139
v_permlane16_swap_b32 v140, v142
v_permlane16_swap_b32 v141, v143
v_lshlrev_b32 v96, 16, v128
v_and_b32 v97, 0xffff0000, v128
v_lshlrev_b32 v98, 16, v129
v_and_b32 v99, 0xffff0000, v129
v_lshlrev_b32 v100, 16, v130
v_and_b32 v101, 0xffff0000, v130
v_lshlrev_b32 v102, 16, v131
v_and_b32 v103, 0xffff0000, v131
v_lshlrev_b32 v104, 16, v132
v_and_b32 v105, 0xffff0000, v132
v_lshlrev_b32 v106, 16, v133
v_and_b32 v107, 0xffff0000, v133
v_lshlrev_b32 v108, 16, v134
v_and_b32 v109, 0xffff0000, v134
v_lshlrev_b32 v110, 16, v135
v_and_b32 v111, 0xffff0000, v135
v_lshlrev_b32 v112, 16, v136
v_and_b32 v113, 0xffff0000, v136
v_lshlrev_b32 v114, 16, v137
v_and_b32 v115, 0xffff0000, v137
v_lshlrev_b32 v116, 16, v138
v_and_b32 v117, 0xffff0000, v138
v_lshlrev_b32 v118, 16, v139
v_and_b32 v119, 0xffff0000, v139
v_lshlrev_b32 v120, 16, v140
v_and_b32 v121, 0xffff0000, v140
v_lshlrev_b32 v122, 16, v141
v_and_b32 v123, 0xffff0000, v141
v_lshlrev_b32 v124, 16, v142
v_and_b32 v125, 0xffff0000, v142
v_lshlrev_b32 v126, 16, v143
v_and_b32 v127, 0xffff0000, v143
s_cmp_lg_u32 s36, 0
s_cbranch_scc1 Lwm_108
s_nop 0
s_branch Lwe_107
Lwm_108:
s_cmp_lg_u32 s36, 1
s_cbranch_scc1 Lwm_109
s_nop 0
s_branch Lwe_107
Lwm_109:
s_cmp_lg_u32 s36, 2
s_cbranch_scc1 Lwm_110
s_nop 0
s_branch Lwe_107
Lwm_110:
s_cmp_lg_u32 s36, 3
s_cbranch_scc1 Lwm_111
s_nop 0
s_branch Lwe_107
Lwm_111:
Lwe_107:
s_barrier
ds_read_b128 v[32:35], v2 offset:0
ds_read_b64_tr_b16 v[40:41], v16 offset:0
ds_read_b64_tr_b16 v[42:43], v16 offset:2048
ds_read_b64_tr_b16 v[44:45], v17 offset:0
ds_read_b64_tr_b16 v[46:47], v17 offset:2048
ds_read_b64_tr_b16 v[48:49], v18 offset:0
ds_read_b64_tr_b16 v[50:51], v18 offset:2048
ds_read_b64_tr_b16 v[52:53], v19 offset:0
ds_read_b64_tr_b16 v[54:55], v19 offset:2048
ds_read_b128 v[36:39], v2 offset:1024
ds_read_b128 v[56:59], v2 offset:8192
ds_read_b64_tr_b16 v[64:65], v16 offset:4096
ds_read_b64_tr_b16 v[66:67], v16 offset:6144
ds_read_b64_tr_b16 v[68:69], v17 offset:4096
ds_read_b64_tr_b16 v[70:71], v17 offset:6144
ds_read_b64_tr_b16 v[72:73], v18 offset:4096
ds_read_b64_tr_b16 v[74:75], v18 offset:6144
ds_read_b64_tr_b16 v[76:77], v19 offset:4096
ds_read_b64_tr_b16 v[78:79], v19 offset:6144
ds_read_b128 v[60:63], v2 offset:9216
s_waitcnt lgkmcnt(0)
s_barrier
v_mfma_f32_16x16x32_bf16 v[96:99], v[40:43], v[32:35], v[96:99]
ds_read_b128 v[144:147], v2 offset:49152
ds_read_b64_tr_b16 v[152:153], v16 offset:8192
v_mfma_f32_16x16x32_bf16 v[100:103], v[44:47], v[32:35], v[100:103]
ds_read_b64_tr_b16 v[154:155], v16 offset:10240
ds_read_b64_tr_b16 v[156:157], v17 offset:8192
v_mfma_f32_16x16x32_bf16 v[104:107], v[48:51], v[32:35], v[104:107]
ds_read_b64_tr_b16 v[158:159], v17 offset:10240
ds_read_b64_tr_b16 v[160:161], v18 offset:8192
v_mfma_f32_16x16x32_bf16 v[108:111], v[52:55], v[32:35], v[108:111]
ds_read_b64_tr_b16 v[162:163], v18 offset:10240
ds_read_b64_tr_b16 v[164:165], v19 offset:8192
v_mfma_f32_16x16x32_bf16 v[124:127], v[52:55], v[36:39], v[124:127]
ds_read_b64_tr_b16 v[166:167], v19 offset:10240
ds_read_b128 v[148:151], v2 offset:50176
v_mfma_f32_16x16x32_bf16 v[120:123], v[48:51], v[36:39], v[120:123]
ds_read_b128 v[168:171], v2 offset:57344
ds_read_b64_tr_b16 v[176:177], v16 offset:12288
v_mfma_f32_16x16x32_bf16 v[116:119], v[44:47], v[36:39], v[116:119]
ds_read_b64_tr_b16 v[178:179], v16 offset:14336
ds_read_b64_tr_b16 v[180:181], v17 offset:12288
v_mfma_f32_16x16x32_bf16 v[112:115], v[40:43], v[36:39], v[112:115]
ds_read_b64_tr_b16 v[182:183], v17 offset:14336
ds_read_b64_tr_b16 v[184:185], v18 offset:12288
v_mfma_f32_16x16x32_bf16 v[96:99], v[64:67], v[56:59], v[96:99]
ds_read_b64_tr_b16 v[186:187], v18 offset:14336
ds_read_b64_tr_b16 v[188:189], v19 offset:12288
v_mfma_f32_16x16x32_bf16 v[100:103], v[68:71], v[56:59], v[100:103]
ds_read_b64_tr_b16 v[190:191], v19 offset:14336
ds_read_b128 v[172:175], v2 offset:58368
v_mfma_f32_16x16x32_bf16 v[104:107], v[72:75], v[56:59], v[104:107]
s_bitcmp0_b32 s36, 1
v_mfma_f32_16x16x32_bf16 v[108:111], v[76:79], v[56:59], v[108:111]
s_cselect_b32 s44, s72, s74
v_mfma_f32_16x16x32_bf16 v[124:127], v[76:79], v[60:63], v[124:127]
s_cselect_b32 s45, s73, s75
v_mfma_f32_16x16x32_bf16 v[120:123], v[72:75], v[60:63], v[120:123]
s_mul_i32 s43, s35, 192
v_mfma_f32_16x16x32_bf16 v[116:119], v[68:71], v[60:63], v[116:119]
s_add_u32 s16, s44, s43
v_mfma_f32_16x16x32_bf16 v[112:115], v[64:67], v[60:63], v[112:115]
s_addc_u32 s17, s45, 0
s_waitcnt lgkmcnt(0)
s_barrier
v_mfma_f32_16x16x32_bf16 v[96:99], v[152:155], v[144:147], v[96:99]
ds_read_b128 v[32:35], v3 offset:0
ds_read_b64_tr_b16 v[40:41], v16 offset:16384
v_mfma_f32_16x16x32_bf16 v[100:103], v[156:159], v[144:147], v[100:103]
ds_read_b64_tr_b16 v[42:43], v16 offset:18432
ds_read_b64_tr_b16 v[44:45], v17 offset:16384
v_mfma_f32_16x16x32_bf16 v[104:107], v[160:163], v[144:147], v[104:107]
ds_read_b64_tr_b16 v[46:47], v17 offset:18432
ds_read_b64_tr_b16 v[48:49], v18 offset:16384
v_mfma_f32_16x16x32_bf16 v[108:111], v[164:167], v[144:147], v[108:111]
ds_read_b64_tr_b16 v[50:51], v18 offset:18432
ds_read_b64_tr_b16 v[52:53], v19 offset:16384
v_mfma_f32_16x16x32_bf16 v[124:127], v[164:167], v[148:151], v[124:127]
ds_read_b64_tr_b16 v[54:55], v19 offset:18432
ds_read_b128 v[36:39], v3 offset:1024
v_mfma_f32_16x16x32_bf16 v[120:123], v[160:163], v[148:151], v[120:123]
ds_read_b128 v[56:59], v3 offset:8192
ds_read_b64_tr_b16 v[64:65], v16 offset:20480
v_mfma_f32_16x16x32_bf16 v[116:119], v[156:159], v[148:151], v[116:119]
ds_read_b64_tr_b16 v[66:67], v16 offset:22528
ds_read_b64_tr_b16 v[68:69], v17 offset:20480
v_mfma_f32_16x16x32_bf16 v[112:115], v[152:155], v[148:151], v[112:115]
ds_read_b64_tr_b16 v[70:71], v17 offset:22528
ds_read_b64_tr_b16 v[72:73], v18 offset:20480
v_mfma_f32_16x16x32_bf16 v[96:99], v[176:179], v[168:171], v[96:99]
ds_read_b64_tr_b16 v[74:75], v18 offset:22528
ds_read_b64_tr_b16 v[76:77], v19 offset:20480
v_mfma_f32_16x16x32_bf16 v[100:103], v[180:183], v[168:171], v[100:103]
ds_read_b64_tr_b16 v[78:79], v19 offset:22528
ds_read_b128 v[60:63], v3 offset:9216
v_mfma_f32_16x16x32_bf16 v[104:107], v[184:187], v[168:171], v[104:107]
s_add_u32 s16, s16, 4096
v_mfma_f32_16x16x32_bf16 v[108:111], v[188:191], v[168:171], v[108:111]
s_addc_u32 s17, s17, 0
v_mfma_f32_16x16x32_bf16 v[124:127], v[188:191], v[172:175], v[124:127]
s_mov_b32 s18, 7333056
v_mfma_f32_16x16x32_bf16 v[120:123], v[184:187], v[172:175], v[120:123]
s_mov_b32 s19, 0x20000
v_mfma_f32_16x16x32_bf16 v[116:119], v[180:183], v[172:175], v[116:119]
v_add_u32 v196, 0, v1
v_mfma_f32_16x16x32_bf16 v[112:115], v[176:179], v[172:175], v[112:115]
v_mul_u32_u24 v197, 5462, v196
s_waitcnt lgkmcnt(0)
s_barrier
v_mfma_f32_16x16x32_bf16 v[96:99], v[40:43], v[32:35], v[96:99]
ds_read_b128 v[144:147], v3 offset:49152
ds_read_b64_tr_b16 v[152:153], v16 offset:24576
v_mfma_f32_16x16x32_bf16 v[100:103], v[44:47], v[32:35], v[100:103]
ds_read_b64_tr_b16 v[154:155], v16 offset:26624
ds_read_b64_tr_b16 v[156:157], v17 offset:24576
v_mfma_f32_16x16x32_bf16 v[104:107], v[48:51], v[32:35], v[104:107]
ds_read_b64_tr_b16 v[158:159], v17 offset:26624
ds_read_b64_tr_b16 v[160:161], v18 offset:24576
v_mfma_f32_16x16x32_bf16 v[108:111], v[52:55], v[32:35], v[108:111]
ds_read_b64_tr_b16 v[162:163], v18 offset:26624
ds_read_b64_tr_b16 v[164:165], v19 offset:24576
v_mfma_f32_16x16x32_bf16 v[124:127], v[52:55], v[36:39], v[124:127]
ds_read_b64_tr_b16 v[166:167], v19 offset:26624
ds_read_b128 v[148:151], v3 offset:50176
v_mfma_f32_16x16x32_bf16 v[120:123], v[48:51], v[36:39], v[120:123]
ds_read_b128 v[168:171], v3 offset:57344
ds_read_b64_tr_b16 v[176:177], v16 offset:28672
v_mfma_f32_16x16x32_bf16 v[116:119], v[44:47], v[36:39], v[116:119]
ds_read_b64_tr_b16 v[178:179], v16 offset:30720
ds_read_b64_tr_b16 v[180:181], v17 offset:28672
v_mfma_f32_16x16x32_bf16 v[112:115], v[40:43], v[36:39], v[112:115]
ds_read_b64_tr_b16 v[182:183], v17 offset:30720
ds_read_b64_tr_b16 v[184:185], v18 offset:28672
v_mfma_f32_16x16x32_bf16 v[96:99], v[64:67], v[56:59], v[96:99]
ds_read_b64_tr_b16 v[186:187], v18 offset:30720
ds_read_b64_tr_b16 v[188:189], v19 offset:28672
v_mfma_f32_16x16x32_bf16 v[100:103], v[68:71], v[56:59], v[100:103]
ds_read_b64_tr_b16 v[190:191], v19 offset:30720
ds_read_b128 v[172:175], v3 offset:58368
v_mfma_f32_16x16x32_bf16 v[104:107], v[72:75], v[56:59], v[104:107]
v_lshrrev_b32 v197, 16, v197
v_mfma_f32_16x16x32_bf16 v[108:111], v[76:79], v[56:59], v[108:111]
v_mul_u32_u24 v198, 12, v197
v_mfma_f32_16x16x32_bf16 v[124:127], v[76:79], v[60:63], v[124:127]
v_sub_u32 v198, v196, v198
v_mfma_f32_16x16x32_bf16 v[120:123], v[72:75], v[60:63], v[120:123]
v_bfe_u32 v199, v197, 2, 1
v_mfma_f32_16x16x32_bf16 v[116:119], v[68:71], v[60:63], v[116:119]
v_cmp_gt_u32 vcc, 8, v198
v_mfma_f32_16x16x32_bf16 v[112:115], v[64:67], v[60:63], v[112:115]
v_lshlrev_b32 v200, 1, v199
s_waitcnt lgkmcnt(0)
s_barrier
v_mfma_f32_16x16x32_bf16 v[96:99], v[152:155], v[144:147], v[96:99]
ds_read_b128 v[32:35], v2 offset:0
ds_read_b64_tr_b16 v[40:41], v16 offset:49152
v_mfma_f32_16x16x32_bf16 v[100:103], v[156:159], v[144:147], v[100:103]
ds_read_b64_tr_b16 v[42:43], v16 offset:51200
ds_read_b64_tr_b16 v[44:45], v17 offset:49152
v_mfma_f32_16x16x32_bf16 v[104:107], v[160:163], v[144:147], v[104:107]
ds_read_b64_tr_b16 v[46:47], v17 offset:51200
ds_read_b64_tr_b16 v[48:49], v18 offset:49152
v_mfma_f32_16x16x32_bf16 v[108:111], v[164:167], v[144:147], v[108:111]
ds_read_b64_tr_b16 v[50:51], v18 offset:51200
ds_read_b64_tr_b16 v[52:53], v19 offset:49152
v_mfma_f32_16x16x32_bf16 v[124:127], v[164:167], v[148:151], v[124:127]
ds_read_b64_tr_b16 v[54:55], v19 offset:51200
ds_read_b128 v[36:39], v2 offset:1024
v_mfma_f32_16x16x32_bf16 v[120:123], v[160:163], v[148:151], v[120:123]
ds_read_b128 v[56:59], v2 offset:8192
ds_read_b64_tr_b16 v[64:65], v16 offset:53248
v_mfma_f32_16x16x32_bf16 v[116:119], v[156:159], v[148:151], v[116:119]
ds_read_b64_tr_b16 v[66:67], v16 offset:55296
ds_read_b64_tr_b16 v[68:69], v17 offset:53248
v_mfma_f32_16x16x32_bf16 v[112:115], v[152:155], v[148:151], v[112:115]
ds_read_b64_tr_b16 v[70:71], v17 offset:55296
ds_read_b64_tr_b16 v[72:73], v18 offset:53248
v_mfma_f32_16x16x32_bf16 v[96:99], v[176:179], v[168:171], v[96:99]
ds_read_b64_tr_b16 v[74:75], v18 offset:55296
ds_read_b64_tr_b16 v[76:77], v19 offset:53248
v_mfma_f32_16x16x32_bf16 v[100:103], v[180:183], v[168:171], v[100:103]
ds_read_b64_tr_b16 v[78:79], v19 offset:55296
ds_read_b128 v[60:63], v2 offset:9216
v_mfma_f32_16x16x32_bf16 v[104:107], v[184:187], v[168:171], v[104:107]
v_mul_u32_u24 v197, 7168, v197
v_mfma_f32_16x16x32_bf16 v[108:111], v[188:191], v[168:171], v[108:111]
v_cndmask_b32 v199, v199, v200, vcc
v_mfma_f32_16x16x32_bf16 v[124:127], v[188:191], v[172:175], v[124:127]
v_xor_b32 v198, v198, v199
v_mfma_f32_16x16x32_bf16 v[120:123], v[184:187], v[172:175], v[120:123]
v_lshl_add_u32 v192, v198, 4, v197
v_mfma_f32_16x16x32_bf16 v[116:119], v[180:183], v[172:175], v[116:119]
v_add_u32 v196, 64, v1
v_mfma_f32_16x16x32_bf16 v[112:115], v[176:179], v[172:175], v[112:115]
v_mul_u32_u24 v197, 5462, v196
s_waitcnt lgkmcnt(0)
s_barrier
v_mfma_f32_16x16x32_bf16 v[96:99], v[40:43], v[32:35], v[96:99]
ds_read_b128 v[144:147], v2 offset:49152
ds_read_b64_tr_b16 v[152:153], v16 offset:57344
v_mfma_f32_16x16x32_bf16 v[100:103], v[44:47], v[32:35], v[100:103]
ds_read_b64_tr_b16 v[154:155], v16 offset:59392
ds_read_b64_tr_b16 v[156:157], v17 offset:57344
v_mfma_f32_16x16x32_bf16 v[104:107], v[48:51], v[32:35], v[104:107]
ds_read_b64_tr_b16 v[158:159], v17 offset:59392
ds_read_b64_tr_b16 v[160:161], v18 offset:57344
v_mfma_f32_16x16x32_bf16 v[108:111], v[52:55], v[32:35], v[108:111]
ds_read_b64_tr_b16 v[162:163], v18 offset:59392
ds_read_b64_tr_b16 v[164:165], v19 offset:57344
v_mfma_f32_16x16x32_bf16 v[124:127], v[52:55], v[36:39], v[124:127]
ds_read_b64_tr_b16 v[166:167], v19 offset:59392
ds_read_b128 v[148:151], v2 offset:50176
v_mfma_f32_16x16x32_bf16 v[120:123], v[48:51], v[36:39], v[120:123]
ds_read_b128 v[168:171], v2 offset:57344
ds_read_b64_tr_b16 v[176:177], v16 offset:61440
v_mfma_f32_16x16x32_bf16 v[116:119], v[44:47], v[36:39], v[116:119]
ds_read_b64_tr_b16 v[178:179], v16 offset:63488
ds_read_b64_tr_b16 v[180:181], v17 offset:61440
v_mfma_f32_16x16x32_bf16 v[112:115], v[40:43], v[36:39], v[112:115]
ds_read_b64_tr_b16 v[182:183], v17 offset:63488
ds_read_b64_tr_b16 v[184:185], v18 offset:61440
v_mfma_f32_16x16x32_bf16 v[96:99], v[64:67], v[56:59], v[96:99]
ds_read_b64_tr_b16 v[186:187], v18 offset:63488
ds_read_b64_tr_b16 v[188:189], v19 offset:61440
v_mfma_f32_16x16x32_bf16 v[100:103], v[68:71], v[56:59], v[100:103]
ds_read_b64_tr_b16 v[190:191], v19 offset:63488
ds_read_b128 v[172:175], v2 offset:58368
v_mfma_f32_16x16x32_bf16 v[104:107], v[72:75], v[56:59], v[104:107]
v_lshrrev_b32 v197, 16, v197
v_mfma_f32_16x16x32_bf16 v[108:111], v[76:79], v[56:59], v[108:111]
v_mul_u32_u24 v198, 12, v197
v_mfma_f32_16x16x32_bf16 v[124:127], v[76:79], v[60:63], v[124:127]
v_sub_u32 v198, v196, v198
v_mfma_f32_16x16x32_bf16 v[120:123], v[72:75], v[60:63], v[120:123]
v_bfe_u32 v199, v197, 2, 1
v_mfma_f32_16x16x32_bf16 v[116:119], v[68:71], v[60:63], v[116:119]
v_cmp_gt_u32 vcc, 8, v198
v_mfma_f32_16x16x32_bf16 v[112:115], v[64:67], v[60:63], v[112:115]
v_lshlrev_b32 v200, 1, v199
s_waitcnt lgkmcnt(0)
s_barrier
v_mfma_f32_16x16x32_bf16 v[96:99], v[152:155], v[144:147], v[96:99]
ds_read_b128 v[32:35], v3 offset:0
ds_read_b64_tr_b16 v[40:41], v20 offset:0
v_mfma_f32_16x16x32_bf16 v[100:103], v[156:159], v[144:147], v[100:103]
ds_read_b64_tr_b16 v[42:43], v20 offset:2048
ds_read_b64_tr_b16 v[44:45], v21 offset:0
v_mfma_f32_16x16x32_bf16 v[104:107], v[160:163], v[144:147], v[104:107]
ds_read_b64_tr_b16 v[46:47], v21 offset:2048
ds_read_b64_tr_b16 v[48:49], v22 offset:0
v_mfma_f32_16x16x32_bf16 v[108:111], v[164:167], v[144:147], v[108:111]
ds_read_b64_tr_b16 v[50:51], v22 offset:2048
ds_read_b64_tr_b16 v[52:53], v23 offset:0
v_mfma_f32_16x16x32_bf16 v[124:127], v[164:167], v[148:151], v[124:127]
ds_read_b64_tr_b16 v[54:55], v23 offset:2048
ds_read_b128 v[36:39], v3 offset:1024
v_mfma_f32_16x16x32_bf16 v[120:123], v[160:163], v[148:151], v[120:123]
ds_read_b128 v[56:59], v3 offset:8192
ds_read_b64_tr_b16 v[64:65], v20 offset:4096
v_mfma_f32_16x16x32_bf16 v[116:119], v[156:159], v[148:151], v[116:119]
ds_read_b64_tr_b16 v[66:67], v20 offset:6144
ds_read_b64_tr_b16 v[68:69], v21 offset:4096
v_mfma_f32_16x16x32_bf16 v[112:115], v[152:155], v[148:151], v[112:115]
ds_read_b64_tr_b16 v[70:71], v21 offset:6144
ds_read_b64_tr_b16 v[72:73], v22 offset:4096
v_mfma_f32_16x16x32_bf16 v[96:99], v[176:179], v[168:171], v[96:99]
ds_read_b64_tr_b16 v[74:75], v22 offset:6144
ds_read_b64_tr_b16 v[76:77], v23 offset:4096
v_mfma_f32_16x16x32_bf16 v[100:103], v[180:183], v[168:171], v[100:103]
ds_read_b64_tr_b16 v[78:79], v23 offset:6144
ds_read_b128 v[60:63], v3 offset:9216
v_mfma_f32_16x16x32_bf16 v[104:107], v[184:187], v[168:171], v[104:107]
v_mul_u32_u24 v197, 7168, v197
v_mfma_f32_16x16x32_bf16 v[108:111], v[188:191], v[168:171], v[108:111]
v_cndmask_b32 v199, v199, v200, vcc
v_mfma_f32_16x16x32_bf16 v[124:127], v[188:191], v[172:175], v[124:127]
v_xor_b32 v198, v198, v199
v_mfma_f32_16x16x32_bf16 v[120:123], v[184:187], v[172:175], v[120:123]
v_lshl_add_u32 v193, v198, 4, v197
v_mfma_f32_16x16x32_bf16 v[116:119], v[180:183], v[172:175], v[116:119]
v_add_u32 v196, 128, v1
v_mfma_f32_16x16x32_bf16 v[112:115], v[176:179], v[172:175], v[112:115]
v_mul_u32_u24 v197, 5462, v196
s_waitcnt lgkmcnt(0)
s_barrier
v_mfma_f32_16x16x32_bf16 v[96:99], v[40:43], v[32:35], v[96:99]
ds_read_b128 v[144:147], v3 offset:49152
ds_read_b64_tr_b16 v[152:153], v20 offset:8192
v_mfma_f32_16x16x32_bf16 v[100:103], v[44:47], v[32:35], v[100:103]
ds_read_b64_tr_b16 v[154:155], v20 offset:10240
ds_read_b64_tr_b16 v[156:157], v21 offset:8192
v_mfma_f32_16x16x32_bf16 v[104:107], v[48:51], v[32:35], v[104:107]
ds_read_b64_tr_b16 v[158:159], v21 offset:10240
ds_read_b64_tr_b16 v[160:161], v22 offset:8192
v_mfma_f32_16x16x32_bf16 v[108:111], v[52:55], v[32:35], v[108:111]
ds_read_b64_tr_b16 v[162:163], v22 offset:10240
ds_read_b64_tr_b16 v[164:165], v23 offset:8192
v_mfma_f32_16x16x32_bf16 v[124:127], v[52:55], v[36:39], v[124:127]
ds_read_b64_tr_b16 v[166:167], v23 offset:10240
ds_read_b128 v[148:151], v3 offset:50176
v_mfma_f32_16x16x32_bf16 v[120:123], v[48:51], v[36:39], v[120:123]
ds_read_b128 v[168:171], v3 offset:57344
ds_read_b64_tr_b16 v[176:177], v20 offset:12288
v_mfma_f32_16x16x32_bf16 v[116:119], v[44:47], v[36:39], v[116:119]
ds_read_b64_tr_b16 v[178:179], v20 offset:14336
ds_read_b64_tr_b16 v[180:181], v21 offset:12288
v_mfma_f32_16x16x32_bf16 v[112:115], v[40:43], v[36:39], v[112:115]
ds_read_b64_tr_b16 v[182:183], v21 offset:14336
ds_read_b64_tr_b16 v[184:185], v22 offset:12288
v_mfma_f32_16x16x32_bf16 v[96:99], v[64:67], v[56:59], v[96:99]
ds_read_b64_tr_b16 v[186:187], v22 offset:14336
ds_read_b64_tr_b16 v[188:189], v23 offset:12288
v_mfma_f32_16x16x32_bf16 v[100:103], v[68:71], v[56:59], v[100:103]
ds_read_b64_tr_b16 v[190:191], v23 offset:14336
ds_read_b128 v[172:175], v3 offset:58368
v_mfma_f32_16x16x32_bf16 v[104:107], v[72:75], v[56:59], v[104:107]
v_lshrrev_b32 v197, 16, v197
v_mfma_f32_16x16x32_bf16 v[108:111], v[76:79], v[56:59], v[108:111]
v_mul_u32_u24 v198, 12, v197
v_mfma_f32_16x16x32_bf16 v[124:127], v[76:79], v[60:63], v[124:127]
v_sub_u32 v198, v196, v198
v_mfma_f32_16x16x32_bf16 v[120:123], v[72:75], v[60:63], v[120:123]
v_bfe_u32 v199, v197, 2, 1
v_mfma_f32_16x16x32_bf16 v[116:119], v[68:71], v[60:63], v[116:119]
v_cmp_gt_u32 vcc, 8, v198
v_mfma_f32_16x16x32_bf16 v[112:115], v[64:67], v[60:63], v[112:115]
v_lshlrev_b32 v200, 1, v199
s_waitcnt lgkmcnt(0)
s_barrier
v_mfma_f32_16x16x32_bf16 v[96:99], v[152:155], v[144:147], v[96:99]
ds_read_b128 v[32:35], v2 offset:0
ds_read_b64_tr_b16 v[40:41], v4 offset:16384
v_mfma_f32_16x16x32_bf16 v[100:103], v[156:159], v[144:147], v[100:103]
ds_read_b64_tr_b16 v[42:43], v4 offset:18432
ds_read_b64_tr_b16 v[44:45], v5 offset:16384
v_mfma_f32_16x16x32_bf16 v[104:107], v[160:163], v[144:147], v[104:107]
ds_read_b64_tr_b16 v[46:47], v5 offset:18432
ds_read_b64_tr_b16 v[48:49], v6 offset:16384
v_mfma_f32_16x16x32_bf16 v[108:111], v[164:167], v[144:147], v[108:111]
ds_read_b64_tr_b16 v[50:51], v6 offset:18432
ds_read_b64_tr_b16 v[52:53], v7 offset:16384
v_mfma_f32_16x16x32_bf16 v[124:127], v[164:167], v[148:151], v[124:127]
ds_read_b64_tr_b16 v[54:55], v7 offset:18432
ds_read_b128 v[36:39], v2 offset:1024
v_mfma_f32_16x16x32_bf16 v[120:123], v[160:163], v[148:151], v[120:123]
ds_read_b128 v[56:59], v2 offset:8192
ds_read_b64_tr_b16 v[64:65], v4 offset:20480
v_mfma_f32_16x16x32_bf16 v[116:119], v[156:159], v[148:151], v[116:119]
ds_read_b64_tr_b16 v[66:67], v4 offset:22528
ds_read_b64_tr_b16 v[68:69], v5 offset:20480
v_mfma_f32_16x16x32_bf16 v[112:115], v[152:155], v[148:151], v[112:115]
ds_read_b64_tr_b16 v[70:71], v5 offset:22528
ds_read_b64_tr_b16 v[72:73], v6 offset:20480
v_mfma_f32_16x16x32_bf16 v[96:99], v[176:179], v[168:171], v[96:99]
ds_read_b64_tr_b16 v[74:75], v6 offset:22528
ds_read_b64_tr_b16 v[76:77], v7 offset:20480
v_mfma_f32_16x16x32_bf16 v[100:103], v[180:183], v[168:171], v[100:103]
ds_read_b64_tr_b16 v[78:79], v7 offset:22528
ds_read_b128 v[60:63], v2 offset:9216
v_mfma_f32_16x16x32_bf16 v[104:107], v[184:187], v[168:171], v[104:107]
v_mul_u32_u24 v197, 7168, v197
v_mfma_f32_16x16x32_bf16 v[108:111], v[188:191], v[168:171], v[108:111]
v_cndmask_b32 v199, v199, v200, vcc
v_mfma_f32_16x16x32_bf16 v[124:127], v[188:191], v[172:175], v[124:127]
v_xor_b32 v198, v198, v199
v_mfma_f32_16x16x32_bf16 v[120:123], v[184:187], v[172:175], v[120:123]
v_lshl_add_u32 v194, v198, 4, v197
v_mfma_f32_16x16x32_bf16 v[116:119], v[180:183], v[172:175], v[116:119]
s_and_b32 s43, s36, 1
v_mfma_f32_16x16x32_bf16 v[112:115], v[176:179], v[172:175], v[112:115]
s_mul_i32 s43, s43, 229376
s_waitcnt lgkmcnt(0)
s_barrier
v_mfma_f32_16x16x32_bf16 v[96:99], v[40:43], v[32:35], v[96:99]
ds_read_b128 v[144:147], v2 offset:49152
ds_read_b64_tr_b16 v[152:153], v4 offset:24576
v_mfma_f32_16x16x32_bf16 v[100:103], v[44:47], v[32:35], v[100:103]
ds_read_b64_tr_b16 v[154:155], v4 offset:26624
ds_read_b64_tr_b16 v[156:157], v5 offset:24576
v_mfma_f32_16x16x32_bf16 v[104:107], v[48:51], v[32:35], v[104:107]
ds_read_b64_tr_b16 v[158:159], v5 offset:26624
ds_read_b64_tr_b16 v[160:161], v6 offset:24576
v_mfma_f32_16x16x32_bf16 v[108:111], v[52:55], v[32:35], v[108:111]
ds_read_b64_tr_b16 v[162:163], v6 offset:26624
ds_read_b64_tr_b16 v[164:165], v7 offset:24576
v_mfma_f32_16x16x32_bf16 v[124:127], v[52:55], v[36:39], v[124:127]
ds_read_b64_tr_b16 v[166:167], v7 offset:26624
ds_read_b128 v[148:151], v2 offset:50176
v_mfma_f32_16x16x32_bf16 v[120:123], v[48:51], v[36:39], v[120:123]
ds_read_b128 v[168:171], v2 offset:57344
ds_read_b64_tr_b16 v[176:177], v4 offset:28672
v_mfma_f32_16x16x32_bf16 v[116:119], v[44:47], v[36:39], v[116:119]
ds_read_b64_tr_b16 v[178:179], v4 offset:30720
ds_read_b64_tr_b16 v[180:181], v5 offset:28672
v_mfma_f32_16x16x32_bf16 v[112:115], v[40:43], v[36:39], v[112:115]
ds_read_b64_tr_b16 v[182:183], v5 offset:30720
ds_read_b64_tr_b16 v[184:185], v6 offset:28672
v_mfma_f32_16x16x32_bf16 v[96:99], v[64:67], v[56:59], v[96:99]
ds_read_b64_tr_b16 v[186:187], v6 offset:30720
ds_read_b64_tr_b16 v[188:189], v7 offset:28672
v_mfma_f32_16x16x32_bf16 v[100:103], v[68:71], v[56:59], v[100:103]
ds_read_b64_tr_b16 v[190:191], v7 offset:30720
ds_read_b128 v[172:175], v2 offset:58368
v_mfma_f32_16x16x32_bf16 v[104:107], v[72:75], v[56:59], v[104:107]
v_add_u32 v192, s43, v192
v_mfma_f32_16x16x32_bf16 v[108:111], v[76:79], v[56:59], v[108:111]
v_add_u32 v193, s43, v193
v_mfma_f32_16x16x32_bf16 v[124:127], v[76:79], v[60:63], v[124:127]
v_add_u32 v194, s43, v194
v_mfma_f32_16x16x32_bf16 v[120:123], v[72:75], v[60:63], v[120:123]
s_and_b32 s43, s36, 3
v_mfma_f32_16x16x32_bf16 v[116:119], v[68:71], v[60:63], v[116:119]
s_mul_i32 s50, s43, 6144
v_mfma_f32_16x16x32_bf16 v[112:115], v[64:67], v[60:63], v[112:115]
s_add_u32 s50, s50, 16384
s_waitcnt lgkmcnt(0)
s_barrier
v_mfma_f32_16x16x32_bf16 v[96:99], v[152:155], v[144:147], v[96:99]
ds_read_b128 v[32:35], v3 offset:0
ds_read_b64_tr_b16 v[40:41], v4 offset:32768
v_mfma_f32_16x16x32_bf16 v[100:103], v[156:159], v[144:147], v[100:103]
ds_read_b64_tr_b16 v[42:43], v4 offset:34816
ds_read_b64_tr_b16 v[44:45], v5 offset:32768
v_mfma_f32_16x16x32_bf16 v[104:107], v[160:163], v[144:147], v[104:107]
ds_read_b64_tr_b16 v[46:47], v5 offset:34816
ds_read_b64_tr_b16 v[48:49], v6 offset:32768
v_mfma_f32_16x16x32_bf16 v[108:111], v[164:167], v[144:147], v[108:111]
ds_read_b64_tr_b16 v[50:51], v6 offset:34816
ds_read_b64_tr_b16 v[52:53], v7 offset:32768
v_mfma_f32_16x16x32_bf16 v[124:127], v[164:167], v[148:151], v[124:127]
ds_read_b64_tr_b16 v[54:55], v7 offset:34816
ds_read_b128 v[36:39], v3 offset:1024
v_mfma_f32_16x16x32_bf16 v[120:123], v[160:163], v[148:151], v[120:123]
ds_read_b128 v[56:59], v3 offset:8192
ds_read_b64_tr_b16 v[64:65], v4 offset:36864
v_mfma_f32_16x16x32_bf16 v[116:119], v[156:159], v[148:151], v[116:119]
ds_read_b64_tr_b16 v[66:67], v4 offset:38912
ds_read_b64_tr_b16 v[68:69], v5 offset:36864
v_mfma_f32_16x16x32_bf16 v[112:115], v[152:155], v[148:151], v[112:115]
ds_read_b64_tr_b16 v[70:71], v5 offset:38912
ds_read_b64_tr_b16 v[72:73], v6 offset:36864
v_mfma_f32_16x16x32_bf16 v[96:99], v[176:179], v[168:171], v[96:99]
ds_read_b64_tr_b16 v[74:75], v6 offset:38912
ds_read_b64_tr_b16 v[76:77], v7 offset:36864
v_mfma_f32_16x16x32_bf16 v[100:103], v[180:183], v[168:171], v[100:103]
ds_read_b64_tr_b16 v[78:79], v7 offset:38912
ds_read_b128 v[60:63], v3 offset:9216
v_mfma_f32_16x16x32_bf16 v[104:107], v[184:187], v[168:171], v[104:107]
s_bitcmp0_b32 s2, 0
v_mfma_f32_16x16x32_bf16 v[108:111], v[188:191], v[168:171], v[108:111]
s_cselect_b32 s88, s72, s74
v_mfma_f32_16x16x32_bf16 v[124:127], v[188:191], v[172:175], v[124:127]
s_cselect_b32 s89, s73, s75
v_mfma_f32_16x16x32_bf16 v[120:123], v[184:187], v[172:175], v[120:123]
s_mov_b32 s90, 7340032
v_mfma_f32_16x16x32_bf16 v[116:119], v[180:183], v[172:175], v[116:119]
s_mov_b32 s91, 0x20000
v_mfma_f32_16x16x32_bf16 v[112:115], v[176:179], v[172:175], v[112:115]
s_bfe_u32 s44, s2, 0x30001
s_waitcnt lgkmcnt(0)
s_barrier
v_mfma_f32_16x16x32_bf16 v[96:99], v[40:43], v[32:35], v[96:99]
ds_read_b128 v[144:147], v3 offset:49152
ds_read_b64_tr_b16 v[152:153], v4 offset:40960
v_mfma_f32_16x16x32_bf16 v[100:103], v[44:47], v[32:35], v[100:103]
ds_read_b64_tr_b16 v[154:155], v4 offset:43008
ds_read_b64_tr_b16 v[156:157], v5 offset:40960
v_mfma_f32_16x16x32_bf16 v[104:107], v[48:51], v[32:35], v[104:107]
ds_read_b64_tr_b16 v[158:159], v5 offset:43008
ds_read_b64_tr_b16 v[160:161], v6 offset:40960
v_mfma_f32_16x16x32_bf16 v[108:111], v[52:55], v[32:35], v[108:111]
ds_read_b64_tr_b16 v[162:163], v6 offset:43008
ds_read_b64_tr_b16 v[164:165], v7 offset:40960
v_mfma_f32_16x16x32_bf16 v[124:127], v[52:55], v[36:39], v[124:127]
ds_read_b64_tr_b16 v[166:167], v7 offset:43008
ds_read_b128 v[148:151], v3 offset:50176
v_mfma_f32_16x16x32_bf16 v[120:123], v[48:51], v[36:39], v[120:123]
ds_read_b128 v[168:171], v3 offset:57344
ds_read_b64_tr_b16 v[176:177], v4 offset:45056
v_mfma_f32_16x16x32_bf16 v[116:119], v[44:47], v[36:39], v[116:119]
s_branch Lov_6
.p2align 12
Lst_6_0:
s_branch Lwr_173
s_nop 0
s_nop 0
Lov_6:
ds_read_b64_tr_b16 v[178:179], v4 offset:47104
ds_read_b64_tr_b16 v[180:181], v5 offset:45056
v_mfma_f32_16x16x32_bf16 v[112:115], v[40:43], v[36:39], v[112:115]
ds_read_b64_tr_b16 v[182:183], v5 offset:47104
ds_read_b64_tr_b16 v[184:185], v6 offset:45056
v_mfma_f32_16x16x32_bf16 v[96:99], v[64:67], v[56:59], v[96:99]
ds_read_b64_tr_b16 v[186:187], v6 offset:47104
ds_read_b64_tr_b16 v[188:189], v7 offset:45056
v_mfma_f32_16x16x32_bf16 v[100:103], v[68:71], v[56:59], v[100:103]
ds_read_b64_tr_b16 v[190:191], v7 offset:47104
ds_read_b128 v[172:175], v3 offset:58368
v_mfma_f32_16x16x32_bf16 v[104:107], v[72:75], v[56:59], v[104:107]
s_lshl_b32 s44, s44, 2
v_mfma_f32_16x16x32_bf16 v[108:111], v[76:79], v[56:59], v[108:111]
s_and_b32 s43, s36, 3
v_mfma_f32_16x16x32_bf16 v[124:127], v[76:79], v[60:63], v[124:127]
s_add_u32 s44, s44, s43
v_mfma_f32_16x16x32_bf16 v[120:123], v[72:75], v[60:63], v[120:123]
s_lshl_b32 s44, s44, 5
v_mfma_f32_16x16x32_bf16 v[116:119], v[68:71], v[60:63], v[116:119]
v_lshrrev_b32 v195, 4, v1
v_mfma_f32_16x16x32_bf16 v[112:115], v[64:67], v[60:63], v[112:115]
v_add_u32 v195, s44, v195
s_waitcnt lgkmcnt(0)
s_barrier
v_mfma_f32_16x16x32_bf16 v[96:99], v[152:155], v[144:147], v[96:99]
ds_read_b128 v[32:35], v2 offset:0
ds_read_b64_tr_b16 v[40:41], v16 offset:49152
v_mfma_f32_16x16x32_bf16 v[100:103], v[156:159], v[144:147], v[100:103]
ds_read_b64_tr_b16 v[42:43], v16 offset:51200
ds_read_b64_tr_b16 v[44:45], v17 offset:49152
v_mfma_f32_16x16x32_bf16 v[104:107], v[160:163], v[144:147], v[104:107]
ds_read_b64_tr_b16 v[46:47], v17 offset:51200
ds_read_b64_tr_b16 v[48:49], v18 offset:49152
v_mfma_f32_16x16x32_bf16 v[108:111], v[164:167], v[144:147], v[108:111]
ds_read_b64_tr_b16 v[50:51], v18 offset:51200
ds_read_b64_tr_b16 v[52:53], v19 offset:49152
v_mfma_f32_16x16x32_bf16 v[124:127], v[164:167], v[148:151], v[124:127]
ds_read_b64_tr_b16 v[54:55], v19 offset:51200
ds_read_b128 v[36:39], v2 offset:1024
v_mfma_f32_16x16x32_bf16 v[120:123], v[160:163], v[148:151], v[120:123]
ds_read_b128 v[56:59], v2 offset:8192
ds_read_b64_tr_b16 v[64:65], v16 offset:53248
v_mfma_f32_16x16x32_bf16 v[116:119], v[156:159], v[148:151], v[116:119]
ds_read_b64_tr_b16 v[66:67], v16 offset:55296
ds_read_b64_tr_b16 v[68:69], v17 offset:53248
v_mfma_f32_16x16x32_bf16 v[112:115], v[152:155], v[148:151], v[112:115]
ds_read_b64_tr_b16 v[70:71], v17 offset:55296
ds_read_b64_tr_b16 v[72:73], v18 offset:53248
v_mfma_f32_16x16x32_bf16 v[96:99], v[176:179], v[168:171], v[96:99]
ds_read_b64_tr_b16 v[74:75], v18 offset:55296
ds_read_b64_tr_b16 v[76:77], v19 offset:53248
v_mfma_f32_16x16x32_bf16 v[100:103], v[180:183], v[168:171], v[100:103]
ds_read_b64_tr_b16 v[78:79], v19 offset:55296
ds_read_b128 v[60:63], v2 offset:9216
v_mfma_f32_16x16x32_bf16 v[104:107], v[184:187], v[168:171], v[104:107]
v_mul_u32_u24 v195, 7168, v195
v_mfma_f32_16x16x32_bf16 v[108:111], v[188:191], v[168:171], v[108:111]
v_and_b32 v196, 15, v1
v_mfma_f32_16x16x32_bf16 v[124:127], v[188:191], v[172:175], v[124:127]
v_lshl_add_u32 v195, v196, 4, v195
v_mfma_f32_16x16x32_bf16 v[120:123], v[184:187], v[172:175], v[120:123]
s_lshr_b32 s43, s2, 4
v_mfma_f32_16x16x32_bf16 v[116:119], v[180:183], v[172:175], v[116:119]
s_lshl_b32 s43, s43, 8
v_mfma_f32_16x16x32_bf16 v[112:115], v[176:179], v[172:175], v[112:115]
v_add_u32 v195, s43, v195
s_waitcnt lgkmcnt(0)
s_barrier
v_mfma_f32_16x16x32_bf16 v[96:99], v[40:43], v[32:35], v[96:99]
ds_read_b128 v[144:147], v2 offset:49152
ds_read_b64_tr_b16 v[152:153], v16 offset:57344
v_mfma_f32_16x16x32_bf16 v[100:103], v[44:47], v[32:35], v[100:103]
ds_read_b64_tr_b16 v[154:155], v16 offset:59392
ds_read_b64_tr_b16 v[156:157], v17 offset:57344
v_mfma_f32_16x16x32_bf16 v[104:107], v[48:51], v[32:35], v[104:107]
ds_read_b64_tr_b16 v[158:159], v17 offset:59392
ds_read_b64_tr_b16 v[160:161], v18 offset:57344
v_mfma_f32_16x16x32_bf16 v[108:111], v[52:55], v[32:35], v[108:111]
ds_read_b64_tr_b16 v[162:163], v18 offset:59392
ds_read_b64_tr_b16 v[164:165], v19 offset:57344
v_mfma_f32_16x16x32_bf16 v[124:127], v[52:55], v[36:39], v[124:127]
ds_read_b64_tr_b16 v[166:167], v19 offset:59392
ds_read_b128 v[148:151], v2 offset:50176
v_mfma_f32_16x16x32_bf16 v[120:123], v[48:51], v[36:39], v[120:123]
ds_read_b128 v[168:171], v2 offset:57344
ds_read_b64_tr_b16 v[176:177], v16 offset:61440
v_mfma_f32_16x16x32_bf16 v[116:119], v[44:47], v[36:39], v[116:119]
ds_read_b64_tr_b16 v[178:179], v16 offset:63488
ds_read_b64_tr_b16 v[180:181], v17 offset:61440
v_mfma_f32_16x16x32_bf16 v[112:115], v[40:43], v[36:39], v[112:115]
ds_read_b64_tr_b16 v[182:183], v17 offset:63488
ds_read_b64_tr_b16 v[184:185], v18 offset:61440
v_mfma_f32_16x16x32_bf16 v[96:99], v[64:67], v[56:59], v[96:99]
ds_read_b64_tr_b16 v[186:187], v18 offset:63488
ds_read_b64_tr_b16 v[188:189], v19 offset:61440
v_mfma_f32_16x16x32_bf16 v[100:103], v[68:71], v[56:59], v[100:103]
ds_read_b64_tr_b16 v[190:191], v19 offset:63488
ds_read_b128 v[172:175], v2 offset:58368
v_mfma_f32_16x16x32_bf16 v[104:107], v[72:75], v[56:59], v[104:107]
v_mfma_f32_16x16x32_bf16 v[108:111], v[76:79], v[56:59], v[108:111]
v_mfma_f32_16x16x32_bf16 v[124:127], v[76:79], v[60:63], v[124:127]
v_mfma_f32_16x16x32_bf16 v[120:123], v[72:75], v[60:63], v[120:123]
v_mfma_f32_16x16x32_bf16 v[116:119], v[68:71], v[60:63], v[116:119]
v_mfma_f32_16x16x32_bf16 v[112:115], v[64:67], v[60:63], v[112:115]
s_waitcnt lgkmcnt(0)
s_barrier
v_mfma_f32_16x16x32_bf16 v[96:99], v[152:155], v[144:147], v[96:99]
ds_read_b128 v[32:35], v3 offset:0
ds_read_b64_tr_b16 v[40:41], v20 offset:0
v_mfma_f32_16x16x32_bf16 v[100:103], v[156:159], v[144:147], v[100:103]
ds_read_b64_tr_b16 v[42:43], v20 offset:2048
ds_read_b64_tr_b16 v[44:45], v21 offset:0
v_mfma_f32_16x16x32_bf16 v[104:107], v[160:163], v[144:147], v[104:107]
ds_read_b64_tr_b16 v[46:47], v21 offset:2048
ds_read_b64_tr_b16 v[48:49], v22 offset:0
v_mfma_f32_16x16x32_bf16 v[108:111], v[164:167], v[144:147], v[108:111]
ds_read_b64_tr_b16 v[50:51], v22 offset:2048
ds_read_b64_tr_b16 v[52:53], v23 offset:0
v_mfma_f32_16x16x32_bf16 v[124:127], v[164:167], v[148:151], v[124:127]
ds_read_b64_tr_b16 v[54:55], v23 offset:2048
ds_read_b128 v[36:39], v3 offset:1024
v_mfma_f32_16x16x32_bf16 v[120:123], v[160:163], v[148:151], v[120:123]
ds_read_b128 v[56:59], v3 offset:8192
ds_read_b64_tr_b16 v[64:65], v20 offset:4096
v_mfma_f32_16x16x32_bf16 v[116:119], v[156:159], v[148:151], v[116:119]
ds_read_b64_tr_b16 v[66:67], v20 offset:6144
ds_read_b64_tr_b16 v[68:69], v21 offset:4096
v_mfma_f32_16x16x32_bf16 v[112:115], v[152:155], v[148:151], v[112:115]
ds_read_b64_tr_b16 v[70:71], v21 offset:6144
ds_read_b64_tr_b16 v[72:73], v22 offset:4096
v_mfma_f32_16x16x32_bf16 v[96:99], v[176:179], v[168:171], v[96:99]
ds_read_b64_tr_b16 v[74:75], v22 offset:6144
ds_read_b64_tr_b16 v[76:77], v23 offset:4096
v_mfma_f32_16x16x32_bf16 v[100:103], v[180:183], v[168:171], v[100:103]
ds_read_b64_tr_b16 v[78:79], v23 offset:6144
ds_read_b128 v[60:63], v3 offset:9216
v_mfma_f32_16x16x32_bf16 v[104:107], v[184:187], v[168:171], v[104:107]
v_mfma_f32_16x16x32_bf16 v[108:111], v[188:191], v[168:171], v[108:111]
v_mfma_f32_16x16x32_bf16 v[124:127], v[188:191], v[172:175], v[124:127]
v_mfma_f32_16x16x32_bf16 v[120:123], v[184:187], v[172:175], v[120:123]
v_mfma_f32_16x16x32_bf16 v[116:119], v[180:183], v[172:175], v[116:119]
v_mfma_f32_16x16x32_bf16 v[112:115], v[176:179], v[172:175], v[112:115]
s_waitcnt lgkmcnt(0)
s_barrier
v_mfma_f32_16x16x32_bf16 v[96:99], v[40:43], v[32:35], v[96:99]
ds_read_b128 v[144:147], v3 offset:49152
ds_read_b64_tr_b16 v[152:153], v20 offset:8192
v_mfma_f32_16x16x32_bf16 v[100:103], v[44:47], v[32:35], v[100:103]
ds_read_b64_tr_b16 v[154:155], v20 offset:10240
ds_read_b64_tr_b16 v[156:157], v21 offset:8192
v_mfma_f32_16x16x32_bf16 v[104:107], v[48:51], v[32:35], v[104:107]
ds_read_b64_tr_b16 v[158:159], v21 offset:10240
ds_read_b64_tr_b16 v[160:161], v22 offset:8192
v_mfma_f32_16x16x32_bf16 v[108:111], v[52:55], v[32:35], v[108:111]
ds_read_b64_tr_b16 v[162:163], v22 offset:10240
ds_read_b64_tr_b16 v[164:165], v23 offset:8192
v_mfma_f32_16x16x32_bf16 v[124:127], v[52:55], v[36:39], v[124:127]
ds_read_b64_tr_b16 v[166:167], v23 offset:10240
ds_read_b128 v[148:151], v3 offset:50176
v_mfma_f32_16x16x32_bf16 v[120:123], v[48:51], v[36:39], v[120:123]
ds_read_b128 v[168:171], v3 offset:57344
ds_read_b64_tr_b16 v[176:177], v20 offset:12288
v_mfma_f32_16x16x32_bf16 v[116:119], v[44:47], v[36:39], v[116:119]
ds_read_b64_tr_b16 v[178:179], v20 offset:14336
ds_read_b64_tr_b16 v[180:181], v21 offset:12288
v_mfma_f32_16x16x32_bf16 v[112:115], v[40:43], v[36:39], v[112:115]
ds_read_b64_tr_b16 v[182:183], v21 offset:14336
ds_read_b64_tr_b16 v[184:185], v22 offset:12288
v_mfma_f32_16x16x32_bf16 v[96:99], v[64:67], v[56:59], v[96:99]
ds_read_b64_tr_b16 v[186:187], v22 offset:14336
ds_read_b64_tr_b16 v[188:189], v23 offset:12288
v_mfma_f32_16x16x32_bf16 v[100:103], v[68:71], v[56:59], v[100:103]
ds_read_b64_tr_b16 v[190:191], v23 offset:14336
ds_read_b128 v[172:175], v3 offset:58368
v_mfma_f32_16x16x32_bf16 v[104:107], v[72:75], v[56:59], v[104:107]
v_mfma_f32_16x16x32_bf16 v[108:111], v[76:79], v[56:59], v[108:111]
v_mfma_f32_16x16x32_bf16 v[124:127], v[76:79], v[60:63], v[124:127]
v_mfma_f32_16x16x32_bf16 v[120:123], v[72:75], v[60:63], v[120:123]
v_mfma_f32_16x16x32_bf16 v[116:119], v[68:71], v[60:63], v[116:119]
v_mfma_f32_16x16x32_bf16 v[112:115], v[64:67], v[60:63], v[112:115]
s_waitcnt lgkmcnt(0)
s_barrier
v_mfma_f32_16x16x32_bf16 v[96:99], v[152:155], v[144:147], v[96:99]
v_mfma_f32_16x16x32_bf16 v[100:103], v[156:159], v[144:147], v[100:103]
v_mfma_f32_16x16x32_bf16 v[104:107], v[160:163], v[144:147], v[104:107]
v_mfma_f32_16x16x32_bf16 v[108:111], v[164:167], v[144:147], v[108:111]
v_mfma_f32_16x16x32_bf16 v[124:127], v[164:167], v[148:151], v[124:127]
v_mfma_f32_16x16x32_bf16 v[120:123], v[160:163], v[148:151], v[120:123]
v_mfma_f32_16x16x32_bf16 v[116:119], v[156:159], v[148:151], v[116:119]
v_mfma_f32_16x16x32_bf16 v[112:115], v[152:155], v[148:151], v[112:115]
v_mfma_f32_16x16x32_bf16 v[96:99], v[176:179], v[168:171], v[96:99]
v_mfma_f32_16x16x32_bf16 v[100:103], v[180:183], v[168:171], v[100:103]
v_mfma_f32_16x16x32_bf16 v[104:107], v[184:187], v[168:171], v[104:107]
v_mfma_f32_16x16x32_bf16 v[108:111], v[188:191], v[168:171], v[108:111]
v_mfma_f32_16x16x32_bf16 v[124:127], v[188:191], v[172:175], v[124:127]
v_mfma_f32_16x16x32_bf16 v[120:123], v[184:187], v[172:175], v[120:123]
v_mfma_f32_16x16x32_bf16 v[116:119], v[180:183], v[172:175], v[116:119]
v_mfma_f32_16x16x32_bf16 v[112:115], v[176:179], v[172:175], v[112:115]
s_nop 3
v_cvt_pk_bf16_f32 v32, v96, v97
v_cvt_pk_bf16_f32 v33, v98, v99
v_cvt_pk_bf16_f32 v34, v100, v101
v_cvt_pk_bf16_f32 v35, v102, v103
s_add_u32 s43, s60, 0
buffer_store_dwordx4 v[32:35], v11, s[20:23], s43 offen offset:0 sc1
v_cvt_pk_bf16_f32 v36, v104, v105
v_cvt_pk_bf16_f32 v37, v106, v107
v_cvt_pk_bf16_f32 v38, v108, v109
v_cvt_pk_bf16_f32 v39, v110, v111
s_add_u32 s43, s60, 8192
buffer_store_dwordx4 v[36:39], v11, s[20:23], s43 offen offset:0 sc1
v_cvt_pk_bf16_f32 v44, v120, v121
v_cvt_pk_bf16_f32 v45, v122, v123
v_cvt_pk_bf16_f32 v46, v124, v125
v_cvt_pk_bf16_f32 v47, v126, v127
s_add_u32 s43, s60, 8192
buffer_store_dwordx4 v[44:47], v11, s[20:23], s43 offen offset:1024 sc1
v_cvt_pk_bf16_f32 v40, v112, v113
v_cvt_pk_bf16_f32 v41, v114, v115
v_cvt_pk_bf16_f32 v42, v116, v117
v_cvt_pk_bf16_f32 v43, v118, v119
s_add_u32 s43, s60, 0
buffer_store_dwordx4 v[40:43], v11, s[20:23], s43 offen offset:1024 sc1
v_mov_b32 v64, 0
v_mov_b32 v65, 0
v_mov_b32 v66, 0
v_mov_b32 v67, 0
v_mov_b32 v68, 0
v_mov_b32 v69, 0
v_mov_b32 v70, 0
v_mov_b32 v71, 0
v_dot2_f32_bf16 v64, v32, s61, v64
v_dot2_f32_bf16 v66, v32, v32, v66
v_dot2_f32_bf16 v68, v40, s61, v68
v_dot2_f32_bf16 v70, v40, v40, v70
v_dot2_f32_bf16 v65, v33, s61, v65
v_dot2_f32_bf16 v67, v33, v33, v67
v_dot2_f32_bf16 v69, v41, s61, v69
v_dot2_f32_bf16 v71, v41, v41, v71
v_dot2_f32_bf16 v64, v34, s61, v64
v_dot2_f32_bf16 v66, v34, v34, v66
v_dot2_f32_bf16 v68, v42, s61, v68
v_dot2_f32_bf16 v70, v42, v42, v70
v_dot2_f32_bf16 v65, v35, s61, v65
v_dot2_f32_bf16 v67, v35, v35, v67
v_dot2_f32_bf16 v69, v43, s61, v69
v_dot2_f32_bf16 v71, v43, v43, v71
v_dot2_f32_bf16 v64, v36, s61, v64
v_dot2_f32_bf16 v66, v36, v36, v66
v_dot2_f32_bf16 v68, v44, s61, v68
v_dot2_f32_bf16 v70, v44, v44, v70
v_dot2_f32_bf16 v65, v37, s61, v65
v_dot2_f32_bf16 v67, v37, v37, v67
v_dot2_f32_bf16 v69, v45, s61, v69
v_dot2_f32_bf16 v71, v45, v45, v71
v_dot2_f32_bf16 v64, v38, s61, v64
v_dot2_f32_bf16 v66, v38, v38, v66
v_dot2_f32_bf16 v68, v46, s61, v68
v_dot2_f32_bf16 v70, v46, v46, v70
v_dot2_f32_bf16 v65, v39, s61, v65
v_dot2_f32_bf16 v67, v39, v39, v67
v_dot2_f32_bf16 v69, v47, s61, v69
v_dot2_f32_bf16 v71, v47, v47, v71
s_nop 2
v_add_f32 v64, v64, v65
v_add_f32 v66, v66, v67
v_add_f32 v68, v68, v69
v_add_f32 v70, v70, v71
s_nop 1
v_permlane32_swap_b32 v64, v68
v_permlane32_swap_b32 v66, v70
v_add_f32 v64, v64, v68
v_add_f32 v66, v66, v70
s_nop 1
v_permlane16_swap_b32 v64, v66
v_add_f32 v64, v64, v66
buffer_store_dword v64, v9, s[24:27], 0 offen sc1
s_lshl_b32 s7, s34, 12
s_add_u32 s7, s7, 49280
v_lshl_add_u32 v4, v1, 8, s7
v_mov_b32 v5, 1
s_waitcnt vmcnt(0)
s_cmp_lg_u32 s36, 0
s_barrier
s_cbranch_scc1 Lk2end_104
s_mov_b64 exec, 0xffff
buffer_atomic_add v5, v4, s[56:59], 0 offen sc1
s_mov_b64 exec, -1
s_branch Lk2end_104
Lprod_105:
s_mul_i32 s43, s34, 262144
s_add_u32 s8, s82, s43
s_addc_u32 s9, s83, 0
s_mov_b32 s10, 262144
s_mov_b32 s11, 0x20000
s_lshl_b32 s43, s35, 7
s_add_u32 s12, s68, s43
s_addc_u32 s13, s69, 0
s_mov_b32 s14, 2095232
s_mov_b32 s15, 0x20000
s_and_b32 s47, s36, 3
s_lshl_b32 s39, s47, 12
v_lshlrev_b32 v2, 4, v1
v_add_u32 v2, s39, v2
v_lshrrev_b32 v12, 3, v1
v_and_b32 v13, 6, v12
v_and_b32 v3, 7, v1
v_xor_b32 v3, v3, v13
v_lshlrev_b32 v3, 4, v3
v_mul_u32_u24 v12, 2048, v12
v_add_u32 v3, v3, v12
s_lshl_b32 s43, s47, 15
v_add_u32 v3, s43, v3
s_lshl_b32 s40, s47, 11
s_add_u32 s37, s35, 0
s_and_b32 s37, s37, 15
s_lshl_b32 s37, s37, 14
s_add_u32 m0, s39, 0
s_nop 0
buffer_load_dwordx4 v2, s[8:11], s37 offen offset:0 sc1 lds
buffer_load_dwordx4 v2, s[8:11], s37 offen offset:1024 sc1 lds
buffer_load_dwordx4 v2, s[8:11], s37 offen offset:2048 sc1 lds
buffer_load_dwordx4 v2, s[8:11], s37 offen offset:3072 sc1 lds
s_add_u32 s38, s35, 4
s_and_b32 s38, s38, 15
s_lshl_b32 s38, s38, 17
s_add_u32 m0, s40, 114688
s_nop 0
buffer_load_dwordx4 v3, s[12:15], s38 offen lds
s_add_u32 m0, s40, 115712
s_add_u32 s38, s38, 16384
buffer_load_dwordx4 v3, s[12:15], s38 offen lds
s_add_u32 s38, s35, 5
s_and_b32 s38, s38, 15
s_lshl_b32 s38, s38, 17
s_add_u32 m0, s40, 122880
s_nop 0
buffer_load_dwordx4 v3, s[12:15], s38 offen lds
s_add_u32 m0, s40, 123904
s_add_u32 s38, s38, 16384
buffer_load_dwordx4 v3, s[12:15], s38 offen lds
s_add_u32 s38, s35, 6
s_and_b32 s38, s38, 15
s_lshl_b32 s38, s38, 17
s_add_u32 m0, s40, 131072
s_nop 0
buffer_load_dwordx4 v3, s[12:15], s38 offen lds
s_add_u32 m0, s40, 132096
s_add_u32 s38, s38, 16384
buffer_load_dwordx4 v3, s[12:15], s38 offen lds
s_add_u32 s38, s35, 7
s_and_b32 s38, s38, 15
s_lshl_b32 s38, s38, 17
s_add_u32 m0, s40, 139264
s_nop 0
buffer_load_dwordx4 v3, s[12:15], s38 offen lds
s_add_u32 m0, s40, 140288
s_add_u32 s38, s38, 16384
buffer_load_dwordx4 v3, s[12:15], s38 offen lds
s_bitcmp0_b32 s36, 1
s_cselect_b32 s44, s72, s74
s_cselect_b32 s45, s73, s75
s_mul_i32 s43, s35, 192
s_add_u32 s88, s44, s43
s_addc_u32 s89, s45, 0
s_add_u32 s88, s88, 4096
s_addc_u32 s89, s89, 0
s_mov_b32 s90, 7333056
s_mov_b32 s91, 0x20000
v_add_u32 v11, 0, v1
v_mul_u32_u24 v12, 5462, v11
v_lshrrev_b32 v12, 16, v12
v_mul_u32_u24 v13, 12, v12
v_sub_u32 v13, v11, v13
v_bfe_u32 v14, v12, 2, 1
v_cmp_gt_u32 vcc, 8, v13
v_lshlrev_b32 v15, 1, v14
v_mul_u32_u24 v12, 7168, v12
v_cndmask_b32 v14, v14, v15, vcc
v_xor_b32 v13, v13, v14
v_lshl_add_u32 v8, v13, 4, v12
v_add_u32 v11, 64, v1
v_mul_u32_u24 v12, 5462, v11
v_lshrrev_b32 v12, 16, v12
v_mul_u32_u24 v13, 12, v12
v_sub_u32 v13, v11, v13
v_bfe_u32 v14, v12, 2, 1
v_cmp_gt_u32 vcc, 8, v13
v_lshlrev_b32 v15, 1, v14
v_mul_u32_u24 v12, 7168, v12
v_cndmask_b32 v14, v14, v15, vcc
v_xor_b32 v13, v13, v14
v_lshl_add_u32 v9, v13, 4, v12
v_add_u32 v11, 128, v1
v_mul_u32_u24 v12, 5462, v11
v_lshrrev_b32 v12, 16, v12
v_mul_u32_u24 v13, 12, v12
v_sub_u32 v13, v11, v13
v_bfe_u32 v14, v12, 2, 1
v_cmp_gt_u32 vcc, 8, v13
v_lshlrev_b32 v15, 1, v14
v_mul_u32_u24 v12, 7168, v12
v_cndmask_b32 v14, v14, v15, vcc
v_xor_b32 v13, v13, v14
v_lshl_add_u32 v10, v13, 4, v12
s_and_b32 s43, s36, 1
s_mul_i32 s43, s43, 229376
v_add_u32 v8, s43, v8
v_add_u32 v9, s43, v9
v_add_u32 v10, s43, v10
s_and_b32 s43, s36, 3
s_mul_i32 s46, s43, 6144
s_add_u32 s46, s46, 16384
s_cmp_eq_u32 s47, 3
s_cbranch_scc0 Lw_112
s_lshl_b32 s92, s34, 4
s_add_u32 s92, s92, s35
s_lshl_b32 s92, s92, 8
s_add_u32 s92, s92, 49152
s_add_u32 s92, s92, 28311552
s_mov_b32 s41, 0x40000
Lpoll_113:
s_load_dword s93, s[82:83], s92 glc
Lpchk_115:
s_waitcnt lgkmcnt(0)
s_cmp_eq_u32 s93, 16
s_cbranch_scc1 Lpok_114
s_sub_u32 s41, s41, 1
s_cmp_lg_u32 s41, 0
s_cbranch_scc1 Lpoll_113
Lpok_114:
Lw_112:
s_and_b32 s44, s36, 3
s_mul_i32 s44, s44, 14
s_bfe_u32 s43, s2, 0x30001
s_lshl_b32 s43, s43, 7
s_add_u32 s44, s44, s43
s_add_u32 s44, s44, 72
s_mul_i32 s44, s44, 7168
s_lshr_b32 s43, s2, 4
s_lshl_b32 s43, s43, 8
s_add_u32 s43, s43, s44
s_bitcmp0_b32 s2, 0
s_cselect_b32 s4, s72, s74
s_cselect_b32 s5, s73, s75
s_add_u32 s4, s4, s43
s_addc_u32 s5, s5, 0
s_cmp_eq_u32 s47, 3
s_cbranch_scc1 Lw_116
s_load_dword s3, s[4:5], 0
s_load_dword s3, s[4:5], 64
s_load_dword s3, s[4:5], 128
s_load_dword s3, s[4:5], 192
s_load_dword s3, s[4:5], 7168
s_load_dword s3, s[4:5], 7232
s_load_dword s3, s[4:5], 7296
s_load_dword s3, s[4:5], 7360
s_load_dword s3, s[4:5], 14336
s_load_dword s3, s[4:5], 14400
s_load_dword s3, s[4:5], 14464
s_load_dword s3, s[4:5], 14528
s_load_dword s3, s[4:5], 21504
s_load_dword s3, s[4:5], 21568
Lw_116:
s_waitcnt vmcnt(8)
s_barrier
s_add_u32 s37, s35, 1
s_and_b32 s37, s37, 15
s_lshl_b32 s37, s37, 14
s_add_u32 m0, s39, 49152
s_nop 0
buffer_load_dwordx4 v2, s[8:11], s37 offen offset:0 sc1 lds
buffer_load_dwordx4 v2, s[8:11], s37 offen offset:1024 sc1 lds
buffer_load_dwordx4 v2, s[8:11], s37 offen offset:2048 sc1 lds
buffer_load_dwordx4 v2, s[8:11], s37 offen offset:3072 sc1 lds
s_add_u32 s37, s35, 2
s_and_b32 s37, s37, 15
s_lshl_b32 s37, s37, 14
s_add_u32 m0, s39, 98304
s_nop 0
buffer_load_dwordx4 v2, s[8:11], s37 offen offset:0 sc1 lds
buffer_load_dwordx4 v2, s[8:11], s37 offen offset:1024 sc1 lds
buffer_load_dwordx4 v2, s[8:11], s37 offen offset:2048 sc1 lds
buffer_load_dwordx4 v2, s[8:11], s37 offen offset:3072 sc1 lds
s_add_u32 s37, s35, 3
s_and_b32 s37, s37, 15
s_lshl_b32 s37, s37, 14
s_add_u32 m0, s39, 147456
s_nop 0
buffer_load_dwordx4 v2, s[8:11], s37 offen offset:0 sc1 lds
buffer_load_dwordx4 v2, s[8:11], s37 offen offset:1024 sc1 lds
buffer_load_dwordx4 v2, s[8:11], s37 offen offset:2048 sc1 lds
buffer_load_dwordx4 v2, s[8:11], s37 offen offset:3072 sc1 lds
s_cmp_eq_u32 s47, 3
s_cbranch_scc0 Lw_117
s_load_dword s3, s[4:5], 0
s_load_dword s3, s[4:5], 64
s_load_dword s3, s[4:5], 128
s_load_dword s3, s[4:5], 192
s_load_dword s3, s[4:5], 7168
s_load_dword s3, s[4:5], 7232
s_load_dword s3, s[4:5], 7296
s_load_dword s3, s[4:5], 7360
s_load_dword s3, s[4:5], 14336
s_load_dword s3, s[4:5], 14400
s_load_dword s3, s[4:5], 14464
s_load_dword s3, s[4:5], 14528
s_load_dword s3, s[4:5], 21504
s_load_dword s3, s[4:5], 21568
Lw_117:
s_waitcnt vmcnt(8)
s_barrier
s_add_u32 s37, s35, 4
s_and_b32 s37, s37, 15
s_lshl_b32 s37, s37, 14
s_add_u32 m0, s39, 0
s_nop 0
buffer_load_dwordx4 v2, s[8:11], s37 offen offset:0 sc1 lds
buffer_load_dwordx4 v2, s[8:11], s37 offen offset:1024 sc1 lds
buffer_load_dwordx4 v2, s[8:11], s37 offen offset:2048 sc1 lds
buffer_load_dwordx4 v2, s[8:11], s37 offen offset:3072 sc1 lds
s_add_u32 s38, s35, 8
s_and_b32 s38, s38, 15
s_lshl_b32 s38, s38, 17
s_add_u32 m0, s40, 16384
s_nop 0
buffer_load_dwordx4 v3, s[12:15], s38 offen lds
s_add_u32 m0, s40, 17408
s_add_u32 s38, s38, 16384
buffer_load_dwordx4 v3, s[12:15], s38 offen lds
v_lshlrev_b32 v240, 16, v128
v_and_b32 v241, 0xffff0000, v128
v_lshlrev_b32 v242, 16, v129
v_and_b32 v243, 0xffff0000, v129
v_lshlrev_b32 v244, 16, v130
v_and_b32 v245, 0xffff0000, v130
v_lshlrev_b32 v246, 16, v131
v_and_b32 v247, 0xffff0000, v131
s_load_dword s3, s[4:5], 21632
s_load_dword s3, s[4:5], 21696
s_load_dword s3, s[4:5], 28672
s_waitcnt vmcnt(10)
s_barrier
s_add_u32 s37, s35, 5
s_and_b32 s37, s37, 15
s_lshl_b32 s37, s37, 14
s_add_u32 m0, s39, 49152
s_nop 0
buffer_load_dwordx4 v2, s[8:11], s37 offen offset:0 sc1 lds
buffer_load_dwordx4 v2, s[8:11], s37 offen offset:1024 sc1 lds
buffer_load_dwordx4 v2, s[8:11], s37 offen offset:2048 sc1 lds
buffer_load_dwordx4 v2, s[8:11], s37 offen offset:3072 sc1 lds
s_add_u32 s38, s35, 9
s_and_b32 s38, s38, 15
s_lshl_b32 s38, s38, 17
s_add_u32 m0, s40, 24576
s_nop 0
buffer_load_dwordx4 v3, s[12:15], s38 offen lds
s_add_u32 m0, s40, 25600
s_add_u32 s38, s38, 16384
buffer_load_dwordx4 v3, s[12:15], s38 offen lds
v_lshlrev_b32 v24, 16, v132
v_and_b32 v25, 0xffff0000, v132
v_lshlrev_b32 v26, 16, v133
v_and_b32 v27, 0xffff0000, v133
v_lshlrev_b32 v28, 16, v134
v_and_b32 v29, 0xffff0000, v134
v_lshlrev_b32 v30, 16, v135
v_and_b32 v31, 0xffff0000, v135
v_add_f32 v240, v240, v24
v_add_f32 v241, v241, v25
v_add_f32 v242, v242, v26
v_add_f32 v243, v243, v27
v_add_f32 v244, v244, v28
v_add_f32 v245, v245, v29
v_add_f32 v246, v246, v30
v_add_f32 v247, v247, v31
s_load_dword s3, s[4:5], 28736
s_load_dword s3, s[4:5], 28800
s_load_dword s3, s[4:5], 28864
s_waitcnt vmcnt(12)
s_barrier
s_add_u32 s37, s35, 6
s_and_b32 s37, s37, 15
s_lshl_b32 s37, s37, 14
s_add_u32 m0, s39, 98304
s_nop 0
buffer_load_dwordx4 v2, s[8:11], s37 offen offset:0 sc1 lds
buffer_load_dwordx4 v2, s[8:11], s37 offen offset:1024 sc1 lds
buffer_load_dwordx4 v2, s[8:11], s37 offen offset:2048 sc1 lds
buffer_load_dwordx4 v2, s[8:11], s37 offen offset:3072 sc1 lds
s_add_u32 s38, s35, 10
s_and_b32 s38, s38, 15
s_lshl_b32 s38, s38, 17
s_add_u32 m0, s40, 32768
s_nop 0
buffer_load_dwordx4 v3, s[12:15], s38 offen lds
s_add_u32 m0, s40, 33792
s_add_u32 s38, s38, 16384
buffer_load_dwordx4 v3, s[12:15], s38 offen lds
v_lshlrev_b32 v24, 16, v136
v_and_b32 v25, 0xffff0000, v136
v_lshlrev_b32 v26, 16, v137
v_and_b32 v27, 0xffff0000, v137
v_lshlrev_b32 v28, 16, v138
v_and_b32 v29, 0xffff0000, v138
v_lshlrev_b32 v30, 16, v139
v_and_b32 v31, 0xffff0000, v139
v_add_f32 v240, v240, v24
v_add_f32 v241, v241, v25
v_add_f32 v242, v242, v26
v_add_f32 v243, v243, v27
v_add_f32 v244, v244, v28
v_add_f32 v245, v245, v29
v_add_f32 v246, v246, v30
v_add_f32 v247, v247, v31
s_load_dword s3, s[4:5], 35840
s_load_dword s3, s[4:5], 35904
s_load_dword s3, s[4:5], 35968
s_waitcnt vmcnt(14)
s_barrier
s_add_u32 s37, s35, 7
s_and_b32 s37, s37, 15
s_lshl_b32 s37, s37, 14
s_add_u32 m0, s39, 147456
s_nop 0
buffer_load_dwordx4 v2, s[8:11], s37 offen offset:0 sc1 lds
buffer_load_dwordx4 v2, s[8:11], s37 offen offset:1024 sc1 lds
buffer_load_dwordx4 v2, s[8:11], s37 offen offset:2048 sc1 lds
buffer_load_dwordx4 v2, s[8:11], s37 offen offset:3072 sc1 lds
s_add_u32 s38, s35, 11
s_and_b32 s38, s38, 15
s_lshl_b32 s38, s38, 17
s_branch Lov_7
.p2align 12
Lst_7_0:
s_branch Lwr_174
s_nop 0
s_nop 0
Lov_7:
s_add_u32 m0, s40, 40960
s_nop 0
buffer_load_dwordx4 v3, s[12:15], s38 offen lds
s_add_u32 m0, s40, 41984
s_add_u32 s38, s38, 16384
buffer_load_dwordx4 v3, s[12:15], s38 offen lds
v_lshlrev_b32 v24, 16, v140
v_and_b32 v25, 0xffff0000, v140
v_lshlrev_b32 v26, 16, v141
v_and_b32 v27, 0xffff0000, v141
v_lshlrev_b32 v28, 16, v142
v_and_b32 v29, 0xffff0000, v142
v_lshlrev_b32 v30, 16, v143
v_and_b32 v31, 0xffff0000, v143
v_add_f32 v240, v240, v24
v_add_f32 v241, v241, v25
v_add_f32 v242, v242, v26
v_add_f32 v243, v243, v27
v_add_f32 v244, v244, v28
v_add_f32 v245, v245, v29
v_add_f32 v246, v246, v30
v_add_f32 v247, v247, v31
s_load_dword s3, s[4:5], 36032
s_load_dword s3, s[4:5], 43008
s_load_dword s3, s[4:5], 43072
s_waitcnt vmcnt(14)
s_barrier
s_add_u32 s37, s35, 8
s_and_b32 s37, s37, 15
s_lshl_b32 s37, s37, 14
s_add_u32 m0, s39, 0
s_nop 0
buffer_load_dwordx4 v2, s[8:11], s37 offen offset:0 sc1 lds
buffer_load_dwordx4 v2, s[8:11], s37 offen offset:1024 sc1 lds
buffer_load_dwordx4 v2, s[8:11], s37 offen offset:2048 sc1 lds
buffer_load_dwordx4 v2, s[8:11], s37 offen offset:3072 sc1 lds
s_add_u32 s38, s35, 12
s_and_b32 s38, s38, 15
s_lshl_b32 s38, s38, 17
s_add_u32 m0, s40, 114688
s_nop 0
buffer_load_dwordx4 v3, s[12:15], s38 offen lds
s_add_u32 m0, s40, 115712
s_add_u32 s38, s38, 16384
buffer_load_dwordx4 v3, s[12:15], s38 offen lds
v_lshlrev_b32 v24, 16, v144
v_and_b32 v25, 0xffff0000, v144
v_lshlrev_b32 v26, 16, v145
v_and_b32 v27, 0xffff0000, v145
v_lshlrev_b32 v28, 16, v146
v_and_b32 v29, 0xffff0000, v146
v_lshlrev_b32 v30, 16, v147
v_and_b32 v31, 0xffff0000, v147
v_add_f32 v240, v240, v24
v_add_f32 v241, v241, v25
v_add_f32 v242, v242, v26
v_add_f32 v243, v243, v27
v_add_f32 v244, v244, v28
v_add_f32 v245, v245, v29
v_add_f32 v246, v246, v30
v_add_f32 v247, v247, v31
s_load_dword s3, s[4:5], 43136
s_load_dword s3, s[4:5], 43200
s_load_dword s3, s[4:5], 50176
s_waitcnt vmcnt(14)
s_barrier
s_add_u32 s37, s35, 9
s_and_b32 s37, s37, 15
s_lshl_b32 s37, s37, 14
s_add_u32 m0, s39, 49152
s_nop 0
buffer_load_dwordx4 v2, s[8:11], s37 offen offset:0 sc1 lds
buffer_load_dwordx4 v2, s[8:11], s37 offen offset:1024 sc1 lds
buffer_load_dwordx4 v2, s[8:11], s37 offen offset:2048 sc1 lds
buffer_load_dwordx4 v2, s[8:11], s37 offen offset:3072 sc1 lds
s_add_u32 s38, s35, 13
s_and_b32 s38, s38, 15
s_lshl_b32 s38, s38, 17
s_add_u32 m0, s40, 122880
s_nop 0
buffer_load_dwordx4 v3, s[12:15], s38 offen lds
s_add_u32 m0, s40, 123904
s_add_u32 s38, s38, 16384
buffer_load_dwordx4 v3, s[12:15], s38 offen lds
v_lshlrev_b32 v24, 16, v148
v_and_b32 v25, 0xffff0000, v148
v_lshlrev_b32 v26, 16, v149
v_and_b32 v27, 0xffff0000, v149
v_lshlrev_b32 v28, 16, v150
v_and_b32 v29, 0xffff0000, v150
v_lshlrev_b32 v30, 16, v151
v_and_b32 v31, 0xffff0000, v151
v_add_f32 v240, v240, v24
v_add_f32 v241, v241, v25
v_add_f32 v242, v242, v26
v_add_f32 v243, v243, v27
v_add_f32 v244, v244, v28
v_add_f32 v245, v245, v29
v_add_f32 v246, v246, v30
v_add_f32 v247, v247, v31
s_load_dword s3, s[4:5], 50240
s_load_dword s3, s[4:5], 50304
s_load_dword s3, s[4:5], 50368
s_waitcnt vmcnt(14)
s_barrier
s_add_u32 s37, s35, 10
s_and_b32 s37, s37, 15
s_lshl_b32 s37, s37, 14
s_add_u32 m0, s39, 98304
s_nop 0
buffer_load_dwordx4 v2, s[8:11], s37 offen offset:0 sc1 lds
buffer_load_dwordx4 v2, s[8:11], s37 offen offset:1024 sc1 lds
buffer_load_dwordx4 v2, s[8:11], s37 offen offset:2048 sc1 lds
buffer_load_dwordx4 v2, s[8:11], s37 offen offset:3072 sc1 lds
s_add_u32 s38, s35, 14
s_and_b32 s38, s38, 15
s_lshl_b32 s38, s38, 17
s_add_u32 m0, s40, 131072
s_nop 0
buffer_load_dwordx4 v3, s[12:15], s38 offen lds
s_add_u32 m0, s40, 132096
s_add_u32 s38, s38, 16384
buffer_load_dwordx4 v3, s[12:15], s38 offen lds
v_lshlrev_b32 v24, 16, v152
v_and_b32 v25, 0xffff0000, v152
v_lshlrev_b32 v26, 16, v153
v_and_b32 v27, 0xffff0000, v153
v_lshlrev_b32 v28, 16, v154
v_and_b32 v29, 0xffff0000, v154
v_lshlrev_b32 v30, 16, v155
v_and_b32 v31, 0xffff0000, v155
v_add_f32 v240, v240, v24
v_add_f32 v241, v241, v25
v_add_f32 v242, v242, v26
v_add_f32 v243, v243, v27
v_add_f32 v244, v244, v28
v_add_f32 v245, v245, v29
v_add_f32 v246, v246, v30
v_add_f32 v247, v247, v31
s_load_dword s3, s[4:5], 57344
s_load_dword s3, s[4:5], 57408
s_load_dword s3, s[4:5], 57472
s_waitcnt vmcnt(14)
s_barrier
s_add_u32 s37, s35, 11
s_and_b32 s37, s37, 15
s_lshl_b32 s37, s37, 14
s_add_u32 m0, s39, 147456
s_nop 0
buffer_load_dwordx4 v2, s[8:11], s37 offen offset:0 sc1 lds
buffer_load_dwordx4 v2, s[8:11], s37 offen offset:1024 sc1 lds
buffer_load_dwordx4 v2, s[8:11], s37 offen offset:2048 sc1 lds
buffer_load_dwordx4 v2, s[8:11], s37 offen offset:3072 sc1 lds
s_add_u32 s38, s35, 15
s_and_b32 s38, s38, 15
s_lshl_b32 s38, s38, 17
s_add_u32 m0, s40, 139264
s_nop 0
buffer_load_dwordx4 v3, s[12:15], s38 offen lds
s_add_u32 m0, s40, 140288
s_add_u32 s38, s38, 16384
buffer_load_dwordx4 v3, s[12:15], s38 offen lds
v_lshlrev_b32 v24, 16, v156
v_and_b32 v25, 0xffff0000, v156
v_lshlrev_b32 v26, 16, v157
v_and_b32 v27, 0xffff0000, v157
v_lshlrev_b32 v28, 16, v158
v_and_b32 v29, 0xffff0000, v158
v_lshlrev_b32 v30, 16, v159
v_and_b32 v31, 0xffff0000, v159
v_add_f32 v240, v240, v24
v_add_f32 v241, v241, v25
v_add_f32 v242, v242, v26
v_add_f32 v243, v243, v27
v_add_f32 v244, v244, v28
v_add_f32 v245, v245, v29
v_add_f32 v246, v246, v30
v_add_f32 v247, v247, v31
s_load_dword s3, s[4:5], 57536
s_load_dword s3, s[4:5], 64512
s_load_dword s3, s[4:5], 64576
s_waitcnt vmcnt(14)
s_barrier
s_add_u32 s37, s35, 12
s_and_b32 s37, s37, 15
s_lshl_b32 s37, s37, 14
s_add_u32 m0, s39, 0
s_nop 0
buffer_load_dwordx4 v2, s[8:11], s37 offen offset:0 sc1 lds
buffer_load_dwordx4 v2, s[8:11], s37 offen offset:1024 sc1 lds
buffer_load_dwordx4 v2, s[8:11], s37 offen offset:2048 sc1 lds
buffer_load_dwordx4 v2, s[8:11], s37 offen offset:3072 sc1 lds
s_load_dword s3, s[4:5], 64640
s_load_dword s3, s[4:5], 64704
s_load_dword s3, s[4:5], 71680
s_waitcnt vmcnt(12)
s_barrier
s_add_u32 s37, s35, 13
s_and_b32 s37, s37, 15
s_lshl_b32 s37, s37, 14
s_add_u32 m0, s39, 49152
s_nop 0
buffer_load_dwordx4 v2, s[8:11], s37 offen offset:0 sc1 lds
buffer_load_dwordx4 v2, s[8:11], s37 offen offset:1024 sc1 lds
buffer_load_dwordx4 v2, s[8:11], s37 offen offset:2048 sc1 lds
buffer_load_dwordx4 v2, s[8:11], s37 offen offset:3072 sc1 lds
s_load_dword s3, s[4:5], 71744
s_load_dword s3, s[4:5], 71808
s_load_dword s3, s[4:5], 71872
s_waitcnt vmcnt(10)
s_barrier
s_add_u32 s37, s35, 14
s_and_b32 s37, s37, 15
s_lshl_b32 s37, s37, 14
s_add_u32 m0, s39, 98304
s_nop 0
buffer_load_dwordx4 v2, s[8:11], s37 offen offset:0 sc1 lds
buffer_load_dwordx4 v2, s[8:11], s37 offen offset:1024 sc1 lds
buffer_load_dwordx4 v2, s[8:11], s37 offen offset:2048 sc1 lds
buffer_load_dwordx4 v2, s[8:11], s37 offen offset:3072 sc1 lds
s_waitcnt vmcnt(8)
s_barrier
s_add_u32 s37, s35, 15
s_and_b32 s37, s37, 15
s_lshl_b32 s37, s37, 14
s_add_u32 m0, s39, 147456
s_nop 0
buffer_load_dwordx4 v2, s[8:11], s37 offen offset:0 sc1 lds
buffer_load_dwordx4 v2, s[8:11], s37 offen offset:1024 sc1 lds
buffer_load_dwordx4 v2, s[8:11], s37 offen offset:2048 sc1 lds
buffer_load_dwordx4 v2, s[8:11], s37 offen offset:3072 sc1 lds
s_waitcnt vmcnt(8)
s_barrier
s_nop 0
v_permlane32_swap_b32 v240, v244
v_permlane32_swap_b32 v241, v245
v_permlane32_swap_b32 v242, v246
v_permlane32_swap_b32 v243, v247
v_add_f32 v240, v240, v244
v_add_f32 v241, v241, v245
v_add_f32 v242, v242, v246
v_add_f32 v243, v243, v247
s_nop 0
v_permlane16_swap_b32 v240, v242
v_permlane16_swap_b32 v241, v243
v_add_f32 v240, v240, v242
v_add_f32 v241, v241, v243
s_waitcnt vmcnt(4)
s_barrier
s_add_u32 s38, s35, 0
s_and_b32 s38, s38, 15
s_mul_i32 s38, s38, 458752
s_add_u32 m0, s46, 0
s_nop 0
buffer_load_dwordx4 v8, s[88:91], s38 offen lds
s_add_u32 m0, s46, 1024
s_nop 0
buffer_load_dwordx4 v9, s[88:91], s38 offen lds
s_add_u32 m0, s46, 2048
s_nop 0
buffer_load_dwordx4 v10, s[88:91], s38 offen lds
s_add_u32 m0, s46, 3072
s_add_u32 s38, s38, 114688
buffer_load_dwordx4 v8, s[88:91], s38 offen lds
s_add_u32 m0, s46, 4096
s_nop 0
buffer_load_dwordx4 v9, s[88:91], s38 offen lds
s_add_u32 m0, s46, 5120
s_nop 0
buffer_load_dwordx4 v10, s[88:91], s38 offen lds
s_add_u32 s38, s35, 1
s_and_b32 s38, s38, 15
s_mul_i32 s38, s38, 458752
s_add_u32 m0, s46, 49152
s_nop 0
buffer_load_dwordx4 v8, s[88:91], s38 offen lds
s_add_u32 m0, s46, 50176
s_nop 0
buffer_load_dwordx4 v9, s[88:91], s38 offen lds
s_add_u32 m0, s46, 51200
s_nop 0
buffer_load_dwordx4 v10, s[88:91], s38 offen lds
s_add_u32 m0, s46, 52224
s_add_u32 s38, s38, 114688
buffer_load_dwordx4 v8, s[88:91], s38 offen lds
s_add_u32 m0, s46, 53248
s_nop 0
buffer_load_dwordx4 v9, s[88:91], s38 offen lds
s_add_u32 m0, s46, 54272
s_nop 0
buffer_load_dwordx4 v10, s[88:91], s38 offen lds
s_waitcnt vmcnt(12)
s_barrier
s_barrier
s_branch Lk3a
Lk2end_104:
Lk3:
s_branch Lgb_118
Lk3a:
s_mul_i32 s43, s34, 262144
s_add_u32 s8, s82, s43
s_addc_u32 s9, s83, 0
s_add_u32 s8, s8, 4194304
s_addc_u32 s9, s9, 0
s_mov_b32 s10, 262144
s_mov_b32 s11, 0x20000
s_mul_i32 s43, s34, 917504
s_add_u32 s24, s82, s43
s_addc_u32 s25, s83, 0
s_add_u32 s24, s24, 8388608
s_addc_u32 s25, s25, 0
s_mov_b32 s26, 917504
s_mov_b32 s27, 0x20000
s_add_u32 s84, s82, 27262976
s_addc_u32 s85, s83, 0
s_mov_b32 s86, 229376
s_mov_b32 s87, 0x20000
s_and_b32 s47, s36, 3
s_lshr_b32 s62, s47, 1
s_and_b32 s63, s47, 1
v_lshlrev_b32 v2, 4, v1
s_lshl_b32 s39, s47, 12
v_add_u32 v3, s39, v2
s_cmp_eq_u32 s62, 0
s_cselect_b32 s44, s72, s74
s_cselect_b32 s45, s73, s75
s_lshl_b32 s43, s35, 8
s_add_u32 s12, s44, s43
s_addc_u32 s13, s45, 0
s_mov_b32 s14, 7333120
s_mov_b32 s15, 0x20000
v_lshrrev_b32 v28, 4, v1
v_lshlrev_b32 v29, 1, v28
v_and_b32 v4, 15, v1
v_xor_b32 v4, v4, v29
v_lshlrev_b32 v4, 4, v4
v_mul_u32_u24 v28, 7168, v28
v_add_u32 v4, v4, v28
s_mul_i32 s43, s63, 229376
v_add_u32 v4, s43, v4
v_xor_b32 v5, 128, v4
v_add_u32 v5, 28672, v5
s_lshl_b32 s40, s47, 13
s_add_u32 s40, s40, 16384
s_lshl_b32 s43, s62, 12
v_add_u32 v9, s43, v2
v_add_u32 v10, 98304, v9
s_lshl_b32 s43, s47, 9
s_add_u32 s43, s43, 151552
v_and_b32 v28, 15, v1
v_lshl_add_u32 v28, v28, 5, s43
v_lshrrev_b32 v29, 4, v1
v_lshl_add_u32 v28, v29, 3, v28
ds_write_b64 v28, v[240:241]
s_waitcnt lgkmcnt(0)
v_lshrrev_b32 v27, 2, v1
v_bfe_u32 v28, v27, 2, 1
v_mul_u32_u24 v27, 192, v27
v_add_u32 v27, 16384, v27
v_and_b32 v29, 3, v1
v_lshl_add_u32 v12, v29, 3, v27
s_lshl_b32 s43, s63, 6
v_add_u32 v12, s43, v12
v_lshl_add_u32 v11, v28, 5, v12
v_xor_b32 v30, 1, v28
v_lshl_add_u32 v12, v30, 5, v12
v_xor_b32 v28, s63, v28
v_lshl_add_u32 v27, v28, 4, v27
v_lshrrev_b32 v28, 1, v29
v_lshl_add_u32 v27, v28, 5, v27
v_and_b32 v28, 1, v29
v_lshl_add_u32 v27, v28, 3, v27
v_add_u32 v13, 128, v27
v_add_u32 v14, 49152, v11
v_add_u32 v15, 49152, v12
v_add_u32 v16, 49152, v13
v_add_u32 v17, 98304, v11
v_add_u32 v18, 98304, v12
v_add_u32 v19, 98304, v13
v_bfe_u32 v28, v1, 3, 1
v_lshlrev_b32 v28, 6, v28
v_bfe_u32 v29, v1, 1, 2
s_lshl_b32 s43, s48, 3
s_lshl_b32 s44, s63, 2
s_add_u32 s43, s43, s44
v_add3_u32 v28, v28, v29, s43
v_mul_u32_u24 v28, 7168, v28
v_and_b32 v29, 1, v1
v_mul_u32_u24 v29, 188, v29
v_add_u32 v20, v28, v29
s_cmp_lg_u32 s36, 4
s_cbranch_scc1 Lwm_120
s_branch Lst_8_1
Lwr_186:
s_branch Lwe_119
Lwm_120:
s_cmp_lg_u32 s36, 5
s_cbranch_scc1 Lwm_121
s_branch Lst_9_1
Lwr_187:
s_branch Lwe_119
Lwm_121:
s_cmp_lg_u32 s36, 6
s_cbranch_scc1 Lwm_122
s_branch Lst_10_1
Lwr_188:
s_branch Lwe_119
Lwm_122:
s_cmp_lg_u32 s36, 7
s_cbranch_scc1 Lwm_123
s_nop 0
s_branch Lwe_119
Lwm_123:
Lwe_119:
s_barrier
s_cmp_lg_u32 s36, 4
s_cbranch_scc1 Lwm_125
s_branch Lst_11_1
Lwr_190:
s_branch Lwe_124
Lwm_125:
s_cmp_lg_u32 s36, 5
s_cbranch_scc1 Lwm_126
s_branch Lst_12_1
Lwr_191:
s_branch Lwe_124
Lwm_126:
s_cmp_lg_u32 s36, 6
s_cbranch_scc1 Lwm_127
s_branch Lst_13_1
Lwr_192:
s_branch Lwe_124
Lwm_127:
s_cmp_lg_u32 s36, 7
s_cbranch_scc1 Lwm_128
s_branch Lst_14_1
Lwr_193:
s_branch Lwe_124
Lwm_128:
Lwe_124:
s_waitcnt vmcnt(0) lgkmcnt(0)
s_barrier
ds_read_b128 v[32:35], v9 offset:0
ds_read_b64_tr_b16 v[48:49], v11 offset:0
ds_read_b64_tr_b16 v[50:51], v11 offset:3072
ds_read_b64_tr_b16 v[52:53], v12 offset:0
ds_read_b64_tr_b16 v[54:55], v12 offset:3072
ds_read_b64_tr_b16 v[56:57], v13 offset:0
ds_read_b64_tr_b16 v[58:59], v13 offset:3072
ds_read_b64_tr_b16 v[60:61], v11 offset:12288
ds_read_b64_tr_b16 v[62:63], v11 offset:15360
ds_read_b64_tr_b16 v[64:65], v12 offset:12288
ds_read_b64_tr_b16 v[66:67], v12 offset:15360
ds_read_b64_tr_b16 v[68:69], v13 offset:12288
ds_read_b64_tr_b16 v[70:71], v13 offset:15360
ds_read_b128 v[36:39], v9 offset:1024
ds_read_b128 v[40:43], v9 offset:2048
ds_read_b128 v[44:47], v9 offset:3072
s_waitcnt lgkmcnt(0)
v_mfma_f32_16x16x32_bf16 v[128:131], v[48:51], v[32:35], 0
ds_read_b128 v[72:75], v9 offset:8192
v_mfma_f32_16x16x32_bf16 v[132:135], v[52:55], v[32:35], 0
ds_read_b64_tr_b16 v[88:89], v11 offset:6144
v_mfma_f32_16x16x32_bf16 v[136:139], v[56:59], v[32:35], 0
ds_read_b64_tr_b16 v[90:91], v11 offset:9216
v_mfma_f32_16x16x32_bf16 v[140:143], v[60:63], v[32:35], 0
ds_read_b64_tr_b16 v[92:93], v12 offset:6144
v_mfma_f32_16x16x32_bf16 v[144:147], v[64:67], v[32:35], 0
ds_read_b64_tr_b16 v[94:95], v12 offset:9216
v_mfma_f32_16x16x32_bf16 v[148:151], v[68:71], v[32:35], 0
ds_read_b64_tr_b16 v[96:97], v13 offset:6144
v_mfma_f32_16x16x32_bf16 v[172:175], v[68:71], v[36:39], 0
ds_read_b64_tr_b16 v[98:99], v13 offset:9216
v_mfma_f32_16x16x32_bf16 v[168:171], v[64:67], v[36:39], 0
ds_read_b64_tr_b16 v[100:101], v11 offset:18432
v_mfma_f32_16x16x32_bf16 v[164:167], v[60:63], v[36:39], 0
ds_read_b64_tr_b16 v[102:103], v11 offset:21504
v_mfma_f32_16x16x32_bf16 v[160:163], v[56:59], v[36:39], 0
ds_read_b64_tr_b16 v[104:105], v12 offset:18432
v_mfma_f32_16x16x32_bf16 v[156:159], v[52:55], v[36:39], 0
ds_read_b64_tr_b16 v[106:107], v12 offset:21504
v_mfma_f32_16x16x32_bf16 v[152:155], v[48:51], v[36:39], 0
ds_read_b64_tr_b16 v[108:109], v13 offset:18432
v_mfma_f32_16x16x32_bf16 v[176:179], v[48:51], v[40:43], 0
ds_read_b64_tr_b16 v[110:111], v13 offset:21504
v_mfma_f32_16x16x32_bf16 v[180:183], v[52:55], v[40:43], 0
ds_read_b128 v[76:79], v9 offset:9216
v_mfma_f32_16x16x32_bf16 v[184:187], v[56:59], v[40:43], 0
ds_read_b128 v[80:83], v9 offset:10240
v_mfma_f32_16x16x32_bf16 v[188:191], v[60:63], v[40:43], 0
ds_read_b128 v[84:87], v9 offset:11264
v_mfma_f32_16x16x32_bf16 v[192:195], v[64:67], v[40:43], 0
v_mfma_f32_16x16x32_bf16 v[196:199], v[68:71], v[40:43], 0
v_mfma_f32_16x16x32_bf16 v[220:223], v[68:71], v[44:47], 0
v_mfma_f32_16x16x32_bf16 v[216:219], v[64:67], v[44:47], 0
v_mfma_f32_16x16x32_bf16 v[212:215], v[60:63], v[44:47], 0
v_mfma_f32_16x16x32_bf16 v[208:211], v[56:59], v[44:47], 0
v_mfma_f32_16x16x32_bf16 v[204:207], v[52:55], v[44:47], 0
v_mfma_f32_16x16x32_bf16 v[200:203], v[48:51], v[44:47], 0
s_waitcnt lgkmcnt(0)
s_barrier
v_mfma_f32_16x16x32_bf16 v[128:131], v[88:91], v[72:75], v[128:131]
ds_read_b128 v[32:35], v9 offset:49152
v_mfma_f32_16x16x32_bf16 v[132:135], v[92:95], v[72:75], v[132:135]
ds_read_b64_tr_b16 v[48:49], v14 offset:0
v_mfma_f32_16x16x32_bf16 v[136:139], v[96:99], v[72:75], v[136:139]
ds_read_b64_tr_b16 v[50:51], v14 offset:3072
v_mfma_f32_16x16x32_bf16 v[140:143], v[100:103], v[72:75], v[140:143]
ds_read_b64_tr_b16 v[52:53], v15 offset:0
v_mfma_f32_16x16x32_bf16 v[144:147], v[104:107], v[72:75], v[144:147]
ds_read_b64_tr_b16 v[54:55], v15 offset:3072
v_mfma_f32_16x16x32_bf16 v[148:151], v[108:111], v[72:75], v[148:151]
ds_read_b64_tr_b16 v[56:57], v16 offset:0
v_mfma_f32_16x16x32_bf16 v[172:175], v[108:111], v[76:79], v[172:175]
ds_read_b64_tr_b16 v[58:59], v16 offset:3072
v_mfma_f32_16x16x32_bf16 v[168:171], v[104:107], v[76:79], v[168:171]
ds_read_b64_tr_b16 v[60:61], v14 offset:12288
v_mfma_f32_16x16x32_bf16 v[164:167], v[100:103], v[76:79], v[164:167]
ds_read_b64_tr_b16 v[62:63], v14 offset:15360
v_mfma_f32_16x16x32_bf16 v[160:163], v[96:99], v[76:79], v[160:163]
ds_read_b64_tr_b16 v[64:65], v15 offset:12288
v_mfma_f32_16x16x32_bf16 v[156:159], v[92:95], v[76:79], v[156:159]
ds_read_b64_tr_b16 v[66:67], v15 offset:15360
v_mfma_f32_16x16x32_bf16 v[152:155], v[88:91], v[76:79], v[152:155]
ds_read_b64_tr_b16 v[68:69], v16 offset:12288
v_mfma_f32_16x16x32_bf16 v[176:179], v[88:91], v[80:83], v[176:179]
ds_read_b64_tr_b16 v[70:71], v16 offset:15360
v_mfma_f32_16x16x32_bf16 v[180:183], v[92:95], v[80:83], v[180:183]
ds_read_b128 v[36:39], v9 offset:50176
v_mfma_f32_16x16x32_bf16 v[184:187], v[96:99], v[80:83], v[184:187]
ds_read_b128 v[40:43], v9 offset:51200
v_mfma_f32_16x16x32_bf16 v[188:191], v[100:103], v[80:83], v[188:191]
ds_read_b128 v[44:47], v9 offset:52224
v_mfma_f32_16x16x32_bf16 v[192:195], v[104:107], v[80:83], v[192:195]
v_mfma_f32_16x16x32_bf16 v[196:199], v[108:111], v[80:83], v[196:199]
v_mfma_f32_16x16x32_bf16 v[220:223], v[108:111], v[84:87], v[220:223]
v_mfma_f32_16x16x32_bf16 v[216:219], v[104:107], v[84:87], v[216:219]
v_mfma_f32_16x16x32_bf16 v[212:215], v[100:103], v[84:87], v[212:215]
v_mfma_f32_16x16x32_bf16 v[208:211], v[96:99], v[84:87], v[208:211]
v_mfma_f32_16x16x32_bf16 v[204:207], v[92:95], v[84:87], v[204:207]
v_mfma_f32_16x16x32_bf16 v[200:203], v[88:91], v[84:87], v[200:203]
s_mov_b32 s41, 5
Lk3l_129:
s_waitcnt lgkmcnt(0)
v_mfma_f32_16x16x32_bf16 v[128:131], v[48:51], v[32:35], v[128:131]
ds_read_b128 v[72:75], v9 offset:57344
v_mfma_f32_16x16x32_bf16 v[132:135], v[52:55], v[32:35], v[132:135]
ds_read_b64_tr_b16 v[88:89], v14 offset:6144
v_mfma_f32_16x16x32_bf16 v[136:139], v[56:59], v[32:35], v[136:139]
ds_read_b64_tr_b16 v[90:91], v14 offset:9216
v_mfma_f32_16x16x32_bf16 v[140:143], v[60:63], v[32:35], v[140:143]
ds_read_b64_tr_b16 v[92:93], v15 offset:6144
v_mfma_f32_16x16x32_bf16 v[144:147], v[64:67], v[32:35], v[144:147]
ds_read_b64_tr_b16 v[94:95], v15 offset:9216
v_mfma_f32_16x16x32_bf16 v[148:151], v[68:71], v[32:35], v[148:151]
ds_read_b64_tr_b16 v[96:97], v16 offset:6144
v_mfma_f32_16x16x32_bf16 v[172:175], v[68:71], v[36:39], v[172:175]
ds_read_b64_tr_b16 v[98:99], v16 offset:9216
v_mfma_f32_16x16x32_bf16 v[168:171], v[64:67], v[36:39], v[168:171]
ds_read_b64_tr_b16 v[100:101], v14 offset:18432
v_mfma_f32_16x16x32_bf16 v[164:167], v[60:63], v[36:39], v[164:167]
ds_read_b64_tr_b16 v[102:103], v14 offset:21504
v_mfma_f32_16x16x32_bf16 v[160:163], v[56:59], v[36:39], v[160:163]
ds_read_b64_tr_b16 v[104:105], v15 offset:18432
v_mfma_f32_16x16x32_bf16 v[156:159], v[52:55], v[36:39], v[156:159]
ds_read_b64_tr_b16 v[106:107], v15 offset:21504
v_mfma_f32_16x16x32_bf16 v[152:155], v[48:51], v[36:39], v[152:155]
ds_read_b64_tr_b16 v[108:109], v16 offset:18432
v_mfma_f32_16x16x32_bf16 v[176:179], v[48:51], v[40:43], v[176:179]
ds_read_b64_tr_b16 v[110:111], v16 offset:21504
v_mfma_f32_16x16x32_bf16 v[180:183], v[52:55], v[40:43], v[180:183]
ds_read_b128 v[76:79], v9 offset:58368
v_mfma_f32_16x16x32_bf16 v[184:187], v[56:59], v[40:43], v[184:187]
ds_read_b128 v[80:83], v9 offset:59392
v_mfma_f32_16x16x32_bf16 v[188:191], v[60:63], v[40:43], v[188:191]
ds_read_b128 v[84:87], v9 offset:60416
v_mfma_f32_16x16x32_bf16 v[192:195], v[64:67], v[40:43], v[192:195]
v_mfma_f32_16x16x32_bf16 v[196:199], v[68:71], v[40:43], v[196:199]
v_mfma_f32_16x16x32_bf16 v[220:223], v[68:71], v[44:47], v[220:223]
v_mfma_f32_16x16x32_bf16 v[216:219], v[64:67], v[44:47], v[216:219]
v_mfma_f32_16x16x32_bf16 v[212:215], v[60:63], v[44:47], v[212:215]
v_mfma_f32_16x16x32_bf16 v[208:211], v[56:59], v[44:47], v[208:211]
v_mfma_f32_16x16x32_bf16 v[204:207], v[52:55], v[44:47], v[204:207]
v_mfma_f32_16x16x32_bf16 v[200:203], v[48:51], v[44:47], v[200:203]
s_waitcnt lgkmcnt(0)
s_barrier
v_mfma_f32_16x16x32_bf16 v[128:131], v[88:91], v[72:75], v[128:131]
ds_read_b128 v[32:35], v10 offset:0
v_mfma_f32_16x16x32_bf16 v[132:135], v[92:95], v[72:75], v[132:135]
ds_read_b64_tr_b16 v[48:49], v17 offset:0
v_mfma_f32_16x16x32_bf16 v[136:139], v[96:99], v[72:75], v[136:139]
ds_read_b64_tr_b16 v[50:51], v17 offset:3072
v_mfma_f32_16x16x32_bf16 v[140:143], v[100:103], v[72:75], v[140:143]
ds_read_b64_tr_b16 v[52:53], v18 offset:0
v_mfma_f32_16x16x32_bf16 v[144:147], v[104:107], v[72:75], v[144:147]
ds_read_b64_tr_b16 v[54:55], v18 offset:3072
v_mfma_f32_16x16x32_bf16 v[148:151], v[108:111], v[72:75], v[148:151]
ds_read_b64_tr_b16 v[56:57], v19 offset:0
v_mfma_f32_16x16x32_bf16 v[172:175], v[108:111], v[76:79], v[172:175]
ds_read_b64_tr_b16 v[58:59], v19 offset:3072
v_mfma_f32_16x16x32_bf16 v[168:171], v[104:107], v[76:79], v[168:171]
ds_read_b64_tr_b16 v[60:61], v17 offset:12288
v_mfma_f32_16x16x32_bf16 v[164:167], v[100:103], v[76:79], v[164:167]
ds_read_b64_tr_b16 v[62:63], v17 offset:15360
v_mfma_f32_16x16x32_bf16 v[160:163], v[96:99], v[76:79], v[160:163]
ds_read_b64_tr_b16 v[64:65], v18 offset:12288
v_mfma_f32_16x16x32_bf16 v[156:159], v[92:95], v[76:79], v[156:159]
ds_read_b64_tr_b16 v[66:67], v18 offset:15360
v_mfma_f32_16x16x32_bf16 v[152:155], v[88:91], v[76:79], v[152:155]
ds_read_b64_tr_b16 v[68:69], v19 offset:12288
v_mfma_f32_16x16x32_bf16 v[176:179], v[88:91], v[80:83], v[176:179]
ds_read_b64_tr_b16 v[70:71], v19 offset:15360
v_mfma_f32_16x16x32_bf16 v[180:183], v[92:95], v[80:83], v[180:183]
ds_read_b128 v[36:39], v10 offset:1024
v_mfma_f32_16x16x32_bf16 v[184:187], v[96:99], v[80:83], v[184:187]
ds_read_b128 v[40:43], v10 offset:2048
v_mfma_f32_16x16x32_bf16 v[188:191], v[100:103], v[80:83], v[188:191]
ds_read_b128 v[44:47], v10 offset:3072
v_mfma_f32_16x16x32_bf16 v[192:195], v[104:107], v[80:83], v[192:195]
v_mfma_f32_16x16x32_bf16 v[196:199], v[108:111], v[80:83], v[196:199]
v_mfma_f32_16x16x32_bf16 v[220:223], v[108:111], v[84:87], v[220:223]
v_mfma_f32_16x16x32_bf16 v[216:219], v[104:107], v[84:87], v[216:219]
v_mfma_f32_16x16x32_bf16 v[212:215], v[100:103], v[84:87], v[212:215]
v_mfma_f32_16x16x32_bf16 v[208:211], v[96:99], v[84:87], v[208:211]
v_mfma_f32_16x16x32_bf16 v[204:207], v[92:95], v[84:87], v[204:207]
v_mfma_f32_16x16x32_bf16 v[200:203], v[88:91], v[84:87], v[200:203]
s_waitcnt lgkmcnt(0)
v_mfma_f32_16x16x32_bf16 v[128:131], v[48:51], v[32:35], v[128:131]
ds_read_b128 v[72:75], v10 offset:8192
v_mfma_f32_16x16x32_bf16 v[132:135], v[52:55], v[32:35], v[132:135]
ds_read_b64_tr_b16 v[88:89], v17 offset:6144
v_mfma_f32_16x16x32_bf16 v[136:139], v[56:59], v[32:35], v[136:139]
ds_read_b64_tr_b16 v[90:91], v17 offset:9216
v_mfma_f32_16x16x32_bf16 v[140:143], v[60:63], v[32:35], v[140:143]
ds_read_b64_tr_b16 v[92:93], v18 offset:6144
v_mfma_f32_16x16x32_bf16 v[144:147], v[64:67], v[32:35], v[144:147]
ds_read_b64_tr_b16 v[94:95], v18 offset:9216
v_mfma_f32_16x16x32_bf16 v[148:151], v[68:71], v[32:35], v[148:151]
ds_read_b64_tr_b16 v[96:97], v19 offset:6144
v_mfma_f32_16x16x32_bf16 v[172:175], v[68:71], v[36:39], v[172:175]
ds_read_b64_tr_b16 v[98:99], v19 offset:9216
v_mfma_f32_16x16x32_bf16 v[168:171], v[64:67], v[36:39], v[168:171]
ds_read_b64_tr_b16 v[100:101], v17 offset:18432
v_mfma_f32_16x16x32_bf16 v[164:167], v[60:63], v[36:39], v[164:167]
ds_read_b64_tr_b16 v[102:103], v17 offset:21504
v_mfma_f32_16x16x32_bf16 v[160:163], v[56:59], v[36:39], v[160:163]
ds_read_b64_tr_b16 v[104:105], v18 offset:18432
v_mfma_f32_16x16x32_bf16 v[156:159], v[52:55], v[36:39], v[156:159]
ds_read_b64_tr_b16 v[106:107], v18 offset:21504
v_mfma_f32_16x16x32_bf16 v[152:155], v[48:51], v[36:39], v[152:155]
ds_read_b64_tr_b16 v[108:109], v19 offset:18432
v_mfma_f32_16x16x32_bf16 v[176:179], v[48:51], v[40:43], v[176:179]
ds_read_b64_tr_b16 v[110:111], v19 offset:21504
v_mfma_f32_16x16x32_bf16 v[180:183], v[52:55], v[40:43], v[180:183]
ds_read_b128 v[76:79], v10 offset:9216
v_mfma_f32_16x16x32_bf16 v[184:187], v[56:59], v[40:43], v[184:187]
ds_read_b128 v[80:83], v10 offset:10240
v_mfma_f32_16x16x32_bf16 v[188:191], v[60:63], v[40:43], v[188:191]
s_branch Lov_8
.p2align 12
Lst_8_0:
s_branch Lwr_175
Lst_8_1:
s_branch Lwr_186
s_nop 0
Lov_8:
ds_read_b128 v[84:87], v10 offset:11264
v_mfma_f32_16x16x32_bf16 v[192:195], v[64:67], v[40:43], v[192:195]
v_mfma_f32_16x16x32_bf16 v[196:199], v[68:71], v[40:43], v[196:199]
v_mfma_f32_16x16x32_bf16 v[220:223], v[68:71], v[44:47], v[220:223]
v_mfma_f32_16x16x32_bf16 v[216:219], v[64:67], v[44:47], v[216:219]
v_mfma_f32_16x16x32_bf16 v[212:215], v[60:63], v[44:47], v[212:215]
v_mfma_f32_16x16x32_bf16 v[208:211], v[56:59], v[44:47], v[208:211]
v_mfma_f32_16x16x32_bf16 v[204:207], v[52:55], v[44:47], v[204:207]
v_mfma_f32_16x16x32_bf16 v[200:203], v[48:51], v[44:47], v[200:203]
s_waitcnt lgkmcnt(0)
s_barrier
v_mfma_f32_16x16x32_bf16 v[128:131], v[88:91], v[72:75], v[128:131]
ds_read_b128 v[32:35], v9 offset:0
v_mfma_f32_16x16x32_bf16 v[132:135], v[92:95], v[72:75], v[132:135]
ds_read_b64_tr_b16 v[48:49], v11 offset:0
v_mfma_f32_16x16x32_bf16 v[136:139], v[96:99], v[72:75], v[136:139]
ds_read_b64_tr_b16 v[50:51], v11 offset:3072
v_mfma_f32_16x16x32_bf16 v[140:143], v[100:103], v[72:75], v[140:143]
ds_read_b64_tr_b16 v[52:53], v12 offset:0
v_mfma_f32_16x16x32_bf16 v[144:147], v[104:107], v[72:75], v[144:147]
ds_read_b64_tr_b16 v[54:55], v12 offset:3072
v_mfma_f32_16x16x32_bf16 v[148:151], v[108:111], v[72:75], v[148:151]
ds_read_b64_tr_b16 v[56:57], v13 offset:0
v_mfma_f32_16x16x32_bf16 v[172:175], v[108:111], v[76:79], v[172:175]
ds_read_b64_tr_b16 v[58:59], v13 offset:3072
v_mfma_f32_16x16x32_bf16 v[168:171], v[104:107], v[76:79], v[168:171]
ds_read_b64_tr_b16 v[60:61], v11 offset:12288
v_mfma_f32_16x16x32_bf16 v[164:167], v[100:103], v[76:79], v[164:167]
ds_read_b64_tr_b16 v[62:63], v11 offset:15360
v_mfma_f32_16x16x32_bf16 v[160:163], v[96:99], v[76:79], v[160:163]
ds_read_b64_tr_b16 v[64:65], v12 offset:12288
v_mfma_f32_16x16x32_bf16 v[156:159], v[92:95], v[76:79], v[156:159]
ds_read_b64_tr_b16 v[66:67], v12 offset:15360
v_mfma_f32_16x16x32_bf16 v[152:155], v[88:91], v[76:79], v[152:155]
ds_read_b64_tr_b16 v[68:69], v13 offset:12288
v_mfma_f32_16x16x32_bf16 v[176:179], v[88:91], v[80:83], v[176:179]
ds_read_b64_tr_b16 v[70:71], v13 offset:15360
v_mfma_f32_16x16x32_bf16 v[180:183], v[92:95], v[80:83], v[180:183]
ds_read_b128 v[36:39], v9 offset:1024
v_mfma_f32_16x16x32_bf16 v[184:187], v[96:99], v[80:83], v[184:187]
ds_read_b128 v[40:43], v9 offset:2048
v_mfma_f32_16x16x32_bf16 v[188:191], v[100:103], v[80:83], v[188:191]
ds_read_b128 v[44:47], v9 offset:3072
v_mfma_f32_16x16x32_bf16 v[192:195], v[104:107], v[80:83], v[192:195]
v_mfma_f32_16x16x32_bf16 v[196:199], v[108:111], v[80:83], v[196:199]
v_mfma_f32_16x16x32_bf16 v[220:223], v[108:111], v[84:87], v[220:223]
v_mfma_f32_16x16x32_bf16 v[216:219], v[104:107], v[84:87], v[216:219]
v_mfma_f32_16x16x32_bf16 v[212:215], v[100:103], v[84:87], v[212:215]
v_mfma_f32_16x16x32_bf16 v[208:211], v[96:99], v[84:87], v[208:211]
v_mfma_f32_16x16x32_bf16 v[204:207], v[92:95], v[84:87], v[204:207]
v_mfma_f32_16x16x32_bf16 v[200:203], v[88:91], v[84:87], v[200:203]
s_waitcnt lgkmcnt(0)
v_mfma_f32_16x16x32_bf16 v[128:131], v[48:51], v[32:35], v[128:131]
ds_read_b128 v[72:75], v9 offset:8192
v_mfma_f32_16x16x32_bf16 v[132:135], v[52:55], v[32:35], v[132:135]
ds_read_b64_tr_b16 v[88:89], v11 offset:6144
v_mfma_f32_16x16x32_bf16 v[136:139], v[56:59], v[32:35], v[136:139]
ds_read_b64_tr_b16 v[90:91], v11 offset:9216
v_mfma_f32_16x16x32_bf16 v[140:143], v[60:63], v[32:35], v[140:143]
ds_read_b64_tr_b16 v[92:93], v12 offset:6144
v_mfma_f32_16x16x32_bf16 v[144:147], v[64:67], v[32:35], v[144:147]
ds_read_b64_tr_b16 v[94:95], v12 offset:9216
v_mfma_f32_16x16x32_bf16 v[148:151], v[68:71], v[32:35], v[148:151]
ds_read_b64_tr_b16 v[96:97], v13 offset:6144
v_mfma_f32_16x16x32_bf16 v[172:175], v[68:71], v[36:39], v[172:175]
ds_read_b64_tr_b16 v[98:99], v13 offset:9216
v_mfma_f32_16x16x32_bf16 v[168:171], v[64:67], v[36:39], v[168:171]
ds_read_b64_tr_b16 v[100:101], v11 offset:18432
v_mfma_f32_16x16x32_bf16 v[164:167], v[60:63], v[36:39], v[164:167]
ds_read_b64_tr_b16 v[102:103], v11 offset:21504
v_mfma_f32_16x16x32_bf16 v[160:163], v[56:59], v[36:39], v[160:163]
ds_read_b64_tr_b16 v[104:105], v12 offset:18432
v_mfma_f32_16x16x32_bf16 v[156:159], v[52:55], v[36:39], v[156:159]
ds_read_b64_tr_b16 v[106:107], v12 offset:21504
v_mfma_f32_16x16x32_bf16 v[152:155], v[48:51], v[36:39], v[152:155]
ds_read_b64_tr_b16 v[108:109], v13 offset:18432
v_mfma_f32_16x16x32_bf16 v[176:179], v[48:51], v[40:43], v[176:179]
ds_read_b64_tr_b16 v[110:111], v13 offset:21504
v_mfma_f32_16x16x32_bf16 v[180:183], v[52:55], v[40:43], v[180:183]
ds_read_b128 v[76:79], v9 offset:9216
v_mfma_f32_16x16x32_bf16 v[184:187], v[56:59], v[40:43], v[184:187]
ds_read_b128 v[80:83], v9 offset:10240
v_mfma_f32_16x16x32_bf16 v[188:191], v[60:63], v[40:43], v[188:191]
ds_read_b128 v[84:87], v9 offset:11264
v_mfma_f32_16x16x32_bf16 v[192:195], v[64:67], v[40:43], v[192:195]
v_mfma_f32_16x16x32_bf16 v[196:199], v[68:71], v[40:43], v[196:199]
v_mfma_f32_16x16x32_bf16 v[220:223], v[68:71], v[44:47], v[220:223]
v_mfma_f32_16x16x32_bf16 v[216:219], v[64:67], v[44:47], v[216:219]
v_mfma_f32_16x16x32_bf16 v[212:215], v[60:63], v[44:47], v[212:215]
v_mfma_f32_16x16x32_bf16 v[208:211], v[56:59], v[44:47], v[208:211]
v_mfma_f32_16x16x32_bf16 v[204:207], v[52:55], v[44:47], v[204:207]
v_mfma_f32_16x16x32_bf16 v[200:203], v[48:51], v[44:47], v[200:203]
s_waitcnt lgkmcnt(0)
s_barrier
v_mfma_f32_16x16x32_bf16 v[128:131], v[88:91], v[72:75], v[128:131]
ds_read_b128 v[32:35], v9 offset:49152
v_mfma_f32_16x16x32_bf16 v[132:135], v[92:95], v[72:75], v[132:135]
ds_read_b64_tr_b16 v[48:49], v14 offset:0
v_mfma_f32_16x16x32_bf16 v[136:139], v[96:99], v[72:75], v[136:139]
ds_read_b64_tr_b16 v[50:51], v14 offset:3072
v_mfma_f32_16x16x32_bf16 v[140:143], v[100:103], v[72:75], v[140:143]
ds_read_b64_tr_b16 v[52:53], v15 offset:0
v_mfma_f32_16x16x32_bf16 v[144:147], v[104:107], v[72:75], v[144:147]
ds_read_b64_tr_b16 v[54:55], v15 offset:3072
v_mfma_f32_16x16x32_bf16 v[148:151], v[108:111], v[72:75], v[148:151]
ds_read_b64_tr_b16 v[56:57], v16 offset:0
v_mfma_f32_16x16x32_bf16 v[172:175], v[108:111], v[76:79], v[172:175]
ds_read_b64_tr_b16 v[58:59], v16 offset:3072
v_mfma_f32_16x16x32_bf16 v[168:171], v[104:107], v[76:79], v[168:171]
ds_read_b64_tr_b16 v[60:61], v14 offset:12288
v_mfma_f32_16x16x32_bf16 v[164:167], v[100:103], v[76:79], v[164:167]
ds_read_b64_tr_b16 v[62:63], v14 offset:15360
v_mfma_f32_16x16x32_bf16 v[160:163], v[96:99], v[76:79], v[160:163]
ds_read_b64_tr_b16 v[64:65], v15 offset:12288
v_mfma_f32_16x16x32_bf16 v[156:159], v[92:95], v[76:79], v[156:159]
ds_read_b64_tr_b16 v[66:67], v15 offset:15360
v_mfma_f32_16x16x32_bf16 v[152:155], v[88:91], v[76:79], v[152:155]
ds_read_b64_tr_b16 v[68:69], v16 offset:12288
v_mfma_f32_16x16x32_bf16 v[176:179], v[88:91], v[80:83], v[176:179]
ds_read_b64_tr_b16 v[70:71], v16 offset:15360
v_mfma_f32_16x16x32_bf16 v[180:183], v[92:95], v[80:83], v[180:183]
ds_read_b128 v[36:39], v9 offset:50176
v_mfma_f32_16x16x32_bf16 v[184:187], v[96:99], v[80:83], v[184:187]
ds_read_b128 v[40:43], v9 offset:51200
v_mfma_f32_16x16x32_bf16 v[188:191], v[100:103], v[80:83], v[188:191]
ds_read_b128 v[44:47], v9 offset:52224
v_mfma_f32_16x16x32_bf16 v[192:195], v[104:107], v[80:83], v[192:195]
v_mfma_f32_16x16x32_bf16 v[196:199], v[108:111], v[80:83], v[196:199]
v_mfma_f32_16x16x32_bf16 v[220:223], v[108:111], v[84:87], v[220:223]
v_mfma_f32_16x16x32_bf16 v[216:219], v[104:107], v[84:87], v[216:219]
v_mfma_f32_16x16x32_bf16 v[212:215], v[100:103], v[84:87], v[212:215]
v_mfma_f32_16x16x32_bf16 v[208:211], v[96:99], v[84:87], v[208:211]
v_mfma_f32_16x16x32_bf16 v[204:207], v[92:95], v[84:87], v[204:207]
v_mfma_f32_16x16x32_bf16 v[200:203], v[88:91], v[84:87], v[200:203]
s_sub_u32 s41, s41, 1
s_cmp_lg_u32 s41, 0
s_cbranch_scc1 Lk3l_129
s_waitcnt lgkmcnt(0)
s_mov_b32 s28, s76
s_mov_b32 s29, s77
s_mov_b32 s30, 7340032
s_mov_b32 s31, 0x20000
s_add_u32 s37, s35, 2
s_and_b32 s37, s37, 15
s_mul_i32 s37, s37, 16384
s_add_u32 m0, s39, 0
s_nop 0
buffer_load_dwordx4 v3, s[8:11], s37 offen sc1 lds
v_lshrrev_b32 v86, 4, v1
s_lshl_b32 s43, s63, 7
s_add_u32 s43, s43, 148992
buffer_load_dwordx4 v3, s[8:11], s37 offen offset:1024 sc1 lds
v_lshl_add_u32 v87, v86, 4, s43
v_lshrrev_b32 v88, 1, v86
v_and_b32 v86, 1, v86
s_lshl_b32 s43, s63, 5
buffer_load_dwordx4 v3, s[8:11], s37 offen offset:2048 sc1 lds
s_add_u32 s43, s43, 149248
v_lshl_add_u32 v88, v88, 6, s43
v_lshl_add_u32 v88, v86, 4, v88
v_and_b32 v86, 15, v1
buffer_load_dwordx4 v3, s[8:11], s37 offen offset:3072 sc1 lds
s_lshl_b32 s43, s62, 9
s_add_u32 s43, s43, 147456
v_lshl_add_u32 v86, v86, 3, s43
s_add_u32 s38, s35, 2
s_and_b32 s38, s38, 15
s_mul_i32 s38, s38, 458752
s_add_u32 m0, s40, 0
s_nop 0
buffer_load_dwordx4 v4, s[12:15], s38 offen lds
ds_read_b128 v[32:35], v87 offset:0
ds_read_b128 v[36:39], v87 offset:64
ds_read_b128 v[40:43], v88 offset:0
ds_read_b128 v[44:47], v87 offset:896
s_add_u32 m0, s40, 1024
s_nop 0
buffer_load_dwordx4 v5, s[12:15], s38 offen lds
ds_read_b128 v[48:51], v87 offset:960
ds_read_b128 v[52:55], v88 offset:896
ds_read_b64 v[56:57], v86 offset:0
ds_read_b64 v[58:59], v86 offset:128
s_add_u32 m0, s40, 2048
s_add_u32 s38, s38, 57344
buffer_load_dwordx4 v4, s[12:15], s38 offen lds
ds_read_b64 v[60:61], v86 offset:256
ds_read_b64 v[62:63], v86 offset:384
s_mul_i32 s54, s35, 24576
s_add_u32 m0, s40, 3072
s_nop 0
buffer_load_dwordx4 v5, s[12:15], s38 offen lds
s_lshl_b32 s43, s62, 12
s_add_u32 s54, s54, s43
s_add_u32 s54, s54, 524288
s_lshl_b32 s43, s63, 9
s_add_u32 m0, s40, 4096
s_add_u32 s38, s38, 57344
buffer_load_dwordx4 v4, s[12:15], s38 offen lds
s_add_u32 s55, s54, s43
s_add_u32 s55, s55, 16384
s_lshl_b32 s43, s63, 13
s_add_u32 s54, s54, s43
s_add_u32 m0, s40, 5120
s_nop 0
buffer_load_dwordx4 v5, s[12:15], s38 offen lds
v_and_b32 v84, 32, v1
v_lshlrev_b32 v84, 4, v84
v_add_u32 v84, v84, v2
s_waitcnt lgkmcnt(0)
s_add_u32 m0, s40, 6144
s_add_u32 s38, s38, 57344
buffer_load_dwordx4 v4, s[12:15], s38 offen lds
s_add_u32 m0, s40, 7168
s_nop 0
buffer_load_dwordx4 v5, s[12:15], s38 offen lds
s_and_b32 s44, s36, 3
s_mul_i32 s43, s2, 28672
s_mul_i32 s44, s44, 7168
s_add_u32 s43, s43, s44
s_add_u32 s4, s76, s43
s_addc_u32 s5, s77, 0
s_barrier
s_cmp_eq_u32 s47, 3
s_cbranch_scc0 Lw_130
v_and_b32 v30, 31, v1
v_lshlrev_b32 v30, 4, v30
v_add_u32 v31, 153600, v30
ds_read_b128 v[108:111], v31 offset:0
ds_read_b128 v[112:115], v31 offset:512
ds_read_b128 v[116:119], v31 offset:1024
ds_read_b128 v[120:123], v31 offset:1536
s_and_b32 s44, s2, 15
s_mul_i32 s44, s44, 14336
s_lshr_b32 s43, s2, 4
s_lshl_b32 s43, s43, 9
s_add_u32 s44, s44, s43
s_waitcnt lgkmcnt(0)
v_add_f32 v108, v108, v112
v_add_f32 v116, v116, v120
v_add_f32 v109, v109, v113
v_add_f32 v117, v117, v121
v_add_f32 v110, v110, v114
v_add_f32 v118, v118, v122
v_add_f32 v111, v111, v115
v_add_f32 v119, v119, v123
v_add_f32 v108, v108, v116
v_add_f32 v109, v109, v117
v_add_f32 v110, v110, v118
v_add_f32 v111, v111, v119
s_mov_b64 exec, 0xffffffff
buffer_store_dwordx4 v[108:111], v30, s[84:87], s44 offen sc1
s_mov_b64 exec, -1
Lw_130:
s_waitcnt lgkmcnt(0)
s_add_u32 s37, s35, 3
s_and_b32 s37, s37, 15
s_mul_i32 s37, s37, 16384
s_add_u32 m0, s39, 49152
s_nop 0
buffer_load_dwordx4 v3, s[8:11], s37 offen sc1 lds
s_load_dword s3, s[4:5], 1792
s_load_dword s3, s[4:5], 1856
s_load_dword s3, s[4:5], 1920
s_load_dword s3, s[4:5], 1984
s_load_dword s3, s[4:5], 2048
s_load_dword s3, s[4:5], 2112
s_load_dword s3, s[4:5], 2176
buffer_load_dwordx4 v3, s[8:11], s37 offen offset:1024 sc1 lds
s_load_dword s3, s[4:5], 2240
s_load_dword s3, s[4:5], 2304
s_load_dword s3, s[4:5], 2368
s_load_dword s3, s[4:5], 2432
s_load_dword s3, s[4:5], 2496
s_load_dword s3, s[4:5], 2560
s_load_dword s3, s[4:5], 2624
buffer_load_dwordx4 v3, s[8:11], s37 offen offset:2048 sc1 lds
v_mul_f32 v66, v57, v57
v_mul_f32 v64, 0xc0135761, v57
v_mul_f32 v65, 0xbdd2d3e8, v57
v_mul_f32 v65, v65, v66
v_rcp_f32 v66, v66
v_mul_f32 v70, v59, v59
v_mul_f32 v68, 0xc0135761, v59
buffer_load_dwordx4 v3, s[8:11], s37 offen offset:3072 sc1 lds
v_mul_f32 v69, 0xbdd2d3e8, v59
v_mul_f32 v69, v69, v70
v_rcp_f32 v70, v70
v_fma_f32 v128, -v56, v32, v128
v_fma_f32 v129, -v56, v33, v129
v_fma_f32 v130, -v56, v34, v130
v_fma_f32 v131, -v56, v35, v131
v_fma_f32 v152, -v58, v32, v152
s_add_u32 s38, s35, 3
s_and_b32 s38, s38, 15
s_mul_i32 s38, s38, 458752
s_add_u32 m0, s40, 49152
s_nop 0
buffer_load_dwordx4 v4, s[12:15], s38 offen lds
v_fma_f32 v153, -v58, v33, v153
v_fma_f32 v154, -v58, v34, v154
v_fma_f32 v155, -v58, v35, v155
v_mul_f32 v72, v128, v128
v_mul_f32 v73, v129, v129
v_mul_f32 v74, v130, v130
v_mul_f32 v75, v131, v131
s_add_u32 m0, s40, 50176
s_nop 0
buffer_load_dwordx4 v5, s[12:15], s38 offen lds
v_mul_f32 v76, v152, v152
v_mul_f32 v77, v153, v153
v_mul_f32 v78, v154, v154
v_mul_f32 v79, v155, v155
v_fma_f32 v72, v72, v65, v64
v_fma_f32 v73, v73, v65, v64
v_fma_f32 v74, v74, v65, v64
s_add_u32 m0, s40, 51200
s_add_u32 s38, s38, 57344
buffer_load_dwordx4 v4, s[12:15], s38 offen lds
v_fma_f32 v75, v75, v65, v64
v_fma_f32 v76, v76, v69, v68
v_fma_f32 v77, v77, v69, v68
v_fma_f32 v78, v78, v69, v68
v_fma_f32 v79, v79, v69, v68
v_mul_f32 v72, v72, v128
v_mul_f32 v73, v73, v129
v_mul_f32 v74, v74, v130
s_add_u32 m0, s40, 52224
s_nop 0
buffer_load_dwordx4 v5, s[12:15], s38 offen lds
v_mul_f32 v75, v75, v131
v_mul_f32 v76, v76, v152
v_mul_f32 v77, v77, v153
v_mul_f32 v78, v78, v154
v_mul_f32 v79, v79, v155
v_exp_f32 v72, v72
v_exp_f32 v73, v73
s_add_u32 m0, s40, 53248
s_add_u32 s38, s38, 57344
buffer_load_dwordx4 v4, s[12:15], s38 offen lds
v_exp_f32 v74, v74
v_exp_f32 v75, v75
v_exp_f32 v76, v76
v_exp_f32 v77, v77
v_exp_f32 v78, v78
v_exp_f32 v79, v79
v_fma_f32 v140, -v56, v44, v140
s_add_u32 m0, s40, 54272
s_nop 0
buffer_load_dwordx4 v5, s[12:15], s38 offen lds
v_fma_f32 v141, -v56, v45, v141
v_fma_f32 v142, -v56, v46, v142
v_fma_f32 v143, -v56, v47, v143
v_fma_f32 v164, -v58, v44, v164
v_fma_f32 v165, -v58, v45, v165
v_fma_f32 v166, -v58, v46, v166
v_fma_f32 v167, -v58, v47, v167
v_fma_f32 v72, v72, v66, v66
s_add_u32 m0, s40, 55296
s_add_u32 s38, s38, 57344
buffer_load_dwordx4 v4, s[12:15], s38 offen lds
s_add_u32 m0, s40, 56320
s_nop 0
buffer_load_dwordx4 v5, s[12:15], s38 offen lds
s_waitcnt vmcnt(12)
s_barrier
s_add_u32 s37, s35, 4
s_and_b32 s37, s37, 15
s_mul_i32 s37, s37, 16384
s_add_u32 m0, s39, 98304
s_nop 0
buffer_load_dwordx4 v3, s[8:11], s37 offen sc1 lds
v_fma_f32 v73, v73, v66, v66
v_fma_f32 v74, v74, v66, v66
v_fma_f32 v75, v75, v66, v66
v_fma_f32 v76, v76, v70, v70
v_fma_f32 v77, v77, v70, v70
v_fma_f32 v78, v78, v70, v70
buffer_load_dwordx4 v3, s[8:11], s37 offen offset:1024 sc1 lds
v_fma_f32 v79, v79, v70, v70
v_rcp_f32 v72, v72
v_rcp_f32 v73, v73
v_rcp_f32 v74, v74
v_rcp_f32 v75, v75
v_rcp_f32 v76, v76
buffer_load_dwordx4 v3, s[8:11], s37 offen offset:2048 sc1 lds
v_rcp_f32 v77, v77
v_rcp_f32 v78, v78
v_rcp_f32 v79, v79
v_mul_f32 v140, v128, v140
v_mul_f32 v141, v129, v141
v_mul_f32 v142, v130, v142
buffer_load_dwordx4 v3, s[8:11], s37 offen offset:3072 sc1 lds
v_mul_f32 v143, v131, v143
v_mul_f32 v164, v152, v164
v_mul_f32 v165, v153, v165
v_mul_f32 v166, v154, v166
v_mul_f32 v167, v155, v167
v_mul_f32 v140, v140, v72
s_add_u32 s38, s35, 4
s_and_b32 s38, s38, 15
s_mul_i32 s38, s38, 458752
s_add_u32 m0, s40, 98304
s_nop 0
buffer_load_dwordx4 v4, s[12:15], s38 offen lds
v_mul_f32 v141, v141, v73
v_mul_f32 v142, v142, v74
v_mul_f32 v143, v143, v75
v_mul_f32 v164, v164, v76
v_mul_f32 v165, v165, v77
v_mul_f32 v166, v166, v78
s_add_u32 m0, s40, 99328
s_nop 0
buffer_load_dwordx4 v5, s[12:15], s38 offen lds
v_mul_f32 v167, v167, v79
v_cvt_pk_bf16_f32 v128, v140, v141
v_cvt_pk_bf16_f32 v129, v142, v143
v_cvt_pk_bf16_f32 v152, v164, v165
v_cvt_pk_bf16_f32 v153, v166, v167
v_fma_f32 v132, -v56, v36, v132
s_add_u32 m0, s40, 100352
s_add_u32 s38, s38, 57344
buffer_load_dwordx4 v4, s[12:15], s38 offen lds
v_fma_f32 v133, -v56, v37, v133
v_fma_f32 v134, -v56, v38, v134
v_fma_f32 v135, -v56, v39, v135
v_fma_f32 v156, -v58, v36, v156
v_fma_f32 v157, -v58, v37, v157
v_fma_f32 v158, -v58, v38, v158
s_add_u32 m0, s40, 101376
s_nop 0
buffer_load_dwordx4 v5, s[12:15], s38 offen lds
v_fma_f32 v159, -v58, v39, v159
v_mul_f32 v72, v132, v132
v_mul_f32 v73, v133, v133
v_mul_f32 v74, v134, v134
v_mul_f32 v75, v135, v135
v_mul_f32 v76, v156, v156
s_add_u32 m0, s40, 102400
s_add_u32 s38, s38, 57344
buffer_load_dwordx4 v4, s[12:15], s38 offen lds
v_mul_f32 v77, v157, v157
v_mul_f32 v78, v158, v158
v_mul_f32 v79, v159, v159
v_fma_f32 v72, v72, v65, v64
v_fma_f32 v73, v73, v65, v64
v_fma_f32 v74, v74, v65, v64
s_add_u32 m0, s40, 103424
s_nop 0
buffer_load_dwordx4 v5, s[12:15], s38 offen lds
v_fma_f32 v75, v75, v65, v64
v_fma_f32 v76, v76, v69, v68
v_fma_f32 v77, v77, v69, v68
v_fma_f32 v78, v78, v69, v68
v_fma_f32 v79, v79, v69, v68
v_mul_f32 v72, v72, v132
s_add_u32 m0, s40, 104448
s_add_u32 s38, s38, 57344
buffer_load_dwordx4 v4, s[12:15], s38 offen lds
s_add_u32 m0, s40, 105472
s_nop 0
buffer_load_dwordx4 v5, s[12:15], s38 offen lds
s_waitcnt vmcnt(12)
s_barrier
s_cmp_eq_u32 s47, 3
s_cbranch_scc0 Lw_131
s_lshr_b32 s43, s2, 4
s_add_u32 s43, s43, 80
s_lshl_b32 s43, s43, 7
v_mov_b32 v30, s43
v_mov_b32 v31, 1
s_mov_b64 exec, 1
buffer_atomic_add v31, v30, s[56:59], 0 offen sc1
s_mov_b64 exec, -1
Lw_131:
s_waitcnt lgkmcnt(0)
s_add_u32 s37, s35, 5
s_and_b32 s37, s37, 15
s_mul_i32 s37, s37, 16384
s_add_u32 m0, s39, 0
s_nop 0
buffer_load_dwordx4 v3, s[8:11], s37 offen sc1 lds
s_load_dword s3, s[4:5], 2688
s_load_dword s3, s[4:5], 2752
s_load_dword s3, s[4:5], 2816
s_load_dword s3, s[4:5], 2880
s_load_dword s3, s[4:5], 2944
s_load_dword s3, s[4:5], 3008
s_load_dword s3, s[4:5], 3072
buffer_load_dwordx4 v3, s[8:11], s37 offen offset:1024 sc1 lds
s_load_dword s3, s[4:5], 3136
s_load_dword s3, s[4:5], 3200
s_load_dword s3, s[4:5], 3264
s_load_dword s3, s[4:5], 3328
s_load_dword s3, s[4:5], 3392
s_load_dword s3, s[4:5], 3456
s_load_dword s3, s[4:5], 3520
buffer_load_dwordx4 v3, s[8:11], s37 offen offset:2048 sc1 lds
v_mul_f32 v73, v73, v133
v_mul_f32 v74, v74, v134
v_mul_f32 v75, v75, v135
v_mul_f32 v76, v76, v156
v_mul_f32 v77, v77, v157
v_mul_f32 v78, v78, v158
v_mul_f32 v79, v79, v159
v_exp_f32 v72, v72
buffer_load_dwordx4 v3, s[8:11], s37 offen offset:3072 sc1 lds
v_exp_f32 v73, v73
v_exp_f32 v74, v74
v_exp_f32 v75, v75
v_exp_f32 v76, v76
v_exp_f32 v77, v77
v_exp_f32 v78, v78
v_exp_f32 v79, v79
s_add_u32 s38, s35, 5
s_and_b32 s38, s38, 15
s_mul_i32 s38, s38, 458752
s_add_u32 m0, s40, 0
s_nop 0
buffer_load_dwordx4 v4, s[12:15], s38 offen lds
v_fma_f32 v144, -v56, v48, v144
v_fma_f32 v145, -v56, v49, v145
v_fma_f32 v146, -v56, v50, v146
v_fma_f32 v147, -v56, v51, v147
v_fma_f32 v168, -v58, v48, v168
v_fma_f32 v169, -v58, v49, v169
v_fma_f32 v170, -v58, v50, v170
v_fma_f32 v171, -v58, v51, v171
s_add_u32 m0, s40, 1024
s_nop 0
buffer_load_dwordx4 v5, s[12:15], s38 offen lds
v_fma_f32 v72, v72, v66, v66
v_fma_f32 v73, v73, v66, v66
v_fma_f32 v74, v74, v66, v66
v_fma_f32 v75, v75, v66, v66
v_fma_f32 v76, v76, v70, v70
v_fma_f32 v77, v77, v70, v70
v_fma_f32 v78, v78, v70, v70
s_add_u32 m0, s40, 2048
s_add_u32 s38, s38, 57344
buffer_load_dwordx4 v4, s[12:15], s38 offen lds
v_fma_f32 v79, v79, v70, v70
v_rcp_f32 v72, v72
v_rcp_f32 v73, v73
v_rcp_f32 v74, v74
v_rcp_f32 v75, v75
v_rcp_f32 v76, v76
v_rcp_f32 v77, v77
s_add_u32 m0, s40, 3072
s_nop 0
buffer_load_dwordx4 v5, s[12:15], s38 offen lds
v_rcp_f32 v78, v78
v_rcp_f32 v79, v79
v_mul_f32 v144, v132, v144
v_mul_f32 v145, v133, v145
v_mul_f32 v146, v134, v146
v_mul_f32 v147, v135, v147
v_mul_f32 v168, v156, v168
v_mul_f32 v169, v157, v169
s_add_u32 m0, s40, 4096
s_add_u32 s38, s38, 57344
buffer_load_dwordx4 v4, s[12:15], s38 offen lds
v_mul_f32 v170, v158, v170
v_mul_f32 v171, v159, v171
v_mul_f32 v144, v144, v72
v_mul_f32 v145, v145, v73
v_mul_f32 v146, v146, v74
v_mul_f32 v147, v147, v75
v_mul_f32 v168, v168, v76
s_add_u32 m0, s40, 5120
s_nop 0
buffer_load_dwordx4 v5, s[12:15], s38 offen lds
v_mul_f32 v169, v169, v77
v_mul_f32 v170, v170, v78
v_mul_f32 v171, v171, v79
v_cvt_pk_bf16_f32 v130, v144, v145
v_cvt_pk_bf16_f32 v131, v146, v147
v_cvt_pk_bf16_f32 v154, v168, v169
v_cvt_pk_bf16_f32 v155, v170, v171
buffer_store_dwordx4 v[128:131], v2, s[24:27], s54 offen offset:0 sc1
s_add_u32 m0, s40, 6144
s_add_u32 s38, s38, 57344
buffer_load_dwordx4 v4, s[12:15], s38 offen lds
s_add_u32 m0, s40, 7168
s_nop 0
buffer_load_dwordx4 v5, s[12:15], s38 offen lds
s_waitcnt vmcnt(13)
s_barrier
s_add_u32 s37, s35, 6
s_and_b32 s37, s37, 15
s_mul_i32 s37, s37, 16384
s_add_u32 m0, s39, 49152
s_nop 0
buffer_load_dwordx4 v3, s[8:11], s37 offen sc1 lds
buffer_store_dwordx4 v[152:155], v2, s[24:27], s54 offen offset:1024 sc1
v_fma_f32 v136, -v56, v40, v136
v_fma_f32 v137, -v56, v41, v137
v_fma_f32 v138, -v56, v42, v138
v_fma_f32 v139, -v56, v43, v139
v_fma_f32 v160, -v58, v40, v160
buffer_load_dwordx4 v3, s[8:11], s37 offen offset:1024 sc1 lds
v_fma_f32 v161, -v58, v41, v161
v_fma_f32 v162, -v58, v42, v162
v_fma_f32 v163, -v58, v43, v163
v_mul_f32 v72, v136, v136
v_mul_f32 v73, v137, v137
v_mul_f32 v74, v138, v138
buffer_load_dwordx4 v3, s[8:11], s37 offen offset:2048 sc1 lds
v_mul_f32 v75, v139, v139
v_mul_f32 v76, v160, v160
v_mul_f32 v77, v161, v161
v_mul_f32 v78, v162, v162
v_mul_f32 v79, v163, v163
v_fma_f32 v72, v72, v65, v64
buffer_load_dwordx4 v3, s[8:11], s37 offen offset:3072 sc1 lds
v_fma_f32 v73, v73, v65, v64
v_fma_f32 v74, v74, v65, v64
v_fma_f32 v75, v75, v65, v64
v_fma_f32 v76, v76, v69, v68
v_fma_f32 v77, v77, v69, v68
v_fma_f32 v78, v78, v69, v68
s_add_u32 s38, s35, 6
s_and_b32 s38, s38, 15
s_mul_i32 s38, s38, 458752
s_add_u32 m0, s40, 49152
s_nop 0
buffer_load_dwordx4 v4, s[12:15], s38 offen lds
v_fma_f32 v79, v79, v69, v68
v_mul_f32 v72, v72, v136
s_branch Lov_9
.p2align 12
Lst_9_0:
s_branch Lwr_176
Lst_9_1:
s_branch Lwr_187
s_nop 0
Lov_9:
v_mul_f32 v73, v73, v137
v_mul_f32 v74, v74, v138
v_mul_f32 v75, v75, v139
v_mul_f32 v76, v76, v160
s_add_u32 m0, s40, 50176
s_nop 0
buffer_load_dwordx4 v5, s[12:15], s38 offen lds
v_mul_f32 v77, v77, v161
v_mul_f32 v78, v78, v162
v_mul_f32 v79, v79, v163
v_exp_f32 v72, v72
v_exp_f32 v73, v73
v_exp_f32 v74, v74
s_add_u32 m0, s40, 51200
s_add_u32 s38, s38, 57344
buffer_load_dwordx4 v4, s[12:15], s38 offen lds
v_exp_f32 v75, v75
v_exp_f32 v76, v76
v_exp_f32 v77, v77
v_exp_f32 v78, v78
v_exp_f32 v79, v79
v_fma_f32 v148, -v56, v52, v148
s_add_u32 m0, s40, 52224
s_nop 0
buffer_load_dwordx4 v5, s[12:15], s38 offen lds
v_fma_f32 v149, -v56, v53, v149
v_fma_f32 v150, -v56, v54, v150
v_fma_f32 v151, -v56, v55, v151
v_fma_f32 v172, -v58, v52, v172
v_fma_f32 v173, -v58, v53, v173
v_fma_f32 v174, -v58, v54, v174
s_add_u32 m0, s40, 53248
s_add_u32 s38, s38, 57344
buffer_load_dwordx4 v4, s[12:15], s38 offen lds
v_fma_f32 v175, -v58, v55, v175
v_fma_f32 v72, v72, v66, v66
v_fma_f32 v73, v73, v66, v66
v_fma_f32 v74, v74, v66, v66
v_fma_f32 v75, v75, v66, v66
v_fma_f32 v76, v76, v70, v70
s_add_u32 m0, s40, 54272
s_nop 0
buffer_load_dwordx4 v5, s[12:15], s38 offen lds
v_fma_f32 v77, v77, v70, v70
v_fma_f32 v78, v78, v70, v70
v_fma_f32 v79, v79, v70, v70
v_rcp_f32 v72, v72
v_rcp_f32 v73, v73
v_rcp_f32 v74, v74
s_add_u32 m0, s40, 55296
s_add_u32 s38, s38, 57344
buffer_load_dwordx4 v4, s[12:15], s38 offen lds
s_add_u32 m0, s40, 56320
s_nop 0
buffer_load_dwordx4 v5, s[12:15], s38 offen lds
s_waitcnt vmcnt(13)
s_barrier
s_waitcnt lgkmcnt(0)
s_add_u32 s37, s35, 7
s_and_b32 s37, s37, 15
s_mul_i32 s37, s37, 16384
s_add_u32 m0, s39, 98304
s_nop 0
buffer_load_dwordx4 v3, s[8:11], s37 offen sc1 lds
s_load_dword s3, s[4:5], 3584
s_load_dword s3, s[4:5], 3648
s_load_dword s3, s[4:5], 3712
s_load_dword s3, s[4:5], 3776
s_load_dword s3, s[4:5], 3840
s_load_dword s3, s[4:5], 3904
s_load_dword s3, s[4:5], 3968
buffer_load_dwordx4 v3, s[8:11], s37 offen offset:1024 sc1 lds
s_load_dword s3, s[4:5], 4032
s_load_dword s3, s[4:5], 4096
s_load_dword s3, s[4:5], 4160
s_load_dword s3, s[4:5], 4224
s_load_dword s3, s[4:5], 4288
s_load_dword s3, s[4:5], 4352
s_load_dword s3, s[4:5], 4416
buffer_load_dwordx4 v3, s[8:11], s37 offen offset:2048 sc1 lds
v_rcp_f32 v75, v75
v_rcp_f32 v76, v76
v_rcp_f32 v77, v77
v_rcp_f32 v78, v78
v_rcp_f32 v79, v79
v_mul_f32 v148, v136, v148
v_mul_f32 v149, v137, v149
buffer_load_dwordx4 v3, s[8:11], s37 offen offset:3072 sc1 lds
v_mul_f32 v150, v138, v150
v_mul_f32 v151, v139, v151
v_mul_f32 v172, v160, v172
v_mul_f32 v173, v161, v173
v_mul_f32 v174, v162, v174
v_mul_f32 v175, v163, v175
v_mul_f32 v148, v148, v72
v_mul_f32 v149, v149, v73
s_add_u32 s38, s35, 7
s_and_b32 s38, s38, 15
s_mul_i32 s38, s38, 458752
s_add_u32 m0, s40, 98304
s_nop 0
buffer_load_dwordx4 v4, s[12:15], s38 offen lds
v_mul_f32 v150, v150, v74
v_mul_f32 v151, v151, v75
v_mul_f32 v172, v172, v76
v_mul_f32 v173, v173, v77
v_mul_f32 v174, v174, v78
v_mul_f32 v175, v175, v79
v_cvt_pk_bf16_f32 v80, v148, v149
s_add_u32 m0, s40, 99328
s_nop 0
buffer_load_dwordx4 v5, s[12:15], s38 offen lds
v_cvt_pk_bf16_f32 v81, v150, v151
v_cvt_pk_bf16_f32 v82, v172, v173
v_cvt_pk_bf16_f32 v83, v174, v175
s_nop 1
v_permlane32_swap_b32 v80, v82
v_permlane32_swap_b32 v81, v83
buffer_store_dwordx4 v[80:83], v84, s[24:27], s55 offen offset:0 sc1
s_add_u32 m0, s40, 100352
s_add_u32 s38, s38, 57344
buffer_load_dwordx4 v4, s[12:15], s38 offen lds
s_nop 1
v_mul_f32 v66, v61, v61
v_mul_f32 v64, 0xc0135761, v61
v_mul_f32 v65, 0xbdd2d3e8, v61
v_mul_f32 v65, v65, v66
v_rcp_f32 v66, v66
v_mul_f32 v70, v63, v63
v_mul_f32 v68, 0xc0135761, v63
s_add_u32 m0, s40, 101376
s_nop 0
buffer_load_dwordx4 v5, s[12:15], s38 offen lds
v_mul_f32 v69, 0xbdd2d3e8, v63
v_mul_f32 v69, v69, v70
v_rcp_f32 v70, v70
v_fma_f32 v176, -v60, v32, v176
v_fma_f32 v177, -v60, v33, v177
v_fma_f32 v178, -v60, v34, v178
v_fma_f32 v179, -v60, v35, v179
s_add_u32 m0, s40, 102400
s_add_u32 s38, s38, 57344
buffer_load_dwordx4 v4, s[12:15], s38 offen lds
v_fma_f32 v200, -v62, v32, v200
v_fma_f32 v201, -v62, v33, v201
v_fma_f32 v202, -v62, v34, v202
v_fma_f32 v203, -v62, v35, v203
v_mul_f32 v72, v176, v176
v_mul_f32 v73, v177, v177
v_mul_f32 v74, v178, v178
s_add_u32 m0, s40, 103424
s_nop 0
buffer_load_dwordx4 v5, s[12:15], s38 offen lds
v_mul_f32 v75, v179, v179
v_mul_f32 v76, v200, v200
v_mul_f32 v77, v201, v201
v_mul_f32 v78, v202, v202
v_mul_f32 v79, v203, v203
v_fma_f32 v72, v72, v65, v64
v_fma_f32 v73, v73, v65, v64
v_fma_f32 v74, v74, v65, v64
s_add_u32 m0, s40, 104448
s_add_u32 s38, s38, 57344
buffer_load_dwordx4 v4, s[12:15], s38 offen lds
s_add_u32 m0, s40, 105472
s_nop 0
buffer_load_dwordx4 v5, s[12:15], s38 offen lds
s_waitcnt vmcnt(13)
s_barrier
s_add_u32 s37, s35, 8
s_and_b32 s37, s37, 15
s_mul_i32 s37, s37, 16384
s_add_u32 m0, s39, 0
s_nop 0
buffer_load_dwordx4 v3, s[8:11], s37 offen sc1 lds
v_fma_f32 v75, v75, v65, v64
v_fma_f32 v76, v76, v69, v68
v_fma_f32 v77, v77, v69, v68
v_fma_f32 v78, v78, v69, v68
v_fma_f32 v79, v79, v69, v68
v_mul_f32 v72, v72, v176
buffer_load_dwordx4 v3, s[8:11], s37 offen offset:1024 sc1 lds
v_mul_f32 v73, v73, v177
v_mul_f32 v74, v74, v178
v_mul_f32 v75, v75, v179
v_mul_f32 v76, v76, v200
v_mul_f32 v77, v77, v201
v_mul_f32 v78, v78, v202
buffer_load_dwordx4 v3, s[8:11], s37 offen offset:2048 sc1 lds
v_mul_f32 v79, v79, v203
v_exp_f32 v72, v72
v_exp_f32 v73, v73
v_exp_f32 v74, v74
v_exp_f32 v75, v75
v_exp_f32 v76, v76
buffer_load_dwordx4 v3, s[8:11], s37 offen offset:3072 sc1 lds
v_exp_f32 v77, v77
v_exp_f32 v78, v78
v_exp_f32 v79, v79
v_fma_f32 v188, -v60, v44, v188
v_fma_f32 v189, -v60, v45, v189
v_fma_f32 v190, -v60, v46, v190
s_add_u32 s38, s35, 8
s_and_b32 s38, s38, 15
s_mul_i32 s38, s38, 458752
s_add_u32 m0, s40, 0
s_nop 0
buffer_load_dwordx4 v4, s[12:15], s38 offen lds
v_fma_f32 v191, -v60, v47, v191
v_fma_f32 v212, -v62, v44, v212
v_fma_f32 v213, -v62, v45, v213
v_fma_f32 v214, -v62, v46, v214
v_fma_f32 v215, -v62, v47, v215
v_fma_f32 v72, v72, v66, v66
s_add_u32 m0, s40, 1024
s_nop 0
buffer_load_dwordx4 v5, s[12:15], s38 offen lds
v_fma_f32 v73, v73, v66, v66
v_fma_f32 v74, v74, v66, v66
v_fma_f32 v75, v75, v66, v66
v_fma_f32 v76, v76, v70, v70
v_fma_f32 v77, v77, v70, v70
v_fma_f32 v78, v78, v70, v70
s_add_u32 m0, s40, 2048
s_add_u32 s38, s38, 57344
buffer_load_dwordx4 v4, s[12:15], s38 offen lds
v_fma_f32 v79, v79, v70, v70
v_rcp_f32 v72, v72
v_rcp_f32 v73, v73
v_rcp_f32 v74, v74
v_rcp_f32 v75, v75
v_rcp_f32 v76, v76
s_add_u32 m0, s40, 3072
s_nop 0
buffer_load_dwordx4 v5, s[12:15], s38 offen lds
v_rcp_f32 v77, v77
v_rcp_f32 v78, v78
v_rcp_f32 v79, v79
v_mul_f32 v188, v176, v188
v_mul_f32 v189, v177, v189
v_mul_f32 v190, v178, v190
s_add_u32 m0, s40, 4096
s_add_u32 s38, s38, 57344
buffer_load_dwordx4 v4, s[12:15], s38 offen lds
v_mul_f32 v191, v179, v191
v_mul_f32 v212, v200, v212
v_mul_f32 v213, v201, v213
v_mul_f32 v214, v202, v214
v_mul_f32 v215, v203, v215
v_mul_f32 v188, v188, v72
s_add_u32 m0, s40, 5120
s_nop 0
buffer_load_dwordx4 v5, s[12:15], s38 offen lds
v_mul_f32 v189, v189, v73
v_mul_f32 v190, v190, v74
v_mul_f32 v191, v191, v75
v_mul_f32 v212, v212, v76
v_mul_f32 v213, v213, v77
v_mul_f32 v214, v214, v78
s_add_u32 m0, s40, 6144
s_add_u32 s38, s38, 57344
buffer_load_dwordx4 v4, s[12:15], s38 offen lds
s_add_u32 m0, s40, 7168
s_nop 0
buffer_load_dwordx4 v5, s[12:15], s38 offen lds
s_waitcnt vmcnt(12)
s_barrier
s_waitcnt lgkmcnt(0)
s_cmp_eq_u32 s47, 3
s_cbranch_scc0 Lw_132
s_lshl_b32 s92, s35, 7
s_add_u32 s92, s92, 28321792
s_load_dword s93, s[82:83], s92 glc
Lw_132:
s_add_u32 s37, s35, 9
s_and_b32 s37, s37, 15
s_mul_i32 s37, s37, 16384
s_add_u32 m0, s39, 49152
s_nop 0
buffer_load_dwordx4 v3, s[8:11], s37 offen sc1 lds
s_load_dword s3, s[4:5], 4480
s_load_dword s3, s[4:5], 4544
s_load_dword s3, s[4:5], 4608
s_load_dword s3, s[4:5], 4672
s_load_dword s3, s[4:5], 4736
s_load_dword s3, s[4:5], 4800
s_load_dword s3, s[4:5], 4864
buffer_load_dwordx4 v3, s[8:11], s37 offen offset:1024 sc1 lds
s_load_dword s3, s[4:5], 4928
s_load_dword s3, s[4:5], 4992
s_load_dword s3, s[4:5], 5056
s_load_dword s3, s[4:5], 5120
s_load_dword s3, s[4:5], 5184
s_load_dword s3, s[4:5], 5248
s_load_dword s3, s[4:5], 5312
buffer_load_dwordx4 v3, s[8:11], s37 offen offset:2048 sc1 lds
v_mul_f32 v215, v215, v79
v_cvt_pk_bf16_f32 v176, v188, v189
v_cvt_pk_bf16_f32 v177, v190, v191
v_cvt_pk_bf16_f32 v200, v212, v213
v_cvt_pk_bf16_f32 v201, v214, v215
v_fma_f32 v180, -v60, v36, v180
v_fma_f32 v181, -v60, v37, v181
v_fma_f32 v182, -v60, v38, v182
buffer_load_dwordx4 v3, s[8:11], s37 offen offset:3072 sc1 lds
v_fma_f32 v183, -v60, v39, v183
v_fma_f32 v204, -v62, v36, v204
v_fma_f32 v205, -v62, v37, v205
v_fma_f32 v206, -v62, v38, v206
v_fma_f32 v207, -v62, v39, v207
v_mul_f32 v72, v180, v180
v_mul_f32 v73, v181, v181
s_add_u32 s38, s35, 9
s_and_b32 s38, s38, 15
s_mul_i32 s38, s38, 458752
s_add_u32 m0, s40, 49152
s_nop 0
buffer_load_dwordx4 v4, s[12:15], s38 offen lds
v_mul_f32 v74, v182, v182
v_mul_f32 v75, v183, v183
v_mul_f32 v76, v204, v204
v_mul_f32 v77, v205, v205
v_mul_f32 v78, v206, v206
v_mul_f32 v79, v207, v207
v_fma_f32 v72, v72, v65, v64
v_fma_f32 v73, v73, v65, v64
s_add_u32 m0, s40, 50176
s_nop 0
buffer_load_dwordx4 v5, s[12:15], s38 offen lds
v_fma_f32 v74, v74, v65, v64
v_fma_f32 v75, v75, v65, v64
v_fma_f32 v76, v76, v69, v68
v_fma_f32 v77, v77, v69, v68
v_fma_f32 v78, v78, v69, v68
v_fma_f32 v79, v79, v69, v68
v_mul_f32 v72, v72, v180
s_add_u32 m0, s40, 51200
s_add_u32 s38, s38, 57344
buffer_load_dwordx4 v4, s[12:15], s38 offen lds
v_mul_f32 v73, v73, v181
v_mul_f32 v74, v74, v182
v_mul_f32 v75, v75, v183
v_mul_f32 v76, v76, v204
v_mul_f32 v77, v77, v205
v_mul_f32 v78, v78, v206
v_mul_f32 v79, v79, v207
s_add_u32 m0, s40, 52224
s_nop 0
buffer_load_dwordx4 v5, s[12:15], s38 offen lds
v_exp_f32 v72, v72
v_exp_f32 v73, v73
v_exp_f32 v74, v74
v_exp_f32 v75, v75
v_exp_f32 v76, v76
v_exp_f32 v77, v77
v_exp_f32 v78, v78
v_exp_f32 v79, v79
s_add_u32 m0, s40, 53248
s_add_u32 s38, s38, 57344
buffer_load_dwordx4 v4, s[12:15], s38 offen lds
v_fma_f32 v192, -v60, v48, v192
v_fma_f32 v193, -v60, v49, v193
v_fma_f32 v194, -v60, v50, v194
v_fma_f32 v195, -v60, v51, v195
v_fma_f32 v216, -v62, v48, v216
v_fma_f32 v217, -v62, v49, v217
v_fma_f32 v218, -v62, v50, v218
s_add_u32 m0, s40, 54272
s_nop 0
buffer_load_dwordx4 v5, s[12:15], s38 offen lds
v_fma_f32 v219, -v62, v51, v219
v_fma_f32 v72, v72, v66, v66
v_fma_f32 v73, v73, v66, v66
v_fma_f32 v74, v74, v66, v66
v_fma_f32 v75, v75, v66, v66
v_fma_f32 v76, v76, v70, v70
v_fma_f32 v77, v77, v70, v70
v_fma_f32 v78, v78, v70, v70
s_add_u32 m0, s40, 55296
s_add_u32 s38, s38, 57344
buffer_load_dwordx4 v4, s[12:15], s38 offen lds
s_add_u32 m0, s40, 56320
s_nop 0
buffer_load_dwordx4 v5, s[12:15], s38 offen lds
s_waitcnt vmcnt(12)
s_barrier
s_add_u32 s37, s35, 10
s_and_b32 s37, s37, 15
s_mul_i32 s37, s37, 16384
s_add_u32 m0, s39, 98304
s_nop 0
buffer_load_dwordx4 v3, s[8:11], s37 offen sc1 lds
v_fma_f32 v79, v79, v70, v70
v_rcp_f32 v72, v72
v_rcp_f32 v73, v73
v_rcp_f32 v74, v74
v_rcp_f32 v75, v75
v_rcp_f32 v76, v76
buffer_load_dwordx4 v3, s[8:11], s37 offen offset:1024 sc1 lds
v_rcp_f32 v77, v77
v_rcp_f32 v78, v78
v_rcp_f32 v79, v79
v_mul_f32 v192, v180, v192
v_mul_f32 v193, v181, v193
v_mul_f32 v194, v182, v194
buffer_load_dwordx4 v3, s[8:11], s37 offen offset:2048 sc1 lds
v_mul_f32 v195, v183, v195
v_mul_f32 v216, v204, v216
v_mul_f32 v217, v205, v217
v_mul_f32 v218, v206, v218
v_mul_f32 v219, v207, v219
v_mul_f32 v192, v192, v72
buffer_load_dwordx4 v3, s[8:11], s37 offen offset:3072 sc1 lds
v_mul_f32 v193, v193, v73
v_mul_f32 v194, v194, v74
v_mul_f32 v195, v195, v75
v_mul_f32 v216, v216, v76
v_mul_f32 v217, v217, v77
v_mul_f32 v218, v218, v78
s_add_u32 s38, s35, 10
s_and_b32 s38, s38, 15
s_mul_i32 s38, s38, 458752
s_add_u32 m0, s40, 98304
s_nop 0
buffer_load_dwordx4 v4, s[12:15], s38 offen lds
v_mul_f32 v219, v219, v79
v_cvt_pk_bf16_f32 v178, v192, v193
v_cvt_pk_bf16_f32 v179, v194, v195
v_cvt_pk_bf16_f32 v202, v216, v217
v_cvt_pk_bf16_f32 v203, v218, v219
buffer_store_dwordx4 v[176:179], v2, s[24:27], s54 offen offset:2048 sc1
s_add_u32 m0, s40, 99328
s_nop 0
buffer_load_dwordx4 v5, s[12:15], s38 offen lds
buffer_store_dwordx4 v[200:203], v2, s[24:27], s54 offen offset:3072 sc1
v_fma_f32 v184, -v60, v40, v184
v_fma_f32 v185, -v60, v41, v185
v_fma_f32 v186, -v60, v42, v186
v_fma_f32 v187, -v60, v43, v187
v_fma_f32 v208, -v62, v40, v208
s_add_u32 m0, s40, 100352
s_add_u32 s38, s38, 57344
buffer_load_dwordx4 v4, s[12:15], s38 offen lds
v_fma_f32 v209, -v62, v41, v209
v_fma_f32 v210, -v62, v42, v210
v_fma_f32 v211, -v62, v43, v211
v_mul_f32 v72, v184, v184
v_mul_f32 v73, v185, v185
v_mul_f32 v74, v186, v186
s_add_u32 m0, s40, 101376
s_nop 0
buffer_load_dwordx4 v5, s[12:15], s38 offen lds
v_mul_f32 v75, v187, v187
v_mul_f32 v76, v208, v208
v_mul_f32 v77, v209, v209
v_mul_f32 v78, v210, v210
v_mul_f32 v79, v211, v211
v_fma_f32 v72, v72, v65, v64
s_add_u32 m0, s40, 102400
s_add_u32 s38, s38, 57344
buffer_load_dwordx4 v4, s[12:15], s38 offen lds
v_fma_f32 v73, v73, v65, v64
v_fma_f32 v74, v74, v65, v64
v_fma_f32 v75, v75, v65, v64
v_fma_f32 v76, v76, v69, v68
v_fma_f32 v77, v77, v69, v68
v_fma_f32 v78, v78, v69, v68
s_add_u32 m0, s40, 103424
s_nop 0
buffer_load_dwordx4 v5, s[12:15], s38 offen lds
v_fma_f32 v79, v79, v69, v68
v_mul_f32 v72, v72, v184
v_mul_f32 v73, v73, v185
v_mul_f32 v74, v74, v186
v_mul_f32 v75, v75, v187
v_mul_f32 v76, v76, v208
s_add_u32 m0, s40, 104448
s_add_u32 s38, s38, 57344
buffer_load_dwordx4 v4, s[12:15], s38 offen lds
s_add_u32 m0, s40, 105472
s_nop 0
buffer_load_dwordx4 v5, s[12:15], s38 offen lds
s_waitcnt vmcnt(14)
s_cmp_eq_u32 s47, 3
s_cbranch_scc0 Lw_133
s_mov_b32 s41, 0x40000
s_branch Lpchk_136
Lpoll_134:
s_load_dword s93, s[82:83], s92 glc
Lpchk_136:
s_waitcnt lgkmcnt(0)
s_cmp_eq_u32 s93, 16
s_cbranch_scc1 Lpok_135
s_sub_u32 s41, s41, 1
s_cmp_lg_u32 s41, 0
s_cbranch_scc1 Lpoll_134
Lpok_135:
Lw_133:
s_barrier
s_lshl_b32 s60, s35, 9
s_lshl_b32 s43, s47, 7
s_add_u32 s60, s60, s43
s_add_u32 s61, s60, 14336
s_add_u32 s52, s43, 148480
s_add_u32 s53, s52, 896
v_lshrrev_b32 v104, 3, v1
v_mul_u32_u24 v104, 28672, v104
v_and_b32 v105, 7, v1
v_lshl_add_u32 v104, v105, 4, v104
s_waitcnt lgkmcnt(0)
buffer_load_dwordx4 v[96:99], v104, s[84:87], s60 offen sc1
s_load_dword s3, s[4:5], 5376
s_load_dword s3, s[4:5], 5440
s_load_dword s3, s[4:5], 5504
s_load_dword s3, s[4:5], 5568
s_load_dword s3, s[4:5], 5632
s_load_dword s3, s[4:5], 5696
buffer_load_dwordx4 v[100:103], v104, s[84:87], s61 offen sc1
s_load_dword s3, s[4:5], 5760
s_load_dword s3, s[4:5], 5824
s_load_dword s3, s[4:5], 5888
s_load_dword s3, s[4:5], 5952
s_load_dword s3, s[4:5], 6016
s_load_dword s3, s[4:5], 6080
s_load_dword s3, s[4:5], 6144
s_add_u32 s37, s35, 11
s_and_b32 s37, s37, 15
s_mul_i32 s37, s37, 16384
s_add_u32 m0, s39, 0
s_nop 0
buffer_load_dwordx4 v3, s[8:11], s37 offen sc1 lds
s_load_dword s3, s[4:5], 6208
v_mul_f32 v77, v77, v209
v_mul_f32 v78, v78, v210
v_mul_f32 v79, v79, v211
v_exp_f32 v72, v72
v_exp_f32 v73, v73
v_exp_f32 v74, v74
buffer_load_dwordx4 v3, s[8:11], s37 offen offset:1024 sc1 lds
v_exp_f32 v75, v75
v_exp_f32 v76, v76
v_exp_f32 v77, v77
v_exp_f32 v78, v78
v_exp_f32 v79, v79
v_fma_f32 v196, -v60, v52, v196
v_fma_f32 v197, -v60, v53, v197
buffer_load_dwordx4 v3, s[8:11], s37 offen offset:2048 sc1 lds
v_fma_f32 v198, -v60, v54, v198
v_fma_f32 v199, -v60, v55, v199
v_fma_f32 v220, -v62, v52, v220
v_fma_f32 v221, -v62, v53, v221
v_fma_f32 v222, -v62, v54, v222
v_fma_f32 v223, -v62, v55, v223
buffer_load_dwordx4 v3, s[8:11], s37 offen offset:3072 sc1 lds
v_fma_f32 v72, v72, v66, v66
v_fma_f32 v73, v73, v66, v66
v_fma_f32 v74, v74, v66, v66
v_fma_f32 v75, v75, v66, v66
v_fma_f32 v76, v76, v70, v70
v_fma_f32 v77, v77, v70, v70
v_fma_f32 v78, v78, v70, v70
s_add_u32 s38, s35, 11
s_and_b32 s38, s38, 15
s_mul_i32 s38, s38, 458752
s_add_u32 m0, s40, 0
s_nop 0
buffer_load_dwordx4 v4, s[12:15], s38 offen lds
v_fma_f32 v79, v79, v70, v70
v_rcp_f32 v72, v72
v_rcp_f32 v73, v73
v_rcp_f32 v74, v74
v_rcp_f32 v75, v75
v_rcp_f32 v76, v76
v_rcp_f32 v77, v77
s_add_u32 m0, s40, 1024
s_nop 0
buffer_load_dwordx4 v5, s[12:15], s38 offen lds
v_rcp_f32 v78, v78
v_rcp_f32 v79, v79
v_mul_f32 v196, v184, v196
v_mul_f32 v197, v185, v197
v_mul_f32 v198, v186, v198
v_mul_f32 v199, v187, v199
v_mul_f32 v220, v208, v220
s_add_u32 m0, s40, 2048
s_add_u32 s38, s38, 57344
buffer_load_dwordx4 v4, s[12:15], s38 offen lds
v_mul_f32 v221, v209, v221
v_mul_f32 v222, v210, v222
v_mul_f32 v223, v211, v223
v_mul_f32 v196, v196, v72
v_mul_f32 v197, v197, v73
v_mul_f32 v198, v198, v74
s_add_u32 m0, s40, 3072
s_nop 0
buffer_load_dwordx4 v5, s[12:15], s38 offen lds
v_mul_f32 v199, v199, v75
v_mul_f32 v220, v220, v76
v_mul_f32 v221, v221, v77
v_mul_f32 v222, v222, v78
v_mul_f32 v223, v223, v79
v_cvt_pk_bf16_f32 v80, v196, v197
v_cvt_pk_bf16_f32 v81, v198, v199
s_add_u32 m0, s40, 4096
s_add_u32 s38, s38, 57344
buffer_load_dwordx4 v4, s[12:15], s38 offen lds
v_cvt_pk_bf16_f32 v82, v220, v221
v_cvt_pk_bf16_f32 v83, v222, v223
s_nop 1
v_permlane32_swap_b32 v80, v82
v_permlane32_swap_b32 v81, v83
buffer_store_dwordx4 v[80:83], v84, s[24:27], s55 offen offset:2048 sc1
s_nop 1
s_add_u32 m0, s40, 5120
s_nop 0
buffer_load_dwordx4 v5, s[12:15], s38 offen lds
v_cmp_gt_u32 vcc, 32, v1
v_mov_b32 v104, s52
v_mov_b32 v106, s53
v_cndmask_b32 v104, v106, v104, vcc
v_lshl_add_u32 v104, v105, 4, v104
v_bfe_u32 v105, v1, 4, 1
v_lshl_add_u32 v104, v105, 2, v104
s_add_u32 m0, s40, 6144
s_add_u32 s38, s38, 57344
buffer_load_dwordx4 v4, s[12:15], s38 offen lds
s_add_u32 m0, s40, 7168
s_nop 0
buffer_load_dwordx4 v5, s[12:15], s38 offen lds
s_waitcnt vmcnt(15)
s_barrier
s_add_u32 s37, s35, 12
s_and_b32 s37, s37, 15
s_mul_i32 s37, s37, 16384
s_add_u32 m0, s39, 49152
s_nop 0
buffer_load_dwordx4 v3, s[8:11], s37 offen sc1 lds
buffer_load_dwordx4 v3, s[8:11], s37 offen offset:1024 sc1 lds
buffer_load_dwordx4 v3, s[8:11], s37 offen offset:2048 sc1 lds
buffer_load_dwordx4 v3, s[8:11], s37 offen offset:3072 sc1 lds
s_add_u32 s38, s35, 12
s_and_b32 s38, s38, 15
s_mul_i32 s38, s38, 458752
s_add_u32 m0, s40, 49152
s_nop 0
buffer_load_dwordx4 v4, s[12:15], s38 offen lds
s_add_u32 m0, s40, 50176
s_nop 0
buffer_load_dwordx4 v5, s[12:15], s38 offen lds
s_add_u32 m0, s40, 51200
s_add_u32 s38, s38, 57344
buffer_load_dwordx4 v4, s[12:15], s38 offen lds
s_add_u32 m0, s40, 52224
s_nop 0
buffer_load_dwordx4 v5, s[12:15], s38 offen lds
s_add_u32 m0, s40, 53248
s_add_u32 s38, s38, 57344
buffer_load_dwordx4 v4, s[12:15], s38 offen lds
s_add_u32 m0, s40, 54272
s_nop 0
buffer_load_dwordx4 v5, s[12:15], s38 offen lds
s_add_u32 m0, s40, 55296
s_add_u32 s38, s38, 57344
buffer_load_dwordx4 v4, s[12:15], s38 offen lds
s_add_u32 m0, s40, 56320
s_branch Lov_10
.p2align 12
Lst_10_0:
s_branch Lwr_177
Lst_10_1:
s_branch Lwr_188
s_nop 0
Lov_10:
s_nop 0
buffer_load_dwordx4 v5, s[12:15], s38 offen lds
s_waitcnt vmcnt(12)
s_barrier
s_cmp_eq_u32 s47, 0
s_cbranch_scc0 Lw_137
s_add_u32 s7, s34, 32
s_lshl_b32 s7, s7, 7
v_mov_b32 v28, s7
v_mov_b32 v29, 1
s_mov_b64 exec, 1
buffer_atomic_add v29, v28, s[56:59], 0 offen sc1
s_mov_b64 exec, -1
Lw_137:
v_permlane32_swap_b32 v96, v100
v_permlane32_swap_b32 v97, v101
v_permlane32_swap_b32 v98, v102
v_permlane32_swap_b32 v99, v103
v_add_f32 v96, v96, v100
v_add_f32 v97, v97, v101
v_add_f32 v98, v98, v102
v_add_f32 v99, v99, v103
s_nop 1
v_permlane16_swap_b32 v96, v97
v_permlane16_swap_b32 v98, v99
v_add_f32 v96, v96, v97
v_add_f32 v98, v98, v99
s_nop 1
v_add_f32_dpp v96, v96, v96 row_ror:8 row_mask:0xf bank_mask:0xf
v_add_f32_dpp v98, v98, v98 row_ror:8 row_mask:0xf bank_mask:0xf
ds_write_b32 v104, v96
ds_write_b32 v104, v98 offset:8
s_waitcnt lgkmcnt(0)
s_add_u32 s37, s35, 13
s_and_b32 s37, s37, 15
s_mul_i32 s37, s37, 16384
s_add_u32 m0, s39, 98304
s_nop 0
buffer_load_dwordx4 v3, s[8:11], s37 offen sc1 lds
s_load_dword s3, s[4:5], 6272
s_load_dword s3, s[4:5], 6336
s_load_dword s3, s[4:5], 6400
s_load_dword s3, s[4:5], 6464
s_load_dword s3, s[4:5], 6528
s_load_dword s3, s[4:5], 6592
buffer_load_dwordx4 v3, s[8:11], s37 offen offset:1024 sc1 lds
s_load_dword s3, s[4:5], 6656
s_load_dword s3, s[4:5], 6720
s_load_dword s3, s[4:5], 6784
s_load_dword s3, s[4:5], 6848
s_load_dword s3, s[4:5], 6912
s_load_dword s3, s[4:5], 6976
buffer_load_dwordx4 v3, s[8:11], s37 offen offset:2048 sc1 lds
s_load_dword s3, s[4:5], 7040
s_load_dword s3, s[4:5], 7104
s_bfe_u32 s61, s35, 0x10002
s_lshr_b32 s60, s35, 3
s_lshl_b32 s60, s60, 2
s_and_b32 s43, s35, 3
buffer_load_dwordx4 v3, s[8:11], s37 offen offset:3072 sc1 lds
s_add_u32 s60, s60, s43
s_lshl_b32 s43, s60, 8
s_add_u32 s28, s76, s43
s_addc_u32 s29, s77, 0
s_mov_b32 s30, 7338240
s_mov_b32 s31, 0x20000
s_mul_i32 s52, s61, 196608
s_add_u32 s38, s35, 13
s_and_b32 s38, s38, 15
s_mul_i32 s38, s38, 458752
s_add_u32 m0, s40, 98304
s_nop 0
buffer_load_dwordx4 v4, s[12:15], s38 offen lds
s_mul_i32 s53, s61, 1572864
s_mul_i32 s90, s61, 163840
s_mul_i32 s91, s61, 1310720
s_lshl_b32 s51, s47, 11
s_lshl_b32 s44, s47, 15
v_lshrrev_b32 v122, 4, v1
s_add_u32 m0, s40, 99328
s_nop 0
buffer_load_dwordx4 v5, s[12:15], s38 offen lds
v_lshlrev_b32 v123, 1, v122
v_and_b32 v23, 15, v1
v_xor_b32 v23, v23, v123
v_lshlrev_b32 v23, 4, v23
v_mul_u32_u24 v122, 2048, v122
v_add_u32 v23, v23, v122
s_add_u32 m0, s40, 100352
s_add_u32 s38, s38, 57344
buffer_load_dwordx4 v4, s[12:15], s38 offen lds
v_add_u32 v23, s44, v23
v_xor_b32 v24, 128, v23
v_add_u32 v24, 8192, v24
s_lshl_b32 s43, s60, 2
s_lshl_b32 s44, s61, 1
s_add_u32 s43, s43, s44
s_add_u32 s43, s43, s63
s_add_u32 m0, s40, 101376
s_nop 0
buffer_load_dwordx4 v5, s[12:15], s38 offen lds
s_lshl_b32 s43, s43, 13
s_lshl_b32 s44, s62, 12
s_add_u32 s50, s43, s44
v_add_u32 v6, s44, v2
v_add_u32 v7, 0x10000, v6
v_add_u32 v8, 0x20000, v6
s_add_u32 m0, s40, 102400
s_add_u32 s38, s38, 57344
buffer_load_dwordx4 v4, s[12:15], s38 offen lds
v_lshrrev_b32 v122, 2, v1
v_and_b32 v123, 7, v122
v_mul_u32_u24 v122, 256, v122
v_lshl_add_u32 v122, v123, 5, v122
v_and_b32 v123, 3, v1
v_lshl_add_u32 v9, v123, 3, v122
s_add_u32 m0, s40, 103424
s_nop 0
buffer_load_dwordx4 v5, s[12:15], s38 offen lds
s_lshl_b32 s43, s61, 7
s_lshl_b32 s44, s63, 6
s_add_u32 s43, s43, s44
v_xor_b32 v9, s43, v9
v_xor_b32 v10, 32, v9
v_xor_b32 v11, 128, v9
v_xor_b32 v12, 128, v10
s_add_u32 m0, s40, 104448
s_add_u32 s38, s38, 57344
buffer_load_dwordx4 v4, s[12:15], s38 offen lds
s_add_u32 m0, s40, 105472
s_nop 0
buffer_load_dwordx4 v5, s[12:15], s38 offen lds
s_waitcnt vmcnt(12)
s_barrier
buffer_load_dwordx4 v[160:163], v2, s[8:11], s50 offen offset:0 sc1
v_add_u32 v13, 65536, v9
v_add_u32 v14, 65536, v10
v_add_u32 v15, 65536, v11
buffer_load_dwordx4 v[164:167], v2, s[8:11], s50 offen offset:1024 sc1
v_add_u32 v16, 65536, v12
v_add_u32 v25, 131072, v9
v_add_u32 v26, 131072, v10
v_add_u32 v27, 131072, v11
buffer_load_dwordx4 v[168:171], v2, s[8:11], s50 offen offset:2048 sc1
v_add_u32 v28, 131072, v12
v_lshrrev_b32 v122, 2, v1
v_bfe_u32 v123, v122, 1, 2
buffer_load_dwordx4 v[172:175], v2, s[8:11], s50 offen offset:3072 sc1
v_mul_u32_u24 v122, 128, v122
v_lshl_add_u32 v122, v123, 5, v122
v_and_b32 v123, 3, v1
v_lshl_add_u32 v224, v123, 3, v122
s_add_u32 s37, s35, 14
s_and_b32 s37, s37, 15
s_mul_i32 s37, s37, 16384
s_add_u32 m0, s39, 0
s_nop 0
buffer_load_dwordx4 v3, s[8:11], s37 offen sc1 lds
v_xor_b32 v224, s44, v224
v_xor_b32 v225, 32, v224
v_add_u32 v226, 65536, v224
buffer_load_dwordx4 v3, s[8:11], s37 offen offset:1024 sc1 lds
v_add_u32 v227, 65536, v225
v_add_u32 v228, 131072, v224
v_add_u32 v229, 131072, v225
s_add_u32 s84, s82, 33554432
buffer_load_dwordx4 v3, s[8:11], s37 offen offset:2048 sc1 lds
s_addc_u32 s85, s83, 0
s_mov_b32 s86, 4194304
s_mov_b32 s87, 0x20000
s_xor_b32 s43, s2, 2
buffer_load_dwordx4 v3, s[8:11], s37 offen offset:3072 sc1 lds
s_lshl_b32 s44, s43, 2
s_add_u32 s44, s44, s47
s_lshl_b32 s45, s44, 12
s_add_u32 s38, s35, 14
s_and_b32 s38, s38, 15
s_mul_i32 s38, s38, 458752
s_add_u32 m0, s40, 0
s_nop 0
buffer_load_dwordx4 v4, s[12:15], s38 offen lds
s_lshl_b32 s46, s2, 2
s_add_u32 s46, s46, s47
s_lshl_b32 s46, s46, 12
s_lshl_b32 s43, s34, 18
s_add_u32 m0, s40, 1024
s_nop 0
buffer_load_dwordx4 v5, s[12:15], s38 offen lds
s_lshl_b32 s42, s60, 8
s_add_u32 s43, s43, s42
s_lshl_b32 s42, s61, 7
s_add_u32 m0, s40, 2048
s_add_u32 s38, s38, 57344
buffer_load_dwordx4 v4, s[12:15], s38 offen lds
s_add_u32 s43, s43, s42
s_lshl_b32 s42, s63, 6
s_add_u32 s43, s43, s42
s_add_u32 s20, s78, s43
s_add_u32 m0, s40, 3072
s_nop 0
buffer_load_dwordx4 v5, s[12:15], s38 offen lds
s_addc_u32 s21, s79, 0
s_mov_b32 s22, 260160
s_mov_b32 s23, 0x20000
s_add_u32 m0, s40, 4096
s_add_u32 s38, s38, 57344
buffer_load_dwordx4 v4, s[12:15], s38 offen lds
v_and_b32 v230, 15, v1
v_lshlrev_b32 v230, 12, v230
v_bfe_u32 v231, v1, 4, 1
v_lshl_add_u32 v230, v231, 5, v230
s_add_u32 m0, s40, 5120
s_nop 0
buffer_load_dwordx4 v5, s[12:15], s38 offen lds
v_bfe_u32 v231, v1, 5, 1
v_lshl_add_u32 v230, v231, 4, v230
s_lshl_b32 s54, s62, 17
s_add_u32 s55, s54, 65536
s_add_u32 m0, s40, 6144
s_add_u32 s38, s38, 57344
buffer_load_dwordx4 v4, s[12:15], s38 offen lds
s_add_u32 m0, s40, 7168
s_nop 0
buffer_load_dwordx4 v5, s[12:15], s38 offen lds
s_waitcnt vmcnt(16)
s_barrier
s_cmp_eq_u32 s47, 3
s_cbranch_scc0 Lw_138
s_lshl_b32 s92, s34, 7
s_add_u32 s92, s92, 28315648
s_load_dword s93, s[82:83], s92 glc
Lw_138:
s_add_u32 s37, s35, 15
s_and_b32 s37, s37, 15
s_mul_i32 s37, s37, 16384
s_add_u32 m0, s39, 49152
s_nop 0
buffer_load_dwordx4 v3, s[8:11], s37 offen sc1 lds
buffer_load_dwordx4 v3, s[8:11], s37 offen offset:1024 sc1 lds
buffer_load_dwordx4 v3, s[8:11], s37 offen offset:2048 sc1 lds
buffer_load_dwordx4 v3, s[8:11], s37 offen offset:3072 sc1 lds
s_add_u32 s38, s35, 15
s_and_b32 s38, s38, 15
s_mul_i32 s38, s38, 458752
s_add_u32 m0, s40, 49152
s_nop 0
buffer_load_dwordx4 v4, s[12:15], s38 offen lds
s_add_u32 m0, s40, 50176
s_nop 0
buffer_load_dwordx4 v5, s[12:15], s38 offen lds
s_add_u32 m0, s40, 51200
s_add_u32 s38, s38, 57344
buffer_load_dwordx4 v4, s[12:15], s38 offen lds
s_add_u32 m0, s40, 52224
s_nop 0
buffer_load_dwordx4 v5, s[12:15], s38 offen lds
s_add_u32 m0, s40, 53248
s_add_u32 s38, s38, 57344
buffer_load_dwordx4 v4, s[12:15], s38 offen lds
s_add_u32 m0, s40, 54272
s_nop 0
buffer_load_dwordx4 v5, s[12:15], s38 offen lds
s_add_u32 m0, s40, 55296
s_add_u32 s38, s38, 57344
buffer_load_dwordx4 v4, s[12:15], s38 offen lds
s_add_u32 m0, s40, 56320
s_nop 0
buffer_load_dwordx4 v5, s[12:15], s38 offen lds
s_waitcnt vmcnt(12)
s_cmp_eq_u32 s47, 3
s_cbranch_scc0 Lw_139
s_mov_b32 s41, 0x40000
s_branch Lpchk_142
Lpoll_140:
s_load_dword s93, s[82:83], s92 glc
Lpchk_142:
s_waitcnt lgkmcnt(0)
s_cmp_eq_u32 s93, 16
s_cbranch_scc1 Lpok_141
s_sub_u32 s41, s41, 1
s_cmp_lg_u32 s41, 0
s_cbranch_scc1 Lpoll_140
Lpok_141:
Lw_139:
s_barrier
s_add_u32 m0, s39, 98304
s_add_u32 s37, s52, 524288
buffer_load_dwordx4 v3, s[24:27], s37 offen sc1 lds
v_lshlrev_b32 v128, 16, v160
v_and_b32 v129, 0xffff0000, v160
v_lshlrev_b32 v130, 16, v161
v_and_b32 v131, 0xffff0000, v161
v_lshlrev_b32 v132, 16, v162
buffer_load_dwordx4 v3, s[24:27], s37 offen offset:1024 sc1 lds
v_and_b32 v133, 0xffff0000, v162
v_lshlrev_b32 v134, 16, v163
v_and_b32 v135, 0xffff0000, v163
v_lshlrev_b32 v136, 16, v164
v_and_b32 v137, 0xffff0000, v164
buffer_load_dwordx4 v3, s[24:27], s37 offen offset:2048 sc1 lds
v_lshlrev_b32 v138, 16, v165
v_and_b32 v139, 0xffff0000, v165
v_lshlrev_b32 v140, 16, v166
v_and_b32 v141, 0xffff0000, v166
v_lshlrev_b32 v142, 16, v167
v_and_b32 v143, 0xffff0000, v167
buffer_load_dwordx4 v3, s[24:27], s37 offen offset:3072 sc1 lds
v_lshlrev_b32 v144, 16, v168
v_and_b32 v145, 0xffff0000, v168
v_lshlrev_b32 v146, 16, v169
v_and_b32 v147, 0xffff0000, v169
v_lshlrev_b32 v148, 16, v170
s_add_u32 m0, s39, 114688
s_add_u32 s38, s53, 4194304
buffer_load_dwordx4 v23, s[28:31], s38 offen lds
v_and_b32 v149, 0xffff0000, v170
v_lshlrev_b32 v150, 16, v171
v_and_b32 v151, 0xffff0000, v171
v_lshlrev_b32 v152, 16, v172
v_and_b32 v153, 0xffff0000, v172
s_add_u32 m0, s39, 115712
s_add_u32 s38, s53, 4194304
buffer_load_dwordx4 v24, s[28:31], s38 offen lds
v_lshlrev_b32 v154, 16, v173
v_and_b32 v155, 0xffff0000, v173
v_lshlrev_b32 v156, 16, v174
v_and_b32 v157, 0xffff0000, v174
v_lshlrev_b32 v158, 16, v175
v_and_b32 v159, 0xffff0000, v175
s_add_u32 m0, s39, 116736
s_add_u32 s38, s53, 4210688
buffer_load_dwordx4 v23, s[28:31], s38 offen lds
s_add_u32 m0, s39, 117760
s_add_u32 s38, s53, 4210688
buffer_load_dwordx4 v24, s[28:31], s38 offen lds
s_waitcnt vmcnt(8)
s_barrier
s_add_u32 m0, s39, 131072
s_add_u32 s37, s52, 540672
buffer_load_dwordx4 v3, s[24:27], s37 offen sc1 lds
buffer_load_dwordx4 v3, s[24:27], s37 offen offset:1024 sc1 lds
buffer_load_dwordx4 v3, s[24:27], s37 offen offset:2048 sc1 lds
buffer_load_dwordx4 v3, s[24:27], s37 offen offset:3072 sc1 lds
s_add_u32 m0, s39, 0
s_add_u32 s38, s53, 4325376
buffer_load_dwordx4 v23, s[28:31], s38 offen lds
s_add_u32 m0, s39, 1024
s_add_u32 s38, s53, 4325376
buffer_load_dwordx4 v24, s[28:31], s38 offen lds
s_add_u32 m0, s39, 2048
s_add_u32 s38, s53, 4341760
buffer_load_dwordx4 v23, s[28:31], s38 offen lds
s_add_u32 m0, s39, 3072
s_add_u32 s38, s53, 4341760
buffer_load_dwordx4 v24, s[28:31], s38 offen lds
s_add_u32 m0, s39, 16384
s_add_u32 s37, s52, 557056
buffer_load_dwordx4 v3, s[24:27], s37 offen sc1 lds
buffer_load_dwordx4 v3, s[24:27], s37 offen offset:1024 sc1 lds
buffer_load_dwordx4 v3, s[24:27], s37 offen offset:2048 sc1 lds
buffer_load_dwordx4 v3, s[24:27], s37 offen offset:3072 sc1 lds
s_add_u32 m0, s39, 32768
s_add_u32 s38, s53, 4456448
buffer_load_dwordx4 v23, s[28:31], s38 offen lds
s_add_u32 m0, s39, 33792
s_add_u32 s38, s53, 4456448
buffer_load_dwordx4 v24, s[28:31], s38 offen lds
s_add_u32 m0, s39, 34816
s_add_u32 s38, s53, 4472832
buffer_load_dwordx4 v23, s[28:31], s38 offen lds
s_add_u32 m0, s39, 35840
s_add_u32 s38, s53, 4472832
buffer_load_dwordx4 v24, s[28:31], s38 offen lds
s_waitcnt vmcnt(16)
s_barrier
ds_read_b128 v[32:35], v7 offset:32768
ds_read_b64_tr_b16 v[48:49], v13 offset:49152
ds_read_b64_tr_b16 v[50:51], v13 offset:53248
ds_read_b64_tr_b16 v[52:53], v14 offset:49152
ds_read_b64_tr_b16 v[54:55], v14 offset:53248
ds_read_b64_tr_b16 v[56:57], v15 offset:49152
ds_read_b64_tr_b16 v[58:59], v15 offset:53248
ds_read_b64_tr_b16 v[60:61], v16 offset:49152
ds_read_b64_tr_b16 v[62:63], v16 offset:53248
ds_read_b128 v[36:39], v7 offset:33792
ds_read_b128 v[40:43], v7 offset:34816
ds_read_b128 v[44:47], v7 offset:35840
ds_read_b128 v[64:67], v7 offset:40960
ds_read_b64_tr_b16 v[80:81], v13 offset:57344
ds_read_b64_tr_b16 v[82:83], v13 offset:61440
ds_read_b64_tr_b16 v[84:85], v14 offset:57344
ds_read_b64_tr_b16 v[86:87], v14 offset:61440
ds_read_b64_tr_b16 v[88:89], v15 offset:57344
ds_read_b64_tr_b16 v[90:91], v15 offset:61440
ds_read_b64_tr_b16 v[92:93], v16 offset:57344
ds_read_b64_tr_b16 v[94:95], v16 offset:61440
ds_read_b128 v[68:71], v7 offset:41984
ds_read_b128 v[72:75], v7 offset:43008
ds_read_b128 v[76:79], v7 offset:44032
s_add_u32 m0, s39, 49152
s_add_u32 s37, s52, 573440
buffer_load_dwordx4 v3, s[24:27], s37 offen sc1 lds
buffer_load_dwordx4 v3, s[24:27], s37 offen offset:1024 sc1 lds
buffer_load_dwordx4 v3, s[24:27], s37 offen offset:2048 sc1 lds
buffer_load_dwordx4 v3, s[24:27], s37 offen offset:3072 sc1 lds
s_add_u32 m0, s39, 65536
s_add_u32 s38, s53, 4587520
buffer_load_dwordx4 v23, s[28:31], s38 offen lds
s_add_u32 m0, s39, 66560
s_add_u32 s38, s53, 4587520
buffer_load_dwordx4 v24, s[28:31], s38 offen lds
s_add_u32 m0, s39, 67584
s_add_u32 s38, s53, 4603904
buffer_load_dwordx4 v23, s[28:31], s38 offen lds
s_add_u32 m0, s39, 68608
s_add_u32 s38, s53, 4603904
buffer_load_dwordx4 v24, s[28:31], s38 offen lds
s_waitcnt vmcnt(16)
s_waitcnt lgkmcnt(0)
s_barrier
v_mfma_f32_16x16x32_bf16 v[128:131], v[48:51], v[32:35], v[128:131]
ds_read_b128 v[96:99], v8 offset:0
v_mfma_f32_16x16x32_bf16 v[132:135], v[52:55], v[32:35], v[132:135]
ds_read_b64_tr_b16 v[112:113], v9 offset:0
v_mfma_f32_16x16x32_bf16 v[160:163], v[56:59], v[32:35], 0
ds_read_b64_tr_b16 v[114:115], v9 offset:4096
v_mfma_f32_16x16x32_bf16 v[164:167], v[60:63], v[32:35], 0
ds_read_b64_tr_b16 v[116:117], v10 offset:0
v_mfma_f32_16x16x32_bf16 v[172:175], v[60:63], v[36:39], 0
ds_read_b64_tr_b16 v[118:119], v10 offset:4096
v_mfma_f32_16x16x32_bf16 v[168:171], v[56:59], v[36:39], 0
ds_read_b64_tr_b16 v[120:121], v11 offset:0
v_mfma_f32_16x16x32_bf16 v[140:143], v[52:55], v[36:39], v[140:143]
ds_read_b64_tr_b16 v[122:123], v11 offset:4096
v_mfma_f32_16x16x32_bf16 v[136:139], v[48:51], v[36:39], v[136:139]
ds_read_b64_tr_b16 v[124:125], v12 offset:0
v_mfma_f32_16x16x32_bf16 v[144:147], v[48:51], v[40:43], v[144:147]
ds_read_b64_tr_b16 v[126:127], v12 offset:4096
v_mfma_f32_16x16x32_bf16 v[148:151], v[52:55], v[40:43], v[148:151]
ds_read_b128 v[100:103], v8 offset:1024
v_mfma_f32_16x16x32_bf16 v[176:179], v[56:59], v[40:43], 0
ds_read_b128 v[104:107], v8 offset:2048
v_mfma_f32_16x16x32_bf16 v[180:183], v[60:63], v[40:43], 0
ds_read_b128 v[108:111], v8 offset:3072
v_mfma_f32_16x16x32_bf16 v[188:191], v[60:63], v[44:47], 0
ds_read_b128 v[192:195], v8 offset:8192
v_mfma_f32_16x16x32_bf16 v[184:187], v[56:59], v[44:47], 0
ds_read_b64_tr_b16 v[208:209], v9 offset:8192
v_mfma_f32_16x16x32_bf16 v[156:159], v[52:55], v[44:47], v[156:159]
ds_read_b64_tr_b16 v[210:211], v9 offset:12288
v_mfma_f32_16x16x32_bf16 v[152:155], v[48:51], v[44:47], v[152:155]
ds_read_b64_tr_b16 v[212:213], v10 offset:8192
v_mfma_f32_16x16x32_bf16 v[128:131], v[80:83], v[64:67], v[128:131]
ds_read_b64_tr_b16 v[214:215], v10 offset:12288
v_mfma_f32_16x16x32_bf16 v[132:135], v[84:87], v[64:67], v[132:135]
ds_read_b64_tr_b16 v[216:217], v11 offset:8192
v_mfma_f32_16x16x32_bf16 v[160:163], v[88:91], v[64:67], v[160:163]
ds_read_b64_tr_b16 v[218:219], v11 offset:12288
v_mfma_f32_16x16x32_bf16 v[164:167], v[92:95], v[64:67], v[164:167]
ds_read_b64_tr_b16 v[220:221], v12 offset:8192
v_mfma_f32_16x16x32_bf16 v[172:175], v[92:95], v[68:71], v[172:175]
ds_read_b64_tr_b16 v[222:223], v12 offset:12288
v_mfma_f32_16x16x32_bf16 v[168:171], v[88:91], v[68:71], v[168:171]
ds_read_b128 v[196:199], v8 offset:9216
v_mfma_f32_16x16x32_bf16 v[140:143], v[84:87], v[68:71], v[140:143]
ds_read_b128 v[200:203], v8 offset:10240
v_mfma_f32_16x16x32_bf16 v[136:139], v[80:83], v[68:71], v[136:139]
ds_read_b128 v[204:207], v8 offset:11264
v_mfma_f32_16x16x32_bf16 v[144:147], v[80:83], v[72:75], v[144:147]
v_mfma_f32_16x16x32_bf16 v[148:151], v[84:87], v[72:75], v[148:151]
v_mfma_f32_16x16x32_bf16 v[176:179], v[88:91], v[72:75], v[176:179]
v_mfma_f32_16x16x32_bf16 v[180:183], v[92:95], v[72:75], v[180:183]
v_mfma_f32_16x16x32_bf16 v[188:191], v[92:95], v[76:79], v[188:191]
v_mfma_f32_16x16x32_bf16 v[184:187], v[88:91], v[76:79], v[184:187]
v_mfma_f32_16x16x32_bf16 v[156:159], v[84:87], v[76:79], v[156:159]
v_mfma_f32_16x16x32_bf16 v[152:155], v[80:83], v[76:79], v[152:155]
s_mov_b32 s41, 2
Lk4_143:
s_waitcnt vmcnt(8)
s_waitcnt lgkmcnt(0)
s_barrier
v_mfma_f32_16x16x32_bf16 v[128:131], v[112:115], v[96:99], v[128:131]
ds_read_b128 v[32:35], v6 offset:16384
v_mfma_f32_16x16x32_bf16 v[132:135], v[116:119], v[96:99], v[132:135]
ds_read_b64_tr_b16 v[48:49], v9 offset:32768
v_mfma_f32_16x16x32_bf16 v[160:163], v[120:123], v[96:99], v[160:163]
ds_read_b64_tr_b16 v[50:51], v9 offset:36864
v_mfma_f32_16x16x32_bf16 v[164:167], v[124:127], v[96:99], v[164:167]
ds_read_b64_tr_b16 v[52:53], v10 offset:32768
v_mfma_f32_16x16x32_bf16 v[172:175], v[124:127], v[100:103], v[172:175]
ds_read_b64_tr_b16 v[54:55], v10 offset:36864
v_mfma_f32_16x16x32_bf16 v[168:171], v[120:123], v[100:103], v[168:171]
ds_read_b64_tr_b16 v[56:57], v11 offset:32768
v_mfma_f32_16x16x32_bf16 v[140:143], v[116:119], v[100:103], v[140:143]
ds_read_b64_tr_b16 v[58:59], v11 offset:36864
v_mfma_f32_16x16x32_bf16 v[136:139], v[112:115], v[100:103], v[136:139]
ds_read_b64_tr_b16 v[60:61], v12 offset:32768
v_mfma_f32_16x16x32_bf16 v[144:147], v[112:115], v[104:107], v[144:147]
ds_read_b64_tr_b16 v[62:63], v12 offset:36864
v_mfma_f32_16x16x32_bf16 v[148:151], v[116:119], v[104:107], v[148:151]
ds_read_b128 v[36:39], v6 offset:17408
v_mfma_f32_16x16x32_bf16 v[176:179], v[120:123], v[104:107], v[176:179]
ds_read_b128 v[40:43], v6 offset:18432
v_mfma_f32_16x16x32_bf16 v[180:183], v[124:127], v[104:107], v[180:183]
ds_read_b128 v[44:47], v6 offset:19456
v_mfma_f32_16x16x32_bf16 v[188:191], v[124:127], v[108:111], v[188:191]
ds_read_b128 v[64:67], v6 offset:24576
v_mfma_f32_16x16x32_bf16 v[184:187], v[120:123], v[108:111], v[184:187]
ds_read_b64_tr_b16 v[80:81], v9 offset:40960
v_mfma_f32_16x16x32_bf16 v[156:159], v[116:119], v[108:111], v[156:159]
ds_read_b64_tr_b16 v[82:83], v9 offset:45056
v_mfma_f32_16x16x32_bf16 v[152:155], v[112:115], v[108:111], v[152:155]
ds_read_b64_tr_b16 v[84:85], v10 offset:40960
v_mfma_f32_16x16x32_bf16 v[128:131], v[208:211], v[192:195], v[128:131]
ds_read_b64_tr_b16 v[86:87], v10 offset:45056
v_mfma_f32_16x16x32_bf16 v[132:135], v[212:215], v[192:195], v[132:135]
ds_read_b64_tr_b16 v[88:89], v11 offset:40960
v_mfma_f32_16x16x32_bf16 v[160:163], v[216:219], v[192:195], v[160:163]
ds_read_b64_tr_b16 v[90:91], v11 offset:45056
v_mfma_f32_16x16x32_bf16 v[164:167], v[220:223], v[192:195], v[164:167]
ds_read_b64_tr_b16 v[92:93], v12 offset:40960
v_mfma_f32_16x16x32_bf16 v[172:175], v[220:223], v[196:199], v[172:175]
ds_read_b64_tr_b16 v[94:95], v12 offset:45056
v_mfma_f32_16x16x32_bf16 v[168:171], v[216:219], v[196:199], v[168:171]
ds_read_b128 v[68:71], v6 offset:25600
v_mfma_f32_16x16x32_bf16 v[140:143], v[212:215], v[196:199], v[140:143]
ds_read_b128 v[72:75], v6 offset:26624
v_mfma_f32_16x16x32_bf16 v[136:139], v[208:211], v[196:199], v[136:139]
ds_read_b128 v[76:79], v6 offset:27648
v_mfma_f32_16x16x32_bf16 v[144:147], v[208:211], v[200:203], v[144:147]
v_mfma_f32_16x16x32_bf16 v[148:151], v[212:215], v[200:203], v[148:151]
v_mfma_f32_16x16x32_bf16 v[176:179], v[216:219], v[200:203], v[176:179]
v_mfma_f32_16x16x32_bf16 v[180:183], v[220:223], v[200:203], v[180:183]
v_mfma_f32_16x16x32_bf16 v[188:191], v[220:223], v[204:207], v[188:191]
v_mfma_f32_16x16x32_bf16 v[184:187], v[216:219], v[204:207], v[184:187]
v_mfma_f32_16x16x32_bf16 v[156:159], v[212:215], v[204:207], v[156:159]
v_mfma_f32_16x16x32_bf16 v[152:155], v[208:211], v[204:207], v[152:155]
s_waitcnt vmcnt(0)
s_waitcnt lgkmcnt(0)
s_barrier
v_mfma_f32_16x16x32_bf16 v[128:131], v[48:51], v[32:35], v[128:131]
ds_read_b128 v[96:99], v6 offset:49152
v_mfma_f32_16x16x32_bf16 v[132:135], v[52:55], v[32:35], v[132:135]
ds_read_b64_tr_b16 v[112:113], v13 offset:0
v_mfma_f32_16x16x32_bf16 v[160:163], v[56:59], v[32:35], v[160:163]
ds_read_b64_tr_b16 v[114:115], v13 offset:4096
v_mfma_f32_16x16x32_bf16 v[164:167], v[60:63], v[32:35], v[164:167]
ds_read_b64_tr_b16 v[116:117], v14 offset:0
v_mfma_f32_16x16x32_bf16 v[172:175], v[60:63], v[36:39], v[172:175]
ds_read_b64_tr_b16 v[118:119], v14 offset:4096
v_mfma_f32_16x16x32_bf16 v[168:171], v[56:59], v[36:39], v[168:171]
ds_read_b64_tr_b16 v[120:121], v15 offset:0
v_mfma_f32_16x16x32_bf16 v[140:143], v[52:55], v[36:39], v[140:143]
ds_read_b64_tr_b16 v[122:123], v15 offset:4096
v_mfma_f32_16x16x32_bf16 v[136:139], v[48:51], v[36:39], v[136:139]
ds_read_b64_tr_b16 v[124:125], v16 offset:0
v_mfma_f32_16x16x32_bf16 v[144:147], v[48:51], v[40:43], v[144:147]
ds_read_b64_tr_b16 v[126:127], v16 offset:4096
v_mfma_f32_16x16x32_bf16 v[148:151], v[52:55], v[40:43], v[148:151]
ds_read_b128 v[100:103], v6 offset:50176
v_mfma_f32_16x16x32_bf16 v[176:179], v[56:59], v[40:43], v[176:179]
ds_read_b128 v[104:107], v6 offset:51200
v_mfma_f32_16x16x32_bf16 v[180:183], v[60:63], v[40:43], v[180:183]
ds_read_b128 v[108:111], v6 offset:52224
v_mfma_f32_16x16x32_bf16 v[188:191], v[60:63], v[44:47], v[188:191]
ds_read_b128 v[192:195], v6 offset:57344
v_mfma_f32_16x16x32_bf16 v[184:187], v[56:59], v[44:47], v[184:187]
ds_read_b64_tr_b16 v[208:209], v13 offset:8192
v_mfma_f32_16x16x32_bf16 v[156:159], v[52:55], v[44:47], v[156:159]
ds_read_b64_tr_b16 v[210:211], v13 offset:12288
v_mfma_f32_16x16x32_bf16 v[152:155], v[48:51], v[44:47], v[152:155]
ds_read_b64_tr_b16 v[212:213], v14 offset:8192
v_mfma_f32_16x16x32_bf16 v[128:131], v[80:83], v[64:67], v[128:131]
ds_read_b64_tr_b16 v[214:215], v14 offset:12288
v_mfma_f32_16x16x32_bf16 v[132:135], v[84:87], v[64:67], v[132:135]
ds_read_b64_tr_b16 v[216:217], v15 offset:8192
v_mfma_f32_16x16x32_bf16 v[160:163], v[88:91], v[64:67], v[160:163]
ds_read_b64_tr_b16 v[218:219], v15 offset:12288
v_mfma_f32_16x16x32_bf16 v[164:167], v[92:95], v[64:67], v[164:167]
ds_read_b64_tr_b16 v[220:221], v16 offset:8192
v_mfma_f32_16x16x32_bf16 v[172:175], v[92:95], v[68:71], v[172:175]
ds_read_b64_tr_b16 v[222:223], v16 offset:12288
v_mfma_f32_16x16x32_bf16 v[168:171], v[88:91], v[68:71], v[168:171]
ds_read_b128 v[196:199], v6 offset:58368
v_mfma_f32_16x16x32_bf16 v[140:143], v[84:87], v[68:71], v[140:143]
ds_read_b128 v[200:203], v6 offset:59392
v_mfma_f32_16x16x32_bf16 v[136:139], v[80:83], v[68:71], v[136:139]
ds_read_b128 v[204:207], v6 offset:60416
v_mfma_f32_16x16x32_bf16 v[144:147], v[80:83], v[72:75], v[144:147]
v_mfma_f32_16x16x32_bf16 v[148:151], v[84:87], v[72:75], v[148:151]
v_mfma_f32_16x16x32_bf16 v[176:179], v[88:91], v[72:75], v[176:179]
v_mfma_f32_16x16x32_bf16 v[180:183], v[92:95], v[72:75], v[180:183]
v_mfma_f32_16x16x32_bf16 v[188:191], v[92:95], v[76:79], v[188:191]
v_mfma_f32_16x16x32_bf16 v[184:187], v[88:91], v[76:79], v[184:187]
v_mfma_f32_16x16x32_bf16 v[156:159], v[84:87], v[76:79], v[156:159]
v_mfma_f32_16x16x32_bf16 v[152:155], v[80:83], v[76:79], v[152:155]
s_waitcnt lgkmcnt(0)
s_barrier
v_mfma_f32_16x16x32_bf16 v[128:131], v[112:115], v[96:99], v[128:131]
s_branch Lov_11
.p2align 12
Lst_11_0:
s_branch Lwr_178
Lst_11_1:
s_branch Lst_15_0
s_nop 0
Lov_11:
ds_read_b128 v[32:35], v7 offset:16384
v_mfma_f32_16x16x32_bf16 v[132:135], v[116:119], v[96:99], v[132:135]
ds_read_b64_tr_b16 v[48:49], v25 offset:16384
v_mfma_f32_16x16x32_bf16 v[160:163], v[120:123], v[96:99], v[160:163]
ds_read_b64_tr_b16 v[50:51], v25 offset:20480
v_mfma_f32_16x16x32_bf16 v[164:167], v[124:127], v[96:99], v[164:167]
ds_read_b64_tr_b16 v[52:53], v26 offset:16384
v_mfma_f32_16x16x32_bf16 v[172:175], v[124:127], v[100:103], v[172:175]
ds_read_b64_tr_b16 v[54:55], v26 offset:20480
v_mfma_f32_16x16x32_bf16 v[168:171], v[120:123], v[100:103], v[168:171]
ds_read_b64_tr_b16 v[56:57], v27 offset:16384
v_mfma_f32_16x16x32_bf16 v[140:143], v[116:119], v[100:103], v[140:143]
ds_read_b64_tr_b16 v[58:59], v27 offset:20480
v_mfma_f32_16x16x32_bf16 v[136:139], v[112:115], v[100:103], v[136:139]
ds_read_b64_tr_b16 v[60:61], v28 offset:16384
v_mfma_f32_16x16x32_bf16 v[144:147], v[112:115], v[104:107], v[144:147]
ds_read_b64_tr_b16 v[62:63], v28 offset:20480
v_mfma_f32_16x16x32_bf16 v[148:151], v[116:119], v[104:107], v[148:151]
ds_read_b128 v[36:39], v7 offset:17408
v_mfma_f32_16x16x32_bf16 v[176:179], v[120:123], v[104:107], v[176:179]
ds_read_b128 v[40:43], v7 offset:18432
v_mfma_f32_16x16x32_bf16 v[180:183], v[124:127], v[104:107], v[180:183]
ds_read_b128 v[44:47], v7 offset:19456
v_mfma_f32_16x16x32_bf16 v[188:191], v[124:127], v[108:111], v[188:191]
ds_read_b128 v[64:67], v7 offset:24576
v_mfma_f32_16x16x32_bf16 v[184:187], v[120:123], v[108:111], v[184:187]
ds_read_b64_tr_b16 v[80:81], v25 offset:24576
v_mfma_f32_16x16x32_bf16 v[156:159], v[116:119], v[108:111], v[156:159]
ds_read_b64_tr_b16 v[82:83], v25 offset:28672
v_mfma_f32_16x16x32_bf16 v[152:155], v[112:115], v[108:111], v[152:155]
ds_read_b64_tr_b16 v[84:85], v26 offset:24576
v_mfma_f32_16x16x32_bf16 v[128:131], v[208:211], v[192:195], v[128:131]
ds_read_b64_tr_b16 v[86:87], v26 offset:28672
v_mfma_f32_16x16x32_bf16 v[132:135], v[212:215], v[192:195], v[132:135]
ds_read_b64_tr_b16 v[88:89], v27 offset:24576
v_mfma_f32_16x16x32_bf16 v[160:163], v[216:219], v[192:195], v[160:163]
ds_read_b64_tr_b16 v[90:91], v27 offset:28672
v_mfma_f32_16x16x32_bf16 v[164:167], v[220:223], v[192:195], v[164:167]
ds_read_b64_tr_b16 v[92:93], v28 offset:24576
v_mfma_f32_16x16x32_bf16 v[172:175], v[220:223], v[196:199], v[172:175]
ds_read_b64_tr_b16 v[94:95], v28 offset:28672
v_mfma_f32_16x16x32_bf16 v[168:171], v[216:219], v[196:199], v[168:171]
ds_read_b128 v[68:71], v7 offset:25600
v_mfma_f32_16x16x32_bf16 v[140:143], v[212:215], v[196:199], v[140:143]
ds_read_b128 v[72:75], v7 offset:26624
v_mfma_f32_16x16x32_bf16 v[136:139], v[208:211], v[196:199], v[136:139]
ds_read_b128 v[76:79], v7 offset:27648
v_mfma_f32_16x16x32_bf16 v[144:147], v[208:211], v[200:203], v[144:147]
v_mfma_f32_16x16x32_bf16 v[148:151], v[212:215], v[200:203], v[148:151]
v_mfma_f32_16x16x32_bf16 v[176:179], v[216:219], v[200:203], v[176:179]
v_mfma_f32_16x16x32_bf16 v[180:183], v[220:223], v[200:203], v[180:183]
v_mfma_f32_16x16x32_bf16 v[188:191], v[220:223], v[204:207], v[188:191]
v_mfma_f32_16x16x32_bf16 v[184:187], v[216:219], v[204:207], v[184:187]
v_mfma_f32_16x16x32_bf16 v[156:159], v[212:215], v[204:207], v[156:159]
v_mfma_f32_16x16x32_bf16 v[152:155], v[208:211], v[204:207], v[152:155]
s_waitcnt lgkmcnt(0)
s_barrier
v_mfma_f32_16x16x32_bf16 v[128:131], v[48:51], v[32:35], v[128:131]
ds_read_b128 v[96:99], v7 offset:32768
v_mfma_f32_16x16x32_bf16 v[132:135], v[52:55], v[32:35], v[132:135]
ds_read_b64_tr_b16 v[112:113], v13 offset:49152
v_mfma_f32_16x16x32_bf16 v[160:163], v[56:59], v[32:35], v[160:163]
ds_read_b64_tr_b16 v[114:115], v13 offset:53248
v_mfma_f32_16x16x32_bf16 v[164:167], v[60:63], v[32:35], v[164:167]
ds_read_b64_tr_b16 v[116:117], v14 offset:49152
v_mfma_f32_16x16x32_bf16 v[172:175], v[60:63], v[36:39], v[172:175]
ds_read_b64_tr_b16 v[118:119], v14 offset:53248
v_mfma_f32_16x16x32_bf16 v[168:171], v[56:59], v[36:39], v[168:171]
ds_read_b64_tr_b16 v[120:121], v15 offset:49152
v_mfma_f32_16x16x32_bf16 v[140:143], v[52:55], v[36:39], v[140:143]
ds_read_b64_tr_b16 v[122:123], v15 offset:53248
v_mfma_f32_16x16x32_bf16 v[136:139], v[48:51], v[36:39], v[136:139]
ds_read_b64_tr_b16 v[124:125], v16 offset:49152
v_mfma_f32_16x16x32_bf16 v[144:147], v[48:51], v[40:43], v[144:147]
ds_read_b64_tr_b16 v[126:127], v16 offset:53248
v_mfma_f32_16x16x32_bf16 v[148:151], v[52:55], v[40:43], v[148:151]
ds_read_b128 v[100:103], v7 offset:33792
v_mfma_f32_16x16x32_bf16 v[176:179], v[56:59], v[40:43], v[176:179]
ds_read_b128 v[104:107], v7 offset:34816
v_mfma_f32_16x16x32_bf16 v[180:183], v[60:63], v[40:43], v[180:183]
ds_read_b128 v[108:111], v7 offset:35840
v_mfma_f32_16x16x32_bf16 v[188:191], v[60:63], v[44:47], v[188:191]
ds_read_b128 v[192:195], v7 offset:40960
v_mfma_f32_16x16x32_bf16 v[184:187], v[56:59], v[44:47], v[184:187]
ds_read_b64_tr_b16 v[208:209], v13 offset:57344
v_mfma_f32_16x16x32_bf16 v[156:159], v[52:55], v[44:47], v[156:159]
ds_read_b64_tr_b16 v[210:211], v13 offset:61440
v_mfma_f32_16x16x32_bf16 v[152:155], v[48:51], v[44:47], v[152:155]
ds_read_b64_tr_b16 v[212:213], v14 offset:57344
v_mfma_f32_16x16x32_bf16 v[128:131], v[80:83], v[64:67], v[128:131]
ds_read_b64_tr_b16 v[214:215], v14 offset:61440
v_mfma_f32_16x16x32_bf16 v[132:135], v[84:87], v[64:67], v[132:135]
ds_read_b64_tr_b16 v[216:217], v15 offset:57344
v_mfma_f32_16x16x32_bf16 v[160:163], v[88:91], v[64:67], v[160:163]
ds_read_b64_tr_b16 v[218:219], v15 offset:61440
v_mfma_f32_16x16x32_bf16 v[164:167], v[92:95], v[64:67], v[164:167]
ds_read_b64_tr_b16 v[220:221], v16 offset:57344
v_mfma_f32_16x16x32_bf16 v[172:175], v[92:95], v[68:71], v[172:175]
ds_read_b64_tr_b16 v[222:223], v16 offset:61440
v_mfma_f32_16x16x32_bf16 v[168:171], v[88:91], v[68:71], v[168:171]
ds_read_b128 v[196:199], v7 offset:41984
v_mfma_f32_16x16x32_bf16 v[140:143], v[84:87], v[68:71], v[140:143]
ds_read_b128 v[200:203], v7 offset:43008
v_mfma_f32_16x16x32_bf16 v[136:139], v[80:83], v[68:71], v[136:139]
ds_read_b128 v[204:207], v7 offset:44032
v_mfma_f32_16x16x32_bf16 v[144:147], v[80:83], v[72:75], v[144:147]
v_mfma_f32_16x16x32_bf16 v[148:151], v[84:87], v[72:75], v[148:151]
v_mfma_f32_16x16x32_bf16 v[176:179], v[88:91], v[72:75], v[176:179]
v_mfma_f32_16x16x32_bf16 v[180:183], v[92:95], v[72:75], v[180:183]
v_mfma_f32_16x16x32_bf16 v[188:191], v[92:95], v[76:79], v[188:191]
v_mfma_f32_16x16x32_bf16 v[184:187], v[88:91], v[76:79], v[184:187]
v_mfma_f32_16x16x32_bf16 v[156:159], v[84:87], v[76:79], v[156:159]
v_mfma_f32_16x16x32_bf16 v[152:155], v[80:83], v[76:79], v[152:155]
s_waitcnt lgkmcnt(0)
s_barrier
v_mfma_f32_16x16x32_bf16 v[128:131], v[112:115], v[96:99], v[128:131]
ds_read_b128 v[32:35], v8 offset:0
v_mfma_f32_16x16x32_bf16 v[132:135], v[116:119], v[96:99], v[132:135]
ds_read_b64_tr_b16 v[48:49], v9 offset:0
v_mfma_f32_16x16x32_bf16 v[160:163], v[120:123], v[96:99], v[160:163]
ds_read_b64_tr_b16 v[50:51], v9 offset:4096
v_mfma_f32_16x16x32_bf16 v[164:167], v[124:127], v[96:99], v[164:167]
ds_read_b64_tr_b16 v[52:53], v10 offset:0
v_mfma_f32_16x16x32_bf16 v[172:175], v[124:127], v[100:103], v[172:175]
ds_read_b64_tr_b16 v[54:55], v10 offset:4096
v_mfma_f32_16x16x32_bf16 v[168:171], v[120:123], v[100:103], v[168:171]
ds_read_b64_tr_b16 v[56:57], v11 offset:0
v_mfma_f32_16x16x32_bf16 v[140:143], v[116:119], v[100:103], v[140:143]
ds_read_b64_tr_b16 v[58:59], v11 offset:4096
v_mfma_f32_16x16x32_bf16 v[136:139], v[112:115], v[100:103], v[136:139]
ds_read_b64_tr_b16 v[60:61], v12 offset:0
v_mfma_f32_16x16x32_bf16 v[144:147], v[112:115], v[104:107], v[144:147]
ds_read_b64_tr_b16 v[62:63], v12 offset:4096
v_mfma_f32_16x16x32_bf16 v[148:151], v[116:119], v[104:107], v[148:151]
ds_read_b128 v[36:39], v8 offset:1024
v_mfma_f32_16x16x32_bf16 v[176:179], v[120:123], v[104:107], v[176:179]
ds_read_b128 v[40:43], v8 offset:2048
v_mfma_f32_16x16x32_bf16 v[180:183], v[124:127], v[104:107], v[180:183]
ds_read_b128 v[44:47], v8 offset:3072
v_mfma_f32_16x16x32_bf16 v[188:191], v[124:127], v[108:111], v[188:191]
ds_read_b128 v[64:67], v8 offset:8192
v_mfma_f32_16x16x32_bf16 v[184:187], v[120:123], v[108:111], v[184:187]
ds_read_b64_tr_b16 v[80:81], v9 offset:8192
v_mfma_f32_16x16x32_bf16 v[156:159], v[116:119], v[108:111], v[156:159]
ds_read_b64_tr_b16 v[82:83], v9 offset:12288
v_mfma_f32_16x16x32_bf16 v[152:155], v[112:115], v[108:111], v[152:155]
ds_read_b64_tr_b16 v[84:85], v10 offset:8192
v_mfma_f32_16x16x32_bf16 v[128:131], v[208:211], v[192:195], v[128:131]
ds_read_b64_tr_b16 v[86:87], v10 offset:12288
v_mfma_f32_16x16x32_bf16 v[132:135], v[212:215], v[192:195], v[132:135]
ds_read_b64_tr_b16 v[88:89], v11 offset:8192
v_mfma_f32_16x16x32_bf16 v[160:163], v[216:219], v[192:195], v[160:163]
ds_read_b64_tr_b16 v[90:91], v11 offset:12288
v_mfma_f32_16x16x32_bf16 v[164:167], v[220:223], v[192:195], v[164:167]
ds_read_b64_tr_b16 v[92:93], v12 offset:8192
v_mfma_f32_16x16x32_bf16 v[172:175], v[220:223], v[196:199], v[172:175]
ds_read_b64_tr_b16 v[94:95], v12 offset:12288
v_mfma_f32_16x16x32_bf16 v[168:171], v[216:219], v[196:199], v[168:171]
ds_read_b128 v[68:71], v8 offset:9216
v_mfma_f32_16x16x32_bf16 v[140:143], v[212:215], v[196:199], v[140:143]
ds_read_b128 v[72:75], v8 offset:10240
v_mfma_f32_16x16x32_bf16 v[136:139], v[208:211], v[196:199], v[136:139]
ds_read_b128 v[76:79], v8 offset:11264
v_mfma_f32_16x16x32_bf16 v[144:147], v[208:211], v[200:203], v[144:147]
v_mfma_f32_16x16x32_bf16 v[148:151], v[212:215], v[200:203], v[148:151]
v_mfma_f32_16x16x32_bf16 v[176:179], v[216:219], v[200:203], v[176:179]
v_mfma_f32_16x16x32_bf16 v[180:183], v[220:223], v[200:203], v[180:183]
v_mfma_f32_16x16x32_bf16 v[188:191], v[220:223], v[204:207], v[188:191]
v_mfma_f32_16x16x32_bf16 v[184:187], v[216:219], v[204:207], v[184:187]
v_mfma_f32_16x16x32_bf16 v[156:159], v[212:215], v[204:207], v[156:159]
v_mfma_f32_16x16x32_bf16 v[152:155], v[208:211], v[204:207], v[152:155]
s_waitcnt lgkmcnt(0)
s_barrier
v_mfma_f32_16x16x32_bf16 v[128:131], v[48:51], v[32:35], v[128:131]
ds_read_b128 v[96:99], v6 offset:16384
v_mfma_f32_16x16x32_bf16 v[132:135], v[52:55], v[32:35], v[132:135]
ds_read_b64_tr_b16 v[112:113], v9 offset:32768
v_mfma_f32_16x16x32_bf16 v[160:163], v[56:59], v[32:35], v[160:163]
ds_read_b64_tr_b16 v[114:115], v9 offset:36864
v_mfma_f32_16x16x32_bf16 v[164:167], v[60:63], v[32:35], v[164:167]
ds_read_b64_tr_b16 v[116:117], v10 offset:32768
v_mfma_f32_16x16x32_bf16 v[172:175], v[60:63], v[36:39], v[172:175]
ds_read_b64_tr_b16 v[118:119], v10 offset:36864
v_mfma_f32_16x16x32_bf16 v[168:171], v[56:59], v[36:39], v[168:171]
ds_read_b64_tr_b16 v[120:121], v11 offset:32768
v_mfma_f32_16x16x32_bf16 v[140:143], v[52:55], v[36:39], v[140:143]
ds_read_b64_tr_b16 v[122:123], v11 offset:36864
v_mfma_f32_16x16x32_bf16 v[136:139], v[48:51], v[36:39], v[136:139]
ds_read_b64_tr_b16 v[124:125], v12 offset:32768
v_mfma_f32_16x16x32_bf16 v[144:147], v[48:51], v[40:43], v[144:147]
ds_read_b64_tr_b16 v[126:127], v12 offset:36864
v_mfma_f32_16x16x32_bf16 v[148:151], v[52:55], v[40:43], v[148:151]
ds_read_b128 v[100:103], v6 offset:17408
v_mfma_f32_16x16x32_bf16 v[176:179], v[56:59], v[40:43], v[176:179]
ds_read_b128 v[104:107], v6 offset:18432
v_mfma_f32_16x16x32_bf16 v[180:183], v[60:63], v[40:43], v[180:183]
ds_read_b128 v[108:111], v6 offset:19456
v_mfma_f32_16x16x32_bf16 v[188:191], v[60:63], v[44:47], v[188:191]
ds_read_b128 v[192:195], v6 offset:24576
v_mfma_f32_16x16x32_bf16 v[184:187], v[56:59], v[44:47], v[184:187]
ds_read_b64_tr_b16 v[208:209], v9 offset:40960
v_mfma_f32_16x16x32_bf16 v[156:159], v[52:55], v[44:47], v[156:159]
ds_read_b64_tr_b16 v[210:211], v9 offset:45056
v_mfma_f32_16x16x32_bf16 v[152:155], v[48:51], v[44:47], v[152:155]
ds_read_b64_tr_b16 v[212:213], v10 offset:40960
v_mfma_f32_16x16x32_bf16 v[128:131], v[80:83], v[64:67], v[128:131]
ds_read_b64_tr_b16 v[214:215], v10 offset:45056
v_mfma_f32_16x16x32_bf16 v[132:135], v[84:87], v[64:67], v[132:135]
ds_read_b64_tr_b16 v[216:217], v11 offset:40960
v_mfma_f32_16x16x32_bf16 v[160:163], v[88:91], v[64:67], v[160:163]
ds_read_b64_tr_b16 v[218:219], v11 offset:45056
v_mfma_f32_16x16x32_bf16 v[164:167], v[92:95], v[64:67], v[164:167]
ds_read_b64_tr_b16 v[220:221], v12 offset:40960
v_mfma_f32_16x16x32_bf16 v[172:175], v[92:95], v[68:71], v[172:175]
ds_read_b64_tr_b16 v[222:223], v12 offset:45056
v_mfma_f32_16x16x32_bf16 v[168:171], v[88:91], v[68:71], v[168:171]
ds_read_b128 v[196:199], v6 offset:25600
v_mfma_f32_16x16x32_bf16 v[140:143], v[84:87], v[68:71], v[140:143]
ds_read_b128 v[200:203], v6 offset:26624
v_mfma_f32_16x16x32_bf16 v[136:139], v[80:83], v[68:71], v[136:139]
ds_read_b128 v[204:207], v6 offset:27648
v_mfma_f32_16x16x32_bf16 v[144:147], v[80:83], v[72:75], v[144:147]
v_mfma_f32_16x16x32_bf16 v[148:151], v[84:87], v[72:75], v[148:151]
v_mfma_f32_16x16x32_bf16 v[176:179], v[88:91], v[72:75], v[176:179]
v_mfma_f32_16x16x32_bf16 v[180:183], v[92:95], v[72:75], v[180:183]
v_mfma_f32_16x16x32_bf16 v[188:191], v[92:95], v[76:79], v[188:191]
v_mfma_f32_16x16x32_bf16 v[184:187], v[88:91], v[76:79], v[184:187]
v_mfma_f32_16x16x32_bf16 v[156:159], v[84:87], v[76:79], v[156:159]
v_mfma_f32_16x16x32_bf16 v[152:155], v[80:83], v[76:79], v[152:155]
s_waitcnt lgkmcnt(0)
s_barrier
v_mfma_f32_16x16x32_bf16 v[128:131], v[112:115], v[96:99], v[128:131]
ds_read_b128 v[32:35], v6 offset:49152
v_mfma_f32_16x16x32_bf16 v[132:135], v[116:119], v[96:99], v[132:135]
ds_read_b64_tr_b16 v[48:49], v13 offset:0
v_mfma_f32_16x16x32_bf16 v[160:163], v[120:123], v[96:99], v[160:163]
ds_read_b64_tr_b16 v[50:51], v13 offset:4096
v_mfma_f32_16x16x32_bf16 v[164:167], v[124:127], v[96:99], v[164:167]
ds_read_b64_tr_b16 v[52:53], v14 offset:0
v_mfma_f32_16x16x32_bf16 v[172:175], v[124:127], v[100:103], v[172:175]
ds_read_b64_tr_b16 v[54:55], v14 offset:4096
v_mfma_f32_16x16x32_bf16 v[168:171], v[120:123], v[100:103], v[168:171]
ds_read_b64_tr_b16 v[56:57], v15 offset:0
v_mfma_f32_16x16x32_bf16 v[140:143], v[116:119], v[100:103], v[140:143]
ds_read_b64_tr_b16 v[58:59], v15 offset:4096
v_mfma_f32_16x16x32_bf16 v[136:139], v[112:115], v[100:103], v[136:139]
ds_read_b64_tr_b16 v[60:61], v16 offset:0
v_mfma_f32_16x16x32_bf16 v[144:147], v[112:115], v[104:107], v[144:147]
ds_read_b64_tr_b16 v[62:63], v16 offset:4096
v_mfma_f32_16x16x32_bf16 v[148:151], v[116:119], v[104:107], v[148:151]
ds_read_b128 v[36:39], v6 offset:50176
v_mfma_f32_16x16x32_bf16 v[176:179], v[120:123], v[104:107], v[176:179]
ds_read_b128 v[40:43], v6 offset:51200
v_mfma_f32_16x16x32_bf16 v[180:183], v[124:127], v[104:107], v[180:183]
ds_read_b128 v[44:47], v6 offset:52224
v_mfma_f32_16x16x32_bf16 v[188:191], v[124:127], v[108:111], v[188:191]
ds_read_b128 v[64:67], v6 offset:57344
v_mfma_f32_16x16x32_bf16 v[184:187], v[120:123], v[108:111], v[184:187]
ds_read_b64_tr_b16 v[80:81], v13 offset:8192
v_mfma_f32_16x16x32_bf16 v[156:159], v[116:119], v[108:111], v[156:159]
ds_read_b64_tr_b16 v[82:83], v13 offset:12288
v_mfma_f32_16x16x32_bf16 v[152:155], v[112:115], v[108:111], v[152:155]
ds_read_b64_tr_b16 v[84:85], v14 offset:8192
v_mfma_f32_16x16x32_bf16 v[128:131], v[208:211], v[192:195], v[128:131]
ds_read_b64_tr_b16 v[86:87], v14 offset:12288
v_mfma_f32_16x16x32_bf16 v[132:135], v[212:215], v[192:195], v[132:135]
ds_read_b64_tr_b16 v[88:89], v15 offset:8192
v_mfma_f32_16x16x32_bf16 v[160:163], v[216:219], v[192:195], v[160:163]
ds_read_b64_tr_b16 v[90:91], v15 offset:12288
v_mfma_f32_16x16x32_bf16 v[164:167], v[220:223], v[192:195], v[164:167]
ds_read_b64_tr_b16 v[92:93], v16 offset:8192
v_mfma_f32_16x16x32_bf16 v[172:175], v[220:223], v[196:199], v[172:175]
ds_read_b64_tr_b16 v[94:95], v16 offset:12288
v_mfma_f32_16x16x32_bf16 v[168:171], v[216:219], v[196:199], v[168:171]
ds_read_b128 v[68:71], v6 offset:58368
v_mfma_f32_16x16x32_bf16 v[140:143], v[212:215], v[196:199], v[140:143]
ds_read_b128 v[72:75], v6 offset:59392
v_mfma_f32_16x16x32_bf16 v[136:139], v[208:211], v[196:199], v[136:139]
ds_read_b128 v[76:79], v6 offset:60416
v_mfma_f32_16x16x32_bf16 v[144:147], v[208:211], v[200:203], v[144:147]
v_mfma_f32_16x16x32_bf16 v[148:151], v[212:215], v[200:203], v[148:151]
v_mfma_f32_16x16x32_bf16 v[176:179], v[216:219], v[200:203], v[176:179]
v_mfma_f32_16x16x32_bf16 v[180:183], v[220:223], v[200:203], v[180:183]
v_mfma_f32_16x16x32_bf16 v[188:191], v[220:223], v[204:207], v[188:191]
v_mfma_f32_16x16x32_bf16 v[184:187], v[216:219], v[204:207], v[184:187]
v_mfma_f32_16x16x32_bf16 v[156:159], v[212:215], v[204:207], v[156:159]
v_mfma_f32_16x16x32_bf16 v[152:155], v[208:211], v[204:207], v[152:155]
s_waitcnt lgkmcnt(0)
s_barrier
v_mfma_f32_16x16x32_bf16 v[128:131], v[48:51], v[32:35], v[128:131]
ds_read_b128 v[96:99], v7 offset:16384
v_mfma_f32_16x16x32_bf16 v[132:135], v[52:55], v[32:35], v[132:135]
ds_read_b64_tr_b16 v[112:113], v25 offset:16384
v_mfma_f32_16x16x32_bf16 v[160:163], v[56:59], v[32:35], v[160:163]
ds_read_b64_tr_b16 v[114:115], v25 offset:20480
v_mfma_f32_16x16x32_bf16 v[164:167], v[60:63], v[32:35], v[164:167]
ds_read_b64_tr_b16 v[116:117], v26 offset:16384
v_mfma_f32_16x16x32_bf16 v[172:175], v[60:63], v[36:39], v[172:175]
ds_read_b64_tr_b16 v[118:119], v26 offset:20480
v_mfma_f32_16x16x32_bf16 v[168:171], v[56:59], v[36:39], v[168:171]
ds_read_b64_tr_b16 v[120:121], v27 offset:16384
v_mfma_f32_16x16x32_bf16 v[140:143], v[52:55], v[36:39], v[140:143]
ds_read_b64_tr_b16 v[122:123], v27 offset:20480
v_mfma_f32_16x16x32_bf16 v[136:139], v[48:51], v[36:39], v[136:139]
ds_read_b64_tr_b16 v[124:125], v28 offset:16384
v_mfma_f32_16x16x32_bf16 v[144:147], v[48:51], v[40:43], v[144:147]
ds_read_b64_tr_b16 v[126:127], v28 offset:20480
v_mfma_f32_16x16x32_bf16 v[148:151], v[52:55], v[40:43], v[148:151]
ds_read_b128 v[100:103], v7 offset:17408
v_mfma_f32_16x16x32_bf16 v[176:179], v[56:59], v[40:43], v[176:179]
ds_read_b128 v[104:107], v7 offset:18432
v_mfma_f32_16x16x32_bf16 v[180:183], v[60:63], v[40:43], v[180:183]
ds_read_b128 v[108:111], v7 offset:19456
v_mfma_f32_16x16x32_bf16 v[188:191], v[60:63], v[44:47], v[188:191]
ds_read_b128 v[192:195], v7 offset:24576
v_mfma_f32_16x16x32_bf16 v[184:187], v[56:59], v[44:47], v[184:187]
ds_read_b64_tr_b16 v[208:209], v25 offset:24576
v_mfma_f32_16x16x32_bf16 v[156:159], v[52:55], v[44:47], v[156:159]
ds_read_b64_tr_b16 v[210:211], v25 offset:28672
v_mfma_f32_16x16x32_bf16 v[152:155], v[48:51], v[44:47], v[152:155]
ds_read_b64_tr_b16 v[212:213], v26 offset:24576
v_mfma_f32_16x16x32_bf16 v[128:131], v[80:83], v[64:67], v[128:131]
ds_read_b64_tr_b16 v[214:215], v26 offset:28672
v_mfma_f32_16x16x32_bf16 v[132:135], v[84:87], v[64:67], v[132:135]
ds_read_b64_tr_b16 v[216:217], v27 offset:24576
v_mfma_f32_16x16x32_bf16 v[160:163], v[88:91], v[64:67], v[160:163]
ds_read_b64_tr_b16 v[218:219], v27 offset:28672
v_mfma_f32_16x16x32_bf16 v[164:167], v[92:95], v[64:67], v[164:167]
ds_read_b64_tr_b16 v[220:221], v28 offset:24576
v_mfma_f32_16x16x32_bf16 v[172:175], v[92:95], v[68:71], v[172:175]
ds_read_b64_tr_b16 v[222:223], v28 offset:28672
v_mfma_f32_16x16x32_bf16 v[168:171], v[88:91], v[68:71], v[168:171]
ds_read_b128 v[196:199], v7 offset:25600
v_mfma_f32_16x16x32_bf16 v[140:143], v[84:87], v[68:71], v[140:143]
ds_read_b128 v[200:203], v7 offset:26624
v_mfma_f32_16x16x32_bf16 v[136:139], v[80:83], v[68:71], v[136:139]
ds_read_b128 v[204:207], v7 offset:27648
v_mfma_f32_16x16x32_bf16 v[144:147], v[80:83], v[72:75], v[144:147]
v_mfma_f32_16x16x32_bf16 v[148:151], v[84:87], v[72:75], v[148:151]
v_mfma_f32_16x16x32_bf16 v[176:179], v[88:91], v[72:75], v[176:179]
v_mfma_f32_16x16x32_bf16 v[180:183], v[92:95], v[72:75], v[180:183]
v_mfma_f32_16x16x32_bf16 v[188:191], v[92:95], v[76:79], v[188:191]
v_mfma_f32_16x16x32_bf16 v[184:187], v[88:91], v[76:79], v[184:187]
v_mfma_f32_16x16x32_bf16 v[156:159], v[84:87], v[76:79], v[156:159]
v_mfma_f32_16x16x32_bf16 v[152:155], v[80:83], v[76:79], v[152:155]
s_waitcnt lgkmcnt(0)
s_barrier
v_mfma_f32_16x16x32_bf16 v[128:131], v[112:115], v[96:99], v[128:131]
ds_read_b128 v[32:35], v7 offset:32768
v_mfma_f32_16x16x32_bf16 v[132:135], v[116:119], v[96:99], v[132:135]
ds_read_b64_tr_b16 v[48:49], v13 offset:49152
v_mfma_f32_16x16x32_bf16 v[160:163], v[120:123], v[96:99], v[160:163]
ds_read_b64_tr_b16 v[50:51], v13 offset:53248
v_mfma_f32_16x16x32_bf16 v[164:167], v[124:127], v[96:99], v[164:167]
ds_read_b64_tr_b16 v[52:53], v14 offset:49152
v_mfma_f32_16x16x32_bf16 v[172:175], v[124:127], v[100:103], v[172:175]
ds_read_b64_tr_b16 v[54:55], v14 offset:53248
v_mfma_f32_16x16x32_bf16 v[168:171], v[120:123], v[100:103], v[168:171]
ds_read_b64_tr_b16 v[56:57], v15 offset:49152
v_mfma_f32_16x16x32_bf16 v[140:143], v[116:119], v[100:103], v[140:143]
ds_read_b64_tr_b16 v[58:59], v15 offset:53248
v_mfma_f32_16x16x32_bf16 v[136:139], v[112:115], v[100:103], v[136:139]
ds_read_b64_tr_b16 v[60:61], v16 offset:49152
v_mfma_f32_16x16x32_bf16 v[144:147], v[112:115], v[104:107], v[144:147]
ds_read_b64_tr_b16 v[62:63], v16 offset:53248
v_mfma_f32_16x16x32_bf16 v[148:151], v[116:119], v[104:107], v[148:151]
ds_read_b128 v[36:39], v7 offset:33792
v_mfma_f32_16x16x32_bf16 v[176:179], v[120:123], v[104:107], v[176:179]
ds_read_b128 v[40:43], v7 offset:34816
v_mfma_f32_16x16x32_bf16 v[180:183], v[124:127], v[104:107], v[180:183]
ds_read_b128 v[44:47], v7 offset:35840
v_mfma_f32_16x16x32_bf16 v[188:191], v[124:127], v[108:111], v[188:191]
ds_read_b128 v[64:67], v7 offset:40960
v_mfma_f32_16x16x32_bf16 v[184:187], v[120:123], v[108:111], v[184:187]
ds_read_b64_tr_b16 v[80:81], v13 offset:57344
v_mfma_f32_16x16x32_bf16 v[156:159], v[116:119], v[108:111], v[156:159]
ds_read_b64_tr_b16 v[82:83], v13 offset:61440
v_mfma_f32_16x16x32_bf16 v[152:155], v[112:115], v[108:111], v[152:155]
ds_read_b64_tr_b16 v[84:85], v14 offset:57344
v_mfma_f32_16x16x32_bf16 v[128:131], v[208:211], v[192:195], v[128:131]
ds_read_b64_tr_b16 v[86:87], v14 offset:61440
v_mfma_f32_16x16x32_bf16 v[132:135], v[212:215], v[192:195], v[132:135]
ds_read_b64_tr_b16 v[88:89], v15 offset:57344
v_mfma_f32_16x16x32_bf16 v[160:163], v[216:219], v[192:195], v[160:163]
ds_read_b64_tr_b16 v[90:91], v15 offset:61440
v_mfma_f32_16x16x32_bf16 v[164:167], v[220:223], v[192:195], v[164:167]
ds_read_b64_tr_b16 v[92:93], v16 offset:57344
v_mfma_f32_16x16x32_bf16 v[172:175], v[220:223], v[196:199], v[172:175]
ds_read_b64_tr_b16 v[94:95], v16 offset:61440
v_mfma_f32_16x16x32_bf16 v[168:171], v[216:219], v[196:199], v[168:171]
ds_read_b128 v[68:71], v7 offset:41984
v_mfma_f32_16x16x32_bf16 v[140:143], v[212:215], v[196:199], v[140:143]
ds_read_b128 v[72:75], v7 offset:43008
v_mfma_f32_16x16x32_bf16 v[136:139], v[208:211], v[196:199], v[136:139]
ds_read_b128 v[76:79], v7 offset:44032
v_mfma_f32_16x16x32_bf16 v[144:147], v[208:211], v[200:203], v[144:147]
v_mfma_f32_16x16x32_bf16 v[148:151], v[212:215], v[200:203], v[148:151]
v_mfma_f32_16x16x32_bf16 v[176:179], v[216:219], v[200:203], v[176:179]
v_mfma_f32_16x16x32_bf16 v[180:183], v[220:223], v[200:203], v[180:183]
v_mfma_f32_16x16x32_bf16 v[188:191], v[220:223], v[204:207], v[188:191]
v_mfma_f32_16x16x32_bf16 v[184:187], v[216:219], v[204:207], v[184:187]
v_mfma_f32_16x16x32_bf16 v[156:159], v[212:215], v[204:207], v[156:159]
v_mfma_f32_16x16x32_bf16 v[152:155], v[208:211], v[204:207], v[152:155]
s_waitcnt lgkmcnt(0)
s_barrier
v_mfma_f32_16x16x32_bf16 v[128:131], v[48:51], v[32:35], v[128:131]
ds_read_b128 v[96:99], v8 offset:0
v_mfma_f32_16x16x32_bf16 v[132:135], v[52:55], v[32:35], v[132:135]
ds_read_b64_tr_b16 v[112:113], v9 offset:0
v_mfma_f32_16x16x32_bf16 v[160:163], v[56:59], v[32:35], v[160:163]
ds_read_b64_tr_b16 v[114:115], v9 offset:4096
v_mfma_f32_16x16x32_bf16 v[164:167], v[60:63], v[32:35], v[164:167]
ds_read_b64_tr_b16 v[116:117], v10 offset:0
v_mfma_f32_16x16x32_bf16 v[172:175], v[60:63], v[36:39], v[172:175]
ds_read_b64_tr_b16 v[118:119], v10 offset:4096
v_mfma_f32_16x16x32_bf16 v[168:171], v[56:59], v[36:39], v[168:171]
ds_read_b64_tr_b16 v[120:121], v11 offset:0
v_mfma_f32_16x16x32_bf16 v[140:143], v[52:55], v[36:39], v[140:143]
ds_read_b64_tr_b16 v[122:123], v11 offset:4096
v_mfma_f32_16x16x32_bf16 v[136:139], v[48:51], v[36:39], v[136:139]
ds_read_b64_tr_b16 v[124:125], v12 offset:0
v_mfma_f32_16x16x32_bf16 v[144:147], v[48:51], v[40:43], v[144:147]
ds_read_b64_tr_b16 v[126:127], v12 offset:4096
v_mfma_f32_16x16x32_bf16 v[148:151], v[52:55], v[40:43], v[148:151]
ds_read_b128 v[100:103], v8 offset:1024
v_mfma_f32_16x16x32_bf16 v[176:179], v[56:59], v[40:43], v[176:179]
ds_read_b128 v[104:107], v8 offset:2048
v_mfma_f32_16x16x32_bf16 v[180:183], v[60:63], v[40:43], v[180:183]
ds_read_b128 v[108:111], v8 offset:3072
v_mfma_f32_16x16x32_bf16 v[188:191], v[60:63], v[44:47], v[188:191]
ds_read_b128 v[192:195], v8 offset:8192
v_mfma_f32_16x16x32_bf16 v[184:187], v[56:59], v[44:47], v[184:187]
ds_read_b64_tr_b16 v[208:209], v9 offset:8192
v_mfma_f32_16x16x32_bf16 v[156:159], v[52:55], v[44:47], v[156:159]
ds_read_b64_tr_b16 v[210:211], v9 offset:12288
v_mfma_f32_16x16x32_bf16 v[152:155], v[48:51], v[44:47], v[152:155]
ds_read_b64_tr_b16 v[212:213], v10 offset:8192
v_mfma_f32_16x16x32_bf16 v[128:131], v[80:83], v[64:67], v[128:131]
ds_read_b64_tr_b16 v[214:215], v10 offset:12288
v_mfma_f32_16x16x32_bf16 v[132:135], v[84:87], v[64:67], v[132:135]
ds_read_b64_tr_b16 v[216:217], v11 offset:8192
v_mfma_f32_16x16x32_bf16 v[160:163], v[88:91], v[64:67], v[160:163]
ds_read_b64_tr_b16 v[218:219], v11 offset:12288
v_mfma_f32_16x16x32_bf16 v[164:167], v[92:95], v[64:67], v[164:167]
ds_read_b64_tr_b16 v[220:221], v12 offset:8192
v_mfma_f32_16x16x32_bf16 v[172:175], v[92:95], v[68:71], v[172:175]
ds_read_b64_tr_b16 v[222:223], v12 offset:12288
v_mfma_f32_16x16x32_bf16 v[168:171], v[88:91], v[68:71], v[168:171]
ds_read_b128 v[196:199], v8 offset:9216
v_mfma_f32_16x16x32_bf16 v[140:143], v[84:87], v[68:71], v[140:143]
ds_read_b128 v[200:203], v8 offset:10240
v_mfma_f32_16x16x32_bf16 v[136:139], v[80:83], v[68:71], v[136:139]
ds_read_b128 v[204:207], v8 offset:11264
v_mfma_f32_16x16x32_bf16 v[144:147], v[80:83], v[72:75], v[144:147]
v_mfma_f32_16x16x32_bf16 v[148:151], v[84:87], v[72:75], v[148:151]
v_mfma_f32_16x16x32_bf16 v[176:179], v[88:91], v[72:75], v[176:179]
v_mfma_f32_16x16x32_bf16 v[180:183], v[92:95], v[72:75], v[180:183]
v_mfma_f32_16x16x32_bf16 v[188:191], v[92:95], v[76:79], v[188:191]
v_mfma_f32_16x16x32_bf16 v[184:187], v[88:91], v[76:79], v[184:187]
v_mfma_f32_16x16x32_bf16 v[156:159], v[84:87], v[76:79], v[156:159]
v_mfma_f32_16x16x32_bf16 v[152:155], v[80:83], v[76:79], v[152:155]
s_sub_u32 s41, s41, 1
s_cmp_lg_u32 s41, 0
s_cbranch_scc1 Lk4_143
s_waitcnt lgkmcnt(0)
s_barrier
v_mfma_f32_16x16x32_bf16 v[128:131], v[112:115], v[96:99], v[128:131]
ds_read_b128 v[32:35], v6 offset:16384
v_mfma_f32_16x16x32_bf16 v[132:135], v[116:119], v[96:99], v[132:135]
ds_read_b64_tr_b16 v[48:49], v224 offset:32768
v_mfma_f32_16x16x32_bf16 v[160:163], v[120:123], v[96:99], v[160:163]
ds_read_b64_tr_b16 v[50:51], v224 offset:34816
v_mfma_f32_16x16x32_bf16 v[164:167], v[124:127], v[96:99], v[164:167]
ds_read_b64_tr_b16 v[52:53], v225 offset:32768
v_mfma_f32_16x16x32_bf16 v[172:175], v[124:127], v[100:103], v[172:175]
ds_read_b64_tr_b16 v[54:55], v225 offset:34816
v_mfma_f32_16x16x32_bf16 v[168:171], v[120:123], v[100:103], v[168:171]
ds_read_b128 v[36:39], v6 offset:17408
v_mfma_f32_16x16x32_bf16 v[140:143], v[116:119], v[100:103], v[140:143]
ds_read_b128 v[40:43], v6 offset:18432
v_mfma_f32_16x16x32_bf16 v[136:139], v[112:115], v[100:103], v[136:139]
ds_read_b128 v[44:47], v6 offset:19456
v_mfma_f32_16x16x32_bf16 v[144:147], v[112:115], v[104:107], v[144:147]
ds_read_b128 v[64:67], v6 offset:24576
v_mfma_f32_16x16x32_bf16 v[148:151], v[116:119], v[104:107], v[148:151]
ds_read_b64_tr_b16 v[80:81], v224 offset:36864
v_mfma_f32_16x16x32_bf16 v[176:179], v[120:123], v[104:107], v[176:179]
ds_read_b64_tr_b16 v[82:83], v224 offset:38912
v_mfma_f32_16x16x32_bf16 v[180:183], v[124:127], v[104:107], v[180:183]
ds_read_b64_tr_b16 v[84:85], v225 offset:36864
v_mfma_f32_16x16x32_bf16 v[188:191], v[124:127], v[108:111], v[188:191]
ds_read_b64_tr_b16 v[86:87], v225 offset:38912
v_mfma_f32_16x16x32_bf16 v[184:187], v[120:123], v[108:111], v[184:187]
ds_read_b128 v[68:71], v6 offset:25600
v_mfma_f32_16x16x32_bf16 v[156:159], v[116:119], v[108:111], v[156:159]
ds_read_b128 v[72:75], v6 offset:26624
v_mfma_f32_16x16x32_bf16 v[152:155], v[112:115], v[108:111], v[152:155]
ds_read_b128 v[76:79], v6 offset:27648
v_mfma_f32_16x16x32_bf16 v[128:131], v[208:211], v[192:195], v[128:131]
v_mfma_f32_16x16x32_bf16 v[132:135], v[212:215], v[192:195], v[132:135]
v_mfma_f32_16x16x32_bf16 v[160:163], v[216:219], v[192:195], v[160:163]
v_mfma_f32_16x16x32_bf16 v[164:167], v[220:223], v[192:195], v[164:167]
v_mfma_f32_16x16x32_bf16 v[172:175], v[220:223], v[196:199], v[172:175]
v_mfma_f32_16x16x32_bf16 v[168:171], v[216:219], v[196:199], v[168:171]
v_mfma_f32_16x16x32_bf16 v[140:143], v[212:215], v[196:199], v[140:143]
v_mfma_f32_16x16x32_bf16 v[136:139], v[208:211], v[196:199], v[136:139]
v_mfma_f32_16x16x32_bf16 v[144:147], v[208:211], v[200:203], v[144:147]
v_mfma_f32_16x16x32_bf16 v[148:151], v[212:215], v[200:203], v[148:151]
v_mfma_f32_16x16x32_bf16 v[176:179], v[216:219], v[200:203], v[176:179]
v_mfma_f32_16x16x32_bf16 v[180:183], v[220:223], v[200:203], v[180:183]
v_mfma_f32_16x16x32_bf16 v[188:191], v[220:223], v[204:207], v[188:191]
v_mfma_f32_16x16x32_bf16 v[184:187], v[216:219], v[204:207], v[184:187]
v_mfma_f32_16x16x32_bf16 v[156:159], v[212:215], v[204:207], v[156:159]
v_mfma_f32_16x16x32_bf16 v[152:155], v[208:211], v[204:207], v[152:155]
s_waitcnt lgkmcnt(0)
s_barrier
v_mfma_f32_16x16x32_bf16 v[128:131], v[48:51], v[32:35], v[128:131]
ds_read_b128 v[96:99], v6 offset:49152
ds_read_b64_tr_b16 v[112:113], v226 offset:0
v_mfma_f32_16x16x32_bf16 v[132:135], v[52:55], v[32:35], v[132:135]
s_branch Lov_12
.p2align 12
Lst_12_0:
s_branch Lwr_179
Lst_12_1:
s_branch Lst_16_0
s_nop 0
Lov_12:
ds_read_b64_tr_b16 v[114:115], v226 offset:2048
ds_read_b64_tr_b16 v[116:117], v227 offset:0
v_mfma_f32_16x16x32_bf16 v[140:143], v[52:55], v[36:39], v[140:143]
ds_read_b64_tr_b16 v[118:119], v227 offset:2048
ds_read_b128 v[100:103], v6 offset:50176
v_mfma_f32_16x16x32_bf16 v[136:139], v[48:51], v[36:39], v[136:139]
ds_read_b128 v[104:107], v6 offset:51200
ds_read_b128 v[108:111], v6 offset:52224
v_mfma_f32_16x16x32_bf16 v[144:147], v[48:51], v[40:43], v[144:147]
ds_read_b128 v[192:195], v6 offset:57344
v_mfma_f32_16x16x32_bf16 v[148:151], v[52:55], v[40:43], v[148:151]
ds_read_b64_tr_b16 v[208:209], v226 offset:4096
v_mfma_f32_16x16x32_bf16 v[156:159], v[52:55], v[44:47], v[156:159]
ds_read_b64_tr_b16 v[210:211], v226 offset:6144
v_cvt_pk_bf16_f32 v160, v160, v161
v_cvt_pk_bf16_f32 v161, v162, v163
v_mfma_f32_16x16x32_bf16 v[152:155], v[48:51], v[44:47], v[152:155]
ds_read_b64_tr_b16 v[212:213], v227 offset:4096
v_cvt_pk_bf16_f32 v162, v164, v165
v_cvt_pk_bf16_f32 v163, v166, v167
v_mfma_f32_16x16x32_bf16 v[128:131], v[80:83], v[64:67], v[128:131]
ds_read_b64_tr_b16 v[214:215], v227 offset:6144
v_cvt_pk_bf16_f32 v164, v168, v169
v_cvt_pk_bf16_f32 v165, v170, v171
v_mfma_f32_16x16x32_bf16 v[132:135], v[84:87], v[64:67], v[132:135]
ds_read_b128 v[196:199], v6 offset:58368
v_cvt_pk_bf16_f32 v166, v172, v173
v_cvt_pk_bf16_f32 v167, v174, v175
v_mfma_f32_16x16x32_bf16 v[140:143], v[84:87], v[68:71], v[140:143]
ds_read_b128 v[200:203], v6 offset:59392
v_cvt_pk_bf16_f32 v168, v176, v177
v_cvt_pk_bf16_f32 v169, v178, v179
v_mfma_f32_16x16x32_bf16 v[136:139], v[80:83], v[68:71], v[136:139]
ds_read_b128 v[204:207], v6 offset:60416
v_cvt_pk_bf16_f32 v170, v180, v181
v_cvt_pk_bf16_f32 v171, v182, v183
v_mfma_f32_16x16x32_bf16 v[144:147], v[80:83], v[72:75], v[144:147]
v_cvt_pk_bf16_f32 v172, v184, v185
v_cvt_pk_bf16_f32 v173, v186, v187
v_mfma_f32_16x16x32_bf16 v[148:151], v[84:87], v[72:75], v[148:151]
v_cvt_pk_bf16_f32 v174, v188, v189
v_cvt_pk_bf16_f32 v175, v190, v191
v_mfma_f32_16x16x32_bf16 v[156:159], v[84:87], v[76:79], v[156:159]
v_mfma_f32_16x16x32_bf16 v[152:155], v[80:83], v[76:79], v[152:155]
buffer_store_dwordx4 v[160:163], v2, s[84:87], s45 offen offset:0 sc1
s_waitcnt lgkmcnt(0)
s_barrier
v_mfma_f32_16x16x32_bf16 v[128:131], v[112:115], v[96:99], v[128:131]
ds_read_b128 v[32:35], v7 offset:16384
ds_read_b64_tr_b16 v[48:49], v228 offset:16384
v_mfma_f32_16x16x32_bf16 v[132:135], v[116:119], v[96:99], v[132:135]
ds_read_b64_tr_b16 v[50:51], v228 offset:18432
ds_read_b64_tr_b16 v[52:53], v229 offset:16384
v_mfma_f32_16x16x32_bf16 v[140:143], v[116:119], v[100:103], v[140:143]
ds_read_b64_tr_b16 v[54:55], v229 offset:18432
ds_read_b128 v[36:39], v7 offset:17408
v_mfma_f32_16x16x32_bf16 v[136:139], v[112:115], v[100:103], v[136:139]
ds_read_b128 v[40:43], v7 offset:18432
ds_read_b128 v[44:47], v7 offset:19456
v_mfma_f32_16x16x32_bf16 v[144:147], v[112:115], v[104:107], v[144:147]
ds_read_b128 v[64:67], v7 offset:24576
v_mfma_f32_16x16x32_bf16 v[148:151], v[116:119], v[104:107], v[148:151]
ds_read_b64_tr_b16 v[80:81], v228 offset:20480
v_mfma_f32_16x16x32_bf16 v[156:159], v[116:119], v[108:111], v[156:159]
ds_read_b64_tr_b16 v[82:83], v228 offset:22528
v_mfma_f32_16x16x32_bf16 v[152:155], v[112:115], v[108:111], v[152:155]
ds_read_b64_tr_b16 v[84:85], v229 offset:20480
v_mfma_f32_16x16x32_bf16 v[128:131], v[208:211], v[192:195], v[128:131]
ds_read_b64_tr_b16 v[86:87], v229 offset:22528
buffer_store_dwordx4 v[164:167], v2, s[84:87], s45 offen offset:1024 sc1
v_mfma_f32_16x16x32_bf16 v[132:135], v[212:215], v[192:195], v[132:135]
ds_read_b128 v[68:71], v7 offset:25600
v_mfma_f32_16x16x32_bf16 v[140:143], v[212:215], v[196:199], v[140:143]
ds_read_b128 v[72:75], v7 offset:26624
v_mfma_f32_16x16x32_bf16 v[136:139], v[208:211], v[196:199], v[136:139]
ds_read_b128 v[76:79], v7 offset:27648
v_mfma_f32_16x16x32_bf16 v[144:147], v[208:211], v[200:203], v[144:147]
v_mfma_f32_16x16x32_bf16 v[148:151], v[212:215], v[200:203], v[148:151]
v_mfma_f32_16x16x32_bf16 v[156:159], v[212:215], v[204:207], v[156:159]
v_mfma_f32_16x16x32_bf16 v[152:155], v[208:211], v[204:207], v[152:155]
s_waitcnt lgkmcnt(0)
s_barrier
v_mfma_f32_16x16x32_bf16 v[128:131], v[48:51], v[32:35], v[128:131]
ds_read_b128 v[96:99], v7 offset:32768
ds_read_b64_tr_b16 v[112:113], v226 offset:49152
v_mfma_f32_16x16x32_bf16 v[132:135], v[52:55], v[32:35], v[132:135]
ds_read_b64_tr_b16 v[114:115], v226 offset:51200
ds_read_b64_tr_b16 v[116:117], v227 offset:49152
v_mfma_f32_16x16x32_bf16 v[140:143], v[52:55], v[36:39], v[140:143]
ds_read_b64_tr_b16 v[118:119], v227 offset:51200
ds_read_b128 v[100:103], v7 offset:33792
v_mfma_f32_16x16x32_bf16 v[136:139], v[48:51], v[36:39], v[136:139]
ds_read_b128 v[104:107], v7 offset:34816
ds_read_b128 v[108:111], v7 offset:35840
v_mfma_f32_16x16x32_bf16 v[144:147], v[48:51], v[40:43], v[144:147]
ds_read_b128 v[192:195], v7 offset:40960
v_mfma_f32_16x16x32_bf16 v[148:151], v[52:55], v[40:43], v[148:151]
ds_read_b64_tr_b16 v[208:209], v226 offset:53248
v_mfma_f32_16x16x32_bf16 v[156:159], v[52:55], v[44:47], v[156:159]
ds_read_b64_tr_b16 v[210:211], v226 offset:55296
v_mfma_f32_16x16x32_bf16 v[152:155], v[48:51], v[44:47], v[152:155]
ds_read_b64_tr_b16 v[212:213], v227 offset:53248
v_mfma_f32_16x16x32_bf16 v[128:131], v[80:83], v[64:67], v[128:131]
ds_read_b64_tr_b16 v[214:215], v227 offset:55296
buffer_store_dwordx4 v[168:171], v2, s[84:87], s45 offen offset:2048 sc1
v_mfma_f32_16x16x32_bf16 v[132:135], v[84:87], v[64:67], v[132:135]
ds_read_b128 v[196:199], v7 offset:41984
v_mfma_f32_16x16x32_bf16 v[140:143], v[84:87], v[68:71], v[140:143]
ds_read_b128 v[200:203], v7 offset:43008
v_mfma_f32_16x16x32_bf16 v[136:139], v[80:83], v[68:71], v[136:139]
ds_read_b128 v[204:207], v7 offset:44032
v_mfma_f32_16x16x32_bf16 v[144:147], v[80:83], v[72:75], v[144:147]
v_mfma_f32_16x16x32_bf16 v[148:151], v[84:87], v[72:75], v[148:151]
v_mfma_f32_16x16x32_bf16 v[156:159], v[84:87], v[76:79], v[156:159]
v_mfma_f32_16x16x32_bf16 v[152:155], v[80:83], v[76:79], v[152:155]
s_waitcnt lgkmcnt(0)
s_barrier
v_mfma_f32_16x16x32_bf16 v[128:131], v[112:115], v[96:99], v[128:131]
ds_read_b128 v[32:35], v8 offset:0
ds_read_b64_tr_b16 v[48:49], v224 offset:0
v_mfma_f32_16x16x32_bf16 v[132:135], v[116:119], v[96:99], v[132:135]
ds_read_b64_tr_b16 v[50:51], v224 offset:2048
ds_read_b64_tr_b16 v[52:53], v225 offset:0
v_mfma_f32_16x16x32_bf16 v[140:143], v[116:119], v[100:103], v[140:143]
ds_read_b64_tr_b16 v[54:55], v225 offset:2048
ds_read_b128 v[36:39], v8 offset:1024
v_mfma_f32_16x16x32_bf16 v[136:139], v[112:115], v[100:103], v[136:139]
ds_read_b128 v[40:43], v8 offset:2048
ds_read_b128 v[44:47], v8 offset:3072
v_mfma_f32_16x16x32_bf16 v[144:147], v[112:115], v[104:107], v[144:147]
ds_read_b128 v[64:67], v8 offset:8192
v_mfma_f32_16x16x32_bf16 v[148:151], v[116:119], v[104:107], v[148:151]
ds_read_b64_tr_b16 v[80:81], v224 offset:4096
v_mfma_f32_16x16x32_bf16 v[156:159], v[116:119], v[108:111], v[156:159]
ds_read_b64_tr_b16 v[82:83], v224 offset:6144
v_mfma_f32_16x16x32_bf16 v[152:155], v[112:115], v[108:111], v[152:155]
ds_read_b64_tr_b16 v[84:85], v225 offset:4096
v_mfma_f32_16x16x32_bf16 v[128:131], v[208:211], v[192:195], v[128:131]
ds_read_b64_tr_b16 v[86:87], v225 offset:6144
buffer_store_dwordx4 v[172:175], v2, s[84:87], s45 offen offset:3072 sc1
v_mfma_f32_16x16x32_bf16 v[132:135], v[212:215], v[192:195], v[132:135]
ds_read_b128 v[68:71], v8 offset:9216
v_mfma_f32_16x16x32_bf16 v[140:143], v[212:215], v[196:199], v[140:143]
ds_read_b128 v[72:75], v8 offset:10240
v_mfma_f32_16x16x32_bf16 v[136:139], v[208:211], v[196:199], v[136:139]
ds_read_b128 v[76:79], v8 offset:11264
v_mfma_f32_16x16x32_bf16 v[144:147], v[208:211], v[200:203], v[144:147]
v_mfma_f32_16x16x32_bf16 v[148:151], v[212:215], v[200:203], v[148:151]
v_mfma_f32_16x16x32_bf16 v[156:159], v[212:215], v[204:207], v[156:159]
v_mfma_f32_16x16x32_bf16 v[152:155], v[208:211], v[204:207], v[152:155]
s_waitcnt lgkmcnt(0)
s_barrier
v_mfma_f32_16x16x32_bf16 v[128:131], v[48:51], v[32:35], v[128:131]
ds_read_b128 v[96:99], v6 offset:16384
ds_read_b64_tr_b16 v[112:113], v224 offset:32768
v_mfma_f32_16x16x32_bf16 v[132:135], v[52:55], v[32:35], v[132:135]
ds_read_b64_tr_b16 v[114:115], v224 offset:34816
ds_read_b64_tr_b16 v[116:117], v225 offset:32768
v_mfma_f32_16x16x32_bf16 v[140:143], v[52:55], v[36:39], v[140:143]
ds_read_b64_tr_b16 v[118:119], v225 offset:34816
ds_read_b128 v[100:103], v6 offset:17408
v_mfma_f32_16x16x32_bf16 v[136:139], v[48:51], v[36:39], v[136:139]
ds_read_b128 v[104:107], v6 offset:18432
ds_read_b128 v[108:111], v6 offset:19456
v_mfma_f32_16x16x32_bf16 v[144:147], v[48:51], v[40:43], v[144:147]
ds_read_b128 v[192:195], v6 offset:24576
v_mfma_f32_16x16x32_bf16 v[148:151], v[52:55], v[40:43], v[148:151]
ds_read_b64_tr_b16 v[208:209], v224 offset:36864
v_mfma_f32_16x16x32_bf16 v[156:159], v[52:55], v[44:47], v[156:159]
ds_read_b64_tr_b16 v[210:211], v224 offset:38912
v_mfma_f32_16x16x32_bf16 v[152:155], v[48:51], v[44:47], v[152:155]
ds_read_b64_tr_b16 v[212:213], v225 offset:36864
v_mfma_f32_16x16x32_bf16 v[128:131], v[80:83], v[64:67], v[128:131]
ds_read_b64_tr_b16 v[214:215], v225 offset:38912
v_mfma_f32_16x16x32_bf16 v[132:135], v[84:87], v[64:67], v[132:135]
ds_read_b128 v[196:199], v6 offset:25600
v_mfma_f32_16x16x32_bf16 v[140:143], v[84:87], v[68:71], v[140:143]
ds_read_b128 v[200:203], v6 offset:26624
v_mfma_f32_16x16x32_bf16 v[136:139], v[80:83], v[68:71], v[136:139]
ds_read_b128 v[204:207], v6 offset:27648
v_mfma_f32_16x16x32_bf16 v[144:147], v[80:83], v[72:75], v[144:147]
v_mfma_f32_16x16x32_bf16 v[148:151], v[84:87], v[72:75], v[148:151]
v_mfma_f32_16x16x32_bf16 v[156:159], v[84:87], v[76:79], v[156:159]
v_mfma_f32_16x16x32_bf16 v[152:155], v[80:83], v[76:79], v[152:155]
s_waitcnt vmcnt(0)
s_waitcnt lgkmcnt(0)
s_barrier
v_mfma_f32_16x16x32_bf16 v[128:131], v[112:115], v[96:99], v[128:131]
ds_read_b128 v[32:35], v6 offset:49152
ds_read_b64_tr_b16 v[48:49], v226 offset:0
v_mfma_f32_16x16x32_bf16 v[132:135], v[116:119], v[96:99], v[132:135]
ds_read_b64_tr_b16 v[50:51], v226 offset:2048
ds_read_b64_tr_b16 v[52:53], v227 offset:0
v_mfma_f32_16x16x32_bf16 v[140:143], v[116:119], v[100:103], v[140:143]
ds_read_b64_tr_b16 v[54:55], v227 offset:2048
ds_read_b128 v[36:39], v6 offset:50176
v_mfma_f32_16x16x32_bf16 v[136:139], v[112:115], v[100:103], v[136:139]
ds_read_b128 v[40:43], v6 offset:51200
ds_read_b128 v[44:47], v6 offset:52224
v_mfma_f32_16x16x32_bf16 v[144:147], v[112:115], v[104:107], v[144:147]
ds_read_b128 v[64:67], v6 offset:57344
v_mfma_f32_16x16x32_bf16 v[148:151], v[116:119], v[104:107], v[148:151]
ds_read_b64_tr_b16 v[80:81], v226 offset:4096
v_mfma_f32_16x16x32_bf16 v[156:159], v[116:119], v[108:111], v[156:159]
ds_read_b64_tr_b16 v[82:83], v226 offset:6144
v_mfma_f32_16x16x32_bf16 v[152:155], v[112:115], v[108:111], v[152:155]
ds_read_b64_tr_b16 v[84:85], v227 offset:4096
v_mfma_f32_16x16x32_bf16 v[128:131], v[208:211], v[192:195], v[128:131]
ds_read_b64_tr_b16 v[86:87], v227 offset:6144
v_mfma_f32_16x16x32_bf16 v[132:135], v[212:215], v[192:195], v[132:135]
ds_read_b128 v[68:71], v6 offset:58368
v_mfma_f32_16x16x32_bf16 v[140:143], v[212:215], v[196:199], v[140:143]
ds_read_b128 v[72:75], v6 offset:59392
v_mfma_f32_16x16x32_bf16 v[136:139], v[208:211], v[196:199], v[136:139]
ds_read_b128 v[76:79], v6 offset:60416
v_mfma_f32_16x16x32_bf16 v[144:147], v[208:211], v[200:203], v[144:147]
v_mfma_f32_16x16x32_bf16 v[148:151], v[212:215], v[200:203], v[148:151]
v_mfma_f32_16x16x32_bf16 v[156:159], v[212:215], v[204:207], v[156:159]
v_mfma_f32_16x16x32_bf16 v[152:155], v[208:211], v[204:207], v[152:155]
s_waitcnt lgkmcnt(0)
s_barrier
v_mfma_f32_16x16x32_bf16 v[128:131], v[48:51], v[32:35], v[128:131]
ds_read_b128 v[96:99], v7 offset:16384
ds_read_b64_tr_b16 v[112:113], v228 offset:16384
v_mfma_f32_16x16x32_bf16 v[132:135], v[52:55], v[32:35], v[132:135]
ds_read_b64_tr_b16 v[114:115], v228 offset:18432
ds_read_b64_tr_b16 v[116:117], v229 offset:16384
v_mfma_f32_16x16x32_bf16 v[140:143], v[52:55], v[36:39], v[140:143]
ds_read_b64_tr_b16 v[118:119], v229 offset:18432
ds_read_b128 v[100:103], v7 offset:17408
v_mfma_f32_16x16x32_bf16 v[136:139], v[48:51], v[36:39], v[136:139]
ds_read_b128 v[104:107], v7 offset:18432
ds_read_b128 v[108:111], v7 offset:19456
v_mfma_f32_16x16x32_bf16 v[144:147], v[48:51], v[40:43], v[144:147]
ds_read_b128 v[192:195], v7 offset:24576
v_mfma_f32_16x16x32_bf16 v[148:151], v[52:55], v[40:43], v[148:151]
ds_read_b64_tr_b16 v[208:209], v228 offset:20480
v_mfma_f32_16x16x32_bf16 v[156:159], v[52:55], v[44:47], v[156:159]
ds_read_b64_tr_b16 v[210:211], v228 offset:22528
v_mfma_f32_16x16x32_bf16 v[152:155], v[48:51], v[44:47], v[152:155]
ds_read_b64_tr_b16 v[212:213], v229 offset:20480
v_mfma_f32_16x16x32_bf16 v[128:131], v[80:83], v[64:67], v[128:131]
ds_read_b64_tr_b16 v[214:215], v229 offset:22528
v_mfma_f32_16x16x32_bf16 v[132:135], v[84:87], v[64:67], v[132:135]
ds_read_b128 v[196:199], v7 offset:25600
v_mfma_f32_16x16x32_bf16 v[140:143], v[84:87], v[68:71], v[140:143]
ds_read_b128 v[200:203], v7 offset:26624
v_mfma_f32_16x16x32_bf16 v[136:139], v[80:83], v[68:71], v[136:139]
ds_read_b128 v[204:207], v7 offset:27648
v_mfma_f32_16x16x32_bf16 v[144:147], v[80:83], v[72:75], v[144:147]
v_mfma_f32_16x16x32_bf16 v[148:151], v[84:87], v[72:75], v[148:151]
v_mfma_f32_16x16x32_bf16 v[156:159], v[84:87], v[76:79], v[156:159]
v_mfma_f32_16x16x32_bf16 v[152:155], v[80:83], v[76:79], v[152:155]
s_waitcnt lgkmcnt(0)
s_barrier
v_mfma_f32_16x16x32_bf16 v[128:131], v[112:115], v[96:99], v[128:131]
ds_read_b128 v[32:35], v7 offset:32768
ds_read_b64_tr_b16 v[48:49], v226 offset:49152
v_mfma_f32_16x16x32_bf16 v[132:135], v[116:119], v[96:99], v[132:135]
ds_read_b64_tr_b16 v[50:51], v226 offset:51200
ds_read_b64_tr_b16 v[52:53], v227 offset:49152
v_mfma_f32_16x16x32_bf16 v[140:143], v[116:119], v[100:103], v[140:143]
ds_read_b64_tr_b16 v[54:55], v227 offset:51200
ds_read_b128 v[36:39], v7 offset:33792
v_mfma_f32_16x16x32_bf16 v[136:139], v[112:115], v[100:103], v[136:139]
ds_read_b128 v[40:43], v7 offset:34816
ds_read_b128 v[44:47], v7 offset:35840
v_mfma_f32_16x16x32_bf16 v[144:147], v[112:115], v[104:107], v[144:147]
ds_read_b128 v[64:67], v7 offset:40960
v_mfma_f32_16x16x32_bf16 v[148:151], v[116:119], v[104:107], v[148:151]
ds_read_b64_tr_b16 v[80:81], v226 offset:53248
v_mfma_f32_16x16x32_bf16 v[156:159], v[116:119], v[108:111], v[156:159]
ds_read_b64_tr_b16 v[82:83], v226 offset:55296
v_mfma_f32_16x16x32_bf16 v[152:155], v[112:115], v[108:111], v[152:155]
ds_read_b64_tr_b16 v[84:85], v227 offset:53248
v_mfma_f32_16x16x32_bf16 v[128:131], v[208:211], v[192:195], v[128:131]
ds_read_b64_tr_b16 v[86:87], v227 offset:55296
v_mfma_f32_16x16x32_bf16 v[132:135], v[212:215], v[192:195], v[132:135]
ds_read_b128 v[68:71], v7 offset:41984
v_mfma_f32_16x16x32_bf16 v[140:143], v[212:215], v[196:199], v[140:143]
ds_read_b128 v[72:75], v7 offset:43008
v_mfma_f32_16x16x32_bf16 v[136:139], v[208:211], v[196:199], v[136:139]
ds_read_b128 v[76:79], v7 offset:44032
v_mfma_f32_16x16x32_bf16 v[144:147], v[208:211], v[200:203], v[144:147]
v_mfma_f32_16x16x32_bf16 v[148:151], v[212:215], v[200:203], v[148:151]
v_mfma_f32_16x16x32_bf16 v[156:159], v[212:215], v[204:207], v[156:159]
v_mfma_f32_16x16x32_bf16 v[152:155], v[208:211], v[204:207], v[152:155]
s_waitcnt lgkmcnt(0)
s_barrier
buffer_load_dwordx4 v[232:235], v2, s[84:87], s46 offen offset:0 sc1
buffer_load_dwordx4 v[236:239], v2, s[84:87], s46 offen offset:1024 sc1
buffer_load_dwordx4 v[240:243], v2, s[84:87], s46 offen offset:2048 sc1
buffer_load_dwordx4 v[244:247], v2, s[84:87], s46 offen offset:3072 sc1
v_mfma_f32_16x16x32_bf16 v[128:131], v[48:51], v[32:35], v[128:131]
ds_read_b128 v[96:99], v8 offset:0
ds_read_b64_tr_b16 v[112:113], v224 offset:0
v_mfma_f32_16x16x32_bf16 v[132:135], v[52:55], v[32:35], v[132:135]
ds_read_b64_tr_b16 v[114:115], v224 offset:2048
ds_read_b64_tr_b16 v[116:117], v225 offset:0
v_mfma_f32_16x16x32_bf16 v[140:143], v[52:55], v[36:39], v[140:143]
ds_read_b64_tr_b16 v[118:119], v225 offset:2048
ds_read_b128 v[100:103], v8 offset:1024
v_mfma_f32_16x16x32_bf16 v[136:139], v[48:51], v[36:39], v[136:139]
ds_read_b128 v[104:107], v8 offset:2048
ds_read_b128 v[108:111], v8 offset:3072
v_mfma_f32_16x16x32_bf16 v[144:147], v[48:51], v[40:43], v[144:147]
ds_read_b128 v[192:195], v8 offset:8192
v_mfma_f32_16x16x32_bf16 v[148:151], v[52:55], v[40:43], v[148:151]
ds_read_b64_tr_b16 v[208:209], v224 offset:4096
v_mfma_f32_16x16x32_bf16 v[156:159], v[52:55], v[44:47], v[156:159]
ds_read_b64_tr_b16 v[210:211], v224 offset:6144
v_mfma_f32_16x16x32_bf16 v[152:155], v[48:51], v[44:47], v[152:155]
ds_read_b64_tr_b16 v[212:213], v225 offset:4096
v_mfma_f32_16x16x32_bf16 v[128:131], v[80:83], v[64:67], v[128:131]
ds_read_b64_tr_b16 v[214:215], v225 offset:6144
v_mfma_f32_16x16x32_bf16 v[132:135], v[84:87], v[64:67], v[132:135]
ds_read_b128 v[196:199], v8 offset:9216
v_mfma_f32_16x16x32_bf16 v[140:143], v[84:87], v[68:71], v[140:143]
ds_read_b128 v[200:203], v8 offset:10240
v_mfma_f32_16x16x32_bf16 v[136:139], v[80:83], v[68:71], v[136:139]
ds_read_b128 v[204:207], v8 offset:11264
v_mfma_f32_16x16x32_bf16 v[144:147], v[80:83], v[72:75], v[144:147]
v_mfma_f32_16x16x32_bf16 v[148:151], v[84:87], v[72:75], v[148:151]
v_mfma_f32_16x16x32_bf16 v[156:159], v[84:87], v[76:79], v[156:159]
v_mfma_f32_16x16x32_bf16 v[152:155], v[80:83], v[76:79], v[152:155]
s_waitcnt lgkmcnt(0)
s_barrier
v_mfma_f32_16x16x32_bf16 v[128:131], v[112:115], v[96:99], v[128:131]
ds_read_b128 v[32:35], v6 offset:16384
ds_read_b64_tr_b16 v[48:49], v224 offset:32768
v_mfma_f32_16x16x32_bf16 v[132:135], v[116:119], v[96:99], v[132:135]
ds_read_b64_tr_b16 v[50:51], v224 offset:34816
ds_read_b64_tr_b16 v[52:53], v225 offset:32768
v_mfma_f32_16x16x32_bf16 v[140:143], v[116:119], v[100:103], v[140:143]
ds_read_b64_tr_b16 v[54:55], v225 offset:34816
ds_read_b128 v[36:39], v6 offset:17408
v_mfma_f32_16x16x32_bf16 v[136:139], v[112:115], v[100:103], v[136:139]
ds_read_b128 v[40:43], v6 offset:18432
ds_read_b128 v[44:47], v6 offset:19456
v_mfma_f32_16x16x32_bf16 v[144:147], v[112:115], v[104:107], v[144:147]
ds_read_b128 v[64:67], v6 offset:24576
v_mfma_f32_16x16x32_bf16 v[148:151], v[116:119], v[104:107], v[148:151]
ds_read_b64_tr_b16 v[80:81], v224 offset:36864
v_mfma_f32_16x16x32_bf16 v[156:159], v[116:119], v[108:111], v[156:159]
ds_read_b64_tr_b16 v[82:83], v224 offset:38912
v_mfma_f32_16x16x32_bf16 v[152:155], v[112:115], v[108:111], v[152:155]
ds_read_b64_tr_b16 v[84:85], v225 offset:36864
v_mfma_f32_16x16x32_bf16 v[128:131], v[208:211], v[192:195], v[128:131]
ds_read_b64_tr_b16 v[86:87], v225 offset:38912
v_mfma_f32_16x16x32_bf16 v[132:135], v[212:215], v[192:195], v[132:135]
ds_read_b128 v[68:71], v6 offset:25600
v_mfma_f32_16x16x32_bf16 v[140:143], v[212:215], v[196:199], v[140:143]
ds_read_b128 v[72:75], v6 offset:26624
v_mfma_f32_16x16x32_bf16 v[136:139], v[208:211], v[196:199], v[136:139]
ds_read_b128 v[76:79], v6 offset:27648
v_mfma_f32_16x16x32_bf16 v[144:147], v[208:211], v[200:203], v[144:147]
v_mfma_f32_16x16x32_bf16 v[148:151], v[212:215], v[200:203], v[148:151]
v_mfma_f32_16x16x32_bf16 v[156:159], v[212:215], v[204:207], v[156:159]
v_mfma_f32_16x16x32_bf16 v[152:155], v[208:211], v[204:207], v[152:155]
s_waitcnt lgkmcnt(0)
s_barrier
v_mfma_f32_16x16x32_bf16 v[128:131], v[48:51], v[32:35], v[128:131]
ds_read_b128 v[96:99], v6 offset:49152
ds_read_b64_tr_b16 v[112:113], v226 offset:0
v_mfma_f32_16x16x32_bf16 v[132:135], v[52:55], v[32:35], v[132:135]
ds_read_b64_tr_b16 v[114:115], v226 offset:2048
ds_read_b64_tr_b16 v[116:117], v227 offset:0
v_mfma_f32_16x16x32_bf16 v[140:143], v[52:55], v[36:39], v[140:143]
ds_read_b64_tr_b16 v[118:119], v227 offset:2048
ds_read_b128 v[100:103], v6 offset:50176
v_mfma_f32_16x16x32_bf16 v[136:139], v[48:51], v[36:39], v[136:139]
ds_read_b128 v[104:107], v6 offset:51200
ds_read_b128 v[108:111], v6 offset:52224
v_mfma_f32_16x16x32_bf16 v[144:147], v[48:51], v[40:43], v[144:147]
ds_read_b128 v[192:195], v6 offset:57344
v_mfma_f32_16x16x32_bf16 v[148:151], v[52:55], v[40:43], v[148:151]
ds_read_b64_tr_b16 v[208:209], v226 offset:4096
v_mfma_f32_16x16x32_bf16 v[156:159], v[52:55], v[44:47], v[156:159]
ds_read_b64_tr_b16 v[210:211], v226 offset:6144
v_mfma_f32_16x16x32_bf16 v[152:155], v[48:51], v[44:47], v[152:155]
ds_read_b64_tr_b16 v[212:213], v227 offset:4096
v_mfma_f32_16x16x32_bf16 v[128:131], v[80:83], v[64:67], v[128:131]
ds_read_b64_tr_b16 v[214:215], v227 offset:6144
v_mfma_f32_16x16x32_bf16 v[132:135], v[84:87], v[64:67], v[132:135]
ds_read_b128 v[196:199], v6 offset:58368
v_mfma_f32_16x16x32_bf16 v[140:143], v[84:87], v[68:71], v[140:143]
ds_read_b128 v[200:203], v6 offset:59392
v_mfma_f32_16x16x32_bf16 v[136:139], v[80:83], v[68:71], v[136:139]
ds_read_b128 v[204:207], v6 offset:60416
v_mfma_f32_16x16x32_bf16 v[144:147], v[80:83], v[72:75], v[144:147]
v_mfma_f32_16x16x32_bf16 v[148:151], v[84:87], v[72:75], v[148:151]
v_mfma_f32_16x16x32_bf16 v[156:159], v[84:87], v[76:79], v[156:159]
v_mfma_f32_16x16x32_bf16 v[152:155], v[80:83], v[76:79], v[152:155]
s_waitcnt vmcnt(0)
s_waitcnt lgkmcnt(0)
s_barrier
v_mfma_f32_16x16x32_bf16 v[128:131], v[112:115], v[96:99], v[128:131]
v_lshlrev_b32 v160, 16, v232
v_and_b32 v161, 0xffff0000, v232
v_mfma_f32_16x16x32_bf16 v[132:135], v[116:119], v[96:99], v[132:135]
v_lshlrev_b32 v162, 16, v233
v_and_b32 v163, 0xffff0000, v233
v_mfma_f32_16x16x32_bf16 v[140:143], v[116:119], v[100:103], v[140:143]
v_lshlrev_b32 v164, 16, v234
v_and_b32 v165, 0xffff0000, v234
v_mfma_f32_16x16x32_bf16 v[136:139], v[112:115], v[100:103], v[136:139]
v_lshlrev_b32 v166, 16, v235
v_and_b32 v167, 0xffff0000, v235
v_mfma_f32_16x16x32_bf16 v[144:147], v[112:115], v[104:107], v[144:147]
v_lshlrev_b32 v168, 16, v236
v_and_b32 v169, 0xffff0000, v236
v_mfma_f32_16x16x32_bf16 v[148:151], v[116:119], v[104:107], v[148:151]
v_lshlrev_b32 v170, 16, v237
v_and_b32 v171, 0xffff0000, v237
v_mfma_f32_16x16x32_bf16 v[156:159], v[116:119], v[108:111], v[156:159]
v_lshlrev_b32 v172, 16, v238
v_and_b32 v173, 0xffff0000, v238
v_mfma_f32_16x16x32_bf16 v[152:155], v[112:115], v[108:111], v[152:155]
v_lshlrev_b32 v174, 16, v239
v_and_b32 v175, 0xffff0000, v239
v_mfma_f32_16x16x32_bf16 v[128:131], v[208:211], v[192:195], v[128:131]
v_lshlrev_b32 v176, 16, v240
v_and_b32 v177, 0xffff0000, v240
v_mfma_f32_16x16x32_bf16 v[132:135], v[212:215], v[192:195], v[132:135]
v_lshlrev_b32 v178, 16, v241
v_and_b32 v179, 0xffff0000, v241
v_mfma_f32_16x16x32_bf16 v[140:143], v[212:215], v[196:199], v[140:143]
v_lshlrev_b32 v180, 16, v242
v_and_b32 v181, 0xffff0000, v242
v_mfma_f32_16x16x32_bf16 v[136:139], v[208:211], v[196:199], v[136:139]
v_lshlrev_b32 v182, 16, v243
v_and_b32 v183, 0xffff0000, v243
v_mfma_f32_16x16x32_bf16 v[144:147], v[208:211], v[200:203], v[144:147]
v_lshlrev_b32 v184, 16, v244
v_and_b32 v185, 0xffff0000, v244
v_mfma_f32_16x16x32_bf16 v[148:151], v[212:215], v[200:203], v[148:151]
v_lshlrev_b32 v186, 16, v245
v_and_b32 v187, 0xffff0000, v245
v_mfma_f32_16x16x32_bf16 v[156:159], v[212:215], v[204:207], v[156:159]
v_lshlrev_b32 v188, 16, v246
v_and_b32 v189, 0xffff0000, v246
v_mfma_f32_16x16x32_bf16 v[152:155], v[208:211], v[204:207], v[152:155]
v_lshlrev_b32 v190, 16, v247
v_and_b32 v191, 0xffff0000, v247
s_nop 1
v_pk_add_f32 v[128:129], v[128:129], v[160:161]
v_pk_add_f32 v[130:131], v[130:131], v[162:163]
v_pk_add_f32 v[132:133], v[132:133], v[164:165]
v_pk_add_f32 v[134:135], v[134:135], v[166:167]
v_cvt_pk_bf16_f32 v32, v128, v129
v_cvt_pk_bf16_f32 v33, v130, v131
v_cvt_pk_bf16_f32 v34, v132, v133
v_cvt_pk_bf16_f32 v35, v134, v135
v_pk_add_f32 v[136:137], v[136:137], v[168:169]
v_pk_add_f32 v[138:139], v[138:139], v[170:171]
v_pk_add_f32 v[140:141], v[140:141], v[172:173]
v_pk_add_f32 v[142:143], v[142:143], v[174:175]
v_cvt_pk_bf16_f32 v36, v136, v137
v_cvt_pk_bf16_f32 v37, v138, v139
v_cvt_pk_bf16_f32 v38, v140, v141
v_cvt_pk_bf16_f32 v39, v142, v143
v_permlane16_swap_b32 v32, v34
v_permlane16_swap_b32 v33, v35
buffer_store_dwordx4 v[32:35], v230, s[20:23], s54 offen offset:0 nt
v_pk_add_f32 v[144:145], v[144:145], v[176:177]
v_pk_add_f32 v[146:147], v[146:147], v[178:179]
v_pk_add_f32 v[148:149], v[148:149], v[180:181]
v_pk_add_f32 v[150:151], v[150:151], v[182:183]
v_cvt_pk_bf16_f32 v40, v144, v145
v_cvt_pk_bf16_f32 v41, v146, v147
v_cvt_pk_bf16_f32 v42, v148, v149
v_cvt_pk_bf16_f32 v43, v150, v151
v_permlane16_swap_b32 v36, v38
v_permlane16_swap_b32 v37, v39
buffer_store_dwordx4 v[36:39], v230, s[20:23], s54 offen offset:2048 nt
v_pk_add_f32 v[152:153], v[152:153], v[184:185]
v_pk_add_f32 v[154:155], v[154:155], v[186:187]
v_pk_add_f32 v[156:157], v[156:157], v[188:189]
v_pk_add_f32 v[158:159], v[158:159], v[190:191]
v_cvt_pk_bf16_f32 v44, v152, v153
v_cvt_pk_bf16_f32 v45, v154, v155
v_cvt_pk_bf16_f32 v46, v156, v157
v_cvt_pk_bf16_f32 v47, v158, v159
v_permlane16_swap_b32 v40, v42
v_permlane16_swap_b32 v41, v43
buffer_store_dwordx4 v[40:43], v230, s[20:23], s55 offen offset:0 nt
s_nop 1
v_permlane16_swap_b32 v44, v46
v_permlane16_swap_b32 v45, v47
buffer_store_dwordx4 v[44:47], v230, s[20:23], s55 offen offset:2048 nt
s_branch Ldone_1
Lgb_118:
s_mul_i32 s43, s34, 262144
s_add_u32 s8, s82, s43
s_addc_u32 s9, s83, 0
s_add_u32 s8, s8, 4194304
s_addc_u32 s9, s9, 0
s_mov_b32 s10, 262144
s_mov_b32 s11, 0x20000
s_lshl_b32 s39, s36, 12
v_lshlrev_b32 v2, 4, v1
v_add_u32 v3, s39, v2
s_add_u32 s37, s35, 0
s_and_b32 s37, s37, 15
s_mul_i32 s37, s37, 16384
s_add_u32 m0, s39, 0
s_nop 0
buffer_load_dwordx4 v3, s[8:11], s37 offen sc1 lds
buffer_load_dwordx4 v3, s[8:11], s37 offen offset:1024 sc1 lds
buffer_load_dwordx4 v3, s[8:11], s37 offen offset:2048 sc1 lds
buffer_load_dwordx4 v3, s[8:11], s37 offen offset:3072 sc1 lds
s_mul_i32 s43, s34, 262144
s_add_u32 s8, s82, s43
s_addc_u32 s9, s83, 0
s_add_u32 s8, s8, 4194304
s_addc_u32 s9, s9, 0
s_mov_b32 s10, 262144
s_mov_b32 s11, 0x20000
s_mul_i32 s43, s34, 917504
s_add_u32 s24, s82, s43
s_addc_u32 s25, s83, 0
s_add_u32 s24, s24, 8388608
s_addc_u32 s25, s25, 0
s_mov_b32 s26, 917504
s_mov_b32 s27, 0x20000
s_add_u32 s84, s82, 27262976
s_addc_u32 s85, s83, 0
s_mov_b32 s86, 229376
s_mov_b32 s87, 0x20000
s_and_b32 s47, s36, 3
s_lshr_b32 s62, s47, 1
s_and_b32 s63, s47, 1
v_lshlrev_b32 v2, 4, v1
s_lshl_b32 s39, s47, 12
v_add_u32 v3, s39, v2
s_cmp_eq_u32 s62, 0
s_cselect_b32 s44, s72, s74
s_cselect_b32 s45, s73, s75
s_lshl_b32 s43, s35, 8
s_add_u32 s12, s44, s43
s_addc_u32 s13, s45, 0
s_mov_b32 s14, 7333120
s_mov_b32 s15, 0x20000
v_lshrrev_b32 v28, 4, v1
v_lshlrev_b32 v29, 1, v28
v_and_b32 v4, 15, v1
v_xor_b32 v4, v4, v29
v_lshlrev_b32 v4, 4, v4
v_mul_u32_u24 v28, 7168, v28
v_add_u32 v4, v4, v28
s_mul_i32 s43, s63, 229376
v_add_u32 v4, s43, v4
v_xor_b32 v5, 128, v4
v_add_u32 v5, 28672, v5
s_lshl_b32 s40, s47, 13
s_branch Lov_13
.p2align 12
Lst_13_0:
s_branch Lwr_180
Lst_13_1:
s_branch Lst_17_0
s_nop 0
Lov_13:
s_add_u32 s40, s40, 16384
s_lshl_b32 s43, s62, 12
v_add_u32 v9, s43, v2
v_add_u32 v10, 98304, v9
v_mov_b32 v6, v192
v_mov_b32 v7, v193
v_mov_b32 v8, v194
v_mov_b32 v24, v195
s_mul_i32 s43, s34, 16384
s_add_u32 s20, s82, s43
s_addc_u32 s21, s83, 0
s_add_u32 s20, s20, 25165824
s_addc_u32 s21, s21, 0
s_mov_b32 s22, 16384
s_mov_b32 s23, 0x20000
s_add_u32 s38, s35, 2
s_and_b32 s38, s38, 15
s_mul_i32 s38, s38, 458752
s_add_u32 m0, s50, 98304
s_nop 0
buffer_load_dwordx4 v6, s[16:19], s38 offen lds
s_add_u32 m0, s50, 99328
s_nop 0
buffer_load_dwordx4 v7, s[16:19], s38 offen lds
s_add_u32 m0, s50, 100352
s_nop 0
buffer_load_dwordx4 v8, s[16:19], s38 offen lds
s_add_u32 m0, s50, 101376
s_add_u32 s38, s38, 114688
buffer_load_dwordx4 v6, s[16:19], s38 offen lds
s_add_u32 m0, s50, 102400
s_nop 0
buffer_load_dwordx4 v7, s[16:19], s38 offen lds
s_add_u32 m0, s50, 103424
s_nop 0
buffer_load_dwordx4 v8, s[16:19], s38 offen lds
s_cmp_eq_u32 s47, 1
s_cbranch_scc0 Lw_144
s_lshl_b32 s92, s34, 4
s_add_u32 s92, s92, s35
s_lshl_b32 s92, s92, 8
s_add_u32 s92, s92, 49280
s_add_u32 s92, s92, 28311552
s_mov_b32 s41, 0x40000
Lpoll_145:
s_load_dword s93, s[82:83], s92 glc
Lpchk_147:
s_waitcnt lgkmcnt(0)
s_cmp_eq_u32 s93, 16
s_cbranch_scc1 Lpok_146
s_sub_u32 s41, s41, 1
s_cmp_lg_u32 s41, 0
s_cbranch_scc1 Lpoll_145
Lpok_146:
Lw_144:
s_waitcnt vmcnt(0)
s_barrier
s_add_u32 s37, s35, 1
s_and_b32 s37, s37, 15
s_mul_i32 s37, s37, 16384
s_add_u32 m0, s39, 49152
s_nop 0
buffer_load_dwordx4 v3, s[8:11], s37 offen sc1 lds
buffer_load_dwordx4 v3, s[8:11], s37 offen offset:1024 sc1 lds
buffer_load_dwordx4 v3, s[8:11], s37 offen offset:2048 sc1 lds
buffer_load_dwordx4 v3, s[8:11], s37 offen offset:3072 sc1 lds
s_add_u32 s37, s35, 2
s_and_b32 s37, s37, 15
s_mul_i32 s37, s37, 16384
s_add_u32 m0, s39, 98304
s_nop 0
buffer_load_dwordx4 v3, s[8:11], s37 offen sc1 lds
buffer_load_dwordx4 v3, s[8:11], s37 offen offset:1024 sc1 lds
buffer_load_dwordx4 v3, s[8:11], s37 offen offset:2048 sc1 lds
buffer_load_dwordx4 v3, s[8:11], s37 offen offset:3072 sc1 lds
buffer_load_dwordx4 v[96:99], v3, s[20:23], 0 offen offset:0 sc1
buffer_load_dwordx4 v[100:103], v3, s[20:23], 0 offen offset:1024 sc1
buffer_load_dwordx4 v[104:107], v3, s[20:23], 0 offen offset:2048 sc1
buffer_load_dwordx4 v[108:111], v3, s[20:23], 0 offen offset:3072 sc1
s_and_b32 s44, s36, 3
s_mul_i32 s44, s44, 14
s_bfe_u32 s43, s2, 0x30001
s_lshl_b32 s43, s43, 7
s_add_u32 s44, s44, s43
s_add_u32 s44, s44, 72
s_mul_i32 s44, s44, 7168
s_lshr_b32 s43, s2, 4
s_lshl_b32 s43, s43, 8
s_add_u32 s43, s43, s44
s_bitcmp0_b32 s2, 0
s_cselect_b32 s4, s72, s74
s_cselect_b32 s5, s73, s75
s_add_u32 s4, s4, s43
s_addc_u32 s5, s5, 0
s_waitcnt vmcnt(8)
s_barrier
s_cmp_eq_u32 s47, 3
s_cbranch_scc0 Lw_148
v_and_b32 v30, 31, v1
v_lshlrev_b32 v30, 4, v30
v_add_u32 v31, 151552, v30
ds_read_b128 v[112:115], v31 offset:0
ds_read_b128 v[116:119], v31 offset:512
ds_read_b128 v[120:123], v31 offset:1024
ds_read_b128 v[124:127], v31 offset:1536
s_and_b32 s44, s2, 15
s_mul_i32 s44, s44, 14336
s_lshr_b32 s43, s2, 4
s_lshl_b32 s43, s43, 9
s_add_u32 s44, s44, s43
s_add_u32 s44, s44, 8192
s_cmp_lt_u32 s2, 192
s_cselect_b32 s44, s44, 0x7fffffff
s_waitcnt lgkmcnt(0)
v_add_f32 v112, v112, v116
v_add_f32 v120, v120, v124
v_add_f32 v113, v113, v117
v_add_f32 v121, v121, v125
v_add_f32 v114, v114, v118
v_add_f32 v122, v122, v126
v_add_f32 v115, v115, v119
v_add_f32 v123, v123, v127
v_add_f32 v112, v112, v120
v_add_f32 v113, v113, v121
v_add_f32 v114, v114, v122
v_add_f32 v115, v115, v123
s_mov_b64 exec, 0xffffffff
buffer_store_dwordx4 v[112:115], v30, s[84:87], s44 offen sc1
s_mov_b64 exec, -1
Lw_148:
s_add_u32 s37, s35, 3
s_and_b32 s37, s37, 15
s_mul_i32 s37, s37, 16384
s_add_u32 m0, s39, 0
s_nop 0
buffer_load_dwordx4 v3, s[8:11], s37 offen sc1 lds
buffer_load_dwordx4 v3, s[8:11], s37 offen offset:1024 sc1 lds
s_load_dword s3, s[4:5], 78848
buffer_load_dwordx4 v3, s[8:11], s37 offen offset:2048 sc1 lds
buffer_load_dwordx4 v3, s[8:11], s37 offen offset:3072 sc1 lds
s_load_dword s3, s[4:5], 78912
s_add_u32 s38, s35, 3
s_and_b32 s38, s38, 15
s_mul_i32 s38, s38, 458752
s_add_u32 m0, s50, 0
s_nop 0
buffer_load_dwordx4 v6, s[16:19], s38 offen lds
s_load_dword s3, s[4:5], 78976
s_add_u32 m0, s50, 1024
s_nop 0
buffer_load_dwordx4 v7, s[16:19], s38 offen lds
s_add_u32 m0, s50, 2048
s_nop 0
buffer_load_dwordx4 v8, s[16:19], s38 offen lds
s_load_dword s3, s[4:5], 79040
s_add_u32 m0, s50, 3072
s_add_u32 s38, s38, 114688
buffer_load_dwordx4 v6, s[16:19], s38 offen lds
s_load_dword s3, s[4:5], 86016
s_add_u32 m0, s50, 4096
s_nop 0
buffer_load_dwordx4 v7, s[16:19], s38 offen lds
s_add_u32 m0, s50, 5120
s_nop 0
buffer_load_dwordx4 v8, s[16:19], s38 offen lds
s_waitcnt vmcnt(14)
s_barrier
s_add_u32 s37, s35, 4
s_and_b32 s37, s37, 15
s_mul_i32 s37, s37, 16384
s_add_u32 m0, s39, 49152
s_nop 0
buffer_load_dwordx4 v3, s[8:11], s37 offen sc1 lds
buffer_load_dwordx4 v3, s[8:11], s37 offen offset:1024 sc1 lds
s_load_dword s3, s[4:5], 86080
buffer_load_dwordx4 v3, s[8:11], s37 offen offset:2048 sc1 lds
buffer_load_dwordx4 v3, s[8:11], s37 offen offset:3072 sc1 lds
s_load_dword s3, s[4:5], 86144
s_add_u32 s38, s35, 4
s_and_b32 s38, s38, 15
s_mul_i32 s38, s38, 458752
s_add_u32 m0, s50, 49152
s_nop 0
buffer_load_dwordx4 v6, s[16:19], s38 offen lds
s_load_dword s3, s[4:5], 86208
s_add_u32 m0, s50, 50176
s_nop 0
buffer_load_dwordx4 v7, s[16:19], s38 offen lds
s_add_u32 m0, s50, 51200
s_nop 0
buffer_load_dwordx4 v8, s[16:19], s38 offen lds
s_load_dword s3, s[4:5], 93184
s_add_u32 m0, s50, 52224
s_add_u32 s38, s38, 114688
buffer_load_dwordx4 v6, s[16:19], s38 offen lds
s_load_dword s3, s[4:5], 93248
s_add_u32 m0, s50, 53248
s_nop 0
buffer_load_dwordx4 v7, s[16:19], s38 offen lds
s_add_u32 m0, s50, 54272
s_nop 0
buffer_load_dwordx4 v8, s[16:19], s38 offen lds
s_waitcnt vmcnt(10)
s_barrier
s_cmp_eq_u32 s47, 3
s_cbranch_scc0 Lw_149
s_cmp_lt_u32 s2, 192
s_cbranch_scc0 Lw_149
s_lshr_b32 s43, s2, 4
s_add_u32 s43, s43, 96
s_lshl_b32 s43, s43, 7
v_mov_b32 v30, s43
v_mov_b32 v31, 1
s_mov_b64 exec, 1
buffer_atomic_add v31, v30, s[56:59], 0 offen sc1
s_mov_b64 exec, -1
Lw_149:
s_add_u32 s37, s35, 5
s_and_b32 s37, s37, 15
s_mul_i32 s37, s37, 16384
s_add_u32 m0, s39, 98304
s_nop 0
buffer_load_dwordx4 v3, s[8:11], s37 offen sc1 lds
v_add_f32 v96, v96, v100
v_add_f32 v97, v97, v101
v_add_f32 v98, v98, v102
buffer_load_dwordx4 v3, s[8:11], s37 offen offset:1024 sc1 lds
v_add_f32 v99, v99, v103
v_add_f32 v104, v104, v108
v_add_f32 v105, v105, v109
buffer_load_dwordx4 v3, s[8:11], s37 offen offset:2048 sc1 lds
v_add_f32 v106, v106, v110
v_add_f32 v107, v107, v111
s_nop 0
buffer_load_dwordx4 v3, s[8:11], s37 offen offset:3072 sc1 lds
v_permlane32_swap_b32 v96, v104
v_permlane32_swap_b32 v97, v105
v_permlane32_swap_b32 v98, v106
v_permlane32_swap_b32 v99, v107
s_add_u32 s38, s35, 5
s_and_b32 s38, s38, 15
s_mul_i32 s38, s38, 458752
s_add_u32 m0, s50, 98304
s_nop 0
buffer_load_dwordx4 v6, s[16:19], s38 offen lds
v_add_f32 v96, v96, v104
v_add_f32 v97, v97, v105
v_add_f32 v98, v98, v106
s_add_u32 m0, s50, 99328
s_nop 0
buffer_load_dwordx4 v7, s[16:19], s38 offen lds
v_add_f32 v99, v99, v107
v_mov_b32 v100, v96
v_mov_b32 v101, v97
s_add_u32 m0, s50, 100352
s_nop 0
buffer_load_dwordx4 v8, s[16:19], s38 offen lds
v_mov_b32 v102, v98
v_mov_b32 v103, v99
s_nop 0
s_add_u32 m0, s50, 101376
s_add_u32 s38, s38, 114688
buffer_load_dwordx4 v6, s[16:19], s38 offen lds
v_permlane16_swap_b32 v96, v100
v_permlane16_swap_b32 v97, v101
v_permlane16_swap_b32 v98, v102
v_permlane16_swap_b32 v99, v103
s_add_u32 m0, s50, 102400
s_nop 0
buffer_load_dwordx4 v7, s[16:19], s38 offen lds
s_add_u32 m0, s50, 103424
s_nop 0
buffer_load_dwordx4 v8, s[16:19], s38 offen lds
s_waitcnt vmcnt(10)
s_barrier
s_add_u32 s37, s35, 6
s_and_b32 s37, s37, 15
s_mul_i32 s37, s37, 16384
s_add_u32 m0, s39, 0
s_nop 0
buffer_load_dwordx4 v3, s[8:11], s37 offen sc1 lds
v_add_f32 v96, v96, v100
v_add_f32 v97, v97, v101
v_add_f32 v98, v98, v102
buffer_load_dwordx4 v3, s[8:11], s37 offen offset:1024 sc1 lds
v_add_f32 v99, v99, v103
s_nop 0
v_add_f32_dpp v96, v96, v96 row_ror:8 row_mask:0xf bank_mask:0xf
buffer_load_dwordx4 v3, s[8:11], s37 offen offset:2048 sc1 lds
v_add_f32_dpp v97, v97, v97 row_ror:8 row_mask:0xf bank_mask:0xf
v_add_f32_dpp v98, v98, v98 row_ror:8 row_mask:0xf bank_mask:0xf
v_add_f32_dpp v99, v99, v99 row_ror:8 row_mask:0xf bank_mask:0xf
v_mul_f32 v96, 0x3a800000, v96
buffer_load_dwordx4 v3, s[8:11], s37 offen offset:3072 sc1 lds
v_mul_f32 v97, 0x3a800000, v97
v_mul_f32 v98, 0x3a800000, v98
v_mul_f32 v99, 0x3a800000, v99
s_add_u32 s38, s35, 6
s_and_b32 s38, s38, 15
s_mul_i32 s38, s38, 458752
s_add_u32 m0, s50, 0
s_nop 0
buffer_load_dwordx4 v6, s[16:19], s38 offen lds
v_fma_f32 v97, -v96, v96, v97
v_fma_f32 v99, -v98, v98, v99
v_max_f32 v97, 0, v97
s_add_u32 m0, s50, 1024
s_nop 0
buffer_load_dwordx4 v7, s[16:19], s38 offen lds
v_max_f32 v99, 0, v99
v_add_f32 v97, 0x3727c5ac, v97
v_add_f32 v99, 0x3727c5ac, v99
v_rsq_f32 v97, v97
s_add_u32 m0, s50, 2048
s_nop 0
buffer_load_dwordx4 v8, s[16:19], s38 offen lds
v_rsq_f32 v99, v99
v_and_b32 v100, 7, v1
s_lshl_b32 s43, s47, 8
s_add_u32 m0, s50, 3072
s_add_u32 s38, s38, 114688
buffer_load_dwordx4 v6, s[16:19], s38 offen lds
s_add_u32 s43, s43, 147456
v_lshl_add_u32 v100, v100, 4, s43
v_lshrrev_b32 v101, 5, v1
v_lshl_add_u32 v100, v101, 7, v100
s_add_u32 m0, s50, 4096
s_nop 0
buffer_load_dwordx4 v7, s[16:19], s38 offen lds
s_add_u32 m0, s50, 5120
s_nop 0
buffer_load_dwordx4 v8, s[16:19], s38 offen lds
s_waitcnt vmcnt(10)
s_barrier
ds_write_b128 v100, v[96:99]
s_waitcnt lgkmcnt(0)
s_add_u32 s37, s35, 7
s_and_b32 s37, s37, 15
s_mul_i32 s37, s37, 16384
s_add_u32 m0, s39, 49152
s_nop 0
buffer_load_dwordx4 v3, s[8:11], s37 offen sc1 lds
s_load_dword s3, s[4:5], 93312
buffer_load_dwordx4 v3, s[8:11], s37 offen offset:1024 sc1 lds
s_load_dword s3, s[4:5], 93376
s_and_b32 s44, s36, 3
buffer_load_dwordx4 v3, s[8:11], s37 offen offset:2048 sc1 lds
s_mul_i32 s43, s2, 28672
buffer_load_dwordx4 v3, s[8:11], s37 offen offset:3072 sc1 lds
s_mul_i32 s44, s44, 7168
s_add_u32 s43, s43, s44
s_add_u32 s38, s35, 7
s_and_b32 s38, s38, 15
s_mul_i32 s38, s38, 458752
s_add_u32 m0, s50, 49152
s_nop 0
buffer_load_dwordx4 v6, s[16:19], s38 offen lds
s_add_u32 s4, s76, s43
s_add_u32 m0, s50, 50176
s_nop 0
buffer_load_dwordx4 v7, s[16:19], s38 offen lds
s_addc_u32 s5, s77, 0
s_load_dword s3, s[4:5], 0
s_add_u32 m0, s50, 51200
s_nop 0
buffer_load_dwordx4 v8, s[16:19], s38 offen lds
s_load_dword s3, s[4:5], 64
s_add_u32 m0, s50, 52224
s_add_u32 s38, s38, 114688
buffer_load_dwordx4 v6, s[16:19], s38 offen lds
s_load_dword s3, s[4:5], 128
s_load_dword s3, s[4:5], 192
s_add_u32 m0, s50, 53248
s_nop 0
buffer_load_dwordx4 v7, s[16:19], s38 offen lds
s_add_u32 m0, s50, 54272
s_nop 0
buffer_load_dwordx4 v8, s[16:19], s38 offen lds
s_waitcnt vmcnt(10)
s_barrier
s_add_u32 s37, s35, 8
s_and_b32 s37, s37, 15
s_mul_i32 s37, s37, 16384
s_add_u32 m0, s39, 98304
s_nop 0
buffer_load_dwordx4 v3, s[8:11], s37 offen sc1 lds
s_load_dword s3, s[4:5], 256
s_load_dword s3, s[4:5], 320
s_load_dword s3, s[4:5], 384
buffer_load_dwordx4 v3, s[8:11], s37 offen offset:1024 sc1 lds
s_load_dword s3, s[4:5], 448
s_load_dword s3, s[4:5], 512
s_load_dword s3, s[4:5], 576
buffer_load_dwordx4 v3, s[8:11], s37 offen offset:2048 sc1 lds
v_lshrrev_b32 v28, 2, v1
v_and_b32 v29, 7, v28
v_mul_u32_u24 v28, 256, v28
buffer_load_dwordx4 v3, s[8:11], s37 offen offset:3072 sc1 lds
v_lshl_add_u32 v28, v29, 5, v28
v_and_b32 v29, 3, v1
v_lshl_add_u32 v11, v29, 3, v28
s_lshl_b32 s43, s63, 7
s_add_u32 s38, s35, 8
s_and_b32 s38, s38, 15
s_mul_i32 s38, s38, 458752
s_add_u32 m0, s50, 98304
s_nop 0
buffer_load_dwordx4 v6, s[16:19], s38 offen lds
v_xor_b32 v11, s43, v11
v_add_u32 v11, 16384, v11
v_xor_b32 v12, 32, v11
s_add_u32 m0, s50, 99328
s_nop 0
buffer_load_dwordx4 v7, s[16:19], s38 offen lds
v_xor_b32 v13, 64, v11
v_xor_b32 v14, 96, v11
v_add_u32 v15, 49152, v11
s_add_u32 m0, s50, 100352
s_nop 0
buffer_load_dwordx4 v8, s[16:19], s38 offen lds
v_add_u32 v16, 49152, v12
v_add_u32 v17, 49152, v13
v_add_u32 v18, 49152, v14
s_add_u32 m0, s50, 101376
s_add_u32 s38, s38, 114688
buffer_load_dwordx4 v6, s[16:19], s38 offen lds
v_add_u32 v19, 98304, v11
v_add_u32 v20, 98304, v12
v_add_u32 v21, 98304, v13
v_add_u32 v22, 98304, v14
s_add_u32 m0, s50, 102400
s_nop 0
buffer_load_dwordx4 v7, s[16:19], s38 offen lds
s_add_u32 m0, s50, 103424
s_nop 0
buffer_load_dwordx4 v8, s[16:19], s38 offen lds
s_waitcnt vmcnt(10)
s_barrier
s_cmp_eq_u32 s47, 3
s_cbranch_scc0 Lw_150
s_mul_i32 s60, s35, 96
s_add_u32 s61, s60, 95
s_and_b32 s60, s60, 0xff80
s_and_b32 s61, s61, 0xff80
s_add_u32 s60, s60, 28323840
s_add_u32 s61, s61, 28323840
s_load_dword s92, s[82:83], s60 glc
s_load_dword s93, s[82:83], s61 glc
Lw_150:
s_add_u32 s37, s35, 9
s_and_b32 s37, s37, 15
s_mul_i32 s37, s37, 16384
s_add_u32 m0, s39, 0
s_nop 0
buffer_load_dwordx4 v3, s[8:11], s37 offen sc1 lds
buffer_load_dwordx4 v3, s[8:11], s37 offen offset:1024 sc1 lds
buffer_load_dwordx4 v3, s[8:11], s37 offen offset:2048 sc1 lds
buffer_load_dwordx4 v3, s[8:11], s37 offen offset:3072 sc1 lds
s_add_u32 s38, s35, 9
s_and_b32 s38, s38, 15
s_mul_i32 s38, s38, 458752
s_add_u32 m0, s50, 0
s_nop 0
buffer_load_dwordx4 v6, s[16:19], s38 offen lds
s_add_u32 m0, s50, 1024
s_nop 0
buffer_load_dwordx4 v7, s[16:19], s38 offen lds
s_add_u32 m0, s50, 2048
s_nop 0
buffer_load_dwordx4 v8, s[16:19], s38 offen lds
s_add_u32 m0, s50, 3072
s_add_u32 s38, s38, 114688
buffer_load_dwordx4 v6, s[16:19], s38 offen lds
s_add_u32 m0, s50, 4096
s_nop 0
buffer_load_dwordx4 v7, s[16:19], s38 offen lds
s_add_u32 m0, s50, 5120
s_nop 0
buffer_load_dwordx4 v8, s[16:19], s38 offen lds
s_waitcnt vmcnt(10)
s_barrier
s_add_u32 s37, s35, 10
s_and_b32 s37, s37, 15
s_mul_i32 s37, s37, 16384
s_add_u32 m0, s39, 49152
s_nop 0
buffer_load_dwordx4 v3, s[8:11], s37 offen sc1 lds
buffer_load_dwordx4 v3, s[8:11], s37 offen offset:1024 sc1 lds
buffer_load_dwordx4 v3, s[8:11], s37 offen offset:2048 sc1 lds
buffer_load_dwordx4 v3, s[8:11], s37 offen offset:3072 sc1 lds
s_add_u32 s38, s35, 10
s_and_b32 s38, s38, 15
s_mul_i32 s38, s38, 458752
s_add_u32 m0, s50, 49152
s_nop 0
buffer_load_dwordx4 v6, s[16:19], s38 offen lds
s_add_u32 m0, s50, 50176
s_nop 0
buffer_load_dwordx4 v7, s[16:19], s38 offen lds
s_add_u32 m0, s50, 51200
s_nop 0
buffer_load_dwordx4 v8, s[16:19], s38 offen lds
s_add_u32 m0, s50, 52224
s_add_u32 s38, s38, 114688
buffer_load_dwordx4 v6, s[16:19], s38 offen lds
s_add_u32 m0, s50, 53248
s_nop 0
buffer_load_dwordx4 v7, s[16:19], s38 offen lds
s_add_u32 m0, s50, 54272
s_nop 0
buffer_load_dwordx4 v8, s[16:19], s38 offen lds
s_mov_b32 s38, 0
buffer_load_dwordx4 v[40:43], v24, s[88:91], s38 offen
s_mov_b32 s38, 28672
buffer_load_dwordx4 v[44:47], v24, s[88:91], s38 offen
s_mov_b32 s38, 57344
buffer_load_dwordx4 v[48:51], v24, s[88:91], s38 offen
s_mov_b32 s38, 86016
buffer_load_dwordx4 v[52:55], v24, s[88:91], s38 offen
s_mov_b32 s38, 114688
buffer_load_dwordx4 v[56:59], v24, s[88:91], s38 offen
s_mov_b32 s38, 143360
buffer_load_dwordx4 v[60:63], v24, s[88:91], s38 offen
s_mov_b32 s38, 172032
buffer_load_dwordx4 v[64:67], v24, s[88:91], s38 offen
s_mov_b32 s38, 200704
buffer_load_dwordx4 v[68:71], v24, s[88:91], s38 offen
s_waitcnt vmcnt(18)
s_cmp_eq_u32 s47, 3
s_cbranch_scc0 Lw_151
s_mov_b32 s41, 0x40000
Lcp_152:
s_waitcnt lgkmcnt(0)
s_and_b32 s92, s92, s93
s_cmp_eq_u32 s92, 16
s_cbranch_scc1 Lco_153
s_load_dword s92, s[82:83], s60 glc
s_load_dword s93, s[82:83], s61 glc
s_sub_u32 s41, s41, 1
s_cmp_lg_u32 s41, 0
s_cbranch_scc1 Lcp_152
s_waitcnt lgkmcnt(0)
Lco_153:
Lw_151:
s_barrier
s_mov_b32 s45, s47
s_cmp_ge_u32 s45, 3
s_cselect_b32 s43, 1, 0
s_mul_i32 s44, s43, 3
s_sub_u32 s45, s45, s44
s_lshl_b32 s45, s45, 7
s_mul_i32 s52, s43, 896
s_add_u32 s52, s52, s45
s_add_u32 s52, s52, 148992
s_mul_i32 s43, s43, 14336
s_add_u32 s43, s43, s45
s_mul_i32 s44, s35, 384
s_add_u32 s43, s43, s44
s_add_u32 s60, s43, 8192
s_add_u32 s45, s47, 4
s_min_u32 s45, s45, 5
s_cmp_ge_u32 s45, 3
s_cselect_b32 s43, 1, 0
s_mul_i32 s44, s43, 3
s_sub_u32 s45, s45, s44
s_lshl_b32 s45, s45, 7
s_mul_i32 s53, s43, 896
s_add_u32 s53, s53, s45
s_add_u32 s53, s53, 148992
s_mul_i32 s43, s43, 14336
s_add_u32 s43, s43, s45
s_mul_i32 s44, s35, 384
s_add_u32 s43, s43, s44
s_add_u32 s61, s43, 8192
v_lshrrev_b32 v104, 3, v1
v_mul_u32_u24 v104, 28672, v104
v_and_b32 v105, 7, v1
v_lshl_add_u32 v104, v105, 4, v104
buffer_load_dwordx4 v[96:99], v104, s[84:87], s60 offen sc1
s_load_dword s3, s[4:5], 640
buffer_load_dwordx4 v[100:103], v104, s[84:87], s61 offen sc1
s_load_dword s3, s[4:5], 704
s_add_u32 s37, s35, 11
s_and_b32 s37, s37, 15
s_mul_i32 s37, s37, 16384
s_add_u32 m0, s39, 98304
s_nop 0
buffer_load_dwordx4 v3, s[8:11], s37 offen sc1 lds
s_load_dword s3, s[4:5], 768
buffer_load_dwordx4 v3, s[8:11], s37 offen offset:1024 sc1 lds
s_load_dword s3, s[4:5], 832
s_load_dword s3, s[4:5], 896
buffer_load_dwordx4 v3, s[8:11], s37 offen offset:2048 sc1 lds
s_load_dword s3, s[4:5], 960
buffer_load_dwordx4 v3, s[8:11], s37 offen offset:3072 sc1 lds
v_cmp_gt_u32 vcc, 32, v1
s_add_u32 s38, s35, 11
s_and_b32 s38, s38, 15
s_mul_i32 s38, s38, 458752
s_add_u32 m0, s50, 98304
s_nop 0
buffer_load_dwordx4 v6, s[16:19], s38 offen lds
v_mov_b32 v104, s52
v_mov_b32 v106, s53
s_add_u32 m0, s50, 99328
s_nop 0
buffer_load_dwordx4 v7, s[16:19], s38 offen lds
v_cndmask_b32 v104, v106, v104, vcc
s_add_u32 m0, s50, 100352
s_nop 0
buffer_load_dwordx4 v8, s[16:19], s38 offen lds
v_lshl_add_u32 v104, v105, 4, v104
s_add_u32 m0, s50, 101376
s_add_u32 s38, s38, 114688
buffer_load_dwordx4 v6, s[16:19], s38 offen lds
v_bfe_u32 v105, v1, 4, 1
v_lshl_add_u32 v104, v105, 2, v104
s_add_u32 m0, s50, 102400
s_nop 0
buffer_load_dwordx4 v7, s[16:19], s38 offen lds
s_add_u32 m0, s50, 103424
s_nop 0
buffer_load_dwordx4 v8, s[16:19], s38 offen lds
s_waitcnt vmcnt(20)
s_barrier
s_add_u32 s37, s35, 12
s_and_b32 s37, s37, 15
s_mul_i32 s37, s37, 16384
s_add_u32 m0, s39, 0
s_nop 0
buffer_load_dwordx4 v3, s[8:11], s37 offen sc1 lds
buffer_load_dwordx4 v3, s[8:11], s37 offen offset:1024 sc1 lds
buffer_load_dwordx4 v3, s[8:11], s37 offen offset:2048 sc1 lds
buffer_load_dwordx4 v3, s[8:11], s37 offen offset:3072 sc1 lds
s_add_u32 s38, s35, 12
s_and_b32 s38, s38, 15
s_mul_i32 s38, s38, 458752
s_add_u32 m0, s50, 0
s_nop 0
buffer_load_dwordx4 v6, s[16:19], s38 offen lds
s_add_u32 m0, s50, 1024
s_nop 0
buffer_load_dwordx4 v7, s[16:19], s38 offen lds
s_add_u32 m0, s50, 2048
s_nop 0
buffer_load_dwordx4 v8, s[16:19], s38 offen lds
s_add_u32 m0, s50, 3072
s_add_u32 s38, s38, 114688
buffer_load_dwordx4 v6, s[16:19], s38 offen lds
s_add_u32 m0, s50, 4096
s_nop 0
buffer_load_dwordx4 v7, s[16:19], s38 offen lds
s_add_u32 m0, s50, 5120
s_nop 0
buffer_load_dwordx4 v8, s[16:19], s38 offen lds
s_waitcnt vmcnt(10)
s_barrier
v_permlane32_swap_b32 v96, v100
v_permlane32_swap_b32 v97, v101
v_permlane32_swap_b32 v98, v102
v_permlane32_swap_b32 v99, v103
v_add_f32 v96, v96, v100
v_add_f32 v97, v97, v101
v_add_f32 v98, v98, v102
v_add_f32 v99, v99, v103
s_nop 1
v_permlane16_swap_b32 v96, v97
v_permlane16_swap_b32 v98, v99
v_add_f32 v96, v96, v97
v_add_f32 v98, v98, v99
s_nop 1
v_add_f32_dpp v96, v96, v96 row_ror:8 row_mask:0xf bank_mask:0xf
v_add_f32_dpp v98, v98, v98 row_ror:8 row_mask:0xf bank_mask:0xf
ds_write_b32 v104, v96
ds_write_b32 v104, v98 offset:8
s_branch Lov_14
.p2align 12
Lst_14_0:
s_branch Lwr_181
Lst_14_1:
s_branch Lwr_193
s_nop 0
Lov_14:
s_waitcnt lgkmcnt(0)
s_add_u32 s37, s35, 13
s_and_b32 s37, s37, 15
s_mul_i32 s37, s37, 16384
s_add_u32 m0, s39, 49152
s_nop 0
buffer_load_dwordx4 v3, s[8:11], s37 offen sc1 lds
s_load_dword s3, s[4:5], 1024
s_load_dword s3, s[4:5], 1088
s_load_dword s3, s[4:5], 1152
s_load_dword s3, s[4:5], 1216
buffer_load_dwordx4 v3, s[8:11], s37 offen offset:1024 sc1 lds
s_load_dword s3, s[4:5], 1280
s_load_dword s3, s[4:5], 1344
v_lshlrev_b32 v72, 16, v40
v_and_b32 v73, 0xffff0000, v40
v_lshlrev_b32 v74, 16, v41
buffer_load_dwordx4 v3, s[8:11], s37 offen offset:2048 sc1 lds
v_and_b32 v75, 0xffff0000, v41
v_lshlrev_b32 v76, 16, v42
v_and_b32 v77, 0xffff0000, v42
v_lshlrev_b32 v78, 16, v43
v_and_b32 v79, 0xffff0000, v43
buffer_load_dwordx4 v3, s[8:11], s37 offen offset:3072 sc1 lds
v_lshlrev_b32 v80, 16, v44
v_and_b32 v81, 0xffff0000, v44
v_lshlrev_b32 v82, 16, v45
v_and_b32 v83, 0xffff0000, v45
v_lshlrev_b32 v84, 16, v46
s_add_u32 s38, s35, 13
s_and_b32 s38, s38, 15
s_mul_i32 s38, s38, 458752
s_add_u32 m0, s50, 49152
s_nop 0
buffer_load_dwordx4 v6, s[16:19], s38 offen lds
v_and_b32 v85, 0xffff0000, v46
v_lshlrev_b32 v86, 16, v47
v_and_b32 v87, 0xffff0000, v47
v_add_f32 v72, v72, v80
v_add_f32 v73, v73, v81
s_add_u32 m0, s50, 50176
s_nop 0
buffer_load_dwordx4 v7, s[16:19], s38 offen lds
v_add_f32 v74, v74, v82
v_add_f32 v75, v75, v83
v_add_f32 v76, v76, v84
v_add_f32 v77, v77, v85
v_add_f32 v78, v78, v86
s_add_u32 m0, s50, 51200
s_nop 0
buffer_load_dwordx4 v8, s[16:19], s38 offen lds
v_add_f32 v79, v79, v87
v_lshlrev_b32 v80, 16, v48
v_and_b32 v81, 0xffff0000, v48
v_lshlrev_b32 v82, 16, v49
v_and_b32 v83, 0xffff0000, v49
s_add_u32 m0, s50, 52224
s_add_u32 s38, s38, 114688
buffer_load_dwordx4 v6, s[16:19], s38 offen lds
v_lshlrev_b32 v84, 16, v50
v_and_b32 v85, 0xffff0000, v50
v_lshlrev_b32 v86, 16, v51
v_and_b32 v87, 0xffff0000, v51
v_add_f32 v72, v72, v80
s_add_u32 m0, s50, 53248
s_nop 0
buffer_load_dwordx4 v7, s[16:19], s38 offen lds
s_add_u32 m0, s50, 54272
s_nop 0
buffer_load_dwordx4 v8, s[16:19], s38 offen lds
s_waitcnt vmcnt(10)
s_barrier
s_add_u32 s37, s35, 14
s_and_b32 s37, s37, 15
s_mul_i32 s37, s37, 16384
s_add_u32 m0, s39, 98304
s_nop 0
buffer_load_dwordx4 v3, s[8:11], s37 offen sc1 lds
s_load_dword s3, s[4:5], 1408
s_load_dword s3, s[4:5], 1472
s_load_dword s3, s[4:5], 1536
s_load_dword s3, s[4:5], 1600
s_load_dword s3, s[4:5], 1664
buffer_load_dwordx4 v3, s[8:11], s37 offen offset:1024 sc1 lds
s_load_dword s3, s[4:5], 1728
v_add_f32 v73, v73, v81
v_add_f32 v74, v74, v82
v_add_f32 v75, v75, v83
v_add_f32 v76, v76, v84
buffer_load_dwordx4 v3, s[8:11], s37 offen offset:2048 sc1 lds
v_add_f32 v77, v77, v85
v_add_f32 v78, v78, v86
v_add_f32 v79, v79, v87
v_lshlrev_b32 v80, 16, v52
v_and_b32 v81, 0xffff0000, v52
buffer_load_dwordx4 v3, s[8:11], s37 offen offset:3072 sc1 lds
v_lshlrev_b32 v82, 16, v53
v_and_b32 v83, 0xffff0000, v53
v_lshlrev_b32 v84, 16, v54
v_and_b32 v85, 0xffff0000, v54
v_lshlrev_b32 v86, 16, v55
s_add_u32 s38, s35, 14
s_and_b32 s38, s38, 15
s_mul_i32 s38, s38, 458752
s_add_u32 m0, s50, 98304
s_nop 0
buffer_load_dwordx4 v6, s[16:19], s38 offen lds
v_and_b32 v87, 0xffff0000, v55
v_add_f32 v72, v72, v80
v_add_f32 v73, v73, v81
v_add_f32 v74, v74, v82
v_add_f32 v75, v75, v83
s_add_u32 m0, s50, 99328
s_nop 0
buffer_load_dwordx4 v7, s[16:19], s38 offen lds
v_add_f32 v76, v76, v84
v_add_f32 v77, v77, v85
v_add_f32 v78, v78, v86
v_add_f32 v79, v79, v87
v_lshlrev_b32 v80, 16, v56
s_add_u32 m0, s50, 100352
s_nop 0
buffer_load_dwordx4 v8, s[16:19], s38 offen lds
v_and_b32 v81, 0xffff0000, v56
v_lshlrev_b32 v82, 16, v57
v_and_b32 v83, 0xffff0000, v57
v_lshlrev_b32 v84, 16, v58
v_and_b32 v85, 0xffff0000, v58
s_add_u32 m0, s50, 101376
s_add_u32 s38, s38, 114688
buffer_load_dwordx4 v6, s[16:19], s38 offen lds
v_lshlrev_b32 v86, 16, v59
v_and_b32 v87, 0xffff0000, v59
v_add_f32 v72, v72, v80
v_add_f32 v73, v73, v81
v_add_f32 v74, v74, v82
s_add_u32 m0, s50, 102400
s_nop 0
buffer_load_dwordx4 v7, s[16:19], s38 offen lds
s_add_u32 m0, s50, 103424
s_nop 0
buffer_load_dwordx4 v8, s[16:19], s38 offen lds
s_waitcnt vmcnt(10)
s_barrier
s_add_u32 s37, s35, 15
s_and_b32 s37, s37, 15
s_mul_i32 s37, s37, 16384
s_add_u32 m0, s39, 0
s_nop 0
buffer_load_dwordx4 v3, s[8:11], s37 offen sc1 lds
v_add_f32 v75, v75, v83
v_add_f32 v76, v76, v84
v_add_f32 v77, v77, v85
v_add_f32 v78, v78, v86
buffer_load_dwordx4 v3, s[8:11], s37 offen offset:1024 sc1 lds
v_add_f32 v79, v79, v87
v_lshlrev_b32 v80, 16, v60
v_and_b32 v81, 0xffff0000, v60
v_lshlrev_b32 v82, 16, v61
buffer_load_dwordx4 v3, s[8:11], s37 offen offset:2048 sc1 lds
v_and_b32 v83, 0xffff0000, v61
v_lshlrev_b32 v84, 16, v62
v_and_b32 v85, 0xffff0000, v62
v_lshlrev_b32 v86, 16, v63
buffer_load_dwordx4 v3, s[8:11], s37 offen offset:3072 sc1 lds
v_and_b32 v87, 0xffff0000, v63
v_add_f32 v72, v72, v80
v_add_f32 v73, v73, v81
v_add_f32 v74, v74, v82
s_add_u32 s38, s35, 15
s_and_b32 s38, s38, 15
s_mul_i32 s38, s38, 458752
s_add_u32 m0, s50, 0
s_nop 0
buffer_load_dwordx4 v6, s[16:19], s38 offen lds
v_add_f32 v75, v75, v83
v_add_f32 v76, v76, v84
v_add_f32 v77, v77, v85
v_add_f32 v78, v78, v86
s_add_u32 m0, s50, 1024
s_nop 0
buffer_load_dwordx4 v7, s[16:19], s38 offen lds
v_add_f32 v79, v79, v87
v_lshlrev_b32 v80, 16, v64
v_and_b32 v81, 0xffff0000, v64
v_lshlrev_b32 v82, 16, v65
s_add_u32 m0, s50, 2048
s_nop 0
buffer_load_dwordx4 v8, s[16:19], s38 offen lds
v_and_b32 v83, 0xffff0000, v65
v_lshlrev_b32 v84, 16, v66
v_and_b32 v85, 0xffff0000, v66
v_lshlrev_b32 v86, 16, v67
s_add_u32 m0, s50, 3072
s_add_u32 s38, s38, 114688
buffer_load_dwordx4 v6, s[16:19], s38 offen lds
v_and_b32 v87, 0xffff0000, v67
v_add_f32 v72, v72, v80
v_add_f32 v73, v73, v81
v_add_f32 v74, v74, v82
v_add_f32 v75, v75, v83
s_add_u32 m0, s50, 4096
s_nop 0
buffer_load_dwordx4 v7, s[16:19], s38 offen lds
s_add_u32 m0, s50, 5120
s_nop 0
buffer_load_dwordx4 v8, s[16:19], s38 offen lds
s_waitcnt vmcnt(10)
s_barrier
s_add_u32 s37, s35, 0
s_and_b32 s37, s37, 15
s_mul_i32 s37, s37, 16384
s_add_u32 m0, s39, 49152
s_nop 0
buffer_load_dwordx4 v3, s[8:11], s37 offen sc1 lds
v_add_f32 v76, v76, v84
v_add_f32 v77, v77, v85
v_add_f32 v78, v78, v86
buffer_load_dwordx4 v3, s[8:11], s37 offen offset:1024 sc1 lds
v_add_f32 v79, v79, v87
v_lshlrev_b32 v80, 16, v68
v_and_b32 v81, 0xffff0000, v68
buffer_load_dwordx4 v3, s[8:11], s37 offen offset:2048 sc1 lds
v_lshlrev_b32 v82, 16, v69
v_and_b32 v83, 0xffff0000, v69
v_lshlrev_b32 v84, 16, v70
v_and_b32 v85, 0xffff0000, v70
buffer_load_dwordx4 v3, s[8:11], s37 offen offset:3072 sc1 lds
v_lshlrev_b32 v86, 16, v71
v_and_b32 v87, 0xffff0000, v71
v_add_f32 v72, v72, v80
s_add_u32 s38, s35, 0
s_and_b32 s38, s38, 15
s_mul_i32 s38, s38, 458752
s_add_u32 m0, s40, 49152
s_nop 0
buffer_load_dwordx4 v4, s[12:15], s38 offen lds
v_add_f32 v73, v73, v81
v_add_f32 v74, v74, v82
v_add_f32 v75, v75, v83
v_add_f32 v76, v76, v84
s_add_u32 m0, s40, 50176
s_nop 0
buffer_load_dwordx4 v5, s[12:15], s38 offen lds
v_add_f32 v77, v77, v85
v_add_f32 v78, v78, v86
v_add_f32 v79, v79, v87
s_add_u32 m0, s40, 51200
s_add_u32 s38, s38, 57344
buffer_load_dwordx4 v4, s[12:15], s38 offen lds
s_nop 0
v_permlane32_swap_b32 v72, v76
v_permlane32_swap_b32 v73, v77
s_add_u32 m0, s40, 52224
s_nop 0
buffer_load_dwordx4 v5, s[12:15], s38 offen lds
v_permlane32_swap_b32 v74, v78
v_permlane32_swap_b32 v75, v79
v_add_f32 v72, v72, v76
v_add_f32 v73, v73, v77
s_add_u32 m0, s40, 53248
s_add_u32 s38, s38, 57344
buffer_load_dwordx4 v4, s[12:15], s38 offen lds
v_add_f32 v74, v74, v78
v_add_f32 v75, v75, v79
s_nop 0
s_add_u32 m0, s40, 54272
s_nop 0
buffer_load_dwordx4 v5, s[12:15], s38 offen lds
v_permlane16_swap_b32 v72, v74
v_permlane16_swap_b32 v73, v75
v_add_f32 v72, v72, v74
v_add_f32 v73, v73, v75
s_add_u32 m0, s40, 55296
s_add_u32 s38, s38, 57344
buffer_load_dwordx4 v4, s[12:15], s38 offen lds
s_add_u32 m0, s40, 56320
s_nop 0
buffer_load_dwordx4 v5, s[12:15], s38 offen lds
s_waitcnt vmcnt(12)
s_barrier
s_lshl_b32 s43, s47, 9
s_add_u32 s43, s43, 153600
v_and_b32 v80, 15, v1
v_lshl_add_u32 v80, v80, 5, s43
v_lshrrev_b32 v81, 4, v1
v_lshl_add_u32 v80, v81, 3, v80
ds_write_b64 v80, v[72:73]
s_waitcnt lgkmcnt(0)
s_add_u32 s37, s35, 1
s_and_b32 s37, s37, 15
s_mul_i32 s37, s37, 16384
s_add_u32 m0, s39, 98304
s_nop 0
buffer_load_dwordx4 v3, s[8:11], s37 offen sc1 lds
s_bfe_u32 s61, s35, 0x10002
s_lshr_b32 s60, s35, 3
buffer_load_dwordx4 v3, s[8:11], s37 offen offset:1024 sc1 lds
s_lshl_b32 s60, s60, 2
s_and_b32 s43, s35, 3
s_add_u32 s60, s60, s43
buffer_load_dwordx4 v3, s[8:11], s37 offen offset:2048 sc1 lds
s_lshl_b32 s43, s60, 8
s_add_u32 s28, s76, s43
buffer_load_dwordx4 v3, s[8:11], s37 offen offset:3072 sc1 lds
s_addc_u32 s29, s77, 0
s_mov_b32 s30, 7338240
s_mov_b32 s31, 0x20000
s_add_u32 s38, s35, 1
s_and_b32 s38, s38, 15
s_mul_i32 s38, s38, 458752
s_add_u32 m0, s40, 98304
s_nop 0
buffer_load_dwordx4 v4, s[12:15], s38 offen lds
s_mul_i32 s52, s61, 196608
s_mul_i32 s53, s61, 1572864
s_mul_i32 s90, s61, 163840
s_add_u32 m0, s40, 99328
s_nop 0
buffer_load_dwordx4 v5, s[12:15], s38 offen lds
s_mul_i32 s91, s61, 1310720
s_lshl_b32 s51, s47, 11
s_add_u32 m0, s40, 100352
s_add_u32 s38, s38, 57344
buffer_load_dwordx4 v4, s[12:15], s38 offen lds
s_lshl_b32 s44, s47, 15
v_lshrrev_b32 v122, 4, v1
v_lshlrev_b32 v123, 1, v122
s_add_u32 m0, s40, 101376
s_nop 0
buffer_load_dwordx4 v5, s[12:15], s38 offen lds
v_and_b32 v23, 15, v1
v_xor_b32 v23, v23, v123
s_add_u32 m0, s40, 102400
s_add_u32 s38, s38, 57344
buffer_load_dwordx4 v4, s[12:15], s38 offen lds
v_lshlrev_b32 v23, 4, v23
v_mul_u32_u24 v122, 2048, v122
v_add_u32 v23, v23, v122
s_add_u32 m0, s40, 103424
s_nop 0
buffer_load_dwordx4 v5, s[12:15], s38 offen lds
v_add_u32 v23, s44, v23
v_xor_b32 v24, 128, v23
v_add_u32 v24, 8192, v24
s_add_u32 m0, s40, 104448
s_add_u32 s38, s38, 57344
buffer_load_dwordx4 v4, s[12:15], s38 offen lds
s_add_u32 m0, s40, 105472
s_nop 0
buffer_load_dwordx4 v5, s[12:15], s38 offen lds
s_waitcnt vmcnt(12)
s_barrier
ds_read_b128 v[28:31], v9 offset:49152
ds_read_b64_tr_b16 v[44:45], v15 offset:0
ds_read_b64_tr_b16 v[46:47], v15 offset:4096
ds_read_b64_tr_b16 v[48:49], v16 offset:0
ds_read_b64_tr_b16 v[50:51], v16 offset:4096
ds_read_b64_tr_b16 v[52:53], v17 offset:0
ds_read_b64_tr_b16 v[54:55], v17 offset:4096
ds_read_b64_tr_b16 v[56:57], v18 offset:0
ds_read_b64_tr_b16 v[58:59], v18 offset:4096
ds_read_b64_tr_b16 v[60:61], v15 offset:16384
ds_read_b64_tr_b16 v[62:63], v15 offset:20480
ds_read_b64_tr_b16 v[64:65], v16 offset:16384
ds_read_b64_tr_b16 v[66:67], v16 offset:20480
ds_read_b64_tr_b16 v[68:69], v17 offset:16384
ds_read_b64_tr_b16 v[70:71], v17 offset:20480
ds_read_b64_tr_b16 v[72:73], v18 offset:16384
ds_read_b64_tr_b16 v[74:75], v18 offset:20480
ds_read_b128 v[32:35], v9 offset:50176
ds_read_b128 v[36:39], v9 offset:51200
ds_read_b128 v[40:43], v9 offset:52224
s_waitcnt lgkmcnt(0)
v_mfma_f32_16x16x32_bf16 v[124:127], v[44:47], v[28:31], 0
ds_read_b128 v[76:79], v9 offset:57344
v_mfma_f32_16x16x32_bf16 v[128:131], v[48:51], v[28:31], 0
ds_read_b64_tr_b16 v[92:93], v15 offset:8192
v_mfma_f32_16x16x32_bf16 v[132:135], v[52:55], v[28:31], 0
ds_read_b64_tr_b16 v[94:95], v15 offset:12288
v_mfma_f32_16x16x32_bf16 v[136:139], v[56:59], v[28:31], 0
ds_read_b64_tr_b16 v[96:97], v16 offset:8192
v_mfma_f32_16x16x32_bf16 v[140:143], v[60:63], v[28:31], 0
ds_read_b64_tr_b16 v[98:99], v16 offset:12288
v_mfma_f32_16x16x32_bf16 v[144:147], v[64:67], v[28:31], 0
ds_read_b64_tr_b16 v[100:101], v17 offset:8192
v_mfma_f32_16x16x32_bf16 v[148:151], v[68:71], v[28:31], 0
ds_read_b64_tr_b16 v[102:103], v17 offset:12288
v_mfma_f32_16x16x32_bf16 v[152:155], v[72:75], v[28:31], 0
ds_read_b64_tr_b16 v[104:105], v18 offset:8192
v_mfma_f32_16x16x32_bf16 v[184:187], v[72:75], v[32:35], 0
ds_read_b64_tr_b16 v[106:107], v18 offset:12288
v_mfma_f32_16x16x32_bf16 v[180:183], v[68:71], v[32:35], 0
ds_read_b64_tr_b16 v[108:109], v15 offset:24576
v_mfma_f32_16x16x32_bf16 v[176:179], v[64:67], v[32:35], 0
ds_read_b64_tr_b16 v[110:111], v15 offset:28672
v_mfma_f32_16x16x32_bf16 v[172:175], v[60:63], v[32:35], 0
ds_read_b64_tr_b16 v[112:113], v16 offset:24576
v_mfma_f32_16x16x32_bf16 v[168:171], v[56:59], v[32:35], 0
ds_read_b64_tr_b16 v[114:115], v16 offset:28672
v_mfma_f32_16x16x32_bf16 v[164:167], v[52:55], v[32:35], 0
ds_read_b64_tr_b16 v[116:117], v17 offset:24576
v_mfma_f32_16x16x32_bf16 v[160:163], v[48:51], v[32:35], 0
ds_read_b64_tr_b16 v[118:119], v17 offset:28672
v_mfma_f32_16x16x32_bf16 v[156:159], v[44:47], v[32:35], 0
ds_read_b64_tr_b16 v[120:121], v18 offset:24576
v_mfma_f32_16x16x32_bf16 v[188:191], v[44:47], v[36:39], 0
ds_read_b64_tr_b16 v[122:123], v18 offset:28672
v_mfma_f32_16x16x32_bf16 v[192:195], v[48:51], v[36:39], 0
ds_read_b128 v[80:83], v9 offset:58368
v_mfma_f32_16x16x32_bf16 v[196:199], v[52:55], v[36:39], 0
ds_read_b128 v[84:87], v9 offset:59392
v_mfma_f32_16x16x32_bf16 v[200:203], v[56:59], v[36:39], 0
ds_read_b128 v[88:91], v9 offset:60416
v_mfma_f32_16x16x32_bf16 v[204:207], v[60:63], v[36:39], 0
v_mfma_f32_16x16x32_bf16 v[208:211], v[64:67], v[36:39], 0
v_mfma_f32_16x16x32_bf16 v[212:215], v[68:71], v[36:39], 0
v_mfma_f32_16x16x32_bf16 v[216:219], v[72:75], v[36:39], 0
v_mfma_f32_16x16x32_bf16 v[248:251], v[72:75], v[40:43], 0
v_mfma_f32_16x16x32_bf16 v[244:247], v[68:71], v[40:43], 0
v_mfma_f32_16x16x32_bf16 v[240:243], v[64:67], v[40:43], 0
v_mfma_f32_16x16x32_bf16 v[236:239], v[60:63], v[40:43], 0
v_mfma_f32_16x16x32_bf16 v[232:235], v[56:59], v[40:43], 0
v_mfma_f32_16x16x32_bf16 v[228:231], v[52:55], v[40:43], 0
v_mfma_f32_16x16x32_bf16 v[224:227], v[48:51], v[40:43], 0
v_mfma_f32_16x16x32_bf16 v[220:223], v[44:47], v[40:43], 0
s_waitcnt vmcnt(0)
s_waitcnt lgkmcnt(0)
s_barrier
v_mfma_f32_16x16x32_bf16 v[124:127], v[92:95], v[76:79], v[124:127]
ds_read_b128 v[28:31], v10 offset:0
v_mfma_f32_16x16x32_bf16 v[128:131], v[96:99], v[76:79], v[128:131]
ds_read_b64_tr_b16 v[44:45], v19 offset:0
v_mfma_f32_16x16x32_bf16 v[132:135], v[100:103], v[76:79], v[132:135]
ds_read_b64_tr_b16 v[46:47], v19 offset:4096
v_mfma_f32_16x16x32_bf16 v[136:139], v[104:107], v[76:79], v[136:139]
ds_read_b64_tr_b16 v[48:49], v20 offset:0
v_mfma_f32_16x16x32_bf16 v[140:143], v[108:111], v[76:79], v[140:143]
ds_read_b64_tr_b16 v[50:51], v20 offset:4096
v_mfma_f32_16x16x32_bf16 v[144:147], v[112:115], v[76:79], v[144:147]
ds_read_b64_tr_b16 v[52:53], v21 offset:0
v_mfma_f32_16x16x32_bf16 v[148:151], v[116:119], v[76:79], v[148:151]
ds_read_b64_tr_b16 v[54:55], v21 offset:4096
v_mfma_f32_16x16x32_bf16 v[152:155], v[120:123], v[76:79], v[152:155]
ds_read_b64_tr_b16 v[56:57], v22 offset:0
v_mfma_f32_16x16x32_bf16 v[184:187], v[120:123], v[80:83], v[184:187]
ds_read_b64_tr_b16 v[58:59], v22 offset:4096
v_mfma_f32_16x16x32_bf16 v[180:183], v[116:119], v[80:83], v[180:183]
ds_read_b64_tr_b16 v[60:61], v19 offset:16384
v_mfma_f32_16x16x32_bf16 v[176:179], v[112:115], v[80:83], v[176:179]
ds_read_b64_tr_b16 v[62:63], v19 offset:20480
v_mfma_f32_16x16x32_bf16 v[172:175], v[108:111], v[80:83], v[172:175]
ds_read_b64_tr_b16 v[64:65], v20 offset:16384
v_mfma_f32_16x16x32_bf16 v[168:171], v[104:107], v[80:83], v[168:171]
ds_read_b64_tr_b16 v[66:67], v20 offset:20480
v_mfma_f32_16x16x32_bf16 v[164:167], v[100:103], v[80:83], v[164:167]
ds_read_b64_tr_b16 v[68:69], v21 offset:16384
v_mfma_f32_16x16x32_bf16 v[160:163], v[96:99], v[80:83], v[160:163]
ds_read_b64_tr_b16 v[70:71], v21 offset:20480
v_mfma_f32_16x16x32_bf16 v[156:159], v[92:95], v[80:83], v[156:159]
ds_read_b64_tr_b16 v[72:73], v22 offset:16384
v_mfma_f32_16x16x32_bf16 v[188:191], v[92:95], v[84:87], v[188:191]
ds_read_b64_tr_b16 v[74:75], v22 offset:20480
v_mfma_f32_16x16x32_bf16 v[192:195], v[96:99], v[84:87], v[192:195]
ds_read_b128 v[32:35], v10 offset:1024
v_mfma_f32_16x16x32_bf16 v[196:199], v[100:103], v[84:87], v[196:199]
ds_read_b128 v[36:39], v10 offset:2048
v_mfma_f32_16x16x32_bf16 v[200:203], v[104:107], v[84:87], v[200:203]
ds_read_b128 v[40:43], v10 offset:3072
v_mfma_f32_16x16x32_bf16 v[204:207], v[108:111], v[84:87], v[204:207]
v_mfma_f32_16x16x32_bf16 v[208:211], v[112:115], v[84:87], v[208:211]
v_mfma_f32_16x16x32_bf16 v[212:215], v[116:119], v[84:87], v[212:215]
v_mfma_f32_16x16x32_bf16 v[216:219], v[120:123], v[84:87], v[216:219]
v_mfma_f32_16x16x32_bf16 v[248:251], v[120:123], v[88:91], v[248:251]
v_mfma_f32_16x16x32_bf16 v[244:247], v[116:119], v[88:91], v[244:247]
v_mfma_f32_16x16x32_bf16 v[240:243], v[112:115], v[88:91], v[240:243]
v_mfma_f32_16x16x32_bf16 v[236:239], v[108:111], v[88:91], v[236:239]
v_mfma_f32_16x16x32_bf16 v[232:235], v[104:107], v[88:91], v[232:235]
v_mfma_f32_16x16x32_bf16 v[228:231], v[100:103], v[88:91], v[228:231]
v_mfma_f32_16x16x32_bf16 v[224:227], v[96:99], v[88:91], v[224:227]
v_mfma_f32_16x16x32_bf16 v[220:223], v[92:95], v[88:91], v[220:223]
s_mov_b32 s41, 5
Lk3l_154:
s_waitcnt lgkmcnt(0)
v_mfma_f32_16x16x32_bf16 v[124:127], v[44:47], v[28:31], v[124:127]
ds_read_b128 v[76:79], v10 offset:8192
v_mfma_f32_16x16x32_bf16 v[128:131], v[48:51], v[28:31], v[128:131]
ds_read_b64_tr_b16 v[92:93], v19 offset:8192
v_mfma_f32_16x16x32_bf16 v[132:135], v[52:55], v[28:31], v[132:135]
ds_read_b64_tr_b16 v[94:95], v19 offset:12288
v_mfma_f32_16x16x32_bf16 v[136:139], v[56:59], v[28:31], v[136:139]
ds_read_b64_tr_b16 v[96:97], v20 offset:8192
v_mfma_f32_16x16x32_bf16 v[140:143], v[60:63], v[28:31], v[140:143]
ds_read_b64_tr_b16 v[98:99], v20 offset:12288
v_mfma_f32_16x16x32_bf16 v[144:147], v[64:67], v[28:31], v[144:147]
ds_read_b64_tr_b16 v[100:101], v21 offset:8192
v_mfma_f32_16x16x32_bf16 v[148:151], v[68:71], v[28:31], v[148:151]
ds_read_b64_tr_b16 v[102:103], v21 offset:12288
v_mfma_f32_16x16x32_bf16 v[152:155], v[72:75], v[28:31], v[152:155]
ds_read_b64_tr_b16 v[104:105], v22 offset:8192
v_mfma_f32_16x16x32_bf16 v[184:187], v[72:75], v[32:35], v[184:187]
ds_read_b64_tr_b16 v[106:107], v22 offset:12288
v_mfma_f32_16x16x32_bf16 v[180:183], v[68:71], v[32:35], v[180:183]
ds_read_b64_tr_b16 v[108:109], v19 offset:24576
v_mfma_f32_16x16x32_bf16 v[176:179], v[64:67], v[32:35], v[176:179]
ds_read_b64_tr_b16 v[110:111], v19 offset:28672
v_mfma_f32_16x16x32_bf16 v[172:175], v[60:63], v[32:35], v[172:175]
ds_read_b64_tr_b16 v[112:113], v20 offset:24576
v_mfma_f32_16x16x32_bf16 v[168:171], v[56:59], v[32:35], v[168:171]
ds_read_b64_tr_b16 v[114:115], v20 offset:28672
v_mfma_f32_16x16x32_bf16 v[164:167], v[52:55], v[32:35], v[164:167]
ds_read_b64_tr_b16 v[116:117], v21 offset:24576
v_mfma_f32_16x16x32_bf16 v[160:163], v[48:51], v[32:35], v[160:163]
ds_read_b64_tr_b16 v[118:119], v21 offset:28672
v_mfma_f32_16x16x32_bf16 v[156:159], v[44:47], v[32:35], v[156:159]
ds_read_b64_tr_b16 v[120:121], v22 offset:24576
v_mfma_f32_16x16x32_bf16 v[188:191], v[44:47], v[36:39], v[188:191]
ds_read_b64_tr_b16 v[122:123], v22 offset:28672
v_mfma_f32_16x16x32_bf16 v[192:195], v[48:51], v[36:39], v[192:195]
ds_read_b128 v[80:83], v10 offset:9216
v_mfma_f32_16x16x32_bf16 v[196:199], v[52:55], v[36:39], v[196:199]
ds_read_b128 v[84:87], v10 offset:10240
v_mfma_f32_16x16x32_bf16 v[200:203], v[56:59], v[36:39], v[200:203]
ds_read_b128 v[88:91], v10 offset:11264
v_mfma_f32_16x16x32_bf16 v[204:207], v[60:63], v[36:39], v[204:207]
v_mfma_f32_16x16x32_bf16 v[208:211], v[64:67], v[36:39], v[208:211]
v_mfma_f32_16x16x32_bf16 v[212:215], v[68:71], v[36:39], v[212:215]
v_mfma_f32_16x16x32_bf16 v[216:219], v[72:75], v[36:39], v[216:219]
v_mfma_f32_16x16x32_bf16 v[248:251], v[72:75], v[40:43], v[248:251]
v_mfma_f32_16x16x32_bf16 v[244:247], v[68:71], v[40:43], v[244:247]
v_mfma_f32_16x16x32_bf16 v[240:243], v[64:67], v[40:43], v[240:243]
v_mfma_f32_16x16x32_bf16 v[236:239], v[60:63], v[40:43], v[236:239]
v_mfma_f32_16x16x32_bf16 v[232:235], v[56:59], v[40:43], v[232:235]
v_mfma_f32_16x16x32_bf16 v[228:231], v[52:55], v[40:43], v[228:231]
v_mfma_f32_16x16x32_bf16 v[224:227], v[48:51], v[40:43], v[224:227]
v_mfma_f32_16x16x32_bf16 v[220:223], v[44:47], v[40:43], v[220:223]
s_waitcnt lgkmcnt(0)
s_barrier
v_mfma_f32_16x16x32_bf16 v[124:127], v[92:95], v[76:79], v[124:127]
ds_read_b128 v[28:31], v9 offset:0
v_mfma_f32_16x16x32_bf16 v[128:131], v[96:99], v[76:79], v[128:131]
ds_read_b64_tr_b16 v[44:45], v11 offset:0
v_mfma_f32_16x16x32_bf16 v[132:135], v[100:103], v[76:79], v[132:135]
ds_read_b64_tr_b16 v[46:47], v11 offset:4096
v_mfma_f32_16x16x32_bf16 v[136:139], v[104:107], v[76:79], v[136:139]
ds_read_b64_tr_b16 v[48:49], v12 offset:0
v_mfma_f32_16x16x32_bf16 v[140:143], v[108:111], v[76:79], v[140:143]
ds_read_b64_tr_b16 v[50:51], v12 offset:4096
v_mfma_f32_16x16x32_bf16 v[144:147], v[112:115], v[76:79], v[144:147]
ds_read_b64_tr_b16 v[52:53], v13 offset:0
v_mfma_f32_16x16x32_bf16 v[148:151], v[116:119], v[76:79], v[148:151]
ds_read_b64_tr_b16 v[54:55], v13 offset:4096
v_mfma_f32_16x16x32_bf16 v[152:155], v[120:123], v[76:79], v[152:155]
ds_read_b64_tr_b16 v[56:57], v14 offset:0
v_mfma_f32_16x16x32_bf16 v[184:187], v[120:123], v[80:83], v[184:187]
ds_read_b64_tr_b16 v[58:59], v14 offset:4096
v_mfma_f32_16x16x32_bf16 v[180:183], v[116:119], v[80:83], v[180:183]
ds_read_b64_tr_b16 v[60:61], v11 offset:16384
v_mfma_f32_16x16x32_bf16 v[176:179], v[112:115], v[80:83], v[176:179]
ds_read_b64_tr_b16 v[62:63], v11 offset:20480
v_mfma_f32_16x16x32_bf16 v[172:175], v[108:111], v[80:83], v[172:175]
ds_read_b64_tr_b16 v[64:65], v12 offset:16384
v_mfma_f32_16x16x32_bf16 v[168:171], v[104:107], v[80:83], v[168:171]
ds_read_b64_tr_b16 v[66:67], v12 offset:20480
v_mfma_f32_16x16x32_bf16 v[164:167], v[100:103], v[80:83], v[164:167]
ds_read_b64_tr_b16 v[68:69], v13 offset:16384
v_mfma_f32_16x16x32_bf16 v[160:163], v[96:99], v[80:83], v[160:163]
ds_read_b64_tr_b16 v[70:71], v13 offset:20480
v_mfma_f32_16x16x32_bf16 v[156:159], v[92:95], v[80:83], v[156:159]
ds_read_b64_tr_b16 v[72:73], v14 offset:16384
v_mfma_f32_16x16x32_bf16 v[188:191], v[92:95], v[84:87], v[188:191]
ds_read_b64_tr_b16 v[74:75], v14 offset:20480
v_mfma_f32_16x16x32_bf16 v[192:195], v[96:99], v[84:87], v[192:195]
ds_read_b128 v[32:35], v9 offset:1024
v_mfma_f32_16x16x32_bf16 v[196:199], v[100:103], v[84:87], v[196:199]
ds_read_b128 v[36:39], v9 offset:2048
v_mfma_f32_16x16x32_bf16 v[200:203], v[104:107], v[84:87], v[200:203]
ds_read_b128 v[40:43], v9 offset:3072
v_mfma_f32_16x16x32_bf16 v[204:207], v[108:111], v[84:87], v[204:207]
v_mfma_f32_16x16x32_bf16 v[208:211], v[112:115], v[84:87], v[208:211]
v_mfma_f32_16x16x32_bf16 v[212:215], v[116:119], v[84:87], v[212:215]
v_mfma_f32_16x16x32_bf16 v[216:219], v[120:123], v[84:87], v[216:219]
v_mfma_f32_16x16x32_bf16 v[248:251], v[120:123], v[88:91], v[248:251]
v_mfma_f32_16x16x32_bf16 v[244:247], v[116:119], v[88:91], v[244:247]
v_mfma_f32_16x16x32_bf16 v[240:243], v[112:115], v[88:91], v[240:243]
v_mfma_f32_16x16x32_bf16 v[236:239], v[108:111], v[88:91], v[236:239]
v_mfma_f32_16x16x32_bf16 v[232:235], v[104:107], v[88:91], v[232:235]
v_mfma_f32_16x16x32_bf16 v[228:231], v[100:103], v[88:91], v[228:231]
v_mfma_f32_16x16x32_bf16 v[224:227], v[96:99], v[88:91], v[224:227]
v_mfma_f32_16x16x32_bf16 v[220:223], v[92:95], v[88:91], v[220:223]
s_waitcnt lgkmcnt(0)
v_mfma_f32_16x16x32_bf16 v[124:127], v[44:47], v[28:31], v[124:127]
ds_read_b128 v[76:79], v9 offset:8192
v_mfma_f32_16x16x32_bf16 v[128:131], v[48:51], v[28:31], v[128:131]
ds_read_b64_tr_b16 v[92:93], v11 offset:8192
v_mfma_f32_16x16x32_bf16 v[132:135], v[52:55], v[28:31], v[132:135]
ds_read_b64_tr_b16 v[94:95], v11 offset:12288
v_mfma_f32_16x16x32_bf16 v[136:139], v[56:59], v[28:31], v[136:139]
ds_read_b64_tr_b16 v[96:97], v12 offset:8192
v_mfma_f32_16x16x32_bf16 v[140:143], v[60:63], v[28:31], v[140:143]
ds_read_b64_tr_b16 v[98:99], v12 offset:12288
v_mfma_f32_16x16x32_bf16 v[144:147], v[64:67], v[28:31], v[144:147]
ds_read_b64_tr_b16 v[100:101], v13 offset:8192
v_mfma_f32_16x16x32_bf16 v[148:151], v[68:71], v[28:31], v[148:151]
ds_read_b64_tr_b16 v[102:103], v13 offset:12288
v_mfma_f32_16x16x32_bf16 v[152:155], v[72:75], v[28:31], v[152:155]
ds_read_b64_tr_b16 v[104:105], v14 offset:8192
v_mfma_f32_16x16x32_bf16 v[184:187], v[72:75], v[32:35], v[184:187]
s_branch Lov_15
.p2align 12
Lst_15_0:
s_branch Lwr_190
s_nop 0
s_nop 0
Lov_15:
ds_read_b64_tr_b16 v[106:107], v14 offset:12288
v_mfma_f32_16x16x32_bf16 v[180:183], v[68:71], v[32:35], v[180:183]
ds_read_b64_tr_b16 v[108:109], v11 offset:24576
v_mfma_f32_16x16x32_bf16 v[176:179], v[64:67], v[32:35], v[176:179]
ds_read_b64_tr_b16 v[110:111], v11 offset:28672
v_mfma_f32_16x16x32_bf16 v[172:175], v[60:63], v[32:35], v[172:175]
ds_read_b64_tr_b16 v[112:113], v12 offset:24576
v_mfma_f32_16x16x32_bf16 v[168:171], v[56:59], v[32:35], v[168:171]
ds_read_b64_tr_b16 v[114:115], v12 offset:28672
v_mfma_f32_16x16x32_bf16 v[164:167], v[52:55], v[32:35], v[164:167]
ds_read_b64_tr_b16 v[116:117], v13 offset:24576
v_mfma_f32_16x16x32_bf16 v[160:163], v[48:51], v[32:35], v[160:163]
ds_read_b64_tr_b16 v[118:119], v13 offset:28672
v_mfma_f32_16x16x32_bf16 v[156:159], v[44:47], v[32:35], v[156:159]
ds_read_b64_tr_b16 v[120:121], v14 offset:24576
v_mfma_f32_16x16x32_bf16 v[188:191], v[44:47], v[36:39], v[188:191]
ds_read_b64_tr_b16 v[122:123], v14 offset:28672
v_mfma_f32_16x16x32_bf16 v[192:195], v[48:51], v[36:39], v[192:195]
ds_read_b128 v[80:83], v9 offset:9216
v_mfma_f32_16x16x32_bf16 v[196:199], v[52:55], v[36:39], v[196:199]
ds_read_b128 v[84:87], v9 offset:10240
v_mfma_f32_16x16x32_bf16 v[200:203], v[56:59], v[36:39], v[200:203]
ds_read_b128 v[88:91], v9 offset:11264
v_mfma_f32_16x16x32_bf16 v[204:207], v[60:63], v[36:39], v[204:207]
v_mfma_f32_16x16x32_bf16 v[208:211], v[64:67], v[36:39], v[208:211]
v_mfma_f32_16x16x32_bf16 v[212:215], v[68:71], v[36:39], v[212:215]
v_mfma_f32_16x16x32_bf16 v[216:219], v[72:75], v[36:39], v[216:219]
v_mfma_f32_16x16x32_bf16 v[248:251], v[72:75], v[40:43], v[248:251]
v_mfma_f32_16x16x32_bf16 v[244:247], v[68:71], v[40:43], v[244:247]
v_mfma_f32_16x16x32_bf16 v[240:243], v[64:67], v[40:43], v[240:243]
v_mfma_f32_16x16x32_bf16 v[236:239], v[60:63], v[40:43], v[236:239]
v_mfma_f32_16x16x32_bf16 v[232:235], v[56:59], v[40:43], v[232:235]
v_mfma_f32_16x16x32_bf16 v[228:231], v[52:55], v[40:43], v[228:231]
v_mfma_f32_16x16x32_bf16 v[224:227], v[48:51], v[40:43], v[224:227]
v_mfma_f32_16x16x32_bf16 v[220:223], v[44:47], v[40:43], v[220:223]
s_waitcnt lgkmcnt(0)
s_barrier
v_mfma_f32_16x16x32_bf16 v[124:127], v[92:95], v[76:79], v[124:127]
ds_read_b128 v[28:31], v9 offset:49152
v_mfma_f32_16x16x32_bf16 v[128:131], v[96:99], v[76:79], v[128:131]
ds_read_b64_tr_b16 v[44:45], v15 offset:0
v_mfma_f32_16x16x32_bf16 v[132:135], v[100:103], v[76:79], v[132:135]
ds_read_b64_tr_b16 v[46:47], v15 offset:4096
v_mfma_f32_16x16x32_bf16 v[136:139], v[104:107], v[76:79], v[136:139]
ds_read_b64_tr_b16 v[48:49], v16 offset:0
v_mfma_f32_16x16x32_bf16 v[140:143], v[108:111], v[76:79], v[140:143]
ds_read_b64_tr_b16 v[50:51], v16 offset:4096
v_mfma_f32_16x16x32_bf16 v[144:147], v[112:115], v[76:79], v[144:147]
ds_read_b64_tr_b16 v[52:53], v17 offset:0
v_mfma_f32_16x16x32_bf16 v[148:151], v[116:119], v[76:79], v[148:151]
ds_read_b64_tr_b16 v[54:55], v17 offset:4096
v_mfma_f32_16x16x32_bf16 v[152:155], v[120:123], v[76:79], v[152:155]
ds_read_b64_tr_b16 v[56:57], v18 offset:0
v_mfma_f32_16x16x32_bf16 v[184:187], v[120:123], v[80:83], v[184:187]
ds_read_b64_tr_b16 v[58:59], v18 offset:4096
v_mfma_f32_16x16x32_bf16 v[180:183], v[116:119], v[80:83], v[180:183]
ds_read_b64_tr_b16 v[60:61], v15 offset:16384
v_mfma_f32_16x16x32_bf16 v[176:179], v[112:115], v[80:83], v[176:179]
ds_read_b64_tr_b16 v[62:63], v15 offset:20480
v_mfma_f32_16x16x32_bf16 v[172:175], v[108:111], v[80:83], v[172:175]
ds_read_b64_tr_b16 v[64:65], v16 offset:16384
v_mfma_f32_16x16x32_bf16 v[168:171], v[104:107], v[80:83], v[168:171]
ds_read_b64_tr_b16 v[66:67], v16 offset:20480
v_mfma_f32_16x16x32_bf16 v[164:167], v[100:103], v[80:83], v[164:167]
ds_read_b64_tr_b16 v[68:69], v17 offset:16384
v_mfma_f32_16x16x32_bf16 v[160:163], v[96:99], v[80:83], v[160:163]
ds_read_b64_tr_b16 v[70:71], v17 offset:20480
v_mfma_f32_16x16x32_bf16 v[156:159], v[92:95], v[80:83], v[156:159]
ds_read_b64_tr_b16 v[72:73], v18 offset:16384
v_mfma_f32_16x16x32_bf16 v[188:191], v[92:95], v[84:87], v[188:191]
ds_read_b64_tr_b16 v[74:75], v18 offset:20480
v_mfma_f32_16x16x32_bf16 v[192:195], v[96:99], v[84:87], v[192:195]
ds_read_b128 v[32:35], v9 offset:50176
v_mfma_f32_16x16x32_bf16 v[196:199], v[100:103], v[84:87], v[196:199]
ds_read_b128 v[36:39], v9 offset:51200
v_mfma_f32_16x16x32_bf16 v[200:203], v[104:107], v[84:87], v[200:203]
ds_read_b128 v[40:43], v9 offset:52224
v_mfma_f32_16x16x32_bf16 v[204:207], v[108:111], v[84:87], v[204:207]
v_mfma_f32_16x16x32_bf16 v[208:211], v[112:115], v[84:87], v[208:211]
v_mfma_f32_16x16x32_bf16 v[212:215], v[116:119], v[84:87], v[212:215]
v_mfma_f32_16x16x32_bf16 v[216:219], v[120:123], v[84:87], v[216:219]
v_mfma_f32_16x16x32_bf16 v[248:251], v[120:123], v[88:91], v[248:251]
v_mfma_f32_16x16x32_bf16 v[244:247], v[116:119], v[88:91], v[244:247]
v_mfma_f32_16x16x32_bf16 v[240:243], v[112:115], v[88:91], v[240:243]
v_mfma_f32_16x16x32_bf16 v[236:239], v[108:111], v[88:91], v[236:239]
v_mfma_f32_16x16x32_bf16 v[232:235], v[104:107], v[88:91], v[232:235]
v_mfma_f32_16x16x32_bf16 v[228:231], v[100:103], v[88:91], v[228:231]
v_mfma_f32_16x16x32_bf16 v[224:227], v[96:99], v[88:91], v[224:227]
v_mfma_f32_16x16x32_bf16 v[220:223], v[92:95], v[88:91], v[220:223]
s_waitcnt lgkmcnt(0)
v_mfma_f32_16x16x32_bf16 v[124:127], v[44:47], v[28:31], v[124:127]
ds_read_b128 v[76:79], v9 offset:57344
v_mfma_f32_16x16x32_bf16 v[128:131], v[48:51], v[28:31], v[128:131]
ds_read_b64_tr_b16 v[92:93], v15 offset:8192
v_mfma_f32_16x16x32_bf16 v[132:135], v[52:55], v[28:31], v[132:135]
ds_read_b64_tr_b16 v[94:95], v15 offset:12288
v_mfma_f32_16x16x32_bf16 v[136:139], v[56:59], v[28:31], v[136:139]
ds_read_b64_tr_b16 v[96:97], v16 offset:8192
v_mfma_f32_16x16x32_bf16 v[140:143], v[60:63], v[28:31], v[140:143]
ds_read_b64_tr_b16 v[98:99], v16 offset:12288
v_mfma_f32_16x16x32_bf16 v[144:147], v[64:67], v[28:31], v[144:147]
ds_read_b64_tr_b16 v[100:101], v17 offset:8192
v_mfma_f32_16x16x32_bf16 v[148:151], v[68:71], v[28:31], v[148:151]
ds_read_b64_tr_b16 v[102:103], v17 offset:12288
v_mfma_f32_16x16x32_bf16 v[152:155], v[72:75], v[28:31], v[152:155]
ds_read_b64_tr_b16 v[104:105], v18 offset:8192
v_mfma_f32_16x16x32_bf16 v[184:187], v[72:75], v[32:35], v[184:187]
ds_read_b64_tr_b16 v[106:107], v18 offset:12288
v_mfma_f32_16x16x32_bf16 v[180:183], v[68:71], v[32:35], v[180:183]
ds_read_b64_tr_b16 v[108:109], v15 offset:24576
v_mfma_f32_16x16x32_bf16 v[176:179], v[64:67], v[32:35], v[176:179]
ds_read_b64_tr_b16 v[110:111], v15 offset:28672
v_mfma_f32_16x16x32_bf16 v[172:175], v[60:63], v[32:35], v[172:175]
ds_read_b64_tr_b16 v[112:113], v16 offset:24576
v_mfma_f32_16x16x32_bf16 v[168:171], v[56:59], v[32:35], v[168:171]
ds_read_b64_tr_b16 v[114:115], v16 offset:28672
v_mfma_f32_16x16x32_bf16 v[164:167], v[52:55], v[32:35], v[164:167]
ds_read_b64_tr_b16 v[116:117], v17 offset:24576
v_mfma_f32_16x16x32_bf16 v[160:163], v[48:51], v[32:35], v[160:163]
ds_read_b64_tr_b16 v[118:119], v17 offset:28672
v_mfma_f32_16x16x32_bf16 v[156:159], v[44:47], v[32:35], v[156:159]
ds_read_b64_tr_b16 v[120:121], v18 offset:24576
v_mfma_f32_16x16x32_bf16 v[188:191], v[44:47], v[36:39], v[188:191]
ds_read_b64_tr_b16 v[122:123], v18 offset:28672
v_mfma_f32_16x16x32_bf16 v[192:195], v[48:51], v[36:39], v[192:195]
ds_read_b128 v[80:83], v9 offset:58368
v_mfma_f32_16x16x32_bf16 v[196:199], v[52:55], v[36:39], v[196:199]
ds_read_b128 v[84:87], v9 offset:59392
v_mfma_f32_16x16x32_bf16 v[200:203], v[56:59], v[36:39], v[200:203]
ds_read_b128 v[88:91], v9 offset:60416
v_mfma_f32_16x16x32_bf16 v[204:207], v[60:63], v[36:39], v[204:207]
v_mfma_f32_16x16x32_bf16 v[208:211], v[64:67], v[36:39], v[208:211]
v_mfma_f32_16x16x32_bf16 v[212:215], v[68:71], v[36:39], v[212:215]
v_mfma_f32_16x16x32_bf16 v[216:219], v[72:75], v[36:39], v[216:219]
v_mfma_f32_16x16x32_bf16 v[248:251], v[72:75], v[40:43], v[248:251]
v_mfma_f32_16x16x32_bf16 v[244:247], v[68:71], v[40:43], v[244:247]
v_mfma_f32_16x16x32_bf16 v[240:243], v[64:67], v[40:43], v[240:243]
v_mfma_f32_16x16x32_bf16 v[236:239], v[60:63], v[40:43], v[236:239]
v_mfma_f32_16x16x32_bf16 v[232:235], v[56:59], v[40:43], v[232:235]
v_mfma_f32_16x16x32_bf16 v[228:231], v[52:55], v[40:43], v[228:231]
v_mfma_f32_16x16x32_bf16 v[224:227], v[48:51], v[40:43], v[224:227]
v_mfma_f32_16x16x32_bf16 v[220:223], v[44:47], v[40:43], v[220:223]
s_waitcnt lgkmcnt(0)
s_barrier
v_mfma_f32_16x16x32_bf16 v[124:127], v[92:95], v[76:79], v[124:127]
ds_read_b128 v[28:31], v10 offset:0
v_mfma_f32_16x16x32_bf16 v[128:131], v[96:99], v[76:79], v[128:131]
ds_read_b64_tr_b16 v[44:45], v19 offset:0
v_mfma_f32_16x16x32_bf16 v[132:135], v[100:103], v[76:79], v[132:135]
ds_read_b64_tr_b16 v[46:47], v19 offset:4096
v_mfma_f32_16x16x32_bf16 v[136:139], v[104:107], v[76:79], v[136:139]
ds_read_b64_tr_b16 v[48:49], v20 offset:0
v_mfma_f32_16x16x32_bf16 v[140:143], v[108:111], v[76:79], v[140:143]
ds_read_b64_tr_b16 v[50:51], v20 offset:4096
v_mfma_f32_16x16x32_bf16 v[144:147], v[112:115], v[76:79], v[144:147]
ds_read_b64_tr_b16 v[52:53], v21 offset:0
v_mfma_f32_16x16x32_bf16 v[148:151], v[116:119], v[76:79], v[148:151]
ds_read_b64_tr_b16 v[54:55], v21 offset:4096
v_mfma_f32_16x16x32_bf16 v[152:155], v[120:123], v[76:79], v[152:155]
ds_read_b64_tr_b16 v[56:57], v22 offset:0
v_mfma_f32_16x16x32_bf16 v[184:187], v[120:123], v[80:83], v[184:187]
ds_read_b64_tr_b16 v[58:59], v22 offset:4096
v_mfma_f32_16x16x32_bf16 v[180:183], v[116:119], v[80:83], v[180:183]
ds_read_b64_tr_b16 v[60:61], v19 offset:16384
v_mfma_f32_16x16x32_bf16 v[176:179], v[112:115], v[80:83], v[176:179]
ds_read_b64_tr_b16 v[62:63], v19 offset:20480
v_mfma_f32_16x16x32_bf16 v[172:175], v[108:111], v[80:83], v[172:175]
ds_read_b64_tr_b16 v[64:65], v20 offset:16384
v_mfma_f32_16x16x32_bf16 v[168:171], v[104:107], v[80:83], v[168:171]
ds_read_b64_tr_b16 v[66:67], v20 offset:20480
v_mfma_f32_16x16x32_bf16 v[164:167], v[100:103], v[80:83], v[164:167]
ds_read_b64_tr_b16 v[68:69], v21 offset:16384
v_mfma_f32_16x16x32_bf16 v[160:163], v[96:99], v[80:83], v[160:163]
ds_read_b64_tr_b16 v[70:71], v21 offset:20480
v_mfma_f32_16x16x32_bf16 v[156:159], v[92:95], v[80:83], v[156:159]
ds_read_b64_tr_b16 v[72:73], v22 offset:16384
v_mfma_f32_16x16x32_bf16 v[188:191], v[92:95], v[84:87], v[188:191]
ds_read_b64_tr_b16 v[74:75], v22 offset:20480
v_mfma_f32_16x16x32_bf16 v[192:195], v[96:99], v[84:87], v[192:195]
ds_read_b128 v[32:35], v10 offset:1024
v_mfma_f32_16x16x32_bf16 v[196:199], v[100:103], v[84:87], v[196:199]
ds_read_b128 v[36:39], v10 offset:2048
v_mfma_f32_16x16x32_bf16 v[200:203], v[104:107], v[84:87], v[200:203]
ds_read_b128 v[40:43], v10 offset:3072
v_mfma_f32_16x16x32_bf16 v[204:207], v[108:111], v[84:87], v[204:207]
v_mfma_f32_16x16x32_bf16 v[208:211], v[112:115], v[84:87], v[208:211]
v_mfma_f32_16x16x32_bf16 v[212:215], v[116:119], v[84:87], v[212:215]
v_mfma_f32_16x16x32_bf16 v[216:219], v[120:123], v[84:87], v[216:219]
v_mfma_f32_16x16x32_bf16 v[248:251], v[120:123], v[88:91], v[248:251]
v_mfma_f32_16x16x32_bf16 v[244:247], v[116:119], v[88:91], v[244:247]
v_mfma_f32_16x16x32_bf16 v[240:243], v[112:115], v[88:91], v[240:243]
v_mfma_f32_16x16x32_bf16 v[236:239], v[108:111], v[88:91], v[236:239]
v_mfma_f32_16x16x32_bf16 v[232:235], v[104:107], v[88:91], v[232:235]
v_mfma_f32_16x16x32_bf16 v[228:231], v[100:103], v[88:91], v[228:231]
v_mfma_f32_16x16x32_bf16 v[224:227], v[96:99], v[88:91], v[224:227]
v_mfma_f32_16x16x32_bf16 v[220:223], v[92:95], v[88:91], v[220:223]
s_sub_u32 s41, s41, 1
s_cmp_lg_u32 s41, 0
s_cbranch_scc1 Lk3l_154
s_waitcnt lgkmcnt(0)
v_lshrrev_b32 v84, 4, v1
s_lshl_b32 s43, s63, 8
s_add_u32 s43, s43, 148480
v_lshl_add_u32 v85, v84, 4, s43
v_and_b32 v84, 15, v1
s_lshl_b32 s43, s62, 9
s_add_u32 s43, s43, 147456
v_lshl_add_u32 v84, v84, 3, s43
ds_read_b128 v[28:31], v85 offset:0
ds_read_b128 v[32:35], v85 offset:64
ds_read_b128 v[36:39], v85 offset:128
ds_read_b128 v[40:43], v85 offset:192
ds_read_b128 v[44:47], v85 offset:896
ds_read_b128 v[48:51], v85 offset:960
ds_read_b128 v[52:55], v85 offset:1024
ds_read_b128 v[56:59], v85 offset:1088
ds_read_b64 v[60:61], v84 offset:0
ds_read_b64 v[62:63], v84 offset:128
ds_read_b64 v[64:65], v84 offset:256
ds_read_b64 v[66:67], v84 offset:384
s_lshl_b32 s54, s35, 15
s_lshl_b32 s43, s63, 14
s_add_u32 s54, s54, s43
s_lshl_b32 s43, s62, 12
s_add_u32 s54, s54, s43
s_add_u32 s55, s54, 8192
v_lshrrev_b32 v122, 3, v1
v_and_b32 v123, 6, v122
v_and_b32 v25, 7, v1
v_xor_b32 v25, v25, v123
v_lshlrev_b32 v25, 4, v25
v_mul_u32_u24 v122, 2048, v122
v_add_u32 v25, v25, v122
s_lshl_b32 s43, s61, 7
s_lshl_b32 s44, s47, 15
s_add_u32 s43, s43, s44
v_add_u32 v25, s43, v25
s_waitcnt lgkmcnt(0)
s_barrier
s_add_u32 m0, s39, 81920
s_add_u32 s37, s52, 589824
buffer_load_dwordx4 v3, s[24:27], s37 offen sc1 lds
v_mul_f32 v70, v61, v61
v_mul_f32 v68, 0xc0135761, v61
v_mul_f32 v69, 0xbdd2d3e8, v61
v_mul_f32 v69, v69, v70
v_rcp_f32 v70, v70
v_mul_f32 v74, v63, v63
v_mul_f32 v72, 0xc0135761, v63
v_mul_f32 v73, 0xbdd2d3e8, v63
v_mul_f32 v73, v73, v74
v_rcp_f32 v74, v74
buffer_load_dwordx4 v3, s[24:27], s37 offen offset:1024 sc1 lds
v_fma_f32 v124, -v60, v28, v124
v_fma_f32 v125, -v60, v29, v125
v_fma_f32 v126, -v60, v30, v126
v_fma_f32 v127, -v60, v31, v127
v_fma_f32 v156, -v62, v28, v156
v_fma_f32 v157, -v62, v29, v157
v_fma_f32 v158, -v62, v30, v158
v_fma_f32 v159, -v62, v31, v159
v_mul_f32 v76, v124, v124
v_mul_f32 v77, v125, v125
buffer_load_dwordx4 v3, s[24:27], s37 offen offset:2048 sc1 lds
v_mul_f32 v78, v126, v126
v_mul_f32 v79, v127, v127
v_mul_f32 v80, v156, v156
v_mul_f32 v81, v157, v157
v_mul_f32 v82, v158, v158
v_mul_f32 v83, v159, v159
v_fma_f32 v76, v76, v69, v68
v_fma_f32 v77, v77, v69, v68
v_fma_f32 v78, v78, v69, v68
v_fma_f32 v79, v79, v69, v68
buffer_load_dwordx4 v3, s[24:27], s37 offen offset:3072 sc1 lds
v_fma_f32 v80, v80, v73, v72
v_fma_f32 v81, v81, v73, v72
v_fma_f32 v82, v82, v73, v72
v_fma_f32 v83, v83, v73, v72
v_mul_f32 v76, v76, v124
v_mul_f32 v77, v77, v125
v_mul_f32 v78, v78, v126
v_mul_f32 v79, v79, v127
v_mul_f32 v80, v80, v156
v_mul_f32 v81, v81, v157
s_add_u32 m0, s39, 147456
s_add_u32 s38, s53, 4718592
buffer_load_dwordx4 v23, s[28:31], s38 offen lds
v_mul_f32 v82, v82, v158
v_mul_f32 v83, v83, v159
v_exp_f32 v76, v76
v_exp_f32 v77, v77
v_exp_f32 v78, v78
v_exp_f32 v79, v79
v_exp_f32 v80, v80
v_exp_f32 v81, v81
v_exp_f32 v82, v82
v_exp_f32 v83, v83
s_add_u32 m0, s39, 148480
s_add_u32 s38, s53, 4718592
buffer_load_dwordx4 v24, s[28:31], s38 offen lds
v_fma_f32 v140, -v60, v44, v140
v_fma_f32 v141, -v60, v45, v141
v_fma_f32 v142, -v60, v46, v142
v_fma_f32 v143, -v60, v47, v143
v_fma_f32 v172, -v62, v44, v172
v_fma_f32 v173, -v62, v45, v173
v_fma_f32 v174, -v62, v46, v174
v_fma_f32 v175, -v62, v47, v175
v_fma_f32 v76, v76, v70, v70
v_fma_f32 v77, v77, v70, v70
s_add_u32 m0, s39, 149504
s_add_u32 s38, s53, 4734976
buffer_load_dwordx4 v23, s[28:31], s38 offen lds
v_fma_f32 v78, v78, v70, v70
v_fma_f32 v79, v79, v70, v70
v_fma_f32 v80, v80, v74, v74
v_fma_f32 v81, v81, v74, v74
v_fma_f32 v82, v82, v74, v74
v_fma_f32 v83, v83, v74, v74
v_rcp_f32 v76, v76
v_rcp_f32 v77, v77
v_rcp_f32 v78, v78
v_rcp_f32 v79, v79
s_add_u32 m0, s39, 150528
s_add_u32 s38, s53, 4734976
buffer_load_dwordx4 v24, s[28:31], s38 offen lds
v_rcp_f32 v80, v80
v_rcp_f32 v81, v81
v_rcp_f32 v82, v82
v_rcp_f32 v83, v83
v_mul_f32 v140, v124, v140
v_mul_f32 v141, v125, v141
v_mul_f32 v142, v126, v142
v_mul_f32 v143, v127, v143
v_mul_f32 v172, v156, v172
v_mul_f32 v173, v157, v173
s_add_u32 m0, s39, 98304
s_add_u32 s37, s52, 606208
buffer_load_dwordx4 v3, s[24:27], s37 offen sc1 lds
v_mul_f32 v174, v158, v174
v_mul_f32 v175, v159, v175
v_mul_f32 v140, v140, v76
v_mul_f32 v141, v141, v77
v_mul_f32 v142, v142, v78
v_mul_f32 v143, v143, v79
v_mul_f32 v172, v172, v80
v_mul_f32 v173, v173, v81
v_mul_f32 v174, v174, v82
v_mul_f32 v175, v175, v83
buffer_load_dwordx4 v3, s[24:27], s37 offen offset:1024 sc1 lds
v_cvt_pk_bf16_f32 v124, v140, v141
v_cvt_pk_bf16_f32 v125, v142, v143
v_cvt_pk_bf16_f32 v156, v172, v173
v_cvt_pk_bf16_f32 v157, v174, v175
v_fma_f32 v128, -v60, v32, v128
v_fma_f32 v129, -v60, v33, v129
v_fma_f32 v130, -v60, v34, v130
v_fma_f32 v131, -v60, v35, v131
v_fma_f32 v160, -v62, v32, v160
v_fma_f32 v161, -v62, v33, v161
buffer_load_dwordx4 v3, s[24:27], s37 offen offset:2048 sc1 lds
v_fma_f32 v162, -v62, v34, v162
v_fma_f32 v163, -v62, v35, v163
v_mul_f32 v76, v128, v128
v_mul_f32 v77, v129, v129
v_mul_f32 v78, v130, v130
v_mul_f32 v79, v131, v131
v_mul_f32 v80, v160, v160
v_mul_f32 v81, v161, v161
v_mul_f32 v82, v162, v162
v_mul_f32 v83, v163, v163
buffer_load_dwordx4 v3, s[24:27], s37 offen offset:3072 sc1 lds
v_fma_f32 v76, v76, v69, v68
v_fma_f32 v77, v77, v69, v68
v_fma_f32 v78, v78, v69, v68
v_fma_f32 v79, v79, v69, v68
v_fma_f32 v80, v80, v73, v72
v_fma_f32 v81, v81, v73, v72
v_fma_f32 v82, v82, v73, v72
v_fma_f32 v83, v83, v73, v72
v_mul_f32 v76, v76, v128
v_mul_f32 v77, v77, v129
s_add_u32 m0, s39, 114688
s_add_u32 s38, s53, 4849664
buffer_load_dwordx4 v23, s[28:31], s38 offen lds
v_mul_f32 v78, v78, v130
v_mul_f32 v79, v79, v131
v_mul_f32 v80, v80, v160
v_mul_f32 v81, v81, v161
v_mul_f32 v82, v82, v162
v_mul_f32 v83, v83, v163
v_exp_f32 v76, v76
v_exp_f32 v77, v77
v_exp_f32 v78, v78
v_exp_f32 v79, v79
s_add_u32 m0, s39, 115712
s_add_u32 s38, s53, 4849664
buffer_load_dwordx4 v24, s[28:31], s38 offen lds
v_exp_f32 v80, v80
v_exp_f32 v81, v81
v_exp_f32 v82, v82
v_exp_f32 v83, v83
v_fma_f32 v144, -v60, v48, v144
v_fma_f32 v145, -v60, v49, v145
v_fma_f32 v146, -v60, v50, v146
v_fma_f32 v147, -v60, v51, v147
v_fma_f32 v176, -v62, v48, v176
v_fma_f32 v177, -v62, v49, v177
s_add_u32 m0, s39, 116736
s_add_u32 s38, s53, 4866048
buffer_load_dwordx4 v23, s[28:31], s38 offen lds
s_add_u32 m0, s39, 117760
s_add_u32 s38, s53, 4866048
buffer_load_dwordx4 v24, s[28:31], s38 offen lds
s_barrier
s_add_u32 m0, s39, 131072
s_add_u32 s37, s52, 622592
buffer_load_dwordx4 v3, s[24:27], s37 offen sc1 lds
v_fma_f32 v178, -v62, v50, v178
v_fma_f32 v179, -v62, v51, v179
v_fma_f32 v76, v76, v70, v70
v_fma_f32 v77, v77, v70, v70
v_fma_f32 v78, v78, v70, v70
v_fma_f32 v79, v79, v70, v70
v_fma_f32 v80, v80, v74, v74
v_fma_f32 v81, v81, v74, v74
v_fma_f32 v82, v82, v74, v74
v_fma_f32 v83, v83, v74, v74
v_rcp_f32 v76, v76
v_rcp_f32 v77, v77
v_rcp_f32 v78, v78
v_rcp_f32 v79, v79
v_rcp_f32 v80, v80
v_rcp_f32 v81, v81
v_rcp_f32 v82, v82
v_rcp_f32 v83, v83
v_mul_f32 v144, v128, v144
v_mul_f32 v145, v129, v145
v_mul_f32 v146, v130, v146
v_mul_f32 v147, v131, v147
v_mul_f32 v176, v160, v176
buffer_load_dwordx4 v3, s[24:27], s37 offen offset:1024 sc1 lds
v_mul_f32 v177, v161, v177
v_mul_f32 v178, v162, v178
v_mul_f32 v179, v163, v179
v_mul_f32 v144, v144, v76
v_mul_f32 v145, v145, v77
v_mul_f32 v146, v146, v78
v_mul_f32 v147, v147, v79
v_mul_f32 v176, v176, v80
v_mul_f32 v177, v177, v81
v_mul_f32 v178, v178, v82
v_mul_f32 v179, v179, v83
v_cvt_pk_bf16_f32 v126, v144, v145
v_cvt_pk_bf16_f32 v127, v146, v147
v_cvt_pk_bf16_f32 v158, v176, v177
v_cvt_pk_bf16_f32 v159, v178, v179
buffer_store_dwordx4 v[124:127], v2, s[24:27], s54 offen offset:0 sc1
buffer_store_dwordx4 v[156:159], v2, s[24:27], s54 offen offset:1024 sc1
v_fma_f32 v132, -v60, v36, v132
v_fma_f32 v133, -v60, v37, v133
v_fma_f32 v134, -v60, v38, v134
v_fma_f32 v135, -v60, v39, v135
v_fma_f32 v164, -v62, v36, v164
v_fma_f32 v165, -v62, v37, v165
buffer_load_dwordx4 v3, s[24:27], s37 offen offset:2048 sc1 lds
v_fma_f32 v166, -v62, v38, v166
v_fma_f32 v167, -v62, v39, v167
v_mul_f32 v76, v132, v132
v_mul_f32 v77, v133, v133
v_mul_f32 v78, v134, v134
v_mul_f32 v79, v135, v135
v_mul_f32 v80, v164, v164
v_mul_f32 v81, v165, v165
v_mul_f32 v82, v166, v166
v_mul_f32 v83, v167, v167
v_fma_f32 v76, v76, v69, v68
v_fma_f32 v77, v77, v69, v68
v_fma_f32 v78, v78, v69, v68
v_fma_f32 v79, v79, v69, v68
v_fma_f32 v80, v80, v73, v72
v_fma_f32 v81, v81, v73, v72
v_fma_f32 v82, v82, v73, v72
v_fma_f32 v83, v83, v73, v72
v_mul_f32 v76, v76, v132
v_mul_f32 v77, v77, v133
v_mul_f32 v78, v78, v134
v_mul_f32 v79, v79, v135
v_mul_f32 v80, v80, v164
v_mul_f32 v81, v81, v165
buffer_load_dwordx4 v3, s[24:27], s37 offen offset:3072 sc1 lds
v_mul_f32 v82, v82, v166
v_mul_f32 v83, v83, v167
v_exp_f32 v76, v76
v_exp_f32 v77, v77
v_exp_f32 v78, v78
v_exp_f32 v79, v79
v_exp_f32 v80, v80
v_exp_f32 v81, v81
v_exp_f32 v82, v82
v_exp_f32 v83, v83
v_fma_f32 v148, -v60, v52, v148
v_fma_f32 v149, -v60, v53, v149
v_fma_f32 v150, -v60, v54, v150
v_fma_f32 v151, -v60, v55, v151
v_fma_f32 v180, -v62, v52, v180
v_fma_f32 v181, -v62, v53, v181
v_fma_f32 v182, -v62, v54, v182
v_fma_f32 v183, -v62, v55, v183
v_fma_f32 v76, v76, v70, v70
v_fma_f32 v77, v77, v70, v70
v_fma_f32 v78, v78, v70, v70
v_fma_f32 v79, v79, v70, v70
v_fma_f32 v80, v80, v74, v74
s_add_u32 m0, s39, 0
s_add_u32 s38, s53, 4980736
buffer_load_dwordx4 v23, s[28:31], s38 offen lds
v_fma_f32 v81, v81, v74, v74
v_fma_f32 v82, v82, v74, v74
v_fma_f32 v83, v83, v74, v74
v_rcp_f32 v76, v76
v_rcp_f32 v77, v77
v_rcp_f32 v78, v78
v_rcp_f32 v79, v79
v_rcp_f32 v80, v80
v_rcp_f32 v81, v81
v_rcp_f32 v82, v82
v_rcp_f32 v83, v83
v_mul_f32 v148, v132, v148
v_mul_f32 v149, v133, v149
v_mul_f32 v150, v134, v150
v_mul_f32 v151, v135, v151
v_mul_f32 v180, v164, v180
v_mul_f32 v181, v165, v181
v_mul_f32 v182, v166, v182
v_mul_f32 v183, v167, v183
v_mul_f32 v148, v148, v76
v_mul_f32 v149, v149, v77
v_mul_f32 v150, v150, v78
v_mul_f32 v151, v151, v79
s_add_u32 m0, s39, 1024
s_add_u32 s38, s53, 4980736
buffer_load_dwordx4 v24, s[28:31], s38 offen lds
v_mul_f32 v180, v180, v80
v_mul_f32 v181, v181, v81
v_mul_f32 v182, v182, v82
v_mul_f32 v183, v183, v83
v_cvt_pk_bf16_f32 v132, v148, v149
v_cvt_pk_bf16_f32 v133, v150, v151
v_cvt_pk_bf16_f32 v164, v180, v181
v_cvt_pk_bf16_f32 v165, v182, v183
v_fma_f32 v136, -v60, v40, v136
v_fma_f32 v137, -v60, v41, v137
v_fma_f32 v138, -v60, v42, v138
v_fma_f32 v139, -v60, v43, v139
v_fma_f32 v168, -v62, v40, v168
v_fma_f32 v169, -v62, v41, v169
v_fma_f32 v170, -v62, v42, v170
v_fma_f32 v171, -v62, v43, v171
v_mul_f32 v76, v136, v136
v_mul_f32 v77, v137, v137
v_mul_f32 v78, v138, v138
v_mul_f32 v79, v139, v139
v_mul_f32 v80, v168, v168
v_mul_f32 v81, v169, v169
v_mul_f32 v82, v170, v170
v_mul_f32 v83, v171, v171
s_add_u32 m0, s39, 2048
s_add_u32 s38, s53, 4997120
buffer_load_dwordx4 v23, s[28:31], s38 offen lds
s_add_u32 m0, s39, 3072
s_add_u32 s38, s53, 4997120
buffer_load_dwordx4 v24, s[28:31], s38 offen lds
s_barrier
s_add_u32 m0, s39, 16384
s_add_u32 s37, s52, 638976
buffer_load_dwordx4 v3, s[24:27], s37 offen sc1 lds
v_fma_f32 v76, v76, v69, v68
v_fma_f32 v77, v77, v69, v68
v_fma_f32 v78, v78, v69, v68
v_fma_f32 v79, v79, v69, v68
v_fma_f32 v80, v80, v73, v72
v_fma_f32 v81, v81, v73, v72
v_fma_f32 v82, v82, v73, v72
v_fma_f32 v83, v83, v73, v72
v_mul_f32 v76, v76, v136
v_mul_f32 v77, v77, v137
v_mul_f32 v78, v78, v138
v_mul_f32 v79, v79, v139
v_mul_f32 v80, v80, v168
v_mul_f32 v81, v81, v169
v_mul_f32 v82, v82, v170
v_mul_f32 v83, v83, v171
v_exp_f32 v76, v76
v_exp_f32 v77, v77
v_exp_f32 v78, v78
v_exp_f32 v79, v79
v_exp_f32 v80, v80
v_exp_f32 v81, v81
v_exp_f32 v82, v82
buffer_load_dwordx4 v3, s[24:27], s37 offen offset:1024 sc1 lds
v_exp_f32 v83, v83
v_fma_f32 v152, -v60, v56, v152
v_fma_f32 v153, -v60, v57, v153
v_fma_f32 v154, -v60, v58, v154
v_fma_f32 v155, -v60, v59, v155
v_fma_f32 v184, -v62, v56, v184
v_fma_f32 v185, -v62, v57, v185
v_fma_f32 v186, -v62, v58, v186
v_fma_f32 v187, -v62, v59, v187
v_fma_f32 v76, v76, v70, v70
v_fma_f32 v77, v77, v70, v70
s_branch Lov_16
.p2align 12
Lst_16_0:
s_branch Lwr_191
s_nop 0
s_nop 0
Lov_16:
v_fma_f32 v78, v78, v70, v70
v_fma_f32 v79, v79, v70, v70
v_fma_f32 v80, v80, v74, v74
v_fma_f32 v81, v81, v74, v74
v_fma_f32 v82, v82, v74, v74
v_fma_f32 v83, v83, v74, v74
v_rcp_f32 v76, v76
v_rcp_f32 v77, v77
v_rcp_f32 v78, v78
v_rcp_f32 v79, v79
v_rcp_f32 v80, v80
v_rcp_f32 v81, v81
buffer_load_dwordx4 v3, s[24:27], s37 offen offset:2048 sc1 lds
v_rcp_f32 v82, v82
v_rcp_f32 v83, v83
v_mul_f32 v152, v136, v152
v_mul_f32 v153, v137, v153
v_mul_f32 v154, v138, v154
v_mul_f32 v155, v139, v155
v_mul_f32 v184, v168, v184
v_mul_f32 v185, v169, v185
v_mul_f32 v186, v170, v186
v_mul_f32 v187, v171, v187
v_mul_f32 v152, v152, v76
v_mul_f32 v153, v153, v77
v_mul_f32 v154, v154, v78
v_mul_f32 v155, v155, v79
v_mul_f32 v184, v184, v80
v_mul_f32 v185, v185, v81
v_mul_f32 v186, v186, v82
v_mul_f32 v187, v187, v83
v_cvt_pk_bf16_f32 v134, v152, v153
v_cvt_pk_bf16_f32 v135, v154, v155
v_cvt_pk_bf16_f32 v166, v184, v185
v_cvt_pk_bf16_f32 v167, v186, v187
buffer_store_dwordx4 v[132:135], v2, s[24:27], s55 offen offset:0 sc1
buffer_store_dwordx4 v[164:167], v2, s[24:27], s55 offen offset:1024 sc1
buffer_load_dwordx4 v3, s[24:27], s37 offen offset:3072 sc1 lds
v_mul_f32 v70, v65, v65
v_mul_f32 v68, 0xc0135761, v65
v_mul_f32 v69, 0xbdd2d3e8, v65
v_mul_f32 v69, v69, v70
v_rcp_f32 v70, v70
v_mul_f32 v74, v67, v67
v_mul_f32 v72, 0xc0135761, v67
v_mul_f32 v73, 0xbdd2d3e8, v67
v_mul_f32 v73, v73, v74
v_rcp_f32 v74, v74
v_fma_f32 v188, -v64, v28, v188
v_fma_f32 v189, -v64, v29, v189
v_fma_f32 v190, -v64, v30, v190
v_fma_f32 v191, -v64, v31, v191
v_fma_f32 v220, -v66, v28, v220
v_fma_f32 v221, -v66, v29, v221
v_fma_f32 v222, -v66, v30, v222
v_fma_f32 v223, -v66, v31, v223
v_mul_f32 v76, v188, v188
v_mul_f32 v77, v189, v189
v_mul_f32 v78, v190, v190
v_mul_f32 v79, v191, v191
v_mul_f32 v80, v220, v220
s_add_u32 m0, s39, 32768
s_add_u32 s38, s53, 5111808
buffer_load_dwordx4 v23, s[28:31], s38 offen lds
v_mul_f32 v81, v221, v221
v_mul_f32 v82, v222, v222
v_mul_f32 v83, v223, v223
v_fma_f32 v76, v76, v69, v68
v_fma_f32 v77, v77, v69, v68
v_fma_f32 v78, v78, v69, v68
v_fma_f32 v79, v79, v69, v68
v_fma_f32 v80, v80, v73, v72
v_fma_f32 v81, v81, v73, v72
v_fma_f32 v82, v82, v73, v72
v_fma_f32 v83, v83, v73, v72
v_mul_f32 v76, v76, v188
v_mul_f32 v77, v77, v189
v_mul_f32 v78, v78, v190
v_mul_f32 v79, v79, v191
v_mul_f32 v80, v80, v220
v_mul_f32 v81, v81, v221
v_mul_f32 v82, v82, v222
v_mul_f32 v83, v83, v223
v_exp_f32 v76, v76
v_exp_f32 v77, v77
v_exp_f32 v78, v78
v_exp_f32 v79, v79
s_add_u32 m0, s39, 33792
s_add_u32 s38, s53, 5111808
buffer_load_dwordx4 v24, s[28:31], s38 offen lds
v_exp_f32 v80, v80
v_exp_f32 v81, v81
v_exp_f32 v82, v82
v_exp_f32 v83, v83
v_fma_f32 v204, -v64, v44, v204
v_fma_f32 v205, -v64, v45, v205
v_fma_f32 v206, -v64, v46, v206
v_fma_f32 v207, -v64, v47, v207
v_fma_f32 v236, -v66, v44, v236
v_fma_f32 v237, -v66, v45, v237
v_fma_f32 v238, -v66, v46, v238
v_fma_f32 v239, -v66, v47, v239
v_fma_f32 v76, v76, v70, v70
v_fma_f32 v77, v77, v70, v70
v_fma_f32 v78, v78, v70, v70
v_fma_f32 v79, v79, v70, v70
v_fma_f32 v80, v80, v74, v74
v_fma_f32 v81, v81, v74, v74
v_fma_f32 v82, v82, v74, v74
v_fma_f32 v83, v83, v74, v74
v_rcp_f32 v76, v76
v_rcp_f32 v77, v77
v_rcp_f32 v78, v78
v_rcp_f32 v79, v79
s_add_u32 m0, s39, 34816
s_add_u32 s38, s53, 5128192
buffer_load_dwordx4 v23, s[28:31], s38 offen lds
s_add_u32 m0, s39, 35840
s_add_u32 s38, s53, 5128192
buffer_load_dwordx4 v24, s[28:31], s38 offen lds
s_waitcnt vmcnt(28)
s_barrier
s_add_u32 m0, s39, 49152
s_add_u32 s37, s52, 655360
buffer_load_dwordx4 v3, s[24:27], s37 offen sc1 lds
v_rcp_f32 v80, v80
v_rcp_f32 v81, v81
v_rcp_f32 v82, v82
v_rcp_f32 v83, v83
v_mul_f32 v204, v188, v204
v_mul_f32 v205, v189, v205
v_mul_f32 v206, v190, v206
v_mul_f32 v207, v191, v207
v_mul_f32 v236, v220, v236
v_mul_f32 v237, v221, v237
v_mul_f32 v238, v222, v238
v_mul_f32 v239, v223, v239
v_mul_f32 v204, v204, v76
v_mul_f32 v205, v205, v77
v_mul_f32 v206, v206, v78
v_mul_f32 v207, v207, v79
v_mul_f32 v236, v236, v80
v_mul_f32 v237, v237, v81
v_mul_f32 v238, v238, v82
v_mul_f32 v239, v239, v83
v_cvt_pk_bf16_f32 v188, v204, v205
v_cvt_pk_bf16_f32 v189, v206, v207
v_cvt_pk_bf16_f32 v220, v236, v237
buffer_load_dwordx4 v3, s[24:27], s37 offen offset:1024 sc1 lds
v_cvt_pk_bf16_f32 v221, v238, v239
v_fma_f32 v192, -v64, v32, v192
v_fma_f32 v193, -v64, v33, v193
v_fma_f32 v194, -v64, v34, v194
v_fma_f32 v195, -v64, v35, v195
v_fma_f32 v224, -v66, v32, v224
v_fma_f32 v225, -v66, v33, v225
v_fma_f32 v226, -v66, v34, v226
v_fma_f32 v227, -v66, v35, v227
v_mul_f32 v76, v192, v192
v_mul_f32 v77, v193, v193
v_mul_f32 v78, v194, v194
v_mul_f32 v79, v195, v195
v_mul_f32 v80, v224, v224
v_mul_f32 v81, v225, v225
v_mul_f32 v82, v226, v226
v_mul_f32 v83, v227, v227
v_fma_f32 v76, v76, v69, v68
v_fma_f32 v77, v77, v69, v68
v_fma_f32 v78, v78, v69, v68
v_fma_f32 v79, v79, v69, v68
v_fma_f32 v80, v80, v73, v72
v_fma_f32 v81, v81, v73, v72
buffer_load_dwordx4 v3, s[24:27], s37 offen offset:2048 sc1 lds
v_fma_f32 v82, v82, v73, v72
v_fma_f32 v83, v83, v73, v72
v_mul_f32 v76, v76, v192
v_mul_f32 v77, v77, v193
v_mul_f32 v78, v78, v194
v_mul_f32 v79, v79, v195
v_mul_f32 v80, v80, v224
v_mul_f32 v81, v81, v225
v_mul_f32 v82, v82, v226
v_mul_f32 v83, v83, v227
v_exp_f32 v76, v76
v_exp_f32 v77, v77
v_exp_f32 v78, v78
v_exp_f32 v79, v79
v_exp_f32 v80, v80
v_exp_f32 v81, v81
v_exp_f32 v82, v82
v_exp_f32 v83, v83
v_fma_f32 v208, -v64, v48, v208
v_fma_f32 v209, -v64, v49, v209
v_fma_f32 v210, -v64, v50, v210
v_fma_f32 v211, -v64, v51, v211
v_fma_f32 v240, -v66, v48, v240
v_fma_f32 v241, -v66, v49, v241
buffer_load_dwordx4 v3, s[24:27], s37 offen offset:3072 sc1 lds
v_fma_f32 v242, -v66, v50, v242
v_fma_f32 v243, -v66, v51, v243
v_fma_f32 v76, v76, v70, v70
v_fma_f32 v77, v77, v70, v70
v_fma_f32 v78, v78, v70, v70
v_fma_f32 v79, v79, v70, v70
v_fma_f32 v80, v80, v74, v74
v_fma_f32 v81, v81, v74, v74
v_fma_f32 v82, v82, v74, v74
v_fma_f32 v83, v83, v74, v74
v_rcp_f32 v76, v76
v_rcp_f32 v77, v77
v_rcp_f32 v78, v78
v_rcp_f32 v79, v79
v_rcp_f32 v80, v80
v_rcp_f32 v81, v81
v_rcp_f32 v82, v82
v_rcp_f32 v83, v83
v_mul_f32 v208, v192, v208
v_mul_f32 v209, v193, v209
v_mul_f32 v210, v194, v210
v_mul_f32 v211, v195, v211
v_mul_f32 v240, v224, v240
s_add_u32 m0, s39, 65536
s_add_u32 s38, s53, 5242880
buffer_load_dwordx4 v23, s[28:31], s38 offen lds
v_mul_f32 v241, v225, v241
v_mul_f32 v242, v226, v242
v_mul_f32 v243, v227, v243
v_mul_f32 v208, v208, v76
v_mul_f32 v209, v209, v77
v_mul_f32 v210, v210, v78
v_mul_f32 v211, v211, v79
v_mul_f32 v240, v240, v80
v_mul_f32 v241, v241, v81
v_mul_f32 v242, v242, v82
v_mul_f32 v243, v243, v83
v_cvt_pk_bf16_f32 v190, v208, v209
v_cvt_pk_bf16_f32 v191, v210, v211
v_cvt_pk_bf16_f32 v222, v240, v241
v_cvt_pk_bf16_f32 v223, v242, v243
buffer_store_dwordx4 v[188:191], v2, s[24:27], s54 offen offset:2048 sc1
buffer_store_dwordx4 v[220:223], v2, s[24:27], s54 offen offset:3072 sc1
v_fma_f32 v196, -v64, v36, v196
v_fma_f32 v197, -v64, v37, v197
v_fma_f32 v198, -v64, v38, v198
v_fma_f32 v199, -v64, v39, v199
v_fma_f32 v228, -v66, v36, v228
v_fma_f32 v229, -v66, v37, v229
s_add_u32 m0, s39, 66560
s_add_u32 s38, s53, 5242880
buffer_load_dwordx4 v24, s[28:31], s38 offen lds
v_fma_f32 v230, -v66, v38, v230
v_fma_f32 v231, -v66, v39, v231
v_mul_f32 v76, v196, v196
v_mul_f32 v77, v197, v197
v_mul_f32 v78, v198, v198
v_mul_f32 v79, v199, v199
v_mul_f32 v80, v228, v228
v_mul_f32 v81, v229, v229
v_mul_f32 v82, v230, v230
v_mul_f32 v83, v231, v231
v_fma_f32 v76, v76, v69, v68
v_fma_f32 v77, v77, v69, v68
v_fma_f32 v78, v78, v69, v68
v_fma_f32 v79, v79, v69, v68
v_fma_f32 v80, v80, v73, v72
v_fma_f32 v81, v81, v73, v72
v_fma_f32 v82, v82, v73, v72
v_fma_f32 v83, v83, v73, v72
v_mul_f32 v76, v76, v196
v_mul_f32 v77, v77, v197
v_mul_f32 v78, v78, v198
v_mul_f32 v79, v79, v199
v_mul_f32 v80, v80, v228
v_mul_f32 v81, v81, v229
s_add_u32 m0, s39, 67584
s_add_u32 s38, s53, 5259264
buffer_load_dwordx4 v23, s[28:31], s38 offen lds
s_add_u32 m0, s39, 68608
s_add_u32 s38, s53, 5259264
buffer_load_dwordx4 v24, s[28:31], s38 offen lds
s_waitcnt vmcnt(30)
s_barrier
s_add_u32 m0, s39, 81920
s_add_u32 s37, s52, 671744
buffer_load_dwordx4 v3, s[24:27], s37 offen sc1 lds
v_mul_f32 v82, v82, v230
v_mul_f32 v83, v83, v231
v_exp_f32 v76, v76
v_exp_f32 v77, v77
v_exp_f32 v78, v78
v_exp_f32 v79, v79
v_exp_f32 v80, v80
v_exp_f32 v81, v81
v_exp_f32 v82, v82
v_exp_f32 v83, v83
v_fma_f32 v212, -v64, v52, v212
v_fma_f32 v213, -v64, v53, v213
v_fma_f32 v214, -v64, v54, v214
v_fma_f32 v215, -v64, v55, v215
v_fma_f32 v244, -v66, v52, v244
v_fma_f32 v245, -v66, v53, v245
v_fma_f32 v246, -v66, v54, v246
v_fma_f32 v247, -v66, v55, v247
v_fma_f32 v76, v76, v70, v70
v_fma_f32 v77, v77, v70, v70
v_fma_f32 v78, v78, v70, v70
v_fma_f32 v79, v79, v70, v70
v_fma_f32 v80, v80, v74, v74
buffer_load_dwordx4 v3, s[24:27], s37 offen offset:1024 sc1 lds
v_fma_f32 v81, v81, v74, v74
v_fma_f32 v82, v82, v74, v74
v_fma_f32 v83, v83, v74, v74
v_rcp_f32 v76, v76
v_rcp_f32 v77, v77
v_rcp_f32 v78, v78
v_rcp_f32 v79, v79
v_rcp_f32 v80, v80
v_rcp_f32 v81, v81
v_rcp_f32 v82, v82
v_rcp_f32 v83, v83
v_mul_f32 v212, v196, v212
v_mul_f32 v213, v197, v213
v_mul_f32 v214, v198, v214
v_mul_f32 v215, v199, v215
v_mul_f32 v244, v228, v244
v_mul_f32 v245, v229, v245
v_mul_f32 v246, v230, v246
v_mul_f32 v247, v231, v247
v_mul_f32 v212, v212, v76
v_mul_f32 v213, v213, v77
v_mul_f32 v214, v214, v78
v_mul_f32 v215, v215, v79
buffer_load_dwordx4 v3, s[24:27], s37 offen offset:2048 sc1 lds
v_mul_f32 v244, v244, v80
v_mul_f32 v245, v245, v81
v_mul_f32 v246, v246, v82
v_mul_f32 v247, v247, v83
v_cvt_pk_bf16_f32 v196, v212, v213
v_cvt_pk_bf16_f32 v197, v214, v215
v_cvt_pk_bf16_f32 v228, v244, v245
v_cvt_pk_bf16_f32 v229, v246, v247
v_fma_f32 v200, -v64, v40, v200
v_fma_f32 v201, -v64, v41, v201
v_fma_f32 v202, -v64, v42, v202
v_fma_f32 v203, -v64, v43, v203
v_fma_f32 v232, -v66, v40, v232
v_fma_f32 v233, -v66, v41, v233
v_fma_f32 v234, -v66, v42, v234
v_fma_f32 v235, -v66, v43, v235
v_mul_f32 v76, v200, v200
v_mul_f32 v77, v201, v201
v_mul_f32 v78, v202, v202
v_mul_f32 v79, v203, v203
v_mul_f32 v80, v232, v232
v_mul_f32 v81, v233, v233
v_mul_f32 v82, v234, v234
v_mul_f32 v83, v235, v235
buffer_load_dwordx4 v3, s[24:27], s37 offen offset:3072 sc1 lds
v_fma_f32 v76, v76, v69, v68
v_fma_f32 v77, v77, v69, v68
v_fma_f32 v78, v78, v69, v68
v_fma_f32 v79, v79, v69, v68
v_fma_f32 v80, v80, v73, v72
v_fma_f32 v81, v81, v73, v72
v_fma_f32 v82, v82, v73, v72
v_fma_f32 v83, v83, v73, v72
v_mul_f32 v76, v76, v200
v_mul_f32 v77, v77, v201
v_mul_f32 v78, v78, v202
v_mul_f32 v79, v79, v203
v_mul_f32 v80, v80, v232
v_mul_f32 v81, v81, v233
v_mul_f32 v82, v82, v234
v_mul_f32 v83, v83, v235
v_exp_f32 v76, v76
v_exp_f32 v77, v77
v_exp_f32 v78, v78
v_exp_f32 v79, v79
v_exp_f32 v80, v80
v_exp_f32 v81, v81
v_exp_f32 v82, v82
s_add_u32 m0, s39, 147456
s_add_u32 s38, s53, 5373952
buffer_load_dwordx4 v23, s[28:31], s38 offen lds
v_exp_f32 v83, v83
v_fma_f32 v216, -v64, v56, v216
v_fma_f32 v217, -v64, v57, v217
v_fma_f32 v218, -v64, v58, v218
v_fma_f32 v219, -v64, v59, v219
v_fma_f32 v248, -v66, v56, v248
v_fma_f32 v249, -v66, v57, v249
v_fma_f32 v250, -v66, v58, v250
v_fma_f32 v251, -v66, v59, v251
v_fma_f32 v76, v76, v70, v70
v_fma_f32 v77, v77, v70, v70
v_fma_f32 v78, v78, v70, v70
v_fma_f32 v79, v79, v70, v70
v_fma_f32 v80, v80, v74, v74
v_fma_f32 v81, v81, v74, v74
v_fma_f32 v82, v82, v74, v74
v_fma_f32 v83, v83, v74, v74
v_rcp_f32 v76, v76
v_rcp_f32 v77, v77
v_rcp_f32 v78, v78
v_rcp_f32 v79, v79
v_rcp_f32 v80, v80
v_rcp_f32 v81, v81
s_add_u32 m0, s39, 148480
s_add_u32 s38, s53, 5373952
buffer_load_dwordx4 v24, s[28:31], s38 offen lds
v_rcp_f32 v82, v82
v_rcp_f32 v83, v83
v_mul_f32 v216, v200, v216
v_mul_f32 v217, v201, v217
v_mul_f32 v218, v202, v218
v_mul_f32 v219, v203, v219
v_mul_f32 v248, v232, v248
v_mul_f32 v249, v233, v249
v_mul_f32 v250, v234, v250
v_mul_f32 v251, v235, v251
v_mul_f32 v216, v216, v76
v_mul_f32 v217, v217, v77
v_mul_f32 v218, v218, v78
v_mul_f32 v219, v219, v79
v_mul_f32 v248, v248, v80
v_mul_f32 v249, v249, v81
v_mul_f32 v250, v250, v82
v_mul_f32 v251, v251, v83
v_cvt_pk_bf16_f32 v198, v216, v217
v_cvt_pk_bf16_f32 v199, v218, v219
v_cvt_pk_bf16_f32 v230, v248, v249
v_cvt_pk_bf16_f32 v231, v250, v251
buffer_store_dwordx4 v[196:199], v2, s[24:27], s55 offen offset:2048 sc1
buffer_store_dwordx4 v[228:231], v2, s[24:27], s55 offen offset:3072 sc1
s_add_u32 m0, s39, 149504
s_add_u32 s38, s53, 5390336
buffer_load_dwordx4 v23, s[28:31], s38 offen lds
s_add_u32 m0, s39, 150528
s_add_u32 s38, s53, 5390336
buffer_load_dwordx4 v24, s[28:31], s38 offen lds
s_waitcnt vmcnt(30)
s_barrier
s_add_u32 m0, s39, 98304
s_add_u32 s37, s52, 688128
buffer_load_dwordx4 v3, s[24:27], s37 offen sc1 lds
buffer_load_dwordx4 v3, s[24:27], s37 offen offset:1024 sc1 lds
buffer_load_dwordx4 v3, s[24:27], s37 offen offset:2048 sc1 lds
buffer_load_dwordx4 v3, s[24:27], s37 offen offset:3072 sc1 lds
s_add_u32 m0, s39, 114688
s_add_u32 s38, s53, 5505024
buffer_load_dwordx4 v23, s[28:31], s38 offen lds
s_add_u32 m0, s39, 115712
s_add_u32 s38, s53, 5505024
buffer_load_dwordx4 v24, s[28:31], s38 offen lds
s_add_u32 m0, s39, 116736
s_add_u32 s38, s53, 5521408
buffer_load_dwordx4 v23, s[28:31], s38 offen lds
s_add_u32 m0, s39, 117760
s_add_u32 s38, s53, 5521408
buffer_load_dwordx4 v24, s[28:31], s38 offen lds
s_waitcnt vmcnt(10)
s_barrier
s_cmp_eq_u32 s47, 0
s_cbranch_scc0 Lw_155
s_add_u32 s7, s34, 48
s_lshl_b32 s7, s7, 7
v_mov_b32 v26, s7
v_mov_b32 v27, 1
s_mov_b64 exec, 1
buffer_atomic_add v27, v26, s[56:59], 0 offen sc1
s_mov_b64 exec, -1
Lw_155:
s_add_u32 m0, s39, 131072
s_add_u32 s37, s52, 704512
buffer_load_dwordx4 v3, s[24:27], s37 offen sc1 lds
buffer_load_dwordx4 v3, s[24:27], s37 offen offset:1024 sc1 lds
buffer_load_dwordx4 v3, s[24:27], s37 offen offset:2048 sc1 lds
buffer_load_dwordx4 v3, s[24:27], s37 offen offset:3072 sc1 lds
s_add_u32 m0, s39, 0
s_add_u32 s38, s53, 5636096
buffer_load_dwordx4 v23, s[28:31], s38 offen lds
s_add_u32 m0, s39, 1024
s_add_u32 s38, s53, 5636096
buffer_load_dwordx4 v24, s[28:31], s38 offen lds
s_add_u32 m0, s39, 2048
s_add_u32 s38, s53, 5652480
buffer_load_dwordx4 v23, s[28:31], s38 offen lds
s_add_u32 m0, s39, 3072
s_add_u32 s38, s53, 5652480
buffer_load_dwordx4 v24, s[28:31], s38 offen lds
s_waitcnt vmcnt(26)
s_barrier
s_add_u32 m0, s39, 32768
s_add_u32 s38, s91, 0
buffer_load_dwordx4 v23, s[28:31], s38 offen lds
s_add_u32 m0, s39, 33792
s_add_u32 s38, s91, 0
buffer_load_dwordx4 v24, s[28:31], s38 offen lds
s_add_u32 m0, s39, 34816
s_add_u32 s38, s91, 16384
buffer_load_dwordx4 v23, s[28:31], s38 offen lds
s_add_u32 m0, s39, 35840
s_add_u32 s38, s91, 16384
buffer_load_dwordx4 v24, s[28:31], s38 offen lds
s_waitcnt vmcnt(20)
s_barrier
s_add_u32 m0, s39, 65536
s_add_u32 s38, s91, 131072
buffer_load_dwordx4 v23, s[28:31], s38 offen lds
s_add_u32 m0, s39, 66560
s_add_u32 s38, s91, 131072
buffer_load_dwordx4 v24, s[28:31], s38 offen lds
s_add_u32 m0, s39, 67584
s_add_u32 s38, s91, 147456
buffer_load_dwordx4 v23, s[28:31], s38 offen lds
s_add_u32 m0, s39, 68608
s_add_u32 s38, s91, 147456
buffer_load_dwordx4 v24, s[28:31], s38 offen lds
s_waitcnt vmcnt(16)
s_barrier
s_cmp_eq_u32 s47, 3
s_cbranch_scc0 Lw_156
s_lshl_b32 s92, s34, 7
s_add_u32 s92, s92, 28317696
s_load_dword s93, s[82:83], s92 glc
Lw_156:
s_add_u32 m0, s39, 147456
s_add_u32 s38, s91, 262144
buffer_load_dwordx4 v23, s[28:31], s38 offen lds
s_add_u32 m0, s39, 148480
s_add_u32 s38, s91, 262144
buffer_load_dwordx4 v24, s[28:31], s38 offen lds
s_add_u32 m0, s39, 149504
s_add_u32 s38, s91, 278528
buffer_load_dwordx4 v23, s[28:31], s38 offen lds
s_add_u32 m0, s39, 150528
s_add_u32 s38, s91, 278528
buffer_load_dwordx4 v24, s[28:31], s38 offen lds
s_waitcnt vmcnt(12)
s_cmp_eq_u32 s47, 3
s_cbranch_scc0 Lw_157
s_mov_b32 s41, 0x40000
s_branch Lpchk_160
Lpoll_158:
s_load_dword s93, s[82:83], s92 glc
Lpchk_160:
s_waitcnt lgkmcnt(0)
s_cmp_eq_u32 s93, 16
s_cbranch_scc1 Lpok_159
s_sub_u32 s41, s41, 1
s_cmp_lg_u32 s41, 0
s_cbranch_scc1 Lpoll_158
Lpok_159:
Lw_157:
s_barrier
s_add_u32 m0, s39, 16384
s_add_u32 s37, s90, 0
buffer_load_dwordx4 v3, s[24:27], s37 offen sc1 lds
buffer_load_dwordx4 v3, s[24:27], s37 offen offset:1024 sc1 lds
buffer_load_dwordx4 v3, s[24:27], s37 offen offset:2048 sc1 lds
buffer_load_dwordx4 v3, s[24:27], s37 offen offset:3072 sc1 lds
s_add_u32 m0, s39, 49152
s_add_u32 s37, s90, 16384
buffer_load_dwordx4 v3, s[24:27], s37 offen sc1 lds
buffer_load_dwordx4 v3, s[24:27], s37 offen offset:1024 sc1 lds
buffer_load_dwordx4 v3, s[24:27], s37 offen offset:2048 sc1 lds
buffer_load_dwordx4 v3, s[24:27], s37 offen offset:3072 sc1 lds
s_add_u32 m0, s39, 81920
s_add_u32 s37, s90, 32768
buffer_load_dwordx4 v3, s[24:27], s37 offen sc1 lds
buffer_load_dwordx4 v3, s[24:27], s37 offen offset:1024 sc1 lds
buffer_load_dwordx4 v3, s[24:27], s37 offen offset:2048 sc1 lds
buffer_load_dwordx4 v3, s[24:27], s37 offen offset:3072 sc1 lds
s_add_u32 m0, s39, 98304
s_add_u32 s37, s90, 49152
buffer_load_dwordx4 v3, s[24:27], s37 offen sc1 lds
buffer_load_dwordx4 v3, s[24:27], s37 offen offset:1024 sc1 lds
buffer_load_dwordx4 v3, s[24:27], s37 offen offset:2048 sc1 lds
buffer_load_dwordx4 v3, s[24:27], s37 offen offset:3072 sc1 lds
s_add_u32 m0, s39, 114688
s_add_u32 s38, s91, 393216
buffer_load_dwordx4 v23, s[28:31], s38 offen lds
s_add_u32 m0, s39, 115712
s_add_u32 s38, s91, 393216
buffer_load_dwordx4 v24, s[28:31], s38 offen lds
s_add_u32 m0, s39, 116736
s_add_u32 s38, s91, 409600
buffer_load_dwordx4 v23, s[28:31], s38 offen lds
s_add_u32 m0, s39, 117760
s_add_u32 s38, s91, 409600
buffer_load_dwordx4 v24, s[28:31], s38 offen lds
s_waitcnt vmcnt(16)
s_barrier
s_add_u32 m0, s39, 131072
s_add_u32 s37, s90, 65536
buffer_load_dwordx4 v3, s[24:27], s37 offen sc1 lds
buffer_load_dwordx4 v3, s[24:27], s37 offen offset:1024 sc1 lds
buffer_load_dwordx4 v3, s[24:27], s37 offen offset:2048 sc1 lds
buffer_load_dwordx4 v3, s[24:27], s37 offen offset:3072 sc1 lds
s_add_u32 m0, s39, 0
s_add_u32 s38, s91, 524288
buffer_load_dwordx4 v23, s[28:31], s38 offen lds
s_add_u32 m0, s39, 1024
s_add_u32 s38, s91, 524288
buffer_load_dwordx4 v24, s[28:31], s38 offen lds
s_add_u32 m0, s39, 2048
s_add_u32 s38, s91, 540672
buffer_load_dwordx4 v23, s[28:31], s38 offen lds
s_add_u32 m0, s39, 3072
s_add_u32 s38, s91, 540672
buffer_load_dwordx4 v24, s[28:31], s38 offen lds
s_waitcnt vmcnt(20)
s_barrier
s_add_u32 m0, s39, 16384
s_add_u32 s37, s90, 81920
buffer_load_dwordx4 v3, s[24:27], s37 offen sc1 lds
buffer_load_dwordx4 v3, s[24:27], s37 offen offset:1024 sc1 lds
buffer_load_dwordx4 v3, s[24:27], s37 offen offset:2048 sc1 lds
buffer_load_dwordx4 v3, s[24:27], s37 offen offset:3072 sc1 lds
s_add_u32 m0, s39, 32768
s_add_u32 s38, s91, 655360
buffer_load_dwordx4 v23, s[28:31], s38 offen lds
s_add_u32 m0, s39, 33792
s_add_u32 s38, s91, 655360
buffer_load_dwordx4 v24, s[28:31], s38 offen lds
s_add_u32 m0, s39, 34816
s_add_u32 s38, s91, 671744
buffer_load_dwordx4 v23, s[28:31], s38 offen lds
s_add_u32 m0, s39, 35840
s_add_u32 s38, s91, 671744
buffer_load_dwordx4 v24, s[28:31], s38 offen lds
s_waitcnt vmcnt(24)
s_barrier
s_add_u32 m0, s39, 49152
s_add_u32 s37, s90, 98304
buffer_load_dwordx4 v3, s[24:27], s37 offen sc1 lds
buffer_load_dwordx4 v3, s[24:27], s37 offen offset:1024 sc1 lds
buffer_load_dwordx4 v3, s[24:27], s37 offen offset:2048 sc1 lds
buffer_load_dwordx4 v3, s[24:27], s37 offen offset:3072 sc1 lds
s_add_u32 m0, s39, 65536
s_add_u32 s38, s91, 786432
buffer_load_dwordx4 v23, s[28:31], s38 offen lds
s_add_u32 m0, s39, 66560
s_add_u32 s38, s91, 786432
buffer_load_dwordx4 v24, s[28:31], s38 offen lds
s_add_u32 m0, s39, 67584
s_add_u32 s38, s91, 802816
buffer_load_dwordx4 v23, s[28:31], s38 offen lds
s_add_u32 m0, s39, 68608
s_add_u32 s38, s91, 802816
s_branch Lov_17
.p2align 12
Lst_17_0:
s_branch Lwr_192
s_nop 0
s_nop 0
Lov_17:
buffer_load_dwordx4 v24, s[28:31], s38 offen lds
s_waitcnt vmcnt(24)
s_barrier
s_add_u32 m0, s39, 81920
s_add_u32 s37, s90, 114688
buffer_load_dwordx4 v3, s[24:27], s37 offen sc1 lds
buffer_load_dwordx4 v3, s[24:27], s37 offen offset:1024 sc1 lds
buffer_load_dwordx4 v3, s[24:27], s37 offen offset:2048 sc1 lds
buffer_load_dwordx4 v3, s[24:27], s37 offen offset:3072 sc1 lds
s_add_u32 m0, s39, 147456
s_add_u32 s38, s91, 917504
buffer_load_dwordx4 v23, s[28:31], s38 offen lds
s_add_u32 m0, s39, 148480
s_add_u32 s38, s91, 917504
buffer_load_dwordx4 v24, s[28:31], s38 offen lds
s_add_u32 m0, s39, 149504
s_add_u32 s38, s91, 933888
buffer_load_dwordx4 v23, s[28:31], s38 offen lds
s_add_u32 m0, s39, 150528
s_add_u32 s38, s91, 933888
buffer_load_dwordx4 v24, s[28:31], s38 offen lds
s_waitcnt vmcnt(24)
s_barrier
s_add_u32 m0, s39, 98304
s_add_u32 s37, s90, 131072
buffer_load_dwordx4 v3, s[24:27], s37 offen sc1 lds
buffer_load_dwordx4 v3, s[24:27], s37 offen offset:1024 sc1 lds
buffer_load_dwordx4 v3, s[24:27], s37 offen offset:2048 sc1 lds
buffer_load_dwordx4 v3, s[24:27], s37 offen offset:3072 sc1 lds
s_add_u32 m0, s39, 114688
s_add_u32 s38, s91, 1048576
buffer_load_dwordx4 v23, s[28:31], s38 offen lds
s_add_u32 m0, s39, 115712
s_add_u32 s38, s91, 1048576
buffer_load_dwordx4 v24, s[28:31], s38 offen lds
s_add_u32 m0, s39, 116736
s_add_u32 s38, s91, 1064960
buffer_load_dwordx4 v23, s[28:31], s38 offen lds
s_add_u32 m0, s39, 117760
s_add_u32 s38, s91, 1064960
buffer_load_dwordx4 v24, s[28:31], s38 offen lds
s_waitcnt vmcnt(24)
s_barrier
s_add_u32 m0, s39, 131072
s_add_u32 s37, s90, 147456
buffer_load_dwordx4 v3, s[24:27], s37 offen sc1 lds
buffer_load_dwordx4 v3, s[24:27], s37 offen offset:1024 sc1 lds
buffer_load_dwordx4 v3, s[24:27], s37 offen offset:2048 sc1 lds
buffer_load_dwordx4 v3, s[24:27], s37 offen offset:3072 sc1 lds
s_add_u32 m0, s39, 0
s_add_u32 s38, s91, 1179648
buffer_load_dwordx4 v23, s[28:31], s38 offen lds
s_add_u32 m0, s39, 1024
s_add_u32 s38, s91, 1179648
buffer_load_dwordx4 v24, s[28:31], s38 offen lds
s_add_u32 m0, s39, 2048
s_add_u32 s38, s91, 1196032
buffer_load_dwordx4 v23, s[28:31], s38 offen lds
s_add_u32 m0, s39, 3072
s_add_u32 s38, s91, 1196032
buffer_load_dwordx4 v24, s[28:31], s38 offen lds
s_waitcnt vmcnt(24)
s_barrier
s_add_u32 m0, s39, 16384
s_mov_b32 s37, 327680
buffer_load_dwordx4 v3, s[24:27], s37 offen sc1 lds
buffer_load_dwordx4 v3, s[24:27], s37 offen offset:1024 sc1 lds
buffer_load_dwordx4 v3, s[24:27], s37 offen offset:2048 sc1 lds
buffer_load_dwordx4 v3, s[24:27], s37 offen offset:3072 sc1 lds
s_add_u32 m0, s51, 32768
s_mov_b32 s38, 2621440
buffer_load_dwordx4 v25, s[28:31], s38 offen lds
s_add_u32 m0, s51, 33792
s_mov_b32 s38, 2637824
buffer_load_dwordx4 v25, s[28:31], s38 offen lds
s_waitcnt vmcnt(22)
s_barrier
s_add_u32 m0, s39, 49152
s_mov_b32 s37, 344064
buffer_load_dwordx4 v3, s[24:27], s37 offen sc1 lds
buffer_load_dwordx4 v3, s[24:27], s37 offen offset:1024 sc1 lds
buffer_load_dwordx4 v3, s[24:27], s37 offen offset:2048 sc1 lds
buffer_load_dwordx4 v3, s[24:27], s37 offen offset:3072 sc1 lds
s_add_u32 m0, s51, 65536
s_mov_b32 s38, 2752512
buffer_load_dwordx4 v25, s[28:31], s38 offen lds
s_add_u32 m0, s51, 66560
s_mov_b32 s38, 2768896
buffer_load_dwordx4 v25, s[28:31], s38 offen lds
s_waitcnt vmcnt(20)
s_barrier
s_add_u32 m0, s39, 81920
s_mov_b32 s37, 360448
buffer_load_dwordx4 v3, s[24:27], s37 offen sc1 lds
buffer_load_dwordx4 v3, s[24:27], s37 offen offset:1024 sc1 lds
buffer_load_dwordx4 v3, s[24:27], s37 offen offset:2048 sc1 lds
buffer_load_dwordx4 v3, s[24:27], s37 offen offset:3072 sc1 lds
s_add_u32 m0, s51, 147456
s_mov_b32 s38, 2883584
buffer_load_dwordx4 v25, s[28:31], s38 offen lds
s_add_u32 m0, s51, 148480
s_mov_b32 s38, 2899968
buffer_load_dwordx4 v25, s[28:31], s38 offen lds
s_waitcnt vmcnt(18)
s_barrier
s_add_u32 m0, s39, 98304
s_mov_b32 s37, 376832
buffer_load_dwordx4 v3, s[24:27], s37 offen sc1 lds
buffer_load_dwordx4 v3, s[24:27], s37 offen offset:1024 sc1 lds
buffer_load_dwordx4 v3, s[24:27], s37 offen offset:2048 sc1 lds
buffer_load_dwordx4 v3, s[24:27], s37 offen offset:3072 sc1 lds
s_add_u32 m0, s51, 114688
s_mov_b32 s38, 3014656
buffer_load_dwordx4 v25, s[28:31], s38 offen lds
s_add_u32 m0, s51, 115712
s_mov_b32 s38, 3031040
buffer_load_dwordx4 v25, s[28:31], s38 offen lds
s_waitcnt vmcnt(18)
s_barrier
s_add_u32 m0, s39, 131072
s_mov_b32 s37, 393216
buffer_load_dwordx4 v3, s[24:27], s37 offen sc1 lds
buffer_load_dwordx4 v3, s[24:27], s37 offen offset:1024 sc1 lds
buffer_load_dwordx4 v3, s[24:27], s37 offen offset:2048 sc1 lds
buffer_load_dwordx4 v3, s[24:27], s37 offen offset:3072 sc1 lds
s_add_u32 m0, s51, 0
s_mov_b32 s38, 3145728
buffer_load_dwordx4 v25, s[28:31], s38 offen lds
s_add_u32 m0, s51, 1024
s_mov_b32 s38, 3162112
buffer_load_dwordx4 v25, s[28:31], s38 offen lds
s_waitcnt vmcnt(18)
s_barrier
s_add_u32 m0, s39, 16384
s_mov_b32 s37, 409600
buffer_load_dwordx4 v3, s[24:27], s37 offen sc1 lds
buffer_load_dwordx4 v3, s[24:27], s37 offen offset:1024 sc1 lds
buffer_load_dwordx4 v3, s[24:27], s37 offen offset:2048 sc1 lds
buffer_load_dwordx4 v3, s[24:27], s37 offen offset:3072 sc1 lds
s_add_u32 m0, s51, 32768
s_mov_b32 s38, 3276800
buffer_load_dwordx4 v25, s[28:31], s38 offen lds
s_add_u32 m0, s51, 33792
s_mov_b32 s38, 3293184
buffer_load_dwordx4 v25, s[28:31], s38 offen lds
s_waitcnt vmcnt(18)
s_barrier
s_add_u32 m0, s39, 49152
s_mov_b32 s37, 425984
buffer_load_dwordx4 v3, s[24:27], s37 offen sc1 lds
buffer_load_dwordx4 v3, s[24:27], s37 offen offset:1024 sc1 lds
buffer_load_dwordx4 v3, s[24:27], s37 offen offset:2048 sc1 lds
buffer_load_dwordx4 v3, s[24:27], s37 offen offset:3072 sc1 lds
s_add_u32 m0, s51, 65536
s_mov_b32 s38, 3407872
buffer_load_dwordx4 v25, s[28:31], s38 offen lds
s_add_u32 m0, s51, 66560
s_mov_b32 s38, 3424256
buffer_load_dwordx4 v25, s[28:31], s38 offen lds
s_waitcnt vmcnt(18)
s_barrier
s_add_u32 m0, s39, 81920
s_mov_b32 s37, 442368
buffer_load_dwordx4 v3, s[24:27], s37 offen sc1 lds
buffer_load_dwordx4 v3, s[24:27], s37 offen offset:1024 sc1 lds
buffer_load_dwordx4 v3, s[24:27], s37 offen offset:2048 sc1 lds
buffer_load_dwordx4 v3, s[24:27], s37 offen offset:3072 sc1 lds
s_add_u32 m0, s51, 147456
s_mov_b32 s38, 3538944
buffer_load_dwordx4 v25, s[28:31], s38 offen lds
s_add_u32 m0, s51, 148480
s_mov_b32 s38, 3555328
buffer_load_dwordx4 v25, s[28:31], s38 offen lds
s_waitcnt vmcnt(18)
s_barrier
s_add_u32 m0, s39, 98304
s_mov_b32 s37, 458752
buffer_load_dwordx4 v3, s[24:27], s37 offen sc1 lds
buffer_load_dwordx4 v3, s[24:27], s37 offen offset:1024 sc1 lds
buffer_load_dwordx4 v3, s[24:27], s37 offen offset:2048 sc1 lds
buffer_load_dwordx4 v3, s[24:27], s37 offen offset:3072 sc1 lds
s_add_u32 m0, s51, 114688
s_mov_b32 s38, 3670016
buffer_load_dwordx4 v25, s[28:31], s38 offen lds
s_add_u32 m0, s51, 115712
s_mov_b32 s38, 3686400
buffer_load_dwordx4 v25, s[28:31], s38 offen lds
s_waitcnt vmcnt(18)
s_barrier
s_add_u32 m0, s39, 131072
s_mov_b32 s37, 475136
buffer_load_dwordx4 v3, s[24:27], s37 offen sc1 lds
buffer_load_dwordx4 v3, s[24:27], s37 offen offset:1024 sc1 lds
buffer_load_dwordx4 v3, s[24:27], s37 offen offset:2048 sc1 lds
buffer_load_dwordx4 v3, s[24:27], s37 offen offset:3072 sc1 lds
s_add_u32 m0, s51, 0
s_mov_b32 s38, 3801088
buffer_load_dwordx4 v25, s[28:31], s38 offen lds
s_add_u32 m0, s51, 1024
s_mov_b32 s38, 3817472
buffer_load_dwordx4 v25, s[28:31], s38 offen lds
s_waitcnt vmcnt(18)
s_barrier
s_cmp_eq_u32 s47, 0
s_cbranch_scc0 Lw_161
s_xor_b32 s43, s2, 2
s_add_u32 s43, s43, 128
s_lshl_b32 s43, s43, 7
v_mov_b32 v26, s43
v_mov_b32 v27, 1
s_mov_b64 exec, 1
buffer_store_dword v27, v26, s[56:59], 0 offen sc1
s_mov_b64 exec, -1
Lw_161:
s_add_u32 m0, s39, 16384
s_mov_b32 s37, 491520
buffer_load_dwordx4 v3, s[24:27], s37 offen sc1 lds
buffer_load_dwordx4 v3, s[24:27], s37 offen offset:1024 sc1 lds
buffer_load_dwordx4 v3, s[24:27], s37 offen offset:2048 sc1 lds
buffer_load_dwordx4 v3, s[24:27], s37 offen offset:3072 sc1 lds
s_add_u32 m0, s51, 32768
s_mov_b32 s38, 3932160
buffer_load_dwordx4 v25, s[28:31], s38 offen lds
s_add_u32 m0, s51, 33792
s_mov_b32 s38, 3948544
buffer_load_dwordx4 v25, s[28:31], s38 offen lds
s_waitcnt vmcnt(18)
s_barrier
s_add_u32 m0, s39, 49152
s_mov_b32 s37, 507904
buffer_load_dwordx4 v3, s[24:27], s37 offen sc1 lds
buffer_load_dwordx4 v3, s[24:27], s37 offen offset:1024 sc1 lds
buffer_load_dwordx4 v3, s[24:27], s37 offen offset:2048 sc1 lds
buffer_load_dwordx4 v3, s[24:27], s37 offen offset:3072 sc1 lds
s_add_u32 m0, s51, 65536
s_mov_b32 s38, 4063232
buffer_load_dwordx4 v25, s[28:31], s38 offen lds
s_add_u32 m0, s51, 66560
s_mov_b32 s38, 4079616
buffer_load_dwordx4 v25, s[28:31], s38 offen lds
s_waitcnt vmcnt(18)
s_barrier
s_cmp_eq_u32 s47, 3
s_cbranch_scc0 Lw_162
s_lshl_b32 s92, s2, 7
s_add_u32 s92, s92, 28327936
s_load_dword s93, s[82:83], s92 glc
Lw_162:
s_waitcnt vmcnt(12)
s_cmp_eq_u32 s47, 3
s_cbranch_scc0 Lw_163
s_mov_b32 s41, 0x40000
s_branch Lpchk_166
Lpoll_164:
s_load_dword s93, s[82:83], s92 glc
Lpchk_166:
s_waitcnt lgkmcnt(0)
s_cmp_eq_u32 s93, 1
s_cbranch_scc1 Lpok_165
s_sub_u32 s41, s41, 1
s_cmp_lg_u32 s41, 0
s_cbranch_scc1 Lpoll_164
Lpok_165:
Lw_163:
s_barrier
s_waitcnt vmcnt(6)
s_barrier
s_waitcnt vmcnt(0)
s_barrier
s_barrier
s_branch Ldone_1
Ldone_1:
Lfin:
Lexit_2:
s_endpgm
.section .rodata,"a"
.p2align 6
.amdhsa_kernel sequential_preLN__sliding_local_dilated__glu_gated_geglu__prompt_kernel
  .amdhsa_next_free_vgpr 256
  .amdhsa_next_free_sgpr 100
  .amdhsa_accum_offset 256
  .amdhsa_group_segment_fixed_size 0
  .amdhsa_kernarg_size 80
  .amdhsa_user_sgpr_count 2
  .amdhsa_user_sgpr_kernarg_segment_ptr 1
  .amdhsa_system_sgpr_workgroup_id_x 1
  .amdhsa_float_denorm_mode_32 3
  .amdhsa_float_denorm_mode_16_64 3
.end_amdhsa_kernel
```

```asm
; @launch grid=(256,1,1) block=(512,1,1) lds=163840
.amdgcn_target "amdgcn-amd-amdhsa--gfx950"
.text
.globl sequential_preLN__sliding_local_dilated__glu_gated_geglu__prompt_kernel
.p2align 8
.type sequential_preLN__sliding_local_dilated__glu_gated_geglu__prompt_kernel,@function
sequential_preLN__sliding_local_dilated__glu_gated_geglu__prompt_kernel:
s_cmp_ge_u32 s2, 256
s_cbranch_scc1 Lexit_2
s_load_dwordx16 s[64:79], s[0:1], 0
s_load_dwordx4 s[80:83], s[0:1], 64
s_and_b32 s3, s2, 7
s_lshr_b32 s42, s2, 3
s_and_b32 s34, s3, 1
s_lshl_b32 s34, s34, 3
s_and_b32 s48, s42, 7
s_add_u32 s34, s34, s48
s_lshr_b32 s35, s3, 1
s_lshr_b32 s49, s42, 3
s_lshl_b32 s35, s35, 2
s_add_u32 s35, s35, s49
v_lshrrev_b32 v12, 6, v0
v_and_b32 v1, 63, v0
v_readfirstlane_b32 s36, v12
Lbeg:
s_lshl_b32 s50, s34, 7
s_sub_u32 s50, s50, 16
v_and_b32 v12, 15, v1
v_lshrrev_b32 v13, 4, v1
s_cmp_lt_u32 s36, 4
s_cbranch_scc1 Lcons_7
Lprod_3:
s_sub_u32 s47, s36, 4
s_lshl_b32 s43, s34, 7
s_lshl_b32 s44, s35, 3
s_add_u32 s63, s43, s44
s_lshl_b32 s44, s47, 1
s_add_u32 s51, s63, s44
v_lshlrev_b32 v10, 4, v1
s_and_b32 s43, s2, 7
s_lshr_b32 s44, s43, 2
s_lshl_b32 s44, s44, 1
s_and_b32 s45, s43, 1
s_add_u32 s44, s44, s45
s_lshr_b32 s45, s2, 3
s_lshl_b32 s45, s45, 2
s_add_u32 s44, s44, s45
s_add_u32 s44, s44, 96
s_bitcmp1_b32 s43, 1
s_cselect_b32 s44, s44, 0x10000
s_cmp_lt_u32 s2, 192
s_cselect_b32 s33, s2, s44
v_lshrrev_b32 v14, 3, v1
v_and_b32 v15, 7, v1
v_lshl_add_u32 v19, v14, 6, v15
s_lshl_b32 s43, s48, 3
v_add_u32 v19, s43, v19
v_mul_u32_u24 v19, 6144, v19
s_cmp_eq_u32 s47, 3
s_cbranch_scc1 Lpf_4
v_and_b32 v16, 2, v14
v_xor_b32 v16, v15, v16
v_lshlrev_b32 v16, 4, v16
v_mul_u32_u24 v17, 6144, v14
s_lshl_b32 s43, s47, 11
v_add3_u32 v2, v17, v16, s43
v_xor_b32 v3, 64, v2
v_lshrrev_b32 v16, 1, v14
v_xor_b32 v16, v15, v16
v_lshlrev_b32 v16, 4, v16
s_lshl_b32 s43, s47, 3
s_add_u32 s43, s43, s50
v_add_u32 v17, s43, v14
s_and_b32 s44, s47, 1
s_lshl_b32 s44, s44, 6
v_add_u32 v18, 0, v17
v_max_i32 v18, 0, v18
v_lshl_add_u32 v18, v18, 11, v16
v_xor_b32 v18, s44, v18
v_mov_b32 v4, v18
v_add_u32 v18, 24, v17
v_max_i32 v18, 0, v18
v_lshl_add_u32 v18, v18, 11, v16
v_xor_b32 v18, s44, v18
v_xor_b32 v5, 64, v18
v_add_u32 v18, 48, v17
v_max_i32 v18, 0, v18
v_lshl_add_u32 v18, v18, 11, v16
v_xor_b32 v18, s44, v18
v_mov_b32 v6, v18
v_add_u32 v18, 72, v17
v_max_i32 v18, 0, v18
v_lshl_add_u32 v18, v18, 11, v16
v_xor_b32 v18, s44, v18
v_xor_b32 v7, 64, v18
v_add_u32 v18, 96, v17
v_max_i32 v18, 0, v18
v_lshl_add_u32 v18, v18, 11, v16
v_xor_b32 v18, s44, v18
v_mov_b32 v8, v18
v_add_u32 v18, 120, v17
v_max_i32 v18, 0, v18
v_lshl_add_u32 v18, v18, 11, v16
v_xor_b32 v18, s44, v18
v_xor_b32 v9, 64, v18
s_lshl_b32 s39, s47, 10
s_lshl_b32 s40, s47, 13
s_add_u32 s40, s40, 18432
s_mov_b32 s37, 0
s_mov_b32 s38, 0
s_bfm_b64 s[60:61], 56, 8
s_cmp_eq_u32 s47, 0
s_cselect_b64 s[60:61], s[60:61], -1
s_lshl_b32 s43, s35, 7
s_waitcnt lgkmcnt(0)
s_mov_b32 s8, s64
s_mov_b32 s9, s65
s_mov_b32 s10, 4194304
s_mov_b32 s11, 0x20000
s_add_u32 s12, s66, s43
s_addc_u32 s13, s67, 0
s_mov_b32 s14, 6289536
s_mov_b32 s15, 0x20000
s_add_u32 m0, s39, 0
s_mov_b64 exec, s[60:61]
buffer_load_dwordx4 v4, s[8:11], s37 offen lds
s_mov_b64 exec, -1
s_add_u32 m0, s39, 3072
s_nop 0
buffer_load_dwordx4 v5, s[8:11], s37 offen lds
s_add_u32 m0, s39, 6144
s_nop 0
buffer_load_dwordx4 v6, s[8:11], s37 offen lds
s_add_u32 m0, s39, 9216
s_nop 0
buffer_load_dwordx4 v7, s[8:11], s37 offen lds
s_add_u32 m0, s39, 12288
s_nop 0
buffer_load_dwordx4 v8, s[8:11], s37 offen lds
s_add_u32 m0, s39, 15360
s_nop 0
buffer_load_dwordx4 v9, s[8:11], s37 offen lds
s_add_u32 m0, s40, 0
s_add_u32 s43, s38, 0
buffer_load_dwordx4 v2, s[12:15], s43 offen lds
s_add_u32 m0, s40, 1024
s_add_u32 s43, s38, 49152
buffer_load_dwordx4 v3, s[12:15], s43 offen lds
s_add_u32 m0, s40, 2048
s_add_u32 s43, s38, 98304
buffer_load_dwordx4 v2, s[12:15], s43 offen lds
s_add_u32 m0, s40, 3072
s_add_u32 s43, s38, 147456
buffer_load_dwordx4 v3, s[12:15], s43 offen lds
s_add_u32 m0, s40, 4096
s_add_u32 s43, s38, 196608
buffer_load_dwordx4 v2, s[12:15], s43 offen lds
s_add_u32 m0, s40, 5120
s_add_u32 s43, s38, 245760
buffer_load_dwordx4 v3, s[12:15], s43 offen lds
s_add_u32 m0, s40, 6144
s_add_u32 s43, s38, 294912
buffer_load_dwordx4 v2, s[12:15], s43 offen lds
s_add_u32 m0, s40, 7168
s_add_u32 s43, s38, 344064
buffer_load_dwordx4 v3, s[12:15], s43 offen lds
s_add_u32 s37, s37, 128
s_add_u32 s38, s38, 393216
s_mov_b32 s28, s66
s_mov_b32 s29, s67
s_mov_b32 s30, 6291456
s_mov_b32 s31, 0x20000
s_mul_i32 s43, s33, 5376
s_add_u32 s43, s43, 393216
v_lshlrev_b32 v30, 7, v1
s_mul_i32 s44, s47, 1792
s_add_u32 s43, s43, s44
s_bfm_b64 exec, 14, 0
buffer_load_dword v31, v30, s[28:31], s43 offen
s_mov_b64 exec, -1
s_lshl_b32 s43, s51, 11
buffer_load_dwordx4 v[96:99], v10, s[8:11], s43 offen offset:0
buffer_load_dwordx4 v[100:103], v10, s[8:11], s43 offen offset:1024
buffer_load_dwordx4 v[104:107], v10, s[8:11], s43 offen offset:2048
buffer_load_dwordx4 v[108:111], v10, s[8:11], s43 offen offset:3072
s_add_u32 m0, s39, 43008
s_mov_b64 exec, s[60:61]
buffer_load_dwordx4 v4, s[8:11], s37 offen lds
s_mov_b64 exec, -1
s_add_u32 m0, s39, 46080
s_nop 0
buffer_load_dwordx4 v5, s[8:11], s37 offen lds
s_add_u32 m0, s39, 49152
s_nop 0
buffer_load_dwordx4 v6, s[8:11], s37 offen lds
s_add_u32 m0, s39, 52224
s_nop 0
buffer_load_dwordx4 v7, s[8:11], s37 offen lds
s_add_u32 m0, s39, 55296
s_nop 0
buffer_load_dwordx4 v8, s[8:11], s37 offen lds
s_add_u32 m0, s39, 58368
s_nop 0
buffer_load_dwordx4 v9, s[8:11], s37 offen lds
s_add_u32 m0, s40, 43008
s_add_u32 s43, s38, 0
buffer_load_dwordx4 v2, s[12:15], s43 offen lds
s_add_u32 m0, s40, 44032
s_add_u32 s43, s38, 49152
buffer_load_dwordx4 v3, s[12:15], s43 offen lds
s_add_u32 m0, s40, 45056
s_add_u32 s43, s38, 98304
buffer_load_dwordx4 v2, s[12:15], s43 offen lds
s_add_u32 m0, s40, 46080
s_add_u32 s43, s38, 147456
buffer_load_dwordx4 v3, s[12:15], s43 offen lds
s_add_u32 m0, s40, 47104
s_add_u32 s43, s38, 196608
buffer_load_dwordx4 v2, s[12:15], s43 offen lds
s_add_u32 m0, s40, 48128
s_add_u32 s43, s38, 245760
buffer_load_dwordx4 v3, s[12:15], s43 offen lds
s_add_u32 m0, s40, 49152
s_add_u32 s43, s38, 294912
buffer_load_dwordx4 v2, s[12:15], s43 offen lds
s_add_u32 m0, s40, 50176
s_add_u32 s43, s38, 344064
buffer_load_dwordx4 v3, s[12:15], s43 offen lds
s_add_u32 s37, s37, 128
s_add_u32 s38, s38, 393216
s_waitcnt vmcnt(19)
s_barrier
s_add_u32 m0, s39, 86016
s_mov_b64 exec, s[60:61]
buffer_load_dwordx4 v4, s[8:11], s37 offen lds
s_mov_b64 exec, -1
s_add_u32 m0, s39, 89088
s_nop 0
buffer_load_dwordx4 v5, s[8:11], s37 offen lds
s_add_u32 m0, s39, 92160
s_nop 0
buffer_load_dwordx4 v6, s[8:11], s37 offen lds
s_add_u32 m0, s39, 95232
s_nop 0
buffer_load_dwordx4 v7, s[8:11], s37 offen lds
s_add_u32 m0, s39, 98304
s_nop 0
buffer_load_dwordx4 v8, s[8:11], s37 offen lds
s_add_u32 m0, s39, 101376
s_nop 0
buffer_load_dwordx4 v9, s[8:11], s37 offen lds
s_add_u32 m0, s40, 86016
s_add_u32 s43, s38, 0
buffer_load_dwordx4 v2, s[12:15], s43 offen lds
s_add_u32 m0, s40, 87040
s_add_u32 s43, s38, 49152
buffer_load_dwordx4 v3, s[12:15], s43 offen lds
s_add_u32 m0, s40, 88064
s_add_u32 s43, s38, 98304
buffer_load_dwordx4 v2, s[12:15], s43 offen lds
s_add_u32 m0, s40, 89088
s_add_u32 s43, s38, 147456
buffer_load_dwordx4 v3, s[12:15], s43 offen lds
s_add_u32 m0, s40, 90112
s_add_u32 s43, s38, 196608
buffer_load_dwordx4 v2, s[12:15], s43 offen lds
s_add_u32 m0, s40, 91136
s_add_u32 s43, s38, 245760
buffer_load_dwordx4 v3, s[12:15], s43 offen lds
s_add_u32 m0, s40, 92160
s_add_u32 s43, s38, 294912
buffer_load_dwordx4 v2, s[12:15], s43 offen lds
s_add_u32 m0, s40, 93184
s_add_u32 s43, s38, 344064
buffer_load_dwordx4 v3, s[12:15], s43 offen lds
s_add_u32 s37, s37, 128
s_add_u32 s38, s38, 393216
s_waitcnt vmcnt(28)
s_mov_b32 s43, 0x3f803f80
v_mov_b32 v116, 0
v_mov_b32 v117, 0
v_mov_b32 v118, 0
v_mov_b32 v119, 0
v_mov_b32 v120, 0
v_mov_b32 v121, 0
v_mov_b32 v122, 0
v_mov_b32 v123, 0
v_dot2_f32_bf16 v116, v96, s43, v116
v_dot2_f32_bf16 v120, v96, v96, v120
v_dot2_f32_bf16 v118, v104, s43, v118
v_dot2_f32_bf16 v122, v104, v104, v122
v_dot2_f32_bf16 v117, v97, s43, v117
v_dot2_f32_bf16 v121, v97, v97, v121
v_dot2_f32_bf16 v119, v105, s43, v119
v_dot2_f32_bf16 v123, v105, v105, v123
v_dot2_f32_bf16 v116, v98, s43, v116
v_dot2_f32_bf16 v120, v98, v98, v120
v_dot2_f32_bf16 v118, v106, s43, v118
v_dot2_f32_bf16 v122, v106, v106, v122
v_dot2_f32_bf16 v117, v99, s43, v117
v_dot2_f32_bf16 v121, v99, v99, v121
v_dot2_f32_bf16 v119, v107, s43, v119
v_dot2_f32_bf16 v123, v107, v107, v123
v_dot2_f32_bf16 v116, v100, s43, v116
v_dot2_f32_bf16 v120, v100, v100, v120
v_dot2_f32_bf16 v118, v108, s43, v118
v_dot2_f32_bf16 v122, v108, v108, v122
v_dot2_f32_bf16 v117, v101, s43, v117
v_dot2_f32_bf16 v121, v101, v101, v121
v_dot2_f32_bf16 v119, v109, s43, v119
v_dot2_f32_bf16 v123, v109, v109, v123
v_dot2_f32_bf16 v116, v102, s43, v116
v_dot2_f32_bf16 v120, v102, v102, v120
v_dot2_f32_bf16 v118, v110, s43, v118
v_dot2_f32_bf16 v122, v110, v110, v122
v_dot2_f32_bf16 v117, v103, s43, v117
v_dot2_f32_bf16 v121, v103, v103, v121
v_dot2_f32_bf16 v119, v111, s43, v119
v_dot2_f32_bf16 v123, v111, v111, v123
s_nop 2
v_add_f32 v116, v116, v117
v_add_f32 v118, v118, v119
v_add_f32 v120, v120, v121
v_add_f32 v122, v122, v123
s_nop 1
v_permlane32_swap_b32 v116, v118
v_permlane32_swap_b32 v120, v122
v_add_f32 v116, v116, v118
v_add_f32 v120, v120, v122
s_nop 1
v_permlane16_swap_b32 v116, v120
v_add_f32 v116, v116, v120
s_nop 1
v_add_f32_dpp v116, v116, v116 row_ror:8 row_mask:0xf bank_mask:0xf
s_nop 1
v_add_f32_dpp v116, v116, v116 row_ror:4 row_mask:0xf bank_mask:0xf
s_nop 1
v_add_f32_dpp v116, v116, v116 row_ror:2 row_mask:0xf bank_mask:0xf
s_nop 1
v_add_f32_dpp v116, v116, v116 row_ror:1 row_mask:0xf bank_mask:0xf
v_mov_b32 v117, v116
s_nop 1
v_permlane16_swap_b32 v116, v117
v_mul_f32 v112, 0x3a800000, v116
v_mul_f32 v113, 0x3a800000, v117
v_fma_f32 v113, -v112, v112, v113
v_max_f32 v113, 0, v113
v_add_f32 v113, 0x3727c5ac, v113
v_rsq_f32 v113, v113
v_lshrrev_b32 v11, 5, v1
s_lshl_b32 s43, s47, 4
s_add_u32 s43, s43, 148608
v_lshl_add_u32 v11, v11, 3, s43
ds_write_b64 v11, v[112:113]
s_waitcnt lgkmcnt(0)
s_and_b32 s44, s36, 3
s_mul_i32 s44, s44, 24
s_bfe_u32 s43, s2, 0x30001
s_lshl_b32 s43, s43, 7
s_add_u32 s44, s44, s43
s_mul_i32 s44, s44, 7168
s_lshr_b32 s43, s2, 4
s_lshl_b32 s43, s43, 8
s_add_u32 s43, s43, s44
s_bitcmp0_b32 s2, 0
s_cselect_b32 s4, s72, s74
s_cselect_b32 s5, s73, s75
s_add_u32 s4, s4, s43
s_addc_u32 s5, s5, 0
s_waitcnt vmcnt(14)
s_barrier
s_add_u32 m0, s39, 0
s_mov_b64 exec, s[60:61]
buffer_load_dwordx4 v4, s[8:11], s37 offen lds
s_mov_b64 exec, -1
s_add_u32 m0, s39, 3072
s_nop 0
buffer_load_dwordx4 v5, s[8:11], s37 offen lds
s_add_u32 m0, s39, 6144
s_nop 0
buffer_load_dwordx4 v6, s[8:11], s37 offen lds
s_add_u32 m0, s39, 9216
s_nop 0
buffer_load_dwordx4 v7, s[8:11], s37 offen lds
s_add_u32 m0, s39, 12288
s_nop 0
buffer_load_dwordx4 v8, s[8:11], s37 offen lds
s_add_u32 m0, s39, 15360
s_nop 0
buffer_load_dwordx4 v9, s[8:11], s37 offen lds
s_add_u32 m0, s40, 0
s_add_u32 s43, s38, 0
buffer_load_dwordx4 v2, s[12:15], s43 offen lds
s_add_u32 m0, s40, 1024
s_add_u32 s43, s38, 49152
buffer_load_dwordx4 v3, s[12:15], s43 offen lds
s_add_u32 m0, s40, 2048
s_add_u32 s43, s38, 98304
buffer_load_dwordx4 v2, s[12:15], s43 offen lds
s_add_u32 m0, s40, 3072
s_add_u32 s43, s38, 147456
buffer_load_dwordx4 v3, s[12:15], s43 offen lds
s_add_u32 m0, s40, 4096
s_add_u32 s43, s38, 196608
buffer_load_dwordx4 v2, s[12:15], s43 offen lds
s_add_u32 m0, s40, 5120
s_add_u32 s43, s38, 245760
buffer_load_dwordx4 v3, s[12:15], s43 offen lds
s_add_u32 m0, s40, 6144
s_add_u32 s43, s38, 294912
buffer_load_dwordx4 v2, s[12:15], s43 offen lds
s_add_u32 m0, s40, 7168
s_add_u32 s43, s38, 344064
buffer_load_dwordx4 v3, s[12:15], s43 offen lds
s_add_u32 s37, s37, 128
s_add_u32 s38, s38, 393216
s_waitcnt vmcnt(14)
s_barrier
s_add_u32 m0, s39, 43008
s_mov_b64 exec, s[60:61]
buffer_load_dwordx4 v4, s[8:11], s37 offen lds
s_mov_b64 exec, -1
s_add_u32 m0, s39, 46080
s_nop 0
buffer_load_dwordx4 v5, s[8:11], s37 offen lds
s_add_u32 m0, s39, 49152
s_nop 0
buffer_load_dwordx4 v6, s[8:11], s37 offen lds
s_add_u32 m0, s39, 52224
s_nop 0
buffer_load_dwordx4 v7, s[8:11], s37 offen lds
s_add_u32 m0, s39, 55296
s_nop 0
buffer_load_dwordx4 v8, s[8:11], s37 offen lds
s_add_u32 m0, s39, 58368
s_nop 0
buffer_load_dwordx4 v9, s[8:11], s37 offen lds
s_add_u32 m0, s40, 43008
s_add_u32 s43, s38, 0
buffer_load_dwordx4 v2, s[12:15], s43 offen lds
s_add_u32 m0, s40, 44032
s_add_u32 s43, s38, 49152
buffer_load_dwordx4 v3, s[12:15], s43 offen lds
s_add_u32 m0, s40, 45056
s_add_u32 s43, s38, 98304
buffer_load_dwordx4 v2, s[12:15], s43 offen lds
s_add_u32 m0, s40, 46080
s_add_u32 s43, s38, 147456
buffer_load_dwordx4 v3, s[12:15], s43 offen lds
s_add_u32 m0, s40, 47104
s_add_u32 s43, s38, 196608
buffer_load_dwordx4 v2, s[12:15], s43 offen lds
s_add_u32 m0, s40, 48128
s_add_u32 s43, s38, 245760
buffer_load_dwordx4 v3, s[12:15], s43 offen lds
s_add_u32 m0, s40, 49152
s_add_u32 s43, s38, 294912
buffer_load_dwordx4 v2, s[12:15], s43 offen lds
s_add_u32 m0, s40, 50176
s_add_u32 s43, s38, 344064
buffer_load_dwordx4 v3, s[12:15], s43 offen lds
s_add_u32 s37, s37, 128
s_add_u32 s38, s38, 393216
s_load_dword s3, s[4:5], 0
s_load_dword s3, s[4:5], 64
s_load_dword s3, s[4:5], 128
s_waitcnt vmcnt(14)
s_barrier
s_add_u32 m0, s39, 86016
s_mov_b64 exec, s[60:61]
buffer_load_dwordx4 v4, s[8:11], s37 offen lds
s_mov_b64 exec, -1
s_add_u32 m0, s39, 89088
s_nop 0
buffer_load_dwordx4 v5, s[8:11], s37 offen lds
s_add_u32 m0, s39, 92160
s_nop 0
buffer_load_dwordx4 v6, s[8:11], s37 offen lds
s_add_u32 m0, s39, 95232
s_nop 0
buffer_load_dwordx4 v7, s[8:11], s37 offen lds
s_add_u32 m0, s39, 98304
s_nop 0
buffer_load_dwordx4 v8, s[8:11], s37 offen lds
s_add_u32 m0, s39, 101376
s_nop 0
buffer_load_dwordx4 v9, s[8:11], s37 offen lds
s_add_u32 m0, s40, 86016
s_add_u32 s43, s38, 0
buffer_load_dwordx4 v2, s[12:15], s43 offen lds
s_add_u32 m0, s40, 87040
s_add_u32 s43, s38, 49152
buffer_load_dwordx4 v3, s[12:15], s43 offen lds
s_add_u32 m0, s40, 88064
s_add_u32 s43, s38, 98304
buffer_load_dwordx4 v2, s[12:15], s43 offen lds
s_add_u32 m0, s40, 89088
s_add_u32 s43, s38, 147456
buffer_load_dwordx4 v3, s[12:15], s43 offen lds
s_add_u32 m0, s40, 90112
s_add_u32 s43, s38, 196608
buffer_load_dwordx4 v2, s[12:15], s43 offen lds
s_add_u32 m0, s40, 91136
s_add_u32 s43, s38, 245760
buffer_load_dwordx4 v3, s[12:15], s43 offen lds
s_add_u32 m0, s40, 92160
s_add_u32 s43, s38, 294912
buffer_load_dwordx4 v2, s[12:15], s43 offen lds
s_add_u32 m0, s40, 93184
s_add_u32 s43, s38, 344064
buffer_load_dwordx4 v3, s[12:15], s43 offen lds
s_add_u32 s37, s37, 128
s_add_u32 s38, s38, 393216
s_load_dword s3, s[4:5], 192
s_load_dword s3, s[4:5], 7168
s_load_dword s3, s[4:5], 7232
s_load_dword s3, s[4:5], 7296
s_waitcnt vmcnt(14)
s_barrier
s_add_u32 m0, s39, 0
s_mov_b64 exec, s[60:61]
buffer_load_dwordx4 v4, s[8:11], s37 offen lds
s_mov_b64 exec, -1
s_add_u32 m0, s39, 3072
s_nop 0
buffer_load_dwordx4 v5, s[8:11], s37 offen lds
s_add_u32 m0, s39, 6144
s_nop 0
buffer_load_dwordx4 v6, s[8:11], s37 offen lds
s_branch Lov_0
.p2align 12
Lst_0_0:
s_branch Lwr_167
s_nop 0
s_nop 0
Lov_0:
s_add_u32 m0, s39, 9216
s_nop 0
buffer_load_dwordx4 v7, s[8:11], s37 offen lds
s_add_u32 m0, s39, 12288
s_nop 0
buffer_load_dwordx4 v8, s[8:11], s37 offen lds
s_add_u32 m0, s39, 15360
s_nop 0
buffer_load_dwordx4 v9, s[8:11], s37 offen lds
s_add_u32 m0, s40, 0
s_add_u32 s43, s38, 0
buffer_load_dwordx4 v2, s[12:15], s43 offen lds
s_add_u32 m0, s40, 1024
s_add_u32 s43, s38, 49152
buffer_load_dwordx4 v3, s[12:15], s43 offen lds
s_add_u32 m0, s40, 2048
s_add_u32 s43, s38, 98304
buffer_load_dwordx4 v2, s[12:15], s43 offen lds
s_add_u32 m0, s40, 3072
s_add_u32 s43, s38, 147456
buffer_load_dwordx4 v3, s[12:15], s43 offen lds
s_add_u32 m0, s40, 4096
s_add_u32 s43, s38, 196608
buffer_load_dwordx4 v2, s[12:15], s43 offen lds
s_add_u32 m0, s40, 5120
s_add_u32 s43, s38, 245760
buffer_load_dwordx4 v3, s[12:15], s43 offen lds
s_add_u32 m0, s40, 6144
s_add_u32 s43, s38, 294912
buffer_load_dwordx4 v2, s[12:15], s43 offen lds
s_add_u32 m0, s40, 7168
s_add_u32 s43, s38, 344064
buffer_load_dwordx4 v3, s[12:15], s43 offen lds
s_add_u32 s37, s37, 128
s_add_u32 s38, s38, 393216
s_load_dword s3, s[4:5], 7360
s_load_dword s3, s[4:5], 14336
s_load_dword s3, s[4:5], 14400
s_load_dword s3, s[4:5], 14464
s_load_dword s3, s[4:5], 14528
s_waitcnt vmcnt(14)
s_barrier
s_add_u32 m0, s39, 43008
s_mov_b64 exec, s[60:61]
buffer_load_dwordx4 v4, s[8:11], s37 offen lds
s_mov_b64 exec, -1
s_add_u32 m0, s39, 46080
s_nop 0
buffer_load_dwordx4 v5, s[8:11], s37 offen lds
s_add_u32 m0, s39, 49152
s_nop 0
buffer_load_dwordx4 v6, s[8:11], s37 offen lds
s_add_u32 m0, s39, 52224
s_nop 0
buffer_load_dwordx4 v7, s[8:11], s37 offen lds
s_add_u32 m0, s39, 55296
s_nop 0
buffer_load_dwordx4 v8, s[8:11], s37 offen lds
s_add_u32 m0, s39, 58368
s_nop 0
buffer_load_dwordx4 v9, s[8:11], s37 offen lds
s_add_u32 m0, s40, 43008
s_add_u32 s43, s38, 0
buffer_load_dwordx4 v2, s[12:15], s43 offen lds
s_add_u32 m0, s40, 44032
s_add_u32 s43, s38, 49152
buffer_load_dwordx4 v3, s[12:15], s43 offen lds
s_add_u32 m0, s40, 45056
s_add_u32 s43, s38, 98304
buffer_load_dwordx4 v2, s[12:15], s43 offen lds
s_add_u32 m0, s40, 46080
s_add_u32 s43, s38, 147456
buffer_load_dwordx4 v3, s[12:15], s43 offen lds
s_add_u32 m0, s40, 47104
s_add_u32 s43, s38, 196608
buffer_load_dwordx4 v2, s[12:15], s43 offen lds
s_add_u32 m0, s40, 48128
s_add_u32 s43, s38, 245760
buffer_load_dwordx4 v3, s[12:15], s43 offen lds
s_add_u32 m0, s40, 49152
s_add_u32 s43, s38, 294912
buffer_load_dwordx4 v2, s[12:15], s43 offen lds
s_add_u32 m0, s40, 50176
s_add_u32 s43, s38, 344064
buffer_load_dwordx4 v3, s[12:15], s43 offen lds
s_add_u32 s37, s37, 128
s_add_u32 s38, s38, 393216
s_load_dword s3, s[4:5], 21504
s_load_dword s3, s[4:5], 21568
s_load_dword s3, s[4:5], 21632
s_load_dword s3, s[4:5], 21696
s_load_dword s3, s[4:5], 28672
s_load_dword s3, s[4:5], 28736
s_waitcnt vmcnt(14)
s_barrier
s_add_u32 m0, s39, 86016
s_mov_b64 exec, s[60:61]
buffer_load_dwordx4 v4, s[8:11], s37 offen lds
s_mov_b64 exec, -1
s_add_u32 m0, s39, 89088
s_nop 0
buffer_load_dwordx4 v5, s[8:11], s37 offen lds
s_add_u32 m0, s39, 92160
s_nop 0
buffer_load_dwordx4 v6, s[8:11], s37 offen lds
s_add_u32 m0, s39, 95232
s_nop 0
buffer_load_dwordx4 v7, s[8:11], s37 offen lds
s_add_u32 m0, s39, 98304
s_nop 0
buffer_load_dwordx4 v8, s[8:11], s37 offen lds
s_add_u32 m0, s39, 101376
s_nop 0
buffer_load_dwordx4 v9, s[8:11], s37 offen lds
s_add_u32 m0, s40, 86016
s_add_u32 s43, s38, 0
buffer_load_dwordx4 v2, s[12:15], s43 offen lds
s_add_u32 m0, s40, 87040
s_add_u32 s43, s38, 49152
buffer_load_dwordx4 v3, s[12:15], s43 offen lds
s_add_u32 m0, s40, 88064
s_add_u32 s43, s38, 98304
buffer_load_dwordx4 v2, s[12:15], s43 offen lds
s_add_u32 m0, s40, 89088
s_add_u32 s43, s38, 147456
buffer_load_dwordx4 v3, s[12:15], s43 offen lds
s_add_u32 m0, s40, 90112
s_add_u32 s43, s38, 196608
buffer_load_dwordx4 v2, s[12:15], s43 offen lds
s_add_u32 m0, s40, 91136
s_add_u32 s43, s38, 245760
buffer_load_dwordx4 v3, s[12:15], s43 offen lds
s_add_u32 m0, s40, 92160
s_add_u32 s43, s38, 294912
buffer_load_dwordx4 v2, s[12:15], s43 offen lds
s_add_u32 m0, s40, 93184
s_add_u32 s43, s38, 344064
buffer_load_dwordx4 v3, s[12:15], s43 offen lds
s_add_u32 s37, s37, 128
s_add_u32 s38, s38, 393216
s_load_dword s3, s[4:5], 28800
s_load_dword s3, s[4:5], 28864
s_load_dword s3, s[4:5], 35840
s_load_dword s3, s[4:5], 35904
s_load_dword s3, s[4:5], 35968
s_load_dword s3, s[4:5], 36032
s_load_dword s3, s[4:5], 43008
s_waitcnt vmcnt(14)
s_barrier
s_add_u32 m0, s39, 0
s_mov_b64 exec, s[60:61]
buffer_load_dwordx4 v4, s[8:11], s37 offen lds
s_mov_b64 exec, -1
s_add_u32 m0, s39, 3072
s_nop 0
buffer_load_dwordx4 v5, s[8:11], s37 offen lds
s_add_u32 m0, s39, 6144
s_nop 0
buffer_load_dwordx4 v6, s[8:11], s37 offen lds
s_add_u32 m0, s39, 9216
s_nop 0
buffer_load_dwordx4 v7, s[8:11], s37 offen lds
s_add_u32 m0, s39, 12288
s_nop 0
buffer_load_dwordx4 v8, s[8:11], s37 offen lds
s_add_u32 m0, s39, 15360
s_nop 0
buffer_load_dwordx4 v9, s[8:11], s37 offen lds
s_add_u32 m0, s40, 0
s_add_u32 s43, s38, 0
buffer_load_dwordx4 v2, s[12:15], s43 offen lds
s_add_u32 m0, s40, 1024
s_add_u32 s43, s38, 49152
buffer_load_dwordx4 v3, s[12:15], s43 offen lds
s_add_u32 m0, s40, 2048
s_add_u32 s43, s38, 98304
buffer_load_dwordx4 v2, s[12:15], s43 offen lds
s_add_u32 m0, s40, 3072
s_add_u32 s43, s38, 147456
buffer_load_dwordx4 v3, s[12:15], s43 offen lds
s_add_u32 m0, s40, 4096
s_add_u32 s43, s38, 196608
buffer_load_dwordx4 v2, s[12:15], s43 offen lds
s_add_u32 m0, s40, 5120
s_add_u32 s43, s38, 245760
buffer_load_dwordx4 v3, s[12:15], s43 offen lds
s_add_u32 m0, s40, 6144
s_add_u32 s43, s38, 294912
buffer_load_dwordx4 v2, s[12:15], s43 offen lds
s_add_u32 m0, s40, 7168
s_add_u32 s43, s38, 344064
buffer_load_dwordx4 v3, s[12:15], s43 offen lds
s_add_u32 s37, s37, 128
s_add_u32 s38, s38, 393216
s_load_dword s3, s[4:5], 43072
s_load_dword s3, s[4:5], 43136
s_load_dword s3, s[4:5], 43200
s_load_dword s3, s[4:5], 50176
s_load_dword s3, s[4:5], 50240
s_load_dword s3, s[4:5], 50304
s_load_dword s3, s[4:5], 50368
s_load_dword s3, s[4:5], 57344
s_waitcnt vmcnt(14)
s_barrier
s_add_u32 m0, s39, 43008
s_mov_b64 exec, s[60:61]
buffer_load_dwordx4 v4, s[8:11], s37 offen lds
s_mov_b64 exec, -1
s_add_u32 m0, s39, 46080
s_nop 0
buffer_load_dwordx4 v5, s[8:11], s37 offen lds
s_add_u32 m0, s39, 49152
s_nop 0
buffer_load_dwordx4 v6, s[8:11], s37 offen lds
s_add_u32 m0, s39, 52224
s_nop 0
buffer_load_dwordx4 v7, s[8:11], s37 offen lds
s_add_u32 m0, s39, 55296
s_nop 0
buffer_load_dwordx4 v8, s[8:11], s37 offen lds
s_add_u32 m0, s39, 58368
s_nop 0
buffer_load_dwordx4 v9, s[8:11], s37 offen lds
s_add_u32 m0, s40, 43008
s_add_u32 s43, s38, 0
buffer_load_dwordx4 v2, s[12:15], s43 offen lds
s_add_u32 m0, s40, 44032
s_add_u32 s43, s38, 49152
buffer_load_dwordx4 v3, s[12:15], s43 offen lds
s_add_u32 m0, s40, 45056
s_add_u32 s43, s38, 98304
buffer_load_dwordx4 v2, s[12:15], s43 offen lds
s_add_u32 m0, s40, 46080
s_add_u32 s43, s38, 147456
buffer_load_dwordx4 v3, s[12:15], s43 offen lds
s_add_u32 m0, s40, 47104
s_add_u32 s43, s38, 196608
buffer_load_dwordx4 v2, s[12:15], s43 offen lds
s_add_u32 m0, s40, 48128
s_add_u32 s43, s38, 245760
buffer_load_dwordx4 v3, s[12:15], s43 offen lds
s_add_u32 m0, s40, 49152
s_add_u32 s43, s38, 294912
buffer_load_dwordx4 v2, s[12:15], s43 offen lds
s_add_u32 m0, s40, 50176
s_add_u32 s43, s38, 344064
buffer_load_dwordx4 v3, s[12:15], s43 offen lds
s_add_u32 s37, s37, 128
s_add_u32 s38, s38, 393216
s_load_dword s3, s[4:5], 57408
s_load_dword s3, s[4:5], 57472
s_load_dword s3, s[4:5], 57536
s_load_dword s3, s[4:5], 64512
s_load_dword s3, s[4:5], 64576
s_load_dword s3, s[4:5], 64640
s_load_dword s3, s[4:5], 64704
s_load_dword s3, s[4:5], 71680
s_load_dword s3, s[4:5], 71744
s_waitcnt vmcnt(14)
s_barrier
s_add_u32 m0, s39, 86016
s_mov_b64 exec, s[60:61]
buffer_load_dwordx4 v4, s[8:11], s37 offen lds
s_mov_b64 exec, -1
s_add_u32 m0, s39, 89088
s_nop 0
buffer_load_dwordx4 v5, s[8:11], s37 offen lds
s_add_u32 m0, s39, 92160
s_nop 0
buffer_load_dwordx4 v6, s[8:11], s37 offen lds
s_add_u32 m0, s39, 95232
s_nop 0
buffer_load_dwordx4 v7, s[8:11], s37 offen lds
s_add_u32 m0, s39, 98304
s_nop 0
buffer_load_dwordx4 v8, s[8:11], s37 offen lds
s_add_u32 m0, s39, 101376
s_nop 0
buffer_load_dwordx4 v9, s[8:11], s37 offen lds
s_add_u32 m0, s40, 86016
s_add_u32 s43, s38, 0
buffer_load_dwordx4 v2, s[12:15], s43 offen lds
s_add_u32 m0, s40, 87040
s_add_u32 s43, s38, 49152
buffer_load_dwordx4 v3, s[12:15], s43 offen lds
s_add_u32 m0, s40, 88064
s_add_u32 s43, s38, 98304
buffer_load_dwordx4 v2, s[12:15], s43 offen lds
s_add_u32 m0, s40, 89088
s_add_u32 s43, s38, 147456
buffer_load_dwordx4 v3, s[12:15], s43 offen lds
s_add_u32 m0, s40, 90112
s_add_u32 s43, s38, 196608
buffer_load_dwordx4 v2, s[12:15], s43 offen lds
s_add_u32 m0, s40, 91136
s_add_u32 s43, s38, 245760
buffer_load_dwordx4 v3, s[12:15], s43 offen lds
s_add_u32 m0, s40, 92160
s_add_u32 s43, s38, 294912
buffer_load_dwordx4 v2, s[12:15], s43 offen lds
s_add_u32 m0, s40, 93184
s_add_u32 s43, s38, 344064
buffer_load_dwordx4 v3, s[12:15], s43 offen lds
s_add_u32 s37, s37, 128
s_add_u32 s38, s38, 393216
s_load_dword s3, s[4:5], 71808
s_load_dword s3, s[4:5], 71872
s_load_dword s3, s[4:5], 78848
s_load_dword s3, s[4:5], 78912
s_load_dword s3, s[4:5], 78976
s_load_dword s3, s[4:5], 79040
s_load_dword s3, s[4:5], 86016
s_load_dword s3, s[4:5], 86080
s_load_dword s3, s[4:5], 86144
s_waitcnt vmcnt(14)
s_barrier
s_add_u32 m0, s39, 0
s_mov_b64 exec, s[60:61]
buffer_load_dwordx4 v4, s[8:11], s37 offen lds
s_mov_b64 exec, -1
s_add_u32 m0, s39, 3072
s_nop 0
buffer_load_dwordx4 v5, s[8:11], s37 offen lds
s_add_u32 m0, s39, 6144
s_nop 0
buffer_load_dwordx4 v6, s[8:11], s37 offen lds
s_add_u32 m0, s39, 9216
s_nop 0
buffer_load_dwordx4 v7, s[8:11], s37 offen lds
s_add_u32 m0, s39, 12288
s_nop 0
buffer_load_dwordx4 v8, s[8:11], s37 offen lds
s_add_u32 m0, s39, 15360
s_nop 0
buffer_load_dwordx4 v9, s[8:11], s37 offen lds
s_add_u32 m0, s40, 0
s_add_u32 s43, s38, 0
buffer_load_dwordx4 v2, s[12:15], s43 offen lds
s_add_u32 m0, s40, 1024
s_add_u32 s43, s38, 49152
buffer_load_dwordx4 v3, s[12:15], s43 offen lds
s_add_u32 m0, s40, 2048
s_add_u32 s43, s38, 98304
buffer_load_dwordx4 v2, s[12:15], s43 offen lds
s_add_u32 m0, s40, 3072
s_add_u32 s43, s38, 147456
buffer_load_dwordx4 v3, s[12:15], s43 offen lds
s_add_u32 m0, s40, 4096
s_add_u32 s43, s38, 196608
buffer_load_dwordx4 v2, s[12:15], s43 offen lds
s_add_u32 m0, s40, 5120
s_add_u32 s43, s38, 245760
buffer_load_dwordx4 v3, s[12:15], s43 offen lds
s_add_u32 m0, s40, 6144
s_add_u32 s43, s38, 294912
buffer_load_dwordx4 v2, s[12:15], s43 offen lds
s_add_u32 m0, s40, 7168
s_add_u32 s43, s38, 344064
buffer_load_dwordx4 v3, s[12:15], s43 offen lds
s_add_u32 s37, s37, 128
s_add_u32 s38, s38, 393216
s_load_dword s3, s[4:5], 86208
s_load_dword s3, s[4:5], 93184
s_load_dword s3, s[4:5], 93248
s_load_dword s3, s[4:5], 93312
s_load_dword s3, s[4:5], 93376
s_load_dword s3, s[4:5], 100352
s_load_dword s3, s[4:5], 100416
s_load_dword s3, s[4:5], 100480
s_load_dword s3, s[4:5], 100544
s_waitcnt vmcnt(14)
s_barrier
s_add_u32 m0, s39, 43008
s_mov_b64 exec, s[60:61]
buffer_load_dwordx4 v4, s[8:11], s37 offen lds
s_mov_b64 exec, -1
s_add_u32 m0, s39, 46080
s_nop 0
buffer_load_dwordx4 v5, s[8:11], s37 offen lds
s_add_u32 m0, s39, 49152
s_nop 0
buffer_load_dwordx4 v6, s[8:11], s37 offen lds
s_add_u32 m0, s39, 52224
s_nop 0
buffer_load_dwordx4 v7, s[8:11], s37 offen lds
s_add_u32 m0, s39, 55296
s_nop 0
buffer_load_dwordx4 v8, s[8:11], s37 offen lds
s_add_u32 m0, s39, 58368
s_nop 0
buffer_load_dwordx4 v9, s[8:11], s37 offen lds
s_add_u32 m0, s40, 43008
s_add_u32 s43, s38, 0
buffer_load_dwordx4 v2, s[12:15], s43 offen lds
s_add_u32 m0, s40, 44032
s_add_u32 s43, s38, 49152
buffer_load_dwordx4 v3, s[12:15], s43 offen lds
s_add_u32 m0, s40, 45056
s_add_u32 s43, s38, 98304
buffer_load_dwordx4 v2, s[12:15], s43 offen lds
s_add_u32 m0, s40, 46080
s_add_u32 s43, s38, 147456
buffer_load_dwordx4 v3, s[12:15], s43 offen lds
s_add_u32 m0, s40, 47104
s_add_u32 s43, s38, 196608
buffer_load_dwordx4 v2, s[12:15], s43 offen lds
s_add_u32 m0, s40, 48128
s_add_u32 s43, s38, 245760
buffer_load_dwordx4 v3, s[12:15], s43 offen lds
s_add_u32 m0, s40, 49152
s_add_u32 s43, s38, 294912
buffer_load_dwordx4 v2, s[12:15], s43 offen lds
s_add_u32 m0, s40, 50176
s_add_u32 s43, s38, 344064
buffer_load_dwordx4 v3, s[12:15], s43 offen lds
s_add_u32 s37, s37, 128
s_add_u32 s38, s38, 393216
s_load_dword s3, s[4:5], 107520
s_load_dword s3, s[4:5], 107584
s_load_dword s3, s[4:5], 107648
s_load_dword s3, s[4:5], 107712
s_load_dword s3, s[4:5], 114688
s_load_dword s3, s[4:5], 114752
s_load_dword s3, s[4:5], 114816
s_load_dword s3, s[4:5], 114880
s_load_dword s3, s[4:5], 121856
s_waitcnt vmcnt(14)
s_barrier
s_add_u32 m0, s39, 86016
s_mov_b64 exec, s[60:61]
buffer_load_dwordx4 v4, s[8:11], s37 offen lds
s_mov_b64 exec, -1
s_add_u32 m0, s39, 89088
s_nop 0
buffer_load_dwordx4 v5, s[8:11], s37 offen lds
s_add_u32 m0, s39, 92160
s_nop 0
buffer_load_dwordx4 v6, s[8:11], s37 offen lds
s_add_u32 m0, s39, 95232
s_nop 0
buffer_load_dwordx4 v7, s[8:11], s37 offen lds
s_add_u32 m0, s39, 98304
s_nop 0
buffer_load_dwordx4 v8, s[8:11], s37 offen lds
s_add_u32 m0, s39, 101376
s_nop 0
buffer_load_dwordx4 v9, s[8:11], s37 offen lds
s_add_u32 m0, s40, 86016
s_add_u32 s43, s38, 0
buffer_load_dwordx4 v2, s[12:15], s43 offen lds
s_add_u32 m0, s40, 87040
s_add_u32 s43, s38, 49152
buffer_load_dwordx4 v3, s[12:15], s43 offen lds
s_add_u32 m0, s40, 88064
s_add_u32 s43, s38, 98304
buffer_load_dwordx4 v2, s[12:15], s43 offen lds
s_add_u32 m0, s40, 89088
s_add_u32 s43, s38, 147456
buffer_load_dwordx4 v3, s[12:15], s43 offen lds
s_add_u32 m0, s40, 90112
s_add_u32 s43, s38, 196608
buffer_load_dwordx4 v2, s[12:15], s43 offen lds
s_add_u32 m0, s40, 91136
s_add_u32 s43, s38, 245760
buffer_load_dwordx4 v3, s[12:15], s43 offen lds
s_add_u32 m0, s40, 92160
s_add_u32 s43, s38, 294912
buffer_load_dwordx4 v2, s[12:15], s43 offen lds
s_add_u32 m0, s40, 93184
s_add_u32 s43, s38, 344064
buffer_load_dwordx4 v3, s[12:15], s43 offen lds
s_add_u32 s37, s37, 128
s_add_u32 s38, s38, 393216
s_load_dword s3, s[4:5], 121920
s_load_dword s3, s[4:5], 121984
s_load_dword s3, s[4:5], 122048
s_load_dword s3, s[4:5], 129024
s_load_dword s3, s[4:5], 129088
s_load_dword s3, s[4:5], 129152
s_load_dword s3, s[4:5], 129216
s_load_dword s3, s[4:5], 136192
s_load_dword s3, s[4:5], 136256
s_waitcnt vmcnt(14)
s_barrier
s_add_u32 m0, s39, 0
s_mov_b64 exec, s[60:61]
buffer_load_dwordx4 v4, s[8:11], s37 offen lds
s_mov_b64 exec, -1
s_add_u32 m0, s39, 3072
s_nop 0
buffer_load_dwordx4 v5, s[8:11], s37 offen lds
s_add_u32 m0, s39, 6144
s_nop 0
buffer_load_dwordx4 v6, s[8:11], s37 offen lds
s_add_u32 m0, s39, 9216
s_nop 0
buffer_load_dwordx4 v7, s[8:11], s37 offen lds
s_add_u32 m0, s39, 12288
s_nop 0
buffer_load_dwordx4 v8, s[8:11], s37 offen lds
s_add_u32 m0, s39, 15360
s_nop 0
buffer_load_dwordx4 v9, s[8:11], s37 offen lds
s_add_u32 m0, s40, 0
s_add_u32 s43, s38, 0
buffer_load_dwordx4 v2, s[12:15], s43 offen lds
s_add_u32 m0, s40, 1024
s_add_u32 s43, s38, 49152
buffer_load_dwordx4 v3, s[12:15], s43 offen lds
s_add_u32 m0, s40, 2048
s_add_u32 s43, s38, 98304
buffer_load_dwordx4 v2, s[12:15], s43 offen lds
s_add_u32 m0, s40, 3072
s_add_u32 s43, s38, 147456
buffer_load_dwordx4 v3, s[12:15], s43 offen lds
s_add_u32 m0, s40, 4096
s_add_u32 s43, s38, 196608
buffer_load_dwordx4 v2, s[12:15], s43 offen lds
s_add_u32 m0, s40, 5120
s_add_u32 s43, s38, 245760
buffer_load_dwordx4 v3, s[12:15], s43 offen lds
s_add_u32 m0, s40, 6144
s_add_u32 s43, s38, 294912
buffer_load_dwordx4 v2, s[12:15], s43 offen lds
s_add_u32 m0, s40, 7168
s_add_u32 s43, s38, 344064
buffer_load_dwordx4 v3, s[12:15], s43 offen lds
s_add_u32 s37, s37, 128
s_add_u32 s38, s38, 393216
s_load_dword s3, s[4:5], 136320
s_load_dword s3, s[4:5], 136384
s_load_dword s3, s[4:5], 143360
s_load_dword s3, s[4:5], 143424
s_load_dword s3, s[4:5], 143488
s_load_dword s3, s[4:5], 143552
s_load_dword s3, s[4:5], 150528
s_load_dword s3, s[4:5], 150592
s_load_dword s3, s[4:5], 150656
s_waitcnt vmcnt(14)
s_barrier
s_load_dword s3, s[4:5], 150720
s_load_dword s3, s[4:5], 157696
s_load_dword s3, s[4:5], 157760
s_load_dword s3, s[4:5], 157824
s_load_dword s3, s[4:5], 157888
s_load_dword s3, s[4:5], 164864
s_load_dword s3, s[4:5], 164928
s_load_dword s3, s[4:5], 164992
s_load_dword s3, s[4:5], 165056
s_waitcnt vmcnt(0)
s_barrier
s_bitcmp0_b32 s2, 0
s_cselect_b32 s88, s72, s74
s_cselect_b32 s89, s73, s75
s_cmp_lt_u32 s2, 192
s_cselect_b32 s90, 7340032, 0
s_mov_b32 s91, 0x20000
s_bfe_u32 s44, s2, 0x30001
s_lshl_b32 s44, s44, 2
s_and_b32 s43, s36, 3
s_add_u32 s44, s44, s43
s_lshl_b32 s44, s44, 5
v_lshrrev_b32 v18, 4, v1
v_add_u32 v18, s44, v18
v_mul_u32_u24 v18, 7168, v18
v_and_b32 v19, 15, v1
v_lshl_add_u32 v18, v19, 4, v18
s_lshr_b32 s43, s2, 4
s_branch Lov_1
.p2align 12
Lst_1_0:
s_branch Lwr_168
s_nop 0
s_nop 0
Lov_1:
s_lshl_b32 s43, s43, 8
s_add_u32 s43, s43, 4096
v_add_u32 v18, s43, v18
s_mov_b32 s43, 0
buffer_load_dwordx4 v[128:131], v18, s[88:91], s43 offen
s_mov_b32 s43, 28672
buffer_load_dwordx4 v[132:135], v18, s[88:91], s43 offen
s_mov_b32 s43, 57344
buffer_load_dwordx4 v[136:139], v18, s[88:91], s43 offen
s_mov_b32 s43, 86016
buffer_load_dwordx4 v[140:143], v18, s[88:91], s43 offen
s_mov_b32 s43, 114688
buffer_load_dwordx4 v[144:147], v18, s[88:91], s43 offen
s_mov_b32 s43, 143360
buffer_load_dwordx4 v[148:151], v18, s[88:91], s43 offen
s_mov_b32 s43, 172032
buffer_load_dwordx4 v[152:155], v18, s[88:91], s43 offen
s_mov_b32 s43, 200704
buffer_load_dwordx4 v[156:159], v18, s[88:91], s43 offen
s_barrier
s_lshl_b32 s43, s35, 7
s_add_u32 s28, s68, s43
s_addc_u32 s29, s69, 0
s_mov_b32 s30, 2095232
s_mov_b32 s31, 0x20000
v_lshrrev_b32 v15, 3, v1
v_and_b32 v16, 6, v15
v_and_b32 v7, 7, v1
v_xor_b32 v7, v7, v16
v_lshlrev_b32 v7, 4, v7
v_mul_u32_u24 v15, 2048, v15
v_add_u32 v7, v7, v15
s_and_b32 s40, s36, 3
s_lshl_b32 s39, s40, 13
s_add_u32 s40, s40, s35
s_add_u32 s42, s40, 0
s_and_b32 s42, s42, 15
s_lshl_b32 s42, s42, 17
s_add_u32 m0, s39, 65536
s_add_u32 s43, s42, 0
buffer_load_dwordx4 v7, s[28:31], s43 offen lds
s_add_u32 m0, s39, 66560
s_add_u32 s43, s42, 16384
buffer_load_dwordx4 v7, s[28:31], s43 offen lds
s_add_u32 m0, s39, 67584
s_add_u32 s43, s42, 32768
buffer_load_dwordx4 v7, s[28:31], s43 offen lds
s_add_u32 m0, s39, 68608
s_add_u32 s43, s42, 49152
buffer_load_dwordx4 v7, s[28:31], s43 offen lds
s_add_u32 m0, s39, 69632
s_add_u32 s43, s42, 65536
buffer_load_dwordx4 v7, s[28:31], s43 offen lds
s_add_u32 m0, s39, 70656
s_add_u32 s43, s42, 81920
buffer_load_dwordx4 v7, s[28:31], s43 offen lds
s_add_u32 m0, s39, 71680
s_add_u32 s43, s42, 98304
buffer_load_dwordx4 v7, s[28:31], s43 offen lds
s_add_u32 m0, s39, 72704
s_add_u32 s43, s42, 114688
buffer_load_dwordx4 v7, s[28:31], s43 offen lds
s_branch Lats_6
Lcons_7:
s_lshl_b32 s43, s35, 7
s_waitcnt lgkmcnt(0)
s_mov_b32 s8, s64
s_mov_b32 s9, s65
s_mov_b32 s10, 4194304
s_mov_b32 s11, 0x20000
s_add_u32 s12, s66, s43
s_addc_u32 s13, s67, 0
s_mov_b32 s14, 6289536
s_mov_b32 s15, 0x20000
s_lshr_b32 s43, s2, 3
s_lshl_b32 s43, s43, 2
s_add_u32 s43, s43, s36
s_sub_u32 s44, s43, 0
s_and_b32 s44, s44, 127
s_cmp_lt_u32 s44, 7
s_cbranch_scc0 Lt_8
s_lshl_b32 s44, s44, 20
s_min_u32 s44, s44, 6291392
s_load_dword s3, s[66:67], s44
Lt_8:
s_sub_u32 s44, s43, 7
s_and_b32 s44, s44, 127
s_cmp_lt_u32 s44, 5
s_cbranch_scc0 Lt_9
s_lshl_b32 s44, s44, 20
s_min_u32 s44, s44, 4194240
s_load_dword s3, s[64:65], s44
Lt_9:
s_sub_u32 s44, s43, 12
s_and_b32 s44, s44, 127
s_cmp_lt_u32 s44, 1
s_cbranch_scc0 Lt_10
s_lshl_b32 s44, s44, 20
s_min_u32 s44, s44, 0
s_load_dword s3, s[80:81], s44 glc
Lt_10:
s_sub_u32 s44, s43, 13
s_and_b32 s44, s44, 127
s_cmp_lt_u32 s44, 24
s_cbranch_scc0 Lt_11
s_lshl_b32 s44, s44, 20
s_min_u32 s44, s44, 24117184
s_load_dword s3, s[82:83], s44 glc
Lt_11:
s_sub_u32 s44, s43, 37
s_and_b32 s44, s44, 127
s_cmp_lt_u32 s44, 8
s_cbranch_scc0 Lt_12
s_lshl_b32 s44, s44, 20
s_min_u32 s44, s44, 7339968
s_load_dword s3, s[72:73], s44
Lt_12:
s_sub_u32 s44, s43, 45
s_and_b32 s44, s44, 127
s_cmp_lt_u32 s44, 8
s_cbranch_scc0 Lt_13
s_lshl_b32 s44, s44, 20
s_min_u32 s44, s44, 7339968
s_load_dword s3, s[74:75], s44
Lt_13:
s_sub_u32 s44, s43, 53
s_and_b32 s44, s44, 127
s_cmp_lt_u32 s44, 3
s_cbranch_scc0 Lt_14
s_lshl_b32 s44, s44, 20
s_min_u32 s44, s44, 2097088
s_load_dword s3, s[68:69], s44
Lt_14:
s_sub_u32 s44, s43, 56
s_and_b32 s44, s44, 127
s_cmp_lt_u32 s44, 5
s_cbranch_scc0 Lt_15
s_lshl_b32 s44, s44, 20
s_min_u32 s44, s44, 4194240
s_add_u32 s44, s44, 25165824
s_load_dword s3, s[82:83], s44 glc
Lt_15:
s_sub_u32 s44, s43, 61
s_and_b32 s44, s44, 127
s_cmp_lt_u32 s44, 8
s_cbranch_scc0 Lt_16
s_lshl_b32 s44, s44, 20
s_min_u32 s44, s44, 7339968
s_load_dword s3, s[76:77], s44
Lt_16:
s_sub_u32 s44, s43, 69
s_and_b32 s44, s44, 127
s_cmp_lt_u32 s44, 5
s_cbranch_scc0 Lt_17
s_lshl_b32 s44, s44, 20
s_min_u32 s44, s44, 4194240
s_add_u32 s44, s44, 33554432
s_load_dword s3, s[82:83], s44 glc
Lt_17:
s_sub_u32 s44, s43, 74
s_and_b32 s44, s44, 127
s_cmp_lt_u32 s44, 5
s_cbranch_scc0 Lt_18
s_lshl_b32 s44, s44, 20
s_min_u32 s44, s44, 4194240
s_load_dword s3, s[78:79], s44 glc
Lt_18:
v_lshrrev_b32 v16, 1, v12
v_xor_b32 v15, v13, v16
v_lshlrev_b32 v15, 4, v15
v_lshl_add_u32 v2, v12, 7, v15
v_xor_b32 v3, 64, v2
v_add_u32 v4, 86016, v2
v_add_u32 v5, 86016, v3
v_lshrrev_b32 v15, 2, v12
v_and_b32 v16, 3, v1
v_lshl_add_u32 v19, v13, 3, v15
v_lshlrev_b32 v19, 7, v19
v_and_b32 v15, 2, v15
v_and_b32 v17, 1, v13
v_lshl_add_u32 v15, v17, 2, v15
v_lshrrev_b32 v17, 1, v16
s_lshl_b32 s43, s36, 1
v_add_u32 v17, s43, v17
v_xor_b32 v15, v15, v17
v_lshl_add_u32 v19, v15, 4, v19
v_and_b32 v16, 1, v16
v_lshl_add_u32 v19, v16, 3, v19
v_add_u32 v6, 18432, v19
v_add_u32 v7, 61440, v19
v_add_u32 v8, 104448, v19
s_and_b32 s43, s36, 1
s_bfe_u32 s44, s36, 0x10001
s_lshr_b32 s45, s36, 2
v_lshlrev_b32 v14, 2, v13
v_sub_u32 v14, v12, v14
v_mov_b32 v16, 0xff800000
s_or_b32 s46, s34, s45
s_cmp_lg_u32 s46, 0
s_cselect_b32 s46, 0, 0xff800000
v_subrev_u32 v15, 0, v14
v_cmp_ge_u32 vcc, 7, v15
v_add_u32 v15, 16, v15
s_nop 0
v_cndmask_b32 v248, v16, 0, vcc
v_cmp_ge_u32 vcc, 7, v15
s_nop 1
v_cndmask_b32 v244, v16, 0, vcc
v_or_b32 v240, s46, v244
v_subrev_u32 v15, 1, v14
v_cmp_ge_u32 vcc, 7, v15
v_add_u32 v15, 16, v15
s_nop 0
v_cndmask_b32 v249, v16, 0, vcc
v_cmp_ge_u32 vcc, 7, v15
s_nop 1
v_cndmask_b32 v245, v16, 0, vcc
v_or_b32 v241, s46, v245
v_subrev_u32 v15, 2, v14
v_cmp_ge_u32 vcc, 7, v15
v_add_u32 v15, 16, v15
s_nop 0
v_cndmask_b32 v250, v16, 0, vcc
v_cmp_ge_u32 vcc, 7, v15
s_nop 1
v_cndmask_b32 v246, v16, 0, vcc
v_or_b32 v242, s46, v246
v_subrev_u32 v15, 3, v14
v_cmp_ge_u32 vcc, 7, v15
v_add_u32 v15, 16, v15
s_nop 0
v_cndmask_b32 v251, v16, 0, vcc
v_cmp_ge_u32 vcc, 7, v15
s_nop 1
v_cndmask_b32 v247, v16, 0, vcc
v_or_b32 v243, s46, v247
s_lshl_b32 s46, s45, 6
s_add_u32 s46, s46, s44
s_add_u32 s46, s46, 16
v_lshl_add_u32 v14, v12, 1, s46
s_lshl_b32 s47, s43, 6
v_lshl_add_u32 v15, v13, 4, s47
v_mul_u32_u24 v20, 400, v14
v_add_u32 v20, v20, v15
v_subrev_u32 v16, 32, v14
v_max_i32 v16, 0, v16
v_mul_u32_u24 v21, 400, v16
v_add_u32 v21, v21, v15
v_lshrrev_b32 v16, 2, v12
v_lshl_add_u32 v16, v13, 2, v16
v_lshl_add_u32 v16, v16, 1, s46
v_and_b32 v17, 3, v1
v_lshl_add_u32 v17, v17, 3, s47
v_mul_u32_u24 v22, 400, v16
v_add_u32 v22, v22, v17
v_subrev_u32 v16, 32, v16
v_max_i32 v16, 0, v16
v_mul_u32_u24 v23, 400, v16
v_add_u32 v23, v23, v17
s_mul_i32 s60, s34, 262144
s_add_u32 s16, s82, s60
s_addc_u32 s17, s83, 0
s_mov_b32 s18, 262144
s_mov_b32 s19, 0x20000
s_lshl_b32 s60, s35, 14
s_lshl_b32 s43, s43, 13
s_add_u32 s60, s60, s43
s_lshl_b32 s43, s45, 12
s_add_u32 s60, s60, s43
s_lshl_b32 s43, s44, 10
s_add_u32 s60, s60, s43
v_lshlrev_b32 v24, 4, v1
s_mov_b32 s61, 0x3e8293ee
s_lshl_b32 s38, s35, 7
s_add_u32 s56, s82, 28311552
s_addc_u32 s57, s83, 0
s_mov_b32 s58, 114688
s_mov_b32 s59, 0x20000
s_barrier
ds_read_b128 v[32:35], v2 offset:0
ds_read_b64_tr_b16 v[72:73], v6 offset:8192
ds_read_b64_tr_b16 v[74:75], v6 offset:8704
ds_read_b64_tr_b16 v[76:77], v6 offset:16384
ds_read_b64_tr_b16 v[78:79], v6 offset:16896
ds_read_b64_tr_b16 v[68:69], v6 offset:0
ds_read_b64_tr_b16 v[70:71], v6 offset:512
ds_read_b128 v[36:39], v2 offset:2048
ds_read_b128 v[40:43], v2 offset:4096
ds_read_b128 v[44:47], v2 offset:6144
ds_read_b128 v[48:51], v2 offset:8192
ds_read_b128 v[52:55], v2 offset:10240
ds_read_b128 v[56:59], v2 offset:12288
ds_read_b128 v[60:63], v2 offset:14336
ds_read_b128 v[64:67], v2 offset:16384
s_waitcnt lgkmcnt(0)
v_mfma_f32_16x16x32_bf16 v[164:167], v[72:75], v[32:35], 0
ds_read_b128 v[80:83], v3 offset:0
v_mfma_f32_16x16x32_bf16 v[200:203], v[76:79], v[32:35], 0
ds_read_b64_tr_b16 v[120:121], v6 offset:12288
v_mfma_f32_16x16x32_bf16 v[128:131], v[68:71], v[32:35], 0
ds_read_b64_tr_b16 v[122:123], v6 offset:12800
v_mfma_f32_16x16x32_bf16 v[132:135], v[68:71], v[36:39], 0
ds_read_b64_tr_b16 v[124:125], v6 offset:20480
v_mfma_f32_16x16x32_bf16 v[204:207], v[76:79], v[36:39], 0
ds_read_b64_tr_b16 v[126:127], v6 offset:20992
v_mfma_f32_16x16x32_bf16 v[168:171], v[72:75], v[36:39], 0
ds_read_b64_tr_b16 v[116:117], v6 offset:4096
v_mfma_f32_16x16x32_bf16 v[172:175], v[72:75], v[40:43], 0
ds_read_b64_tr_b16 v[118:119], v6 offset:4608
v_mfma_f32_16x16x32_bf16 v[208:211], v[76:79], v[40:43], 0
ds_read_b128 v[84:87], v3 offset:2048
v_mfma_f32_16x16x32_bf16 v[136:139], v[68:71], v[40:43], 0
ds_read_b128 v[88:91], v3 offset:4096
v_mfma_f32_16x16x32_bf16 v[140:143], v[68:71], v[44:47], 0
ds_read_b128 v[92:95], v3 offset:6144
v_mfma_f32_16x16x32_bf16 v[212:215], v[76:79], v[44:47], 0
ds_read_b128 v[96:99], v3 offset:8192
v_mfma_f32_16x16x32_bf16 v[176:179], v[72:75], v[44:47], 0
ds_read_b128 v[100:103], v3 offset:10240
v_mfma_f32_16x16x32_bf16 v[180:183], v[72:75], v[48:51], 0
ds_read_b128 v[104:107], v3 offset:12288
v_mfma_f32_16x16x32_bf16 v[216:219], v[76:79], v[48:51], 0
ds_read_b128 v[108:111], v3 offset:14336
v_mfma_f32_16x16x32_bf16 v[144:147], v[68:71], v[48:51], 0
ds_read_b128 v[112:115], v3 offset:16384
v_mfma_f32_16x16x32_bf16 v[148:151], v[68:71], v[52:55], 0
v_mfma_f32_16x16x32_bf16 v[220:223], v[76:79], v[52:55], 0
v_mfma_f32_16x16x32_bf16 v[184:187], v[72:75], v[52:55], 0
v_mfma_f32_16x16x32_bf16 v[188:191], v[72:75], v[56:59], 0
v_mfma_f32_16x16x32_bf16 v[224:227], v[76:79], v[56:59], 0
v_mfma_f32_16x16x32_bf16 v[152:155], v[68:71], v[56:59], 0
v_mfma_f32_16x16x32_bf16 v[156:159], v[68:71], v[60:63], 0
v_mfma_f32_16x16x32_bf16 v[228:231], v[76:79], v[60:63], 0
v_mfma_f32_16x16x32_bf16 v[192:195], v[72:75], v[60:63], 0
v_mfma_f32_16x16x32_bf16 v[196:199], v[72:75], v[64:67], 0
v_mfma_f32_16x16x32_bf16 v[232:235], v[76:79], v[64:67], 0
v_mfma_f32_16x16x32_bf16 v[160:163], v[68:71], v[64:67], 0
s_waitcnt lgkmcnt(0)
s_barrier
v_mfma_f32_16x16x32_bf16 v[164:167], v[120:123], v[80:83], v[164:167]
ds_read_b128 v[32:35], v2 offset:43008
v_mfma_f32_16x16x32_bf16 v[200:203], v[124:127], v[80:83], v[200:203]
ds_read_b64_tr_b16 v[72:73], v7 offset:8192
v_mfma_f32_16x16x32_bf16 v[128:131], v[116:119], v[80:83], v[128:131]
ds_read_b64_tr_b16 v[74:75], v7 offset:8704
v_mfma_f32_16x16x32_bf16 v[132:135], v[116:119], v[84:87], v[132:135]
ds_read_b64_tr_b16 v[76:77], v7 offset:16384
v_mfma_f32_16x16x32_bf16 v[204:207], v[124:127], v[84:87], v[204:207]
ds_read_b64_tr_b16 v[78:79], v7 offset:16896
v_mfma_f32_16x16x32_bf16 v[168:171], v[120:123], v[84:87], v[168:171]
ds_read_b64_tr_b16 v[68:69], v7 offset:0
v_mfma_f32_16x16x32_bf16 v[172:175], v[120:123], v[88:91], v[172:175]
ds_read_b64_tr_b16 v[70:71], v7 offset:512
v_mfma_f32_16x16x32_bf16 v[208:211], v[124:127], v[88:91], v[208:211]
ds_read_b128 v[36:39], v2 offset:45056
v_mfma_f32_16x16x32_bf16 v[136:139], v[116:119], v[88:91], v[136:139]
ds_read_b128 v[40:43], v2 offset:47104
v_mfma_f32_16x16x32_bf16 v[140:143], v[116:119], v[92:95], v[140:143]
ds_read_b128 v[44:47], v2 offset:49152
v_mfma_f32_16x16x32_bf16 v[212:215], v[124:127], v[92:95], v[212:215]
ds_read_b128 v[48:51], v2 offset:51200
v_mfma_f32_16x16x32_bf16 v[176:179], v[120:123], v[92:95], v[176:179]
ds_read_b128 v[52:55], v2 offset:53248
v_mfma_f32_16x16x32_bf16 v[180:183], v[120:123], v[96:99], v[180:183]
ds_read_b128 v[56:59], v2 offset:55296
v_mfma_f32_16x16x32_bf16 v[216:219], v[124:127], v[96:99], v[216:219]
ds_read_b128 v[60:63], v2 offset:57344
v_mfma_f32_16x16x32_bf16 v[144:147], v[116:119], v[96:99], v[144:147]
ds_read_b128 v[64:67], v2 offset:59392
v_mfma_f32_16x16x32_bf16 v[148:151], v[116:119], v[100:103], v[148:151]
v_mfma_f32_16x16x32_bf16 v[220:223], v[124:127], v[100:103], v[220:223]
v_mfma_f32_16x16x32_bf16 v[184:187], v[120:123], v[100:103], v[184:187]
v_mfma_f32_16x16x32_bf16 v[188:191], v[120:123], v[104:107], v[188:191]
v_mfma_f32_16x16x32_bf16 v[224:227], v[124:127], v[104:107], v[224:227]
v_mfma_f32_16x16x32_bf16 v[152:155], v[116:119], v[104:107], v[152:155]
v_mfma_f32_16x16x32_bf16 v[156:159], v[116:119], v[108:111], v[156:159]
v_mfma_f32_16x16x32_bf16 v[228:231], v[124:127], v[108:111], v[228:231]
v_mfma_f32_16x16x32_bf16 v[192:195], v[120:123], v[108:111], v[192:195]
v_mfma_f32_16x16x32_bf16 v[196:199], v[120:123], v[112:115], v[196:199]
v_mfma_f32_16x16x32_bf16 v[232:235], v[124:127], v[112:115], v[232:235]
v_mfma_f32_16x16x32_bf16 v[160:163], v[116:119], v[112:115], v[160:163]
s_waitcnt lgkmcnt(0)
v_mfma_f32_16x16x32_bf16 v[164:167], v[72:75], v[32:35], v[164:167]
ds_read_b128 v[80:83], v3 offset:43008
v_mfma_f32_16x16x32_bf16 v[200:203], v[76:79], v[32:35], v[200:203]
ds_read_b64_tr_b16 v[120:121], v7 offset:12288
v_mfma_f32_16x16x32_bf16 v[128:131], v[68:71], v[32:35], v[128:131]
ds_read_b64_tr_b16 v[122:123], v7 offset:12800
v_mfma_f32_16x16x32_bf16 v[132:135], v[68:71], v[36:39], v[132:135]
ds_read_b64_tr_b16 v[124:125], v7 offset:20480
v_mfma_f32_16x16x32_bf16 v[204:207], v[76:79], v[36:39], v[204:207]
ds_read_b64_tr_b16 v[126:127], v7 offset:20992
v_mfma_f32_16x16x32_bf16 v[168:171], v[72:75], v[36:39], v[168:171]
ds_read_b64_tr_b16 v[116:117], v7 offset:4096
v_mfma_f32_16x16x32_bf16 v[172:175], v[72:75], v[40:43], v[172:175]
ds_read_b64_tr_b16 v[118:119], v7 offset:4608
v_mfma_f32_16x16x32_bf16 v[208:211], v[76:79], v[40:43], v[208:211]
ds_read_b128 v[84:87], v3 offset:45056
v_mfma_f32_16x16x32_bf16 v[136:139], v[68:71], v[40:43], v[136:139]
ds_read_b128 v[88:91], v3 offset:47104
v_mfma_f32_16x16x32_bf16 v[140:143], v[68:71], v[44:47], v[140:143]
ds_read_b128 v[92:95], v3 offset:49152
v_mfma_f32_16x16x32_bf16 v[212:215], v[76:79], v[44:47], v[212:215]
ds_read_b128 v[96:99], v3 offset:51200
v_mfma_f32_16x16x32_bf16 v[176:179], v[72:75], v[44:47], v[176:179]
ds_read_b128 v[100:103], v3 offset:53248
v_mfma_f32_16x16x32_bf16 v[180:183], v[72:75], v[48:51], v[180:183]
ds_read_b128 v[104:107], v3 offset:55296
v_mfma_f32_16x16x32_bf16 v[216:219], v[76:79], v[48:51], v[216:219]
ds_read_b128 v[108:111], v3 offset:57344
v_mfma_f32_16x16x32_bf16 v[144:147], v[68:71], v[48:51], v[144:147]
ds_read_b128 v[112:115], v3 offset:59392
v_mfma_f32_16x16x32_bf16 v[148:151], v[68:71], v[52:55], v[148:151]
v_mfma_f32_16x16x32_bf16 v[220:223], v[76:79], v[52:55], v[220:223]
v_mfma_f32_16x16x32_bf16 v[184:187], v[72:75], v[52:55], v[184:187]
v_mfma_f32_16x16x32_bf16 v[188:191], v[72:75], v[56:59], v[188:191]
v_mfma_f32_16x16x32_bf16 v[224:227], v[76:79], v[56:59], v[224:227]
v_mfma_f32_16x16x32_bf16 v[152:155], v[68:71], v[56:59], v[152:155]
v_mfma_f32_16x16x32_bf16 v[156:159], v[68:71], v[60:63], v[156:159]
v_mfma_f32_16x16x32_bf16 v[228:231], v[76:79], v[60:63], v[228:231]
v_mfma_f32_16x16x32_bf16 v[192:195], v[72:75], v[60:63], v[192:195]
v_mfma_f32_16x16x32_bf16 v[196:199], v[72:75], v[64:67], v[196:199]
v_mfma_f32_16x16x32_bf16 v[232:235], v[76:79], v[64:67], v[232:235]
v_mfma_f32_16x16x32_bf16 v[160:163], v[68:71], v[64:67], v[160:163]
s_waitcnt lgkmcnt(0)
s_barrier
v_mfma_f32_16x16x32_bf16 v[164:167], v[120:123], v[80:83], v[164:167]
ds_read_b128 v[32:35], v4 offset:0
v_mfma_f32_16x16x32_bf16 v[200:203], v[124:127], v[80:83], v[200:203]
ds_read_b64_tr_b16 v[72:73], v8 offset:8192
v_mfma_f32_16x16x32_bf16 v[128:131], v[116:119], v[80:83], v[128:131]
ds_read_b64_tr_b16 v[74:75], v8 offset:8704
v_mfma_f32_16x16x32_bf16 v[132:135], v[116:119], v[84:87], v[132:135]
ds_read_b64_tr_b16 v[76:77], v8 offset:16384
v_mfma_f32_16x16x32_bf16 v[204:207], v[124:127], v[84:87], v[204:207]
ds_read_b64_tr_b16 v[78:79], v8 offset:16896
v_mfma_f32_16x16x32_bf16 v[168:171], v[120:123], v[84:87], v[168:171]
ds_read_b64_tr_b16 v[68:69], v8 offset:0
v_mfma_f32_16x16x32_bf16 v[172:175], v[120:123], v[88:91], v[172:175]
ds_read_b64_tr_b16 v[70:71], v8 offset:512
v_mfma_f32_16x16x32_bf16 v[208:211], v[124:127], v[88:91], v[208:211]
ds_read_b128 v[36:39], v4 offset:2048
v_mfma_f32_16x16x32_bf16 v[136:139], v[116:119], v[88:91], v[136:139]
ds_read_b128 v[40:43], v4 offset:4096
v_mfma_f32_16x16x32_bf16 v[140:143], v[116:119], v[92:95], v[140:143]
ds_read_b128 v[44:47], v4 offset:6144
v_mfma_f32_16x16x32_bf16 v[212:215], v[124:127], v[92:95], v[212:215]
ds_read_b128 v[48:51], v4 offset:8192
v_mfma_f32_16x16x32_bf16 v[176:179], v[120:123], v[92:95], v[176:179]
ds_read_b128 v[52:55], v4 offset:10240
v_mfma_f32_16x16x32_bf16 v[180:183], v[120:123], v[96:99], v[180:183]
ds_read_b128 v[56:59], v4 offset:12288
v_mfma_f32_16x16x32_bf16 v[216:219], v[124:127], v[96:99], v[216:219]
ds_read_b128 v[60:63], v4 offset:14336
v_mfma_f32_16x16x32_bf16 v[144:147], v[116:119], v[96:99], v[144:147]
ds_read_b128 v[64:67], v4 offset:16384
v_mfma_f32_16x16x32_bf16 v[148:151], v[116:119], v[100:103], v[148:151]
v_mfma_f32_16x16x32_bf16 v[220:223], v[124:127], v[100:103], v[220:223]
v_mfma_f32_16x16x32_bf16 v[184:187], v[120:123], v[100:103], v[184:187]
v_mfma_f32_16x16x32_bf16 v[188:191], v[120:123], v[104:107], v[188:191]
v_mfma_f32_16x16x32_bf16 v[224:227], v[124:127], v[104:107], v[224:227]
v_mfma_f32_16x16x32_bf16 v[152:155], v[116:119], v[104:107], v[152:155]
v_mfma_f32_16x16x32_bf16 v[156:159], v[116:119], v[108:111], v[156:159]
v_mfma_f32_16x16x32_bf16 v[228:231], v[124:127], v[108:111], v[228:231]
v_mfma_f32_16x16x32_bf16 v[192:195], v[120:123], v[108:111], v[192:195]
v_mfma_f32_16x16x32_bf16 v[196:199], v[120:123], v[112:115], v[196:199]
v_mfma_f32_16x16x32_bf16 v[232:235], v[124:127], v[112:115], v[232:235]
v_mfma_f32_16x16x32_bf16 v[160:163], v[116:119], v[112:115], v[160:163]
s_waitcnt lgkmcnt(0)
v_mfma_f32_16x16x32_bf16 v[164:167], v[72:75], v[32:35], v[164:167]
ds_read_b128 v[80:83], v5 offset:0
v_mfma_f32_16x16x32_bf16 v[200:203], v[76:79], v[32:35], v[200:203]
ds_read_b64_tr_b16 v[120:121], v8 offset:12288
v_mfma_f32_16x16x32_bf16 v[128:131], v[68:71], v[32:35], v[128:131]
ds_read_b64_tr_b16 v[122:123], v8 offset:12800
v_mfma_f32_16x16x32_bf16 v[132:135], v[68:71], v[36:39], v[132:135]
ds_read_b64_tr_b16 v[124:125], v8 offset:20480
v_mfma_f32_16x16x32_bf16 v[204:207], v[76:79], v[36:39], v[204:207]
ds_read_b64_tr_b16 v[126:127], v8 offset:20992
v_mfma_f32_16x16x32_bf16 v[168:171], v[72:75], v[36:39], v[168:171]
ds_read_b64_tr_b16 v[116:117], v8 offset:4096
v_mfma_f32_16x16x32_bf16 v[172:175], v[72:75], v[40:43], v[172:175]
ds_read_b64_tr_b16 v[118:119], v8 offset:4608
v_mfma_f32_16x16x32_bf16 v[208:211], v[76:79], v[40:43], v[208:211]
ds_read_b128 v[84:87], v5 offset:2048
v_mfma_f32_16x16x32_bf16 v[136:139], v[68:71], v[40:43], v[136:139]
ds_read_b128 v[88:91], v5 offset:4096
v_mfma_f32_16x16x32_bf16 v[140:143], v[68:71], v[44:47], v[140:143]
ds_read_b128 v[92:95], v5 offset:6144
v_mfma_f32_16x16x32_bf16 v[212:215], v[76:79], v[44:47], v[212:215]
ds_read_b128 v[96:99], v5 offset:8192
v_mfma_f32_16x16x32_bf16 v[176:179], v[72:75], v[44:47], v[176:179]
ds_read_b128 v[100:103], v5 offset:10240
v_mfma_f32_16x16x32_bf16 v[180:183], v[72:75], v[48:51], v[180:183]
ds_read_b128 v[104:107], v5 offset:12288
v_mfma_f32_16x16x32_bf16 v[216:219], v[76:79], v[48:51], v[216:219]
ds_read_b128 v[108:111], v5 offset:14336
v_mfma_f32_16x16x32_bf16 v[144:147], v[68:71], v[48:51], v[144:147]
ds_read_b128 v[112:115], v5 offset:16384
v_mfma_f32_16x16x32_bf16 v[148:151], v[68:71], v[52:55], v[148:151]
v_mfma_f32_16x16x32_bf16 v[220:223], v[76:79], v[52:55], v[220:223]
v_mfma_f32_16x16x32_bf16 v[184:187], v[72:75], v[52:55], v[184:187]
v_mfma_f32_16x16x32_bf16 v[188:191], v[72:75], v[56:59], v[188:191]
v_mfma_f32_16x16x32_bf16 v[224:227], v[76:79], v[56:59], v[224:227]
v_mfma_f32_16x16x32_bf16 v[152:155], v[68:71], v[56:59], v[152:155]
v_mfma_f32_16x16x32_bf16 v[156:159], v[68:71], v[60:63], v[156:159]
v_mfma_f32_16x16x32_bf16 v[228:231], v[76:79], v[60:63], v[228:231]
v_mfma_f32_16x16x32_bf16 v[192:195], v[72:75], v[60:63], v[192:195]
v_mfma_f32_16x16x32_bf16 v[196:199], v[72:75], v[64:67], v[196:199]
v_mfma_f32_16x16x32_bf16 v[232:235], v[76:79], v[64:67], v[232:235]
v_mfma_f32_16x16x32_bf16 v[160:163], v[68:71], v[64:67], v[160:163]
s_waitcnt lgkmcnt(0)
s_barrier
v_mfma_f32_16x16x32_bf16 v[164:167], v[120:123], v[80:83], v[164:167]
ds_read_b128 v[32:35], v2 offset:0
v_mfma_f32_16x16x32_bf16 v[200:203], v[124:127], v[80:83], v[200:203]
ds_read_b64_tr_b16 v[72:73], v6 offset:8192
v_mfma_f32_16x16x32_bf16 v[128:131], v[116:119], v[80:83], v[128:131]
ds_read_b64_tr_b16 v[74:75], v6 offset:8704
v_mfma_f32_16x16x32_bf16 v[132:135], v[116:119], v[84:87], v[132:135]
ds_read_b64_tr_b16 v[76:77], v6 offset:16384
v_mfma_f32_16x16x32_bf16 v[204:207], v[124:127], v[84:87], v[204:207]
ds_read_b64_tr_b16 v[78:79], v6 offset:16896
v_mfma_f32_16x16x32_bf16 v[168:171], v[120:123], v[84:87], v[168:171]
ds_read_b64_tr_b16 v[68:69], v6 offset:0
v_mfma_f32_16x16x32_bf16 v[172:175], v[120:123], v[88:91], v[172:175]
ds_read_b64_tr_b16 v[70:71], v6 offset:512
v_mfma_f32_16x16x32_bf16 v[208:211], v[124:127], v[88:91], v[208:211]
ds_read_b128 v[36:39], v2 offset:2048
v_mfma_f32_16x16x32_bf16 v[136:139], v[116:119], v[88:91], v[136:139]
ds_read_b128 v[40:43], v2 offset:4096
v_mfma_f32_16x16x32_bf16 v[140:143], v[116:119], v[92:95], v[140:143]
ds_read_b128 v[44:47], v2 offset:6144
v_mfma_f32_16x16x32_bf16 v[212:215], v[124:127], v[92:95], v[212:215]
ds_read_b128 v[48:51], v2 offset:8192
v_mfma_f32_16x16x32_bf16 v[176:179], v[120:123], v[92:95], v[176:179]
ds_read_b128 v[52:55], v2 offset:10240
v_mfma_f32_16x16x32_bf16 v[180:183], v[120:123], v[96:99], v[180:183]
ds_read_b128 v[56:59], v2 offset:12288
v_mfma_f32_16x16x32_bf16 v[216:219], v[124:127], v[96:99], v[216:219]
ds_read_b128 v[60:63], v2 offset:14336
v_mfma_f32_16x16x32_bf16 v[144:147], v[116:119], v[96:99], v[144:147]
ds_read_b128 v[64:67], v2 offset:16384
v_mfma_f32_16x16x32_bf16 v[148:151], v[116:119], v[100:103], v[148:151]
v_mfma_f32_16x16x32_bf16 v[220:223], v[124:127], v[100:103], v[220:223]
v_mfma_f32_16x16x32_bf16 v[184:187], v[120:123], v[100:103], v[184:187]
v_mfma_f32_16x16x32_bf16 v[188:191], v[120:123], v[104:107], v[188:191]
v_mfma_f32_16x16x32_bf16 v[224:227], v[124:127], v[104:107], v[224:227]
v_mfma_f32_16x16x32_bf16 v[152:155], v[116:119], v[104:107], v[152:155]
v_mfma_f32_16x16x32_bf16 v[156:159], v[116:119], v[108:111], v[156:159]
v_mfma_f32_16x16x32_bf16 v[228:231], v[124:127], v[108:111], v[228:231]
v_mfma_f32_16x16x32_bf16 v[192:195], v[120:123], v[108:111], v[192:195]
v_mfma_f32_16x16x32_bf16 v[196:199], v[120:123], v[112:115], v[196:199]
v_mfma_f32_16x16x32_bf16 v[232:235], v[124:127], v[112:115], v[232:235]
v_mfma_f32_16x16x32_bf16 v[160:163], v[116:119], v[112:115], v[160:163]
s_mov_b32 s41, 4
Lcl_19:
s_waitcnt lgkmcnt(0)
v_mfma_f32_16x16x32_bf16 v[164:167], v[72:75], v[32:35], v[164:167]
ds_read_b128 v[80:83], v3 offset:0
v_mfma_f32_16x16x32_bf16 v[200:203], v[76:79], v[32:35], v[200:203]
ds_read_b64_tr_b16 v[120:121], v6 offset:12288
v_mfma_f32_16x16x32_bf16 v[128:131], v[68:71], v[32:35], v[128:131]
ds_read_b64_tr_b16 v[122:123], v6 offset:12800
v_mfma_f32_16x16x32_bf16 v[132:135], v[68:71], v[36:39], v[132:135]
ds_read_b64_tr_b16 v[124:125], v6 offset:20480
v_mfma_f32_16x16x32_bf16 v[204:207], v[76:79], v[36:39], v[204:207]
ds_read_b64_tr_b16 v[126:127], v6 offset:20992
v_mfma_f32_16x16x32_bf16 v[168:171], v[72:75], v[36:39], v[168:171]
ds_read_b64_tr_b16 v[116:117], v6 offset:4096
v_mfma_f32_16x16x32_bf16 v[172:175], v[72:75], v[40:43], v[172:175]
ds_read_b64_tr_b16 v[118:119], v6 offset:4608
v_mfma_f32_16x16x32_bf16 v[208:211], v[76:79], v[40:43], v[208:211]
ds_read_b128 v[84:87], v3 offset:2048
v_mfma_f32_16x16x32_bf16 v[136:139], v[68:71], v[40:43], v[136:139]
ds_read_b128 v[88:91], v3 offset:4096
v_mfma_f32_16x16x32_bf16 v[140:143], v[68:71], v[44:47], v[140:143]
ds_read_b128 v[92:95], v3 offset:6144
v_mfma_f32_16x16x32_bf16 v[212:215], v[76:79], v[44:47], v[212:215]
ds_read_b128 v[96:99], v3 offset:8192
v_mfma_f32_16x16x32_bf16 v[176:179], v[72:75], v[44:47], v[176:179]
ds_read_b128 v[100:103], v3 offset:10240
v_mfma_f32_16x16x32_bf16 v[180:183], v[72:75], v[48:51], v[180:183]
ds_read_b128 v[104:107], v3 offset:12288
v_mfma_f32_16x16x32_bf16 v[216:219], v[76:79], v[48:51], v[216:219]
ds_read_b128 v[108:111], v3 offset:14336
v_mfma_f32_16x16x32_bf16 v[144:147], v[68:71], v[48:51], v[144:147]
ds_read_b128 v[112:115], v3 offset:16384
v_mfma_f32_16x16x32_bf16 v[148:151], v[68:71], v[52:55], v[148:151]
v_mfma_f32_16x16x32_bf16 v[220:223], v[76:79], v[52:55], v[220:223]
v_mfma_f32_16x16x32_bf16 v[184:187], v[72:75], v[52:55], v[184:187]
v_mfma_f32_16x16x32_bf16 v[188:191], v[72:75], v[56:59], v[188:191]
v_mfma_f32_16x16x32_bf16 v[224:227], v[76:79], v[56:59], v[224:227]
v_mfma_f32_16x16x32_bf16 v[152:155], v[68:71], v[56:59], v[152:155]
v_mfma_f32_16x16x32_bf16 v[156:159], v[68:71], v[60:63], v[156:159]
v_mfma_f32_16x16x32_bf16 v[228:231], v[76:79], v[60:63], v[228:231]
v_mfma_f32_16x16x32_bf16 v[192:195], v[72:75], v[60:63], v[192:195]
v_mfma_f32_16x16x32_bf16 v[196:199], v[72:75], v[64:67], v[196:199]
v_mfma_f32_16x16x32_bf16 v[232:235], v[76:79], v[64:67], v[232:235]
v_mfma_f32_16x16x32_bf16 v[160:163], v[68:71], v[64:67], v[160:163]
s_waitcnt lgkmcnt(0)
s_barrier
v_mfma_f32_16x16x32_bf16 v[164:167], v[120:123], v[80:83], v[164:167]
s_branch Lov_2
.p2align 12
.fill 16, 4, 0xbf800000
Lst_2_0:
s_branch Lwr_169
s_nop 0
s_nop 0
Lov_2:
ds_read_b128 v[32:35], v2 offset:43008
v_mfma_f32_16x16x32_bf16 v[200:203], v[124:127], v[80:83], v[200:203]
ds_read_b64_tr_b16 v[72:73], v7 offset:8192
v_mfma_f32_16x16x32_bf16 v[128:131], v[116:119], v[80:83], v[128:131]
ds_read_b64_tr_b16 v[74:75], v7 offset:8704
v_mfma_f32_16x16x32_bf16 v[132:135], v[116:119], v[84:87], v[132:135]
ds_read_b64_tr_b16 v[76:77], v7 offset:16384
v_mfma_f32_16x16x32_bf16 v[204:207], v[124:127], v[84:87], v[204:207]
ds_read_b64_tr_b16 v[78:79], v7 offset:16896
v_mfma_f32_16x16x32_bf16 v[168:171], v[120:123], v[84:87], v[168:171]
ds_read_b64_tr_b16 v[68:69], v7 offset:0
v_mfma_f32_16x16x32_bf16 v[172:175], v[120:123], v[88:91], v[172:175]
ds_read_b64_tr_b16 v[70:71], v7 offset:512
v_mfma_f32_16x16x32_bf16 v[208:211], v[124:127], v[88:91], v[208:211]
ds_read_b128 v[36:39], v2 offset:45056
v_mfma_f32_16x16x32_bf16 v[136:139], v[116:119], v[88:91], v[136:139]
ds_read_b128 v[40:43], v2 offset:47104
v_mfma_f32_16x16x32_bf16 v[140:143], v[116:119], v[92:95], v[140:143]
ds_read_b128 v[44:47], v2 offset:49152
v_mfma_f32_16x16x32_bf16 v[212:215], v[124:127], v[92:95], v[212:215]
ds_read_b128 v[48:51], v2 offset:51200
v_mfma_f32_16x16x32_bf16 v[176:179], v[120:123], v[92:95], v[176:179]
ds_read_b128 v[52:55], v2 offset:53248
v_mfma_f32_16x16x32_bf16 v[180:183], v[120:123], v[96:99], v[180:183]
ds_read_b128 v[56:59], v2 offset:55296
v_mfma_f32_16x16x32_bf16 v[216:219], v[124:127], v[96:99], v[216:219]
ds_read_b128 v[60:63], v2 offset:57344
v_mfma_f32_16x16x32_bf16 v[144:147], v[116:119], v[96:99], v[144:147]
ds_read_b128 v[64:67], v2 offset:59392
v_mfma_f32_16x16x32_bf16 v[148:151], v[116:119], v[100:103], v[148:151]
v_mfma_f32_16x16x32_bf16 v[220:223], v[124:127], v[100:103], v[220:223]
v_mfma_f32_16x16x32_bf16 v[184:187], v[120:123], v[100:103], v[184:187]
v_mfma_f32_16x16x32_bf16 v[188:191], v[120:123], v[104:107], v[188:191]
v_mfma_f32_16x16x32_bf16 v[224:227], v[124:127], v[104:107], v[224:227]
v_mfma_f32_16x16x32_bf16 v[152:155], v[116:119], v[104:107], v[152:155]
v_mfma_f32_16x16x32_bf16 v[156:159], v[116:119], v[108:111], v[156:159]
v_mfma_f32_16x16x32_bf16 v[228:231], v[124:127], v[108:111], v[228:231]
v_mfma_f32_16x16x32_bf16 v[192:195], v[120:123], v[108:111], v[192:195]
v_mfma_f32_16x16x32_bf16 v[196:199], v[120:123], v[112:115], v[196:199]
v_mfma_f32_16x16x32_bf16 v[232:235], v[124:127], v[112:115], v[232:235]
v_mfma_f32_16x16x32_bf16 v[160:163], v[116:119], v[112:115], v[160:163]
s_waitcnt lgkmcnt(0)
v_mfma_f32_16x16x32_bf16 v[164:167], v[72:75], v[32:35], v[164:167]
ds_read_b128 v[80:83], v3 offset:43008
v_mfma_f32_16x16x32_bf16 v[200:203], v[76:79], v[32:35], v[200:203]
ds_read_b64_tr_b16 v[120:121], v7 offset:12288
v_mfma_f32_16x16x32_bf16 v[128:131], v[68:71], v[32:35], v[128:131]
ds_read_b64_tr_b16 v[122:123], v7 offset:12800
v_mfma_f32_16x16x32_bf16 v[132:135], v[68:71], v[36:39], v[132:135]
ds_read_b64_tr_b16 v[124:125], v7 offset:20480
v_mfma_f32_16x16x32_bf16 v[204:207], v[76:79], v[36:39], v[204:207]
ds_read_b64_tr_b16 v[126:127], v7 offset:20992
v_mfma_f32_16x16x32_bf16 v[168:171], v[72:75], v[36:39], v[168:171]
ds_read_b64_tr_b16 v[116:117], v7 offset:4096
v_mfma_f32_16x16x32_bf16 v[172:175], v[72:75], v[40:43], v[172:175]
ds_read_b64_tr_b16 v[118:119], v7 offset:4608
v_mfma_f32_16x16x32_bf16 v[208:211], v[76:79], v[40:43], v[208:211]
ds_read_b128 v[84:87], v3 offset:45056
v_mfma_f32_16x16x32_bf16 v[136:139], v[68:71], v[40:43], v[136:139]
ds_read_b128 v[88:91], v3 offset:47104
v_mfma_f32_16x16x32_bf16 v[140:143], v[68:71], v[44:47], v[140:143]
ds_read_b128 v[92:95], v3 offset:49152
v_mfma_f32_16x16x32_bf16 v[212:215], v[76:79], v[44:47], v[212:215]
ds_read_b128 v[96:99], v3 offset:51200
v_mfma_f32_16x16x32_bf16 v[176:179], v[72:75], v[44:47], v[176:179]
ds_read_b128 v[100:103], v3 offset:53248
v_mfma_f32_16x16x32_bf16 v[180:183], v[72:75], v[48:51], v[180:183]
ds_read_b128 v[104:107], v3 offset:55296
v_mfma_f32_16x16x32_bf16 v[216:219], v[76:79], v[48:51], v[216:219]
ds_read_b128 v[108:111], v3 offset:57344
v_mfma_f32_16x16x32_bf16 v[144:147], v[68:71], v[48:51], v[144:147]
ds_read_b128 v[112:115], v3 offset:59392
v_mfma_f32_16x16x32_bf16 v[148:151], v[68:71], v[52:55], v[148:151]
v_mfma_f32_16x16x32_bf16 v[220:223], v[76:79], v[52:55], v[220:223]
v_mfma_f32_16x16x32_bf16 v[184:187], v[72:75], v[52:55], v[184:187]
v_mfma_f32_16x16x32_bf16 v[188:191], v[72:75], v[56:59], v[188:191]
v_mfma_f32_16x16x32_bf16 v[224:227], v[76:79], v[56:59], v[224:227]
v_mfma_f32_16x16x32_bf16 v[152:155], v[68:71], v[56:59], v[152:155]
v_mfma_f32_16x16x32_bf16 v[156:159], v[68:71], v[60:63], v[156:159]
v_mfma_f32_16x16x32_bf16 v[228:231], v[76:79], v[60:63], v[228:231]
v_mfma_f32_16x16x32_bf16 v[192:195], v[72:75], v[60:63], v[192:195]
v_mfma_f32_16x16x32_bf16 v[196:199], v[72:75], v[64:67], v[196:199]
v_mfma_f32_16x16x32_bf16 v[232:235], v[76:79], v[64:67], v[232:235]
v_mfma_f32_16x16x32_bf16 v[160:163], v[68:71], v[64:67], v[160:163]
s_waitcnt lgkmcnt(0)
s_barrier
v_mfma_f32_16x16x32_bf16 v[164:167], v[120:123], v[80:83], v[164:167]
ds_read_b128 v[32:35], v4 offset:0
v_mfma_f32_16x16x32_bf16 v[200:203], v[124:127], v[80:83], v[200:203]
ds_read_b64_tr_b16 v[72:73], v8 offset:8192
v_mfma_f32_16x16x32_bf16 v[128:131], v[116:119], v[80:83], v[128:131]
ds_read_b64_tr_b16 v[74:75], v8 offset:8704
v_mfma_f32_16x16x32_bf16 v[132:135], v[116:119], v[84:87], v[132:135]
ds_read_b64_tr_b16 v[76:77], v8 offset:16384
v_mfma_f32_16x16x32_bf16 v[204:207], v[124:127], v[84:87], v[204:207]
ds_read_b64_tr_b16 v[78:79], v8 offset:16896
v_mfma_f32_16x16x32_bf16 v[168:171], v[120:123], v[84:87], v[168:171]
ds_read_b64_tr_b16 v[68:69], v8 offset:0
v_mfma_f32_16x16x32_bf16 v[172:175], v[120:123], v[88:91], v[172:175]
ds_read_b64_tr_b16 v[70:71], v8 offset:512
v_mfma_f32_16x16x32_bf16 v[208:211], v[124:127], v[88:91], v[208:211]
ds_read_b128 v[36:39], v4 offset:2048
v_mfma_f32_16x16x32_bf16 v[136:139], v[116:119], v[88:91], v[136:139]
ds_read_b128 v[40:43], v4 offset:4096
v_mfma_f32_16x16x32_bf16 v[140:143], v[116:119], v[92:95], v[140:143]
ds_read_b128 v[44:47], v4 offset:6144
v_mfma_f32_16x16x32_bf16 v[212:215], v[124:127], v[92:95], v[212:215]
ds_read_b128 v[48:51], v4 offset:8192
v_mfma_f32_16x16x32_bf16 v[176:179], v[120:123], v[92:95], v[176:179]
ds_read_b128 v[52:55], v4 offset:10240
v_mfma_f32_16x16x32_bf16 v[180:183], v[120:123], v[96:99], v[180:183]
ds_read_b128 v[56:59], v4 offset:12288
v_mfma_f32_16x16x32_bf16 v[216:219], v[124:127], v[96:99], v[216:219]
ds_read_b128 v[60:63], v4 offset:14336
v_mfma_f32_16x16x32_bf16 v[144:147], v[116:119], v[96:99], v[144:147]
ds_read_b128 v[64:67], v4 offset:16384
v_mfma_f32_16x16x32_bf16 v[148:151], v[116:119], v[100:103], v[148:151]
v_mfma_f32_16x16x32_bf16 v[220:223], v[124:127], v[100:103], v[220:223]
v_mfma_f32_16x16x32_bf16 v[184:187], v[120:123], v[100:103], v[184:187]
v_mfma_f32_16x16x32_bf16 v[188:191], v[120:123], v[104:107], v[188:191]
v_mfma_f32_16x16x32_bf16 v[224:227], v[124:127], v[104:107], v[224:227]
v_mfma_f32_16x16x32_bf16 v[152:155], v[116:119], v[104:107], v[152:155]
v_mfma_f32_16x16x32_bf16 v[156:159], v[116:119], v[108:111], v[156:159]
v_mfma_f32_16x16x32_bf16 v[228:231], v[124:127], v[108:111], v[228:231]
v_mfma_f32_16x16x32_bf16 v[192:195], v[120:123], v[108:111], v[192:195]
v_mfma_f32_16x16x32_bf16 v[196:199], v[120:123], v[112:115], v[196:199]
v_mfma_f32_16x16x32_bf16 v[232:235], v[124:127], v[112:115], v[232:235]
v_mfma_f32_16x16x32_bf16 v[160:163], v[116:119], v[112:115], v[160:163]
s_waitcnt lgkmcnt(0)
v_mfma_f32_16x16x32_bf16 v[164:167], v[72:75], v[32:35], v[164:167]
ds_read_b128 v[80:83], v5 offset:0
v_mfma_f32_16x16x32_bf16 v[200:203], v[76:79], v[32:35], v[200:203]
ds_read_b64_tr_b16 v[120:121], v8 offset:12288
v_mfma_f32_16x16x32_bf16 v[128:131], v[68:71], v[32:35], v[128:131]
ds_read_b64_tr_b16 v[122:123], v8 offset:12800
v_mfma_f32_16x16x32_bf16 v[132:135], v[68:71], v[36:39], v[132:135]
ds_read_b64_tr_b16 v[124:125], v8 offset:20480
v_mfma_f32_16x16x32_bf16 v[204:207], v[76:79], v[36:39], v[204:207]
ds_read_b64_tr_b16 v[126:127], v8 offset:20992
v_mfma_f32_16x16x32_bf16 v[168:171], v[72:75], v[36:39], v[168:171]
ds_read_b64_tr_b16 v[116:117], v8 offset:4096
v_mfma_f32_16x16x32_bf16 v[172:175], v[72:75], v[40:43], v[172:175]
ds_read_b64_tr_b16 v[118:119], v8 offset:4608
v_mfma_f32_16x16x32_bf16 v[208:211], v[76:79], v[40:43], v[208:211]
ds_read_b128 v[84:87], v5 offset:2048
v_mfma_f32_16x16x32_bf16 v[136:139], v[68:71], v[40:43], v[136:139]
ds_read_b128 v[88:91], v5 offset:4096
v_mfma_f32_16x16x32_bf16 v[140:143], v[68:71], v[44:47], v[140:143]
ds_read_b128 v[92:95], v5 offset:6144
v_mfma_f32_16x16x32_bf16 v[212:215], v[76:79], v[44:47], v[212:215]
ds_read_b128 v[96:99], v5 offset:8192
v_mfma_f32_16x16x32_bf16 v[176:179], v[72:75], v[44:47], v[176:179]
ds_read_b128 v[100:103], v5 offset:10240
v_mfma_f32_16x16x32_bf16 v[180:183], v[72:75], v[48:51], v[180:183]
ds_read_b128 v[104:107], v5 offset:12288
v_mfma_f32_16x16x32_bf16 v[216:219], v[76:79], v[48:51], v[216:219]
ds_read_b128 v[108:111], v5 offset:14336
v_mfma_f32_16x16x32_bf16 v[144:147], v[68:71], v[48:51], v[144:147]
ds_read_b128 v[112:115], v5 offset:16384
v_mfma_f32_16x16x32_bf16 v[148:151], v[68:71], v[52:55], v[148:151]
v_mfma_f32_16x16x32_bf16 v[220:223], v[76:79], v[52:55], v[220:223]
v_mfma_f32_16x16x32_bf16 v[184:187], v[72:75], v[52:55], v[184:187]
v_mfma_f32_16x16x32_bf16 v[188:191], v[72:75], v[56:59], v[188:191]
v_mfma_f32_16x16x32_bf16 v[224:227], v[76:79], v[56:59], v[224:227]
v_mfma_f32_16x16x32_bf16 v[152:155], v[68:71], v[56:59], v[152:155]
v_mfma_f32_16x16x32_bf16 v[156:159], v[68:71], v[60:63], v[156:159]
v_mfma_f32_16x16x32_bf16 v[228:231], v[76:79], v[60:63], v[228:231]
v_mfma_f32_16x16x32_bf16 v[192:195], v[72:75], v[60:63], v[192:195]
v_mfma_f32_16x16x32_bf16 v[196:199], v[72:75], v[64:67], v[196:199]
v_mfma_f32_16x16x32_bf16 v[232:235], v[76:79], v[64:67], v[232:235]
v_mfma_f32_16x16x32_bf16 v[160:163], v[68:71], v[64:67], v[160:163]
s_waitcnt lgkmcnt(0)
s_barrier
v_mfma_f32_16x16x32_bf16 v[164:167], v[120:123], v[80:83], v[164:167]
ds_read_b128 v[32:35], v2 offset:0
v_mfma_f32_16x16x32_bf16 v[200:203], v[124:127], v[80:83], v[200:203]
ds_read_b64_tr_b16 v[72:73], v6 offset:8192
v_mfma_f32_16x16x32_bf16 v[128:131], v[116:119], v[80:83], v[128:131]
ds_read_b64_tr_b16 v[74:75], v6 offset:8704
v_mfma_f32_16x16x32_bf16 v[132:135], v[116:119], v[84:87], v[132:135]
ds_read_b64_tr_b16 v[76:77], v6 offset:16384
v_mfma_f32_16x16x32_bf16 v[204:207], v[124:127], v[84:87], v[204:207]
ds_read_b64_tr_b16 v[78:79], v6 offset:16896
v_mfma_f32_16x16x32_bf16 v[168:171], v[120:123], v[84:87], v[168:171]
ds_read_b64_tr_b16 v[68:69], v6 offset:0
v_mfma_f32_16x16x32_bf16 v[172:175], v[120:123], v[88:91], v[172:175]
ds_read_b64_tr_b16 v[70:71], v6 offset:512
v_mfma_f32_16x16x32_bf16 v[208:211], v[124:127], v[88:91], v[208:211]
ds_read_b128 v[36:39], v2 offset:2048
v_mfma_f32_16x16x32_bf16 v[136:139], v[116:119], v[88:91], v[136:139]
ds_read_b128 v[40:43], v2 offset:4096
v_mfma_f32_16x16x32_bf16 v[140:143], v[116:119], v[92:95], v[140:143]
ds_read_b128 v[44:47], v2 offset:6144
v_mfma_f32_16x16x32_bf16 v[212:215], v[124:127], v[92:95], v[212:215]
ds_read_b128 v[48:51], v2 offset:8192
v_mfma_f32_16x16x32_bf16 v[176:179], v[120:123], v[92:95], v[176:179]
ds_read_b128 v[52:55], v2 offset:10240
v_mfma_f32_16x16x32_bf16 v[180:183], v[120:123], v[96:99], v[180:183]
ds_read_b128 v[56:59], v2 offset:12288
v_mfma_f32_16x16x32_bf16 v[216:219], v[124:127], v[96:99], v[216:219]
ds_read_b128 v[60:63], v2 offset:14336
v_mfma_f32_16x16x32_bf16 v[144:147], v[116:119], v[96:99], v[144:147]
ds_read_b128 v[64:67], v2 offset:16384
v_mfma_f32_16x16x32_bf16 v[148:151], v[116:119], v[100:103], v[148:151]
v_mfma_f32_16x16x32_bf16 v[220:223], v[124:127], v[100:103], v[220:223]
v_mfma_f32_16x16x32_bf16 v[184:187], v[120:123], v[100:103], v[184:187]
v_mfma_f32_16x16x32_bf16 v[188:191], v[120:123], v[104:107], v[188:191]
v_mfma_f32_16x16x32_bf16 v[224:227], v[124:127], v[104:107], v[224:227]
v_mfma_f32_16x16x32_bf16 v[152:155], v[116:119], v[104:107], v[152:155]
v_mfma_f32_16x16x32_bf16 v[156:159], v[116:119], v[108:111], v[156:159]
v_mfma_f32_16x16x32_bf16 v[228:231], v[124:127], v[108:111], v[228:231]
v_mfma_f32_16x16x32_bf16 v[192:195], v[120:123], v[108:111], v[192:195]
v_mfma_f32_16x16x32_bf16 v[196:199], v[120:123], v[112:115], v[196:199]
v_mfma_f32_16x16x32_bf16 v[232:235], v[124:127], v[112:115], v[232:235]
v_mfma_f32_16x16x32_bf16 v[160:163], v[116:119], v[112:115], v[160:163]
s_sub_u32 s41, s41, 1
s_cmp_lg_u32 s41, 0
s_cbranch_scc1 Lcl_19
s_waitcnt lgkmcnt(0)
v_mfma_f32_16x16x32_bf16 v[164:167], v[72:75], v[32:35], v[164:167]
ds_read_b128 v[80:83], v3 offset:0
v_mfma_f32_16x16x32_bf16 v[200:203], v[76:79], v[32:35], v[200:203]
ds_read_b64_tr_b16 v[120:121], v6 offset:12288
v_mfma_f32_16x16x32_bf16 v[128:131], v[68:71], v[32:35], v[128:131]
ds_read_b64_tr_b16 v[122:123], v6 offset:12800
v_mfma_f32_16x16x32_bf16 v[132:135], v[68:71], v[36:39], v[132:135]
ds_read_b64_tr_b16 v[124:125], v6 offset:20480
v_mfma_f32_16x16x32_bf16 v[204:207], v[76:79], v[36:39], v[204:207]
ds_read_b64_tr_b16 v[126:127], v6 offset:20992
v_mfma_f32_16x16x32_bf16 v[168:171], v[72:75], v[36:39], v[168:171]
ds_read_b64_tr_b16 v[116:117], v6 offset:4096
v_mfma_f32_16x16x32_bf16 v[172:175], v[72:75], v[40:43], v[172:175]
ds_read_b64_tr_b16 v[118:119], v6 offset:4608
v_mfma_f32_16x16x32_bf16 v[208:211], v[76:79], v[40:43], v[208:211]
ds_read_b128 v[84:87], v3 offset:2048
v_mfma_f32_16x16x32_bf16 v[136:139], v[68:71], v[40:43], v[136:139]
ds_read_b128 v[88:91], v3 offset:4096
v_mfma_f32_16x16x32_bf16 v[140:143], v[68:71], v[44:47], v[140:143]
ds_read_b128 v[92:95], v3 offset:6144
v_mfma_f32_16x16x32_bf16 v[212:215], v[76:79], v[44:47], v[212:215]
ds_read_b128 v[96:99], v3 offset:8192
v_mfma_f32_16x16x32_bf16 v[176:179], v[72:75], v[44:47], v[176:179]
ds_read_b128 v[100:103], v3 offset:10240
v_mfma_f32_16x16x32_bf16 v[180:183], v[72:75], v[48:51], v[180:183]
ds_read_b128 v[104:107], v3 offset:12288
v_mfma_f32_16x16x32_bf16 v[216:219], v[76:79], v[48:51], v[216:219]
ds_read_b128 v[108:111], v3 offset:14336
v_mfma_f32_16x16x32_bf16 v[144:147], v[68:71], v[48:51], v[144:147]
ds_read_b128 v[112:115], v3 offset:16384
v_mfma_f32_16x16x32_bf16 v[148:151], v[68:71], v[52:55], v[148:151]
v_mfma_f32_16x16x32_bf16 v[220:223], v[76:79], v[52:55], v[220:223]
v_mfma_f32_16x16x32_bf16 v[184:187], v[72:75], v[52:55], v[184:187]
v_mfma_f32_16x16x32_bf16 v[188:191], v[72:75], v[56:59], v[188:191]
v_mfma_f32_16x16x32_bf16 v[224:227], v[76:79], v[56:59], v[224:227]
v_mfma_f32_16x16x32_bf16 v[152:155], v[68:71], v[56:59], v[152:155]
v_mfma_f32_16x16x32_bf16 v[156:159], v[68:71], v[60:63], v[156:159]
v_mfma_f32_16x16x32_bf16 v[228:231], v[76:79], v[60:63], v[228:231]
v_mfma_f32_16x16x32_bf16 v[192:195], v[72:75], v[60:63], v[192:195]
v_mfma_f32_16x16x32_bf16 v[196:199], v[72:75], v[64:67], v[196:199]
v_mfma_f32_16x16x32_bf16 v[232:235], v[76:79], v[64:67], v[232:235]
v_mfma_f32_16x16x32_bf16 v[160:163], v[68:71], v[64:67], v[160:163]
s_waitcnt lgkmcnt(0)
v_mfma_f32_16x16x32_bf16 v[164:167], v[120:123], v[80:83], v[164:167]
v_mfma_f32_16x16x32_bf16 v[200:203], v[124:127], v[80:83], v[200:203]
v_mfma_f32_16x16x32_bf16 v[128:131], v[116:119], v[80:83], v[128:131]
v_mfma_f32_16x16x32_bf16 v[132:135], v[116:119], v[84:87], v[132:135]
v_mfma_f32_16x16x32_bf16 v[204:207], v[124:127], v[84:87], v[204:207]
v_mfma_f32_16x16x32_bf16 v[168:171], v[120:123], v[84:87], v[168:171]
v_mfma_f32_16x16x32_bf16 v[172:175], v[120:123], v[88:91], v[172:175]
v_mfma_f32_16x16x32_bf16 v[208:211], v[124:127], v[88:91], v[208:211]
v_mfma_f32_16x16x32_bf16 v[136:139], v[116:119], v[88:91], v[136:139]
v_mfma_f32_16x16x32_bf16 v[140:143], v[116:119], v[92:95], v[140:143]
v_mfma_f32_16x16x32_bf16 v[212:215], v[124:127], v[92:95], v[212:215]
v_mfma_f32_16x16x32_bf16 v[176:179], v[120:123], v[92:95], v[176:179]
v_mfma_f32_16x16x32_bf16 v[180:183], v[120:123], v[96:99], v[180:183]
v_mfma_f32_16x16x32_bf16 v[216:219], v[124:127], v[96:99], v[216:219]
v_mfma_f32_16x16x32_bf16 v[144:147], v[116:119], v[96:99], v[144:147]
v_mfma_f32_16x16x32_bf16 v[148:151], v[116:119], v[100:103], v[148:151]
v_mfma_f32_16x16x32_bf16 v[220:223], v[124:127], v[100:103], v[220:223]
v_mfma_f32_16x16x32_bf16 v[184:187], v[120:123], v[100:103], v[184:187]
v_mfma_f32_16x16x32_bf16 v[188:191], v[120:123], v[104:107], v[188:191]
v_mfma_f32_16x16x32_bf16 v[224:227], v[124:127], v[104:107], v[224:227]
v_mfma_f32_16x16x32_bf16 v[152:155], v[116:119], v[104:107], v[152:155]
v_mfma_f32_16x16x32_bf16 v[156:159], v[116:119], v[108:111], v[156:159]
v_mfma_f32_16x16x32_bf16 v[228:231], v[124:127], v[108:111], v[228:231]
v_mfma_f32_16x16x32_bf16 v[192:195], v[120:123], v[108:111], v[192:195]
v_mfma_f32_16x16x32_bf16 v[196:199], v[120:123], v[112:115], v[196:199]
v_mfma_f32_16x16x32_bf16 v[232:235], v[124:127], v[112:115], v[232:235]
v_mfma_f32_16x16x32_bf16 v[160:163], v[116:119], v[112:115], v[160:163]
v_lshlrev_b32 v14, 3, v12
v_add_u32 v14, 147456, v14
v_mul_u32_u24 v15, 400, v12
v_lshl_add_u32 v15, v13, 3, v15
s_lshl_b32 s43, s36, 5
v_add_u32 v15, s43, v15
s_barrier
ds_read_b64 v[32:33], v14 offset:0
ds_read_b64 v[34:35], v14 offset:128
ds_read_b64 v[36:37], v14 offset:256
ds_read_b64 v[38:39], v14 offset:384
ds_read_b64 v[40:41], v14 offset:512
ds_read_b64 v[42:43], v14 offset:640
ds_read_b64 v[44:45], v14 offset:768
ds_read_b64 v[46:47], v14 offset:896
ds_read_b64 v[48:49], v14 offset:1024
v_mov_b32_dpp v52, v128 row_newbcast:0 row_mask:0xf bank_mask:0xf
v_mov_b32_dpp v53, v129 row_newbcast:0 row_mask:0xf bank_mask:0xf
v_mov_b32_dpp v54, v130 row_newbcast:0 row_mask:0xf bank_mask:0xf
v_mov_b32_dpp v55, v131 row_newbcast:0 row_mask:0xf bank_mask:0xf
v_mov_b32_dpp v56, v164 row_newbcast:0 row_mask:0xf bank_mask:0xf
v_mov_b32_dpp v57, v165 row_newbcast:0 row_mask:0xf bank_mask:0xf
v_mov_b32_dpp v58, v166 row_newbcast:0 row_mask:0xf bank_mask:0xf
v_mov_b32_dpp v59, v167 row_newbcast:0 row_mask:0xf bank_mask:0xf
v_mov_b32_dpp v60, v200 row_newbcast:0 row_mask:0xf bank_mask:0xf
v_mov_b32_dpp v61, v201 row_newbcast:0 row_mask:0xf bank_mask:0xf
v_mov_b32_dpp v62, v202 row_newbcast:0 row_mask:0xf bank_mask:0xf
v_mov_b32_dpp v63, v203 row_newbcast:0 row_mask:0xf bank_mask:0xf
s_waitcnt lgkmcnt(0)
v_pk_fma_f32 v[164:165], v[32:33], v[56:57], v[164:165] op_sel_hi:[0,1,1] neg_lo:[1,0,0] neg_hi:[1,0,0]
v_pk_fma_f32 v[166:167], v[32:33], v[58:59], v[166:167] op_sel_hi:[0,1,1] neg_lo:[1,0,0] neg_hi:[1,0,0]
v_pk_fma_f32 v[200:201], v[32:33], v[60:61], v[200:201] op_sel_hi:[0,1,1] neg_lo:[1,0,0] neg_hi:[1,0,0]
v_pk_fma_f32 v[202:203], v[32:33], v[62:63], v[202:203] op_sel_hi:[0,1,1] neg_lo:[1,0,0] neg_hi:[1,0,0]
v_pk_mul_f32 v[164:165], v[32:33], v[164:165] op_sel:[1,0] op_sel_hi:[1,1]
v_pk_mul_f32 v[166:167], v[32:33], v[166:167] op_sel:[1,0] op_sel_hi:[1,1]
v_pk_fma_f32 v[132:133], v[34:35], v[52:53], v[132:133] op_sel_hi:[0,1,1] neg_lo:[1,0,0] neg_hi:[1,0,0]
v_pk_fma_f32 v[134:135], v[34:35], v[54:55], v[134:135] op_sel_hi:[0,1,1] neg_lo:[1,0,0] neg_hi:[1,0,0]
v_pk_mul_f32 v[200:201], v[32:33], v[200:201] op_sel:[1,0] op_sel_hi:[1,1]
v_pk_mul_f32 v[202:203], v[32:33], v[202:203] op_sel:[1,0] op_sel_hi:[1,1]
v_cvt_pk_bf16_f32 v164, v164, v165
v_cvt_pk_bf16_f32 v165, v166, v167
ds_write_b64 v15, v[164:165] offset:128
v_pk_fma_f32 v[168:169], v[34:35], v[56:57], v[168:169] op_sel_hi:[0,1,1] neg_lo:[1,0,0] neg_hi:[1,0,0]
v_pk_fma_f32 v[170:171], v[34:35], v[58:59], v[170:171] op_sel_hi:[0,1,1] neg_lo:[1,0,0] neg_hi:[1,0,0]
v_pk_mul_f32 v[132:133], v[34:35], v[132:133] op_sel:[1,0] op_sel_hi:[1,1]
v_pk_mul_f32 v[134:135], v[34:35], v[134:135] op_sel:[1,0] op_sel_hi:[1,1]
v_cvt_pk_bf16_f32 v200, v200, v201
v_cvt_pk_bf16_f32 v201, v202, v203
ds_write_b64 v15, v[200:201] offset:256
v_pk_fma_f32 v[204:205], v[34:35], v[60:61], v[204:205] op_sel_hi:[0,1,1] neg_lo:[1,0,0] neg_hi:[1,0,0]
v_pk_fma_f32 v[206:207], v[34:35], v[62:63], v[206:207] op_sel_hi:[0,1,1] neg_lo:[1,0,0] neg_hi:[1,0,0]
v_pk_mul_f32 v[168:169], v[34:35], v[168:169] op_sel:[1,0] op_sel_hi:[1,1]
v_pk_mul_f32 v[170:171], v[34:35], v[170:171] op_sel:[1,0] op_sel_hi:[1,1]
v_cvt_pk_bf16_f32 v132, v132, v133
v_cvt_pk_bf16_f32 v133, v134, v135
ds_write_b64 v15, v[132:133] offset:6400
v_pk_fma_f32 v[136:137], v[36:37], v[52:53], v[136:137] op_sel_hi:[0,1,1] neg_lo:[1,0,0] neg_hi:[1,0,0]
v_pk_fma_f32 v[138:139], v[36:37], v[54:55], v[138:139] op_sel_hi:[0,1,1] neg_lo:[1,0,0] neg_hi:[1,0,0]
v_pk_mul_f32 v[204:205], v[34:35], v[204:205] op_sel:[1,0] op_sel_hi:[1,1]
v_pk_mul_f32 v[206:207], v[34:35], v[206:207] op_sel:[1,0] op_sel_hi:[1,1]
v_cvt_pk_bf16_f32 v168, v168, v169
v_cvt_pk_bf16_f32 v169, v170, v171
ds_write_b64 v15, v[168:169] offset:6528
v_pk_fma_f32 v[172:173], v[36:37], v[56:57], v[172:173] op_sel_hi:[0,1,1] neg_lo:[1,0,0] neg_hi:[1,0,0]
v_pk_fma_f32 v[174:175], v[36:37], v[58:59], v[174:175] op_sel_hi:[0,1,1] neg_lo:[1,0,0] neg_hi:[1,0,0]
v_pk_mul_f32 v[136:137], v[36:37], v[136:137] op_sel:[1,0] op_sel_hi:[1,1]
v_pk_mul_f32 v[138:139], v[36:37], v[138:139] op_sel:[1,0] op_sel_hi:[1,1]
v_cvt_pk_bf16_f32 v204, v204, v205
v_cvt_pk_bf16_f32 v205, v206, v207
ds_write_b64 v15, v[204:205] offset:6656
v_pk_fma_f32 v[208:209], v[36:37], v[60:61], v[208:209] op_sel_hi:[0,1,1] neg_lo:[1,0,0] neg_hi:[1,0,0]
v_pk_fma_f32 v[210:211], v[36:37], v[62:63], v[210:211] op_sel_hi:[0,1,1] neg_lo:[1,0,0] neg_hi:[1,0,0]
v_pk_mul_f32 v[172:173], v[36:37], v[172:173] op_sel:[1,0] op_sel_hi:[1,1]
v_pk_mul_f32 v[174:175], v[36:37], v[174:175] op_sel:[1,0] op_sel_hi:[1,1]
v_cvt_pk_bf16_f32 v136, v136, v137
v_cvt_pk_bf16_f32 v137, v138, v139
ds_write_b64 v15, v[136:137] offset:12800
v_pk_fma_f32 v[140:141], v[38:39], v[52:53], v[140:141] op_sel_hi:[0,1,1] neg_lo:[1,0,0] neg_hi:[1,0,0]
v_pk_fma_f32 v[142:143], v[38:39], v[54:55], v[142:143] op_sel_hi:[0,1,1] neg_lo:[1,0,0] neg_hi:[1,0,0]
v_pk_mul_f32 v[208:209], v[36:37], v[208:209] op_sel:[1,0] op_sel_hi:[1,1]
v_pk_mul_f32 v[210:211], v[36:37], v[210:211] op_sel:[1,0] op_sel_hi:[1,1]
v_cvt_pk_bf16_f32 v172, v172, v173
v_cvt_pk_bf16_f32 v173, v174, v175
ds_write_b64 v15, v[172:173] offset:12928
v_pk_fma_f32 v[176:177], v[38:39], v[56:57], v[176:177] op_sel_hi:[0,1,1] neg_lo:[1,0,0] neg_hi:[1,0,0]
v_pk_fma_f32 v[178:179], v[38:39], v[58:59], v[178:179] op_sel_hi:[0,1,1] neg_lo:[1,0,0] neg_hi:[1,0,0]
v_pk_mul_f32 v[140:141], v[38:39], v[140:141] op_sel:[1,0] op_sel_hi:[1,1]
v_pk_mul_f32 v[142:143], v[38:39], v[142:143] op_sel:[1,0] op_sel_hi:[1,1]
v_cvt_pk_bf16_f32 v208, v208, v209
v_cvt_pk_bf16_f32 v209, v210, v211
ds_write_b64 v15, v[208:209] offset:13056
v_pk_fma_f32 v[212:213], v[38:39], v[60:61], v[212:213] op_sel_hi:[0,1,1] neg_lo:[1,0,0] neg_hi:[1,0,0]
v_pk_fma_f32 v[214:215], v[38:39], v[62:63], v[214:215] op_sel_hi:[0,1,1] neg_lo:[1,0,0] neg_hi:[1,0,0]
v_pk_mul_f32 v[176:177], v[38:39], v[176:177] op_sel:[1,0] op_sel_hi:[1,1]
v_pk_mul_f32 v[178:179], v[38:39], v[178:179] op_sel:[1,0] op_sel_hi:[1,1]
v_cvt_pk_bf16_f32 v140, v140, v141
v_cvt_pk_bf16_f32 v141, v142, v143
ds_write_b64 v15, v[140:141] offset:19200
v_pk_fma_f32 v[144:145], v[40:41], v[52:53], v[144:145] op_sel_hi:[0,1,1] neg_lo:[1,0,0] neg_hi:[1,0,0]
v_pk_fma_f32 v[146:147], v[40:41], v[54:55], v[146:147] op_sel_hi:[0,1,1] neg_lo:[1,0,0] neg_hi:[1,0,0]
v_pk_mul_f32 v[212:213], v[38:39], v[212:213] op_sel:[1,0] op_sel_hi:[1,1]
v_pk_mul_f32 v[214:215], v[38:39], v[214:215] op_sel:[1,0] op_sel_hi:[1,1]
v_cvt_pk_bf16_f32 v176, v176, v177
v_cvt_pk_bf16_f32 v177, v178, v179
ds_write_b64 v15, v[176:177] offset:19328
v_pk_fma_f32 v[180:181], v[40:41], v[56:57], v[180:181] op_sel_hi:[0,1,1] neg_lo:[1,0,0] neg_hi:[1,0,0]
v_pk_fma_f32 v[182:183], v[40:41], v[58:59], v[182:183] op_sel_hi:[0,1,1] neg_lo:[1,0,0] neg_hi:[1,0,0]
v_pk_mul_f32 v[144:145], v[40:41], v[144:145] op_sel:[1,0] op_sel_hi:[1,1]
v_pk_mul_f32 v[146:147], v[40:41], v[146:147] op_sel:[1,0] op_sel_hi:[1,1]
v_cvt_pk_bf16_f32 v212, v212, v213
v_cvt_pk_bf16_f32 v213, v214, v215
ds_write_b64 v15, v[212:213] offset:19456
v_pk_fma_f32 v[216:217], v[40:41], v[60:61], v[216:217] op_sel_hi:[0,1,1] neg_lo:[1,0,0] neg_hi:[1,0,0]
v_pk_fma_f32 v[218:219], v[40:41], v[62:63], v[218:219] op_sel_hi:[0,1,1] neg_lo:[1,0,0] neg_hi:[1,0,0]
v_pk_mul_f32 v[180:181], v[40:41], v[180:181] op_sel:[1,0] op_sel_hi:[1,1]
v_pk_mul_f32 v[182:183], v[40:41], v[182:183] op_sel:[1,0] op_sel_hi:[1,1]
v_cvt_pk_bf16_f32 v144, v144, v145
v_cvt_pk_bf16_f32 v145, v146, v147
ds_write_b64 v15, v[144:145] offset:25600
v_pk_fma_f32 v[148:149], v[42:43], v[52:53], v[148:149] op_sel_hi:[0,1,1] neg_lo:[1,0,0] neg_hi:[1,0,0]
v_pk_fma_f32 v[150:151], v[42:43], v[54:55], v[150:151] op_sel_hi:[0,1,1] neg_lo:[1,0,0] neg_hi:[1,0,0]
v_pk_mul_f32 v[216:217], v[40:41], v[216:217] op_sel:[1,0] op_sel_hi:[1,1]
v_pk_mul_f32 v[218:219], v[40:41], v[218:219] op_sel:[1,0] op_sel_hi:[1,1]
v_cvt_pk_bf16_f32 v180, v180, v181
v_cvt_pk_bf16_f32 v181, v182, v183
ds_write_b64 v15, v[180:181] offset:25728
v_pk_fma_f32 v[184:185], v[42:43], v[56:57], v[184:185] op_sel_hi:[0,1,1] neg_lo:[1,0,0] neg_hi:[1,0,0]
v_pk_fma_f32 v[186:187], v[42:43], v[58:59], v[186:187] op_sel_hi:[0,1,1] neg_lo:[1,0,0] neg_hi:[1,0,0]
v_pk_mul_f32 v[148:149], v[42:43], v[148:149] op_sel:[1,0] op_sel_hi:[1,1]
v_pk_mul_f32 v[150:151], v[42:43], v[150:151] op_sel:[1,0] op_sel_hi:[1,1]
v_cvt_pk_bf16_f32 v216, v216, v217
v_cvt_pk_bf16_f32 v217, v218, v219
ds_write_b64 v15, v[216:217] offset:25856
v_pk_fma_f32 v[220:221], v[42:43], v[60:61], v[220:221] op_sel_hi:[0,1,1] neg_lo:[1,0,0] neg_hi:[1,0,0]
v_pk_fma_f32 v[222:223], v[42:43], v[62:63], v[222:223] op_sel_hi:[0,1,1] neg_lo:[1,0,0] neg_hi:[1,0,0]
v_pk_mul_f32 v[184:185], v[42:43], v[184:185] op_sel:[1,0] op_sel_hi:[1,1]
v_pk_mul_f32 v[186:187], v[42:43], v[186:187] op_sel:[1,0] op_sel_hi:[1,1]
v_cvt_pk_bf16_f32 v148, v148, v149
v_cvt_pk_bf16_f32 v149, v150, v151
ds_write_b64 v15, v[148:149] offset:32000
v_pk_fma_f32 v[152:153], v[44:45], v[52:53], v[152:153] op_sel_hi:[0,1,1] neg_lo:[1,0,0] neg_hi:[1,0,0]
v_pk_fma_f32 v[154:155], v[44:45], v[54:55], v[154:155] op_sel_hi:[0,1,1] neg_lo:[1,0,0] neg_hi:[1,0,0]
v_pk_mul_f32 v[220:221], v[42:43], v[220:221] op_sel:[1,0] op_sel_hi:[1,1]
v_pk_mul_f32 v[222:223], v[42:43], v[222:223] op_sel:[1,0] op_sel_hi:[1,1]
v_cvt_pk_bf16_f32 v184, v184, v185
v_cvt_pk_bf16_f32 v185, v186, v187
ds_write_b64 v15, v[184:185] offset:32128
v_pk_fma_f32 v[188:189], v[44:45], v[56:57], v[188:189] op_sel_hi:[0,1,1] neg_lo:[1,0,0] neg_hi:[1,0,0]
v_pk_fma_f32 v[190:191], v[44:45], v[58:59], v[190:191] op_sel_hi:[0,1,1] neg_lo:[1,0,0] neg_hi:[1,0,0]
v_pk_mul_f32 v[152:153], v[44:45], v[152:153] op_sel:[1,0] op_sel_hi:[1,1]
v_pk_mul_f32 v[154:155], v[44:45], v[154:155] op_sel:[1,0] op_sel_hi:[1,1]
v_cvt_pk_bf16_f32 v220, v220, v221
v_cvt_pk_bf16_f32 v221, v222, v223
ds_write_b64 v15, v[220:221] offset:32256
v_pk_fma_f32 v[224:225], v[44:45], v[60:61], v[224:225] op_sel_hi:[0,1,1] neg_lo:[1,0,0] neg_hi:[1,0,0]
v_pk_fma_f32 v[226:227], v[44:45], v[62:63], v[226:227] op_sel_hi:[0,1,1] neg_lo:[1,0,0] neg_hi:[1,0,0]
v_pk_mul_f32 v[188:189], v[44:45], v[188:189] op_sel:[1,0] op_sel_hi:[1,1]
v_pk_mul_f32 v[190:191], v[44:45], v[190:191] op_sel:[1,0] op_sel_hi:[1,1]
v_cvt_pk_bf16_f32 v152, v152, v153
v_cvt_pk_bf16_f32 v153, v154, v155
ds_write_b64 v15, v[152:153] offset:38400
v_pk_fma_f32 v[156:157], v[46:47], v[52:53], v[156:157] op_sel_hi:[0,1,1] neg_lo:[1,0,0] neg_hi:[1,0,0]
v_pk_fma_f32 v[158:159], v[46:47], v[54:55], v[158:159] op_sel_hi:[0,1,1] neg_lo:[1,0,0] neg_hi:[1,0,0]
v_pk_mul_f32 v[224:225], v[44:45], v[224:225] op_sel:[1,0] op_sel_hi:[1,1]
v_pk_mul_f32 v[226:227], v[44:45], v[226:227] op_sel:[1,0] op_sel_hi:[1,1]
v_cvt_pk_bf16_f32 v188, v188, v189
v_cvt_pk_bf16_f32 v189, v190, v191
ds_write_b64 v15, v[188:189] offset:38528
v_pk_fma_f32 v[192:193], v[46:47], v[56:57], v[192:193] op_sel_hi:[0,1,1] neg_lo:[1,0,0] neg_hi:[1,0,0]
v_pk_fma_f32 v[194:195], v[46:47], v[58:59], v[194:195] op_sel_hi:[0,1,1] neg_lo:[1,0,0] neg_hi:[1,0,0]
v_pk_mul_f32 v[156:157], v[46:47], v[156:157] op_sel:[1,0] op_sel_hi:[1,1]
v_pk_mul_f32 v[158:159], v[46:47], v[158:159] op_sel:[1,0] op_sel_hi:[1,1]
v_cvt_pk_bf16_f32 v224, v224, v225
v_cvt_pk_bf16_f32 v225, v226, v227
ds_write_b64 v15, v[224:225] offset:38656
v_pk_fma_f32 v[228:229], v[46:47], v[60:61], v[228:229] op_sel_hi:[0,1,1] neg_lo:[1,0,0] neg_hi:[1,0,0]
v_pk_fma_f32 v[230:231], v[46:47], v[62:63], v[230:231] op_sel_hi:[0,1,1] neg_lo:[1,0,0] neg_hi:[1,0,0]
v_pk_mul_f32 v[192:193], v[46:47], v[192:193] op_sel:[1,0] op_sel_hi:[1,1]
v_pk_mul_f32 v[194:195], v[46:47], v[194:195] op_sel:[1,0] op_sel_hi:[1,1]
v_cvt_pk_bf16_f32 v156, v156, v157
v_cvt_pk_bf16_f32 v157, v158, v159
ds_write_b64 v15, v[156:157] offset:44800
v_pk_fma_f32 v[160:161], v[48:49], v[52:53], v[160:161] op_sel_hi:[0,1,1] neg_lo:[1,0,0] neg_hi:[1,0,0]
v_pk_fma_f32 v[162:163], v[48:49], v[54:55], v[162:163] op_sel_hi:[0,1,1] neg_lo:[1,0,0] neg_hi:[1,0,0]
v_pk_mul_f32 v[228:229], v[46:47], v[228:229] op_sel:[1,0] op_sel_hi:[1,1]
v_pk_mul_f32 v[230:231], v[46:47], v[230:231] op_sel:[1,0] op_sel_hi:[1,1]
v_cvt_pk_bf16_f32 v192, v192, v193
v_cvt_pk_bf16_f32 v193, v194, v195
ds_write_b64 v15, v[192:193] offset:44928
v_pk_fma_f32 v[196:197], v[48:49], v[56:57], v[196:197] op_sel_hi:[0,1,1] neg_lo:[1,0,0] neg_hi:[1,0,0]
v_pk_fma_f32 v[198:199], v[48:49], v[58:59], v[198:199] op_sel_hi:[0,1,1] neg_lo:[1,0,0] neg_hi:[1,0,0]
v_pk_mul_f32 v[160:161], v[48:49], v[160:161] op_sel:[1,0] op_sel_hi:[1,1]
v_pk_mul_f32 v[162:163], v[48:49], v[162:163] op_sel:[1,0] op_sel_hi:[1,1]
v_cvt_pk_bf16_f32 v228, v228, v229
v_cvt_pk_bf16_f32 v229, v230, v231
ds_write_b64 v15, v[228:229] offset:45056
v_pk_fma_f32 v[232:233], v[48:49], v[60:61], v[232:233] op_sel_hi:[0,1,1] neg_lo:[1,0,0] neg_hi:[1,0,0]
v_pk_fma_f32 v[234:235], v[48:49], v[62:63], v[234:235] op_sel_hi:[0,1,1] neg_lo:[1,0,0] neg_hi:[1,0,0]
v_pk_mul_f32 v[196:197], v[48:49], v[196:197] op_sel:[1,0] op_sel_hi:[1,1]
v_pk_mul_f32 v[198:199], v[48:49], v[198:199] op_sel:[1,0] op_sel_hi:[1,1]
v_cvt_pk_bf16_f32 v160, v160, v161
v_cvt_pk_bf16_f32 v161, v162, v163
ds_write_b64 v15, v[160:161] offset:51200
v_pk_mul_f32 v[232:233], v[48:49], v[232:233] op_sel:[1,0] op_sel_hi:[1,1]
v_pk_mul_f32 v[234:235], v[48:49], v[234:235] op_sel:[1,0] op_sel_hi:[1,1]
v_cvt_pk_bf16_f32 v196, v196, v197
v_cvt_pk_bf16_f32 v197, v198, v199
ds_write_b64 v15, v[196:197] offset:51328
v_cvt_pk_bf16_f32 v232, v232, v233
v_cvt_pk_bf16_f32 v233, v234, v235
ds_write_b64 v15, v[232:233] offset:51456
s_waitcnt lgkmcnt(0)
s_branch Latt_5
Lpf_4:
s_lshl_b32 s43, s35, 7
s_waitcnt lgkmcnt(0)
s_mov_b32 s8, s64
s_mov_b32 s9, s65
s_mov_b32 s10, 4194304
s_mov_b32 s11, 0x20000
s_add_u32 s12, s66, s43
s_addc_u32 s13, s67, 0
s_mov_b32 s14, 6289536
s_mov_b32 s15, 0x20000
s_add_u32 s84, s82, 28311552
s_addc_u32 s85, s83, 0
s_branch Lov_3
.p2align 12
.fill 16, 4, 0xbf800000
Lst_3_0:
s_branch Lwr_170
s_nop 0
s_nop 0
Lov_3:
s_mov_b32 s86, 114688
s_mov_b32 s87, 0x20000
s_mov_b32 s56, s80
s_mov_b32 s57, s81
s_mov_b32 s58, 256
s_mov_b32 s59, 0x20000
v_mov_b32 v5, 0
v_lshlrev_b32 v14, 7, v1
s_or_b32 s43, s34, s35
s_cmp_lg_u32 s43, 0
s_cbranch_scc1 Lz_20
s_movk_i32 s43, 0x2000
buffer_store_dword v5, v14, s[84:87], 0 offen sc1
s_bfm_b64 exec, 44, 0
buffer_store_dword v5, v14, s[84:87], s43 offen sc1
s_mov_b64 exec, 1
v_mov_b32 v6, 1
s_waitcnt vmcnt(0)
buffer_store_dword v6, v5, s[56:59], 0 offen sc1
s_mov_b64 exec, -1
Lz_20:
s_lshl_b32 s43, s51, 11
buffer_load_dwordx4 v[96:99], v10, s[8:11], s43 offen offset:0
buffer_load_dwordx4 v[100:103], v10, s[8:11], s43 offen offset:1024
buffer_load_dwordx4 v[104:107], v10, s[8:11], s43 offen offset:2048
buffer_load_dwordx4 v[108:111], v10, s[8:11], s43 offen offset:3072
v_min_u32 v14, 23, v1
v_lshrrev_b32 v15, 3, v14
v_mul_u32_u24 v15, 43008, v15
v_and_b32 v14, 7, v14
v_lshl_add_u32 v15, v14, 4, v15
v_mov_b32 v32, 0x3f803f80
v_mov_b32 v33, 0x3f803f80
v_mov_b32 v34, 0x3f803f80
v_mov_b32 v35, 0x3f803f80
ds_write_b128 v15, v[32:35]
s_add_u32 s20, s82, 26214400
s_addc_u32 s21, s83, 0
s_mov_b32 s22, 16384
s_mov_b32 s23, 0x20000
s_add_u32 s43, s2, 128
s_lshl_b32 s43, s43, 7
v_lshlrev_b32 v14, 2, v1
s_mov_b64 exec, 15
buffer_store_dword v5, v14, s[84:87], s43 offen sc1
s_mov_b64 exec, -1
s_lshl_b32 s43, s34, 4
s_add_u32 s43, s43, s35
s_lshl_b32 s43, s43, 8
s_add_u32 s43, s43, 49152
v_lshlrev_b32 v14, 7, v1
s_mov_b64 exec, 3
buffer_store_dword v5, v14, s[84:87], s43 offen sc1
s_mov_b64 exec, -1
s_lshl_b32 s52, s34, 7
s_add_u32 s52, s52, 28319744
s_sub_u32 s53, s52, 128
s_cmp_eq_u32 s34, 0
s_cselect_b32 s53, s52, s53
s_waitcnt lgkmcnt(0)
s_barrier
s_waitcnt vmcnt(2)
s_mov_b32 s43, 0x3f803f80
v_mov_b32 v116, 0
v_mov_b32 v117, 0
v_mov_b32 v118, 0
v_mov_b32 v119, 0
v_mov_b32 v120, 0
v_mov_b32 v121, 0
v_mov_b32 v122, 0
v_mov_b32 v123, 0
v_dot2_f32_bf16 v116, v96, s43, v116
v_dot2_f32_bf16 v120, v96, v96, v120
v_dot2_f32_bf16 v118, v104, s43, v118
v_dot2_f32_bf16 v122, v104, v104, v122
v_dot2_f32_bf16 v117, v97, s43, v117
v_dot2_f32_bf16 v121, v97, v97, v121
v_dot2_f32_bf16 v119, v105, s43, v119
v_dot2_f32_bf16 v123, v105, v105, v123
v_dot2_f32_bf16 v116, v98, s43, v116
v_dot2_f32_bf16 v120, v98, v98, v120
v_dot2_f32_bf16 v118, v106, s43, v118
v_dot2_f32_bf16 v122, v106, v106, v122
v_dot2_f32_bf16 v117, v99, s43, v117
v_dot2_f32_bf16 v121, v99, v99, v121
v_dot2_f32_bf16 v119, v107, s43, v119
v_dot2_f32_bf16 v123, v107, v107, v123
v_dot2_f32_bf16 v116, v100, s43, v116
v_dot2_f32_bf16 v120, v100, v100, v120
v_dot2_f32_bf16 v118, v108, s43, v118
v_dot2_f32_bf16 v122, v108, v108, v122
v_dot2_f32_bf16 v117, v101, s43, v117
v_dot2_f32_bf16 v121, v101, v101, v121
v_dot2_f32_bf16 v119, v109, s43, v119
v_dot2_f32_bf16 v123, v109, v109, v123
v_dot2_f32_bf16 v116, v102, s43, v116
v_dot2_f32_bf16 v120, v102, v102, v120
v_dot2_f32_bf16 v118, v110, s43, v118
v_dot2_f32_bf16 v122, v110, v110, v122
v_dot2_f32_bf16 v117, v103, s43, v117
v_dot2_f32_bf16 v121, v103, v103, v121
v_dot2_f32_bf16 v119, v111, s43, v119
v_dot2_f32_bf16 v123, v111, v111, v123
s_nop 2
v_add_f32 v116, v116, v117
v_add_f32 v118, v118, v119
v_add_f32 v120, v120, v121
v_add_f32 v122, v122, v123
s_nop 1
v_permlane32_swap_b32 v116, v118
v_permlane32_swap_b32 v120, v122
v_add_f32 v116, v116, v118
v_add_f32 v120, v120, v122
s_nop 1
v_permlane16_swap_b32 v116, v120
v_add_f32 v116, v116, v120
s_nop 1
v_add_f32_dpp v116, v116, v116 row_ror:8 row_mask:0xf bank_mask:0xf
s_nop 1
v_add_f32_dpp v116, v116, v116 row_ror:4 row_mask:0xf bank_mask:0xf
s_nop 1
v_add_f32_dpp v116, v116, v116 row_ror:2 row_mask:0xf bank_mask:0xf
s_nop 1
v_add_f32_dpp v116, v116, v116 row_ror:1 row_mask:0xf bank_mask:0xf
v_mov_b32 v117, v116
s_nop 1
v_permlane16_swap_b32 v116, v117
v_mul_f32 v112, 0x3a800000, v116
v_mul_f32 v113, 0x3a800000, v117
v_fma_f32 v113, -v112, v112, v113
v_max_f32 v113, 0, v113
v_add_f32 v113, 0x3727c5ac, v113
v_rsq_f32 v113, v113
v_lshrrev_b32 v11, 5, v1
s_lshl_b32 s43, s47, 4
s_add_u32 s43, s43, 148608
v_lshl_add_u32 v11, v11, 3, s43
ds_write_b64 v11, v[112:113]
s_waitcnt lgkmcnt(0)
s_mov_b32 s28, s66
s_mov_b32 s29, s67
s_mov_b32 s30, 6291456
s_mov_b32 s31, 0x20000
s_mul_i32 s43, s33, 10624
s_add_u32 s43, s43, 1572864
v_lshlrev_b32 v30, 7, v1
buffer_load_dword v31, v30, s[28:31], s43 offen
s_add_u32 s43, s43, 8192
s_bfm_b64 exec, 19, 0
buffer_load_dword v31, v30, s[28:31], s43 offen
s_mov_b64 exec, -1
s_branch Lst_0_0
Lwr_167:
s_barrier
v_lshlrev_b32 v5, 4, v1
v_and_b32 v5, 63, v5
v_add_u32 v6, 148608, v5
ds_read_b128 v[112:115], v6
s_lshl_b32 s43, s63, 3
v_add_u32 v5, s43, v5
s_waitcnt lgkmcnt(0)
s_mov_b64 exec, 15
buffer_store_dwordx4 v[112:115], v5, s[20:23], 0 offen sc1
s_mov_b64 exec, -1
v_mov_b32 v4, 0
buffer_load_dword v6, v4, s[56:59], 0 offen sc1
s_mov_b32 s62, 0
s_branch Lst_1_0
Lwr_168:
s_barrier
s_mov_b32 s28, s66
s_mov_b32 s29, s67
s_mov_b32 s30, 6291456
s_mov_b32 s31, 0x20000
s_mul_i32 s43, s33, 10624
s_add_u32 s43, s43, 3932160
v_lshlrev_b32 v30, 7, v1
buffer_load_dword v31, v30, s[28:31], s43 offen
s_add_u32 s43, s43, 8192
s_bfm_b64 exec, 19, 0
buffer_load_dword v31, v30, s[28:31], s43 offen
s_mov_b64 exec, -1
s_lshl_b32 s43, s35, 7
s_add_u32 s28, s68, s43
s_addc_u32 s29, s69, 0
s_mov_b32 s30, 2095232
s_mov_b32 s31, 0x20000
v_and_b32 v29, 7, v1
v_lshrrev_b32 v30, 3, v1
v_lshl_add_u32 v29, v30, 6, v29
s_lshl_b32 s43, s48, 3
v_add_u32 v29, s43, v29
v_lshlrev_b32 v29, 11, v29
s_mov_b32 s43, 1048576
s_mov_b32 s28, s68
s_mov_b32 s29, s69
s_mov_b32 s30, 2097152
s_mov_b32 s31, 0x20000
s_mul_i32 s43, s33, 9472
v_lshlrev_b32 v30, 7, v1
buffer_load_dword v31, v30, s[28:31], s43 offen
s_add_u32 s43, s43, 8192
s_bfm_b64 exec, 10, 0
buffer_load_dword v31, v30, s[28:31], s43 offen
s_mov_b64 exec, -1
s_branch Lst_2_0
Lwr_169:
s_barrier
s_cmp_eq_u32 s62, 3
s_cbranch_scc1 Lste_24
s_cmp_eq_u32 s62, 2
s_cbranch_scc1 Lst2_22
s_cmp_ge_u32 s62, 4
s_cbranch_scc1 Lst4_23
s_cmp_eq_u32 s62, 1
s_cbranch_scc1 Lst1_21
s_waitcnt vmcnt(4)
v_readfirstlane_b32 s54, v6
s_cmp_eq_u32 s54, 0
s_cbranch_scc0 Lrep_25
buffer_load_dword v6, v4, s[56:59], 0 offen sc1
s_branch Lste_24
Lrep_25:
s_add_u32 s7, s34, 64
s_lshl_b32 s7, s7, 7
v_mov_b32 v5, s7
v_mov_b32 v6, 1
s_mov_b64 exec, 1
buffer_atomic_add v6, v5, s[84:87], 0 offen sc1
s_mov_b64 exec, -1
s_mov_b32 s62, 1
s_mov_b32 s54, 0
s_mov_b32 s55, 0
s_branch Lste_24
Lst1_21:
s_and_b32 s43, s54, s55
s_cmp_eq_u32 s43, 16
s_cbranch_scc1 Lg_26
s_load_dword s54, s[82:83], s52 glc
s_load_dword s55, s[82:83], s53 glc
s_branch Lste_24
Lg_26:
v_add_u32 v5, 0, v1
v_min_u32 v5, 143, v5
v_lshlrev_b32 v20, 3, v5
v_add_u32 v5, s50, v5
v_max_i32 v5, 0, v5
v_lshlrev_b32 v5, 3, v5
buffer_load_dwordx2 v[32:33], v5, s[20:23], 0 offen sc1
v_add_u32 v5, 64, v1
v_min_u32 v5, 143, v5
v_lshlrev_b32 v21, 3, v5
v_add_u32 v5, s50, v5
v_max_i32 v5, 0, v5
v_lshlrev_b32 v5, 3, v5
buffer_load_dwordx2 v[34:35], v5, s[20:23], 0 offen sc1
v_add_u32 v5, 128, v1
v_min_u32 v5, 143, v5
v_lshlrev_b32 v22, 3, v5
v_add_u32 v5, s50, v5
v_max_i32 v5, 0, v5
v_lshlrev_b32 v5, 3, v5
buffer_load_dwordx2 v[36:37], v5, s[20:23], 0 offen sc1
s_mov_b32 s62, 4
s_branch Lste_24
Lst4_23:
s_mov_b32 s62, 2
s_branch Lste_24
Lst2_22:
s_waitcnt vmcnt(0)
v_add_u32 v20, 147456, v20
ds_write_b64 v20, v[32:33]
v_add_u32 v21, 147456, v21
ds_write_b64 v21, v[34:35]
v_add_u32 v22, 147456, v22
ds_write_b64 v22, v[36:37]
s_waitcnt lgkmcnt(0)
s_mov_b32 s62, 3
Lste_24:
s_branch Lst_3_0
Lwr_170:
s_barrier
s_cmp_eq_u32 s62, 3
s_cbranch_scc1 Lste_30
s_cmp_eq_u32 s62, 2
s_cbranch_scc1 Lst2_28
s_cmp_ge_u32 s62, 4
s_cbranch_scc1 Lst4_29
s_cmp_eq_u32 s62, 1
s_cbranch_scc1 Lst1_27
s_waitcnt vmcnt(0)
v_readfirstlane_b32 s54, v6
s_cmp_eq_u32 s54, 0
s_cbranch_scc0 Lrep_31
buffer_load_dword v6, v4, s[56:59], 0 offen sc1
s_branch Lste_30
Lrep_31:
s_add_u32 s7, s34, 64
s_lshl_b32 s7, s7, 7
v_mov_b32 v5, s7
v_mov_b32 v6, 1
s_mov_b64 exec, 1
buffer_atomic_add v6, v5, s[84:87], 0 offen sc1
s_mov_b64 exec, -1
s_mov_b32 s62, 1
s_mov_b32 s54, 0
s_mov_b32 s55, 0
s_branch Lste_30
Lst1_27:
s_and_b32 s43, s54, s55
s_cmp_eq_u32 s43, 16
s_cbranch_scc1 Lg_32
s_load_dword s54, s[82:83], s52 glc
s_load_dword s55, s[82:83], s53 glc
s_branch Lste_30
Lg_32:
v_add_u32 v5, 0, v1
v_min_u32 v5, 143, v5
v_lshlrev_b32 v20, 3, v5
v_add_u32 v5, s50, v5
v_max_i32 v5, 0, v5
v_lshlrev_b32 v5, 3, v5
buffer_load_dwordx2 v[32:33], v5, s[20:23], 0 offen sc1
v_add_u32 v5, 64, v1
v_min_u32 v5, 143, v5
v_lshlrev_b32 v21, 3, v5
v_add_u32 v5, s50, v5
v_max_i32 v5, 0, v5
v_lshlrev_b32 v5, 3, v5
buffer_load_dwordx2 v[34:35], v5, s[20:23], 0 offen sc1
v_add_u32 v5, 128, v1
v_min_u32 v5, 143, v5
v_lshlrev_b32 v22, 3, v5
v_add_u32 v5, s50, v5
v_max_i32 v5, 0, v5
v_lshlrev_b32 v5, 3, v5
buffer_load_dwordx2 v[36:37], v5, s[20:23], 0 offen sc1
s_mov_b32 s62, 4
s_branch Lste_30
Lst4_29:
s_mov_b32 s62, 2
s_branch Lste_30
Lst2_28:
s_waitcnt vmcnt(0)
v_add_u32 v20, 147456, v20
ds_write_b64 v20, v[32:33]
v_add_u32 v21, 147456, v21
ds_write_b64 v21, v[34:35]
v_add_u32 v22, 147456, v22
ds_write_b64 v22, v[36:37]
s_waitcnt lgkmcnt(0)
s_mov_b32 s62, 3
Lste_30:
s_branch Lst_4_0
Lwr_171:
s_barrier
s_cmp_eq_u32 s62, 3
s_cbranch_scc1 Lste_36
s_cmp_eq_u32 s62, 2
s_cbranch_scc1 Lst2_34
s_cmp_ge_u32 s62, 4
s_cbranch_scc1 Lst4_35
s_cmp_eq_u32 s62, 1
s_cbranch_scc1 Lst1_33
s_waitcnt vmcnt(0)
v_readfirstlane_b32 s54, v6
s_cmp_eq_u32 s54, 0
s_cbranch_scc0 Lrep_37
buffer_load_dword v6, v4, s[56:59], 0 offen sc1
s_branch Lste_36
Lrep_37:
s_add_u32 s7, s34, 64
s_lshl_b32 s7, s7, 7
v_mov_b32 v5, s7
v_mov_b32 v6, 1
s_mov_b64 exec, 1
buffer_atomic_add v6, v5, s[84:87], 0 offen sc1
s_mov_b64 exec, -1
s_mov_b32 s62, 1
s_mov_b32 s54, 0
s_mov_b32 s55, 0
s_branch Lste_36
Lst1_33:
s_and_b32 s43, s54, s55
s_cmp_eq_u32 s43, 16
s_cbranch_scc1 Lg_38
s_load_dword s54, s[82:83], s52 glc
s_load_dword s55, s[82:83], s53 glc
s_branch Lste_36
Lg_38:
v_add_u32 v5, 0, v1
v_min_u32 v5, 143, v5
v_lshlrev_b32 v20, 3, v5
v_add_u32 v5, s50, v5
v_max_i32 v5, 0, v5
v_lshlrev_b32 v5, 3, v5
buffer_load_dwordx2 v[32:33], v5, s[20:23], 0 offen sc1
v_add_u32 v5, 64, v1
v_min_u32 v5, 143, v5
v_lshlrev_b32 v21, 3, v5
v_add_u32 v5, s50, v5
v_max_i32 v5, 0, v5
v_lshlrev_b32 v5, 3, v5
buffer_load_dwordx2 v[34:35], v5, s[20:23], 0 offen sc1
v_add_u32 v5, 128, v1
v_min_u32 v5, 143, v5
v_lshlrev_b32 v22, 3, v5
v_add_u32 v5, s50, v5
v_max_i32 v5, 0, v5
v_lshlrev_b32 v5, 3, v5
buffer_load_dwordx2 v[36:37], v5, s[20:23], 0 offen sc1
s_mov_b32 s62, 4
s_branch Lste_36
Lst4_35:
s_mov_b32 s62, 2
s_branch Lste_36
Lst2_34:
s_waitcnt vmcnt(0)
v_add_u32 v20, 147456, v20
ds_write_b64 v20, v[32:33]
v_add_u32 v21, 147456, v21
ds_write_b64 v21, v[34:35]
v_add_u32 v22, 147456, v22
ds_write_b64 v22, v[36:37]
s_waitcnt lgkmcnt(0)
s_mov_b32 s62, 3
Lste_36:
s_branch Lst_5_0
Lwr_172:
s_barrier
s_cmp_eq_u32 s62, 3
s_cbranch_scc1 Lste_42
s_cmp_eq_u32 s62, 2
s_cbranch_scc1 Lst2_40
s_cmp_ge_u32 s62, 4
s_cbranch_scc1 Lst4_41
s_cmp_eq_u32 s62, 1
s_cbranch_scc1 Lst1_39
s_waitcnt vmcnt(0)
v_readfirstlane_b32 s54, v6
s_cmp_eq_u32 s54, 0
s_cbranch_scc0 Lrep_43
buffer_load_dword v6, v4, s[56:59], 0 offen sc1
s_branch Lste_42
Lrep_43:
s_add_u32 s7, s34, 64
s_lshl_b32 s7, s7, 7
v_mov_b32 v5, s7
v_mov_b32 v6, 1
s_mov_b64 exec, 1
buffer_atomic_add v6, v5, s[84:87], 0 offen sc1
s_mov_b64 exec, -1
s_mov_b32 s62, 1
s_mov_b32 s54, 0
s_mov_b32 s55, 0
s_branch Lste_42
Lst1_39:
s_and_b32 s43, s54, s55
s_cmp_eq_u32 s43, 16
s_cbranch_scc1 Lg_44
s_load_dword s54, s[82:83], s52 glc
s_load_dword s55, s[82:83], s53 glc
s_branch Lste_42
Lg_44:
v_add_u32 v5, 0, v1
v_min_u32 v5, 143, v5
v_lshlrev_b32 v20, 3, v5
v_add_u32 v5, s50, v5
v_max_i32 v5, 0, v5
v_lshlrev_b32 v5, 3, v5
buffer_load_dwordx2 v[32:33], v5, s[20:23], 0 offen sc1
v_add_u32 v5, 64, v1
v_min_u32 v5, 143, v5
v_lshlrev_b32 v21, 3, v5
v_add_u32 v5, s50, v5
v_max_i32 v5, 0, v5
v_lshlrev_b32 v5, 3, v5
buffer_load_dwordx2 v[34:35], v5, s[20:23], 0 offen sc1
v_add_u32 v5, 128, v1
v_min_u32 v5, 143, v5
v_lshlrev_b32 v22, 3, v5
v_add_u32 v5, s50, v5
v_max_i32 v5, 0, v5
v_lshlrev_b32 v5, 3, v5
buffer_load_dwordx2 v[36:37], v5, s[20:23], 0 offen sc1
s_mov_b32 s62, 4
s_branch Lste_42
Lst4_41:
s_mov_b32 s62, 2
s_branch Lste_42
Lst2_40:
s_waitcnt vmcnt(0)
v_add_u32 v20, 147456, v20
ds_write_b64 v20, v[32:33]
v_add_u32 v21, 147456, v21
ds_write_b64 v21, v[34:35]
v_add_u32 v22, 147456, v22
ds_write_b64 v22, v[36:37]
s_waitcnt lgkmcnt(0)
s_mov_b32 s62, 3
Lste_42:
s_branch Lst_6_0
Lwr_173:
s_barrier
s_cmp_eq_u32 s62, 3
s_cbranch_scc1 Lste_48
s_cmp_eq_u32 s62, 2
s_cbranch_scc1 Lst2_46
s_cmp_ge_u32 s62, 4
s_cbranch_scc1 Lst4_47
s_cmp_eq_u32 s62, 1
s_cbranch_scc1 Lst1_45
s_waitcnt vmcnt(0)
v_readfirstlane_b32 s54, v6
s_cmp_eq_u32 s54, 0
s_cbranch_scc0 Lrep_49
buffer_load_dword v6, v4, s[56:59], 0 offen sc1
s_branch Lste_48
Lrep_49:
s_add_u32 s7, s34, 64
s_lshl_b32 s7, s7, 7
v_mov_b32 v5, s7
v_mov_b32 v6, 1
s_mov_b64 exec, 1
buffer_atomic_add v6, v5, s[84:87], 0 offen sc1
s_mov_b64 exec, -1
s_mov_b32 s62, 1
s_mov_b32 s54, 0
s_mov_b32 s55, 0
s_branch Lste_48
Lst1_45:
s_and_b32 s43, s54, s55
s_cmp_eq_u32 s43, 16
s_cbranch_scc1 Lg_50
s_load_dword s54, s[82:83], s52 glc
s_load_dword s55, s[82:83], s53 glc
s_branch Lste_48
Lg_50:
v_add_u32 v5, 0, v1
v_min_u32 v5, 143, v5
v_lshlrev_b32 v20, 3, v5
v_add_u32 v5, s50, v5
v_max_i32 v5, 0, v5
v_lshlrev_b32 v5, 3, v5
buffer_load_dwordx2 v[32:33], v5, s[20:23], 0 offen sc1
v_add_u32 v5, 64, v1
v_min_u32 v5, 143, v5
v_lshlrev_b32 v21, 3, v5
v_add_u32 v5, s50, v5
v_max_i32 v5, 0, v5
v_lshlrev_b32 v5, 3, v5
buffer_load_dwordx2 v[34:35], v5, s[20:23], 0 offen sc1
v_add_u32 v5, 128, v1
v_min_u32 v5, 143, v5
v_lshlrev_b32 v22, 3, v5
v_add_u32 v5, s50, v5
v_max_i32 v5, 0, v5
v_lshlrev_b32 v5, 3, v5
buffer_load_dwordx2 v[36:37], v5, s[20:23], 0 offen sc1
s_mov_b32 s62, 4
s_branch Lste_48
Lst4_47:
s_mov_b32 s62, 2
s_branch Lste_48
Lst2_46:
s_waitcnt vmcnt(0)
v_add_u32 v20, 147456, v20
ds_write_b64 v20, v[32:33]
v_add_u32 v21, 147456, v21
ds_write_b64 v21, v[34:35]
v_add_u32 v22, 147456, v22
ds_write_b64 v22, v[36:37]
s_waitcnt lgkmcnt(0)
s_mov_b32 s62, 3
Lste_48:
s_branch Lst_7_0
Lwr_174:
s_barrier
s_cmp_eq_u32 s62, 3
s_cbranch_scc1 Lste_54
s_cmp_eq_u32 s62, 2
s_cbranch_scc1 Lst2_52
s_cmp_ge_u32 s62, 4
s_cbranch_scc1 Lst4_53
s_cmp_eq_u32 s62, 1
s_cbranch_scc1 Lst1_51
s_waitcnt vmcnt(0)
v_readfirstlane_b32 s54, v6
s_cmp_eq_u32 s54, 0
s_cbranch_scc0 Lrep_55
buffer_load_dword v6, v4, s[56:59], 0 offen sc1
s_branch Lste_54
Lrep_55:
s_add_u32 s7, s34, 64
s_lshl_b32 s7, s7, 7
v_mov_b32 v5, s7
v_mov_b32 v6, 1
s_mov_b64 exec, 1
buffer_atomic_add v6, v5, s[84:87], 0 offen sc1
s_mov_b64 exec, -1
s_mov_b32 s62, 1
s_mov_b32 s54, 0
s_mov_b32 s55, 0
s_branch Lste_54
Lst1_51:
s_and_b32 s43, s54, s55
s_cmp_eq_u32 s43, 16
s_cbranch_scc1 Lg_56
s_load_dword s54, s[82:83], s52 glc
s_load_dword s55, s[82:83], s53 glc
s_branch Lste_54
Lg_56:
v_add_u32 v5, 0, v1
v_min_u32 v5, 143, v5
v_lshlrev_b32 v20, 3, v5
v_add_u32 v5, s50, v5
v_max_i32 v5, 0, v5
v_lshlrev_b32 v5, 3, v5
buffer_load_dwordx2 v[32:33], v5, s[20:23], 0 offen sc1
v_add_u32 v5, 64, v1
v_min_u32 v5, 143, v5
v_lshlrev_b32 v21, 3, v5
v_add_u32 v5, s50, v5
v_max_i32 v5, 0, v5
v_lshlrev_b32 v5, 3, v5
buffer_load_dwordx2 v[34:35], v5, s[20:23], 0 offen sc1
v_add_u32 v5, 128, v1
v_min_u32 v5, 143, v5
v_lshlrev_b32 v22, 3, v5
v_add_u32 v5, s50, v5
v_max_i32 v5, 0, v5
v_lshlrev_b32 v5, 3, v5
buffer_load_dwordx2 v[36:37], v5, s[20:23], 0 offen sc1
s_mov_b32 s62, 4
s_branch Lste_54
Lst4_53:
s_mov_b32 s62, 2
s_branch Lste_54
Lst2_52:
s_waitcnt vmcnt(0)
v_add_u32 v20, 147456, v20
ds_write_b64 v20, v[32:33]
v_add_u32 v21, 147456, v21
ds_write_b64 v21, v[34:35]
v_add_u32 v22, 147456, v22
ds_write_b64 v22, v[36:37]
s_waitcnt lgkmcnt(0)
s_mov_b32 s62, 3
Lste_54:
s_branch Lst_8_0
Lwr_175:
s_barrier
s_cmp_eq_u32 s62, 3
s_cbranch_scc1 Lste_60
s_cmp_eq_u32 s62, 2
s_cbranch_scc1 Lst2_58
s_cmp_ge_u32 s62, 4
s_cbranch_scc1 Lst4_59
s_cmp_eq_u32 s62, 1
s_cbranch_scc1 Lst1_57
s_waitcnt vmcnt(0)
v_readfirstlane_b32 s54, v6
s_cmp_eq_u32 s54, 0
s_cbranch_scc0 Lrep_61
buffer_load_dword v6, v4, s[56:59], 0 offen sc1
s_branch Lste_60
Lrep_61:
s_add_u32 s7, s34, 64
s_lshl_b32 s7, s7, 7
v_mov_b32 v5, s7
v_mov_b32 v6, 1
s_mov_b64 exec, 1
buffer_atomic_add v6, v5, s[84:87], 0 offen sc1
s_mov_b64 exec, -1
s_mov_b32 s62, 1
s_mov_b32 s54, 0
s_mov_b32 s55, 0
s_branch Lste_60
Lst1_57:
s_and_b32 s43, s54, s55
s_cmp_eq_u32 s43, 16
s_cbranch_scc1 Lg_62
s_load_dword s54, s[82:83], s52 glc
s_load_dword s55, s[82:83], s53 glc
s_branch Lste_60
Lg_62:
v_add_u32 v5, 0, v1
v_min_u32 v5, 143, v5
v_lshlrev_b32 v20, 3, v5
v_add_u32 v5, s50, v5
v_max_i32 v5, 0, v5
v_lshlrev_b32 v5, 3, v5
buffer_load_dwordx2 v[32:33], v5, s[20:23], 0 offen sc1
v_add_u32 v5, 64, v1
v_min_u32 v5, 143, v5
v_lshlrev_b32 v21, 3, v5
v_add_u32 v5, s50, v5
v_max_i32 v5, 0, v5
v_lshlrev_b32 v5, 3, v5
buffer_load_dwordx2 v[34:35], v5, s[20:23], 0 offen sc1
v_add_u32 v5, 128, v1
v_min_u32 v5, 143, v5
v_lshlrev_b32 v22, 3, v5
v_add_u32 v5, s50, v5
v_max_i32 v5, 0, v5
v_lshlrev_b32 v5, 3, v5
buffer_load_dwordx2 v[36:37], v5, s[20:23], 0 offen sc1
s_mov_b32 s62, 4
s_branch Lste_60
Lst4_59:
s_mov_b32 s62, 2
s_branch Lste_60
Lst2_58:
s_waitcnt vmcnt(0)
v_add_u32 v20, 147456, v20
ds_write_b64 v20, v[32:33]
v_add_u32 v21, 147456, v21
ds_write_b64 v21, v[34:35]
v_add_u32 v22, 147456, v22
ds_write_b64 v22, v[36:37]
s_waitcnt lgkmcnt(0)
s_mov_b32 s62, 3
Lste_60:
s_branch Lst_9_0
Lwr_176:
s_barrier
s_cmp_eq_u32 s62, 3
s_cbranch_scc1 Lste_66
s_cmp_eq_u32 s62, 2
s_cbranch_scc1 Lst2_64
s_cmp_ge_u32 s62, 4
s_cbranch_scc1 Lst4_65
s_cmp_eq_u32 s62, 1
s_cbranch_scc1 Lst1_63
s_waitcnt vmcnt(0)
v_readfirstlane_b32 s54, v6
s_cmp_eq_u32 s54, 0
s_cbranch_scc0 Lrep_67
buffer_load_dword v6, v4, s[56:59], 0 offen sc1
s_branch Lste_66
Lrep_67:
s_add_u32 s7, s34, 64
s_lshl_b32 s7, s7, 7
v_mov_b32 v5, s7
v_mov_b32 v6, 1
s_mov_b64 exec, 1
buffer_atomic_add v6, v5, s[84:87], 0 offen sc1
s_mov_b64 exec, -1
s_mov_b32 s62, 1
s_mov_b32 s54, 0
s_mov_b32 s55, 0
s_branch Lste_66
Lst1_63:
s_and_b32 s43, s54, s55
s_cmp_eq_u32 s43, 16
s_cbranch_scc1 Lg_68
s_load_dword s54, s[82:83], s52 glc
s_load_dword s55, s[82:83], s53 glc
s_branch Lste_66
Lg_68:
v_add_u32 v5, 0, v1
v_min_u32 v5, 143, v5
v_lshlrev_b32 v20, 3, v5
v_add_u32 v5, s50, v5
v_max_i32 v5, 0, v5
v_lshlrev_b32 v5, 3, v5
buffer_load_dwordx2 v[32:33], v5, s[20:23], 0 offen sc1
v_add_u32 v5, 64, v1
v_min_u32 v5, 143, v5
v_lshlrev_b32 v21, 3, v5
v_add_u32 v5, s50, v5
v_max_i32 v5, 0, v5
v_lshlrev_b32 v5, 3, v5
buffer_load_dwordx2 v[34:35], v5, s[20:23], 0 offen sc1
v_add_u32 v5, 128, v1
v_min_u32 v5, 143, v5
v_lshlrev_b32 v22, 3, v5
v_add_u32 v5, s50, v5
v_max_i32 v5, 0, v5
v_lshlrev_b32 v5, 3, v5
buffer_load_dwordx2 v[36:37], v5, s[20:23], 0 offen sc1
s_mov_b32 s62, 4
s_branch Lste_66
Lst4_65:
s_mov_b32 s62, 2
s_branch Lste_66
Lst2_64:
s_waitcnt vmcnt(0)
v_add_u32 v20, 147456, v20
ds_write_b64 v20, v[32:33]
v_add_u32 v21, 147456, v21
ds_write_b64 v21, v[34:35]
v_add_u32 v22, 147456, v22
ds_write_b64 v22, v[36:37]
s_waitcnt lgkmcnt(0)
s_mov_b32 s62, 3
Lste_66:
s_branch Lst_10_0
Lwr_177:
s_barrier
s_cmp_eq_u32 s62, 3
s_cbranch_scc1 Lste_72
s_cmp_eq_u32 s62, 2
s_cbranch_scc1 Lst2_70
s_cmp_ge_u32 s62, 4
s_cbranch_scc1 Lst4_71
s_cmp_eq_u32 s62, 1
s_cbranch_scc1 Lst1_69
s_waitcnt vmcnt(0)
v_readfirstlane_b32 s54, v6
s_cmp_eq_u32 s54, 0
s_cbranch_scc0 Lrep_73
buffer_load_dword v6, v4, s[56:59], 0 offen sc1
s_branch Lste_72
Lrep_73:
s_add_u32 s7, s34, 64
s_lshl_b32 s7, s7, 7
v_mov_b32 v5, s7
v_mov_b32 v6, 1
s_mov_b64 exec, 1
buffer_atomic_add v6, v5, s[84:87], 0 offen sc1
s_mov_b64 exec, -1
s_mov_b32 s62, 1
s_mov_b32 s54, 0
s_mov_b32 s55, 0
s_branch Lste_72
Lst1_69:
s_and_b32 s43, s54, s55
s_cmp_eq_u32 s43, 16
s_branch Lov_4
.p2align 12
.fill 32, 4, 0xbf800000
Lst_4_0:
s_branch Lwr_171
s_nop 0
s_nop 0
Lov_4:
s_cbranch_scc1 Lg_74
s_load_dword s54, s[82:83], s52 glc
s_load_dword s55, s[82:83], s53 glc
s_branch Lste_72
Lg_74:
v_add_u32 v5, 0, v1
v_min_u32 v5, 143, v5
v_lshlrev_b32 v20, 3, v5
v_add_u32 v5, s50, v5
v_max_i32 v5, 0, v5
v_lshlrev_b32 v5, 3, v5
buffer_load_dwordx2 v[32:33], v5, s[20:23], 0 offen sc1
v_add_u32 v5, 64, v1
v_min_u32 v5, 143, v5
v_lshlrev_b32 v21, 3, v5
v_add_u32 v5, s50, v5
v_max_i32 v5, 0, v5
v_lshlrev_b32 v5, 3, v5
buffer_load_dwordx2 v[34:35], v5, s[20:23], 0 offen sc1
v_add_u32 v5, 128, v1
v_min_u32 v5, 143, v5
v_lshlrev_b32 v22, 3, v5
v_add_u32 v5, s50, v5
v_max_i32 v5, 0, v5
v_lshlrev_b32 v5, 3, v5
buffer_load_dwordx2 v[36:37], v5, s[20:23], 0 offen sc1
s_mov_b32 s62, 4
s_branch Lste_72
Lst4_71:
s_mov_b32 s62, 2
s_branch Lste_72
Lst2_70:
s_waitcnt vmcnt(0)
v_add_u32 v20, 147456, v20
ds_write_b64 v20, v[32:33]
v_add_u32 v21, 147456, v21
ds_write_b64 v21, v[34:35]
v_add_u32 v22, 147456, v22
ds_write_b64 v22, v[36:37]
s_waitcnt lgkmcnt(0)
s_mov_b32 s62, 3
Lste_72:
s_branch Lst_11_0
Lwr_178:
s_barrier
s_cmp_eq_u32 s62, 3
s_cbranch_scc1 Lste_78
s_cmp_eq_u32 s62, 2
s_cbranch_scc1 Lst2_76
s_cmp_ge_u32 s62, 4
s_cbranch_scc1 Lst4_77
s_cmp_eq_u32 s62, 1
s_cbranch_scc1 Lst1_75
s_waitcnt vmcnt(0)
v_readfirstlane_b32 s54, v6
s_cmp_eq_u32 s54, 0
s_cbranch_scc0 Lrep_79
buffer_load_dword v6, v4, s[56:59], 0 offen sc1
s_branch Lste_78
Lrep_79:
s_add_u32 s7, s34, 64
s_lshl_b32 s7, s7, 7
v_mov_b32 v5, s7
v_mov_b32 v6, 1
s_mov_b64 exec, 1
buffer_atomic_add v6, v5, s[84:87], 0 offen sc1
s_mov_b64 exec, -1
s_mov_b32 s62, 1
s_mov_b32 s54, 0
s_mov_b32 s55, 0
s_branch Lste_78
Lst1_75:
s_and_b32 s43, s54, s55
s_cmp_eq_u32 s43, 16
s_cbranch_scc1 Lg_80
s_load_dword s54, s[82:83], s52 glc
s_load_dword s55, s[82:83], s53 glc
s_branch Lste_78
Lg_80:
v_add_u32 v5, 0, v1
v_min_u32 v5, 143, v5
v_lshlrev_b32 v20, 3, v5
v_add_u32 v5, s50, v5
v_max_i32 v5, 0, v5
v_lshlrev_b32 v5, 3, v5
buffer_load_dwordx2 v[32:33], v5, s[20:23], 0 offen sc1
v_add_u32 v5, 64, v1
v_min_u32 v5, 143, v5
v_lshlrev_b32 v21, 3, v5
v_add_u32 v5, s50, v5
v_max_i32 v5, 0, v5
v_lshlrev_b32 v5, 3, v5
buffer_load_dwordx2 v[34:35], v5, s[20:23], 0 offen sc1
v_add_u32 v5, 128, v1
v_min_u32 v5, 143, v5
v_lshlrev_b32 v22, 3, v5
v_add_u32 v5, s50, v5
v_max_i32 v5, 0, v5
v_lshlrev_b32 v5, 3, v5
buffer_load_dwordx2 v[36:37], v5, s[20:23], 0 offen sc1
s_mov_b32 s62, 4
s_branch Lste_78
Lst4_77:
s_mov_b32 s62, 2
s_branch Lste_78
Lst2_76:
s_waitcnt vmcnt(0)
v_add_u32 v20, 147456, v20
ds_write_b64 v20, v[32:33]
v_add_u32 v21, 147456, v21
ds_write_b64 v21, v[34:35]
v_add_u32 v22, 147456, v22
ds_write_b64 v22, v[36:37]
s_waitcnt lgkmcnt(0)
s_mov_b32 s62, 3
Lste_78:
s_branch Lst_12_0
Lwr_179:
s_barrier
s_cmp_eq_u32 s62, 3
s_cbranch_scc1 Lste_84
s_cmp_eq_u32 s62, 2
s_cbranch_scc1 Lst2_82
s_cmp_ge_u32 s62, 4
s_cbranch_scc1 Lst4_83
s_cmp_eq_u32 s62, 1
s_cbranch_scc1 Lst1_81
s_waitcnt vmcnt(0)
v_readfirstlane_b32 s54, v6
s_cmp_eq_u32 s54, 0
s_cbranch_scc0 Lrep_85
buffer_load_dword v6, v4, s[56:59], 0 offen sc1
s_branch Lste_84
Lrep_85:
s_add_u32 s7, s34, 64
s_lshl_b32 s7, s7, 7
v_mov_b32 v5, s7
v_mov_b32 v6, 1
s_mov_b64 exec, 1
buffer_atomic_add v6, v5, s[84:87], 0 offen sc1
s_mov_b64 exec, -1
s_mov_b32 s62, 1
s_mov_b32 s54, 0
s_mov_b32 s55, 0
s_branch Lste_84
Lst1_81:
s_and_b32 s43, s54, s55
s_cmp_eq_u32 s43, 16
s_cbranch_scc1 Lg_86
s_load_dword s54, s[82:83], s52 glc
s_load_dword s55, s[82:83], s53 glc
s_branch Lste_84
Lg_86:
v_add_u32 v5, 0, v1
v_min_u32 v5, 143, v5
v_lshlrev_b32 v20, 3, v5
v_add_u32 v5, s50, v5
v_max_i32 v5, 0, v5
v_lshlrev_b32 v5, 3, v5
buffer_load_dwordx2 v[32:33], v5, s[20:23], 0 offen sc1
v_add_u32 v5, 64, v1
v_min_u32 v5, 143, v5
v_lshlrev_b32 v21, 3, v5
v_add_u32 v5, s50, v5
v_max_i32 v5, 0, v5
v_lshlrev_b32 v5, 3, v5
buffer_load_dwordx2 v[34:35], v5, s[20:23], 0 offen sc1
v_add_u32 v5, 128, v1
v_min_u32 v5, 143, v5
v_lshlrev_b32 v22, 3, v5
v_add_u32 v5, s50, v5
v_max_i32 v5, 0, v5
v_lshlrev_b32 v5, 3, v5
buffer_load_dwordx2 v[36:37], v5, s[20:23], 0 offen sc1
s_mov_b32 s62, 4
s_branch Lste_84
Lst4_83:
s_mov_b32 s62, 2
s_branch Lste_84
Lst2_82:
s_waitcnt vmcnt(0)
v_add_u32 v20, 147456, v20
ds_write_b64 v20, v[32:33]
v_add_u32 v21, 147456, v21
ds_write_b64 v21, v[34:35]
v_add_u32 v22, 147456, v22
ds_write_b64 v22, v[36:37]
s_waitcnt lgkmcnt(0)
s_mov_b32 s62, 3
Lste_84:
s_branch Lst_13_0
Lwr_180:
s_barrier
s_cmp_eq_u32 s62, 3
s_cbranch_scc1 Lste_90
s_cmp_eq_u32 s62, 2
s_cbranch_scc1 Lst2_88
s_cmp_ge_u32 s62, 4
s_cbranch_scc1 Lst4_89
s_cmp_eq_u32 s62, 1
s_cbranch_scc1 Lst1_87
s_waitcnt vmcnt(0)
v_readfirstlane_b32 s54, v6
s_cmp_eq_u32 s54, 0
s_cbranch_scc0 Lrep_91
buffer_load_dword v6, v4, s[56:59], 0 offen sc1
s_branch Lste_90
Lrep_91:
s_add_u32 s7, s34, 64
s_lshl_b32 s7, s7, 7
v_mov_b32 v5, s7
v_mov_b32 v6, 1
s_mov_b64 exec, 1
buffer_atomic_add v6, v5, s[84:87], 0 offen sc1
s_mov_b64 exec, -1
s_mov_b32 s62, 1
s_mov_b32 s54, 0
s_mov_b32 s55, 0
s_branch Lste_90
Lst1_87:
s_and_b32 s43, s54, s55
s_cmp_eq_u32 s43, 16
s_cbranch_scc1 Lg_92
s_load_dword s54, s[82:83], s52 glc
s_load_dword s55, s[82:83], s53 glc
s_branch Lste_90
Lg_92:
v_add_u32 v5, 0, v1
v_min_u32 v5, 143, v5
v_lshlrev_b32 v20, 3, v5
v_add_u32 v5, s50, v5
v_max_i32 v5, 0, v5
v_lshlrev_b32 v5, 3, v5
buffer_load_dwordx2 v[32:33], v5, s[20:23], 0 offen sc1
v_add_u32 v5, 64, v1
v_min_u32 v5, 143, v5
v_lshlrev_b32 v21, 3, v5
v_add_u32 v5, s50, v5
v_max_i32 v5, 0, v5
v_lshlrev_b32 v5, 3, v5
buffer_load_dwordx2 v[34:35], v5, s[20:23], 0 offen sc1
v_add_u32 v5, 128, v1
v_min_u32 v5, 143, v5
v_lshlrev_b32 v22, 3, v5
v_add_u32 v5, s50, v5
v_max_i32 v5, 0, v5
v_lshlrev_b32 v5, 3, v5
buffer_load_dwordx2 v[36:37], v5, s[20:23], 0 offen sc1
s_mov_b32 s62, 4
s_branch Lste_90
Lst4_89:
s_mov_b32 s62, 2
s_branch Lste_90
Lst2_88:
s_waitcnt vmcnt(0)
v_add_u32 v20, 147456, v20
ds_write_b64 v20, v[32:33]
v_add_u32 v21, 147456, v21
ds_write_b64 v21, v[34:35]
v_add_u32 v22, 147456, v22
ds_write_b64 v22, v[36:37]
s_waitcnt lgkmcnt(0)
s_mov_b32 s62, 3
Lste_90:
s_branch Lst_14_0
Lwr_181:
s_barrier
s_cmp_eq_u32 s62, 3
s_cbranch_scc1 Lste_95
s_cmp_ge_u32 s62, 5
s_cbranch_scc1 Lg_100
s_cmp_ge_u32 s62, 2
s_cbranch_scc1 Lst2_94
s_cmp_eq_u32 s62, 1
s_cbranch_scc1 Lst1_93
s_mov_b32 s41, 0x40000
Lz0_96:
s_waitcnt vmcnt(0)
v_readfirstlane_b32 s54, v6
s_cmp_eq_u32 s54, 0
s_cbranch_scc0 Lzok_97
buffer_load_dword v6, v4, s[56:59], 0 offen sc1
s_sub_u32 s41, s41, 1
s_cmp_lg_u32 s41, 0
s_cbranch_scc1 Lz0_96
s_waitcnt lgkmcnt(0)
Lzok_97:
s_add_u32 s7, s34, 64
s_lshl_b32 s7, s7, 7
v_mov_b32 v5, s7
v_mov_b32 v6, 1
s_mov_b64 exec, 1
buffer_atomic_add v6, v5, s[84:87], 0 offen sc1
s_mov_b64 exec, -1
Lst1_93:
s_load_dword s54, s[82:83], s52 glc
s_load_dword s55, s[82:83], s53 glc
s_mov_b32 s41, 200
Lpoll_98:
s_waitcnt lgkmcnt(0)
s_and_b32 s54, s54, s55
s_cmp_eq_u32 s54, 16
s_cbranch_scc1 Lg_100
s_load_dword s54, s[82:83], s52 glc
s_load_dword s55, s[82:83], s53 glc
s_sub_u32 s41, s41, 1
s_cmp_lg_u32 s41, 0
s_cbranch_scc1 Lpoll_98
s_waitcnt lgkmcnt(0)
s_mov_b32 s41, 0
Lfb_99:
s_add_u32 s62, s50, s41
s_max_i32 s62, s62, 0
s_lshl_b32 s43, s62, 11
buffer_load_dwordx4 v[96:99], v10, s[8:11], s43 offen offset:0
buffer_load_dwordx4 v[100:103], v10, s[8:11], s43 offen offset:1024
buffer_load_dwordx4 v[104:107], v10, s[8:11], s43 offen offset:2048
buffer_load_dwordx4 v[108:111], v10, s[8:11], s43 offen offset:3072
s_waitcnt vmcnt(0)
s_mov_b32 s43, 0x3f803f80
v_mov_b32 v116, 0
v_mov_b32 v117, 0
v_mov_b32 v118, 0
v_mov_b32 v119, 0
v_mov_b32 v120, 0
v_mov_b32 v121, 0
v_mov_b32 v122, 0
v_mov_b32 v123, 0
v_dot2_f32_bf16 v116, v96, s43, v116
v_dot2_f32_bf16 v120, v96, v96, v120
v_dot2_f32_bf16 v118, v104, s43, v118
v_dot2_f32_bf16 v122, v104, v104, v122
v_dot2_f32_bf16 v117, v97, s43, v117
v_dot2_f32_bf16 v121, v97, v97, v121
v_dot2_f32_bf16 v119, v105, s43, v119
v_dot2_f32_bf16 v123, v105, v105, v123
v_dot2_f32_bf16 v116, v98, s43, v116
v_dot2_f32_bf16 v120, v98, v98, v120
v_dot2_f32_bf16 v118, v106, s43, v118
v_dot2_f32_bf16 v122, v106, v106, v122
v_dot2_f32_bf16 v117, v99, s43, v117
v_dot2_f32_bf16 v121, v99, v99, v121
v_dot2_f32_bf16 v119, v107, s43, v119
v_dot2_f32_bf16 v123, v107, v107, v123
v_dot2_f32_bf16 v116, v100, s43, v116
v_dot2_f32_bf16 v120, v100, v100, v120
v_dot2_f32_bf16 v118, v108, s43, v118
v_dot2_f32_bf16 v122, v108, v108, v122
v_dot2_f32_bf16 v117, v101, s43, v117
v_dot2_f32_bf16 v121, v101, v101, v121
v_dot2_f32_bf16 v119, v109, s43, v119
v_dot2_f32_bf16 v123, v109, v109, v123
v_dot2_f32_bf16 v116, v102, s43, v116
v_dot2_f32_bf16 v120, v102, v102, v120
v_dot2_f32_bf16 v118, v110, s43, v118
v_dot2_f32_bf16 v122, v110, v110, v122
v_dot2_f32_bf16 v117, v103, s43, v117
v_dot2_f32_bf16 v121, v103, v103, v121
v_dot2_f32_bf16 v119, v111, s43, v119
v_dot2_f32_bf16 v123, v111, v111, v123
s_nop 2
v_add_f32 v116, v116, v117
v_add_f32 v118, v118, v119
v_add_f32 v120, v120, v121
v_add_f32 v122, v122, v123
s_nop 1
v_permlane32_swap_b32 v116, v118
v_permlane32_swap_b32 v120, v122
v_add_f32 v116, v116, v118
v_add_f32 v120, v120, v122
s_nop 1
v_permlane16_swap_b32 v116, v120
v_add_f32 v116, v116, v120
s_nop 1
v_add_f32_dpp v116, v116, v116 row_ror:8 row_mask:0xf bank_mask:0xf
s_nop 1
v_add_f32_dpp v116, v116, v116 row_ror:4 row_mask:0xf bank_mask:0xf
s_nop 1
v_add_f32_dpp v116, v116, v116 row_ror:2 row_mask:0xf bank_mask:0xf
s_nop 1
v_add_f32_dpp v116, v116, v116 row_ror:1 row_mask:0xf bank_mask:0xf
v_mov_b32 v117, v116
s_nop 1
v_permlane16_swap_b32 v116, v117
v_mul_f32 v112, 0x3a800000, v116
v_mul_f32 v113, 0x3a800000, v117
v_fma_f32 v113, -v112, v112, v113
v_max_f32 v113, 0, v113
v_add_f32 v113, 0x3727c5ac, v113
v_rsq_f32 v113, v113
v_lshrrev_b32 v11, 5, v1
s_lshl_b32 s43, s41, 3
s_add_u32 s43, s43, 147456
v_lshl_add_u32 v11, v11, 3, s43
ds_write_b64 v11, v[112:113]
s_add_u32 s41, s41, 2
s_cmp_lt_u32 s41, 144
s_cbranch_scc1 Lfb_99
s_waitcnt lgkmcnt(0)
s_branch Lste_95
Lg_100:
v_add_u32 v5, 0, v1
v_min_u32 v5, 143, v5
v_lshlrev_b32 v20, 3, v5
v_add_u32 v5, s50, v5
v_max_i32 v5, 0, v5
v_lshlrev_b32 v5, 3, v5
buffer_load_dwordx2 v[32:33], v5, s[20:23], 0 offen sc1
v_add_u32 v5, 64, v1
v_min_u32 v5, 143, v5
v_lshlrev_b32 v21, 3, v5
v_add_u32 v5, s50, v5
v_max_i32 v5, 0, v5
v_lshlrev_b32 v5, 3, v5
buffer_load_dwordx2 v[34:35], v5, s[20:23], 0 offen sc1
v_add_u32 v5, 128, v1
v_min_u32 v5, 143, v5
v_lshlrev_b32 v22, 3, v5
v_add_u32 v5, s50, v5
v_max_i32 v5, 0, v5
v_lshlrev_b32 v5, 3, v5
buffer_load_dwordx2 v[36:37], v5, s[20:23], 0 offen sc1
Lst2_94:
s_waitcnt vmcnt(0)
v_add_u32 v20, 147456, v20
ds_write_b64 v20, v[32:33]
v_add_u32 v21, 147456, v21
ds_write_b64 v21, v[34:35]
v_add_u32 v22, 147456, v22
ds_write_b64 v22, v[36:37]
s_waitcnt lgkmcnt(0)
Lste_95:
s_bitcmp0_b32 s2, 0
s_cselect_b32 s88, s72, s74
s_cselect_b32 s89, s73, s75
s_cmp_lt_u32 s2, 192
s_cselect_b32 s90, 7340032, 0
s_mov_b32 s91, 0x20000
s_bfe_u32 s44, s2, 0x30001
s_lshl_b32 s44, s44, 2
s_and_b32 s43, s36, 3
s_add_u32 s44, s44, s43
s_lshl_b32 s44, s44, 5
v_lshrrev_b32 v18, 4, v1
v_add_u32 v18, s44, v18
v_mul_u32_u24 v18, 7168, v18
v_and_b32 v19, 15, v1
v_lshl_add_u32 v18, v19, 4, v18
s_lshr_b32 s43, s2, 4
s_lshl_b32 s43, s43, 8
s_add_u32 s43, s43, 4096
v_add_u32 v18, s43, v18
s_mov_b32 s43, 0
buffer_load_dwordx4 v[128:131], v18, s[88:91], s43 offen
s_mov_b32 s43, 28672
buffer_load_dwordx4 v[132:135], v18, s[88:91], s43 offen
s_mov_b32 s43, 57344
buffer_load_dwordx4 v[136:139], v18, s[88:91], s43 offen
s_mov_b32 s43, 86016
buffer_load_dwordx4 v[140:143], v18, s[88:91], s43 offen
s_mov_b32 s43, 114688
buffer_load_dwordx4 v[144:147], v18, s[88:91], s43 offen
s_mov_b32 s43, 143360
buffer_load_dwordx4 v[148:151], v18, s[88:91], s43 offen
s_mov_b32 s43, 172032
buffer_load_dwordx4 v[152:155], v18, s[88:91], s43 offen
s_mov_b32 s43, 200704
buffer_load_dwordx4 v[156:159], v18, s[88:91], s43 offen
s_barrier
s_lshl_b32 s43, s35, 7
s_add_u32 s28, s68, s43
s_addc_u32 s29, s69, 0
s_mov_b32 s30, 2095232
s_mov_b32 s31, 0x20000
v_lshrrev_b32 v15, 3, v1
v_and_b32 v16, 6, v15
v_and_b32 v7, 7, v1
v_xor_b32 v7, v7, v16
v_lshlrev_b32 v7, 4, v7
v_mul_u32_u24 v15, 2048, v15
v_add_u32 v7, v7, v15
s_and_b32 s40, s36, 3
s_lshl_b32 s39, s40, 13
s_add_u32 s40, s40, s35
s_add_u32 s42, s40, 0
s_and_b32 s42, s42, 15
s_lshl_b32 s42, s42, 17
s_add_u32 m0, s39, 65536
s_add_u32 s43, s42, 0
buffer_load_dwordx4 v7, s[28:31], s43 offen lds
s_add_u32 m0, s39, 66560
s_add_u32 s43, s42, 16384
buffer_load_dwordx4 v7, s[28:31], s43 offen lds
s_add_u32 m0, s39, 67584
s_add_u32 s43, s42, 32768
buffer_load_dwordx4 v7, s[28:31], s43 offen lds
s_add_u32 m0, s39, 68608
s_add_u32 s43, s42, 49152
buffer_load_dwordx4 v7, s[28:31], s43 offen lds
s_add_u32 m0, s39, 69632
s_add_u32 s43, s42, 65536
buffer_load_dwordx4 v7, s[28:31], s43 offen lds
s_add_u32 m0, s39, 70656
s_add_u32 s43, s42, 81920
buffer_load_dwordx4 v7, s[28:31], s43 offen lds
s_add_u32 m0, s39, 71680
s_add_u32 s43, s42, 98304
buffer_load_dwordx4 v7, s[28:31], s43 offen lds
s_add_u32 m0, s39, 72704
s_add_u32 s43, s42, 114688
buffer_load_dwordx4 v7, s[28:31], s43 offen lds
Lats_6:
s_and_b32 s43, s36, 1
s_bfe_u32 s44, s36, 0x10001
s_lshr_b32 s45, s36, 2
v_lshlrev_b32 v14, 2, v13
v_sub_u32 v14, v12, v14
v_mov_b32 v16, 0xff800000
s_or_b32 s46, s34, s45
s_cmp_lg_u32 s46, 0
s_cselect_b32 s46, 0, 0xff800000
v_subrev_u32 v15, 0, v14
v_cmp_ge_u32 vcc, 7, v15
v_add_u32 v15, 16, v15
s_nop 0
v_cndmask_b32 v248, v16, 0, vcc
v_cmp_ge_u32 vcc, 7, v15
s_nop 1
v_cndmask_b32 v244, v16, 0, vcc
v_or_b32 v240, s46, v244
v_subrev_u32 v15, 1, v14
v_cmp_ge_u32 vcc, 7, v15
v_add_u32 v15, 16, v15
s_nop 0
v_cndmask_b32 v249, v16, 0, vcc
v_cmp_ge_u32 vcc, 7, v15
s_nop 1
v_cndmask_b32 v245, v16, 0, vcc
v_or_b32 v241, s46, v245
v_subrev_u32 v15, 2, v14
v_cmp_ge_u32 vcc, 7, v15
v_add_u32 v15, 16, v15
s_nop 0
v_cndmask_b32 v250, v16, 0, vcc
v_cmp_ge_u32 vcc, 7, v15
s_nop 1
v_cndmask_b32 v246, v16, 0, vcc
v_or_b32 v242, s46, v246
v_subrev_u32 v15, 3, v14
v_cmp_ge_u32 vcc, 7, v15
v_add_u32 v15, 16, v15
s_nop 0
v_cndmask_b32 v251, v16, 0, vcc
v_cmp_ge_u32 vcc, 7, v15
s_nop 1
v_cndmask_b32 v247, v16, 0, vcc
v_or_b32 v243, s46, v247
s_lshl_b32 s46, s45, 6
s_add_u32 s46, s46, s44
s_add_u32 s46, s46, 16
v_lshl_add_u32 v14, v12, 1, s46
s_lshl_b32 s47, s43, 6
v_lshl_add_u32 v15, v13, 4, s47
v_mul_u32_u24 v20, 400, v14
v_add_u32 v20, v20, v15
v_subrev_u32 v16, 32, v14
v_max_i32 v16, 0, v16
v_mul_u32_u24 v21, 400, v16
v_add_u32 v21, v21, v15
v_lshrrev_b32 v16, 2, v12
v_lshl_add_u32 v16, v13, 2, v16
v_lshl_add_u32 v16, v16, 1, s46
v_and_b32 v17, 3, v1
v_lshl_add_u32 v17, v17, 3, s47
v_mul_u32_u24 v22, 400, v16
v_add_u32 v22, v22, v17
v_subrev_u32 v16, 32, v16
v_max_i32 v16, 0, v16
v_mul_u32_u24 v23, 400, v16
v_add_u32 v23, v23, v17
s_mul_i32 s60, s34, 262144
s_add_u32 s16, s82, s60
s_addc_u32 s17, s83, 0
s_mov_b32 s18, 262144
s_mov_b32 s19, 0x20000
s_lshl_b32 s60, s35, 14
s_lshl_b32 s43, s43, 13
s_add_u32 s60, s60, s43
s_lshl_b32 s43, s45, 12
s_add_u32 s60, s60, s43
s_lshl_b32 s43, s44, 10
s_add_u32 s60, s60, s43
v_lshlrev_b32 v24, 4, v1
s_mov_b32 s61, 0x3e8293ee
s_lshl_b32 s38, s35, 7
Latt_5:
s_barrier
ds_read_b128 v[32:35], v20 offset:0
ds_read_b128 v[36:39], v20 offset:128
ds_read_b128 v[40:43], v21 offset:128
ds_read_b128 v[80:83], v20 offset:12800
ds_read_b128 v[84:87], v20 offset:12928
ds_read_b128 v[88:91], v20 offset:128
ds_read_b64_tr_b16 v[44:45], v23 offset:256
ds_read_b64_tr_b16 v[46:47], v22 offset:256
ds_read_b64_tr_b16 v[48:49], v23 offset:288
ds_read_b64_tr_b16 v[50:51], v22 offset:288
ds_read_b64_tr_b16 v[92:93], v22 offset:256
ds_read_b64_tr_b16 v[94:95], v22 offset:13056
ds_read_b64_tr_b16 v[96:97], v22 offset:288
ds_read_b64_tr_b16 v[98:99], v22 offset:13088
s_waitcnt lgkmcnt(11)
v_mfma_f32_16x16x32_bf16 v[52:55], v[40:43], v[32:35], v[240:243]
v_mfma_f32_16x16x32_bf16 v[56:59], v[36:39], v[32:35], v[248:251]
s_waitcnt lgkmcnt(8)
v_mfma_f32_16x16x32_bf16 v[100:103], v[88:91], v[80:83], v[244:247]
v_mfma_f32_16x16x32_bf16 v[104:107], v[84:87], v[80:83], v[248:251]
s_nop 4
v_max3_f32 v60, v52, v53, v54
v_max3_f32 v108, v100, v101, v102
v_max3_f32 v61, v55, v56, v57
v_max3_f32 v109, v103, v104, v105
v_max3_f32 v60, v60, v58, v59
v_max3_f32 v108, v108, v106, v107
v_max_f32 v60, v60, v61
v_max_f32 v108, v108, v109
s_nop 0
v_permlane32_swap_b32 v60, v108
v_max_f32 v60, v60, v108
v_mov_b32 v61, v60
s_nop 1
v_permlane16_swap_b32 v60, v61
v_max_f32 v60, v60, v61
v_mul_f32 v60, s61, v60
s_nop 0
v_mov_b32 v108, v60
s_nop 1
v_permlane32_swap_b32 v60, v108
v_fma_f32 v52, v52, s61, -v60
v_fma_f32 v100, v100, s61, -v108
v_fma_f32 v53, v53, s61, -v60
v_fma_f32 v101, v101, s61, -v108
v_fma_f32 v54, v54, s61, -v60
v_fma_f32 v102, v102, s61, -v108
v_fma_f32 v55, v55, s61, -v60
v_fma_f32 v103, v103, s61, -v108
v_fma_f32 v56, v56, s61, -v60
v_fma_f32 v104, v104, s61, -v108
v_fma_f32 v57, v57, s61, -v60
v_fma_f32 v105, v105, s61, -v108
v_fma_f32 v58, v58, s61, -v60
v_fma_f32 v106, v106, s61, -v108
v_fma_f32 v59, v59, s61, -v60
v_fma_f32 v107, v107, s61, -v108
v_exp_f32 v52, v52
v_exp_f32 v100, v100
v_exp_f32 v53, v53
v_exp_f32 v101, v101
v_exp_f32 v54, v54
v_exp_f32 v102, v102
v_exp_f32 v55, v55
v_exp_f32 v103, v103
v_exp_f32 v56, v56
v_exp_f32 v104, v104
v_exp_f32 v57, v57
v_exp_f32 v105, v105
v_exp_f32 v58, v58
v_exp_f32 v106, v106
v_exp_f32 v59, v59
v_exp_f32 v107, v107
v_cvt_pk_bf16_f32 v64, v52, v53
v_cvt_pk_bf16_f32 v112, v100, v101
v_cvt_pk_bf16_f32 v65, v54, v55
v_cvt_pk_bf16_f32 v113, v102, v103
v_cvt_pk_bf16_f32 v66, v56, v57
v_cvt_pk_bf16_f32 v114, v104, v105
v_cvt_pk_bf16_f32 v67, v58, v59
v_cvt_pk_bf16_f32 v115, v106, v107
v_pk_add_f32 v[52:53], v[52:53], v[54:55]
v_pk_add_f32 v[100:101], v[100:101], v[102:103]
v_pk_add_f32 v[56:57], v[56:57], v[58:59]
v_pk_add_f32 v[104:105], v[104:105], v[106:107]
s_waitcnt lgkmcnt(0)
s_waitcnt lgkmcnt(0)
v_mfma_f32_16x16x32_bf16 v[68:71], v[44:47], v[64:67], 0
v_mfma_f32_16x16x32_bf16 v[116:119], v[92:95], v[112:115], 0
v_mfma_f32_16x16x32_bf16 v[72:75], v[48:51], v[64:67], 0
v_mfma_f32_16x16x32_bf16 v[120:123], v[96:99], v[112:115], 0
v_pk_add_f32 v[52:53], v[52:53], v[56:57]
v_pk_add_f32 v[100:101], v[100:101], v[104:105]
v_add_f32 v60, v52, v53
v_add_f32 v108, v100, v101
s_nop 0
v_permlane32_swap_b32 v60, v108
v_add_f32 v60, v60, v108
v_mov_b32 v61, v60
s_nop 1
v_permlane16_swap_b32 v60, v61
v_add_f32 v60, v60, v61
v_rcp_f32 v60, v60
s_nop 0
v_mov_b32 v108, v60
s_nop 1
v_permlane32_swap_b32 v60, v108
v_pk_mul_f32 v[68:69], v[60:61], v[68:69] op_sel_hi:[0,1]
v_pk_mul_f32 v[116:117], v[108:109], v[116:117] op_sel_hi:[0,1]
v_pk_mul_f32 v[70:71], v[60:61], v[70:71] op_sel_hi:[0,1]
v_pk_mul_f32 v[118:119], v[108:109], v[118:119] op_sel_hi:[0,1]
v_pk_mul_f32 v[72:73], v[60:61], v[72:73] op_sel_hi:[0,1]
v_pk_mul_f32 v[120:121], v[108:109], v[120:121] op_sel_hi:[0,1]
v_pk_mul_f32 v[74:75], v[60:61], v[74:75] op_sel_hi:[0,1]
v_pk_mul_f32 v[122:123], v[108:109], v[122:123] op_sel_hi:[0,1]
v_cvt_pk_bf16_f32 v64, v68, v69
v_cvt_pk_bf16_f32 v112, v116, v117
v_cvt_pk_bf16_f32 v65, v70, v71
v_cvt_pk_bf16_f32 v113, v118, v119
v_cvt_pk_bf16_f32 v66, v72, v73
v_cvt_pk_bf16_f32 v114, v120, v121
v_cvt_pk_bf16_f32 v67, v74, v75
v_cvt_pk_bf16_f32 v115, v122, v123
buffer_store_dwordx4 v[64:67], v24, s[16:19], s60 offen offset:0 sc1
buffer_store_dwordx4 v[112:115], v24, s[16:19], s60 offen offset:2048 sc1
s_add_u32 s56, s82, 28311552
s_addc_u32 s57, s83, 0
s_mov_b32 s58, 114688
s_mov_b32 s59, 0x20000
s_lshl_b32 s7, s34, 12
s_add_u32 s7, s7, 49152
v_lshl_add_u32 v26, v1, 8, s7
v_mov_b32 v27, 1
s_cmp_ge_u32 s36, 4
s_cbranch_scc1 Lh_102
s_waitcnt vmcnt(0)
s_branch Lo_101
Lh_102:
s_waitcnt vmcnt(0)
Lo_101:
s_branch Lov_5
.p2align 12
.fill 32, 4, 0xbf800000
Lst_5_0:
s_branch Lwr_172
s_nop 0
s_nop 0
Lov_5:
s_cmp_lg_u32 s36, 0
s_barrier
s_cbranch_scc1 Lsig_103
s_mov_b64 exec, 0xffff
buffer_atomic_add v27, v26, s[56:59], 0 offen sc1
s_mov_b64 exec, -1
Lsig_103:
s_cmp_ge_u32 s36, 4
s_cbranch_scc1 Lprod_105
v_and_b32 v12, 15, v1
v_lshrrev_b32 v13, 4, v1
v_lshlrev_b32 v10, 12, v12
v_and_b32 v14, 1, v13
v_lshl_add_u32 v10, v14, 5, v10
v_lshrrev_b32 v14, 1, v13
v_lshl_add_u32 v10, v14, 4, v10
s_lshl_b32 s43, s34, 18
s_lshl_b32 s44, s36, 16
s_add_u32 s43, s43, s44
s_lshl_b32 s44, s35, 7
s_add_u32 s43, s43, s44
buffer_load_dwordx4 v[128:131], v10, s[8:11], s43 offen offset:0
buffer_load_dwordx4 v[132:135], v10, s[8:11], s43 offen offset:64
buffer_load_dwordx4 v[136:139], v10, s[8:11], s43 offen offset:2048
buffer_load_dwordx4 v[140:143], v10, s[8:11], s43 offen offset:2112
v_and_b32 v12, 15, v1
v_lshrrev_b32 v13, 4, v1
s_mul_i32 s43, s34, 262144
s_add_u32 s20, s82, s43
s_addc_u32 s21, s83, 0
s_add_u32 s20, s20, 4194304
s_addc_u32 s21, s21, 0
s_mov_b32 s22, 262144
s_mov_b32 s23, 0x20000
s_mul_i32 s43, s34, 16384
s_add_u32 s24, s82, s43
s_addc_u32 s25, s83, 0
s_add_u32 s24, s24, 25165824
s_addc_u32 s25, s25, 0
s_mov_b32 s26, 16384
s_mov_b32 s27, 0x20000
v_lshlrev_b32 v11, 4, v1
s_lshl_b32 s43, s36, 11
v_add_u32 v2, s43, v11
v_add_u32 v3, 98304, v2
v_lshrrev_b32 v14, 2, v1
v_bfe_u32 v15, v14, 1, 2
v_mul_u32_u24 v14, 128, v14
v_lshl_add_u32 v14, v15, 5, v14
v_and_b32 v15, 3, v1
v_lshl_add_u32 v4, v15, 3, v14
v_xor_b32 v5, 32, v4
v_xor_b32 v6, 64, v4
v_xor_b32 v7, 96, v4
v_add_u32 v16, 0x10000, v4
v_add_u32 v20, 0x20000, v4
v_add_u32 v17, 0x10000, v5
v_add_u32 v21, 0x20000, v5
v_add_u32 v18, 0x10000, v6
v_add_u32 v22, 0x20000, v6
v_add_u32 v19, 0x10000, v7
v_add_u32 v23, 0x20000, v7
s_lshl_b32 s44, s35, 14
s_add_u32 s60, s44, s43
v_lshrrev_b32 v14, 1, v13
v_lshlrev_b32 v14, 11, v14
v_lshl_add_u32 v14, v12, 3, v14
v_and_b32 v15, 1, v13
v_lshl_add_u32 v14, v15, 2, v14
s_lshl_b32 s43, s36, 12
s_lshl_b32 s44, s35, 7
s_add_u32 s43, s43, s44
v_add_u32 v9, s43, v14
s_mov_b32 s61, 0x3f803f80
s_waitcnt vmcnt(0)
v_permlane16_swap_b32 v128, v130
v_permlane16_swap_b32 v129, v131
v_permlane16_swap_b32 v132, v134
v_permlane16_swap_b32 v133, v135
v_permlane16_swap_b32 v136, v138
v_permlane16_swap_b32 v137, v139
v_permlane16_swap_b32 v140, v142
v_permlane16_swap_b32 v141, v143
v_lshlrev_b32 v96, 16, v128
v_and_b32 v97, 0xffff0000, v128
v_lshlrev_b32 v98, 16, v129
v_and_b32 v99, 0xffff0000, v129
v_lshlrev_b32 v100, 16, v130
v_and_b32 v101, 0xffff0000, v130
v_lshlrev_b32 v102, 16, v131
v_and_b32 v103, 0xffff0000, v131
v_lshlrev_b32 v104, 16, v132
v_and_b32 v105, 0xffff0000, v132
v_lshlrev_b32 v106, 16, v133
v_and_b32 v107, 0xffff0000, v133
v_lshlrev_b32 v108, 16, v134
v_and_b32 v109, 0xffff0000, v134
v_lshlrev_b32 v110, 16, v135
v_and_b32 v111, 0xffff0000, v135
v_lshlrev_b32 v112, 16, v136
v_and_b32 v113, 0xffff0000, v136
v_lshlrev_b32 v114, 16, v137
v_and_b32 v115, 0xffff0000, v137
v_lshlrev_b32 v116, 16, v138
v_and_b32 v117, 0xffff0000, v138
v_lshlrev_b32 v118, 16, v139
v_and_b32 v119, 0xffff0000, v139
v_lshlrev_b32 v120, 16, v140
v_and_b32 v121, 0xffff0000, v140
v_lshlrev_b32 v122, 16, v141
v_and_b32 v123, 0xffff0000, v141
v_lshlrev_b32 v124, 16, v142
v_and_b32 v125, 0xffff0000, v142
v_lshlrev_b32 v126, 16, v143
v_and_b32 v127, 0xffff0000, v143
s_cmp_lg_u32 s36, 0
s_cbranch_scc1 Lwm_108
s_nop 0
s_branch Lwe_107
Lwm_108:
s_cmp_lg_u32 s36, 1
s_cbranch_scc1 Lwm_109
s_nop 0
s_branch Lwe_107
Lwm_109:
s_cmp_lg_u32 s36, 2
s_cbranch_scc1 Lwm_110
s_nop 0
s_branch Lwe_107
Lwm_110:
s_cmp_lg_u32 s36, 3
s_cbranch_scc1 Lwm_111
s_nop 0
s_branch Lwe_107
Lwm_111:
Lwe_107:
s_barrier
ds_read_b128 v[32:35], v2 offset:0
ds_read_b64_tr_b16 v[40:41], v16 offset:0
ds_read_b64_tr_b16 v[42:43], v16 offset:2048
ds_read_b64_tr_b16 v[44:45], v17 offset:0
ds_read_b64_tr_b16 v[46:47], v17 offset:2048
ds_read_b64_tr_b16 v[48:49], v18 offset:0
ds_read_b64_tr_b16 v[50:51], v18 offset:2048
ds_read_b64_tr_b16 v[52:53], v19 offset:0
ds_read_b64_tr_b16 v[54:55], v19 offset:2048
ds_read_b128 v[36:39], v2 offset:1024
ds_read_b128 v[56:59], v2 offset:8192
ds_read_b64_tr_b16 v[64:65], v16 offset:4096
ds_read_b64_tr_b16 v[66:67], v16 offset:6144
ds_read_b64_tr_b16 v[68:69], v17 offset:4096
ds_read_b64_tr_b16 v[70:71], v17 offset:6144
ds_read_b64_tr_b16 v[72:73], v18 offset:4096
ds_read_b64_tr_b16 v[74:75], v18 offset:6144
ds_read_b64_tr_b16 v[76:77], v19 offset:4096
ds_read_b64_tr_b16 v[78:79], v19 offset:6144
ds_read_b128 v[60:63], v2 offset:9216
s_waitcnt lgkmcnt(0)
s_barrier
v_mfma_f32_16x16x32_bf16 v[96:99], v[40:43], v[32:35], v[96:99]
ds_read_b128 v[144:147], v2 offset:49152
ds_read_b64_tr_b16 v[152:153], v16 offset:8192
v_mfma_f32_16x16x32_bf16 v[100:103], v[44:47], v[32:35], v[100:103]
ds_read_b64_tr_b16 v[154:155], v16 offset:10240
ds_read_b64_tr_b16 v[156:157], v17 offset:8192
v_mfma_f32_16x16x32_bf16 v[104:107], v[48:51], v[32:35], v[104:107]
ds_read_b64_tr_b16 v[158:159], v17 offset:10240
ds_read_b64_tr_b16 v[160:161], v18 offset:8192
v_mfma_f32_16x16x32_bf16 v[108:111], v[52:55], v[32:35], v[108:111]
ds_read_b64_tr_b16 v[162:163], v18 offset:10240
ds_read_b64_tr_b16 v[164:165], v19 offset:8192
v_mfma_f32_16x16x32_bf16 v[124:127], v[52:55], v[36:39], v[124:127]
ds_read_b64_tr_b16 v[166:167], v19 offset:10240
ds_read_b128 v[148:151], v2 offset:50176
v_mfma_f32_16x16x32_bf16 v[120:123], v[48:51], v[36:39], v[120:123]
ds_read_b128 v[168:171], v2 offset:57344
ds_read_b64_tr_b16 v[176:177], v16 offset:12288
v_mfma_f32_16x16x32_bf16 v[116:119], v[44:47], v[36:39], v[116:119]
ds_read_b64_tr_b16 v[178:179], v16 offset:14336
ds_read_b64_tr_b16 v[180:181], v17 offset:12288
v_mfma_f32_16x16x32_bf16 v[112:115], v[40:43], v[36:39], v[112:115]
ds_read_b64_tr_b16 v[182:183], v17 offset:14336
ds_read_b64_tr_b16 v[184:185], v18 offset:12288
v_mfma_f32_16x16x32_bf16 v[96:99], v[64:67], v[56:59], v[96:99]
ds_read_b64_tr_b16 v[186:187], v18 offset:14336
ds_read_b64_tr_b16 v[188:189], v19 offset:12288
v_mfma_f32_16x16x32_bf16 v[100:103], v[68:71], v[56:59], v[100:103]
ds_read_b64_tr_b16 v[190:191], v19 offset:14336
ds_read_b128 v[172:175], v2 offset:58368
v_mfma_f32_16x16x32_bf16 v[104:107], v[72:75], v[56:59], v[104:107]
s_bitcmp0_b32 s36, 1
v_mfma_f32_16x16x32_bf16 v[108:111], v[76:79], v[56:59], v[108:111]
s_cselect_b32 s44, s72, s74
v_mfma_f32_16x16x32_bf16 v[124:127], v[76:79], v[60:63], v[124:127]
s_cselect_b32 s45, s73, s75
v_mfma_f32_16x16x32_bf16 v[120:123], v[72:75], v[60:63], v[120:123]
s_mul_i32 s43, s35, 192
v_mfma_f32_16x16x32_bf16 v[116:119], v[68:71], v[60:63], v[116:119]
s_add_u32 s16, s44, s43
v_mfma_f32_16x16x32_bf16 v[112:115], v[64:67], v[60:63], v[112:115]
s_addc_u32 s17, s45, 0
s_waitcnt lgkmcnt(0)
s_barrier
v_mfma_f32_16x16x32_bf16 v[96:99], v[152:155], v[144:147], v[96:99]
ds_read_b128 v[32:35], v3 offset:0
ds_read_b64_tr_b16 v[40:41], v16 offset:16384
v_mfma_f32_16x16x32_bf16 v[100:103], v[156:159], v[144:147], v[100:103]
ds_read_b64_tr_b16 v[42:43], v16 offset:18432
ds_read_b64_tr_b16 v[44:45], v17 offset:16384
v_mfma_f32_16x16x32_bf16 v[104:107], v[160:163], v[144:147], v[104:107]
ds_read_b64_tr_b16 v[46:47], v17 offset:18432
ds_read_b64_tr_b16 v[48:49], v18 offset:16384
v_mfma_f32_16x16x32_bf16 v[108:111], v[164:167], v[144:147], v[108:111]
ds_read_b64_tr_b16 v[50:51], v18 offset:18432
ds_read_b64_tr_b16 v[52:53], v19 offset:16384
v_mfma_f32_16x16x32_bf16 v[124:127], v[164:167], v[148:151], v[124:127]
ds_read_b64_tr_b16 v[54:55], v19 offset:18432
ds_read_b128 v[36:39], v3 offset:1024
v_mfma_f32_16x16x32_bf16 v[120:123], v[160:163], v[148:151], v[120:123]
ds_read_b128 v[56:59], v3 offset:8192
ds_read_b64_tr_b16 v[64:65], v16 offset:20480
v_mfma_f32_16x16x32_bf16 v[116:119], v[156:159], v[148:151], v[116:119]
ds_read_b64_tr_b16 v[66:67], v16 offset:22528
ds_read_b64_tr_b16 v[68:69], v17 offset:20480
v_mfma_f32_16x16x32_bf16 v[112:115], v[152:155], v[148:151], v[112:115]
ds_read_b64_tr_b16 v[70:71], v17 offset:22528
ds_read_b64_tr_b16 v[72:73], v18 offset:20480
v_mfma_f32_16x16x32_bf16 v[96:99], v[176:179], v[168:171], v[96:99]
ds_read_b64_tr_b16 v[74:75], v18 offset:22528
ds_read_b64_tr_b16 v[76:77], v19 offset:20480
v_mfma_f32_16x16x32_bf16 v[100:103], v[180:183], v[168:171], v[100:103]
ds_read_b64_tr_b16 v[78:79], v19 offset:22528
ds_read_b128 v[60:63], v3 offset:9216
v_mfma_f32_16x16x32_bf16 v[104:107], v[184:187], v[168:171], v[104:107]
s_add_u32 s16, s16, 4096
v_mfma_f32_16x16x32_bf16 v[108:111], v[188:191], v[168:171], v[108:111]
s_addc_u32 s17, s17, 0
v_mfma_f32_16x16x32_bf16 v[124:127], v[188:191], v[172:175], v[124:127]
s_mov_b32 s18, 7333056
v_mfma_f32_16x16x32_bf16 v[120:123], v[184:187], v[172:175], v[120:123]
s_mov_b32 s19, 0x20000
v_mfma_f32_16x16x32_bf16 v[116:119], v[180:183], v[172:175], v[116:119]
v_add_u32 v196, 0, v1
v_mfma_f32_16x16x32_bf16 v[112:115], v[176:179], v[172:175], v[112:115]
v_mul_u32_u24 v197, 5462, v196
s_waitcnt lgkmcnt(0)
s_barrier
v_mfma_f32_16x16x32_bf16 v[96:99], v[40:43], v[32:35], v[96:99]
ds_read_b128 v[144:147], v3 offset:49152
ds_read_b64_tr_b16 v[152:153], v16 offset:24576
v_mfma_f32_16x16x32_bf16 v[100:103], v[44:47], v[32:35], v[100:103]
ds_read_b64_tr_b16 v[154:155], v16 offset:26624
ds_read_b64_tr_b16 v[156:157], v17 offset:24576
v_mfma_f32_16x16x32_bf16 v[104:107], v[48:51], v[32:35], v[104:107]
ds_read_b64_tr_b16 v[158:159], v17 offset:26624
ds_read_b64_tr_b16 v[160:161], v18 offset:24576
v_mfma_f32_16x16x32_bf16 v[108:111], v[52:55], v[32:35], v[108:111]
ds_read_b64_tr_b16 v[162:163], v18 offset:26624
ds_read_b64_tr_b16 v[164:165], v19 offset:24576
v_mfma_f32_16x16x32_bf16 v[124:127], v[52:55], v[36:39], v[124:127]
ds_read_b64_tr_b16 v[166:167], v19 offset:26624
ds_read_b128 v[148:151], v3 offset:50176
v_mfma_f32_16x16x32_bf16 v[120:123], v[48:51], v[36:39], v[120:123]
ds_read_b128 v[168:171], v3 offset:57344
ds_read_b64_tr_b16 v[176:177], v16 offset:28672
v_mfma_f32_16x16x32_bf16 v[116:119], v[44:47], v[36:39], v[116:119]
ds_read_b64_tr_b16 v[178:179], v16 offset:30720
ds_read_b64_tr_b16 v[180:181], v17 offset:28672
v_mfma_f32_16x16x32_bf16 v[112:115], v[40:43], v[36:39], v[112:115]
ds_read_b64_tr_b16 v[182:183], v17 offset:30720
ds_read_b64_tr_b16 v[184:185], v18 offset:28672
v_mfma_f32_16x16x32_bf16 v[96:99], v[64:67], v[56:59], v[96:99]
ds_read_b64_tr_b16 v[186:187], v18 offset:30720
ds_read_b64_tr_b16 v[188:189], v19 offset:28672
v_mfma_f32_16x16x32_bf16 v[100:103], v[68:71], v[56:59], v[100:103]
ds_read_b64_tr_b16 v[190:191], v19 offset:30720
ds_read_b128 v[172:175], v3 offset:58368
v_mfma_f32_16x16x32_bf16 v[104:107], v[72:75], v[56:59], v[104:107]
v_lshrrev_b32 v197, 16, v197
v_mfma_f32_16x16x32_bf16 v[108:111], v[76:79], v[56:59], v[108:111]
v_mul_u32_u24 v198, 12, v197
v_mfma_f32_16x16x32_bf16 v[124:127], v[76:79], v[60:63], v[124:127]
v_sub_u32 v198, v196, v198
v_mfma_f32_16x16x32_bf16 v[120:123], v[72:75], v[60:63], v[120:123]
v_bfe_u32 v199, v197, 2, 1
v_mfma_f32_16x16x32_bf16 v[116:119], v[68:71], v[60:63], v[116:119]
v_cmp_gt_u32 vcc, 8, v198
v_mfma_f32_16x16x32_bf16 v[112:115], v[64:67], v[60:63], v[112:115]
v_lshlrev_b32 v200, 1, v199
s_waitcnt lgkmcnt(0)
s_barrier
v_mfma_f32_16x16x32_bf16 v[96:99], v[152:155], v[144:147], v[96:99]
ds_read_b128 v[32:35], v2 offset:0
ds_read_b64_tr_b16 v[40:41], v16 offset:49152
v_mfma_f32_16x16x32_bf16 v[100:103], v[156:159], v[144:147], v[100:103]
ds_read_b64_tr_b16 v[42:43], v16 offset:51200
ds_read_b64_tr_b16 v[44:45], v17 offset:49152
v_mfma_f32_16x16x32_bf16 v[104:107], v[160:163], v[144:147], v[104:107]
ds_read_b64_tr_b16 v[46:47], v17 offset:51200
ds_read_b64_tr_b16 v[48:49], v18 offset:49152
v_mfma_f32_16x16x32_bf16 v[108:111], v[164:167], v[144:147], v[108:111]
ds_read_b64_tr_b16 v[50:51], v18 offset:51200
ds_read_b64_tr_b16 v[52:53], v19 offset:49152
v_mfma_f32_16x16x32_bf16 v[124:127], v[164:167], v[148:151], v[124:127]
ds_read_b64_tr_b16 v[54:55], v19 offset:51200
ds_read_b128 v[36:39], v2 offset:1024
v_mfma_f32_16x16x32_bf16 v[120:123], v[160:163], v[148:151], v[120:123]
ds_read_b128 v[56:59], v2 offset:8192
ds_read_b64_tr_b16 v[64:65], v16 offset:53248
v_mfma_f32_16x16x32_bf16 v[116:119], v[156:159], v[148:151], v[116:119]
ds_read_b64_tr_b16 v[66:67], v16 offset:55296
ds_read_b64_tr_b16 v[68:69], v17 offset:53248
v_mfma_f32_16x16x32_bf16 v[112:115], v[152:155], v[148:151], v[112:115]
ds_read_b64_tr_b16 v[70:71], v17 offset:55296
ds_read_b64_tr_b16 v[72:73], v18 offset:53248
v_mfma_f32_16x16x32_bf16 v[96:99], v[176:179], v[168:171], v[96:99]
ds_read_b64_tr_b16 v[74:75], v18 offset:55296
ds_read_b64_tr_b16 v[76:77], v19 offset:53248
v_mfma_f32_16x16x32_bf16 v[100:103], v[180:183], v[168:171], v[100:103]
ds_read_b64_tr_b16 v[78:79], v19 offset:55296
ds_read_b128 v[60:63], v2 offset:9216
v_mfma_f32_16x16x32_bf16 v[104:107], v[184:187], v[168:171], v[104:107]
v_mul_u32_u24 v197, 7168, v197
v_mfma_f32_16x16x32_bf16 v[108:111], v[188:191], v[168:171], v[108:111]
v_cndmask_b32 v199, v199, v200, vcc
v_mfma_f32_16x16x32_bf16 v[124:127], v[188:191], v[172:175], v[124:127]
v_xor_b32 v198, v198, v199
v_mfma_f32_16x16x32_bf16 v[120:123], v[184:187], v[172:175], v[120:123]
v_lshl_add_u32 v192, v198, 4, v197
v_mfma_f32_16x16x32_bf16 v[116:119], v[180:183], v[172:175], v[116:119]
v_add_u32 v196, 64, v1
v_mfma_f32_16x16x32_bf16 v[112:115], v[176:179], v[172:175], v[112:115]
v_mul_u32_u24 v197, 5462, v196
s_waitcnt lgkmcnt(0)
s_barrier
v_mfma_f32_16x16x32_bf16 v[96:99], v[40:43], v[32:35], v[96:99]
ds_read_b128 v[144:147], v2 offset:49152
ds_read_b64_tr_b16 v[152:153], v16 offset:57344
v_mfma_f32_16x16x32_bf16 v[100:103], v[44:47], v[32:35], v[100:103]
ds_read_b64_tr_b16 v[154:155], v16 offset:59392
ds_read_b64_tr_b16 v[156:157], v17 offset:57344
v_mfma_f32_16x16x32_bf16 v[104:107], v[48:51], v[32:35], v[104:107]
ds_read_b64_tr_b16 v[158:159], v17 offset:59392
ds_read_b64_tr_b16 v[160:161], v18 offset:57344
v_mfma_f32_16x16x32_bf16 v[108:111], v[52:55], v[32:35], v[108:111]
ds_read_b64_tr_b16 v[162:163], v18 offset:59392
ds_read_b64_tr_b16 v[164:165], v19 offset:57344
v_mfma_f32_16x16x32_bf16 v[124:127], v[52:55], v[36:39], v[124:127]
ds_read_b64_tr_b16 v[166:167], v19 offset:59392
ds_read_b128 v[148:151], v2 offset:50176
v_mfma_f32_16x16x32_bf16 v[120:123], v[48:51], v[36:39], v[120:123]
ds_read_b128 v[168:171], v2 offset:57344
ds_read_b64_tr_b16 v[176:177], v16 offset:61440
v_mfma_f32_16x16x32_bf16 v[116:119], v[44:47], v[36:39], v[116:119]
ds_read_b64_tr_b16 v[178:179], v16 offset:63488
ds_read_b64_tr_b16 v[180:181], v17 offset:61440
v_mfma_f32_16x16x32_bf16 v[112:115], v[40:43], v[36:39], v[112:115]
ds_read_b64_tr_b16 v[182:183], v17 offset:63488
ds_read_b64_tr_b16 v[184:185], v18 offset:61440
v_mfma_f32_16x16x32_bf16 v[96:99], v[64:67], v[56:59], v[96:99]
ds_read_b64_tr_b16 v[186:187], v18 offset:63488
ds_read_b64_tr_b16 v[188:189], v19 offset:61440
v_mfma_f32_16x16x32_bf16 v[100:103], v[68:71], v[56:59], v[100:103]
ds_read_b64_tr_b16 v[190:191], v19 offset:63488
ds_read_b128 v[172:175], v2 offset:58368
v_mfma_f32_16x16x32_bf16 v[104:107], v[72:75], v[56:59], v[104:107]
v_lshrrev_b32 v197, 16, v197
v_mfma_f32_16x16x32_bf16 v[108:111], v[76:79], v[56:59], v[108:111]
v_mul_u32_u24 v198, 12, v197
v_mfma_f32_16x16x32_bf16 v[124:127], v[76:79], v[60:63], v[124:127]
v_sub_u32 v198, v196, v198
v_mfma_f32_16x16x32_bf16 v[120:123], v[72:75], v[60:63], v[120:123]
v_bfe_u32 v199, v197, 2, 1
v_mfma_f32_16x16x32_bf16 v[116:119], v[68:71], v[60:63], v[116:119]
v_cmp_gt_u32 vcc, 8, v198
v_mfma_f32_16x16x32_bf16 v[112:115], v[64:67], v[60:63], v[112:115]
v_lshlrev_b32 v200, 1, v199
s_waitcnt lgkmcnt(0)
s_barrier
v_mfma_f32_16x16x32_bf16 v[96:99], v[152:155], v[144:147], v[96:99]
ds_read_b128 v[32:35], v3 offset:0
ds_read_b64_tr_b16 v[40:41], v20 offset:0
v_mfma_f32_16x16x32_bf16 v[100:103], v[156:159], v[144:147], v[100:103]
ds_read_b64_tr_b16 v[42:43], v20 offset:2048
ds_read_b64_tr_b16 v[44:45], v21 offset:0
v_mfma_f32_16x16x32_bf16 v[104:107], v[160:163], v[144:147], v[104:107]
ds_read_b64_tr_b16 v[46:47], v21 offset:2048
ds_read_b64_tr_b16 v[48:49], v22 offset:0
v_mfma_f32_16x16x32_bf16 v[108:111], v[164:167], v[144:147], v[108:111]
ds_read_b64_tr_b16 v[50:51], v22 offset:2048
ds_read_b64_tr_b16 v[52:53], v23 offset:0
v_mfma_f32_16x16x32_bf16 v[124:127], v[164:167], v[148:151], v[124:127]
ds_read_b64_tr_b16 v[54:55], v23 offset:2048
ds_read_b128 v[36:39], v3 offset:1024
v_mfma_f32_16x16x32_bf16 v[120:123], v[160:163], v[148:151], v[120:123]
ds_read_b128 v[56:59], v3 offset:8192
ds_read_b64_tr_b16 v[64:65], v20 offset:4096
v_mfma_f32_16x16x32_bf16 v[116:119], v[156:159], v[148:151], v[116:119]
ds_read_b64_tr_b16 v[66:67], v20 offset:6144
ds_read_b64_tr_b16 v[68:69], v21 offset:4096
v_mfma_f32_16x16x32_bf16 v[112:115], v[152:155], v[148:151], v[112:115]
ds_read_b64_tr_b16 v[70:71], v21 offset:6144
ds_read_b64_tr_b16 v[72:73], v22 offset:4096
v_mfma_f32_16x16x32_bf16 v[96:99], v[176:179], v[168:171], v[96:99]
ds_read_b64_tr_b16 v[74:75], v22 offset:6144
ds_read_b64_tr_b16 v[76:77], v23 offset:4096
v_mfma_f32_16x16x32_bf16 v[100:103], v[180:183], v[168:171], v[100:103]
ds_read_b64_tr_b16 v[78:79], v23 offset:6144
ds_read_b128 v[60:63], v3 offset:9216
v_mfma_f32_16x16x32_bf16 v[104:107], v[184:187], v[168:171], v[104:107]
v_mul_u32_u24 v197, 7168, v197
v_mfma_f32_16x16x32_bf16 v[108:111], v[188:191], v[168:171], v[108:111]
v_cndmask_b32 v199, v199, v200, vcc
v_mfma_f32_16x16x32_bf16 v[124:127], v[188:191], v[172:175], v[124:127]
v_xor_b32 v198, v198, v199
v_mfma_f32_16x16x32_bf16 v[120:123], v[184:187], v[172:175], v[120:123]
v_lshl_add_u32 v193, v198, 4, v197
v_mfma_f32_16x16x32_bf16 v[116:119], v[180:183], v[172:175], v[116:119]
v_add_u32 v196, 128, v1
v_mfma_f32_16x16x32_bf16 v[112:115], v[176:179], v[172:175], v[112:115]
v_mul_u32_u24 v197, 5462, v196
s_waitcnt lgkmcnt(0)
s_barrier
v_mfma_f32_16x16x32_bf16 v[96:99], v[40:43], v[32:35], v[96:99]
ds_read_b128 v[144:147], v3 offset:49152
ds_read_b64_tr_b16 v[152:153], v20 offset:8192
v_mfma_f32_16x16x32_bf16 v[100:103], v[44:47], v[32:35], v[100:103]
ds_read_b64_tr_b16 v[154:155], v20 offset:10240
ds_read_b64_tr_b16 v[156:157], v21 offset:8192
v_mfma_f32_16x16x32_bf16 v[104:107], v[48:51], v[32:35], v[104:107]
ds_read_b64_tr_b16 v[158:159], v21 offset:10240
ds_read_b64_tr_b16 v[160:161], v22 offset:8192
v_mfma_f32_16x16x32_bf16 v[108:111], v[52:55], v[32:35], v[108:111]
ds_read_b64_tr_b16 v[162:163], v22 offset:10240
ds_read_b64_tr_b16 v[164:165], v23 offset:8192
v_mfma_f32_16x16x32_bf16 v[124:127], v[52:55], v[36:39], v[124:127]
ds_read_b64_tr_b16 v[166:167], v23 offset:10240
ds_read_b128 v[148:151], v3 offset:50176
v_mfma_f32_16x16x32_bf16 v[120:123], v[48:51], v[36:39], v[120:123]
ds_read_b128 v[168:171], v3 offset:57344
ds_read_b64_tr_b16 v[176:177], v20 offset:12288
v_mfma_f32_16x16x32_bf16 v[116:119], v[44:47], v[36:39], v[116:119]
ds_read_b64_tr_b16 v[178:179], v20 offset:14336
ds_read_b64_tr_b16 v[180:181], v21 offset:12288
v_mfma_f32_16x16x32_bf16 v[112:115], v[40:43], v[36:39], v[112:115]
ds_read_b64_tr_b16 v[182:183], v21 offset:14336
ds_read_b64_tr_b16 v[184:185], v22 offset:12288
v_mfma_f32_16x16x32_bf16 v[96:99], v[64:67], v[56:59], v[96:99]
ds_read_b64_tr_b16 v[186:187], v22 offset:14336
ds_read_b64_tr_b16 v[188:189], v23 offset:12288
v_mfma_f32_16x16x32_bf16 v[100:103], v[68:71], v[56:59], v[100:103]
ds_read_b64_tr_b16 v[190:191], v23 offset:14336
ds_read_b128 v[172:175], v3 offset:58368
v_mfma_f32_16x16x32_bf16 v[104:107], v[72:75], v[56:59], v[104:107]
v_lshrrev_b32 v197, 16, v197
v_mfma_f32_16x16x32_bf16 v[108:111], v[76:79], v[56:59], v[108:111]
v_mul_u32_u24 v198, 12, v197
v_mfma_f32_16x16x32_bf16 v[124:127], v[76:79], v[60:63], v[124:127]
v_sub_u32 v198, v196, v198
v_mfma_f32_16x16x32_bf16 v[120:123], v[72:75], v[60:63], v[120:123]
v_bfe_u32 v199, v197, 2, 1
v_mfma_f32_16x16x32_bf16 v[116:119], v[68:71], v[60:63], v[116:119]
v_cmp_gt_u32 vcc, 8, v198
v_mfma_f32_16x16x32_bf16 v[112:115], v[64:67], v[60:63], v[112:115]
v_lshlrev_b32 v200, 1, v199
s_waitcnt lgkmcnt(0)
s_barrier
v_mfma_f32_16x16x32_bf16 v[96:99], v[152:155], v[144:147], v[96:99]
ds_read_b128 v[32:35], v2 offset:0
ds_read_b64_tr_b16 v[40:41], v4 offset:16384
v_mfma_f32_16x16x32_bf16 v[100:103], v[156:159], v[144:147], v[100:103]
ds_read_b64_tr_b16 v[42:43], v4 offset:18432
ds_read_b64_tr_b16 v[44:45], v5 offset:16384
v_mfma_f32_16x16x32_bf16 v[104:107], v[160:163], v[144:147], v[104:107]
ds_read_b64_tr_b16 v[46:47], v5 offset:18432
ds_read_b64_tr_b16 v[48:49], v6 offset:16384
v_mfma_f32_16x16x32_bf16 v[108:111], v[164:167], v[144:147], v[108:111]
ds_read_b64_tr_b16 v[50:51], v6 offset:18432
ds_read_b64_tr_b16 v[52:53], v7 offset:16384
v_mfma_f32_16x16x32_bf16 v[124:127], v[164:167], v[148:151], v[124:127]
ds_read_b64_tr_b16 v[54:55], v7 offset:18432
ds_read_b128 v[36:39], v2 offset:1024
v_mfma_f32_16x16x32_bf16 v[120:123], v[160:163], v[148:151], v[120:123]
ds_read_b128 v[56:59], v2 offset:8192
ds_read_b64_tr_b16 v[64:65], v4 offset:20480
v_mfma_f32_16x16x32_bf16 v[116:119], v[156:159], v[148:151], v[116:119]
ds_read_b64_tr_b16 v[66:67], v4 offset:22528
ds_read_b64_tr_b16 v[68:69], v5 offset:20480
v_mfma_f32_16x16x32_bf16 v[112:115], v[152:155], v[148:151], v[112:115]
ds_read_b64_tr_b16 v[70:71], v5 offset:22528
ds_read_b64_tr_b16 v[72:73], v6 offset:20480
v_mfma_f32_16x16x32_bf16 v[96:99], v[176:179], v[168:171], v[96:99]
ds_read_b64_tr_b16 v[74:75], v6 offset:22528
ds_read_b64_tr_b16 v[76:77], v7 offset:20480
v_mfma_f32_16x16x32_bf16 v[100:103], v[180:183], v[168:171], v[100:103]
ds_read_b64_tr_b16 v[78:79], v7 offset:22528
ds_read_b128 v[60:63], v2 offset:9216
v_mfma_f32_16x16x32_bf16 v[104:107], v[184:187], v[168:171], v[104:107]
v_mul_u32_u24 v197, 7168, v197
v_mfma_f32_16x16x32_bf16 v[108:111], v[188:191], v[168:171], v[108:111]
v_cndmask_b32 v199, v199, v200, vcc
v_mfma_f32_16x16x32_bf16 v[124:127], v[188:191], v[172:175], v[124:127]
v_xor_b32 v198, v198, v199
v_mfma_f32_16x16x32_bf16 v[120:123], v[184:187], v[172:175], v[120:123]
v_lshl_add_u32 v194, v198, 4, v197
v_mfma_f32_16x16x32_bf16 v[116:119], v[180:183], v[172:175], v[116:119]
s_and_b32 s43, s36, 1
v_mfma_f32_16x16x32_bf16 v[112:115], v[176:179], v[172:175], v[112:115]
s_mul_i32 s43, s43, 229376
s_waitcnt lgkmcnt(0)
s_barrier
v_mfma_f32_16x16x32_bf16 v[96:99], v[40:43], v[32:35], v[96:99]
ds_read_b128 v[144:147], v2 offset:49152
ds_read_b64_tr_b16 v[152:153], v4 offset:24576
v_mfma_f32_16x16x32_bf16 v[100:103], v[44:47], v[32:35], v[100:103]
ds_read_b64_tr_b16 v[154:155], v4 offset:26624
ds_read_b64_tr_b16 v[156:157], v5 offset:24576
v_mfma_f32_16x16x32_bf16 v[104:107], v[48:51], v[32:35], v[104:107]
ds_read_b64_tr_b16 v[158:159], v5 offset:26624
ds_read_b64_tr_b16 v[160:161], v6 offset:24576
v_mfma_f32_16x16x32_bf16 v[108:111], v[52:55], v[32:35], v[108:111]
ds_read_b64_tr_b16 v[162:163], v6 offset:26624
ds_read_b64_tr_b16 v[164:165], v7 offset:24576
v_mfma_f32_16x16x32_bf16 v[124:127], v[52:55], v[36:39], v[124:127]
ds_read_b64_tr_b16 v[166:167], v7 offset:26624
ds_read_b128 v[148:151], v2 offset:50176
v_mfma_f32_16x16x32_bf16 v[120:123], v[48:51], v[36:39], v[120:123]
ds_read_b128 v[168:171], v2 offset:57344
ds_read_b64_tr_b16 v[176:177], v4 offset:28672
v_mfma_f32_16x16x32_bf16 v[116:119], v[44:47], v[36:39], v[116:119]
ds_read_b64_tr_b16 v[178:179], v4 offset:30720
ds_read_b64_tr_b16 v[180:181], v5 offset:28672
v_mfma_f32_16x16x32_bf16 v[112:115], v[40:43], v[36:39], v[112:115]
ds_read_b64_tr_b16 v[182:183], v5 offset:30720
ds_read_b64_tr_b16 v[184:185], v6 offset:28672
v_mfma_f32_16x16x32_bf16 v[96:99], v[64:67], v[56:59], v[96:99]
ds_read_b64_tr_b16 v[186:187], v6 offset:30720
ds_read_b64_tr_b16 v[188:189], v7 offset:28672
v_mfma_f32_16x16x32_bf16 v[100:103], v[68:71], v[56:59], v[100:103]
ds_read_b64_tr_b16 v[190:191], v7 offset:30720
ds_read_b128 v[172:175], v2 offset:58368
v_mfma_f32_16x16x32_bf16 v[104:107], v[72:75], v[56:59], v[104:107]
v_add_u32 v192, s43, v192
v_mfma_f32_16x16x32_bf16 v[108:111], v[76:79], v[56:59], v[108:111]
v_add_u32 v193, s43, v193
v_mfma_f32_16x16x32_bf16 v[124:127], v[76:79], v[60:63], v[124:127]
v_add_u32 v194, s43, v194
v_mfma_f32_16x16x32_bf16 v[120:123], v[72:75], v[60:63], v[120:123]
s_and_b32 s43, s36, 3
v_mfma_f32_16x16x32_bf16 v[116:119], v[68:71], v[60:63], v[116:119]
s_mul_i32 s50, s43, 6144
v_mfma_f32_16x16x32_bf16 v[112:115], v[64:67], v[60:63], v[112:115]
s_add_u32 s50, s50, 16384
s_waitcnt lgkmcnt(0)
s_barrier
v_mfma_f32_16x16x32_bf16 v[96:99], v[152:155], v[144:147], v[96:99]
ds_read_b128 v[32:35], v3 offset:0
ds_read_b64_tr_b16 v[40:41], v4 offset:32768
v_mfma_f32_16x16x32_bf16 v[100:103], v[156:159], v[144:147], v[100:103]
ds_read_b64_tr_b16 v[42:43], v4 offset:34816
ds_read_b64_tr_b16 v[44:45], v5 offset:32768
v_mfma_f32_16x16x32_bf16 v[104:107], v[160:163], v[144:147], v[104:107]
ds_read_b64_tr_b16 v[46:47], v5 offset:34816
ds_read_b64_tr_b16 v[48:49], v6 offset:32768
v_mfma_f32_16x16x32_bf16 v[108:111], v[164:167], v[144:147], v[108:111]
ds_read_b64_tr_b16 v[50:51], v6 offset:34816
ds_read_b64_tr_b16 v[52:53], v7 offset:32768
v_mfma_f32_16x16x32_bf16 v[124:127], v[164:167], v[148:151], v[124:127]
s_branch Lov_6
.p2align 12
.fill 48, 4, 0xbf800000
Lst_6_0:
s_branch Lwr_173
s_nop 0
s_nop 0
Lov_6:
ds_read_b64_tr_b16 v[54:55], v7 offset:34816
ds_read_b128 v[36:39], v3 offset:1024
v_mfma_f32_16x16x32_bf16 v[120:123], v[160:163], v[148:151], v[120:123]
ds_read_b128 v[56:59], v3 offset:8192
ds_read_b64_tr_b16 v[64:65], v4 offset:36864
v_mfma_f32_16x16x32_bf16 v[116:119], v[156:159], v[148:151], v[116:119]
ds_read_b64_tr_b16 v[66:67], v4 offset:38912
ds_read_b64_tr_b16 v[68:69], v5 offset:36864
v_mfma_f32_16x16x32_bf16 v[112:115], v[152:155], v[148:151], v[112:115]
ds_read_b64_tr_b16 v[70:71], v5 offset:38912
ds_read_b64_tr_b16 v[72:73], v6 offset:36864
v_mfma_f32_16x16x32_bf16 v[96:99], v[176:179], v[168:171], v[96:99]
ds_read_b64_tr_b16 v[74:75], v6 offset:38912
ds_read_b64_tr_b16 v[76:77], v7 offset:36864
v_mfma_f32_16x16x32_bf16 v[100:103], v[180:183], v[168:171], v[100:103]
ds_read_b64_tr_b16 v[78:79], v7 offset:38912
ds_read_b128 v[60:63], v3 offset:9216
v_mfma_f32_16x16x32_bf16 v[104:107], v[184:187], v[168:171], v[104:107]
s_bitcmp0_b32 s2, 0
v_mfma_f32_16x16x32_bf16 v[108:111], v[188:191], v[168:171], v[108:111]
s_cselect_b32 s88, s72, s74
v_mfma_f32_16x16x32_bf16 v[124:127], v[188:191], v[172:175], v[124:127]
s_cselect_b32 s89, s73, s75
v_mfma_f32_16x16x32_bf16 v[120:123], v[184:187], v[172:175], v[120:123]
s_mov_b32 s90, 7340032
v_mfma_f32_16x16x32_bf16 v[116:119], v[180:183], v[172:175], v[116:119]
s_mov_b32 s91, 0x20000
v_mfma_f32_16x16x32_bf16 v[112:115], v[176:179], v[172:175], v[112:115]
s_bfe_u32 s44, s2, 0x30001
s_waitcnt lgkmcnt(0)
s_barrier
v_mfma_f32_16x16x32_bf16 v[96:99], v[40:43], v[32:35], v[96:99]
ds_read_b128 v[144:147], v3 offset:49152
ds_read_b64_tr_b16 v[152:153], v4 offset:40960
v_mfma_f32_16x16x32_bf16 v[100:103], v[44:47], v[32:35], v[100:103]
ds_read_b64_tr_b16 v[154:155], v4 offset:43008
ds_read_b64_tr_b16 v[156:157], v5 offset:40960
v_mfma_f32_16x16x32_bf16 v[104:107], v[48:51], v[32:35], v[104:107]
ds_read_b64_tr_b16 v[158:159], v5 offset:43008
ds_read_b64_tr_b16 v[160:161], v6 offset:40960
v_mfma_f32_16x16x32_bf16 v[108:111], v[52:55], v[32:35], v[108:111]
ds_read_b64_tr_b16 v[162:163], v6 offset:43008
ds_read_b64_tr_b16 v[164:165], v7 offset:40960
v_mfma_f32_16x16x32_bf16 v[124:127], v[52:55], v[36:39], v[124:127]
ds_read_b64_tr_b16 v[166:167], v7 offset:43008
ds_read_b128 v[148:151], v3 offset:50176
v_mfma_f32_16x16x32_bf16 v[120:123], v[48:51], v[36:39], v[120:123]
ds_read_b128 v[168:171], v3 offset:57344
ds_read_b64_tr_b16 v[176:177], v4 offset:45056
v_mfma_f32_16x16x32_bf16 v[116:119], v[44:47], v[36:39], v[116:119]
ds_read_b64_tr_b16 v[178:179], v4 offset:47104
ds_read_b64_tr_b16 v[180:181], v5 offset:45056
v_mfma_f32_16x16x32_bf16 v[112:115], v[40:43], v[36:39], v[112:115]
ds_read_b64_tr_b16 v[182:183], v5 offset:47104
ds_read_b64_tr_b16 v[184:185], v6 offset:45056
v_mfma_f32_16x16x32_bf16 v[96:99], v[64:67], v[56:59], v[96:99]
ds_read_b64_tr_b16 v[186:187], v6 offset:47104
ds_read_b64_tr_b16 v[188:189], v7 offset:45056
v_mfma_f32_16x16x32_bf16 v[100:103], v[68:71], v[56:59], v[100:103]
ds_read_b64_tr_b16 v[190:191], v7 offset:47104
ds_read_b128 v[172:175], v3 offset:58368
v_mfma_f32_16x16x32_bf16 v[104:107], v[72:75], v[56:59], v[104:107]
s_lshl_b32 s44, s44, 2
v_mfma_f32_16x16x32_bf16 v[108:111], v[76:79], v[56:59], v[108:111]
s_and_b32 s43, s36, 3
v_mfma_f32_16x16x32_bf16 v[124:127], v[76:79], v[60:63], v[124:127]
s_add_u32 s44, s44, s43
v_mfma_f32_16x16x32_bf16 v[120:123], v[72:75], v[60:63], v[120:123]
s_lshl_b32 s44, s44, 5
v_mfma_f32_16x16x32_bf16 v[116:119], v[68:71], v[60:63], v[116:119]
v_lshrrev_b32 v195, 4, v1
v_mfma_f32_16x16x32_bf16 v[112:115], v[64:67], v[60:63], v[112:115]
v_add_u32 v195, s44, v195
s_waitcnt lgkmcnt(0)
s_barrier
v_mfma_f32_16x16x32_bf16 v[96:99], v[152:155], v[144:147], v[96:99]
ds_read_b128 v[32:35], v2 offset:0
ds_read_b64_tr_b16 v[40:41], v16 offset:49152
v_mfma_f32_16x16x32_bf16 v[100:103], v[156:159], v[144:147], v[100:103]
ds_read_b64_tr_b16 v[42:43], v16 offset:51200
ds_read_b64_tr_b16 v[44:45], v17 offset:49152
v_mfma_f32_16x16x32_bf16 v[104:107], v[160:163], v[144:147], v[104:107]
ds_read_b64_tr_b16 v[46:47], v17 offset:51200
ds_read_b64_tr_b16 v[48:49], v18 offset:49152
v_mfma_f32_16x16x32_bf16 v[108:111], v[164:167], v[144:147], v[108:111]
ds_read_b64_tr_b16 v[50:51], v18 offset:51200
ds_read_b64_tr_b16 v[52:53], v19 offset:49152
v_mfma_f32_16x16x32_bf16 v[124:127], v[164:167], v[148:151], v[124:127]
ds_read_b64_tr_b16 v[54:55], v19 offset:51200
ds_read_b128 v[36:39], v2 offset:1024
v_mfma_f32_16x16x32_bf16 v[120:123], v[160:163], v[148:151], v[120:123]
ds_read_b128 v[56:59], v2 offset:8192
ds_read_b64_tr_b16 v[64:65], v16 offset:53248
v_mfma_f32_16x16x32_bf16 v[116:119], v[156:159], v[148:151], v[116:119]
ds_read_b64_tr_b16 v[66:67], v16 offset:55296
ds_read_b64_tr_b16 v[68:69], v17 offset:53248
v_mfma_f32_16x16x32_bf16 v[112:115], v[152:155], v[148:151], v[112:115]
ds_read_b64_tr_b16 v[70:71], v17 offset:55296
ds_read_b64_tr_b16 v[72:73], v18 offset:53248
v_mfma_f32_16x16x32_bf16 v[96:99], v[176:179], v[168:171], v[96:99]
ds_read_b64_tr_b16 v[74:75], v18 offset:55296
ds_read_b64_tr_b16 v[76:77], v19 offset:53248
v_mfma_f32_16x16x32_bf16 v[100:103], v[180:183], v[168:171], v[100:103]
ds_read_b64_tr_b16 v[78:79], v19 offset:55296
ds_read_b128 v[60:63], v2 offset:9216
v_mfma_f32_16x16x32_bf16 v[104:107], v[184:187], v[168:171], v[104:107]
v_mul_u32_u24 v195, 7168, v195
v_mfma_f32_16x16x32_bf16 v[108:111], v[188:191], v[168:171], v[108:111]
v_and_b32 v196, 15, v1
v_mfma_f32_16x16x32_bf16 v[124:127], v[188:191], v[172:175], v[124:127]
v_lshl_add_u32 v195, v196, 4, v195
v_mfma_f32_16x16x32_bf16 v[120:123], v[184:187], v[172:175], v[120:123]
s_lshr_b32 s43, s2, 4
v_mfma_f32_16x16x32_bf16 v[116:119], v[180:183], v[172:175], v[116:119]
s_lshl_b32 s43, s43, 8
v_mfma_f32_16x16x32_bf16 v[112:115], v[176:179], v[172:175], v[112:115]
v_add_u32 v195, s43, v195
s_waitcnt lgkmcnt(0)
s_barrier
v_mfma_f32_16x16x32_bf16 v[96:99], v[40:43], v[32:35], v[96:99]
ds_read_b128 v[144:147], v2 offset:49152
ds_read_b64_tr_b16 v[152:153], v16 offset:57344
v_mfma_f32_16x16x32_bf16 v[100:103], v[44:47], v[32:35], v[100:103]
ds_read_b64_tr_b16 v[154:155], v16 offset:59392
ds_read_b64_tr_b16 v[156:157], v17 offset:57344
v_mfma_f32_16x16x32_bf16 v[104:107], v[48:51], v[32:35], v[104:107]
ds_read_b64_tr_b16 v[158:159], v17 offset:59392
ds_read_b64_tr_b16 v[160:161], v18 offset:57344
v_mfma_f32_16x16x32_bf16 v[108:111], v[52:55], v[32:35], v[108:111]
ds_read_b64_tr_b16 v[162:163], v18 offset:59392
ds_read_b64_tr_b16 v[164:165], v19 offset:57344
v_mfma_f32_16x16x32_bf16 v[124:127], v[52:55], v[36:39], v[124:127]
ds_read_b64_tr_b16 v[166:167], v19 offset:59392
ds_read_b128 v[148:151], v2 offset:50176
v_mfma_f32_16x16x32_bf16 v[120:123], v[48:51], v[36:39], v[120:123]
ds_read_b128 v[168:171], v2 offset:57344
ds_read_b64_tr_b16 v[176:177], v16 offset:61440
v_mfma_f32_16x16x32_bf16 v[116:119], v[44:47], v[36:39], v[116:119]
ds_read_b64_tr_b16 v[178:179], v16 offset:63488
ds_read_b64_tr_b16 v[180:181], v17 offset:61440
v_mfma_f32_16x16x32_bf16 v[112:115], v[40:43], v[36:39], v[112:115]
ds_read_b64_tr_b16 v[182:183], v17 offset:63488
ds_read_b64_tr_b16 v[184:185], v18 offset:61440
v_mfma_f32_16x16x32_bf16 v[96:99], v[64:67], v[56:59], v[96:99]
ds_read_b64_tr_b16 v[186:187], v18 offset:63488
ds_read_b64_tr_b16 v[188:189], v19 offset:61440
v_mfma_f32_16x16x32_bf16 v[100:103], v[68:71], v[56:59], v[100:103]
ds_read_b64_tr_b16 v[190:191], v19 offset:63488
ds_read_b128 v[172:175], v2 offset:58368
v_mfma_f32_16x16x32_bf16 v[104:107], v[72:75], v[56:59], v[104:107]
v_mfma_f32_16x16x32_bf16 v[108:111], v[76:79], v[56:59], v[108:111]
v_mfma_f32_16x16x32_bf16 v[124:127], v[76:79], v[60:63], v[124:127]
v_mfma_f32_16x16x32_bf16 v[120:123], v[72:75], v[60:63], v[120:123]
v_mfma_f32_16x16x32_bf16 v[116:119], v[68:71], v[60:63], v[116:119]
v_mfma_f32_16x16x32_bf16 v[112:115], v[64:67], v[60:63], v[112:115]
s_waitcnt lgkmcnt(0)
s_barrier
v_mfma_f32_16x16x32_bf16 v[96:99], v[152:155], v[144:147], v[96:99]
ds_read_b128 v[32:35], v3 offset:0
ds_read_b64_tr_b16 v[40:41], v20 offset:0
v_mfma_f32_16x16x32_bf16 v[100:103], v[156:159], v[144:147], v[100:103]
ds_read_b64_tr_b16 v[42:43], v20 offset:2048
ds_read_b64_tr_b16 v[44:45], v21 offset:0
v_mfma_f32_16x16x32_bf16 v[104:107], v[160:163], v[144:147], v[104:107]
ds_read_b64_tr_b16 v[46:47], v21 offset:2048
ds_read_b64_tr_b16 v[48:49], v22 offset:0
v_mfma_f32_16x16x32_bf16 v[108:111], v[164:167], v[144:147], v[108:111]
ds_read_b64_tr_b16 v[50:51], v22 offset:2048
ds_read_b64_tr_b16 v[52:53], v23 offset:0
v_mfma_f32_16x16x32_bf16 v[124:127], v[164:167], v[148:151], v[124:127]
ds_read_b64_tr_b16 v[54:55], v23 offset:2048
ds_read_b128 v[36:39], v3 offset:1024
v_mfma_f32_16x16x32_bf16 v[120:123], v[160:163], v[148:151], v[120:123]
ds_read_b128 v[56:59], v3 offset:8192
ds_read_b64_tr_b16 v[64:65], v20 offset:4096
v_mfma_f32_16x16x32_bf16 v[116:119], v[156:159], v[148:151], v[116:119]
ds_read_b64_tr_b16 v[66:67], v20 offset:6144
ds_read_b64_tr_b16 v[68:69], v21 offset:4096
v_mfma_f32_16x16x32_bf16 v[112:115], v[152:155], v[148:151], v[112:115]
ds_read_b64_tr_b16 v[70:71], v21 offset:6144
ds_read_b64_tr_b16 v[72:73], v22 offset:4096
v_mfma_f32_16x16x32_bf16 v[96:99], v[176:179], v[168:171], v[96:99]
ds_read_b64_tr_b16 v[74:75], v22 offset:6144
ds_read_b64_tr_b16 v[76:77], v23 offset:4096
v_mfma_f32_16x16x32_bf16 v[100:103], v[180:183], v[168:171], v[100:103]
ds_read_b64_tr_b16 v[78:79], v23 offset:6144
ds_read_b128 v[60:63], v3 offset:9216
v_mfma_f32_16x16x32_bf16 v[104:107], v[184:187], v[168:171], v[104:107]
v_mfma_f32_16x16x32_bf16 v[108:111], v[188:191], v[168:171], v[108:111]
v_mfma_f32_16x16x32_bf16 v[124:127], v[188:191], v[172:175], v[124:127]
v_mfma_f32_16x16x32_bf16 v[120:123], v[184:187], v[172:175], v[120:123]
v_mfma_f32_16x16x32_bf16 v[116:119], v[180:183], v[172:175], v[116:119]
v_mfma_f32_16x16x32_bf16 v[112:115], v[176:179], v[172:175], v[112:115]
s_waitcnt lgkmcnt(0)
s_barrier
v_mfma_f32_16x16x32_bf16 v[96:99], v[40:43], v[32:35], v[96:99]
ds_read_b128 v[144:147], v3 offset:49152
ds_read_b64_tr_b16 v[152:153], v20 offset:8192
v_mfma_f32_16x16x32_bf16 v[100:103], v[44:47], v[32:35], v[100:103]
ds_read_b64_tr_b16 v[154:155], v20 offset:10240
ds_read_b64_tr_b16 v[156:157], v21 offset:8192
v_mfma_f32_16x16x32_bf16 v[104:107], v[48:51], v[32:35], v[104:107]
ds_read_b64_tr_b16 v[158:159], v21 offset:10240
ds_read_b64_tr_b16 v[160:161], v22 offset:8192
v_mfma_f32_16x16x32_bf16 v[108:111], v[52:55], v[32:35], v[108:111]
ds_read_b64_tr_b16 v[162:163], v22 offset:10240
ds_read_b64_tr_b16 v[164:165], v23 offset:8192
v_mfma_f32_16x16x32_bf16 v[124:127], v[52:55], v[36:39], v[124:127]
ds_read_b64_tr_b16 v[166:167], v23 offset:10240
ds_read_b128 v[148:151], v3 offset:50176
v_mfma_f32_16x16x32_bf16 v[120:123], v[48:51], v[36:39], v[120:123]
ds_read_b128 v[168:171], v3 offset:57344
ds_read_b64_tr_b16 v[176:177], v20 offset:12288
v_mfma_f32_16x16x32_bf16 v[116:119], v[44:47], v[36:39], v[116:119]
ds_read_b64_tr_b16 v[178:179], v20 offset:14336
ds_read_b64_tr_b16 v[180:181], v21 offset:12288
v_mfma_f32_16x16x32_bf16 v[112:115], v[40:43], v[36:39], v[112:115]
ds_read_b64_tr_b16 v[182:183], v21 offset:14336
ds_read_b64_tr_b16 v[184:185], v22 offset:12288
v_mfma_f32_16x16x32_bf16 v[96:99], v[64:67], v[56:59], v[96:99]
ds_read_b64_tr_b16 v[186:187], v22 offset:14336
ds_read_b64_tr_b16 v[188:189], v23 offset:12288
v_mfma_f32_16x16x32_bf16 v[100:103], v[68:71], v[56:59], v[100:103]
ds_read_b64_tr_b16 v[190:191], v23 offset:14336
ds_read_b128 v[172:175], v3 offset:58368
v_mfma_f32_16x16x32_bf16 v[104:107], v[72:75], v[56:59], v[104:107]
v_mfma_f32_16x16x32_bf16 v[108:111], v[76:79], v[56:59], v[108:111]
v_mfma_f32_16x16x32_bf16 v[124:127], v[76:79], v[60:63], v[124:127]
v_mfma_f32_16x16x32_bf16 v[120:123], v[72:75], v[60:63], v[120:123]
v_mfma_f32_16x16x32_bf16 v[116:119], v[68:71], v[60:63], v[116:119]
v_mfma_f32_16x16x32_bf16 v[112:115], v[64:67], v[60:63], v[112:115]
s_waitcnt lgkmcnt(0)
s_barrier
v_mfma_f32_16x16x32_bf16 v[96:99], v[152:155], v[144:147], v[96:99]
v_mfma_f32_16x16x32_bf16 v[100:103], v[156:159], v[144:147], v[100:103]
v_mfma_f32_16x16x32_bf16 v[104:107], v[160:163], v[144:147], v[104:107]
v_mfma_f32_16x16x32_bf16 v[108:111], v[164:167], v[144:147], v[108:111]
v_mfma_f32_16x16x32_bf16 v[124:127], v[164:167], v[148:151], v[124:127]
v_mfma_f32_16x16x32_bf16 v[120:123], v[160:163], v[148:151], v[120:123]
v_mfma_f32_16x16x32_bf16 v[116:119], v[156:159], v[148:151], v[116:119]
v_mfma_f32_16x16x32_bf16 v[112:115], v[152:155], v[148:151], v[112:115]
v_mfma_f32_16x16x32_bf16 v[96:99], v[176:179], v[168:171], v[96:99]
v_mfma_f32_16x16x32_bf16 v[100:103], v[180:183], v[168:171], v[100:103]
v_mfma_f32_16x16x32_bf16 v[104:107], v[184:187], v[168:171], v[104:107]
v_mfma_f32_16x16x32_bf16 v[108:111], v[188:191], v[168:171], v[108:111]
v_mfma_f32_16x16x32_bf16 v[124:127], v[188:191], v[172:175], v[124:127]
v_mfma_f32_16x16x32_bf16 v[120:123], v[184:187], v[172:175], v[120:123]
v_mfma_f32_16x16x32_bf16 v[116:119], v[180:183], v[172:175], v[116:119]
v_mfma_f32_16x16x32_bf16 v[112:115], v[176:179], v[172:175], v[112:115]
s_nop 3
v_cvt_pk_bf16_f32 v32, v96, v97
v_cvt_pk_bf16_f32 v33, v98, v99
v_cvt_pk_bf16_f32 v34, v100, v101
v_cvt_pk_bf16_f32 v35, v102, v103
s_add_u32 s43, s60, 0
buffer_store_dwordx4 v[32:35], v11, s[20:23], s43 offen offset:0 sc1
v_cvt_pk_bf16_f32 v36, v104, v105
v_cvt_pk_bf16_f32 v37, v106, v107
v_cvt_pk_bf16_f32 v38, v108, v109
v_cvt_pk_bf16_f32 v39, v110, v111
s_add_u32 s43, s60, 8192
buffer_store_dwordx4 v[36:39], v11, s[20:23], s43 offen offset:0 sc1
v_cvt_pk_bf16_f32 v44, v120, v121
v_cvt_pk_bf16_f32 v45, v122, v123
v_cvt_pk_bf16_f32 v46, v124, v125
v_cvt_pk_bf16_f32 v47, v126, v127
s_add_u32 s43, s60, 8192
buffer_store_dwordx4 v[44:47], v11, s[20:23], s43 offen offset:1024 sc1
v_cvt_pk_bf16_f32 v40, v112, v113
v_cvt_pk_bf16_f32 v41, v114, v115
v_cvt_pk_bf16_f32 v42, v116, v117
v_cvt_pk_bf16_f32 v43, v118, v119
s_add_u32 s43, s60, 0
buffer_store_dwordx4 v[40:43], v11, s[20:23], s43 offen offset:1024 sc1
v_mov_b32 v64, 0
v_mov_b32 v65, 0
v_mov_b32 v66, 0
v_mov_b32 v67, 0
v_mov_b32 v68, 0
v_mov_b32 v69, 0
v_mov_b32 v70, 0
v_mov_b32 v71, 0
v_dot2_f32_bf16 v64, v32, s61, v64
v_dot2_f32_bf16 v66, v32, v32, v66
v_dot2_f32_bf16 v68, v40, s61, v68
v_dot2_f32_bf16 v70, v40, v40, v70
v_dot2_f32_bf16 v65, v33, s61, v65
v_dot2_f32_bf16 v67, v33, v33, v67
v_dot2_f32_bf16 v69, v41, s61, v69
v_dot2_f32_bf16 v71, v41, v41, v71
v_dot2_f32_bf16 v64, v34, s61, v64
v_dot2_f32_bf16 v66, v34, v34, v66
v_dot2_f32_bf16 v68, v42, s61, v68
v_dot2_f32_bf16 v70, v42, v42, v70
v_dot2_f32_bf16 v65, v35, s61, v65
v_dot2_f32_bf16 v67, v35, v35, v67
v_dot2_f32_bf16 v69, v43, s61, v69
v_dot2_f32_bf16 v71, v43, v43, v71
v_dot2_f32_bf16 v64, v36, s61, v64
v_dot2_f32_bf16 v66, v36, v36, v66
v_dot2_f32_bf16 v68, v44, s61, v68
v_dot2_f32_bf16 v70, v44, v44, v70
v_dot2_f32_bf16 v65, v37, s61, v65
v_dot2_f32_bf16 v67, v37, v37, v67
v_dot2_f32_bf16 v69, v45, s61, v69
v_dot2_f32_bf16 v71, v45, v45, v71
v_dot2_f32_bf16 v64, v38, s61, v64
v_dot2_f32_bf16 v66, v38, v38, v66
v_dot2_f32_bf16 v68, v46, s61, v68
v_dot2_f32_bf16 v70, v46, v46, v70
v_dot2_f32_bf16 v65, v39, s61, v65
v_dot2_f32_bf16 v67, v39, v39, v67
v_dot2_f32_bf16 v69, v47, s61, v69
v_dot2_f32_bf16 v71, v47, v47, v71
s_nop 2
v_add_f32 v64, v64, v65
v_add_f32 v66, v66, v67
v_add_f32 v68, v68, v69
v_add_f32 v70, v70, v71
s_nop 1
v_permlane32_swap_b32 v64, v68
v_permlane32_swap_b32 v66, v70
v_add_f32 v64, v64, v68
v_add_f32 v66, v66, v70
s_nop 1
v_permlane16_swap_b32 v64, v66
v_add_f32 v64, v64, v66
buffer_store_dword v64, v9, s[24:27], 0 offen sc1
s_lshl_b32 s7, s34, 12
s_add_u32 s7, s7, 49280
v_lshl_add_u32 v4, v1, 8, s7
v_mov_b32 v5, 1
s_waitcnt vmcnt(0)
s_cmp_lg_u32 s36, 0
s_barrier
s_cbranch_scc1 Lk2end_104
s_mov_b64 exec, 0xffff
buffer_atomic_add v5, v4, s[56:59], 0 offen sc1
s_mov_b64 exec, -1
s_branch Lk2end_104
Lprod_105:
s_mul_i32 s43, s34, 262144
s_add_u32 s8, s82, s43
s_addc_u32 s9, s83, 0
s_mov_b32 s10, 262144
s_mov_b32 s11, 0x20000
s_lshl_b32 s43, s35, 7
s_add_u32 s12, s68, s43
s_addc_u32 s13, s69, 0
s_mov_b32 s14, 2095232
s_mov_b32 s15, 0x20000
s_and_b32 s47, s36, 3
s_lshl_b32 s39, s47, 12
v_lshlrev_b32 v2, 4, v1
v_add_u32 v2, s39, v2
v_lshrrev_b32 v12, 3, v1
v_and_b32 v13, 6, v12
v_and_b32 v3, 7, v1
v_xor_b32 v3, v3, v13
v_lshlrev_b32 v3, 4, v3
v_mul_u32_u24 v12, 2048, v12
v_add_u32 v3, v3, v12
s_lshl_b32 s43, s47, 15
v_add_u32 v3, s43, v3
s_lshl_b32 s40, s47, 11
s_add_u32 s37, s35, 0
s_and_b32 s37, s37, 15
s_lshl_b32 s37, s37, 14
s_add_u32 m0, s39, 0
s_nop 0
buffer_load_dwordx4 v2, s[8:11], s37 offen offset:0 sc1 lds
buffer_load_dwordx4 v2, s[8:11], s37 offen offset:1024 sc1 lds
buffer_load_dwordx4 v2, s[8:11], s37 offen offset:2048 sc1 lds
buffer_load_dwordx4 v2, s[8:11], s37 offen offset:3072 sc1 lds
s_add_u32 s38, s35, 4
s_and_b32 s38, s38, 15
s_lshl_b32 s38, s38, 17
s_add_u32 m0, s40, 114688
s_nop 0
buffer_load_dwordx4 v3, s[12:15], s38 offen lds
s_add_u32 m0, s40, 115712
s_add_u32 s38, s38, 16384
buffer_load_dwordx4 v3, s[12:15], s38 offen lds
s_add_u32 s38, s35, 5
s_and_b32 s38, s38, 15
s_lshl_b32 s38, s38, 17
s_add_u32 m0, s40, 122880
s_nop 0
buffer_load_dwordx4 v3, s[12:15], s38 offen lds
s_add_u32 m0, s40, 123904
s_add_u32 s38, s38, 16384
buffer_load_dwordx4 v3, s[12:15], s38 offen lds
s_add_u32 s38, s35, 6
s_and_b32 s38, s38, 15
s_lshl_b32 s38, s38, 17
s_add_u32 m0, s40, 131072
s_nop 0
buffer_load_dwordx4 v3, s[12:15], s38 offen lds
s_add_u32 m0, s40, 132096
s_add_u32 s38, s38, 16384
buffer_load_dwordx4 v3, s[12:15], s38 offen lds
s_add_u32 s38, s35, 7
s_and_b32 s38, s38, 15
s_lshl_b32 s38, s38, 17
s_add_u32 m0, s40, 139264
s_nop 0
buffer_load_dwordx4 v3, s[12:15], s38 offen lds
s_add_u32 m0, s40, 140288
s_add_u32 s38, s38, 16384
buffer_load_dwordx4 v3, s[12:15], s38 offen lds
s_bitcmp0_b32 s36, 1
s_cselect_b32 s44, s72, s74
s_cselect_b32 s45, s73, s75
s_mul_i32 s43, s35, 192
s_add_u32 s88, s44, s43
s_addc_u32 s89, s45, 0
s_add_u32 s88, s88, 4096
s_addc_u32 s89, s89, 0
s_mov_b32 s90, 7333056
s_mov_b32 s91, 0x20000
v_add_u32 v11, 0, v1
v_mul_u32_u24 v12, 5462, v11
v_lshrrev_b32 v12, 16, v12
v_mul_u32_u24 v13, 12, v12
v_sub_u32 v13, v11, v13
v_bfe_u32 v14, v12, 2, 1
v_cmp_gt_u32 vcc, 8, v13
v_lshlrev_b32 v15, 1, v14
v_mul_u32_u24 v12, 7168, v12
v_cndmask_b32 v14, v14, v15, vcc
v_xor_b32 v13, v13, v14
v_lshl_add_u32 v8, v13, 4, v12
v_add_u32 v11, 64, v1
v_mul_u32_u24 v12, 5462, v11
v_lshrrev_b32 v12, 16, v12
v_mul_u32_u24 v13, 12, v12
v_sub_u32 v13, v11, v13
v_bfe_u32 v14, v12, 2, 1
v_cmp_gt_u32 vcc, 8, v13
v_lshlrev_b32 v15, 1, v14
v_mul_u32_u24 v12, 7168, v12
v_cndmask_b32 v14, v14, v15, vcc
v_xor_b32 v13, v13, v14
v_lshl_add_u32 v9, v13, 4, v12
v_add_u32 v11, 128, v1
v_mul_u32_u24 v12, 5462, v11
v_lshrrev_b32 v12, 16, v12
v_mul_u32_u24 v13, 12, v12
v_sub_u32 v13, v11, v13
v_bfe_u32 v14, v12, 2, 1
v_cmp_gt_u32 vcc, 8, v13
v_lshlrev_b32 v15, 1, v14
v_mul_u32_u24 v12, 7168, v12
v_cndmask_b32 v14, v14, v15, vcc
v_xor_b32 v13, v13, v14
v_lshl_add_u32 v10, v13, 4, v12
s_and_b32 s43, s36, 1
s_mul_i32 s43, s43, 229376
v_add_u32 v8, s43, v8
v_add_u32 v9, s43, v9
v_add_u32 v10, s43, v10
s_and_b32 s43, s36, 3
s_mul_i32 s46, s43, 6144
s_add_u32 s46, s46, 16384
s_cmp_eq_u32 s47, 3
s_cbranch_scc0 Lw_112
s_lshl_b32 s92, s34, 4
s_add_u32 s92, s92, s35
s_lshl_b32 s92, s92, 8
s_add_u32 s92, s92, 49152
s_add_u32 s92, s92, 28311552
s_mov_b32 s41, 0x40000
Lpoll_113:
s_load_dword s93, s[82:83], s92 glc
Lpchk_115:
s_waitcnt lgkmcnt(0)
s_cmp_eq_u32 s93, 16
s_cbranch_scc1 Lpok_114
s_sub_u32 s41, s41, 1
s_cmp_lg_u32 s41, 0
s_cbranch_scc1 Lpoll_113
Lpok_114:
Lw_112:
s_and_b32 s44, s36, 3
s_mul_i32 s44, s44, 14
s_bfe_u32 s43, s2, 0x30001
s_lshl_b32 s43, s43, 7
s_add_u32 s44, s44, s43
s_add_u32 s44, s44, 72
s_mul_i32 s44, s44, 7168
s_lshr_b32 s43, s2, 4
s_lshl_b32 s43, s43, 8
s_add_u32 s43, s43, s44
s_bitcmp0_b32 s2, 0
s_cselect_b32 s4, s72, s74
s_cselect_b32 s5, s73, s75
s_add_u32 s4, s4, s43
s_addc_u32 s5, s5, 0
s_cmp_eq_u32 s47, 3
s_cbranch_scc1 Lw_116
s_load_dword s3, s[4:5], 0
s_load_dword s3, s[4:5], 64
s_load_dword s3, s[4:5], 128
s_load_dword s3, s[4:5], 192
s_load_dword s3, s[4:5], 7168
s_load_dword s3, s[4:5], 7232
s_load_dword s3, s[4:5], 7296
s_load_dword s3, s[4:5], 7360
s_load_dword s3, s[4:5], 14336
s_load_dword s3, s[4:5], 14400
s_load_dword s3, s[4:5], 14464
s_load_dword s3, s[4:5], 14528
s_load_dword s3, s[4:5], 21504
s_load_dword s3, s[4:5], 21568
Lw_116:
s_waitcnt vmcnt(8)
s_barrier
s_add_u32 s37, s35, 1
s_and_b32 s37, s37, 15
s_lshl_b32 s37, s37, 14
s_add_u32 m0, s39, 49152
s_nop 0
buffer_load_dwordx4 v2, s[8:11], s37 offen offset:0 sc1 lds
buffer_load_dwordx4 v2, s[8:11], s37 offen offset:1024 sc1 lds
buffer_load_dwordx4 v2, s[8:11], s37 offen offset:2048 sc1 lds
buffer_load_dwordx4 v2, s[8:11], s37 offen offset:3072 sc1 lds
s_add_u32 s37, s35, 2
s_and_b32 s37, s37, 15
s_lshl_b32 s37, s37, 14
s_add_u32 m0, s39, 98304
s_nop 0
buffer_load_dwordx4 v2, s[8:11], s37 offen offset:0 sc1 lds
buffer_load_dwordx4 v2, s[8:11], s37 offen offset:1024 sc1 lds
buffer_load_dwordx4 v2, s[8:11], s37 offen offset:2048 sc1 lds
buffer_load_dwordx4 v2, s[8:11], s37 offen offset:3072 sc1 lds
s_add_u32 s37, s35, 3
s_and_b32 s37, s37, 15
s_lshl_b32 s37, s37, 14
s_add_u32 m0, s39, 147456
s_nop 0
buffer_load_dwordx4 v2, s[8:11], s37 offen offset:0 sc1 lds
buffer_load_dwordx4 v2, s[8:11], s37 offen offset:1024 sc1 lds
buffer_load_dwordx4 v2, s[8:11], s37 offen offset:2048 sc1 lds
buffer_load_dwordx4 v2, s[8:11], s37 offen offset:3072 sc1 lds
s_cmp_eq_u32 s47, 3
s_cbranch_scc0 Lw_117
s_load_dword s3, s[4:5], 0
s_load_dword s3, s[4:5], 64
s_load_dword s3, s[4:5], 128
s_load_dword s3, s[4:5], 192
s_load_dword s3, s[4:5], 7168
s_load_dword s3, s[4:5], 7232
s_load_dword s3, s[4:5], 7296
s_load_dword s3, s[4:5], 7360
s_load_dword s3, s[4:5], 14336
s_load_dword s3, s[4:5], 14400
s_load_dword s3, s[4:5], 14464
s_load_dword s3, s[4:5], 14528
s_load_dword s3, s[4:5], 21504
s_load_dword s3, s[4:5], 21568
Lw_117:
s_waitcnt vmcnt(8)
s_barrier
s_add_u32 s37, s35, 4
s_and_b32 s37, s37, 15
s_lshl_b32 s37, s37, 14
s_add_u32 m0, s39, 0
s_nop 0
buffer_load_dwordx4 v2, s[8:11], s37 offen offset:0 sc1 lds
buffer_load_dwordx4 v2, s[8:11], s37 offen offset:1024 sc1 lds
buffer_load_dwordx4 v2, s[8:11], s37 offen offset:2048 sc1 lds
buffer_load_dwordx4 v2, s[8:11], s37 offen offset:3072 sc1 lds
s_add_u32 s38, s35, 8
s_and_b32 s38, s38, 15
s_lshl_b32 s38, s38, 17
s_add_u32 m0, s40, 16384
s_nop 0
buffer_load_dwordx4 v3, s[12:15], s38 offen lds
s_add_u32 m0, s40, 17408
s_add_u32 s38, s38, 16384
buffer_load_dwordx4 v3, s[12:15], s38 offen lds
v_lshlrev_b32 v240, 16, v128
v_and_b32 v241, 0xffff0000, v128
v_lshlrev_b32 v242, 16, v129
v_and_b32 v243, 0xffff0000, v129
s_branch Lov_7
.p2align 12
.fill 48, 4, 0xbf800000
Lst_7_0:
s_branch Lwr_174
s_nop 0
s_nop 0
Lov_7:
v_lshlrev_b32 v244, 16, v130
v_and_b32 v245, 0xffff0000, v130
v_lshlrev_b32 v246, 16, v131
v_and_b32 v247, 0xffff0000, v131
s_load_dword s3, s[4:5], 21632
s_load_dword s3, s[4:5], 21696
s_load_dword s3, s[4:5], 28672
s_waitcnt vmcnt(10)
s_barrier
s_add_u32 s37, s35, 5
s_and_b32 s37, s37, 15
s_lshl_b32 s37, s37, 14
s_add_u32 m0, s39, 49152
s_nop 0
buffer_load_dwordx4 v2, s[8:11], s37 offen offset:0 sc1 lds
buffer_load_dwordx4 v2, s[8:11], s37 offen offset:1024 sc1 lds
buffer_load_dwordx4 v2, s[8:11], s37 offen offset:2048 sc1 lds
buffer_load_dwordx4 v2, s[8:11], s37 offen offset:3072 sc1 lds
s_add_u32 s38, s35, 9
s_and_b32 s38, s38, 15
s_lshl_b32 s38, s38, 17
s_add_u32 m0, s40, 24576
s_nop 0
buffer_load_dwordx4 v3, s[12:15], s38 offen lds
s_add_u32 m0, s40, 25600
s_add_u32 s38, s38, 16384
buffer_load_dwordx4 v3, s[12:15], s38 offen lds
v_lshlrev_b32 v24, 16, v132
v_and_b32 v25, 0xffff0000, v132
v_lshlrev_b32 v26, 16, v133
v_and_b32 v27, 0xffff0000, v133
v_lshlrev_b32 v28, 16, v134
v_and_b32 v29, 0xffff0000, v134
v_lshlrev_b32 v30, 16, v135
v_and_b32 v31, 0xffff0000, v135
v_add_f32 v240, v240, v24
v_add_f32 v241, v241, v25
v_add_f32 v242, v242, v26
v_add_f32 v243, v243, v27
v_add_f32 v244, v244, v28
v_add_f32 v245, v245, v29
v_add_f32 v246, v246, v30
v_add_f32 v247, v247, v31
s_load_dword s3, s[4:5], 28736
s_load_dword s3, s[4:5], 28800
s_load_dword s3, s[4:5], 28864
s_waitcnt vmcnt(12)
s_barrier
s_add_u32 s37, s35, 6
s_and_b32 s37, s37, 15
s_lshl_b32 s37, s37, 14
s_add_u32 m0, s39, 98304
s_nop 0
buffer_load_dwordx4 v2, s[8:11], s37 offen offset:0 sc1 lds
buffer_load_dwordx4 v2, s[8:11], s37 offen offset:1024 sc1 lds
buffer_load_dwordx4 v2, s[8:11], s37 offen offset:2048 sc1 lds
buffer_load_dwordx4 v2, s[8:11], s37 offen offset:3072 sc1 lds
s_add_u32 s38, s35, 10
s_and_b32 s38, s38, 15
s_lshl_b32 s38, s38, 17
s_add_u32 m0, s40, 32768
s_nop 0
buffer_load_dwordx4 v3, s[12:15], s38 offen lds
s_add_u32 m0, s40, 33792
s_add_u32 s38, s38, 16384
buffer_load_dwordx4 v3, s[12:15], s38 offen lds
v_lshlrev_b32 v24, 16, v136
v_and_b32 v25, 0xffff0000, v136
v_lshlrev_b32 v26, 16, v137
v_and_b32 v27, 0xffff0000, v137
v_lshlrev_b32 v28, 16, v138
v_and_b32 v29, 0xffff0000, v138
v_lshlrev_b32 v30, 16, v139
v_and_b32 v31, 0xffff0000, v139
v_add_f32 v240, v240, v24
v_add_f32 v241, v241, v25
v_add_f32 v242, v242, v26
v_add_f32 v243, v243, v27
v_add_f32 v244, v244, v28
v_add_f32 v245, v245, v29
v_add_f32 v246, v246, v30
v_add_f32 v247, v247, v31
s_load_dword s3, s[4:5], 35840
s_load_dword s3, s[4:5], 35904
s_load_dword s3, s[4:5], 35968
s_waitcnt vmcnt(14)
s_barrier
s_add_u32 s37, s35, 7
s_and_b32 s37, s37, 15
s_lshl_b32 s37, s37, 14
s_add_u32 m0, s39, 147456
s_nop 0
buffer_load_dwordx4 v2, s[8:11], s37 offen offset:0 sc1 lds
buffer_load_dwordx4 v2, s[8:11], s37 offen offset:1024 sc1 lds
buffer_load_dwordx4 v2, s[8:11], s37 offen offset:2048 sc1 lds
buffer_load_dwordx4 v2, s[8:11], s37 offen offset:3072 sc1 lds
s_add_u32 s38, s35, 11
s_and_b32 s38, s38, 15
s_lshl_b32 s38, s38, 17
s_add_u32 m0, s40, 40960
s_nop 0
buffer_load_dwordx4 v3, s[12:15], s38 offen lds
s_add_u32 m0, s40, 41984
s_add_u32 s38, s38, 16384
buffer_load_dwordx4 v3, s[12:15], s38 offen lds
v_lshlrev_b32 v24, 16, v140
v_and_b32 v25, 0xffff0000, v140
v_lshlrev_b32 v26, 16, v141
v_and_b32 v27, 0xffff0000, v141
v_lshlrev_b32 v28, 16, v142
v_and_b32 v29, 0xffff0000, v142
v_lshlrev_b32 v30, 16, v143
v_and_b32 v31, 0xffff0000, v143
v_add_f32 v240, v240, v24
v_add_f32 v241, v241, v25
v_add_f32 v242, v242, v26
v_add_f32 v243, v243, v27
v_add_f32 v244, v244, v28
v_add_f32 v245, v245, v29
v_add_f32 v246, v246, v30
v_add_f32 v247, v247, v31
s_load_dword s3, s[4:5], 36032
s_load_dword s3, s[4:5], 43008
s_load_dword s3, s[4:5], 43072
s_waitcnt vmcnt(14)
s_barrier
s_add_u32 s37, s35, 8
s_and_b32 s37, s37, 15
s_lshl_b32 s37, s37, 14
s_add_u32 m0, s39, 0
s_nop 0
buffer_load_dwordx4 v2, s[8:11], s37 offen offset:0 sc1 lds
buffer_load_dwordx4 v2, s[8:11], s37 offen offset:1024 sc1 lds
buffer_load_dwordx4 v2, s[8:11], s37 offen offset:2048 sc1 lds
buffer_load_dwordx4 v2, s[8:11], s37 offen offset:3072 sc1 lds
s_add_u32 s38, s35, 12
s_and_b32 s38, s38, 15
s_lshl_b32 s38, s38, 17
s_add_u32 m0, s40, 114688
s_nop 0
buffer_load_dwordx4 v3, s[12:15], s38 offen lds
s_add_u32 m0, s40, 115712
s_add_u32 s38, s38, 16384
buffer_load_dwordx4 v3, s[12:15], s38 offen lds
v_lshlrev_b32 v24, 16, v144
v_and_b32 v25, 0xffff0000, v144
v_lshlrev_b32 v26, 16, v145
v_and_b32 v27, 0xffff0000, v145
v_lshlrev_b32 v28, 16, v146
v_and_b32 v29, 0xffff0000, v146
v_lshlrev_b32 v30, 16, v147
v_and_b32 v31, 0xffff0000, v147
v_add_f32 v240, v240, v24
v_add_f32 v241, v241, v25
v_add_f32 v242, v242, v26
v_add_f32 v243, v243, v27
v_add_f32 v244, v244, v28
v_add_f32 v245, v245, v29
v_add_f32 v246, v246, v30
v_add_f32 v247, v247, v31
s_load_dword s3, s[4:5], 43136
s_load_dword s3, s[4:5], 43200
s_load_dword s3, s[4:5], 50176
s_waitcnt vmcnt(14)
s_barrier
s_add_u32 s37, s35, 9
s_and_b32 s37, s37, 15
s_lshl_b32 s37, s37, 14
s_add_u32 m0, s39, 49152
s_nop 0
buffer_load_dwordx4 v2, s[8:11], s37 offen offset:0 sc1 lds
buffer_load_dwordx4 v2, s[8:11], s37 offen offset:1024 sc1 lds
buffer_load_dwordx4 v2, s[8:11], s37 offen offset:2048 sc1 lds
buffer_load_dwordx4 v2, s[8:11], s37 offen offset:3072 sc1 lds
s_add_u32 s38, s35, 13
s_and_b32 s38, s38, 15
s_lshl_b32 s38, s38, 17
s_add_u32 m0, s40, 122880
s_nop 0
buffer_load_dwordx4 v3, s[12:15], s38 offen lds
s_add_u32 m0, s40, 123904
s_add_u32 s38, s38, 16384
buffer_load_dwordx4 v3, s[12:15], s38 offen lds
v_lshlrev_b32 v24, 16, v148
v_and_b32 v25, 0xffff0000, v148
v_lshlrev_b32 v26, 16, v149
v_and_b32 v27, 0xffff0000, v149
v_lshlrev_b32 v28, 16, v150
v_and_b32 v29, 0xffff0000, v150
v_lshlrev_b32 v30, 16, v151
v_and_b32 v31, 0xffff0000, v151
v_add_f32 v240, v240, v24
v_add_f32 v241, v241, v25
v_add_f32 v242, v242, v26
v_add_f32 v243, v243, v27
v_add_f32 v244, v244, v28
v_add_f32 v245, v245, v29
v_add_f32 v246, v246, v30
v_add_f32 v247, v247, v31
s_load_dword s3, s[4:5], 50240
s_load_dword s3, s[4:5], 50304
s_load_dword s3, s[4:5], 50368
s_waitcnt vmcnt(14)
s_barrier
s_add_u32 s37, s35, 10
s_and_b32 s37, s37, 15
s_lshl_b32 s37, s37, 14
s_add_u32 m0, s39, 98304
s_nop 0
buffer_load_dwordx4 v2, s[8:11], s37 offen offset:0 sc1 lds
buffer_load_dwordx4 v2, s[8:11], s37 offen offset:1024 sc1 lds
buffer_load_dwordx4 v2, s[8:11], s37 offen offset:2048 sc1 lds
buffer_load_dwordx4 v2, s[8:11], s37 offen offset:3072 sc1 lds
s_add_u32 s38, s35, 14
s_and_b32 s38, s38, 15
s_lshl_b32 s38, s38, 17
s_add_u32 m0, s40, 131072
s_nop 0
buffer_load_dwordx4 v3, s[12:15], s38 offen lds
s_add_u32 m0, s40, 132096
s_add_u32 s38, s38, 16384
buffer_load_dwordx4 v3, s[12:15], s38 offen lds
v_lshlrev_b32 v24, 16, v152
v_and_b32 v25, 0xffff0000, v152
v_lshlrev_b32 v26, 16, v153
v_and_b32 v27, 0xffff0000, v153
v_lshlrev_b32 v28, 16, v154
v_and_b32 v29, 0xffff0000, v154
v_lshlrev_b32 v30, 16, v155
v_and_b32 v31, 0xffff0000, v155
v_add_f32 v240, v240, v24
v_add_f32 v241, v241, v25
v_add_f32 v242, v242, v26
v_add_f32 v243, v243, v27
v_add_f32 v244, v244, v28
v_add_f32 v245, v245, v29
v_add_f32 v246, v246, v30
v_add_f32 v247, v247, v31
s_load_dword s3, s[4:5], 57344
s_load_dword s3, s[4:5], 57408
s_load_dword s3, s[4:5], 57472
s_waitcnt vmcnt(14)
s_barrier
s_add_u32 s37, s35, 11
s_and_b32 s37, s37, 15
s_lshl_b32 s37, s37, 14
s_add_u32 m0, s39, 147456
s_nop 0
buffer_load_dwordx4 v2, s[8:11], s37 offen offset:0 sc1 lds
buffer_load_dwordx4 v2, s[8:11], s37 offen offset:1024 sc1 lds
buffer_load_dwordx4 v2, s[8:11], s37 offen offset:2048 sc1 lds
buffer_load_dwordx4 v2, s[8:11], s37 offen offset:3072 sc1 lds
s_add_u32 s38, s35, 15
s_and_b32 s38, s38, 15
s_lshl_b32 s38, s38, 17
s_add_u32 m0, s40, 139264
s_nop 0
buffer_load_dwordx4 v3, s[12:15], s38 offen lds
s_add_u32 m0, s40, 140288
s_add_u32 s38, s38, 16384
buffer_load_dwordx4 v3, s[12:15], s38 offen lds
v_lshlrev_b32 v24, 16, v156
v_and_b32 v25, 0xffff0000, v156
v_lshlrev_b32 v26, 16, v157
v_and_b32 v27, 0xffff0000, v157
v_lshlrev_b32 v28, 16, v158
v_and_b32 v29, 0xffff0000, v158
v_lshlrev_b32 v30, 16, v159
v_and_b32 v31, 0xffff0000, v159
v_add_f32 v240, v240, v24
v_add_f32 v241, v241, v25
v_add_f32 v242, v242, v26
v_add_f32 v243, v243, v27
v_add_f32 v244, v244, v28
v_add_f32 v245, v245, v29
v_add_f32 v246, v246, v30
v_add_f32 v247, v247, v31
s_load_dword s3, s[4:5], 57536
s_load_dword s3, s[4:5], 64512
s_load_dword s3, s[4:5], 64576
s_waitcnt vmcnt(14)
s_barrier
s_add_u32 s37, s35, 12
s_and_b32 s37, s37, 15
s_lshl_b32 s37, s37, 14
s_add_u32 m0, s39, 0
s_nop 0
buffer_load_dwordx4 v2, s[8:11], s37 offen offset:0 sc1 lds
buffer_load_dwordx4 v2, s[8:11], s37 offen offset:1024 sc1 lds
buffer_load_dwordx4 v2, s[8:11], s37 offen offset:2048 sc1 lds
buffer_load_dwordx4 v2, s[8:11], s37 offen offset:3072 sc1 lds
s_load_dword s3, s[4:5], 64640
s_load_dword s3, s[4:5], 64704
s_load_dword s3, s[4:5], 71680
s_waitcnt vmcnt(12)
s_barrier
s_add_u32 s37, s35, 13
s_and_b32 s37, s37, 15
s_lshl_b32 s37, s37, 14
s_add_u32 m0, s39, 49152
s_nop 0
buffer_load_dwordx4 v2, s[8:11], s37 offen offset:0 sc1 lds
buffer_load_dwordx4 v2, s[8:11], s37 offen offset:1024 sc1 lds
buffer_load_dwordx4 v2, s[8:11], s37 offen offset:2048 sc1 lds
buffer_load_dwordx4 v2, s[8:11], s37 offen offset:3072 sc1 lds
s_load_dword s3, s[4:5], 71744
s_load_dword s3, s[4:5], 71808
s_load_dword s3, s[4:5], 71872
s_waitcnt vmcnt(10)
s_barrier
s_add_u32 s37, s35, 14
s_and_b32 s37, s37, 15
s_lshl_b32 s37, s37, 14
s_add_u32 m0, s39, 98304
s_nop 0
buffer_load_dwordx4 v2, s[8:11], s37 offen offset:0 sc1 lds
buffer_load_dwordx4 v2, s[8:11], s37 offen offset:1024 sc1 lds
buffer_load_dwordx4 v2, s[8:11], s37 offen offset:2048 sc1 lds
buffer_load_dwordx4 v2, s[8:11], s37 offen offset:3072 sc1 lds
s_waitcnt vmcnt(8)
s_barrier
s_add_u32 s37, s35, 15
s_and_b32 s37, s37, 15
s_lshl_b32 s37, s37, 14
s_add_u32 m0, s39, 147456
s_nop 0
buffer_load_dwordx4 v2, s[8:11], s37 offen offset:0 sc1 lds
buffer_load_dwordx4 v2, s[8:11], s37 offen offset:1024 sc1 lds
buffer_load_dwordx4 v2, s[8:11], s37 offen offset:2048 sc1 lds
buffer_load_dwordx4 v2, s[8:11], s37 offen offset:3072 sc1 lds
s_waitcnt vmcnt(8)
s_barrier
s_nop 0
v_permlane32_swap_b32 v240, v244
v_permlane32_swap_b32 v241, v245
v_permlane32_swap_b32 v242, v246
v_permlane32_swap_b32 v243, v247
v_add_f32 v240, v240, v244
v_add_f32 v241, v241, v245
v_add_f32 v242, v242, v246
v_add_f32 v243, v243, v247
s_nop 0
v_permlane16_swap_b32 v240, v242
v_permlane16_swap_b32 v241, v243
v_add_f32 v240, v240, v242
v_add_f32 v241, v241, v243
s_waitcnt vmcnt(4)
s_barrier
s_add_u32 s38, s35, 0
s_and_b32 s38, s38, 15
s_mul_i32 s38, s38, 458752
s_add_u32 m0, s46, 0
s_nop 0
buffer_load_dwordx4 v8, s[88:91], s38 offen lds
s_add_u32 m0, s46, 1024
s_nop 0
buffer_load_dwordx4 v9, s[88:91], s38 offen lds
s_add_u32 m0, s46, 2048
s_nop 0
buffer_load_dwordx4 v10, s[88:91], s38 offen lds
s_add_u32 m0, s46, 3072
s_add_u32 s38, s38, 114688
buffer_load_dwordx4 v8, s[88:91], s38 offen lds
s_add_u32 m0, s46, 4096
s_nop 0
buffer_load_dwordx4 v9, s[88:91], s38 offen lds
s_add_u32 m0, s46, 5120
s_nop 0
buffer_load_dwordx4 v10, s[88:91], s38 offen lds
s_add_u32 s38, s35, 1
s_and_b32 s38, s38, 15
s_mul_i32 s38, s38, 458752
s_add_u32 m0, s46, 49152
s_nop 0
buffer_load_dwordx4 v8, s[88:91], s38 offen lds
s_add_u32 m0, s46, 50176
s_nop 0
buffer_load_dwordx4 v9, s[88:91], s38 offen lds
s_add_u32 m0, s46, 51200
s_nop 0
buffer_load_dwordx4 v10, s[88:91], s38 offen lds
s_add_u32 m0, s46, 52224
s_add_u32 s38, s38, 114688
buffer_load_dwordx4 v8, s[88:91], s38 offen lds
s_add_u32 m0, s46, 53248
s_nop 0
buffer_load_dwordx4 v9, s[88:91], s38 offen lds
s_add_u32 m0, s46, 54272
s_nop 0
buffer_load_dwordx4 v10, s[88:91], s38 offen lds
s_waitcnt vmcnt(12)
s_barrier
s_barrier
s_branch Lk3a
Lk2end_104:
Lk3:
s_branch Lgb_118
Lk3a:
s_mul_i32 s43, s34, 262144
s_add_u32 s8, s82, s43
s_addc_u32 s9, s83, 0
s_add_u32 s8, s8, 4194304
s_addc_u32 s9, s9, 0
s_mov_b32 s10, 262144
s_mov_b32 s11, 0x20000
s_mul_i32 s43, s34, 917504
s_add_u32 s24, s82, s43
s_addc_u32 s25, s83, 0
s_add_u32 s24, s24, 8388608
s_addc_u32 s25, s25, 0
s_mov_b32 s26, 917504
s_mov_b32 s27, 0x20000
s_add_u32 s84, s82, 27262976
s_addc_u32 s85, s83, 0
s_mov_b32 s86, 229376
s_mov_b32 s87, 0x20000
s_and_b32 s47, s36, 3
s_lshr_b32 s62, s47, 1
s_and_b32 s63, s47, 1
v_lshlrev_b32 v2, 4, v1
s_lshl_b32 s39, s47, 12
v_add_u32 v3, s39, v2
s_cmp_eq_u32 s62, 0
s_cselect_b32 s44, s72, s74
s_cselect_b32 s45, s73, s75
s_lshl_b32 s43, s35, 8
s_add_u32 s12, s44, s43
s_addc_u32 s13, s45, 0
s_mov_b32 s14, 7333120
s_mov_b32 s15, 0x20000
v_lshrrev_b32 v28, 4, v1
v_lshlrev_b32 v29, 1, v28
v_and_b32 v4, 15, v1
v_xor_b32 v4, v4, v29
v_lshlrev_b32 v4, 4, v4
v_mul_u32_u24 v28, 7168, v28
v_add_u32 v4, v4, v28
s_mul_i32 s43, s63, 229376
v_add_u32 v4, s43, v4
v_xor_b32 v5, 128, v4
v_add_u32 v5, 28672, v5
s_lshl_b32 s40, s47, 13
s_add_u32 s40, s40, 16384
s_lshl_b32 s43, s62, 12
v_add_u32 v9, s43, v2
v_add_u32 v10, 98304, v9
s_lshl_b32 s43, s47, 9
s_add_u32 s43, s43, 151552
v_and_b32 v28, 15, v1
v_lshl_add_u32 v28, v28, 5, s43
v_lshrrev_b32 v29, 4, v1
v_lshl_add_u32 v28, v29, 3, v28
ds_write_b64 v28, v[240:241]
s_waitcnt lgkmcnt(0)
v_lshrrev_b32 v27, 2, v1
v_bfe_u32 v28, v27, 2, 1
v_mul_u32_u24 v27, 192, v27
v_add_u32 v27, 16384, v27
v_and_b32 v29, 3, v1
v_lshl_add_u32 v12, v29, 3, v27
s_lshl_b32 s43, s63, 6
v_add_u32 v12, s43, v12
v_lshl_add_u32 v11, v28, 5, v12
v_xor_b32 v30, 1, v28
v_lshl_add_u32 v12, v30, 5, v12
v_xor_b32 v28, s63, v28
v_lshl_add_u32 v27, v28, 4, v27
v_lshrrev_b32 v28, 1, v29
v_lshl_add_u32 v27, v28, 5, v27
v_and_b32 v28, 1, v29
v_lshl_add_u32 v27, v28, 3, v27
v_add_u32 v13, 128, v27
v_add_u32 v14, 49152, v11
v_add_u32 v15, 49152, v12
v_add_u32 v16, 49152, v13
v_add_u32 v17, 98304, v11
v_add_u32 v18, 98304, v12
v_add_u32 v19, 98304, v13
v_bfe_u32 v28, v1, 3, 1
v_lshlrev_b32 v28, 6, v28
v_bfe_u32 v29, v1, 1, 2
s_lshl_b32 s43, s48, 3
s_lshl_b32 s44, s63, 2
s_add_u32 s43, s43, s44
v_add3_u32 v28, v28, v29, s43
v_mul_u32_u24 v28, 7168, v28
v_and_b32 v29, 1, v1
v_mul_u32_u24 v29, 188, v29
v_add_u32 v20, v28, v29
s_cmp_lg_u32 s36, 4
s_cbranch_scc1 Lwm_120
s_branch Lst_8_1
Lwr_186:
s_branch Lwe_119
Lwm_120:
s_cmp_lg_u32 s36, 5
s_cbranch_scc1 Lwm_121
s_branch Lst_9_1
Lwr_187:
s_branch Lwe_119
Lwm_121:
s_cmp_lg_u32 s36, 6
s_cbranch_scc1 Lwm_122
s_branch Lst_10_1
Lwr_188:
s_branch Lwe_119
Lwm_122:
s_cmp_lg_u32 s36, 7
s_cbranch_scc1 Lwm_123
s_nop 0
s_branch Lwe_119
Lwm_123:
Lwe_119:
s_barrier
s_cmp_lg_u32 s36, 4
s_cbranch_scc1 Lwm_125
s_branch Lst_11_1
Lwr_190:
s_branch Lwe_124
Lwm_125:
s_cmp_lg_u32 s36, 5
s_cbranch_scc1 Lwm_126
s_branch Lst_12_1
Lwr_191:
s_branch Lwe_124
Lwm_126:
s_cmp_lg_u32 s36, 6
s_cbranch_scc1 Lwm_127
s_branch Lst_13_1
Lwr_192:
s_branch Lwe_124
Lwm_127:
s_cmp_lg_u32 s36, 7
s_cbranch_scc1 Lwm_128
s_branch Lst_14_1
Lwr_193:
s_branch Lwe_124
Lwm_128:
Lwe_124:
s_waitcnt vmcnt(0) lgkmcnt(0)
s_barrier
ds_read_b128 v[32:35], v9 offset:0
ds_read_b64_tr_b16 v[48:49], v11 offset:0
ds_read_b64_tr_b16 v[50:51], v11 offset:3072
ds_read_b64_tr_b16 v[52:53], v12 offset:0
ds_read_b64_tr_b16 v[54:55], v12 offset:3072
ds_read_b64_tr_b16 v[56:57], v13 offset:0
ds_read_b64_tr_b16 v[58:59], v13 offset:3072
ds_read_b64_tr_b16 v[60:61], v11 offset:12288
ds_read_b64_tr_b16 v[62:63], v11 offset:15360
ds_read_b64_tr_b16 v[64:65], v12 offset:12288
ds_read_b64_tr_b16 v[66:67], v12 offset:15360
ds_read_b64_tr_b16 v[68:69], v13 offset:12288
ds_read_b64_tr_b16 v[70:71], v13 offset:15360
ds_read_b128 v[36:39], v9 offset:1024
ds_read_b128 v[40:43], v9 offset:2048
ds_read_b128 v[44:47], v9 offset:3072
s_waitcnt lgkmcnt(0)
v_mfma_f32_16x16x32_bf16 v[128:131], v[48:51], v[32:35], 0
ds_read_b128 v[72:75], v9 offset:8192
v_mfma_f32_16x16x32_bf16 v[132:135], v[52:55], v[32:35], 0
ds_read_b64_tr_b16 v[88:89], v11 offset:6144
v_mfma_f32_16x16x32_bf16 v[136:139], v[56:59], v[32:35], 0
ds_read_b64_tr_b16 v[90:91], v11 offset:9216
v_mfma_f32_16x16x32_bf16 v[140:143], v[60:63], v[32:35], 0
ds_read_b64_tr_b16 v[92:93], v12 offset:6144
v_mfma_f32_16x16x32_bf16 v[144:147], v[64:67], v[32:35], 0
ds_read_b64_tr_b16 v[94:95], v12 offset:9216
v_mfma_f32_16x16x32_bf16 v[148:151], v[68:71], v[32:35], 0
ds_read_b64_tr_b16 v[96:97], v13 offset:6144
v_mfma_f32_16x16x32_bf16 v[172:175], v[68:71], v[36:39], 0
ds_read_b64_tr_b16 v[98:99], v13 offset:9216
v_mfma_f32_16x16x32_bf16 v[168:171], v[64:67], v[36:39], 0
ds_read_b64_tr_b16 v[100:101], v11 offset:18432
v_mfma_f32_16x16x32_bf16 v[164:167], v[60:63], v[36:39], 0
ds_read_b64_tr_b16 v[102:103], v11 offset:21504
v_mfma_f32_16x16x32_bf16 v[160:163], v[56:59], v[36:39], 0
ds_read_b64_tr_b16 v[104:105], v12 offset:18432
v_mfma_f32_16x16x32_bf16 v[156:159], v[52:55], v[36:39], 0
ds_read_b64_tr_b16 v[106:107], v12 offset:21504
v_mfma_f32_16x16x32_bf16 v[152:155], v[48:51], v[36:39], 0
ds_read_b64_tr_b16 v[108:109], v13 offset:18432
v_mfma_f32_16x16x32_bf16 v[176:179], v[48:51], v[40:43], 0
ds_read_b64_tr_b16 v[110:111], v13 offset:21504
v_mfma_f32_16x16x32_bf16 v[180:183], v[52:55], v[40:43], 0
ds_read_b128 v[76:79], v9 offset:9216
v_mfma_f32_16x16x32_bf16 v[184:187], v[56:59], v[40:43], 0
ds_read_b128 v[80:83], v9 offset:10240
v_mfma_f32_16x16x32_bf16 v[188:191], v[60:63], v[40:43], 0
ds_read_b128 v[84:87], v9 offset:11264
v_mfma_f32_16x16x32_bf16 v[192:195], v[64:67], v[40:43], 0
v_mfma_f32_16x16x32_bf16 v[196:199], v[68:71], v[40:43], 0
v_mfma_f32_16x16x32_bf16 v[220:223], v[68:71], v[44:47], 0
v_mfma_f32_16x16x32_bf16 v[216:219], v[64:67], v[44:47], 0
v_mfma_f32_16x16x32_bf16 v[212:215], v[60:63], v[44:47], 0
v_mfma_f32_16x16x32_bf16 v[208:211], v[56:59], v[44:47], 0
v_mfma_f32_16x16x32_bf16 v[204:207], v[52:55], v[44:47], 0
v_mfma_f32_16x16x32_bf16 v[200:203], v[48:51], v[44:47], 0
s_waitcnt lgkmcnt(0)
s_barrier
v_mfma_f32_16x16x32_bf16 v[128:131], v[88:91], v[72:75], v[128:131]
ds_read_b128 v[32:35], v9 offset:49152
v_mfma_f32_16x16x32_bf16 v[132:135], v[92:95], v[72:75], v[132:135]
ds_read_b64_tr_b16 v[48:49], v14 offset:0
v_mfma_f32_16x16x32_bf16 v[136:139], v[96:99], v[72:75], v[136:139]
ds_read_b64_tr_b16 v[50:51], v14 offset:3072
v_mfma_f32_16x16x32_bf16 v[140:143], v[100:103], v[72:75], v[140:143]
ds_read_b64_tr_b16 v[52:53], v15 offset:0
v_mfma_f32_16x16x32_bf16 v[144:147], v[104:107], v[72:75], v[144:147]
ds_read_b64_tr_b16 v[54:55], v15 offset:3072
v_mfma_f32_16x16x32_bf16 v[148:151], v[108:111], v[72:75], v[148:151]
ds_read_b64_tr_b16 v[56:57], v16 offset:0
v_mfma_f32_16x16x32_bf16 v[172:175], v[108:111], v[76:79], v[172:175]
ds_read_b64_tr_b16 v[58:59], v16 offset:3072
v_mfma_f32_16x16x32_bf16 v[168:171], v[104:107], v[76:79], v[168:171]
ds_read_b64_tr_b16 v[60:61], v14 offset:12288
v_mfma_f32_16x16x32_bf16 v[164:167], v[100:103], v[76:79], v[164:167]
ds_read_b64_tr_b16 v[62:63], v14 offset:15360
v_mfma_f32_16x16x32_bf16 v[160:163], v[96:99], v[76:79], v[160:163]
ds_read_b64_tr_b16 v[64:65], v15 offset:12288
v_mfma_f32_16x16x32_bf16 v[156:159], v[92:95], v[76:79], v[156:159]
ds_read_b64_tr_b16 v[66:67], v15 offset:15360
v_mfma_f32_16x16x32_bf16 v[152:155], v[88:91], v[76:79], v[152:155]
ds_read_b64_tr_b16 v[68:69], v16 offset:12288
v_mfma_f32_16x16x32_bf16 v[176:179], v[88:91], v[80:83], v[176:179]
ds_read_b64_tr_b16 v[70:71], v16 offset:15360
v_mfma_f32_16x16x32_bf16 v[180:183], v[92:95], v[80:83], v[180:183]
ds_read_b128 v[36:39], v9 offset:50176
v_mfma_f32_16x16x32_bf16 v[184:187], v[96:99], v[80:83], v[184:187]
ds_read_b128 v[40:43], v9 offset:51200
v_mfma_f32_16x16x32_bf16 v[188:191], v[100:103], v[80:83], v[188:191]
ds_read_b128 v[44:47], v9 offset:52224
v_mfma_f32_16x16x32_bf16 v[192:195], v[104:107], v[80:83], v[192:195]
v_mfma_f32_16x16x32_bf16 v[196:199], v[108:111], v[80:83], v[196:199]
v_mfma_f32_16x16x32_bf16 v[220:223], v[108:111], v[84:87], v[220:223]
v_mfma_f32_16x16x32_bf16 v[216:219], v[104:107], v[84:87], v[216:219]
v_mfma_f32_16x16x32_bf16 v[212:215], v[100:103], v[84:87], v[212:215]
v_mfma_f32_16x16x32_bf16 v[208:211], v[96:99], v[84:87], v[208:211]
v_mfma_f32_16x16x32_bf16 v[204:207], v[92:95], v[84:87], v[204:207]
v_mfma_f32_16x16x32_bf16 v[200:203], v[88:91], v[84:87], v[200:203]
s_mov_b32 s41, 5
Lk3l_129:
s_waitcnt lgkmcnt(0)
v_mfma_f32_16x16x32_bf16 v[128:131], v[48:51], v[32:35], v[128:131]
ds_read_b128 v[72:75], v9 offset:57344
v_mfma_f32_16x16x32_bf16 v[132:135], v[52:55], v[32:35], v[132:135]
ds_read_b64_tr_b16 v[88:89], v14 offset:6144
v_mfma_f32_16x16x32_bf16 v[136:139], v[56:59], v[32:35], v[136:139]
ds_read_b64_tr_b16 v[90:91], v14 offset:9216
v_mfma_f32_16x16x32_bf16 v[140:143], v[60:63], v[32:35], v[140:143]
ds_read_b64_tr_b16 v[92:93], v15 offset:6144
v_mfma_f32_16x16x32_bf16 v[144:147], v[64:67], v[32:35], v[144:147]
ds_read_b64_tr_b16 v[94:95], v15 offset:9216
v_mfma_f32_16x16x32_bf16 v[148:151], v[68:71], v[32:35], v[148:151]
ds_read_b64_tr_b16 v[96:97], v16 offset:6144
v_mfma_f32_16x16x32_bf16 v[172:175], v[68:71], v[36:39], v[172:175]
ds_read_b64_tr_b16 v[98:99], v16 offset:9216
v_mfma_f32_16x16x32_bf16 v[168:171], v[64:67], v[36:39], v[168:171]
ds_read_b64_tr_b16 v[100:101], v14 offset:18432
v_mfma_f32_16x16x32_bf16 v[164:167], v[60:63], v[36:39], v[164:167]
s_branch Lov_8
.p2align 12
.fill 64, 4, 0xbf800000
Lst_8_0:
s_branch Lwr_175
Lst_8_1:
s_branch Lwr_186
s_nop 0
Lov_8:
ds_read_b64_tr_b16 v[102:103], v14 offset:21504
v_mfma_f32_16x16x32_bf16 v[160:163], v[56:59], v[36:39], v[160:163]
ds_read_b64_tr_b16 v[104:105], v15 offset:18432
v_mfma_f32_16x16x32_bf16 v[156:159], v[52:55], v[36:39], v[156:159]
ds_read_b64_tr_b16 v[106:107], v15 offset:21504
v_mfma_f32_16x16x32_bf16 v[152:155], v[48:51], v[36:39], v[152:155]
ds_read_b64_tr_b16 v[108:109], v16 offset:18432
v_mfma_f32_16x16x32_bf16 v[176:179], v[48:51], v[40:43], v[176:179]
ds_read_b64_tr_b16 v[110:111], v16 offset:21504
v_mfma_f32_16x16x32_bf16 v[180:183], v[52:55], v[40:43], v[180:183]
ds_read_b128 v[76:79], v9 offset:58368
v_mfma_f32_16x16x32_bf16 v[184:187], v[56:59], v[40:43], v[184:187]
ds_read_b128 v[80:83], v9 offset:59392
v_mfma_f32_16x16x32_bf16 v[188:191], v[60:63], v[40:43], v[188:191]
ds_read_b128 v[84:87], v9 offset:60416
v_mfma_f32_16x16x32_bf16 v[192:195], v[64:67], v[40:43], v[192:195]
v_mfma_f32_16x16x32_bf16 v[196:199], v[68:71], v[40:43], v[196:199]
v_mfma_f32_16x16x32_bf16 v[220:223], v[68:71], v[44:47], v[220:223]
v_mfma_f32_16x16x32_bf16 v[216:219], v[64:67], v[44:47], v[216:219]
v_mfma_f32_16x16x32_bf16 v[212:215], v[60:63], v[44:47], v[212:215]
v_mfma_f32_16x16x32_bf16 v[208:211], v[56:59], v[44:47], v[208:211]
v_mfma_f32_16x16x32_bf16 v[204:207], v[52:55], v[44:47], v[204:207]
v_mfma_f32_16x16x32_bf16 v[200:203], v[48:51], v[44:47], v[200:203]
s_waitcnt lgkmcnt(0)
s_barrier
v_mfma_f32_16x16x32_bf16 v[128:131], v[88:91], v[72:75], v[128:131]
ds_read_b128 v[32:35], v10 offset:0
v_mfma_f32_16x16x32_bf16 v[132:135], v[92:95], v[72:75], v[132:135]
ds_read_b64_tr_b16 v[48:49], v17 offset:0
v_mfma_f32_16x16x32_bf16 v[136:139], v[96:99], v[72:75], v[136:139]
ds_read_b64_tr_b16 v[50:51], v17 offset:3072
v_mfma_f32_16x16x32_bf16 v[140:143], v[100:103], v[72:75], v[140:143]
ds_read_b64_tr_b16 v[52:53], v18 offset:0
v_mfma_f32_16x16x32_bf16 v[144:147], v[104:107], v[72:75], v[144:147]
ds_read_b64_tr_b16 v[54:55], v18 offset:3072
v_mfma_f32_16x16x32_bf16 v[148:151], v[108:111], v[72:75], v[148:151]
ds_read_b64_tr_b16 v[56:57], v19 offset:0
v_mfma_f32_16x16x32_bf16 v[172:175], v[108:111], v[76:79], v[172:175]
ds_read_b64_tr_b16 v[58:59], v19 offset:3072
v_mfma_f32_16x16x32_bf16 v[168:171], v[104:107], v[76:79], v[168:171]
ds_read_b64_tr_b16 v[60:61], v17 offset:12288
v_mfma_f32_16x16x32_bf16 v[164:167], v[100:103], v[76:79], v[164:167]
ds_read_b64_tr_b16 v[62:63], v17 offset:15360
v_mfma_f32_16x16x32_bf16 v[160:163], v[96:99], v[76:79], v[160:163]
ds_read_b64_tr_b16 v[64:65], v18 offset:12288
v_mfma_f32_16x16x32_bf16 v[156:159], v[92:95], v[76:79], v[156:159]
ds_read_b64_tr_b16 v[66:67], v18 offset:15360
v_mfma_f32_16x16x32_bf16 v[152:155], v[88:91], v[76:79], v[152:155]
ds_read_b64_tr_b16 v[68:69], v19 offset:12288
v_mfma_f32_16x16x32_bf16 v[176:179], v[88:91], v[80:83], v[176:179]
ds_read_b64_tr_b16 v[70:71], v19 offset:15360
v_mfma_f32_16x16x32_bf16 v[180:183], v[92:95], v[80:83], v[180:183]
ds_read_b128 v[36:39], v10 offset:1024
v_mfma_f32_16x16x32_bf16 v[184:187], v[96:99], v[80:83], v[184:187]
ds_read_b128 v[40:43], v10 offset:2048
v_mfma_f32_16x16x32_bf16 v[188:191], v[100:103], v[80:83], v[188:191]
ds_read_b128 v[44:47], v10 offset:3072
v_mfma_f32_16x16x32_bf16 v[192:195], v[104:107], v[80:83], v[192:195]
v_mfma_f32_16x16x32_bf16 v[196:199], v[108:111], v[80:83], v[196:199]
v_mfma_f32_16x16x32_bf16 v[220:223], v[108:111], v[84:87], v[220:223]
v_mfma_f32_16x16x32_bf16 v[216:219], v[104:107], v[84:87], v[216:219]
v_mfma_f32_16x16x32_bf16 v[212:215], v[100:103], v[84:87], v[212:215]
v_mfma_f32_16x16x32_bf16 v[208:211], v[96:99], v[84:87], v[208:211]
v_mfma_f32_16x16x32_bf16 v[204:207], v[92:95], v[84:87], v[204:207]
v_mfma_f32_16x16x32_bf16 v[200:203], v[88:91], v[84:87], v[200:203]
s_waitcnt lgkmcnt(0)
v_mfma_f32_16x16x32_bf16 v[128:131], v[48:51], v[32:35], v[128:131]
ds_read_b128 v[72:75], v10 offset:8192
v_mfma_f32_16x16x32_bf16 v[132:135], v[52:55], v[32:35], v[132:135]
ds_read_b64_tr_b16 v[88:89], v17 offset:6144
v_mfma_f32_16x16x32_bf16 v[136:139], v[56:59], v[32:35], v[136:139]
ds_read_b64_tr_b16 v[90:91], v17 offset:9216
v_mfma_f32_16x16x32_bf16 v[140:143], v[60:63], v[32:35], v[140:143]
ds_read_b64_tr_b16 v[92:93], v18 offset:6144
v_mfma_f32_16x16x32_bf16 v[144:147], v[64:67], v[32:35], v[144:147]
ds_read_b64_tr_b16 v[94:95], v18 offset:9216
v_mfma_f32_16x16x32_bf16 v[148:151], v[68:71], v[32:35], v[148:151]
ds_read_b64_tr_b16 v[96:97], v19 offset:6144
v_mfma_f32_16x16x32_bf16 v[172:175], v[68:71], v[36:39], v[172:175]
ds_read_b64_tr_b16 v[98:99], v19 offset:9216
v_mfma_f32_16x16x32_bf16 v[168:171], v[64:67], v[36:39], v[168:171]
ds_read_b64_tr_b16 v[100:101], v17 offset:18432
v_mfma_f32_16x16x32_bf16 v[164:167], v[60:63], v[36:39], v[164:167]
ds_read_b64_tr_b16 v[102:103], v17 offset:21504
v_mfma_f32_16x16x32_bf16 v[160:163], v[56:59], v[36:39], v[160:163]
ds_read_b64_tr_b16 v[104:105], v18 offset:18432
v_mfma_f32_16x16x32_bf16 v[156:159], v[52:55], v[36:39], v[156:159]
ds_read_b64_tr_b16 v[106:107], v18 offset:21504
v_mfma_f32_16x16x32_bf16 v[152:155], v[48:51], v[36:39], v[152:155]
ds_read_b64_tr_b16 v[108:109], v19 offset:18432
v_mfma_f32_16x16x32_bf16 v[176:179], v[48:51], v[40:43], v[176:179]
ds_read_b64_tr_b16 v[110:111], v19 offset:21504
v_mfma_f32_16x16x32_bf16 v[180:183], v[52:55], v[40:43], v[180:183]
ds_read_b128 v[76:79], v10 offset:9216
v_mfma_f32_16x16x32_bf16 v[184:187], v[56:59], v[40:43], v[184:187]
ds_read_b128 v[80:83], v10 offset:10240
v_mfma_f32_16x16x32_bf16 v[188:191], v[60:63], v[40:43], v[188:191]
ds_read_b128 v[84:87], v10 offset:11264
v_mfma_f32_16x16x32_bf16 v[192:195], v[64:67], v[40:43], v[192:195]
v_mfma_f32_16x16x32_bf16 v[196:199], v[68:71], v[40:43], v[196:199]
v_mfma_f32_16x16x32_bf16 v[220:223], v[68:71], v[44:47], v[220:223]
v_mfma_f32_16x16x32_bf16 v[216:219], v[64:67], v[44:47], v[216:219]
v_mfma_f32_16x16x32_bf16 v[212:215], v[60:63], v[44:47], v[212:215]
v_mfma_f32_16x16x32_bf16 v[208:211], v[56:59], v[44:47], v[208:211]
v_mfma_f32_16x16x32_bf16 v[204:207], v[52:55], v[44:47], v[204:207]
v_mfma_f32_16x16x32_bf16 v[200:203], v[48:51], v[44:47], v[200:203]
s_waitcnt lgkmcnt(0)
s_barrier
v_mfma_f32_16x16x32_bf16 v[128:131], v[88:91], v[72:75], v[128:131]
ds_read_b128 v[32:35], v9 offset:0
v_mfma_f32_16x16x32_bf16 v[132:135], v[92:95], v[72:75], v[132:135]
ds_read_b64_tr_b16 v[48:49], v11 offset:0
v_mfma_f32_16x16x32_bf16 v[136:139], v[96:99], v[72:75], v[136:139]
ds_read_b64_tr_b16 v[50:51], v11 offset:3072
v_mfma_f32_16x16x32_bf16 v[140:143], v[100:103], v[72:75], v[140:143]
ds_read_b64_tr_b16 v[52:53], v12 offset:0
v_mfma_f32_16x16x32_bf16 v[144:147], v[104:107], v[72:75], v[144:147]
ds_read_b64_tr_b16 v[54:55], v12 offset:3072
v_mfma_f32_16x16x32_bf16 v[148:151], v[108:111], v[72:75], v[148:151]
ds_read_b64_tr_b16 v[56:57], v13 offset:0
v_mfma_f32_16x16x32_bf16 v[172:175], v[108:111], v[76:79], v[172:175]
ds_read_b64_tr_b16 v[58:59], v13 offset:3072
v_mfma_f32_16x16x32_bf16 v[168:171], v[104:107], v[76:79], v[168:171]
ds_read_b64_tr_b16 v[60:61], v11 offset:12288
v_mfma_f32_16x16x32_bf16 v[164:167], v[100:103], v[76:79], v[164:167]
ds_read_b64_tr_b16 v[62:63], v11 offset:15360
v_mfma_f32_16x16x32_bf16 v[160:163], v[96:99], v[76:79], v[160:163]
ds_read_b64_tr_b16 v[64:65], v12 offset:12288
v_mfma_f32_16x16x32_bf16 v[156:159], v[92:95], v[76:79], v[156:159]
ds_read_b64_tr_b16 v[66:67], v12 offset:15360
v_mfma_f32_16x16x32_bf16 v[152:155], v[88:91], v[76:79], v[152:155]
ds_read_b64_tr_b16 v[68:69], v13 offset:12288
v_mfma_f32_16x16x32_bf16 v[176:179], v[88:91], v[80:83], v[176:179]
ds_read_b64_tr_b16 v[70:71], v13 offset:15360
v_mfma_f32_16x16x32_bf16 v[180:183], v[92:95], v[80:83], v[180:183]
ds_read_b128 v[36:39], v9 offset:1024
v_mfma_f32_16x16x32_bf16 v[184:187], v[96:99], v[80:83], v[184:187]
ds_read_b128 v[40:43], v9 offset:2048
v_mfma_f32_16x16x32_bf16 v[188:191], v[100:103], v[80:83], v[188:191]
ds_read_b128 v[44:47], v9 offset:3072
v_mfma_f32_16x16x32_bf16 v[192:195], v[104:107], v[80:83], v[192:195]
v_mfma_f32_16x16x32_bf16 v[196:199], v[108:111], v[80:83], v[196:199]
v_mfma_f32_16x16x32_bf16 v[220:223], v[108:111], v[84:87], v[220:223]
v_mfma_f32_16x16x32_bf16 v[216:219], v[104:107], v[84:87], v[216:219]
v_mfma_f32_16x16x32_bf16 v[212:215], v[100:103], v[84:87], v[212:215]
v_mfma_f32_16x16x32_bf16 v[208:211], v[96:99], v[84:87], v[208:211]
v_mfma_f32_16x16x32_bf16 v[204:207], v[92:95], v[84:87], v[204:207]
v_mfma_f32_16x16x32_bf16 v[200:203], v[88:91], v[84:87], v[200:203]
s_waitcnt lgkmcnt(0)
v_mfma_f32_16x16x32_bf16 v[128:131], v[48:51], v[32:35], v[128:131]
ds_read_b128 v[72:75], v9 offset:8192
v_mfma_f32_16x16x32_bf16 v[132:135], v[52:55], v[32:35], v[132:135]
ds_read_b64_tr_b16 v[88:89], v11 offset:6144
v_mfma_f32_16x16x32_bf16 v[136:139], v[56:59], v[32:35], v[136:139]
ds_read_b64_tr_b16 v[90:91], v11 offset:9216
v_mfma_f32_16x16x32_bf16 v[140:143], v[60:63], v[32:35], v[140:143]
ds_read_b64_tr_b16 v[92:93], v12 offset:6144
v_mfma_f32_16x16x32_bf16 v[144:147], v[64:67], v[32:35], v[144:147]
ds_read_b64_tr_b16 v[94:95], v12 offset:9216
v_mfma_f32_16x16x32_bf16 v[148:151], v[68:71], v[32:35], v[148:151]
ds_read_b64_tr_b16 v[96:97], v13 offset:6144
v_mfma_f32_16x16x32_bf16 v[172:175], v[68:71], v[36:39], v[172:175]
ds_read_b64_tr_b16 v[98:99], v13 offset:9216
v_mfma_f32_16x16x32_bf16 v[168:171], v[64:67], v[36:39], v[168:171]
ds_read_b64_tr_b16 v[100:101], v11 offset:18432
v_mfma_f32_16x16x32_bf16 v[164:167], v[60:63], v[36:39], v[164:167]
ds_read_b64_tr_b16 v[102:103], v11 offset:21504
v_mfma_f32_16x16x32_bf16 v[160:163], v[56:59], v[36:39], v[160:163]
ds_read_b64_tr_b16 v[104:105], v12 offset:18432
v_mfma_f32_16x16x32_bf16 v[156:159], v[52:55], v[36:39], v[156:159]
ds_read_b64_tr_b16 v[106:107], v12 offset:21504
v_mfma_f32_16x16x32_bf16 v[152:155], v[48:51], v[36:39], v[152:155]
ds_read_b64_tr_b16 v[108:109], v13 offset:18432
v_mfma_f32_16x16x32_bf16 v[176:179], v[48:51], v[40:43], v[176:179]
ds_read_b64_tr_b16 v[110:111], v13 offset:21504
v_mfma_f32_16x16x32_bf16 v[180:183], v[52:55], v[40:43], v[180:183]
ds_read_b128 v[76:79], v9 offset:9216
v_mfma_f32_16x16x32_bf16 v[184:187], v[56:59], v[40:43], v[184:187]
ds_read_b128 v[80:83], v9 offset:10240
v_mfma_f32_16x16x32_bf16 v[188:191], v[60:63], v[40:43], v[188:191]
ds_read_b128 v[84:87], v9 offset:11264
v_mfma_f32_16x16x32_bf16 v[192:195], v[64:67], v[40:43], v[192:195]
v_mfma_f32_16x16x32_bf16 v[196:199], v[68:71], v[40:43], v[196:199]
v_mfma_f32_16x16x32_bf16 v[220:223], v[68:71], v[44:47], v[220:223]
v_mfma_f32_16x16x32_bf16 v[216:219], v[64:67], v[44:47], v[216:219]
v_mfma_f32_16x16x32_bf16 v[212:215], v[60:63], v[44:47], v[212:215]
v_mfma_f32_16x16x32_bf16 v[208:211], v[56:59], v[44:47], v[208:211]
v_mfma_f32_16x16x32_bf16 v[204:207], v[52:55], v[44:47], v[204:207]
v_mfma_f32_16x16x32_bf16 v[200:203], v[48:51], v[44:47], v[200:203]
s_waitcnt lgkmcnt(0)
s_barrier
v_mfma_f32_16x16x32_bf16 v[128:131], v[88:91], v[72:75], v[128:131]
ds_read_b128 v[32:35], v9 offset:49152
v_mfma_f32_16x16x32_bf16 v[132:135], v[92:95], v[72:75], v[132:135]
ds_read_b64_tr_b16 v[48:49], v14 offset:0
v_mfma_f32_16x16x32_bf16 v[136:139], v[96:99], v[72:75], v[136:139]
ds_read_b64_tr_b16 v[50:51], v14 offset:3072
v_mfma_f32_16x16x32_bf16 v[140:143], v[100:103], v[72:75], v[140:143]
ds_read_b64_tr_b16 v[52:53], v15 offset:0
v_mfma_f32_16x16x32_bf16 v[144:147], v[104:107], v[72:75], v[144:147]
ds_read_b64_tr_b16 v[54:55], v15 offset:3072
v_mfma_f32_16x16x32_bf16 v[148:151], v[108:111], v[72:75], v[148:151]
ds_read_b64_tr_b16 v[56:57], v16 offset:0
v_mfma_f32_16x16x32_bf16 v[172:175], v[108:111], v[76:79], v[172:175]
ds_read_b64_tr_b16 v[58:59], v16 offset:3072
v_mfma_f32_16x16x32_bf16 v[168:171], v[104:107], v[76:79], v[168:171]
ds_read_b64_tr_b16 v[60:61], v14 offset:12288
v_mfma_f32_16x16x32_bf16 v[164:167], v[100:103], v[76:79], v[164:167]
ds_read_b64_tr_b16 v[62:63], v14 offset:15360
v_mfma_f32_16x16x32_bf16 v[160:163], v[96:99], v[76:79], v[160:163]
ds_read_b64_tr_b16 v[64:65], v15 offset:12288
v_mfma_f32_16x16x32_bf16 v[156:159], v[92:95], v[76:79], v[156:159]
ds_read_b64_tr_b16 v[66:67], v15 offset:15360
v_mfma_f32_16x16x32_bf16 v[152:155], v[88:91], v[76:79], v[152:155]
ds_read_b64_tr_b16 v[68:69], v16 offset:12288
v_mfma_f32_16x16x32_bf16 v[176:179], v[88:91], v[80:83], v[176:179]
ds_read_b64_tr_b16 v[70:71], v16 offset:15360
v_mfma_f32_16x16x32_bf16 v[180:183], v[92:95], v[80:83], v[180:183]
ds_read_b128 v[36:39], v9 offset:50176
v_mfma_f32_16x16x32_bf16 v[184:187], v[96:99], v[80:83], v[184:187]
ds_read_b128 v[40:43], v9 offset:51200
v_mfma_f32_16x16x32_bf16 v[188:191], v[100:103], v[80:83], v[188:191]
ds_read_b128 v[44:47], v9 offset:52224
v_mfma_f32_16x16x32_bf16 v[192:195], v[104:107], v[80:83], v[192:195]
v_mfma_f32_16x16x32_bf16 v[196:199], v[108:111], v[80:83], v[196:199]
v_mfma_f32_16x16x32_bf16 v[220:223], v[108:111], v[84:87], v[220:223]
v_mfma_f32_16x16x32_bf16 v[216:219], v[104:107], v[84:87], v[216:219]
v_mfma_f32_16x16x32_bf16 v[212:215], v[100:103], v[84:87], v[212:215]
v_mfma_f32_16x16x32_bf16 v[208:211], v[96:99], v[84:87], v[208:211]
v_mfma_f32_16x16x32_bf16 v[204:207], v[92:95], v[84:87], v[204:207]
v_mfma_f32_16x16x32_bf16 v[200:203], v[88:91], v[84:87], v[200:203]
s_sub_u32 s41, s41, 1
s_cmp_lg_u32 s41, 0
s_cbranch_scc1 Lk3l_129
s_waitcnt lgkmcnt(0)
s_mov_b32 s28, s76
s_mov_b32 s29, s77
s_mov_b32 s30, 7340032
s_mov_b32 s31, 0x20000
s_add_u32 s37, s35, 2
s_and_b32 s37, s37, 15
s_mul_i32 s37, s37, 16384
s_add_u32 m0, s39, 0
s_nop 0
buffer_load_dwordx4 v3, s[8:11], s37 offen sc1 lds
v_lshrrev_b32 v86, 4, v1
s_lshl_b32 s43, s63, 7
s_add_u32 s43, s43, 148992
buffer_load_dwordx4 v3, s[8:11], s37 offen offset:1024 sc1 lds
v_lshl_add_u32 v87, v86, 4, s43
v_lshrrev_b32 v88, 1, v86
v_and_b32 v86, 1, v86
s_lshl_b32 s43, s63, 5
buffer_load_dwordx4 v3, s[8:11], s37 offen offset:2048 sc1 lds
s_add_u32 s43, s43, 149248
v_lshl_add_u32 v88, v88, 6, s43
v_lshl_add_u32 v88, v86, 4, v88
v_and_b32 v86, 15, v1
buffer_load_dwordx4 v3, s[8:11], s37 offen offset:3072 sc1 lds
s_lshl_b32 s43, s62, 9
s_add_u32 s43, s43, 147456
v_lshl_add_u32 v86, v86, 3, s43
s_add_u32 s38, s35, 2
s_and_b32 s38, s38, 15
s_mul_i32 s38, s38, 458752
s_add_u32 m0, s40, 0
s_nop 0
buffer_load_dwordx4 v4, s[12:15], s38 offen lds
ds_read_b128 v[32:35], v87 offset:0
ds_read_b128 v[36:39], v87 offset:64
ds_read_b128 v[40:43], v88 offset:0
ds_read_b128 v[44:47], v87 offset:896
s_add_u32 m0, s40, 1024
s_nop 0
buffer_load_dwordx4 v5, s[12:15], s38 offen lds
ds_read_b128 v[48:51], v87 offset:960
ds_read_b128 v[52:55], v88 offset:896
ds_read_b64 v[56:57], v86 offset:0
ds_read_b64 v[58:59], v86 offset:128
s_add_u32 m0, s40, 2048
s_add_u32 s38, s38, 57344
buffer_load_dwordx4 v4, s[12:15], s38 offen lds
ds_read_b64 v[60:61], v86 offset:256
ds_read_b64 v[62:63], v86 offset:384
s_mul_i32 s54, s35, 24576
s_add_u32 m0, s40, 3072
s_nop 0
buffer_load_dwordx4 v5, s[12:15], s38 offen lds
s_lshl_b32 s43, s62, 12
s_add_u32 s54, s54, s43
s_add_u32 s54, s54, 524288
s_lshl_b32 s43, s63, 9
s_add_u32 m0, s40, 4096
s_add_u32 s38, s38, 57344
buffer_load_dwordx4 v4, s[12:15], s38 offen lds
s_add_u32 s55, s54, s43
s_add_u32 s55, s55, 16384
s_lshl_b32 s43, s63, 13
s_add_u32 s54, s54, s43
s_add_u32 m0, s40, 5120
s_nop 0
buffer_load_dwordx4 v5, s[12:15], s38 offen lds
v_and_b32 v84, 32, v1
v_lshlrev_b32 v84, 4, v84
v_add_u32 v84, v84, v2
s_waitcnt lgkmcnt(0)
s_add_u32 m0, s40, 6144
s_add_u32 s38, s38, 57344
buffer_load_dwordx4 v4, s[12:15], s38 offen lds
s_add_u32 m0, s40, 7168
s_nop 0
buffer_load_dwordx4 v5, s[12:15], s38 offen lds
s_and_b32 s44, s36, 3
s_mul_i32 s43, s2, 28672
s_mul_i32 s44, s44, 7168
s_add_u32 s43, s43, s44
s_add_u32 s4, s76, s43
s_addc_u32 s5, s77, 0
s_barrier
s_cmp_eq_u32 s47, 3
s_cbranch_scc0 Lw_130
v_and_b32 v30, 31, v1
v_lshlrev_b32 v30, 4, v30
v_add_u32 v31, 153600, v30
ds_read_b128 v[108:111], v31 offset:0
ds_read_b128 v[112:115], v31 offset:512
ds_read_b128 v[116:119], v31 offset:1024
ds_read_b128 v[120:123], v31 offset:1536
s_and_b32 s44, s2, 15
s_mul_i32 s44, s44, 14336
s_lshr_b32 s43, s2, 4
s_lshl_b32 s43, s43, 9
s_add_u32 s44, s44, s43
s_waitcnt lgkmcnt(0)
v_add_f32 v108, v108, v112
v_add_f32 v116, v116, v120
v_add_f32 v109, v109, v113
v_add_f32 v117, v117, v121
v_add_f32 v110, v110, v114
v_add_f32 v118, v118, v122
v_add_f32 v111, v111, v115
v_add_f32 v119, v119, v123
v_add_f32 v108, v108, v116
v_add_f32 v109, v109, v117
v_add_f32 v110, v110, v118
v_add_f32 v111, v111, v119
s_mov_b64 exec, 0xffffffff
buffer_store_dwordx4 v[108:111], v30, s[84:87], s44 offen sc1
s_mov_b64 exec, -1
Lw_130:
s_waitcnt lgkmcnt(0)
s_add_u32 s37, s35, 3
s_and_b32 s37, s37, 15
s_mul_i32 s37, s37, 16384
s_add_u32 m0, s39, 49152
s_nop 0
buffer_load_dwordx4 v3, s[8:11], s37 offen sc1 lds
s_load_dword s3, s[4:5], 1792
s_load_dword s3, s[4:5], 1856
s_load_dword s3, s[4:5], 1920
s_load_dword s3, s[4:5], 1984
s_load_dword s3, s[4:5], 2048
s_load_dword s3, s[4:5], 2112
s_load_dword s3, s[4:5], 2176
buffer_load_dwordx4 v3, s[8:11], s37 offen offset:1024 sc1 lds
s_load_dword s3, s[4:5], 2240
s_load_dword s3, s[4:5], 2304
s_load_dword s3, s[4:5], 2368
s_load_dword s3, s[4:5], 2432
s_load_dword s3, s[4:5], 2496
s_load_dword s3, s[4:5], 2560
s_load_dword s3, s[4:5], 2624
buffer_load_dwordx4 v3, s[8:11], s37 offen offset:2048 sc1 lds
v_mul_f32 v66, v57, v57
v_mul_f32 v64, 0xc0135761, v57
v_mul_f32 v65, 0xbdd2d3e8, v57
v_mul_f32 v65, v65, v66
v_rcp_f32 v66, v66
v_mul_f32 v70, v59, v59
v_mul_f32 v68, 0xc0135761, v59
buffer_load_dwordx4 v3, s[8:11], s37 offen offset:3072 sc1 lds
v_mul_f32 v69, 0xbdd2d3e8, v59
v_mul_f32 v69, v69, v70
v_rcp_f32 v70, v70
v_fma_f32 v128, -v56, v32, v128
v_fma_f32 v129, -v56, v33, v129
v_fma_f32 v130, -v56, v34, v130
v_fma_f32 v131, -v56, v35, v131
v_fma_f32 v152, -v58, v32, v152
s_add_u32 s38, s35, 3
s_and_b32 s38, s38, 15
s_mul_i32 s38, s38, 458752
s_add_u32 m0, s40, 49152
s_nop 0
buffer_load_dwordx4 v4, s[12:15], s38 offen lds
v_fma_f32 v153, -v58, v33, v153
v_fma_f32 v154, -v58, v34, v154
v_fma_f32 v155, -v58, v35, v155
v_mul_f32 v72, v128, v128
v_mul_f32 v73, v129, v129
v_mul_f32 v74, v130, v130
v_mul_f32 v75, v131, v131
s_add_u32 m0, s40, 50176
s_nop 0
buffer_load_dwordx4 v5, s[12:15], s38 offen lds
v_mul_f32 v76, v152, v152
v_mul_f32 v77, v153, v153
v_mul_f32 v78, v154, v154
v_mul_f32 v79, v155, v155
v_fma_f32 v72, v72, v65, v64
v_fma_f32 v73, v73, v65, v64
v_fma_f32 v74, v74, v65, v64
s_add_u32 m0, s40, 51200
s_add_u32 s38, s38, 57344
buffer_load_dwordx4 v4, s[12:15], s38 offen lds
v_fma_f32 v75, v75, v65, v64
v_fma_f32 v76, v76, v69, v68
v_fma_f32 v77, v77, v69, v68
v_fma_f32 v78, v78, v69, v68
v_fma_f32 v79, v79, v69, v68
v_mul_f32 v72, v72, v128
v_mul_f32 v73, v73, v129
v_mul_f32 v74, v74, v130
s_add_u32 m0, s40, 52224
s_nop 0
buffer_load_dwordx4 v5, s[12:15], s38 offen lds
v_mul_f32 v75, v75, v131
v_mul_f32 v76, v76, v152
v_mul_f32 v77, v77, v153
v_mul_f32 v78, v78, v154
v_mul_f32 v79, v79, v155
v_exp_f32 v72, v72
v_exp_f32 v73, v73
s_add_u32 m0, s40, 53248
s_add_u32 s38, s38, 57344
buffer_load_dwordx4 v4, s[12:15], s38 offen lds
v_exp_f32 v74, v74
v_exp_f32 v75, v75
v_exp_f32 v76, v76
v_exp_f32 v77, v77
v_exp_f32 v78, v78
v_exp_f32 v79, v79
v_fma_f32 v140, -v56, v44, v140
s_add_u32 m0, s40, 54272
s_nop 0
buffer_load_dwordx4 v5, s[12:15], s38 offen lds
v_fma_f32 v141, -v56, v45, v141
v_fma_f32 v142, -v56, v46, v142
v_fma_f32 v143, -v56, v47, v143
v_fma_f32 v164, -v58, v44, v164
v_fma_f32 v165, -v58, v45, v165
v_fma_f32 v166, -v58, v46, v166
v_fma_f32 v167, -v58, v47, v167
v_fma_f32 v72, v72, v66, v66
s_add_u32 m0, s40, 55296
s_add_u32 s38, s38, 57344
buffer_load_dwordx4 v4, s[12:15], s38 offen lds
s_add_u32 m0, s40, 56320
s_nop 0
buffer_load_dwordx4 v5, s[12:15], s38 offen lds
s_waitcnt vmcnt(12)
s_barrier
s_add_u32 s37, s35, 4
s_and_b32 s37, s37, 15
s_mul_i32 s37, s37, 16384
s_add_u32 m0, s39, 98304
s_nop 0
buffer_load_dwordx4 v3, s[8:11], s37 offen sc1 lds
v_fma_f32 v73, v73, v66, v66
v_fma_f32 v74, v74, v66, v66
v_fma_f32 v75, v75, v66, v66
v_fma_f32 v76, v76, v70, v70
v_fma_f32 v77, v77, v70, v70
v_fma_f32 v78, v78, v70, v70
buffer_load_dwordx4 v3, s[8:11], s37 offen offset:1024 sc1 lds
v_fma_f32 v79, v79, v70, v70
v_rcp_f32 v72, v72
v_rcp_f32 v73, v73
v_rcp_f32 v74, v74
v_rcp_f32 v75, v75
v_rcp_f32 v76, v76
buffer_load_dwordx4 v3, s[8:11], s37 offen offset:2048 sc1 lds
v_rcp_f32 v77, v77
v_rcp_f32 v78, v78
v_rcp_f32 v79, v79
v_mul_f32 v140, v128, v140
v_mul_f32 v141, v129, v141
v_mul_f32 v142, v130, v142
buffer_load_dwordx4 v3, s[8:11], s37 offen offset:3072 sc1 lds
v_mul_f32 v143, v131, v143
v_mul_f32 v164, v152, v164
v_mul_f32 v165, v153, v165
v_mul_f32 v166, v154, v166
v_mul_f32 v167, v155, v167
v_mul_f32 v140, v140, v72
s_add_u32 s38, s35, 4
s_and_b32 s38, s38, 15
s_mul_i32 s38, s38, 458752
s_add_u32 m0, s40, 98304
s_nop 0
buffer_load_dwordx4 v4, s[12:15], s38 offen lds
v_mul_f32 v141, v141, v73
v_mul_f32 v142, v142, v74
v_mul_f32 v143, v143, v75
v_mul_f32 v164, v164, v76
v_mul_f32 v165, v165, v77
v_mul_f32 v166, v166, v78
s_add_u32 m0, s40, 99328
s_nop 0
buffer_load_dwordx4 v5, s[12:15], s38 offen lds
v_mul_f32 v167, v167, v79
v_cvt_pk_bf16_f32 v128, v140, v141
v_cvt_pk_bf16_f32 v129, v142, v143
v_cvt_pk_bf16_f32 v152, v164, v165
v_cvt_pk_bf16_f32 v153, v166, v167
v_fma_f32 v132, -v56, v36, v132
s_add_u32 m0, s40, 100352
s_add_u32 s38, s38, 57344
buffer_load_dwordx4 v4, s[12:15], s38 offen lds
v_fma_f32 v133, -v56, v37, v133
v_fma_f32 v134, -v56, v38, v134
v_fma_f32 v135, -v56, v39, v135
v_fma_f32 v156, -v58, v36, v156
v_fma_f32 v157, -v58, v37, v157
v_fma_f32 v158, -v58, v38, v158
s_add_u32 m0, s40, 101376
s_nop 0
buffer_load_dwordx4 v5, s[12:15], s38 offen lds
v_fma_f32 v159, -v58, v39, v159
v_mul_f32 v72, v132, v132
v_mul_f32 v73, v133, v133
v_mul_f32 v74, v134, v134
v_mul_f32 v75, v135, v135
v_mul_f32 v76, v156, v156
s_add_u32 m0, s40, 102400
s_add_u32 s38, s38, 57344
buffer_load_dwordx4 v4, s[12:15], s38 offen lds
v_mul_f32 v77, v157, v157
v_mul_f32 v78, v158, v158
v_mul_f32 v79, v159, v159
v_fma_f32 v72, v72, v65, v64
v_fma_f32 v73, v73, v65, v64
v_fma_f32 v74, v74, v65, v64
s_add_u32 m0, s40, 103424
s_nop 0
buffer_load_dwordx4 v5, s[12:15], s38 offen lds
v_fma_f32 v75, v75, v65, v64
v_fma_f32 v76, v76, v69, v68
v_fma_f32 v77, v77, v69, v68
v_fma_f32 v78, v78, v69, v68
v_fma_f32 v79, v79, v69, v68
v_mul_f32 v72, v72, v132
s_add_u32 m0, s40, 104448
s_add_u32 s38, s38, 57344
buffer_load_dwordx4 v4, s[12:15], s38 offen lds
s_add_u32 m0, s40, 105472
s_nop 0
s_branch Lov_9
.p2align 12
.fill 64, 4, 0xbf800000
Lst_9_0:
s_branch Lwr_176
Lst_9_1:
s_branch Lwr_187
s_nop 0
Lov_9:
buffer_load_dwordx4 v5, s[12:15], s38 offen lds
s_waitcnt vmcnt(12)
s_barrier
s_cmp_eq_u32 s47, 3
s_cbranch_scc0 Lw_131
s_lshr_b32 s43, s2, 4
s_add_u32 s43, s43, 80
s_lshl_b32 s43, s43, 7
v_mov_b32 v30, s43
v_mov_b32 v31, 1
s_mov_b64 exec, 1
buffer_atomic_add v31, v30, s[56:59], 0 offen sc1
s_mov_b64 exec, -1
Lw_131:
s_waitcnt lgkmcnt(0)
s_add_u32 s37, s35, 5
s_and_b32 s37, s37, 15
s_mul_i32 s37, s37, 16384
s_add_u32 m0, s39, 0
s_nop 0
buffer_load_dwordx4 v3, s[8:11], s37 offen sc1 lds
s_load_dword s3, s[4:5], 2688
s_load_dword s3, s[4:5], 2752
s_load_dword s3, s[4:5], 2816
s_load_dword s3, s[4:5], 2880
s_load_dword s3, s[4:5], 2944
s_load_dword s3, s[4:5], 3008
s_load_dword s3, s[4:5], 3072
buffer_load_dwordx4 v3, s[8:11], s37 offen offset:1024 sc1 lds
s_load_dword s3, s[4:5], 3136
s_load_dword s3, s[4:5], 3200
s_load_dword s3, s[4:5], 3264
s_load_dword s3, s[4:5], 3328
s_load_dword s3, s[4:5], 3392
s_load_dword s3, s[4:5], 3456
s_load_dword s3, s[4:5], 3520
buffer_load_dwordx4 v3, s[8:11], s37 offen offset:2048 sc1 lds
v_mul_f32 v73, v73, v133
v_mul_f32 v74, v74, v134
v_mul_f32 v75, v75, v135
v_mul_f32 v76, v76, v156
v_mul_f32 v77, v77, v157
v_mul_f32 v78, v78, v158
v_mul_f32 v79, v79, v159
v_exp_f32 v72, v72
buffer_load_dwordx4 v3, s[8:11], s37 offen offset:3072 sc1 lds
v_exp_f32 v73, v73
v_exp_f32 v74, v74
v_exp_f32 v75, v75
v_exp_f32 v76, v76
v_exp_f32 v77, v77
v_exp_f32 v78, v78
v_exp_f32 v79, v79
s_add_u32 s38, s35, 5
s_and_b32 s38, s38, 15
s_mul_i32 s38, s38, 458752
s_add_u32 m0, s40, 0
s_nop 0
buffer_load_dwordx4 v4, s[12:15], s38 offen lds
v_fma_f32 v144, -v56, v48, v144
v_fma_f32 v145, -v56, v49, v145
v_fma_f32 v146, -v56, v50, v146
v_fma_f32 v147, -v56, v51, v147
v_fma_f32 v168, -v58, v48, v168
v_fma_f32 v169, -v58, v49, v169
v_fma_f32 v170, -v58, v50, v170
v_fma_f32 v171, -v58, v51, v171
s_add_u32 m0, s40, 1024
s_nop 0
buffer_load_dwordx4 v5, s[12:15], s38 offen lds
v_fma_f32 v72, v72, v66, v66
v_fma_f32 v73, v73, v66, v66
v_fma_f32 v74, v74, v66, v66
v_fma_f32 v75, v75, v66, v66
v_fma_f32 v76, v76, v70, v70
v_fma_f32 v77, v77, v70, v70
v_fma_f32 v78, v78, v70, v70
s_add_u32 m0, s40, 2048
s_add_u32 s38, s38, 57344
buffer_load_dwordx4 v4, s[12:15], s38 offen lds
v_fma_f32 v79, v79, v70, v70
v_rcp_f32 v72, v72
v_rcp_f32 v73, v73
v_rcp_f32 v74, v74
v_rcp_f32 v75, v75
v_rcp_f32 v76, v76
v_rcp_f32 v77, v77
s_add_u32 m0, s40, 3072
s_nop 0
buffer_load_dwordx4 v5, s[12:15], s38 offen lds
v_rcp_f32 v78, v78
v_rcp_f32 v79, v79
v_mul_f32 v144, v132, v144
v_mul_f32 v145, v133, v145
v_mul_f32 v146, v134, v146
v_mul_f32 v147, v135, v147
v_mul_f32 v168, v156, v168
v_mul_f32 v169, v157, v169
s_add_u32 m0, s40, 4096
s_add_u32 s38, s38, 57344
buffer_load_dwordx4 v4, s[12:15], s38 offen lds
v_mul_f32 v170, v158, v170
v_mul_f32 v171, v159, v171
v_mul_f32 v144, v144, v72
v_mul_f32 v145, v145, v73
v_mul_f32 v146, v146, v74
v_mul_f32 v147, v147, v75
v_mul_f32 v168, v168, v76
s_add_u32 m0, s40, 5120
s_nop 0
buffer_load_dwordx4 v5, s[12:15], s38 offen lds
v_mul_f32 v169, v169, v77
v_mul_f32 v170, v170, v78
v_mul_f32 v171, v171, v79
v_cvt_pk_bf16_f32 v130, v144, v145
v_cvt_pk_bf16_f32 v131, v146, v147
v_cvt_pk_bf16_f32 v154, v168, v169
v_cvt_pk_bf16_f32 v155, v170, v171
buffer_store_dwordx4 v[128:131], v2, s[24:27], s54 offen offset:0 sc1
s_add_u32 m0, s40, 6144
s_add_u32 s38, s38, 57344
buffer_load_dwordx4 v4, s[12:15], s38 offen lds
s_add_u32 m0, s40, 7168
s_nop 0
buffer_load_dwordx4 v5, s[12:15], s38 offen lds
s_waitcnt vmcnt(13)
s_barrier
s_add_u32 s37, s35, 6
s_and_b32 s37, s37, 15
s_mul_i32 s37, s37, 16384
s_add_u32 m0, s39, 49152
s_nop 0
buffer_load_dwordx4 v3, s[8:11], s37 offen sc1 lds
buffer_store_dwordx4 v[152:155], v2, s[24:27], s54 offen offset:1024 sc1
v_fma_f32 v136, -v56, v40, v136
v_fma_f32 v137, -v56, v41, v137
v_fma_f32 v138, -v56, v42, v138
v_fma_f32 v139, -v56, v43, v139
v_fma_f32 v160, -v58, v40, v160
buffer_load_dwordx4 v3, s[8:11], s37 offen offset:1024 sc1 lds
v_fma_f32 v161, -v58, v41, v161
v_fma_f32 v162, -v58, v42, v162
v_fma_f32 v163, -v58, v43, v163
v_mul_f32 v72, v136, v136
v_mul_f32 v73, v137, v137
v_mul_f32 v74, v138, v138
buffer_load_dwordx4 v3, s[8:11], s37 offen offset:2048 sc1 lds
v_mul_f32 v75, v139, v139
v_mul_f32 v76, v160, v160
v_mul_f32 v77, v161, v161
v_mul_f32 v78, v162, v162
v_mul_f32 v79, v163, v163
v_fma_f32 v72, v72, v65, v64
buffer_load_dwordx4 v3, s[8:11], s37 offen offset:3072 sc1 lds
v_fma_f32 v73, v73, v65, v64
v_fma_f32 v74, v74, v65, v64
v_fma_f32 v75, v75, v65, v64
v_fma_f32 v76, v76, v69, v68
v_fma_f32 v77, v77, v69, v68
v_fma_f32 v78, v78, v69, v68
s_add_u32 s38, s35, 6
s_and_b32 s38, s38, 15
s_mul_i32 s38, s38, 458752
s_add_u32 m0, s40, 49152
s_nop 0
buffer_load_dwordx4 v4, s[12:15], s38 offen lds
v_fma_f32 v79, v79, v69, v68
v_mul_f32 v72, v72, v136
v_mul_f32 v73, v73, v137
v_mul_f32 v74, v74, v138
v_mul_f32 v75, v75, v139
v_mul_f32 v76, v76, v160
s_add_u32 m0, s40, 50176
s_nop 0
buffer_load_dwordx4 v5, s[12:15], s38 offen lds
v_mul_f32 v77, v77, v161
v_mul_f32 v78, v78, v162
v_mul_f32 v79, v79, v163
v_exp_f32 v72, v72
v_exp_f32 v73, v73
v_exp_f32 v74, v74
s_add_u32 m0, s40, 51200
s_add_u32 s38, s38, 57344
buffer_load_dwordx4 v4, s[12:15], s38 offen lds
v_exp_f32 v75, v75
v_exp_f32 v76, v76
v_exp_f32 v77, v77
v_exp_f32 v78, v78
v_exp_f32 v79, v79
v_fma_f32 v148, -v56, v52, v148
s_add_u32 m0, s40, 52224
s_nop 0
buffer_load_dwordx4 v5, s[12:15], s38 offen lds
v_fma_f32 v149, -v56, v53, v149
v_fma_f32 v150, -v56, v54, v150
v_fma_f32 v151, -v56, v55, v151
v_fma_f32 v172, -v58, v52, v172
v_fma_f32 v173, -v58, v53, v173
v_fma_f32 v174, -v58, v54, v174
s_add_u32 m0, s40, 53248
s_add_u32 s38, s38, 57344
buffer_load_dwordx4 v4, s[12:15], s38 offen lds
v_fma_f32 v175, -v58, v55, v175
v_fma_f32 v72, v72, v66, v66
v_fma_f32 v73, v73, v66, v66
v_fma_f32 v74, v74, v66, v66
v_fma_f32 v75, v75, v66, v66
v_fma_f32 v76, v76, v70, v70
s_add_u32 m0, s40, 54272
s_nop 0
buffer_load_dwordx4 v5, s[12:15], s38 offen lds
v_fma_f32 v77, v77, v70, v70
v_fma_f32 v78, v78, v70, v70
v_fma_f32 v79, v79, v70, v70
v_rcp_f32 v72, v72
v_rcp_f32 v73, v73
v_rcp_f32 v74, v74
s_add_u32 m0, s40, 55296
s_add_u32 s38, s38, 57344
buffer_load_dwordx4 v4, s[12:15], s38 offen lds
s_add_u32 m0, s40, 56320
s_nop 0
buffer_load_dwordx4 v5, s[12:15], s38 offen lds
s_waitcnt vmcnt(13)
s_barrier
s_waitcnt lgkmcnt(0)
s_add_u32 s37, s35, 7
s_and_b32 s37, s37, 15
s_mul_i32 s37, s37, 16384
s_add_u32 m0, s39, 98304
s_nop 0
buffer_load_dwordx4 v3, s[8:11], s37 offen sc1 lds
s_load_dword s3, s[4:5], 3584
s_load_dword s3, s[4:5], 3648
s_load_dword s3, s[4:5], 3712
s_load_dword s3, s[4:5], 3776
s_load_dword s3, s[4:5], 3840
s_load_dword s3, s[4:5], 3904
s_load_dword s3, s[4:5], 3968
buffer_load_dwordx4 v3, s[8:11], s37 offen offset:1024 sc1 lds
s_load_dword s3, s[4:5], 4032
s_load_dword s3, s[4:5], 4096
s_load_dword s3, s[4:5], 4160
s_load_dword s3, s[4:5], 4224
s_load_dword s3, s[4:5], 4288
s_load_dword s3, s[4:5], 4352
s_load_dword s3, s[4:5], 4416
buffer_load_dwordx4 v3, s[8:11], s37 offen offset:2048 sc1 lds
v_rcp_f32 v75, v75
v_rcp_f32 v76, v76
v_rcp_f32 v77, v77
v_rcp_f32 v78, v78
v_rcp_f32 v79, v79
v_mul_f32 v148, v136, v148
v_mul_f32 v149, v137, v149
buffer_load_dwordx4 v3, s[8:11], s37 offen offset:3072 sc1 lds
v_mul_f32 v150, v138, v150
v_mul_f32 v151, v139, v151
v_mul_f32 v172, v160, v172
v_mul_f32 v173, v161, v173
v_mul_f32 v174, v162, v174
v_mul_f32 v175, v163, v175
v_mul_f32 v148, v148, v72
v_mul_f32 v149, v149, v73
s_add_u32 s38, s35, 7
s_and_b32 s38, s38, 15
s_mul_i32 s38, s38, 458752
s_add_u32 m0, s40, 98304
s_nop 0
buffer_load_dwordx4 v4, s[12:15], s38 offen lds
v_mul_f32 v150, v150, v74
v_mul_f32 v151, v151, v75
v_mul_f32 v172, v172, v76
v_mul_f32 v173, v173, v77
v_mul_f32 v174, v174, v78
v_mul_f32 v175, v175, v79
v_cvt_pk_bf16_f32 v80, v148, v149
s_add_u32 m0, s40, 99328
s_nop 0
buffer_load_dwordx4 v5, s[12:15], s38 offen lds
v_cvt_pk_bf16_f32 v81, v150, v151
v_cvt_pk_bf16_f32 v82, v172, v173
v_cvt_pk_bf16_f32 v83, v174, v175
s_nop 1
v_permlane32_swap_b32 v80, v82
v_permlane32_swap_b32 v81, v83
buffer_store_dwordx4 v[80:83], v84, s[24:27], s55 offen offset:0 sc1
s_add_u32 m0, s40, 100352
s_add_u32 s38, s38, 57344
buffer_load_dwordx4 v4, s[12:15], s38 offen lds
s_nop 1
v_mul_f32 v66, v61, v61
v_mul_f32 v64, 0xc0135761, v61
v_mul_f32 v65, 0xbdd2d3e8, v61
v_mul_f32 v65, v65, v66
v_rcp_f32 v66, v66
v_mul_f32 v70, v63, v63
v_mul_f32 v68, 0xc0135761, v63
s_add_u32 m0, s40, 101376
s_nop 0
buffer_load_dwordx4 v5, s[12:15], s38 offen lds
v_mul_f32 v69, 0xbdd2d3e8, v63
v_mul_f32 v69, v69, v70
v_rcp_f32 v70, v70
v_fma_f32 v176, -v60, v32, v176
v_fma_f32 v177, -v60, v33, v177
v_fma_f32 v178, -v60, v34, v178
v_fma_f32 v179, -v60, v35, v179
s_add_u32 m0, s40, 102400
s_add_u32 s38, s38, 57344
buffer_load_dwordx4 v4, s[12:15], s38 offen lds
v_fma_f32 v200, -v62, v32, v200
v_fma_f32 v201, -v62, v33, v201
v_fma_f32 v202, -v62, v34, v202
v_fma_f32 v203, -v62, v35, v203
v_mul_f32 v72, v176, v176
v_mul_f32 v73, v177, v177
v_mul_f32 v74, v178, v178
s_add_u32 m0, s40, 103424
s_nop 0
buffer_load_dwordx4 v5, s[12:15], s38 offen lds
v_mul_f32 v75, v179, v179
v_mul_f32 v76, v200, v200
v_mul_f32 v77, v201, v201
v_mul_f32 v78, v202, v202
v_mul_f32 v79, v203, v203
v_fma_f32 v72, v72, v65, v64
v_fma_f32 v73, v73, v65, v64
v_fma_f32 v74, v74, v65, v64
s_add_u32 m0, s40, 104448
s_add_u32 s38, s38, 57344
buffer_load_dwordx4 v4, s[12:15], s38 offen lds
s_add_u32 m0, s40, 105472
s_nop 0
buffer_load_dwordx4 v5, s[12:15], s38 offen lds
s_waitcnt vmcnt(13)
s_barrier
s_add_u32 s37, s35, 8
s_and_b32 s37, s37, 15
s_mul_i32 s37, s37, 16384
s_add_u32 m0, s39, 0
s_nop 0
buffer_load_dwordx4 v3, s[8:11], s37 offen sc1 lds
v_fma_f32 v75, v75, v65, v64
v_fma_f32 v76, v76, v69, v68
v_fma_f32 v77, v77, v69, v68
v_fma_f32 v78, v78, v69, v68
v_fma_f32 v79, v79, v69, v68
v_mul_f32 v72, v72, v176
buffer_load_dwordx4 v3, s[8:11], s37 offen offset:1024 sc1 lds
v_mul_f32 v73, v73, v177
v_mul_f32 v74, v74, v178
v_mul_f32 v75, v75, v179
v_mul_f32 v76, v76, v200
v_mul_f32 v77, v77, v201
v_mul_f32 v78, v78, v202
buffer_load_dwordx4 v3, s[8:11], s37 offen offset:2048 sc1 lds
v_mul_f32 v79, v79, v203
v_exp_f32 v72, v72
v_exp_f32 v73, v73
v_exp_f32 v74, v74
v_exp_f32 v75, v75
v_exp_f32 v76, v76
buffer_load_dwordx4 v3, s[8:11], s37 offen offset:3072 sc1 lds
v_exp_f32 v77, v77
v_exp_f32 v78, v78
v_exp_f32 v79, v79
v_fma_f32 v188, -v60, v44, v188
v_fma_f32 v189, -v60, v45, v189
v_fma_f32 v190, -v60, v46, v190
s_add_u32 s38, s35, 8
s_and_b32 s38, s38, 15
s_mul_i32 s38, s38, 458752
s_add_u32 m0, s40, 0
s_nop 0
buffer_load_dwordx4 v4, s[12:15], s38 offen lds
v_fma_f32 v191, -v60, v47, v191
v_fma_f32 v212, -v62, v44, v212
v_fma_f32 v213, -v62, v45, v213
v_fma_f32 v214, -v62, v46, v214
v_fma_f32 v215, -v62, v47, v215
v_fma_f32 v72, v72, v66, v66
s_add_u32 m0, s40, 1024
s_nop 0
buffer_load_dwordx4 v5, s[12:15], s38 offen lds
v_fma_f32 v73, v73, v66, v66
v_fma_f32 v74, v74, v66, v66
v_fma_f32 v75, v75, v66, v66
v_fma_f32 v76, v76, v70, v70
v_fma_f32 v77, v77, v70, v70
v_fma_f32 v78, v78, v70, v70
s_add_u32 m0, s40, 2048
s_add_u32 s38, s38, 57344
buffer_load_dwordx4 v4, s[12:15], s38 offen lds
v_fma_f32 v79, v79, v70, v70
v_rcp_f32 v72, v72
v_rcp_f32 v73, v73
v_rcp_f32 v74, v74
v_rcp_f32 v75, v75
v_rcp_f32 v76, v76
s_add_u32 m0, s40, 3072
s_nop 0
buffer_load_dwordx4 v5, s[12:15], s38 offen lds
v_rcp_f32 v77, v77
v_rcp_f32 v78, v78
v_rcp_f32 v79, v79
v_mul_f32 v188, v176, v188
v_mul_f32 v189, v177, v189
v_mul_f32 v190, v178, v190
s_add_u32 m0, s40, 4096
s_add_u32 s38, s38, 57344
buffer_load_dwordx4 v4, s[12:15], s38 offen lds
v_mul_f32 v191, v179, v191
v_mul_f32 v212, v200, v212
v_mul_f32 v213, v201, v213
v_mul_f32 v214, v202, v214
v_mul_f32 v215, v203, v215
v_mul_f32 v188, v188, v72
s_add_u32 m0, s40, 5120
s_nop 0
buffer_load_dwordx4 v5, s[12:15], s38 offen lds
v_mul_f32 v189, v189, v73
v_mul_f32 v190, v190, v74
v_mul_f32 v191, v191, v75
v_mul_f32 v212, v212, v76
v_mul_f32 v213, v213, v77
v_mul_f32 v214, v214, v78
s_add_u32 m0, s40, 6144
s_add_u32 s38, s38, 57344
buffer_load_dwordx4 v4, s[12:15], s38 offen lds
s_add_u32 m0, s40, 7168
s_nop 0
buffer_load_dwordx4 v5, s[12:15], s38 offen lds
s_waitcnt vmcnt(12)
s_barrier
s_waitcnt lgkmcnt(0)
s_cmp_eq_u32 s47, 3
s_cbranch_scc0 Lw_132
s_lshl_b32 s92, s35, 7
s_add_u32 s92, s92, 28321792
s_load_dword s93, s[82:83], s92 glc
Lw_132:
s_add_u32 s37, s35, 9
s_and_b32 s37, s37, 15
s_mul_i32 s37, s37, 16384
s_add_u32 m0, s39, 49152
s_nop 0
buffer_load_dwordx4 v3, s[8:11], s37 offen sc1 lds
s_load_dword s3, s[4:5], 4480
s_load_dword s3, s[4:5], 4544
s_load_dword s3, s[4:5], 4608
s_load_dword s3, s[4:5], 4672
s_load_dword s3, s[4:5], 4736
s_load_dword s3, s[4:5], 4800
s_load_dword s3, s[4:5], 4864
buffer_load_dwordx4 v3, s[8:11], s37 offen offset:1024 sc1 lds
s_load_dword s3, s[4:5], 4928
s_load_dword s3, s[4:5], 4992
s_load_dword s3, s[4:5], 5056
s_load_dword s3, s[4:5], 5120
s_load_dword s3, s[4:5], 5184
s_load_dword s3, s[4:5], 5248
s_load_dword s3, s[4:5], 5312
buffer_load_dwordx4 v3, s[8:11], s37 offen offset:2048 sc1 lds
v_mul_f32 v215, v215, v79
v_cvt_pk_bf16_f32 v176, v188, v189
v_cvt_pk_bf16_f32 v177, v190, v191
v_cvt_pk_bf16_f32 v200, v212, v213
v_cvt_pk_bf16_f32 v201, v214, v215
v_fma_f32 v180, -v60, v36, v180
v_fma_f32 v181, -v60, v37, v181
v_fma_f32 v182, -v60, v38, v182
buffer_load_dwordx4 v3, s[8:11], s37 offen offset:3072 sc1 lds
v_fma_f32 v183, -v60, v39, v183
v_fma_f32 v204, -v62, v36, v204
v_fma_f32 v205, -v62, v37, v205
v_fma_f32 v206, -v62, v38, v206
v_fma_f32 v207, -v62, v39, v207
v_mul_f32 v72, v180, v180
v_mul_f32 v73, v181, v181
s_add_u32 s38, s35, 9
s_and_b32 s38, s38, 15
s_mul_i32 s38, s38, 458752
s_add_u32 m0, s40, 49152
s_nop 0
buffer_load_dwordx4 v4, s[12:15], s38 offen lds
v_mul_f32 v74, v182, v182
v_mul_f32 v75, v183, v183
v_mul_f32 v76, v204, v204
v_mul_f32 v77, v205, v205
v_mul_f32 v78, v206, v206
v_mul_f32 v79, v207, v207
v_fma_f32 v72, v72, v65, v64
v_fma_f32 v73, v73, v65, v64
s_add_u32 m0, s40, 50176
s_nop 0
buffer_load_dwordx4 v5, s[12:15], s38 offen lds
v_fma_f32 v74, v74, v65, v64
v_fma_f32 v75, v75, v65, v64
v_fma_f32 v76, v76, v69, v68
v_fma_f32 v77, v77, v69, v68
v_fma_f32 v78, v78, v69, v68
v_fma_f32 v79, v79, v69, v68
v_mul_f32 v72, v72, v180
s_add_u32 m0, s40, 51200
s_add_u32 s38, s38, 57344
buffer_load_dwordx4 v4, s[12:15], s38 offen lds
v_mul_f32 v73, v73, v181
v_mul_f32 v74, v74, v182
v_mul_f32 v75, v75, v183
v_mul_f32 v76, v76, v204
v_mul_f32 v77, v77, v205
v_mul_f32 v78, v78, v206
v_mul_f32 v79, v79, v207
s_add_u32 m0, s40, 52224
s_nop 0
buffer_load_dwordx4 v5, s[12:15], s38 offen lds
v_exp_f32 v72, v72
v_exp_f32 v73, v73
v_exp_f32 v74, v74
v_exp_f32 v75, v75
v_exp_f32 v76, v76
v_exp_f32 v77, v77
v_exp_f32 v78, v78
v_exp_f32 v79, v79
s_add_u32 m0, s40, 53248
s_add_u32 s38, s38, 57344
buffer_load_dwordx4 v4, s[12:15], s38 offen lds
v_fma_f32 v192, -v60, v48, v192
v_fma_f32 v193, -v60, v49, v193
v_fma_f32 v194, -v60, v50, v194
v_fma_f32 v195, -v60, v51, v195
v_fma_f32 v216, -v62, v48, v216
v_fma_f32 v217, -v62, v49, v217
v_fma_f32 v218, -v62, v50, v218
s_add_u32 m0, s40, 54272
s_nop 0
buffer_load_dwordx4 v5, s[12:15], s38 offen lds
v_fma_f32 v219, -v62, v51, v219
v_fma_f32 v72, v72, v66, v66
v_fma_f32 v73, v73, v66, v66
v_fma_f32 v74, v74, v66, v66
v_fma_f32 v75, v75, v66, v66
v_fma_f32 v76, v76, v70, v70
v_fma_f32 v77, v77, v70, v70
v_fma_f32 v78, v78, v70, v70
s_add_u32 m0, s40, 55296
s_add_u32 s38, s38, 57344
buffer_load_dwordx4 v4, s[12:15], s38 offen lds
s_add_u32 m0, s40, 56320
s_nop 0
buffer_load_dwordx4 v5, s[12:15], s38 offen lds
s_waitcnt vmcnt(12)
s_barrier
s_add_u32 s37, s35, 10
s_and_b32 s37, s37, 15
s_mul_i32 s37, s37, 16384
s_add_u32 m0, s39, 98304
s_nop 0
buffer_load_dwordx4 v3, s[8:11], s37 offen sc1 lds
v_fma_f32 v79, v79, v70, v70
v_rcp_f32 v72, v72
v_rcp_f32 v73, v73
v_rcp_f32 v74, v74
v_rcp_f32 v75, v75
v_rcp_f32 v76, v76
buffer_load_dwordx4 v3, s[8:11], s37 offen offset:1024 sc1 lds
v_rcp_f32 v77, v77
v_rcp_f32 v78, v78
v_rcp_f32 v79, v79
v_mul_f32 v192, v180, v192
v_mul_f32 v193, v181, v193
v_mul_f32 v194, v182, v194
buffer_load_dwordx4 v3, s[8:11], s37 offen offset:2048 sc1 lds
v_mul_f32 v195, v183, v195
v_mul_f32 v216, v204, v216
v_mul_f32 v217, v205, v217
v_mul_f32 v218, v206, v218
v_mul_f32 v219, v207, v219
v_mul_f32 v192, v192, v72
buffer_load_dwordx4 v3, s[8:11], s37 offen offset:3072 sc1 lds
v_mul_f32 v193, v193, v73
v_mul_f32 v194, v194, v74
v_mul_f32 v195, v195, v75
v_mul_f32 v216, v216, v76
v_mul_f32 v217, v217, v77
v_mul_f32 v218, v218, v78
s_add_u32 s38, s35, 10
s_and_b32 s38, s38, 15
s_mul_i32 s38, s38, 458752
s_add_u32 m0, s40, 98304
s_nop 0
buffer_load_dwordx4 v4, s[12:15], s38 offen lds
v_mul_f32 v219, v219, v79
v_cvt_pk_bf16_f32 v178, v192, v193
v_cvt_pk_bf16_f32 v179, v194, v195
v_cvt_pk_bf16_f32 v202, v216, v217
v_cvt_pk_bf16_f32 v203, v218, v219
buffer_store_dwordx4 v[176:179], v2, s[24:27], s54 offen offset:2048 sc1
s_add_u32 m0, s40, 99328
s_nop 0
buffer_load_dwordx4 v5, s[12:15], s38 offen lds
buffer_store_dwordx4 v[200:203], v2, s[24:27], s54 offen offset:3072 sc1
v_fma_f32 v184, -v60, v40, v184
v_fma_f32 v185, -v60, v41, v185
v_fma_f32 v186, -v60, v42, v186
v_fma_f32 v187, -v60, v43, v187
v_fma_f32 v208, -v62, v40, v208
s_add_u32 m0, s40, 100352
s_add_u32 s38, s38, 57344
buffer_load_dwordx4 v4, s[12:15], s38 offen lds
v_fma_f32 v209, -v62, v41, v209
v_fma_f32 v210, -v62, v42, v210
v_fma_f32 v211, -v62, v43, v211
v_mul_f32 v72, v184, v184
v_mul_f32 v73, v185, v185
v_mul_f32 v74, v186, v186
s_add_u32 m0, s40, 101376
s_nop 0
buffer_load_dwordx4 v5, s[12:15], s38 offen lds
v_mul_f32 v75, v187, v187
v_mul_f32 v76, v208, v208
v_mul_f32 v77, v209, v209
v_mul_f32 v78, v210, v210
s_branch Lov_10
.p2align 12
.fill 80, 4, 0xbf800000
Lst_10_0:
s_branch Lwr_177
Lst_10_1:
s_branch Lwr_188
s_nop 0
Lov_10:
v_mul_f32 v79, v211, v211
v_fma_f32 v72, v72, v65, v64
s_add_u32 m0, s40, 102400
s_add_u32 s38, s38, 57344
buffer_load_dwordx4 v4, s[12:15], s38 offen lds
v_fma_f32 v73, v73, v65, v64
v_fma_f32 v74, v74, v65, v64
v_fma_f32 v75, v75, v65, v64
v_fma_f32 v76, v76, v69, v68
v_fma_f32 v77, v77, v69, v68
v_fma_f32 v78, v78, v69, v68
s_add_u32 m0, s40, 103424
s_nop 0
buffer_load_dwordx4 v5, s[12:15], s38 offen lds
v_fma_f32 v79, v79, v69, v68
v_mul_f32 v72, v72, v184
v_mul_f32 v73, v73, v185
v_mul_f32 v74, v74, v186
v_mul_f32 v75, v75, v187
v_mul_f32 v76, v76, v208
s_add_u32 m0, s40, 104448
s_add_u32 s38, s38, 57344
buffer_load_dwordx4 v4, s[12:15], s38 offen lds
s_add_u32 m0, s40, 105472
s_nop 0
buffer_load_dwordx4 v5, s[12:15], s38 offen lds
s_waitcnt vmcnt(14)
s_cmp_eq_u32 s47, 3
s_cbranch_scc0 Lw_133
s_mov_b32 s41, 0x40000
s_branch Lpchk_136
Lpoll_134:
s_load_dword s93, s[82:83], s92 glc
Lpchk_136:
s_waitcnt lgkmcnt(0)
s_cmp_eq_u32 s93, 16
s_cbranch_scc1 Lpok_135
s_sub_u32 s41, s41, 1
s_cmp_lg_u32 s41, 0
s_cbranch_scc1 Lpoll_134
Lpok_135:
Lw_133:
s_barrier
s_lshl_b32 s60, s35, 9
s_lshl_b32 s43, s47, 7
s_add_u32 s60, s60, s43
s_add_u32 s61, s60, 14336
s_add_u32 s52, s43, 148480
s_add_u32 s53, s52, 896
v_lshrrev_b32 v104, 3, v1
v_mul_u32_u24 v104, 28672, v104
v_and_b32 v105, 7, v1
v_lshl_add_u32 v104, v105, 4, v104
s_waitcnt lgkmcnt(0)
buffer_load_dwordx4 v[96:99], v104, s[84:87], s60 offen sc1
s_load_dword s3, s[4:5], 5376
s_load_dword s3, s[4:5], 5440
s_load_dword s3, s[4:5], 5504
s_load_dword s3, s[4:5], 5568
s_load_dword s3, s[4:5], 5632
s_load_dword s3, s[4:5], 5696
buffer_load_dwordx4 v[100:103], v104, s[84:87], s61 offen sc1
s_load_dword s3, s[4:5], 5760
s_load_dword s3, s[4:5], 5824
s_load_dword s3, s[4:5], 5888
s_load_dword s3, s[4:5], 5952
s_load_dword s3, s[4:5], 6016
s_load_dword s3, s[4:5], 6080
s_load_dword s3, s[4:5], 6144
s_add_u32 s37, s35, 11
s_and_b32 s37, s37, 15
s_mul_i32 s37, s37, 16384
s_add_u32 m0, s39, 0
s_nop 0
buffer_load_dwordx4 v3, s[8:11], s37 offen sc1 lds
s_load_dword s3, s[4:5], 6208
v_mul_f32 v77, v77, v209
v_mul_f32 v78, v78, v210
v_mul_f32 v79, v79, v211
v_exp_f32 v72, v72
v_exp_f32 v73, v73
v_exp_f32 v74, v74
buffer_load_dwordx4 v3, s[8:11], s37 offen offset:1024 sc1 lds
v_exp_f32 v75, v75
v_exp_f32 v76, v76
v_exp_f32 v77, v77
v_exp_f32 v78, v78
v_exp_f32 v79, v79
v_fma_f32 v196, -v60, v52, v196
v_fma_f32 v197, -v60, v53, v197
buffer_load_dwordx4 v3, s[8:11], s37 offen offset:2048 sc1 lds
v_fma_f32 v198, -v60, v54, v198
v_fma_f32 v199, -v60, v55, v199
v_fma_f32 v220, -v62, v52, v220
v_fma_f32 v221, -v62, v53, v221
v_fma_f32 v222, -v62, v54, v222
v_fma_f32 v223, -v62, v55, v223
buffer_load_dwordx4 v3, s[8:11], s37 offen offset:3072 sc1 lds
v_fma_f32 v72, v72, v66, v66
v_fma_f32 v73, v73, v66, v66
v_fma_f32 v74, v74, v66, v66
v_fma_f32 v75, v75, v66, v66
v_fma_f32 v76, v76, v70, v70
v_fma_f32 v77, v77, v70, v70
v_fma_f32 v78, v78, v70, v70
s_add_u32 s38, s35, 11
s_and_b32 s38, s38, 15
s_mul_i32 s38, s38, 458752
s_add_u32 m0, s40, 0
s_nop 0
buffer_load_dwordx4 v4, s[12:15], s38 offen lds
v_fma_f32 v79, v79, v70, v70
v_rcp_f32 v72, v72
v_rcp_f32 v73, v73
v_rcp_f32 v74, v74
v_rcp_f32 v75, v75
v_rcp_f32 v76, v76
v_rcp_f32 v77, v77
s_add_u32 m0, s40, 1024
s_nop 0
buffer_load_dwordx4 v5, s[12:15], s38 offen lds
v_rcp_f32 v78, v78
v_rcp_f32 v79, v79
v_mul_f32 v196, v184, v196
v_mul_f32 v197, v185, v197
v_mul_f32 v198, v186, v198
v_mul_f32 v199, v187, v199
v_mul_f32 v220, v208, v220
s_add_u32 m0, s40, 2048
s_add_u32 s38, s38, 57344
buffer_load_dwordx4 v4, s[12:15], s38 offen lds
v_mul_f32 v221, v209, v221
v_mul_f32 v222, v210, v222
v_mul_f32 v223, v211, v223
v_mul_f32 v196, v196, v72
v_mul_f32 v197, v197, v73
v_mul_f32 v198, v198, v74
s_add_u32 m0, s40, 3072
s_nop 0
buffer_load_dwordx4 v5, s[12:15], s38 offen lds
v_mul_f32 v199, v199, v75
v_mul_f32 v220, v220, v76
v_mul_f32 v221, v221, v77
v_mul_f32 v222, v222, v78
v_mul_f32 v223, v223, v79
v_cvt_pk_bf16_f32 v80, v196, v197
v_cvt_pk_bf16_f32 v81, v198, v199
s_add_u32 m0, s40, 4096
s_add_u32 s38, s38, 57344
buffer_load_dwordx4 v4, s[12:15], s38 offen lds
v_cvt_pk_bf16_f32 v82, v220, v221
v_cvt_pk_bf16_f32 v83, v222, v223
s_nop 1
v_permlane32_swap_b32 v80, v82
v_permlane32_swap_b32 v81, v83
buffer_store_dwordx4 v[80:83], v84, s[24:27], s55 offen offset:2048 sc1
s_nop 1
s_add_u32 m0, s40, 5120
s_nop 0
buffer_load_dwordx4 v5, s[12:15], s38 offen lds
v_cmp_gt_u32 vcc, 32, v1
v_mov_b32 v104, s52
v_mov_b32 v106, s53
v_cndmask_b32 v104, v106, v104, vcc
v_lshl_add_u32 v104, v105, 4, v104
v_bfe_u32 v105, v1, 4, 1
v_lshl_add_u32 v104, v105, 2, v104
s_add_u32 m0, s40, 6144
s_add_u32 s38, s38, 57344
buffer_load_dwordx4 v4, s[12:15], s38 offen lds
s_add_u32 m0, s40, 7168
s_nop 0
buffer_load_dwordx4 v5, s[12:15], s38 offen lds
s_waitcnt vmcnt(15)
s_barrier
s_add_u32 s37, s35, 12
s_and_b32 s37, s37, 15
s_mul_i32 s37, s37, 16384
s_add_u32 m0, s39, 49152
s_nop 0
buffer_load_dwordx4 v3, s[8:11], s37 offen sc1 lds
buffer_load_dwordx4 v3, s[8:11], s37 offen offset:1024 sc1 lds
buffer_load_dwordx4 v3, s[8:11], s37 offen offset:2048 sc1 lds
buffer_load_dwordx4 v3, s[8:11], s37 offen offset:3072 sc1 lds
s_add_u32 s38, s35, 12
s_and_b32 s38, s38, 15
s_mul_i32 s38, s38, 458752
s_add_u32 m0, s40, 49152
s_nop 0
buffer_load_dwordx4 v4, s[12:15], s38 offen lds
s_add_u32 m0, s40, 50176
s_nop 0
buffer_load_dwordx4 v5, s[12:15], s38 offen lds
s_add_u32 m0, s40, 51200
s_add_u32 s38, s38, 57344
buffer_load_dwordx4 v4, s[12:15], s38 offen lds
s_add_u32 m0, s40, 52224
s_nop 0
buffer_load_dwordx4 v5, s[12:15], s38 offen lds
s_add_u32 m0, s40, 53248
s_add_u32 s38, s38, 57344
buffer_load_dwordx4 v4, s[12:15], s38 offen lds
s_add_u32 m0, s40, 54272
s_nop 0
buffer_load_dwordx4 v5, s[12:15], s38 offen lds
s_add_u32 m0, s40, 55296
s_add_u32 s38, s38, 57344
buffer_load_dwordx4 v4, s[12:15], s38 offen lds
s_add_u32 m0, s40, 56320
s_nop 0
buffer_load_dwordx4 v5, s[12:15], s38 offen lds
s_waitcnt vmcnt(12)
s_barrier
s_cmp_eq_u32 s47, 0
s_cbranch_scc0 Lw_137
s_add_u32 s7, s34, 32
s_lshl_b32 s7, s7, 7
v_mov_b32 v28, s7
v_mov_b32 v29, 1
s_mov_b64 exec, 1
buffer_atomic_add v29, v28, s[56:59], 0 offen sc1
s_mov_b64 exec, -1
Lw_137:
v_permlane32_swap_b32 v96, v100
v_permlane32_swap_b32 v97, v101
v_permlane32_swap_b32 v98, v102
v_permlane32_swap_b32 v99, v103
v_add_f32 v96, v96, v100
v_add_f32 v97, v97, v101
v_add_f32 v98, v98, v102
v_add_f32 v99, v99, v103
s_nop 1
v_permlane16_swap_b32 v96, v97
v_permlane16_swap_b32 v98, v99
v_add_f32 v96, v96, v97
v_add_f32 v98, v98, v99
s_nop 1
v_add_f32_dpp v96, v96, v96 row_ror:8 row_mask:0xf bank_mask:0xf
v_add_f32_dpp v98, v98, v98 row_ror:8 row_mask:0xf bank_mask:0xf
ds_write_b32 v104, v96
ds_write_b32 v104, v98 offset:8
s_waitcnt lgkmcnt(0)
s_add_u32 s37, s35, 13
s_and_b32 s37, s37, 15
s_mul_i32 s37, s37, 16384
s_add_u32 m0, s39, 98304
s_nop 0
buffer_load_dwordx4 v3, s[8:11], s37 offen sc1 lds
s_load_dword s3, s[4:5], 6272
s_load_dword s3, s[4:5], 6336
s_load_dword s3, s[4:5], 6400
s_load_dword s3, s[4:5], 6464
s_load_dword s3, s[4:5], 6528
s_load_dword s3, s[4:5], 6592
buffer_load_dwordx4 v3, s[8:11], s37 offen offset:1024 sc1 lds
s_load_dword s3, s[4:5], 6656
s_load_dword s3, s[4:5], 6720
s_load_dword s3, s[4:5], 6784
s_load_dword s3, s[4:5], 6848
s_load_dword s3, s[4:5], 6912
s_load_dword s3, s[4:5], 6976
buffer_load_dwordx4 v3, s[8:11], s37 offen offset:2048 sc1 lds
s_load_dword s3, s[4:5], 7040
s_load_dword s3, s[4:5], 7104
s_bfe_u32 s61, s35, 0x10002
s_lshr_b32 s60, s35, 3
s_lshl_b32 s60, s60, 2
s_and_b32 s43, s35, 3
buffer_load_dwordx4 v3, s[8:11], s37 offen offset:3072 sc1 lds
s_add_u32 s60, s60, s43
s_lshl_b32 s43, s60, 8
s_add_u32 s28, s76, s43
s_addc_u32 s29, s77, 0
s_mov_b32 s30, 7338240
s_mov_b32 s31, 0x20000
s_mul_i32 s52, s61, 196608
s_add_u32 s38, s35, 13
s_and_b32 s38, s38, 15
s_mul_i32 s38, s38, 458752
s_add_u32 m0, s40, 98304
s_nop 0
buffer_load_dwordx4 v4, s[12:15], s38 offen lds
s_mul_i32 s53, s61, 1572864
s_mul_i32 s90, s61, 163840
s_mul_i32 s91, s61, 1310720
s_lshl_b32 s51, s47, 11
s_lshl_b32 s44, s47, 15
v_lshrrev_b32 v122, 4, v1
s_add_u32 m0, s40, 99328
s_nop 0
buffer_load_dwordx4 v5, s[12:15], s38 offen lds
v_lshlrev_b32 v123, 1, v122
v_and_b32 v23, 15, v1
v_xor_b32 v23, v23, v123
v_lshlrev_b32 v23, 4, v23
v_mul_u32_u24 v122, 2048, v122
v_add_u32 v23, v23, v122
s_add_u32 m0, s40, 100352
s_add_u32 s38, s38, 57344
buffer_load_dwordx4 v4, s[12:15], s38 offen lds
v_add_u32 v23, s44, v23
v_xor_b32 v24, 128, v23
v_add_u32 v24, 8192, v24
s_lshl_b32 s43, s60, 2
s_lshl_b32 s44, s61, 1
s_add_u32 s43, s43, s44
s_add_u32 s43, s43, s63
s_add_u32 m0, s40, 101376
s_nop 0
buffer_load_dwordx4 v5, s[12:15], s38 offen lds
s_lshl_b32 s43, s43, 13
s_lshl_b32 s44, s62, 12
s_add_u32 s50, s43, s44
v_add_u32 v6, s44, v2
v_add_u32 v7, 0x10000, v6
v_add_u32 v8, 0x20000, v6
s_add_u32 m0, s40, 102400
s_add_u32 s38, s38, 57344
buffer_load_dwordx4 v4, s[12:15], s38 offen lds
v_lshrrev_b32 v122, 2, v1
v_and_b32 v123, 7, v122
v_mul_u32_u24 v122, 256, v122
v_lshl_add_u32 v122, v123, 5, v122
v_and_b32 v123, 3, v1
v_lshl_add_u32 v9, v123, 3, v122
s_add_u32 m0, s40, 103424
s_nop 0
buffer_load_dwordx4 v5, s[12:15], s38 offen lds
s_lshl_b32 s43, s61, 7
s_lshl_b32 s44, s63, 6
s_add_u32 s43, s43, s44
v_xor_b32 v9, s43, v9
v_xor_b32 v10, 32, v9
v_xor_b32 v11, 128, v9
v_xor_b32 v12, 128, v10
s_add_u32 m0, s40, 104448
s_add_u32 s38, s38, 57344
buffer_load_dwordx4 v4, s[12:15], s38 offen lds
s_add_u32 m0, s40, 105472
s_nop 0
buffer_load_dwordx4 v5, s[12:15], s38 offen lds
s_waitcnt vmcnt(12)
s_barrier
buffer_load_dwordx4 v[160:163], v2, s[8:11], s50 offen offset:0 sc1
v_add_u32 v13, 65536, v9
v_add_u32 v14, 65536, v10
v_add_u32 v15, 65536, v11
buffer_load_dwordx4 v[164:167], v2, s[8:11], s50 offen offset:1024 sc1
v_add_u32 v16, 65536, v12
v_add_u32 v25, 131072, v9
v_add_u32 v26, 131072, v10
v_add_u32 v27, 131072, v11
buffer_load_dwordx4 v[168:171], v2, s[8:11], s50 offen offset:2048 sc1
v_add_u32 v28, 131072, v12
v_lshrrev_b32 v122, 2, v1
v_bfe_u32 v123, v122, 1, 2
buffer_load_dwordx4 v[172:175], v2, s[8:11], s50 offen offset:3072 sc1
v_mul_u32_u24 v122, 128, v122
v_lshl_add_u32 v122, v123, 5, v122
v_and_b32 v123, 3, v1
v_lshl_add_u32 v224, v123, 3, v122
s_add_u32 s37, s35, 14
s_and_b32 s37, s37, 15
s_mul_i32 s37, s37, 16384
s_add_u32 m0, s39, 0
s_nop 0
buffer_load_dwordx4 v3, s[8:11], s37 offen sc1 lds
v_xor_b32 v224, s44, v224
v_xor_b32 v225, 32, v224
v_add_u32 v226, 65536, v224
buffer_load_dwordx4 v3, s[8:11], s37 offen offset:1024 sc1 lds
v_add_u32 v227, 65536, v225
v_add_u32 v228, 131072, v224
v_add_u32 v229, 131072, v225
s_add_u32 s84, s82, 33554432
buffer_load_dwordx4 v3, s[8:11], s37 offen offset:2048 sc1 lds
s_addc_u32 s85, s83, 0
s_mov_b32 s86, 4194304
s_mov_b32 s87, 0x20000
s_xor_b32 s43, s2, 2
buffer_load_dwordx4 v3, s[8:11], s37 offen offset:3072 sc1 lds
s_lshl_b32 s44, s43, 2
s_add_u32 s44, s44, s47
s_lshl_b32 s45, s44, 12
s_add_u32 s38, s35, 14
s_and_b32 s38, s38, 15
s_mul_i32 s38, s38, 458752
s_add_u32 m0, s40, 0
s_nop 0
buffer_load_dwordx4 v4, s[12:15], s38 offen lds
s_lshl_b32 s46, s2, 2
s_add_u32 s46, s46, s47
s_lshl_b32 s46, s46, 12
s_lshl_b32 s43, s34, 18
s_add_u32 m0, s40, 1024
s_nop 0
buffer_load_dwordx4 v5, s[12:15], s38 offen lds
s_lshl_b32 s42, s60, 8
s_add_u32 s43, s43, s42
s_lshl_b32 s42, s61, 7
s_add_u32 m0, s40, 2048
s_add_u32 s38, s38, 57344
buffer_load_dwordx4 v4, s[12:15], s38 offen lds
s_add_u32 s43, s43, s42
s_lshl_b32 s42, s63, 6
s_add_u32 s43, s43, s42
s_add_u32 s20, s78, s43
s_add_u32 m0, s40, 3072
s_nop 0
buffer_load_dwordx4 v5, s[12:15], s38 offen lds
s_addc_u32 s21, s79, 0
s_mov_b32 s22, 260160
s_mov_b32 s23, 0x20000
s_add_u32 m0, s40, 4096
s_add_u32 s38, s38, 57344
buffer_load_dwordx4 v4, s[12:15], s38 offen lds
v_and_b32 v230, 15, v1
v_lshlrev_b32 v230, 12, v230
v_bfe_u32 v231, v1, 4, 1
v_lshl_add_u32 v230, v231, 5, v230
s_add_u32 m0, s40, 5120
s_nop 0
buffer_load_dwordx4 v5, s[12:15], s38 offen lds
v_bfe_u32 v231, v1, 5, 1
v_lshl_add_u32 v230, v231, 4, v230
s_lshl_b32 s54, s62, 17
s_add_u32 s55, s54, 65536
s_add_u32 m0, s40, 6144
s_add_u32 s38, s38, 57344
buffer_load_dwordx4 v4, s[12:15], s38 offen lds
s_add_u32 m0, s40, 7168
s_nop 0
buffer_load_dwordx4 v5, s[12:15], s38 offen lds
s_waitcnt vmcnt(16)
s_barrier
s_cmp_eq_u32 s47, 3
s_cbranch_scc0 Lw_138
s_lshl_b32 s92, s34, 7
s_add_u32 s92, s92, 28315648
s_load_dword s93, s[82:83], s92 glc
Lw_138:
s_add_u32 s37, s35, 15
s_and_b32 s37, s37, 15
s_mul_i32 s37, s37, 16384
s_add_u32 m0, s39, 49152
s_nop 0
buffer_load_dwordx4 v3, s[8:11], s37 offen sc1 lds
buffer_load_dwordx4 v3, s[8:11], s37 offen offset:1024 sc1 lds
buffer_load_dwordx4 v3, s[8:11], s37 offen offset:2048 sc1 lds
buffer_load_dwordx4 v3, s[8:11], s37 offen offset:3072 sc1 lds
s_add_u32 s38, s35, 15
s_and_b32 s38, s38, 15
s_mul_i32 s38, s38, 458752
s_add_u32 m0, s40, 49152
s_nop 0
buffer_load_dwordx4 v4, s[12:15], s38 offen lds
s_add_u32 m0, s40, 50176
s_nop 0
buffer_load_dwordx4 v5, s[12:15], s38 offen lds
s_add_u32 m0, s40, 51200
s_add_u32 s38, s38, 57344
buffer_load_dwordx4 v4, s[12:15], s38 offen lds
s_add_u32 m0, s40, 52224
s_nop 0
buffer_load_dwordx4 v5, s[12:15], s38 offen lds
s_add_u32 m0, s40, 53248
s_add_u32 s38, s38, 57344
buffer_load_dwordx4 v4, s[12:15], s38 offen lds
s_add_u32 m0, s40, 54272
s_nop 0
buffer_load_dwordx4 v5, s[12:15], s38 offen lds
s_add_u32 m0, s40, 55296
s_add_u32 s38, s38, 57344
buffer_load_dwordx4 v4, s[12:15], s38 offen lds
s_add_u32 m0, s40, 56320
s_nop 0
buffer_load_dwordx4 v5, s[12:15], s38 offen lds
s_waitcnt vmcnt(12)
s_cmp_eq_u32 s47, 3
s_cbranch_scc0 Lw_139
s_mov_b32 s41, 0x40000
s_branch Lpchk_142
Lpoll_140:
s_load_dword s93, s[82:83], s92 glc
Lpchk_142:
s_waitcnt lgkmcnt(0)
s_cmp_eq_u32 s93, 16
s_cbranch_scc1 Lpok_141
s_sub_u32 s41, s41, 1
s_cmp_lg_u32 s41, 0
s_cbranch_scc1 Lpoll_140
Lpok_141:
Lw_139:
s_barrier
s_add_u32 m0, s39, 98304
s_add_u32 s37, s52, 524288
buffer_load_dwordx4 v3, s[24:27], s37 offen sc1 lds
v_lshlrev_b32 v128, 16, v160
v_and_b32 v129, 0xffff0000, v160
v_lshlrev_b32 v130, 16, v161
v_and_b32 v131, 0xffff0000, v161
v_lshlrev_b32 v132, 16, v162
buffer_load_dwordx4 v3, s[24:27], s37 offen offset:1024 sc1 lds
v_and_b32 v133, 0xffff0000, v162
v_lshlrev_b32 v134, 16, v163
v_and_b32 v135, 0xffff0000, v163
v_lshlrev_b32 v136, 16, v164
v_and_b32 v137, 0xffff0000, v164
buffer_load_dwordx4 v3, s[24:27], s37 offen offset:2048 sc1 lds
v_lshlrev_b32 v138, 16, v165
v_and_b32 v139, 0xffff0000, v165
v_lshlrev_b32 v140, 16, v166
v_and_b32 v141, 0xffff0000, v166
v_lshlrev_b32 v142, 16, v167
v_and_b32 v143, 0xffff0000, v167
buffer_load_dwordx4 v3, s[24:27], s37 offen offset:3072 sc1 lds
v_lshlrev_b32 v144, 16, v168
v_and_b32 v145, 0xffff0000, v168
v_lshlrev_b32 v146, 16, v169
v_and_b32 v147, 0xffff0000, v169
v_lshlrev_b32 v148, 16, v170
s_add_u32 m0, s39, 114688
s_add_u32 s38, s53, 4194304
buffer_load_dwordx4 v23, s[28:31], s38 offen lds
v_and_b32 v149, 0xffff0000, v170
v_lshlrev_b32 v150, 16, v171
v_and_b32 v151, 0xffff0000, v171
v_lshlrev_b32 v152, 16, v172
v_and_b32 v153, 0xffff0000, v172
s_add_u32 m0, s39, 115712
s_add_u32 s38, s53, 4194304
buffer_load_dwordx4 v24, s[28:31], s38 offen lds
v_lshlrev_b32 v154, 16, v173
v_and_b32 v155, 0xffff0000, v173
v_lshlrev_b32 v156, 16, v174
v_and_b32 v157, 0xffff0000, v174
v_lshlrev_b32 v158, 16, v175
v_and_b32 v159, 0xffff0000, v175
s_add_u32 m0, s39, 116736
s_add_u32 s38, s53, 4210688
buffer_load_dwordx4 v23, s[28:31], s38 offen lds
s_add_u32 m0, s39, 117760
s_add_u32 s38, s53, 4210688
buffer_load_dwordx4 v24, s[28:31], s38 offen lds
s_waitcnt vmcnt(8)
s_barrier
s_add_u32 m0, s39, 131072
s_add_u32 s37, s52, 540672
buffer_load_dwordx4 v3, s[24:27], s37 offen sc1 lds
buffer_load_dwordx4 v3, s[24:27], s37 offen offset:1024 sc1 lds
buffer_load_dwordx4 v3, s[24:27], s37 offen offset:2048 sc1 lds
buffer_load_dwordx4 v3, s[24:27], s37 offen offset:3072 sc1 lds
s_add_u32 m0, s39, 0
s_add_u32 s38, s53, 4325376
buffer_load_dwordx4 v23, s[28:31], s38 offen lds
s_add_u32 m0, s39, 1024
s_add_u32 s38, s53, 4325376
buffer_load_dwordx4 v24, s[28:31], s38 offen lds
s_add_u32 m0, s39, 2048
s_add_u32 s38, s53, 4341760
buffer_load_dwordx4 v23, s[28:31], s38 offen lds
s_add_u32 m0, s39, 3072
s_add_u32 s38, s53, 4341760
buffer_load_dwordx4 v24, s[28:31], s38 offen lds
s_add_u32 m0, s39, 16384
s_add_u32 s37, s52, 557056
buffer_load_dwordx4 v3, s[24:27], s37 offen sc1 lds
buffer_load_dwordx4 v3, s[24:27], s37 offen offset:1024 sc1 lds
buffer_load_dwordx4 v3, s[24:27], s37 offen offset:2048 sc1 lds
buffer_load_dwordx4 v3, s[24:27], s37 offen offset:3072 sc1 lds
s_add_u32 m0, s39, 32768
s_add_u32 s38, s53, 4456448
buffer_load_dwordx4 v23, s[28:31], s38 offen lds
s_add_u32 m0, s39, 33792
s_add_u32 s38, s53, 4456448
buffer_load_dwordx4 v24, s[28:31], s38 offen lds
s_add_u32 m0, s39, 34816
s_add_u32 s38, s53, 4472832
buffer_load_dwordx4 v23, s[28:31], s38 offen lds
s_add_u32 m0, s39, 35840
s_add_u32 s38, s53, 4472832
buffer_load_dwordx4 v24, s[28:31], s38 offen lds
s_waitcnt vmcnt(16)
s_barrier
ds_read_b128 v[32:35], v7 offset:32768
ds_read_b64_tr_b16 v[48:49], v13 offset:49152
ds_read_b64_tr_b16 v[50:51], v13 offset:53248
ds_read_b64_tr_b16 v[52:53], v14 offset:49152
ds_read_b64_tr_b16 v[54:55], v14 offset:53248
ds_read_b64_tr_b16 v[56:57], v15 offset:49152
ds_read_b64_tr_b16 v[58:59], v15 offset:53248
ds_read_b64_tr_b16 v[60:61], v16 offset:49152
ds_read_b64_tr_b16 v[62:63], v16 offset:53248
ds_read_b128 v[36:39], v7 offset:33792
ds_read_b128 v[40:43], v7 offset:34816
ds_read_b128 v[44:47], v7 offset:35840
ds_read_b128 v[64:67], v7 offset:40960
ds_read_b64_tr_b16 v[80:81], v13 offset:57344
ds_read_b64_tr_b16 v[82:83], v13 offset:61440
ds_read_b64_tr_b16 v[84:85], v14 offset:57344
ds_read_b64_tr_b16 v[86:87], v14 offset:61440
ds_read_b64_tr_b16 v[88:89], v15 offset:57344
s_branch Lov_11
.p2align 12
.fill 80, 4, 0xbf800000
Lst_11_0:
s_branch Lwr_178
Lst_11_1:
s_branch Lst_15_0
s_nop 0
Lov_11:
ds_read_b64_tr_b16 v[90:91], v15 offset:61440
ds_read_b64_tr_b16 v[92:93], v16 offset:57344
ds_read_b64_tr_b16 v[94:95], v16 offset:61440
ds_read_b128 v[68:71], v7 offset:41984
ds_read_b128 v[72:75], v7 offset:43008
ds_read_b128 v[76:79], v7 offset:44032
s_add_u32 m0, s39, 49152
s_add_u32 s37, s52, 573440
buffer_load_dwordx4 v3, s[24:27], s37 offen sc1 lds
buffer_load_dwordx4 v3, s[24:27], s37 offen offset:1024 sc1 lds
buffer_load_dwordx4 v3, s[24:27], s37 offen offset:2048 sc1 lds
buffer_load_dwordx4 v3, s[24:27], s37 offen offset:3072 sc1 lds
s_add_u32 m0, s39, 65536
s_add_u32 s38, s53, 4587520
buffer_load_dwordx4 v23, s[28:31], s38 offen lds
s_add_u32 m0, s39, 66560
s_add_u32 s38, s53, 4587520
buffer_load_dwordx4 v24, s[28:31], s38 offen lds
s_add_u32 m0, s39, 67584
s_add_u32 s38, s53, 4603904
buffer_load_dwordx4 v23, s[28:31], s38 offen lds
s_add_u32 m0, s39, 68608
s_add_u32 s38, s53, 4603904
buffer_load_dwordx4 v24, s[28:31], s38 offen lds
s_waitcnt vmcnt(16)
s_waitcnt lgkmcnt(0)
s_barrier
v_mfma_f32_16x16x32_bf16 v[128:131], v[48:51], v[32:35], v[128:131]
ds_read_b128 v[96:99], v8 offset:0
v_mfma_f32_16x16x32_bf16 v[132:135], v[52:55], v[32:35], v[132:135]
ds_read_b64_tr_b16 v[112:113], v9 offset:0
v_mfma_f32_16x16x32_bf16 v[160:163], v[56:59], v[32:35], 0
ds_read_b64_tr_b16 v[114:115], v9 offset:4096
v_mfma_f32_16x16x32_bf16 v[164:167], v[60:63], v[32:35], 0
ds_read_b64_tr_b16 v[116:117], v10 offset:0
v_mfma_f32_16x16x32_bf16 v[172:175], v[60:63], v[36:39], 0
ds_read_b64_tr_b16 v[118:119], v10 offset:4096
v_mfma_f32_16x16x32_bf16 v[168:171], v[56:59], v[36:39], 0
ds_read_b64_tr_b16 v[120:121], v11 offset:0
v_mfma_f32_16x16x32_bf16 v[140:143], v[52:55], v[36:39], v[140:143]
ds_read_b64_tr_b16 v[122:123], v11 offset:4096
v_mfma_f32_16x16x32_bf16 v[136:139], v[48:51], v[36:39], v[136:139]
ds_read_b64_tr_b16 v[124:125], v12 offset:0
v_mfma_f32_16x16x32_bf16 v[144:147], v[48:51], v[40:43], v[144:147]
ds_read_b64_tr_b16 v[126:127], v12 offset:4096
v_mfma_f32_16x16x32_bf16 v[148:151], v[52:55], v[40:43], v[148:151]
ds_read_b128 v[100:103], v8 offset:1024
v_mfma_f32_16x16x32_bf16 v[176:179], v[56:59], v[40:43], 0
ds_read_b128 v[104:107], v8 offset:2048
v_mfma_f32_16x16x32_bf16 v[180:183], v[60:63], v[40:43], 0
ds_read_b128 v[108:111], v8 offset:3072
v_mfma_f32_16x16x32_bf16 v[188:191], v[60:63], v[44:47], 0
ds_read_b128 v[192:195], v8 offset:8192
v_mfma_f32_16x16x32_bf16 v[184:187], v[56:59], v[44:47], 0
ds_read_b64_tr_b16 v[208:209], v9 offset:8192
v_mfma_f32_16x16x32_bf16 v[156:159], v[52:55], v[44:47], v[156:159]
ds_read_b64_tr_b16 v[210:211], v9 offset:12288
v_mfma_f32_16x16x32_bf16 v[152:155], v[48:51], v[44:47], v[152:155]
ds_read_b64_tr_b16 v[212:213], v10 offset:8192
v_mfma_f32_16x16x32_bf16 v[128:131], v[80:83], v[64:67], v[128:131]
ds_read_b64_tr_b16 v[214:215], v10 offset:12288
v_mfma_f32_16x16x32_bf16 v[132:135], v[84:87], v[64:67], v[132:135]
ds_read_b64_tr_b16 v[216:217], v11 offset:8192
v_mfma_f32_16x16x32_bf16 v[160:163], v[88:91], v[64:67], v[160:163]
ds_read_b64_tr_b16 v[218:219], v11 offset:12288
v_mfma_f32_16x16x32_bf16 v[164:167], v[92:95], v[64:67], v[164:167]
ds_read_b64_tr_b16 v[220:221], v12 offset:8192
v_mfma_f32_16x16x32_bf16 v[172:175], v[92:95], v[68:71], v[172:175]
ds_read_b64_tr_b16 v[222:223], v12 offset:12288
v_mfma_f32_16x16x32_bf16 v[168:171], v[88:91], v[68:71], v[168:171]
ds_read_b128 v[196:199], v8 offset:9216
v_mfma_f32_16x16x32_bf16 v[140:143], v[84:87], v[68:71], v[140:143]
ds_read_b128 v[200:203], v8 offset:10240
v_mfma_f32_16x16x32_bf16 v[136:139], v[80:83], v[68:71], v[136:139]
ds_read_b128 v[204:207], v8 offset:11264
v_mfma_f32_16x16x32_bf16 v[144:147], v[80:83], v[72:75], v[144:147]
v_mfma_f32_16x16x32_bf16 v[148:151], v[84:87], v[72:75], v[148:151]
v_mfma_f32_16x16x32_bf16 v[176:179], v[88:91], v[72:75], v[176:179]
v_mfma_f32_16x16x32_bf16 v[180:183], v[92:95], v[72:75], v[180:183]
v_mfma_f32_16x16x32_bf16 v[188:191], v[92:95], v[76:79], v[188:191]
v_mfma_f32_16x16x32_bf16 v[184:187], v[88:91], v[76:79], v[184:187]
v_mfma_f32_16x16x32_bf16 v[156:159], v[84:87], v[76:79], v[156:159]
v_mfma_f32_16x16x32_bf16 v[152:155], v[80:83], v[76:79], v[152:155]
s_mov_b32 s41, 2
Lk4_143:
s_waitcnt vmcnt(8)
s_waitcnt lgkmcnt(0)
s_barrier
v_mfma_f32_16x16x32_bf16 v[128:131], v[112:115], v[96:99], v[128:131]
ds_read_b128 v[32:35], v6 offset:16384
v_mfma_f32_16x16x32_bf16 v[132:135], v[116:119], v[96:99], v[132:135]
ds_read_b64_tr_b16 v[48:49], v9 offset:32768
v_mfma_f32_16x16x32_bf16 v[160:163], v[120:123], v[96:99], v[160:163]
ds_read_b64_tr_b16 v[50:51], v9 offset:36864
v_mfma_f32_16x16x32_bf16 v[164:167], v[124:127], v[96:99], v[164:167]
ds_read_b64_tr_b16 v[52:53], v10 offset:32768
v_mfma_f32_16x16x32_bf16 v[172:175], v[124:127], v[100:103], v[172:175]
ds_read_b64_tr_b16 v[54:55], v10 offset:36864
v_mfma_f32_16x16x32_bf16 v[168:171], v[120:123], v[100:103], v[168:171]
ds_read_b64_tr_b16 v[56:57], v11 offset:32768
v_mfma_f32_16x16x32_bf16 v[140:143], v[116:119], v[100:103], v[140:143]
ds_read_b64_tr_b16 v[58:59], v11 offset:36864
v_mfma_f32_16x16x32_bf16 v[136:139], v[112:115], v[100:103], v[136:139]
ds_read_b64_tr_b16 v[60:61], v12 offset:32768
v_mfma_f32_16x16x32_bf16 v[144:147], v[112:115], v[104:107], v[144:147]
ds_read_b64_tr_b16 v[62:63], v12 offset:36864
v_mfma_f32_16x16x32_bf16 v[148:151], v[116:119], v[104:107], v[148:151]
ds_read_b128 v[36:39], v6 offset:17408
v_mfma_f32_16x16x32_bf16 v[176:179], v[120:123], v[104:107], v[176:179]
ds_read_b128 v[40:43], v6 offset:18432
v_mfma_f32_16x16x32_bf16 v[180:183], v[124:127], v[104:107], v[180:183]
ds_read_b128 v[44:47], v6 offset:19456
v_mfma_f32_16x16x32_bf16 v[188:191], v[124:127], v[108:111], v[188:191]
ds_read_b128 v[64:67], v6 offset:24576
v_mfma_f32_16x16x32_bf16 v[184:187], v[120:123], v[108:111], v[184:187]
ds_read_b64_tr_b16 v[80:81], v9 offset:40960
v_mfma_f32_16x16x32_bf16 v[156:159], v[116:119], v[108:111], v[156:159]
ds_read_b64_tr_b16 v[82:83], v9 offset:45056
v_mfma_f32_16x16x32_bf16 v[152:155], v[112:115], v[108:111], v[152:155]
ds_read_b64_tr_b16 v[84:85], v10 offset:40960
v_mfma_f32_16x16x32_bf16 v[128:131], v[208:211], v[192:195], v[128:131]
ds_read_b64_tr_b16 v[86:87], v10 offset:45056
v_mfma_f32_16x16x32_bf16 v[132:135], v[212:215], v[192:195], v[132:135]
ds_read_b64_tr_b16 v[88:89], v11 offset:40960
v_mfma_f32_16x16x32_bf16 v[160:163], v[216:219], v[192:195], v[160:163]
ds_read_b64_tr_b16 v[90:91], v11 offset:45056
v_mfma_f32_16x16x32_bf16 v[164:167], v[220:223], v[192:195], v[164:167]
ds_read_b64_tr_b16 v[92:93], v12 offset:40960
v_mfma_f32_16x16x32_bf16 v[172:175], v[220:223], v[196:199], v[172:175]
ds_read_b64_tr_b16 v[94:95], v12 offset:45056
v_mfma_f32_16x16x32_bf16 v[168:171], v[216:219], v[196:199], v[168:171]
ds_read_b128 v[68:71], v6 offset:25600
v_mfma_f32_16x16x32_bf16 v[140:143], v[212:215], v[196:199], v[140:143]
ds_read_b128 v[72:75], v6 offset:26624
v_mfma_f32_16x16x32_bf16 v[136:139], v[208:211], v[196:199], v[136:139]
ds_read_b128 v[76:79], v6 offset:27648
v_mfma_f32_16x16x32_bf16 v[144:147], v[208:211], v[200:203], v[144:147]
v_mfma_f32_16x16x32_bf16 v[148:151], v[212:215], v[200:203], v[148:151]
v_mfma_f32_16x16x32_bf16 v[176:179], v[216:219], v[200:203], v[176:179]
v_mfma_f32_16x16x32_bf16 v[180:183], v[220:223], v[200:203], v[180:183]
v_mfma_f32_16x16x32_bf16 v[188:191], v[220:223], v[204:207], v[188:191]
v_mfma_f32_16x16x32_bf16 v[184:187], v[216:219], v[204:207], v[184:187]
v_mfma_f32_16x16x32_bf16 v[156:159], v[212:215], v[204:207], v[156:159]
v_mfma_f32_16x16x32_bf16 v[152:155], v[208:211], v[204:207], v[152:155]
s_waitcnt vmcnt(0)
s_waitcnt lgkmcnt(0)
s_barrier
v_mfma_f32_16x16x32_bf16 v[128:131], v[48:51], v[32:35], v[128:131]
ds_read_b128 v[96:99], v6 offset:49152
v_mfma_f32_16x16x32_bf16 v[132:135], v[52:55], v[32:35], v[132:135]
ds_read_b64_tr_b16 v[112:113], v13 offset:0
v_mfma_f32_16x16x32_bf16 v[160:163], v[56:59], v[32:35], v[160:163]
ds_read_b64_tr_b16 v[114:115], v13 offset:4096
v_mfma_f32_16x16x32_bf16 v[164:167], v[60:63], v[32:35], v[164:167]
ds_read_b64_tr_b16 v[116:117], v14 offset:0
v_mfma_f32_16x16x32_bf16 v[172:175], v[60:63], v[36:39], v[172:175]
ds_read_b64_tr_b16 v[118:119], v14 offset:4096
v_mfma_f32_16x16x32_bf16 v[168:171], v[56:59], v[36:39], v[168:171]
ds_read_b64_tr_b16 v[120:121], v15 offset:0
v_mfma_f32_16x16x32_bf16 v[140:143], v[52:55], v[36:39], v[140:143]
ds_read_b64_tr_b16 v[122:123], v15 offset:4096
v_mfma_f32_16x16x32_bf16 v[136:139], v[48:51], v[36:39], v[136:139]
ds_read_b64_tr_b16 v[124:125], v16 offset:0
v_mfma_f32_16x16x32_bf16 v[144:147], v[48:51], v[40:43], v[144:147]
ds_read_b64_tr_b16 v[126:127], v16 offset:4096
v_mfma_f32_16x16x32_bf16 v[148:151], v[52:55], v[40:43], v[148:151]
ds_read_b128 v[100:103], v6 offset:50176
v_mfma_f32_16x16x32_bf16 v[176:179], v[56:59], v[40:43], v[176:179]
ds_read_b128 v[104:107], v6 offset:51200
v_mfma_f32_16x16x32_bf16 v[180:183], v[60:63], v[40:43], v[180:183]
ds_read_b128 v[108:111], v6 offset:52224
v_mfma_f32_16x16x32_bf16 v[188:191], v[60:63], v[44:47], v[188:191]
ds_read_b128 v[192:195], v6 offset:57344
v_mfma_f32_16x16x32_bf16 v[184:187], v[56:59], v[44:47], v[184:187]
ds_read_b64_tr_b16 v[208:209], v13 offset:8192
v_mfma_f32_16x16x32_bf16 v[156:159], v[52:55], v[44:47], v[156:159]
ds_read_b64_tr_b16 v[210:211], v13 offset:12288
v_mfma_f32_16x16x32_bf16 v[152:155], v[48:51], v[44:47], v[152:155]
ds_read_b64_tr_b16 v[212:213], v14 offset:8192
v_mfma_f32_16x16x32_bf16 v[128:131], v[80:83], v[64:67], v[128:131]
ds_read_b64_tr_b16 v[214:215], v14 offset:12288
v_mfma_f32_16x16x32_bf16 v[132:135], v[84:87], v[64:67], v[132:135]
ds_read_b64_tr_b16 v[216:217], v15 offset:8192
v_mfma_f32_16x16x32_bf16 v[160:163], v[88:91], v[64:67], v[160:163]
ds_read_b64_tr_b16 v[218:219], v15 offset:12288
v_mfma_f32_16x16x32_bf16 v[164:167], v[92:95], v[64:67], v[164:167]
ds_read_b64_tr_b16 v[220:221], v16 offset:8192
v_mfma_f32_16x16x32_bf16 v[172:175], v[92:95], v[68:71], v[172:175]
ds_read_b64_tr_b16 v[222:223], v16 offset:12288
v_mfma_f32_16x16x32_bf16 v[168:171], v[88:91], v[68:71], v[168:171]
ds_read_b128 v[196:199], v6 offset:58368
v_mfma_f32_16x16x32_bf16 v[140:143], v[84:87], v[68:71], v[140:143]
ds_read_b128 v[200:203], v6 offset:59392
v_mfma_f32_16x16x32_bf16 v[136:139], v[80:83], v[68:71], v[136:139]
ds_read_b128 v[204:207], v6 offset:60416
v_mfma_f32_16x16x32_bf16 v[144:147], v[80:83], v[72:75], v[144:147]
v_mfma_f32_16x16x32_bf16 v[148:151], v[84:87], v[72:75], v[148:151]
v_mfma_f32_16x16x32_bf16 v[176:179], v[88:91], v[72:75], v[176:179]
v_mfma_f32_16x16x32_bf16 v[180:183], v[92:95], v[72:75], v[180:183]
v_mfma_f32_16x16x32_bf16 v[188:191], v[92:95], v[76:79], v[188:191]
v_mfma_f32_16x16x32_bf16 v[184:187], v[88:91], v[76:79], v[184:187]
v_mfma_f32_16x16x32_bf16 v[156:159], v[84:87], v[76:79], v[156:159]
v_mfma_f32_16x16x32_bf16 v[152:155], v[80:83], v[76:79], v[152:155]
s_waitcnt lgkmcnt(0)
s_barrier
v_mfma_f32_16x16x32_bf16 v[128:131], v[112:115], v[96:99], v[128:131]
ds_read_b128 v[32:35], v7 offset:16384
v_mfma_f32_16x16x32_bf16 v[132:135], v[116:119], v[96:99], v[132:135]
ds_read_b64_tr_b16 v[48:49], v25 offset:16384
v_mfma_f32_16x16x32_bf16 v[160:163], v[120:123], v[96:99], v[160:163]
ds_read_b64_tr_b16 v[50:51], v25 offset:20480
v_mfma_f32_16x16x32_bf16 v[164:167], v[124:127], v[96:99], v[164:167]
ds_read_b64_tr_b16 v[52:53], v26 offset:16384
v_mfma_f32_16x16x32_bf16 v[172:175], v[124:127], v[100:103], v[172:175]
ds_read_b64_tr_b16 v[54:55], v26 offset:20480
v_mfma_f32_16x16x32_bf16 v[168:171], v[120:123], v[100:103], v[168:171]
ds_read_b64_tr_b16 v[56:57], v27 offset:16384
v_mfma_f32_16x16x32_bf16 v[140:143], v[116:119], v[100:103], v[140:143]
ds_read_b64_tr_b16 v[58:59], v27 offset:20480
v_mfma_f32_16x16x32_bf16 v[136:139], v[112:115], v[100:103], v[136:139]
ds_read_b64_tr_b16 v[60:61], v28 offset:16384
v_mfma_f32_16x16x32_bf16 v[144:147], v[112:115], v[104:107], v[144:147]
ds_read_b64_tr_b16 v[62:63], v28 offset:20480
v_mfma_f32_16x16x32_bf16 v[148:151], v[116:119], v[104:107], v[148:151]
ds_read_b128 v[36:39], v7 offset:17408
v_mfma_f32_16x16x32_bf16 v[176:179], v[120:123], v[104:107], v[176:179]
ds_read_b128 v[40:43], v7 offset:18432
v_mfma_f32_16x16x32_bf16 v[180:183], v[124:127], v[104:107], v[180:183]
ds_read_b128 v[44:47], v7 offset:19456
v_mfma_f32_16x16x32_bf16 v[188:191], v[124:127], v[108:111], v[188:191]
ds_read_b128 v[64:67], v7 offset:24576
v_mfma_f32_16x16x32_bf16 v[184:187], v[120:123], v[108:111], v[184:187]
ds_read_b64_tr_b16 v[80:81], v25 offset:24576
v_mfma_f32_16x16x32_bf16 v[156:159], v[116:119], v[108:111], v[156:159]
ds_read_b64_tr_b16 v[82:83], v25 offset:28672
v_mfma_f32_16x16x32_bf16 v[152:155], v[112:115], v[108:111], v[152:155]
ds_read_b64_tr_b16 v[84:85], v26 offset:24576
v_mfma_f32_16x16x32_bf16 v[128:131], v[208:211], v[192:195], v[128:131]
ds_read_b64_tr_b16 v[86:87], v26 offset:28672
v_mfma_f32_16x16x32_bf16 v[132:135], v[212:215], v[192:195], v[132:135]
ds_read_b64_tr_b16 v[88:89], v27 offset:24576
v_mfma_f32_16x16x32_bf16 v[160:163], v[216:219], v[192:195], v[160:163]
ds_read_b64_tr_b16 v[90:91], v27 offset:28672
v_mfma_f32_16x16x32_bf16 v[164:167], v[220:223], v[192:195], v[164:167]
ds_read_b64_tr_b16 v[92:93], v28 offset:24576
v_mfma_f32_16x16x32_bf16 v[172:175], v[220:223], v[196:199], v[172:175]
ds_read_b64_tr_b16 v[94:95], v28 offset:28672
v_mfma_f32_16x16x32_bf16 v[168:171], v[216:219], v[196:199], v[168:171]
ds_read_b128 v[68:71], v7 offset:25600
v_mfma_f32_16x16x32_bf16 v[140:143], v[212:215], v[196:199], v[140:143]
ds_read_b128 v[72:75], v7 offset:26624
v_mfma_f32_16x16x32_bf16 v[136:139], v[208:211], v[196:199], v[136:139]
ds_read_b128 v[76:79], v7 offset:27648
v_mfma_f32_16x16x32_bf16 v[144:147], v[208:211], v[200:203], v[144:147]
v_mfma_f32_16x16x32_bf16 v[148:151], v[212:215], v[200:203], v[148:151]
v_mfma_f32_16x16x32_bf16 v[176:179], v[216:219], v[200:203], v[176:179]
v_mfma_f32_16x16x32_bf16 v[180:183], v[220:223], v[200:203], v[180:183]
v_mfma_f32_16x16x32_bf16 v[188:191], v[220:223], v[204:207], v[188:191]
v_mfma_f32_16x16x32_bf16 v[184:187], v[216:219], v[204:207], v[184:187]
v_mfma_f32_16x16x32_bf16 v[156:159], v[212:215], v[204:207], v[156:159]
v_mfma_f32_16x16x32_bf16 v[152:155], v[208:211], v[204:207], v[152:155]
s_waitcnt lgkmcnt(0)
s_barrier
v_mfma_f32_16x16x32_bf16 v[128:131], v[48:51], v[32:35], v[128:131]
ds_read_b128 v[96:99], v7 offset:32768
v_mfma_f32_16x16x32_bf16 v[132:135], v[52:55], v[32:35], v[132:135]
ds_read_b64_tr_b16 v[112:113], v13 offset:49152
v_mfma_f32_16x16x32_bf16 v[160:163], v[56:59], v[32:35], v[160:163]
ds_read_b64_tr_b16 v[114:115], v13 offset:53248
v_mfma_f32_16x16x32_bf16 v[164:167], v[60:63], v[32:35], v[164:167]
ds_read_b64_tr_b16 v[116:117], v14 offset:49152
v_mfma_f32_16x16x32_bf16 v[172:175], v[60:63], v[36:39], v[172:175]
ds_read_b64_tr_b16 v[118:119], v14 offset:53248
v_mfma_f32_16x16x32_bf16 v[168:171], v[56:59], v[36:39], v[168:171]
ds_read_b64_tr_b16 v[120:121], v15 offset:49152
v_mfma_f32_16x16x32_bf16 v[140:143], v[52:55], v[36:39], v[140:143]
ds_read_b64_tr_b16 v[122:123], v15 offset:53248
v_mfma_f32_16x16x32_bf16 v[136:139], v[48:51], v[36:39], v[136:139]
ds_read_b64_tr_b16 v[124:125], v16 offset:49152
v_mfma_f32_16x16x32_bf16 v[144:147], v[48:51], v[40:43], v[144:147]
ds_read_b64_tr_b16 v[126:127], v16 offset:53248
v_mfma_f32_16x16x32_bf16 v[148:151], v[52:55], v[40:43], v[148:151]
ds_read_b128 v[100:103], v7 offset:33792
v_mfma_f32_16x16x32_bf16 v[176:179], v[56:59], v[40:43], v[176:179]
ds_read_b128 v[104:107], v7 offset:34816
v_mfma_f32_16x16x32_bf16 v[180:183], v[60:63], v[40:43], v[180:183]
ds_read_b128 v[108:111], v7 offset:35840
v_mfma_f32_16x16x32_bf16 v[188:191], v[60:63], v[44:47], v[188:191]
ds_read_b128 v[192:195], v7 offset:40960
v_mfma_f32_16x16x32_bf16 v[184:187], v[56:59], v[44:47], v[184:187]
ds_read_b64_tr_b16 v[208:209], v13 offset:57344
v_mfma_f32_16x16x32_bf16 v[156:159], v[52:55], v[44:47], v[156:159]
ds_read_b64_tr_b16 v[210:211], v13 offset:61440
v_mfma_f32_16x16x32_bf16 v[152:155], v[48:51], v[44:47], v[152:155]
ds_read_b64_tr_b16 v[212:213], v14 offset:57344
v_mfma_f32_16x16x32_bf16 v[128:131], v[80:83], v[64:67], v[128:131]
ds_read_b64_tr_b16 v[214:215], v14 offset:61440
v_mfma_f32_16x16x32_bf16 v[132:135], v[84:87], v[64:67], v[132:135]
ds_read_b64_tr_b16 v[216:217], v15 offset:57344
v_mfma_f32_16x16x32_bf16 v[160:163], v[88:91], v[64:67], v[160:163]
ds_read_b64_tr_b16 v[218:219], v15 offset:61440
v_mfma_f32_16x16x32_bf16 v[164:167], v[92:95], v[64:67], v[164:167]
ds_read_b64_tr_b16 v[220:221], v16 offset:57344
v_mfma_f32_16x16x32_bf16 v[172:175], v[92:95], v[68:71], v[172:175]
ds_read_b64_tr_b16 v[222:223], v16 offset:61440
v_mfma_f32_16x16x32_bf16 v[168:171], v[88:91], v[68:71], v[168:171]
ds_read_b128 v[196:199], v7 offset:41984
v_mfma_f32_16x16x32_bf16 v[140:143], v[84:87], v[68:71], v[140:143]
ds_read_b128 v[200:203], v7 offset:43008
v_mfma_f32_16x16x32_bf16 v[136:139], v[80:83], v[68:71], v[136:139]
ds_read_b128 v[204:207], v7 offset:44032
v_mfma_f32_16x16x32_bf16 v[144:147], v[80:83], v[72:75], v[144:147]
v_mfma_f32_16x16x32_bf16 v[148:151], v[84:87], v[72:75], v[148:151]
v_mfma_f32_16x16x32_bf16 v[176:179], v[88:91], v[72:75], v[176:179]
v_mfma_f32_16x16x32_bf16 v[180:183], v[92:95], v[72:75], v[180:183]
v_mfma_f32_16x16x32_bf16 v[188:191], v[92:95], v[76:79], v[188:191]
v_mfma_f32_16x16x32_bf16 v[184:187], v[88:91], v[76:79], v[184:187]
v_mfma_f32_16x16x32_bf16 v[156:159], v[84:87], v[76:79], v[156:159]
v_mfma_f32_16x16x32_bf16 v[152:155], v[80:83], v[76:79], v[152:155]
s_waitcnt lgkmcnt(0)
s_barrier
v_mfma_f32_16x16x32_bf16 v[128:131], v[112:115], v[96:99], v[128:131]
ds_read_b128 v[32:35], v8 offset:0
v_mfma_f32_16x16x32_bf16 v[132:135], v[116:119], v[96:99], v[132:135]
ds_read_b64_tr_b16 v[48:49], v9 offset:0
v_mfma_f32_16x16x32_bf16 v[160:163], v[120:123], v[96:99], v[160:163]
ds_read_b64_tr_b16 v[50:51], v9 offset:4096
v_mfma_f32_16x16x32_bf16 v[164:167], v[124:127], v[96:99], v[164:167]
ds_read_b64_tr_b16 v[52:53], v10 offset:0
v_mfma_f32_16x16x32_bf16 v[172:175], v[124:127], v[100:103], v[172:175]
ds_read_b64_tr_b16 v[54:55], v10 offset:4096
v_mfma_f32_16x16x32_bf16 v[168:171], v[120:123], v[100:103], v[168:171]
ds_read_b64_tr_b16 v[56:57], v11 offset:0
v_mfma_f32_16x16x32_bf16 v[140:143], v[116:119], v[100:103], v[140:143]
ds_read_b64_tr_b16 v[58:59], v11 offset:4096
v_mfma_f32_16x16x32_bf16 v[136:139], v[112:115], v[100:103], v[136:139]
ds_read_b64_tr_b16 v[60:61], v12 offset:0
v_mfma_f32_16x16x32_bf16 v[144:147], v[112:115], v[104:107], v[144:147]
ds_read_b64_tr_b16 v[62:63], v12 offset:4096
v_mfma_f32_16x16x32_bf16 v[148:151], v[116:119], v[104:107], v[148:151]
ds_read_b128 v[36:39], v8 offset:1024
v_mfma_f32_16x16x32_bf16 v[176:179], v[120:123], v[104:107], v[176:179]
ds_read_b128 v[40:43], v8 offset:2048
v_mfma_f32_16x16x32_bf16 v[180:183], v[124:127], v[104:107], v[180:183]
ds_read_b128 v[44:47], v8 offset:3072
v_mfma_f32_16x16x32_bf16 v[188:191], v[124:127], v[108:111], v[188:191]
ds_read_b128 v[64:67], v8 offset:8192
v_mfma_f32_16x16x32_bf16 v[184:187], v[120:123], v[108:111], v[184:187]
ds_read_b64_tr_b16 v[80:81], v9 offset:8192
v_mfma_f32_16x16x32_bf16 v[156:159], v[116:119], v[108:111], v[156:159]
ds_read_b64_tr_b16 v[82:83], v9 offset:12288
v_mfma_f32_16x16x32_bf16 v[152:155], v[112:115], v[108:111], v[152:155]
ds_read_b64_tr_b16 v[84:85], v10 offset:8192
v_mfma_f32_16x16x32_bf16 v[128:131], v[208:211], v[192:195], v[128:131]
ds_read_b64_tr_b16 v[86:87], v10 offset:12288
v_mfma_f32_16x16x32_bf16 v[132:135], v[212:215], v[192:195], v[132:135]
ds_read_b64_tr_b16 v[88:89], v11 offset:8192
v_mfma_f32_16x16x32_bf16 v[160:163], v[216:219], v[192:195], v[160:163]
ds_read_b64_tr_b16 v[90:91], v11 offset:12288
v_mfma_f32_16x16x32_bf16 v[164:167], v[220:223], v[192:195], v[164:167]
ds_read_b64_tr_b16 v[92:93], v12 offset:8192
v_mfma_f32_16x16x32_bf16 v[172:175], v[220:223], v[196:199], v[172:175]
ds_read_b64_tr_b16 v[94:95], v12 offset:12288
v_mfma_f32_16x16x32_bf16 v[168:171], v[216:219], v[196:199], v[168:171]
ds_read_b128 v[68:71], v8 offset:9216
v_mfma_f32_16x16x32_bf16 v[140:143], v[212:215], v[196:199], v[140:143]
ds_read_b128 v[72:75], v8 offset:10240
v_mfma_f32_16x16x32_bf16 v[136:139], v[208:211], v[196:199], v[136:139]
ds_read_b128 v[76:79], v8 offset:11264
v_mfma_f32_16x16x32_bf16 v[144:147], v[208:211], v[200:203], v[144:147]
v_mfma_f32_16x16x32_bf16 v[148:151], v[212:215], v[200:203], v[148:151]
v_mfma_f32_16x16x32_bf16 v[176:179], v[216:219], v[200:203], v[176:179]
v_mfma_f32_16x16x32_bf16 v[180:183], v[220:223], v[200:203], v[180:183]
v_mfma_f32_16x16x32_bf16 v[188:191], v[220:223], v[204:207], v[188:191]
v_mfma_f32_16x16x32_bf16 v[184:187], v[216:219], v[204:207], v[184:187]
v_mfma_f32_16x16x32_bf16 v[156:159], v[212:215], v[204:207], v[156:159]
v_mfma_f32_16x16x32_bf16 v[152:155], v[208:211], v[204:207], v[152:155]
s_waitcnt lgkmcnt(0)
s_barrier
v_mfma_f32_16x16x32_bf16 v[128:131], v[48:51], v[32:35], v[128:131]
ds_read_b128 v[96:99], v6 offset:16384
v_mfma_f32_16x16x32_bf16 v[132:135], v[52:55], v[32:35], v[132:135]
ds_read_b64_tr_b16 v[112:113], v9 offset:32768
v_mfma_f32_16x16x32_bf16 v[160:163], v[56:59], v[32:35], v[160:163]
ds_read_b64_tr_b16 v[114:115], v9 offset:36864
v_mfma_f32_16x16x32_bf16 v[164:167], v[60:63], v[32:35], v[164:167]
ds_read_b64_tr_b16 v[116:117], v10 offset:32768
v_mfma_f32_16x16x32_bf16 v[172:175], v[60:63], v[36:39], v[172:175]
ds_read_b64_tr_b16 v[118:119], v10 offset:36864
v_mfma_f32_16x16x32_bf16 v[168:171], v[56:59], v[36:39], v[168:171]
ds_read_b64_tr_b16 v[120:121], v11 offset:32768
v_mfma_f32_16x16x32_bf16 v[140:143], v[52:55], v[36:39], v[140:143]
ds_read_b64_tr_b16 v[122:123], v11 offset:36864
v_mfma_f32_16x16x32_bf16 v[136:139], v[48:51], v[36:39], v[136:139]
ds_read_b64_tr_b16 v[124:125], v12 offset:32768
v_mfma_f32_16x16x32_bf16 v[144:147], v[48:51], v[40:43], v[144:147]
ds_read_b64_tr_b16 v[126:127], v12 offset:36864
v_mfma_f32_16x16x32_bf16 v[148:151], v[52:55], v[40:43], v[148:151]
ds_read_b128 v[100:103], v6 offset:17408
v_mfma_f32_16x16x32_bf16 v[176:179], v[56:59], v[40:43], v[176:179]
ds_read_b128 v[104:107], v6 offset:18432
v_mfma_f32_16x16x32_bf16 v[180:183], v[60:63], v[40:43], v[180:183]
ds_read_b128 v[108:111], v6 offset:19456
v_mfma_f32_16x16x32_bf16 v[188:191], v[60:63], v[44:47], v[188:191]
ds_read_b128 v[192:195], v6 offset:24576
v_mfma_f32_16x16x32_bf16 v[184:187], v[56:59], v[44:47], v[184:187]
ds_read_b64_tr_b16 v[208:209], v9 offset:40960
v_mfma_f32_16x16x32_bf16 v[156:159], v[52:55], v[44:47], v[156:159]
ds_read_b64_tr_b16 v[210:211], v9 offset:45056
v_mfma_f32_16x16x32_bf16 v[152:155], v[48:51], v[44:47], v[152:155]
ds_read_b64_tr_b16 v[212:213], v10 offset:40960
v_mfma_f32_16x16x32_bf16 v[128:131], v[80:83], v[64:67], v[128:131]
ds_read_b64_tr_b16 v[214:215], v10 offset:45056
v_mfma_f32_16x16x32_bf16 v[132:135], v[84:87], v[64:67], v[132:135]
ds_read_b64_tr_b16 v[216:217], v11 offset:40960
v_mfma_f32_16x16x32_bf16 v[160:163], v[88:91], v[64:67], v[160:163]
ds_read_b64_tr_b16 v[218:219], v11 offset:45056
v_mfma_f32_16x16x32_bf16 v[164:167], v[92:95], v[64:67], v[164:167]
ds_read_b64_tr_b16 v[220:221], v12 offset:40960
v_mfma_f32_16x16x32_bf16 v[172:175], v[92:95], v[68:71], v[172:175]
ds_read_b64_tr_b16 v[222:223], v12 offset:45056
v_mfma_f32_16x16x32_bf16 v[168:171], v[88:91], v[68:71], v[168:171]
ds_read_b128 v[196:199], v6 offset:25600
v_mfma_f32_16x16x32_bf16 v[140:143], v[84:87], v[68:71], v[140:143]
ds_read_b128 v[200:203], v6 offset:26624
v_mfma_f32_16x16x32_bf16 v[136:139], v[80:83], v[68:71], v[136:139]
ds_read_b128 v[204:207], v6 offset:27648
v_mfma_f32_16x16x32_bf16 v[144:147], v[80:83], v[72:75], v[144:147]
v_mfma_f32_16x16x32_bf16 v[148:151], v[84:87], v[72:75], v[148:151]
v_mfma_f32_16x16x32_bf16 v[176:179], v[88:91], v[72:75], v[176:179]
v_mfma_f32_16x16x32_bf16 v[180:183], v[92:95], v[72:75], v[180:183]
v_mfma_f32_16x16x32_bf16 v[188:191], v[92:95], v[76:79], v[188:191]
v_mfma_f32_16x16x32_bf16 v[184:187], v[88:91], v[76:79], v[184:187]
v_mfma_f32_16x16x32_bf16 v[156:159], v[84:87], v[76:79], v[156:159]
v_mfma_f32_16x16x32_bf16 v[152:155], v[80:83], v[76:79], v[152:155]
s_waitcnt lgkmcnt(0)
s_barrier
v_mfma_f32_16x16x32_bf16 v[128:131], v[112:115], v[96:99], v[128:131]
ds_read_b128 v[32:35], v6 offset:49152
v_mfma_f32_16x16x32_bf16 v[132:135], v[116:119], v[96:99], v[132:135]
ds_read_b64_tr_b16 v[48:49], v13 offset:0
v_mfma_f32_16x16x32_bf16 v[160:163], v[120:123], v[96:99], v[160:163]
ds_read_b64_tr_b16 v[50:51], v13 offset:4096
v_mfma_f32_16x16x32_bf16 v[164:167], v[124:127], v[96:99], v[164:167]
ds_read_b64_tr_b16 v[52:53], v14 offset:0
v_mfma_f32_16x16x32_bf16 v[172:175], v[124:127], v[100:103], v[172:175]
ds_read_b64_tr_b16 v[54:55], v14 offset:4096
v_mfma_f32_16x16x32_bf16 v[168:171], v[120:123], v[100:103], v[168:171]
ds_read_b64_tr_b16 v[56:57], v15 offset:0
v_mfma_f32_16x16x32_bf16 v[140:143], v[116:119], v[100:103], v[140:143]
ds_read_b64_tr_b16 v[58:59], v15 offset:4096
v_mfma_f32_16x16x32_bf16 v[136:139], v[112:115], v[100:103], v[136:139]
ds_read_b64_tr_b16 v[60:61], v16 offset:0
v_mfma_f32_16x16x32_bf16 v[144:147], v[112:115], v[104:107], v[144:147]
ds_read_b64_tr_b16 v[62:63], v16 offset:4096
v_mfma_f32_16x16x32_bf16 v[148:151], v[116:119], v[104:107], v[148:151]
ds_read_b128 v[36:39], v6 offset:50176
v_mfma_f32_16x16x32_bf16 v[176:179], v[120:123], v[104:107], v[176:179]
ds_read_b128 v[40:43], v6 offset:51200
v_mfma_f32_16x16x32_bf16 v[180:183], v[124:127], v[104:107], v[180:183]
ds_read_b128 v[44:47], v6 offset:52224
v_mfma_f32_16x16x32_bf16 v[188:191], v[124:127], v[108:111], v[188:191]
ds_read_b128 v[64:67], v6 offset:57344
v_mfma_f32_16x16x32_bf16 v[184:187], v[120:123], v[108:111], v[184:187]
ds_read_b64_tr_b16 v[80:81], v13 offset:8192
v_mfma_f32_16x16x32_bf16 v[156:159], v[116:119], v[108:111], v[156:159]
ds_read_b64_tr_b16 v[82:83], v13 offset:12288
v_mfma_f32_16x16x32_bf16 v[152:155], v[112:115], v[108:111], v[152:155]
ds_read_b64_tr_b16 v[84:85], v14 offset:8192
v_mfma_f32_16x16x32_bf16 v[128:131], v[208:211], v[192:195], v[128:131]
ds_read_b64_tr_b16 v[86:87], v14 offset:12288
v_mfma_f32_16x16x32_bf16 v[132:135], v[212:215], v[192:195], v[132:135]
ds_read_b64_tr_b16 v[88:89], v15 offset:8192
v_mfma_f32_16x16x32_bf16 v[160:163], v[216:219], v[192:195], v[160:163]
ds_read_b64_tr_b16 v[90:91], v15 offset:12288
v_mfma_f32_16x16x32_bf16 v[164:167], v[220:223], v[192:195], v[164:167]
ds_read_b64_tr_b16 v[92:93], v16 offset:8192
v_mfma_f32_16x16x32_bf16 v[172:175], v[220:223], v[196:199], v[172:175]
ds_read_b64_tr_b16 v[94:95], v16 offset:12288
v_mfma_f32_16x16x32_bf16 v[168:171], v[216:219], v[196:199], v[168:171]
ds_read_b128 v[68:71], v6 offset:58368
s_branch Lov_12
.p2align 12
.fill 96, 4, 0xbf800000
Lst_12_0:
s_branch Lwr_179
Lst_12_1:
s_branch Lst_16_0
s_nop 0
Lov_12:
v_mfma_f32_16x16x32_bf16 v[140:143], v[212:215], v[196:199], v[140:143]
ds_read_b128 v[72:75], v6 offset:59392
v_mfma_f32_16x16x32_bf16 v[136:139], v[208:211], v[196:199], v[136:139]
ds_read_b128 v[76:79], v6 offset:60416
v_mfma_f32_16x16x32_bf16 v[144:147], v[208:211], v[200:203], v[144:147]
v_mfma_f32_16x16x32_bf16 v[148:151], v[212:215], v[200:203], v[148:151]
v_mfma_f32_16x16x32_bf16 v[176:179], v[216:219], v[200:203], v[176:179]
v_mfma_f32_16x16x32_bf16 v[180:183], v[220:223], v[200:203], v[180:183]
v_mfma_f32_16x16x32_bf16 v[188:191], v[220:223], v[204:207], v[188:191]
v_mfma_f32_16x16x32_bf16 v[184:187], v[216:219], v[204:207], v[184:187]
v_mfma_f32_16x16x32_bf16 v[156:159], v[212:215], v[204:207], v[156:159]
v_mfma_f32_16x16x32_bf16 v[152:155], v[208:211], v[204:207], v[152:155]
s_waitcnt lgkmcnt(0)
s_barrier
v_mfma_f32_16x16x32_bf16 v[128:131], v[48:51], v[32:35], v[128:131]
ds_read_b128 v[96:99], v7 offset:16384
v_mfma_f32_16x16x32_bf16 v[132:135], v[52:55], v[32:35], v[132:135]
ds_read_b64_tr_b16 v[112:113], v25 offset:16384
v_mfma_f32_16x16x32_bf16 v[160:163], v[56:59], v[32:35], v[160:163]
ds_read_b64_tr_b16 v[114:115], v25 offset:20480
v_mfma_f32_16x16x32_bf16 v[164:167], v[60:63], v[32:35], v[164:167]
ds_read_b64_tr_b16 v[116:117], v26 offset:16384
v_mfma_f32_16x16x32_bf16 v[172:175], v[60:63], v[36:39], v[172:175]
ds_read_b64_tr_b16 v[118:119], v26 offset:20480
v_mfma_f32_16x16x32_bf16 v[168:171], v[56:59], v[36:39], v[168:171]
ds_read_b64_tr_b16 v[120:121], v27 offset:16384
v_mfma_f32_16x16x32_bf16 v[140:143], v[52:55], v[36:39], v[140:143]
ds_read_b64_tr_b16 v[122:123], v27 offset:20480
v_mfma_f32_16x16x32_bf16 v[136:139], v[48:51], v[36:39], v[136:139]
ds_read_b64_tr_b16 v[124:125], v28 offset:16384
v_mfma_f32_16x16x32_bf16 v[144:147], v[48:51], v[40:43], v[144:147]
ds_read_b64_tr_b16 v[126:127], v28 offset:20480
v_mfma_f32_16x16x32_bf16 v[148:151], v[52:55], v[40:43], v[148:151]
ds_read_b128 v[100:103], v7 offset:17408
v_mfma_f32_16x16x32_bf16 v[176:179], v[56:59], v[40:43], v[176:179]
ds_read_b128 v[104:107], v7 offset:18432
v_mfma_f32_16x16x32_bf16 v[180:183], v[60:63], v[40:43], v[180:183]
ds_read_b128 v[108:111], v7 offset:19456
v_mfma_f32_16x16x32_bf16 v[188:191], v[60:63], v[44:47], v[188:191]
ds_read_b128 v[192:195], v7 offset:24576
v_mfma_f32_16x16x32_bf16 v[184:187], v[56:59], v[44:47], v[184:187]
ds_read_b64_tr_b16 v[208:209], v25 offset:24576
v_mfma_f32_16x16x32_bf16 v[156:159], v[52:55], v[44:47], v[156:159]
ds_read_b64_tr_b16 v[210:211], v25 offset:28672
v_mfma_f32_16x16x32_bf16 v[152:155], v[48:51], v[44:47], v[152:155]
ds_read_b64_tr_b16 v[212:213], v26 offset:24576
v_mfma_f32_16x16x32_bf16 v[128:131], v[80:83], v[64:67], v[128:131]
ds_read_b64_tr_b16 v[214:215], v26 offset:28672
v_mfma_f32_16x16x32_bf16 v[132:135], v[84:87], v[64:67], v[132:135]
ds_read_b64_tr_b16 v[216:217], v27 offset:24576
v_mfma_f32_16x16x32_bf16 v[160:163], v[88:91], v[64:67], v[160:163]
ds_read_b64_tr_b16 v[218:219], v27 offset:28672
v_mfma_f32_16x16x32_bf16 v[164:167], v[92:95], v[64:67], v[164:167]
ds_read_b64_tr_b16 v[220:221], v28 offset:24576
v_mfma_f32_16x16x32_bf16 v[172:175], v[92:95], v[68:71], v[172:175]
ds_read_b64_tr_b16 v[222:223], v28 offset:28672
v_mfma_f32_16x16x32_bf16 v[168:171], v[88:91], v[68:71], v[168:171]
ds_read_b128 v[196:199], v7 offset:25600
v_mfma_f32_16x16x32_bf16 v[140:143], v[84:87], v[68:71], v[140:143]
ds_read_b128 v[200:203], v7 offset:26624
v_mfma_f32_16x16x32_bf16 v[136:139], v[80:83], v[68:71], v[136:139]
ds_read_b128 v[204:207], v7 offset:27648
v_mfma_f32_16x16x32_bf16 v[144:147], v[80:83], v[72:75], v[144:147]
v_mfma_f32_16x16x32_bf16 v[148:151], v[84:87], v[72:75], v[148:151]
v_mfma_f32_16x16x32_bf16 v[176:179], v[88:91], v[72:75], v[176:179]
v_mfma_f32_16x16x32_bf16 v[180:183], v[92:95], v[72:75], v[180:183]
v_mfma_f32_16x16x32_bf16 v[188:191], v[92:95], v[76:79], v[188:191]
v_mfma_f32_16x16x32_bf16 v[184:187], v[88:91], v[76:79], v[184:187]
v_mfma_f32_16x16x32_bf16 v[156:159], v[84:87], v[76:79], v[156:159]
v_mfma_f32_16x16x32_bf16 v[152:155], v[80:83], v[76:79], v[152:155]
s_waitcnt lgkmcnt(0)
s_barrier
v_mfma_f32_16x16x32_bf16 v[128:131], v[112:115], v[96:99], v[128:131]
ds_read_b128 v[32:35], v7 offset:32768
v_mfma_f32_16x16x32_bf16 v[132:135], v[116:119], v[96:99], v[132:135]
ds_read_b64_tr_b16 v[48:49], v13 offset:49152
v_mfma_f32_16x16x32_bf16 v[160:163], v[120:123], v[96:99], v[160:163]
ds_read_b64_tr_b16 v[50:51], v13 offset:53248
v_mfma_f32_16x16x32_bf16 v[164:167], v[124:127], v[96:99], v[164:167]
ds_read_b64_tr_b16 v[52:53], v14 offset:49152
v_mfma_f32_16x16x32_bf16 v[172:175], v[124:127], v[100:103], v[172:175]
ds_read_b64_tr_b16 v[54:55], v14 offset:53248
v_mfma_f32_16x16x32_bf16 v[168:171], v[120:123], v[100:103], v[168:171]
ds_read_b64_tr_b16 v[56:57], v15 offset:49152
v_mfma_f32_16x16x32_bf16 v[140:143], v[116:119], v[100:103], v[140:143]
ds_read_b64_tr_b16 v[58:59], v15 offset:53248
v_mfma_f32_16x16x32_bf16 v[136:139], v[112:115], v[100:103], v[136:139]
ds_read_b64_tr_b16 v[60:61], v16 offset:49152
v_mfma_f32_16x16x32_bf16 v[144:147], v[112:115], v[104:107], v[144:147]
ds_read_b64_tr_b16 v[62:63], v16 offset:53248
v_mfma_f32_16x16x32_bf16 v[148:151], v[116:119], v[104:107], v[148:151]
ds_read_b128 v[36:39], v7 offset:33792
v_mfma_f32_16x16x32_bf16 v[176:179], v[120:123], v[104:107], v[176:179]
ds_read_b128 v[40:43], v7 offset:34816
v_mfma_f32_16x16x32_bf16 v[180:183], v[124:127], v[104:107], v[180:183]
ds_read_b128 v[44:47], v7 offset:35840
v_mfma_f32_16x16x32_bf16 v[188:191], v[124:127], v[108:111], v[188:191]
ds_read_b128 v[64:67], v7 offset:40960
v_mfma_f32_16x16x32_bf16 v[184:187], v[120:123], v[108:111], v[184:187]
ds_read_b64_tr_b16 v[80:81], v13 offset:57344
v_mfma_f32_16x16x32_bf16 v[156:159], v[116:119], v[108:111], v[156:159]
ds_read_b64_tr_b16 v[82:83], v13 offset:61440
v_mfma_f32_16x16x32_bf16 v[152:155], v[112:115], v[108:111], v[152:155]
ds_read_b64_tr_b16 v[84:85], v14 offset:57344
v_mfma_f32_16x16x32_bf16 v[128:131], v[208:211], v[192:195], v[128:131]
ds_read_b64_tr_b16 v[86:87], v14 offset:61440
v_mfma_f32_16x16x32_bf16 v[132:135], v[212:215], v[192:195], v[132:135]
ds_read_b64_tr_b16 v[88:89], v15 offset:57344
v_mfma_f32_16x16x32_bf16 v[160:163], v[216:219], v[192:195], v[160:163]
ds_read_b64_tr_b16 v[90:91], v15 offset:61440
v_mfma_f32_16x16x32_bf16 v[164:167], v[220:223], v[192:195], v[164:167]
ds_read_b64_tr_b16 v[92:93], v16 offset:57344
v_mfma_f32_16x16x32_bf16 v[172:175], v[220:223], v[196:199], v[172:175]
ds_read_b64_tr_b16 v[94:95], v16 offset:61440
v_mfma_f32_16x16x32_bf16 v[168:171], v[216:219], v[196:199], v[168:171]
ds_read_b128 v[68:71], v7 offset:41984
v_mfma_f32_16x16x32_bf16 v[140:143], v[212:215], v[196:199], v[140:143]
ds_read_b128 v[72:75], v7 offset:43008
v_mfma_f32_16x16x32_bf16 v[136:139], v[208:211], v[196:199], v[136:139]
ds_read_b128 v[76:79], v7 offset:44032
v_mfma_f32_16x16x32_bf16 v[144:147], v[208:211], v[200:203], v[144:147]
v_mfma_f32_16x16x32_bf16 v[148:151], v[212:215], v[200:203], v[148:151]
v_mfma_f32_16x16x32_bf16 v[176:179], v[216:219], v[200:203], v[176:179]
v_mfma_f32_16x16x32_bf16 v[180:183], v[220:223], v[200:203], v[180:183]
v_mfma_f32_16x16x32_bf16 v[188:191], v[220:223], v[204:207], v[188:191]
v_mfma_f32_16x16x32_bf16 v[184:187], v[216:219], v[204:207], v[184:187]
v_mfma_f32_16x16x32_bf16 v[156:159], v[212:215], v[204:207], v[156:159]
v_mfma_f32_16x16x32_bf16 v[152:155], v[208:211], v[204:207], v[152:155]
s_waitcnt lgkmcnt(0)
s_barrier
v_mfma_f32_16x16x32_bf16 v[128:131], v[48:51], v[32:35], v[128:131]
ds_read_b128 v[96:99], v8 offset:0
v_mfma_f32_16x16x32_bf16 v[132:135], v[52:55], v[32:35], v[132:135]
ds_read_b64_tr_b16 v[112:113], v9 offset:0
v_mfma_f32_16x16x32_bf16 v[160:163], v[56:59], v[32:35], v[160:163]
ds_read_b64_tr_b16 v[114:115], v9 offset:4096
v_mfma_f32_16x16x32_bf16 v[164:167], v[60:63], v[32:35], v[164:167]
ds_read_b64_tr_b16 v[116:117], v10 offset:0
v_mfma_f32_16x16x32_bf16 v[172:175], v[60:63], v[36:39], v[172:175]
ds_read_b64_tr_b16 v[118:119], v10 offset:4096
v_mfma_f32_16x16x32_bf16 v[168:171], v[56:59], v[36:39], v[168:171]
ds_read_b64_tr_b16 v[120:121], v11 offset:0
v_mfma_f32_16x16x32_bf16 v[140:143], v[52:55], v[36:39], v[140:143]
ds_read_b64_tr_b16 v[122:123], v11 offset:4096
v_mfma_f32_16x16x32_bf16 v[136:139], v[48:51], v[36:39], v[136:139]
ds_read_b64_tr_b16 v[124:125], v12 offset:0
v_mfma_f32_16x16x32_bf16 v[144:147], v[48:51], v[40:43], v[144:147]
ds_read_b64_tr_b16 v[126:127], v12 offset:4096
v_mfma_f32_16x16x32_bf16 v[148:151], v[52:55], v[40:43], v[148:151]
ds_read_b128 v[100:103], v8 offset:1024
v_mfma_f32_16x16x32_bf16 v[176:179], v[56:59], v[40:43], v[176:179]
ds_read_b128 v[104:107], v8 offset:2048
v_mfma_f32_16x16x32_bf16 v[180:183], v[60:63], v[40:43], v[180:183]
ds_read_b128 v[108:111], v8 offset:3072
v_mfma_f32_16x16x32_bf16 v[188:191], v[60:63], v[44:47], v[188:191]
ds_read_b128 v[192:195], v8 offset:8192
v_mfma_f32_16x16x32_bf16 v[184:187], v[56:59], v[44:47], v[184:187]
ds_read_b64_tr_b16 v[208:209], v9 offset:8192
v_mfma_f32_16x16x32_bf16 v[156:159], v[52:55], v[44:47], v[156:159]
ds_read_b64_tr_b16 v[210:211], v9 offset:12288
v_mfma_f32_16x16x32_bf16 v[152:155], v[48:51], v[44:47], v[152:155]
ds_read_b64_tr_b16 v[212:213], v10 offset:8192
v_mfma_f32_16x16x32_bf16 v[128:131], v[80:83], v[64:67], v[128:131]
ds_read_b64_tr_b16 v[214:215], v10 offset:12288
v_mfma_f32_16x16x32_bf16 v[132:135], v[84:87], v[64:67], v[132:135]
ds_read_b64_tr_b16 v[216:217], v11 offset:8192
v_mfma_f32_16x16x32_bf16 v[160:163], v[88:91], v[64:67], v[160:163]
ds_read_b64_tr_b16 v[218:219], v11 offset:12288
v_mfma_f32_16x16x32_bf16 v[164:167], v[92:95], v[64:67], v[164:167]
ds_read_b64_tr_b16 v[220:221], v12 offset:8192
v_mfma_f32_16x16x32_bf16 v[172:175], v[92:95], v[68:71], v[172:175]
ds_read_b64_tr_b16 v[222:223], v12 offset:12288
v_mfma_f32_16x16x32_bf16 v[168:171], v[88:91], v[68:71], v[168:171]
ds_read_b128 v[196:199], v8 offset:9216
v_mfma_f32_16x16x32_bf16 v[140:143], v[84:87], v[68:71], v[140:143]
ds_read_b128 v[200:203], v8 offset:10240
v_mfma_f32_16x16x32_bf16 v[136:139], v[80:83], v[68:71], v[136:139]
ds_read_b128 v[204:207], v8 offset:11264
v_mfma_f32_16x16x32_bf16 v[144:147], v[80:83], v[72:75], v[144:147]
v_mfma_f32_16x16x32_bf16 v[148:151], v[84:87], v[72:75], v[148:151]
v_mfma_f32_16x16x32_bf16 v[176:179], v[88:91], v[72:75], v[176:179]
v_mfma_f32_16x16x32_bf16 v[180:183], v[92:95], v[72:75], v[180:183]
v_mfma_f32_16x16x32_bf16 v[188:191], v[92:95], v[76:79], v[188:191]
v_mfma_f32_16x16x32_bf16 v[184:187], v[88:91], v[76:79], v[184:187]
v_mfma_f32_16x16x32_bf16 v[156:159], v[84:87], v[76:79], v[156:159]
v_mfma_f32_16x16x32_bf16 v[152:155], v[80:83], v[76:79], v[152:155]
s_sub_u32 s41, s41, 1
s_cmp_lg_u32 s41, 0
s_cbranch_scc1 Lk4_143
s_waitcnt lgkmcnt(0)
s_barrier
v_mfma_f32_16x16x32_bf16 v[128:131], v[112:115], v[96:99], v[128:131]
ds_read_b128 v[32:35], v6 offset:16384
v_mfma_f32_16x16x32_bf16 v[132:135], v[116:119], v[96:99], v[132:135]
ds_read_b64_tr_b16 v[48:49], v224 offset:32768
v_mfma_f32_16x16x32_bf16 v[160:163], v[120:123], v[96:99], v[160:163]
ds_read_b64_tr_b16 v[50:51], v224 offset:34816
v_mfma_f32_16x16x32_bf16 v[164:167], v[124:127], v[96:99], v[164:167]
ds_read_b64_tr_b16 v[52:53], v225 offset:32768
v_mfma_f32_16x16x32_bf16 v[172:175], v[124:127], v[100:103], v[172:175]
ds_read_b64_tr_b16 v[54:55], v225 offset:34816
v_mfma_f32_16x16x32_bf16 v[168:171], v[120:123], v[100:103], v[168:171]
ds_read_b128 v[36:39], v6 offset:17408
v_mfma_f32_16x16x32_bf16 v[140:143], v[116:119], v[100:103], v[140:143]
ds_read_b128 v[40:43], v6 offset:18432
v_mfma_f32_16x16x32_bf16 v[136:139], v[112:115], v[100:103], v[136:139]
ds_read_b128 v[44:47], v6 offset:19456
v_mfma_f32_16x16x32_bf16 v[144:147], v[112:115], v[104:107], v[144:147]
ds_read_b128 v[64:67], v6 offset:24576
v_mfma_f32_16x16x32_bf16 v[148:151], v[116:119], v[104:107], v[148:151]
ds_read_b64_tr_b16 v[80:81], v224 offset:36864
v_mfma_f32_16x16x32_bf16 v[176:179], v[120:123], v[104:107], v[176:179]
ds_read_b64_tr_b16 v[82:83], v224 offset:38912
v_mfma_f32_16x16x32_bf16 v[180:183], v[124:127], v[104:107], v[180:183]
ds_read_b64_tr_b16 v[84:85], v225 offset:36864
v_mfma_f32_16x16x32_bf16 v[188:191], v[124:127], v[108:111], v[188:191]
ds_read_b64_tr_b16 v[86:87], v225 offset:38912
v_mfma_f32_16x16x32_bf16 v[184:187], v[120:123], v[108:111], v[184:187]
ds_read_b128 v[68:71], v6 offset:25600
v_mfma_f32_16x16x32_bf16 v[156:159], v[116:119], v[108:111], v[156:159]
ds_read_b128 v[72:75], v6 offset:26624
v_mfma_f32_16x16x32_bf16 v[152:155], v[112:115], v[108:111], v[152:155]
ds_read_b128 v[76:79], v6 offset:27648
v_mfma_f32_16x16x32_bf16 v[128:131], v[208:211], v[192:195], v[128:131]
v_mfma_f32_16x16x32_bf16 v[132:135], v[212:215], v[192:195], v[132:135]
v_mfma_f32_16x16x32_bf16 v[160:163], v[216:219], v[192:195], v[160:163]
v_mfma_f32_16x16x32_bf16 v[164:167], v[220:223], v[192:195], v[164:167]
v_mfma_f32_16x16x32_bf16 v[172:175], v[220:223], v[196:199], v[172:175]
v_mfma_f32_16x16x32_bf16 v[168:171], v[216:219], v[196:199], v[168:171]
v_mfma_f32_16x16x32_bf16 v[140:143], v[212:215], v[196:199], v[140:143]
v_mfma_f32_16x16x32_bf16 v[136:139], v[208:211], v[196:199], v[136:139]
v_mfma_f32_16x16x32_bf16 v[144:147], v[208:211], v[200:203], v[144:147]
v_mfma_f32_16x16x32_bf16 v[148:151], v[212:215], v[200:203], v[148:151]
v_mfma_f32_16x16x32_bf16 v[176:179], v[216:219], v[200:203], v[176:179]
v_mfma_f32_16x16x32_bf16 v[180:183], v[220:223], v[200:203], v[180:183]
v_mfma_f32_16x16x32_bf16 v[188:191], v[220:223], v[204:207], v[188:191]
v_mfma_f32_16x16x32_bf16 v[184:187], v[216:219], v[204:207], v[184:187]
v_mfma_f32_16x16x32_bf16 v[156:159], v[212:215], v[204:207], v[156:159]
v_mfma_f32_16x16x32_bf16 v[152:155], v[208:211], v[204:207], v[152:155]
s_waitcnt lgkmcnt(0)
s_barrier
v_mfma_f32_16x16x32_bf16 v[128:131], v[48:51], v[32:35], v[128:131]
ds_read_b128 v[96:99], v6 offset:49152
ds_read_b64_tr_b16 v[112:113], v226 offset:0
v_mfma_f32_16x16x32_bf16 v[132:135], v[52:55], v[32:35], v[132:135]
ds_read_b64_tr_b16 v[114:115], v226 offset:2048
ds_read_b64_tr_b16 v[116:117], v227 offset:0
v_mfma_f32_16x16x32_bf16 v[140:143], v[52:55], v[36:39], v[140:143]
ds_read_b64_tr_b16 v[118:119], v227 offset:2048
ds_read_b128 v[100:103], v6 offset:50176
v_mfma_f32_16x16x32_bf16 v[136:139], v[48:51], v[36:39], v[136:139]
ds_read_b128 v[104:107], v6 offset:51200
ds_read_b128 v[108:111], v6 offset:52224
v_mfma_f32_16x16x32_bf16 v[144:147], v[48:51], v[40:43], v[144:147]
ds_read_b128 v[192:195], v6 offset:57344
v_mfma_f32_16x16x32_bf16 v[148:151], v[52:55], v[40:43], v[148:151]
ds_read_b64_tr_b16 v[208:209], v226 offset:4096
v_mfma_f32_16x16x32_bf16 v[156:159], v[52:55], v[44:47], v[156:159]
ds_read_b64_tr_b16 v[210:211], v226 offset:6144
v_cvt_pk_bf16_f32 v160, v160, v161
v_cvt_pk_bf16_f32 v161, v162, v163
v_mfma_f32_16x16x32_bf16 v[152:155], v[48:51], v[44:47], v[152:155]
ds_read_b64_tr_b16 v[212:213], v227 offset:4096
v_cvt_pk_bf16_f32 v162, v164, v165
v_cvt_pk_bf16_f32 v163, v166, v167
v_mfma_f32_16x16x32_bf16 v[128:131], v[80:83], v[64:67], v[128:131]
ds_read_b64_tr_b16 v[214:215], v227 offset:6144
v_cvt_pk_bf16_f32 v164, v168, v169
v_cvt_pk_bf16_f32 v165, v170, v171
v_mfma_f32_16x16x32_bf16 v[132:135], v[84:87], v[64:67], v[132:135]
ds_read_b128 v[196:199], v6 offset:58368
v_cvt_pk_bf16_f32 v166, v172, v173
v_cvt_pk_bf16_f32 v167, v174, v175
v_mfma_f32_16x16x32_bf16 v[140:143], v[84:87], v[68:71], v[140:143]
ds_read_b128 v[200:203], v6 offset:59392
v_cvt_pk_bf16_f32 v168, v176, v177
v_cvt_pk_bf16_f32 v169, v178, v179
v_mfma_f32_16x16x32_bf16 v[136:139], v[80:83], v[68:71], v[136:139]
ds_read_b128 v[204:207], v6 offset:60416
v_cvt_pk_bf16_f32 v170, v180, v181
v_cvt_pk_bf16_f32 v171, v182, v183
v_mfma_f32_16x16x32_bf16 v[144:147], v[80:83], v[72:75], v[144:147]
v_cvt_pk_bf16_f32 v172, v184, v185
v_cvt_pk_bf16_f32 v173, v186, v187
v_mfma_f32_16x16x32_bf16 v[148:151], v[84:87], v[72:75], v[148:151]
v_cvt_pk_bf16_f32 v174, v188, v189
v_cvt_pk_bf16_f32 v175, v190, v191
v_mfma_f32_16x16x32_bf16 v[156:159], v[84:87], v[76:79], v[156:159]
v_mfma_f32_16x16x32_bf16 v[152:155], v[80:83], v[76:79], v[152:155]
buffer_store_dwordx4 v[160:163], v2, s[84:87], s45 offen offset:0 sc1
s_waitcnt lgkmcnt(0)
s_barrier
v_mfma_f32_16x16x32_bf16 v[128:131], v[112:115], v[96:99], v[128:131]
ds_read_b128 v[32:35], v7 offset:16384
ds_read_b64_tr_b16 v[48:49], v228 offset:16384
v_mfma_f32_16x16x32_bf16 v[132:135], v[116:119], v[96:99], v[132:135]
ds_read_b64_tr_b16 v[50:51], v228 offset:18432
ds_read_b64_tr_b16 v[52:53], v229 offset:16384
v_mfma_f32_16x16x32_bf16 v[140:143], v[116:119], v[100:103], v[140:143]
ds_read_b64_tr_b16 v[54:55], v229 offset:18432
ds_read_b128 v[36:39], v7 offset:17408
v_mfma_f32_16x16x32_bf16 v[136:139], v[112:115], v[100:103], v[136:139]
ds_read_b128 v[40:43], v7 offset:18432
ds_read_b128 v[44:47], v7 offset:19456
v_mfma_f32_16x16x32_bf16 v[144:147], v[112:115], v[104:107], v[144:147]
ds_read_b128 v[64:67], v7 offset:24576
v_mfma_f32_16x16x32_bf16 v[148:151], v[116:119], v[104:107], v[148:151]
ds_read_b64_tr_b16 v[80:81], v228 offset:20480
v_mfma_f32_16x16x32_bf16 v[156:159], v[116:119], v[108:111], v[156:159]
ds_read_b64_tr_b16 v[82:83], v228 offset:22528
v_mfma_f32_16x16x32_bf16 v[152:155], v[112:115], v[108:111], v[152:155]
ds_read_b64_tr_b16 v[84:85], v229 offset:20480
v_mfma_f32_16x16x32_bf16 v[128:131], v[208:211], v[192:195], v[128:131]
ds_read_b64_tr_b16 v[86:87], v229 offset:22528
buffer_store_dwordx4 v[164:167], v2, s[84:87], s45 offen offset:1024 sc1
v_mfma_f32_16x16x32_bf16 v[132:135], v[212:215], v[192:195], v[132:135]
ds_read_b128 v[68:71], v7 offset:25600
v_mfma_f32_16x16x32_bf16 v[140:143], v[212:215], v[196:199], v[140:143]
ds_read_b128 v[72:75], v7 offset:26624
v_mfma_f32_16x16x32_bf16 v[136:139], v[208:211], v[196:199], v[136:139]
ds_read_b128 v[76:79], v7 offset:27648
v_mfma_f32_16x16x32_bf16 v[144:147], v[208:211], v[200:203], v[144:147]
v_mfma_f32_16x16x32_bf16 v[148:151], v[212:215], v[200:203], v[148:151]
v_mfma_f32_16x16x32_bf16 v[156:159], v[212:215], v[204:207], v[156:159]
v_mfma_f32_16x16x32_bf16 v[152:155], v[208:211], v[204:207], v[152:155]
s_waitcnt lgkmcnt(0)
s_barrier
v_mfma_f32_16x16x32_bf16 v[128:131], v[48:51], v[32:35], v[128:131]
ds_read_b128 v[96:99], v7 offset:32768
ds_read_b64_tr_b16 v[112:113], v226 offset:49152
v_mfma_f32_16x16x32_bf16 v[132:135], v[52:55], v[32:35], v[132:135]
ds_read_b64_tr_b16 v[114:115], v226 offset:51200
ds_read_b64_tr_b16 v[116:117], v227 offset:49152
v_mfma_f32_16x16x32_bf16 v[140:143], v[52:55], v[36:39], v[140:143]
ds_read_b64_tr_b16 v[118:119], v227 offset:51200
ds_read_b128 v[100:103], v7 offset:33792
v_mfma_f32_16x16x32_bf16 v[136:139], v[48:51], v[36:39], v[136:139]
ds_read_b128 v[104:107], v7 offset:34816
ds_read_b128 v[108:111], v7 offset:35840
v_mfma_f32_16x16x32_bf16 v[144:147], v[48:51], v[40:43], v[144:147]
ds_read_b128 v[192:195], v7 offset:40960
v_mfma_f32_16x16x32_bf16 v[148:151], v[52:55], v[40:43], v[148:151]
ds_read_b64_tr_b16 v[208:209], v226 offset:53248
v_mfma_f32_16x16x32_bf16 v[156:159], v[52:55], v[44:47], v[156:159]
ds_read_b64_tr_b16 v[210:211], v226 offset:55296
v_mfma_f32_16x16x32_bf16 v[152:155], v[48:51], v[44:47], v[152:155]
ds_read_b64_tr_b16 v[212:213], v227 offset:53248
v_mfma_f32_16x16x32_bf16 v[128:131], v[80:83], v[64:67], v[128:131]
ds_read_b64_tr_b16 v[214:215], v227 offset:55296
buffer_store_dwordx4 v[168:171], v2, s[84:87], s45 offen offset:2048 sc1
v_mfma_f32_16x16x32_bf16 v[132:135], v[84:87], v[64:67], v[132:135]
ds_read_b128 v[196:199], v7 offset:41984
v_mfma_f32_16x16x32_bf16 v[140:143], v[84:87], v[68:71], v[140:143]
ds_read_b128 v[200:203], v7 offset:43008
v_mfma_f32_16x16x32_bf16 v[136:139], v[80:83], v[68:71], v[136:139]
ds_read_b128 v[204:207], v7 offset:44032
v_mfma_f32_16x16x32_bf16 v[144:147], v[80:83], v[72:75], v[144:147]
v_mfma_f32_16x16x32_bf16 v[148:151], v[84:87], v[72:75], v[148:151]
v_mfma_f32_16x16x32_bf16 v[156:159], v[84:87], v[76:79], v[156:159]
v_mfma_f32_16x16x32_bf16 v[152:155], v[80:83], v[76:79], v[152:155]
s_waitcnt lgkmcnt(0)
s_barrier
v_mfma_f32_16x16x32_bf16 v[128:131], v[112:115], v[96:99], v[128:131]
ds_read_b128 v[32:35], v8 offset:0
ds_read_b64_tr_b16 v[48:49], v224 offset:0
v_mfma_f32_16x16x32_bf16 v[132:135], v[116:119], v[96:99], v[132:135]
ds_read_b64_tr_b16 v[50:51], v224 offset:2048
ds_read_b64_tr_b16 v[52:53], v225 offset:0
v_mfma_f32_16x16x32_bf16 v[140:143], v[116:119], v[100:103], v[140:143]
ds_read_b64_tr_b16 v[54:55], v225 offset:2048
ds_read_b128 v[36:39], v8 offset:1024
v_mfma_f32_16x16x32_bf16 v[136:139], v[112:115], v[100:103], v[136:139]
ds_read_b128 v[40:43], v8 offset:2048
ds_read_b128 v[44:47], v8 offset:3072
v_mfma_f32_16x16x32_bf16 v[144:147], v[112:115], v[104:107], v[144:147]
ds_read_b128 v[64:67], v8 offset:8192
v_mfma_f32_16x16x32_bf16 v[148:151], v[116:119], v[104:107], v[148:151]
ds_read_b64_tr_b16 v[80:81], v224 offset:4096
v_mfma_f32_16x16x32_bf16 v[156:159], v[116:119], v[108:111], v[156:159]
ds_read_b64_tr_b16 v[82:83], v224 offset:6144
v_mfma_f32_16x16x32_bf16 v[152:155], v[112:115], v[108:111], v[152:155]
ds_read_b64_tr_b16 v[84:85], v225 offset:4096
v_mfma_f32_16x16x32_bf16 v[128:131], v[208:211], v[192:195], v[128:131]
ds_read_b64_tr_b16 v[86:87], v225 offset:6144
buffer_store_dwordx4 v[172:175], v2, s[84:87], s45 offen offset:3072 sc1
v_mfma_f32_16x16x32_bf16 v[132:135], v[212:215], v[192:195], v[132:135]
ds_read_b128 v[68:71], v8 offset:9216
v_mfma_f32_16x16x32_bf16 v[140:143], v[212:215], v[196:199], v[140:143]
ds_read_b128 v[72:75], v8 offset:10240
v_mfma_f32_16x16x32_bf16 v[136:139], v[208:211], v[196:199], v[136:139]
ds_read_b128 v[76:79], v8 offset:11264
v_mfma_f32_16x16x32_bf16 v[144:147], v[208:211], v[200:203], v[144:147]
v_mfma_f32_16x16x32_bf16 v[148:151], v[212:215], v[200:203], v[148:151]
v_mfma_f32_16x16x32_bf16 v[156:159], v[212:215], v[204:207], v[156:159]
v_mfma_f32_16x16x32_bf16 v[152:155], v[208:211], v[204:207], v[152:155]
s_waitcnt lgkmcnt(0)
s_barrier
v_mfma_f32_16x16x32_bf16 v[128:131], v[48:51], v[32:35], v[128:131]
ds_read_b128 v[96:99], v6 offset:16384
ds_read_b64_tr_b16 v[112:113], v224 offset:32768
v_mfma_f32_16x16x32_bf16 v[132:135], v[52:55], v[32:35], v[132:135]
ds_read_b64_tr_b16 v[114:115], v224 offset:34816
ds_read_b64_tr_b16 v[116:117], v225 offset:32768
v_mfma_f32_16x16x32_bf16 v[140:143], v[52:55], v[36:39], v[140:143]
ds_read_b64_tr_b16 v[118:119], v225 offset:34816
ds_read_b128 v[100:103], v6 offset:17408
v_mfma_f32_16x16x32_bf16 v[136:139], v[48:51], v[36:39], v[136:139]
ds_read_b128 v[104:107], v6 offset:18432
ds_read_b128 v[108:111], v6 offset:19456
v_mfma_f32_16x16x32_bf16 v[144:147], v[48:51], v[40:43], v[144:147]
ds_read_b128 v[192:195], v6 offset:24576
v_mfma_f32_16x16x32_bf16 v[148:151], v[52:55], v[40:43], v[148:151]
ds_read_b64_tr_b16 v[208:209], v224 offset:36864
v_mfma_f32_16x16x32_bf16 v[156:159], v[52:55], v[44:47], v[156:159]
ds_read_b64_tr_b16 v[210:211], v224 offset:38912
v_mfma_f32_16x16x32_bf16 v[152:155], v[48:51], v[44:47], v[152:155]
ds_read_b64_tr_b16 v[212:213], v225 offset:36864
v_mfma_f32_16x16x32_bf16 v[128:131], v[80:83], v[64:67], v[128:131]
ds_read_b64_tr_b16 v[214:215], v225 offset:38912
v_mfma_f32_16x16x32_bf16 v[132:135], v[84:87], v[64:67], v[132:135]
ds_read_b128 v[196:199], v6 offset:25600
v_mfma_f32_16x16x32_bf16 v[140:143], v[84:87], v[68:71], v[140:143]
ds_read_b128 v[200:203], v6 offset:26624
v_mfma_f32_16x16x32_bf16 v[136:139], v[80:83], v[68:71], v[136:139]
ds_read_b128 v[204:207], v6 offset:27648
v_mfma_f32_16x16x32_bf16 v[144:147], v[80:83], v[72:75], v[144:147]
v_mfma_f32_16x16x32_bf16 v[148:151], v[84:87], v[72:75], v[148:151]
v_mfma_f32_16x16x32_bf16 v[156:159], v[84:87], v[76:79], v[156:159]
v_mfma_f32_16x16x32_bf16 v[152:155], v[80:83], v[76:79], v[152:155]
s_waitcnt vmcnt(0)
s_waitcnt lgkmcnt(0)
s_barrier
v_mfma_f32_16x16x32_bf16 v[128:131], v[112:115], v[96:99], v[128:131]
ds_read_b128 v[32:35], v6 offset:49152
ds_read_b64_tr_b16 v[48:49], v226 offset:0
v_mfma_f32_16x16x32_bf16 v[132:135], v[116:119], v[96:99], v[132:135]
ds_read_b64_tr_b16 v[50:51], v226 offset:2048
ds_read_b64_tr_b16 v[52:53], v227 offset:0
v_mfma_f32_16x16x32_bf16 v[140:143], v[116:119], v[100:103], v[140:143]
ds_read_b64_tr_b16 v[54:55], v227 offset:2048
ds_read_b128 v[36:39], v6 offset:50176
v_mfma_f32_16x16x32_bf16 v[136:139], v[112:115], v[100:103], v[136:139]
ds_read_b128 v[40:43], v6 offset:51200
ds_read_b128 v[44:47], v6 offset:52224
v_mfma_f32_16x16x32_bf16 v[144:147], v[112:115], v[104:107], v[144:147]
ds_read_b128 v[64:67], v6 offset:57344
v_mfma_f32_16x16x32_bf16 v[148:151], v[116:119], v[104:107], v[148:151]
ds_read_b64_tr_b16 v[80:81], v226 offset:4096
v_mfma_f32_16x16x32_bf16 v[156:159], v[116:119], v[108:111], v[156:159]
ds_read_b64_tr_b16 v[82:83], v226 offset:6144
v_mfma_f32_16x16x32_bf16 v[152:155], v[112:115], v[108:111], v[152:155]
ds_read_b64_tr_b16 v[84:85], v227 offset:4096
v_mfma_f32_16x16x32_bf16 v[128:131], v[208:211], v[192:195], v[128:131]
ds_read_b64_tr_b16 v[86:87], v227 offset:6144
v_mfma_f32_16x16x32_bf16 v[132:135], v[212:215], v[192:195], v[132:135]
ds_read_b128 v[68:71], v6 offset:58368
v_mfma_f32_16x16x32_bf16 v[140:143], v[212:215], v[196:199], v[140:143]
ds_read_b128 v[72:75], v6 offset:59392
v_mfma_f32_16x16x32_bf16 v[136:139], v[208:211], v[196:199], v[136:139]
ds_read_b128 v[76:79], v6 offset:60416
v_mfma_f32_16x16x32_bf16 v[144:147], v[208:211], v[200:203], v[144:147]
v_mfma_f32_16x16x32_bf16 v[148:151], v[212:215], v[200:203], v[148:151]
v_mfma_f32_16x16x32_bf16 v[156:159], v[212:215], v[204:207], v[156:159]
v_mfma_f32_16x16x32_bf16 v[152:155], v[208:211], v[204:207], v[152:155]
s_waitcnt lgkmcnt(0)
s_barrier
v_mfma_f32_16x16x32_bf16 v[128:131], v[48:51], v[32:35], v[128:131]
ds_read_b128 v[96:99], v7 offset:16384
ds_read_b64_tr_b16 v[112:113], v228 offset:16384
v_mfma_f32_16x16x32_bf16 v[132:135], v[52:55], v[32:35], v[132:135]
ds_read_b64_tr_b16 v[114:115], v228 offset:18432
ds_read_b64_tr_b16 v[116:117], v229 offset:16384
v_mfma_f32_16x16x32_bf16 v[140:143], v[52:55], v[36:39], v[140:143]
ds_read_b64_tr_b16 v[118:119], v229 offset:18432
ds_read_b128 v[100:103], v7 offset:17408
s_branch Lov_13
.p2align 12
.fill 96, 4, 0xbf800000
Lst_13_0:
s_branch Lwr_180
Lst_13_1:
s_branch Lst_17_0
s_nop 0
Lov_13:
v_mfma_f32_16x16x32_bf16 v[136:139], v[48:51], v[36:39], v[136:139]
ds_read_b128 v[104:107], v7 offset:18432
ds_read_b128 v[108:111], v7 offset:19456
v_mfma_f32_16x16x32_bf16 v[144:147], v[48:51], v[40:43], v[144:147]
ds_read_b128 v[192:195], v7 offset:24576
v_mfma_f32_16x16x32_bf16 v[148:151], v[52:55], v[40:43], v[148:151]
ds_read_b64_tr_b16 v[208:209], v228 offset:20480
v_mfma_f32_16x16x32_bf16 v[156:159], v[52:55], v[44:47], v[156:159]
ds_read_b64_tr_b16 v[210:211], v228 offset:22528
v_mfma_f32_16x16x32_bf16 v[152:155], v[48:51], v[44:47], v[152:155]
ds_read_b64_tr_b16 v[212:213], v229 offset:20480
v_mfma_f32_16x16x32_bf16 v[128:131], v[80:83], v[64:67], v[128:131]
ds_read_b64_tr_b16 v[214:215], v229 offset:22528
v_mfma_f32_16x16x32_bf16 v[132:135], v[84:87], v[64:67], v[132:135]
ds_read_b128 v[196:199], v7 offset:25600
v_mfma_f32_16x16x32_bf16 v[140:143], v[84:87], v[68:71], v[140:143]
ds_read_b128 v[200:203], v7 offset:26624
v_mfma_f32_16x16x32_bf16 v[136:139], v[80:83], v[68:71], v[136:139]
ds_read_b128 v[204:207], v7 offset:27648
v_mfma_f32_16x16x32_bf16 v[144:147], v[80:83], v[72:75], v[144:147]
v_mfma_f32_16x16x32_bf16 v[148:151], v[84:87], v[72:75], v[148:151]
v_mfma_f32_16x16x32_bf16 v[156:159], v[84:87], v[76:79], v[156:159]
v_mfma_f32_16x16x32_bf16 v[152:155], v[80:83], v[76:79], v[152:155]
s_waitcnt lgkmcnt(0)
s_barrier
v_mfma_f32_16x16x32_bf16 v[128:131], v[112:115], v[96:99], v[128:131]
ds_read_b128 v[32:35], v7 offset:32768
ds_read_b64_tr_b16 v[48:49], v226 offset:49152
v_mfma_f32_16x16x32_bf16 v[132:135], v[116:119], v[96:99], v[132:135]
ds_read_b64_tr_b16 v[50:51], v226 offset:51200
ds_read_b64_tr_b16 v[52:53], v227 offset:49152
v_mfma_f32_16x16x32_bf16 v[140:143], v[116:119], v[100:103], v[140:143]
ds_read_b64_tr_b16 v[54:55], v227 offset:51200
ds_read_b128 v[36:39], v7 offset:33792
v_mfma_f32_16x16x32_bf16 v[136:139], v[112:115], v[100:103], v[136:139]
ds_read_b128 v[40:43], v7 offset:34816
ds_read_b128 v[44:47], v7 offset:35840
v_mfma_f32_16x16x32_bf16 v[144:147], v[112:115], v[104:107], v[144:147]
ds_read_b128 v[64:67], v7 offset:40960
v_mfma_f32_16x16x32_bf16 v[148:151], v[116:119], v[104:107], v[148:151]
ds_read_b64_tr_b16 v[80:81], v226 offset:53248
v_mfma_f32_16x16x32_bf16 v[156:159], v[116:119], v[108:111], v[156:159]
ds_read_b64_tr_b16 v[82:83], v226 offset:55296
v_mfma_f32_16x16x32_bf16 v[152:155], v[112:115], v[108:111], v[152:155]
ds_read_b64_tr_b16 v[84:85], v227 offset:53248
v_mfma_f32_16x16x32_bf16 v[128:131], v[208:211], v[192:195], v[128:131]
ds_read_b64_tr_b16 v[86:87], v227 offset:55296
v_mfma_f32_16x16x32_bf16 v[132:135], v[212:215], v[192:195], v[132:135]
ds_read_b128 v[68:71], v7 offset:41984
v_mfma_f32_16x16x32_bf16 v[140:143], v[212:215], v[196:199], v[140:143]
ds_read_b128 v[72:75], v7 offset:43008
v_mfma_f32_16x16x32_bf16 v[136:139], v[208:211], v[196:199], v[136:139]
ds_read_b128 v[76:79], v7 offset:44032
v_mfma_f32_16x16x32_bf16 v[144:147], v[208:211], v[200:203], v[144:147]
v_mfma_f32_16x16x32_bf16 v[148:151], v[212:215], v[200:203], v[148:151]
v_mfma_f32_16x16x32_bf16 v[156:159], v[212:215], v[204:207], v[156:159]
v_mfma_f32_16x16x32_bf16 v[152:155], v[208:211], v[204:207], v[152:155]
s_waitcnt lgkmcnt(0)
s_barrier
buffer_load_dwordx4 v[232:235], v2, s[84:87], s46 offen offset:0 sc1
buffer_load_dwordx4 v[236:239], v2, s[84:87], s46 offen offset:1024 sc1
buffer_load_dwordx4 v[240:243], v2, s[84:87], s46 offen offset:2048 sc1
buffer_load_dwordx4 v[244:247], v2, s[84:87], s46 offen offset:3072 sc1
v_mfma_f32_16x16x32_bf16 v[128:131], v[48:51], v[32:35], v[128:131]
ds_read_b128 v[96:99], v8 offset:0
ds_read_b64_tr_b16 v[112:113], v224 offset:0
v_mfma_f32_16x16x32_bf16 v[132:135], v[52:55], v[32:35], v[132:135]
ds_read_b64_tr_b16 v[114:115], v224 offset:2048
ds_read_b64_tr_b16 v[116:117], v225 offset:0
v_mfma_f32_16x16x32_bf16 v[140:143], v[52:55], v[36:39], v[140:143]
ds_read_b64_tr_b16 v[118:119], v225 offset:2048
ds_read_b128 v[100:103], v8 offset:1024
v_mfma_f32_16x16x32_bf16 v[136:139], v[48:51], v[36:39], v[136:139]
ds_read_b128 v[104:107], v8 offset:2048
ds_read_b128 v[108:111], v8 offset:3072
v_mfma_f32_16x16x32_bf16 v[144:147], v[48:51], v[40:43], v[144:147]
ds_read_b128 v[192:195], v8 offset:8192
v_mfma_f32_16x16x32_bf16 v[148:151], v[52:55], v[40:43], v[148:151]
ds_read_b64_tr_b16 v[208:209], v224 offset:4096
v_mfma_f32_16x16x32_bf16 v[156:159], v[52:55], v[44:47], v[156:159]
ds_read_b64_tr_b16 v[210:211], v224 offset:6144
v_mfma_f32_16x16x32_bf16 v[152:155], v[48:51], v[44:47], v[152:155]
ds_read_b64_tr_b16 v[212:213], v225 offset:4096
v_mfma_f32_16x16x32_bf16 v[128:131], v[80:83], v[64:67], v[128:131]
ds_read_b64_tr_b16 v[214:215], v225 offset:6144
v_mfma_f32_16x16x32_bf16 v[132:135], v[84:87], v[64:67], v[132:135]
ds_read_b128 v[196:199], v8 offset:9216
v_mfma_f32_16x16x32_bf16 v[140:143], v[84:87], v[68:71], v[140:143]
ds_read_b128 v[200:203], v8 offset:10240
v_mfma_f32_16x16x32_bf16 v[136:139], v[80:83], v[68:71], v[136:139]
ds_read_b128 v[204:207], v8 offset:11264
v_mfma_f32_16x16x32_bf16 v[144:147], v[80:83], v[72:75], v[144:147]
v_mfma_f32_16x16x32_bf16 v[148:151], v[84:87], v[72:75], v[148:151]
v_mfma_f32_16x16x32_bf16 v[156:159], v[84:87], v[76:79], v[156:159]
v_mfma_f32_16x16x32_bf16 v[152:155], v[80:83], v[76:79], v[152:155]
s_waitcnt lgkmcnt(0)
s_barrier
v_mfma_f32_16x16x32_bf16 v[128:131], v[112:115], v[96:99], v[128:131]
ds_read_b128 v[32:35], v6 offset:16384
ds_read_b64_tr_b16 v[48:49], v224 offset:32768
v_mfma_f32_16x16x32_bf16 v[132:135], v[116:119], v[96:99], v[132:135]
ds_read_b64_tr_b16 v[50:51], v224 offset:34816
ds_read_b64_tr_b16 v[52:53], v225 offset:32768
v_mfma_f32_16x16x32_bf16 v[140:143], v[116:119], v[100:103], v[140:143]
ds_read_b64_tr_b16 v[54:55], v225 offset:34816
ds_read_b128 v[36:39], v6 offset:17408
v_mfma_f32_16x16x32_bf16 v[136:139], v[112:115], v[100:103], v[136:139]
ds_read_b128 v[40:43], v6 offset:18432
ds_read_b128 v[44:47], v6 offset:19456
v_mfma_f32_16x16x32_bf16 v[144:147], v[112:115], v[104:107], v[144:147]
ds_read_b128 v[64:67], v6 offset:24576
v_mfma_f32_16x16x32_bf16 v[148:151], v[116:119], v[104:107], v[148:151]
ds_read_b64_tr_b16 v[80:81], v224 offset:36864
v_mfma_f32_16x16x32_bf16 v[156:159], v[116:119], v[108:111], v[156:159]
ds_read_b64_tr_b16 v[82:83], v224 offset:38912
v_mfma_f32_16x16x32_bf16 v[152:155], v[112:115], v[108:111], v[152:155]
ds_read_b64_tr_b16 v[84:85], v225 offset:36864
v_mfma_f32_16x16x32_bf16 v[128:131], v[208:211], v[192:195], v[128:131]
ds_read_b64_tr_b16 v[86:87], v225 offset:38912
v_mfma_f32_16x16x32_bf16 v[132:135], v[212:215], v[192:195], v[132:135]
ds_read_b128 v[68:71], v6 offset:25600
v_mfma_f32_16x16x32_bf16 v[140:143], v[212:215], v[196:199], v[140:143]
ds_read_b128 v[72:75], v6 offset:26624
v_mfma_f32_16x16x32_bf16 v[136:139], v[208:211], v[196:199], v[136:139]
ds_read_b128 v[76:79], v6 offset:27648
v_mfma_f32_16x16x32_bf16 v[144:147], v[208:211], v[200:203], v[144:147]
v_mfma_f32_16x16x32_bf16 v[148:151], v[212:215], v[200:203], v[148:151]
v_mfma_f32_16x16x32_bf16 v[156:159], v[212:215], v[204:207], v[156:159]
v_mfma_f32_16x16x32_bf16 v[152:155], v[208:211], v[204:207], v[152:155]
s_waitcnt lgkmcnt(0)
s_barrier
v_mfma_f32_16x16x32_bf16 v[128:131], v[48:51], v[32:35], v[128:131]
ds_read_b128 v[96:99], v6 offset:49152
ds_read_b64_tr_b16 v[112:113], v226 offset:0
v_mfma_f32_16x16x32_bf16 v[132:135], v[52:55], v[32:35], v[132:135]
ds_read_b64_tr_b16 v[114:115], v226 offset:2048
ds_read_b64_tr_b16 v[116:117], v227 offset:0
v_mfma_f32_16x16x32_bf16 v[140:143], v[52:55], v[36:39], v[140:143]
ds_read_b64_tr_b16 v[118:119], v227 offset:2048
ds_read_b128 v[100:103], v6 offset:50176
v_mfma_f32_16x16x32_bf16 v[136:139], v[48:51], v[36:39], v[136:139]
ds_read_b128 v[104:107], v6 offset:51200
ds_read_b128 v[108:111], v6 offset:52224
v_mfma_f32_16x16x32_bf16 v[144:147], v[48:51], v[40:43], v[144:147]
ds_read_b128 v[192:195], v6 offset:57344
v_mfma_f32_16x16x32_bf16 v[148:151], v[52:55], v[40:43], v[148:151]
ds_read_b64_tr_b16 v[208:209], v226 offset:4096
v_mfma_f32_16x16x32_bf16 v[156:159], v[52:55], v[44:47], v[156:159]
ds_read_b64_tr_b16 v[210:211], v226 offset:6144
v_mfma_f32_16x16x32_bf16 v[152:155], v[48:51], v[44:47], v[152:155]
ds_read_b64_tr_b16 v[212:213], v227 offset:4096
v_mfma_f32_16x16x32_bf16 v[128:131], v[80:83], v[64:67], v[128:131]
ds_read_b64_tr_b16 v[214:215], v227 offset:6144
v_mfma_f32_16x16x32_bf16 v[132:135], v[84:87], v[64:67], v[132:135]
ds_read_b128 v[196:199], v6 offset:58368
v_mfma_f32_16x16x32_bf16 v[140:143], v[84:87], v[68:71], v[140:143]
ds_read_b128 v[200:203], v6 offset:59392
v_mfma_f32_16x16x32_bf16 v[136:139], v[80:83], v[68:71], v[136:139]
ds_read_b128 v[204:207], v6 offset:60416
v_mfma_f32_16x16x32_bf16 v[144:147], v[80:83], v[72:75], v[144:147]
v_mfma_f32_16x16x32_bf16 v[148:151], v[84:87], v[72:75], v[148:151]
v_mfma_f32_16x16x32_bf16 v[156:159], v[84:87], v[76:79], v[156:159]
v_mfma_f32_16x16x32_bf16 v[152:155], v[80:83], v[76:79], v[152:155]
s_waitcnt vmcnt(0)
s_waitcnt lgkmcnt(0)
s_barrier
v_mfma_f32_16x16x32_bf16 v[128:131], v[112:115], v[96:99], v[128:131]
v_lshlrev_b32 v160, 16, v232
v_and_b32 v161, 0xffff0000, v232
v_mfma_f32_16x16x32_bf16 v[132:135], v[116:119], v[96:99], v[132:135]
v_lshlrev_b32 v162, 16, v233
v_and_b32 v163, 0xffff0000, v233
v_mfma_f32_16x16x32_bf16 v[140:143], v[116:119], v[100:103], v[140:143]
v_lshlrev_b32 v164, 16, v234
v_and_b32 v165, 0xffff0000, v234
v_mfma_f32_16x16x32_bf16 v[136:139], v[112:115], v[100:103], v[136:139]
v_lshlrev_b32 v166, 16, v235
v_and_b32 v167, 0xffff0000, v235
v_mfma_f32_16x16x32_bf16 v[144:147], v[112:115], v[104:107], v[144:147]
v_lshlrev_b32 v168, 16, v236
v_and_b32 v169, 0xffff0000, v236
v_mfma_f32_16x16x32_bf16 v[148:151], v[116:119], v[104:107], v[148:151]
v_lshlrev_b32 v170, 16, v237
v_and_b32 v171, 0xffff0000, v237
v_mfma_f32_16x16x32_bf16 v[156:159], v[116:119], v[108:111], v[156:159]
v_lshlrev_b32 v172, 16, v238
v_and_b32 v173, 0xffff0000, v238
v_mfma_f32_16x16x32_bf16 v[152:155], v[112:115], v[108:111], v[152:155]
v_lshlrev_b32 v174, 16, v239
v_and_b32 v175, 0xffff0000, v239
v_mfma_f32_16x16x32_bf16 v[128:131], v[208:211], v[192:195], v[128:131]
v_lshlrev_b32 v176, 16, v240
v_and_b32 v177, 0xffff0000, v240
v_mfma_f32_16x16x32_bf16 v[132:135], v[212:215], v[192:195], v[132:135]
v_lshlrev_b32 v178, 16, v241
v_and_b32 v179, 0xffff0000, v241
v_mfma_f32_16x16x32_bf16 v[140:143], v[212:215], v[196:199], v[140:143]
v_lshlrev_b32 v180, 16, v242
v_and_b32 v181, 0xffff0000, v242
v_mfma_f32_16x16x32_bf16 v[136:139], v[208:211], v[196:199], v[136:139]
v_lshlrev_b32 v182, 16, v243
v_and_b32 v183, 0xffff0000, v243
v_mfma_f32_16x16x32_bf16 v[144:147], v[208:211], v[200:203], v[144:147]
v_lshlrev_b32 v184, 16, v244
v_and_b32 v185, 0xffff0000, v244
v_mfma_f32_16x16x32_bf16 v[148:151], v[212:215], v[200:203], v[148:151]
v_lshlrev_b32 v186, 16, v245
v_and_b32 v187, 0xffff0000, v245
v_mfma_f32_16x16x32_bf16 v[156:159], v[212:215], v[204:207], v[156:159]
v_lshlrev_b32 v188, 16, v246
v_and_b32 v189, 0xffff0000, v246
v_mfma_f32_16x16x32_bf16 v[152:155], v[208:211], v[204:207], v[152:155]
v_lshlrev_b32 v190, 16, v247
v_and_b32 v191, 0xffff0000, v247
s_nop 1
v_pk_add_f32 v[128:129], v[128:129], v[160:161]
v_pk_add_f32 v[130:131], v[130:131], v[162:163]
v_pk_add_f32 v[132:133], v[132:133], v[164:165]
v_pk_add_f32 v[134:135], v[134:135], v[166:167]
v_cvt_pk_bf16_f32 v32, v128, v129
v_cvt_pk_bf16_f32 v33, v130, v131
v_cvt_pk_bf16_f32 v34, v132, v133
v_cvt_pk_bf16_f32 v35, v134, v135
v_pk_add_f32 v[136:137], v[136:137], v[168:169]
v_pk_add_f32 v[138:139], v[138:139], v[170:171]
v_pk_add_f32 v[140:141], v[140:141], v[172:173]
v_pk_add_f32 v[142:143], v[142:143], v[174:175]
v_cvt_pk_bf16_f32 v36, v136, v137
v_cvt_pk_bf16_f32 v37, v138, v139
v_cvt_pk_bf16_f32 v38, v140, v141
v_cvt_pk_bf16_f32 v39, v142, v143
v_permlane16_swap_b32 v32, v34
v_permlane16_swap_b32 v33, v35
buffer_store_dwordx4 v[32:35], v230, s[20:23], s54 offen offset:0 nt
v_pk_add_f32 v[144:145], v[144:145], v[176:177]
v_pk_add_f32 v[146:147], v[146:147], v[178:179]
v_pk_add_f32 v[148:149], v[148:149], v[180:181]
v_pk_add_f32 v[150:151], v[150:151], v[182:183]
v_cvt_pk_bf16_f32 v40, v144, v145
v_cvt_pk_bf16_f32 v41, v146, v147
v_cvt_pk_bf16_f32 v42, v148, v149
v_cvt_pk_bf16_f32 v43, v150, v151
v_permlane16_swap_b32 v36, v38
v_permlane16_swap_b32 v37, v39
buffer_store_dwordx4 v[36:39], v230, s[20:23], s54 offen offset:2048 nt
v_pk_add_f32 v[152:153], v[152:153], v[184:185]
v_pk_add_f32 v[154:155], v[154:155], v[186:187]
v_pk_add_f32 v[156:157], v[156:157], v[188:189]
v_pk_add_f32 v[158:159], v[158:159], v[190:191]
v_cvt_pk_bf16_f32 v44, v152, v153
v_cvt_pk_bf16_f32 v45, v154, v155
v_cvt_pk_bf16_f32 v46, v156, v157
v_cvt_pk_bf16_f32 v47, v158, v159
v_permlane16_swap_b32 v40, v42
v_permlane16_swap_b32 v41, v43
buffer_store_dwordx4 v[40:43], v230, s[20:23], s55 offen offset:0 nt
s_nop 1
v_permlane16_swap_b32 v44, v46
v_permlane16_swap_b32 v45, v47
buffer_store_dwordx4 v[44:47], v230, s[20:23], s55 offen offset:2048 nt
s_branch Ldone_1
Lgb_118:
s_mul_i32 s43, s34, 262144
s_add_u32 s8, s82, s43
s_addc_u32 s9, s83, 0
s_add_u32 s8, s8, 4194304
s_addc_u32 s9, s9, 0
s_mov_b32 s10, 262144
s_mov_b32 s11, 0x20000
s_lshl_b32 s39, s36, 12
v_lshlrev_b32 v2, 4, v1
v_add_u32 v3, s39, v2
s_add_u32 s37, s35, 0
s_and_b32 s37, s37, 15
s_mul_i32 s37, s37, 16384
s_add_u32 m0, s39, 0
s_nop 0
buffer_load_dwordx4 v3, s[8:11], s37 offen sc1 lds
buffer_load_dwordx4 v3, s[8:11], s37 offen offset:1024 sc1 lds
buffer_load_dwordx4 v3, s[8:11], s37 offen offset:2048 sc1 lds
buffer_load_dwordx4 v3, s[8:11], s37 offen offset:3072 sc1 lds
s_mul_i32 s43, s34, 262144
s_add_u32 s8, s82, s43
s_addc_u32 s9, s83, 0
s_add_u32 s8, s8, 4194304
s_addc_u32 s9, s9, 0
s_mov_b32 s10, 262144
s_mov_b32 s11, 0x20000
s_mul_i32 s43, s34, 917504
s_add_u32 s24, s82, s43
s_addc_u32 s25, s83, 0
s_add_u32 s24, s24, 8388608
s_addc_u32 s25, s25, 0
s_mov_b32 s26, 917504
s_mov_b32 s27, 0x20000
s_add_u32 s84, s82, 27262976
s_addc_u32 s85, s83, 0
s_mov_b32 s86, 229376
s_mov_b32 s87, 0x20000
s_and_b32 s47, s36, 3
s_lshr_b32 s62, s47, 1
s_and_b32 s63, s47, 1
v_lshlrev_b32 v2, 4, v1
s_lshl_b32 s39, s47, 12
v_add_u32 v3, s39, v2
s_cmp_eq_u32 s62, 0
s_cselect_b32 s44, s72, s74
s_cselect_b32 s45, s73, s75
s_lshl_b32 s43, s35, 8
s_add_u32 s12, s44, s43
s_addc_u32 s13, s45, 0
s_mov_b32 s14, 7333120
s_mov_b32 s15, 0x20000
v_lshrrev_b32 v28, 4, v1
v_lshlrev_b32 v29, 1, v28
v_and_b32 v4, 15, v1
v_xor_b32 v4, v4, v29
v_lshlrev_b32 v4, 4, v4
v_mul_u32_u24 v28, 7168, v28
v_add_u32 v4, v4, v28
s_mul_i32 s43, s63, 229376
v_add_u32 v4, s43, v4
v_xor_b32 v5, 128, v4
v_add_u32 v5, 28672, v5
s_lshl_b32 s40, s47, 13
s_add_u32 s40, s40, 16384
s_lshl_b32 s43, s62, 12
v_add_u32 v9, s43, v2
v_add_u32 v10, 98304, v9
v_mov_b32 v6, v192
v_mov_b32 v7, v193
v_mov_b32 v8, v194
v_mov_b32 v24, v195
s_mul_i32 s43, s34, 16384
s_add_u32 s20, s82, s43
s_addc_u32 s21, s83, 0
s_add_u32 s20, s20, 25165824
s_addc_u32 s21, s21, 0
s_mov_b32 s22, 16384
s_mov_b32 s23, 0x20000
s_add_u32 s38, s35, 2
s_and_b32 s38, s38, 15
s_mul_i32 s38, s38, 458752
s_add_u32 m0, s50, 98304
s_nop 0
buffer_load_dwordx4 v6, s[16:19], s38 offen lds
s_add_u32 m0, s50, 99328
s_nop 0
buffer_load_dwordx4 v7, s[16:19], s38 offen lds
s_add_u32 m0, s50, 100352
s_nop 0
buffer_load_dwordx4 v8, s[16:19], s38 offen lds
s_add_u32 m0, s50, 101376
s_add_u32 s38, s38, 114688
buffer_load_dwordx4 v6, s[16:19], s38 offen lds
s_add_u32 m0, s50, 102400
s_nop 0
buffer_load_dwordx4 v7, s[16:19], s38 offen lds
s_add_u32 m0, s50, 103424
s_nop 0
buffer_load_dwordx4 v8, s[16:19], s38 offen lds
s_cmp_eq_u32 s47, 1
s_cbranch_scc0 Lw_144
s_lshl_b32 s92, s34, 4
s_add_u32 s92, s92, s35
s_lshl_b32 s92, s92, 8
s_add_u32 s92, s92, 49280
s_add_u32 s92, s92, 28311552
s_mov_b32 s41, 0x40000
Lpoll_145:
s_load_dword s93, s[82:83], s92 glc
Lpchk_147:
s_waitcnt lgkmcnt(0)
s_cmp_eq_u32 s93, 16
s_cbranch_scc1 Lpok_146
s_sub_u32 s41, s41, 1
s_cmp_lg_u32 s41, 0
s_cbranch_scc1 Lpoll_145
Lpok_146:
Lw_144:
s_waitcnt vmcnt(0)
s_barrier
s_add_u32 s37, s35, 1
s_and_b32 s37, s37, 15
s_mul_i32 s37, s37, 16384
s_add_u32 m0, s39, 49152
s_nop 0
buffer_load_dwordx4 v3, s[8:11], s37 offen sc1 lds
buffer_load_dwordx4 v3, s[8:11], s37 offen offset:1024 sc1 lds
buffer_load_dwordx4 v3, s[8:11], s37 offen offset:2048 sc1 lds
buffer_load_dwordx4 v3, s[8:11], s37 offen offset:3072 sc1 lds
s_add_u32 s37, s35, 2
s_and_b32 s37, s37, 15
s_mul_i32 s37, s37, 16384
s_add_u32 m0, s39, 98304
s_nop 0
buffer_load_dwordx4 v3, s[8:11], s37 offen sc1 lds
buffer_load_dwordx4 v3, s[8:11], s37 offen offset:1024 sc1 lds
buffer_load_dwordx4 v3, s[8:11], s37 offen offset:2048 sc1 lds
buffer_load_dwordx4 v3, s[8:11], s37 offen offset:3072 sc1 lds
buffer_load_dwordx4 v[96:99], v3, s[20:23], 0 offen offset:0 sc1
buffer_load_dwordx4 v[100:103], v3, s[20:23], 0 offen offset:1024 sc1
buffer_load_dwordx4 v[104:107], v3, s[20:23], 0 offen offset:2048 sc1
buffer_load_dwordx4 v[108:111], v3, s[20:23], 0 offen offset:3072 sc1
s_and_b32 s44, s36, 3
s_mul_i32 s44, s44, 14
s_bfe_u32 s43, s2, 0x30001
s_lshl_b32 s43, s43, 7
s_add_u32 s44, s44, s43
s_add_u32 s44, s44, 72
s_mul_i32 s44, s44, 7168
s_lshr_b32 s43, s2, 4
s_lshl_b32 s43, s43, 8
s_add_u32 s43, s43, s44
s_bitcmp0_b32 s2, 0
s_cselect_b32 s4, s72, s74
s_cselect_b32 s5, s73, s75
s_add_u32 s4, s4, s43
s_addc_u32 s5, s5, 0
s_waitcnt vmcnt(8)
s_barrier
s_cmp_eq_u32 s47, 3
s_cbranch_scc0 Lw_148
v_and_b32 v30, 31, v1
v_lshlrev_b32 v30, 4, v30
v_add_u32 v31, 151552, v30
ds_read_b128 v[112:115], v31 offset:0
ds_read_b128 v[116:119], v31 offset:512
ds_read_b128 v[120:123], v31 offset:1024
ds_read_b128 v[124:127], v31 offset:1536
s_and_b32 s44, s2, 15
s_mul_i32 s44, s44, 14336
s_lshr_b32 s43, s2, 4
s_lshl_b32 s43, s43, 9
s_add_u32 s44, s44, s43
s_add_u32 s44, s44, 8192
s_cmp_lt_u32 s2, 192
s_cselect_b32 s44, s44, 0x7fffffff
s_waitcnt lgkmcnt(0)
v_add_f32 v112, v112, v116
v_add_f32 v120, v120, v124
v_add_f32 v113, v113, v117
v_add_f32 v121, v121, v125
v_add_f32 v114, v114, v118
v_add_f32 v122, v122, v126
v_add_f32 v115, v115, v119
v_add_f32 v123, v123, v127
v_add_f32 v112, v112, v120
v_add_f32 v113, v113, v121
v_add_f32 v114, v114, v122
v_add_f32 v115, v115, v123
s_mov_b64 exec, 0xffffffff
buffer_store_dwordx4 v[112:115], v30, s[84:87], s44 offen sc1
s_mov_b64 exec, -1
Lw_148:
s_add_u32 s37, s35, 3
s_and_b32 s37, s37, 15
s_mul_i32 s37, s37, 16384
s_add_u32 m0, s39, 0
s_nop 0
buffer_load_dwordx4 v3, s[8:11], s37 offen sc1 lds
buffer_load_dwordx4 v3, s[8:11], s37 offen offset:1024 sc1 lds
s_load_dword s3, s[4:5], 78848
buffer_load_dwordx4 v3, s[8:11], s37 offen offset:2048 sc1 lds
buffer_load_dwordx4 v3, s[8:11], s37 offen offset:3072 sc1 lds
s_load_dword s3, s[4:5], 78912
s_add_u32 s38, s35, 3
s_and_b32 s38, s38, 15
s_mul_i32 s38, s38, 458752
s_add_u32 m0, s50, 0
s_nop 0
buffer_load_dwordx4 v6, s[16:19], s38 offen lds
s_load_dword s3, s[4:5], 78976
s_add_u32 m0, s50, 1024
s_nop 0
buffer_load_dwordx4 v7, s[16:19], s38 offen lds
s_add_u32 m0, s50, 2048
s_nop 0
buffer_load_dwordx4 v8, s[16:19], s38 offen lds
s_load_dword s3, s[4:5], 79040
s_add_u32 m0, s50, 3072
s_add_u32 s38, s38, 114688
buffer_load_dwordx4 v6, s[16:19], s38 offen lds
s_load_dword s3, s[4:5], 86016
s_add_u32 m0, s50, 4096
s_nop 0
buffer_load_dwordx4 v7, s[16:19], s38 offen lds
s_add_u32 m0, s50, 5120
s_nop 0
buffer_load_dwordx4 v8, s[16:19], s38 offen lds
s_waitcnt vmcnt(14)
s_barrier
s_add_u32 s37, s35, 4
s_and_b32 s37, s37, 15
s_mul_i32 s37, s37, 16384
s_add_u32 m0, s39, 49152
s_nop 0
buffer_load_dwordx4 v3, s[8:11], s37 offen sc1 lds
buffer_load_dwordx4 v3, s[8:11], s37 offen offset:1024 sc1 lds
s_load_dword s3, s[4:5], 86080
buffer_load_dwordx4 v3, s[8:11], s37 offen offset:2048 sc1 lds
buffer_load_dwordx4 v3, s[8:11], s37 offen offset:3072 sc1 lds
s_load_dword s3, s[4:5], 86144
s_add_u32 s38, s35, 4
s_and_b32 s38, s38, 15
s_mul_i32 s38, s38, 458752
s_add_u32 m0, s50, 49152
s_nop 0
buffer_load_dwordx4 v6, s[16:19], s38 offen lds
s_load_dword s3, s[4:5], 86208
s_add_u32 m0, s50, 50176
s_nop 0
buffer_load_dwordx4 v7, s[16:19], s38 offen lds
s_add_u32 m0, s50, 51200
s_nop 0
buffer_load_dwordx4 v8, s[16:19], s38 offen lds
s_load_dword s3, s[4:5], 93184
s_add_u32 m0, s50, 52224
s_add_u32 s38, s38, 114688
buffer_load_dwordx4 v6, s[16:19], s38 offen lds
s_load_dword s3, s[4:5], 93248
s_add_u32 m0, s50, 53248
s_nop 0
buffer_load_dwordx4 v7, s[16:19], s38 offen lds
s_add_u32 m0, s50, 54272
s_nop 0
buffer_load_dwordx4 v8, s[16:19], s38 offen lds
s_waitcnt vmcnt(10)
s_barrier
s_cmp_eq_u32 s47, 3
s_cbranch_scc0 Lw_149
s_cmp_lt_u32 s2, 192
s_cbranch_scc0 Lw_149
s_lshr_b32 s43, s2, 4
s_add_u32 s43, s43, 96
s_lshl_b32 s43, s43, 7
v_mov_b32 v30, s43
v_mov_b32 v31, 1
s_mov_b64 exec, 1
buffer_atomic_add v31, v30, s[56:59], 0 offen sc1
s_mov_b64 exec, -1
Lw_149:
s_add_u32 s37, s35, 5
s_and_b32 s37, s37, 15
s_mul_i32 s37, s37, 16384
s_add_u32 m0, s39, 98304
s_nop 0
buffer_load_dwordx4 v3, s[8:11], s37 offen sc1 lds
v_add_f32 v96, v96, v100
v_add_f32 v97, v97, v101
v_add_f32 v98, v98, v102
buffer_load_dwordx4 v3, s[8:11], s37 offen offset:1024 sc1 lds
v_add_f32 v99, v99, v103
v_add_f32 v104, v104, v108
v_add_f32 v105, v105, v109
buffer_load_dwordx4 v3, s[8:11], s37 offen offset:2048 sc1 lds
v_add_f32 v106, v106, v110
v_add_f32 v107, v107, v111
s_nop 0
buffer_load_dwordx4 v3, s[8:11], s37 offen offset:3072 sc1 lds
v_permlane32_swap_b32 v96, v104
v_permlane32_swap_b32 v97, v105
v_permlane32_swap_b32 v98, v106
v_permlane32_swap_b32 v99, v107
s_add_u32 s38, s35, 5
s_and_b32 s38, s38, 15
s_mul_i32 s38, s38, 458752
s_add_u32 m0, s50, 98304
s_nop 0
s_branch Lov_14
.p2align 12
.fill 112, 4, 0xbf800000
Lst_14_0:
s_branch Lwr_181
Lst_14_1:
s_branch Lst_18_0
s_nop 0
Lov_14:
buffer_load_dwordx4 v6, s[16:19], s38 offen lds
v_add_f32 v96, v96, v104
v_add_f32 v97, v97, v105
v_add_f32 v98, v98, v106
s_add_u32 m0, s50, 99328
s_nop 0
buffer_load_dwordx4 v7, s[16:19], s38 offen lds
v_add_f32 v99, v99, v107
v_mov_b32 v100, v96
v_mov_b32 v101, v97
s_add_u32 m0, s50, 100352
s_nop 0
buffer_load_dwordx4 v8, s[16:19], s38 offen lds
v_mov_b32 v102, v98
v_mov_b32 v103, v99
s_nop 0
s_add_u32 m0, s50, 101376
s_add_u32 s38, s38, 114688
buffer_load_dwordx4 v6, s[16:19], s38 offen lds
v_permlane16_swap_b32 v96, v100
v_permlane16_swap_b32 v97, v101
v_permlane16_swap_b32 v98, v102
v_permlane16_swap_b32 v99, v103
s_add_u32 m0, s50, 102400
s_nop 0
buffer_load_dwordx4 v7, s[16:19], s38 offen lds
s_add_u32 m0, s50, 103424
s_nop 0
buffer_load_dwordx4 v8, s[16:19], s38 offen lds
s_waitcnt vmcnt(10)
s_barrier
s_add_u32 s37, s35, 6
s_and_b32 s37, s37, 15
s_mul_i32 s37, s37, 16384
s_add_u32 m0, s39, 0
s_nop 0
buffer_load_dwordx4 v3, s[8:11], s37 offen sc1 lds
v_add_f32 v96, v96, v100
v_add_f32 v97, v97, v101
v_add_f32 v98, v98, v102
buffer_load_dwordx4 v3, s[8:11], s37 offen offset:1024 sc1 lds
v_add_f32 v99, v99, v103
s_nop 0
v_add_f32_dpp v96, v96, v96 row_ror:8 row_mask:0xf bank_mask:0xf
buffer_load_dwordx4 v3, s[8:11], s37 offen offset:2048 sc1 lds
v_add_f32_dpp v97, v97, v97 row_ror:8 row_mask:0xf bank_mask:0xf
v_add_f32_dpp v98, v98, v98 row_ror:8 row_mask:0xf bank_mask:0xf
v_add_f32_dpp v99, v99, v99 row_ror:8 row_mask:0xf bank_mask:0xf
v_mul_f32 v96, 0x3a800000, v96
buffer_load_dwordx4 v3, s[8:11], s37 offen offset:3072 sc1 lds
v_mul_f32 v97, 0x3a800000, v97
v_mul_f32 v98, 0x3a800000, v98
v_mul_f32 v99, 0x3a800000, v99
s_add_u32 s38, s35, 6
s_and_b32 s38, s38, 15
s_mul_i32 s38, s38, 458752
s_add_u32 m0, s50, 0
s_nop 0
buffer_load_dwordx4 v6, s[16:19], s38 offen lds
v_fma_f32 v97, -v96, v96, v97
v_fma_f32 v99, -v98, v98, v99
v_max_f32 v97, 0, v97
s_add_u32 m0, s50, 1024
s_nop 0
buffer_load_dwordx4 v7, s[16:19], s38 offen lds
v_max_f32 v99, 0, v99
v_add_f32 v97, 0x3727c5ac, v97
v_add_f32 v99, 0x3727c5ac, v99
v_rsq_f32 v97, v97
s_add_u32 m0, s50, 2048
s_nop 0
buffer_load_dwordx4 v8, s[16:19], s38 offen lds
v_rsq_f32 v99, v99
v_and_b32 v100, 7, v1
s_lshl_b32 s43, s47, 8
s_add_u32 m0, s50, 3072
s_add_u32 s38, s38, 114688
buffer_load_dwordx4 v6, s[16:19], s38 offen lds
s_add_u32 s43, s43, 147456
v_lshl_add_u32 v100, v100, 4, s43
v_lshrrev_b32 v101, 5, v1
v_lshl_add_u32 v100, v101, 7, v100
s_add_u32 m0, s50, 4096
s_nop 0
buffer_load_dwordx4 v7, s[16:19], s38 offen lds
s_add_u32 m0, s50, 5120
s_nop 0
buffer_load_dwordx4 v8, s[16:19], s38 offen lds
s_waitcnt vmcnt(10)
s_barrier
ds_write_b128 v100, v[96:99]
s_waitcnt lgkmcnt(0)
s_add_u32 s37, s35, 7
s_and_b32 s37, s37, 15
s_mul_i32 s37, s37, 16384
s_add_u32 m0, s39, 49152
s_nop 0
buffer_load_dwordx4 v3, s[8:11], s37 offen sc1 lds
s_load_dword s3, s[4:5], 93312
buffer_load_dwordx4 v3, s[8:11], s37 offen offset:1024 sc1 lds
s_load_dword s3, s[4:5], 93376
s_and_b32 s44, s36, 3
buffer_load_dwordx4 v3, s[8:11], s37 offen offset:2048 sc1 lds
s_mul_i32 s43, s2, 28672
buffer_load_dwordx4 v3, s[8:11], s37 offen offset:3072 sc1 lds
s_mul_i32 s44, s44, 7168
s_add_u32 s43, s43, s44
s_add_u32 s38, s35, 7
s_and_b32 s38, s38, 15
s_mul_i32 s38, s38, 458752
s_add_u32 m0, s50, 49152
s_nop 0
buffer_load_dwordx4 v6, s[16:19], s38 offen lds
s_add_u32 s4, s76, s43
s_add_u32 m0, s50, 50176
s_nop 0
buffer_load_dwordx4 v7, s[16:19], s38 offen lds
s_addc_u32 s5, s77, 0
s_load_dword s3, s[4:5], 0
s_add_u32 m0, s50, 51200
s_nop 0
buffer_load_dwordx4 v8, s[16:19], s38 offen lds
s_load_dword s3, s[4:5], 64
s_add_u32 m0, s50, 52224
s_add_u32 s38, s38, 114688
buffer_load_dwordx4 v6, s[16:19], s38 offen lds
s_load_dword s3, s[4:5], 128
s_load_dword s3, s[4:5], 192
s_add_u32 m0, s50, 53248
s_nop 0
buffer_load_dwordx4 v7, s[16:19], s38 offen lds
s_add_u32 m0, s50, 54272
s_nop 0
buffer_load_dwordx4 v8, s[16:19], s38 offen lds
s_waitcnt vmcnt(10)
s_barrier
s_add_u32 s37, s35, 8
s_and_b32 s37, s37, 15
s_mul_i32 s37, s37, 16384
s_add_u32 m0, s39, 98304
s_nop 0
buffer_load_dwordx4 v3, s[8:11], s37 offen sc1 lds
s_load_dword s3, s[4:5], 256
s_load_dword s3, s[4:5], 320
s_load_dword s3, s[4:5], 384
buffer_load_dwordx4 v3, s[8:11], s37 offen offset:1024 sc1 lds
s_load_dword s3, s[4:5], 448
s_load_dword s3, s[4:5], 512
s_load_dword s3, s[4:5], 576
buffer_load_dwordx4 v3, s[8:11], s37 offen offset:2048 sc1 lds
v_lshrrev_b32 v28, 2, v1
v_and_b32 v29, 7, v28
v_mul_u32_u24 v28, 256, v28
buffer_load_dwordx4 v3, s[8:11], s37 offen offset:3072 sc1 lds
v_lshl_add_u32 v28, v29, 5, v28
v_and_b32 v29, 3, v1
v_lshl_add_u32 v11, v29, 3, v28
s_lshl_b32 s43, s63, 7
s_add_u32 s38, s35, 8
s_and_b32 s38, s38, 15
s_mul_i32 s38, s38, 458752
s_add_u32 m0, s50, 98304
s_nop 0
buffer_load_dwordx4 v6, s[16:19], s38 offen lds
v_xor_b32 v11, s43, v11
v_add_u32 v11, 16384, v11
v_xor_b32 v12, 32, v11
s_add_u32 m0, s50, 99328
s_nop 0
buffer_load_dwordx4 v7, s[16:19], s38 offen lds
v_xor_b32 v13, 64, v11
v_xor_b32 v14, 96, v11
v_add_u32 v15, 49152, v11
s_add_u32 m0, s50, 100352
s_nop 0
buffer_load_dwordx4 v8, s[16:19], s38 offen lds
v_add_u32 v16, 49152, v12
v_add_u32 v17, 49152, v13
v_add_u32 v18, 49152, v14
s_add_u32 m0, s50, 101376
s_add_u32 s38, s38, 114688
buffer_load_dwordx4 v6, s[16:19], s38 offen lds
v_add_u32 v19, 98304, v11
v_add_u32 v20, 98304, v12
v_add_u32 v21, 98304, v13
v_add_u32 v22, 98304, v14
s_add_u32 m0, s50, 102400
s_nop 0
buffer_load_dwordx4 v7, s[16:19], s38 offen lds
s_add_u32 m0, s50, 103424
s_nop 0
buffer_load_dwordx4 v8, s[16:19], s38 offen lds
s_waitcnt vmcnt(10)
s_barrier
s_cmp_eq_u32 s47, 3
s_cbranch_scc0 Lw_150
s_mul_i32 s60, s35, 96
s_add_u32 s61, s60, 95
s_and_b32 s60, s60, 0xff80
s_and_b32 s61, s61, 0xff80
s_add_u32 s60, s60, 28323840
s_add_u32 s61, s61, 28323840
s_load_dword s92, s[82:83], s60 glc
s_load_dword s93, s[82:83], s61 glc
Lw_150:
s_add_u32 s37, s35, 9
s_and_b32 s37, s37, 15
s_mul_i32 s37, s37, 16384
s_add_u32 m0, s39, 0
s_nop 0
buffer_load_dwordx4 v3, s[8:11], s37 offen sc1 lds
buffer_load_dwordx4 v3, s[8:11], s37 offen offset:1024 sc1 lds
buffer_load_dwordx4 v3, s[8:11], s37 offen offset:2048 sc1 lds
buffer_load_dwordx4 v3, s[8:11], s37 offen offset:3072 sc1 lds
s_add_u32 s38, s35, 9
s_and_b32 s38, s38, 15
s_mul_i32 s38, s38, 458752
s_add_u32 m0, s50, 0
s_nop 0
buffer_load_dwordx4 v6, s[16:19], s38 offen lds
s_add_u32 m0, s50, 1024
s_nop 0
buffer_load_dwordx4 v7, s[16:19], s38 offen lds
s_add_u32 m0, s50, 2048
s_nop 0
buffer_load_dwordx4 v8, s[16:19], s38 offen lds
s_add_u32 m0, s50, 3072
s_add_u32 s38, s38, 114688
buffer_load_dwordx4 v6, s[16:19], s38 offen lds
s_add_u32 m0, s50, 4096
s_nop 0
buffer_load_dwordx4 v7, s[16:19], s38 offen lds
s_add_u32 m0, s50, 5120
s_nop 0
buffer_load_dwordx4 v8, s[16:19], s38 offen lds
s_waitcnt vmcnt(10)
s_barrier
s_add_u32 s37, s35, 10
s_and_b32 s37, s37, 15
s_mul_i32 s37, s37, 16384
s_add_u32 m0, s39, 49152
s_nop 0
buffer_load_dwordx4 v3, s[8:11], s37 offen sc1 lds
buffer_load_dwordx4 v3, s[8:11], s37 offen offset:1024 sc1 lds
buffer_load_dwordx4 v3, s[8:11], s37 offen offset:2048 sc1 lds
buffer_load_dwordx4 v3, s[8:11], s37 offen offset:3072 sc1 lds
s_add_u32 s38, s35, 10
s_and_b32 s38, s38, 15
s_mul_i32 s38, s38, 458752
s_add_u32 m0, s50, 49152
s_nop 0
buffer_load_dwordx4 v6, s[16:19], s38 offen lds
s_add_u32 m0, s50, 50176
s_nop 0
buffer_load_dwordx4 v7, s[16:19], s38 offen lds
s_add_u32 m0, s50, 51200
s_nop 0
buffer_load_dwordx4 v8, s[16:19], s38 offen lds
s_add_u32 m0, s50, 52224
s_add_u32 s38, s38, 114688
buffer_load_dwordx4 v6, s[16:19], s38 offen lds
s_add_u32 m0, s50, 53248
s_nop 0
buffer_load_dwordx4 v7, s[16:19], s38 offen lds
s_add_u32 m0, s50, 54272
s_nop 0
buffer_load_dwordx4 v8, s[16:19], s38 offen lds
s_mov_b32 s38, 0
buffer_load_dwordx4 v[40:43], v24, s[88:91], s38 offen
s_mov_b32 s38, 28672
buffer_load_dwordx4 v[44:47], v24, s[88:91], s38 offen
s_mov_b32 s38, 57344
buffer_load_dwordx4 v[48:51], v24, s[88:91], s38 offen
s_mov_b32 s38, 86016
buffer_load_dwordx4 v[52:55], v24, s[88:91], s38 offen
s_mov_b32 s38, 114688
buffer_load_dwordx4 v[56:59], v24, s[88:91], s38 offen
s_mov_b32 s38, 143360
buffer_load_dwordx4 v[60:63], v24, s[88:91], s38 offen
s_mov_b32 s38, 172032
buffer_load_dwordx4 v[64:67], v24, s[88:91], s38 offen
s_mov_b32 s38, 200704
buffer_load_dwordx4 v[68:71], v24, s[88:91], s38 offen
s_waitcnt vmcnt(18)
s_cmp_eq_u32 s47, 3
s_cbranch_scc0 Lw_151
s_mov_b32 s41, 0x40000
Lcp_152:
s_waitcnt lgkmcnt(0)
s_and_b32 s92, s92, s93
s_cmp_eq_u32 s92, 16
s_cbranch_scc1 Lco_153
s_load_dword s92, s[82:83], s60 glc
s_load_dword s93, s[82:83], s61 glc
s_sub_u32 s41, s41, 1
s_cmp_lg_u32 s41, 0
s_cbranch_scc1 Lcp_152
s_waitcnt lgkmcnt(0)
Lco_153:
Lw_151:
s_barrier
s_mov_b32 s45, s47
s_cmp_ge_u32 s45, 3
s_cselect_b32 s43, 1, 0
s_mul_i32 s44, s43, 3
s_sub_u32 s45, s45, s44
s_lshl_b32 s45, s45, 7
s_mul_i32 s52, s43, 896
s_add_u32 s52, s52, s45
s_add_u32 s52, s52, 148992
s_mul_i32 s43, s43, 14336
s_add_u32 s43, s43, s45
s_mul_i32 s44, s35, 384
s_add_u32 s43, s43, s44
s_add_u32 s60, s43, 8192
s_add_u32 s45, s47, 4
s_min_u32 s45, s45, 5
s_cmp_ge_u32 s45, 3
s_cselect_b32 s43, 1, 0
s_mul_i32 s44, s43, 3
s_sub_u32 s45, s45, s44
s_lshl_b32 s45, s45, 7
s_mul_i32 s53, s43, 896
s_add_u32 s53, s53, s45
s_add_u32 s53, s53, 148992
s_mul_i32 s43, s43, 14336
s_add_u32 s43, s43, s45
s_mul_i32 s44, s35, 384
s_add_u32 s43, s43, s44
s_add_u32 s61, s43, 8192
v_lshrrev_b32 v104, 3, v1
v_mul_u32_u24 v104, 28672, v104
v_and_b32 v105, 7, v1
v_lshl_add_u32 v104, v105, 4, v104
buffer_load_dwordx4 v[96:99], v104, s[84:87], s60 offen sc1
s_load_dword s3, s[4:5], 640
buffer_load_dwordx4 v[100:103], v104, s[84:87], s61 offen sc1
s_load_dword s3, s[4:5], 704
s_add_u32 s37, s35, 11
s_and_b32 s37, s37, 15
s_mul_i32 s37, s37, 16384
s_add_u32 m0, s39, 98304
s_nop 0
buffer_load_dwordx4 v3, s[8:11], s37 offen sc1 lds
s_load_dword s3, s[4:5], 768
buffer_load_dwordx4 v3, s[8:11], s37 offen offset:1024 sc1 lds
s_load_dword s3, s[4:5], 832
s_load_dword s3, s[4:5], 896
buffer_load_dwordx4 v3, s[8:11], s37 offen offset:2048 sc1 lds
s_load_dword s3, s[4:5], 960
buffer_load_dwordx4 v3, s[8:11], s37 offen offset:3072 sc1 lds
v_cmp_gt_u32 vcc, 32, v1
s_add_u32 s38, s35, 11
s_and_b32 s38, s38, 15
s_mul_i32 s38, s38, 458752
s_add_u32 m0, s50, 98304
s_nop 0
buffer_load_dwordx4 v6, s[16:19], s38 offen lds
v_mov_b32 v104, s52
v_mov_b32 v106, s53
s_add_u32 m0, s50, 99328
s_nop 0
buffer_load_dwordx4 v7, s[16:19], s38 offen lds
v_cndmask_b32 v104, v106, v104, vcc
s_add_u32 m0, s50, 100352
s_nop 0
buffer_load_dwordx4 v8, s[16:19], s38 offen lds
v_lshl_add_u32 v104, v105, 4, v104
s_add_u32 m0, s50, 101376
s_add_u32 s38, s38, 114688
buffer_load_dwordx4 v6, s[16:19], s38 offen lds
v_bfe_u32 v105, v1, 4, 1
v_lshl_add_u32 v104, v105, 2, v104
s_add_u32 m0, s50, 102400
s_nop 0
buffer_load_dwordx4 v7, s[16:19], s38 offen lds
s_add_u32 m0, s50, 103424
s_nop 0
buffer_load_dwordx4 v8, s[16:19], s38 offen lds
s_waitcnt vmcnt(20)
s_barrier
s_add_u32 s37, s35, 12
s_and_b32 s37, s37, 15
s_mul_i32 s37, s37, 16384
s_add_u32 m0, s39, 0
s_nop 0
buffer_load_dwordx4 v3, s[8:11], s37 offen sc1 lds
buffer_load_dwordx4 v3, s[8:11], s37 offen offset:1024 sc1 lds
buffer_load_dwordx4 v3, s[8:11], s37 offen offset:2048 sc1 lds
buffer_load_dwordx4 v3, s[8:11], s37 offen offset:3072 sc1 lds
s_add_u32 s38, s35, 12
s_and_b32 s38, s38, 15
s_mul_i32 s38, s38, 458752
s_add_u32 m0, s50, 0
s_nop 0
buffer_load_dwordx4 v6, s[16:19], s38 offen lds
s_add_u32 m0, s50, 1024
s_nop 0
buffer_load_dwordx4 v7, s[16:19], s38 offen lds
s_add_u32 m0, s50, 2048
s_nop 0
buffer_load_dwordx4 v8, s[16:19], s38 offen lds
s_add_u32 m0, s50, 3072
s_add_u32 s38, s38, 114688
buffer_load_dwordx4 v6, s[16:19], s38 offen lds
s_add_u32 m0, s50, 4096
s_nop 0
buffer_load_dwordx4 v7, s[16:19], s38 offen lds
s_add_u32 m0, s50, 5120
s_nop 0
buffer_load_dwordx4 v8, s[16:19], s38 offen lds
s_waitcnt vmcnt(10)
s_barrier
v_permlane32_swap_b32 v96, v100
v_permlane32_swap_b32 v97, v101
v_permlane32_swap_b32 v98, v102
v_permlane32_swap_b32 v99, v103
v_add_f32 v96, v96, v100
v_add_f32 v97, v97, v101
v_add_f32 v98, v98, v102
v_add_f32 v99, v99, v103
s_nop 1
v_permlane16_swap_b32 v96, v97
v_permlane16_swap_b32 v98, v99
v_add_f32 v96, v96, v97
v_add_f32 v98, v98, v99
s_nop 1
v_add_f32_dpp v96, v96, v96 row_ror:8 row_mask:0xf bank_mask:0xf
v_add_f32_dpp v98, v98, v98 row_ror:8 row_mask:0xf bank_mask:0xf
ds_write_b32 v104, v96
ds_write_b32 v104, v98 offset:8
s_waitcnt lgkmcnt(0)
s_add_u32 s37, s35, 13
s_and_b32 s37, s37, 15
s_mul_i32 s37, s37, 16384
s_add_u32 m0, s39, 49152
s_nop 0
buffer_load_dwordx4 v3, s[8:11], s37 offen sc1 lds
s_load_dword s3, s[4:5], 1024
s_load_dword s3, s[4:5], 1088
s_load_dword s3, s[4:5], 1152
s_load_dword s3, s[4:5], 1216
buffer_load_dwordx4 v3, s[8:11], s37 offen offset:1024 sc1 lds
s_load_dword s3, s[4:5], 1280
s_load_dword s3, s[4:5], 1344
v_lshlrev_b32 v72, 16, v40
v_and_b32 v73, 0xffff0000, v40
v_lshlrev_b32 v74, 16, v41
buffer_load_dwordx4 v3, s[8:11], s37 offen offset:2048 sc1 lds
v_and_b32 v75, 0xffff0000, v41
v_lshlrev_b32 v76, 16, v42
v_and_b32 v77, 0xffff0000, v42
v_lshlrev_b32 v78, 16, v43
v_and_b32 v79, 0xffff0000, v43
buffer_load_dwordx4 v3, s[8:11], s37 offen offset:3072 sc1 lds
v_lshlrev_b32 v80, 16, v44
v_and_b32 v81, 0xffff0000, v44
v_lshlrev_b32 v82, 16, v45
v_and_b32 v83, 0xffff0000, v45
v_lshlrev_b32 v84, 16, v46
s_add_u32 s38, s35, 13
s_and_b32 s38, s38, 15
s_mul_i32 s38, s38, 458752
s_add_u32 m0, s50, 49152
s_nop 0
buffer_load_dwordx4 v6, s[16:19], s38 offen lds
v_and_b32 v85, 0xffff0000, v46
v_lshlrev_b32 v86, 16, v47
v_and_b32 v87, 0xffff0000, v47
v_add_f32 v72, v72, v80
v_add_f32 v73, v73, v81
s_add_u32 m0, s50, 50176
s_nop 0
buffer_load_dwordx4 v7, s[16:19], s38 offen lds
v_add_f32 v74, v74, v82
v_add_f32 v75, v75, v83
v_add_f32 v76, v76, v84
v_add_f32 v77, v77, v85
v_add_f32 v78, v78, v86
s_add_u32 m0, s50, 51200
s_nop 0
buffer_load_dwordx4 v8, s[16:19], s38 offen lds
v_add_f32 v79, v79, v87
v_lshlrev_b32 v80, 16, v48
v_and_b32 v81, 0xffff0000, v48
v_lshlrev_b32 v82, 16, v49
v_and_b32 v83, 0xffff0000, v49
s_add_u32 m0, s50, 52224
s_add_u32 s38, s38, 114688
buffer_load_dwordx4 v6, s[16:19], s38 offen lds
v_lshlrev_b32 v84, 16, v50
v_and_b32 v85, 0xffff0000, v50
v_lshlrev_b32 v86, 16, v51
v_and_b32 v87, 0xffff0000, v51
v_add_f32 v72, v72, v80
s_add_u32 m0, s50, 53248
s_nop 0
buffer_load_dwordx4 v7, s[16:19], s38 offen lds
s_add_u32 m0, s50, 54272
s_nop 0
buffer_load_dwordx4 v8, s[16:19], s38 offen lds
s_waitcnt vmcnt(10)
s_barrier
s_add_u32 s37, s35, 14
s_and_b32 s37, s37, 15
s_mul_i32 s37, s37, 16384
s_add_u32 m0, s39, 98304
s_nop 0
buffer_load_dwordx4 v3, s[8:11], s37 offen sc1 lds
s_load_dword s3, s[4:5], 1408
s_load_dword s3, s[4:5], 1472
s_load_dword s3, s[4:5], 1536
s_load_dword s3, s[4:5], 1600
s_load_dword s3, s[4:5], 1664
buffer_load_dwordx4 v3, s[8:11], s37 offen offset:1024 sc1 lds
s_load_dword s3, s[4:5], 1728
v_add_f32 v73, v73, v81
v_add_f32 v74, v74, v82
v_add_f32 v75, v75, v83
v_add_f32 v76, v76, v84
buffer_load_dwordx4 v3, s[8:11], s37 offen offset:2048 sc1 lds
v_add_f32 v77, v77, v85
v_add_f32 v78, v78, v86
v_add_f32 v79, v79, v87
v_lshlrev_b32 v80, 16, v52
v_and_b32 v81, 0xffff0000, v52
buffer_load_dwordx4 v3, s[8:11], s37 offen offset:3072 sc1 lds
v_lshlrev_b32 v82, 16, v53
v_and_b32 v83, 0xffff0000, v53
v_lshlrev_b32 v84, 16, v54
v_and_b32 v85, 0xffff0000, v54
v_lshlrev_b32 v86, 16, v55
s_add_u32 s38, s35, 14
s_and_b32 s38, s38, 15
s_mul_i32 s38, s38, 458752
s_add_u32 m0, s50, 98304
s_nop 0
buffer_load_dwordx4 v6, s[16:19], s38 offen lds
v_and_b32 v87, 0xffff0000, v55
v_add_f32 v72, v72, v80
v_add_f32 v73, v73, v81
v_add_f32 v74, v74, v82
v_add_f32 v75, v75, v83
s_add_u32 m0, s50, 99328
s_nop 0
buffer_load_dwordx4 v7, s[16:19], s38 offen lds
v_add_f32 v76, v76, v84
v_add_f32 v77, v77, v85
v_add_f32 v78, v78, v86
v_add_f32 v79, v79, v87
v_lshlrev_b32 v80, 16, v56
s_add_u32 m0, s50, 100352
s_nop 0
buffer_load_dwordx4 v8, s[16:19], s38 offen lds
v_and_b32 v81, 0xffff0000, v56
v_lshlrev_b32 v82, 16, v57
v_and_b32 v83, 0xffff0000, v57
v_lshlrev_b32 v84, 16, v58
v_and_b32 v85, 0xffff0000, v58
s_add_u32 m0, s50, 101376
s_add_u32 s38, s38, 114688
buffer_load_dwordx4 v6, s[16:19], s38 offen lds
v_lshlrev_b32 v86, 16, v59
v_and_b32 v87, 0xffff0000, v59
v_add_f32 v72, v72, v80
v_add_f32 v73, v73, v81
v_add_f32 v74, v74, v82
s_add_u32 m0, s50, 102400
s_nop 0
buffer_load_dwordx4 v7, s[16:19], s38 offen lds
s_add_u32 m0, s50, 103424
s_nop 0
buffer_load_dwordx4 v8, s[16:19], s38 offen lds
s_waitcnt vmcnt(10)
s_barrier
s_add_u32 s37, s35, 15
s_and_b32 s37, s37, 15
s_mul_i32 s37, s37, 16384
s_add_u32 m0, s39, 0
s_nop 0
buffer_load_dwordx4 v3, s[8:11], s37 offen sc1 lds
v_add_f32 v75, v75, v83
v_add_f32 v76, v76, v84
v_add_f32 v77, v77, v85
v_add_f32 v78, v78, v86
buffer_load_dwordx4 v3, s[8:11], s37 offen offset:1024 sc1 lds
v_add_f32 v79, v79, v87
v_lshlrev_b32 v80, 16, v60
v_and_b32 v81, 0xffff0000, v60
v_lshlrev_b32 v82, 16, v61
buffer_load_dwordx4 v3, s[8:11], s37 offen offset:2048 sc1 lds
v_and_b32 v83, 0xffff0000, v61
s_branch Lov_15
.p2align 12
.fill 112, 4, 0xbf800000
Lst_15_0:
s_branch Lwr_190
s_nop 0
s_nop 0
Lov_15:
v_lshlrev_b32 v84, 16, v62
v_and_b32 v85, 0xffff0000, v62
v_lshlrev_b32 v86, 16, v63
buffer_load_dwordx4 v3, s[8:11], s37 offen offset:3072 sc1 lds
v_and_b32 v87, 0xffff0000, v63
v_add_f32 v72, v72, v80
v_add_f32 v73, v73, v81
v_add_f32 v74, v74, v82
s_add_u32 s38, s35, 15
s_and_b32 s38, s38, 15
s_mul_i32 s38, s38, 458752
s_add_u32 m0, s50, 0
s_nop 0
buffer_load_dwordx4 v6, s[16:19], s38 offen lds
v_add_f32 v75, v75, v83
v_add_f32 v76, v76, v84
v_add_f32 v77, v77, v85
v_add_f32 v78, v78, v86
s_add_u32 m0, s50, 1024
s_nop 0
buffer_load_dwordx4 v7, s[16:19], s38 offen lds
v_add_f32 v79, v79, v87
v_lshlrev_b32 v80, 16, v64
v_and_b32 v81, 0xffff0000, v64
v_lshlrev_b32 v82, 16, v65
s_add_u32 m0, s50, 2048
s_nop 0
buffer_load_dwordx4 v8, s[16:19], s38 offen lds
v_and_b32 v83, 0xffff0000, v65
v_lshlrev_b32 v84, 16, v66
v_and_b32 v85, 0xffff0000, v66
v_lshlrev_b32 v86, 16, v67
s_add_u32 m0, s50, 3072
s_add_u32 s38, s38, 114688
buffer_load_dwordx4 v6, s[16:19], s38 offen lds
v_and_b32 v87, 0xffff0000, v67
v_add_f32 v72, v72, v80
v_add_f32 v73, v73, v81
v_add_f32 v74, v74, v82
v_add_f32 v75, v75, v83
s_add_u32 m0, s50, 4096
s_nop 0
buffer_load_dwordx4 v7, s[16:19], s38 offen lds
s_add_u32 m0, s50, 5120
s_nop 0
buffer_load_dwordx4 v8, s[16:19], s38 offen lds
s_waitcnt vmcnt(10)
s_barrier
s_add_u32 s37, s35, 0
s_and_b32 s37, s37, 15
s_mul_i32 s37, s37, 16384
s_add_u32 m0, s39, 49152
s_nop 0
buffer_load_dwordx4 v3, s[8:11], s37 offen sc1 lds
v_add_f32 v76, v76, v84
v_add_f32 v77, v77, v85
v_add_f32 v78, v78, v86
buffer_load_dwordx4 v3, s[8:11], s37 offen offset:1024 sc1 lds
v_add_f32 v79, v79, v87
v_lshlrev_b32 v80, 16, v68
v_and_b32 v81, 0xffff0000, v68
buffer_load_dwordx4 v3, s[8:11], s37 offen offset:2048 sc1 lds
v_lshlrev_b32 v82, 16, v69
v_and_b32 v83, 0xffff0000, v69
v_lshlrev_b32 v84, 16, v70
v_and_b32 v85, 0xffff0000, v70
buffer_load_dwordx4 v3, s[8:11], s37 offen offset:3072 sc1 lds
v_lshlrev_b32 v86, 16, v71
v_and_b32 v87, 0xffff0000, v71
v_add_f32 v72, v72, v80
s_add_u32 s38, s35, 0
s_and_b32 s38, s38, 15
s_mul_i32 s38, s38, 458752
s_add_u32 m0, s40, 49152
s_nop 0
buffer_load_dwordx4 v4, s[12:15], s38 offen lds
v_add_f32 v73, v73, v81
v_add_f32 v74, v74, v82
v_add_f32 v75, v75, v83
v_add_f32 v76, v76, v84
s_add_u32 m0, s40, 50176
s_nop 0
buffer_load_dwordx4 v5, s[12:15], s38 offen lds
v_add_f32 v77, v77, v85
v_add_f32 v78, v78, v86
v_add_f32 v79, v79, v87
s_add_u32 m0, s40, 51200
s_add_u32 s38, s38, 57344
buffer_load_dwordx4 v4, s[12:15], s38 offen lds
s_nop 0
v_permlane32_swap_b32 v72, v76
v_permlane32_swap_b32 v73, v77
s_add_u32 m0, s40, 52224
s_nop 0
buffer_load_dwordx4 v5, s[12:15], s38 offen lds
v_permlane32_swap_b32 v74, v78
v_permlane32_swap_b32 v75, v79
v_add_f32 v72, v72, v76
v_add_f32 v73, v73, v77
s_add_u32 m0, s40, 53248
s_add_u32 s38, s38, 57344
buffer_load_dwordx4 v4, s[12:15], s38 offen lds
v_add_f32 v74, v74, v78
v_add_f32 v75, v75, v79
s_nop 0
s_add_u32 m0, s40, 54272
s_nop 0
buffer_load_dwordx4 v5, s[12:15], s38 offen lds
v_permlane16_swap_b32 v72, v74
v_permlane16_swap_b32 v73, v75
v_add_f32 v72, v72, v74
v_add_f32 v73, v73, v75
s_add_u32 m0, s40, 55296
s_add_u32 s38, s38, 57344
buffer_load_dwordx4 v4, s[12:15], s38 offen lds
s_add_u32 m0, s40, 56320
s_nop 0
buffer_load_dwordx4 v5, s[12:15], s38 offen lds
s_waitcnt vmcnt(12)
s_barrier
s_lshl_b32 s43, s47, 9
s_add_u32 s43, s43, 153600
v_and_b32 v80, 15, v1
v_lshl_add_u32 v80, v80, 5, s43
v_lshrrev_b32 v81, 4, v1
v_lshl_add_u32 v80, v81, 3, v80
ds_write_b64 v80, v[72:73]
s_waitcnt lgkmcnt(0)
s_add_u32 s37, s35, 1
s_and_b32 s37, s37, 15
s_mul_i32 s37, s37, 16384
s_add_u32 m0, s39, 98304
s_nop 0
buffer_load_dwordx4 v3, s[8:11], s37 offen sc1 lds
s_bfe_u32 s61, s35, 0x10002
s_lshr_b32 s60, s35, 3
buffer_load_dwordx4 v3, s[8:11], s37 offen offset:1024 sc1 lds
s_lshl_b32 s60, s60, 2
s_and_b32 s43, s35, 3
s_add_u32 s60, s60, s43
buffer_load_dwordx4 v3, s[8:11], s37 offen offset:2048 sc1 lds
s_lshl_b32 s43, s60, 8
s_add_u32 s28, s76, s43
buffer_load_dwordx4 v3, s[8:11], s37 offen offset:3072 sc1 lds
s_addc_u32 s29, s77, 0
s_mov_b32 s30, 7338240
s_mov_b32 s31, 0x20000
s_add_u32 s38, s35, 1
s_and_b32 s38, s38, 15
s_mul_i32 s38, s38, 458752
s_add_u32 m0, s40, 98304
s_nop 0
buffer_load_dwordx4 v4, s[12:15], s38 offen lds
s_mul_i32 s52, s61, 196608
s_mul_i32 s53, s61, 1572864
s_mul_i32 s90, s61, 163840
s_add_u32 m0, s40, 99328
s_nop 0
buffer_load_dwordx4 v5, s[12:15], s38 offen lds
s_mul_i32 s91, s61, 1310720
s_lshl_b32 s51, s47, 11
s_add_u32 m0, s40, 100352
s_add_u32 s38, s38, 57344
buffer_load_dwordx4 v4, s[12:15], s38 offen lds
s_lshl_b32 s44, s47, 15
v_lshrrev_b32 v122, 4, v1
v_lshlrev_b32 v123, 1, v122
s_add_u32 m0, s40, 101376
s_nop 0
buffer_load_dwordx4 v5, s[12:15], s38 offen lds
v_and_b32 v23, 15, v1
v_xor_b32 v23, v23, v123
s_add_u32 m0, s40, 102400
s_add_u32 s38, s38, 57344
buffer_load_dwordx4 v4, s[12:15], s38 offen lds
v_lshlrev_b32 v23, 4, v23
v_mul_u32_u24 v122, 2048, v122
v_add_u32 v23, v23, v122
s_add_u32 m0, s40, 103424
s_nop 0
buffer_load_dwordx4 v5, s[12:15], s38 offen lds
v_add_u32 v23, s44, v23
v_xor_b32 v24, 128, v23
v_add_u32 v24, 8192, v24
s_add_u32 m0, s40, 104448
s_add_u32 s38, s38, 57344
buffer_load_dwordx4 v4, s[12:15], s38 offen lds
s_add_u32 m0, s40, 105472
s_nop 0
buffer_load_dwordx4 v5, s[12:15], s38 offen lds
s_waitcnt vmcnt(12)
s_barrier
ds_read_b128 v[28:31], v9 offset:49152
ds_read_b64_tr_b16 v[44:45], v15 offset:0
ds_read_b64_tr_b16 v[46:47], v15 offset:4096
ds_read_b64_tr_b16 v[48:49], v16 offset:0
ds_read_b64_tr_b16 v[50:51], v16 offset:4096
ds_read_b64_tr_b16 v[52:53], v17 offset:0
ds_read_b64_tr_b16 v[54:55], v17 offset:4096
ds_read_b64_tr_b16 v[56:57], v18 offset:0
ds_read_b64_tr_b16 v[58:59], v18 offset:4096
ds_read_b64_tr_b16 v[60:61], v15 offset:16384
ds_read_b64_tr_b16 v[62:63], v15 offset:20480
ds_read_b64_tr_b16 v[64:65], v16 offset:16384
ds_read_b64_tr_b16 v[66:67], v16 offset:20480
ds_read_b64_tr_b16 v[68:69], v17 offset:16384
ds_read_b64_tr_b16 v[70:71], v17 offset:20480
ds_read_b64_tr_b16 v[72:73], v18 offset:16384
ds_read_b64_tr_b16 v[74:75], v18 offset:20480
ds_read_b128 v[32:35], v9 offset:50176
ds_read_b128 v[36:39], v9 offset:51200
ds_read_b128 v[40:43], v9 offset:52224
s_waitcnt lgkmcnt(0)
v_mfma_f32_16x16x32_bf16 v[124:127], v[44:47], v[28:31], 0
ds_read_b128 v[76:79], v9 offset:57344
v_mfma_f32_16x16x32_bf16 v[128:131], v[48:51], v[28:31], 0
ds_read_b64_tr_b16 v[92:93], v15 offset:8192
v_mfma_f32_16x16x32_bf16 v[132:135], v[52:55], v[28:31], 0
ds_read_b64_tr_b16 v[94:95], v15 offset:12288
v_mfma_f32_16x16x32_bf16 v[136:139], v[56:59], v[28:31], 0
ds_read_b64_tr_b16 v[96:97], v16 offset:8192
v_mfma_f32_16x16x32_bf16 v[140:143], v[60:63], v[28:31], 0
ds_read_b64_tr_b16 v[98:99], v16 offset:12288
v_mfma_f32_16x16x32_bf16 v[144:147], v[64:67], v[28:31], 0
ds_read_b64_tr_b16 v[100:101], v17 offset:8192
v_mfma_f32_16x16x32_bf16 v[148:151], v[68:71], v[28:31], 0
ds_read_b64_tr_b16 v[102:103], v17 offset:12288
v_mfma_f32_16x16x32_bf16 v[152:155], v[72:75], v[28:31], 0
ds_read_b64_tr_b16 v[104:105], v18 offset:8192
v_mfma_f32_16x16x32_bf16 v[184:187], v[72:75], v[32:35], 0
ds_read_b64_tr_b16 v[106:107], v18 offset:12288
v_mfma_f32_16x16x32_bf16 v[180:183], v[68:71], v[32:35], 0
ds_read_b64_tr_b16 v[108:109], v15 offset:24576
v_mfma_f32_16x16x32_bf16 v[176:179], v[64:67], v[32:35], 0
ds_read_b64_tr_b16 v[110:111], v15 offset:28672
v_mfma_f32_16x16x32_bf16 v[172:175], v[60:63], v[32:35], 0
ds_read_b64_tr_b16 v[112:113], v16 offset:24576
v_mfma_f32_16x16x32_bf16 v[168:171], v[56:59], v[32:35], 0
ds_read_b64_tr_b16 v[114:115], v16 offset:28672
v_mfma_f32_16x16x32_bf16 v[164:167], v[52:55], v[32:35], 0
ds_read_b64_tr_b16 v[116:117], v17 offset:24576
v_mfma_f32_16x16x32_bf16 v[160:163], v[48:51], v[32:35], 0
ds_read_b64_tr_b16 v[118:119], v17 offset:28672
v_mfma_f32_16x16x32_bf16 v[156:159], v[44:47], v[32:35], 0
ds_read_b64_tr_b16 v[120:121], v18 offset:24576
v_mfma_f32_16x16x32_bf16 v[188:191], v[44:47], v[36:39], 0
ds_read_b64_tr_b16 v[122:123], v18 offset:28672
v_mfma_f32_16x16x32_bf16 v[192:195], v[48:51], v[36:39], 0
ds_read_b128 v[80:83], v9 offset:58368
v_mfma_f32_16x16x32_bf16 v[196:199], v[52:55], v[36:39], 0
ds_read_b128 v[84:87], v9 offset:59392
v_mfma_f32_16x16x32_bf16 v[200:203], v[56:59], v[36:39], 0
ds_read_b128 v[88:91], v9 offset:60416
v_mfma_f32_16x16x32_bf16 v[204:207], v[60:63], v[36:39], 0
v_mfma_f32_16x16x32_bf16 v[208:211], v[64:67], v[36:39], 0
v_mfma_f32_16x16x32_bf16 v[212:215], v[68:71], v[36:39], 0
v_mfma_f32_16x16x32_bf16 v[216:219], v[72:75], v[36:39], 0
v_mfma_f32_16x16x32_bf16 v[248:251], v[72:75], v[40:43], 0
v_mfma_f32_16x16x32_bf16 v[244:247], v[68:71], v[40:43], 0
v_mfma_f32_16x16x32_bf16 v[240:243], v[64:67], v[40:43], 0
v_mfma_f32_16x16x32_bf16 v[236:239], v[60:63], v[40:43], 0
v_mfma_f32_16x16x32_bf16 v[232:235], v[56:59], v[40:43], 0
v_mfma_f32_16x16x32_bf16 v[228:231], v[52:55], v[40:43], 0
v_mfma_f32_16x16x32_bf16 v[224:227], v[48:51], v[40:43], 0
v_mfma_f32_16x16x32_bf16 v[220:223], v[44:47], v[40:43], 0
s_waitcnt vmcnt(0)
s_waitcnt lgkmcnt(0)
s_barrier
v_mfma_f32_16x16x32_bf16 v[124:127], v[92:95], v[76:79], v[124:127]
ds_read_b128 v[28:31], v10 offset:0
v_mfma_f32_16x16x32_bf16 v[128:131], v[96:99], v[76:79], v[128:131]
ds_read_b64_tr_b16 v[44:45], v19 offset:0
v_mfma_f32_16x16x32_bf16 v[132:135], v[100:103], v[76:79], v[132:135]
ds_read_b64_tr_b16 v[46:47], v19 offset:4096
v_mfma_f32_16x16x32_bf16 v[136:139], v[104:107], v[76:79], v[136:139]
ds_read_b64_tr_b16 v[48:49], v20 offset:0
v_mfma_f32_16x16x32_bf16 v[140:143], v[108:111], v[76:79], v[140:143]
ds_read_b64_tr_b16 v[50:51], v20 offset:4096
v_mfma_f32_16x16x32_bf16 v[144:147], v[112:115], v[76:79], v[144:147]
ds_read_b64_tr_b16 v[52:53], v21 offset:0
v_mfma_f32_16x16x32_bf16 v[148:151], v[116:119], v[76:79], v[148:151]
ds_read_b64_tr_b16 v[54:55], v21 offset:4096
v_mfma_f32_16x16x32_bf16 v[152:155], v[120:123], v[76:79], v[152:155]
ds_read_b64_tr_b16 v[56:57], v22 offset:0
v_mfma_f32_16x16x32_bf16 v[184:187], v[120:123], v[80:83], v[184:187]
ds_read_b64_tr_b16 v[58:59], v22 offset:4096
v_mfma_f32_16x16x32_bf16 v[180:183], v[116:119], v[80:83], v[180:183]
ds_read_b64_tr_b16 v[60:61], v19 offset:16384
v_mfma_f32_16x16x32_bf16 v[176:179], v[112:115], v[80:83], v[176:179]
ds_read_b64_tr_b16 v[62:63], v19 offset:20480
v_mfma_f32_16x16x32_bf16 v[172:175], v[108:111], v[80:83], v[172:175]
ds_read_b64_tr_b16 v[64:65], v20 offset:16384
v_mfma_f32_16x16x32_bf16 v[168:171], v[104:107], v[80:83], v[168:171]
ds_read_b64_tr_b16 v[66:67], v20 offset:20480
v_mfma_f32_16x16x32_bf16 v[164:167], v[100:103], v[80:83], v[164:167]
ds_read_b64_tr_b16 v[68:69], v21 offset:16384
v_mfma_f32_16x16x32_bf16 v[160:163], v[96:99], v[80:83], v[160:163]
ds_read_b64_tr_b16 v[70:71], v21 offset:20480
v_mfma_f32_16x16x32_bf16 v[156:159], v[92:95], v[80:83], v[156:159]
ds_read_b64_tr_b16 v[72:73], v22 offset:16384
v_mfma_f32_16x16x32_bf16 v[188:191], v[92:95], v[84:87], v[188:191]
ds_read_b64_tr_b16 v[74:75], v22 offset:20480
v_mfma_f32_16x16x32_bf16 v[192:195], v[96:99], v[84:87], v[192:195]
ds_read_b128 v[32:35], v10 offset:1024
v_mfma_f32_16x16x32_bf16 v[196:199], v[100:103], v[84:87], v[196:199]
ds_read_b128 v[36:39], v10 offset:2048
v_mfma_f32_16x16x32_bf16 v[200:203], v[104:107], v[84:87], v[200:203]
ds_read_b128 v[40:43], v10 offset:3072
v_mfma_f32_16x16x32_bf16 v[204:207], v[108:111], v[84:87], v[204:207]
v_mfma_f32_16x16x32_bf16 v[208:211], v[112:115], v[84:87], v[208:211]
v_mfma_f32_16x16x32_bf16 v[212:215], v[116:119], v[84:87], v[212:215]
v_mfma_f32_16x16x32_bf16 v[216:219], v[120:123], v[84:87], v[216:219]
v_mfma_f32_16x16x32_bf16 v[248:251], v[120:123], v[88:91], v[248:251]
v_mfma_f32_16x16x32_bf16 v[244:247], v[116:119], v[88:91], v[244:247]
v_mfma_f32_16x16x32_bf16 v[240:243], v[112:115], v[88:91], v[240:243]
v_mfma_f32_16x16x32_bf16 v[236:239], v[108:111], v[88:91], v[236:239]
v_mfma_f32_16x16x32_bf16 v[232:235], v[104:107], v[88:91], v[232:235]
v_mfma_f32_16x16x32_bf16 v[228:231], v[100:103], v[88:91], v[228:231]
v_mfma_f32_16x16x32_bf16 v[224:227], v[96:99], v[88:91], v[224:227]
v_mfma_f32_16x16x32_bf16 v[220:223], v[92:95], v[88:91], v[220:223]
s_mov_b32 s41, 5
Lk3l_154:
s_waitcnt lgkmcnt(0)
v_mfma_f32_16x16x32_bf16 v[124:127], v[44:47], v[28:31], v[124:127]
ds_read_b128 v[76:79], v10 offset:8192
v_mfma_f32_16x16x32_bf16 v[128:131], v[48:51], v[28:31], v[128:131]
ds_read_b64_tr_b16 v[92:93], v19 offset:8192
v_mfma_f32_16x16x32_bf16 v[132:135], v[52:55], v[28:31], v[132:135]
ds_read_b64_tr_b16 v[94:95], v19 offset:12288
v_mfma_f32_16x16x32_bf16 v[136:139], v[56:59], v[28:31], v[136:139]
ds_read_b64_tr_b16 v[96:97], v20 offset:8192
v_mfma_f32_16x16x32_bf16 v[140:143], v[60:63], v[28:31], v[140:143]
ds_read_b64_tr_b16 v[98:99], v20 offset:12288
v_mfma_f32_16x16x32_bf16 v[144:147], v[64:67], v[28:31], v[144:147]
ds_read_b64_tr_b16 v[100:101], v21 offset:8192
v_mfma_f32_16x16x32_bf16 v[148:151], v[68:71], v[28:31], v[148:151]
ds_read_b64_tr_b16 v[102:103], v21 offset:12288
v_mfma_f32_16x16x32_bf16 v[152:155], v[72:75], v[28:31], v[152:155]
ds_read_b64_tr_b16 v[104:105], v22 offset:8192
v_mfma_f32_16x16x32_bf16 v[184:187], v[72:75], v[32:35], v[184:187]
ds_read_b64_tr_b16 v[106:107], v22 offset:12288
v_mfma_f32_16x16x32_bf16 v[180:183], v[68:71], v[32:35], v[180:183]
ds_read_b64_tr_b16 v[108:109], v19 offset:24576
v_mfma_f32_16x16x32_bf16 v[176:179], v[64:67], v[32:35], v[176:179]
ds_read_b64_tr_b16 v[110:111], v19 offset:28672
v_mfma_f32_16x16x32_bf16 v[172:175], v[60:63], v[32:35], v[172:175]
ds_read_b64_tr_b16 v[112:113], v20 offset:24576
v_mfma_f32_16x16x32_bf16 v[168:171], v[56:59], v[32:35], v[168:171]
ds_read_b64_tr_b16 v[114:115], v20 offset:28672
v_mfma_f32_16x16x32_bf16 v[164:167], v[52:55], v[32:35], v[164:167]
ds_read_b64_tr_b16 v[116:117], v21 offset:24576
v_mfma_f32_16x16x32_bf16 v[160:163], v[48:51], v[32:35], v[160:163]
ds_read_b64_tr_b16 v[118:119], v21 offset:28672
v_mfma_f32_16x16x32_bf16 v[156:159], v[44:47], v[32:35], v[156:159]
ds_read_b64_tr_b16 v[120:121], v22 offset:24576
v_mfma_f32_16x16x32_bf16 v[188:191], v[44:47], v[36:39], v[188:191]
ds_read_b64_tr_b16 v[122:123], v22 offset:28672
v_mfma_f32_16x16x32_bf16 v[192:195], v[48:51], v[36:39], v[192:195]
ds_read_b128 v[80:83], v10 offset:9216
v_mfma_f32_16x16x32_bf16 v[196:199], v[52:55], v[36:39], v[196:199]
ds_read_b128 v[84:87], v10 offset:10240
v_mfma_f32_16x16x32_bf16 v[200:203], v[56:59], v[36:39], v[200:203]
ds_read_b128 v[88:91], v10 offset:11264
v_mfma_f32_16x16x32_bf16 v[204:207], v[60:63], v[36:39], v[204:207]
v_mfma_f32_16x16x32_bf16 v[208:211], v[64:67], v[36:39], v[208:211]
v_mfma_f32_16x16x32_bf16 v[212:215], v[68:71], v[36:39], v[212:215]
v_mfma_f32_16x16x32_bf16 v[216:219], v[72:75], v[36:39], v[216:219]
v_mfma_f32_16x16x32_bf16 v[248:251], v[72:75], v[40:43], v[248:251]
v_mfma_f32_16x16x32_bf16 v[244:247], v[68:71], v[40:43], v[244:247]
v_mfma_f32_16x16x32_bf16 v[240:243], v[64:67], v[40:43], v[240:243]
v_mfma_f32_16x16x32_bf16 v[236:239], v[60:63], v[40:43], v[236:239]
v_mfma_f32_16x16x32_bf16 v[232:235], v[56:59], v[40:43], v[232:235]
v_mfma_f32_16x16x32_bf16 v[228:231], v[52:55], v[40:43], v[228:231]
v_mfma_f32_16x16x32_bf16 v[224:227], v[48:51], v[40:43], v[224:227]
v_mfma_f32_16x16x32_bf16 v[220:223], v[44:47], v[40:43], v[220:223]
s_waitcnt lgkmcnt(0)
s_barrier
v_mfma_f32_16x16x32_bf16 v[124:127], v[92:95], v[76:79], v[124:127]
ds_read_b128 v[28:31], v9 offset:0
v_mfma_f32_16x16x32_bf16 v[128:131], v[96:99], v[76:79], v[128:131]
ds_read_b64_tr_b16 v[44:45], v11 offset:0
v_mfma_f32_16x16x32_bf16 v[132:135], v[100:103], v[76:79], v[132:135]
ds_read_b64_tr_b16 v[46:47], v11 offset:4096
v_mfma_f32_16x16x32_bf16 v[136:139], v[104:107], v[76:79], v[136:139]
ds_read_b64_tr_b16 v[48:49], v12 offset:0
v_mfma_f32_16x16x32_bf16 v[140:143], v[108:111], v[76:79], v[140:143]
ds_read_b64_tr_b16 v[50:51], v12 offset:4096
v_mfma_f32_16x16x32_bf16 v[144:147], v[112:115], v[76:79], v[144:147]
ds_read_b64_tr_b16 v[52:53], v13 offset:0
v_mfma_f32_16x16x32_bf16 v[148:151], v[116:119], v[76:79], v[148:151]
ds_read_b64_tr_b16 v[54:55], v13 offset:4096
v_mfma_f32_16x16x32_bf16 v[152:155], v[120:123], v[76:79], v[152:155]
ds_read_b64_tr_b16 v[56:57], v14 offset:0
v_mfma_f32_16x16x32_bf16 v[184:187], v[120:123], v[80:83], v[184:187]
ds_read_b64_tr_b16 v[58:59], v14 offset:4096
v_mfma_f32_16x16x32_bf16 v[180:183], v[116:119], v[80:83], v[180:183]
ds_read_b64_tr_b16 v[60:61], v11 offset:16384
v_mfma_f32_16x16x32_bf16 v[176:179], v[112:115], v[80:83], v[176:179]
ds_read_b64_tr_b16 v[62:63], v11 offset:20480
v_mfma_f32_16x16x32_bf16 v[172:175], v[108:111], v[80:83], v[172:175]
ds_read_b64_tr_b16 v[64:65], v12 offset:16384
v_mfma_f32_16x16x32_bf16 v[168:171], v[104:107], v[80:83], v[168:171]
ds_read_b64_tr_b16 v[66:67], v12 offset:20480
v_mfma_f32_16x16x32_bf16 v[164:167], v[100:103], v[80:83], v[164:167]
ds_read_b64_tr_b16 v[68:69], v13 offset:16384
v_mfma_f32_16x16x32_bf16 v[160:163], v[96:99], v[80:83], v[160:163]
ds_read_b64_tr_b16 v[70:71], v13 offset:20480
v_mfma_f32_16x16x32_bf16 v[156:159], v[92:95], v[80:83], v[156:159]
ds_read_b64_tr_b16 v[72:73], v14 offset:16384
v_mfma_f32_16x16x32_bf16 v[188:191], v[92:95], v[84:87], v[188:191]
ds_read_b64_tr_b16 v[74:75], v14 offset:20480
v_mfma_f32_16x16x32_bf16 v[192:195], v[96:99], v[84:87], v[192:195]
ds_read_b128 v[32:35], v9 offset:1024
v_mfma_f32_16x16x32_bf16 v[196:199], v[100:103], v[84:87], v[196:199]
ds_read_b128 v[36:39], v9 offset:2048
v_mfma_f32_16x16x32_bf16 v[200:203], v[104:107], v[84:87], v[200:203]
ds_read_b128 v[40:43], v9 offset:3072
v_mfma_f32_16x16x32_bf16 v[204:207], v[108:111], v[84:87], v[204:207]
v_mfma_f32_16x16x32_bf16 v[208:211], v[112:115], v[84:87], v[208:211]
v_mfma_f32_16x16x32_bf16 v[212:215], v[116:119], v[84:87], v[212:215]
v_mfma_f32_16x16x32_bf16 v[216:219], v[120:123], v[84:87], v[216:219]
v_mfma_f32_16x16x32_bf16 v[248:251], v[120:123], v[88:91], v[248:251]
v_mfma_f32_16x16x32_bf16 v[244:247], v[116:119], v[88:91], v[244:247]
v_mfma_f32_16x16x32_bf16 v[240:243], v[112:115], v[88:91], v[240:243]
v_mfma_f32_16x16x32_bf16 v[236:239], v[108:111], v[88:91], v[236:239]
v_mfma_f32_16x16x32_bf16 v[232:235], v[104:107], v[88:91], v[232:235]
v_mfma_f32_16x16x32_bf16 v[228:231], v[100:103], v[88:91], v[228:231]
v_mfma_f32_16x16x32_bf16 v[224:227], v[96:99], v[88:91], v[224:227]
v_mfma_f32_16x16x32_bf16 v[220:223], v[92:95], v[88:91], v[220:223]
s_waitcnt lgkmcnt(0)
v_mfma_f32_16x16x32_bf16 v[124:127], v[44:47], v[28:31], v[124:127]
ds_read_b128 v[76:79], v9 offset:8192
v_mfma_f32_16x16x32_bf16 v[128:131], v[48:51], v[28:31], v[128:131]
ds_read_b64_tr_b16 v[92:93], v11 offset:8192
v_mfma_f32_16x16x32_bf16 v[132:135], v[52:55], v[28:31], v[132:135]
ds_read_b64_tr_b16 v[94:95], v11 offset:12288
v_mfma_f32_16x16x32_bf16 v[136:139], v[56:59], v[28:31], v[136:139]
ds_read_b64_tr_b16 v[96:97], v12 offset:8192
v_mfma_f32_16x16x32_bf16 v[140:143], v[60:63], v[28:31], v[140:143]
ds_read_b64_tr_b16 v[98:99], v12 offset:12288
v_mfma_f32_16x16x32_bf16 v[144:147], v[64:67], v[28:31], v[144:147]
ds_read_b64_tr_b16 v[100:101], v13 offset:8192
v_mfma_f32_16x16x32_bf16 v[148:151], v[68:71], v[28:31], v[148:151]
ds_read_b64_tr_b16 v[102:103], v13 offset:12288
v_mfma_f32_16x16x32_bf16 v[152:155], v[72:75], v[28:31], v[152:155]
ds_read_b64_tr_b16 v[104:105], v14 offset:8192
v_mfma_f32_16x16x32_bf16 v[184:187], v[72:75], v[32:35], v[184:187]
ds_read_b64_tr_b16 v[106:107], v14 offset:12288
v_mfma_f32_16x16x32_bf16 v[180:183], v[68:71], v[32:35], v[180:183]
ds_read_b64_tr_b16 v[108:109], v11 offset:24576
v_mfma_f32_16x16x32_bf16 v[176:179], v[64:67], v[32:35], v[176:179]
ds_read_b64_tr_b16 v[110:111], v11 offset:28672
v_mfma_f32_16x16x32_bf16 v[172:175], v[60:63], v[32:35], v[172:175]
ds_read_b64_tr_b16 v[112:113], v12 offset:24576
v_mfma_f32_16x16x32_bf16 v[168:171], v[56:59], v[32:35], v[168:171]
ds_read_b64_tr_b16 v[114:115], v12 offset:28672
v_mfma_f32_16x16x32_bf16 v[164:167], v[52:55], v[32:35], v[164:167]
ds_read_b64_tr_b16 v[116:117], v13 offset:24576
v_mfma_f32_16x16x32_bf16 v[160:163], v[48:51], v[32:35], v[160:163]
ds_read_b64_tr_b16 v[118:119], v13 offset:28672
v_mfma_f32_16x16x32_bf16 v[156:159], v[44:47], v[32:35], v[156:159]
ds_read_b64_tr_b16 v[120:121], v14 offset:24576
v_mfma_f32_16x16x32_bf16 v[188:191], v[44:47], v[36:39], v[188:191]
ds_read_b64_tr_b16 v[122:123], v14 offset:28672
v_mfma_f32_16x16x32_bf16 v[192:195], v[48:51], v[36:39], v[192:195]
ds_read_b128 v[80:83], v9 offset:9216
v_mfma_f32_16x16x32_bf16 v[196:199], v[52:55], v[36:39], v[196:199]
ds_read_b128 v[84:87], v9 offset:10240
v_mfma_f32_16x16x32_bf16 v[200:203], v[56:59], v[36:39], v[200:203]
ds_read_b128 v[88:91], v9 offset:11264
v_mfma_f32_16x16x32_bf16 v[204:207], v[60:63], v[36:39], v[204:207]
v_mfma_f32_16x16x32_bf16 v[208:211], v[64:67], v[36:39], v[208:211]
v_mfma_f32_16x16x32_bf16 v[212:215], v[68:71], v[36:39], v[212:215]
v_mfma_f32_16x16x32_bf16 v[216:219], v[72:75], v[36:39], v[216:219]
v_mfma_f32_16x16x32_bf16 v[248:251], v[72:75], v[40:43], v[248:251]
v_mfma_f32_16x16x32_bf16 v[244:247], v[68:71], v[40:43], v[244:247]
v_mfma_f32_16x16x32_bf16 v[240:243], v[64:67], v[40:43], v[240:243]
v_mfma_f32_16x16x32_bf16 v[236:239], v[60:63], v[40:43], v[236:239]
v_mfma_f32_16x16x32_bf16 v[232:235], v[56:59], v[40:43], v[232:235]
v_mfma_f32_16x16x32_bf16 v[228:231], v[52:55], v[40:43], v[228:231]
v_mfma_f32_16x16x32_bf16 v[224:227], v[48:51], v[40:43], v[224:227]
v_mfma_f32_16x16x32_bf16 v[220:223], v[44:47], v[40:43], v[220:223]
s_waitcnt lgkmcnt(0)
s_barrier
v_mfma_f32_16x16x32_bf16 v[124:127], v[92:95], v[76:79], v[124:127]
ds_read_b128 v[28:31], v9 offset:49152
v_mfma_f32_16x16x32_bf16 v[128:131], v[96:99], v[76:79], v[128:131]
ds_read_b64_tr_b16 v[44:45], v15 offset:0
v_mfma_f32_16x16x32_bf16 v[132:135], v[100:103], v[76:79], v[132:135]
ds_read_b64_tr_b16 v[46:47], v15 offset:4096
v_mfma_f32_16x16x32_bf16 v[136:139], v[104:107], v[76:79], v[136:139]
ds_read_b64_tr_b16 v[48:49], v16 offset:0
v_mfma_f32_16x16x32_bf16 v[140:143], v[108:111], v[76:79], v[140:143]
ds_read_b64_tr_b16 v[50:51], v16 offset:4096
v_mfma_f32_16x16x32_bf16 v[144:147], v[112:115], v[76:79], v[144:147]
ds_read_b64_tr_b16 v[52:53], v17 offset:0
v_mfma_f32_16x16x32_bf16 v[148:151], v[116:119], v[76:79], v[148:151]
ds_read_b64_tr_b16 v[54:55], v17 offset:4096
v_mfma_f32_16x16x32_bf16 v[152:155], v[120:123], v[76:79], v[152:155]
ds_read_b64_tr_b16 v[56:57], v18 offset:0
v_mfma_f32_16x16x32_bf16 v[184:187], v[120:123], v[80:83], v[184:187]
ds_read_b64_tr_b16 v[58:59], v18 offset:4096
v_mfma_f32_16x16x32_bf16 v[180:183], v[116:119], v[80:83], v[180:183]
ds_read_b64_tr_b16 v[60:61], v15 offset:16384
v_mfma_f32_16x16x32_bf16 v[176:179], v[112:115], v[80:83], v[176:179]
ds_read_b64_tr_b16 v[62:63], v15 offset:20480
v_mfma_f32_16x16x32_bf16 v[172:175], v[108:111], v[80:83], v[172:175]
ds_read_b64_tr_b16 v[64:65], v16 offset:16384
v_mfma_f32_16x16x32_bf16 v[168:171], v[104:107], v[80:83], v[168:171]
ds_read_b64_tr_b16 v[66:67], v16 offset:20480
v_mfma_f32_16x16x32_bf16 v[164:167], v[100:103], v[80:83], v[164:167]
s_branch Lov_16
.p2align 12
.fill 128, 4, 0xbf800000
Lst_16_0:
s_branch Lwr_191
s_nop 0
s_nop 0
Lov_16:
ds_read_b64_tr_b16 v[68:69], v17 offset:16384
v_mfma_f32_16x16x32_bf16 v[160:163], v[96:99], v[80:83], v[160:163]
ds_read_b64_tr_b16 v[70:71], v17 offset:20480
v_mfma_f32_16x16x32_bf16 v[156:159], v[92:95], v[80:83], v[156:159]
ds_read_b64_tr_b16 v[72:73], v18 offset:16384
v_mfma_f32_16x16x32_bf16 v[188:191], v[92:95], v[84:87], v[188:191]
ds_read_b64_tr_b16 v[74:75], v18 offset:20480
v_mfma_f32_16x16x32_bf16 v[192:195], v[96:99], v[84:87], v[192:195]
ds_read_b128 v[32:35], v9 offset:50176
v_mfma_f32_16x16x32_bf16 v[196:199], v[100:103], v[84:87], v[196:199]
ds_read_b128 v[36:39], v9 offset:51200
v_mfma_f32_16x16x32_bf16 v[200:203], v[104:107], v[84:87], v[200:203]
ds_read_b128 v[40:43], v9 offset:52224
v_mfma_f32_16x16x32_bf16 v[204:207], v[108:111], v[84:87], v[204:207]
v_mfma_f32_16x16x32_bf16 v[208:211], v[112:115], v[84:87], v[208:211]
v_mfma_f32_16x16x32_bf16 v[212:215], v[116:119], v[84:87], v[212:215]
v_mfma_f32_16x16x32_bf16 v[216:219], v[120:123], v[84:87], v[216:219]
v_mfma_f32_16x16x32_bf16 v[248:251], v[120:123], v[88:91], v[248:251]
v_mfma_f32_16x16x32_bf16 v[244:247], v[116:119], v[88:91], v[244:247]
v_mfma_f32_16x16x32_bf16 v[240:243], v[112:115], v[88:91], v[240:243]
v_mfma_f32_16x16x32_bf16 v[236:239], v[108:111], v[88:91], v[236:239]
v_mfma_f32_16x16x32_bf16 v[232:235], v[104:107], v[88:91], v[232:235]
v_mfma_f32_16x16x32_bf16 v[228:231], v[100:103], v[88:91], v[228:231]
v_mfma_f32_16x16x32_bf16 v[224:227], v[96:99], v[88:91], v[224:227]
v_mfma_f32_16x16x32_bf16 v[220:223], v[92:95], v[88:91], v[220:223]
s_waitcnt lgkmcnt(0)
v_mfma_f32_16x16x32_bf16 v[124:127], v[44:47], v[28:31], v[124:127]
ds_read_b128 v[76:79], v9 offset:57344
v_mfma_f32_16x16x32_bf16 v[128:131], v[48:51], v[28:31], v[128:131]
ds_read_b64_tr_b16 v[92:93], v15 offset:8192
v_mfma_f32_16x16x32_bf16 v[132:135], v[52:55], v[28:31], v[132:135]
ds_read_b64_tr_b16 v[94:95], v15 offset:12288
v_mfma_f32_16x16x32_bf16 v[136:139], v[56:59], v[28:31], v[136:139]
ds_read_b64_tr_b16 v[96:97], v16 offset:8192
v_mfma_f32_16x16x32_bf16 v[140:143], v[60:63], v[28:31], v[140:143]
ds_read_b64_tr_b16 v[98:99], v16 offset:12288
v_mfma_f32_16x16x32_bf16 v[144:147], v[64:67], v[28:31], v[144:147]
ds_read_b64_tr_b16 v[100:101], v17 offset:8192
v_mfma_f32_16x16x32_bf16 v[148:151], v[68:71], v[28:31], v[148:151]
ds_read_b64_tr_b16 v[102:103], v17 offset:12288
v_mfma_f32_16x16x32_bf16 v[152:155], v[72:75], v[28:31], v[152:155]
ds_read_b64_tr_b16 v[104:105], v18 offset:8192
v_mfma_f32_16x16x32_bf16 v[184:187], v[72:75], v[32:35], v[184:187]
ds_read_b64_tr_b16 v[106:107], v18 offset:12288
v_mfma_f32_16x16x32_bf16 v[180:183], v[68:71], v[32:35], v[180:183]
ds_read_b64_tr_b16 v[108:109], v15 offset:24576
v_mfma_f32_16x16x32_bf16 v[176:179], v[64:67], v[32:35], v[176:179]
ds_read_b64_tr_b16 v[110:111], v15 offset:28672
v_mfma_f32_16x16x32_bf16 v[172:175], v[60:63], v[32:35], v[172:175]
ds_read_b64_tr_b16 v[112:113], v16 offset:24576
v_mfma_f32_16x16x32_bf16 v[168:171], v[56:59], v[32:35], v[168:171]
ds_read_b64_tr_b16 v[114:115], v16 offset:28672
v_mfma_f32_16x16x32_bf16 v[164:167], v[52:55], v[32:35], v[164:167]
ds_read_b64_tr_b16 v[116:117], v17 offset:24576
v_mfma_f32_16x16x32_bf16 v[160:163], v[48:51], v[32:35], v[160:163]
ds_read_b64_tr_b16 v[118:119], v17 offset:28672
v_mfma_f32_16x16x32_bf16 v[156:159], v[44:47], v[32:35], v[156:159]
ds_read_b64_tr_b16 v[120:121], v18 offset:24576
v_mfma_f32_16x16x32_bf16 v[188:191], v[44:47], v[36:39], v[188:191]
ds_read_b64_tr_b16 v[122:123], v18 offset:28672
v_mfma_f32_16x16x32_bf16 v[192:195], v[48:51], v[36:39], v[192:195]
ds_read_b128 v[80:83], v9 offset:58368
v_mfma_f32_16x16x32_bf16 v[196:199], v[52:55], v[36:39], v[196:199]
ds_read_b128 v[84:87], v9 offset:59392
v_mfma_f32_16x16x32_bf16 v[200:203], v[56:59], v[36:39], v[200:203]
ds_read_b128 v[88:91], v9 offset:60416
v_mfma_f32_16x16x32_bf16 v[204:207], v[60:63], v[36:39], v[204:207]
v_mfma_f32_16x16x32_bf16 v[208:211], v[64:67], v[36:39], v[208:211]
v_mfma_f32_16x16x32_bf16 v[212:215], v[68:71], v[36:39], v[212:215]
v_mfma_f32_16x16x32_bf16 v[216:219], v[72:75], v[36:39], v[216:219]
v_mfma_f32_16x16x32_bf16 v[248:251], v[72:75], v[40:43], v[248:251]
v_mfma_f32_16x16x32_bf16 v[244:247], v[68:71], v[40:43], v[244:247]
v_mfma_f32_16x16x32_bf16 v[240:243], v[64:67], v[40:43], v[240:243]
v_mfma_f32_16x16x32_bf16 v[236:239], v[60:63], v[40:43], v[236:239]
v_mfma_f32_16x16x32_bf16 v[232:235], v[56:59], v[40:43], v[232:235]
v_mfma_f32_16x16x32_bf16 v[228:231], v[52:55], v[40:43], v[228:231]
v_mfma_f32_16x16x32_bf16 v[224:227], v[48:51], v[40:43], v[224:227]
v_mfma_f32_16x16x32_bf16 v[220:223], v[44:47], v[40:43], v[220:223]
s_waitcnt lgkmcnt(0)
s_barrier
v_mfma_f32_16x16x32_bf16 v[124:127], v[92:95], v[76:79], v[124:127]
ds_read_b128 v[28:31], v10 offset:0
v_mfma_f32_16x16x32_bf16 v[128:131], v[96:99], v[76:79], v[128:131]
ds_read_b64_tr_b16 v[44:45], v19 offset:0
v_mfma_f32_16x16x32_bf16 v[132:135], v[100:103], v[76:79], v[132:135]
ds_read_b64_tr_b16 v[46:47], v19 offset:4096
v_mfma_f32_16x16x32_bf16 v[136:139], v[104:107], v[76:79], v[136:139]
ds_read_b64_tr_b16 v[48:49], v20 offset:0
v_mfma_f32_16x16x32_bf16 v[140:143], v[108:111], v[76:79], v[140:143]
ds_read_b64_tr_b16 v[50:51], v20 offset:4096
v_mfma_f32_16x16x32_bf16 v[144:147], v[112:115], v[76:79], v[144:147]
ds_read_b64_tr_b16 v[52:53], v21 offset:0
v_mfma_f32_16x16x32_bf16 v[148:151], v[116:119], v[76:79], v[148:151]
ds_read_b64_tr_b16 v[54:55], v21 offset:4096
v_mfma_f32_16x16x32_bf16 v[152:155], v[120:123], v[76:79], v[152:155]
ds_read_b64_tr_b16 v[56:57], v22 offset:0
v_mfma_f32_16x16x32_bf16 v[184:187], v[120:123], v[80:83], v[184:187]
ds_read_b64_tr_b16 v[58:59], v22 offset:4096
v_mfma_f32_16x16x32_bf16 v[180:183], v[116:119], v[80:83], v[180:183]
ds_read_b64_tr_b16 v[60:61], v19 offset:16384
v_mfma_f32_16x16x32_bf16 v[176:179], v[112:115], v[80:83], v[176:179]
ds_read_b64_tr_b16 v[62:63], v19 offset:20480
v_mfma_f32_16x16x32_bf16 v[172:175], v[108:111], v[80:83], v[172:175]
ds_read_b64_tr_b16 v[64:65], v20 offset:16384
v_mfma_f32_16x16x32_bf16 v[168:171], v[104:107], v[80:83], v[168:171]
ds_read_b64_tr_b16 v[66:67], v20 offset:20480
v_mfma_f32_16x16x32_bf16 v[164:167], v[100:103], v[80:83], v[164:167]
ds_read_b64_tr_b16 v[68:69], v21 offset:16384
v_mfma_f32_16x16x32_bf16 v[160:163], v[96:99], v[80:83], v[160:163]
ds_read_b64_tr_b16 v[70:71], v21 offset:20480
v_mfma_f32_16x16x32_bf16 v[156:159], v[92:95], v[80:83], v[156:159]
ds_read_b64_tr_b16 v[72:73], v22 offset:16384
v_mfma_f32_16x16x32_bf16 v[188:191], v[92:95], v[84:87], v[188:191]
ds_read_b64_tr_b16 v[74:75], v22 offset:20480
v_mfma_f32_16x16x32_bf16 v[192:195], v[96:99], v[84:87], v[192:195]
ds_read_b128 v[32:35], v10 offset:1024
v_mfma_f32_16x16x32_bf16 v[196:199], v[100:103], v[84:87], v[196:199]
ds_read_b128 v[36:39], v10 offset:2048
v_mfma_f32_16x16x32_bf16 v[200:203], v[104:107], v[84:87], v[200:203]
ds_read_b128 v[40:43], v10 offset:3072
v_mfma_f32_16x16x32_bf16 v[204:207], v[108:111], v[84:87], v[204:207]
v_mfma_f32_16x16x32_bf16 v[208:211], v[112:115], v[84:87], v[208:211]
v_mfma_f32_16x16x32_bf16 v[212:215], v[116:119], v[84:87], v[212:215]
v_mfma_f32_16x16x32_bf16 v[216:219], v[120:123], v[84:87], v[216:219]
v_mfma_f32_16x16x32_bf16 v[248:251], v[120:123], v[88:91], v[248:251]
v_mfma_f32_16x16x32_bf16 v[244:247], v[116:119], v[88:91], v[244:247]
v_mfma_f32_16x16x32_bf16 v[240:243], v[112:115], v[88:91], v[240:243]
v_mfma_f32_16x16x32_bf16 v[236:239], v[108:111], v[88:91], v[236:239]
v_mfma_f32_16x16x32_bf16 v[232:235], v[104:107], v[88:91], v[232:235]
v_mfma_f32_16x16x32_bf16 v[228:231], v[100:103], v[88:91], v[228:231]
v_mfma_f32_16x16x32_bf16 v[224:227], v[96:99], v[88:91], v[224:227]
v_mfma_f32_16x16x32_bf16 v[220:223], v[92:95], v[88:91], v[220:223]
s_sub_u32 s41, s41, 1
s_cmp_lg_u32 s41, 0
s_cbranch_scc1 Lk3l_154
s_waitcnt lgkmcnt(0)
v_lshrrev_b32 v84, 4, v1
s_lshl_b32 s43, s63, 8
s_add_u32 s43, s43, 148480
v_lshl_add_u32 v85, v84, 4, s43
v_and_b32 v84, 15, v1
s_lshl_b32 s43, s62, 9
s_add_u32 s43, s43, 147456
v_lshl_add_u32 v84, v84, 3, s43
ds_read_b128 v[28:31], v85 offset:0
ds_read_b128 v[32:35], v85 offset:64
ds_read_b128 v[36:39], v85 offset:128
ds_read_b128 v[40:43], v85 offset:192
ds_read_b128 v[44:47], v85 offset:896
ds_read_b128 v[48:51], v85 offset:960
ds_read_b128 v[52:55], v85 offset:1024
ds_read_b128 v[56:59], v85 offset:1088
ds_read_b64 v[60:61], v84 offset:0
ds_read_b64 v[62:63], v84 offset:128
ds_read_b64 v[64:65], v84 offset:256
ds_read_b64 v[66:67], v84 offset:384
s_lshl_b32 s54, s35, 15
s_lshl_b32 s43, s63, 14
s_add_u32 s54, s54, s43
s_lshl_b32 s43, s62, 12
s_add_u32 s54, s54, s43
s_add_u32 s55, s54, 8192
v_lshrrev_b32 v122, 3, v1
v_and_b32 v123, 6, v122
v_and_b32 v25, 7, v1
v_xor_b32 v25, v25, v123
v_lshlrev_b32 v25, 4, v25
v_mul_u32_u24 v122, 2048, v122
v_add_u32 v25, v25, v122
s_lshl_b32 s43, s61, 7
s_lshl_b32 s44, s47, 15
s_add_u32 s43, s43, s44
v_add_u32 v25, s43, v25
s_waitcnt lgkmcnt(0)
s_barrier
s_add_u32 m0, s39, 81920
s_add_u32 s37, s52, 589824
buffer_load_dwordx4 v3, s[24:27], s37 offen sc1 lds
v_mul_f32 v70, v61, v61
v_mul_f32 v68, 0xc0135761, v61
v_mul_f32 v69, 0xbdd2d3e8, v61
v_mul_f32 v69, v69, v70
v_rcp_f32 v70, v70
v_mul_f32 v74, v63, v63
v_mul_f32 v72, 0xc0135761, v63
v_mul_f32 v73, 0xbdd2d3e8, v63
v_mul_f32 v73, v73, v74
v_rcp_f32 v74, v74
buffer_load_dwordx4 v3, s[24:27], s37 offen offset:1024 sc1 lds
v_fma_f32 v124, -v60, v28, v124
v_fma_f32 v125, -v60, v29, v125
v_fma_f32 v126, -v60, v30, v126
v_fma_f32 v127, -v60, v31, v127
v_fma_f32 v156, -v62, v28, v156
v_fma_f32 v157, -v62, v29, v157
v_fma_f32 v158, -v62, v30, v158
v_fma_f32 v159, -v62, v31, v159
v_mul_f32 v76, v124, v124
v_mul_f32 v77, v125, v125
buffer_load_dwordx4 v3, s[24:27], s37 offen offset:2048 sc1 lds
v_mul_f32 v78, v126, v126
v_mul_f32 v79, v127, v127
v_mul_f32 v80, v156, v156
v_mul_f32 v81, v157, v157
v_mul_f32 v82, v158, v158
v_mul_f32 v83, v159, v159
v_fma_f32 v76, v76, v69, v68
v_fma_f32 v77, v77, v69, v68
v_fma_f32 v78, v78, v69, v68
v_fma_f32 v79, v79, v69, v68
buffer_load_dwordx4 v3, s[24:27], s37 offen offset:3072 sc1 lds
v_fma_f32 v80, v80, v73, v72
v_fma_f32 v81, v81, v73, v72
v_fma_f32 v82, v82, v73, v72
v_fma_f32 v83, v83, v73, v72
v_mul_f32 v76, v76, v124
v_mul_f32 v77, v77, v125
v_mul_f32 v78, v78, v126
v_mul_f32 v79, v79, v127
v_mul_f32 v80, v80, v156
v_mul_f32 v81, v81, v157
s_add_u32 m0, s39, 147456
s_add_u32 s38, s53, 4718592
buffer_load_dwordx4 v23, s[28:31], s38 offen lds
v_mul_f32 v82, v82, v158
v_mul_f32 v83, v83, v159
v_exp_f32 v76, v76
v_exp_f32 v77, v77
v_exp_f32 v78, v78
v_exp_f32 v79, v79
v_exp_f32 v80, v80
v_exp_f32 v81, v81
v_exp_f32 v82, v82
v_exp_f32 v83, v83
s_add_u32 m0, s39, 148480
s_add_u32 s38, s53, 4718592
buffer_load_dwordx4 v24, s[28:31], s38 offen lds
v_fma_f32 v140, -v60, v44, v140
v_fma_f32 v141, -v60, v45, v141
v_fma_f32 v142, -v60, v46, v142
v_fma_f32 v143, -v60, v47, v143
v_fma_f32 v172, -v62, v44, v172
v_fma_f32 v173, -v62, v45, v173
v_fma_f32 v174, -v62, v46, v174
v_fma_f32 v175, -v62, v47, v175
v_fma_f32 v76, v76, v70, v70
v_fma_f32 v77, v77, v70, v70
s_add_u32 m0, s39, 149504
s_add_u32 s38, s53, 4734976
buffer_load_dwordx4 v23, s[28:31], s38 offen lds
v_fma_f32 v78, v78, v70, v70
v_fma_f32 v79, v79, v70, v70
v_fma_f32 v80, v80, v74, v74
v_fma_f32 v81, v81, v74, v74
v_fma_f32 v82, v82, v74, v74
v_fma_f32 v83, v83, v74, v74
v_rcp_f32 v76, v76
v_rcp_f32 v77, v77
v_rcp_f32 v78, v78
v_rcp_f32 v79, v79
s_add_u32 m0, s39, 150528
s_add_u32 s38, s53, 4734976
buffer_load_dwordx4 v24, s[28:31], s38 offen lds
v_rcp_f32 v80, v80
v_rcp_f32 v81, v81
v_rcp_f32 v82, v82
v_rcp_f32 v83, v83
v_mul_f32 v140, v124, v140
v_mul_f32 v141, v125, v141
v_mul_f32 v142, v126, v142
v_mul_f32 v143, v127, v143
v_mul_f32 v172, v156, v172
v_mul_f32 v173, v157, v173
s_add_u32 m0, s39, 98304
s_add_u32 s37, s52, 606208
buffer_load_dwordx4 v3, s[24:27], s37 offen sc1 lds
v_mul_f32 v174, v158, v174
v_mul_f32 v175, v159, v175
v_mul_f32 v140, v140, v76
v_mul_f32 v141, v141, v77
v_mul_f32 v142, v142, v78
v_mul_f32 v143, v143, v79
v_mul_f32 v172, v172, v80
v_mul_f32 v173, v173, v81
v_mul_f32 v174, v174, v82
v_mul_f32 v175, v175, v83
buffer_load_dwordx4 v3, s[24:27], s37 offen offset:1024 sc1 lds
v_cvt_pk_bf16_f32 v124, v140, v141
v_cvt_pk_bf16_f32 v125, v142, v143
v_cvt_pk_bf16_f32 v156, v172, v173
v_cvt_pk_bf16_f32 v157, v174, v175
v_fma_f32 v128, -v60, v32, v128
v_fma_f32 v129, -v60, v33, v129
v_fma_f32 v130, -v60, v34, v130
v_fma_f32 v131, -v60, v35, v131
v_fma_f32 v160, -v62, v32, v160
v_fma_f32 v161, -v62, v33, v161
buffer_load_dwordx4 v3, s[24:27], s37 offen offset:2048 sc1 lds
v_fma_f32 v162, -v62, v34, v162
v_fma_f32 v163, -v62, v35, v163
v_mul_f32 v76, v128, v128
v_mul_f32 v77, v129, v129
v_mul_f32 v78, v130, v130
v_mul_f32 v79, v131, v131
v_mul_f32 v80, v160, v160
v_mul_f32 v81, v161, v161
v_mul_f32 v82, v162, v162
v_mul_f32 v83, v163, v163
buffer_load_dwordx4 v3, s[24:27], s37 offen offset:3072 sc1 lds
v_fma_f32 v76, v76, v69, v68
v_fma_f32 v77, v77, v69, v68
v_fma_f32 v78, v78, v69, v68
v_fma_f32 v79, v79, v69, v68
v_fma_f32 v80, v80, v73, v72
v_fma_f32 v81, v81, v73, v72
v_fma_f32 v82, v82, v73, v72
v_fma_f32 v83, v83, v73, v72
v_mul_f32 v76, v76, v128
v_mul_f32 v77, v77, v129
s_add_u32 m0, s39, 114688
s_add_u32 s38, s53, 4849664
buffer_load_dwordx4 v23, s[28:31], s38 offen lds
v_mul_f32 v78, v78, v130
v_mul_f32 v79, v79, v131
v_mul_f32 v80, v80, v160
v_mul_f32 v81, v81, v161
v_mul_f32 v82, v82, v162
v_mul_f32 v83, v83, v163
v_exp_f32 v76, v76
v_exp_f32 v77, v77
v_exp_f32 v78, v78
v_exp_f32 v79, v79
s_add_u32 m0, s39, 115712
s_add_u32 s38, s53, 4849664
buffer_load_dwordx4 v24, s[28:31], s38 offen lds
v_exp_f32 v80, v80
v_exp_f32 v81, v81
v_exp_f32 v82, v82
v_exp_f32 v83, v83
v_fma_f32 v144, -v60, v48, v144
v_fma_f32 v145, -v60, v49, v145
v_fma_f32 v146, -v60, v50, v146
v_fma_f32 v147, -v60, v51, v147
v_fma_f32 v176, -v62, v48, v176
v_fma_f32 v177, -v62, v49, v177
s_add_u32 m0, s39, 116736
s_add_u32 s38, s53, 4866048
buffer_load_dwordx4 v23, s[28:31], s38 offen lds
s_add_u32 m0, s39, 117760
s_add_u32 s38, s53, 4866048
buffer_load_dwordx4 v24, s[28:31], s38 offen lds
s_barrier
s_add_u32 m0, s39, 131072
s_add_u32 s37, s52, 622592
buffer_load_dwordx4 v3, s[24:27], s37 offen sc1 lds
v_fma_f32 v178, -v62, v50, v178
v_fma_f32 v179, -v62, v51, v179
v_fma_f32 v76, v76, v70, v70
v_fma_f32 v77, v77, v70, v70
v_fma_f32 v78, v78, v70, v70
v_fma_f32 v79, v79, v70, v70
v_fma_f32 v80, v80, v74, v74
v_fma_f32 v81, v81, v74, v74
v_fma_f32 v82, v82, v74, v74
v_fma_f32 v83, v83, v74, v74
v_rcp_f32 v76, v76
v_rcp_f32 v77, v77
v_rcp_f32 v78, v78
v_rcp_f32 v79, v79
v_rcp_f32 v80, v80
v_rcp_f32 v81, v81
v_rcp_f32 v82, v82
v_rcp_f32 v83, v83
v_mul_f32 v144, v128, v144
v_mul_f32 v145, v129, v145
v_mul_f32 v146, v130, v146
v_mul_f32 v147, v131, v147
v_mul_f32 v176, v160, v176
buffer_load_dwordx4 v3, s[24:27], s37 offen offset:1024 sc1 lds
v_mul_f32 v177, v161, v177
v_mul_f32 v178, v162, v178
v_mul_f32 v179, v163, v179
v_mul_f32 v144, v144, v76
v_mul_f32 v145, v145, v77
v_mul_f32 v146, v146, v78
v_mul_f32 v147, v147, v79
v_mul_f32 v176, v176, v80
v_mul_f32 v177, v177, v81
v_mul_f32 v178, v178, v82
v_mul_f32 v179, v179, v83
v_cvt_pk_bf16_f32 v126, v144, v145
v_cvt_pk_bf16_f32 v127, v146, v147
v_cvt_pk_bf16_f32 v158, v176, v177
v_cvt_pk_bf16_f32 v159, v178, v179
buffer_store_dwordx4 v[124:127], v2, s[24:27], s54 offen offset:0 sc1
buffer_store_dwordx4 v[156:159], v2, s[24:27], s54 offen offset:1024 sc1
v_fma_f32 v132, -v60, v36, v132
v_fma_f32 v133, -v60, v37, v133
v_fma_f32 v134, -v60, v38, v134
v_fma_f32 v135, -v60, v39, v135
v_fma_f32 v164, -v62, v36, v164
v_fma_f32 v165, -v62, v37, v165
buffer_load_dwordx4 v3, s[24:27], s37 offen offset:2048 sc1 lds
v_fma_f32 v166, -v62, v38, v166
v_fma_f32 v167, -v62, v39, v167
v_mul_f32 v76, v132, v132
v_mul_f32 v77, v133, v133
v_mul_f32 v78, v134, v134
v_mul_f32 v79, v135, v135
v_mul_f32 v80, v164, v164
v_mul_f32 v81, v165, v165
v_mul_f32 v82, v166, v166
v_mul_f32 v83, v167, v167
v_fma_f32 v76, v76, v69, v68
v_fma_f32 v77, v77, v69, v68
v_fma_f32 v78, v78, v69, v68
v_fma_f32 v79, v79, v69, v68
v_fma_f32 v80, v80, v73, v72
v_fma_f32 v81, v81, v73, v72
v_fma_f32 v82, v82, v73, v72
v_fma_f32 v83, v83, v73, v72
v_mul_f32 v76, v76, v132
v_mul_f32 v77, v77, v133
v_mul_f32 v78, v78, v134
v_mul_f32 v79, v79, v135
v_mul_f32 v80, v80, v164
v_mul_f32 v81, v81, v165
buffer_load_dwordx4 v3, s[24:27], s37 offen offset:3072 sc1 lds
v_mul_f32 v82, v82, v166
v_mul_f32 v83, v83, v167
v_exp_f32 v76, v76
v_exp_f32 v77, v77
v_exp_f32 v78, v78
v_exp_f32 v79, v79
v_exp_f32 v80, v80
v_exp_f32 v81, v81
v_exp_f32 v82, v82
v_exp_f32 v83, v83
v_fma_f32 v148, -v60, v52, v148
v_fma_f32 v149, -v60, v53, v149
v_fma_f32 v150, -v60, v54, v150
v_fma_f32 v151, -v60, v55, v151
v_fma_f32 v180, -v62, v52, v180
v_fma_f32 v181, -v62, v53, v181
v_fma_f32 v182, -v62, v54, v182
v_fma_f32 v183, -v62, v55, v183
v_fma_f32 v76, v76, v70, v70
v_fma_f32 v77, v77, v70, v70
v_fma_f32 v78, v78, v70, v70
v_fma_f32 v79, v79, v70, v70
v_fma_f32 v80, v80, v74, v74
s_add_u32 m0, s39, 0
s_add_u32 s38, s53, 4980736
buffer_load_dwordx4 v23, s[28:31], s38 offen lds
v_fma_f32 v81, v81, v74, v74
v_fma_f32 v82, v82, v74, v74
v_fma_f32 v83, v83, v74, v74
v_rcp_f32 v76, v76
v_rcp_f32 v77, v77
v_rcp_f32 v78, v78
v_rcp_f32 v79, v79
v_rcp_f32 v80, v80
v_rcp_f32 v81, v81
v_rcp_f32 v82, v82
v_rcp_f32 v83, v83
v_mul_f32 v148, v132, v148
v_mul_f32 v149, v133, v149
v_mul_f32 v150, v134, v150
v_mul_f32 v151, v135, v151
v_mul_f32 v180, v164, v180
v_mul_f32 v181, v165, v181
v_mul_f32 v182, v166, v182
v_mul_f32 v183, v167, v183
v_mul_f32 v148, v148, v76
v_mul_f32 v149, v149, v77
v_mul_f32 v150, v150, v78
v_mul_f32 v151, v151, v79
s_add_u32 m0, s39, 1024
s_add_u32 s38, s53, 4980736
buffer_load_dwordx4 v24, s[28:31], s38 offen lds
v_mul_f32 v180, v180, v80
v_mul_f32 v181, v181, v81
v_mul_f32 v182, v182, v82
v_mul_f32 v183, v183, v83
v_cvt_pk_bf16_f32 v132, v148, v149
v_cvt_pk_bf16_f32 v133, v150, v151
v_cvt_pk_bf16_f32 v164, v180, v181
v_cvt_pk_bf16_f32 v165, v182, v183
v_fma_f32 v136, -v60, v40, v136
v_fma_f32 v137, -v60, v41, v137
v_fma_f32 v138, -v60, v42, v138
v_fma_f32 v139, -v60, v43, v139
v_fma_f32 v168, -v62, v40, v168
v_fma_f32 v169, -v62, v41, v169
v_fma_f32 v170, -v62, v42, v170
v_fma_f32 v171, -v62, v43, v171
v_mul_f32 v76, v136, v136
v_mul_f32 v77, v137, v137
v_mul_f32 v78, v138, v138
v_mul_f32 v79, v139, v139
v_mul_f32 v80, v168, v168
v_mul_f32 v81, v169, v169
v_mul_f32 v82, v170, v170
v_mul_f32 v83, v171, v171
s_add_u32 m0, s39, 2048
s_add_u32 s38, s53, 4997120
buffer_load_dwordx4 v23, s[28:31], s38 offen lds
s_add_u32 m0, s39, 3072
s_add_u32 s38, s53, 4997120
buffer_load_dwordx4 v24, s[28:31], s38 offen lds
s_barrier
s_add_u32 m0, s39, 16384
s_add_u32 s37, s52, 638976
buffer_load_dwordx4 v3, s[24:27], s37 offen sc1 lds
v_fma_f32 v76, v76, v69, v68
v_fma_f32 v77, v77, v69, v68
v_fma_f32 v78, v78, v69, v68
v_fma_f32 v79, v79, v69, v68
v_fma_f32 v80, v80, v73, v72
v_fma_f32 v81, v81, v73, v72
v_fma_f32 v82, v82, v73, v72
v_fma_f32 v83, v83, v73, v72
v_mul_f32 v76, v76, v136
v_mul_f32 v77, v77, v137
v_mul_f32 v78, v78, v138
v_mul_f32 v79, v79, v139
v_mul_f32 v80, v80, v168
v_mul_f32 v81, v81, v169
v_mul_f32 v82, v82, v170
v_mul_f32 v83, v83, v171
v_exp_f32 v76, v76
v_exp_f32 v77, v77
v_exp_f32 v78, v78
v_exp_f32 v79, v79
v_exp_f32 v80, v80
v_exp_f32 v81, v81
v_exp_f32 v82, v82
buffer_load_dwordx4 v3, s[24:27], s37 offen offset:1024 sc1 lds
v_exp_f32 v83, v83
v_fma_f32 v152, -v60, v56, v152
v_fma_f32 v153, -v60, v57, v153
v_fma_f32 v154, -v60, v58, v154
v_fma_f32 v155, -v60, v59, v155
v_fma_f32 v184, -v62, v56, v184
v_fma_f32 v185, -v62, v57, v185
v_fma_f32 v186, -v62, v58, v186
v_fma_f32 v187, -v62, v59, v187
v_fma_f32 v76, v76, v70, v70
s_branch Lov_17
.p2align 12
.fill 128, 4, 0xbf800000
Lst_17_0:
s_branch Lwr_192
s_nop 0
s_nop 0
Lov_17:
v_fma_f32 v77, v77, v70, v70
v_fma_f32 v78, v78, v70, v70
v_fma_f32 v79, v79, v70, v70
v_fma_f32 v80, v80, v74, v74
v_fma_f32 v81, v81, v74, v74
v_fma_f32 v82, v82, v74, v74
v_fma_f32 v83, v83, v74, v74
v_rcp_f32 v76, v76
v_rcp_f32 v77, v77
v_rcp_f32 v78, v78
v_rcp_f32 v79, v79
v_rcp_f32 v80, v80
v_rcp_f32 v81, v81
buffer_load_dwordx4 v3, s[24:27], s37 offen offset:2048 sc1 lds
v_rcp_f32 v82, v82
v_rcp_f32 v83, v83
v_mul_f32 v152, v136, v152
v_mul_f32 v153, v137, v153
v_mul_f32 v154, v138, v154
v_mul_f32 v155, v139, v155
v_mul_f32 v184, v168, v184
v_mul_f32 v185, v169, v185
v_mul_f32 v186, v170, v186
v_mul_f32 v187, v171, v187
v_mul_f32 v152, v152, v76
v_mul_f32 v153, v153, v77
v_mul_f32 v154, v154, v78
v_mul_f32 v155, v155, v79
v_mul_f32 v184, v184, v80
v_mul_f32 v185, v185, v81
v_mul_f32 v186, v186, v82
v_mul_f32 v187, v187, v83
v_cvt_pk_bf16_f32 v134, v152, v153
v_cvt_pk_bf16_f32 v135, v154, v155
v_cvt_pk_bf16_f32 v166, v184, v185
v_cvt_pk_bf16_f32 v167, v186, v187
buffer_store_dwordx4 v[132:135], v2, s[24:27], s55 offen offset:0 sc1
buffer_store_dwordx4 v[164:167], v2, s[24:27], s55 offen offset:1024 sc1
buffer_load_dwordx4 v3, s[24:27], s37 offen offset:3072 sc1 lds
v_mul_f32 v70, v65, v65
v_mul_f32 v68, 0xc0135761, v65
v_mul_f32 v69, 0xbdd2d3e8, v65
v_mul_f32 v69, v69, v70
v_rcp_f32 v70, v70
v_mul_f32 v74, v67, v67
v_mul_f32 v72, 0xc0135761, v67
v_mul_f32 v73, 0xbdd2d3e8, v67
v_mul_f32 v73, v73, v74
v_rcp_f32 v74, v74
v_fma_f32 v188, -v64, v28, v188
v_fma_f32 v189, -v64, v29, v189
v_fma_f32 v190, -v64, v30, v190
v_fma_f32 v191, -v64, v31, v191
v_fma_f32 v220, -v66, v28, v220
v_fma_f32 v221, -v66, v29, v221
v_fma_f32 v222, -v66, v30, v222
v_fma_f32 v223, -v66, v31, v223
v_mul_f32 v76, v188, v188
v_mul_f32 v77, v189, v189
v_mul_f32 v78, v190, v190
v_mul_f32 v79, v191, v191
v_mul_f32 v80, v220, v220
s_add_u32 m0, s39, 32768
s_add_u32 s38, s53, 5111808
buffer_load_dwordx4 v23, s[28:31], s38 offen lds
v_mul_f32 v81, v221, v221
v_mul_f32 v82, v222, v222
v_mul_f32 v83, v223, v223
v_fma_f32 v76, v76, v69, v68
v_fma_f32 v77, v77, v69, v68
v_fma_f32 v78, v78, v69, v68
v_fma_f32 v79, v79, v69, v68
v_fma_f32 v80, v80, v73, v72
v_fma_f32 v81, v81, v73, v72
v_fma_f32 v82, v82, v73, v72
v_fma_f32 v83, v83, v73, v72
v_mul_f32 v76, v76, v188
v_mul_f32 v77, v77, v189
v_mul_f32 v78, v78, v190
v_mul_f32 v79, v79, v191
v_mul_f32 v80, v80, v220
v_mul_f32 v81, v81, v221
v_mul_f32 v82, v82, v222
v_mul_f32 v83, v83, v223
v_exp_f32 v76, v76
v_exp_f32 v77, v77
v_exp_f32 v78, v78
v_exp_f32 v79, v79
s_add_u32 m0, s39, 33792
s_add_u32 s38, s53, 5111808
buffer_load_dwordx4 v24, s[28:31], s38 offen lds
v_exp_f32 v80, v80
v_exp_f32 v81, v81
v_exp_f32 v82, v82
v_exp_f32 v83, v83
v_fma_f32 v204, -v64, v44, v204
v_fma_f32 v205, -v64, v45, v205
v_fma_f32 v206, -v64, v46, v206
v_fma_f32 v207, -v64, v47, v207
v_fma_f32 v236, -v66, v44, v236
v_fma_f32 v237, -v66, v45, v237
v_fma_f32 v238, -v66, v46, v238
v_fma_f32 v239, -v66, v47, v239
v_fma_f32 v76, v76, v70, v70
v_fma_f32 v77, v77, v70, v70
v_fma_f32 v78, v78, v70, v70
v_fma_f32 v79, v79, v70, v70
v_fma_f32 v80, v80, v74, v74
v_fma_f32 v81, v81, v74, v74
v_fma_f32 v82, v82, v74, v74
v_fma_f32 v83, v83, v74, v74
v_rcp_f32 v76, v76
v_rcp_f32 v77, v77
v_rcp_f32 v78, v78
v_rcp_f32 v79, v79
s_add_u32 m0, s39, 34816
s_add_u32 s38, s53, 5128192
buffer_load_dwordx4 v23, s[28:31], s38 offen lds
s_add_u32 m0, s39, 35840
s_add_u32 s38, s53, 5128192
buffer_load_dwordx4 v24, s[28:31], s38 offen lds
s_waitcnt vmcnt(28)
s_barrier
s_add_u32 m0, s39, 49152
s_add_u32 s37, s52, 655360
buffer_load_dwordx4 v3, s[24:27], s37 offen sc1 lds
v_rcp_f32 v80, v80
v_rcp_f32 v81, v81
v_rcp_f32 v82, v82
v_rcp_f32 v83, v83
v_mul_f32 v204, v188, v204
v_mul_f32 v205, v189, v205
v_mul_f32 v206, v190, v206
v_mul_f32 v207, v191, v207
v_mul_f32 v236, v220, v236
v_mul_f32 v237, v221, v237
v_mul_f32 v238, v222, v238
v_mul_f32 v239, v223, v239
v_mul_f32 v204, v204, v76
v_mul_f32 v205, v205, v77
v_mul_f32 v206, v206, v78
v_mul_f32 v207, v207, v79
v_mul_f32 v236, v236, v80
v_mul_f32 v237, v237, v81
v_mul_f32 v238, v238, v82
v_mul_f32 v239, v239, v83
v_cvt_pk_bf16_f32 v188, v204, v205
v_cvt_pk_bf16_f32 v189, v206, v207
v_cvt_pk_bf16_f32 v220, v236, v237
buffer_load_dwordx4 v3, s[24:27], s37 offen offset:1024 sc1 lds
v_cvt_pk_bf16_f32 v221, v238, v239
v_fma_f32 v192, -v64, v32, v192
v_fma_f32 v193, -v64, v33, v193
v_fma_f32 v194, -v64, v34, v194
v_fma_f32 v195, -v64, v35, v195
v_fma_f32 v224, -v66, v32, v224
v_fma_f32 v225, -v66, v33, v225
v_fma_f32 v226, -v66, v34, v226
v_fma_f32 v227, -v66, v35, v227
v_mul_f32 v76, v192, v192
v_mul_f32 v77, v193, v193
v_mul_f32 v78, v194, v194
v_mul_f32 v79, v195, v195
v_mul_f32 v80, v224, v224
v_mul_f32 v81, v225, v225
v_mul_f32 v82, v226, v226
v_mul_f32 v83, v227, v227
v_fma_f32 v76, v76, v69, v68
v_fma_f32 v77, v77, v69, v68
v_fma_f32 v78, v78, v69, v68
v_fma_f32 v79, v79, v69, v68
v_fma_f32 v80, v80, v73, v72
v_fma_f32 v81, v81, v73, v72
buffer_load_dwordx4 v3, s[24:27], s37 offen offset:2048 sc1 lds
v_fma_f32 v82, v82, v73, v72
v_fma_f32 v83, v83, v73, v72
v_mul_f32 v76, v76, v192
v_mul_f32 v77, v77, v193
v_mul_f32 v78, v78, v194
v_mul_f32 v79, v79, v195
v_mul_f32 v80, v80, v224
v_mul_f32 v81, v81, v225
v_mul_f32 v82, v82, v226
v_mul_f32 v83, v83, v227
v_exp_f32 v76, v76
v_exp_f32 v77, v77
v_exp_f32 v78, v78
v_exp_f32 v79, v79
v_exp_f32 v80, v80
v_exp_f32 v81, v81
v_exp_f32 v82, v82
v_exp_f32 v83, v83
v_fma_f32 v208, -v64, v48, v208
v_fma_f32 v209, -v64, v49, v209
v_fma_f32 v210, -v64, v50, v210
v_fma_f32 v211, -v64, v51, v211
v_fma_f32 v240, -v66, v48, v240
v_fma_f32 v241, -v66, v49, v241
buffer_load_dwordx4 v3, s[24:27], s37 offen offset:3072 sc1 lds
v_fma_f32 v242, -v66, v50, v242
v_fma_f32 v243, -v66, v51, v243
v_fma_f32 v76, v76, v70, v70
v_fma_f32 v77, v77, v70, v70
v_fma_f32 v78, v78, v70, v70
v_fma_f32 v79, v79, v70, v70
v_fma_f32 v80, v80, v74, v74
v_fma_f32 v81, v81, v74, v74
v_fma_f32 v82, v82, v74, v74
v_fma_f32 v83, v83, v74, v74
v_rcp_f32 v76, v76
v_rcp_f32 v77, v77
v_rcp_f32 v78, v78
v_rcp_f32 v79, v79
v_rcp_f32 v80, v80
v_rcp_f32 v81, v81
v_rcp_f32 v82, v82
v_rcp_f32 v83, v83
v_mul_f32 v208, v192, v208
v_mul_f32 v209, v193, v209
v_mul_f32 v210, v194, v210
v_mul_f32 v211, v195, v211
v_mul_f32 v240, v224, v240
s_add_u32 m0, s39, 65536
s_add_u32 s38, s53, 5242880
buffer_load_dwordx4 v23, s[28:31], s38 offen lds
v_mul_f32 v241, v225, v241
v_mul_f32 v242, v226, v242
v_mul_f32 v243, v227, v243
v_mul_f32 v208, v208, v76
v_mul_f32 v209, v209, v77
v_mul_f32 v210, v210, v78
v_mul_f32 v211, v211, v79
v_mul_f32 v240, v240, v80
v_mul_f32 v241, v241, v81
v_mul_f32 v242, v242, v82
v_mul_f32 v243, v243, v83
v_cvt_pk_bf16_f32 v190, v208, v209
v_cvt_pk_bf16_f32 v191, v210, v211
v_cvt_pk_bf16_f32 v222, v240, v241
v_cvt_pk_bf16_f32 v223, v242, v243
buffer_store_dwordx4 v[188:191], v2, s[24:27], s54 offen offset:2048 sc1
buffer_store_dwordx4 v[220:223], v2, s[24:27], s54 offen offset:3072 sc1
v_fma_f32 v196, -v64, v36, v196
v_fma_f32 v197, -v64, v37, v197
v_fma_f32 v198, -v64, v38, v198
v_fma_f32 v199, -v64, v39, v199
v_fma_f32 v228, -v66, v36, v228
v_fma_f32 v229, -v66, v37, v229
s_add_u32 m0, s39, 66560
s_add_u32 s38, s53, 5242880
buffer_load_dwordx4 v24, s[28:31], s38 offen lds
v_fma_f32 v230, -v66, v38, v230
v_fma_f32 v231, -v66, v39, v231
v_mul_f32 v76, v196, v196
v_mul_f32 v77, v197, v197
v_mul_f32 v78, v198, v198
v_mul_f32 v79, v199, v199
v_mul_f32 v80, v228, v228
v_mul_f32 v81, v229, v229
v_mul_f32 v82, v230, v230
v_mul_f32 v83, v231, v231
v_fma_f32 v76, v76, v69, v68
v_fma_f32 v77, v77, v69, v68
v_fma_f32 v78, v78, v69, v68
v_fma_f32 v79, v79, v69, v68
v_fma_f32 v80, v80, v73, v72
v_fma_f32 v81, v81, v73, v72
v_fma_f32 v82, v82, v73, v72
v_fma_f32 v83, v83, v73, v72
v_mul_f32 v76, v76, v196
v_mul_f32 v77, v77, v197
v_mul_f32 v78, v78, v198
v_mul_f32 v79, v79, v199
v_mul_f32 v80, v80, v228
v_mul_f32 v81, v81, v229
s_add_u32 m0, s39, 67584
s_add_u32 s38, s53, 5259264
buffer_load_dwordx4 v23, s[28:31], s38 offen lds
s_add_u32 m0, s39, 68608
s_add_u32 s38, s53, 5259264
buffer_load_dwordx4 v24, s[28:31], s38 offen lds
s_waitcnt vmcnt(30)
s_barrier
s_add_u32 m0, s39, 81920
s_add_u32 s37, s52, 671744
buffer_load_dwordx4 v3, s[24:27], s37 offen sc1 lds
v_mul_f32 v82, v82, v230
v_mul_f32 v83, v83, v231
v_exp_f32 v76, v76
v_exp_f32 v77, v77
v_exp_f32 v78, v78
v_exp_f32 v79, v79
v_exp_f32 v80, v80
v_exp_f32 v81, v81
v_exp_f32 v82, v82
v_exp_f32 v83, v83
v_fma_f32 v212, -v64, v52, v212
v_fma_f32 v213, -v64, v53, v213
v_fma_f32 v214, -v64, v54, v214
v_fma_f32 v215, -v64, v55, v215
v_fma_f32 v244, -v66, v52, v244
v_fma_f32 v245, -v66, v53, v245
v_fma_f32 v246, -v66, v54, v246
v_fma_f32 v247, -v66, v55, v247
v_fma_f32 v76, v76, v70, v70
v_fma_f32 v77, v77, v70, v70
v_fma_f32 v78, v78, v70, v70
v_fma_f32 v79, v79, v70, v70
v_fma_f32 v80, v80, v74, v74
buffer_load_dwordx4 v3, s[24:27], s37 offen offset:1024 sc1 lds
v_fma_f32 v81, v81, v74, v74
v_fma_f32 v82, v82, v74, v74
v_fma_f32 v83, v83, v74, v74
v_rcp_f32 v76, v76
v_rcp_f32 v77, v77
v_rcp_f32 v78, v78
v_rcp_f32 v79, v79
v_rcp_f32 v80, v80
v_rcp_f32 v81, v81
v_rcp_f32 v82, v82
v_rcp_f32 v83, v83
v_mul_f32 v212, v196, v212
v_mul_f32 v213, v197, v213
v_mul_f32 v214, v198, v214
v_mul_f32 v215, v199, v215
v_mul_f32 v244, v228, v244
v_mul_f32 v245, v229, v245
v_mul_f32 v246, v230, v246
v_mul_f32 v247, v231, v247
v_mul_f32 v212, v212, v76
v_mul_f32 v213, v213, v77
v_mul_f32 v214, v214, v78
v_mul_f32 v215, v215, v79
buffer_load_dwordx4 v3, s[24:27], s37 offen offset:2048 sc1 lds
v_mul_f32 v244, v244, v80
v_mul_f32 v245, v245, v81
v_mul_f32 v246, v246, v82
v_mul_f32 v247, v247, v83
v_cvt_pk_bf16_f32 v196, v212, v213
v_cvt_pk_bf16_f32 v197, v214, v215
v_cvt_pk_bf16_f32 v228, v244, v245
v_cvt_pk_bf16_f32 v229, v246, v247
v_fma_f32 v200, -v64, v40, v200
v_fma_f32 v201, -v64, v41, v201
v_fma_f32 v202, -v64, v42, v202
v_fma_f32 v203, -v64, v43, v203
v_fma_f32 v232, -v66, v40, v232
v_fma_f32 v233, -v66, v41, v233
v_fma_f32 v234, -v66, v42, v234
v_fma_f32 v235, -v66, v43, v235
v_mul_f32 v76, v200, v200
v_mul_f32 v77, v201, v201
v_mul_f32 v78, v202, v202
v_mul_f32 v79, v203, v203
v_mul_f32 v80, v232, v232
v_mul_f32 v81, v233, v233
v_mul_f32 v82, v234, v234
v_mul_f32 v83, v235, v235
buffer_load_dwordx4 v3, s[24:27], s37 offen offset:3072 sc1 lds
v_fma_f32 v76, v76, v69, v68
v_fma_f32 v77, v77, v69, v68
v_fma_f32 v78, v78, v69, v68
v_fma_f32 v79, v79, v69, v68
v_fma_f32 v80, v80, v73, v72
v_fma_f32 v81, v81, v73, v72
v_fma_f32 v82, v82, v73, v72
v_fma_f32 v83, v83, v73, v72
v_mul_f32 v76, v76, v200
v_mul_f32 v77, v77, v201
v_mul_f32 v78, v78, v202
v_mul_f32 v79, v79, v203
v_mul_f32 v80, v80, v232
v_mul_f32 v81, v81, v233
v_mul_f32 v82, v82, v234
v_mul_f32 v83, v83, v235
v_exp_f32 v76, v76
v_exp_f32 v77, v77
v_exp_f32 v78, v78
v_exp_f32 v79, v79
v_exp_f32 v80, v80
v_exp_f32 v81, v81
v_exp_f32 v82, v82
s_add_u32 m0, s39, 147456
s_add_u32 s38, s53, 5373952
buffer_load_dwordx4 v23, s[28:31], s38 offen lds
v_exp_f32 v83, v83
v_fma_f32 v216, -v64, v56, v216
v_fma_f32 v217, -v64, v57, v217
v_fma_f32 v218, -v64, v58, v218
v_fma_f32 v219, -v64, v59, v219
v_fma_f32 v248, -v66, v56, v248
v_fma_f32 v249, -v66, v57, v249
v_fma_f32 v250, -v66, v58, v250
v_fma_f32 v251, -v66, v59, v251
v_fma_f32 v76, v76, v70, v70
v_fma_f32 v77, v77, v70, v70
v_fma_f32 v78, v78, v70, v70
v_fma_f32 v79, v79, v70, v70
v_fma_f32 v80, v80, v74, v74
v_fma_f32 v81, v81, v74, v74
v_fma_f32 v82, v82, v74, v74
v_fma_f32 v83, v83, v74, v74
v_rcp_f32 v76, v76
v_rcp_f32 v77, v77
v_rcp_f32 v78, v78
v_rcp_f32 v79, v79
v_rcp_f32 v80, v80
v_rcp_f32 v81, v81
s_add_u32 m0, s39, 148480
s_add_u32 s38, s53, 5373952
buffer_load_dwordx4 v24, s[28:31], s38 offen lds
v_rcp_f32 v82, v82
v_rcp_f32 v83, v83
v_mul_f32 v216, v200, v216
v_mul_f32 v217, v201, v217
v_mul_f32 v218, v202, v218
v_mul_f32 v219, v203, v219
v_mul_f32 v248, v232, v248
v_mul_f32 v249, v233, v249
v_mul_f32 v250, v234, v250
v_mul_f32 v251, v235, v251
v_mul_f32 v216, v216, v76
v_mul_f32 v217, v217, v77
v_mul_f32 v218, v218, v78
v_mul_f32 v219, v219, v79
v_mul_f32 v248, v248, v80
v_mul_f32 v249, v249, v81
v_mul_f32 v250, v250, v82
v_mul_f32 v251, v251, v83
v_cvt_pk_bf16_f32 v198, v216, v217
v_cvt_pk_bf16_f32 v199, v218, v219
v_cvt_pk_bf16_f32 v230, v248, v249
v_cvt_pk_bf16_f32 v231, v250, v251
buffer_store_dwordx4 v[196:199], v2, s[24:27], s55 offen offset:2048 sc1
buffer_store_dwordx4 v[228:231], v2, s[24:27], s55 offen offset:3072 sc1
s_add_u32 m0, s39, 149504
s_add_u32 s38, s53, 5390336
buffer_load_dwordx4 v23, s[28:31], s38 offen lds
s_add_u32 m0, s39, 150528
s_add_u32 s38, s53, 5390336
buffer_load_dwordx4 v24, s[28:31], s38 offen lds
s_waitcnt vmcnt(30)
s_barrier
s_add_u32 m0, s39, 98304
s_add_u32 s37, s52, 688128
buffer_load_dwordx4 v3, s[24:27], s37 offen sc1 lds
buffer_load_dwordx4 v3, s[24:27], s37 offen offset:1024 sc1 lds
buffer_load_dwordx4 v3, s[24:27], s37 offen offset:2048 sc1 lds
buffer_load_dwordx4 v3, s[24:27], s37 offen offset:3072 sc1 lds
s_add_u32 m0, s39, 114688
s_add_u32 s38, s53, 5505024
buffer_load_dwordx4 v23, s[28:31], s38 offen lds
s_add_u32 m0, s39, 115712
s_add_u32 s38, s53, 5505024
buffer_load_dwordx4 v24, s[28:31], s38 offen lds
s_add_u32 m0, s39, 116736
s_add_u32 s38, s53, 5521408
buffer_load_dwordx4 v23, s[28:31], s38 offen lds
s_add_u32 m0, s39, 117760
s_add_u32 s38, s53, 5521408
buffer_load_dwordx4 v24, s[28:31], s38 offen lds
s_waitcnt vmcnt(10)
s_barrier
s_cmp_eq_u32 s47, 0
s_cbranch_scc0 Lw_155
s_add_u32 s7, s34, 48
s_lshl_b32 s7, s7, 7
v_mov_b32 v26, s7
v_mov_b32 v27, 1
s_mov_b64 exec, 1
buffer_atomic_add v27, v26, s[56:59], 0 offen sc1
s_mov_b64 exec, -1
Lw_155:
s_add_u32 m0, s39, 131072
s_add_u32 s37, s52, 704512
buffer_load_dwordx4 v3, s[24:27], s37 offen sc1 lds
buffer_load_dwordx4 v3, s[24:27], s37 offen offset:1024 sc1 lds
buffer_load_dwordx4 v3, s[24:27], s37 offen offset:2048 sc1 lds
buffer_load_dwordx4 v3, s[24:27], s37 offen offset:3072 sc1 lds
s_add_u32 m0, s39, 0
s_add_u32 s38, s53, 5636096
buffer_load_dwordx4 v23, s[28:31], s38 offen lds
s_add_u32 m0, s39, 1024
s_add_u32 s38, s53, 5636096
buffer_load_dwordx4 v24, s[28:31], s38 offen lds
s_add_u32 m0, s39, 2048
s_add_u32 s38, s53, 5652480
buffer_load_dwordx4 v23, s[28:31], s38 offen lds
s_add_u32 m0, s39, 3072
s_add_u32 s38, s53, 5652480
buffer_load_dwordx4 v24, s[28:31], s38 offen lds
s_waitcnt vmcnt(26)
s_barrier
s_add_u32 m0, s39, 32768
s_add_u32 s38, s91, 0
buffer_load_dwordx4 v23, s[28:31], s38 offen lds
s_add_u32 m0, s39, 33792
s_add_u32 s38, s91, 0
buffer_load_dwordx4 v24, s[28:31], s38 offen lds
s_add_u32 m0, s39, 34816
s_add_u32 s38, s91, 16384
buffer_load_dwordx4 v23, s[28:31], s38 offen lds
s_add_u32 m0, s39, 35840
s_add_u32 s38, s91, 16384
buffer_load_dwordx4 v24, s[28:31], s38 offen lds
s_waitcnt vmcnt(20)
s_barrier
s_add_u32 m0, s39, 65536
s_add_u32 s38, s91, 131072
buffer_load_dwordx4 v23, s[28:31], s38 offen lds
s_add_u32 m0, s39, 66560
s_add_u32 s38, s91, 131072
buffer_load_dwordx4 v24, s[28:31], s38 offen lds
s_add_u32 m0, s39, 67584
s_add_u32 s38, s91, 147456
buffer_load_dwordx4 v23, s[28:31], s38 offen lds
s_add_u32 m0, s39, 68608
s_add_u32 s38, s91, 147456
buffer_load_dwordx4 v24, s[28:31], s38 offen lds
s_waitcnt vmcnt(16)
s_barrier
s_cmp_eq_u32 s47, 3
s_cbranch_scc0 Lw_156
s_lshl_b32 s92, s34, 7
s_add_u32 s92, s92, 28317696
s_load_dword s93, s[82:83], s92 glc
Lw_156:
s_add_u32 m0, s39, 147456
s_add_u32 s38, s91, 262144
buffer_load_dwordx4 v23, s[28:31], s38 offen lds
s_add_u32 m0, s39, 148480
s_add_u32 s38, s91, 262144
buffer_load_dwordx4 v24, s[28:31], s38 offen lds
s_add_u32 m0, s39, 149504
s_add_u32 s38, s91, 278528
buffer_load_dwordx4 v23, s[28:31], s38 offen lds
s_add_u32 m0, s39, 150528
s_add_u32 s38, s91, 278528
buffer_load_dwordx4 v24, s[28:31], s38 offen lds
s_waitcnt vmcnt(12)
s_cmp_eq_u32 s47, 3
s_cbranch_scc0 Lw_157
s_mov_b32 s41, 0x40000
s_branch Lpchk_160
Lpoll_158:
s_load_dword s93, s[82:83], s92 glc
Lpchk_160:
s_waitcnt lgkmcnt(0)
s_cmp_eq_u32 s93, 16
s_cbranch_scc1 Lpok_159
s_sub_u32 s41, s41, 1
s_cmp_lg_u32 s41, 0
s_cbranch_scc1 Lpoll_158
Lpok_159:
Lw_157:
s_barrier
s_add_u32 m0, s39, 16384
s_add_u32 s37, s90, 0
buffer_load_dwordx4 v3, s[24:27], s37 offen sc1 lds
buffer_load_dwordx4 v3, s[24:27], s37 offen offset:1024 sc1 lds
buffer_load_dwordx4 v3, s[24:27], s37 offen offset:2048 sc1 lds
buffer_load_dwordx4 v3, s[24:27], s37 offen offset:3072 sc1 lds
s_add_u32 m0, s39, 49152
s_add_u32 s37, s90, 16384
buffer_load_dwordx4 v3, s[24:27], s37 offen sc1 lds
buffer_load_dwordx4 v3, s[24:27], s37 offen offset:1024 sc1 lds
buffer_load_dwordx4 v3, s[24:27], s37 offen offset:2048 sc1 lds
buffer_load_dwordx4 v3, s[24:27], s37 offen offset:3072 sc1 lds
s_add_u32 m0, s39, 81920
s_add_u32 s37, s90, 32768
buffer_load_dwordx4 v3, s[24:27], s37 offen sc1 lds
buffer_load_dwordx4 v3, s[24:27], s37 offen offset:1024 sc1 lds
buffer_load_dwordx4 v3, s[24:27], s37 offen offset:2048 sc1 lds
buffer_load_dwordx4 v3, s[24:27], s37 offen offset:3072 sc1 lds
s_add_u32 m0, s39, 98304
s_add_u32 s37, s90, 49152
buffer_load_dwordx4 v3, s[24:27], s37 offen sc1 lds
buffer_load_dwordx4 v3, s[24:27], s37 offen offset:1024 sc1 lds
buffer_load_dwordx4 v3, s[24:27], s37 offen offset:2048 sc1 lds
buffer_load_dwordx4 v3, s[24:27], s37 offen offset:3072 sc1 lds
s_add_u32 m0, s39, 114688
s_add_u32 s38, s91, 393216
buffer_load_dwordx4 v23, s[28:31], s38 offen lds
s_branch Lov_18
.p2align 12
.fill 144, 4, 0xbf800000
Lst_18_0:
s_branch Lwr_193
s_nop 0
s_nop 0
Lov_18:
s_add_u32 m0, s39, 115712
s_add_u32 s38, s91, 393216
buffer_load_dwordx4 v24, s[28:31], s38 offen lds
s_add_u32 m0, s39, 116736
s_add_u32 s38, s91, 409600
buffer_load_dwordx4 v23, s[28:31], s38 offen lds
s_add_u32 m0, s39, 117760
s_add_u32 s38, s91, 409600
buffer_load_dwordx4 v24, s[28:31], s38 offen lds
s_waitcnt vmcnt(16)
s_barrier
s_add_u32 m0, s39, 131072
s_add_u32 s37, s90, 65536
buffer_load_dwordx4 v3, s[24:27], s37 offen sc1 lds
buffer_load_dwordx4 v3, s[24:27], s37 offen offset:1024 sc1 lds
buffer_load_dwordx4 v3, s[24:27], s37 offen offset:2048 sc1 lds
buffer_load_dwordx4 v3, s[24:27], s37 offen offset:3072 sc1 lds
s_add_u32 m0, s39, 0
s_add_u32 s38, s91, 524288
buffer_load_dwordx4 v23, s[28:31], s38 offen lds
s_add_u32 m0, s39, 1024
s_add_u32 s38, s91, 524288
buffer_load_dwordx4 v24, s[28:31], s38 offen lds
s_add_u32 m0, s39, 2048
s_add_u32 s38, s91, 540672
buffer_load_dwordx4 v23, s[28:31], s38 offen lds
s_add_u32 m0, s39, 3072
s_add_u32 s38, s91, 540672
buffer_load_dwordx4 v24, s[28:31], s38 offen lds
s_waitcnt vmcnt(20)
s_barrier
s_add_u32 m0, s39, 16384
s_add_u32 s37, s90, 81920
buffer_load_dwordx4 v3, s[24:27], s37 offen sc1 lds
buffer_load_dwordx4 v3, s[24:27], s37 offen offset:1024 sc1 lds
buffer_load_dwordx4 v3, s[24:27], s37 offen offset:2048 sc1 lds
buffer_load_dwordx4 v3, s[24:27], s37 offen offset:3072 sc1 lds
s_add_u32 m0, s39, 32768
s_add_u32 s38, s91, 655360
buffer_load_dwordx4 v23, s[28:31], s38 offen lds
s_add_u32 m0, s39, 33792
s_add_u32 s38, s91, 655360
buffer_load_dwordx4 v24, s[28:31], s38 offen lds
s_add_u32 m0, s39, 34816
s_add_u32 s38, s91, 671744
buffer_load_dwordx4 v23, s[28:31], s38 offen lds
s_add_u32 m0, s39, 35840
s_add_u32 s38, s91, 671744
buffer_load_dwordx4 v24, s[28:31], s38 offen lds
s_waitcnt vmcnt(24)
s_barrier
s_add_u32 m0, s39, 49152
s_add_u32 s37, s90, 98304
buffer_load_dwordx4 v3, s[24:27], s37 offen sc1 lds
buffer_load_dwordx4 v3, s[24:27], s37 offen offset:1024 sc1 lds
buffer_load_dwordx4 v3, s[24:27], s37 offen offset:2048 sc1 lds
buffer_load_dwordx4 v3, s[24:27], s37 offen offset:3072 sc1 lds
s_add_u32 m0, s39, 65536
s_add_u32 s38, s91, 786432
buffer_load_dwordx4 v23, s[28:31], s38 offen lds
s_add_u32 m0, s39, 66560
s_add_u32 s38, s91, 786432
buffer_load_dwordx4 v24, s[28:31], s38 offen lds
s_add_u32 m0, s39, 67584
s_add_u32 s38, s91, 802816
buffer_load_dwordx4 v23, s[28:31], s38 offen lds
s_add_u32 m0, s39, 68608
s_add_u32 s38, s91, 802816
buffer_load_dwordx4 v24, s[28:31], s38 offen lds
s_waitcnt vmcnt(24)
s_barrier
s_add_u32 m0, s39, 81920
s_add_u32 s37, s90, 114688
buffer_load_dwordx4 v3, s[24:27], s37 offen sc1 lds
buffer_load_dwordx4 v3, s[24:27], s37 offen offset:1024 sc1 lds
buffer_load_dwordx4 v3, s[24:27], s37 offen offset:2048 sc1 lds
buffer_load_dwordx4 v3, s[24:27], s37 offen offset:3072 sc1 lds
s_add_u32 m0, s39, 147456
s_add_u32 s38, s91, 917504
buffer_load_dwordx4 v23, s[28:31], s38 offen lds
s_add_u32 m0, s39, 148480
s_add_u32 s38, s91, 917504
buffer_load_dwordx4 v24, s[28:31], s38 offen lds
s_add_u32 m0, s39, 149504
s_add_u32 s38, s91, 933888
buffer_load_dwordx4 v23, s[28:31], s38 offen lds
s_add_u32 m0, s39, 150528
s_add_u32 s38, s91, 933888
buffer_load_dwordx4 v24, s[28:31], s38 offen lds
s_waitcnt vmcnt(24)
s_barrier
s_add_u32 m0, s39, 98304
s_add_u32 s37, s90, 131072
buffer_load_dwordx4 v3, s[24:27], s37 offen sc1 lds
buffer_load_dwordx4 v3, s[24:27], s37 offen offset:1024 sc1 lds
buffer_load_dwordx4 v3, s[24:27], s37 offen offset:2048 sc1 lds
buffer_load_dwordx4 v3, s[24:27], s37 offen offset:3072 sc1 lds
s_add_u32 m0, s39, 114688
s_add_u32 s38, s91, 1048576
buffer_load_dwordx4 v23, s[28:31], s38 offen lds
s_add_u32 m0, s39, 115712
s_add_u32 s38, s91, 1048576
buffer_load_dwordx4 v24, s[28:31], s38 offen lds
s_add_u32 m0, s39, 116736
s_add_u32 s38, s91, 1064960
buffer_load_dwordx4 v23, s[28:31], s38 offen lds
s_add_u32 m0, s39, 117760
s_add_u32 s38, s91, 1064960
buffer_load_dwordx4 v24, s[28:31], s38 offen lds
s_waitcnt vmcnt(24)
s_barrier
s_add_u32 m0, s39, 131072
s_add_u32 s37, s90, 147456
buffer_load_dwordx4 v3, s[24:27], s37 offen sc1 lds
buffer_load_dwordx4 v3, s[24:27], s37 offen offset:1024 sc1 lds
buffer_load_dwordx4 v3, s[24:27], s37 offen offset:2048 sc1 lds
buffer_load_dwordx4 v3, s[24:27], s37 offen offset:3072 sc1 lds
s_add_u32 m0, s39, 0
s_add_u32 s38, s91, 1179648
buffer_load_dwordx4 v23, s[28:31], s38 offen lds
s_add_u32 m0, s39, 1024
s_add_u32 s38, s91, 1179648
buffer_load_dwordx4 v24, s[28:31], s38 offen lds
s_add_u32 m0, s39, 2048
s_add_u32 s38, s91, 1196032
buffer_load_dwordx4 v23, s[28:31], s38 offen lds
s_add_u32 m0, s39, 3072
s_add_u32 s38, s91, 1196032
buffer_load_dwordx4 v24, s[28:31], s38 offen lds
s_waitcnt vmcnt(24)
s_barrier
s_add_u32 m0, s39, 16384
s_mov_b32 s37, 327680
buffer_load_dwordx4 v3, s[24:27], s37 offen sc1 lds
buffer_load_dwordx4 v3, s[24:27], s37 offen offset:1024 sc1 lds
buffer_load_dwordx4 v3, s[24:27], s37 offen offset:2048 sc1 lds
buffer_load_dwordx4 v3, s[24:27], s37 offen offset:3072 sc1 lds
s_add_u32 m0, s51, 32768
s_mov_b32 s38, 2621440
buffer_load_dwordx4 v25, s[28:31], s38 offen lds
s_add_u32 m0, s51, 33792
s_mov_b32 s38, 2637824
buffer_load_dwordx4 v25, s[28:31], s38 offen lds
s_waitcnt vmcnt(22)
s_barrier
s_add_u32 m0, s39, 49152
s_mov_b32 s37, 344064
buffer_load_dwordx4 v3, s[24:27], s37 offen sc1 lds
buffer_load_dwordx4 v3, s[24:27], s37 offen offset:1024 sc1 lds
buffer_load_dwordx4 v3, s[24:27], s37 offen offset:2048 sc1 lds
buffer_load_dwordx4 v3, s[24:27], s37 offen offset:3072 sc1 lds
s_add_u32 m0, s51, 65536
s_mov_b32 s38, 2752512
buffer_load_dwordx4 v25, s[28:31], s38 offen lds
s_add_u32 m0, s51, 66560
s_mov_b32 s38, 2768896
buffer_load_dwordx4 v25, s[28:31], s38 offen lds
s_waitcnt vmcnt(20)
s_barrier
s_add_u32 m0, s39, 81920
s_mov_b32 s37, 360448
buffer_load_dwordx4 v3, s[24:27], s37 offen sc1 lds
buffer_load_dwordx4 v3, s[24:27], s37 offen offset:1024 sc1 lds
buffer_load_dwordx4 v3, s[24:27], s37 offen offset:2048 sc1 lds
buffer_load_dwordx4 v3, s[24:27], s37 offen offset:3072 sc1 lds
s_add_u32 m0, s51, 147456
s_mov_b32 s38, 2883584
buffer_load_dwordx4 v25, s[28:31], s38 offen lds
s_add_u32 m0, s51, 148480
s_mov_b32 s38, 2899968
buffer_load_dwordx4 v25, s[28:31], s38 offen lds
s_waitcnt vmcnt(18)
s_barrier
s_add_u32 m0, s39, 98304
s_mov_b32 s37, 376832
buffer_load_dwordx4 v3, s[24:27], s37 offen sc1 lds
buffer_load_dwordx4 v3, s[24:27], s37 offen offset:1024 sc1 lds
buffer_load_dwordx4 v3, s[24:27], s37 offen offset:2048 sc1 lds
buffer_load_dwordx4 v3, s[24:27], s37 offen offset:3072 sc1 lds
s_add_u32 m0, s51, 114688
s_mov_b32 s38, 3014656
buffer_load_dwordx4 v25, s[28:31], s38 offen lds
s_add_u32 m0, s51, 115712
s_mov_b32 s38, 3031040
buffer_load_dwordx4 v25, s[28:31], s38 offen lds
s_waitcnt vmcnt(18)
s_barrier
s_add_u32 m0, s39, 131072
s_mov_b32 s37, 393216
buffer_load_dwordx4 v3, s[24:27], s37 offen sc1 lds
buffer_load_dwordx4 v3, s[24:27], s37 offen offset:1024 sc1 lds
buffer_load_dwordx4 v3, s[24:27], s37 offen offset:2048 sc1 lds
buffer_load_dwordx4 v3, s[24:27], s37 offen offset:3072 sc1 lds
s_add_u32 m0, s51, 0
s_mov_b32 s38, 3145728
buffer_load_dwordx4 v25, s[28:31], s38 offen lds
s_add_u32 m0, s51, 1024
s_mov_b32 s38, 3162112
buffer_load_dwordx4 v25, s[28:31], s38 offen lds
s_waitcnt vmcnt(18)
s_barrier
s_add_u32 m0, s39, 16384
s_mov_b32 s37, 409600
buffer_load_dwordx4 v3, s[24:27], s37 offen sc1 lds
buffer_load_dwordx4 v3, s[24:27], s37 offen offset:1024 sc1 lds
buffer_load_dwordx4 v3, s[24:27], s37 offen offset:2048 sc1 lds
buffer_load_dwordx4 v3, s[24:27], s37 offen offset:3072 sc1 lds
s_add_u32 m0, s51, 32768
s_mov_b32 s38, 3276800
buffer_load_dwordx4 v25, s[28:31], s38 offen lds
s_add_u32 m0, s51, 33792
s_mov_b32 s38, 3293184
buffer_load_dwordx4 v25, s[28:31], s38 offen lds
s_waitcnt vmcnt(18)
s_barrier
s_add_u32 m0, s39, 49152
s_mov_b32 s37, 425984
buffer_load_dwordx4 v3, s[24:27], s37 offen sc1 lds
buffer_load_dwordx4 v3, s[24:27], s37 offen offset:1024 sc1 lds
buffer_load_dwordx4 v3, s[24:27], s37 offen offset:2048 sc1 lds
buffer_load_dwordx4 v3, s[24:27], s37 offen offset:3072 sc1 lds
s_add_u32 m0, s51, 65536
s_mov_b32 s38, 3407872
buffer_load_dwordx4 v25, s[28:31], s38 offen lds
s_add_u32 m0, s51, 66560
s_mov_b32 s38, 3424256
buffer_load_dwordx4 v25, s[28:31], s38 offen lds
s_waitcnt vmcnt(18)
s_barrier
s_add_u32 m0, s39, 81920
s_mov_b32 s37, 442368
buffer_load_dwordx4 v3, s[24:27], s37 offen sc1 lds
buffer_load_dwordx4 v3, s[24:27], s37 offen offset:1024 sc1 lds
buffer_load_dwordx4 v3, s[24:27], s37 offen offset:2048 sc1 lds
buffer_load_dwordx4 v3, s[24:27], s37 offen offset:3072 sc1 lds
s_add_u32 m0, s51, 147456
s_mov_b32 s38, 3538944
buffer_load_dwordx4 v25, s[28:31], s38 offen lds
s_add_u32 m0, s51, 148480
s_mov_b32 s38, 3555328
buffer_load_dwordx4 v25, s[28:31], s38 offen lds
s_waitcnt vmcnt(18)
s_barrier
s_add_u32 m0, s39, 98304
s_mov_b32 s37, 458752
buffer_load_dwordx4 v3, s[24:27], s37 offen sc1 lds
buffer_load_dwordx4 v3, s[24:27], s37 offen offset:1024 sc1 lds
buffer_load_dwordx4 v3, s[24:27], s37 offen offset:2048 sc1 lds
buffer_load_dwordx4 v3, s[24:27], s37 offen offset:3072 sc1 lds
s_add_u32 m0, s51, 114688
s_mov_b32 s38, 3670016
buffer_load_dwordx4 v25, s[28:31], s38 offen lds
s_add_u32 m0, s51, 115712
s_mov_b32 s38, 3686400
buffer_load_dwordx4 v25, s[28:31], s38 offen lds
s_waitcnt vmcnt(18)
s_barrier
s_add_u32 m0, s39, 131072
s_mov_b32 s37, 475136
buffer_load_dwordx4 v3, s[24:27], s37 offen sc1 lds
buffer_load_dwordx4 v3, s[24:27], s37 offen offset:1024 sc1 lds
buffer_load_dwordx4 v3, s[24:27], s37 offen offset:2048 sc1 lds
buffer_load_dwordx4 v3, s[24:27], s37 offen offset:3072 sc1 lds
s_add_u32 m0, s51, 0
s_mov_b32 s38, 3801088
buffer_load_dwordx4 v25, s[28:31], s38 offen lds
s_add_u32 m0, s51, 1024
s_mov_b32 s38, 3817472
buffer_load_dwordx4 v25, s[28:31], s38 offen lds
s_waitcnt vmcnt(18)
s_barrier
s_cmp_eq_u32 s47, 0
s_cbranch_scc0 Lw_161
s_xor_b32 s43, s2, 2
s_add_u32 s43, s43, 128
s_lshl_b32 s43, s43, 7
v_mov_b32 v26, s43
v_mov_b32 v27, 1
s_mov_b64 exec, 1
buffer_store_dword v27, v26, s[56:59], 0 offen sc1
s_mov_b64 exec, -1
Lw_161:
s_add_u32 m0, s39, 16384
s_mov_b32 s37, 491520
buffer_load_dwordx4 v3, s[24:27], s37 offen sc1 lds
buffer_load_dwordx4 v3, s[24:27], s37 offen offset:1024 sc1 lds
buffer_load_dwordx4 v3, s[24:27], s37 offen offset:2048 sc1 lds
buffer_load_dwordx4 v3, s[24:27], s37 offen offset:3072 sc1 lds
s_add_u32 m0, s51, 32768
s_mov_b32 s38, 3932160
buffer_load_dwordx4 v25, s[28:31], s38 offen lds
s_add_u32 m0, s51, 33792
s_mov_b32 s38, 3948544
buffer_load_dwordx4 v25, s[28:31], s38 offen lds
s_waitcnt vmcnt(18)
s_barrier
s_add_u32 m0, s39, 49152
s_mov_b32 s37, 507904
buffer_load_dwordx4 v3, s[24:27], s37 offen sc1 lds
buffer_load_dwordx4 v3, s[24:27], s37 offen offset:1024 sc1 lds
buffer_load_dwordx4 v3, s[24:27], s37 offen offset:2048 sc1 lds
buffer_load_dwordx4 v3, s[24:27], s37 offen offset:3072 sc1 lds
s_add_u32 m0, s51, 65536
s_mov_b32 s38, 4063232
buffer_load_dwordx4 v25, s[28:31], s38 offen lds
s_add_u32 m0, s51, 66560
s_mov_b32 s38, 4079616
buffer_load_dwordx4 v25, s[28:31], s38 offen lds
s_waitcnt vmcnt(18)
s_barrier
s_cmp_eq_u32 s47, 3
s_cbranch_scc0 Lw_162
s_lshl_b32 s92, s2, 7
s_add_u32 s92, s92, 28327936
s_load_dword s93, s[82:83], s92 glc
Lw_162:
s_waitcnt vmcnt(12)
s_cmp_eq_u32 s47, 3
s_cbranch_scc0 Lw_163
s_mov_b32 s41, 0x40000
s_branch Lpchk_166
Lpoll_164:
s_load_dword s93, s[82:83], s92 glc
Lpchk_166:
s_waitcnt lgkmcnt(0)
s_cmp_eq_u32 s93, 1
s_cbranch_scc1 Lpok_165
s_sub_u32 s41, s41, 1
s_cmp_lg_u32 s41, 0
s_cbranch_scc1 Lpoll_164
Lpok_165:
Lw_163:
s_barrier
s_waitcnt vmcnt(6)
s_barrier
s_waitcnt vmcnt(0)
s_barrier
s_barrier
s_branch Ldone_1
Ldone_1:
Lfin:
Lexit_2:
s_endpgm
.section .rodata,"a"
.p2align 6
.amdhsa_kernel sequential_preLN__sliding_local_dilated__glu_gated_geglu__prompt_kernel
  .amdhsa_next_free_vgpr 256
  .amdhsa_next_free_sgpr 100
  .amdhsa_accum_offset 256
  .amdhsa_group_segment_fixed_size 0
  .amdhsa_kernarg_size 80
  .amdhsa_user_sgpr_count 2
  .amdhsa_user_sgpr_kernarg_segment_ptr 1
  .amdhsa_system_sgpr_workgroup_id_x 1
  .amdhsa_float_denorm_mode_32 3
  .amdhsa_float_denorm_mode_16_64 3
.end_amdhsa_kernel
```

```asm
; @launch grid=(256,1,1) block=(512,1,1) lds=163840
.amdgcn_target "amdgcn-amd-amdhsa--gfx950"
.text
.globl sequential_preLN__sliding_local_dilated__glu_gated_geglu__prompt_kernel
.p2align 8
.type sequential_preLN__sliding_local_dilated__glu_gated_geglu__prompt_kernel,@function
sequential_preLN__sliding_local_dilated__glu_gated_geglu__prompt_kernel:
s_cmp_ge_u32 s2, 256
s_cbranch_scc1 Lexit_2
s_load_dwordx16 s[64:79], s[0:1], 0
s_load_dwordx4 s[80:83], s[0:1], 64
s_and_b32 s3, s2, 7
s_lshr_b32 s42, s2, 3
s_and_b32 s34, s3, 1
s_lshl_b32 s34, s34, 3
s_and_b32 s48, s42, 7
s_add_u32 s34, s34, s48
s_lshr_b32 s35, s3, 1
s_lshr_b32 s49, s42, 3
s_lshl_b32 s35, s35, 2
s_add_u32 s35, s35, s49
v_lshrrev_b32 v12, 6, v0
v_and_b32 v1, 63, v0
v_readfirstlane_b32 s36, v12
Lbeg:
s_lshl_b32 s50, s34, 7
s_sub_u32 s50, s50, 16
v_and_b32 v12, 15, v1
v_lshrrev_b32 v13, 4, v1
s_cmp_lt_u32 s36, 4
s_cbranch_scc1 Lcons_7
Lprod_3:
s_sub_u32 s47, s36, 4
s_lshl_b32 s43, s34, 7
s_lshl_b32 s44, s35, 3
s_add_u32 s63, s43, s44
s_lshl_b32 s44, s47, 1
s_add_u32 s51, s63, s44
v_lshlrev_b32 v10, 4, v1
s_and_b32 s43, s2, 7
s_lshr_b32 s44, s43, 2
s_lshl_b32 s44, s44, 1
s_and_b32 s45, s43, 1
s_add_u32 s44, s44, s45
s_lshr_b32 s45, s2, 3
s_lshl_b32 s45, s45, 2
s_add_u32 s44, s44, s45
s_add_u32 s44, s44, 96
s_bitcmp1_b32 s43, 1
s_cselect_b32 s44, s44, 0x10000
s_cmp_lt_u32 s2, 192
s_cselect_b32 s33, s2, s44
v_lshrrev_b32 v14, 3, v1
v_and_b32 v15, 7, v1
v_lshl_add_u32 v19, v14, 6, v15
s_lshl_b32 s43, s48, 3
v_add_u32 v19, s43, v19
v_mul_u32_u24 v19, 6144, v19
s_cmp_eq_u32 s47, 3
s_cbranch_scc1 Lpf_4
v_and_b32 v16, 2, v14
v_xor_b32 v16, v15, v16
v_lshlrev_b32 v16, 4, v16
v_mul_u32_u24 v17, 6144, v14
s_lshl_b32 s43, s47, 11
v_add3_u32 v2, v17, v16, s43
v_xor_b32 v3, 64, v2
v_lshrrev_b32 v16, 1, v14
v_xor_b32 v16, v15, v16
v_lshlrev_b32 v16, 4, v16
s_lshl_b32 s43, s47, 3
s_add_u32 s43, s43, s50
v_add_u32 v17, s43, v14
s_and_b32 s44, s47, 1
s_lshl_b32 s44, s44, 6
v_add_u32 v18, 0, v17
v_max_i32 v18, 0, v18
v_lshl_add_u32 v18, v18, 11, v16
v_xor_b32 v18, s44, v18
v_mov_b32 v4, v18
v_add_u32 v18, 24, v17
v_max_i32 v18, 0, v18
v_lshl_add_u32 v18, v18, 11, v16
v_xor_b32 v18, s44, v18
v_xor_b32 v5, 64, v18
v_add_u32 v18, 48, v17
v_max_i32 v18, 0, v18
v_lshl_add_u32 v18, v18, 11, v16
v_xor_b32 v18, s44, v18
v_mov_b32 v6, v18
v_add_u32 v18, 72, v17
v_max_i32 v18, 0, v18
v_lshl_add_u32 v18, v18, 11, v16
v_xor_b32 v18, s44, v18
v_xor_b32 v7, 64, v18
v_add_u32 v18, 96, v17
v_max_i32 v18, 0, v18
v_lshl_add_u32 v18, v18, 11, v16
v_xor_b32 v18, s44, v18
v_mov_b32 v8, v18
v_add_u32 v18, 120, v17
v_max_i32 v18, 0, v18
v_lshl_add_u32 v18, v18, 11, v16
v_xor_b32 v18, s44, v18
v_xor_b32 v9, 64, v18
s_lshl_b32 s39, s47, 10
s_lshl_b32 s40, s47, 13
s_add_u32 s40, s40, 18432
s_mov_b32 s37, 0
s_mov_b32 s38, 0
s_bfm_b64 s[60:61], 56, 8
s_cmp_eq_u32 s47, 0
s_cselect_b64 s[60:61], s[60:61], -1
s_lshl_b32 s43, s35, 7
s_waitcnt lgkmcnt(0)
s_mov_b32 s8, s64
s_mov_b32 s9, s65
s_mov_b32 s10, 4194304
s_mov_b32 s11, 0x20000
s_add_u32 s12, s66, s43
s_addc_u32 s13, s67, 0
s_mov_b32 s14, 6289536
s_mov_b32 s15, 0x20000
s_add_u32 m0, s39, 0
s_mov_b64 exec, s[60:61]
buffer_load_dwordx4 v4, s[8:11], s37 offen lds
s_mov_b64 exec, -1
s_add_u32 m0, s39, 3072
s_nop 0
buffer_load_dwordx4 v5, s[8:11], s37 offen lds
s_add_u32 m0, s39, 6144
s_nop 0
buffer_load_dwordx4 v6, s[8:11], s37 offen lds
s_add_u32 m0, s39, 9216
s_nop 0
buffer_load_dwordx4 v7, s[8:11], s37 offen lds
s_add_u32 m0, s39, 12288
s_nop 0
buffer_load_dwordx4 v8, s[8:11], s37 offen lds
s_add_u32 m0, s39, 15360
s_nop 0
buffer_load_dwordx4 v9, s[8:11], s37 offen lds
s_add_u32 m0, s40, 0
s_add_u32 s43, s38, 0
buffer_load_dwordx4 v2, s[12:15], s43 offen lds
s_add_u32 m0, s40, 1024
s_add_u32 s43, s38, 49152
buffer_load_dwordx4 v3, s[12:15], s43 offen lds
s_add_u32 m0, s40, 2048
s_add_u32 s43, s38, 98304
buffer_load_dwordx4 v2, s[12:15], s43 offen lds
s_add_u32 m0, s40, 3072
s_add_u32 s43, s38, 147456
buffer_load_dwordx4 v3, s[12:15], s43 offen lds
s_add_u32 m0, s40, 4096
s_add_u32 s43, s38, 196608
buffer_load_dwordx4 v2, s[12:15], s43 offen lds
s_add_u32 m0, s40, 5120
s_add_u32 s43, s38, 245760
buffer_load_dwordx4 v3, s[12:15], s43 offen lds
s_add_u32 m0, s40, 6144
s_add_u32 s43, s38, 294912
buffer_load_dwordx4 v2, s[12:15], s43 offen lds
s_add_u32 m0, s40, 7168
s_add_u32 s43, s38, 344064
buffer_load_dwordx4 v3, s[12:15], s43 offen lds
s_add_u32 s37, s37, 128
s_add_u32 s38, s38, 393216
s_mov_b32 s28, s66
s_mov_b32 s29, s67
s_mov_b32 s30, 6291456
s_mov_b32 s31, 0x20000
s_mul_i32 s43, s33, 3840
s_add_u32 s43, s43, 393216
v_lshlrev_b32 v30, 7, v1
s_mul_i32 s44, s47, 1280
s_add_u32 s43, s43, s44
s_bfm_b64 exec, 10, 0
buffer_load_dword v31, v30, s[28:31], s43 offen
s_mov_b64 exec, -1
s_lshl_b32 s43, s51, 11
buffer_load_dwordx4 v[96:99], v10, s[8:11], s43 offen offset:0
buffer_load_dwordx4 v[100:103], v10, s[8:11], s43 offen offset:1024
buffer_load_dwordx4 v[104:107], v10, s[8:11], s43 offen offset:2048
buffer_load_dwordx4 v[108:111], v10, s[8:11], s43 offen offset:3072
s_add_u32 m0, s39, 43008
s_mov_b64 exec, s[60:61]
buffer_load_dwordx4 v4, s[8:11], s37 offen lds
s_mov_b64 exec, -1
s_add_u32 m0, s39, 46080
s_nop 0
buffer_load_dwordx4 v5, s[8:11], s37 offen lds
s_add_u32 m0, s39, 49152
s_nop 0
buffer_load_dwordx4 v6, s[8:11], s37 offen lds
s_add_u32 m0, s39, 52224
s_nop 0
buffer_load_dwordx4 v7, s[8:11], s37 offen lds
s_add_u32 m0, s39, 55296
s_nop 0
buffer_load_dwordx4 v8, s[8:11], s37 offen lds
s_add_u32 m0, s39, 58368
s_nop 0
buffer_load_dwordx4 v9, s[8:11], s37 offen lds
s_add_u32 m0, s40, 43008
s_add_u32 s43, s38, 0
buffer_load_dwordx4 v2, s[12:15], s43 offen lds
s_add_u32 m0, s40, 44032
s_add_u32 s43, s38, 49152
buffer_load_dwordx4 v3, s[12:15], s43 offen lds
s_add_u32 m0, s40, 45056
s_add_u32 s43, s38, 98304
buffer_load_dwordx4 v2, s[12:15], s43 offen lds
s_add_u32 m0, s40, 46080
s_add_u32 s43, s38, 147456
buffer_load_dwordx4 v3, s[12:15], s43 offen lds
s_add_u32 m0, s40, 47104
s_add_u32 s43, s38, 196608
buffer_load_dwordx4 v2, s[12:15], s43 offen lds
s_add_u32 m0, s40, 48128
s_add_u32 s43, s38, 245760
buffer_load_dwordx4 v3, s[12:15], s43 offen lds
s_add_u32 m0, s40, 49152
s_add_u32 s43, s38, 294912
buffer_load_dwordx4 v2, s[12:15], s43 offen lds
s_add_u32 m0, s40, 50176
s_add_u32 s43, s38, 344064
buffer_load_dwordx4 v3, s[12:15], s43 offen lds
s_add_u32 s37, s37, 128
s_add_u32 s38, s38, 393216
s_waitcnt vmcnt(19)
s_barrier
s_add_u32 m0, s39, 86016
s_mov_b64 exec, s[60:61]
buffer_load_dwordx4 v4, s[8:11], s37 offen lds
s_mov_b64 exec, -1
s_add_u32 m0, s39, 89088
s_nop 0
buffer_load_dwordx4 v5, s[8:11], s37 offen lds
s_add_u32 m0, s39, 92160
s_nop 0
buffer_load_dwordx4 v6, s[8:11], s37 offen lds
s_add_u32 m0, s39, 95232
s_nop 0
buffer_load_dwordx4 v7, s[8:11], s37 offen lds
s_add_u32 m0, s39, 98304
s_nop 0
buffer_load_dwordx4 v8, s[8:11], s37 offen lds
s_add_u32 m0, s39, 101376
s_nop 0
buffer_load_dwordx4 v9, s[8:11], s37 offen lds
s_add_u32 m0, s40, 86016
s_add_u32 s43, s38, 0
buffer_load_dwordx4 v2, s[12:15], s43 offen lds
s_add_u32 m0, s40, 87040
s_add_u32 s43, s38, 49152
buffer_load_dwordx4 v3, s[12:15], s43 offen lds
s_add_u32 m0, s40, 88064
s_add_u32 s43, s38, 98304
buffer_load_dwordx4 v2, s[12:15], s43 offen lds
s_add_u32 m0, s40, 89088
s_add_u32 s43, s38, 147456
buffer_load_dwordx4 v3, s[12:15], s43 offen lds
s_add_u32 m0, s40, 90112
s_add_u32 s43, s38, 196608
buffer_load_dwordx4 v2, s[12:15], s43 offen lds
s_add_u32 m0, s40, 91136
s_add_u32 s43, s38, 245760
buffer_load_dwordx4 v3, s[12:15], s43 offen lds
s_add_u32 m0, s40, 92160
s_add_u32 s43, s38, 294912
buffer_load_dwordx4 v2, s[12:15], s43 offen lds
s_add_u32 m0, s40, 93184
s_add_u32 s43, s38, 344064
buffer_load_dwordx4 v3, s[12:15], s43 offen lds
s_add_u32 s37, s37, 128
s_add_u32 s38, s38, 393216
s_waitcnt vmcnt(28)
s_mov_b32 s43, 0x3f803f80
v_mov_b32 v116, 0
v_mov_b32 v117, 0
v_mov_b32 v118, 0
v_mov_b32 v119, 0
v_mov_b32 v120, 0
v_mov_b32 v121, 0
v_mov_b32 v122, 0
v_mov_b32 v123, 0
v_dot2_f32_bf16 v116, v96, s43, v116
v_dot2_f32_bf16 v120, v96, v96, v120
v_dot2_f32_bf16 v118, v104, s43, v118
v_dot2_f32_bf16 v122, v104, v104, v122
v_dot2_f32_bf16 v117, v97, s43, v117
v_dot2_f32_bf16 v121, v97, v97, v121
v_dot2_f32_bf16 v119, v105, s43, v119
v_dot2_f32_bf16 v123, v105, v105, v123
v_dot2_f32_bf16 v116, v98, s43, v116
v_dot2_f32_bf16 v120, v98, v98, v120
v_dot2_f32_bf16 v118, v106, s43, v118
v_dot2_f32_bf16 v122, v106, v106, v122
v_dot2_f32_bf16 v117, v99, s43, v117
v_dot2_f32_bf16 v121, v99, v99, v121
v_dot2_f32_bf16 v119, v107, s43, v119
v_dot2_f32_bf16 v123, v107, v107, v123
v_dot2_f32_bf16 v116, v100, s43, v116
v_dot2_f32_bf16 v120, v100, v100, v120
v_dot2_f32_bf16 v118, v108, s43, v118
v_dot2_f32_bf16 v122, v108, v108, v122
v_dot2_f32_bf16 v117, v101, s43, v117
v_dot2_f32_bf16 v121, v101, v101, v121
v_dot2_f32_bf16 v119, v109, s43, v119
v_dot2_f32_bf16 v123, v109, v109, v123
v_dot2_f32_bf16 v116, v102, s43, v116
v_dot2_f32_bf16 v120, v102, v102, v120
v_dot2_f32_bf16 v118, v110, s43, v118
v_dot2_f32_bf16 v122, v110, v110, v122
v_dot2_f32_bf16 v117, v103, s43, v117
v_dot2_f32_bf16 v121, v103, v103, v121
v_dot2_f32_bf16 v119, v111, s43, v119
v_dot2_f32_bf16 v123, v111, v111, v123
s_nop 2
v_add_f32 v116, v116, v117
v_add_f32 v118, v118, v119
v_add_f32 v120, v120, v121
v_add_f32 v122, v122, v123
s_nop 1
v_permlane32_swap_b32 v116, v118
v_permlane32_swap_b32 v120, v122
v_add_f32 v116, v116, v118
v_add_f32 v120, v120, v122
s_nop 1
v_permlane16_swap_b32 v116, v120
v_add_f32 v116, v116, v120
s_nop 1
v_add_f32_dpp v116, v116, v116 row_ror:8 row_mask:0xf bank_mask:0xf
s_nop 1
v_add_f32_dpp v116, v116, v116 row_ror:4 row_mask:0xf bank_mask:0xf
s_nop 1
v_add_f32_dpp v116, v116, v116 row_ror:2 row_mask:0xf bank_mask:0xf
s_nop 1
v_add_f32_dpp v116, v116, v116 row_ror:1 row_mask:0xf bank_mask:0xf
v_mov_b32 v117, v116
s_nop 1
v_permlane16_swap_b32 v116, v117
v_mul_f32 v112, 0x3a800000, v116
v_mul_f32 v113, 0x3a800000, v117
v_fma_f32 v113, -v112, v112, v113
v_max_f32 v113, 0, v113
v_add_f32 v113, 0x3727c5ac, v113
v_rsq_f32 v113, v113
v_lshrrev_b32 v11, 5, v1
s_lshl_b32 s43, s47, 4
s_add_u32 s43, s43, 148608
v_lshl_add_u32 v11, v11, 3, s43
ds_write_b64 v11, v[112:113]
s_waitcnt lgkmcnt(0)
s_and_b32 s44, s36, 3
s_mul_i32 s44, s44, 24
s_bfe_u32 s43, s2, 0x30001
s_lshl_b32 s43, s43, 7
s_add_u32 s44, s44, s43
s_mul_i32 s44, s44, 7168
s_lshr_b32 s43, s2, 4
s_lshl_b32 s43, s43, 8
s_add_u32 s43, s43, s44
s_bitcmp0_b32 s2, 0
s_cselect_b32 s4, s72, s74
s_cselect_b32 s5, s73, s75
s_add_u32 s4, s4, s43
s_addc_u32 s5, s5, 0
s_waitcnt vmcnt(14)
s_barrier
s_add_u32 m0, s39, 0
s_mov_b64 exec, s[60:61]
buffer_load_dwordx4 v4, s[8:11], s37 offen lds
s_mov_b64 exec, -1
s_add_u32 m0, s39, 3072
s_nop 0
buffer_load_dwordx4 v5, s[8:11], s37 offen lds
s_add_u32 m0, s39, 6144
s_nop 0
buffer_load_dwordx4 v6, s[8:11], s37 offen lds
s_add_u32 m0, s39, 9216
s_nop 0
buffer_load_dwordx4 v7, s[8:11], s37 offen lds
s_add_u32 m0, s39, 12288
s_nop 0
buffer_load_dwordx4 v8, s[8:11], s37 offen lds
s_add_u32 m0, s39, 15360
s_nop 0
buffer_load_dwordx4 v9, s[8:11], s37 offen lds
s_add_u32 m0, s40, 0
s_add_u32 s43, s38, 0
buffer_load_dwordx4 v2, s[12:15], s43 offen lds
s_add_u32 m0, s40, 1024
s_add_u32 s43, s38, 49152
buffer_load_dwordx4 v3, s[12:15], s43 offen lds
s_add_u32 m0, s40, 2048
s_add_u32 s43, s38, 98304
buffer_load_dwordx4 v2, s[12:15], s43 offen lds
s_add_u32 m0, s40, 3072
s_add_u32 s43, s38, 147456
buffer_load_dwordx4 v3, s[12:15], s43 offen lds
s_add_u32 m0, s40, 4096
s_add_u32 s43, s38, 196608
buffer_load_dwordx4 v2, s[12:15], s43 offen lds
s_add_u32 m0, s40, 5120
s_add_u32 s43, s38, 245760
buffer_load_dwordx4 v3, s[12:15], s43 offen lds
s_add_u32 m0, s40, 6144
s_add_u32 s43, s38, 294912
buffer_load_dwordx4 v2, s[12:15], s43 offen lds
s_add_u32 m0, s40, 7168
s_add_u32 s43, s38, 344064
buffer_load_dwordx4 v3, s[12:15], s43 offen lds
s_add_u32 s37, s37, 128
s_add_u32 s38, s38, 393216
s_waitcnt vmcnt(14)
s_barrier
s_add_u32 m0, s39, 43008
s_mov_b64 exec, s[60:61]
buffer_load_dwordx4 v4, s[8:11], s37 offen lds
s_mov_b64 exec, -1
s_add_u32 m0, s39, 46080
s_nop 0
buffer_load_dwordx4 v5, s[8:11], s37 offen lds
s_add_u32 m0, s39, 49152
s_nop 0
buffer_load_dwordx4 v6, s[8:11], s37 offen lds
s_add_u32 m0, s39, 52224
s_nop 0
buffer_load_dwordx4 v7, s[8:11], s37 offen lds
s_add_u32 m0, s39, 55296
s_nop 0
buffer_load_dwordx4 v8, s[8:11], s37 offen lds
s_add_u32 m0, s39, 58368
s_nop 0
buffer_load_dwordx4 v9, s[8:11], s37 offen lds
s_add_u32 m0, s40, 43008
s_add_u32 s43, s38, 0
buffer_load_dwordx4 v2, s[12:15], s43 offen lds
s_add_u32 m0, s40, 44032
s_add_u32 s43, s38, 49152
buffer_load_dwordx4 v3, s[12:15], s43 offen lds
s_add_u32 m0, s40, 45056
s_add_u32 s43, s38, 98304
buffer_load_dwordx4 v2, s[12:15], s43 offen lds
s_add_u32 m0, s40, 46080
s_add_u32 s43, s38, 147456
buffer_load_dwordx4 v3, s[12:15], s43 offen lds
s_add_u32 m0, s40, 47104
s_add_u32 s43, s38, 196608
buffer_load_dwordx4 v2, s[12:15], s43 offen lds
s_add_u32 m0, s40, 48128
s_add_u32 s43, s38, 245760
buffer_load_dwordx4 v3, s[12:15], s43 offen lds
s_add_u32 m0, s40, 49152
s_add_u32 s43, s38, 294912
buffer_load_dwordx4 v2, s[12:15], s43 offen lds
s_add_u32 m0, s40, 50176
s_add_u32 s43, s38, 344064
buffer_load_dwordx4 v3, s[12:15], s43 offen lds
s_add_u32 s37, s37, 128
s_add_u32 s38, s38, 393216
s_load_dword s3, s[4:5], 0
s_load_dword s3, s[4:5], 64
s_load_dword s3, s[4:5], 128
s_waitcnt vmcnt(14)
s_barrier
s_add_u32 m0, s39, 86016
s_mov_b64 exec, s[60:61]
buffer_load_dwordx4 v4, s[8:11], s37 offen lds
s_mov_b64 exec, -1
s_add_u32 m0, s39, 89088
s_nop 0
buffer_load_dwordx4 v5, s[8:11], s37 offen lds
s_add_u32 m0, s39, 92160
s_nop 0
buffer_load_dwordx4 v6, s[8:11], s37 offen lds
s_add_u32 m0, s39, 95232
s_nop 0
buffer_load_dwordx4 v7, s[8:11], s37 offen lds
s_add_u32 m0, s39, 98304
s_nop 0
buffer_load_dwordx4 v8, s[8:11], s37 offen lds
s_add_u32 m0, s39, 101376
s_nop 0
buffer_load_dwordx4 v9, s[8:11], s37 offen lds
s_add_u32 m0, s40, 86016
s_add_u32 s43, s38, 0
buffer_load_dwordx4 v2, s[12:15], s43 offen lds
s_add_u32 m0, s40, 87040
s_add_u32 s43, s38, 49152
buffer_load_dwordx4 v3, s[12:15], s43 offen lds
s_add_u32 m0, s40, 88064
s_add_u32 s43, s38, 98304
buffer_load_dwordx4 v2, s[12:15], s43 offen lds
s_add_u32 m0, s40, 89088
s_add_u32 s43, s38, 147456
buffer_load_dwordx4 v3, s[12:15], s43 offen lds
s_add_u32 m0, s40, 90112
s_add_u32 s43, s38, 196608
buffer_load_dwordx4 v2, s[12:15], s43 offen lds
s_add_u32 m0, s40, 91136
s_add_u32 s43, s38, 245760
buffer_load_dwordx4 v3, s[12:15], s43 offen lds
s_add_u32 m0, s40, 92160
s_add_u32 s43, s38, 294912
buffer_load_dwordx4 v2, s[12:15], s43 offen lds
s_add_u32 m0, s40, 93184
s_add_u32 s43, s38, 344064
buffer_load_dwordx4 v3, s[12:15], s43 offen lds
s_add_u32 s37, s37, 128
s_add_u32 s38, s38, 393216
s_load_dword s3, s[4:5], 192
s_load_dword s3, s[4:5], 7168
s_load_dword s3, s[4:5], 7232
s_load_dword s3, s[4:5], 7296
s_waitcnt vmcnt(14)
s_barrier
s_add_u32 m0, s39, 0
s_mov_b64 exec, s[60:61]
buffer_load_dwordx4 v4, s[8:11], s37 offen lds
s_mov_b64 exec, -1
s_add_u32 m0, s39, 3072
s_nop 0
buffer_load_dwordx4 v5, s[8:11], s37 offen lds
s_add_u32 m0, s39, 6144
s_nop 0
buffer_load_dwordx4 v6, s[8:11], s37 offen lds
s_branch Lov_0
.p2align 12
Lst_0_0:
s_branch Lwr_146
s_nop 0
s_nop 0
Lov_0:
s_add_u32 m0, s39, 9216
s_nop 0
buffer_load_dwordx4 v7, s[8:11], s37 offen lds
s_add_u32 m0, s39, 12288
s_nop 0
buffer_load_dwordx4 v8, s[8:11], s37 offen lds
s_add_u32 m0, s39, 15360
s_nop 0
buffer_load_dwordx4 v9, s[8:11], s37 offen lds
s_add_u32 m0, s40, 0
s_add_u32 s43, s38, 0
buffer_load_dwordx4 v2, s[12:15], s43 offen lds
s_add_u32 m0, s40, 1024
s_add_u32 s43, s38, 49152
buffer_load_dwordx4 v3, s[12:15], s43 offen lds
s_add_u32 m0, s40, 2048
s_add_u32 s43, s38, 98304
buffer_load_dwordx4 v2, s[12:15], s43 offen lds
s_add_u32 m0, s40, 3072
s_add_u32 s43, s38, 147456
buffer_load_dwordx4 v3, s[12:15], s43 offen lds
s_add_u32 m0, s40, 4096
s_add_u32 s43, s38, 196608
buffer_load_dwordx4 v2, s[12:15], s43 offen lds
s_add_u32 m0, s40, 5120
s_add_u32 s43, s38, 245760
buffer_load_dwordx4 v3, s[12:15], s43 offen lds
s_add_u32 m0, s40, 6144
s_add_u32 s43, s38, 294912
buffer_load_dwordx4 v2, s[12:15], s43 offen lds
s_add_u32 m0, s40, 7168
s_add_u32 s43, s38, 344064
buffer_load_dwordx4 v3, s[12:15], s43 offen lds
s_add_u32 s37, s37, 128
s_add_u32 s38, s38, 393216
s_load_dword s3, s[4:5], 7360
s_load_dword s3, s[4:5], 14336
s_load_dword s3, s[4:5], 14400
s_load_dword s3, s[4:5], 14464
s_load_dword s3, s[4:5], 14528
s_waitcnt vmcnt(14)
s_barrier
s_add_u32 m0, s39, 43008
s_mov_b64 exec, s[60:61]
buffer_load_dwordx4 v4, s[8:11], s37 offen lds
s_mov_b64 exec, -1
s_add_u32 m0, s39, 46080
s_nop 0
buffer_load_dwordx4 v5, s[8:11], s37 offen lds
s_add_u32 m0, s39, 49152
s_nop 0
buffer_load_dwordx4 v6, s[8:11], s37 offen lds
s_add_u32 m0, s39, 52224
s_nop 0
buffer_load_dwordx4 v7, s[8:11], s37 offen lds
s_add_u32 m0, s39, 55296
s_nop 0
buffer_load_dwordx4 v8, s[8:11], s37 offen lds
s_add_u32 m0, s39, 58368
s_nop 0
buffer_load_dwordx4 v9, s[8:11], s37 offen lds
s_add_u32 m0, s40, 43008
s_add_u32 s43, s38, 0
buffer_load_dwordx4 v2, s[12:15], s43 offen lds
s_add_u32 m0, s40, 44032
s_add_u32 s43, s38, 49152
buffer_load_dwordx4 v3, s[12:15], s43 offen lds
s_add_u32 m0, s40, 45056
s_add_u32 s43, s38, 98304
buffer_load_dwordx4 v2, s[12:15], s43 offen lds
s_add_u32 m0, s40, 46080
s_add_u32 s43, s38, 147456
buffer_load_dwordx4 v3, s[12:15], s43 offen lds
s_add_u32 m0, s40, 47104
s_add_u32 s43, s38, 196608
buffer_load_dwordx4 v2, s[12:15], s43 offen lds
s_add_u32 m0, s40, 48128
s_add_u32 s43, s38, 245760
buffer_load_dwordx4 v3, s[12:15], s43 offen lds
s_add_u32 m0, s40, 49152
s_add_u32 s43, s38, 294912
buffer_load_dwordx4 v2, s[12:15], s43 offen lds
s_add_u32 m0, s40, 50176
s_add_u32 s43, s38, 344064
buffer_load_dwordx4 v3, s[12:15], s43 offen lds
s_add_u32 s37, s37, 128
s_add_u32 s38, s38, 393216
s_load_dword s3, s[4:5], 21504
s_load_dword s3, s[4:5], 21568
s_load_dword s3, s[4:5], 21632
s_load_dword s3, s[4:5], 21696
s_load_dword s3, s[4:5], 28672
s_load_dword s3, s[4:5], 28736
s_waitcnt vmcnt(14)
s_barrier
s_add_u32 m0, s39, 86016
s_mov_b64 exec, s[60:61]
buffer_load_dwordx4 v4, s[8:11], s37 offen lds
s_mov_b64 exec, -1
s_add_u32 m0, s39, 89088
s_nop 0
buffer_load_dwordx4 v5, s[8:11], s37 offen lds
s_add_u32 m0, s39, 92160
s_nop 0
buffer_load_dwordx4 v6, s[8:11], s37 offen lds
s_add_u32 m0, s39, 95232
s_nop 0
buffer_load_dwordx4 v7, s[8:11], s37 offen lds
s_add_u32 m0, s39, 98304
s_nop 0
buffer_load_dwordx4 v8, s[8:11], s37 offen lds
s_add_u32 m0, s39, 101376
s_nop 0
buffer_load_dwordx4 v9, s[8:11], s37 offen lds
s_add_u32 m0, s40, 86016
s_add_u32 s43, s38, 0
buffer_load_dwordx4 v2, s[12:15], s43 offen lds
s_add_u32 m0, s40, 87040
s_add_u32 s43, s38, 49152
buffer_load_dwordx4 v3, s[12:15], s43 offen lds
s_add_u32 m0, s40, 88064
s_add_u32 s43, s38, 98304
buffer_load_dwordx4 v2, s[12:15], s43 offen lds
s_add_u32 m0, s40, 89088
s_add_u32 s43, s38, 147456
buffer_load_dwordx4 v3, s[12:15], s43 offen lds
s_add_u32 m0, s40, 90112
s_add_u32 s43, s38, 196608
buffer_load_dwordx4 v2, s[12:15], s43 offen lds
s_add_u32 m0, s40, 91136
s_add_u32 s43, s38, 245760
buffer_load_dwordx4 v3, s[12:15], s43 offen lds
s_add_u32 m0, s40, 92160
s_add_u32 s43, s38, 294912
buffer_load_dwordx4 v2, s[12:15], s43 offen lds
s_add_u32 m0, s40, 93184
s_add_u32 s43, s38, 344064
buffer_load_dwordx4 v3, s[12:15], s43 offen lds
s_add_u32 s37, s37, 128
s_add_u32 s38, s38, 393216
s_load_dword s3, s[4:5], 28800
s_load_dword s3, s[4:5], 28864
s_load_dword s3, s[4:5], 35840
s_load_dword s3, s[4:5], 35904
s_load_dword s3, s[4:5], 35968
s_load_dword s3, s[4:5], 36032
s_load_dword s3, s[4:5], 43008
s_waitcnt vmcnt(14)
s_barrier
s_add_u32 m0, s39, 0
s_mov_b64 exec, s[60:61]
buffer_load_dwordx4 v4, s[8:11], s37 offen lds
s_mov_b64 exec, -1
s_add_u32 m0, s39, 3072
s_nop 0
buffer_load_dwordx4 v5, s[8:11], s37 offen lds
s_add_u32 m0, s39, 6144
s_nop 0
buffer_load_dwordx4 v6, s[8:11], s37 offen lds
s_add_u32 m0, s39, 9216
s_nop 0
buffer_load_dwordx4 v7, s[8:11], s37 offen lds
s_add_u32 m0, s39, 12288
s_nop 0
buffer_load_dwordx4 v8, s[8:11], s37 offen lds
s_add_u32 m0, s39, 15360
s_nop 0
buffer_load_dwordx4 v9, s[8:11], s37 offen lds
s_add_u32 m0, s40, 0
s_add_u32 s43, s38, 0
buffer_load_dwordx4 v2, s[12:15], s43 offen lds
s_add_u32 m0, s40, 1024
s_add_u32 s43, s38, 49152
buffer_load_dwordx4 v3, s[12:15], s43 offen lds
s_add_u32 m0, s40, 2048
s_add_u32 s43, s38, 98304
buffer_load_dwordx4 v2, s[12:15], s43 offen lds
s_add_u32 m0, s40, 3072
s_add_u32 s43, s38, 147456
buffer_load_dwordx4 v3, s[12:15], s43 offen lds
s_add_u32 m0, s40, 4096
s_add_u32 s43, s38, 196608
buffer_load_dwordx4 v2, s[12:15], s43 offen lds
s_add_u32 m0, s40, 5120
s_add_u32 s43, s38, 245760
buffer_load_dwordx4 v3, s[12:15], s43 offen lds
s_add_u32 m0, s40, 6144
s_add_u32 s43, s38, 294912
buffer_load_dwordx4 v2, s[12:15], s43 offen lds
s_add_u32 m0, s40, 7168
s_add_u32 s43, s38, 344064
buffer_load_dwordx4 v3, s[12:15], s43 offen lds
s_add_u32 s37, s37, 128
s_add_u32 s38, s38, 393216
s_load_dword s3, s[4:5], 43072
s_load_dword s3, s[4:5], 43136
s_load_dword s3, s[4:5], 43200
s_load_dword s3, s[4:5], 50176
s_load_dword s3, s[4:5], 50240
s_load_dword s3, s[4:5], 50304
s_load_dword s3, s[4:5], 50368
s_load_dword s3, s[4:5], 57344
s_waitcnt vmcnt(14)
s_barrier
s_add_u32 m0, s39, 43008
s_mov_b64 exec, s[60:61]
buffer_load_dwordx4 v4, s[8:11], s37 offen lds
s_mov_b64 exec, -1
s_add_u32 m0, s39, 46080
s_nop 0
buffer_load_dwordx4 v5, s[8:11], s37 offen lds
s_add_u32 m0, s39, 49152
s_nop 0
buffer_load_dwordx4 v6, s[8:11], s37 offen lds
s_add_u32 m0, s39, 52224
s_nop 0
buffer_load_dwordx4 v7, s[8:11], s37 offen lds
s_add_u32 m0, s39, 55296
s_nop 0
buffer_load_dwordx4 v8, s[8:11], s37 offen lds
s_add_u32 m0, s39, 58368
s_nop 0
buffer_load_dwordx4 v9, s[8:11], s37 offen lds
s_add_u32 m0, s40, 43008
s_add_u32 s43, s38, 0
buffer_load_dwordx4 v2, s[12:15], s43 offen lds
s_add_u32 m0, s40, 44032
s_add_u32 s43, s38, 49152
buffer_load_dwordx4 v3, s[12:15], s43 offen lds
s_add_u32 m0, s40, 45056
s_add_u32 s43, s38, 98304
buffer_load_dwordx4 v2, s[12:15], s43 offen lds
s_add_u32 m0, s40, 46080
s_add_u32 s43, s38, 147456
buffer_load_dwordx4 v3, s[12:15], s43 offen lds
s_add_u32 m0, s40, 47104
s_add_u32 s43, s38, 196608
buffer_load_dwordx4 v2, s[12:15], s43 offen lds
s_add_u32 m0, s40, 48128
s_add_u32 s43, s38, 245760
buffer_load_dwordx4 v3, s[12:15], s43 offen lds
s_add_u32 m0, s40, 49152
s_add_u32 s43, s38, 294912
buffer_load_dwordx4 v2, s[12:15], s43 offen lds
s_add_u32 m0, s40, 50176
s_add_u32 s43, s38, 344064
buffer_load_dwordx4 v3, s[12:15], s43 offen lds
s_add_u32 s37, s37, 128
s_add_u32 s38, s38, 393216
s_load_dword s3, s[4:5], 57408
s_load_dword s3, s[4:5], 57472
s_load_dword s3, s[4:5], 57536
s_load_dword s3, s[4:5], 64512
s_load_dword s3, s[4:5], 64576
s_load_dword s3, s[4:5], 64640
s_load_dword s3, s[4:5], 64704
s_load_dword s3, s[4:5], 71680
s_load_dword s3, s[4:5], 71744
s_waitcnt vmcnt(14)
s_barrier
s_add_u32 m0, s39, 86016
s_mov_b64 exec, s[60:61]
buffer_load_dwordx4 v4, s[8:11], s37 offen lds
s_mov_b64 exec, -1
s_add_u32 m0, s39, 89088
s_nop 0
buffer_load_dwordx4 v5, s[8:11], s37 offen lds
s_add_u32 m0, s39, 92160
s_nop 0
buffer_load_dwordx4 v6, s[8:11], s37 offen lds
s_add_u32 m0, s39, 95232
s_nop 0
buffer_load_dwordx4 v7, s[8:11], s37 offen lds
s_add_u32 m0, s39, 98304
s_nop 0
buffer_load_dwordx4 v8, s[8:11], s37 offen lds
s_add_u32 m0, s39, 101376
s_nop 0
buffer_load_dwordx4 v9, s[8:11], s37 offen lds
s_add_u32 m0, s40, 86016
s_add_u32 s43, s38, 0
buffer_load_dwordx4 v2, s[12:15], s43 offen lds
s_add_u32 m0, s40, 87040
s_add_u32 s43, s38, 49152
buffer_load_dwordx4 v3, s[12:15], s43 offen lds
s_add_u32 m0, s40, 88064
s_add_u32 s43, s38, 98304
buffer_load_dwordx4 v2, s[12:15], s43 offen lds
s_add_u32 m0, s40, 89088
s_add_u32 s43, s38, 147456
buffer_load_dwordx4 v3, s[12:15], s43 offen lds
s_add_u32 m0, s40, 90112
s_add_u32 s43, s38, 196608
buffer_load_dwordx4 v2, s[12:15], s43 offen lds
s_add_u32 m0, s40, 91136
s_add_u32 s43, s38, 245760
buffer_load_dwordx4 v3, s[12:15], s43 offen lds
s_add_u32 m0, s40, 92160
s_add_u32 s43, s38, 294912
buffer_load_dwordx4 v2, s[12:15], s43 offen lds
s_add_u32 m0, s40, 93184
s_add_u32 s43, s38, 344064
buffer_load_dwordx4 v3, s[12:15], s43 offen lds
s_add_u32 s37, s37, 128
s_add_u32 s38, s38, 393216
s_load_dword s3, s[4:5], 71808
s_load_dword s3, s[4:5], 71872
s_load_dword s3, s[4:5], 78848
s_load_dword s3, s[4:5], 78912
s_load_dword s3, s[4:5], 78976
s_load_dword s3, s[4:5], 79040
s_load_dword s3, s[4:5], 86016
s_load_dword s3, s[4:5], 86080
s_load_dword s3, s[4:5], 86144
s_waitcnt vmcnt(14)
s_barrier
s_add_u32 m0, s39, 0
s_mov_b64 exec, s[60:61]
buffer_load_dwordx4 v4, s[8:11], s37 offen lds
s_mov_b64 exec, -1
s_add_u32 m0, s39, 3072
s_nop 0
buffer_load_dwordx4 v5, s[8:11], s37 offen lds
s_add_u32 m0, s39, 6144
s_nop 0
buffer_load_dwordx4 v6, s[8:11], s37 offen lds
s_add_u32 m0, s39, 9216
s_nop 0
buffer_load_dwordx4 v7, s[8:11], s37 offen lds
s_add_u32 m0, s39, 12288
s_nop 0
buffer_load_dwordx4 v8, s[8:11], s37 offen lds
s_add_u32 m0, s39, 15360
s_nop 0
buffer_load_dwordx4 v9, s[8:11], s37 offen lds
s_add_u32 m0, s40, 0
s_add_u32 s43, s38, 0
buffer_load_dwordx4 v2, s[12:15], s43 offen lds
s_add_u32 m0, s40, 1024
s_add_u32 s43, s38, 49152
buffer_load_dwordx4 v3, s[12:15], s43 offen lds
s_add_u32 m0, s40, 2048
s_add_u32 s43, s38, 98304
buffer_load_dwordx4 v2, s[12:15], s43 offen lds
s_add_u32 m0, s40, 3072
s_add_u32 s43, s38, 147456
buffer_load_dwordx4 v3, s[12:15], s43 offen lds
s_add_u32 m0, s40, 4096
s_add_u32 s43, s38, 196608
buffer_load_dwordx4 v2, s[12:15], s43 offen lds
s_add_u32 m0, s40, 5120
s_add_u32 s43, s38, 245760
buffer_load_dwordx4 v3, s[12:15], s43 offen lds
s_add_u32 m0, s40, 6144
s_add_u32 s43, s38, 294912
buffer_load_dwordx4 v2, s[12:15], s43 offen lds
s_add_u32 m0, s40, 7168
s_add_u32 s43, s38, 344064
buffer_load_dwordx4 v3, s[12:15], s43 offen lds
s_add_u32 s37, s37, 128
s_add_u32 s38, s38, 393216
s_load_dword s3, s[4:5], 86208
s_load_dword s3, s[4:5], 93184
s_load_dword s3, s[4:5], 93248
s_load_dword s3, s[4:5], 93312
s_load_dword s3, s[4:5], 93376
s_load_dword s3, s[4:5], 100352
s_load_dword s3, s[4:5], 100416
s_load_dword s3, s[4:5], 100480
s_load_dword s3, s[4:5], 100544
s_waitcnt vmcnt(14)
s_barrier
s_add_u32 m0, s39, 43008
s_mov_b64 exec, s[60:61]
buffer_load_dwordx4 v4, s[8:11], s37 offen lds
s_mov_b64 exec, -1
s_add_u32 m0, s39, 46080
s_nop 0
buffer_load_dwordx4 v5, s[8:11], s37 offen lds
s_add_u32 m0, s39, 49152
s_nop 0
buffer_load_dwordx4 v6, s[8:11], s37 offen lds
s_add_u32 m0, s39, 52224
s_nop 0
buffer_load_dwordx4 v7, s[8:11], s37 offen lds
s_add_u32 m0, s39, 55296
s_nop 0
buffer_load_dwordx4 v8, s[8:11], s37 offen lds
s_add_u32 m0, s39, 58368
s_nop 0
buffer_load_dwordx4 v9, s[8:11], s37 offen lds
s_add_u32 m0, s40, 43008
s_add_u32 s43, s38, 0
buffer_load_dwordx4 v2, s[12:15], s43 offen lds
s_add_u32 m0, s40, 44032
s_add_u32 s43, s38, 49152
buffer_load_dwordx4 v3, s[12:15], s43 offen lds
s_add_u32 m0, s40, 45056
s_add_u32 s43, s38, 98304
buffer_load_dwordx4 v2, s[12:15], s43 offen lds
s_add_u32 m0, s40, 46080
s_add_u32 s43, s38, 147456
buffer_load_dwordx4 v3, s[12:15], s43 offen lds
s_add_u32 m0, s40, 47104
s_add_u32 s43, s38, 196608
buffer_load_dwordx4 v2, s[12:15], s43 offen lds
s_add_u32 m0, s40, 48128
s_add_u32 s43, s38, 245760
buffer_load_dwordx4 v3, s[12:15], s43 offen lds
s_add_u32 m0, s40, 49152
s_add_u32 s43, s38, 294912
buffer_load_dwordx4 v2, s[12:15], s43 offen lds
s_add_u32 m0, s40, 50176
s_add_u32 s43, s38, 344064
buffer_load_dwordx4 v3, s[12:15], s43 offen lds
s_add_u32 s37, s37, 128
s_add_u32 s38, s38, 393216
s_load_dword s3, s[4:5], 107520
s_load_dword s3, s[4:5], 107584
s_load_dword s3, s[4:5], 107648
s_load_dword s3, s[4:5], 107712
s_load_dword s3, s[4:5], 114688
s_load_dword s3, s[4:5], 114752
s_load_dword s3, s[4:5], 114816
s_load_dword s3, s[4:5], 114880
s_load_dword s3, s[4:5], 121856
s_waitcnt vmcnt(14)
s_barrier
s_add_u32 m0, s39, 86016
s_mov_b64 exec, s[60:61]
buffer_load_dwordx4 v4, s[8:11], s37 offen lds
s_mov_b64 exec, -1
s_add_u32 m0, s39, 89088
s_nop 0
buffer_load_dwordx4 v5, s[8:11], s37 offen lds
s_add_u32 m0, s39, 92160
s_nop 0
buffer_load_dwordx4 v6, s[8:11], s37 offen lds
s_add_u32 m0, s39, 95232
s_nop 0
buffer_load_dwordx4 v7, s[8:11], s37 offen lds
s_add_u32 m0, s39, 98304
s_nop 0
buffer_load_dwordx4 v8, s[8:11], s37 offen lds
s_add_u32 m0, s39, 101376
s_nop 0
buffer_load_dwordx4 v9, s[8:11], s37 offen lds
s_add_u32 m0, s40, 86016
s_add_u32 s43, s38, 0
buffer_load_dwordx4 v2, s[12:15], s43 offen lds
s_add_u32 m0, s40, 87040
s_add_u32 s43, s38, 49152
buffer_load_dwordx4 v3, s[12:15], s43 offen lds
s_add_u32 m0, s40, 88064
s_add_u32 s43, s38, 98304
buffer_load_dwordx4 v2, s[12:15], s43 offen lds
s_add_u32 m0, s40, 89088
s_add_u32 s43, s38, 147456
buffer_load_dwordx4 v3, s[12:15], s43 offen lds
s_add_u32 m0, s40, 90112
s_add_u32 s43, s38, 196608
buffer_load_dwordx4 v2, s[12:15], s43 offen lds
s_add_u32 m0, s40, 91136
s_add_u32 s43, s38, 245760
buffer_load_dwordx4 v3, s[12:15], s43 offen lds
s_add_u32 m0, s40, 92160
s_add_u32 s43, s38, 294912
buffer_load_dwordx4 v2, s[12:15], s43 offen lds
s_add_u32 m0, s40, 93184
s_add_u32 s43, s38, 344064
buffer_load_dwordx4 v3, s[12:15], s43 offen lds
s_add_u32 s37, s37, 128
s_add_u32 s38, s38, 393216
s_load_dword s3, s[4:5], 121920
s_load_dword s3, s[4:5], 121984
s_load_dword s3, s[4:5], 122048
s_load_dword s3, s[4:5], 129024
s_load_dword s3, s[4:5], 129088
s_load_dword s3, s[4:5], 129152
s_load_dword s3, s[4:5], 129216
s_load_dword s3, s[4:5], 136192
s_load_dword s3, s[4:5], 136256
s_waitcnt vmcnt(14)
s_barrier
s_add_u32 m0, s39, 0
s_mov_b64 exec, s[60:61]
buffer_load_dwordx4 v4, s[8:11], s37 offen lds
s_mov_b64 exec, -1
s_add_u32 m0, s39, 3072
s_nop 0
buffer_load_dwordx4 v5, s[8:11], s37 offen lds
s_add_u32 m0, s39, 6144
s_nop 0
buffer_load_dwordx4 v6, s[8:11], s37 offen lds
s_add_u32 m0, s39, 9216
s_nop 0
buffer_load_dwordx4 v7, s[8:11], s37 offen lds
s_add_u32 m0, s39, 12288
s_nop 0
buffer_load_dwordx4 v8, s[8:11], s37 offen lds
s_add_u32 m0, s39, 15360
s_nop 0
buffer_load_dwordx4 v9, s[8:11], s37 offen lds
s_add_u32 m0, s40, 0
s_add_u32 s43, s38, 0
buffer_load_dwordx4 v2, s[12:15], s43 offen lds
s_add_u32 m0, s40, 1024
s_add_u32 s43, s38, 49152
buffer_load_dwordx4 v3, s[12:15], s43 offen lds
s_add_u32 m0, s40, 2048
s_add_u32 s43, s38, 98304
buffer_load_dwordx4 v2, s[12:15], s43 offen lds
s_add_u32 m0, s40, 3072
s_add_u32 s43, s38, 147456
buffer_load_dwordx4 v3, s[12:15], s43 offen lds
s_add_u32 m0, s40, 4096
s_add_u32 s43, s38, 196608
buffer_load_dwordx4 v2, s[12:15], s43 offen lds
s_add_u32 m0, s40, 5120
s_add_u32 s43, s38, 245760
buffer_load_dwordx4 v3, s[12:15], s43 offen lds
s_add_u32 m0, s40, 6144
s_add_u32 s43, s38, 294912
buffer_load_dwordx4 v2, s[12:15], s43 offen lds
s_add_u32 m0, s40, 7168
s_add_u32 s43, s38, 344064
buffer_load_dwordx4 v3, s[12:15], s43 offen lds
s_add_u32 s37, s37, 128
s_add_u32 s38, s38, 393216
s_load_dword s3, s[4:5], 136320
s_load_dword s3, s[4:5], 136384
s_load_dword s3, s[4:5], 143360
s_load_dword s3, s[4:5], 143424
s_load_dword s3, s[4:5], 143488
s_load_dword s3, s[4:5], 143552
s_load_dword s3, s[4:5], 150528
s_load_dword s3, s[4:5], 150592
s_load_dword s3, s[4:5], 150656
s_waitcnt vmcnt(14)
s_barrier
s_load_dword s3, s[4:5], 150720
s_load_dword s3, s[4:5], 157696
s_load_dword s3, s[4:5], 157760
s_load_dword s3, s[4:5], 157824
s_load_dword s3, s[4:5], 157888
s_load_dword s3, s[4:5], 164864
s_load_dword s3, s[4:5], 164928
s_load_dword s3, s[4:5], 164992
s_load_dword s3, s[4:5], 165056
s_waitcnt vmcnt(0)
s_barrier
s_bitcmp0_b32 s2, 0
s_cselect_b32 s88, s72, s74
s_cselect_b32 s89, s73, s75
s_cmp_lt_u32 s2, 192
s_cselect_b32 s90, 7340032, 0
s_mov_b32 s91, 0x20000
s_bfe_u32 s44, s2, 0x30001
s_lshl_b32 s44, s44, 2
s_and_b32 s43, s36, 3
s_add_u32 s44, s44, s43
s_lshl_b32 s44, s44, 5
v_lshrrev_b32 v18, 4, v1
v_add_u32 v18, s44, v18
v_mul_u32_u24 v18, 7168, v18
v_and_b32 v19, 15, v1
v_lshl_add_u32 v18, v19, 4, v18
s_lshr_b32 s43, s2, 4
s_branch Lov_1
.p2align 12
Lst_1_0:
s_branch Lwr_147
s_nop 0
s_nop 0
Lov_1:
s_lshl_b32 s43, s43, 8
s_add_u32 s43, s43, 4096
v_add_u32 v18, s43, v18
s_mov_b32 s43, 0
buffer_load_dwordx4 v[128:131], v18, s[88:91], s43 offen
s_mov_b32 s43, 28672
buffer_load_dwordx4 v[132:135], v18, s[88:91], s43 offen
s_mov_b32 s43, 57344
buffer_load_dwordx4 v[136:139], v18, s[88:91], s43 offen
s_mov_b32 s43, 86016
buffer_load_dwordx4 v[140:143], v18, s[88:91], s43 offen
s_mov_b32 s43, 114688
buffer_load_dwordx4 v[144:147], v18, s[88:91], s43 offen
s_mov_b32 s43, 143360
buffer_load_dwordx4 v[148:151], v18, s[88:91], s43 offen
s_mov_b32 s43, 172032
buffer_load_dwordx4 v[152:155], v18, s[88:91], s43 offen
s_mov_b32 s43, 200704
buffer_load_dwordx4 v[156:159], v18, s[88:91], s43 offen
s_barrier
s_lshl_b32 s43, s35, 7
s_add_u32 s28, s68, s43
s_addc_u32 s29, s69, 0
s_mov_b32 s30, 2095232
s_mov_b32 s31, 0x20000
v_lshrrev_b32 v15, 3, v1
v_and_b32 v16, 6, v15
v_and_b32 v7, 7, v1
v_xor_b32 v7, v7, v16
v_lshlrev_b32 v7, 4, v7
v_mul_u32_u24 v15, 2048, v15
v_add_u32 v7, v7, v15
s_and_b32 s40, s36, 3
s_lshl_b32 s39, s40, 13
s_add_u32 s40, s40, s35
s_add_u32 s42, s40, 0
s_and_b32 s42, s42, 15
s_lshl_b32 s42, s42, 17
s_add_u32 m0, s39, 65536
s_add_u32 s43, s42, 0
buffer_load_dwordx4 v7, s[28:31], s43 offen lds
s_add_u32 m0, s39, 66560
s_add_u32 s43, s42, 16384
buffer_load_dwordx4 v7, s[28:31], s43 offen lds
s_add_u32 m0, s39, 67584
s_add_u32 s43, s42, 32768
buffer_load_dwordx4 v7, s[28:31], s43 offen lds
s_add_u32 m0, s39, 68608
s_add_u32 s43, s42, 49152
buffer_load_dwordx4 v7, s[28:31], s43 offen lds
s_add_u32 m0, s39, 69632
s_add_u32 s43, s42, 65536
buffer_load_dwordx4 v7, s[28:31], s43 offen lds
s_add_u32 m0, s39, 70656
s_add_u32 s43, s42, 81920
buffer_load_dwordx4 v7, s[28:31], s43 offen lds
s_add_u32 m0, s39, 71680
s_add_u32 s43, s42, 98304
buffer_load_dwordx4 v7, s[28:31], s43 offen lds
s_add_u32 m0, s39, 72704
s_add_u32 s43, s42, 114688
buffer_load_dwordx4 v7, s[28:31], s43 offen lds
s_branch Lats_6
Lcons_7:
s_lshl_b32 s43, s35, 7
s_waitcnt lgkmcnt(0)
s_mov_b32 s8, s64
s_mov_b32 s9, s65
s_mov_b32 s10, 4194304
s_mov_b32 s11, 0x20000
s_add_u32 s12, s66, s43
s_addc_u32 s13, s67, 0
s_mov_b32 s14, 6289536
s_mov_b32 s15, 0x20000
s_lshr_b32 s43, s2, 3
s_lshl_b32 s43, s43, 2
s_add_u32 s43, s43, s36
s_sub_u32 s44, s43, 0
s_and_b32 s44, s44, 127
s_cmp_lt_u32 s44, 24
s_cbranch_scc0 Lt_8
s_lshl_b32 s44, s44, 20
s_min_u32 s44, s44, 24117184
s_load_dword s3, s[82:83], s44 glc
Lt_8:
s_sub_u32 s44, s43, 24
s_and_b32 s44, s44, 127
s_cmp_lt_u32 s44, 8
s_cbranch_scc0 Lt_9
s_lshl_b32 s44, s44, 20
s_min_u32 s44, s44, 7339968
s_load_dword s3, s[72:73], s44
Lt_9:
s_sub_u32 s44, s43, 32
s_and_b32 s44, s44, 127
s_cmp_lt_u32 s44, 8
s_cbranch_scc0 Lt_10
s_lshl_b32 s44, s44, 20
s_min_u32 s44, s44, 7339968
s_load_dword s3, s[74:75], s44
Lt_10:
s_sub_u32 s44, s43, 40
s_and_b32 s44, s44, 127
s_cmp_lt_u32 s44, 3
s_cbranch_scc0 Lt_11
s_lshl_b32 s44, s44, 20
s_min_u32 s44, s44, 2097088
s_load_dword s3, s[68:69], s44
Lt_11:
s_sub_u32 s44, s43, 43
s_and_b32 s44, s44, 127
s_cmp_lt_u32 s44, 5
s_cbranch_scc0 Lt_12
s_lshl_b32 s44, s44, 20
s_min_u32 s44, s44, 4194240
s_add_u32 s44, s44, 25165824
s_load_dword s3, s[82:83], s44 glc
Lt_12:
s_sub_u32 s44, s43, 48
s_and_b32 s44, s44, 127
s_cmp_lt_u32 s44, 8
s_cbranch_scc0 Lt_13
s_lshl_b32 s44, s44, 20
s_min_u32 s44, s44, 7339968
s_load_dword s3, s[76:77], s44
Lt_13:
s_sub_u32 s44, s43, 56
s_and_b32 s44, s44, 127
s_cmp_lt_u32 s44, 5
s_cbranch_scc0 Lt_14
s_lshl_b32 s44, s44, 20
s_min_u32 s44, s44, 4194240
s_add_u32 s44, s44, 33554432
s_load_dword s3, s[82:83], s44 glc
Lt_14:
s_sub_u32 s44, s43, 61
s_and_b32 s44, s44, 127
s_cmp_lt_u32 s44, 5
s_cbranch_scc0 Lt_15
s_lshl_b32 s44, s44, 20
s_min_u32 s44, s44, 4194240
s_load_dword s3, s[78:79], s44 glc
Lt_15:
v_lshrrev_b32 v16, 1, v12
v_xor_b32 v15, v13, v16
v_lshlrev_b32 v15, 4, v15
v_lshl_add_u32 v2, v12, 7, v15
v_xor_b32 v3, 64, v2
v_add_u32 v4, 86016, v2
v_add_u32 v5, 86016, v3
v_lshrrev_b32 v15, 2, v12
v_and_b32 v16, 3, v1
v_lshl_add_u32 v19, v13, 3, v15
v_lshlrev_b32 v19, 7, v19
v_and_b32 v15, 2, v15
v_and_b32 v17, 1, v13
v_lshl_add_u32 v15, v17, 2, v15
v_lshrrev_b32 v17, 1, v16
s_lshl_b32 s43, s36, 1
v_add_u32 v17, s43, v17
v_xor_b32 v15, v15, v17
v_lshl_add_u32 v19, v15, 4, v19
v_and_b32 v16, 1, v16
v_lshl_add_u32 v19, v16, 3, v19
v_add_u32 v6, 18432, v19
v_add_u32 v7, 61440, v19
v_add_u32 v8, 104448, v19
s_and_b32 s43, s36, 1
s_bfe_u32 s44, s36, 0x10001
s_lshr_b32 s45, s36, 2
v_lshlrev_b32 v14, 2, v13
v_sub_u32 v14, v12, v14
v_mov_b32 v16, 0xff800000
s_or_b32 s46, s34, s45
s_cmp_lg_u32 s46, 0
s_cselect_b32 s46, 0, 0xff800000
v_subrev_u32 v15, 0, v14
v_cmp_ge_u32 vcc, 7, v15
v_add_u32 v15, 16, v15
s_nop 0
v_cndmask_b32 v248, v16, 0, vcc
v_cmp_ge_u32 vcc, 7, v15
s_nop 1
v_cndmask_b32 v244, v16, 0, vcc
v_or_b32 v240, s46, v244
v_subrev_u32 v15, 1, v14
v_cmp_ge_u32 vcc, 7, v15
v_add_u32 v15, 16, v15
s_nop 0
v_cndmask_b32 v249, v16, 0, vcc
v_cmp_ge_u32 vcc, 7, v15
s_nop 1
v_cndmask_b32 v245, v16, 0, vcc
v_or_b32 v241, s46, v245
v_subrev_u32 v15, 2, v14
v_cmp_ge_u32 vcc, 7, v15
v_add_u32 v15, 16, v15
s_nop 0
v_cndmask_b32 v250, v16, 0, vcc
v_cmp_ge_u32 vcc, 7, v15
s_nop 1
v_cndmask_b32 v246, v16, 0, vcc
v_or_b32 v242, s46, v246
v_subrev_u32 v15, 3, v14
v_cmp_ge_u32 vcc, 7, v15
v_add_u32 v15, 16, v15
s_nop 0
v_cndmask_b32 v251, v16, 0, vcc
v_cmp_ge_u32 vcc, 7, v15
s_nop 1
v_cndmask_b32 v247, v16, 0, vcc
v_or_b32 v243, s46, v247
s_lshl_b32 s46, s45, 6
s_add_u32 s46, s46, s44
s_add_u32 s46, s46, 16
v_lshl_add_u32 v14, v12, 1, s46
s_lshl_b32 s47, s43, 6
v_lshl_add_u32 v15, v13, 4, s47
v_mul_u32_u24 v20, 400, v14
v_add_u32 v20, v20, v15
v_subrev_u32 v16, 32, v14
v_max_i32 v16, 0, v16
v_mul_u32_u24 v21, 400, v16
v_add_u32 v21, v21, v15
v_lshrrev_b32 v16, 2, v12
v_lshl_add_u32 v16, v13, 2, v16
v_lshl_add_u32 v16, v16, 1, s46
v_and_b32 v17, 3, v1
v_lshl_add_u32 v17, v17, 3, s47
v_mul_u32_u24 v22, 400, v16
v_add_u32 v22, v22, v17
v_subrev_u32 v16, 32, v16
v_max_i32 v16, 0, v16
v_mul_u32_u24 v23, 400, v16
v_add_u32 v23, v23, v17
s_mul_i32 s60, s34, 262144
s_add_u32 s16, s82, s60
s_addc_u32 s17, s83, 0
s_mov_b32 s18, 262144
s_mov_b32 s19, 0x20000
s_lshl_b32 s60, s35, 14
s_lshl_b32 s43, s43, 13
s_add_u32 s60, s60, s43
s_lshl_b32 s43, s45, 12
s_add_u32 s60, s60, s43
s_lshl_b32 s43, s44, 10
s_add_u32 s60, s60, s43
v_lshlrev_b32 v24, 4, v1
s_mov_b32 s61, 0x3e8293ee
s_lshl_b32 s38, s35, 7
s_add_u32 s56, s82, 28311552
s_addc_u32 s57, s83, 0
s_mov_b32 s58, 114688
s_mov_b32 s59, 0x20000
s_barrier
ds_read_b128 v[32:35], v2 offset:0
ds_read_b64_tr_b16 v[72:73], v6 offset:8192
ds_read_b64_tr_b16 v[74:75], v6 offset:8704
ds_read_b64_tr_b16 v[76:77], v6 offset:16384
ds_read_b64_tr_b16 v[78:79], v6 offset:16896
ds_read_b64_tr_b16 v[68:69], v6 offset:0
ds_read_b64_tr_b16 v[70:71], v6 offset:512
ds_read_b128 v[36:39], v2 offset:2048
ds_read_b128 v[40:43], v2 offset:4096
ds_read_b128 v[44:47], v2 offset:6144
ds_read_b128 v[48:51], v2 offset:8192
ds_read_b128 v[52:55], v2 offset:10240
ds_read_b128 v[56:59], v2 offset:12288
ds_read_b128 v[60:63], v2 offset:14336
ds_read_b128 v[64:67], v2 offset:16384
s_waitcnt lgkmcnt(0)
v_mfma_f32_16x16x32_bf16 v[164:167], v[72:75], v[32:35], 0
ds_read_b128 v[80:83], v3 offset:0
v_mfma_f32_16x16x32_bf16 v[200:203], v[76:79], v[32:35], 0
ds_read_b64_tr_b16 v[120:121], v6 offset:12288
v_mfma_f32_16x16x32_bf16 v[128:131], v[68:71], v[32:35], 0
ds_read_b64_tr_b16 v[122:123], v6 offset:12800
v_mfma_f32_16x16x32_bf16 v[132:135], v[68:71], v[36:39], 0
ds_read_b64_tr_b16 v[124:125], v6 offset:20480
v_mfma_f32_16x16x32_bf16 v[204:207], v[76:79], v[36:39], 0
ds_read_b64_tr_b16 v[126:127], v6 offset:20992
v_mfma_f32_16x16x32_bf16 v[168:171], v[72:75], v[36:39], 0
ds_read_b64_tr_b16 v[116:117], v6 offset:4096
v_mfma_f32_16x16x32_bf16 v[172:175], v[72:75], v[40:43], 0
ds_read_b64_tr_b16 v[118:119], v6 offset:4608
v_mfma_f32_16x16x32_bf16 v[208:211], v[76:79], v[40:43], 0
ds_read_b128 v[84:87], v3 offset:2048
v_mfma_f32_16x16x32_bf16 v[136:139], v[68:71], v[40:43], 0
ds_read_b128 v[88:91], v3 offset:4096
v_mfma_f32_16x16x32_bf16 v[140:143], v[68:71], v[44:47], 0
ds_read_b128 v[92:95], v3 offset:6144
v_mfma_f32_16x16x32_bf16 v[212:215], v[76:79], v[44:47], 0
ds_read_b128 v[96:99], v3 offset:8192
v_mfma_f32_16x16x32_bf16 v[176:179], v[72:75], v[44:47], 0
ds_read_b128 v[100:103], v3 offset:10240
v_mfma_f32_16x16x32_bf16 v[180:183], v[72:75], v[48:51], 0
ds_read_b128 v[104:107], v3 offset:12288
v_mfma_f32_16x16x32_bf16 v[216:219], v[76:79], v[48:51], 0
ds_read_b128 v[108:111], v3 offset:14336
v_mfma_f32_16x16x32_bf16 v[144:147], v[68:71], v[48:51], 0
ds_read_b128 v[112:115], v3 offset:16384
v_mfma_f32_16x16x32_bf16 v[148:151], v[68:71], v[52:55], 0
v_mfma_f32_16x16x32_bf16 v[220:223], v[76:79], v[52:55], 0
v_mfma_f32_16x16x32_bf16 v[184:187], v[72:75], v[52:55], 0
v_mfma_f32_16x16x32_bf16 v[188:191], v[72:75], v[56:59], 0
v_mfma_f32_16x16x32_bf16 v[224:227], v[76:79], v[56:59], 0
v_mfma_f32_16x16x32_bf16 v[152:155], v[68:71], v[56:59], 0
v_mfma_f32_16x16x32_bf16 v[156:159], v[68:71], v[60:63], 0
v_mfma_f32_16x16x32_bf16 v[228:231], v[76:79], v[60:63], 0
v_mfma_f32_16x16x32_bf16 v[192:195], v[72:75], v[60:63], 0
v_mfma_f32_16x16x32_bf16 v[196:199], v[72:75], v[64:67], 0
v_mfma_f32_16x16x32_bf16 v[232:235], v[76:79], v[64:67], 0
v_mfma_f32_16x16x32_bf16 v[160:163], v[68:71], v[64:67], 0
s_waitcnt lgkmcnt(0)
s_barrier
v_mfma_f32_16x16x32_bf16 v[164:167], v[120:123], v[80:83], v[164:167]
ds_read_b128 v[32:35], v2 offset:43008
v_mfma_f32_16x16x32_bf16 v[200:203], v[124:127], v[80:83], v[200:203]
ds_read_b64_tr_b16 v[72:73], v7 offset:8192
v_mfma_f32_16x16x32_bf16 v[128:131], v[116:119], v[80:83], v[128:131]
ds_read_b64_tr_b16 v[74:75], v7 offset:8704
v_mfma_f32_16x16x32_bf16 v[132:135], v[116:119], v[84:87], v[132:135]
ds_read_b64_tr_b16 v[76:77], v7 offset:16384
v_mfma_f32_16x16x32_bf16 v[204:207], v[124:127], v[84:87], v[204:207]
ds_read_b64_tr_b16 v[78:79], v7 offset:16896
v_mfma_f32_16x16x32_bf16 v[168:171], v[120:123], v[84:87], v[168:171]
ds_read_b64_tr_b16 v[68:69], v7 offset:0
v_mfma_f32_16x16x32_bf16 v[172:175], v[120:123], v[88:91], v[172:175]
ds_read_b64_tr_b16 v[70:71], v7 offset:512
v_mfma_f32_16x16x32_bf16 v[208:211], v[124:127], v[88:91], v[208:211]
ds_read_b128 v[36:39], v2 offset:45056
v_mfma_f32_16x16x32_bf16 v[136:139], v[116:119], v[88:91], v[136:139]
ds_read_b128 v[40:43], v2 offset:47104
v_mfma_f32_16x16x32_bf16 v[140:143], v[116:119], v[92:95], v[140:143]
ds_read_b128 v[44:47], v2 offset:49152
v_mfma_f32_16x16x32_bf16 v[212:215], v[124:127], v[92:95], v[212:215]
ds_read_b128 v[48:51], v2 offset:51200
v_mfma_f32_16x16x32_bf16 v[176:179], v[120:123], v[92:95], v[176:179]
ds_read_b128 v[52:55], v2 offset:53248
v_mfma_f32_16x16x32_bf16 v[180:183], v[120:123], v[96:99], v[180:183]
ds_read_b128 v[56:59], v2 offset:55296
v_mfma_f32_16x16x32_bf16 v[216:219], v[124:127], v[96:99], v[216:219]
ds_read_b128 v[60:63], v2 offset:57344
v_mfma_f32_16x16x32_bf16 v[144:147], v[116:119], v[96:99], v[144:147]
ds_read_b128 v[64:67], v2 offset:59392
v_mfma_f32_16x16x32_bf16 v[148:151], v[116:119], v[100:103], v[148:151]
v_mfma_f32_16x16x32_bf16 v[220:223], v[124:127], v[100:103], v[220:223]
v_mfma_f32_16x16x32_bf16 v[184:187], v[120:123], v[100:103], v[184:187]
v_mfma_f32_16x16x32_bf16 v[188:191], v[120:123], v[104:107], v[188:191]
v_mfma_f32_16x16x32_bf16 v[224:227], v[124:127], v[104:107], v[224:227]
v_mfma_f32_16x16x32_bf16 v[152:155], v[116:119], v[104:107], v[152:155]
v_mfma_f32_16x16x32_bf16 v[156:159], v[116:119], v[108:111], v[156:159]
v_mfma_f32_16x16x32_bf16 v[228:231], v[124:127], v[108:111], v[228:231]
v_mfma_f32_16x16x32_bf16 v[192:195], v[120:123], v[108:111], v[192:195]
v_mfma_f32_16x16x32_bf16 v[196:199], v[120:123], v[112:115], v[196:199]
v_mfma_f32_16x16x32_bf16 v[232:235], v[124:127], v[112:115], v[232:235]
v_mfma_f32_16x16x32_bf16 v[160:163], v[116:119], v[112:115], v[160:163]
s_waitcnt lgkmcnt(0)
v_mfma_f32_16x16x32_bf16 v[164:167], v[72:75], v[32:35], v[164:167]
ds_read_b128 v[80:83], v3 offset:43008
v_mfma_f32_16x16x32_bf16 v[200:203], v[76:79], v[32:35], v[200:203]
ds_read_b64_tr_b16 v[120:121], v7 offset:12288
v_mfma_f32_16x16x32_bf16 v[128:131], v[68:71], v[32:35], v[128:131]
ds_read_b64_tr_b16 v[122:123], v7 offset:12800
v_mfma_f32_16x16x32_bf16 v[132:135], v[68:71], v[36:39], v[132:135]
ds_read_b64_tr_b16 v[124:125], v7 offset:20480
v_mfma_f32_16x16x32_bf16 v[204:207], v[76:79], v[36:39], v[204:207]
ds_read_b64_tr_b16 v[126:127], v7 offset:20992
v_mfma_f32_16x16x32_bf16 v[168:171], v[72:75], v[36:39], v[168:171]
ds_read_b64_tr_b16 v[116:117], v7 offset:4096
v_mfma_f32_16x16x32_bf16 v[172:175], v[72:75], v[40:43], v[172:175]
ds_read_b64_tr_b16 v[118:119], v7 offset:4608
v_mfma_f32_16x16x32_bf16 v[208:211], v[76:79], v[40:43], v[208:211]
ds_read_b128 v[84:87], v3 offset:45056
v_mfma_f32_16x16x32_bf16 v[136:139], v[68:71], v[40:43], v[136:139]
ds_read_b128 v[88:91], v3 offset:47104
v_mfma_f32_16x16x32_bf16 v[140:143], v[68:71], v[44:47], v[140:143]
ds_read_b128 v[92:95], v3 offset:49152
v_mfma_f32_16x16x32_bf16 v[212:215], v[76:79], v[44:47], v[212:215]
ds_read_b128 v[96:99], v3 offset:51200
v_mfma_f32_16x16x32_bf16 v[176:179], v[72:75], v[44:47], v[176:179]
ds_read_b128 v[100:103], v3 offset:53248
v_mfma_f32_16x16x32_bf16 v[180:183], v[72:75], v[48:51], v[180:183]
ds_read_b128 v[104:107], v3 offset:55296
v_mfma_f32_16x16x32_bf16 v[216:219], v[76:79], v[48:51], v[216:219]
ds_read_b128 v[108:111], v3 offset:57344
v_mfma_f32_16x16x32_bf16 v[144:147], v[68:71], v[48:51], v[144:147]
ds_read_b128 v[112:115], v3 offset:59392
v_mfma_f32_16x16x32_bf16 v[148:151], v[68:71], v[52:55], v[148:151]
v_mfma_f32_16x16x32_bf16 v[220:223], v[76:79], v[52:55], v[220:223]
v_mfma_f32_16x16x32_bf16 v[184:187], v[72:75], v[52:55], v[184:187]
v_mfma_f32_16x16x32_bf16 v[188:191], v[72:75], v[56:59], v[188:191]
v_mfma_f32_16x16x32_bf16 v[224:227], v[76:79], v[56:59], v[224:227]
v_mfma_f32_16x16x32_bf16 v[152:155], v[68:71], v[56:59], v[152:155]
v_mfma_f32_16x16x32_bf16 v[156:159], v[68:71], v[60:63], v[156:159]
v_mfma_f32_16x16x32_bf16 v[228:231], v[76:79], v[60:63], v[228:231]
v_mfma_f32_16x16x32_bf16 v[192:195], v[72:75], v[60:63], v[192:195]
v_mfma_f32_16x16x32_bf16 v[196:199], v[72:75], v[64:67], v[196:199]
v_mfma_f32_16x16x32_bf16 v[232:235], v[76:79], v[64:67], v[232:235]
v_mfma_f32_16x16x32_bf16 v[160:163], v[68:71], v[64:67], v[160:163]
s_waitcnt lgkmcnt(0)
s_barrier
v_mfma_f32_16x16x32_bf16 v[164:167], v[120:123], v[80:83], v[164:167]
ds_read_b128 v[32:35], v4 offset:0
v_mfma_f32_16x16x32_bf16 v[200:203], v[124:127], v[80:83], v[200:203]
ds_read_b64_tr_b16 v[72:73], v8 offset:8192
v_mfma_f32_16x16x32_bf16 v[128:131], v[116:119], v[80:83], v[128:131]
ds_read_b64_tr_b16 v[74:75], v8 offset:8704
v_mfma_f32_16x16x32_bf16 v[132:135], v[116:119], v[84:87], v[132:135]
ds_read_b64_tr_b16 v[76:77], v8 offset:16384
v_mfma_f32_16x16x32_bf16 v[204:207], v[124:127], v[84:87], v[204:207]
ds_read_b64_tr_b16 v[78:79], v8 offset:16896
v_mfma_f32_16x16x32_bf16 v[168:171], v[120:123], v[84:87], v[168:171]
ds_read_b64_tr_b16 v[68:69], v8 offset:0
v_mfma_f32_16x16x32_bf16 v[172:175], v[120:123], v[88:91], v[172:175]
ds_read_b64_tr_b16 v[70:71], v8 offset:512
v_mfma_f32_16x16x32_bf16 v[208:211], v[124:127], v[88:91], v[208:211]
ds_read_b128 v[36:39], v4 offset:2048
v_mfma_f32_16x16x32_bf16 v[136:139], v[116:119], v[88:91], v[136:139]
ds_read_b128 v[40:43], v4 offset:4096
v_mfma_f32_16x16x32_bf16 v[140:143], v[116:119], v[92:95], v[140:143]
ds_read_b128 v[44:47], v4 offset:6144
v_mfma_f32_16x16x32_bf16 v[212:215], v[124:127], v[92:95], v[212:215]
ds_read_b128 v[48:51], v4 offset:8192
v_mfma_f32_16x16x32_bf16 v[176:179], v[120:123], v[92:95], v[176:179]
ds_read_b128 v[52:55], v4 offset:10240
v_mfma_f32_16x16x32_bf16 v[180:183], v[120:123], v[96:99], v[180:183]
ds_read_b128 v[56:59], v4 offset:12288
v_mfma_f32_16x16x32_bf16 v[216:219], v[124:127], v[96:99], v[216:219]
ds_read_b128 v[60:63], v4 offset:14336
v_mfma_f32_16x16x32_bf16 v[144:147], v[116:119], v[96:99], v[144:147]
ds_read_b128 v[64:67], v4 offset:16384
v_mfma_f32_16x16x32_bf16 v[148:151], v[116:119], v[100:103], v[148:151]
v_mfma_f32_16x16x32_bf16 v[220:223], v[124:127], v[100:103], v[220:223]
v_mfma_f32_16x16x32_bf16 v[184:187], v[120:123], v[100:103], v[184:187]
v_mfma_f32_16x16x32_bf16 v[188:191], v[120:123], v[104:107], v[188:191]
v_mfma_f32_16x16x32_bf16 v[224:227], v[124:127], v[104:107], v[224:227]
v_mfma_f32_16x16x32_bf16 v[152:155], v[116:119], v[104:107], v[152:155]
v_mfma_f32_16x16x32_bf16 v[156:159], v[116:119], v[108:111], v[156:159]
v_mfma_f32_16x16x32_bf16 v[228:231], v[124:127], v[108:111], v[228:231]
v_mfma_f32_16x16x32_bf16 v[192:195], v[120:123], v[108:111], v[192:195]
v_mfma_f32_16x16x32_bf16 v[196:199], v[120:123], v[112:115], v[196:199]
v_mfma_f32_16x16x32_bf16 v[232:235], v[124:127], v[112:115], v[232:235]
v_mfma_f32_16x16x32_bf16 v[160:163], v[116:119], v[112:115], v[160:163]
s_waitcnt lgkmcnt(0)
v_mfma_f32_16x16x32_bf16 v[164:167], v[72:75], v[32:35], v[164:167]
ds_read_b128 v[80:83], v5 offset:0
v_mfma_f32_16x16x32_bf16 v[200:203], v[76:79], v[32:35], v[200:203]
ds_read_b64_tr_b16 v[120:121], v8 offset:12288
v_mfma_f32_16x16x32_bf16 v[128:131], v[68:71], v[32:35], v[128:131]
ds_read_b64_tr_b16 v[122:123], v8 offset:12800
v_mfma_f32_16x16x32_bf16 v[132:135], v[68:71], v[36:39], v[132:135]
ds_read_b64_tr_b16 v[124:125], v8 offset:20480
v_mfma_f32_16x16x32_bf16 v[204:207], v[76:79], v[36:39], v[204:207]
ds_read_b64_tr_b16 v[126:127], v8 offset:20992
v_mfma_f32_16x16x32_bf16 v[168:171], v[72:75], v[36:39], v[168:171]
ds_read_b64_tr_b16 v[116:117], v8 offset:4096
v_mfma_f32_16x16x32_bf16 v[172:175], v[72:75], v[40:43], v[172:175]
ds_read_b64_tr_b16 v[118:119], v8 offset:4608
v_mfma_f32_16x16x32_bf16 v[208:211], v[76:79], v[40:43], v[208:211]
ds_read_b128 v[84:87], v5 offset:2048
v_mfma_f32_16x16x32_bf16 v[136:139], v[68:71], v[40:43], v[136:139]
ds_read_b128 v[88:91], v5 offset:4096
v_mfma_f32_16x16x32_bf16 v[140:143], v[68:71], v[44:47], v[140:143]
ds_read_b128 v[92:95], v5 offset:6144
v_mfma_f32_16x16x32_bf16 v[212:215], v[76:79], v[44:47], v[212:215]
ds_read_b128 v[96:99], v5 offset:8192
v_mfma_f32_16x16x32_bf16 v[176:179], v[72:75], v[44:47], v[176:179]
ds_read_b128 v[100:103], v5 offset:10240
v_mfma_f32_16x16x32_bf16 v[180:183], v[72:75], v[48:51], v[180:183]
ds_read_b128 v[104:107], v5 offset:12288
v_mfma_f32_16x16x32_bf16 v[216:219], v[76:79], v[48:51], v[216:219]
ds_read_b128 v[108:111], v5 offset:14336
v_mfma_f32_16x16x32_bf16 v[144:147], v[68:71], v[48:51], v[144:147]
ds_read_b128 v[112:115], v5 offset:16384
v_mfma_f32_16x16x32_bf16 v[148:151], v[68:71], v[52:55], v[148:151]
v_mfma_f32_16x16x32_bf16 v[220:223], v[76:79], v[52:55], v[220:223]
v_mfma_f32_16x16x32_bf16 v[184:187], v[72:75], v[52:55], v[184:187]
v_mfma_f32_16x16x32_bf16 v[188:191], v[72:75], v[56:59], v[188:191]
v_mfma_f32_16x16x32_bf16 v[224:227], v[76:79], v[56:59], v[224:227]
v_mfma_f32_16x16x32_bf16 v[152:155], v[68:71], v[56:59], v[152:155]
v_mfma_f32_16x16x32_bf16 v[156:159], v[68:71], v[60:63], v[156:159]
v_mfma_f32_16x16x32_bf16 v[228:231], v[76:79], v[60:63], v[228:231]
v_mfma_f32_16x16x32_bf16 v[192:195], v[72:75], v[60:63], v[192:195]
v_mfma_f32_16x16x32_bf16 v[196:199], v[72:75], v[64:67], v[196:199]
v_mfma_f32_16x16x32_bf16 v[232:235], v[76:79], v[64:67], v[232:235]
v_mfma_f32_16x16x32_bf16 v[160:163], v[68:71], v[64:67], v[160:163]
s_waitcnt lgkmcnt(0)
s_barrier
v_mfma_f32_16x16x32_bf16 v[164:167], v[120:123], v[80:83], v[164:167]
ds_read_b128 v[32:35], v2 offset:0
v_mfma_f32_16x16x32_bf16 v[200:203], v[124:127], v[80:83], v[200:203]
ds_read_b64_tr_b16 v[72:73], v6 offset:8192
v_mfma_f32_16x16x32_bf16 v[128:131], v[116:119], v[80:83], v[128:131]
ds_read_b64_tr_b16 v[74:75], v6 offset:8704
v_mfma_f32_16x16x32_bf16 v[132:135], v[116:119], v[84:87], v[132:135]
ds_read_b64_tr_b16 v[76:77], v6 offset:16384
v_mfma_f32_16x16x32_bf16 v[204:207], v[124:127], v[84:87], v[204:207]
ds_read_b64_tr_b16 v[78:79], v6 offset:16896
v_mfma_f32_16x16x32_bf16 v[168:171], v[120:123], v[84:87], v[168:171]
ds_read_b64_tr_b16 v[68:69], v6 offset:0
v_mfma_f32_16x16x32_bf16 v[172:175], v[120:123], v[88:91], v[172:175]
ds_read_b64_tr_b16 v[70:71], v6 offset:512
v_mfma_f32_16x16x32_bf16 v[208:211], v[124:127], v[88:91], v[208:211]
ds_read_b128 v[36:39], v2 offset:2048
v_mfma_f32_16x16x32_bf16 v[136:139], v[116:119], v[88:91], v[136:139]
ds_read_b128 v[40:43], v2 offset:4096
v_mfma_f32_16x16x32_bf16 v[140:143], v[116:119], v[92:95], v[140:143]
ds_read_b128 v[44:47], v2 offset:6144
v_mfma_f32_16x16x32_bf16 v[212:215], v[124:127], v[92:95], v[212:215]
ds_read_b128 v[48:51], v2 offset:8192
v_mfma_f32_16x16x32_bf16 v[176:179], v[120:123], v[92:95], v[176:179]
ds_read_b128 v[52:55], v2 offset:10240
v_mfma_f32_16x16x32_bf16 v[180:183], v[120:123], v[96:99], v[180:183]
ds_read_b128 v[56:59], v2 offset:12288
v_mfma_f32_16x16x32_bf16 v[216:219], v[124:127], v[96:99], v[216:219]
ds_read_b128 v[60:63], v2 offset:14336
v_mfma_f32_16x16x32_bf16 v[144:147], v[116:119], v[96:99], v[144:147]
ds_read_b128 v[64:67], v2 offset:16384
v_mfma_f32_16x16x32_bf16 v[148:151], v[116:119], v[100:103], v[148:151]
v_mfma_f32_16x16x32_bf16 v[220:223], v[124:127], v[100:103], v[220:223]
v_mfma_f32_16x16x32_bf16 v[184:187], v[120:123], v[100:103], v[184:187]
v_mfma_f32_16x16x32_bf16 v[188:191], v[120:123], v[104:107], v[188:191]
v_mfma_f32_16x16x32_bf16 v[224:227], v[124:127], v[104:107], v[224:227]
v_mfma_f32_16x16x32_bf16 v[152:155], v[116:119], v[104:107], v[152:155]
v_mfma_f32_16x16x32_bf16 v[156:159], v[116:119], v[108:111], v[156:159]
v_mfma_f32_16x16x32_bf16 v[228:231], v[124:127], v[108:111], v[228:231]
v_mfma_f32_16x16x32_bf16 v[192:195], v[120:123], v[108:111], v[192:195]
v_mfma_f32_16x16x32_bf16 v[196:199], v[120:123], v[112:115], v[196:199]
v_mfma_f32_16x16x32_bf16 v[232:235], v[124:127], v[112:115], v[232:235]
v_mfma_f32_16x16x32_bf16 v[160:163], v[116:119], v[112:115], v[160:163]
s_mov_b32 s41, 4
Lcl_16:
s_waitcnt lgkmcnt(0)
v_mfma_f32_16x16x32_bf16 v[164:167], v[72:75], v[32:35], v[164:167]
ds_read_b128 v[80:83], v3 offset:0
v_mfma_f32_16x16x32_bf16 v[200:203], v[76:79], v[32:35], v[200:203]
ds_read_b64_tr_b16 v[120:121], v6 offset:12288
v_mfma_f32_16x16x32_bf16 v[128:131], v[68:71], v[32:35], v[128:131]
ds_read_b64_tr_b16 v[122:123], v6 offset:12800
v_mfma_f32_16x16x32_bf16 v[132:135], v[68:71], v[36:39], v[132:135]
ds_read_b64_tr_b16 v[124:125], v6 offset:20480
v_mfma_f32_16x16x32_bf16 v[204:207], v[76:79], v[36:39], v[204:207]
ds_read_b64_tr_b16 v[126:127], v6 offset:20992
v_mfma_f32_16x16x32_bf16 v[168:171], v[72:75], v[36:39], v[168:171]
ds_read_b64_tr_b16 v[116:117], v6 offset:4096
v_mfma_f32_16x16x32_bf16 v[172:175], v[72:75], v[40:43], v[172:175]
ds_read_b64_tr_b16 v[118:119], v6 offset:4608
v_mfma_f32_16x16x32_bf16 v[208:211], v[76:79], v[40:43], v[208:211]
ds_read_b128 v[84:87], v3 offset:2048
v_mfma_f32_16x16x32_bf16 v[136:139], v[68:71], v[40:43], v[136:139]
ds_read_b128 v[88:91], v3 offset:4096
v_mfma_f32_16x16x32_bf16 v[140:143], v[68:71], v[44:47], v[140:143]
ds_read_b128 v[92:95], v3 offset:6144
v_mfma_f32_16x16x32_bf16 v[212:215], v[76:79], v[44:47], v[212:215]
ds_read_b128 v[96:99], v3 offset:8192
v_mfma_f32_16x16x32_bf16 v[176:179], v[72:75], v[44:47], v[176:179]
ds_read_b128 v[100:103], v3 offset:10240
v_mfma_f32_16x16x32_bf16 v[180:183], v[72:75], v[48:51], v[180:183]
ds_read_b128 v[104:107], v3 offset:12288
v_mfma_f32_16x16x32_bf16 v[216:219], v[76:79], v[48:51], v[216:219]
ds_read_b128 v[108:111], v3 offset:14336
v_mfma_f32_16x16x32_bf16 v[144:147], v[68:71], v[48:51], v[144:147]
ds_read_b128 v[112:115], v3 offset:16384
v_mfma_f32_16x16x32_bf16 v[148:151], v[68:71], v[52:55], v[148:151]
v_mfma_f32_16x16x32_bf16 v[220:223], v[76:79], v[52:55], v[220:223]
v_mfma_f32_16x16x32_bf16 v[184:187], v[72:75], v[52:55], v[184:187]
v_mfma_f32_16x16x32_bf16 v[188:191], v[72:75], v[56:59], v[188:191]
v_mfma_f32_16x16x32_bf16 v[224:227], v[76:79], v[56:59], v[224:227]
v_mfma_f32_16x16x32_bf16 v[152:155], v[68:71], v[56:59], v[152:155]
v_mfma_f32_16x16x32_bf16 v[156:159], v[68:71], v[60:63], v[156:159]
v_mfma_f32_16x16x32_bf16 v[228:231], v[76:79], v[60:63], v[228:231]
v_mfma_f32_16x16x32_bf16 v[192:195], v[72:75], v[60:63], v[192:195]
v_mfma_f32_16x16x32_bf16 v[196:199], v[72:75], v[64:67], v[196:199]
v_mfma_f32_16x16x32_bf16 v[232:235], v[76:79], v[64:67], v[232:235]
v_mfma_f32_16x16x32_bf16 v[160:163], v[68:71], v[64:67], v[160:163]
s_waitcnt lgkmcnt(0)
s_barrier
v_mfma_f32_16x16x32_bf16 v[164:167], v[120:123], v[80:83], v[164:167]
ds_read_b128 v[32:35], v2 offset:43008
v_mfma_f32_16x16x32_bf16 v[200:203], v[124:127], v[80:83], v[200:203]
ds_read_b64_tr_b16 v[72:73], v7 offset:8192
v_mfma_f32_16x16x32_bf16 v[128:131], v[116:119], v[80:83], v[128:131]
ds_read_b64_tr_b16 v[74:75], v7 offset:8704
v_mfma_f32_16x16x32_bf16 v[132:135], v[116:119], v[84:87], v[132:135]
ds_read_b64_tr_b16 v[76:77], v7 offset:16384
v_mfma_f32_16x16x32_bf16 v[204:207], v[124:127], v[84:87], v[204:207]
ds_read_b64_tr_b16 v[78:79], v7 offset:16896
v_mfma_f32_16x16x32_bf16 v[168:171], v[120:123], v[84:87], v[168:171]
ds_read_b64_tr_b16 v[68:69], v7 offset:0
v_mfma_f32_16x16x32_bf16 v[172:175], v[120:123], v[88:91], v[172:175]
ds_read_b64_tr_b16 v[70:71], v7 offset:512
v_mfma_f32_16x16x32_bf16 v[208:211], v[124:127], v[88:91], v[208:211]
ds_read_b128 v[36:39], v2 offset:45056
v_mfma_f32_16x16x32_bf16 v[136:139], v[116:119], v[88:91], v[136:139]
s_branch Lov_2
.p2align 12
.fill 16, 4, 0xbf800000
Lst_2_0:
s_branch Lwr_148
s_nop 0
s_nop 0
Lov_2:
ds_read_b128 v[40:43], v2 offset:47104
v_mfma_f32_16x16x32_bf16 v[140:143], v[116:119], v[92:95], v[140:143]
ds_read_b128 v[44:47], v2 offset:49152
v_mfma_f32_16x16x32_bf16 v[212:215], v[124:127], v[92:95], v[212:215]
ds_read_b128 v[48:51], v2 offset:51200
v_mfma_f32_16x16x32_bf16 v[176:179], v[120:123], v[92:95], v[176:179]
ds_read_b128 v[52:55], v2 offset:53248
v_mfma_f32_16x16x32_bf16 v[180:183], v[120:123], v[96:99], v[180:183]
ds_read_b128 v[56:59], v2 offset:55296
v_mfma_f32_16x16x32_bf16 v[216:219], v[124:127], v[96:99], v[216:219]
ds_read_b128 v[60:63], v2 offset:57344
v_mfma_f32_16x16x32_bf16 v[144:147], v[116:119], v[96:99], v[144:147]
ds_read_b128 v[64:67], v2 offset:59392
v_mfma_f32_16x16x32_bf16 v[148:151], v[116:119], v[100:103], v[148:151]
v_mfma_f32_16x16x32_bf16 v[220:223], v[124:127], v[100:103], v[220:223]
v_mfma_f32_16x16x32_bf16 v[184:187], v[120:123], v[100:103], v[184:187]
v_mfma_f32_16x16x32_bf16 v[188:191], v[120:123], v[104:107], v[188:191]
v_mfma_f32_16x16x32_bf16 v[224:227], v[124:127], v[104:107], v[224:227]
v_mfma_f32_16x16x32_bf16 v[152:155], v[116:119], v[104:107], v[152:155]
v_mfma_f32_16x16x32_bf16 v[156:159], v[116:119], v[108:111], v[156:159]
v_mfma_f32_16x16x32_bf16 v[228:231], v[124:127], v[108:111], v[228:231]
v_mfma_f32_16x16x32_bf16 v[192:195], v[120:123], v[108:111], v[192:195]
v_mfma_f32_16x16x32_bf16 v[196:199], v[120:123], v[112:115], v[196:199]
v_mfma_f32_16x16x32_bf16 v[232:235], v[124:127], v[112:115], v[232:235]
v_mfma_f32_16x16x32_bf16 v[160:163], v[116:119], v[112:115], v[160:163]
s_waitcnt lgkmcnt(0)
v_mfma_f32_16x16x32_bf16 v[164:167], v[72:75], v[32:35], v[164:167]
ds_read_b128 v[80:83], v3 offset:43008
v_mfma_f32_16x16x32_bf16 v[200:203], v[76:79], v[32:35], v[200:203]
ds_read_b64_tr_b16 v[120:121], v7 offset:12288
v_mfma_f32_16x16x32_bf16 v[128:131], v[68:71], v[32:35], v[128:131]
ds_read_b64_tr_b16 v[122:123], v7 offset:12800
v_mfma_f32_16x16x32_bf16 v[132:135], v[68:71], v[36:39], v[132:135]
ds_read_b64_tr_b16 v[124:125], v7 offset:20480
v_mfma_f32_16x16x32_bf16 v[204:207], v[76:79], v[36:39], v[204:207]
ds_read_b64_tr_b16 v[126:127], v7 offset:20992
v_mfma_f32_16x16x32_bf16 v[168:171], v[72:75], v[36:39], v[168:171]
ds_read_b64_tr_b16 v[116:117], v7 offset:4096
v_mfma_f32_16x16x32_bf16 v[172:175], v[72:75], v[40:43], v[172:175]
ds_read_b64_tr_b16 v[118:119], v7 offset:4608
v_mfma_f32_16x16x32_bf16 v[208:211], v[76:79], v[40:43], v[208:211]
ds_read_b128 v[84:87], v3 offset:45056
v_mfma_f32_16x16x32_bf16 v[136:139], v[68:71], v[40:43], v[136:139]
ds_read_b128 v[88:91], v3 offset:47104
v_mfma_f32_16x16x32_bf16 v[140:143], v[68:71], v[44:47], v[140:143]
ds_read_b128 v[92:95], v3 offset:49152
v_mfma_f32_16x16x32_bf16 v[212:215], v[76:79], v[44:47], v[212:215]
ds_read_b128 v[96:99], v3 offset:51200
v_mfma_f32_16x16x32_bf16 v[176:179], v[72:75], v[44:47], v[176:179]
ds_read_b128 v[100:103], v3 offset:53248
v_mfma_f32_16x16x32_bf16 v[180:183], v[72:75], v[48:51], v[180:183]
ds_read_b128 v[104:107], v3 offset:55296
v_mfma_f32_16x16x32_bf16 v[216:219], v[76:79], v[48:51], v[216:219]
ds_read_b128 v[108:111], v3 offset:57344
v_mfma_f32_16x16x32_bf16 v[144:147], v[68:71], v[48:51], v[144:147]
ds_read_b128 v[112:115], v3 offset:59392
v_mfma_f32_16x16x32_bf16 v[148:151], v[68:71], v[52:55], v[148:151]
v_mfma_f32_16x16x32_bf16 v[220:223], v[76:79], v[52:55], v[220:223]
v_mfma_f32_16x16x32_bf16 v[184:187], v[72:75], v[52:55], v[184:187]
v_mfma_f32_16x16x32_bf16 v[188:191], v[72:75], v[56:59], v[188:191]
v_mfma_f32_16x16x32_bf16 v[224:227], v[76:79], v[56:59], v[224:227]
v_mfma_f32_16x16x32_bf16 v[152:155], v[68:71], v[56:59], v[152:155]
v_mfma_f32_16x16x32_bf16 v[156:159], v[68:71], v[60:63], v[156:159]
v_mfma_f32_16x16x32_bf16 v[228:231], v[76:79], v[60:63], v[228:231]
v_mfma_f32_16x16x32_bf16 v[192:195], v[72:75], v[60:63], v[192:195]
v_mfma_f32_16x16x32_bf16 v[196:199], v[72:75], v[64:67], v[196:199]
v_mfma_f32_16x16x32_bf16 v[232:235], v[76:79], v[64:67], v[232:235]
v_mfma_f32_16x16x32_bf16 v[160:163], v[68:71], v[64:67], v[160:163]
s_waitcnt lgkmcnt(0)
s_barrier
v_mfma_f32_16x16x32_bf16 v[164:167], v[120:123], v[80:83], v[164:167]
ds_read_b128 v[32:35], v4 offset:0
v_mfma_f32_16x16x32_bf16 v[200:203], v[124:127], v[80:83], v[200:203]
ds_read_b64_tr_b16 v[72:73], v8 offset:8192
v_mfma_f32_16x16x32_bf16 v[128:131], v[116:119], v[80:83], v[128:131]
ds_read_b64_tr_b16 v[74:75], v8 offset:8704
v_mfma_f32_16x16x32_bf16 v[132:135], v[116:119], v[84:87], v[132:135]
ds_read_b64_tr_b16 v[76:77], v8 offset:16384
v_mfma_f32_16x16x32_bf16 v[204:207], v[124:127], v[84:87], v[204:207]
ds_read_b64_tr_b16 v[78:79], v8 offset:16896
v_mfma_f32_16x16x32_bf16 v[168:171], v[120:123], v[84:87], v[168:171]
ds_read_b64_tr_b16 v[68:69], v8 offset:0
v_mfma_f32_16x16x32_bf16 v[172:175], v[120:123], v[88:91], v[172:175]
ds_read_b64_tr_b16 v[70:71], v8 offset:512
v_mfma_f32_16x16x32_bf16 v[208:211], v[124:127], v[88:91], v[208:211]
ds_read_b128 v[36:39], v4 offset:2048
v_mfma_f32_16x16x32_bf16 v[136:139], v[116:119], v[88:91], v[136:139]
ds_read_b128 v[40:43], v4 offset:4096
v_mfma_f32_16x16x32_bf16 v[140:143], v[116:119], v[92:95], v[140:143]
ds_read_b128 v[44:47], v4 offset:6144
v_mfma_f32_16x16x32_bf16 v[212:215], v[124:127], v[92:95], v[212:215]
ds_read_b128 v[48:51], v4 offset:8192
v_mfma_f32_16x16x32_bf16 v[176:179], v[120:123], v[92:95], v[176:179]
ds_read_b128 v[52:55], v4 offset:10240
v_mfma_f32_16x16x32_bf16 v[180:183], v[120:123], v[96:99], v[180:183]
ds_read_b128 v[56:59], v4 offset:12288
v_mfma_f32_16x16x32_bf16 v[216:219], v[124:127], v[96:99], v[216:219]
ds_read_b128 v[60:63], v4 offset:14336
v_mfma_f32_16x16x32_bf16 v[144:147], v[116:119], v[96:99], v[144:147]
ds_read_b128 v[64:67], v4 offset:16384
v_mfma_f32_16x16x32_bf16 v[148:151], v[116:119], v[100:103], v[148:151]
v_mfma_f32_16x16x32_bf16 v[220:223], v[124:127], v[100:103], v[220:223]
v_mfma_f32_16x16x32_bf16 v[184:187], v[120:123], v[100:103], v[184:187]
v_mfma_f32_16x16x32_bf16 v[188:191], v[120:123], v[104:107], v[188:191]
v_mfma_f32_16x16x32_bf16 v[224:227], v[124:127], v[104:107], v[224:227]
v_mfma_f32_16x16x32_bf16 v[152:155], v[116:119], v[104:107], v[152:155]
v_mfma_f32_16x16x32_bf16 v[156:159], v[116:119], v[108:111], v[156:159]
v_mfma_f32_16x16x32_bf16 v[228:231], v[124:127], v[108:111], v[228:231]
v_mfma_f32_16x16x32_bf16 v[192:195], v[120:123], v[108:111], v[192:195]
v_mfma_f32_16x16x32_bf16 v[196:199], v[120:123], v[112:115], v[196:199]
v_mfma_f32_16x16x32_bf16 v[232:235], v[124:127], v[112:115], v[232:235]
v_mfma_f32_16x16x32_bf16 v[160:163], v[116:119], v[112:115], v[160:163]
s_waitcnt lgkmcnt(0)
v_mfma_f32_16x16x32_bf16 v[164:167], v[72:75], v[32:35], v[164:167]
ds_read_b128 v[80:83], v5 offset:0
v_mfma_f32_16x16x32_bf16 v[200:203], v[76:79], v[32:35], v[200:203]
ds_read_b64_tr_b16 v[120:121], v8 offset:12288
v_mfma_f32_16x16x32_bf16 v[128:131], v[68:71], v[32:35], v[128:131]
ds_read_b64_tr_b16 v[122:123], v8 offset:12800
v_mfma_f32_16x16x32_bf16 v[132:135], v[68:71], v[36:39], v[132:135]
ds_read_b64_tr_b16 v[124:125], v8 offset:20480
v_mfma_f32_16x16x32_bf16 v[204:207], v[76:79], v[36:39], v[204:207]
ds_read_b64_tr_b16 v[126:127], v8 offset:20992
v_mfma_f32_16x16x32_bf16 v[168:171], v[72:75], v[36:39], v[168:171]
ds_read_b64_tr_b16 v[116:117], v8 offset:4096
v_mfma_f32_16x16x32_bf16 v[172:175], v[72:75], v[40:43], v[172:175]
ds_read_b64_tr_b16 v[118:119], v8 offset:4608
v_mfma_f32_16x16x32_bf16 v[208:211], v[76:79], v[40:43], v[208:211]
ds_read_b128 v[84:87], v5 offset:2048
v_mfma_f32_16x16x32_bf16 v[136:139], v[68:71], v[40:43], v[136:139]
ds_read_b128 v[88:91], v5 offset:4096
v_mfma_f32_16x16x32_bf16 v[140:143], v[68:71], v[44:47], v[140:143]
ds_read_b128 v[92:95], v5 offset:6144
v_mfma_f32_16x16x32_bf16 v[212:215], v[76:79], v[44:47], v[212:215]
ds_read_b128 v[96:99], v5 offset:8192
v_mfma_f32_16x16x32_bf16 v[176:179], v[72:75], v[44:47], v[176:179]
ds_read_b128 v[100:103], v5 offset:10240
v_mfma_f32_16x16x32_bf16 v[180:183], v[72:75], v[48:51], v[180:183]
ds_read_b128 v[104:107], v5 offset:12288
v_mfma_f32_16x16x32_bf16 v[216:219], v[76:79], v[48:51], v[216:219]
ds_read_b128 v[108:111], v5 offset:14336
v_mfma_f32_16x16x32_bf16 v[144:147], v[68:71], v[48:51], v[144:147]
ds_read_b128 v[112:115], v5 offset:16384
v_mfma_f32_16x16x32_bf16 v[148:151], v[68:71], v[52:55], v[148:151]
v_mfma_f32_16x16x32_bf16 v[220:223], v[76:79], v[52:55], v[220:223]
v_mfma_f32_16x16x32_bf16 v[184:187], v[72:75], v[52:55], v[184:187]
v_mfma_f32_16x16x32_bf16 v[188:191], v[72:75], v[56:59], v[188:191]
v_mfma_f32_16x16x32_bf16 v[224:227], v[76:79], v[56:59], v[224:227]
v_mfma_f32_16x16x32_bf16 v[152:155], v[68:71], v[56:59], v[152:155]
v_mfma_f32_16x16x32_bf16 v[156:159], v[68:71], v[60:63], v[156:159]
v_mfma_f32_16x16x32_bf16 v[228:231], v[76:79], v[60:63], v[228:231]
v_mfma_f32_16x16x32_bf16 v[192:195], v[72:75], v[60:63], v[192:195]
v_mfma_f32_16x16x32_bf16 v[196:199], v[72:75], v[64:67], v[196:199]
v_mfma_f32_16x16x32_bf16 v[232:235], v[76:79], v[64:67], v[232:235]
v_mfma_f32_16x16x32_bf16 v[160:163], v[68:71], v[64:67], v[160:163]
s_waitcnt lgkmcnt(0)
s_barrier
v_mfma_f32_16x16x32_bf16 v[164:167], v[120:123], v[80:83], v[164:167]
ds_read_b128 v[32:35], v2 offset:0
v_mfma_f32_16x16x32_bf16 v[200:203], v[124:127], v[80:83], v[200:203]
ds_read_b64_tr_b16 v[72:73], v6 offset:8192
v_mfma_f32_16x16x32_bf16 v[128:131], v[116:119], v[80:83], v[128:131]
ds_read_b64_tr_b16 v[74:75], v6 offset:8704
v_mfma_f32_16x16x32_bf16 v[132:135], v[116:119], v[84:87], v[132:135]
ds_read_b64_tr_b16 v[76:77], v6 offset:16384
v_mfma_f32_16x16x32_bf16 v[204:207], v[124:127], v[84:87], v[204:207]
ds_read_b64_tr_b16 v[78:79], v6 offset:16896
v_mfma_f32_16x16x32_bf16 v[168:171], v[120:123], v[84:87], v[168:171]
ds_read_b64_tr_b16 v[68:69], v6 offset:0
v_mfma_f32_16x16x32_bf16 v[172:175], v[120:123], v[88:91], v[172:175]
ds_read_b64_tr_b16 v[70:71], v6 offset:512
v_mfma_f32_16x16x32_bf16 v[208:211], v[124:127], v[88:91], v[208:211]
ds_read_b128 v[36:39], v2 offset:2048
v_mfma_f32_16x16x32_bf16 v[136:139], v[116:119], v[88:91], v[136:139]
ds_read_b128 v[40:43], v2 offset:4096
v_mfma_f32_16x16x32_bf16 v[140:143], v[116:119], v[92:95], v[140:143]
ds_read_b128 v[44:47], v2 offset:6144
v_mfma_f32_16x16x32_bf16 v[212:215], v[124:127], v[92:95], v[212:215]
ds_read_b128 v[48:51], v2 offset:8192
v_mfma_f32_16x16x32_bf16 v[176:179], v[120:123], v[92:95], v[176:179]
ds_read_b128 v[52:55], v2 offset:10240
v_mfma_f32_16x16x32_bf16 v[180:183], v[120:123], v[96:99], v[180:183]
ds_read_b128 v[56:59], v2 offset:12288
v_mfma_f32_16x16x32_bf16 v[216:219], v[124:127], v[96:99], v[216:219]
ds_read_b128 v[60:63], v2 offset:14336
v_mfma_f32_16x16x32_bf16 v[144:147], v[116:119], v[96:99], v[144:147]
ds_read_b128 v[64:67], v2 offset:16384
v_mfma_f32_16x16x32_bf16 v[148:151], v[116:119], v[100:103], v[148:151]
v_mfma_f32_16x16x32_bf16 v[220:223], v[124:127], v[100:103], v[220:223]
v_mfma_f32_16x16x32_bf16 v[184:187], v[120:123], v[100:103], v[184:187]
v_mfma_f32_16x16x32_bf16 v[188:191], v[120:123], v[104:107], v[188:191]
v_mfma_f32_16x16x32_bf16 v[224:227], v[124:127], v[104:107], v[224:227]
v_mfma_f32_16x16x32_bf16 v[152:155], v[116:119], v[104:107], v[152:155]
v_mfma_f32_16x16x32_bf16 v[156:159], v[116:119], v[108:111], v[156:159]
v_mfma_f32_16x16x32_bf16 v[228:231], v[124:127], v[108:111], v[228:231]
v_mfma_f32_16x16x32_bf16 v[192:195], v[120:123], v[108:111], v[192:195]
v_mfma_f32_16x16x32_bf16 v[196:199], v[120:123], v[112:115], v[196:199]
v_mfma_f32_16x16x32_bf16 v[232:235], v[124:127], v[112:115], v[232:235]
v_mfma_f32_16x16x32_bf16 v[160:163], v[116:119], v[112:115], v[160:163]
s_sub_u32 s41, s41, 1
s_cmp_lg_u32 s41, 0
s_cbranch_scc1 Lcl_16
s_waitcnt lgkmcnt(0)
v_mfma_f32_16x16x32_bf16 v[164:167], v[72:75], v[32:35], v[164:167]
ds_read_b128 v[80:83], v3 offset:0
v_mfma_f32_16x16x32_bf16 v[200:203], v[76:79], v[32:35], v[200:203]
ds_read_b64_tr_b16 v[120:121], v6 offset:12288
v_mfma_f32_16x16x32_bf16 v[128:131], v[68:71], v[32:35], v[128:131]
ds_read_b64_tr_b16 v[122:123], v6 offset:12800
v_mfma_f32_16x16x32_bf16 v[132:135], v[68:71], v[36:39], v[132:135]
ds_read_b64_tr_b16 v[124:125], v6 offset:20480
v_mfma_f32_16x16x32_bf16 v[204:207], v[76:79], v[36:39], v[204:207]
ds_read_b64_tr_b16 v[126:127], v6 offset:20992
v_mfma_f32_16x16x32_bf16 v[168:171], v[72:75], v[36:39], v[168:171]
ds_read_b64_tr_b16 v[116:117], v6 offset:4096
v_mfma_f32_16x16x32_bf16 v[172:175], v[72:75], v[40:43], v[172:175]
ds_read_b64_tr_b16 v[118:119], v6 offset:4608
v_mfma_f32_16x16x32_bf16 v[208:211], v[76:79], v[40:43], v[208:211]
ds_read_b128 v[84:87], v3 offset:2048
v_mfma_f32_16x16x32_bf16 v[136:139], v[68:71], v[40:43], v[136:139]
ds_read_b128 v[88:91], v3 offset:4096
v_mfma_f32_16x16x32_bf16 v[140:143], v[68:71], v[44:47], v[140:143]
ds_read_b128 v[92:95], v3 offset:6144
v_mfma_f32_16x16x32_bf16 v[212:215], v[76:79], v[44:47], v[212:215]
ds_read_b128 v[96:99], v3 offset:8192
v_mfma_f32_16x16x32_bf16 v[176:179], v[72:75], v[44:47], v[176:179]
ds_read_b128 v[100:103], v3 offset:10240
v_mfma_f32_16x16x32_bf16 v[180:183], v[72:75], v[48:51], v[180:183]
ds_read_b128 v[104:107], v3 offset:12288
v_mfma_f32_16x16x32_bf16 v[216:219], v[76:79], v[48:51], v[216:219]
ds_read_b128 v[108:111], v3 offset:14336
v_mfma_f32_16x16x32_bf16 v[144:147], v[68:71], v[48:51], v[144:147]
ds_read_b128 v[112:115], v3 offset:16384
v_mfma_f32_16x16x32_bf16 v[148:151], v[68:71], v[52:55], v[148:151]
v_mfma_f32_16x16x32_bf16 v[220:223], v[76:79], v[52:55], v[220:223]
v_mfma_f32_16x16x32_bf16 v[184:187], v[72:75], v[52:55], v[184:187]
v_mfma_f32_16x16x32_bf16 v[188:191], v[72:75], v[56:59], v[188:191]
v_mfma_f32_16x16x32_bf16 v[224:227], v[76:79], v[56:59], v[224:227]
v_mfma_f32_16x16x32_bf16 v[152:155], v[68:71], v[56:59], v[152:155]
v_mfma_f32_16x16x32_bf16 v[156:159], v[68:71], v[60:63], v[156:159]
v_mfma_f32_16x16x32_bf16 v[228:231], v[76:79], v[60:63], v[228:231]
v_mfma_f32_16x16x32_bf16 v[192:195], v[72:75], v[60:63], v[192:195]
v_mfma_f32_16x16x32_bf16 v[196:199], v[72:75], v[64:67], v[196:199]
v_mfma_f32_16x16x32_bf16 v[232:235], v[76:79], v[64:67], v[232:235]
v_mfma_f32_16x16x32_bf16 v[160:163], v[68:71], v[64:67], v[160:163]
s_waitcnt lgkmcnt(0)
v_mfma_f32_16x16x32_bf16 v[164:167], v[120:123], v[80:83], v[164:167]
v_mfma_f32_16x16x32_bf16 v[200:203], v[124:127], v[80:83], v[200:203]
v_mfma_f32_16x16x32_bf16 v[128:131], v[116:119], v[80:83], v[128:131]
v_mfma_f32_16x16x32_bf16 v[132:135], v[116:119], v[84:87], v[132:135]
v_mfma_f32_16x16x32_bf16 v[204:207], v[124:127], v[84:87], v[204:207]
v_mfma_f32_16x16x32_bf16 v[168:171], v[120:123], v[84:87], v[168:171]
v_mfma_f32_16x16x32_bf16 v[172:175], v[120:123], v[88:91], v[172:175]
v_mfma_f32_16x16x32_bf16 v[208:211], v[124:127], v[88:91], v[208:211]
v_mfma_f32_16x16x32_bf16 v[136:139], v[116:119], v[88:91], v[136:139]
v_mfma_f32_16x16x32_bf16 v[140:143], v[116:119], v[92:95], v[140:143]
v_mfma_f32_16x16x32_bf16 v[212:215], v[124:127], v[92:95], v[212:215]
v_mfma_f32_16x16x32_bf16 v[176:179], v[120:123], v[92:95], v[176:179]
v_mfma_f32_16x16x32_bf16 v[180:183], v[120:123], v[96:99], v[180:183]
v_mfma_f32_16x16x32_bf16 v[216:219], v[124:127], v[96:99], v[216:219]
v_mfma_f32_16x16x32_bf16 v[144:147], v[116:119], v[96:99], v[144:147]
v_mfma_f32_16x16x32_bf16 v[148:151], v[116:119], v[100:103], v[148:151]
v_mfma_f32_16x16x32_bf16 v[220:223], v[124:127], v[100:103], v[220:223]
v_mfma_f32_16x16x32_bf16 v[184:187], v[120:123], v[100:103], v[184:187]
v_mfma_f32_16x16x32_bf16 v[188:191], v[120:123], v[104:107], v[188:191]
v_mfma_f32_16x16x32_bf16 v[224:227], v[124:127], v[104:107], v[224:227]
v_mfma_f32_16x16x32_bf16 v[152:155], v[116:119], v[104:107], v[152:155]
v_mfma_f32_16x16x32_bf16 v[156:159], v[116:119], v[108:111], v[156:159]
v_mfma_f32_16x16x32_bf16 v[228:231], v[124:127], v[108:111], v[228:231]
v_mfma_f32_16x16x32_bf16 v[192:195], v[120:123], v[108:111], v[192:195]
v_mfma_f32_16x16x32_bf16 v[196:199], v[120:123], v[112:115], v[196:199]
v_mfma_f32_16x16x32_bf16 v[232:235], v[124:127], v[112:115], v[232:235]
v_mfma_f32_16x16x32_bf16 v[160:163], v[116:119], v[112:115], v[160:163]
v_lshlrev_b32 v14, 3, v12
v_add_u32 v14, 147456, v14
v_mul_u32_u24 v15, 400, v12
v_lshl_add_u32 v15, v13, 3, v15
s_lshl_b32 s43, s36, 5
v_add_u32 v15, s43, v15
s_barrier
ds_read_b64 v[32:33], v14 offset:0
ds_read_b64 v[34:35], v14 offset:128
ds_read_b64 v[36:37], v14 offset:256
ds_read_b64 v[38:39], v14 offset:384
ds_read_b64 v[40:41], v14 offset:512
ds_read_b64 v[42:43], v14 offset:640
ds_read_b64 v[44:45], v14 offset:768
ds_read_b64 v[46:47], v14 offset:896
ds_read_b64 v[48:49], v14 offset:1024
v_mov_b32_dpp v52, v128 row_newbcast:0 row_mask:0xf bank_mask:0xf
v_mov_b32_dpp v53, v129 row_newbcast:0 row_mask:0xf bank_mask:0xf
v_mov_b32_dpp v54, v130 row_newbcast:0 row_mask:0xf bank_mask:0xf
v_mov_b32_dpp v55, v131 row_newbcast:0 row_mask:0xf bank_mask:0xf
v_mov_b32_dpp v56, v164 row_newbcast:0 row_mask:0xf bank_mask:0xf
v_mov_b32_dpp v57, v165 row_newbcast:0 row_mask:0xf bank_mask:0xf
v_mov_b32_dpp v58, v166 row_newbcast:0 row_mask:0xf bank_mask:0xf
v_mov_b32_dpp v59, v167 row_newbcast:0 row_mask:0xf bank_mask:0xf
v_mov_b32_dpp v60, v200 row_newbcast:0 row_mask:0xf bank_mask:0xf
v_mov_b32_dpp v61, v201 row_newbcast:0 row_mask:0xf bank_mask:0xf
v_mov_b32_dpp v62, v202 row_newbcast:0 row_mask:0xf bank_mask:0xf
v_mov_b32_dpp v63, v203 row_newbcast:0 row_mask:0xf bank_mask:0xf
s_waitcnt lgkmcnt(0)
v_pk_fma_f32 v[164:165], v[32:33], v[56:57], v[164:165] op_sel_hi:[0,1,1] neg_lo:[1,0,0] neg_hi:[1,0,0]
v_pk_fma_f32 v[166:167], v[32:33], v[58:59], v[166:167] op_sel_hi:[0,1,1] neg_lo:[1,0,0] neg_hi:[1,0,0]
v_pk_fma_f32 v[200:201], v[32:33], v[60:61], v[200:201] op_sel_hi:[0,1,1] neg_lo:[1,0,0] neg_hi:[1,0,0]
v_pk_fma_f32 v[202:203], v[32:33], v[62:63], v[202:203] op_sel_hi:[0,1,1] neg_lo:[1,0,0] neg_hi:[1,0,0]
v_pk_mul_f32 v[164:165], v[32:33], v[164:165] op_sel:[1,0] op_sel_hi:[1,1]
v_pk_mul_f32 v[166:167], v[32:33], v[166:167] op_sel:[1,0] op_sel_hi:[1,1]
v_pk_fma_f32 v[132:133], v[34:35], v[52:53], v[132:133] op_sel_hi:[0,1,1] neg_lo:[1,0,0] neg_hi:[1,0,0]
v_pk_fma_f32 v[134:135], v[34:35], v[54:55], v[134:135] op_sel_hi:[0,1,1] neg_lo:[1,0,0] neg_hi:[1,0,0]
v_pk_mul_f32 v[200:201], v[32:33], v[200:201] op_sel:[1,0] op_sel_hi:[1,1]
v_pk_mul_f32 v[202:203], v[32:33], v[202:203] op_sel:[1,0] op_sel_hi:[1,1]
v_cvt_pk_bf16_f32 v164, v164, v165
v_cvt_pk_bf16_f32 v165, v166, v167
ds_write_b64 v15, v[164:165] offset:128
v_pk_fma_f32 v[168:169], v[34:35], v[56:57], v[168:169] op_sel_hi:[0,1,1] neg_lo:[1,0,0] neg_hi:[1,0,0]
v_pk_fma_f32 v[170:171], v[34:35], v[58:59], v[170:171] op_sel_hi:[0,1,1] neg_lo:[1,0,0] neg_hi:[1,0,0]
v_pk_mul_f32 v[132:133], v[34:35], v[132:133] op_sel:[1,0] op_sel_hi:[1,1]
v_pk_mul_f32 v[134:135], v[34:35], v[134:135] op_sel:[1,0] op_sel_hi:[1,1]
v_cvt_pk_bf16_f32 v200, v200, v201
v_cvt_pk_bf16_f32 v201, v202, v203
ds_write_b64 v15, v[200:201] offset:256
v_pk_fma_f32 v[204:205], v[34:35], v[60:61], v[204:205] op_sel_hi:[0,1,1] neg_lo:[1,0,0] neg_hi:[1,0,0]
v_pk_fma_f32 v[206:207], v[34:35], v[62:63], v[206:207] op_sel_hi:[0,1,1] neg_lo:[1,0,0] neg_hi:[1,0,0]
v_pk_mul_f32 v[168:169], v[34:35], v[168:169] op_sel:[1,0] op_sel_hi:[1,1]
v_pk_mul_f32 v[170:171], v[34:35], v[170:171] op_sel:[1,0] op_sel_hi:[1,1]
v_cvt_pk_bf16_f32 v132, v132, v133
v_cvt_pk_bf16_f32 v133, v134, v135
ds_write_b64 v15, v[132:133] offset:6400
v_pk_fma_f32 v[136:137], v[36:37], v[52:53], v[136:137] op_sel_hi:[0,1,1] neg_lo:[1,0,0] neg_hi:[1,0,0]
v_pk_fma_f32 v[138:139], v[36:37], v[54:55], v[138:139] op_sel_hi:[0,1,1] neg_lo:[1,0,0] neg_hi:[1,0,0]
v_pk_mul_f32 v[204:205], v[34:35], v[204:205] op_sel:[1,0] op_sel_hi:[1,1]
v_pk_mul_f32 v[206:207], v[34:35], v[206:207] op_sel:[1,0] op_sel_hi:[1,1]
v_cvt_pk_bf16_f32 v168, v168, v169
v_cvt_pk_bf16_f32 v169, v170, v171
ds_write_b64 v15, v[168:169] offset:6528
v_pk_fma_f32 v[172:173], v[36:37], v[56:57], v[172:173] op_sel_hi:[0,1,1] neg_lo:[1,0,0] neg_hi:[1,0,0]
v_pk_fma_f32 v[174:175], v[36:37], v[58:59], v[174:175] op_sel_hi:[0,1,1] neg_lo:[1,0,0] neg_hi:[1,0,0]
v_pk_mul_f32 v[136:137], v[36:37], v[136:137] op_sel:[1,0] op_sel_hi:[1,1]
v_pk_mul_f32 v[138:139], v[36:37], v[138:139] op_sel:[1,0] op_sel_hi:[1,1]
v_cvt_pk_bf16_f32 v204, v204, v205
v_cvt_pk_bf16_f32 v205, v206, v207
ds_write_b64 v15, v[204:205] offset:6656
v_pk_fma_f32 v[208:209], v[36:37], v[60:61], v[208:209] op_sel_hi:[0,1,1] neg_lo:[1,0,0] neg_hi:[1,0,0]
v_pk_fma_f32 v[210:211], v[36:37], v[62:63], v[210:211] op_sel_hi:[0,1,1] neg_lo:[1,0,0] neg_hi:[1,0,0]
v_pk_mul_f32 v[172:173], v[36:37], v[172:173] op_sel:[1,0] op_sel_hi:[1,1]
v_pk_mul_f32 v[174:175], v[36:37], v[174:175] op_sel:[1,0] op_sel_hi:[1,1]
v_cvt_pk_bf16_f32 v136, v136, v137
v_cvt_pk_bf16_f32 v137, v138, v139
ds_write_b64 v15, v[136:137] offset:12800
v_pk_fma_f32 v[140:141], v[38:39], v[52:53], v[140:141] op_sel_hi:[0,1,1] neg_lo:[1,0,0] neg_hi:[1,0,0]
v_pk_fma_f32 v[142:143], v[38:39], v[54:55], v[142:143] op_sel_hi:[0,1,1] neg_lo:[1,0,0] neg_hi:[1,0,0]
v_pk_mul_f32 v[208:209], v[36:37], v[208:209] op_sel:[1,0] op_sel_hi:[1,1]
v_pk_mul_f32 v[210:211], v[36:37], v[210:211] op_sel:[1,0] op_sel_hi:[1,1]
v_cvt_pk_bf16_f32 v172, v172, v173
v_cvt_pk_bf16_f32 v173, v174, v175
ds_write_b64 v15, v[172:173] offset:12928
v_pk_fma_f32 v[176:177], v[38:39], v[56:57], v[176:177] op_sel_hi:[0,1,1] neg_lo:[1,0,0] neg_hi:[1,0,0]
v_pk_fma_f32 v[178:179], v[38:39], v[58:59], v[178:179] op_sel_hi:[0,1,1] neg_lo:[1,0,0] neg_hi:[1,0,0]
v_pk_mul_f32 v[140:141], v[38:39], v[140:141] op_sel:[1,0] op_sel_hi:[1,1]
v_pk_mul_f32 v[142:143], v[38:39], v[142:143] op_sel:[1,0] op_sel_hi:[1,1]
v_cvt_pk_bf16_f32 v208, v208, v209
v_cvt_pk_bf16_f32 v209, v210, v211
ds_write_b64 v15, v[208:209] offset:13056
v_pk_fma_f32 v[212:213], v[38:39], v[60:61], v[212:213] op_sel_hi:[0,1,1] neg_lo:[1,0,0] neg_hi:[1,0,0]
v_pk_fma_f32 v[214:215], v[38:39], v[62:63], v[214:215] op_sel_hi:[0,1,1] neg_lo:[1,0,0] neg_hi:[1,0,0]
v_pk_mul_f32 v[176:177], v[38:39], v[176:177] op_sel:[1,0] op_sel_hi:[1,1]
v_pk_mul_f32 v[178:179], v[38:39], v[178:179] op_sel:[1,0] op_sel_hi:[1,1]
v_cvt_pk_bf16_f32 v140, v140, v141
v_cvt_pk_bf16_f32 v141, v142, v143
ds_write_b64 v15, v[140:141] offset:19200
v_pk_fma_f32 v[144:145], v[40:41], v[52:53], v[144:145] op_sel_hi:[0,1,1] neg_lo:[1,0,0] neg_hi:[1,0,0]
v_pk_fma_f32 v[146:147], v[40:41], v[54:55], v[146:147] op_sel_hi:[0,1,1] neg_lo:[1,0,0] neg_hi:[1,0,0]
v_pk_mul_f32 v[212:213], v[38:39], v[212:213] op_sel:[1,0] op_sel_hi:[1,1]
v_pk_mul_f32 v[214:215], v[38:39], v[214:215] op_sel:[1,0] op_sel_hi:[1,1]
v_cvt_pk_bf16_f32 v176, v176, v177
v_cvt_pk_bf16_f32 v177, v178, v179
ds_write_b64 v15, v[176:177] offset:19328
v_pk_fma_f32 v[180:181], v[40:41], v[56:57], v[180:181] op_sel_hi:[0,1,1] neg_lo:[1,0,0] neg_hi:[1,0,0]
v_pk_fma_f32 v[182:183], v[40:41], v[58:59], v[182:183] op_sel_hi:[0,1,1] neg_lo:[1,0,0] neg_hi:[1,0,0]
v_pk_mul_f32 v[144:145], v[40:41], v[144:145] op_sel:[1,0] op_sel_hi:[1,1]
v_pk_mul_f32 v[146:147], v[40:41], v[146:147] op_sel:[1,0] op_sel_hi:[1,1]
v_cvt_pk_bf16_f32 v212, v212, v213
v_cvt_pk_bf16_f32 v213, v214, v215
ds_write_b64 v15, v[212:213] offset:19456
v_pk_fma_f32 v[216:217], v[40:41], v[60:61], v[216:217] op_sel_hi:[0,1,1] neg_lo:[1,0,0] neg_hi:[1,0,0]
v_pk_fma_f32 v[218:219], v[40:41], v[62:63], v[218:219] op_sel_hi:[0,1,1] neg_lo:[1,0,0] neg_hi:[1,0,0]
v_pk_mul_f32 v[180:181], v[40:41], v[180:181] op_sel:[1,0] op_sel_hi:[1,1]
v_pk_mul_f32 v[182:183], v[40:41], v[182:183] op_sel:[1,0] op_sel_hi:[1,1]
v_cvt_pk_bf16_f32 v144, v144, v145
v_cvt_pk_bf16_f32 v145, v146, v147
ds_write_b64 v15, v[144:145] offset:25600
v_pk_fma_f32 v[148:149], v[42:43], v[52:53], v[148:149] op_sel_hi:[0,1,1] neg_lo:[1,0,0] neg_hi:[1,0,0]
v_pk_fma_f32 v[150:151], v[42:43], v[54:55], v[150:151] op_sel_hi:[0,1,1] neg_lo:[1,0,0] neg_hi:[1,0,0]
v_pk_mul_f32 v[216:217], v[40:41], v[216:217] op_sel:[1,0] op_sel_hi:[1,1]
v_pk_mul_f32 v[218:219], v[40:41], v[218:219] op_sel:[1,0] op_sel_hi:[1,1]
v_cvt_pk_bf16_f32 v180, v180, v181
v_cvt_pk_bf16_f32 v181, v182, v183
ds_write_b64 v15, v[180:181] offset:25728
v_pk_fma_f32 v[184:185], v[42:43], v[56:57], v[184:185] op_sel_hi:[0,1,1] neg_lo:[1,0,0] neg_hi:[1,0,0]
v_pk_fma_f32 v[186:187], v[42:43], v[58:59], v[186:187] op_sel_hi:[0,1,1] neg_lo:[1,0,0] neg_hi:[1,0,0]
v_pk_mul_f32 v[148:149], v[42:43], v[148:149] op_sel:[1,0] op_sel_hi:[1,1]
v_pk_mul_f32 v[150:151], v[42:43], v[150:151] op_sel:[1,0] op_sel_hi:[1,1]
v_cvt_pk_bf16_f32 v216, v216, v217
v_cvt_pk_bf16_f32 v217, v218, v219
ds_write_b64 v15, v[216:217] offset:25856
v_pk_fma_f32 v[220:221], v[42:43], v[60:61], v[220:221] op_sel_hi:[0,1,1] neg_lo:[1,0,0] neg_hi:[1,0,0]
v_pk_fma_f32 v[222:223], v[42:43], v[62:63], v[222:223] op_sel_hi:[0,1,1] neg_lo:[1,0,0] neg_hi:[1,0,0]
v_pk_mul_f32 v[184:185], v[42:43], v[184:185] op_sel:[1,0] op_sel_hi:[1,1]
v_pk_mul_f32 v[186:187], v[42:43], v[186:187] op_sel:[1,0] op_sel_hi:[1,1]
v_cvt_pk_bf16_f32 v148, v148, v149
v_cvt_pk_bf16_f32 v149, v150, v151
ds_write_b64 v15, v[148:149] offset:32000
v_pk_fma_f32 v[152:153], v[44:45], v[52:53], v[152:153] op_sel_hi:[0,1,1] neg_lo:[1,0,0] neg_hi:[1,0,0]
v_pk_fma_f32 v[154:155], v[44:45], v[54:55], v[154:155] op_sel_hi:[0,1,1] neg_lo:[1,0,0] neg_hi:[1,0,0]
v_pk_mul_f32 v[220:221], v[42:43], v[220:221] op_sel:[1,0] op_sel_hi:[1,1]
v_pk_mul_f32 v[222:223], v[42:43], v[222:223] op_sel:[1,0] op_sel_hi:[1,1]
v_cvt_pk_bf16_f32 v184, v184, v185
v_cvt_pk_bf16_f32 v185, v186, v187
ds_write_b64 v15, v[184:185] offset:32128
v_pk_fma_f32 v[188:189], v[44:45], v[56:57], v[188:189] op_sel_hi:[0,1,1] neg_lo:[1,0,0] neg_hi:[1,0,0]
v_pk_fma_f32 v[190:191], v[44:45], v[58:59], v[190:191] op_sel_hi:[0,1,1] neg_lo:[1,0,0] neg_hi:[1,0,0]
v_pk_mul_f32 v[152:153], v[44:45], v[152:153] op_sel:[1,0] op_sel_hi:[1,1]
v_pk_mul_f32 v[154:155], v[44:45], v[154:155] op_sel:[1,0] op_sel_hi:[1,1]
v_cvt_pk_bf16_f32 v220, v220, v221
v_cvt_pk_bf16_f32 v221, v222, v223
ds_write_b64 v15, v[220:221] offset:32256
v_pk_fma_f32 v[224:225], v[44:45], v[60:61], v[224:225] op_sel_hi:[0,1,1] neg_lo:[1,0,0] neg_hi:[1,0,0]
v_pk_fma_f32 v[226:227], v[44:45], v[62:63], v[226:227] op_sel_hi:[0,1,1] neg_lo:[1,0,0] neg_hi:[1,0,0]
v_pk_mul_f32 v[188:189], v[44:45], v[188:189] op_sel:[1,0] op_sel_hi:[1,1]
v_pk_mul_f32 v[190:191], v[44:45], v[190:191] op_sel:[1,0] op_sel_hi:[1,1]
v_cvt_pk_bf16_f32 v152, v152, v153
v_cvt_pk_bf16_f32 v153, v154, v155
ds_write_b64 v15, v[152:153] offset:38400
v_pk_fma_f32 v[156:157], v[46:47], v[52:53], v[156:157] op_sel_hi:[0,1,1] neg_lo:[1,0,0] neg_hi:[1,0,0]
v_pk_fma_f32 v[158:159], v[46:47], v[54:55], v[158:159] op_sel_hi:[0,1,1] neg_lo:[1,0,0] neg_hi:[1,0,0]
v_pk_mul_f32 v[224:225], v[44:45], v[224:225] op_sel:[1,0] op_sel_hi:[1,1]
v_pk_mul_f32 v[226:227], v[44:45], v[226:227] op_sel:[1,0] op_sel_hi:[1,1]
v_cvt_pk_bf16_f32 v188, v188, v189
v_cvt_pk_bf16_f32 v189, v190, v191
ds_write_b64 v15, v[188:189] offset:38528
v_pk_fma_f32 v[192:193], v[46:47], v[56:57], v[192:193] op_sel_hi:[0,1,1] neg_lo:[1,0,0] neg_hi:[1,0,0]
v_pk_fma_f32 v[194:195], v[46:47], v[58:59], v[194:195] op_sel_hi:[0,1,1] neg_lo:[1,0,0] neg_hi:[1,0,0]
v_pk_mul_f32 v[156:157], v[46:47], v[156:157] op_sel:[1,0] op_sel_hi:[1,1]
v_pk_mul_f32 v[158:159], v[46:47], v[158:159] op_sel:[1,0] op_sel_hi:[1,1]
v_cvt_pk_bf16_f32 v224, v224, v225
v_cvt_pk_bf16_f32 v225, v226, v227
ds_write_b64 v15, v[224:225] offset:38656
v_pk_fma_f32 v[228:229], v[46:47], v[60:61], v[228:229] op_sel_hi:[0,1,1] neg_lo:[1,0,0] neg_hi:[1,0,0]
v_pk_fma_f32 v[230:231], v[46:47], v[62:63], v[230:231] op_sel_hi:[0,1,1] neg_lo:[1,0,0] neg_hi:[1,0,0]
v_pk_mul_f32 v[192:193], v[46:47], v[192:193] op_sel:[1,0] op_sel_hi:[1,1]
v_pk_mul_f32 v[194:195], v[46:47], v[194:195] op_sel:[1,0] op_sel_hi:[1,1]
v_cvt_pk_bf16_f32 v156, v156, v157
v_cvt_pk_bf16_f32 v157, v158, v159
ds_write_b64 v15, v[156:157] offset:44800
v_pk_fma_f32 v[160:161], v[48:49], v[52:53], v[160:161] op_sel_hi:[0,1,1] neg_lo:[1,0,0] neg_hi:[1,0,0]
v_pk_fma_f32 v[162:163], v[48:49], v[54:55], v[162:163] op_sel_hi:[0,1,1] neg_lo:[1,0,0] neg_hi:[1,0,0]
v_pk_mul_f32 v[228:229], v[46:47], v[228:229] op_sel:[1,0] op_sel_hi:[1,1]
v_pk_mul_f32 v[230:231], v[46:47], v[230:231] op_sel:[1,0] op_sel_hi:[1,1]
v_cvt_pk_bf16_f32 v192, v192, v193
v_cvt_pk_bf16_f32 v193, v194, v195
ds_write_b64 v15, v[192:193] offset:44928
v_pk_fma_f32 v[196:197], v[48:49], v[56:57], v[196:197] op_sel_hi:[0,1,1] neg_lo:[1,0,0] neg_hi:[1,0,0]
v_pk_fma_f32 v[198:199], v[48:49], v[58:59], v[198:199] op_sel_hi:[0,1,1] neg_lo:[1,0,0] neg_hi:[1,0,0]
v_pk_mul_f32 v[160:161], v[48:49], v[160:161] op_sel:[1,0] op_sel_hi:[1,1]
v_pk_mul_f32 v[162:163], v[48:49], v[162:163] op_sel:[1,0] op_sel_hi:[1,1]
v_cvt_pk_bf16_f32 v228, v228, v229
v_cvt_pk_bf16_f32 v229, v230, v231
ds_write_b64 v15, v[228:229] offset:45056
v_pk_fma_f32 v[232:233], v[48:49], v[60:61], v[232:233] op_sel_hi:[0,1,1] neg_lo:[1,0,0] neg_hi:[1,0,0]
v_pk_fma_f32 v[234:235], v[48:49], v[62:63], v[234:235] op_sel_hi:[0,1,1] neg_lo:[1,0,0] neg_hi:[1,0,0]
v_pk_mul_f32 v[196:197], v[48:49], v[196:197] op_sel:[1,0] op_sel_hi:[1,1]
v_pk_mul_f32 v[198:199], v[48:49], v[198:199] op_sel:[1,0] op_sel_hi:[1,1]
v_cvt_pk_bf16_f32 v160, v160, v161
v_cvt_pk_bf16_f32 v161, v162, v163
ds_write_b64 v15, v[160:161] offset:51200
v_pk_mul_f32 v[232:233], v[48:49], v[232:233] op_sel:[1,0] op_sel_hi:[1,1]
v_pk_mul_f32 v[234:235], v[48:49], v[234:235] op_sel:[1,0] op_sel_hi:[1,1]
v_cvt_pk_bf16_f32 v196, v196, v197
v_cvt_pk_bf16_f32 v197, v198, v199
ds_write_b64 v15, v[196:197] offset:51328
v_cvt_pk_bf16_f32 v232, v232, v233
v_cvt_pk_bf16_f32 v233, v234, v235
ds_write_b64 v15, v[232:233] offset:51456
s_waitcnt lgkmcnt(0)
s_branch Latt_5
Lpf_4:
s_lshl_b32 s43, s35, 7
s_waitcnt lgkmcnt(0)
s_mov_b32 s8, s64
s_mov_b32 s9, s65
s_mov_b32 s10, 4194304
s_mov_b32 s11, 0x20000
s_add_u32 s12, s66, s43
s_addc_u32 s13, s67, 0
s_mov_b32 s14, 6289536
s_mov_b32 s15, 0x20000
s_add_u32 s84, s82, 28311552
s_addc_u32 s85, s83, 0
s_mov_b32 s86, 114688
s_mov_b32 s87, 0x20000
s_mov_b32 s56, s80
s_mov_b32 s57, s81
s_mov_b32 s58, 256
s_mov_b32 s59, 0x20000
v_mov_b32 v5, 0
v_lshlrev_b32 v14, 7, v1
s_or_b32 s43, s34, s35
s_cmp_lg_u32 s43, 0
s_cbranch_scc1 Lz_17
s_movk_i32 s43, 0x2000
buffer_store_dword v5, v14, s[84:87], 0 offen sc1
s_bfm_b64 exec, 44, 0
buffer_store_dword v5, v14, s[84:87], s43 offen sc1
s_mov_b64 exec, 1
v_mov_b32 v6, 1
s_waitcnt vmcnt(0)
buffer_store_dword v6, v5, s[56:59], 0 offen sc1
s_mov_b64 exec, -1
Lz_17:
s_lshl_b32 s43, s51, 11
buffer_load_dwordx4 v[96:99], v10, s[8:11], s43 offen offset:0
buffer_load_dwordx4 v[100:103], v10, s[8:11], s43 offen offset:1024
s_branch Lov_3
.p2align 12
.fill 16, 4, 0xbf800000
Lst_3_0:
s_branch Lwr_149
s_nop 0
s_nop 0
Lov_3:
buffer_load_dwordx4 v[104:107], v10, s[8:11], s43 offen offset:2048
buffer_load_dwordx4 v[108:111], v10, s[8:11], s43 offen offset:3072
v_min_u32 v14, 23, v1
v_lshrrev_b32 v15, 3, v14
v_mul_u32_u24 v15, 43008, v15
v_and_b32 v14, 7, v14
v_lshl_add_u32 v15, v14, 4, v15
v_mov_b32 v32, 0x3f803f80
v_mov_b32 v33, 0x3f803f80
v_mov_b32 v34, 0x3f803f80
v_mov_b32 v35, 0x3f803f80
ds_write_b128 v15, v[32:35]
s_add_u32 s20, s82, 26214400
s_addc_u32 s21, s83, 0
s_mov_b32 s22, 16384
s_mov_b32 s23, 0x20000
s_add_u32 s43, s2, 128
s_lshl_b32 s43, s43, 7
v_lshlrev_b32 v14, 2, v1
s_mov_b64 exec, 15
buffer_store_dword v5, v14, s[84:87], s43 offen sc1
s_mov_b64 exec, -1
s_lshl_b32 s43, s34, 4
s_add_u32 s43, s43, s35
s_lshl_b32 s43, s43, 8
s_add_u32 s43, s43, 49152
v_lshlrev_b32 v14, 7, v1
s_mov_b64 exec, 3
buffer_store_dword v5, v14, s[84:87], s43 offen sc1
s_mov_b64 exec, -1
s_lshl_b32 s52, s34, 7
s_add_u32 s52, s52, 28319744
s_sub_u32 s53, s52, 128
s_cmp_eq_u32 s34, 0
s_cselect_b32 s53, s52, s53
s_waitcnt lgkmcnt(0)
s_barrier
s_waitcnt vmcnt(2)
s_mov_b32 s43, 0x3f803f80
v_mov_b32 v116, 0
v_mov_b32 v117, 0
v_mov_b32 v118, 0
v_mov_b32 v119, 0
v_mov_b32 v120, 0
v_mov_b32 v121, 0
v_mov_b32 v122, 0
v_mov_b32 v123, 0
v_dot2_f32_bf16 v116, v96, s43, v116
v_dot2_f32_bf16 v120, v96, v96, v120
v_dot2_f32_bf16 v118, v104, s43, v118
v_dot2_f32_bf16 v122, v104, v104, v122
v_dot2_f32_bf16 v117, v97, s43, v117
v_dot2_f32_bf16 v121, v97, v97, v121
v_dot2_f32_bf16 v119, v105, s43, v119
v_dot2_f32_bf16 v123, v105, v105, v123
v_dot2_f32_bf16 v116, v98, s43, v116
v_dot2_f32_bf16 v120, v98, v98, v120
v_dot2_f32_bf16 v118, v106, s43, v118
v_dot2_f32_bf16 v122, v106, v106, v122
v_dot2_f32_bf16 v117, v99, s43, v117
v_dot2_f32_bf16 v121, v99, v99, v121
v_dot2_f32_bf16 v119, v107, s43, v119
v_dot2_f32_bf16 v123, v107, v107, v123
v_dot2_f32_bf16 v116, v100, s43, v116
v_dot2_f32_bf16 v120, v100, v100, v120
v_dot2_f32_bf16 v118, v108, s43, v118
v_dot2_f32_bf16 v122, v108, v108, v122
v_dot2_f32_bf16 v117, v101, s43, v117
v_dot2_f32_bf16 v121, v101, v101, v121
v_dot2_f32_bf16 v119, v109, s43, v119
v_dot2_f32_bf16 v123, v109, v109, v123
v_dot2_f32_bf16 v116, v102, s43, v116
v_dot2_f32_bf16 v120, v102, v102, v120
v_dot2_f32_bf16 v118, v110, s43, v118
v_dot2_f32_bf16 v122, v110, v110, v122
v_dot2_f32_bf16 v117, v103, s43, v117
v_dot2_f32_bf16 v121, v103, v103, v121
v_dot2_f32_bf16 v119, v111, s43, v119
v_dot2_f32_bf16 v123, v111, v111, v123
s_nop 2
v_add_f32 v116, v116, v117
v_add_f32 v118, v118, v119
v_add_f32 v120, v120, v121
v_add_f32 v122, v122, v123
s_nop 1
v_permlane32_swap_b32 v116, v118
v_permlane32_swap_b32 v120, v122
v_add_f32 v116, v116, v118
v_add_f32 v120, v120, v122
s_nop 1
v_permlane16_swap_b32 v116, v120
v_add_f32 v116, v116, v120
s_nop 1
v_add_f32_dpp v116, v116, v116 row_ror:8 row_mask:0xf bank_mask:0xf
s_nop 1
v_add_f32_dpp v116, v116, v116 row_ror:4 row_mask:0xf bank_mask:0xf
s_nop 1
v_add_f32_dpp v116, v116, v116 row_ror:2 row_mask:0xf bank_mask:0xf
s_nop 1
v_add_f32_dpp v116, v116, v116 row_ror:1 row_mask:0xf bank_mask:0xf
v_mov_b32 v117, v116
s_nop 1
v_permlane16_swap_b32 v116, v117
v_mul_f32 v112, 0x3a800000, v116
v_mul_f32 v113, 0x3a800000, v117
v_fma_f32 v113, -v112, v112, v113
v_max_f32 v113, 0, v113
v_add_f32 v113, 0x3727c5ac, v113
v_rsq_f32 v113, v113
v_lshrrev_b32 v11, 5, v1
s_lshl_b32 s43, s47, 4
s_add_u32 s43, s43, 148608
v_lshl_add_u32 v11, v11, 3, s43
ds_write_b64 v11, v[112:113]
s_waitcnt lgkmcnt(0)
s_mov_b32 s28, s66
s_mov_b32 s29, s67
s_mov_b32 s30, 6291456
s_mov_b32 s31, 0x20000
s_mul_i32 s43, s33, 7040
s_add_u32 s43, s43, 1179648
v_lshlrev_b32 v30, 7, v1
s_bfm_b64 exec, 55, 0
buffer_load_dword v31, v30, s[28:31], s43 offen
s_mov_b64 exec, -1
s_branch Lst_0_0
Lwr_146:
s_barrier
v_lshlrev_b32 v5, 4, v1
v_and_b32 v5, 63, v5
v_add_u32 v6, 148608, v5
ds_read_b128 v[112:115], v6
s_lshl_b32 s43, s63, 3
v_add_u32 v5, s43, v5
s_waitcnt lgkmcnt(0)
s_mov_b64 exec, 15
buffer_store_dwordx4 v[112:115], v5, s[20:23], 0 offen sc1
s_mov_b64 exec, -1
v_mov_b32 v4, 0
buffer_load_dword v6, v4, s[56:59], 0 offen sc1
s_mov_b32 s62, 0
s_mov_b32 s28, s66
s_mov_b32 s29, s67
s_mov_b32 s30, 6291456
s_mov_b32 s31, 0x20000
s_mul_i32 s43, s33, 15872
s_add_u32 s43, s43, 2752512
v_lshlrev_b32 v30, 7, v1
buffer_load_dword v31, v30, s[28:31], s43 offen
s_add_u32 s43, s43, 8192
s_bfm_b64 exec, 60, 0
buffer_load_dword v31, v30, s[28:31], s43 offen
s_mov_b64 exec, -1
s_lshl_b32 s43, s35, 7
s_add_u32 s28, s68, s43
s_addc_u32 s29, s69, 0
s_mov_b32 s30, 2095232
s_mov_b32 s31, 0x20000
v_and_b32 v29, 7, v1
v_lshrrev_b32 v30, 3, v1
v_lshl_add_u32 v29, v30, 6, v29
s_lshl_b32 s43, s48, 3
v_add_u32 v29, s43, v29
v_lshlrev_b32 v29, 11, v29
s_mov_b32 s43, 1048576
s_mov_b32 s28, s68
s_mov_b32 s29, s69
s_mov_b32 s30, 2097152
s_mov_b32 s31, 0x20000
s_mul_i32 s43, s33, 9472
v_lshlrev_b32 v30, 7, v1
buffer_load_dword v31, v30, s[28:31], s43 offen
s_add_u32 s43, s43, 8192
s_bfm_b64 exec, 10, 0
buffer_load_dword v31, v30, s[28:31], s43 offen
s_mov_b64 exec, -1
s_branch Lst_1_0
Lwr_147:
s_barrier
s_branch Lst_2_0
Lwr_148:
s_barrier
s_branch Lst_3_0
Lwr_149:
s_barrier
s_branch Lst_4_0
Lwr_150:
s_barrier
s_branch Lst_5_0
Lwr_151:
s_barrier
s_cmp_eq_u32 s62, 3
s_cbranch_scc1 Lste_21
s_cmp_eq_u32 s62, 2
s_cbranch_scc1 Lst2_19
s_cmp_ge_u32 s62, 4
s_cbranch_scc1 Lst4_20
s_cmp_eq_u32 s62, 1
s_cbranch_scc1 Lst1_18
s_waitcnt vmcnt(4)
v_readfirstlane_b32 s54, v6
s_cmp_eq_u32 s54, 0
s_cbranch_scc0 Lrep_22
buffer_load_dword v6, v4, s[56:59], 0 offen sc1
s_branch Lste_21
Lrep_22:
s_add_u32 s7, s34, 64
s_lshl_b32 s7, s7, 7
v_mov_b32 v5, s7
v_mov_b32 v6, 1
s_mov_b64 exec, 1
buffer_atomic_add v6, v5, s[84:87], 0 offen sc1
s_mov_b64 exec, -1
s_mov_b32 s62, 1
s_mov_b32 s54, 0
s_mov_b32 s55, 0
s_branch Lste_21
Lst1_18:
s_and_b32 s43, s54, s55
s_cmp_eq_u32 s43, 16
s_cbranch_scc1 Lg_23
s_load_dword s54, s[82:83], s52 glc
s_load_dword s55, s[82:83], s53 glc
s_branch Lste_21
Lg_23:
v_add_u32 v5, 0, v1
v_min_u32 v5, 143, v5
v_lshlrev_b32 v20, 3, v5
v_add_u32 v5, s50, v5
v_max_i32 v5, 0, v5
v_lshlrev_b32 v5, 3, v5
buffer_load_dwordx2 v[32:33], v5, s[20:23], 0 offen sc1
v_add_u32 v5, 64, v1
v_min_u32 v5, 143, v5
v_lshlrev_b32 v21, 3, v5
v_add_u32 v5, s50, v5
v_max_i32 v5, 0, v5
v_lshlrev_b32 v5, 3, v5
buffer_load_dwordx2 v[34:35], v5, s[20:23], 0 offen sc1
v_add_u32 v5, 128, v1
v_min_u32 v5, 143, v5
v_lshlrev_b32 v22, 3, v5
v_add_u32 v5, s50, v5
v_max_i32 v5, 0, v5
v_lshlrev_b32 v5, 3, v5
buffer_load_dwordx2 v[36:37], v5, s[20:23], 0 offen sc1
s_mov_b32 s62, 4
s_branch Lste_21
Lst4_20:
s_mov_b32 s62, 2
s_branch Lste_21
Lst2_19:
s_waitcnt vmcnt(0)
v_add_u32 v20, 147456, v20
ds_write_b64 v20, v[32:33]
v_add_u32 v21, 147456, v21
ds_write_b64 v21, v[34:35]
v_add_u32 v22, 147456, v22
ds_write_b64 v22, v[36:37]
s_waitcnt lgkmcnt(0)
s_mov_b32 s62, 3
Lste_21:
s_branch Lst_6_0
Lwr_152:
s_barrier
s_cmp_eq_u32 s62, 3
s_cbranch_scc1 Lste_27
s_cmp_eq_u32 s62, 2
s_cbranch_scc1 Lst2_25
s_cmp_ge_u32 s62, 4
s_cbranch_scc1 Lst4_26
s_cmp_eq_u32 s62, 1
s_cbranch_scc1 Lst1_24
s_waitcnt vmcnt(0)
v_readfirstlane_b32 s54, v6
s_cmp_eq_u32 s54, 0
s_cbranch_scc0 Lrep_28
buffer_load_dword v6, v4, s[56:59], 0 offen sc1
s_branch Lste_27
Lrep_28:
s_add_u32 s7, s34, 64
s_lshl_b32 s7, s7, 7
v_mov_b32 v5, s7
v_mov_b32 v6, 1
s_mov_b64 exec, 1
buffer_atomic_add v6, v5, s[84:87], 0 offen sc1
s_mov_b64 exec, -1
s_mov_b32 s62, 1
s_mov_b32 s54, 0
s_mov_b32 s55, 0
s_branch Lste_27
Lst1_24:
s_and_b32 s43, s54, s55
s_cmp_eq_u32 s43, 16
s_cbranch_scc1 Lg_29
s_load_dword s54, s[82:83], s52 glc
s_load_dword s55, s[82:83], s53 glc
s_branch Lste_27
Lg_29:
v_add_u32 v5, 0, v1
v_min_u32 v5, 143, v5
v_lshlrev_b32 v20, 3, v5
v_add_u32 v5, s50, v5
v_max_i32 v5, 0, v5
v_lshlrev_b32 v5, 3, v5
buffer_load_dwordx2 v[32:33], v5, s[20:23], 0 offen sc1
v_add_u32 v5, 64, v1
v_min_u32 v5, 143, v5
v_lshlrev_b32 v21, 3, v5
v_add_u32 v5, s50, v5
v_max_i32 v5, 0, v5
v_lshlrev_b32 v5, 3, v5
buffer_load_dwordx2 v[34:35], v5, s[20:23], 0 offen sc1
v_add_u32 v5, 128, v1
v_min_u32 v5, 143, v5
v_lshlrev_b32 v22, 3, v5
v_add_u32 v5, s50, v5
v_max_i32 v5, 0, v5
v_lshlrev_b32 v5, 3, v5
buffer_load_dwordx2 v[36:37], v5, s[20:23], 0 offen sc1
s_mov_b32 s62, 4
s_branch Lste_27
Lst4_26:
s_mov_b32 s62, 2
s_branch Lste_27
Lst2_25:
s_waitcnt vmcnt(0)
v_add_u32 v20, 147456, v20
ds_write_b64 v20, v[32:33]
v_add_u32 v21, 147456, v21
ds_write_b64 v21, v[34:35]
v_add_u32 v22, 147456, v22
ds_write_b64 v22, v[36:37]
s_waitcnt lgkmcnt(0)
s_mov_b32 s62, 3
Lste_27:
s_branch Lst_7_0
Lwr_153:
s_barrier
s_cmp_eq_u32 s62, 3
s_cbranch_scc1 Lste_33
s_cmp_eq_u32 s62, 2
s_cbranch_scc1 Lst2_31
s_cmp_ge_u32 s62, 4
s_cbranch_scc1 Lst4_32
s_cmp_eq_u32 s62, 1
s_cbranch_scc1 Lst1_30
s_waitcnt vmcnt(0)
v_readfirstlane_b32 s54, v6
s_cmp_eq_u32 s54, 0
s_cbranch_scc0 Lrep_34
buffer_load_dword v6, v4, s[56:59], 0 offen sc1
s_branch Lste_33
Lrep_34:
s_add_u32 s7, s34, 64
s_lshl_b32 s7, s7, 7
v_mov_b32 v5, s7
v_mov_b32 v6, 1
s_mov_b64 exec, 1
buffer_atomic_add v6, v5, s[84:87], 0 offen sc1
s_mov_b64 exec, -1
s_mov_b32 s62, 1
s_mov_b32 s54, 0
s_mov_b32 s55, 0
s_branch Lste_33
Lst1_30:
s_and_b32 s43, s54, s55
s_cmp_eq_u32 s43, 16
s_cbranch_scc1 Lg_35
s_load_dword s54, s[82:83], s52 glc
s_load_dword s55, s[82:83], s53 glc
s_branch Lste_33
Lg_35:
v_add_u32 v5, 0, v1
v_min_u32 v5, 143, v5
v_lshlrev_b32 v20, 3, v5
v_add_u32 v5, s50, v5
v_max_i32 v5, 0, v5
v_lshlrev_b32 v5, 3, v5
buffer_load_dwordx2 v[32:33], v5, s[20:23], 0 offen sc1
v_add_u32 v5, 64, v1
v_min_u32 v5, 143, v5
v_lshlrev_b32 v21, 3, v5
v_add_u32 v5, s50, v5
v_max_i32 v5, 0, v5
v_lshlrev_b32 v5, 3, v5
buffer_load_dwordx2 v[34:35], v5, s[20:23], 0 offen sc1
v_add_u32 v5, 128, v1
v_min_u32 v5, 143, v5
v_lshlrev_b32 v22, 3, v5
v_add_u32 v5, s50, v5
v_max_i32 v5, 0, v5
v_lshlrev_b32 v5, 3, v5
buffer_load_dwordx2 v[36:37], v5, s[20:23], 0 offen sc1
s_mov_b32 s62, 4
s_branch Lste_33
Lst4_32:
s_mov_b32 s62, 2
s_branch Lste_33
Lst2_31:
s_waitcnt vmcnt(0)
v_add_u32 v20, 147456, v20
ds_write_b64 v20, v[32:33]
v_add_u32 v21, 147456, v21
ds_write_b64 v21, v[34:35]
v_add_u32 v22, 147456, v22
ds_write_b64 v22, v[36:37]
s_waitcnt lgkmcnt(0)
s_mov_b32 s62, 3
Lste_33:
s_branch Lst_8_0
Lwr_154:
s_barrier
s_cmp_eq_u32 s62, 3
s_cbranch_scc1 Lste_39
s_cmp_eq_u32 s62, 2
s_cbranch_scc1 Lst2_37
s_cmp_ge_u32 s62, 4
s_cbranch_scc1 Lst4_38
s_cmp_eq_u32 s62, 1
s_cbranch_scc1 Lst1_36
s_waitcnt vmcnt(0)
v_readfirstlane_b32 s54, v6
s_cmp_eq_u32 s54, 0
s_cbranch_scc0 Lrep_40
buffer_load_dword v6, v4, s[56:59], 0 offen sc1
s_branch Lste_39
Lrep_40:
s_add_u32 s7, s34, 64
s_lshl_b32 s7, s7, 7
v_mov_b32 v5, s7
v_mov_b32 v6, 1
s_mov_b64 exec, 1
buffer_atomic_add v6, v5, s[84:87], 0 offen sc1
s_mov_b64 exec, -1
s_mov_b32 s62, 1
s_mov_b32 s54, 0
s_mov_b32 s55, 0
s_branch Lste_39
Lst1_36:
s_and_b32 s43, s54, s55
s_cmp_eq_u32 s43, 16
s_cbranch_scc1 Lg_41
s_load_dword s54, s[82:83], s52 glc
s_load_dword s55, s[82:83], s53 glc
s_branch Lste_39
Lg_41:
v_add_u32 v5, 0, v1
v_min_u32 v5, 143, v5
v_lshlrev_b32 v20, 3, v5
v_add_u32 v5, s50, v5
v_max_i32 v5, 0, v5
v_lshlrev_b32 v5, 3, v5
buffer_load_dwordx2 v[32:33], v5, s[20:23], 0 offen sc1
v_add_u32 v5, 64, v1
v_min_u32 v5, 143, v5
v_lshlrev_b32 v21, 3, v5
v_add_u32 v5, s50, v5
v_max_i32 v5, 0, v5
v_lshlrev_b32 v5, 3, v5
buffer_load_dwordx2 v[34:35], v5, s[20:23], 0 offen sc1
v_add_u32 v5, 128, v1
v_min_u32 v5, 143, v5
v_lshlrev_b32 v22, 3, v5
v_add_u32 v5, s50, v5
v_max_i32 v5, 0, v5
v_lshlrev_b32 v5, 3, v5
buffer_load_dwordx2 v[36:37], v5, s[20:23], 0 offen sc1
s_mov_b32 s62, 4
s_branch Lste_39
Lst4_38:
s_mov_b32 s62, 2
s_branch Lste_39
Lst2_37:
s_waitcnt vmcnt(0)
v_add_u32 v20, 147456, v20
ds_write_b64 v20, v[32:33]
v_add_u32 v21, 147456, v21
ds_write_b64 v21, v[34:35]
v_add_u32 v22, 147456, v22
ds_write_b64 v22, v[36:37]
s_waitcnt lgkmcnt(0)
s_mov_b32 s62, 3
Lste_39:
s_branch Lst_9_0
Lwr_155:
s_barrier
s_cmp_eq_u32 s62, 3
s_cbranch_scc1 Lste_45
s_cmp_eq_u32 s62, 2
s_cbranch_scc1 Lst2_43
s_cmp_ge_u32 s62, 4
s_cbranch_scc1 Lst4_44
s_cmp_eq_u32 s62, 1
s_cbranch_scc1 Lst1_42
s_waitcnt vmcnt(0)
v_readfirstlane_b32 s54, v6
s_cmp_eq_u32 s54, 0
s_cbranch_scc0 Lrep_46
buffer_load_dword v6, v4, s[56:59], 0 offen sc1
s_branch Lste_45
Lrep_46:
s_add_u32 s7, s34, 64
s_lshl_b32 s7, s7, 7
v_mov_b32 v5, s7
v_mov_b32 v6, 1
s_mov_b64 exec, 1
buffer_atomic_add v6, v5, s[84:87], 0 offen sc1
s_mov_b64 exec, -1
s_mov_b32 s62, 1
s_mov_b32 s54, 0
s_mov_b32 s55, 0
s_branch Lste_45
Lst1_42:
s_and_b32 s43, s54, s55
s_cmp_eq_u32 s43, 16
s_cbranch_scc1 Lg_47
s_load_dword s54, s[82:83], s52 glc
s_load_dword s55, s[82:83], s53 glc
s_branch Lste_45
Lg_47:
v_add_u32 v5, 0, v1
v_min_u32 v5, 143, v5
v_lshlrev_b32 v20, 3, v5
v_add_u32 v5, s50, v5
v_max_i32 v5, 0, v5
v_lshlrev_b32 v5, 3, v5
buffer_load_dwordx2 v[32:33], v5, s[20:23], 0 offen sc1
v_add_u32 v5, 64, v1
v_min_u32 v5, 143, v5
v_lshlrev_b32 v21, 3, v5
v_add_u32 v5, s50, v5
v_max_i32 v5, 0, v5
v_lshlrev_b32 v5, 3, v5
buffer_load_dwordx2 v[34:35], v5, s[20:23], 0 offen sc1
v_add_u32 v5, 128, v1
v_min_u32 v5, 143, v5
v_lshlrev_b32 v22, 3, v5
v_add_u32 v5, s50, v5
v_max_i32 v5, 0, v5
v_lshlrev_b32 v5, 3, v5
buffer_load_dwordx2 v[36:37], v5, s[20:23], 0 offen sc1
s_mov_b32 s62, 4
s_branch Lste_45
Lst4_44:
s_mov_b32 s62, 2
s_branch Lste_45
Lst2_43:
s_waitcnt vmcnt(0)
v_add_u32 v20, 147456, v20
ds_write_b64 v20, v[32:33]
v_add_u32 v21, 147456, v21
ds_write_b64 v21, v[34:35]
v_add_u32 v22, 147456, v22
ds_write_b64 v22, v[36:37]
s_waitcnt lgkmcnt(0)
s_mov_b32 s62, 3
Lste_45:
s_branch Lst_10_0
Lwr_156:
s_barrier
s_cmp_eq_u32 s62, 3
s_cbranch_scc1 Lste_51
s_cmp_eq_u32 s62, 2
s_cbranch_scc1 Lst2_49
s_cmp_ge_u32 s62, 4
s_cbranch_scc1 Lst4_50
s_cmp_eq_u32 s62, 1
s_cbranch_scc1 Lst1_48
s_waitcnt vmcnt(0)
v_readfirstlane_b32 s54, v6
s_cmp_eq_u32 s54, 0
s_cbranch_scc0 Lrep_52
buffer_load_dword v6, v4, s[56:59], 0 offen sc1
s_branch Lste_51
Lrep_52:
s_add_u32 s7, s34, 64
s_lshl_b32 s7, s7, 7
v_mov_b32 v5, s7
v_mov_b32 v6, 1
s_mov_b64 exec, 1
buffer_atomic_add v6, v5, s[84:87], 0 offen sc1
s_mov_b64 exec, -1
s_mov_b32 s62, 1
s_mov_b32 s54, 0
s_mov_b32 s55, 0
s_branch Lste_51
Lst1_48:
s_and_b32 s43, s54, s55
s_cmp_eq_u32 s43, 16
s_cbranch_scc1 Lg_53
s_load_dword s54, s[82:83], s52 glc
s_load_dword s55, s[82:83], s53 glc
s_branch Lste_51
Lg_53:
v_add_u32 v5, 0, v1
v_min_u32 v5, 143, v5
v_lshlrev_b32 v20, 3, v5
v_add_u32 v5, s50, v5
v_max_i32 v5, 0, v5
v_lshlrev_b32 v5, 3, v5
buffer_load_dwordx2 v[32:33], v5, s[20:23], 0 offen sc1
v_add_u32 v5, 64, v1
v_min_u32 v5, 143, v5
v_lshlrev_b32 v21, 3, v5
v_add_u32 v5, s50, v5
v_max_i32 v5, 0, v5
v_lshlrev_b32 v5, 3, v5
buffer_load_dwordx2 v[34:35], v5, s[20:23], 0 offen sc1
v_add_u32 v5, 128, v1
v_min_u32 v5, 143, v5
v_lshlrev_b32 v22, 3, v5
v_add_u32 v5, s50, v5
v_max_i32 v5, 0, v5
v_lshlrev_b32 v5, 3, v5
buffer_load_dwordx2 v[36:37], v5, s[20:23], 0 offen sc1
s_mov_b32 s62, 4
s_branch Lste_51
Lst4_50:
s_mov_b32 s62, 2
s_branch Lste_51
Lst2_49:
s_waitcnt vmcnt(0)
v_add_u32 v20, 147456, v20
ds_write_b64 v20, v[32:33]
v_add_u32 v21, 147456, v21
ds_write_b64 v21, v[34:35]
v_add_u32 v22, 147456, v22
ds_write_b64 v22, v[36:37]
s_waitcnt lgkmcnt(0)
s_mov_b32 s62, 3
Lste_51:
s_branch Lst_11_0
Lwr_157:
s_barrier
s_cmp_eq_u32 s62, 3
s_cbranch_scc1 Lste_57
s_cmp_eq_u32 s62, 2
s_cbranch_scc1 Lst2_55
s_cmp_ge_u32 s62, 4
s_cbranch_scc1 Lst4_56
s_cmp_eq_u32 s62, 1
s_cbranch_scc1 Lst1_54
s_waitcnt vmcnt(0)
v_readfirstlane_b32 s54, v6
s_cmp_eq_u32 s54, 0
s_cbranch_scc0 Lrep_58
buffer_load_dword v6, v4, s[56:59], 0 offen sc1
s_branch Lste_57
Lrep_58:
s_add_u32 s7, s34, 64
s_lshl_b32 s7, s7, 7
v_mov_b32 v5, s7
v_mov_b32 v6, 1
s_mov_b64 exec, 1
buffer_atomic_add v6, v5, s[84:87], 0 offen sc1
s_mov_b64 exec, -1
s_mov_b32 s62, 1
s_mov_b32 s54, 0
s_mov_b32 s55, 0
s_branch Lste_57
Lst1_54:
s_and_b32 s43, s54, s55
s_cmp_eq_u32 s43, 16
s_cbranch_scc1 Lg_59
s_load_dword s54, s[82:83], s52 glc
s_load_dword s55, s[82:83], s53 glc
s_branch Lste_57
Lg_59:
v_add_u32 v5, 0, v1
v_min_u32 v5, 143, v5
v_lshlrev_b32 v20, 3, v5
v_add_u32 v5, s50, v5
v_max_i32 v5, 0, v5
v_lshlrev_b32 v5, 3, v5
buffer_load_dwordx2 v[32:33], v5, s[20:23], 0 offen sc1
v_add_u32 v5, 64, v1
v_min_u32 v5, 143, v5
v_lshlrev_b32 v21, 3, v5
v_add_u32 v5, s50, v5
v_max_i32 v5, 0, v5
v_lshlrev_b32 v5, 3, v5
buffer_load_dwordx2 v[34:35], v5, s[20:23], 0 offen sc1
v_add_u32 v5, 128, v1
v_min_u32 v5, 143, v5
v_lshlrev_b32 v22, 3, v5
v_add_u32 v5, s50, v5
v_max_i32 v5, 0, v5
v_lshlrev_b32 v5, 3, v5
buffer_load_dwordx2 v[36:37], v5, s[20:23], 0 offen sc1
s_mov_b32 s62, 4
s_branch Lste_57
Lst4_56:
s_mov_b32 s62, 2
s_branch Lste_57
Lst2_55:
s_waitcnt vmcnt(0)
v_add_u32 v20, 147456, v20
ds_write_b64 v20, v[32:33]
v_add_u32 v21, 147456, v21
ds_write_b64 v21, v[34:35]
v_add_u32 v22, 147456, v22
ds_write_b64 v22, v[36:37]
s_waitcnt lgkmcnt(0)
s_mov_b32 s62, 3
Lste_57:
s_branch Lst_12_0
Lwr_158:
s_barrier
s_cmp_eq_u32 s62, 3
s_cbranch_scc1 Lste_63
s_cmp_eq_u32 s62, 2
s_cbranch_scc1 Lst2_61
s_cmp_ge_u32 s62, 4
s_cbranch_scc1 Lst4_62
s_cmp_eq_u32 s62, 1
s_cbranch_scc1 Lst1_60
s_waitcnt vmcnt(0)
v_readfirstlane_b32 s54, v6
s_cmp_eq_u32 s54, 0
s_cbranch_scc0 Lrep_64
buffer_load_dword v6, v4, s[56:59], 0 offen sc1
s_branch Lste_63
Lrep_64:
s_add_u32 s7, s34, 64
s_lshl_b32 s7, s7, 7
v_mov_b32 v5, s7
v_mov_b32 v6, 1
s_mov_b64 exec, 1
buffer_atomic_add v6, v5, s[84:87], 0 offen sc1
s_mov_b64 exec, -1
s_mov_b32 s62, 1
s_mov_b32 s54, 0
s_mov_b32 s55, 0
s_branch Lste_63
Lst1_60:
s_and_b32 s43, s54, s55
s_cmp_eq_u32 s43, 16
s_cbranch_scc1 Lg_65
s_load_dword s54, s[82:83], s52 glc
s_load_dword s55, s[82:83], s53 glc
s_branch Lste_63
Lg_65:
v_add_u32 v5, 0, v1
v_min_u32 v5, 143, v5
v_lshlrev_b32 v20, 3, v5
v_add_u32 v5, s50, v5
v_max_i32 v5, 0, v5
v_lshlrev_b32 v5, 3, v5
buffer_load_dwordx2 v[32:33], v5, s[20:23], 0 offen sc1
v_add_u32 v5, 64, v1
v_min_u32 v5, 143, v5
v_lshlrev_b32 v21, 3, v5
v_add_u32 v5, s50, v5
v_max_i32 v5, 0, v5
v_lshlrev_b32 v5, 3, v5
buffer_load_dwordx2 v[34:35], v5, s[20:23], 0 offen sc1
v_add_u32 v5, 128, v1
v_min_u32 v5, 143, v5
v_lshlrev_b32 v22, 3, v5
v_add_u32 v5, s50, v5
v_max_i32 v5, 0, v5
v_lshlrev_b32 v5, 3, v5
buffer_load_dwordx2 v[36:37], v5, s[20:23], 0 offen sc1
s_mov_b32 s62, 4
s_branch Lste_63
Lst4_62:
s_mov_b32 s62, 2
s_branch Lste_63
Lst2_61:
s_waitcnt vmcnt(0)
v_add_u32 v20, 147456, v20
ds_write_b64 v20, v[32:33]
v_add_u32 v21, 147456, v21
ds_write_b64 v21, v[34:35]
v_add_u32 v22, 147456, v22
ds_write_b64 v22, v[36:37]
s_waitcnt lgkmcnt(0)
s_mov_b32 s62, 3
Lste_63:
s_branch Lst_13_0
Lwr_159:
s_barrier
s_cmp_eq_u32 s62, 3
s_cbranch_scc1 Lste_69
s_cmp_eq_u32 s62, 2
s_cbranch_scc1 Lst2_67
s_cmp_ge_u32 s62, 4
s_cbranch_scc1 Lst4_68
s_cmp_eq_u32 s62, 1
s_cbranch_scc1 Lst1_66
s_waitcnt vmcnt(0)
v_readfirstlane_b32 s54, v6
s_cmp_eq_u32 s54, 0
s_cbranch_scc0 Lrep_70
buffer_load_dword v6, v4, s[56:59], 0 offen sc1
s_branch Lste_69
Lrep_70:
s_add_u32 s7, s34, 64
s_lshl_b32 s7, s7, 7
v_mov_b32 v5, s7
v_mov_b32 v6, 1
s_mov_b64 exec, 1
buffer_atomic_add v6, v5, s[84:87], 0 offen sc1
s_mov_b64 exec, -1
s_mov_b32 s62, 1
s_mov_b32 s54, 0
s_mov_b32 s55, 0
s_branch Lste_69
Lst1_66:
s_and_b32 s43, s54, s55
s_cmp_eq_u32 s43, 16
s_cbranch_scc1 Lg_71
s_load_dword s54, s[82:83], s52 glc
s_load_dword s55, s[82:83], s53 glc
s_branch Lste_69
Lg_71:
v_add_u32 v5, 0, v1
v_min_u32 v5, 143, v5
v_lshlrev_b32 v20, 3, v5
v_add_u32 v5, s50, v5
v_max_i32 v5, 0, v5
v_lshlrev_b32 v5, 3, v5
buffer_load_dwordx2 v[32:33], v5, s[20:23], 0 offen sc1
v_add_u32 v5, 64, v1
v_min_u32 v5, 143, v5
v_lshlrev_b32 v21, 3, v5
v_add_u32 v5, s50, v5
v_max_i32 v5, 0, v5
v_lshlrev_b32 v5, 3, v5
buffer_load_dwordx2 v[34:35], v5, s[20:23], 0 offen sc1
v_add_u32 v5, 128, v1
v_min_u32 v5, 143, v5
v_lshlrev_b32 v22, 3, v5
v_add_u32 v5, s50, v5
s_branch Lov_4
.p2align 12
.fill 32, 4, 0xbf800000
Lst_4_0:
s_branch Lwr_150
s_nop 0
s_nop 0
Lov_4:
v_max_i32 v5, 0, v5
v_lshlrev_b32 v5, 3, v5
buffer_load_dwordx2 v[36:37], v5, s[20:23], 0 offen sc1
s_mov_b32 s62, 4
s_branch Lste_69
Lst4_68:
s_mov_b32 s62, 2
s_branch Lste_69
Lst2_67:
s_waitcnt vmcnt(0)
v_add_u32 v20, 147456, v20
ds_write_b64 v20, v[32:33]
v_add_u32 v21, 147456, v21
ds_write_b64 v21, v[34:35]
v_add_u32 v22, 147456, v22
ds_write_b64 v22, v[36:37]
s_waitcnt lgkmcnt(0)
s_mov_b32 s62, 3
Lste_69:
s_branch Lst_14_0
Lwr_160:
s_barrier
s_cmp_eq_u32 s62, 3
s_cbranch_scc1 Lste_74
s_cmp_ge_u32 s62, 5
s_cbranch_scc1 Lg_79
s_cmp_ge_u32 s62, 2
s_cbranch_scc1 Lst2_73
s_cmp_eq_u32 s62, 1
s_cbranch_scc1 Lst1_72
s_mov_b32 s41, 0x40000
Lz0_75:
s_waitcnt vmcnt(0)
v_readfirstlane_b32 s54, v6
s_cmp_eq_u32 s54, 0
s_cbranch_scc0 Lzok_76
buffer_load_dword v6, v4, s[56:59], 0 offen sc1
s_sub_u32 s41, s41, 1
s_cmp_lg_u32 s41, 0
s_cbranch_scc1 Lz0_75
s_waitcnt lgkmcnt(0)
Lzok_76:
s_add_u32 s7, s34, 64
s_lshl_b32 s7, s7, 7
v_mov_b32 v5, s7
v_mov_b32 v6, 1
s_mov_b64 exec, 1
buffer_atomic_add v6, v5, s[84:87], 0 offen sc1
s_mov_b64 exec, -1
Lst1_72:
s_load_dword s54, s[82:83], s52 glc
s_load_dword s55, s[82:83], s53 glc
s_mov_b32 s41, 200
Lpoll_77:
s_waitcnt lgkmcnt(0)
s_and_b32 s54, s54, s55
s_cmp_eq_u32 s54, 16
s_cbranch_scc1 Lg_79
s_load_dword s54, s[82:83], s52 glc
s_load_dword s55, s[82:83], s53 glc
s_sub_u32 s41, s41, 1
s_cmp_lg_u32 s41, 0
s_cbranch_scc1 Lpoll_77
s_waitcnt lgkmcnt(0)
s_mov_b32 s41, 0
Lfb_78:
s_add_u32 s62, s50, s41
s_max_i32 s62, s62, 0
s_lshl_b32 s43, s62, 11
buffer_load_dwordx4 v[96:99], v10, s[8:11], s43 offen offset:0
buffer_load_dwordx4 v[100:103], v10, s[8:11], s43 offen offset:1024
buffer_load_dwordx4 v[104:107], v10, s[8:11], s43 offen offset:2048
buffer_load_dwordx4 v[108:111], v10, s[8:11], s43 offen offset:3072
s_waitcnt vmcnt(0)
s_mov_b32 s43, 0x3f803f80
v_mov_b32 v116, 0
v_mov_b32 v117, 0
v_mov_b32 v118, 0
v_mov_b32 v119, 0
v_mov_b32 v120, 0
v_mov_b32 v121, 0
v_mov_b32 v122, 0
v_mov_b32 v123, 0
v_dot2_f32_bf16 v116, v96, s43, v116
v_dot2_f32_bf16 v120, v96, v96, v120
v_dot2_f32_bf16 v118, v104, s43, v118
v_dot2_f32_bf16 v122, v104, v104, v122
v_dot2_f32_bf16 v117, v97, s43, v117
v_dot2_f32_bf16 v121, v97, v97, v121
v_dot2_f32_bf16 v119, v105, s43, v119
v_dot2_f32_bf16 v123, v105, v105, v123
v_dot2_f32_bf16 v116, v98, s43, v116
v_dot2_f32_bf16 v120, v98, v98, v120
v_dot2_f32_bf16 v118, v106, s43, v118
v_dot2_f32_bf16 v122, v106, v106, v122
v_dot2_f32_bf16 v117, v99, s43, v117
v_dot2_f32_bf16 v121, v99, v99, v121
v_dot2_f32_bf16 v119, v107, s43, v119
v_dot2_f32_bf16 v123, v107, v107, v123
v_dot2_f32_bf16 v116, v100, s43, v116
v_dot2_f32_bf16 v120, v100, v100, v120
v_dot2_f32_bf16 v118, v108, s43, v118
v_dot2_f32_bf16 v122, v108, v108, v122
v_dot2_f32_bf16 v117, v101, s43, v117
v_dot2_f32_bf16 v121, v101, v101, v121
v_dot2_f32_bf16 v119, v109, s43, v119
v_dot2_f32_bf16 v123, v109, v109, v123
v_dot2_f32_bf16 v116, v102, s43, v116
v_dot2_f32_bf16 v120, v102, v102, v120
v_dot2_f32_bf16 v118, v110, s43, v118
v_dot2_f32_bf16 v122, v110, v110, v122
v_dot2_f32_bf16 v117, v103, s43, v117
v_dot2_f32_bf16 v121, v103, v103, v121
v_dot2_f32_bf16 v119, v111, s43, v119
v_dot2_f32_bf16 v123, v111, v111, v123
s_nop 2
v_add_f32 v116, v116, v117
v_add_f32 v118, v118, v119
v_add_f32 v120, v120, v121
v_add_f32 v122, v122, v123
s_nop 1
v_permlane32_swap_b32 v116, v118
v_permlane32_swap_b32 v120, v122
v_add_f32 v116, v116, v118
v_add_f32 v120, v120, v122
s_nop 1
v_permlane16_swap_b32 v116, v120
v_add_f32 v116, v116, v120
s_nop 1
v_add_f32_dpp v116, v116, v116 row_ror:8 row_mask:0xf bank_mask:0xf
s_nop 1
v_add_f32_dpp v116, v116, v116 row_ror:4 row_mask:0xf bank_mask:0xf
s_nop 1
v_add_f32_dpp v116, v116, v116 row_ror:2 row_mask:0xf bank_mask:0xf
s_nop 1
v_add_f32_dpp v116, v116, v116 row_ror:1 row_mask:0xf bank_mask:0xf
v_mov_b32 v117, v116
s_nop 1
v_permlane16_swap_b32 v116, v117
v_mul_f32 v112, 0x3a800000, v116
v_mul_f32 v113, 0x3a800000, v117
v_fma_f32 v113, -v112, v112, v113
v_max_f32 v113, 0, v113
v_add_f32 v113, 0x3727c5ac, v113
v_rsq_f32 v113, v113
v_lshrrev_b32 v11, 5, v1
s_lshl_b32 s43, s41, 3
s_add_u32 s43, s43, 147456
v_lshl_add_u32 v11, v11, 3, s43
ds_write_b64 v11, v[112:113]
s_add_u32 s41, s41, 2
s_cmp_lt_u32 s41, 144
s_cbranch_scc1 Lfb_78
s_waitcnt lgkmcnt(0)
s_branch Lste_74
Lg_79:
v_add_u32 v5, 0, v1
v_min_u32 v5, 143, v5
v_lshlrev_b32 v20, 3, v5
v_add_u32 v5, s50, v5
v_max_i32 v5, 0, v5
v_lshlrev_b32 v5, 3, v5
buffer_load_dwordx2 v[32:33], v5, s[20:23], 0 offen sc1
v_add_u32 v5, 64, v1
v_min_u32 v5, 143, v5
v_lshlrev_b32 v21, 3, v5
v_add_u32 v5, s50, v5
v_max_i32 v5, 0, v5
v_lshlrev_b32 v5, 3, v5
buffer_load_dwordx2 v[34:35], v5, s[20:23], 0 offen sc1
v_add_u32 v5, 128, v1
v_min_u32 v5, 143, v5
v_lshlrev_b32 v22, 3, v5
v_add_u32 v5, s50, v5
v_max_i32 v5, 0, v5
v_lshlrev_b32 v5, 3, v5
buffer_load_dwordx2 v[36:37], v5, s[20:23], 0 offen sc1
Lst2_73:
s_waitcnt vmcnt(0)
v_add_u32 v20, 147456, v20
ds_write_b64 v20, v[32:33]
v_add_u32 v21, 147456, v21
ds_write_b64 v21, v[34:35]
v_add_u32 v22, 147456, v22
ds_write_b64 v22, v[36:37]
s_waitcnt lgkmcnt(0)
Lste_74:
s_bitcmp0_b32 s2, 0
s_cselect_b32 s88, s72, s74
s_cselect_b32 s89, s73, s75
s_cmp_lt_u32 s2, 192
s_cselect_b32 s90, 7340032, 0
s_mov_b32 s91, 0x20000
s_bfe_u32 s44, s2, 0x30001
s_lshl_b32 s44, s44, 2
s_and_b32 s43, s36, 3
s_add_u32 s44, s44, s43
s_lshl_b32 s44, s44, 5
v_lshrrev_b32 v18, 4, v1
v_add_u32 v18, s44, v18
v_mul_u32_u24 v18, 7168, v18
v_and_b32 v19, 15, v1
v_lshl_add_u32 v18, v19, 4, v18
s_lshr_b32 s43, s2, 4
s_lshl_b32 s43, s43, 8
s_add_u32 s43, s43, 4096
v_add_u32 v18, s43, v18
s_mov_b32 s43, 0
buffer_load_dwordx4 v[128:131], v18, s[88:91], s43 offen
s_mov_b32 s43, 28672
buffer_load_dwordx4 v[132:135], v18, s[88:91], s43 offen
s_mov_b32 s43, 57344
buffer_load_dwordx4 v[136:139], v18, s[88:91], s43 offen
s_mov_b32 s43, 86016
buffer_load_dwordx4 v[140:143], v18, s[88:91], s43 offen
s_mov_b32 s43, 114688
buffer_load_dwordx4 v[144:147], v18, s[88:91], s43 offen
s_mov_b32 s43, 143360
buffer_load_dwordx4 v[148:151], v18, s[88:91], s43 offen
s_mov_b32 s43, 172032
buffer_load_dwordx4 v[152:155], v18, s[88:91], s43 offen
s_mov_b32 s43, 200704
buffer_load_dwordx4 v[156:159], v18, s[88:91], s43 offen
s_barrier
s_lshl_b32 s43, s35, 7
s_add_u32 s28, s68, s43
s_addc_u32 s29, s69, 0
s_mov_b32 s30, 2095232
s_mov_b32 s31, 0x20000
v_lshrrev_b32 v15, 3, v1
v_and_b32 v16, 6, v15
v_and_b32 v7, 7, v1
v_xor_b32 v7, v7, v16
v_lshlrev_b32 v7, 4, v7
v_mul_u32_u24 v15, 2048, v15
v_add_u32 v7, v7, v15
s_and_b32 s40, s36, 3
s_lshl_b32 s39, s40, 13
s_add_u32 s40, s40, s35
s_add_u32 s42, s40, 0
s_and_b32 s42, s42, 15
s_lshl_b32 s42, s42, 17
s_add_u32 m0, s39, 65536
s_add_u32 s43, s42, 0
buffer_load_dwordx4 v7, s[28:31], s43 offen lds
s_add_u32 m0, s39, 66560
s_add_u32 s43, s42, 16384
buffer_load_dwordx4 v7, s[28:31], s43 offen lds
s_add_u32 m0, s39, 67584
s_add_u32 s43, s42, 32768
buffer_load_dwordx4 v7, s[28:31], s43 offen lds
s_add_u32 m0, s39, 68608
s_add_u32 s43, s42, 49152
buffer_load_dwordx4 v7, s[28:31], s43 offen lds
s_add_u32 m0, s39, 69632
s_add_u32 s43, s42, 65536
buffer_load_dwordx4 v7, s[28:31], s43 offen lds
s_add_u32 m0, s39, 70656
s_add_u32 s43, s42, 81920
buffer_load_dwordx4 v7, s[28:31], s43 offen lds
s_add_u32 m0, s39, 71680
s_add_u32 s43, s42, 98304
buffer_load_dwordx4 v7, s[28:31], s43 offen lds
s_add_u32 m0, s39, 72704
s_add_u32 s43, s42, 114688
buffer_load_dwordx4 v7, s[28:31], s43 offen lds
Lats_6:
s_and_b32 s43, s36, 1
s_bfe_u32 s44, s36, 0x10001
s_lshr_b32 s45, s36, 2
v_lshlrev_b32 v14, 2, v13
v_sub_u32 v14, v12, v14
v_mov_b32 v16, 0xff800000
s_or_b32 s46, s34, s45
s_cmp_lg_u32 s46, 0
s_cselect_b32 s46, 0, 0xff800000
v_subrev_u32 v15, 0, v14
v_cmp_ge_u32 vcc, 7, v15
v_add_u32 v15, 16, v15
s_nop 0
v_cndmask_b32 v248, v16, 0, vcc
v_cmp_ge_u32 vcc, 7, v15
s_nop 1
v_cndmask_b32 v244, v16, 0, vcc
v_or_b32 v240, s46, v244
v_subrev_u32 v15, 1, v14
v_cmp_ge_u32 vcc, 7, v15
v_add_u32 v15, 16, v15
s_nop 0
v_cndmask_b32 v249, v16, 0, vcc
v_cmp_ge_u32 vcc, 7, v15
s_nop 1
v_cndmask_b32 v245, v16, 0, vcc
v_or_b32 v241, s46, v245
v_subrev_u32 v15, 2, v14
v_cmp_ge_u32 vcc, 7, v15
v_add_u32 v15, 16, v15
s_nop 0
v_cndmask_b32 v250, v16, 0, vcc
v_cmp_ge_u32 vcc, 7, v15
s_nop 1
v_cndmask_b32 v246, v16, 0, vcc
v_or_b32 v242, s46, v246
v_subrev_u32 v15, 3, v14
v_cmp_ge_u32 vcc, 7, v15
v_add_u32 v15, 16, v15
s_nop 0
v_cndmask_b32 v251, v16, 0, vcc
v_cmp_ge_u32 vcc, 7, v15
s_nop 1
v_cndmask_b32 v247, v16, 0, vcc
v_or_b32 v243, s46, v247
s_lshl_b32 s46, s45, 6
s_add_u32 s46, s46, s44
s_add_u32 s46, s46, 16
v_lshl_add_u32 v14, v12, 1, s46
s_lshl_b32 s47, s43, 6
v_lshl_add_u32 v15, v13, 4, s47
v_mul_u32_u24 v20, 400, v14
v_add_u32 v20, v20, v15
v_subrev_u32 v16, 32, v14
v_max_i32 v16, 0, v16
v_mul_u32_u24 v21, 400, v16
v_add_u32 v21, v21, v15
v_lshrrev_b32 v16, 2, v12
v_lshl_add_u32 v16, v13, 2, v16
v_lshl_add_u32 v16, v16, 1, s46
v_and_b32 v17, 3, v1
v_lshl_add_u32 v17, v17, 3, s47
v_mul_u32_u24 v22, 400, v16
v_add_u32 v22, v22, v17
v_subrev_u32 v16, 32, v16
v_max_i32 v16, 0, v16
v_mul_u32_u24 v23, 400, v16
v_add_u32 v23, v23, v17
s_mul_i32 s60, s34, 262144
s_add_u32 s16, s82, s60
s_addc_u32 s17, s83, 0
s_mov_b32 s18, 262144
s_mov_b32 s19, 0x20000
s_lshl_b32 s60, s35, 14
s_lshl_b32 s43, s43, 13
s_add_u32 s60, s60, s43
s_lshl_b32 s43, s45, 12
s_add_u32 s60, s60, s43
s_lshl_b32 s43, s44, 10
s_add_u32 s60, s60, s43
v_lshlrev_b32 v24, 4, v1
s_mov_b32 s61, 0x3e8293ee
s_lshl_b32 s38, s35, 7
Latt_5:
s_barrier
ds_read_b128 v[32:35], v20 offset:0
ds_read_b128 v[36:39], v20 offset:128
ds_read_b128 v[40:43], v21 offset:128
ds_read_b128 v[80:83], v20 offset:12800
ds_read_b128 v[84:87], v20 offset:12928
ds_read_b128 v[88:91], v20 offset:128
ds_read_b64_tr_b16 v[44:45], v23 offset:256
ds_read_b64_tr_b16 v[46:47], v22 offset:256
ds_read_b64_tr_b16 v[48:49], v23 offset:288
ds_read_b64_tr_b16 v[50:51], v22 offset:288
ds_read_b64_tr_b16 v[92:93], v22 offset:256
ds_read_b64_tr_b16 v[94:95], v22 offset:13056
ds_read_b64_tr_b16 v[96:97], v22 offset:288
ds_read_b64_tr_b16 v[98:99], v22 offset:13088
s_waitcnt lgkmcnt(11)
v_mfma_f32_16x16x32_bf16 v[52:55], v[40:43], v[32:35], v[240:243]
v_mfma_f32_16x16x32_bf16 v[56:59], v[36:39], v[32:35], v[248:251]
s_waitcnt lgkmcnt(8)
v_mfma_f32_16x16x32_bf16 v[100:103], v[88:91], v[80:83], v[244:247]
v_mfma_f32_16x16x32_bf16 v[104:107], v[84:87], v[80:83], v[248:251]
s_nop 4
v_max3_f32 v60, v52, v53, v54
v_max3_f32 v108, v100, v101, v102
v_max3_f32 v61, v55, v56, v57
v_max3_f32 v109, v103, v104, v105
v_max3_f32 v60, v60, v58, v59
v_max3_f32 v108, v108, v106, v107
v_max_f32 v60, v60, v61
v_max_f32 v108, v108, v109
s_nop 0
v_permlane32_swap_b32 v60, v108
v_max_f32 v60, v60, v108
v_mov_b32 v61, v60
s_nop 1
v_permlane16_swap_b32 v60, v61
v_max_f32 v60, v60, v61
v_mul_f32 v60, s61, v60
s_nop 0
v_mov_b32 v108, v60
s_nop 1
v_permlane32_swap_b32 v60, v108
v_fma_f32 v52, v52, s61, -v60
v_fma_f32 v100, v100, s61, -v108
v_fma_f32 v53, v53, s61, -v60
v_fma_f32 v101, v101, s61, -v108
v_fma_f32 v54, v54, s61, -v60
v_fma_f32 v102, v102, s61, -v108
v_fma_f32 v55, v55, s61, -v60
v_fma_f32 v103, v103, s61, -v108
v_fma_f32 v56, v56, s61, -v60
v_fma_f32 v104, v104, s61, -v108
v_fma_f32 v57, v57, s61, -v60
v_fma_f32 v105, v105, s61, -v108
v_fma_f32 v58, v58, s61, -v60
v_fma_f32 v106, v106, s61, -v108
v_fma_f32 v59, v59, s61, -v60
v_fma_f32 v107, v107, s61, -v108
v_exp_f32 v52, v52
v_exp_f32 v100, v100
v_exp_f32 v53, v53
v_exp_f32 v101, v101
v_exp_f32 v54, v54
v_exp_f32 v102, v102
v_exp_f32 v55, v55
v_exp_f32 v103, v103
v_exp_f32 v56, v56
v_exp_f32 v104, v104
v_exp_f32 v57, v57
v_exp_f32 v105, v105
v_exp_f32 v58, v58
v_exp_f32 v106, v106
v_exp_f32 v59, v59
v_exp_f32 v107, v107
v_cvt_pk_bf16_f32 v64, v52, v53
v_cvt_pk_bf16_f32 v112, v100, v101
v_cvt_pk_bf16_f32 v65, v54, v55
v_cvt_pk_bf16_f32 v113, v102, v103
v_cvt_pk_bf16_f32 v66, v56, v57
v_cvt_pk_bf16_f32 v114, v104, v105
v_cvt_pk_bf16_f32 v67, v58, v59
v_cvt_pk_bf16_f32 v115, v106, v107
v_pk_add_f32 v[52:53], v[52:53], v[54:55]
v_pk_add_f32 v[100:101], v[100:101], v[102:103]
v_pk_add_f32 v[56:57], v[56:57], v[58:59]
v_pk_add_f32 v[104:105], v[104:105], v[106:107]
s_waitcnt lgkmcnt(0)
s_waitcnt lgkmcnt(0)
v_mfma_f32_16x16x32_bf16 v[68:71], v[44:47], v[64:67], 0
v_mfma_f32_16x16x32_bf16 v[116:119], v[92:95], v[112:115], 0
v_mfma_f32_16x16x32_bf16 v[72:75], v[48:51], v[64:67], 0
v_mfma_f32_16x16x32_bf16 v[120:123], v[96:99], v[112:115], 0
v_pk_add_f32 v[52:53], v[52:53], v[56:57]
v_pk_add_f32 v[100:101], v[100:101], v[104:105]
v_add_f32 v60, v52, v53
v_add_f32 v108, v100, v101
s_nop 0
v_permlane32_swap_b32 v60, v108
v_add_f32 v60, v60, v108
v_mov_b32 v61, v60
s_nop 1
v_permlane16_swap_b32 v60, v61
v_add_f32 v60, v60, v61
v_rcp_f32 v60, v60
s_nop 0
v_mov_b32 v108, v60
s_nop 1
v_permlane32_swap_b32 v60, v108
v_pk_mul_f32 v[68:69], v[60:61], v[68:69] op_sel_hi:[0,1]
v_pk_mul_f32 v[116:117], v[108:109], v[116:117] op_sel_hi:[0,1]
v_pk_mul_f32 v[70:71], v[60:61], v[70:71] op_sel_hi:[0,1]
v_pk_mul_f32 v[118:119], v[108:109], v[118:119] op_sel_hi:[0,1]
v_pk_mul_f32 v[72:73], v[60:61], v[72:73] op_sel_hi:[0,1]
v_pk_mul_f32 v[120:121], v[108:109], v[120:121] op_sel_hi:[0,1]
v_pk_mul_f32 v[74:75], v[60:61], v[74:75] op_sel_hi:[0,1]
v_pk_mul_f32 v[122:123], v[108:109], v[122:123] op_sel_hi:[0,1]
v_cvt_pk_bf16_f32 v64, v68, v69
v_cvt_pk_bf16_f32 v112, v116, v117
v_cvt_pk_bf16_f32 v65, v70, v71
v_cvt_pk_bf16_f32 v113, v118, v119
v_cvt_pk_bf16_f32 v66, v72, v73
v_cvt_pk_bf16_f32 v114, v120, v121
v_cvt_pk_bf16_f32 v67, v74, v75
v_cvt_pk_bf16_f32 v115, v122, v123
buffer_store_dwordx4 v[64:67], v24, s[16:19], s60 offen offset:0 sc1
buffer_store_dwordx4 v[112:115], v24, s[16:19], s60 offen offset:2048 sc1
s_add_u32 s56, s82, 28311552
s_addc_u32 s57, s83, 0
s_mov_b32 s58, 114688
s_mov_b32 s59, 0x20000
s_lshl_b32 s7, s34, 12
s_add_u32 s7, s7, 49152
v_lshl_add_u32 v26, v1, 8, s7
v_mov_b32 v27, 1
s_cmp_ge_u32 s36, 4
s_cbranch_scc1 Lh_81
s_waitcnt vmcnt(0)
s_branch Lo_80
Lh_81:
s_waitcnt vmcnt(0)
Lo_80:
s_cmp_lg_u32 s36, 0
s_barrier
s_cbranch_scc1 Lsig_82
s_mov_b64 exec, 0xffff
buffer_atomic_add v27, v26, s[56:59], 0 offen sc1
s_mov_b64 exec, -1
Lsig_82:
s_cmp_ge_u32 s36, 4
s_cbranch_scc1 Lprod_84
v_and_b32 v12, 15, v1
v_lshrrev_b32 v13, 4, v1
v_lshlrev_b32 v10, 12, v12
v_and_b32 v14, 1, v13
v_lshl_add_u32 v10, v14, 5, v10
v_lshrrev_b32 v14, 1, v13
v_lshl_add_u32 v10, v14, 4, v10
s_lshl_b32 s43, s34, 18
s_lshl_b32 s44, s36, 16
s_add_u32 s43, s43, s44
s_lshl_b32 s44, s35, 7
s_add_u32 s43, s43, s44
buffer_load_dwordx4 v[128:131], v10, s[8:11], s43 offen offset:0
buffer_load_dwordx4 v[132:135], v10, s[8:11], s43 offen offset:64
buffer_load_dwordx4 v[136:139], v10, s[8:11], s43 offen offset:2048
buffer_load_dwordx4 v[140:143], v10, s[8:11], s43 offen offset:2112
v_and_b32 v12, 15, v1
v_lshrrev_b32 v13, 4, v1
s_mul_i32 s43, s34, 262144
s_add_u32 s20, s82, s43
s_addc_u32 s21, s83, 0
s_add_u32 s20, s20, 4194304
s_addc_u32 s21, s21, 0
s_mov_b32 s22, 262144
s_mov_b32 s23, 0x20000
s_mul_i32 s43, s34, 16384
s_add_u32 s24, s82, s43
s_addc_u32 s25, s83, 0
s_add_u32 s24, s24, 25165824
s_addc_u32 s25, s25, 0
s_mov_b32 s26, 16384
s_mov_b32 s27, 0x20000
v_lshlrev_b32 v11, 4, v1
s_lshl_b32 s43, s36, 11
v_add_u32 v2, s43, v11
v_add_u32 v3, 98304, v2
v_lshrrev_b32 v14, 2, v1
v_bfe_u32 v15, v14, 1, 2
v_mul_u32_u24 v14, 128, v14
v_lshl_add_u32 v14, v15, 5, v14
v_and_b32 v15, 3, v1
v_lshl_add_u32 v4, v15, 3, v14
v_xor_b32 v5, 32, v4
v_xor_b32 v6, 64, v4
v_xor_b32 v7, 96, v4
v_add_u32 v16, 0x10000, v4
v_add_u32 v20, 0x20000, v4
v_add_u32 v17, 0x10000, v5
v_add_u32 v21, 0x20000, v5
v_add_u32 v18, 0x10000, v6
v_add_u32 v22, 0x20000, v6
v_add_u32 v19, 0x10000, v7
v_add_u32 v23, 0x20000, v7
s_lshl_b32 s44, s35, 14
s_add_u32 s60, s44, s43
v_lshrrev_b32 v14, 1, v13
v_lshlrev_b32 v14, 11, v14
v_lshl_add_u32 v14, v12, 3, v14
v_and_b32 v15, 1, v13
v_lshl_add_u32 v14, v15, 2, v14
s_lshl_b32 s43, s36, 12
s_lshl_b32 s44, s35, 7
s_add_u32 s43, s43, s44
v_add_u32 v9, s43, v14
s_mov_b32 s61, 0x3f803f80
s_waitcnt vmcnt(0)
v_permlane16_swap_b32 v128, v130
v_permlane16_swap_b32 v129, v131
v_permlane16_swap_b32 v132, v134
v_permlane16_swap_b32 v133, v135
v_permlane16_swap_b32 v136, v138
v_permlane16_swap_b32 v137, v139
v_permlane16_swap_b32 v140, v142
v_permlane16_swap_b32 v141, v143
v_lshlrev_b32 v96, 16, v128
v_and_b32 v97, 0xffff0000, v128
v_lshlrev_b32 v98, 16, v129
v_and_b32 v99, 0xffff0000, v129
v_lshlrev_b32 v100, 16, v130
v_and_b32 v101, 0xffff0000, v130
v_lshlrev_b32 v102, 16, v131
v_and_b32 v103, 0xffff0000, v131
v_lshlrev_b32 v104, 16, v132
v_and_b32 v105, 0xffff0000, v132
v_lshlrev_b32 v106, 16, v133
v_and_b32 v107, 0xffff0000, v133
v_lshlrev_b32 v108, 16, v134
v_and_b32 v109, 0xffff0000, v134
v_lshlrev_b32 v110, 16, v135
v_and_b32 v111, 0xffff0000, v135
v_lshlrev_b32 v112, 16, v136
v_and_b32 v113, 0xffff0000, v136
v_lshlrev_b32 v114, 16, v137
v_and_b32 v115, 0xffff0000, v137
v_lshlrev_b32 v116, 16, v138
v_and_b32 v117, 0xffff0000, v138
v_lshlrev_b32 v118, 16, v139
v_and_b32 v119, 0xffff0000, v139
v_lshlrev_b32 v120, 16, v140
v_and_b32 v121, 0xffff0000, v140
v_lshlrev_b32 v122, 16, v141
v_and_b32 v123, 0xffff0000, v141
v_lshlrev_b32 v124, 16, v142
v_and_b32 v125, 0xffff0000, v142
v_lshlrev_b32 v126, 16, v143
v_and_b32 v127, 0xffff0000, v143
s_cmp_lg_u32 s36, 0
s_cbranch_scc1 Lwm_87
s_nop 0
s_branch Lwe_86
Lwm_87:
s_cmp_lg_u32 s36, 1
s_cbranch_scc1 Lwm_88
s_nop 0
s_branch Lwe_86
Lwm_88:
s_cmp_lg_u32 s36, 2
s_cbranch_scc1 Lwm_89
s_nop 0
s_branch Lwe_86
Lwm_89:
s_cmp_lg_u32 s36, 3
s_cbranch_scc1 Lwm_90
s_nop 0
s_branch Lwe_86
Lwm_90:
Lwe_86:
s_barrier
ds_read_b128 v[32:35], v2 offset:0
ds_read_b64_tr_b16 v[40:41], v16 offset:0
ds_read_b64_tr_b16 v[42:43], v16 offset:2048
ds_read_b64_tr_b16 v[44:45], v17 offset:0
ds_read_b64_tr_b16 v[46:47], v17 offset:2048
ds_read_b64_tr_b16 v[48:49], v18 offset:0
ds_read_b64_tr_b16 v[50:51], v18 offset:2048
ds_read_b64_tr_b16 v[52:53], v19 offset:0
ds_read_b64_tr_b16 v[54:55], v19 offset:2048
ds_read_b128 v[36:39], v2 offset:1024
ds_read_b128 v[56:59], v2 offset:8192
ds_read_b64_tr_b16 v[64:65], v16 offset:4096
ds_read_b64_tr_b16 v[66:67], v16 offset:6144
ds_read_b64_tr_b16 v[68:69], v17 offset:4096
ds_read_b64_tr_b16 v[70:71], v17 offset:6144
ds_read_b64_tr_b16 v[72:73], v18 offset:4096
ds_read_b64_tr_b16 v[74:75], v18 offset:6144
ds_read_b64_tr_b16 v[76:77], v19 offset:4096
ds_read_b64_tr_b16 v[78:79], v19 offset:6144
ds_read_b128 v[60:63], v2 offset:9216
s_waitcnt lgkmcnt(0)
s_barrier
v_mfma_f32_16x16x32_bf16 v[96:99], v[40:43], v[32:35], v[96:99]
ds_read_b128 v[144:147], v2 offset:49152
ds_read_b64_tr_b16 v[152:153], v16 offset:8192
v_mfma_f32_16x16x32_bf16 v[100:103], v[44:47], v[32:35], v[100:103]
ds_read_b64_tr_b16 v[154:155], v16 offset:10240
ds_read_b64_tr_b16 v[156:157], v17 offset:8192
v_mfma_f32_16x16x32_bf16 v[104:107], v[48:51], v[32:35], v[104:107]
ds_read_b64_tr_b16 v[158:159], v17 offset:10240
ds_read_b64_tr_b16 v[160:161], v18 offset:8192
v_mfma_f32_16x16x32_bf16 v[108:111], v[52:55], v[32:35], v[108:111]
ds_read_b64_tr_b16 v[162:163], v18 offset:10240
ds_read_b64_tr_b16 v[164:165], v19 offset:8192
v_mfma_f32_16x16x32_bf16 v[124:127], v[52:55], v[36:39], v[124:127]
ds_read_b64_tr_b16 v[166:167], v19 offset:10240
ds_read_b128 v[148:151], v2 offset:50176
v_mfma_f32_16x16x32_bf16 v[120:123], v[48:51], v[36:39], v[120:123]
ds_read_b128 v[168:171], v2 offset:57344
ds_read_b64_tr_b16 v[176:177], v16 offset:12288
v_mfma_f32_16x16x32_bf16 v[116:119], v[44:47], v[36:39], v[116:119]
ds_read_b64_tr_b16 v[178:179], v16 offset:14336
ds_read_b64_tr_b16 v[180:181], v17 offset:12288
v_mfma_f32_16x16x32_bf16 v[112:115], v[40:43], v[36:39], v[112:115]
ds_read_b64_tr_b16 v[182:183], v17 offset:14336
ds_read_b64_tr_b16 v[184:185], v18 offset:12288
v_mfma_f32_16x16x32_bf16 v[96:99], v[64:67], v[56:59], v[96:99]
ds_read_b64_tr_b16 v[186:187], v18 offset:14336
ds_read_b64_tr_b16 v[188:189], v19 offset:12288
v_mfma_f32_16x16x32_bf16 v[100:103], v[68:71], v[56:59], v[100:103]
ds_read_b64_tr_b16 v[190:191], v19 offset:14336
ds_read_b128 v[172:175], v2 offset:58368
s_branch Lov_5
.p2align 12
.fill 32, 4, 0xbf800000
Lst_5_0:
s_branch Lwr_151
s_nop 0
s_nop 0
Lov_5:
v_mfma_f32_16x16x32_bf16 v[104:107], v[72:75], v[56:59], v[104:107]
s_bitcmp0_b32 s36, 1
v_mfma_f32_16x16x32_bf16 v[108:111], v[76:79], v[56:59], v[108:111]
s_cselect_b32 s44, s72, s74
v_mfma_f32_16x16x32_bf16 v[124:127], v[76:79], v[60:63], v[124:127]
s_cselect_b32 s45, s73, s75
v_mfma_f32_16x16x32_bf16 v[120:123], v[72:75], v[60:63], v[120:123]
s_mul_i32 s43, s35, 192
v_mfma_f32_16x16x32_bf16 v[116:119], v[68:71], v[60:63], v[116:119]
s_add_u32 s16, s44, s43
v_mfma_f32_16x16x32_bf16 v[112:115], v[64:67], v[60:63], v[112:115]
s_addc_u32 s17, s45, 0
s_waitcnt lgkmcnt(0)
s_barrier
v_mfma_f32_16x16x32_bf16 v[96:99], v[152:155], v[144:147], v[96:99]
ds_read_b128 v[32:35], v3 offset:0
ds_read_b64_tr_b16 v[40:41], v16 offset:16384
v_mfma_f32_16x16x32_bf16 v[100:103], v[156:159], v[144:147], v[100:103]
ds_read_b64_tr_b16 v[42:43], v16 offset:18432
ds_read_b64_tr_b16 v[44:45], v17 offset:16384
v_mfma_f32_16x16x32_bf16 v[104:107], v[160:163], v[144:147], v[104:107]
ds_read_b64_tr_b16 v[46:47], v17 offset:18432
ds_read_b64_tr_b16 v[48:49], v18 offset:16384
v_mfma_f32_16x16x32_bf16 v[108:111], v[164:167], v[144:147], v[108:111]
ds_read_b64_tr_b16 v[50:51], v18 offset:18432
ds_read_b64_tr_b16 v[52:53], v19 offset:16384
v_mfma_f32_16x16x32_bf16 v[124:127], v[164:167], v[148:151], v[124:127]
ds_read_b64_tr_b16 v[54:55], v19 offset:18432
ds_read_b128 v[36:39], v3 offset:1024
v_mfma_f32_16x16x32_bf16 v[120:123], v[160:163], v[148:151], v[120:123]
ds_read_b128 v[56:59], v3 offset:8192
ds_read_b64_tr_b16 v[64:65], v16 offset:20480
v_mfma_f32_16x16x32_bf16 v[116:119], v[156:159], v[148:151], v[116:119]
ds_read_b64_tr_b16 v[66:67], v16 offset:22528
ds_read_b64_tr_b16 v[68:69], v17 offset:20480
v_mfma_f32_16x16x32_bf16 v[112:115], v[152:155], v[148:151], v[112:115]
ds_read_b64_tr_b16 v[70:71], v17 offset:22528
ds_read_b64_tr_b16 v[72:73], v18 offset:20480
v_mfma_f32_16x16x32_bf16 v[96:99], v[176:179], v[168:171], v[96:99]
ds_read_b64_tr_b16 v[74:75], v18 offset:22528
ds_read_b64_tr_b16 v[76:77], v19 offset:20480
v_mfma_f32_16x16x32_bf16 v[100:103], v[180:183], v[168:171], v[100:103]
ds_read_b64_tr_b16 v[78:79], v19 offset:22528
ds_read_b128 v[60:63], v3 offset:9216
v_mfma_f32_16x16x32_bf16 v[104:107], v[184:187], v[168:171], v[104:107]
s_add_u32 s16, s16, 4096
v_mfma_f32_16x16x32_bf16 v[108:111], v[188:191], v[168:171], v[108:111]
s_addc_u32 s17, s17, 0
v_mfma_f32_16x16x32_bf16 v[124:127], v[188:191], v[172:175], v[124:127]
s_mov_b32 s18, 7333056
v_mfma_f32_16x16x32_bf16 v[120:123], v[184:187], v[172:175], v[120:123]
s_mov_b32 s19, 0x20000
v_mfma_f32_16x16x32_bf16 v[116:119], v[180:183], v[172:175], v[116:119]
v_add_u32 v196, 0, v1
v_mfma_f32_16x16x32_bf16 v[112:115], v[176:179], v[172:175], v[112:115]
v_mul_u32_u24 v197, 5462, v196
s_waitcnt lgkmcnt(0)
s_barrier
v_mfma_f32_16x16x32_bf16 v[96:99], v[40:43], v[32:35], v[96:99]
ds_read_b128 v[144:147], v3 offset:49152
ds_read_b64_tr_b16 v[152:153], v16 offset:24576
v_mfma_f32_16x16x32_bf16 v[100:103], v[44:47], v[32:35], v[100:103]
ds_read_b64_tr_b16 v[154:155], v16 offset:26624
ds_read_b64_tr_b16 v[156:157], v17 offset:24576
v_mfma_f32_16x16x32_bf16 v[104:107], v[48:51], v[32:35], v[104:107]
ds_read_b64_tr_b16 v[158:159], v17 offset:26624
ds_read_b64_tr_b16 v[160:161], v18 offset:24576
v_mfma_f32_16x16x32_bf16 v[108:111], v[52:55], v[32:35], v[108:111]
ds_read_b64_tr_b16 v[162:163], v18 offset:26624
ds_read_b64_tr_b16 v[164:165], v19 offset:24576
v_mfma_f32_16x16x32_bf16 v[124:127], v[52:55], v[36:39], v[124:127]
ds_read_b64_tr_b16 v[166:167], v19 offset:26624
ds_read_b128 v[148:151], v3 offset:50176
v_mfma_f32_16x16x32_bf16 v[120:123], v[48:51], v[36:39], v[120:123]
ds_read_b128 v[168:171], v3 offset:57344
ds_read_b64_tr_b16 v[176:177], v16 offset:28672
v_mfma_f32_16x16x32_bf16 v[116:119], v[44:47], v[36:39], v[116:119]
ds_read_b64_tr_b16 v[178:179], v16 offset:30720
ds_read_b64_tr_b16 v[180:181], v17 offset:28672
v_mfma_f32_16x16x32_bf16 v[112:115], v[40:43], v[36:39], v[112:115]
ds_read_b64_tr_b16 v[182:183], v17 offset:30720
ds_read_b64_tr_b16 v[184:185], v18 offset:28672
v_mfma_f32_16x16x32_bf16 v[96:99], v[64:67], v[56:59], v[96:99]
ds_read_b64_tr_b16 v[186:187], v18 offset:30720
ds_read_b64_tr_b16 v[188:189], v19 offset:28672
v_mfma_f32_16x16x32_bf16 v[100:103], v[68:71], v[56:59], v[100:103]
ds_read_b64_tr_b16 v[190:191], v19 offset:30720
ds_read_b128 v[172:175], v3 offset:58368
v_mfma_f32_16x16x32_bf16 v[104:107], v[72:75], v[56:59], v[104:107]
v_lshrrev_b32 v197, 16, v197
v_mfma_f32_16x16x32_bf16 v[108:111], v[76:79], v[56:59], v[108:111]
v_mul_u32_u24 v198, 12, v197
v_mfma_f32_16x16x32_bf16 v[124:127], v[76:79], v[60:63], v[124:127]
v_sub_u32 v198, v196, v198
v_mfma_f32_16x16x32_bf16 v[120:123], v[72:75], v[60:63], v[120:123]
v_bfe_u32 v199, v197, 2, 1
v_mfma_f32_16x16x32_bf16 v[116:119], v[68:71], v[60:63], v[116:119]
v_cmp_gt_u32 vcc, 8, v198
v_mfma_f32_16x16x32_bf16 v[112:115], v[64:67], v[60:63], v[112:115]
v_lshlrev_b32 v200, 1, v199
s_waitcnt lgkmcnt(0)
s_barrier
v_mfma_f32_16x16x32_bf16 v[96:99], v[152:155], v[144:147], v[96:99]
ds_read_b128 v[32:35], v2 offset:0
ds_read_b64_tr_b16 v[40:41], v16 offset:49152
v_mfma_f32_16x16x32_bf16 v[100:103], v[156:159], v[144:147], v[100:103]
ds_read_b64_tr_b16 v[42:43], v16 offset:51200
ds_read_b64_tr_b16 v[44:45], v17 offset:49152
v_mfma_f32_16x16x32_bf16 v[104:107], v[160:163], v[144:147], v[104:107]
ds_read_b64_tr_b16 v[46:47], v17 offset:51200
ds_read_b64_tr_b16 v[48:49], v18 offset:49152
v_mfma_f32_16x16x32_bf16 v[108:111], v[164:167], v[144:147], v[108:111]
ds_read_b64_tr_b16 v[50:51], v18 offset:51200
ds_read_b64_tr_b16 v[52:53], v19 offset:49152
v_mfma_f32_16x16x32_bf16 v[124:127], v[164:167], v[148:151], v[124:127]
ds_read_b64_tr_b16 v[54:55], v19 offset:51200
ds_read_b128 v[36:39], v2 offset:1024
v_mfma_f32_16x16x32_bf16 v[120:123], v[160:163], v[148:151], v[120:123]
ds_read_b128 v[56:59], v2 offset:8192
ds_read_b64_tr_b16 v[64:65], v16 offset:53248
v_mfma_f32_16x16x32_bf16 v[116:119], v[156:159], v[148:151], v[116:119]
ds_read_b64_tr_b16 v[66:67], v16 offset:55296
ds_read_b64_tr_b16 v[68:69], v17 offset:53248
v_mfma_f32_16x16x32_bf16 v[112:115], v[152:155], v[148:151], v[112:115]
ds_read_b64_tr_b16 v[70:71], v17 offset:55296
ds_read_b64_tr_b16 v[72:73], v18 offset:53248
v_mfma_f32_16x16x32_bf16 v[96:99], v[176:179], v[168:171], v[96:99]
ds_read_b64_tr_b16 v[74:75], v18 offset:55296
ds_read_b64_tr_b16 v[76:77], v19 offset:53248
v_mfma_f32_16x16x32_bf16 v[100:103], v[180:183], v[168:171], v[100:103]
ds_read_b64_tr_b16 v[78:79], v19 offset:55296
ds_read_b128 v[60:63], v2 offset:9216
v_mfma_f32_16x16x32_bf16 v[104:107], v[184:187], v[168:171], v[104:107]
v_mul_u32_u24 v197, 7168, v197
v_mfma_f32_16x16x32_bf16 v[108:111], v[188:191], v[168:171], v[108:111]
v_cndmask_b32 v199, v199, v200, vcc
v_mfma_f32_16x16x32_bf16 v[124:127], v[188:191], v[172:175], v[124:127]
v_xor_b32 v198, v198, v199
v_mfma_f32_16x16x32_bf16 v[120:123], v[184:187], v[172:175], v[120:123]
v_lshl_add_u32 v192, v198, 4, v197
v_mfma_f32_16x16x32_bf16 v[116:119], v[180:183], v[172:175], v[116:119]
v_add_u32 v196, 64, v1
v_mfma_f32_16x16x32_bf16 v[112:115], v[176:179], v[172:175], v[112:115]
v_mul_u32_u24 v197, 5462, v196
s_waitcnt lgkmcnt(0)
s_barrier
v_mfma_f32_16x16x32_bf16 v[96:99], v[40:43], v[32:35], v[96:99]
ds_read_b128 v[144:147], v2 offset:49152
ds_read_b64_tr_b16 v[152:153], v16 offset:57344
v_mfma_f32_16x16x32_bf16 v[100:103], v[44:47], v[32:35], v[100:103]
ds_read_b64_tr_b16 v[154:155], v16 offset:59392
ds_read_b64_tr_b16 v[156:157], v17 offset:57344
v_mfma_f32_16x16x32_bf16 v[104:107], v[48:51], v[32:35], v[104:107]
ds_read_b64_tr_b16 v[158:159], v17 offset:59392
ds_read_b64_tr_b16 v[160:161], v18 offset:57344
v_mfma_f32_16x16x32_bf16 v[108:111], v[52:55], v[32:35], v[108:111]
ds_read_b64_tr_b16 v[162:163], v18 offset:59392
ds_read_b64_tr_b16 v[164:165], v19 offset:57344
v_mfma_f32_16x16x32_bf16 v[124:127], v[52:55], v[36:39], v[124:127]
ds_read_b64_tr_b16 v[166:167], v19 offset:59392
ds_read_b128 v[148:151], v2 offset:50176
v_mfma_f32_16x16x32_bf16 v[120:123], v[48:51], v[36:39], v[120:123]
ds_read_b128 v[168:171], v2 offset:57344
ds_read_b64_tr_b16 v[176:177], v16 offset:61440
v_mfma_f32_16x16x32_bf16 v[116:119], v[44:47], v[36:39], v[116:119]
ds_read_b64_tr_b16 v[178:179], v16 offset:63488
ds_read_b64_tr_b16 v[180:181], v17 offset:61440
v_mfma_f32_16x16x32_bf16 v[112:115], v[40:43], v[36:39], v[112:115]
ds_read_b64_tr_b16 v[182:183], v17 offset:63488
ds_read_b64_tr_b16 v[184:185], v18 offset:61440
v_mfma_f32_16x16x32_bf16 v[96:99], v[64:67], v[56:59], v[96:99]
ds_read_b64_tr_b16 v[186:187], v18 offset:63488
ds_read_b64_tr_b16 v[188:189], v19 offset:61440
v_mfma_f32_16x16x32_bf16 v[100:103], v[68:71], v[56:59], v[100:103]
ds_read_b64_tr_b16 v[190:191], v19 offset:63488
ds_read_b128 v[172:175], v2 offset:58368
v_mfma_f32_16x16x32_bf16 v[104:107], v[72:75], v[56:59], v[104:107]
v_lshrrev_b32 v197, 16, v197
v_mfma_f32_16x16x32_bf16 v[108:111], v[76:79], v[56:59], v[108:111]
v_mul_u32_u24 v198, 12, v197
v_mfma_f32_16x16x32_bf16 v[124:127], v[76:79], v[60:63], v[124:127]
v_sub_u32 v198, v196, v198
v_mfma_f32_16x16x32_bf16 v[120:123], v[72:75], v[60:63], v[120:123]
v_bfe_u32 v199, v197, 2, 1
v_mfma_f32_16x16x32_bf16 v[116:119], v[68:71], v[60:63], v[116:119]
v_cmp_gt_u32 vcc, 8, v198
v_mfma_f32_16x16x32_bf16 v[112:115], v[64:67], v[60:63], v[112:115]
v_lshlrev_b32 v200, 1, v199
s_waitcnt lgkmcnt(0)
s_barrier
v_mfma_f32_16x16x32_bf16 v[96:99], v[152:155], v[144:147], v[96:99]
ds_read_b128 v[32:35], v3 offset:0
ds_read_b64_tr_b16 v[40:41], v20 offset:0
v_mfma_f32_16x16x32_bf16 v[100:103], v[156:159], v[144:147], v[100:103]
ds_read_b64_tr_b16 v[42:43], v20 offset:2048
ds_read_b64_tr_b16 v[44:45], v21 offset:0
v_mfma_f32_16x16x32_bf16 v[104:107], v[160:163], v[144:147], v[104:107]
ds_read_b64_tr_b16 v[46:47], v21 offset:2048
ds_read_b64_tr_b16 v[48:49], v22 offset:0
v_mfma_f32_16x16x32_bf16 v[108:111], v[164:167], v[144:147], v[108:111]
ds_read_b64_tr_b16 v[50:51], v22 offset:2048
ds_read_b64_tr_b16 v[52:53], v23 offset:0
v_mfma_f32_16x16x32_bf16 v[124:127], v[164:167], v[148:151], v[124:127]
ds_read_b64_tr_b16 v[54:55], v23 offset:2048
ds_read_b128 v[36:39], v3 offset:1024
v_mfma_f32_16x16x32_bf16 v[120:123], v[160:163], v[148:151], v[120:123]
ds_read_b128 v[56:59], v3 offset:8192
ds_read_b64_tr_b16 v[64:65], v20 offset:4096
v_mfma_f32_16x16x32_bf16 v[116:119], v[156:159], v[148:151], v[116:119]
ds_read_b64_tr_b16 v[66:67], v20 offset:6144
ds_read_b64_tr_b16 v[68:69], v21 offset:4096
v_mfma_f32_16x16x32_bf16 v[112:115], v[152:155], v[148:151], v[112:115]
ds_read_b64_tr_b16 v[70:71], v21 offset:6144
ds_read_b64_tr_b16 v[72:73], v22 offset:4096
v_mfma_f32_16x16x32_bf16 v[96:99], v[176:179], v[168:171], v[96:99]
ds_read_b64_tr_b16 v[74:75], v22 offset:6144
ds_read_b64_tr_b16 v[76:77], v23 offset:4096
v_mfma_f32_16x16x32_bf16 v[100:103], v[180:183], v[168:171], v[100:103]
ds_read_b64_tr_b16 v[78:79], v23 offset:6144
ds_read_b128 v[60:63], v3 offset:9216
v_mfma_f32_16x16x32_bf16 v[104:107], v[184:187], v[168:171], v[104:107]
v_mul_u32_u24 v197, 7168, v197
v_mfma_f32_16x16x32_bf16 v[108:111], v[188:191], v[168:171], v[108:111]
v_cndmask_b32 v199, v199, v200, vcc
v_mfma_f32_16x16x32_bf16 v[124:127], v[188:191], v[172:175], v[124:127]
v_xor_b32 v198, v198, v199
v_mfma_f32_16x16x32_bf16 v[120:123], v[184:187], v[172:175], v[120:123]
v_lshl_add_u32 v193, v198, 4, v197
v_mfma_f32_16x16x32_bf16 v[116:119], v[180:183], v[172:175], v[116:119]
v_add_u32 v196, 128, v1
v_mfma_f32_16x16x32_bf16 v[112:115], v[176:179], v[172:175], v[112:115]
v_mul_u32_u24 v197, 5462, v196
s_waitcnt lgkmcnt(0)
s_barrier
v_mfma_f32_16x16x32_bf16 v[96:99], v[40:43], v[32:35], v[96:99]
ds_read_b128 v[144:147], v3 offset:49152
ds_read_b64_tr_b16 v[152:153], v20 offset:8192
v_mfma_f32_16x16x32_bf16 v[100:103], v[44:47], v[32:35], v[100:103]
ds_read_b64_tr_b16 v[154:155], v20 offset:10240
ds_read_b64_tr_b16 v[156:157], v21 offset:8192
v_mfma_f32_16x16x32_bf16 v[104:107], v[48:51], v[32:35], v[104:107]
ds_read_b64_tr_b16 v[158:159], v21 offset:10240
ds_read_b64_tr_b16 v[160:161], v22 offset:8192
v_mfma_f32_16x16x32_bf16 v[108:111], v[52:55], v[32:35], v[108:111]
ds_read_b64_tr_b16 v[162:163], v22 offset:10240
ds_read_b64_tr_b16 v[164:165], v23 offset:8192
v_mfma_f32_16x16x32_bf16 v[124:127], v[52:55], v[36:39], v[124:127]
ds_read_b64_tr_b16 v[166:167], v23 offset:10240
ds_read_b128 v[148:151], v3 offset:50176
v_mfma_f32_16x16x32_bf16 v[120:123], v[48:51], v[36:39], v[120:123]
ds_read_b128 v[168:171], v3 offset:57344
ds_read_b64_tr_b16 v[176:177], v20 offset:12288
v_mfma_f32_16x16x32_bf16 v[116:119], v[44:47], v[36:39], v[116:119]
ds_read_b64_tr_b16 v[178:179], v20 offset:14336
ds_read_b64_tr_b16 v[180:181], v21 offset:12288
v_mfma_f32_16x16x32_bf16 v[112:115], v[40:43], v[36:39], v[112:115]
ds_read_b64_tr_b16 v[182:183], v21 offset:14336
ds_read_b64_tr_b16 v[184:185], v22 offset:12288
v_mfma_f32_16x16x32_bf16 v[96:99], v[64:67], v[56:59], v[96:99]
ds_read_b64_tr_b16 v[186:187], v22 offset:14336
ds_read_b64_tr_b16 v[188:189], v23 offset:12288
v_mfma_f32_16x16x32_bf16 v[100:103], v[68:71], v[56:59], v[100:103]
ds_read_b64_tr_b16 v[190:191], v23 offset:14336
ds_read_b128 v[172:175], v3 offset:58368
v_mfma_f32_16x16x32_bf16 v[104:107], v[72:75], v[56:59], v[104:107]
v_lshrrev_b32 v197, 16, v197
v_mfma_f32_16x16x32_bf16 v[108:111], v[76:79], v[56:59], v[108:111]
v_mul_u32_u24 v198, 12, v197
v_mfma_f32_16x16x32_bf16 v[124:127], v[76:79], v[60:63], v[124:127]
v_sub_u32 v198, v196, v198
v_mfma_f32_16x16x32_bf16 v[120:123], v[72:75], v[60:63], v[120:123]
v_bfe_u32 v199, v197, 2, 1
v_mfma_f32_16x16x32_bf16 v[116:119], v[68:71], v[60:63], v[116:119]
v_cmp_gt_u32 vcc, 8, v198
v_mfma_f32_16x16x32_bf16 v[112:115], v[64:67], v[60:63], v[112:115]
v_lshlrev_b32 v200, 1, v199
s_waitcnt lgkmcnt(0)
s_barrier
v_mfma_f32_16x16x32_bf16 v[96:99], v[152:155], v[144:147], v[96:99]
ds_read_b128 v[32:35], v2 offset:0
ds_read_b64_tr_b16 v[40:41], v4 offset:16384
v_mfma_f32_16x16x32_bf16 v[100:103], v[156:159], v[144:147], v[100:103]
ds_read_b64_tr_b16 v[42:43], v4 offset:18432
ds_read_b64_tr_b16 v[44:45], v5 offset:16384
v_mfma_f32_16x16x32_bf16 v[104:107], v[160:163], v[144:147], v[104:107]
ds_read_b64_tr_b16 v[46:47], v5 offset:18432
ds_read_b64_tr_b16 v[48:49], v6 offset:16384
v_mfma_f32_16x16x32_bf16 v[108:111], v[164:167], v[144:147], v[108:111]
ds_read_b64_tr_b16 v[50:51], v6 offset:18432
ds_read_b64_tr_b16 v[52:53], v7 offset:16384
v_mfma_f32_16x16x32_bf16 v[124:127], v[164:167], v[148:151], v[124:127]
ds_read_b64_tr_b16 v[54:55], v7 offset:18432
ds_read_b128 v[36:39], v2 offset:1024
v_mfma_f32_16x16x32_bf16 v[120:123], v[160:163], v[148:151], v[120:123]
ds_read_b128 v[56:59], v2 offset:8192
ds_read_b64_tr_b16 v[64:65], v4 offset:20480
v_mfma_f32_16x16x32_bf16 v[116:119], v[156:159], v[148:151], v[116:119]
ds_read_b64_tr_b16 v[66:67], v4 offset:22528
ds_read_b64_tr_b16 v[68:69], v5 offset:20480
v_mfma_f32_16x16x32_bf16 v[112:115], v[152:155], v[148:151], v[112:115]
ds_read_b64_tr_b16 v[70:71], v5 offset:22528
ds_read_b64_tr_b16 v[72:73], v6 offset:20480
v_mfma_f32_16x16x32_bf16 v[96:99], v[176:179], v[168:171], v[96:99]
ds_read_b64_tr_b16 v[74:75], v6 offset:22528
ds_read_b64_tr_b16 v[76:77], v7 offset:20480
v_mfma_f32_16x16x32_bf16 v[100:103], v[180:183], v[168:171], v[100:103]
ds_read_b64_tr_b16 v[78:79], v7 offset:22528
ds_read_b128 v[60:63], v2 offset:9216
v_mfma_f32_16x16x32_bf16 v[104:107], v[184:187], v[168:171], v[104:107]
v_mul_u32_u24 v197, 7168, v197
v_mfma_f32_16x16x32_bf16 v[108:111], v[188:191], v[168:171], v[108:111]
v_cndmask_b32 v199, v199, v200, vcc
v_mfma_f32_16x16x32_bf16 v[124:127], v[188:191], v[172:175], v[124:127]
v_xor_b32 v198, v198, v199
v_mfma_f32_16x16x32_bf16 v[120:123], v[184:187], v[172:175], v[120:123]
v_lshl_add_u32 v194, v198, 4, v197
v_mfma_f32_16x16x32_bf16 v[116:119], v[180:183], v[172:175], v[116:119]
s_and_b32 s43, s36, 1
v_mfma_f32_16x16x32_bf16 v[112:115], v[176:179], v[172:175], v[112:115]
s_mul_i32 s43, s43, 229376
s_waitcnt lgkmcnt(0)
s_barrier
v_mfma_f32_16x16x32_bf16 v[96:99], v[40:43], v[32:35], v[96:99]
ds_read_b128 v[144:147], v2 offset:49152
ds_read_b64_tr_b16 v[152:153], v4 offset:24576
v_mfma_f32_16x16x32_bf16 v[100:103], v[44:47], v[32:35], v[100:103]
ds_read_b64_tr_b16 v[154:155], v4 offset:26624
ds_read_b64_tr_b16 v[156:157], v5 offset:24576
v_mfma_f32_16x16x32_bf16 v[104:107], v[48:51], v[32:35], v[104:107]
ds_read_b64_tr_b16 v[158:159], v5 offset:26624
ds_read_b64_tr_b16 v[160:161], v6 offset:24576
v_mfma_f32_16x16x32_bf16 v[108:111], v[52:55], v[32:35], v[108:111]
ds_read_b64_tr_b16 v[162:163], v6 offset:26624
ds_read_b64_tr_b16 v[164:165], v7 offset:24576
v_mfma_f32_16x16x32_bf16 v[124:127], v[52:55], v[36:39], v[124:127]
ds_read_b64_tr_b16 v[166:167], v7 offset:26624
ds_read_b128 v[148:151], v2 offset:50176
v_mfma_f32_16x16x32_bf16 v[120:123], v[48:51], v[36:39], v[120:123]
ds_read_b128 v[168:171], v2 offset:57344
ds_read_b64_tr_b16 v[176:177], v4 offset:28672
v_mfma_f32_16x16x32_bf16 v[116:119], v[44:47], v[36:39], v[116:119]
ds_read_b64_tr_b16 v[178:179], v4 offset:30720
ds_read_b64_tr_b16 v[180:181], v5 offset:28672
v_mfma_f32_16x16x32_bf16 v[112:115], v[40:43], v[36:39], v[112:115]
ds_read_b64_tr_b16 v[182:183], v5 offset:30720
ds_read_b64_tr_b16 v[184:185], v6 offset:28672
v_mfma_f32_16x16x32_bf16 v[96:99], v[64:67], v[56:59], v[96:99]
ds_read_b64_tr_b16 v[186:187], v6 offset:30720
ds_read_b64_tr_b16 v[188:189], v7 offset:28672
v_mfma_f32_16x16x32_bf16 v[100:103], v[68:71], v[56:59], v[100:103]
ds_read_b64_tr_b16 v[190:191], v7 offset:30720
ds_read_b128 v[172:175], v2 offset:58368
v_mfma_f32_16x16x32_bf16 v[104:107], v[72:75], v[56:59], v[104:107]
v_add_u32 v192, s43, v192
v_mfma_f32_16x16x32_bf16 v[108:111], v[76:79], v[56:59], v[108:111]
v_add_u32 v193, s43, v193
v_mfma_f32_16x16x32_bf16 v[124:127], v[76:79], v[60:63], v[124:127]
v_add_u32 v194, s43, v194
v_mfma_f32_16x16x32_bf16 v[120:123], v[72:75], v[60:63], v[120:123]
s_and_b32 s43, s36, 3
v_mfma_f32_16x16x32_bf16 v[116:119], v[68:71], v[60:63], v[116:119]
s_mul_i32 s50, s43, 6144
v_mfma_f32_16x16x32_bf16 v[112:115], v[64:67], v[60:63], v[112:115]
s_add_u32 s50, s50, 16384
s_waitcnt lgkmcnt(0)
s_barrier
v_mfma_f32_16x16x32_bf16 v[96:99], v[152:155], v[144:147], v[96:99]
ds_read_b128 v[32:35], v3 offset:0
ds_read_b64_tr_b16 v[40:41], v4 offset:32768
v_mfma_f32_16x16x32_bf16 v[100:103], v[156:159], v[144:147], v[100:103]
ds_read_b64_tr_b16 v[42:43], v4 offset:34816
ds_read_b64_tr_b16 v[44:45], v5 offset:32768
v_mfma_f32_16x16x32_bf16 v[104:107], v[160:163], v[144:147], v[104:107]
ds_read_b64_tr_b16 v[46:47], v5 offset:34816
ds_read_b64_tr_b16 v[48:49], v6 offset:32768
v_mfma_f32_16x16x32_bf16 v[108:111], v[164:167], v[144:147], v[108:111]
ds_read_b64_tr_b16 v[50:51], v6 offset:34816
ds_read_b64_tr_b16 v[52:53], v7 offset:32768
v_mfma_f32_16x16x32_bf16 v[124:127], v[164:167], v[148:151], v[124:127]
ds_read_b64_tr_b16 v[54:55], v7 offset:34816
ds_read_b128 v[36:39], v3 offset:1024
v_mfma_f32_16x16x32_bf16 v[120:123], v[160:163], v[148:151], v[120:123]
ds_read_b128 v[56:59], v3 offset:8192
ds_read_b64_tr_b16 v[64:65], v4 offset:36864
v_mfma_f32_16x16x32_bf16 v[116:119], v[156:159], v[148:151], v[116:119]
ds_read_b64_tr_b16 v[66:67], v4 offset:38912
ds_read_b64_tr_b16 v[68:69], v5 offset:36864
v_mfma_f32_16x16x32_bf16 v[112:115], v[152:155], v[148:151], v[112:115]
ds_read_b64_tr_b16 v[70:71], v5 offset:38912
ds_read_b64_tr_b16 v[72:73], v6 offset:36864
v_mfma_f32_16x16x32_bf16 v[96:99], v[176:179], v[168:171], v[96:99]
ds_read_b64_tr_b16 v[74:75], v6 offset:38912
ds_read_b64_tr_b16 v[76:77], v7 offset:36864
v_mfma_f32_16x16x32_bf16 v[100:103], v[180:183], v[168:171], v[100:103]
ds_read_b64_tr_b16 v[78:79], v7 offset:38912
ds_read_b128 v[60:63], v3 offset:9216
v_mfma_f32_16x16x32_bf16 v[104:107], v[184:187], v[168:171], v[104:107]
s_bitcmp0_b32 s2, 0
v_mfma_f32_16x16x32_bf16 v[108:111], v[188:191], v[168:171], v[108:111]
s_cselect_b32 s88, s72, s74
v_mfma_f32_16x16x32_bf16 v[124:127], v[188:191], v[172:175], v[124:127]
s_cselect_b32 s89, s73, s75
v_mfma_f32_16x16x32_bf16 v[120:123], v[184:187], v[172:175], v[120:123]
s_mov_b32 s90, 7340032
v_mfma_f32_16x16x32_bf16 v[116:119], v[180:183], v[172:175], v[116:119]
s_mov_b32 s91, 0x20000
v_mfma_f32_16x16x32_bf16 v[112:115], v[176:179], v[172:175], v[112:115]
s_bfe_u32 s44, s2, 0x30001
s_waitcnt lgkmcnt(0)
s_barrier
v_mfma_f32_16x16x32_bf16 v[96:99], v[40:43], v[32:35], v[96:99]
ds_read_b128 v[144:147], v3 offset:49152
ds_read_b64_tr_b16 v[152:153], v4 offset:40960
v_mfma_f32_16x16x32_bf16 v[100:103], v[44:47], v[32:35], v[100:103]
ds_read_b64_tr_b16 v[154:155], v4 offset:43008
ds_read_b64_tr_b16 v[156:157], v5 offset:40960
v_mfma_f32_16x16x32_bf16 v[104:107], v[48:51], v[32:35], v[104:107]
ds_read_b64_tr_b16 v[158:159], v5 offset:43008
ds_read_b64_tr_b16 v[160:161], v6 offset:40960
v_mfma_f32_16x16x32_bf16 v[108:111], v[52:55], v[32:35], v[108:111]
ds_read_b64_tr_b16 v[162:163], v6 offset:43008
ds_read_b64_tr_b16 v[164:165], v7 offset:40960
v_mfma_f32_16x16x32_bf16 v[124:127], v[52:55], v[36:39], v[124:127]
ds_read_b64_tr_b16 v[166:167], v7 offset:43008
ds_read_b128 v[148:151], v3 offset:50176
v_mfma_f32_16x16x32_bf16 v[120:123], v[48:51], v[36:39], v[120:123]
ds_read_b128 v[168:171], v3 offset:57344
ds_read_b64_tr_b16 v[176:177], v4 offset:45056
v_mfma_f32_16x16x32_bf16 v[116:119], v[44:47], v[36:39], v[116:119]
ds_read_b64_tr_b16 v[178:179], v4 offset:47104
ds_read_b64_tr_b16 v[180:181], v5 offset:45056
v_mfma_f32_16x16x32_bf16 v[112:115], v[40:43], v[36:39], v[112:115]
ds_read_b64_tr_b16 v[182:183], v5 offset:47104
ds_read_b64_tr_b16 v[184:185], v6 offset:45056
v_mfma_f32_16x16x32_bf16 v[96:99], v[64:67], v[56:59], v[96:99]
ds_read_b64_tr_b16 v[186:187], v6 offset:47104
ds_read_b64_tr_b16 v[188:189], v7 offset:45056
v_mfma_f32_16x16x32_bf16 v[100:103], v[68:71], v[56:59], v[100:103]
ds_read_b64_tr_b16 v[190:191], v7 offset:47104
ds_read_b128 v[172:175], v3 offset:58368
v_mfma_f32_16x16x32_bf16 v[104:107], v[72:75], v[56:59], v[104:107]
s_lshl_b32 s44, s44, 2
v_mfma_f32_16x16x32_bf16 v[108:111], v[76:79], v[56:59], v[108:111]
s_and_b32 s43, s36, 3
v_mfma_f32_16x16x32_bf16 v[124:127], v[76:79], v[60:63], v[124:127]
s_add_u32 s44, s44, s43
v_mfma_f32_16x16x32_bf16 v[120:123], v[72:75], v[60:63], v[120:123]
s_lshl_b32 s44, s44, 5
v_mfma_f32_16x16x32_bf16 v[116:119], v[68:71], v[60:63], v[116:119]
v_lshrrev_b32 v195, 4, v1
v_mfma_f32_16x16x32_bf16 v[112:115], v[64:67], v[60:63], v[112:115]
v_add_u32 v195, s44, v195
s_waitcnt lgkmcnt(0)
s_barrier
v_mfma_f32_16x16x32_bf16 v[96:99], v[152:155], v[144:147], v[96:99]
ds_read_b128 v[32:35], v2 offset:0
ds_read_b64_tr_b16 v[40:41], v16 offset:49152
v_mfma_f32_16x16x32_bf16 v[100:103], v[156:159], v[144:147], v[100:103]
ds_read_b64_tr_b16 v[42:43], v16 offset:51200
ds_read_b64_tr_b16 v[44:45], v17 offset:49152
v_mfma_f32_16x16x32_bf16 v[104:107], v[160:163], v[144:147], v[104:107]
ds_read_b64_tr_b16 v[46:47], v17 offset:51200
ds_read_b64_tr_b16 v[48:49], v18 offset:49152
v_mfma_f32_16x16x32_bf16 v[108:111], v[164:167], v[144:147], v[108:111]
ds_read_b64_tr_b16 v[50:51], v18 offset:51200
ds_read_b64_tr_b16 v[52:53], v19 offset:49152
v_mfma_f32_16x16x32_bf16 v[124:127], v[164:167], v[148:151], v[124:127]
ds_read_b64_tr_b16 v[54:55], v19 offset:51200
ds_read_b128 v[36:39], v2 offset:1024
v_mfma_f32_16x16x32_bf16 v[120:123], v[160:163], v[148:151], v[120:123]
ds_read_b128 v[56:59], v2 offset:8192
ds_read_b64_tr_b16 v[64:65], v16 offset:53248
v_mfma_f32_16x16x32_bf16 v[116:119], v[156:159], v[148:151], v[116:119]
ds_read_b64_tr_b16 v[66:67], v16 offset:55296
ds_read_b64_tr_b16 v[68:69], v17 offset:53248
v_mfma_f32_16x16x32_bf16 v[112:115], v[152:155], v[148:151], v[112:115]
ds_read_b64_tr_b16 v[70:71], v17 offset:55296
ds_read_b64_tr_b16 v[72:73], v18 offset:53248
v_mfma_f32_16x16x32_bf16 v[96:99], v[176:179], v[168:171], v[96:99]
ds_read_b64_tr_b16 v[74:75], v18 offset:55296
ds_read_b64_tr_b16 v[76:77], v19 offset:53248
v_mfma_f32_16x16x32_bf16 v[100:103], v[180:183], v[168:171], v[100:103]
ds_read_b64_tr_b16 v[78:79], v19 offset:55296
ds_read_b128 v[60:63], v2 offset:9216
v_mfma_f32_16x16x32_bf16 v[104:107], v[184:187], v[168:171], v[104:107]
v_mul_u32_u24 v195, 7168, v195
v_mfma_f32_16x16x32_bf16 v[108:111], v[188:191], v[168:171], v[108:111]
v_and_b32 v196, 15, v1
v_mfma_f32_16x16x32_bf16 v[124:127], v[188:191], v[172:175], v[124:127]
v_lshl_add_u32 v195, v196, 4, v195
v_mfma_f32_16x16x32_bf16 v[120:123], v[184:187], v[172:175], v[120:123]
s_lshr_b32 s43, s2, 4
v_mfma_f32_16x16x32_bf16 v[116:119], v[180:183], v[172:175], v[116:119]
s_lshl_b32 s43, s43, 8
v_mfma_f32_16x16x32_bf16 v[112:115], v[176:179], v[172:175], v[112:115]
v_add_u32 v195, s43, v195
s_waitcnt lgkmcnt(0)
s_barrier
v_mfma_f32_16x16x32_bf16 v[96:99], v[40:43], v[32:35], v[96:99]
ds_read_b128 v[144:147], v2 offset:49152
ds_read_b64_tr_b16 v[152:153], v16 offset:57344
v_mfma_f32_16x16x32_bf16 v[100:103], v[44:47], v[32:35], v[100:103]
ds_read_b64_tr_b16 v[154:155], v16 offset:59392
ds_read_b64_tr_b16 v[156:157], v17 offset:57344
v_mfma_f32_16x16x32_bf16 v[104:107], v[48:51], v[32:35], v[104:107]
ds_read_b64_tr_b16 v[158:159], v17 offset:59392
ds_read_b64_tr_b16 v[160:161], v18 offset:57344
v_mfma_f32_16x16x32_bf16 v[108:111], v[52:55], v[32:35], v[108:111]
ds_read_b64_tr_b16 v[162:163], v18 offset:59392
ds_read_b64_tr_b16 v[164:165], v19 offset:57344
v_mfma_f32_16x16x32_bf16 v[124:127], v[52:55], v[36:39], v[124:127]
ds_read_b64_tr_b16 v[166:167], v19 offset:59392
ds_read_b128 v[148:151], v2 offset:50176
v_mfma_f32_16x16x32_bf16 v[120:123], v[48:51], v[36:39], v[120:123]
ds_read_b128 v[168:171], v2 offset:57344
ds_read_b64_tr_b16 v[176:177], v16 offset:61440
v_mfma_f32_16x16x32_bf16 v[116:119], v[44:47], v[36:39], v[116:119]
ds_read_b64_tr_b16 v[178:179], v16 offset:63488
ds_read_b64_tr_b16 v[180:181], v17 offset:61440
v_mfma_f32_16x16x32_bf16 v[112:115], v[40:43], v[36:39], v[112:115]
ds_read_b64_tr_b16 v[182:183], v17 offset:63488
ds_read_b64_tr_b16 v[184:185], v18 offset:61440
v_mfma_f32_16x16x32_bf16 v[96:99], v[64:67], v[56:59], v[96:99]
ds_read_b64_tr_b16 v[186:187], v18 offset:63488
ds_read_b64_tr_b16 v[188:189], v19 offset:61440
v_mfma_f32_16x16x32_bf16 v[100:103], v[68:71], v[56:59], v[100:103]
ds_read_b64_tr_b16 v[190:191], v19 offset:63488
ds_read_b128 v[172:175], v2 offset:58368
v_mfma_f32_16x16x32_bf16 v[104:107], v[72:75], v[56:59], v[104:107]
s_branch Lov_6
.p2align 12
.fill 48, 4, 0xbf800000
Lst_6_0:
s_branch Lwr_152
s_nop 0
s_nop 0
Lov_6:
v_mfma_f32_16x16x32_bf16 v[108:111], v[76:79], v[56:59], v[108:111]
v_mfma_f32_16x16x32_bf16 v[124:127], v[76:79], v[60:63], v[124:127]
v_mfma_f32_16x16x32_bf16 v[120:123], v[72:75], v[60:63], v[120:123]
v_mfma_f32_16x16x32_bf16 v[116:119], v[68:71], v[60:63], v[116:119]
v_mfma_f32_16x16x32_bf16 v[112:115], v[64:67], v[60:63], v[112:115]
s_waitcnt lgkmcnt(0)
s_barrier
v_mfma_f32_16x16x32_bf16 v[96:99], v[152:155], v[144:147], v[96:99]
ds_read_b128 v[32:35], v3 offset:0
ds_read_b64_tr_b16 v[40:41], v20 offset:0
v_mfma_f32_16x16x32_bf16 v[100:103], v[156:159], v[144:147], v[100:103]
ds_read_b64_tr_b16 v[42:43], v20 offset:2048
ds_read_b64_tr_b16 v[44:45], v21 offset:0
v_mfma_f32_16x16x32_bf16 v[104:107], v[160:163], v[144:147], v[104:107]
ds_read_b64_tr_b16 v[46:47], v21 offset:2048
ds_read_b64_tr_b16 v[48:49], v22 offset:0
v_mfma_f32_16x16x32_bf16 v[108:111], v[164:167], v[144:147], v[108:111]
ds_read_b64_tr_b16 v[50:51], v22 offset:2048
ds_read_b64_tr_b16 v[52:53], v23 offset:0
v_mfma_f32_16x16x32_bf16 v[124:127], v[164:167], v[148:151], v[124:127]
ds_read_b64_tr_b16 v[54:55], v23 offset:2048
ds_read_b128 v[36:39], v3 offset:1024
v_mfma_f32_16x16x32_bf16 v[120:123], v[160:163], v[148:151], v[120:123]
ds_read_b128 v[56:59], v3 offset:8192
ds_read_b64_tr_b16 v[64:65], v20 offset:4096
v_mfma_f32_16x16x32_bf16 v[116:119], v[156:159], v[148:151], v[116:119]
ds_read_b64_tr_b16 v[66:67], v20 offset:6144
ds_read_b64_tr_b16 v[68:69], v21 offset:4096
v_mfma_f32_16x16x32_bf16 v[112:115], v[152:155], v[148:151], v[112:115]
ds_read_b64_tr_b16 v[70:71], v21 offset:6144
ds_read_b64_tr_b16 v[72:73], v22 offset:4096
v_mfma_f32_16x16x32_bf16 v[96:99], v[176:179], v[168:171], v[96:99]
ds_read_b64_tr_b16 v[74:75], v22 offset:6144
ds_read_b64_tr_b16 v[76:77], v23 offset:4096
v_mfma_f32_16x16x32_bf16 v[100:103], v[180:183], v[168:171], v[100:103]
ds_read_b64_tr_b16 v[78:79], v23 offset:6144
ds_read_b128 v[60:63], v3 offset:9216
v_mfma_f32_16x16x32_bf16 v[104:107], v[184:187], v[168:171], v[104:107]
v_mfma_f32_16x16x32_bf16 v[108:111], v[188:191], v[168:171], v[108:111]
v_mfma_f32_16x16x32_bf16 v[124:127], v[188:191], v[172:175], v[124:127]
v_mfma_f32_16x16x32_bf16 v[120:123], v[184:187], v[172:175], v[120:123]
v_mfma_f32_16x16x32_bf16 v[116:119], v[180:183], v[172:175], v[116:119]
v_mfma_f32_16x16x32_bf16 v[112:115], v[176:179], v[172:175], v[112:115]
s_waitcnt lgkmcnt(0)
s_barrier
v_mfma_f32_16x16x32_bf16 v[96:99], v[40:43], v[32:35], v[96:99]
ds_read_b128 v[144:147], v3 offset:49152
ds_read_b64_tr_b16 v[152:153], v20 offset:8192
v_mfma_f32_16x16x32_bf16 v[100:103], v[44:47], v[32:35], v[100:103]
ds_read_b64_tr_b16 v[154:155], v20 offset:10240
ds_read_b64_tr_b16 v[156:157], v21 offset:8192
v_mfma_f32_16x16x32_bf16 v[104:107], v[48:51], v[32:35], v[104:107]
ds_read_b64_tr_b16 v[158:159], v21 offset:10240
ds_read_b64_tr_b16 v[160:161], v22 offset:8192
v_mfma_f32_16x16x32_bf16 v[108:111], v[52:55], v[32:35], v[108:111]
ds_read_b64_tr_b16 v[162:163], v22 offset:10240
ds_read_b64_tr_b16 v[164:165], v23 offset:8192
v_mfma_f32_16x16x32_bf16 v[124:127], v[52:55], v[36:39], v[124:127]
ds_read_b64_tr_b16 v[166:167], v23 offset:10240
ds_read_b128 v[148:151], v3 offset:50176
v_mfma_f32_16x16x32_bf16 v[120:123], v[48:51], v[36:39], v[120:123]
ds_read_b128 v[168:171], v3 offset:57344
ds_read_b64_tr_b16 v[176:177], v20 offset:12288
v_mfma_f32_16x16x32_bf16 v[116:119], v[44:47], v[36:39], v[116:119]
ds_read_b64_tr_b16 v[178:179], v20 offset:14336
ds_read_b64_tr_b16 v[180:181], v21 offset:12288
v_mfma_f32_16x16x32_bf16 v[112:115], v[40:43], v[36:39], v[112:115]
ds_read_b64_tr_b16 v[182:183], v21 offset:14336
ds_read_b64_tr_b16 v[184:185], v22 offset:12288
v_mfma_f32_16x16x32_bf16 v[96:99], v[64:67], v[56:59], v[96:99]
ds_read_b64_tr_b16 v[186:187], v22 offset:14336
ds_read_b64_tr_b16 v[188:189], v23 offset:12288
v_mfma_f32_16x16x32_bf16 v[100:103], v[68:71], v[56:59], v[100:103]
ds_read_b64_tr_b16 v[190:191], v23 offset:14336
ds_read_b128 v[172:175], v3 offset:58368
v_mfma_f32_16x16x32_bf16 v[104:107], v[72:75], v[56:59], v[104:107]
v_mfma_f32_16x16x32_bf16 v[108:111], v[76:79], v[56:59], v[108:111]
v_mfma_f32_16x16x32_bf16 v[124:127], v[76:79], v[60:63], v[124:127]
v_mfma_f32_16x16x32_bf16 v[120:123], v[72:75], v[60:63], v[120:123]
v_mfma_f32_16x16x32_bf16 v[116:119], v[68:71], v[60:63], v[116:119]
v_mfma_f32_16x16x32_bf16 v[112:115], v[64:67], v[60:63], v[112:115]
s_waitcnt lgkmcnt(0)
s_barrier
v_mfma_f32_16x16x32_bf16 v[96:99], v[152:155], v[144:147], v[96:99]
v_mfma_f32_16x16x32_bf16 v[100:103], v[156:159], v[144:147], v[100:103]
v_mfma_f32_16x16x32_bf16 v[104:107], v[160:163], v[144:147], v[104:107]
v_mfma_f32_16x16x32_bf16 v[108:111], v[164:167], v[144:147], v[108:111]
v_mfma_f32_16x16x32_bf16 v[124:127], v[164:167], v[148:151], v[124:127]
v_mfma_f32_16x16x32_bf16 v[120:123], v[160:163], v[148:151], v[120:123]
v_mfma_f32_16x16x32_bf16 v[116:119], v[156:159], v[148:151], v[116:119]
v_mfma_f32_16x16x32_bf16 v[112:115], v[152:155], v[148:151], v[112:115]
v_mfma_f32_16x16x32_bf16 v[96:99], v[176:179], v[168:171], v[96:99]
v_mfma_f32_16x16x32_bf16 v[100:103], v[180:183], v[168:171], v[100:103]
v_mfma_f32_16x16x32_bf16 v[104:107], v[184:187], v[168:171], v[104:107]
v_mfma_f32_16x16x32_bf16 v[108:111], v[188:191], v[168:171], v[108:111]
v_mfma_f32_16x16x32_bf16 v[124:127], v[188:191], v[172:175], v[124:127]
v_mfma_f32_16x16x32_bf16 v[120:123], v[184:187], v[172:175], v[120:123]
v_mfma_f32_16x16x32_bf16 v[116:119], v[180:183], v[172:175], v[116:119]
v_mfma_f32_16x16x32_bf16 v[112:115], v[176:179], v[172:175], v[112:115]
s_nop 3
v_cvt_pk_bf16_f32 v32, v96, v97
v_cvt_pk_bf16_f32 v33, v98, v99
v_cvt_pk_bf16_f32 v34, v100, v101
v_cvt_pk_bf16_f32 v35, v102, v103
s_add_u32 s43, s60, 0
buffer_store_dwordx4 v[32:35], v11, s[20:23], s43 offen offset:0 sc1
v_cvt_pk_bf16_f32 v36, v104, v105
v_cvt_pk_bf16_f32 v37, v106, v107
v_cvt_pk_bf16_f32 v38, v108, v109
v_cvt_pk_bf16_f32 v39, v110, v111
s_add_u32 s43, s60, 8192
buffer_store_dwordx4 v[36:39], v11, s[20:23], s43 offen offset:0 sc1
v_cvt_pk_bf16_f32 v44, v120, v121
v_cvt_pk_bf16_f32 v45, v122, v123
v_cvt_pk_bf16_f32 v46, v124, v125
v_cvt_pk_bf16_f32 v47, v126, v127
s_add_u32 s43, s60, 8192
buffer_store_dwordx4 v[44:47], v11, s[20:23], s43 offen offset:1024 sc1
v_cvt_pk_bf16_f32 v40, v112, v113
v_cvt_pk_bf16_f32 v41, v114, v115
v_cvt_pk_bf16_f32 v42, v116, v117
v_cvt_pk_bf16_f32 v43, v118, v119
s_add_u32 s43, s60, 0
buffer_store_dwordx4 v[40:43], v11, s[20:23], s43 offen offset:1024 sc1
v_mov_b32 v64, 0
v_mov_b32 v65, 0
v_mov_b32 v66, 0
v_mov_b32 v67, 0
v_mov_b32 v68, 0
v_mov_b32 v69, 0
v_mov_b32 v70, 0
v_mov_b32 v71, 0
v_dot2_f32_bf16 v64, v32, s61, v64
v_dot2_f32_bf16 v66, v32, v32, v66
v_dot2_f32_bf16 v68, v40, s61, v68
v_dot2_f32_bf16 v70, v40, v40, v70
v_dot2_f32_bf16 v65, v33, s61, v65
v_dot2_f32_bf16 v67, v33, v33, v67
v_dot2_f32_bf16 v69, v41, s61, v69
v_dot2_f32_bf16 v71, v41, v41, v71
v_dot2_f32_bf16 v64, v34, s61, v64
v_dot2_f32_bf16 v66, v34, v34, v66
v_dot2_f32_bf16 v68, v42, s61, v68
v_dot2_f32_bf16 v70, v42, v42, v70
v_dot2_f32_bf16 v65, v35, s61, v65
v_dot2_f32_bf16 v67, v35, v35, v67
v_dot2_f32_bf16 v69, v43, s61, v69
v_dot2_f32_bf16 v71, v43, v43, v71
v_dot2_f32_bf16 v64, v36, s61, v64
v_dot2_f32_bf16 v66, v36, v36, v66
v_dot2_f32_bf16 v68, v44, s61, v68
v_dot2_f32_bf16 v70, v44, v44, v70
v_dot2_f32_bf16 v65, v37, s61, v65
v_dot2_f32_bf16 v67, v37, v37, v67
v_dot2_f32_bf16 v69, v45, s61, v69
v_dot2_f32_bf16 v71, v45, v45, v71
v_dot2_f32_bf16 v64, v38, s61, v64
v_dot2_f32_bf16 v66, v38, v38, v66
v_dot2_f32_bf16 v68, v46, s61, v68
v_dot2_f32_bf16 v70, v46, v46, v70
v_dot2_f32_bf16 v65, v39, s61, v65
v_dot2_f32_bf16 v67, v39, v39, v67
v_dot2_f32_bf16 v69, v47, s61, v69
v_dot2_f32_bf16 v71, v47, v47, v71
s_nop 2
v_add_f32 v64, v64, v65
v_add_f32 v66, v66, v67
v_add_f32 v68, v68, v69
v_add_f32 v70, v70, v71
s_nop 1
v_permlane32_swap_b32 v64, v68
v_permlane32_swap_b32 v66, v70
v_add_f32 v64, v64, v68
v_add_f32 v66, v66, v70
s_nop 1
v_permlane16_swap_b32 v64, v66
v_add_f32 v64, v64, v66
buffer_store_dword v64, v9, s[24:27], 0 offen sc1
s_lshl_b32 s7, s34, 12
s_add_u32 s7, s7, 49280
v_lshl_add_u32 v4, v1, 8, s7
v_mov_b32 v5, 1
s_waitcnt vmcnt(0)
s_cmp_lg_u32 s36, 0
s_barrier
s_cbranch_scc1 Lk2end_83
s_mov_b64 exec, 0xffff
buffer_atomic_add v5, v4, s[56:59], 0 offen sc1
s_mov_b64 exec, -1
s_branch Lk2end_83
Lprod_84:
s_mul_i32 s43, s34, 262144
s_add_u32 s8, s82, s43
s_addc_u32 s9, s83, 0
s_mov_b32 s10, 262144
s_mov_b32 s11, 0x20000
s_lshl_b32 s43, s35, 7
s_add_u32 s12, s68, s43
s_addc_u32 s13, s69, 0
s_mov_b32 s14, 2095232
s_mov_b32 s15, 0x20000
s_and_b32 s47, s36, 3
s_lshl_b32 s39, s47, 12
v_lshlrev_b32 v2, 4, v1
v_add_u32 v2, s39, v2
v_lshrrev_b32 v12, 3, v1
v_and_b32 v13, 6, v12
v_and_b32 v3, 7, v1
v_xor_b32 v3, v3, v13
v_lshlrev_b32 v3, 4, v3
v_mul_u32_u24 v12, 2048, v12
v_add_u32 v3, v3, v12
s_lshl_b32 s43, s47, 15
v_add_u32 v3, s43, v3
s_lshl_b32 s40, s47, 11
s_add_u32 s37, s35, 0
s_and_b32 s37, s37, 15
s_lshl_b32 s37, s37, 14
s_add_u32 m0, s39, 0
s_nop 0
buffer_load_dwordx4 v2, s[8:11], s37 offen offset:0 sc1 lds
buffer_load_dwordx4 v2, s[8:11], s37 offen offset:1024 sc1 lds
buffer_load_dwordx4 v2, s[8:11], s37 offen offset:2048 sc1 lds
buffer_load_dwordx4 v2, s[8:11], s37 offen offset:3072 sc1 lds
s_add_u32 s38, s35, 4
s_and_b32 s38, s38, 15
s_lshl_b32 s38, s38, 17
s_add_u32 m0, s40, 114688
s_nop 0
buffer_load_dwordx4 v3, s[12:15], s38 offen lds
s_add_u32 m0, s40, 115712
s_add_u32 s38, s38, 16384
buffer_load_dwordx4 v3, s[12:15], s38 offen lds
s_add_u32 s38, s35, 5
s_and_b32 s38, s38, 15
s_lshl_b32 s38, s38, 17
s_add_u32 m0, s40, 122880
s_nop 0
buffer_load_dwordx4 v3, s[12:15], s38 offen lds
s_add_u32 m0, s40, 123904
s_add_u32 s38, s38, 16384
buffer_load_dwordx4 v3, s[12:15], s38 offen lds
s_add_u32 s38, s35, 6
s_and_b32 s38, s38, 15
s_lshl_b32 s38, s38, 17
s_add_u32 m0, s40, 131072
s_nop 0
buffer_load_dwordx4 v3, s[12:15], s38 offen lds
s_add_u32 m0, s40, 132096
s_add_u32 s38, s38, 16384
buffer_load_dwordx4 v3, s[12:15], s38 offen lds
s_add_u32 s38, s35, 7
s_and_b32 s38, s38, 15
s_lshl_b32 s38, s38, 17
s_add_u32 m0, s40, 139264
s_nop 0
buffer_load_dwordx4 v3, s[12:15], s38 offen lds
s_add_u32 m0, s40, 140288
s_add_u32 s38, s38, 16384
buffer_load_dwordx4 v3, s[12:15], s38 offen lds
s_bitcmp0_b32 s36, 1
s_cselect_b32 s44, s72, s74
s_cselect_b32 s45, s73, s75
s_mul_i32 s43, s35, 192
s_add_u32 s88, s44, s43
s_addc_u32 s89, s45, 0
s_add_u32 s88, s88, 4096
s_addc_u32 s89, s89, 0
s_mov_b32 s90, 7333056
s_mov_b32 s91, 0x20000
v_add_u32 v11, 0, v1
v_mul_u32_u24 v12, 5462, v11
v_lshrrev_b32 v12, 16, v12
v_mul_u32_u24 v13, 12, v12
v_sub_u32 v13, v11, v13
v_bfe_u32 v14, v12, 2, 1
v_cmp_gt_u32 vcc, 8, v13
v_lshlrev_b32 v15, 1, v14
v_mul_u32_u24 v12, 7168, v12
v_cndmask_b32 v14, v14, v15, vcc
v_xor_b32 v13, v13, v14
v_lshl_add_u32 v8, v13, 4, v12
v_add_u32 v11, 64, v1
v_mul_u32_u24 v12, 5462, v11
v_lshrrev_b32 v12, 16, v12
v_mul_u32_u24 v13, 12, v12
v_sub_u32 v13, v11, v13
v_bfe_u32 v14, v12, 2, 1
v_cmp_gt_u32 vcc, 8, v13
v_lshlrev_b32 v15, 1, v14
v_mul_u32_u24 v12, 7168, v12
v_cndmask_b32 v14, v14, v15, vcc
v_xor_b32 v13, v13, v14
v_lshl_add_u32 v9, v13, 4, v12
v_add_u32 v11, 128, v1
v_mul_u32_u24 v12, 5462, v11
v_lshrrev_b32 v12, 16, v12
v_mul_u32_u24 v13, 12, v12
v_sub_u32 v13, v11, v13
v_bfe_u32 v14, v12, 2, 1
v_cmp_gt_u32 vcc, 8, v13
v_lshlrev_b32 v15, 1, v14
v_mul_u32_u24 v12, 7168, v12
v_cndmask_b32 v14, v14, v15, vcc
v_xor_b32 v13, v13, v14
v_lshl_add_u32 v10, v13, 4, v12
s_and_b32 s43, s36, 1
s_mul_i32 s43, s43, 229376
v_add_u32 v8, s43, v8
v_add_u32 v9, s43, v9
v_add_u32 v10, s43, v10
s_and_b32 s43, s36, 3
s_mul_i32 s46, s43, 6144
s_add_u32 s46, s46, 16384
s_cmp_eq_u32 s47, 3
s_cbranch_scc0 Lw_91
s_lshl_b32 s92, s34, 4
s_add_u32 s92, s92, s35
s_lshl_b32 s92, s92, 8
s_add_u32 s92, s92, 49152
s_add_u32 s92, s92, 28311552
s_mov_b32 s41, 0x40000
Lpoll_92:
s_load_dword s93, s[82:83], s92 glc
Lpchk_94:
s_waitcnt lgkmcnt(0)
s_cmp_eq_u32 s93, 16
s_cbranch_scc1 Lpok_93
s_sub_u32 s41, s41, 1
s_cmp_lg_u32 s41, 0
s_cbranch_scc1 Lpoll_92
Lpok_93:
Lw_91:
s_and_b32 s44, s36, 3
s_mul_i32 s44, s44, 14
s_bfe_u32 s43, s2, 0x30001
s_lshl_b32 s43, s43, 7
s_add_u32 s44, s44, s43
s_add_u32 s44, s44, 72
s_mul_i32 s44, s44, 7168
s_lshr_b32 s43, s2, 4
s_lshl_b32 s43, s43, 8
s_add_u32 s43, s43, s44
s_bitcmp0_b32 s2, 0
s_cselect_b32 s4, s72, s74
s_cselect_b32 s5, s73, s75
s_add_u32 s4, s4, s43
s_addc_u32 s5, s5, 0
s_cmp_eq_u32 s47, 3
s_cbranch_scc1 Lw_95
s_load_dword s3, s[4:5], 0
s_load_dword s3, s[4:5], 64
s_load_dword s3, s[4:5], 128
s_load_dword s3, s[4:5], 192
s_load_dword s3, s[4:5], 7168
s_load_dword s3, s[4:5], 7232
s_load_dword s3, s[4:5], 7296
s_load_dword s3, s[4:5], 7360
s_load_dword s3, s[4:5], 14336
s_load_dword s3, s[4:5], 14400
s_load_dword s3, s[4:5], 14464
s_load_dword s3, s[4:5], 14528
s_load_dword s3, s[4:5], 21504
s_load_dword s3, s[4:5], 21568
Lw_95:
s_waitcnt vmcnt(8)
s_barrier
s_add_u32 s37, s35, 1
s_and_b32 s37, s37, 15
s_lshl_b32 s37, s37, 14
s_add_u32 m0, s39, 49152
s_nop 0
buffer_load_dwordx4 v2, s[8:11], s37 offen offset:0 sc1 lds
buffer_load_dwordx4 v2, s[8:11], s37 offen offset:1024 sc1 lds
buffer_load_dwordx4 v2, s[8:11], s37 offen offset:2048 sc1 lds
buffer_load_dwordx4 v2, s[8:11], s37 offen offset:3072 sc1 lds
s_add_u32 s37, s35, 2
s_and_b32 s37, s37, 15
s_lshl_b32 s37, s37, 14
s_add_u32 m0, s39, 98304
s_nop 0
buffer_load_dwordx4 v2, s[8:11], s37 offen offset:0 sc1 lds
buffer_load_dwordx4 v2, s[8:11], s37 offen offset:1024 sc1 lds
buffer_load_dwordx4 v2, s[8:11], s37 offen offset:2048 sc1 lds
buffer_load_dwordx4 v2, s[8:11], s37 offen offset:3072 sc1 lds
s_add_u32 s37, s35, 3
s_and_b32 s37, s37, 15
s_lshl_b32 s37, s37, 14
s_add_u32 m0, s39, 147456
s_nop 0
buffer_load_dwordx4 v2, s[8:11], s37 offen offset:0 sc1 lds
buffer_load_dwordx4 v2, s[8:11], s37 offen offset:1024 sc1 lds
buffer_load_dwordx4 v2, s[8:11], s37 offen offset:2048 sc1 lds
buffer_load_dwordx4 v2, s[8:11], s37 offen offset:3072 sc1 lds
s_cmp_eq_u32 s47, 3
s_cbranch_scc0 Lw_96
s_load_dword s3, s[4:5], 0
s_load_dword s3, s[4:5], 64
s_load_dword s3, s[4:5], 128
s_load_dword s3, s[4:5], 192
s_load_dword s3, s[4:5], 7168
s_load_dword s3, s[4:5], 7232
s_load_dword s3, s[4:5], 7296
s_load_dword s3, s[4:5], 7360
s_load_dword s3, s[4:5], 14336
s_load_dword s3, s[4:5], 14400
s_load_dword s3, s[4:5], 14464
s_load_dword s3, s[4:5], 14528
s_load_dword s3, s[4:5], 21504
s_load_dword s3, s[4:5], 21568
Lw_96:
s_waitcnt vmcnt(8)
s_barrier
s_add_u32 s37, s35, 4
s_and_b32 s37, s37, 15
s_lshl_b32 s37, s37, 14
s_add_u32 m0, s39, 0
s_nop 0
buffer_load_dwordx4 v2, s[8:11], s37 offen offset:0 sc1 lds
buffer_load_dwordx4 v2, s[8:11], s37 offen offset:1024 sc1 lds
buffer_load_dwordx4 v2, s[8:11], s37 offen offset:2048 sc1 lds
buffer_load_dwordx4 v2, s[8:11], s37 offen offset:3072 sc1 lds
s_add_u32 s38, s35, 8
s_and_b32 s38, s38, 15
s_lshl_b32 s38, s38, 17
s_add_u32 m0, s40, 16384
s_nop 0
buffer_load_dwordx4 v3, s[12:15], s38 offen lds
s_add_u32 m0, s40, 17408
s_add_u32 s38, s38, 16384
buffer_load_dwordx4 v3, s[12:15], s38 offen lds
v_lshlrev_b32 v240, 16, v128
v_and_b32 v241, 0xffff0000, v128
v_lshlrev_b32 v242, 16, v129
v_and_b32 v243, 0xffff0000, v129
v_lshlrev_b32 v244, 16, v130
v_and_b32 v245, 0xffff0000, v130
v_lshlrev_b32 v246, 16, v131
v_and_b32 v247, 0xffff0000, v131
s_load_dword s3, s[4:5], 21632
s_load_dword s3, s[4:5], 21696
s_load_dword s3, s[4:5], 28672
s_waitcnt vmcnt(10)
s_barrier
s_add_u32 s37, s35, 5
s_and_b32 s37, s37, 15
s_lshl_b32 s37, s37, 14
s_add_u32 m0, s39, 49152
s_nop 0
buffer_load_dwordx4 v2, s[8:11], s37 offen offset:0 sc1 lds
buffer_load_dwordx4 v2, s[8:11], s37 offen offset:1024 sc1 lds
buffer_load_dwordx4 v2, s[8:11], s37 offen offset:2048 sc1 lds
buffer_load_dwordx4 v2, s[8:11], s37 offen offset:3072 sc1 lds
s_add_u32 s38, s35, 9
s_and_b32 s38, s38, 15
s_lshl_b32 s38, s38, 17
s_add_u32 m0, s40, 24576
s_nop 0
buffer_load_dwordx4 v3, s[12:15], s38 offen lds
s_add_u32 m0, s40, 25600
s_add_u32 s38, s38, 16384
buffer_load_dwordx4 v3, s[12:15], s38 offen lds
v_lshlrev_b32 v24, 16, v132
v_and_b32 v25, 0xffff0000, v132
v_lshlrev_b32 v26, 16, v133
v_and_b32 v27, 0xffff0000, v133
v_lshlrev_b32 v28, 16, v134
v_and_b32 v29, 0xffff0000, v134
v_lshlrev_b32 v30, 16, v135
v_and_b32 v31, 0xffff0000, v135
v_add_f32 v240, v240, v24
v_add_f32 v241, v241, v25
v_add_f32 v242, v242, v26
v_add_f32 v243, v243, v27
v_add_f32 v244, v244, v28
v_add_f32 v245, v245, v29
v_add_f32 v246, v246, v30
v_add_f32 v247, v247, v31
s_load_dword s3, s[4:5], 28736
s_load_dword s3, s[4:5], 28800
s_load_dword s3, s[4:5], 28864
s_waitcnt vmcnt(12)
s_barrier
s_add_u32 s37, s35, 6
s_and_b32 s37, s37, 15
s_lshl_b32 s37, s37, 14
s_add_u32 m0, s39, 98304
s_nop 0
buffer_load_dwordx4 v2, s[8:11], s37 offen offset:0 sc1 lds
buffer_load_dwordx4 v2, s[8:11], s37 offen offset:1024 sc1 lds
buffer_load_dwordx4 v2, s[8:11], s37 offen offset:2048 sc1 lds
buffer_load_dwordx4 v2, s[8:11], s37 offen offset:3072 sc1 lds
s_add_u32 s38, s35, 10
s_and_b32 s38, s38, 15
s_lshl_b32 s38, s38, 17
s_add_u32 m0, s40, 32768
s_nop 0
buffer_load_dwordx4 v3, s[12:15], s38 offen lds
s_add_u32 m0, s40, 33792
s_add_u32 s38, s38, 16384
buffer_load_dwordx4 v3, s[12:15], s38 offen lds
v_lshlrev_b32 v24, 16, v136
v_and_b32 v25, 0xffff0000, v136
v_lshlrev_b32 v26, 16, v137
v_and_b32 v27, 0xffff0000, v137
v_lshlrev_b32 v28, 16, v138
v_and_b32 v29, 0xffff0000, v138
v_lshlrev_b32 v30, 16, v139
v_and_b32 v31, 0xffff0000, v139
v_add_f32 v240, v240, v24
v_add_f32 v241, v241, v25
v_add_f32 v242, v242, v26
v_add_f32 v243, v243, v27
v_add_f32 v244, v244, v28
v_add_f32 v245, v245, v29
v_add_f32 v246, v246, v30
v_add_f32 v247, v247, v31
s_load_dword s3, s[4:5], 35840
s_load_dword s3, s[4:5], 35904
s_load_dword s3, s[4:5], 35968
s_waitcnt vmcnt(14)
s_barrier
s_add_u32 s37, s35, 7
s_and_b32 s37, s37, 15
s_lshl_b32 s37, s37, 14
s_add_u32 m0, s39, 147456
s_nop 0
buffer_load_dwordx4 v2, s[8:11], s37 offen offset:0 sc1 lds
buffer_load_dwordx4 v2, s[8:11], s37 offen offset:1024 sc1 lds
buffer_load_dwordx4 v2, s[8:11], s37 offen offset:2048 sc1 lds
buffer_load_dwordx4 v2, s[8:11], s37 offen offset:3072 sc1 lds
s_add_u32 s38, s35, 11
s_and_b32 s38, s38, 15
s_lshl_b32 s38, s38, 17
s_add_u32 m0, s40, 40960
s_nop 0
buffer_load_dwordx4 v3, s[12:15], s38 offen lds
s_add_u32 m0, s40, 41984
s_add_u32 s38, s38, 16384
buffer_load_dwordx4 v3, s[12:15], s38 offen lds
v_lshlrev_b32 v24, 16, v140
v_and_b32 v25, 0xffff0000, v140
v_lshlrev_b32 v26, 16, v141
v_and_b32 v27, 0xffff0000, v141
v_lshlrev_b32 v28, 16, v142
v_and_b32 v29, 0xffff0000, v142
v_lshlrev_b32 v30, 16, v143
v_and_b32 v31, 0xffff0000, v143
v_add_f32 v240, v240, v24
v_add_f32 v241, v241, v25
v_add_f32 v242, v242, v26
v_add_f32 v243, v243, v27
v_add_f32 v244, v244, v28
v_add_f32 v245, v245, v29
v_add_f32 v246, v246, v30
v_add_f32 v247, v247, v31
s_load_dword s3, s[4:5], 36032
s_load_dword s3, s[4:5], 43008
s_load_dword s3, s[4:5], 43072
s_waitcnt vmcnt(14)
s_barrier
s_add_u32 s37, s35, 8
s_and_b32 s37, s37, 15
s_lshl_b32 s37, s37, 14
s_add_u32 m0, s39, 0
s_nop 0
buffer_load_dwordx4 v2, s[8:11], s37 offen offset:0 sc1 lds
buffer_load_dwordx4 v2, s[8:11], s37 offen offset:1024 sc1 lds
buffer_load_dwordx4 v2, s[8:11], s37 offen offset:2048 sc1 lds
buffer_load_dwordx4 v2, s[8:11], s37 offen offset:3072 sc1 lds
s_add_u32 s38, s35, 12
s_and_b32 s38, s38, 15
s_lshl_b32 s38, s38, 17
s_add_u32 m0, s40, 114688
s_nop 0
buffer_load_dwordx4 v3, s[12:15], s38 offen lds
s_add_u32 m0, s40, 115712
s_add_u32 s38, s38, 16384
buffer_load_dwordx4 v3, s[12:15], s38 offen lds
v_lshlrev_b32 v24, 16, v144
v_and_b32 v25, 0xffff0000, v144
v_lshlrev_b32 v26, 16, v145
v_and_b32 v27, 0xffff0000, v145
v_lshlrev_b32 v28, 16, v146
v_and_b32 v29, 0xffff0000, v146
v_lshlrev_b32 v30, 16, v147
v_and_b32 v31, 0xffff0000, v147
v_add_f32 v240, v240, v24
v_add_f32 v241, v241, v25
v_add_f32 v242, v242, v26
v_add_f32 v243, v243, v27
v_add_f32 v244, v244, v28
v_add_f32 v245, v245, v29
v_add_f32 v246, v246, v30
v_add_f32 v247, v247, v31
s_load_dword s3, s[4:5], 43136
s_load_dword s3, s[4:5], 43200
s_load_dword s3, s[4:5], 50176
s_waitcnt vmcnt(14)
s_barrier
s_add_u32 s37, s35, 9
s_and_b32 s37, s37, 15
s_lshl_b32 s37, s37, 14
s_add_u32 m0, s39, 49152
s_nop 0
buffer_load_dwordx4 v2, s[8:11], s37 offen offset:0 sc1 lds
buffer_load_dwordx4 v2, s[8:11], s37 offen offset:1024 sc1 lds
buffer_load_dwordx4 v2, s[8:11], s37 offen offset:2048 sc1 lds
buffer_load_dwordx4 v2, s[8:11], s37 offen offset:3072 sc1 lds
s_add_u32 s38, s35, 13
s_and_b32 s38, s38, 15
s_lshl_b32 s38, s38, 17
s_add_u32 m0, s40, 122880
s_nop 0
buffer_load_dwordx4 v3, s[12:15], s38 offen lds
s_add_u32 m0, s40, 123904
s_add_u32 s38, s38, 16384
buffer_load_dwordx4 v3, s[12:15], s38 offen lds
v_lshlrev_b32 v24, 16, v148
v_and_b32 v25, 0xffff0000, v148
v_lshlrev_b32 v26, 16, v149
v_and_b32 v27, 0xffff0000, v149
v_lshlrev_b32 v28, 16, v150
v_and_b32 v29, 0xffff0000, v150
v_lshlrev_b32 v30, 16, v151
v_and_b32 v31, 0xffff0000, v151
v_add_f32 v240, v240, v24
v_add_f32 v241, v241, v25
v_add_f32 v242, v242, v26
v_add_f32 v243, v243, v27
s_branch Lov_7
.p2align 12
.fill 48, 4, 0xbf800000
Lst_7_0:
s_branch Lwr_153
s_nop 0
s_nop 0
Lov_7:
v_add_f32 v244, v244, v28
v_add_f32 v245, v245, v29
v_add_f32 v246, v246, v30
v_add_f32 v247, v247, v31
s_load_dword s3, s[4:5], 50240
s_load_dword s3, s[4:5], 50304
s_load_dword s3, s[4:5], 50368
s_waitcnt vmcnt(14)
s_barrier
s_add_u32 s37, s35, 10
s_and_b32 s37, s37, 15
s_lshl_b32 s37, s37, 14
s_add_u32 m0, s39, 98304
s_nop 0
buffer_load_dwordx4 v2, s[8:11], s37 offen offset:0 sc1 lds
buffer_load_dwordx4 v2, s[8:11], s37 offen offset:1024 sc1 lds
buffer_load_dwordx4 v2, s[8:11], s37 offen offset:2048 sc1 lds
buffer_load_dwordx4 v2, s[8:11], s37 offen offset:3072 sc1 lds
s_add_u32 s38, s35, 14
s_and_b32 s38, s38, 15
s_lshl_b32 s38, s38, 17
s_add_u32 m0, s40, 131072
s_nop 0
buffer_load_dwordx4 v3, s[12:15], s38 offen lds
s_add_u32 m0, s40, 132096
s_add_u32 s38, s38, 16384
buffer_load_dwordx4 v3, s[12:15], s38 offen lds
v_lshlrev_b32 v24, 16, v152
v_and_b32 v25, 0xffff0000, v152
v_lshlrev_b32 v26, 16, v153
v_and_b32 v27, 0xffff0000, v153
v_lshlrev_b32 v28, 16, v154
v_and_b32 v29, 0xffff0000, v154
v_lshlrev_b32 v30, 16, v155
v_and_b32 v31, 0xffff0000, v155
v_add_f32 v240, v240, v24
v_add_f32 v241, v241, v25
v_add_f32 v242, v242, v26
v_add_f32 v243, v243, v27
v_add_f32 v244, v244, v28
v_add_f32 v245, v245, v29
v_add_f32 v246, v246, v30
v_add_f32 v247, v247, v31
s_load_dword s3, s[4:5], 57344
s_load_dword s3, s[4:5], 57408
s_load_dword s3, s[4:5], 57472
s_waitcnt vmcnt(14)
s_barrier
s_add_u32 s37, s35, 11
s_and_b32 s37, s37, 15
s_lshl_b32 s37, s37, 14
s_add_u32 m0, s39, 147456
s_nop 0
buffer_load_dwordx4 v2, s[8:11], s37 offen offset:0 sc1 lds
buffer_load_dwordx4 v2, s[8:11], s37 offen offset:1024 sc1 lds
buffer_load_dwordx4 v2, s[8:11], s37 offen offset:2048 sc1 lds
buffer_load_dwordx4 v2, s[8:11], s37 offen offset:3072 sc1 lds
s_add_u32 s38, s35, 15
s_and_b32 s38, s38, 15
s_lshl_b32 s38, s38, 17
s_add_u32 m0, s40, 139264
s_nop 0
buffer_load_dwordx4 v3, s[12:15], s38 offen lds
s_add_u32 m0, s40, 140288
s_add_u32 s38, s38, 16384
buffer_load_dwordx4 v3, s[12:15], s38 offen lds
v_lshlrev_b32 v24, 16, v156
v_and_b32 v25, 0xffff0000, v156
v_lshlrev_b32 v26, 16, v157
v_and_b32 v27, 0xffff0000, v157
v_lshlrev_b32 v28, 16, v158
v_and_b32 v29, 0xffff0000, v158
v_lshlrev_b32 v30, 16, v159
v_and_b32 v31, 0xffff0000, v159
v_add_f32 v240, v240, v24
v_add_f32 v241, v241, v25
v_add_f32 v242, v242, v26
v_add_f32 v243, v243, v27
v_add_f32 v244, v244, v28
v_add_f32 v245, v245, v29
v_add_f32 v246, v246, v30
v_add_f32 v247, v247, v31
s_load_dword s3, s[4:5], 57536
s_load_dword s3, s[4:5], 64512
s_load_dword s3, s[4:5], 64576
s_waitcnt vmcnt(14)
s_barrier
s_add_u32 s37, s35, 12
s_and_b32 s37, s37, 15
s_lshl_b32 s37, s37, 14
s_add_u32 m0, s39, 0
s_nop 0
buffer_load_dwordx4 v2, s[8:11], s37 offen offset:0 sc1 lds
buffer_load_dwordx4 v2, s[8:11], s37 offen offset:1024 sc1 lds
buffer_load_dwordx4 v2, s[8:11], s37 offen offset:2048 sc1 lds
buffer_load_dwordx4 v2, s[8:11], s37 offen offset:3072 sc1 lds
s_load_dword s3, s[4:5], 64640
s_load_dword s3, s[4:5], 64704
s_load_dword s3, s[4:5], 71680
s_waitcnt vmcnt(12)
s_barrier
s_add_u32 s37, s35, 13
s_and_b32 s37, s37, 15
s_lshl_b32 s37, s37, 14
s_add_u32 m0, s39, 49152
s_nop 0
buffer_load_dwordx4 v2, s[8:11], s37 offen offset:0 sc1 lds
buffer_load_dwordx4 v2, s[8:11], s37 offen offset:1024 sc1 lds
buffer_load_dwordx4 v2, s[8:11], s37 offen offset:2048 sc1 lds
buffer_load_dwordx4 v2, s[8:11], s37 offen offset:3072 sc1 lds
s_load_dword s3, s[4:5], 71744
s_load_dword s3, s[4:5], 71808
s_load_dword s3, s[4:5], 71872
s_waitcnt vmcnt(10)
s_barrier
s_add_u32 s37, s35, 14
s_and_b32 s37, s37, 15
s_lshl_b32 s37, s37, 14
s_add_u32 m0, s39, 98304
s_nop 0
buffer_load_dwordx4 v2, s[8:11], s37 offen offset:0 sc1 lds
buffer_load_dwordx4 v2, s[8:11], s37 offen offset:1024 sc1 lds
buffer_load_dwordx4 v2, s[8:11], s37 offen offset:2048 sc1 lds
buffer_load_dwordx4 v2, s[8:11], s37 offen offset:3072 sc1 lds
s_waitcnt vmcnt(8)
s_barrier
s_add_u32 s37, s35, 15
s_and_b32 s37, s37, 15
s_lshl_b32 s37, s37, 14
s_add_u32 m0, s39, 147456
s_nop 0
buffer_load_dwordx4 v2, s[8:11], s37 offen offset:0 sc1 lds
buffer_load_dwordx4 v2, s[8:11], s37 offen offset:1024 sc1 lds
buffer_load_dwordx4 v2, s[8:11], s37 offen offset:2048 sc1 lds
buffer_load_dwordx4 v2, s[8:11], s37 offen offset:3072 sc1 lds
s_waitcnt vmcnt(8)
s_barrier
s_nop 0
v_permlane32_swap_b32 v240, v244
v_permlane32_swap_b32 v241, v245
v_permlane32_swap_b32 v242, v246
v_permlane32_swap_b32 v243, v247
v_add_f32 v240, v240, v244
v_add_f32 v241, v241, v245
v_add_f32 v242, v242, v246
v_add_f32 v243, v243, v247
s_nop 0
v_permlane16_swap_b32 v240, v242
v_permlane16_swap_b32 v241, v243
v_add_f32 v240, v240, v242
v_add_f32 v241, v241, v243
s_waitcnt vmcnt(4)
s_barrier
s_add_u32 s38, s35, 0
s_and_b32 s38, s38, 15
s_mul_i32 s38, s38, 458752
s_add_u32 m0, s46, 0
s_nop 0
buffer_load_dwordx4 v8, s[88:91], s38 offen lds
s_add_u32 m0, s46, 1024
s_nop 0
buffer_load_dwordx4 v9, s[88:91], s38 offen lds
s_add_u32 m0, s46, 2048
s_nop 0
buffer_load_dwordx4 v10, s[88:91], s38 offen lds
s_add_u32 m0, s46, 3072
s_add_u32 s38, s38, 114688
buffer_load_dwordx4 v8, s[88:91], s38 offen lds
s_add_u32 m0, s46, 4096
s_nop 0
buffer_load_dwordx4 v9, s[88:91], s38 offen lds
s_add_u32 m0, s46, 5120
s_nop 0
buffer_load_dwordx4 v10, s[88:91], s38 offen lds
s_add_u32 s38, s35, 1
s_and_b32 s38, s38, 15
s_mul_i32 s38, s38, 458752
s_add_u32 m0, s46, 49152
s_nop 0
buffer_load_dwordx4 v8, s[88:91], s38 offen lds
s_add_u32 m0, s46, 50176
s_nop 0
buffer_load_dwordx4 v9, s[88:91], s38 offen lds
s_add_u32 m0, s46, 51200
s_nop 0
buffer_load_dwordx4 v10, s[88:91], s38 offen lds
s_add_u32 m0, s46, 52224
s_add_u32 s38, s38, 114688
buffer_load_dwordx4 v8, s[88:91], s38 offen lds
s_add_u32 m0, s46, 53248
s_nop 0
buffer_load_dwordx4 v9, s[88:91], s38 offen lds
s_add_u32 m0, s46, 54272
s_nop 0
buffer_load_dwordx4 v10, s[88:91], s38 offen lds
s_waitcnt vmcnt(12)
s_barrier
s_barrier
s_branch Lk3a
Lk2end_83:
Lk3:
s_branch Lgb_97
Lk3a:
s_mul_i32 s43, s34, 262144
s_add_u32 s8, s82, s43
s_addc_u32 s9, s83, 0
s_add_u32 s8, s8, 4194304
s_addc_u32 s9, s9, 0
s_mov_b32 s10, 262144
s_mov_b32 s11, 0x20000
s_mul_i32 s43, s34, 917504
s_add_u32 s24, s82, s43
s_addc_u32 s25, s83, 0
s_add_u32 s24, s24, 8388608
s_addc_u32 s25, s25, 0
s_mov_b32 s26, 917504
s_mov_b32 s27, 0x20000
s_add_u32 s84, s82, 27262976
s_addc_u32 s85, s83, 0
s_mov_b32 s86, 229376
s_mov_b32 s87, 0x20000
s_and_b32 s47, s36, 3
s_lshr_b32 s62, s47, 1
s_and_b32 s63, s47, 1
v_lshlrev_b32 v2, 4, v1
s_lshl_b32 s39, s47, 12
v_add_u32 v3, s39, v2
s_cmp_eq_u32 s62, 0
s_cselect_b32 s44, s72, s74
s_cselect_b32 s45, s73, s75
s_lshl_b32 s43, s35, 8
s_add_u32 s12, s44, s43
s_addc_u32 s13, s45, 0
s_mov_b32 s14, 7333120
s_mov_b32 s15, 0x20000
v_lshrrev_b32 v28, 4, v1
v_lshlrev_b32 v29, 1, v28
v_and_b32 v4, 15, v1
v_xor_b32 v4, v4, v29
v_lshlrev_b32 v4, 4, v4
v_mul_u32_u24 v28, 7168, v28
v_add_u32 v4, v4, v28
s_mul_i32 s43, s63, 229376
v_add_u32 v4, s43, v4
v_xor_b32 v5, 128, v4
v_add_u32 v5, 28672, v5
s_lshl_b32 s40, s47, 13
s_add_u32 s40, s40, 16384
s_lshl_b32 s43, s62, 12
v_add_u32 v9, s43, v2
v_add_u32 v10, 98304, v9
s_lshl_b32 s43, s47, 9
s_add_u32 s43, s43, 151552
v_and_b32 v28, 15, v1
v_lshl_add_u32 v28, v28, 5, s43
v_lshrrev_b32 v29, 4, v1
v_lshl_add_u32 v28, v29, 3, v28
ds_write_b64 v28, v[240:241]
s_waitcnt lgkmcnt(0)
v_lshrrev_b32 v27, 2, v1
v_bfe_u32 v28, v27, 2, 1
v_mul_u32_u24 v27, 192, v27
v_add_u32 v27, 16384, v27
v_and_b32 v29, 3, v1
v_lshl_add_u32 v12, v29, 3, v27
s_lshl_b32 s43, s63, 6
v_add_u32 v12, s43, v12
v_lshl_add_u32 v11, v28, 5, v12
v_xor_b32 v30, 1, v28
v_lshl_add_u32 v12, v30, 5, v12
v_xor_b32 v28, s63, v28
v_lshl_add_u32 v27, v28, 4, v27
v_lshrrev_b32 v28, 1, v29
v_lshl_add_u32 v27, v28, 5, v27
v_and_b32 v28, 1, v29
v_lshl_add_u32 v27, v28, 3, v27
v_add_u32 v13, 128, v27
v_add_u32 v14, 49152, v11
v_add_u32 v15, 49152, v12
v_add_u32 v16, 49152, v13
v_add_u32 v17, 98304, v11
v_add_u32 v18, 98304, v12
v_add_u32 v19, 98304, v13
v_bfe_u32 v28, v1, 3, 1
v_lshlrev_b32 v28, 6, v28
v_bfe_u32 v29, v1, 1, 2
s_lshl_b32 s43, s48, 3
s_lshl_b32 s44, s63, 2
s_add_u32 s43, s43, s44
v_add3_u32 v28, v28, v29, s43
v_mul_u32_u24 v28, 7168, v28
v_and_b32 v29, 1, v1
v_mul_u32_u24 v29, 188, v29
v_add_u32 v20, v28, v29
s_cmp_lg_u32 s36, 4
s_cbranch_scc1 Lwm_99
s_branch Lst_8_1
Lwr_165:
s_branch Lwe_98
Lwm_99:
s_cmp_lg_u32 s36, 5
s_cbranch_scc1 Lwm_100
s_branch Lst_9_1
Lwr_166:
s_branch Lwe_98
Lwm_100:
s_cmp_lg_u32 s36, 6
s_cbranch_scc1 Lwm_101
s_branch Lst_10_1
Lwr_167:
s_branch Lwe_98
Lwm_101:
s_cmp_lg_u32 s36, 7
s_cbranch_scc1 Lwm_102
s_nop 0
s_branch Lwe_98
Lwm_102:
Lwe_98:
s_barrier
s_cmp_lg_u32 s36, 4
s_cbranch_scc1 Lwm_104
s_branch Lst_11_1
Lwr_169:
s_branch Lwe_103
Lwm_104:
s_cmp_lg_u32 s36, 5
s_cbranch_scc1 Lwm_105
s_branch Lst_12_1
Lwr_170:
s_branch Lwe_103
Lwm_105:
s_cmp_lg_u32 s36, 6
s_cbranch_scc1 Lwm_106
s_branch Lst_13_1
Lwr_171:
s_branch Lwe_103
Lwm_106:
s_cmp_lg_u32 s36, 7
s_cbranch_scc1 Lwm_107
s_branch Lst_14_1
Lwr_172:
s_branch Lwe_103
Lwm_107:
Lwe_103:
s_waitcnt vmcnt(0) lgkmcnt(0)
s_barrier
ds_read_b128 v[32:35], v9 offset:0
ds_read_b64_tr_b16 v[48:49], v11 offset:0
ds_read_b64_tr_b16 v[50:51], v11 offset:3072
ds_read_b64_tr_b16 v[52:53], v12 offset:0
ds_read_b64_tr_b16 v[54:55], v12 offset:3072
ds_read_b64_tr_b16 v[56:57], v13 offset:0
ds_read_b64_tr_b16 v[58:59], v13 offset:3072
ds_read_b64_tr_b16 v[60:61], v11 offset:12288
ds_read_b64_tr_b16 v[62:63], v11 offset:15360
ds_read_b64_tr_b16 v[64:65], v12 offset:12288
ds_read_b64_tr_b16 v[66:67], v12 offset:15360
ds_read_b64_tr_b16 v[68:69], v13 offset:12288
ds_read_b64_tr_b16 v[70:71], v13 offset:15360
ds_read_b128 v[36:39], v9 offset:1024
ds_read_b128 v[40:43], v9 offset:2048
ds_read_b128 v[44:47], v9 offset:3072
s_waitcnt lgkmcnt(0)
v_mfma_f32_16x16x32_bf16 v[128:131], v[48:51], v[32:35], 0
ds_read_b128 v[72:75], v9 offset:8192
v_mfma_f32_16x16x32_bf16 v[132:135], v[52:55], v[32:35], 0
ds_read_b64_tr_b16 v[88:89], v11 offset:6144
v_mfma_f32_16x16x32_bf16 v[136:139], v[56:59], v[32:35], 0
ds_read_b64_tr_b16 v[90:91], v11 offset:9216
v_mfma_f32_16x16x32_bf16 v[140:143], v[60:63], v[32:35], 0
ds_read_b64_tr_b16 v[92:93], v12 offset:6144
v_mfma_f32_16x16x32_bf16 v[144:147], v[64:67], v[32:35], 0
ds_read_b64_tr_b16 v[94:95], v12 offset:9216
v_mfma_f32_16x16x32_bf16 v[148:151], v[68:71], v[32:35], 0
ds_read_b64_tr_b16 v[96:97], v13 offset:6144
v_mfma_f32_16x16x32_bf16 v[172:175], v[68:71], v[36:39], 0
ds_read_b64_tr_b16 v[98:99], v13 offset:9216
v_mfma_f32_16x16x32_bf16 v[168:171], v[64:67], v[36:39], 0
ds_read_b64_tr_b16 v[100:101], v11 offset:18432
v_mfma_f32_16x16x32_bf16 v[164:167], v[60:63], v[36:39], 0
ds_read_b64_tr_b16 v[102:103], v11 offset:21504
v_mfma_f32_16x16x32_bf16 v[160:163], v[56:59], v[36:39], 0
ds_read_b64_tr_b16 v[104:105], v12 offset:18432
v_mfma_f32_16x16x32_bf16 v[156:159], v[52:55], v[36:39], 0
ds_read_b64_tr_b16 v[106:107], v12 offset:21504
v_mfma_f32_16x16x32_bf16 v[152:155], v[48:51], v[36:39], 0
ds_read_b64_tr_b16 v[108:109], v13 offset:18432
v_mfma_f32_16x16x32_bf16 v[176:179], v[48:51], v[40:43], 0
ds_read_b64_tr_b16 v[110:111], v13 offset:21504
v_mfma_f32_16x16x32_bf16 v[180:183], v[52:55], v[40:43], 0
ds_read_b128 v[76:79], v9 offset:9216
v_mfma_f32_16x16x32_bf16 v[184:187], v[56:59], v[40:43], 0
ds_read_b128 v[80:83], v9 offset:10240
v_mfma_f32_16x16x32_bf16 v[188:191], v[60:63], v[40:43], 0
ds_read_b128 v[84:87], v9 offset:11264
v_mfma_f32_16x16x32_bf16 v[192:195], v[64:67], v[40:43], 0
v_mfma_f32_16x16x32_bf16 v[196:199], v[68:71], v[40:43], 0
v_mfma_f32_16x16x32_bf16 v[220:223], v[68:71], v[44:47], 0
v_mfma_f32_16x16x32_bf16 v[216:219], v[64:67], v[44:47], 0
v_mfma_f32_16x16x32_bf16 v[212:215], v[60:63], v[44:47], 0
v_mfma_f32_16x16x32_bf16 v[208:211], v[56:59], v[44:47], 0
v_mfma_f32_16x16x32_bf16 v[204:207], v[52:55], v[44:47], 0
v_mfma_f32_16x16x32_bf16 v[200:203], v[48:51], v[44:47], 0
s_waitcnt lgkmcnt(0)
s_barrier
v_mfma_f32_16x16x32_bf16 v[128:131], v[88:91], v[72:75], v[128:131]
ds_read_b128 v[32:35], v9 offset:49152
v_mfma_f32_16x16x32_bf16 v[132:135], v[92:95], v[72:75], v[132:135]
ds_read_b64_tr_b16 v[48:49], v14 offset:0
v_mfma_f32_16x16x32_bf16 v[136:139], v[96:99], v[72:75], v[136:139]
ds_read_b64_tr_b16 v[50:51], v14 offset:3072
v_mfma_f32_16x16x32_bf16 v[140:143], v[100:103], v[72:75], v[140:143]
ds_read_b64_tr_b16 v[52:53], v15 offset:0
v_mfma_f32_16x16x32_bf16 v[144:147], v[104:107], v[72:75], v[144:147]
ds_read_b64_tr_b16 v[54:55], v15 offset:3072
v_mfma_f32_16x16x32_bf16 v[148:151], v[108:111], v[72:75], v[148:151]
ds_read_b64_tr_b16 v[56:57], v16 offset:0
v_mfma_f32_16x16x32_bf16 v[172:175], v[108:111], v[76:79], v[172:175]
ds_read_b64_tr_b16 v[58:59], v16 offset:3072
v_mfma_f32_16x16x32_bf16 v[168:171], v[104:107], v[76:79], v[168:171]
ds_read_b64_tr_b16 v[60:61], v14 offset:12288
v_mfma_f32_16x16x32_bf16 v[164:167], v[100:103], v[76:79], v[164:167]
ds_read_b64_tr_b16 v[62:63], v14 offset:15360
v_mfma_f32_16x16x32_bf16 v[160:163], v[96:99], v[76:79], v[160:163]
ds_read_b64_tr_b16 v[64:65], v15 offset:12288
v_mfma_f32_16x16x32_bf16 v[156:159], v[92:95], v[76:79], v[156:159]
ds_read_b64_tr_b16 v[66:67], v15 offset:15360
v_mfma_f32_16x16x32_bf16 v[152:155], v[88:91], v[76:79], v[152:155]
ds_read_b64_tr_b16 v[68:69], v16 offset:12288
v_mfma_f32_16x16x32_bf16 v[176:179], v[88:91], v[80:83], v[176:179]
ds_read_b64_tr_b16 v[70:71], v16 offset:15360
v_mfma_f32_16x16x32_bf16 v[180:183], v[92:95], v[80:83], v[180:183]
ds_read_b128 v[36:39], v9 offset:50176
v_mfma_f32_16x16x32_bf16 v[184:187], v[96:99], v[80:83], v[184:187]
ds_read_b128 v[40:43], v9 offset:51200
v_mfma_f32_16x16x32_bf16 v[188:191], v[100:103], v[80:83], v[188:191]
ds_read_b128 v[44:47], v9 offset:52224
v_mfma_f32_16x16x32_bf16 v[192:195], v[104:107], v[80:83], v[192:195]
v_mfma_f32_16x16x32_bf16 v[196:199], v[108:111], v[80:83], v[196:199]
v_mfma_f32_16x16x32_bf16 v[220:223], v[108:111], v[84:87], v[220:223]
v_mfma_f32_16x16x32_bf16 v[216:219], v[104:107], v[84:87], v[216:219]
v_mfma_f32_16x16x32_bf16 v[212:215], v[100:103], v[84:87], v[212:215]
v_mfma_f32_16x16x32_bf16 v[208:211], v[96:99], v[84:87], v[208:211]
v_mfma_f32_16x16x32_bf16 v[204:207], v[92:95], v[84:87], v[204:207]
v_mfma_f32_16x16x32_bf16 v[200:203], v[88:91], v[84:87], v[200:203]
s_mov_b32 s41, 5
Lk3l_108:
s_waitcnt lgkmcnt(0)
v_mfma_f32_16x16x32_bf16 v[128:131], v[48:51], v[32:35], v[128:131]
ds_read_b128 v[72:75], v9 offset:57344
v_mfma_f32_16x16x32_bf16 v[132:135], v[52:55], v[32:35], v[132:135]
ds_read_b64_tr_b16 v[88:89], v14 offset:6144
v_mfma_f32_16x16x32_bf16 v[136:139], v[56:59], v[32:35], v[136:139]
ds_read_b64_tr_b16 v[90:91], v14 offset:9216
v_mfma_f32_16x16x32_bf16 v[140:143], v[60:63], v[32:35], v[140:143]
ds_read_b64_tr_b16 v[92:93], v15 offset:6144
v_mfma_f32_16x16x32_bf16 v[144:147], v[64:67], v[32:35], v[144:147]
ds_read_b64_tr_b16 v[94:95], v15 offset:9216
v_mfma_f32_16x16x32_bf16 v[148:151], v[68:71], v[32:35], v[148:151]
ds_read_b64_tr_b16 v[96:97], v16 offset:6144
v_mfma_f32_16x16x32_bf16 v[172:175], v[68:71], v[36:39], v[172:175]
ds_read_b64_tr_b16 v[98:99], v16 offset:9216
v_mfma_f32_16x16x32_bf16 v[168:171], v[64:67], v[36:39], v[168:171]
ds_read_b64_tr_b16 v[100:101], v14 offset:18432
v_mfma_f32_16x16x32_bf16 v[164:167], v[60:63], v[36:39], v[164:167]
ds_read_b64_tr_b16 v[102:103], v14 offset:21504
v_mfma_f32_16x16x32_bf16 v[160:163], v[56:59], v[36:39], v[160:163]
ds_read_b64_tr_b16 v[104:105], v15 offset:18432
v_mfma_f32_16x16x32_bf16 v[156:159], v[52:55], v[36:39], v[156:159]
ds_read_b64_tr_b16 v[106:107], v15 offset:21504
v_mfma_f32_16x16x32_bf16 v[152:155], v[48:51], v[36:39], v[152:155]
ds_read_b64_tr_b16 v[108:109], v16 offset:18432
v_mfma_f32_16x16x32_bf16 v[176:179], v[48:51], v[40:43], v[176:179]
ds_read_b64_tr_b16 v[110:111], v16 offset:21504
v_mfma_f32_16x16x32_bf16 v[180:183], v[52:55], v[40:43], v[180:183]
ds_read_b128 v[76:79], v9 offset:58368
v_mfma_f32_16x16x32_bf16 v[184:187], v[56:59], v[40:43], v[184:187]
ds_read_b128 v[80:83], v9 offset:59392
v_mfma_f32_16x16x32_bf16 v[188:191], v[60:63], v[40:43], v[188:191]
ds_read_b128 v[84:87], v9 offset:60416
v_mfma_f32_16x16x32_bf16 v[192:195], v[64:67], v[40:43], v[192:195]
v_mfma_f32_16x16x32_bf16 v[196:199], v[68:71], v[40:43], v[196:199]
v_mfma_f32_16x16x32_bf16 v[220:223], v[68:71], v[44:47], v[220:223]
v_mfma_f32_16x16x32_bf16 v[216:219], v[64:67], v[44:47], v[216:219]
v_mfma_f32_16x16x32_bf16 v[212:215], v[60:63], v[44:47], v[212:215]
v_mfma_f32_16x16x32_bf16 v[208:211], v[56:59], v[44:47], v[208:211]
v_mfma_f32_16x16x32_bf16 v[204:207], v[52:55], v[44:47], v[204:207]
v_mfma_f32_16x16x32_bf16 v[200:203], v[48:51], v[44:47], v[200:203]
s_waitcnt lgkmcnt(0)
s_barrier
v_mfma_f32_16x16x32_bf16 v[128:131], v[88:91], v[72:75], v[128:131]
ds_read_b128 v[32:35], v10 offset:0
v_mfma_f32_16x16x32_bf16 v[132:135], v[92:95], v[72:75], v[132:135]
ds_read_b64_tr_b16 v[48:49], v17 offset:0
v_mfma_f32_16x16x32_bf16 v[136:139], v[96:99], v[72:75], v[136:139]
ds_read_b64_tr_b16 v[50:51], v17 offset:3072
v_mfma_f32_16x16x32_bf16 v[140:143], v[100:103], v[72:75], v[140:143]
ds_read_b64_tr_b16 v[52:53], v18 offset:0
v_mfma_f32_16x16x32_bf16 v[144:147], v[104:107], v[72:75], v[144:147]
ds_read_b64_tr_b16 v[54:55], v18 offset:3072
v_mfma_f32_16x16x32_bf16 v[148:151], v[108:111], v[72:75], v[148:151]
ds_read_b64_tr_b16 v[56:57], v19 offset:0
v_mfma_f32_16x16x32_bf16 v[172:175], v[108:111], v[76:79], v[172:175]
ds_read_b64_tr_b16 v[58:59], v19 offset:3072
v_mfma_f32_16x16x32_bf16 v[168:171], v[104:107], v[76:79], v[168:171]
ds_read_b64_tr_b16 v[60:61], v17 offset:12288
v_mfma_f32_16x16x32_bf16 v[164:167], v[100:103], v[76:79], v[164:167]
ds_read_b64_tr_b16 v[62:63], v17 offset:15360
v_mfma_f32_16x16x32_bf16 v[160:163], v[96:99], v[76:79], v[160:163]
ds_read_b64_tr_b16 v[64:65], v18 offset:12288
v_mfma_f32_16x16x32_bf16 v[156:159], v[92:95], v[76:79], v[156:159]
ds_read_b64_tr_b16 v[66:67], v18 offset:15360
v_mfma_f32_16x16x32_bf16 v[152:155], v[88:91], v[76:79], v[152:155]
ds_read_b64_tr_b16 v[68:69], v19 offset:12288
v_mfma_f32_16x16x32_bf16 v[176:179], v[88:91], v[80:83], v[176:179]
ds_read_b64_tr_b16 v[70:71], v19 offset:15360
v_mfma_f32_16x16x32_bf16 v[180:183], v[92:95], v[80:83], v[180:183]
ds_read_b128 v[36:39], v10 offset:1024
v_mfma_f32_16x16x32_bf16 v[184:187], v[96:99], v[80:83], v[184:187]
ds_read_b128 v[40:43], v10 offset:2048
v_mfma_f32_16x16x32_bf16 v[188:191], v[100:103], v[80:83], v[188:191]
ds_read_b128 v[44:47], v10 offset:3072
v_mfma_f32_16x16x32_bf16 v[192:195], v[104:107], v[80:83], v[192:195]
v_mfma_f32_16x16x32_bf16 v[196:199], v[108:111], v[80:83], v[196:199]
v_mfma_f32_16x16x32_bf16 v[220:223], v[108:111], v[84:87], v[220:223]
v_mfma_f32_16x16x32_bf16 v[216:219], v[104:107], v[84:87], v[216:219]
v_mfma_f32_16x16x32_bf16 v[212:215], v[100:103], v[84:87], v[212:215]
v_mfma_f32_16x16x32_bf16 v[208:211], v[96:99], v[84:87], v[208:211]
v_mfma_f32_16x16x32_bf16 v[204:207], v[92:95], v[84:87], v[204:207]
v_mfma_f32_16x16x32_bf16 v[200:203], v[88:91], v[84:87], v[200:203]
s_waitcnt lgkmcnt(0)
v_mfma_f32_16x16x32_bf16 v[128:131], v[48:51], v[32:35], v[128:131]
ds_read_b128 v[72:75], v10 offset:8192
v_mfma_f32_16x16x32_bf16 v[132:135], v[52:55], v[32:35], v[132:135]
ds_read_b64_tr_b16 v[88:89], v17 offset:6144
v_mfma_f32_16x16x32_bf16 v[136:139], v[56:59], v[32:35], v[136:139]
ds_read_b64_tr_b16 v[90:91], v17 offset:9216
v_mfma_f32_16x16x32_bf16 v[140:143], v[60:63], v[32:35], v[140:143]
ds_read_b64_tr_b16 v[92:93], v18 offset:6144
v_mfma_f32_16x16x32_bf16 v[144:147], v[64:67], v[32:35], v[144:147]
ds_read_b64_tr_b16 v[94:95], v18 offset:9216
v_mfma_f32_16x16x32_bf16 v[148:151], v[68:71], v[32:35], v[148:151]
ds_read_b64_tr_b16 v[96:97], v19 offset:6144
v_mfma_f32_16x16x32_bf16 v[172:175], v[68:71], v[36:39], v[172:175]
ds_read_b64_tr_b16 v[98:99], v19 offset:9216
v_mfma_f32_16x16x32_bf16 v[168:171], v[64:67], v[36:39], v[168:171]
ds_read_b64_tr_b16 v[100:101], v17 offset:18432
v_mfma_f32_16x16x32_bf16 v[164:167], v[60:63], v[36:39], v[164:167]
ds_read_b64_tr_b16 v[102:103], v17 offset:21504
v_mfma_f32_16x16x32_bf16 v[160:163], v[56:59], v[36:39], v[160:163]
ds_read_b64_tr_b16 v[104:105], v18 offset:18432
v_mfma_f32_16x16x32_bf16 v[156:159], v[52:55], v[36:39], v[156:159]
ds_read_b64_tr_b16 v[106:107], v18 offset:21504
v_mfma_f32_16x16x32_bf16 v[152:155], v[48:51], v[36:39], v[152:155]
ds_read_b64_tr_b16 v[108:109], v19 offset:18432
v_mfma_f32_16x16x32_bf16 v[176:179], v[48:51], v[40:43], v[176:179]
ds_read_b64_tr_b16 v[110:111], v19 offset:21504
v_mfma_f32_16x16x32_bf16 v[180:183], v[52:55], v[40:43], v[180:183]
ds_read_b128 v[76:79], v10 offset:9216
v_mfma_f32_16x16x32_bf16 v[184:187], v[56:59], v[40:43], v[184:187]
ds_read_b128 v[80:83], v10 offset:10240
v_mfma_f32_16x16x32_bf16 v[188:191], v[60:63], v[40:43], v[188:191]
ds_read_b128 v[84:87], v10 offset:11264
v_mfma_f32_16x16x32_bf16 v[192:195], v[64:67], v[40:43], v[192:195]
v_mfma_f32_16x16x32_bf16 v[196:199], v[68:71], v[40:43], v[196:199]
v_mfma_f32_16x16x32_bf16 v[220:223], v[68:71], v[44:47], v[220:223]
v_mfma_f32_16x16x32_bf16 v[216:219], v[64:67], v[44:47], v[216:219]
v_mfma_f32_16x16x32_bf16 v[212:215], v[60:63], v[44:47], v[212:215]
v_mfma_f32_16x16x32_bf16 v[208:211], v[56:59], v[44:47], v[208:211]
v_mfma_f32_16x16x32_bf16 v[204:207], v[52:55], v[44:47], v[204:207]
v_mfma_f32_16x16x32_bf16 v[200:203], v[48:51], v[44:47], v[200:203]
s_waitcnt lgkmcnt(0)
s_barrier
v_mfma_f32_16x16x32_bf16 v[128:131], v[88:91], v[72:75], v[128:131]
ds_read_b128 v[32:35], v9 offset:0
v_mfma_f32_16x16x32_bf16 v[132:135], v[92:95], v[72:75], v[132:135]
ds_read_b64_tr_b16 v[48:49], v11 offset:0
v_mfma_f32_16x16x32_bf16 v[136:139], v[96:99], v[72:75], v[136:139]
ds_read_b64_tr_b16 v[50:51], v11 offset:3072
v_mfma_f32_16x16x32_bf16 v[140:143], v[100:103], v[72:75], v[140:143]
ds_read_b64_tr_b16 v[52:53], v12 offset:0
v_mfma_f32_16x16x32_bf16 v[144:147], v[104:107], v[72:75], v[144:147]
ds_read_b64_tr_b16 v[54:55], v12 offset:3072
v_mfma_f32_16x16x32_bf16 v[148:151], v[108:111], v[72:75], v[148:151]
ds_read_b64_tr_b16 v[56:57], v13 offset:0
v_mfma_f32_16x16x32_bf16 v[172:175], v[108:111], v[76:79], v[172:175]
ds_read_b64_tr_b16 v[58:59], v13 offset:3072
v_mfma_f32_16x16x32_bf16 v[168:171], v[104:107], v[76:79], v[168:171]
ds_read_b64_tr_b16 v[60:61], v11 offset:12288
v_mfma_f32_16x16x32_bf16 v[164:167], v[100:103], v[76:79], v[164:167]
ds_read_b64_tr_b16 v[62:63], v11 offset:15360
v_mfma_f32_16x16x32_bf16 v[160:163], v[96:99], v[76:79], v[160:163]
ds_read_b64_tr_b16 v[64:65], v12 offset:12288
v_mfma_f32_16x16x32_bf16 v[156:159], v[92:95], v[76:79], v[156:159]
ds_read_b64_tr_b16 v[66:67], v12 offset:15360
v_mfma_f32_16x16x32_bf16 v[152:155], v[88:91], v[76:79], v[152:155]
ds_read_b64_tr_b16 v[68:69], v13 offset:12288
v_mfma_f32_16x16x32_bf16 v[176:179], v[88:91], v[80:83], v[176:179]
ds_read_b64_tr_b16 v[70:71], v13 offset:15360
v_mfma_f32_16x16x32_bf16 v[180:183], v[92:95], v[80:83], v[180:183]
ds_read_b128 v[36:39], v9 offset:1024
v_mfma_f32_16x16x32_bf16 v[184:187], v[96:99], v[80:83], v[184:187]
ds_read_b128 v[40:43], v9 offset:2048
v_mfma_f32_16x16x32_bf16 v[188:191], v[100:103], v[80:83], v[188:191]
ds_read_b128 v[44:47], v9 offset:3072
v_mfma_f32_16x16x32_bf16 v[192:195], v[104:107], v[80:83], v[192:195]
v_mfma_f32_16x16x32_bf16 v[196:199], v[108:111], v[80:83], v[196:199]
v_mfma_f32_16x16x32_bf16 v[220:223], v[108:111], v[84:87], v[220:223]
s_branch Lov_8
.p2align 12
.fill 64, 4, 0xbf800000
Lst_8_0:
s_branch Lwr_154
Lst_8_1:
s_branch Lwr_165
s_nop 0
Lov_8:
v_mfma_f32_16x16x32_bf16 v[216:219], v[104:107], v[84:87], v[216:219]
v_mfma_f32_16x16x32_bf16 v[212:215], v[100:103], v[84:87], v[212:215]
v_mfma_f32_16x16x32_bf16 v[208:211], v[96:99], v[84:87], v[208:211]
v_mfma_f32_16x16x32_bf16 v[204:207], v[92:95], v[84:87], v[204:207]
v_mfma_f32_16x16x32_bf16 v[200:203], v[88:91], v[84:87], v[200:203]
s_waitcnt lgkmcnt(0)
v_mfma_f32_16x16x32_bf16 v[128:131], v[48:51], v[32:35], v[128:131]
ds_read_b128 v[72:75], v9 offset:8192
v_mfma_f32_16x16x32_bf16 v[132:135], v[52:55], v[32:35], v[132:135]
ds_read_b64_tr_b16 v[88:89], v11 offset:6144
v_mfma_f32_16x16x32_bf16 v[136:139], v[56:59], v[32:35], v[136:139]
ds_read_b64_tr_b16 v[90:91], v11 offset:9216
v_mfma_f32_16x16x32_bf16 v[140:143], v[60:63], v[32:35], v[140:143]
ds_read_b64_tr_b16 v[92:93], v12 offset:6144
v_mfma_f32_16x16x32_bf16 v[144:147], v[64:67], v[32:35], v[144:147]
ds_read_b64_tr_b16 v[94:95], v12 offset:9216
v_mfma_f32_16x16x32_bf16 v[148:151], v[68:71], v[32:35], v[148:151]
ds_read_b64_tr_b16 v[96:97], v13 offset:6144
v_mfma_f32_16x16x32_bf16 v[172:175], v[68:71], v[36:39], v[172:175]
ds_read_b64_tr_b16 v[98:99], v13 offset:9216
v_mfma_f32_16x16x32_bf16 v[168:171], v[64:67], v[36:39], v[168:171]
ds_read_b64_tr_b16 v[100:101], v11 offset:18432
v_mfma_f32_16x16x32_bf16 v[164:167], v[60:63], v[36:39], v[164:167]
ds_read_b64_tr_b16 v[102:103], v11 offset:21504
v_mfma_f32_16x16x32_bf16 v[160:163], v[56:59], v[36:39], v[160:163]
ds_read_b64_tr_b16 v[104:105], v12 offset:18432
v_mfma_f32_16x16x32_bf16 v[156:159], v[52:55], v[36:39], v[156:159]
ds_read_b64_tr_b16 v[106:107], v12 offset:21504
v_mfma_f32_16x16x32_bf16 v[152:155], v[48:51], v[36:39], v[152:155]
ds_read_b64_tr_b16 v[108:109], v13 offset:18432
v_mfma_f32_16x16x32_bf16 v[176:179], v[48:51], v[40:43], v[176:179]
ds_read_b64_tr_b16 v[110:111], v13 offset:21504
v_mfma_f32_16x16x32_bf16 v[180:183], v[52:55], v[40:43], v[180:183]
ds_read_b128 v[76:79], v9 offset:9216
v_mfma_f32_16x16x32_bf16 v[184:187], v[56:59], v[40:43], v[184:187]
ds_read_b128 v[80:83], v9 offset:10240
v_mfma_f32_16x16x32_bf16 v[188:191], v[60:63], v[40:43], v[188:191]
ds_read_b128 v[84:87], v9 offset:11264
v_mfma_f32_16x16x32_bf16 v[192:195], v[64:67], v[40:43], v[192:195]
v_mfma_f32_16x16x32_bf16 v[196:199], v[68:71], v[40:43], v[196:199]
v_mfma_f32_16x16x32_bf16 v[220:223], v[68:71], v[44:47], v[220:223]
v_mfma_f32_16x16x32_bf16 v[216:219], v[64:67], v[44:47], v[216:219]
v_mfma_f32_16x16x32_bf16 v[212:215], v[60:63], v[44:47], v[212:215]
v_mfma_f32_16x16x32_bf16 v[208:211], v[56:59], v[44:47], v[208:211]
v_mfma_f32_16x16x32_bf16 v[204:207], v[52:55], v[44:47], v[204:207]
v_mfma_f32_16x16x32_bf16 v[200:203], v[48:51], v[44:47], v[200:203]
s_waitcnt lgkmcnt(0)
s_barrier
v_mfma_f32_16x16x32_bf16 v[128:131], v[88:91], v[72:75], v[128:131]
ds_read_b128 v[32:35], v9 offset:49152
v_mfma_f32_16x16x32_bf16 v[132:135], v[92:95], v[72:75], v[132:135]
ds_read_b64_tr_b16 v[48:49], v14 offset:0
v_mfma_f32_16x16x32_bf16 v[136:139], v[96:99], v[72:75], v[136:139]
ds_read_b64_tr_b16 v[50:51], v14 offset:3072
v_mfma_f32_16x16x32_bf16 v[140:143], v[100:103], v[72:75], v[140:143]
ds_read_b64_tr_b16 v[52:53], v15 offset:0
v_mfma_f32_16x16x32_bf16 v[144:147], v[104:107], v[72:75], v[144:147]
ds_read_b64_tr_b16 v[54:55], v15 offset:3072
v_mfma_f32_16x16x32_bf16 v[148:151], v[108:111], v[72:75], v[148:151]
ds_read_b64_tr_b16 v[56:57], v16 offset:0
v_mfma_f32_16x16x32_bf16 v[172:175], v[108:111], v[76:79], v[172:175]
ds_read_b64_tr_b16 v[58:59], v16 offset:3072
v_mfma_f32_16x16x32_bf16 v[168:171], v[104:107], v[76:79], v[168:171]
ds_read_b64_tr_b16 v[60:61], v14 offset:12288
v_mfma_f32_16x16x32_bf16 v[164:167], v[100:103], v[76:79], v[164:167]
ds_read_b64_tr_b16 v[62:63], v14 offset:15360
v_mfma_f32_16x16x32_bf16 v[160:163], v[96:99], v[76:79], v[160:163]
ds_read_b64_tr_b16 v[64:65], v15 offset:12288
v_mfma_f32_16x16x32_bf16 v[156:159], v[92:95], v[76:79], v[156:159]
ds_read_b64_tr_b16 v[66:67], v15 offset:15360
v_mfma_f32_16x16x32_bf16 v[152:155], v[88:91], v[76:79], v[152:155]
ds_read_b64_tr_b16 v[68:69], v16 offset:12288
v_mfma_f32_16x16x32_bf16 v[176:179], v[88:91], v[80:83], v[176:179]
ds_read_b64_tr_b16 v[70:71], v16 offset:15360
v_mfma_f32_16x16x32_bf16 v[180:183], v[92:95], v[80:83], v[180:183]
ds_read_b128 v[36:39], v9 offset:50176
v_mfma_f32_16x16x32_bf16 v[184:187], v[96:99], v[80:83], v[184:187]
ds_read_b128 v[40:43], v9 offset:51200
v_mfma_f32_16x16x32_bf16 v[188:191], v[100:103], v[80:83], v[188:191]
ds_read_b128 v[44:47], v9 offset:52224
v_mfma_f32_16x16x32_bf16 v[192:195], v[104:107], v[80:83], v[192:195]
v_mfma_f32_16x16x32_bf16 v[196:199], v[108:111], v[80:83], v[196:199]
v_mfma_f32_16x16x32_bf16 v[220:223], v[108:111], v[84:87], v[220:223]
v_mfma_f32_16x16x32_bf16 v[216:219], v[104:107], v[84:87], v[216:219]
v_mfma_f32_16x16x32_bf16 v[212:215], v[100:103], v[84:87], v[212:215]
v_mfma_f32_16x16x32_bf16 v[208:211], v[96:99], v[84:87], v[208:211]
v_mfma_f32_16x16x32_bf16 v[204:207], v[92:95], v[84:87], v[204:207]
v_mfma_f32_16x16x32_bf16 v[200:203], v[88:91], v[84:87], v[200:203]
s_sub_u32 s41, s41, 1
s_cmp_lg_u32 s41, 0
s_cbranch_scc1 Lk3l_108
s_waitcnt lgkmcnt(0)
s_mov_b32 s28, s76
s_mov_b32 s29, s77
s_mov_b32 s30, 7340032
s_mov_b32 s31, 0x20000
s_add_u32 s37, s35, 2
s_and_b32 s37, s37, 15
s_mul_i32 s37, s37, 16384
s_add_u32 m0, s39, 0
s_nop 0
buffer_load_dwordx4 v3, s[8:11], s37 offen sc1 lds
v_lshrrev_b32 v86, 4, v1
s_lshl_b32 s43, s63, 7
s_add_u32 s43, s43, 148992
buffer_load_dwordx4 v3, s[8:11], s37 offen offset:1024 sc1 lds
v_lshl_add_u32 v87, v86, 4, s43
v_lshrrev_b32 v88, 1, v86
v_and_b32 v86, 1, v86
s_lshl_b32 s43, s63, 5
buffer_load_dwordx4 v3, s[8:11], s37 offen offset:2048 sc1 lds
s_add_u32 s43, s43, 149248
v_lshl_add_u32 v88, v88, 6, s43
v_lshl_add_u32 v88, v86, 4, v88
v_and_b32 v86, 15, v1
buffer_load_dwordx4 v3, s[8:11], s37 offen offset:3072 sc1 lds
s_lshl_b32 s43, s62, 9
s_add_u32 s43, s43, 147456
v_lshl_add_u32 v86, v86, 3, s43
s_add_u32 s38, s35, 2
s_and_b32 s38, s38, 15
s_mul_i32 s38, s38, 458752
s_add_u32 m0, s40, 0
s_nop 0
buffer_load_dwordx4 v4, s[12:15], s38 offen lds
ds_read_b128 v[32:35], v87 offset:0
ds_read_b128 v[36:39], v87 offset:64
ds_read_b128 v[40:43], v88 offset:0
ds_read_b128 v[44:47], v87 offset:896
s_add_u32 m0, s40, 1024
s_nop 0
buffer_load_dwordx4 v5, s[12:15], s38 offen lds
ds_read_b128 v[48:51], v87 offset:960
ds_read_b128 v[52:55], v88 offset:896
ds_read_b64 v[56:57], v86 offset:0
ds_read_b64 v[58:59], v86 offset:128
s_add_u32 m0, s40, 2048
s_add_u32 s38, s38, 57344
buffer_load_dwordx4 v4, s[12:15], s38 offen lds
ds_read_b64 v[60:61], v86 offset:256
ds_read_b64 v[62:63], v86 offset:384
s_mul_i32 s54, s35, 24576
s_add_u32 m0, s40, 3072
s_nop 0
buffer_load_dwordx4 v5, s[12:15], s38 offen lds
s_lshl_b32 s43, s62, 12
s_add_u32 s54, s54, s43
s_add_u32 s54, s54, 524288
s_lshl_b32 s43, s63, 9
s_add_u32 m0, s40, 4096
s_add_u32 s38, s38, 57344
buffer_load_dwordx4 v4, s[12:15], s38 offen lds
s_add_u32 s55, s54, s43
s_add_u32 s55, s55, 16384
s_lshl_b32 s43, s63, 13
s_add_u32 s54, s54, s43
s_add_u32 m0, s40, 5120
s_nop 0
buffer_load_dwordx4 v5, s[12:15], s38 offen lds
v_and_b32 v84, 32, v1
v_lshlrev_b32 v84, 4, v84
v_add_u32 v84, v84, v2
s_waitcnt lgkmcnt(0)
s_add_u32 m0, s40, 6144
s_add_u32 s38, s38, 57344
buffer_load_dwordx4 v4, s[12:15], s38 offen lds
s_add_u32 m0, s40, 7168
s_nop 0
buffer_load_dwordx4 v5, s[12:15], s38 offen lds
s_and_b32 s44, s36, 3
s_mul_i32 s43, s2, 28672
s_mul_i32 s44, s44, 7168
s_add_u32 s43, s43, s44
s_add_u32 s4, s76, s43
s_addc_u32 s5, s77, 0
s_barrier
s_cmp_eq_u32 s47, 3
s_cbranch_scc0 Lw_109
v_and_b32 v30, 31, v1
v_lshlrev_b32 v30, 4, v30
v_add_u32 v31, 153600, v30
ds_read_b128 v[108:111], v31 offset:0
ds_read_b128 v[112:115], v31 offset:512
ds_read_b128 v[116:119], v31 offset:1024
ds_read_b128 v[120:123], v31 offset:1536
s_and_b32 s44, s2, 15
s_mul_i32 s44, s44, 14336
s_lshr_b32 s43, s2, 4
s_lshl_b32 s43, s43, 9
s_add_u32 s44, s44, s43
s_waitcnt lgkmcnt(0)
v_add_f32 v108, v108, v112
v_add_f32 v116, v116, v120
v_add_f32 v109, v109, v113
v_add_f32 v117, v117, v121
v_add_f32 v110, v110, v114
v_add_f32 v118, v118, v122
v_add_f32 v111, v111, v115
v_add_f32 v119, v119, v123
v_add_f32 v108, v108, v116
v_add_f32 v109, v109, v117
v_add_f32 v110, v110, v118
v_add_f32 v111, v111, v119
s_mov_b64 exec, 0xffffffff
buffer_store_dwordx4 v[108:111], v30, s[84:87], s44 offen sc1
s_mov_b64 exec, -1
Lw_109:
s_waitcnt lgkmcnt(0)
s_add_u32 s37, s35, 3
s_and_b32 s37, s37, 15
s_mul_i32 s37, s37, 16384
s_add_u32 m0, s39, 49152
s_nop 0
buffer_load_dwordx4 v3, s[8:11], s37 offen sc1 lds
s_load_dword s3, s[4:5], 1792
s_load_dword s3, s[4:5], 1856
s_load_dword s3, s[4:5], 1920
s_load_dword s3, s[4:5], 1984
s_load_dword s3, s[4:5], 2048
s_load_dword s3, s[4:5], 2112
s_load_dword s3, s[4:5], 2176
buffer_load_dwordx4 v3, s[8:11], s37 offen offset:1024 sc1 lds
s_load_dword s3, s[4:5], 2240
s_load_dword s3, s[4:5], 2304
s_load_dword s3, s[4:5], 2368
s_load_dword s3, s[4:5], 2432
s_load_dword s3, s[4:5], 2496
s_load_dword s3, s[4:5], 2560
s_load_dword s3, s[4:5], 2624
buffer_load_dwordx4 v3, s[8:11], s37 offen offset:2048 sc1 lds
v_mul_f32 v66, v57, v57
v_mul_f32 v64, 0xc0135761, v57
v_mul_f32 v65, 0xbdd2d3e8, v57
v_mul_f32 v65, v65, v66
v_rcp_f32 v66, v66
v_mul_f32 v70, v59, v59
v_mul_f32 v68, 0xc0135761, v59
buffer_load_dwordx4 v3, s[8:11], s37 offen offset:3072 sc1 lds
v_mul_f32 v69, 0xbdd2d3e8, v59
v_mul_f32 v69, v69, v70
v_rcp_f32 v70, v70
v_fma_f32 v128, -v56, v32, v128
v_fma_f32 v129, -v56, v33, v129
v_fma_f32 v130, -v56, v34, v130
v_fma_f32 v131, -v56, v35, v131
v_fma_f32 v152, -v58, v32, v152
s_add_u32 s38, s35, 3
s_and_b32 s38, s38, 15
s_mul_i32 s38, s38, 458752
s_add_u32 m0, s40, 49152
s_nop 0
buffer_load_dwordx4 v4, s[12:15], s38 offen lds
v_fma_f32 v153, -v58, v33, v153
v_fma_f32 v154, -v58, v34, v154
v_fma_f32 v155, -v58, v35, v155
v_mul_f32 v72, v128, v128
v_mul_f32 v73, v129, v129
v_mul_f32 v74, v130, v130
v_mul_f32 v75, v131, v131
s_add_u32 m0, s40, 50176
s_nop 0
buffer_load_dwordx4 v5, s[12:15], s38 offen lds
v_mul_f32 v76, v152, v152
v_mul_f32 v77, v153, v153
v_mul_f32 v78, v154, v154
v_mul_f32 v79, v155, v155
v_fma_f32 v72, v72, v65, v64
v_fma_f32 v73, v73, v65, v64
v_fma_f32 v74, v74, v65, v64
s_add_u32 m0, s40, 51200
s_add_u32 s38, s38, 57344
buffer_load_dwordx4 v4, s[12:15], s38 offen lds
v_fma_f32 v75, v75, v65, v64
v_fma_f32 v76, v76, v69, v68
v_fma_f32 v77, v77, v69, v68
v_fma_f32 v78, v78, v69, v68
v_fma_f32 v79, v79, v69, v68
v_mul_f32 v72, v72, v128
v_mul_f32 v73, v73, v129
v_mul_f32 v74, v74, v130
s_add_u32 m0, s40, 52224
s_nop 0
buffer_load_dwordx4 v5, s[12:15], s38 offen lds
v_mul_f32 v75, v75, v131
v_mul_f32 v76, v76, v152
v_mul_f32 v77, v77, v153
v_mul_f32 v78, v78, v154
v_mul_f32 v79, v79, v155
v_exp_f32 v72, v72
v_exp_f32 v73, v73
s_add_u32 m0, s40, 53248
s_add_u32 s38, s38, 57344
buffer_load_dwordx4 v4, s[12:15], s38 offen lds
v_exp_f32 v74, v74
v_exp_f32 v75, v75
v_exp_f32 v76, v76
v_exp_f32 v77, v77
v_exp_f32 v78, v78
v_exp_f32 v79, v79
v_fma_f32 v140, -v56, v44, v140
s_add_u32 m0, s40, 54272
s_nop 0
buffer_load_dwordx4 v5, s[12:15], s38 offen lds
v_fma_f32 v141, -v56, v45, v141
v_fma_f32 v142, -v56, v46, v142
v_fma_f32 v143, -v56, v47, v143
v_fma_f32 v164, -v58, v44, v164
v_fma_f32 v165, -v58, v45, v165
v_fma_f32 v166, -v58, v46, v166
v_fma_f32 v167, -v58, v47, v167
v_fma_f32 v72, v72, v66, v66
s_add_u32 m0, s40, 55296
s_add_u32 s38, s38, 57344
buffer_load_dwordx4 v4, s[12:15], s38 offen lds
s_add_u32 m0, s40, 56320
s_nop 0
buffer_load_dwordx4 v5, s[12:15], s38 offen lds
s_waitcnt vmcnt(12)
s_barrier
s_add_u32 s37, s35, 4
s_and_b32 s37, s37, 15
s_mul_i32 s37, s37, 16384
s_add_u32 m0, s39, 98304
s_nop 0
buffer_load_dwordx4 v3, s[8:11], s37 offen sc1 lds
v_fma_f32 v73, v73, v66, v66
v_fma_f32 v74, v74, v66, v66
v_fma_f32 v75, v75, v66, v66
v_fma_f32 v76, v76, v70, v70
v_fma_f32 v77, v77, v70, v70
v_fma_f32 v78, v78, v70, v70
buffer_load_dwordx4 v3, s[8:11], s37 offen offset:1024 sc1 lds
v_fma_f32 v79, v79, v70, v70
v_rcp_f32 v72, v72
v_rcp_f32 v73, v73
v_rcp_f32 v74, v74
v_rcp_f32 v75, v75
v_rcp_f32 v76, v76
buffer_load_dwordx4 v3, s[8:11], s37 offen offset:2048 sc1 lds
v_rcp_f32 v77, v77
v_rcp_f32 v78, v78
v_rcp_f32 v79, v79
v_mul_f32 v140, v128, v140
v_mul_f32 v141, v129, v141
v_mul_f32 v142, v130, v142
buffer_load_dwordx4 v3, s[8:11], s37 offen offset:3072 sc1 lds
v_mul_f32 v143, v131, v143
v_mul_f32 v164, v152, v164
v_mul_f32 v165, v153, v165
v_mul_f32 v166, v154, v166
v_mul_f32 v167, v155, v167
v_mul_f32 v140, v140, v72
s_add_u32 s38, s35, 4
s_and_b32 s38, s38, 15
s_mul_i32 s38, s38, 458752
s_add_u32 m0, s40, 98304
s_nop 0
buffer_load_dwordx4 v4, s[12:15], s38 offen lds
v_mul_f32 v141, v141, v73
v_mul_f32 v142, v142, v74
v_mul_f32 v143, v143, v75
v_mul_f32 v164, v164, v76
v_mul_f32 v165, v165, v77
v_mul_f32 v166, v166, v78
s_add_u32 m0, s40, 99328
s_nop 0
buffer_load_dwordx4 v5, s[12:15], s38 offen lds
v_mul_f32 v167, v167, v79
v_cvt_pk_bf16_f32 v128, v140, v141
v_cvt_pk_bf16_f32 v129, v142, v143
v_cvt_pk_bf16_f32 v152, v164, v165
v_cvt_pk_bf16_f32 v153, v166, v167
v_fma_f32 v132, -v56, v36, v132
s_add_u32 m0, s40, 100352
s_add_u32 s38, s38, 57344
buffer_load_dwordx4 v4, s[12:15], s38 offen lds
v_fma_f32 v133, -v56, v37, v133
v_fma_f32 v134, -v56, v38, v134
v_fma_f32 v135, -v56, v39, v135
v_fma_f32 v156, -v58, v36, v156
v_fma_f32 v157, -v58, v37, v157
v_fma_f32 v158, -v58, v38, v158
s_add_u32 m0, s40, 101376
s_nop 0
buffer_load_dwordx4 v5, s[12:15], s38 offen lds
v_fma_f32 v159, -v58, v39, v159
v_mul_f32 v72, v132, v132
v_mul_f32 v73, v133, v133
v_mul_f32 v74, v134, v134
v_mul_f32 v75, v135, v135
v_mul_f32 v76, v156, v156
s_add_u32 m0, s40, 102400
s_add_u32 s38, s38, 57344
buffer_load_dwordx4 v4, s[12:15], s38 offen lds
v_mul_f32 v77, v157, v157
v_mul_f32 v78, v158, v158
v_mul_f32 v79, v159, v159
v_fma_f32 v72, v72, v65, v64
v_fma_f32 v73, v73, v65, v64
v_fma_f32 v74, v74, v65, v64
s_add_u32 m0, s40, 103424
s_nop 0
buffer_load_dwordx4 v5, s[12:15], s38 offen lds
v_fma_f32 v75, v75, v65, v64
v_fma_f32 v76, v76, v69, v68
v_fma_f32 v77, v77, v69, v68
v_fma_f32 v78, v78, v69, v68
v_fma_f32 v79, v79, v69, v68
v_mul_f32 v72, v72, v132
s_add_u32 m0, s40, 104448
s_add_u32 s38, s38, 57344
buffer_load_dwordx4 v4, s[12:15], s38 offen lds
s_add_u32 m0, s40, 105472
s_nop 0
buffer_load_dwordx4 v5, s[12:15], s38 offen lds
s_waitcnt vmcnt(12)
s_barrier
s_cmp_eq_u32 s47, 3
s_cbranch_scc0 Lw_110
s_lshr_b32 s43, s2, 4
s_add_u32 s43, s43, 80
s_lshl_b32 s43, s43, 7
v_mov_b32 v30, s43
v_mov_b32 v31, 1
s_mov_b64 exec, 1
buffer_atomic_add v31, v30, s[56:59], 0 offen sc1
s_mov_b64 exec, -1
Lw_110:
s_waitcnt lgkmcnt(0)
s_add_u32 s37, s35, 5
s_and_b32 s37, s37, 15
s_mul_i32 s37, s37, 16384
s_add_u32 m0, s39, 0
s_nop 0
buffer_load_dwordx4 v3, s[8:11], s37 offen sc1 lds
s_load_dword s3, s[4:5], 2688
s_load_dword s3, s[4:5], 2752
s_load_dword s3, s[4:5], 2816
s_load_dword s3, s[4:5], 2880
s_load_dword s3, s[4:5], 2944
s_load_dword s3, s[4:5], 3008
s_load_dword s3, s[4:5], 3072
buffer_load_dwordx4 v3, s[8:11], s37 offen offset:1024 sc1 lds
s_load_dword s3, s[4:5], 3136
s_load_dword s3, s[4:5], 3200
s_load_dword s3, s[4:5], 3264
s_load_dword s3, s[4:5], 3328
s_load_dword s3, s[4:5], 3392
s_load_dword s3, s[4:5], 3456
s_load_dword s3, s[4:5], 3520
buffer_load_dwordx4 v3, s[8:11], s37 offen offset:2048 sc1 lds
v_mul_f32 v73, v73, v133
v_mul_f32 v74, v74, v134
v_mul_f32 v75, v75, v135
v_mul_f32 v76, v76, v156
v_mul_f32 v77, v77, v157
v_mul_f32 v78, v78, v158
v_mul_f32 v79, v79, v159
v_exp_f32 v72, v72
buffer_load_dwordx4 v3, s[8:11], s37 offen offset:3072 sc1 lds
v_exp_f32 v73, v73
v_exp_f32 v74, v74
v_exp_f32 v75, v75
v_exp_f32 v76, v76
v_exp_f32 v77, v77
v_exp_f32 v78, v78
v_exp_f32 v79, v79
s_add_u32 s38, s35, 5
s_and_b32 s38, s38, 15
s_mul_i32 s38, s38, 458752
s_add_u32 m0, s40, 0
s_nop 0
buffer_load_dwordx4 v4, s[12:15], s38 offen lds
v_fma_f32 v144, -v56, v48, v144
v_fma_f32 v145, -v56, v49, v145
v_fma_f32 v146, -v56, v50, v146
v_fma_f32 v147, -v56, v51, v147
v_fma_f32 v168, -v58, v48, v168
v_fma_f32 v169, -v58, v49, v169
v_fma_f32 v170, -v58, v50, v170
v_fma_f32 v171, -v58, v51, v171
s_add_u32 m0, s40, 1024
s_nop 0
buffer_load_dwordx4 v5, s[12:15], s38 offen lds
v_fma_f32 v72, v72, v66, v66
v_fma_f32 v73, v73, v66, v66
v_fma_f32 v74, v74, v66, v66
v_fma_f32 v75, v75, v66, v66
v_fma_f32 v76, v76, v70, v70
v_fma_f32 v77, v77, v70, v70
v_fma_f32 v78, v78, v70, v70
s_add_u32 m0, s40, 2048
s_add_u32 s38, s38, 57344
buffer_load_dwordx4 v4, s[12:15], s38 offen lds
v_fma_f32 v79, v79, v70, v70
v_rcp_f32 v72, v72
v_rcp_f32 v73, v73
v_rcp_f32 v74, v74
v_rcp_f32 v75, v75
v_rcp_f32 v76, v76
v_rcp_f32 v77, v77
s_add_u32 m0, s40, 3072
s_nop 0
buffer_load_dwordx4 v5, s[12:15], s38 offen lds
v_rcp_f32 v78, v78
v_rcp_f32 v79, v79
v_mul_f32 v144, v132, v144
v_mul_f32 v145, v133, v145
v_mul_f32 v146, v134, v146
v_mul_f32 v147, v135, v147
v_mul_f32 v168, v156, v168
v_mul_f32 v169, v157, v169
s_add_u32 m0, s40, 4096
s_add_u32 s38, s38, 57344
buffer_load_dwordx4 v4, s[12:15], s38 offen lds
v_mul_f32 v170, v158, v170
v_mul_f32 v171, v159, v171
v_mul_f32 v144, v144, v72
v_mul_f32 v145, v145, v73
v_mul_f32 v146, v146, v74
v_mul_f32 v147, v147, v75
v_mul_f32 v168, v168, v76
s_add_u32 m0, s40, 5120
s_nop 0
buffer_load_dwordx4 v5, s[12:15], s38 offen lds
v_mul_f32 v169, v169, v77
v_mul_f32 v170, v170, v78
v_mul_f32 v171, v171, v79
v_cvt_pk_bf16_f32 v130, v144, v145
v_cvt_pk_bf16_f32 v131, v146, v147
v_cvt_pk_bf16_f32 v154, v168, v169
v_cvt_pk_bf16_f32 v155, v170, v171
buffer_store_dwordx4 v[128:131], v2, s[24:27], s54 offen offset:0 sc1
s_add_u32 m0, s40, 6144
s_add_u32 s38, s38, 57344
buffer_load_dwordx4 v4, s[12:15], s38 offen lds
s_add_u32 m0, s40, 7168
s_nop 0
buffer_load_dwordx4 v5, s[12:15], s38 offen lds
s_waitcnt vmcnt(13)
s_barrier
s_add_u32 s37, s35, 6
s_and_b32 s37, s37, 15
s_mul_i32 s37, s37, 16384
s_add_u32 m0, s39, 49152
s_nop 0
buffer_load_dwordx4 v3, s[8:11], s37 offen sc1 lds
buffer_store_dwordx4 v[152:155], v2, s[24:27], s54 offen offset:1024 sc1
v_fma_f32 v136, -v56, v40, v136
v_fma_f32 v137, -v56, v41, v137
v_fma_f32 v138, -v56, v42, v138
v_fma_f32 v139, -v56, v43, v139
v_fma_f32 v160, -v58, v40, v160
buffer_load_dwordx4 v3, s[8:11], s37 offen offset:1024 sc1 lds
v_fma_f32 v161, -v58, v41, v161
v_fma_f32 v162, -v58, v42, v162
v_fma_f32 v163, -v58, v43, v163
v_mul_f32 v72, v136, v136
v_mul_f32 v73, v137, v137
v_mul_f32 v74, v138, v138
buffer_load_dwordx4 v3, s[8:11], s37 offen offset:2048 sc1 lds
v_mul_f32 v75, v139, v139
v_mul_f32 v76, v160, v160
v_mul_f32 v77, v161, v161
v_mul_f32 v78, v162, v162
v_mul_f32 v79, v163, v163
v_fma_f32 v72, v72, v65, v64
buffer_load_dwordx4 v3, s[8:11], s37 offen offset:3072 sc1 lds
v_fma_f32 v73, v73, v65, v64
v_fma_f32 v74, v74, v65, v64
v_fma_f32 v75, v75, v65, v64
v_fma_f32 v76, v76, v69, v68
v_fma_f32 v77, v77, v69, v68
v_fma_f32 v78, v78, v69, v68
s_add_u32 s38, s35, 6
s_and_b32 s38, s38, 15
s_mul_i32 s38, s38, 458752
s_add_u32 m0, s40, 49152
s_nop 0
buffer_load_dwordx4 v4, s[12:15], s38 offen lds
v_fma_f32 v79, v79, v69, v68
v_mul_f32 v72, v72, v136
v_mul_f32 v73, v73, v137
v_mul_f32 v74, v74, v138
v_mul_f32 v75, v75, v139
v_mul_f32 v76, v76, v160
s_add_u32 m0, s40, 50176
s_nop 0
buffer_load_dwordx4 v5, s[12:15], s38 offen lds
v_mul_f32 v77, v77, v161
v_mul_f32 v78, v78, v162
v_mul_f32 v79, v79, v163
v_exp_f32 v72, v72
v_exp_f32 v73, v73
v_exp_f32 v74, v74
s_add_u32 m0, s40, 51200
s_add_u32 s38, s38, 57344
buffer_load_dwordx4 v4, s[12:15], s38 offen lds
v_exp_f32 v75, v75
v_exp_f32 v76, v76
v_exp_f32 v77, v77
v_exp_f32 v78, v78
v_exp_f32 v79, v79
s_branch Lov_9
.p2align 12
.fill 64, 4, 0xbf800000
Lst_9_0:
s_branch Lwr_155
Lst_9_1:
s_branch Lwr_166
s_nop 0
Lov_9:
v_fma_f32 v148, -v56, v52, v148
s_add_u32 m0, s40, 52224
s_nop 0
buffer_load_dwordx4 v5, s[12:15], s38 offen lds
v_fma_f32 v149, -v56, v53, v149
v_fma_f32 v150, -v56, v54, v150
v_fma_f32 v151, -v56, v55, v151
v_fma_f32 v172, -v58, v52, v172
v_fma_f32 v173, -v58, v53, v173
v_fma_f32 v174, -v58, v54, v174
s_add_u32 m0, s40, 53248
s_add_u32 s38, s38, 57344
buffer_load_dwordx4 v4, s[12:15], s38 offen lds
v_fma_f32 v175, -v58, v55, v175
v_fma_f32 v72, v72, v66, v66
v_fma_f32 v73, v73, v66, v66
v_fma_f32 v74, v74, v66, v66
v_fma_f32 v75, v75, v66, v66
v_fma_f32 v76, v76, v70, v70
s_add_u32 m0, s40, 54272
s_nop 0
buffer_load_dwordx4 v5, s[12:15], s38 offen lds
v_fma_f32 v77, v77, v70, v70
v_fma_f32 v78, v78, v70, v70
v_fma_f32 v79, v79, v70, v70
v_rcp_f32 v72, v72
v_rcp_f32 v73, v73
v_rcp_f32 v74, v74
s_add_u32 m0, s40, 55296
s_add_u32 s38, s38, 57344
buffer_load_dwordx4 v4, s[12:15], s38 offen lds
s_add_u32 m0, s40, 56320
s_nop 0
buffer_load_dwordx4 v5, s[12:15], s38 offen lds
s_waitcnt vmcnt(13)
s_barrier
s_waitcnt lgkmcnt(0)
s_add_u32 s37, s35, 7
s_and_b32 s37, s37, 15
s_mul_i32 s37, s37, 16384
s_add_u32 m0, s39, 98304
s_nop 0
buffer_load_dwordx4 v3, s[8:11], s37 offen sc1 lds
s_load_dword s3, s[4:5], 3584
s_load_dword s3, s[4:5], 3648
s_load_dword s3, s[4:5], 3712
s_load_dword s3, s[4:5], 3776
s_load_dword s3, s[4:5], 3840
s_load_dword s3, s[4:5], 3904
s_load_dword s3, s[4:5], 3968
buffer_load_dwordx4 v3, s[8:11], s37 offen offset:1024 sc1 lds
s_load_dword s3, s[4:5], 4032
s_load_dword s3, s[4:5], 4096
s_load_dword s3, s[4:5], 4160
s_load_dword s3, s[4:5], 4224
s_load_dword s3, s[4:5], 4288
s_load_dword s3, s[4:5], 4352
s_load_dword s3, s[4:5], 4416
buffer_load_dwordx4 v3, s[8:11], s37 offen offset:2048 sc1 lds
v_rcp_f32 v75, v75
v_rcp_f32 v76, v76
v_rcp_f32 v77, v77
v_rcp_f32 v78, v78
v_rcp_f32 v79, v79
v_mul_f32 v148, v136, v148
v_mul_f32 v149, v137, v149
buffer_load_dwordx4 v3, s[8:11], s37 offen offset:3072 sc1 lds
v_mul_f32 v150, v138, v150
v_mul_f32 v151, v139, v151
v_mul_f32 v172, v160, v172
v_mul_f32 v173, v161, v173
v_mul_f32 v174, v162, v174
v_mul_f32 v175, v163, v175
v_mul_f32 v148, v148, v72
v_mul_f32 v149, v149, v73
s_add_u32 s38, s35, 7
s_and_b32 s38, s38, 15
s_mul_i32 s38, s38, 458752
s_add_u32 m0, s40, 98304
s_nop 0
buffer_load_dwordx4 v4, s[12:15], s38 offen lds
v_mul_f32 v150, v150, v74
v_mul_f32 v151, v151, v75
v_mul_f32 v172, v172, v76
v_mul_f32 v173, v173, v77
v_mul_f32 v174, v174, v78
v_mul_f32 v175, v175, v79
v_cvt_pk_bf16_f32 v80, v148, v149
s_add_u32 m0, s40, 99328
s_nop 0
buffer_load_dwordx4 v5, s[12:15], s38 offen lds
v_cvt_pk_bf16_f32 v81, v150, v151
v_cvt_pk_bf16_f32 v82, v172, v173
v_cvt_pk_bf16_f32 v83, v174, v175
s_nop 1
v_permlane32_swap_b32 v80, v82
v_permlane32_swap_b32 v81, v83
buffer_store_dwordx4 v[80:83], v84, s[24:27], s55 offen offset:0 sc1
s_add_u32 m0, s40, 100352
s_add_u32 s38, s38, 57344
buffer_load_dwordx4 v4, s[12:15], s38 offen lds
s_nop 1
v_mul_f32 v66, v61, v61
v_mul_f32 v64, 0xc0135761, v61
v_mul_f32 v65, 0xbdd2d3e8, v61
v_mul_f32 v65, v65, v66
v_rcp_f32 v66, v66
v_mul_f32 v70, v63, v63
v_mul_f32 v68, 0xc0135761, v63
s_add_u32 m0, s40, 101376
s_nop 0
buffer_load_dwordx4 v5, s[12:15], s38 offen lds
v_mul_f32 v69, 0xbdd2d3e8, v63
v_mul_f32 v69, v69, v70
v_rcp_f32 v70, v70
v_fma_f32 v176, -v60, v32, v176
v_fma_f32 v177, -v60, v33, v177
v_fma_f32 v178, -v60, v34, v178
v_fma_f32 v179, -v60, v35, v179
s_add_u32 m0, s40, 102400
s_add_u32 s38, s38, 57344
buffer_load_dwordx4 v4, s[12:15], s38 offen lds
v_fma_f32 v200, -v62, v32, v200
v_fma_f32 v201, -v62, v33, v201
v_fma_f32 v202, -v62, v34, v202
v_fma_f32 v203, -v62, v35, v203
v_mul_f32 v72, v176, v176
v_mul_f32 v73, v177, v177
v_mul_f32 v74, v178, v178
s_add_u32 m0, s40, 103424
s_nop 0
buffer_load_dwordx4 v5, s[12:15], s38 offen lds
v_mul_f32 v75, v179, v179
v_mul_f32 v76, v200, v200
v_mul_f32 v77, v201, v201
v_mul_f32 v78, v202, v202
v_mul_f32 v79, v203, v203
v_fma_f32 v72, v72, v65, v64
v_fma_f32 v73, v73, v65, v64
v_fma_f32 v74, v74, v65, v64
s_add_u32 m0, s40, 104448
s_add_u32 s38, s38, 57344
buffer_load_dwordx4 v4, s[12:15], s38 offen lds
s_add_u32 m0, s40, 105472
s_nop 0
buffer_load_dwordx4 v5, s[12:15], s38 offen lds
s_waitcnt vmcnt(13)
s_barrier
s_add_u32 s37, s35, 8
s_and_b32 s37, s37, 15
s_mul_i32 s37, s37, 16384
s_add_u32 m0, s39, 0
s_nop 0
buffer_load_dwordx4 v3, s[8:11], s37 offen sc1 lds
v_fma_f32 v75, v75, v65, v64
v_fma_f32 v76, v76, v69, v68
v_fma_f32 v77, v77, v69, v68
v_fma_f32 v78, v78, v69, v68
v_fma_f32 v79, v79, v69, v68
v_mul_f32 v72, v72, v176
buffer_load_dwordx4 v3, s[8:11], s37 offen offset:1024 sc1 lds
v_mul_f32 v73, v73, v177
v_mul_f32 v74, v74, v178
v_mul_f32 v75, v75, v179
v_mul_f32 v76, v76, v200
v_mul_f32 v77, v77, v201
v_mul_f32 v78, v78, v202
buffer_load_dwordx4 v3, s[8:11], s37 offen offset:2048 sc1 lds
v_mul_f32 v79, v79, v203
v_exp_f32 v72, v72
v_exp_f32 v73, v73
v_exp_f32 v74, v74
v_exp_f32 v75, v75
v_exp_f32 v76, v76
buffer_load_dwordx4 v3, s[8:11], s37 offen offset:3072 sc1 lds
v_exp_f32 v77, v77
v_exp_f32 v78, v78
v_exp_f32 v79, v79
v_fma_f32 v188, -v60, v44, v188
v_fma_f32 v189, -v60, v45, v189
v_fma_f32 v190, -v60, v46, v190
s_add_u32 s38, s35, 8
s_and_b32 s38, s38, 15
s_mul_i32 s38, s38, 458752
s_add_u32 m0, s40, 0
s_nop 0
buffer_load_dwordx4 v4, s[12:15], s38 offen lds
v_fma_f32 v191, -v60, v47, v191
v_fma_f32 v212, -v62, v44, v212
v_fma_f32 v213, -v62, v45, v213
v_fma_f32 v214, -v62, v46, v214
v_fma_f32 v215, -v62, v47, v215
v_fma_f32 v72, v72, v66, v66
s_add_u32 m0, s40, 1024
s_nop 0
buffer_load_dwordx4 v5, s[12:15], s38 offen lds
v_fma_f32 v73, v73, v66, v66
v_fma_f32 v74, v74, v66, v66
v_fma_f32 v75, v75, v66, v66
v_fma_f32 v76, v76, v70, v70
v_fma_f32 v77, v77, v70, v70
v_fma_f32 v78, v78, v70, v70
s_add_u32 m0, s40, 2048
s_add_u32 s38, s38, 57344
buffer_load_dwordx4 v4, s[12:15], s38 offen lds
v_fma_f32 v79, v79, v70, v70
v_rcp_f32 v72, v72
v_rcp_f32 v73, v73
v_rcp_f32 v74, v74
v_rcp_f32 v75, v75
v_rcp_f32 v76, v76
s_add_u32 m0, s40, 3072
s_nop 0
buffer_load_dwordx4 v5, s[12:15], s38 offen lds
v_rcp_f32 v77, v77
v_rcp_f32 v78, v78
v_rcp_f32 v79, v79
v_mul_f32 v188, v176, v188
v_mul_f32 v189, v177, v189
v_mul_f32 v190, v178, v190
s_add_u32 m0, s40, 4096
s_add_u32 s38, s38, 57344
buffer_load_dwordx4 v4, s[12:15], s38 offen lds
v_mul_f32 v191, v179, v191
v_mul_f32 v212, v200, v212
v_mul_f32 v213, v201, v213
v_mul_f32 v214, v202, v214
v_mul_f32 v215, v203, v215
v_mul_f32 v188, v188, v72
s_add_u32 m0, s40, 5120
s_nop 0
buffer_load_dwordx4 v5, s[12:15], s38 offen lds
v_mul_f32 v189, v189, v73
v_mul_f32 v190, v190, v74
v_mul_f32 v191, v191, v75
v_mul_f32 v212, v212, v76
v_mul_f32 v213, v213, v77
v_mul_f32 v214, v214, v78
s_add_u32 m0, s40, 6144
s_add_u32 s38, s38, 57344
buffer_load_dwordx4 v4, s[12:15], s38 offen lds
s_add_u32 m0, s40, 7168
s_nop 0
buffer_load_dwordx4 v5, s[12:15], s38 offen lds
s_waitcnt vmcnt(12)
s_barrier
s_waitcnt lgkmcnt(0)
s_cmp_eq_u32 s47, 3
s_cbranch_scc0 Lw_111
s_lshl_b32 s92, s35, 7
s_add_u32 s92, s92, 28321792
s_load_dword s93, s[82:83], s92 glc
Lw_111:
s_add_u32 s37, s35, 9
s_and_b32 s37, s37, 15
s_mul_i32 s37, s37, 16384
s_add_u32 m0, s39, 49152
s_nop 0
buffer_load_dwordx4 v3, s[8:11], s37 offen sc1 lds
s_load_dword s3, s[4:5], 4480
s_load_dword s3, s[4:5], 4544
s_load_dword s3, s[4:5], 4608
s_load_dword s3, s[4:5], 4672
s_load_dword s3, s[4:5], 4736
s_load_dword s3, s[4:5], 4800
s_load_dword s3, s[4:5], 4864
buffer_load_dwordx4 v3, s[8:11], s37 offen offset:1024 sc1 lds
s_load_dword s3, s[4:5], 4928
s_load_dword s3, s[4:5], 4992
s_load_dword s3, s[4:5], 5056
s_load_dword s3, s[4:5], 5120
s_load_dword s3, s[4:5], 5184
s_load_dword s3, s[4:5], 5248
s_load_dword s3, s[4:5], 5312
buffer_load_dwordx4 v3, s[8:11], s37 offen offset:2048 sc1 lds
v_mul_f32 v215, v215, v79
v_cvt_pk_bf16_f32 v176, v188, v189
v_cvt_pk_bf16_f32 v177, v190, v191
v_cvt_pk_bf16_f32 v200, v212, v213
v_cvt_pk_bf16_f32 v201, v214, v215
v_fma_f32 v180, -v60, v36, v180
v_fma_f32 v181, -v60, v37, v181
v_fma_f32 v182, -v60, v38, v182
buffer_load_dwordx4 v3, s[8:11], s37 offen offset:3072 sc1 lds
v_fma_f32 v183, -v60, v39, v183
v_fma_f32 v204, -v62, v36, v204
v_fma_f32 v205, -v62, v37, v205
v_fma_f32 v206, -v62, v38, v206
v_fma_f32 v207, -v62, v39, v207
v_mul_f32 v72, v180, v180
v_mul_f32 v73, v181, v181
s_add_u32 s38, s35, 9
s_and_b32 s38, s38, 15
s_mul_i32 s38, s38, 458752
s_add_u32 m0, s40, 49152
s_nop 0
buffer_load_dwordx4 v4, s[12:15], s38 offen lds
v_mul_f32 v74, v182, v182
v_mul_f32 v75, v183, v183
v_mul_f32 v76, v204, v204
v_mul_f32 v77, v205, v205
v_mul_f32 v78, v206, v206
v_mul_f32 v79, v207, v207
v_fma_f32 v72, v72, v65, v64
v_fma_f32 v73, v73, v65, v64
s_add_u32 m0, s40, 50176
s_nop 0
buffer_load_dwordx4 v5, s[12:15], s38 offen lds
v_fma_f32 v74, v74, v65, v64
v_fma_f32 v75, v75, v65, v64
v_fma_f32 v76, v76, v69, v68
v_fma_f32 v77, v77, v69, v68
v_fma_f32 v78, v78, v69, v68
v_fma_f32 v79, v79, v69, v68
v_mul_f32 v72, v72, v180
s_add_u32 m0, s40, 51200
s_add_u32 s38, s38, 57344
buffer_load_dwordx4 v4, s[12:15], s38 offen lds
v_mul_f32 v73, v73, v181
v_mul_f32 v74, v74, v182
v_mul_f32 v75, v75, v183
v_mul_f32 v76, v76, v204
v_mul_f32 v77, v77, v205
v_mul_f32 v78, v78, v206
v_mul_f32 v79, v79, v207
s_add_u32 m0, s40, 52224
s_nop 0
buffer_load_dwordx4 v5, s[12:15], s38 offen lds
v_exp_f32 v72, v72
v_exp_f32 v73, v73
v_exp_f32 v74, v74
v_exp_f32 v75, v75
v_exp_f32 v76, v76
v_exp_f32 v77, v77
v_exp_f32 v78, v78
v_exp_f32 v79, v79
s_add_u32 m0, s40, 53248
s_add_u32 s38, s38, 57344
buffer_load_dwordx4 v4, s[12:15], s38 offen lds
v_fma_f32 v192, -v60, v48, v192
v_fma_f32 v193, -v60, v49, v193
v_fma_f32 v194, -v60, v50, v194
v_fma_f32 v195, -v60, v51, v195
v_fma_f32 v216, -v62, v48, v216
v_fma_f32 v217, -v62, v49, v217
v_fma_f32 v218, -v62, v50, v218
s_add_u32 m0, s40, 54272
s_nop 0
buffer_load_dwordx4 v5, s[12:15], s38 offen lds
v_fma_f32 v219, -v62, v51, v219
v_fma_f32 v72, v72, v66, v66
v_fma_f32 v73, v73, v66, v66
v_fma_f32 v74, v74, v66, v66
v_fma_f32 v75, v75, v66, v66
v_fma_f32 v76, v76, v70, v70
v_fma_f32 v77, v77, v70, v70
v_fma_f32 v78, v78, v70, v70
s_add_u32 m0, s40, 55296
s_add_u32 s38, s38, 57344
buffer_load_dwordx4 v4, s[12:15], s38 offen lds
s_add_u32 m0, s40, 56320
s_nop 0
buffer_load_dwordx4 v5, s[12:15], s38 offen lds
s_waitcnt vmcnt(12)
s_barrier
s_add_u32 s37, s35, 10
s_and_b32 s37, s37, 15
s_mul_i32 s37, s37, 16384
s_add_u32 m0, s39, 98304
s_nop 0
buffer_load_dwordx4 v3, s[8:11], s37 offen sc1 lds
v_fma_f32 v79, v79, v70, v70
v_rcp_f32 v72, v72
v_rcp_f32 v73, v73
v_rcp_f32 v74, v74
v_rcp_f32 v75, v75
v_rcp_f32 v76, v76
buffer_load_dwordx4 v3, s[8:11], s37 offen offset:1024 sc1 lds
v_rcp_f32 v77, v77
v_rcp_f32 v78, v78
v_rcp_f32 v79, v79
v_mul_f32 v192, v180, v192
v_mul_f32 v193, v181, v193
v_mul_f32 v194, v182, v194
buffer_load_dwordx4 v3, s[8:11], s37 offen offset:2048 sc1 lds
v_mul_f32 v195, v183, v195
v_mul_f32 v216, v204, v216
v_mul_f32 v217, v205, v217
v_mul_f32 v218, v206, v218
v_mul_f32 v219, v207, v219
v_mul_f32 v192, v192, v72
buffer_load_dwordx4 v3, s[8:11], s37 offen offset:3072 sc1 lds
v_mul_f32 v193, v193, v73
v_mul_f32 v194, v194, v74
v_mul_f32 v195, v195, v75
v_mul_f32 v216, v216, v76
v_mul_f32 v217, v217, v77
v_mul_f32 v218, v218, v78
s_add_u32 s38, s35, 10
s_and_b32 s38, s38, 15
s_mul_i32 s38, s38, 458752
s_add_u32 m0, s40, 98304
s_nop 0
buffer_load_dwordx4 v4, s[12:15], s38 offen lds
v_mul_f32 v219, v219, v79
v_cvt_pk_bf16_f32 v178, v192, v193
v_cvt_pk_bf16_f32 v179, v194, v195
v_cvt_pk_bf16_f32 v202, v216, v217
v_cvt_pk_bf16_f32 v203, v218, v219
buffer_store_dwordx4 v[176:179], v2, s[24:27], s54 offen offset:2048 sc1
s_add_u32 m0, s40, 99328
s_nop 0
buffer_load_dwordx4 v5, s[12:15], s38 offen lds
buffer_store_dwordx4 v[200:203], v2, s[24:27], s54 offen offset:3072 sc1
v_fma_f32 v184, -v60, v40, v184
v_fma_f32 v185, -v60, v41, v185
v_fma_f32 v186, -v60, v42, v186
v_fma_f32 v187, -v60, v43, v187
v_fma_f32 v208, -v62, v40, v208
s_add_u32 m0, s40, 100352
s_add_u32 s38, s38, 57344
buffer_load_dwordx4 v4, s[12:15], s38 offen lds
v_fma_f32 v209, -v62, v41, v209
v_fma_f32 v210, -v62, v42, v210
v_fma_f32 v211, -v62, v43, v211
v_mul_f32 v72, v184, v184
v_mul_f32 v73, v185, v185
v_mul_f32 v74, v186, v186
s_add_u32 m0, s40, 101376
s_nop 0
buffer_load_dwordx4 v5, s[12:15], s38 offen lds
v_mul_f32 v75, v187, v187
v_mul_f32 v76, v208, v208
v_mul_f32 v77, v209, v209
v_mul_f32 v78, v210, v210
v_mul_f32 v79, v211, v211
v_fma_f32 v72, v72, v65, v64
s_add_u32 m0, s40, 102400
s_add_u32 s38, s38, 57344
buffer_load_dwordx4 v4, s[12:15], s38 offen lds
v_fma_f32 v73, v73, v65, v64
v_fma_f32 v74, v74, v65, v64
v_fma_f32 v75, v75, v65, v64
v_fma_f32 v76, v76, v69, v68
v_fma_f32 v77, v77, v69, v68
v_fma_f32 v78, v78, v69, v68
s_add_u32 m0, s40, 103424
s_nop 0
buffer_load_dwordx4 v5, s[12:15], s38 offen lds
v_fma_f32 v79, v79, v69, v68
v_mul_f32 v72, v72, v184
v_mul_f32 v73, v73, v185
v_mul_f32 v74, v74, v186
v_mul_f32 v75, v75, v187
v_mul_f32 v76, v76, v208
s_add_u32 m0, s40, 104448
s_add_u32 s38, s38, 57344
buffer_load_dwordx4 v4, s[12:15], s38 offen lds
s_add_u32 m0, s40, 105472
s_nop 0
buffer_load_dwordx4 v5, s[12:15], s38 offen lds
s_waitcnt vmcnt(14)
s_cmp_eq_u32 s47, 3
s_cbranch_scc0 Lw_112
s_mov_b32 s41, 0x40000
s_branch Lpchk_115
Lpoll_113:
s_load_dword s93, s[82:83], s92 glc
Lpchk_115:
s_waitcnt lgkmcnt(0)
s_cmp_eq_u32 s93, 16
s_cbranch_scc1 Lpok_114
s_sub_u32 s41, s41, 1
s_cmp_lg_u32 s41, 0
s_cbranch_scc1 Lpoll_113
Lpok_114:
Lw_112:
s_barrier
s_lshl_b32 s60, s35, 9
s_lshl_b32 s43, s47, 7
s_add_u32 s60, s60, s43
s_add_u32 s61, s60, 14336
s_add_u32 s52, s43, 148480
s_add_u32 s53, s52, 896
v_lshrrev_b32 v104, 3, v1
v_mul_u32_u24 v104, 28672, v104
v_and_b32 v105, 7, v1
v_lshl_add_u32 v104, v105, 4, v104
s_waitcnt lgkmcnt(0)
buffer_load_dwordx4 v[96:99], v104, s[84:87], s60 offen sc1
s_load_dword s3, s[4:5], 5376
s_load_dword s3, s[4:5], 5440
s_load_dword s3, s[4:5], 5504
s_load_dword s3, s[4:5], 5568
s_load_dword s3, s[4:5], 5632
s_load_dword s3, s[4:5], 5696
buffer_load_dwordx4 v[100:103], v104, s[84:87], s61 offen sc1
s_load_dword s3, s[4:5], 5760
s_load_dword s3, s[4:5], 5824
s_load_dword s3, s[4:5], 5888
s_load_dword s3, s[4:5], 5952
s_load_dword s3, s[4:5], 6016
s_load_dword s3, s[4:5], 6080
s_load_dword s3, s[4:5], 6144
s_add_u32 s37, s35, 11
s_and_b32 s37, s37, 15
s_mul_i32 s37, s37, 16384
s_add_u32 m0, s39, 0
s_nop 0
buffer_load_dwordx4 v3, s[8:11], s37 offen sc1 lds
s_load_dword s3, s[4:5], 6208
v_mul_f32 v77, v77, v209
v_mul_f32 v78, v78, v210
v_mul_f32 v79, v79, v211
v_exp_f32 v72, v72
v_exp_f32 v73, v73
v_exp_f32 v74, v74
buffer_load_dwordx4 v3, s[8:11], s37 offen offset:1024 sc1 lds
v_exp_f32 v75, v75
v_exp_f32 v76, v76
v_exp_f32 v77, v77
v_exp_f32 v78, v78
v_exp_f32 v79, v79
v_fma_f32 v196, -v60, v52, v196
v_fma_f32 v197, -v60, v53, v197
buffer_load_dwordx4 v3, s[8:11], s37 offen offset:2048 sc1 lds
v_fma_f32 v198, -v60, v54, v198
v_fma_f32 v199, -v60, v55, v199
v_fma_f32 v220, -v62, v52, v220
v_fma_f32 v221, -v62, v53, v221
v_fma_f32 v222, -v62, v54, v222
v_fma_f32 v223, -v62, v55, v223
buffer_load_dwordx4 v3, s[8:11], s37 offen offset:3072 sc1 lds
v_fma_f32 v72, v72, v66, v66
v_fma_f32 v73, v73, v66, v66
v_fma_f32 v74, v74, v66, v66
v_fma_f32 v75, v75, v66, v66
v_fma_f32 v76, v76, v70, v70
v_fma_f32 v77, v77, v70, v70
v_fma_f32 v78, v78, v70, v70
s_add_u32 s38, s35, 11
s_and_b32 s38, s38, 15
s_mul_i32 s38, s38, 458752
s_add_u32 m0, s40, 0
s_nop 0
buffer_load_dwordx4 v4, s[12:15], s38 offen lds
v_fma_f32 v79, v79, v70, v70
v_rcp_f32 v72, v72
v_rcp_f32 v73, v73
v_rcp_f32 v74, v74
v_rcp_f32 v75, v75
v_rcp_f32 v76, v76
v_rcp_f32 v77, v77
s_add_u32 m0, s40, 1024
s_nop 0
buffer_load_dwordx4 v5, s[12:15], s38 offen lds
v_rcp_f32 v78, v78
v_rcp_f32 v79, v79
v_mul_f32 v196, v184, v196
v_mul_f32 v197, v185, v197
v_mul_f32 v198, v186, v198
v_mul_f32 v199, v187, v199
v_mul_f32 v220, v208, v220
s_add_u32 m0, s40, 2048
s_add_u32 s38, s38, 57344
buffer_load_dwordx4 v4, s[12:15], s38 offen lds
v_mul_f32 v221, v209, v221
v_mul_f32 v222, v210, v222
v_mul_f32 v223, v211, v223
v_mul_f32 v196, v196, v72
v_mul_f32 v197, v197, v73
v_mul_f32 v198, v198, v74
s_add_u32 m0, s40, 3072
s_nop 0
buffer_load_dwordx4 v5, s[12:15], s38 offen lds
v_mul_f32 v199, v199, v75
v_mul_f32 v220, v220, v76
v_mul_f32 v221, v221, v77
v_mul_f32 v222, v222, v78
v_mul_f32 v223, v223, v79
v_cvt_pk_bf16_f32 v80, v196, v197
v_cvt_pk_bf16_f32 v81, v198, v199
s_add_u32 m0, s40, 4096
s_add_u32 s38, s38, 57344
buffer_load_dwordx4 v4, s[12:15], s38 offen lds
v_cvt_pk_bf16_f32 v82, v220, v221
v_cvt_pk_bf16_f32 v83, v222, v223
s_nop 1
v_permlane32_swap_b32 v80, v82
v_permlane32_swap_b32 v81, v83
buffer_store_dwordx4 v[80:83], v84, s[24:27], s55 offen offset:2048 sc1
s_nop 1
s_add_u32 m0, s40, 5120
s_nop 0
buffer_load_dwordx4 v5, s[12:15], s38 offen lds
v_cmp_gt_u32 vcc, 32, v1
v_mov_b32 v104, s52
v_mov_b32 v106, s53
v_cndmask_b32 v104, v106, v104, vcc
v_lshl_add_u32 v104, v105, 4, v104
v_bfe_u32 v105, v1, 4, 1
v_lshl_add_u32 v104, v105, 2, v104
s_add_u32 m0, s40, 6144
s_add_u32 s38, s38, 57344
buffer_load_dwordx4 v4, s[12:15], s38 offen lds
s_add_u32 m0, s40, 7168
s_nop 0
buffer_load_dwordx4 v5, s[12:15], s38 offen lds
s_waitcnt vmcnt(15)
s_barrier
s_add_u32 s37, s35, 12
s_and_b32 s37, s37, 15
s_mul_i32 s37, s37, 16384
s_add_u32 m0, s39, 49152
s_nop 0
buffer_load_dwordx4 v3, s[8:11], s37 offen sc1 lds
buffer_load_dwordx4 v3, s[8:11], s37 offen offset:1024 sc1 lds
buffer_load_dwordx4 v3, s[8:11], s37 offen offset:2048 sc1 lds
buffer_load_dwordx4 v3, s[8:11], s37 offen offset:3072 sc1 lds
s_add_u32 s38, s35, 12
s_and_b32 s38, s38, 15
s_mul_i32 s38, s38, 458752
s_add_u32 m0, s40, 49152
s_branch Lov_10
.p2align 12
.fill 80, 4, 0xbf800000
Lst_10_0:
s_branch Lwr_156
Lst_10_1:
s_branch Lwr_167
s_nop 0
Lov_10:
s_nop 0
buffer_load_dwordx4 v4, s[12:15], s38 offen lds
s_add_u32 m0, s40, 50176
s_nop 0
buffer_load_dwordx4 v5, s[12:15], s38 offen lds
s_add_u32 m0, s40, 51200
s_add_u32 s38, s38, 57344
buffer_load_dwordx4 v4, s[12:15], s38 offen lds
s_add_u32 m0, s40, 52224
s_nop 0
buffer_load_dwordx4 v5, s[12:15], s38 offen lds
s_add_u32 m0, s40, 53248
s_add_u32 s38, s38, 57344
buffer_load_dwordx4 v4, s[12:15], s38 offen lds
s_add_u32 m0, s40, 54272
s_nop 0
buffer_load_dwordx4 v5, s[12:15], s38 offen lds
s_add_u32 m0, s40, 55296
s_add_u32 s38, s38, 57344
buffer_load_dwordx4 v4, s[12:15], s38 offen lds
s_add_u32 m0, s40, 56320
s_nop 0
buffer_load_dwordx4 v5, s[12:15], s38 offen lds
s_waitcnt vmcnt(12)
s_barrier
s_cmp_eq_u32 s47, 0
s_cbranch_scc0 Lw_116
s_add_u32 s7, s34, 32
s_lshl_b32 s7, s7, 7
v_mov_b32 v28, s7
v_mov_b32 v29, 1
s_mov_b64 exec, 1
buffer_atomic_add v29, v28, s[56:59], 0 offen sc1
s_mov_b64 exec, -1
Lw_116:
v_permlane32_swap_b32 v96, v100
v_permlane32_swap_b32 v97, v101
v_permlane32_swap_b32 v98, v102
v_permlane32_swap_b32 v99, v103
v_add_f32 v96, v96, v100
v_add_f32 v97, v97, v101
v_add_f32 v98, v98, v102
v_add_f32 v99, v99, v103
s_nop 1
v_permlane16_swap_b32 v96, v97
v_permlane16_swap_b32 v98, v99
v_add_f32 v96, v96, v97
v_add_f32 v98, v98, v99
s_nop 1
v_add_f32_dpp v96, v96, v96 row_ror:8 row_mask:0xf bank_mask:0xf
v_add_f32_dpp v98, v98, v98 row_ror:8 row_mask:0xf bank_mask:0xf
ds_write_b32 v104, v96
ds_write_b32 v104, v98 offset:8
s_waitcnt lgkmcnt(0)
s_add_u32 s37, s35, 13
s_and_b32 s37, s37, 15
s_mul_i32 s37, s37, 16384
s_add_u32 m0, s39, 98304
s_nop 0
buffer_load_dwordx4 v3, s[8:11], s37 offen sc1 lds
s_load_dword s3, s[4:5], 6272
s_load_dword s3, s[4:5], 6336
s_load_dword s3, s[4:5], 6400
s_load_dword s3, s[4:5], 6464
s_load_dword s3, s[4:5], 6528
s_load_dword s3, s[4:5], 6592
buffer_load_dwordx4 v3, s[8:11], s37 offen offset:1024 sc1 lds
s_load_dword s3, s[4:5], 6656
s_load_dword s3, s[4:5], 6720
s_load_dword s3, s[4:5], 6784
s_load_dword s3, s[4:5], 6848
s_load_dword s3, s[4:5], 6912
s_load_dword s3, s[4:5], 6976
buffer_load_dwordx4 v3, s[8:11], s37 offen offset:2048 sc1 lds
s_load_dword s3, s[4:5], 7040
s_load_dword s3, s[4:5], 7104
s_bfe_u32 s61, s35, 0x10002
s_lshr_b32 s60, s35, 3
s_lshl_b32 s60, s60, 2
s_and_b32 s43, s35, 3
buffer_load_dwordx4 v3, s[8:11], s37 offen offset:3072 sc1 lds
s_add_u32 s60, s60, s43
s_lshl_b32 s43, s60, 8
s_add_u32 s28, s76, s43
s_addc_u32 s29, s77, 0
s_mov_b32 s30, 7338240
s_mov_b32 s31, 0x20000
s_mul_i32 s52, s61, 196608
s_add_u32 s38, s35, 13
s_and_b32 s38, s38, 15
s_mul_i32 s38, s38, 458752
s_add_u32 m0, s40, 98304
s_nop 0
buffer_load_dwordx4 v4, s[12:15], s38 offen lds
s_mul_i32 s53, s61, 1572864
s_mul_i32 s90, s61, 163840
s_mul_i32 s91, s61, 1310720
s_lshl_b32 s51, s47, 11
s_lshl_b32 s44, s47, 15
v_lshrrev_b32 v122, 4, v1
s_add_u32 m0, s40, 99328
s_nop 0
buffer_load_dwordx4 v5, s[12:15], s38 offen lds
v_lshlrev_b32 v123, 1, v122
v_and_b32 v23, 15, v1
v_xor_b32 v23, v23, v123
v_lshlrev_b32 v23, 4, v23
v_mul_u32_u24 v122, 2048, v122
v_add_u32 v23, v23, v122
s_add_u32 m0, s40, 100352
s_add_u32 s38, s38, 57344
buffer_load_dwordx4 v4, s[12:15], s38 offen lds
v_add_u32 v23, s44, v23
v_xor_b32 v24, 128, v23
v_add_u32 v24, 8192, v24
s_lshl_b32 s43, s60, 2
s_lshl_b32 s44, s61, 1
s_add_u32 s43, s43, s44
s_add_u32 s43, s43, s63
s_add_u32 m0, s40, 101376
s_nop 0
buffer_load_dwordx4 v5, s[12:15], s38 offen lds
s_lshl_b32 s43, s43, 13
s_lshl_b32 s44, s62, 12
s_add_u32 s50, s43, s44
v_add_u32 v6, s44, v2
v_add_u32 v7, 0x10000, v6
v_add_u32 v8, 0x20000, v6
s_add_u32 m0, s40, 102400
s_add_u32 s38, s38, 57344
buffer_load_dwordx4 v4, s[12:15], s38 offen lds
v_lshrrev_b32 v122, 2, v1
v_and_b32 v123, 7, v122
v_mul_u32_u24 v122, 256, v122
v_lshl_add_u32 v122, v123, 5, v122
v_and_b32 v123, 3, v1
v_lshl_add_u32 v9, v123, 3, v122
s_add_u32 m0, s40, 103424
s_nop 0
buffer_load_dwordx4 v5, s[12:15], s38 offen lds
s_lshl_b32 s43, s61, 7
s_lshl_b32 s44, s63, 6
s_add_u32 s43, s43, s44
v_xor_b32 v9, s43, v9
v_xor_b32 v10, 32, v9
v_xor_b32 v11, 128, v9
v_xor_b32 v12, 128, v10
s_add_u32 m0, s40, 104448
s_add_u32 s38, s38, 57344
buffer_load_dwordx4 v4, s[12:15], s38 offen lds
s_add_u32 m0, s40, 105472
s_nop 0
buffer_load_dwordx4 v5, s[12:15], s38 offen lds
s_waitcnt vmcnt(12)
s_barrier
buffer_load_dwordx4 v[160:163], v2, s[8:11], s50 offen offset:0 sc1
v_add_u32 v13, 65536, v9
v_add_u32 v14, 65536, v10
v_add_u32 v15, 65536, v11
buffer_load_dwordx4 v[164:167], v2, s[8:11], s50 offen offset:1024 sc1
v_add_u32 v16, 65536, v12
v_add_u32 v25, 131072, v9
v_add_u32 v26, 131072, v10
v_add_u32 v27, 131072, v11
buffer_load_dwordx4 v[168:171], v2, s[8:11], s50 offen offset:2048 sc1
v_add_u32 v28, 131072, v12
v_lshrrev_b32 v122, 2, v1
v_bfe_u32 v123, v122, 1, 2
buffer_load_dwordx4 v[172:175], v2, s[8:11], s50 offen offset:3072 sc1
v_mul_u32_u24 v122, 128, v122
v_lshl_add_u32 v122, v123, 5, v122
v_and_b32 v123, 3, v1
v_lshl_add_u32 v224, v123, 3, v122
s_add_u32 s37, s35, 14
s_and_b32 s37, s37, 15
s_mul_i32 s37, s37, 16384
s_add_u32 m0, s39, 0
s_nop 0
buffer_load_dwordx4 v3, s[8:11], s37 offen sc1 lds
v_xor_b32 v224, s44, v224
v_xor_b32 v225, 32, v224
v_add_u32 v226, 65536, v224
buffer_load_dwordx4 v3, s[8:11], s37 offen offset:1024 sc1 lds
v_add_u32 v227, 65536, v225
v_add_u32 v228, 131072, v224
v_add_u32 v229, 131072, v225
s_add_u32 s84, s82, 33554432
buffer_load_dwordx4 v3, s[8:11], s37 offen offset:2048 sc1 lds
s_addc_u32 s85, s83, 0
s_mov_b32 s86, 4194304
s_mov_b32 s87, 0x20000
s_xor_b32 s43, s2, 2
buffer_load_dwordx4 v3, s[8:11], s37 offen offset:3072 sc1 lds
s_lshl_b32 s44, s43, 2
s_add_u32 s44, s44, s47
s_lshl_b32 s45, s44, 12
s_add_u32 s38, s35, 14
s_and_b32 s38, s38, 15
s_mul_i32 s38, s38, 458752
s_add_u32 m0, s40, 0
s_nop 0
buffer_load_dwordx4 v4, s[12:15], s38 offen lds
s_lshl_b32 s46, s2, 2
s_add_u32 s46, s46, s47
s_lshl_b32 s46, s46, 12
s_lshl_b32 s43, s34, 18
s_add_u32 m0, s40, 1024
s_nop 0
buffer_load_dwordx4 v5, s[12:15], s38 offen lds
s_lshl_b32 s42, s60, 8
s_add_u32 s43, s43, s42
s_lshl_b32 s42, s61, 7
s_add_u32 m0, s40, 2048
s_add_u32 s38, s38, 57344
buffer_load_dwordx4 v4, s[12:15], s38 offen lds
s_add_u32 s43, s43, s42
s_lshl_b32 s42, s63, 6
s_add_u32 s43, s43, s42
s_add_u32 s20, s78, s43
s_add_u32 m0, s40, 3072
s_nop 0
buffer_load_dwordx4 v5, s[12:15], s38 offen lds
s_addc_u32 s21, s79, 0
s_mov_b32 s22, 260160
s_mov_b32 s23, 0x20000
s_add_u32 m0, s40, 4096
s_add_u32 s38, s38, 57344
buffer_load_dwordx4 v4, s[12:15], s38 offen lds
v_and_b32 v230, 15, v1
v_lshlrev_b32 v230, 12, v230
v_bfe_u32 v231, v1, 4, 1
v_lshl_add_u32 v230, v231, 5, v230
s_add_u32 m0, s40, 5120
s_nop 0
buffer_load_dwordx4 v5, s[12:15], s38 offen lds
v_bfe_u32 v231, v1, 5, 1
v_lshl_add_u32 v230, v231, 4, v230
s_lshl_b32 s54, s62, 17
s_add_u32 s55, s54, 65536
s_add_u32 m0, s40, 6144
s_add_u32 s38, s38, 57344
buffer_load_dwordx4 v4, s[12:15], s38 offen lds
s_add_u32 m0, s40, 7168
s_nop 0
buffer_load_dwordx4 v5, s[12:15], s38 offen lds
s_waitcnt vmcnt(16)
s_barrier
s_cmp_eq_u32 s47, 3
s_cbranch_scc0 Lw_117
s_lshl_b32 s92, s34, 7
s_add_u32 s92, s92, 28315648
s_load_dword s93, s[82:83], s92 glc
Lw_117:
s_add_u32 s37, s35, 15
s_and_b32 s37, s37, 15
s_mul_i32 s37, s37, 16384
s_add_u32 m0, s39, 49152
s_nop 0
buffer_load_dwordx4 v3, s[8:11], s37 offen sc1 lds
buffer_load_dwordx4 v3, s[8:11], s37 offen offset:1024 sc1 lds
buffer_load_dwordx4 v3, s[8:11], s37 offen offset:2048 sc1 lds
buffer_load_dwordx4 v3, s[8:11], s37 offen offset:3072 sc1 lds
s_add_u32 s38, s35, 15
s_and_b32 s38, s38, 15
s_mul_i32 s38, s38, 458752
s_add_u32 m0, s40, 49152
s_nop 0
buffer_load_dwordx4 v4, s[12:15], s38 offen lds
s_add_u32 m0, s40, 50176
s_nop 0
buffer_load_dwordx4 v5, s[12:15], s38 offen lds
s_add_u32 m0, s40, 51200
s_add_u32 s38, s38, 57344
buffer_load_dwordx4 v4, s[12:15], s38 offen lds
s_add_u32 m0, s40, 52224
s_nop 0
buffer_load_dwordx4 v5, s[12:15], s38 offen lds
s_add_u32 m0, s40, 53248
s_add_u32 s38, s38, 57344
buffer_load_dwordx4 v4, s[12:15], s38 offen lds
s_add_u32 m0, s40, 54272
s_nop 0
buffer_load_dwordx4 v5, s[12:15], s38 offen lds
s_add_u32 m0, s40, 55296
s_add_u32 s38, s38, 57344
buffer_load_dwordx4 v4, s[12:15], s38 offen lds
s_add_u32 m0, s40, 56320
s_nop 0
buffer_load_dwordx4 v5, s[12:15], s38 offen lds
s_waitcnt vmcnt(12)
s_cmp_eq_u32 s47, 3
s_cbranch_scc0 Lw_118
s_mov_b32 s41, 0x40000
s_branch Lpchk_121
Lpoll_119:
s_load_dword s93, s[82:83], s92 glc
Lpchk_121:
s_waitcnt lgkmcnt(0)
s_cmp_eq_u32 s93, 16
s_cbranch_scc1 Lpok_120
s_sub_u32 s41, s41, 1
s_cmp_lg_u32 s41, 0
s_cbranch_scc1 Lpoll_119
Lpok_120:
Lw_118:
s_barrier
s_add_u32 m0, s39, 98304
s_add_u32 s37, s52, 524288
buffer_load_dwordx4 v3, s[24:27], s37 offen sc1 lds
v_lshlrev_b32 v128, 16, v160
v_and_b32 v129, 0xffff0000, v160
v_lshlrev_b32 v130, 16, v161
v_and_b32 v131, 0xffff0000, v161
v_lshlrev_b32 v132, 16, v162
buffer_load_dwordx4 v3, s[24:27], s37 offen offset:1024 sc1 lds
v_and_b32 v133, 0xffff0000, v162
v_lshlrev_b32 v134, 16, v163
v_and_b32 v135, 0xffff0000, v163
v_lshlrev_b32 v136, 16, v164
v_and_b32 v137, 0xffff0000, v164
buffer_load_dwordx4 v3, s[24:27], s37 offen offset:2048 sc1 lds
v_lshlrev_b32 v138, 16, v165
v_and_b32 v139, 0xffff0000, v165
v_lshlrev_b32 v140, 16, v166
v_and_b32 v141, 0xffff0000, v166
v_lshlrev_b32 v142, 16, v167
v_and_b32 v143, 0xffff0000, v167
buffer_load_dwordx4 v3, s[24:27], s37 offen offset:3072 sc1 lds
v_lshlrev_b32 v144, 16, v168
v_and_b32 v145, 0xffff0000, v168
v_lshlrev_b32 v146, 16, v169
v_and_b32 v147, 0xffff0000, v169
v_lshlrev_b32 v148, 16, v170
s_add_u32 m0, s39, 114688
s_add_u32 s38, s53, 4194304
buffer_load_dwordx4 v23, s[28:31], s38 offen lds
v_and_b32 v149, 0xffff0000, v170
v_lshlrev_b32 v150, 16, v171
v_and_b32 v151, 0xffff0000, v171
v_lshlrev_b32 v152, 16, v172
v_and_b32 v153, 0xffff0000, v172
s_add_u32 m0, s39, 115712
s_add_u32 s38, s53, 4194304
buffer_load_dwordx4 v24, s[28:31], s38 offen lds
v_lshlrev_b32 v154, 16, v173
v_and_b32 v155, 0xffff0000, v173
v_lshlrev_b32 v156, 16, v174
v_and_b32 v157, 0xffff0000, v174
v_lshlrev_b32 v158, 16, v175
v_and_b32 v159, 0xffff0000, v175
s_add_u32 m0, s39, 116736
s_add_u32 s38, s53, 4210688
buffer_load_dwordx4 v23, s[28:31], s38 offen lds
s_add_u32 m0, s39, 117760
s_add_u32 s38, s53, 4210688
buffer_load_dwordx4 v24, s[28:31], s38 offen lds
s_waitcnt vmcnt(8)
s_barrier
s_add_u32 m0, s39, 131072
s_add_u32 s37, s52, 540672
buffer_load_dwordx4 v3, s[24:27], s37 offen sc1 lds
buffer_load_dwordx4 v3, s[24:27], s37 offen offset:1024 sc1 lds
buffer_load_dwordx4 v3, s[24:27], s37 offen offset:2048 sc1 lds
buffer_load_dwordx4 v3, s[24:27], s37 offen offset:3072 sc1 lds
s_add_u32 m0, s39, 0
s_add_u32 s38, s53, 4325376
buffer_load_dwordx4 v23, s[28:31], s38 offen lds
s_add_u32 m0, s39, 1024
s_add_u32 s38, s53, 4325376
buffer_load_dwordx4 v24, s[28:31], s38 offen lds
s_add_u32 m0, s39, 2048
s_add_u32 s38, s53, 4341760
buffer_load_dwordx4 v23, s[28:31], s38 offen lds
s_add_u32 m0, s39, 3072
s_add_u32 s38, s53, 4341760
buffer_load_dwordx4 v24, s[28:31], s38 offen lds
s_add_u32 m0, s39, 16384
s_add_u32 s37, s52, 557056
buffer_load_dwordx4 v3, s[24:27], s37 offen sc1 lds
buffer_load_dwordx4 v3, s[24:27], s37 offen offset:1024 sc1 lds
buffer_load_dwordx4 v3, s[24:27], s37 offen offset:2048 sc1 lds
buffer_load_dwordx4 v3, s[24:27], s37 offen offset:3072 sc1 lds
s_add_u32 m0, s39, 32768
s_add_u32 s38, s53, 4456448
buffer_load_dwordx4 v23, s[28:31], s38 offen lds
s_add_u32 m0, s39, 33792
s_add_u32 s38, s53, 4456448
buffer_load_dwordx4 v24, s[28:31], s38 offen lds
s_add_u32 m0, s39, 34816
s_add_u32 s38, s53, 4472832
buffer_load_dwordx4 v23, s[28:31], s38 offen lds
s_add_u32 m0, s39, 35840
s_add_u32 s38, s53, 4472832
buffer_load_dwordx4 v24, s[28:31], s38 offen lds
s_waitcnt vmcnt(16)
s_barrier
ds_read_b128 v[32:35], v7 offset:32768
ds_read_b64_tr_b16 v[48:49], v13 offset:49152
ds_read_b64_tr_b16 v[50:51], v13 offset:53248
ds_read_b64_tr_b16 v[52:53], v14 offset:49152
ds_read_b64_tr_b16 v[54:55], v14 offset:53248
ds_read_b64_tr_b16 v[56:57], v15 offset:49152
ds_read_b64_tr_b16 v[58:59], v15 offset:53248
ds_read_b64_tr_b16 v[60:61], v16 offset:49152
ds_read_b64_tr_b16 v[62:63], v16 offset:53248
ds_read_b128 v[36:39], v7 offset:33792
ds_read_b128 v[40:43], v7 offset:34816
ds_read_b128 v[44:47], v7 offset:35840
ds_read_b128 v[64:67], v7 offset:40960
ds_read_b64_tr_b16 v[80:81], v13 offset:57344
ds_read_b64_tr_b16 v[82:83], v13 offset:61440
ds_read_b64_tr_b16 v[84:85], v14 offset:57344
ds_read_b64_tr_b16 v[86:87], v14 offset:61440
ds_read_b64_tr_b16 v[88:89], v15 offset:57344
ds_read_b64_tr_b16 v[90:91], v15 offset:61440
ds_read_b64_tr_b16 v[92:93], v16 offset:57344
ds_read_b64_tr_b16 v[94:95], v16 offset:61440
ds_read_b128 v[68:71], v7 offset:41984
ds_read_b128 v[72:75], v7 offset:43008
ds_read_b128 v[76:79], v7 offset:44032
s_add_u32 m0, s39, 49152
s_add_u32 s37, s52, 573440
buffer_load_dwordx4 v3, s[24:27], s37 offen sc1 lds
buffer_load_dwordx4 v3, s[24:27], s37 offen offset:1024 sc1 lds
buffer_load_dwordx4 v3, s[24:27], s37 offen offset:2048 sc1 lds
buffer_load_dwordx4 v3, s[24:27], s37 offen offset:3072 sc1 lds
s_add_u32 m0, s39, 65536
s_add_u32 s38, s53, 4587520
buffer_load_dwordx4 v23, s[28:31], s38 offen lds
s_add_u32 m0, s39, 66560
s_add_u32 s38, s53, 4587520
buffer_load_dwordx4 v24, s[28:31], s38 offen lds
s_add_u32 m0, s39, 67584
s_add_u32 s38, s53, 4603904
buffer_load_dwordx4 v23, s[28:31], s38 offen lds
s_add_u32 m0, s39, 68608
s_add_u32 s38, s53, 4603904
buffer_load_dwordx4 v24, s[28:31], s38 offen lds
s_waitcnt vmcnt(16)
s_waitcnt lgkmcnt(0)
s_barrier
v_mfma_f32_16x16x32_bf16 v[128:131], v[48:51], v[32:35], v[128:131]
ds_read_b128 v[96:99], v8 offset:0
v_mfma_f32_16x16x32_bf16 v[132:135], v[52:55], v[32:35], v[132:135]
ds_read_b64_tr_b16 v[112:113], v9 offset:0
v_mfma_f32_16x16x32_bf16 v[160:163], v[56:59], v[32:35], 0
ds_read_b64_tr_b16 v[114:115], v9 offset:4096
v_mfma_f32_16x16x32_bf16 v[164:167], v[60:63], v[32:35], 0
ds_read_b64_tr_b16 v[116:117], v10 offset:0
v_mfma_f32_16x16x32_bf16 v[172:175], v[60:63], v[36:39], 0
ds_read_b64_tr_b16 v[118:119], v10 offset:4096
v_mfma_f32_16x16x32_bf16 v[168:171], v[56:59], v[36:39], 0
ds_read_b64_tr_b16 v[120:121], v11 offset:0
v_mfma_f32_16x16x32_bf16 v[140:143], v[52:55], v[36:39], v[140:143]
ds_read_b64_tr_b16 v[122:123], v11 offset:4096
v_mfma_f32_16x16x32_bf16 v[136:139], v[48:51], v[36:39], v[136:139]
ds_read_b64_tr_b16 v[124:125], v12 offset:0
v_mfma_f32_16x16x32_bf16 v[144:147], v[48:51], v[40:43], v[144:147]
ds_read_b64_tr_b16 v[126:127], v12 offset:4096
v_mfma_f32_16x16x32_bf16 v[148:151], v[52:55], v[40:43], v[148:151]
ds_read_b128 v[100:103], v8 offset:1024
v_mfma_f32_16x16x32_bf16 v[176:179], v[56:59], v[40:43], 0
ds_read_b128 v[104:107], v8 offset:2048
v_mfma_f32_16x16x32_bf16 v[180:183], v[60:63], v[40:43], 0
ds_read_b128 v[108:111], v8 offset:3072
v_mfma_f32_16x16x32_bf16 v[188:191], v[60:63], v[44:47], 0
ds_read_b128 v[192:195], v8 offset:8192
v_mfma_f32_16x16x32_bf16 v[184:187], v[56:59], v[44:47], 0
ds_read_b64_tr_b16 v[208:209], v9 offset:8192
v_mfma_f32_16x16x32_bf16 v[156:159], v[52:55], v[44:47], v[156:159]
ds_read_b64_tr_b16 v[210:211], v9 offset:12288
v_mfma_f32_16x16x32_bf16 v[152:155], v[48:51], v[44:47], v[152:155]
ds_read_b64_tr_b16 v[212:213], v10 offset:8192
v_mfma_f32_16x16x32_bf16 v[128:131], v[80:83], v[64:67], v[128:131]
ds_read_b64_tr_b16 v[214:215], v10 offset:12288
v_mfma_f32_16x16x32_bf16 v[132:135], v[84:87], v[64:67], v[132:135]
ds_read_b64_tr_b16 v[216:217], v11 offset:8192
v_mfma_f32_16x16x32_bf16 v[160:163], v[88:91], v[64:67], v[160:163]
ds_read_b64_tr_b16 v[218:219], v11 offset:12288
v_mfma_f32_16x16x32_bf16 v[164:167], v[92:95], v[64:67], v[164:167]
ds_read_b64_tr_b16 v[220:221], v12 offset:8192
v_mfma_f32_16x16x32_bf16 v[172:175], v[92:95], v[68:71], v[172:175]
ds_read_b64_tr_b16 v[222:223], v12 offset:12288
v_mfma_f32_16x16x32_bf16 v[168:171], v[88:91], v[68:71], v[168:171]
ds_read_b128 v[196:199], v8 offset:9216
v_mfma_f32_16x16x32_bf16 v[140:143], v[84:87], v[68:71], v[140:143]
ds_read_b128 v[200:203], v8 offset:10240
v_mfma_f32_16x16x32_bf16 v[136:139], v[80:83], v[68:71], v[136:139]
ds_read_b128 v[204:207], v8 offset:11264
v_mfma_f32_16x16x32_bf16 v[144:147], v[80:83], v[72:75], v[144:147]
v_mfma_f32_16x16x32_bf16 v[148:151], v[84:87], v[72:75], v[148:151]
v_mfma_f32_16x16x32_bf16 v[176:179], v[88:91], v[72:75], v[176:179]
v_mfma_f32_16x16x32_bf16 v[180:183], v[92:95], v[72:75], v[180:183]
v_mfma_f32_16x16x32_bf16 v[188:191], v[92:95], v[76:79], v[188:191]
v_mfma_f32_16x16x32_bf16 v[184:187], v[88:91], v[76:79], v[184:187]
v_mfma_f32_16x16x32_bf16 v[156:159], v[84:87], v[76:79], v[156:159]
v_mfma_f32_16x16x32_bf16 v[152:155], v[80:83], v[76:79], v[152:155]
s_mov_b32 s41, 2
Lk4_122:
s_waitcnt vmcnt(8)
s_waitcnt lgkmcnt(0)
s_barrier
v_mfma_f32_16x16x32_bf16 v[128:131], v[112:115], v[96:99], v[128:131]
ds_read_b128 v[32:35], v6 offset:16384
v_mfma_f32_16x16x32_bf16 v[132:135], v[116:119], v[96:99], v[132:135]
ds_read_b64_tr_b16 v[48:49], v9 offset:32768
v_mfma_f32_16x16x32_bf16 v[160:163], v[120:123], v[96:99], v[160:163]
ds_read_b64_tr_b16 v[50:51], v9 offset:36864
v_mfma_f32_16x16x32_bf16 v[164:167], v[124:127], v[96:99], v[164:167]
ds_read_b64_tr_b16 v[52:53], v10 offset:32768
v_mfma_f32_16x16x32_bf16 v[172:175], v[124:127], v[100:103], v[172:175]
ds_read_b64_tr_b16 v[54:55], v10 offset:36864
v_mfma_f32_16x16x32_bf16 v[168:171], v[120:123], v[100:103], v[168:171]
ds_read_b64_tr_b16 v[56:57], v11 offset:32768
v_mfma_f32_16x16x32_bf16 v[140:143], v[116:119], v[100:103], v[140:143]
ds_read_b64_tr_b16 v[58:59], v11 offset:36864
v_mfma_f32_16x16x32_bf16 v[136:139], v[112:115], v[100:103], v[136:139]
ds_read_b64_tr_b16 v[60:61], v12 offset:32768
v_mfma_f32_16x16x32_bf16 v[144:147], v[112:115], v[104:107], v[144:147]
ds_read_b64_tr_b16 v[62:63], v12 offset:36864
v_mfma_f32_16x16x32_bf16 v[148:151], v[116:119], v[104:107], v[148:151]
ds_read_b128 v[36:39], v6 offset:17408
v_mfma_f32_16x16x32_bf16 v[176:179], v[120:123], v[104:107], v[176:179]
ds_read_b128 v[40:43], v6 offset:18432
v_mfma_f32_16x16x32_bf16 v[180:183], v[124:127], v[104:107], v[180:183]
ds_read_b128 v[44:47], v6 offset:19456
v_mfma_f32_16x16x32_bf16 v[188:191], v[124:127], v[108:111], v[188:191]
ds_read_b128 v[64:67], v6 offset:24576
v_mfma_f32_16x16x32_bf16 v[184:187], v[120:123], v[108:111], v[184:187]
ds_read_b64_tr_b16 v[80:81], v9 offset:40960
v_mfma_f32_16x16x32_bf16 v[156:159], v[116:119], v[108:111], v[156:159]
ds_read_b64_tr_b16 v[82:83], v9 offset:45056
v_mfma_f32_16x16x32_bf16 v[152:155], v[112:115], v[108:111], v[152:155]
ds_read_b64_tr_b16 v[84:85], v10 offset:40960
v_mfma_f32_16x16x32_bf16 v[128:131], v[208:211], v[192:195], v[128:131]
ds_read_b64_tr_b16 v[86:87], v10 offset:45056
v_mfma_f32_16x16x32_bf16 v[132:135], v[212:215], v[192:195], v[132:135]
ds_read_b64_tr_b16 v[88:89], v11 offset:40960
v_mfma_f32_16x16x32_bf16 v[160:163], v[216:219], v[192:195], v[160:163]
ds_read_b64_tr_b16 v[90:91], v11 offset:45056
v_mfma_f32_16x16x32_bf16 v[164:167], v[220:223], v[192:195], v[164:167]
ds_read_b64_tr_b16 v[92:93], v12 offset:40960
v_mfma_f32_16x16x32_bf16 v[172:175], v[220:223], v[196:199], v[172:175]
ds_read_b64_tr_b16 v[94:95], v12 offset:45056
v_mfma_f32_16x16x32_bf16 v[168:171], v[216:219], v[196:199], v[168:171]
ds_read_b128 v[68:71], v6 offset:25600
v_mfma_f32_16x16x32_bf16 v[140:143], v[212:215], v[196:199], v[140:143]
ds_read_b128 v[72:75], v6 offset:26624
v_mfma_f32_16x16x32_bf16 v[136:139], v[208:211], v[196:199], v[136:139]
ds_read_b128 v[76:79], v6 offset:27648
v_mfma_f32_16x16x32_bf16 v[144:147], v[208:211], v[200:203], v[144:147]
v_mfma_f32_16x16x32_bf16 v[148:151], v[212:215], v[200:203], v[148:151]
v_mfma_f32_16x16x32_bf16 v[176:179], v[216:219], v[200:203], v[176:179]
v_mfma_f32_16x16x32_bf16 v[180:183], v[220:223], v[200:203], v[180:183]
v_mfma_f32_16x16x32_bf16 v[188:191], v[220:223], v[204:207], v[188:191]
v_mfma_f32_16x16x32_bf16 v[184:187], v[216:219], v[204:207], v[184:187]
v_mfma_f32_16x16x32_bf16 v[156:159], v[212:215], v[204:207], v[156:159]
v_mfma_f32_16x16x32_bf16 v[152:155], v[208:211], v[204:207], v[152:155]
s_waitcnt vmcnt(0)
s_waitcnt lgkmcnt(0)
s_branch Lov_11
.p2align 12
.fill 80, 4, 0xbf800000
Lst_11_0:
s_branch Lwr_157
Lst_11_1:
s_branch Lst_15_0
s_nop 0
Lov_11:
s_barrier
v_mfma_f32_16x16x32_bf16 v[128:131], v[48:51], v[32:35], v[128:131]
ds_read_b128 v[96:99], v6 offset:49152
v_mfma_f32_16x16x32_bf16 v[132:135], v[52:55], v[32:35], v[132:135]
ds_read_b64_tr_b16 v[112:113], v13 offset:0
v_mfma_f32_16x16x32_bf16 v[160:163], v[56:59], v[32:35], v[160:163]
ds_read_b64_tr_b16 v[114:115], v13 offset:4096
v_mfma_f32_16x16x32_bf16 v[164:167], v[60:63], v[32:35], v[164:167]
ds_read_b64_tr_b16 v[116:117], v14 offset:0
v_mfma_f32_16x16x32_bf16 v[172:175], v[60:63], v[36:39], v[172:175]
ds_read_b64_tr_b16 v[118:119], v14 offset:4096
v_mfma_f32_16x16x32_bf16 v[168:171], v[56:59], v[36:39], v[168:171]
ds_read_b64_tr_b16 v[120:121], v15 offset:0
v_mfma_f32_16x16x32_bf16 v[140:143], v[52:55], v[36:39], v[140:143]
ds_read_b64_tr_b16 v[122:123], v15 offset:4096
v_mfma_f32_16x16x32_bf16 v[136:139], v[48:51], v[36:39], v[136:139]
ds_read_b64_tr_b16 v[124:125], v16 offset:0
v_mfma_f32_16x16x32_bf16 v[144:147], v[48:51], v[40:43], v[144:147]
ds_read_b64_tr_b16 v[126:127], v16 offset:4096
v_mfma_f32_16x16x32_bf16 v[148:151], v[52:55], v[40:43], v[148:151]
ds_read_b128 v[100:103], v6 offset:50176
v_mfma_f32_16x16x32_bf16 v[176:179], v[56:59], v[40:43], v[176:179]
ds_read_b128 v[104:107], v6 offset:51200
v_mfma_f32_16x16x32_bf16 v[180:183], v[60:63], v[40:43], v[180:183]
ds_read_b128 v[108:111], v6 offset:52224
v_mfma_f32_16x16x32_bf16 v[188:191], v[60:63], v[44:47], v[188:191]
ds_read_b128 v[192:195], v6 offset:57344
v_mfma_f32_16x16x32_bf16 v[184:187], v[56:59], v[44:47], v[184:187]
ds_read_b64_tr_b16 v[208:209], v13 offset:8192
v_mfma_f32_16x16x32_bf16 v[156:159], v[52:55], v[44:47], v[156:159]
ds_read_b64_tr_b16 v[210:211], v13 offset:12288
v_mfma_f32_16x16x32_bf16 v[152:155], v[48:51], v[44:47], v[152:155]
ds_read_b64_tr_b16 v[212:213], v14 offset:8192
v_mfma_f32_16x16x32_bf16 v[128:131], v[80:83], v[64:67], v[128:131]
ds_read_b64_tr_b16 v[214:215], v14 offset:12288
v_mfma_f32_16x16x32_bf16 v[132:135], v[84:87], v[64:67], v[132:135]
ds_read_b64_tr_b16 v[216:217], v15 offset:8192
v_mfma_f32_16x16x32_bf16 v[160:163], v[88:91], v[64:67], v[160:163]
ds_read_b64_tr_b16 v[218:219], v15 offset:12288
v_mfma_f32_16x16x32_bf16 v[164:167], v[92:95], v[64:67], v[164:167]
ds_read_b64_tr_b16 v[220:221], v16 offset:8192
v_mfma_f32_16x16x32_bf16 v[172:175], v[92:95], v[68:71], v[172:175]
ds_read_b64_tr_b16 v[222:223], v16 offset:12288
v_mfma_f32_16x16x32_bf16 v[168:171], v[88:91], v[68:71], v[168:171]
ds_read_b128 v[196:199], v6 offset:58368
v_mfma_f32_16x16x32_bf16 v[140:143], v[84:87], v[68:71], v[140:143]
ds_read_b128 v[200:203], v6 offset:59392
v_mfma_f32_16x16x32_bf16 v[136:139], v[80:83], v[68:71], v[136:139]
ds_read_b128 v[204:207], v6 offset:60416
v_mfma_f32_16x16x32_bf16 v[144:147], v[80:83], v[72:75], v[144:147]
v_mfma_f32_16x16x32_bf16 v[148:151], v[84:87], v[72:75], v[148:151]
v_mfma_f32_16x16x32_bf16 v[176:179], v[88:91], v[72:75], v[176:179]
v_mfma_f32_16x16x32_bf16 v[180:183], v[92:95], v[72:75], v[180:183]
v_mfma_f32_16x16x32_bf16 v[188:191], v[92:95], v[76:79], v[188:191]
v_mfma_f32_16x16x32_bf16 v[184:187], v[88:91], v[76:79], v[184:187]
v_mfma_f32_16x16x32_bf16 v[156:159], v[84:87], v[76:79], v[156:159]
v_mfma_f32_16x16x32_bf16 v[152:155], v[80:83], v[76:79], v[152:155]
s_waitcnt lgkmcnt(0)
s_barrier
v_mfma_f32_16x16x32_bf16 v[128:131], v[112:115], v[96:99], v[128:131]
ds_read_b128 v[32:35], v7 offset:16384
v_mfma_f32_16x16x32_bf16 v[132:135], v[116:119], v[96:99], v[132:135]
ds_read_b64_tr_b16 v[48:49], v25 offset:16384
v_mfma_f32_16x16x32_bf16 v[160:163], v[120:123], v[96:99], v[160:163]
ds_read_b64_tr_b16 v[50:51], v25 offset:20480
v_mfma_f32_16x16x32_bf16 v[164:167], v[124:127], v[96:99], v[164:167]
ds_read_b64_tr_b16 v[52:53], v26 offset:16384
v_mfma_f32_16x16x32_bf16 v[172:175], v[124:127], v[100:103], v[172:175]
ds_read_b64_tr_b16 v[54:55], v26 offset:20480
v_mfma_f32_16x16x32_bf16 v[168:171], v[120:123], v[100:103], v[168:171]
ds_read_b64_tr_b16 v[56:57], v27 offset:16384
v_mfma_f32_16x16x32_bf16 v[140:143], v[116:119], v[100:103], v[140:143]
ds_read_b64_tr_b16 v[58:59], v27 offset:20480
v_mfma_f32_16x16x32_bf16 v[136:139], v[112:115], v[100:103], v[136:139]
ds_read_b64_tr_b16 v[60:61], v28 offset:16384
v_mfma_f32_16x16x32_bf16 v[144:147], v[112:115], v[104:107], v[144:147]
ds_read_b64_tr_b16 v[62:63], v28 offset:20480
v_mfma_f32_16x16x32_bf16 v[148:151], v[116:119], v[104:107], v[148:151]
ds_read_b128 v[36:39], v7 offset:17408
v_mfma_f32_16x16x32_bf16 v[176:179], v[120:123], v[104:107], v[176:179]
ds_read_b128 v[40:43], v7 offset:18432
v_mfma_f32_16x16x32_bf16 v[180:183], v[124:127], v[104:107], v[180:183]
ds_read_b128 v[44:47], v7 offset:19456
v_mfma_f32_16x16x32_bf16 v[188:191], v[124:127], v[108:111], v[188:191]
ds_read_b128 v[64:67], v7 offset:24576
v_mfma_f32_16x16x32_bf16 v[184:187], v[120:123], v[108:111], v[184:187]
ds_read_b64_tr_b16 v[80:81], v25 offset:24576
v_mfma_f32_16x16x32_bf16 v[156:159], v[116:119], v[108:111], v[156:159]
ds_read_b64_tr_b16 v[82:83], v25 offset:28672
v_mfma_f32_16x16x32_bf16 v[152:155], v[112:115], v[108:111], v[152:155]
ds_read_b64_tr_b16 v[84:85], v26 offset:24576
v_mfma_f32_16x16x32_bf16 v[128:131], v[208:211], v[192:195], v[128:131]
ds_read_b64_tr_b16 v[86:87], v26 offset:28672
v_mfma_f32_16x16x32_bf16 v[132:135], v[212:215], v[192:195], v[132:135]
ds_read_b64_tr_b16 v[88:89], v27 offset:24576
v_mfma_f32_16x16x32_bf16 v[160:163], v[216:219], v[192:195], v[160:163]
ds_read_b64_tr_b16 v[90:91], v27 offset:28672
v_mfma_f32_16x16x32_bf16 v[164:167], v[220:223], v[192:195], v[164:167]
ds_read_b64_tr_b16 v[92:93], v28 offset:24576
v_mfma_f32_16x16x32_bf16 v[172:175], v[220:223], v[196:199], v[172:175]
ds_read_b64_tr_b16 v[94:95], v28 offset:28672
v_mfma_f32_16x16x32_bf16 v[168:171], v[216:219], v[196:199], v[168:171]
ds_read_b128 v[68:71], v7 offset:25600
v_mfma_f32_16x16x32_bf16 v[140:143], v[212:215], v[196:199], v[140:143]
ds_read_b128 v[72:75], v7 offset:26624
v_mfma_f32_16x16x32_bf16 v[136:139], v[208:211], v[196:199], v[136:139]
ds_read_b128 v[76:79], v7 offset:27648
v_mfma_f32_16x16x32_bf16 v[144:147], v[208:211], v[200:203], v[144:147]
v_mfma_f32_16x16x32_bf16 v[148:151], v[212:215], v[200:203], v[148:151]
v_mfma_f32_16x16x32_bf16 v[176:179], v[216:219], v[200:203], v[176:179]
v_mfma_f32_16x16x32_bf16 v[180:183], v[220:223], v[200:203], v[180:183]
v_mfma_f32_16x16x32_bf16 v[188:191], v[220:223], v[204:207], v[188:191]
v_mfma_f32_16x16x32_bf16 v[184:187], v[216:219], v[204:207], v[184:187]
v_mfma_f32_16x16x32_bf16 v[156:159], v[212:215], v[204:207], v[156:159]
v_mfma_f32_16x16x32_bf16 v[152:155], v[208:211], v[204:207], v[152:155]
s_waitcnt lgkmcnt(0)
s_barrier
v_mfma_f32_16x16x32_bf16 v[128:131], v[48:51], v[32:35], v[128:131]
ds_read_b128 v[96:99], v7 offset:32768
v_mfma_f32_16x16x32_bf16 v[132:135], v[52:55], v[32:35], v[132:135]
ds_read_b64_tr_b16 v[112:113], v13 offset:49152
v_mfma_f32_16x16x32_bf16 v[160:163], v[56:59], v[32:35], v[160:163]
ds_read_b64_tr_b16 v[114:115], v13 offset:53248
v_mfma_f32_16x16x32_bf16 v[164:167], v[60:63], v[32:35], v[164:167]
ds_read_b64_tr_b16 v[116:117], v14 offset:49152
v_mfma_f32_16x16x32_bf16 v[172:175], v[60:63], v[36:39], v[172:175]
ds_read_b64_tr_b16 v[118:119], v14 offset:53248
v_mfma_f32_16x16x32_bf16 v[168:171], v[56:59], v[36:39], v[168:171]
ds_read_b64_tr_b16 v[120:121], v15 offset:49152
v_mfma_f32_16x16x32_bf16 v[140:143], v[52:55], v[36:39], v[140:143]
ds_read_b64_tr_b16 v[122:123], v15 offset:53248
v_mfma_f32_16x16x32_bf16 v[136:139], v[48:51], v[36:39], v[136:139]
ds_read_b64_tr_b16 v[124:125], v16 offset:49152
v_mfma_f32_16x16x32_bf16 v[144:147], v[48:51], v[40:43], v[144:147]
ds_read_b64_tr_b16 v[126:127], v16 offset:53248
v_mfma_f32_16x16x32_bf16 v[148:151], v[52:55], v[40:43], v[148:151]
ds_read_b128 v[100:103], v7 offset:33792
v_mfma_f32_16x16x32_bf16 v[176:179], v[56:59], v[40:43], v[176:179]
ds_read_b128 v[104:107], v7 offset:34816
v_mfma_f32_16x16x32_bf16 v[180:183], v[60:63], v[40:43], v[180:183]
ds_read_b128 v[108:111], v7 offset:35840
v_mfma_f32_16x16x32_bf16 v[188:191], v[60:63], v[44:47], v[188:191]
ds_read_b128 v[192:195], v7 offset:40960
v_mfma_f32_16x16x32_bf16 v[184:187], v[56:59], v[44:47], v[184:187]
ds_read_b64_tr_b16 v[208:209], v13 offset:57344
v_mfma_f32_16x16x32_bf16 v[156:159], v[52:55], v[44:47], v[156:159]
ds_read_b64_tr_b16 v[210:211], v13 offset:61440
v_mfma_f32_16x16x32_bf16 v[152:155], v[48:51], v[44:47], v[152:155]
ds_read_b64_tr_b16 v[212:213], v14 offset:57344
v_mfma_f32_16x16x32_bf16 v[128:131], v[80:83], v[64:67], v[128:131]
ds_read_b64_tr_b16 v[214:215], v14 offset:61440
v_mfma_f32_16x16x32_bf16 v[132:135], v[84:87], v[64:67], v[132:135]
ds_read_b64_tr_b16 v[216:217], v15 offset:57344
v_mfma_f32_16x16x32_bf16 v[160:163], v[88:91], v[64:67], v[160:163]
ds_read_b64_tr_b16 v[218:219], v15 offset:61440
v_mfma_f32_16x16x32_bf16 v[164:167], v[92:95], v[64:67], v[164:167]
ds_read_b64_tr_b16 v[220:221], v16 offset:57344
v_mfma_f32_16x16x32_bf16 v[172:175], v[92:95], v[68:71], v[172:175]
ds_read_b64_tr_b16 v[222:223], v16 offset:61440
v_mfma_f32_16x16x32_bf16 v[168:171], v[88:91], v[68:71], v[168:171]
ds_read_b128 v[196:199], v7 offset:41984
v_mfma_f32_16x16x32_bf16 v[140:143], v[84:87], v[68:71], v[140:143]
ds_read_b128 v[200:203], v7 offset:43008
v_mfma_f32_16x16x32_bf16 v[136:139], v[80:83], v[68:71], v[136:139]
ds_read_b128 v[204:207], v7 offset:44032
v_mfma_f32_16x16x32_bf16 v[144:147], v[80:83], v[72:75], v[144:147]
v_mfma_f32_16x16x32_bf16 v[148:151], v[84:87], v[72:75], v[148:151]
v_mfma_f32_16x16x32_bf16 v[176:179], v[88:91], v[72:75], v[176:179]
v_mfma_f32_16x16x32_bf16 v[180:183], v[92:95], v[72:75], v[180:183]
v_mfma_f32_16x16x32_bf16 v[188:191], v[92:95], v[76:79], v[188:191]
v_mfma_f32_16x16x32_bf16 v[184:187], v[88:91], v[76:79], v[184:187]
v_mfma_f32_16x16x32_bf16 v[156:159], v[84:87], v[76:79], v[156:159]
v_mfma_f32_16x16x32_bf16 v[152:155], v[80:83], v[76:79], v[152:155]
s_waitcnt lgkmcnt(0)
s_barrier
v_mfma_f32_16x16x32_bf16 v[128:131], v[112:115], v[96:99], v[128:131]
ds_read_b128 v[32:35], v8 offset:0
v_mfma_f32_16x16x32_bf16 v[132:135], v[116:119], v[96:99], v[132:135]
ds_read_b64_tr_b16 v[48:49], v9 offset:0
v_mfma_f32_16x16x32_bf16 v[160:163], v[120:123], v[96:99], v[160:163]
ds_read_b64_tr_b16 v[50:51], v9 offset:4096
v_mfma_f32_16x16x32_bf16 v[164:167], v[124:127], v[96:99], v[164:167]
ds_read_b64_tr_b16 v[52:53], v10 offset:0
v_mfma_f32_16x16x32_bf16 v[172:175], v[124:127], v[100:103], v[172:175]
ds_read_b64_tr_b16 v[54:55], v10 offset:4096
v_mfma_f32_16x16x32_bf16 v[168:171], v[120:123], v[100:103], v[168:171]
ds_read_b64_tr_b16 v[56:57], v11 offset:0
v_mfma_f32_16x16x32_bf16 v[140:143], v[116:119], v[100:103], v[140:143]
ds_read_b64_tr_b16 v[58:59], v11 offset:4096
v_mfma_f32_16x16x32_bf16 v[136:139], v[112:115], v[100:103], v[136:139]
ds_read_b64_tr_b16 v[60:61], v12 offset:0
v_mfma_f32_16x16x32_bf16 v[144:147], v[112:115], v[104:107], v[144:147]
ds_read_b64_tr_b16 v[62:63], v12 offset:4096
v_mfma_f32_16x16x32_bf16 v[148:151], v[116:119], v[104:107], v[148:151]
ds_read_b128 v[36:39], v8 offset:1024
v_mfma_f32_16x16x32_bf16 v[176:179], v[120:123], v[104:107], v[176:179]
ds_read_b128 v[40:43], v8 offset:2048
v_mfma_f32_16x16x32_bf16 v[180:183], v[124:127], v[104:107], v[180:183]
ds_read_b128 v[44:47], v8 offset:3072
v_mfma_f32_16x16x32_bf16 v[188:191], v[124:127], v[108:111], v[188:191]
ds_read_b128 v[64:67], v8 offset:8192
v_mfma_f32_16x16x32_bf16 v[184:187], v[120:123], v[108:111], v[184:187]
ds_read_b64_tr_b16 v[80:81], v9 offset:8192
v_mfma_f32_16x16x32_bf16 v[156:159], v[116:119], v[108:111], v[156:159]
ds_read_b64_tr_b16 v[82:83], v9 offset:12288
v_mfma_f32_16x16x32_bf16 v[152:155], v[112:115], v[108:111], v[152:155]
ds_read_b64_tr_b16 v[84:85], v10 offset:8192
v_mfma_f32_16x16x32_bf16 v[128:131], v[208:211], v[192:195], v[128:131]
ds_read_b64_tr_b16 v[86:87], v10 offset:12288
v_mfma_f32_16x16x32_bf16 v[132:135], v[212:215], v[192:195], v[132:135]
ds_read_b64_tr_b16 v[88:89], v11 offset:8192
v_mfma_f32_16x16x32_bf16 v[160:163], v[216:219], v[192:195], v[160:163]
ds_read_b64_tr_b16 v[90:91], v11 offset:12288
v_mfma_f32_16x16x32_bf16 v[164:167], v[220:223], v[192:195], v[164:167]
ds_read_b64_tr_b16 v[92:93], v12 offset:8192
v_mfma_f32_16x16x32_bf16 v[172:175], v[220:223], v[196:199], v[172:175]
ds_read_b64_tr_b16 v[94:95], v12 offset:12288
v_mfma_f32_16x16x32_bf16 v[168:171], v[216:219], v[196:199], v[168:171]
ds_read_b128 v[68:71], v8 offset:9216
v_mfma_f32_16x16x32_bf16 v[140:143], v[212:215], v[196:199], v[140:143]
ds_read_b128 v[72:75], v8 offset:10240
v_mfma_f32_16x16x32_bf16 v[136:139], v[208:211], v[196:199], v[136:139]
ds_read_b128 v[76:79], v8 offset:11264
v_mfma_f32_16x16x32_bf16 v[144:147], v[208:211], v[200:203], v[144:147]
v_mfma_f32_16x16x32_bf16 v[148:151], v[212:215], v[200:203], v[148:151]
v_mfma_f32_16x16x32_bf16 v[176:179], v[216:219], v[200:203], v[176:179]
v_mfma_f32_16x16x32_bf16 v[180:183], v[220:223], v[200:203], v[180:183]
v_mfma_f32_16x16x32_bf16 v[188:191], v[220:223], v[204:207], v[188:191]
v_mfma_f32_16x16x32_bf16 v[184:187], v[216:219], v[204:207], v[184:187]
v_mfma_f32_16x16x32_bf16 v[156:159], v[212:215], v[204:207], v[156:159]
v_mfma_f32_16x16x32_bf16 v[152:155], v[208:211], v[204:207], v[152:155]
s_waitcnt lgkmcnt(0)
s_barrier
v_mfma_f32_16x16x32_bf16 v[128:131], v[48:51], v[32:35], v[128:131]
ds_read_b128 v[96:99], v6 offset:16384
v_mfma_f32_16x16x32_bf16 v[132:135], v[52:55], v[32:35], v[132:135]
ds_read_b64_tr_b16 v[112:113], v9 offset:32768
v_mfma_f32_16x16x32_bf16 v[160:163], v[56:59], v[32:35], v[160:163]
ds_read_b64_tr_b16 v[114:115], v9 offset:36864
v_mfma_f32_16x16x32_bf16 v[164:167], v[60:63], v[32:35], v[164:167]
ds_read_b64_tr_b16 v[116:117], v10 offset:32768
v_mfma_f32_16x16x32_bf16 v[172:175], v[60:63], v[36:39], v[172:175]
ds_read_b64_tr_b16 v[118:119], v10 offset:36864
v_mfma_f32_16x16x32_bf16 v[168:171], v[56:59], v[36:39], v[168:171]
ds_read_b64_tr_b16 v[120:121], v11 offset:32768
v_mfma_f32_16x16x32_bf16 v[140:143], v[52:55], v[36:39], v[140:143]
ds_read_b64_tr_b16 v[122:123], v11 offset:36864
v_mfma_f32_16x16x32_bf16 v[136:139], v[48:51], v[36:39], v[136:139]
ds_read_b64_tr_b16 v[124:125], v12 offset:32768
v_mfma_f32_16x16x32_bf16 v[144:147], v[48:51], v[40:43], v[144:147]
ds_read_b64_tr_b16 v[126:127], v12 offset:36864
v_mfma_f32_16x16x32_bf16 v[148:151], v[52:55], v[40:43], v[148:151]
ds_read_b128 v[100:103], v6 offset:17408
v_mfma_f32_16x16x32_bf16 v[176:179], v[56:59], v[40:43], v[176:179]
ds_read_b128 v[104:107], v6 offset:18432
v_mfma_f32_16x16x32_bf16 v[180:183], v[60:63], v[40:43], v[180:183]
ds_read_b128 v[108:111], v6 offset:19456
v_mfma_f32_16x16x32_bf16 v[188:191], v[60:63], v[44:47], v[188:191]
ds_read_b128 v[192:195], v6 offset:24576
v_mfma_f32_16x16x32_bf16 v[184:187], v[56:59], v[44:47], v[184:187]
ds_read_b64_tr_b16 v[208:209], v9 offset:40960
v_mfma_f32_16x16x32_bf16 v[156:159], v[52:55], v[44:47], v[156:159]
ds_read_b64_tr_b16 v[210:211], v9 offset:45056
v_mfma_f32_16x16x32_bf16 v[152:155], v[48:51], v[44:47], v[152:155]
ds_read_b64_tr_b16 v[212:213], v10 offset:40960
v_mfma_f32_16x16x32_bf16 v[128:131], v[80:83], v[64:67], v[128:131]
ds_read_b64_tr_b16 v[214:215], v10 offset:45056
v_mfma_f32_16x16x32_bf16 v[132:135], v[84:87], v[64:67], v[132:135]
ds_read_b64_tr_b16 v[216:217], v11 offset:40960
v_mfma_f32_16x16x32_bf16 v[160:163], v[88:91], v[64:67], v[160:163]
ds_read_b64_tr_b16 v[218:219], v11 offset:45056
v_mfma_f32_16x16x32_bf16 v[164:167], v[92:95], v[64:67], v[164:167]
ds_read_b64_tr_b16 v[220:221], v12 offset:40960
v_mfma_f32_16x16x32_bf16 v[172:175], v[92:95], v[68:71], v[172:175]
ds_read_b64_tr_b16 v[222:223], v12 offset:45056
v_mfma_f32_16x16x32_bf16 v[168:171], v[88:91], v[68:71], v[168:171]
ds_read_b128 v[196:199], v6 offset:25600
v_mfma_f32_16x16x32_bf16 v[140:143], v[84:87], v[68:71], v[140:143]
ds_read_b128 v[200:203], v6 offset:26624
v_mfma_f32_16x16x32_bf16 v[136:139], v[80:83], v[68:71], v[136:139]
ds_read_b128 v[204:207], v6 offset:27648
v_mfma_f32_16x16x32_bf16 v[144:147], v[80:83], v[72:75], v[144:147]
v_mfma_f32_16x16x32_bf16 v[148:151], v[84:87], v[72:75], v[148:151]
v_mfma_f32_16x16x32_bf16 v[176:179], v[88:91], v[72:75], v[176:179]
v_mfma_f32_16x16x32_bf16 v[180:183], v[92:95], v[72:75], v[180:183]
v_mfma_f32_16x16x32_bf16 v[188:191], v[92:95], v[76:79], v[188:191]
v_mfma_f32_16x16x32_bf16 v[184:187], v[88:91], v[76:79], v[184:187]
v_mfma_f32_16x16x32_bf16 v[156:159], v[84:87], v[76:79], v[156:159]
v_mfma_f32_16x16x32_bf16 v[152:155], v[80:83], v[76:79], v[152:155]
s_waitcnt lgkmcnt(0)
s_barrier
v_mfma_f32_16x16x32_bf16 v[128:131], v[112:115], v[96:99], v[128:131]
ds_read_b128 v[32:35], v6 offset:49152
v_mfma_f32_16x16x32_bf16 v[132:135], v[116:119], v[96:99], v[132:135]
ds_read_b64_tr_b16 v[48:49], v13 offset:0
v_mfma_f32_16x16x32_bf16 v[160:163], v[120:123], v[96:99], v[160:163]
ds_read_b64_tr_b16 v[50:51], v13 offset:4096
v_mfma_f32_16x16x32_bf16 v[164:167], v[124:127], v[96:99], v[164:167]
ds_read_b64_tr_b16 v[52:53], v14 offset:0
v_mfma_f32_16x16x32_bf16 v[172:175], v[124:127], v[100:103], v[172:175]
ds_read_b64_tr_b16 v[54:55], v14 offset:4096
v_mfma_f32_16x16x32_bf16 v[168:171], v[120:123], v[100:103], v[168:171]
ds_read_b64_tr_b16 v[56:57], v15 offset:0
v_mfma_f32_16x16x32_bf16 v[140:143], v[116:119], v[100:103], v[140:143]
ds_read_b64_tr_b16 v[58:59], v15 offset:4096
v_mfma_f32_16x16x32_bf16 v[136:139], v[112:115], v[100:103], v[136:139]
ds_read_b64_tr_b16 v[60:61], v16 offset:0
v_mfma_f32_16x16x32_bf16 v[144:147], v[112:115], v[104:107], v[144:147]
ds_read_b64_tr_b16 v[62:63], v16 offset:4096
v_mfma_f32_16x16x32_bf16 v[148:151], v[116:119], v[104:107], v[148:151]
ds_read_b128 v[36:39], v6 offset:50176
v_mfma_f32_16x16x32_bf16 v[176:179], v[120:123], v[104:107], v[176:179]
ds_read_b128 v[40:43], v6 offset:51200
v_mfma_f32_16x16x32_bf16 v[180:183], v[124:127], v[104:107], v[180:183]
ds_read_b128 v[44:47], v6 offset:52224
v_mfma_f32_16x16x32_bf16 v[188:191], v[124:127], v[108:111], v[188:191]
ds_read_b128 v[64:67], v6 offset:57344
v_mfma_f32_16x16x32_bf16 v[184:187], v[120:123], v[108:111], v[184:187]
ds_read_b64_tr_b16 v[80:81], v13 offset:8192
v_mfma_f32_16x16x32_bf16 v[156:159], v[116:119], v[108:111], v[156:159]
ds_read_b64_tr_b16 v[82:83], v13 offset:12288
v_mfma_f32_16x16x32_bf16 v[152:155], v[112:115], v[108:111], v[152:155]
ds_read_b64_tr_b16 v[84:85], v14 offset:8192
v_mfma_f32_16x16x32_bf16 v[128:131], v[208:211], v[192:195], v[128:131]
ds_read_b64_tr_b16 v[86:87], v14 offset:12288
v_mfma_f32_16x16x32_bf16 v[132:135], v[212:215], v[192:195], v[132:135]
ds_read_b64_tr_b16 v[88:89], v15 offset:8192
v_mfma_f32_16x16x32_bf16 v[160:163], v[216:219], v[192:195], v[160:163]
ds_read_b64_tr_b16 v[90:91], v15 offset:12288
v_mfma_f32_16x16x32_bf16 v[164:167], v[220:223], v[192:195], v[164:167]
ds_read_b64_tr_b16 v[92:93], v16 offset:8192
v_mfma_f32_16x16x32_bf16 v[172:175], v[220:223], v[196:199], v[172:175]
ds_read_b64_tr_b16 v[94:95], v16 offset:12288
v_mfma_f32_16x16x32_bf16 v[168:171], v[216:219], v[196:199], v[168:171]
ds_read_b128 v[68:71], v6 offset:58368
v_mfma_f32_16x16x32_bf16 v[140:143], v[212:215], v[196:199], v[140:143]
ds_read_b128 v[72:75], v6 offset:59392
v_mfma_f32_16x16x32_bf16 v[136:139], v[208:211], v[196:199], v[136:139]
ds_read_b128 v[76:79], v6 offset:60416
v_mfma_f32_16x16x32_bf16 v[144:147], v[208:211], v[200:203], v[144:147]
v_mfma_f32_16x16x32_bf16 v[148:151], v[212:215], v[200:203], v[148:151]
v_mfma_f32_16x16x32_bf16 v[176:179], v[216:219], v[200:203], v[176:179]
v_mfma_f32_16x16x32_bf16 v[180:183], v[220:223], v[200:203], v[180:183]
v_mfma_f32_16x16x32_bf16 v[188:191], v[220:223], v[204:207], v[188:191]
v_mfma_f32_16x16x32_bf16 v[184:187], v[216:219], v[204:207], v[184:187]
v_mfma_f32_16x16x32_bf16 v[156:159], v[212:215], v[204:207], v[156:159]
v_mfma_f32_16x16x32_bf16 v[152:155], v[208:211], v[204:207], v[152:155]
s_waitcnt lgkmcnt(0)
s_barrier
v_mfma_f32_16x16x32_bf16 v[128:131], v[48:51], v[32:35], v[128:131]
ds_read_b128 v[96:99], v7 offset:16384
v_mfma_f32_16x16x32_bf16 v[132:135], v[52:55], v[32:35], v[132:135]
ds_read_b64_tr_b16 v[112:113], v25 offset:16384
v_mfma_f32_16x16x32_bf16 v[160:163], v[56:59], v[32:35], v[160:163]
ds_read_b64_tr_b16 v[114:115], v25 offset:20480
v_mfma_f32_16x16x32_bf16 v[164:167], v[60:63], v[32:35], v[164:167]
ds_read_b64_tr_b16 v[116:117], v26 offset:16384
v_mfma_f32_16x16x32_bf16 v[172:175], v[60:63], v[36:39], v[172:175]
ds_read_b64_tr_b16 v[118:119], v26 offset:20480
v_mfma_f32_16x16x32_bf16 v[168:171], v[56:59], v[36:39], v[168:171]
ds_read_b64_tr_b16 v[120:121], v27 offset:16384
v_mfma_f32_16x16x32_bf16 v[140:143], v[52:55], v[36:39], v[140:143]
ds_read_b64_tr_b16 v[122:123], v27 offset:20480
v_mfma_f32_16x16x32_bf16 v[136:139], v[48:51], v[36:39], v[136:139]
ds_read_b64_tr_b16 v[124:125], v28 offset:16384
v_mfma_f32_16x16x32_bf16 v[144:147], v[48:51], v[40:43], v[144:147]
ds_read_b64_tr_b16 v[126:127], v28 offset:20480
v_mfma_f32_16x16x32_bf16 v[148:151], v[52:55], v[40:43], v[148:151]
ds_read_b128 v[100:103], v7 offset:17408
v_mfma_f32_16x16x32_bf16 v[176:179], v[56:59], v[40:43], v[176:179]
ds_read_b128 v[104:107], v7 offset:18432
v_mfma_f32_16x16x32_bf16 v[180:183], v[60:63], v[40:43], v[180:183]
ds_read_b128 v[108:111], v7 offset:19456
v_mfma_f32_16x16x32_bf16 v[188:191], v[60:63], v[44:47], v[188:191]
ds_read_b128 v[192:195], v7 offset:24576
v_mfma_f32_16x16x32_bf16 v[184:187], v[56:59], v[44:47], v[184:187]
ds_read_b64_tr_b16 v[208:209], v25 offset:24576
v_mfma_f32_16x16x32_bf16 v[156:159], v[52:55], v[44:47], v[156:159]
ds_read_b64_tr_b16 v[210:211], v25 offset:28672
v_mfma_f32_16x16x32_bf16 v[152:155], v[48:51], v[44:47], v[152:155]
ds_read_b64_tr_b16 v[212:213], v26 offset:24576
v_mfma_f32_16x16x32_bf16 v[128:131], v[80:83], v[64:67], v[128:131]
ds_read_b64_tr_b16 v[214:215], v26 offset:28672
v_mfma_f32_16x16x32_bf16 v[132:135], v[84:87], v[64:67], v[132:135]
ds_read_b64_tr_b16 v[216:217], v27 offset:24576
v_mfma_f32_16x16x32_bf16 v[160:163], v[88:91], v[64:67], v[160:163]
ds_read_b64_tr_b16 v[218:219], v27 offset:28672
v_mfma_f32_16x16x32_bf16 v[164:167], v[92:95], v[64:67], v[164:167]
ds_read_b64_tr_b16 v[220:221], v28 offset:24576
v_mfma_f32_16x16x32_bf16 v[172:175], v[92:95], v[68:71], v[172:175]
ds_read_b64_tr_b16 v[222:223], v28 offset:28672
v_mfma_f32_16x16x32_bf16 v[168:171], v[88:91], v[68:71], v[168:171]
ds_read_b128 v[196:199], v7 offset:25600
v_mfma_f32_16x16x32_bf16 v[140:143], v[84:87], v[68:71], v[140:143]
ds_read_b128 v[200:203], v7 offset:26624
v_mfma_f32_16x16x32_bf16 v[136:139], v[80:83], v[68:71], v[136:139]
ds_read_b128 v[204:207], v7 offset:27648
v_mfma_f32_16x16x32_bf16 v[144:147], v[80:83], v[72:75], v[144:147]
v_mfma_f32_16x16x32_bf16 v[148:151], v[84:87], v[72:75], v[148:151]
v_mfma_f32_16x16x32_bf16 v[176:179], v[88:91], v[72:75], v[176:179]
v_mfma_f32_16x16x32_bf16 v[180:183], v[92:95], v[72:75], v[180:183]
v_mfma_f32_16x16x32_bf16 v[188:191], v[92:95], v[76:79], v[188:191]
v_mfma_f32_16x16x32_bf16 v[184:187], v[88:91], v[76:79], v[184:187]
v_mfma_f32_16x16x32_bf16 v[156:159], v[84:87], v[76:79], v[156:159]
v_mfma_f32_16x16x32_bf16 v[152:155], v[80:83], v[76:79], v[152:155]
s_waitcnt lgkmcnt(0)
s_barrier
v_mfma_f32_16x16x32_bf16 v[128:131], v[112:115], v[96:99], v[128:131]
ds_read_b128 v[32:35], v7 offset:32768
v_mfma_f32_16x16x32_bf16 v[132:135], v[116:119], v[96:99], v[132:135]
ds_read_b64_tr_b16 v[48:49], v13 offset:49152
v_mfma_f32_16x16x32_bf16 v[160:163], v[120:123], v[96:99], v[160:163]
ds_read_b64_tr_b16 v[50:51], v13 offset:53248
v_mfma_f32_16x16x32_bf16 v[164:167], v[124:127], v[96:99], v[164:167]
ds_read_b64_tr_b16 v[52:53], v14 offset:49152
v_mfma_f32_16x16x32_bf16 v[172:175], v[124:127], v[100:103], v[172:175]
ds_read_b64_tr_b16 v[54:55], v14 offset:53248
v_mfma_f32_16x16x32_bf16 v[168:171], v[120:123], v[100:103], v[168:171]
ds_read_b64_tr_b16 v[56:57], v15 offset:49152
v_mfma_f32_16x16x32_bf16 v[140:143], v[116:119], v[100:103], v[140:143]
ds_read_b64_tr_b16 v[58:59], v15 offset:53248
v_mfma_f32_16x16x32_bf16 v[136:139], v[112:115], v[100:103], v[136:139]
ds_read_b64_tr_b16 v[60:61], v16 offset:49152
v_mfma_f32_16x16x32_bf16 v[144:147], v[112:115], v[104:107], v[144:147]
ds_read_b64_tr_b16 v[62:63], v16 offset:53248
v_mfma_f32_16x16x32_bf16 v[148:151], v[116:119], v[104:107], v[148:151]
ds_read_b128 v[36:39], v7 offset:33792
v_mfma_f32_16x16x32_bf16 v[176:179], v[120:123], v[104:107], v[176:179]
ds_read_b128 v[40:43], v7 offset:34816
v_mfma_f32_16x16x32_bf16 v[180:183], v[124:127], v[104:107], v[180:183]
ds_read_b128 v[44:47], v7 offset:35840
v_mfma_f32_16x16x32_bf16 v[188:191], v[124:127], v[108:111], v[188:191]
ds_read_b128 v[64:67], v7 offset:40960
v_mfma_f32_16x16x32_bf16 v[184:187], v[120:123], v[108:111], v[184:187]
ds_read_b64_tr_b16 v[80:81], v13 offset:57344
v_mfma_f32_16x16x32_bf16 v[156:159], v[116:119], v[108:111], v[156:159]
ds_read_b64_tr_b16 v[82:83], v13 offset:61440
v_mfma_f32_16x16x32_bf16 v[152:155], v[112:115], v[108:111], v[152:155]
ds_read_b64_tr_b16 v[84:85], v14 offset:57344
v_mfma_f32_16x16x32_bf16 v[128:131], v[208:211], v[192:195], v[128:131]
ds_read_b64_tr_b16 v[86:87], v14 offset:61440
v_mfma_f32_16x16x32_bf16 v[132:135], v[212:215], v[192:195], v[132:135]
ds_read_b64_tr_b16 v[88:89], v15 offset:57344
v_mfma_f32_16x16x32_bf16 v[160:163], v[216:219], v[192:195], v[160:163]
ds_read_b64_tr_b16 v[90:91], v15 offset:61440
v_mfma_f32_16x16x32_bf16 v[164:167], v[220:223], v[192:195], v[164:167]
ds_read_b64_tr_b16 v[92:93], v16 offset:57344
v_mfma_f32_16x16x32_bf16 v[172:175], v[220:223], v[196:199], v[172:175]
ds_read_b64_tr_b16 v[94:95], v16 offset:61440
v_mfma_f32_16x16x32_bf16 v[168:171], v[216:219], v[196:199], v[168:171]
ds_read_b128 v[68:71], v7 offset:41984
v_mfma_f32_16x16x32_bf16 v[140:143], v[212:215], v[196:199], v[140:143]
ds_read_b128 v[72:75], v7 offset:43008
v_mfma_f32_16x16x32_bf16 v[136:139], v[208:211], v[196:199], v[136:139]
ds_read_b128 v[76:79], v7 offset:44032
v_mfma_f32_16x16x32_bf16 v[144:147], v[208:211], v[200:203], v[144:147]
v_mfma_f32_16x16x32_bf16 v[148:151], v[212:215], v[200:203], v[148:151]
v_mfma_f32_16x16x32_bf16 v[176:179], v[216:219], v[200:203], v[176:179]
v_mfma_f32_16x16x32_bf16 v[180:183], v[220:223], v[200:203], v[180:183]
v_mfma_f32_16x16x32_bf16 v[188:191], v[220:223], v[204:207], v[188:191]
v_mfma_f32_16x16x32_bf16 v[184:187], v[216:219], v[204:207], v[184:187]
v_mfma_f32_16x16x32_bf16 v[156:159], v[212:215], v[204:207], v[156:159]
v_mfma_f32_16x16x32_bf16 v[152:155], v[208:211], v[204:207], v[152:155]
s_waitcnt lgkmcnt(0)
s_barrier
v_mfma_f32_16x16x32_bf16 v[128:131], v[48:51], v[32:35], v[128:131]
ds_read_b128 v[96:99], v8 offset:0
v_mfma_f32_16x16x32_bf16 v[132:135], v[52:55], v[32:35], v[132:135]
ds_read_b64_tr_b16 v[112:113], v9 offset:0
v_mfma_f32_16x16x32_bf16 v[160:163], v[56:59], v[32:35], v[160:163]
ds_read_b64_tr_b16 v[114:115], v9 offset:4096
v_mfma_f32_16x16x32_bf16 v[164:167], v[60:63], v[32:35], v[164:167]
ds_read_b64_tr_b16 v[116:117], v10 offset:0
v_mfma_f32_16x16x32_bf16 v[172:175], v[60:63], v[36:39], v[172:175]
ds_read_b64_tr_b16 v[118:119], v10 offset:4096
v_mfma_f32_16x16x32_bf16 v[168:171], v[56:59], v[36:39], v[168:171]
ds_read_b64_tr_b16 v[120:121], v11 offset:0
v_mfma_f32_16x16x32_bf16 v[140:143], v[52:55], v[36:39], v[140:143]
s_branch Lov_12
.p2align 12
.fill 96, 4, 0xbf800000
Lst_12_0:
s_branch Lwr_158
Lst_12_1:
s_branch Lst_16_0
s_nop 0
Lov_12:
ds_read_b64_tr_b16 v[122:123], v11 offset:4096
v_mfma_f32_16x16x32_bf16 v[136:139], v[48:51], v[36:39], v[136:139]
ds_read_b64_tr_b16 v[124:125], v12 offset:0
v_mfma_f32_16x16x32_bf16 v[144:147], v[48:51], v[40:43], v[144:147]
ds_read_b64_tr_b16 v[126:127], v12 offset:4096
v_mfma_f32_16x16x32_bf16 v[148:151], v[52:55], v[40:43], v[148:151]
ds_read_b128 v[100:103], v8 offset:1024
v_mfma_f32_16x16x32_bf16 v[176:179], v[56:59], v[40:43], v[176:179]
ds_read_b128 v[104:107], v8 offset:2048
v_mfma_f32_16x16x32_bf16 v[180:183], v[60:63], v[40:43], v[180:183]
ds_read_b128 v[108:111], v8 offset:3072
v_mfma_f32_16x16x32_bf16 v[188:191], v[60:63], v[44:47], v[188:191]
ds_read_b128 v[192:195], v8 offset:8192
v_mfma_f32_16x16x32_bf16 v[184:187], v[56:59], v[44:47], v[184:187]
ds_read_b64_tr_b16 v[208:209], v9 offset:8192
v_mfma_f32_16x16x32_bf16 v[156:159], v[52:55], v[44:47], v[156:159]
ds_read_b64_tr_b16 v[210:211], v9 offset:12288
v_mfma_f32_16x16x32_bf16 v[152:155], v[48:51], v[44:47], v[152:155]
ds_read_b64_tr_b16 v[212:213], v10 offset:8192
v_mfma_f32_16x16x32_bf16 v[128:131], v[80:83], v[64:67], v[128:131]
ds_read_b64_tr_b16 v[214:215], v10 offset:12288
v_mfma_f32_16x16x32_bf16 v[132:135], v[84:87], v[64:67], v[132:135]
ds_read_b64_tr_b16 v[216:217], v11 offset:8192
v_mfma_f32_16x16x32_bf16 v[160:163], v[88:91], v[64:67], v[160:163]
ds_read_b64_tr_b16 v[218:219], v11 offset:12288
v_mfma_f32_16x16x32_bf16 v[164:167], v[92:95], v[64:67], v[164:167]
ds_read_b64_tr_b16 v[220:221], v12 offset:8192
v_mfma_f32_16x16x32_bf16 v[172:175], v[92:95], v[68:71], v[172:175]
ds_read_b64_tr_b16 v[222:223], v12 offset:12288
v_mfma_f32_16x16x32_bf16 v[168:171], v[88:91], v[68:71], v[168:171]
ds_read_b128 v[196:199], v8 offset:9216
v_mfma_f32_16x16x32_bf16 v[140:143], v[84:87], v[68:71], v[140:143]
ds_read_b128 v[200:203], v8 offset:10240
v_mfma_f32_16x16x32_bf16 v[136:139], v[80:83], v[68:71], v[136:139]
ds_read_b128 v[204:207], v8 offset:11264
v_mfma_f32_16x16x32_bf16 v[144:147], v[80:83], v[72:75], v[144:147]
v_mfma_f32_16x16x32_bf16 v[148:151], v[84:87], v[72:75], v[148:151]
v_mfma_f32_16x16x32_bf16 v[176:179], v[88:91], v[72:75], v[176:179]
v_mfma_f32_16x16x32_bf16 v[180:183], v[92:95], v[72:75], v[180:183]
v_mfma_f32_16x16x32_bf16 v[188:191], v[92:95], v[76:79], v[188:191]
v_mfma_f32_16x16x32_bf16 v[184:187], v[88:91], v[76:79], v[184:187]
v_mfma_f32_16x16x32_bf16 v[156:159], v[84:87], v[76:79], v[156:159]
v_mfma_f32_16x16x32_bf16 v[152:155], v[80:83], v[76:79], v[152:155]
s_sub_u32 s41, s41, 1
s_cmp_lg_u32 s41, 0
s_cbranch_scc1 Lk4_122
s_waitcnt lgkmcnt(0)
s_barrier
v_mfma_f32_16x16x32_bf16 v[128:131], v[112:115], v[96:99], v[128:131]
ds_read_b128 v[32:35], v6 offset:16384
v_mfma_f32_16x16x32_bf16 v[132:135], v[116:119], v[96:99], v[132:135]
ds_read_b64_tr_b16 v[48:49], v224 offset:32768
v_mfma_f32_16x16x32_bf16 v[160:163], v[120:123], v[96:99], v[160:163]
ds_read_b64_tr_b16 v[50:51], v224 offset:34816
v_mfma_f32_16x16x32_bf16 v[164:167], v[124:127], v[96:99], v[164:167]
ds_read_b64_tr_b16 v[52:53], v225 offset:32768
v_mfma_f32_16x16x32_bf16 v[172:175], v[124:127], v[100:103], v[172:175]
ds_read_b64_tr_b16 v[54:55], v225 offset:34816
v_mfma_f32_16x16x32_bf16 v[168:171], v[120:123], v[100:103], v[168:171]
ds_read_b128 v[36:39], v6 offset:17408
v_mfma_f32_16x16x32_bf16 v[140:143], v[116:119], v[100:103], v[140:143]
ds_read_b128 v[40:43], v6 offset:18432
v_mfma_f32_16x16x32_bf16 v[136:139], v[112:115], v[100:103], v[136:139]
ds_read_b128 v[44:47], v6 offset:19456
v_mfma_f32_16x16x32_bf16 v[144:147], v[112:115], v[104:107], v[144:147]
ds_read_b128 v[64:67], v6 offset:24576
v_mfma_f32_16x16x32_bf16 v[148:151], v[116:119], v[104:107], v[148:151]
ds_read_b64_tr_b16 v[80:81], v224 offset:36864
v_mfma_f32_16x16x32_bf16 v[176:179], v[120:123], v[104:107], v[176:179]
ds_read_b64_tr_b16 v[82:83], v224 offset:38912
v_mfma_f32_16x16x32_bf16 v[180:183], v[124:127], v[104:107], v[180:183]
ds_read_b64_tr_b16 v[84:85], v225 offset:36864
v_mfma_f32_16x16x32_bf16 v[188:191], v[124:127], v[108:111], v[188:191]
ds_read_b64_tr_b16 v[86:87], v225 offset:38912
v_mfma_f32_16x16x32_bf16 v[184:187], v[120:123], v[108:111], v[184:187]
ds_read_b128 v[68:71], v6 offset:25600
v_mfma_f32_16x16x32_bf16 v[156:159], v[116:119], v[108:111], v[156:159]
ds_read_b128 v[72:75], v6 offset:26624
v_mfma_f32_16x16x32_bf16 v[152:155], v[112:115], v[108:111], v[152:155]
ds_read_b128 v[76:79], v6 offset:27648
v_mfma_f32_16x16x32_bf16 v[128:131], v[208:211], v[192:195], v[128:131]
v_mfma_f32_16x16x32_bf16 v[132:135], v[212:215], v[192:195], v[132:135]
v_mfma_f32_16x16x32_bf16 v[160:163], v[216:219], v[192:195], v[160:163]
v_mfma_f32_16x16x32_bf16 v[164:167], v[220:223], v[192:195], v[164:167]
v_mfma_f32_16x16x32_bf16 v[172:175], v[220:223], v[196:199], v[172:175]
v_mfma_f32_16x16x32_bf16 v[168:171], v[216:219], v[196:199], v[168:171]
v_mfma_f32_16x16x32_bf16 v[140:143], v[212:215], v[196:199], v[140:143]
v_mfma_f32_16x16x32_bf16 v[136:139], v[208:211], v[196:199], v[136:139]
v_mfma_f32_16x16x32_bf16 v[144:147], v[208:211], v[200:203], v[144:147]
v_mfma_f32_16x16x32_bf16 v[148:151], v[212:215], v[200:203], v[148:151]
v_mfma_f32_16x16x32_bf16 v[176:179], v[216:219], v[200:203], v[176:179]
v_mfma_f32_16x16x32_bf16 v[180:183], v[220:223], v[200:203], v[180:183]
v_mfma_f32_16x16x32_bf16 v[188:191], v[220:223], v[204:207], v[188:191]
v_mfma_f32_16x16x32_bf16 v[184:187], v[216:219], v[204:207], v[184:187]
v_mfma_f32_16x16x32_bf16 v[156:159], v[212:215], v[204:207], v[156:159]
v_mfma_f32_16x16x32_bf16 v[152:155], v[208:211], v[204:207], v[152:155]
s_waitcnt lgkmcnt(0)
s_barrier
v_mfma_f32_16x16x32_bf16 v[128:131], v[48:51], v[32:35], v[128:131]
ds_read_b128 v[96:99], v6 offset:49152
ds_read_b64_tr_b16 v[112:113], v226 offset:0
v_mfma_f32_16x16x32_bf16 v[132:135], v[52:55], v[32:35], v[132:135]
ds_read_b64_tr_b16 v[114:115], v226 offset:2048
ds_read_b64_tr_b16 v[116:117], v227 offset:0
v_mfma_f32_16x16x32_bf16 v[140:143], v[52:55], v[36:39], v[140:143]
ds_read_b64_tr_b16 v[118:119], v227 offset:2048
ds_read_b128 v[100:103], v6 offset:50176
v_mfma_f32_16x16x32_bf16 v[136:139], v[48:51], v[36:39], v[136:139]
ds_read_b128 v[104:107], v6 offset:51200
ds_read_b128 v[108:111], v6 offset:52224
v_mfma_f32_16x16x32_bf16 v[144:147], v[48:51], v[40:43], v[144:147]
ds_read_b128 v[192:195], v6 offset:57344
v_mfma_f32_16x16x32_bf16 v[148:151], v[52:55], v[40:43], v[148:151]
ds_read_b64_tr_b16 v[208:209], v226 offset:4096
v_mfma_f32_16x16x32_bf16 v[156:159], v[52:55], v[44:47], v[156:159]
ds_read_b64_tr_b16 v[210:211], v226 offset:6144
v_cvt_pk_bf16_f32 v160, v160, v161
v_cvt_pk_bf16_f32 v161, v162, v163
v_mfma_f32_16x16x32_bf16 v[152:155], v[48:51], v[44:47], v[152:155]
ds_read_b64_tr_b16 v[212:213], v227 offset:4096
v_cvt_pk_bf16_f32 v162, v164, v165
v_cvt_pk_bf16_f32 v163, v166, v167
v_mfma_f32_16x16x32_bf16 v[128:131], v[80:83], v[64:67], v[128:131]
ds_read_b64_tr_b16 v[214:215], v227 offset:6144
v_cvt_pk_bf16_f32 v164, v168, v169
v_cvt_pk_bf16_f32 v165, v170, v171
v_mfma_f32_16x16x32_bf16 v[132:135], v[84:87], v[64:67], v[132:135]
ds_read_b128 v[196:199], v6 offset:58368
v_cvt_pk_bf16_f32 v166, v172, v173
v_cvt_pk_bf16_f32 v167, v174, v175
v_mfma_f32_16x16x32_bf16 v[140:143], v[84:87], v[68:71], v[140:143]
ds_read_b128 v[200:203], v6 offset:59392
v_cvt_pk_bf16_f32 v168, v176, v177
v_cvt_pk_bf16_f32 v169, v178, v179
v_mfma_f32_16x16x32_bf16 v[136:139], v[80:83], v[68:71], v[136:139]
ds_read_b128 v[204:207], v6 offset:60416
v_cvt_pk_bf16_f32 v170, v180, v181
v_cvt_pk_bf16_f32 v171, v182, v183
v_mfma_f32_16x16x32_bf16 v[144:147], v[80:83], v[72:75], v[144:147]
v_cvt_pk_bf16_f32 v172, v184, v185
v_cvt_pk_bf16_f32 v173, v186, v187
v_mfma_f32_16x16x32_bf16 v[148:151], v[84:87], v[72:75], v[148:151]
v_cvt_pk_bf16_f32 v174, v188, v189
v_cvt_pk_bf16_f32 v175, v190, v191
v_mfma_f32_16x16x32_bf16 v[156:159], v[84:87], v[76:79], v[156:159]
v_mfma_f32_16x16x32_bf16 v[152:155], v[80:83], v[76:79], v[152:155]
buffer_store_dwordx4 v[160:163], v2, s[84:87], s45 offen offset:0 sc1
s_waitcnt lgkmcnt(0)
s_barrier
v_mfma_f32_16x16x32_bf16 v[128:131], v[112:115], v[96:99], v[128:131]
ds_read_b128 v[32:35], v7 offset:16384
ds_read_b64_tr_b16 v[48:49], v228 offset:16384
v_mfma_f32_16x16x32_bf16 v[132:135], v[116:119], v[96:99], v[132:135]
ds_read_b64_tr_b16 v[50:51], v228 offset:18432
ds_read_b64_tr_b16 v[52:53], v229 offset:16384
v_mfma_f32_16x16x32_bf16 v[140:143], v[116:119], v[100:103], v[140:143]
ds_read_b64_tr_b16 v[54:55], v229 offset:18432
ds_read_b128 v[36:39], v7 offset:17408
v_mfma_f32_16x16x32_bf16 v[136:139], v[112:115], v[100:103], v[136:139]
ds_read_b128 v[40:43], v7 offset:18432
ds_read_b128 v[44:47], v7 offset:19456
v_mfma_f32_16x16x32_bf16 v[144:147], v[112:115], v[104:107], v[144:147]
ds_read_b128 v[64:67], v7 offset:24576
v_mfma_f32_16x16x32_bf16 v[148:151], v[116:119], v[104:107], v[148:151]
ds_read_b64_tr_b16 v[80:81], v228 offset:20480
v_mfma_f32_16x16x32_bf16 v[156:159], v[116:119], v[108:111], v[156:159]
ds_read_b64_tr_b16 v[82:83], v228 offset:22528
v_mfma_f32_16x16x32_bf16 v[152:155], v[112:115], v[108:111], v[152:155]
ds_read_b64_tr_b16 v[84:85], v229 offset:20480
v_mfma_f32_16x16x32_bf16 v[128:131], v[208:211], v[192:195], v[128:131]
ds_read_b64_tr_b16 v[86:87], v229 offset:22528
buffer_store_dwordx4 v[164:167], v2, s[84:87], s45 offen offset:1024 sc1
v_mfma_f32_16x16x32_bf16 v[132:135], v[212:215], v[192:195], v[132:135]
ds_read_b128 v[68:71], v7 offset:25600
v_mfma_f32_16x16x32_bf16 v[140:143], v[212:215], v[196:199], v[140:143]
ds_read_b128 v[72:75], v7 offset:26624
v_mfma_f32_16x16x32_bf16 v[136:139], v[208:211], v[196:199], v[136:139]
ds_read_b128 v[76:79], v7 offset:27648
v_mfma_f32_16x16x32_bf16 v[144:147], v[208:211], v[200:203], v[144:147]
v_mfma_f32_16x16x32_bf16 v[148:151], v[212:215], v[200:203], v[148:151]
v_mfma_f32_16x16x32_bf16 v[156:159], v[212:215], v[204:207], v[156:159]
v_mfma_f32_16x16x32_bf16 v[152:155], v[208:211], v[204:207], v[152:155]
s_waitcnt lgkmcnt(0)
s_barrier
v_mfma_f32_16x16x32_bf16 v[128:131], v[48:51], v[32:35], v[128:131]
ds_read_b128 v[96:99], v7 offset:32768
ds_read_b64_tr_b16 v[112:113], v226 offset:49152
v_mfma_f32_16x16x32_bf16 v[132:135], v[52:55], v[32:35], v[132:135]
ds_read_b64_tr_b16 v[114:115], v226 offset:51200
ds_read_b64_tr_b16 v[116:117], v227 offset:49152
v_mfma_f32_16x16x32_bf16 v[140:143], v[52:55], v[36:39], v[140:143]
ds_read_b64_tr_b16 v[118:119], v227 offset:51200
ds_read_b128 v[100:103], v7 offset:33792
v_mfma_f32_16x16x32_bf16 v[136:139], v[48:51], v[36:39], v[136:139]
ds_read_b128 v[104:107], v7 offset:34816
ds_read_b128 v[108:111], v7 offset:35840
v_mfma_f32_16x16x32_bf16 v[144:147], v[48:51], v[40:43], v[144:147]
ds_read_b128 v[192:195], v7 offset:40960
v_mfma_f32_16x16x32_bf16 v[148:151], v[52:55], v[40:43], v[148:151]
ds_read_b64_tr_b16 v[208:209], v226 offset:53248
v_mfma_f32_16x16x32_bf16 v[156:159], v[52:55], v[44:47], v[156:159]
ds_read_b64_tr_b16 v[210:211], v226 offset:55296
v_mfma_f32_16x16x32_bf16 v[152:155], v[48:51], v[44:47], v[152:155]
ds_read_b64_tr_b16 v[212:213], v227 offset:53248
v_mfma_f32_16x16x32_bf16 v[128:131], v[80:83], v[64:67], v[128:131]
ds_read_b64_tr_b16 v[214:215], v227 offset:55296
buffer_store_dwordx4 v[168:171], v2, s[84:87], s45 offen offset:2048 sc1
v_mfma_f32_16x16x32_bf16 v[132:135], v[84:87], v[64:67], v[132:135]
ds_read_b128 v[196:199], v7 offset:41984
v_mfma_f32_16x16x32_bf16 v[140:143], v[84:87], v[68:71], v[140:143]
ds_read_b128 v[200:203], v7 offset:43008
v_mfma_f32_16x16x32_bf16 v[136:139], v[80:83], v[68:71], v[136:139]
ds_read_b128 v[204:207], v7 offset:44032
v_mfma_f32_16x16x32_bf16 v[144:147], v[80:83], v[72:75], v[144:147]
v_mfma_f32_16x16x32_bf16 v[148:151], v[84:87], v[72:75], v[148:151]
v_mfma_f32_16x16x32_bf16 v[156:159], v[84:87], v[76:79], v[156:159]
v_mfma_f32_16x16x32_bf16 v[152:155], v[80:83], v[76:79], v[152:155]
s_waitcnt lgkmcnt(0)
s_barrier
v_mfma_f32_16x16x32_bf16 v[128:131], v[112:115], v[96:99], v[128:131]
ds_read_b128 v[32:35], v8 offset:0
ds_read_b64_tr_b16 v[48:49], v224 offset:0
v_mfma_f32_16x16x32_bf16 v[132:135], v[116:119], v[96:99], v[132:135]
ds_read_b64_tr_b16 v[50:51], v224 offset:2048
ds_read_b64_tr_b16 v[52:53], v225 offset:0
v_mfma_f32_16x16x32_bf16 v[140:143], v[116:119], v[100:103], v[140:143]
ds_read_b64_tr_b16 v[54:55], v225 offset:2048
ds_read_b128 v[36:39], v8 offset:1024
v_mfma_f32_16x16x32_bf16 v[136:139], v[112:115], v[100:103], v[136:139]
ds_read_b128 v[40:43], v8 offset:2048
ds_read_b128 v[44:47], v8 offset:3072
v_mfma_f32_16x16x32_bf16 v[144:147], v[112:115], v[104:107], v[144:147]
ds_read_b128 v[64:67], v8 offset:8192
v_mfma_f32_16x16x32_bf16 v[148:151], v[116:119], v[104:107], v[148:151]
ds_read_b64_tr_b16 v[80:81], v224 offset:4096
v_mfma_f32_16x16x32_bf16 v[156:159], v[116:119], v[108:111], v[156:159]
ds_read_b64_tr_b16 v[82:83], v224 offset:6144
v_mfma_f32_16x16x32_bf16 v[152:155], v[112:115], v[108:111], v[152:155]
ds_read_b64_tr_b16 v[84:85], v225 offset:4096
v_mfma_f32_16x16x32_bf16 v[128:131], v[208:211], v[192:195], v[128:131]
ds_read_b64_tr_b16 v[86:87], v225 offset:6144
buffer_store_dwordx4 v[172:175], v2, s[84:87], s45 offen offset:3072 sc1
v_mfma_f32_16x16x32_bf16 v[132:135], v[212:215], v[192:195], v[132:135]
ds_read_b128 v[68:71], v8 offset:9216
v_mfma_f32_16x16x32_bf16 v[140:143], v[212:215], v[196:199], v[140:143]
ds_read_b128 v[72:75], v8 offset:10240
v_mfma_f32_16x16x32_bf16 v[136:139], v[208:211], v[196:199], v[136:139]
ds_read_b128 v[76:79], v8 offset:11264
v_mfma_f32_16x16x32_bf16 v[144:147], v[208:211], v[200:203], v[144:147]
v_mfma_f32_16x16x32_bf16 v[148:151], v[212:215], v[200:203], v[148:151]
v_mfma_f32_16x16x32_bf16 v[156:159], v[212:215], v[204:207], v[156:159]
v_mfma_f32_16x16x32_bf16 v[152:155], v[208:211], v[204:207], v[152:155]
s_waitcnt lgkmcnt(0)
s_barrier
v_mfma_f32_16x16x32_bf16 v[128:131], v[48:51], v[32:35], v[128:131]
ds_read_b128 v[96:99], v6 offset:16384
ds_read_b64_tr_b16 v[112:113], v224 offset:32768
v_mfma_f32_16x16x32_bf16 v[132:135], v[52:55], v[32:35], v[132:135]
ds_read_b64_tr_b16 v[114:115], v224 offset:34816
ds_read_b64_tr_b16 v[116:117], v225 offset:32768
v_mfma_f32_16x16x32_bf16 v[140:143], v[52:55], v[36:39], v[140:143]
ds_read_b64_tr_b16 v[118:119], v225 offset:34816
ds_read_b128 v[100:103], v6 offset:17408
v_mfma_f32_16x16x32_bf16 v[136:139], v[48:51], v[36:39], v[136:139]
ds_read_b128 v[104:107], v6 offset:18432
ds_read_b128 v[108:111], v6 offset:19456
v_mfma_f32_16x16x32_bf16 v[144:147], v[48:51], v[40:43], v[144:147]
ds_read_b128 v[192:195], v6 offset:24576
v_mfma_f32_16x16x32_bf16 v[148:151], v[52:55], v[40:43], v[148:151]
ds_read_b64_tr_b16 v[208:209], v224 offset:36864
v_mfma_f32_16x16x32_bf16 v[156:159], v[52:55], v[44:47], v[156:159]
ds_read_b64_tr_b16 v[210:211], v224 offset:38912
v_mfma_f32_16x16x32_bf16 v[152:155], v[48:51], v[44:47], v[152:155]
ds_read_b64_tr_b16 v[212:213], v225 offset:36864
v_mfma_f32_16x16x32_bf16 v[128:131], v[80:83], v[64:67], v[128:131]
ds_read_b64_tr_b16 v[214:215], v225 offset:38912
v_mfma_f32_16x16x32_bf16 v[132:135], v[84:87], v[64:67], v[132:135]
ds_read_b128 v[196:199], v6 offset:25600
v_mfma_f32_16x16x32_bf16 v[140:143], v[84:87], v[68:71], v[140:143]
ds_read_b128 v[200:203], v6 offset:26624
v_mfma_f32_16x16x32_bf16 v[136:139], v[80:83], v[68:71], v[136:139]
ds_read_b128 v[204:207], v6 offset:27648
v_mfma_f32_16x16x32_bf16 v[144:147], v[80:83], v[72:75], v[144:147]
v_mfma_f32_16x16x32_bf16 v[148:151], v[84:87], v[72:75], v[148:151]
v_mfma_f32_16x16x32_bf16 v[156:159], v[84:87], v[76:79], v[156:159]
v_mfma_f32_16x16x32_bf16 v[152:155], v[80:83], v[76:79], v[152:155]
s_waitcnt vmcnt(0)
s_waitcnt lgkmcnt(0)
s_barrier
v_mfma_f32_16x16x32_bf16 v[128:131], v[112:115], v[96:99], v[128:131]
ds_read_b128 v[32:35], v6 offset:49152
ds_read_b64_tr_b16 v[48:49], v226 offset:0
v_mfma_f32_16x16x32_bf16 v[132:135], v[116:119], v[96:99], v[132:135]
ds_read_b64_tr_b16 v[50:51], v226 offset:2048
ds_read_b64_tr_b16 v[52:53], v227 offset:0
v_mfma_f32_16x16x32_bf16 v[140:143], v[116:119], v[100:103], v[140:143]
ds_read_b64_tr_b16 v[54:55], v227 offset:2048
ds_read_b128 v[36:39], v6 offset:50176
v_mfma_f32_16x16x32_bf16 v[136:139], v[112:115], v[100:103], v[136:139]
ds_read_b128 v[40:43], v6 offset:51200
ds_read_b128 v[44:47], v6 offset:52224
v_mfma_f32_16x16x32_bf16 v[144:147], v[112:115], v[104:107], v[144:147]
ds_read_b128 v[64:67], v6 offset:57344
v_mfma_f32_16x16x32_bf16 v[148:151], v[116:119], v[104:107], v[148:151]
ds_read_b64_tr_b16 v[80:81], v226 offset:4096
v_mfma_f32_16x16x32_bf16 v[156:159], v[116:119], v[108:111], v[156:159]
ds_read_b64_tr_b16 v[82:83], v226 offset:6144
v_mfma_f32_16x16x32_bf16 v[152:155], v[112:115], v[108:111], v[152:155]
ds_read_b64_tr_b16 v[84:85], v227 offset:4096
v_mfma_f32_16x16x32_bf16 v[128:131], v[208:211], v[192:195], v[128:131]
ds_read_b64_tr_b16 v[86:87], v227 offset:6144
v_mfma_f32_16x16x32_bf16 v[132:135], v[212:215], v[192:195], v[132:135]
ds_read_b128 v[68:71], v6 offset:58368
v_mfma_f32_16x16x32_bf16 v[140:143], v[212:215], v[196:199], v[140:143]
ds_read_b128 v[72:75], v6 offset:59392
v_mfma_f32_16x16x32_bf16 v[136:139], v[208:211], v[196:199], v[136:139]
ds_read_b128 v[76:79], v6 offset:60416
v_mfma_f32_16x16x32_bf16 v[144:147], v[208:211], v[200:203], v[144:147]
v_mfma_f32_16x16x32_bf16 v[148:151], v[212:215], v[200:203], v[148:151]
v_mfma_f32_16x16x32_bf16 v[156:159], v[212:215], v[204:207], v[156:159]
v_mfma_f32_16x16x32_bf16 v[152:155], v[208:211], v[204:207], v[152:155]
s_waitcnt lgkmcnt(0)
s_barrier
v_mfma_f32_16x16x32_bf16 v[128:131], v[48:51], v[32:35], v[128:131]
ds_read_b128 v[96:99], v7 offset:16384
ds_read_b64_tr_b16 v[112:113], v228 offset:16384
v_mfma_f32_16x16x32_bf16 v[132:135], v[52:55], v[32:35], v[132:135]
ds_read_b64_tr_b16 v[114:115], v228 offset:18432
ds_read_b64_tr_b16 v[116:117], v229 offset:16384
v_mfma_f32_16x16x32_bf16 v[140:143], v[52:55], v[36:39], v[140:143]
ds_read_b64_tr_b16 v[118:119], v229 offset:18432
ds_read_b128 v[100:103], v7 offset:17408
v_mfma_f32_16x16x32_bf16 v[136:139], v[48:51], v[36:39], v[136:139]
ds_read_b128 v[104:107], v7 offset:18432
ds_read_b128 v[108:111], v7 offset:19456
v_mfma_f32_16x16x32_bf16 v[144:147], v[48:51], v[40:43], v[144:147]
ds_read_b128 v[192:195], v7 offset:24576
v_mfma_f32_16x16x32_bf16 v[148:151], v[52:55], v[40:43], v[148:151]
ds_read_b64_tr_b16 v[208:209], v228 offset:20480
v_mfma_f32_16x16x32_bf16 v[156:159], v[52:55], v[44:47], v[156:159]
ds_read_b64_tr_b16 v[210:211], v228 offset:22528
v_mfma_f32_16x16x32_bf16 v[152:155], v[48:51], v[44:47], v[152:155]
ds_read_b64_tr_b16 v[212:213], v229 offset:20480
v_mfma_f32_16x16x32_bf16 v[128:131], v[80:83], v[64:67], v[128:131]
ds_read_b64_tr_b16 v[214:215], v229 offset:22528
v_mfma_f32_16x16x32_bf16 v[132:135], v[84:87], v[64:67], v[132:135]
ds_read_b128 v[196:199], v7 offset:25600
v_mfma_f32_16x16x32_bf16 v[140:143], v[84:87], v[68:71], v[140:143]
ds_read_b128 v[200:203], v7 offset:26624
v_mfma_f32_16x16x32_bf16 v[136:139], v[80:83], v[68:71], v[136:139]
ds_read_b128 v[204:207], v7 offset:27648
v_mfma_f32_16x16x32_bf16 v[144:147], v[80:83], v[72:75], v[144:147]
v_mfma_f32_16x16x32_bf16 v[148:151], v[84:87], v[72:75], v[148:151]
v_mfma_f32_16x16x32_bf16 v[156:159], v[84:87], v[76:79], v[156:159]
v_mfma_f32_16x16x32_bf16 v[152:155], v[80:83], v[76:79], v[152:155]
s_waitcnt lgkmcnt(0)
s_barrier
v_mfma_f32_16x16x32_bf16 v[128:131], v[112:115], v[96:99], v[128:131]
ds_read_b128 v[32:35], v7 offset:32768
ds_read_b64_tr_b16 v[48:49], v226 offset:49152
v_mfma_f32_16x16x32_bf16 v[132:135], v[116:119], v[96:99], v[132:135]
ds_read_b64_tr_b16 v[50:51], v226 offset:51200
ds_read_b64_tr_b16 v[52:53], v227 offset:49152
v_mfma_f32_16x16x32_bf16 v[140:143], v[116:119], v[100:103], v[140:143]
ds_read_b64_tr_b16 v[54:55], v227 offset:51200
ds_read_b128 v[36:39], v7 offset:33792
v_mfma_f32_16x16x32_bf16 v[136:139], v[112:115], v[100:103], v[136:139]
ds_read_b128 v[40:43], v7 offset:34816
ds_read_b128 v[44:47], v7 offset:35840
v_mfma_f32_16x16x32_bf16 v[144:147], v[112:115], v[104:107], v[144:147]
ds_read_b128 v[64:67], v7 offset:40960
v_mfma_f32_16x16x32_bf16 v[148:151], v[116:119], v[104:107], v[148:151]
ds_read_b64_tr_b16 v[80:81], v226 offset:53248
v_mfma_f32_16x16x32_bf16 v[156:159], v[116:119], v[108:111], v[156:159]
ds_read_b64_tr_b16 v[82:83], v226 offset:55296
v_mfma_f32_16x16x32_bf16 v[152:155], v[112:115], v[108:111], v[152:155]
ds_read_b64_tr_b16 v[84:85], v227 offset:53248
v_mfma_f32_16x16x32_bf16 v[128:131], v[208:211], v[192:195], v[128:131]
ds_read_b64_tr_b16 v[86:87], v227 offset:55296
v_mfma_f32_16x16x32_bf16 v[132:135], v[212:215], v[192:195], v[132:135]
ds_read_b128 v[68:71], v7 offset:41984
v_mfma_f32_16x16x32_bf16 v[140:143], v[212:215], v[196:199], v[140:143]
ds_read_b128 v[72:75], v7 offset:43008
v_mfma_f32_16x16x32_bf16 v[136:139], v[208:211], v[196:199], v[136:139]
ds_read_b128 v[76:79], v7 offset:44032
v_mfma_f32_16x16x32_bf16 v[144:147], v[208:211], v[200:203], v[144:147]
v_mfma_f32_16x16x32_bf16 v[148:151], v[212:215], v[200:203], v[148:151]
v_mfma_f32_16x16x32_bf16 v[156:159], v[212:215], v[204:207], v[156:159]
v_mfma_f32_16x16x32_bf16 v[152:155], v[208:211], v[204:207], v[152:155]
s_waitcnt lgkmcnt(0)
s_barrier
buffer_load_dwordx4 v[232:235], v2, s[84:87], s46 offen offset:0 sc1
buffer_load_dwordx4 v[236:239], v2, s[84:87], s46 offen offset:1024 sc1
buffer_load_dwordx4 v[240:243], v2, s[84:87], s46 offen offset:2048 sc1
buffer_load_dwordx4 v[244:247], v2, s[84:87], s46 offen offset:3072 sc1
v_mfma_f32_16x16x32_bf16 v[128:131], v[48:51], v[32:35], v[128:131]
ds_read_b128 v[96:99], v8 offset:0
ds_read_b64_tr_b16 v[112:113], v224 offset:0
v_mfma_f32_16x16x32_bf16 v[132:135], v[52:55], v[32:35], v[132:135]
ds_read_b64_tr_b16 v[114:115], v224 offset:2048
ds_read_b64_tr_b16 v[116:117], v225 offset:0
v_mfma_f32_16x16x32_bf16 v[140:143], v[52:55], v[36:39], v[140:143]
ds_read_b64_tr_b16 v[118:119], v225 offset:2048
ds_read_b128 v[100:103], v8 offset:1024
v_mfma_f32_16x16x32_bf16 v[136:139], v[48:51], v[36:39], v[136:139]
ds_read_b128 v[104:107], v8 offset:2048
ds_read_b128 v[108:111], v8 offset:3072
v_mfma_f32_16x16x32_bf16 v[144:147], v[48:51], v[40:43], v[144:147]
ds_read_b128 v[192:195], v8 offset:8192
v_mfma_f32_16x16x32_bf16 v[148:151], v[52:55], v[40:43], v[148:151]
ds_read_b64_tr_b16 v[208:209], v224 offset:4096
v_mfma_f32_16x16x32_bf16 v[156:159], v[52:55], v[44:47], v[156:159]
ds_read_b64_tr_b16 v[210:211], v224 offset:6144
v_mfma_f32_16x16x32_bf16 v[152:155], v[48:51], v[44:47], v[152:155]
ds_read_b64_tr_b16 v[212:213], v225 offset:4096
v_mfma_f32_16x16x32_bf16 v[128:131], v[80:83], v[64:67], v[128:131]
ds_read_b64_tr_b16 v[214:215], v225 offset:6144
v_mfma_f32_16x16x32_bf16 v[132:135], v[84:87], v[64:67], v[132:135]
ds_read_b128 v[196:199], v8 offset:9216
v_mfma_f32_16x16x32_bf16 v[140:143], v[84:87], v[68:71], v[140:143]
ds_read_b128 v[200:203], v8 offset:10240
v_mfma_f32_16x16x32_bf16 v[136:139], v[80:83], v[68:71], v[136:139]
ds_read_b128 v[204:207], v8 offset:11264
v_mfma_f32_16x16x32_bf16 v[144:147], v[80:83], v[72:75], v[144:147]
v_mfma_f32_16x16x32_bf16 v[148:151], v[84:87], v[72:75], v[148:151]
v_mfma_f32_16x16x32_bf16 v[156:159], v[84:87], v[76:79], v[156:159]
v_mfma_f32_16x16x32_bf16 v[152:155], v[80:83], v[76:79], v[152:155]
s_waitcnt lgkmcnt(0)
s_barrier
v_mfma_f32_16x16x32_bf16 v[128:131], v[112:115], v[96:99], v[128:131]
ds_read_b128 v[32:35], v6 offset:16384
ds_read_b64_tr_b16 v[48:49], v224 offset:32768
v_mfma_f32_16x16x32_bf16 v[132:135], v[116:119], v[96:99], v[132:135]
ds_read_b64_tr_b16 v[50:51], v224 offset:34816
ds_read_b64_tr_b16 v[52:53], v225 offset:32768
v_mfma_f32_16x16x32_bf16 v[140:143], v[116:119], v[100:103], v[140:143]
ds_read_b64_tr_b16 v[54:55], v225 offset:34816
ds_read_b128 v[36:39], v6 offset:17408
v_mfma_f32_16x16x32_bf16 v[136:139], v[112:115], v[100:103], v[136:139]
ds_read_b128 v[40:43], v6 offset:18432
ds_read_b128 v[44:47], v6 offset:19456
v_mfma_f32_16x16x32_bf16 v[144:147], v[112:115], v[104:107], v[144:147]
ds_read_b128 v[64:67], v6 offset:24576
v_mfma_f32_16x16x32_bf16 v[148:151], v[116:119], v[104:107], v[148:151]
ds_read_b64_tr_b16 v[80:81], v224 offset:36864
v_mfma_f32_16x16x32_bf16 v[156:159], v[116:119], v[108:111], v[156:159]
ds_read_b64_tr_b16 v[82:83], v224 offset:38912
v_mfma_f32_16x16x32_bf16 v[152:155], v[112:115], v[108:111], v[152:155]
ds_read_b64_tr_b16 v[84:85], v225 offset:36864
v_mfma_f32_16x16x32_bf16 v[128:131], v[208:211], v[192:195], v[128:131]
ds_read_b64_tr_b16 v[86:87], v225 offset:38912
v_mfma_f32_16x16x32_bf16 v[132:135], v[212:215], v[192:195], v[132:135]
ds_read_b128 v[68:71], v6 offset:25600
v_mfma_f32_16x16x32_bf16 v[140:143], v[212:215], v[196:199], v[140:143]
ds_read_b128 v[72:75], v6 offset:26624
v_mfma_f32_16x16x32_bf16 v[136:139], v[208:211], v[196:199], v[136:139]
ds_read_b128 v[76:79], v6 offset:27648
v_mfma_f32_16x16x32_bf16 v[144:147], v[208:211], v[200:203], v[144:147]
v_mfma_f32_16x16x32_bf16 v[148:151], v[212:215], v[200:203], v[148:151]
v_mfma_f32_16x16x32_bf16 v[156:159], v[212:215], v[204:207], v[156:159]
v_mfma_f32_16x16x32_bf16 v[152:155], v[208:211], v[204:207], v[152:155]
s_waitcnt lgkmcnt(0)
s_barrier
v_mfma_f32_16x16x32_bf16 v[128:131], v[48:51], v[32:35], v[128:131]
ds_read_b128 v[96:99], v6 offset:49152
ds_read_b64_tr_b16 v[112:113], v226 offset:0
v_mfma_f32_16x16x32_bf16 v[132:135], v[52:55], v[32:35], v[132:135]
ds_read_b64_tr_b16 v[114:115], v226 offset:2048
ds_read_b64_tr_b16 v[116:117], v227 offset:0
v_mfma_f32_16x16x32_bf16 v[140:143], v[52:55], v[36:39], v[140:143]
ds_read_b64_tr_b16 v[118:119], v227 offset:2048
ds_read_b128 v[100:103], v6 offset:50176
v_mfma_f32_16x16x32_bf16 v[136:139], v[48:51], v[36:39], v[136:139]
ds_read_b128 v[104:107], v6 offset:51200
ds_read_b128 v[108:111], v6 offset:52224
v_mfma_f32_16x16x32_bf16 v[144:147], v[48:51], v[40:43], v[144:147]
s_branch Lov_13
.p2align 12
.fill 96, 4, 0xbf800000
Lst_13_0:
s_branch Lwr_159
Lst_13_1:
s_branch Lst_17_0
s_nop 0
Lov_13:
ds_read_b128 v[192:195], v6 offset:57344
v_mfma_f32_16x16x32_bf16 v[148:151], v[52:55], v[40:43], v[148:151]
ds_read_b64_tr_b16 v[208:209], v226 offset:4096
v_mfma_f32_16x16x32_bf16 v[156:159], v[52:55], v[44:47], v[156:159]
ds_read_b64_tr_b16 v[210:211], v226 offset:6144
v_mfma_f32_16x16x32_bf16 v[152:155], v[48:51], v[44:47], v[152:155]
ds_read_b64_tr_b16 v[212:213], v227 offset:4096
v_mfma_f32_16x16x32_bf16 v[128:131], v[80:83], v[64:67], v[128:131]
ds_read_b64_tr_b16 v[214:215], v227 offset:6144
v_mfma_f32_16x16x32_bf16 v[132:135], v[84:87], v[64:67], v[132:135]
ds_read_b128 v[196:199], v6 offset:58368
v_mfma_f32_16x16x32_bf16 v[140:143], v[84:87], v[68:71], v[140:143]
ds_read_b128 v[200:203], v6 offset:59392
v_mfma_f32_16x16x32_bf16 v[136:139], v[80:83], v[68:71], v[136:139]
ds_read_b128 v[204:207], v6 offset:60416
v_mfma_f32_16x16x32_bf16 v[144:147], v[80:83], v[72:75], v[144:147]
v_mfma_f32_16x16x32_bf16 v[148:151], v[84:87], v[72:75], v[148:151]
v_mfma_f32_16x16x32_bf16 v[156:159], v[84:87], v[76:79], v[156:159]
v_mfma_f32_16x16x32_bf16 v[152:155], v[80:83], v[76:79], v[152:155]
s_waitcnt vmcnt(0)
s_waitcnt lgkmcnt(0)
s_barrier
v_mfma_f32_16x16x32_bf16 v[128:131], v[112:115], v[96:99], v[128:131]
v_lshlrev_b32 v160, 16, v232
v_and_b32 v161, 0xffff0000, v232
v_mfma_f32_16x16x32_bf16 v[132:135], v[116:119], v[96:99], v[132:135]
v_lshlrev_b32 v162, 16, v233
v_and_b32 v163, 0xffff0000, v233
v_mfma_f32_16x16x32_bf16 v[140:143], v[116:119], v[100:103], v[140:143]
v_lshlrev_b32 v164, 16, v234
v_and_b32 v165, 0xffff0000, v234
v_mfma_f32_16x16x32_bf16 v[136:139], v[112:115], v[100:103], v[136:139]
v_lshlrev_b32 v166, 16, v235
v_and_b32 v167, 0xffff0000, v235
v_mfma_f32_16x16x32_bf16 v[144:147], v[112:115], v[104:107], v[144:147]
v_lshlrev_b32 v168, 16, v236
v_and_b32 v169, 0xffff0000, v236
v_mfma_f32_16x16x32_bf16 v[148:151], v[116:119], v[104:107], v[148:151]
v_lshlrev_b32 v170, 16, v237
v_and_b32 v171, 0xffff0000, v237
v_mfma_f32_16x16x32_bf16 v[156:159], v[116:119], v[108:111], v[156:159]
v_lshlrev_b32 v172, 16, v238
v_and_b32 v173, 0xffff0000, v238
v_mfma_f32_16x16x32_bf16 v[152:155], v[112:115], v[108:111], v[152:155]
v_lshlrev_b32 v174, 16, v239
v_and_b32 v175, 0xffff0000, v239
v_mfma_f32_16x16x32_bf16 v[128:131], v[208:211], v[192:195], v[128:131]
v_lshlrev_b32 v176, 16, v240
v_and_b32 v177, 0xffff0000, v240
v_mfma_f32_16x16x32_bf16 v[132:135], v[212:215], v[192:195], v[132:135]
v_lshlrev_b32 v178, 16, v241
v_and_b32 v179, 0xffff0000, v241
v_mfma_f32_16x16x32_bf16 v[140:143], v[212:215], v[196:199], v[140:143]
v_lshlrev_b32 v180, 16, v242
v_and_b32 v181, 0xffff0000, v242
v_mfma_f32_16x16x32_bf16 v[136:139], v[208:211], v[196:199], v[136:139]
v_lshlrev_b32 v182, 16, v243
v_and_b32 v183, 0xffff0000, v243
v_mfma_f32_16x16x32_bf16 v[144:147], v[208:211], v[200:203], v[144:147]
v_lshlrev_b32 v184, 16, v244
v_and_b32 v185, 0xffff0000, v244
v_mfma_f32_16x16x32_bf16 v[148:151], v[212:215], v[200:203], v[148:151]
v_lshlrev_b32 v186, 16, v245
v_and_b32 v187, 0xffff0000, v245
v_mfma_f32_16x16x32_bf16 v[156:159], v[212:215], v[204:207], v[156:159]
v_lshlrev_b32 v188, 16, v246
v_and_b32 v189, 0xffff0000, v246
v_mfma_f32_16x16x32_bf16 v[152:155], v[208:211], v[204:207], v[152:155]
v_lshlrev_b32 v190, 16, v247
v_and_b32 v191, 0xffff0000, v247
s_nop 1
v_pk_add_f32 v[128:129], v[128:129], v[160:161]
v_pk_add_f32 v[130:131], v[130:131], v[162:163]
v_pk_add_f32 v[132:133], v[132:133], v[164:165]
v_pk_add_f32 v[134:135], v[134:135], v[166:167]
v_cvt_pk_bf16_f32 v32, v128, v129
v_cvt_pk_bf16_f32 v33, v130, v131
v_cvt_pk_bf16_f32 v34, v132, v133
v_cvt_pk_bf16_f32 v35, v134, v135
v_pk_add_f32 v[136:137], v[136:137], v[168:169]
v_pk_add_f32 v[138:139], v[138:139], v[170:171]
v_pk_add_f32 v[140:141], v[140:141], v[172:173]
v_pk_add_f32 v[142:143], v[142:143], v[174:175]
v_cvt_pk_bf16_f32 v36, v136, v137
v_cvt_pk_bf16_f32 v37, v138, v139
v_cvt_pk_bf16_f32 v38, v140, v141
v_cvt_pk_bf16_f32 v39, v142, v143
v_permlane16_swap_b32 v32, v34
v_permlane16_swap_b32 v33, v35
buffer_store_dwordx4 v[32:35], v230, s[20:23], s54 offen offset:0 nt
v_pk_add_f32 v[144:145], v[144:145], v[176:177]
v_pk_add_f32 v[146:147], v[146:147], v[178:179]
v_pk_add_f32 v[148:149], v[148:149], v[180:181]
v_pk_add_f32 v[150:151], v[150:151], v[182:183]
v_cvt_pk_bf16_f32 v40, v144, v145
v_cvt_pk_bf16_f32 v41, v146, v147
v_cvt_pk_bf16_f32 v42, v148, v149
v_cvt_pk_bf16_f32 v43, v150, v151
v_permlane16_swap_b32 v36, v38
v_permlane16_swap_b32 v37, v39
buffer_store_dwordx4 v[36:39], v230, s[20:23], s54 offen offset:2048 nt
v_pk_add_f32 v[152:153], v[152:153], v[184:185]
v_pk_add_f32 v[154:155], v[154:155], v[186:187]
v_pk_add_f32 v[156:157], v[156:157], v[188:189]
v_pk_add_f32 v[158:159], v[158:159], v[190:191]
v_cvt_pk_bf16_f32 v44, v152, v153
v_cvt_pk_bf16_f32 v45, v154, v155
v_cvt_pk_bf16_f32 v46, v156, v157
v_cvt_pk_bf16_f32 v47, v158, v159
v_permlane16_swap_b32 v40, v42
v_permlane16_swap_b32 v41, v43
buffer_store_dwordx4 v[40:43], v230, s[20:23], s55 offen offset:0 nt
s_nop 1
v_permlane16_swap_b32 v44, v46
v_permlane16_swap_b32 v45, v47
buffer_store_dwordx4 v[44:47], v230, s[20:23], s55 offen offset:2048 nt
s_branch Ldone_1
Lgb_97:
s_mul_i32 s43, s34, 262144
s_add_u32 s8, s82, s43
s_addc_u32 s9, s83, 0
s_add_u32 s8, s8, 4194304
s_addc_u32 s9, s9, 0
s_mov_b32 s10, 262144
s_mov_b32 s11, 0x20000
s_lshl_b32 s39, s36, 12
v_lshlrev_b32 v2, 4, v1
v_add_u32 v3, s39, v2
s_add_u32 s37, s35, 0
s_and_b32 s37, s37, 15
s_mul_i32 s37, s37, 16384
s_add_u32 m0, s39, 0
s_nop 0
buffer_load_dwordx4 v3, s[8:11], s37 offen sc1 lds
buffer_load_dwordx4 v3, s[8:11], s37 offen offset:1024 sc1 lds
buffer_load_dwordx4 v3, s[8:11], s37 offen offset:2048 sc1 lds
buffer_load_dwordx4 v3, s[8:11], s37 offen offset:3072 sc1 lds
s_mul_i32 s43, s34, 262144
s_add_u32 s8, s82, s43
s_addc_u32 s9, s83, 0
s_add_u32 s8, s8, 4194304
s_addc_u32 s9, s9, 0
s_mov_b32 s10, 262144
s_mov_b32 s11, 0x20000
s_mul_i32 s43, s34, 917504
s_add_u32 s24, s82, s43
s_addc_u32 s25, s83, 0
s_add_u32 s24, s24, 8388608
s_addc_u32 s25, s25, 0
s_mov_b32 s26, 917504
s_mov_b32 s27, 0x20000
s_add_u32 s84, s82, 27262976
s_addc_u32 s85, s83, 0
s_mov_b32 s86, 229376
s_mov_b32 s87, 0x20000
s_and_b32 s47, s36, 3
s_lshr_b32 s62, s47, 1
s_and_b32 s63, s47, 1
v_lshlrev_b32 v2, 4, v1
s_lshl_b32 s39, s47, 12
v_add_u32 v3, s39, v2
s_cmp_eq_u32 s62, 0
s_cselect_b32 s44, s72, s74
s_cselect_b32 s45, s73, s75
s_lshl_b32 s43, s35, 8
s_add_u32 s12, s44, s43
s_addc_u32 s13, s45, 0
s_mov_b32 s14, 7333120
s_mov_b32 s15, 0x20000
v_lshrrev_b32 v28, 4, v1
v_lshlrev_b32 v29, 1, v28
v_and_b32 v4, 15, v1
v_xor_b32 v4, v4, v29
v_lshlrev_b32 v4, 4, v4
v_mul_u32_u24 v28, 7168, v28
v_add_u32 v4, v4, v28
s_mul_i32 s43, s63, 229376
v_add_u32 v4, s43, v4
v_xor_b32 v5, 128, v4
v_add_u32 v5, 28672, v5
s_lshl_b32 s40, s47, 13
s_add_u32 s40, s40, 16384
s_lshl_b32 s43, s62, 12
v_add_u32 v9, s43, v2
v_add_u32 v10, 98304, v9
v_mov_b32 v6, v192
v_mov_b32 v7, v193
v_mov_b32 v8, v194
v_mov_b32 v24, v195
s_mul_i32 s43, s34, 16384
s_add_u32 s20, s82, s43
s_addc_u32 s21, s83, 0
s_add_u32 s20, s20, 25165824
s_addc_u32 s21, s21, 0
s_mov_b32 s22, 16384
s_mov_b32 s23, 0x20000
s_add_u32 s38, s35, 2
s_and_b32 s38, s38, 15
s_mul_i32 s38, s38, 458752
s_add_u32 m0, s50, 98304
s_nop 0
buffer_load_dwordx4 v6, s[16:19], s38 offen lds
s_add_u32 m0, s50, 99328
s_nop 0
buffer_load_dwordx4 v7, s[16:19], s38 offen lds
s_add_u32 m0, s50, 100352
s_nop 0
buffer_load_dwordx4 v8, s[16:19], s38 offen lds
s_add_u32 m0, s50, 101376
s_add_u32 s38, s38, 114688
buffer_load_dwordx4 v6, s[16:19], s38 offen lds
s_add_u32 m0, s50, 102400
s_nop 0
buffer_load_dwordx4 v7, s[16:19], s38 offen lds
s_add_u32 m0, s50, 103424
s_nop 0
buffer_load_dwordx4 v8, s[16:19], s38 offen lds
s_cmp_eq_u32 s47, 1
s_cbranch_scc0 Lw_123
s_lshl_b32 s92, s34, 4
s_add_u32 s92, s92, s35
s_lshl_b32 s92, s92, 8
s_add_u32 s92, s92, 49280
s_add_u32 s92, s92, 28311552
s_mov_b32 s41, 0x40000
Lpoll_124:
s_load_dword s93, s[82:83], s92 glc
Lpchk_126:
s_waitcnt lgkmcnt(0)
s_cmp_eq_u32 s93, 16
s_cbranch_scc1 Lpok_125
s_sub_u32 s41, s41, 1
s_cmp_lg_u32 s41, 0
s_cbranch_scc1 Lpoll_124
Lpok_125:
Lw_123:
s_waitcnt vmcnt(0)
s_barrier
s_add_u32 s37, s35, 1
s_and_b32 s37, s37, 15
s_mul_i32 s37, s37, 16384
s_add_u32 m0, s39, 49152
s_nop 0
buffer_load_dwordx4 v3, s[8:11], s37 offen sc1 lds
buffer_load_dwordx4 v3, s[8:11], s37 offen offset:1024 sc1 lds
buffer_load_dwordx4 v3, s[8:11], s37 offen offset:2048 sc1 lds
buffer_load_dwordx4 v3, s[8:11], s37 offen offset:3072 sc1 lds
s_add_u32 s37, s35, 2
s_and_b32 s37, s37, 15
s_mul_i32 s37, s37, 16384
s_add_u32 m0, s39, 98304
s_nop 0
buffer_load_dwordx4 v3, s[8:11], s37 offen sc1 lds
buffer_load_dwordx4 v3, s[8:11], s37 offen offset:1024 sc1 lds
buffer_load_dwordx4 v3, s[8:11], s37 offen offset:2048 sc1 lds
buffer_load_dwordx4 v3, s[8:11], s37 offen offset:3072 sc1 lds
buffer_load_dwordx4 v[96:99], v3, s[20:23], 0 offen offset:0 sc1
buffer_load_dwordx4 v[100:103], v3, s[20:23], 0 offen offset:1024 sc1
buffer_load_dwordx4 v[104:107], v3, s[20:23], 0 offen offset:2048 sc1
buffer_load_dwordx4 v[108:111], v3, s[20:23], 0 offen offset:3072 sc1
s_and_b32 s44, s36, 3
s_mul_i32 s44, s44, 14
s_bfe_u32 s43, s2, 0x30001
s_lshl_b32 s43, s43, 7
s_add_u32 s44, s44, s43
s_add_u32 s44, s44, 72
s_mul_i32 s44, s44, 7168
s_lshr_b32 s43, s2, 4
s_lshl_b32 s43, s43, 8
s_add_u32 s43, s43, s44
s_bitcmp0_b32 s2, 0
s_cselect_b32 s4, s72, s74
s_cselect_b32 s5, s73, s75
s_add_u32 s4, s4, s43
s_addc_u32 s5, s5, 0
s_waitcnt vmcnt(8)
s_barrier
s_cmp_eq_u32 s47, 3
s_cbranch_scc0 Lw_127
v_and_b32 v30, 31, v1
v_lshlrev_b32 v30, 4, v30
v_add_u32 v31, 151552, v30
ds_read_b128 v[112:115], v31 offset:0
ds_read_b128 v[116:119], v31 offset:512
ds_read_b128 v[120:123], v31 offset:1024
ds_read_b128 v[124:127], v31 offset:1536
s_and_b32 s44, s2, 15
s_mul_i32 s44, s44, 14336
s_lshr_b32 s43, s2, 4
s_lshl_b32 s43, s43, 9
s_add_u32 s44, s44, s43
s_add_u32 s44, s44, 8192
s_cmp_lt_u32 s2, 192
s_cselect_b32 s44, s44, 0x7fffffff
s_waitcnt lgkmcnt(0)
v_add_f32 v112, v112, v116
v_add_f32 v120, v120, v124
v_add_f32 v113, v113, v117
v_add_f32 v121, v121, v125
v_add_f32 v114, v114, v118
v_add_f32 v122, v122, v126
v_add_f32 v115, v115, v119
v_add_f32 v123, v123, v127
v_add_f32 v112, v112, v120
v_add_f32 v113, v113, v121
v_add_f32 v114, v114, v122
v_add_f32 v115, v115, v123
s_mov_b64 exec, 0xffffffff
buffer_store_dwordx4 v[112:115], v30, s[84:87], s44 offen sc1
s_mov_b64 exec, -1
Lw_127:
s_add_u32 s37, s35, 3
s_and_b32 s37, s37, 15
s_mul_i32 s37, s37, 16384
s_add_u32 m0, s39, 0
s_nop 0
buffer_load_dwordx4 v3, s[8:11], s37 offen sc1 lds
buffer_load_dwordx4 v3, s[8:11], s37 offen offset:1024 sc1 lds
s_load_dword s3, s[4:5], 78848
buffer_load_dwordx4 v3, s[8:11], s37 offen offset:2048 sc1 lds
buffer_load_dwordx4 v3, s[8:11], s37 offen offset:3072 sc1 lds
s_load_dword s3, s[4:5], 78912
s_add_u32 s38, s35, 3
s_and_b32 s38, s38, 15
s_mul_i32 s38, s38, 458752
s_add_u32 m0, s50, 0
s_nop 0
buffer_load_dwordx4 v6, s[16:19], s38 offen lds
s_load_dword s3, s[4:5], 78976
s_add_u32 m0, s50, 1024
s_nop 0
buffer_load_dwordx4 v7, s[16:19], s38 offen lds
s_add_u32 m0, s50, 2048
s_nop 0
buffer_load_dwordx4 v8, s[16:19], s38 offen lds
s_load_dword s3, s[4:5], 79040
s_add_u32 m0, s50, 3072
s_add_u32 s38, s38, 114688
buffer_load_dwordx4 v6, s[16:19], s38 offen lds
s_load_dword s3, s[4:5], 86016
s_add_u32 m0, s50, 4096
s_nop 0
buffer_load_dwordx4 v7, s[16:19], s38 offen lds
s_add_u32 m0, s50, 5120
s_nop 0
buffer_load_dwordx4 v8, s[16:19], s38 offen lds
s_waitcnt vmcnt(14)
s_barrier
s_add_u32 s37, s35, 4
s_and_b32 s37, s37, 15
s_mul_i32 s37, s37, 16384
s_add_u32 m0, s39, 49152
s_nop 0
buffer_load_dwordx4 v3, s[8:11], s37 offen sc1 lds
buffer_load_dwordx4 v3, s[8:11], s37 offen offset:1024 sc1 lds
s_load_dword s3, s[4:5], 86080
buffer_load_dwordx4 v3, s[8:11], s37 offen offset:2048 sc1 lds
buffer_load_dwordx4 v3, s[8:11], s37 offen offset:3072 sc1 lds
s_load_dword s3, s[4:5], 86144
s_add_u32 s38, s35, 4
s_and_b32 s38, s38, 15
s_mul_i32 s38, s38, 458752
s_add_u32 m0, s50, 49152
s_nop 0
buffer_load_dwordx4 v6, s[16:19], s38 offen lds
s_load_dword s3, s[4:5], 86208
s_add_u32 m0, s50, 50176
s_nop 0
buffer_load_dwordx4 v7, s[16:19], s38 offen lds
s_add_u32 m0, s50, 51200
s_nop 0
buffer_load_dwordx4 v8, s[16:19], s38 offen lds
s_load_dword s3, s[4:5], 93184
s_add_u32 m0, s50, 52224
s_add_u32 s38, s38, 114688
buffer_load_dwordx4 v6, s[16:19], s38 offen lds
s_load_dword s3, s[4:5], 93248
s_add_u32 m0, s50, 53248
s_nop 0
buffer_load_dwordx4 v7, s[16:19], s38 offen lds
s_add_u32 m0, s50, 54272
s_nop 0
buffer_load_dwordx4 v8, s[16:19], s38 offen lds
s_waitcnt vmcnt(10)
s_barrier
s_cmp_eq_u32 s47, 3
s_cbranch_scc0 Lw_128
s_cmp_lt_u32 s2, 192
s_cbranch_scc0 Lw_128
s_lshr_b32 s43, s2, 4
s_add_u32 s43, s43, 96
s_lshl_b32 s43, s43, 7
v_mov_b32 v30, s43
v_mov_b32 v31, 1
s_mov_b64 exec, 1
buffer_atomic_add v31, v30, s[56:59], 0 offen sc1
s_mov_b64 exec, -1
Lw_128:
s_add_u32 s37, s35, 5
s_and_b32 s37, s37, 15
s_mul_i32 s37, s37, 16384
s_add_u32 m0, s39, 98304
s_nop 0
buffer_load_dwordx4 v3, s[8:11], s37 offen sc1 lds
v_add_f32 v96, v96, v100
v_add_f32 v97, v97, v101
v_add_f32 v98, v98, v102
buffer_load_dwordx4 v3, s[8:11], s37 offen offset:1024 sc1 lds
v_add_f32 v99, v99, v103
v_add_f32 v104, v104, v108
v_add_f32 v105, v105, v109
buffer_load_dwordx4 v3, s[8:11], s37 offen offset:2048 sc1 lds
v_add_f32 v106, v106, v110
v_add_f32 v107, v107, v111
s_nop 0
buffer_load_dwordx4 v3, s[8:11], s37 offen offset:3072 sc1 lds
v_permlane32_swap_b32 v96, v104
v_permlane32_swap_b32 v97, v105
v_permlane32_swap_b32 v98, v106
v_permlane32_swap_b32 v99, v107
s_add_u32 s38, s35, 5
s_and_b32 s38, s38, 15
s_mul_i32 s38, s38, 458752
s_add_u32 m0, s50, 98304
s_nop 0
buffer_load_dwordx4 v6, s[16:19], s38 offen lds
v_add_f32 v96, v96, v104
v_add_f32 v97, v97, v105
v_add_f32 v98, v98, v106
s_add_u32 m0, s50, 99328
s_nop 0
buffer_load_dwordx4 v7, s[16:19], s38 offen lds
v_add_f32 v99, v99, v107
v_mov_b32 v100, v96
v_mov_b32 v101, v97
s_add_u32 m0, s50, 100352
s_nop 0
buffer_load_dwordx4 v8, s[16:19], s38 offen lds
v_mov_b32 v102, v98
v_mov_b32 v103, v99
s_nop 0
s_add_u32 m0, s50, 101376
s_add_u32 s38, s38, 114688
buffer_load_dwordx4 v6, s[16:19], s38 offen lds
v_permlane16_swap_b32 v96, v100
v_permlane16_swap_b32 v97, v101
v_permlane16_swap_b32 v98, v102
v_permlane16_swap_b32 v99, v103
s_add_u32 m0, s50, 102400
s_nop 0
buffer_load_dwordx4 v7, s[16:19], s38 offen lds
s_add_u32 m0, s50, 103424
s_nop 0
buffer_load_dwordx4 v8, s[16:19], s38 offen lds
s_waitcnt vmcnt(10)
s_barrier
s_add_u32 s37, s35, 6
s_and_b32 s37, s37, 15
s_mul_i32 s37, s37, 16384
s_add_u32 m0, s39, 0
s_nop 0
buffer_load_dwordx4 v3, s[8:11], s37 offen sc1 lds
v_add_f32 v96, v96, v100
v_add_f32 v97, v97, v101
v_add_f32 v98, v98, v102
buffer_load_dwordx4 v3, s[8:11], s37 offen offset:1024 sc1 lds
v_add_f32 v99, v99, v103
s_nop 0
v_add_f32_dpp v96, v96, v96 row_ror:8 row_mask:0xf bank_mask:0xf
buffer_load_dwordx4 v3, s[8:11], s37 offen offset:2048 sc1 lds
v_add_f32_dpp v97, v97, v97 row_ror:8 row_mask:0xf bank_mask:0xf
v_add_f32_dpp v98, v98, v98 row_ror:8 row_mask:0xf bank_mask:0xf
v_add_f32_dpp v99, v99, v99 row_ror:8 row_mask:0xf bank_mask:0xf
v_mul_f32 v96, 0x3a800000, v96
buffer_load_dwordx4 v3, s[8:11], s37 offen offset:3072 sc1 lds
v_mul_f32 v97, 0x3a800000, v97
v_mul_f32 v98, 0x3a800000, v98
v_mul_f32 v99, 0x3a800000, v99
s_add_u32 s38, s35, 6
s_and_b32 s38, s38, 15
s_mul_i32 s38, s38, 458752
s_add_u32 m0, s50, 0
s_nop 0
buffer_load_dwordx4 v6, s[16:19], s38 offen lds
v_fma_f32 v97, -v96, v96, v97
v_fma_f32 v99, -v98, v98, v99
v_max_f32 v97, 0, v97
s_add_u32 m0, s50, 1024
s_nop 0
buffer_load_dwordx4 v7, s[16:19], s38 offen lds
v_max_f32 v99, 0, v99
v_add_f32 v97, 0x3727c5ac, v97
v_add_f32 v99, 0x3727c5ac, v99
v_rsq_f32 v97, v97
s_add_u32 m0, s50, 2048
s_nop 0
buffer_load_dwordx4 v8, s[16:19], s38 offen lds
v_rsq_f32 v99, v99
v_and_b32 v100, 7, v1
s_lshl_b32 s43, s47, 8
s_add_u32 m0, s50, 3072
s_add_u32 s38, s38, 114688
buffer_load_dwordx4 v6, s[16:19], s38 offen lds
s_add_u32 s43, s43, 147456
v_lshl_add_u32 v100, v100, 4, s43
v_lshrrev_b32 v101, 5, v1
v_lshl_add_u32 v100, v101, 7, v100
s_add_u32 m0, s50, 4096
s_nop 0
buffer_load_dwordx4 v7, s[16:19], s38 offen lds
s_add_u32 m0, s50, 5120
s_nop 0
buffer_load_dwordx4 v8, s[16:19], s38 offen lds
s_waitcnt vmcnt(10)
s_barrier
ds_write_b128 v100, v[96:99]
s_waitcnt lgkmcnt(0)
s_add_u32 s37, s35, 7
s_and_b32 s37, s37, 15
s_mul_i32 s37, s37, 16384
s_add_u32 m0, s39, 49152
s_nop 0
buffer_load_dwordx4 v3, s[8:11], s37 offen sc1 lds
s_load_dword s3, s[4:5], 93312
buffer_load_dwordx4 v3, s[8:11], s37 offen offset:1024 sc1 lds
s_load_dword s3, s[4:5], 93376
s_and_b32 s44, s36, 3
buffer_load_dwordx4 v3, s[8:11], s37 offen offset:2048 sc1 lds
s_mul_i32 s43, s2, 28672
buffer_load_dwordx4 v3, s[8:11], s37 offen offset:3072 sc1 lds
s_mul_i32 s44, s44, 7168
s_add_u32 s43, s43, s44
s_add_u32 s38, s35, 7
s_and_b32 s38, s38, 15
s_mul_i32 s38, s38, 458752
s_add_u32 m0, s50, 49152
s_nop 0
buffer_load_dwordx4 v6, s[16:19], s38 offen lds
s_add_u32 s4, s76, s43
s_add_u32 m0, s50, 50176
s_nop 0
buffer_load_dwordx4 v7, s[16:19], s38 offen lds
s_addc_u32 s5, s77, 0
s_load_dword s3, s[4:5], 0
s_add_u32 m0, s50, 51200
s_nop 0
buffer_load_dwordx4 v8, s[16:19], s38 offen lds
s_load_dword s3, s[4:5], 64
s_add_u32 m0, s50, 52224
s_add_u32 s38, s38, 114688
buffer_load_dwordx4 v6, s[16:19], s38 offen lds
s_load_dword s3, s[4:5], 128
s_load_dword s3, s[4:5], 192
s_add_u32 m0, s50, 53248
s_nop 0
buffer_load_dwordx4 v7, s[16:19], s38 offen lds
s_add_u32 m0, s50, 54272
s_nop 0
buffer_load_dwordx4 v8, s[16:19], s38 offen lds
s_waitcnt vmcnt(10)
s_barrier
s_add_u32 s37, s35, 8
s_and_b32 s37, s37, 15
s_mul_i32 s37, s37, 16384
s_add_u32 m0, s39, 98304
s_nop 0
buffer_load_dwordx4 v3, s[8:11], s37 offen sc1 lds
s_load_dword s3, s[4:5], 256
s_load_dword s3, s[4:5], 320
s_load_dword s3, s[4:5], 384
buffer_load_dwordx4 v3, s[8:11], s37 offen offset:1024 sc1 lds
s_load_dword s3, s[4:5], 448
s_load_dword s3, s[4:5], 512
s_load_dword s3, s[4:5], 576
buffer_load_dwordx4 v3, s[8:11], s37 offen offset:2048 sc1 lds
v_lshrrev_b32 v28, 2, v1
v_and_b32 v29, 7, v28
v_mul_u32_u24 v28, 256, v28
buffer_load_dwordx4 v3, s[8:11], s37 offen offset:3072 sc1 lds
v_lshl_add_u32 v28, v29, 5, v28
v_and_b32 v29, 3, v1
v_lshl_add_u32 v11, v29, 3, v28
s_lshl_b32 s43, s63, 7
s_add_u32 s38, s35, 8
s_and_b32 s38, s38, 15
s_mul_i32 s38, s38, 458752
s_add_u32 m0, s50, 98304
s_nop 0
buffer_load_dwordx4 v6, s[16:19], s38 offen lds
v_xor_b32 v11, s43, v11
v_add_u32 v11, 16384, v11
v_xor_b32 v12, 32, v11
s_add_u32 m0, s50, 99328
s_nop 0
buffer_load_dwordx4 v7, s[16:19], s38 offen lds
v_xor_b32 v13, 64, v11
v_xor_b32 v14, 96, v11
v_add_u32 v15, 49152, v11
s_add_u32 m0, s50, 100352
s_nop 0
buffer_load_dwordx4 v8, s[16:19], s38 offen lds
v_add_u32 v16, 49152, v12
v_add_u32 v17, 49152, v13
s_branch Lov_14
.p2align 12
.fill 112, 4, 0xbf800000
Lst_14_0:
s_branch Lwr_160
Lst_14_1:
s_branch Lst_18_0
s_nop 0
Lov_14:
v_add_u32 v18, 49152, v14
s_add_u32 m0, s50, 101376
s_add_u32 s38, s38, 114688
buffer_load_dwordx4 v6, s[16:19], s38 offen lds
v_add_u32 v19, 98304, v11
v_add_u32 v20, 98304, v12
v_add_u32 v21, 98304, v13
v_add_u32 v22, 98304, v14
s_add_u32 m0, s50, 102400
s_nop 0
buffer_load_dwordx4 v7, s[16:19], s38 offen lds
s_add_u32 m0, s50, 103424
s_nop 0
buffer_load_dwordx4 v8, s[16:19], s38 offen lds
s_waitcnt vmcnt(10)
s_barrier
s_cmp_eq_u32 s47, 3
s_cbranch_scc0 Lw_129
s_mul_i32 s60, s35, 96
s_add_u32 s61, s60, 95
s_and_b32 s60, s60, 0xff80
s_and_b32 s61, s61, 0xff80
s_add_u32 s60, s60, 28323840
s_add_u32 s61, s61, 28323840
s_load_dword s92, s[82:83], s60 glc
s_load_dword s93, s[82:83], s61 glc
Lw_129:
s_add_u32 s37, s35, 9
s_and_b32 s37, s37, 15
s_mul_i32 s37, s37, 16384
s_add_u32 m0, s39, 0
s_nop 0
buffer_load_dwordx4 v3, s[8:11], s37 offen sc1 lds
buffer_load_dwordx4 v3, s[8:11], s37 offen offset:1024 sc1 lds
buffer_load_dwordx4 v3, s[8:11], s37 offen offset:2048 sc1 lds
buffer_load_dwordx4 v3, s[8:11], s37 offen offset:3072 sc1 lds
s_add_u32 s38, s35, 9
s_and_b32 s38, s38, 15
s_mul_i32 s38, s38, 458752
s_add_u32 m0, s50, 0
s_nop 0
buffer_load_dwordx4 v6, s[16:19], s38 offen lds
s_add_u32 m0, s50, 1024
s_nop 0
buffer_load_dwordx4 v7, s[16:19], s38 offen lds
s_add_u32 m0, s50, 2048
s_nop 0
buffer_load_dwordx4 v8, s[16:19], s38 offen lds
s_add_u32 m0, s50, 3072
s_add_u32 s38, s38, 114688
buffer_load_dwordx4 v6, s[16:19], s38 offen lds
s_add_u32 m0, s50, 4096
s_nop 0
buffer_load_dwordx4 v7, s[16:19], s38 offen lds
s_add_u32 m0, s50, 5120
s_nop 0
buffer_load_dwordx4 v8, s[16:19], s38 offen lds
s_waitcnt vmcnt(10)
s_barrier
s_add_u32 s37, s35, 10
s_and_b32 s37, s37, 15
s_mul_i32 s37, s37, 16384
s_add_u32 m0, s39, 49152
s_nop 0
buffer_load_dwordx4 v3, s[8:11], s37 offen sc1 lds
buffer_load_dwordx4 v3, s[8:11], s37 offen offset:1024 sc1 lds
buffer_load_dwordx4 v3, s[8:11], s37 offen offset:2048 sc1 lds
buffer_load_dwordx4 v3, s[8:11], s37 offen offset:3072 sc1 lds
s_add_u32 s38, s35, 10
s_and_b32 s38, s38, 15
s_mul_i32 s38, s38, 458752
s_add_u32 m0, s50, 49152
s_nop 0
buffer_load_dwordx4 v6, s[16:19], s38 offen lds
s_add_u32 m0, s50, 50176
s_nop 0
buffer_load_dwordx4 v7, s[16:19], s38 offen lds
s_add_u32 m0, s50, 51200
s_nop 0
buffer_load_dwordx4 v8, s[16:19], s38 offen lds
s_add_u32 m0, s50, 52224
s_add_u32 s38, s38, 114688
buffer_load_dwordx4 v6, s[16:19], s38 offen lds
s_add_u32 m0, s50, 53248
s_nop 0
buffer_load_dwordx4 v7, s[16:19], s38 offen lds
s_add_u32 m0, s50, 54272
s_nop 0
buffer_load_dwordx4 v8, s[16:19], s38 offen lds
s_mov_b32 s38, 0
buffer_load_dwordx4 v[40:43], v24, s[88:91], s38 offen
s_mov_b32 s38, 28672
buffer_load_dwordx4 v[44:47], v24, s[88:91], s38 offen
s_mov_b32 s38, 57344
buffer_load_dwordx4 v[48:51], v24, s[88:91], s38 offen
s_mov_b32 s38, 86016
buffer_load_dwordx4 v[52:55], v24, s[88:91], s38 offen
s_mov_b32 s38, 114688
buffer_load_dwordx4 v[56:59], v24, s[88:91], s38 offen
s_mov_b32 s38, 143360
buffer_load_dwordx4 v[60:63], v24, s[88:91], s38 offen
s_mov_b32 s38, 172032
buffer_load_dwordx4 v[64:67], v24, s[88:91], s38 offen
s_mov_b32 s38, 200704
buffer_load_dwordx4 v[68:71], v24, s[88:91], s38 offen
s_waitcnt vmcnt(18)
s_cmp_eq_u32 s47, 3
s_cbranch_scc0 Lw_130
s_mov_b32 s41, 0x40000
Lcp_131:
s_waitcnt lgkmcnt(0)
s_and_b32 s92, s92, s93
s_cmp_eq_u32 s92, 16
s_cbranch_scc1 Lco_132
s_load_dword s92, s[82:83], s60 glc
s_load_dword s93, s[82:83], s61 glc
s_sub_u32 s41, s41, 1
s_cmp_lg_u32 s41, 0
s_cbranch_scc1 Lcp_131
s_waitcnt lgkmcnt(0)
Lco_132:
Lw_130:
s_barrier
s_mov_b32 s45, s47
s_cmp_ge_u32 s45, 3
s_cselect_b32 s43, 1, 0
s_mul_i32 s44, s43, 3
s_sub_u32 s45, s45, s44
s_lshl_b32 s45, s45, 7
s_mul_i32 s52, s43, 896
s_add_u32 s52, s52, s45
s_add_u32 s52, s52, 148992
s_mul_i32 s43, s43, 14336
s_add_u32 s43, s43, s45
s_mul_i32 s44, s35, 384
s_add_u32 s43, s43, s44
s_add_u32 s60, s43, 8192
s_add_u32 s45, s47, 4
s_min_u32 s45, s45, 5
s_cmp_ge_u32 s45, 3
s_cselect_b32 s43, 1, 0
s_mul_i32 s44, s43, 3
s_sub_u32 s45, s45, s44
s_lshl_b32 s45, s45, 7
s_mul_i32 s53, s43, 896
s_add_u32 s53, s53, s45
s_add_u32 s53, s53, 148992
s_mul_i32 s43, s43, 14336
s_add_u32 s43, s43, s45
s_mul_i32 s44, s35, 384
s_add_u32 s43, s43, s44
s_add_u32 s61, s43, 8192
v_lshrrev_b32 v104, 3, v1
v_mul_u32_u24 v104, 28672, v104
v_and_b32 v105, 7, v1
v_lshl_add_u32 v104, v105, 4, v104
buffer_load_dwordx4 v[96:99], v104, s[84:87], s60 offen sc1
s_load_dword s3, s[4:5], 640
buffer_load_dwordx4 v[100:103], v104, s[84:87], s61 offen sc1
s_load_dword s3, s[4:5], 704
s_add_u32 s37, s35, 11
s_and_b32 s37, s37, 15
s_mul_i32 s37, s37, 16384
s_add_u32 m0, s39, 98304
s_nop 0
buffer_load_dwordx4 v3, s[8:11], s37 offen sc1 lds
s_load_dword s3, s[4:5], 768
buffer_load_dwordx4 v3, s[8:11], s37 offen offset:1024 sc1 lds
s_load_dword s3, s[4:5], 832
s_load_dword s3, s[4:5], 896
buffer_load_dwordx4 v3, s[8:11], s37 offen offset:2048 sc1 lds
s_load_dword s3, s[4:5], 960
buffer_load_dwordx4 v3, s[8:11], s37 offen offset:3072 sc1 lds
v_cmp_gt_u32 vcc, 32, v1
s_add_u32 s38, s35, 11
s_and_b32 s38, s38, 15
s_mul_i32 s38, s38, 458752
s_add_u32 m0, s50, 98304
s_nop 0
buffer_load_dwordx4 v6, s[16:19], s38 offen lds
v_mov_b32 v104, s52
v_mov_b32 v106, s53
s_add_u32 m0, s50, 99328
s_nop 0
buffer_load_dwordx4 v7, s[16:19], s38 offen lds
v_cndmask_b32 v104, v106, v104, vcc
s_add_u32 m0, s50, 100352
s_nop 0
buffer_load_dwordx4 v8, s[16:19], s38 offen lds
v_lshl_add_u32 v104, v105, 4, v104
s_add_u32 m0, s50, 101376
s_add_u32 s38, s38, 114688
buffer_load_dwordx4 v6, s[16:19], s38 offen lds
v_bfe_u32 v105, v1, 4, 1
v_lshl_add_u32 v104, v105, 2, v104
s_add_u32 m0, s50, 102400
s_nop 0
buffer_load_dwordx4 v7, s[16:19], s38 offen lds
s_add_u32 m0, s50, 103424
s_nop 0
buffer_load_dwordx4 v8, s[16:19], s38 offen lds
s_waitcnt vmcnt(20)
s_barrier
s_add_u32 s37, s35, 12
s_and_b32 s37, s37, 15
s_mul_i32 s37, s37, 16384
s_add_u32 m0, s39, 0
s_nop 0
buffer_load_dwordx4 v3, s[8:11], s37 offen sc1 lds
buffer_load_dwordx4 v3, s[8:11], s37 offen offset:1024 sc1 lds
buffer_load_dwordx4 v3, s[8:11], s37 offen offset:2048 sc1 lds
buffer_load_dwordx4 v3, s[8:11], s37 offen offset:3072 sc1 lds
s_add_u32 s38, s35, 12
s_and_b32 s38, s38, 15
s_mul_i32 s38, s38, 458752
s_add_u32 m0, s50, 0
s_nop 0
buffer_load_dwordx4 v6, s[16:19], s38 offen lds
s_add_u32 m0, s50, 1024
s_nop 0
buffer_load_dwordx4 v7, s[16:19], s38 offen lds
s_add_u32 m0, s50, 2048
s_nop 0
buffer_load_dwordx4 v8, s[16:19], s38 offen lds
s_add_u32 m0, s50, 3072
s_add_u32 s38, s38, 114688
buffer_load_dwordx4 v6, s[16:19], s38 offen lds
s_add_u32 m0, s50, 4096
s_nop 0
buffer_load_dwordx4 v7, s[16:19], s38 offen lds
s_add_u32 m0, s50, 5120
s_nop 0
buffer_load_dwordx4 v8, s[16:19], s38 offen lds
s_waitcnt vmcnt(10)
s_barrier
v_permlane32_swap_b32 v96, v100
v_permlane32_swap_b32 v97, v101
v_permlane32_swap_b32 v98, v102
v_permlane32_swap_b32 v99, v103
v_add_f32 v96, v96, v100
v_add_f32 v97, v97, v101
v_add_f32 v98, v98, v102
v_add_f32 v99, v99, v103
s_nop 1
v_permlane16_swap_b32 v96, v97
v_permlane16_swap_b32 v98, v99
v_add_f32 v96, v96, v97
v_add_f32 v98, v98, v99
s_nop 1
v_add_f32_dpp v96, v96, v96 row_ror:8 row_mask:0xf bank_mask:0xf
v_add_f32_dpp v98, v98, v98 row_ror:8 row_mask:0xf bank_mask:0xf
ds_write_b32 v104, v96
ds_write_b32 v104, v98 offset:8
s_waitcnt lgkmcnt(0)
s_add_u32 s37, s35, 13
s_and_b32 s37, s37, 15
s_mul_i32 s37, s37, 16384
s_add_u32 m0, s39, 49152
s_nop 0
buffer_load_dwordx4 v3, s[8:11], s37 offen sc1 lds
s_load_dword s3, s[4:5], 1024
s_load_dword s3, s[4:5], 1088
s_load_dword s3, s[4:5], 1152
s_load_dword s3, s[4:5], 1216
buffer_load_dwordx4 v3, s[8:11], s37 offen offset:1024 sc1 lds
s_load_dword s3, s[4:5], 1280
s_load_dword s3, s[4:5], 1344
v_lshlrev_b32 v72, 16, v40
v_and_b32 v73, 0xffff0000, v40
v_lshlrev_b32 v74, 16, v41
buffer_load_dwordx4 v3, s[8:11], s37 offen offset:2048 sc1 lds
v_and_b32 v75, 0xffff0000, v41
v_lshlrev_b32 v76, 16, v42
v_and_b32 v77, 0xffff0000, v42
v_lshlrev_b32 v78, 16, v43
v_and_b32 v79, 0xffff0000, v43
buffer_load_dwordx4 v3, s[8:11], s37 offen offset:3072 sc1 lds
v_lshlrev_b32 v80, 16, v44
v_and_b32 v81, 0xffff0000, v44
v_lshlrev_b32 v82, 16, v45
v_and_b32 v83, 0xffff0000, v45
v_lshlrev_b32 v84, 16, v46
s_add_u32 s38, s35, 13
s_and_b32 s38, s38, 15
s_mul_i32 s38, s38, 458752
s_add_u32 m0, s50, 49152
s_nop 0
buffer_load_dwordx4 v6, s[16:19], s38 offen lds
v_and_b32 v85, 0xffff0000, v46
v_lshlrev_b32 v86, 16, v47
v_and_b32 v87, 0xffff0000, v47
v_add_f32 v72, v72, v80
v_add_f32 v73, v73, v81
s_add_u32 m0, s50, 50176
s_nop 0
buffer_load_dwordx4 v7, s[16:19], s38 offen lds
v_add_f32 v74, v74, v82
v_add_f32 v75, v75, v83
v_add_f32 v76, v76, v84
v_add_f32 v77, v77, v85
v_add_f32 v78, v78, v86
s_add_u32 m0, s50, 51200
s_nop 0
buffer_load_dwordx4 v8, s[16:19], s38 offen lds
v_add_f32 v79, v79, v87
v_lshlrev_b32 v80, 16, v48
v_and_b32 v81, 0xffff0000, v48
v_lshlrev_b32 v82, 16, v49
v_and_b32 v83, 0xffff0000, v49
s_add_u32 m0, s50, 52224
s_add_u32 s38, s38, 114688
buffer_load_dwordx4 v6, s[16:19], s38 offen lds
v_lshlrev_b32 v84, 16, v50
v_and_b32 v85, 0xffff0000, v50
v_lshlrev_b32 v86, 16, v51
v_and_b32 v87, 0xffff0000, v51
v_add_f32 v72, v72, v80
s_add_u32 m0, s50, 53248
s_nop 0
buffer_load_dwordx4 v7, s[16:19], s38 offen lds
s_add_u32 m0, s50, 54272
s_nop 0
buffer_load_dwordx4 v8, s[16:19], s38 offen lds
s_waitcnt vmcnt(10)
s_barrier
s_add_u32 s37, s35, 14
s_and_b32 s37, s37, 15
s_mul_i32 s37, s37, 16384
s_add_u32 m0, s39, 98304
s_nop 0
buffer_load_dwordx4 v3, s[8:11], s37 offen sc1 lds
s_load_dword s3, s[4:5], 1408
s_load_dword s3, s[4:5], 1472
s_load_dword s3, s[4:5], 1536
s_load_dword s3, s[4:5], 1600
s_load_dword s3, s[4:5], 1664
buffer_load_dwordx4 v3, s[8:11], s37 offen offset:1024 sc1 lds
s_load_dword s3, s[4:5], 1728
v_add_f32 v73, v73, v81
v_add_f32 v74, v74, v82
v_add_f32 v75, v75, v83
v_add_f32 v76, v76, v84
buffer_load_dwordx4 v3, s[8:11], s37 offen offset:2048 sc1 lds
v_add_f32 v77, v77, v85
v_add_f32 v78, v78, v86
v_add_f32 v79, v79, v87
v_lshlrev_b32 v80, 16, v52
v_and_b32 v81, 0xffff0000, v52
buffer_load_dwordx4 v3, s[8:11], s37 offen offset:3072 sc1 lds
v_lshlrev_b32 v82, 16, v53
v_and_b32 v83, 0xffff0000, v53
v_lshlrev_b32 v84, 16, v54
v_and_b32 v85, 0xffff0000, v54
v_lshlrev_b32 v86, 16, v55
s_add_u32 s38, s35, 14
s_and_b32 s38, s38, 15
s_mul_i32 s38, s38, 458752
s_add_u32 m0, s50, 98304
s_nop 0
buffer_load_dwordx4 v6, s[16:19], s38 offen lds
v_and_b32 v87, 0xffff0000, v55
v_add_f32 v72, v72, v80
v_add_f32 v73, v73, v81
v_add_f32 v74, v74, v82
v_add_f32 v75, v75, v83
s_add_u32 m0, s50, 99328
s_nop 0
buffer_load_dwordx4 v7, s[16:19], s38 offen lds
v_add_f32 v76, v76, v84
v_add_f32 v77, v77, v85
v_add_f32 v78, v78, v86
v_add_f32 v79, v79, v87
v_lshlrev_b32 v80, 16, v56
s_add_u32 m0, s50, 100352
s_nop 0
buffer_load_dwordx4 v8, s[16:19], s38 offen lds
v_and_b32 v81, 0xffff0000, v56
v_lshlrev_b32 v82, 16, v57
v_and_b32 v83, 0xffff0000, v57
v_lshlrev_b32 v84, 16, v58
v_and_b32 v85, 0xffff0000, v58
s_add_u32 m0, s50, 101376
s_add_u32 s38, s38, 114688
buffer_load_dwordx4 v6, s[16:19], s38 offen lds
v_lshlrev_b32 v86, 16, v59
v_and_b32 v87, 0xffff0000, v59
v_add_f32 v72, v72, v80
v_add_f32 v73, v73, v81
v_add_f32 v74, v74, v82
s_add_u32 m0, s50, 102400
s_nop 0
buffer_load_dwordx4 v7, s[16:19], s38 offen lds
s_add_u32 m0, s50, 103424
s_nop 0
buffer_load_dwordx4 v8, s[16:19], s38 offen lds
s_waitcnt vmcnt(10)
s_barrier
s_add_u32 s37, s35, 15
s_and_b32 s37, s37, 15
s_mul_i32 s37, s37, 16384
s_add_u32 m0, s39, 0
s_nop 0
buffer_load_dwordx4 v3, s[8:11], s37 offen sc1 lds
v_add_f32 v75, v75, v83
v_add_f32 v76, v76, v84
v_add_f32 v77, v77, v85
v_add_f32 v78, v78, v86
buffer_load_dwordx4 v3, s[8:11], s37 offen offset:1024 sc1 lds
v_add_f32 v79, v79, v87
v_lshlrev_b32 v80, 16, v60
v_and_b32 v81, 0xffff0000, v60
v_lshlrev_b32 v82, 16, v61
buffer_load_dwordx4 v3, s[8:11], s37 offen offset:2048 sc1 lds
v_and_b32 v83, 0xffff0000, v61
v_lshlrev_b32 v84, 16, v62
v_and_b32 v85, 0xffff0000, v62
v_lshlrev_b32 v86, 16, v63
buffer_load_dwordx4 v3, s[8:11], s37 offen offset:3072 sc1 lds
v_and_b32 v87, 0xffff0000, v63
v_add_f32 v72, v72, v80
v_add_f32 v73, v73, v81
v_add_f32 v74, v74, v82
s_add_u32 s38, s35, 15
s_and_b32 s38, s38, 15
s_mul_i32 s38, s38, 458752
s_add_u32 m0, s50, 0
s_nop 0
buffer_load_dwordx4 v6, s[16:19], s38 offen lds
v_add_f32 v75, v75, v83
v_add_f32 v76, v76, v84
v_add_f32 v77, v77, v85
v_add_f32 v78, v78, v86
s_add_u32 m0, s50, 1024
s_nop 0
buffer_load_dwordx4 v7, s[16:19], s38 offen lds
v_add_f32 v79, v79, v87
v_lshlrev_b32 v80, 16, v64
v_and_b32 v81, 0xffff0000, v64
v_lshlrev_b32 v82, 16, v65
s_add_u32 m0, s50, 2048
s_nop 0
buffer_load_dwordx4 v8, s[16:19], s38 offen lds
v_and_b32 v83, 0xffff0000, v65
v_lshlrev_b32 v84, 16, v66
v_and_b32 v85, 0xffff0000, v66
v_lshlrev_b32 v86, 16, v67
s_add_u32 m0, s50, 3072
s_add_u32 s38, s38, 114688
buffer_load_dwordx4 v6, s[16:19], s38 offen lds
v_and_b32 v87, 0xffff0000, v67
v_add_f32 v72, v72, v80
v_add_f32 v73, v73, v81
v_add_f32 v74, v74, v82
v_add_f32 v75, v75, v83
s_add_u32 m0, s50, 4096
s_nop 0
buffer_load_dwordx4 v7, s[16:19], s38 offen lds
s_add_u32 m0, s50, 5120
s_nop 0
buffer_load_dwordx4 v8, s[16:19], s38 offen lds
s_waitcnt vmcnt(10)
s_barrier
s_add_u32 s37, s35, 0
s_and_b32 s37, s37, 15
s_mul_i32 s37, s37, 16384
s_add_u32 m0, s39, 49152
s_nop 0
buffer_load_dwordx4 v3, s[8:11], s37 offen sc1 lds
v_add_f32 v76, v76, v84
v_add_f32 v77, v77, v85
v_add_f32 v78, v78, v86
buffer_load_dwordx4 v3, s[8:11], s37 offen offset:1024 sc1 lds
v_add_f32 v79, v79, v87
v_lshlrev_b32 v80, 16, v68
v_and_b32 v81, 0xffff0000, v68
buffer_load_dwordx4 v3, s[8:11], s37 offen offset:2048 sc1 lds
v_lshlrev_b32 v82, 16, v69
v_and_b32 v83, 0xffff0000, v69
v_lshlrev_b32 v84, 16, v70
v_and_b32 v85, 0xffff0000, v70
buffer_load_dwordx4 v3, s[8:11], s37 offen offset:3072 sc1 lds
v_lshlrev_b32 v86, 16, v71
v_and_b32 v87, 0xffff0000, v71
v_add_f32 v72, v72, v80
s_add_u32 s38, s35, 0
s_and_b32 s38, s38, 15
s_mul_i32 s38, s38, 458752
s_add_u32 m0, s40, 49152
s_nop 0
buffer_load_dwordx4 v4, s[12:15], s38 offen lds
v_add_f32 v73, v73, v81
v_add_f32 v74, v74, v82
v_add_f32 v75, v75, v83
v_add_f32 v76, v76, v84
s_add_u32 m0, s40, 50176
s_nop 0
buffer_load_dwordx4 v5, s[12:15], s38 offen lds
v_add_f32 v77, v77, v85
v_add_f32 v78, v78, v86
v_add_f32 v79, v79, v87
s_add_u32 m0, s40, 51200
s_add_u32 s38, s38, 57344
buffer_load_dwordx4 v4, s[12:15], s38 offen lds
s_nop 0
v_permlane32_swap_b32 v72, v76
v_permlane32_swap_b32 v73, v77
s_add_u32 m0, s40, 52224
s_nop 0
buffer_load_dwordx4 v5, s[12:15], s38 offen lds
v_permlane32_swap_b32 v74, v78
v_permlane32_swap_b32 v75, v79
v_add_f32 v72, v72, v76
v_add_f32 v73, v73, v77
s_add_u32 m0, s40, 53248
s_add_u32 s38, s38, 57344
buffer_load_dwordx4 v4, s[12:15], s38 offen lds
v_add_f32 v74, v74, v78
v_add_f32 v75, v75, v79
s_nop 0
s_add_u32 m0, s40, 54272
s_nop 0
buffer_load_dwordx4 v5, s[12:15], s38 offen lds
v_permlane16_swap_b32 v72, v74
v_permlane16_swap_b32 v73, v75
v_add_f32 v72, v72, v74
v_add_f32 v73, v73, v75
s_add_u32 m0, s40, 55296
s_add_u32 s38, s38, 57344
buffer_load_dwordx4 v4, s[12:15], s38 offen lds
s_add_u32 m0, s40, 56320
s_nop 0
buffer_load_dwordx4 v5, s[12:15], s38 offen lds
s_waitcnt vmcnt(12)
s_barrier
s_lshl_b32 s43, s47, 9
s_add_u32 s43, s43, 153600
v_and_b32 v80, 15, v1
v_lshl_add_u32 v80, v80, 5, s43
v_lshrrev_b32 v81, 4, v1
v_lshl_add_u32 v80, v81, 3, v80
ds_write_b64 v80, v[72:73]
s_waitcnt lgkmcnt(0)
s_add_u32 s37, s35, 1
s_and_b32 s37, s37, 15
s_mul_i32 s37, s37, 16384
s_add_u32 m0, s39, 98304
s_nop 0
buffer_load_dwordx4 v3, s[8:11], s37 offen sc1 lds
s_bfe_u32 s61, s35, 0x10002
s_lshr_b32 s60, s35, 3
buffer_load_dwordx4 v3, s[8:11], s37 offen offset:1024 sc1 lds
s_lshl_b32 s60, s60, 2
s_and_b32 s43, s35, 3
s_add_u32 s60, s60, s43
buffer_load_dwordx4 v3, s[8:11], s37 offen offset:2048 sc1 lds
s_lshl_b32 s43, s60, 8
s_add_u32 s28, s76, s43
buffer_load_dwordx4 v3, s[8:11], s37 offen offset:3072 sc1 lds
s_addc_u32 s29, s77, 0
s_mov_b32 s30, 7338240
s_mov_b32 s31, 0x20000
s_add_u32 s38, s35, 1
s_and_b32 s38, s38, 15
s_mul_i32 s38, s38, 458752
s_add_u32 m0, s40, 98304
s_nop 0
buffer_load_dwordx4 v4, s[12:15], s38 offen lds
s_mul_i32 s52, s61, 196608
s_mul_i32 s53, s61, 1572864
s_mul_i32 s90, s61, 163840
s_add_u32 m0, s40, 99328
s_nop 0
buffer_load_dwordx4 v5, s[12:15], s38 offen lds
s_mul_i32 s91, s61, 1310720
s_lshl_b32 s51, s47, 11
s_add_u32 m0, s40, 100352
s_add_u32 s38, s38, 57344
buffer_load_dwordx4 v4, s[12:15], s38 offen lds
s_lshl_b32 s44, s47, 15
v_lshrrev_b32 v122, 4, v1
v_lshlrev_b32 v123, 1, v122
s_add_u32 m0, s40, 101376
s_nop 0
buffer_load_dwordx4 v5, s[12:15], s38 offen lds
v_and_b32 v23, 15, v1
v_xor_b32 v23, v23, v123
s_add_u32 m0, s40, 102400
s_add_u32 s38, s38, 57344
buffer_load_dwordx4 v4, s[12:15], s38 offen lds
v_lshlrev_b32 v23, 4, v23
v_mul_u32_u24 v122, 2048, v122
v_add_u32 v23, v23, v122
s_add_u32 m0, s40, 103424
s_nop 0
buffer_load_dwordx4 v5, s[12:15], s38 offen lds
v_add_u32 v23, s44, v23
v_xor_b32 v24, 128, v23
v_add_u32 v24, 8192, v24
s_add_u32 m0, s40, 104448
s_add_u32 s38, s38, 57344
buffer_load_dwordx4 v4, s[12:15], s38 offen lds
s_add_u32 m0, s40, 105472
s_nop 0
s_branch Lov_15
.p2align 12
.fill 112, 4, 0xbf800000
Lst_15_0:
s_branch Lwr_169
s_nop 0
s_nop 0
Lov_15:
buffer_load_dwordx4 v5, s[12:15], s38 offen lds
s_waitcnt vmcnt(12)
s_barrier
ds_read_b128 v[28:31], v9 offset:49152
ds_read_b64_tr_b16 v[44:45], v15 offset:0
ds_read_b64_tr_b16 v[46:47], v15 offset:4096
ds_read_b64_tr_b16 v[48:49], v16 offset:0
ds_read_b64_tr_b16 v[50:51], v16 offset:4096
ds_read_b64_tr_b16 v[52:53], v17 offset:0
ds_read_b64_tr_b16 v[54:55], v17 offset:4096
ds_read_b64_tr_b16 v[56:57], v18 offset:0
ds_read_b64_tr_b16 v[58:59], v18 offset:4096
ds_read_b64_tr_b16 v[60:61], v15 offset:16384
ds_read_b64_tr_b16 v[62:63], v15 offset:20480
ds_read_b64_tr_b16 v[64:65], v16 offset:16384
ds_read_b64_tr_b16 v[66:67], v16 offset:20480
ds_read_b64_tr_b16 v[68:69], v17 offset:16384
ds_read_b64_tr_b16 v[70:71], v17 offset:20480
ds_read_b64_tr_b16 v[72:73], v18 offset:16384
ds_read_b64_tr_b16 v[74:75], v18 offset:20480
ds_read_b128 v[32:35], v9 offset:50176
ds_read_b128 v[36:39], v9 offset:51200
ds_read_b128 v[40:43], v9 offset:52224
s_waitcnt lgkmcnt(0)
v_mfma_f32_16x16x32_bf16 v[124:127], v[44:47], v[28:31], 0
ds_read_b128 v[76:79], v9 offset:57344
v_mfma_f32_16x16x32_bf16 v[128:131], v[48:51], v[28:31], 0
ds_read_b64_tr_b16 v[92:93], v15 offset:8192
v_mfma_f32_16x16x32_bf16 v[132:135], v[52:55], v[28:31], 0
ds_read_b64_tr_b16 v[94:95], v15 offset:12288
v_mfma_f32_16x16x32_bf16 v[136:139], v[56:59], v[28:31], 0
ds_read_b64_tr_b16 v[96:97], v16 offset:8192
v_mfma_f32_16x16x32_bf16 v[140:143], v[60:63], v[28:31], 0
ds_read_b64_tr_b16 v[98:99], v16 offset:12288
v_mfma_f32_16x16x32_bf16 v[144:147], v[64:67], v[28:31], 0
ds_read_b64_tr_b16 v[100:101], v17 offset:8192
v_mfma_f32_16x16x32_bf16 v[148:151], v[68:71], v[28:31], 0
ds_read_b64_tr_b16 v[102:103], v17 offset:12288
v_mfma_f32_16x16x32_bf16 v[152:155], v[72:75], v[28:31], 0
ds_read_b64_tr_b16 v[104:105], v18 offset:8192
v_mfma_f32_16x16x32_bf16 v[184:187], v[72:75], v[32:35], 0
ds_read_b64_tr_b16 v[106:107], v18 offset:12288
v_mfma_f32_16x16x32_bf16 v[180:183], v[68:71], v[32:35], 0
ds_read_b64_tr_b16 v[108:109], v15 offset:24576
v_mfma_f32_16x16x32_bf16 v[176:179], v[64:67], v[32:35], 0
ds_read_b64_tr_b16 v[110:111], v15 offset:28672
v_mfma_f32_16x16x32_bf16 v[172:175], v[60:63], v[32:35], 0
ds_read_b64_tr_b16 v[112:113], v16 offset:24576
v_mfma_f32_16x16x32_bf16 v[168:171], v[56:59], v[32:35], 0
ds_read_b64_tr_b16 v[114:115], v16 offset:28672
v_mfma_f32_16x16x32_bf16 v[164:167], v[52:55], v[32:35], 0
ds_read_b64_tr_b16 v[116:117], v17 offset:24576
v_mfma_f32_16x16x32_bf16 v[160:163], v[48:51], v[32:35], 0
ds_read_b64_tr_b16 v[118:119], v17 offset:28672
v_mfma_f32_16x16x32_bf16 v[156:159], v[44:47], v[32:35], 0
ds_read_b64_tr_b16 v[120:121], v18 offset:24576
v_mfma_f32_16x16x32_bf16 v[188:191], v[44:47], v[36:39], 0
ds_read_b64_tr_b16 v[122:123], v18 offset:28672
v_mfma_f32_16x16x32_bf16 v[192:195], v[48:51], v[36:39], 0
ds_read_b128 v[80:83], v9 offset:58368
v_mfma_f32_16x16x32_bf16 v[196:199], v[52:55], v[36:39], 0
ds_read_b128 v[84:87], v9 offset:59392
v_mfma_f32_16x16x32_bf16 v[200:203], v[56:59], v[36:39], 0
ds_read_b128 v[88:91], v9 offset:60416
v_mfma_f32_16x16x32_bf16 v[204:207], v[60:63], v[36:39], 0
v_mfma_f32_16x16x32_bf16 v[208:211], v[64:67], v[36:39], 0
v_mfma_f32_16x16x32_bf16 v[212:215], v[68:71], v[36:39], 0
v_mfma_f32_16x16x32_bf16 v[216:219], v[72:75], v[36:39], 0
v_mfma_f32_16x16x32_bf16 v[248:251], v[72:75], v[40:43], 0
v_mfma_f32_16x16x32_bf16 v[244:247], v[68:71], v[40:43], 0
v_mfma_f32_16x16x32_bf16 v[240:243], v[64:67], v[40:43], 0
v_mfma_f32_16x16x32_bf16 v[236:239], v[60:63], v[40:43], 0
v_mfma_f32_16x16x32_bf16 v[232:235], v[56:59], v[40:43], 0
v_mfma_f32_16x16x32_bf16 v[228:231], v[52:55], v[40:43], 0
v_mfma_f32_16x16x32_bf16 v[224:227], v[48:51], v[40:43], 0
v_mfma_f32_16x16x32_bf16 v[220:223], v[44:47], v[40:43], 0
s_waitcnt vmcnt(0)
s_waitcnt lgkmcnt(0)
s_barrier
v_mfma_f32_16x16x32_bf16 v[124:127], v[92:95], v[76:79], v[124:127]
ds_read_b128 v[28:31], v10 offset:0
v_mfma_f32_16x16x32_bf16 v[128:131], v[96:99], v[76:79], v[128:131]
ds_read_b64_tr_b16 v[44:45], v19 offset:0
v_mfma_f32_16x16x32_bf16 v[132:135], v[100:103], v[76:79], v[132:135]
ds_read_b64_tr_b16 v[46:47], v19 offset:4096
v_mfma_f32_16x16x32_bf16 v[136:139], v[104:107], v[76:79], v[136:139]
ds_read_b64_tr_b16 v[48:49], v20 offset:0
v_mfma_f32_16x16x32_bf16 v[140:143], v[108:111], v[76:79], v[140:143]
ds_read_b64_tr_b16 v[50:51], v20 offset:4096
v_mfma_f32_16x16x32_bf16 v[144:147], v[112:115], v[76:79], v[144:147]
ds_read_b64_tr_b16 v[52:53], v21 offset:0
v_mfma_f32_16x16x32_bf16 v[148:151], v[116:119], v[76:79], v[148:151]
ds_read_b64_tr_b16 v[54:55], v21 offset:4096
v_mfma_f32_16x16x32_bf16 v[152:155], v[120:123], v[76:79], v[152:155]
ds_read_b64_tr_b16 v[56:57], v22 offset:0
v_mfma_f32_16x16x32_bf16 v[184:187], v[120:123], v[80:83], v[184:187]
ds_read_b64_tr_b16 v[58:59], v22 offset:4096
v_mfma_f32_16x16x32_bf16 v[180:183], v[116:119], v[80:83], v[180:183]
ds_read_b64_tr_b16 v[60:61], v19 offset:16384
v_mfma_f32_16x16x32_bf16 v[176:179], v[112:115], v[80:83], v[176:179]
ds_read_b64_tr_b16 v[62:63], v19 offset:20480
v_mfma_f32_16x16x32_bf16 v[172:175], v[108:111], v[80:83], v[172:175]
ds_read_b64_tr_b16 v[64:65], v20 offset:16384
v_mfma_f32_16x16x32_bf16 v[168:171], v[104:107], v[80:83], v[168:171]
ds_read_b64_tr_b16 v[66:67], v20 offset:20480
v_mfma_f32_16x16x32_bf16 v[164:167], v[100:103], v[80:83], v[164:167]
ds_read_b64_tr_b16 v[68:69], v21 offset:16384
v_mfma_f32_16x16x32_bf16 v[160:163], v[96:99], v[80:83], v[160:163]
ds_read_b64_tr_b16 v[70:71], v21 offset:20480
v_mfma_f32_16x16x32_bf16 v[156:159], v[92:95], v[80:83], v[156:159]
ds_read_b64_tr_b16 v[72:73], v22 offset:16384
v_mfma_f32_16x16x32_bf16 v[188:191], v[92:95], v[84:87], v[188:191]
ds_read_b64_tr_b16 v[74:75], v22 offset:20480
v_mfma_f32_16x16x32_bf16 v[192:195], v[96:99], v[84:87], v[192:195]
ds_read_b128 v[32:35], v10 offset:1024
v_mfma_f32_16x16x32_bf16 v[196:199], v[100:103], v[84:87], v[196:199]
ds_read_b128 v[36:39], v10 offset:2048
v_mfma_f32_16x16x32_bf16 v[200:203], v[104:107], v[84:87], v[200:203]
ds_read_b128 v[40:43], v10 offset:3072
v_mfma_f32_16x16x32_bf16 v[204:207], v[108:111], v[84:87], v[204:207]
v_mfma_f32_16x16x32_bf16 v[208:211], v[112:115], v[84:87], v[208:211]
v_mfma_f32_16x16x32_bf16 v[212:215], v[116:119], v[84:87], v[212:215]
v_mfma_f32_16x16x32_bf16 v[216:219], v[120:123], v[84:87], v[216:219]
v_mfma_f32_16x16x32_bf16 v[248:251], v[120:123], v[88:91], v[248:251]
v_mfma_f32_16x16x32_bf16 v[244:247], v[116:119], v[88:91], v[244:247]
v_mfma_f32_16x16x32_bf16 v[240:243], v[112:115], v[88:91], v[240:243]
v_mfma_f32_16x16x32_bf16 v[236:239], v[108:111], v[88:91], v[236:239]
v_mfma_f32_16x16x32_bf16 v[232:235], v[104:107], v[88:91], v[232:235]
v_mfma_f32_16x16x32_bf16 v[228:231], v[100:103], v[88:91], v[228:231]
v_mfma_f32_16x16x32_bf16 v[224:227], v[96:99], v[88:91], v[224:227]
v_mfma_f32_16x16x32_bf16 v[220:223], v[92:95], v[88:91], v[220:223]
s_mov_b32 s41, 5
Lk3l_133:
s_waitcnt lgkmcnt(0)
v_mfma_f32_16x16x32_bf16 v[124:127], v[44:47], v[28:31], v[124:127]
ds_read_b128 v[76:79], v10 offset:8192
v_mfma_f32_16x16x32_bf16 v[128:131], v[48:51], v[28:31], v[128:131]
ds_read_b64_tr_b16 v[92:93], v19 offset:8192
v_mfma_f32_16x16x32_bf16 v[132:135], v[52:55], v[28:31], v[132:135]
ds_read_b64_tr_b16 v[94:95], v19 offset:12288
v_mfma_f32_16x16x32_bf16 v[136:139], v[56:59], v[28:31], v[136:139]
ds_read_b64_tr_b16 v[96:97], v20 offset:8192
v_mfma_f32_16x16x32_bf16 v[140:143], v[60:63], v[28:31], v[140:143]
ds_read_b64_tr_b16 v[98:99], v20 offset:12288
v_mfma_f32_16x16x32_bf16 v[144:147], v[64:67], v[28:31], v[144:147]
ds_read_b64_tr_b16 v[100:101], v21 offset:8192
v_mfma_f32_16x16x32_bf16 v[148:151], v[68:71], v[28:31], v[148:151]
ds_read_b64_tr_b16 v[102:103], v21 offset:12288
v_mfma_f32_16x16x32_bf16 v[152:155], v[72:75], v[28:31], v[152:155]
ds_read_b64_tr_b16 v[104:105], v22 offset:8192
v_mfma_f32_16x16x32_bf16 v[184:187], v[72:75], v[32:35], v[184:187]
ds_read_b64_tr_b16 v[106:107], v22 offset:12288
v_mfma_f32_16x16x32_bf16 v[180:183], v[68:71], v[32:35], v[180:183]
ds_read_b64_tr_b16 v[108:109], v19 offset:24576
v_mfma_f32_16x16x32_bf16 v[176:179], v[64:67], v[32:35], v[176:179]
ds_read_b64_tr_b16 v[110:111], v19 offset:28672
v_mfma_f32_16x16x32_bf16 v[172:175], v[60:63], v[32:35], v[172:175]
ds_read_b64_tr_b16 v[112:113], v20 offset:24576
v_mfma_f32_16x16x32_bf16 v[168:171], v[56:59], v[32:35], v[168:171]
ds_read_b64_tr_b16 v[114:115], v20 offset:28672
v_mfma_f32_16x16x32_bf16 v[164:167], v[52:55], v[32:35], v[164:167]
ds_read_b64_tr_b16 v[116:117], v21 offset:24576
v_mfma_f32_16x16x32_bf16 v[160:163], v[48:51], v[32:35], v[160:163]
ds_read_b64_tr_b16 v[118:119], v21 offset:28672
v_mfma_f32_16x16x32_bf16 v[156:159], v[44:47], v[32:35], v[156:159]
ds_read_b64_tr_b16 v[120:121], v22 offset:24576
v_mfma_f32_16x16x32_bf16 v[188:191], v[44:47], v[36:39], v[188:191]
ds_read_b64_tr_b16 v[122:123], v22 offset:28672
v_mfma_f32_16x16x32_bf16 v[192:195], v[48:51], v[36:39], v[192:195]
ds_read_b128 v[80:83], v10 offset:9216
v_mfma_f32_16x16x32_bf16 v[196:199], v[52:55], v[36:39], v[196:199]
ds_read_b128 v[84:87], v10 offset:10240
v_mfma_f32_16x16x32_bf16 v[200:203], v[56:59], v[36:39], v[200:203]
ds_read_b128 v[88:91], v10 offset:11264
v_mfma_f32_16x16x32_bf16 v[204:207], v[60:63], v[36:39], v[204:207]
v_mfma_f32_16x16x32_bf16 v[208:211], v[64:67], v[36:39], v[208:211]
v_mfma_f32_16x16x32_bf16 v[212:215], v[68:71], v[36:39], v[212:215]
v_mfma_f32_16x16x32_bf16 v[216:219], v[72:75], v[36:39], v[216:219]
v_mfma_f32_16x16x32_bf16 v[248:251], v[72:75], v[40:43], v[248:251]
v_mfma_f32_16x16x32_bf16 v[244:247], v[68:71], v[40:43], v[244:247]
v_mfma_f32_16x16x32_bf16 v[240:243], v[64:67], v[40:43], v[240:243]
v_mfma_f32_16x16x32_bf16 v[236:239], v[60:63], v[40:43], v[236:239]
v_mfma_f32_16x16x32_bf16 v[232:235], v[56:59], v[40:43], v[232:235]
v_mfma_f32_16x16x32_bf16 v[228:231], v[52:55], v[40:43], v[228:231]
v_mfma_f32_16x16x32_bf16 v[224:227], v[48:51], v[40:43], v[224:227]
v_mfma_f32_16x16x32_bf16 v[220:223], v[44:47], v[40:43], v[220:223]
s_waitcnt lgkmcnt(0)
s_barrier
v_mfma_f32_16x16x32_bf16 v[124:127], v[92:95], v[76:79], v[124:127]
ds_read_b128 v[28:31], v9 offset:0
v_mfma_f32_16x16x32_bf16 v[128:131], v[96:99], v[76:79], v[128:131]
ds_read_b64_tr_b16 v[44:45], v11 offset:0
v_mfma_f32_16x16x32_bf16 v[132:135], v[100:103], v[76:79], v[132:135]
ds_read_b64_tr_b16 v[46:47], v11 offset:4096
v_mfma_f32_16x16x32_bf16 v[136:139], v[104:107], v[76:79], v[136:139]
ds_read_b64_tr_b16 v[48:49], v12 offset:0
v_mfma_f32_16x16x32_bf16 v[140:143], v[108:111], v[76:79], v[140:143]
ds_read_b64_tr_b16 v[50:51], v12 offset:4096
v_mfma_f32_16x16x32_bf16 v[144:147], v[112:115], v[76:79], v[144:147]
ds_read_b64_tr_b16 v[52:53], v13 offset:0
v_mfma_f32_16x16x32_bf16 v[148:151], v[116:119], v[76:79], v[148:151]
ds_read_b64_tr_b16 v[54:55], v13 offset:4096
v_mfma_f32_16x16x32_bf16 v[152:155], v[120:123], v[76:79], v[152:155]
ds_read_b64_tr_b16 v[56:57], v14 offset:0
v_mfma_f32_16x16x32_bf16 v[184:187], v[120:123], v[80:83], v[184:187]
ds_read_b64_tr_b16 v[58:59], v14 offset:4096
v_mfma_f32_16x16x32_bf16 v[180:183], v[116:119], v[80:83], v[180:183]
ds_read_b64_tr_b16 v[60:61], v11 offset:16384
v_mfma_f32_16x16x32_bf16 v[176:179], v[112:115], v[80:83], v[176:179]
ds_read_b64_tr_b16 v[62:63], v11 offset:20480
v_mfma_f32_16x16x32_bf16 v[172:175], v[108:111], v[80:83], v[172:175]
ds_read_b64_tr_b16 v[64:65], v12 offset:16384
v_mfma_f32_16x16x32_bf16 v[168:171], v[104:107], v[80:83], v[168:171]
ds_read_b64_tr_b16 v[66:67], v12 offset:20480
v_mfma_f32_16x16x32_bf16 v[164:167], v[100:103], v[80:83], v[164:167]
ds_read_b64_tr_b16 v[68:69], v13 offset:16384
v_mfma_f32_16x16x32_bf16 v[160:163], v[96:99], v[80:83], v[160:163]
ds_read_b64_tr_b16 v[70:71], v13 offset:20480
v_mfma_f32_16x16x32_bf16 v[156:159], v[92:95], v[80:83], v[156:159]
ds_read_b64_tr_b16 v[72:73], v14 offset:16384
v_mfma_f32_16x16x32_bf16 v[188:191], v[92:95], v[84:87], v[188:191]
ds_read_b64_tr_b16 v[74:75], v14 offset:20480
v_mfma_f32_16x16x32_bf16 v[192:195], v[96:99], v[84:87], v[192:195]
ds_read_b128 v[32:35], v9 offset:1024
v_mfma_f32_16x16x32_bf16 v[196:199], v[100:103], v[84:87], v[196:199]
ds_read_b128 v[36:39], v9 offset:2048
v_mfma_f32_16x16x32_bf16 v[200:203], v[104:107], v[84:87], v[200:203]
ds_read_b128 v[40:43], v9 offset:3072
v_mfma_f32_16x16x32_bf16 v[204:207], v[108:111], v[84:87], v[204:207]
v_mfma_f32_16x16x32_bf16 v[208:211], v[112:115], v[84:87], v[208:211]
v_mfma_f32_16x16x32_bf16 v[212:215], v[116:119], v[84:87], v[212:215]
v_mfma_f32_16x16x32_bf16 v[216:219], v[120:123], v[84:87], v[216:219]
v_mfma_f32_16x16x32_bf16 v[248:251], v[120:123], v[88:91], v[248:251]
v_mfma_f32_16x16x32_bf16 v[244:247], v[116:119], v[88:91], v[244:247]
v_mfma_f32_16x16x32_bf16 v[240:243], v[112:115], v[88:91], v[240:243]
v_mfma_f32_16x16x32_bf16 v[236:239], v[108:111], v[88:91], v[236:239]
v_mfma_f32_16x16x32_bf16 v[232:235], v[104:107], v[88:91], v[232:235]
v_mfma_f32_16x16x32_bf16 v[228:231], v[100:103], v[88:91], v[228:231]
v_mfma_f32_16x16x32_bf16 v[224:227], v[96:99], v[88:91], v[224:227]
v_mfma_f32_16x16x32_bf16 v[220:223], v[92:95], v[88:91], v[220:223]
s_waitcnt lgkmcnt(0)
v_mfma_f32_16x16x32_bf16 v[124:127], v[44:47], v[28:31], v[124:127]
ds_read_b128 v[76:79], v9 offset:8192
v_mfma_f32_16x16x32_bf16 v[128:131], v[48:51], v[28:31], v[128:131]
ds_read_b64_tr_b16 v[92:93], v11 offset:8192
v_mfma_f32_16x16x32_bf16 v[132:135], v[52:55], v[28:31], v[132:135]
ds_read_b64_tr_b16 v[94:95], v11 offset:12288
v_mfma_f32_16x16x32_bf16 v[136:139], v[56:59], v[28:31], v[136:139]
ds_read_b64_tr_b16 v[96:97], v12 offset:8192
v_mfma_f32_16x16x32_bf16 v[140:143], v[60:63], v[28:31], v[140:143]
ds_read_b64_tr_b16 v[98:99], v12 offset:12288
v_mfma_f32_16x16x32_bf16 v[144:147], v[64:67], v[28:31], v[144:147]
ds_read_b64_tr_b16 v[100:101], v13 offset:8192
v_mfma_f32_16x16x32_bf16 v[148:151], v[68:71], v[28:31], v[148:151]
ds_read_b64_tr_b16 v[102:103], v13 offset:12288
v_mfma_f32_16x16x32_bf16 v[152:155], v[72:75], v[28:31], v[152:155]
ds_read_b64_tr_b16 v[104:105], v14 offset:8192
v_mfma_f32_16x16x32_bf16 v[184:187], v[72:75], v[32:35], v[184:187]
ds_read_b64_tr_b16 v[106:107], v14 offset:12288
v_mfma_f32_16x16x32_bf16 v[180:183], v[68:71], v[32:35], v[180:183]
ds_read_b64_tr_b16 v[108:109], v11 offset:24576
v_mfma_f32_16x16x32_bf16 v[176:179], v[64:67], v[32:35], v[176:179]
ds_read_b64_tr_b16 v[110:111], v11 offset:28672
v_mfma_f32_16x16x32_bf16 v[172:175], v[60:63], v[32:35], v[172:175]
ds_read_b64_tr_b16 v[112:113], v12 offset:24576
v_mfma_f32_16x16x32_bf16 v[168:171], v[56:59], v[32:35], v[168:171]
ds_read_b64_tr_b16 v[114:115], v12 offset:28672
v_mfma_f32_16x16x32_bf16 v[164:167], v[52:55], v[32:35], v[164:167]
ds_read_b64_tr_b16 v[116:117], v13 offset:24576
v_mfma_f32_16x16x32_bf16 v[160:163], v[48:51], v[32:35], v[160:163]
ds_read_b64_tr_b16 v[118:119], v13 offset:28672
v_mfma_f32_16x16x32_bf16 v[156:159], v[44:47], v[32:35], v[156:159]
ds_read_b64_tr_b16 v[120:121], v14 offset:24576
v_mfma_f32_16x16x32_bf16 v[188:191], v[44:47], v[36:39], v[188:191]
ds_read_b64_tr_b16 v[122:123], v14 offset:28672
v_mfma_f32_16x16x32_bf16 v[192:195], v[48:51], v[36:39], v[192:195]
ds_read_b128 v[80:83], v9 offset:9216
v_mfma_f32_16x16x32_bf16 v[196:199], v[52:55], v[36:39], v[196:199]
ds_read_b128 v[84:87], v9 offset:10240
v_mfma_f32_16x16x32_bf16 v[200:203], v[56:59], v[36:39], v[200:203]
ds_read_b128 v[88:91], v9 offset:11264
v_mfma_f32_16x16x32_bf16 v[204:207], v[60:63], v[36:39], v[204:207]
v_mfma_f32_16x16x32_bf16 v[208:211], v[64:67], v[36:39], v[208:211]
v_mfma_f32_16x16x32_bf16 v[212:215], v[68:71], v[36:39], v[212:215]
v_mfma_f32_16x16x32_bf16 v[216:219], v[72:75], v[36:39], v[216:219]
v_mfma_f32_16x16x32_bf16 v[248:251], v[72:75], v[40:43], v[248:251]
v_mfma_f32_16x16x32_bf16 v[244:247], v[68:71], v[40:43], v[244:247]
v_mfma_f32_16x16x32_bf16 v[240:243], v[64:67], v[40:43], v[240:243]
v_mfma_f32_16x16x32_bf16 v[236:239], v[60:63], v[40:43], v[236:239]
v_mfma_f32_16x16x32_bf16 v[232:235], v[56:59], v[40:43], v[232:235]
v_mfma_f32_16x16x32_bf16 v[228:231], v[52:55], v[40:43], v[228:231]
v_mfma_f32_16x16x32_bf16 v[224:227], v[48:51], v[40:43], v[224:227]
v_mfma_f32_16x16x32_bf16 v[220:223], v[44:47], v[40:43], v[220:223]
s_waitcnt lgkmcnt(0)
s_barrier
v_mfma_f32_16x16x32_bf16 v[124:127], v[92:95], v[76:79], v[124:127]
ds_read_b128 v[28:31], v9 offset:49152
v_mfma_f32_16x16x32_bf16 v[128:131], v[96:99], v[76:79], v[128:131]
ds_read_b64_tr_b16 v[44:45], v15 offset:0
v_mfma_f32_16x16x32_bf16 v[132:135], v[100:103], v[76:79], v[132:135]
ds_read_b64_tr_b16 v[46:47], v15 offset:4096
v_mfma_f32_16x16x32_bf16 v[136:139], v[104:107], v[76:79], v[136:139]
ds_read_b64_tr_b16 v[48:49], v16 offset:0
v_mfma_f32_16x16x32_bf16 v[140:143], v[108:111], v[76:79], v[140:143]
ds_read_b64_tr_b16 v[50:51], v16 offset:4096
v_mfma_f32_16x16x32_bf16 v[144:147], v[112:115], v[76:79], v[144:147]
ds_read_b64_tr_b16 v[52:53], v17 offset:0
v_mfma_f32_16x16x32_bf16 v[148:151], v[116:119], v[76:79], v[148:151]
ds_read_b64_tr_b16 v[54:55], v17 offset:4096
v_mfma_f32_16x16x32_bf16 v[152:155], v[120:123], v[76:79], v[152:155]
ds_read_b64_tr_b16 v[56:57], v18 offset:0
v_mfma_f32_16x16x32_bf16 v[184:187], v[120:123], v[80:83], v[184:187]
ds_read_b64_tr_b16 v[58:59], v18 offset:4096
v_mfma_f32_16x16x32_bf16 v[180:183], v[116:119], v[80:83], v[180:183]
ds_read_b64_tr_b16 v[60:61], v15 offset:16384
v_mfma_f32_16x16x32_bf16 v[176:179], v[112:115], v[80:83], v[176:179]
ds_read_b64_tr_b16 v[62:63], v15 offset:20480
v_mfma_f32_16x16x32_bf16 v[172:175], v[108:111], v[80:83], v[172:175]
ds_read_b64_tr_b16 v[64:65], v16 offset:16384
v_mfma_f32_16x16x32_bf16 v[168:171], v[104:107], v[80:83], v[168:171]
ds_read_b64_tr_b16 v[66:67], v16 offset:20480
v_mfma_f32_16x16x32_bf16 v[164:167], v[100:103], v[80:83], v[164:167]
ds_read_b64_tr_b16 v[68:69], v17 offset:16384
v_mfma_f32_16x16x32_bf16 v[160:163], v[96:99], v[80:83], v[160:163]
ds_read_b64_tr_b16 v[70:71], v17 offset:20480
v_mfma_f32_16x16x32_bf16 v[156:159], v[92:95], v[80:83], v[156:159]
ds_read_b64_tr_b16 v[72:73], v18 offset:16384
v_mfma_f32_16x16x32_bf16 v[188:191], v[92:95], v[84:87], v[188:191]
ds_read_b64_tr_b16 v[74:75], v18 offset:20480
v_mfma_f32_16x16x32_bf16 v[192:195], v[96:99], v[84:87], v[192:195]
ds_read_b128 v[32:35], v9 offset:50176
v_mfma_f32_16x16x32_bf16 v[196:199], v[100:103], v[84:87], v[196:199]
ds_read_b128 v[36:39], v9 offset:51200
v_mfma_f32_16x16x32_bf16 v[200:203], v[104:107], v[84:87], v[200:203]
ds_read_b128 v[40:43], v9 offset:52224
v_mfma_f32_16x16x32_bf16 v[204:207], v[108:111], v[84:87], v[204:207]
v_mfma_f32_16x16x32_bf16 v[208:211], v[112:115], v[84:87], v[208:211]
v_mfma_f32_16x16x32_bf16 v[212:215], v[116:119], v[84:87], v[212:215]
v_mfma_f32_16x16x32_bf16 v[216:219], v[120:123], v[84:87], v[216:219]
v_mfma_f32_16x16x32_bf16 v[248:251], v[120:123], v[88:91], v[248:251]
v_mfma_f32_16x16x32_bf16 v[244:247], v[116:119], v[88:91], v[244:247]
v_mfma_f32_16x16x32_bf16 v[240:243], v[112:115], v[88:91], v[240:243]
v_mfma_f32_16x16x32_bf16 v[236:239], v[108:111], v[88:91], v[236:239]
v_mfma_f32_16x16x32_bf16 v[232:235], v[104:107], v[88:91], v[232:235]
v_mfma_f32_16x16x32_bf16 v[228:231], v[100:103], v[88:91], v[228:231]
v_mfma_f32_16x16x32_bf16 v[224:227], v[96:99], v[88:91], v[224:227]
v_mfma_f32_16x16x32_bf16 v[220:223], v[92:95], v[88:91], v[220:223]
s_waitcnt lgkmcnt(0)
v_mfma_f32_16x16x32_bf16 v[124:127], v[44:47], v[28:31], v[124:127]
ds_read_b128 v[76:79], v9 offset:57344
v_mfma_f32_16x16x32_bf16 v[128:131], v[48:51], v[28:31], v[128:131]
ds_read_b64_tr_b16 v[92:93], v15 offset:8192
v_mfma_f32_16x16x32_bf16 v[132:135], v[52:55], v[28:31], v[132:135]
ds_read_b64_tr_b16 v[94:95], v15 offset:12288
v_mfma_f32_16x16x32_bf16 v[136:139], v[56:59], v[28:31], v[136:139]
ds_read_b64_tr_b16 v[96:97], v16 offset:8192
v_mfma_f32_16x16x32_bf16 v[140:143], v[60:63], v[28:31], v[140:143]
ds_read_b64_tr_b16 v[98:99], v16 offset:12288
v_mfma_f32_16x16x32_bf16 v[144:147], v[64:67], v[28:31], v[144:147]
ds_read_b64_tr_b16 v[100:101], v17 offset:8192
v_mfma_f32_16x16x32_bf16 v[148:151], v[68:71], v[28:31], v[148:151]
ds_read_b64_tr_b16 v[102:103], v17 offset:12288
v_mfma_f32_16x16x32_bf16 v[152:155], v[72:75], v[28:31], v[152:155]
ds_read_b64_tr_b16 v[104:105], v18 offset:8192
v_mfma_f32_16x16x32_bf16 v[184:187], v[72:75], v[32:35], v[184:187]
ds_read_b64_tr_b16 v[106:107], v18 offset:12288
v_mfma_f32_16x16x32_bf16 v[180:183], v[68:71], v[32:35], v[180:183]
ds_read_b64_tr_b16 v[108:109], v15 offset:24576
v_mfma_f32_16x16x32_bf16 v[176:179], v[64:67], v[32:35], v[176:179]
ds_read_b64_tr_b16 v[110:111], v15 offset:28672
v_mfma_f32_16x16x32_bf16 v[172:175], v[60:63], v[32:35], v[172:175]
ds_read_b64_tr_b16 v[112:113], v16 offset:24576
v_mfma_f32_16x16x32_bf16 v[168:171], v[56:59], v[32:35], v[168:171]
ds_read_b64_tr_b16 v[114:115], v16 offset:28672
v_mfma_f32_16x16x32_bf16 v[164:167], v[52:55], v[32:35], v[164:167]
ds_read_b64_tr_b16 v[116:117], v17 offset:24576
v_mfma_f32_16x16x32_bf16 v[160:163], v[48:51], v[32:35], v[160:163]
ds_read_b64_tr_b16 v[118:119], v17 offset:28672
v_mfma_f32_16x16x32_bf16 v[156:159], v[44:47], v[32:35], v[156:159]
ds_read_b64_tr_b16 v[120:121], v18 offset:24576
v_mfma_f32_16x16x32_bf16 v[188:191], v[44:47], v[36:39], v[188:191]
ds_read_b64_tr_b16 v[122:123], v18 offset:28672
v_mfma_f32_16x16x32_bf16 v[192:195], v[48:51], v[36:39], v[192:195]
ds_read_b128 v[80:83], v9 offset:58368
v_mfma_f32_16x16x32_bf16 v[196:199], v[52:55], v[36:39], v[196:199]
ds_read_b128 v[84:87], v9 offset:59392
v_mfma_f32_16x16x32_bf16 v[200:203], v[56:59], v[36:39], v[200:203]
ds_read_b128 v[88:91], v9 offset:60416
v_mfma_f32_16x16x32_bf16 v[204:207], v[60:63], v[36:39], v[204:207]
v_mfma_f32_16x16x32_bf16 v[208:211], v[64:67], v[36:39], v[208:211]
v_mfma_f32_16x16x32_bf16 v[212:215], v[68:71], v[36:39], v[212:215]
v_mfma_f32_16x16x32_bf16 v[216:219], v[72:75], v[36:39], v[216:219]
v_mfma_f32_16x16x32_bf16 v[248:251], v[72:75], v[40:43], v[248:251]
v_mfma_f32_16x16x32_bf16 v[244:247], v[68:71], v[40:43], v[244:247]
v_mfma_f32_16x16x32_bf16 v[240:243], v[64:67], v[40:43], v[240:243]
v_mfma_f32_16x16x32_bf16 v[236:239], v[60:63], v[40:43], v[236:239]
v_mfma_f32_16x16x32_bf16 v[232:235], v[56:59], v[40:43], v[232:235]
v_mfma_f32_16x16x32_bf16 v[228:231], v[52:55], v[40:43], v[228:231]
v_mfma_f32_16x16x32_bf16 v[224:227], v[48:51], v[40:43], v[224:227]
v_mfma_f32_16x16x32_bf16 v[220:223], v[44:47], v[40:43], v[220:223]
s_waitcnt lgkmcnt(0)
s_barrier
v_mfma_f32_16x16x32_bf16 v[124:127], v[92:95], v[76:79], v[124:127]
ds_read_b128 v[28:31], v10 offset:0
v_mfma_f32_16x16x32_bf16 v[128:131], v[96:99], v[76:79], v[128:131]
ds_read_b64_tr_b16 v[44:45], v19 offset:0
v_mfma_f32_16x16x32_bf16 v[132:135], v[100:103], v[76:79], v[132:135]
ds_read_b64_tr_b16 v[46:47], v19 offset:4096
v_mfma_f32_16x16x32_bf16 v[136:139], v[104:107], v[76:79], v[136:139]
ds_read_b64_tr_b16 v[48:49], v20 offset:0
v_mfma_f32_16x16x32_bf16 v[140:143], v[108:111], v[76:79], v[140:143]
ds_read_b64_tr_b16 v[50:51], v20 offset:4096
v_mfma_f32_16x16x32_bf16 v[144:147], v[112:115], v[76:79], v[144:147]
ds_read_b64_tr_b16 v[52:53], v21 offset:0
v_mfma_f32_16x16x32_bf16 v[148:151], v[116:119], v[76:79], v[148:151]
ds_read_b64_tr_b16 v[54:55], v21 offset:4096
v_mfma_f32_16x16x32_bf16 v[152:155], v[120:123], v[76:79], v[152:155]
ds_read_b64_tr_b16 v[56:57], v22 offset:0
v_mfma_f32_16x16x32_bf16 v[184:187], v[120:123], v[80:83], v[184:187]
ds_read_b64_tr_b16 v[58:59], v22 offset:4096
v_mfma_f32_16x16x32_bf16 v[180:183], v[116:119], v[80:83], v[180:183]
ds_read_b64_tr_b16 v[60:61], v19 offset:16384
v_mfma_f32_16x16x32_bf16 v[176:179], v[112:115], v[80:83], v[176:179]
ds_read_b64_tr_b16 v[62:63], v19 offset:20480
v_mfma_f32_16x16x32_bf16 v[172:175], v[108:111], v[80:83], v[172:175]
ds_read_b64_tr_b16 v[64:65], v20 offset:16384
v_mfma_f32_16x16x32_bf16 v[168:171], v[104:107], v[80:83], v[168:171]
ds_read_b64_tr_b16 v[66:67], v20 offset:20480
v_mfma_f32_16x16x32_bf16 v[164:167], v[100:103], v[80:83], v[164:167]
ds_read_b64_tr_b16 v[68:69], v21 offset:16384
v_mfma_f32_16x16x32_bf16 v[160:163], v[96:99], v[80:83], v[160:163]
ds_read_b64_tr_b16 v[70:71], v21 offset:20480
v_mfma_f32_16x16x32_bf16 v[156:159], v[92:95], v[80:83], v[156:159]
ds_read_b64_tr_b16 v[72:73], v22 offset:16384
v_mfma_f32_16x16x32_bf16 v[188:191], v[92:95], v[84:87], v[188:191]
ds_read_b64_tr_b16 v[74:75], v22 offset:20480
v_mfma_f32_16x16x32_bf16 v[192:195], v[96:99], v[84:87], v[192:195]
ds_read_b128 v[32:35], v10 offset:1024
v_mfma_f32_16x16x32_bf16 v[196:199], v[100:103], v[84:87], v[196:199]
ds_read_b128 v[36:39], v10 offset:2048
v_mfma_f32_16x16x32_bf16 v[200:203], v[104:107], v[84:87], v[200:203]
ds_read_b128 v[40:43], v10 offset:3072
v_mfma_f32_16x16x32_bf16 v[204:207], v[108:111], v[84:87], v[204:207]
v_mfma_f32_16x16x32_bf16 v[208:211], v[112:115], v[84:87], v[208:211]
v_mfma_f32_16x16x32_bf16 v[212:215], v[116:119], v[84:87], v[212:215]
v_mfma_f32_16x16x32_bf16 v[216:219], v[120:123], v[84:87], v[216:219]
v_mfma_f32_16x16x32_bf16 v[248:251], v[120:123], v[88:91], v[248:251]
v_mfma_f32_16x16x32_bf16 v[244:247], v[116:119], v[88:91], v[244:247]
v_mfma_f32_16x16x32_bf16 v[240:243], v[112:115], v[88:91], v[240:243]
v_mfma_f32_16x16x32_bf16 v[236:239], v[108:111], v[88:91], v[236:239]
v_mfma_f32_16x16x32_bf16 v[232:235], v[104:107], v[88:91], v[232:235]
v_mfma_f32_16x16x32_bf16 v[228:231], v[100:103], v[88:91], v[228:231]
v_mfma_f32_16x16x32_bf16 v[224:227], v[96:99], v[88:91], v[224:227]
v_mfma_f32_16x16x32_bf16 v[220:223], v[92:95], v[88:91], v[220:223]
s_sub_u32 s41, s41, 1
s_cmp_lg_u32 s41, 0
s_cbranch_scc1 Lk3l_133
s_waitcnt lgkmcnt(0)
v_lshrrev_b32 v84, 4, v1
s_lshl_b32 s43, s63, 8
s_add_u32 s43, s43, 148480
v_lshl_add_u32 v85, v84, 4, s43
v_and_b32 v84, 15, v1
s_lshl_b32 s43, s62, 9
s_add_u32 s43, s43, 147456
v_lshl_add_u32 v84, v84, 3, s43
ds_read_b128 v[28:31], v85 offset:0
s_branch Lov_16
.p2align 12
.fill 128, 4, 0xbf800000
Lst_16_0:
s_branch Lwr_170
s_nop 0
s_nop 0
Lov_16:
ds_read_b128 v[32:35], v85 offset:64
ds_read_b128 v[36:39], v85 offset:128
ds_read_b128 v[40:43], v85 offset:192
ds_read_b128 v[44:47], v85 offset:896
ds_read_b128 v[48:51], v85 offset:960
ds_read_b128 v[52:55], v85 offset:1024
ds_read_b128 v[56:59], v85 offset:1088
ds_read_b64 v[60:61], v84 offset:0
ds_read_b64 v[62:63], v84 offset:128
ds_read_b64 v[64:65], v84 offset:256
ds_read_b64 v[66:67], v84 offset:384
s_lshl_b32 s54, s35, 15
s_lshl_b32 s43, s63, 14
s_add_u32 s54, s54, s43
s_lshl_b32 s43, s62, 12
s_add_u32 s54, s54, s43
s_add_u32 s55, s54, 8192
v_lshrrev_b32 v122, 3, v1
v_and_b32 v123, 6, v122
v_and_b32 v25, 7, v1
v_xor_b32 v25, v25, v123
v_lshlrev_b32 v25, 4, v25
v_mul_u32_u24 v122, 2048, v122
v_add_u32 v25, v25, v122
s_lshl_b32 s43, s61, 7
s_lshl_b32 s44, s47, 15
s_add_u32 s43, s43, s44
v_add_u32 v25, s43, v25
s_waitcnt lgkmcnt(0)
s_barrier
s_add_u32 m0, s39, 81920
s_add_u32 s37, s52, 589824
buffer_load_dwordx4 v3, s[24:27], s37 offen sc1 lds
v_mul_f32 v70, v61, v61
v_mul_f32 v68, 0xc0135761, v61
v_mul_f32 v69, 0xbdd2d3e8, v61
v_mul_f32 v69, v69, v70
v_rcp_f32 v70, v70
v_mul_f32 v74, v63, v63
v_mul_f32 v72, 0xc0135761, v63
v_mul_f32 v73, 0xbdd2d3e8, v63
v_mul_f32 v73, v73, v74
v_rcp_f32 v74, v74
buffer_load_dwordx4 v3, s[24:27], s37 offen offset:1024 sc1 lds
v_fma_f32 v124, -v60, v28, v124
v_fma_f32 v125, -v60, v29, v125
v_fma_f32 v126, -v60, v30, v126
v_fma_f32 v127, -v60, v31, v127
v_fma_f32 v156, -v62, v28, v156
v_fma_f32 v157, -v62, v29, v157
v_fma_f32 v158, -v62, v30, v158
v_fma_f32 v159, -v62, v31, v159
v_mul_f32 v76, v124, v124
v_mul_f32 v77, v125, v125
buffer_load_dwordx4 v3, s[24:27], s37 offen offset:2048 sc1 lds
v_mul_f32 v78, v126, v126
v_mul_f32 v79, v127, v127
v_mul_f32 v80, v156, v156
v_mul_f32 v81, v157, v157
v_mul_f32 v82, v158, v158
v_mul_f32 v83, v159, v159
v_fma_f32 v76, v76, v69, v68
v_fma_f32 v77, v77, v69, v68
v_fma_f32 v78, v78, v69, v68
v_fma_f32 v79, v79, v69, v68
buffer_load_dwordx4 v3, s[24:27], s37 offen offset:3072 sc1 lds
v_fma_f32 v80, v80, v73, v72
v_fma_f32 v81, v81, v73, v72
v_fma_f32 v82, v82, v73, v72
v_fma_f32 v83, v83, v73, v72
v_mul_f32 v76, v76, v124
v_mul_f32 v77, v77, v125
v_mul_f32 v78, v78, v126
v_mul_f32 v79, v79, v127
v_mul_f32 v80, v80, v156
v_mul_f32 v81, v81, v157
s_add_u32 m0, s39, 147456
s_add_u32 s38, s53, 4718592
buffer_load_dwordx4 v23, s[28:31], s38 offen lds
v_mul_f32 v82, v82, v158
v_mul_f32 v83, v83, v159
v_exp_f32 v76, v76
v_exp_f32 v77, v77
v_exp_f32 v78, v78
v_exp_f32 v79, v79
v_exp_f32 v80, v80
v_exp_f32 v81, v81
v_exp_f32 v82, v82
v_exp_f32 v83, v83
s_add_u32 m0, s39, 148480
s_add_u32 s38, s53, 4718592
buffer_load_dwordx4 v24, s[28:31], s38 offen lds
v_fma_f32 v140, -v60, v44, v140
v_fma_f32 v141, -v60, v45, v141
v_fma_f32 v142, -v60, v46, v142
v_fma_f32 v143, -v60, v47, v143
v_fma_f32 v172, -v62, v44, v172
v_fma_f32 v173, -v62, v45, v173
v_fma_f32 v174, -v62, v46, v174
v_fma_f32 v175, -v62, v47, v175
v_fma_f32 v76, v76, v70, v70
v_fma_f32 v77, v77, v70, v70
s_add_u32 m0, s39, 149504
s_add_u32 s38, s53, 4734976
buffer_load_dwordx4 v23, s[28:31], s38 offen lds
v_fma_f32 v78, v78, v70, v70
v_fma_f32 v79, v79, v70, v70
v_fma_f32 v80, v80, v74, v74
v_fma_f32 v81, v81, v74, v74
v_fma_f32 v82, v82, v74, v74
v_fma_f32 v83, v83, v74, v74
v_rcp_f32 v76, v76
v_rcp_f32 v77, v77
v_rcp_f32 v78, v78
v_rcp_f32 v79, v79
s_add_u32 m0, s39, 150528
s_add_u32 s38, s53, 4734976
buffer_load_dwordx4 v24, s[28:31], s38 offen lds
v_rcp_f32 v80, v80
v_rcp_f32 v81, v81
v_rcp_f32 v82, v82
v_rcp_f32 v83, v83
v_mul_f32 v140, v124, v140
v_mul_f32 v141, v125, v141
v_mul_f32 v142, v126, v142
v_mul_f32 v143, v127, v143
v_mul_f32 v172, v156, v172
v_mul_f32 v173, v157, v173
s_add_u32 m0, s39, 98304
s_add_u32 s37, s52, 606208
buffer_load_dwordx4 v3, s[24:27], s37 offen sc1 lds
v_mul_f32 v174, v158, v174
v_mul_f32 v175, v159, v175
v_mul_f32 v140, v140, v76
v_mul_f32 v141, v141, v77
v_mul_f32 v142, v142, v78
v_mul_f32 v143, v143, v79
v_mul_f32 v172, v172, v80
v_mul_f32 v173, v173, v81
v_mul_f32 v174, v174, v82
v_mul_f32 v175, v175, v83
buffer_load_dwordx4 v3, s[24:27], s37 offen offset:1024 sc1 lds
v_cvt_pk_bf16_f32 v124, v140, v141
v_cvt_pk_bf16_f32 v125, v142, v143
v_cvt_pk_bf16_f32 v156, v172, v173
v_cvt_pk_bf16_f32 v157, v174, v175
v_fma_f32 v128, -v60, v32, v128
v_fma_f32 v129, -v60, v33, v129
v_fma_f32 v130, -v60, v34, v130
v_fma_f32 v131, -v60, v35, v131
v_fma_f32 v160, -v62, v32, v160
v_fma_f32 v161, -v62, v33, v161
buffer_load_dwordx4 v3, s[24:27], s37 offen offset:2048 sc1 lds
v_fma_f32 v162, -v62, v34, v162
v_fma_f32 v163, -v62, v35, v163
v_mul_f32 v76, v128, v128
v_mul_f32 v77, v129, v129
v_mul_f32 v78, v130, v130
v_mul_f32 v79, v131, v131
v_mul_f32 v80, v160, v160
v_mul_f32 v81, v161, v161
v_mul_f32 v82, v162, v162
v_mul_f32 v83, v163, v163
buffer_load_dwordx4 v3, s[24:27], s37 offen offset:3072 sc1 lds
v_fma_f32 v76, v76, v69, v68
v_fma_f32 v77, v77, v69, v68
v_fma_f32 v78, v78, v69, v68
v_fma_f32 v79, v79, v69, v68
v_fma_f32 v80, v80, v73, v72
v_fma_f32 v81, v81, v73, v72
v_fma_f32 v82, v82, v73, v72
v_fma_f32 v83, v83, v73, v72
v_mul_f32 v76, v76, v128
v_mul_f32 v77, v77, v129
s_add_u32 m0, s39, 114688
s_add_u32 s38, s53, 4849664
buffer_load_dwordx4 v23, s[28:31], s38 offen lds
v_mul_f32 v78, v78, v130
v_mul_f32 v79, v79, v131
v_mul_f32 v80, v80, v160
v_mul_f32 v81, v81, v161
v_mul_f32 v82, v82, v162
v_mul_f32 v83, v83, v163
v_exp_f32 v76, v76
v_exp_f32 v77, v77
v_exp_f32 v78, v78
v_exp_f32 v79, v79
s_add_u32 m0, s39, 115712
s_add_u32 s38, s53, 4849664
buffer_load_dwordx4 v24, s[28:31], s38 offen lds
v_exp_f32 v80, v80
v_exp_f32 v81, v81
v_exp_f32 v82, v82
v_exp_f32 v83, v83
v_fma_f32 v144, -v60, v48, v144
v_fma_f32 v145, -v60, v49, v145
v_fma_f32 v146, -v60, v50, v146
v_fma_f32 v147, -v60, v51, v147
v_fma_f32 v176, -v62, v48, v176
v_fma_f32 v177, -v62, v49, v177
s_add_u32 m0, s39, 116736
s_add_u32 s38, s53, 4866048
buffer_load_dwordx4 v23, s[28:31], s38 offen lds
s_add_u32 m0, s39, 117760
s_add_u32 s38, s53, 4866048
buffer_load_dwordx4 v24, s[28:31], s38 offen lds
s_barrier
s_add_u32 m0, s39, 131072
s_add_u32 s37, s52, 622592
buffer_load_dwordx4 v3, s[24:27], s37 offen sc1 lds
v_fma_f32 v178, -v62, v50, v178
v_fma_f32 v179, -v62, v51, v179
v_fma_f32 v76, v76, v70, v70
v_fma_f32 v77, v77, v70, v70
v_fma_f32 v78, v78, v70, v70
v_fma_f32 v79, v79, v70, v70
v_fma_f32 v80, v80, v74, v74
v_fma_f32 v81, v81, v74, v74
v_fma_f32 v82, v82, v74, v74
v_fma_f32 v83, v83, v74, v74
v_rcp_f32 v76, v76
v_rcp_f32 v77, v77
v_rcp_f32 v78, v78
v_rcp_f32 v79, v79
v_rcp_f32 v80, v80
v_rcp_f32 v81, v81
v_rcp_f32 v82, v82
v_rcp_f32 v83, v83
v_mul_f32 v144, v128, v144
v_mul_f32 v145, v129, v145
v_mul_f32 v146, v130, v146
v_mul_f32 v147, v131, v147
v_mul_f32 v176, v160, v176
buffer_load_dwordx4 v3, s[24:27], s37 offen offset:1024 sc1 lds
v_mul_f32 v177, v161, v177
v_mul_f32 v178, v162, v178
v_mul_f32 v179, v163, v179
v_mul_f32 v144, v144, v76
v_mul_f32 v145, v145, v77
v_mul_f32 v146, v146, v78
v_mul_f32 v147, v147, v79
v_mul_f32 v176, v176, v80
v_mul_f32 v177, v177, v81
v_mul_f32 v178, v178, v82
v_mul_f32 v179, v179, v83
v_cvt_pk_bf16_f32 v126, v144, v145
v_cvt_pk_bf16_f32 v127, v146, v147
v_cvt_pk_bf16_f32 v158, v176, v177
v_cvt_pk_bf16_f32 v159, v178, v179
buffer_store_dwordx4 v[124:127], v2, s[24:27], s54 offen offset:0 sc1
buffer_store_dwordx4 v[156:159], v2, s[24:27], s54 offen offset:1024 sc1
v_fma_f32 v132, -v60, v36, v132
v_fma_f32 v133, -v60, v37, v133
v_fma_f32 v134, -v60, v38, v134
v_fma_f32 v135, -v60, v39, v135
v_fma_f32 v164, -v62, v36, v164
v_fma_f32 v165, -v62, v37, v165
buffer_load_dwordx4 v3, s[24:27], s37 offen offset:2048 sc1 lds
v_fma_f32 v166, -v62, v38, v166
v_fma_f32 v167, -v62, v39, v167
v_mul_f32 v76, v132, v132
v_mul_f32 v77, v133, v133
v_mul_f32 v78, v134, v134
v_mul_f32 v79, v135, v135
v_mul_f32 v80, v164, v164
v_mul_f32 v81, v165, v165
v_mul_f32 v82, v166, v166
v_mul_f32 v83, v167, v167
v_fma_f32 v76, v76, v69, v68
v_fma_f32 v77, v77, v69, v68
v_fma_f32 v78, v78, v69, v68
v_fma_f32 v79, v79, v69, v68
v_fma_f32 v80, v80, v73, v72
v_fma_f32 v81, v81, v73, v72
v_fma_f32 v82, v82, v73, v72
v_fma_f32 v83, v83, v73, v72
v_mul_f32 v76, v76, v132
v_mul_f32 v77, v77, v133
v_mul_f32 v78, v78, v134
v_mul_f32 v79, v79, v135
v_mul_f32 v80, v80, v164
v_mul_f32 v81, v81, v165
buffer_load_dwordx4 v3, s[24:27], s37 offen offset:3072 sc1 lds
v_mul_f32 v82, v82, v166
v_mul_f32 v83, v83, v167
v_exp_f32 v76, v76
v_exp_f32 v77, v77
v_exp_f32 v78, v78
v_exp_f32 v79, v79
v_exp_f32 v80, v80
v_exp_f32 v81, v81
v_exp_f32 v82, v82
v_exp_f32 v83, v83
v_fma_f32 v148, -v60, v52, v148
v_fma_f32 v149, -v60, v53, v149
v_fma_f32 v150, -v60, v54, v150
v_fma_f32 v151, -v60, v55, v151
v_fma_f32 v180, -v62, v52, v180
v_fma_f32 v181, -v62, v53, v181
v_fma_f32 v182, -v62, v54, v182
v_fma_f32 v183, -v62, v55, v183
v_fma_f32 v76, v76, v70, v70
v_fma_f32 v77, v77, v70, v70
v_fma_f32 v78, v78, v70, v70
v_fma_f32 v79, v79, v70, v70
v_fma_f32 v80, v80, v74, v74
s_add_u32 m0, s39, 0
s_add_u32 s38, s53, 4980736
buffer_load_dwordx4 v23, s[28:31], s38 offen lds
v_fma_f32 v81, v81, v74, v74
v_fma_f32 v82, v82, v74, v74
v_fma_f32 v83, v83, v74, v74
v_rcp_f32 v76, v76
v_rcp_f32 v77, v77
v_rcp_f32 v78, v78
v_rcp_f32 v79, v79
v_rcp_f32 v80, v80
v_rcp_f32 v81, v81
v_rcp_f32 v82, v82
v_rcp_f32 v83, v83
v_mul_f32 v148, v132, v148
v_mul_f32 v149, v133, v149
v_mul_f32 v150, v134, v150
v_mul_f32 v151, v135, v151
v_mul_f32 v180, v164, v180
v_mul_f32 v181, v165, v181
v_mul_f32 v182, v166, v182
v_mul_f32 v183, v167, v183
v_mul_f32 v148, v148, v76
v_mul_f32 v149, v149, v77
v_mul_f32 v150, v150, v78
v_mul_f32 v151, v151, v79
s_add_u32 m0, s39, 1024
s_add_u32 s38, s53, 4980736
buffer_load_dwordx4 v24, s[28:31], s38 offen lds
v_mul_f32 v180, v180, v80
v_mul_f32 v181, v181, v81
v_mul_f32 v182, v182, v82
v_mul_f32 v183, v183, v83
v_cvt_pk_bf16_f32 v132, v148, v149
v_cvt_pk_bf16_f32 v133, v150, v151
v_cvt_pk_bf16_f32 v164, v180, v181
v_cvt_pk_bf16_f32 v165, v182, v183
v_fma_f32 v136, -v60, v40, v136
v_fma_f32 v137, -v60, v41, v137
v_fma_f32 v138, -v60, v42, v138
v_fma_f32 v139, -v60, v43, v139
v_fma_f32 v168, -v62, v40, v168
v_fma_f32 v169, -v62, v41, v169
v_fma_f32 v170, -v62, v42, v170
v_fma_f32 v171, -v62, v43, v171
v_mul_f32 v76, v136, v136
v_mul_f32 v77, v137, v137
v_mul_f32 v78, v138, v138
v_mul_f32 v79, v139, v139
v_mul_f32 v80, v168, v168
v_mul_f32 v81, v169, v169
v_mul_f32 v82, v170, v170
v_mul_f32 v83, v171, v171
s_add_u32 m0, s39, 2048
s_add_u32 s38, s53, 4997120
buffer_load_dwordx4 v23, s[28:31], s38 offen lds
s_add_u32 m0, s39, 3072
s_add_u32 s38, s53, 4997120
buffer_load_dwordx4 v24, s[28:31], s38 offen lds
s_barrier
s_add_u32 m0, s39, 16384
s_add_u32 s37, s52, 638976
buffer_load_dwordx4 v3, s[24:27], s37 offen sc1 lds
v_fma_f32 v76, v76, v69, v68
v_fma_f32 v77, v77, v69, v68
v_fma_f32 v78, v78, v69, v68
v_fma_f32 v79, v79, v69, v68
v_fma_f32 v80, v80, v73, v72
v_fma_f32 v81, v81, v73, v72
v_fma_f32 v82, v82, v73, v72
v_fma_f32 v83, v83, v73, v72
v_mul_f32 v76, v76, v136
v_mul_f32 v77, v77, v137
v_mul_f32 v78, v78, v138
v_mul_f32 v79, v79, v139
v_mul_f32 v80, v80, v168
v_mul_f32 v81, v81, v169
v_mul_f32 v82, v82, v170
v_mul_f32 v83, v83, v171
v_exp_f32 v76, v76
v_exp_f32 v77, v77
v_exp_f32 v78, v78
v_exp_f32 v79, v79
v_exp_f32 v80, v80
v_exp_f32 v81, v81
v_exp_f32 v82, v82
buffer_load_dwordx4 v3, s[24:27], s37 offen offset:1024 sc1 lds
v_exp_f32 v83, v83
v_fma_f32 v152, -v60, v56, v152
v_fma_f32 v153, -v60, v57, v153
v_fma_f32 v154, -v60, v58, v154
v_fma_f32 v155, -v60, v59, v155
v_fma_f32 v184, -v62, v56, v184
v_fma_f32 v185, -v62, v57, v185
v_fma_f32 v186, -v62, v58, v186
v_fma_f32 v187, -v62, v59, v187
v_fma_f32 v76, v76, v70, v70
v_fma_f32 v77, v77, v70, v70
v_fma_f32 v78, v78, v70, v70
v_fma_f32 v79, v79, v70, v70
v_fma_f32 v80, v80, v74, v74
v_fma_f32 v81, v81, v74, v74
v_fma_f32 v82, v82, v74, v74
v_fma_f32 v83, v83, v74, v74
v_rcp_f32 v76, v76
v_rcp_f32 v77, v77
v_rcp_f32 v78, v78
v_rcp_f32 v79, v79
v_rcp_f32 v80, v80
v_rcp_f32 v81, v81
buffer_load_dwordx4 v3, s[24:27], s37 offen offset:2048 sc1 lds
v_rcp_f32 v82, v82
v_rcp_f32 v83, v83
v_mul_f32 v152, v136, v152
v_mul_f32 v153, v137, v153
v_mul_f32 v154, v138, v154
v_mul_f32 v155, v139, v155
v_mul_f32 v184, v168, v184
v_mul_f32 v185, v169, v185
v_mul_f32 v186, v170, v186
v_mul_f32 v187, v171, v187
v_mul_f32 v152, v152, v76
v_mul_f32 v153, v153, v77
v_mul_f32 v154, v154, v78
v_mul_f32 v155, v155, v79
v_mul_f32 v184, v184, v80
v_mul_f32 v185, v185, v81
v_mul_f32 v186, v186, v82
v_mul_f32 v187, v187, v83
v_cvt_pk_bf16_f32 v134, v152, v153
v_cvt_pk_bf16_f32 v135, v154, v155
v_cvt_pk_bf16_f32 v166, v184, v185
v_cvt_pk_bf16_f32 v167, v186, v187
buffer_store_dwordx4 v[132:135], v2, s[24:27], s55 offen offset:0 sc1
buffer_store_dwordx4 v[164:167], v2, s[24:27], s55 offen offset:1024 sc1
buffer_load_dwordx4 v3, s[24:27], s37 offen offset:3072 sc1 lds
v_mul_f32 v70, v65, v65
v_mul_f32 v68, 0xc0135761, v65
v_mul_f32 v69, 0xbdd2d3e8, v65
v_mul_f32 v69, v69, v70
v_rcp_f32 v70, v70
v_mul_f32 v74, v67, v67
v_mul_f32 v72, 0xc0135761, v67
v_mul_f32 v73, 0xbdd2d3e8, v67
v_mul_f32 v73, v73, v74
v_rcp_f32 v74, v74
v_fma_f32 v188, -v64, v28, v188
v_fma_f32 v189, -v64, v29, v189
v_fma_f32 v190, -v64, v30, v190
v_fma_f32 v191, -v64, v31, v191
v_fma_f32 v220, -v66, v28, v220
v_fma_f32 v221, -v66, v29, v221
v_fma_f32 v222, -v66, v30, v222
v_fma_f32 v223, -v66, v31, v223
v_mul_f32 v76, v188, v188
v_mul_f32 v77, v189, v189
v_mul_f32 v78, v190, v190
v_mul_f32 v79, v191, v191
v_mul_f32 v80, v220, v220
s_add_u32 m0, s39, 32768
s_add_u32 s38, s53, 5111808
buffer_load_dwordx4 v23, s[28:31], s38 offen lds
v_mul_f32 v81, v221, v221
v_mul_f32 v82, v222, v222
v_mul_f32 v83, v223, v223
v_fma_f32 v76, v76, v69, v68
v_fma_f32 v77, v77, v69, v68
v_fma_f32 v78, v78, v69, v68
v_fma_f32 v79, v79, v69, v68
v_fma_f32 v80, v80, v73, v72
v_fma_f32 v81, v81, v73, v72
v_fma_f32 v82, v82, v73, v72
v_fma_f32 v83, v83, v73, v72
v_mul_f32 v76, v76, v188
v_mul_f32 v77, v77, v189
v_mul_f32 v78, v78, v190
v_mul_f32 v79, v79, v191
v_mul_f32 v80, v80, v220
v_mul_f32 v81, v81, v221
v_mul_f32 v82, v82, v222
v_mul_f32 v83, v83, v223
v_exp_f32 v76, v76
v_exp_f32 v77, v77
v_exp_f32 v78, v78
v_exp_f32 v79, v79
s_add_u32 m0, s39, 33792
s_add_u32 s38, s53, 5111808
buffer_load_dwordx4 v24, s[28:31], s38 offen lds
v_exp_f32 v80, v80
v_exp_f32 v81, v81
v_exp_f32 v82, v82
v_exp_f32 v83, v83
v_fma_f32 v204, -v64, v44, v204
v_fma_f32 v205, -v64, v45, v205
v_fma_f32 v206, -v64, v46, v206
v_fma_f32 v207, -v64, v47, v207
v_fma_f32 v236, -v66, v44, v236
v_fma_f32 v237, -v66, v45, v237
v_fma_f32 v238, -v66, v46, v238
v_fma_f32 v239, -v66, v47, v239
v_fma_f32 v76, v76, v70, v70
v_fma_f32 v77, v77, v70, v70
v_fma_f32 v78, v78, v70, v70
v_fma_f32 v79, v79, v70, v70
v_fma_f32 v80, v80, v74, v74
v_fma_f32 v81, v81, v74, v74
v_fma_f32 v82, v82, v74, v74
v_fma_f32 v83, v83, v74, v74
v_rcp_f32 v76, v76
v_rcp_f32 v77, v77
v_rcp_f32 v78, v78
v_rcp_f32 v79, v79
s_add_u32 m0, s39, 34816
s_add_u32 s38, s53, 5128192
buffer_load_dwordx4 v23, s[28:31], s38 offen lds
s_add_u32 m0, s39, 35840
s_add_u32 s38, s53, 5128192
buffer_load_dwordx4 v24, s[28:31], s38 offen lds
s_waitcnt vmcnt(28)
s_barrier
s_add_u32 m0, s39, 49152
s_add_u32 s37, s52, 655360
buffer_load_dwordx4 v3, s[24:27], s37 offen sc1 lds
v_rcp_f32 v80, v80
v_rcp_f32 v81, v81
v_rcp_f32 v82, v82
v_rcp_f32 v83, v83
v_mul_f32 v204, v188, v204
v_mul_f32 v205, v189, v205
v_mul_f32 v206, v190, v206
v_mul_f32 v207, v191, v207
v_mul_f32 v236, v220, v236
v_mul_f32 v237, v221, v237
v_mul_f32 v238, v222, v238
v_mul_f32 v239, v223, v239
v_mul_f32 v204, v204, v76
v_mul_f32 v205, v205, v77
v_mul_f32 v206, v206, v78
v_mul_f32 v207, v207, v79
v_mul_f32 v236, v236, v80
v_mul_f32 v237, v237, v81
v_mul_f32 v238, v238, v82
v_mul_f32 v239, v239, v83
v_cvt_pk_bf16_f32 v188, v204, v205
v_cvt_pk_bf16_f32 v189, v206, v207
v_cvt_pk_bf16_f32 v220, v236, v237
buffer_load_dwordx4 v3, s[24:27], s37 offen offset:1024 sc1 lds
v_cvt_pk_bf16_f32 v221, v238, v239
v_fma_f32 v192, -v64, v32, v192
v_fma_f32 v193, -v64, v33, v193
v_fma_f32 v194, -v64, v34, v194
v_fma_f32 v195, -v64, v35, v195
v_fma_f32 v224, -v66, v32, v224
v_fma_f32 v225, -v66, v33, v225
v_fma_f32 v226, -v66, v34, v226
v_fma_f32 v227, -v66, v35, v227
v_mul_f32 v76, v192, v192
v_mul_f32 v77, v193, v193
v_mul_f32 v78, v194, v194
v_mul_f32 v79, v195, v195
v_mul_f32 v80, v224, v224
v_mul_f32 v81, v225, v225
v_mul_f32 v82, v226, v226
v_mul_f32 v83, v227, v227
v_fma_f32 v76, v76, v69, v68
v_fma_f32 v77, v77, v69, v68
v_fma_f32 v78, v78, v69, v68
v_fma_f32 v79, v79, v69, v68
v_fma_f32 v80, v80, v73, v72
v_fma_f32 v81, v81, v73, v72
buffer_load_dwordx4 v3, s[24:27], s37 offen offset:2048 sc1 lds
v_fma_f32 v82, v82, v73, v72
v_fma_f32 v83, v83, v73, v72
v_mul_f32 v76, v76, v192
v_mul_f32 v77, v77, v193
v_mul_f32 v78, v78, v194
v_mul_f32 v79, v79, v195
v_mul_f32 v80, v80, v224
v_mul_f32 v81, v81, v225
v_mul_f32 v82, v82, v226
v_mul_f32 v83, v83, v227
v_exp_f32 v76, v76
v_exp_f32 v77, v77
v_exp_f32 v78, v78
v_exp_f32 v79, v79
v_exp_f32 v80, v80
v_exp_f32 v81, v81
v_exp_f32 v82, v82
v_exp_f32 v83, v83
s_branch Lov_17
.p2align 12
.fill 128, 4, 0xbf800000
Lst_17_0:
s_branch Lwr_171
s_nop 0
s_nop 0
Lov_17:
v_fma_f32 v208, -v64, v48, v208
v_fma_f32 v209, -v64, v49, v209
v_fma_f32 v210, -v64, v50, v210
v_fma_f32 v211, -v64, v51, v211
v_fma_f32 v240, -v66, v48, v240
v_fma_f32 v241, -v66, v49, v241
buffer_load_dwordx4 v3, s[24:27], s37 offen offset:3072 sc1 lds
v_fma_f32 v242, -v66, v50, v242
v_fma_f32 v243, -v66, v51, v243
v_fma_f32 v76, v76, v70, v70
v_fma_f32 v77, v77, v70, v70
v_fma_f32 v78, v78, v70, v70
v_fma_f32 v79, v79, v70, v70
v_fma_f32 v80, v80, v74, v74
v_fma_f32 v81, v81, v74, v74
v_fma_f32 v82, v82, v74, v74
v_fma_f32 v83, v83, v74, v74
v_rcp_f32 v76, v76
v_rcp_f32 v77, v77
v_rcp_f32 v78, v78
v_rcp_f32 v79, v79
v_rcp_f32 v80, v80
v_rcp_f32 v81, v81
v_rcp_f32 v82, v82
v_rcp_f32 v83, v83
v_mul_f32 v208, v192, v208
v_mul_f32 v209, v193, v209
v_mul_f32 v210, v194, v210
v_mul_f32 v211, v195, v211
v_mul_f32 v240, v224, v240
s_add_u32 m0, s39, 65536
s_add_u32 s38, s53, 5242880
buffer_load_dwordx4 v23, s[28:31], s38 offen lds
v_mul_f32 v241, v225, v241
v_mul_f32 v242, v226, v242
v_mul_f32 v243, v227, v243
v_mul_f32 v208, v208, v76
v_mul_f32 v209, v209, v77
v_mul_f32 v210, v210, v78
v_mul_f32 v211, v211, v79
v_mul_f32 v240, v240, v80
v_mul_f32 v241, v241, v81
v_mul_f32 v242, v242, v82
v_mul_f32 v243, v243, v83
v_cvt_pk_bf16_f32 v190, v208, v209
v_cvt_pk_bf16_f32 v191, v210, v211
v_cvt_pk_bf16_f32 v222, v240, v241
v_cvt_pk_bf16_f32 v223, v242, v243
buffer_store_dwordx4 v[188:191], v2, s[24:27], s54 offen offset:2048 sc1
buffer_store_dwordx4 v[220:223], v2, s[24:27], s54 offen offset:3072 sc1
v_fma_f32 v196, -v64, v36, v196
v_fma_f32 v197, -v64, v37, v197
v_fma_f32 v198, -v64, v38, v198
v_fma_f32 v199, -v64, v39, v199
v_fma_f32 v228, -v66, v36, v228
v_fma_f32 v229, -v66, v37, v229
s_add_u32 m0, s39, 66560
s_add_u32 s38, s53, 5242880
buffer_load_dwordx4 v24, s[28:31], s38 offen lds
v_fma_f32 v230, -v66, v38, v230
v_fma_f32 v231, -v66, v39, v231
v_mul_f32 v76, v196, v196
v_mul_f32 v77, v197, v197
v_mul_f32 v78, v198, v198
v_mul_f32 v79, v199, v199
v_mul_f32 v80, v228, v228
v_mul_f32 v81, v229, v229
v_mul_f32 v82, v230, v230
v_mul_f32 v83, v231, v231
v_fma_f32 v76, v76, v69, v68
v_fma_f32 v77, v77, v69, v68
v_fma_f32 v78, v78, v69, v68
v_fma_f32 v79, v79, v69, v68
v_fma_f32 v80, v80, v73, v72
v_fma_f32 v81, v81, v73, v72
v_fma_f32 v82, v82, v73, v72
v_fma_f32 v83, v83, v73, v72
v_mul_f32 v76, v76, v196
v_mul_f32 v77, v77, v197
v_mul_f32 v78, v78, v198
v_mul_f32 v79, v79, v199
v_mul_f32 v80, v80, v228
v_mul_f32 v81, v81, v229
s_add_u32 m0, s39, 67584
s_add_u32 s38, s53, 5259264
buffer_load_dwordx4 v23, s[28:31], s38 offen lds
s_add_u32 m0, s39, 68608
s_add_u32 s38, s53, 5259264
buffer_load_dwordx4 v24, s[28:31], s38 offen lds
s_waitcnt vmcnt(30)
s_barrier
s_add_u32 m0, s39, 81920
s_add_u32 s37, s52, 671744
buffer_load_dwordx4 v3, s[24:27], s37 offen sc1 lds
v_mul_f32 v82, v82, v230
v_mul_f32 v83, v83, v231
v_exp_f32 v76, v76
v_exp_f32 v77, v77
v_exp_f32 v78, v78
v_exp_f32 v79, v79
v_exp_f32 v80, v80
v_exp_f32 v81, v81
v_exp_f32 v82, v82
v_exp_f32 v83, v83
v_fma_f32 v212, -v64, v52, v212
v_fma_f32 v213, -v64, v53, v213
v_fma_f32 v214, -v64, v54, v214
v_fma_f32 v215, -v64, v55, v215
v_fma_f32 v244, -v66, v52, v244
v_fma_f32 v245, -v66, v53, v245
v_fma_f32 v246, -v66, v54, v246
v_fma_f32 v247, -v66, v55, v247
v_fma_f32 v76, v76, v70, v70
v_fma_f32 v77, v77, v70, v70
v_fma_f32 v78, v78, v70, v70
v_fma_f32 v79, v79, v70, v70
v_fma_f32 v80, v80, v74, v74
buffer_load_dwordx4 v3, s[24:27], s37 offen offset:1024 sc1 lds
v_fma_f32 v81, v81, v74, v74
v_fma_f32 v82, v82, v74, v74
v_fma_f32 v83, v83, v74, v74
v_rcp_f32 v76, v76
v_rcp_f32 v77, v77
v_rcp_f32 v78, v78
v_rcp_f32 v79, v79
v_rcp_f32 v80, v80
v_rcp_f32 v81, v81
v_rcp_f32 v82, v82
v_rcp_f32 v83, v83
v_mul_f32 v212, v196, v212
v_mul_f32 v213, v197, v213
v_mul_f32 v214, v198, v214
v_mul_f32 v215, v199, v215
v_mul_f32 v244, v228, v244
v_mul_f32 v245, v229, v245
v_mul_f32 v246, v230, v246
v_mul_f32 v247, v231, v247
v_mul_f32 v212, v212, v76
v_mul_f32 v213, v213, v77
v_mul_f32 v214, v214, v78
v_mul_f32 v215, v215, v79
buffer_load_dwordx4 v3, s[24:27], s37 offen offset:2048 sc1 lds
v_mul_f32 v244, v244, v80
v_mul_f32 v245, v245, v81
v_mul_f32 v246, v246, v82
v_mul_f32 v247, v247, v83
v_cvt_pk_bf16_f32 v196, v212, v213
v_cvt_pk_bf16_f32 v197, v214, v215
v_cvt_pk_bf16_f32 v228, v244, v245
v_cvt_pk_bf16_f32 v229, v246, v247
v_fma_f32 v200, -v64, v40, v200
v_fma_f32 v201, -v64, v41, v201
v_fma_f32 v202, -v64, v42, v202
v_fma_f32 v203, -v64, v43, v203
v_fma_f32 v232, -v66, v40, v232
v_fma_f32 v233, -v66, v41, v233
v_fma_f32 v234, -v66, v42, v234
v_fma_f32 v235, -v66, v43, v235
v_mul_f32 v76, v200, v200
v_mul_f32 v77, v201, v201
v_mul_f32 v78, v202, v202
v_mul_f32 v79, v203, v203
v_mul_f32 v80, v232, v232
v_mul_f32 v81, v233, v233
v_mul_f32 v82, v234, v234
v_mul_f32 v83, v235, v235
buffer_load_dwordx4 v3, s[24:27], s37 offen offset:3072 sc1 lds
v_fma_f32 v76, v76, v69, v68
v_fma_f32 v77, v77, v69, v68
v_fma_f32 v78, v78, v69, v68
v_fma_f32 v79, v79, v69, v68
v_fma_f32 v80, v80, v73, v72
v_fma_f32 v81, v81, v73, v72
v_fma_f32 v82, v82, v73, v72
v_fma_f32 v83, v83, v73, v72
v_mul_f32 v76, v76, v200
v_mul_f32 v77, v77, v201
v_mul_f32 v78, v78, v202
v_mul_f32 v79, v79, v203
v_mul_f32 v80, v80, v232
v_mul_f32 v81, v81, v233
v_mul_f32 v82, v82, v234
v_mul_f32 v83, v83, v235
v_exp_f32 v76, v76
v_exp_f32 v77, v77
v_exp_f32 v78, v78
v_exp_f32 v79, v79
v_exp_f32 v80, v80
v_exp_f32 v81, v81
v_exp_f32 v82, v82
s_add_u32 m0, s39, 147456
s_add_u32 s38, s53, 5373952
buffer_load_dwordx4 v23, s[28:31], s38 offen lds
v_exp_f32 v83, v83
v_fma_f32 v216, -v64, v56, v216
v_fma_f32 v217, -v64, v57, v217
v_fma_f32 v218, -v64, v58, v218
v_fma_f32 v219, -v64, v59, v219
v_fma_f32 v248, -v66, v56, v248
v_fma_f32 v249, -v66, v57, v249
v_fma_f32 v250, -v66, v58, v250
v_fma_f32 v251, -v66, v59, v251
v_fma_f32 v76, v76, v70, v70
v_fma_f32 v77, v77, v70, v70
v_fma_f32 v78, v78, v70, v70
v_fma_f32 v79, v79, v70, v70
v_fma_f32 v80, v80, v74, v74
v_fma_f32 v81, v81, v74, v74
v_fma_f32 v82, v82, v74, v74
v_fma_f32 v83, v83, v74, v74
v_rcp_f32 v76, v76
v_rcp_f32 v77, v77
v_rcp_f32 v78, v78
v_rcp_f32 v79, v79
v_rcp_f32 v80, v80
v_rcp_f32 v81, v81
s_add_u32 m0, s39, 148480
s_add_u32 s38, s53, 5373952
buffer_load_dwordx4 v24, s[28:31], s38 offen lds
v_rcp_f32 v82, v82
v_rcp_f32 v83, v83
v_mul_f32 v216, v200, v216
v_mul_f32 v217, v201, v217
v_mul_f32 v218, v202, v218
v_mul_f32 v219, v203, v219
v_mul_f32 v248, v232, v248
v_mul_f32 v249, v233, v249
v_mul_f32 v250, v234, v250
v_mul_f32 v251, v235, v251
v_mul_f32 v216, v216, v76
v_mul_f32 v217, v217, v77
v_mul_f32 v218, v218, v78
v_mul_f32 v219, v219, v79
v_mul_f32 v248, v248, v80
v_mul_f32 v249, v249, v81
v_mul_f32 v250, v250, v82
v_mul_f32 v251, v251, v83
v_cvt_pk_bf16_f32 v198, v216, v217
v_cvt_pk_bf16_f32 v199, v218, v219
v_cvt_pk_bf16_f32 v230, v248, v249
v_cvt_pk_bf16_f32 v231, v250, v251
buffer_store_dwordx4 v[196:199], v2, s[24:27], s55 offen offset:2048 sc1
buffer_store_dwordx4 v[228:231], v2, s[24:27], s55 offen offset:3072 sc1
s_add_u32 m0, s39, 149504
s_add_u32 s38, s53, 5390336
buffer_load_dwordx4 v23, s[28:31], s38 offen lds
s_add_u32 m0, s39, 150528
s_add_u32 s38, s53, 5390336
buffer_load_dwordx4 v24, s[28:31], s38 offen lds
s_waitcnt vmcnt(30)
s_barrier
s_add_u32 m0, s39, 98304
s_add_u32 s37, s52, 688128
buffer_load_dwordx4 v3, s[24:27], s37 offen sc1 lds
buffer_load_dwordx4 v3, s[24:27], s37 offen offset:1024 sc1 lds
buffer_load_dwordx4 v3, s[24:27], s37 offen offset:2048 sc1 lds
buffer_load_dwordx4 v3, s[24:27], s37 offen offset:3072 sc1 lds
s_add_u32 m0, s39, 114688
s_add_u32 s38, s53, 5505024
buffer_load_dwordx4 v23, s[28:31], s38 offen lds
s_add_u32 m0, s39, 115712
s_add_u32 s38, s53, 5505024
buffer_load_dwordx4 v24, s[28:31], s38 offen lds
s_add_u32 m0, s39, 116736
s_add_u32 s38, s53, 5521408
buffer_load_dwordx4 v23, s[28:31], s38 offen lds
s_add_u32 m0, s39, 117760
s_add_u32 s38, s53, 5521408
buffer_load_dwordx4 v24, s[28:31], s38 offen lds
s_waitcnt vmcnt(10)
s_barrier
s_cmp_eq_u32 s47, 0
s_cbranch_scc0 Lw_134
s_add_u32 s7, s34, 48
s_lshl_b32 s7, s7, 7
v_mov_b32 v26, s7
v_mov_b32 v27, 1
s_mov_b64 exec, 1
buffer_atomic_add v27, v26, s[56:59], 0 offen sc1
s_mov_b64 exec, -1
Lw_134:
s_add_u32 m0, s39, 131072
s_add_u32 s37, s52, 704512
buffer_load_dwordx4 v3, s[24:27], s37 offen sc1 lds
buffer_load_dwordx4 v3, s[24:27], s37 offen offset:1024 sc1 lds
buffer_load_dwordx4 v3, s[24:27], s37 offen offset:2048 sc1 lds
buffer_load_dwordx4 v3, s[24:27], s37 offen offset:3072 sc1 lds
s_add_u32 m0, s39, 0
s_add_u32 s38, s53, 5636096
buffer_load_dwordx4 v23, s[28:31], s38 offen lds
s_add_u32 m0, s39, 1024
s_add_u32 s38, s53, 5636096
buffer_load_dwordx4 v24, s[28:31], s38 offen lds
s_add_u32 m0, s39, 2048
s_add_u32 s38, s53, 5652480
buffer_load_dwordx4 v23, s[28:31], s38 offen lds
s_add_u32 m0, s39, 3072
s_add_u32 s38, s53, 5652480
buffer_load_dwordx4 v24, s[28:31], s38 offen lds
s_waitcnt vmcnt(26)
s_barrier
s_add_u32 m0, s39, 32768
s_add_u32 s38, s91, 0
buffer_load_dwordx4 v23, s[28:31], s38 offen lds
s_add_u32 m0, s39, 33792
s_add_u32 s38, s91, 0
buffer_load_dwordx4 v24, s[28:31], s38 offen lds
s_add_u32 m0, s39, 34816
s_add_u32 s38, s91, 16384
buffer_load_dwordx4 v23, s[28:31], s38 offen lds
s_add_u32 m0, s39, 35840
s_add_u32 s38, s91, 16384
buffer_load_dwordx4 v24, s[28:31], s38 offen lds
s_waitcnt vmcnt(20)
s_barrier
s_add_u32 m0, s39, 65536
s_add_u32 s38, s91, 131072
buffer_load_dwordx4 v23, s[28:31], s38 offen lds
s_add_u32 m0, s39, 66560
s_add_u32 s38, s91, 131072
buffer_load_dwordx4 v24, s[28:31], s38 offen lds
s_add_u32 m0, s39, 67584
s_add_u32 s38, s91, 147456
buffer_load_dwordx4 v23, s[28:31], s38 offen lds
s_add_u32 m0, s39, 68608
s_add_u32 s38, s91, 147456
buffer_load_dwordx4 v24, s[28:31], s38 offen lds
s_waitcnt vmcnt(16)
s_barrier
s_cmp_eq_u32 s47, 3
s_cbranch_scc0 Lw_135
s_lshl_b32 s92, s34, 7
s_add_u32 s92, s92, 28317696
s_load_dword s93, s[82:83], s92 glc
Lw_135:
s_add_u32 m0, s39, 147456
s_add_u32 s38, s91, 262144
buffer_load_dwordx4 v23, s[28:31], s38 offen lds
s_add_u32 m0, s39, 148480
s_add_u32 s38, s91, 262144
buffer_load_dwordx4 v24, s[28:31], s38 offen lds
s_add_u32 m0, s39, 149504
s_add_u32 s38, s91, 278528
buffer_load_dwordx4 v23, s[28:31], s38 offen lds
s_add_u32 m0, s39, 150528
s_add_u32 s38, s91, 278528
buffer_load_dwordx4 v24, s[28:31], s38 offen lds
s_waitcnt vmcnt(12)
s_cmp_eq_u32 s47, 3
s_cbranch_scc0 Lw_136
s_mov_b32 s41, 0x40000
s_branch Lpchk_139
Lpoll_137:
s_load_dword s93, s[82:83], s92 glc
Lpchk_139:
s_waitcnt lgkmcnt(0)
s_cmp_eq_u32 s93, 16
s_cbranch_scc1 Lpok_138
s_sub_u32 s41, s41, 1
s_cmp_lg_u32 s41, 0
s_cbranch_scc1 Lpoll_137
Lpok_138:
Lw_136:
s_barrier
s_add_u32 m0, s39, 16384
s_add_u32 s37, s90, 0
buffer_load_dwordx4 v3, s[24:27], s37 offen sc1 lds
buffer_load_dwordx4 v3, s[24:27], s37 offen offset:1024 sc1 lds
buffer_load_dwordx4 v3, s[24:27], s37 offen offset:2048 sc1 lds
buffer_load_dwordx4 v3, s[24:27], s37 offen offset:3072 sc1 lds
s_add_u32 m0, s39, 49152
s_add_u32 s37, s90, 16384
buffer_load_dwordx4 v3, s[24:27], s37 offen sc1 lds
buffer_load_dwordx4 v3, s[24:27], s37 offen offset:1024 sc1 lds
buffer_load_dwordx4 v3, s[24:27], s37 offen offset:2048 sc1 lds
buffer_load_dwordx4 v3, s[24:27], s37 offen offset:3072 sc1 lds
s_add_u32 m0, s39, 81920
s_add_u32 s37, s90, 32768
buffer_load_dwordx4 v3, s[24:27], s37 offen sc1 lds
buffer_load_dwordx4 v3, s[24:27], s37 offen offset:1024 sc1 lds
buffer_load_dwordx4 v3, s[24:27], s37 offen offset:2048 sc1 lds
buffer_load_dwordx4 v3, s[24:27], s37 offen offset:3072 sc1 lds
s_add_u32 m0, s39, 98304
s_add_u32 s37, s90, 49152
buffer_load_dwordx4 v3, s[24:27], s37 offen sc1 lds
buffer_load_dwordx4 v3, s[24:27], s37 offen offset:1024 sc1 lds
buffer_load_dwordx4 v3, s[24:27], s37 offen offset:2048 sc1 lds
buffer_load_dwordx4 v3, s[24:27], s37 offen offset:3072 sc1 lds
s_add_u32 m0, s39, 114688
s_add_u32 s38, s91, 393216
buffer_load_dwordx4 v23, s[28:31], s38 offen lds
s_add_u32 m0, s39, 115712
s_add_u32 s38, s91, 393216
buffer_load_dwordx4 v24, s[28:31], s38 offen lds
s_add_u32 m0, s39, 116736
s_add_u32 s38, s91, 409600
buffer_load_dwordx4 v23, s[28:31], s38 offen lds
s_add_u32 m0, s39, 117760
s_add_u32 s38, s91, 409600
buffer_load_dwordx4 v24, s[28:31], s38 offen lds
s_waitcnt vmcnt(16)
s_barrier
s_add_u32 m0, s39, 131072
s_add_u32 s37, s90, 65536
buffer_load_dwordx4 v3, s[24:27], s37 offen sc1 lds
buffer_load_dwordx4 v3, s[24:27], s37 offen offset:1024 sc1 lds
buffer_load_dwordx4 v3, s[24:27], s37 offen offset:2048 sc1 lds
buffer_load_dwordx4 v3, s[24:27], s37 offen offset:3072 sc1 lds
s_add_u32 m0, s39, 0
s_add_u32 s38, s91, 524288
buffer_load_dwordx4 v23, s[28:31], s38 offen lds
s_add_u32 m0, s39, 1024
s_add_u32 s38, s91, 524288
buffer_load_dwordx4 v24, s[28:31], s38 offen lds
s_add_u32 m0, s39, 2048
s_add_u32 s38, s91, 540672
buffer_load_dwordx4 v23, s[28:31], s38 offen lds
s_add_u32 m0, s39, 3072
s_add_u32 s38, s91, 540672
buffer_load_dwordx4 v24, s[28:31], s38 offen lds
s_waitcnt vmcnt(20)
s_barrier
s_add_u32 m0, s39, 16384
s_add_u32 s37, s90, 81920
buffer_load_dwordx4 v3, s[24:27], s37 offen sc1 lds
buffer_load_dwordx4 v3, s[24:27], s37 offen offset:1024 sc1 lds
buffer_load_dwordx4 v3, s[24:27], s37 offen offset:2048 sc1 lds
buffer_load_dwordx4 v3, s[24:27], s37 offen offset:3072 sc1 lds
s_add_u32 m0, s39, 32768
s_add_u32 s38, s91, 655360
buffer_load_dwordx4 v23, s[28:31], s38 offen lds
s_add_u32 m0, s39, 33792
s_add_u32 s38, s91, 655360
buffer_load_dwordx4 v24, s[28:31], s38 offen lds
s_add_u32 m0, s39, 34816
s_add_u32 s38, s91, 671744
buffer_load_dwordx4 v23, s[28:31], s38 offen lds
s_add_u32 m0, s39, 35840
s_add_u32 s38, s91, 671744
buffer_load_dwordx4 v24, s[28:31], s38 offen lds
s_waitcnt vmcnt(24)
s_barrier
s_add_u32 m0, s39, 49152
s_add_u32 s37, s90, 98304
buffer_load_dwordx4 v3, s[24:27], s37 offen sc1 lds
buffer_load_dwordx4 v3, s[24:27], s37 offen offset:1024 sc1 lds
buffer_load_dwordx4 v3, s[24:27], s37 offen offset:2048 sc1 lds
buffer_load_dwordx4 v3, s[24:27], s37 offen offset:3072 sc1 lds
s_add_u32 m0, s39, 65536
s_add_u32 s38, s91, 786432
buffer_load_dwordx4 v23, s[28:31], s38 offen lds
s_add_u32 m0, s39, 66560
s_add_u32 s38, s91, 786432
buffer_load_dwordx4 v24, s[28:31], s38 offen lds
s_add_u32 m0, s39, 67584
s_add_u32 s38, s91, 802816
buffer_load_dwordx4 v23, s[28:31], s38 offen lds
s_add_u32 m0, s39, 68608
s_add_u32 s38, s91, 802816
buffer_load_dwordx4 v24, s[28:31], s38 offen lds
s_waitcnt vmcnt(24)
s_barrier
s_add_u32 m0, s39, 81920
s_add_u32 s37, s90, 114688
buffer_load_dwordx4 v3, s[24:27], s37 offen sc1 lds
buffer_load_dwordx4 v3, s[24:27], s37 offen offset:1024 sc1 lds
buffer_load_dwordx4 v3, s[24:27], s37 offen offset:2048 sc1 lds
buffer_load_dwordx4 v3, s[24:27], s37 offen offset:3072 sc1 lds
s_add_u32 m0, s39, 147456
s_add_u32 s38, s91, 917504
buffer_load_dwordx4 v23, s[28:31], s38 offen lds
s_add_u32 m0, s39, 148480
s_add_u32 s38, s91, 917504
buffer_load_dwordx4 v24, s[28:31], s38 offen lds
s_add_u32 m0, s39, 149504
s_add_u32 s38, s91, 933888
buffer_load_dwordx4 v23, s[28:31], s38 offen lds
s_add_u32 m0, s39, 150528
s_add_u32 s38, s91, 933888
buffer_load_dwordx4 v24, s[28:31], s38 offen lds
s_waitcnt vmcnt(24)
s_barrier
s_add_u32 m0, s39, 98304
s_add_u32 s37, s90, 131072
buffer_load_dwordx4 v3, s[24:27], s37 offen sc1 lds
buffer_load_dwordx4 v3, s[24:27], s37 offen offset:1024 sc1 lds
buffer_load_dwordx4 v3, s[24:27], s37 offen offset:2048 sc1 lds
buffer_load_dwordx4 v3, s[24:27], s37 offen offset:3072 sc1 lds
s_add_u32 m0, s39, 114688
s_add_u32 s38, s91, 1048576
buffer_load_dwordx4 v23, s[28:31], s38 offen lds
s_add_u32 m0, s39, 115712
s_add_u32 s38, s91, 1048576
buffer_load_dwordx4 v24, s[28:31], s38 offen lds
s_add_u32 m0, s39, 116736
s_add_u32 s38, s91, 1064960
buffer_load_dwordx4 v23, s[28:31], s38 offen lds
s_add_u32 m0, s39, 117760
s_add_u32 s38, s91, 1064960
buffer_load_dwordx4 v24, s[28:31], s38 offen lds
s_waitcnt vmcnt(24)
s_barrier
s_add_u32 m0, s39, 131072
s_add_u32 s37, s90, 147456
buffer_load_dwordx4 v3, s[24:27], s37 offen sc1 lds
buffer_load_dwordx4 v3, s[24:27], s37 offen offset:1024 sc1 lds
buffer_load_dwordx4 v3, s[24:27], s37 offen offset:2048 sc1 lds
buffer_load_dwordx4 v3, s[24:27], s37 offen offset:3072 sc1 lds
s_add_u32 m0, s39, 0
s_add_u32 s38, s91, 1179648
buffer_load_dwordx4 v23, s[28:31], s38 offen lds
s_add_u32 m0, s39, 1024
s_add_u32 s38, s91, 1179648
buffer_load_dwordx4 v24, s[28:31], s38 offen lds
s_add_u32 m0, s39, 2048
s_add_u32 s38, s91, 1196032
buffer_load_dwordx4 v23, s[28:31], s38 offen lds
s_add_u32 m0, s39, 3072
s_add_u32 s38, s91, 1196032
buffer_load_dwordx4 v24, s[28:31], s38 offen lds
s_waitcnt vmcnt(24)
s_barrier
s_add_u32 m0, s39, 16384
s_mov_b32 s37, 327680
buffer_load_dwordx4 v3, s[24:27], s37 offen sc1 lds
buffer_load_dwordx4 v3, s[24:27], s37 offen offset:1024 sc1 lds
buffer_load_dwordx4 v3, s[24:27], s37 offen offset:2048 sc1 lds
buffer_load_dwordx4 v3, s[24:27], s37 offen offset:3072 sc1 lds
s_add_u32 m0, s51, 32768
s_mov_b32 s38, 2621440
buffer_load_dwordx4 v25, s[28:31], s38 offen lds
s_add_u32 m0, s51, 33792
s_mov_b32 s38, 2637824
buffer_load_dwordx4 v25, s[28:31], s38 offen lds
s_waitcnt vmcnt(22)
s_barrier
s_add_u32 m0, s39, 49152
s_mov_b32 s37, 344064
buffer_load_dwordx4 v3, s[24:27], s37 offen sc1 lds
buffer_load_dwordx4 v3, s[24:27], s37 offen offset:1024 sc1 lds
s_branch Lov_18
.p2align 12
.fill 144, 4, 0xbf800000
Lst_18_0:
s_branch Lwr_172
s_nop 0
s_nop 0
Lov_18:
buffer_load_dwordx4 v3, s[24:27], s37 offen offset:2048 sc1 lds
buffer_load_dwordx4 v3, s[24:27], s37 offen offset:3072 sc1 lds
s_add_u32 m0, s51, 65536
s_mov_b32 s38, 2752512
buffer_load_dwordx4 v25, s[28:31], s38 offen lds
s_add_u32 m0, s51, 66560
s_mov_b32 s38, 2768896
buffer_load_dwordx4 v25, s[28:31], s38 offen lds
s_waitcnt vmcnt(20)
s_barrier
s_add_u32 m0, s39, 81920
s_mov_b32 s37, 360448
buffer_load_dwordx4 v3, s[24:27], s37 offen sc1 lds
buffer_load_dwordx4 v3, s[24:27], s37 offen offset:1024 sc1 lds
buffer_load_dwordx4 v3, s[24:27], s37 offen offset:2048 sc1 lds
buffer_load_dwordx4 v3, s[24:27], s37 offen offset:3072 sc1 lds
s_add_u32 m0, s51, 147456
s_mov_b32 s38, 2883584
buffer_load_dwordx4 v25, s[28:31], s38 offen lds
s_add_u32 m0, s51, 148480
s_mov_b32 s38, 2899968
buffer_load_dwordx4 v25, s[28:31], s38 offen lds
s_waitcnt vmcnt(18)
s_barrier
s_add_u32 m0, s39, 98304
s_mov_b32 s37, 376832
buffer_load_dwordx4 v3, s[24:27], s37 offen sc1 lds
buffer_load_dwordx4 v3, s[24:27], s37 offen offset:1024 sc1 lds
buffer_load_dwordx4 v3, s[24:27], s37 offen offset:2048 sc1 lds
buffer_load_dwordx4 v3, s[24:27], s37 offen offset:3072 sc1 lds
s_add_u32 m0, s51, 114688
s_mov_b32 s38, 3014656
buffer_load_dwordx4 v25, s[28:31], s38 offen lds
s_add_u32 m0, s51, 115712
s_mov_b32 s38, 3031040
buffer_load_dwordx4 v25, s[28:31], s38 offen lds
s_waitcnt vmcnt(18)
s_barrier
s_add_u32 m0, s39, 131072
s_mov_b32 s37, 393216
buffer_load_dwordx4 v3, s[24:27], s37 offen sc1 lds
buffer_load_dwordx4 v3, s[24:27], s37 offen offset:1024 sc1 lds
buffer_load_dwordx4 v3, s[24:27], s37 offen offset:2048 sc1 lds
buffer_load_dwordx4 v3, s[24:27], s37 offen offset:3072 sc1 lds
s_add_u32 m0, s51, 0
s_mov_b32 s38, 3145728
buffer_load_dwordx4 v25, s[28:31], s38 offen lds
s_add_u32 m0, s51, 1024
s_mov_b32 s38, 3162112
buffer_load_dwordx4 v25, s[28:31], s38 offen lds
s_waitcnt vmcnt(18)
s_barrier
s_add_u32 m0, s39, 16384
s_mov_b32 s37, 409600
buffer_load_dwordx4 v3, s[24:27], s37 offen sc1 lds
buffer_load_dwordx4 v3, s[24:27], s37 offen offset:1024 sc1 lds
buffer_load_dwordx4 v3, s[24:27], s37 offen offset:2048 sc1 lds
buffer_load_dwordx4 v3, s[24:27], s37 offen offset:3072 sc1 lds
s_add_u32 m0, s51, 32768
s_mov_b32 s38, 3276800
buffer_load_dwordx4 v25, s[28:31], s38 offen lds
s_add_u32 m0, s51, 33792
s_mov_b32 s38, 3293184
buffer_load_dwordx4 v25, s[28:31], s38 offen lds
s_waitcnt vmcnt(18)
s_barrier
s_add_u32 m0, s39, 49152
s_mov_b32 s37, 425984
buffer_load_dwordx4 v3, s[24:27], s37 offen sc1 lds
buffer_load_dwordx4 v3, s[24:27], s37 offen offset:1024 sc1 lds
buffer_load_dwordx4 v3, s[24:27], s37 offen offset:2048 sc1 lds
buffer_load_dwordx4 v3, s[24:27], s37 offen offset:3072 sc1 lds
s_add_u32 m0, s51, 65536
s_mov_b32 s38, 3407872
buffer_load_dwordx4 v25, s[28:31], s38 offen lds
s_add_u32 m0, s51, 66560
s_mov_b32 s38, 3424256
buffer_load_dwordx4 v25, s[28:31], s38 offen lds
s_waitcnt vmcnt(18)
s_barrier
s_add_u32 m0, s39, 81920
s_mov_b32 s37, 442368
buffer_load_dwordx4 v3, s[24:27], s37 offen sc1 lds
buffer_load_dwordx4 v3, s[24:27], s37 offen offset:1024 sc1 lds
buffer_load_dwordx4 v3, s[24:27], s37 offen offset:2048 sc1 lds
buffer_load_dwordx4 v3, s[24:27], s37 offen offset:3072 sc1 lds
s_add_u32 m0, s51, 147456
s_mov_b32 s38, 3538944
buffer_load_dwordx4 v25, s[28:31], s38 offen lds
s_add_u32 m0, s51, 148480
s_mov_b32 s38, 3555328
buffer_load_dwordx4 v25, s[28:31], s38 offen lds
s_waitcnt vmcnt(18)
s_barrier
s_add_u32 m0, s39, 98304
s_mov_b32 s37, 458752
buffer_load_dwordx4 v3, s[24:27], s37 offen sc1 lds
buffer_load_dwordx4 v3, s[24:27], s37 offen offset:1024 sc1 lds
buffer_load_dwordx4 v3, s[24:27], s37 offen offset:2048 sc1 lds
buffer_load_dwordx4 v3, s[24:27], s37 offen offset:3072 sc1 lds
s_add_u32 m0, s51, 114688
s_mov_b32 s38, 3670016
buffer_load_dwordx4 v25, s[28:31], s38 offen lds
s_add_u32 m0, s51, 115712
s_mov_b32 s38, 3686400
buffer_load_dwordx4 v25, s[28:31], s38 offen lds
s_waitcnt vmcnt(18)
s_barrier
s_add_u32 m0, s39, 131072
s_mov_b32 s37, 475136
buffer_load_dwordx4 v3, s[24:27], s37 offen sc1 lds
buffer_load_dwordx4 v3, s[24:27], s37 offen offset:1024 sc1 lds
buffer_load_dwordx4 v3, s[24:27], s37 offen offset:2048 sc1 lds
buffer_load_dwordx4 v3, s[24:27], s37 offen offset:3072 sc1 lds
s_add_u32 m0, s51, 0
s_mov_b32 s38, 3801088
buffer_load_dwordx4 v25, s[28:31], s38 offen lds
s_add_u32 m0, s51, 1024
s_mov_b32 s38, 3817472
buffer_load_dwordx4 v25, s[28:31], s38 offen lds
s_waitcnt vmcnt(18)
s_barrier
s_cmp_eq_u32 s47, 0
s_cbranch_scc0 Lw_140
s_xor_b32 s43, s2, 2
s_add_u32 s43, s43, 128
s_lshl_b32 s43, s43, 7
v_mov_b32 v26, s43
v_mov_b32 v27, 1
s_mov_b64 exec, 1
buffer_store_dword v27, v26, s[56:59], 0 offen sc1
s_mov_b64 exec, -1
Lw_140:
s_add_u32 m0, s39, 16384
s_mov_b32 s37, 491520
buffer_load_dwordx4 v3, s[24:27], s37 offen sc1 lds
buffer_load_dwordx4 v3, s[24:27], s37 offen offset:1024 sc1 lds
buffer_load_dwordx4 v3, s[24:27], s37 offen offset:2048 sc1 lds
buffer_load_dwordx4 v3, s[24:27], s37 offen offset:3072 sc1 lds
s_add_u32 m0, s51, 32768
s_mov_b32 s38, 3932160
buffer_load_dwordx4 v25, s[28:31], s38 offen lds
s_add_u32 m0, s51, 33792
s_mov_b32 s38, 3948544
buffer_load_dwordx4 v25, s[28:31], s38 offen lds
s_waitcnt vmcnt(18)
s_barrier
s_add_u32 m0, s39, 49152
s_mov_b32 s37, 507904
buffer_load_dwordx4 v3, s[24:27], s37 offen sc1 lds
buffer_load_dwordx4 v3, s[24:27], s37 offen offset:1024 sc1 lds
buffer_load_dwordx4 v3, s[24:27], s37 offen offset:2048 sc1 lds
buffer_load_dwordx4 v3, s[24:27], s37 offen offset:3072 sc1 lds
s_add_u32 m0, s51, 65536
s_mov_b32 s38, 4063232
buffer_load_dwordx4 v25, s[28:31], s38 offen lds
s_add_u32 m0, s51, 66560
s_mov_b32 s38, 4079616
buffer_load_dwordx4 v25, s[28:31], s38 offen lds
s_waitcnt vmcnt(18)
s_barrier
s_cmp_eq_u32 s47, 3
s_cbranch_scc0 Lw_141
s_lshl_b32 s92, s2, 7
s_add_u32 s92, s92, 28327936
s_load_dword s93, s[82:83], s92 glc
Lw_141:
s_waitcnt vmcnt(12)
s_cmp_eq_u32 s47, 3
s_cbranch_scc0 Lw_142
s_mov_b32 s41, 0x40000
s_branch Lpchk_145
Lpoll_143:
s_load_dword s93, s[82:83], s92 glc
Lpchk_145:
s_waitcnt lgkmcnt(0)
s_cmp_eq_u32 s93, 1
s_cbranch_scc1 Lpok_144
s_sub_u32 s41, s41, 1
s_cmp_lg_u32 s41, 0
s_cbranch_scc1 Lpoll_143
Lpok_144:
Lw_142:
s_barrier
s_waitcnt vmcnt(6)
s_barrier
s_waitcnt vmcnt(0)
s_barrier
s_barrier
s_branch Ldone_1
Ldone_1:
Lfin:
Lexit_2:
s_endpgm
.section .rodata,"a"
.p2align 6
.amdhsa_kernel sequential_preLN__sliding_local_dilated__glu_gated_geglu__prompt_kernel
  .amdhsa_next_free_vgpr 256
  .amdhsa_next_free_sgpr 100
  .amdhsa_accum_offset 256
  .amdhsa_group_segment_fixed_size 0
  .amdhsa_kernarg_size 80
  .amdhsa_user_sgpr_count 2
  .amdhsa_user_sgpr_kernarg_segment_ptr 1
  .amdhsa_system_sgpr_workgroup_id_x 1
  .amdhsa_float_denorm_mode_32 3
  .amdhsa_float_denorm_mode_16_64 3
.end_amdhsa_kernel
```

```asm
; @launch grid=(256,1,1) block=(512,1,1) lds=163840
.amdgcn_target "amdgcn-amd-amdhsa--gfx950"
.text
.globl sequential_preLN__sliding_local_dilated__glu_gated_geglu__prompt_kernel
.p2align 8
.type sequential_preLN__sliding_local_dilated__glu_gated_geglu__prompt_kernel,@function
sequential_preLN__sliding_local_dilated__glu_gated_geglu__prompt_kernel:
s_cmp_ge_u32 s2, 256
s_cbranch_scc1 Lexit_2
s_load_dwordx16 s[64:79], s[0:1], 0
s_load_dwordx4 s[80:83], s[0:1], 64
s_and_b32 s3, s2, 7
s_lshr_b32 s42, s2, 3
s_and_b32 s34, s3, 1
s_lshl_b32 s34, s34, 3
s_and_b32 s48, s42, 7
s_add_u32 s34, s34, s48
s_lshr_b32 s35, s3, 1
s_lshr_b32 s49, s42, 3
s_lshl_b32 s35, s35, 2
s_add_u32 s35, s35, s49
v_lshrrev_b32 v12, 6, v0
v_and_b32 v1, 63, v0
v_readfirstlane_b32 s36, v12
Lbeg:
s_lshl_b32 s50, s34, 7
s_sub_u32 s50, s50, 16
v_and_b32 v12, 15, v1
v_lshrrev_b32 v13, 4, v1
s_cmp_lt_u32 s36, 4
s_cbranch_scc1 Lcons_7
Lprod_3:
s_sub_u32 s47, s36, 4
s_lshl_b32 s43, s34, 7
s_lshl_b32 s44, s35, 3
s_add_u32 s63, s43, s44
s_lshl_b32 s44, s47, 1
s_add_u32 s51, s63, s44
v_lshlrev_b32 v10, 4, v1
s_and_b32 s43, s2, 7
s_lshr_b32 s44, s43, 2
s_lshl_b32 s44, s44, 1
s_and_b32 s45, s43, 1
s_add_u32 s44, s44, s45
s_lshr_b32 s45, s2, 3
s_lshl_b32 s45, s45, 2
s_add_u32 s44, s44, s45
s_add_u32 s44, s44, 96
s_bitcmp1_b32 s43, 1
s_cselect_b32 s44, s44, 0x10000
s_cmp_lt_u32 s2, 192
s_cselect_b32 s33, s2, s44
v_lshrrev_b32 v14, 3, v1
v_and_b32 v15, 7, v1
v_lshl_add_u32 v19, v14, 6, v15
s_lshl_b32 s43, s48, 3
v_add_u32 v19, s43, v19
v_mul_u32_u24 v19, 6144, v19
s_cmp_eq_u32 s47, 3
s_cbranch_scc1 Lpf_4
v_and_b32 v16, 2, v14
v_xor_b32 v16, v15, v16
v_lshlrev_b32 v16, 4, v16
v_mul_u32_u24 v17, 6144, v14
s_lshl_b32 s43, s47, 11
v_add3_u32 v2, v17, v16, s43
v_xor_b32 v3, 64, v2
v_lshrrev_b32 v16, 1, v14
v_xor_b32 v16, v15, v16
v_lshlrev_b32 v16, 4, v16
s_lshl_b32 s43, s47, 3
s_add_u32 s43, s43, s50
v_add_u32 v17, s43, v14
s_and_b32 s44, s47, 1
s_lshl_b32 s44, s44, 6
v_add_u32 v18, 0, v17
v_max_i32 v18, 0, v18
v_lshl_add_u32 v18, v18, 11, v16
v_xor_b32 v18, s44, v18
v_mov_b32 v4, v18
v_add_u32 v18, 24, v17
v_max_i32 v18, 0, v18
v_lshl_add_u32 v18, v18, 11, v16
v_xor_b32 v18, s44, v18
v_xor_b32 v5, 64, v18
v_add_u32 v18, 48, v17
v_max_i32 v18, 0, v18
v_lshl_add_u32 v18, v18, 11, v16
v_xor_b32 v18, s44, v18
v_mov_b32 v6, v18
v_add_u32 v18, 72, v17
v_max_i32 v18, 0, v18
v_lshl_add_u32 v18, v18, 11, v16
v_xor_b32 v18, s44, v18
v_xor_b32 v7, 64, v18
v_add_u32 v18, 96, v17
v_max_i32 v18, 0, v18
v_lshl_add_u32 v18, v18, 11, v16
v_xor_b32 v18, s44, v18
v_mov_b32 v8, v18
v_add_u32 v18, 120, v17
v_max_i32 v18, 0, v18
v_lshl_add_u32 v18, v18, 11, v16
v_xor_b32 v18, s44, v18
v_xor_b32 v9, 64, v18
s_lshl_b32 s39, s47, 10
s_lshl_b32 s40, s47, 13
s_add_u32 s40, s40, 18432
s_mov_b32 s37, 0
s_mov_b32 s38, 0
s_bfm_b64 s[60:61], 56, 8
s_cmp_eq_u32 s47, 0
s_cselect_b64 s[60:61], s[60:61], -1
s_lshl_b32 s43, s35, 7
s_waitcnt lgkmcnt(0)
s_mov_b32 s8, s64
s_mov_b32 s9, s65
s_mov_b32 s10, 4194304
s_mov_b32 s11, 0x20000
s_add_u32 s12, s66, s43
s_addc_u32 s13, s67, 0
s_mov_b32 s14, 6289536
s_mov_b32 s15, 0x20000
s_add_u32 m0, s39, 0
s_mov_b64 exec, s[60:61]
buffer_load_dwordx4 v4, s[8:11], s37 offen lds
s_mov_b64 exec, -1
s_add_u32 m0, s39, 3072
s_nop 0
buffer_load_dwordx4 v5, s[8:11], s37 offen lds
s_add_u32 m0, s39, 6144
s_nop 0
buffer_load_dwordx4 v6, s[8:11], s37 offen lds
s_add_u32 m0, s39, 9216
s_nop 0
buffer_load_dwordx4 v7, s[8:11], s37 offen lds
s_add_u32 m0, s39, 12288
s_nop 0
buffer_load_dwordx4 v8, s[8:11], s37 offen lds
s_add_u32 m0, s39, 15360
s_nop 0
buffer_load_dwordx4 v9, s[8:11], s37 offen lds
s_add_u32 m0, s40, 0
s_add_u32 s43, s38, 0
buffer_load_dwordx4 v2, s[12:15], s43 offen lds
s_add_u32 m0, s40, 1024
s_add_u32 s43, s38, 49152
buffer_load_dwordx4 v3, s[12:15], s43 offen lds
s_add_u32 m0, s40, 2048
s_add_u32 s43, s38, 98304
buffer_load_dwordx4 v2, s[12:15], s43 offen lds
s_add_u32 m0, s40, 3072
s_add_u32 s43, s38, 147456
buffer_load_dwordx4 v3, s[12:15], s43 offen lds
s_add_u32 m0, s40, 4096
s_add_u32 s43, s38, 196608
buffer_load_dwordx4 v2, s[12:15], s43 offen lds
s_add_u32 m0, s40, 5120
s_add_u32 s43, s38, 245760
buffer_load_dwordx4 v3, s[12:15], s43 offen lds
s_add_u32 m0, s40, 6144
s_add_u32 s43, s38, 294912
buffer_load_dwordx4 v2, s[12:15], s43 offen lds
s_add_u32 m0, s40, 7168
s_add_u32 s43, s38, 344064
buffer_load_dwordx4 v3, s[12:15], s43 offen lds
s_add_u32 s37, s37, 128
s_add_u32 s38, s38, 393216
s_mov_b32 s28, s66
s_mov_b32 s29, s67
s_mov_b32 s30, 6291456
s_mov_b32 s31, 0x20000
s_mul_i32 s43, s33, 3840
s_add_u32 s43, s43, 393216
v_lshlrev_b32 v30, 7, v1
s_mul_i32 s44, s47, 1280
s_add_u32 s43, s43, s44
s_bfm_b64 exec, 10, 0
buffer_load_dword v31, v30, s[28:31], s43 offen
s_mov_b64 exec, -1
s_lshl_b32 s43, s51, 11
buffer_load_dwordx4 v[96:99], v10, s[8:11], s43 offen offset:0
buffer_load_dwordx4 v[100:103], v10, s[8:11], s43 offen offset:1024
buffer_load_dwordx4 v[104:107], v10, s[8:11], s43 offen offset:2048
buffer_load_dwordx4 v[108:111], v10, s[8:11], s43 offen offset:3072
s_add_u32 m0, s39, 43008
s_mov_b64 exec, s[60:61]
buffer_load_dwordx4 v4, s[8:11], s37 offen lds
s_mov_b64 exec, -1
s_add_u32 m0, s39, 46080
s_nop 0
buffer_load_dwordx4 v5, s[8:11], s37 offen lds
s_add_u32 m0, s39, 49152
s_nop 0
buffer_load_dwordx4 v6, s[8:11], s37 offen lds
s_add_u32 m0, s39, 52224
s_nop 0
buffer_load_dwordx4 v7, s[8:11], s37 offen lds
s_add_u32 m0, s39, 55296
s_nop 0
buffer_load_dwordx4 v8, s[8:11], s37 offen lds
s_add_u32 m0, s39, 58368
s_nop 0
buffer_load_dwordx4 v9, s[8:11], s37 offen lds
s_add_u32 m0, s40, 43008
s_add_u32 s43, s38, 0
buffer_load_dwordx4 v2, s[12:15], s43 offen lds
s_add_u32 m0, s40, 44032
s_add_u32 s43, s38, 49152
buffer_load_dwordx4 v3, s[12:15], s43 offen lds
s_add_u32 m0, s40, 45056
s_add_u32 s43, s38, 98304
buffer_load_dwordx4 v2, s[12:15], s43 offen lds
s_add_u32 m0, s40, 46080
s_add_u32 s43, s38, 147456
buffer_load_dwordx4 v3, s[12:15], s43 offen lds
s_add_u32 m0, s40, 47104
s_add_u32 s43, s38, 196608
buffer_load_dwordx4 v2, s[12:15], s43 offen lds
s_add_u32 m0, s40, 48128
s_add_u32 s43, s38, 245760
buffer_load_dwordx4 v3, s[12:15], s43 offen lds
s_add_u32 m0, s40, 49152
s_add_u32 s43, s38, 294912
buffer_load_dwordx4 v2, s[12:15], s43 offen lds
s_add_u32 m0, s40, 50176
s_add_u32 s43, s38, 344064
buffer_load_dwordx4 v3, s[12:15], s43 offen lds
s_add_u32 s37, s37, 128
s_add_u32 s38, s38, 393216
s_waitcnt vmcnt(19)
s_barrier
s_add_u32 m0, s39, 86016
s_mov_b64 exec, s[60:61]
buffer_load_dwordx4 v4, s[8:11], s37 offen lds
s_mov_b64 exec, -1
s_add_u32 m0, s39, 89088
s_nop 0
buffer_load_dwordx4 v5, s[8:11], s37 offen lds
s_add_u32 m0, s39, 92160
s_nop 0
buffer_load_dwordx4 v6, s[8:11], s37 offen lds
s_add_u32 m0, s39, 95232
s_nop 0
buffer_load_dwordx4 v7, s[8:11], s37 offen lds
s_add_u32 m0, s39, 98304
s_nop 0
buffer_load_dwordx4 v8, s[8:11], s37 offen lds
s_add_u32 m0, s39, 101376
s_nop 0
buffer_load_dwordx4 v9, s[8:11], s37 offen lds
s_add_u32 m0, s40, 86016
s_add_u32 s43, s38, 0
buffer_load_dwordx4 v2, s[12:15], s43 offen lds
s_add_u32 m0, s40, 87040
s_add_u32 s43, s38, 49152
buffer_load_dwordx4 v3, s[12:15], s43 offen lds
s_add_u32 m0, s40, 88064
s_add_u32 s43, s38, 98304
buffer_load_dwordx4 v2, s[12:15], s43 offen lds
s_add_u32 m0, s40, 89088
s_add_u32 s43, s38, 147456
buffer_load_dwordx4 v3, s[12:15], s43 offen lds
s_add_u32 m0, s40, 90112
s_add_u32 s43, s38, 196608
buffer_load_dwordx4 v2, s[12:15], s43 offen lds
s_add_u32 m0, s40, 91136
s_add_u32 s43, s38, 245760
buffer_load_dwordx4 v3, s[12:15], s43 offen lds
s_add_u32 m0, s40, 92160
s_add_u32 s43, s38, 294912
buffer_load_dwordx4 v2, s[12:15], s43 offen lds
s_add_u32 m0, s40, 93184
s_add_u32 s43, s38, 344064
buffer_load_dwordx4 v3, s[12:15], s43 offen lds
s_add_u32 s37, s37, 128
s_add_u32 s38, s38, 393216
s_waitcnt vmcnt(28)
s_mov_b32 s43, 0x3f803f80
v_mov_b32 v116, 0
v_mov_b32 v117, 0
v_mov_b32 v118, 0
v_mov_b32 v119, 0
v_mov_b32 v120, 0
v_mov_b32 v121, 0
v_mov_b32 v122, 0
v_mov_b32 v123, 0
v_dot2_f32_bf16 v116, v96, s43, v116
v_dot2_f32_bf16 v120, v96, v96, v120
v_dot2_f32_bf16 v118, v104, s43, v118
v_dot2_f32_bf16 v122, v104, v104, v122
v_dot2_f32_bf16 v117, v97, s43, v117
v_dot2_f32_bf16 v121, v97, v97, v121
v_dot2_f32_bf16 v119, v105, s43, v119
v_dot2_f32_bf16 v123, v105, v105, v123
v_dot2_f32_bf16 v116, v98, s43, v116
v_dot2_f32_bf16 v120, v98, v98, v120
v_dot2_f32_bf16 v118, v106, s43, v118
v_dot2_f32_bf16 v122, v106, v106, v122
v_dot2_f32_bf16 v117, v99, s43, v117
v_dot2_f32_bf16 v121, v99, v99, v121
v_dot2_f32_bf16 v119, v107, s43, v119
v_dot2_f32_bf16 v123, v107, v107, v123
v_dot2_f32_bf16 v116, v100, s43, v116
v_dot2_f32_bf16 v120, v100, v100, v120
v_dot2_f32_bf16 v118, v108, s43, v118
v_dot2_f32_bf16 v122, v108, v108, v122
v_dot2_f32_bf16 v117, v101, s43, v117
v_dot2_f32_bf16 v121, v101, v101, v121
v_dot2_f32_bf16 v119, v109, s43, v119
v_dot2_f32_bf16 v123, v109, v109, v123
v_dot2_f32_bf16 v116, v102, s43, v116
v_dot2_f32_bf16 v120, v102, v102, v120
v_dot2_f32_bf16 v118, v110, s43, v118
v_dot2_f32_bf16 v122, v110, v110, v122
v_dot2_f32_bf16 v117, v103, s43, v117
v_dot2_f32_bf16 v121, v103, v103, v121
v_dot2_f32_bf16 v119, v111, s43, v119
v_dot2_f32_bf16 v123, v111, v111, v123
s_nop 2
v_add_f32 v116, v116, v117
v_add_f32 v118, v118, v119
v_add_f32 v120, v120, v121
v_add_f32 v122, v122, v123
s_nop 1
v_permlane32_swap_b32 v116, v118
v_permlane32_swap_b32 v120, v122
v_add_f32 v116, v116, v118
v_add_f32 v120, v120, v122
s_nop 1
v_permlane16_swap_b32 v116, v120
v_add_f32 v116, v116, v120
s_nop 1
v_add_f32_dpp v116, v116, v116 row_ror:8 row_mask:0xf bank_mask:0xf
s_nop 1
v_add_f32_dpp v116, v116, v116 row_ror:4 row_mask:0xf bank_mask:0xf
s_nop 1
v_add_f32_dpp v116, v116, v116 row_ror:2 row_mask:0xf bank_mask:0xf
s_nop 1
v_add_f32_dpp v116, v116, v116 row_ror:1 row_mask:0xf bank_mask:0xf
v_mov_b32 v117, v116
s_nop 1
v_permlane16_swap_b32 v116, v117
v_mul_f32 v112, 0x3a800000, v116
v_mul_f32 v113, 0x3a800000, v117
v_fma_f32 v113, -v112, v112, v113
v_max_f32 v113, 0, v113
v_add_f32 v113, 0x3727c5ac, v113
v_rsq_f32 v113, v113
v_lshrrev_b32 v11, 5, v1
s_lshl_b32 s43, s47, 4
s_add_u32 s43, s43, 148608
v_lshl_add_u32 v11, v11, 3, s43
ds_write_b64 v11, v[112:113]
s_waitcnt lgkmcnt(0)
s_and_b32 s44, s36, 3
s_mul_i32 s44, s44, 24
s_bfe_u32 s43, s2, 0x30001
s_lshl_b32 s43, s43, 7
s_add_u32 s44, s44, s43
s_mul_i32 s44, s44, 7168
s_lshr_b32 s43, s2, 4
s_lshl_b32 s43, s43, 8
s_add_u32 s43, s43, s44
s_bitcmp0_b32 s2, 0
s_cselect_b32 s4, s72, s74
s_cselect_b32 s5, s73, s75
s_add_u32 s4, s4, s43
s_addc_u32 s5, s5, 0
s_waitcnt vmcnt(14)
s_barrier
s_add_u32 m0, s39, 0
s_mov_b64 exec, s[60:61]
buffer_load_dwordx4 v4, s[8:11], s37 offen lds
s_mov_b64 exec, -1
s_add_u32 m0, s39, 3072
s_nop 0
buffer_load_dwordx4 v5, s[8:11], s37 offen lds
s_add_u32 m0, s39, 6144
s_nop 0
buffer_load_dwordx4 v6, s[8:11], s37 offen lds
s_add_u32 m0, s39, 9216
s_nop 0
buffer_load_dwordx4 v7, s[8:11], s37 offen lds
s_add_u32 m0, s39, 12288
s_nop 0
buffer_load_dwordx4 v8, s[8:11], s37 offen lds
s_add_u32 m0, s39, 15360
s_nop 0
buffer_load_dwordx4 v9, s[8:11], s37 offen lds
s_add_u32 m0, s40, 0
s_add_u32 s43, s38, 0
buffer_load_dwordx4 v2, s[12:15], s43 offen lds
s_add_u32 m0, s40, 1024
s_add_u32 s43, s38, 49152
buffer_load_dwordx4 v3, s[12:15], s43 offen lds
s_add_u32 m0, s40, 2048
s_add_u32 s43, s38, 98304
buffer_load_dwordx4 v2, s[12:15], s43 offen lds
s_add_u32 m0, s40, 3072
s_add_u32 s43, s38, 147456
buffer_load_dwordx4 v3, s[12:15], s43 offen lds
s_add_u32 m0, s40, 4096
s_add_u32 s43, s38, 196608
buffer_load_dwordx4 v2, s[12:15], s43 offen lds
s_add_u32 m0, s40, 5120
s_add_u32 s43, s38, 245760
buffer_load_dwordx4 v3, s[12:15], s43 offen lds
s_add_u32 m0, s40, 6144
s_add_u32 s43, s38, 294912
buffer_load_dwordx4 v2, s[12:15], s43 offen lds
s_add_u32 m0, s40, 7168
s_add_u32 s43, s38, 344064
buffer_load_dwordx4 v3, s[12:15], s43 offen lds
s_add_u32 s37, s37, 128
s_add_u32 s38, s38, 393216
s_waitcnt vmcnt(14)
s_barrier
s_add_u32 m0, s39, 43008
s_mov_b64 exec, s[60:61]
buffer_load_dwordx4 v4, s[8:11], s37 offen lds
s_mov_b64 exec, -1
s_add_u32 m0, s39, 46080
s_nop 0
buffer_load_dwordx4 v5, s[8:11], s37 offen lds
s_add_u32 m0, s39, 49152
s_nop 0
buffer_load_dwordx4 v6, s[8:11], s37 offen lds
s_add_u32 m0, s39, 52224
s_nop 0
buffer_load_dwordx4 v7, s[8:11], s37 offen lds
s_add_u32 m0, s39, 55296
s_nop 0
buffer_load_dwordx4 v8, s[8:11], s37 offen lds
s_add_u32 m0, s39, 58368
s_nop 0
buffer_load_dwordx4 v9, s[8:11], s37 offen lds
s_add_u32 m0, s40, 43008
s_add_u32 s43, s38, 0
buffer_load_dwordx4 v2, s[12:15], s43 offen lds
s_add_u32 m0, s40, 44032
s_add_u32 s43, s38, 49152
buffer_load_dwordx4 v3, s[12:15], s43 offen lds
s_add_u32 m0, s40, 45056
s_add_u32 s43, s38, 98304
buffer_load_dwordx4 v2, s[12:15], s43 offen lds
s_add_u32 m0, s40, 46080
s_add_u32 s43, s38, 147456
buffer_load_dwordx4 v3, s[12:15], s43 offen lds
s_add_u32 m0, s40, 47104
s_add_u32 s43, s38, 196608
buffer_load_dwordx4 v2, s[12:15], s43 offen lds
s_add_u32 m0, s40, 48128
s_add_u32 s43, s38, 245760
buffer_load_dwordx4 v3, s[12:15], s43 offen lds
s_add_u32 m0, s40, 49152
s_add_u32 s43, s38, 294912
buffer_load_dwordx4 v2, s[12:15], s43 offen lds
s_add_u32 m0, s40, 50176
s_add_u32 s43, s38, 344064
buffer_load_dwordx4 v3, s[12:15], s43 offen lds
s_add_u32 s37, s37, 128
s_add_u32 s38, s38, 393216
s_load_dword s3, s[4:5], 0
s_load_dword s3, s[4:5], 64
s_load_dword s3, s[4:5], 128
s_waitcnt vmcnt(14)
s_barrier
s_add_u32 m0, s39, 86016
s_mov_b64 exec, s[60:61]
buffer_load_dwordx4 v4, s[8:11], s37 offen lds
s_mov_b64 exec, -1
s_add_u32 m0, s39, 89088
s_nop 0
buffer_load_dwordx4 v5, s[8:11], s37 offen lds
s_add_u32 m0, s39, 92160
s_nop 0
buffer_load_dwordx4 v6, s[8:11], s37 offen lds
s_add_u32 m0, s39, 95232
s_nop 0
buffer_load_dwordx4 v7, s[8:11], s37 offen lds
s_add_u32 m0, s39, 98304
s_nop 0
buffer_load_dwordx4 v8, s[8:11], s37 offen lds
s_add_u32 m0, s39, 101376
s_nop 0
buffer_load_dwordx4 v9, s[8:11], s37 offen lds
s_add_u32 m0, s40, 86016
s_add_u32 s43, s38, 0
buffer_load_dwordx4 v2, s[12:15], s43 offen lds
s_add_u32 m0, s40, 87040
s_add_u32 s43, s38, 49152
buffer_load_dwordx4 v3, s[12:15], s43 offen lds
s_add_u32 m0, s40, 88064
s_add_u32 s43, s38, 98304
buffer_load_dwordx4 v2, s[12:15], s43 offen lds
s_add_u32 m0, s40, 89088
s_add_u32 s43, s38, 147456
buffer_load_dwordx4 v3, s[12:15], s43 offen lds
s_add_u32 m0, s40, 90112
s_add_u32 s43, s38, 196608
buffer_load_dwordx4 v2, s[12:15], s43 offen lds
s_add_u32 m0, s40, 91136
s_add_u32 s43, s38, 245760
buffer_load_dwordx4 v3, s[12:15], s43 offen lds
s_add_u32 m0, s40, 92160
s_add_u32 s43, s38, 294912
buffer_load_dwordx4 v2, s[12:15], s43 offen lds
s_add_u32 m0, s40, 93184
s_add_u32 s43, s38, 344064
buffer_load_dwordx4 v3, s[12:15], s43 offen lds
s_add_u32 s37, s37, 128
s_add_u32 s38, s38, 393216
s_load_dword s3, s[4:5], 192
s_load_dword s3, s[4:5], 7168
s_load_dword s3, s[4:5], 7232
s_load_dword s3, s[4:5], 7296
s_waitcnt vmcnt(14)
s_barrier
s_add_u32 m0, s39, 0
s_mov_b64 exec, s[60:61]
buffer_load_dwordx4 v4, s[8:11], s37 offen lds
s_mov_b64 exec, -1
s_add_u32 m0, s39, 3072
s_nop 0
buffer_load_dwordx4 v5, s[8:11], s37 offen lds
s_add_u32 m0, s39, 6144
s_nop 0
buffer_load_dwordx4 v6, s[8:11], s37 offen lds
s_branch Lov_0
.p2align 12
Lst_0_0:
s_branch Lwr_145
s_nop 0
s_nop 0
Lov_0:
s_add_u32 m0, s39, 9216
s_nop 0
buffer_load_dwordx4 v7, s[8:11], s37 offen lds
s_add_u32 m0, s39, 12288
s_nop 0
buffer_load_dwordx4 v8, s[8:11], s37 offen lds
s_add_u32 m0, s39, 15360
s_nop 0
buffer_load_dwordx4 v9, s[8:11], s37 offen lds
s_add_u32 m0, s40, 0
s_add_u32 s43, s38, 0
buffer_load_dwordx4 v2, s[12:15], s43 offen lds
s_add_u32 m0, s40, 1024
s_add_u32 s43, s38, 49152
buffer_load_dwordx4 v3, s[12:15], s43 offen lds
s_add_u32 m0, s40, 2048
s_add_u32 s43, s38, 98304
buffer_load_dwordx4 v2, s[12:15], s43 offen lds
s_add_u32 m0, s40, 3072
s_add_u32 s43, s38, 147456
buffer_load_dwordx4 v3, s[12:15], s43 offen lds
s_add_u32 m0, s40, 4096
s_add_u32 s43, s38, 196608
buffer_load_dwordx4 v2, s[12:15], s43 offen lds
s_add_u32 m0, s40, 5120
s_add_u32 s43, s38, 245760
buffer_load_dwordx4 v3, s[12:15], s43 offen lds
s_add_u32 m0, s40, 6144
s_add_u32 s43, s38, 294912
buffer_load_dwordx4 v2, s[12:15], s43 offen lds
s_add_u32 m0, s40, 7168
s_add_u32 s43, s38, 344064
buffer_load_dwordx4 v3, s[12:15], s43 offen lds
s_add_u32 s37, s37, 128
s_add_u32 s38, s38, 393216
s_load_dword s3, s[4:5], 7360
s_load_dword s3, s[4:5], 14336
s_load_dword s3, s[4:5], 14400
s_load_dword s3, s[4:5], 14464
s_load_dword s3, s[4:5], 14528
s_waitcnt vmcnt(14)
s_barrier
s_add_u32 m0, s39, 43008
s_mov_b64 exec, s[60:61]
buffer_load_dwordx4 v4, s[8:11], s37 offen lds
s_mov_b64 exec, -1
s_add_u32 m0, s39, 46080
s_nop 0
buffer_load_dwordx4 v5, s[8:11], s37 offen lds
s_add_u32 m0, s39, 49152
s_nop 0
buffer_load_dwordx4 v6, s[8:11], s37 offen lds
s_add_u32 m0, s39, 52224
s_nop 0
buffer_load_dwordx4 v7, s[8:11], s37 offen lds
s_add_u32 m0, s39, 55296
s_nop 0
buffer_load_dwordx4 v8, s[8:11], s37 offen lds
s_add_u32 m0, s39, 58368
s_nop 0
buffer_load_dwordx4 v9, s[8:11], s37 offen lds
s_add_u32 m0, s40, 43008
s_add_u32 s43, s38, 0
buffer_load_dwordx4 v2, s[12:15], s43 offen lds
s_add_u32 m0, s40, 44032
s_add_u32 s43, s38, 49152
buffer_load_dwordx4 v3, s[12:15], s43 offen lds
s_add_u32 m0, s40, 45056
s_add_u32 s43, s38, 98304
buffer_load_dwordx4 v2, s[12:15], s43 offen lds
s_add_u32 m0, s40, 46080
s_add_u32 s43, s38, 147456
buffer_load_dwordx4 v3, s[12:15], s43 offen lds
s_add_u32 m0, s40, 47104
s_add_u32 s43, s38, 196608
buffer_load_dwordx4 v2, s[12:15], s43 offen lds
s_add_u32 m0, s40, 48128
s_add_u32 s43, s38, 245760
buffer_load_dwordx4 v3, s[12:15], s43 offen lds
s_add_u32 m0, s40, 49152
s_add_u32 s43, s38, 294912
buffer_load_dwordx4 v2, s[12:15], s43 offen lds
s_add_u32 m0, s40, 50176
s_add_u32 s43, s38, 344064
buffer_load_dwordx4 v3, s[12:15], s43 offen lds
s_add_u32 s37, s37, 128
s_add_u32 s38, s38, 393216
s_load_dword s3, s[4:5], 21504
s_load_dword s3, s[4:5], 21568
s_load_dword s3, s[4:5], 21632
s_load_dword s3, s[4:5], 21696
s_load_dword s3, s[4:5], 28672
s_load_dword s3, s[4:5], 28736
s_waitcnt vmcnt(14)
s_barrier
s_add_u32 m0, s39, 86016
s_mov_b64 exec, s[60:61]
buffer_load_dwordx4 v4, s[8:11], s37 offen lds
s_mov_b64 exec, -1
s_add_u32 m0, s39, 89088
s_nop 0
buffer_load_dwordx4 v5, s[8:11], s37 offen lds
s_add_u32 m0, s39, 92160
s_nop 0
buffer_load_dwordx4 v6, s[8:11], s37 offen lds
s_add_u32 m0, s39, 95232
s_nop 0
buffer_load_dwordx4 v7, s[8:11], s37 offen lds
s_add_u32 m0, s39, 98304
s_nop 0
buffer_load_dwordx4 v8, s[8:11], s37 offen lds
s_add_u32 m0, s39, 101376
s_nop 0
buffer_load_dwordx4 v9, s[8:11], s37 offen lds
s_add_u32 m0, s40, 86016
s_add_u32 s43, s38, 0
buffer_load_dwordx4 v2, s[12:15], s43 offen lds
s_add_u32 m0, s40, 87040
s_add_u32 s43, s38, 49152
buffer_load_dwordx4 v3, s[12:15], s43 offen lds
s_add_u32 m0, s40, 88064
s_add_u32 s43, s38, 98304
buffer_load_dwordx4 v2, s[12:15], s43 offen lds
s_add_u32 m0, s40, 89088
s_add_u32 s43, s38, 147456
buffer_load_dwordx4 v3, s[12:15], s43 offen lds
s_add_u32 m0, s40, 90112
s_add_u32 s43, s38, 196608
buffer_load_dwordx4 v2, s[12:15], s43 offen lds
s_add_u32 m0, s40, 91136
s_add_u32 s43, s38, 245760
buffer_load_dwordx4 v3, s[12:15], s43 offen lds
s_add_u32 m0, s40, 92160
s_add_u32 s43, s38, 294912
buffer_load_dwordx4 v2, s[12:15], s43 offen lds
s_add_u32 m0, s40, 93184
s_add_u32 s43, s38, 344064
buffer_load_dwordx4 v3, s[12:15], s43 offen lds
s_add_u32 s37, s37, 128
s_add_u32 s38, s38, 393216
s_load_dword s3, s[4:5], 28800
s_load_dword s3, s[4:5], 28864
s_load_dword s3, s[4:5], 35840
s_load_dword s3, s[4:5], 35904
s_load_dword s3, s[4:5], 35968
s_load_dword s3, s[4:5], 36032
s_load_dword s3, s[4:5], 43008
s_waitcnt vmcnt(14)
s_barrier
s_add_u32 m0, s39, 0
s_mov_b64 exec, s[60:61]
buffer_load_dwordx4 v4, s[8:11], s37 offen lds
s_mov_b64 exec, -1
s_add_u32 m0, s39, 3072
s_nop 0
buffer_load_dwordx4 v5, s[8:11], s37 offen lds
s_add_u32 m0, s39, 6144
s_nop 0
buffer_load_dwordx4 v6, s[8:11], s37 offen lds
s_add_u32 m0, s39, 9216
s_nop 0
buffer_load_dwordx4 v7, s[8:11], s37 offen lds
s_add_u32 m0, s39, 12288
s_nop 0
buffer_load_dwordx4 v8, s[8:11], s37 offen lds
s_add_u32 m0, s39, 15360
s_nop 0
buffer_load_dwordx4 v9, s[8:11], s37 offen lds
s_add_u32 m0, s40, 0
s_add_u32 s43, s38, 0
buffer_load_dwordx4 v2, s[12:15], s43 offen lds
s_add_u32 m0, s40, 1024
s_add_u32 s43, s38, 49152
buffer_load_dwordx4 v3, s[12:15], s43 offen lds
s_add_u32 m0, s40, 2048
s_add_u32 s43, s38, 98304
buffer_load_dwordx4 v2, s[12:15], s43 offen lds
s_add_u32 m0, s40, 3072
s_add_u32 s43, s38, 147456
buffer_load_dwordx4 v3, s[12:15], s43 offen lds
s_add_u32 m0, s40, 4096
s_add_u32 s43, s38, 196608
buffer_load_dwordx4 v2, s[12:15], s43 offen lds
s_add_u32 m0, s40, 5120
s_add_u32 s43, s38, 245760
buffer_load_dwordx4 v3, s[12:15], s43 offen lds
s_add_u32 m0, s40, 6144
s_add_u32 s43, s38, 294912
buffer_load_dwordx4 v2, s[12:15], s43 offen lds
s_add_u32 m0, s40, 7168
s_add_u32 s43, s38, 344064
buffer_load_dwordx4 v3, s[12:15], s43 offen lds
s_add_u32 s37, s37, 128
s_add_u32 s38, s38, 393216
s_load_dword s3, s[4:5], 43072
s_load_dword s3, s[4:5], 43136
s_load_dword s3, s[4:5], 43200
s_load_dword s3, s[4:5], 50176
s_load_dword s3, s[4:5], 50240
s_load_dword s3, s[4:5], 50304
s_load_dword s3, s[4:5], 50368
s_load_dword s3, s[4:5], 57344
s_waitcnt vmcnt(14)
s_barrier
s_add_u32 m0, s39, 43008
s_mov_b64 exec, s[60:61]
buffer_load_dwordx4 v4, s[8:11], s37 offen lds
s_mov_b64 exec, -1
s_add_u32 m0, s39, 46080
s_nop 0
buffer_load_dwordx4 v5, s[8:11], s37 offen lds
s_add_u32 m0, s39, 49152
s_nop 0
buffer_load_dwordx4 v6, s[8:11], s37 offen lds
s_add_u32 m0, s39, 52224
s_nop 0
buffer_load_dwordx4 v7, s[8:11], s37 offen lds
s_add_u32 m0, s39, 55296
s_nop 0
buffer_load_dwordx4 v8, s[8:11], s37 offen lds
s_add_u32 m0, s39, 58368
s_nop 0
buffer_load_dwordx4 v9, s[8:11], s37 offen lds
s_add_u32 m0, s40, 43008
s_add_u32 s43, s38, 0
buffer_load_dwordx4 v2, s[12:15], s43 offen lds
s_add_u32 m0, s40, 44032
s_add_u32 s43, s38, 49152
buffer_load_dwordx4 v3, s[12:15], s43 offen lds
s_add_u32 m0, s40, 45056
s_add_u32 s43, s38, 98304
buffer_load_dwordx4 v2, s[12:15], s43 offen lds
s_add_u32 m0, s40, 46080
s_add_u32 s43, s38, 147456
buffer_load_dwordx4 v3, s[12:15], s43 offen lds
s_add_u32 m0, s40, 47104
s_add_u32 s43, s38, 196608
buffer_load_dwordx4 v2, s[12:15], s43 offen lds
s_add_u32 m0, s40, 48128
s_add_u32 s43, s38, 245760
buffer_load_dwordx4 v3, s[12:15], s43 offen lds
s_add_u32 m0, s40, 49152
s_add_u32 s43, s38, 294912
buffer_load_dwordx4 v2, s[12:15], s43 offen lds
s_add_u32 m0, s40, 50176
s_add_u32 s43, s38, 344064
buffer_load_dwordx4 v3, s[12:15], s43 offen lds
s_add_u32 s37, s37, 128
s_add_u32 s38, s38, 393216
s_load_dword s3, s[4:5], 57408
s_load_dword s3, s[4:5], 57472
s_load_dword s3, s[4:5], 57536
s_load_dword s3, s[4:5], 64512
s_load_dword s3, s[4:5], 64576
s_load_dword s3, s[4:5], 64640
s_load_dword s3, s[4:5], 64704
s_load_dword s3, s[4:5], 71680
s_load_dword s3, s[4:5], 71744
s_waitcnt vmcnt(14)
s_barrier
s_add_u32 m0, s39, 86016
s_mov_b64 exec, s[60:61]
buffer_load_dwordx4 v4, s[8:11], s37 offen lds
s_mov_b64 exec, -1
s_add_u32 m0, s39, 89088
s_nop 0
buffer_load_dwordx4 v5, s[8:11], s37 offen lds
s_add_u32 m0, s39, 92160
s_nop 0
buffer_load_dwordx4 v6, s[8:11], s37 offen lds
s_add_u32 m0, s39, 95232
s_nop 0
buffer_load_dwordx4 v7, s[8:11], s37 offen lds
s_add_u32 m0, s39, 98304
s_nop 0
buffer_load_dwordx4 v8, s[8:11], s37 offen lds
s_add_u32 m0, s39, 101376
s_nop 0
buffer_load_dwordx4 v9, s[8:11], s37 offen lds
s_add_u32 m0, s40, 86016
s_add_u32 s43, s38, 0
buffer_load_dwordx4 v2, s[12:15], s43 offen lds
s_add_u32 m0, s40, 87040
s_add_u32 s43, s38, 49152
buffer_load_dwordx4 v3, s[12:15], s43 offen lds
s_add_u32 m0, s40, 88064
s_add_u32 s43, s38, 98304
buffer_load_dwordx4 v2, s[12:15], s43 offen lds
s_add_u32 m0, s40, 89088
s_add_u32 s43, s38, 147456
buffer_load_dwordx4 v3, s[12:15], s43 offen lds
s_add_u32 m0, s40, 90112
s_add_u32 s43, s38, 196608
buffer_load_dwordx4 v2, s[12:15], s43 offen lds
s_add_u32 m0, s40, 91136
s_add_u32 s43, s38, 245760
buffer_load_dwordx4 v3, s[12:15], s43 offen lds
s_add_u32 m0, s40, 92160
s_add_u32 s43, s38, 294912
buffer_load_dwordx4 v2, s[12:15], s43 offen lds
s_add_u32 m0, s40, 93184
s_add_u32 s43, s38, 344064
buffer_load_dwordx4 v3, s[12:15], s43 offen lds
s_add_u32 s37, s37, 128
s_add_u32 s38, s38, 393216
s_load_dword s3, s[4:5], 71808
s_load_dword s3, s[4:5], 71872
s_load_dword s3, s[4:5], 78848
s_load_dword s3, s[4:5], 78912
s_load_dword s3, s[4:5], 78976
s_load_dword s3, s[4:5], 79040
s_load_dword s3, s[4:5], 86016
s_load_dword s3, s[4:5], 86080
s_load_dword s3, s[4:5], 86144
s_waitcnt vmcnt(14)
s_barrier
s_add_u32 m0, s39, 0
s_mov_b64 exec, s[60:61]
buffer_load_dwordx4 v4, s[8:11], s37 offen lds
s_mov_b64 exec, -1
s_add_u32 m0, s39, 3072
s_nop 0
buffer_load_dwordx4 v5, s[8:11], s37 offen lds
s_add_u32 m0, s39, 6144
s_nop 0
buffer_load_dwordx4 v6, s[8:11], s37 offen lds
s_add_u32 m0, s39, 9216
s_nop 0
buffer_load_dwordx4 v7, s[8:11], s37 offen lds
s_add_u32 m0, s39, 12288
s_nop 0
buffer_load_dwordx4 v8, s[8:11], s37 offen lds
s_add_u32 m0, s39, 15360
s_nop 0
buffer_load_dwordx4 v9, s[8:11], s37 offen lds
s_add_u32 m0, s40, 0
s_add_u32 s43, s38, 0
buffer_load_dwordx4 v2, s[12:15], s43 offen lds
s_add_u32 m0, s40, 1024
s_add_u32 s43, s38, 49152
buffer_load_dwordx4 v3, s[12:15], s43 offen lds
s_add_u32 m0, s40, 2048
s_add_u32 s43, s38, 98304
buffer_load_dwordx4 v2, s[12:15], s43 offen lds
s_add_u32 m0, s40, 3072
s_add_u32 s43, s38, 147456
buffer_load_dwordx4 v3, s[12:15], s43 offen lds
s_add_u32 m0, s40, 4096
s_add_u32 s43, s38, 196608
buffer_load_dwordx4 v2, s[12:15], s43 offen lds
s_add_u32 m0, s40, 5120
s_add_u32 s43, s38, 245760
buffer_load_dwordx4 v3, s[12:15], s43 offen lds
s_add_u32 m0, s40, 6144
s_add_u32 s43, s38, 294912
buffer_load_dwordx4 v2, s[12:15], s43 offen lds
s_add_u32 m0, s40, 7168
s_add_u32 s43, s38, 344064
buffer_load_dwordx4 v3, s[12:15], s43 offen lds
s_add_u32 s37, s37, 128
s_add_u32 s38, s38, 393216
s_load_dword s3, s[4:5], 86208
s_load_dword s3, s[4:5], 93184
s_load_dword s3, s[4:5], 93248
s_load_dword s3, s[4:5], 93312
s_load_dword s3, s[4:5], 93376
s_load_dword s3, s[4:5], 100352
s_load_dword s3, s[4:5], 100416
s_load_dword s3, s[4:5], 100480
s_load_dword s3, s[4:5], 100544
s_waitcnt vmcnt(14)
s_barrier
s_add_u32 m0, s39, 43008
s_mov_b64 exec, s[60:61]
buffer_load_dwordx4 v4, s[8:11], s37 offen lds
s_mov_b64 exec, -1
s_add_u32 m0, s39, 46080
s_nop 0
buffer_load_dwordx4 v5, s[8:11], s37 offen lds
s_add_u32 m0, s39, 49152
s_nop 0
buffer_load_dwordx4 v6, s[8:11], s37 offen lds
s_add_u32 m0, s39, 52224
s_nop 0
buffer_load_dwordx4 v7, s[8:11], s37 offen lds
s_add_u32 m0, s39, 55296
s_nop 0
buffer_load_dwordx4 v8, s[8:11], s37 offen lds
s_add_u32 m0, s39, 58368
s_nop 0
buffer_load_dwordx4 v9, s[8:11], s37 offen lds
s_add_u32 m0, s40, 43008
s_add_u32 s43, s38, 0
buffer_load_dwordx4 v2, s[12:15], s43 offen lds
s_add_u32 m0, s40, 44032
s_add_u32 s43, s38, 49152
buffer_load_dwordx4 v3, s[12:15], s43 offen lds
s_add_u32 m0, s40, 45056
s_add_u32 s43, s38, 98304
buffer_load_dwordx4 v2, s[12:15], s43 offen lds
s_add_u32 m0, s40, 46080
s_add_u32 s43, s38, 147456
buffer_load_dwordx4 v3, s[12:15], s43 offen lds
s_add_u32 m0, s40, 47104
s_add_u32 s43, s38, 196608
buffer_load_dwordx4 v2, s[12:15], s43 offen lds
s_add_u32 m0, s40, 48128
s_add_u32 s43, s38, 245760
buffer_load_dwordx4 v3, s[12:15], s43 offen lds
s_add_u32 m0, s40, 49152
s_add_u32 s43, s38, 294912
buffer_load_dwordx4 v2, s[12:15], s43 offen lds
s_add_u32 m0, s40, 50176
s_add_u32 s43, s38, 344064
buffer_load_dwordx4 v3, s[12:15], s43 offen lds
s_add_u32 s37, s37, 128
s_add_u32 s38, s38, 393216
s_load_dword s3, s[4:5], 107520
s_load_dword s3, s[4:5], 107584
s_load_dword s3, s[4:5], 107648
s_load_dword s3, s[4:5], 107712
s_load_dword s3, s[4:5], 114688
s_load_dword s3, s[4:5], 114752
s_load_dword s3, s[4:5], 114816
s_load_dword s3, s[4:5], 114880
s_load_dword s3, s[4:5], 121856
s_waitcnt vmcnt(14)
s_barrier
s_add_u32 m0, s39, 86016
s_mov_b64 exec, s[60:61]
buffer_load_dwordx4 v4, s[8:11], s37 offen lds
s_mov_b64 exec, -1
s_add_u32 m0, s39, 89088
s_nop 0
buffer_load_dwordx4 v5, s[8:11], s37 offen lds
s_add_u32 m0, s39, 92160
s_nop 0
buffer_load_dwordx4 v6, s[8:11], s37 offen lds
s_add_u32 m0, s39, 95232
s_nop 0
buffer_load_dwordx4 v7, s[8:11], s37 offen lds
s_add_u32 m0, s39, 98304
s_nop 0
buffer_load_dwordx4 v8, s[8:11], s37 offen lds
s_add_u32 m0, s39, 101376
s_nop 0
buffer_load_dwordx4 v9, s[8:11], s37 offen lds
s_add_u32 m0, s40, 86016
s_add_u32 s43, s38, 0
buffer_load_dwordx4 v2, s[12:15], s43 offen lds
s_add_u32 m0, s40, 87040
s_add_u32 s43, s38, 49152
buffer_load_dwordx4 v3, s[12:15], s43 offen lds
s_add_u32 m0, s40, 88064
s_add_u32 s43, s38, 98304
buffer_load_dwordx4 v2, s[12:15], s43 offen lds
s_add_u32 m0, s40, 89088
s_add_u32 s43, s38, 147456
buffer_load_dwordx4 v3, s[12:15], s43 offen lds
s_add_u32 m0, s40, 90112
s_add_u32 s43, s38, 196608
buffer_load_dwordx4 v2, s[12:15], s43 offen lds
s_add_u32 m0, s40, 91136
s_add_u32 s43, s38, 245760
buffer_load_dwordx4 v3, s[12:15], s43 offen lds
s_add_u32 m0, s40, 92160
s_add_u32 s43, s38, 294912
buffer_load_dwordx4 v2, s[12:15], s43 offen lds
s_add_u32 m0, s40, 93184
s_add_u32 s43, s38, 344064
buffer_load_dwordx4 v3, s[12:15], s43 offen lds
s_add_u32 s37, s37, 128
s_add_u32 s38, s38, 393216
s_load_dword s3, s[4:5], 121920
s_load_dword s3, s[4:5], 121984
s_load_dword s3, s[4:5], 122048
s_load_dword s3, s[4:5], 129024
s_load_dword s3, s[4:5], 129088
s_load_dword s3, s[4:5], 129152
s_load_dword s3, s[4:5], 129216
s_load_dword s3, s[4:5], 136192
s_load_dword s3, s[4:5], 136256
s_waitcnt vmcnt(14)
s_barrier
s_add_u32 m0, s39, 0
s_mov_b64 exec, s[60:61]
buffer_load_dwordx4 v4, s[8:11], s37 offen lds
s_mov_b64 exec, -1
s_add_u32 m0, s39, 3072
s_nop 0
buffer_load_dwordx4 v5, s[8:11], s37 offen lds
s_add_u32 m0, s39, 6144
s_nop 0
buffer_load_dwordx4 v6, s[8:11], s37 offen lds
s_add_u32 m0, s39, 9216
s_nop 0
buffer_load_dwordx4 v7, s[8:11], s37 offen lds
s_add_u32 m0, s39, 12288
s_nop 0
buffer_load_dwordx4 v8, s[8:11], s37 offen lds
s_add_u32 m0, s39, 15360
s_nop 0
buffer_load_dwordx4 v9, s[8:11], s37 offen lds
s_add_u32 m0, s40, 0
s_add_u32 s43, s38, 0
buffer_load_dwordx4 v2, s[12:15], s43 offen lds
s_add_u32 m0, s40, 1024
s_add_u32 s43, s38, 49152
buffer_load_dwordx4 v3, s[12:15], s43 offen lds
s_add_u32 m0, s40, 2048
s_add_u32 s43, s38, 98304
buffer_load_dwordx4 v2, s[12:15], s43 offen lds
s_add_u32 m0, s40, 3072
s_add_u32 s43, s38, 147456
buffer_load_dwordx4 v3, s[12:15], s43 offen lds
s_add_u32 m0, s40, 4096
s_add_u32 s43, s38, 196608
buffer_load_dwordx4 v2, s[12:15], s43 offen lds
s_add_u32 m0, s40, 5120
s_add_u32 s43, s38, 245760
buffer_load_dwordx4 v3, s[12:15], s43 offen lds
s_add_u32 m0, s40, 6144
s_add_u32 s43, s38, 294912
buffer_load_dwordx4 v2, s[12:15], s43 offen lds
s_add_u32 m0, s40, 7168
s_add_u32 s43, s38, 344064
buffer_load_dwordx4 v3, s[12:15], s43 offen lds
s_add_u32 s37, s37, 128
s_add_u32 s38, s38, 393216
s_load_dword s3, s[4:5], 136320
s_load_dword s3, s[4:5], 136384
s_load_dword s3, s[4:5], 143360
s_load_dword s3, s[4:5], 143424
s_load_dword s3, s[4:5], 143488
s_load_dword s3, s[4:5], 143552
s_load_dword s3, s[4:5], 150528
s_load_dword s3, s[4:5], 150592
s_load_dword s3, s[4:5], 150656
s_waitcnt vmcnt(14)
s_barrier
s_load_dword s3, s[4:5], 150720
s_load_dword s3, s[4:5], 157696
s_load_dword s3, s[4:5], 157760
s_load_dword s3, s[4:5], 157824
s_load_dword s3, s[4:5], 157888
s_load_dword s3, s[4:5], 164864
s_load_dword s3, s[4:5], 164928
s_load_dword s3, s[4:5], 164992
s_load_dword s3, s[4:5], 165056
s_waitcnt vmcnt(0)
s_barrier
s_bitcmp0_b32 s2, 0
s_cselect_b32 s88, s72, s74
s_cselect_b32 s89, s73, s75
s_cmp_lt_u32 s2, 192
s_cselect_b32 s90, 7340032, 0
s_mov_b32 s91, 0x20000
s_bfe_u32 s44, s2, 0x30001
s_lshl_b32 s44, s44, 2
s_and_b32 s43, s36, 3
s_add_u32 s44, s44, s43
s_lshl_b32 s44, s44, 5
v_lshrrev_b32 v18, 4, v1
v_add_u32 v18, s44, v18
v_mul_u32_u24 v18, 7168, v18
v_and_b32 v19, 15, v1
v_lshl_add_u32 v18, v19, 4, v18
s_lshr_b32 s43, s2, 4
s_branch Lov_1
.p2align 12
Lst_1_0:
s_branch Lwr_146
s_nop 0
s_nop 0
Lov_1:
s_lshl_b32 s43, s43, 8
s_add_u32 s43, s43, 4096
v_add_u32 v18, s43, v18
s_mov_b32 s43, 0
buffer_load_dwordx4 v[128:131], v18, s[88:91], s43 offen
s_mov_b32 s43, 28672
buffer_load_dwordx4 v[132:135], v18, s[88:91], s43 offen
s_mov_b32 s43, 57344
buffer_load_dwordx4 v[136:139], v18, s[88:91], s43 offen
s_mov_b32 s43, 86016
buffer_load_dwordx4 v[140:143], v18, s[88:91], s43 offen
s_mov_b32 s43, 114688
buffer_load_dwordx4 v[144:147], v18, s[88:91], s43 offen
s_mov_b32 s43, 143360
buffer_load_dwordx4 v[148:151], v18, s[88:91], s43 offen
s_mov_b32 s43, 172032
buffer_load_dwordx4 v[152:155], v18, s[88:91], s43 offen
s_mov_b32 s43, 200704
buffer_load_dwordx4 v[156:159], v18, s[88:91], s43 offen
s_barrier
s_lshl_b32 s43, s35, 7
s_add_u32 s28, s68, s43
s_addc_u32 s29, s69, 0
s_mov_b32 s30, 2095232
s_mov_b32 s31, 0x20000
v_lshrrev_b32 v15, 3, v1
v_and_b32 v16, 6, v15
v_and_b32 v7, 7, v1
v_xor_b32 v7, v7, v16
v_lshlrev_b32 v7, 4, v7
v_mul_u32_u24 v15, 2048, v15
v_add_u32 v7, v7, v15
s_and_b32 s40, s36, 3
s_lshl_b32 s39, s40, 13
s_add_u32 s40, s40, s35
s_add_u32 s42, s40, 0
s_and_b32 s42, s42, 15
s_lshl_b32 s42, s42, 17
s_add_u32 m0, s39, 65536
s_add_u32 s43, s42, 0
buffer_load_dwordx4 v7, s[28:31], s43 offen lds
s_add_u32 m0, s39, 66560
s_add_u32 s43, s42, 16384
buffer_load_dwordx4 v7, s[28:31], s43 offen lds
s_add_u32 m0, s39, 67584
s_add_u32 s43, s42, 32768
buffer_load_dwordx4 v7, s[28:31], s43 offen lds
s_add_u32 m0, s39, 68608
s_add_u32 s43, s42, 49152
buffer_load_dwordx4 v7, s[28:31], s43 offen lds
s_add_u32 m0, s39, 69632
s_add_u32 s43, s42, 65536
buffer_load_dwordx4 v7, s[28:31], s43 offen lds
s_add_u32 m0, s39, 70656
s_add_u32 s43, s42, 81920
buffer_load_dwordx4 v7, s[28:31], s43 offen lds
s_add_u32 m0, s39, 71680
s_add_u32 s43, s42, 98304
buffer_load_dwordx4 v7, s[28:31], s43 offen lds
s_add_u32 m0, s39, 72704
s_add_u32 s43, s42, 114688
buffer_load_dwordx4 v7, s[28:31], s43 offen lds
s_branch Lats_6
Lcons_7:
s_lshl_b32 s43, s35, 7
s_waitcnt lgkmcnt(0)
s_mov_b32 s8, s64
s_mov_b32 s9, s65
s_mov_b32 s10, 4194304
s_mov_b32 s11, 0x20000
s_add_u32 s12, s66, s43
s_addc_u32 s13, s67, 0
s_mov_b32 s14, 6289536
s_mov_b32 s15, 0x20000
s_lshr_b32 s43, s2, 3
s_lshl_b32 s43, s43, 2
s_add_u32 s43, s43, s36
s_sub_u32 s44, s43, 0
s_and_b32 s44, s44, 127
s_cmp_lt_u32 s44, 24
s_cbranch_scc0 Lt_8
s_lshl_b32 s44, s44, 20
s_min_u32 s44, s44, 24117184
s_load_dword s3, s[82:83], s44 glc
Lt_8:
s_sub_u32 s44, s43, 24
s_and_b32 s44, s44, 127
s_cmp_lt_u32 s44, 8
s_cbranch_scc0 Lt_9
s_lshl_b32 s44, s44, 20
s_min_u32 s44, s44, 7339968
s_load_dword s3, s[72:73], s44
Lt_9:
s_sub_u32 s44, s43, 32
s_and_b32 s44, s44, 127
s_cmp_lt_u32 s44, 8
s_cbranch_scc0 Lt_10
s_lshl_b32 s44, s44, 20
s_min_u32 s44, s44, 7339968
s_load_dword s3, s[74:75], s44
Lt_10:
s_sub_u32 s44, s43, 40
s_and_b32 s44, s44, 127
s_cmp_lt_u32 s44, 3
s_cbranch_scc0 Lt_11
s_lshl_b32 s44, s44, 20
s_min_u32 s44, s44, 2097088
s_load_dword s3, s[68:69], s44
Lt_11:
s_sub_u32 s44, s43, 43
s_and_b32 s44, s44, 127
s_cmp_lt_u32 s44, 5
s_cbranch_scc0 Lt_12
s_lshl_b32 s44, s44, 20
s_min_u32 s44, s44, 4194240
s_add_u32 s44, s44, 25165824
s_load_dword s3, s[82:83], s44 glc
Lt_12:
s_sub_u32 s44, s43, 48
s_and_b32 s44, s44, 127
s_cmp_lt_u32 s44, 8
s_cbranch_scc0 Lt_13
s_lshl_b32 s44, s44, 20
s_min_u32 s44, s44, 7339968
s_load_dword s3, s[76:77], s44
Lt_13:
s_sub_u32 s44, s43, 56
s_and_b32 s44, s44, 127
s_cmp_lt_u32 s44, 5
s_cbranch_scc0 Lt_14
s_lshl_b32 s44, s44, 20
s_min_u32 s44, s44, 4194240
s_add_u32 s44, s44, 33554432
s_load_dword s3, s[82:83], s44 glc
Lt_14:
s_sub_u32 s44, s43, 61
s_and_b32 s44, s44, 127
s_cmp_lt_u32 s44, 5
s_cbranch_scc0 Lt_15
s_lshl_b32 s44, s44, 20
s_min_u32 s44, s44, 4194240
s_load_dword s3, s[78:79], s44 glc
Lt_15:
v_lshrrev_b32 v16, 1, v12
v_xor_b32 v15, v13, v16
v_lshlrev_b32 v15, 4, v15
v_lshl_add_u32 v2, v12, 7, v15
v_xor_b32 v3, 64, v2
v_add_u32 v4, 86016, v2
v_add_u32 v5, 86016, v3
v_lshrrev_b32 v15, 2, v12
v_and_b32 v16, 3, v1
v_lshl_add_u32 v19, v13, 3, v15
v_lshlrev_b32 v19, 7, v19
v_and_b32 v15, 2, v15
v_and_b32 v17, 1, v13
v_lshl_add_u32 v15, v17, 2, v15
v_lshrrev_b32 v17, 1, v16
s_lshl_b32 s43, s36, 1
v_add_u32 v17, s43, v17
v_xor_b32 v15, v15, v17
v_lshl_add_u32 v19, v15, 4, v19
v_and_b32 v16, 1, v16
v_lshl_add_u32 v19, v16, 3, v19
v_add_u32 v6, 18432, v19
v_add_u32 v7, 61440, v19
v_add_u32 v8, 104448, v19
s_and_b32 s43, s36, 1
s_bfe_u32 s44, s36, 0x10001
s_lshr_b32 s45, s36, 2
v_lshlrev_b32 v14, 2, v13
v_sub_u32 v14, v12, v14
v_mov_b32 v16, 0xff800000
s_or_b32 s46, s34, s45
s_cmp_lg_u32 s46, 0
s_cselect_b32 s46, 0, 0xff800000
v_subrev_u32 v15, 0, v14
v_cmp_ge_u32 vcc, 7, v15
v_add_u32 v15, 16, v15
s_nop 0
v_cndmask_b32 v248, v16, 0, vcc
v_cmp_ge_u32 vcc, 7, v15
s_nop 1
v_cndmask_b32 v244, v16, 0, vcc
v_or_b32 v240, s46, v244
v_subrev_u32 v15, 1, v14
v_cmp_ge_u32 vcc, 7, v15
v_add_u32 v15, 16, v15
s_nop 0
v_cndmask_b32 v249, v16, 0, vcc
v_cmp_ge_u32 vcc, 7, v15
s_nop 1
v_cndmask_b32 v245, v16, 0, vcc
v_or_b32 v241, s46, v245
v_subrev_u32 v15, 2, v14
v_cmp_ge_u32 vcc, 7, v15
v_add_u32 v15, 16, v15
s_nop 0
v_cndmask_b32 v250, v16, 0, vcc
v_cmp_ge_u32 vcc, 7, v15
s_nop 1
v_cndmask_b32 v246, v16, 0, vcc
v_or_b32 v242, s46, v246
v_subrev_u32 v15, 3, v14
v_cmp_ge_u32 vcc, 7, v15
v_add_u32 v15, 16, v15
s_nop 0
v_cndmask_b32 v251, v16, 0, vcc
v_cmp_ge_u32 vcc, 7, v15
s_nop 1
v_cndmask_b32 v247, v16, 0, vcc
v_or_b32 v243, s46, v247
s_lshl_b32 s46, s45, 6
s_add_u32 s46, s46, s44
s_add_u32 s46, s46, 16
v_lshl_add_u32 v14, v12, 1, s46
s_lshl_b32 s47, s43, 6
v_lshl_add_u32 v15, v13, 4, s47
v_mul_u32_u24 v20, 400, v14
v_add_u32 v20, v20, v15
v_subrev_u32 v16, 32, v14
v_max_i32 v16, 0, v16
v_mul_u32_u24 v21, 400, v16
v_add_u32 v21, v21, v15
v_lshrrev_b32 v16, 2, v12
v_lshl_add_u32 v16, v13, 2, v16
v_lshl_add_u32 v16, v16, 1, s46
v_and_b32 v17, 3, v1
v_lshl_add_u32 v17, v17, 3, s47
v_mul_u32_u24 v22, 400, v16
v_add_u32 v22, v22, v17
v_subrev_u32 v16, 32, v16
v_max_i32 v16, 0, v16
v_mul_u32_u24 v23, 400, v16
v_add_u32 v23, v23, v17
s_mul_i32 s60, s34, 262144
s_add_u32 s16, s82, s60
s_addc_u32 s17, s83, 0
s_mov_b32 s18, 262144
s_mov_b32 s19, 0x20000
s_lshl_b32 s60, s35, 14
s_lshl_b32 s43, s43, 13
s_add_u32 s60, s60, s43
s_lshl_b32 s43, s45, 12
s_add_u32 s60, s60, s43
s_lshl_b32 s43, s44, 10
s_add_u32 s60, s60, s43
v_lshlrev_b32 v24, 4, v1
s_mov_b32 s61, 0x3e8293ee
s_lshl_b32 s38, s35, 7
s_add_u32 s56, s82, 28311552
s_addc_u32 s57, s83, 0
s_mov_b32 s58, 114688
s_mov_b32 s59, 0x20000
s_barrier
ds_read_b128 v[32:35], v2 offset:0
ds_read_b64_tr_b16 v[72:73], v6 offset:8192
ds_read_b64_tr_b16 v[74:75], v6 offset:8704
ds_read_b64_tr_b16 v[76:77], v6 offset:16384
ds_read_b64_tr_b16 v[78:79], v6 offset:16896
ds_read_b64_tr_b16 v[68:69], v6 offset:0
ds_read_b64_tr_b16 v[70:71], v6 offset:512
ds_read_b128 v[36:39], v2 offset:2048
ds_read_b128 v[40:43], v2 offset:4096
ds_read_b128 v[44:47], v2 offset:6144
ds_read_b128 v[48:51], v2 offset:8192
ds_read_b128 v[52:55], v2 offset:10240
ds_read_b128 v[56:59], v2 offset:12288
ds_read_b128 v[60:63], v2 offset:14336
ds_read_b128 v[64:67], v2 offset:16384
s_waitcnt lgkmcnt(0)
v_mfma_f32_16x16x32_bf16 v[164:167], v[72:75], v[32:35], 0
ds_read_b128 v[80:83], v3 offset:0
v_mfma_f32_16x16x32_bf16 v[200:203], v[76:79], v[32:35], 0
ds_read_b64_tr_b16 v[120:121], v6 offset:12288
v_mfma_f32_16x16x32_bf16 v[128:131], v[68:71], v[32:35], 0
ds_read_b64_tr_b16 v[122:123], v6 offset:12800
v_mfma_f32_16x16x32_bf16 v[132:135], v[68:71], v[36:39], 0
ds_read_b64_tr_b16 v[124:125], v6 offset:20480
v_mfma_f32_16x16x32_bf16 v[204:207], v[76:79], v[36:39], 0
ds_read_b64_tr_b16 v[126:127], v6 offset:20992
v_mfma_f32_16x16x32_bf16 v[168:171], v[72:75], v[36:39], 0
ds_read_b64_tr_b16 v[116:117], v6 offset:4096
v_mfma_f32_16x16x32_bf16 v[172:175], v[72:75], v[40:43], 0
ds_read_b64_tr_b16 v[118:119], v6 offset:4608
v_mfma_f32_16x16x32_bf16 v[208:211], v[76:79], v[40:43], 0
ds_read_b128 v[84:87], v3 offset:2048
v_mfma_f32_16x16x32_bf16 v[136:139], v[68:71], v[40:43], 0
ds_read_b128 v[88:91], v3 offset:4096
v_mfma_f32_16x16x32_bf16 v[140:143], v[68:71], v[44:47], 0
ds_read_b128 v[92:95], v3 offset:6144
v_mfma_f32_16x16x32_bf16 v[212:215], v[76:79], v[44:47], 0
ds_read_b128 v[96:99], v3 offset:8192
v_mfma_f32_16x16x32_bf16 v[176:179], v[72:75], v[44:47], 0
ds_read_b128 v[100:103], v3 offset:10240
v_mfma_f32_16x16x32_bf16 v[180:183], v[72:75], v[48:51], 0
ds_read_b128 v[104:107], v3 offset:12288
v_mfma_f32_16x16x32_bf16 v[216:219], v[76:79], v[48:51], 0
ds_read_b128 v[108:111], v3 offset:14336
v_mfma_f32_16x16x32_bf16 v[144:147], v[68:71], v[48:51], 0
ds_read_b128 v[112:115], v3 offset:16384
v_mfma_f32_16x16x32_bf16 v[148:151], v[68:71], v[52:55], 0
v_mfma_f32_16x16x32_bf16 v[220:223], v[76:79], v[52:55], 0
v_mfma_f32_16x16x32_bf16 v[184:187], v[72:75], v[52:55], 0
v_mfma_f32_16x16x32_bf16 v[188:191], v[72:75], v[56:59], 0
v_mfma_f32_16x16x32_bf16 v[224:227], v[76:79], v[56:59], 0
v_mfma_f32_16x16x32_bf16 v[152:155], v[68:71], v[56:59], 0
v_mfma_f32_16x16x32_bf16 v[156:159], v[68:71], v[60:63], 0
v_mfma_f32_16x16x32_bf16 v[228:231], v[76:79], v[60:63], 0
v_mfma_f32_16x16x32_bf16 v[192:195], v[72:75], v[60:63], 0
v_mfma_f32_16x16x32_bf16 v[196:199], v[72:75], v[64:67], 0
v_mfma_f32_16x16x32_bf16 v[232:235], v[76:79], v[64:67], 0
v_mfma_f32_16x16x32_bf16 v[160:163], v[68:71], v[64:67], 0
s_waitcnt lgkmcnt(0)
s_barrier
v_mfma_f32_16x16x32_bf16 v[164:167], v[120:123], v[80:83], v[164:167]
ds_read_b128 v[32:35], v2 offset:43008
v_mfma_f32_16x16x32_bf16 v[200:203], v[124:127], v[80:83], v[200:203]
ds_read_b64_tr_b16 v[72:73], v7 offset:8192
v_mfma_f32_16x16x32_bf16 v[128:131], v[116:119], v[80:83], v[128:131]
ds_read_b64_tr_b16 v[74:75], v7 offset:8704
v_mfma_f32_16x16x32_bf16 v[132:135], v[116:119], v[84:87], v[132:135]
ds_read_b64_tr_b16 v[76:77], v7 offset:16384
v_mfma_f32_16x16x32_bf16 v[204:207], v[124:127], v[84:87], v[204:207]
ds_read_b64_tr_b16 v[78:79], v7 offset:16896
v_mfma_f32_16x16x32_bf16 v[168:171], v[120:123], v[84:87], v[168:171]
ds_read_b64_tr_b16 v[68:69], v7 offset:0
v_mfma_f32_16x16x32_bf16 v[172:175], v[120:123], v[88:91], v[172:175]
ds_read_b64_tr_b16 v[70:71], v7 offset:512
v_mfma_f32_16x16x32_bf16 v[208:211], v[124:127], v[88:91], v[208:211]
ds_read_b128 v[36:39], v2 offset:45056
v_mfma_f32_16x16x32_bf16 v[136:139], v[116:119], v[88:91], v[136:139]
ds_read_b128 v[40:43], v2 offset:47104
v_mfma_f32_16x16x32_bf16 v[140:143], v[116:119], v[92:95], v[140:143]
ds_read_b128 v[44:47], v2 offset:49152
v_mfma_f32_16x16x32_bf16 v[212:215], v[124:127], v[92:95], v[212:215]
ds_read_b128 v[48:51], v2 offset:51200
v_mfma_f32_16x16x32_bf16 v[176:179], v[120:123], v[92:95], v[176:179]
ds_read_b128 v[52:55], v2 offset:53248
v_mfma_f32_16x16x32_bf16 v[180:183], v[120:123], v[96:99], v[180:183]
ds_read_b128 v[56:59], v2 offset:55296
v_mfma_f32_16x16x32_bf16 v[216:219], v[124:127], v[96:99], v[216:219]
ds_read_b128 v[60:63], v2 offset:57344
v_mfma_f32_16x16x32_bf16 v[144:147], v[116:119], v[96:99], v[144:147]
ds_read_b128 v[64:67], v2 offset:59392
v_mfma_f32_16x16x32_bf16 v[148:151], v[116:119], v[100:103], v[148:151]
v_mfma_f32_16x16x32_bf16 v[220:223], v[124:127], v[100:103], v[220:223]
v_mfma_f32_16x16x32_bf16 v[184:187], v[120:123], v[100:103], v[184:187]
v_mfma_f32_16x16x32_bf16 v[188:191], v[120:123], v[104:107], v[188:191]
v_mfma_f32_16x16x32_bf16 v[224:227], v[124:127], v[104:107], v[224:227]
v_mfma_f32_16x16x32_bf16 v[152:155], v[116:119], v[104:107], v[152:155]
v_mfma_f32_16x16x32_bf16 v[156:159], v[116:119], v[108:111], v[156:159]
v_mfma_f32_16x16x32_bf16 v[228:231], v[124:127], v[108:111], v[228:231]
v_mfma_f32_16x16x32_bf16 v[192:195], v[120:123], v[108:111], v[192:195]
v_mfma_f32_16x16x32_bf16 v[196:199], v[120:123], v[112:115], v[196:199]
v_mfma_f32_16x16x32_bf16 v[232:235], v[124:127], v[112:115], v[232:235]
v_mfma_f32_16x16x32_bf16 v[160:163], v[116:119], v[112:115], v[160:163]
s_waitcnt lgkmcnt(0)
v_mfma_f32_16x16x32_bf16 v[164:167], v[72:75], v[32:35], v[164:167]
ds_read_b128 v[80:83], v3 offset:43008
v_mfma_f32_16x16x32_bf16 v[200:203], v[76:79], v[32:35], v[200:203]
ds_read_b64_tr_b16 v[120:121], v7 offset:12288
v_mfma_f32_16x16x32_bf16 v[128:131], v[68:71], v[32:35], v[128:131]
ds_read_b64_tr_b16 v[122:123], v7 offset:12800
v_mfma_f32_16x16x32_bf16 v[132:135], v[68:71], v[36:39], v[132:135]
ds_read_b64_tr_b16 v[124:125], v7 offset:20480
v_mfma_f32_16x16x32_bf16 v[204:207], v[76:79], v[36:39], v[204:207]
ds_read_b64_tr_b16 v[126:127], v7 offset:20992
v_mfma_f32_16x16x32_bf16 v[168:171], v[72:75], v[36:39], v[168:171]
ds_read_b64_tr_b16 v[116:117], v7 offset:4096
v_mfma_f32_16x16x32_bf16 v[172:175], v[72:75], v[40:43], v[172:175]
ds_read_b64_tr_b16 v[118:119], v7 offset:4608
v_mfma_f32_16x16x32_bf16 v[208:211], v[76:79], v[40:43], v[208:211]
ds_read_b128 v[84:87], v3 offset:45056
v_mfma_f32_16x16x32_bf16 v[136:139], v[68:71], v[40:43], v[136:139]
ds_read_b128 v[88:91], v3 offset:47104
v_mfma_f32_16x16x32_bf16 v[140:143], v[68:71], v[44:47], v[140:143]
ds_read_b128 v[92:95], v3 offset:49152
v_mfma_f32_16x16x32_bf16 v[212:215], v[76:79], v[44:47], v[212:215]
ds_read_b128 v[96:99], v3 offset:51200
v_mfma_f32_16x16x32_bf16 v[176:179], v[72:75], v[44:47], v[176:179]
ds_read_b128 v[100:103], v3 offset:53248
v_mfma_f32_16x16x32_bf16 v[180:183], v[72:75], v[48:51], v[180:183]
ds_read_b128 v[104:107], v3 offset:55296
v_mfma_f32_16x16x32_bf16 v[216:219], v[76:79], v[48:51], v[216:219]
ds_read_b128 v[108:111], v3 offset:57344
v_mfma_f32_16x16x32_bf16 v[144:147], v[68:71], v[48:51], v[144:147]
ds_read_b128 v[112:115], v3 offset:59392
v_mfma_f32_16x16x32_bf16 v[148:151], v[68:71], v[52:55], v[148:151]
v_mfma_f32_16x16x32_bf16 v[220:223], v[76:79], v[52:55], v[220:223]
v_mfma_f32_16x16x32_bf16 v[184:187], v[72:75], v[52:55], v[184:187]
v_mfma_f32_16x16x32_bf16 v[188:191], v[72:75], v[56:59], v[188:191]
v_mfma_f32_16x16x32_bf16 v[224:227], v[76:79], v[56:59], v[224:227]
v_mfma_f32_16x16x32_bf16 v[152:155], v[68:71], v[56:59], v[152:155]
v_mfma_f32_16x16x32_bf16 v[156:159], v[68:71], v[60:63], v[156:159]
v_mfma_f32_16x16x32_bf16 v[228:231], v[76:79], v[60:63], v[228:231]
v_mfma_f32_16x16x32_bf16 v[192:195], v[72:75], v[60:63], v[192:195]
v_mfma_f32_16x16x32_bf16 v[196:199], v[72:75], v[64:67], v[196:199]
v_mfma_f32_16x16x32_bf16 v[232:235], v[76:79], v[64:67], v[232:235]
v_mfma_f32_16x16x32_bf16 v[160:163], v[68:71], v[64:67], v[160:163]
s_waitcnt lgkmcnt(0)
s_barrier
v_mfma_f32_16x16x32_bf16 v[164:167], v[120:123], v[80:83], v[164:167]
ds_read_b128 v[32:35], v4 offset:0
v_mfma_f32_16x16x32_bf16 v[200:203], v[124:127], v[80:83], v[200:203]
ds_read_b64_tr_b16 v[72:73], v8 offset:8192
v_mfma_f32_16x16x32_bf16 v[128:131], v[116:119], v[80:83], v[128:131]
ds_read_b64_tr_b16 v[74:75], v8 offset:8704
v_mfma_f32_16x16x32_bf16 v[132:135], v[116:119], v[84:87], v[132:135]
ds_read_b64_tr_b16 v[76:77], v8 offset:16384
v_mfma_f32_16x16x32_bf16 v[204:207], v[124:127], v[84:87], v[204:207]
ds_read_b64_tr_b16 v[78:79], v8 offset:16896
v_mfma_f32_16x16x32_bf16 v[168:171], v[120:123], v[84:87], v[168:171]
ds_read_b64_tr_b16 v[68:69], v8 offset:0
v_mfma_f32_16x16x32_bf16 v[172:175], v[120:123], v[88:91], v[172:175]
ds_read_b64_tr_b16 v[70:71], v8 offset:512
v_mfma_f32_16x16x32_bf16 v[208:211], v[124:127], v[88:91], v[208:211]
ds_read_b128 v[36:39], v4 offset:2048
v_mfma_f32_16x16x32_bf16 v[136:139], v[116:119], v[88:91], v[136:139]
ds_read_b128 v[40:43], v4 offset:4096
v_mfma_f32_16x16x32_bf16 v[140:143], v[116:119], v[92:95], v[140:143]
ds_read_b128 v[44:47], v4 offset:6144
v_mfma_f32_16x16x32_bf16 v[212:215], v[124:127], v[92:95], v[212:215]
ds_read_b128 v[48:51], v4 offset:8192
v_mfma_f32_16x16x32_bf16 v[176:179], v[120:123], v[92:95], v[176:179]
ds_read_b128 v[52:55], v4 offset:10240
v_mfma_f32_16x16x32_bf16 v[180:183], v[120:123], v[96:99], v[180:183]
ds_read_b128 v[56:59], v4 offset:12288
v_mfma_f32_16x16x32_bf16 v[216:219], v[124:127], v[96:99], v[216:219]
ds_read_b128 v[60:63], v4 offset:14336
v_mfma_f32_16x16x32_bf16 v[144:147], v[116:119], v[96:99], v[144:147]
ds_read_b128 v[64:67], v4 offset:16384
v_mfma_f32_16x16x32_bf16 v[148:151], v[116:119], v[100:103], v[148:151]
v_mfma_f32_16x16x32_bf16 v[220:223], v[124:127], v[100:103], v[220:223]
v_mfma_f32_16x16x32_bf16 v[184:187], v[120:123], v[100:103], v[184:187]
v_mfma_f32_16x16x32_bf16 v[188:191], v[120:123], v[104:107], v[188:191]
v_mfma_f32_16x16x32_bf16 v[224:227], v[124:127], v[104:107], v[224:227]
v_mfma_f32_16x16x32_bf16 v[152:155], v[116:119], v[104:107], v[152:155]
v_mfma_f32_16x16x32_bf16 v[156:159], v[116:119], v[108:111], v[156:159]
v_mfma_f32_16x16x32_bf16 v[228:231], v[124:127], v[108:111], v[228:231]
v_mfma_f32_16x16x32_bf16 v[192:195], v[120:123], v[108:111], v[192:195]
v_mfma_f32_16x16x32_bf16 v[196:199], v[120:123], v[112:115], v[196:199]
v_mfma_f32_16x16x32_bf16 v[232:235], v[124:127], v[112:115], v[232:235]
v_mfma_f32_16x16x32_bf16 v[160:163], v[116:119], v[112:115], v[160:163]
s_waitcnt lgkmcnt(0)
v_mfma_f32_16x16x32_bf16 v[164:167], v[72:75], v[32:35], v[164:167]
ds_read_b128 v[80:83], v5 offset:0
v_mfma_f32_16x16x32_bf16 v[200:203], v[76:79], v[32:35], v[200:203]
ds_read_b64_tr_b16 v[120:121], v8 offset:12288
v_mfma_f32_16x16x32_bf16 v[128:131], v[68:71], v[32:35], v[128:131]
ds_read_b64_tr_b16 v[122:123], v8 offset:12800
v_mfma_f32_16x16x32_bf16 v[132:135], v[68:71], v[36:39], v[132:135]
ds_read_b64_tr_b16 v[124:125], v8 offset:20480
v_mfma_f32_16x16x32_bf16 v[204:207], v[76:79], v[36:39], v[204:207]
ds_read_b64_tr_b16 v[126:127], v8 offset:20992
v_mfma_f32_16x16x32_bf16 v[168:171], v[72:75], v[36:39], v[168:171]
ds_read_b64_tr_b16 v[116:117], v8 offset:4096
v_mfma_f32_16x16x32_bf16 v[172:175], v[72:75], v[40:43], v[172:175]
ds_read_b64_tr_b16 v[118:119], v8 offset:4608
v_mfma_f32_16x16x32_bf16 v[208:211], v[76:79], v[40:43], v[208:211]
ds_read_b128 v[84:87], v5 offset:2048
v_mfma_f32_16x16x32_bf16 v[136:139], v[68:71], v[40:43], v[136:139]
ds_read_b128 v[88:91], v5 offset:4096
v_mfma_f32_16x16x32_bf16 v[140:143], v[68:71], v[44:47], v[140:143]
ds_read_b128 v[92:95], v5 offset:6144
v_mfma_f32_16x16x32_bf16 v[212:215], v[76:79], v[44:47], v[212:215]
ds_read_b128 v[96:99], v5 offset:8192
v_mfma_f32_16x16x32_bf16 v[176:179], v[72:75], v[44:47], v[176:179]
ds_read_b128 v[100:103], v5 offset:10240
v_mfma_f32_16x16x32_bf16 v[180:183], v[72:75], v[48:51], v[180:183]
ds_read_b128 v[104:107], v5 offset:12288
v_mfma_f32_16x16x32_bf16 v[216:219], v[76:79], v[48:51], v[216:219]
ds_read_b128 v[108:111], v5 offset:14336
v_mfma_f32_16x16x32_bf16 v[144:147], v[68:71], v[48:51], v[144:147]
ds_read_b128 v[112:115], v5 offset:16384
v_mfma_f32_16x16x32_bf16 v[148:151], v[68:71], v[52:55], v[148:151]
v_mfma_f32_16x16x32_bf16 v[220:223], v[76:79], v[52:55], v[220:223]
v_mfma_f32_16x16x32_bf16 v[184:187], v[72:75], v[52:55], v[184:187]
v_mfma_f32_16x16x32_bf16 v[188:191], v[72:75], v[56:59], v[188:191]
v_mfma_f32_16x16x32_bf16 v[224:227], v[76:79], v[56:59], v[224:227]
v_mfma_f32_16x16x32_bf16 v[152:155], v[68:71], v[56:59], v[152:155]
v_mfma_f32_16x16x32_bf16 v[156:159], v[68:71], v[60:63], v[156:159]
v_mfma_f32_16x16x32_bf16 v[228:231], v[76:79], v[60:63], v[228:231]
v_mfma_f32_16x16x32_bf16 v[192:195], v[72:75], v[60:63], v[192:195]
v_mfma_f32_16x16x32_bf16 v[196:199], v[72:75], v[64:67], v[196:199]
v_mfma_f32_16x16x32_bf16 v[232:235], v[76:79], v[64:67], v[232:235]
v_mfma_f32_16x16x32_bf16 v[160:163], v[68:71], v[64:67], v[160:163]
s_waitcnt lgkmcnt(0)
s_barrier
v_mfma_f32_16x16x32_bf16 v[164:167], v[120:123], v[80:83], v[164:167]
ds_read_b128 v[32:35], v2 offset:0
v_mfma_f32_16x16x32_bf16 v[200:203], v[124:127], v[80:83], v[200:203]
ds_read_b64_tr_b16 v[72:73], v6 offset:8192
v_mfma_f32_16x16x32_bf16 v[128:131], v[116:119], v[80:83], v[128:131]
ds_read_b64_tr_b16 v[74:75], v6 offset:8704
v_mfma_f32_16x16x32_bf16 v[132:135], v[116:119], v[84:87], v[132:135]
ds_read_b64_tr_b16 v[76:77], v6 offset:16384
v_mfma_f32_16x16x32_bf16 v[204:207], v[124:127], v[84:87], v[204:207]
ds_read_b64_tr_b16 v[78:79], v6 offset:16896
v_mfma_f32_16x16x32_bf16 v[168:171], v[120:123], v[84:87], v[168:171]
ds_read_b64_tr_b16 v[68:69], v6 offset:0
v_mfma_f32_16x16x32_bf16 v[172:175], v[120:123], v[88:91], v[172:175]
ds_read_b64_tr_b16 v[70:71], v6 offset:512
v_mfma_f32_16x16x32_bf16 v[208:211], v[124:127], v[88:91], v[208:211]
ds_read_b128 v[36:39], v2 offset:2048
v_mfma_f32_16x16x32_bf16 v[136:139], v[116:119], v[88:91], v[136:139]
ds_read_b128 v[40:43], v2 offset:4096
v_mfma_f32_16x16x32_bf16 v[140:143], v[116:119], v[92:95], v[140:143]
ds_read_b128 v[44:47], v2 offset:6144
v_mfma_f32_16x16x32_bf16 v[212:215], v[124:127], v[92:95], v[212:215]
ds_read_b128 v[48:51], v2 offset:8192
v_mfma_f32_16x16x32_bf16 v[176:179], v[120:123], v[92:95], v[176:179]
ds_read_b128 v[52:55], v2 offset:10240
v_mfma_f32_16x16x32_bf16 v[180:183], v[120:123], v[96:99], v[180:183]
ds_read_b128 v[56:59], v2 offset:12288
v_mfma_f32_16x16x32_bf16 v[216:219], v[124:127], v[96:99], v[216:219]
ds_read_b128 v[60:63], v2 offset:14336
v_mfma_f32_16x16x32_bf16 v[144:147], v[116:119], v[96:99], v[144:147]
ds_read_b128 v[64:67], v2 offset:16384
v_mfma_f32_16x16x32_bf16 v[148:151], v[116:119], v[100:103], v[148:151]
v_mfma_f32_16x16x32_bf16 v[220:223], v[124:127], v[100:103], v[220:223]
v_mfma_f32_16x16x32_bf16 v[184:187], v[120:123], v[100:103], v[184:187]
v_mfma_f32_16x16x32_bf16 v[188:191], v[120:123], v[104:107], v[188:191]
v_mfma_f32_16x16x32_bf16 v[224:227], v[124:127], v[104:107], v[224:227]
v_mfma_f32_16x16x32_bf16 v[152:155], v[116:119], v[104:107], v[152:155]
v_mfma_f32_16x16x32_bf16 v[156:159], v[116:119], v[108:111], v[156:159]
v_mfma_f32_16x16x32_bf16 v[228:231], v[124:127], v[108:111], v[228:231]
v_mfma_f32_16x16x32_bf16 v[192:195], v[120:123], v[108:111], v[192:195]
v_mfma_f32_16x16x32_bf16 v[196:199], v[120:123], v[112:115], v[196:199]
v_mfma_f32_16x16x32_bf16 v[232:235], v[124:127], v[112:115], v[232:235]
v_mfma_f32_16x16x32_bf16 v[160:163], v[116:119], v[112:115], v[160:163]
s_mov_b32 s41, 4
Lcl_16:
s_waitcnt lgkmcnt(0)
v_mfma_f32_16x16x32_bf16 v[164:167], v[72:75], v[32:35], v[164:167]
ds_read_b128 v[80:83], v3 offset:0
v_mfma_f32_16x16x32_bf16 v[200:203], v[76:79], v[32:35], v[200:203]
ds_read_b64_tr_b16 v[120:121], v6 offset:12288
v_mfma_f32_16x16x32_bf16 v[128:131], v[68:71], v[32:35], v[128:131]
ds_read_b64_tr_b16 v[122:123], v6 offset:12800
v_mfma_f32_16x16x32_bf16 v[132:135], v[68:71], v[36:39], v[132:135]
ds_read_b64_tr_b16 v[124:125], v6 offset:20480
v_mfma_f32_16x16x32_bf16 v[204:207], v[76:79], v[36:39], v[204:207]
ds_read_b64_tr_b16 v[126:127], v6 offset:20992
v_mfma_f32_16x16x32_bf16 v[168:171], v[72:75], v[36:39], v[168:171]
ds_read_b64_tr_b16 v[116:117], v6 offset:4096
v_mfma_f32_16x16x32_bf16 v[172:175], v[72:75], v[40:43], v[172:175]
ds_read_b64_tr_b16 v[118:119], v6 offset:4608
v_mfma_f32_16x16x32_bf16 v[208:211], v[76:79], v[40:43], v[208:211]
ds_read_b128 v[84:87], v3 offset:2048
v_mfma_f32_16x16x32_bf16 v[136:139], v[68:71], v[40:43], v[136:139]
ds_read_b128 v[88:91], v3 offset:4096
v_mfma_f32_16x16x32_bf16 v[140:143], v[68:71], v[44:47], v[140:143]
ds_read_b128 v[92:95], v3 offset:6144
v_mfma_f32_16x16x32_bf16 v[212:215], v[76:79], v[44:47], v[212:215]
ds_read_b128 v[96:99], v3 offset:8192
v_mfma_f32_16x16x32_bf16 v[176:179], v[72:75], v[44:47], v[176:179]
ds_read_b128 v[100:103], v3 offset:10240
v_mfma_f32_16x16x32_bf16 v[180:183], v[72:75], v[48:51], v[180:183]
ds_read_b128 v[104:107], v3 offset:12288
v_mfma_f32_16x16x32_bf16 v[216:219], v[76:79], v[48:51], v[216:219]
ds_read_b128 v[108:111], v3 offset:14336
v_mfma_f32_16x16x32_bf16 v[144:147], v[68:71], v[48:51], v[144:147]
ds_read_b128 v[112:115], v3 offset:16384
v_mfma_f32_16x16x32_bf16 v[148:151], v[68:71], v[52:55], v[148:151]
v_mfma_f32_16x16x32_bf16 v[220:223], v[76:79], v[52:55], v[220:223]
v_mfma_f32_16x16x32_bf16 v[184:187], v[72:75], v[52:55], v[184:187]
v_mfma_f32_16x16x32_bf16 v[188:191], v[72:75], v[56:59], v[188:191]
v_mfma_f32_16x16x32_bf16 v[224:227], v[76:79], v[56:59], v[224:227]
v_mfma_f32_16x16x32_bf16 v[152:155], v[68:71], v[56:59], v[152:155]
v_mfma_f32_16x16x32_bf16 v[156:159], v[68:71], v[60:63], v[156:159]
v_mfma_f32_16x16x32_bf16 v[228:231], v[76:79], v[60:63], v[228:231]
v_mfma_f32_16x16x32_bf16 v[192:195], v[72:75], v[60:63], v[192:195]
v_mfma_f32_16x16x32_bf16 v[196:199], v[72:75], v[64:67], v[196:199]
v_mfma_f32_16x16x32_bf16 v[232:235], v[76:79], v[64:67], v[232:235]
v_mfma_f32_16x16x32_bf16 v[160:163], v[68:71], v[64:67], v[160:163]
s_waitcnt lgkmcnt(0)
s_barrier
v_mfma_f32_16x16x32_bf16 v[164:167], v[120:123], v[80:83], v[164:167]
ds_read_b128 v[32:35], v2 offset:43008
v_mfma_f32_16x16x32_bf16 v[200:203], v[124:127], v[80:83], v[200:203]
ds_read_b64_tr_b16 v[72:73], v7 offset:8192
v_mfma_f32_16x16x32_bf16 v[128:131], v[116:119], v[80:83], v[128:131]
ds_read_b64_tr_b16 v[74:75], v7 offset:8704
v_mfma_f32_16x16x32_bf16 v[132:135], v[116:119], v[84:87], v[132:135]
ds_read_b64_tr_b16 v[76:77], v7 offset:16384
v_mfma_f32_16x16x32_bf16 v[204:207], v[124:127], v[84:87], v[204:207]
ds_read_b64_tr_b16 v[78:79], v7 offset:16896
v_mfma_f32_16x16x32_bf16 v[168:171], v[120:123], v[84:87], v[168:171]
ds_read_b64_tr_b16 v[68:69], v7 offset:0
v_mfma_f32_16x16x32_bf16 v[172:175], v[120:123], v[88:91], v[172:175]
ds_read_b64_tr_b16 v[70:71], v7 offset:512
v_mfma_f32_16x16x32_bf16 v[208:211], v[124:127], v[88:91], v[208:211]
ds_read_b128 v[36:39], v2 offset:45056
v_mfma_f32_16x16x32_bf16 v[136:139], v[116:119], v[88:91], v[136:139]
s_branch Lov_2
.p2align 12
.fill 16, 4, 0xbf800000
Lst_2_0:
s_branch Lwr_147
s_nop 0
s_nop 0
Lov_2:
ds_read_b128 v[40:43], v2 offset:47104
v_mfma_f32_16x16x32_bf16 v[140:143], v[116:119], v[92:95], v[140:143]
ds_read_b128 v[44:47], v2 offset:49152
v_mfma_f32_16x16x32_bf16 v[212:215], v[124:127], v[92:95], v[212:215]
ds_read_b128 v[48:51], v2 offset:51200
v_mfma_f32_16x16x32_bf16 v[176:179], v[120:123], v[92:95], v[176:179]
ds_read_b128 v[52:55], v2 offset:53248
v_mfma_f32_16x16x32_bf16 v[180:183], v[120:123], v[96:99], v[180:183]
ds_read_b128 v[56:59], v2 offset:55296
v_mfma_f32_16x16x32_bf16 v[216:219], v[124:127], v[96:99], v[216:219]
ds_read_b128 v[60:63], v2 offset:57344
v_mfma_f32_16x16x32_bf16 v[144:147], v[116:119], v[96:99], v[144:147]
ds_read_b128 v[64:67], v2 offset:59392
v_mfma_f32_16x16x32_bf16 v[148:151], v[116:119], v[100:103], v[148:151]
v_mfma_f32_16x16x32_bf16 v[220:223], v[124:127], v[100:103], v[220:223]
v_mfma_f32_16x16x32_bf16 v[184:187], v[120:123], v[100:103], v[184:187]
v_mfma_f32_16x16x32_bf16 v[188:191], v[120:123], v[104:107], v[188:191]
v_mfma_f32_16x16x32_bf16 v[224:227], v[124:127], v[104:107], v[224:227]
v_mfma_f32_16x16x32_bf16 v[152:155], v[116:119], v[104:107], v[152:155]
v_mfma_f32_16x16x32_bf16 v[156:159], v[116:119], v[108:111], v[156:159]
v_mfma_f32_16x16x32_bf16 v[228:231], v[124:127], v[108:111], v[228:231]
v_mfma_f32_16x16x32_bf16 v[192:195], v[120:123], v[108:111], v[192:195]
v_mfma_f32_16x16x32_bf16 v[196:199], v[120:123], v[112:115], v[196:199]
v_mfma_f32_16x16x32_bf16 v[232:235], v[124:127], v[112:115], v[232:235]
v_mfma_f32_16x16x32_bf16 v[160:163], v[116:119], v[112:115], v[160:163]
s_waitcnt lgkmcnt(0)
v_mfma_f32_16x16x32_bf16 v[164:167], v[72:75], v[32:35], v[164:167]
ds_read_b128 v[80:83], v3 offset:43008
v_mfma_f32_16x16x32_bf16 v[200:203], v[76:79], v[32:35], v[200:203]
ds_read_b64_tr_b16 v[120:121], v7 offset:12288
v_mfma_f32_16x16x32_bf16 v[128:131], v[68:71], v[32:35], v[128:131]
ds_read_b64_tr_b16 v[122:123], v7 offset:12800
v_mfma_f32_16x16x32_bf16 v[132:135], v[68:71], v[36:39], v[132:135]
ds_read_b64_tr_b16 v[124:125], v7 offset:20480
v_mfma_f32_16x16x32_bf16 v[204:207], v[76:79], v[36:39], v[204:207]
ds_read_b64_tr_b16 v[126:127], v7 offset:20992
v_mfma_f32_16x16x32_bf16 v[168:171], v[72:75], v[36:39], v[168:171]
ds_read_b64_tr_b16 v[116:117], v7 offset:4096
v_mfma_f32_16x16x32_bf16 v[172:175], v[72:75], v[40:43], v[172:175]
ds_read_b64_tr_b16 v[118:119], v7 offset:4608
v_mfma_f32_16x16x32_bf16 v[208:211], v[76:79], v[40:43], v[208:211]
ds_read_b128 v[84:87], v3 offset:45056
v_mfma_f32_16x16x32_bf16 v[136:139], v[68:71], v[40:43], v[136:139]
ds_read_b128 v[88:91], v3 offset:47104
v_mfma_f32_16x16x32_bf16 v[140:143], v[68:71], v[44:47], v[140:143]
ds_read_b128 v[92:95], v3 offset:49152
v_mfma_f32_16x16x32_bf16 v[212:215], v[76:79], v[44:47], v[212:215]
ds_read_b128 v[96:99], v3 offset:51200
v_mfma_f32_16x16x32_bf16 v[176:179], v[72:75], v[44:47], v[176:179]
ds_read_b128 v[100:103], v3 offset:53248
v_mfma_f32_16x16x32_bf16 v[180:183], v[72:75], v[48:51], v[180:183]
ds_read_b128 v[104:107], v3 offset:55296
v_mfma_f32_16x16x32_bf16 v[216:219], v[76:79], v[48:51], v[216:219]
ds_read_b128 v[108:111], v3 offset:57344
v_mfma_f32_16x16x32_bf16 v[144:147], v[68:71], v[48:51], v[144:147]
ds_read_b128 v[112:115], v3 offset:59392
v_mfma_f32_16x16x32_bf16 v[148:151], v[68:71], v[52:55], v[148:151]
v_mfma_f32_16x16x32_bf16 v[220:223], v[76:79], v[52:55], v[220:223]
v_mfma_f32_16x16x32_bf16 v[184:187], v[72:75], v[52:55], v[184:187]
v_mfma_f32_16x16x32_bf16 v[188:191], v[72:75], v[56:59], v[188:191]
v_mfma_f32_16x16x32_bf16 v[224:227], v[76:79], v[56:59], v[224:227]
v_mfma_f32_16x16x32_bf16 v[152:155], v[68:71], v[56:59], v[152:155]
v_mfma_f32_16x16x32_bf16 v[156:159], v[68:71], v[60:63], v[156:159]
v_mfma_f32_16x16x32_bf16 v[228:231], v[76:79], v[60:63], v[228:231]
v_mfma_f32_16x16x32_bf16 v[192:195], v[72:75], v[60:63], v[192:195]
v_mfma_f32_16x16x32_bf16 v[196:199], v[72:75], v[64:67], v[196:199]
v_mfma_f32_16x16x32_bf16 v[232:235], v[76:79], v[64:67], v[232:235]
v_mfma_f32_16x16x32_bf16 v[160:163], v[68:71], v[64:67], v[160:163]
s_waitcnt lgkmcnt(0)
s_barrier
v_mfma_f32_16x16x32_bf16 v[164:167], v[120:123], v[80:83], v[164:167]
ds_read_b128 v[32:35], v4 offset:0
v_mfma_f32_16x16x32_bf16 v[200:203], v[124:127], v[80:83], v[200:203]
ds_read_b64_tr_b16 v[72:73], v8 offset:8192
v_mfma_f32_16x16x32_bf16 v[128:131], v[116:119], v[80:83], v[128:131]
ds_read_b64_tr_b16 v[74:75], v8 offset:8704
v_mfma_f32_16x16x32_bf16 v[132:135], v[116:119], v[84:87], v[132:135]
ds_read_b64_tr_b16 v[76:77], v8 offset:16384
v_mfma_f32_16x16x32_bf16 v[204:207], v[124:127], v[84:87], v[204:207]
ds_read_b64_tr_b16 v[78:79], v8 offset:16896
v_mfma_f32_16x16x32_bf16 v[168:171], v[120:123], v[84:87], v[168:171]
ds_read_b64_tr_b16 v[68:69], v8 offset:0
v_mfma_f32_16x16x32_bf16 v[172:175], v[120:123], v[88:91], v[172:175]
ds_read_b64_tr_b16 v[70:71], v8 offset:512
v_mfma_f32_16x16x32_bf16 v[208:211], v[124:127], v[88:91], v[208:211]
ds_read_b128 v[36:39], v4 offset:2048
v_mfma_f32_16x16x32_bf16 v[136:139], v[116:119], v[88:91], v[136:139]
ds_read_b128 v[40:43], v4 offset:4096
v_mfma_f32_16x16x32_bf16 v[140:143], v[116:119], v[92:95], v[140:143]
ds_read_b128 v[44:47], v4 offset:6144
v_mfma_f32_16x16x32_bf16 v[212:215], v[124:127], v[92:95], v[212:215]
ds_read_b128 v[48:51], v4 offset:8192
v_mfma_f32_16x16x32_bf16 v[176:179], v[120:123], v[92:95], v[176:179]
ds_read_b128 v[52:55], v4 offset:10240
v_mfma_f32_16x16x32_bf16 v[180:183], v[120:123], v[96:99], v[180:183]
ds_read_b128 v[56:59], v4 offset:12288
v_mfma_f32_16x16x32_bf16 v[216:219], v[124:127], v[96:99], v[216:219]
ds_read_b128 v[60:63], v4 offset:14336
v_mfma_f32_16x16x32_bf16 v[144:147], v[116:119], v[96:99], v[144:147]
ds_read_b128 v[64:67], v4 offset:16384
v_mfma_f32_16x16x32_bf16 v[148:151], v[116:119], v[100:103], v[148:151]
v_mfma_f32_16x16x32_bf16 v[220:223], v[124:127], v[100:103], v[220:223]
v_mfma_f32_16x16x32_bf16 v[184:187], v[120:123], v[100:103], v[184:187]
v_mfma_f32_16x16x32_bf16 v[188:191], v[120:123], v[104:107], v[188:191]
v_mfma_f32_16x16x32_bf16 v[224:227], v[124:127], v[104:107], v[224:227]
v_mfma_f32_16x16x32_bf16 v[152:155], v[116:119], v[104:107], v[152:155]
v_mfma_f32_16x16x32_bf16 v[156:159], v[116:119], v[108:111], v[156:159]
v_mfma_f32_16x16x32_bf16 v[228:231], v[124:127], v[108:111], v[228:231]
v_mfma_f32_16x16x32_bf16 v[192:195], v[120:123], v[108:111], v[192:195]
v_mfma_f32_16x16x32_bf16 v[196:199], v[120:123], v[112:115], v[196:199]
v_mfma_f32_16x16x32_bf16 v[232:235], v[124:127], v[112:115], v[232:235]
v_mfma_f32_16x16x32_bf16 v[160:163], v[116:119], v[112:115], v[160:163]
s_waitcnt lgkmcnt(0)
v_mfma_f32_16x16x32_bf16 v[164:167], v[72:75], v[32:35], v[164:167]
ds_read_b128 v[80:83], v5 offset:0
v_mfma_f32_16x16x32_bf16 v[200:203], v[76:79], v[32:35], v[200:203]
ds_read_b64_tr_b16 v[120:121], v8 offset:12288
v_mfma_f32_16x16x32_bf16 v[128:131], v[68:71], v[32:35], v[128:131]
ds_read_b64_tr_b16 v[122:123], v8 offset:12800
v_mfma_f32_16x16x32_bf16 v[132:135], v[68:71], v[36:39], v[132:135]
ds_read_b64_tr_b16 v[124:125], v8 offset:20480
v_mfma_f32_16x16x32_bf16 v[204:207], v[76:79], v[36:39], v[204:207]
ds_read_b64_tr_b16 v[126:127], v8 offset:20992
v_mfma_f32_16x16x32_bf16 v[168:171], v[72:75], v[36:39], v[168:171]
ds_read_b64_tr_b16 v[116:117], v8 offset:4096
v_mfma_f32_16x16x32_bf16 v[172:175], v[72:75], v[40:43], v[172:175]
ds_read_b64_tr_b16 v[118:119], v8 offset:4608
v_mfma_f32_16x16x32_bf16 v[208:211], v[76:79], v[40:43], v[208:211]
ds_read_b128 v[84:87], v5 offset:2048
v_mfma_f32_16x16x32_bf16 v[136:139], v[68:71], v[40:43], v[136:139]
ds_read_b128 v[88:91], v5 offset:4096
v_mfma_f32_16x16x32_bf16 v[140:143], v[68:71], v[44:47], v[140:143]
ds_read_b128 v[92:95], v5 offset:6144
v_mfma_f32_16x16x32_bf16 v[212:215], v[76:79], v[44:47], v[212:215]
ds_read_b128 v[96:99], v5 offset:8192
v_mfma_f32_16x16x32_bf16 v[176:179], v[72:75], v[44:47], v[176:179]
ds_read_b128 v[100:103], v5 offset:10240
v_mfma_f32_16x16x32_bf16 v[180:183], v[72:75], v[48:51], v[180:183]
ds_read_b128 v[104:107], v5 offset:12288
v_mfma_f32_16x16x32_bf16 v[216:219], v[76:79], v[48:51], v[216:219]
ds_read_b128 v[108:111], v5 offset:14336
v_mfma_f32_16x16x32_bf16 v[144:147], v[68:71], v[48:51], v[144:147]
ds_read_b128 v[112:115], v5 offset:16384
v_mfma_f32_16x16x32_bf16 v[148:151], v[68:71], v[52:55], v[148:151]
v_mfma_f32_16x16x32_bf16 v[220:223], v[76:79], v[52:55], v[220:223]
v_mfma_f32_16x16x32_bf16 v[184:187], v[72:75], v[52:55], v[184:187]
v_mfma_f32_16x16x32_bf16 v[188:191], v[72:75], v[56:59], v[188:191]
v_mfma_f32_16x16x32_bf16 v[224:227], v[76:79], v[56:59], v[224:227]
v_mfma_f32_16x16x32_bf16 v[152:155], v[68:71], v[56:59], v[152:155]
v_mfma_f32_16x16x32_bf16 v[156:159], v[68:71], v[60:63], v[156:159]
v_mfma_f32_16x16x32_bf16 v[228:231], v[76:79], v[60:63], v[228:231]
v_mfma_f32_16x16x32_bf16 v[192:195], v[72:75], v[60:63], v[192:195]
v_mfma_f32_16x16x32_bf16 v[196:199], v[72:75], v[64:67], v[196:199]
v_mfma_f32_16x16x32_bf16 v[232:235], v[76:79], v[64:67], v[232:235]
v_mfma_f32_16x16x32_bf16 v[160:163], v[68:71], v[64:67], v[160:163]
s_waitcnt lgkmcnt(0)
s_barrier
v_mfma_f32_16x16x32_bf16 v[164:167], v[120:123], v[80:83], v[164:167]
ds_read_b128 v[32:35], v2 offset:0
v_mfma_f32_16x16x32_bf16 v[200:203], v[124:127], v[80:83], v[200:203]
ds_read_b64_tr_b16 v[72:73], v6 offset:8192
v_mfma_f32_16x16x32_bf16 v[128:131], v[116:119], v[80:83], v[128:131]
ds_read_b64_tr_b16 v[74:75], v6 offset:8704
v_mfma_f32_16x16x32_bf16 v[132:135], v[116:119], v[84:87], v[132:135]
ds_read_b64_tr_b16 v[76:77], v6 offset:16384
v_mfma_f32_16x16x32_bf16 v[204:207], v[124:127], v[84:87], v[204:207]
ds_read_b64_tr_b16 v[78:79], v6 offset:16896
v_mfma_f32_16x16x32_bf16 v[168:171], v[120:123], v[84:87], v[168:171]
ds_read_b64_tr_b16 v[68:69], v6 offset:0
v_mfma_f32_16x16x32_bf16 v[172:175], v[120:123], v[88:91], v[172:175]
ds_read_b64_tr_b16 v[70:71], v6 offset:512
v_mfma_f32_16x16x32_bf16 v[208:211], v[124:127], v[88:91], v[208:211]
ds_read_b128 v[36:39], v2 offset:2048
v_mfma_f32_16x16x32_bf16 v[136:139], v[116:119], v[88:91], v[136:139]
ds_read_b128 v[40:43], v2 offset:4096
v_mfma_f32_16x16x32_bf16 v[140:143], v[116:119], v[92:95], v[140:143]
ds_read_b128 v[44:47], v2 offset:6144
v_mfma_f32_16x16x32_bf16 v[212:215], v[124:127], v[92:95], v[212:215]
ds_read_b128 v[48:51], v2 offset:8192
v_mfma_f32_16x16x32_bf16 v[176:179], v[120:123], v[92:95], v[176:179]
ds_read_b128 v[52:55], v2 offset:10240
v_mfma_f32_16x16x32_bf16 v[180:183], v[120:123], v[96:99], v[180:183]
ds_read_b128 v[56:59], v2 offset:12288
v_mfma_f32_16x16x32_bf16 v[216:219], v[124:127], v[96:99], v[216:219]
ds_read_b128 v[60:63], v2 offset:14336
v_mfma_f32_16x16x32_bf16 v[144:147], v[116:119], v[96:99], v[144:147]
ds_read_b128 v[64:67], v2 offset:16384
v_mfma_f32_16x16x32_bf16 v[148:151], v[116:119], v[100:103], v[148:151]
v_mfma_f32_16x16x32_bf16 v[220:223], v[124:127], v[100:103], v[220:223]
v_mfma_f32_16x16x32_bf16 v[184:187], v[120:123], v[100:103], v[184:187]
v_mfma_f32_16x16x32_bf16 v[188:191], v[120:123], v[104:107], v[188:191]
v_mfma_f32_16x16x32_bf16 v[224:227], v[124:127], v[104:107], v[224:227]
v_mfma_f32_16x16x32_bf16 v[152:155], v[116:119], v[104:107], v[152:155]
v_mfma_f32_16x16x32_bf16 v[156:159], v[116:119], v[108:111], v[156:159]
v_mfma_f32_16x16x32_bf16 v[228:231], v[124:127], v[108:111], v[228:231]
v_mfma_f32_16x16x32_bf16 v[192:195], v[120:123], v[108:111], v[192:195]
v_mfma_f32_16x16x32_bf16 v[196:199], v[120:123], v[112:115], v[196:199]
v_mfma_f32_16x16x32_bf16 v[232:235], v[124:127], v[112:115], v[232:235]
v_mfma_f32_16x16x32_bf16 v[160:163], v[116:119], v[112:115], v[160:163]
s_sub_u32 s41, s41, 1
s_cmp_lg_u32 s41, 0
s_cbranch_scc1 Lcl_16
s_waitcnt lgkmcnt(0)
v_mfma_f32_16x16x32_bf16 v[164:167], v[72:75], v[32:35], v[164:167]
ds_read_b128 v[80:83], v3 offset:0
v_mfma_f32_16x16x32_bf16 v[200:203], v[76:79], v[32:35], v[200:203]
ds_read_b64_tr_b16 v[120:121], v6 offset:12288
v_mfma_f32_16x16x32_bf16 v[128:131], v[68:71], v[32:35], v[128:131]
ds_read_b64_tr_b16 v[122:123], v6 offset:12800
v_mfma_f32_16x16x32_bf16 v[132:135], v[68:71], v[36:39], v[132:135]
ds_read_b64_tr_b16 v[124:125], v6 offset:20480
v_mfma_f32_16x16x32_bf16 v[204:207], v[76:79], v[36:39], v[204:207]
ds_read_b64_tr_b16 v[126:127], v6 offset:20992
v_mfma_f32_16x16x32_bf16 v[168:171], v[72:75], v[36:39], v[168:171]
ds_read_b64_tr_b16 v[116:117], v6 offset:4096
v_mfma_f32_16x16x32_bf16 v[172:175], v[72:75], v[40:43], v[172:175]
ds_read_b64_tr_b16 v[118:119], v6 offset:4608
v_mfma_f32_16x16x32_bf16 v[208:211], v[76:79], v[40:43], v[208:211]
ds_read_b128 v[84:87], v3 offset:2048
v_mfma_f32_16x16x32_bf16 v[136:139], v[68:71], v[40:43], v[136:139]
ds_read_b128 v[88:91], v3 offset:4096
v_mfma_f32_16x16x32_bf16 v[140:143], v[68:71], v[44:47], v[140:143]
ds_read_b128 v[92:95], v3 offset:6144
v_mfma_f32_16x16x32_bf16 v[212:215], v[76:79], v[44:47], v[212:215]
ds_read_b128 v[96:99], v3 offset:8192
v_mfma_f32_16x16x32_bf16 v[176:179], v[72:75], v[44:47], v[176:179]
ds_read_b128 v[100:103], v3 offset:10240
v_mfma_f32_16x16x32_bf16 v[180:183], v[72:75], v[48:51], v[180:183]
ds_read_b128 v[104:107], v3 offset:12288
v_mfma_f32_16x16x32_bf16 v[216:219], v[76:79], v[48:51], v[216:219]
ds_read_b128 v[108:111], v3 offset:14336
v_mfma_f32_16x16x32_bf16 v[144:147], v[68:71], v[48:51], v[144:147]
ds_read_b128 v[112:115], v3 offset:16384
v_mfma_f32_16x16x32_bf16 v[148:151], v[68:71], v[52:55], v[148:151]
v_mfma_f32_16x16x32_bf16 v[220:223], v[76:79], v[52:55], v[220:223]
v_mfma_f32_16x16x32_bf16 v[184:187], v[72:75], v[52:55], v[184:187]
v_mfma_f32_16x16x32_bf16 v[188:191], v[72:75], v[56:59], v[188:191]
v_mfma_f32_16x16x32_bf16 v[224:227], v[76:79], v[56:59], v[224:227]
v_mfma_f32_16x16x32_bf16 v[152:155], v[68:71], v[56:59], v[152:155]
v_mfma_f32_16x16x32_bf16 v[156:159], v[68:71], v[60:63], v[156:159]
v_mfma_f32_16x16x32_bf16 v[228:231], v[76:79], v[60:63], v[228:231]
v_mfma_f32_16x16x32_bf16 v[192:195], v[72:75], v[60:63], v[192:195]
v_mfma_f32_16x16x32_bf16 v[196:199], v[72:75], v[64:67], v[196:199]
v_mfma_f32_16x16x32_bf16 v[232:235], v[76:79], v[64:67], v[232:235]
v_mfma_f32_16x16x32_bf16 v[160:163], v[68:71], v[64:67], v[160:163]
s_waitcnt lgkmcnt(0)
v_mfma_f32_16x16x32_bf16 v[164:167], v[120:123], v[80:83], v[164:167]
v_mfma_f32_16x16x32_bf16 v[200:203], v[124:127], v[80:83], v[200:203]
v_mfma_f32_16x16x32_bf16 v[128:131], v[116:119], v[80:83], v[128:131]
v_mfma_f32_16x16x32_bf16 v[132:135], v[116:119], v[84:87], v[132:135]
v_mfma_f32_16x16x32_bf16 v[204:207], v[124:127], v[84:87], v[204:207]
v_mfma_f32_16x16x32_bf16 v[168:171], v[120:123], v[84:87], v[168:171]
v_mfma_f32_16x16x32_bf16 v[172:175], v[120:123], v[88:91], v[172:175]
v_mfma_f32_16x16x32_bf16 v[208:211], v[124:127], v[88:91], v[208:211]
v_mfma_f32_16x16x32_bf16 v[136:139], v[116:119], v[88:91], v[136:139]
v_mfma_f32_16x16x32_bf16 v[140:143], v[116:119], v[92:95], v[140:143]
v_mfma_f32_16x16x32_bf16 v[212:215], v[124:127], v[92:95], v[212:215]
v_mfma_f32_16x16x32_bf16 v[176:179], v[120:123], v[92:95], v[176:179]
v_mfma_f32_16x16x32_bf16 v[180:183], v[120:123], v[96:99], v[180:183]
v_mfma_f32_16x16x32_bf16 v[216:219], v[124:127], v[96:99], v[216:219]
v_mfma_f32_16x16x32_bf16 v[144:147], v[116:119], v[96:99], v[144:147]
v_mfma_f32_16x16x32_bf16 v[148:151], v[116:119], v[100:103], v[148:151]
v_mfma_f32_16x16x32_bf16 v[220:223], v[124:127], v[100:103], v[220:223]
v_mfma_f32_16x16x32_bf16 v[184:187], v[120:123], v[100:103], v[184:187]
v_mfma_f32_16x16x32_bf16 v[188:191], v[120:123], v[104:107], v[188:191]
v_mfma_f32_16x16x32_bf16 v[224:227], v[124:127], v[104:107], v[224:227]
v_mfma_f32_16x16x32_bf16 v[152:155], v[116:119], v[104:107], v[152:155]
v_mfma_f32_16x16x32_bf16 v[156:159], v[116:119], v[108:111], v[156:159]
v_mfma_f32_16x16x32_bf16 v[228:231], v[124:127], v[108:111], v[228:231]
v_mfma_f32_16x16x32_bf16 v[192:195], v[120:123], v[108:111], v[192:195]
v_mfma_f32_16x16x32_bf16 v[196:199], v[120:123], v[112:115], v[196:199]
v_mfma_f32_16x16x32_bf16 v[232:235], v[124:127], v[112:115], v[232:235]
v_mfma_f32_16x16x32_bf16 v[160:163], v[116:119], v[112:115], v[160:163]
v_lshlrev_b32 v14, 3, v12
v_add_u32 v14, 147456, v14
v_mul_u32_u24 v15, 400, v12
v_lshl_add_u32 v15, v13, 3, v15
s_lshl_b32 s43, s36, 5
v_add_u32 v15, s43, v15
s_barrier
ds_read_b64 v[32:33], v14 offset:0
ds_read_b64 v[34:35], v14 offset:128
ds_read_b64 v[36:37], v14 offset:256
ds_read_b64 v[38:39], v14 offset:384
ds_read_b64 v[40:41], v14 offset:512
ds_read_b64 v[42:43], v14 offset:640
ds_read_b64 v[44:45], v14 offset:768
ds_read_b64 v[46:47], v14 offset:896
ds_read_b64 v[48:49], v14 offset:1024
v_mov_b32_dpp v52, v128 row_newbcast:0 row_mask:0xf bank_mask:0xf
v_mov_b32_dpp v53, v129 row_newbcast:0 row_mask:0xf bank_mask:0xf
v_mov_b32_dpp v54, v130 row_newbcast:0 row_mask:0xf bank_mask:0xf
v_mov_b32_dpp v55, v131 row_newbcast:0 row_mask:0xf bank_mask:0xf
v_mov_b32_dpp v56, v164 row_newbcast:0 row_mask:0xf bank_mask:0xf
v_mov_b32_dpp v57, v165 row_newbcast:0 row_mask:0xf bank_mask:0xf
v_mov_b32_dpp v58, v166 row_newbcast:0 row_mask:0xf bank_mask:0xf
v_mov_b32_dpp v59, v167 row_newbcast:0 row_mask:0xf bank_mask:0xf
v_mov_b32_dpp v60, v200 row_newbcast:0 row_mask:0xf bank_mask:0xf
v_mov_b32_dpp v61, v201 row_newbcast:0 row_mask:0xf bank_mask:0xf
v_mov_b32_dpp v62, v202 row_newbcast:0 row_mask:0xf bank_mask:0xf
v_mov_b32_dpp v63, v203 row_newbcast:0 row_mask:0xf bank_mask:0xf
s_waitcnt lgkmcnt(0)
v_pk_fma_f32 v[164:165], v[32:33], v[56:57], v[164:165] op_sel_hi:[0,1,1] neg_lo:[1,0,0] neg_hi:[1,0,0]
v_pk_fma_f32 v[166:167], v[32:33], v[58:59], v[166:167] op_sel_hi:[0,1,1] neg_lo:[1,0,0] neg_hi:[1,0,0]
v_pk_fma_f32 v[200:201], v[32:33], v[60:61], v[200:201] op_sel_hi:[0,1,1] neg_lo:[1,0,0] neg_hi:[1,0,0]
v_pk_fma_f32 v[202:203], v[32:33], v[62:63], v[202:203] op_sel_hi:[0,1,1] neg_lo:[1,0,0] neg_hi:[1,0,0]
v_pk_mul_f32 v[164:165], v[32:33], v[164:165] op_sel:[1,0] op_sel_hi:[1,1]
v_pk_mul_f32 v[166:167], v[32:33], v[166:167] op_sel:[1,0] op_sel_hi:[1,1]
v_pk_fma_f32 v[132:133], v[34:35], v[52:53], v[132:133] op_sel_hi:[0,1,1] neg_lo:[1,0,0] neg_hi:[1,0,0]
v_pk_fma_f32 v[134:135], v[34:35], v[54:55], v[134:135] op_sel_hi:[0,1,1] neg_lo:[1,0,0] neg_hi:[1,0,0]
v_pk_mul_f32 v[200:201], v[32:33], v[200:201] op_sel:[1,0] op_sel_hi:[1,1]
v_pk_mul_f32 v[202:203], v[32:33], v[202:203] op_sel:[1,0] op_sel_hi:[1,1]
v_cvt_pk_bf16_f32 v164, v164, v165
v_cvt_pk_bf16_f32 v165, v166, v167
ds_write_b64 v15, v[164:165] offset:128
v_pk_fma_f32 v[168:169], v[34:35], v[56:57], v[168:169] op_sel_hi:[0,1,1] neg_lo:[1,0,0] neg_hi:[1,0,0]
v_pk_fma_f32 v[170:171], v[34:35], v[58:59], v[170:171] op_sel_hi:[0,1,1] neg_lo:[1,0,0] neg_hi:[1,0,0]
v_pk_mul_f32 v[132:133], v[34:35], v[132:133] op_sel:[1,0] op_sel_hi:[1,1]
v_pk_mul_f32 v[134:135], v[34:35], v[134:135] op_sel:[1,0] op_sel_hi:[1,1]
v_cvt_pk_bf16_f32 v200, v200, v201
v_cvt_pk_bf16_f32 v201, v202, v203
ds_write_b64 v15, v[200:201] offset:256
v_pk_fma_f32 v[204:205], v[34:35], v[60:61], v[204:205] op_sel_hi:[0,1,1] neg_lo:[1,0,0] neg_hi:[1,0,0]
v_pk_fma_f32 v[206:207], v[34:35], v[62:63], v[206:207] op_sel_hi:[0,1,1] neg_lo:[1,0,0] neg_hi:[1,0,0]
v_pk_mul_f32 v[168:169], v[34:35], v[168:169] op_sel:[1,0] op_sel_hi:[1,1]
v_pk_mul_f32 v[170:171], v[34:35], v[170:171] op_sel:[1,0] op_sel_hi:[1,1]
v_cvt_pk_bf16_f32 v132, v132, v133
v_cvt_pk_bf16_f32 v133, v134, v135
ds_write_b64 v15, v[132:133] offset:6400
v_pk_fma_f32 v[136:137], v[36:37], v[52:53], v[136:137] op_sel_hi:[0,1,1] neg_lo:[1,0,0] neg_hi:[1,0,0]
v_pk_fma_f32 v[138:139], v[36:37], v[54:55], v[138:139] op_sel_hi:[0,1,1] neg_lo:[1,0,0] neg_hi:[1,0,0]
v_pk_mul_f32 v[204:205], v[34:35], v[204:205] op_sel:[1,0] op_sel_hi:[1,1]
v_pk_mul_f32 v[206:207], v[34:35], v[206:207] op_sel:[1,0] op_sel_hi:[1,1]
v_cvt_pk_bf16_f32 v168, v168, v169
v_cvt_pk_bf16_f32 v169, v170, v171
ds_write_b64 v15, v[168:169] offset:6528
v_pk_fma_f32 v[172:173], v[36:37], v[56:57], v[172:173] op_sel_hi:[0,1,1] neg_lo:[1,0,0] neg_hi:[1,0,0]
v_pk_fma_f32 v[174:175], v[36:37], v[58:59], v[174:175] op_sel_hi:[0,1,1] neg_lo:[1,0,0] neg_hi:[1,0,0]
v_pk_mul_f32 v[136:137], v[36:37], v[136:137] op_sel:[1,0] op_sel_hi:[1,1]
v_pk_mul_f32 v[138:139], v[36:37], v[138:139] op_sel:[1,0] op_sel_hi:[1,1]
v_cvt_pk_bf16_f32 v204, v204, v205
v_cvt_pk_bf16_f32 v205, v206, v207
ds_write_b64 v15, v[204:205] offset:6656
v_pk_fma_f32 v[208:209], v[36:37], v[60:61], v[208:209] op_sel_hi:[0,1,1] neg_lo:[1,0,0] neg_hi:[1,0,0]
v_pk_fma_f32 v[210:211], v[36:37], v[62:63], v[210:211] op_sel_hi:[0,1,1] neg_lo:[1,0,0] neg_hi:[1,0,0]
v_pk_mul_f32 v[172:173], v[36:37], v[172:173] op_sel:[1,0] op_sel_hi:[1,1]
v_pk_mul_f32 v[174:175], v[36:37], v[174:175] op_sel:[1,0] op_sel_hi:[1,1]
v_cvt_pk_bf16_f32 v136, v136, v137
v_cvt_pk_bf16_f32 v137, v138, v139
ds_write_b64 v15, v[136:137] offset:12800
v_pk_fma_f32 v[140:141], v[38:39], v[52:53], v[140:141] op_sel_hi:[0,1,1] neg_lo:[1,0,0] neg_hi:[1,0,0]
v_pk_fma_f32 v[142:143], v[38:39], v[54:55], v[142:143] op_sel_hi:[0,1,1] neg_lo:[1,0,0] neg_hi:[1,0,0]
v_pk_mul_f32 v[208:209], v[36:37], v[208:209] op_sel:[1,0] op_sel_hi:[1,1]
v_pk_mul_f32 v[210:211], v[36:37], v[210:211] op_sel:[1,0] op_sel_hi:[1,1]
v_cvt_pk_bf16_f32 v172, v172, v173
v_cvt_pk_bf16_f32 v173, v174, v175
ds_write_b64 v15, v[172:173] offset:12928
v_pk_fma_f32 v[176:177], v[38:39], v[56:57], v[176:177] op_sel_hi:[0,1,1] neg_lo:[1,0,0] neg_hi:[1,0,0]
v_pk_fma_f32 v[178:179], v[38:39], v[58:59], v[178:179] op_sel_hi:[0,1,1] neg_lo:[1,0,0] neg_hi:[1,0,0]
v_pk_mul_f32 v[140:141], v[38:39], v[140:141] op_sel:[1,0] op_sel_hi:[1,1]
v_pk_mul_f32 v[142:143], v[38:39], v[142:143] op_sel:[1,0] op_sel_hi:[1,1]
v_cvt_pk_bf16_f32 v208, v208, v209
v_cvt_pk_bf16_f32 v209, v210, v211
ds_write_b64 v15, v[208:209] offset:13056
v_pk_fma_f32 v[212:213], v[38:39], v[60:61], v[212:213] op_sel_hi:[0,1,1] neg_lo:[1,0,0] neg_hi:[1,0,0]
v_pk_fma_f32 v[214:215], v[38:39], v[62:63], v[214:215] op_sel_hi:[0,1,1] neg_lo:[1,0,0] neg_hi:[1,0,0]
v_pk_mul_f32 v[176:177], v[38:39], v[176:177] op_sel:[1,0] op_sel_hi:[1,1]
v_pk_mul_f32 v[178:179], v[38:39], v[178:179] op_sel:[1,0] op_sel_hi:[1,1]
v_cvt_pk_bf16_f32 v140, v140, v141
v_cvt_pk_bf16_f32 v141, v142, v143
ds_write_b64 v15, v[140:141] offset:19200
v_pk_fma_f32 v[144:145], v[40:41], v[52:53], v[144:145] op_sel_hi:[0,1,1] neg_lo:[1,0,0] neg_hi:[1,0,0]
v_pk_fma_f32 v[146:147], v[40:41], v[54:55], v[146:147] op_sel_hi:[0,1,1] neg_lo:[1,0,0] neg_hi:[1,0,0]
v_pk_mul_f32 v[212:213], v[38:39], v[212:213] op_sel:[1,0] op_sel_hi:[1,1]
v_pk_mul_f32 v[214:215], v[38:39], v[214:215] op_sel:[1,0] op_sel_hi:[1,1]
v_cvt_pk_bf16_f32 v176, v176, v177
v_cvt_pk_bf16_f32 v177, v178, v179
ds_write_b64 v15, v[176:177] offset:19328
v_pk_fma_f32 v[180:181], v[40:41], v[56:57], v[180:181] op_sel_hi:[0,1,1] neg_lo:[1,0,0] neg_hi:[1,0,0]
v_pk_fma_f32 v[182:183], v[40:41], v[58:59], v[182:183] op_sel_hi:[0,1,1] neg_lo:[1,0,0] neg_hi:[1,0,0]
v_pk_mul_f32 v[144:145], v[40:41], v[144:145] op_sel:[1,0] op_sel_hi:[1,1]
v_pk_mul_f32 v[146:147], v[40:41], v[146:147] op_sel:[1,0] op_sel_hi:[1,1]
v_cvt_pk_bf16_f32 v212, v212, v213
v_cvt_pk_bf16_f32 v213, v214, v215
ds_write_b64 v15, v[212:213] offset:19456
v_pk_fma_f32 v[216:217], v[40:41], v[60:61], v[216:217] op_sel_hi:[0,1,1] neg_lo:[1,0,0] neg_hi:[1,0,0]
v_pk_fma_f32 v[218:219], v[40:41], v[62:63], v[218:219] op_sel_hi:[0,1,1] neg_lo:[1,0,0] neg_hi:[1,0,0]
v_pk_mul_f32 v[180:181], v[40:41], v[180:181] op_sel:[1,0] op_sel_hi:[1,1]
v_pk_mul_f32 v[182:183], v[40:41], v[182:183] op_sel:[1,0] op_sel_hi:[1,1]
v_cvt_pk_bf16_f32 v144, v144, v145
v_cvt_pk_bf16_f32 v145, v146, v147
ds_write_b64 v15, v[144:145] offset:25600
v_pk_fma_f32 v[148:149], v[42:43], v[52:53], v[148:149] op_sel_hi:[0,1,1] neg_lo:[1,0,0] neg_hi:[1,0,0]
v_pk_fma_f32 v[150:151], v[42:43], v[54:55], v[150:151] op_sel_hi:[0,1,1] neg_lo:[1,0,0] neg_hi:[1,0,0]
v_pk_mul_f32 v[216:217], v[40:41], v[216:217] op_sel:[1,0] op_sel_hi:[1,1]
v_pk_mul_f32 v[218:219], v[40:41], v[218:219] op_sel:[1,0] op_sel_hi:[1,1]
v_cvt_pk_bf16_f32 v180, v180, v181
v_cvt_pk_bf16_f32 v181, v182, v183
ds_write_b64 v15, v[180:181] offset:25728
v_pk_fma_f32 v[184:185], v[42:43], v[56:57], v[184:185] op_sel_hi:[0,1,1] neg_lo:[1,0,0] neg_hi:[1,0,0]
v_pk_fma_f32 v[186:187], v[42:43], v[58:59], v[186:187] op_sel_hi:[0,1,1] neg_lo:[1,0,0] neg_hi:[1,0,0]
v_pk_mul_f32 v[148:149], v[42:43], v[148:149] op_sel:[1,0] op_sel_hi:[1,1]
v_pk_mul_f32 v[150:151], v[42:43], v[150:151] op_sel:[1,0] op_sel_hi:[1,1]
v_cvt_pk_bf16_f32 v216, v216, v217
v_cvt_pk_bf16_f32 v217, v218, v219
ds_write_b64 v15, v[216:217] offset:25856
v_pk_fma_f32 v[220:221], v[42:43], v[60:61], v[220:221] op_sel_hi:[0,1,1] neg_lo:[1,0,0] neg_hi:[1,0,0]
v_pk_fma_f32 v[222:223], v[42:43], v[62:63], v[222:223] op_sel_hi:[0,1,1] neg_lo:[1,0,0] neg_hi:[1,0,0]
v_pk_mul_f32 v[184:185], v[42:43], v[184:185] op_sel:[1,0] op_sel_hi:[1,1]
v_pk_mul_f32 v[186:187], v[42:43], v[186:187] op_sel:[1,0] op_sel_hi:[1,1]
v_cvt_pk_bf16_f32 v148, v148, v149
v_cvt_pk_bf16_f32 v149, v150, v151
ds_write_b64 v15, v[148:149] offset:32000
v_pk_fma_f32 v[152:153], v[44:45], v[52:53], v[152:153] op_sel_hi:[0,1,1] neg_lo:[1,0,0] neg_hi:[1,0,0]
v_pk_fma_f32 v[154:155], v[44:45], v[54:55], v[154:155] op_sel_hi:[0,1,1] neg_lo:[1,0,0] neg_hi:[1,0,0]
v_pk_mul_f32 v[220:221], v[42:43], v[220:221] op_sel:[1,0] op_sel_hi:[1,1]
v_pk_mul_f32 v[222:223], v[42:43], v[222:223] op_sel:[1,0] op_sel_hi:[1,1]
v_cvt_pk_bf16_f32 v184, v184, v185
v_cvt_pk_bf16_f32 v185, v186, v187
ds_write_b64 v15, v[184:185] offset:32128
v_pk_fma_f32 v[188:189], v[44:45], v[56:57], v[188:189] op_sel_hi:[0,1,1] neg_lo:[1,0,0] neg_hi:[1,0,0]
v_pk_fma_f32 v[190:191], v[44:45], v[58:59], v[190:191] op_sel_hi:[0,1,1] neg_lo:[1,0,0] neg_hi:[1,0,0]
v_pk_mul_f32 v[152:153], v[44:45], v[152:153] op_sel:[1,0] op_sel_hi:[1,1]
v_pk_mul_f32 v[154:155], v[44:45], v[154:155] op_sel:[1,0] op_sel_hi:[1,1]
v_cvt_pk_bf16_f32 v220, v220, v221
v_cvt_pk_bf16_f32 v221, v222, v223
ds_write_b64 v15, v[220:221] offset:32256
v_pk_fma_f32 v[224:225], v[44:45], v[60:61], v[224:225] op_sel_hi:[0,1,1] neg_lo:[1,0,0] neg_hi:[1,0,0]
v_pk_fma_f32 v[226:227], v[44:45], v[62:63], v[226:227] op_sel_hi:[0,1,1] neg_lo:[1,0,0] neg_hi:[1,0,0]
v_pk_mul_f32 v[188:189], v[44:45], v[188:189] op_sel:[1,0] op_sel_hi:[1,1]
v_pk_mul_f32 v[190:191], v[44:45], v[190:191] op_sel:[1,0] op_sel_hi:[1,1]
v_cvt_pk_bf16_f32 v152, v152, v153
v_cvt_pk_bf16_f32 v153, v154, v155
ds_write_b64 v15, v[152:153] offset:38400
v_pk_fma_f32 v[156:157], v[46:47], v[52:53], v[156:157] op_sel_hi:[0,1,1] neg_lo:[1,0,0] neg_hi:[1,0,0]
v_pk_fma_f32 v[158:159], v[46:47], v[54:55], v[158:159] op_sel_hi:[0,1,1] neg_lo:[1,0,0] neg_hi:[1,0,0]
v_pk_mul_f32 v[224:225], v[44:45], v[224:225] op_sel:[1,0] op_sel_hi:[1,1]
v_pk_mul_f32 v[226:227], v[44:45], v[226:227] op_sel:[1,0] op_sel_hi:[1,1]
v_cvt_pk_bf16_f32 v188, v188, v189
v_cvt_pk_bf16_f32 v189, v190, v191
ds_write_b64 v15, v[188:189] offset:38528
v_pk_fma_f32 v[192:193], v[46:47], v[56:57], v[192:193] op_sel_hi:[0,1,1] neg_lo:[1,0,0] neg_hi:[1,0,0]
v_pk_fma_f32 v[194:195], v[46:47], v[58:59], v[194:195] op_sel_hi:[0,1,1] neg_lo:[1,0,0] neg_hi:[1,0,0]
v_pk_mul_f32 v[156:157], v[46:47], v[156:157] op_sel:[1,0] op_sel_hi:[1,1]
v_pk_mul_f32 v[158:159], v[46:47], v[158:159] op_sel:[1,0] op_sel_hi:[1,1]
v_cvt_pk_bf16_f32 v224, v224, v225
v_cvt_pk_bf16_f32 v225, v226, v227
ds_write_b64 v15, v[224:225] offset:38656
v_pk_fma_f32 v[228:229], v[46:47], v[60:61], v[228:229] op_sel_hi:[0,1,1] neg_lo:[1,0,0] neg_hi:[1,0,0]
v_pk_fma_f32 v[230:231], v[46:47], v[62:63], v[230:231] op_sel_hi:[0,1,1] neg_lo:[1,0,0] neg_hi:[1,0,0]
v_pk_mul_f32 v[192:193], v[46:47], v[192:193] op_sel:[1,0] op_sel_hi:[1,1]
v_pk_mul_f32 v[194:195], v[46:47], v[194:195] op_sel:[1,0] op_sel_hi:[1,1]
v_cvt_pk_bf16_f32 v156, v156, v157
v_cvt_pk_bf16_f32 v157, v158, v159
ds_write_b64 v15, v[156:157] offset:44800
v_pk_fma_f32 v[160:161], v[48:49], v[52:53], v[160:161] op_sel_hi:[0,1,1] neg_lo:[1,0,0] neg_hi:[1,0,0]
v_pk_fma_f32 v[162:163], v[48:49], v[54:55], v[162:163] op_sel_hi:[0,1,1] neg_lo:[1,0,0] neg_hi:[1,0,0]
v_pk_mul_f32 v[228:229], v[46:47], v[228:229] op_sel:[1,0] op_sel_hi:[1,1]
v_pk_mul_f32 v[230:231], v[46:47], v[230:231] op_sel:[1,0] op_sel_hi:[1,1]
v_cvt_pk_bf16_f32 v192, v192, v193
v_cvt_pk_bf16_f32 v193, v194, v195
ds_write_b64 v15, v[192:193] offset:44928
v_pk_fma_f32 v[196:197], v[48:49], v[56:57], v[196:197] op_sel_hi:[0,1,1] neg_lo:[1,0,0] neg_hi:[1,0,0]
v_pk_fma_f32 v[198:199], v[48:49], v[58:59], v[198:199] op_sel_hi:[0,1,1] neg_lo:[1,0,0] neg_hi:[1,0,0]
v_pk_mul_f32 v[160:161], v[48:49], v[160:161] op_sel:[1,0] op_sel_hi:[1,1]
v_pk_mul_f32 v[162:163], v[48:49], v[162:163] op_sel:[1,0] op_sel_hi:[1,1]
v_cvt_pk_bf16_f32 v228, v228, v229
v_cvt_pk_bf16_f32 v229, v230, v231
ds_write_b64 v15, v[228:229] offset:45056
v_pk_fma_f32 v[232:233], v[48:49], v[60:61], v[232:233] op_sel_hi:[0,1,1] neg_lo:[1,0,0] neg_hi:[1,0,0]
v_pk_fma_f32 v[234:235], v[48:49], v[62:63], v[234:235] op_sel_hi:[0,1,1] neg_lo:[1,0,0] neg_hi:[1,0,0]
v_pk_mul_f32 v[196:197], v[48:49], v[196:197] op_sel:[1,0] op_sel_hi:[1,1]
v_pk_mul_f32 v[198:199], v[48:49], v[198:199] op_sel:[1,0] op_sel_hi:[1,1]
v_cvt_pk_bf16_f32 v160, v160, v161
v_cvt_pk_bf16_f32 v161, v162, v163
ds_write_b64 v15, v[160:161] offset:51200
v_pk_mul_f32 v[232:233], v[48:49], v[232:233] op_sel:[1,0] op_sel_hi:[1,1]
v_pk_mul_f32 v[234:235], v[48:49], v[234:235] op_sel:[1,0] op_sel_hi:[1,1]
v_cvt_pk_bf16_f32 v196, v196, v197
v_cvt_pk_bf16_f32 v197, v198, v199
ds_write_b64 v15, v[196:197] offset:51328
v_cvt_pk_bf16_f32 v232, v232, v233
v_cvt_pk_bf16_f32 v233, v234, v235
ds_write_b64 v15, v[232:233] offset:51456
s_waitcnt lgkmcnt(0)
s_branch Latt_5
Lpf_4:
s_lshl_b32 s43, s35, 7
s_waitcnt lgkmcnt(0)
s_mov_b32 s8, s64
s_mov_b32 s9, s65
s_mov_b32 s10, 4194304
s_mov_b32 s11, 0x20000
s_add_u32 s12, s66, s43
s_addc_u32 s13, s67, 0
s_mov_b32 s14, 6289536
s_mov_b32 s15, 0x20000
s_add_u32 s84, s82, 28311552
s_addc_u32 s85, s83, 0
s_mov_b32 s86, 114688
s_mov_b32 s87, 0x20000
s_mov_b32 s56, s80
s_mov_b32 s57, s81
s_mov_b32 s58, 256
s_mov_b32 s59, 0x20000
v_mov_b32 v5, 0
v_lshlrev_b32 v14, 7, v1
s_or_b32 s43, s34, s35
s_cmp_lg_u32 s43, 0
s_cbranch_scc1 Lz_17
s_movk_i32 s43, 0x2000
buffer_store_dword v5, v14, s[84:87], 0 offen sc1
s_bfm_b64 exec, 44, 0
buffer_store_dword v5, v14, s[84:87], s43 offen sc1
s_mov_b64 exec, 1
v_mov_b32 v6, 1
s_waitcnt vmcnt(0)
buffer_store_dword v6, v5, s[56:59], 0 offen sc1
s_mov_b64 exec, -1
Lz_17:
s_lshl_b32 s43, s51, 11
buffer_load_dwordx4 v[96:99], v10, s[8:11], s43 offen offset:0
buffer_load_dwordx4 v[100:103], v10, s[8:11], s43 offen offset:1024
s_branch Lov_3
.p2align 12
.fill 16, 4, 0xbf800000
Lst_3_0:
s_branch Lwr_148
s_nop 0
s_nop 0
Lov_3:
buffer_load_dwordx4 v[104:107], v10, s[8:11], s43 offen offset:2048
buffer_load_dwordx4 v[108:111], v10, s[8:11], s43 offen offset:3072
v_min_u32 v14, 23, v1
v_lshrrev_b32 v15, 3, v14
v_mul_u32_u24 v15, 43008, v15
v_and_b32 v14, 7, v14
v_lshl_add_u32 v15, v14, 4, v15
v_mov_b32 v32, 0x3f803f80
v_mov_b32 v33, 0x3f803f80
v_mov_b32 v34, 0x3f803f80
v_mov_b32 v35, 0x3f803f80
ds_write_b128 v15, v[32:35]
s_add_u32 s20, s82, 26214400
s_addc_u32 s21, s83, 0
s_mov_b32 s22, 16384
s_mov_b32 s23, 0x20000
s_add_u32 s43, s2, 128
s_lshl_b32 s43, s43, 7
v_lshlrev_b32 v14, 2, v1
s_mov_b64 exec, 15
buffer_store_dword v5, v14, s[84:87], s43 offen sc1
s_mov_b64 exec, -1
s_lshl_b32 s43, s34, 4
s_add_u32 s43, s43, s35
s_lshl_b32 s43, s43, 8
s_add_u32 s43, s43, 49152
v_lshlrev_b32 v14, 7, v1
s_mov_b64 exec, 3
buffer_store_dword v5, v14, s[84:87], s43 offen sc1
s_mov_b64 exec, -1
s_lshl_b32 s52, s34, 7
s_add_u32 s52, s52, 28319744
s_sub_u32 s53, s52, 128
s_cmp_eq_u32 s34, 0
s_cselect_b32 s53, s52, s53
s_waitcnt lgkmcnt(0)
s_barrier
s_waitcnt vmcnt(2)
s_mov_b32 s43, 0x3f803f80
v_mov_b32 v116, 0
v_mov_b32 v117, 0
v_mov_b32 v118, 0
v_mov_b32 v119, 0
v_mov_b32 v120, 0
v_mov_b32 v121, 0
v_mov_b32 v122, 0
v_mov_b32 v123, 0
v_dot2_f32_bf16 v116, v96, s43, v116
v_dot2_f32_bf16 v120, v96, v96, v120
v_dot2_f32_bf16 v118, v104, s43, v118
v_dot2_f32_bf16 v122, v104, v104, v122
v_dot2_f32_bf16 v117, v97, s43, v117
v_dot2_f32_bf16 v121, v97, v97, v121
v_dot2_f32_bf16 v119, v105, s43, v119
v_dot2_f32_bf16 v123, v105, v105, v123
v_dot2_f32_bf16 v116, v98, s43, v116
v_dot2_f32_bf16 v120, v98, v98, v120
v_dot2_f32_bf16 v118, v106, s43, v118
v_dot2_f32_bf16 v122, v106, v106, v122
v_dot2_f32_bf16 v117, v99, s43, v117
v_dot2_f32_bf16 v121, v99, v99, v121
v_dot2_f32_bf16 v119, v107, s43, v119
v_dot2_f32_bf16 v123, v107, v107, v123
v_dot2_f32_bf16 v116, v100, s43, v116
v_dot2_f32_bf16 v120, v100, v100, v120
v_dot2_f32_bf16 v118, v108, s43, v118
v_dot2_f32_bf16 v122, v108, v108, v122
v_dot2_f32_bf16 v117, v101, s43, v117
v_dot2_f32_bf16 v121, v101, v101, v121
v_dot2_f32_bf16 v119, v109, s43, v119
v_dot2_f32_bf16 v123, v109, v109, v123
v_dot2_f32_bf16 v116, v102, s43, v116
v_dot2_f32_bf16 v120, v102, v102, v120
v_dot2_f32_bf16 v118, v110, s43, v118
v_dot2_f32_bf16 v122, v110, v110, v122
v_dot2_f32_bf16 v117, v103, s43, v117
v_dot2_f32_bf16 v121, v103, v103, v121
v_dot2_f32_bf16 v119, v111, s43, v119
v_dot2_f32_bf16 v123, v111, v111, v123
s_nop 2
v_add_f32 v116, v116, v117
v_add_f32 v118, v118, v119
v_add_f32 v120, v120, v121
v_add_f32 v122, v122, v123
s_nop 1
v_permlane32_swap_b32 v116, v118
v_permlane32_swap_b32 v120, v122
v_add_f32 v116, v116, v118
v_add_f32 v120, v120, v122
s_nop 1
v_permlane16_swap_b32 v116, v120
v_add_f32 v116, v116, v120
s_nop 1
v_add_f32_dpp v116, v116, v116 row_ror:8 row_mask:0xf bank_mask:0xf
s_nop 1
v_add_f32_dpp v116, v116, v116 row_ror:4 row_mask:0xf bank_mask:0xf
s_nop 1
v_add_f32_dpp v116, v116, v116 row_ror:2 row_mask:0xf bank_mask:0xf
s_nop 1
v_add_f32_dpp v116, v116, v116 row_ror:1 row_mask:0xf bank_mask:0xf
v_mov_b32 v117, v116
s_nop 1
v_permlane16_swap_b32 v116, v117
v_mul_f32 v112, 0x3a800000, v116
v_mul_f32 v113, 0x3a800000, v117
v_fma_f32 v113, -v112, v112, v113
v_max_f32 v113, 0, v113
v_add_f32 v113, 0x3727c5ac, v113
v_rsq_f32 v113, v113
v_lshrrev_b32 v11, 5, v1
s_lshl_b32 s43, s47, 4
s_add_u32 s43, s43, 148608
v_lshl_add_u32 v11, v11, 3, s43
ds_write_b64 v11, v[112:113]
s_waitcnt lgkmcnt(0)
s_mov_b32 s28, s66
s_mov_b32 s29, s67
s_mov_b32 s30, 6291456
s_mov_b32 s31, 0x20000
s_mul_i32 s43, s33, 7040
s_add_u32 s43, s43, 1179648
v_lshlrev_b32 v30, 7, v1
s_bfm_b64 exec, 55, 0
buffer_load_dword v31, v30, s[28:31], s43 offen
s_mov_b64 exec, -1
s_branch Lst_0_0
Lwr_145:
s_barrier
v_lshlrev_b32 v5, 4, v1
v_and_b32 v5, 63, v5
v_add_u32 v6, 148608, v5
ds_read_b128 v[112:115], v6
s_lshl_b32 s43, s63, 3
v_add_u32 v5, s43, v5
s_waitcnt lgkmcnt(0)
s_mov_b64 exec, 15
buffer_store_dwordx4 v[112:115], v5, s[20:23], 0 offen sc1
s_mov_b64 exec, -1
v_mov_b32 v4, 0
buffer_load_dword v6, v4, s[56:59], 0 offen sc1
s_mov_b32 s62, 0
s_mov_b32 s28, s66
s_mov_b32 s29, s67
s_mov_b32 s30, 6291456
s_mov_b32 s31, 0x20000
s_mul_i32 s43, s33, 15872
s_add_u32 s43, s43, 2752512
v_lshlrev_b32 v30, 7, v1
buffer_load_dword v31, v30, s[28:31], s43 offen
s_add_u32 s43, s43, 8192
s_bfm_b64 exec, 60, 0
buffer_load_dword v31, v30, s[28:31], s43 offen
s_mov_b64 exec, -1
s_lshl_b32 s43, s35, 7
s_add_u32 s28, s68, s43
s_addc_u32 s29, s69, 0
s_mov_b32 s30, 2095232
s_mov_b32 s31, 0x20000
v_and_b32 v29, 7, v1
v_lshrrev_b32 v30, 3, v1
v_lshl_add_u32 v29, v30, 6, v29
s_lshl_b32 s43, s48, 3
v_add_u32 v29, s43, v29
v_lshlrev_b32 v29, 11, v29
s_mov_b32 s43, 1048576
s_mov_b32 s28, s68
s_mov_b32 s29, s69
s_mov_b32 s30, 2097152
s_mov_b32 s31, 0x20000
s_mul_i32 s43, s33, 9472
v_lshlrev_b32 v30, 7, v1
buffer_load_dword v31, v30, s[28:31], s43 offen
s_add_u32 s43, s43, 8192
s_bfm_b64 exec, 10, 0
buffer_load_dword v31, v30, s[28:31], s43 offen
s_mov_b64 exec, -1
s_branch Lst_1_0
Lwr_146:
s_barrier
s_branch Lst_2_0
Lwr_147:
s_barrier
s_branch Lst_3_0
Lwr_148:
s_barrier
s_branch Lst_4_0
Lwr_149:
s_barrier
s_branch Lst_5_0
Lwr_150:
s_barrier
s_cmp_eq_u32 s62, 3
s_cbranch_scc1 Lste_21
s_cmp_eq_u32 s62, 2
s_cbranch_scc1 Lst2_19
s_cmp_ge_u32 s62, 4
s_cbranch_scc1 Lst4_20
s_cmp_eq_u32 s62, 1
s_cbranch_scc1 Lst1_18
s_waitcnt vmcnt(4)
v_readfirstlane_b32 s54, v6
s_cmp_eq_u32 s54, 0
s_cbranch_scc0 Lrep_22
buffer_load_dword v6, v4, s[56:59], 0 offen sc1
s_branch Lste_21
Lrep_22:
s_add_u32 s7, s34, 64
s_lshl_b32 s7, s7, 7
v_mov_b32 v5, s7
v_mov_b32 v6, 1
s_mov_b64 exec, 1
buffer_atomic_add v6, v5, s[84:87], 0 offen sc1
s_mov_b64 exec, -1
s_mov_b32 s62, 1
s_mov_b32 s54, 0
s_mov_b32 s55, 0
s_branch Lste_21
Lst1_18:
s_and_b32 s43, s54, s55
s_cmp_eq_u32 s43, 16
s_cbranch_scc1 Lg_23
s_load_dword s54, s[82:83], s52 glc
s_load_dword s55, s[82:83], s53 glc
s_branch Lste_21
Lg_23:
v_add_u32 v5, 0, v1
v_min_u32 v5, 143, v5
v_lshlrev_b32 v20, 3, v5
v_add_u32 v5, s50, v5
v_max_i32 v5, 0, v5
v_lshlrev_b32 v5, 3, v5
buffer_load_dwordx2 v[32:33], v5, s[20:23], 0 offen sc1
v_add_u32 v5, 64, v1
v_min_u32 v5, 143, v5
v_lshlrev_b32 v21, 3, v5
v_add_u32 v5, s50, v5
v_max_i32 v5, 0, v5
v_lshlrev_b32 v5, 3, v5
buffer_load_dwordx2 v[34:35], v5, s[20:23], 0 offen sc1
v_add_u32 v5, 128, v1
v_min_u32 v5, 143, v5
v_lshlrev_b32 v22, 3, v5
v_add_u32 v5, s50, v5
v_max_i32 v5, 0, v5
v_lshlrev_b32 v5, 3, v5
buffer_load_dwordx2 v[36:37], v5, s[20:23], 0 offen sc1
s_mov_b32 s62, 4
s_branch Lste_21
Lst4_20:
s_mov_b32 s62, 2
s_branch Lste_21
Lst2_19:
s_waitcnt vmcnt(0)
v_add_u32 v20, 147456, v20
ds_write_b64 v20, v[32:33]
v_add_u32 v21, 147456, v21
ds_write_b64 v21, v[34:35]
v_add_u32 v22, 147456, v22
ds_write_b64 v22, v[36:37]
s_waitcnt lgkmcnt(0)
s_mov_b32 s62, 3
Lste_21:
s_branch Lst_6_0
Lwr_151:
s_barrier
s_cmp_eq_u32 s62, 3
s_cbranch_scc1 Lste_27
s_cmp_eq_u32 s62, 2
s_cbranch_scc1 Lst2_25
s_cmp_ge_u32 s62, 4
s_cbranch_scc1 Lst4_26
s_cmp_eq_u32 s62, 1
s_cbranch_scc1 Lst1_24
s_waitcnt vmcnt(0)
v_readfirstlane_b32 s54, v6
s_cmp_eq_u32 s54, 0
s_cbranch_scc0 Lrep_28
buffer_load_dword v6, v4, s[56:59], 0 offen sc1
s_branch Lste_27
Lrep_28:
s_add_u32 s7, s34, 64
s_lshl_b32 s7, s7, 7
v_mov_b32 v5, s7
v_mov_b32 v6, 1
s_mov_b64 exec, 1
buffer_atomic_add v6, v5, s[84:87], 0 offen sc1
s_mov_b64 exec, -1
s_mov_b32 s62, 1
s_mov_b32 s54, 0
s_mov_b32 s55, 0
s_branch Lste_27
Lst1_24:
s_and_b32 s43, s54, s55
s_cmp_eq_u32 s43, 16
s_cbranch_scc1 Lg_29
s_load_dword s54, s[82:83], s52 glc
s_load_dword s55, s[82:83], s53 glc
s_branch Lste_27
Lg_29:
v_add_u32 v5, 0, v1
v_min_u32 v5, 143, v5
v_lshlrev_b32 v20, 3, v5
v_add_u32 v5, s50, v5
v_max_i32 v5, 0, v5
v_lshlrev_b32 v5, 3, v5
buffer_load_dwordx2 v[32:33], v5, s[20:23], 0 offen sc1
v_add_u32 v5, 64, v1
v_min_u32 v5, 143, v5
v_lshlrev_b32 v21, 3, v5
v_add_u32 v5, s50, v5
v_max_i32 v5, 0, v5
v_lshlrev_b32 v5, 3, v5
buffer_load_dwordx2 v[34:35], v5, s[20:23], 0 offen sc1
v_add_u32 v5, 128, v1
v_min_u32 v5, 143, v5
v_lshlrev_b32 v22, 3, v5
v_add_u32 v5, s50, v5
v_max_i32 v5, 0, v5
v_lshlrev_b32 v5, 3, v5
buffer_load_dwordx2 v[36:37], v5, s[20:23], 0 offen sc1
s_mov_b32 s62, 4
s_branch Lste_27
Lst4_26:
s_mov_b32 s62, 2
s_branch Lste_27
Lst2_25:
s_waitcnt vmcnt(0)
v_add_u32 v20, 147456, v20
ds_write_b64 v20, v[32:33]
v_add_u32 v21, 147456, v21
ds_write_b64 v21, v[34:35]
v_add_u32 v22, 147456, v22
ds_write_b64 v22, v[36:37]
s_waitcnt lgkmcnt(0)
s_mov_b32 s62, 3
Lste_27:
s_branch Lst_7_0
Lwr_152:
s_barrier
s_cmp_eq_u32 s62, 3
s_cbranch_scc1 Lste_33
s_cmp_eq_u32 s62, 2
s_cbranch_scc1 Lst2_31
s_cmp_ge_u32 s62, 4
s_cbranch_scc1 Lst4_32
s_cmp_eq_u32 s62, 1
s_cbranch_scc1 Lst1_30
s_waitcnt vmcnt(0)
v_readfirstlane_b32 s54, v6
s_cmp_eq_u32 s54, 0
s_cbranch_scc0 Lrep_34
buffer_load_dword v6, v4, s[56:59], 0 offen sc1
s_branch Lste_33
Lrep_34:
s_add_u32 s7, s34, 64
s_lshl_b32 s7, s7, 7
v_mov_b32 v5, s7
v_mov_b32 v6, 1
s_mov_b64 exec, 1
buffer_atomic_add v6, v5, s[84:87], 0 offen sc1
s_mov_b64 exec, -1
s_mov_b32 s62, 1
s_mov_b32 s54, 0
s_mov_b32 s55, 0
s_branch Lste_33
Lst1_30:
s_and_b32 s43, s54, s55
s_cmp_eq_u32 s43, 16
s_cbranch_scc1 Lg_35
s_load_dword s54, s[82:83], s52 glc
s_load_dword s55, s[82:83], s53 glc
s_branch Lste_33
Lg_35:
v_add_u32 v5, 0, v1
v_min_u32 v5, 143, v5
v_lshlrev_b32 v20, 3, v5
v_add_u32 v5, s50, v5
v_max_i32 v5, 0, v5
v_lshlrev_b32 v5, 3, v5
buffer_load_dwordx2 v[32:33], v5, s[20:23], 0 offen sc1
v_add_u32 v5, 64, v1
v_min_u32 v5, 143, v5
v_lshlrev_b32 v21, 3, v5
v_add_u32 v5, s50, v5
v_max_i32 v5, 0, v5
v_lshlrev_b32 v5, 3, v5
buffer_load_dwordx2 v[34:35], v5, s[20:23], 0 offen sc1
v_add_u32 v5, 128, v1
v_min_u32 v5, 143, v5
v_lshlrev_b32 v22, 3, v5
v_add_u32 v5, s50, v5
v_max_i32 v5, 0, v5
v_lshlrev_b32 v5, 3, v5
buffer_load_dwordx2 v[36:37], v5, s[20:23], 0 offen sc1
s_mov_b32 s62, 4
s_branch Lste_33
Lst4_32:
s_mov_b32 s62, 2
s_branch Lste_33
Lst2_31:
s_waitcnt vmcnt(0)
v_add_u32 v20, 147456, v20
ds_write_b64 v20, v[32:33]
v_add_u32 v21, 147456, v21
ds_write_b64 v21, v[34:35]
v_add_u32 v22, 147456, v22
ds_write_b64 v22, v[36:37]
s_waitcnt lgkmcnt(0)
s_mov_b32 s62, 3
Lste_33:
s_branch Lst_8_0
Lwr_153:
s_barrier
s_cmp_eq_u32 s62, 3
s_cbranch_scc1 Lste_39
s_cmp_eq_u32 s62, 2
s_cbranch_scc1 Lst2_37
s_cmp_ge_u32 s62, 4
s_cbranch_scc1 Lst4_38
s_cmp_eq_u32 s62, 1
s_cbranch_scc1 Lst1_36
s_waitcnt vmcnt(0)
v_readfirstlane_b32 s54, v6
s_cmp_eq_u32 s54, 0
s_cbranch_scc0 Lrep_40
buffer_load_dword v6, v4, s[56:59], 0 offen sc1
s_branch Lste_39
Lrep_40:
s_add_u32 s7, s34, 64
s_lshl_b32 s7, s7, 7
v_mov_b32 v5, s7
v_mov_b32 v6, 1
s_mov_b64 exec, 1
buffer_atomic_add v6, v5, s[84:87], 0 offen sc1
s_mov_b64 exec, -1
s_mov_b32 s62, 1
s_mov_b32 s54, 0
s_mov_b32 s55, 0
s_branch Lste_39
Lst1_36:
s_and_b32 s43, s54, s55
s_cmp_eq_u32 s43, 16
s_cbranch_scc1 Lg_41
s_load_dword s54, s[82:83], s52 glc
s_load_dword s55, s[82:83], s53 glc
s_branch Lste_39
Lg_41:
v_add_u32 v5, 0, v1
v_min_u32 v5, 143, v5
v_lshlrev_b32 v20, 3, v5
v_add_u32 v5, s50, v5
v_max_i32 v5, 0, v5
v_lshlrev_b32 v5, 3, v5
buffer_load_dwordx2 v[32:33], v5, s[20:23], 0 offen sc1
v_add_u32 v5, 64, v1
v_min_u32 v5, 143, v5
v_lshlrev_b32 v21, 3, v5
v_add_u32 v5, s50, v5
v_max_i32 v5, 0, v5
v_lshlrev_b32 v5, 3, v5
buffer_load_dwordx2 v[34:35], v5, s[20:23], 0 offen sc1
v_add_u32 v5, 128, v1
v_min_u32 v5, 143, v5
v_lshlrev_b32 v22, 3, v5
v_add_u32 v5, s50, v5
v_max_i32 v5, 0, v5
v_lshlrev_b32 v5, 3, v5
buffer_load_dwordx2 v[36:37], v5, s[20:23], 0 offen sc1
s_mov_b32 s62, 4
s_branch Lste_39
Lst4_38:
s_mov_b32 s62, 2
s_branch Lste_39
Lst2_37:
s_waitcnt vmcnt(0)
v_add_u32 v20, 147456, v20
ds_write_b64 v20, v[32:33]
v_add_u32 v21, 147456, v21
ds_write_b64 v21, v[34:35]
v_add_u32 v22, 147456, v22
ds_write_b64 v22, v[36:37]
s_waitcnt lgkmcnt(0)
s_mov_b32 s62, 3
Lste_39:
s_branch Lst_9_0
Lwr_154:
s_barrier
s_cmp_eq_u32 s62, 3
s_cbranch_scc1 Lste_45
s_cmp_eq_u32 s62, 2
s_cbranch_scc1 Lst2_43
s_cmp_ge_u32 s62, 4
s_cbranch_scc1 Lst4_44
s_cmp_eq_u32 s62, 1
s_cbranch_scc1 Lst1_42
s_waitcnt vmcnt(0)
v_readfirstlane_b32 s54, v6
s_cmp_eq_u32 s54, 0
s_cbranch_scc0 Lrep_46
buffer_load_dword v6, v4, s[56:59], 0 offen sc1
s_branch Lste_45
Lrep_46:
s_add_u32 s7, s34, 64
s_lshl_b32 s7, s7, 7
v_mov_b32 v5, s7
v_mov_b32 v6, 1
s_mov_b64 exec, 1
buffer_atomic_add v6, v5, s[84:87], 0 offen sc1
s_mov_b64 exec, -1
s_mov_b32 s62, 1
s_mov_b32 s54, 0
s_mov_b32 s55, 0
s_branch Lste_45
Lst1_42:
s_and_b32 s43, s54, s55
s_cmp_eq_u32 s43, 16
s_cbranch_scc1 Lg_47
s_load_dword s54, s[82:83], s52 glc
s_load_dword s55, s[82:83], s53 glc
s_branch Lste_45
Lg_47:
v_add_u32 v5, 0, v1
v_min_u32 v5, 143, v5
v_lshlrev_b32 v20, 3, v5
v_add_u32 v5, s50, v5
v_max_i32 v5, 0, v5
v_lshlrev_b32 v5, 3, v5
buffer_load_dwordx2 v[32:33], v5, s[20:23], 0 offen sc1
v_add_u32 v5, 64, v1
v_min_u32 v5, 143, v5
v_lshlrev_b32 v21, 3, v5
v_add_u32 v5, s50, v5
v_max_i32 v5, 0, v5
v_lshlrev_b32 v5, 3, v5
buffer_load_dwordx2 v[34:35], v5, s[20:23], 0 offen sc1
v_add_u32 v5, 128, v1
v_min_u32 v5, 143, v5
v_lshlrev_b32 v22, 3, v5
v_add_u32 v5, s50, v5
v_max_i32 v5, 0, v5
v_lshlrev_b32 v5, 3, v5
buffer_load_dwordx2 v[36:37], v5, s[20:23], 0 offen sc1
s_mov_b32 s62, 4
s_branch Lste_45
Lst4_44:
s_mov_b32 s62, 2
s_branch Lste_45
Lst2_43:
s_waitcnt vmcnt(0)
v_add_u32 v20, 147456, v20
ds_write_b64 v20, v[32:33]
v_add_u32 v21, 147456, v21
ds_write_b64 v21, v[34:35]
v_add_u32 v22, 147456, v22
ds_write_b64 v22, v[36:37]
s_waitcnt lgkmcnt(0)
s_mov_b32 s62, 3
Lste_45:
s_branch Lst_10_0
Lwr_155:
s_barrier
s_cmp_eq_u32 s62, 3
s_cbranch_scc1 Lste_51
s_cmp_eq_u32 s62, 2
s_cbranch_scc1 Lst2_49
s_cmp_ge_u32 s62, 4
s_cbranch_scc1 Lst4_50
s_cmp_eq_u32 s62, 1
s_cbranch_scc1 Lst1_48
s_waitcnt vmcnt(0)
v_readfirstlane_b32 s54, v6
s_cmp_eq_u32 s54, 0
s_cbranch_scc0 Lrep_52
buffer_load_dword v6, v4, s[56:59], 0 offen sc1
s_branch Lste_51
Lrep_52:
s_add_u32 s7, s34, 64
s_lshl_b32 s7, s7, 7
v_mov_b32 v5, s7
v_mov_b32 v6, 1
s_mov_b64 exec, 1
buffer_atomic_add v6, v5, s[84:87], 0 offen sc1
s_mov_b64 exec, -1
s_mov_b32 s62, 1
s_mov_b32 s54, 0
s_mov_b32 s55, 0
s_branch Lste_51
Lst1_48:
s_and_b32 s43, s54, s55
s_cmp_eq_u32 s43, 16
s_cbranch_scc1 Lg_53
s_load_dword s54, s[82:83], s52 glc
s_load_dword s55, s[82:83], s53 glc
s_branch Lste_51
Lg_53:
v_add_u32 v5, 0, v1
v_min_u32 v5, 143, v5
v_lshlrev_b32 v20, 3, v5
v_add_u32 v5, s50, v5
v_max_i32 v5, 0, v5
v_lshlrev_b32 v5, 3, v5
buffer_load_dwordx2 v[32:33], v5, s[20:23], 0 offen sc1
v_add_u32 v5, 64, v1
v_min_u32 v5, 143, v5
v_lshlrev_b32 v21, 3, v5
v_add_u32 v5, s50, v5
v_max_i32 v5, 0, v5
v_lshlrev_b32 v5, 3, v5
buffer_load_dwordx2 v[34:35], v5, s[20:23], 0 offen sc1
v_add_u32 v5, 128, v1
v_min_u32 v5, 143, v5
v_lshlrev_b32 v22, 3, v5
v_add_u32 v5, s50, v5
v_max_i32 v5, 0, v5
v_lshlrev_b32 v5, 3, v5
buffer_load_dwordx2 v[36:37], v5, s[20:23], 0 offen sc1
s_mov_b32 s62, 4
s_branch Lste_51
Lst4_50:
s_mov_b32 s62, 2
s_branch Lste_51
Lst2_49:
s_waitcnt vmcnt(0)
v_add_u32 v20, 147456, v20
ds_write_b64 v20, v[32:33]
v_add_u32 v21, 147456, v21
ds_write_b64 v21, v[34:35]
v_add_u32 v22, 147456, v22
ds_write_b64 v22, v[36:37]
s_waitcnt lgkmcnt(0)
s_mov_b32 s62, 3
Lste_51:
s_branch Lst_11_0
Lwr_156:
s_barrier
s_cmp_eq_u32 s62, 3
s_cbranch_scc1 Lste_57
s_cmp_eq_u32 s62, 2
s_cbranch_scc1 Lst2_55
s_cmp_ge_u32 s62, 4
s_cbranch_scc1 Lst4_56
s_cmp_eq_u32 s62, 1
s_cbranch_scc1 Lst1_54
s_waitcnt vmcnt(0)
v_readfirstlane_b32 s54, v6
s_cmp_eq_u32 s54, 0
s_cbranch_scc0 Lrep_58
buffer_load_dword v6, v4, s[56:59], 0 offen sc1
s_branch Lste_57
Lrep_58:
s_add_u32 s7, s34, 64
s_lshl_b32 s7, s7, 7
v_mov_b32 v5, s7
v_mov_b32 v6, 1
s_mov_b64 exec, 1
buffer_atomic_add v6, v5, s[84:87], 0 offen sc1
s_mov_b64 exec, -1
s_mov_b32 s62, 1
s_mov_b32 s54, 0
s_mov_b32 s55, 0
s_branch Lste_57
Lst1_54:
s_and_b32 s43, s54, s55
s_cmp_eq_u32 s43, 16
s_cbranch_scc1 Lg_59
s_load_dword s54, s[82:83], s52 glc
s_load_dword s55, s[82:83], s53 glc
s_branch Lste_57
Lg_59:
v_add_u32 v5, 0, v1
v_min_u32 v5, 143, v5
v_lshlrev_b32 v20, 3, v5
v_add_u32 v5, s50, v5
v_max_i32 v5, 0, v5
v_lshlrev_b32 v5, 3, v5
buffer_load_dwordx2 v[32:33], v5, s[20:23], 0 offen sc1
v_add_u32 v5, 64, v1
v_min_u32 v5, 143, v5
v_lshlrev_b32 v21, 3, v5
v_add_u32 v5, s50, v5
v_max_i32 v5, 0, v5
v_lshlrev_b32 v5, 3, v5
buffer_load_dwordx2 v[34:35], v5, s[20:23], 0 offen sc1
v_add_u32 v5, 128, v1
v_min_u32 v5, 143, v5
v_lshlrev_b32 v22, 3, v5
v_add_u32 v5, s50, v5
v_max_i32 v5, 0, v5
v_lshlrev_b32 v5, 3, v5
buffer_load_dwordx2 v[36:37], v5, s[20:23], 0 offen sc1
s_mov_b32 s62, 4
s_branch Lste_57
Lst4_56:
s_mov_b32 s62, 2
s_branch Lste_57
Lst2_55:
s_waitcnt vmcnt(0)
v_add_u32 v20, 147456, v20
ds_write_b64 v20, v[32:33]
v_add_u32 v21, 147456, v21
ds_write_b64 v21, v[34:35]
v_add_u32 v22, 147456, v22
ds_write_b64 v22, v[36:37]
s_waitcnt lgkmcnt(0)
s_mov_b32 s62, 3
Lste_57:
s_branch Lst_12_0
Lwr_157:
s_barrier
s_cmp_eq_u32 s62, 3
s_cbranch_scc1 Lste_63
s_cmp_eq_u32 s62, 2
s_cbranch_scc1 Lst2_61
s_cmp_ge_u32 s62, 4
s_cbranch_scc1 Lst4_62
s_cmp_eq_u32 s62, 1
s_cbranch_scc1 Lst1_60
s_waitcnt vmcnt(0)
v_readfirstlane_b32 s54, v6
s_cmp_eq_u32 s54, 0
s_cbranch_scc0 Lrep_64
buffer_load_dword v6, v4, s[56:59], 0 offen sc1
s_branch Lste_63
Lrep_64:
s_add_u32 s7, s34, 64
s_lshl_b32 s7, s7, 7
v_mov_b32 v5, s7
v_mov_b32 v6, 1
s_mov_b64 exec, 1
buffer_atomic_add v6, v5, s[84:87], 0 offen sc1
s_mov_b64 exec, -1
s_mov_b32 s62, 1
s_mov_b32 s54, 0
s_mov_b32 s55, 0
s_branch Lste_63
Lst1_60:
s_and_b32 s43, s54, s55
s_cmp_eq_u32 s43, 16
s_cbranch_scc1 Lg_65
s_load_dword s54, s[82:83], s52 glc
s_load_dword s55, s[82:83], s53 glc
s_branch Lste_63
Lg_65:
v_add_u32 v5, 0, v1
v_min_u32 v5, 143, v5
v_lshlrev_b32 v20, 3, v5
v_add_u32 v5, s50, v5
v_max_i32 v5, 0, v5
v_lshlrev_b32 v5, 3, v5
buffer_load_dwordx2 v[32:33], v5, s[20:23], 0 offen sc1
v_add_u32 v5, 64, v1
v_min_u32 v5, 143, v5
v_lshlrev_b32 v21, 3, v5
v_add_u32 v5, s50, v5
v_max_i32 v5, 0, v5
v_lshlrev_b32 v5, 3, v5
buffer_load_dwordx2 v[34:35], v5, s[20:23], 0 offen sc1
v_add_u32 v5, 128, v1
v_min_u32 v5, 143, v5
v_lshlrev_b32 v22, 3, v5
v_add_u32 v5, s50, v5
v_max_i32 v5, 0, v5
v_lshlrev_b32 v5, 3, v5
buffer_load_dwordx2 v[36:37], v5, s[20:23], 0 offen sc1
s_mov_b32 s62, 4
s_branch Lste_63
Lst4_62:
s_mov_b32 s62, 2
s_branch Lste_63
Lst2_61:
s_waitcnt vmcnt(0)
v_add_u32 v20, 147456, v20
ds_write_b64 v20, v[32:33]
v_add_u32 v21, 147456, v21
ds_write_b64 v21, v[34:35]
v_add_u32 v22, 147456, v22
ds_write_b64 v22, v[36:37]
s_waitcnt lgkmcnt(0)
s_mov_b32 s62, 3
Lste_63:
s_branch Lst_13_0
Lwr_158:
s_barrier
s_cmp_eq_u32 s62, 3
s_cbranch_scc1 Lste_69
s_cmp_eq_u32 s62, 2
s_cbranch_scc1 Lst2_67
s_cmp_ge_u32 s62, 4
s_cbranch_scc1 Lst4_68
s_cmp_eq_u32 s62, 1
s_cbranch_scc1 Lst1_66
s_waitcnt vmcnt(0)
v_readfirstlane_b32 s54, v6
s_cmp_eq_u32 s54, 0
s_cbranch_scc0 Lrep_70
buffer_load_dword v6, v4, s[56:59], 0 offen sc1
s_branch Lste_69
Lrep_70:
s_add_u32 s7, s34, 64
s_lshl_b32 s7, s7, 7
v_mov_b32 v5, s7
v_mov_b32 v6, 1
s_mov_b64 exec, 1
buffer_atomic_add v6, v5, s[84:87], 0 offen sc1
s_mov_b64 exec, -1
s_mov_b32 s62, 1
s_mov_b32 s54, 0
s_mov_b32 s55, 0
s_branch Lste_69
Lst1_66:
s_and_b32 s43, s54, s55
s_cmp_eq_u32 s43, 16
s_cbranch_scc1 Lg_71
s_load_dword s54, s[82:83], s52 glc
s_load_dword s55, s[82:83], s53 glc
s_branch Lste_69
Lg_71:
v_add_u32 v5, 0, v1
v_min_u32 v5, 143, v5
v_lshlrev_b32 v20, 3, v5
v_add_u32 v5, s50, v5
v_max_i32 v5, 0, v5
v_lshlrev_b32 v5, 3, v5
buffer_load_dwordx2 v[32:33], v5, s[20:23], 0 offen sc1
v_add_u32 v5, 64, v1
v_min_u32 v5, 143, v5
v_lshlrev_b32 v21, 3, v5
v_add_u32 v5, s50, v5
v_max_i32 v5, 0, v5
v_lshlrev_b32 v5, 3, v5
buffer_load_dwordx2 v[34:35], v5, s[20:23], 0 offen sc1
v_add_u32 v5, 128, v1
v_min_u32 v5, 143, v5
v_lshlrev_b32 v22, 3, v5
v_add_u32 v5, s50, v5
s_branch Lov_4
.p2align 12
.fill 32, 4, 0xbf800000
Lst_4_0:
s_branch Lwr_149
s_nop 0
s_nop 0
Lov_4:
v_max_i32 v5, 0, v5
v_lshlrev_b32 v5, 3, v5
buffer_load_dwordx2 v[36:37], v5, s[20:23], 0 offen sc1
s_mov_b32 s62, 4
s_branch Lste_69
Lst4_68:
s_mov_b32 s62, 2
s_branch Lste_69
Lst2_67:
s_waitcnt vmcnt(0)
v_add_u32 v20, 147456, v20
ds_write_b64 v20, v[32:33]
v_add_u32 v21, 147456, v21
ds_write_b64 v21, v[34:35]
v_add_u32 v22, 147456, v22
ds_write_b64 v22, v[36:37]
s_waitcnt lgkmcnt(0)
s_mov_b32 s62, 3
Lste_69:
s_branch Lst_14_0
Lwr_159:
s_barrier
s_cmp_eq_u32 s62, 3
s_cbranch_scc1 Lste_74
s_cmp_ge_u32 s62, 5
s_cbranch_scc1 Lg_79
s_cmp_ge_u32 s62, 2
s_cbranch_scc1 Lst2_73
s_cmp_eq_u32 s62, 1
s_cbranch_scc1 Lst1_72
s_mov_b32 s41, 0x40000
Lz0_75:
s_waitcnt vmcnt(0)
v_readfirstlane_b32 s54, v6
s_cmp_eq_u32 s54, 0
s_cbranch_scc0 Lzok_76
buffer_load_dword v6, v4, s[56:59], 0 offen sc1
s_sub_u32 s41, s41, 1
s_cmp_lg_u32 s41, 0
s_cbranch_scc1 Lz0_75
s_waitcnt lgkmcnt(0)
Lzok_76:
s_add_u32 s7, s34, 64
s_lshl_b32 s7, s7, 7
v_mov_b32 v5, s7
v_mov_b32 v6, 1
s_mov_b64 exec, 1
buffer_atomic_add v6, v5, s[84:87], 0 offen sc1
s_mov_b64 exec, -1
Lst1_72:
s_load_dword s54, s[82:83], s52 glc
s_load_dword s55, s[82:83], s53 glc
s_mov_b32 s41, 0x40000
Lpoll_77:
s_waitcnt lgkmcnt(0)
s_and_b32 s54, s54, s55
s_cmp_eq_u32 s54, 16
s_cbranch_scc1 Lg_79
s_load_dword s54, s[82:83], s52 glc
s_load_dword s55, s[82:83], s53 glc
s_sub_u32 s41, s41, 1
s_cmp_lg_u32 s41, 0
s_cbranch_scc1 Lpoll_77
s_waitcnt lgkmcnt(0)
Lg_79:
v_add_u32 v5, 0, v1
v_min_u32 v5, 143, v5
v_lshlrev_b32 v20, 3, v5
v_add_u32 v5, s50, v5
v_max_i32 v5, 0, v5
v_lshlrev_b32 v5, 3, v5
buffer_load_dwordx2 v[32:33], v5, s[20:23], 0 offen sc1
v_add_u32 v5, 64, v1
v_min_u32 v5, 143, v5
v_lshlrev_b32 v21, 3, v5
v_add_u32 v5, s50, v5
v_max_i32 v5, 0, v5
v_lshlrev_b32 v5, 3, v5
buffer_load_dwordx2 v[34:35], v5, s[20:23], 0 offen sc1
v_add_u32 v5, 128, v1
v_min_u32 v5, 143, v5
v_lshlrev_b32 v22, 3, v5
v_add_u32 v5, s50, v5
v_max_i32 v5, 0, v5
v_lshlrev_b32 v5, 3, v5
buffer_load_dwordx2 v[36:37], v5, s[20:23], 0 offen sc1
Lst2_73:
s_waitcnt vmcnt(0)
v_add_u32 v20, 147456, v20
ds_write_b64 v20, v[32:33]
v_add_u32 v21, 147456, v21
ds_write_b64 v21, v[34:35]
v_add_u32 v22, 147456, v22
ds_write_b64 v22, v[36:37]
s_waitcnt lgkmcnt(0)
Lste_74:
s_bitcmp0_b32 s2, 0
s_cselect_b32 s88, s72, s74
s_cselect_b32 s89, s73, s75
s_cmp_lt_u32 s2, 192
s_cselect_b32 s90, 7340032, 0
s_mov_b32 s91, 0x20000
s_bfe_u32 s44, s2, 0x30001
s_lshl_b32 s44, s44, 2
s_and_b32 s43, s36, 3
s_add_u32 s44, s44, s43
s_lshl_b32 s44, s44, 5
v_lshrrev_b32 v18, 4, v1
v_add_u32 v18, s44, v18
v_mul_u32_u24 v18, 7168, v18
v_and_b32 v19, 15, v1
v_lshl_add_u32 v18, v19, 4, v18
s_lshr_b32 s43, s2, 4
s_lshl_b32 s43, s43, 8
s_add_u32 s43, s43, 4096
v_add_u32 v18, s43, v18
s_mov_b32 s43, 0
buffer_load_dwordx4 v[128:131], v18, s[88:91], s43 offen
s_mov_b32 s43, 28672
buffer_load_dwordx4 v[132:135], v18, s[88:91], s43 offen
s_mov_b32 s43, 57344
buffer_load_dwordx4 v[136:139], v18, s[88:91], s43 offen
s_mov_b32 s43, 86016
buffer_load_dwordx4 v[140:143], v18, s[88:91], s43 offen
s_mov_b32 s43, 114688
buffer_load_dwordx4 v[144:147], v18, s[88:91], s43 offen
s_mov_b32 s43, 143360
buffer_load_dwordx4 v[148:151], v18, s[88:91], s43 offen
s_mov_b32 s43, 172032
buffer_load_dwordx4 v[152:155], v18, s[88:91], s43 offen
s_mov_b32 s43, 200704
buffer_load_dwordx4 v[156:159], v18, s[88:91], s43 offen
s_barrier
s_lshl_b32 s43, s35, 7
s_add_u32 s28, s68, s43
s_addc_u32 s29, s69, 0
s_mov_b32 s30, 2095232
s_mov_b32 s31, 0x20000
v_lshrrev_b32 v15, 3, v1
v_and_b32 v16, 6, v15
v_and_b32 v7, 7, v1
v_xor_b32 v7, v7, v16
v_lshlrev_b32 v7, 4, v7
v_mul_u32_u24 v15, 2048, v15
v_add_u32 v7, v7, v15
s_and_b32 s40, s36, 3
s_lshl_b32 s39, s40, 13
s_add_u32 s40, s40, s35
s_add_u32 s42, s40, 0
s_and_b32 s42, s42, 15
s_lshl_b32 s42, s42, 17
s_add_u32 m0, s39, 65536
s_add_u32 s43, s42, 0
buffer_load_dwordx4 v7, s[28:31], s43 offen lds
s_add_u32 m0, s39, 66560
s_add_u32 s43, s42, 16384
buffer_load_dwordx4 v7, s[28:31], s43 offen lds
s_add_u32 m0, s39, 67584
s_add_u32 s43, s42, 32768
buffer_load_dwordx4 v7, s[28:31], s43 offen lds
s_add_u32 m0, s39, 68608
s_add_u32 s43, s42, 49152
buffer_load_dwordx4 v7, s[28:31], s43 offen lds
s_add_u32 m0, s39, 69632
s_add_u32 s43, s42, 65536
buffer_load_dwordx4 v7, s[28:31], s43 offen lds
s_add_u32 m0, s39, 70656
s_add_u32 s43, s42, 81920
buffer_load_dwordx4 v7, s[28:31], s43 offen lds
s_add_u32 m0, s39, 71680
s_add_u32 s43, s42, 98304
buffer_load_dwordx4 v7, s[28:31], s43 offen lds
s_add_u32 m0, s39, 72704
s_add_u32 s43, s42, 114688
buffer_load_dwordx4 v7, s[28:31], s43 offen lds
Lats_6:
s_and_b32 s43, s36, 1
s_bfe_u32 s44, s36, 0x10001
s_lshr_b32 s45, s36, 2
v_lshlrev_b32 v14, 2, v13
v_sub_u32 v14, v12, v14
v_mov_b32 v16, 0xff800000
s_or_b32 s46, s34, s45
s_cmp_lg_u32 s46, 0
s_cselect_b32 s46, 0, 0xff800000
v_subrev_u32 v15, 0, v14
v_cmp_ge_u32 vcc, 7, v15
v_add_u32 v15, 16, v15
s_nop 0
v_cndmask_b32 v248, v16, 0, vcc
v_cmp_ge_u32 vcc, 7, v15
s_nop 1
v_cndmask_b32 v244, v16, 0, vcc
v_or_b32 v240, s46, v244
v_subrev_u32 v15, 1, v14
v_cmp_ge_u32 vcc, 7, v15
v_add_u32 v15, 16, v15
s_nop 0
v_cndmask_b32 v249, v16, 0, vcc
v_cmp_ge_u32 vcc, 7, v15
s_nop 1
v_cndmask_b32 v245, v16, 0, vcc
v_or_b32 v241, s46, v245
v_subrev_u32 v15, 2, v14
v_cmp_ge_u32 vcc, 7, v15
v_add_u32 v15, 16, v15
s_nop 0
v_cndmask_b32 v250, v16, 0, vcc
v_cmp_ge_u32 vcc, 7, v15
s_nop 1
v_cndmask_b32 v246, v16, 0, vcc
v_or_b32 v242, s46, v246
v_subrev_u32 v15, 3, v14
v_cmp_ge_u32 vcc, 7, v15
v_add_u32 v15, 16, v15
s_nop 0
v_cndmask_b32 v251, v16, 0, vcc
v_cmp_ge_u32 vcc, 7, v15
s_nop 1
v_cndmask_b32 v247, v16, 0, vcc
v_or_b32 v243, s46, v247
s_lshl_b32 s46, s45, 6
s_add_u32 s46, s46, s44
s_add_u32 s46, s46, 16
v_lshl_add_u32 v14, v12, 1, s46
s_lshl_b32 s47, s43, 6
v_lshl_add_u32 v15, v13, 4, s47
v_mul_u32_u24 v20, 400, v14
v_add_u32 v20, v20, v15
v_subrev_u32 v16, 32, v14
v_max_i32 v16, 0, v16
v_mul_u32_u24 v21, 400, v16
v_add_u32 v21, v21, v15
v_lshrrev_b32 v16, 2, v12
v_lshl_add_u32 v16, v13, 2, v16
v_lshl_add_u32 v16, v16, 1, s46
v_and_b32 v17, 3, v1
v_lshl_add_u32 v17, v17, 3, s47
v_mul_u32_u24 v22, 400, v16
v_add_u32 v22, v22, v17
v_subrev_u32 v16, 32, v16
v_max_i32 v16, 0, v16
v_mul_u32_u24 v23, 400, v16
v_add_u32 v23, v23, v17
s_mul_i32 s60, s34, 262144
s_add_u32 s16, s82, s60
s_addc_u32 s17, s83, 0
s_mov_b32 s18, 262144
s_mov_b32 s19, 0x20000
s_lshl_b32 s60, s35, 14
s_lshl_b32 s43, s43, 13
s_add_u32 s60, s60, s43
s_lshl_b32 s43, s45, 12
s_add_u32 s60, s60, s43
s_lshl_b32 s43, s44, 10
s_add_u32 s60, s60, s43
v_lshlrev_b32 v24, 4, v1
s_mov_b32 s61, 0x3e8293ee
s_lshl_b32 s38, s35, 7
Latt_5:
s_barrier
ds_read_b128 v[32:35], v20 offset:0
ds_read_b128 v[36:39], v20 offset:128
ds_read_b128 v[40:43], v21 offset:128
ds_read_b128 v[80:83], v20 offset:12800
ds_read_b128 v[84:87], v20 offset:12928
ds_read_b128 v[88:91], v20 offset:128
ds_read_b64_tr_b16 v[44:45], v23 offset:256
ds_read_b64_tr_b16 v[46:47], v22 offset:256
ds_read_b64_tr_b16 v[48:49], v23 offset:288
ds_read_b64_tr_b16 v[50:51], v22 offset:288
ds_read_b64_tr_b16 v[92:93], v22 offset:256
ds_read_b64_tr_b16 v[94:95], v22 offset:13056
ds_read_b64_tr_b16 v[96:97], v22 offset:288
ds_read_b64_tr_b16 v[98:99], v22 offset:13088
s_waitcnt lgkmcnt(11)
v_mfma_f32_16x16x32_bf16 v[52:55], v[40:43], v[32:35], v[240:243]
v_mfma_f32_16x16x32_bf16 v[56:59], v[36:39], v[32:35], v[248:251]
s_waitcnt lgkmcnt(8)
v_mfma_f32_16x16x32_bf16 v[100:103], v[88:91], v[80:83], v[244:247]
v_mfma_f32_16x16x32_bf16 v[104:107], v[84:87], v[80:83], v[248:251]
s_nop 5
v_max3_f32 v60, v52, v53, v54
v_max3_f32 v108, v100, v101, v102
v_max3_f32 v61, v55, v56, v57
v_max3_f32 v109, v103, v104, v105
v_max3_f32 v60, v60, v58, v59
v_max3_f32 v108, v108, v106, v107
v_max_f32 v60, v60, v61
v_max_f32 v108, v108, v109
s_nop 1
v_permlane32_swap_b32 v60, v108
v_max_f32 v60, v60, v108
v_mov_b32 v61, v60
s_nop 1
v_permlane16_swap_b32 v60, v61
v_max_f32 v60, v60, v61
v_mul_f32 v60, s61, v60
s_nop 0
v_mov_b32 v108, v60
s_nop 1
v_permlane32_swap_b32 v60, v108
v_fma_f32 v52, v52, s61, -v60
v_fma_f32 v100, v100, s61, -v108
v_fma_f32 v53, v53, s61, -v60
v_fma_f32 v101, v101, s61, -v108
v_fma_f32 v54, v54, s61, -v60
v_fma_f32 v102, v102, s61, -v108
v_fma_f32 v55, v55, s61, -v60
v_fma_f32 v103, v103, s61, -v108
v_fma_f32 v56, v56, s61, -v60
v_fma_f32 v104, v104, s61, -v108
v_fma_f32 v57, v57, s61, -v60
v_fma_f32 v105, v105, s61, -v108
v_fma_f32 v58, v58, s61, -v60
v_fma_f32 v106, v106, s61, -v108
v_fma_f32 v59, v59, s61, -v60
v_fma_f32 v107, v107, s61, -v108
v_exp_f32 v52, v52
v_exp_f32 v100, v100
v_exp_f32 v53, v53
v_exp_f32 v101, v101
v_exp_f32 v54, v54
v_exp_f32 v102, v102
v_exp_f32 v55, v55
v_exp_f32 v103, v103
v_exp_f32 v56, v56
v_exp_f32 v104, v104
v_exp_f32 v57, v57
v_exp_f32 v105, v105
v_exp_f32 v58, v58
v_exp_f32 v106, v106
v_exp_f32 v59, v59
v_exp_f32 v107, v107
v_cvt_pk_bf16_f32 v64, v52, v53
v_cvt_pk_bf16_f32 v112, v100, v101
v_cvt_pk_bf16_f32 v65, v54, v55
v_cvt_pk_bf16_f32 v113, v102, v103
v_cvt_pk_bf16_f32 v66, v56, v57
v_cvt_pk_bf16_f32 v114, v104, v105
v_cvt_pk_bf16_f32 v67, v58, v59
v_cvt_pk_bf16_f32 v115, v106, v107
v_pk_add_f32 v[52:53], v[52:53], v[54:55]
v_pk_add_f32 v[100:101], v[100:101], v[102:103]
v_pk_add_f32 v[56:57], v[56:57], v[58:59]
v_pk_add_f32 v[104:105], v[104:105], v[106:107]
s_waitcnt lgkmcnt(0)
s_waitcnt lgkmcnt(0)
v_mfma_f32_16x16x32_bf16 v[68:71], v[44:47], v[64:67], 0
v_mfma_f32_16x16x32_bf16 v[116:119], v[92:95], v[112:115], 0
v_mfma_f32_16x16x32_bf16 v[72:75], v[48:51], v[64:67], 0
v_mfma_f32_16x16x32_bf16 v[120:123], v[96:99], v[112:115], 0
v_pk_add_f32 v[52:53], v[52:53], v[56:57]
v_pk_add_f32 v[100:101], v[100:101], v[104:105]
v_add_f32 v60, v52, v53
v_add_f32 v108, v100, v101
s_nop 1
v_permlane32_swap_b32 v60, v108
v_add_f32 v60, v60, v108
v_mov_b32 v61, v60
s_nop 1
v_permlane16_swap_b32 v60, v61
v_add_f32 v60, v60, v61
v_rcp_f32 v60, v60
s_nop 0
v_mov_b32 v108, v60
s_nop 1
v_permlane32_swap_b32 v60, v108
v_pk_mul_f32 v[68:69], v[60:61], v[68:69] op_sel_hi:[0,1]
v_pk_mul_f32 v[116:117], v[108:109], v[116:117] op_sel_hi:[0,1]
v_pk_mul_f32 v[70:71], v[60:61], v[70:71] op_sel_hi:[0,1]
v_pk_mul_f32 v[118:119], v[108:109], v[118:119] op_sel_hi:[0,1]
v_pk_mul_f32 v[72:73], v[60:61], v[72:73] op_sel_hi:[0,1]
v_pk_mul_f32 v[120:121], v[108:109], v[120:121] op_sel_hi:[0,1]
v_pk_mul_f32 v[74:75], v[60:61], v[74:75] op_sel_hi:[0,1]
v_pk_mul_f32 v[122:123], v[108:109], v[122:123] op_sel_hi:[0,1]
v_cvt_pk_bf16_f32 v64, v68, v69
v_cvt_pk_bf16_f32 v112, v116, v117
v_cvt_pk_bf16_f32 v65, v70, v71
v_cvt_pk_bf16_f32 v113, v118, v119
v_cvt_pk_bf16_f32 v66, v72, v73
v_cvt_pk_bf16_f32 v114, v120, v121
v_cvt_pk_bf16_f32 v67, v74, v75
v_cvt_pk_bf16_f32 v115, v122, v123
buffer_store_dwordx4 v[64:67], v24, s[16:19], s60 offen offset:0 sc1
buffer_store_dwordx4 v[112:115], v24, s[16:19], s60 offen offset:2048 sc1
s_add_u32 s56, s82, 28311552
s_addc_u32 s57, s83, 0
s_mov_b32 s58, 114688
s_mov_b32 s59, 0x20000
s_lshl_b32 s7, s34, 12
s_add_u32 s7, s7, 49152
v_lshl_add_u32 v26, v1, 8, s7
v_mov_b32 v27, 1
s_cmp_ge_u32 s36, 4
s_cbranch_scc1 Lh_81
s_waitcnt vmcnt(0)
s_branch Lo_80
Lh_81:
s_waitcnt vmcnt(0)
Lo_80:
s_cmp_lg_u32 s36, 0
s_barrier
s_cbranch_scc1 Lsig_82
s_mov_b64 exec, 0xffff
buffer_atomic_add v27, v26, s[56:59], 0 offen sc1
s_mov_b64 exec, -1
Lsig_82:
s_cmp_ge_u32 s36, 4
s_cbranch_scc1 Lprod_84
v_and_b32 v12, 15, v1
v_lshrrev_b32 v13, 4, v1
v_lshlrev_b32 v10, 12, v12
v_and_b32 v14, 1, v13
v_lshl_add_u32 v10, v14, 5, v10
v_lshrrev_b32 v14, 1, v13
v_lshl_add_u32 v10, v14, 4, v10
s_lshl_b32 s43, s34, 18
s_lshl_b32 s44, s36, 16
s_add_u32 s43, s43, s44
s_lshl_b32 s44, s35, 7
s_add_u32 s43, s43, s44
buffer_load_dwordx4 v[128:131], v10, s[8:11], s43 offen offset:0
buffer_load_dwordx4 v[132:135], v10, s[8:11], s43 offen offset:64
buffer_load_dwordx4 v[136:139], v10, s[8:11], s43 offen offset:2048
buffer_load_dwordx4 v[140:143], v10, s[8:11], s43 offen offset:2112
v_and_b32 v12, 15, v1
v_lshrrev_b32 v13, 4, v1
s_mul_i32 s43, s34, 262144
s_add_u32 s20, s82, s43
s_addc_u32 s21, s83, 0
s_add_u32 s20, s20, 4194304
s_addc_u32 s21, s21, 0
s_mov_b32 s22, 262144
s_mov_b32 s23, 0x20000
s_mul_i32 s43, s34, 16384
s_add_u32 s24, s82, s43
s_addc_u32 s25, s83, 0
s_add_u32 s24, s24, 25165824
s_addc_u32 s25, s25, 0
s_mov_b32 s26, 16384
s_mov_b32 s27, 0x20000
v_lshlrev_b32 v11, 4, v1
s_lshl_b32 s43, s36, 11
v_add_u32 v2, s43, v11
v_add_u32 v3, 98304, v2
v_lshrrev_b32 v14, 2, v1
v_bfe_u32 v15, v14, 1, 2
v_mul_u32_u24 v14, 128, v14
v_lshl_add_u32 v14, v15, 5, v14
v_and_b32 v15, 3, v1
v_lshl_add_u32 v4, v15, 3, v14
v_xor_b32 v5, 32, v4
v_xor_b32 v6, 64, v4
v_xor_b32 v7, 96, v4
v_add_u32 v16, 0x10000, v4
v_add_u32 v20, 0x20000, v4
v_add_u32 v17, 0x10000, v5
v_add_u32 v21, 0x20000, v5
v_add_u32 v18, 0x10000, v6
v_add_u32 v22, 0x20000, v6
v_add_u32 v19, 0x10000, v7
v_add_u32 v23, 0x20000, v7
s_lshl_b32 s44, s35, 14
s_add_u32 s60, s44, s43
v_lshrrev_b32 v14, 1, v13
v_lshlrev_b32 v14, 11, v14
v_lshl_add_u32 v14, v12, 3, v14
v_and_b32 v15, 1, v13
v_lshl_add_u32 v14, v15, 2, v14
s_lshl_b32 s43, s36, 12
s_lshl_b32 s44, s35, 7
s_add_u32 s43, s43, s44
v_add_u32 v9, s43, v14
s_mov_b32 s61, 0x3f803f80
s_waitcnt vmcnt(0)
v_permlane16_swap_b32 v128, v130
v_permlane16_swap_b32 v129, v131
v_permlane16_swap_b32 v132, v134
v_permlane16_swap_b32 v133, v135
v_permlane16_swap_b32 v136, v138
v_permlane16_swap_b32 v137, v139
v_permlane16_swap_b32 v140, v142
v_permlane16_swap_b32 v141, v143
v_lshlrev_b32 v96, 16, v128
v_and_b32 v97, 0xffff0000, v128
v_lshlrev_b32 v98, 16, v129
v_and_b32 v99, 0xffff0000, v129
v_lshlrev_b32 v100, 16, v130
v_and_b32 v101, 0xffff0000, v130
v_lshlrev_b32 v102, 16, v131
v_and_b32 v103, 0xffff0000, v131
v_lshlrev_b32 v104, 16, v132
v_and_b32 v105, 0xffff0000, v132
v_lshlrev_b32 v106, 16, v133
v_and_b32 v107, 0xffff0000, v133
v_lshlrev_b32 v108, 16, v134
v_and_b32 v109, 0xffff0000, v134
v_lshlrev_b32 v110, 16, v135
v_and_b32 v111, 0xffff0000, v135
v_lshlrev_b32 v112, 16, v136
v_and_b32 v113, 0xffff0000, v136
v_lshlrev_b32 v114, 16, v137
v_and_b32 v115, 0xffff0000, v137
v_lshlrev_b32 v116, 16, v138
v_and_b32 v117, 0xffff0000, v138
v_lshlrev_b32 v118, 16, v139
v_and_b32 v119, 0xffff0000, v139
v_lshlrev_b32 v120, 16, v140
v_and_b32 v121, 0xffff0000, v140
v_lshlrev_b32 v122, 16, v141
v_and_b32 v123, 0xffff0000, v141
v_lshlrev_b32 v124, 16, v142
v_and_b32 v125, 0xffff0000, v142
v_lshlrev_b32 v126, 16, v143
v_and_b32 v127, 0xffff0000, v143
s_cmp_lg_u32 s36, 0
s_cbranch_scc1 Lwm_87
s_nop 0
s_branch Lwe_86
Lwm_87:
s_cmp_lg_u32 s36, 1
s_cbranch_scc1 Lwm_88
s_nop 0
s_branch Lwe_86
Lwm_88:
s_cmp_lg_u32 s36, 2
s_cbranch_scc1 Lwm_89
s_nop 0
s_branch Lwe_86
Lwm_89:
s_cmp_lg_u32 s36, 3
s_cbranch_scc1 Lwm_90
s_nop 0
s_branch Lwe_86
Lwm_90:
Lwe_86:
s_barrier
ds_read_b128 v[32:35], v2 offset:0
ds_read_b64_tr_b16 v[40:41], v16 offset:0
ds_read_b64_tr_b16 v[42:43], v16 offset:2048
ds_read_b64_tr_b16 v[44:45], v17 offset:0
ds_read_b64_tr_b16 v[46:47], v17 offset:2048
ds_read_b64_tr_b16 v[48:49], v18 offset:0
ds_read_b64_tr_b16 v[50:51], v18 offset:2048
ds_read_b64_tr_b16 v[52:53], v19 offset:0
ds_read_b64_tr_b16 v[54:55], v19 offset:2048
ds_read_b128 v[36:39], v2 offset:1024
ds_read_b128 v[56:59], v2 offset:8192
ds_read_b64_tr_b16 v[64:65], v16 offset:4096
ds_read_b64_tr_b16 v[66:67], v16 offset:6144
ds_read_b64_tr_b16 v[68:69], v17 offset:4096
ds_read_b64_tr_b16 v[70:71], v17 offset:6144
ds_read_b64_tr_b16 v[72:73], v18 offset:4096
ds_read_b64_tr_b16 v[74:75], v18 offset:6144
ds_read_b64_tr_b16 v[76:77], v19 offset:4096
ds_read_b64_tr_b16 v[78:79], v19 offset:6144
ds_read_b128 v[60:63], v2 offset:9216
s_waitcnt lgkmcnt(0)
s_barrier
v_mfma_f32_16x16x32_bf16 v[96:99], v[40:43], v[32:35], v[96:99]
ds_read_b128 v[144:147], v2 offset:49152
ds_read_b64_tr_b16 v[152:153], v16 offset:8192
v_mfma_f32_16x16x32_bf16 v[100:103], v[44:47], v[32:35], v[100:103]
ds_read_b64_tr_b16 v[154:155], v16 offset:10240
ds_read_b64_tr_b16 v[156:157], v17 offset:8192
v_mfma_f32_16x16x32_bf16 v[104:107], v[48:51], v[32:35], v[104:107]
ds_read_b64_tr_b16 v[158:159], v17 offset:10240
ds_read_b64_tr_b16 v[160:161], v18 offset:8192
v_mfma_f32_16x16x32_bf16 v[108:111], v[52:55], v[32:35], v[108:111]
ds_read_b64_tr_b16 v[162:163], v18 offset:10240
ds_read_b64_tr_b16 v[164:165], v19 offset:8192
v_mfma_f32_16x16x32_bf16 v[124:127], v[52:55], v[36:39], v[124:127]
ds_read_b64_tr_b16 v[166:167], v19 offset:10240
ds_read_b128 v[148:151], v2 offset:50176
v_mfma_f32_16x16x32_bf16 v[120:123], v[48:51], v[36:39], v[120:123]
ds_read_b128 v[168:171], v2 offset:57344
ds_read_b64_tr_b16 v[176:177], v16 offset:12288
v_mfma_f32_16x16x32_bf16 v[116:119], v[44:47], v[36:39], v[116:119]
ds_read_b64_tr_b16 v[178:179], v16 offset:14336
ds_read_b64_tr_b16 v[180:181], v17 offset:12288
v_mfma_f32_16x16x32_bf16 v[112:115], v[40:43], v[36:39], v[112:115]
ds_read_b64_tr_b16 v[182:183], v17 offset:14336
ds_read_b64_tr_b16 v[184:185], v18 offset:12288
v_mfma_f32_16x16x32_bf16 v[96:99], v[64:67], v[56:59], v[96:99]
ds_read_b64_tr_b16 v[186:187], v18 offset:14336
ds_read_b64_tr_b16 v[188:189], v19 offset:12288
v_mfma_f32_16x16x32_bf16 v[100:103], v[68:71], v[56:59], v[100:103]
ds_read_b64_tr_b16 v[190:191], v19 offset:14336
ds_read_b128 v[172:175], v2 offset:58368
v_mfma_f32_16x16x32_bf16 v[104:107], v[72:75], v[56:59], v[104:107]
s_bitcmp0_b32 s36, 1
v_mfma_f32_16x16x32_bf16 v[108:111], v[76:79], v[56:59], v[108:111]
s_cselect_b32 s44, s72, s74
v_mfma_f32_16x16x32_bf16 v[124:127], v[76:79], v[60:63], v[124:127]
s_cselect_b32 s45, s73, s75
v_mfma_f32_16x16x32_bf16 v[120:123], v[72:75], v[60:63], v[120:123]
s_mul_i32 s43, s35, 192
v_mfma_f32_16x16x32_bf16 v[116:119], v[68:71], v[60:63], v[116:119]
s_add_u32 s16, s44, s43
v_mfma_f32_16x16x32_bf16 v[112:115], v[64:67], v[60:63], v[112:115]
s_addc_u32 s17, s45, 0
s_waitcnt lgkmcnt(0)
s_barrier
v_mfma_f32_16x16x32_bf16 v[96:99], v[152:155], v[144:147], v[96:99]
ds_read_b128 v[32:35], v3 offset:0
ds_read_b64_tr_b16 v[40:41], v16 offset:16384
v_mfma_f32_16x16x32_bf16 v[100:103], v[156:159], v[144:147], v[100:103]
ds_read_b64_tr_b16 v[42:43], v16 offset:18432
ds_read_b64_tr_b16 v[44:45], v17 offset:16384
v_mfma_f32_16x16x32_bf16 v[104:107], v[160:163], v[144:147], v[104:107]
ds_read_b64_tr_b16 v[46:47], v17 offset:18432
ds_read_b64_tr_b16 v[48:49], v18 offset:16384
v_mfma_f32_16x16x32_bf16 v[108:111], v[164:167], v[144:147], v[108:111]
ds_read_b64_tr_b16 v[50:51], v18 offset:18432
ds_read_b64_tr_b16 v[52:53], v19 offset:16384
v_mfma_f32_16x16x32_bf16 v[124:127], v[164:167], v[148:151], v[124:127]
ds_read_b64_tr_b16 v[54:55], v19 offset:18432
ds_read_b128 v[36:39], v3 offset:1024
v_mfma_f32_16x16x32_bf16 v[120:123], v[160:163], v[148:151], v[120:123]
ds_read_b128 v[56:59], v3 offset:8192
ds_read_b64_tr_b16 v[64:65], v16 offset:20480
v_mfma_f32_16x16x32_bf16 v[116:119], v[156:159], v[148:151], v[116:119]
ds_read_b64_tr_b16 v[66:67], v16 offset:22528
ds_read_b64_tr_b16 v[68:69], v17 offset:20480
v_mfma_f32_16x16x32_bf16 v[112:115], v[152:155], v[148:151], v[112:115]
ds_read_b64_tr_b16 v[70:71], v17 offset:22528
ds_read_b64_tr_b16 v[72:73], v18 offset:20480
v_mfma_f32_16x16x32_bf16 v[96:99], v[176:179], v[168:171], v[96:99]
ds_read_b64_tr_b16 v[74:75], v18 offset:22528
ds_read_b64_tr_b16 v[76:77], v19 offset:20480
v_mfma_f32_16x16x32_bf16 v[100:103], v[180:183], v[168:171], v[100:103]
ds_read_b64_tr_b16 v[78:79], v19 offset:22528
ds_read_b128 v[60:63], v3 offset:9216
v_mfma_f32_16x16x32_bf16 v[104:107], v[184:187], v[168:171], v[104:107]
s_add_u32 s16, s16, 4096
v_mfma_f32_16x16x32_bf16 v[108:111], v[188:191], v[168:171], v[108:111]
s_addc_u32 s17, s17, 0
v_mfma_f32_16x16x32_bf16 v[124:127], v[188:191], v[172:175], v[124:127]
s_mov_b32 s18, 7333056
v_mfma_f32_16x16x32_bf16 v[120:123], v[184:187], v[172:175], v[120:123]
s_mov_b32 s19, 0x20000
v_mfma_f32_16x16x32_bf16 v[116:119], v[180:183], v[172:175], v[116:119]
s_and_b32 s43, s36, 1
v_mfma_f32_16x16x32_bf16 v[112:115], v[176:179], v[172:175], v[112:115]
s_mul_i32 s43, s43, 229376
s_waitcnt lgkmcnt(0)
s_barrier
v_mfma_f32_16x16x32_bf16 v[96:99], v[40:43], v[32:35], v[96:99]
ds_read_b128 v[144:147], v3 offset:49152
ds_read_b64_tr_b16 v[152:153], v16 offset:24576
v_mfma_f32_16x16x32_bf16 v[100:103], v[44:47], v[32:35], v[100:103]
ds_read_b64_tr_b16 v[154:155], v16 offset:26624
ds_read_b64_tr_b16 v[156:157], v17 offset:24576
v_mfma_f32_16x16x32_bf16 v[104:107], v[48:51], v[32:35], v[104:107]
ds_read_b64_tr_b16 v[158:159], v17 offset:26624
ds_read_b64_tr_b16 v[160:161], v18 offset:24576
v_mfma_f32_16x16x32_bf16 v[108:111], v[52:55], v[32:35], v[108:111]
ds_read_b64_tr_b16 v[162:163], v18 offset:26624
ds_read_b64_tr_b16 v[164:165], v19 offset:24576
v_mfma_f32_16x16x32_bf16 v[124:127], v[52:55], v[36:39], v[124:127]
ds_read_b64_tr_b16 v[166:167], v19 offset:26624
ds_read_b128 v[148:151], v3 offset:50176
v_mfma_f32_16x16x32_bf16 v[120:123], v[48:51], v[36:39], v[120:123]
ds_read_b128 v[168:171], v3 offset:57344
s_branch Lov_5
.p2align 12
.fill 32, 4, 0xbf800000
Lst_5_0:
s_branch Lwr_150
s_nop 0
s_nop 0
Lov_5:
ds_read_b64_tr_b16 v[176:177], v16 offset:28672
v_mfma_f32_16x16x32_bf16 v[116:119], v[44:47], v[36:39], v[116:119]
ds_read_b64_tr_b16 v[178:179], v16 offset:30720
ds_read_b64_tr_b16 v[180:181], v17 offset:28672
v_mfma_f32_16x16x32_bf16 v[112:115], v[40:43], v[36:39], v[112:115]
ds_read_b64_tr_b16 v[182:183], v17 offset:30720
ds_read_b64_tr_b16 v[184:185], v18 offset:28672
v_mfma_f32_16x16x32_bf16 v[96:99], v[64:67], v[56:59], v[96:99]
ds_read_b64_tr_b16 v[186:187], v18 offset:30720
ds_read_b64_tr_b16 v[188:189], v19 offset:28672
v_mfma_f32_16x16x32_bf16 v[100:103], v[68:71], v[56:59], v[100:103]
ds_read_b64_tr_b16 v[190:191], v19 offset:30720
ds_read_b128 v[172:175], v3 offset:58368
v_mfma_f32_16x16x32_bf16 v[104:107], v[72:75], v[56:59], v[104:107]
v_add_u32 v196, 0, v1
v_mfma_f32_16x16x32_bf16 v[108:111], v[76:79], v[56:59], v[108:111]
v_mul_u32_u24 v197, 5462, v196
v_mfma_f32_16x16x32_bf16 v[124:127], v[76:79], v[60:63], v[124:127]
v_lshrrev_b32 v197, 16, v197
v_mfma_f32_16x16x32_bf16 v[120:123], v[72:75], v[60:63], v[120:123]
v_mul_u32_u24 v198, 12, v197
v_mfma_f32_16x16x32_bf16 v[116:119], v[68:71], v[60:63], v[116:119]
v_sub_u32 v198, v196, v198
v_mfma_f32_16x16x32_bf16 v[112:115], v[64:67], v[60:63], v[112:115]
v_bfe_u32 v199, v197, 2, 1
s_waitcnt lgkmcnt(0)
s_barrier
v_mfma_f32_16x16x32_bf16 v[96:99], v[152:155], v[144:147], v[96:99]
ds_read_b128 v[32:35], v2 offset:0
ds_read_b64_tr_b16 v[40:41], v16 offset:49152
v_mfma_f32_16x16x32_bf16 v[100:103], v[156:159], v[144:147], v[100:103]
ds_read_b64_tr_b16 v[42:43], v16 offset:51200
ds_read_b64_tr_b16 v[44:45], v17 offset:49152
v_mfma_f32_16x16x32_bf16 v[104:107], v[160:163], v[144:147], v[104:107]
ds_read_b64_tr_b16 v[46:47], v17 offset:51200
ds_read_b64_tr_b16 v[48:49], v18 offset:49152
v_mfma_f32_16x16x32_bf16 v[108:111], v[164:167], v[144:147], v[108:111]
ds_read_b64_tr_b16 v[50:51], v18 offset:51200
ds_read_b64_tr_b16 v[52:53], v19 offset:49152
v_mfma_f32_16x16x32_bf16 v[124:127], v[164:167], v[148:151], v[124:127]
ds_read_b64_tr_b16 v[54:55], v19 offset:51200
ds_read_b128 v[36:39], v2 offset:1024
v_mfma_f32_16x16x32_bf16 v[120:123], v[160:163], v[148:151], v[120:123]
ds_read_b128 v[56:59], v2 offset:8192
ds_read_b64_tr_b16 v[64:65], v16 offset:53248
v_mfma_f32_16x16x32_bf16 v[116:119], v[156:159], v[148:151], v[116:119]
ds_read_b64_tr_b16 v[66:67], v16 offset:55296
ds_read_b64_tr_b16 v[68:69], v17 offset:53248
v_mfma_f32_16x16x32_bf16 v[112:115], v[152:155], v[148:151], v[112:115]
ds_read_b64_tr_b16 v[70:71], v17 offset:55296
ds_read_b64_tr_b16 v[72:73], v18 offset:53248
v_mfma_f32_16x16x32_bf16 v[96:99], v[176:179], v[168:171], v[96:99]
ds_read_b64_tr_b16 v[74:75], v18 offset:55296
ds_read_b64_tr_b16 v[76:77], v19 offset:53248
v_mfma_f32_16x16x32_bf16 v[100:103], v[180:183], v[168:171], v[100:103]
ds_read_b64_tr_b16 v[78:79], v19 offset:55296
ds_read_b128 v[60:63], v2 offset:9216
v_mfma_f32_16x16x32_bf16 v[104:107], v[184:187], v[168:171], v[104:107]
v_cmp_gt_u32 vcc, 8, v198
v_mfma_f32_16x16x32_bf16 v[108:111], v[188:191], v[168:171], v[108:111]
v_lshlrev_b32 v200, 1, v199
v_mfma_f32_16x16x32_bf16 v[124:127], v[188:191], v[172:175], v[124:127]
v_mul_u32_u24 v197, 7168, v197
v_mfma_f32_16x16x32_bf16 v[120:123], v[184:187], v[172:175], v[120:123]
v_cndmask_b32 v199, v199, v200, vcc
v_mfma_f32_16x16x32_bf16 v[116:119], v[180:183], v[172:175], v[116:119]
v_xor_b32 v198, v198, v199
v_mfma_f32_16x16x32_bf16 v[112:115], v[176:179], v[172:175], v[112:115]
v_lshl_add_u32 v192, v198, 4, v197
s_waitcnt lgkmcnt(0)
s_barrier
v_mfma_f32_16x16x32_bf16 v[96:99], v[40:43], v[32:35], v[96:99]
ds_read_b128 v[144:147], v2 offset:49152
ds_read_b64_tr_b16 v[152:153], v16 offset:57344
v_mfma_f32_16x16x32_bf16 v[100:103], v[44:47], v[32:35], v[100:103]
ds_read_b64_tr_b16 v[154:155], v16 offset:59392
ds_read_b64_tr_b16 v[156:157], v17 offset:57344
v_mfma_f32_16x16x32_bf16 v[104:107], v[48:51], v[32:35], v[104:107]
ds_read_b64_tr_b16 v[158:159], v17 offset:59392
ds_read_b64_tr_b16 v[160:161], v18 offset:57344
v_mfma_f32_16x16x32_bf16 v[108:111], v[52:55], v[32:35], v[108:111]
ds_read_b64_tr_b16 v[162:163], v18 offset:59392
ds_read_b64_tr_b16 v[164:165], v19 offset:57344
v_mfma_f32_16x16x32_bf16 v[124:127], v[52:55], v[36:39], v[124:127]
ds_read_b64_tr_b16 v[166:167], v19 offset:59392
ds_read_b128 v[148:151], v2 offset:50176
v_mfma_f32_16x16x32_bf16 v[120:123], v[48:51], v[36:39], v[120:123]
ds_read_b128 v[168:171], v2 offset:57344
ds_read_b64_tr_b16 v[176:177], v16 offset:61440
v_mfma_f32_16x16x32_bf16 v[116:119], v[44:47], v[36:39], v[116:119]
ds_read_b64_tr_b16 v[178:179], v16 offset:63488
ds_read_b64_tr_b16 v[180:181], v17 offset:61440
v_mfma_f32_16x16x32_bf16 v[112:115], v[40:43], v[36:39], v[112:115]
ds_read_b64_tr_b16 v[182:183], v17 offset:63488
ds_read_b64_tr_b16 v[184:185], v18 offset:61440
v_mfma_f32_16x16x32_bf16 v[96:99], v[64:67], v[56:59], v[96:99]
ds_read_b64_tr_b16 v[186:187], v18 offset:63488
ds_read_b64_tr_b16 v[188:189], v19 offset:61440
v_mfma_f32_16x16x32_bf16 v[100:103], v[68:71], v[56:59], v[100:103]
ds_read_b64_tr_b16 v[190:191], v19 offset:63488
ds_read_b128 v[172:175], v2 offset:58368
v_mfma_f32_16x16x32_bf16 v[104:107], v[72:75], v[56:59], v[104:107]
v_add_u32 v196, 64, v1
v_mfma_f32_16x16x32_bf16 v[108:111], v[76:79], v[56:59], v[108:111]
v_mul_u32_u24 v197, 5462, v196
v_mfma_f32_16x16x32_bf16 v[124:127], v[76:79], v[60:63], v[124:127]
v_lshrrev_b32 v197, 16, v197
v_mfma_f32_16x16x32_bf16 v[120:123], v[72:75], v[60:63], v[120:123]
v_mul_u32_u24 v198, 12, v197
v_mfma_f32_16x16x32_bf16 v[116:119], v[68:71], v[60:63], v[116:119]
v_sub_u32 v198, v196, v198
v_mfma_f32_16x16x32_bf16 v[112:115], v[64:67], v[60:63], v[112:115]
v_bfe_u32 v199, v197, 2, 1
s_waitcnt lgkmcnt(0)
s_barrier
v_mfma_f32_16x16x32_bf16 v[96:99], v[152:155], v[144:147], v[96:99]
ds_read_b128 v[32:35], v3 offset:0
ds_read_b64_tr_b16 v[40:41], v20 offset:0
v_mfma_f32_16x16x32_bf16 v[100:103], v[156:159], v[144:147], v[100:103]
ds_read_b64_tr_b16 v[42:43], v20 offset:2048
ds_read_b64_tr_b16 v[44:45], v21 offset:0
v_mfma_f32_16x16x32_bf16 v[104:107], v[160:163], v[144:147], v[104:107]
ds_read_b64_tr_b16 v[46:47], v21 offset:2048
ds_read_b64_tr_b16 v[48:49], v22 offset:0
v_mfma_f32_16x16x32_bf16 v[108:111], v[164:167], v[144:147], v[108:111]
ds_read_b64_tr_b16 v[50:51], v22 offset:2048
ds_read_b64_tr_b16 v[52:53], v23 offset:0
v_mfma_f32_16x16x32_bf16 v[124:127], v[164:167], v[148:151], v[124:127]
ds_read_b64_tr_b16 v[54:55], v23 offset:2048
ds_read_b128 v[36:39], v3 offset:1024
v_mfma_f32_16x16x32_bf16 v[120:123], v[160:163], v[148:151], v[120:123]
ds_read_b128 v[56:59], v3 offset:8192
ds_read_b64_tr_b16 v[64:65], v20 offset:4096
v_mfma_f32_16x16x32_bf16 v[116:119], v[156:159], v[148:151], v[116:119]
ds_read_b64_tr_b16 v[66:67], v20 offset:6144
ds_read_b64_tr_b16 v[68:69], v21 offset:4096
v_mfma_f32_16x16x32_bf16 v[112:115], v[152:155], v[148:151], v[112:115]
ds_read_b64_tr_b16 v[70:71], v21 offset:6144
ds_read_b64_tr_b16 v[72:73], v22 offset:4096
v_mfma_f32_16x16x32_bf16 v[96:99], v[176:179], v[168:171], v[96:99]
ds_read_b64_tr_b16 v[74:75], v22 offset:6144
ds_read_b64_tr_b16 v[76:77], v23 offset:4096
v_mfma_f32_16x16x32_bf16 v[100:103], v[180:183], v[168:171], v[100:103]
ds_read_b64_tr_b16 v[78:79], v23 offset:6144
ds_read_b128 v[60:63], v3 offset:9216
v_mfma_f32_16x16x32_bf16 v[104:107], v[184:187], v[168:171], v[104:107]
v_cmp_gt_u32 vcc, 8, v198
v_mfma_f32_16x16x32_bf16 v[108:111], v[188:191], v[168:171], v[108:111]
v_lshlrev_b32 v200, 1, v199
v_mfma_f32_16x16x32_bf16 v[124:127], v[188:191], v[172:175], v[124:127]
v_mul_u32_u24 v197, 7168, v197
v_mfma_f32_16x16x32_bf16 v[120:123], v[184:187], v[172:175], v[120:123]
v_cndmask_b32 v199, v199, v200, vcc
v_mfma_f32_16x16x32_bf16 v[116:119], v[180:183], v[172:175], v[116:119]
v_xor_b32 v198, v198, v199
v_mfma_f32_16x16x32_bf16 v[112:115], v[176:179], v[172:175], v[112:115]
v_lshl_add_u32 v193, v198, 4, v197
s_waitcnt lgkmcnt(0)
s_barrier
v_mfma_f32_16x16x32_bf16 v[96:99], v[40:43], v[32:35], v[96:99]
ds_read_b128 v[144:147], v3 offset:49152
ds_read_b64_tr_b16 v[152:153], v20 offset:8192
v_mfma_f32_16x16x32_bf16 v[100:103], v[44:47], v[32:35], v[100:103]
ds_read_b64_tr_b16 v[154:155], v20 offset:10240
ds_read_b64_tr_b16 v[156:157], v21 offset:8192
v_mfma_f32_16x16x32_bf16 v[104:107], v[48:51], v[32:35], v[104:107]
ds_read_b64_tr_b16 v[158:159], v21 offset:10240
ds_read_b64_tr_b16 v[160:161], v22 offset:8192
v_mfma_f32_16x16x32_bf16 v[108:111], v[52:55], v[32:35], v[108:111]
ds_read_b64_tr_b16 v[162:163], v22 offset:10240
ds_read_b64_tr_b16 v[164:165], v23 offset:8192
v_mfma_f32_16x16x32_bf16 v[124:127], v[52:55], v[36:39], v[124:127]
ds_read_b64_tr_b16 v[166:167], v23 offset:10240
ds_read_b128 v[148:151], v3 offset:50176
v_mfma_f32_16x16x32_bf16 v[120:123], v[48:51], v[36:39], v[120:123]
ds_read_b128 v[168:171], v3 offset:57344
ds_read_b64_tr_b16 v[176:177], v20 offset:12288
v_mfma_f32_16x16x32_bf16 v[116:119], v[44:47], v[36:39], v[116:119]
ds_read_b64_tr_b16 v[178:179], v20 offset:14336
ds_read_b64_tr_b16 v[180:181], v21 offset:12288
v_mfma_f32_16x16x32_bf16 v[112:115], v[40:43], v[36:39], v[112:115]
ds_read_b64_tr_b16 v[182:183], v21 offset:14336
ds_read_b64_tr_b16 v[184:185], v22 offset:12288
v_mfma_f32_16x16x32_bf16 v[96:99], v[64:67], v[56:59], v[96:99]
ds_read_b64_tr_b16 v[186:187], v22 offset:14336
ds_read_b64_tr_b16 v[188:189], v23 offset:12288
v_mfma_f32_16x16x32_bf16 v[100:103], v[68:71], v[56:59], v[100:103]
ds_read_b64_tr_b16 v[190:191], v23 offset:14336
ds_read_b128 v[172:175], v3 offset:58368
v_mfma_f32_16x16x32_bf16 v[104:107], v[72:75], v[56:59], v[104:107]
v_add_u32 v196, 128, v1
v_mfma_f32_16x16x32_bf16 v[108:111], v[76:79], v[56:59], v[108:111]
v_mul_u32_u24 v197, 5462, v196
v_mfma_f32_16x16x32_bf16 v[124:127], v[76:79], v[60:63], v[124:127]
v_lshrrev_b32 v197, 16, v197
v_mfma_f32_16x16x32_bf16 v[120:123], v[72:75], v[60:63], v[120:123]
v_mul_u32_u24 v198, 12, v197
v_mfma_f32_16x16x32_bf16 v[116:119], v[68:71], v[60:63], v[116:119]
v_sub_u32 v198, v196, v198
v_mfma_f32_16x16x32_bf16 v[112:115], v[64:67], v[60:63], v[112:115]
v_bfe_u32 v199, v197, 2, 1
s_waitcnt lgkmcnt(0)
s_barrier
v_mfma_f32_16x16x32_bf16 v[96:99], v[152:155], v[144:147], v[96:99]
ds_read_b128 v[32:35], v2 offset:0
ds_read_b64_tr_b16 v[40:41], v4 offset:16384
v_mfma_f32_16x16x32_bf16 v[100:103], v[156:159], v[144:147], v[100:103]
ds_read_b64_tr_b16 v[42:43], v4 offset:18432
ds_read_b64_tr_b16 v[44:45], v5 offset:16384
v_mfma_f32_16x16x32_bf16 v[104:107], v[160:163], v[144:147], v[104:107]
ds_read_b64_tr_b16 v[46:47], v5 offset:18432
ds_read_b64_tr_b16 v[48:49], v6 offset:16384
v_mfma_f32_16x16x32_bf16 v[108:111], v[164:167], v[144:147], v[108:111]
ds_read_b64_tr_b16 v[50:51], v6 offset:18432
ds_read_b64_tr_b16 v[52:53], v7 offset:16384
v_mfma_f32_16x16x32_bf16 v[124:127], v[164:167], v[148:151], v[124:127]
ds_read_b64_tr_b16 v[54:55], v7 offset:18432
ds_read_b128 v[36:39], v2 offset:1024
v_mfma_f32_16x16x32_bf16 v[120:123], v[160:163], v[148:151], v[120:123]
ds_read_b128 v[56:59], v2 offset:8192
ds_read_b64_tr_b16 v[64:65], v4 offset:20480
v_mfma_f32_16x16x32_bf16 v[116:119], v[156:159], v[148:151], v[116:119]
ds_read_b64_tr_b16 v[66:67], v4 offset:22528
ds_read_b64_tr_b16 v[68:69], v5 offset:20480
v_mfma_f32_16x16x32_bf16 v[112:115], v[152:155], v[148:151], v[112:115]
ds_read_b64_tr_b16 v[70:71], v5 offset:22528
ds_read_b64_tr_b16 v[72:73], v6 offset:20480
v_mfma_f32_16x16x32_bf16 v[96:99], v[176:179], v[168:171], v[96:99]
ds_read_b64_tr_b16 v[74:75], v6 offset:22528
ds_read_b64_tr_b16 v[76:77], v7 offset:20480
v_mfma_f32_16x16x32_bf16 v[100:103], v[180:183], v[168:171], v[100:103]
ds_read_b64_tr_b16 v[78:79], v7 offset:22528
ds_read_b128 v[60:63], v2 offset:9216
v_mfma_f32_16x16x32_bf16 v[104:107], v[184:187], v[168:171], v[104:107]
v_cmp_gt_u32 vcc, 8, v198
v_mfma_f32_16x16x32_bf16 v[108:111], v[188:191], v[168:171], v[108:111]
v_lshlrev_b32 v200, 1, v199
v_mfma_f32_16x16x32_bf16 v[124:127], v[188:191], v[172:175], v[124:127]
v_mul_u32_u24 v197, 7168, v197
v_mfma_f32_16x16x32_bf16 v[120:123], v[184:187], v[172:175], v[120:123]
v_cndmask_b32 v199, v199, v200, vcc
v_mfma_f32_16x16x32_bf16 v[116:119], v[180:183], v[172:175], v[116:119]
v_xor_b32 v198, v198, v199
v_mfma_f32_16x16x32_bf16 v[112:115], v[176:179], v[172:175], v[112:115]
v_lshl_add_u32 v194, v198, 4, v197
s_waitcnt lgkmcnt(0)
s_barrier
v_mfma_f32_16x16x32_bf16 v[96:99], v[40:43], v[32:35], v[96:99]
ds_read_b128 v[144:147], v2 offset:49152
ds_read_b64_tr_b16 v[152:153], v4 offset:24576
v_mfma_f32_16x16x32_bf16 v[100:103], v[44:47], v[32:35], v[100:103]
ds_read_b64_tr_b16 v[154:155], v4 offset:26624
ds_read_b64_tr_b16 v[156:157], v5 offset:24576
v_mfma_f32_16x16x32_bf16 v[104:107], v[48:51], v[32:35], v[104:107]
ds_read_b64_tr_b16 v[158:159], v5 offset:26624
ds_read_b64_tr_b16 v[160:161], v6 offset:24576
v_mfma_f32_16x16x32_bf16 v[108:111], v[52:55], v[32:35], v[108:111]
ds_read_b64_tr_b16 v[162:163], v6 offset:26624
ds_read_b64_tr_b16 v[164:165], v7 offset:24576
v_mfma_f32_16x16x32_bf16 v[124:127], v[52:55], v[36:39], v[124:127]
ds_read_b64_tr_b16 v[166:167], v7 offset:26624
ds_read_b128 v[148:151], v2 offset:50176
v_mfma_f32_16x16x32_bf16 v[120:123], v[48:51], v[36:39], v[120:123]
ds_read_b128 v[168:171], v2 offset:57344
ds_read_b64_tr_b16 v[176:177], v4 offset:28672
v_mfma_f32_16x16x32_bf16 v[116:119], v[44:47], v[36:39], v[116:119]
ds_read_b64_tr_b16 v[178:179], v4 offset:30720
ds_read_b64_tr_b16 v[180:181], v5 offset:28672
v_mfma_f32_16x16x32_bf16 v[112:115], v[40:43], v[36:39], v[112:115]
ds_read_b64_tr_b16 v[182:183], v5 offset:30720
ds_read_b64_tr_b16 v[184:185], v6 offset:28672
v_mfma_f32_16x16x32_bf16 v[96:99], v[64:67], v[56:59], v[96:99]
ds_read_b64_tr_b16 v[186:187], v6 offset:30720
ds_read_b64_tr_b16 v[188:189], v7 offset:28672
v_mfma_f32_16x16x32_bf16 v[100:103], v[68:71], v[56:59], v[100:103]
ds_read_b64_tr_b16 v[190:191], v7 offset:30720
ds_read_b128 v[172:175], v2 offset:58368
v_mfma_f32_16x16x32_bf16 v[104:107], v[72:75], v[56:59], v[104:107]
v_add_u32 v192, s43, v192
v_mfma_f32_16x16x32_bf16 v[108:111], v[76:79], v[56:59], v[108:111]
v_add_u32 v193, s43, v193
v_mfma_f32_16x16x32_bf16 v[124:127], v[76:79], v[60:63], v[124:127]
v_add_u32 v194, s43, v194
v_mfma_f32_16x16x32_bf16 v[120:123], v[72:75], v[60:63], v[120:123]
s_and_b32 s43, s36, 3
v_mfma_f32_16x16x32_bf16 v[116:119], v[68:71], v[60:63], v[116:119]
s_mul_i32 s50, s43, 6144
v_mfma_f32_16x16x32_bf16 v[112:115], v[64:67], v[60:63], v[112:115]
s_add_u32 s50, s50, 16384
s_waitcnt lgkmcnt(0)
s_barrier
v_mfma_f32_16x16x32_bf16 v[96:99], v[152:155], v[144:147], v[96:99]
ds_read_b128 v[32:35], v3 offset:0
ds_read_b64_tr_b16 v[40:41], v4 offset:32768
v_mfma_f32_16x16x32_bf16 v[100:103], v[156:159], v[144:147], v[100:103]
ds_read_b64_tr_b16 v[42:43], v4 offset:34816
ds_read_b64_tr_b16 v[44:45], v5 offset:32768
v_mfma_f32_16x16x32_bf16 v[104:107], v[160:163], v[144:147], v[104:107]
ds_read_b64_tr_b16 v[46:47], v5 offset:34816
ds_read_b64_tr_b16 v[48:49], v6 offset:32768
v_mfma_f32_16x16x32_bf16 v[108:111], v[164:167], v[144:147], v[108:111]
ds_read_b64_tr_b16 v[50:51], v6 offset:34816
ds_read_b64_tr_b16 v[52:53], v7 offset:32768
v_mfma_f32_16x16x32_bf16 v[124:127], v[164:167], v[148:151], v[124:127]
ds_read_b64_tr_b16 v[54:55], v7 offset:34816
ds_read_b128 v[36:39], v3 offset:1024
v_mfma_f32_16x16x32_bf16 v[120:123], v[160:163], v[148:151], v[120:123]
ds_read_b128 v[56:59], v3 offset:8192
ds_read_b64_tr_b16 v[64:65], v4 offset:36864
v_mfma_f32_16x16x32_bf16 v[116:119], v[156:159], v[148:151], v[116:119]
ds_read_b64_tr_b16 v[66:67], v4 offset:38912
ds_read_b64_tr_b16 v[68:69], v5 offset:36864
v_mfma_f32_16x16x32_bf16 v[112:115], v[152:155], v[148:151], v[112:115]
ds_read_b64_tr_b16 v[70:71], v5 offset:38912
ds_read_b64_tr_b16 v[72:73], v6 offset:36864
v_mfma_f32_16x16x32_bf16 v[96:99], v[176:179], v[168:171], v[96:99]
ds_read_b64_tr_b16 v[74:75], v6 offset:38912
ds_read_b64_tr_b16 v[76:77], v7 offset:36864
v_mfma_f32_16x16x32_bf16 v[100:103], v[180:183], v[168:171], v[100:103]
ds_read_b64_tr_b16 v[78:79], v7 offset:38912
ds_read_b128 v[60:63], v3 offset:9216
v_mfma_f32_16x16x32_bf16 v[104:107], v[184:187], v[168:171], v[104:107]
s_bitcmp0_b32 s2, 0
v_mfma_f32_16x16x32_bf16 v[108:111], v[188:191], v[168:171], v[108:111]
s_cselect_b32 s88, s72, s74
v_mfma_f32_16x16x32_bf16 v[124:127], v[188:191], v[172:175], v[124:127]
s_cselect_b32 s89, s73, s75
v_mfma_f32_16x16x32_bf16 v[120:123], v[184:187], v[172:175], v[120:123]
s_mov_b32 s90, 7340032
v_mfma_f32_16x16x32_bf16 v[116:119], v[180:183], v[172:175], v[116:119]
s_mov_b32 s91, 0x20000
v_mfma_f32_16x16x32_bf16 v[112:115], v[176:179], v[172:175], v[112:115]
s_bfe_u32 s44, s2, 0x30001
s_waitcnt lgkmcnt(0)
s_barrier
v_mfma_f32_16x16x32_bf16 v[96:99], v[40:43], v[32:35], v[96:99]
ds_read_b128 v[144:147], v3 offset:49152
ds_read_b64_tr_b16 v[152:153], v4 offset:40960
v_mfma_f32_16x16x32_bf16 v[100:103], v[44:47], v[32:35], v[100:103]
ds_read_b64_tr_b16 v[154:155], v4 offset:43008
ds_read_b64_tr_b16 v[156:157], v5 offset:40960
v_mfma_f32_16x16x32_bf16 v[104:107], v[48:51], v[32:35], v[104:107]
ds_read_b64_tr_b16 v[158:159], v5 offset:43008
ds_read_b64_tr_b16 v[160:161], v6 offset:40960
v_mfma_f32_16x16x32_bf16 v[108:111], v[52:55], v[32:35], v[108:111]
ds_read_b64_tr_b16 v[162:163], v6 offset:43008
ds_read_b64_tr_b16 v[164:165], v7 offset:40960
v_mfma_f32_16x16x32_bf16 v[124:127], v[52:55], v[36:39], v[124:127]
ds_read_b64_tr_b16 v[166:167], v7 offset:43008
ds_read_b128 v[148:151], v3 offset:50176
v_mfma_f32_16x16x32_bf16 v[120:123], v[48:51], v[36:39], v[120:123]
ds_read_b128 v[168:171], v3 offset:57344
ds_read_b64_tr_b16 v[176:177], v4 offset:45056
v_mfma_f32_16x16x32_bf16 v[116:119], v[44:47], v[36:39], v[116:119]
ds_read_b64_tr_b16 v[178:179], v4 offset:47104
ds_read_b64_tr_b16 v[180:181], v5 offset:45056
v_mfma_f32_16x16x32_bf16 v[112:115], v[40:43], v[36:39], v[112:115]
ds_read_b64_tr_b16 v[182:183], v5 offset:47104
ds_read_b64_tr_b16 v[184:185], v6 offset:45056
v_mfma_f32_16x16x32_bf16 v[96:99], v[64:67], v[56:59], v[96:99]
ds_read_b64_tr_b16 v[186:187], v6 offset:47104
ds_read_b64_tr_b16 v[188:189], v7 offset:45056
v_mfma_f32_16x16x32_bf16 v[100:103], v[68:71], v[56:59], v[100:103]
ds_read_b64_tr_b16 v[190:191], v7 offset:47104
ds_read_b128 v[172:175], v3 offset:58368
v_mfma_f32_16x16x32_bf16 v[104:107], v[72:75], v[56:59], v[104:107]
s_lshl_b32 s44, s44, 2
v_mfma_f32_16x16x32_bf16 v[108:111], v[76:79], v[56:59], v[108:111]
s_and_b32 s43, s36, 3
v_mfma_f32_16x16x32_bf16 v[124:127], v[76:79], v[60:63], v[124:127]
s_add_u32 s44, s44, s43
v_mfma_f32_16x16x32_bf16 v[120:123], v[72:75], v[60:63], v[120:123]
s_lshl_b32 s44, s44, 5
v_mfma_f32_16x16x32_bf16 v[116:119], v[68:71], v[60:63], v[116:119]
v_lshrrev_b32 v195, 4, v1
v_mfma_f32_16x16x32_bf16 v[112:115], v[64:67], v[60:63], v[112:115]
v_add_u32 v195, s44, v195
s_waitcnt lgkmcnt(0)
s_barrier
v_mfma_f32_16x16x32_bf16 v[96:99], v[152:155], v[144:147], v[96:99]
ds_read_b128 v[32:35], v2 offset:0
ds_read_b64_tr_b16 v[40:41], v16 offset:49152
v_mfma_f32_16x16x32_bf16 v[100:103], v[156:159], v[144:147], v[100:103]
ds_read_b64_tr_b16 v[42:43], v16 offset:51200
ds_read_b64_tr_b16 v[44:45], v17 offset:49152
v_mfma_f32_16x16x32_bf16 v[104:107], v[160:163], v[144:147], v[104:107]
ds_read_b64_tr_b16 v[46:47], v17 offset:51200
ds_read_b64_tr_b16 v[48:49], v18 offset:49152
v_mfma_f32_16x16x32_bf16 v[108:111], v[164:167], v[144:147], v[108:111]
ds_read_b64_tr_b16 v[50:51], v18 offset:51200
ds_read_b64_tr_b16 v[52:53], v19 offset:49152
v_mfma_f32_16x16x32_bf16 v[124:127], v[164:167], v[148:151], v[124:127]
ds_read_b64_tr_b16 v[54:55], v19 offset:51200
ds_read_b128 v[36:39], v2 offset:1024
v_mfma_f32_16x16x32_bf16 v[120:123], v[160:163], v[148:151], v[120:123]
ds_read_b128 v[56:59], v2 offset:8192
ds_read_b64_tr_b16 v[64:65], v16 offset:53248
v_mfma_f32_16x16x32_bf16 v[116:119], v[156:159], v[148:151], v[116:119]
ds_read_b64_tr_b16 v[66:67], v16 offset:55296
ds_read_b64_tr_b16 v[68:69], v17 offset:53248
v_mfma_f32_16x16x32_bf16 v[112:115], v[152:155], v[148:151], v[112:115]
ds_read_b64_tr_b16 v[70:71], v17 offset:55296
ds_read_b64_tr_b16 v[72:73], v18 offset:53248
v_mfma_f32_16x16x32_bf16 v[96:99], v[176:179], v[168:171], v[96:99]
ds_read_b64_tr_b16 v[74:75], v18 offset:55296
ds_read_b64_tr_b16 v[76:77], v19 offset:53248
v_mfma_f32_16x16x32_bf16 v[100:103], v[180:183], v[168:171], v[100:103]
ds_read_b64_tr_b16 v[78:79], v19 offset:55296
ds_read_b128 v[60:63], v2 offset:9216
v_mfma_f32_16x16x32_bf16 v[104:107], v[184:187], v[168:171], v[104:107]
v_mul_u32_u24 v195, 7168, v195
v_mfma_f32_16x16x32_bf16 v[108:111], v[188:191], v[168:171], v[108:111]
v_and_b32 v196, 15, v1
v_mfma_f32_16x16x32_bf16 v[124:127], v[188:191], v[172:175], v[124:127]
v_lshl_add_u32 v195, v196, 4, v195
v_mfma_f32_16x16x32_bf16 v[120:123], v[184:187], v[172:175], v[120:123]
s_lshr_b32 s43, s2, 4
v_mfma_f32_16x16x32_bf16 v[116:119], v[180:183], v[172:175], v[116:119]
s_lshl_b32 s43, s43, 8
v_mfma_f32_16x16x32_bf16 v[112:115], v[176:179], v[172:175], v[112:115]
v_add_u32 v195, s43, v195
s_waitcnt lgkmcnt(0)
s_barrier
v_mfma_f32_16x16x32_bf16 v[96:99], v[40:43], v[32:35], v[96:99]
ds_read_b128 v[144:147], v2 offset:49152
ds_read_b64_tr_b16 v[152:153], v16 offset:57344
v_mfma_f32_16x16x32_bf16 v[100:103], v[44:47], v[32:35], v[100:103]
ds_read_b64_tr_b16 v[154:155], v16 offset:59392
ds_read_b64_tr_b16 v[156:157], v17 offset:57344
v_mfma_f32_16x16x32_bf16 v[104:107], v[48:51], v[32:35], v[104:107]
ds_read_b64_tr_b16 v[158:159], v17 offset:59392
ds_read_b64_tr_b16 v[160:161], v18 offset:57344
v_mfma_f32_16x16x32_bf16 v[108:111], v[52:55], v[32:35], v[108:111]
ds_read_b64_tr_b16 v[162:163], v18 offset:59392
ds_read_b64_tr_b16 v[164:165], v19 offset:57344
v_mfma_f32_16x16x32_bf16 v[124:127], v[52:55], v[36:39], v[124:127]
ds_read_b64_tr_b16 v[166:167], v19 offset:59392
ds_read_b128 v[148:151], v2 offset:50176
v_mfma_f32_16x16x32_bf16 v[120:123], v[48:51], v[36:39], v[120:123]
ds_read_b128 v[168:171], v2 offset:57344
ds_read_b64_tr_b16 v[176:177], v16 offset:61440
v_mfma_f32_16x16x32_bf16 v[116:119], v[44:47], v[36:39], v[116:119]
ds_read_b64_tr_b16 v[178:179], v16 offset:63488
ds_read_b64_tr_b16 v[180:181], v17 offset:61440
v_mfma_f32_16x16x32_bf16 v[112:115], v[40:43], v[36:39], v[112:115]
ds_read_b64_tr_b16 v[182:183], v17 offset:63488
ds_read_b64_tr_b16 v[184:185], v18 offset:61440
v_mfma_f32_16x16x32_bf16 v[96:99], v[64:67], v[56:59], v[96:99]
ds_read_b64_tr_b16 v[186:187], v18 offset:63488
ds_read_b64_tr_b16 v[188:189], v19 offset:61440
v_mfma_f32_16x16x32_bf16 v[100:103], v[68:71], v[56:59], v[100:103]
ds_read_b64_tr_b16 v[190:191], v19 offset:63488
ds_read_b128 v[172:175], v2 offset:58368
v_mfma_f32_16x16x32_bf16 v[104:107], v[72:75], v[56:59], v[104:107]
v_mfma_f32_16x16x32_bf16 v[108:111], v[76:79], v[56:59], v[108:111]
v_mfma_f32_16x16x32_bf16 v[124:127], v[76:79], v[60:63], v[124:127]
v_mfma_f32_16x16x32_bf16 v[120:123], v[72:75], v[60:63], v[120:123]
v_mfma_f32_16x16x32_bf16 v[116:119], v[68:71], v[60:63], v[116:119]
v_mfma_f32_16x16x32_bf16 v[112:115], v[64:67], v[60:63], v[112:115]
s_waitcnt lgkmcnt(0)
s_barrier
v_mfma_f32_16x16x32_bf16 v[96:99], v[152:155], v[144:147], v[96:99]
ds_read_b128 v[32:35], v3 offset:0
ds_read_b64_tr_b16 v[40:41], v20 offset:0
v_mfma_f32_16x16x32_bf16 v[100:103], v[156:159], v[144:147], v[100:103]
ds_read_b64_tr_b16 v[42:43], v20 offset:2048
ds_read_b64_tr_b16 v[44:45], v21 offset:0
v_mfma_f32_16x16x32_bf16 v[104:107], v[160:163], v[144:147], v[104:107]
ds_read_b64_tr_b16 v[46:47], v21 offset:2048
ds_read_b64_tr_b16 v[48:49], v22 offset:0
v_mfma_f32_16x16x32_bf16 v[108:111], v[164:167], v[144:147], v[108:111]
ds_read_b64_tr_b16 v[50:51], v22 offset:2048
ds_read_b64_tr_b16 v[52:53], v23 offset:0
v_mfma_f32_16x16x32_bf16 v[124:127], v[164:167], v[148:151], v[124:127]
ds_read_b64_tr_b16 v[54:55], v23 offset:2048
ds_read_b128 v[36:39], v3 offset:1024
v_mfma_f32_16x16x32_bf16 v[120:123], v[160:163], v[148:151], v[120:123]
ds_read_b128 v[56:59], v3 offset:8192
ds_read_b64_tr_b16 v[64:65], v20 offset:4096
v_mfma_f32_16x16x32_bf16 v[116:119], v[156:159], v[148:151], v[116:119]
ds_read_b64_tr_b16 v[66:67], v20 offset:6144
ds_read_b64_tr_b16 v[68:69], v21 offset:4096
v_mfma_f32_16x16x32_bf16 v[112:115], v[152:155], v[148:151], v[112:115]
ds_read_b64_tr_b16 v[70:71], v21 offset:6144
ds_read_b64_tr_b16 v[72:73], v22 offset:4096
v_mfma_f32_16x16x32_bf16 v[96:99], v[176:179], v[168:171], v[96:99]
ds_read_b64_tr_b16 v[74:75], v22 offset:6144
ds_read_b64_tr_b16 v[76:77], v23 offset:4096
v_mfma_f32_16x16x32_bf16 v[100:103], v[180:183], v[168:171], v[100:103]
ds_read_b64_tr_b16 v[78:79], v23 offset:6144
ds_read_b128 v[60:63], v3 offset:9216
v_mfma_f32_16x16x32_bf16 v[104:107], v[184:187], v[168:171], v[104:107]
v_mfma_f32_16x16x32_bf16 v[108:111], v[188:191], v[168:171], v[108:111]
v_mfma_f32_16x16x32_bf16 v[124:127], v[188:191], v[172:175], v[124:127]
v_mfma_f32_16x16x32_bf16 v[120:123], v[184:187], v[172:175], v[120:123]
v_mfma_f32_16x16x32_bf16 v[116:119], v[180:183], v[172:175], v[116:119]
v_mfma_f32_16x16x32_bf16 v[112:115], v[176:179], v[172:175], v[112:115]
s_waitcnt lgkmcnt(0)
s_barrier
v_mfma_f32_16x16x32_bf16 v[96:99], v[40:43], v[32:35], v[96:99]
ds_read_b128 v[144:147], v3 offset:49152
ds_read_b64_tr_b16 v[152:153], v20 offset:8192
v_mfma_f32_16x16x32_bf16 v[100:103], v[44:47], v[32:35], v[100:103]
ds_read_b64_tr_b16 v[154:155], v20 offset:10240
ds_read_b64_tr_b16 v[156:157], v21 offset:8192
v_mfma_f32_16x16x32_bf16 v[104:107], v[48:51], v[32:35], v[104:107]
ds_read_b64_tr_b16 v[158:159], v21 offset:10240
ds_read_b64_tr_b16 v[160:161], v22 offset:8192
v_mfma_f32_16x16x32_bf16 v[108:111], v[52:55], v[32:35], v[108:111]
ds_read_b64_tr_b16 v[162:163], v22 offset:10240
ds_read_b64_tr_b16 v[164:165], v23 offset:8192
v_mfma_f32_16x16x32_bf16 v[124:127], v[52:55], v[36:39], v[124:127]
ds_read_b64_tr_b16 v[166:167], v23 offset:10240
ds_read_b128 v[148:151], v3 offset:50176
v_mfma_f32_16x16x32_bf16 v[120:123], v[48:51], v[36:39], v[120:123]
ds_read_b128 v[168:171], v3 offset:57344
ds_read_b64_tr_b16 v[176:177], v20 offset:12288
v_mfma_f32_16x16x32_bf16 v[116:119], v[44:47], v[36:39], v[116:119]
ds_read_b64_tr_b16 v[178:179], v20 offset:14336
ds_read_b64_tr_b16 v[180:181], v21 offset:12288
v_mfma_f32_16x16x32_bf16 v[112:115], v[40:43], v[36:39], v[112:115]
ds_read_b64_tr_b16 v[182:183], v21 offset:14336
ds_read_b64_tr_b16 v[184:185], v22 offset:12288
v_mfma_f32_16x16x32_bf16 v[96:99], v[64:67], v[56:59], v[96:99]
ds_read_b64_tr_b16 v[186:187], v22 offset:14336
ds_read_b64_tr_b16 v[188:189], v23 offset:12288
s_branch Lov_6
.p2align 12
.fill 48, 4, 0xbf800000
Lst_6_0:
s_branch Lwr_151
s_nop 0
s_nop 0
Lov_6:
v_mfma_f32_16x16x32_bf16 v[100:103], v[68:71], v[56:59], v[100:103]
ds_read_b64_tr_b16 v[190:191], v23 offset:14336
ds_read_b128 v[172:175], v3 offset:58368
v_mfma_f32_16x16x32_bf16 v[104:107], v[72:75], v[56:59], v[104:107]
v_mfma_f32_16x16x32_bf16 v[108:111], v[76:79], v[56:59], v[108:111]
v_mfma_f32_16x16x32_bf16 v[124:127], v[76:79], v[60:63], v[124:127]
v_mfma_f32_16x16x32_bf16 v[120:123], v[72:75], v[60:63], v[120:123]
v_mfma_f32_16x16x32_bf16 v[116:119], v[68:71], v[60:63], v[116:119]
v_mfma_f32_16x16x32_bf16 v[112:115], v[64:67], v[60:63], v[112:115]
s_waitcnt lgkmcnt(0)
s_barrier
v_mfma_f32_16x16x32_bf16 v[96:99], v[152:155], v[144:147], v[96:99]
v_mfma_f32_16x16x32_bf16 v[100:103], v[156:159], v[144:147], v[100:103]
v_mfma_f32_16x16x32_bf16 v[104:107], v[160:163], v[144:147], v[104:107]
v_mfma_f32_16x16x32_bf16 v[108:111], v[164:167], v[144:147], v[108:111]
v_mfma_f32_16x16x32_bf16 v[124:127], v[164:167], v[148:151], v[124:127]
v_mfma_f32_16x16x32_bf16 v[120:123], v[160:163], v[148:151], v[120:123]
v_mfma_f32_16x16x32_bf16 v[116:119], v[156:159], v[148:151], v[116:119]
v_mfma_f32_16x16x32_bf16 v[112:115], v[152:155], v[148:151], v[112:115]
v_mfma_f32_16x16x32_bf16 v[96:99], v[176:179], v[168:171], v[96:99]
v_mfma_f32_16x16x32_bf16 v[100:103], v[180:183], v[168:171], v[100:103]
v_mfma_f32_16x16x32_bf16 v[104:107], v[184:187], v[168:171], v[104:107]
v_mfma_f32_16x16x32_bf16 v[108:111], v[188:191], v[168:171], v[108:111]
v_mfma_f32_16x16x32_bf16 v[124:127], v[188:191], v[172:175], v[124:127]
v_mfma_f32_16x16x32_bf16 v[120:123], v[184:187], v[172:175], v[120:123]
v_mfma_f32_16x16x32_bf16 v[116:119], v[180:183], v[172:175], v[116:119]
v_mfma_f32_16x16x32_bf16 v[112:115], v[176:179], v[172:175], v[112:115]
s_nop 3
v_cvt_pk_bf16_f32 v32, v96, v97
v_cvt_pk_bf16_f32 v33, v98, v99
v_cvt_pk_bf16_f32 v34, v100, v101
v_cvt_pk_bf16_f32 v35, v102, v103
s_add_u32 s43, s60, 0
buffer_store_dwordx4 v[32:35], v11, s[20:23], s43 offen offset:0 sc1
v_cvt_pk_bf16_f32 v36, v104, v105
v_cvt_pk_bf16_f32 v37, v106, v107
v_cvt_pk_bf16_f32 v38, v108, v109
v_cvt_pk_bf16_f32 v39, v110, v111
s_add_u32 s43, s60, 8192
buffer_store_dwordx4 v[36:39], v11, s[20:23], s43 offen offset:0 sc1
v_cvt_pk_bf16_f32 v44, v120, v121
v_cvt_pk_bf16_f32 v45, v122, v123
v_cvt_pk_bf16_f32 v46, v124, v125
v_cvt_pk_bf16_f32 v47, v126, v127
s_add_u32 s43, s60, 8192
buffer_store_dwordx4 v[44:47], v11, s[20:23], s43 offen offset:1024 sc1
v_cvt_pk_bf16_f32 v40, v112, v113
v_cvt_pk_bf16_f32 v41, v114, v115
v_cvt_pk_bf16_f32 v42, v116, v117
v_cvt_pk_bf16_f32 v43, v118, v119
s_add_u32 s43, s60, 0
buffer_store_dwordx4 v[40:43], v11, s[20:23], s43 offen offset:1024 sc1
v_mov_b32 v64, 0
v_mov_b32 v65, 0
v_mov_b32 v66, 0
v_mov_b32 v67, 0
v_mov_b32 v68, 0
v_mov_b32 v69, 0
v_mov_b32 v70, 0
v_mov_b32 v71, 0
v_dot2_f32_bf16 v64, v32, s61, v64
v_dot2_f32_bf16 v66, v32, v32, v66
v_dot2_f32_bf16 v68, v40, s61, v68
v_dot2_f32_bf16 v70, v40, v40, v70
v_dot2_f32_bf16 v65, v33, s61, v65
v_dot2_f32_bf16 v67, v33, v33, v67
v_dot2_f32_bf16 v69, v41, s61, v69
v_dot2_f32_bf16 v71, v41, v41, v71
v_dot2_f32_bf16 v64, v34, s61, v64
v_dot2_f32_bf16 v66, v34, v34, v66
v_dot2_f32_bf16 v68, v42, s61, v68
v_dot2_f32_bf16 v70, v42, v42, v70
v_dot2_f32_bf16 v65, v35, s61, v65
v_dot2_f32_bf16 v67, v35, v35, v67
v_dot2_f32_bf16 v69, v43, s61, v69
v_dot2_f32_bf16 v71, v43, v43, v71
v_dot2_f32_bf16 v64, v36, s61, v64
v_dot2_f32_bf16 v66, v36, v36, v66
v_dot2_f32_bf16 v68, v44, s61, v68
v_dot2_f32_bf16 v70, v44, v44, v70
v_dot2_f32_bf16 v65, v37, s61, v65
v_dot2_f32_bf16 v67, v37, v37, v67
v_dot2_f32_bf16 v69, v45, s61, v69
v_dot2_f32_bf16 v71, v45, v45, v71
v_dot2_f32_bf16 v64, v38, s61, v64
v_dot2_f32_bf16 v66, v38, v38, v66
v_dot2_f32_bf16 v68, v46, s61, v68
v_dot2_f32_bf16 v70, v46, v46, v70
v_dot2_f32_bf16 v65, v39, s61, v65
v_dot2_f32_bf16 v67, v39, v39, v67
v_dot2_f32_bf16 v69, v47, s61, v69
v_dot2_f32_bf16 v71, v47, v47, v71
s_nop 2
v_add_f32 v64, v64, v65
v_add_f32 v66, v66, v67
v_add_f32 v68, v68, v69
v_add_f32 v70, v70, v71
s_nop 1
v_permlane32_swap_b32 v64, v68
v_permlane32_swap_b32 v66, v70
v_add_f32 v64, v64, v68
v_add_f32 v66, v66, v70
s_nop 1
v_permlane16_swap_b32 v64, v66
v_add_f32 v64, v64, v66
buffer_store_dword v64, v9, s[24:27], 0 offen sc1
s_lshl_b32 s7, s34, 12
s_add_u32 s7, s7, 49280
v_lshl_add_u32 v4, v1, 8, s7
v_mov_b32 v5, 1
s_waitcnt vmcnt(0)
s_cmp_lg_u32 s36, 0
s_barrier
s_cbranch_scc1 Lk2end_83
s_mov_b64 exec, 0xffff
buffer_atomic_add v5, v4, s[56:59], 0 offen sc1
s_mov_b64 exec, -1
s_branch Lk2end_83
Lprod_84:
s_mul_i32 s43, s34, 262144
s_add_u32 s8, s82, s43
s_addc_u32 s9, s83, 0
s_mov_b32 s10, 262144
s_mov_b32 s11, 0x20000
s_lshl_b32 s43, s35, 7
s_add_u32 s12, s68, s43
s_addc_u32 s13, s69, 0
s_mov_b32 s14, 2095232
s_mov_b32 s15, 0x20000
s_and_b32 s47, s36, 3
s_lshl_b32 s39, s47, 12
v_lshlrev_b32 v2, 4, v1
v_add_u32 v2, s39, v2
v_lshrrev_b32 v12, 3, v1
v_and_b32 v13, 6, v12
v_and_b32 v3, 7, v1
v_xor_b32 v3, v3, v13
v_lshlrev_b32 v3, 4, v3
v_mul_u32_u24 v12, 2048, v12
v_add_u32 v3, v3, v12
s_lshl_b32 s43, s47, 15
v_add_u32 v3, s43, v3
s_lshl_b32 s40, s47, 11
s_add_u32 s37, s35, 0
s_and_b32 s37, s37, 15
s_lshl_b32 s37, s37, 14
s_add_u32 m0, s39, 0
s_nop 0
buffer_load_dwordx4 v2, s[8:11], s37 offen offset:0 sc1 lds
buffer_load_dwordx4 v2, s[8:11], s37 offen offset:1024 sc1 lds
buffer_load_dwordx4 v2, s[8:11], s37 offen offset:2048 sc1 lds
buffer_load_dwordx4 v2, s[8:11], s37 offen offset:3072 sc1 lds
s_add_u32 s38, s35, 4
s_and_b32 s38, s38, 15
s_lshl_b32 s38, s38, 17
s_add_u32 m0, s40, 114688
s_nop 0
buffer_load_dwordx4 v3, s[12:15], s38 offen lds
s_add_u32 m0, s40, 115712
s_add_u32 s38, s38, 16384
buffer_load_dwordx4 v3, s[12:15], s38 offen lds
s_add_u32 s38, s35, 5
s_and_b32 s38, s38, 15
s_lshl_b32 s38, s38, 17
s_add_u32 m0, s40, 122880
s_nop 0
buffer_load_dwordx4 v3, s[12:15], s38 offen lds
s_add_u32 m0, s40, 123904
s_add_u32 s38, s38, 16384
buffer_load_dwordx4 v3, s[12:15], s38 offen lds
s_add_u32 s38, s35, 6
s_and_b32 s38, s38, 15
s_lshl_b32 s38, s38, 17
s_add_u32 m0, s40, 131072
s_nop 0
buffer_load_dwordx4 v3, s[12:15], s38 offen lds
s_add_u32 m0, s40, 132096
s_add_u32 s38, s38, 16384
buffer_load_dwordx4 v3, s[12:15], s38 offen lds
s_add_u32 s38, s35, 7
s_and_b32 s38, s38, 15
s_lshl_b32 s38, s38, 17
s_add_u32 m0, s40, 139264
s_nop 0
buffer_load_dwordx4 v3, s[12:15], s38 offen lds
s_add_u32 m0, s40, 140288
s_add_u32 s38, s38, 16384
buffer_load_dwordx4 v3, s[12:15], s38 offen lds
s_bitcmp0_b32 s36, 1
s_cselect_b32 s44, s72, s74
s_cselect_b32 s45, s73, s75
s_mul_i32 s43, s35, 192
s_add_u32 s16, s44, s43
s_addc_u32 s17, s45, 0
s_add_u32 s16, s16, 4096
s_addc_u32 s17, s17, 0
s_mov_b32 s18, 7333056
s_mov_b32 s19, 0x20000
s_and_b32 s43, s36, 1
s_mul_i32 s43, s43, 229376
v_add_u32 v196, 0, v1
v_mul_u32_u24 v197, 5462, v196
v_lshrrev_b32 v197, 16, v197
v_mul_u32_u24 v198, 12, v197
v_sub_u32 v198, v196, v198
v_bfe_u32 v199, v197, 2, 1
v_cmp_gt_u32 vcc, 8, v198
v_lshlrev_b32 v200, 1, v199
v_mul_u32_u24 v197, 7168, v197
v_cndmask_b32 v199, v199, v200, vcc
v_xor_b32 v198, v198, v199
v_lshl_add_u32 v192, v198, 4, v197
v_add_u32 v196, 64, v1
v_mul_u32_u24 v197, 5462, v196
v_lshrrev_b32 v197, 16, v197
v_mul_u32_u24 v198, 12, v197
v_sub_u32 v198, v196, v198
v_bfe_u32 v199, v197, 2, 1
v_cmp_gt_u32 vcc, 8, v198
v_lshlrev_b32 v200, 1, v199
v_mul_u32_u24 v197, 7168, v197
v_cndmask_b32 v199, v199, v200, vcc
v_xor_b32 v198, v198, v199
v_lshl_add_u32 v193, v198, 4, v197
v_add_u32 v196, 128, v1
v_mul_u32_u24 v197, 5462, v196
v_lshrrev_b32 v197, 16, v197
v_mul_u32_u24 v198, 12, v197
v_sub_u32 v198, v196, v198
v_bfe_u32 v199, v197, 2, 1
v_cmp_gt_u32 vcc, 8, v198
v_lshlrev_b32 v200, 1, v199
v_mul_u32_u24 v197, 7168, v197
v_cndmask_b32 v199, v199, v200, vcc
v_xor_b32 v198, v198, v199
v_lshl_add_u32 v194, v198, 4, v197
v_add_u32 v192, s43, v192
v_add_u32 v193, s43, v193
v_add_u32 v194, s43, v194
s_and_b32 s43, s36, 3
s_mul_i32 s50, s43, 6144
s_add_u32 s50, s50, 16384
s_cmp_eq_u32 s47, 3
s_cbranch_scc0 Lw_91
s_lshl_b32 s92, s34, 4
s_add_u32 s92, s92, s35
s_lshl_b32 s92, s92, 8
s_add_u32 s92, s92, 49152
s_add_u32 s92, s92, 28311552
s_mov_b32 s41, 0x40000
Lpoll_92:
s_load_dword s93, s[82:83], s92 glc
Lpchk_94:
s_waitcnt lgkmcnt(0)
s_cmp_eq_u32 s93, 16
s_cbranch_scc1 Lpok_93
s_sub_u32 s41, s41, 1
s_cmp_lg_u32 s41, 0
s_cbranch_scc1 Lpoll_92
Lpok_93:
Lw_91:
s_and_b32 s44, s36, 3
s_mul_i32 s44, s44, 14
s_bfe_u32 s43, s2, 0x30001
s_lshl_b32 s43, s43, 7
s_add_u32 s44, s44, s43
s_add_u32 s44, s44, 72
s_mul_i32 s44, s44, 7168
s_lshr_b32 s43, s2, 4
s_lshl_b32 s43, s43, 8
s_add_u32 s43, s43, s44
s_bitcmp0_b32 s2, 0
s_cselect_b32 s4, s72, s74
s_cselect_b32 s5, s73, s75
s_add_u32 s4, s4, s43
s_addc_u32 s5, s5, 0
s_cmp_eq_u32 s47, 3
s_cbranch_scc1 Lw_95
s_load_dword s3, s[4:5], 0
s_load_dword s3, s[4:5], 64
s_load_dword s3, s[4:5], 128
s_load_dword s3, s[4:5], 192
s_load_dword s3, s[4:5], 7168
s_load_dword s3, s[4:5], 7232
s_load_dword s3, s[4:5], 7296
s_load_dword s3, s[4:5], 7360
s_load_dword s3, s[4:5], 14336
s_load_dword s3, s[4:5], 14400
s_load_dword s3, s[4:5], 14464
s_load_dword s3, s[4:5], 14528
s_load_dword s3, s[4:5], 21504
s_load_dword s3, s[4:5], 21568
Lw_95:
s_waitcnt vmcnt(8)
s_barrier
s_add_u32 s37, s35, 1
s_and_b32 s37, s37, 15
s_lshl_b32 s37, s37, 14
s_add_u32 m0, s39, 49152
s_nop 0
buffer_load_dwordx4 v2, s[8:11], s37 offen offset:0 sc1 lds
buffer_load_dwordx4 v2, s[8:11], s37 offen offset:1024 sc1 lds
buffer_load_dwordx4 v2, s[8:11], s37 offen offset:2048 sc1 lds
buffer_load_dwordx4 v2, s[8:11], s37 offen offset:3072 sc1 lds
s_add_u32 s37, s35, 2
s_and_b32 s37, s37, 15
s_lshl_b32 s37, s37, 14
s_add_u32 m0, s39, 98304
s_nop 0
buffer_load_dwordx4 v2, s[8:11], s37 offen offset:0 sc1 lds
buffer_load_dwordx4 v2, s[8:11], s37 offen offset:1024 sc1 lds
buffer_load_dwordx4 v2, s[8:11], s37 offen offset:2048 sc1 lds
buffer_load_dwordx4 v2, s[8:11], s37 offen offset:3072 sc1 lds
s_add_u32 s37, s35, 3
s_and_b32 s37, s37, 15
s_lshl_b32 s37, s37, 14
s_add_u32 m0, s39, 147456
s_nop 0
buffer_load_dwordx4 v2, s[8:11], s37 offen offset:0 sc1 lds
buffer_load_dwordx4 v2, s[8:11], s37 offen offset:1024 sc1 lds
buffer_load_dwordx4 v2, s[8:11], s37 offen offset:2048 sc1 lds
buffer_load_dwordx4 v2, s[8:11], s37 offen offset:3072 sc1 lds
s_cmp_eq_u32 s47, 3
s_cbranch_scc0 Lw_96
s_load_dword s3, s[4:5], 0
s_load_dword s3, s[4:5], 64
s_load_dword s3, s[4:5], 128
s_load_dword s3, s[4:5], 192
s_load_dword s3, s[4:5], 7168
s_load_dword s3, s[4:5], 7232
s_load_dword s3, s[4:5], 7296
s_load_dword s3, s[4:5], 7360
s_load_dword s3, s[4:5], 14336
s_load_dword s3, s[4:5], 14400
s_load_dword s3, s[4:5], 14464
s_load_dword s3, s[4:5], 14528
s_load_dword s3, s[4:5], 21504
s_load_dword s3, s[4:5], 21568
Lw_96:
s_waitcnt vmcnt(8)
s_barrier
s_add_u32 s37, s35, 4
s_and_b32 s37, s37, 15
s_lshl_b32 s37, s37, 14
s_add_u32 m0, s39, 0
s_nop 0
buffer_load_dwordx4 v2, s[8:11], s37 offen offset:0 sc1 lds
buffer_load_dwordx4 v2, s[8:11], s37 offen offset:1024 sc1 lds
buffer_load_dwordx4 v2, s[8:11], s37 offen offset:2048 sc1 lds
buffer_load_dwordx4 v2, s[8:11], s37 offen offset:3072 sc1 lds
s_add_u32 s38, s35, 8
s_and_b32 s38, s38, 15
s_lshl_b32 s38, s38, 17
s_add_u32 m0, s40, 16384
s_nop 0
buffer_load_dwordx4 v3, s[12:15], s38 offen lds
s_add_u32 m0, s40, 17408
s_add_u32 s38, s38, 16384
buffer_load_dwordx4 v3, s[12:15], s38 offen lds
v_lshlrev_b32 v240, 16, v128
v_and_b32 v241, 0xffff0000, v128
v_lshlrev_b32 v242, 16, v129
v_and_b32 v243, 0xffff0000, v129
v_lshlrev_b32 v244, 16, v130
v_and_b32 v245, 0xffff0000, v130
v_lshlrev_b32 v246, 16, v131
v_and_b32 v247, 0xffff0000, v131
s_load_dword s3, s[4:5], 21632
s_load_dword s3, s[4:5], 21696
s_load_dword s3, s[4:5], 28672
s_waitcnt vmcnt(10)
s_barrier
s_add_u32 s37, s35, 5
s_and_b32 s37, s37, 15
s_lshl_b32 s37, s37, 14
s_add_u32 m0, s39, 49152
s_nop 0
buffer_load_dwordx4 v2, s[8:11], s37 offen offset:0 sc1 lds
buffer_load_dwordx4 v2, s[8:11], s37 offen offset:1024 sc1 lds
buffer_load_dwordx4 v2, s[8:11], s37 offen offset:2048 sc1 lds
buffer_load_dwordx4 v2, s[8:11], s37 offen offset:3072 sc1 lds
s_add_u32 s38, s35, 9
s_and_b32 s38, s38, 15
s_lshl_b32 s38, s38, 17
s_add_u32 m0, s40, 24576
s_nop 0
buffer_load_dwordx4 v3, s[12:15], s38 offen lds
s_add_u32 m0, s40, 25600
s_add_u32 s38, s38, 16384
buffer_load_dwordx4 v3, s[12:15], s38 offen lds
v_lshlrev_b32 v24, 16, v132
v_and_b32 v25, 0xffff0000, v132
v_lshlrev_b32 v26, 16, v133
v_and_b32 v27, 0xffff0000, v133
v_lshlrev_b32 v28, 16, v134
v_and_b32 v29, 0xffff0000, v134
v_lshlrev_b32 v30, 16, v135
v_and_b32 v31, 0xffff0000, v135
v_add_f32 v240, v240, v24
v_add_f32 v241, v241, v25
v_add_f32 v242, v242, v26
v_add_f32 v243, v243, v27
v_add_f32 v244, v244, v28
v_add_f32 v245, v245, v29
v_add_f32 v246, v246, v30
v_add_f32 v247, v247, v31
s_load_dword s3, s[4:5], 28736
s_load_dword s3, s[4:5], 28800
s_load_dword s3, s[4:5], 28864
s_waitcnt vmcnt(12)
s_barrier
s_add_u32 s37, s35, 6
s_and_b32 s37, s37, 15
s_lshl_b32 s37, s37, 14
s_add_u32 m0, s39, 98304
s_nop 0
buffer_load_dwordx4 v2, s[8:11], s37 offen offset:0 sc1 lds
buffer_load_dwordx4 v2, s[8:11], s37 offen offset:1024 sc1 lds
buffer_load_dwordx4 v2, s[8:11], s37 offen offset:2048 sc1 lds
buffer_load_dwordx4 v2, s[8:11], s37 offen offset:3072 sc1 lds
s_add_u32 s38, s35, 10
s_and_b32 s38, s38, 15
s_lshl_b32 s38, s38, 17
s_add_u32 m0, s40, 32768
s_nop 0
buffer_load_dwordx4 v3, s[12:15], s38 offen lds
s_add_u32 m0, s40, 33792
s_add_u32 s38, s38, 16384
buffer_load_dwordx4 v3, s[12:15], s38 offen lds
v_lshlrev_b32 v24, 16, v136
v_and_b32 v25, 0xffff0000, v136
v_lshlrev_b32 v26, 16, v137
v_and_b32 v27, 0xffff0000, v137
v_lshlrev_b32 v28, 16, v138
v_and_b32 v29, 0xffff0000, v138
v_lshlrev_b32 v30, 16, v139
v_and_b32 v31, 0xffff0000, v139
v_add_f32 v240, v240, v24
v_add_f32 v241, v241, v25
v_add_f32 v242, v242, v26
v_add_f32 v243, v243, v27
v_add_f32 v244, v244, v28
v_add_f32 v245, v245, v29
v_add_f32 v246, v246, v30
v_add_f32 v247, v247, v31
s_load_dword s3, s[4:5], 35840
s_load_dword s3, s[4:5], 35904
s_load_dword s3, s[4:5], 35968
s_waitcnt vmcnt(14)
s_barrier
s_add_u32 s37, s35, 7
s_and_b32 s37, s37, 15
s_lshl_b32 s37, s37, 14
s_add_u32 m0, s39, 147456
s_nop 0
buffer_load_dwordx4 v2, s[8:11], s37 offen offset:0 sc1 lds
buffer_load_dwordx4 v2, s[8:11], s37 offen offset:1024 sc1 lds
buffer_load_dwordx4 v2, s[8:11], s37 offen offset:2048 sc1 lds
buffer_load_dwordx4 v2, s[8:11], s37 offen offset:3072 sc1 lds
s_add_u32 s38, s35, 11
s_and_b32 s38, s38, 15
s_lshl_b32 s38, s38, 17
s_add_u32 m0, s40, 40960
s_nop 0
buffer_load_dwordx4 v3, s[12:15], s38 offen lds
s_add_u32 m0, s40, 41984
s_add_u32 s38, s38, 16384
buffer_load_dwordx4 v3, s[12:15], s38 offen lds
v_lshlrev_b32 v24, 16, v140
v_and_b32 v25, 0xffff0000, v140
v_lshlrev_b32 v26, 16, v141
v_and_b32 v27, 0xffff0000, v141
v_lshlrev_b32 v28, 16, v142
v_and_b32 v29, 0xffff0000, v142
v_lshlrev_b32 v30, 16, v143
v_and_b32 v31, 0xffff0000, v143
v_add_f32 v240, v240, v24
v_add_f32 v241, v241, v25
v_add_f32 v242, v242, v26
v_add_f32 v243, v243, v27
v_add_f32 v244, v244, v28
v_add_f32 v245, v245, v29
v_add_f32 v246, v246, v30
v_add_f32 v247, v247, v31
s_load_dword s3, s[4:5], 36032
s_load_dword s3, s[4:5], 43008
s_load_dword s3, s[4:5], 43072
s_waitcnt vmcnt(14)
s_barrier
s_add_u32 s37, s35, 8
s_and_b32 s37, s37, 15
s_lshl_b32 s37, s37, 14
s_add_u32 m0, s39, 0
s_nop 0
buffer_load_dwordx4 v2, s[8:11], s37 offen offset:0 sc1 lds
buffer_load_dwordx4 v2, s[8:11], s37 offen offset:1024 sc1 lds
buffer_load_dwordx4 v2, s[8:11], s37 offen offset:2048 sc1 lds
buffer_load_dwordx4 v2, s[8:11], s37 offen offset:3072 sc1 lds
s_add_u32 s38, s35, 12
s_and_b32 s38, s38, 15
s_lshl_b32 s38, s38, 17
s_add_u32 m0, s40, 114688
s_nop 0
buffer_load_dwordx4 v3, s[12:15], s38 offen lds
s_add_u32 m0, s40, 115712
s_add_u32 s38, s38, 16384
buffer_load_dwordx4 v3, s[12:15], s38 offen lds
v_lshlrev_b32 v24, 16, v144
v_and_b32 v25, 0xffff0000, v144
v_lshlrev_b32 v26, 16, v145
v_and_b32 v27, 0xffff0000, v145
v_lshlrev_b32 v28, 16, v146
v_and_b32 v29, 0xffff0000, v146
v_lshlrev_b32 v30, 16, v147
v_and_b32 v31, 0xffff0000, v147
v_add_f32 v240, v240, v24
v_add_f32 v241, v241, v25
v_add_f32 v242, v242, v26
v_add_f32 v243, v243, v27
v_add_f32 v244, v244, v28
v_add_f32 v245, v245, v29
v_add_f32 v246, v246, v30
v_add_f32 v247, v247, v31
s_load_dword s3, s[4:5], 43136
s_load_dword s3, s[4:5], 43200
s_load_dword s3, s[4:5], 50176
s_waitcnt vmcnt(14)
s_barrier
s_add_u32 s37, s35, 9
s_and_b32 s37, s37, 15
s_lshl_b32 s37, s37, 14
s_add_u32 m0, s39, 49152
s_nop 0
buffer_load_dwordx4 v2, s[8:11], s37 offen offset:0 sc1 lds
buffer_load_dwordx4 v2, s[8:11], s37 offen offset:1024 sc1 lds
buffer_load_dwordx4 v2, s[8:11], s37 offen offset:2048 sc1 lds
buffer_load_dwordx4 v2, s[8:11], s37 offen offset:3072 sc1 lds
s_add_u32 s38, s35, 13
s_and_b32 s38, s38, 15
s_lshl_b32 s38, s38, 17
s_add_u32 m0, s40, 122880
s_nop 0
buffer_load_dwordx4 v3, s[12:15], s38 offen lds
s_add_u32 m0, s40, 123904
s_add_u32 s38, s38, 16384
buffer_load_dwordx4 v3, s[12:15], s38 offen lds
v_lshlrev_b32 v24, 16, v148
v_and_b32 v25, 0xffff0000, v148
v_lshlrev_b32 v26, 16, v149
v_and_b32 v27, 0xffff0000, v149
v_lshlrev_b32 v28, 16, v150
v_and_b32 v29, 0xffff0000, v150
v_lshlrev_b32 v30, 16, v151
v_and_b32 v31, 0xffff0000, v151
v_add_f32 v240, v240, v24
v_add_f32 v241, v241, v25
v_add_f32 v242, v242, v26
v_add_f32 v243, v243, v27
v_add_f32 v244, v244, v28
v_add_f32 v245, v245, v29
v_add_f32 v246, v246, v30
v_add_f32 v247, v247, v31
s_load_dword s3, s[4:5], 50240
s_load_dword s3, s[4:5], 50304
s_load_dword s3, s[4:5], 50368
s_waitcnt vmcnt(14)
s_barrier
s_add_u32 s37, s35, 10
s_and_b32 s37, s37, 15
s_lshl_b32 s37, s37, 14
s_add_u32 m0, s39, 98304
s_nop 0
buffer_load_dwordx4 v2, s[8:11], s37 offen offset:0 sc1 lds
buffer_load_dwordx4 v2, s[8:11], s37 offen offset:1024 sc1 lds
buffer_load_dwordx4 v2, s[8:11], s37 offen offset:2048 sc1 lds
buffer_load_dwordx4 v2, s[8:11], s37 offen offset:3072 sc1 lds
s_add_u32 s38, s35, 14
s_and_b32 s38, s38, 15
s_lshl_b32 s38, s38, 17
s_add_u32 m0, s40, 131072
s_nop 0
buffer_load_dwordx4 v3, s[12:15], s38 offen lds
s_add_u32 m0, s40, 132096
s_add_u32 s38, s38, 16384
buffer_load_dwordx4 v3, s[12:15], s38 offen lds
v_lshlrev_b32 v24, 16, v152
v_and_b32 v25, 0xffff0000, v152
v_lshlrev_b32 v26, 16, v153
v_and_b32 v27, 0xffff0000, v153
v_lshlrev_b32 v28, 16, v154
v_and_b32 v29, 0xffff0000, v154
v_lshlrev_b32 v30, 16, v155
v_and_b32 v31, 0xffff0000, v155
v_add_f32 v240, v240, v24
v_add_f32 v241, v241, v25
v_add_f32 v242, v242, v26
v_add_f32 v243, v243, v27
v_add_f32 v244, v244, v28
v_add_f32 v245, v245, v29
v_add_f32 v246, v246, v30
v_add_f32 v247, v247, v31
s_load_dword s3, s[4:5], 57344
s_load_dword s3, s[4:5], 57408
s_load_dword s3, s[4:5], 57472
s_waitcnt vmcnt(14)
s_barrier
s_add_u32 s37, s35, 11
s_and_b32 s37, s37, 15
s_lshl_b32 s37, s37, 14
s_add_u32 m0, s39, 147456
s_nop 0
buffer_load_dwordx4 v2, s[8:11], s37 offen offset:0 sc1 lds
buffer_load_dwordx4 v2, s[8:11], s37 offen offset:1024 sc1 lds
buffer_load_dwordx4 v2, s[8:11], s37 offen offset:2048 sc1 lds
buffer_load_dwordx4 v2, s[8:11], s37 offen offset:3072 sc1 lds
s_add_u32 s38, s35, 15
s_and_b32 s38, s38, 15
s_lshl_b32 s38, s38, 17
s_add_u32 m0, s40, 139264
s_nop 0
buffer_load_dwordx4 v3, s[12:15], s38 offen lds
s_add_u32 m0, s40, 140288
s_add_u32 s38, s38, 16384
buffer_load_dwordx4 v3, s[12:15], s38 offen lds
v_lshlrev_b32 v24, 16, v156
v_and_b32 v25, 0xffff0000, v156
v_lshlrev_b32 v26, 16, v157
v_and_b32 v27, 0xffff0000, v157
v_lshlrev_b32 v28, 16, v158
v_and_b32 v29, 0xffff0000, v158
v_lshlrev_b32 v30, 16, v159
v_and_b32 v31, 0xffff0000, v159
v_add_f32 v240, v240, v24
v_add_f32 v241, v241, v25
v_add_f32 v242, v242, v26
v_add_f32 v243, v243, v27
v_add_f32 v244, v244, v28
v_add_f32 v245, v245, v29
v_add_f32 v246, v246, v30
v_add_f32 v247, v247, v31
s_load_dword s3, s[4:5], 57536
s_load_dword s3, s[4:5], 64512
s_load_dword s3, s[4:5], 64576
s_waitcnt vmcnt(14)
s_barrier
s_add_u32 s37, s35, 12
s_and_b32 s37, s37, 15
s_lshl_b32 s37, s37, 14
s_add_u32 m0, s39, 0
s_nop 0
buffer_load_dwordx4 v2, s[8:11], s37 offen offset:0 sc1 lds
buffer_load_dwordx4 v2, s[8:11], s37 offen offset:1024 sc1 lds
buffer_load_dwordx4 v2, s[8:11], s37 offen offset:2048 sc1 lds
buffer_load_dwordx4 v2, s[8:11], s37 offen offset:3072 sc1 lds
s_load_dword s3, s[4:5], 64640
s_branch Lov_7
.p2align 12
.fill 48, 4, 0xbf800000
Lst_7_0:
s_branch Lwr_152
s_nop 0
s_nop 0
Lov_7:
s_load_dword s3, s[4:5], 64704
s_load_dword s3, s[4:5], 71680
s_waitcnt vmcnt(12)
s_barrier
s_add_u32 s37, s35, 13
s_and_b32 s37, s37, 15
s_lshl_b32 s37, s37, 14
s_add_u32 m0, s39, 49152
s_nop 0
buffer_load_dwordx4 v2, s[8:11], s37 offen offset:0 sc1 lds
buffer_load_dwordx4 v2, s[8:11], s37 offen offset:1024 sc1 lds
buffer_load_dwordx4 v2, s[8:11], s37 offen offset:2048 sc1 lds
buffer_load_dwordx4 v2, s[8:11], s37 offen offset:3072 sc1 lds
s_load_dword s3, s[4:5], 71744
s_load_dword s3, s[4:5], 71808
s_load_dword s3, s[4:5], 71872
s_waitcnt vmcnt(10)
s_barrier
s_add_u32 s37, s35, 14
s_and_b32 s37, s37, 15
s_lshl_b32 s37, s37, 14
s_add_u32 m0, s39, 98304
s_nop 0
buffer_load_dwordx4 v2, s[8:11], s37 offen offset:0 sc1 lds
buffer_load_dwordx4 v2, s[8:11], s37 offen offset:1024 sc1 lds
buffer_load_dwordx4 v2, s[8:11], s37 offen offset:2048 sc1 lds
buffer_load_dwordx4 v2, s[8:11], s37 offen offset:3072 sc1 lds
s_waitcnt vmcnt(8)
s_barrier
s_add_u32 s37, s35, 15
s_and_b32 s37, s37, 15
s_lshl_b32 s37, s37, 14
s_add_u32 m0, s39, 147456
s_nop 0
buffer_load_dwordx4 v2, s[8:11], s37 offen offset:0 sc1 lds
buffer_load_dwordx4 v2, s[8:11], s37 offen offset:1024 sc1 lds
buffer_load_dwordx4 v2, s[8:11], s37 offen offset:2048 sc1 lds
buffer_load_dwordx4 v2, s[8:11], s37 offen offset:3072 sc1 lds
s_waitcnt vmcnt(8)
s_barrier
s_nop 0
v_permlane32_swap_b32 v240, v244
v_permlane32_swap_b32 v241, v245
v_permlane32_swap_b32 v242, v246
v_permlane32_swap_b32 v243, v247
v_add_f32 v240, v240, v244
v_add_f32 v241, v241, v245
v_add_f32 v242, v242, v246
v_add_f32 v243, v243, v247
s_nop 0
v_permlane16_swap_b32 v240, v242
v_permlane16_swap_b32 v241, v243
v_add_f32 v240, v240, v242
v_add_f32 v241, v241, v243
s_waitcnt vmcnt(4)
s_barrier
s_add_u32 s38, s35, 0
s_and_b32 s38, s38, 15
s_mul_i32 s38, s38, 458752
s_add_u32 m0, s50, 0
s_nop 0
buffer_load_dwordx4 v192, s[16:19], s38 offen lds
s_add_u32 m0, s50, 1024
s_nop 0
buffer_load_dwordx4 v193, s[16:19], s38 offen lds
s_add_u32 m0, s50, 2048
s_nop 0
buffer_load_dwordx4 v194, s[16:19], s38 offen lds
s_add_u32 m0, s50, 3072
s_add_u32 s38, s38, 114688
buffer_load_dwordx4 v192, s[16:19], s38 offen lds
s_add_u32 m0, s50, 4096
s_nop 0
buffer_load_dwordx4 v193, s[16:19], s38 offen lds
s_add_u32 m0, s50, 5120
s_nop 0
buffer_load_dwordx4 v194, s[16:19], s38 offen lds
s_add_u32 s38, s35, 1
s_and_b32 s38, s38, 15
s_mul_i32 s38, s38, 458752
s_add_u32 m0, s50, 49152
s_nop 0
buffer_load_dwordx4 v192, s[16:19], s38 offen lds
s_add_u32 m0, s50, 50176
s_nop 0
buffer_load_dwordx4 v193, s[16:19], s38 offen lds
s_add_u32 m0, s50, 51200
s_nop 0
buffer_load_dwordx4 v194, s[16:19], s38 offen lds
s_add_u32 m0, s50, 52224
s_add_u32 s38, s38, 114688
buffer_load_dwordx4 v192, s[16:19], s38 offen lds
s_add_u32 m0, s50, 53248
s_nop 0
buffer_load_dwordx4 v193, s[16:19], s38 offen lds
s_add_u32 m0, s50, 54272
s_nop 0
buffer_load_dwordx4 v194, s[16:19], s38 offen lds
s_waitcnt vmcnt(12)
s_barrier
s_barrier
s_branch Lk3a
Lk2end_83:
Lk3:
s_branch Lgb_97
Lk3a:
s_mul_i32 s43, s34, 262144
s_add_u32 s8, s82, s43
s_addc_u32 s9, s83, 0
s_add_u32 s8, s8, 4194304
s_addc_u32 s9, s9, 0
s_mov_b32 s10, 262144
s_mov_b32 s11, 0x20000
s_mul_i32 s43, s34, 917504
s_add_u32 s24, s82, s43
s_addc_u32 s25, s83, 0
s_add_u32 s24, s24, 8388608
s_addc_u32 s25, s25, 0
s_mov_b32 s26, 917504
s_mov_b32 s27, 0x20000
s_add_u32 s84, s82, 27262976
s_addc_u32 s85, s83, 0
s_mov_b32 s86, 229376
s_mov_b32 s87, 0x20000
s_and_b32 s47, s36, 3
s_lshr_b32 s62, s47, 1
s_and_b32 s63, s47, 1
v_lshlrev_b32 v2, 4, v1
s_lshl_b32 s39, s47, 12
v_add_u32 v3, s39, v2
s_bitcmp0_b32 s36, 1
s_cselect_b32 s44, s72, s74
s_cselect_b32 s45, s73, s75
s_mul_i32 s43, s35, 256
s_add_u32 s12, s44, s43
s_addc_u32 s13, s45, 0
s_mov_b32 s14, 7333120
s_mov_b32 s15, 0x20000
s_and_b32 s43, s36, 1
s_mul_i32 s43, s43, 229376
v_lshrrev_b32 v28, 4, v1
v_lshlrev_b32 v29, 1, v28
v_and_b32 v4, 15, v1
v_xor_b32 v4, v4, v29
v_lshlrev_b32 v4, 4, v4
v_mul_u32_u24 v28, 7168, v28
v_add_u32 v4, v4, v28
v_add_u32 v4, s43, v4
v_xor_b32 v5, 128, v4
v_add_u32 v5, 28672, v5
s_and_b32 s43, s36, 3
s_mul_i32 s40, s43, 8192
s_add_u32 s40, s40, 16384
v_mov_b32 v6, v192
v_mov_b32 v7, v193
v_mov_b32 v8, v194
s_lshl_b32 s43, s62, 12
v_add_u32 v9, s43, v2
v_add_u32 v10, 98304, v9
s_lshl_b32 s43, s47, 9
s_add_u32 s43, s43, 151552
v_and_b32 v28, 15, v1
v_lshl_add_u32 v28, v28, 5, s43
v_lshrrev_b32 v29, 4, v1
v_lshl_add_u32 v28, v29, 3, v28
ds_write_b64 v28, v[240:241]
s_waitcnt lgkmcnt(0)
v_lshrrev_b32 v27, 2, v1
v_bfe_u32 v28, v27, 2, 1
v_mul_u32_u24 v27, 192, v27
v_add_u32 v27, 16384, v27
v_and_b32 v29, 3, v1
v_lshl_add_u32 v12, v29, 3, v27
s_lshl_b32 s43, s63, 6
v_add_u32 v12, s43, v12
v_lshl_add_u32 v11, v28, 5, v12
v_xor_b32 v30, 1, v28
v_lshl_add_u32 v12, v30, 5, v12
v_xor_b32 v28, s63, v28
v_lshl_add_u32 v27, v28, 4, v27
v_lshrrev_b32 v28, 1, v29
v_lshl_add_u32 v27, v28, 5, v27
v_and_b32 v28, 1, v29
v_lshl_add_u32 v27, v28, 3, v27
v_add_u32 v13, 128, v27
v_add_u32 v14, 49152, v11
v_add_u32 v15, 49152, v12
v_add_u32 v16, 49152, v13
v_add_u32 v17, 98304, v11
v_add_u32 v18, 98304, v12
v_add_u32 v19, 98304, v13
s_cmp_lg_u32 s36, 4
s_cbranch_scc1 Lwm_99
s_branch Lst_8_1
Lwr_164:
s_branch Lwe_98
Lwm_99:
s_cmp_lg_u32 s36, 5
s_cbranch_scc1 Lwm_100
s_branch Lst_9_1
Lwr_165:
s_branch Lwe_98
Lwm_100:
s_cmp_lg_u32 s36, 6
s_cbranch_scc1 Lwm_101
s_branch Lst_10_1
Lwr_166:
s_branch Lwe_98
Lwm_101:
s_cmp_lg_u32 s36, 7
s_cbranch_scc1 Lwm_102
s_nop 0
s_branch Lwe_98
Lwm_102:
Lwe_98:
s_barrier
s_cmp_lg_u32 s36, 4
s_cbranch_scc1 Lwm_104
s_branch Lst_11_1
Lwr_168:
s_branch Lwe_103
Lwm_104:
s_cmp_lg_u32 s36, 5
s_cbranch_scc1 Lwm_105
s_branch Lst_12_1
Lwr_169:
s_branch Lwe_103
Lwm_105:
s_cmp_lg_u32 s36, 6
s_cbranch_scc1 Lwm_106
s_branch Lst_13_1
Lwr_170:
s_branch Lwe_103
Lwm_106:
s_cmp_lg_u32 s36, 7
s_cbranch_scc1 Lwm_107
s_branch Lst_14_1
Lwr_171:
s_branch Lwe_103
Lwm_107:
Lwe_103:
s_waitcnt vmcnt(0) lgkmcnt(0)
s_barrier
ds_read_b128 v[32:35], v9 offset:0
ds_read_b64_tr_b16 v[48:49], v11 offset:0
ds_read_b64_tr_b16 v[50:51], v11 offset:3072
ds_read_b64_tr_b16 v[52:53], v12 offset:0
ds_read_b64_tr_b16 v[54:55], v12 offset:3072
ds_read_b64_tr_b16 v[56:57], v13 offset:0
ds_read_b64_tr_b16 v[58:59], v13 offset:3072
ds_read_b64_tr_b16 v[60:61], v11 offset:12288
ds_read_b64_tr_b16 v[62:63], v11 offset:15360
ds_read_b64_tr_b16 v[64:65], v12 offset:12288
ds_read_b64_tr_b16 v[66:67], v12 offset:15360
ds_read_b64_tr_b16 v[68:69], v13 offset:12288
ds_read_b64_tr_b16 v[70:71], v13 offset:15360
ds_read_b128 v[36:39], v9 offset:1024
ds_read_b128 v[40:43], v9 offset:2048
ds_read_b128 v[44:47], v9 offset:3072
s_waitcnt lgkmcnt(0)
v_mfma_f32_16x16x32_bf16 v[128:131], v[48:51], v[32:35], 0
ds_read_b128 v[72:75], v9 offset:8192
v_mfma_f32_16x16x32_bf16 v[132:135], v[52:55], v[32:35], 0
ds_read_b64_tr_b16 v[88:89], v11 offset:6144
v_mfma_f32_16x16x32_bf16 v[136:139], v[56:59], v[32:35], 0
ds_read_b64_tr_b16 v[90:91], v11 offset:9216
v_mfma_f32_16x16x32_bf16 v[140:143], v[60:63], v[32:35], 0
ds_read_b64_tr_b16 v[92:93], v12 offset:6144
v_mfma_f32_16x16x32_bf16 v[144:147], v[64:67], v[32:35], 0
ds_read_b64_tr_b16 v[94:95], v12 offset:9216
v_mfma_f32_16x16x32_bf16 v[148:151], v[68:71], v[32:35], 0
ds_read_b64_tr_b16 v[96:97], v13 offset:6144
v_mfma_f32_16x16x32_bf16 v[172:175], v[68:71], v[36:39], 0
ds_read_b64_tr_b16 v[98:99], v13 offset:9216
v_mfma_f32_16x16x32_bf16 v[168:171], v[64:67], v[36:39], 0
ds_read_b64_tr_b16 v[100:101], v11 offset:18432
v_mfma_f32_16x16x32_bf16 v[164:167], v[60:63], v[36:39], 0
ds_read_b64_tr_b16 v[102:103], v11 offset:21504
v_mfma_f32_16x16x32_bf16 v[160:163], v[56:59], v[36:39], 0
ds_read_b64_tr_b16 v[104:105], v12 offset:18432
v_mfma_f32_16x16x32_bf16 v[156:159], v[52:55], v[36:39], 0
ds_read_b64_tr_b16 v[106:107], v12 offset:21504
v_mfma_f32_16x16x32_bf16 v[152:155], v[48:51], v[36:39], 0
ds_read_b64_tr_b16 v[108:109], v13 offset:18432
v_mfma_f32_16x16x32_bf16 v[176:179], v[48:51], v[40:43], 0
ds_read_b64_tr_b16 v[110:111], v13 offset:21504
v_mfma_f32_16x16x32_bf16 v[180:183], v[52:55], v[40:43], 0
ds_read_b128 v[76:79], v9 offset:9216
v_mfma_f32_16x16x32_bf16 v[184:187], v[56:59], v[40:43], 0
ds_read_b128 v[80:83], v9 offset:10240
v_mfma_f32_16x16x32_bf16 v[188:191], v[60:63], v[40:43], 0
ds_read_b128 v[84:87], v9 offset:11264
v_mfma_f32_16x16x32_bf16 v[192:195], v[64:67], v[40:43], 0
v_mfma_f32_16x16x32_bf16 v[196:199], v[68:71], v[40:43], 0
v_mfma_f32_16x16x32_bf16 v[220:223], v[68:71], v[44:47], 0
v_mfma_f32_16x16x32_bf16 v[216:219], v[64:67], v[44:47], 0
v_mfma_f32_16x16x32_bf16 v[212:215], v[60:63], v[44:47], 0
v_mfma_f32_16x16x32_bf16 v[208:211], v[56:59], v[44:47], 0
v_mfma_f32_16x16x32_bf16 v[204:207], v[52:55], v[44:47], 0
v_mfma_f32_16x16x32_bf16 v[200:203], v[48:51], v[44:47], 0
s_waitcnt lgkmcnt(0)
s_barrier
v_mfma_f32_16x16x32_bf16 v[128:131], v[88:91], v[72:75], v[128:131]
ds_read_b128 v[32:35], v9 offset:49152
v_mfma_f32_16x16x32_bf16 v[132:135], v[92:95], v[72:75], v[132:135]
ds_read_b64_tr_b16 v[48:49], v14 offset:0
v_mfma_f32_16x16x32_bf16 v[136:139], v[96:99], v[72:75], v[136:139]
ds_read_b64_tr_b16 v[50:51], v14 offset:3072
v_mfma_f32_16x16x32_bf16 v[140:143], v[100:103], v[72:75], v[140:143]
ds_read_b64_tr_b16 v[52:53], v15 offset:0
v_mfma_f32_16x16x32_bf16 v[144:147], v[104:107], v[72:75], v[144:147]
ds_read_b64_tr_b16 v[54:55], v15 offset:3072
v_mfma_f32_16x16x32_bf16 v[148:151], v[108:111], v[72:75], v[148:151]
ds_read_b64_tr_b16 v[56:57], v16 offset:0
v_mfma_f32_16x16x32_bf16 v[172:175], v[108:111], v[76:79], v[172:175]
ds_read_b64_tr_b16 v[58:59], v16 offset:3072
v_mfma_f32_16x16x32_bf16 v[168:171], v[104:107], v[76:79], v[168:171]
ds_read_b64_tr_b16 v[60:61], v14 offset:12288
v_mfma_f32_16x16x32_bf16 v[164:167], v[100:103], v[76:79], v[164:167]
ds_read_b64_tr_b16 v[62:63], v14 offset:15360
v_mfma_f32_16x16x32_bf16 v[160:163], v[96:99], v[76:79], v[160:163]
ds_read_b64_tr_b16 v[64:65], v15 offset:12288
v_mfma_f32_16x16x32_bf16 v[156:159], v[92:95], v[76:79], v[156:159]
ds_read_b64_tr_b16 v[66:67], v15 offset:15360
v_mfma_f32_16x16x32_bf16 v[152:155], v[88:91], v[76:79], v[152:155]
ds_read_b64_tr_b16 v[68:69], v16 offset:12288
v_mfma_f32_16x16x32_bf16 v[176:179], v[88:91], v[80:83], v[176:179]
ds_read_b64_tr_b16 v[70:71], v16 offset:15360
v_mfma_f32_16x16x32_bf16 v[180:183], v[92:95], v[80:83], v[180:183]
ds_read_b128 v[36:39], v9 offset:50176
v_mfma_f32_16x16x32_bf16 v[184:187], v[96:99], v[80:83], v[184:187]
ds_read_b128 v[40:43], v9 offset:51200
v_mfma_f32_16x16x32_bf16 v[188:191], v[100:103], v[80:83], v[188:191]
ds_read_b128 v[44:47], v9 offset:52224
v_mfma_f32_16x16x32_bf16 v[192:195], v[104:107], v[80:83], v[192:195]
v_mfma_f32_16x16x32_bf16 v[196:199], v[108:111], v[80:83], v[196:199]
v_mfma_f32_16x16x32_bf16 v[220:223], v[108:111], v[84:87], v[220:223]
v_mfma_f32_16x16x32_bf16 v[216:219], v[104:107], v[84:87], v[216:219]
v_mfma_f32_16x16x32_bf16 v[212:215], v[100:103], v[84:87], v[212:215]
v_mfma_f32_16x16x32_bf16 v[208:211], v[96:99], v[84:87], v[208:211]
v_mfma_f32_16x16x32_bf16 v[204:207], v[92:95], v[84:87], v[204:207]
v_mfma_f32_16x16x32_bf16 v[200:203], v[88:91], v[84:87], v[200:203]
s_mov_b32 s41, 5
Lk3l_108:
s_waitcnt lgkmcnt(0)
v_mfma_f32_16x16x32_bf16 v[128:131], v[48:51], v[32:35], v[128:131]
ds_read_b128 v[72:75], v9 offset:57344
v_mfma_f32_16x16x32_bf16 v[132:135], v[52:55], v[32:35], v[132:135]
ds_read_b64_tr_b16 v[88:89], v14 offset:6144
v_mfma_f32_16x16x32_bf16 v[136:139], v[56:59], v[32:35], v[136:139]
ds_read_b64_tr_b16 v[90:91], v14 offset:9216
v_mfma_f32_16x16x32_bf16 v[140:143], v[60:63], v[32:35], v[140:143]
ds_read_b64_tr_b16 v[92:93], v15 offset:6144
v_mfma_f32_16x16x32_bf16 v[144:147], v[64:67], v[32:35], v[144:147]
ds_read_b64_tr_b16 v[94:95], v15 offset:9216
v_mfma_f32_16x16x32_bf16 v[148:151], v[68:71], v[32:35], v[148:151]
ds_read_b64_tr_b16 v[96:97], v16 offset:6144
v_mfma_f32_16x16x32_bf16 v[172:175], v[68:71], v[36:39], v[172:175]
ds_read_b64_tr_b16 v[98:99], v16 offset:9216
v_mfma_f32_16x16x32_bf16 v[168:171], v[64:67], v[36:39], v[168:171]
ds_read_b64_tr_b16 v[100:101], v14 offset:18432
v_mfma_f32_16x16x32_bf16 v[164:167], v[60:63], v[36:39], v[164:167]
ds_read_b64_tr_b16 v[102:103], v14 offset:21504
v_mfma_f32_16x16x32_bf16 v[160:163], v[56:59], v[36:39], v[160:163]
ds_read_b64_tr_b16 v[104:105], v15 offset:18432
v_mfma_f32_16x16x32_bf16 v[156:159], v[52:55], v[36:39], v[156:159]
ds_read_b64_tr_b16 v[106:107], v15 offset:21504
v_mfma_f32_16x16x32_bf16 v[152:155], v[48:51], v[36:39], v[152:155]
ds_read_b64_tr_b16 v[108:109], v16 offset:18432
v_mfma_f32_16x16x32_bf16 v[176:179], v[48:51], v[40:43], v[176:179]
ds_read_b64_tr_b16 v[110:111], v16 offset:21504
v_mfma_f32_16x16x32_bf16 v[180:183], v[52:55], v[40:43], v[180:183]
ds_read_b128 v[76:79], v9 offset:58368
v_mfma_f32_16x16x32_bf16 v[184:187], v[56:59], v[40:43], v[184:187]
ds_read_b128 v[80:83], v9 offset:59392
v_mfma_f32_16x16x32_bf16 v[188:191], v[60:63], v[40:43], v[188:191]
ds_read_b128 v[84:87], v9 offset:60416
v_mfma_f32_16x16x32_bf16 v[192:195], v[64:67], v[40:43], v[192:195]
v_mfma_f32_16x16x32_bf16 v[196:199], v[68:71], v[40:43], v[196:199]
v_mfma_f32_16x16x32_bf16 v[220:223], v[68:71], v[44:47], v[220:223]
v_mfma_f32_16x16x32_bf16 v[216:219], v[64:67], v[44:47], v[216:219]
v_mfma_f32_16x16x32_bf16 v[212:215], v[60:63], v[44:47], v[212:215]
v_mfma_f32_16x16x32_bf16 v[208:211], v[56:59], v[44:47], v[208:211]
v_mfma_f32_16x16x32_bf16 v[204:207], v[52:55], v[44:47], v[204:207]
v_mfma_f32_16x16x32_bf16 v[200:203], v[48:51], v[44:47], v[200:203]
s_waitcnt lgkmcnt(0)
s_barrier
v_mfma_f32_16x16x32_bf16 v[128:131], v[88:91], v[72:75], v[128:131]
ds_read_b128 v[32:35], v10 offset:0
v_mfma_f32_16x16x32_bf16 v[132:135], v[92:95], v[72:75], v[132:135]
ds_read_b64_tr_b16 v[48:49], v17 offset:0
v_mfma_f32_16x16x32_bf16 v[136:139], v[96:99], v[72:75], v[136:139]
ds_read_b64_tr_b16 v[50:51], v17 offset:3072
v_mfma_f32_16x16x32_bf16 v[140:143], v[100:103], v[72:75], v[140:143]
ds_read_b64_tr_b16 v[52:53], v18 offset:0
v_mfma_f32_16x16x32_bf16 v[144:147], v[104:107], v[72:75], v[144:147]
ds_read_b64_tr_b16 v[54:55], v18 offset:3072
v_mfma_f32_16x16x32_bf16 v[148:151], v[108:111], v[72:75], v[148:151]
ds_read_b64_tr_b16 v[56:57], v19 offset:0
v_mfma_f32_16x16x32_bf16 v[172:175], v[108:111], v[76:79], v[172:175]
ds_read_b64_tr_b16 v[58:59], v19 offset:3072
v_mfma_f32_16x16x32_bf16 v[168:171], v[104:107], v[76:79], v[168:171]
ds_read_b64_tr_b16 v[60:61], v17 offset:12288
v_mfma_f32_16x16x32_bf16 v[164:167], v[100:103], v[76:79], v[164:167]
ds_read_b64_tr_b16 v[62:63], v17 offset:15360
v_mfma_f32_16x16x32_bf16 v[160:163], v[96:99], v[76:79], v[160:163]
ds_read_b64_tr_b16 v[64:65], v18 offset:12288
v_mfma_f32_16x16x32_bf16 v[156:159], v[92:95], v[76:79], v[156:159]
ds_read_b64_tr_b16 v[66:67], v18 offset:15360
v_mfma_f32_16x16x32_bf16 v[152:155], v[88:91], v[76:79], v[152:155]
ds_read_b64_tr_b16 v[68:69], v19 offset:12288
v_mfma_f32_16x16x32_bf16 v[176:179], v[88:91], v[80:83], v[176:179]
ds_read_b64_tr_b16 v[70:71], v19 offset:15360
v_mfma_f32_16x16x32_bf16 v[180:183], v[92:95], v[80:83], v[180:183]
ds_read_b128 v[36:39], v10 offset:1024
v_mfma_f32_16x16x32_bf16 v[184:187], v[96:99], v[80:83], v[184:187]
ds_read_b128 v[40:43], v10 offset:2048
v_mfma_f32_16x16x32_bf16 v[188:191], v[100:103], v[80:83], v[188:191]
ds_read_b128 v[44:47], v10 offset:3072
v_mfma_f32_16x16x32_bf16 v[192:195], v[104:107], v[80:83], v[192:195]
v_mfma_f32_16x16x32_bf16 v[196:199], v[108:111], v[80:83], v[196:199]
v_mfma_f32_16x16x32_bf16 v[220:223], v[108:111], v[84:87], v[220:223]
v_mfma_f32_16x16x32_bf16 v[216:219], v[104:107], v[84:87], v[216:219]
v_mfma_f32_16x16x32_bf16 v[212:215], v[100:103], v[84:87], v[212:215]
v_mfma_f32_16x16x32_bf16 v[208:211], v[96:99], v[84:87], v[208:211]
v_mfma_f32_16x16x32_bf16 v[204:207], v[92:95], v[84:87], v[204:207]
v_mfma_f32_16x16x32_bf16 v[200:203], v[88:91], v[84:87], v[200:203]
s_waitcnt lgkmcnt(0)
v_mfma_f32_16x16x32_bf16 v[128:131], v[48:51], v[32:35], v[128:131]
ds_read_b128 v[72:75], v10 offset:8192
v_mfma_f32_16x16x32_bf16 v[132:135], v[52:55], v[32:35], v[132:135]
ds_read_b64_tr_b16 v[88:89], v17 offset:6144
v_mfma_f32_16x16x32_bf16 v[136:139], v[56:59], v[32:35], v[136:139]
ds_read_b64_tr_b16 v[90:91], v17 offset:9216
v_mfma_f32_16x16x32_bf16 v[140:143], v[60:63], v[32:35], v[140:143]
ds_read_b64_tr_b16 v[92:93], v18 offset:6144
v_mfma_f32_16x16x32_bf16 v[144:147], v[64:67], v[32:35], v[144:147]
ds_read_b64_tr_b16 v[94:95], v18 offset:9216
v_mfma_f32_16x16x32_bf16 v[148:151], v[68:71], v[32:35], v[148:151]
ds_read_b64_tr_b16 v[96:97], v19 offset:6144
v_mfma_f32_16x16x32_bf16 v[172:175], v[68:71], v[36:39], v[172:175]
ds_read_b64_tr_b16 v[98:99], v19 offset:9216
v_mfma_f32_16x16x32_bf16 v[168:171], v[64:67], v[36:39], v[168:171]
ds_read_b64_tr_b16 v[100:101], v17 offset:18432
v_mfma_f32_16x16x32_bf16 v[164:167], v[60:63], v[36:39], v[164:167]
ds_read_b64_tr_b16 v[102:103], v17 offset:21504
v_mfma_f32_16x16x32_bf16 v[160:163], v[56:59], v[36:39], v[160:163]
ds_read_b64_tr_b16 v[104:105], v18 offset:18432
v_mfma_f32_16x16x32_bf16 v[156:159], v[52:55], v[36:39], v[156:159]
ds_read_b64_tr_b16 v[106:107], v18 offset:21504
v_mfma_f32_16x16x32_bf16 v[152:155], v[48:51], v[36:39], v[152:155]
ds_read_b64_tr_b16 v[108:109], v19 offset:18432
v_mfma_f32_16x16x32_bf16 v[176:179], v[48:51], v[40:43], v[176:179]
ds_read_b64_tr_b16 v[110:111], v19 offset:21504
v_mfma_f32_16x16x32_bf16 v[180:183], v[52:55], v[40:43], v[180:183]
ds_read_b128 v[76:79], v10 offset:9216
v_mfma_f32_16x16x32_bf16 v[184:187], v[56:59], v[40:43], v[184:187]
ds_read_b128 v[80:83], v10 offset:10240
v_mfma_f32_16x16x32_bf16 v[188:191], v[60:63], v[40:43], v[188:191]
ds_read_b128 v[84:87], v10 offset:11264
v_mfma_f32_16x16x32_bf16 v[192:195], v[64:67], v[40:43], v[192:195]
v_mfma_f32_16x16x32_bf16 v[196:199], v[68:71], v[40:43], v[196:199]
v_mfma_f32_16x16x32_bf16 v[220:223], v[68:71], v[44:47], v[220:223]
v_mfma_f32_16x16x32_bf16 v[216:219], v[64:67], v[44:47], v[216:219]
v_mfma_f32_16x16x32_bf16 v[212:215], v[60:63], v[44:47], v[212:215]
v_mfma_f32_16x16x32_bf16 v[208:211], v[56:59], v[44:47], v[208:211]
v_mfma_f32_16x16x32_bf16 v[204:207], v[52:55], v[44:47], v[204:207]
v_mfma_f32_16x16x32_bf16 v[200:203], v[48:51], v[44:47], v[200:203]
s_waitcnt lgkmcnt(0)
s_barrier
v_mfma_f32_16x16x32_bf16 v[128:131], v[88:91], v[72:75], v[128:131]
ds_read_b128 v[32:35], v9 offset:0
v_mfma_f32_16x16x32_bf16 v[132:135], v[92:95], v[72:75], v[132:135]
ds_read_b64_tr_b16 v[48:49], v11 offset:0
v_mfma_f32_16x16x32_bf16 v[136:139], v[96:99], v[72:75], v[136:139]
ds_read_b64_tr_b16 v[50:51], v11 offset:3072
v_mfma_f32_16x16x32_bf16 v[140:143], v[100:103], v[72:75], v[140:143]
ds_read_b64_tr_b16 v[52:53], v12 offset:0
v_mfma_f32_16x16x32_bf16 v[144:147], v[104:107], v[72:75], v[144:147]
ds_read_b64_tr_b16 v[54:55], v12 offset:3072
v_mfma_f32_16x16x32_bf16 v[148:151], v[108:111], v[72:75], v[148:151]
ds_read_b64_tr_b16 v[56:57], v13 offset:0
v_mfma_f32_16x16x32_bf16 v[172:175], v[108:111], v[76:79], v[172:175]
ds_read_b64_tr_b16 v[58:59], v13 offset:3072
v_mfma_f32_16x16x32_bf16 v[168:171], v[104:107], v[76:79], v[168:171]
ds_read_b64_tr_b16 v[60:61], v11 offset:12288
v_mfma_f32_16x16x32_bf16 v[164:167], v[100:103], v[76:79], v[164:167]
ds_read_b64_tr_b16 v[62:63], v11 offset:15360
v_mfma_f32_16x16x32_bf16 v[160:163], v[96:99], v[76:79], v[160:163]
ds_read_b64_tr_b16 v[64:65], v12 offset:12288
v_mfma_f32_16x16x32_bf16 v[156:159], v[92:95], v[76:79], v[156:159]
ds_read_b64_tr_b16 v[66:67], v12 offset:15360
v_mfma_f32_16x16x32_bf16 v[152:155], v[88:91], v[76:79], v[152:155]
ds_read_b64_tr_b16 v[68:69], v13 offset:12288
v_mfma_f32_16x16x32_bf16 v[176:179], v[88:91], v[80:83], v[176:179]
ds_read_b64_tr_b16 v[70:71], v13 offset:15360
v_mfma_f32_16x16x32_bf16 v[180:183], v[92:95], v[80:83], v[180:183]
ds_read_b128 v[36:39], v9 offset:1024
v_mfma_f32_16x16x32_bf16 v[184:187], v[96:99], v[80:83], v[184:187]
ds_read_b128 v[40:43], v9 offset:2048
v_mfma_f32_16x16x32_bf16 v[188:191], v[100:103], v[80:83], v[188:191]
ds_read_b128 v[44:47], v9 offset:3072
v_mfma_f32_16x16x32_bf16 v[192:195], v[104:107], v[80:83], v[192:195]
v_mfma_f32_16x16x32_bf16 v[196:199], v[108:111], v[80:83], v[196:199]
v_mfma_f32_16x16x32_bf16 v[220:223], v[108:111], v[84:87], v[220:223]
v_mfma_f32_16x16x32_bf16 v[216:219], v[104:107], v[84:87], v[216:219]
v_mfma_f32_16x16x32_bf16 v[212:215], v[100:103], v[84:87], v[212:215]
v_mfma_f32_16x16x32_bf16 v[208:211], v[96:99], v[84:87], v[208:211]
v_mfma_f32_16x16x32_bf16 v[204:207], v[92:95], v[84:87], v[204:207]
v_mfma_f32_16x16x32_bf16 v[200:203], v[88:91], v[84:87], v[200:203]
s_waitcnt lgkmcnt(0)
v_mfma_f32_16x16x32_bf16 v[128:131], v[48:51], v[32:35], v[128:131]
ds_read_b128 v[72:75], v9 offset:8192
v_mfma_f32_16x16x32_bf16 v[132:135], v[52:55], v[32:35], v[132:135]
ds_read_b64_tr_b16 v[88:89], v11 offset:6144
v_mfma_f32_16x16x32_bf16 v[136:139], v[56:59], v[32:35], v[136:139]
ds_read_b64_tr_b16 v[90:91], v11 offset:9216
v_mfma_f32_16x16x32_bf16 v[140:143], v[60:63], v[32:35], v[140:143]
ds_read_b64_tr_b16 v[92:93], v12 offset:6144
v_mfma_f32_16x16x32_bf16 v[144:147], v[64:67], v[32:35], v[144:147]
ds_read_b64_tr_b16 v[94:95], v12 offset:9216
v_mfma_f32_16x16x32_bf16 v[148:151], v[68:71], v[32:35], v[148:151]
ds_read_b64_tr_b16 v[96:97], v13 offset:6144
v_mfma_f32_16x16x32_bf16 v[172:175], v[68:71], v[36:39], v[172:175]
ds_read_b64_tr_b16 v[98:99], v13 offset:9216
v_mfma_f32_16x16x32_bf16 v[168:171], v[64:67], v[36:39], v[168:171]
ds_read_b64_tr_b16 v[100:101], v11 offset:18432
v_mfma_f32_16x16x32_bf16 v[164:167], v[60:63], v[36:39], v[164:167]
ds_read_b64_tr_b16 v[102:103], v11 offset:21504
v_mfma_f32_16x16x32_bf16 v[160:163], v[56:59], v[36:39], v[160:163]
ds_read_b64_tr_b16 v[104:105], v12 offset:18432
v_mfma_f32_16x16x32_bf16 v[156:159], v[52:55], v[36:39], v[156:159]
ds_read_b64_tr_b16 v[106:107], v12 offset:21504
v_mfma_f32_16x16x32_bf16 v[152:155], v[48:51], v[36:39], v[152:155]
ds_read_b64_tr_b16 v[108:109], v13 offset:18432
v_mfma_f32_16x16x32_bf16 v[176:179], v[48:51], v[40:43], v[176:179]
ds_read_b64_tr_b16 v[110:111], v13 offset:21504
v_mfma_f32_16x16x32_bf16 v[180:183], v[52:55], v[40:43], v[180:183]
ds_read_b128 v[76:79], v9 offset:9216
v_mfma_f32_16x16x32_bf16 v[184:187], v[56:59], v[40:43], v[184:187]
ds_read_b128 v[80:83], v9 offset:10240
v_mfma_f32_16x16x32_bf16 v[188:191], v[60:63], v[40:43], v[188:191]
ds_read_b128 v[84:87], v9 offset:11264
v_mfma_f32_16x16x32_bf16 v[192:195], v[64:67], v[40:43], v[192:195]
v_mfma_f32_16x16x32_bf16 v[196:199], v[68:71], v[40:43], v[196:199]
v_mfma_f32_16x16x32_bf16 v[220:223], v[68:71], v[44:47], v[220:223]
v_mfma_f32_16x16x32_bf16 v[216:219], v[64:67], v[44:47], v[216:219]
v_mfma_f32_16x16x32_bf16 v[212:215], v[60:63], v[44:47], v[212:215]
v_mfma_f32_16x16x32_bf16 v[208:211], v[56:59], v[44:47], v[208:211]
v_mfma_f32_16x16x32_bf16 v[204:207], v[52:55], v[44:47], v[204:207]
v_mfma_f32_16x16x32_bf16 v[200:203], v[48:51], v[44:47], v[200:203]
s_waitcnt lgkmcnt(0)
s_barrier
v_mfma_f32_16x16x32_bf16 v[128:131], v[88:91], v[72:75], v[128:131]
ds_read_b128 v[32:35], v9 offset:49152
v_mfma_f32_16x16x32_bf16 v[132:135], v[92:95], v[72:75], v[132:135]
ds_read_b64_tr_b16 v[48:49], v14 offset:0
v_mfma_f32_16x16x32_bf16 v[136:139], v[96:99], v[72:75], v[136:139]
ds_read_b64_tr_b16 v[50:51], v14 offset:3072
v_mfma_f32_16x16x32_bf16 v[140:143], v[100:103], v[72:75], v[140:143]
ds_read_b64_tr_b16 v[52:53], v15 offset:0
v_mfma_f32_16x16x32_bf16 v[144:147], v[104:107], v[72:75], v[144:147]
ds_read_b64_tr_b16 v[54:55], v15 offset:3072
v_mfma_f32_16x16x32_bf16 v[148:151], v[108:111], v[72:75], v[148:151]
ds_read_b64_tr_b16 v[56:57], v16 offset:0
v_mfma_f32_16x16x32_bf16 v[172:175], v[108:111], v[76:79], v[172:175]
ds_read_b64_tr_b16 v[58:59], v16 offset:3072
v_mfma_f32_16x16x32_bf16 v[168:171], v[104:107], v[76:79], v[168:171]
ds_read_b64_tr_b16 v[60:61], v14 offset:12288
v_mfma_f32_16x16x32_bf16 v[164:167], v[100:103], v[76:79], v[164:167]
ds_read_b64_tr_b16 v[62:63], v14 offset:15360
v_mfma_f32_16x16x32_bf16 v[160:163], v[96:99], v[76:79], v[160:163]
ds_read_b64_tr_b16 v[64:65], v15 offset:12288
v_mfma_f32_16x16x32_bf16 v[156:159], v[92:95], v[76:79], v[156:159]
ds_read_b64_tr_b16 v[66:67], v15 offset:15360
v_mfma_f32_16x16x32_bf16 v[152:155], v[88:91], v[76:79], v[152:155]
ds_read_b64_tr_b16 v[68:69], v16 offset:12288
v_mfma_f32_16x16x32_bf16 v[176:179], v[88:91], v[80:83], v[176:179]
ds_read_b64_tr_b16 v[70:71], v16 offset:15360
v_mfma_f32_16x16x32_bf16 v[180:183], v[92:95], v[80:83], v[180:183]
ds_read_b128 v[36:39], v9 offset:50176
s_branch Lov_8
.p2align 12
.fill 64, 4, 0xbf800000
Lst_8_0:
s_branch Lwr_153
Lst_8_1:
s_branch Lwr_164
s_nop 0
Lov_8:
v_mfma_f32_16x16x32_bf16 v[184:187], v[96:99], v[80:83], v[184:187]
ds_read_b128 v[40:43], v9 offset:51200
v_mfma_f32_16x16x32_bf16 v[188:191], v[100:103], v[80:83], v[188:191]
ds_read_b128 v[44:47], v9 offset:52224
v_mfma_f32_16x16x32_bf16 v[192:195], v[104:107], v[80:83], v[192:195]
v_mfma_f32_16x16x32_bf16 v[196:199], v[108:111], v[80:83], v[196:199]
v_mfma_f32_16x16x32_bf16 v[220:223], v[108:111], v[84:87], v[220:223]
v_mfma_f32_16x16x32_bf16 v[216:219], v[104:107], v[84:87], v[216:219]
v_mfma_f32_16x16x32_bf16 v[212:215], v[100:103], v[84:87], v[212:215]
v_mfma_f32_16x16x32_bf16 v[208:211], v[96:99], v[84:87], v[208:211]
v_mfma_f32_16x16x32_bf16 v[204:207], v[92:95], v[84:87], v[204:207]
v_mfma_f32_16x16x32_bf16 v[200:203], v[88:91], v[84:87], v[200:203]
s_sub_u32 s41, s41, 1
s_cmp_lg_u32 s41, 0
s_cbranch_scc1 Lk3l_108
s_waitcnt lgkmcnt(0)
s_add_u32 s37, s35, 2
s_and_b32 s37, s37, 15
s_mul_i32 s37, s37, 16384
s_add_u32 m0, s39, 0
s_nop 0
buffer_load_dwordx4 v3, s[8:11], s37 offen sc1 lds
v_lshrrev_b32 v86, 4, v1
s_lshl_b32 s43, s63, 7
s_add_u32 s43, s43, 148992
buffer_load_dwordx4 v3, s[8:11], s37 offen offset:1024 sc1 lds
v_lshl_add_u32 v87, v86, 4, s43
v_lshrrev_b32 v88, 1, v86
v_and_b32 v86, 1, v86
s_lshl_b32 s43, s63, 5
buffer_load_dwordx4 v3, s[8:11], s37 offen offset:2048 sc1 lds
s_add_u32 s43, s43, 149248
v_lshl_add_u32 v88, v88, 6, s43
v_lshl_add_u32 v88, v86, 4, v88
v_and_b32 v86, 15, v1
buffer_load_dwordx4 v3, s[8:11], s37 offen offset:3072 sc1 lds
s_lshl_b32 s43, s62, 9
s_add_u32 s43, s43, 147456
v_lshl_add_u32 v86, v86, 3, s43
s_add_u32 s38, s35, 2
s_and_b32 s38, s38, 15
s_mul_i32 s38, s38, 458752
s_add_u32 m0, s40, 0
s_nop 0
buffer_load_dwordx4 v4, s[12:15], s38 offen lds
ds_read_b128 v[32:35], v87 offset:0
ds_read_b128 v[36:39], v87 offset:64
ds_read_b128 v[40:43], v88 offset:0
ds_read_b128 v[44:47], v87 offset:896
s_add_u32 m0, s40, 1024
s_nop 0
buffer_load_dwordx4 v5, s[12:15], s38 offen lds
ds_read_b128 v[48:51], v87 offset:960
ds_read_b128 v[52:55], v88 offset:896
ds_read_b64 v[56:57], v86 offset:0
ds_read_b64 v[58:59], v86 offset:128
s_add_u32 m0, s40, 2048
s_add_u32 s38, s38, 57344
buffer_load_dwordx4 v4, s[12:15], s38 offen lds
ds_read_b64 v[60:61], v86 offset:256
ds_read_b64 v[62:63], v86 offset:384
s_mul_i32 s54, s35, 24576
s_add_u32 m0, s40, 3072
s_nop 0
buffer_load_dwordx4 v5, s[12:15], s38 offen lds
s_lshl_b32 s43, s62, 12
s_add_u32 s54, s54, s43
s_add_u32 s54, s54, 524288
s_lshl_b32 s43, s63, 9
s_add_u32 m0, s40, 4096
s_add_u32 s38, s38, 57344
buffer_load_dwordx4 v4, s[12:15], s38 offen lds
s_add_u32 s55, s54, s43
s_add_u32 s55, s55, 16384
s_lshl_b32 s43, s63, 13
s_add_u32 s54, s54, s43
s_add_u32 m0, s40, 5120
s_nop 0
buffer_load_dwordx4 v5, s[12:15], s38 offen lds
v_and_b32 v84, 32, v1
v_lshlrev_b32 v84, 4, v84
v_add_u32 v84, v84, v2
s_waitcnt lgkmcnt(0)
s_add_u32 m0, s40, 6144
s_add_u32 s38, s38, 57344
buffer_load_dwordx4 v4, s[12:15], s38 offen lds
s_add_u32 m0, s40, 7168
s_nop 0
buffer_load_dwordx4 v5, s[12:15], s38 offen lds
s_and_b32 s44, s36, 3
s_mul_i32 s43, s2, 28672
s_mul_i32 s44, s44, 7168
s_add_u32 s43, s43, s44
s_add_u32 s4, s76, s43
s_addc_u32 s5, s77, 0
s_barrier
s_cmp_eq_u32 s47, 3
s_cbranch_scc0 Lw_109
v_and_b32 v90, 31, v1
v_lshlrev_b32 v90, 4, v90
v_add_u32 v91, 153600, v90
ds_read_b128 v[108:111], v91 offset:0
ds_read_b128 v[112:115], v91 offset:512
ds_read_b128 v[116:119], v91 offset:1024
ds_read_b128 v[120:123], v91 offset:1536
s_and_b32 s44, s2, 15
s_mul_i32 s44, s44, 14336
s_lshr_b32 s43, s2, 4
s_lshl_b32 s43, s43, 9
s_add_u32 s44, s44, s43
s_waitcnt lgkmcnt(0)
v_add_f32 v108, v108, v112
v_add_f32 v116, v116, v120
v_add_f32 v109, v109, v113
v_add_f32 v117, v117, v121
v_add_f32 v110, v110, v114
v_add_f32 v118, v118, v122
v_add_f32 v111, v111, v115
v_add_f32 v119, v119, v123
v_add_f32 v108, v108, v116
v_add_f32 v109, v109, v117
v_add_f32 v110, v110, v118
v_add_f32 v111, v111, v119
s_mov_b64 exec, 0xffffffff
buffer_store_dwordx4 v[108:111], v90, s[84:87], s44 offen sc1
s_mov_b64 exec, -1
Lw_109:
s_waitcnt lgkmcnt(0)
s_add_u32 s37, s35, 3
s_and_b32 s37, s37, 15
s_mul_i32 s37, s37, 16384
s_add_u32 m0, s39, 49152
s_nop 0
buffer_load_dwordx4 v3, s[8:11], s37 offen sc1 lds
s_load_dword s3, s[4:5], 1792
s_load_dword s3, s[4:5], 1856
s_load_dword s3, s[4:5], 1920
s_load_dword s3, s[4:5], 1984
s_load_dword s3, s[4:5], 2048
s_load_dword s3, s[4:5], 2112
s_load_dword s3, s[4:5], 2176
buffer_load_dwordx4 v3, s[8:11], s37 offen offset:1024 sc1 lds
s_load_dword s3, s[4:5], 2240
s_load_dword s3, s[4:5], 2304
s_load_dword s3, s[4:5], 2368
s_load_dword s3, s[4:5], 2432
s_load_dword s3, s[4:5], 2496
s_load_dword s3, s[4:5], 2560
s_load_dword s3, s[4:5], 2624
buffer_load_dwordx4 v3, s[8:11], s37 offen offset:2048 sc1 lds
v_mul_f32 v66, v57, v57
v_mul_f32 v64, 0xc0135761, v57
v_mul_f32 v65, 0xbdd2d3e8, v57
v_mul_f32 v65, v65, v66
v_rcp_f32 v66, v66
v_mul_f32 v70, v59, v59
v_mul_f32 v68, 0xc0135761, v59
buffer_load_dwordx4 v3, s[8:11], s37 offen offset:3072 sc1 lds
v_mul_f32 v69, 0xbdd2d3e8, v59
v_mul_f32 v69, v69, v70
v_rcp_f32 v70, v70
v_fma_f32 v128, -v56, v32, v128
v_fma_f32 v129, -v56, v33, v129
v_fma_f32 v130, -v56, v34, v130
v_fma_f32 v131, -v56, v35, v131
v_fma_f32 v152, -v58, v32, v152
s_add_u32 s38, s35, 3
s_and_b32 s38, s38, 15
s_mul_i32 s38, s38, 458752
s_add_u32 m0, s40, 49152
s_nop 0
buffer_load_dwordx4 v4, s[12:15], s38 offen lds
v_fma_f32 v153, -v58, v33, v153
v_fma_f32 v154, -v58, v34, v154
v_fma_f32 v155, -v58, v35, v155
v_mul_f32 v72, v128, v128
v_mul_f32 v73, v129, v129
v_mul_f32 v74, v130, v130
v_mul_f32 v75, v131, v131
s_add_u32 m0, s40, 50176
s_nop 0
buffer_load_dwordx4 v5, s[12:15], s38 offen lds
v_mul_f32 v76, v152, v152
v_mul_f32 v77, v153, v153
v_mul_f32 v78, v154, v154
v_mul_f32 v79, v155, v155
v_fma_f32 v72, v72, v65, v64
v_fma_f32 v73, v73, v65, v64
v_fma_f32 v74, v74, v65, v64
s_add_u32 m0, s40, 51200
s_add_u32 s38, s38, 57344
buffer_load_dwordx4 v4, s[12:15], s38 offen lds
v_fma_f32 v75, v75, v65, v64
v_fma_f32 v76, v76, v69, v68
v_fma_f32 v77, v77, v69, v68
v_fma_f32 v78, v78, v69, v68
v_fma_f32 v79, v79, v69, v68
v_mul_f32 v72, v72, v128
v_mul_f32 v73, v73, v129
v_mul_f32 v74, v74, v130
s_add_u32 m0, s40, 52224
s_nop 0
buffer_load_dwordx4 v5, s[12:15], s38 offen lds
v_mul_f32 v75, v75, v131
v_mul_f32 v76, v76, v152
v_mul_f32 v77, v77, v153
v_mul_f32 v78, v78, v154
v_mul_f32 v79, v79, v155
v_exp_f32 v72, v72
v_exp_f32 v73, v73
s_add_u32 m0, s40, 53248
s_add_u32 s38, s38, 57344
buffer_load_dwordx4 v4, s[12:15], s38 offen lds
v_exp_f32 v74, v74
v_exp_f32 v75, v75
v_exp_f32 v76, v76
v_exp_f32 v77, v77
v_exp_f32 v78, v78
v_exp_f32 v79, v79
v_fma_f32 v140, -v56, v44, v140
s_add_u32 m0, s40, 54272
s_nop 0
buffer_load_dwordx4 v5, s[12:15], s38 offen lds
v_fma_f32 v141, -v56, v45, v141
v_fma_f32 v142, -v56, v46, v142
v_fma_f32 v143, -v56, v47, v143
v_fma_f32 v164, -v58, v44, v164
v_fma_f32 v165, -v58, v45, v165
v_fma_f32 v166, -v58, v46, v166
v_fma_f32 v167, -v58, v47, v167
v_fma_f32 v72, v72, v66, v66
s_add_u32 m0, s40, 55296
s_add_u32 s38, s38, 57344
buffer_load_dwordx4 v4, s[12:15], s38 offen lds
s_add_u32 m0, s40, 56320
s_nop 0
buffer_load_dwordx4 v5, s[12:15], s38 offen lds
s_waitcnt vmcnt(12)
s_barrier
s_add_u32 s37, s35, 4
s_and_b32 s37, s37, 15
s_mul_i32 s37, s37, 16384
s_add_u32 m0, s39, 98304
s_nop 0
buffer_load_dwordx4 v3, s[8:11], s37 offen sc1 lds
v_fma_f32 v73, v73, v66, v66
v_fma_f32 v74, v74, v66, v66
v_fma_f32 v75, v75, v66, v66
v_fma_f32 v76, v76, v70, v70
v_fma_f32 v77, v77, v70, v70
v_fma_f32 v78, v78, v70, v70
buffer_load_dwordx4 v3, s[8:11], s37 offen offset:1024 sc1 lds
v_fma_f32 v79, v79, v70, v70
v_rcp_f32 v72, v72
v_rcp_f32 v73, v73
v_rcp_f32 v74, v74
v_rcp_f32 v75, v75
v_rcp_f32 v76, v76
buffer_load_dwordx4 v3, s[8:11], s37 offen offset:2048 sc1 lds
v_rcp_f32 v77, v77
v_rcp_f32 v78, v78
v_rcp_f32 v79, v79
v_mul_f32 v140, v128, v140
v_mul_f32 v141, v129, v141
v_mul_f32 v142, v130, v142
buffer_load_dwordx4 v3, s[8:11], s37 offen offset:3072 sc1 lds
v_mul_f32 v143, v131, v143
v_mul_f32 v164, v152, v164
v_mul_f32 v165, v153, v165
v_mul_f32 v166, v154, v166
v_mul_f32 v167, v155, v167
v_mul_f32 v140, v140, v72
s_add_u32 s38, s35, 4
s_and_b32 s38, s38, 15
s_mul_i32 s38, s38, 458752
s_add_u32 m0, s40, 98304
s_nop 0
buffer_load_dwordx4 v4, s[12:15], s38 offen lds
v_mul_f32 v141, v141, v73
v_mul_f32 v142, v142, v74
v_mul_f32 v143, v143, v75
v_mul_f32 v164, v164, v76
v_mul_f32 v165, v165, v77
v_mul_f32 v166, v166, v78
s_add_u32 m0, s40, 99328
s_nop 0
buffer_load_dwordx4 v5, s[12:15], s38 offen lds
v_mul_f32 v167, v167, v79
v_cvt_pk_bf16_f32 v128, v140, v141
v_cvt_pk_bf16_f32 v129, v142, v143
v_cvt_pk_bf16_f32 v152, v164, v165
v_cvt_pk_bf16_f32 v153, v166, v167
v_fma_f32 v132, -v56, v36, v132
s_add_u32 m0, s40, 100352
s_add_u32 s38, s38, 57344
buffer_load_dwordx4 v4, s[12:15], s38 offen lds
v_fma_f32 v133, -v56, v37, v133
v_fma_f32 v134, -v56, v38, v134
v_fma_f32 v135, -v56, v39, v135
v_fma_f32 v156, -v58, v36, v156
v_fma_f32 v157, -v58, v37, v157
v_fma_f32 v158, -v58, v38, v158
s_add_u32 m0, s40, 101376
s_nop 0
buffer_load_dwordx4 v5, s[12:15], s38 offen lds
v_fma_f32 v159, -v58, v39, v159
v_mul_f32 v72, v132, v132
v_mul_f32 v73, v133, v133
v_mul_f32 v74, v134, v134
v_mul_f32 v75, v135, v135
v_mul_f32 v76, v156, v156
s_add_u32 m0, s40, 102400
s_add_u32 s38, s38, 57344
buffer_load_dwordx4 v4, s[12:15], s38 offen lds
v_mul_f32 v77, v157, v157
v_mul_f32 v78, v158, v158
v_mul_f32 v79, v159, v159
v_fma_f32 v72, v72, v65, v64
v_fma_f32 v73, v73, v65, v64
v_fma_f32 v74, v74, v65, v64
s_add_u32 m0, s40, 103424
s_nop 0
buffer_load_dwordx4 v5, s[12:15], s38 offen lds
v_fma_f32 v75, v75, v65, v64
v_fma_f32 v76, v76, v69, v68
v_fma_f32 v77, v77, v69, v68
v_fma_f32 v78, v78, v69, v68
v_fma_f32 v79, v79, v69, v68
v_mul_f32 v72, v72, v132
s_add_u32 m0, s40, 104448
s_add_u32 s38, s38, 57344
buffer_load_dwordx4 v4, s[12:15], s38 offen lds
s_add_u32 m0, s40, 105472
s_nop 0
buffer_load_dwordx4 v5, s[12:15], s38 offen lds
s_waitcnt vmcnt(12)
s_barrier
s_cmp_eq_u32 s47, 3
s_cbranch_scc0 Lw_110
s_lshr_b32 s43, s2, 4
s_add_u32 s43, s43, 80
s_lshl_b32 s43, s43, 7
v_mov_b32 v90, s43
v_mov_b32 v91, 1
s_mov_b64 exec, 1
buffer_atomic_add v91, v90, s[56:59], 0 offen sc1
s_mov_b64 exec, -1
Lw_110:
s_waitcnt lgkmcnt(0)
s_add_u32 s37, s35, 5
s_and_b32 s37, s37, 15
s_mul_i32 s37, s37, 16384
s_add_u32 m0, s39, 0
s_nop 0
buffer_load_dwordx4 v3, s[8:11], s37 offen sc1 lds
s_load_dword s3, s[4:5], 2688
s_load_dword s3, s[4:5], 2752
s_load_dword s3, s[4:5], 2816
s_load_dword s3, s[4:5], 2880
s_load_dword s3, s[4:5], 2944
s_load_dword s3, s[4:5], 3008
s_load_dword s3, s[4:5], 3072
buffer_load_dwordx4 v3, s[8:11], s37 offen offset:1024 sc1 lds
s_load_dword s3, s[4:5], 3136
s_load_dword s3, s[4:5], 3200
s_load_dword s3, s[4:5], 3264
s_load_dword s3, s[4:5], 3328
s_load_dword s3, s[4:5], 3392
s_load_dword s3, s[4:5], 3456
s_load_dword s3, s[4:5], 3520
buffer_load_dwordx4 v3, s[8:11], s37 offen offset:2048 sc1 lds
v_mul_f32 v73, v73, v133
v_mul_f32 v74, v74, v134
v_mul_f32 v75, v75, v135
v_mul_f32 v76, v76, v156
v_mul_f32 v77, v77, v157
v_mul_f32 v78, v78, v158
v_mul_f32 v79, v79, v159
v_exp_f32 v72, v72
buffer_load_dwordx4 v3, s[8:11], s37 offen offset:3072 sc1 lds
v_exp_f32 v73, v73
v_exp_f32 v74, v74
v_exp_f32 v75, v75
v_exp_f32 v76, v76
v_exp_f32 v77, v77
v_exp_f32 v78, v78
v_exp_f32 v79, v79
s_add_u32 s38, s35, 5
s_and_b32 s38, s38, 15
s_mul_i32 s38, s38, 458752
s_add_u32 m0, s40, 0
s_nop 0
buffer_load_dwordx4 v4, s[12:15], s38 offen lds
v_fma_f32 v144, -v56, v48, v144
v_fma_f32 v145, -v56, v49, v145
v_fma_f32 v146, -v56, v50, v146
v_fma_f32 v147, -v56, v51, v147
v_fma_f32 v168, -v58, v48, v168
v_fma_f32 v169, -v58, v49, v169
v_fma_f32 v170, -v58, v50, v170
v_fma_f32 v171, -v58, v51, v171
s_add_u32 m0, s40, 1024
s_nop 0
buffer_load_dwordx4 v5, s[12:15], s38 offen lds
v_fma_f32 v72, v72, v66, v66
v_fma_f32 v73, v73, v66, v66
v_fma_f32 v74, v74, v66, v66
v_fma_f32 v75, v75, v66, v66
v_fma_f32 v76, v76, v70, v70
v_fma_f32 v77, v77, v70, v70
v_fma_f32 v78, v78, v70, v70
s_add_u32 m0, s40, 2048
s_add_u32 s38, s38, 57344
buffer_load_dwordx4 v4, s[12:15], s38 offen lds
v_fma_f32 v79, v79, v70, v70
v_rcp_f32 v72, v72
v_rcp_f32 v73, v73
v_rcp_f32 v74, v74
v_rcp_f32 v75, v75
v_rcp_f32 v76, v76
v_rcp_f32 v77, v77
s_add_u32 m0, s40, 3072
s_nop 0
buffer_load_dwordx4 v5, s[12:15], s38 offen lds
v_rcp_f32 v78, v78
v_rcp_f32 v79, v79
v_mul_f32 v144, v132, v144
v_mul_f32 v145, v133, v145
v_mul_f32 v146, v134, v146
v_mul_f32 v147, v135, v147
v_mul_f32 v168, v156, v168
v_mul_f32 v169, v157, v169
s_add_u32 m0, s40, 4096
s_add_u32 s38, s38, 57344
buffer_load_dwordx4 v4, s[12:15], s38 offen lds
v_mul_f32 v170, v158, v170
v_mul_f32 v171, v159, v171
v_mul_f32 v144, v144, v72
v_mul_f32 v145, v145, v73
v_mul_f32 v146, v146, v74
v_mul_f32 v147, v147, v75
v_mul_f32 v168, v168, v76
s_add_u32 m0, s40, 5120
s_nop 0
buffer_load_dwordx4 v5, s[12:15], s38 offen lds
v_mul_f32 v169, v169, v77
v_mul_f32 v170, v170, v78
v_mul_f32 v171, v171, v79
v_cvt_pk_bf16_f32 v130, v144, v145
v_cvt_pk_bf16_f32 v131, v146, v147
v_cvt_pk_bf16_f32 v154, v168, v169
v_cvt_pk_bf16_f32 v155, v170, v171
buffer_store_dwordx4 v[128:131], v2, s[24:27], s54 offen offset:0 sc1
s_add_u32 m0, s40, 6144
s_add_u32 s38, s38, 57344
buffer_load_dwordx4 v4, s[12:15], s38 offen lds
s_add_u32 m0, s40, 7168
s_nop 0
buffer_load_dwordx4 v5, s[12:15], s38 offen lds
s_waitcnt vmcnt(13)
s_barrier
s_add_u32 s37, s35, 6
s_and_b32 s37, s37, 15
s_mul_i32 s37, s37, 16384
s_add_u32 m0, s39, 49152
s_nop 0
buffer_load_dwordx4 v3, s[8:11], s37 offen sc1 lds
buffer_store_dwordx4 v[152:155], v2, s[24:27], s54 offen offset:1024 sc1
v_fma_f32 v136, -v56, v40, v136
v_fma_f32 v137, -v56, v41, v137
v_fma_f32 v138, -v56, v42, v138
v_fma_f32 v139, -v56, v43, v139
v_fma_f32 v160, -v58, v40, v160
buffer_load_dwordx4 v3, s[8:11], s37 offen offset:1024 sc1 lds
v_fma_f32 v161, -v58, v41, v161
v_fma_f32 v162, -v58, v42, v162
v_fma_f32 v163, -v58, v43, v163
v_mul_f32 v72, v136, v136
v_mul_f32 v73, v137, v137
v_mul_f32 v74, v138, v138
buffer_load_dwordx4 v3, s[8:11], s37 offen offset:2048 sc1 lds
v_mul_f32 v75, v139, v139
v_mul_f32 v76, v160, v160
v_mul_f32 v77, v161, v161
v_mul_f32 v78, v162, v162
v_mul_f32 v79, v163, v163
v_fma_f32 v72, v72, v65, v64
buffer_load_dwordx4 v3, s[8:11], s37 offen offset:3072 sc1 lds
v_fma_f32 v73, v73, v65, v64
v_fma_f32 v74, v74, v65, v64
v_fma_f32 v75, v75, v65, v64
v_fma_f32 v76, v76, v69, v68
v_fma_f32 v77, v77, v69, v68
v_fma_f32 v78, v78, v69, v68
s_add_u32 s38, s35, 6
s_and_b32 s38, s38, 15
s_mul_i32 s38, s38, 458752
s_add_u32 m0, s40, 49152
s_nop 0
buffer_load_dwordx4 v4, s[12:15], s38 offen lds
v_fma_f32 v79, v79, v69, v68
v_mul_f32 v72, v72, v136
v_mul_f32 v73, v73, v137
v_mul_f32 v74, v74, v138
v_mul_f32 v75, v75, v139
v_mul_f32 v76, v76, v160
s_add_u32 m0, s40, 50176
s_nop 0
buffer_load_dwordx4 v5, s[12:15], s38 offen lds
v_mul_f32 v77, v77, v161
v_mul_f32 v78, v78, v162
v_mul_f32 v79, v79, v163
v_exp_f32 v72, v72
v_exp_f32 v73, v73
v_exp_f32 v74, v74
s_add_u32 m0, s40, 51200
s_add_u32 s38, s38, 57344
buffer_load_dwordx4 v4, s[12:15], s38 offen lds
v_exp_f32 v75, v75
v_exp_f32 v76, v76
v_exp_f32 v77, v77
v_exp_f32 v78, v78
v_exp_f32 v79, v79
v_fma_f32 v148, -v56, v52, v148
s_add_u32 m0, s40, 52224
s_nop 0
buffer_load_dwordx4 v5, s[12:15], s38 offen lds
v_fma_f32 v149, -v56, v53, v149
v_fma_f32 v150, -v56, v54, v150
v_fma_f32 v151, -v56, v55, v151
v_fma_f32 v172, -v58, v52, v172
v_fma_f32 v173, -v58, v53, v173
v_fma_f32 v174, -v58, v54, v174
s_add_u32 m0, s40, 53248
s_add_u32 s38, s38, 57344
buffer_load_dwordx4 v4, s[12:15], s38 offen lds
v_fma_f32 v175, -v58, v55, v175
v_fma_f32 v72, v72, v66, v66
v_fma_f32 v73, v73, v66, v66
v_fma_f32 v74, v74, v66, v66
v_fma_f32 v75, v75, v66, v66
v_fma_f32 v76, v76, v70, v70
s_add_u32 m0, s40, 54272
s_nop 0
buffer_load_dwordx4 v5, s[12:15], s38 offen lds
v_fma_f32 v77, v77, v70, v70
v_fma_f32 v78, v78, v70, v70
v_fma_f32 v79, v79, v70, v70
v_rcp_f32 v72, v72
v_rcp_f32 v73, v73
v_rcp_f32 v74, v74
s_add_u32 m0, s40, 55296
s_add_u32 s38, s38, 57344
buffer_load_dwordx4 v4, s[12:15], s38 offen lds
s_add_u32 m0, s40, 56320
s_nop 0
buffer_load_dwordx4 v5, s[12:15], s38 offen lds
s_waitcnt vmcnt(13)
s_barrier
s_waitcnt lgkmcnt(0)
s_add_u32 s37, s35, 7
s_and_b32 s37, s37, 15
s_mul_i32 s37, s37, 16384
s_add_u32 m0, s39, 98304
s_nop 0
buffer_load_dwordx4 v3, s[8:11], s37 offen sc1 lds
s_load_dword s3, s[4:5], 3584
s_load_dword s3, s[4:5], 3648
s_load_dword s3, s[4:5], 3712
s_load_dword s3, s[4:5], 3776
s_load_dword s3, s[4:5], 3840
s_load_dword s3, s[4:5], 3904
s_load_dword s3, s[4:5], 3968
buffer_load_dwordx4 v3, s[8:11], s37 offen offset:1024 sc1 lds
s_load_dword s3, s[4:5], 4032
s_load_dword s3, s[4:5], 4096
s_load_dword s3, s[4:5], 4160
s_load_dword s3, s[4:5], 4224
s_load_dword s3, s[4:5], 4288
s_load_dword s3, s[4:5], 4352
s_load_dword s3, s[4:5], 4416
buffer_load_dwordx4 v3, s[8:11], s37 offen offset:2048 sc1 lds
v_rcp_f32 v75, v75
v_rcp_f32 v76, v76
v_rcp_f32 v77, v77
v_rcp_f32 v78, v78
v_rcp_f32 v79, v79
v_mul_f32 v148, v136, v148
v_mul_f32 v149, v137, v149
buffer_load_dwordx4 v3, s[8:11], s37 offen offset:3072 sc1 lds
v_mul_f32 v150, v138, v150
v_mul_f32 v151, v139, v151
v_mul_f32 v172, v160, v172
v_mul_f32 v173, v161, v173
v_mul_f32 v174, v162, v174
v_mul_f32 v175, v163, v175
v_mul_f32 v148, v148, v72
v_mul_f32 v149, v149, v73
s_add_u32 s38, s35, 7
s_and_b32 s38, s38, 15
s_mul_i32 s38, s38, 458752
s_add_u32 m0, s40, 98304
s_nop 0
buffer_load_dwordx4 v4, s[12:15], s38 offen lds
v_mul_f32 v150, v150, v74
v_mul_f32 v151, v151, v75
v_mul_f32 v172, v172, v76
v_mul_f32 v173, v173, v77
v_mul_f32 v174, v174, v78
v_mul_f32 v175, v175, v79
v_cvt_pk_bf16_f32 v80, v148, v149
s_add_u32 m0, s40, 99328
s_nop 0
buffer_load_dwordx4 v5, s[12:15], s38 offen lds
v_cvt_pk_bf16_f32 v81, v150, v151
v_cvt_pk_bf16_f32 v82, v172, v173
v_cvt_pk_bf16_f32 v83, v174, v175
s_nop 1
v_permlane32_swap_b32 v80, v82
v_permlane32_swap_b32 v81, v83
s_branch Lov_9
.p2align 12
.fill 64, 4, 0xbf800000
Lst_9_0:
s_branch Lwr_154
Lst_9_1:
s_branch Lwr_165
s_nop 0
Lov_9:
buffer_store_dwordx4 v[80:83], v84, s[24:27], s55 offen offset:0 sc1
s_add_u32 m0, s40, 100352
s_add_u32 s38, s38, 57344
buffer_load_dwordx4 v4, s[12:15], s38 offen lds
s_nop 1
v_mul_f32 v66, v61, v61
v_mul_f32 v64, 0xc0135761, v61
v_mul_f32 v65, 0xbdd2d3e8, v61
v_mul_f32 v65, v65, v66
v_rcp_f32 v66, v66
v_mul_f32 v70, v63, v63
v_mul_f32 v68, 0xc0135761, v63
s_add_u32 m0, s40, 101376
s_nop 0
buffer_load_dwordx4 v5, s[12:15], s38 offen lds
v_mul_f32 v69, 0xbdd2d3e8, v63
v_mul_f32 v69, v69, v70
v_rcp_f32 v70, v70
v_fma_f32 v176, -v60, v32, v176
v_fma_f32 v177, -v60, v33, v177
v_fma_f32 v178, -v60, v34, v178
v_fma_f32 v179, -v60, v35, v179
s_add_u32 m0, s40, 102400
s_add_u32 s38, s38, 57344
buffer_load_dwordx4 v4, s[12:15], s38 offen lds
v_fma_f32 v200, -v62, v32, v200
v_fma_f32 v201, -v62, v33, v201
v_fma_f32 v202, -v62, v34, v202
v_fma_f32 v203, -v62, v35, v203
v_mul_f32 v72, v176, v176
v_mul_f32 v73, v177, v177
v_mul_f32 v74, v178, v178
s_add_u32 m0, s40, 103424
s_nop 0
buffer_load_dwordx4 v5, s[12:15], s38 offen lds
v_mul_f32 v75, v179, v179
v_mul_f32 v76, v200, v200
v_mul_f32 v77, v201, v201
v_mul_f32 v78, v202, v202
v_mul_f32 v79, v203, v203
v_fma_f32 v72, v72, v65, v64
v_fma_f32 v73, v73, v65, v64
v_fma_f32 v74, v74, v65, v64
s_add_u32 m0, s40, 104448
s_add_u32 s38, s38, 57344
buffer_load_dwordx4 v4, s[12:15], s38 offen lds
s_add_u32 m0, s40, 105472
s_nop 0
buffer_load_dwordx4 v5, s[12:15], s38 offen lds
s_waitcnt vmcnt(13)
s_barrier
s_add_u32 s37, s35, 8
s_and_b32 s37, s37, 15
s_mul_i32 s37, s37, 16384
s_add_u32 m0, s39, 0
s_nop 0
buffer_load_dwordx4 v3, s[8:11], s37 offen sc1 lds
v_fma_f32 v75, v75, v65, v64
v_fma_f32 v76, v76, v69, v68
v_fma_f32 v77, v77, v69, v68
v_fma_f32 v78, v78, v69, v68
v_fma_f32 v79, v79, v69, v68
v_mul_f32 v72, v72, v176
buffer_load_dwordx4 v3, s[8:11], s37 offen offset:1024 sc1 lds
v_mul_f32 v73, v73, v177
v_mul_f32 v74, v74, v178
v_mul_f32 v75, v75, v179
v_mul_f32 v76, v76, v200
v_mul_f32 v77, v77, v201
v_mul_f32 v78, v78, v202
buffer_load_dwordx4 v3, s[8:11], s37 offen offset:2048 sc1 lds
v_mul_f32 v79, v79, v203
v_exp_f32 v72, v72
v_exp_f32 v73, v73
v_exp_f32 v74, v74
v_exp_f32 v75, v75
v_exp_f32 v76, v76
buffer_load_dwordx4 v3, s[8:11], s37 offen offset:3072 sc1 lds
v_exp_f32 v77, v77
v_exp_f32 v78, v78
v_exp_f32 v79, v79
v_fma_f32 v188, -v60, v44, v188
v_fma_f32 v189, -v60, v45, v189
v_fma_f32 v190, -v60, v46, v190
s_add_u32 s38, s35, 8
s_and_b32 s38, s38, 15
s_mul_i32 s38, s38, 458752
s_add_u32 m0, s40, 0
s_nop 0
buffer_load_dwordx4 v4, s[12:15], s38 offen lds
v_fma_f32 v191, -v60, v47, v191
v_fma_f32 v212, -v62, v44, v212
v_fma_f32 v213, -v62, v45, v213
v_fma_f32 v214, -v62, v46, v214
v_fma_f32 v215, -v62, v47, v215
v_fma_f32 v72, v72, v66, v66
s_add_u32 m0, s40, 1024
s_nop 0
buffer_load_dwordx4 v5, s[12:15], s38 offen lds
v_fma_f32 v73, v73, v66, v66
v_fma_f32 v74, v74, v66, v66
v_fma_f32 v75, v75, v66, v66
v_fma_f32 v76, v76, v70, v70
v_fma_f32 v77, v77, v70, v70
v_fma_f32 v78, v78, v70, v70
s_add_u32 m0, s40, 2048
s_add_u32 s38, s38, 57344
buffer_load_dwordx4 v4, s[12:15], s38 offen lds
v_fma_f32 v79, v79, v70, v70
v_rcp_f32 v72, v72
v_rcp_f32 v73, v73
v_rcp_f32 v74, v74
v_rcp_f32 v75, v75
v_rcp_f32 v76, v76
s_add_u32 m0, s40, 3072
s_nop 0
buffer_load_dwordx4 v5, s[12:15], s38 offen lds
v_rcp_f32 v77, v77
v_rcp_f32 v78, v78
v_rcp_f32 v79, v79
v_mul_f32 v188, v176, v188
v_mul_f32 v189, v177, v189
v_mul_f32 v190, v178, v190
s_add_u32 m0, s40, 4096
s_add_u32 s38, s38, 57344
buffer_load_dwordx4 v4, s[12:15], s38 offen lds
v_mul_f32 v191, v179, v191
v_mul_f32 v212, v200, v212
v_mul_f32 v213, v201, v213
v_mul_f32 v214, v202, v214
v_mul_f32 v215, v203, v215
v_mul_f32 v188, v188, v72
s_add_u32 m0, s40, 5120
s_nop 0
buffer_load_dwordx4 v5, s[12:15], s38 offen lds
v_mul_f32 v189, v189, v73
v_mul_f32 v190, v190, v74
v_mul_f32 v191, v191, v75
v_mul_f32 v212, v212, v76
v_mul_f32 v213, v213, v77
v_mul_f32 v214, v214, v78
s_add_u32 m0, s40, 6144
s_add_u32 s38, s38, 57344
buffer_load_dwordx4 v4, s[12:15], s38 offen lds
s_add_u32 m0, s40, 7168
s_nop 0
buffer_load_dwordx4 v5, s[12:15], s38 offen lds
s_waitcnt vmcnt(12)
s_barrier
s_waitcnt lgkmcnt(0)
s_cmp_eq_u32 s47, 3
s_cbranch_scc0 Lw_111
s_lshl_b32 s60, s35, 7
s_add_u32 s60, s60, 28321792
s_mov_b32 s61, s60
s_load_dword s92, s[82:83], s60 glc
s_load_dword s93, s[82:83], s61 glc
Lw_111:
s_add_u32 s37, s35, 9
s_and_b32 s37, s37, 15
s_mul_i32 s37, s37, 16384
s_add_u32 m0, s39, 49152
s_nop 0
buffer_load_dwordx4 v3, s[8:11], s37 offen sc1 lds
s_load_dword s3, s[4:5], 4480
s_load_dword s3, s[4:5], 4544
s_load_dword s3, s[4:5], 4608
s_load_dword s3, s[4:5], 4672
s_load_dword s3, s[4:5], 4736
s_load_dword s3, s[4:5], 4800
s_load_dword s3, s[4:5], 4864
buffer_load_dwordx4 v3, s[8:11], s37 offen offset:1024 sc1 lds
s_load_dword s3, s[4:5], 4928
s_load_dword s3, s[4:5], 4992
s_load_dword s3, s[4:5], 5056
s_load_dword s3, s[4:5], 5120
s_load_dword s3, s[4:5], 5184
s_load_dword s3, s[4:5], 5248
s_load_dword s3, s[4:5], 5312
buffer_load_dwordx4 v3, s[8:11], s37 offen offset:2048 sc1 lds
v_mul_f32 v215, v215, v79
v_cvt_pk_bf16_f32 v176, v188, v189
v_cvt_pk_bf16_f32 v177, v190, v191
v_cvt_pk_bf16_f32 v200, v212, v213
v_cvt_pk_bf16_f32 v201, v214, v215
v_fma_f32 v180, -v60, v36, v180
v_fma_f32 v181, -v60, v37, v181
v_fma_f32 v182, -v60, v38, v182
buffer_load_dwordx4 v3, s[8:11], s37 offen offset:3072 sc1 lds
v_fma_f32 v183, -v60, v39, v183
v_fma_f32 v204, -v62, v36, v204
v_fma_f32 v205, -v62, v37, v205
v_fma_f32 v206, -v62, v38, v206
v_fma_f32 v207, -v62, v39, v207
v_mul_f32 v72, v180, v180
v_mul_f32 v73, v181, v181
s_add_u32 s38, s35, 9
s_and_b32 s38, s38, 15
s_mul_i32 s38, s38, 458752
s_add_u32 m0, s40, 49152
s_nop 0
buffer_load_dwordx4 v4, s[12:15], s38 offen lds
v_mul_f32 v74, v182, v182
v_mul_f32 v75, v183, v183
v_mul_f32 v76, v204, v204
v_mul_f32 v77, v205, v205
v_mul_f32 v78, v206, v206
v_mul_f32 v79, v207, v207
v_fma_f32 v72, v72, v65, v64
v_fma_f32 v73, v73, v65, v64
s_add_u32 m0, s40, 50176
s_nop 0
buffer_load_dwordx4 v5, s[12:15], s38 offen lds
v_fma_f32 v74, v74, v65, v64
v_fma_f32 v75, v75, v65, v64
v_fma_f32 v76, v76, v69, v68
v_fma_f32 v77, v77, v69, v68
v_fma_f32 v78, v78, v69, v68
v_fma_f32 v79, v79, v69, v68
v_mul_f32 v72, v72, v180
s_add_u32 m0, s40, 51200
s_add_u32 s38, s38, 57344
buffer_load_dwordx4 v4, s[12:15], s38 offen lds
v_mul_f32 v73, v73, v181
v_mul_f32 v74, v74, v182
v_mul_f32 v75, v75, v183
v_mul_f32 v76, v76, v204
v_mul_f32 v77, v77, v205
v_mul_f32 v78, v78, v206
v_mul_f32 v79, v79, v207
s_add_u32 m0, s40, 52224
s_nop 0
buffer_load_dwordx4 v5, s[12:15], s38 offen lds
v_exp_f32 v72, v72
v_exp_f32 v73, v73
v_exp_f32 v74, v74
v_exp_f32 v75, v75
v_exp_f32 v76, v76
v_exp_f32 v77, v77
v_exp_f32 v78, v78
v_exp_f32 v79, v79
s_add_u32 m0, s40, 53248
s_add_u32 s38, s38, 57344
buffer_load_dwordx4 v4, s[12:15], s38 offen lds
v_fma_f32 v192, -v60, v48, v192
v_fma_f32 v193, -v60, v49, v193
v_fma_f32 v194, -v60, v50, v194
v_fma_f32 v195, -v60, v51, v195
v_fma_f32 v216, -v62, v48, v216
v_fma_f32 v217, -v62, v49, v217
v_fma_f32 v218, -v62, v50, v218
s_add_u32 m0, s40, 54272
s_nop 0
buffer_load_dwordx4 v5, s[12:15], s38 offen lds
v_fma_f32 v219, -v62, v51, v219
v_fma_f32 v72, v72, v66, v66
v_fma_f32 v73, v73, v66, v66
v_fma_f32 v74, v74, v66, v66
v_fma_f32 v75, v75, v66, v66
v_fma_f32 v76, v76, v70, v70
v_fma_f32 v77, v77, v70, v70
v_fma_f32 v78, v78, v70, v70
s_add_u32 m0, s40, 55296
s_add_u32 s38, s38, 57344
buffer_load_dwordx4 v4, s[12:15], s38 offen lds
s_add_u32 m0, s40, 56320
s_nop 0
buffer_load_dwordx4 v5, s[12:15], s38 offen lds
s_waitcnt vmcnt(12)
s_barrier
s_add_u32 s37, s35, 10
s_and_b32 s37, s37, 15
s_mul_i32 s37, s37, 16384
s_add_u32 m0, s39, 98304
s_nop 0
buffer_load_dwordx4 v3, s[8:11], s37 offen sc1 lds
v_fma_f32 v79, v79, v70, v70
v_rcp_f32 v72, v72
v_rcp_f32 v73, v73
v_rcp_f32 v74, v74
v_rcp_f32 v75, v75
v_rcp_f32 v76, v76
buffer_load_dwordx4 v3, s[8:11], s37 offen offset:1024 sc1 lds
v_rcp_f32 v77, v77
v_rcp_f32 v78, v78
v_rcp_f32 v79, v79
v_mul_f32 v192, v180, v192
v_mul_f32 v193, v181, v193
v_mul_f32 v194, v182, v194
buffer_load_dwordx4 v3, s[8:11], s37 offen offset:2048 sc1 lds
v_mul_f32 v195, v183, v195
v_mul_f32 v216, v204, v216
v_mul_f32 v217, v205, v217
v_mul_f32 v218, v206, v218
v_mul_f32 v219, v207, v219
v_mul_f32 v192, v192, v72
buffer_load_dwordx4 v3, s[8:11], s37 offen offset:3072 sc1 lds
v_mul_f32 v193, v193, v73
v_mul_f32 v194, v194, v74
v_mul_f32 v195, v195, v75
v_mul_f32 v216, v216, v76
v_mul_f32 v217, v217, v77
v_mul_f32 v218, v218, v78
s_add_u32 s38, s35, 10
s_and_b32 s38, s38, 15
s_mul_i32 s38, s38, 458752
s_add_u32 m0, s40, 98304
s_nop 0
buffer_load_dwordx4 v4, s[12:15], s38 offen lds
v_mul_f32 v219, v219, v79
v_cvt_pk_bf16_f32 v178, v192, v193
v_cvt_pk_bf16_f32 v179, v194, v195
v_cvt_pk_bf16_f32 v202, v216, v217
v_cvt_pk_bf16_f32 v203, v218, v219
buffer_store_dwordx4 v[176:179], v2, s[24:27], s54 offen offset:2048 sc1
s_add_u32 m0, s40, 99328
s_nop 0
buffer_load_dwordx4 v5, s[12:15], s38 offen lds
buffer_store_dwordx4 v[200:203], v2, s[24:27], s54 offen offset:3072 sc1
v_fma_f32 v184, -v60, v40, v184
v_fma_f32 v185, -v60, v41, v185
v_fma_f32 v186, -v60, v42, v186
v_fma_f32 v187, -v60, v43, v187
v_fma_f32 v208, -v62, v40, v208
s_add_u32 m0, s40, 100352
s_add_u32 s38, s38, 57344
buffer_load_dwordx4 v4, s[12:15], s38 offen lds
v_fma_f32 v209, -v62, v41, v209
v_fma_f32 v210, -v62, v42, v210
v_fma_f32 v211, -v62, v43, v211
v_mul_f32 v72, v184, v184
v_mul_f32 v73, v185, v185
v_mul_f32 v74, v186, v186
s_add_u32 m0, s40, 101376
s_nop 0
buffer_load_dwordx4 v5, s[12:15], s38 offen lds
v_mul_f32 v75, v187, v187
v_mul_f32 v76, v208, v208
v_mul_f32 v77, v209, v209
v_mul_f32 v78, v210, v210
v_mul_f32 v79, v211, v211
v_fma_f32 v72, v72, v65, v64
s_add_u32 m0, s40, 102400
s_add_u32 s38, s38, 57344
buffer_load_dwordx4 v4, s[12:15], s38 offen lds
v_fma_f32 v73, v73, v65, v64
v_fma_f32 v74, v74, v65, v64
v_fma_f32 v75, v75, v65, v64
v_fma_f32 v76, v76, v69, v68
v_fma_f32 v77, v77, v69, v68
v_fma_f32 v78, v78, v69, v68
s_add_u32 m0, s40, 103424
s_nop 0
buffer_load_dwordx4 v5, s[12:15], s38 offen lds
v_fma_f32 v79, v79, v69, v68
v_mul_f32 v72, v72, v184
v_mul_f32 v73, v73, v185
v_mul_f32 v74, v74, v186
v_mul_f32 v75, v75, v187
v_mul_f32 v76, v76, v208
s_add_u32 m0, s40, 104448
s_add_u32 s38, s38, 57344
buffer_load_dwordx4 v4, s[12:15], s38 offen lds
s_add_u32 m0, s40, 105472
s_nop 0
buffer_load_dwordx4 v5, s[12:15], s38 offen lds
s_waitcnt vmcnt(14)
s_cmp_eq_u32 s47, 3
s_cbranch_scc0 Lw_112
s_mov_b32 s41, 0x40000
Lcp_113:
s_waitcnt lgkmcnt(0)
s_and_b32 s92, s92, s93
s_cmp_eq_u32 s92, 16
s_cbranch_scc1 Lco_114
s_load_dword s92, s[82:83], s60 glc
s_load_dword s93, s[82:83], s61 glc
s_sub_u32 s41, s41, 1
s_cmp_lg_u32 s41, 0
s_cbranch_scc1 Lcp_113
s_waitcnt lgkmcnt(0)
Lco_114:
Lw_112:
s_barrier
s_lshl_b32 s60, s35, 9
s_lshl_b32 s43, s47, 7
s_add_u32 s60, s60, s43
s_add_u32 s61, s60, 14336
s_add_u32 s52, s43, 148480
s_add_u32 s53, s52, 896
v_lshrrev_b32 v104, 3, v1
v_mul_u32_u24 v104, 28672, v104
v_and_b32 v105, 7, v1
v_lshl_add_u32 v104, v105, 4, v104
s_waitcnt lgkmcnt(0)
buffer_load_dwordx4 v[96:99], v104, s[84:87], s60 offen sc1
s_load_dword s3, s[4:5], 5376
s_load_dword s3, s[4:5], 5440
s_load_dword s3, s[4:5], 5504
s_load_dword s3, s[4:5], 5568
s_load_dword s3, s[4:5], 5632
s_load_dword s3, s[4:5], 5696
buffer_load_dwordx4 v[100:103], v104, s[84:87], s61 offen sc1
s_load_dword s3, s[4:5], 5760
s_load_dword s3, s[4:5], 5824
s_load_dword s3, s[4:5], 5888
s_load_dword s3, s[4:5], 5952
s_load_dword s3, s[4:5], 6016
s_load_dword s3, s[4:5], 6080
s_load_dword s3, s[4:5], 6144
s_add_u32 s37, s35, 11
s_and_b32 s37, s37, 15
s_mul_i32 s37, s37, 16384
s_add_u32 m0, s39, 0
s_nop 0
buffer_load_dwordx4 v3, s[8:11], s37 offen sc1 lds
s_load_dword s3, s[4:5], 6208
v_mul_f32 v77, v77, v209
v_mul_f32 v78, v78, v210
v_mul_f32 v79, v79, v211
v_exp_f32 v72, v72
v_exp_f32 v73, v73
v_exp_f32 v74, v74
buffer_load_dwordx4 v3, s[8:11], s37 offen offset:1024 sc1 lds
v_exp_f32 v75, v75
v_exp_f32 v76, v76
v_exp_f32 v77, v77
v_exp_f32 v78, v78
v_exp_f32 v79, v79
v_fma_f32 v196, -v60, v52, v196
v_fma_f32 v197, -v60, v53, v197
buffer_load_dwordx4 v3, s[8:11], s37 offen offset:2048 sc1 lds
v_fma_f32 v198, -v60, v54, v198
v_fma_f32 v199, -v60, v55, v199
v_fma_f32 v220, -v62, v52, v220
v_fma_f32 v221, -v62, v53, v221
v_fma_f32 v222, -v62, v54, v222
v_fma_f32 v223, -v62, v55, v223
buffer_load_dwordx4 v3, s[8:11], s37 offen offset:3072 sc1 lds
v_fma_f32 v72, v72, v66, v66
v_fma_f32 v73, v73, v66, v66
v_fma_f32 v74, v74, v66, v66
v_fma_f32 v75, v75, v66, v66
v_fma_f32 v76, v76, v70, v70
v_fma_f32 v77, v77, v70, v70
v_fma_f32 v78, v78, v70, v70
s_add_u32 s38, s35, 11
s_and_b32 s38, s38, 15
s_mul_i32 s38, s38, 458752
s_add_u32 m0, s40, 0
s_nop 0
buffer_load_dwordx4 v4, s[12:15], s38 offen lds
v_fma_f32 v79, v79, v70, v70
v_rcp_f32 v72, v72
v_rcp_f32 v73, v73
v_rcp_f32 v74, v74
v_rcp_f32 v75, v75
v_rcp_f32 v76, v76
v_rcp_f32 v77, v77
s_add_u32 m0, s40, 1024
s_nop 0
buffer_load_dwordx4 v5, s[12:15], s38 offen lds
v_rcp_f32 v78, v78
v_rcp_f32 v79, v79
v_mul_f32 v196, v184, v196
v_mul_f32 v197, v185, v197
v_mul_f32 v198, v186, v198
v_mul_f32 v199, v187, v199
v_mul_f32 v220, v208, v220
s_add_u32 m0, s40, 2048
s_add_u32 s38, s38, 57344
buffer_load_dwordx4 v4, s[12:15], s38 offen lds
v_mul_f32 v221, v209, v221
v_mul_f32 v222, v210, v222
v_mul_f32 v223, v211, v223
v_mul_f32 v196, v196, v72
v_mul_f32 v197, v197, v73
v_mul_f32 v198, v198, v74
s_add_u32 m0, s40, 3072
s_nop 0
buffer_load_dwordx4 v5, s[12:15], s38 offen lds
v_mul_f32 v199, v199, v75
v_mul_f32 v220, v220, v76
v_mul_f32 v221, v221, v77
v_mul_f32 v222, v222, v78
v_mul_f32 v223, v223, v79
v_cvt_pk_bf16_f32 v80, v196, v197
v_cvt_pk_bf16_f32 v81, v198, v199
s_add_u32 m0, s40, 4096
s_add_u32 s38, s38, 57344
buffer_load_dwordx4 v4, s[12:15], s38 offen lds
v_cvt_pk_bf16_f32 v82, v220, v221
v_cvt_pk_bf16_f32 v83, v222, v223
s_nop 1
v_permlane32_swap_b32 v80, v82
v_permlane32_swap_b32 v81, v83
buffer_store_dwordx4 v[80:83], v84, s[24:27], s55 offen offset:2048 sc1
s_nop 1
s_add_u32 m0, s40, 5120
s_nop 0
buffer_load_dwordx4 v5, s[12:15], s38 offen lds
v_cmp_gt_u32 vcc, 32, v1
v_mov_b32 v104, s52
v_mov_b32 v106, s53
v_cndmask_b32 v104, v106, v104, vcc
v_lshl_add_u32 v104, v105, 4, v104
v_bfe_u32 v105, v1, 4, 1
v_lshl_add_u32 v104, v105, 2, v104
s_add_u32 m0, s40, 6144
s_add_u32 s38, s38, 57344
buffer_load_dwordx4 v4, s[12:15], s38 offen lds
s_add_u32 m0, s40, 7168
s_nop 0
buffer_load_dwordx4 v5, s[12:15], s38 offen lds
s_waitcnt vmcnt(15)
s_barrier
s_add_u32 s37, s35, 12
s_and_b32 s37, s37, 15
s_mul_i32 s37, s37, 16384
s_add_u32 m0, s39, 49152
s_nop 0
buffer_load_dwordx4 v3, s[8:11], s37 offen sc1 lds
buffer_load_dwordx4 v3, s[8:11], s37 offen offset:1024 sc1 lds
buffer_load_dwordx4 v3, s[8:11], s37 offen offset:2048 sc1 lds
buffer_load_dwordx4 v3, s[8:11], s37 offen offset:3072 sc1 lds
s_add_u32 s38, s35, 12
s_and_b32 s38, s38, 15
s_mul_i32 s38, s38, 458752
s_add_u32 m0, s40, 49152
s_nop 0
buffer_load_dwordx4 v4, s[12:15], s38 offen lds
s_add_u32 m0, s40, 50176
s_nop 0
buffer_load_dwordx4 v5, s[12:15], s38 offen lds
s_add_u32 m0, s40, 51200
s_add_u32 s38, s38, 57344
buffer_load_dwordx4 v4, s[12:15], s38 offen lds
s_add_u32 m0, s40, 52224
s_nop 0
buffer_load_dwordx4 v5, s[12:15], s38 offen lds
s_add_u32 m0, s40, 53248
s_add_u32 s38, s38, 57344
buffer_load_dwordx4 v4, s[12:15], s38 offen lds
s_add_u32 m0, s40, 54272
s_nop 0
buffer_load_dwordx4 v5, s[12:15], s38 offen lds
s_add_u32 m0, s40, 55296
s_add_u32 s38, s38, 57344
buffer_load_dwordx4 v4, s[12:15], s38 offen lds
s_add_u32 m0, s40, 56320
s_nop 0
buffer_load_dwordx4 v5, s[12:15], s38 offen lds
s_waitcnt vmcnt(12)
s_barrier
s_cmp_eq_u32 s47, 0
s_cbranch_scc0 Lw_115
s_add_u32 s7, s34, 32
s_lshl_b32 s7, s7, 7
v_mov_b32 v90, s7
v_mov_b32 v91, 1
s_mov_b64 exec, 1
buffer_atomic_add v91, v90, s[56:59], 0 offen sc1
s_mov_b64 exec, -1
Lw_115:
v_permlane32_swap_b32 v96, v100
v_permlane32_swap_b32 v97, v101
v_permlane32_swap_b32 v98, v102
v_permlane32_swap_b32 v99, v103
v_add_f32 v96, v96, v100
v_add_f32 v97, v97, v101
v_add_f32 v98, v98, v102
v_add_f32 v99, v99, v103
s_nop 1
v_permlane16_swap_b32 v96, v97
v_permlane16_swap_b32 v98, v99
v_add_f32 v96, v96, v97
v_add_f32 v98, v98, v99
s_nop 1
v_add_f32_dpp v96, v96, v96 row_ror:8 row_mask:0xf bank_mask:0xf
v_add_f32_dpp v98, v98, v98 row_ror:8 row_mask:0xf bank_mask:0xf
ds_write_b32 v104, v96
ds_write_b32 v104, v98 offset:8
s_waitcnt lgkmcnt(0)
s_add_u32 s37, s35, 13
s_and_b32 s37, s37, 15
s_mul_i32 s37, s37, 16384
s_add_u32 m0, s39, 98304
s_nop 0
buffer_load_dwordx4 v3, s[8:11], s37 offen sc1 lds
s_load_dword s3, s[4:5], 6272
s_load_dword s3, s[4:5], 6336
s_load_dword s3, s[4:5], 6400
s_load_dword s3, s[4:5], 6464
s_load_dword s3, s[4:5], 6528
s_load_dword s3, s[4:5], 6592
buffer_load_dwordx4 v3, s[8:11], s37 offen offset:1024 sc1 lds
s_load_dword s3, s[4:5], 6656
s_load_dword s3, s[4:5], 6720
s_load_dword s3, s[4:5], 6784
s_load_dword s3, s[4:5], 6848
s_load_dword s3, s[4:5], 6912
s_load_dword s3, s[4:5], 6976
buffer_load_dwordx4 v3, s[8:11], s37 offen offset:2048 sc1 lds
s_load_dword s3, s[4:5], 7040
s_load_dword s3, s[4:5], 7104
s_bfe_u32 s61, s35, 0x10002
s_lshr_b32 s60, s35, 3
s_lshl_b32 s60, s60, 2
s_and_b32 s43, s35, 3
buffer_load_dwordx4 v3, s[8:11], s37 offen offset:3072 sc1 lds
s_add_u32 s60, s60, s43
s_lshl_b32 s43, s60, 8
s_add_u32 s28, s76, s43
s_addc_u32 s29, s77, 0
s_mov_b32 s30, 7338240
s_mov_b32 s31, 0x20000
s_mul_i32 s52, s61, 196608
s_add_u32 s38, s35, 13
s_and_b32 s38, s38, 15
s_mul_i32 s38, s38, 458752
s_add_u32 m0, s40, 98304
s_nop 0
buffer_load_dwordx4 v4, s[12:15], s38 offen lds
s_mul_i32 s53, s61, 1572864
s_mul_i32 s90, s61, 163840
s_branch Lov_10
.p2align 12
.fill 80, 4, 0xbf800000
Lst_10_0:
s_branch Lwr_155
Lst_10_1:
s_branch Lwr_166
s_nop 0
Lov_10:
s_mul_i32 s91, s61, 1310720
s_lshl_b32 s51, s47, 11
s_lshl_b32 s44, s47, 15
v_lshrrev_b32 v122, 4, v1
s_add_u32 m0, s40, 99328
s_nop 0
buffer_load_dwordx4 v5, s[12:15], s38 offen lds
v_lshlrev_b32 v123, 1, v122
v_and_b32 v23, 15, v1
v_xor_b32 v23, v23, v123
v_lshlrev_b32 v23, 4, v23
v_mul_u32_u24 v122, 2048, v122
v_add_u32 v23, v23, v122
s_add_u32 m0, s40, 100352
s_add_u32 s38, s38, 57344
buffer_load_dwordx4 v4, s[12:15], s38 offen lds
v_add_u32 v23, s44, v23
v_xor_b32 v24, 128, v23
v_add_u32 v24, 8192, v24
s_lshl_b32 s43, s60, 2
s_lshl_b32 s44, s61, 1
s_add_u32 s43, s43, s44
s_add_u32 s43, s43, s63
s_add_u32 m0, s40, 101376
s_nop 0
buffer_load_dwordx4 v5, s[12:15], s38 offen lds
s_lshl_b32 s43, s43, 13
s_lshl_b32 s44, s62, 12
s_add_u32 s50, s43, s44
v_add_u32 v17, s44, v2
v_add_u32 v18, 0x10000, v17
v_add_u32 v19, 0x20000, v17
s_add_u32 m0, s40, 102400
s_add_u32 s38, s38, 57344
buffer_load_dwordx4 v4, s[12:15], s38 offen lds
v_lshrrev_b32 v122, 2, v1
v_and_b32 v123, 7, v122
v_mul_u32_u24 v122, 256, v122
v_lshl_add_u32 v122, v123, 5, v122
v_and_b32 v123, 3, v1
v_lshl_add_u32 v9, v123, 3, v122
s_add_u32 m0, s40, 103424
s_nop 0
buffer_load_dwordx4 v5, s[12:15], s38 offen lds
s_lshl_b32 s43, s61, 7
s_lshl_b32 s44, s63, 6
s_add_u32 s43, s43, s44
v_xor_b32 v9, s43, v9
v_xor_b32 v10, 32, v9
v_xor_b32 v11, 128, v9
v_xor_b32 v12, 128, v10
s_add_u32 m0, s40, 104448
s_add_u32 s38, s38, 57344
buffer_load_dwordx4 v4, s[12:15], s38 offen lds
s_add_u32 m0, s40, 105472
s_nop 0
buffer_load_dwordx4 v5, s[12:15], s38 offen lds
s_waitcnt vmcnt(12)
s_barrier
buffer_load_dwordx4 v[160:163], v2, s[8:11], s50 offen offset:0 sc1
v_add_u32 v13, 65536, v9
v_add_u32 v14, 65536, v10
v_add_u32 v15, 65536, v11
buffer_load_dwordx4 v[164:167], v2, s[8:11], s50 offen offset:1024 sc1
v_add_u32 v16, 65536, v12
v_add_u32 v25, 131072, v9
v_add_u32 v26, 131072, v10
v_add_u32 v27, 131072, v11
buffer_load_dwordx4 v[168:171], v2, s[8:11], s50 offen offset:2048 sc1
v_add_u32 v28, 131072, v12
v_lshrrev_b32 v122, 2, v1
v_bfe_u32 v123, v122, 1, 2
buffer_load_dwordx4 v[172:175], v2, s[8:11], s50 offen offset:3072 sc1
v_mul_u32_u24 v122, 128, v122
v_lshl_add_u32 v122, v123, 5, v122
v_and_b32 v123, 3, v1
v_lshl_add_u32 v224, v123, 3, v122
s_add_u32 s37, s35, 14
s_and_b32 s37, s37, 15
s_mul_i32 s37, s37, 16384
s_add_u32 m0, s39, 0
s_nop 0
buffer_load_dwordx4 v3, s[8:11], s37 offen sc1 lds
v_xor_b32 v224, s44, v224
v_xor_b32 v225, 32, v224
v_add_u32 v226, 65536, v224
buffer_load_dwordx4 v3, s[8:11], s37 offen offset:1024 sc1 lds
v_add_u32 v227, 65536, v225
v_add_u32 v228, 131072, v224
v_add_u32 v229, 131072, v225
s_add_u32 s84, s82, 33554432
buffer_load_dwordx4 v3, s[8:11], s37 offen offset:2048 sc1 lds
s_addc_u32 s85, s83, 0
s_mov_b32 s86, 4194304
s_mov_b32 s87, 0x20000
s_xor_b32 s43, s2, 2
buffer_load_dwordx4 v3, s[8:11], s37 offen offset:3072 sc1 lds
s_lshl_b32 s44, s43, 2
s_add_u32 s44, s44, s47
s_lshl_b32 s45, s44, 12
s_add_u32 s38, s35, 14
s_and_b32 s38, s38, 15
s_mul_i32 s38, s38, 458752
s_add_u32 m0, s40, 0
s_nop 0
buffer_load_dwordx4 v4, s[12:15], s38 offen lds
s_lshl_b32 s46, s2, 2
s_add_u32 s46, s46, s47
s_lshl_b32 s46, s46, 12
s_lshl_b32 s43, s34, 18
s_add_u32 m0, s40, 1024
s_nop 0
buffer_load_dwordx4 v5, s[12:15], s38 offen lds
s_lshl_b32 s42, s60, 8
s_add_u32 s43, s43, s42
s_lshl_b32 s42, s61, 7
s_add_u32 m0, s40, 2048
s_add_u32 s38, s38, 57344
buffer_load_dwordx4 v4, s[12:15], s38 offen lds
s_add_u32 s43, s43, s42
s_lshl_b32 s42, s63, 6
s_add_u32 s43, s43, s42
s_add_u32 s20, s78, s43
s_add_u32 m0, s40, 3072
s_nop 0
buffer_load_dwordx4 v5, s[12:15], s38 offen lds
s_addc_u32 s21, s79, 0
s_mov_b32 s22, 260160
s_mov_b32 s23, 0x20000
s_add_u32 m0, s40, 4096
s_add_u32 s38, s38, 57344
buffer_load_dwordx4 v4, s[12:15], s38 offen lds
v_and_b32 v230, 15, v1
v_lshlrev_b32 v230, 12, v230
v_bfe_u32 v231, v1, 4, 1
v_lshl_add_u32 v230, v231, 5, v230
s_add_u32 m0, s40, 5120
s_nop 0
buffer_load_dwordx4 v5, s[12:15], s38 offen lds
v_bfe_u32 v231, v1, 5, 1
v_lshl_add_u32 v230, v231, 4, v230
s_lshl_b32 s54, s62, 17
s_add_u32 s55, s54, 65536
s_add_u32 m0, s40, 6144
s_add_u32 s38, s38, 57344
buffer_load_dwordx4 v4, s[12:15], s38 offen lds
s_add_u32 m0, s40, 7168
s_nop 0
buffer_load_dwordx4 v5, s[12:15], s38 offen lds
s_waitcnt vmcnt(16)
s_barrier
s_cmp_eq_u32 s47, 3
s_cbranch_scc0 Lw_116
s_lshl_b32 s92, s34, 7
s_add_u32 s92, s92, 28315648
s_load_dword s93, s[82:83], s92 glc
Lw_116:
s_add_u32 s37, s35, 15
s_and_b32 s37, s37, 15
s_mul_i32 s37, s37, 16384
s_add_u32 m0, s39, 49152
s_nop 0
buffer_load_dwordx4 v3, s[8:11], s37 offen sc1 lds
buffer_load_dwordx4 v3, s[8:11], s37 offen offset:1024 sc1 lds
buffer_load_dwordx4 v3, s[8:11], s37 offen offset:2048 sc1 lds
buffer_load_dwordx4 v3, s[8:11], s37 offen offset:3072 sc1 lds
s_add_u32 s38, s35, 15
s_and_b32 s38, s38, 15
s_mul_i32 s38, s38, 458752
s_add_u32 m0, s40, 49152
s_nop 0
buffer_load_dwordx4 v4, s[12:15], s38 offen lds
s_add_u32 m0, s40, 50176
s_nop 0
buffer_load_dwordx4 v5, s[12:15], s38 offen lds
s_add_u32 m0, s40, 51200
s_add_u32 s38, s38, 57344
buffer_load_dwordx4 v4, s[12:15], s38 offen lds
s_add_u32 m0, s40, 52224
s_nop 0
buffer_load_dwordx4 v5, s[12:15], s38 offen lds
s_add_u32 m0, s40, 53248
s_add_u32 s38, s38, 57344
buffer_load_dwordx4 v4, s[12:15], s38 offen lds
s_add_u32 m0, s40, 54272
s_nop 0
buffer_load_dwordx4 v5, s[12:15], s38 offen lds
s_add_u32 m0, s40, 55296
s_add_u32 s38, s38, 57344
buffer_load_dwordx4 v4, s[12:15], s38 offen lds
s_add_u32 m0, s40, 56320
s_nop 0
buffer_load_dwordx4 v5, s[12:15], s38 offen lds
s_waitcnt vmcnt(12)
s_cmp_eq_u32 s47, 3
s_cbranch_scc0 Lw_117
s_mov_b32 s41, 0x40000
s_branch Lpchk_120
Lpoll_118:
s_load_dword s93, s[82:83], s92 glc
Lpchk_120:
s_waitcnt lgkmcnt(0)
s_cmp_eq_u32 s93, 16
s_cbranch_scc1 Lpok_119
s_sub_u32 s41, s41, 1
s_cmp_lg_u32 s41, 0
s_cbranch_scc1 Lpoll_118
Lpok_119:
Lw_117:
s_barrier
s_add_u32 m0, s39, 98304
s_add_u32 s37, s52, 524288
buffer_load_dwordx4 v3, s[24:27], s37 offen sc1 lds
v_lshlrev_b32 v128, 16, v160
v_and_b32 v129, 0xffff0000, v160
v_lshlrev_b32 v130, 16, v161
v_and_b32 v131, 0xffff0000, v161
v_lshlrev_b32 v132, 16, v162
buffer_load_dwordx4 v3, s[24:27], s37 offen offset:1024 sc1 lds
v_and_b32 v133, 0xffff0000, v162
v_lshlrev_b32 v134, 16, v163
v_and_b32 v135, 0xffff0000, v163
v_lshlrev_b32 v136, 16, v164
v_and_b32 v137, 0xffff0000, v164
buffer_load_dwordx4 v3, s[24:27], s37 offen offset:2048 sc1 lds
v_lshlrev_b32 v138, 16, v165
v_and_b32 v139, 0xffff0000, v165
v_lshlrev_b32 v140, 16, v166
v_and_b32 v141, 0xffff0000, v166
v_lshlrev_b32 v142, 16, v167
v_and_b32 v143, 0xffff0000, v167
buffer_load_dwordx4 v3, s[24:27], s37 offen offset:3072 sc1 lds
v_lshlrev_b32 v144, 16, v168
v_and_b32 v145, 0xffff0000, v168
v_lshlrev_b32 v146, 16, v169
v_and_b32 v147, 0xffff0000, v169
v_lshlrev_b32 v148, 16, v170
s_add_u32 m0, s39, 114688
s_add_u32 s38, s53, 4194304
buffer_load_dwordx4 v23, s[28:31], s38 offen lds
v_and_b32 v149, 0xffff0000, v170
v_lshlrev_b32 v150, 16, v171
v_and_b32 v151, 0xffff0000, v171
v_lshlrev_b32 v152, 16, v172
v_and_b32 v153, 0xffff0000, v172
s_add_u32 m0, s39, 115712
s_add_u32 s38, s53, 4194304
buffer_load_dwordx4 v24, s[28:31], s38 offen lds
v_lshlrev_b32 v154, 16, v173
v_and_b32 v155, 0xffff0000, v173
v_lshlrev_b32 v156, 16, v174
v_and_b32 v157, 0xffff0000, v174
v_lshlrev_b32 v158, 16, v175
v_and_b32 v159, 0xffff0000, v175
s_add_u32 m0, s39, 116736
s_add_u32 s38, s53, 4210688
buffer_load_dwordx4 v23, s[28:31], s38 offen lds
s_add_u32 m0, s39, 117760
s_add_u32 s38, s53, 4210688
buffer_load_dwordx4 v24, s[28:31], s38 offen lds
s_waitcnt vmcnt(8)
s_barrier
s_add_u32 m0, s39, 131072
s_add_u32 s37, s52, 540672
buffer_load_dwordx4 v3, s[24:27], s37 offen sc1 lds
buffer_load_dwordx4 v3, s[24:27], s37 offen offset:1024 sc1 lds
buffer_load_dwordx4 v3, s[24:27], s37 offen offset:2048 sc1 lds
buffer_load_dwordx4 v3, s[24:27], s37 offen offset:3072 sc1 lds
s_add_u32 m0, s39, 0
s_add_u32 s38, s53, 4325376
buffer_load_dwordx4 v23, s[28:31], s38 offen lds
s_add_u32 m0, s39, 1024
s_add_u32 s38, s53, 4325376
buffer_load_dwordx4 v24, s[28:31], s38 offen lds
s_add_u32 m0, s39, 2048
s_add_u32 s38, s53, 4341760
buffer_load_dwordx4 v23, s[28:31], s38 offen lds
s_add_u32 m0, s39, 3072
s_add_u32 s38, s53, 4341760
buffer_load_dwordx4 v24, s[28:31], s38 offen lds
s_add_u32 m0, s39, 16384
s_add_u32 s37, s52, 557056
buffer_load_dwordx4 v3, s[24:27], s37 offen sc1 lds
buffer_load_dwordx4 v3, s[24:27], s37 offen offset:1024 sc1 lds
buffer_load_dwordx4 v3, s[24:27], s37 offen offset:2048 sc1 lds
buffer_load_dwordx4 v3, s[24:27], s37 offen offset:3072 sc1 lds
s_add_u32 m0, s39, 32768
s_add_u32 s38, s53, 4456448
buffer_load_dwordx4 v23, s[28:31], s38 offen lds
s_add_u32 m0, s39, 33792
s_add_u32 s38, s53, 4456448
buffer_load_dwordx4 v24, s[28:31], s38 offen lds
s_add_u32 m0, s39, 34816
s_add_u32 s38, s53, 4472832
buffer_load_dwordx4 v23, s[28:31], s38 offen lds
s_add_u32 m0, s39, 35840
s_add_u32 s38, s53, 4472832
buffer_load_dwordx4 v24, s[28:31], s38 offen lds
s_waitcnt vmcnt(16)
s_barrier
ds_read_b128 v[32:35], v18 offset:32768
ds_read_b64_tr_b16 v[48:49], v13 offset:49152
ds_read_b64_tr_b16 v[50:51], v13 offset:53248
ds_read_b64_tr_b16 v[52:53], v14 offset:49152
ds_read_b64_tr_b16 v[54:55], v14 offset:53248
ds_read_b64_tr_b16 v[56:57], v15 offset:49152
ds_read_b64_tr_b16 v[58:59], v15 offset:53248
ds_read_b64_tr_b16 v[60:61], v16 offset:49152
ds_read_b64_tr_b16 v[62:63], v16 offset:53248
ds_read_b128 v[36:39], v18 offset:33792
ds_read_b128 v[40:43], v18 offset:34816
ds_read_b128 v[44:47], v18 offset:35840
ds_read_b128 v[64:67], v18 offset:40960
ds_read_b64_tr_b16 v[80:81], v13 offset:57344
ds_read_b64_tr_b16 v[82:83], v13 offset:61440
ds_read_b64_tr_b16 v[84:85], v14 offset:57344
ds_read_b64_tr_b16 v[86:87], v14 offset:61440
ds_read_b64_tr_b16 v[88:89], v15 offset:57344
ds_read_b64_tr_b16 v[90:91], v15 offset:61440
ds_read_b64_tr_b16 v[92:93], v16 offset:57344
ds_read_b64_tr_b16 v[94:95], v16 offset:61440
ds_read_b128 v[68:71], v18 offset:41984
ds_read_b128 v[72:75], v18 offset:43008
ds_read_b128 v[76:79], v18 offset:44032
s_add_u32 m0, s39, 49152
s_add_u32 s37, s52, 573440
buffer_load_dwordx4 v3, s[24:27], s37 offen sc1 lds
buffer_load_dwordx4 v3, s[24:27], s37 offen offset:1024 sc1 lds
buffer_load_dwordx4 v3, s[24:27], s37 offen offset:2048 sc1 lds
buffer_load_dwordx4 v3, s[24:27], s37 offen offset:3072 sc1 lds
s_add_u32 m0, s39, 65536
s_add_u32 s38, s53, 4587520
buffer_load_dwordx4 v23, s[28:31], s38 offen lds
s_add_u32 m0, s39, 66560
s_add_u32 s38, s53, 4587520
buffer_load_dwordx4 v24, s[28:31], s38 offen lds
s_add_u32 m0, s39, 67584
s_add_u32 s38, s53, 4603904
buffer_load_dwordx4 v23, s[28:31], s38 offen lds
s_add_u32 m0, s39, 68608
s_add_u32 s38, s53, 4603904
buffer_load_dwordx4 v24, s[28:31], s38 offen lds
s_waitcnt vmcnt(16)
s_waitcnt lgkmcnt(0)
s_barrier
v_mfma_f32_16x16x32_bf16 v[128:131], v[48:51], v[32:35], v[128:131]
ds_read_b128 v[96:99], v19 offset:0
v_mfma_f32_16x16x32_bf16 v[132:135], v[52:55], v[32:35], v[132:135]
ds_read_b64_tr_b16 v[112:113], v9 offset:0
v_mfma_f32_16x16x32_bf16 v[160:163], v[56:59], v[32:35], 0
ds_read_b64_tr_b16 v[114:115], v9 offset:4096
v_mfma_f32_16x16x32_bf16 v[164:167], v[60:63], v[32:35], 0
ds_read_b64_tr_b16 v[116:117], v10 offset:0
v_mfma_f32_16x16x32_bf16 v[172:175], v[60:63], v[36:39], 0
ds_read_b64_tr_b16 v[118:119], v10 offset:4096
v_mfma_f32_16x16x32_bf16 v[168:171], v[56:59], v[36:39], 0
ds_read_b64_tr_b16 v[120:121], v11 offset:0
v_mfma_f32_16x16x32_bf16 v[140:143], v[52:55], v[36:39], v[140:143]
ds_read_b64_tr_b16 v[122:123], v11 offset:4096
v_mfma_f32_16x16x32_bf16 v[136:139], v[48:51], v[36:39], v[136:139]
ds_read_b64_tr_b16 v[124:125], v12 offset:0
v_mfma_f32_16x16x32_bf16 v[144:147], v[48:51], v[40:43], v[144:147]
ds_read_b64_tr_b16 v[126:127], v12 offset:4096
v_mfma_f32_16x16x32_bf16 v[148:151], v[52:55], v[40:43], v[148:151]
ds_read_b128 v[100:103], v19 offset:1024
v_mfma_f32_16x16x32_bf16 v[176:179], v[56:59], v[40:43], 0
ds_read_b128 v[104:107], v19 offset:2048
v_mfma_f32_16x16x32_bf16 v[180:183], v[60:63], v[40:43], 0
ds_read_b128 v[108:111], v19 offset:3072
v_mfma_f32_16x16x32_bf16 v[188:191], v[60:63], v[44:47], 0
ds_read_b128 v[192:195], v19 offset:8192
v_mfma_f32_16x16x32_bf16 v[184:187], v[56:59], v[44:47], 0
ds_read_b64_tr_b16 v[208:209], v9 offset:8192
v_mfma_f32_16x16x32_bf16 v[156:159], v[52:55], v[44:47], v[156:159]
ds_read_b64_tr_b16 v[210:211], v9 offset:12288
v_mfma_f32_16x16x32_bf16 v[152:155], v[48:51], v[44:47], v[152:155]
ds_read_b64_tr_b16 v[212:213], v10 offset:8192
v_mfma_f32_16x16x32_bf16 v[128:131], v[80:83], v[64:67], v[128:131]
ds_read_b64_tr_b16 v[214:215], v10 offset:12288
v_mfma_f32_16x16x32_bf16 v[132:135], v[84:87], v[64:67], v[132:135]
ds_read_b64_tr_b16 v[216:217], v11 offset:8192
v_mfma_f32_16x16x32_bf16 v[160:163], v[88:91], v[64:67], v[160:163]
ds_read_b64_tr_b16 v[218:219], v11 offset:12288
v_mfma_f32_16x16x32_bf16 v[164:167], v[92:95], v[64:67], v[164:167]
ds_read_b64_tr_b16 v[220:221], v12 offset:8192
v_mfma_f32_16x16x32_bf16 v[172:175], v[92:95], v[68:71], v[172:175]
ds_read_b64_tr_b16 v[222:223], v12 offset:12288
v_mfma_f32_16x16x32_bf16 v[168:171], v[88:91], v[68:71], v[168:171]
ds_read_b128 v[196:199], v19 offset:9216
v_mfma_f32_16x16x32_bf16 v[140:143], v[84:87], v[68:71], v[140:143]
ds_read_b128 v[200:203], v19 offset:10240
v_mfma_f32_16x16x32_bf16 v[136:139], v[80:83], v[68:71], v[136:139]
ds_read_b128 v[204:207], v19 offset:11264
v_mfma_f32_16x16x32_bf16 v[144:147], v[80:83], v[72:75], v[144:147]
v_mfma_f32_16x16x32_bf16 v[148:151], v[84:87], v[72:75], v[148:151]
v_mfma_f32_16x16x32_bf16 v[176:179], v[88:91], v[72:75], v[176:179]
v_mfma_f32_16x16x32_bf16 v[180:183], v[92:95], v[72:75], v[180:183]
v_mfma_f32_16x16x32_bf16 v[188:191], v[92:95], v[76:79], v[188:191]
v_mfma_f32_16x16x32_bf16 v[184:187], v[88:91], v[76:79], v[184:187]
v_mfma_f32_16x16x32_bf16 v[156:159], v[84:87], v[76:79], v[156:159]
v_mfma_f32_16x16x32_bf16 v[152:155], v[80:83], v[76:79], v[152:155]
s_mov_b32 s41, 2
Lk4_121:
s_waitcnt vmcnt(8)
s_waitcnt lgkmcnt(0)
s_barrier
v_mfma_f32_16x16x32_bf16 v[128:131], v[112:115], v[96:99], v[128:131]
ds_read_b128 v[32:35], v17 offset:16384
v_mfma_f32_16x16x32_bf16 v[132:135], v[116:119], v[96:99], v[132:135]
ds_read_b64_tr_b16 v[48:49], v9 offset:32768
v_mfma_f32_16x16x32_bf16 v[160:163], v[120:123], v[96:99], v[160:163]
ds_read_b64_tr_b16 v[50:51], v9 offset:36864
v_mfma_f32_16x16x32_bf16 v[164:167], v[124:127], v[96:99], v[164:167]
ds_read_b64_tr_b16 v[52:53], v10 offset:32768
v_mfma_f32_16x16x32_bf16 v[172:175], v[124:127], v[100:103], v[172:175]
ds_read_b64_tr_b16 v[54:55], v10 offset:36864
v_mfma_f32_16x16x32_bf16 v[168:171], v[120:123], v[100:103], v[168:171]
ds_read_b64_tr_b16 v[56:57], v11 offset:32768
v_mfma_f32_16x16x32_bf16 v[140:143], v[116:119], v[100:103], v[140:143]
ds_read_b64_tr_b16 v[58:59], v11 offset:36864
v_mfma_f32_16x16x32_bf16 v[136:139], v[112:115], v[100:103], v[136:139]
ds_read_b64_tr_b16 v[60:61], v12 offset:32768
v_mfma_f32_16x16x32_bf16 v[144:147], v[112:115], v[104:107], v[144:147]
ds_read_b64_tr_b16 v[62:63], v12 offset:36864
v_mfma_f32_16x16x32_bf16 v[148:151], v[116:119], v[104:107], v[148:151]
ds_read_b128 v[36:39], v17 offset:17408
v_mfma_f32_16x16x32_bf16 v[176:179], v[120:123], v[104:107], v[176:179]
ds_read_b128 v[40:43], v17 offset:18432
v_mfma_f32_16x16x32_bf16 v[180:183], v[124:127], v[104:107], v[180:183]
ds_read_b128 v[44:47], v17 offset:19456
v_mfma_f32_16x16x32_bf16 v[188:191], v[124:127], v[108:111], v[188:191]
ds_read_b128 v[64:67], v17 offset:24576
v_mfma_f32_16x16x32_bf16 v[184:187], v[120:123], v[108:111], v[184:187]
ds_read_b64_tr_b16 v[80:81], v9 offset:40960
v_mfma_f32_16x16x32_bf16 v[156:159], v[116:119], v[108:111], v[156:159]
ds_read_b64_tr_b16 v[82:83], v9 offset:45056
v_mfma_f32_16x16x32_bf16 v[152:155], v[112:115], v[108:111], v[152:155]
ds_read_b64_tr_b16 v[84:85], v10 offset:40960
v_mfma_f32_16x16x32_bf16 v[128:131], v[208:211], v[192:195], v[128:131]
ds_read_b64_tr_b16 v[86:87], v10 offset:45056
v_mfma_f32_16x16x32_bf16 v[132:135], v[212:215], v[192:195], v[132:135]
ds_read_b64_tr_b16 v[88:89], v11 offset:40960
v_mfma_f32_16x16x32_bf16 v[160:163], v[216:219], v[192:195], v[160:163]
ds_read_b64_tr_b16 v[90:91], v11 offset:45056
v_mfma_f32_16x16x32_bf16 v[164:167], v[220:223], v[192:195], v[164:167]
ds_read_b64_tr_b16 v[92:93], v12 offset:40960
v_mfma_f32_16x16x32_bf16 v[172:175], v[220:223], v[196:199], v[172:175]
ds_read_b64_tr_b16 v[94:95], v12 offset:45056
v_mfma_f32_16x16x32_bf16 v[168:171], v[216:219], v[196:199], v[168:171]
ds_read_b128 v[68:71], v17 offset:25600
v_mfma_f32_16x16x32_bf16 v[140:143], v[212:215], v[196:199], v[140:143]
ds_read_b128 v[72:75], v17 offset:26624
v_mfma_f32_16x16x32_bf16 v[136:139], v[208:211], v[196:199], v[136:139]
ds_read_b128 v[76:79], v17 offset:27648
v_mfma_f32_16x16x32_bf16 v[144:147], v[208:211], v[200:203], v[144:147]
v_mfma_f32_16x16x32_bf16 v[148:151], v[212:215], v[200:203], v[148:151]
v_mfma_f32_16x16x32_bf16 v[176:179], v[216:219], v[200:203], v[176:179]
v_mfma_f32_16x16x32_bf16 v[180:183], v[220:223], v[200:203], v[180:183]
v_mfma_f32_16x16x32_bf16 v[188:191], v[220:223], v[204:207], v[188:191]
v_mfma_f32_16x16x32_bf16 v[184:187], v[216:219], v[204:207], v[184:187]
v_mfma_f32_16x16x32_bf16 v[156:159], v[212:215], v[204:207], v[156:159]
v_mfma_f32_16x16x32_bf16 v[152:155], v[208:211], v[204:207], v[152:155]
s_waitcnt vmcnt(0)
s_waitcnt lgkmcnt(0)
s_barrier
v_mfma_f32_16x16x32_bf16 v[128:131], v[48:51], v[32:35], v[128:131]
ds_read_b128 v[96:99], v17 offset:49152
v_mfma_f32_16x16x32_bf16 v[132:135], v[52:55], v[32:35], v[132:135]
ds_read_b64_tr_b16 v[112:113], v13 offset:0
v_mfma_f32_16x16x32_bf16 v[160:163], v[56:59], v[32:35], v[160:163]
ds_read_b64_tr_b16 v[114:115], v13 offset:4096
v_mfma_f32_16x16x32_bf16 v[164:167], v[60:63], v[32:35], v[164:167]
ds_read_b64_tr_b16 v[116:117], v14 offset:0
v_mfma_f32_16x16x32_bf16 v[172:175], v[60:63], v[36:39], v[172:175]
ds_read_b64_tr_b16 v[118:119], v14 offset:4096
v_mfma_f32_16x16x32_bf16 v[168:171], v[56:59], v[36:39], v[168:171]
ds_read_b64_tr_b16 v[120:121], v15 offset:0
v_mfma_f32_16x16x32_bf16 v[140:143], v[52:55], v[36:39], v[140:143]
ds_read_b64_tr_b16 v[122:123], v15 offset:4096
v_mfma_f32_16x16x32_bf16 v[136:139], v[48:51], v[36:39], v[136:139]
ds_read_b64_tr_b16 v[124:125], v16 offset:0
v_mfma_f32_16x16x32_bf16 v[144:147], v[48:51], v[40:43], v[144:147]
ds_read_b64_tr_b16 v[126:127], v16 offset:4096
v_mfma_f32_16x16x32_bf16 v[148:151], v[52:55], v[40:43], v[148:151]
ds_read_b128 v[100:103], v17 offset:50176
v_mfma_f32_16x16x32_bf16 v[176:179], v[56:59], v[40:43], v[176:179]
ds_read_b128 v[104:107], v17 offset:51200
v_mfma_f32_16x16x32_bf16 v[180:183], v[60:63], v[40:43], v[180:183]
ds_read_b128 v[108:111], v17 offset:52224
v_mfma_f32_16x16x32_bf16 v[188:191], v[60:63], v[44:47], v[188:191]
ds_read_b128 v[192:195], v17 offset:57344
v_mfma_f32_16x16x32_bf16 v[184:187], v[56:59], v[44:47], v[184:187]
ds_read_b64_tr_b16 v[208:209], v13 offset:8192
v_mfma_f32_16x16x32_bf16 v[156:159], v[52:55], v[44:47], v[156:159]
ds_read_b64_tr_b16 v[210:211], v13 offset:12288
v_mfma_f32_16x16x32_bf16 v[152:155], v[48:51], v[44:47], v[152:155]
ds_read_b64_tr_b16 v[212:213], v14 offset:8192
v_mfma_f32_16x16x32_bf16 v[128:131], v[80:83], v[64:67], v[128:131]
ds_read_b64_tr_b16 v[214:215], v14 offset:12288
v_mfma_f32_16x16x32_bf16 v[132:135], v[84:87], v[64:67], v[132:135]
ds_read_b64_tr_b16 v[216:217], v15 offset:8192
v_mfma_f32_16x16x32_bf16 v[160:163], v[88:91], v[64:67], v[160:163]
ds_read_b64_tr_b16 v[218:219], v15 offset:12288
v_mfma_f32_16x16x32_bf16 v[164:167], v[92:95], v[64:67], v[164:167]
ds_read_b64_tr_b16 v[220:221], v16 offset:8192
v_mfma_f32_16x16x32_bf16 v[172:175], v[92:95], v[68:71], v[172:175]
ds_read_b64_tr_b16 v[222:223], v16 offset:12288
v_mfma_f32_16x16x32_bf16 v[168:171], v[88:91], v[68:71], v[168:171]
ds_read_b128 v[196:199], v17 offset:58368
v_mfma_f32_16x16x32_bf16 v[140:143], v[84:87], v[68:71], v[140:143]
ds_read_b128 v[200:203], v17 offset:59392
v_mfma_f32_16x16x32_bf16 v[136:139], v[80:83], v[68:71], v[136:139]
ds_read_b128 v[204:207], v17 offset:60416
v_mfma_f32_16x16x32_bf16 v[144:147], v[80:83], v[72:75], v[144:147]
v_mfma_f32_16x16x32_bf16 v[148:151], v[84:87], v[72:75], v[148:151]
v_mfma_f32_16x16x32_bf16 v[176:179], v[88:91], v[72:75], v[176:179]
v_mfma_f32_16x16x32_bf16 v[180:183], v[92:95], v[72:75], v[180:183]
v_mfma_f32_16x16x32_bf16 v[188:191], v[92:95], v[76:79], v[188:191]
v_mfma_f32_16x16x32_bf16 v[184:187], v[88:91], v[76:79], v[184:187]
v_mfma_f32_16x16x32_bf16 v[156:159], v[84:87], v[76:79], v[156:159]
v_mfma_f32_16x16x32_bf16 v[152:155], v[80:83], v[76:79], v[152:155]
s_waitcnt lgkmcnt(0)
s_barrier
v_mfma_f32_16x16x32_bf16 v[128:131], v[112:115], v[96:99], v[128:131]
ds_read_b128 v[32:35], v18 offset:16384
v_mfma_f32_16x16x32_bf16 v[132:135], v[116:119], v[96:99], v[132:135]
ds_read_b64_tr_b16 v[48:49], v25 offset:16384
v_mfma_f32_16x16x32_bf16 v[160:163], v[120:123], v[96:99], v[160:163]
ds_read_b64_tr_b16 v[50:51], v25 offset:20480
v_mfma_f32_16x16x32_bf16 v[164:167], v[124:127], v[96:99], v[164:167]
ds_read_b64_tr_b16 v[52:53], v26 offset:16384
v_mfma_f32_16x16x32_bf16 v[172:175], v[124:127], v[100:103], v[172:175]
ds_read_b64_tr_b16 v[54:55], v26 offset:20480
v_mfma_f32_16x16x32_bf16 v[168:171], v[120:123], v[100:103], v[168:171]
ds_read_b64_tr_b16 v[56:57], v27 offset:16384
v_mfma_f32_16x16x32_bf16 v[140:143], v[116:119], v[100:103], v[140:143]
ds_read_b64_tr_b16 v[58:59], v27 offset:20480
v_mfma_f32_16x16x32_bf16 v[136:139], v[112:115], v[100:103], v[136:139]
ds_read_b64_tr_b16 v[60:61], v28 offset:16384
s_branch Lov_11
.p2align 12
.fill 80, 4, 0xbf800000
Lst_11_0:
s_branch Lwr_156
Lst_11_1:
s_branch Lst_15_0
s_nop 0
Lov_11:
v_mfma_f32_16x16x32_bf16 v[144:147], v[112:115], v[104:107], v[144:147]
ds_read_b64_tr_b16 v[62:63], v28 offset:20480
v_mfma_f32_16x16x32_bf16 v[148:151], v[116:119], v[104:107], v[148:151]
ds_read_b128 v[36:39], v18 offset:17408
v_mfma_f32_16x16x32_bf16 v[176:179], v[120:123], v[104:107], v[176:179]
ds_read_b128 v[40:43], v18 offset:18432
v_mfma_f32_16x16x32_bf16 v[180:183], v[124:127], v[104:107], v[180:183]
ds_read_b128 v[44:47], v18 offset:19456
v_mfma_f32_16x16x32_bf16 v[188:191], v[124:127], v[108:111], v[188:191]
ds_read_b128 v[64:67], v18 offset:24576
v_mfma_f32_16x16x32_bf16 v[184:187], v[120:123], v[108:111], v[184:187]
ds_read_b64_tr_b16 v[80:81], v25 offset:24576
v_mfma_f32_16x16x32_bf16 v[156:159], v[116:119], v[108:111], v[156:159]
ds_read_b64_tr_b16 v[82:83], v25 offset:28672
v_mfma_f32_16x16x32_bf16 v[152:155], v[112:115], v[108:111], v[152:155]
ds_read_b64_tr_b16 v[84:85], v26 offset:24576
v_mfma_f32_16x16x32_bf16 v[128:131], v[208:211], v[192:195], v[128:131]
ds_read_b64_tr_b16 v[86:87], v26 offset:28672
v_mfma_f32_16x16x32_bf16 v[132:135], v[212:215], v[192:195], v[132:135]
ds_read_b64_tr_b16 v[88:89], v27 offset:24576
v_mfma_f32_16x16x32_bf16 v[160:163], v[216:219], v[192:195], v[160:163]
ds_read_b64_tr_b16 v[90:91], v27 offset:28672
v_mfma_f32_16x16x32_bf16 v[164:167], v[220:223], v[192:195], v[164:167]
ds_read_b64_tr_b16 v[92:93], v28 offset:24576
v_mfma_f32_16x16x32_bf16 v[172:175], v[220:223], v[196:199], v[172:175]
ds_read_b64_tr_b16 v[94:95], v28 offset:28672
v_mfma_f32_16x16x32_bf16 v[168:171], v[216:219], v[196:199], v[168:171]
ds_read_b128 v[68:71], v18 offset:25600
v_mfma_f32_16x16x32_bf16 v[140:143], v[212:215], v[196:199], v[140:143]
ds_read_b128 v[72:75], v18 offset:26624
v_mfma_f32_16x16x32_bf16 v[136:139], v[208:211], v[196:199], v[136:139]
ds_read_b128 v[76:79], v18 offset:27648
v_mfma_f32_16x16x32_bf16 v[144:147], v[208:211], v[200:203], v[144:147]
v_mfma_f32_16x16x32_bf16 v[148:151], v[212:215], v[200:203], v[148:151]
v_mfma_f32_16x16x32_bf16 v[176:179], v[216:219], v[200:203], v[176:179]
v_mfma_f32_16x16x32_bf16 v[180:183], v[220:223], v[200:203], v[180:183]
v_mfma_f32_16x16x32_bf16 v[188:191], v[220:223], v[204:207], v[188:191]
v_mfma_f32_16x16x32_bf16 v[184:187], v[216:219], v[204:207], v[184:187]
v_mfma_f32_16x16x32_bf16 v[156:159], v[212:215], v[204:207], v[156:159]
v_mfma_f32_16x16x32_bf16 v[152:155], v[208:211], v[204:207], v[152:155]
s_waitcnt lgkmcnt(0)
s_barrier
v_mfma_f32_16x16x32_bf16 v[128:131], v[48:51], v[32:35], v[128:131]
ds_read_b128 v[96:99], v18 offset:32768
v_mfma_f32_16x16x32_bf16 v[132:135], v[52:55], v[32:35], v[132:135]
ds_read_b64_tr_b16 v[112:113], v13 offset:49152
v_mfma_f32_16x16x32_bf16 v[160:163], v[56:59], v[32:35], v[160:163]
ds_read_b64_tr_b16 v[114:115], v13 offset:53248
v_mfma_f32_16x16x32_bf16 v[164:167], v[60:63], v[32:35], v[164:167]
ds_read_b64_tr_b16 v[116:117], v14 offset:49152
v_mfma_f32_16x16x32_bf16 v[172:175], v[60:63], v[36:39], v[172:175]
ds_read_b64_tr_b16 v[118:119], v14 offset:53248
v_mfma_f32_16x16x32_bf16 v[168:171], v[56:59], v[36:39], v[168:171]
ds_read_b64_tr_b16 v[120:121], v15 offset:49152
v_mfma_f32_16x16x32_bf16 v[140:143], v[52:55], v[36:39], v[140:143]
ds_read_b64_tr_b16 v[122:123], v15 offset:53248
v_mfma_f32_16x16x32_bf16 v[136:139], v[48:51], v[36:39], v[136:139]
ds_read_b64_tr_b16 v[124:125], v16 offset:49152
v_mfma_f32_16x16x32_bf16 v[144:147], v[48:51], v[40:43], v[144:147]
ds_read_b64_tr_b16 v[126:127], v16 offset:53248
v_mfma_f32_16x16x32_bf16 v[148:151], v[52:55], v[40:43], v[148:151]
ds_read_b128 v[100:103], v18 offset:33792
v_mfma_f32_16x16x32_bf16 v[176:179], v[56:59], v[40:43], v[176:179]
ds_read_b128 v[104:107], v18 offset:34816
v_mfma_f32_16x16x32_bf16 v[180:183], v[60:63], v[40:43], v[180:183]
ds_read_b128 v[108:111], v18 offset:35840
v_mfma_f32_16x16x32_bf16 v[188:191], v[60:63], v[44:47], v[188:191]
ds_read_b128 v[192:195], v18 offset:40960
v_mfma_f32_16x16x32_bf16 v[184:187], v[56:59], v[44:47], v[184:187]
ds_read_b64_tr_b16 v[208:209], v13 offset:57344
v_mfma_f32_16x16x32_bf16 v[156:159], v[52:55], v[44:47], v[156:159]
ds_read_b64_tr_b16 v[210:211], v13 offset:61440
v_mfma_f32_16x16x32_bf16 v[152:155], v[48:51], v[44:47], v[152:155]
ds_read_b64_tr_b16 v[212:213], v14 offset:57344
v_mfma_f32_16x16x32_bf16 v[128:131], v[80:83], v[64:67], v[128:131]
ds_read_b64_tr_b16 v[214:215], v14 offset:61440
v_mfma_f32_16x16x32_bf16 v[132:135], v[84:87], v[64:67], v[132:135]
ds_read_b64_tr_b16 v[216:217], v15 offset:57344
v_mfma_f32_16x16x32_bf16 v[160:163], v[88:91], v[64:67], v[160:163]
ds_read_b64_tr_b16 v[218:219], v15 offset:61440
v_mfma_f32_16x16x32_bf16 v[164:167], v[92:95], v[64:67], v[164:167]
ds_read_b64_tr_b16 v[220:221], v16 offset:57344
v_mfma_f32_16x16x32_bf16 v[172:175], v[92:95], v[68:71], v[172:175]
ds_read_b64_tr_b16 v[222:223], v16 offset:61440
v_mfma_f32_16x16x32_bf16 v[168:171], v[88:91], v[68:71], v[168:171]
ds_read_b128 v[196:199], v18 offset:41984
v_mfma_f32_16x16x32_bf16 v[140:143], v[84:87], v[68:71], v[140:143]
ds_read_b128 v[200:203], v18 offset:43008
v_mfma_f32_16x16x32_bf16 v[136:139], v[80:83], v[68:71], v[136:139]
ds_read_b128 v[204:207], v18 offset:44032
v_mfma_f32_16x16x32_bf16 v[144:147], v[80:83], v[72:75], v[144:147]
v_mfma_f32_16x16x32_bf16 v[148:151], v[84:87], v[72:75], v[148:151]
v_mfma_f32_16x16x32_bf16 v[176:179], v[88:91], v[72:75], v[176:179]
v_mfma_f32_16x16x32_bf16 v[180:183], v[92:95], v[72:75], v[180:183]
v_mfma_f32_16x16x32_bf16 v[188:191], v[92:95], v[76:79], v[188:191]
v_mfma_f32_16x16x32_bf16 v[184:187], v[88:91], v[76:79], v[184:187]
v_mfma_f32_16x16x32_bf16 v[156:159], v[84:87], v[76:79], v[156:159]
v_mfma_f32_16x16x32_bf16 v[152:155], v[80:83], v[76:79], v[152:155]
s_waitcnt lgkmcnt(0)
s_barrier
v_mfma_f32_16x16x32_bf16 v[128:131], v[112:115], v[96:99], v[128:131]
ds_read_b128 v[32:35], v19 offset:0
v_mfma_f32_16x16x32_bf16 v[132:135], v[116:119], v[96:99], v[132:135]
ds_read_b64_tr_b16 v[48:49], v9 offset:0
v_mfma_f32_16x16x32_bf16 v[160:163], v[120:123], v[96:99], v[160:163]
ds_read_b64_tr_b16 v[50:51], v9 offset:4096
v_mfma_f32_16x16x32_bf16 v[164:167], v[124:127], v[96:99], v[164:167]
ds_read_b64_tr_b16 v[52:53], v10 offset:0
v_mfma_f32_16x16x32_bf16 v[172:175], v[124:127], v[100:103], v[172:175]
ds_read_b64_tr_b16 v[54:55], v10 offset:4096
v_mfma_f32_16x16x32_bf16 v[168:171], v[120:123], v[100:103], v[168:171]
ds_read_b64_tr_b16 v[56:57], v11 offset:0
v_mfma_f32_16x16x32_bf16 v[140:143], v[116:119], v[100:103], v[140:143]
ds_read_b64_tr_b16 v[58:59], v11 offset:4096
v_mfma_f32_16x16x32_bf16 v[136:139], v[112:115], v[100:103], v[136:139]
ds_read_b64_tr_b16 v[60:61], v12 offset:0
v_mfma_f32_16x16x32_bf16 v[144:147], v[112:115], v[104:107], v[144:147]
ds_read_b64_tr_b16 v[62:63], v12 offset:4096
v_mfma_f32_16x16x32_bf16 v[148:151], v[116:119], v[104:107], v[148:151]
ds_read_b128 v[36:39], v19 offset:1024
v_mfma_f32_16x16x32_bf16 v[176:179], v[120:123], v[104:107], v[176:179]
ds_read_b128 v[40:43], v19 offset:2048
v_mfma_f32_16x16x32_bf16 v[180:183], v[124:127], v[104:107], v[180:183]
ds_read_b128 v[44:47], v19 offset:3072
v_mfma_f32_16x16x32_bf16 v[188:191], v[124:127], v[108:111], v[188:191]
ds_read_b128 v[64:67], v19 offset:8192
v_mfma_f32_16x16x32_bf16 v[184:187], v[120:123], v[108:111], v[184:187]
ds_read_b64_tr_b16 v[80:81], v9 offset:8192
v_mfma_f32_16x16x32_bf16 v[156:159], v[116:119], v[108:111], v[156:159]
ds_read_b64_tr_b16 v[82:83], v9 offset:12288
v_mfma_f32_16x16x32_bf16 v[152:155], v[112:115], v[108:111], v[152:155]
ds_read_b64_tr_b16 v[84:85], v10 offset:8192
v_mfma_f32_16x16x32_bf16 v[128:131], v[208:211], v[192:195], v[128:131]
ds_read_b64_tr_b16 v[86:87], v10 offset:12288
v_mfma_f32_16x16x32_bf16 v[132:135], v[212:215], v[192:195], v[132:135]
ds_read_b64_tr_b16 v[88:89], v11 offset:8192
v_mfma_f32_16x16x32_bf16 v[160:163], v[216:219], v[192:195], v[160:163]
ds_read_b64_tr_b16 v[90:91], v11 offset:12288
v_mfma_f32_16x16x32_bf16 v[164:167], v[220:223], v[192:195], v[164:167]
ds_read_b64_tr_b16 v[92:93], v12 offset:8192
v_mfma_f32_16x16x32_bf16 v[172:175], v[220:223], v[196:199], v[172:175]
ds_read_b64_tr_b16 v[94:95], v12 offset:12288
v_mfma_f32_16x16x32_bf16 v[168:171], v[216:219], v[196:199], v[168:171]
ds_read_b128 v[68:71], v19 offset:9216
v_mfma_f32_16x16x32_bf16 v[140:143], v[212:215], v[196:199], v[140:143]
ds_read_b128 v[72:75], v19 offset:10240
v_mfma_f32_16x16x32_bf16 v[136:139], v[208:211], v[196:199], v[136:139]
ds_read_b128 v[76:79], v19 offset:11264
v_mfma_f32_16x16x32_bf16 v[144:147], v[208:211], v[200:203], v[144:147]
v_mfma_f32_16x16x32_bf16 v[148:151], v[212:215], v[200:203], v[148:151]
v_mfma_f32_16x16x32_bf16 v[176:179], v[216:219], v[200:203], v[176:179]
v_mfma_f32_16x16x32_bf16 v[180:183], v[220:223], v[200:203], v[180:183]
v_mfma_f32_16x16x32_bf16 v[188:191], v[220:223], v[204:207], v[188:191]
v_mfma_f32_16x16x32_bf16 v[184:187], v[216:219], v[204:207], v[184:187]
v_mfma_f32_16x16x32_bf16 v[156:159], v[212:215], v[204:207], v[156:159]
v_mfma_f32_16x16x32_bf16 v[152:155], v[208:211], v[204:207], v[152:155]
s_waitcnt lgkmcnt(0)
s_barrier
v_mfma_f32_16x16x32_bf16 v[128:131], v[48:51], v[32:35], v[128:131]
ds_read_b128 v[96:99], v17 offset:16384
v_mfma_f32_16x16x32_bf16 v[132:135], v[52:55], v[32:35], v[132:135]
ds_read_b64_tr_b16 v[112:113], v9 offset:32768
v_mfma_f32_16x16x32_bf16 v[160:163], v[56:59], v[32:35], v[160:163]
ds_read_b64_tr_b16 v[114:115], v9 offset:36864
v_mfma_f32_16x16x32_bf16 v[164:167], v[60:63], v[32:35], v[164:167]
ds_read_b64_tr_b16 v[116:117], v10 offset:32768
v_mfma_f32_16x16x32_bf16 v[172:175], v[60:63], v[36:39], v[172:175]
ds_read_b64_tr_b16 v[118:119], v10 offset:36864
v_mfma_f32_16x16x32_bf16 v[168:171], v[56:59], v[36:39], v[168:171]
ds_read_b64_tr_b16 v[120:121], v11 offset:32768
v_mfma_f32_16x16x32_bf16 v[140:143], v[52:55], v[36:39], v[140:143]
ds_read_b64_tr_b16 v[122:123], v11 offset:36864
v_mfma_f32_16x16x32_bf16 v[136:139], v[48:51], v[36:39], v[136:139]
ds_read_b64_tr_b16 v[124:125], v12 offset:32768
v_mfma_f32_16x16x32_bf16 v[144:147], v[48:51], v[40:43], v[144:147]
ds_read_b64_tr_b16 v[126:127], v12 offset:36864
v_mfma_f32_16x16x32_bf16 v[148:151], v[52:55], v[40:43], v[148:151]
ds_read_b128 v[100:103], v17 offset:17408
v_mfma_f32_16x16x32_bf16 v[176:179], v[56:59], v[40:43], v[176:179]
ds_read_b128 v[104:107], v17 offset:18432
v_mfma_f32_16x16x32_bf16 v[180:183], v[60:63], v[40:43], v[180:183]
ds_read_b128 v[108:111], v17 offset:19456
v_mfma_f32_16x16x32_bf16 v[188:191], v[60:63], v[44:47], v[188:191]
ds_read_b128 v[192:195], v17 offset:24576
v_mfma_f32_16x16x32_bf16 v[184:187], v[56:59], v[44:47], v[184:187]
ds_read_b64_tr_b16 v[208:209], v9 offset:40960
v_mfma_f32_16x16x32_bf16 v[156:159], v[52:55], v[44:47], v[156:159]
ds_read_b64_tr_b16 v[210:211], v9 offset:45056
v_mfma_f32_16x16x32_bf16 v[152:155], v[48:51], v[44:47], v[152:155]
ds_read_b64_tr_b16 v[212:213], v10 offset:40960
v_mfma_f32_16x16x32_bf16 v[128:131], v[80:83], v[64:67], v[128:131]
ds_read_b64_tr_b16 v[214:215], v10 offset:45056
v_mfma_f32_16x16x32_bf16 v[132:135], v[84:87], v[64:67], v[132:135]
ds_read_b64_tr_b16 v[216:217], v11 offset:40960
v_mfma_f32_16x16x32_bf16 v[160:163], v[88:91], v[64:67], v[160:163]
ds_read_b64_tr_b16 v[218:219], v11 offset:45056
v_mfma_f32_16x16x32_bf16 v[164:167], v[92:95], v[64:67], v[164:167]
ds_read_b64_tr_b16 v[220:221], v12 offset:40960
v_mfma_f32_16x16x32_bf16 v[172:175], v[92:95], v[68:71], v[172:175]
ds_read_b64_tr_b16 v[222:223], v12 offset:45056
v_mfma_f32_16x16x32_bf16 v[168:171], v[88:91], v[68:71], v[168:171]
ds_read_b128 v[196:199], v17 offset:25600
v_mfma_f32_16x16x32_bf16 v[140:143], v[84:87], v[68:71], v[140:143]
ds_read_b128 v[200:203], v17 offset:26624
v_mfma_f32_16x16x32_bf16 v[136:139], v[80:83], v[68:71], v[136:139]
ds_read_b128 v[204:207], v17 offset:27648
v_mfma_f32_16x16x32_bf16 v[144:147], v[80:83], v[72:75], v[144:147]
v_mfma_f32_16x16x32_bf16 v[148:151], v[84:87], v[72:75], v[148:151]
v_mfma_f32_16x16x32_bf16 v[176:179], v[88:91], v[72:75], v[176:179]
v_mfma_f32_16x16x32_bf16 v[180:183], v[92:95], v[72:75], v[180:183]
v_mfma_f32_16x16x32_bf16 v[188:191], v[92:95], v[76:79], v[188:191]
v_mfma_f32_16x16x32_bf16 v[184:187], v[88:91], v[76:79], v[184:187]
v_mfma_f32_16x16x32_bf16 v[156:159], v[84:87], v[76:79], v[156:159]
v_mfma_f32_16x16x32_bf16 v[152:155], v[80:83], v[76:79], v[152:155]
s_waitcnt lgkmcnt(0)
s_barrier
v_mfma_f32_16x16x32_bf16 v[128:131], v[112:115], v[96:99], v[128:131]
ds_read_b128 v[32:35], v17 offset:49152
v_mfma_f32_16x16x32_bf16 v[132:135], v[116:119], v[96:99], v[132:135]
ds_read_b64_tr_b16 v[48:49], v13 offset:0
v_mfma_f32_16x16x32_bf16 v[160:163], v[120:123], v[96:99], v[160:163]
ds_read_b64_tr_b16 v[50:51], v13 offset:4096
v_mfma_f32_16x16x32_bf16 v[164:167], v[124:127], v[96:99], v[164:167]
ds_read_b64_tr_b16 v[52:53], v14 offset:0
v_mfma_f32_16x16x32_bf16 v[172:175], v[124:127], v[100:103], v[172:175]
ds_read_b64_tr_b16 v[54:55], v14 offset:4096
v_mfma_f32_16x16x32_bf16 v[168:171], v[120:123], v[100:103], v[168:171]
ds_read_b64_tr_b16 v[56:57], v15 offset:0
v_mfma_f32_16x16x32_bf16 v[140:143], v[116:119], v[100:103], v[140:143]
ds_read_b64_tr_b16 v[58:59], v15 offset:4096
v_mfma_f32_16x16x32_bf16 v[136:139], v[112:115], v[100:103], v[136:139]
ds_read_b64_tr_b16 v[60:61], v16 offset:0
v_mfma_f32_16x16x32_bf16 v[144:147], v[112:115], v[104:107], v[144:147]
ds_read_b64_tr_b16 v[62:63], v16 offset:4096
v_mfma_f32_16x16x32_bf16 v[148:151], v[116:119], v[104:107], v[148:151]
ds_read_b128 v[36:39], v17 offset:50176
v_mfma_f32_16x16x32_bf16 v[176:179], v[120:123], v[104:107], v[176:179]
ds_read_b128 v[40:43], v17 offset:51200
v_mfma_f32_16x16x32_bf16 v[180:183], v[124:127], v[104:107], v[180:183]
ds_read_b128 v[44:47], v17 offset:52224
v_mfma_f32_16x16x32_bf16 v[188:191], v[124:127], v[108:111], v[188:191]
ds_read_b128 v[64:67], v17 offset:57344
v_mfma_f32_16x16x32_bf16 v[184:187], v[120:123], v[108:111], v[184:187]
ds_read_b64_tr_b16 v[80:81], v13 offset:8192
v_mfma_f32_16x16x32_bf16 v[156:159], v[116:119], v[108:111], v[156:159]
ds_read_b64_tr_b16 v[82:83], v13 offset:12288
v_mfma_f32_16x16x32_bf16 v[152:155], v[112:115], v[108:111], v[152:155]
ds_read_b64_tr_b16 v[84:85], v14 offset:8192
v_mfma_f32_16x16x32_bf16 v[128:131], v[208:211], v[192:195], v[128:131]
ds_read_b64_tr_b16 v[86:87], v14 offset:12288
v_mfma_f32_16x16x32_bf16 v[132:135], v[212:215], v[192:195], v[132:135]
ds_read_b64_tr_b16 v[88:89], v15 offset:8192
v_mfma_f32_16x16x32_bf16 v[160:163], v[216:219], v[192:195], v[160:163]
ds_read_b64_tr_b16 v[90:91], v15 offset:12288
v_mfma_f32_16x16x32_bf16 v[164:167], v[220:223], v[192:195], v[164:167]
ds_read_b64_tr_b16 v[92:93], v16 offset:8192
v_mfma_f32_16x16x32_bf16 v[172:175], v[220:223], v[196:199], v[172:175]
ds_read_b64_tr_b16 v[94:95], v16 offset:12288
v_mfma_f32_16x16x32_bf16 v[168:171], v[216:219], v[196:199], v[168:171]
ds_read_b128 v[68:71], v17 offset:58368
v_mfma_f32_16x16x32_bf16 v[140:143], v[212:215], v[196:199], v[140:143]
ds_read_b128 v[72:75], v17 offset:59392
v_mfma_f32_16x16x32_bf16 v[136:139], v[208:211], v[196:199], v[136:139]
ds_read_b128 v[76:79], v17 offset:60416
v_mfma_f32_16x16x32_bf16 v[144:147], v[208:211], v[200:203], v[144:147]
v_mfma_f32_16x16x32_bf16 v[148:151], v[212:215], v[200:203], v[148:151]
v_mfma_f32_16x16x32_bf16 v[176:179], v[216:219], v[200:203], v[176:179]
v_mfma_f32_16x16x32_bf16 v[180:183], v[220:223], v[200:203], v[180:183]
v_mfma_f32_16x16x32_bf16 v[188:191], v[220:223], v[204:207], v[188:191]
v_mfma_f32_16x16x32_bf16 v[184:187], v[216:219], v[204:207], v[184:187]
v_mfma_f32_16x16x32_bf16 v[156:159], v[212:215], v[204:207], v[156:159]
v_mfma_f32_16x16x32_bf16 v[152:155], v[208:211], v[204:207], v[152:155]
s_waitcnt lgkmcnt(0)
s_barrier
v_mfma_f32_16x16x32_bf16 v[128:131], v[48:51], v[32:35], v[128:131]
ds_read_b128 v[96:99], v18 offset:16384
v_mfma_f32_16x16x32_bf16 v[132:135], v[52:55], v[32:35], v[132:135]
ds_read_b64_tr_b16 v[112:113], v25 offset:16384
v_mfma_f32_16x16x32_bf16 v[160:163], v[56:59], v[32:35], v[160:163]
ds_read_b64_tr_b16 v[114:115], v25 offset:20480
v_mfma_f32_16x16x32_bf16 v[164:167], v[60:63], v[32:35], v[164:167]
ds_read_b64_tr_b16 v[116:117], v26 offset:16384
v_mfma_f32_16x16x32_bf16 v[172:175], v[60:63], v[36:39], v[172:175]
ds_read_b64_tr_b16 v[118:119], v26 offset:20480
v_mfma_f32_16x16x32_bf16 v[168:171], v[56:59], v[36:39], v[168:171]
ds_read_b64_tr_b16 v[120:121], v27 offset:16384
v_mfma_f32_16x16x32_bf16 v[140:143], v[52:55], v[36:39], v[140:143]
ds_read_b64_tr_b16 v[122:123], v27 offset:20480
v_mfma_f32_16x16x32_bf16 v[136:139], v[48:51], v[36:39], v[136:139]
ds_read_b64_tr_b16 v[124:125], v28 offset:16384
v_mfma_f32_16x16x32_bf16 v[144:147], v[48:51], v[40:43], v[144:147]
ds_read_b64_tr_b16 v[126:127], v28 offset:20480
v_mfma_f32_16x16x32_bf16 v[148:151], v[52:55], v[40:43], v[148:151]
ds_read_b128 v[100:103], v18 offset:17408
v_mfma_f32_16x16x32_bf16 v[176:179], v[56:59], v[40:43], v[176:179]
ds_read_b128 v[104:107], v18 offset:18432
v_mfma_f32_16x16x32_bf16 v[180:183], v[60:63], v[40:43], v[180:183]
ds_read_b128 v[108:111], v18 offset:19456
v_mfma_f32_16x16x32_bf16 v[188:191], v[60:63], v[44:47], v[188:191]
ds_read_b128 v[192:195], v18 offset:24576
v_mfma_f32_16x16x32_bf16 v[184:187], v[56:59], v[44:47], v[184:187]
ds_read_b64_tr_b16 v[208:209], v25 offset:24576
v_mfma_f32_16x16x32_bf16 v[156:159], v[52:55], v[44:47], v[156:159]
ds_read_b64_tr_b16 v[210:211], v25 offset:28672
v_mfma_f32_16x16x32_bf16 v[152:155], v[48:51], v[44:47], v[152:155]
ds_read_b64_tr_b16 v[212:213], v26 offset:24576
v_mfma_f32_16x16x32_bf16 v[128:131], v[80:83], v[64:67], v[128:131]
ds_read_b64_tr_b16 v[214:215], v26 offset:28672
v_mfma_f32_16x16x32_bf16 v[132:135], v[84:87], v[64:67], v[132:135]
ds_read_b64_tr_b16 v[216:217], v27 offset:24576
v_mfma_f32_16x16x32_bf16 v[160:163], v[88:91], v[64:67], v[160:163]
ds_read_b64_tr_b16 v[218:219], v27 offset:28672
v_mfma_f32_16x16x32_bf16 v[164:167], v[92:95], v[64:67], v[164:167]
ds_read_b64_tr_b16 v[220:221], v28 offset:24576
v_mfma_f32_16x16x32_bf16 v[172:175], v[92:95], v[68:71], v[172:175]
ds_read_b64_tr_b16 v[222:223], v28 offset:28672
v_mfma_f32_16x16x32_bf16 v[168:171], v[88:91], v[68:71], v[168:171]
ds_read_b128 v[196:199], v18 offset:25600
v_mfma_f32_16x16x32_bf16 v[140:143], v[84:87], v[68:71], v[140:143]
ds_read_b128 v[200:203], v18 offset:26624
v_mfma_f32_16x16x32_bf16 v[136:139], v[80:83], v[68:71], v[136:139]
ds_read_b128 v[204:207], v18 offset:27648
v_mfma_f32_16x16x32_bf16 v[144:147], v[80:83], v[72:75], v[144:147]
v_mfma_f32_16x16x32_bf16 v[148:151], v[84:87], v[72:75], v[148:151]
v_mfma_f32_16x16x32_bf16 v[176:179], v[88:91], v[72:75], v[176:179]
v_mfma_f32_16x16x32_bf16 v[180:183], v[92:95], v[72:75], v[180:183]
v_mfma_f32_16x16x32_bf16 v[188:191], v[92:95], v[76:79], v[188:191]
v_mfma_f32_16x16x32_bf16 v[184:187], v[88:91], v[76:79], v[184:187]
v_mfma_f32_16x16x32_bf16 v[156:159], v[84:87], v[76:79], v[156:159]
v_mfma_f32_16x16x32_bf16 v[152:155], v[80:83], v[76:79], v[152:155]
s_waitcnt lgkmcnt(0)
s_barrier
v_mfma_f32_16x16x32_bf16 v[128:131], v[112:115], v[96:99], v[128:131]
ds_read_b128 v[32:35], v18 offset:32768
v_mfma_f32_16x16x32_bf16 v[132:135], v[116:119], v[96:99], v[132:135]
ds_read_b64_tr_b16 v[48:49], v13 offset:49152
v_mfma_f32_16x16x32_bf16 v[160:163], v[120:123], v[96:99], v[160:163]
ds_read_b64_tr_b16 v[50:51], v13 offset:53248
v_mfma_f32_16x16x32_bf16 v[164:167], v[124:127], v[96:99], v[164:167]
ds_read_b64_tr_b16 v[52:53], v14 offset:49152
v_mfma_f32_16x16x32_bf16 v[172:175], v[124:127], v[100:103], v[172:175]
ds_read_b64_tr_b16 v[54:55], v14 offset:53248
v_mfma_f32_16x16x32_bf16 v[168:171], v[120:123], v[100:103], v[168:171]
ds_read_b64_tr_b16 v[56:57], v15 offset:49152
v_mfma_f32_16x16x32_bf16 v[140:143], v[116:119], v[100:103], v[140:143]
ds_read_b64_tr_b16 v[58:59], v15 offset:53248
v_mfma_f32_16x16x32_bf16 v[136:139], v[112:115], v[100:103], v[136:139]
ds_read_b64_tr_b16 v[60:61], v16 offset:49152
v_mfma_f32_16x16x32_bf16 v[144:147], v[112:115], v[104:107], v[144:147]
ds_read_b64_tr_b16 v[62:63], v16 offset:53248
v_mfma_f32_16x16x32_bf16 v[148:151], v[116:119], v[104:107], v[148:151]
ds_read_b128 v[36:39], v18 offset:33792
v_mfma_f32_16x16x32_bf16 v[176:179], v[120:123], v[104:107], v[176:179]
ds_read_b128 v[40:43], v18 offset:34816
v_mfma_f32_16x16x32_bf16 v[180:183], v[124:127], v[104:107], v[180:183]
ds_read_b128 v[44:47], v18 offset:35840
v_mfma_f32_16x16x32_bf16 v[188:191], v[124:127], v[108:111], v[188:191]
ds_read_b128 v[64:67], v18 offset:40960
v_mfma_f32_16x16x32_bf16 v[184:187], v[120:123], v[108:111], v[184:187]
ds_read_b64_tr_b16 v[80:81], v13 offset:57344
v_mfma_f32_16x16x32_bf16 v[156:159], v[116:119], v[108:111], v[156:159]
ds_read_b64_tr_b16 v[82:83], v13 offset:61440
v_mfma_f32_16x16x32_bf16 v[152:155], v[112:115], v[108:111], v[152:155]
ds_read_b64_tr_b16 v[84:85], v14 offset:57344
v_mfma_f32_16x16x32_bf16 v[128:131], v[208:211], v[192:195], v[128:131]
ds_read_b64_tr_b16 v[86:87], v14 offset:61440
v_mfma_f32_16x16x32_bf16 v[132:135], v[212:215], v[192:195], v[132:135]
ds_read_b64_tr_b16 v[88:89], v15 offset:57344
v_mfma_f32_16x16x32_bf16 v[160:163], v[216:219], v[192:195], v[160:163]
ds_read_b64_tr_b16 v[90:91], v15 offset:61440
v_mfma_f32_16x16x32_bf16 v[164:167], v[220:223], v[192:195], v[164:167]
ds_read_b64_tr_b16 v[92:93], v16 offset:57344
v_mfma_f32_16x16x32_bf16 v[172:175], v[220:223], v[196:199], v[172:175]
ds_read_b64_tr_b16 v[94:95], v16 offset:61440
v_mfma_f32_16x16x32_bf16 v[168:171], v[216:219], v[196:199], v[168:171]
ds_read_b128 v[68:71], v18 offset:41984
v_mfma_f32_16x16x32_bf16 v[140:143], v[212:215], v[196:199], v[140:143]
ds_read_b128 v[72:75], v18 offset:43008
v_mfma_f32_16x16x32_bf16 v[136:139], v[208:211], v[196:199], v[136:139]
ds_read_b128 v[76:79], v18 offset:44032
v_mfma_f32_16x16x32_bf16 v[144:147], v[208:211], v[200:203], v[144:147]
v_mfma_f32_16x16x32_bf16 v[148:151], v[212:215], v[200:203], v[148:151]
v_mfma_f32_16x16x32_bf16 v[176:179], v[216:219], v[200:203], v[176:179]
v_mfma_f32_16x16x32_bf16 v[180:183], v[220:223], v[200:203], v[180:183]
v_mfma_f32_16x16x32_bf16 v[188:191], v[220:223], v[204:207], v[188:191]
v_mfma_f32_16x16x32_bf16 v[184:187], v[216:219], v[204:207], v[184:187]
v_mfma_f32_16x16x32_bf16 v[156:159], v[212:215], v[204:207], v[156:159]
v_mfma_f32_16x16x32_bf16 v[152:155], v[208:211], v[204:207], v[152:155]
s_waitcnt lgkmcnt(0)
s_barrier
v_mfma_f32_16x16x32_bf16 v[128:131], v[48:51], v[32:35], v[128:131]
ds_read_b128 v[96:99], v19 offset:0
v_mfma_f32_16x16x32_bf16 v[132:135], v[52:55], v[32:35], v[132:135]
ds_read_b64_tr_b16 v[112:113], v9 offset:0
v_mfma_f32_16x16x32_bf16 v[160:163], v[56:59], v[32:35], v[160:163]
ds_read_b64_tr_b16 v[114:115], v9 offset:4096
v_mfma_f32_16x16x32_bf16 v[164:167], v[60:63], v[32:35], v[164:167]
ds_read_b64_tr_b16 v[116:117], v10 offset:0
v_mfma_f32_16x16x32_bf16 v[172:175], v[60:63], v[36:39], v[172:175]
ds_read_b64_tr_b16 v[118:119], v10 offset:4096
v_mfma_f32_16x16x32_bf16 v[168:171], v[56:59], v[36:39], v[168:171]
ds_read_b64_tr_b16 v[120:121], v11 offset:0
v_mfma_f32_16x16x32_bf16 v[140:143], v[52:55], v[36:39], v[140:143]
ds_read_b64_tr_b16 v[122:123], v11 offset:4096
v_mfma_f32_16x16x32_bf16 v[136:139], v[48:51], v[36:39], v[136:139]
ds_read_b64_tr_b16 v[124:125], v12 offset:0
v_mfma_f32_16x16x32_bf16 v[144:147], v[48:51], v[40:43], v[144:147]
ds_read_b64_tr_b16 v[126:127], v12 offset:4096
v_mfma_f32_16x16x32_bf16 v[148:151], v[52:55], v[40:43], v[148:151]
ds_read_b128 v[100:103], v19 offset:1024
v_mfma_f32_16x16x32_bf16 v[176:179], v[56:59], v[40:43], v[176:179]
ds_read_b128 v[104:107], v19 offset:2048
v_mfma_f32_16x16x32_bf16 v[180:183], v[60:63], v[40:43], v[180:183]
ds_read_b128 v[108:111], v19 offset:3072
v_mfma_f32_16x16x32_bf16 v[188:191], v[60:63], v[44:47], v[188:191]
ds_read_b128 v[192:195], v19 offset:8192
v_mfma_f32_16x16x32_bf16 v[184:187], v[56:59], v[44:47], v[184:187]
ds_read_b64_tr_b16 v[208:209], v9 offset:8192
v_mfma_f32_16x16x32_bf16 v[156:159], v[52:55], v[44:47], v[156:159]
ds_read_b64_tr_b16 v[210:211], v9 offset:12288
v_mfma_f32_16x16x32_bf16 v[152:155], v[48:51], v[44:47], v[152:155]
ds_read_b64_tr_b16 v[212:213], v10 offset:8192
v_mfma_f32_16x16x32_bf16 v[128:131], v[80:83], v[64:67], v[128:131]
ds_read_b64_tr_b16 v[214:215], v10 offset:12288
v_mfma_f32_16x16x32_bf16 v[132:135], v[84:87], v[64:67], v[132:135]
ds_read_b64_tr_b16 v[216:217], v11 offset:8192
v_mfma_f32_16x16x32_bf16 v[160:163], v[88:91], v[64:67], v[160:163]
ds_read_b64_tr_b16 v[218:219], v11 offset:12288
v_mfma_f32_16x16x32_bf16 v[164:167], v[92:95], v[64:67], v[164:167]
ds_read_b64_tr_b16 v[220:221], v12 offset:8192
v_mfma_f32_16x16x32_bf16 v[172:175], v[92:95], v[68:71], v[172:175]
ds_read_b64_tr_b16 v[222:223], v12 offset:12288
v_mfma_f32_16x16x32_bf16 v[168:171], v[88:91], v[68:71], v[168:171]
ds_read_b128 v[196:199], v19 offset:9216
v_mfma_f32_16x16x32_bf16 v[140:143], v[84:87], v[68:71], v[140:143]
ds_read_b128 v[200:203], v19 offset:10240
v_mfma_f32_16x16x32_bf16 v[136:139], v[80:83], v[68:71], v[136:139]
ds_read_b128 v[204:207], v19 offset:11264
v_mfma_f32_16x16x32_bf16 v[144:147], v[80:83], v[72:75], v[144:147]
v_mfma_f32_16x16x32_bf16 v[148:151], v[84:87], v[72:75], v[148:151]
v_mfma_f32_16x16x32_bf16 v[176:179], v[88:91], v[72:75], v[176:179]
v_mfma_f32_16x16x32_bf16 v[180:183], v[92:95], v[72:75], v[180:183]
v_mfma_f32_16x16x32_bf16 v[188:191], v[92:95], v[76:79], v[188:191]
v_mfma_f32_16x16x32_bf16 v[184:187], v[88:91], v[76:79], v[184:187]
v_mfma_f32_16x16x32_bf16 v[156:159], v[84:87], v[76:79], v[156:159]
v_mfma_f32_16x16x32_bf16 v[152:155], v[80:83], v[76:79], v[152:155]
s_sub_u32 s41, s41, 1
s_cmp_lg_u32 s41, 0
s_cbranch_scc1 Lk4_121
s_waitcnt lgkmcnt(0)
s_barrier
v_mfma_f32_16x16x32_bf16 v[128:131], v[112:115], v[96:99], v[128:131]
ds_read_b128 v[32:35], v17 offset:16384
v_mfma_f32_16x16x32_bf16 v[132:135], v[116:119], v[96:99], v[132:135]
ds_read_b64_tr_b16 v[48:49], v224 offset:32768
v_mfma_f32_16x16x32_bf16 v[160:163], v[120:123], v[96:99], v[160:163]
ds_read_b64_tr_b16 v[50:51], v224 offset:34816
v_mfma_f32_16x16x32_bf16 v[164:167], v[124:127], v[96:99], v[164:167]
ds_read_b64_tr_b16 v[52:53], v225 offset:32768
v_mfma_f32_16x16x32_bf16 v[172:175], v[124:127], v[100:103], v[172:175]
ds_read_b64_tr_b16 v[54:55], v225 offset:34816
v_mfma_f32_16x16x32_bf16 v[168:171], v[120:123], v[100:103], v[168:171]
ds_read_b128 v[36:39], v17 offset:17408
v_mfma_f32_16x16x32_bf16 v[140:143], v[116:119], v[100:103], v[140:143]
ds_read_b128 v[40:43], v17 offset:18432
v_mfma_f32_16x16x32_bf16 v[136:139], v[112:115], v[100:103], v[136:139]
ds_read_b128 v[44:47], v17 offset:19456
v_mfma_f32_16x16x32_bf16 v[144:147], v[112:115], v[104:107], v[144:147]
ds_read_b128 v[64:67], v17 offset:24576
v_mfma_f32_16x16x32_bf16 v[148:151], v[116:119], v[104:107], v[148:151]
ds_read_b64_tr_b16 v[80:81], v224 offset:36864
v_mfma_f32_16x16x32_bf16 v[176:179], v[120:123], v[104:107], v[176:179]
ds_read_b64_tr_b16 v[82:83], v224 offset:38912
v_mfma_f32_16x16x32_bf16 v[180:183], v[124:127], v[104:107], v[180:183]
ds_read_b64_tr_b16 v[84:85], v225 offset:36864
v_mfma_f32_16x16x32_bf16 v[188:191], v[124:127], v[108:111], v[188:191]
ds_read_b64_tr_b16 v[86:87], v225 offset:38912
v_mfma_f32_16x16x32_bf16 v[184:187], v[120:123], v[108:111], v[184:187]
ds_read_b128 v[68:71], v17 offset:25600
s_branch Lov_12
.p2align 12
.fill 96, 4, 0xbf800000
Lst_12_0:
s_branch Lwr_157
Lst_12_1:
s_branch Lst_16_0
s_nop 0
Lov_12:
v_mfma_f32_16x16x32_bf16 v[156:159], v[116:119], v[108:111], v[156:159]
ds_read_b128 v[72:75], v17 offset:26624
v_mfma_f32_16x16x32_bf16 v[152:155], v[112:115], v[108:111], v[152:155]
ds_read_b128 v[76:79], v17 offset:27648
v_mfma_f32_16x16x32_bf16 v[128:131], v[208:211], v[192:195], v[128:131]
v_mfma_f32_16x16x32_bf16 v[132:135], v[212:215], v[192:195], v[132:135]
v_mfma_f32_16x16x32_bf16 v[160:163], v[216:219], v[192:195], v[160:163]
v_mfma_f32_16x16x32_bf16 v[164:167], v[220:223], v[192:195], v[164:167]
v_mfma_f32_16x16x32_bf16 v[172:175], v[220:223], v[196:199], v[172:175]
v_mfma_f32_16x16x32_bf16 v[168:171], v[216:219], v[196:199], v[168:171]
v_mfma_f32_16x16x32_bf16 v[140:143], v[212:215], v[196:199], v[140:143]
v_mfma_f32_16x16x32_bf16 v[136:139], v[208:211], v[196:199], v[136:139]
v_mfma_f32_16x16x32_bf16 v[144:147], v[208:211], v[200:203], v[144:147]
v_mfma_f32_16x16x32_bf16 v[148:151], v[212:215], v[200:203], v[148:151]
v_mfma_f32_16x16x32_bf16 v[176:179], v[216:219], v[200:203], v[176:179]
v_mfma_f32_16x16x32_bf16 v[180:183], v[220:223], v[200:203], v[180:183]
v_mfma_f32_16x16x32_bf16 v[188:191], v[220:223], v[204:207], v[188:191]
v_mfma_f32_16x16x32_bf16 v[184:187], v[216:219], v[204:207], v[184:187]
v_mfma_f32_16x16x32_bf16 v[156:159], v[212:215], v[204:207], v[156:159]
v_mfma_f32_16x16x32_bf16 v[152:155], v[208:211], v[204:207], v[152:155]
s_waitcnt lgkmcnt(0)
s_barrier
v_mfma_f32_16x16x32_bf16 v[128:131], v[48:51], v[32:35], v[128:131]
ds_read_b128 v[96:99], v17 offset:49152
ds_read_b64_tr_b16 v[112:113], v226 offset:0
v_mfma_f32_16x16x32_bf16 v[132:135], v[52:55], v[32:35], v[132:135]
ds_read_b64_tr_b16 v[114:115], v226 offset:2048
ds_read_b64_tr_b16 v[116:117], v227 offset:0
v_mfma_f32_16x16x32_bf16 v[140:143], v[52:55], v[36:39], v[140:143]
ds_read_b64_tr_b16 v[118:119], v227 offset:2048
ds_read_b128 v[100:103], v17 offset:50176
v_mfma_f32_16x16x32_bf16 v[136:139], v[48:51], v[36:39], v[136:139]
ds_read_b128 v[104:107], v17 offset:51200
ds_read_b128 v[108:111], v17 offset:52224
v_mfma_f32_16x16x32_bf16 v[144:147], v[48:51], v[40:43], v[144:147]
ds_read_b128 v[192:195], v17 offset:57344
v_mfma_f32_16x16x32_bf16 v[148:151], v[52:55], v[40:43], v[148:151]
ds_read_b64_tr_b16 v[208:209], v226 offset:4096
v_mfma_f32_16x16x32_bf16 v[156:159], v[52:55], v[44:47], v[156:159]
ds_read_b64_tr_b16 v[210:211], v226 offset:6144
v_cvt_pk_bf16_f32 v160, v160, v161
v_cvt_pk_bf16_f32 v161, v162, v163
v_mfma_f32_16x16x32_bf16 v[152:155], v[48:51], v[44:47], v[152:155]
ds_read_b64_tr_b16 v[212:213], v227 offset:4096
v_cvt_pk_bf16_f32 v162, v164, v165
v_cvt_pk_bf16_f32 v163, v166, v167
v_mfma_f32_16x16x32_bf16 v[128:131], v[80:83], v[64:67], v[128:131]
ds_read_b64_tr_b16 v[214:215], v227 offset:6144
v_cvt_pk_bf16_f32 v164, v168, v169
v_cvt_pk_bf16_f32 v165, v170, v171
v_mfma_f32_16x16x32_bf16 v[132:135], v[84:87], v[64:67], v[132:135]
ds_read_b128 v[196:199], v17 offset:58368
v_cvt_pk_bf16_f32 v166, v172, v173
v_cvt_pk_bf16_f32 v167, v174, v175
v_mfma_f32_16x16x32_bf16 v[140:143], v[84:87], v[68:71], v[140:143]
ds_read_b128 v[200:203], v17 offset:59392
v_cvt_pk_bf16_f32 v168, v176, v177
v_cvt_pk_bf16_f32 v169, v178, v179
v_mfma_f32_16x16x32_bf16 v[136:139], v[80:83], v[68:71], v[136:139]
ds_read_b128 v[204:207], v17 offset:60416
v_cvt_pk_bf16_f32 v170, v180, v181
v_cvt_pk_bf16_f32 v171, v182, v183
v_mfma_f32_16x16x32_bf16 v[144:147], v[80:83], v[72:75], v[144:147]
v_cvt_pk_bf16_f32 v172, v184, v185
v_cvt_pk_bf16_f32 v173, v186, v187
v_mfma_f32_16x16x32_bf16 v[148:151], v[84:87], v[72:75], v[148:151]
v_cvt_pk_bf16_f32 v174, v188, v189
v_cvt_pk_bf16_f32 v175, v190, v191
v_mfma_f32_16x16x32_bf16 v[156:159], v[84:87], v[76:79], v[156:159]
v_mfma_f32_16x16x32_bf16 v[152:155], v[80:83], v[76:79], v[152:155]
buffer_store_dwordx4 v[160:163], v2, s[84:87], s45 offen offset:0 sc1
s_waitcnt lgkmcnt(0)
s_barrier
v_mfma_f32_16x16x32_bf16 v[128:131], v[112:115], v[96:99], v[128:131]
ds_read_b128 v[32:35], v18 offset:16384
ds_read_b64_tr_b16 v[48:49], v228 offset:16384
v_mfma_f32_16x16x32_bf16 v[132:135], v[116:119], v[96:99], v[132:135]
ds_read_b64_tr_b16 v[50:51], v228 offset:18432
ds_read_b64_tr_b16 v[52:53], v229 offset:16384
v_mfma_f32_16x16x32_bf16 v[140:143], v[116:119], v[100:103], v[140:143]
ds_read_b64_tr_b16 v[54:55], v229 offset:18432
ds_read_b128 v[36:39], v18 offset:17408
v_mfma_f32_16x16x32_bf16 v[136:139], v[112:115], v[100:103], v[136:139]
ds_read_b128 v[40:43], v18 offset:18432
ds_read_b128 v[44:47], v18 offset:19456
v_mfma_f32_16x16x32_bf16 v[144:147], v[112:115], v[104:107], v[144:147]
ds_read_b128 v[64:67], v18 offset:24576
v_mfma_f32_16x16x32_bf16 v[148:151], v[116:119], v[104:107], v[148:151]
ds_read_b64_tr_b16 v[80:81], v228 offset:20480
v_mfma_f32_16x16x32_bf16 v[156:159], v[116:119], v[108:111], v[156:159]
ds_read_b64_tr_b16 v[82:83], v228 offset:22528
v_mfma_f32_16x16x32_bf16 v[152:155], v[112:115], v[108:111], v[152:155]
ds_read_b64_tr_b16 v[84:85], v229 offset:20480
v_mfma_f32_16x16x32_bf16 v[128:131], v[208:211], v[192:195], v[128:131]
ds_read_b64_tr_b16 v[86:87], v229 offset:22528
buffer_store_dwordx4 v[164:167], v2, s[84:87], s45 offen offset:1024 sc1
v_mfma_f32_16x16x32_bf16 v[132:135], v[212:215], v[192:195], v[132:135]
ds_read_b128 v[68:71], v18 offset:25600
v_mfma_f32_16x16x32_bf16 v[140:143], v[212:215], v[196:199], v[140:143]
ds_read_b128 v[72:75], v18 offset:26624
v_mfma_f32_16x16x32_bf16 v[136:139], v[208:211], v[196:199], v[136:139]
ds_read_b128 v[76:79], v18 offset:27648
v_mfma_f32_16x16x32_bf16 v[144:147], v[208:211], v[200:203], v[144:147]
v_mfma_f32_16x16x32_bf16 v[148:151], v[212:215], v[200:203], v[148:151]
v_mfma_f32_16x16x32_bf16 v[156:159], v[212:215], v[204:207], v[156:159]
v_mfma_f32_16x16x32_bf16 v[152:155], v[208:211], v[204:207], v[152:155]
s_waitcnt lgkmcnt(0)
s_barrier
v_mfma_f32_16x16x32_bf16 v[128:131], v[48:51], v[32:35], v[128:131]
ds_read_b128 v[96:99], v18 offset:32768
ds_read_b64_tr_b16 v[112:113], v226 offset:49152
v_mfma_f32_16x16x32_bf16 v[132:135], v[52:55], v[32:35], v[132:135]
ds_read_b64_tr_b16 v[114:115], v226 offset:51200
ds_read_b64_tr_b16 v[116:117], v227 offset:49152
v_mfma_f32_16x16x32_bf16 v[140:143], v[52:55], v[36:39], v[140:143]
ds_read_b64_tr_b16 v[118:119], v227 offset:51200
ds_read_b128 v[100:103], v18 offset:33792
v_mfma_f32_16x16x32_bf16 v[136:139], v[48:51], v[36:39], v[136:139]
ds_read_b128 v[104:107], v18 offset:34816
ds_read_b128 v[108:111], v18 offset:35840
v_mfma_f32_16x16x32_bf16 v[144:147], v[48:51], v[40:43], v[144:147]
ds_read_b128 v[192:195], v18 offset:40960
v_mfma_f32_16x16x32_bf16 v[148:151], v[52:55], v[40:43], v[148:151]
ds_read_b64_tr_b16 v[208:209], v226 offset:53248
v_mfma_f32_16x16x32_bf16 v[156:159], v[52:55], v[44:47], v[156:159]
ds_read_b64_tr_b16 v[210:211], v226 offset:55296
v_mfma_f32_16x16x32_bf16 v[152:155], v[48:51], v[44:47], v[152:155]
ds_read_b64_tr_b16 v[212:213], v227 offset:53248
v_mfma_f32_16x16x32_bf16 v[128:131], v[80:83], v[64:67], v[128:131]
ds_read_b64_tr_b16 v[214:215], v227 offset:55296
buffer_store_dwordx4 v[168:171], v2, s[84:87], s45 offen offset:2048 sc1
v_mfma_f32_16x16x32_bf16 v[132:135], v[84:87], v[64:67], v[132:135]
ds_read_b128 v[196:199], v18 offset:41984
v_mfma_f32_16x16x32_bf16 v[140:143], v[84:87], v[68:71], v[140:143]
ds_read_b128 v[200:203], v18 offset:43008
v_mfma_f32_16x16x32_bf16 v[136:139], v[80:83], v[68:71], v[136:139]
ds_read_b128 v[204:207], v18 offset:44032
v_mfma_f32_16x16x32_bf16 v[144:147], v[80:83], v[72:75], v[144:147]
v_mfma_f32_16x16x32_bf16 v[148:151], v[84:87], v[72:75], v[148:151]
v_mfma_f32_16x16x32_bf16 v[156:159], v[84:87], v[76:79], v[156:159]
v_mfma_f32_16x16x32_bf16 v[152:155], v[80:83], v[76:79], v[152:155]
s_waitcnt lgkmcnt(0)
s_barrier
v_mfma_f32_16x16x32_bf16 v[128:131], v[112:115], v[96:99], v[128:131]
ds_read_b128 v[32:35], v19 offset:0
ds_read_b64_tr_b16 v[48:49], v224 offset:0
v_mfma_f32_16x16x32_bf16 v[132:135], v[116:119], v[96:99], v[132:135]
ds_read_b64_tr_b16 v[50:51], v224 offset:2048
ds_read_b64_tr_b16 v[52:53], v225 offset:0
v_mfma_f32_16x16x32_bf16 v[140:143], v[116:119], v[100:103], v[140:143]
ds_read_b64_tr_b16 v[54:55], v225 offset:2048
ds_read_b128 v[36:39], v19 offset:1024
v_mfma_f32_16x16x32_bf16 v[136:139], v[112:115], v[100:103], v[136:139]
ds_read_b128 v[40:43], v19 offset:2048
ds_read_b128 v[44:47], v19 offset:3072
v_mfma_f32_16x16x32_bf16 v[144:147], v[112:115], v[104:107], v[144:147]
ds_read_b128 v[64:67], v19 offset:8192
v_mfma_f32_16x16x32_bf16 v[148:151], v[116:119], v[104:107], v[148:151]
ds_read_b64_tr_b16 v[80:81], v224 offset:4096
v_mfma_f32_16x16x32_bf16 v[156:159], v[116:119], v[108:111], v[156:159]
ds_read_b64_tr_b16 v[82:83], v224 offset:6144
v_mfma_f32_16x16x32_bf16 v[152:155], v[112:115], v[108:111], v[152:155]
ds_read_b64_tr_b16 v[84:85], v225 offset:4096
v_mfma_f32_16x16x32_bf16 v[128:131], v[208:211], v[192:195], v[128:131]
ds_read_b64_tr_b16 v[86:87], v225 offset:6144
buffer_store_dwordx4 v[172:175], v2, s[84:87], s45 offen offset:3072 sc1
v_mfma_f32_16x16x32_bf16 v[132:135], v[212:215], v[192:195], v[132:135]
ds_read_b128 v[68:71], v19 offset:9216
v_mfma_f32_16x16x32_bf16 v[140:143], v[212:215], v[196:199], v[140:143]
ds_read_b128 v[72:75], v19 offset:10240
v_mfma_f32_16x16x32_bf16 v[136:139], v[208:211], v[196:199], v[136:139]
ds_read_b128 v[76:79], v19 offset:11264
v_mfma_f32_16x16x32_bf16 v[144:147], v[208:211], v[200:203], v[144:147]
v_mfma_f32_16x16x32_bf16 v[148:151], v[212:215], v[200:203], v[148:151]
v_mfma_f32_16x16x32_bf16 v[156:159], v[212:215], v[204:207], v[156:159]
v_mfma_f32_16x16x32_bf16 v[152:155], v[208:211], v[204:207], v[152:155]
s_waitcnt lgkmcnt(0)
s_barrier
v_mfma_f32_16x16x32_bf16 v[128:131], v[48:51], v[32:35], v[128:131]
ds_read_b128 v[96:99], v17 offset:16384
ds_read_b64_tr_b16 v[112:113], v224 offset:32768
v_mfma_f32_16x16x32_bf16 v[132:135], v[52:55], v[32:35], v[132:135]
ds_read_b64_tr_b16 v[114:115], v224 offset:34816
ds_read_b64_tr_b16 v[116:117], v225 offset:32768
v_mfma_f32_16x16x32_bf16 v[140:143], v[52:55], v[36:39], v[140:143]
ds_read_b64_tr_b16 v[118:119], v225 offset:34816
ds_read_b128 v[100:103], v17 offset:17408
v_mfma_f32_16x16x32_bf16 v[136:139], v[48:51], v[36:39], v[136:139]
ds_read_b128 v[104:107], v17 offset:18432
ds_read_b128 v[108:111], v17 offset:19456
v_mfma_f32_16x16x32_bf16 v[144:147], v[48:51], v[40:43], v[144:147]
ds_read_b128 v[192:195], v17 offset:24576
v_mfma_f32_16x16x32_bf16 v[148:151], v[52:55], v[40:43], v[148:151]
ds_read_b64_tr_b16 v[208:209], v224 offset:36864
v_mfma_f32_16x16x32_bf16 v[156:159], v[52:55], v[44:47], v[156:159]
ds_read_b64_tr_b16 v[210:211], v224 offset:38912
v_mfma_f32_16x16x32_bf16 v[152:155], v[48:51], v[44:47], v[152:155]
ds_read_b64_tr_b16 v[212:213], v225 offset:36864
v_mfma_f32_16x16x32_bf16 v[128:131], v[80:83], v[64:67], v[128:131]
ds_read_b64_tr_b16 v[214:215], v225 offset:38912
v_mfma_f32_16x16x32_bf16 v[132:135], v[84:87], v[64:67], v[132:135]
ds_read_b128 v[196:199], v17 offset:25600
v_mfma_f32_16x16x32_bf16 v[140:143], v[84:87], v[68:71], v[140:143]
ds_read_b128 v[200:203], v17 offset:26624
v_mfma_f32_16x16x32_bf16 v[136:139], v[80:83], v[68:71], v[136:139]
ds_read_b128 v[204:207], v17 offset:27648
v_mfma_f32_16x16x32_bf16 v[144:147], v[80:83], v[72:75], v[144:147]
v_mfma_f32_16x16x32_bf16 v[148:151], v[84:87], v[72:75], v[148:151]
v_mfma_f32_16x16x32_bf16 v[156:159], v[84:87], v[76:79], v[156:159]
v_mfma_f32_16x16x32_bf16 v[152:155], v[80:83], v[76:79], v[152:155]
s_waitcnt vmcnt(0)
s_waitcnt lgkmcnt(0)
s_barrier
v_mfma_f32_16x16x32_bf16 v[128:131], v[112:115], v[96:99], v[128:131]
ds_read_b128 v[32:35], v17 offset:49152
ds_read_b64_tr_b16 v[48:49], v226 offset:0
v_mfma_f32_16x16x32_bf16 v[132:135], v[116:119], v[96:99], v[132:135]
ds_read_b64_tr_b16 v[50:51], v226 offset:2048
ds_read_b64_tr_b16 v[52:53], v227 offset:0
v_mfma_f32_16x16x32_bf16 v[140:143], v[116:119], v[100:103], v[140:143]
ds_read_b64_tr_b16 v[54:55], v227 offset:2048
ds_read_b128 v[36:39], v17 offset:50176
v_mfma_f32_16x16x32_bf16 v[136:139], v[112:115], v[100:103], v[136:139]
ds_read_b128 v[40:43], v17 offset:51200
ds_read_b128 v[44:47], v17 offset:52224
v_mfma_f32_16x16x32_bf16 v[144:147], v[112:115], v[104:107], v[144:147]
ds_read_b128 v[64:67], v17 offset:57344
v_mfma_f32_16x16x32_bf16 v[148:151], v[116:119], v[104:107], v[148:151]
ds_read_b64_tr_b16 v[80:81], v226 offset:4096
v_mfma_f32_16x16x32_bf16 v[156:159], v[116:119], v[108:111], v[156:159]
ds_read_b64_tr_b16 v[82:83], v226 offset:6144
v_mfma_f32_16x16x32_bf16 v[152:155], v[112:115], v[108:111], v[152:155]
ds_read_b64_tr_b16 v[84:85], v227 offset:4096
v_mfma_f32_16x16x32_bf16 v[128:131], v[208:211], v[192:195], v[128:131]
ds_read_b64_tr_b16 v[86:87], v227 offset:6144
v_mfma_f32_16x16x32_bf16 v[132:135], v[212:215], v[192:195], v[132:135]
ds_read_b128 v[68:71], v17 offset:58368
v_mfma_f32_16x16x32_bf16 v[140:143], v[212:215], v[196:199], v[140:143]
ds_read_b128 v[72:75], v17 offset:59392
v_mfma_f32_16x16x32_bf16 v[136:139], v[208:211], v[196:199], v[136:139]
ds_read_b128 v[76:79], v17 offset:60416
v_mfma_f32_16x16x32_bf16 v[144:147], v[208:211], v[200:203], v[144:147]
v_mfma_f32_16x16x32_bf16 v[148:151], v[212:215], v[200:203], v[148:151]
v_mfma_f32_16x16x32_bf16 v[156:159], v[212:215], v[204:207], v[156:159]
v_mfma_f32_16x16x32_bf16 v[152:155], v[208:211], v[204:207], v[152:155]
s_waitcnt lgkmcnt(0)
s_barrier
v_mfma_f32_16x16x32_bf16 v[128:131], v[48:51], v[32:35], v[128:131]
ds_read_b128 v[96:99], v18 offset:16384
ds_read_b64_tr_b16 v[112:113], v228 offset:16384
v_mfma_f32_16x16x32_bf16 v[132:135], v[52:55], v[32:35], v[132:135]
ds_read_b64_tr_b16 v[114:115], v228 offset:18432
ds_read_b64_tr_b16 v[116:117], v229 offset:16384
v_mfma_f32_16x16x32_bf16 v[140:143], v[52:55], v[36:39], v[140:143]
ds_read_b64_tr_b16 v[118:119], v229 offset:18432
ds_read_b128 v[100:103], v18 offset:17408
v_mfma_f32_16x16x32_bf16 v[136:139], v[48:51], v[36:39], v[136:139]
ds_read_b128 v[104:107], v18 offset:18432
ds_read_b128 v[108:111], v18 offset:19456
v_mfma_f32_16x16x32_bf16 v[144:147], v[48:51], v[40:43], v[144:147]
ds_read_b128 v[192:195], v18 offset:24576
v_mfma_f32_16x16x32_bf16 v[148:151], v[52:55], v[40:43], v[148:151]
ds_read_b64_tr_b16 v[208:209], v228 offset:20480
v_mfma_f32_16x16x32_bf16 v[156:159], v[52:55], v[44:47], v[156:159]
ds_read_b64_tr_b16 v[210:211], v228 offset:22528
v_mfma_f32_16x16x32_bf16 v[152:155], v[48:51], v[44:47], v[152:155]
ds_read_b64_tr_b16 v[212:213], v229 offset:20480
v_mfma_f32_16x16x32_bf16 v[128:131], v[80:83], v[64:67], v[128:131]
ds_read_b64_tr_b16 v[214:215], v229 offset:22528
v_mfma_f32_16x16x32_bf16 v[132:135], v[84:87], v[64:67], v[132:135]
ds_read_b128 v[196:199], v18 offset:25600
v_mfma_f32_16x16x32_bf16 v[140:143], v[84:87], v[68:71], v[140:143]
ds_read_b128 v[200:203], v18 offset:26624
v_mfma_f32_16x16x32_bf16 v[136:139], v[80:83], v[68:71], v[136:139]
ds_read_b128 v[204:207], v18 offset:27648
v_mfma_f32_16x16x32_bf16 v[144:147], v[80:83], v[72:75], v[144:147]
v_mfma_f32_16x16x32_bf16 v[148:151], v[84:87], v[72:75], v[148:151]
v_mfma_f32_16x16x32_bf16 v[156:159], v[84:87], v[76:79], v[156:159]
v_mfma_f32_16x16x32_bf16 v[152:155], v[80:83], v[76:79], v[152:155]
s_waitcnt lgkmcnt(0)
s_barrier
v_mfma_f32_16x16x32_bf16 v[128:131], v[112:115], v[96:99], v[128:131]
ds_read_b128 v[32:35], v18 offset:32768
ds_read_b64_tr_b16 v[48:49], v226 offset:49152
v_mfma_f32_16x16x32_bf16 v[132:135], v[116:119], v[96:99], v[132:135]
ds_read_b64_tr_b16 v[50:51], v226 offset:51200
ds_read_b64_tr_b16 v[52:53], v227 offset:49152
v_mfma_f32_16x16x32_bf16 v[140:143], v[116:119], v[100:103], v[140:143]
ds_read_b64_tr_b16 v[54:55], v227 offset:51200
ds_read_b128 v[36:39], v18 offset:33792
v_mfma_f32_16x16x32_bf16 v[136:139], v[112:115], v[100:103], v[136:139]
ds_read_b128 v[40:43], v18 offset:34816
ds_read_b128 v[44:47], v18 offset:35840
v_mfma_f32_16x16x32_bf16 v[144:147], v[112:115], v[104:107], v[144:147]
ds_read_b128 v[64:67], v18 offset:40960
v_mfma_f32_16x16x32_bf16 v[148:151], v[116:119], v[104:107], v[148:151]
ds_read_b64_tr_b16 v[80:81], v226 offset:53248
v_mfma_f32_16x16x32_bf16 v[156:159], v[116:119], v[108:111], v[156:159]
ds_read_b64_tr_b16 v[82:83], v226 offset:55296
v_mfma_f32_16x16x32_bf16 v[152:155], v[112:115], v[108:111], v[152:155]
ds_read_b64_tr_b16 v[84:85], v227 offset:53248
v_mfma_f32_16x16x32_bf16 v[128:131], v[208:211], v[192:195], v[128:131]
ds_read_b64_tr_b16 v[86:87], v227 offset:55296
v_mfma_f32_16x16x32_bf16 v[132:135], v[212:215], v[192:195], v[132:135]
ds_read_b128 v[68:71], v18 offset:41984
v_mfma_f32_16x16x32_bf16 v[140:143], v[212:215], v[196:199], v[140:143]
ds_read_b128 v[72:75], v18 offset:43008
v_mfma_f32_16x16x32_bf16 v[136:139], v[208:211], v[196:199], v[136:139]
ds_read_b128 v[76:79], v18 offset:44032
v_mfma_f32_16x16x32_bf16 v[144:147], v[208:211], v[200:203], v[144:147]
v_mfma_f32_16x16x32_bf16 v[148:151], v[212:215], v[200:203], v[148:151]
v_mfma_f32_16x16x32_bf16 v[156:159], v[212:215], v[204:207], v[156:159]
v_mfma_f32_16x16x32_bf16 v[152:155], v[208:211], v[204:207], v[152:155]
s_waitcnt lgkmcnt(0)
s_barrier
buffer_load_dwordx4 v[232:235], v2, s[84:87], s46 offen offset:0 sc1
buffer_load_dwordx4 v[236:239], v2, s[84:87], s46 offen offset:1024 sc1
buffer_load_dwordx4 v[240:243], v2, s[84:87], s46 offen offset:2048 sc1
buffer_load_dwordx4 v[244:247], v2, s[84:87], s46 offen offset:3072 sc1
v_mfma_f32_16x16x32_bf16 v[128:131], v[48:51], v[32:35], v[128:131]
ds_read_b128 v[96:99], v19 offset:0
ds_read_b64_tr_b16 v[112:113], v224 offset:0
v_mfma_f32_16x16x32_bf16 v[132:135], v[52:55], v[32:35], v[132:135]
ds_read_b64_tr_b16 v[114:115], v224 offset:2048
ds_read_b64_tr_b16 v[116:117], v225 offset:0
v_mfma_f32_16x16x32_bf16 v[140:143], v[52:55], v[36:39], v[140:143]
ds_read_b64_tr_b16 v[118:119], v225 offset:2048
ds_read_b128 v[100:103], v19 offset:1024
v_mfma_f32_16x16x32_bf16 v[136:139], v[48:51], v[36:39], v[136:139]
ds_read_b128 v[104:107], v19 offset:2048
ds_read_b128 v[108:111], v19 offset:3072
v_mfma_f32_16x16x32_bf16 v[144:147], v[48:51], v[40:43], v[144:147]
ds_read_b128 v[192:195], v19 offset:8192
v_mfma_f32_16x16x32_bf16 v[148:151], v[52:55], v[40:43], v[148:151]
ds_read_b64_tr_b16 v[208:209], v224 offset:4096
v_mfma_f32_16x16x32_bf16 v[156:159], v[52:55], v[44:47], v[156:159]
ds_read_b64_tr_b16 v[210:211], v224 offset:6144
v_mfma_f32_16x16x32_bf16 v[152:155], v[48:51], v[44:47], v[152:155]
ds_read_b64_tr_b16 v[212:213], v225 offset:4096
v_mfma_f32_16x16x32_bf16 v[128:131], v[80:83], v[64:67], v[128:131]
ds_read_b64_tr_b16 v[214:215], v225 offset:6144
v_mfma_f32_16x16x32_bf16 v[132:135], v[84:87], v[64:67], v[132:135]
ds_read_b128 v[196:199], v19 offset:9216
v_mfma_f32_16x16x32_bf16 v[140:143], v[84:87], v[68:71], v[140:143]
ds_read_b128 v[200:203], v19 offset:10240
v_mfma_f32_16x16x32_bf16 v[136:139], v[80:83], v[68:71], v[136:139]
ds_read_b128 v[204:207], v19 offset:11264
v_mfma_f32_16x16x32_bf16 v[144:147], v[80:83], v[72:75], v[144:147]
v_mfma_f32_16x16x32_bf16 v[148:151], v[84:87], v[72:75], v[148:151]
v_mfma_f32_16x16x32_bf16 v[156:159], v[84:87], v[76:79], v[156:159]
v_mfma_f32_16x16x32_bf16 v[152:155], v[80:83], v[76:79], v[152:155]
s_waitcnt lgkmcnt(0)
s_barrier
v_mfma_f32_16x16x32_bf16 v[128:131], v[112:115], v[96:99], v[128:131]
ds_read_b128 v[32:35], v17 offset:16384
ds_read_b64_tr_b16 v[48:49], v224 offset:32768
v_mfma_f32_16x16x32_bf16 v[132:135], v[116:119], v[96:99], v[132:135]
ds_read_b64_tr_b16 v[50:51], v224 offset:34816
ds_read_b64_tr_b16 v[52:53], v225 offset:32768
v_mfma_f32_16x16x32_bf16 v[140:143], v[116:119], v[100:103], v[140:143]
ds_read_b64_tr_b16 v[54:55], v225 offset:34816
ds_read_b128 v[36:39], v17 offset:17408
v_mfma_f32_16x16x32_bf16 v[136:139], v[112:115], v[100:103], v[136:139]
ds_read_b128 v[40:43], v17 offset:18432
ds_read_b128 v[44:47], v17 offset:19456
v_mfma_f32_16x16x32_bf16 v[144:147], v[112:115], v[104:107], v[144:147]
ds_read_b128 v[64:67], v17 offset:24576
v_mfma_f32_16x16x32_bf16 v[148:151], v[116:119], v[104:107], v[148:151]
ds_read_b64_tr_b16 v[80:81], v224 offset:36864
v_mfma_f32_16x16x32_bf16 v[156:159], v[116:119], v[108:111], v[156:159]
ds_read_b64_tr_b16 v[82:83], v224 offset:38912
v_mfma_f32_16x16x32_bf16 v[152:155], v[112:115], v[108:111], v[152:155]
ds_read_b64_tr_b16 v[84:85], v225 offset:36864
v_mfma_f32_16x16x32_bf16 v[128:131], v[208:211], v[192:195], v[128:131]
ds_read_b64_tr_b16 v[86:87], v225 offset:38912
v_mfma_f32_16x16x32_bf16 v[132:135], v[212:215], v[192:195], v[132:135]
ds_read_b128 v[68:71], v17 offset:25600
v_mfma_f32_16x16x32_bf16 v[140:143], v[212:215], v[196:199], v[140:143]
ds_read_b128 v[72:75], v17 offset:26624
v_mfma_f32_16x16x32_bf16 v[136:139], v[208:211], v[196:199], v[136:139]
ds_read_b128 v[76:79], v17 offset:27648
v_mfma_f32_16x16x32_bf16 v[144:147], v[208:211], v[200:203], v[144:147]
v_mfma_f32_16x16x32_bf16 v[148:151], v[212:215], v[200:203], v[148:151]
v_mfma_f32_16x16x32_bf16 v[156:159], v[212:215], v[204:207], v[156:159]
v_mfma_f32_16x16x32_bf16 v[152:155], v[208:211], v[204:207], v[152:155]
s_waitcnt lgkmcnt(0)
s_barrier
v_mfma_f32_16x16x32_bf16 v[128:131], v[48:51], v[32:35], v[128:131]
ds_read_b128 v[96:99], v17 offset:49152
ds_read_b64_tr_b16 v[112:113], v226 offset:0
v_mfma_f32_16x16x32_bf16 v[132:135], v[52:55], v[32:35], v[132:135]
ds_read_b64_tr_b16 v[114:115], v226 offset:2048
ds_read_b64_tr_b16 v[116:117], v227 offset:0
v_mfma_f32_16x16x32_bf16 v[140:143], v[52:55], v[36:39], v[140:143]
ds_read_b64_tr_b16 v[118:119], v227 offset:2048
ds_read_b128 v[100:103], v17 offset:50176
v_mfma_f32_16x16x32_bf16 v[136:139], v[48:51], v[36:39], v[136:139]
ds_read_b128 v[104:107], v17 offset:51200
ds_read_b128 v[108:111], v17 offset:52224
v_mfma_f32_16x16x32_bf16 v[144:147], v[48:51], v[40:43], v[144:147]
ds_read_b128 v[192:195], v17 offset:57344
v_mfma_f32_16x16x32_bf16 v[148:151], v[52:55], v[40:43], v[148:151]
ds_read_b64_tr_b16 v[208:209], v226 offset:4096
v_mfma_f32_16x16x32_bf16 v[156:159], v[52:55], v[44:47], v[156:159]
ds_read_b64_tr_b16 v[210:211], v226 offset:6144
v_mfma_f32_16x16x32_bf16 v[152:155], v[48:51], v[44:47], v[152:155]
ds_read_b64_tr_b16 v[212:213], v227 offset:4096
v_mfma_f32_16x16x32_bf16 v[128:131], v[80:83], v[64:67], v[128:131]
ds_read_b64_tr_b16 v[214:215], v227 offset:6144
v_mfma_f32_16x16x32_bf16 v[132:135], v[84:87], v[64:67], v[132:135]
ds_read_b128 v[196:199], v17 offset:58368
v_mfma_f32_16x16x32_bf16 v[140:143], v[84:87], v[68:71], v[140:143]
ds_read_b128 v[200:203], v17 offset:59392
v_mfma_f32_16x16x32_bf16 v[136:139], v[80:83], v[68:71], v[136:139]
ds_read_b128 v[204:207], v17 offset:60416
v_mfma_f32_16x16x32_bf16 v[144:147], v[80:83], v[72:75], v[144:147]
v_mfma_f32_16x16x32_bf16 v[148:151], v[84:87], v[72:75], v[148:151]
v_mfma_f32_16x16x32_bf16 v[156:159], v[84:87], v[76:79], v[156:159]
v_mfma_f32_16x16x32_bf16 v[152:155], v[80:83], v[76:79], v[152:155]
s_waitcnt vmcnt(0)
s_waitcnt lgkmcnt(0)
s_barrier
v_mfma_f32_16x16x32_bf16 v[128:131], v[112:115], v[96:99], v[128:131]
v_lshlrev_b32 v160, 16, v232
v_and_b32 v161, 0xffff0000, v232
v_mfma_f32_16x16x32_bf16 v[132:135], v[116:119], v[96:99], v[132:135]
v_lshlrev_b32 v162, 16, v233
v_and_b32 v163, 0xffff0000, v233
v_mfma_f32_16x16x32_bf16 v[140:143], v[116:119], v[100:103], v[140:143]
v_lshlrev_b32 v164, 16, v234
v_and_b32 v165, 0xffff0000, v234
v_mfma_f32_16x16x32_bf16 v[136:139], v[112:115], v[100:103], v[136:139]
v_lshlrev_b32 v166, 16, v235
v_and_b32 v167, 0xffff0000, v235
v_mfma_f32_16x16x32_bf16 v[144:147], v[112:115], v[104:107], v[144:147]
v_lshlrev_b32 v168, 16, v236
v_and_b32 v169, 0xffff0000, v236
v_mfma_f32_16x16x32_bf16 v[148:151], v[116:119], v[104:107], v[148:151]
v_lshlrev_b32 v170, 16, v237
v_and_b32 v171, 0xffff0000, v237
v_mfma_f32_16x16x32_bf16 v[156:159], v[116:119], v[108:111], v[156:159]
v_lshlrev_b32 v172, 16, v238
v_and_b32 v173, 0xffff0000, v238
v_mfma_f32_16x16x32_bf16 v[152:155], v[112:115], v[108:111], v[152:155]
v_lshlrev_b32 v174, 16, v239
v_and_b32 v175, 0xffff0000, v239
v_mfma_f32_16x16x32_bf16 v[128:131], v[208:211], v[192:195], v[128:131]
v_lshlrev_b32 v176, 16, v240
v_and_b32 v177, 0xffff0000, v240
v_mfma_f32_16x16x32_bf16 v[132:135], v[212:215], v[192:195], v[132:135]
v_lshlrev_b32 v178, 16, v241
v_and_b32 v179, 0xffff0000, v241
v_mfma_f32_16x16x32_bf16 v[140:143], v[212:215], v[196:199], v[140:143]
v_lshlrev_b32 v180, 16, v242
v_and_b32 v181, 0xffff0000, v242
v_mfma_f32_16x16x32_bf16 v[136:139], v[208:211], v[196:199], v[136:139]
v_lshlrev_b32 v182, 16, v243
v_and_b32 v183, 0xffff0000, v243
v_mfma_f32_16x16x32_bf16 v[144:147], v[208:211], v[200:203], v[144:147]
v_lshlrev_b32 v184, 16, v244
v_and_b32 v185, 0xffff0000, v244
v_mfma_f32_16x16x32_bf16 v[148:151], v[212:215], v[200:203], v[148:151]
v_lshlrev_b32 v186, 16, v245
v_and_b32 v187, 0xffff0000, v245
v_mfma_f32_16x16x32_bf16 v[156:159], v[212:215], v[204:207], v[156:159]
v_lshlrev_b32 v188, 16, v246
v_and_b32 v189, 0xffff0000, v246
v_mfma_f32_16x16x32_bf16 v[152:155], v[208:211], v[204:207], v[152:155]
v_lshlrev_b32 v190, 16, v247
v_and_b32 v191, 0xffff0000, v247
s_nop 1
v_pk_add_f32 v[128:129], v[128:129], v[160:161]
v_pk_add_f32 v[130:131], v[130:131], v[162:163]
v_pk_add_f32 v[132:133], v[132:133], v[164:165]
v_pk_add_f32 v[134:135], v[134:135], v[166:167]
v_cvt_pk_bf16_f32 v32, v128, v129
v_cvt_pk_bf16_f32 v33, v130, v131
v_cvt_pk_bf16_f32 v34, v132, v133
v_cvt_pk_bf16_f32 v35, v134, v135
v_pk_add_f32 v[136:137], v[136:137], v[168:169]
v_pk_add_f32 v[138:139], v[138:139], v[170:171]
v_pk_add_f32 v[140:141], v[140:141], v[172:173]
v_pk_add_f32 v[142:143], v[142:143], v[174:175]
s_branch Lov_13
.p2align 12
.fill 96, 4, 0xbf800000
Lst_13_0:
s_branch Lwr_158
Lst_13_1:
s_branch Lst_17_0
s_nop 0
Lov_13:
v_cvt_pk_bf16_f32 v36, v136, v137
v_cvt_pk_bf16_f32 v37, v138, v139
v_cvt_pk_bf16_f32 v38, v140, v141
v_cvt_pk_bf16_f32 v39, v142, v143
v_permlane16_swap_b32 v32, v34
v_permlane16_swap_b32 v33, v35
buffer_store_dwordx4 v[32:35], v230, s[20:23], s54 offen offset:0 nt
v_pk_add_f32 v[144:145], v[144:145], v[176:177]
v_pk_add_f32 v[146:147], v[146:147], v[178:179]
v_pk_add_f32 v[148:149], v[148:149], v[180:181]
v_pk_add_f32 v[150:151], v[150:151], v[182:183]
v_cvt_pk_bf16_f32 v40, v144, v145
v_cvt_pk_bf16_f32 v41, v146, v147
v_cvt_pk_bf16_f32 v42, v148, v149
v_cvt_pk_bf16_f32 v43, v150, v151
v_permlane16_swap_b32 v36, v38
v_permlane16_swap_b32 v37, v39
buffer_store_dwordx4 v[36:39], v230, s[20:23], s54 offen offset:2048 nt
v_pk_add_f32 v[152:153], v[152:153], v[184:185]
v_pk_add_f32 v[154:155], v[154:155], v[186:187]
v_pk_add_f32 v[156:157], v[156:157], v[188:189]
v_pk_add_f32 v[158:159], v[158:159], v[190:191]
v_cvt_pk_bf16_f32 v44, v152, v153
v_cvt_pk_bf16_f32 v45, v154, v155
v_cvt_pk_bf16_f32 v46, v156, v157
v_cvt_pk_bf16_f32 v47, v158, v159
v_permlane16_swap_b32 v40, v42
v_permlane16_swap_b32 v41, v43
buffer_store_dwordx4 v[40:43], v230, s[20:23], s55 offen offset:0 nt
s_nop 1
v_permlane16_swap_b32 v44, v46
v_permlane16_swap_b32 v45, v47
buffer_store_dwordx4 v[44:47], v230, s[20:23], s55 offen offset:2048 nt
s_branch Ldone_1
Lgb_97:
s_mul_i32 s43, s34, 262144
s_add_u32 s8, s82, s43
s_addc_u32 s9, s83, 0
s_add_u32 s8, s8, 4194304
s_addc_u32 s9, s9, 0
s_mov_b32 s10, 262144
s_mov_b32 s11, 0x20000
s_lshl_b32 s39, s36, 12
v_lshlrev_b32 v2, 4, v1
v_add_u32 v3, s39, v2
s_add_u32 s37, s35, 0
s_and_b32 s37, s37, 15
s_mul_i32 s37, s37, 16384
s_add_u32 m0, s39, 0
s_nop 0
buffer_load_dwordx4 v3, s[8:11], s37 offen sc1 lds
buffer_load_dwordx4 v3, s[8:11], s37 offen offset:1024 sc1 lds
buffer_load_dwordx4 v3, s[8:11], s37 offen offset:2048 sc1 lds
buffer_load_dwordx4 v3, s[8:11], s37 offen offset:3072 sc1 lds
s_mul_i32 s43, s34, 262144
s_add_u32 s8, s82, s43
s_addc_u32 s9, s83, 0
s_add_u32 s8, s8, 4194304
s_addc_u32 s9, s9, 0
s_mov_b32 s10, 262144
s_mov_b32 s11, 0x20000
s_mul_i32 s43, s34, 917504
s_add_u32 s24, s82, s43
s_addc_u32 s25, s83, 0
s_add_u32 s24, s24, 8388608
s_addc_u32 s25, s25, 0
s_mov_b32 s26, 917504
s_mov_b32 s27, 0x20000
s_add_u32 s84, s82, 27262976
s_addc_u32 s85, s83, 0
s_mov_b32 s86, 229376
s_mov_b32 s87, 0x20000
s_and_b32 s47, s36, 3
s_lshr_b32 s62, s47, 1
s_and_b32 s63, s47, 1
v_lshlrev_b32 v2, 4, v1
s_lshl_b32 s39, s47, 12
v_add_u32 v3, s39, v2
s_bitcmp0_b32 s36, 1
s_cselect_b32 s44, s72, s74
s_cselect_b32 s45, s73, s75
s_mul_i32 s43, s35, 256
s_add_u32 s12, s44, s43
s_addc_u32 s13, s45, 0
s_mov_b32 s14, 7333120
s_mov_b32 s15, 0x20000
s_and_b32 s43, s36, 1
s_mul_i32 s43, s43, 229376
v_lshrrev_b32 v28, 4, v1
v_lshlrev_b32 v29, 1, v28
v_and_b32 v4, 15, v1
v_xor_b32 v4, v4, v29
v_lshlrev_b32 v4, 4, v4
v_mul_u32_u24 v28, 7168, v28
v_add_u32 v4, v4, v28
v_add_u32 v4, s43, v4
v_xor_b32 v5, 128, v4
v_add_u32 v5, 28672, v5
s_and_b32 s43, s36, 3
s_mul_i32 s40, s43, 8192
s_add_u32 s40, s40, 16384
v_mov_b32 v6, v192
v_mov_b32 v7, v193
v_mov_b32 v8, v194
s_lshl_b32 s43, s62, 12
v_add_u32 v9, s43, v2
v_add_u32 v10, 98304, v9
v_mov_b32 v24, v195
s_mul_i32 s43, s34, 16384
s_add_u32 s20, s82, s43
s_addc_u32 s21, s83, 0
s_add_u32 s20, s20, 25165824
s_addc_u32 s21, s21, 0
s_mov_b32 s22, 16384
s_mov_b32 s23, 0x20000
s_add_u32 s38, s35, 2
s_and_b32 s38, s38, 15
s_mul_i32 s38, s38, 458752
s_add_u32 m0, s50, 98304
s_nop 0
buffer_load_dwordx4 v6, s[16:19], s38 offen lds
s_add_u32 m0, s50, 99328
s_nop 0
buffer_load_dwordx4 v7, s[16:19], s38 offen lds
s_add_u32 m0, s50, 100352
s_nop 0
buffer_load_dwordx4 v8, s[16:19], s38 offen lds
s_add_u32 m0, s50, 101376
s_add_u32 s38, s38, 114688
buffer_load_dwordx4 v6, s[16:19], s38 offen lds
s_add_u32 m0, s50, 102400
s_nop 0
buffer_load_dwordx4 v7, s[16:19], s38 offen lds
s_add_u32 m0, s50, 103424
s_nop 0
buffer_load_dwordx4 v8, s[16:19], s38 offen lds
s_cmp_eq_u32 s47, 1
s_cbranch_scc0 Lw_122
s_lshl_b32 s92, s34, 4
s_add_u32 s92, s92, s35
s_lshl_b32 s92, s92, 8
s_add_u32 s92, s92, 49280
s_add_u32 s92, s92, 28311552
s_mov_b32 s41, 0x40000
Lpoll_123:
s_load_dword s93, s[82:83], s92 glc
Lpchk_125:
s_waitcnt lgkmcnt(0)
s_cmp_eq_u32 s93, 16
s_cbranch_scc1 Lpok_124
s_sub_u32 s41, s41, 1
s_cmp_lg_u32 s41, 0
s_cbranch_scc1 Lpoll_123
Lpok_124:
Lw_122:
s_waitcnt vmcnt(0)
s_barrier
s_add_u32 s37, s35, 1
s_and_b32 s37, s37, 15
s_mul_i32 s37, s37, 16384
s_add_u32 m0, s39, 49152
s_nop 0
buffer_load_dwordx4 v3, s[8:11], s37 offen sc1 lds
buffer_load_dwordx4 v3, s[8:11], s37 offen offset:1024 sc1 lds
buffer_load_dwordx4 v3, s[8:11], s37 offen offset:2048 sc1 lds
buffer_load_dwordx4 v3, s[8:11], s37 offen offset:3072 sc1 lds
s_add_u32 s37, s35, 2
s_and_b32 s37, s37, 15
s_mul_i32 s37, s37, 16384
s_add_u32 m0, s39, 98304
s_nop 0
buffer_load_dwordx4 v3, s[8:11], s37 offen sc1 lds
buffer_load_dwordx4 v3, s[8:11], s37 offen offset:1024 sc1 lds
buffer_load_dwordx4 v3, s[8:11], s37 offen offset:2048 sc1 lds
buffer_load_dwordx4 v3, s[8:11], s37 offen offset:3072 sc1 lds
buffer_load_dwordx4 v[96:99], v3, s[20:23], 0 offen offset:0 sc1
buffer_load_dwordx4 v[100:103], v3, s[20:23], 0 offen offset:1024 sc1
buffer_load_dwordx4 v[104:107], v3, s[20:23], 0 offen offset:2048 sc1
buffer_load_dwordx4 v[108:111], v3, s[20:23], 0 offen offset:3072 sc1
s_and_b32 s44, s36, 3
s_mul_i32 s44, s44, 14
s_bfe_u32 s43, s2, 0x30001
s_lshl_b32 s43, s43, 7
s_add_u32 s44, s44, s43
s_add_u32 s44, s44, 72
s_mul_i32 s44, s44, 7168
s_lshr_b32 s43, s2, 4
s_lshl_b32 s43, s43, 8
s_add_u32 s43, s43, s44
s_bitcmp0_b32 s2, 0
s_cselect_b32 s4, s72, s74
s_cselect_b32 s5, s73, s75
s_add_u32 s4, s4, s43
s_addc_u32 s5, s5, 0
s_waitcnt vmcnt(8)
s_barrier
s_cmp_eq_u32 s47, 3
s_cbranch_scc0 Lw_126
v_and_b32 v90, 31, v1
v_lshlrev_b32 v90, 4, v90
v_add_u32 v91, 151552, v90
ds_read_b128 v[112:115], v91 offset:0
ds_read_b128 v[116:119], v91 offset:512
ds_read_b128 v[120:123], v91 offset:1024
ds_read_b128 v[124:127], v91 offset:1536
s_and_b32 s44, s2, 15
s_mul_i32 s44, s44, 14336
s_lshr_b32 s43, s2, 4
s_lshl_b32 s43, s43, 9
s_add_u32 s44, s44, s43
s_add_u32 s44, s44, 8192
s_cmp_lt_u32 s2, 192
s_cselect_b32 s44, s44, 0x7fffffff
s_waitcnt lgkmcnt(0)
v_add_f32 v112, v112, v116
v_add_f32 v120, v120, v124
v_add_f32 v113, v113, v117
v_add_f32 v121, v121, v125
v_add_f32 v114, v114, v118
v_add_f32 v122, v122, v126
v_add_f32 v115, v115, v119
v_add_f32 v123, v123, v127
v_add_f32 v112, v112, v120
v_add_f32 v113, v113, v121
v_add_f32 v114, v114, v122
v_add_f32 v115, v115, v123
s_mov_b64 exec, 0xffffffff
buffer_store_dwordx4 v[112:115], v90, s[84:87], s44 offen sc1
s_mov_b64 exec, -1
Lw_126:
s_add_u32 s37, s35, 3
s_and_b32 s37, s37, 15
s_mul_i32 s37, s37, 16384
s_add_u32 m0, s39, 0
s_nop 0
buffer_load_dwordx4 v3, s[8:11], s37 offen sc1 lds
buffer_load_dwordx4 v3, s[8:11], s37 offen offset:1024 sc1 lds
s_load_dword s3, s[4:5], 78848
buffer_load_dwordx4 v3, s[8:11], s37 offen offset:2048 sc1 lds
buffer_load_dwordx4 v3, s[8:11], s37 offen offset:3072 sc1 lds
s_load_dword s3, s[4:5], 78912
s_add_u32 s38, s35, 3
s_and_b32 s38, s38, 15
s_mul_i32 s38, s38, 458752
s_add_u32 m0, s50, 0
s_nop 0
buffer_load_dwordx4 v6, s[16:19], s38 offen lds
s_load_dword s3, s[4:5], 78976
s_add_u32 m0, s50, 1024
s_nop 0
buffer_load_dwordx4 v7, s[16:19], s38 offen lds
s_add_u32 m0, s50, 2048
s_nop 0
buffer_load_dwordx4 v8, s[16:19], s38 offen lds
s_load_dword s3, s[4:5], 79040
s_add_u32 m0, s50, 3072
s_add_u32 s38, s38, 114688
buffer_load_dwordx4 v6, s[16:19], s38 offen lds
s_load_dword s3, s[4:5], 86016
s_add_u32 m0, s50, 4096
s_nop 0
buffer_load_dwordx4 v7, s[16:19], s38 offen lds
s_add_u32 m0, s50, 5120
s_nop 0
buffer_load_dwordx4 v8, s[16:19], s38 offen lds
s_waitcnt vmcnt(14)
s_barrier
s_add_u32 s37, s35, 4
s_and_b32 s37, s37, 15
s_mul_i32 s37, s37, 16384
s_add_u32 m0, s39, 49152
s_nop 0
buffer_load_dwordx4 v3, s[8:11], s37 offen sc1 lds
buffer_load_dwordx4 v3, s[8:11], s37 offen offset:1024 sc1 lds
s_load_dword s3, s[4:5], 86080
buffer_load_dwordx4 v3, s[8:11], s37 offen offset:2048 sc1 lds
buffer_load_dwordx4 v3, s[8:11], s37 offen offset:3072 sc1 lds
s_load_dword s3, s[4:5], 86144
s_add_u32 s38, s35, 4
s_and_b32 s38, s38, 15
s_mul_i32 s38, s38, 458752
s_add_u32 m0, s50, 49152
s_nop 0
buffer_load_dwordx4 v6, s[16:19], s38 offen lds
s_load_dword s3, s[4:5], 86208
s_add_u32 m0, s50, 50176
s_nop 0
buffer_load_dwordx4 v7, s[16:19], s38 offen lds
s_add_u32 m0, s50, 51200
s_nop 0
buffer_load_dwordx4 v8, s[16:19], s38 offen lds
s_load_dword s3, s[4:5], 93184
s_add_u32 m0, s50, 52224
s_add_u32 s38, s38, 114688
buffer_load_dwordx4 v6, s[16:19], s38 offen lds
s_load_dword s3, s[4:5], 93248
s_add_u32 m0, s50, 53248
s_nop 0
buffer_load_dwordx4 v7, s[16:19], s38 offen lds
s_add_u32 m0, s50, 54272
s_nop 0
buffer_load_dwordx4 v8, s[16:19], s38 offen lds
s_waitcnt vmcnt(10)
s_barrier
s_cmp_eq_u32 s47, 3
s_cbranch_scc0 Lw_127
s_cmp_lt_u32 s2, 192
s_cbranch_scc0 Lw_127
s_lshr_b32 s43, s2, 4
s_add_u32 s43, s43, 96
s_lshl_b32 s43, s43, 7
v_mov_b32 v90, s43
v_mov_b32 v91, 1
s_mov_b64 exec, 1
buffer_atomic_add v91, v90, s[56:59], 0 offen sc1
s_mov_b64 exec, -1
Lw_127:
s_add_u32 s37, s35, 5
s_and_b32 s37, s37, 15
s_mul_i32 s37, s37, 16384
s_add_u32 m0, s39, 98304
s_nop 0
buffer_load_dwordx4 v3, s[8:11], s37 offen sc1 lds
v_add_f32 v96, v96, v100
v_add_f32 v97, v97, v101
v_add_f32 v98, v98, v102
buffer_load_dwordx4 v3, s[8:11], s37 offen offset:1024 sc1 lds
v_add_f32 v99, v99, v103
v_add_f32 v104, v104, v108
v_add_f32 v105, v105, v109
buffer_load_dwordx4 v3, s[8:11], s37 offen offset:2048 sc1 lds
v_add_f32 v106, v106, v110
v_add_f32 v107, v107, v111
s_nop 0
buffer_load_dwordx4 v3, s[8:11], s37 offen offset:3072 sc1 lds
v_permlane32_swap_b32 v96, v104
v_permlane32_swap_b32 v97, v105
v_permlane32_swap_b32 v98, v106
v_permlane32_swap_b32 v99, v107
s_add_u32 s38, s35, 5
s_and_b32 s38, s38, 15
s_mul_i32 s38, s38, 458752
s_add_u32 m0, s50, 98304
s_nop 0
buffer_load_dwordx4 v6, s[16:19], s38 offen lds
v_add_f32 v96, v96, v104
v_add_f32 v97, v97, v105
v_add_f32 v98, v98, v106
s_add_u32 m0, s50, 99328
s_nop 0
buffer_load_dwordx4 v7, s[16:19], s38 offen lds
v_add_f32 v99, v99, v107
v_mov_b32 v100, v96
v_mov_b32 v101, v97
s_add_u32 m0, s50, 100352
s_nop 0
buffer_load_dwordx4 v8, s[16:19], s38 offen lds
v_mov_b32 v102, v98
v_mov_b32 v103, v99
s_nop 0
s_add_u32 m0, s50, 101376
s_add_u32 s38, s38, 114688
buffer_load_dwordx4 v6, s[16:19], s38 offen lds
v_permlane16_swap_b32 v96, v100
v_permlane16_swap_b32 v97, v101
v_permlane16_swap_b32 v98, v102
v_permlane16_swap_b32 v99, v103
s_add_u32 m0, s50, 102400
s_nop 0
buffer_load_dwordx4 v7, s[16:19], s38 offen lds
s_add_u32 m0, s50, 103424
s_nop 0
buffer_load_dwordx4 v8, s[16:19], s38 offen lds
s_waitcnt vmcnt(10)
s_barrier
s_add_u32 s37, s35, 6
s_and_b32 s37, s37, 15
s_mul_i32 s37, s37, 16384
s_add_u32 m0, s39, 0
s_nop 0
buffer_load_dwordx4 v3, s[8:11], s37 offen sc1 lds
v_add_f32 v96, v96, v100
v_add_f32 v97, v97, v101
v_add_f32 v98, v98, v102
buffer_load_dwordx4 v3, s[8:11], s37 offen offset:1024 sc1 lds
v_add_f32 v99, v99, v103
s_nop 0
v_add_f32_dpp v96, v96, v96 row_ror:8 row_mask:0xf bank_mask:0xf
buffer_load_dwordx4 v3, s[8:11], s37 offen offset:2048 sc1 lds
v_add_f32_dpp v97, v97, v97 row_ror:8 row_mask:0xf bank_mask:0xf
v_add_f32_dpp v98, v98, v98 row_ror:8 row_mask:0xf bank_mask:0xf
v_add_f32_dpp v99, v99, v99 row_ror:8 row_mask:0xf bank_mask:0xf
v_mul_f32 v96, 0x3a800000, v96
buffer_load_dwordx4 v3, s[8:11], s37 offen offset:3072 sc1 lds
v_mul_f32 v97, 0x3a800000, v97
v_mul_f32 v98, 0x3a800000, v98
v_mul_f32 v99, 0x3a800000, v99
s_add_u32 s38, s35, 6
s_and_b32 s38, s38, 15
s_mul_i32 s38, s38, 458752
s_add_u32 m0, s50, 0
s_nop 0
buffer_load_dwordx4 v6, s[16:19], s38 offen lds
v_fma_f32 v97, -v96, v96, v97
v_fma_f32 v99, -v98, v98, v99
v_max_f32 v97, 0, v97
s_add_u32 m0, s50, 1024
s_nop 0
buffer_load_dwordx4 v7, s[16:19], s38 offen lds
v_max_f32 v99, 0, v99
v_add_f32 v97, 0x3727c5ac, v97
v_add_f32 v99, 0x3727c5ac, v99
v_rsq_f32 v97, v97
s_add_u32 m0, s50, 2048
s_nop 0
buffer_load_dwordx4 v8, s[16:19], s38 offen lds
v_rsq_f32 v99, v99
v_and_b32 v100, 7, v1
s_lshl_b32 s43, s47, 8
s_add_u32 m0, s50, 3072
s_add_u32 s38, s38, 114688
buffer_load_dwordx4 v6, s[16:19], s38 offen lds
s_add_u32 s43, s43, 147456
v_lshl_add_u32 v100, v100, 4, s43
v_lshrrev_b32 v101, 5, v1
v_lshl_add_u32 v100, v101, 7, v100
s_add_u32 m0, s50, 4096
s_nop 0
buffer_load_dwordx4 v7, s[16:19], s38 offen lds
s_add_u32 m0, s50, 5120
s_nop 0
buffer_load_dwordx4 v8, s[16:19], s38 offen lds
s_waitcnt vmcnt(10)
s_barrier
ds_write_b128 v100, v[96:99]
s_waitcnt lgkmcnt(0)
s_add_u32 s37, s35, 7
s_and_b32 s37, s37, 15
s_mul_i32 s37, s37, 16384
s_add_u32 m0, s39, 49152
s_nop 0
buffer_load_dwordx4 v3, s[8:11], s37 offen sc1 lds
s_load_dword s3, s[4:5], 93312
buffer_load_dwordx4 v3, s[8:11], s37 offen offset:1024 sc1 lds
s_load_dword s3, s[4:5], 93376
s_and_b32 s44, s36, 3
buffer_load_dwordx4 v3, s[8:11], s37 offen offset:2048 sc1 lds
s_mul_i32 s43, s2, 28672
buffer_load_dwordx4 v3, s[8:11], s37 offen offset:3072 sc1 lds
s_mul_i32 s44, s44, 7168
s_add_u32 s43, s43, s44
s_add_u32 s38, s35, 7
s_and_b32 s38, s38, 15
s_mul_i32 s38, s38, 458752
s_add_u32 m0, s50, 49152
s_nop 0
buffer_load_dwordx4 v6, s[16:19], s38 offen lds
s_add_u32 s4, s76, s43
s_add_u32 m0, s50, 50176
s_nop 0
buffer_load_dwordx4 v7, s[16:19], s38 offen lds
s_addc_u32 s5, s77, 0
s_load_dword s3, s[4:5], 0
s_add_u32 m0, s50, 51200
s_nop 0
buffer_load_dwordx4 v8, s[16:19], s38 offen lds
s_load_dword s3, s[4:5], 64
s_add_u32 m0, s50, 52224
s_add_u32 s38, s38, 114688
buffer_load_dwordx4 v6, s[16:19], s38 offen lds
s_load_dword s3, s[4:5], 128
s_load_dword s3, s[4:5], 192
s_add_u32 m0, s50, 53248
s_nop 0
buffer_load_dwordx4 v7, s[16:19], s38 offen lds
s_add_u32 m0, s50, 54272
s_nop 0
buffer_load_dwordx4 v8, s[16:19], s38 offen lds
s_waitcnt vmcnt(10)
s_barrier
s_add_u32 s37, s35, 8
s_and_b32 s37, s37, 15
s_mul_i32 s37, s37, 16384
s_add_u32 m0, s39, 98304
s_nop 0
buffer_load_dwordx4 v3, s[8:11], s37 offen sc1 lds
s_load_dword s3, s[4:5], 256
s_load_dword s3, s[4:5], 320
s_load_dword s3, s[4:5], 384
buffer_load_dwordx4 v3, s[8:11], s37 offen offset:1024 sc1 lds
s_load_dword s3, s[4:5], 448
s_load_dword s3, s[4:5], 512
s_load_dword s3, s[4:5], 576
buffer_load_dwordx4 v3, s[8:11], s37 offen offset:2048 sc1 lds
v_lshrrev_b32 v28, 2, v1
v_and_b32 v29, 7, v28
v_mul_u32_u24 v28, 256, v28
buffer_load_dwordx4 v3, s[8:11], s37 offen offset:3072 sc1 lds
v_lshl_add_u32 v28, v29, 5, v28
v_and_b32 v29, 3, v1
v_lshl_add_u32 v11, v29, 3, v28
s_lshl_b32 s43, s63, 7
s_add_u32 s38, s35, 8
s_and_b32 s38, s38, 15
s_mul_i32 s38, s38, 458752
s_add_u32 m0, s50, 98304
s_nop 0
buffer_load_dwordx4 v6, s[16:19], s38 offen lds
v_xor_b32 v11, s43, v11
v_add_u32 v11, 16384, v11
v_xor_b32 v12, 32, v11
s_add_u32 m0, s50, 99328
s_nop 0
buffer_load_dwordx4 v7, s[16:19], s38 offen lds
v_xor_b32 v13, 64, v11
v_xor_b32 v14, 96, v11
v_add_u32 v15, 49152, v11
s_add_u32 m0, s50, 100352
s_nop 0
buffer_load_dwordx4 v8, s[16:19], s38 offen lds
v_add_u32 v16, 49152, v12
v_add_u32 v17, 49152, v13
v_add_u32 v18, 49152, v14
s_add_u32 m0, s50, 101376
s_add_u32 s38, s38, 114688
buffer_load_dwordx4 v6, s[16:19], s38 offen lds
v_add_u32 v19, 98304, v11
v_add_u32 v20, 98304, v12
v_add_u32 v21, 98304, v13
v_add_u32 v22, 98304, v14
s_add_u32 m0, s50, 102400
s_nop 0
buffer_load_dwordx4 v7, s[16:19], s38 offen lds
s_add_u32 m0, s50, 103424
s_nop 0
buffer_load_dwordx4 v8, s[16:19], s38 offen lds
s_waitcnt vmcnt(10)
s_barrier
s_cmp_eq_u32 s47, 3
s_cbranch_scc0 Lw_128
s_mul_i32 s60, s35, 96
s_add_u32 s61, s60, 95
s_and_b32 s60, s60, 0xff80
s_and_b32 s61, s61, 0xff80
s_add_u32 s60, s60, 28323840
s_add_u32 s61, s61, 28323840
s_load_dword s92, s[82:83], s60 glc
s_load_dword s93, s[82:83], s61 glc
Lw_128:
s_add_u32 s37, s35, 9
s_and_b32 s37, s37, 15
s_mul_i32 s37, s37, 16384
s_add_u32 m0, s39, 0
s_nop 0
buffer_load_dwordx4 v3, s[8:11], s37 offen sc1 lds
buffer_load_dwordx4 v3, s[8:11], s37 offen offset:1024 sc1 lds
buffer_load_dwordx4 v3, s[8:11], s37 offen offset:2048 sc1 lds
buffer_load_dwordx4 v3, s[8:11], s37 offen offset:3072 sc1 lds
s_add_u32 s38, s35, 9
s_and_b32 s38, s38, 15
s_mul_i32 s38, s38, 458752
s_add_u32 m0, s50, 0
s_nop 0
buffer_load_dwordx4 v6, s[16:19], s38 offen lds
s_add_u32 m0, s50, 1024
s_nop 0
buffer_load_dwordx4 v7, s[16:19], s38 offen lds
s_add_u32 m0, s50, 2048
s_nop 0
buffer_load_dwordx4 v8, s[16:19], s38 offen lds
s_add_u32 m0, s50, 3072
s_add_u32 s38, s38, 114688
buffer_load_dwordx4 v6, s[16:19], s38 offen lds
s_add_u32 m0, s50, 4096
s_nop 0
buffer_load_dwordx4 v7, s[16:19], s38 offen lds
s_add_u32 m0, s50, 5120
s_nop 0
buffer_load_dwordx4 v8, s[16:19], s38 offen lds
s_waitcnt vmcnt(10)
s_barrier
s_add_u32 s37, s35, 10
s_and_b32 s37, s37, 15
s_mul_i32 s37, s37, 16384
s_add_u32 m0, s39, 49152
s_nop 0
buffer_load_dwordx4 v3, s[8:11], s37 offen sc1 lds
buffer_load_dwordx4 v3, s[8:11], s37 offen offset:1024 sc1 lds
buffer_load_dwordx4 v3, s[8:11], s37 offen offset:2048 sc1 lds
buffer_load_dwordx4 v3, s[8:11], s37 offen offset:3072 sc1 lds
s_add_u32 s38, s35, 10
s_and_b32 s38, s38, 15
s_mul_i32 s38, s38, 458752
s_add_u32 m0, s50, 49152
s_nop 0
buffer_load_dwordx4 v6, s[16:19], s38 offen lds
s_add_u32 m0, s50, 50176
s_nop 0
buffer_load_dwordx4 v7, s[16:19], s38 offen lds
s_add_u32 m0, s50, 51200
s_nop 0
buffer_load_dwordx4 v8, s[16:19], s38 offen lds
s_add_u32 m0, s50, 52224
s_add_u32 s38, s38, 114688
buffer_load_dwordx4 v6, s[16:19], s38 offen lds
s_add_u32 m0, s50, 53248
s_nop 0
buffer_load_dwordx4 v7, s[16:19], s38 offen lds
s_add_u32 m0, s50, 54272
s_branch Lov_14
.p2align 12
.fill 112, 4, 0xbf800000
Lst_14_0:
s_branch Lwr_159
Lst_14_1:
s_branch Lst_18_0
s_nop 0
Lov_14:
s_nop 0
buffer_load_dwordx4 v8, s[16:19], s38 offen lds
s_mov_b32 s38, 0
buffer_load_dwordx4 v[40:43], v24, s[88:91], s38 offen
s_mov_b32 s38, 28672
buffer_load_dwordx4 v[44:47], v24, s[88:91], s38 offen
s_mov_b32 s38, 57344
buffer_load_dwordx4 v[48:51], v24, s[88:91], s38 offen
s_mov_b32 s38, 86016
buffer_load_dwordx4 v[52:55], v24, s[88:91], s38 offen
s_mov_b32 s38, 114688
buffer_load_dwordx4 v[56:59], v24, s[88:91], s38 offen
s_mov_b32 s38, 143360
buffer_load_dwordx4 v[60:63], v24, s[88:91], s38 offen
s_mov_b32 s38, 172032
buffer_load_dwordx4 v[64:67], v24, s[88:91], s38 offen
s_mov_b32 s38, 200704
buffer_load_dwordx4 v[68:71], v24, s[88:91], s38 offen
s_waitcnt vmcnt(18)
s_cmp_eq_u32 s47, 3
s_cbranch_scc0 Lw_129
s_mov_b32 s41, 0x40000
Lcp_130:
s_waitcnt lgkmcnt(0)
s_and_b32 s92, s92, s93
s_cmp_eq_u32 s92, 16
s_cbranch_scc1 Lco_131
s_load_dword s92, s[82:83], s60 glc
s_load_dword s93, s[82:83], s61 glc
s_sub_u32 s41, s41, 1
s_cmp_lg_u32 s41, 0
s_cbranch_scc1 Lcp_130
s_waitcnt lgkmcnt(0)
Lco_131:
Lw_129:
s_barrier
s_mov_b32 s45, s47
s_cmp_ge_u32 s45, 3
s_cselect_b32 s43, 1, 0
s_mul_i32 s44, s43, 3
s_sub_u32 s45, s45, s44
s_lshl_b32 s45, s45, 7
s_mul_i32 s52, s43, 896
s_add_u32 s52, s52, s45
s_add_u32 s52, s52, 148992
s_mul_i32 s43, s43, 14336
s_add_u32 s43, s43, s45
s_mul_i32 s44, s35, 384
s_add_u32 s43, s43, s44
s_add_u32 s60, s43, 8192
s_add_u32 s45, s47, 4
s_min_u32 s45, s45, 5
s_cmp_ge_u32 s45, 3
s_cselect_b32 s43, 1, 0
s_mul_i32 s44, s43, 3
s_sub_u32 s45, s45, s44
s_lshl_b32 s45, s45, 7
s_mul_i32 s53, s43, 896
s_add_u32 s53, s53, s45
s_add_u32 s53, s53, 148992
s_mul_i32 s43, s43, 14336
s_add_u32 s43, s43, s45
s_mul_i32 s44, s35, 384
s_add_u32 s43, s43, s44
s_add_u32 s61, s43, 8192
v_lshrrev_b32 v104, 3, v1
v_mul_u32_u24 v104, 28672, v104
v_and_b32 v105, 7, v1
v_lshl_add_u32 v104, v105, 4, v104
buffer_load_dwordx4 v[96:99], v104, s[84:87], s60 offen sc1
s_load_dword s3, s[4:5], 640
buffer_load_dwordx4 v[100:103], v104, s[84:87], s61 offen sc1
s_load_dword s3, s[4:5], 704
s_add_u32 s37, s35, 11
s_and_b32 s37, s37, 15
s_mul_i32 s37, s37, 16384
s_add_u32 m0, s39, 98304
s_nop 0
buffer_load_dwordx4 v3, s[8:11], s37 offen sc1 lds
s_load_dword s3, s[4:5], 768
buffer_load_dwordx4 v3, s[8:11], s37 offen offset:1024 sc1 lds
s_load_dword s3, s[4:5], 832
s_load_dword s3, s[4:5], 896
buffer_load_dwordx4 v3, s[8:11], s37 offen offset:2048 sc1 lds
s_load_dword s3, s[4:5], 960
buffer_load_dwordx4 v3, s[8:11], s37 offen offset:3072 sc1 lds
v_cmp_gt_u32 vcc, 32, v1
s_add_u32 s38, s35, 11
s_and_b32 s38, s38, 15
s_mul_i32 s38, s38, 458752
s_add_u32 m0, s50, 98304
s_nop 0
buffer_load_dwordx4 v6, s[16:19], s38 offen lds
v_mov_b32 v104, s52
v_mov_b32 v106, s53
s_add_u32 m0, s50, 99328
s_nop 0
buffer_load_dwordx4 v7, s[16:19], s38 offen lds
v_cndmask_b32 v104, v106, v104, vcc
s_add_u32 m0, s50, 100352
s_nop 0
buffer_load_dwordx4 v8, s[16:19], s38 offen lds
v_lshl_add_u32 v104, v105, 4, v104
s_add_u32 m0, s50, 101376
s_add_u32 s38, s38, 114688
buffer_load_dwordx4 v6, s[16:19], s38 offen lds
v_bfe_u32 v105, v1, 4, 1
v_lshl_add_u32 v104, v105, 2, v104
s_add_u32 m0, s50, 102400
s_nop 0
buffer_load_dwordx4 v7, s[16:19], s38 offen lds
s_add_u32 m0, s50, 103424
s_nop 0
buffer_load_dwordx4 v8, s[16:19], s38 offen lds
s_waitcnt vmcnt(20)
s_barrier
s_add_u32 s37, s35, 12
s_and_b32 s37, s37, 15
s_mul_i32 s37, s37, 16384
s_add_u32 m0, s39, 0
s_nop 0
buffer_load_dwordx4 v3, s[8:11], s37 offen sc1 lds
buffer_load_dwordx4 v3, s[8:11], s37 offen offset:1024 sc1 lds
buffer_load_dwordx4 v3, s[8:11], s37 offen offset:2048 sc1 lds
buffer_load_dwordx4 v3, s[8:11], s37 offen offset:3072 sc1 lds
s_add_u32 s38, s35, 12
s_and_b32 s38, s38, 15
s_mul_i32 s38, s38, 458752
s_add_u32 m0, s50, 0
s_nop 0
buffer_load_dwordx4 v6, s[16:19], s38 offen lds
s_add_u32 m0, s50, 1024
s_nop 0
buffer_load_dwordx4 v7, s[16:19], s38 offen lds
s_add_u32 m0, s50, 2048
s_nop 0
buffer_load_dwordx4 v8, s[16:19], s38 offen lds
s_add_u32 m0, s50, 3072
s_add_u32 s38, s38, 114688
buffer_load_dwordx4 v6, s[16:19], s38 offen lds
s_add_u32 m0, s50, 4096
s_nop 0
buffer_load_dwordx4 v7, s[16:19], s38 offen lds
s_add_u32 m0, s50, 5120
s_nop 0
buffer_load_dwordx4 v8, s[16:19], s38 offen lds
s_waitcnt vmcnt(10)
s_barrier
v_permlane32_swap_b32 v96, v100
v_permlane32_swap_b32 v97, v101
v_permlane32_swap_b32 v98, v102
v_permlane32_swap_b32 v99, v103
v_add_f32 v96, v96, v100
v_add_f32 v97, v97, v101
v_add_f32 v98, v98, v102
v_add_f32 v99, v99, v103
s_nop 1
v_permlane16_swap_b32 v96, v97
v_permlane16_swap_b32 v98, v99
v_add_f32 v96, v96, v97
v_add_f32 v98, v98, v99
s_nop 1
v_add_f32_dpp v96, v96, v96 row_ror:8 row_mask:0xf bank_mask:0xf
v_add_f32_dpp v98, v98, v98 row_ror:8 row_mask:0xf bank_mask:0xf
ds_write_b32 v104, v96
ds_write_b32 v104, v98 offset:8
s_waitcnt lgkmcnt(0)
s_add_u32 s37, s35, 13
s_and_b32 s37, s37, 15
s_mul_i32 s37, s37, 16384
s_add_u32 m0, s39, 49152
s_nop 0
buffer_load_dwordx4 v3, s[8:11], s37 offen sc1 lds
s_load_dword s3, s[4:5], 1024
s_load_dword s3, s[4:5], 1088
s_load_dword s3, s[4:5], 1152
s_load_dword s3, s[4:5], 1216
buffer_load_dwordx4 v3, s[8:11], s37 offen offset:1024 sc1 lds
s_load_dword s3, s[4:5], 1280
s_load_dword s3, s[4:5], 1344
v_lshlrev_b32 v72, 16, v40
v_and_b32 v73, 0xffff0000, v40
v_lshlrev_b32 v74, 16, v41
buffer_load_dwordx4 v3, s[8:11], s37 offen offset:2048 sc1 lds
v_and_b32 v75, 0xffff0000, v41
v_lshlrev_b32 v76, 16, v42
v_and_b32 v77, 0xffff0000, v42
v_lshlrev_b32 v78, 16, v43
v_and_b32 v79, 0xffff0000, v43
buffer_load_dwordx4 v3, s[8:11], s37 offen offset:3072 sc1 lds
v_lshlrev_b32 v80, 16, v44
v_and_b32 v81, 0xffff0000, v44
v_lshlrev_b32 v82, 16, v45
v_and_b32 v83, 0xffff0000, v45
v_lshlrev_b32 v84, 16, v46
s_add_u32 s38, s35, 13
s_and_b32 s38, s38, 15
s_mul_i32 s38, s38, 458752
s_add_u32 m0, s50, 49152
s_nop 0
buffer_load_dwordx4 v6, s[16:19], s38 offen lds
v_and_b32 v85, 0xffff0000, v46
v_lshlrev_b32 v86, 16, v47
v_and_b32 v87, 0xffff0000, v47
v_add_f32 v72, v72, v80
v_add_f32 v73, v73, v81
s_add_u32 m0, s50, 50176
s_nop 0
buffer_load_dwordx4 v7, s[16:19], s38 offen lds
v_add_f32 v74, v74, v82
v_add_f32 v75, v75, v83
v_add_f32 v76, v76, v84
v_add_f32 v77, v77, v85
v_add_f32 v78, v78, v86
s_add_u32 m0, s50, 51200
s_nop 0
buffer_load_dwordx4 v8, s[16:19], s38 offen lds
v_add_f32 v79, v79, v87
v_lshlrev_b32 v80, 16, v48
v_and_b32 v81, 0xffff0000, v48
v_lshlrev_b32 v82, 16, v49
v_and_b32 v83, 0xffff0000, v49
s_add_u32 m0, s50, 52224
s_add_u32 s38, s38, 114688
buffer_load_dwordx4 v6, s[16:19], s38 offen lds
v_lshlrev_b32 v84, 16, v50
v_and_b32 v85, 0xffff0000, v50
v_lshlrev_b32 v86, 16, v51
v_and_b32 v87, 0xffff0000, v51
v_add_f32 v72, v72, v80
s_add_u32 m0, s50, 53248
s_nop 0
buffer_load_dwordx4 v7, s[16:19], s38 offen lds
s_add_u32 m0, s50, 54272
s_nop 0
buffer_load_dwordx4 v8, s[16:19], s38 offen lds
s_waitcnt vmcnt(10)
s_barrier
s_add_u32 s37, s35, 14
s_and_b32 s37, s37, 15
s_mul_i32 s37, s37, 16384
s_add_u32 m0, s39, 98304
s_nop 0
buffer_load_dwordx4 v3, s[8:11], s37 offen sc1 lds
s_load_dword s3, s[4:5], 1408
s_load_dword s3, s[4:5], 1472
s_load_dword s3, s[4:5], 1536
s_load_dword s3, s[4:5], 1600
s_load_dword s3, s[4:5], 1664
buffer_load_dwordx4 v3, s[8:11], s37 offen offset:1024 sc1 lds
s_load_dword s3, s[4:5], 1728
v_add_f32 v73, v73, v81
v_add_f32 v74, v74, v82
v_add_f32 v75, v75, v83
v_add_f32 v76, v76, v84
buffer_load_dwordx4 v3, s[8:11], s37 offen offset:2048 sc1 lds
v_add_f32 v77, v77, v85
v_add_f32 v78, v78, v86
v_add_f32 v79, v79, v87
v_lshlrev_b32 v80, 16, v52
v_and_b32 v81, 0xffff0000, v52
buffer_load_dwordx4 v3, s[8:11], s37 offen offset:3072 sc1 lds
v_lshlrev_b32 v82, 16, v53
v_and_b32 v83, 0xffff0000, v53
v_lshlrev_b32 v84, 16, v54
v_and_b32 v85, 0xffff0000, v54
v_lshlrev_b32 v86, 16, v55
s_add_u32 s38, s35, 14
s_and_b32 s38, s38, 15
s_mul_i32 s38, s38, 458752
s_add_u32 m0, s50, 98304
s_nop 0
buffer_load_dwordx4 v6, s[16:19], s38 offen lds
v_and_b32 v87, 0xffff0000, v55
v_add_f32 v72, v72, v80
v_add_f32 v73, v73, v81
v_add_f32 v74, v74, v82
v_add_f32 v75, v75, v83
s_add_u32 m0, s50, 99328
s_nop 0
buffer_load_dwordx4 v7, s[16:19], s38 offen lds
v_add_f32 v76, v76, v84
v_add_f32 v77, v77, v85
v_add_f32 v78, v78, v86
v_add_f32 v79, v79, v87
v_lshlrev_b32 v80, 16, v56
s_add_u32 m0, s50, 100352
s_nop 0
buffer_load_dwordx4 v8, s[16:19], s38 offen lds
v_and_b32 v81, 0xffff0000, v56
v_lshlrev_b32 v82, 16, v57
v_and_b32 v83, 0xffff0000, v57
v_lshlrev_b32 v84, 16, v58
v_and_b32 v85, 0xffff0000, v58
s_add_u32 m0, s50, 101376
s_add_u32 s38, s38, 114688
buffer_load_dwordx4 v6, s[16:19], s38 offen lds
v_lshlrev_b32 v86, 16, v59
v_and_b32 v87, 0xffff0000, v59
v_add_f32 v72, v72, v80
v_add_f32 v73, v73, v81
v_add_f32 v74, v74, v82
s_add_u32 m0, s50, 102400
s_nop 0
buffer_load_dwordx4 v7, s[16:19], s38 offen lds
s_add_u32 m0, s50, 103424
s_nop 0
buffer_load_dwordx4 v8, s[16:19], s38 offen lds
s_waitcnt vmcnt(10)
s_barrier
s_add_u32 s37, s35, 15
s_and_b32 s37, s37, 15
s_mul_i32 s37, s37, 16384
s_add_u32 m0, s39, 0
s_nop 0
buffer_load_dwordx4 v3, s[8:11], s37 offen sc1 lds
v_add_f32 v75, v75, v83
v_add_f32 v76, v76, v84
v_add_f32 v77, v77, v85
v_add_f32 v78, v78, v86
buffer_load_dwordx4 v3, s[8:11], s37 offen offset:1024 sc1 lds
v_add_f32 v79, v79, v87
v_lshlrev_b32 v80, 16, v60
v_and_b32 v81, 0xffff0000, v60
v_lshlrev_b32 v82, 16, v61
buffer_load_dwordx4 v3, s[8:11], s37 offen offset:2048 sc1 lds
v_and_b32 v83, 0xffff0000, v61
v_lshlrev_b32 v84, 16, v62
v_and_b32 v85, 0xffff0000, v62
v_lshlrev_b32 v86, 16, v63
buffer_load_dwordx4 v3, s[8:11], s37 offen offset:3072 sc1 lds
v_and_b32 v87, 0xffff0000, v63
v_add_f32 v72, v72, v80
v_add_f32 v73, v73, v81
v_add_f32 v74, v74, v82
s_add_u32 s38, s35, 15
s_and_b32 s38, s38, 15
s_mul_i32 s38, s38, 458752
s_add_u32 m0, s50, 0
s_nop 0
buffer_load_dwordx4 v6, s[16:19], s38 offen lds
v_add_f32 v75, v75, v83
v_add_f32 v76, v76, v84
v_add_f32 v77, v77, v85
v_add_f32 v78, v78, v86
s_add_u32 m0, s50, 1024
s_nop 0
buffer_load_dwordx4 v7, s[16:19], s38 offen lds
v_add_f32 v79, v79, v87
v_lshlrev_b32 v80, 16, v64
v_and_b32 v81, 0xffff0000, v64
v_lshlrev_b32 v82, 16, v65
s_add_u32 m0, s50, 2048
s_nop 0
buffer_load_dwordx4 v8, s[16:19], s38 offen lds
v_and_b32 v83, 0xffff0000, v65
v_lshlrev_b32 v84, 16, v66
v_and_b32 v85, 0xffff0000, v66
v_lshlrev_b32 v86, 16, v67
s_add_u32 m0, s50, 3072
s_add_u32 s38, s38, 114688
buffer_load_dwordx4 v6, s[16:19], s38 offen lds
v_and_b32 v87, 0xffff0000, v67
v_add_f32 v72, v72, v80
v_add_f32 v73, v73, v81
v_add_f32 v74, v74, v82
v_add_f32 v75, v75, v83
s_add_u32 m0, s50, 4096
s_nop 0
buffer_load_dwordx4 v7, s[16:19], s38 offen lds
s_add_u32 m0, s50, 5120
s_nop 0
buffer_load_dwordx4 v8, s[16:19], s38 offen lds
s_waitcnt vmcnt(10)
s_barrier
s_add_u32 s37, s35, 0
s_and_b32 s37, s37, 15
s_mul_i32 s37, s37, 16384
s_add_u32 m0, s39, 49152
s_nop 0
buffer_load_dwordx4 v3, s[8:11], s37 offen sc1 lds
v_add_f32 v76, v76, v84
v_add_f32 v77, v77, v85
v_add_f32 v78, v78, v86
buffer_load_dwordx4 v3, s[8:11], s37 offen offset:1024 sc1 lds
v_add_f32 v79, v79, v87
v_lshlrev_b32 v80, 16, v68
v_and_b32 v81, 0xffff0000, v68
buffer_load_dwordx4 v3, s[8:11], s37 offen offset:2048 sc1 lds
v_lshlrev_b32 v82, 16, v69
v_and_b32 v83, 0xffff0000, v69
v_lshlrev_b32 v84, 16, v70
v_and_b32 v85, 0xffff0000, v70
buffer_load_dwordx4 v3, s[8:11], s37 offen offset:3072 sc1 lds
v_lshlrev_b32 v86, 16, v71
v_and_b32 v87, 0xffff0000, v71
v_add_f32 v72, v72, v80
s_add_u32 s38, s35, 0
s_and_b32 s38, s38, 15
s_mul_i32 s38, s38, 458752
s_add_u32 m0, s40, 49152
s_nop 0
buffer_load_dwordx4 v4, s[12:15], s38 offen lds
v_add_f32 v73, v73, v81
v_add_f32 v74, v74, v82
v_add_f32 v75, v75, v83
v_add_f32 v76, v76, v84
s_add_u32 m0, s40, 50176
s_nop 0
buffer_load_dwordx4 v5, s[12:15], s38 offen lds
v_add_f32 v77, v77, v85
v_add_f32 v78, v78, v86
v_add_f32 v79, v79, v87
s_add_u32 m0, s40, 51200
s_add_u32 s38, s38, 57344
buffer_load_dwordx4 v4, s[12:15], s38 offen lds
s_nop 0
v_permlane32_swap_b32 v72, v76
v_permlane32_swap_b32 v73, v77
s_add_u32 m0, s40, 52224
s_nop 0
buffer_load_dwordx4 v5, s[12:15], s38 offen lds
v_permlane32_swap_b32 v74, v78
v_permlane32_swap_b32 v75, v79
v_add_f32 v72, v72, v76
v_add_f32 v73, v73, v77
s_add_u32 m0, s40, 53248
s_add_u32 s38, s38, 57344
buffer_load_dwordx4 v4, s[12:15], s38 offen lds
v_add_f32 v74, v74, v78
v_add_f32 v75, v75, v79
s_nop 0
s_add_u32 m0, s40, 54272
s_nop 0
buffer_load_dwordx4 v5, s[12:15], s38 offen lds
v_permlane16_swap_b32 v72, v74
v_permlane16_swap_b32 v73, v75
v_add_f32 v72, v72, v74
v_add_f32 v73, v73, v75
s_add_u32 m0, s40, 55296
s_add_u32 s38, s38, 57344
buffer_load_dwordx4 v4, s[12:15], s38 offen lds
s_add_u32 m0, s40, 56320
s_nop 0
buffer_load_dwordx4 v5, s[12:15], s38 offen lds
s_waitcnt vmcnt(12)
s_barrier
s_lshl_b32 s43, s47, 9
s_add_u32 s43, s43, 153600
v_and_b32 v80, 15, v1
v_lshl_add_u32 v80, v80, 5, s43
v_lshrrev_b32 v81, 4, v1
v_lshl_add_u32 v80, v81, 3, v80
ds_write_b64 v80, v[72:73]
s_waitcnt lgkmcnt(0)
s_add_u32 s37, s35, 1
s_and_b32 s37, s37, 15
s_mul_i32 s37, s37, 16384
s_add_u32 m0, s39, 98304
s_nop 0
buffer_load_dwordx4 v3, s[8:11], s37 offen sc1 lds
s_bfe_u32 s61, s35, 0x10002
s_lshr_b32 s60, s35, 3
buffer_load_dwordx4 v3, s[8:11], s37 offen offset:1024 sc1 lds
s_lshl_b32 s60, s60, 2
s_and_b32 s43, s35, 3
s_add_u32 s60, s60, s43
buffer_load_dwordx4 v3, s[8:11], s37 offen offset:2048 sc1 lds
s_lshl_b32 s43, s60, 8
s_add_u32 s28, s76, s43
buffer_load_dwordx4 v3, s[8:11], s37 offen offset:3072 sc1 lds
s_addc_u32 s29, s77, 0
s_mov_b32 s30, 7338240
s_mov_b32 s31, 0x20000
s_add_u32 s38, s35, 1
s_and_b32 s38, s38, 15
s_mul_i32 s38, s38, 458752
s_add_u32 m0, s40, 98304
s_nop 0
buffer_load_dwordx4 v4, s[12:15], s38 offen lds
s_mul_i32 s52, s61, 196608
s_mul_i32 s53, s61, 1572864
s_mul_i32 s90, s61, 163840
s_add_u32 m0, s40, 99328
s_nop 0
buffer_load_dwordx4 v5, s[12:15], s38 offen lds
s_mul_i32 s91, s61, 1310720
s_lshl_b32 s51, s47, 11
s_add_u32 m0, s40, 100352
s_add_u32 s38, s38, 57344
buffer_load_dwordx4 v4, s[12:15], s38 offen lds
s_lshl_b32 s44, s47, 15
v_lshrrev_b32 v122, 4, v1
v_lshlrev_b32 v123, 1, v122
s_add_u32 m0, s40, 101376
s_nop 0
buffer_load_dwordx4 v5, s[12:15], s38 offen lds
v_and_b32 v23, 15, v1
v_xor_b32 v23, v23, v123
s_add_u32 m0, s40, 102400
s_add_u32 s38, s38, 57344
buffer_load_dwordx4 v4, s[12:15], s38 offen lds
v_lshlrev_b32 v23, 4, v23
v_mul_u32_u24 v122, 2048, v122
v_add_u32 v23, v23, v122
s_add_u32 m0, s40, 103424
s_nop 0
buffer_load_dwordx4 v5, s[12:15], s38 offen lds
v_add_u32 v23, s44, v23
v_xor_b32 v24, 128, v23
v_add_u32 v24, 8192, v24
s_add_u32 m0, s40, 104448
s_add_u32 s38, s38, 57344
buffer_load_dwordx4 v4, s[12:15], s38 offen lds
s_add_u32 m0, s40, 105472
s_nop 0
buffer_load_dwordx4 v5, s[12:15], s38 offen lds
s_waitcnt vmcnt(12)
s_barrier
ds_read_b128 v[28:31], v9 offset:49152
ds_read_b64_tr_b16 v[44:45], v15 offset:0
ds_read_b64_tr_b16 v[46:47], v15 offset:4096
ds_read_b64_tr_b16 v[48:49], v16 offset:0
ds_read_b64_tr_b16 v[50:51], v16 offset:4096
ds_read_b64_tr_b16 v[52:53], v17 offset:0
ds_read_b64_tr_b16 v[54:55], v17 offset:4096
ds_read_b64_tr_b16 v[56:57], v18 offset:0
ds_read_b64_tr_b16 v[58:59], v18 offset:4096
ds_read_b64_tr_b16 v[60:61], v15 offset:16384
ds_read_b64_tr_b16 v[62:63], v15 offset:20480
ds_read_b64_tr_b16 v[64:65], v16 offset:16384
ds_read_b64_tr_b16 v[66:67], v16 offset:20480
ds_read_b64_tr_b16 v[68:69], v17 offset:16384
ds_read_b64_tr_b16 v[70:71], v17 offset:20480
ds_read_b64_tr_b16 v[72:73], v18 offset:16384
ds_read_b64_tr_b16 v[74:75], v18 offset:20480
ds_read_b128 v[32:35], v9 offset:50176
ds_read_b128 v[36:39], v9 offset:51200
ds_read_b128 v[40:43], v9 offset:52224
s_waitcnt lgkmcnt(0)
v_mfma_f32_16x16x32_bf16 v[124:127], v[44:47], v[28:31], 0
ds_read_b128 v[76:79], v9 offset:57344
v_mfma_f32_16x16x32_bf16 v[128:131], v[48:51], v[28:31], 0
ds_read_b64_tr_b16 v[92:93], v15 offset:8192
v_mfma_f32_16x16x32_bf16 v[132:135], v[52:55], v[28:31], 0
ds_read_b64_tr_b16 v[94:95], v15 offset:12288
v_mfma_f32_16x16x32_bf16 v[136:139], v[56:59], v[28:31], 0
ds_read_b64_tr_b16 v[96:97], v16 offset:8192
v_mfma_f32_16x16x32_bf16 v[140:143], v[60:63], v[28:31], 0
ds_read_b64_tr_b16 v[98:99], v16 offset:12288
v_mfma_f32_16x16x32_bf16 v[144:147], v[64:67], v[28:31], 0
ds_read_b64_tr_b16 v[100:101], v17 offset:8192
v_mfma_f32_16x16x32_bf16 v[148:151], v[68:71], v[28:31], 0
ds_read_b64_tr_b16 v[102:103], v17 offset:12288
v_mfma_f32_16x16x32_bf16 v[152:155], v[72:75], v[28:31], 0
ds_read_b64_tr_b16 v[104:105], v18 offset:8192
v_mfma_f32_16x16x32_bf16 v[184:187], v[72:75], v[32:35], 0
ds_read_b64_tr_b16 v[106:107], v18 offset:12288
v_mfma_f32_16x16x32_bf16 v[180:183], v[68:71], v[32:35], 0
ds_read_b64_tr_b16 v[108:109], v15 offset:24576
v_mfma_f32_16x16x32_bf16 v[176:179], v[64:67], v[32:35], 0
ds_read_b64_tr_b16 v[110:111], v15 offset:28672
v_mfma_f32_16x16x32_bf16 v[172:175], v[60:63], v[32:35], 0
ds_read_b64_tr_b16 v[112:113], v16 offset:24576
v_mfma_f32_16x16x32_bf16 v[168:171], v[56:59], v[32:35], 0
ds_read_b64_tr_b16 v[114:115], v16 offset:28672
v_mfma_f32_16x16x32_bf16 v[164:167], v[52:55], v[32:35], 0
ds_read_b64_tr_b16 v[116:117], v17 offset:24576
v_mfma_f32_16x16x32_bf16 v[160:163], v[48:51], v[32:35], 0
ds_read_b64_tr_b16 v[118:119], v17 offset:28672
v_mfma_f32_16x16x32_bf16 v[156:159], v[44:47], v[32:35], 0
ds_read_b64_tr_b16 v[120:121], v18 offset:24576
v_mfma_f32_16x16x32_bf16 v[188:191], v[44:47], v[36:39], 0
ds_read_b64_tr_b16 v[122:123], v18 offset:28672
v_mfma_f32_16x16x32_bf16 v[192:195], v[48:51], v[36:39], 0
ds_read_b128 v[80:83], v9 offset:58368
v_mfma_f32_16x16x32_bf16 v[196:199], v[52:55], v[36:39], 0
ds_read_b128 v[84:87], v9 offset:59392
v_mfma_f32_16x16x32_bf16 v[200:203], v[56:59], v[36:39], 0
ds_read_b128 v[88:91], v9 offset:60416
v_mfma_f32_16x16x32_bf16 v[204:207], v[60:63], v[36:39], 0
v_mfma_f32_16x16x32_bf16 v[208:211], v[64:67], v[36:39], 0
v_mfma_f32_16x16x32_bf16 v[212:215], v[68:71], v[36:39], 0
v_mfma_f32_16x16x32_bf16 v[216:219], v[72:75], v[36:39], 0
v_mfma_f32_16x16x32_bf16 v[248:251], v[72:75], v[40:43], 0
v_mfma_f32_16x16x32_bf16 v[244:247], v[68:71], v[40:43], 0
v_mfma_f32_16x16x32_bf16 v[240:243], v[64:67], v[40:43], 0
v_mfma_f32_16x16x32_bf16 v[236:239], v[60:63], v[40:43], 0
v_mfma_f32_16x16x32_bf16 v[232:235], v[56:59], v[40:43], 0
s_branch Lov_15
.p2align 12
.fill 112, 4, 0xbf800000
Lst_15_0:
s_branch Lwr_168
s_nop 0
s_nop 0
Lov_15:
v_mfma_f32_16x16x32_bf16 v[228:231], v[52:55], v[40:43], 0
v_mfma_f32_16x16x32_bf16 v[224:227], v[48:51], v[40:43], 0
v_mfma_f32_16x16x32_bf16 v[220:223], v[44:47], v[40:43], 0
s_waitcnt vmcnt(0)
s_waitcnt lgkmcnt(0)
s_barrier
v_mfma_f32_16x16x32_bf16 v[124:127], v[92:95], v[76:79], v[124:127]
ds_read_b128 v[28:31], v10 offset:0
v_mfma_f32_16x16x32_bf16 v[128:131], v[96:99], v[76:79], v[128:131]
ds_read_b64_tr_b16 v[44:45], v19 offset:0
v_mfma_f32_16x16x32_bf16 v[132:135], v[100:103], v[76:79], v[132:135]
ds_read_b64_tr_b16 v[46:47], v19 offset:4096
v_mfma_f32_16x16x32_bf16 v[136:139], v[104:107], v[76:79], v[136:139]
ds_read_b64_tr_b16 v[48:49], v20 offset:0
v_mfma_f32_16x16x32_bf16 v[140:143], v[108:111], v[76:79], v[140:143]
ds_read_b64_tr_b16 v[50:51], v20 offset:4096
v_mfma_f32_16x16x32_bf16 v[144:147], v[112:115], v[76:79], v[144:147]
ds_read_b64_tr_b16 v[52:53], v21 offset:0
v_mfma_f32_16x16x32_bf16 v[148:151], v[116:119], v[76:79], v[148:151]
ds_read_b64_tr_b16 v[54:55], v21 offset:4096
v_mfma_f32_16x16x32_bf16 v[152:155], v[120:123], v[76:79], v[152:155]
ds_read_b64_tr_b16 v[56:57], v22 offset:0
v_mfma_f32_16x16x32_bf16 v[184:187], v[120:123], v[80:83], v[184:187]
ds_read_b64_tr_b16 v[58:59], v22 offset:4096
v_mfma_f32_16x16x32_bf16 v[180:183], v[116:119], v[80:83], v[180:183]
ds_read_b64_tr_b16 v[60:61], v19 offset:16384
v_mfma_f32_16x16x32_bf16 v[176:179], v[112:115], v[80:83], v[176:179]
ds_read_b64_tr_b16 v[62:63], v19 offset:20480
v_mfma_f32_16x16x32_bf16 v[172:175], v[108:111], v[80:83], v[172:175]
ds_read_b64_tr_b16 v[64:65], v20 offset:16384
v_mfma_f32_16x16x32_bf16 v[168:171], v[104:107], v[80:83], v[168:171]
ds_read_b64_tr_b16 v[66:67], v20 offset:20480
v_mfma_f32_16x16x32_bf16 v[164:167], v[100:103], v[80:83], v[164:167]
ds_read_b64_tr_b16 v[68:69], v21 offset:16384
v_mfma_f32_16x16x32_bf16 v[160:163], v[96:99], v[80:83], v[160:163]
ds_read_b64_tr_b16 v[70:71], v21 offset:20480
v_mfma_f32_16x16x32_bf16 v[156:159], v[92:95], v[80:83], v[156:159]
ds_read_b64_tr_b16 v[72:73], v22 offset:16384
v_mfma_f32_16x16x32_bf16 v[188:191], v[92:95], v[84:87], v[188:191]
ds_read_b64_tr_b16 v[74:75], v22 offset:20480
v_mfma_f32_16x16x32_bf16 v[192:195], v[96:99], v[84:87], v[192:195]
ds_read_b128 v[32:35], v10 offset:1024
v_mfma_f32_16x16x32_bf16 v[196:199], v[100:103], v[84:87], v[196:199]
ds_read_b128 v[36:39], v10 offset:2048
v_mfma_f32_16x16x32_bf16 v[200:203], v[104:107], v[84:87], v[200:203]
ds_read_b128 v[40:43], v10 offset:3072
v_mfma_f32_16x16x32_bf16 v[204:207], v[108:111], v[84:87], v[204:207]
v_mfma_f32_16x16x32_bf16 v[208:211], v[112:115], v[84:87], v[208:211]
v_mfma_f32_16x16x32_bf16 v[212:215], v[116:119], v[84:87], v[212:215]
v_mfma_f32_16x16x32_bf16 v[216:219], v[120:123], v[84:87], v[216:219]
v_mfma_f32_16x16x32_bf16 v[248:251], v[120:123], v[88:91], v[248:251]
v_mfma_f32_16x16x32_bf16 v[244:247], v[116:119], v[88:91], v[244:247]
v_mfma_f32_16x16x32_bf16 v[240:243], v[112:115], v[88:91], v[240:243]
v_mfma_f32_16x16x32_bf16 v[236:239], v[108:111], v[88:91], v[236:239]
v_mfma_f32_16x16x32_bf16 v[232:235], v[104:107], v[88:91], v[232:235]
v_mfma_f32_16x16x32_bf16 v[228:231], v[100:103], v[88:91], v[228:231]
v_mfma_f32_16x16x32_bf16 v[224:227], v[96:99], v[88:91], v[224:227]
v_mfma_f32_16x16x32_bf16 v[220:223], v[92:95], v[88:91], v[220:223]
s_mov_b32 s41, 5
Lk3l_132:
s_waitcnt lgkmcnt(0)
v_mfma_f32_16x16x32_bf16 v[124:127], v[44:47], v[28:31], v[124:127]
ds_read_b128 v[76:79], v10 offset:8192
v_mfma_f32_16x16x32_bf16 v[128:131], v[48:51], v[28:31], v[128:131]
ds_read_b64_tr_b16 v[92:93], v19 offset:8192
v_mfma_f32_16x16x32_bf16 v[132:135], v[52:55], v[28:31], v[132:135]
ds_read_b64_tr_b16 v[94:95], v19 offset:12288
v_mfma_f32_16x16x32_bf16 v[136:139], v[56:59], v[28:31], v[136:139]
ds_read_b64_tr_b16 v[96:97], v20 offset:8192
v_mfma_f32_16x16x32_bf16 v[140:143], v[60:63], v[28:31], v[140:143]
ds_read_b64_tr_b16 v[98:99], v20 offset:12288
v_mfma_f32_16x16x32_bf16 v[144:147], v[64:67], v[28:31], v[144:147]
ds_read_b64_tr_b16 v[100:101], v21 offset:8192
v_mfma_f32_16x16x32_bf16 v[148:151], v[68:71], v[28:31], v[148:151]
ds_read_b64_tr_b16 v[102:103], v21 offset:12288
v_mfma_f32_16x16x32_bf16 v[152:155], v[72:75], v[28:31], v[152:155]
ds_read_b64_tr_b16 v[104:105], v22 offset:8192
v_mfma_f32_16x16x32_bf16 v[184:187], v[72:75], v[32:35], v[184:187]
ds_read_b64_tr_b16 v[106:107], v22 offset:12288
v_mfma_f32_16x16x32_bf16 v[180:183], v[68:71], v[32:35], v[180:183]
ds_read_b64_tr_b16 v[108:109], v19 offset:24576
v_mfma_f32_16x16x32_bf16 v[176:179], v[64:67], v[32:35], v[176:179]
ds_read_b64_tr_b16 v[110:111], v19 offset:28672
v_mfma_f32_16x16x32_bf16 v[172:175], v[60:63], v[32:35], v[172:175]
ds_read_b64_tr_b16 v[112:113], v20 offset:24576
v_mfma_f32_16x16x32_bf16 v[168:171], v[56:59], v[32:35], v[168:171]
ds_read_b64_tr_b16 v[114:115], v20 offset:28672
v_mfma_f32_16x16x32_bf16 v[164:167], v[52:55], v[32:35], v[164:167]
ds_read_b64_tr_b16 v[116:117], v21 offset:24576
v_mfma_f32_16x16x32_bf16 v[160:163], v[48:51], v[32:35], v[160:163]
ds_read_b64_tr_b16 v[118:119], v21 offset:28672
v_mfma_f32_16x16x32_bf16 v[156:159], v[44:47], v[32:35], v[156:159]
ds_read_b64_tr_b16 v[120:121], v22 offset:24576
v_mfma_f32_16x16x32_bf16 v[188:191], v[44:47], v[36:39], v[188:191]
ds_read_b64_tr_b16 v[122:123], v22 offset:28672
v_mfma_f32_16x16x32_bf16 v[192:195], v[48:51], v[36:39], v[192:195]
ds_read_b128 v[80:83], v10 offset:9216
v_mfma_f32_16x16x32_bf16 v[196:199], v[52:55], v[36:39], v[196:199]
ds_read_b128 v[84:87], v10 offset:10240
v_mfma_f32_16x16x32_bf16 v[200:203], v[56:59], v[36:39], v[200:203]
ds_read_b128 v[88:91], v10 offset:11264
v_mfma_f32_16x16x32_bf16 v[204:207], v[60:63], v[36:39], v[204:207]
v_mfma_f32_16x16x32_bf16 v[208:211], v[64:67], v[36:39], v[208:211]
v_mfma_f32_16x16x32_bf16 v[212:215], v[68:71], v[36:39], v[212:215]
v_mfma_f32_16x16x32_bf16 v[216:219], v[72:75], v[36:39], v[216:219]
v_mfma_f32_16x16x32_bf16 v[248:251], v[72:75], v[40:43], v[248:251]
v_mfma_f32_16x16x32_bf16 v[244:247], v[68:71], v[40:43], v[244:247]
v_mfma_f32_16x16x32_bf16 v[240:243], v[64:67], v[40:43], v[240:243]
v_mfma_f32_16x16x32_bf16 v[236:239], v[60:63], v[40:43], v[236:239]
v_mfma_f32_16x16x32_bf16 v[232:235], v[56:59], v[40:43], v[232:235]
v_mfma_f32_16x16x32_bf16 v[228:231], v[52:55], v[40:43], v[228:231]
v_mfma_f32_16x16x32_bf16 v[224:227], v[48:51], v[40:43], v[224:227]
v_mfma_f32_16x16x32_bf16 v[220:223], v[44:47], v[40:43], v[220:223]
s_waitcnt lgkmcnt(0)
s_barrier
v_mfma_f32_16x16x32_bf16 v[124:127], v[92:95], v[76:79], v[124:127]
ds_read_b128 v[28:31], v9 offset:0
v_mfma_f32_16x16x32_bf16 v[128:131], v[96:99], v[76:79], v[128:131]
ds_read_b64_tr_b16 v[44:45], v11 offset:0
v_mfma_f32_16x16x32_bf16 v[132:135], v[100:103], v[76:79], v[132:135]
ds_read_b64_tr_b16 v[46:47], v11 offset:4096
v_mfma_f32_16x16x32_bf16 v[136:139], v[104:107], v[76:79], v[136:139]
ds_read_b64_tr_b16 v[48:49], v12 offset:0
v_mfma_f32_16x16x32_bf16 v[140:143], v[108:111], v[76:79], v[140:143]
ds_read_b64_tr_b16 v[50:51], v12 offset:4096
v_mfma_f32_16x16x32_bf16 v[144:147], v[112:115], v[76:79], v[144:147]
ds_read_b64_tr_b16 v[52:53], v13 offset:0
v_mfma_f32_16x16x32_bf16 v[148:151], v[116:119], v[76:79], v[148:151]
ds_read_b64_tr_b16 v[54:55], v13 offset:4096
v_mfma_f32_16x16x32_bf16 v[152:155], v[120:123], v[76:79], v[152:155]
ds_read_b64_tr_b16 v[56:57], v14 offset:0
v_mfma_f32_16x16x32_bf16 v[184:187], v[120:123], v[80:83], v[184:187]
ds_read_b64_tr_b16 v[58:59], v14 offset:4096
v_mfma_f32_16x16x32_bf16 v[180:183], v[116:119], v[80:83], v[180:183]
ds_read_b64_tr_b16 v[60:61], v11 offset:16384
v_mfma_f32_16x16x32_bf16 v[176:179], v[112:115], v[80:83], v[176:179]
ds_read_b64_tr_b16 v[62:63], v11 offset:20480
v_mfma_f32_16x16x32_bf16 v[172:175], v[108:111], v[80:83], v[172:175]
ds_read_b64_tr_b16 v[64:65], v12 offset:16384
v_mfma_f32_16x16x32_bf16 v[168:171], v[104:107], v[80:83], v[168:171]
ds_read_b64_tr_b16 v[66:67], v12 offset:20480
v_mfma_f32_16x16x32_bf16 v[164:167], v[100:103], v[80:83], v[164:167]
ds_read_b64_tr_b16 v[68:69], v13 offset:16384
v_mfma_f32_16x16x32_bf16 v[160:163], v[96:99], v[80:83], v[160:163]
ds_read_b64_tr_b16 v[70:71], v13 offset:20480
v_mfma_f32_16x16x32_bf16 v[156:159], v[92:95], v[80:83], v[156:159]
ds_read_b64_tr_b16 v[72:73], v14 offset:16384
v_mfma_f32_16x16x32_bf16 v[188:191], v[92:95], v[84:87], v[188:191]
ds_read_b64_tr_b16 v[74:75], v14 offset:20480
v_mfma_f32_16x16x32_bf16 v[192:195], v[96:99], v[84:87], v[192:195]
ds_read_b128 v[32:35], v9 offset:1024
v_mfma_f32_16x16x32_bf16 v[196:199], v[100:103], v[84:87], v[196:199]
ds_read_b128 v[36:39], v9 offset:2048
v_mfma_f32_16x16x32_bf16 v[200:203], v[104:107], v[84:87], v[200:203]
ds_read_b128 v[40:43], v9 offset:3072
v_mfma_f32_16x16x32_bf16 v[204:207], v[108:111], v[84:87], v[204:207]
v_mfma_f32_16x16x32_bf16 v[208:211], v[112:115], v[84:87], v[208:211]
v_mfma_f32_16x16x32_bf16 v[212:215], v[116:119], v[84:87], v[212:215]
v_mfma_f32_16x16x32_bf16 v[216:219], v[120:123], v[84:87], v[216:219]
v_mfma_f32_16x16x32_bf16 v[248:251], v[120:123], v[88:91], v[248:251]
v_mfma_f32_16x16x32_bf16 v[244:247], v[116:119], v[88:91], v[244:247]
v_mfma_f32_16x16x32_bf16 v[240:243], v[112:115], v[88:91], v[240:243]
v_mfma_f32_16x16x32_bf16 v[236:239], v[108:111], v[88:91], v[236:239]
v_mfma_f32_16x16x32_bf16 v[232:235], v[104:107], v[88:91], v[232:235]
v_mfma_f32_16x16x32_bf16 v[228:231], v[100:103], v[88:91], v[228:231]
v_mfma_f32_16x16x32_bf16 v[224:227], v[96:99], v[88:91], v[224:227]
v_mfma_f32_16x16x32_bf16 v[220:223], v[92:95], v[88:91], v[220:223]
s_waitcnt lgkmcnt(0)
v_mfma_f32_16x16x32_bf16 v[124:127], v[44:47], v[28:31], v[124:127]
ds_read_b128 v[76:79], v9 offset:8192
v_mfma_f32_16x16x32_bf16 v[128:131], v[48:51], v[28:31], v[128:131]
ds_read_b64_tr_b16 v[92:93], v11 offset:8192
v_mfma_f32_16x16x32_bf16 v[132:135], v[52:55], v[28:31], v[132:135]
ds_read_b64_tr_b16 v[94:95], v11 offset:12288
v_mfma_f32_16x16x32_bf16 v[136:139], v[56:59], v[28:31], v[136:139]
ds_read_b64_tr_b16 v[96:97], v12 offset:8192
v_mfma_f32_16x16x32_bf16 v[140:143], v[60:63], v[28:31], v[140:143]
ds_read_b64_tr_b16 v[98:99], v12 offset:12288
v_mfma_f32_16x16x32_bf16 v[144:147], v[64:67], v[28:31], v[144:147]
ds_read_b64_tr_b16 v[100:101], v13 offset:8192
v_mfma_f32_16x16x32_bf16 v[148:151], v[68:71], v[28:31], v[148:151]
ds_read_b64_tr_b16 v[102:103], v13 offset:12288
v_mfma_f32_16x16x32_bf16 v[152:155], v[72:75], v[28:31], v[152:155]
ds_read_b64_tr_b16 v[104:105], v14 offset:8192
v_mfma_f32_16x16x32_bf16 v[184:187], v[72:75], v[32:35], v[184:187]
ds_read_b64_tr_b16 v[106:107], v14 offset:12288
v_mfma_f32_16x16x32_bf16 v[180:183], v[68:71], v[32:35], v[180:183]
ds_read_b64_tr_b16 v[108:109], v11 offset:24576
v_mfma_f32_16x16x32_bf16 v[176:179], v[64:67], v[32:35], v[176:179]
ds_read_b64_tr_b16 v[110:111], v11 offset:28672
v_mfma_f32_16x16x32_bf16 v[172:175], v[60:63], v[32:35], v[172:175]
ds_read_b64_tr_b16 v[112:113], v12 offset:24576
v_mfma_f32_16x16x32_bf16 v[168:171], v[56:59], v[32:35], v[168:171]
ds_read_b64_tr_b16 v[114:115], v12 offset:28672
v_mfma_f32_16x16x32_bf16 v[164:167], v[52:55], v[32:35], v[164:167]
ds_read_b64_tr_b16 v[116:117], v13 offset:24576
v_mfma_f32_16x16x32_bf16 v[160:163], v[48:51], v[32:35], v[160:163]
ds_read_b64_tr_b16 v[118:119], v13 offset:28672
v_mfma_f32_16x16x32_bf16 v[156:159], v[44:47], v[32:35], v[156:159]
ds_read_b64_tr_b16 v[120:121], v14 offset:24576
v_mfma_f32_16x16x32_bf16 v[188:191], v[44:47], v[36:39], v[188:191]
ds_read_b64_tr_b16 v[122:123], v14 offset:28672
v_mfma_f32_16x16x32_bf16 v[192:195], v[48:51], v[36:39], v[192:195]
ds_read_b128 v[80:83], v9 offset:9216
v_mfma_f32_16x16x32_bf16 v[196:199], v[52:55], v[36:39], v[196:199]
ds_read_b128 v[84:87], v9 offset:10240
v_mfma_f32_16x16x32_bf16 v[200:203], v[56:59], v[36:39], v[200:203]
ds_read_b128 v[88:91], v9 offset:11264
v_mfma_f32_16x16x32_bf16 v[204:207], v[60:63], v[36:39], v[204:207]
v_mfma_f32_16x16x32_bf16 v[208:211], v[64:67], v[36:39], v[208:211]
v_mfma_f32_16x16x32_bf16 v[212:215], v[68:71], v[36:39], v[212:215]
v_mfma_f32_16x16x32_bf16 v[216:219], v[72:75], v[36:39], v[216:219]
v_mfma_f32_16x16x32_bf16 v[248:251], v[72:75], v[40:43], v[248:251]
v_mfma_f32_16x16x32_bf16 v[244:247], v[68:71], v[40:43], v[244:247]
v_mfma_f32_16x16x32_bf16 v[240:243], v[64:67], v[40:43], v[240:243]
v_mfma_f32_16x16x32_bf16 v[236:239], v[60:63], v[40:43], v[236:239]
v_mfma_f32_16x16x32_bf16 v[232:235], v[56:59], v[40:43], v[232:235]
v_mfma_f32_16x16x32_bf16 v[228:231], v[52:55], v[40:43], v[228:231]
v_mfma_f32_16x16x32_bf16 v[224:227], v[48:51], v[40:43], v[224:227]
v_mfma_f32_16x16x32_bf16 v[220:223], v[44:47], v[40:43], v[220:223]
s_waitcnt lgkmcnt(0)
s_barrier
v_mfma_f32_16x16x32_bf16 v[124:127], v[92:95], v[76:79], v[124:127]
ds_read_b128 v[28:31], v9 offset:49152
v_mfma_f32_16x16x32_bf16 v[128:131], v[96:99], v[76:79], v[128:131]
ds_read_b64_tr_b16 v[44:45], v15 offset:0
v_mfma_f32_16x16x32_bf16 v[132:135], v[100:103], v[76:79], v[132:135]
ds_read_b64_tr_b16 v[46:47], v15 offset:4096
v_mfma_f32_16x16x32_bf16 v[136:139], v[104:107], v[76:79], v[136:139]
ds_read_b64_tr_b16 v[48:49], v16 offset:0
v_mfma_f32_16x16x32_bf16 v[140:143], v[108:111], v[76:79], v[140:143]
ds_read_b64_tr_b16 v[50:51], v16 offset:4096
v_mfma_f32_16x16x32_bf16 v[144:147], v[112:115], v[76:79], v[144:147]
ds_read_b64_tr_b16 v[52:53], v17 offset:0
v_mfma_f32_16x16x32_bf16 v[148:151], v[116:119], v[76:79], v[148:151]
ds_read_b64_tr_b16 v[54:55], v17 offset:4096
v_mfma_f32_16x16x32_bf16 v[152:155], v[120:123], v[76:79], v[152:155]
ds_read_b64_tr_b16 v[56:57], v18 offset:0
v_mfma_f32_16x16x32_bf16 v[184:187], v[120:123], v[80:83], v[184:187]
ds_read_b64_tr_b16 v[58:59], v18 offset:4096
v_mfma_f32_16x16x32_bf16 v[180:183], v[116:119], v[80:83], v[180:183]
ds_read_b64_tr_b16 v[60:61], v15 offset:16384
v_mfma_f32_16x16x32_bf16 v[176:179], v[112:115], v[80:83], v[176:179]
ds_read_b64_tr_b16 v[62:63], v15 offset:20480
v_mfma_f32_16x16x32_bf16 v[172:175], v[108:111], v[80:83], v[172:175]
ds_read_b64_tr_b16 v[64:65], v16 offset:16384
v_mfma_f32_16x16x32_bf16 v[168:171], v[104:107], v[80:83], v[168:171]
ds_read_b64_tr_b16 v[66:67], v16 offset:20480
v_mfma_f32_16x16x32_bf16 v[164:167], v[100:103], v[80:83], v[164:167]
ds_read_b64_tr_b16 v[68:69], v17 offset:16384
v_mfma_f32_16x16x32_bf16 v[160:163], v[96:99], v[80:83], v[160:163]
ds_read_b64_tr_b16 v[70:71], v17 offset:20480
v_mfma_f32_16x16x32_bf16 v[156:159], v[92:95], v[80:83], v[156:159]
ds_read_b64_tr_b16 v[72:73], v18 offset:16384
v_mfma_f32_16x16x32_bf16 v[188:191], v[92:95], v[84:87], v[188:191]
ds_read_b64_tr_b16 v[74:75], v18 offset:20480
v_mfma_f32_16x16x32_bf16 v[192:195], v[96:99], v[84:87], v[192:195]
ds_read_b128 v[32:35], v9 offset:50176
v_mfma_f32_16x16x32_bf16 v[196:199], v[100:103], v[84:87], v[196:199]
ds_read_b128 v[36:39], v9 offset:51200
v_mfma_f32_16x16x32_bf16 v[200:203], v[104:107], v[84:87], v[200:203]
ds_read_b128 v[40:43], v9 offset:52224
v_mfma_f32_16x16x32_bf16 v[204:207], v[108:111], v[84:87], v[204:207]
v_mfma_f32_16x16x32_bf16 v[208:211], v[112:115], v[84:87], v[208:211]
v_mfma_f32_16x16x32_bf16 v[212:215], v[116:119], v[84:87], v[212:215]
v_mfma_f32_16x16x32_bf16 v[216:219], v[120:123], v[84:87], v[216:219]
v_mfma_f32_16x16x32_bf16 v[248:251], v[120:123], v[88:91], v[248:251]
v_mfma_f32_16x16x32_bf16 v[244:247], v[116:119], v[88:91], v[244:247]
v_mfma_f32_16x16x32_bf16 v[240:243], v[112:115], v[88:91], v[240:243]
v_mfma_f32_16x16x32_bf16 v[236:239], v[108:111], v[88:91], v[236:239]
v_mfma_f32_16x16x32_bf16 v[232:235], v[104:107], v[88:91], v[232:235]
v_mfma_f32_16x16x32_bf16 v[228:231], v[100:103], v[88:91], v[228:231]
v_mfma_f32_16x16x32_bf16 v[224:227], v[96:99], v[88:91], v[224:227]
v_mfma_f32_16x16x32_bf16 v[220:223], v[92:95], v[88:91], v[220:223]
s_waitcnt lgkmcnt(0)
v_mfma_f32_16x16x32_bf16 v[124:127], v[44:47], v[28:31], v[124:127]
ds_read_b128 v[76:79], v9 offset:57344
v_mfma_f32_16x16x32_bf16 v[128:131], v[48:51], v[28:31], v[128:131]
ds_read_b64_tr_b16 v[92:93], v15 offset:8192
v_mfma_f32_16x16x32_bf16 v[132:135], v[52:55], v[28:31], v[132:135]
ds_read_b64_tr_b16 v[94:95], v15 offset:12288
v_mfma_f32_16x16x32_bf16 v[136:139], v[56:59], v[28:31], v[136:139]
ds_read_b64_tr_b16 v[96:97], v16 offset:8192
v_mfma_f32_16x16x32_bf16 v[140:143], v[60:63], v[28:31], v[140:143]
ds_read_b64_tr_b16 v[98:99], v16 offset:12288
v_mfma_f32_16x16x32_bf16 v[144:147], v[64:67], v[28:31], v[144:147]
ds_read_b64_tr_b16 v[100:101], v17 offset:8192
v_mfma_f32_16x16x32_bf16 v[148:151], v[68:71], v[28:31], v[148:151]
ds_read_b64_tr_b16 v[102:103], v17 offset:12288
v_mfma_f32_16x16x32_bf16 v[152:155], v[72:75], v[28:31], v[152:155]
ds_read_b64_tr_b16 v[104:105], v18 offset:8192
v_mfma_f32_16x16x32_bf16 v[184:187], v[72:75], v[32:35], v[184:187]
ds_read_b64_tr_b16 v[106:107], v18 offset:12288
v_mfma_f32_16x16x32_bf16 v[180:183], v[68:71], v[32:35], v[180:183]
ds_read_b64_tr_b16 v[108:109], v15 offset:24576
v_mfma_f32_16x16x32_bf16 v[176:179], v[64:67], v[32:35], v[176:179]
ds_read_b64_tr_b16 v[110:111], v15 offset:28672
v_mfma_f32_16x16x32_bf16 v[172:175], v[60:63], v[32:35], v[172:175]
ds_read_b64_tr_b16 v[112:113], v16 offset:24576
v_mfma_f32_16x16x32_bf16 v[168:171], v[56:59], v[32:35], v[168:171]
ds_read_b64_tr_b16 v[114:115], v16 offset:28672
v_mfma_f32_16x16x32_bf16 v[164:167], v[52:55], v[32:35], v[164:167]
ds_read_b64_tr_b16 v[116:117], v17 offset:24576
v_mfma_f32_16x16x32_bf16 v[160:163], v[48:51], v[32:35], v[160:163]
ds_read_b64_tr_b16 v[118:119], v17 offset:28672
v_mfma_f32_16x16x32_bf16 v[156:159], v[44:47], v[32:35], v[156:159]
ds_read_b64_tr_b16 v[120:121], v18 offset:24576
v_mfma_f32_16x16x32_bf16 v[188:191], v[44:47], v[36:39], v[188:191]
ds_read_b64_tr_b16 v[122:123], v18 offset:28672
v_mfma_f32_16x16x32_bf16 v[192:195], v[48:51], v[36:39], v[192:195]
ds_read_b128 v[80:83], v9 offset:58368
v_mfma_f32_16x16x32_bf16 v[196:199], v[52:55], v[36:39], v[196:199]
ds_read_b128 v[84:87], v9 offset:59392
v_mfma_f32_16x16x32_bf16 v[200:203], v[56:59], v[36:39], v[200:203]
ds_read_b128 v[88:91], v9 offset:60416
v_mfma_f32_16x16x32_bf16 v[204:207], v[60:63], v[36:39], v[204:207]
v_mfma_f32_16x16x32_bf16 v[208:211], v[64:67], v[36:39], v[208:211]
v_mfma_f32_16x16x32_bf16 v[212:215], v[68:71], v[36:39], v[212:215]
v_mfma_f32_16x16x32_bf16 v[216:219], v[72:75], v[36:39], v[216:219]
v_mfma_f32_16x16x32_bf16 v[248:251], v[72:75], v[40:43], v[248:251]
v_mfma_f32_16x16x32_bf16 v[244:247], v[68:71], v[40:43], v[244:247]
v_mfma_f32_16x16x32_bf16 v[240:243], v[64:67], v[40:43], v[240:243]
v_mfma_f32_16x16x32_bf16 v[236:239], v[60:63], v[40:43], v[236:239]
v_mfma_f32_16x16x32_bf16 v[232:235], v[56:59], v[40:43], v[232:235]
v_mfma_f32_16x16x32_bf16 v[228:231], v[52:55], v[40:43], v[228:231]
v_mfma_f32_16x16x32_bf16 v[224:227], v[48:51], v[40:43], v[224:227]
v_mfma_f32_16x16x32_bf16 v[220:223], v[44:47], v[40:43], v[220:223]
s_waitcnt lgkmcnt(0)
s_barrier
v_mfma_f32_16x16x32_bf16 v[124:127], v[92:95], v[76:79], v[124:127]
ds_read_b128 v[28:31], v10 offset:0
v_mfma_f32_16x16x32_bf16 v[128:131], v[96:99], v[76:79], v[128:131]
ds_read_b64_tr_b16 v[44:45], v19 offset:0
v_mfma_f32_16x16x32_bf16 v[132:135], v[100:103], v[76:79], v[132:135]
ds_read_b64_tr_b16 v[46:47], v19 offset:4096
v_mfma_f32_16x16x32_bf16 v[136:139], v[104:107], v[76:79], v[136:139]
ds_read_b64_tr_b16 v[48:49], v20 offset:0
v_mfma_f32_16x16x32_bf16 v[140:143], v[108:111], v[76:79], v[140:143]
ds_read_b64_tr_b16 v[50:51], v20 offset:4096
v_mfma_f32_16x16x32_bf16 v[144:147], v[112:115], v[76:79], v[144:147]
ds_read_b64_tr_b16 v[52:53], v21 offset:0
v_mfma_f32_16x16x32_bf16 v[148:151], v[116:119], v[76:79], v[148:151]
ds_read_b64_tr_b16 v[54:55], v21 offset:4096
v_mfma_f32_16x16x32_bf16 v[152:155], v[120:123], v[76:79], v[152:155]
ds_read_b64_tr_b16 v[56:57], v22 offset:0
v_mfma_f32_16x16x32_bf16 v[184:187], v[120:123], v[80:83], v[184:187]
ds_read_b64_tr_b16 v[58:59], v22 offset:4096
v_mfma_f32_16x16x32_bf16 v[180:183], v[116:119], v[80:83], v[180:183]
ds_read_b64_tr_b16 v[60:61], v19 offset:16384
v_mfma_f32_16x16x32_bf16 v[176:179], v[112:115], v[80:83], v[176:179]
ds_read_b64_tr_b16 v[62:63], v19 offset:20480
v_mfma_f32_16x16x32_bf16 v[172:175], v[108:111], v[80:83], v[172:175]
ds_read_b64_tr_b16 v[64:65], v20 offset:16384
v_mfma_f32_16x16x32_bf16 v[168:171], v[104:107], v[80:83], v[168:171]
ds_read_b64_tr_b16 v[66:67], v20 offset:20480
v_mfma_f32_16x16x32_bf16 v[164:167], v[100:103], v[80:83], v[164:167]
ds_read_b64_tr_b16 v[68:69], v21 offset:16384
v_mfma_f32_16x16x32_bf16 v[160:163], v[96:99], v[80:83], v[160:163]
ds_read_b64_tr_b16 v[70:71], v21 offset:20480
v_mfma_f32_16x16x32_bf16 v[156:159], v[92:95], v[80:83], v[156:159]
ds_read_b64_tr_b16 v[72:73], v22 offset:16384
v_mfma_f32_16x16x32_bf16 v[188:191], v[92:95], v[84:87], v[188:191]
ds_read_b64_tr_b16 v[74:75], v22 offset:20480
v_mfma_f32_16x16x32_bf16 v[192:195], v[96:99], v[84:87], v[192:195]
ds_read_b128 v[32:35], v10 offset:1024
v_mfma_f32_16x16x32_bf16 v[196:199], v[100:103], v[84:87], v[196:199]
ds_read_b128 v[36:39], v10 offset:2048
v_mfma_f32_16x16x32_bf16 v[200:203], v[104:107], v[84:87], v[200:203]
ds_read_b128 v[40:43], v10 offset:3072
v_mfma_f32_16x16x32_bf16 v[204:207], v[108:111], v[84:87], v[204:207]
v_mfma_f32_16x16x32_bf16 v[208:211], v[112:115], v[84:87], v[208:211]
v_mfma_f32_16x16x32_bf16 v[212:215], v[116:119], v[84:87], v[212:215]
v_mfma_f32_16x16x32_bf16 v[216:219], v[120:123], v[84:87], v[216:219]
v_mfma_f32_16x16x32_bf16 v[248:251], v[120:123], v[88:91], v[248:251]
v_mfma_f32_16x16x32_bf16 v[244:247], v[116:119], v[88:91], v[244:247]
v_mfma_f32_16x16x32_bf16 v[240:243], v[112:115], v[88:91], v[240:243]
v_mfma_f32_16x16x32_bf16 v[236:239], v[108:111], v[88:91], v[236:239]
v_mfma_f32_16x16x32_bf16 v[232:235], v[104:107], v[88:91], v[232:235]
v_mfma_f32_16x16x32_bf16 v[228:231], v[100:103], v[88:91], v[228:231]
v_mfma_f32_16x16x32_bf16 v[224:227], v[96:99], v[88:91], v[224:227]
v_mfma_f32_16x16x32_bf16 v[220:223], v[92:95], v[88:91], v[220:223]
s_sub_u32 s41, s41, 1
s_cmp_lg_u32 s41, 0
s_cbranch_scc1 Lk3l_132
s_waitcnt lgkmcnt(0)
v_lshrrev_b32 v84, 4, v1
s_lshl_b32 s43, s63, 8
s_add_u32 s43, s43, 148480
v_lshl_add_u32 v85, v84, 4, s43
v_and_b32 v84, 15, v1
s_lshl_b32 s43, s62, 9
s_add_u32 s43, s43, 147456
v_lshl_add_u32 v84, v84, 3, s43
ds_read_b128 v[28:31], v85 offset:0
ds_read_b128 v[32:35], v85 offset:64
ds_read_b128 v[36:39], v85 offset:128
ds_read_b128 v[40:43], v85 offset:192
ds_read_b128 v[44:47], v85 offset:896
ds_read_b128 v[48:51], v85 offset:960
ds_read_b128 v[52:55], v85 offset:1024
ds_read_b128 v[56:59], v85 offset:1088
ds_read_b64 v[60:61], v84 offset:0
ds_read_b64 v[62:63], v84 offset:128
ds_read_b64 v[64:65], v84 offset:256
ds_read_b64 v[66:67], v84 offset:384
s_lshl_b32 s54, s35, 15
s_lshl_b32 s43, s63, 14
s_add_u32 s54, s54, s43
s_lshl_b32 s43, s62, 12
s_add_u32 s54, s54, s43
s_add_u32 s55, s54, 8192
v_lshrrev_b32 v122, 3, v1
v_and_b32 v123, 6, v122
v_and_b32 v25, 7, v1
v_xor_b32 v25, v25, v123
v_lshlrev_b32 v25, 4, v25
v_mul_u32_u24 v122, 2048, v122
v_add_u32 v25, v25, v122
s_lshl_b32 s43, s61, 7
s_lshl_b32 s44, s47, 15
s_add_u32 s43, s43, s44
v_add_u32 v25, s43, v25
s_waitcnt lgkmcnt(0)
s_barrier
s_add_u32 m0, s39, 81920
s_add_u32 s37, s52, 589824
buffer_load_dwordx4 v3, s[24:27], s37 offen sc1 lds
v_mul_f32 v70, v61, v61
v_mul_f32 v68, 0xc0135761, v61
v_mul_f32 v69, 0xbdd2d3e8, v61
v_mul_f32 v69, v69, v70
v_rcp_f32 v70, v70
v_mul_f32 v74, v63, v63
v_mul_f32 v72, 0xc0135761, v63
v_mul_f32 v73, 0xbdd2d3e8, v63
v_mul_f32 v73, v73, v74
v_rcp_f32 v74, v74
buffer_load_dwordx4 v3, s[24:27], s37 offen offset:1024 sc1 lds
v_fma_f32 v124, -v60, v28, v124
v_fma_f32 v125, -v60, v29, v125
v_fma_f32 v126, -v60, v30, v126
v_fma_f32 v127, -v60, v31, v127
v_fma_f32 v156, -v62, v28, v156
v_fma_f32 v157, -v62, v29, v157
v_fma_f32 v158, -v62, v30, v158
v_fma_f32 v159, -v62, v31, v159
v_mul_f32 v76, v124, v124
v_mul_f32 v77, v125, v125
buffer_load_dwordx4 v3, s[24:27], s37 offen offset:2048 sc1 lds
v_mul_f32 v78, v126, v126
v_mul_f32 v79, v127, v127
v_mul_f32 v80, v156, v156
v_mul_f32 v81, v157, v157
v_mul_f32 v82, v158, v158
v_mul_f32 v83, v159, v159
v_fma_f32 v76, v76, v69, v68
v_fma_f32 v77, v77, v69, v68
v_fma_f32 v78, v78, v69, v68
v_fma_f32 v79, v79, v69, v68
buffer_load_dwordx4 v3, s[24:27], s37 offen offset:3072 sc1 lds
v_fma_f32 v80, v80, v73, v72
v_fma_f32 v81, v81, v73, v72
v_fma_f32 v82, v82, v73, v72
v_fma_f32 v83, v83, v73, v72
v_mul_f32 v76, v76, v124
v_mul_f32 v77, v77, v125
v_mul_f32 v78, v78, v126
v_mul_f32 v79, v79, v127
v_mul_f32 v80, v80, v156
v_mul_f32 v81, v81, v157
s_add_u32 m0, s39, 147456
s_add_u32 s38, s53, 4718592
buffer_load_dwordx4 v23, s[28:31], s38 offen lds
v_mul_f32 v82, v82, v158
v_mul_f32 v83, v83, v159
v_exp_f32 v76, v76
v_exp_f32 v77, v77
v_exp_f32 v78, v78
v_exp_f32 v79, v79
v_exp_f32 v80, v80
v_exp_f32 v81, v81
v_exp_f32 v82, v82
v_exp_f32 v83, v83
s_add_u32 m0, s39, 148480
s_add_u32 s38, s53, 4718592
buffer_load_dwordx4 v24, s[28:31], s38 offen lds
v_fma_f32 v140, -v60, v44, v140
v_fma_f32 v141, -v60, v45, v141
v_fma_f32 v142, -v60, v46, v142
s_branch Lov_16
.p2align 12
.fill 128, 4, 0xbf800000
Lst_16_0:
s_branch Lwr_169
s_nop 0
s_nop 0
Lov_16:
v_fma_f32 v143, -v60, v47, v143
v_fma_f32 v172, -v62, v44, v172
v_fma_f32 v173, -v62, v45, v173
v_fma_f32 v174, -v62, v46, v174
v_fma_f32 v175, -v62, v47, v175
v_fma_f32 v76, v76, v70, v70
v_fma_f32 v77, v77, v70, v70
s_add_u32 m0, s39, 149504
s_add_u32 s38, s53, 4734976
buffer_load_dwordx4 v23, s[28:31], s38 offen lds
v_fma_f32 v78, v78, v70, v70
v_fma_f32 v79, v79, v70, v70
v_fma_f32 v80, v80, v74, v74
v_fma_f32 v81, v81, v74, v74
v_fma_f32 v82, v82, v74, v74
v_fma_f32 v83, v83, v74, v74
v_rcp_f32 v76, v76
v_rcp_f32 v77, v77
v_rcp_f32 v78, v78
v_rcp_f32 v79, v79
s_add_u32 m0, s39, 150528
s_add_u32 s38, s53, 4734976
buffer_load_dwordx4 v24, s[28:31], s38 offen lds
v_rcp_f32 v80, v80
v_rcp_f32 v81, v81
v_rcp_f32 v82, v82
v_rcp_f32 v83, v83
v_mul_f32 v140, v124, v140
v_mul_f32 v141, v125, v141
v_mul_f32 v142, v126, v142
v_mul_f32 v143, v127, v143
v_mul_f32 v172, v156, v172
v_mul_f32 v173, v157, v173
s_add_u32 m0, s39, 98304
s_add_u32 s37, s52, 606208
buffer_load_dwordx4 v3, s[24:27], s37 offen sc1 lds
v_mul_f32 v174, v158, v174
v_mul_f32 v175, v159, v175
v_mul_f32 v140, v140, v76
v_mul_f32 v141, v141, v77
v_mul_f32 v142, v142, v78
v_mul_f32 v143, v143, v79
v_mul_f32 v172, v172, v80
v_mul_f32 v173, v173, v81
v_mul_f32 v174, v174, v82
v_mul_f32 v175, v175, v83
buffer_load_dwordx4 v3, s[24:27], s37 offen offset:1024 sc1 lds
v_cvt_pk_bf16_f32 v124, v140, v141
v_cvt_pk_bf16_f32 v125, v142, v143
v_cvt_pk_bf16_f32 v156, v172, v173
v_cvt_pk_bf16_f32 v157, v174, v175
v_fma_f32 v128, -v60, v32, v128
v_fma_f32 v129, -v60, v33, v129
v_fma_f32 v130, -v60, v34, v130
v_fma_f32 v131, -v60, v35, v131
v_fma_f32 v160, -v62, v32, v160
v_fma_f32 v161, -v62, v33, v161
buffer_load_dwordx4 v3, s[24:27], s37 offen offset:2048 sc1 lds
v_fma_f32 v162, -v62, v34, v162
v_fma_f32 v163, -v62, v35, v163
v_mul_f32 v76, v128, v128
v_mul_f32 v77, v129, v129
v_mul_f32 v78, v130, v130
v_mul_f32 v79, v131, v131
v_mul_f32 v80, v160, v160
v_mul_f32 v81, v161, v161
v_mul_f32 v82, v162, v162
v_mul_f32 v83, v163, v163
buffer_load_dwordx4 v3, s[24:27], s37 offen offset:3072 sc1 lds
v_fma_f32 v76, v76, v69, v68
v_fma_f32 v77, v77, v69, v68
v_fma_f32 v78, v78, v69, v68
v_fma_f32 v79, v79, v69, v68
v_fma_f32 v80, v80, v73, v72
v_fma_f32 v81, v81, v73, v72
v_fma_f32 v82, v82, v73, v72
v_fma_f32 v83, v83, v73, v72
v_mul_f32 v76, v76, v128
v_mul_f32 v77, v77, v129
s_add_u32 m0, s39, 114688
s_add_u32 s38, s53, 4849664
buffer_load_dwordx4 v23, s[28:31], s38 offen lds
v_mul_f32 v78, v78, v130
v_mul_f32 v79, v79, v131
v_mul_f32 v80, v80, v160
v_mul_f32 v81, v81, v161
v_mul_f32 v82, v82, v162
v_mul_f32 v83, v83, v163
v_exp_f32 v76, v76
v_exp_f32 v77, v77
v_exp_f32 v78, v78
v_exp_f32 v79, v79
s_add_u32 m0, s39, 115712
s_add_u32 s38, s53, 4849664
buffer_load_dwordx4 v24, s[28:31], s38 offen lds
v_exp_f32 v80, v80
v_exp_f32 v81, v81
v_exp_f32 v82, v82
v_exp_f32 v83, v83
v_fma_f32 v144, -v60, v48, v144
v_fma_f32 v145, -v60, v49, v145
v_fma_f32 v146, -v60, v50, v146
v_fma_f32 v147, -v60, v51, v147
v_fma_f32 v176, -v62, v48, v176
v_fma_f32 v177, -v62, v49, v177
s_add_u32 m0, s39, 116736
s_add_u32 s38, s53, 4866048
buffer_load_dwordx4 v23, s[28:31], s38 offen lds
s_add_u32 m0, s39, 117760
s_add_u32 s38, s53, 4866048
buffer_load_dwordx4 v24, s[28:31], s38 offen lds
s_barrier
s_add_u32 m0, s39, 131072
s_add_u32 s37, s52, 622592
buffer_load_dwordx4 v3, s[24:27], s37 offen sc1 lds
v_fma_f32 v178, -v62, v50, v178
v_fma_f32 v179, -v62, v51, v179
v_fma_f32 v76, v76, v70, v70
v_fma_f32 v77, v77, v70, v70
v_fma_f32 v78, v78, v70, v70
v_fma_f32 v79, v79, v70, v70
v_fma_f32 v80, v80, v74, v74
v_fma_f32 v81, v81, v74, v74
v_fma_f32 v82, v82, v74, v74
v_fma_f32 v83, v83, v74, v74
v_rcp_f32 v76, v76
v_rcp_f32 v77, v77
v_rcp_f32 v78, v78
v_rcp_f32 v79, v79
v_rcp_f32 v80, v80
v_rcp_f32 v81, v81
v_rcp_f32 v82, v82
v_rcp_f32 v83, v83
v_mul_f32 v144, v128, v144
v_mul_f32 v145, v129, v145
v_mul_f32 v146, v130, v146
v_mul_f32 v147, v131, v147
v_mul_f32 v176, v160, v176
buffer_load_dwordx4 v3, s[24:27], s37 offen offset:1024 sc1 lds
v_mul_f32 v177, v161, v177
v_mul_f32 v178, v162, v178
v_mul_f32 v179, v163, v179
v_mul_f32 v144, v144, v76
v_mul_f32 v145, v145, v77
v_mul_f32 v146, v146, v78
v_mul_f32 v147, v147, v79
v_mul_f32 v176, v176, v80
v_mul_f32 v177, v177, v81
v_mul_f32 v178, v178, v82
v_mul_f32 v179, v179, v83
v_cvt_pk_bf16_f32 v126, v144, v145
v_cvt_pk_bf16_f32 v127, v146, v147
v_cvt_pk_bf16_f32 v158, v176, v177
v_cvt_pk_bf16_f32 v159, v178, v179
buffer_store_dwordx4 v[124:127], v2, s[24:27], s54 offen offset:0 sc1
buffer_store_dwordx4 v[156:159], v2, s[24:27], s54 offen offset:1024 sc1
v_fma_f32 v132, -v60, v36, v132
v_fma_f32 v133, -v60, v37, v133
v_fma_f32 v134, -v60, v38, v134
v_fma_f32 v135, -v60, v39, v135
v_fma_f32 v164, -v62, v36, v164
v_fma_f32 v165, -v62, v37, v165
buffer_load_dwordx4 v3, s[24:27], s37 offen offset:2048 sc1 lds
v_fma_f32 v166, -v62, v38, v166
v_fma_f32 v167, -v62, v39, v167
v_mul_f32 v76, v132, v132
v_mul_f32 v77, v133, v133
v_mul_f32 v78, v134, v134
v_mul_f32 v79, v135, v135
v_mul_f32 v80, v164, v164
v_mul_f32 v81, v165, v165
v_mul_f32 v82, v166, v166
v_mul_f32 v83, v167, v167
v_fma_f32 v76, v76, v69, v68
v_fma_f32 v77, v77, v69, v68
v_fma_f32 v78, v78, v69, v68
v_fma_f32 v79, v79, v69, v68
v_fma_f32 v80, v80, v73, v72
v_fma_f32 v81, v81, v73, v72
v_fma_f32 v82, v82, v73, v72
v_fma_f32 v83, v83, v73, v72
v_mul_f32 v76, v76, v132
v_mul_f32 v77, v77, v133
v_mul_f32 v78, v78, v134
v_mul_f32 v79, v79, v135
v_mul_f32 v80, v80, v164
v_mul_f32 v81, v81, v165
buffer_load_dwordx4 v3, s[24:27], s37 offen offset:3072 sc1 lds
v_mul_f32 v82, v82, v166
v_mul_f32 v83, v83, v167
v_exp_f32 v76, v76
v_exp_f32 v77, v77
v_exp_f32 v78, v78
v_exp_f32 v79, v79
v_exp_f32 v80, v80
v_exp_f32 v81, v81
v_exp_f32 v82, v82
v_exp_f32 v83, v83
v_fma_f32 v148, -v60, v52, v148
v_fma_f32 v149, -v60, v53, v149
v_fma_f32 v150, -v60, v54, v150
v_fma_f32 v151, -v60, v55, v151
v_fma_f32 v180, -v62, v52, v180
v_fma_f32 v181, -v62, v53, v181
v_fma_f32 v182, -v62, v54, v182
v_fma_f32 v183, -v62, v55, v183
v_fma_f32 v76, v76, v70, v70
v_fma_f32 v77, v77, v70, v70
v_fma_f32 v78, v78, v70, v70
v_fma_f32 v79, v79, v70, v70
v_fma_f32 v80, v80, v74, v74
s_add_u32 m0, s39, 0
s_add_u32 s38, s53, 4980736
buffer_load_dwordx4 v23, s[28:31], s38 offen lds
v_fma_f32 v81, v81, v74, v74
v_fma_f32 v82, v82, v74, v74
v_fma_f32 v83, v83, v74, v74
v_rcp_f32 v76, v76
v_rcp_f32 v77, v77
v_rcp_f32 v78, v78
v_rcp_f32 v79, v79
v_rcp_f32 v80, v80
v_rcp_f32 v81, v81
v_rcp_f32 v82, v82
v_rcp_f32 v83, v83
v_mul_f32 v148, v132, v148
v_mul_f32 v149, v133, v149
v_mul_f32 v150, v134, v150
v_mul_f32 v151, v135, v151
v_mul_f32 v180, v164, v180
v_mul_f32 v181, v165, v181
v_mul_f32 v182, v166, v182
v_mul_f32 v183, v167, v183
v_mul_f32 v148, v148, v76
v_mul_f32 v149, v149, v77
v_mul_f32 v150, v150, v78
v_mul_f32 v151, v151, v79
s_add_u32 m0, s39, 1024
s_add_u32 s38, s53, 4980736
buffer_load_dwordx4 v24, s[28:31], s38 offen lds
v_mul_f32 v180, v180, v80
v_mul_f32 v181, v181, v81
v_mul_f32 v182, v182, v82
v_mul_f32 v183, v183, v83
v_cvt_pk_bf16_f32 v132, v148, v149
v_cvt_pk_bf16_f32 v133, v150, v151
v_cvt_pk_bf16_f32 v164, v180, v181
v_cvt_pk_bf16_f32 v165, v182, v183
v_fma_f32 v136, -v60, v40, v136
v_fma_f32 v137, -v60, v41, v137
v_fma_f32 v138, -v60, v42, v138
v_fma_f32 v139, -v60, v43, v139
v_fma_f32 v168, -v62, v40, v168
v_fma_f32 v169, -v62, v41, v169
v_fma_f32 v170, -v62, v42, v170
v_fma_f32 v171, -v62, v43, v171
v_mul_f32 v76, v136, v136
v_mul_f32 v77, v137, v137
v_mul_f32 v78, v138, v138
v_mul_f32 v79, v139, v139
v_mul_f32 v80, v168, v168
v_mul_f32 v81, v169, v169
v_mul_f32 v82, v170, v170
v_mul_f32 v83, v171, v171
s_add_u32 m0, s39, 2048
s_add_u32 s38, s53, 4997120
buffer_load_dwordx4 v23, s[28:31], s38 offen lds
s_add_u32 m0, s39, 3072
s_add_u32 s38, s53, 4997120
buffer_load_dwordx4 v24, s[28:31], s38 offen lds
s_barrier
s_add_u32 m0, s39, 16384
s_add_u32 s37, s52, 638976
buffer_load_dwordx4 v3, s[24:27], s37 offen sc1 lds
v_fma_f32 v76, v76, v69, v68
v_fma_f32 v77, v77, v69, v68
v_fma_f32 v78, v78, v69, v68
v_fma_f32 v79, v79, v69, v68
v_fma_f32 v80, v80, v73, v72
v_fma_f32 v81, v81, v73, v72
v_fma_f32 v82, v82, v73, v72
v_fma_f32 v83, v83, v73, v72
v_mul_f32 v76, v76, v136
v_mul_f32 v77, v77, v137
v_mul_f32 v78, v78, v138
v_mul_f32 v79, v79, v139
v_mul_f32 v80, v80, v168
v_mul_f32 v81, v81, v169
v_mul_f32 v82, v82, v170
v_mul_f32 v83, v83, v171
v_exp_f32 v76, v76
v_exp_f32 v77, v77
v_exp_f32 v78, v78
v_exp_f32 v79, v79
v_exp_f32 v80, v80
v_exp_f32 v81, v81
v_exp_f32 v82, v82
buffer_load_dwordx4 v3, s[24:27], s37 offen offset:1024 sc1 lds
v_exp_f32 v83, v83
v_fma_f32 v152, -v60, v56, v152
v_fma_f32 v153, -v60, v57, v153
v_fma_f32 v154, -v60, v58, v154
v_fma_f32 v155, -v60, v59, v155
v_fma_f32 v184, -v62, v56, v184
v_fma_f32 v185, -v62, v57, v185
v_fma_f32 v186, -v62, v58, v186
v_fma_f32 v187, -v62, v59, v187
v_fma_f32 v76, v76, v70, v70
v_fma_f32 v77, v77, v70, v70
v_fma_f32 v78, v78, v70, v70
v_fma_f32 v79, v79, v70, v70
v_fma_f32 v80, v80, v74, v74
v_fma_f32 v81, v81, v74, v74
v_fma_f32 v82, v82, v74, v74
v_fma_f32 v83, v83, v74, v74
v_rcp_f32 v76, v76
v_rcp_f32 v77, v77
v_rcp_f32 v78, v78
v_rcp_f32 v79, v79
v_rcp_f32 v80, v80
v_rcp_f32 v81, v81
buffer_load_dwordx4 v3, s[24:27], s37 offen offset:2048 sc1 lds
v_rcp_f32 v82, v82
v_rcp_f32 v83, v83
v_mul_f32 v152, v136, v152
v_mul_f32 v153, v137, v153
v_mul_f32 v154, v138, v154
v_mul_f32 v155, v139, v155
v_mul_f32 v184, v168, v184
v_mul_f32 v185, v169, v185
v_mul_f32 v186, v170, v186
v_mul_f32 v187, v171, v187
v_mul_f32 v152, v152, v76
v_mul_f32 v153, v153, v77
v_mul_f32 v154, v154, v78
v_mul_f32 v155, v155, v79
v_mul_f32 v184, v184, v80
v_mul_f32 v185, v185, v81
v_mul_f32 v186, v186, v82
v_mul_f32 v187, v187, v83
v_cvt_pk_bf16_f32 v134, v152, v153
v_cvt_pk_bf16_f32 v135, v154, v155
v_cvt_pk_bf16_f32 v166, v184, v185
v_cvt_pk_bf16_f32 v167, v186, v187
buffer_store_dwordx4 v[132:135], v2, s[24:27], s55 offen offset:0 sc1
buffer_store_dwordx4 v[164:167], v2, s[24:27], s55 offen offset:1024 sc1
buffer_load_dwordx4 v3, s[24:27], s37 offen offset:3072 sc1 lds
v_mul_f32 v70, v65, v65
v_mul_f32 v68, 0xc0135761, v65
v_mul_f32 v69, 0xbdd2d3e8, v65
v_mul_f32 v69, v69, v70
v_rcp_f32 v70, v70
v_mul_f32 v74, v67, v67
v_mul_f32 v72, 0xc0135761, v67
v_mul_f32 v73, 0xbdd2d3e8, v67
v_mul_f32 v73, v73, v74
v_rcp_f32 v74, v74
v_fma_f32 v188, -v64, v28, v188
v_fma_f32 v189, -v64, v29, v189
v_fma_f32 v190, -v64, v30, v190
v_fma_f32 v191, -v64, v31, v191
v_fma_f32 v220, -v66, v28, v220
v_fma_f32 v221, -v66, v29, v221
v_fma_f32 v222, -v66, v30, v222
v_fma_f32 v223, -v66, v31, v223
v_mul_f32 v76, v188, v188
v_mul_f32 v77, v189, v189
v_mul_f32 v78, v190, v190
v_mul_f32 v79, v191, v191
v_mul_f32 v80, v220, v220
s_add_u32 m0, s39, 32768
s_add_u32 s38, s53, 5111808
buffer_load_dwordx4 v23, s[28:31], s38 offen lds
v_mul_f32 v81, v221, v221
v_mul_f32 v82, v222, v222
v_mul_f32 v83, v223, v223
v_fma_f32 v76, v76, v69, v68
v_fma_f32 v77, v77, v69, v68
v_fma_f32 v78, v78, v69, v68
v_fma_f32 v79, v79, v69, v68
v_fma_f32 v80, v80, v73, v72
v_fma_f32 v81, v81, v73, v72
v_fma_f32 v82, v82, v73, v72
v_fma_f32 v83, v83, v73, v72
v_mul_f32 v76, v76, v188
v_mul_f32 v77, v77, v189
v_mul_f32 v78, v78, v190
v_mul_f32 v79, v79, v191
v_mul_f32 v80, v80, v220
v_mul_f32 v81, v81, v221
v_mul_f32 v82, v82, v222
v_mul_f32 v83, v83, v223
v_exp_f32 v76, v76
v_exp_f32 v77, v77
v_exp_f32 v78, v78
v_exp_f32 v79, v79
s_add_u32 m0, s39, 33792
s_add_u32 s38, s53, 5111808
buffer_load_dwordx4 v24, s[28:31], s38 offen lds
v_exp_f32 v80, v80
v_exp_f32 v81, v81
v_exp_f32 v82, v82
v_exp_f32 v83, v83
v_fma_f32 v204, -v64, v44, v204
v_fma_f32 v205, -v64, v45, v205
v_fma_f32 v206, -v64, v46, v206
v_fma_f32 v207, -v64, v47, v207
v_fma_f32 v236, -v66, v44, v236
v_fma_f32 v237, -v66, v45, v237
v_fma_f32 v238, -v66, v46, v238
v_fma_f32 v239, -v66, v47, v239
v_fma_f32 v76, v76, v70, v70
v_fma_f32 v77, v77, v70, v70
v_fma_f32 v78, v78, v70, v70
v_fma_f32 v79, v79, v70, v70
v_fma_f32 v80, v80, v74, v74
v_fma_f32 v81, v81, v74, v74
v_fma_f32 v82, v82, v74, v74
v_fma_f32 v83, v83, v74, v74
v_rcp_f32 v76, v76
v_rcp_f32 v77, v77
v_rcp_f32 v78, v78
v_rcp_f32 v79, v79
s_add_u32 m0, s39, 34816
s_add_u32 s38, s53, 5128192
buffer_load_dwordx4 v23, s[28:31], s38 offen lds
s_add_u32 m0, s39, 35840
s_add_u32 s38, s53, 5128192
buffer_load_dwordx4 v24, s[28:31], s38 offen lds
s_waitcnt vmcnt(28)
s_barrier
s_add_u32 m0, s39, 49152
s_add_u32 s37, s52, 655360
buffer_load_dwordx4 v3, s[24:27], s37 offen sc1 lds
v_rcp_f32 v80, v80
v_rcp_f32 v81, v81
v_rcp_f32 v82, v82
v_rcp_f32 v83, v83
v_mul_f32 v204, v188, v204
v_mul_f32 v205, v189, v205
v_mul_f32 v206, v190, v206
v_mul_f32 v207, v191, v207
v_mul_f32 v236, v220, v236
v_mul_f32 v237, v221, v237
v_mul_f32 v238, v222, v238
v_mul_f32 v239, v223, v239
v_mul_f32 v204, v204, v76
v_mul_f32 v205, v205, v77
v_mul_f32 v206, v206, v78
v_mul_f32 v207, v207, v79
v_mul_f32 v236, v236, v80
v_mul_f32 v237, v237, v81
v_mul_f32 v238, v238, v82
v_mul_f32 v239, v239, v83
v_cvt_pk_bf16_f32 v188, v204, v205
v_cvt_pk_bf16_f32 v189, v206, v207
v_cvt_pk_bf16_f32 v220, v236, v237
buffer_load_dwordx4 v3, s[24:27], s37 offen offset:1024 sc1 lds
v_cvt_pk_bf16_f32 v221, v238, v239
v_fma_f32 v192, -v64, v32, v192
v_fma_f32 v193, -v64, v33, v193
v_fma_f32 v194, -v64, v34, v194
v_fma_f32 v195, -v64, v35, v195
v_fma_f32 v224, -v66, v32, v224
v_fma_f32 v225, -v66, v33, v225
v_fma_f32 v226, -v66, v34, v226
v_fma_f32 v227, -v66, v35, v227
v_mul_f32 v76, v192, v192
v_mul_f32 v77, v193, v193
v_mul_f32 v78, v194, v194
v_mul_f32 v79, v195, v195
v_mul_f32 v80, v224, v224
v_mul_f32 v81, v225, v225
v_mul_f32 v82, v226, v226
v_mul_f32 v83, v227, v227
v_fma_f32 v76, v76, v69, v68
v_fma_f32 v77, v77, v69, v68
v_fma_f32 v78, v78, v69, v68
v_fma_f32 v79, v79, v69, v68
v_fma_f32 v80, v80, v73, v72
v_fma_f32 v81, v81, v73, v72
buffer_load_dwordx4 v3, s[24:27], s37 offen offset:2048 sc1 lds
v_fma_f32 v82, v82, v73, v72
v_fma_f32 v83, v83, v73, v72
v_mul_f32 v76, v76, v192
v_mul_f32 v77, v77, v193
v_mul_f32 v78, v78, v194
v_mul_f32 v79, v79, v195
v_mul_f32 v80, v80, v224
v_mul_f32 v81, v81, v225
v_mul_f32 v82, v82, v226
v_mul_f32 v83, v83, v227
v_exp_f32 v76, v76
v_exp_f32 v77, v77
v_exp_f32 v78, v78
v_exp_f32 v79, v79
v_exp_f32 v80, v80
v_exp_f32 v81, v81
v_exp_f32 v82, v82
v_exp_f32 v83, v83
v_fma_f32 v208, -v64, v48, v208
v_fma_f32 v209, -v64, v49, v209
v_fma_f32 v210, -v64, v50, v210
v_fma_f32 v211, -v64, v51, v211
v_fma_f32 v240, -v66, v48, v240
v_fma_f32 v241, -v66, v49, v241
buffer_load_dwordx4 v3, s[24:27], s37 offen offset:3072 sc1 lds
v_fma_f32 v242, -v66, v50, v242
v_fma_f32 v243, -v66, v51, v243
v_fma_f32 v76, v76, v70, v70
v_fma_f32 v77, v77, v70, v70
v_fma_f32 v78, v78, v70, v70
v_fma_f32 v79, v79, v70, v70
v_fma_f32 v80, v80, v74, v74
v_fma_f32 v81, v81, v74, v74
v_fma_f32 v82, v82, v74, v74
v_fma_f32 v83, v83, v74, v74
v_rcp_f32 v76, v76
v_rcp_f32 v77, v77
v_rcp_f32 v78, v78
v_rcp_f32 v79, v79
v_rcp_f32 v80, v80
v_rcp_f32 v81, v81
v_rcp_f32 v82, v82
v_rcp_f32 v83, v83
v_mul_f32 v208, v192, v208
v_mul_f32 v209, v193, v209
v_mul_f32 v210, v194, v210
v_mul_f32 v211, v195, v211
v_mul_f32 v240, v224, v240
s_add_u32 m0, s39, 65536
s_add_u32 s38, s53, 5242880
buffer_load_dwordx4 v23, s[28:31], s38 offen lds
v_mul_f32 v241, v225, v241
v_mul_f32 v242, v226, v242
v_mul_f32 v243, v227, v243
v_mul_f32 v208, v208, v76
v_mul_f32 v209, v209, v77
v_mul_f32 v210, v210, v78
v_mul_f32 v211, v211, v79
v_mul_f32 v240, v240, v80
v_mul_f32 v241, v241, v81
v_mul_f32 v242, v242, v82
v_mul_f32 v243, v243, v83
v_cvt_pk_bf16_f32 v190, v208, v209
v_cvt_pk_bf16_f32 v191, v210, v211
v_cvt_pk_bf16_f32 v222, v240, v241
v_cvt_pk_bf16_f32 v223, v242, v243
buffer_store_dwordx4 v[188:191], v2, s[24:27], s54 offen offset:2048 sc1
buffer_store_dwordx4 v[220:223], v2, s[24:27], s54 offen offset:3072 sc1
v_fma_f32 v196, -v64, v36, v196
v_fma_f32 v197, -v64, v37, v197
v_fma_f32 v198, -v64, v38, v198
v_fma_f32 v199, -v64, v39, v199
v_fma_f32 v228, -v66, v36, v228
v_fma_f32 v229, -v66, v37, v229
s_add_u32 m0, s39, 66560
s_add_u32 s38, s53, 5242880
buffer_load_dwordx4 v24, s[28:31], s38 offen lds
v_fma_f32 v230, -v66, v38, v230
v_fma_f32 v231, -v66, v39, v231
v_mul_f32 v76, v196, v196
v_mul_f32 v77, v197, v197
v_mul_f32 v78, v198, v198
v_mul_f32 v79, v199, v199
v_mul_f32 v80, v228, v228
v_mul_f32 v81, v229, v229
v_mul_f32 v82, v230, v230
v_mul_f32 v83, v231, v231
v_fma_f32 v76, v76, v69, v68
v_fma_f32 v77, v77, v69, v68
v_fma_f32 v78, v78, v69, v68
v_fma_f32 v79, v79, v69, v68
v_fma_f32 v80, v80, v73, v72
v_fma_f32 v81, v81, v73, v72
v_fma_f32 v82, v82, v73, v72
v_fma_f32 v83, v83, v73, v72
v_mul_f32 v76, v76, v196
v_mul_f32 v77, v77, v197
v_mul_f32 v78, v78, v198
v_mul_f32 v79, v79, v199
v_mul_f32 v80, v80, v228
v_mul_f32 v81, v81, v229
s_add_u32 m0, s39, 67584
s_add_u32 s38, s53, 5259264
buffer_load_dwordx4 v23, s[28:31], s38 offen lds
s_add_u32 m0, s39, 68608
s_add_u32 s38, s53, 5259264
buffer_load_dwordx4 v24, s[28:31], s38 offen lds
s_waitcnt vmcnt(30)
s_barrier
s_branch Lov_17
.p2align 12
.fill 128, 4, 0xbf800000
Lst_17_0:
s_branch Lwr_170
s_nop 0
s_nop 0
Lov_17:
s_add_u32 m0, s39, 81920
s_add_u32 s37, s52, 671744
buffer_load_dwordx4 v3, s[24:27], s37 offen sc1 lds
v_mul_f32 v82, v82, v230
v_mul_f32 v83, v83, v231
v_exp_f32 v76, v76
v_exp_f32 v77, v77
v_exp_f32 v78, v78
v_exp_f32 v79, v79
v_exp_f32 v80, v80
v_exp_f32 v81, v81
v_exp_f32 v82, v82
v_exp_f32 v83, v83
v_fma_f32 v212, -v64, v52, v212
v_fma_f32 v213, -v64, v53, v213
v_fma_f32 v214, -v64, v54, v214
v_fma_f32 v215, -v64, v55, v215
v_fma_f32 v244, -v66, v52, v244
v_fma_f32 v245, -v66, v53, v245
v_fma_f32 v246, -v66, v54, v246
v_fma_f32 v247, -v66, v55, v247
v_fma_f32 v76, v76, v70, v70
v_fma_f32 v77, v77, v70, v70
v_fma_f32 v78, v78, v70, v70
v_fma_f32 v79, v79, v70, v70
v_fma_f32 v80, v80, v74, v74
buffer_load_dwordx4 v3, s[24:27], s37 offen offset:1024 sc1 lds
v_fma_f32 v81, v81, v74, v74
v_fma_f32 v82, v82, v74, v74
v_fma_f32 v83, v83, v74, v74
v_rcp_f32 v76, v76
v_rcp_f32 v77, v77
v_rcp_f32 v78, v78
v_rcp_f32 v79, v79
v_rcp_f32 v80, v80
v_rcp_f32 v81, v81
v_rcp_f32 v82, v82
v_rcp_f32 v83, v83
v_mul_f32 v212, v196, v212
v_mul_f32 v213, v197, v213
v_mul_f32 v214, v198, v214
v_mul_f32 v215, v199, v215
v_mul_f32 v244, v228, v244
v_mul_f32 v245, v229, v245
v_mul_f32 v246, v230, v246
v_mul_f32 v247, v231, v247
v_mul_f32 v212, v212, v76
v_mul_f32 v213, v213, v77
v_mul_f32 v214, v214, v78
v_mul_f32 v215, v215, v79
buffer_load_dwordx4 v3, s[24:27], s37 offen offset:2048 sc1 lds
v_mul_f32 v244, v244, v80
v_mul_f32 v245, v245, v81
v_mul_f32 v246, v246, v82
v_mul_f32 v247, v247, v83
v_cvt_pk_bf16_f32 v196, v212, v213
v_cvt_pk_bf16_f32 v197, v214, v215
v_cvt_pk_bf16_f32 v228, v244, v245
v_cvt_pk_bf16_f32 v229, v246, v247
v_fma_f32 v200, -v64, v40, v200
v_fma_f32 v201, -v64, v41, v201
v_fma_f32 v202, -v64, v42, v202
v_fma_f32 v203, -v64, v43, v203
v_fma_f32 v232, -v66, v40, v232
v_fma_f32 v233, -v66, v41, v233
v_fma_f32 v234, -v66, v42, v234
v_fma_f32 v235, -v66, v43, v235
v_mul_f32 v76, v200, v200
v_mul_f32 v77, v201, v201
v_mul_f32 v78, v202, v202
v_mul_f32 v79, v203, v203
v_mul_f32 v80, v232, v232
v_mul_f32 v81, v233, v233
v_mul_f32 v82, v234, v234
v_mul_f32 v83, v235, v235
buffer_load_dwordx4 v3, s[24:27], s37 offen offset:3072 sc1 lds
v_fma_f32 v76, v76, v69, v68
v_fma_f32 v77, v77, v69, v68
v_fma_f32 v78, v78, v69, v68
v_fma_f32 v79, v79, v69, v68
v_fma_f32 v80, v80, v73, v72
v_fma_f32 v81, v81, v73, v72
v_fma_f32 v82, v82, v73, v72
v_fma_f32 v83, v83, v73, v72
v_mul_f32 v76, v76, v200
v_mul_f32 v77, v77, v201
v_mul_f32 v78, v78, v202
v_mul_f32 v79, v79, v203
v_mul_f32 v80, v80, v232
v_mul_f32 v81, v81, v233
v_mul_f32 v82, v82, v234
v_mul_f32 v83, v83, v235
v_exp_f32 v76, v76
v_exp_f32 v77, v77
v_exp_f32 v78, v78
v_exp_f32 v79, v79
v_exp_f32 v80, v80
v_exp_f32 v81, v81
v_exp_f32 v82, v82
s_add_u32 m0, s39, 147456
s_add_u32 s38, s53, 5373952
buffer_load_dwordx4 v23, s[28:31], s38 offen lds
v_exp_f32 v83, v83
v_fma_f32 v216, -v64, v56, v216
v_fma_f32 v217, -v64, v57, v217
v_fma_f32 v218, -v64, v58, v218
v_fma_f32 v219, -v64, v59, v219
v_fma_f32 v248, -v66, v56, v248
v_fma_f32 v249, -v66, v57, v249
v_fma_f32 v250, -v66, v58, v250
v_fma_f32 v251, -v66, v59, v251
v_fma_f32 v76, v76, v70, v70
v_fma_f32 v77, v77, v70, v70
v_fma_f32 v78, v78, v70, v70
v_fma_f32 v79, v79, v70, v70
v_fma_f32 v80, v80, v74, v74
v_fma_f32 v81, v81, v74, v74
v_fma_f32 v82, v82, v74, v74
v_fma_f32 v83, v83, v74, v74
v_rcp_f32 v76, v76
v_rcp_f32 v77, v77
v_rcp_f32 v78, v78
v_rcp_f32 v79, v79
v_rcp_f32 v80, v80
v_rcp_f32 v81, v81
s_add_u32 m0, s39, 148480
s_add_u32 s38, s53, 5373952
buffer_load_dwordx4 v24, s[28:31], s38 offen lds
v_rcp_f32 v82, v82
v_rcp_f32 v83, v83
v_mul_f32 v216, v200, v216
v_mul_f32 v217, v201, v217
v_mul_f32 v218, v202, v218
v_mul_f32 v219, v203, v219
v_mul_f32 v248, v232, v248
v_mul_f32 v249, v233, v249
v_mul_f32 v250, v234, v250
v_mul_f32 v251, v235, v251
v_mul_f32 v216, v216, v76
v_mul_f32 v217, v217, v77
v_mul_f32 v218, v218, v78
v_mul_f32 v219, v219, v79
v_mul_f32 v248, v248, v80
v_mul_f32 v249, v249, v81
v_mul_f32 v250, v250, v82
v_mul_f32 v251, v251, v83
v_cvt_pk_bf16_f32 v198, v216, v217
v_cvt_pk_bf16_f32 v199, v218, v219
v_cvt_pk_bf16_f32 v230, v248, v249
v_cvt_pk_bf16_f32 v231, v250, v251
buffer_store_dwordx4 v[196:199], v2, s[24:27], s55 offen offset:2048 sc1
buffer_store_dwordx4 v[228:231], v2, s[24:27], s55 offen offset:3072 sc1
s_add_u32 m0, s39, 149504
s_add_u32 s38, s53, 5390336
buffer_load_dwordx4 v23, s[28:31], s38 offen lds
s_add_u32 m0, s39, 150528
s_add_u32 s38, s53, 5390336
buffer_load_dwordx4 v24, s[28:31], s38 offen lds
s_waitcnt vmcnt(30)
s_barrier
s_add_u32 m0, s39, 98304
s_add_u32 s37, s52, 688128
buffer_load_dwordx4 v3, s[24:27], s37 offen sc1 lds
buffer_load_dwordx4 v3, s[24:27], s37 offen offset:1024 sc1 lds
buffer_load_dwordx4 v3, s[24:27], s37 offen offset:2048 sc1 lds
buffer_load_dwordx4 v3, s[24:27], s37 offen offset:3072 sc1 lds
s_add_u32 m0, s39, 114688
s_add_u32 s38, s53, 5505024
buffer_load_dwordx4 v23, s[28:31], s38 offen lds
s_add_u32 m0, s39, 115712
s_add_u32 s38, s53, 5505024
buffer_load_dwordx4 v24, s[28:31], s38 offen lds
s_add_u32 m0, s39, 116736
s_add_u32 s38, s53, 5521408
buffer_load_dwordx4 v23, s[28:31], s38 offen lds
s_add_u32 m0, s39, 117760
s_add_u32 s38, s53, 5521408
buffer_load_dwordx4 v24, s[28:31], s38 offen lds
s_waitcnt vmcnt(10)
s_barrier
s_cmp_eq_u32 s47, 0
s_cbranch_scc0 Lw_133
s_add_u32 s7, s34, 48
s_lshl_b32 s7, s7, 7
v_mov_b32 v26, s7
v_mov_b32 v27, 1
s_mov_b64 exec, 1
buffer_atomic_add v27, v26, s[56:59], 0 offen sc1
s_mov_b64 exec, -1
Lw_133:
s_add_u32 m0, s39, 131072
s_add_u32 s37, s52, 704512
buffer_load_dwordx4 v3, s[24:27], s37 offen sc1 lds
buffer_load_dwordx4 v3, s[24:27], s37 offen offset:1024 sc1 lds
buffer_load_dwordx4 v3, s[24:27], s37 offen offset:2048 sc1 lds
buffer_load_dwordx4 v3, s[24:27], s37 offen offset:3072 sc1 lds
s_add_u32 m0, s39, 0
s_add_u32 s38, s53, 5636096
buffer_load_dwordx4 v23, s[28:31], s38 offen lds
s_add_u32 m0, s39, 1024
s_add_u32 s38, s53, 5636096
buffer_load_dwordx4 v24, s[28:31], s38 offen lds
s_add_u32 m0, s39, 2048
s_add_u32 s38, s53, 5652480
buffer_load_dwordx4 v23, s[28:31], s38 offen lds
s_add_u32 m0, s39, 3072
s_add_u32 s38, s53, 5652480
buffer_load_dwordx4 v24, s[28:31], s38 offen lds
s_waitcnt vmcnt(26)
s_barrier
s_add_u32 m0, s39, 32768
s_add_u32 s38, s91, 0
buffer_load_dwordx4 v23, s[28:31], s38 offen lds
s_add_u32 m0, s39, 33792
s_add_u32 s38, s91, 0
buffer_load_dwordx4 v24, s[28:31], s38 offen lds
s_add_u32 m0, s39, 34816
s_add_u32 s38, s91, 16384
buffer_load_dwordx4 v23, s[28:31], s38 offen lds
s_add_u32 m0, s39, 35840
s_add_u32 s38, s91, 16384
buffer_load_dwordx4 v24, s[28:31], s38 offen lds
s_waitcnt vmcnt(20)
s_barrier
s_add_u32 m0, s39, 65536
s_add_u32 s38, s91, 131072
buffer_load_dwordx4 v23, s[28:31], s38 offen lds
s_add_u32 m0, s39, 66560
s_add_u32 s38, s91, 131072
buffer_load_dwordx4 v24, s[28:31], s38 offen lds
s_add_u32 m0, s39, 67584
s_add_u32 s38, s91, 147456
buffer_load_dwordx4 v23, s[28:31], s38 offen lds
s_add_u32 m0, s39, 68608
s_add_u32 s38, s91, 147456
buffer_load_dwordx4 v24, s[28:31], s38 offen lds
s_waitcnt vmcnt(16)
s_barrier
s_cmp_eq_u32 s47, 3
s_cbranch_scc0 Lw_134
s_lshl_b32 s92, s34, 7
s_add_u32 s92, s92, 28317696
s_load_dword s93, s[82:83], s92 glc
Lw_134:
s_add_u32 m0, s39, 147456
s_add_u32 s38, s91, 262144
buffer_load_dwordx4 v23, s[28:31], s38 offen lds
s_add_u32 m0, s39, 148480
s_add_u32 s38, s91, 262144
buffer_load_dwordx4 v24, s[28:31], s38 offen lds
s_add_u32 m0, s39, 149504
s_add_u32 s38, s91, 278528
buffer_load_dwordx4 v23, s[28:31], s38 offen lds
s_add_u32 m0, s39, 150528
s_add_u32 s38, s91, 278528
buffer_load_dwordx4 v24, s[28:31], s38 offen lds
s_waitcnt vmcnt(12)
s_cmp_eq_u32 s47, 3
s_cbranch_scc0 Lw_135
s_mov_b32 s41, 0x40000
s_branch Lpchk_138
Lpoll_136:
s_load_dword s93, s[82:83], s92 glc
Lpchk_138:
s_waitcnt lgkmcnt(0)
s_cmp_eq_u32 s93, 16
s_cbranch_scc1 Lpok_137
s_sub_u32 s41, s41, 1
s_cmp_lg_u32 s41, 0
s_cbranch_scc1 Lpoll_136
Lpok_137:
Lw_135:
s_barrier
s_add_u32 m0, s39, 16384
s_add_u32 s37, s90, 0
buffer_load_dwordx4 v3, s[24:27], s37 offen sc1 lds
buffer_load_dwordx4 v3, s[24:27], s37 offen offset:1024 sc1 lds
buffer_load_dwordx4 v3, s[24:27], s37 offen offset:2048 sc1 lds
buffer_load_dwordx4 v3, s[24:27], s37 offen offset:3072 sc1 lds
s_add_u32 m0, s39, 49152
s_add_u32 s37, s90, 16384
buffer_load_dwordx4 v3, s[24:27], s37 offen sc1 lds
buffer_load_dwordx4 v3, s[24:27], s37 offen offset:1024 sc1 lds
buffer_load_dwordx4 v3, s[24:27], s37 offen offset:2048 sc1 lds
buffer_load_dwordx4 v3, s[24:27], s37 offen offset:3072 sc1 lds
s_add_u32 m0, s39, 81920
s_add_u32 s37, s90, 32768
buffer_load_dwordx4 v3, s[24:27], s37 offen sc1 lds
buffer_load_dwordx4 v3, s[24:27], s37 offen offset:1024 sc1 lds
buffer_load_dwordx4 v3, s[24:27], s37 offen offset:2048 sc1 lds
buffer_load_dwordx4 v3, s[24:27], s37 offen offset:3072 sc1 lds
s_add_u32 m0, s39, 98304
s_add_u32 s37, s90, 49152
buffer_load_dwordx4 v3, s[24:27], s37 offen sc1 lds
buffer_load_dwordx4 v3, s[24:27], s37 offen offset:1024 sc1 lds
buffer_load_dwordx4 v3, s[24:27], s37 offen offset:2048 sc1 lds
buffer_load_dwordx4 v3, s[24:27], s37 offen offset:3072 sc1 lds
s_add_u32 m0, s39, 114688
s_add_u32 s38, s91, 393216
buffer_load_dwordx4 v23, s[28:31], s38 offen lds
s_add_u32 m0, s39, 115712
s_add_u32 s38, s91, 393216
buffer_load_dwordx4 v24, s[28:31], s38 offen lds
s_add_u32 m0, s39, 116736
s_add_u32 s38, s91, 409600
buffer_load_dwordx4 v23, s[28:31], s38 offen lds
s_add_u32 m0, s39, 117760
s_add_u32 s38, s91, 409600
buffer_load_dwordx4 v24, s[28:31], s38 offen lds
s_waitcnt vmcnt(16)
s_barrier
s_add_u32 m0, s39, 131072
s_add_u32 s37, s90, 65536
buffer_load_dwordx4 v3, s[24:27], s37 offen sc1 lds
buffer_load_dwordx4 v3, s[24:27], s37 offen offset:1024 sc1 lds
buffer_load_dwordx4 v3, s[24:27], s37 offen offset:2048 sc1 lds
buffer_load_dwordx4 v3, s[24:27], s37 offen offset:3072 sc1 lds
s_add_u32 m0, s39, 0
s_add_u32 s38, s91, 524288
buffer_load_dwordx4 v23, s[28:31], s38 offen lds
s_add_u32 m0, s39, 1024
s_add_u32 s38, s91, 524288
buffer_load_dwordx4 v24, s[28:31], s38 offen lds
s_add_u32 m0, s39, 2048
s_add_u32 s38, s91, 540672
buffer_load_dwordx4 v23, s[28:31], s38 offen lds
s_add_u32 m0, s39, 3072
s_add_u32 s38, s91, 540672
buffer_load_dwordx4 v24, s[28:31], s38 offen lds
s_waitcnt vmcnt(20)
s_barrier
s_add_u32 m0, s39, 16384
s_add_u32 s37, s90, 81920
buffer_load_dwordx4 v3, s[24:27], s37 offen sc1 lds
buffer_load_dwordx4 v3, s[24:27], s37 offen offset:1024 sc1 lds
buffer_load_dwordx4 v3, s[24:27], s37 offen offset:2048 sc1 lds
buffer_load_dwordx4 v3, s[24:27], s37 offen offset:3072 sc1 lds
s_add_u32 m0, s39, 32768
s_add_u32 s38, s91, 655360
buffer_load_dwordx4 v23, s[28:31], s38 offen lds
s_add_u32 m0, s39, 33792
s_add_u32 s38, s91, 655360
buffer_load_dwordx4 v24, s[28:31], s38 offen lds
s_add_u32 m0, s39, 34816
s_add_u32 s38, s91, 671744
buffer_load_dwordx4 v23, s[28:31], s38 offen lds
s_add_u32 m0, s39, 35840
s_add_u32 s38, s91, 671744
buffer_load_dwordx4 v24, s[28:31], s38 offen lds
s_waitcnt vmcnt(24)
s_barrier
s_add_u32 m0, s39, 49152
s_add_u32 s37, s90, 98304
buffer_load_dwordx4 v3, s[24:27], s37 offen sc1 lds
buffer_load_dwordx4 v3, s[24:27], s37 offen offset:1024 sc1 lds
buffer_load_dwordx4 v3, s[24:27], s37 offen offset:2048 sc1 lds
buffer_load_dwordx4 v3, s[24:27], s37 offen offset:3072 sc1 lds
s_add_u32 m0, s39, 65536
s_add_u32 s38, s91, 786432
buffer_load_dwordx4 v23, s[28:31], s38 offen lds
s_add_u32 m0, s39, 66560
s_add_u32 s38, s91, 786432
buffer_load_dwordx4 v24, s[28:31], s38 offen lds
s_add_u32 m0, s39, 67584
s_add_u32 s38, s91, 802816
buffer_load_dwordx4 v23, s[28:31], s38 offen lds
s_add_u32 m0, s39, 68608
s_add_u32 s38, s91, 802816
buffer_load_dwordx4 v24, s[28:31], s38 offen lds
s_waitcnt vmcnt(24)
s_barrier
s_add_u32 m0, s39, 81920
s_add_u32 s37, s90, 114688
buffer_load_dwordx4 v3, s[24:27], s37 offen sc1 lds
buffer_load_dwordx4 v3, s[24:27], s37 offen offset:1024 sc1 lds
buffer_load_dwordx4 v3, s[24:27], s37 offen offset:2048 sc1 lds
buffer_load_dwordx4 v3, s[24:27], s37 offen offset:3072 sc1 lds
s_add_u32 m0, s39, 147456
s_add_u32 s38, s91, 917504
buffer_load_dwordx4 v23, s[28:31], s38 offen lds
s_add_u32 m0, s39, 148480
s_add_u32 s38, s91, 917504
buffer_load_dwordx4 v24, s[28:31], s38 offen lds
s_add_u32 m0, s39, 149504
s_add_u32 s38, s91, 933888
buffer_load_dwordx4 v23, s[28:31], s38 offen lds
s_add_u32 m0, s39, 150528
s_add_u32 s38, s91, 933888
buffer_load_dwordx4 v24, s[28:31], s38 offen lds
s_waitcnt vmcnt(24)
s_barrier
s_add_u32 m0, s39, 98304
s_add_u32 s37, s90, 131072
buffer_load_dwordx4 v3, s[24:27], s37 offen sc1 lds
buffer_load_dwordx4 v3, s[24:27], s37 offen offset:1024 sc1 lds
buffer_load_dwordx4 v3, s[24:27], s37 offen offset:2048 sc1 lds
buffer_load_dwordx4 v3, s[24:27], s37 offen offset:3072 sc1 lds
s_add_u32 m0, s39, 114688
s_add_u32 s38, s91, 1048576
buffer_load_dwordx4 v23, s[28:31], s38 offen lds
s_add_u32 m0, s39, 115712
s_add_u32 s38, s91, 1048576
buffer_load_dwordx4 v24, s[28:31], s38 offen lds
s_add_u32 m0, s39, 116736
s_add_u32 s38, s91, 1064960
buffer_load_dwordx4 v23, s[28:31], s38 offen lds
s_add_u32 m0, s39, 117760
s_add_u32 s38, s91, 1064960
buffer_load_dwordx4 v24, s[28:31], s38 offen lds
s_waitcnt vmcnt(24)
s_barrier
s_add_u32 m0, s39, 131072
s_add_u32 s37, s90, 147456
buffer_load_dwordx4 v3, s[24:27], s37 offen sc1 lds
buffer_load_dwordx4 v3, s[24:27], s37 offen offset:1024 sc1 lds
buffer_load_dwordx4 v3, s[24:27], s37 offen offset:2048 sc1 lds
buffer_load_dwordx4 v3, s[24:27], s37 offen offset:3072 sc1 lds
s_add_u32 m0, s39, 0
s_add_u32 s38, s91, 1179648
buffer_load_dwordx4 v23, s[28:31], s38 offen lds
s_add_u32 m0, s39, 1024
s_add_u32 s38, s91, 1179648
buffer_load_dwordx4 v24, s[28:31], s38 offen lds
s_add_u32 m0, s39, 2048
s_add_u32 s38, s91, 1196032
buffer_load_dwordx4 v23, s[28:31], s38 offen lds
s_add_u32 m0, s39, 3072
s_add_u32 s38, s91, 1196032
buffer_load_dwordx4 v24, s[28:31], s38 offen lds
s_waitcnt vmcnt(24)
s_barrier
s_add_u32 m0, s39, 16384
s_mov_b32 s37, 327680
buffer_load_dwordx4 v3, s[24:27], s37 offen sc1 lds
buffer_load_dwordx4 v3, s[24:27], s37 offen offset:1024 sc1 lds
buffer_load_dwordx4 v3, s[24:27], s37 offen offset:2048 sc1 lds
buffer_load_dwordx4 v3, s[24:27], s37 offen offset:3072 sc1 lds
s_add_u32 m0, s51, 32768
s_mov_b32 s38, 2621440
buffer_load_dwordx4 v25, s[28:31], s38 offen lds
s_add_u32 m0, s51, 33792
s_mov_b32 s38, 2637824
buffer_load_dwordx4 v25, s[28:31], s38 offen lds
s_waitcnt vmcnt(22)
s_barrier
s_add_u32 m0, s39, 49152
s_mov_b32 s37, 344064
buffer_load_dwordx4 v3, s[24:27], s37 offen sc1 lds
buffer_load_dwordx4 v3, s[24:27], s37 offen offset:1024 sc1 lds
buffer_load_dwordx4 v3, s[24:27], s37 offen offset:2048 sc1 lds
buffer_load_dwordx4 v3, s[24:27], s37 offen offset:3072 sc1 lds
s_add_u32 m0, s51, 65536
s_mov_b32 s38, 2752512
buffer_load_dwordx4 v25, s[28:31], s38 offen lds
s_add_u32 m0, s51, 66560
s_mov_b32 s38, 2768896
buffer_load_dwordx4 v25, s[28:31], s38 offen lds
s_waitcnt vmcnt(20)
s_barrier
s_add_u32 m0, s39, 81920
s_mov_b32 s37, 360448
buffer_load_dwordx4 v3, s[24:27], s37 offen sc1 lds
buffer_load_dwordx4 v3, s[24:27], s37 offen offset:1024 sc1 lds
buffer_load_dwordx4 v3, s[24:27], s37 offen offset:2048 sc1 lds
buffer_load_dwordx4 v3, s[24:27], s37 offen offset:3072 sc1 lds
s_add_u32 m0, s51, 147456
s_mov_b32 s38, 2883584
buffer_load_dwordx4 v25, s[28:31], s38 offen lds
s_add_u32 m0, s51, 148480
s_mov_b32 s38, 2899968
buffer_load_dwordx4 v25, s[28:31], s38 offen lds
s_waitcnt vmcnt(18)
s_barrier
s_add_u32 m0, s39, 98304
s_mov_b32 s37, 376832
buffer_load_dwordx4 v3, s[24:27], s37 offen sc1 lds
buffer_load_dwordx4 v3, s[24:27], s37 offen offset:1024 sc1 lds
buffer_load_dwordx4 v3, s[24:27], s37 offen offset:2048 sc1 lds
buffer_load_dwordx4 v3, s[24:27], s37 offen offset:3072 sc1 lds
s_add_u32 m0, s51, 114688
s_mov_b32 s38, 3014656
buffer_load_dwordx4 v25, s[28:31], s38 offen lds
s_add_u32 m0, s51, 115712
s_mov_b32 s38, 3031040
buffer_load_dwordx4 v25, s[28:31], s38 offen lds
s_waitcnt vmcnt(18)
s_barrier
s_add_u32 m0, s39, 131072
s_mov_b32 s37, 393216
buffer_load_dwordx4 v3, s[24:27], s37 offen sc1 lds
buffer_load_dwordx4 v3, s[24:27], s37 offen offset:1024 sc1 lds
buffer_load_dwordx4 v3, s[24:27], s37 offen offset:2048 sc1 lds
buffer_load_dwordx4 v3, s[24:27], s37 offen offset:3072 sc1 lds
s_add_u32 m0, s51, 0
s_mov_b32 s38, 3145728
buffer_load_dwordx4 v25, s[28:31], s38 offen lds
s_add_u32 m0, s51, 1024
s_mov_b32 s38, 3162112
buffer_load_dwordx4 v25, s[28:31], s38 offen lds
s_waitcnt vmcnt(18)
s_barrier
s_add_u32 m0, s39, 16384
s_mov_b32 s37, 409600
buffer_load_dwordx4 v3, s[24:27], s37 offen sc1 lds
buffer_load_dwordx4 v3, s[24:27], s37 offen offset:1024 sc1 lds
buffer_load_dwordx4 v3, s[24:27], s37 offen offset:2048 sc1 lds
buffer_load_dwordx4 v3, s[24:27], s37 offen offset:3072 sc1 lds
s_add_u32 m0, s51, 32768
s_mov_b32 s38, 3276800
buffer_load_dwordx4 v25, s[28:31], s38 offen lds
s_add_u32 m0, s51, 33792
s_mov_b32 s38, 3293184
buffer_load_dwordx4 v25, s[28:31], s38 offen lds
s_waitcnt vmcnt(18)
s_barrier
s_add_u32 m0, s39, 49152
s_mov_b32 s37, 425984
buffer_load_dwordx4 v3, s[24:27], s37 offen sc1 lds
buffer_load_dwordx4 v3, s[24:27], s37 offen offset:1024 sc1 lds
buffer_load_dwordx4 v3, s[24:27], s37 offen offset:2048 sc1 lds
buffer_load_dwordx4 v3, s[24:27], s37 offen offset:3072 sc1 lds
s_add_u32 m0, s51, 65536
s_mov_b32 s38, 3407872
buffer_load_dwordx4 v25, s[28:31], s38 offen lds
s_add_u32 m0, s51, 66560
s_branch Lov_18
.p2align 12
.fill 144, 4, 0xbf800000
Lst_18_0:
s_branch Lwr_171
s_nop 0
s_nop 0
Lov_18:
s_mov_b32 s38, 3424256
buffer_load_dwordx4 v25, s[28:31], s38 offen lds
s_waitcnt vmcnt(18)
s_barrier
s_add_u32 m0, s39, 81920
s_mov_b32 s37, 442368
buffer_load_dwordx4 v3, s[24:27], s37 offen sc1 lds
buffer_load_dwordx4 v3, s[24:27], s37 offen offset:1024 sc1 lds
buffer_load_dwordx4 v3, s[24:27], s37 offen offset:2048 sc1 lds
buffer_load_dwordx4 v3, s[24:27], s37 offen offset:3072 sc1 lds
s_add_u32 m0, s51, 147456
s_mov_b32 s38, 3538944
buffer_load_dwordx4 v25, s[28:31], s38 offen lds
s_add_u32 m0, s51, 148480
s_mov_b32 s38, 3555328
buffer_load_dwordx4 v25, s[28:31], s38 offen lds
s_waitcnt vmcnt(18)
s_barrier
s_add_u32 m0, s39, 98304
s_mov_b32 s37, 458752
buffer_load_dwordx4 v3, s[24:27], s37 offen sc1 lds
buffer_load_dwordx4 v3, s[24:27], s37 offen offset:1024 sc1 lds
buffer_load_dwordx4 v3, s[24:27], s37 offen offset:2048 sc1 lds
buffer_load_dwordx4 v3, s[24:27], s37 offen offset:3072 sc1 lds
s_add_u32 m0, s51, 114688
s_mov_b32 s38, 3670016
buffer_load_dwordx4 v25, s[28:31], s38 offen lds
s_add_u32 m0, s51, 115712
s_mov_b32 s38, 3686400
buffer_load_dwordx4 v25, s[28:31], s38 offen lds
s_waitcnt vmcnt(18)
s_barrier
s_add_u32 m0, s39, 131072
s_mov_b32 s37, 475136
buffer_load_dwordx4 v3, s[24:27], s37 offen sc1 lds
buffer_load_dwordx4 v3, s[24:27], s37 offen offset:1024 sc1 lds
buffer_load_dwordx4 v3, s[24:27], s37 offen offset:2048 sc1 lds
buffer_load_dwordx4 v3, s[24:27], s37 offen offset:3072 sc1 lds
s_add_u32 m0, s51, 0
s_mov_b32 s38, 3801088
buffer_load_dwordx4 v25, s[28:31], s38 offen lds
s_add_u32 m0, s51, 1024
s_mov_b32 s38, 3817472
buffer_load_dwordx4 v25, s[28:31], s38 offen lds
s_waitcnt vmcnt(18)
s_barrier
s_cmp_eq_u32 s47, 0
s_cbranch_scc0 Lw_139
s_xor_b32 s43, s2, 2
s_add_u32 s43, s43, 128
s_lshl_b32 s43, s43, 7
v_mov_b32 v26, s43
v_mov_b32 v27, 1
s_mov_b64 exec, 1
buffer_store_dword v27, v26, s[56:59], 0 offen sc1
s_mov_b64 exec, -1
Lw_139:
s_add_u32 m0, s39, 16384
s_mov_b32 s37, 491520
buffer_load_dwordx4 v3, s[24:27], s37 offen sc1 lds
buffer_load_dwordx4 v3, s[24:27], s37 offen offset:1024 sc1 lds
buffer_load_dwordx4 v3, s[24:27], s37 offen offset:2048 sc1 lds
buffer_load_dwordx4 v3, s[24:27], s37 offen offset:3072 sc1 lds
s_add_u32 m0, s51, 32768
s_mov_b32 s38, 3932160
buffer_load_dwordx4 v25, s[28:31], s38 offen lds
s_add_u32 m0, s51, 33792
s_mov_b32 s38, 3948544
buffer_load_dwordx4 v25, s[28:31], s38 offen lds
s_waitcnt vmcnt(18)
s_barrier
s_add_u32 m0, s39, 49152
s_mov_b32 s37, 507904
buffer_load_dwordx4 v3, s[24:27], s37 offen sc1 lds
buffer_load_dwordx4 v3, s[24:27], s37 offen offset:1024 sc1 lds
buffer_load_dwordx4 v3, s[24:27], s37 offen offset:2048 sc1 lds
buffer_load_dwordx4 v3, s[24:27], s37 offen offset:3072 sc1 lds
s_add_u32 m0, s51, 65536
s_mov_b32 s38, 4063232
buffer_load_dwordx4 v25, s[28:31], s38 offen lds
s_add_u32 m0, s51, 66560
s_mov_b32 s38, 4079616
buffer_load_dwordx4 v25, s[28:31], s38 offen lds
s_waitcnt vmcnt(18)
s_barrier
s_cmp_eq_u32 s47, 3
s_cbranch_scc0 Lw_140
s_lshl_b32 s92, s2, 7
s_add_u32 s92, s92, 28327936
s_load_dword s93, s[82:83], s92 glc
Lw_140:
s_waitcnt vmcnt(12)
s_cmp_eq_u32 s47, 3
s_cbranch_scc0 Lw_141
s_mov_b32 s41, 0x40000
s_branch Lpchk_144
Lpoll_142:
s_load_dword s93, s[82:83], s92 glc
Lpchk_144:
s_waitcnt lgkmcnt(0)
s_cmp_eq_u32 s93, 1
s_cbranch_scc1 Lpok_143
s_sub_u32 s41, s41, 1
s_cmp_lg_u32 s41, 0
s_cbranch_scc1 Lpoll_142
Lpok_143:
Lw_141:
s_barrier
s_waitcnt vmcnt(6)
s_barrier
s_waitcnt vmcnt(0)
s_barrier
s_barrier
s_branch Ldone_1
Ldone_1:
Lfin:
Lexit_2:
s_endpgm
.section .rodata,"a"
.p2align 6
.amdhsa_kernel sequential_preLN__sliding_local_dilated__glu_gated_geglu__prompt_kernel
  .amdhsa_next_free_vgpr 256
  .amdhsa_next_free_sgpr 100
  .amdhsa_accum_offset 256
  .amdhsa_group_segment_fixed_size 0
  .amdhsa_kernarg_size 80
  .amdhsa_user_sgpr_count 2
  .amdhsa_user_sgpr_kernarg_segment_ptr 1
  .amdhsa_system_sgpr_workgroup_id_x 1
  .amdhsa_float_denorm_mode_32 3
  .amdhsa_float_denorm_mode_16_64 3
.end_amdhsa_kernel
```

```asm
; @launch grid=(256,1,1) block=(512,1,1) lds=163840
.amdgcn_target "amdgcn-amd-amdhsa--gfx950"
.text
.globl sequential_preLN__sliding_local_dilated__glu_gated_geglu__prompt_kernel
.p2align 8
.type sequential_preLN__sliding_local_dilated__glu_gated_geglu__prompt_kernel,@function
sequential_preLN__sliding_local_dilated__glu_gated_geglu__prompt_kernel:
s_cmp_ge_u32 s2, 256
s_cbranch_scc1 Lexit_2
s_load_dwordx16 s[64:79], s[0:1], 0
s_load_dwordx4 s[80:83], s[0:1], 64
s_and_b32 s3, s2, 7
s_lshr_b32 s42, s2, 3
s_and_b32 s34, s3, 1
s_lshl_b32 s34, s34, 3
s_and_b32 s48, s42, 7
s_add_u32 s34, s34, s48
s_lshr_b32 s35, s3, 1
s_lshr_b32 s49, s42, 3
s_lshl_b32 s35, s35, 2
s_add_u32 s35, s35, s49
v_lshrrev_b32 v12, 6, v0
v_and_b32 v1, 63, v0
v_readfirstlane_b32 s36, v12
Lbeg:
s_lshl_b32 s50, s34, 7
s_sub_u32 s50, s50, 16
v_and_b32 v12, 15, v1
v_lshrrev_b32 v13, 4, v1
s_cmp_lt_u32 s36, 4
s_cbranch_scc1 Lcons_7
Lprod_3:
s_sub_u32 s47, s36, 4
s_lshl_b32 s43, s34, 7
s_lshl_b32 s44, s35, 3
s_add_u32 s63, s43, s44
s_lshl_b32 s44, s47, 1
s_add_u32 s51, s63, s44
v_lshlrev_b32 v10, 4, v1
s_and_b32 s43, s2, 7
s_lshr_b32 s44, s43, 2
s_lshl_b32 s44, s44, 1
s_and_b32 s45, s43, 1
s_add_u32 s44, s44, s45
s_lshr_b32 s45, s2, 3
s_lshl_b32 s45, s45, 2
s_add_u32 s44, s44, s45
s_add_u32 s44, s44, 96
s_bitcmp1_b32 s43, 1
s_cselect_b32 s44, s44, 0x10000
s_cmp_lt_u32 s2, 192
s_cselect_b32 s33, s2, s44
v_lshrrev_b32 v14, 3, v1
v_and_b32 v15, 7, v1
v_lshl_add_u32 v19, v14, 6, v15
s_lshl_b32 s43, s48, 3
v_add_u32 v19, s43, v19
v_mul_u32_u24 v19, 6144, v19
s_cmp_eq_u32 s47, 3
s_cbranch_scc1 Lpf_4
v_and_b32 v16, 2, v14
v_xor_b32 v16, v15, v16
v_lshlrev_b32 v16, 4, v16
v_mul_u32_u24 v17, 6144, v14
s_lshl_b32 s43, s47, 11
v_add3_u32 v2, v17, v16, s43
v_xor_b32 v3, 64, v2
v_lshrrev_b32 v16, 1, v14
v_xor_b32 v16, v15, v16
v_lshlrev_b32 v16, 4, v16
s_lshl_b32 s43, s47, 3
s_add_u32 s43, s43, s50
v_add_u32 v17, s43, v14
s_and_b32 s44, s47, 1
s_lshl_b32 s44, s44, 6
v_add_u32 v18, 0, v17
v_max_i32 v18, 0, v18
v_lshl_add_u32 v18, v18, 11, v16
v_xor_b32 v18, s44, v18
v_mov_b32 v4, v18
v_add_u32 v18, 24, v17
v_max_i32 v18, 0, v18
v_lshl_add_u32 v18, v18, 11, v16
v_xor_b32 v18, s44, v18
v_xor_b32 v5, 64, v18
v_add_u32 v18, 48, v17
v_max_i32 v18, 0, v18
v_lshl_add_u32 v18, v18, 11, v16
v_xor_b32 v18, s44, v18
v_mov_b32 v6, v18
v_add_u32 v18, 72, v17
v_max_i32 v18, 0, v18
v_lshl_add_u32 v18, v18, 11, v16
v_xor_b32 v18, s44, v18
v_xor_b32 v7, 64, v18
v_add_u32 v18, 96, v17
v_max_i32 v18, 0, v18
v_lshl_add_u32 v18, v18, 11, v16
v_xor_b32 v18, s44, v18
v_mov_b32 v8, v18
v_add_u32 v18, 120, v17
v_max_i32 v18, 0, v18
v_lshl_add_u32 v18, v18, 11, v16
v_xor_b32 v18, s44, v18
v_xor_b32 v9, 64, v18
s_lshl_b32 s39, s47, 10
s_lshl_b32 s40, s47, 13
s_add_u32 s40, s40, 18432
s_mov_b32 s37, 0
s_mov_b32 s38, 0
s_bfm_b64 s[60:61], 56, 8
s_cmp_eq_u32 s47, 0
s_cselect_b64 s[60:61], s[60:61], -1
s_lshl_b32 s43, s35, 7
s_waitcnt lgkmcnt(0)
s_mov_b32 s8, s64
s_mov_b32 s9, s65
s_mov_b32 s10, 4194304
s_mov_b32 s11, 0x20000
s_add_u32 s12, s66, s43
s_addc_u32 s13, s67, 0
s_mov_b32 s14, 6289536
s_mov_b32 s15, 0x20000
s_add_u32 m0, s39, 0
s_mov_b64 exec, s[60:61]
buffer_load_dwordx4 v4, s[8:11], s37 offen lds
s_mov_b64 exec, -1
s_add_u32 m0, s39, 3072
s_nop 0
buffer_load_dwordx4 v5, s[8:11], s37 offen lds
s_add_u32 m0, s39, 6144
s_nop 0
buffer_load_dwordx4 v6, s[8:11], s37 offen lds
s_add_u32 m0, s39, 9216
s_nop 0
buffer_load_dwordx4 v7, s[8:11], s37 offen lds
s_add_u32 m0, s39, 12288
s_nop 0
buffer_load_dwordx4 v8, s[8:11], s37 offen lds
s_add_u32 m0, s39, 15360
s_nop 0
buffer_load_dwordx4 v9, s[8:11], s37 offen lds
s_add_u32 m0, s40, 0
s_add_u32 s43, s38, 0
buffer_load_dwordx4 v2, s[12:15], s43 offen lds
s_add_u32 m0, s40, 1024
s_add_u32 s43, s38, 49152
buffer_load_dwordx4 v3, s[12:15], s43 offen lds
s_add_u32 m0, s40, 2048
s_add_u32 s43, s38, 98304
buffer_load_dwordx4 v2, s[12:15], s43 offen lds
s_add_u32 m0, s40, 3072
s_add_u32 s43, s38, 147456
buffer_load_dwordx4 v3, s[12:15], s43 offen lds
s_add_u32 m0, s40, 4096
s_add_u32 s43, s38, 196608
buffer_load_dwordx4 v2, s[12:15], s43 offen lds
s_add_u32 m0, s40, 5120
s_add_u32 s43, s38, 245760
buffer_load_dwordx4 v3, s[12:15], s43 offen lds
s_add_u32 m0, s40, 6144
s_add_u32 s43, s38, 294912
buffer_load_dwordx4 v2, s[12:15], s43 offen lds
s_add_u32 m0, s40, 7168
s_add_u32 s43, s38, 344064
buffer_load_dwordx4 v3, s[12:15], s43 offen lds
s_add_u32 s37, s37, 128
s_add_u32 s38, s38, 393216
s_mov_b32 s28, s66
s_mov_b32 s29, s67
s_mov_b32 s30, 6291456
s_mov_b32 s31, 0x20000
s_mul_i32 s43, s33, 3840
s_add_u32 s43, s43, 393216
v_lshlrev_b32 v30, 7, v1
s_mul_i32 s44, s47, 1280
s_add_u32 s43, s43, s44
s_bfm_b64 exec, 10, 0
buffer_load_dword v31, v30, s[28:31], s43 offen
s_mov_b64 exec, -1
s_lshl_b32 s43, s51, 11
buffer_load_dwordx4 v[96:99], v10, s[8:11], s43 offen offset:0
buffer_load_dwordx4 v[100:103], v10, s[8:11], s43 offen offset:1024
buffer_load_dwordx4 v[104:107], v10, s[8:11], s43 offen offset:2048
buffer_load_dwordx4 v[108:111], v10, s[8:11], s43 offen offset:3072
s_add_u32 m0, s39, 43008
s_mov_b64 exec, s[60:61]
buffer_load_dwordx4 v4, s[8:11], s37 offen lds
s_mov_b64 exec, -1
s_add_u32 m0, s39, 46080
s_nop 0
buffer_load_dwordx4 v5, s[8:11], s37 offen lds
s_add_u32 m0, s39, 49152
s_nop 0
buffer_load_dwordx4 v6, s[8:11], s37 offen lds
s_add_u32 m0, s39, 52224
s_nop 0
buffer_load_dwordx4 v7, s[8:11], s37 offen lds
s_add_u32 m0, s39, 55296
s_nop 0
buffer_load_dwordx4 v8, s[8:11], s37 offen lds
s_add_u32 m0, s39, 58368
s_nop 0
buffer_load_dwordx4 v9, s[8:11], s37 offen lds
s_add_u32 m0, s40, 43008
s_add_u32 s43, s38, 0
buffer_load_dwordx4 v2, s[12:15], s43 offen lds
s_add_u32 m0, s40, 44032
s_add_u32 s43, s38, 49152
buffer_load_dwordx4 v3, s[12:15], s43 offen lds
s_add_u32 m0, s40, 45056
s_add_u32 s43, s38, 98304
buffer_load_dwordx4 v2, s[12:15], s43 offen lds
s_add_u32 m0, s40, 46080
s_add_u32 s43, s38, 147456
buffer_load_dwordx4 v3, s[12:15], s43 offen lds
s_add_u32 m0, s40, 47104
s_add_u32 s43, s38, 196608
buffer_load_dwordx4 v2, s[12:15], s43 offen lds
s_add_u32 m0, s40, 48128
s_add_u32 s43, s38, 245760
buffer_load_dwordx4 v3, s[12:15], s43 offen lds
s_add_u32 m0, s40, 49152
s_add_u32 s43, s38, 294912
buffer_load_dwordx4 v2, s[12:15], s43 offen lds
s_add_u32 m0, s40, 50176
s_add_u32 s43, s38, 344064
buffer_load_dwordx4 v3, s[12:15], s43 offen lds
s_add_u32 s37, s37, 128
s_add_u32 s38, s38, 393216
s_waitcnt vmcnt(19)
s_barrier
s_add_u32 m0, s39, 86016
s_mov_b64 exec, s[60:61]
buffer_load_dwordx4 v4, s[8:11], s37 offen lds
s_mov_b64 exec, -1
s_add_u32 m0, s39, 89088
s_nop 0
buffer_load_dwordx4 v5, s[8:11], s37 offen lds
s_add_u32 m0, s39, 92160
s_nop 0
buffer_load_dwordx4 v6, s[8:11], s37 offen lds
s_add_u32 m0, s39, 95232
s_nop 0
buffer_load_dwordx4 v7, s[8:11], s37 offen lds
s_add_u32 m0, s39, 98304
s_nop 0
buffer_load_dwordx4 v8, s[8:11], s37 offen lds
s_add_u32 m0, s39, 101376
s_nop 0
buffer_load_dwordx4 v9, s[8:11], s37 offen lds
s_add_u32 m0, s40, 86016
s_add_u32 s43, s38, 0
buffer_load_dwordx4 v2, s[12:15], s43 offen lds
s_add_u32 m0, s40, 87040
s_add_u32 s43, s38, 49152
buffer_load_dwordx4 v3, s[12:15], s43 offen lds
s_add_u32 m0, s40, 88064
s_add_u32 s43, s38, 98304
buffer_load_dwordx4 v2, s[12:15], s43 offen lds
s_add_u32 m0, s40, 89088
s_add_u32 s43, s38, 147456
buffer_load_dwordx4 v3, s[12:15], s43 offen lds
s_add_u32 m0, s40, 90112
s_add_u32 s43, s38, 196608
buffer_load_dwordx4 v2, s[12:15], s43 offen lds
s_add_u32 m0, s40, 91136
s_add_u32 s43, s38, 245760
buffer_load_dwordx4 v3, s[12:15], s43 offen lds
s_add_u32 m0, s40, 92160
s_add_u32 s43, s38, 294912
buffer_load_dwordx4 v2, s[12:15], s43 offen lds
s_add_u32 m0, s40, 93184
s_add_u32 s43, s38, 344064
buffer_load_dwordx4 v3, s[12:15], s43 offen lds
s_add_u32 s37, s37, 128
s_add_u32 s38, s38, 393216
s_waitcnt vmcnt(28)
s_mov_b32 s43, 0x3f803f80
v_mov_b32 v116, 0
v_mov_b32 v117, 0
v_mov_b32 v118, 0
v_mov_b32 v119, 0
v_mov_b32 v120, 0
v_mov_b32 v121, 0
v_mov_b32 v122, 0
v_mov_b32 v123, 0
v_dot2_f32_bf16 v116, v96, s43, v116
v_dot2_f32_bf16 v120, v96, v96, v120
v_dot2_f32_bf16 v118, v104, s43, v118
v_dot2_f32_bf16 v122, v104, v104, v122
v_dot2_f32_bf16 v117, v97, s43, v117
v_dot2_f32_bf16 v121, v97, v97, v121
v_dot2_f32_bf16 v119, v105, s43, v119
v_dot2_f32_bf16 v123, v105, v105, v123
v_dot2_f32_bf16 v116, v98, s43, v116
v_dot2_f32_bf16 v120, v98, v98, v120
v_dot2_f32_bf16 v118, v106, s43, v118
v_dot2_f32_bf16 v122, v106, v106, v122
v_dot2_f32_bf16 v117, v99, s43, v117
v_dot2_f32_bf16 v121, v99, v99, v121
v_dot2_f32_bf16 v119, v107, s43, v119
v_dot2_f32_bf16 v123, v107, v107, v123
v_dot2_f32_bf16 v116, v100, s43, v116
v_dot2_f32_bf16 v120, v100, v100, v120
v_dot2_f32_bf16 v118, v108, s43, v118
v_dot2_f32_bf16 v122, v108, v108, v122
v_dot2_f32_bf16 v117, v101, s43, v117
v_dot2_f32_bf16 v121, v101, v101, v121
v_dot2_f32_bf16 v119, v109, s43, v119
v_dot2_f32_bf16 v123, v109, v109, v123
v_dot2_f32_bf16 v116, v102, s43, v116
v_dot2_f32_bf16 v120, v102, v102, v120
v_dot2_f32_bf16 v118, v110, s43, v118
v_dot2_f32_bf16 v122, v110, v110, v122
v_dot2_f32_bf16 v117, v103, s43, v117
v_dot2_f32_bf16 v121, v103, v103, v121
v_dot2_f32_bf16 v119, v111, s43, v119
v_dot2_f32_bf16 v123, v111, v111, v123
s_nop 2
v_add_f32 v116, v116, v117
v_add_f32 v118, v118, v119
v_add_f32 v120, v120, v121
v_add_f32 v122, v122, v123
s_nop 1
v_permlane32_swap_b32 v116, v118
v_permlane32_swap_b32 v120, v122
v_add_f32 v116, v116, v118
v_add_f32 v120, v120, v122
s_nop 1
v_permlane16_swap_b32 v116, v120
v_add_f32 v116, v116, v120
s_nop 1
v_add_f32_dpp v116, v116, v116 row_ror:8 row_mask:0xf bank_mask:0xf
s_nop 1
v_add_f32_dpp v116, v116, v116 row_ror:4 row_mask:0xf bank_mask:0xf
s_nop 1
v_add_f32_dpp v116, v116, v116 row_ror:2 row_mask:0xf bank_mask:0xf
s_nop 1
v_add_f32_dpp v116, v116, v116 row_ror:1 row_mask:0xf bank_mask:0xf
v_mov_b32 v117, v116
s_nop 1
v_permlane16_swap_b32 v116, v117
v_mul_f32 v112, 0x3a800000, v116
v_mul_f32 v113, 0x3a800000, v117
v_fma_f32 v113, -v112, v112, v113
v_max_f32 v113, 0, v113
v_add_f32 v113, 0x3727c5ac, v113
v_rsq_f32 v113, v113
v_lshrrev_b32 v11, 5, v1
s_lshl_b32 s43, s47, 4
s_add_u32 s43, s43, 148608
v_lshl_add_u32 v11, v11, 3, s43
ds_write_b64 v11, v[112:113]
s_waitcnt lgkmcnt(0)
s_and_b32 s44, s36, 3
s_mul_i32 s44, s44, 24
s_bfe_u32 s43, s2, 0x30001
s_lshl_b32 s43, s43, 7
s_add_u32 s44, s44, s43
s_mul_i32 s44, s44, 7168
s_lshr_b32 s43, s2, 4
s_lshl_b32 s43, s43, 8
s_add_u32 s43, s43, s44
s_bitcmp0_b32 s2, 0
s_cselect_b32 s4, s72, s74
s_cselect_b32 s5, s73, s75
s_add_u32 s4, s4, s43
s_addc_u32 s5, s5, 0
s_waitcnt vmcnt(14)
s_barrier
s_add_u32 m0, s39, 0
s_mov_b64 exec, s[60:61]
buffer_load_dwordx4 v4, s[8:11], s37 offen lds
s_mov_b64 exec, -1
s_add_u32 m0, s39, 3072
s_nop 0
buffer_load_dwordx4 v5, s[8:11], s37 offen lds
s_add_u32 m0, s39, 6144
s_nop 0
buffer_load_dwordx4 v6, s[8:11], s37 offen lds
s_add_u32 m0, s39, 9216
s_nop 0
buffer_load_dwordx4 v7, s[8:11], s37 offen lds
s_add_u32 m0, s39, 12288
s_nop 0
buffer_load_dwordx4 v8, s[8:11], s37 offen lds
s_add_u32 m0, s39, 15360
s_nop 0
buffer_load_dwordx4 v9, s[8:11], s37 offen lds
s_add_u32 m0, s40, 0
s_add_u32 s43, s38, 0
buffer_load_dwordx4 v2, s[12:15], s43 offen lds
s_add_u32 m0, s40, 1024
s_add_u32 s43, s38, 49152
buffer_load_dwordx4 v3, s[12:15], s43 offen lds
s_add_u32 m0, s40, 2048
s_add_u32 s43, s38, 98304
buffer_load_dwordx4 v2, s[12:15], s43 offen lds
s_add_u32 m0, s40, 3072
s_add_u32 s43, s38, 147456
buffer_load_dwordx4 v3, s[12:15], s43 offen lds
s_add_u32 m0, s40, 4096
s_add_u32 s43, s38, 196608
buffer_load_dwordx4 v2, s[12:15], s43 offen lds
s_add_u32 m0, s40, 5120
s_add_u32 s43, s38, 245760
buffer_load_dwordx4 v3, s[12:15], s43 offen lds
s_add_u32 m0, s40, 6144
s_add_u32 s43, s38, 294912
buffer_load_dwordx4 v2, s[12:15], s43 offen lds
s_add_u32 m0, s40, 7168
s_add_u32 s43, s38, 344064
buffer_load_dwordx4 v3, s[12:15], s43 offen lds
s_add_u32 s37, s37, 128
s_add_u32 s38, s38, 393216
s_waitcnt vmcnt(14)
s_barrier
s_add_u32 m0, s39, 43008
s_mov_b64 exec, s[60:61]
buffer_load_dwordx4 v4, s[8:11], s37 offen lds
s_mov_b64 exec, -1
s_add_u32 m0, s39, 46080
s_nop 0
buffer_load_dwordx4 v5, s[8:11], s37 offen lds
s_add_u32 m0, s39, 49152
s_nop 0
buffer_load_dwordx4 v6, s[8:11], s37 offen lds
s_add_u32 m0, s39, 52224
s_nop 0
buffer_load_dwordx4 v7, s[8:11], s37 offen lds
s_add_u32 m0, s39, 55296
s_nop 0
buffer_load_dwordx4 v8, s[8:11], s37 offen lds
s_add_u32 m0, s39, 58368
s_nop 0
buffer_load_dwordx4 v9, s[8:11], s37 offen lds
s_add_u32 m0, s40, 43008
s_add_u32 s43, s38, 0
buffer_load_dwordx4 v2, s[12:15], s43 offen lds
s_add_u32 m0, s40, 44032
s_add_u32 s43, s38, 49152
buffer_load_dwordx4 v3, s[12:15], s43 offen lds
s_add_u32 m0, s40, 45056
s_add_u32 s43, s38, 98304
buffer_load_dwordx4 v2, s[12:15], s43 offen lds
s_add_u32 m0, s40, 46080
s_add_u32 s43, s38, 147456
buffer_load_dwordx4 v3, s[12:15], s43 offen lds
s_add_u32 m0, s40, 47104
s_add_u32 s43, s38, 196608
buffer_load_dwordx4 v2, s[12:15], s43 offen lds
s_add_u32 m0, s40, 48128
s_add_u32 s43, s38, 245760
buffer_load_dwordx4 v3, s[12:15], s43 offen lds
s_add_u32 m0, s40, 49152
s_add_u32 s43, s38, 294912
buffer_load_dwordx4 v2, s[12:15], s43 offen lds
s_add_u32 m0, s40, 50176
s_add_u32 s43, s38, 344064
buffer_load_dwordx4 v3, s[12:15], s43 offen lds
s_add_u32 s37, s37, 128
s_add_u32 s38, s38, 393216
s_load_dword s3, s[4:5], 0
s_load_dword s3, s[4:5], 64
s_load_dword s3, s[4:5], 128
s_waitcnt vmcnt(14)
s_barrier
s_add_u32 m0, s39, 86016
s_mov_b64 exec, s[60:61]
buffer_load_dwordx4 v4, s[8:11], s37 offen lds
s_mov_b64 exec, -1
s_add_u32 m0, s39, 89088
s_nop 0
buffer_load_dwordx4 v5, s[8:11], s37 offen lds
s_add_u32 m0, s39, 92160
s_nop 0
buffer_load_dwordx4 v6, s[8:11], s37 offen lds
s_add_u32 m0, s39, 95232
s_nop 0
buffer_load_dwordx4 v7, s[8:11], s37 offen lds
s_add_u32 m0, s39, 98304
s_nop 0
buffer_load_dwordx4 v8, s[8:11], s37 offen lds
s_add_u32 m0, s39, 101376
s_nop 0
buffer_load_dwordx4 v9, s[8:11], s37 offen lds
s_add_u32 m0, s40, 86016
s_add_u32 s43, s38, 0
buffer_load_dwordx4 v2, s[12:15], s43 offen lds
s_add_u32 m0, s40, 87040
s_add_u32 s43, s38, 49152
buffer_load_dwordx4 v3, s[12:15], s43 offen lds
s_add_u32 m0, s40, 88064
s_add_u32 s43, s38, 98304
buffer_load_dwordx4 v2, s[12:15], s43 offen lds
s_add_u32 m0, s40, 89088
s_add_u32 s43, s38, 147456
buffer_load_dwordx4 v3, s[12:15], s43 offen lds
s_add_u32 m0, s40, 90112
s_add_u32 s43, s38, 196608
buffer_load_dwordx4 v2, s[12:15], s43 offen lds
s_add_u32 m0, s40, 91136
s_add_u32 s43, s38, 245760
buffer_load_dwordx4 v3, s[12:15], s43 offen lds
s_add_u32 m0, s40, 92160
s_add_u32 s43, s38, 294912
buffer_load_dwordx4 v2, s[12:15], s43 offen lds
s_add_u32 m0, s40, 93184
s_add_u32 s43, s38, 344064
buffer_load_dwordx4 v3, s[12:15], s43 offen lds
s_add_u32 s37, s37, 128
s_add_u32 s38, s38, 393216
s_load_dword s3, s[4:5], 192
s_load_dword s3, s[4:5], 7168
s_load_dword s3, s[4:5], 7232
s_load_dword s3, s[4:5], 7296
s_waitcnt vmcnt(14)
s_barrier
s_add_u32 m0, s39, 0
s_mov_b64 exec, s[60:61]
buffer_load_dwordx4 v4, s[8:11], s37 offen lds
s_mov_b64 exec, -1
s_add_u32 m0, s39, 3072
s_nop 0
buffer_load_dwordx4 v5, s[8:11], s37 offen lds
s_add_u32 m0, s39, 6144
s_nop 0
buffer_load_dwordx4 v6, s[8:11], s37 offen lds
s_branch Lov_0
.p2align 12
Lst_0_0:
s_branch Lwr_145
s_nop 0
s_nop 0
Lov_0:
s_add_u32 m0, s39, 9216
s_nop 0
buffer_load_dwordx4 v7, s[8:11], s37 offen lds
s_add_u32 m0, s39, 12288
s_nop 0
buffer_load_dwordx4 v8, s[8:11], s37 offen lds
s_add_u32 m0, s39, 15360
s_nop 0
buffer_load_dwordx4 v9, s[8:11], s37 offen lds
s_add_u32 m0, s40, 0
s_add_u32 s43, s38, 0
buffer_load_dwordx4 v2, s[12:15], s43 offen lds
s_add_u32 m0, s40, 1024
s_add_u32 s43, s38, 49152
buffer_load_dwordx4 v3, s[12:15], s43 offen lds
s_add_u32 m0, s40, 2048
s_add_u32 s43, s38, 98304
buffer_load_dwordx4 v2, s[12:15], s43 offen lds
s_add_u32 m0, s40, 3072
s_add_u32 s43, s38, 147456
buffer_load_dwordx4 v3, s[12:15], s43 offen lds
s_add_u32 m0, s40, 4096
s_add_u32 s43, s38, 196608
buffer_load_dwordx4 v2, s[12:15], s43 offen lds
s_add_u32 m0, s40, 5120
s_add_u32 s43, s38, 245760
buffer_load_dwordx4 v3, s[12:15], s43 offen lds
s_add_u32 m0, s40, 6144
s_add_u32 s43, s38, 294912
buffer_load_dwordx4 v2, s[12:15], s43 offen lds
s_add_u32 m0, s40, 7168
s_add_u32 s43, s38, 344064
buffer_load_dwordx4 v3, s[12:15], s43 offen lds
s_add_u32 s37, s37, 128
s_add_u32 s38, s38, 393216
s_load_dword s3, s[4:5], 7360
s_load_dword s3, s[4:5], 14336
s_load_dword s3, s[4:5], 14400
s_load_dword s3, s[4:5], 14464
s_load_dword s3, s[4:5], 14528
s_waitcnt vmcnt(14)
s_barrier
s_add_u32 m0, s39, 43008
s_mov_b64 exec, s[60:61]
buffer_load_dwordx4 v4, s[8:11], s37 offen lds
s_mov_b64 exec, -1
s_add_u32 m0, s39, 46080
s_nop 0
buffer_load_dwordx4 v5, s[8:11], s37 offen lds
s_add_u32 m0, s39, 49152
s_nop 0
buffer_load_dwordx4 v6, s[8:11], s37 offen lds
s_add_u32 m0, s39, 52224
s_nop 0
buffer_load_dwordx4 v7, s[8:11], s37 offen lds
s_add_u32 m0, s39, 55296
s_nop 0
buffer_load_dwordx4 v8, s[8:11], s37 offen lds
s_add_u32 m0, s39, 58368
s_nop 0
buffer_load_dwordx4 v9, s[8:11], s37 offen lds
s_add_u32 m0, s40, 43008
s_add_u32 s43, s38, 0
buffer_load_dwordx4 v2, s[12:15], s43 offen lds
s_add_u32 m0, s40, 44032
s_add_u32 s43, s38, 49152
buffer_load_dwordx4 v3, s[12:15], s43 offen lds
s_add_u32 m0, s40, 45056
s_add_u32 s43, s38, 98304
buffer_load_dwordx4 v2, s[12:15], s43 offen lds
s_add_u32 m0, s40, 46080
s_add_u32 s43, s38, 147456
buffer_load_dwordx4 v3, s[12:15], s43 offen lds
s_add_u32 m0, s40, 47104
s_add_u32 s43, s38, 196608
buffer_load_dwordx4 v2, s[12:15], s43 offen lds
s_add_u32 m0, s40, 48128
s_add_u32 s43, s38, 245760
buffer_load_dwordx4 v3, s[12:15], s43 offen lds
s_add_u32 m0, s40, 49152
s_add_u32 s43, s38, 294912
buffer_load_dwordx4 v2, s[12:15], s43 offen lds
s_add_u32 m0, s40, 50176
s_add_u32 s43, s38, 344064
buffer_load_dwordx4 v3, s[12:15], s43 offen lds
s_add_u32 s37, s37, 128
s_add_u32 s38, s38, 393216
s_load_dword s3, s[4:5], 21504
s_load_dword s3, s[4:5], 21568
s_load_dword s3, s[4:5], 21632
s_load_dword s3, s[4:5], 21696
s_load_dword s3, s[4:5], 28672
s_load_dword s3, s[4:5], 28736
s_waitcnt vmcnt(14)
s_barrier
s_add_u32 m0, s39, 86016
s_mov_b64 exec, s[60:61]
buffer_load_dwordx4 v4, s[8:11], s37 offen lds
s_mov_b64 exec, -1
s_add_u32 m0, s39, 89088
s_nop 0
buffer_load_dwordx4 v5, s[8:11], s37 offen lds
s_add_u32 m0, s39, 92160
s_nop 0
buffer_load_dwordx4 v6, s[8:11], s37 offen lds
s_add_u32 m0, s39, 95232
s_nop 0
buffer_load_dwordx4 v7, s[8:11], s37 offen lds
s_add_u32 m0, s39, 98304
s_nop 0
buffer_load_dwordx4 v8, s[8:11], s37 offen lds
s_add_u32 m0, s39, 101376
s_nop 0
buffer_load_dwordx4 v9, s[8:11], s37 offen lds
s_add_u32 m0, s40, 86016
s_add_u32 s43, s38, 0
buffer_load_dwordx4 v2, s[12:15], s43 offen lds
s_add_u32 m0, s40, 87040
s_add_u32 s43, s38, 49152
buffer_load_dwordx4 v3, s[12:15], s43 offen lds
s_add_u32 m0, s40, 88064
s_add_u32 s43, s38, 98304
buffer_load_dwordx4 v2, s[12:15], s43 offen lds
s_add_u32 m0, s40, 89088
s_add_u32 s43, s38, 147456
buffer_load_dwordx4 v3, s[12:15], s43 offen lds
s_add_u32 m0, s40, 90112
s_add_u32 s43, s38, 196608
buffer_load_dwordx4 v2, s[12:15], s43 offen lds
s_add_u32 m0, s40, 91136
s_add_u32 s43, s38, 245760
buffer_load_dwordx4 v3, s[12:15], s43 offen lds
s_add_u32 m0, s40, 92160
s_add_u32 s43, s38, 294912
buffer_load_dwordx4 v2, s[12:15], s43 offen lds
s_add_u32 m0, s40, 93184
s_add_u32 s43, s38, 344064
buffer_load_dwordx4 v3, s[12:15], s43 offen lds
s_add_u32 s37, s37, 128
s_add_u32 s38, s38, 393216
s_load_dword s3, s[4:5], 28800
s_load_dword s3, s[4:5], 28864
s_load_dword s3, s[4:5], 35840
s_load_dword s3, s[4:5], 35904
s_load_dword s3, s[4:5], 35968
s_load_dword s3, s[4:5], 36032
s_load_dword s3, s[4:5], 43008
s_waitcnt vmcnt(14)
s_barrier
s_add_u32 m0, s39, 0
s_mov_b64 exec, s[60:61]
buffer_load_dwordx4 v4, s[8:11], s37 offen lds
s_mov_b64 exec, -1
s_add_u32 m0, s39, 3072
s_nop 0
buffer_load_dwordx4 v5, s[8:11], s37 offen lds
s_add_u32 m0, s39, 6144
s_nop 0
buffer_load_dwordx4 v6, s[8:11], s37 offen lds
s_add_u32 m0, s39, 9216
s_nop 0
buffer_load_dwordx4 v7, s[8:11], s37 offen lds
s_add_u32 m0, s39, 12288
s_nop 0
buffer_load_dwordx4 v8, s[8:11], s37 offen lds
s_add_u32 m0, s39, 15360
s_nop 0
buffer_load_dwordx4 v9, s[8:11], s37 offen lds
s_add_u32 m0, s40, 0
s_add_u32 s43, s38, 0
buffer_load_dwordx4 v2, s[12:15], s43 offen lds
s_add_u32 m0, s40, 1024
s_add_u32 s43, s38, 49152
buffer_load_dwordx4 v3, s[12:15], s43 offen lds
s_add_u32 m0, s40, 2048
s_add_u32 s43, s38, 98304
buffer_load_dwordx4 v2, s[12:15], s43 offen lds
s_add_u32 m0, s40, 3072
s_add_u32 s43, s38, 147456
buffer_load_dwordx4 v3, s[12:15], s43 offen lds
s_add_u32 m0, s40, 4096
s_add_u32 s43, s38, 196608
buffer_load_dwordx4 v2, s[12:15], s43 offen lds
s_add_u32 m0, s40, 5120
s_add_u32 s43, s38, 245760
buffer_load_dwordx4 v3, s[12:15], s43 offen lds
s_add_u32 m0, s40, 6144
s_add_u32 s43, s38, 294912
buffer_load_dwordx4 v2, s[12:15], s43 offen lds
s_add_u32 m0, s40, 7168
s_add_u32 s43, s38, 344064
buffer_load_dwordx4 v3, s[12:15], s43 offen lds
s_add_u32 s37, s37, 128
s_add_u32 s38, s38, 393216
s_load_dword s3, s[4:5], 43072
s_load_dword s3, s[4:5], 43136
s_load_dword s3, s[4:5], 43200
s_load_dword s3, s[4:5], 50176
s_load_dword s3, s[4:5], 50240
s_load_dword s3, s[4:5], 50304
s_load_dword s3, s[4:5], 50368
s_load_dword s3, s[4:5], 57344
s_waitcnt vmcnt(14)
s_barrier
s_add_u32 m0, s39, 43008
s_mov_b64 exec, s[60:61]
buffer_load_dwordx4 v4, s[8:11], s37 offen lds
s_mov_b64 exec, -1
s_add_u32 m0, s39, 46080
s_nop 0
buffer_load_dwordx4 v5, s[8:11], s37 offen lds
s_add_u32 m0, s39, 49152
s_nop 0
buffer_load_dwordx4 v6, s[8:11], s37 offen lds
s_add_u32 m0, s39, 52224
s_nop 0
buffer_load_dwordx4 v7, s[8:11], s37 offen lds
s_add_u32 m0, s39, 55296
s_nop 0
buffer_load_dwordx4 v8, s[8:11], s37 offen lds
s_add_u32 m0, s39, 58368
s_nop 0
buffer_load_dwordx4 v9, s[8:11], s37 offen lds
s_add_u32 m0, s40, 43008
s_add_u32 s43, s38, 0
buffer_load_dwordx4 v2, s[12:15], s43 offen lds
s_add_u32 m0, s40, 44032
s_add_u32 s43, s38, 49152
buffer_load_dwordx4 v3, s[12:15], s43 offen lds
s_add_u32 m0, s40, 45056
s_add_u32 s43, s38, 98304
buffer_load_dwordx4 v2, s[12:15], s43 offen lds
s_add_u32 m0, s40, 46080
s_add_u32 s43, s38, 147456
buffer_load_dwordx4 v3, s[12:15], s43 offen lds
s_add_u32 m0, s40, 47104
s_add_u32 s43, s38, 196608
buffer_load_dwordx4 v2, s[12:15], s43 offen lds
s_add_u32 m0, s40, 48128
s_add_u32 s43, s38, 245760
buffer_load_dwordx4 v3, s[12:15], s43 offen lds
s_add_u32 m0, s40, 49152
s_add_u32 s43, s38, 294912
buffer_load_dwordx4 v2, s[12:15], s43 offen lds
s_add_u32 m0, s40, 50176
s_add_u32 s43, s38, 344064
buffer_load_dwordx4 v3, s[12:15], s43 offen lds
s_add_u32 s37, s37, 128
s_add_u32 s38, s38, 393216
s_load_dword s3, s[4:5], 57408
s_load_dword s3, s[4:5], 57472
s_load_dword s3, s[4:5], 57536
s_load_dword s3, s[4:5], 64512
s_load_dword s3, s[4:5], 64576
s_load_dword s3, s[4:5], 64640
s_load_dword s3, s[4:5], 64704
s_load_dword s3, s[4:5], 71680
s_load_dword s3, s[4:5], 71744
s_waitcnt vmcnt(14)
s_barrier
s_add_u32 m0, s39, 86016
s_mov_b64 exec, s[60:61]
buffer_load_dwordx4 v4, s[8:11], s37 offen lds
s_mov_b64 exec, -1
s_add_u32 m0, s39, 89088
s_nop 0
buffer_load_dwordx4 v5, s[8:11], s37 offen lds
s_add_u32 m0, s39, 92160
s_nop 0
buffer_load_dwordx4 v6, s[8:11], s37 offen lds
s_add_u32 m0, s39, 95232
s_nop 0
buffer_load_dwordx4 v7, s[8:11], s37 offen lds
s_add_u32 m0, s39, 98304
s_nop 0
buffer_load_dwordx4 v8, s[8:11], s37 offen lds
s_add_u32 m0, s39, 101376
s_nop 0
buffer_load_dwordx4 v9, s[8:11], s37 offen lds
s_add_u32 m0, s40, 86016
s_add_u32 s43, s38, 0
buffer_load_dwordx4 v2, s[12:15], s43 offen lds
s_add_u32 m0, s40, 87040
s_add_u32 s43, s38, 49152
buffer_load_dwordx4 v3, s[12:15], s43 offen lds
s_add_u32 m0, s40, 88064
s_add_u32 s43, s38, 98304
buffer_load_dwordx4 v2, s[12:15], s43 offen lds
s_add_u32 m0, s40, 89088
s_add_u32 s43, s38, 147456
buffer_load_dwordx4 v3, s[12:15], s43 offen lds
s_add_u32 m0, s40, 90112
s_add_u32 s43, s38, 196608
buffer_load_dwordx4 v2, s[12:15], s43 offen lds
s_add_u32 m0, s40, 91136
s_add_u32 s43, s38, 245760
buffer_load_dwordx4 v3, s[12:15], s43 offen lds
s_add_u32 m0, s40, 92160
s_add_u32 s43, s38, 294912
buffer_load_dwordx4 v2, s[12:15], s43 offen lds
s_add_u32 m0, s40, 93184
s_add_u32 s43, s38, 344064
buffer_load_dwordx4 v3, s[12:15], s43 offen lds
s_add_u32 s37, s37, 128
s_add_u32 s38, s38, 393216
s_load_dword s3, s[4:5], 71808
s_load_dword s3, s[4:5], 71872
s_load_dword s3, s[4:5], 78848
s_load_dword s3, s[4:5], 78912
s_load_dword s3, s[4:5], 78976
s_load_dword s3, s[4:5], 79040
s_load_dword s3, s[4:5], 86016
s_load_dword s3, s[4:5], 86080
s_load_dword s3, s[4:5], 86144
s_waitcnt vmcnt(14)
s_barrier
s_add_u32 m0, s39, 0
s_mov_b64 exec, s[60:61]
buffer_load_dwordx4 v4, s[8:11], s37 offen lds
s_mov_b64 exec, -1
s_add_u32 m0, s39, 3072
s_nop 0
buffer_load_dwordx4 v5, s[8:11], s37 offen lds
s_add_u32 m0, s39, 6144
s_nop 0
buffer_load_dwordx4 v6, s[8:11], s37 offen lds
s_add_u32 m0, s39, 9216
s_nop 0
buffer_load_dwordx4 v7, s[8:11], s37 offen lds
s_add_u32 m0, s39, 12288
s_nop 0
buffer_load_dwordx4 v8, s[8:11], s37 offen lds
s_add_u32 m0, s39, 15360
s_nop 0
buffer_load_dwordx4 v9, s[8:11], s37 offen lds
s_add_u32 m0, s40, 0
s_add_u32 s43, s38, 0
buffer_load_dwordx4 v2, s[12:15], s43 offen lds
s_add_u32 m0, s40, 1024
s_add_u32 s43, s38, 49152
buffer_load_dwordx4 v3, s[12:15], s43 offen lds
s_add_u32 m0, s40, 2048
s_add_u32 s43, s38, 98304
buffer_load_dwordx4 v2, s[12:15], s43 offen lds
s_add_u32 m0, s40, 3072
s_add_u32 s43, s38, 147456
buffer_load_dwordx4 v3, s[12:15], s43 offen lds
s_add_u32 m0, s40, 4096
s_add_u32 s43, s38, 196608
buffer_load_dwordx4 v2, s[12:15], s43 offen lds
s_add_u32 m0, s40, 5120
s_add_u32 s43, s38, 245760
buffer_load_dwordx4 v3, s[12:15], s43 offen lds
s_add_u32 m0, s40, 6144
s_add_u32 s43, s38, 294912
buffer_load_dwordx4 v2, s[12:15], s43 offen lds
s_add_u32 m0, s40, 7168
s_add_u32 s43, s38, 344064
buffer_load_dwordx4 v3, s[12:15], s43 offen lds
s_add_u32 s37, s37, 128
s_add_u32 s38, s38, 393216
s_load_dword s3, s[4:5], 86208
s_load_dword s3, s[4:5], 93184
s_load_dword s3, s[4:5], 93248
s_load_dword s3, s[4:5], 93312
s_load_dword s3, s[4:5], 93376
s_load_dword s3, s[4:5], 100352
s_load_dword s3, s[4:5], 100416
s_load_dword s3, s[4:5], 100480
s_load_dword s3, s[4:5], 100544
s_waitcnt vmcnt(14)
s_barrier
s_add_u32 m0, s39, 43008
s_mov_b64 exec, s[60:61]
buffer_load_dwordx4 v4, s[8:11], s37 offen lds
s_mov_b64 exec, -1
s_add_u32 m0, s39, 46080
s_nop 0
buffer_load_dwordx4 v5, s[8:11], s37 offen lds
s_add_u32 m0, s39, 49152
s_nop 0
buffer_load_dwordx4 v6, s[8:11], s37 offen lds
s_add_u32 m0, s39, 52224
s_nop 0
buffer_load_dwordx4 v7, s[8:11], s37 offen lds
s_add_u32 m0, s39, 55296
s_nop 0
buffer_load_dwordx4 v8, s[8:11], s37 offen lds
s_add_u32 m0, s39, 58368
s_nop 0
buffer_load_dwordx4 v9, s[8:11], s37 offen lds
s_add_u32 m0, s40, 43008
s_add_u32 s43, s38, 0
buffer_load_dwordx4 v2, s[12:15], s43 offen lds
s_add_u32 m0, s40, 44032
s_add_u32 s43, s38, 49152
buffer_load_dwordx4 v3, s[12:15], s43 offen lds
s_add_u32 m0, s40, 45056
s_add_u32 s43, s38, 98304
buffer_load_dwordx4 v2, s[12:15], s43 offen lds
s_add_u32 m0, s40, 46080
s_add_u32 s43, s38, 147456
buffer_load_dwordx4 v3, s[12:15], s43 offen lds
s_add_u32 m0, s40, 47104
s_add_u32 s43, s38, 196608
buffer_load_dwordx4 v2, s[12:15], s43 offen lds
s_add_u32 m0, s40, 48128
s_add_u32 s43, s38, 245760
buffer_load_dwordx4 v3, s[12:15], s43 offen lds
s_add_u32 m0, s40, 49152
s_add_u32 s43, s38, 294912
buffer_load_dwordx4 v2, s[12:15], s43 offen lds
s_add_u32 m0, s40, 50176
s_add_u32 s43, s38, 344064
buffer_load_dwordx4 v3, s[12:15], s43 offen lds
s_add_u32 s37, s37, 128
s_add_u32 s38, s38, 393216
s_load_dword s3, s[4:5], 107520
s_load_dword s3, s[4:5], 107584
s_load_dword s3, s[4:5], 107648
s_load_dword s3, s[4:5], 107712
s_load_dword s3, s[4:5], 114688
s_load_dword s3, s[4:5], 114752
s_load_dword s3, s[4:5], 114816
s_load_dword s3, s[4:5], 114880
s_load_dword s3, s[4:5], 121856
s_waitcnt vmcnt(14)
s_barrier
s_add_u32 m0, s39, 86016
s_mov_b64 exec, s[60:61]
buffer_load_dwordx4 v4, s[8:11], s37 offen lds
s_mov_b64 exec, -1
s_add_u32 m0, s39, 89088
s_nop 0
buffer_load_dwordx4 v5, s[8:11], s37 offen lds
s_add_u32 m0, s39, 92160
s_nop 0
buffer_load_dwordx4 v6, s[8:11], s37 offen lds
s_add_u32 m0, s39, 95232
s_nop 0
buffer_load_dwordx4 v7, s[8:11], s37 offen lds
s_add_u32 m0, s39, 98304
s_nop 0
buffer_load_dwordx4 v8, s[8:11], s37 offen lds
s_add_u32 m0, s39, 101376
s_nop 0
buffer_load_dwordx4 v9, s[8:11], s37 offen lds
s_add_u32 m0, s40, 86016
s_add_u32 s43, s38, 0
buffer_load_dwordx4 v2, s[12:15], s43 offen lds
s_add_u32 m0, s40, 87040
s_add_u32 s43, s38, 49152
buffer_load_dwordx4 v3, s[12:15], s43 offen lds
s_add_u32 m0, s40, 88064
s_add_u32 s43, s38, 98304
buffer_load_dwordx4 v2, s[12:15], s43 offen lds
s_add_u32 m0, s40, 89088
s_add_u32 s43, s38, 147456
buffer_load_dwordx4 v3, s[12:15], s43 offen lds
s_add_u32 m0, s40, 90112
s_add_u32 s43, s38, 196608
buffer_load_dwordx4 v2, s[12:15], s43 offen lds
s_add_u32 m0, s40, 91136
s_add_u32 s43, s38, 245760
buffer_load_dwordx4 v3, s[12:15], s43 offen lds
s_add_u32 m0, s40, 92160
s_add_u32 s43, s38, 294912
buffer_load_dwordx4 v2, s[12:15], s43 offen lds
s_add_u32 m0, s40, 93184
s_add_u32 s43, s38, 344064
buffer_load_dwordx4 v3, s[12:15], s43 offen lds
s_add_u32 s37, s37, 128
s_add_u32 s38, s38, 393216
s_load_dword s3, s[4:5], 121920
s_load_dword s3, s[4:5], 121984
s_load_dword s3, s[4:5], 122048
s_load_dword s3, s[4:5], 129024
s_load_dword s3, s[4:5], 129088
s_load_dword s3, s[4:5], 129152
s_load_dword s3, s[4:5], 129216
s_load_dword s3, s[4:5], 136192
s_load_dword s3, s[4:5], 136256
s_waitcnt vmcnt(14)
s_barrier
s_add_u32 m0, s39, 0
s_mov_b64 exec, s[60:61]
buffer_load_dwordx4 v4, s[8:11], s37 offen lds
s_mov_b64 exec, -1
s_add_u32 m0, s39, 3072
s_nop 0
buffer_load_dwordx4 v5, s[8:11], s37 offen lds
s_add_u32 m0, s39, 6144
s_nop 0
buffer_load_dwordx4 v6, s[8:11], s37 offen lds
s_add_u32 m0, s39, 9216
s_nop 0
buffer_load_dwordx4 v7, s[8:11], s37 offen lds
s_add_u32 m0, s39, 12288
s_nop 0
buffer_load_dwordx4 v8, s[8:11], s37 offen lds
s_add_u32 m0, s39, 15360
s_nop 0
buffer_load_dwordx4 v9, s[8:11], s37 offen lds
s_add_u32 m0, s40, 0
s_add_u32 s43, s38, 0
buffer_load_dwordx4 v2, s[12:15], s43 offen lds
s_add_u32 m0, s40, 1024
s_add_u32 s43, s38, 49152
buffer_load_dwordx4 v3, s[12:15], s43 offen lds
s_add_u32 m0, s40, 2048
s_add_u32 s43, s38, 98304
buffer_load_dwordx4 v2, s[12:15], s43 offen lds
s_add_u32 m0, s40, 3072
s_add_u32 s43, s38, 147456
buffer_load_dwordx4 v3, s[12:15], s43 offen lds
s_add_u32 m0, s40, 4096
s_add_u32 s43, s38, 196608
buffer_load_dwordx4 v2, s[12:15], s43 offen lds
s_add_u32 m0, s40, 5120
s_add_u32 s43, s38, 245760
buffer_load_dwordx4 v3, s[12:15], s43 offen lds
s_add_u32 m0, s40, 6144
s_add_u32 s43, s38, 294912
buffer_load_dwordx4 v2, s[12:15], s43 offen lds
s_add_u32 m0, s40, 7168
s_add_u32 s43, s38, 344064
buffer_load_dwordx4 v3, s[12:15], s43 offen lds
s_add_u32 s37, s37, 128
s_add_u32 s38, s38, 393216
s_load_dword s3, s[4:5], 136320
s_load_dword s3, s[4:5], 136384
s_load_dword s3, s[4:5], 143360
s_load_dword s3, s[4:5], 143424
s_load_dword s3, s[4:5], 143488
s_load_dword s3, s[4:5], 143552
s_load_dword s3, s[4:5], 150528
s_load_dword s3, s[4:5], 150592
s_load_dword s3, s[4:5], 150656
s_waitcnt vmcnt(14)
s_barrier
s_load_dword s3, s[4:5], 150720
s_load_dword s3, s[4:5], 157696
s_load_dword s3, s[4:5], 157760
s_load_dword s3, s[4:5], 157824
s_load_dword s3, s[4:5], 157888
s_load_dword s3, s[4:5], 164864
s_load_dword s3, s[4:5], 164928
s_load_dword s3, s[4:5], 164992
s_load_dword s3, s[4:5], 165056
s_waitcnt vmcnt(0)
s_barrier
s_bitcmp0_b32 s2, 0
s_cselect_b32 s88, s72, s74
s_cselect_b32 s89, s73, s75
s_cmp_lt_u32 s2, 192
s_cselect_b32 s90, 7340032, 0
s_mov_b32 s91, 0x20000
s_bfe_u32 s44, s2, 0x30001
s_lshl_b32 s44, s44, 2
s_and_b32 s43, s36, 3
s_add_u32 s44, s44, s43
s_lshl_b32 s44, s44, 5
v_lshrrev_b32 v18, 4, v1
v_add_u32 v18, s44, v18
v_mul_u32_u24 v18, 7168, v18
v_and_b32 v19, 15, v1
v_lshl_add_u32 v18, v19, 4, v18
s_lshr_b32 s43, s2, 4
s_branch Lov_1
.p2align 12
Lst_1_0:
s_branch Lwr_146
s_nop 0
s_nop 0
Lov_1:
s_lshl_b32 s43, s43, 8
s_add_u32 s43, s43, 4096
v_add_u32 v18, s43, v18
s_mov_b32 s43, 0
buffer_load_dwordx4 v[128:131], v18, s[88:91], s43 offen
s_mov_b32 s43, 28672
buffer_load_dwordx4 v[132:135], v18, s[88:91], s43 offen
s_mov_b32 s43, 57344
buffer_load_dwordx4 v[136:139], v18, s[88:91], s43 offen
s_mov_b32 s43, 86016
buffer_load_dwordx4 v[140:143], v18, s[88:91], s43 offen
s_mov_b32 s43, 114688
buffer_load_dwordx4 v[144:147], v18, s[88:91], s43 offen
s_mov_b32 s43, 143360
buffer_load_dwordx4 v[148:151], v18, s[88:91], s43 offen
s_mov_b32 s43, 172032
buffer_load_dwordx4 v[152:155], v18, s[88:91], s43 offen
s_mov_b32 s43, 200704
buffer_load_dwordx4 v[156:159], v18, s[88:91], s43 offen
s_barrier
s_lshl_b32 s43, s35, 7
s_add_u32 s28, s68, s43
s_addc_u32 s29, s69, 0
s_mov_b32 s30, 2095232
s_mov_b32 s31, 0x20000
v_lshrrev_b32 v15, 3, v1
v_and_b32 v16, 6, v15
v_and_b32 v7, 7, v1
v_xor_b32 v7, v7, v16
v_lshlrev_b32 v7, 4, v7
v_mul_u32_u24 v15, 2048, v15
v_add_u32 v7, v7, v15
s_and_b32 s40, s36, 3
s_lshl_b32 s39, s40, 13
s_add_u32 s40, s40, s35
s_add_u32 s42, s40, 0
s_and_b32 s42, s42, 15
s_lshl_b32 s42, s42, 17
s_add_u32 m0, s39, 65536
s_add_u32 s43, s42, 0
buffer_load_dwordx4 v7, s[28:31], s43 offen lds
s_add_u32 m0, s39, 66560
s_add_u32 s43, s42, 16384
buffer_load_dwordx4 v7, s[28:31], s43 offen lds
s_add_u32 m0, s39, 67584
s_add_u32 s43, s42, 32768
buffer_load_dwordx4 v7, s[28:31], s43 offen lds
s_add_u32 m0, s39, 68608
s_add_u32 s43, s42, 49152
buffer_load_dwordx4 v7, s[28:31], s43 offen lds
s_add_u32 m0, s39, 69632
s_add_u32 s43, s42, 65536
buffer_load_dwordx4 v7, s[28:31], s43 offen lds
s_add_u32 m0, s39, 70656
s_add_u32 s43, s42, 81920
buffer_load_dwordx4 v7, s[28:31], s43 offen lds
s_add_u32 m0, s39, 71680
s_add_u32 s43, s42, 98304
buffer_load_dwordx4 v7, s[28:31], s43 offen lds
s_add_u32 m0, s39, 72704
s_add_u32 s43, s42, 114688
buffer_load_dwordx4 v7, s[28:31], s43 offen lds
s_branch Lats_6
Lcons_7:
s_lshl_b32 s43, s35, 7
s_waitcnt lgkmcnt(0)
s_mov_b32 s8, s64
s_mov_b32 s9, s65
s_mov_b32 s10, 4194304
s_mov_b32 s11, 0x20000
s_add_u32 s12, s66, s43
s_addc_u32 s13, s67, 0
s_mov_b32 s14, 6289536
s_mov_b32 s15, 0x20000
s_lshr_b32 s43, s2, 3
s_lshl_b32 s43, s43, 2
s_add_u32 s43, s43, s36
s_sub_u32 s44, s43, 0
s_and_b32 s44, s44, 127
s_cmp_lt_u32 s44, 24
s_cbranch_scc0 Lt_8
s_lshl_b32 s44, s44, 20
s_min_u32 s44, s44, 24117184
s_load_dword s3, s[82:83], s44 glc
Lt_8:
s_sub_u32 s44, s43, 24
s_and_b32 s44, s44, 127
s_cmp_lt_u32 s44, 8
s_cbranch_scc0 Lt_9
s_lshl_b32 s44, s44, 20
s_min_u32 s44, s44, 7339968
s_load_dword s3, s[72:73], s44
Lt_9:
s_sub_u32 s44, s43, 32
s_and_b32 s44, s44, 127
s_cmp_lt_u32 s44, 8
s_cbranch_scc0 Lt_10
s_lshl_b32 s44, s44, 20
s_min_u32 s44, s44, 7339968
s_load_dword s3, s[74:75], s44
Lt_10:
s_sub_u32 s44, s43, 40
s_and_b32 s44, s44, 127
s_cmp_lt_u32 s44, 3
s_cbranch_scc0 Lt_11
s_lshl_b32 s44, s44, 20
s_min_u32 s44, s44, 2097088
s_load_dword s3, s[68:69], s44
Lt_11:
s_sub_u32 s44, s43, 43
s_and_b32 s44, s44, 127
s_cmp_lt_u32 s44, 5
s_cbranch_scc0 Lt_12
s_lshl_b32 s44, s44, 20
s_min_u32 s44, s44, 4194240
s_add_u32 s44, s44, 25165824
s_load_dword s3, s[82:83], s44 glc
Lt_12:
s_sub_u32 s44, s43, 48
s_and_b32 s44, s44, 127
s_cmp_lt_u32 s44, 8
s_cbranch_scc0 Lt_13
s_lshl_b32 s44, s44, 20
s_min_u32 s44, s44, 7339968
s_load_dword s3, s[76:77], s44
Lt_13:
s_sub_u32 s44, s43, 56
s_and_b32 s44, s44, 127
s_cmp_lt_u32 s44, 5
s_cbranch_scc0 Lt_14
s_lshl_b32 s44, s44, 20
s_min_u32 s44, s44, 4194240
s_add_u32 s44, s44, 33554432
s_load_dword s3, s[82:83], s44 glc
Lt_14:
s_sub_u32 s44, s43, 61
s_and_b32 s44, s44, 127
s_cmp_lt_u32 s44, 5
s_cbranch_scc0 Lt_15
s_lshl_b32 s44, s44, 20
s_min_u32 s44, s44, 4194240
s_load_dword s3, s[78:79], s44 glc
Lt_15:
v_lshrrev_b32 v16, 1, v12
v_xor_b32 v15, v13, v16
v_lshlrev_b32 v15, 4, v15
v_lshl_add_u32 v2, v12, 7, v15
v_xor_b32 v3, 64, v2
v_add_u32 v4, 86016, v2
v_add_u32 v5, 86016, v3
v_lshrrev_b32 v15, 2, v12
v_and_b32 v16, 3, v1
v_lshl_add_u32 v19, v13, 3, v15
v_lshlrev_b32 v19, 7, v19
v_and_b32 v15, 2, v15
v_and_b32 v17, 1, v13
v_lshl_add_u32 v15, v17, 2, v15
v_lshrrev_b32 v17, 1, v16
s_lshl_b32 s43, s36, 1
v_add_u32 v17, s43, v17
v_xor_b32 v15, v15, v17
v_lshl_add_u32 v19, v15, 4, v19
v_and_b32 v16, 1, v16
v_lshl_add_u32 v19, v16, 3, v19
v_add_u32 v6, 18432, v19
v_add_u32 v7, 61440, v19
v_add_u32 v8, 104448, v19
s_and_b32 s43, s36, 1
s_bfe_u32 s44, s36, 0x10001
s_lshr_b32 s45, s36, 2
v_lshlrev_b32 v14, 2, v13
v_sub_u32 v14, v12, v14
v_mov_b32 v16, 0xff800000
s_or_b32 s46, s34, s45
s_cmp_lg_u32 s46, 0
s_cselect_b32 s46, 0, 0xff800000
v_subrev_u32 v15, 0, v14
v_cmp_ge_u32 vcc, 7, v15
v_add_u32 v15, 16, v15
s_nop 0
v_cndmask_b32 v248, v16, 0, vcc
v_cmp_ge_u32 vcc, 7, v15
s_nop 1
v_cndmask_b32 v244, v16, 0, vcc
v_or_b32 v240, s46, v244
v_subrev_u32 v15, 1, v14
v_cmp_ge_u32 vcc, 7, v15
v_add_u32 v15, 16, v15
s_nop 0
v_cndmask_b32 v249, v16, 0, vcc
v_cmp_ge_u32 vcc, 7, v15
s_nop 1
v_cndmask_b32 v245, v16, 0, vcc
v_or_b32 v241, s46, v245
v_subrev_u32 v15, 2, v14
v_cmp_ge_u32 vcc, 7, v15
v_add_u32 v15, 16, v15
s_nop 0
v_cndmask_b32 v250, v16, 0, vcc
v_cmp_ge_u32 vcc, 7, v15
s_nop 1
v_cndmask_b32 v246, v16, 0, vcc
v_or_b32 v242, s46, v246
v_subrev_u32 v15, 3, v14
v_cmp_ge_u32 vcc, 7, v15
v_add_u32 v15, 16, v15
s_nop 0
v_cndmask_b32 v251, v16, 0, vcc
v_cmp_ge_u32 vcc, 7, v15
s_nop 1
v_cndmask_b32 v247, v16, 0, vcc
v_or_b32 v243, s46, v247
s_lshl_b32 s46, s45, 6
s_add_u32 s46, s46, s44
s_add_u32 s46, s46, 16
v_lshl_add_u32 v14, v12, 1, s46
s_lshl_b32 s47, s43, 6
v_lshl_add_u32 v15, v13, 4, s47
v_mul_u32_u24 v20, 400, v14
v_add_u32 v20, v20, v15
v_subrev_u32 v16, 32, v14
v_max_i32 v16, 0, v16
v_mul_u32_u24 v21, 400, v16
v_add_u32 v21, v21, v15
v_lshrrev_b32 v16, 2, v12
v_lshl_add_u32 v16, v13, 2, v16
v_lshl_add_u32 v16, v16, 1, s46
v_and_b32 v17, 3, v1
v_lshl_add_u32 v17, v17, 3, s47
v_mul_u32_u24 v22, 400, v16
v_add_u32 v22, v22, v17
v_subrev_u32 v16, 32, v16
v_max_i32 v16, 0, v16
v_mul_u32_u24 v23, 400, v16
v_add_u32 v23, v23, v17
s_mul_i32 s60, s34, 262144
s_add_u32 s16, s82, s60
s_addc_u32 s17, s83, 0
s_mov_b32 s18, 262144
s_mov_b32 s19, 0x20000
s_lshl_b32 s60, s35, 14
s_lshl_b32 s43, s43, 13
s_add_u32 s60, s60, s43
s_lshl_b32 s43, s45, 12
s_add_u32 s60, s60, s43
s_lshl_b32 s43, s44, 10
s_add_u32 s60, s60, s43
v_lshlrev_b32 v24, 4, v1
s_mov_b32 s61, 0x3e8293ee
s_lshl_b32 s38, s35, 7
s_add_u32 s56, s82, 28311552
s_addc_u32 s57, s83, 0
s_mov_b32 s58, 114688
s_mov_b32 s59, 0x20000
s_barrier
ds_read_b128 v[32:35], v2 offset:0
ds_read_b64_tr_b16 v[72:73], v6 offset:8192
ds_read_b64_tr_b16 v[74:75], v6 offset:8704
ds_read_b64_tr_b16 v[76:77], v6 offset:16384
ds_read_b64_tr_b16 v[78:79], v6 offset:16896
ds_read_b64_tr_b16 v[68:69], v6 offset:0
ds_read_b64_tr_b16 v[70:71], v6 offset:512
ds_read_b128 v[36:39], v2 offset:2048
ds_read_b128 v[40:43], v2 offset:4096
ds_read_b128 v[44:47], v2 offset:6144
ds_read_b128 v[48:51], v2 offset:8192
ds_read_b128 v[52:55], v2 offset:10240
ds_read_b128 v[56:59], v2 offset:12288
ds_read_b128 v[60:63], v2 offset:14336
ds_read_b128 v[64:67], v2 offset:16384
s_waitcnt lgkmcnt(0)
v_mfma_f32_16x16x32_bf16 v[164:167], v[72:75], v[32:35], 0
ds_read_b128 v[80:83], v3 offset:0
v_mfma_f32_16x16x32_bf16 v[200:203], v[76:79], v[32:35], 0
ds_read_b64_tr_b16 v[120:121], v6 offset:12288
v_mfma_f32_16x16x32_bf16 v[128:131], v[68:71], v[32:35], 0
ds_read_b64_tr_b16 v[122:123], v6 offset:12800
v_mfma_f32_16x16x32_bf16 v[132:135], v[68:71], v[36:39], 0
ds_read_b64_tr_b16 v[124:125], v6 offset:20480
v_mfma_f32_16x16x32_bf16 v[204:207], v[76:79], v[36:39], 0
ds_read_b64_tr_b16 v[126:127], v6 offset:20992
v_mfma_f32_16x16x32_bf16 v[168:171], v[72:75], v[36:39], 0
ds_read_b64_tr_b16 v[116:117], v6 offset:4096
v_mfma_f32_16x16x32_bf16 v[172:175], v[72:75], v[40:43], 0
ds_read_b64_tr_b16 v[118:119], v6 offset:4608
v_mfma_f32_16x16x32_bf16 v[208:211], v[76:79], v[40:43], 0
ds_read_b128 v[84:87], v3 offset:2048
v_mfma_f32_16x16x32_bf16 v[136:139], v[68:71], v[40:43], 0
ds_read_b128 v[88:91], v3 offset:4096
v_mfma_f32_16x16x32_bf16 v[140:143], v[68:71], v[44:47], 0
ds_read_b128 v[92:95], v3 offset:6144
v_mfma_f32_16x16x32_bf16 v[212:215], v[76:79], v[44:47], 0
ds_read_b128 v[96:99], v3 offset:8192
v_mfma_f32_16x16x32_bf16 v[176:179], v[72:75], v[44:47], 0
ds_read_b128 v[100:103], v3 offset:10240
v_mfma_f32_16x16x32_bf16 v[180:183], v[72:75], v[48:51], 0
ds_read_b128 v[104:107], v3 offset:12288
v_mfma_f32_16x16x32_bf16 v[216:219], v[76:79], v[48:51], 0
ds_read_b128 v[108:111], v3 offset:14336
v_mfma_f32_16x16x32_bf16 v[144:147], v[68:71], v[48:51], 0
ds_read_b128 v[112:115], v3 offset:16384
v_mfma_f32_16x16x32_bf16 v[148:151], v[68:71], v[52:55], 0
v_mfma_f32_16x16x32_bf16 v[220:223], v[76:79], v[52:55], 0
v_mfma_f32_16x16x32_bf16 v[184:187], v[72:75], v[52:55], 0
v_mfma_f32_16x16x32_bf16 v[188:191], v[72:75], v[56:59], 0
v_mfma_f32_16x16x32_bf16 v[224:227], v[76:79], v[56:59], 0
v_mfma_f32_16x16x32_bf16 v[152:155], v[68:71], v[56:59], 0
v_mfma_f32_16x16x32_bf16 v[156:159], v[68:71], v[60:63], 0
v_mfma_f32_16x16x32_bf16 v[228:231], v[76:79], v[60:63], 0
v_mfma_f32_16x16x32_bf16 v[192:195], v[72:75], v[60:63], 0
v_mfma_f32_16x16x32_bf16 v[196:199], v[72:75], v[64:67], 0
v_mfma_f32_16x16x32_bf16 v[232:235], v[76:79], v[64:67], 0
v_mfma_f32_16x16x32_bf16 v[160:163], v[68:71], v[64:67], 0
s_waitcnt lgkmcnt(0)
s_barrier
v_mfma_f32_16x16x32_bf16 v[164:167], v[120:123], v[80:83], v[164:167]
ds_read_b128 v[32:35], v2 offset:43008
v_mfma_f32_16x16x32_bf16 v[200:203], v[124:127], v[80:83], v[200:203]
ds_read_b64_tr_b16 v[72:73], v7 offset:8192
v_mfma_f32_16x16x32_bf16 v[128:131], v[116:119], v[80:83], v[128:131]
ds_read_b64_tr_b16 v[74:75], v7 offset:8704
v_mfma_f32_16x16x32_bf16 v[132:135], v[116:119], v[84:87], v[132:135]
ds_read_b64_tr_b16 v[76:77], v7 offset:16384
v_mfma_f32_16x16x32_bf16 v[204:207], v[124:127], v[84:87], v[204:207]
ds_read_b64_tr_b16 v[78:79], v7 offset:16896
v_mfma_f32_16x16x32_bf16 v[168:171], v[120:123], v[84:87], v[168:171]
ds_read_b64_tr_b16 v[68:69], v7 offset:0
v_mfma_f32_16x16x32_bf16 v[172:175], v[120:123], v[88:91], v[172:175]
ds_read_b64_tr_b16 v[70:71], v7 offset:512
v_mfma_f32_16x16x32_bf16 v[208:211], v[124:127], v[88:91], v[208:211]
ds_read_b128 v[36:39], v2 offset:45056
v_mfma_f32_16x16x32_bf16 v[136:139], v[116:119], v[88:91], v[136:139]
ds_read_b128 v[40:43], v2 offset:47104
v_mfma_f32_16x16x32_bf16 v[140:143], v[116:119], v[92:95], v[140:143]
ds_read_b128 v[44:47], v2 offset:49152
v_mfma_f32_16x16x32_bf16 v[212:215], v[124:127], v[92:95], v[212:215]
ds_read_b128 v[48:51], v2 offset:51200
v_mfma_f32_16x16x32_bf16 v[176:179], v[120:123], v[92:95], v[176:179]
ds_read_b128 v[52:55], v2 offset:53248
v_mfma_f32_16x16x32_bf16 v[180:183], v[120:123], v[96:99], v[180:183]
ds_read_b128 v[56:59], v2 offset:55296
v_mfma_f32_16x16x32_bf16 v[216:219], v[124:127], v[96:99], v[216:219]
ds_read_b128 v[60:63], v2 offset:57344
v_mfma_f32_16x16x32_bf16 v[144:147], v[116:119], v[96:99], v[144:147]
ds_read_b128 v[64:67], v2 offset:59392
v_mfma_f32_16x16x32_bf16 v[148:151], v[116:119], v[100:103], v[148:151]
v_mfma_f32_16x16x32_bf16 v[220:223], v[124:127], v[100:103], v[220:223]
v_mfma_f32_16x16x32_bf16 v[184:187], v[120:123], v[100:103], v[184:187]
v_mfma_f32_16x16x32_bf16 v[188:191], v[120:123], v[104:107], v[188:191]
v_mfma_f32_16x16x32_bf16 v[224:227], v[124:127], v[104:107], v[224:227]
v_mfma_f32_16x16x32_bf16 v[152:155], v[116:119], v[104:107], v[152:155]
v_mfma_f32_16x16x32_bf16 v[156:159], v[116:119], v[108:111], v[156:159]
v_mfma_f32_16x16x32_bf16 v[228:231], v[124:127], v[108:111], v[228:231]
v_mfma_f32_16x16x32_bf16 v[192:195], v[120:123], v[108:111], v[192:195]
v_mfma_f32_16x16x32_bf16 v[196:199], v[120:123], v[112:115], v[196:199]
v_mfma_f32_16x16x32_bf16 v[232:235], v[124:127], v[112:115], v[232:235]
v_mfma_f32_16x16x32_bf16 v[160:163], v[116:119], v[112:115], v[160:163]
s_waitcnt lgkmcnt(0)
v_mfma_f32_16x16x32_bf16 v[164:167], v[72:75], v[32:35], v[164:167]
ds_read_b128 v[80:83], v3 offset:43008
v_mfma_f32_16x16x32_bf16 v[200:203], v[76:79], v[32:35], v[200:203]
ds_read_b64_tr_b16 v[120:121], v7 offset:12288
v_mfma_f32_16x16x32_bf16 v[128:131], v[68:71], v[32:35], v[128:131]
ds_read_b64_tr_b16 v[122:123], v7 offset:12800
v_mfma_f32_16x16x32_bf16 v[132:135], v[68:71], v[36:39], v[132:135]
ds_read_b64_tr_b16 v[124:125], v7 offset:20480
v_mfma_f32_16x16x32_bf16 v[204:207], v[76:79], v[36:39], v[204:207]
ds_read_b64_tr_b16 v[126:127], v7 offset:20992
v_mfma_f32_16x16x32_bf16 v[168:171], v[72:75], v[36:39], v[168:171]
ds_read_b64_tr_b16 v[116:117], v7 offset:4096
v_mfma_f32_16x16x32_bf16 v[172:175], v[72:75], v[40:43], v[172:175]
ds_read_b64_tr_b16 v[118:119], v7 offset:4608
v_mfma_f32_16x16x32_bf16 v[208:211], v[76:79], v[40:43], v[208:211]
ds_read_b128 v[84:87], v3 offset:45056
v_mfma_f32_16x16x32_bf16 v[136:139], v[68:71], v[40:43], v[136:139]
ds_read_b128 v[88:91], v3 offset:47104
v_mfma_f32_16x16x32_bf16 v[140:143], v[68:71], v[44:47], v[140:143]
ds_read_b128 v[92:95], v3 offset:49152
v_mfma_f32_16x16x32_bf16 v[212:215], v[76:79], v[44:47], v[212:215]
ds_read_b128 v[96:99], v3 offset:51200
v_mfma_f32_16x16x32_bf16 v[176:179], v[72:75], v[44:47], v[176:179]
ds_read_b128 v[100:103], v3 offset:53248
v_mfma_f32_16x16x32_bf16 v[180:183], v[72:75], v[48:51], v[180:183]
ds_read_b128 v[104:107], v3 offset:55296
v_mfma_f32_16x16x32_bf16 v[216:219], v[76:79], v[48:51], v[216:219]
ds_read_b128 v[108:111], v3 offset:57344
v_mfma_f32_16x16x32_bf16 v[144:147], v[68:71], v[48:51], v[144:147]
ds_read_b128 v[112:115], v3 offset:59392
v_mfma_f32_16x16x32_bf16 v[148:151], v[68:71], v[52:55], v[148:151]
v_mfma_f32_16x16x32_bf16 v[220:223], v[76:79], v[52:55], v[220:223]
v_mfma_f32_16x16x32_bf16 v[184:187], v[72:75], v[52:55], v[184:187]
v_mfma_f32_16x16x32_bf16 v[188:191], v[72:75], v[56:59], v[188:191]
v_mfma_f32_16x16x32_bf16 v[224:227], v[76:79], v[56:59], v[224:227]
v_mfma_f32_16x16x32_bf16 v[152:155], v[68:71], v[56:59], v[152:155]
v_mfma_f32_16x16x32_bf16 v[156:159], v[68:71], v[60:63], v[156:159]
v_mfma_f32_16x16x32_bf16 v[228:231], v[76:79], v[60:63], v[228:231]
v_mfma_f32_16x16x32_bf16 v[192:195], v[72:75], v[60:63], v[192:195]
v_mfma_f32_16x16x32_bf16 v[196:199], v[72:75], v[64:67], v[196:199]
v_mfma_f32_16x16x32_bf16 v[232:235], v[76:79], v[64:67], v[232:235]
v_mfma_f32_16x16x32_bf16 v[160:163], v[68:71], v[64:67], v[160:163]
s_waitcnt lgkmcnt(0)
s_barrier
v_mfma_f32_16x16x32_bf16 v[164:167], v[120:123], v[80:83], v[164:167]
ds_read_b128 v[32:35], v4 offset:0
v_mfma_f32_16x16x32_bf16 v[200:203], v[124:127], v[80:83], v[200:203]
ds_read_b64_tr_b16 v[72:73], v8 offset:8192
v_mfma_f32_16x16x32_bf16 v[128:131], v[116:119], v[80:83], v[128:131]
ds_read_b64_tr_b16 v[74:75], v8 offset:8704
v_mfma_f32_16x16x32_bf16 v[132:135], v[116:119], v[84:87], v[132:135]
ds_read_b64_tr_b16 v[76:77], v8 offset:16384
v_mfma_f32_16x16x32_bf16 v[204:207], v[124:127], v[84:87], v[204:207]
ds_read_b64_tr_b16 v[78:79], v8 offset:16896
v_mfma_f32_16x16x32_bf16 v[168:171], v[120:123], v[84:87], v[168:171]
ds_read_b64_tr_b16 v[68:69], v8 offset:0
v_mfma_f32_16x16x32_bf16 v[172:175], v[120:123], v[88:91], v[172:175]
ds_read_b64_tr_b16 v[70:71], v8 offset:512
v_mfma_f32_16x16x32_bf16 v[208:211], v[124:127], v[88:91], v[208:211]
ds_read_b128 v[36:39], v4 offset:2048
v_mfma_f32_16x16x32_bf16 v[136:139], v[116:119], v[88:91], v[136:139]
ds_read_b128 v[40:43], v4 offset:4096
v_mfma_f32_16x16x32_bf16 v[140:143], v[116:119], v[92:95], v[140:143]
ds_read_b128 v[44:47], v4 offset:6144
v_mfma_f32_16x16x32_bf16 v[212:215], v[124:127], v[92:95], v[212:215]
ds_read_b128 v[48:51], v4 offset:8192
v_mfma_f32_16x16x32_bf16 v[176:179], v[120:123], v[92:95], v[176:179]
ds_read_b128 v[52:55], v4 offset:10240
v_mfma_f32_16x16x32_bf16 v[180:183], v[120:123], v[96:99], v[180:183]
ds_read_b128 v[56:59], v4 offset:12288
v_mfma_f32_16x16x32_bf16 v[216:219], v[124:127], v[96:99], v[216:219]
ds_read_b128 v[60:63], v4 offset:14336
v_mfma_f32_16x16x32_bf16 v[144:147], v[116:119], v[96:99], v[144:147]
ds_read_b128 v[64:67], v4 offset:16384
v_mfma_f32_16x16x32_bf16 v[148:151], v[116:119], v[100:103], v[148:151]
v_mfma_f32_16x16x32_bf16 v[220:223], v[124:127], v[100:103], v[220:223]
v_mfma_f32_16x16x32_bf16 v[184:187], v[120:123], v[100:103], v[184:187]
v_mfma_f32_16x16x32_bf16 v[188:191], v[120:123], v[104:107], v[188:191]
v_mfma_f32_16x16x32_bf16 v[224:227], v[124:127], v[104:107], v[224:227]
v_mfma_f32_16x16x32_bf16 v[152:155], v[116:119], v[104:107], v[152:155]
v_mfma_f32_16x16x32_bf16 v[156:159], v[116:119], v[108:111], v[156:159]
v_mfma_f32_16x16x32_bf16 v[228:231], v[124:127], v[108:111], v[228:231]
v_mfma_f32_16x16x32_bf16 v[192:195], v[120:123], v[108:111], v[192:195]
v_mfma_f32_16x16x32_bf16 v[196:199], v[120:123], v[112:115], v[196:199]
v_mfma_f32_16x16x32_bf16 v[232:235], v[124:127], v[112:115], v[232:235]
v_mfma_f32_16x16x32_bf16 v[160:163], v[116:119], v[112:115], v[160:163]
s_waitcnt lgkmcnt(0)
v_mfma_f32_16x16x32_bf16 v[164:167], v[72:75], v[32:35], v[164:167]
ds_read_b128 v[80:83], v5 offset:0
v_mfma_f32_16x16x32_bf16 v[200:203], v[76:79], v[32:35], v[200:203]
ds_read_b64_tr_b16 v[120:121], v8 offset:12288
v_mfma_f32_16x16x32_bf16 v[128:131], v[68:71], v[32:35], v[128:131]
ds_read_b64_tr_b16 v[122:123], v8 offset:12800
v_mfma_f32_16x16x32_bf16 v[132:135], v[68:71], v[36:39], v[132:135]
ds_read_b64_tr_b16 v[124:125], v8 offset:20480
v_mfma_f32_16x16x32_bf16 v[204:207], v[76:79], v[36:39], v[204:207]
ds_read_b64_tr_b16 v[126:127], v8 offset:20992
v_mfma_f32_16x16x32_bf16 v[168:171], v[72:75], v[36:39], v[168:171]
ds_read_b64_tr_b16 v[116:117], v8 offset:4096
v_mfma_f32_16x16x32_bf16 v[172:175], v[72:75], v[40:43], v[172:175]
ds_read_b64_tr_b16 v[118:119], v8 offset:4608
v_mfma_f32_16x16x32_bf16 v[208:211], v[76:79], v[40:43], v[208:211]
ds_read_b128 v[84:87], v5 offset:2048
v_mfma_f32_16x16x32_bf16 v[136:139], v[68:71], v[40:43], v[136:139]
ds_read_b128 v[88:91], v5 offset:4096
v_mfma_f32_16x16x32_bf16 v[140:143], v[68:71], v[44:47], v[140:143]
ds_read_b128 v[92:95], v5 offset:6144
v_mfma_f32_16x16x32_bf16 v[212:215], v[76:79], v[44:47], v[212:215]
ds_read_b128 v[96:99], v5 offset:8192
v_mfma_f32_16x16x32_bf16 v[176:179], v[72:75], v[44:47], v[176:179]
ds_read_b128 v[100:103], v5 offset:10240
v_mfma_f32_16x16x32_bf16 v[180:183], v[72:75], v[48:51], v[180:183]
ds_read_b128 v[104:107], v5 offset:12288
v_mfma_f32_16x16x32_bf16 v[216:219], v[76:79], v[48:51], v[216:219]
ds_read_b128 v[108:111], v5 offset:14336
v_mfma_f32_16x16x32_bf16 v[144:147], v[68:71], v[48:51], v[144:147]
ds_read_b128 v[112:115], v5 offset:16384
v_mfma_f32_16x16x32_bf16 v[148:151], v[68:71], v[52:55], v[148:151]
v_mfma_f32_16x16x32_bf16 v[220:223], v[76:79], v[52:55], v[220:223]
v_mfma_f32_16x16x32_bf16 v[184:187], v[72:75], v[52:55], v[184:187]
v_mfma_f32_16x16x32_bf16 v[188:191], v[72:75], v[56:59], v[188:191]
v_mfma_f32_16x16x32_bf16 v[224:227], v[76:79], v[56:59], v[224:227]
v_mfma_f32_16x16x32_bf16 v[152:155], v[68:71], v[56:59], v[152:155]
v_mfma_f32_16x16x32_bf16 v[156:159], v[68:71], v[60:63], v[156:159]
v_mfma_f32_16x16x32_bf16 v[228:231], v[76:79], v[60:63], v[228:231]
v_mfma_f32_16x16x32_bf16 v[192:195], v[72:75], v[60:63], v[192:195]
v_mfma_f32_16x16x32_bf16 v[196:199], v[72:75], v[64:67], v[196:199]
v_mfma_f32_16x16x32_bf16 v[232:235], v[76:79], v[64:67], v[232:235]
v_mfma_f32_16x16x32_bf16 v[160:163], v[68:71], v[64:67], v[160:163]
s_waitcnt lgkmcnt(0)
s_barrier
v_mfma_f32_16x16x32_bf16 v[164:167], v[120:123], v[80:83], v[164:167]
ds_read_b128 v[32:35], v2 offset:0
v_mfma_f32_16x16x32_bf16 v[200:203], v[124:127], v[80:83], v[200:203]
ds_read_b64_tr_b16 v[72:73], v6 offset:8192
v_mfma_f32_16x16x32_bf16 v[128:131], v[116:119], v[80:83], v[128:131]
ds_read_b64_tr_b16 v[74:75], v6 offset:8704
v_mfma_f32_16x16x32_bf16 v[132:135], v[116:119], v[84:87], v[132:135]
ds_read_b64_tr_b16 v[76:77], v6 offset:16384
v_mfma_f32_16x16x32_bf16 v[204:207], v[124:127], v[84:87], v[204:207]
ds_read_b64_tr_b16 v[78:79], v6 offset:16896
v_mfma_f32_16x16x32_bf16 v[168:171], v[120:123], v[84:87], v[168:171]
ds_read_b64_tr_b16 v[68:69], v6 offset:0
v_mfma_f32_16x16x32_bf16 v[172:175], v[120:123], v[88:91], v[172:175]
ds_read_b64_tr_b16 v[70:71], v6 offset:512
v_mfma_f32_16x16x32_bf16 v[208:211], v[124:127], v[88:91], v[208:211]
ds_read_b128 v[36:39], v2 offset:2048
v_mfma_f32_16x16x32_bf16 v[136:139], v[116:119], v[88:91], v[136:139]
ds_read_b128 v[40:43], v2 offset:4096
v_mfma_f32_16x16x32_bf16 v[140:143], v[116:119], v[92:95], v[140:143]
ds_read_b128 v[44:47], v2 offset:6144
v_mfma_f32_16x16x32_bf16 v[212:215], v[124:127], v[92:95], v[212:215]
ds_read_b128 v[48:51], v2 offset:8192
v_mfma_f32_16x16x32_bf16 v[176:179], v[120:123], v[92:95], v[176:179]
ds_read_b128 v[52:55], v2 offset:10240
v_mfma_f32_16x16x32_bf16 v[180:183], v[120:123], v[96:99], v[180:183]
ds_read_b128 v[56:59], v2 offset:12288
v_mfma_f32_16x16x32_bf16 v[216:219], v[124:127], v[96:99], v[216:219]
ds_read_b128 v[60:63], v2 offset:14336
v_mfma_f32_16x16x32_bf16 v[144:147], v[116:119], v[96:99], v[144:147]
ds_read_b128 v[64:67], v2 offset:16384
v_mfma_f32_16x16x32_bf16 v[148:151], v[116:119], v[100:103], v[148:151]
v_mfma_f32_16x16x32_bf16 v[220:223], v[124:127], v[100:103], v[220:223]
v_mfma_f32_16x16x32_bf16 v[184:187], v[120:123], v[100:103], v[184:187]
v_mfma_f32_16x16x32_bf16 v[188:191], v[120:123], v[104:107], v[188:191]
v_mfma_f32_16x16x32_bf16 v[224:227], v[124:127], v[104:107], v[224:227]
v_mfma_f32_16x16x32_bf16 v[152:155], v[116:119], v[104:107], v[152:155]
v_mfma_f32_16x16x32_bf16 v[156:159], v[116:119], v[108:111], v[156:159]
v_mfma_f32_16x16x32_bf16 v[228:231], v[124:127], v[108:111], v[228:231]
v_mfma_f32_16x16x32_bf16 v[192:195], v[120:123], v[108:111], v[192:195]
v_mfma_f32_16x16x32_bf16 v[196:199], v[120:123], v[112:115], v[196:199]
v_mfma_f32_16x16x32_bf16 v[232:235], v[124:127], v[112:115], v[232:235]
v_mfma_f32_16x16x32_bf16 v[160:163], v[116:119], v[112:115], v[160:163]
s_mov_b32 s41, 4
Lcl_16:
s_waitcnt lgkmcnt(0)
v_mfma_f32_16x16x32_bf16 v[164:167], v[72:75], v[32:35], v[164:167]
ds_read_b128 v[80:83], v3 offset:0
v_mfma_f32_16x16x32_bf16 v[200:203], v[76:79], v[32:35], v[200:203]
ds_read_b64_tr_b16 v[120:121], v6 offset:12288
v_mfma_f32_16x16x32_bf16 v[128:131], v[68:71], v[32:35], v[128:131]
ds_read_b64_tr_b16 v[122:123], v6 offset:12800
v_mfma_f32_16x16x32_bf16 v[132:135], v[68:71], v[36:39], v[132:135]
ds_read_b64_tr_b16 v[124:125], v6 offset:20480
v_mfma_f32_16x16x32_bf16 v[204:207], v[76:79], v[36:39], v[204:207]
ds_read_b64_tr_b16 v[126:127], v6 offset:20992
v_mfma_f32_16x16x32_bf16 v[168:171], v[72:75], v[36:39], v[168:171]
ds_read_b64_tr_b16 v[116:117], v6 offset:4096
v_mfma_f32_16x16x32_bf16 v[172:175], v[72:75], v[40:43], v[172:175]
ds_read_b64_tr_b16 v[118:119], v6 offset:4608
v_mfma_f32_16x16x32_bf16 v[208:211], v[76:79], v[40:43], v[208:211]
ds_read_b128 v[84:87], v3 offset:2048
v_mfma_f32_16x16x32_bf16 v[136:139], v[68:71], v[40:43], v[136:139]
ds_read_b128 v[88:91], v3 offset:4096
v_mfma_f32_16x16x32_bf16 v[140:143], v[68:71], v[44:47], v[140:143]
ds_read_b128 v[92:95], v3 offset:6144
v_mfma_f32_16x16x32_bf16 v[212:215], v[76:79], v[44:47], v[212:215]
ds_read_b128 v[96:99], v3 offset:8192
v_mfma_f32_16x16x32_bf16 v[176:179], v[72:75], v[44:47], v[176:179]
ds_read_b128 v[100:103], v3 offset:10240
v_mfma_f32_16x16x32_bf16 v[180:183], v[72:75], v[48:51], v[180:183]
ds_read_b128 v[104:107], v3 offset:12288
v_mfma_f32_16x16x32_bf16 v[216:219], v[76:79], v[48:51], v[216:219]
ds_read_b128 v[108:111], v3 offset:14336
v_mfma_f32_16x16x32_bf16 v[144:147], v[68:71], v[48:51], v[144:147]
ds_read_b128 v[112:115], v3 offset:16384
v_mfma_f32_16x16x32_bf16 v[148:151], v[68:71], v[52:55], v[148:151]
v_mfma_f32_16x16x32_bf16 v[220:223], v[76:79], v[52:55], v[220:223]
v_mfma_f32_16x16x32_bf16 v[184:187], v[72:75], v[52:55], v[184:187]
v_mfma_f32_16x16x32_bf16 v[188:191], v[72:75], v[56:59], v[188:191]
v_mfma_f32_16x16x32_bf16 v[224:227], v[76:79], v[56:59], v[224:227]
v_mfma_f32_16x16x32_bf16 v[152:155], v[68:71], v[56:59], v[152:155]
v_mfma_f32_16x16x32_bf16 v[156:159], v[68:71], v[60:63], v[156:159]
v_mfma_f32_16x16x32_bf16 v[228:231], v[76:79], v[60:63], v[228:231]
v_mfma_f32_16x16x32_bf16 v[192:195], v[72:75], v[60:63], v[192:195]
v_mfma_f32_16x16x32_bf16 v[196:199], v[72:75], v[64:67], v[196:199]
v_mfma_f32_16x16x32_bf16 v[232:235], v[76:79], v[64:67], v[232:235]
v_mfma_f32_16x16x32_bf16 v[160:163], v[68:71], v[64:67], v[160:163]
s_waitcnt lgkmcnt(0)
s_barrier
v_mfma_f32_16x16x32_bf16 v[164:167], v[120:123], v[80:83], v[164:167]
ds_read_b128 v[32:35], v2 offset:43008
v_mfma_f32_16x16x32_bf16 v[200:203], v[124:127], v[80:83], v[200:203]
ds_read_b64_tr_b16 v[72:73], v7 offset:8192
v_mfma_f32_16x16x32_bf16 v[128:131], v[116:119], v[80:83], v[128:131]
ds_read_b64_tr_b16 v[74:75], v7 offset:8704
v_mfma_f32_16x16x32_bf16 v[132:135], v[116:119], v[84:87], v[132:135]
ds_read_b64_tr_b16 v[76:77], v7 offset:16384
v_mfma_f32_16x16x32_bf16 v[204:207], v[124:127], v[84:87], v[204:207]
ds_read_b64_tr_b16 v[78:79], v7 offset:16896
v_mfma_f32_16x16x32_bf16 v[168:171], v[120:123], v[84:87], v[168:171]
ds_read_b64_tr_b16 v[68:69], v7 offset:0
v_mfma_f32_16x16x32_bf16 v[172:175], v[120:123], v[88:91], v[172:175]
ds_read_b64_tr_b16 v[70:71], v7 offset:512
v_mfma_f32_16x16x32_bf16 v[208:211], v[124:127], v[88:91], v[208:211]
ds_read_b128 v[36:39], v2 offset:45056
v_mfma_f32_16x16x32_bf16 v[136:139], v[116:119], v[88:91], v[136:139]
s_branch Lov_2
.p2align 12
.fill 16, 4, 0xbf800000
Lst_2_0:
s_branch Lwr_147
s_nop 0
s_nop 0
Lov_2:
ds_read_b128 v[40:43], v2 offset:47104
v_mfma_f32_16x16x32_bf16 v[140:143], v[116:119], v[92:95], v[140:143]
ds_read_b128 v[44:47], v2 offset:49152
v_mfma_f32_16x16x32_bf16 v[212:215], v[124:127], v[92:95], v[212:215]
ds_read_b128 v[48:51], v2 offset:51200
v_mfma_f32_16x16x32_bf16 v[176:179], v[120:123], v[92:95], v[176:179]
ds_read_b128 v[52:55], v2 offset:53248
v_mfma_f32_16x16x32_bf16 v[180:183], v[120:123], v[96:99], v[180:183]
ds_read_b128 v[56:59], v2 offset:55296
v_mfma_f32_16x16x32_bf16 v[216:219], v[124:127], v[96:99], v[216:219]
ds_read_b128 v[60:63], v2 offset:57344
v_mfma_f32_16x16x32_bf16 v[144:147], v[116:119], v[96:99], v[144:147]
ds_read_b128 v[64:67], v2 offset:59392
v_mfma_f32_16x16x32_bf16 v[148:151], v[116:119], v[100:103], v[148:151]
v_mfma_f32_16x16x32_bf16 v[220:223], v[124:127], v[100:103], v[220:223]
v_mfma_f32_16x16x32_bf16 v[184:187], v[120:123], v[100:103], v[184:187]
v_mfma_f32_16x16x32_bf16 v[188:191], v[120:123], v[104:107], v[188:191]
v_mfma_f32_16x16x32_bf16 v[224:227], v[124:127], v[104:107], v[224:227]
v_mfma_f32_16x16x32_bf16 v[152:155], v[116:119], v[104:107], v[152:155]
v_mfma_f32_16x16x32_bf16 v[156:159], v[116:119], v[108:111], v[156:159]
v_mfma_f32_16x16x32_bf16 v[228:231], v[124:127], v[108:111], v[228:231]
v_mfma_f32_16x16x32_bf16 v[192:195], v[120:123], v[108:111], v[192:195]
v_mfma_f32_16x16x32_bf16 v[196:199], v[120:123], v[112:115], v[196:199]
v_mfma_f32_16x16x32_bf16 v[232:235], v[124:127], v[112:115], v[232:235]
v_mfma_f32_16x16x32_bf16 v[160:163], v[116:119], v[112:115], v[160:163]
s_waitcnt lgkmcnt(0)
v_mfma_f32_16x16x32_bf16 v[164:167], v[72:75], v[32:35], v[164:167]
ds_read_b128 v[80:83], v3 offset:43008
v_mfma_f32_16x16x32_bf16 v[200:203], v[76:79], v[32:35], v[200:203]
ds_read_b64_tr_b16 v[120:121], v7 offset:12288
v_mfma_f32_16x16x32_bf16 v[128:131], v[68:71], v[32:35], v[128:131]
ds_read_b64_tr_b16 v[122:123], v7 offset:12800
v_mfma_f32_16x16x32_bf16 v[132:135], v[68:71], v[36:39], v[132:135]
ds_read_b64_tr_b16 v[124:125], v7 offset:20480
v_mfma_f32_16x16x32_bf16 v[204:207], v[76:79], v[36:39], v[204:207]
ds_read_b64_tr_b16 v[126:127], v7 offset:20992
v_mfma_f32_16x16x32_bf16 v[168:171], v[72:75], v[36:39], v[168:171]
ds_read_b64_tr_b16 v[116:117], v7 offset:4096
v_mfma_f32_16x16x32_bf16 v[172:175], v[72:75], v[40:43], v[172:175]
ds_read_b64_tr_b16 v[118:119], v7 offset:4608
v_mfma_f32_16x16x32_bf16 v[208:211], v[76:79], v[40:43], v[208:211]
ds_read_b128 v[84:87], v3 offset:45056
v_mfma_f32_16x16x32_bf16 v[136:139], v[68:71], v[40:43], v[136:139]
ds_read_b128 v[88:91], v3 offset:47104
v_mfma_f32_16x16x32_bf16 v[140:143], v[68:71], v[44:47], v[140:143]
ds_read_b128 v[92:95], v3 offset:49152
v_mfma_f32_16x16x32_bf16 v[212:215], v[76:79], v[44:47], v[212:215]
ds_read_b128 v[96:99], v3 offset:51200
v_mfma_f32_16x16x32_bf16 v[176:179], v[72:75], v[44:47], v[176:179]
ds_read_b128 v[100:103], v3 offset:53248
v_mfma_f32_16x16x32_bf16 v[180:183], v[72:75], v[48:51], v[180:183]
ds_read_b128 v[104:107], v3 offset:55296
v_mfma_f32_16x16x32_bf16 v[216:219], v[76:79], v[48:51], v[216:219]
ds_read_b128 v[108:111], v3 offset:57344
v_mfma_f32_16x16x32_bf16 v[144:147], v[68:71], v[48:51], v[144:147]
ds_read_b128 v[112:115], v3 offset:59392
v_mfma_f32_16x16x32_bf16 v[148:151], v[68:71], v[52:55], v[148:151]
v_mfma_f32_16x16x32_bf16 v[220:223], v[76:79], v[52:55], v[220:223]
v_mfma_f32_16x16x32_bf16 v[184:187], v[72:75], v[52:55], v[184:187]
v_mfma_f32_16x16x32_bf16 v[188:191], v[72:75], v[56:59], v[188:191]
v_mfma_f32_16x16x32_bf16 v[224:227], v[76:79], v[56:59], v[224:227]
v_mfma_f32_16x16x32_bf16 v[152:155], v[68:71], v[56:59], v[152:155]
v_mfma_f32_16x16x32_bf16 v[156:159], v[68:71], v[60:63], v[156:159]
v_mfma_f32_16x16x32_bf16 v[228:231], v[76:79], v[60:63], v[228:231]
v_mfma_f32_16x16x32_bf16 v[192:195], v[72:75], v[60:63], v[192:195]
v_mfma_f32_16x16x32_bf16 v[196:199], v[72:75], v[64:67], v[196:199]
v_mfma_f32_16x16x32_bf16 v[232:235], v[76:79], v[64:67], v[232:235]
v_mfma_f32_16x16x32_bf16 v[160:163], v[68:71], v[64:67], v[160:163]
s_waitcnt lgkmcnt(0)
s_barrier
v_mfma_f32_16x16x32_bf16 v[164:167], v[120:123], v[80:83], v[164:167]
ds_read_b128 v[32:35], v4 offset:0
v_mfma_f32_16x16x32_bf16 v[200:203], v[124:127], v[80:83], v[200:203]
ds_read_b64_tr_b16 v[72:73], v8 offset:8192
v_mfma_f32_16x16x32_bf16 v[128:131], v[116:119], v[80:83], v[128:131]
ds_read_b64_tr_b16 v[74:75], v8 offset:8704
v_mfma_f32_16x16x32_bf16 v[132:135], v[116:119], v[84:87], v[132:135]
ds_read_b64_tr_b16 v[76:77], v8 offset:16384
v_mfma_f32_16x16x32_bf16 v[204:207], v[124:127], v[84:87], v[204:207]
ds_read_b64_tr_b16 v[78:79], v8 offset:16896
v_mfma_f32_16x16x32_bf16 v[168:171], v[120:123], v[84:87], v[168:171]
ds_read_b64_tr_b16 v[68:69], v8 offset:0
v_mfma_f32_16x16x32_bf16 v[172:175], v[120:123], v[88:91], v[172:175]
ds_read_b64_tr_b16 v[70:71], v8 offset:512
v_mfma_f32_16x16x32_bf16 v[208:211], v[124:127], v[88:91], v[208:211]
ds_read_b128 v[36:39], v4 offset:2048
v_mfma_f32_16x16x32_bf16 v[136:139], v[116:119], v[88:91], v[136:139]
ds_read_b128 v[40:43], v4 offset:4096
v_mfma_f32_16x16x32_bf16 v[140:143], v[116:119], v[92:95], v[140:143]
ds_read_b128 v[44:47], v4 offset:6144
v_mfma_f32_16x16x32_bf16 v[212:215], v[124:127], v[92:95], v[212:215]
ds_read_b128 v[48:51], v4 offset:8192
v_mfma_f32_16x16x32_bf16 v[176:179], v[120:123], v[92:95], v[176:179]
ds_read_b128 v[52:55], v4 offset:10240
v_mfma_f32_16x16x32_bf16 v[180:183], v[120:123], v[96:99], v[180:183]
ds_read_b128 v[56:59], v4 offset:12288
v_mfma_f32_16x16x32_bf16 v[216:219], v[124:127], v[96:99], v[216:219]
ds_read_b128 v[60:63], v4 offset:14336
v_mfma_f32_16x16x32_bf16 v[144:147], v[116:119], v[96:99], v[144:147]
ds_read_b128 v[64:67], v4 offset:16384
v_mfma_f32_16x16x32_bf16 v[148:151], v[116:119], v[100:103], v[148:151]
v_mfma_f32_16x16x32_bf16 v[220:223], v[124:127], v[100:103], v[220:223]
v_mfma_f32_16x16x32_bf16 v[184:187], v[120:123], v[100:103], v[184:187]
v_mfma_f32_16x16x32_bf16 v[188:191], v[120:123], v[104:107], v[188:191]
v_mfma_f32_16x16x32_bf16 v[224:227], v[124:127], v[104:107], v[224:227]
v_mfma_f32_16x16x32_bf16 v[152:155], v[116:119], v[104:107], v[152:155]
v_mfma_f32_16x16x32_bf16 v[156:159], v[116:119], v[108:111], v[156:159]
v_mfma_f32_16x16x32_bf16 v[228:231], v[124:127], v[108:111], v[228:231]
v_mfma_f32_16x16x32_bf16 v[192:195], v[120:123], v[108:111], v[192:195]
v_mfma_f32_16x16x32_bf16 v[196:199], v[120:123], v[112:115], v[196:199]
v_mfma_f32_16x16x32_bf16 v[232:235], v[124:127], v[112:115], v[232:235]
v_mfma_f32_16x16x32_bf16 v[160:163], v[116:119], v[112:115], v[160:163]
s_waitcnt lgkmcnt(0)
v_mfma_f32_16x16x32_bf16 v[164:167], v[72:75], v[32:35], v[164:167]
ds_read_b128 v[80:83], v5 offset:0
v_mfma_f32_16x16x32_bf16 v[200:203], v[76:79], v[32:35], v[200:203]
ds_read_b64_tr_b16 v[120:121], v8 offset:12288
v_mfma_f32_16x16x32_bf16 v[128:131], v[68:71], v[32:35], v[128:131]
ds_read_b64_tr_b16 v[122:123], v8 offset:12800
v_mfma_f32_16x16x32_bf16 v[132:135], v[68:71], v[36:39], v[132:135]
ds_read_b64_tr_b16 v[124:125], v8 offset:20480
v_mfma_f32_16x16x32_bf16 v[204:207], v[76:79], v[36:39], v[204:207]
ds_read_b64_tr_b16 v[126:127], v8 offset:20992
v_mfma_f32_16x16x32_bf16 v[168:171], v[72:75], v[36:39], v[168:171]
ds_read_b64_tr_b16 v[116:117], v8 offset:4096
v_mfma_f32_16x16x32_bf16 v[172:175], v[72:75], v[40:43], v[172:175]
ds_read_b64_tr_b16 v[118:119], v8 offset:4608
v_mfma_f32_16x16x32_bf16 v[208:211], v[76:79], v[40:43], v[208:211]
ds_read_b128 v[84:87], v5 offset:2048
v_mfma_f32_16x16x32_bf16 v[136:139], v[68:71], v[40:43], v[136:139]
ds_read_b128 v[88:91], v5 offset:4096
v_mfma_f32_16x16x32_bf16 v[140:143], v[68:71], v[44:47], v[140:143]
ds_read_b128 v[92:95], v5 offset:6144
v_mfma_f32_16x16x32_bf16 v[212:215], v[76:79], v[44:47], v[212:215]
ds_read_b128 v[96:99], v5 offset:8192
v_mfma_f32_16x16x32_bf16 v[176:179], v[72:75], v[44:47], v[176:179]
ds_read_b128 v[100:103], v5 offset:10240
v_mfma_f32_16x16x32_bf16 v[180:183], v[72:75], v[48:51], v[180:183]
ds_read_b128 v[104:107], v5 offset:12288
v_mfma_f32_16x16x32_bf16 v[216:219], v[76:79], v[48:51], v[216:219]
ds_read_b128 v[108:111], v5 offset:14336
v_mfma_f32_16x16x32_bf16 v[144:147], v[68:71], v[48:51], v[144:147]
ds_read_b128 v[112:115], v5 offset:16384
v_mfma_f32_16x16x32_bf16 v[148:151], v[68:71], v[52:55], v[148:151]
v_mfma_f32_16x16x32_bf16 v[220:223], v[76:79], v[52:55], v[220:223]
v_mfma_f32_16x16x32_bf16 v[184:187], v[72:75], v[52:55], v[184:187]
v_mfma_f32_16x16x32_bf16 v[188:191], v[72:75], v[56:59], v[188:191]
v_mfma_f32_16x16x32_bf16 v[224:227], v[76:79], v[56:59], v[224:227]
v_mfma_f32_16x16x32_bf16 v[152:155], v[68:71], v[56:59], v[152:155]
v_mfma_f32_16x16x32_bf16 v[156:159], v[68:71], v[60:63], v[156:159]
v_mfma_f32_16x16x32_bf16 v[228:231], v[76:79], v[60:63], v[228:231]
v_mfma_f32_16x16x32_bf16 v[192:195], v[72:75], v[60:63], v[192:195]
v_mfma_f32_16x16x32_bf16 v[196:199], v[72:75], v[64:67], v[196:199]
v_mfma_f32_16x16x32_bf16 v[232:235], v[76:79], v[64:67], v[232:235]
v_mfma_f32_16x16x32_bf16 v[160:163], v[68:71], v[64:67], v[160:163]
s_waitcnt lgkmcnt(0)
s_barrier
v_mfma_f32_16x16x32_bf16 v[164:167], v[120:123], v[80:83], v[164:167]
ds_read_b128 v[32:35], v2 offset:0
v_mfma_f32_16x16x32_bf16 v[200:203], v[124:127], v[80:83], v[200:203]
ds_read_b64_tr_b16 v[72:73], v6 offset:8192
v_mfma_f32_16x16x32_bf16 v[128:131], v[116:119], v[80:83], v[128:131]
ds_read_b64_tr_b16 v[74:75], v6 offset:8704
v_mfma_f32_16x16x32_bf16 v[132:135], v[116:119], v[84:87], v[132:135]
ds_read_b64_tr_b16 v[76:77], v6 offset:16384
v_mfma_f32_16x16x32_bf16 v[204:207], v[124:127], v[84:87], v[204:207]
ds_read_b64_tr_b16 v[78:79], v6 offset:16896
v_mfma_f32_16x16x32_bf16 v[168:171], v[120:123], v[84:87], v[168:171]
ds_read_b64_tr_b16 v[68:69], v6 offset:0
v_mfma_f32_16x16x32_bf16 v[172:175], v[120:123], v[88:91], v[172:175]
ds_read_b64_tr_b16 v[70:71], v6 offset:512
v_mfma_f32_16x16x32_bf16 v[208:211], v[124:127], v[88:91], v[208:211]
ds_read_b128 v[36:39], v2 offset:2048
v_mfma_f32_16x16x32_bf16 v[136:139], v[116:119], v[88:91], v[136:139]
ds_read_b128 v[40:43], v2 offset:4096
v_mfma_f32_16x16x32_bf16 v[140:143], v[116:119], v[92:95], v[140:143]
ds_read_b128 v[44:47], v2 offset:6144
v_mfma_f32_16x16x32_bf16 v[212:215], v[124:127], v[92:95], v[212:215]
ds_read_b128 v[48:51], v2 offset:8192
v_mfma_f32_16x16x32_bf16 v[176:179], v[120:123], v[92:95], v[176:179]
ds_read_b128 v[52:55], v2 offset:10240
v_mfma_f32_16x16x32_bf16 v[180:183], v[120:123], v[96:99], v[180:183]
ds_read_b128 v[56:59], v2 offset:12288
v_mfma_f32_16x16x32_bf16 v[216:219], v[124:127], v[96:99], v[216:219]
ds_read_b128 v[60:63], v2 offset:14336
v_mfma_f32_16x16x32_bf16 v[144:147], v[116:119], v[96:99], v[144:147]
ds_read_b128 v[64:67], v2 offset:16384
v_mfma_f32_16x16x32_bf16 v[148:151], v[116:119], v[100:103], v[148:151]
v_mfma_f32_16x16x32_bf16 v[220:223], v[124:127], v[100:103], v[220:223]
v_mfma_f32_16x16x32_bf16 v[184:187], v[120:123], v[100:103], v[184:187]
v_mfma_f32_16x16x32_bf16 v[188:191], v[120:123], v[104:107], v[188:191]
v_mfma_f32_16x16x32_bf16 v[224:227], v[124:127], v[104:107], v[224:227]
v_mfma_f32_16x16x32_bf16 v[152:155], v[116:119], v[104:107], v[152:155]
v_mfma_f32_16x16x32_bf16 v[156:159], v[116:119], v[108:111], v[156:159]
v_mfma_f32_16x16x32_bf16 v[228:231], v[124:127], v[108:111], v[228:231]
v_mfma_f32_16x16x32_bf16 v[192:195], v[120:123], v[108:111], v[192:195]
v_mfma_f32_16x16x32_bf16 v[196:199], v[120:123], v[112:115], v[196:199]
v_mfma_f32_16x16x32_bf16 v[232:235], v[124:127], v[112:115], v[232:235]
v_mfma_f32_16x16x32_bf16 v[160:163], v[116:119], v[112:115], v[160:163]
s_sub_u32 s41, s41, 1
s_cmp_lg_u32 s41, 0
s_cbranch_scc1 Lcl_16
s_waitcnt lgkmcnt(0)
v_mfma_f32_16x16x32_bf16 v[164:167], v[72:75], v[32:35], v[164:167]
ds_read_b128 v[80:83], v3 offset:0
v_mfma_f32_16x16x32_bf16 v[200:203], v[76:79], v[32:35], v[200:203]
ds_read_b64_tr_b16 v[120:121], v6 offset:12288
v_mfma_f32_16x16x32_bf16 v[128:131], v[68:71], v[32:35], v[128:131]
ds_read_b64_tr_b16 v[122:123], v6 offset:12800
v_mfma_f32_16x16x32_bf16 v[132:135], v[68:71], v[36:39], v[132:135]
ds_read_b64_tr_b16 v[124:125], v6 offset:20480
v_mfma_f32_16x16x32_bf16 v[204:207], v[76:79], v[36:39], v[204:207]
ds_read_b64_tr_b16 v[126:127], v6 offset:20992
v_mfma_f32_16x16x32_bf16 v[168:171], v[72:75], v[36:39], v[168:171]
ds_read_b64_tr_b16 v[116:117], v6 offset:4096
v_mfma_f32_16x16x32_bf16 v[172:175], v[72:75], v[40:43], v[172:175]
ds_read_b64_tr_b16 v[118:119], v6 offset:4608
v_mfma_f32_16x16x32_bf16 v[208:211], v[76:79], v[40:43], v[208:211]
ds_read_b128 v[84:87], v3 offset:2048
v_mfma_f32_16x16x32_bf16 v[136:139], v[68:71], v[40:43], v[136:139]
ds_read_b128 v[88:91], v3 offset:4096
v_mfma_f32_16x16x32_bf16 v[140:143], v[68:71], v[44:47], v[140:143]
ds_read_b128 v[92:95], v3 offset:6144
v_mfma_f32_16x16x32_bf16 v[212:215], v[76:79], v[44:47], v[212:215]
ds_read_b128 v[96:99], v3 offset:8192
v_mfma_f32_16x16x32_bf16 v[176:179], v[72:75], v[44:47], v[176:179]
ds_read_b128 v[100:103], v3 offset:10240
v_mfma_f32_16x16x32_bf16 v[180:183], v[72:75], v[48:51], v[180:183]
ds_read_b128 v[104:107], v3 offset:12288
v_mfma_f32_16x16x32_bf16 v[216:219], v[76:79], v[48:51], v[216:219]
ds_read_b128 v[108:111], v3 offset:14336
v_mfma_f32_16x16x32_bf16 v[144:147], v[68:71], v[48:51], v[144:147]
ds_read_b128 v[112:115], v3 offset:16384
v_mfma_f32_16x16x32_bf16 v[148:151], v[68:71], v[52:55], v[148:151]
v_mfma_f32_16x16x32_bf16 v[220:223], v[76:79], v[52:55], v[220:223]
v_mfma_f32_16x16x32_bf16 v[184:187], v[72:75], v[52:55], v[184:187]
v_mfma_f32_16x16x32_bf16 v[188:191], v[72:75], v[56:59], v[188:191]
v_mfma_f32_16x16x32_bf16 v[224:227], v[76:79], v[56:59], v[224:227]
v_mfma_f32_16x16x32_bf16 v[152:155], v[68:71], v[56:59], v[152:155]
v_mfma_f32_16x16x32_bf16 v[156:159], v[68:71], v[60:63], v[156:159]
v_mfma_f32_16x16x32_bf16 v[228:231], v[76:79], v[60:63], v[228:231]
v_mfma_f32_16x16x32_bf16 v[192:195], v[72:75], v[60:63], v[192:195]
v_mfma_f32_16x16x32_bf16 v[196:199], v[72:75], v[64:67], v[196:199]
v_mfma_f32_16x16x32_bf16 v[232:235], v[76:79], v[64:67], v[232:235]
v_mfma_f32_16x16x32_bf16 v[160:163], v[68:71], v[64:67], v[160:163]
s_waitcnt lgkmcnt(0)
v_mfma_f32_16x16x32_bf16 v[164:167], v[120:123], v[80:83], v[164:167]
v_mfma_f32_16x16x32_bf16 v[200:203], v[124:127], v[80:83], v[200:203]
v_mfma_f32_16x16x32_bf16 v[128:131], v[116:119], v[80:83], v[128:131]
v_mfma_f32_16x16x32_bf16 v[132:135], v[116:119], v[84:87], v[132:135]
v_mfma_f32_16x16x32_bf16 v[204:207], v[124:127], v[84:87], v[204:207]
v_mfma_f32_16x16x32_bf16 v[168:171], v[120:123], v[84:87], v[168:171]
v_mfma_f32_16x16x32_bf16 v[172:175], v[120:123], v[88:91], v[172:175]
v_mfma_f32_16x16x32_bf16 v[208:211], v[124:127], v[88:91], v[208:211]
v_mfma_f32_16x16x32_bf16 v[136:139], v[116:119], v[88:91], v[136:139]
v_mfma_f32_16x16x32_bf16 v[140:143], v[116:119], v[92:95], v[140:143]
v_mfma_f32_16x16x32_bf16 v[212:215], v[124:127], v[92:95], v[212:215]
v_mfma_f32_16x16x32_bf16 v[176:179], v[120:123], v[92:95], v[176:179]
v_mfma_f32_16x16x32_bf16 v[180:183], v[120:123], v[96:99], v[180:183]
v_mfma_f32_16x16x32_bf16 v[216:219], v[124:127], v[96:99], v[216:219]
v_mfma_f32_16x16x32_bf16 v[144:147], v[116:119], v[96:99], v[144:147]
v_mfma_f32_16x16x32_bf16 v[148:151], v[116:119], v[100:103], v[148:151]
v_mfma_f32_16x16x32_bf16 v[220:223], v[124:127], v[100:103], v[220:223]
v_mfma_f32_16x16x32_bf16 v[184:187], v[120:123], v[100:103], v[184:187]
v_mfma_f32_16x16x32_bf16 v[188:191], v[120:123], v[104:107], v[188:191]
v_mfma_f32_16x16x32_bf16 v[224:227], v[124:127], v[104:107], v[224:227]
v_mfma_f32_16x16x32_bf16 v[152:155], v[116:119], v[104:107], v[152:155]
v_mfma_f32_16x16x32_bf16 v[156:159], v[116:119], v[108:111], v[156:159]
v_mfma_f32_16x16x32_bf16 v[228:231], v[124:127], v[108:111], v[228:231]
v_mfma_f32_16x16x32_bf16 v[192:195], v[120:123], v[108:111], v[192:195]
v_mfma_f32_16x16x32_bf16 v[196:199], v[120:123], v[112:115], v[196:199]
v_mfma_f32_16x16x32_bf16 v[232:235], v[124:127], v[112:115], v[232:235]
v_mfma_f32_16x16x32_bf16 v[160:163], v[116:119], v[112:115], v[160:163]
v_lshlrev_b32 v14, 3, v12
v_add_u32 v14, 147456, v14
v_mul_u32_u24 v15, 400, v12
v_lshl_add_u32 v15, v13, 3, v15
s_lshl_b32 s43, s36, 5
v_add_u32 v15, s43, v15
s_barrier
ds_read_b64 v[32:33], v14 offset:0
ds_read_b64 v[34:35], v14 offset:128
ds_read_b64 v[36:37], v14 offset:256
ds_read_b64 v[38:39], v14 offset:384
ds_read_b64 v[40:41], v14 offset:512
ds_read_b64 v[42:43], v14 offset:640
ds_read_b64 v[44:45], v14 offset:768
ds_read_b64 v[46:47], v14 offset:896
ds_read_b64 v[48:49], v14 offset:1024
v_mov_b32_dpp v52, v128 row_newbcast:0 row_mask:0xf bank_mask:0xf
v_mov_b32_dpp v53, v129 row_newbcast:0 row_mask:0xf bank_mask:0xf
v_mov_b32_dpp v54, v130 row_newbcast:0 row_mask:0xf bank_mask:0xf
v_mov_b32_dpp v55, v131 row_newbcast:0 row_mask:0xf bank_mask:0xf
v_mov_b32_dpp v56, v164 row_newbcast:0 row_mask:0xf bank_mask:0xf
v_mov_b32_dpp v57, v165 row_newbcast:0 row_mask:0xf bank_mask:0xf
v_mov_b32_dpp v58, v166 row_newbcast:0 row_mask:0xf bank_mask:0xf
v_mov_b32_dpp v59, v167 row_newbcast:0 row_mask:0xf bank_mask:0xf
v_mov_b32_dpp v60, v200 row_newbcast:0 row_mask:0xf bank_mask:0xf
v_mov_b32_dpp v61, v201 row_newbcast:0 row_mask:0xf bank_mask:0xf
v_mov_b32_dpp v62, v202 row_newbcast:0 row_mask:0xf bank_mask:0xf
v_mov_b32_dpp v63, v203 row_newbcast:0 row_mask:0xf bank_mask:0xf
s_waitcnt lgkmcnt(0)
v_pk_fma_f32 v[164:165], v[32:33], v[56:57], v[164:165] op_sel_hi:[0,1,1] neg_lo:[1,0,0] neg_hi:[1,0,0]
v_pk_fma_f32 v[166:167], v[32:33], v[58:59], v[166:167] op_sel_hi:[0,1,1] neg_lo:[1,0,0] neg_hi:[1,0,0]
v_pk_fma_f32 v[200:201], v[32:33], v[60:61], v[200:201] op_sel_hi:[0,1,1] neg_lo:[1,0,0] neg_hi:[1,0,0]
v_pk_fma_f32 v[202:203], v[32:33], v[62:63], v[202:203] op_sel_hi:[0,1,1] neg_lo:[1,0,0] neg_hi:[1,0,0]
v_pk_mul_f32 v[164:165], v[32:33], v[164:165] op_sel:[1,0] op_sel_hi:[1,1]
v_pk_mul_f32 v[166:167], v[32:33], v[166:167] op_sel:[1,0] op_sel_hi:[1,1]
v_pk_fma_f32 v[132:133], v[34:35], v[52:53], v[132:133] op_sel_hi:[0,1,1] neg_lo:[1,0,0] neg_hi:[1,0,0]
v_pk_fma_f32 v[134:135], v[34:35], v[54:55], v[134:135] op_sel_hi:[0,1,1] neg_lo:[1,0,0] neg_hi:[1,0,0]
v_pk_mul_f32 v[200:201], v[32:33], v[200:201] op_sel:[1,0] op_sel_hi:[1,1]
v_pk_mul_f32 v[202:203], v[32:33], v[202:203] op_sel:[1,0] op_sel_hi:[1,1]
v_cvt_pk_bf16_f32 v164, v164, v165
v_cvt_pk_bf16_f32 v165, v166, v167
ds_write_b64 v15, v[164:165] offset:128
v_pk_fma_f32 v[168:169], v[34:35], v[56:57], v[168:169] op_sel_hi:[0,1,1] neg_lo:[1,0,0] neg_hi:[1,0,0]
v_pk_fma_f32 v[170:171], v[34:35], v[58:59], v[170:171] op_sel_hi:[0,1,1] neg_lo:[1,0,0] neg_hi:[1,0,0]
v_pk_mul_f32 v[132:133], v[34:35], v[132:133] op_sel:[1,0] op_sel_hi:[1,1]
v_pk_mul_f32 v[134:135], v[34:35], v[134:135] op_sel:[1,0] op_sel_hi:[1,1]
v_cvt_pk_bf16_f32 v200, v200, v201
v_cvt_pk_bf16_f32 v201, v202, v203
ds_write_b64 v15, v[200:201] offset:256
v_pk_fma_f32 v[204:205], v[34:35], v[60:61], v[204:205] op_sel_hi:[0,1,1] neg_lo:[1,0,0] neg_hi:[1,0,0]
v_pk_fma_f32 v[206:207], v[34:35], v[62:63], v[206:207] op_sel_hi:[0,1,1] neg_lo:[1,0,0] neg_hi:[1,0,0]
v_pk_mul_f32 v[168:169], v[34:35], v[168:169] op_sel:[1,0] op_sel_hi:[1,1]
v_pk_mul_f32 v[170:171], v[34:35], v[170:171] op_sel:[1,0] op_sel_hi:[1,1]
v_cvt_pk_bf16_f32 v132, v132, v133
v_cvt_pk_bf16_f32 v133, v134, v135
ds_write_b64 v15, v[132:133] offset:6400
v_pk_fma_f32 v[136:137], v[36:37], v[52:53], v[136:137] op_sel_hi:[0,1,1] neg_lo:[1,0,0] neg_hi:[1,0,0]
v_pk_fma_f32 v[138:139], v[36:37], v[54:55], v[138:139] op_sel_hi:[0,1,1] neg_lo:[1,0,0] neg_hi:[1,0,0]
v_pk_mul_f32 v[204:205], v[34:35], v[204:205] op_sel:[1,0] op_sel_hi:[1,1]
v_pk_mul_f32 v[206:207], v[34:35], v[206:207] op_sel:[1,0] op_sel_hi:[1,1]
v_cvt_pk_bf16_f32 v168, v168, v169
v_cvt_pk_bf16_f32 v169, v170, v171
ds_write_b64 v15, v[168:169] offset:6528
v_pk_fma_f32 v[172:173], v[36:37], v[56:57], v[172:173] op_sel_hi:[0,1,1] neg_lo:[1,0,0] neg_hi:[1,0,0]
v_pk_fma_f32 v[174:175], v[36:37], v[58:59], v[174:175] op_sel_hi:[0,1,1] neg_lo:[1,0,0] neg_hi:[1,0,0]
v_pk_mul_f32 v[136:137], v[36:37], v[136:137] op_sel:[1,0] op_sel_hi:[1,1]
v_pk_mul_f32 v[138:139], v[36:37], v[138:139] op_sel:[1,0] op_sel_hi:[1,1]
v_cvt_pk_bf16_f32 v204, v204, v205
v_cvt_pk_bf16_f32 v205, v206, v207
ds_write_b64 v15, v[204:205] offset:6656
v_pk_fma_f32 v[208:209], v[36:37], v[60:61], v[208:209] op_sel_hi:[0,1,1] neg_lo:[1,0,0] neg_hi:[1,0,0]
v_pk_fma_f32 v[210:211], v[36:37], v[62:63], v[210:211] op_sel_hi:[0,1,1] neg_lo:[1,0,0] neg_hi:[1,0,0]
v_pk_mul_f32 v[172:173], v[36:37], v[172:173] op_sel:[1,0] op_sel_hi:[1,1]
v_pk_mul_f32 v[174:175], v[36:37], v[174:175] op_sel:[1,0] op_sel_hi:[1,1]
v_cvt_pk_bf16_f32 v136, v136, v137
v_cvt_pk_bf16_f32 v137, v138, v139
ds_write_b64 v15, v[136:137] offset:12800
v_pk_fma_f32 v[140:141], v[38:39], v[52:53], v[140:141] op_sel_hi:[0,1,1] neg_lo:[1,0,0] neg_hi:[1,0,0]
v_pk_fma_f32 v[142:143], v[38:39], v[54:55], v[142:143] op_sel_hi:[0,1,1] neg_lo:[1,0,0] neg_hi:[1,0,0]
v_pk_mul_f32 v[208:209], v[36:37], v[208:209] op_sel:[1,0] op_sel_hi:[1,1]
v_pk_mul_f32 v[210:211], v[36:37], v[210:211] op_sel:[1,0] op_sel_hi:[1,1]
v_cvt_pk_bf16_f32 v172, v172, v173
v_cvt_pk_bf16_f32 v173, v174, v175
ds_write_b64 v15, v[172:173] offset:12928
v_pk_fma_f32 v[176:177], v[38:39], v[56:57], v[176:177] op_sel_hi:[0,1,1] neg_lo:[1,0,0] neg_hi:[1,0,0]
v_pk_fma_f32 v[178:179], v[38:39], v[58:59], v[178:179] op_sel_hi:[0,1,1] neg_lo:[1,0,0] neg_hi:[1,0,0]
v_pk_mul_f32 v[140:141], v[38:39], v[140:141] op_sel:[1,0] op_sel_hi:[1,1]
v_pk_mul_f32 v[142:143], v[38:39], v[142:143] op_sel:[1,0] op_sel_hi:[1,1]
v_cvt_pk_bf16_f32 v208, v208, v209
v_cvt_pk_bf16_f32 v209, v210, v211
ds_write_b64 v15, v[208:209] offset:13056
v_pk_fma_f32 v[212:213], v[38:39], v[60:61], v[212:213] op_sel_hi:[0,1,1] neg_lo:[1,0,0] neg_hi:[1,0,0]
v_pk_fma_f32 v[214:215], v[38:39], v[62:63], v[214:215] op_sel_hi:[0,1,1] neg_lo:[1,0,0] neg_hi:[1,0,0]
v_pk_mul_f32 v[176:177], v[38:39], v[176:177] op_sel:[1,0] op_sel_hi:[1,1]
v_pk_mul_f32 v[178:179], v[38:39], v[178:179] op_sel:[1,0] op_sel_hi:[1,1]
v_cvt_pk_bf16_f32 v140, v140, v141
v_cvt_pk_bf16_f32 v141, v142, v143
ds_write_b64 v15, v[140:141] offset:19200
v_pk_fma_f32 v[144:145], v[40:41], v[52:53], v[144:145] op_sel_hi:[0,1,1] neg_lo:[1,0,0] neg_hi:[1,0,0]
v_pk_fma_f32 v[146:147], v[40:41], v[54:55], v[146:147] op_sel_hi:[0,1,1] neg_lo:[1,0,0] neg_hi:[1,0,0]
v_pk_mul_f32 v[212:213], v[38:39], v[212:213] op_sel:[1,0] op_sel_hi:[1,1]
v_pk_mul_f32 v[214:215], v[38:39], v[214:215] op_sel:[1,0] op_sel_hi:[1,1]
v_cvt_pk_bf16_f32 v176, v176, v177
v_cvt_pk_bf16_f32 v177, v178, v179
ds_write_b64 v15, v[176:177] offset:19328
v_pk_fma_f32 v[180:181], v[40:41], v[56:57], v[180:181] op_sel_hi:[0,1,1] neg_lo:[1,0,0] neg_hi:[1,0,0]
v_pk_fma_f32 v[182:183], v[40:41], v[58:59], v[182:183] op_sel_hi:[0,1,1] neg_lo:[1,0,0] neg_hi:[1,0,0]
v_pk_mul_f32 v[144:145], v[40:41], v[144:145] op_sel:[1,0] op_sel_hi:[1,1]
v_pk_mul_f32 v[146:147], v[40:41], v[146:147] op_sel:[1,0] op_sel_hi:[1,1]
v_cvt_pk_bf16_f32 v212, v212, v213
v_cvt_pk_bf16_f32 v213, v214, v215
ds_write_b64 v15, v[212:213] offset:19456
v_pk_fma_f32 v[216:217], v[40:41], v[60:61], v[216:217] op_sel_hi:[0,1,1] neg_lo:[1,0,0] neg_hi:[1,0,0]
v_pk_fma_f32 v[218:219], v[40:41], v[62:63], v[218:219] op_sel_hi:[0,1,1] neg_lo:[1,0,0] neg_hi:[1,0,0]
v_pk_mul_f32 v[180:181], v[40:41], v[180:181] op_sel:[1,0] op_sel_hi:[1,1]
v_pk_mul_f32 v[182:183], v[40:41], v[182:183] op_sel:[1,0] op_sel_hi:[1,1]
v_cvt_pk_bf16_f32 v144, v144, v145
v_cvt_pk_bf16_f32 v145, v146, v147
ds_write_b64 v15, v[144:145] offset:25600
v_pk_fma_f32 v[148:149], v[42:43], v[52:53], v[148:149] op_sel_hi:[0,1,1] neg_lo:[1,0,0] neg_hi:[1,0,0]
v_pk_fma_f32 v[150:151], v[42:43], v[54:55], v[150:151] op_sel_hi:[0,1,1] neg_lo:[1,0,0] neg_hi:[1,0,0]
v_pk_mul_f32 v[216:217], v[40:41], v[216:217] op_sel:[1,0] op_sel_hi:[1,1]
v_pk_mul_f32 v[218:219], v[40:41], v[218:219] op_sel:[1,0] op_sel_hi:[1,1]
v_cvt_pk_bf16_f32 v180, v180, v181
v_cvt_pk_bf16_f32 v181, v182, v183
ds_write_b64 v15, v[180:181] offset:25728
v_pk_fma_f32 v[184:185], v[42:43], v[56:57], v[184:185] op_sel_hi:[0,1,1] neg_lo:[1,0,0] neg_hi:[1,0,0]
v_pk_fma_f32 v[186:187], v[42:43], v[58:59], v[186:187] op_sel_hi:[0,1,1] neg_lo:[1,0,0] neg_hi:[1,0,0]
v_pk_mul_f32 v[148:149], v[42:43], v[148:149] op_sel:[1,0] op_sel_hi:[1,1]
v_pk_mul_f32 v[150:151], v[42:43], v[150:151] op_sel:[1,0] op_sel_hi:[1,1]
v_cvt_pk_bf16_f32 v216, v216, v217
v_cvt_pk_bf16_f32 v217, v218, v219
ds_write_b64 v15, v[216:217] offset:25856
v_pk_fma_f32 v[220:221], v[42:43], v[60:61], v[220:221] op_sel_hi:[0,1,1] neg_lo:[1,0,0] neg_hi:[1,0,0]
v_pk_fma_f32 v[222:223], v[42:43], v[62:63], v[222:223] op_sel_hi:[0,1,1] neg_lo:[1,0,0] neg_hi:[1,0,0]
v_pk_mul_f32 v[184:185], v[42:43], v[184:185] op_sel:[1,0] op_sel_hi:[1,1]
v_pk_mul_f32 v[186:187], v[42:43], v[186:187] op_sel:[1,0] op_sel_hi:[1,1]
v_cvt_pk_bf16_f32 v148, v148, v149
v_cvt_pk_bf16_f32 v149, v150, v151
ds_write_b64 v15, v[148:149] offset:32000
v_pk_fma_f32 v[152:153], v[44:45], v[52:53], v[152:153] op_sel_hi:[0,1,1] neg_lo:[1,0,0] neg_hi:[1,0,0]
v_pk_fma_f32 v[154:155], v[44:45], v[54:55], v[154:155] op_sel_hi:[0,1,1] neg_lo:[1,0,0] neg_hi:[1,0,0]
v_pk_mul_f32 v[220:221], v[42:43], v[220:221] op_sel:[1,0] op_sel_hi:[1,1]
v_pk_mul_f32 v[222:223], v[42:43], v[222:223] op_sel:[1,0] op_sel_hi:[1,1]
v_cvt_pk_bf16_f32 v184, v184, v185
v_cvt_pk_bf16_f32 v185, v186, v187
ds_write_b64 v15, v[184:185] offset:32128
v_pk_fma_f32 v[188:189], v[44:45], v[56:57], v[188:189] op_sel_hi:[0,1,1] neg_lo:[1,0,0] neg_hi:[1,0,0]
v_pk_fma_f32 v[190:191], v[44:45], v[58:59], v[190:191] op_sel_hi:[0,1,1] neg_lo:[1,0,0] neg_hi:[1,0,0]
v_pk_mul_f32 v[152:153], v[44:45], v[152:153] op_sel:[1,0] op_sel_hi:[1,1]
v_pk_mul_f32 v[154:155], v[44:45], v[154:155] op_sel:[1,0] op_sel_hi:[1,1]
v_cvt_pk_bf16_f32 v220, v220, v221
v_cvt_pk_bf16_f32 v221, v222, v223
ds_write_b64 v15, v[220:221] offset:32256
v_pk_fma_f32 v[224:225], v[44:45], v[60:61], v[224:225] op_sel_hi:[0,1,1] neg_lo:[1,0,0] neg_hi:[1,0,0]
v_pk_fma_f32 v[226:227], v[44:45], v[62:63], v[226:227] op_sel_hi:[0,1,1] neg_lo:[1,0,0] neg_hi:[1,0,0]
v_pk_mul_f32 v[188:189], v[44:45], v[188:189] op_sel:[1,0] op_sel_hi:[1,1]
v_pk_mul_f32 v[190:191], v[44:45], v[190:191] op_sel:[1,0] op_sel_hi:[1,1]
v_cvt_pk_bf16_f32 v152, v152, v153
v_cvt_pk_bf16_f32 v153, v154, v155
ds_write_b64 v15, v[152:153] offset:38400
v_pk_fma_f32 v[156:157], v[46:47], v[52:53], v[156:157] op_sel_hi:[0,1,1] neg_lo:[1,0,0] neg_hi:[1,0,0]
v_pk_fma_f32 v[158:159], v[46:47], v[54:55], v[158:159] op_sel_hi:[0,1,1] neg_lo:[1,0,0] neg_hi:[1,0,0]
v_pk_mul_f32 v[224:225], v[44:45], v[224:225] op_sel:[1,0] op_sel_hi:[1,1]
v_pk_mul_f32 v[226:227], v[44:45], v[226:227] op_sel:[1,0] op_sel_hi:[1,1]
v_cvt_pk_bf16_f32 v188, v188, v189
v_cvt_pk_bf16_f32 v189, v190, v191
ds_write_b64 v15, v[188:189] offset:38528
v_pk_fma_f32 v[192:193], v[46:47], v[56:57], v[192:193] op_sel_hi:[0,1,1] neg_lo:[1,0,0] neg_hi:[1,0,0]
v_pk_fma_f32 v[194:195], v[46:47], v[58:59], v[194:195] op_sel_hi:[0,1,1] neg_lo:[1,0,0] neg_hi:[1,0,0]
v_pk_mul_f32 v[156:157], v[46:47], v[156:157] op_sel:[1,0] op_sel_hi:[1,1]
v_pk_mul_f32 v[158:159], v[46:47], v[158:159] op_sel:[1,0] op_sel_hi:[1,1]
v_cvt_pk_bf16_f32 v224, v224, v225
v_cvt_pk_bf16_f32 v225, v226, v227
ds_write_b64 v15, v[224:225] offset:38656
v_pk_fma_f32 v[228:229], v[46:47], v[60:61], v[228:229] op_sel_hi:[0,1,1] neg_lo:[1,0,0] neg_hi:[1,0,0]
v_pk_fma_f32 v[230:231], v[46:47], v[62:63], v[230:231] op_sel_hi:[0,1,1] neg_lo:[1,0,0] neg_hi:[1,0,0]
v_pk_mul_f32 v[192:193], v[46:47], v[192:193] op_sel:[1,0] op_sel_hi:[1,1]
v_pk_mul_f32 v[194:195], v[46:47], v[194:195] op_sel:[1,0] op_sel_hi:[1,1]
v_cvt_pk_bf16_f32 v156, v156, v157
v_cvt_pk_bf16_f32 v157, v158, v159
ds_write_b64 v15, v[156:157] offset:44800
v_pk_fma_f32 v[160:161], v[48:49], v[52:53], v[160:161] op_sel_hi:[0,1,1] neg_lo:[1,0,0] neg_hi:[1,0,0]
v_pk_fma_f32 v[162:163], v[48:49], v[54:55], v[162:163] op_sel_hi:[0,1,1] neg_lo:[1,0,0] neg_hi:[1,0,0]
v_pk_mul_f32 v[228:229], v[46:47], v[228:229] op_sel:[1,0] op_sel_hi:[1,1]
v_pk_mul_f32 v[230:231], v[46:47], v[230:231] op_sel:[1,0] op_sel_hi:[1,1]
v_cvt_pk_bf16_f32 v192, v192, v193
v_cvt_pk_bf16_f32 v193, v194, v195
ds_write_b64 v15, v[192:193] offset:44928
v_pk_fma_f32 v[196:197], v[48:49], v[56:57], v[196:197] op_sel_hi:[0,1,1] neg_lo:[1,0,0] neg_hi:[1,0,0]
v_pk_fma_f32 v[198:199], v[48:49], v[58:59], v[198:199] op_sel_hi:[0,1,1] neg_lo:[1,0,0] neg_hi:[1,0,0]
v_pk_mul_f32 v[160:161], v[48:49], v[160:161] op_sel:[1,0] op_sel_hi:[1,1]
v_pk_mul_f32 v[162:163], v[48:49], v[162:163] op_sel:[1,0] op_sel_hi:[1,1]
v_cvt_pk_bf16_f32 v228, v228, v229
v_cvt_pk_bf16_f32 v229, v230, v231
ds_write_b64 v15, v[228:229] offset:45056
v_pk_fma_f32 v[232:233], v[48:49], v[60:61], v[232:233] op_sel_hi:[0,1,1] neg_lo:[1,0,0] neg_hi:[1,0,0]
v_pk_fma_f32 v[234:235], v[48:49], v[62:63], v[234:235] op_sel_hi:[0,1,1] neg_lo:[1,0,0] neg_hi:[1,0,0]
v_pk_mul_f32 v[196:197], v[48:49], v[196:197] op_sel:[1,0] op_sel_hi:[1,1]
v_pk_mul_f32 v[198:199], v[48:49], v[198:199] op_sel:[1,0] op_sel_hi:[1,1]
v_cvt_pk_bf16_f32 v160, v160, v161
v_cvt_pk_bf16_f32 v161, v162, v163
ds_write_b64 v15, v[160:161] offset:51200
v_pk_mul_f32 v[232:233], v[48:49], v[232:233] op_sel:[1,0] op_sel_hi:[1,1]
v_pk_mul_f32 v[234:235], v[48:49], v[234:235] op_sel:[1,0] op_sel_hi:[1,1]
v_cvt_pk_bf16_f32 v196, v196, v197
v_cvt_pk_bf16_f32 v197, v198, v199
ds_write_b64 v15, v[196:197] offset:51328
v_cvt_pk_bf16_f32 v232, v232, v233
v_cvt_pk_bf16_f32 v233, v234, v235
ds_write_b64 v15, v[232:233] offset:51456
s_waitcnt lgkmcnt(0)
s_branch Latt_5
Lpf_4:
s_lshl_b32 s43, s35, 7
s_waitcnt lgkmcnt(0)
s_mov_b32 s8, s64
s_mov_b32 s9, s65
s_mov_b32 s10, 4194304
s_mov_b32 s11, 0x20000
s_add_u32 s12, s66, s43
s_addc_u32 s13, s67, 0
s_mov_b32 s14, 6289536
s_mov_b32 s15, 0x20000
s_add_u32 s84, s82, 28311552
s_addc_u32 s85, s83, 0
s_mov_b32 s86, 114688
s_mov_b32 s87, 0x20000
s_mov_b32 s56, s80
s_mov_b32 s57, s81
s_mov_b32 s58, 256
s_mov_b32 s59, 0x20000
v_mov_b32 v5, 0
v_lshlrev_b32 v14, 7, v1
s_or_b32 s43, s34, s35
s_cmp_lg_u32 s43, 0
s_cbranch_scc1 Lz_17
s_movk_i32 s43, 0x2000
buffer_store_dword v5, v14, s[84:87], 0 offen sc1
s_bfm_b64 exec, 44, 0
buffer_store_dword v5, v14, s[84:87], s43 offen sc1
s_mov_b64 exec, 1
v_mov_b32 v6, 1
s_waitcnt vmcnt(0)
buffer_store_dword v6, v5, s[56:59], 0 offen sc1
s_mov_b64 exec, -1
Lz_17:
s_lshl_b32 s43, s51, 11
buffer_load_dwordx4 v[96:99], v10, s[8:11], s43 offen offset:0
buffer_load_dwordx4 v[100:103], v10, s[8:11], s43 offen offset:1024
s_branch Lov_3
.p2align 12
.fill 16, 4, 0xbf800000
Lst_3_0:
s_branch Lwr_148
s_nop 0
s_nop 0
Lov_3:
buffer_load_dwordx4 v[104:107], v10, s[8:11], s43 offen offset:2048
buffer_load_dwordx4 v[108:111], v10, s[8:11], s43 offen offset:3072
v_min_u32 v14, 23, v1
v_lshrrev_b32 v15, 3, v14
v_mul_u32_u24 v15, 43008, v15
v_and_b32 v14, 7, v14
v_lshl_add_u32 v15, v14, 4, v15
v_mov_b32 v32, 0x3f803f80
v_mov_b32 v33, 0x3f803f80
v_mov_b32 v34, 0x3f803f80
v_mov_b32 v35, 0x3f803f80
ds_write_b128 v15, v[32:35]
s_add_u32 s20, s82, 26214400
s_addc_u32 s21, s83, 0
s_mov_b32 s22, 16384
s_mov_b32 s23, 0x20000
s_add_u32 s43, s2, 128
s_lshl_b32 s43, s43, 7
v_lshlrev_b32 v14, 2, v1
s_mov_b64 exec, 15
buffer_store_dword v5, v14, s[84:87], s43 offen sc1
s_mov_b64 exec, -1
s_lshl_b32 s43, s34, 4
s_add_u32 s43, s43, s35
s_lshl_b32 s43, s43, 8
s_add_u32 s43, s43, 49152
v_lshlrev_b32 v14, 7, v1
s_mov_b64 exec, 3
buffer_store_dword v5, v14, s[84:87], s43 offen sc1
s_mov_b64 exec, -1
s_lshl_b32 s52, s34, 7
s_add_u32 s52, s52, 28319744
s_sub_u32 s53, s52, 128
s_cmp_eq_u32 s34, 0
s_cselect_b32 s53, s52, s53
s_waitcnt lgkmcnt(0)
s_barrier
s_waitcnt vmcnt(2)
s_mov_b32 s43, 0x3f803f80
v_mov_b32 v116, 0
v_mov_b32 v117, 0
v_mov_b32 v118, 0
v_mov_b32 v119, 0
v_mov_b32 v120, 0
v_mov_b32 v121, 0
v_mov_b32 v122, 0
v_mov_b32 v123, 0
v_dot2_f32_bf16 v116, v96, s43, v116
v_dot2_f32_bf16 v120, v96, v96, v120
v_dot2_f32_bf16 v118, v104, s43, v118
v_dot2_f32_bf16 v122, v104, v104, v122
v_dot2_f32_bf16 v117, v97, s43, v117
v_dot2_f32_bf16 v121, v97, v97, v121
v_dot2_f32_bf16 v119, v105, s43, v119
v_dot2_f32_bf16 v123, v105, v105, v123
v_dot2_f32_bf16 v116, v98, s43, v116
v_dot2_f32_bf16 v120, v98, v98, v120
v_dot2_f32_bf16 v118, v106, s43, v118
v_dot2_f32_bf16 v122, v106, v106, v122
v_dot2_f32_bf16 v117, v99, s43, v117
v_dot2_f32_bf16 v121, v99, v99, v121
v_dot2_f32_bf16 v119, v107, s43, v119
v_dot2_f32_bf16 v123, v107, v107, v123
v_dot2_f32_bf16 v116, v100, s43, v116
v_dot2_f32_bf16 v120, v100, v100, v120
v_dot2_f32_bf16 v118, v108, s43, v118
v_dot2_f32_bf16 v122, v108, v108, v122
v_dot2_f32_bf16 v117, v101, s43, v117
v_dot2_f32_bf16 v121, v101, v101, v121
v_dot2_f32_bf16 v119, v109, s43, v119
v_dot2_f32_bf16 v123, v109, v109, v123
v_dot2_f32_bf16 v116, v102, s43, v116
v_dot2_f32_bf16 v120, v102, v102, v120
v_dot2_f32_bf16 v118, v110, s43, v118
v_dot2_f32_bf16 v122, v110, v110, v122
v_dot2_f32_bf16 v117, v103, s43, v117
v_dot2_f32_bf16 v121, v103, v103, v121
v_dot2_f32_bf16 v119, v111, s43, v119
v_dot2_f32_bf16 v123, v111, v111, v123
s_nop 2
v_add_f32 v116, v116, v117
v_add_f32 v118, v118, v119
v_add_f32 v120, v120, v121
v_add_f32 v122, v122, v123
s_nop 1
v_permlane32_swap_b32 v116, v118
v_permlane32_swap_b32 v120, v122
v_add_f32 v116, v116, v118
v_add_f32 v120, v120, v122
s_nop 1
v_permlane16_swap_b32 v116, v120
v_add_f32 v116, v116, v120
s_nop 1
v_add_f32_dpp v116, v116, v116 row_ror:8 row_mask:0xf bank_mask:0xf
s_nop 1
v_add_f32_dpp v116, v116, v116 row_ror:4 row_mask:0xf bank_mask:0xf
s_nop 1
v_add_f32_dpp v116, v116, v116 row_ror:2 row_mask:0xf bank_mask:0xf
s_nop 1
v_add_f32_dpp v116, v116, v116 row_ror:1 row_mask:0xf bank_mask:0xf
v_mov_b32 v117, v116
s_nop 1
v_permlane16_swap_b32 v116, v117
v_mul_f32 v112, 0x3a800000, v116
v_mul_f32 v113, 0x3a800000, v117
v_fma_f32 v113, -v112, v112, v113
v_max_f32 v113, 0, v113
v_add_f32 v113, 0x3727c5ac, v113
v_rsq_f32 v113, v113
v_lshrrev_b32 v11, 5, v1
s_lshl_b32 s43, s47, 4
s_add_u32 s43, s43, 148608
v_lshl_add_u32 v11, v11, 3, s43
ds_write_b64 v11, v[112:113]
s_waitcnt lgkmcnt(0)
s_mov_b32 s28, s66
s_mov_b32 s29, s67
s_mov_b32 s30, 6291456
s_mov_b32 s31, 0x20000
s_mul_i32 s43, s33, 7040
s_add_u32 s43, s43, 1179648
v_lshlrev_b32 v30, 7, v1
s_bfm_b64 exec, 55, 0
buffer_load_dword v31, v30, s[28:31], s43 offen
s_mov_b64 exec, -1
s_branch Lst_0_0
Lwr_145:
s_barrier
v_lshlrev_b32 v5, 4, v1
v_and_b32 v5, 63, v5
v_add_u32 v6, 148608, v5
ds_read_b128 v[112:115], v6
s_lshl_b32 s43, s63, 3
v_add_u32 v5, s43, v5
s_waitcnt lgkmcnt(0)
s_mov_b64 exec, 15
buffer_store_dwordx4 v[112:115], v5, s[20:23], 0 offen sc1
s_mov_b64 exec, -1
v_mov_b32 v4, 0
buffer_load_dword v6, v4, s[56:59], 0 offen sc1
s_mov_b32 s62, 0
s_mov_b32 s28, s66
s_mov_b32 s29, s67
s_mov_b32 s30, 6291456
s_mov_b32 s31, 0x20000
s_mul_i32 s43, s33, 15872
s_add_u32 s43, s43, 2752512
v_lshlrev_b32 v30, 7, v1
buffer_load_dword v31, v30, s[28:31], s43 offen
s_add_u32 s43, s43, 8192
s_bfm_b64 exec, 60, 0
buffer_load_dword v31, v30, s[28:31], s43 offen
s_mov_b64 exec, -1
s_lshl_b32 s43, s35, 7
s_add_u32 s28, s68, s43
s_addc_u32 s29, s69, 0
s_mov_b32 s30, 2095232
s_mov_b32 s31, 0x20000
v_and_b32 v29, 7, v1
v_lshrrev_b32 v30, 3, v1
v_lshl_add_u32 v29, v30, 6, v29
s_lshl_b32 s43, s48, 3
v_add_u32 v29, s43, v29
v_lshlrev_b32 v29, 11, v29
s_mov_b32 s43, 1048576
s_mov_b32 s28, s68
s_mov_b32 s29, s69
s_mov_b32 s30, 2097152
s_mov_b32 s31, 0x20000
s_mul_i32 s43, s33, 9472
v_lshlrev_b32 v30, 7, v1
buffer_load_dword v31, v30, s[28:31], s43 offen
s_add_u32 s43, s43, 8192
s_bfm_b64 exec, 10, 0
buffer_load_dword v31, v30, s[28:31], s43 offen
s_mov_b64 exec, -1
s_branch Lst_1_0
Lwr_146:
s_barrier
s_branch Lst_2_0
Lwr_147:
s_barrier
s_branch Lst_3_0
Lwr_148:
s_barrier
s_branch Lst_4_0
Lwr_149:
s_barrier
s_branch Lst_5_0
Lwr_150:
s_barrier
s_cmp_eq_u32 s62, 3
s_cbranch_scc1 Lste_21
s_cmp_eq_u32 s62, 2
s_cbranch_scc1 Lst2_19
s_cmp_ge_u32 s62, 4
s_cbranch_scc1 Lst4_20
s_cmp_eq_u32 s62, 1
s_cbranch_scc1 Lst1_18
s_waitcnt vmcnt(4)
v_readfirstlane_b32 s54, v6
s_cmp_eq_u32 s54, 0
s_cbranch_scc0 Lrep_22
buffer_load_dword v6, v4, s[56:59], 0 offen sc1
s_branch Lste_21
Lrep_22:
s_add_u32 s7, s34, 64
s_lshl_b32 s7, s7, 7
v_mov_b32 v5, s7
v_mov_b32 v6, 1
s_mov_b64 exec, 1
buffer_atomic_add v6, v5, s[84:87], 0 offen sc1
s_mov_b64 exec, -1
s_mov_b32 s62, 1
s_mov_b32 s54, 0
s_mov_b32 s55, 0
s_branch Lste_21
Lst1_18:
s_and_b32 s43, s54, s55
s_cmp_eq_u32 s43, 16
s_cbranch_scc1 Lg_23
s_load_dword s54, s[82:83], s52 glc
s_load_dword s55, s[82:83], s53 glc
s_branch Lste_21
Lg_23:
v_add_u32 v5, 0, v1
v_min_u32 v5, 143, v5
v_lshlrev_b32 v20, 3, v5
v_add_u32 v5, s50, v5
v_max_i32 v5, 0, v5
v_lshlrev_b32 v5, 3, v5
buffer_load_dwordx2 v[32:33], v5, s[20:23], 0 offen sc1
v_add_u32 v5, 64, v1
v_min_u32 v5, 143, v5
v_lshlrev_b32 v21, 3, v5
v_add_u32 v5, s50, v5
v_max_i32 v5, 0, v5
v_lshlrev_b32 v5, 3, v5
buffer_load_dwordx2 v[34:35], v5, s[20:23], 0 offen sc1
v_add_u32 v5, 128, v1
v_min_u32 v5, 143, v5
v_lshlrev_b32 v22, 3, v5
v_add_u32 v5, s50, v5
v_max_i32 v5, 0, v5
v_lshlrev_b32 v5, 3, v5
buffer_load_dwordx2 v[36:37], v5, s[20:23], 0 offen sc1
s_mov_b32 s62, 4
s_branch Lste_21
Lst4_20:
s_mov_b32 s62, 2
s_branch Lste_21
Lst2_19:
s_waitcnt vmcnt(0)
v_add_u32 v20, 147456, v20
ds_write_b64 v20, v[32:33]
v_add_u32 v21, 147456, v21
ds_write_b64 v21, v[34:35]
v_add_u32 v22, 147456, v22
ds_write_b64 v22, v[36:37]
s_waitcnt lgkmcnt(0)
s_mov_b32 s62, 3
Lste_21:
s_branch Lst_6_0
Lwr_151:
s_barrier
s_cmp_eq_u32 s62, 3
s_cbranch_scc1 Lste_27
s_cmp_eq_u32 s62, 2
s_cbranch_scc1 Lst2_25
s_cmp_ge_u32 s62, 4
s_cbranch_scc1 Lst4_26
s_cmp_eq_u32 s62, 1
s_cbranch_scc1 Lst1_24
s_waitcnt vmcnt(0)
v_readfirstlane_b32 s54, v6
s_cmp_eq_u32 s54, 0
s_cbranch_scc0 Lrep_28
buffer_load_dword v6, v4, s[56:59], 0 offen sc1
s_branch Lste_27
Lrep_28:
s_add_u32 s7, s34, 64
s_lshl_b32 s7, s7, 7
v_mov_b32 v5, s7
v_mov_b32 v6, 1
s_mov_b64 exec, 1
buffer_atomic_add v6, v5, s[84:87], 0 offen sc1
s_mov_b64 exec, -1
s_mov_b32 s62, 1
s_mov_b32 s54, 0
s_mov_b32 s55, 0
s_branch Lste_27
Lst1_24:
s_and_b32 s43, s54, s55
s_cmp_eq_u32 s43, 16
s_cbranch_scc1 Lg_29
s_load_dword s54, s[82:83], s52 glc
s_load_dword s55, s[82:83], s53 glc
s_branch Lste_27
Lg_29:
v_add_u32 v5, 0, v1
v_min_u32 v5, 143, v5
v_lshlrev_b32 v20, 3, v5
v_add_u32 v5, s50, v5
v_max_i32 v5, 0, v5
v_lshlrev_b32 v5, 3, v5
buffer_load_dwordx2 v[32:33], v5, s[20:23], 0 offen sc1
v_add_u32 v5, 64, v1
v_min_u32 v5, 143, v5
v_lshlrev_b32 v21, 3, v5
v_add_u32 v5, s50, v5
v_max_i32 v5, 0, v5
v_lshlrev_b32 v5, 3, v5
buffer_load_dwordx2 v[34:35], v5, s[20:23], 0 offen sc1
v_add_u32 v5, 128, v1
v_min_u32 v5, 143, v5
v_lshlrev_b32 v22, 3, v5
v_add_u32 v5, s50, v5
v_max_i32 v5, 0, v5
v_lshlrev_b32 v5, 3, v5
buffer_load_dwordx2 v[36:37], v5, s[20:23], 0 offen sc1
s_mov_b32 s62, 4
s_branch Lste_27
Lst4_26:
s_mov_b32 s62, 2
s_branch Lste_27
Lst2_25:
s_waitcnt vmcnt(0)
v_add_u32 v20, 147456, v20
ds_write_b64 v20, v[32:33]
v_add_u32 v21, 147456, v21
ds_write_b64 v21, v[34:35]
v_add_u32 v22, 147456, v22
ds_write_b64 v22, v[36:37]
s_waitcnt lgkmcnt(0)
s_mov_b32 s62, 3
Lste_27:
s_branch Lst_7_0
Lwr_152:
s_barrier
s_cmp_eq_u32 s62, 3
s_cbranch_scc1 Lste_33
s_cmp_eq_u32 s62, 2
s_cbranch_scc1 Lst2_31
s_cmp_ge_u32 s62, 4
s_cbranch_scc1 Lst4_32
s_cmp_eq_u32 s62, 1
s_cbranch_scc1 Lst1_30
s_waitcnt vmcnt(0)
v_readfirstlane_b32 s54, v6
s_cmp_eq_u32 s54, 0
s_cbranch_scc0 Lrep_34
buffer_load_dword v6, v4, s[56:59], 0 offen sc1
s_branch Lste_33
Lrep_34:
s_add_u32 s7, s34, 64
s_lshl_b32 s7, s7, 7
v_mov_b32 v5, s7
v_mov_b32 v6, 1
s_mov_b64 exec, 1
buffer_atomic_add v6, v5, s[84:87], 0 offen sc1
s_mov_b64 exec, -1
s_mov_b32 s62, 1
s_mov_b32 s54, 0
s_mov_b32 s55, 0
s_branch Lste_33
Lst1_30:
s_and_b32 s43, s54, s55
s_cmp_eq_u32 s43, 16
s_cbranch_scc1 Lg_35
s_load_dword s54, s[82:83], s52 glc
s_load_dword s55, s[82:83], s53 glc
s_branch Lste_33
Lg_35:
v_add_u32 v5, 0, v1
v_min_u32 v5, 143, v5
v_lshlrev_b32 v20, 3, v5
v_add_u32 v5, s50, v5
v_max_i32 v5, 0, v5
v_lshlrev_b32 v5, 3, v5
buffer_load_dwordx2 v[32:33], v5, s[20:23], 0 offen sc1
v_add_u32 v5, 64, v1
v_min_u32 v5, 143, v5
v_lshlrev_b32 v21, 3, v5
v_add_u32 v5, s50, v5
v_max_i32 v5, 0, v5
v_lshlrev_b32 v5, 3, v5
buffer_load_dwordx2 v[34:35], v5, s[20:23], 0 offen sc1
v_add_u32 v5, 128, v1
v_min_u32 v5, 143, v5
v_lshlrev_b32 v22, 3, v5
v_add_u32 v5, s50, v5
v_max_i32 v5, 0, v5
v_lshlrev_b32 v5, 3, v5
buffer_load_dwordx2 v[36:37], v5, s[20:23], 0 offen sc1
s_mov_b32 s62, 4
s_branch Lste_33
Lst4_32:
s_mov_b32 s62, 2
s_branch Lste_33
Lst2_31:
s_waitcnt vmcnt(0)
v_add_u32 v20, 147456, v20
ds_write_b64 v20, v[32:33]
v_add_u32 v21, 147456, v21
ds_write_b64 v21, v[34:35]
v_add_u32 v22, 147456, v22
ds_write_b64 v22, v[36:37]
s_waitcnt lgkmcnt(0)
s_mov_b32 s62, 3
Lste_33:
s_branch Lst_8_0
Lwr_153:
s_barrier
s_cmp_eq_u32 s62, 3
s_cbranch_scc1 Lste_39
s_cmp_eq_u32 s62, 2
s_cbranch_scc1 Lst2_37
s_cmp_ge_u32 s62, 4
s_cbranch_scc1 Lst4_38
s_cmp_eq_u32 s62, 1
s_cbranch_scc1 Lst1_36
s_waitcnt vmcnt(0)
v_readfirstlane_b32 s54, v6
s_cmp_eq_u32 s54, 0
s_cbranch_scc0 Lrep_40
buffer_load_dword v6, v4, s[56:59], 0 offen sc1
s_branch Lste_39
Lrep_40:
s_add_u32 s7, s34, 64
s_lshl_b32 s7, s7, 7
v_mov_b32 v5, s7
v_mov_b32 v6, 1
s_mov_b64 exec, 1
buffer_atomic_add v6, v5, s[84:87], 0 offen sc1
s_mov_b64 exec, -1
s_mov_b32 s62, 1
s_mov_b32 s54, 0
s_mov_b32 s55, 0
s_branch Lste_39
Lst1_36:
s_and_b32 s43, s54, s55
s_cmp_eq_u32 s43, 16
s_cbranch_scc1 Lg_41
s_load_dword s54, s[82:83], s52 glc
s_load_dword s55, s[82:83], s53 glc
s_branch Lste_39
Lg_41:
v_add_u32 v5, 0, v1
v_min_u32 v5, 143, v5
v_lshlrev_b32 v20, 3, v5
v_add_u32 v5, s50, v5
v_max_i32 v5, 0, v5
v_lshlrev_b32 v5, 3, v5
buffer_load_dwordx2 v[32:33], v5, s[20:23], 0 offen sc1
v_add_u32 v5, 64, v1
v_min_u32 v5, 143, v5
v_lshlrev_b32 v21, 3, v5
v_add_u32 v5, s50, v5
v_max_i32 v5, 0, v5
v_lshlrev_b32 v5, 3, v5
buffer_load_dwordx2 v[34:35], v5, s[20:23], 0 offen sc1
v_add_u32 v5, 128, v1
v_min_u32 v5, 143, v5
v_lshlrev_b32 v22, 3, v5
v_add_u32 v5, s50, v5
v_max_i32 v5, 0, v5
v_lshlrev_b32 v5, 3, v5
buffer_load_dwordx2 v[36:37], v5, s[20:23], 0 offen sc1
s_mov_b32 s62, 4
s_branch Lste_39
Lst4_38:
s_mov_b32 s62, 2
s_branch Lste_39
Lst2_37:
s_waitcnt vmcnt(0)
v_add_u32 v20, 147456, v20
ds_write_b64 v20, v[32:33]
v_add_u32 v21, 147456, v21
ds_write_b64 v21, v[34:35]
v_add_u32 v22, 147456, v22
ds_write_b64 v22, v[36:37]
s_waitcnt lgkmcnt(0)
s_mov_b32 s62, 3
Lste_39:
s_branch Lst_9_0
Lwr_154:
s_barrier
s_cmp_eq_u32 s62, 3
s_cbranch_scc1 Lste_45
s_cmp_eq_u32 s62, 2
s_cbranch_scc1 Lst2_43
s_cmp_ge_u32 s62, 4
s_cbranch_scc1 Lst4_44
s_cmp_eq_u32 s62, 1
s_cbranch_scc1 Lst1_42
s_waitcnt vmcnt(0)
v_readfirstlane_b32 s54, v6
s_cmp_eq_u32 s54, 0
s_cbranch_scc0 Lrep_46
buffer_load_dword v6, v4, s[56:59], 0 offen sc1
s_branch Lste_45
Lrep_46:
s_add_u32 s7, s34, 64
s_lshl_b32 s7, s7, 7
v_mov_b32 v5, s7
v_mov_b32 v6, 1
s_mov_b64 exec, 1
buffer_atomic_add v6, v5, s[84:87], 0 offen sc1
s_mov_b64 exec, -1
s_mov_b32 s62, 1
s_mov_b32 s54, 0
s_mov_b32 s55, 0
s_branch Lste_45
Lst1_42:
s_and_b32 s43, s54, s55
s_cmp_eq_u32 s43, 16
s_cbranch_scc1 Lg_47
s_load_dword s54, s[82:83], s52 glc
s_load_dword s55, s[82:83], s53 glc
s_branch Lste_45
Lg_47:
v_add_u32 v5, 0, v1
v_min_u32 v5, 143, v5
v_lshlrev_b32 v20, 3, v5
v_add_u32 v5, s50, v5
v_max_i32 v5, 0, v5
v_lshlrev_b32 v5, 3, v5
buffer_load_dwordx2 v[32:33], v5, s[20:23], 0 offen sc1
v_add_u32 v5, 64, v1
v_min_u32 v5, 143, v5
v_lshlrev_b32 v21, 3, v5
v_add_u32 v5, s50, v5
v_max_i32 v5, 0, v5
v_lshlrev_b32 v5, 3, v5
buffer_load_dwordx2 v[34:35], v5, s[20:23], 0 offen sc1
v_add_u32 v5, 128, v1
v_min_u32 v5, 143, v5
v_lshlrev_b32 v22, 3, v5
v_add_u32 v5, s50, v5
v_max_i32 v5, 0, v5
v_lshlrev_b32 v5, 3, v5
buffer_load_dwordx2 v[36:37], v5, s[20:23], 0 offen sc1
s_mov_b32 s62, 4
s_branch Lste_45
Lst4_44:
s_mov_b32 s62, 2
s_branch Lste_45
Lst2_43:
s_waitcnt vmcnt(0)
v_add_u32 v20, 147456, v20
ds_write_b64 v20, v[32:33]
v_add_u32 v21, 147456, v21
ds_write_b64 v21, v[34:35]
v_add_u32 v22, 147456, v22
ds_write_b64 v22, v[36:37]
s_waitcnt lgkmcnt(0)
s_mov_b32 s62, 3
Lste_45:
s_branch Lst_10_0
Lwr_155:
s_barrier
s_cmp_eq_u32 s62, 3
s_cbranch_scc1 Lste_51
s_cmp_eq_u32 s62, 2
s_cbranch_scc1 Lst2_49
s_cmp_ge_u32 s62, 4
s_cbranch_scc1 Lst4_50
s_cmp_eq_u32 s62, 1
s_cbranch_scc1 Lst1_48
s_waitcnt vmcnt(0)
v_readfirstlane_b32 s54, v6
s_cmp_eq_u32 s54, 0
s_cbranch_scc0 Lrep_52
buffer_load_dword v6, v4, s[56:59], 0 offen sc1
s_branch Lste_51
Lrep_52:
s_add_u32 s7, s34, 64
s_lshl_b32 s7, s7, 7
v_mov_b32 v5, s7
v_mov_b32 v6, 1
s_mov_b64 exec, 1
buffer_atomic_add v6, v5, s[84:87], 0 offen sc1
s_mov_b64 exec, -1
s_mov_b32 s62, 1
s_mov_b32 s54, 0
s_mov_b32 s55, 0
s_branch Lste_51
Lst1_48:
s_and_b32 s43, s54, s55
s_cmp_eq_u32 s43, 16
s_cbranch_scc1 Lg_53
s_load_dword s54, s[82:83], s52 glc
s_load_dword s55, s[82:83], s53 glc
s_branch Lste_51
Lg_53:
v_add_u32 v5, 0, v1
v_min_u32 v5, 143, v5
v_lshlrev_b32 v20, 3, v5
v_add_u32 v5, s50, v5
v_max_i32 v5, 0, v5
v_lshlrev_b32 v5, 3, v5
buffer_load_dwordx2 v[32:33], v5, s[20:23], 0 offen sc1
v_add_u32 v5, 64, v1
v_min_u32 v5, 143, v5
v_lshlrev_b32 v21, 3, v5
v_add_u32 v5, s50, v5
v_max_i32 v5, 0, v5
v_lshlrev_b32 v5, 3, v5
buffer_load_dwordx2 v[34:35], v5, s[20:23], 0 offen sc1
v_add_u32 v5, 128, v1
v_min_u32 v5, 143, v5
v_lshlrev_b32 v22, 3, v5
v_add_u32 v5, s50, v5
v_max_i32 v5, 0, v5
v_lshlrev_b32 v5, 3, v5
buffer_load_dwordx2 v[36:37], v5, s[20:23], 0 offen sc1
s_mov_b32 s62, 4
s_branch Lste_51
Lst4_50:
s_mov_b32 s62, 2
s_branch Lste_51
Lst2_49:
s_waitcnt vmcnt(0)
v_add_u32 v20, 147456, v20
ds_write_b64 v20, v[32:33]
v_add_u32 v21, 147456, v21
ds_write_b64 v21, v[34:35]
v_add_u32 v22, 147456, v22
ds_write_b64 v22, v[36:37]
s_waitcnt lgkmcnt(0)
s_mov_b32 s62, 3
Lste_51:
s_branch Lst_11_0
Lwr_156:
s_barrier
s_cmp_eq_u32 s62, 3
s_cbranch_scc1 Lste_57
s_cmp_eq_u32 s62, 2
s_cbranch_scc1 Lst2_55
s_cmp_ge_u32 s62, 4
s_cbranch_scc1 Lst4_56
s_cmp_eq_u32 s62, 1
s_cbranch_scc1 Lst1_54
s_waitcnt vmcnt(0)
v_readfirstlane_b32 s54, v6
s_cmp_eq_u32 s54, 0
s_cbranch_scc0 Lrep_58
buffer_load_dword v6, v4, s[56:59], 0 offen sc1
s_branch Lste_57
Lrep_58:
s_add_u32 s7, s34, 64
s_lshl_b32 s7, s7, 7
v_mov_b32 v5, s7
v_mov_b32 v6, 1
s_mov_b64 exec, 1
buffer_atomic_add v6, v5, s[84:87], 0 offen sc1
s_mov_b64 exec, -1
s_mov_b32 s62, 1
s_mov_b32 s54, 0
s_mov_b32 s55, 0
s_branch Lste_57
Lst1_54:
s_and_b32 s43, s54, s55
s_cmp_eq_u32 s43, 16
s_cbranch_scc1 Lg_59
s_load_dword s54, s[82:83], s52 glc
s_load_dword s55, s[82:83], s53 glc
s_branch Lste_57
Lg_59:
v_add_u32 v5, 0, v1
v_min_u32 v5, 143, v5
v_lshlrev_b32 v20, 3, v5
v_add_u32 v5, s50, v5
v_max_i32 v5, 0, v5
v_lshlrev_b32 v5, 3, v5
buffer_load_dwordx2 v[32:33], v5, s[20:23], 0 offen sc1
v_add_u32 v5, 64, v1
v_min_u32 v5, 143, v5
v_lshlrev_b32 v21, 3, v5
v_add_u32 v5, s50, v5
v_max_i32 v5, 0, v5
v_lshlrev_b32 v5, 3, v5
buffer_load_dwordx2 v[34:35], v5, s[20:23], 0 offen sc1
v_add_u32 v5, 128, v1
v_min_u32 v5, 143, v5
v_lshlrev_b32 v22, 3, v5
v_add_u32 v5, s50, v5
v_max_i32 v5, 0, v5
v_lshlrev_b32 v5, 3, v5
buffer_load_dwordx2 v[36:37], v5, s[20:23], 0 offen sc1
s_mov_b32 s62, 4
s_branch Lste_57
Lst4_56:
s_mov_b32 s62, 2
s_branch Lste_57
Lst2_55:
s_waitcnt vmcnt(0)
v_add_u32 v20, 147456, v20
ds_write_b64 v20, v[32:33]
v_add_u32 v21, 147456, v21
ds_write_b64 v21, v[34:35]
v_add_u32 v22, 147456, v22
ds_write_b64 v22, v[36:37]
s_waitcnt lgkmcnt(0)
s_mov_b32 s62, 3
Lste_57:
s_branch Lst_12_0
Lwr_157:
s_barrier
s_cmp_eq_u32 s62, 3
s_cbranch_scc1 Lste_63
s_cmp_eq_u32 s62, 2
s_cbranch_scc1 Lst2_61
s_cmp_ge_u32 s62, 4
s_cbranch_scc1 Lst4_62
s_cmp_eq_u32 s62, 1
s_cbranch_scc1 Lst1_60
s_waitcnt vmcnt(0)
v_readfirstlane_b32 s54, v6
s_cmp_eq_u32 s54, 0
s_cbranch_scc0 Lrep_64
buffer_load_dword v6, v4, s[56:59], 0 offen sc1
s_branch Lste_63
Lrep_64:
s_add_u32 s7, s34, 64
s_lshl_b32 s7, s7, 7
v_mov_b32 v5, s7
v_mov_b32 v6, 1
s_mov_b64 exec, 1
buffer_atomic_add v6, v5, s[84:87], 0 offen sc1
s_mov_b64 exec, -1
s_mov_b32 s62, 1
s_mov_b32 s54, 0
s_mov_b32 s55, 0
s_branch Lste_63
Lst1_60:
s_and_b32 s43, s54, s55
s_cmp_eq_u32 s43, 16
s_cbranch_scc1 Lg_65
s_load_dword s54, s[82:83], s52 glc
s_load_dword s55, s[82:83], s53 glc
s_branch Lste_63
Lg_65:
v_add_u32 v5, 0, v1
v_min_u32 v5, 143, v5
v_lshlrev_b32 v20, 3, v5
v_add_u32 v5, s50, v5
v_max_i32 v5, 0, v5
v_lshlrev_b32 v5, 3, v5
buffer_load_dwordx2 v[32:33], v5, s[20:23], 0 offen sc1
v_add_u32 v5, 64, v1
v_min_u32 v5, 143, v5
v_lshlrev_b32 v21, 3, v5
v_add_u32 v5, s50, v5
v_max_i32 v5, 0, v5
v_lshlrev_b32 v5, 3, v5
buffer_load_dwordx2 v[34:35], v5, s[20:23], 0 offen sc1
v_add_u32 v5, 128, v1
v_min_u32 v5, 143, v5
v_lshlrev_b32 v22, 3, v5
v_add_u32 v5, s50, v5
v_max_i32 v5, 0, v5
v_lshlrev_b32 v5, 3, v5
buffer_load_dwordx2 v[36:37], v5, s[20:23], 0 offen sc1
s_mov_b32 s62, 4
s_branch Lste_63
Lst4_62:
s_mov_b32 s62, 2
s_branch Lste_63
Lst2_61:
s_waitcnt vmcnt(0)
v_add_u32 v20, 147456, v20
ds_write_b64 v20, v[32:33]
v_add_u32 v21, 147456, v21
ds_write_b64 v21, v[34:35]
v_add_u32 v22, 147456, v22
ds_write_b64 v22, v[36:37]
s_waitcnt lgkmcnt(0)
s_mov_b32 s62, 3
Lste_63:
s_branch Lst_13_0
Lwr_158:
s_barrier
s_cmp_eq_u32 s62, 3
s_cbranch_scc1 Lste_69
s_cmp_eq_u32 s62, 2
s_cbranch_scc1 Lst2_67
s_cmp_ge_u32 s62, 4
s_cbranch_scc1 Lst4_68
s_cmp_eq_u32 s62, 1
s_cbranch_scc1 Lst1_66
s_waitcnt vmcnt(0)
v_readfirstlane_b32 s54, v6
s_cmp_eq_u32 s54, 0
s_cbranch_scc0 Lrep_70
buffer_load_dword v6, v4, s[56:59], 0 offen sc1
s_branch Lste_69
Lrep_70:
s_add_u32 s7, s34, 64
s_lshl_b32 s7, s7, 7
v_mov_b32 v5, s7
v_mov_b32 v6, 1
s_mov_b64 exec, 1
buffer_atomic_add v6, v5, s[84:87], 0 offen sc1
s_mov_b64 exec, -1
s_mov_b32 s62, 1
s_mov_b32 s54, 0
s_mov_b32 s55, 0
s_branch Lste_69
Lst1_66:
s_and_b32 s43, s54, s55
s_cmp_eq_u32 s43, 16
s_cbranch_scc1 Lg_71
s_load_dword s54, s[82:83], s52 glc
s_load_dword s55, s[82:83], s53 glc
s_branch Lste_69
Lg_71:
v_add_u32 v5, 0, v1
v_min_u32 v5, 143, v5
v_lshlrev_b32 v20, 3, v5
v_add_u32 v5, s50, v5
v_max_i32 v5, 0, v5
v_lshlrev_b32 v5, 3, v5
buffer_load_dwordx2 v[32:33], v5, s[20:23], 0 offen sc1
v_add_u32 v5, 64, v1
v_min_u32 v5, 143, v5
v_lshlrev_b32 v21, 3, v5
v_add_u32 v5, s50, v5
v_max_i32 v5, 0, v5
v_lshlrev_b32 v5, 3, v5
buffer_load_dwordx2 v[34:35], v5, s[20:23], 0 offen sc1
v_add_u32 v5, 128, v1
v_min_u32 v5, 143, v5
v_lshlrev_b32 v22, 3, v5
v_add_u32 v5, s50, v5
s_branch Lov_4
.p2align 12
.fill 32, 4, 0xbf800000
Lst_4_0:
s_branch Lwr_149
s_nop 0
s_nop 0
Lov_4:
v_max_i32 v5, 0, v5
v_lshlrev_b32 v5, 3, v5
buffer_load_dwordx2 v[36:37], v5, s[20:23], 0 offen sc1
s_mov_b32 s62, 4
s_branch Lste_69
Lst4_68:
s_mov_b32 s62, 2
s_branch Lste_69
Lst2_67:
s_waitcnt vmcnt(0)
v_add_u32 v20, 147456, v20
ds_write_b64 v20, v[32:33]
v_add_u32 v21, 147456, v21
ds_write_b64 v21, v[34:35]
v_add_u32 v22, 147456, v22
ds_write_b64 v22, v[36:37]
s_waitcnt lgkmcnt(0)
s_mov_b32 s62, 3
Lste_69:
s_branch Lst_14_0
Lwr_159:
s_barrier
s_cmp_eq_u32 s62, 3
s_cbranch_scc1 Lste_74
s_cmp_ge_u32 s62, 5
s_cbranch_scc1 Lg_79
s_cmp_ge_u32 s62, 2
s_cbranch_scc1 Lst2_73
s_cmp_eq_u32 s62, 1
s_cbranch_scc1 Lst1_72
s_mov_b32 s41, 0x40000
Lz0_75:
s_waitcnt vmcnt(0)
v_readfirstlane_b32 s54, v6
s_cmp_eq_u32 s54, 0
s_cbranch_scc0 Lzok_76
buffer_load_dword v6, v4, s[56:59], 0 offen sc1
s_sub_u32 s41, s41, 1
s_cmp_lg_u32 s41, 0
s_cbranch_scc1 Lz0_75
s_waitcnt lgkmcnt(0)
Lzok_76:
s_add_u32 s7, s34, 64
s_lshl_b32 s7, s7, 7
v_mov_b32 v5, s7
v_mov_b32 v6, 1
s_mov_b64 exec, 1
buffer_atomic_add v6, v5, s[84:87], 0 offen sc1
s_mov_b64 exec, -1
Lst1_72:
s_load_dword s54, s[82:83], s52 glc
s_load_dword s55, s[82:83], s53 glc
s_mov_b32 s41, 0x40000
Lpoll_77:
s_waitcnt lgkmcnt(0)
s_and_b32 s54, s54, s55
s_cmp_eq_u32 s54, 16
s_cbranch_scc1 Lg_79
s_load_dword s54, s[82:83], s52 glc
s_load_dword s55, s[82:83], s53 glc
s_sub_u32 s41, s41, 1
s_cmp_lg_u32 s41, 0
s_cbranch_scc1 Lpoll_77
s_waitcnt lgkmcnt(0)
Lg_79:
v_add_u32 v5, 0, v1
v_min_u32 v5, 143, v5
v_lshlrev_b32 v20, 3, v5
v_add_u32 v5, s50, v5
v_max_i32 v5, 0, v5
v_lshlrev_b32 v5, 3, v5
buffer_load_dwordx2 v[32:33], v5, s[20:23], 0 offen sc1
v_add_u32 v5, 64, v1
v_min_u32 v5, 143, v5
v_lshlrev_b32 v21, 3, v5
v_add_u32 v5, s50, v5
v_max_i32 v5, 0, v5
v_lshlrev_b32 v5, 3, v5
buffer_load_dwordx2 v[34:35], v5, s[20:23], 0 offen sc1
v_add_u32 v5, 128, v1
v_min_u32 v5, 143, v5
v_lshlrev_b32 v22, 3, v5
v_add_u32 v5, s50, v5
v_max_i32 v5, 0, v5
v_lshlrev_b32 v5, 3, v5
buffer_load_dwordx2 v[36:37], v5, s[20:23], 0 offen sc1
Lst2_73:
s_waitcnt vmcnt(0)
v_add_u32 v20, 147456, v20
ds_write_b64 v20, v[32:33]
v_add_u32 v21, 147456, v21
ds_write_b64 v21, v[34:35]
v_add_u32 v22, 147456, v22
ds_write_b64 v22, v[36:37]
s_waitcnt lgkmcnt(0)
Lste_74:
s_bitcmp0_b32 s2, 0
s_cselect_b32 s88, s72, s74
s_cselect_b32 s89, s73, s75
s_cmp_lt_u32 s2, 192
s_cselect_b32 s90, 7340032, 0
s_mov_b32 s91, 0x20000
s_bfe_u32 s44, s2, 0x30001
s_lshl_b32 s44, s44, 2
s_and_b32 s43, s36, 3
s_add_u32 s44, s44, s43
s_lshl_b32 s44, s44, 5
v_lshrrev_b32 v18, 4, v1
v_add_u32 v18, s44, v18
v_mul_u32_u24 v18, 7168, v18
v_and_b32 v19, 15, v1
v_lshl_add_u32 v18, v19, 4, v18
s_lshr_b32 s43, s2, 4
s_lshl_b32 s43, s43, 8
s_add_u32 s43, s43, 4096
v_add_u32 v18, s43, v18
s_mov_b32 s43, 0
buffer_load_dwordx4 v[128:131], v18, s[88:91], s43 offen
s_mov_b32 s43, 28672
buffer_load_dwordx4 v[132:135], v18, s[88:91], s43 offen
s_mov_b32 s43, 57344
buffer_load_dwordx4 v[136:139], v18, s[88:91], s43 offen
s_mov_b32 s43, 86016
buffer_load_dwordx4 v[140:143], v18, s[88:91], s43 offen
s_mov_b32 s43, 114688
buffer_load_dwordx4 v[144:147], v18, s[88:91], s43 offen
s_mov_b32 s43, 143360
buffer_load_dwordx4 v[148:151], v18, s[88:91], s43 offen
s_mov_b32 s43, 172032
buffer_load_dwordx4 v[152:155], v18, s[88:91], s43 offen
s_mov_b32 s43, 200704
buffer_load_dwordx4 v[156:159], v18, s[88:91], s43 offen
s_barrier
s_lshl_b32 s43, s35, 7
s_add_u32 s28, s68, s43
s_addc_u32 s29, s69, 0
s_mov_b32 s30, 2095232
s_mov_b32 s31, 0x20000
v_lshrrev_b32 v15, 3, v1
v_and_b32 v16, 6, v15
v_and_b32 v7, 7, v1
v_xor_b32 v7, v7, v16
v_lshlrev_b32 v7, 4, v7
v_mul_u32_u24 v15, 2048, v15
v_add_u32 v7, v7, v15
s_and_b32 s40, s36, 3
s_lshl_b32 s39, s40, 13
s_add_u32 s40, s40, s35
s_add_u32 s42, s40, 0
s_and_b32 s42, s42, 15
s_lshl_b32 s42, s42, 17
s_add_u32 m0, s39, 65536
s_add_u32 s43, s42, 0
buffer_load_dwordx4 v7, s[28:31], s43 offen lds
s_add_u32 m0, s39, 66560
s_add_u32 s43, s42, 16384
buffer_load_dwordx4 v7, s[28:31], s43 offen lds
s_add_u32 m0, s39, 67584
s_add_u32 s43, s42, 32768
buffer_load_dwordx4 v7, s[28:31], s43 offen lds
s_add_u32 m0, s39, 68608
s_add_u32 s43, s42, 49152
buffer_load_dwordx4 v7, s[28:31], s43 offen lds
s_add_u32 m0, s39, 69632
s_add_u32 s43, s42, 65536
buffer_load_dwordx4 v7, s[28:31], s43 offen lds
s_add_u32 m0, s39, 70656
s_add_u32 s43, s42, 81920
buffer_load_dwordx4 v7, s[28:31], s43 offen lds
s_add_u32 m0, s39, 71680
s_add_u32 s43, s42, 98304
buffer_load_dwordx4 v7, s[28:31], s43 offen lds
s_add_u32 m0, s39, 72704
s_add_u32 s43, s42, 114688
buffer_load_dwordx4 v7, s[28:31], s43 offen lds
Lats_6:
s_and_b32 s43, s36, 1
s_bfe_u32 s44, s36, 0x10001
s_lshr_b32 s45, s36, 2
v_lshlrev_b32 v14, 2, v13
v_sub_u32 v14, v12, v14
v_mov_b32 v16, 0xff800000
s_or_b32 s46, s34, s45
s_cmp_lg_u32 s46, 0
s_cselect_b32 s46, 0, 0xff800000
v_subrev_u32 v15, 0, v14
v_cmp_ge_u32 vcc, 7, v15
v_add_u32 v15, 16, v15
s_nop 0
v_cndmask_b32 v248, v16, 0, vcc
v_cmp_ge_u32 vcc, 7, v15
s_nop 1
v_cndmask_b32 v244, v16, 0, vcc
v_or_b32 v240, s46, v244
v_subrev_u32 v15, 1, v14
v_cmp_ge_u32 vcc, 7, v15
v_add_u32 v15, 16, v15
s_nop 0
v_cndmask_b32 v249, v16, 0, vcc
v_cmp_ge_u32 vcc, 7, v15
s_nop 1
v_cndmask_b32 v245, v16, 0, vcc
v_or_b32 v241, s46, v245
v_subrev_u32 v15, 2, v14
v_cmp_ge_u32 vcc, 7, v15
v_add_u32 v15, 16, v15
s_nop 0
v_cndmask_b32 v250, v16, 0, vcc
v_cmp_ge_u32 vcc, 7, v15
s_nop 1
v_cndmask_b32 v246, v16, 0, vcc
v_or_b32 v242, s46, v246
v_subrev_u32 v15, 3, v14
v_cmp_ge_u32 vcc, 7, v15
v_add_u32 v15, 16, v15
s_nop 0
v_cndmask_b32 v251, v16, 0, vcc
v_cmp_ge_u32 vcc, 7, v15
s_nop 1
v_cndmask_b32 v247, v16, 0, vcc
v_or_b32 v243, s46, v247
s_lshl_b32 s46, s45, 6
s_add_u32 s46, s46, s44
s_add_u32 s46, s46, 16
v_lshl_add_u32 v14, v12, 1, s46
s_lshl_b32 s47, s43, 6
v_lshl_add_u32 v15, v13, 4, s47
v_mul_u32_u24 v20, 400, v14
v_add_u32 v20, v20, v15
v_subrev_u32 v16, 32, v14
v_max_i32 v16, 0, v16
v_mul_u32_u24 v21, 400, v16
v_add_u32 v21, v21, v15
v_lshrrev_b32 v16, 2, v12
v_lshl_add_u32 v16, v13, 2, v16
v_lshl_add_u32 v16, v16, 1, s46
v_and_b32 v17, 3, v1
v_lshl_add_u32 v17, v17, 3, s47
v_mul_u32_u24 v22, 400, v16
v_add_u32 v22, v22, v17
v_subrev_u32 v16, 32, v16
v_max_i32 v16, 0, v16
v_mul_u32_u24 v23, 400, v16
v_add_u32 v23, v23, v17
s_mul_i32 s60, s34, 262144
s_add_u32 s16, s82, s60
s_addc_u32 s17, s83, 0
s_mov_b32 s18, 262144
s_mov_b32 s19, 0x20000
s_lshl_b32 s60, s35, 14
s_lshl_b32 s43, s43, 13
s_add_u32 s60, s60, s43
s_lshl_b32 s43, s45, 12
s_add_u32 s60, s60, s43
s_lshl_b32 s43, s44, 10
s_add_u32 s60, s60, s43
v_lshlrev_b32 v24, 4, v1
s_mov_b32 s61, 0x3e8293ee
s_lshl_b32 s38, s35, 7
Latt_5:
s_barrier
ds_read_b128 v[32:35], v20 offset:0
ds_read_b128 v[36:39], v20 offset:128
ds_read_b128 v[40:43], v21 offset:128
ds_read_b128 v[80:83], v20 offset:12800
ds_read_b128 v[84:87], v20 offset:12928
ds_read_b128 v[88:91], v20 offset:128
ds_read_b64_tr_b16 v[44:45], v23 offset:256
ds_read_b64_tr_b16 v[46:47], v22 offset:256
ds_read_b64_tr_b16 v[48:49], v23 offset:288
ds_read_b64_tr_b16 v[50:51], v22 offset:288
ds_read_b64_tr_b16 v[92:93], v22 offset:256
ds_read_b64_tr_b16 v[94:95], v22 offset:13056
ds_read_b64_tr_b16 v[96:97], v22 offset:288
ds_read_b64_tr_b16 v[98:99], v22 offset:13088
s_waitcnt lgkmcnt(11)
v_mfma_f32_16x16x32_bf16 v[52:55], v[40:43], v[32:35], v[240:243]
v_mfma_f32_16x16x32_bf16 v[56:59], v[36:39], v[32:35], v[248:251]
s_waitcnt lgkmcnt(8)
v_mfma_f32_16x16x32_bf16 v[100:103], v[88:91], v[80:83], v[244:247]
v_mfma_f32_16x16x32_bf16 v[104:107], v[84:87], v[80:83], v[248:251]
s_nop 5
v_max3_f32 v60, v52, v53, v54
v_max3_f32 v108, v100, v101, v102
v_max3_f32 v61, v55, v56, v57
v_max3_f32 v109, v103, v104, v105
v_max3_f32 v60, v60, v58, v59
v_max3_f32 v108, v108, v106, v107
v_max_f32 v60, v60, v61
v_max_f32 v108, v108, v109
s_nop 1
v_permlane32_swap_b32 v60, v108
v_max_f32 v60, v60, v108
v_mov_b32 v61, v60
s_nop 1
v_permlane16_swap_b32 v60, v61
v_max_f32 v60, v60, v61
v_mul_f32 v60, s61, v60
s_nop 0
v_mov_b32 v108, v60
s_nop 1
v_permlane32_swap_b32 v60, v108
v_fma_f32 v52, v52, s61, -v60
v_fma_f32 v100, v100, s61, -v108
v_fma_f32 v53, v53, s61, -v60
v_fma_f32 v101, v101, s61, -v108
v_fma_f32 v54, v54, s61, -v60
v_fma_f32 v102, v102, s61, -v108
v_fma_f32 v55, v55, s61, -v60
v_fma_f32 v103, v103, s61, -v108
v_fma_f32 v56, v56, s61, -v60
v_fma_f32 v104, v104, s61, -v108
v_fma_f32 v57, v57, s61, -v60
v_fma_f32 v105, v105, s61, -v108
v_fma_f32 v58, v58, s61, -v60
v_fma_f32 v106, v106, s61, -v108
v_fma_f32 v59, v59, s61, -v60
v_fma_f32 v107, v107, s61, -v108
v_exp_f32 v52, v52
v_exp_f32 v100, v100
v_exp_f32 v53, v53
v_exp_f32 v101, v101
v_exp_f32 v54, v54
v_exp_f32 v102, v102
v_exp_f32 v55, v55
v_exp_f32 v103, v103
v_exp_f32 v56, v56
v_exp_f32 v104, v104
v_exp_f32 v57, v57
v_exp_f32 v105, v105
v_exp_f32 v58, v58
v_exp_f32 v106, v106
v_exp_f32 v59, v59
v_exp_f32 v107, v107
v_cvt_pk_bf16_f32 v64, v52, v53
v_cvt_pk_bf16_f32 v112, v100, v101
v_cvt_pk_bf16_f32 v65, v54, v55
v_cvt_pk_bf16_f32 v113, v102, v103
v_cvt_pk_bf16_f32 v66, v56, v57
v_cvt_pk_bf16_f32 v114, v104, v105
v_cvt_pk_bf16_f32 v67, v58, v59
v_cvt_pk_bf16_f32 v115, v106, v107
v_pk_add_f32 v[52:53], v[52:53], v[54:55]
v_pk_add_f32 v[100:101], v[100:101], v[102:103]
v_pk_add_f32 v[56:57], v[56:57], v[58:59]
v_pk_add_f32 v[104:105], v[104:105], v[106:107]
s_waitcnt lgkmcnt(0)
s_waitcnt lgkmcnt(0)
v_mfma_f32_16x16x32_bf16 v[68:71], v[44:47], v[64:67], 0
v_mfma_f32_16x16x32_bf16 v[116:119], v[92:95], v[112:115], 0
v_mfma_f32_16x16x32_bf16 v[72:75], v[48:51], v[64:67], 0
v_mfma_f32_16x16x32_bf16 v[120:123], v[96:99], v[112:115], 0
v_pk_add_f32 v[52:53], v[52:53], v[56:57]
v_pk_add_f32 v[100:101], v[100:101], v[104:105]
v_add_f32 v60, v52, v53
v_add_f32 v108, v100, v101
s_nop 1
v_permlane32_swap_b32 v60, v108
v_add_f32 v60, v60, v108
v_mov_b32 v61, v60
s_nop 1
v_permlane16_swap_b32 v60, v61
v_add_f32 v60, v60, v61
v_rcp_f32 v60, v60
s_nop 0
v_mov_b32 v108, v60
s_nop 1
v_permlane32_swap_b32 v60, v108
v_pk_mul_f32 v[68:69], v[60:61], v[68:69] op_sel_hi:[0,1]
v_pk_mul_f32 v[116:117], v[108:109], v[116:117] op_sel_hi:[0,1]
v_pk_mul_f32 v[70:71], v[60:61], v[70:71] op_sel_hi:[0,1]
v_pk_mul_f32 v[118:119], v[108:109], v[118:119] op_sel_hi:[0,1]
v_pk_mul_f32 v[72:73], v[60:61], v[72:73] op_sel_hi:[0,1]
v_pk_mul_f32 v[120:121], v[108:109], v[120:121] op_sel_hi:[0,1]
v_pk_mul_f32 v[74:75], v[60:61], v[74:75] op_sel_hi:[0,1]
v_pk_mul_f32 v[122:123], v[108:109], v[122:123] op_sel_hi:[0,1]
v_cvt_pk_bf16_f32 v64, v68, v69
v_cvt_pk_bf16_f32 v112, v116, v117
v_cvt_pk_bf16_f32 v65, v70, v71
v_cvt_pk_bf16_f32 v113, v118, v119
v_cvt_pk_bf16_f32 v66, v72, v73
v_cvt_pk_bf16_f32 v114, v120, v121
v_cvt_pk_bf16_f32 v67, v74, v75
v_cvt_pk_bf16_f32 v115, v122, v123
buffer_store_dwordx4 v[64:67], v24, s[16:19], s60 offen offset:0 sc1
buffer_store_dwordx4 v[112:115], v24, s[16:19], s60 offen offset:2048 sc1
s_add_u32 s56, s82, 28311552
s_addc_u32 s57, s83, 0
s_mov_b32 s58, 114688
s_mov_b32 s59, 0x20000
s_lshl_b32 s7, s34, 12
s_add_u32 s7, s7, 49152
v_lshl_add_u32 v26, v1, 8, s7
v_mov_b32 v27, 1
s_cmp_ge_u32 s36, 4
s_cbranch_scc1 Lh_81
s_waitcnt vmcnt(0)
s_branch Lo_80
Lh_81:
s_waitcnt vmcnt(0)
Lo_80:
s_cmp_lg_u32 s36, 0
s_barrier
s_cbranch_scc1 Lsig_82
s_mov_b64 exec, 0xffff
buffer_atomic_add v27, v26, s[56:59], 0 offen sc1
s_mov_b64 exec, -1
Lsig_82:
s_cmp_ge_u32 s36, 4
s_cbranch_scc1 Lprod_84
v_and_b32 v12, 15, v1
v_lshrrev_b32 v13, 4, v1
v_lshlrev_b32 v10, 12, v12
v_and_b32 v14, 1, v13
v_lshl_add_u32 v10, v14, 5, v10
v_lshrrev_b32 v14, 1, v13
v_lshl_add_u32 v10, v14, 4, v10
s_lshl_b32 s43, s34, 18
s_lshl_b32 s44, s36, 16
s_add_u32 s43, s43, s44
s_lshl_b32 s44, s35, 7
s_add_u32 s43, s43, s44
buffer_load_dwordx4 v[128:131], v10, s[8:11], s43 offen offset:0
buffer_load_dwordx4 v[132:135], v10, s[8:11], s43 offen offset:64
buffer_load_dwordx4 v[136:139], v10, s[8:11], s43 offen offset:2048
buffer_load_dwordx4 v[140:143], v10, s[8:11], s43 offen offset:2112
v_and_b32 v12, 15, v1
v_lshrrev_b32 v13, 4, v1
s_mul_i32 s43, s34, 262144
s_add_u32 s20, s82, s43
s_addc_u32 s21, s83, 0
s_add_u32 s20, s20, 4194304
s_addc_u32 s21, s21, 0
s_mov_b32 s22, 262144
s_mov_b32 s23, 0x20000
s_mul_i32 s43, s34, 16384
s_add_u32 s24, s82, s43
s_addc_u32 s25, s83, 0
s_add_u32 s24, s24, 25165824
s_addc_u32 s25, s25, 0
s_mov_b32 s26, 16384
s_mov_b32 s27, 0x20000
v_lshlrev_b32 v11, 4, v1
s_lshl_b32 s43, s36, 11
v_add_u32 v2, s43, v11
v_add_u32 v3, 98304, v2
v_lshrrev_b32 v14, 2, v1
v_bfe_u32 v15, v14, 1, 2
v_mul_u32_u24 v14, 128, v14
v_lshl_add_u32 v14, v15, 5, v14
v_and_b32 v15, 3, v1
v_lshl_add_u32 v4, v15, 3, v14
v_xor_b32 v5, 32, v4
v_xor_b32 v6, 64, v4
v_xor_b32 v7, 96, v4
v_add_u32 v16, 0x10000, v4
v_add_u32 v20, 0x20000, v4
v_add_u32 v17, 0x10000, v5
v_add_u32 v21, 0x20000, v5
v_add_u32 v18, 0x10000, v6
v_add_u32 v22, 0x20000, v6
v_add_u32 v19, 0x10000, v7
v_add_u32 v23, 0x20000, v7
s_lshl_b32 s44, s35, 14
s_add_u32 s60, s44, s43
v_lshrrev_b32 v14, 1, v13
v_lshlrev_b32 v14, 11, v14
v_lshl_add_u32 v14, v12, 3, v14
v_and_b32 v15, 1, v13
v_lshl_add_u32 v14, v15, 2, v14
s_lshl_b32 s43, s36, 12
s_lshl_b32 s44, s35, 7
s_add_u32 s43, s43, s44
v_add_u32 v9, s43, v14
s_mov_b32 s61, 0x3f803f80
s_waitcnt vmcnt(0)
v_permlane16_swap_b32 v128, v130
v_permlane16_swap_b32 v129, v131
v_permlane16_swap_b32 v132, v134
v_permlane16_swap_b32 v133, v135
v_permlane16_swap_b32 v136, v138
v_permlane16_swap_b32 v137, v139
v_permlane16_swap_b32 v140, v142
v_permlane16_swap_b32 v141, v143
v_lshlrev_b32 v96, 16, v128
v_and_b32 v97, 0xffff0000, v128
v_lshlrev_b32 v98, 16, v129
v_and_b32 v99, 0xffff0000, v129
v_lshlrev_b32 v100, 16, v130
v_and_b32 v101, 0xffff0000, v130
v_lshlrev_b32 v102, 16, v131
v_and_b32 v103, 0xffff0000, v131
v_lshlrev_b32 v104, 16, v132
v_and_b32 v105, 0xffff0000, v132
v_lshlrev_b32 v106, 16, v133
v_and_b32 v107, 0xffff0000, v133
v_lshlrev_b32 v108, 16, v134
v_and_b32 v109, 0xffff0000, v134
v_lshlrev_b32 v110, 16, v135
v_and_b32 v111, 0xffff0000, v135
v_lshlrev_b32 v112, 16, v136
v_and_b32 v113, 0xffff0000, v136
v_lshlrev_b32 v114, 16, v137
v_and_b32 v115, 0xffff0000, v137
v_lshlrev_b32 v116, 16, v138
v_and_b32 v117, 0xffff0000, v138
v_lshlrev_b32 v118, 16, v139
v_and_b32 v119, 0xffff0000, v139
v_lshlrev_b32 v120, 16, v140
v_and_b32 v121, 0xffff0000, v140
v_lshlrev_b32 v122, 16, v141
v_and_b32 v123, 0xffff0000, v141
v_lshlrev_b32 v124, 16, v142
v_and_b32 v125, 0xffff0000, v142
v_lshlrev_b32 v126, 16, v143
v_and_b32 v127, 0xffff0000, v143
s_cmp_lg_u32 s36, 0
s_cbranch_scc1 Lwm_87
s_nop 0
s_branch Lwe_86
Lwm_87:
s_cmp_lg_u32 s36, 1
s_cbranch_scc1 Lwm_88
s_nop 0
s_branch Lwe_86
Lwm_88:
s_cmp_lg_u32 s36, 2
s_cbranch_scc1 Lwm_89
s_nop 0
s_branch Lwe_86
Lwm_89:
s_cmp_lg_u32 s36, 3
s_cbranch_scc1 Lwm_90
s_nop 0
s_branch Lwe_86
Lwm_90:
Lwe_86:
s_barrier
ds_read_b128 v[32:35], v2 offset:0
ds_read_b64_tr_b16 v[40:41], v16 offset:0
ds_read_b64_tr_b16 v[42:43], v16 offset:2048
ds_read_b64_tr_b16 v[44:45], v17 offset:0
ds_read_b64_tr_b16 v[46:47], v17 offset:2048
ds_read_b64_tr_b16 v[48:49], v18 offset:0
ds_read_b64_tr_b16 v[50:51], v18 offset:2048
ds_read_b64_tr_b16 v[52:53], v19 offset:0
ds_read_b64_tr_b16 v[54:55], v19 offset:2048
ds_read_b128 v[36:39], v2 offset:1024
ds_read_b128 v[56:59], v2 offset:8192
ds_read_b64_tr_b16 v[64:65], v16 offset:4096
ds_read_b64_tr_b16 v[66:67], v16 offset:6144
ds_read_b64_tr_b16 v[68:69], v17 offset:4096
ds_read_b64_tr_b16 v[70:71], v17 offset:6144
ds_read_b64_tr_b16 v[72:73], v18 offset:4096
ds_read_b64_tr_b16 v[74:75], v18 offset:6144
ds_read_b64_tr_b16 v[76:77], v19 offset:4096
ds_read_b64_tr_b16 v[78:79], v19 offset:6144
ds_read_b128 v[60:63], v2 offset:9216
s_waitcnt lgkmcnt(0)
s_barrier
v_mfma_f32_16x16x32_bf16 v[96:99], v[40:43], v[32:35], v[96:99]
ds_read_b128 v[144:147], v2 offset:49152
ds_read_b64_tr_b16 v[152:153], v16 offset:8192
v_mfma_f32_16x16x32_bf16 v[100:103], v[44:47], v[32:35], v[100:103]
ds_read_b64_tr_b16 v[154:155], v16 offset:10240
ds_read_b64_tr_b16 v[156:157], v17 offset:8192
v_mfma_f32_16x16x32_bf16 v[104:107], v[48:51], v[32:35], v[104:107]
ds_read_b64_tr_b16 v[158:159], v17 offset:10240
ds_read_b64_tr_b16 v[160:161], v18 offset:8192
v_mfma_f32_16x16x32_bf16 v[108:111], v[52:55], v[32:35], v[108:111]
ds_read_b64_tr_b16 v[162:163], v18 offset:10240
ds_read_b64_tr_b16 v[164:165], v19 offset:8192
v_mfma_f32_16x16x32_bf16 v[124:127], v[52:55], v[36:39], v[124:127]
ds_read_b64_tr_b16 v[166:167], v19 offset:10240
ds_read_b128 v[148:151], v2 offset:50176
v_mfma_f32_16x16x32_bf16 v[120:123], v[48:51], v[36:39], v[120:123]
ds_read_b128 v[168:171], v2 offset:57344
ds_read_b64_tr_b16 v[176:177], v16 offset:12288
v_mfma_f32_16x16x32_bf16 v[116:119], v[44:47], v[36:39], v[116:119]
ds_read_b64_tr_b16 v[178:179], v16 offset:14336
ds_read_b64_tr_b16 v[180:181], v17 offset:12288
v_mfma_f32_16x16x32_bf16 v[112:115], v[40:43], v[36:39], v[112:115]
ds_read_b64_tr_b16 v[182:183], v17 offset:14336
ds_read_b64_tr_b16 v[184:185], v18 offset:12288
v_mfma_f32_16x16x32_bf16 v[96:99], v[64:67], v[56:59], v[96:99]
ds_read_b64_tr_b16 v[186:187], v18 offset:14336
ds_read_b64_tr_b16 v[188:189], v19 offset:12288
v_mfma_f32_16x16x32_bf16 v[100:103], v[68:71], v[56:59], v[100:103]
ds_read_b64_tr_b16 v[190:191], v19 offset:14336
ds_read_b128 v[172:175], v2 offset:58368
v_mfma_f32_16x16x32_bf16 v[104:107], v[72:75], v[56:59], v[104:107]
s_bitcmp0_b32 s36, 1
v_mfma_f32_16x16x32_bf16 v[108:111], v[76:79], v[56:59], v[108:111]
s_cselect_b32 s44, s72, s74
v_mfma_f32_16x16x32_bf16 v[124:127], v[76:79], v[60:63], v[124:127]
s_cselect_b32 s45, s73, s75
v_mfma_f32_16x16x32_bf16 v[120:123], v[72:75], v[60:63], v[120:123]
s_mul_i32 s43, s35, 192
v_mfma_f32_16x16x32_bf16 v[116:119], v[68:71], v[60:63], v[116:119]
s_add_u32 s16, s44, s43
v_mfma_f32_16x16x32_bf16 v[112:115], v[64:67], v[60:63], v[112:115]
s_addc_u32 s17, s45, 0
s_waitcnt lgkmcnt(0)
s_barrier
v_mfma_f32_16x16x32_bf16 v[96:99], v[152:155], v[144:147], v[96:99]
ds_read_b128 v[32:35], v3 offset:0
ds_read_b64_tr_b16 v[40:41], v16 offset:16384
v_mfma_f32_16x16x32_bf16 v[100:103], v[156:159], v[144:147], v[100:103]
ds_read_b64_tr_b16 v[42:43], v16 offset:18432
ds_read_b64_tr_b16 v[44:45], v17 offset:16384
v_mfma_f32_16x16x32_bf16 v[104:107], v[160:163], v[144:147], v[104:107]
ds_read_b64_tr_b16 v[46:47], v17 offset:18432
ds_read_b64_tr_b16 v[48:49], v18 offset:16384
v_mfma_f32_16x16x32_bf16 v[108:111], v[164:167], v[144:147], v[108:111]
ds_read_b64_tr_b16 v[50:51], v18 offset:18432
ds_read_b64_tr_b16 v[52:53], v19 offset:16384
v_mfma_f32_16x16x32_bf16 v[124:127], v[164:167], v[148:151], v[124:127]
ds_read_b64_tr_b16 v[54:55], v19 offset:18432
ds_read_b128 v[36:39], v3 offset:1024
v_mfma_f32_16x16x32_bf16 v[120:123], v[160:163], v[148:151], v[120:123]
ds_read_b128 v[56:59], v3 offset:8192
ds_read_b64_tr_b16 v[64:65], v16 offset:20480
v_mfma_f32_16x16x32_bf16 v[116:119], v[156:159], v[148:151], v[116:119]
ds_read_b64_tr_b16 v[66:67], v16 offset:22528
ds_read_b64_tr_b16 v[68:69], v17 offset:20480
v_mfma_f32_16x16x32_bf16 v[112:115], v[152:155], v[148:151], v[112:115]
ds_read_b64_tr_b16 v[70:71], v17 offset:22528
ds_read_b64_tr_b16 v[72:73], v18 offset:20480
v_mfma_f32_16x16x32_bf16 v[96:99], v[176:179], v[168:171], v[96:99]
ds_read_b64_tr_b16 v[74:75], v18 offset:22528
ds_read_b64_tr_b16 v[76:77], v19 offset:20480
v_mfma_f32_16x16x32_bf16 v[100:103], v[180:183], v[168:171], v[100:103]
ds_read_b64_tr_b16 v[78:79], v19 offset:22528
ds_read_b128 v[60:63], v3 offset:9216
v_mfma_f32_16x16x32_bf16 v[104:107], v[184:187], v[168:171], v[104:107]
s_add_u32 s16, s16, 4096
v_mfma_f32_16x16x32_bf16 v[108:111], v[188:191], v[168:171], v[108:111]
s_addc_u32 s17, s17, 0
v_mfma_f32_16x16x32_bf16 v[124:127], v[188:191], v[172:175], v[124:127]
s_mov_b32 s18, 7333056
v_mfma_f32_16x16x32_bf16 v[120:123], v[184:187], v[172:175], v[120:123]
s_mov_b32 s19, 0x20000
v_mfma_f32_16x16x32_bf16 v[116:119], v[180:183], v[172:175], v[116:119]
s_and_b32 s43, s36, 1
v_mfma_f32_16x16x32_bf16 v[112:115], v[176:179], v[172:175], v[112:115]
s_mul_i32 s43, s43, 229376
s_waitcnt lgkmcnt(0)
s_barrier
v_mfma_f32_16x16x32_bf16 v[96:99], v[40:43], v[32:35], v[96:99]
ds_read_b128 v[144:147], v3 offset:49152
ds_read_b64_tr_b16 v[152:153], v16 offset:24576
v_mfma_f32_16x16x32_bf16 v[100:103], v[44:47], v[32:35], v[100:103]
ds_read_b64_tr_b16 v[154:155], v16 offset:26624
ds_read_b64_tr_b16 v[156:157], v17 offset:24576
v_mfma_f32_16x16x32_bf16 v[104:107], v[48:51], v[32:35], v[104:107]
ds_read_b64_tr_b16 v[158:159], v17 offset:26624
ds_read_b64_tr_b16 v[160:161], v18 offset:24576
v_mfma_f32_16x16x32_bf16 v[108:111], v[52:55], v[32:35], v[108:111]
ds_read_b64_tr_b16 v[162:163], v18 offset:26624
ds_read_b64_tr_b16 v[164:165], v19 offset:24576
v_mfma_f32_16x16x32_bf16 v[124:127], v[52:55], v[36:39], v[124:127]
ds_read_b64_tr_b16 v[166:167], v19 offset:26624
ds_read_b128 v[148:151], v3 offset:50176
v_mfma_f32_16x16x32_bf16 v[120:123], v[48:51], v[36:39], v[120:123]
ds_read_b128 v[168:171], v3 offset:57344
s_branch Lov_5
.p2align 12
.fill 32, 4, 0xbf800000
Lst_5_0:
s_branch Lwr_150
s_nop 0
s_nop 0
Lov_5:
ds_read_b64_tr_b16 v[176:177], v16 offset:28672
v_mfma_f32_16x16x32_bf16 v[116:119], v[44:47], v[36:39], v[116:119]
ds_read_b64_tr_b16 v[178:179], v16 offset:30720
ds_read_b64_tr_b16 v[180:181], v17 offset:28672
v_mfma_f32_16x16x32_bf16 v[112:115], v[40:43], v[36:39], v[112:115]
ds_read_b64_tr_b16 v[182:183], v17 offset:30720
ds_read_b64_tr_b16 v[184:185], v18 offset:28672
v_mfma_f32_16x16x32_bf16 v[96:99], v[64:67], v[56:59], v[96:99]
ds_read_b64_tr_b16 v[186:187], v18 offset:30720
ds_read_b64_tr_b16 v[188:189], v19 offset:28672
v_mfma_f32_16x16x32_bf16 v[100:103], v[68:71], v[56:59], v[100:103]
ds_read_b64_tr_b16 v[190:191], v19 offset:30720
ds_read_b128 v[172:175], v3 offset:58368
v_mfma_f32_16x16x32_bf16 v[104:107], v[72:75], v[56:59], v[104:107]
v_add_u32 v196, 0, v1
v_mfma_f32_16x16x32_bf16 v[108:111], v[76:79], v[56:59], v[108:111]
v_mul_u32_u24 v197, 5462, v196
v_mfma_f32_16x16x32_bf16 v[124:127], v[76:79], v[60:63], v[124:127]
v_lshrrev_b32 v197, 16, v197
v_mfma_f32_16x16x32_bf16 v[120:123], v[72:75], v[60:63], v[120:123]
v_mul_u32_u24 v198, 12, v197
v_mfma_f32_16x16x32_bf16 v[116:119], v[68:71], v[60:63], v[116:119]
v_sub_u32 v198, v196, v198
v_mfma_f32_16x16x32_bf16 v[112:115], v[64:67], v[60:63], v[112:115]
v_bfe_u32 v199, v197, 2, 1
s_waitcnt lgkmcnt(0)
s_barrier
v_mfma_f32_16x16x32_bf16 v[96:99], v[152:155], v[144:147], v[96:99]
ds_read_b128 v[32:35], v2 offset:0
ds_read_b64_tr_b16 v[40:41], v16 offset:49152
v_mfma_f32_16x16x32_bf16 v[100:103], v[156:159], v[144:147], v[100:103]
ds_read_b64_tr_b16 v[42:43], v16 offset:51200
ds_read_b64_tr_b16 v[44:45], v17 offset:49152
v_mfma_f32_16x16x32_bf16 v[104:107], v[160:163], v[144:147], v[104:107]
ds_read_b64_tr_b16 v[46:47], v17 offset:51200
ds_read_b64_tr_b16 v[48:49], v18 offset:49152
v_mfma_f32_16x16x32_bf16 v[108:111], v[164:167], v[144:147], v[108:111]
ds_read_b64_tr_b16 v[50:51], v18 offset:51200
ds_read_b64_tr_b16 v[52:53], v19 offset:49152
v_mfma_f32_16x16x32_bf16 v[124:127], v[164:167], v[148:151], v[124:127]
ds_read_b64_tr_b16 v[54:55], v19 offset:51200
ds_read_b128 v[36:39], v2 offset:1024
v_mfma_f32_16x16x32_bf16 v[120:123], v[160:163], v[148:151], v[120:123]
ds_read_b128 v[56:59], v2 offset:8192
ds_read_b64_tr_b16 v[64:65], v16 offset:53248
v_mfma_f32_16x16x32_bf16 v[116:119], v[156:159], v[148:151], v[116:119]
ds_read_b64_tr_b16 v[66:67], v16 offset:55296
ds_read_b64_tr_b16 v[68:69], v17 offset:53248
v_mfma_f32_16x16x32_bf16 v[112:115], v[152:155], v[148:151], v[112:115]
ds_read_b64_tr_b16 v[70:71], v17 offset:55296
ds_read_b64_tr_b16 v[72:73], v18 offset:53248
v_mfma_f32_16x16x32_bf16 v[96:99], v[176:179], v[168:171], v[96:99]
ds_read_b64_tr_b16 v[74:75], v18 offset:55296
ds_read_b64_tr_b16 v[76:77], v19 offset:53248
v_mfma_f32_16x16x32_bf16 v[100:103], v[180:183], v[168:171], v[100:103]
ds_read_b64_tr_b16 v[78:79], v19 offset:55296
ds_read_b128 v[60:63], v2 offset:9216
v_mfma_f32_16x16x32_bf16 v[104:107], v[184:187], v[168:171], v[104:107]
v_cmp_gt_u32 vcc, 8, v198
v_mfma_f32_16x16x32_bf16 v[108:111], v[188:191], v[168:171], v[108:111]
v_lshlrev_b32 v200, 1, v199
v_mfma_f32_16x16x32_bf16 v[124:127], v[188:191], v[172:175], v[124:127]
v_mul_u32_u24 v197, 7168, v197
v_mfma_f32_16x16x32_bf16 v[120:123], v[184:187], v[172:175], v[120:123]
v_cndmask_b32 v199, v199, v200, vcc
v_mfma_f32_16x16x32_bf16 v[116:119], v[180:183], v[172:175], v[116:119]
v_xor_b32 v198, v198, v199
v_mfma_f32_16x16x32_bf16 v[112:115], v[176:179], v[172:175], v[112:115]
v_lshl_add_u32 v192, v198, 4, v197
s_waitcnt lgkmcnt(0)
s_barrier
v_mfma_f32_16x16x32_bf16 v[96:99], v[40:43], v[32:35], v[96:99]
ds_read_b128 v[144:147], v2 offset:49152
ds_read_b64_tr_b16 v[152:153], v16 offset:57344
v_mfma_f32_16x16x32_bf16 v[100:103], v[44:47], v[32:35], v[100:103]
ds_read_b64_tr_b16 v[154:155], v16 offset:59392
ds_read_b64_tr_b16 v[156:157], v17 offset:57344
v_mfma_f32_16x16x32_bf16 v[104:107], v[48:51], v[32:35], v[104:107]
ds_read_b64_tr_b16 v[158:159], v17 offset:59392
ds_read_b64_tr_b16 v[160:161], v18 offset:57344
v_mfma_f32_16x16x32_bf16 v[108:111], v[52:55], v[32:35], v[108:111]
ds_read_b64_tr_b16 v[162:163], v18 offset:59392
ds_read_b64_tr_b16 v[164:165], v19 offset:57344
v_mfma_f32_16x16x32_bf16 v[124:127], v[52:55], v[36:39], v[124:127]
ds_read_b64_tr_b16 v[166:167], v19 offset:59392
ds_read_b128 v[148:151], v2 offset:50176
v_mfma_f32_16x16x32_bf16 v[120:123], v[48:51], v[36:39], v[120:123]
ds_read_b128 v[168:171], v2 offset:57344
ds_read_b64_tr_b16 v[176:177], v16 offset:61440
v_mfma_f32_16x16x32_bf16 v[116:119], v[44:47], v[36:39], v[116:119]
ds_read_b64_tr_b16 v[178:179], v16 offset:63488
ds_read_b64_tr_b16 v[180:181], v17 offset:61440
v_mfma_f32_16x16x32_bf16 v[112:115], v[40:43], v[36:39], v[112:115]
ds_read_b64_tr_b16 v[182:183], v17 offset:63488
ds_read_b64_tr_b16 v[184:185], v18 offset:61440
v_mfma_f32_16x16x32_bf16 v[96:99], v[64:67], v[56:59], v[96:99]
ds_read_b64_tr_b16 v[186:187], v18 offset:63488
ds_read_b64_tr_b16 v[188:189], v19 offset:61440
v_mfma_f32_16x16x32_bf16 v[100:103], v[68:71], v[56:59], v[100:103]
ds_read_b64_tr_b16 v[190:191], v19 offset:63488
ds_read_b128 v[172:175], v2 offset:58368
v_mfma_f32_16x16x32_bf16 v[104:107], v[72:75], v[56:59], v[104:107]
v_add_u32 v196, 64, v1
v_mfma_f32_16x16x32_bf16 v[108:111], v[76:79], v[56:59], v[108:111]
v_mul_u32_u24 v197, 5462, v196
v_mfma_f32_16x16x32_bf16 v[124:127], v[76:79], v[60:63], v[124:127]
v_lshrrev_b32 v197, 16, v197
v_mfma_f32_16x16x32_bf16 v[120:123], v[72:75], v[60:63], v[120:123]
v_mul_u32_u24 v198, 12, v197
v_mfma_f32_16x16x32_bf16 v[116:119], v[68:71], v[60:63], v[116:119]
v_sub_u32 v198, v196, v198
v_mfma_f32_16x16x32_bf16 v[112:115], v[64:67], v[60:63], v[112:115]
v_bfe_u32 v199, v197, 2, 1
s_waitcnt lgkmcnt(0)
s_barrier
v_mfma_f32_16x16x32_bf16 v[96:99], v[152:155], v[144:147], v[96:99]
ds_read_b128 v[32:35], v3 offset:0
ds_read_b64_tr_b16 v[40:41], v20 offset:0
v_mfma_f32_16x16x32_bf16 v[100:103], v[156:159], v[144:147], v[100:103]
ds_read_b64_tr_b16 v[42:43], v20 offset:2048
ds_read_b64_tr_b16 v[44:45], v21 offset:0
v_mfma_f32_16x16x32_bf16 v[104:107], v[160:163], v[144:147], v[104:107]
ds_read_b64_tr_b16 v[46:47], v21 offset:2048
ds_read_b64_tr_b16 v[48:49], v22 offset:0
v_mfma_f32_16x16x32_bf16 v[108:111], v[164:167], v[144:147], v[108:111]
ds_read_b64_tr_b16 v[50:51], v22 offset:2048
ds_read_b64_tr_b16 v[52:53], v23 offset:0
v_mfma_f32_16x16x32_bf16 v[124:127], v[164:167], v[148:151], v[124:127]
ds_read_b64_tr_b16 v[54:55], v23 offset:2048
ds_read_b128 v[36:39], v3 offset:1024
v_mfma_f32_16x16x32_bf16 v[120:123], v[160:163], v[148:151], v[120:123]
ds_read_b128 v[56:59], v3 offset:8192
ds_read_b64_tr_b16 v[64:65], v20 offset:4096
v_mfma_f32_16x16x32_bf16 v[116:119], v[156:159], v[148:151], v[116:119]
ds_read_b64_tr_b16 v[66:67], v20 offset:6144
ds_read_b64_tr_b16 v[68:69], v21 offset:4096
v_mfma_f32_16x16x32_bf16 v[112:115], v[152:155], v[148:151], v[112:115]
ds_read_b64_tr_b16 v[70:71], v21 offset:6144
ds_read_b64_tr_b16 v[72:73], v22 offset:4096
v_mfma_f32_16x16x32_bf16 v[96:99], v[176:179], v[168:171], v[96:99]
ds_read_b64_tr_b16 v[74:75], v22 offset:6144
ds_read_b64_tr_b16 v[76:77], v23 offset:4096
v_mfma_f32_16x16x32_bf16 v[100:103], v[180:183], v[168:171], v[100:103]
ds_read_b64_tr_b16 v[78:79], v23 offset:6144
ds_read_b128 v[60:63], v3 offset:9216
v_mfma_f32_16x16x32_bf16 v[104:107], v[184:187], v[168:171], v[104:107]
v_cmp_gt_u32 vcc, 8, v198
v_mfma_f32_16x16x32_bf16 v[108:111], v[188:191], v[168:171], v[108:111]
v_lshlrev_b32 v200, 1, v199
v_mfma_f32_16x16x32_bf16 v[124:127], v[188:191], v[172:175], v[124:127]
v_mul_u32_u24 v197, 7168, v197
v_mfma_f32_16x16x32_bf16 v[120:123], v[184:187], v[172:175], v[120:123]
v_cndmask_b32 v199, v199, v200, vcc
v_mfma_f32_16x16x32_bf16 v[116:119], v[180:183], v[172:175], v[116:119]
v_xor_b32 v198, v198, v199
v_mfma_f32_16x16x32_bf16 v[112:115], v[176:179], v[172:175], v[112:115]
v_lshl_add_u32 v193, v198, 4, v197
s_waitcnt lgkmcnt(0)
s_barrier
v_mfma_f32_16x16x32_bf16 v[96:99], v[40:43], v[32:35], v[96:99]
ds_read_b128 v[144:147], v3 offset:49152
ds_read_b64_tr_b16 v[152:153], v20 offset:8192
v_mfma_f32_16x16x32_bf16 v[100:103], v[44:47], v[32:35], v[100:103]
ds_read_b64_tr_b16 v[154:155], v20 offset:10240
ds_read_b64_tr_b16 v[156:157], v21 offset:8192
v_mfma_f32_16x16x32_bf16 v[104:107], v[48:51], v[32:35], v[104:107]
ds_read_b64_tr_b16 v[158:159], v21 offset:10240
ds_read_b64_tr_b16 v[160:161], v22 offset:8192
v_mfma_f32_16x16x32_bf16 v[108:111], v[52:55], v[32:35], v[108:111]
ds_read_b64_tr_b16 v[162:163], v22 offset:10240
ds_read_b64_tr_b16 v[164:165], v23 offset:8192
v_mfma_f32_16x16x32_bf16 v[124:127], v[52:55], v[36:39], v[124:127]
ds_read_b64_tr_b16 v[166:167], v23 offset:10240
ds_read_b128 v[148:151], v3 offset:50176
v_mfma_f32_16x16x32_bf16 v[120:123], v[48:51], v[36:39], v[120:123]
ds_read_b128 v[168:171], v3 offset:57344
ds_read_b64_tr_b16 v[176:177], v20 offset:12288
v_mfma_f32_16x16x32_bf16 v[116:119], v[44:47], v[36:39], v[116:119]
ds_read_b64_tr_b16 v[178:179], v20 offset:14336
ds_read_b64_tr_b16 v[180:181], v21 offset:12288
v_mfma_f32_16x16x32_bf16 v[112:115], v[40:43], v[36:39], v[112:115]
ds_read_b64_tr_b16 v[182:183], v21 offset:14336
ds_read_b64_tr_b16 v[184:185], v22 offset:12288
v_mfma_f32_16x16x32_bf16 v[96:99], v[64:67], v[56:59], v[96:99]
ds_read_b64_tr_b16 v[186:187], v22 offset:14336
ds_read_b64_tr_b16 v[188:189], v23 offset:12288
v_mfma_f32_16x16x32_bf16 v[100:103], v[68:71], v[56:59], v[100:103]
ds_read_b64_tr_b16 v[190:191], v23 offset:14336
ds_read_b128 v[172:175], v3 offset:58368
v_mfma_f32_16x16x32_bf16 v[104:107], v[72:75], v[56:59], v[104:107]
v_add_u32 v196, 128, v1
v_mfma_f32_16x16x32_bf16 v[108:111], v[76:79], v[56:59], v[108:111]
v_mul_u32_u24 v197, 5462, v196
v_mfma_f32_16x16x32_bf16 v[124:127], v[76:79], v[60:63], v[124:127]
v_lshrrev_b32 v197, 16, v197
v_mfma_f32_16x16x32_bf16 v[120:123], v[72:75], v[60:63], v[120:123]
v_mul_u32_u24 v198, 12, v197
v_mfma_f32_16x16x32_bf16 v[116:119], v[68:71], v[60:63], v[116:119]
v_sub_u32 v198, v196, v198
v_mfma_f32_16x16x32_bf16 v[112:115], v[64:67], v[60:63], v[112:115]
v_bfe_u32 v199, v197, 2, 1
s_waitcnt lgkmcnt(0)
s_barrier
v_mfma_f32_16x16x32_bf16 v[96:99], v[152:155], v[144:147], v[96:99]
ds_read_b128 v[32:35], v2 offset:0
ds_read_b64_tr_b16 v[40:41], v4 offset:16384
v_mfma_f32_16x16x32_bf16 v[100:103], v[156:159], v[144:147], v[100:103]
ds_read_b64_tr_b16 v[42:43], v4 offset:18432
ds_read_b64_tr_b16 v[44:45], v5 offset:16384
v_mfma_f32_16x16x32_bf16 v[104:107], v[160:163], v[144:147], v[104:107]
ds_read_b64_tr_b16 v[46:47], v5 offset:18432
ds_read_b64_tr_b16 v[48:49], v6 offset:16384
v_mfma_f32_16x16x32_bf16 v[108:111], v[164:167], v[144:147], v[108:111]
ds_read_b64_tr_b16 v[50:51], v6 offset:18432
ds_read_b64_tr_b16 v[52:53], v7 offset:16384
v_mfma_f32_16x16x32_bf16 v[124:127], v[164:167], v[148:151], v[124:127]
ds_read_b64_tr_b16 v[54:55], v7 offset:18432
ds_read_b128 v[36:39], v2 offset:1024
v_mfma_f32_16x16x32_bf16 v[120:123], v[160:163], v[148:151], v[120:123]
ds_read_b128 v[56:59], v2 offset:8192
ds_read_b64_tr_b16 v[64:65], v4 offset:20480
v_mfma_f32_16x16x32_bf16 v[116:119], v[156:159], v[148:151], v[116:119]
ds_read_b64_tr_b16 v[66:67], v4 offset:22528
ds_read_b64_tr_b16 v[68:69], v5 offset:20480
v_mfma_f32_16x16x32_bf16 v[112:115], v[152:155], v[148:151], v[112:115]
ds_read_b64_tr_b16 v[70:71], v5 offset:22528
ds_read_b64_tr_b16 v[72:73], v6 offset:20480
v_mfma_f32_16x16x32_bf16 v[96:99], v[176:179], v[168:171], v[96:99]
ds_read_b64_tr_b16 v[74:75], v6 offset:22528
ds_read_b64_tr_b16 v[76:77], v7 offset:20480
v_mfma_f32_16x16x32_bf16 v[100:103], v[180:183], v[168:171], v[100:103]
ds_read_b64_tr_b16 v[78:79], v7 offset:22528
ds_read_b128 v[60:63], v2 offset:9216
v_mfma_f32_16x16x32_bf16 v[104:107], v[184:187], v[168:171], v[104:107]
v_cmp_gt_u32 vcc, 8, v198
v_mfma_f32_16x16x32_bf16 v[108:111], v[188:191], v[168:171], v[108:111]
v_lshlrev_b32 v200, 1, v199
v_mfma_f32_16x16x32_bf16 v[124:127], v[188:191], v[172:175], v[124:127]
v_mul_u32_u24 v197, 7168, v197
v_mfma_f32_16x16x32_bf16 v[120:123], v[184:187], v[172:175], v[120:123]
v_cndmask_b32 v199, v199, v200, vcc
v_mfma_f32_16x16x32_bf16 v[116:119], v[180:183], v[172:175], v[116:119]
v_xor_b32 v198, v198, v199
v_mfma_f32_16x16x32_bf16 v[112:115], v[176:179], v[172:175], v[112:115]
v_lshl_add_u32 v194, v198, 4, v197
s_waitcnt lgkmcnt(0)
s_barrier
v_mfma_f32_16x16x32_bf16 v[96:99], v[40:43], v[32:35], v[96:99]
ds_read_b128 v[144:147], v2 offset:49152
ds_read_b64_tr_b16 v[152:153], v4 offset:24576
v_mfma_f32_16x16x32_bf16 v[100:103], v[44:47], v[32:35], v[100:103]
ds_read_b64_tr_b16 v[154:155], v4 offset:26624
ds_read_b64_tr_b16 v[156:157], v5 offset:24576
v_mfma_f32_16x16x32_bf16 v[104:107], v[48:51], v[32:35], v[104:107]
ds_read_b64_tr_b16 v[158:159], v5 offset:26624
ds_read_b64_tr_b16 v[160:161], v6 offset:24576
v_mfma_f32_16x16x32_bf16 v[108:111], v[52:55], v[32:35], v[108:111]
ds_read_b64_tr_b16 v[162:163], v6 offset:26624
ds_read_b64_tr_b16 v[164:165], v7 offset:24576
v_mfma_f32_16x16x32_bf16 v[124:127], v[52:55], v[36:39], v[124:127]
ds_read_b64_tr_b16 v[166:167], v7 offset:26624
ds_read_b128 v[148:151], v2 offset:50176
v_mfma_f32_16x16x32_bf16 v[120:123], v[48:51], v[36:39], v[120:123]
ds_read_b128 v[168:171], v2 offset:57344
ds_read_b64_tr_b16 v[176:177], v4 offset:28672
v_mfma_f32_16x16x32_bf16 v[116:119], v[44:47], v[36:39], v[116:119]
ds_read_b64_tr_b16 v[178:179], v4 offset:30720
ds_read_b64_tr_b16 v[180:181], v5 offset:28672
v_mfma_f32_16x16x32_bf16 v[112:115], v[40:43], v[36:39], v[112:115]
ds_read_b64_tr_b16 v[182:183], v5 offset:30720
ds_read_b64_tr_b16 v[184:185], v6 offset:28672
v_mfma_f32_16x16x32_bf16 v[96:99], v[64:67], v[56:59], v[96:99]
ds_read_b64_tr_b16 v[186:187], v6 offset:30720
ds_read_b64_tr_b16 v[188:189], v7 offset:28672
v_mfma_f32_16x16x32_bf16 v[100:103], v[68:71], v[56:59], v[100:103]
ds_read_b64_tr_b16 v[190:191], v7 offset:30720
ds_read_b128 v[172:175], v2 offset:58368
v_mfma_f32_16x16x32_bf16 v[104:107], v[72:75], v[56:59], v[104:107]
v_add_u32 v192, s43, v192
v_mfma_f32_16x16x32_bf16 v[108:111], v[76:79], v[56:59], v[108:111]
v_add_u32 v193, s43, v193
v_mfma_f32_16x16x32_bf16 v[124:127], v[76:79], v[60:63], v[124:127]
v_add_u32 v194, s43, v194
v_mfma_f32_16x16x32_bf16 v[120:123], v[72:75], v[60:63], v[120:123]
s_and_b32 s43, s36, 3
v_mfma_f32_16x16x32_bf16 v[116:119], v[68:71], v[60:63], v[116:119]
s_mul_i32 s50, s43, 6144
v_mfma_f32_16x16x32_bf16 v[112:115], v[64:67], v[60:63], v[112:115]
s_add_u32 s50, s50, 16384
s_waitcnt lgkmcnt(0)
s_barrier
v_mfma_f32_16x16x32_bf16 v[96:99], v[152:155], v[144:147], v[96:99]
ds_read_b128 v[32:35], v3 offset:0
ds_read_b64_tr_b16 v[40:41], v4 offset:32768
v_mfma_f32_16x16x32_bf16 v[100:103], v[156:159], v[144:147], v[100:103]
ds_read_b64_tr_b16 v[42:43], v4 offset:34816
ds_read_b64_tr_b16 v[44:45], v5 offset:32768
v_mfma_f32_16x16x32_bf16 v[104:107], v[160:163], v[144:147], v[104:107]
ds_read_b64_tr_b16 v[46:47], v5 offset:34816
ds_read_b64_tr_b16 v[48:49], v6 offset:32768
v_mfma_f32_16x16x32_bf16 v[108:111], v[164:167], v[144:147], v[108:111]
ds_read_b64_tr_b16 v[50:51], v6 offset:34816
ds_read_b64_tr_b16 v[52:53], v7 offset:32768
v_mfma_f32_16x16x32_bf16 v[124:127], v[164:167], v[148:151], v[124:127]
ds_read_b64_tr_b16 v[54:55], v7 offset:34816
ds_read_b128 v[36:39], v3 offset:1024
v_mfma_f32_16x16x32_bf16 v[120:123], v[160:163], v[148:151], v[120:123]
ds_read_b128 v[56:59], v3 offset:8192
ds_read_b64_tr_b16 v[64:65], v4 offset:36864
v_mfma_f32_16x16x32_bf16 v[116:119], v[156:159], v[148:151], v[116:119]
ds_read_b64_tr_b16 v[66:67], v4 offset:38912
ds_read_b64_tr_b16 v[68:69], v5 offset:36864
v_mfma_f32_16x16x32_bf16 v[112:115], v[152:155], v[148:151], v[112:115]
ds_read_b64_tr_b16 v[70:71], v5 offset:38912
ds_read_b64_tr_b16 v[72:73], v6 offset:36864
v_mfma_f32_16x16x32_bf16 v[96:99], v[176:179], v[168:171], v[96:99]
ds_read_b64_tr_b16 v[74:75], v6 offset:38912
ds_read_b64_tr_b16 v[76:77], v7 offset:36864
v_mfma_f32_16x16x32_bf16 v[100:103], v[180:183], v[168:171], v[100:103]
ds_read_b64_tr_b16 v[78:79], v7 offset:38912
ds_read_b128 v[60:63], v3 offset:9216
v_mfma_f32_16x16x32_bf16 v[104:107], v[184:187], v[168:171], v[104:107]
s_bitcmp0_b32 s2, 0
v_mfma_f32_16x16x32_bf16 v[108:111], v[188:191], v[168:171], v[108:111]
s_cselect_b32 s88, s72, s74
v_mfma_f32_16x16x32_bf16 v[124:127], v[188:191], v[172:175], v[124:127]
s_cselect_b32 s89, s73, s75
v_mfma_f32_16x16x32_bf16 v[120:123], v[184:187], v[172:175], v[120:123]
s_mov_b32 s90, 7340032
v_mfma_f32_16x16x32_bf16 v[116:119], v[180:183], v[172:175], v[116:119]
s_mov_b32 s91, 0x20000
v_mfma_f32_16x16x32_bf16 v[112:115], v[176:179], v[172:175], v[112:115]
s_bfe_u32 s44, s2, 0x30001
s_waitcnt lgkmcnt(0)
s_barrier
v_mfma_f32_16x16x32_bf16 v[96:99], v[40:43], v[32:35], v[96:99]
ds_read_b128 v[144:147], v3 offset:49152
ds_read_b64_tr_b16 v[152:153], v4 offset:40960
v_mfma_f32_16x16x32_bf16 v[100:103], v[44:47], v[32:35], v[100:103]
ds_read_b64_tr_b16 v[154:155], v4 offset:43008
ds_read_b64_tr_b16 v[156:157], v5 offset:40960
v_mfma_f32_16x16x32_bf16 v[104:107], v[48:51], v[32:35], v[104:107]
ds_read_b64_tr_b16 v[158:159], v5 offset:43008
ds_read_b64_tr_b16 v[160:161], v6 offset:40960
v_mfma_f32_16x16x32_bf16 v[108:111], v[52:55], v[32:35], v[108:111]
ds_read_b64_tr_b16 v[162:163], v6 offset:43008
ds_read_b64_tr_b16 v[164:165], v7 offset:40960
v_mfma_f32_16x16x32_bf16 v[124:127], v[52:55], v[36:39], v[124:127]
ds_read_b64_tr_b16 v[166:167], v7 offset:43008
ds_read_b128 v[148:151], v3 offset:50176
v_mfma_f32_16x16x32_bf16 v[120:123], v[48:51], v[36:39], v[120:123]
ds_read_b128 v[168:171], v3 offset:57344
ds_read_b64_tr_b16 v[176:177], v4 offset:45056
v_mfma_f32_16x16x32_bf16 v[116:119], v[44:47], v[36:39], v[116:119]
ds_read_b64_tr_b16 v[178:179], v4 offset:47104
ds_read_b64_tr_b16 v[180:181], v5 offset:45056
v_mfma_f32_16x16x32_bf16 v[112:115], v[40:43], v[36:39], v[112:115]
ds_read_b64_tr_b16 v[182:183], v5 offset:47104
ds_read_b64_tr_b16 v[184:185], v6 offset:45056
v_mfma_f32_16x16x32_bf16 v[96:99], v[64:67], v[56:59], v[96:99]
ds_read_b64_tr_b16 v[186:187], v6 offset:47104
ds_read_b64_tr_b16 v[188:189], v7 offset:45056
v_mfma_f32_16x16x32_bf16 v[100:103], v[68:71], v[56:59], v[100:103]
ds_read_b64_tr_b16 v[190:191], v7 offset:47104
ds_read_b128 v[172:175], v3 offset:58368
v_mfma_f32_16x16x32_bf16 v[104:107], v[72:75], v[56:59], v[104:107]
s_lshl_b32 s44, s44, 2
v_mfma_f32_16x16x32_bf16 v[108:111], v[76:79], v[56:59], v[108:111]
s_and_b32 s43, s36, 3
v_mfma_f32_16x16x32_bf16 v[124:127], v[76:79], v[60:63], v[124:127]
s_add_u32 s44, s44, s43
v_mfma_f32_16x16x32_bf16 v[120:123], v[72:75], v[60:63], v[120:123]
s_lshl_b32 s44, s44, 5
v_mfma_f32_16x16x32_bf16 v[116:119], v[68:71], v[60:63], v[116:119]
v_lshrrev_b32 v195, 4, v1
v_mfma_f32_16x16x32_bf16 v[112:115], v[64:67], v[60:63], v[112:115]
v_add_u32 v195, s44, v195
s_waitcnt lgkmcnt(0)
s_barrier
v_mfma_f32_16x16x32_bf16 v[96:99], v[152:155], v[144:147], v[96:99]
ds_read_b128 v[32:35], v2 offset:0
ds_read_b64_tr_b16 v[40:41], v16 offset:49152
v_mfma_f32_16x16x32_bf16 v[100:103], v[156:159], v[144:147], v[100:103]
ds_read_b64_tr_b16 v[42:43], v16 offset:51200
ds_read_b64_tr_b16 v[44:45], v17 offset:49152
v_mfma_f32_16x16x32_bf16 v[104:107], v[160:163], v[144:147], v[104:107]
ds_read_b64_tr_b16 v[46:47], v17 offset:51200
ds_read_b64_tr_b16 v[48:49], v18 offset:49152
v_mfma_f32_16x16x32_bf16 v[108:111], v[164:167], v[144:147], v[108:111]
ds_read_b64_tr_b16 v[50:51], v18 offset:51200
ds_read_b64_tr_b16 v[52:53], v19 offset:49152
v_mfma_f32_16x16x32_bf16 v[124:127], v[164:167], v[148:151], v[124:127]
ds_read_b64_tr_b16 v[54:55], v19 offset:51200
ds_read_b128 v[36:39], v2 offset:1024
v_mfma_f32_16x16x32_bf16 v[120:123], v[160:163], v[148:151], v[120:123]
ds_read_b128 v[56:59], v2 offset:8192
ds_read_b64_tr_b16 v[64:65], v16 offset:53248
v_mfma_f32_16x16x32_bf16 v[116:119], v[156:159], v[148:151], v[116:119]
ds_read_b64_tr_b16 v[66:67], v16 offset:55296
ds_read_b64_tr_b16 v[68:69], v17 offset:53248
v_mfma_f32_16x16x32_bf16 v[112:115], v[152:155], v[148:151], v[112:115]
ds_read_b64_tr_b16 v[70:71], v17 offset:55296
ds_read_b64_tr_b16 v[72:73], v18 offset:53248
v_mfma_f32_16x16x32_bf16 v[96:99], v[176:179], v[168:171], v[96:99]
ds_read_b64_tr_b16 v[74:75], v18 offset:55296
ds_read_b64_tr_b16 v[76:77], v19 offset:53248
v_mfma_f32_16x16x32_bf16 v[100:103], v[180:183], v[168:171], v[100:103]
ds_read_b64_tr_b16 v[78:79], v19 offset:55296
ds_read_b128 v[60:63], v2 offset:9216
v_mfma_f32_16x16x32_bf16 v[104:107], v[184:187], v[168:171], v[104:107]
v_mul_u32_u24 v195, 7168, v195
v_mfma_f32_16x16x32_bf16 v[108:111], v[188:191], v[168:171], v[108:111]
v_and_b32 v196, 15, v1
v_mfma_f32_16x16x32_bf16 v[124:127], v[188:191], v[172:175], v[124:127]
v_lshl_add_u32 v195, v196, 4, v195
v_mfma_f32_16x16x32_bf16 v[120:123], v[184:187], v[172:175], v[120:123]
s_lshr_b32 s43, s2, 4
v_mfma_f32_16x16x32_bf16 v[116:119], v[180:183], v[172:175], v[116:119]
s_lshl_b32 s43, s43, 8
v_mfma_f32_16x16x32_bf16 v[112:115], v[176:179], v[172:175], v[112:115]
v_add_u32 v195, s43, v195
s_waitcnt lgkmcnt(0)
s_barrier
v_mfma_f32_16x16x32_bf16 v[96:99], v[40:43], v[32:35], v[96:99]
ds_read_b128 v[144:147], v2 offset:49152
ds_read_b64_tr_b16 v[152:153], v16 offset:57344
v_mfma_f32_16x16x32_bf16 v[100:103], v[44:47], v[32:35], v[100:103]
ds_read_b64_tr_b16 v[154:155], v16 offset:59392
ds_read_b64_tr_b16 v[156:157], v17 offset:57344
v_mfma_f32_16x16x32_bf16 v[104:107], v[48:51], v[32:35], v[104:107]
ds_read_b64_tr_b16 v[158:159], v17 offset:59392
ds_read_b64_tr_b16 v[160:161], v18 offset:57344
v_mfma_f32_16x16x32_bf16 v[108:111], v[52:55], v[32:35], v[108:111]
ds_read_b64_tr_b16 v[162:163], v18 offset:59392
ds_read_b64_tr_b16 v[164:165], v19 offset:57344
v_mfma_f32_16x16x32_bf16 v[124:127], v[52:55], v[36:39], v[124:127]
ds_read_b64_tr_b16 v[166:167], v19 offset:59392
ds_read_b128 v[148:151], v2 offset:50176
v_mfma_f32_16x16x32_bf16 v[120:123], v[48:51], v[36:39], v[120:123]
ds_read_b128 v[168:171], v2 offset:57344
ds_read_b64_tr_b16 v[176:177], v16 offset:61440
v_mfma_f32_16x16x32_bf16 v[116:119], v[44:47], v[36:39], v[116:119]
ds_read_b64_tr_b16 v[178:179], v16 offset:63488
ds_read_b64_tr_b16 v[180:181], v17 offset:61440
v_mfma_f32_16x16x32_bf16 v[112:115], v[40:43], v[36:39], v[112:115]
ds_read_b64_tr_b16 v[182:183], v17 offset:63488
ds_read_b64_tr_b16 v[184:185], v18 offset:61440
v_mfma_f32_16x16x32_bf16 v[96:99], v[64:67], v[56:59], v[96:99]
ds_read_b64_tr_b16 v[186:187], v18 offset:63488
ds_read_b64_tr_b16 v[188:189], v19 offset:61440
v_mfma_f32_16x16x32_bf16 v[100:103], v[68:71], v[56:59], v[100:103]
ds_read_b64_tr_b16 v[190:191], v19 offset:63488
ds_read_b128 v[172:175], v2 offset:58368
v_mfma_f32_16x16x32_bf16 v[104:107], v[72:75], v[56:59], v[104:107]
v_mfma_f32_16x16x32_bf16 v[108:111], v[76:79], v[56:59], v[108:111]
v_mfma_f32_16x16x32_bf16 v[124:127], v[76:79], v[60:63], v[124:127]
v_mfma_f32_16x16x32_bf16 v[120:123], v[72:75], v[60:63], v[120:123]
v_mfma_f32_16x16x32_bf16 v[116:119], v[68:71], v[60:63], v[116:119]
v_mfma_f32_16x16x32_bf16 v[112:115], v[64:67], v[60:63], v[112:115]
s_waitcnt lgkmcnt(0)
s_barrier
v_mfma_f32_16x16x32_bf16 v[96:99], v[152:155], v[144:147], v[96:99]
ds_read_b128 v[32:35], v3 offset:0
ds_read_b64_tr_b16 v[40:41], v20 offset:0
v_mfma_f32_16x16x32_bf16 v[100:103], v[156:159], v[144:147], v[100:103]
ds_read_b64_tr_b16 v[42:43], v20 offset:2048
ds_read_b64_tr_b16 v[44:45], v21 offset:0
v_mfma_f32_16x16x32_bf16 v[104:107], v[160:163], v[144:147], v[104:107]
ds_read_b64_tr_b16 v[46:47], v21 offset:2048
ds_read_b64_tr_b16 v[48:49], v22 offset:0
v_mfma_f32_16x16x32_bf16 v[108:111], v[164:167], v[144:147], v[108:111]
ds_read_b64_tr_b16 v[50:51], v22 offset:2048
ds_read_b64_tr_b16 v[52:53], v23 offset:0
v_mfma_f32_16x16x32_bf16 v[124:127], v[164:167], v[148:151], v[124:127]
ds_read_b64_tr_b16 v[54:55], v23 offset:2048
ds_read_b128 v[36:39], v3 offset:1024
v_mfma_f32_16x16x32_bf16 v[120:123], v[160:163], v[148:151], v[120:123]
ds_read_b128 v[56:59], v3 offset:8192
ds_read_b64_tr_b16 v[64:65], v20 offset:4096
v_mfma_f32_16x16x32_bf16 v[116:119], v[156:159], v[148:151], v[116:119]
ds_read_b64_tr_b16 v[66:67], v20 offset:6144
ds_read_b64_tr_b16 v[68:69], v21 offset:4096
v_mfma_f32_16x16x32_bf16 v[112:115], v[152:155], v[148:151], v[112:115]
ds_read_b64_tr_b16 v[70:71], v21 offset:6144
ds_read_b64_tr_b16 v[72:73], v22 offset:4096
v_mfma_f32_16x16x32_bf16 v[96:99], v[176:179], v[168:171], v[96:99]
ds_read_b64_tr_b16 v[74:75], v22 offset:6144
ds_read_b64_tr_b16 v[76:77], v23 offset:4096
v_mfma_f32_16x16x32_bf16 v[100:103], v[180:183], v[168:171], v[100:103]
ds_read_b64_tr_b16 v[78:79], v23 offset:6144
ds_read_b128 v[60:63], v3 offset:9216
v_mfma_f32_16x16x32_bf16 v[104:107], v[184:187], v[168:171], v[104:107]
v_mfma_f32_16x16x32_bf16 v[108:111], v[188:191], v[168:171], v[108:111]
v_mfma_f32_16x16x32_bf16 v[124:127], v[188:191], v[172:175], v[124:127]
v_mfma_f32_16x16x32_bf16 v[120:123], v[184:187], v[172:175], v[120:123]
v_mfma_f32_16x16x32_bf16 v[116:119], v[180:183], v[172:175], v[116:119]
v_mfma_f32_16x16x32_bf16 v[112:115], v[176:179], v[172:175], v[112:115]
s_waitcnt lgkmcnt(0)
s_barrier
v_mfma_f32_16x16x32_bf16 v[96:99], v[40:43], v[32:35], v[96:99]
ds_read_b128 v[144:147], v3 offset:49152
ds_read_b64_tr_b16 v[152:153], v20 offset:8192
v_mfma_f32_16x16x32_bf16 v[100:103], v[44:47], v[32:35], v[100:103]
ds_read_b64_tr_b16 v[154:155], v20 offset:10240
ds_read_b64_tr_b16 v[156:157], v21 offset:8192
v_mfma_f32_16x16x32_bf16 v[104:107], v[48:51], v[32:35], v[104:107]
ds_read_b64_tr_b16 v[158:159], v21 offset:10240
ds_read_b64_tr_b16 v[160:161], v22 offset:8192
v_mfma_f32_16x16x32_bf16 v[108:111], v[52:55], v[32:35], v[108:111]
ds_read_b64_tr_b16 v[162:163], v22 offset:10240
ds_read_b64_tr_b16 v[164:165], v23 offset:8192
v_mfma_f32_16x16x32_bf16 v[124:127], v[52:55], v[36:39], v[124:127]
ds_read_b64_tr_b16 v[166:167], v23 offset:10240
ds_read_b128 v[148:151], v3 offset:50176
v_mfma_f32_16x16x32_bf16 v[120:123], v[48:51], v[36:39], v[120:123]
ds_read_b128 v[168:171], v3 offset:57344
ds_read_b64_tr_b16 v[176:177], v20 offset:12288
v_mfma_f32_16x16x32_bf16 v[116:119], v[44:47], v[36:39], v[116:119]
ds_read_b64_tr_b16 v[178:179], v20 offset:14336
ds_read_b64_tr_b16 v[180:181], v21 offset:12288
v_mfma_f32_16x16x32_bf16 v[112:115], v[40:43], v[36:39], v[112:115]
ds_read_b64_tr_b16 v[182:183], v21 offset:14336
ds_read_b64_tr_b16 v[184:185], v22 offset:12288
v_mfma_f32_16x16x32_bf16 v[96:99], v[64:67], v[56:59], v[96:99]
ds_read_b64_tr_b16 v[186:187], v22 offset:14336
ds_read_b64_tr_b16 v[188:189], v23 offset:12288
s_branch Lov_6
.p2align 12
.fill 48, 4, 0xbf800000
Lst_6_0:
s_branch Lwr_151
s_nop 0
s_nop 0
Lov_6:
v_mfma_f32_16x16x32_bf16 v[100:103], v[68:71], v[56:59], v[100:103]
ds_read_b64_tr_b16 v[190:191], v23 offset:14336
ds_read_b128 v[172:175], v3 offset:58368
v_mfma_f32_16x16x32_bf16 v[104:107], v[72:75], v[56:59], v[104:107]
v_mfma_f32_16x16x32_bf16 v[108:111], v[76:79], v[56:59], v[108:111]
v_mfma_f32_16x16x32_bf16 v[124:127], v[76:79], v[60:63], v[124:127]
v_mfma_f32_16x16x32_bf16 v[120:123], v[72:75], v[60:63], v[120:123]
v_mfma_f32_16x16x32_bf16 v[116:119], v[68:71], v[60:63], v[116:119]
v_mfma_f32_16x16x32_bf16 v[112:115], v[64:67], v[60:63], v[112:115]
s_waitcnt lgkmcnt(0)
s_barrier
v_mfma_f32_16x16x32_bf16 v[96:99], v[152:155], v[144:147], v[96:99]
v_mfma_f32_16x16x32_bf16 v[100:103], v[156:159], v[144:147], v[100:103]
v_mfma_f32_16x16x32_bf16 v[104:107], v[160:163], v[144:147], v[104:107]
v_mfma_f32_16x16x32_bf16 v[108:111], v[164:167], v[144:147], v[108:111]
v_mfma_f32_16x16x32_bf16 v[124:127], v[164:167], v[148:151], v[124:127]
v_mfma_f32_16x16x32_bf16 v[120:123], v[160:163], v[148:151], v[120:123]
v_mfma_f32_16x16x32_bf16 v[116:119], v[156:159], v[148:151], v[116:119]
v_mfma_f32_16x16x32_bf16 v[112:115], v[152:155], v[148:151], v[112:115]
v_mfma_f32_16x16x32_bf16 v[96:99], v[176:179], v[168:171], v[96:99]
v_mfma_f32_16x16x32_bf16 v[100:103], v[180:183], v[168:171], v[100:103]
v_mfma_f32_16x16x32_bf16 v[104:107], v[184:187], v[168:171], v[104:107]
v_mfma_f32_16x16x32_bf16 v[108:111], v[188:191], v[168:171], v[108:111]
v_mfma_f32_16x16x32_bf16 v[124:127], v[188:191], v[172:175], v[124:127]
v_mfma_f32_16x16x32_bf16 v[120:123], v[184:187], v[172:175], v[120:123]
v_mfma_f32_16x16x32_bf16 v[116:119], v[180:183], v[172:175], v[116:119]
v_mfma_f32_16x16x32_bf16 v[112:115], v[176:179], v[172:175], v[112:115]
s_nop 3
v_cvt_pk_bf16_f32 v32, v96, v97
v_cvt_pk_bf16_f32 v33, v98, v99
v_cvt_pk_bf16_f32 v34, v100, v101
v_cvt_pk_bf16_f32 v35, v102, v103
s_add_u32 s43, s60, 0
buffer_store_dwordx4 v[32:35], v11, s[20:23], s43 offen offset:0 sc1
v_cvt_pk_bf16_f32 v36, v104, v105
v_cvt_pk_bf16_f32 v37, v106, v107
v_cvt_pk_bf16_f32 v38, v108, v109
v_cvt_pk_bf16_f32 v39, v110, v111
s_add_u32 s43, s60, 8192
buffer_store_dwordx4 v[36:39], v11, s[20:23], s43 offen offset:0 sc1
v_cvt_pk_bf16_f32 v44, v120, v121
v_cvt_pk_bf16_f32 v45, v122, v123
v_cvt_pk_bf16_f32 v46, v124, v125
v_cvt_pk_bf16_f32 v47, v126, v127
s_add_u32 s43, s60, 8192
buffer_store_dwordx4 v[44:47], v11, s[20:23], s43 offen offset:1024 sc1
v_cvt_pk_bf16_f32 v40, v112, v113
v_cvt_pk_bf16_f32 v41, v114, v115
v_cvt_pk_bf16_f32 v42, v116, v117
v_cvt_pk_bf16_f32 v43, v118, v119
s_add_u32 s43, s60, 0
buffer_store_dwordx4 v[40:43], v11, s[20:23], s43 offen offset:1024 sc1
v_mov_b32 v64, 0
v_mov_b32 v65, 0
v_mov_b32 v66, 0
v_mov_b32 v67, 0
v_mov_b32 v68, 0
v_mov_b32 v69, 0
v_mov_b32 v70, 0
v_mov_b32 v71, 0
v_dot2_f32_bf16 v64, v32, s61, v64
v_dot2_f32_bf16 v66, v32, v32, v66
v_dot2_f32_bf16 v68, v40, s61, v68
v_dot2_f32_bf16 v70, v40, v40, v70
v_dot2_f32_bf16 v65, v33, s61, v65
v_dot2_f32_bf16 v67, v33, v33, v67
v_dot2_f32_bf16 v69, v41, s61, v69
v_dot2_f32_bf16 v71, v41, v41, v71
v_dot2_f32_bf16 v64, v34, s61, v64
v_dot2_f32_bf16 v66, v34, v34, v66
v_dot2_f32_bf16 v68, v42, s61, v68
v_dot2_f32_bf16 v70, v42, v42, v70
v_dot2_f32_bf16 v65, v35, s61, v65
v_dot2_f32_bf16 v67, v35, v35, v67
v_dot2_f32_bf16 v69, v43, s61, v69
v_dot2_f32_bf16 v71, v43, v43, v71
v_dot2_f32_bf16 v64, v36, s61, v64
v_dot2_f32_bf16 v66, v36, v36, v66
v_dot2_f32_bf16 v68, v44, s61, v68
v_dot2_f32_bf16 v70, v44, v44, v70
v_dot2_f32_bf16 v65, v37, s61, v65
v_dot2_f32_bf16 v67, v37, v37, v67
v_dot2_f32_bf16 v69, v45, s61, v69
v_dot2_f32_bf16 v71, v45, v45, v71
v_dot2_f32_bf16 v64, v38, s61, v64
v_dot2_f32_bf16 v66, v38, v38, v66
v_dot2_f32_bf16 v68, v46, s61, v68
v_dot2_f32_bf16 v70, v46, v46, v70
v_dot2_f32_bf16 v65, v39, s61, v65
v_dot2_f32_bf16 v67, v39, v39, v67
v_dot2_f32_bf16 v69, v47, s61, v69
v_dot2_f32_bf16 v71, v47, v47, v71
s_nop 2
v_add_f32 v64, v64, v65
v_add_f32 v66, v66, v67
v_add_f32 v68, v68, v69
v_add_f32 v70, v70, v71
s_nop 1
v_permlane32_swap_b32 v64, v68
v_permlane32_swap_b32 v66, v70
v_add_f32 v64, v64, v68
v_add_f32 v66, v66, v70
s_nop 1
v_permlane16_swap_b32 v64, v66
v_add_f32 v64, v64, v66
buffer_store_dword v64, v9, s[24:27], 0 offen sc1
s_lshl_b32 s7, s34, 12
s_add_u32 s7, s7, 49280
v_lshl_add_u32 v4, v1, 8, s7
v_mov_b32 v5, 1
s_waitcnt vmcnt(0)
s_cmp_lg_u32 s36, 0
s_barrier
s_cbranch_scc1 Lk2end_83
s_mov_b64 exec, 0xffff
buffer_atomic_add v5, v4, s[56:59], 0 offen sc1
s_mov_b64 exec, -1
s_branch Lk2end_83
Lprod_84:
s_mul_i32 s43, s34, 262144
s_add_u32 s8, s82, s43
s_addc_u32 s9, s83, 0
s_mov_b32 s10, 262144
s_mov_b32 s11, 0x20000
s_lshl_b32 s43, s35, 7
s_add_u32 s12, s68, s43
s_addc_u32 s13, s69, 0
s_mov_b32 s14, 2095232
s_mov_b32 s15, 0x20000
s_and_b32 s47, s36, 3
s_lshl_b32 s39, s47, 12
v_lshlrev_b32 v2, 4, v1
v_add_u32 v2, s39, v2
v_lshrrev_b32 v12, 3, v1
v_and_b32 v13, 6, v12
v_and_b32 v3, 7, v1
v_xor_b32 v3, v3, v13
v_lshlrev_b32 v3, 4, v3
v_mul_u32_u24 v12, 2048, v12
v_add_u32 v3, v3, v12
s_lshl_b32 s43, s47, 15
v_add_u32 v3, s43, v3
s_lshl_b32 s40, s47, 11
s_add_u32 s37, s35, 0
s_and_b32 s37, s37, 15
s_lshl_b32 s37, s37, 14
s_add_u32 m0, s39, 0
s_nop 0
buffer_load_dwordx4 v2, s[8:11], s37 offen offset:0 sc1 lds
buffer_load_dwordx4 v2, s[8:11], s37 offen offset:1024 sc1 lds
buffer_load_dwordx4 v2, s[8:11], s37 offen offset:2048 sc1 lds
buffer_load_dwordx4 v2, s[8:11], s37 offen offset:3072 sc1 lds
s_add_u32 s38, s35, 4
s_and_b32 s38, s38, 15
s_lshl_b32 s38, s38, 17
s_add_u32 m0, s40, 114688
s_nop 0
buffer_load_dwordx4 v3, s[12:15], s38 offen lds
s_add_u32 m0, s40, 115712
s_add_u32 s38, s38, 16384
buffer_load_dwordx4 v3, s[12:15], s38 offen lds
s_add_u32 s38, s35, 5
s_and_b32 s38, s38, 15
s_lshl_b32 s38, s38, 17
s_add_u32 m0, s40, 122880
s_nop 0
buffer_load_dwordx4 v3, s[12:15], s38 offen lds
s_add_u32 m0, s40, 123904
s_add_u32 s38, s38, 16384
buffer_load_dwordx4 v3, s[12:15], s38 offen lds
s_add_u32 s38, s35, 6
s_and_b32 s38, s38, 15
s_lshl_b32 s38, s38, 17
s_add_u32 m0, s40, 131072
s_nop 0
buffer_load_dwordx4 v3, s[12:15], s38 offen lds
s_add_u32 m0, s40, 132096
s_add_u32 s38, s38, 16384
buffer_load_dwordx4 v3, s[12:15], s38 offen lds
s_add_u32 s38, s35, 7
s_and_b32 s38, s38, 15
s_lshl_b32 s38, s38, 17
s_add_u32 m0, s40, 139264
s_nop 0
buffer_load_dwordx4 v3, s[12:15], s38 offen lds
s_add_u32 m0, s40, 140288
s_add_u32 s38, s38, 16384
buffer_load_dwordx4 v3, s[12:15], s38 offen lds
s_bitcmp0_b32 s36, 1
s_cselect_b32 s44, s72, s74
s_cselect_b32 s45, s73, s75
s_mul_i32 s43, s35, 192
s_add_u32 s16, s44, s43
s_addc_u32 s17, s45, 0
s_add_u32 s16, s16, 4096
s_addc_u32 s17, s17, 0
s_mov_b32 s18, 7333056
s_mov_b32 s19, 0x20000
s_and_b32 s43, s36, 1
s_mul_i32 s43, s43, 229376
v_add_u32 v196, 0, v1
v_mul_u32_u24 v197, 5462, v196
v_lshrrev_b32 v197, 16, v197
v_mul_u32_u24 v198, 12, v197
v_sub_u32 v198, v196, v198
v_bfe_u32 v199, v197, 2, 1
v_cmp_gt_u32 vcc, 8, v198
v_lshlrev_b32 v200, 1, v199
v_mul_u32_u24 v197, 7168, v197
v_cndmask_b32 v199, v199, v200, vcc
v_xor_b32 v198, v198, v199
v_lshl_add_u32 v192, v198, 4, v197
v_add_u32 v196, 64, v1
v_mul_u32_u24 v197, 5462, v196
v_lshrrev_b32 v197, 16, v197
v_mul_u32_u24 v198, 12, v197
v_sub_u32 v198, v196, v198
v_bfe_u32 v199, v197, 2, 1
v_cmp_gt_u32 vcc, 8, v198
v_lshlrev_b32 v200, 1, v199
v_mul_u32_u24 v197, 7168, v197
v_cndmask_b32 v199, v199, v200, vcc
v_xor_b32 v198, v198, v199
v_lshl_add_u32 v193, v198, 4, v197
v_add_u32 v196, 128, v1
v_mul_u32_u24 v197, 5462, v196
v_lshrrev_b32 v197, 16, v197
v_mul_u32_u24 v198, 12, v197
v_sub_u32 v198, v196, v198
v_bfe_u32 v199, v197, 2, 1
v_cmp_gt_u32 vcc, 8, v198
v_lshlrev_b32 v200, 1, v199
v_mul_u32_u24 v197, 7168, v197
v_cndmask_b32 v199, v199, v200, vcc
v_xor_b32 v198, v198, v199
v_lshl_add_u32 v194, v198, 4, v197
v_add_u32 v192, s43, v192
v_add_u32 v193, s43, v193
v_add_u32 v194, s43, v194
s_and_b32 s43, s36, 3
s_mul_i32 s50, s43, 6144
s_add_u32 s50, s50, 16384
s_cmp_eq_u32 s47, 3
s_cbranch_scc0 Lw_91
s_lshl_b32 s92, s34, 4
s_add_u32 s92, s92, s35
s_lshl_b32 s92, s92, 8
s_add_u32 s92, s92, 49152
s_add_u32 s92, s92, 28311552
s_mov_b32 s41, 0x40000
Lpoll_92:
s_load_dword s93, s[82:83], s92 glc
Lpchk_94:
s_waitcnt lgkmcnt(0)
s_cmp_eq_u32 s93, 16
s_cbranch_scc1 Lpok_93
s_sub_u32 s41, s41, 1
s_cmp_lg_u32 s41, 0
s_cbranch_scc1 Lpoll_92
Lpok_93:
Lw_91:
s_and_b32 s44, s36, 3
s_mul_i32 s44, s44, 14
s_bfe_u32 s43, s2, 0x30001
s_lshl_b32 s43, s43, 7
s_add_u32 s44, s44, s43
s_add_u32 s44, s44, 72
s_mul_i32 s44, s44, 7168
s_lshr_b32 s43, s2, 4
s_lshl_b32 s43, s43, 8
s_add_u32 s43, s43, s44
s_bitcmp0_b32 s2, 0
s_cselect_b32 s4, s72, s74
s_cselect_b32 s5, s73, s75
s_add_u32 s4, s4, s43
s_addc_u32 s5, s5, 0
s_cmp_eq_u32 s47, 3
s_cbranch_scc1 Lw_95
s_load_dword s3, s[4:5], 0
s_load_dword s3, s[4:5], 64
s_load_dword s3, s[4:5], 128
s_load_dword s3, s[4:5], 192
s_load_dword s3, s[4:5], 7168
s_load_dword s3, s[4:5], 7232
s_load_dword s3, s[4:5], 7296
s_load_dword s3, s[4:5], 7360
s_load_dword s3, s[4:5], 14336
s_load_dword s3, s[4:5], 14400
s_load_dword s3, s[4:5], 14464
s_load_dword s3, s[4:5], 14528
s_load_dword s3, s[4:5], 21504
s_load_dword s3, s[4:5], 21568
Lw_95:
s_waitcnt vmcnt(8)
s_barrier
s_add_u32 s37, s35, 1
s_and_b32 s37, s37, 15
s_lshl_b32 s37, s37, 14
s_add_u32 m0, s39, 49152
s_nop 0
buffer_load_dwordx4 v2, s[8:11], s37 offen offset:0 sc1 lds
buffer_load_dwordx4 v2, s[8:11], s37 offen offset:1024 sc1 lds
buffer_load_dwordx4 v2, s[8:11], s37 offen offset:2048 sc1 lds
buffer_load_dwordx4 v2, s[8:11], s37 offen offset:3072 sc1 lds
s_add_u32 s37, s35, 2
s_and_b32 s37, s37, 15
s_lshl_b32 s37, s37, 14
s_add_u32 m0, s39, 98304
s_nop 0
buffer_load_dwordx4 v2, s[8:11], s37 offen offset:0 sc1 lds
buffer_load_dwordx4 v2, s[8:11], s37 offen offset:1024 sc1 lds
buffer_load_dwordx4 v2, s[8:11], s37 offen offset:2048 sc1 lds
buffer_load_dwordx4 v2, s[8:11], s37 offen offset:3072 sc1 lds
s_add_u32 s37, s35, 3
s_and_b32 s37, s37, 15
s_lshl_b32 s37, s37, 14
s_add_u32 m0, s39, 147456
s_nop 0
buffer_load_dwordx4 v2, s[8:11], s37 offen offset:0 sc1 lds
buffer_load_dwordx4 v2, s[8:11], s37 offen offset:1024 sc1 lds
buffer_load_dwordx4 v2, s[8:11], s37 offen offset:2048 sc1 lds
buffer_load_dwordx4 v2, s[8:11], s37 offen offset:3072 sc1 lds
s_cmp_eq_u32 s47, 3
s_cbranch_scc0 Lw_96
s_load_dword s3, s[4:5], 0
s_load_dword s3, s[4:5], 64
s_load_dword s3, s[4:5], 128
s_load_dword s3, s[4:5], 192
s_load_dword s3, s[4:5], 7168
s_load_dword s3, s[4:5], 7232
s_load_dword s3, s[4:5], 7296
s_load_dword s3, s[4:5], 7360
s_load_dword s3, s[4:5], 14336
s_load_dword s3, s[4:5], 14400
s_load_dword s3, s[4:5], 14464
s_load_dword s3, s[4:5], 14528
s_load_dword s3, s[4:5], 21504
s_load_dword s3, s[4:5], 21568
Lw_96:
s_waitcnt vmcnt(8)
s_barrier
s_add_u32 s37, s35, 4
s_and_b32 s37, s37, 15
s_lshl_b32 s37, s37, 14
s_add_u32 m0, s39, 0
s_nop 0
buffer_load_dwordx4 v2, s[8:11], s37 offen offset:0 sc1 lds
buffer_load_dwordx4 v2, s[8:11], s37 offen offset:1024 sc1 lds
buffer_load_dwordx4 v2, s[8:11], s37 offen offset:2048 sc1 lds
buffer_load_dwordx4 v2, s[8:11], s37 offen offset:3072 sc1 lds
s_add_u32 s38, s35, 8
s_and_b32 s38, s38, 15
s_lshl_b32 s38, s38, 17
s_add_u32 m0, s40, 16384
s_nop 0
buffer_load_dwordx4 v3, s[12:15], s38 offen lds
s_add_u32 m0, s40, 17408
s_add_u32 s38, s38, 16384
buffer_load_dwordx4 v3, s[12:15], s38 offen lds
v_lshlrev_b32 v240, 16, v128
v_and_b32 v241, 0xffff0000, v128
v_lshlrev_b32 v242, 16, v129
v_and_b32 v243, 0xffff0000, v129
v_lshlrev_b32 v244, 16, v130
v_and_b32 v245, 0xffff0000, v130
v_lshlrev_b32 v246, 16, v131
v_and_b32 v247, 0xffff0000, v131
s_load_dword s3, s[4:5], 21632
s_load_dword s3, s[4:5], 21696
s_load_dword s3, s[4:5], 28672
s_waitcnt vmcnt(10)
s_barrier
s_add_u32 s37, s35, 5
s_and_b32 s37, s37, 15
s_lshl_b32 s37, s37, 14
s_add_u32 m0, s39, 49152
s_nop 0
buffer_load_dwordx4 v2, s[8:11], s37 offen offset:0 sc1 lds
buffer_load_dwordx4 v2, s[8:11], s37 offen offset:1024 sc1 lds
buffer_load_dwordx4 v2, s[8:11], s37 offen offset:2048 sc1 lds
buffer_load_dwordx4 v2, s[8:11], s37 offen offset:3072 sc1 lds
s_add_u32 s38, s35, 9
s_and_b32 s38, s38, 15
s_lshl_b32 s38, s38, 17
s_add_u32 m0, s40, 24576
s_nop 0
buffer_load_dwordx4 v3, s[12:15], s38 offen lds
s_add_u32 m0, s40, 25600
s_add_u32 s38, s38, 16384
buffer_load_dwordx4 v3, s[12:15], s38 offen lds
v_lshlrev_b32 v24, 16, v132
v_and_b32 v25, 0xffff0000, v132
v_lshlrev_b32 v26, 16, v133
v_and_b32 v27, 0xffff0000, v133
v_lshlrev_b32 v28, 16, v134
v_and_b32 v29, 0xffff0000, v134
v_lshlrev_b32 v30, 16, v135
v_and_b32 v31, 0xffff0000, v135
v_add_f32 v240, v240, v24
v_add_f32 v241, v241, v25
v_add_f32 v242, v242, v26
v_add_f32 v243, v243, v27
v_add_f32 v244, v244, v28
v_add_f32 v245, v245, v29
v_add_f32 v246, v246, v30
v_add_f32 v247, v247, v31
s_load_dword s3, s[4:5], 28736
s_load_dword s3, s[4:5], 28800
s_load_dword s3, s[4:5], 28864
s_waitcnt vmcnt(12)
s_barrier
s_add_u32 s37, s35, 6
s_and_b32 s37, s37, 15
s_lshl_b32 s37, s37, 14
s_add_u32 m0, s39, 98304
s_nop 0
buffer_load_dwordx4 v2, s[8:11], s37 offen offset:0 sc1 lds
buffer_load_dwordx4 v2, s[8:11], s37 offen offset:1024 sc1 lds
buffer_load_dwordx4 v2, s[8:11], s37 offen offset:2048 sc1 lds
buffer_load_dwordx4 v2, s[8:11], s37 offen offset:3072 sc1 lds
s_add_u32 s38, s35, 10
s_and_b32 s38, s38, 15
s_lshl_b32 s38, s38, 17
s_add_u32 m0, s40, 32768
s_nop 0
buffer_load_dwordx4 v3, s[12:15], s38 offen lds
s_add_u32 m0, s40, 33792
s_add_u32 s38, s38, 16384
buffer_load_dwordx4 v3, s[12:15], s38 offen lds
v_lshlrev_b32 v24, 16, v136
v_and_b32 v25, 0xffff0000, v136
v_lshlrev_b32 v26, 16, v137
v_and_b32 v27, 0xffff0000, v137
v_lshlrev_b32 v28, 16, v138
v_and_b32 v29, 0xffff0000, v138
v_lshlrev_b32 v30, 16, v139
v_and_b32 v31, 0xffff0000, v139
v_add_f32 v240, v240, v24
v_add_f32 v241, v241, v25
v_add_f32 v242, v242, v26
v_add_f32 v243, v243, v27
v_add_f32 v244, v244, v28
v_add_f32 v245, v245, v29
v_add_f32 v246, v246, v30
v_add_f32 v247, v247, v31
s_load_dword s3, s[4:5], 35840
s_load_dword s3, s[4:5], 35904
s_load_dword s3, s[4:5], 35968
s_waitcnt vmcnt(14)
s_barrier
s_add_u32 s37, s35, 7
s_and_b32 s37, s37, 15
s_lshl_b32 s37, s37, 14
s_add_u32 m0, s39, 147456
s_nop 0
buffer_load_dwordx4 v2, s[8:11], s37 offen offset:0 sc1 lds
buffer_load_dwordx4 v2, s[8:11], s37 offen offset:1024 sc1 lds
buffer_load_dwordx4 v2, s[8:11], s37 offen offset:2048 sc1 lds
buffer_load_dwordx4 v2, s[8:11], s37 offen offset:3072 sc1 lds
s_add_u32 s38, s35, 11
s_and_b32 s38, s38, 15
s_lshl_b32 s38, s38, 17
s_add_u32 m0, s40, 40960
s_nop 0
buffer_load_dwordx4 v3, s[12:15], s38 offen lds
s_add_u32 m0, s40, 41984
s_add_u32 s38, s38, 16384
buffer_load_dwordx4 v3, s[12:15], s38 offen lds
v_lshlrev_b32 v24, 16, v140
v_and_b32 v25, 0xffff0000, v140
v_lshlrev_b32 v26, 16, v141
v_and_b32 v27, 0xffff0000, v141
v_lshlrev_b32 v28, 16, v142
v_and_b32 v29, 0xffff0000, v142
v_lshlrev_b32 v30, 16, v143
v_and_b32 v31, 0xffff0000, v143
v_add_f32 v240, v240, v24
v_add_f32 v241, v241, v25
v_add_f32 v242, v242, v26
v_add_f32 v243, v243, v27
v_add_f32 v244, v244, v28
v_add_f32 v245, v245, v29
v_add_f32 v246, v246, v30
v_add_f32 v247, v247, v31
s_load_dword s3, s[4:5], 36032
s_load_dword s3, s[4:5], 43008
s_load_dword s3, s[4:5], 43072
s_waitcnt vmcnt(14)
s_barrier
s_add_u32 s37, s35, 8
s_and_b32 s37, s37, 15
s_lshl_b32 s37, s37, 14
s_add_u32 m0, s39, 0
s_nop 0
buffer_load_dwordx4 v2, s[8:11], s37 offen offset:0 sc1 lds
buffer_load_dwordx4 v2, s[8:11], s37 offen offset:1024 sc1 lds
buffer_load_dwordx4 v2, s[8:11], s37 offen offset:2048 sc1 lds
buffer_load_dwordx4 v2, s[8:11], s37 offen offset:3072 sc1 lds
s_add_u32 s38, s35, 12
s_and_b32 s38, s38, 15
s_lshl_b32 s38, s38, 17
s_add_u32 m0, s40, 114688
s_nop 0
buffer_load_dwordx4 v3, s[12:15], s38 offen lds
s_add_u32 m0, s40, 115712
s_add_u32 s38, s38, 16384
buffer_load_dwordx4 v3, s[12:15], s38 offen lds
v_lshlrev_b32 v24, 16, v144
v_and_b32 v25, 0xffff0000, v144
v_lshlrev_b32 v26, 16, v145
v_and_b32 v27, 0xffff0000, v145
v_lshlrev_b32 v28, 16, v146
v_and_b32 v29, 0xffff0000, v146
v_lshlrev_b32 v30, 16, v147
v_and_b32 v31, 0xffff0000, v147
v_add_f32 v240, v240, v24
v_add_f32 v241, v241, v25
v_add_f32 v242, v242, v26
v_add_f32 v243, v243, v27
v_add_f32 v244, v244, v28
v_add_f32 v245, v245, v29
v_add_f32 v246, v246, v30
v_add_f32 v247, v247, v31
s_load_dword s3, s[4:5], 43136
s_load_dword s3, s[4:5], 43200
s_load_dword s3, s[4:5], 50176
s_waitcnt vmcnt(14)
s_barrier
s_add_u32 s37, s35, 9
s_and_b32 s37, s37, 15
s_lshl_b32 s37, s37, 14
s_add_u32 m0, s39, 49152
s_nop 0
buffer_load_dwordx4 v2, s[8:11], s37 offen offset:0 sc1 lds
buffer_load_dwordx4 v2, s[8:11], s37 offen offset:1024 sc1 lds
buffer_load_dwordx4 v2, s[8:11], s37 offen offset:2048 sc1 lds
buffer_load_dwordx4 v2, s[8:11], s37 offen offset:3072 sc1 lds
s_add_u32 s38, s35, 13
s_and_b32 s38, s38, 15
s_lshl_b32 s38, s38, 17
s_add_u32 m0, s40, 122880
s_nop 0
buffer_load_dwordx4 v3, s[12:15], s38 offen lds
s_add_u32 m0, s40, 123904
s_add_u32 s38, s38, 16384
buffer_load_dwordx4 v3, s[12:15], s38 offen lds
v_lshlrev_b32 v24, 16, v148
v_and_b32 v25, 0xffff0000, v148
v_lshlrev_b32 v26, 16, v149
v_and_b32 v27, 0xffff0000, v149
v_lshlrev_b32 v28, 16, v150
v_and_b32 v29, 0xffff0000, v150
v_lshlrev_b32 v30, 16, v151
v_and_b32 v31, 0xffff0000, v151
v_add_f32 v240, v240, v24
v_add_f32 v241, v241, v25
v_add_f32 v242, v242, v26
v_add_f32 v243, v243, v27
v_add_f32 v244, v244, v28
v_add_f32 v245, v245, v29
v_add_f32 v246, v246, v30
v_add_f32 v247, v247, v31
s_load_dword s3, s[4:5], 50240
s_load_dword s3, s[4:5], 50304
s_load_dword s3, s[4:5], 50368
s_waitcnt vmcnt(14)
s_barrier
s_add_u32 s37, s35, 10
s_and_b32 s37, s37, 15
s_lshl_b32 s37, s37, 14
s_add_u32 m0, s39, 98304
s_nop 0
buffer_load_dwordx4 v2, s[8:11], s37 offen offset:0 sc1 lds
buffer_load_dwordx4 v2, s[8:11], s37 offen offset:1024 sc1 lds
buffer_load_dwordx4 v2, s[8:11], s37 offen offset:2048 sc1 lds
buffer_load_dwordx4 v2, s[8:11], s37 offen offset:3072 sc1 lds
s_add_u32 s38, s35, 14
s_and_b32 s38, s38, 15
s_lshl_b32 s38, s38, 17
s_add_u32 m0, s40, 131072
s_nop 0
buffer_load_dwordx4 v3, s[12:15], s38 offen lds
s_add_u32 m0, s40, 132096
s_add_u32 s38, s38, 16384
buffer_load_dwordx4 v3, s[12:15], s38 offen lds
v_lshlrev_b32 v24, 16, v152
v_and_b32 v25, 0xffff0000, v152
v_lshlrev_b32 v26, 16, v153
v_and_b32 v27, 0xffff0000, v153
v_lshlrev_b32 v28, 16, v154
v_and_b32 v29, 0xffff0000, v154
v_lshlrev_b32 v30, 16, v155
v_and_b32 v31, 0xffff0000, v155
v_add_f32 v240, v240, v24
v_add_f32 v241, v241, v25
v_add_f32 v242, v242, v26
v_add_f32 v243, v243, v27
v_add_f32 v244, v244, v28
v_add_f32 v245, v245, v29
v_add_f32 v246, v246, v30
v_add_f32 v247, v247, v31
s_load_dword s3, s[4:5], 57344
s_load_dword s3, s[4:5], 57408
s_load_dword s3, s[4:5], 57472
s_waitcnt vmcnt(14)
s_barrier
s_add_u32 s37, s35, 11
s_and_b32 s37, s37, 15
s_lshl_b32 s37, s37, 14
s_add_u32 m0, s39, 147456
s_nop 0
buffer_load_dwordx4 v2, s[8:11], s37 offen offset:0 sc1 lds
buffer_load_dwordx4 v2, s[8:11], s37 offen offset:1024 sc1 lds
buffer_load_dwordx4 v2, s[8:11], s37 offen offset:2048 sc1 lds
buffer_load_dwordx4 v2, s[8:11], s37 offen offset:3072 sc1 lds
s_add_u32 s38, s35, 15
s_and_b32 s38, s38, 15
s_lshl_b32 s38, s38, 17
s_add_u32 m0, s40, 139264
s_nop 0
buffer_load_dwordx4 v3, s[12:15], s38 offen lds
s_add_u32 m0, s40, 140288
s_add_u32 s38, s38, 16384
buffer_load_dwordx4 v3, s[12:15], s38 offen lds
v_lshlrev_b32 v24, 16, v156
v_and_b32 v25, 0xffff0000, v156
v_lshlrev_b32 v26, 16, v157
v_and_b32 v27, 0xffff0000, v157
v_lshlrev_b32 v28, 16, v158
v_and_b32 v29, 0xffff0000, v158
v_lshlrev_b32 v30, 16, v159
v_and_b32 v31, 0xffff0000, v159
v_add_f32 v240, v240, v24
v_add_f32 v241, v241, v25
v_add_f32 v242, v242, v26
v_add_f32 v243, v243, v27
v_add_f32 v244, v244, v28
v_add_f32 v245, v245, v29
v_add_f32 v246, v246, v30
v_add_f32 v247, v247, v31
s_load_dword s3, s[4:5], 57536
s_load_dword s3, s[4:5], 64512
s_load_dword s3, s[4:5], 64576
s_waitcnt vmcnt(14)
s_barrier
s_add_u32 s37, s35, 12
s_and_b32 s37, s37, 15
s_lshl_b32 s37, s37, 14
s_add_u32 m0, s39, 0
s_nop 0
buffer_load_dwordx4 v2, s[8:11], s37 offen offset:0 sc1 lds
buffer_load_dwordx4 v2, s[8:11], s37 offen offset:1024 sc1 lds
buffer_load_dwordx4 v2, s[8:11], s37 offen offset:2048 sc1 lds
buffer_load_dwordx4 v2, s[8:11], s37 offen offset:3072 sc1 lds
s_load_dword s3, s[4:5], 64640
s_branch Lov_7
.p2align 12
.fill 48, 4, 0xbf800000
Lst_7_0:
s_branch Lwr_152
s_nop 0
s_nop 0
Lov_7:
s_load_dword s3, s[4:5], 64704
s_load_dword s3, s[4:5], 71680
s_waitcnt vmcnt(12)
s_barrier
s_add_u32 s37, s35, 13
s_and_b32 s37, s37, 15
s_lshl_b32 s37, s37, 14
s_add_u32 m0, s39, 49152
s_nop 0
buffer_load_dwordx4 v2, s[8:11], s37 offen offset:0 sc1 lds
buffer_load_dwordx4 v2, s[8:11], s37 offen offset:1024 sc1 lds
buffer_load_dwordx4 v2, s[8:11], s37 offen offset:2048 sc1 lds
buffer_load_dwordx4 v2, s[8:11], s37 offen offset:3072 sc1 lds
s_load_dword s3, s[4:5], 71744
s_load_dword s3, s[4:5], 71808
s_load_dword s3, s[4:5], 71872
s_waitcnt vmcnt(10)
s_barrier
s_add_u32 s37, s35, 14
s_and_b32 s37, s37, 15
s_lshl_b32 s37, s37, 14
s_add_u32 m0, s39, 98304
s_nop 0
buffer_load_dwordx4 v2, s[8:11], s37 offen offset:0 sc1 lds
buffer_load_dwordx4 v2, s[8:11], s37 offen offset:1024 sc1 lds
buffer_load_dwordx4 v2, s[8:11], s37 offen offset:2048 sc1 lds
buffer_load_dwordx4 v2, s[8:11], s37 offen offset:3072 sc1 lds
s_waitcnt vmcnt(8)
s_barrier
s_add_u32 s37, s35, 15
s_and_b32 s37, s37, 15
s_lshl_b32 s37, s37, 14
s_add_u32 m0, s39, 147456
s_nop 0
buffer_load_dwordx4 v2, s[8:11], s37 offen offset:0 sc1 lds
buffer_load_dwordx4 v2, s[8:11], s37 offen offset:1024 sc1 lds
buffer_load_dwordx4 v2, s[8:11], s37 offen offset:2048 sc1 lds
buffer_load_dwordx4 v2, s[8:11], s37 offen offset:3072 sc1 lds
s_waitcnt vmcnt(8)
s_barrier
s_nop 0
v_permlane32_swap_b32 v240, v244
v_permlane32_swap_b32 v241, v245
v_permlane32_swap_b32 v242, v246
v_permlane32_swap_b32 v243, v247
v_add_f32 v240, v240, v244
v_add_f32 v241, v241, v245
v_add_f32 v242, v242, v246
v_add_f32 v243, v243, v247
s_nop 0
v_permlane16_swap_b32 v240, v242
v_permlane16_swap_b32 v241, v243
v_add_f32 v240, v240, v242
v_add_f32 v241, v241, v243
s_waitcnt vmcnt(4)
s_barrier
s_add_u32 s38, s35, 0
s_and_b32 s38, s38, 15
s_mul_i32 s38, s38, 458752
s_add_u32 m0, s50, 0
s_nop 0
buffer_load_dwordx4 v192, s[16:19], s38 offen lds
s_add_u32 m0, s50, 1024
s_nop 0
buffer_load_dwordx4 v193, s[16:19], s38 offen lds
s_add_u32 m0, s50, 2048
s_nop 0
buffer_load_dwordx4 v194, s[16:19], s38 offen lds
s_add_u32 m0, s50, 3072
s_add_u32 s38, s38, 114688
buffer_load_dwordx4 v192, s[16:19], s38 offen lds
s_add_u32 m0, s50, 4096
s_nop 0
buffer_load_dwordx4 v193, s[16:19], s38 offen lds
s_add_u32 m0, s50, 5120
s_nop 0
buffer_load_dwordx4 v194, s[16:19], s38 offen lds
s_add_u32 s38, s35, 1
s_and_b32 s38, s38, 15
s_mul_i32 s38, s38, 458752
s_add_u32 m0, s50, 49152
s_nop 0
buffer_load_dwordx4 v192, s[16:19], s38 offen lds
s_add_u32 m0, s50, 50176
s_nop 0
buffer_load_dwordx4 v193, s[16:19], s38 offen lds
s_add_u32 m0, s50, 51200
s_nop 0
buffer_load_dwordx4 v194, s[16:19], s38 offen lds
s_add_u32 m0, s50, 52224
s_add_u32 s38, s38, 114688
buffer_load_dwordx4 v192, s[16:19], s38 offen lds
s_add_u32 m0, s50, 53248
s_nop 0
buffer_load_dwordx4 v193, s[16:19], s38 offen lds
s_add_u32 m0, s50, 54272
s_nop 0
buffer_load_dwordx4 v194, s[16:19], s38 offen lds
s_waitcnt vmcnt(12)
s_barrier
s_barrier
s_branch Lk3a
Lk2end_83:
Lk3:
s_branch Lgb_97
Lk3a:
s_mul_i32 s43, s34, 262144
s_add_u32 s8, s82, s43
s_addc_u32 s9, s83, 0
s_add_u32 s8, s8, 4194304
s_addc_u32 s9, s9, 0
s_mov_b32 s10, 262144
s_mov_b32 s11, 0x20000
s_mul_i32 s43, s34, 917504
s_add_u32 s24, s82, s43
s_addc_u32 s25, s83, 0
s_add_u32 s24, s24, 8388608
s_addc_u32 s25, s25, 0
s_mov_b32 s26, 917504
s_mov_b32 s27, 0x20000
s_add_u32 s84, s82, 27262976
s_addc_u32 s85, s83, 0
s_mov_b32 s86, 229376
s_mov_b32 s87, 0x20000
s_and_b32 s47, s36, 3
s_lshr_b32 s62, s47, 1
s_and_b32 s63, s47, 1
v_lshlrev_b32 v2, 4, v1
s_lshl_b32 s39, s47, 12
v_add_u32 v3, s39, v2
s_bitcmp0_b32 s36, 1
s_cselect_b32 s44, s72, s74
s_cselect_b32 s45, s73, s75
s_mul_i32 s43, s35, 256
s_add_u32 s12, s44, s43
s_addc_u32 s13, s45, 0
s_mov_b32 s14, 7333120
s_mov_b32 s15, 0x20000
s_and_b32 s43, s36, 1
s_mul_i32 s43, s43, 229376
v_lshrrev_b32 v28, 4, v1
v_lshlrev_b32 v29, 1, v28
v_and_b32 v4, 15, v1
v_xor_b32 v4, v4, v29
v_lshlrev_b32 v4, 4, v4
v_mul_u32_u24 v28, 7168, v28
v_add_u32 v4, v4, v28
v_add_u32 v4, s43, v4
v_xor_b32 v5, 128, v4
v_add_u32 v5, 28672, v5
s_and_b32 s43, s36, 3
s_mul_i32 s40, s43, 8192
s_add_u32 s40, s40, 16384
v_mov_b32 v6, v192
v_mov_b32 v7, v193
v_mov_b32 v8, v194
s_lshl_b32 s43, s62, 12
v_add_u32 v9, s43, v2
v_add_u32 v10, 98304, v9
s_lshl_b32 s43, s47, 9
s_add_u32 s43, s43, 151552
v_and_b32 v28, 15, v1
v_lshl_add_u32 v28, v28, 5, s43
v_lshrrev_b32 v29, 4, v1
v_lshl_add_u32 v28, v29, 3, v28
ds_write_b64 v28, v[240:241]
s_waitcnt lgkmcnt(0)
v_lshrrev_b32 v27, 2, v1
v_bfe_u32 v28, v27, 2, 1
v_mul_u32_u24 v27, 192, v27
v_add_u32 v27, 16384, v27
v_and_b32 v29, 3, v1
v_lshl_add_u32 v12, v29, 3, v27
s_lshl_b32 s43, s63, 6
v_add_u32 v12, s43, v12
v_lshl_add_u32 v11, v28, 5, v12
v_xor_b32 v30, 1, v28
v_lshl_add_u32 v12, v30, 5, v12
v_xor_b32 v28, s63, v28
v_lshl_add_u32 v27, v28, 4, v27
v_lshrrev_b32 v28, 1, v29
v_lshl_add_u32 v27, v28, 5, v27
v_and_b32 v28, 1, v29
v_lshl_add_u32 v27, v28, 3, v27
v_add_u32 v13, 128, v27
v_add_u32 v14, 49152, v11
v_add_u32 v15, 49152, v12
v_add_u32 v16, 49152, v13
v_add_u32 v17, 98304, v11
v_add_u32 v18, 98304, v12
v_add_u32 v19, 98304, v13
s_cmp_lg_u32 s36, 4
s_cbranch_scc1 Lwm_99
s_branch Lst_8_1
Lwr_164:
s_branch Lwe_98
Lwm_99:
s_cmp_lg_u32 s36, 5
s_cbranch_scc1 Lwm_100
s_branch Lst_9_1
Lwr_165:
s_branch Lwe_98
Lwm_100:
s_cmp_lg_u32 s36, 6
s_cbranch_scc1 Lwm_101
s_branch Lst_10_1
Lwr_166:
s_branch Lwe_98
Lwm_101:
s_cmp_lg_u32 s36, 7
s_cbranch_scc1 Lwm_102
s_nop 0
s_branch Lwe_98
Lwm_102:
Lwe_98:
s_barrier
s_cmp_lg_u32 s36, 4
s_cbranch_scc1 Lwm_104
s_branch Lst_11_1
Lwr_168:
s_branch Lwe_103
Lwm_104:
s_cmp_lg_u32 s36, 5
s_cbranch_scc1 Lwm_105
s_branch Lst_12_1
Lwr_169:
s_branch Lwe_103
Lwm_105:
s_cmp_lg_u32 s36, 6
s_cbranch_scc1 Lwm_106
s_branch Lst_13_1
Lwr_170:
s_branch Lwe_103
Lwm_106:
s_cmp_lg_u32 s36, 7
s_cbranch_scc1 Lwm_107
s_branch Lst_14_1
Lwr_171:
s_branch Lwe_103
Lwm_107:
Lwe_103:
s_waitcnt vmcnt(0) lgkmcnt(0)
s_barrier
ds_read_b128 v[32:35], v9 offset:0
ds_read_b64_tr_b16 v[48:49], v11 offset:0
ds_read_b64_tr_b16 v[50:51], v11 offset:3072
ds_read_b64_tr_b16 v[52:53], v12 offset:0
ds_read_b64_tr_b16 v[54:55], v12 offset:3072
ds_read_b64_tr_b16 v[56:57], v13 offset:0
ds_read_b64_tr_b16 v[58:59], v13 offset:3072
ds_read_b64_tr_b16 v[60:61], v11 offset:12288
ds_read_b64_tr_b16 v[62:63], v11 offset:15360
ds_read_b64_tr_b16 v[64:65], v12 offset:12288
ds_read_b64_tr_b16 v[66:67], v12 offset:15360
ds_read_b64_tr_b16 v[68:69], v13 offset:12288
ds_read_b64_tr_b16 v[70:71], v13 offset:15360
ds_read_b128 v[36:39], v9 offset:1024
ds_read_b128 v[40:43], v9 offset:2048
ds_read_b128 v[44:47], v9 offset:3072
s_waitcnt lgkmcnt(0)
v_mfma_f32_16x16x32_bf16 v[128:131], v[48:51], v[32:35], 0
ds_read_b128 v[72:75], v9 offset:8192
v_mfma_f32_16x16x32_bf16 v[132:135], v[52:55], v[32:35], 0
ds_read_b64_tr_b16 v[88:89], v11 offset:6144
v_mfma_f32_16x16x32_bf16 v[136:139], v[56:59], v[32:35], 0
ds_read_b64_tr_b16 v[90:91], v11 offset:9216
v_mfma_f32_16x16x32_bf16 v[140:143], v[60:63], v[32:35], 0
ds_read_b64_tr_b16 v[92:93], v12 offset:6144
v_mfma_f32_16x16x32_bf16 v[144:147], v[64:67], v[32:35], 0
ds_read_b64_tr_b16 v[94:95], v12 offset:9216
v_mfma_f32_16x16x32_bf16 v[148:151], v[68:71], v[32:35], 0
ds_read_b64_tr_b16 v[96:97], v13 offset:6144
v_mfma_f32_16x16x32_bf16 v[172:175], v[68:71], v[36:39], 0
ds_read_b64_tr_b16 v[98:99], v13 offset:9216
v_mfma_f32_16x16x32_bf16 v[168:171], v[64:67], v[36:39], 0
ds_read_b64_tr_b16 v[100:101], v11 offset:18432
v_mfma_f32_16x16x32_bf16 v[164:167], v[60:63], v[36:39], 0
ds_read_b64_tr_b16 v[102:103], v11 offset:21504
v_mfma_f32_16x16x32_bf16 v[160:163], v[56:59], v[36:39], 0
ds_read_b64_tr_b16 v[104:105], v12 offset:18432
v_mfma_f32_16x16x32_bf16 v[156:159], v[52:55], v[36:39], 0
ds_read_b64_tr_b16 v[106:107], v12 offset:21504
v_mfma_f32_16x16x32_bf16 v[152:155], v[48:51], v[36:39], 0
ds_read_b64_tr_b16 v[108:109], v13 offset:18432
v_mfma_f32_16x16x32_bf16 v[176:179], v[48:51], v[40:43], 0
ds_read_b64_tr_b16 v[110:111], v13 offset:21504
v_mfma_f32_16x16x32_bf16 v[180:183], v[52:55], v[40:43], 0
ds_read_b128 v[76:79], v9 offset:9216
v_mfma_f32_16x16x32_bf16 v[184:187], v[56:59], v[40:43], 0
ds_read_b128 v[80:83], v9 offset:10240
v_mfma_f32_16x16x32_bf16 v[188:191], v[60:63], v[40:43], 0
ds_read_b128 v[84:87], v9 offset:11264
v_mfma_f32_16x16x32_bf16 v[192:195], v[64:67], v[40:43], 0
v_mfma_f32_16x16x32_bf16 v[196:199], v[68:71], v[40:43], 0
v_mfma_f32_16x16x32_bf16 v[220:223], v[68:71], v[44:47], 0
v_mfma_f32_16x16x32_bf16 v[216:219], v[64:67], v[44:47], 0
v_mfma_f32_16x16x32_bf16 v[212:215], v[60:63], v[44:47], 0
v_mfma_f32_16x16x32_bf16 v[208:211], v[56:59], v[44:47], 0
v_mfma_f32_16x16x32_bf16 v[204:207], v[52:55], v[44:47], 0
v_mfma_f32_16x16x32_bf16 v[200:203], v[48:51], v[44:47], 0
s_waitcnt lgkmcnt(0)
s_barrier
v_mfma_f32_16x16x32_bf16 v[128:131], v[88:91], v[72:75], v[128:131]
ds_read_b128 v[32:35], v9 offset:49152
v_mfma_f32_16x16x32_bf16 v[132:135], v[92:95], v[72:75], v[132:135]
ds_read_b64_tr_b16 v[48:49], v14 offset:0
v_mfma_f32_16x16x32_bf16 v[136:139], v[96:99], v[72:75], v[136:139]
ds_read_b64_tr_b16 v[50:51], v14 offset:3072
v_mfma_f32_16x16x32_bf16 v[140:143], v[100:103], v[72:75], v[140:143]
ds_read_b64_tr_b16 v[52:53], v15 offset:0
v_mfma_f32_16x16x32_bf16 v[144:147], v[104:107], v[72:75], v[144:147]
ds_read_b64_tr_b16 v[54:55], v15 offset:3072
v_mfma_f32_16x16x32_bf16 v[148:151], v[108:111], v[72:75], v[148:151]
ds_read_b64_tr_b16 v[56:57], v16 offset:0
v_mfma_f32_16x16x32_bf16 v[172:175], v[108:111], v[76:79], v[172:175]
ds_read_b64_tr_b16 v[58:59], v16 offset:3072
v_mfma_f32_16x16x32_bf16 v[168:171], v[104:107], v[76:79], v[168:171]
ds_read_b64_tr_b16 v[60:61], v14 offset:12288
v_mfma_f32_16x16x32_bf16 v[164:167], v[100:103], v[76:79], v[164:167]
ds_read_b64_tr_b16 v[62:63], v14 offset:15360
v_mfma_f32_16x16x32_bf16 v[160:163], v[96:99], v[76:79], v[160:163]
ds_read_b64_tr_b16 v[64:65], v15 offset:12288
v_mfma_f32_16x16x32_bf16 v[156:159], v[92:95], v[76:79], v[156:159]
ds_read_b64_tr_b16 v[66:67], v15 offset:15360
v_mfma_f32_16x16x32_bf16 v[152:155], v[88:91], v[76:79], v[152:155]
ds_read_b64_tr_b16 v[68:69], v16 offset:12288
v_mfma_f32_16x16x32_bf16 v[176:179], v[88:91], v[80:83], v[176:179]
ds_read_b64_tr_b16 v[70:71], v16 offset:15360
v_mfma_f32_16x16x32_bf16 v[180:183], v[92:95], v[80:83], v[180:183]
ds_read_b128 v[36:39], v9 offset:50176
v_mfma_f32_16x16x32_bf16 v[184:187], v[96:99], v[80:83], v[184:187]
ds_read_b128 v[40:43], v9 offset:51200
v_mfma_f32_16x16x32_bf16 v[188:191], v[100:103], v[80:83], v[188:191]
ds_read_b128 v[44:47], v9 offset:52224
v_mfma_f32_16x16x32_bf16 v[192:195], v[104:107], v[80:83], v[192:195]
v_mfma_f32_16x16x32_bf16 v[196:199], v[108:111], v[80:83], v[196:199]
v_mfma_f32_16x16x32_bf16 v[220:223], v[108:111], v[84:87], v[220:223]
v_mfma_f32_16x16x32_bf16 v[216:219], v[104:107], v[84:87], v[216:219]
v_mfma_f32_16x16x32_bf16 v[212:215], v[100:103], v[84:87], v[212:215]
v_mfma_f32_16x16x32_bf16 v[208:211], v[96:99], v[84:87], v[208:211]
v_mfma_f32_16x16x32_bf16 v[204:207], v[92:95], v[84:87], v[204:207]
v_mfma_f32_16x16x32_bf16 v[200:203], v[88:91], v[84:87], v[200:203]
s_mov_b32 s41, 5
Lk3l_108:
s_waitcnt lgkmcnt(0)
v_mfma_f32_16x16x32_bf16 v[128:131], v[48:51], v[32:35], v[128:131]
ds_read_b128 v[72:75], v9 offset:57344
v_mfma_f32_16x16x32_bf16 v[132:135], v[52:55], v[32:35], v[132:135]
ds_read_b64_tr_b16 v[88:89], v14 offset:6144
v_mfma_f32_16x16x32_bf16 v[136:139], v[56:59], v[32:35], v[136:139]
ds_read_b64_tr_b16 v[90:91], v14 offset:9216
v_mfma_f32_16x16x32_bf16 v[140:143], v[60:63], v[32:35], v[140:143]
ds_read_b64_tr_b16 v[92:93], v15 offset:6144
v_mfma_f32_16x16x32_bf16 v[144:147], v[64:67], v[32:35], v[144:147]
ds_read_b64_tr_b16 v[94:95], v15 offset:9216
v_mfma_f32_16x16x32_bf16 v[148:151], v[68:71], v[32:35], v[148:151]
ds_read_b64_tr_b16 v[96:97], v16 offset:6144
v_mfma_f32_16x16x32_bf16 v[172:175], v[68:71], v[36:39], v[172:175]
ds_read_b64_tr_b16 v[98:99], v16 offset:9216
v_mfma_f32_16x16x32_bf16 v[168:171], v[64:67], v[36:39], v[168:171]
ds_read_b64_tr_b16 v[100:101], v14 offset:18432
v_mfma_f32_16x16x32_bf16 v[164:167], v[60:63], v[36:39], v[164:167]
ds_read_b64_tr_b16 v[102:103], v14 offset:21504
v_mfma_f32_16x16x32_bf16 v[160:163], v[56:59], v[36:39], v[160:163]
ds_read_b64_tr_b16 v[104:105], v15 offset:18432
v_mfma_f32_16x16x32_bf16 v[156:159], v[52:55], v[36:39], v[156:159]
ds_read_b64_tr_b16 v[106:107], v15 offset:21504
v_mfma_f32_16x16x32_bf16 v[152:155], v[48:51], v[36:39], v[152:155]
ds_read_b64_tr_b16 v[108:109], v16 offset:18432
v_mfma_f32_16x16x32_bf16 v[176:179], v[48:51], v[40:43], v[176:179]
ds_read_b64_tr_b16 v[110:111], v16 offset:21504
v_mfma_f32_16x16x32_bf16 v[180:183], v[52:55], v[40:43], v[180:183]
ds_read_b128 v[76:79], v9 offset:58368
v_mfma_f32_16x16x32_bf16 v[184:187], v[56:59], v[40:43], v[184:187]
ds_read_b128 v[80:83], v9 offset:59392
v_mfma_f32_16x16x32_bf16 v[188:191], v[60:63], v[40:43], v[188:191]
ds_read_b128 v[84:87], v9 offset:60416
v_mfma_f32_16x16x32_bf16 v[192:195], v[64:67], v[40:43], v[192:195]
v_mfma_f32_16x16x32_bf16 v[196:199], v[68:71], v[40:43], v[196:199]
v_mfma_f32_16x16x32_bf16 v[220:223], v[68:71], v[44:47], v[220:223]
v_mfma_f32_16x16x32_bf16 v[216:219], v[64:67], v[44:47], v[216:219]
v_mfma_f32_16x16x32_bf16 v[212:215], v[60:63], v[44:47], v[212:215]
v_mfma_f32_16x16x32_bf16 v[208:211], v[56:59], v[44:47], v[208:211]
v_mfma_f32_16x16x32_bf16 v[204:207], v[52:55], v[44:47], v[204:207]
v_mfma_f32_16x16x32_bf16 v[200:203], v[48:51], v[44:47], v[200:203]
s_waitcnt lgkmcnt(0)
s_barrier
v_mfma_f32_16x16x32_bf16 v[128:131], v[88:91], v[72:75], v[128:131]
ds_read_b128 v[32:35], v10 offset:0
v_mfma_f32_16x16x32_bf16 v[132:135], v[92:95], v[72:75], v[132:135]
ds_read_b64_tr_b16 v[48:49], v17 offset:0
v_mfma_f32_16x16x32_bf16 v[136:139], v[96:99], v[72:75], v[136:139]
ds_read_b64_tr_b16 v[50:51], v17 offset:3072
v_mfma_f32_16x16x32_bf16 v[140:143], v[100:103], v[72:75], v[140:143]
ds_read_b64_tr_b16 v[52:53], v18 offset:0
v_mfma_f32_16x16x32_bf16 v[144:147], v[104:107], v[72:75], v[144:147]
ds_read_b64_tr_b16 v[54:55], v18 offset:3072
v_mfma_f32_16x16x32_bf16 v[148:151], v[108:111], v[72:75], v[148:151]
ds_read_b64_tr_b16 v[56:57], v19 offset:0
v_mfma_f32_16x16x32_bf16 v[172:175], v[108:111], v[76:79], v[172:175]
ds_read_b64_tr_b16 v[58:59], v19 offset:3072
v_mfma_f32_16x16x32_bf16 v[168:171], v[104:107], v[76:79], v[168:171]
ds_read_b64_tr_b16 v[60:61], v17 offset:12288
v_mfma_f32_16x16x32_bf16 v[164:167], v[100:103], v[76:79], v[164:167]
ds_read_b64_tr_b16 v[62:63], v17 offset:15360
v_mfma_f32_16x16x32_bf16 v[160:163], v[96:99], v[76:79], v[160:163]
ds_read_b64_tr_b16 v[64:65], v18 offset:12288
v_mfma_f32_16x16x32_bf16 v[156:159], v[92:95], v[76:79], v[156:159]
ds_read_b64_tr_b16 v[66:67], v18 offset:15360
v_mfma_f32_16x16x32_bf16 v[152:155], v[88:91], v[76:79], v[152:155]
ds_read_b64_tr_b16 v[68:69], v19 offset:12288
v_mfma_f32_16x16x32_bf16 v[176:179], v[88:91], v[80:83], v[176:179]
ds_read_b64_tr_b16 v[70:71], v19 offset:15360
v_mfma_f32_16x16x32_bf16 v[180:183], v[92:95], v[80:83], v[180:183]
ds_read_b128 v[36:39], v10 offset:1024
v_mfma_f32_16x16x32_bf16 v[184:187], v[96:99], v[80:83], v[184:187]
ds_read_b128 v[40:43], v10 offset:2048
v_mfma_f32_16x16x32_bf16 v[188:191], v[100:103], v[80:83], v[188:191]
ds_read_b128 v[44:47], v10 offset:3072
v_mfma_f32_16x16x32_bf16 v[192:195], v[104:107], v[80:83], v[192:195]
v_mfma_f32_16x16x32_bf16 v[196:199], v[108:111], v[80:83], v[196:199]
v_mfma_f32_16x16x32_bf16 v[220:223], v[108:111], v[84:87], v[220:223]
v_mfma_f32_16x16x32_bf16 v[216:219], v[104:107], v[84:87], v[216:219]
v_mfma_f32_16x16x32_bf16 v[212:215], v[100:103], v[84:87], v[212:215]
v_mfma_f32_16x16x32_bf16 v[208:211], v[96:99], v[84:87], v[208:211]
v_mfma_f32_16x16x32_bf16 v[204:207], v[92:95], v[84:87], v[204:207]
v_mfma_f32_16x16x32_bf16 v[200:203], v[88:91], v[84:87], v[200:203]
s_waitcnt lgkmcnt(0)
v_mfma_f32_16x16x32_bf16 v[128:131], v[48:51], v[32:35], v[128:131]
ds_read_b128 v[72:75], v10 offset:8192
v_mfma_f32_16x16x32_bf16 v[132:135], v[52:55], v[32:35], v[132:135]
ds_read_b64_tr_b16 v[88:89], v17 offset:6144
v_mfma_f32_16x16x32_bf16 v[136:139], v[56:59], v[32:35], v[136:139]
ds_read_b64_tr_b16 v[90:91], v17 offset:9216
v_mfma_f32_16x16x32_bf16 v[140:143], v[60:63], v[32:35], v[140:143]
ds_read_b64_tr_b16 v[92:93], v18 offset:6144
v_mfma_f32_16x16x32_bf16 v[144:147], v[64:67], v[32:35], v[144:147]
ds_read_b64_tr_b16 v[94:95], v18 offset:9216
v_mfma_f32_16x16x32_bf16 v[148:151], v[68:71], v[32:35], v[148:151]
ds_read_b64_tr_b16 v[96:97], v19 offset:6144
v_mfma_f32_16x16x32_bf16 v[172:175], v[68:71], v[36:39], v[172:175]
ds_read_b64_tr_b16 v[98:99], v19 offset:9216
v_mfma_f32_16x16x32_bf16 v[168:171], v[64:67], v[36:39], v[168:171]
ds_read_b64_tr_b16 v[100:101], v17 offset:18432
v_mfma_f32_16x16x32_bf16 v[164:167], v[60:63], v[36:39], v[164:167]
ds_read_b64_tr_b16 v[102:103], v17 offset:21504
v_mfma_f32_16x16x32_bf16 v[160:163], v[56:59], v[36:39], v[160:163]
ds_read_b64_tr_b16 v[104:105], v18 offset:18432
v_mfma_f32_16x16x32_bf16 v[156:159], v[52:55], v[36:39], v[156:159]
ds_read_b64_tr_b16 v[106:107], v18 offset:21504
v_mfma_f32_16x16x32_bf16 v[152:155], v[48:51], v[36:39], v[152:155]
ds_read_b64_tr_b16 v[108:109], v19 offset:18432
v_mfma_f32_16x16x32_bf16 v[176:179], v[48:51], v[40:43], v[176:179]
ds_read_b64_tr_b16 v[110:111], v19 offset:21504
v_mfma_f32_16x16x32_bf16 v[180:183], v[52:55], v[40:43], v[180:183]
ds_read_b128 v[76:79], v10 offset:9216
v_mfma_f32_16x16x32_bf16 v[184:187], v[56:59], v[40:43], v[184:187]
ds_read_b128 v[80:83], v10 offset:10240
v_mfma_f32_16x16x32_bf16 v[188:191], v[60:63], v[40:43], v[188:191]
ds_read_b128 v[84:87], v10 offset:11264
v_mfma_f32_16x16x32_bf16 v[192:195], v[64:67], v[40:43], v[192:195]
v_mfma_f32_16x16x32_bf16 v[196:199], v[68:71], v[40:43], v[196:199]
v_mfma_f32_16x16x32_bf16 v[220:223], v[68:71], v[44:47], v[220:223]
v_mfma_f32_16x16x32_bf16 v[216:219], v[64:67], v[44:47], v[216:219]
v_mfma_f32_16x16x32_bf16 v[212:215], v[60:63], v[44:47], v[212:215]
v_mfma_f32_16x16x32_bf16 v[208:211], v[56:59], v[44:47], v[208:211]
v_mfma_f32_16x16x32_bf16 v[204:207], v[52:55], v[44:47], v[204:207]
v_mfma_f32_16x16x32_bf16 v[200:203], v[48:51], v[44:47], v[200:203]
s_waitcnt lgkmcnt(0)
s_barrier
v_mfma_f32_16x16x32_bf16 v[128:131], v[88:91], v[72:75], v[128:131]
ds_read_b128 v[32:35], v9 offset:0
v_mfma_f32_16x16x32_bf16 v[132:135], v[92:95], v[72:75], v[132:135]
ds_read_b64_tr_b16 v[48:49], v11 offset:0
v_mfma_f32_16x16x32_bf16 v[136:139], v[96:99], v[72:75], v[136:139]
ds_read_b64_tr_b16 v[50:51], v11 offset:3072
v_mfma_f32_16x16x32_bf16 v[140:143], v[100:103], v[72:75], v[140:143]
ds_read_b64_tr_b16 v[52:53], v12 offset:0
v_mfma_f32_16x16x32_bf16 v[144:147], v[104:107], v[72:75], v[144:147]
ds_read_b64_tr_b16 v[54:55], v12 offset:3072
v_mfma_f32_16x16x32_bf16 v[148:151], v[108:111], v[72:75], v[148:151]
ds_read_b64_tr_b16 v[56:57], v13 offset:0
v_mfma_f32_16x16x32_bf16 v[172:175], v[108:111], v[76:79], v[172:175]
ds_read_b64_tr_b16 v[58:59], v13 offset:3072
v_mfma_f32_16x16x32_bf16 v[168:171], v[104:107], v[76:79], v[168:171]
ds_read_b64_tr_b16 v[60:61], v11 offset:12288
v_mfma_f32_16x16x32_bf16 v[164:167], v[100:103], v[76:79], v[164:167]
ds_read_b64_tr_b16 v[62:63], v11 offset:15360
v_mfma_f32_16x16x32_bf16 v[160:163], v[96:99], v[76:79], v[160:163]
ds_read_b64_tr_b16 v[64:65], v12 offset:12288
v_mfma_f32_16x16x32_bf16 v[156:159], v[92:95], v[76:79], v[156:159]
ds_read_b64_tr_b16 v[66:67], v12 offset:15360
v_mfma_f32_16x16x32_bf16 v[152:155], v[88:91], v[76:79], v[152:155]
ds_read_b64_tr_b16 v[68:69], v13 offset:12288
v_mfma_f32_16x16x32_bf16 v[176:179], v[88:91], v[80:83], v[176:179]
ds_read_b64_tr_b16 v[70:71], v13 offset:15360
v_mfma_f32_16x16x32_bf16 v[180:183], v[92:95], v[80:83], v[180:183]
ds_read_b128 v[36:39], v9 offset:1024
v_mfma_f32_16x16x32_bf16 v[184:187], v[96:99], v[80:83], v[184:187]
ds_read_b128 v[40:43], v9 offset:2048
v_mfma_f32_16x16x32_bf16 v[188:191], v[100:103], v[80:83], v[188:191]
ds_read_b128 v[44:47], v9 offset:3072
v_mfma_f32_16x16x32_bf16 v[192:195], v[104:107], v[80:83], v[192:195]
v_mfma_f32_16x16x32_bf16 v[196:199], v[108:111], v[80:83], v[196:199]
v_mfma_f32_16x16x32_bf16 v[220:223], v[108:111], v[84:87], v[220:223]
v_mfma_f32_16x16x32_bf16 v[216:219], v[104:107], v[84:87], v[216:219]
v_mfma_f32_16x16x32_bf16 v[212:215], v[100:103], v[84:87], v[212:215]
v_mfma_f32_16x16x32_bf16 v[208:211], v[96:99], v[84:87], v[208:211]
v_mfma_f32_16x16x32_bf16 v[204:207], v[92:95], v[84:87], v[204:207]
v_mfma_f32_16x16x32_bf16 v[200:203], v[88:91], v[84:87], v[200:203]
s_waitcnt lgkmcnt(0)
v_mfma_f32_16x16x32_bf16 v[128:131], v[48:51], v[32:35], v[128:131]
ds_read_b128 v[72:75], v9 offset:8192
v_mfma_f32_16x16x32_bf16 v[132:135], v[52:55], v[32:35], v[132:135]
ds_read_b64_tr_b16 v[88:89], v11 offset:6144
v_mfma_f32_16x16x32_bf16 v[136:139], v[56:59], v[32:35], v[136:139]
ds_read_b64_tr_b16 v[90:91], v11 offset:9216
v_mfma_f32_16x16x32_bf16 v[140:143], v[60:63], v[32:35], v[140:143]
ds_read_b64_tr_b16 v[92:93], v12 offset:6144
v_mfma_f32_16x16x32_bf16 v[144:147], v[64:67], v[32:35], v[144:147]
ds_read_b64_tr_b16 v[94:95], v12 offset:9216
v_mfma_f32_16x16x32_bf16 v[148:151], v[68:71], v[32:35], v[148:151]
ds_read_b64_tr_b16 v[96:97], v13 offset:6144
v_mfma_f32_16x16x32_bf16 v[172:175], v[68:71], v[36:39], v[172:175]
ds_read_b64_tr_b16 v[98:99], v13 offset:9216
v_mfma_f32_16x16x32_bf16 v[168:171], v[64:67], v[36:39], v[168:171]
ds_read_b64_tr_b16 v[100:101], v11 offset:18432
v_mfma_f32_16x16x32_bf16 v[164:167], v[60:63], v[36:39], v[164:167]
ds_read_b64_tr_b16 v[102:103], v11 offset:21504
v_mfma_f32_16x16x32_bf16 v[160:163], v[56:59], v[36:39], v[160:163]
ds_read_b64_tr_b16 v[104:105], v12 offset:18432
v_mfma_f32_16x16x32_bf16 v[156:159], v[52:55], v[36:39], v[156:159]
ds_read_b64_tr_b16 v[106:107], v12 offset:21504
v_mfma_f32_16x16x32_bf16 v[152:155], v[48:51], v[36:39], v[152:155]
ds_read_b64_tr_b16 v[108:109], v13 offset:18432
v_mfma_f32_16x16x32_bf16 v[176:179], v[48:51], v[40:43], v[176:179]
ds_read_b64_tr_b16 v[110:111], v13 offset:21504
v_mfma_f32_16x16x32_bf16 v[180:183], v[52:55], v[40:43], v[180:183]
ds_read_b128 v[76:79], v9 offset:9216
v_mfma_f32_16x16x32_bf16 v[184:187], v[56:59], v[40:43], v[184:187]
ds_read_b128 v[80:83], v9 offset:10240
v_mfma_f32_16x16x32_bf16 v[188:191], v[60:63], v[40:43], v[188:191]
ds_read_b128 v[84:87], v9 offset:11264
v_mfma_f32_16x16x32_bf16 v[192:195], v[64:67], v[40:43], v[192:195]
v_mfma_f32_16x16x32_bf16 v[196:199], v[68:71], v[40:43], v[196:199]
v_mfma_f32_16x16x32_bf16 v[220:223], v[68:71], v[44:47], v[220:223]
v_mfma_f32_16x16x32_bf16 v[216:219], v[64:67], v[44:47], v[216:219]
v_mfma_f32_16x16x32_bf16 v[212:215], v[60:63], v[44:47], v[212:215]
v_mfma_f32_16x16x32_bf16 v[208:211], v[56:59], v[44:47], v[208:211]
v_mfma_f32_16x16x32_bf16 v[204:207], v[52:55], v[44:47], v[204:207]
v_mfma_f32_16x16x32_bf16 v[200:203], v[48:51], v[44:47], v[200:203]
s_waitcnt lgkmcnt(0)
s_barrier
v_mfma_f32_16x16x32_bf16 v[128:131], v[88:91], v[72:75], v[128:131]
ds_read_b128 v[32:35], v9 offset:49152
v_mfma_f32_16x16x32_bf16 v[132:135], v[92:95], v[72:75], v[132:135]
ds_read_b64_tr_b16 v[48:49], v14 offset:0
v_mfma_f32_16x16x32_bf16 v[136:139], v[96:99], v[72:75], v[136:139]
ds_read_b64_tr_b16 v[50:51], v14 offset:3072
v_mfma_f32_16x16x32_bf16 v[140:143], v[100:103], v[72:75], v[140:143]
ds_read_b64_tr_b16 v[52:53], v15 offset:0
v_mfma_f32_16x16x32_bf16 v[144:147], v[104:107], v[72:75], v[144:147]
ds_read_b64_tr_b16 v[54:55], v15 offset:3072
v_mfma_f32_16x16x32_bf16 v[148:151], v[108:111], v[72:75], v[148:151]
ds_read_b64_tr_b16 v[56:57], v16 offset:0
v_mfma_f32_16x16x32_bf16 v[172:175], v[108:111], v[76:79], v[172:175]
ds_read_b64_tr_b16 v[58:59], v16 offset:3072
v_mfma_f32_16x16x32_bf16 v[168:171], v[104:107], v[76:79], v[168:171]
ds_read_b64_tr_b16 v[60:61], v14 offset:12288
v_mfma_f32_16x16x32_bf16 v[164:167], v[100:103], v[76:79], v[164:167]
ds_read_b64_tr_b16 v[62:63], v14 offset:15360
v_mfma_f32_16x16x32_bf16 v[160:163], v[96:99], v[76:79], v[160:163]
ds_read_b64_tr_b16 v[64:65], v15 offset:12288
v_mfma_f32_16x16x32_bf16 v[156:159], v[92:95], v[76:79], v[156:159]
ds_read_b64_tr_b16 v[66:67], v15 offset:15360
v_mfma_f32_16x16x32_bf16 v[152:155], v[88:91], v[76:79], v[152:155]
ds_read_b64_tr_b16 v[68:69], v16 offset:12288
v_mfma_f32_16x16x32_bf16 v[176:179], v[88:91], v[80:83], v[176:179]
ds_read_b64_tr_b16 v[70:71], v16 offset:15360
v_mfma_f32_16x16x32_bf16 v[180:183], v[92:95], v[80:83], v[180:183]
ds_read_b128 v[36:39], v9 offset:50176
s_branch Lov_8
.p2align 12
.fill 64, 4, 0xbf800000
Lst_8_0:
s_branch Lwr_153
Lst_8_1:
s_branch Lwr_164
s_nop 0
Lov_8:
v_mfma_f32_16x16x32_bf16 v[184:187], v[96:99], v[80:83], v[184:187]
ds_read_b128 v[40:43], v9 offset:51200
v_mfma_f32_16x16x32_bf16 v[188:191], v[100:103], v[80:83], v[188:191]
ds_read_b128 v[44:47], v9 offset:52224
v_mfma_f32_16x16x32_bf16 v[192:195], v[104:107], v[80:83], v[192:195]
v_mfma_f32_16x16x32_bf16 v[196:199], v[108:111], v[80:83], v[196:199]
v_mfma_f32_16x16x32_bf16 v[220:223], v[108:111], v[84:87], v[220:223]
v_mfma_f32_16x16x32_bf16 v[216:219], v[104:107], v[84:87], v[216:219]
v_mfma_f32_16x16x32_bf16 v[212:215], v[100:103], v[84:87], v[212:215]
v_mfma_f32_16x16x32_bf16 v[208:211], v[96:99], v[84:87], v[208:211]
v_mfma_f32_16x16x32_bf16 v[204:207], v[92:95], v[84:87], v[204:207]
v_mfma_f32_16x16x32_bf16 v[200:203], v[88:91], v[84:87], v[200:203]
s_sub_u32 s41, s41, 1
s_cmp_lg_u32 s41, 0
s_cbranch_scc1 Lk3l_108
s_waitcnt lgkmcnt(0)
s_add_u32 s37, s35, 2
s_and_b32 s37, s37, 15
s_mul_i32 s37, s37, 16384
s_add_u32 m0, s39, 0
s_nop 0
buffer_load_dwordx4 v3, s[8:11], s37 offen sc1 lds
v_lshrrev_b32 v86, 4, v1
s_lshl_b32 s43, s63, 7
s_add_u32 s43, s43, 148992
buffer_load_dwordx4 v3, s[8:11], s37 offen offset:1024 sc1 lds
v_lshl_add_u32 v87, v86, 4, s43
v_lshrrev_b32 v88, 1, v86
v_and_b32 v86, 1, v86
s_lshl_b32 s43, s63, 5
buffer_load_dwordx4 v3, s[8:11], s37 offen offset:2048 sc1 lds
s_add_u32 s43, s43, 149248
v_lshl_add_u32 v88, v88, 6, s43
v_lshl_add_u32 v88, v86, 4, v88
v_and_b32 v86, 15, v1
buffer_load_dwordx4 v3, s[8:11], s37 offen offset:3072 sc1 lds
s_lshl_b32 s43, s62, 9
s_add_u32 s43, s43, 147456
v_lshl_add_u32 v86, v86, 3, s43
s_add_u32 s38, s35, 2
s_and_b32 s38, s38, 15
s_mul_i32 s38, s38, 458752
s_add_u32 m0, s40, 0
s_nop 0
buffer_load_dwordx4 v4, s[12:15], s38 offen lds
ds_read_b128 v[32:35], v87 offset:0
ds_read_b128 v[36:39], v87 offset:64
ds_read_b128 v[40:43], v88 offset:0
ds_read_b128 v[44:47], v87 offset:896
s_add_u32 m0, s40, 1024
s_nop 0
buffer_load_dwordx4 v5, s[12:15], s38 offen lds
ds_read_b128 v[48:51], v87 offset:960
ds_read_b128 v[52:55], v88 offset:896
ds_read_b64 v[56:57], v86 offset:0
ds_read_b64 v[58:59], v86 offset:128
s_add_u32 m0, s40, 2048
s_add_u32 s38, s38, 57344
buffer_load_dwordx4 v4, s[12:15], s38 offen lds
ds_read_b64 v[60:61], v86 offset:256
ds_read_b64 v[62:63], v86 offset:384
s_mul_i32 s54, s35, 24576
s_add_u32 m0, s40, 3072
s_nop 0
buffer_load_dwordx4 v5, s[12:15], s38 offen lds
s_lshl_b32 s43, s62, 12
s_add_u32 s54, s54, s43
s_add_u32 s54, s54, 524288
s_lshl_b32 s43, s63, 9
s_add_u32 m0, s40, 4096
s_add_u32 s38, s38, 57344
buffer_load_dwordx4 v4, s[12:15], s38 offen lds
s_add_u32 s55, s54, s43
s_add_u32 s55, s55, 16384
s_lshl_b32 s43, s63, 13
s_add_u32 s54, s54, s43
s_add_u32 m0, s40, 5120
s_nop 0
buffer_load_dwordx4 v5, s[12:15], s38 offen lds
v_and_b32 v84, 32, v1
v_lshlrev_b32 v84, 4, v84
v_add_u32 v84, v84, v2
s_waitcnt lgkmcnt(0)
s_add_u32 m0, s40, 6144
s_add_u32 s38, s38, 57344
buffer_load_dwordx4 v4, s[12:15], s38 offen lds
s_add_u32 m0, s40, 7168
s_nop 0
buffer_load_dwordx4 v5, s[12:15], s38 offen lds
s_and_b32 s44, s36, 3
s_mul_i32 s43, s2, 28672
s_mul_i32 s44, s44, 7168
s_add_u32 s43, s43, s44
s_add_u32 s4, s76, s43
s_addc_u32 s5, s77, 0
s_barrier
s_cmp_eq_u32 s47, 3
s_cbranch_scc0 Lw_109
v_and_b32 v90, 31, v1
v_lshlrev_b32 v90, 4, v90
v_add_u32 v91, 153600, v90
ds_read_b128 v[108:111], v91 offset:0
ds_read_b128 v[112:115], v91 offset:512
ds_read_b128 v[116:119], v91 offset:1024
ds_read_b128 v[120:123], v91 offset:1536
s_and_b32 s44, s2, 15
s_mul_i32 s44, s44, 14336
s_lshr_b32 s43, s2, 4
s_lshl_b32 s43, s43, 9
s_add_u32 s44, s44, s43
s_waitcnt lgkmcnt(0)
v_add_f32 v108, v108, v112
v_add_f32 v116, v116, v120
v_add_f32 v109, v109, v113
v_add_f32 v117, v117, v121
v_add_f32 v110, v110, v114
v_add_f32 v118, v118, v122
v_add_f32 v111, v111, v115
v_add_f32 v119, v119, v123
v_add_f32 v108, v108, v116
v_add_f32 v109, v109, v117
v_add_f32 v110, v110, v118
v_add_f32 v111, v111, v119
s_mov_b64 exec, 0xffffffff
buffer_store_dwordx4 v[108:111], v90, s[84:87], s44 offen sc1
s_mov_b64 exec, -1
Lw_109:
s_waitcnt lgkmcnt(0)
s_add_u32 s37, s35, 3
s_and_b32 s37, s37, 15
s_mul_i32 s37, s37, 16384
s_add_u32 m0, s39, 49152
s_nop 0
buffer_load_dwordx4 v3, s[8:11], s37 offen sc1 lds
s_load_dword s3, s[4:5], 1792
s_load_dword s3, s[4:5], 1856
s_load_dword s3, s[4:5], 1920
s_load_dword s3, s[4:5], 1984
s_load_dword s3, s[4:5], 2048
s_load_dword s3, s[4:5], 2112
s_load_dword s3, s[4:5], 2176
buffer_load_dwordx4 v3, s[8:11], s37 offen offset:1024 sc1 lds
s_load_dword s3, s[4:5], 2240
s_load_dword s3, s[4:5], 2304
s_load_dword s3, s[4:5], 2368
s_load_dword s3, s[4:5], 2432
s_load_dword s3, s[4:5], 2496
s_load_dword s3, s[4:5], 2560
s_load_dword s3, s[4:5], 2624
buffer_load_dwordx4 v3, s[8:11], s37 offen offset:2048 sc1 lds
v_mul_f32 v66, v57, v57
v_mul_f32 v64, 0xc0135761, v57
v_mul_f32 v65, 0xbdd2d3e8, v57
v_mul_f32 v65, v65, v66
v_rcp_f32 v66, v66
v_mul_f32 v70, v59, v59
v_mul_f32 v68, 0xc0135761, v59
buffer_load_dwordx4 v3, s[8:11], s37 offen offset:3072 sc1 lds
v_mul_f32 v69, 0xbdd2d3e8, v59
v_mul_f32 v69, v69, v70
v_rcp_f32 v70, v70
v_fma_f32 v128, -v56, v32, v128
v_fma_f32 v129, -v56, v33, v129
v_fma_f32 v130, -v56, v34, v130
v_fma_f32 v131, -v56, v35, v131
v_fma_f32 v152, -v58, v32, v152
s_add_u32 s38, s35, 3
s_and_b32 s38, s38, 15
s_mul_i32 s38, s38, 458752
s_add_u32 m0, s40, 49152
s_nop 0
buffer_load_dwordx4 v4, s[12:15], s38 offen lds
v_fma_f32 v153, -v58, v33, v153
v_fma_f32 v154, -v58, v34, v154
v_fma_f32 v155, -v58, v35, v155
v_mul_f32 v72, v128, v128
v_mul_f32 v73, v129, v129
v_mul_f32 v74, v130, v130
v_mul_f32 v75, v131, v131
s_add_u32 m0, s40, 50176
s_nop 0
buffer_load_dwordx4 v5, s[12:15], s38 offen lds
v_mul_f32 v76, v152, v152
v_mul_f32 v77, v153, v153
v_mul_f32 v78, v154, v154
v_mul_f32 v79, v155, v155
v_fma_f32 v72, v72, v65, v64
v_fma_f32 v73, v73, v65, v64
v_fma_f32 v74, v74, v65, v64
s_add_u32 m0, s40, 51200
s_add_u32 s38, s38, 57344
buffer_load_dwordx4 v4, s[12:15], s38 offen lds
v_fma_f32 v75, v75, v65, v64
v_fma_f32 v76, v76, v69, v68
v_fma_f32 v77, v77, v69, v68
v_fma_f32 v78, v78, v69, v68
v_fma_f32 v79, v79, v69, v68
v_mul_f32 v72, v72, v128
v_mul_f32 v73, v73, v129
v_mul_f32 v74, v74, v130
s_add_u32 m0, s40, 52224
s_nop 0
buffer_load_dwordx4 v5, s[12:15], s38 offen lds
v_mul_f32 v75, v75, v131
v_mul_f32 v76, v76, v152
v_mul_f32 v77, v77, v153
v_mul_f32 v78, v78, v154
v_mul_f32 v79, v79, v155
v_exp_f32 v72, v72
v_exp_f32 v73, v73
s_add_u32 m0, s40, 53248
s_add_u32 s38, s38, 57344
buffer_load_dwordx4 v4, s[12:15], s38 offen lds
v_exp_f32 v74, v74
v_exp_f32 v75, v75
v_exp_f32 v76, v76
v_exp_f32 v77, v77
v_exp_f32 v78, v78
v_exp_f32 v79, v79
v_fma_f32 v140, -v56, v44, v140
s_add_u32 m0, s40, 54272
s_nop 0
buffer_load_dwordx4 v5, s[12:15], s38 offen lds
v_fma_f32 v141, -v56, v45, v141
v_fma_f32 v142, -v56, v46, v142
v_fma_f32 v143, -v56, v47, v143
v_fma_f32 v164, -v58, v44, v164
v_fma_f32 v165, -v58, v45, v165
v_fma_f32 v166, -v58, v46, v166
v_fma_f32 v167, -v58, v47, v167
v_fma_f32 v72, v72, v66, v66
s_add_u32 m0, s40, 55296
s_add_u32 s38, s38, 57344
buffer_load_dwordx4 v4, s[12:15], s38 offen lds
s_add_u32 m0, s40, 56320
s_nop 0
buffer_load_dwordx4 v5, s[12:15], s38 offen lds
s_waitcnt vmcnt(12)
s_barrier
s_add_u32 s37, s35, 4
s_and_b32 s37, s37, 15
s_mul_i32 s37, s37, 16384
s_add_u32 m0, s39, 98304
s_nop 0
buffer_load_dwordx4 v3, s[8:11], s37 offen sc1 lds
v_fma_f32 v73, v73, v66, v66
v_fma_f32 v74, v74, v66, v66
v_fma_f32 v75, v75, v66, v66
v_fma_f32 v76, v76, v70, v70
v_fma_f32 v77, v77, v70, v70
v_fma_f32 v78, v78, v70, v70
buffer_load_dwordx4 v3, s[8:11], s37 offen offset:1024 sc1 lds
v_fma_f32 v79, v79, v70, v70
v_rcp_f32 v72, v72
v_rcp_f32 v73, v73
v_rcp_f32 v74, v74
v_rcp_f32 v75, v75
v_rcp_f32 v76, v76
buffer_load_dwordx4 v3, s[8:11], s37 offen offset:2048 sc1 lds
v_rcp_f32 v77, v77
v_rcp_f32 v78, v78
v_rcp_f32 v79, v79
v_mul_f32 v140, v128, v140
v_mul_f32 v141, v129, v141
v_mul_f32 v142, v130, v142
buffer_load_dwordx4 v3, s[8:11], s37 offen offset:3072 sc1 lds
v_mul_f32 v143, v131, v143
v_mul_f32 v164, v152, v164
v_mul_f32 v165, v153, v165
v_mul_f32 v166, v154, v166
v_mul_f32 v167, v155, v167
v_mul_f32 v140, v140, v72
s_add_u32 s38, s35, 4
s_and_b32 s38, s38, 15
s_mul_i32 s38, s38, 458752
s_add_u32 m0, s40, 98304
s_nop 0
buffer_load_dwordx4 v4, s[12:15], s38 offen lds
v_mul_f32 v141, v141, v73
v_mul_f32 v142, v142, v74
v_mul_f32 v143, v143, v75
v_mul_f32 v164, v164, v76
v_mul_f32 v165, v165, v77
v_mul_f32 v166, v166, v78
s_add_u32 m0, s40, 99328
s_nop 0
buffer_load_dwordx4 v5, s[12:15], s38 offen lds
v_mul_f32 v167, v167, v79
v_cvt_pk_bf16_f32 v128, v140, v141
v_cvt_pk_bf16_f32 v129, v142, v143
v_cvt_pk_bf16_f32 v152, v164, v165
v_cvt_pk_bf16_f32 v153, v166, v167
v_fma_f32 v132, -v56, v36, v132
s_add_u32 m0, s40, 100352
s_add_u32 s38, s38, 57344
buffer_load_dwordx4 v4, s[12:15], s38 offen lds
v_fma_f32 v133, -v56, v37, v133
v_fma_f32 v134, -v56, v38, v134
v_fma_f32 v135, -v56, v39, v135
v_fma_f32 v156, -v58, v36, v156
v_fma_f32 v157, -v58, v37, v157
v_fma_f32 v158, -v58, v38, v158
s_add_u32 m0, s40, 101376
s_nop 0
buffer_load_dwordx4 v5, s[12:15], s38 offen lds
v_fma_f32 v159, -v58, v39, v159
v_mul_f32 v72, v132, v132
v_mul_f32 v73, v133, v133
v_mul_f32 v74, v134, v134
v_mul_f32 v75, v135, v135
v_mul_f32 v76, v156, v156
s_add_u32 m0, s40, 102400
s_add_u32 s38, s38, 57344
buffer_load_dwordx4 v4, s[12:15], s38 offen lds
v_mul_f32 v77, v157, v157
v_mul_f32 v78, v158, v158
v_mul_f32 v79, v159, v159
v_fma_f32 v72, v72, v65, v64
v_fma_f32 v73, v73, v65, v64
v_fma_f32 v74, v74, v65, v64
s_add_u32 m0, s40, 103424
s_nop 0
buffer_load_dwordx4 v5, s[12:15], s38 offen lds
v_fma_f32 v75, v75, v65, v64
v_fma_f32 v76, v76, v69, v68
v_fma_f32 v77, v77, v69, v68
v_fma_f32 v78, v78, v69, v68
v_fma_f32 v79, v79, v69, v68
v_mul_f32 v72, v72, v132
s_add_u32 m0, s40, 104448
s_add_u32 s38, s38, 57344
buffer_load_dwordx4 v4, s[12:15], s38 offen lds
s_add_u32 m0, s40, 105472
s_nop 0
buffer_load_dwordx4 v5, s[12:15], s38 offen lds
s_waitcnt vmcnt(12)
s_barrier
s_cmp_eq_u32 s47, 3
s_cbranch_scc0 Lw_110
s_lshr_b32 s43, s2, 4
s_add_u32 s43, s43, 80
s_lshl_b32 s43, s43, 7
v_mov_b32 v90, s43
v_mov_b32 v91, 1
s_mov_b64 exec, 1
buffer_atomic_add v91, v90, s[56:59], 0 offen sc1
s_mov_b64 exec, -1
Lw_110:
s_waitcnt lgkmcnt(0)
s_add_u32 s37, s35, 5
s_and_b32 s37, s37, 15
s_mul_i32 s37, s37, 16384
s_add_u32 m0, s39, 0
s_nop 0
buffer_load_dwordx4 v3, s[8:11], s37 offen sc1 lds
s_load_dword s3, s[4:5], 2688
s_load_dword s3, s[4:5], 2752
s_load_dword s3, s[4:5], 2816
s_load_dword s3, s[4:5], 2880
s_load_dword s3, s[4:5], 2944
s_load_dword s3, s[4:5], 3008
s_load_dword s3, s[4:5], 3072
buffer_load_dwordx4 v3, s[8:11], s37 offen offset:1024 sc1 lds
s_load_dword s3, s[4:5], 3136
s_load_dword s3, s[4:5], 3200
s_load_dword s3, s[4:5], 3264
s_load_dword s3, s[4:5], 3328
s_load_dword s3, s[4:5], 3392
s_load_dword s3, s[4:5], 3456
s_load_dword s3, s[4:5], 3520
buffer_load_dwordx4 v3, s[8:11], s37 offen offset:2048 sc1 lds
v_mul_f32 v73, v73, v133
v_mul_f32 v74, v74, v134
v_mul_f32 v75, v75, v135
v_mul_f32 v76, v76, v156
v_mul_f32 v77, v77, v157
v_mul_f32 v78, v78, v158
v_mul_f32 v79, v79, v159
v_exp_f32 v72, v72
buffer_load_dwordx4 v3, s[8:11], s37 offen offset:3072 sc1 lds
v_exp_f32 v73, v73
v_exp_f32 v74, v74
v_exp_f32 v75, v75
v_exp_f32 v76, v76
v_exp_f32 v77, v77
v_exp_f32 v78, v78
v_exp_f32 v79, v79
s_add_u32 s38, s35, 5
s_and_b32 s38, s38, 15
s_mul_i32 s38, s38, 458752
s_add_u32 m0, s40, 0
s_nop 0
buffer_load_dwordx4 v4, s[12:15], s38 offen lds
v_fma_f32 v144, -v56, v48, v144
v_fma_f32 v145, -v56, v49, v145
v_fma_f32 v146, -v56, v50, v146
v_fma_f32 v147, -v56, v51, v147
v_fma_f32 v168, -v58, v48, v168
v_fma_f32 v169, -v58, v49, v169
v_fma_f32 v170, -v58, v50, v170
v_fma_f32 v171, -v58, v51, v171
s_add_u32 m0, s40, 1024
s_nop 0
buffer_load_dwordx4 v5, s[12:15], s38 offen lds
v_fma_f32 v72, v72, v66, v66
v_fma_f32 v73, v73, v66, v66
v_fma_f32 v74, v74, v66, v66
v_fma_f32 v75, v75, v66, v66
v_fma_f32 v76, v76, v70, v70
v_fma_f32 v77, v77, v70, v70
v_fma_f32 v78, v78, v70, v70
s_add_u32 m0, s40, 2048
s_add_u32 s38, s38, 57344
buffer_load_dwordx4 v4, s[12:15], s38 offen lds
v_fma_f32 v79, v79, v70, v70
v_rcp_f32 v72, v72
v_rcp_f32 v73, v73
v_rcp_f32 v74, v74
v_rcp_f32 v75, v75
v_rcp_f32 v76, v76
v_rcp_f32 v77, v77
s_add_u32 m0, s40, 3072
s_nop 0
buffer_load_dwordx4 v5, s[12:15], s38 offen lds
v_rcp_f32 v78, v78
v_rcp_f32 v79, v79
v_mul_f32 v144, v132, v144
v_mul_f32 v145, v133, v145
v_mul_f32 v146, v134, v146
v_mul_f32 v147, v135, v147
v_mul_f32 v168, v156, v168
v_mul_f32 v169, v157, v169
s_add_u32 m0, s40, 4096
s_add_u32 s38, s38, 57344
buffer_load_dwordx4 v4, s[12:15], s38 offen lds
v_mul_f32 v170, v158, v170
v_mul_f32 v171, v159, v171
v_mul_f32 v144, v144, v72
v_mul_f32 v145, v145, v73
v_mul_f32 v146, v146, v74
v_mul_f32 v147, v147, v75
v_mul_f32 v168, v168, v76
s_add_u32 m0, s40, 5120
s_nop 0
buffer_load_dwordx4 v5, s[12:15], s38 offen lds
v_mul_f32 v169, v169, v77
v_mul_f32 v170, v170, v78
v_mul_f32 v171, v171, v79
v_cvt_pk_bf16_f32 v130, v144, v145
v_cvt_pk_bf16_f32 v131, v146, v147
v_cvt_pk_bf16_f32 v154, v168, v169
v_cvt_pk_bf16_f32 v155, v170, v171
buffer_store_dwordx4 v[128:131], v2, s[24:27], s54 offen offset:0 sc1
s_add_u32 m0, s40, 6144
s_add_u32 s38, s38, 57344
buffer_load_dwordx4 v4, s[12:15], s38 offen lds
s_add_u32 m0, s40, 7168
s_nop 0
buffer_load_dwordx4 v5, s[12:15], s38 offen lds
s_waitcnt vmcnt(13)
s_barrier
s_add_u32 s37, s35, 6
s_and_b32 s37, s37, 15
s_mul_i32 s37, s37, 16384
s_add_u32 m0, s39, 49152
s_nop 0
buffer_load_dwordx4 v3, s[8:11], s37 offen sc1 lds
buffer_store_dwordx4 v[152:155], v2, s[24:27], s54 offen offset:1024 sc1
v_fma_f32 v136, -v56, v40, v136
v_fma_f32 v137, -v56, v41, v137
v_fma_f32 v138, -v56, v42, v138
v_fma_f32 v139, -v56, v43, v139
v_fma_f32 v160, -v58, v40, v160
buffer_load_dwordx4 v3, s[8:11], s37 offen offset:1024 sc1 lds
v_fma_f32 v161, -v58, v41, v161
v_fma_f32 v162, -v58, v42, v162
v_fma_f32 v163, -v58, v43, v163
v_mul_f32 v72, v136, v136
v_mul_f32 v73, v137, v137
v_mul_f32 v74, v138, v138
buffer_load_dwordx4 v3, s[8:11], s37 offen offset:2048 sc1 lds
v_mul_f32 v75, v139, v139
v_mul_f32 v76, v160, v160
v_mul_f32 v77, v161, v161
v_mul_f32 v78, v162, v162
v_mul_f32 v79, v163, v163
v_fma_f32 v72, v72, v65, v64
buffer_load_dwordx4 v3, s[8:11], s37 offen offset:3072 sc1 lds
v_fma_f32 v73, v73, v65, v64
v_fma_f32 v74, v74, v65, v64
v_fma_f32 v75, v75, v65, v64
v_fma_f32 v76, v76, v69, v68
v_fma_f32 v77, v77, v69, v68
v_fma_f32 v78, v78, v69, v68
s_add_u32 s38, s35, 6
s_and_b32 s38, s38, 15
s_mul_i32 s38, s38, 458752
s_add_u32 m0, s40, 49152
s_nop 0
buffer_load_dwordx4 v4, s[12:15], s38 offen lds
v_fma_f32 v79, v79, v69, v68
v_mul_f32 v72, v72, v136
v_mul_f32 v73, v73, v137
v_mul_f32 v74, v74, v138
v_mul_f32 v75, v75, v139
v_mul_f32 v76, v76, v160
s_add_u32 m0, s40, 50176
s_nop 0
buffer_load_dwordx4 v5, s[12:15], s38 offen lds
v_mul_f32 v77, v77, v161
v_mul_f32 v78, v78, v162
v_mul_f32 v79, v79, v163
v_exp_f32 v72, v72
v_exp_f32 v73, v73
v_exp_f32 v74, v74
s_add_u32 m0, s40, 51200
s_add_u32 s38, s38, 57344
buffer_load_dwordx4 v4, s[12:15], s38 offen lds
v_exp_f32 v75, v75
v_exp_f32 v76, v76
v_exp_f32 v77, v77
v_exp_f32 v78, v78
v_exp_f32 v79, v79
v_fma_f32 v148, -v56, v52, v148
s_add_u32 m0, s40, 52224
s_nop 0
buffer_load_dwordx4 v5, s[12:15], s38 offen lds
v_fma_f32 v149, -v56, v53, v149
v_fma_f32 v150, -v56, v54, v150
v_fma_f32 v151, -v56, v55, v151
v_fma_f32 v172, -v58, v52, v172
v_fma_f32 v173, -v58, v53, v173
v_fma_f32 v174, -v58, v54, v174
s_add_u32 m0, s40, 53248
s_add_u32 s38, s38, 57344
buffer_load_dwordx4 v4, s[12:15], s38 offen lds
v_fma_f32 v175, -v58, v55, v175
v_fma_f32 v72, v72, v66, v66
v_fma_f32 v73, v73, v66, v66
v_fma_f32 v74, v74, v66, v66
v_fma_f32 v75, v75, v66, v66
v_fma_f32 v76, v76, v70, v70
s_add_u32 m0, s40, 54272
s_nop 0
buffer_load_dwordx4 v5, s[12:15], s38 offen lds
v_fma_f32 v77, v77, v70, v70
v_fma_f32 v78, v78, v70, v70
v_fma_f32 v79, v79, v70, v70
v_rcp_f32 v72, v72
v_rcp_f32 v73, v73
v_rcp_f32 v74, v74
s_add_u32 m0, s40, 55296
s_add_u32 s38, s38, 57344
buffer_load_dwordx4 v4, s[12:15], s38 offen lds
s_add_u32 m0, s40, 56320
s_nop 0
buffer_load_dwordx4 v5, s[12:15], s38 offen lds
s_waitcnt vmcnt(13)
s_barrier
s_waitcnt lgkmcnt(0)
s_add_u32 s37, s35, 7
s_and_b32 s37, s37, 15
s_mul_i32 s37, s37, 16384
s_add_u32 m0, s39, 98304
s_nop 0
buffer_load_dwordx4 v3, s[8:11], s37 offen sc1 lds
s_load_dword s3, s[4:5], 3584
s_load_dword s3, s[4:5], 3648
s_load_dword s3, s[4:5], 3712
s_load_dword s3, s[4:5], 3776
s_load_dword s3, s[4:5], 3840
s_load_dword s3, s[4:5], 3904
s_load_dword s3, s[4:5], 3968
buffer_load_dwordx4 v3, s[8:11], s37 offen offset:1024 sc1 lds
s_load_dword s3, s[4:5], 4032
s_load_dword s3, s[4:5], 4096
s_load_dword s3, s[4:5], 4160
s_load_dword s3, s[4:5], 4224
s_load_dword s3, s[4:5], 4288
s_load_dword s3, s[4:5], 4352
s_load_dword s3, s[4:5], 4416
buffer_load_dwordx4 v3, s[8:11], s37 offen offset:2048 sc1 lds
v_rcp_f32 v75, v75
v_rcp_f32 v76, v76
v_rcp_f32 v77, v77
v_rcp_f32 v78, v78
v_rcp_f32 v79, v79
v_mul_f32 v148, v136, v148
v_mul_f32 v149, v137, v149
buffer_load_dwordx4 v3, s[8:11], s37 offen offset:3072 sc1 lds
v_mul_f32 v150, v138, v150
v_mul_f32 v151, v139, v151
v_mul_f32 v172, v160, v172
v_mul_f32 v173, v161, v173
v_mul_f32 v174, v162, v174
v_mul_f32 v175, v163, v175
v_mul_f32 v148, v148, v72
v_mul_f32 v149, v149, v73
s_add_u32 s38, s35, 7
s_and_b32 s38, s38, 15
s_mul_i32 s38, s38, 458752
s_add_u32 m0, s40, 98304
s_nop 0
buffer_load_dwordx4 v4, s[12:15], s38 offen lds
v_mul_f32 v150, v150, v74
v_mul_f32 v151, v151, v75
v_mul_f32 v172, v172, v76
v_mul_f32 v173, v173, v77
v_mul_f32 v174, v174, v78
v_mul_f32 v175, v175, v79
v_cvt_pk_bf16_f32 v80, v148, v149
s_add_u32 m0, s40, 99328
s_nop 0
buffer_load_dwordx4 v5, s[12:15], s38 offen lds
v_cvt_pk_bf16_f32 v81, v150, v151
v_cvt_pk_bf16_f32 v82, v172, v173
v_cvt_pk_bf16_f32 v83, v174, v175
s_nop 1
v_permlane32_swap_b32 v80, v82
v_permlane32_swap_b32 v81, v83
s_branch Lov_9
.p2align 12
.fill 64, 4, 0xbf800000
Lst_9_0:
s_branch Lwr_154
Lst_9_1:
s_branch Lwr_165
s_nop 0
Lov_9:
buffer_store_dwordx4 v[80:83], v84, s[24:27], s55 offen offset:0 sc1
s_add_u32 m0, s40, 100352
s_add_u32 s38, s38, 57344
buffer_load_dwordx4 v4, s[12:15], s38 offen lds
s_nop 1
v_mul_f32 v66, v61, v61
v_mul_f32 v64, 0xc0135761, v61
v_mul_f32 v65, 0xbdd2d3e8, v61
v_mul_f32 v65, v65, v66
v_rcp_f32 v66, v66
v_mul_f32 v70, v63, v63
v_mul_f32 v68, 0xc0135761, v63
s_add_u32 m0, s40, 101376
s_nop 0
buffer_load_dwordx4 v5, s[12:15], s38 offen lds
v_mul_f32 v69, 0xbdd2d3e8, v63
v_mul_f32 v69, v69, v70
v_rcp_f32 v70, v70
v_fma_f32 v176, -v60, v32, v176
v_fma_f32 v177, -v60, v33, v177
v_fma_f32 v178, -v60, v34, v178
v_fma_f32 v179, -v60, v35, v179
s_add_u32 m0, s40, 102400
s_add_u32 s38, s38, 57344
buffer_load_dwordx4 v4, s[12:15], s38 offen lds
v_fma_f32 v200, -v62, v32, v200
v_fma_f32 v201, -v62, v33, v201
v_fma_f32 v202, -v62, v34, v202
v_fma_f32 v203, -v62, v35, v203
v_mul_f32 v72, v176, v176
v_mul_f32 v73, v177, v177
v_mul_f32 v74, v178, v178
s_add_u32 m0, s40, 103424
s_nop 0
buffer_load_dwordx4 v5, s[12:15], s38 offen lds
v_mul_f32 v75, v179, v179
v_mul_f32 v76, v200, v200
v_mul_f32 v77, v201, v201
v_mul_f32 v78, v202, v202
v_mul_f32 v79, v203, v203
v_fma_f32 v72, v72, v65, v64
v_fma_f32 v73, v73, v65, v64
v_fma_f32 v74, v74, v65, v64
s_add_u32 m0, s40, 104448
s_add_u32 s38, s38, 57344
buffer_load_dwordx4 v4, s[12:15], s38 offen lds
s_add_u32 m0, s40, 105472
s_nop 0
buffer_load_dwordx4 v5, s[12:15], s38 offen lds
s_waitcnt vmcnt(13)
s_barrier
s_add_u32 s37, s35, 8
s_and_b32 s37, s37, 15
s_mul_i32 s37, s37, 16384
s_add_u32 m0, s39, 0
s_nop 0
buffer_load_dwordx4 v3, s[8:11], s37 offen sc1 lds
v_fma_f32 v75, v75, v65, v64
v_fma_f32 v76, v76, v69, v68
v_fma_f32 v77, v77, v69, v68
v_fma_f32 v78, v78, v69, v68
v_fma_f32 v79, v79, v69, v68
v_mul_f32 v72, v72, v176
buffer_load_dwordx4 v3, s[8:11], s37 offen offset:1024 sc1 lds
v_mul_f32 v73, v73, v177
v_mul_f32 v74, v74, v178
v_mul_f32 v75, v75, v179
v_mul_f32 v76, v76, v200
v_mul_f32 v77, v77, v201
v_mul_f32 v78, v78, v202
buffer_load_dwordx4 v3, s[8:11], s37 offen offset:2048 sc1 lds
v_mul_f32 v79, v79, v203
v_exp_f32 v72, v72
v_exp_f32 v73, v73
v_exp_f32 v74, v74
v_exp_f32 v75, v75
v_exp_f32 v76, v76
buffer_load_dwordx4 v3, s[8:11], s37 offen offset:3072 sc1 lds
v_exp_f32 v77, v77
v_exp_f32 v78, v78
v_exp_f32 v79, v79
v_fma_f32 v188, -v60, v44, v188
v_fma_f32 v189, -v60, v45, v189
v_fma_f32 v190, -v60, v46, v190
s_add_u32 s38, s35, 8
s_and_b32 s38, s38, 15
s_mul_i32 s38, s38, 458752
s_add_u32 m0, s40, 0
s_nop 0
buffer_load_dwordx4 v4, s[12:15], s38 offen lds
v_fma_f32 v191, -v60, v47, v191
v_fma_f32 v212, -v62, v44, v212
v_fma_f32 v213, -v62, v45, v213
v_fma_f32 v214, -v62, v46, v214
v_fma_f32 v215, -v62, v47, v215
v_fma_f32 v72, v72, v66, v66
s_add_u32 m0, s40, 1024
s_nop 0
buffer_load_dwordx4 v5, s[12:15], s38 offen lds
v_fma_f32 v73, v73, v66, v66
v_fma_f32 v74, v74, v66, v66
v_fma_f32 v75, v75, v66, v66
v_fma_f32 v76, v76, v70, v70
v_fma_f32 v77, v77, v70, v70
v_fma_f32 v78, v78, v70, v70
s_add_u32 m0, s40, 2048
s_add_u32 s38, s38, 57344
buffer_load_dwordx4 v4, s[12:15], s38 offen lds
v_fma_f32 v79, v79, v70, v70
v_rcp_f32 v72, v72
v_rcp_f32 v73, v73
v_rcp_f32 v74, v74
v_rcp_f32 v75, v75
v_rcp_f32 v76, v76
s_add_u32 m0, s40, 3072
s_nop 0
buffer_load_dwordx4 v5, s[12:15], s38 offen lds
v_rcp_f32 v77, v77
v_rcp_f32 v78, v78
v_rcp_f32 v79, v79
v_mul_f32 v188, v176, v188
v_mul_f32 v189, v177, v189
v_mul_f32 v190, v178, v190
s_add_u32 m0, s40, 4096
s_add_u32 s38, s38, 57344
buffer_load_dwordx4 v4, s[12:15], s38 offen lds
v_mul_f32 v191, v179, v191
v_mul_f32 v212, v200, v212
v_mul_f32 v213, v201, v213
v_mul_f32 v214, v202, v214
v_mul_f32 v215, v203, v215
v_mul_f32 v188, v188, v72
s_add_u32 m0, s40, 5120
s_nop 0
buffer_load_dwordx4 v5, s[12:15], s38 offen lds
v_mul_f32 v189, v189, v73
v_mul_f32 v190, v190, v74
v_mul_f32 v191, v191, v75
v_mul_f32 v212, v212, v76
v_mul_f32 v213, v213, v77
v_mul_f32 v214, v214, v78
s_add_u32 m0, s40, 6144
s_add_u32 s38, s38, 57344
buffer_load_dwordx4 v4, s[12:15], s38 offen lds
s_add_u32 m0, s40, 7168
s_nop 0
buffer_load_dwordx4 v5, s[12:15], s38 offen lds
s_waitcnt vmcnt(12)
s_barrier
s_waitcnt lgkmcnt(0)
s_cmp_eq_u32 s47, 3
s_cbranch_scc0 Lw_111
s_lshl_b32 s60, s35, 7
s_add_u32 s60, s60, 28321792
s_mov_b32 s61, s60
s_load_dword s92, s[82:83], s60 glc
s_load_dword s93, s[82:83], s61 glc
Lw_111:
s_add_u32 s37, s35, 9
s_and_b32 s37, s37, 15
s_mul_i32 s37, s37, 16384
s_add_u32 m0, s39, 49152
s_nop 0
buffer_load_dwordx4 v3, s[8:11], s37 offen sc1 lds
s_load_dword s3, s[4:5], 4480
s_load_dword s3, s[4:5], 4544
s_load_dword s3, s[4:5], 4608
s_load_dword s3, s[4:5], 4672
s_load_dword s3, s[4:5], 4736
s_load_dword s3, s[4:5], 4800
s_load_dword s3, s[4:5], 4864
buffer_load_dwordx4 v3, s[8:11], s37 offen offset:1024 sc1 lds
s_load_dword s3, s[4:5], 4928
s_load_dword s3, s[4:5], 4992
s_load_dword s3, s[4:5], 5056
s_load_dword s3, s[4:5], 5120
s_load_dword s3, s[4:5], 5184
s_load_dword s3, s[4:5], 5248
s_load_dword s3, s[4:5], 5312
buffer_load_dwordx4 v3, s[8:11], s37 offen offset:2048 sc1 lds
v_mul_f32 v215, v215, v79
v_cvt_pk_bf16_f32 v176, v188, v189
v_cvt_pk_bf16_f32 v177, v190, v191
v_cvt_pk_bf16_f32 v200, v212, v213
v_cvt_pk_bf16_f32 v201, v214, v215
v_fma_f32 v180, -v60, v36, v180
v_fma_f32 v181, -v60, v37, v181
v_fma_f32 v182, -v60, v38, v182
buffer_load_dwordx4 v3, s[8:11], s37 offen offset:3072 sc1 lds
v_fma_f32 v183, -v60, v39, v183
v_fma_f32 v204, -v62, v36, v204
v_fma_f32 v205, -v62, v37, v205
v_fma_f32 v206, -v62, v38, v206
v_fma_f32 v207, -v62, v39, v207
v_mul_f32 v72, v180, v180
v_mul_f32 v73, v181, v181
s_add_u32 s38, s35, 9
s_and_b32 s38, s38, 15
s_mul_i32 s38, s38, 458752
s_add_u32 m0, s40, 49152
s_nop 0
buffer_load_dwordx4 v4, s[12:15], s38 offen lds
v_mul_f32 v74, v182, v182
v_mul_f32 v75, v183, v183
v_mul_f32 v76, v204, v204
v_mul_f32 v77, v205, v205
v_mul_f32 v78, v206, v206
v_mul_f32 v79, v207, v207
v_fma_f32 v72, v72, v65, v64
v_fma_f32 v73, v73, v65, v64
s_add_u32 m0, s40, 50176
s_nop 0
buffer_load_dwordx4 v5, s[12:15], s38 offen lds
v_fma_f32 v74, v74, v65, v64
v_fma_f32 v75, v75, v65, v64
v_fma_f32 v76, v76, v69, v68
v_fma_f32 v77, v77, v69, v68
v_fma_f32 v78, v78, v69, v68
v_fma_f32 v79, v79, v69, v68
v_mul_f32 v72, v72, v180
s_add_u32 m0, s40, 51200
s_add_u32 s38, s38, 57344
buffer_load_dwordx4 v4, s[12:15], s38 offen lds
v_mul_f32 v73, v73, v181
v_mul_f32 v74, v74, v182
v_mul_f32 v75, v75, v183
v_mul_f32 v76, v76, v204
v_mul_f32 v77, v77, v205
v_mul_f32 v78, v78, v206
v_mul_f32 v79, v79, v207
s_add_u32 m0, s40, 52224
s_nop 0
buffer_load_dwordx4 v5, s[12:15], s38 offen lds
v_exp_f32 v72, v72
v_exp_f32 v73, v73
v_exp_f32 v74, v74
v_exp_f32 v75, v75
v_exp_f32 v76, v76
v_exp_f32 v77, v77
v_exp_f32 v78, v78
v_exp_f32 v79, v79
s_add_u32 m0, s40, 53248
s_add_u32 s38, s38, 57344
buffer_load_dwordx4 v4, s[12:15], s38 offen lds
v_fma_f32 v192, -v60, v48, v192
v_fma_f32 v193, -v60, v49, v193
v_fma_f32 v194, -v60, v50, v194
v_fma_f32 v195, -v60, v51, v195
v_fma_f32 v216, -v62, v48, v216
v_fma_f32 v217, -v62, v49, v217
v_fma_f32 v218, -v62, v50, v218
s_add_u32 m0, s40, 54272
s_nop 0
buffer_load_dwordx4 v5, s[12:15], s38 offen lds
v_fma_f32 v219, -v62, v51, v219
v_fma_f32 v72, v72, v66, v66
v_fma_f32 v73, v73, v66, v66
v_fma_f32 v74, v74, v66, v66
v_fma_f32 v75, v75, v66, v66
v_fma_f32 v76, v76, v70, v70
v_fma_f32 v77, v77, v70, v70
v_fma_f32 v78, v78, v70, v70
s_add_u32 m0, s40, 55296
s_add_u32 s38, s38, 57344
buffer_load_dwordx4 v4, s[12:15], s38 offen lds
s_add_u32 m0, s40, 56320
s_nop 0
buffer_load_dwordx4 v5, s[12:15], s38 offen lds
s_waitcnt vmcnt(12)
s_barrier
s_add_u32 s37, s35, 10
s_and_b32 s37, s37, 15
s_mul_i32 s37, s37, 16384
s_add_u32 m0, s39, 98304
s_nop 0
buffer_load_dwordx4 v3, s[8:11], s37 offen sc1 lds
v_fma_f32 v79, v79, v70, v70
v_rcp_f32 v72, v72
v_rcp_f32 v73, v73
v_rcp_f32 v74, v74
v_rcp_f32 v75, v75
v_rcp_f32 v76, v76
buffer_load_dwordx4 v3, s[8:11], s37 offen offset:1024 sc1 lds
v_rcp_f32 v77, v77
v_rcp_f32 v78, v78
v_rcp_f32 v79, v79
v_mul_f32 v192, v180, v192
v_mul_f32 v193, v181, v193
v_mul_f32 v194, v182, v194
buffer_load_dwordx4 v3, s[8:11], s37 offen offset:2048 sc1 lds
v_mul_f32 v195, v183, v195
v_mul_f32 v216, v204, v216
v_mul_f32 v217, v205, v217
v_mul_f32 v218, v206, v218
v_mul_f32 v219, v207, v219
v_mul_f32 v192, v192, v72
buffer_load_dwordx4 v3, s[8:11], s37 offen offset:3072 sc1 lds
v_mul_f32 v193, v193, v73
v_mul_f32 v194, v194, v74
v_mul_f32 v195, v195, v75
v_mul_f32 v216, v216, v76
v_mul_f32 v217, v217, v77
v_mul_f32 v218, v218, v78
s_add_u32 s38, s35, 10
s_and_b32 s38, s38, 15
s_mul_i32 s38, s38, 458752
s_add_u32 m0, s40, 98304
s_nop 0
buffer_load_dwordx4 v4, s[12:15], s38 offen lds
v_mul_f32 v219, v219, v79
v_cvt_pk_bf16_f32 v178, v192, v193
v_cvt_pk_bf16_f32 v179, v194, v195
v_cvt_pk_bf16_f32 v202, v216, v217
v_cvt_pk_bf16_f32 v203, v218, v219
buffer_store_dwordx4 v[176:179], v2, s[24:27], s54 offen offset:2048 sc1
s_add_u32 m0, s40, 99328
s_nop 0
buffer_load_dwordx4 v5, s[12:15], s38 offen lds
buffer_store_dwordx4 v[200:203], v2, s[24:27], s54 offen offset:3072 sc1
v_fma_f32 v184, -v60, v40, v184
v_fma_f32 v185, -v60, v41, v185
v_fma_f32 v186, -v60, v42, v186
v_fma_f32 v187, -v60, v43, v187
v_fma_f32 v208, -v62, v40, v208
s_add_u32 m0, s40, 100352
s_add_u32 s38, s38, 57344
buffer_load_dwordx4 v4, s[12:15], s38 offen lds
v_fma_f32 v209, -v62, v41, v209
v_fma_f32 v210, -v62, v42, v210
v_fma_f32 v211, -v62, v43, v211
v_mul_f32 v72, v184, v184
v_mul_f32 v73, v185, v185
v_mul_f32 v74, v186, v186
s_add_u32 m0, s40, 101376
s_nop 0
buffer_load_dwordx4 v5, s[12:15], s38 offen lds
v_mul_f32 v75, v187, v187
v_mul_f32 v76, v208, v208
v_mul_f32 v77, v209, v209
v_mul_f32 v78, v210, v210
v_mul_f32 v79, v211, v211
v_fma_f32 v72, v72, v65, v64
s_add_u32 m0, s40, 102400
s_add_u32 s38, s38, 57344
buffer_load_dwordx4 v4, s[12:15], s38 offen lds
v_fma_f32 v73, v73, v65, v64
v_fma_f32 v74, v74, v65, v64
v_fma_f32 v75, v75, v65, v64
v_fma_f32 v76, v76, v69, v68
v_fma_f32 v77, v77, v69, v68
v_fma_f32 v78, v78, v69, v68
s_add_u32 m0, s40, 103424
s_nop 0
buffer_load_dwordx4 v5, s[12:15], s38 offen lds
v_fma_f32 v79, v79, v69, v68
v_mul_f32 v72, v72, v184
v_mul_f32 v73, v73, v185
v_mul_f32 v74, v74, v186
v_mul_f32 v75, v75, v187
v_mul_f32 v76, v76, v208
s_add_u32 m0, s40, 104448
s_add_u32 s38, s38, 57344
buffer_load_dwordx4 v4, s[12:15], s38 offen lds
s_add_u32 m0, s40, 105472
s_nop 0
buffer_load_dwordx4 v5, s[12:15], s38 offen lds
s_waitcnt vmcnt(14)
s_cmp_eq_u32 s47, 3
s_cbranch_scc0 Lw_112
s_mov_b32 s41, 0x40000
Lcp_113:
s_waitcnt lgkmcnt(0)
s_and_b32 s92, s92, s93
s_cmp_eq_u32 s92, 16
s_cbranch_scc1 Lco_114
s_load_dword s92, s[82:83], s60 glc
s_load_dword s93, s[82:83], s61 glc
s_sub_u32 s41, s41, 1
s_cmp_lg_u32 s41, 0
s_cbranch_scc1 Lcp_113
s_waitcnt lgkmcnt(0)
Lco_114:
Lw_112:
s_barrier
s_lshl_b32 s60, s35, 9
s_lshl_b32 s43, s47, 7
s_add_u32 s60, s60, s43
s_add_u32 s61, s60, 14336
s_add_u32 s52, s43, 148480
s_add_u32 s53, s52, 896
v_lshrrev_b32 v104, 3, v1
v_mul_u32_u24 v104, 28672, v104
v_and_b32 v105, 7, v1
v_lshl_add_u32 v104, v105, 4, v104
s_waitcnt lgkmcnt(0)
buffer_load_dwordx4 v[96:99], v104, s[84:87], s60 offen sc1
s_load_dword s3, s[4:5], 5376
s_load_dword s3, s[4:5], 5440
s_load_dword s3, s[4:5], 5504
s_load_dword s3, s[4:5], 5568
s_load_dword s3, s[4:5], 5632
s_load_dword s3, s[4:5], 5696
buffer_load_dwordx4 v[100:103], v104, s[84:87], s61 offen sc1
s_load_dword s3, s[4:5], 5760
s_load_dword s3, s[4:5], 5824
s_load_dword s3, s[4:5], 5888
s_load_dword s3, s[4:5], 5952
s_load_dword s3, s[4:5], 6016
s_load_dword s3, s[4:5], 6080
s_load_dword s3, s[4:5], 6144
s_add_u32 s37, s35, 11
s_and_b32 s37, s37, 15
s_mul_i32 s37, s37, 16384
s_add_u32 m0, s39, 0
s_nop 0
buffer_load_dwordx4 v3, s[8:11], s37 offen sc1 lds
s_load_dword s3, s[4:5], 6208
v_mul_f32 v77, v77, v209
v_mul_f32 v78, v78, v210
v_mul_f32 v79, v79, v211
v_exp_f32 v72, v72
v_exp_f32 v73, v73
v_exp_f32 v74, v74
buffer_load_dwordx4 v3, s[8:11], s37 offen offset:1024 sc1 lds
v_exp_f32 v75, v75
v_exp_f32 v76, v76
v_exp_f32 v77, v77
v_exp_f32 v78, v78
v_exp_f32 v79, v79
v_fma_f32 v196, -v60, v52, v196
v_fma_f32 v197, -v60, v53, v197
buffer_load_dwordx4 v3, s[8:11], s37 offen offset:2048 sc1 lds
v_fma_f32 v198, -v60, v54, v198
v_fma_f32 v199, -v60, v55, v199
v_fma_f32 v220, -v62, v52, v220
v_fma_f32 v221, -v62, v53, v221
v_fma_f32 v222, -v62, v54, v222
v_fma_f32 v223, -v62, v55, v223
buffer_load_dwordx4 v3, s[8:11], s37 offen offset:3072 sc1 lds
v_fma_f32 v72, v72, v66, v66
v_fma_f32 v73, v73, v66, v66
v_fma_f32 v74, v74, v66, v66
v_fma_f32 v75, v75, v66, v66
v_fma_f32 v76, v76, v70, v70
v_fma_f32 v77, v77, v70, v70
v_fma_f32 v78, v78, v70, v70
s_add_u32 s38, s35, 11
s_and_b32 s38, s38, 15
s_mul_i32 s38, s38, 458752
s_add_u32 m0, s40, 0
s_nop 0
buffer_load_dwordx4 v4, s[12:15], s38 offen lds
v_fma_f32 v79, v79, v70, v70
v_rcp_f32 v72, v72
v_rcp_f32 v73, v73
v_rcp_f32 v74, v74
v_rcp_f32 v75, v75
v_rcp_f32 v76, v76
v_rcp_f32 v77, v77
s_add_u32 m0, s40, 1024
s_nop 0
buffer_load_dwordx4 v5, s[12:15], s38 offen lds
v_rcp_f32 v78, v78
v_rcp_f32 v79, v79
v_mul_f32 v196, v184, v196
v_mul_f32 v197, v185, v197
v_mul_f32 v198, v186, v198
v_mul_f32 v199, v187, v199
v_mul_f32 v220, v208, v220
s_add_u32 m0, s40, 2048
s_add_u32 s38, s38, 57344
buffer_load_dwordx4 v4, s[12:15], s38 offen lds
v_mul_f32 v221, v209, v221
v_mul_f32 v222, v210, v222
v_mul_f32 v223, v211, v223
v_mul_f32 v196, v196, v72
v_mul_f32 v197, v197, v73
v_mul_f32 v198, v198, v74
s_add_u32 m0, s40, 3072
s_nop 0
buffer_load_dwordx4 v5, s[12:15], s38 offen lds
v_mul_f32 v199, v199, v75
v_mul_f32 v220, v220, v76
v_mul_f32 v221, v221, v77
v_mul_f32 v222, v222, v78
v_mul_f32 v223, v223, v79
v_cvt_pk_bf16_f32 v80, v196, v197
v_cvt_pk_bf16_f32 v81, v198, v199
s_add_u32 m0, s40, 4096
s_add_u32 s38, s38, 57344
buffer_load_dwordx4 v4, s[12:15], s38 offen lds
v_cvt_pk_bf16_f32 v82, v220, v221
v_cvt_pk_bf16_f32 v83, v222, v223
s_nop 1
v_permlane32_swap_b32 v80, v82
v_permlane32_swap_b32 v81, v83
buffer_store_dwordx4 v[80:83], v84, s[24:27], s55 offen offset:2048 sc1
s_nop 1
s_add_u32 m0, s40, 5120
s_nop 0
buffer_load_dwordx4 v5, s[12:15], s38 offen lds
v_cmp_gt_u32 vcc, 32, v1
v_mov_b32 v104, s52
v_mov_b32 v106, s53
v_cndmask_b32 v104, v106, v104, vcc
v_lshl_add_u32 v104, v105, 4, v104
v_bfe_u32 v105, v1, 4, 1
v_lshl_add_u32 v104, v105, 2, v104
s_add_u32 m0, s40, 6144
s_add_u32 s38, s38, 57344
buffer_load_dwordx4 v4, s[12:15], s38 offen lds
s_add_u32 m0, s40, 7168
s_nop 0
buffer_load_dwordx4 v5, s[12:15], s38 offen lds
s_waitcnt vmcnt(15)
s_barrier
s_add_u32 s37, s35, 12
s_and_b32 s37, s37, 15
s_mul_i32 s37, s37, 16384
s_add_u32 m0, s39, 49152
s_nop 0
buffer_load_dwordx4 v3, s[8:11], s37 offen sc1 lds
buffer_load_dwordx4 v3, s[8:11], s37 offen offset:1024 sc1 lds
buffer_load_dwordx4 v3, s[8:11], s37 offen offset:2048 sc1 lds
buffer_load_dwordx4 v3, s[8:11], s37 offen offset:3072 sc1 lds
s_add_u32 s38, s35, 12
s_and_b32 s38, s38, 15
s_mul_i32 s38, s38, 458752
s_add_u32 m0, s40, 49152
s_nop 0
buffer_load_dwordx4 v4, s[12:15], s38 offen lds
s_add_u32 m0, s40, 50176
s_nop 0
buffer_load_dwordx4 v5, s[12:15], s38 offen lds
s_add_u32 m0, s40, 51200
s_add_u32 s38, s38, 57344
buffer_load_dwordx4 v4, s[12:15], s38 offen lds
s_add_u32 m0, s40, 52224
s_nop 0
buffer_load_dwordx4 v5, s[12:15], s38 offen lds
s_add_u32 m0, s40, 53248
s_add_u32 s38, s38, 57344
buffer_load_dwordx4 v4, s[12:15], s38 offen lds
s_add_u32 m0, s40, 54272
s_nop 0
buffer_load_dwordx4 v5, s[12:15], s38 offen lds
s_add_u32 m0, s40, 55296
s_add_u32 s38, s38, 57344
buffer_load_dwordx4 v4, s[12:15], s38 offen lds
s_add_u32 m0, s40, 56320
s_nop 0
buffer_load_dwordx4 v5, s[12:15], s38 offen lds
s_waitcnt vmcnt(12)
s_barrier
s_cmp_eq_u32 s47, 0
s_cbranch_scc0 Lw_115
s_add_u32 s7, s34, 32
s_lshl_b32 s7, s7, 7
v_mov_b32 v90, s7
v_mov_b32 v91, 1
s_mov_b64 exec, 1
buffer_atomic_add v91, v90, s[56:59], 0 offen sc1
s_mov_b64 exec, -1
Lw_115:
v_permlane32_swap_b32 v96, v100
v_permlane32_swap_b32 v97, v101
v_permlane32_swap_b32 v98, v102
v_permlane32_swap_b32 v99, v103
v_add_f32 v96, v96, v100
v_add_f32 v97, v97, v101
v_add_f32 v98, v98, v102
v_add_f32 v99, v99, v103
s_nop 1
v_permlane16_swap_b32 v96, v97
v_permlane16_swap_b32 v98, v99
v_add_f32 v96, v96, v97
v_add_f32 v98, v98, v99
s_nop 1
v_add_f32_dpp v96, v96, v96 row_ror:8 row_mask:0xf bank_mask:0xf
v_add_f32_dpp v98, v98, v98 row_ror:8 row_mask:0xf bank_mask:0xf
ds_write_b32 v104, v96
ds_write_b32 v104, v98 offset:8
s_waitcnt lgkmcnt(0)
s_add_u32 s37, s35, 13
s_and_b32 s37, s37, 15
s_mul_i32 s37, s37, 16384
s_add_u32 m0, s39, 98304
s_nop 0
buffer_load_dwordx4 v3, s[8:11], s37 offen sc1 lds
s_load_dword s3, s[4:5], 6272
s_load_dword s3, s[4:5], 6336
s_load_dword s3, s[4:5], 6400
s_load_dword s3, s[4:5], 6464
s_load_dword s3, s[4:5], 6528
s_load_dword s3, s[4:5], 6592
buffer_load_dwordx4 v3, s[8:11], s37 offen offset:1024 sc1 lds
s_load_dword s3, s[4:5], 6656
s_load_dword s3, s[4:5], 6720
s_load_dword s3, s[4:5], 6784
s_load_dword s3, s[4:5], 6848
s_load_dword s3, s[4:5], 6912
s_load_dword s3, s[4:5], 6976
s_load_dword s3, s[4:5], 7040
buffer_load_dwordx4 v3, s[8:11], s37 offen offset:2048 sc1 lds
s_load_dword s3, s[4:5], 7104
s_bfe_u32 s61, s35, 0x10002
s_lshr_b32 s60, s35, 3
s_lshl_b32 s60, s60, 2
s_and_b32 s43, s35, 3
s_add_u32 s60, s60, s43
buffer_load_dwordx4 v3, s[8:11], s37 offen offset:3072 sc1 lds
s_lshl_b32 s43, s60, 8
s_add_u32 s28, s76, s43
s_addc_u32 s29, s77, 0
s_mov_b32 s30, 7338240
s_mov_b32 s31, 0x20000
s_mul_i32 s52, s61, 196608
s_mul_i32 s53, s61, 1572864
s_add_u32 s38, s35, 13
s_and_b32 s38, s38, 15
s_mul_i32 s38, s38, 458752
s_add_u32 m0, s40, 98304
s_nop 0
buffer_load_dwordx4 v4, s[12:15], s38 offen lds
s_mul_i32 s90, s61, 163840
s_branch Lov_10
.p2align 12
.fill 80, 4, 0xbf800000
Lst_10_0:
s_branch Lwr_155
Lst_10_1:
s_branch Lwr_166
s_nop 0
Lov_10:
s_mul_i32 s91, s61, 1310720
s_and_b32 s43, s35, 3
s_mul_i32 s32, s43, 3
s_mul_i32 s33, s43, 10
s_lshr_b32 s33, s33, 2
s_add_u32 m0, s40, 99328
s_nop 0
buffer_load_dwordx4 v5, s[12:15], s38 offen lds
s_lshl_b32 s51, s47, 11
s_lshl_b32 s44, s47, 15
v_lshrrev_b32 v122, 4, v1
v_lshlrev_b32 v123, 1, v122
v_and_b32 v23, 15, v1
v_xor_b32 v23, v23, v123
v_lshlrev_b32 v23, 4, v23
s_add_u32 m0, s40, 100352
s_add_u32 s38, s38, 57344
buffer_load_dwordx4 v4, s[12:15], s38 offen lds
v_mul_u32_u24 v122, 2048, v122
v_add_u32 v23, v23, v122
v_add_u32 v23, s44, v23
v_xor_b32 v24, 128, v23
v_add_u32 v24, 8192, v24
s_lshl_b32 s43, s60, 2
s_add_u32 m0, s40, 101376
s_nop 0
buffer_load_dwordx4 v5, s[12:15], s38 offen lds
s_lshl_b32 s44, s61, 1
s_add_u32 s43, s43, s44
s_add_u32 s43, s43, s63
s_lshl_b32 s43, s43, 13
s_lshl_b32 s44, s62, 12
s_add_u32 s50, s43, s44
v_add_u32 v17, s44, v2
s_add_u32 m0, s40, 102400
s_add_u32 s38, s38, 57344
buffer_load_dwordx4 v4, s[12:15], s38 offen lds
v_add_u32 v18, 0x10000, v17
v_add_u32 v19, 0x20000, v17
v_lshrrev_b32 v122, 2, v1
v_and_b32 v123, 7, v122
v_mul_u32_u24 v122, 256, v122
v_lshl_add_u32 v122, v123, 5, v122
s_add_u32 m0, s40, 103424
s_nop 0
buffer_load_dwordx4 v5, s[12:15], s38 offen lds
v_and_b32 v123, 3, v1
v_lshl_add_u32 v9, v123, 3, v122
s_lshl_b32 s43, s61, 7
s_lshl_b32 s44, s63, 6
s_add_u32 s43, s43, s44
v_xor_b32 v9, s43, v9
v_xor_b32 v10, 32, v9
s_add_u32 m0, s40, 104448
s_add_u32 s38, s38, 57344
buffer_load_dwordx4 v4, s[12:15], s38 offen lds
s_add_u32 m0, s40, 105472
s_nop 0
buffer_load_dwordx4 v5, s[12:15], s38 offen lds
s_waitcnt vmcnt(12)
s_barrier
buffer_load_dwordx4 v[160:163], v2, s[8:11], s50 offen offset:0 sc1
v_xor_b32 v11, 128, v9
v_xor_b32 v12, 128, v10
v_add_u32 v13, 65536, v9
buffer_load_dwordx4 v[164:167], v2, s[8:11], s50 offen offset:1024 sc1
v_add_u32 v14, 65536, v10
v_add_u32 v15, 65536, v11
v_add_u32 v16, 65536, v12
v_add_u32 v25, 131072, v9
buffer_load_dwordx4 v[168:171], v2, s[8:11], s50 offen offset:2048 sc1
v_add_u32 v26, 131072, v10
v_add_u32 v27, 131072, v11
v_add_u32 v28, 131072, v12
v_lshrrev_b32 v122, 2, v1
buffer_load_dwordx4 v[172:175], v2, s[8:11], s50 offen offset:3072 sc1
v_bfe_u32 v123, v122, 1, 2
v_mul_u32_u24 v122, 128, v122
v_lshl_add_u32 v122, v123, 5, v122
s_add_u32 s37, s35, 14
s_and_b32 s37, s37, 15
s_mul_i32 s37, s37, 16384
s_add_u32 m0, s39, 0
s_nop 0
buffer_load_dwordx4 v3, s[8:11], s37 offen sc1 lds
v_and_b32 v123, 3, v1
v_lshl_add_u32 v224, v123, 3, v122
v_xor_b32 v224, s44, v224
v_xor_b32 v225, 32, v224
buffer_load_dwordx4 v3, s[8:11], s37 offen offset:1024 sc1 lds
v_add_u32 v226, 65536, v224
v_add_u32 v227, 65536, v225
v_add_u32 v228, 131072, v224
v_add_u32 v229, 131072, v225
buffer_load_dwordx4 v3, s[8:11], s37 offen offset:2048 sc1 lds
s_add_u32 s84, s82, 33554432
s_addc_u32 s85, s83, 0
s_mov_b32 s86, 4194304
s_mov_b32 s87, 0x20000
buffer_load_dwordx4 v3, s[8:11], s37 offen offset:3072 sc1 lds
s_xor_b32 s43, s2, 2
s_lshl_b32 s44, s43, 2
s_add_u32 s44, s44, s47
s_add_u32 s38, s35, 14
s_and_b32 s38, s38, 15
s_mul_i32 s38, s38, 458752
s_add_u32 m0, s40, 0
s_nop 0
buffer_load_dwordx4 v4, s[12:15], s38 offen lds
s_lshl_b32 s45, s44, 12
s_lshl_b32 s46, s2, 2
s_add_u32 s46, s46, s47
s_lshl_b32 s46, s46, 12
s_add_u32 m0, s40, 1024
s_nop 0
buffer_load_dwordx4 v5, s[12:15], s38 offen lds
s_lshl_b32 s43, s34, 18
s_lshl_b32 s42, s60, 8
s_add_u32 s43, s43, s42
s_lshl_b32 s42, s61, 7
s_add_u32 m0, s40, 2048
s_add_u32 s38, s38, 57344
buffer_load_dwordx4 v4, s[12:15], s38 offen lds
s_add_u32 s43, s43, s42
s_lshl_b32 s42, s63, 6
s_add_u32 s43, s43, s42
s_add_u32 m0, s40, 3072
s_nop 0
buffer_load_dwordx4 v5, s[12:15], s38 offen lds
s_add_u32 s20, s78, s43
s_addc_u32 s21, s79, 0
s_mov_b32 s22, 260160
s_mov_b32 s23, 0x20000
s_add_u32 m0, s40, 4096
s_add_u32 s38, s38, 57344
buffer_load_dwordx4 v4, s[12:15], s38 offen lds
v_and_b32 v230, 15, v1
v_lshlrev_b32 v230, 12, v230
v_bfe_u32 v231, v1, 4, 1
v_lshl_add_u32 v230, v231, 5, v230
s_add_u32 m0, s40, 5120
s_nop 0
buffer_load_dwordx4 v5, s[12:15], s38 offen lds
v_bfe_u32 v231, v1, 5, 1
v_lshl_add_u32 v230, v231, 4, v230
s_lshl_b32 s54, s62, 17
s_add_u32 s55, s54, 65536
s_add_u32 m0, s40, 6144
s_add_u32 s38, s38, 57344
buffer_load_dwordx4 v4, s[12:15], s38 offen lds
s_add_u32 m0, s40, 7168
s_nop 0
buffer_load_dwordx4 v5, s[12:15], s38 offen lds
s_waitcnt vmcnt(16)
s_barrier
s_cmp_eq_u32 s47, 3
s_cbranch_scc0 Lw_116
s_lshl_b32 s92, s34, 7
s_add_u32 s92, s92, 28315648
s_load_dword s93, s[82:83], s92 glc
Lw_116:
s_add_u32 s37, s35, 15
s_and_b32 s37, s37, 15
s_mul_i32 s37, s37, 16384
s_add_u32 m0, s39, 49152
s_nop 0
buffer_load_dwordx4 v3, s[8:11], s37 offen sc1 lds
buffer_load_dwordx4 v3, s[8:11], s37 offen offset:1024 sc1 lds
buffer_load_dwordx4 v3, s[8:11], s37 offen offset:2048 sc1 lds
buffer_load_dwordx4 v3, s[8:11], s37 offen offset:3072 sc1 lds
s_add_u32 s38, s35, 15
s_and_b32 s38, s38, 15
s_mul_i32 s38, s38, 458752
s_add_u32 m0, s40, 49152
s_nop 0
buffer_load_dwordx4 v4, s[12:15], s38 offen lds
s_add_u32 m0, s40, 50176
s_nop 0
buffer_load_dwordx4 v5, s[12:15], s38 offen lds
s_add_u32 m0, s40, 51200
s_add_u32 s38, s38, 57344
buffer_load_dwordx4 v4, s[12:15], s38 offen lds
s_add_u32 m0, s40, 52224
s_nop 0
buffer_load_dwordx4 v5, s[12:15], s38 offen lds
s_add_u32 m0, s40, 53248
s_add_u32 s38, s38, 57344
buffer_load_dwordx4 v4, s[12:15], s38 offen lds
s_add_u32 m0, s40, 54272
s_nop 0
buffer_load_dwordx4 v5, s[12:15], s38 offen lds
s_add_u32 m0, s40, 55296
s_add_u32 s38, s38, 57344
buffer_load_dwordx4 v4, s[12:15], s38 offen lds
s_add_u32 m0, s40, 56320
s_nop 0
buffer_load_dwordx4 v5, s[12:15], s38 offen lds
s_waitcnt vmcnt(12)
s_cmp_eq_u32 s47, 3
s_cbranch_scc0 Lw_117
s_mov_b32 s41, 0x40000
s_branch Lpchk_120
Lpoll_118:
s_load_dword s93, s[82:83], s92 glc
Lpchk_120:
s_waitcnt lgkmcnt(0)
s_cmp_eq_u32 s93, 16
s_cbranch_scc1 Lpok_119
s_sub_u32 s41, s41, 1
s_cmp_lg_u32 s41, 0
s_cbranch_scc1 Lpoll_118
Lpok_119:
Lw_117:
s_barrier
s_add_u32 s37, s52, 524288
s_add_u32 m0, s39, 98304
s_nop 0
buffer_load_dwordx4 v3, s[24:27], s37 offen sc1 lds
v_lshlrev_b32 v128, 16, v160
v_and_b32 v129, 0xffff0000, v160
v_lshlrev_b32 v130, 16, v161
v_and_b32 v131, 0xffff0000, v161
v_lshlrev_b32 v132, 16, v162
buffer_load_dwordx4 v3, s[24:27], s37 offen offset:1024 sc1 lds
v_and_b32 v133, 0xffff0000, v162
v_lshlrev_b32 v134, 16, v163
v_and_b32 v135, 0xffff0000, v163
v_lshlrev_b32 v136, 16, v164
v_and_b32 v137, 0xffff0000, v164
buffer_load_dwordx4 v3, s[24:27], s37 offen offset:2048 sc1 lds
v_lshlrev_b32 v138, 16, v165
v_and_b32 v139, 0xffff0000, v165
v_lshlrev_b32 v140, 16, v166
v_and_b32 v141, 0xffff0000, v166
v_lshlrev_b32 v142, 16, v167
v_and_b32 v143, 0xffff0000, v167
buffer_load_dwordx4 v3, s[24:27], s37 offen offset:3072 sc1 lds
v_lshlrev_b32 v144, 16, v168
v_and_b32 v145, 0xffff0000, v168
v_lshlrev_b32 v146, 16, v169
v_and_b32 v147, 0xffff0000, v169
v_lshlrev_b32 v148, 16, v170
s_add_u32 s38, s53, 4194304
s_add_u32 m0, s39, 114688
s_nop 0
buffer_load_dwordx4 v23, s[28:31], s38 offen lds
v_and_b32 v149, 0xffff0000, v170
v_lshlrev_b32 v150, 16, v171
v_and_b32 v151, 0xffff0000, v171
v_lshlrev_b32 v152, 16, v172
v_and_b32 v153, 0xffff0000, v172
s_add_u32 m0, s39, 115712
s_nop 0
buffer_load_dwordx4 v24, s[28:31], s38 offen lds
v_lshlrev_b32 v154, 16, v173
v_and_b32 v155, 0xffff0000, v173
v_lshlrev_b32 v156, 16, v174
v_and_b32 v157, 0xffff0000, v174
v_lshlrev_b32 v158, 16, v175
v_and_b32 v159, 0xffff0000, v175
s_add_u32 m0, s39, 116736
s_add_u32 s38, s38, 16384
buffer_load_dwordx4 v23, s[28:31], s38 offen lds
s_add_u32 m0, s39, 117760
s_nop 0
buffer_load_dwordx4 v24, s[28:31], s38 offen lds
s_waitcnt vmcnt(8)
s_barrier
s_add_u32 s37, s52, 540672
s_add_u32 m0, s39, 131072
s_nop 0
buffer_load_dwordx4 v3, s[24:27], s37 offen sc1 lds
buffer_load_dwordx4 v3, s[24:27], s37 offen offset:1024 sc1 lds
buffer_load_dwordx4 v3, s[24:27], s37 offen offset:2048 sc1 lds
buffer_load_dwordx4 v3, s[24:27], s37 offen offset:3072 sc1 lds
s_add_u32 s38, s53, 4325376
s_add_u32 m0, s39, 0
s_nop 0
buffer_load_dwordx4 v23, s[28:31], s38 offen lds
s_add_u32 m0, s39, 1024
s_nop 0
buffer_load_dwordx4 v24, s[28:31], s38 offen lds
s_add_u32 m0, s39, 2048
s_add_u32 s38, s38, 16384
buffer_load_dwordx4 v23, s[28:31], s38 offen lds
s_add_u32 m0, s39, 3072
s_nop 0
buffer_load_dwordx4 v24, s[28:31], s38 offen lds
s_add_u32 s37, s52, 557056
s_add_u32 m0, s39, 16384
s_nop 0
buffer_load_dwordx4 v3, s[24:27], s37 offen sc1 lds
buffer_load_dwordx4 v3, s[24:27], s37 offen offset:1024 sc1 lds
buffer_load_dwordx4 v3, s[24:27], s37 offen offset:2048 sc1 lds
buffer_load_dwordx4 v3, s[24:27], s37 offen offset:3072 sc1 lds
s_add_u32 s38, s53, 4456448
s_add_u32 m0, s39, 32768
s_nop 0
buffer_load_dwordx4 v23, s[28:31], s38 offen lds
s_add_u32 m0, s39, 33792
s_nop 0
buffer_load_dwordx4 v24, s[28:31], s38 offen lds
s_add_u32 m0, s39, 34816
s_add_u32 s38, s38, 16384
buffer_load_dwordx4 v23, s[28:31], s38 offen lds
s_add_u32 m0, s39, 35840
s_nop 0
buffer_load_dwordx4 v24, s[28:31], s38 offen lds
s_waitcnt vmcnt(16)
s_barrier
ds_read_b128 v[32:35], v18 offset:32768
ds_read_b64_tr_b16 v[48:49], v13 offset:49152
ds_read_b64_tr_b16 v[50:51], v13 offset:53248
ds_read_b64_tr_b16 v[52:53], v14 offset:49152
ds_read_b64_tr_b16 v[54:55], v14 offset:53248
ds_read_b64_tr_b16 v[56:57], v15 offset:49152
ds_read_b64_tr_b16 v[58:59], v15 offset:53248
ds_read_b64_tr_b16 v[60:61], v16 offset:49152
ds_read_b64_tr_b16 v[62:63], v16 offset:53248
ds_read_b128 v[36:39], v18 offset:33792
ds_read_b128 v[40:43], v18 offset:34816
ds_read_b128 v[44:47], v18 offset:35840
ds_read_b128 v[64:67], v18 offset:40960
ds_read_b64_tr_b16 v[80:81], v13 offset:57344
ds_read_b64_tr_b16 v[82:83], v13 offset:61440
ds_read_b64_tr_b16 v[84:85], v14 offset:57344
ds_read_b64_tr_b16 v[86:87], v14 offset:61440
ds_read_b64_tr_b16 v[88:89], v15 offset:57344
ds_read_b64_tr_b16 v[90:91], v15 offset:61440
ds_read_b64_tr_b16 v[92:93], v16 offset:57344
ds_read_b64_tr_b16 v[94:95], v16 offset:61440
ds_read_b128 v[68:71], v18 offset:41984
ds_read_b128 v[72:75], v18 offset:43008
ds_read_b128 v[76:79], v18 offset:44032
s_add_u32 s37, s52, 573440
s_add_u32 m0, s39, 49152
s_nop 0
buffer_load_dwordx4 v3, s[24:27], s37 offen sc1 lds
buffer_load_dwordx4 v3, s[24:27], s37 offen offset:1024 sc1 lds
buffer_load_dwordx4 v3, s[24:27], s37 offen offset:2048 sc1 lds
buffer_load_dwordx4 v3, s[24:27], s37 offen offset:3072 sc1 lds
s_add_u32 s38, s53, 4587520
s_add_u32 m0, s39, 65536
s_nop 0
buffer_load_dwordx4 v23, s[28:31], s38 offen lds
s_add_u32 m0, s39, 66560
s_nop 0
buffer_load_dwordx4 v24, s[28:31], s38 offen lds
s_add_u32 m0, s39, 67584
s_add_u32 s38, s38, 16384
buffer_load_dwordx4 v23, s[28:31], s38 offen lds
s_add_u32 m0, s39, 68608
s_nop 0
buffer_load_dwordx4 v24, s[28:31], s38 offen lds
s_waitcnt vmcnt(16)
s_waitcnt lgkmcnt(0)
s_barrier
v_mfma_f32_16x16x32_bf16 v[128:131], v[48:51], v[32:35], v[128:131]
ds_read_b128 v[96:99], v19 offset:0
v_mfma_f32_16x16x32_bf16 v[132:135], v[52:55], v[32:35], v[132:135]
ds_read_b64_tr_b16 v[112:113], v9 offset:0
v_mfma_f32_16x16x32_bf16 v[160:163], v[56:59], v[32:35], 0
ds_read_b64_tr_b16 v[114:115], v9 offset:4096
v_mfma_f32_16x16x32_bf16 v[164:167], v[60:63], v[32:35], 0
ds_read_b64_tr_b16 v[116:117], v10 offset:0
v_mfma_f32_16x16x32_bf16 v[172:175], v[60:63], v[36:39], 0
ds_read_b64_tr_b16 v[118:119], v10 offset:4096
v_mfma_f32_16x16x32_bf16 v[168:171], v[56:59], v[36:39], 0
ds_read_b64_tr_b16 v[120:121], v11 offset:0
v_mfma_f32_16x16x32_bf16 v[140:143], v[52:55], v[36:39], v[140:143]
ds_read_b64_tr_b16 v[122:123], v11 offset:4096
v_mfma_f32_16x16x32_bf16 v[136:139], v[48:51], v[36:39], v[136:139]
ds_read_b64_tr_b16 v[124:125], v12 offset:0
v_mfma_f32_16x16x32_bf16 v[144:147], v[48:51], v[40:43], v[144:147]
ds_read_b64_tr_b16 v[126:127], v12 offset:4096
v_mfma_f32_16x16x32_bf16 v[148:151], v[52:55], v[40:43], v[148:151]
ds_read_b128 v[100:103], v19 offset:1024
v_mfma_f32_16x16x32_bf16 v[176:179], v[56:59], v[40:43], 0
ds_read_b128 v[104:107], v19 offset:2048
v_mfma_f32_16x16x32_bf16 v[180:183], v[60:63], v[40:43], 0
ds_read_b128 v[108:111], v19 offset:3072
v_mfma_f32_16x16x32_bf16 v[188:191], v[60:63], v[44:47], 0
ds_read_b128 v[192:195], v19 offset:8192
v_mfma_f32_16x16x32_bf16 v[184:187], v[56:59], v[44:47], 0
ds_read_b64_tr_b16 v[208:209], v9 offset:8192
v_mfma_f32_16x16x32_bf16 v[156:159], v[52:55], v[44:47], v[156:159]
ds_read_b64_tr_b16 v[210:211], v9 offset:12288
v_mfma_f32_16x16x32_bf16 v[152:155], v[48:51], v[44:47], v[152:155]
ds_read_b64_tr_b16 v[212:213], v10 offset:8192
v_mfma_f32_16x16x32_bf16 v[128:131], v[80:83], v[64:67], v[128:131]
ds_read_b64_tr_b16 v[214:215], v10 offset:12288
v_mfma_f32_16x16x32_bf16 v[132:135], v[84:87], v[64:67], v[132:135]
ds_read_b64_tr_b16 v[216:217], v11 offset:8192
v_mfma_f32_16x16x32_bf16 v[160:163], v[88:91], v[64:67], v[160:163]
ds_read_b64_tr_b16 v[218:219], v11 offset:12288
v_mfma_f32_16x16x32_bf16 v[164:167], v[92:95], v[64:67], v[164:167]
ds_read_b64_tr_b16 v[220:221], v12 offset:8192
v_mfma_f32_16x16x32_bf16 v[172:175], v[92:95], v[68:71], v[172:175]
ds_read_b64_tr_b16 v[222:223], v12 offset:12288
v_mfma_f32_16x16x32_bf16 v[168:171], v[88:91], v[68:71], v[168:171]
ds_read_b128 v[196:199], v19 offset:9216
v_mfma_f32_16x16x32_bf16 v[140:143], v[84:87], v[68:71], v[140:143]
ds_read_b128 v[200:203], v19 offset:10240
v_mfma_f32_16x16x32_bf16 v[136:139], v[80:83], v[68:71], v[136:139]
ds_read_b128 v[204:207], v19 offset:11264
v_mfma_f32_16x16x32_bf16 v[144:147], v[80:83], v[72:75], v[144:147]
v_mfma_f32_16x16x32_bf16 v[148:151], v[84:87], v[72:75], v[148:151]
v_mfma_f32_16x16x32_bf16 v[176:179], v[88:91], v[72:75], v[176:179]
v_mfma_f32_16x16x32_bf16 v[180:183], v[92:95], v[72:75], v[180:183]
v_mfma_f32_16x16x32_bf16 v[188:191], v[92:95], v[76:79], v[188:191]
v_mfma_f32_16x16x32_bf16 v[184:187], v[88:91], v[76:79], v[184:187]
v_mfma_f32_16x16x32_bf16 v[156:159], v[84:87], v[76:79], v[156:159]
v_mfma_f32_16x16x32_bf16 v[152:155], v[80:83], v[76:79], v[152:155]
s_mov_b32 s41, 2
Lk4_121:
s_waitcnt vmcnt(8)
s_waitcnt lgkmcnt(0)
s_barrier
v_mfma_f32_16x16x32_bf16 v[128:131], v[112:115], v[96:99], v[128:131]
ds_read_b128 v[32:35], v17 offset:16384
v_mfma_f32_16x16x32_bf16 v[132:135], v[116:119], v[96:99], v[132:135]
ds_read_b64_tr_b16 v[48:49], v9 offset:32768
v_mfma_f32_16x16x32_bf16 v[160:163], v[120:123], v[96:99], v[160:163]
ds_read_b64_tr_b16 v[50:51], v9 offset:36864
v_mfma_f32_16x16x32_bf16 v[164:167], v[124:127], v[96:99], v[164:167]
ds_read_b64_tr_b16 v[52:53], v10 offset:32768
v_mfma_f32_16x16x32_bf16 v[172:175], v[124:127], v[100:103], v[172:175]
ds_read_b64_tr_b16 v[54:55], v10 offset:36864
v_mfma_f32_16x16x32_bf16 v[168:171], v[120:123], v[100:103], v[168:171]
ds_read_b64_tr_b16 v[56:57], v11 offset:32768
v_mfma_f32_16x16x32_bf16 v[140:143], v[116:119], v[100:103], v[140:143]
ds_read_b64_tr_b16 v[58:59], v11 offset:36864
v_mfma_f32_16x16x32_bf16 v[136:139], v[112:115], v[100:103], v[136:139]
ds_read_b64_tr_b16 v[60:61], v12 offset:32768
v_mfma_f32_16x16x32_bf16 v[144:147], v[112:115], v[104:107], v[144:147]
ds_read_b64_tr_b16 v[62:63], v12 offset:36864
v_mfma_f32_16x16x32_bf16 v[148:151], v[116:119], v[104:107], v[148:151]
ds_read_b128 v[36:39], v17 offset:17408
v_mfma_f32_16x16x32_bf16 v[176:179], v[120:123], v[104:107], v[176:179]
ds_read_b128 v[40:43], v17 offset:18432
v_mfma_f32_16x16x32_bf16 v[180:183], v[124:127], v[104:107], v[180:183]
ds_read_b128 v[44:47], v17 offset:19456
v_mfma_f32_16x16x32_bf16 v[188:191], v[124:127], v[108:111], v[188:191]
ds_read_b128 v[64:67], v17 offset:24576
v_mfma_f32_16x16x32_bf16 v[184:187], v[120:123], v[108:111], v[184:187]
ds_read_b64_tr_b16 v[80:81], v9 offset:40960
v_mfma_f32_16x16x32_bf16 v[156:159], v[116:119], v[108:111], v[156:159]
ds_read_b64_tr_b16 v[82:83], v9 offset:45056
v_mfma_f32_16x16x32_bf16 v[152:155], v[112:115], v[108:111], v[152:155]
ds_read_b64_tr_b16 v[84:85], v10 offset:40960
v_mfma_f32_16x16x32_bf16 v[128:131], v[208:211], v[192:195], v[128:131]
ds_read_b64_tr_b16 v[86:87], v10 offset:45056
v_mfma_f32_16x16x32_bf16 v[132:135], v[212:215], v[192:195], v[132:135]
ds_read_b64_tr_b16 v[88:89], v11 offset:40960
v_mfma_f32_16x16x32_bf16 v[160:163], v[216:219], v[192:195], v[160:163]
ds_read_b64_tr_b16 v[90:91], v11 offset:45056
v_mfma_f32_16x16x32_bf16 v[164:167], v[220:223], v[192:195], v[164:167]
ds_read_b64_tr_b16 v[92:93], v12 offset:40960
v_mfma_f32_16x16x32_bf16 v[172:175], v[220:223], v[196:199], v[172:175]
ds_read_b64_tr_b16 v[94:95], v12 offset:45056
v_mfma_f32_16x16x32_bf16 v[168:171], v[216:219], v[196:199], v[168:171]
ds_read_b128 v[68:71], v17 offset:25600
v_mfma_f32_16x16x32_bf16 v[140:143], v[212:215], v[196:199], v[140:143]
ds_read_b128 v[72:75], v17 offset:26624
v_mfma_f32_16x16x32_bf16 v[136:139], v[208:211], v[196:199], v[136:139]
ds_read_b128 v[76:79], v17 offset:27648
v_mfma_f32_16x16x32_bf16 v[144:147], v[208:211], v[200:203], v[144:147]
v_mfma_f32_16x16x32_bf16 v[148:151], v[212:215], v[200:203], v[148:151]
v_mfma_f32_16x16x32_bf16 v[176:179], v[216:219], v[200:203], v[176:179]
v_mfma_f32_16x16x32_bf16 v[180:183], v[220:223], v[200:203], v[180:183]
v_mfma_f32_16x16x32_bf16 v[188:191], v[220:223], v[204:207], v[188:191]
v_mfma_f32_16x16x32_bf16 v[184:187], v[216:219], v[204:207], v[184:187]
v_mfma_f32_16x16x32_bf16 v[156:159], v[212:215], v[204:207], v[156:159]
v_mfma_f32_16x16x32_bf16 v[152:155], v[208:211], v[204:207], v[152:155]
s_waitcnt vmcnt(0)
s_waitcnt lgkmcnt(0)
s_barrier
v_mfma_f32_16x16x32_bf16 v[128:131], v[48:51], v[32:35], v[128:131]
ds_read_b128 v[96:99], v17 offset:49152
v_mfma_f32_16x16x32_bf16 v[132:135], v[52:55], v[32:35], v[132:135]
ds_read_b64_tr_b16 v[112:113], v13 offset:0
v_mfma_f32_16x16x32_bf16 v[160:163], v[56:59], v[32:35], v[160:163]
ds_read_b64_tr_b16 v[114:115], v13 offset:4096
v_mfma_f32_16x16x32_bf16 v[164:167], v[60:63], v[32:35], v[164:167]
ds_read_b64_tr_b16 v[116:117], v14 offset:0
v_mfma_f32_16x16x32_bf16 v[172:175], v[60:63], v[36:39], v[172:175]
ds_read_b64_tr_b16 v[118:119], v14 offset:4096
v_mfma_f32_16x16x32_bf16 v[168:171], v[56:59], v[36:39], v[168:171]
ds_read_b64_tr_b16 v[120:121], v15 offset:0
v_mfma_f32_16x16x32_bf16 v[140:143], v[52:55], v[36:39], v[140:143]
ds_read_b64_tr_b16 v[122:123], v15 offset:4096
v_mfma_f32_16x16x32_bf16 v[136:139], v[48:51], v[36:39], v[136:139]
ds_read_b64_tr_b16 v[124:125], v16 offset:0
v_mfma_f32_16x16x32_bf16 v[144:147], v[48:51], v[40:43], v[144:147]
ds_read_b64_tr_b16 v[126:127], v16 offset:4096
v_mfma_f32_16x16x32_bf16 v[148:151], v[52:55], v[40:43], v[148:151]
ds_read_b128 v[100:103], v17 offset:50176
v_mfma_f32_16x16x32_bf16 v[176:179], v[56:59], v[40:43], v[176:179]
ds_read_b128 v[104:107], v17 offset:51200
v_mfma_f32_16x16x32_bf16 v[180:183], v[60:63], v[40:43], v[180:183]
ds_read_b128 v[108:111], v17 offset:52224
v_mfma_f32_16x16x32_bf16 v[188:191], v[60:63], v[44:47], v[188:191]
ds_read_b128 v[192:195], v17 offset:57344
v_mfma_f32_16x16x32_bf16 v[184:187], v[56:59], v[44:47], v[184:187]
ds_read_b64_tr_b16 v[208:209], v13 offset:8192
v_mfma_f32_16x16x32_bf16 v[156:159], v[52:55], v[44:47], v[156:159]
ds_read_b64_tr_b16 v[210:211], v13 offset:12288
v_mfma_f32_16x16x32_bf16 v[152:155], v[48:51], v[44:47], v[152:155]
ds_read_b64_tr_b16 v[212:213], v14 offset:8192
v_mfma_f32_16x16x32_bf16 v[128:131], v[80:83], v[64:67], v[128:131]
ds_read_b64_tr_b16 v[214:215], v14 offset:12288
v_mfma_f32_16x16x32_bf16 v[132:135], v[84:87], v[64:67], v[132:135]
ds_read_b64_tr_b16 v[216:217], v15 offset:8192
v_mfma_f32_16x16x32_bf16 v[160:163], v[88:91], v[64:67], v[160:163]
ds_read_b64_tr_b16 v[218:219], v15 offset:12288
v_mfma_f32_16x16x32_bf16 v[164:167], v[92:95], v[64:67], v[164:167]
ds_read_b64_tr_b16 v[220:221], v16 offset:8192
v_mfma_f32_16x16x32_bf16 v[172:175], v[92:95], v[68:71], v[172:175]
ds_read_b64_tr_b16 v[222:223], v16 offset:12288
v_mfma_f32_16x16x32_bf16 v[168:171], v[88:91], v[68:71], v[168:171]
ds_read_b128 v[196:199], v17 offset:58368
v_mfma_f32_16x16x32_bf16 v[140:143], v[84:87], v[68:71], v[140:143]
ds_read_b128 v[200:203], v17 offset:59392
v_mfma_f32_16x16x32_bf16 v[136:139], v[80:83], v[68:71], v[136:139]
ds_read_b128 v[204:207], v17 offset:60416
v_mfma_f32_16x16x32_bf16 v[144:147], v[80:83], v[72:75], v[144:147]
v_mfma_f32_16x16x32_bf16 v[148:151], v[84:87], v[72:75], v[148:151]
v_mfma_f32_16x16x32_bf16 v[176:179], v[88:91], v[72:75], v[176:179]
v_mfma_f32_16x16x32_bf16 v[180:183], v[92:95], v[72:75], v[180:183]
v_mfma_f32_16x16x32_bf16 v[188:191], v[92:95], v[76:79], v[188:191]
v_mfma_f32_16x16x32_bf16 v[184:187], v[88:91], v[76:79], v[184:187]
v_mfma_f32_16x16x32_bf16 v[156:159], v[84:87], v[76:79], v[156:159]
v_mfma_f32_16x16x32_bf16 v[152:155], v[80:83], v[76:79], v[152:155]
s_waitcnt lgkmcnt(0)
s_barrier
v_mfma_f32_16x16x32_bf16 v[128:131], v[112:115], v[96:99], v[128:131]
ds_read_b128 v[32:35], v18 offset:16384
v_mfma_f32_16x16x32_bf16 v[132:135], v[116:119], v[96:99], v[132:135]
ds_read_b64_tr_b16 v[48:49], v25 offset:16384
v_mfma_f32_16x16x32_bf16 v[160:163], v[120:123], v[96:99], v[160:163]
ds_read_b64_tr_b16 v[50:51], v25 offset:20480
v_mfma_f32_16x16x32_bf16 v[164:167], v[124:127], v[96:99], v[164:167]
ds_read_b64_tr_b16 v[52:53], v26 offset:16384
v_mfma_f32_16x16x32_bf16 v[172:175], v[124:127], v[100:103], v[172:175]
ds_read_b64_tr_b16 v[54:55], v26 offset:20480
v_mfma_f32_16x16x32_bf16 v[168:171], v[120:123], v[100:103], v[168:171]
ds_read_b64_tr_b16 v[56:57], v27 offset:16384
v_mfma_f32_16x16x32_bf16 v[140:143], v[116:119], v[100:103], v[140:143]
ds_read_b64_tr_b16 v[58:59], v27 offset:20480
s_branch Lov_11
.p2align 12
.fill 80, 4, 0xbf800000
Lst_11_0:
s_branch Lwr_156
Lst_11_1:
s_branch Lst_15_0
s_nop 0
Lov_11:
v_mfma_f32_16x16x32_bf16 v[136:139], v[112:115], v[100:103], v[136:139]
ds_read_b64_tr_b16 v[60:61], v28 offset:16384
v_mfma_f32_16x16x32_bf16 v[144:147], v[112:115], v[104:107], v[144:147]
ds_read_b64_tr_b16 v[62:63], v28 offset:20480
v_mfma_f32_16x16x32_bf16 v[148:151], v[116:119], v[104:107], v[148:151]
ds_read_b128 v[36:39], v18 offset:17408
v_mfma_f32_16x16x32_bf16 v[176:179], v[120:123], v[104:107], v[176:179]
ds_read_b128 v[40:43], v18 offset:18432
v_mfma_f32_16x16x32_bf16 v[180:183], v[124:127], v[104:107], v[180:183]
ds_read_b128 v[44:47], v18 offset:19456
v_mfma_f32_16x16x32_bf16 v[188:191], v[124:127], v[108:111], v[188:191]
ds_read_b128 v[64:67], v18 offset:24576
v_mfma_f32_16x16x32_bf16 v[184:187], v[120:123], v[108:111], v[184:187]
ds_read_b64_tr_b16 v[80:81], v25 offset:24576
v_mfma_f32_16x16x32_bf16 v[156:159], v[116:119], v[108:111], v[156:159]
ds_read_b64_tr_b16 v[82:83], v25 offset:28672
v_mfma_f32_16x16x32_bf16 v[152:155], v[112:115], v[108:111], v[152:155]
ds_read_b64_tr_b16 v[84:85], v26 offset:24576
v_mfma_f32_16x16x32_bf16 v[128:131], v[208:211], v[192:195], v[128:131]
ds_read_b64_tr_b16 v[86:87], v26 offset:28672
v_mfma_f32_16x16x32_bf16 v[132:135], v[212:215], v[192:195], v[132:135]
ds_read_b64_tr_b16 v[88:89], v27 offset:24576
v_mfma_f32_16x16x32_bf16 v[160:163], v[216:219], v[192:195], v[160:163]
ds_read_b64_tr_b16 v[90:91], v27 offset:28672
v_mfma_f32_16x16x32_bf16 v[164:167], v[220:223], v[192:195], v[164:167]
ds_read_b64_tr_b16 v[92:93], v28 offset:24576
v_mfma_f32_16x16x32_bf16 v[172:175], v[220:223], v[196:199], v[172:175]
ds_read_b64_tr_b16 v[94:95], v28 offset:28672
v_mfma_f32_16x16x32_bf16 v[168:171], v[216:219], v[196:199], v[168:171]
ds_read_b128 v[68:71], v18 offset:25600
v_mfma_f32_16x16x32_bf16 v[140:143], v[212:215], v[196:199], v[140:143]
ds_read_b128 v[72:75], v18 offset:26624
v_mfma_f32_16x16x32_bf16 v[136:139], v[208:211], v[196:199], v[136:139]
ds_read_b128 v[76:79], v18 offset:27648
v_mfma_f32_16x16x32_bf16 v[144:147], v[208:211], v[200:203], v[144:147]
v_mfma_f32_16x16x32_bf16 v[148:151], v[212:215], v[200:203], v[148:151]
v_mfma_f32_16x16x32_bf16 v[176:179], v[216:219], v[200:203], v[176:179]
v_mfma_f32_16x16x32_bf16 v[180:183], v[220:223], v[200:203], v[180:183]
v_mfma_f32_16x16x32_bf16 v[188:191], v[220:223], v[204:207], v[188:191]
v_mfma_f32_16x16x32_bf16 v[184:187], v[216:219], v[204:207], v[184:187]
v_mfma_f32_16x16x32_bf16 v[156:159], v[212:215], v[204:207], v[156:159]
v_mfma_f32_16x16x32_bf16 v[152:155], v[208:211], v[204:207], v[152:155]
s_waitcnt lgkmcnt(0)
s_barrier
v_mfma_f32_16x16x32_bf16 v[128:131], v[48:51], v[32:35], v[128:131]
ds_read_b128 v[96:99], v18 offset:32768
v_mfma_f32_16x16x32_bf16 v[132:135], v[52:55], v[32:35], v[132:135]
ds_read_b64_tr_b16 v[112:113], v13 offset:49152
v_mfma_f32_16x16x32_bf16 v[160:163], v[56:59], v[32:35], v[160:163]
ds_read_b64_tr_b16 v[114:115], v13 offset:53248
v_mfma_f32_16x16x32_bf16 v[164:167], v[60:63], v[32:35], v[164:167]
ds_read_b64_tr_b16 v[116:117], v14 offset:49152
v_mfma_f32_16x16x32_bf16 v[172:175], v[60:63], v[36:39], v[172:175]
ds_read_b64_tr_b16 v[118:119], v14 offset:53248
v_mfma_f32_16x16x32_bf16 v[168:171], v[56:59], v[36:39], v[168:171]
ds_read_b64_tr_b16 v[120:121], v15 offset:49152
v_mfma_f32_16x16x32_bf16 v[140:143], v[52:55], v[36:39], v[140:143]
ds_read_b64_tr_b16 v[122:123], v15 offset:53248
v_mfma_f32_16x16x32_bf16 v[136:139], v[48:51], v[36:39], v[136:139]
ds_read_b64_tr_b16 v[124:125], v16 offset:49152
v_mfma_f32_16x16x32_bf16 v[144:147], v[48:51], v[40:43], v[144:147]
ds_read_b64_tr_b16 v[126:127], v16 offset:53248
v_mfma_f32_16x16x32_bf16 v[148:151], v[52:55], v[40:43], v[148:151]
ds_read_b128 v[100:103], v18 offset:33792
v_mfma_f32_16x16x32_bf16 v[176:179], v[56:59], v[40:43], v[176:179]
ds_read_b128 v[104:107], v18 offset:34816
v_mfma_f32_16x16x32_bf16 v[180:183], v[60:63], v[40:43], v[180:183]
ds_read_b128 v[108:111], v18 offset:35840
v_mfma_f32_16x16x32_bf16 v[188:191], v[60:63], v[44:47], v[188:191]
ds_read_b128 v[192:195], v18 offset:40960
v_mfma_f32_16x16x32_bf16 v[184:187], v[56:59], v[44:47], v[184:187]
ds_read_b64_tr_b16 v[208:209], v13 offset:57344
v_mfma_f32_16x16x32_bf16 v[156:159], v[52:55], v[44:47], v[156:159]
ds_read_b64_tr_b16 v[210:211], v13 offset:61440
v_mfma_f32_16x16x32_bf16 v[152:155], v[48:51], v[44:47], v[152:155]
ds_read_b64_tr_b16 v[212:213], v14 offset:57344
v_mfma_f32_16x16x32_bf16 v[128:131], v[80:83], v[64:67], v[128:131]
ds_read_b64_tr_b16 v[214:215], v14 offset:61440
v_mfma_f32_16x16x32_bf16 v[132:135], v[84:87], v[64:67], v[132:135]
ds_read_b64_tr_b16 v[216:217], v15 offset:57344
v_mfma_f32_16x16x32_bf16 v[160:163], v[88:91], v[64:67], v[160:163]
ds_read_b64_tr_b16 v[218:219], v15 offset:61440
v_mfma_f32_16x16x32_bf16 v[164:167], v[92:95], v[64:67], v[164:167]
ds_read_b64_tr_b16 v[220:221], v16 offset:57344
v_mfma_f32_16x16x32_bf16 v[172:175], v[92:95], v[68:71], v[172:175]
ds_read_b64_tr_b16 v[222:223], v16 offset:61440
v_mfma_f32_16x16x32_bf16 v[168:171], v[88:91], v[68:71], v[168:171]
ds_read_b128 v[196:199], v18 offset:41984
v_mfma_f32_16x16x32_bf16 v[140:143], v[84:87], v[68:71], v[140:143]
ds_read_b128 v[200:203], v18 offset:43008
v_mfma_f32_16x16x32_bf16 v[136:139], v[80:83], v[68:71], v[136:139]
ds_read_b128 v[204:207], v18 offset:44032
v_mfma_f32_16x16x32_bf16 v[144:147], v[80:83], v[72:75], v[144:147]
v_mfma_f32_16x16x32_bf16 v[148:151], v[84:87], v[72:75], v[148:151]
v_mfma_f32_16x16x32_bf16 v[176:179], v[88:91], v[72:75], v[176:179]
v_mfma_f32_16x16x32_bf16 v[180:183], v[92:95], v[72:75], v[180:183]
v_mfma_f32_16x16x32_bf16 v[188:191], v[92:95], v[76:79], v[188:191]
v_mfma_f32_16x16x32_bf16 v[184:187], v[88:91], v[76:79], v[184:187]
v_mfma_f32_16x16x32_bf16 v[156:159], v[84:87], v[76:79], v[156:159]
v_mfma_f32_16x16x32_bf16 v[152:155], v[80:83], v[76:79], v[152:155]
s_waitcnt lgkmcnt(0)
s_barrier
v_mfma_f32_16x16x32_bf16 v[128:131], v[112:115], v[96:99], v[128:131]
ds_read_b128 v[32:35], v19 offset:0
v_mfma_f32_16x16x32_bf16 v[132:135], v[116:119], v[96:99], v[132:135]
ds_read_b64_tr_b16 v[48:49], v9 offset:0
v_mfma_f32_16x16x32_bf16 v[160:163], v[120:123], v[96:99], v[160:163]
ds_read_b64_tr_b16 v[50:51], v9 offset:4096
v_mfma_f32_16x16x32_bf16 v[164:167], v[124:127], v[96:99], v[164:167]
ds_read_b64_tr_b16 v[52:53], v10 offset:0
v_mfma_f32_16x16x32_bf16 v[172:175], v[124:127], v[100:103], v[172:175]
ds_read_b64_tr_b16 v[54:55], v10 offset:4096
v_mfma_f32_16x16x32_bf16 v[168:171], v[120:123], v[100:103], v[168:171]
ds_read_b64_tr_b16 v[56:57], v11 offset:0
v_mfma_f32_16x16x32_bf16 v[140:143], v[116:119], v[100:103], v[140:143]
ds_read_b64_tr_b16 v[58:59], v11 offset:4096
v_mfma_f32_16x16x32_bf16 v[136:139], v[112:115], v[100:103], v[136:139]
ds_read_b64_tr_b16 v[60:61], v12 offset:0
v_mfma_f32_16x16x32_bf16 v[144:147], v[112:115], v[104:107], v[144:147]
ds_read_b64_tr_b16 v[62:63], v12 offset:4096
v_mfma_f32_16x16x32_bf16 v[148:151], v[116:119], v[104:107], v[148:151]
ds_read_b128 v[36:39], v19 offset:1024
v_mfma_f32_16x16x32_bf16 v[176:179], v[120:123], v[104:107], v[176:179]
ds_read_b128 v[40:43], v19 offset:2048
v_mfma_f32_16x16x32_bf16 v[180:183], v[124:127], v[104:107], v[180:183]
ds_read_b128 v[44:47], v19 offset:3072
v_mfma_f32_16x16x32_bf16 v[188:191], v[124:127], v[108:111], v[188:191]
ds_read_b128 v[64:67], v19 offset:8192
v_mfma_f32_16x16x32_bf16 v[184:187], v[120:123], v[108:111], v[184:187]
ds_read_b64_tr_b16 v[80:81], v9 offset:8192
v_mfma_f32_16x16x32_bf16 v[156:159], v[116:119], v[108:111], v[156:159]
ds_read_b64_tr_b16 v[82:83], v9 offset:12288
v_mfma_f32_16x16x32_bf16 v[152:155], v[112:115], v[108:111], v[152:155]
ds_read_b64_tr_b16 v[84:85], v10 offset:8192
v_mfma_f32_16x16x32_bf16 v[128:131], v[208:211], v[192:195], v[128:131]
ds_read_b64_tr_b16 v[86:87], v10 offset:12288
v_mfma_f32_16x16x32_bf16 v[132:135], v[212:215], v[192:195], v[132:135]
ds_read_b64_tr_b16 v[88:89], v11 offset:8192
v_mfma_f32_16x16x32_bf16 v[160:163], v[216:219], v[192:195], v[160:163]
ds_read_b64_tr_b16 v[90:91], v11 offset:12288
v_mfma_f32_16x16x32_bf16 v[164:167], v[220:223], v[192:195], v[164:167]
ds_read_b64_tr_b16 v[92:93], v12 offset:8192
v_mfma_f32_16x16x32_bf16 v[172:175], v[220:223], v[196:199], v[172:175]
ds_read_b64_tr_b16 v[94:95], v12 offset:12288
v_mfma_f32_16x16x32_bf16 v[168:171], v[216:219], v[196:199], v[168:171]
ds_read_b128 v[68:71], v19 offset:9216
v_mfma_f32_16x16x32_bf16 v[140:143], v[212:215], v[196:199], v[140:143]
ds_read_b128 v[72:75], v19 offset:10240
v_mfma_f32_16x16x32_bf16 v[136:139], v[208:211], v[196:199], v[136:139]
ds_read_b128 v[76:79], v19 offset:11264
v_mfma_f32_16x16x32_bf16 v[144:147], v[208:211], v[200:203], v[144:147]
v_mfma_f32_16x16x32_bf16 v[148:151], v[212:215], v[200:203], v[148:151]
v_mfma_f32_16x16x32_bf16 v[176:179], v[216:219], v[200:203], v[176:179]
v_mfma_f32_16x16x32_bf16 v[180:183], v[220:223], v[200:203], v[180:183]
v_mfma_f32_16x16x32_bf16 v[188:191], v[220:223], v[204:207], v[188:191]
v_mfma_f32_16x16x32_bf16 v[184:187], v[216:219], v[204:207], v[184:187]
v_mfma_f32_16x16x32_bf16 v[156:159], v[212:215], v[204:207], v[156:159]
v_mfma_f32_16x16x32_bf16 v[152:155], v[208:211], v[204:207], v[152:155]
s_waitcnt lgkmcnt(0)
s_barrier
v_mfma_f32_16x16x32_bf16 v[128:131], v[48:51], v[32:35], v[128:131]
ds_read_b128 v[96:99], v17 offset:16384
v_mfma_f32_16x16x32_bf16 v[132:135], v[52:55], v[32:35], v[132:135]
ds_read_b64_tr_b16 v[112:113], v9 offset:32768
v_mfma_f32_16x16x32_bf16 v[160:163], v[56:59], v[32:35], v[160:163]
ds_read_b64_tr_b16 v[114:115], v9 offset:36864
v_mfma_f32_16x16x32_bf16 v[164:167], v[60:63], v[32:35], v[164:167]
ds_read_b64_tr_b16 v[116:117], v10 offset:32768
v_mfma_f32_16x16x32_bf16 v[172:175], v[60:63], v[36:39], v[172:175]
ds_read_b64_tr_b16 v[118:119], v10 offset:36864
v_mfma_f32_16x16x32_bf16 v[168:171], v[56:59], v[36:39], v[168:171]
ds_read_b64_tr_b16 v[120:121], v11 offset:32768
v_mfma_f32_16x16x32_bf16 v[140:143], v[52:55], v[36:39], v[140:143]
ds_read_b64_tr_b16 v[122:123], v11 offset:36864
v_mfma_f32_16x16x32_bf16 v[136:139], v[48:51], v[36:39], v[136:139]
ds_read_b64_tr_b16 v[124:125], v12 offset:32768
v_mfma_f32_16x16x32_bf16 v[144:147], v[48:51], v[40:43], v[144:147]
ds_read_b64_tr_b16 v[126:127], v12 offset:36864
v_mfma_f32_16x16x32_bf16 v[148:151], v[52:55], v[40:43], v[148:151]
ds_read_b128 v[100:103], v17 offset:17408
v_mfma_f32_16x16x32_bf16 v[176:179], v[56:59], v[40:43], v[176:179]
ds_read_b128 v[104:107], v17 offset:18432
v_mfma_f32_16x16x32_bf16 v[180:183], v[60:63], v[40:43], v[180:183]
ds_read_b128 v[108:111], v17 offset:19456
v_mfma_f32_16x16x32_bf16 v[188:191], v[60:63], v[44:47], v[188:191]
ds_read_b128 v[192:195], v17 offset:24576
v_mfma_f32_16x16x32_bf16 v[184:187], v[56:59], v[44:47], v[184:187]
ds_read_b64_tr_b16 v[208:209], v9 offset:40960
v_mfma_f32_16x16x32_bf16 v[156:159], v[52:55], v[44:47], v[156:159]
ds_read_b64_tr_b16 v[210:211], v9 offset:45056
v_mfma_f32_16x16x32_bf16 v[152:155], v[48:51], v[44:47], v[152:155]
ds_read_b64_tr_b16 v[212:213], v10 offset:40960
v_mfma_f32_16x16x32_bf16 v[128:131], v[80:83], v[64:67], v[128:131]
ds_read_b64_tr_b16 v[214:215], v10 offset:45056
v_mfma_f32_16x16x32_bf16 v[132:135], v[84:87], v[64:67], v[132:135]
ds_read_b64_tr_b16 v[216:217], v11 offset:40960
v_mfma_f32_16x16x32_bf16 v[160:163], v[88:91], v[64:67], v[160:163]
ds_read_b64_tr_b16 v[218:219], v11 offset:45056
v_mfma_f32_16x16x32_bf16 v[164:167], v[92:95], v[64:67], v[164:167]
ds_read_b64_tr_b16 v[220:221], v12 offset:40960
v_mfma_f32_16x16x32_bf16 v[172:175], v[92:95], v[68:71], v[172:175]
ds_read_b64_tr_b16 v[222:223], v12 offset:45056
v_mfma_f32_16x16x32_bf16 v[168:171], v[88:91], v[68:71], v[168:171]
ds_read_b128 v[196:199], v17 offset:25600
v_mfma_f32_16x16x32_bf16 v[140:143], v[84:87], v[68:71], v[140:143]
ds_read_b128 v[200:203], v17 offset:26624
v_mfma_f32_16x16x32_bf16 v[136:139], v[80:83], v[68:71], v[136:139]
ds_read_b128 v[204:207], v17 offset:27648
v_mfma_f32_16x16x32_bf16 v[144:147], v[80:83], v[72:75], v[144:147]
v_mfma_f32_16x16x32_bf16 v[148:151], v[84:87], v[72:75], v[148:151]
v_mfma_f32_16x16x32_bf16 v[176:179], v[88:91], v[72:75], v[176:179]
v_mfma_f32_16x16x32_bf16 v[180:183], v[92:95], v[72:75], v[180:183]
v_mfma_f32_16x16x32_bf16 v[188:191], v[92:95], v[76:79], v[188:191]
v_mfma_f32_16x16x32_bf16 v[184:187], v[88:91], v[76:79], v[184:187]
v_mfma_f32_16x16x32_bf16 v[156:159], v[84:87], v[76:79], v[156:159]
v_mfma_f32_16x16x32_bf16 v[152:155], v[80:83], v[76:79], v[152:155]
s_waitcnt lgkmcnt(0)
s_barrier
v_mfma_f32_16x16x32_bf16 v[128:131], v[112:115], v[96:99], v[128:131]
ds_read_b128 v[32:35], v17 offset:49152
v_mfma_f32_16x16x32_bf16 v[132:135], v[116:119], v[96:99], v[132:135]
ds_read_b64_tr_b16 v[48:49], v13 offset:0
v_mfma_f32_16x16x32_bf16 v[160:163], v[120:123], v[96:99], v[160:163]
ds_read_b64_tr_b16 v[50:51], v13 offset:4096
v_mfma_f32_16x16x32_bf16 v[164:167], v[124:127], v[96:99], v[164:167]
ds_read_b64_tr_b16 v[52:53], v14 offset:0
v_mfma_f32_16x16x32_bf16 v[172:175], v[124:127], v[100:103], v[172:175]
ds_read_b64_tr_b16 v[54:55], v14 offset:4096
v_mfma_f32_16x16x32_bf16 v[168:171], v[120:123], v[100:103], v[168:171]
ds_read_b64_tr_b16 v[56:57], v15 offset:0
v_mfma_f32_16x16x32_bf16 v[140:143], v[116:119], v[100:103], v[140:143]
ds_read_b64_tr_b16 v[58:59], v15 offset:4096
v_mfma_f32_16x16x32_bf16 v[136:139], v[112:115], v[100:103], v[136:139]
ds_read_b64_tr_b16 v[60:61], v16 offset:0
v_mfma_f32_16x16x32_bf16 v[144:147], v[112:115], v[104:107], v[144:147]
ds_read_b64_tr_b16 v[62:63], v16 offset:4096
v_mfma_f32_16x16x32_bf16 v[148:151], v[116:119], v[104:107], v[148:151]
ds_read_b128 v[36:39], v17 offset:50176
v_mfma_f32_16x16x32_bf16 v[176:179], v[120:123], v[104:107], v[176:179]
ds_read_b128 v[40:43], v17 offset:51200
v_mfma_f32_16x16x32_bf16 v[180:183], v[124:127], v[104:107], v[180:183]
ds_read_b128 v[44:47], v17 offset:52224
v_mfma_f32_16x16x32_bf16 v[188:191], v[124:127], v[108:111], v[188:191]
ds_read_b128 v[64:67], v17 offset:57344
v_mfma_f32_16x16x32_bf16 v[184:187], v[120:123], v[108:111], v[184:187]
ds_read_b64_tr_b16 v[80:81], v13 offset:8192
v_mfma_f32_16x16x32_bf16 v[156:159], v[116:119], v[108:111], v[156:159]
ds_read_b64_tr_b16 v[82:83], v13 offset:12288
v_mfma_f32_16x16x32_bf16 v[152:155], v[112:115], v[108:111], v[152:155]
ds_read_b64_tr_b16 v[84:85], v14 offset:8192
v_mfma_f32_16x16x32_bf16 v[128:131], v[208:211], v[192:195], v[128:131]
ds_read_b64_tr_b16 v[86:87], v14 offset:12288
v_mfma_f32_16x16x32_bf16 v[132:135], v[212:215], v[192:195], v[132:135]
ds_read_b64_tr_b16 v[88:89], v15 offset:8192
v_mfma_f32_16x16x32_bf16 v[160:163], v[216:219], v[192:195], v[160:163]
ds_read_b64_tr_b16 v[90:91], v15 offset:12288
v_mfma_f32_16x16x32_bf16 v[164:167], v[220:223], v[192:195], v[164:167]
ds_read_b64_tr_b16 v[92:93], v16 offset:8192
v_mfma_f32_16x16x32_bf16 v[172:175], v[220:223], v[196:199], v[172:175]
ds_read_b64_tr_b16 v[94:95], v16 offset:12288
v_mfma_f32_16x16x32_bf16 v[168:171], v[216:219], v[196:199], v[168:171]
ds_read_b128 v[68:71], v17 offset:58368
v_mfma_f32_16x16x32_bf16 v[140:143], v[212:215], v[196:199], v[140:143]
ds_read_b128 v[72:75], v17 offset:59392
v_mfma_f32_16x16x32_bf16 v[136:139], v[208:211], v[196:199], v[136:139]
ds_read_b128 v[76:79], v17 offset:60416
v_mfma_f32_16x16x32_bf16 v[144:147], v[208:211], v[200:203], v[144:147]
v_mfma_f32_16x16x32_bf16 v[148:151], v[212:215], v[200:203], v[148:151]
v_mfma_f32_16x16x32_bf16 v[176:179], v[216:219], v[200:203], v[176:179]
v_mfma_f32_16x16x32_bf16 v[180:183], v[220:223], v[200:203], v[180:183]
v_mfma_f32_16x16x32_bf16 v[188:191], v[220:223], v[204:207], v[188:191]
v_mfma_f32_16x16x32_bf16 v[184:187], v[216:219], v[204:207], v[184:187]
v_mfma_f32_16x16x32_bf16 v[156:159], v[212:215], v[204:207], v[156:159]
v_mfma_f32_16x16x32_bf16 v[152:155], v[208:211], v[204:207], v[152:155]
s_waitcnt lgkmcnt(0)
s_barrier
v_mfma_f32_16x16x32_bf16 v[128:131], v[48:51], v[32:35], v[128:131]
ds_read_b128 v[96:99], v18 offset:16384
v_mfma_f32_16x16x32_bf16 v[132:135], v[52:55], v[32:35], v[132:135]
ds_read_b64_tr_b16 v[112:113], v25 offset:16384
v_mfma_f32_16x16x32_bf16 v[160:163], v[56:59], v[32:35], v[160:163]
ds_read_b64_tr_b16 v[114:115], v25 offset:20480
v_mfma_f32_16x16x32_bf16 v[164:167], v[60:63], v[32:35], v[164:167]
ds_read_b64_tr_b16 v[116:117], v26 offset:16384
v_mfma_f32_16x16x32_bf16 v[172:175], v[60:63], v[36:39], v[172:175]
ds_read_b64_tr_b16 v[118:119], v26 offset:20480
v_mfma_f32_16x16x32_bf16 v[168:171], v[56:59], v[36:39], v[168:171]
ds_read_b64_tr_b16 v[120:121], v27 offset:16384
v_mfma_f32_16x16x32_bf16 v[140:143], v[52:55], v[36:39], v[140:143]
ds_read_b64_tr_b16 v[122:123], v27 offset:20480
v_mfma_f32_16x16x32_bf16 v[136:139], v[48:51], v[36:39], v[136:139]
ds_read_b64_tr_b16 v[124:125], v28 offset:16384
v_mfma_f32_16x16x32_bf16 v[144:147], v[48:51], v[40:43], v[144:147]
ds_read_b64_tr_b16 v[126:127], v28 offset:20480
v_mfma_f32_16x16x32_bf16 v[148:151], v[52:55], v[40:43], v[148:151]
ds_read_b128 v[100:103], v18 offset:17408
v_mfma_f32_16x16x32_bf16 v[176:179], v[56:59], v[40:43], v[176:179]
ds_read_b128 v[104:107], v18 offset:18432
v_mfma_f32_16x16x32_bf16 v[180:183], v[60:63], v[40:43], v[180:183]
ds_read_b128 v[108:111], v18 offset:19456
v_mfma_f32_16x16x32_bf16 v[188:191], v[60:63], v[44:47], v[188:191]
ds_read_b128 v[192:195], v18 offset:24576
v_mfma_f32_16x16x32_bf16 v[184:187], v[56:59], v[44:47], v[184:187]
ds_read_b64_tr_b16 v[208:209], v25 offset:24576
v_mfma_f32_16x16x32_bf16 v[156:159], v[52:55], v[44:47], v[156:159]
ds_read_b64_tr_b16 v[210:211], v25 offset:28672
v_mfma_f32_16x16x32_bf16 v[152:155], v[48:51], v[44:47], v[152:155]
ds_read_b64_tr_b16 v[212:213], v26 offset:24576
v_mfma_f32_16x16x32_bf16 v[128:131], v[80:83], v[64:67], v[128:131]
ds_read_b64_tr_b16 v[214:215], v26 offset:28672
v_mfma_f32_16x16x32_bf16 v[132:135], v[84:87], v[64:67], v[132:135]
ds_read_b64_tr_b16 v[216:217], v27 offset:24576
v_mfma_f32_16x16x32_bf16 v[160:163], v[88:91], v[64:67], v[160:163]
ds_read_b64_tr_b16 v[218:219], v27 offset:28672
v_mfma_f32_16x16x32_bf16 v[164:167], v[92:95], v[64:67], v[164:167]
ds_read_b64_tr_b16 v[220:221], v28 offset:24576
v_mfma_f32_16x16x32_bf16 v[172:175], v[92:95], v[68:71], v[172:175]
ds_read_b64_tr_b16 v[222:223], v28 offset:28672
v_mfma_f32_16x16x32_bf16 v[168:171], v[88:91], v[68:71], v[168:171]
ds_read_b128 v[196:199], v18 offset:25600
v_mfma_f32_16x16x32_bf16 v[140:143], v[84:87], v[68:71], v[140:143]
ds_read_b128 v[200:203], v18 offset:26624
v_mfma_f32_16x16x32_bf16 v[136:139], v[80:83], v[68:71], v[136:139]
ds_read_b128 v[204:207], v18 offset:27648
v_mfma_f32_16x16x32_bf16 v[144:147], v[80:83], v[72:75], v[144:147]
v_mfma_f32_16x16x32_bf16 v[148:151], v[84:87], v[72:75], v[148:151]
v_mfma_f32_16x16x32_bf16 v[176:179], v[88:91], v[72:75], v[176:179]
v_mfma_f32_16x16x32_bf16 v[180:183], v[92:95], v[72:75], v[180:183]
v_mfma_f32_16x16x32_bf16 v[188:191], v[92:95], v[76:79], v[188:191]
v_mfma_f32_16x16x32_bf16 v[184:187], v[88:91], v[76:79], v[184:187]
v_mfma_f32_16x16x32_bf16 v[156:159], v[84:87], v[76:79], v[156:159]
v_mfma_f32_16x16x32_bf16 v[152:155], v[80:83], v[76:79], v[152:155]
s_waitcnt lgkmcnt(0)
s_barrier
v_mfma_f32_16x16x32_bf16 v[128:131], v[112:115], v[96:99], v[128:131]
ds_read_b128 v[32:35], v18 offset:32768
v_mfma_f32_16x16x32_bf16 v[132:135], v[116:119], v[96:99], v[132:135]
ds_read_b64_tr_b16 v[48:49], v13 offset:49152
v_mfma_f32_16x16x32_bf16 v[160:163], v[120:123], v[96:99], v[160:163]
ds_read_b64_tr_b16 v[50:51], v13 offset:53248
v_mfma_f32_16x16x32_bf16 v[164:167], v[124:127], v[96:99], v[164:167]
ds_read_b64_tr_b16 v[52:53], v14 offset:49152
v_mfma_f32_16x16x32_bf16 v[172:175], v[124:127], v[100:103], v[172:175]
ds_read_b64_tr_b16 v[54:55], v14 offset:53248
v_mfma_f32_16x16x32_bf16 v[168:171], v[120:123], v[100:103], v[168:171]
ds_read_b64_tr_b16 v[56:57], v15 offset:49152
v_mfma_f32_16x16x32_bf16 v[140:143], v[116:119], v[100:103], v[140:143]
ds_read_b64_tr_b16 v[58:59], v15 offset:53248
v_mfma_f32_16x16x32_bf16 v[136:139], v[112:115], v[100:103], v[136:139]
ds_read_b64_tr_b16 v[60:61], v16 offset:49152
v_mfma_f32_16x16x32_bf16 v[144:147], v[112:115], v[104:107], v[144:147]
ds_read_b64_tr_b16 v[62:63], v16 offset:53248
v_mfma_f32_16x16x32_bf16 v[148:151], v[116:119], v[104:107], v[148:151]
ds_read_b128 v[36:39], v18 offset:33792
v_mfma_f32_16x16x32_bf16 v[176:179], v[120:123], v[104:107], v[176:179]
ds_read_b128 v[40:43], v18 offset:34816
v_mfma_f32_16x16x32_bf16 v[180:183], v[124:127], v[104:107], v[180:183]
ds_read_b128 v[44:47], v18 offset:35840
v_mfma_f32_16x16x32_bf16 v[188:191], v[124:127], v[108:111], v[188:191]
ds_read_b128 v[64:67], v18 offset:40960
v_mfma_f32_16x16x32_bf16 v[184:187], v[120:123], v[108:111], v[184:187]
ds_read_b64_tr_b16 v[80:81], v13 offset:57344
v_mfma_f32_16x16x32_bf16 v[156:159], v[116:119], v[108:111], v[156:159]
ds_read_b64_tr_b16 v[82:83], v13 offset:61440
v_mfma_f32_16x16x32_bf16 v[152:155], v[112:115], v[108:111], v[152:155]
ds_read_b64_tr_b16 v[84:85], v14 offset:57344
v_mfma_f32_16x16x32_bf16 v[128:131], v[208:211], v[192:195], v[128:131]
ds_read_b64_tr_b16 v[86:87], v14 offset:61440
v_mfma_f32_16x16x32_bf16 v[132:135], v[212:215], v[192:195], v[132:135]
ds_read_b64_tr_b16 v[88:89], v15 offset:57344
v_mfma_f32_16x16x32_bf16 v[160:163], v[216:219], v[192:195], v[160:163]
ds_read_b64_tr_b16 v[90:91], v15 offset:61440
v_mfma_f32_16x16x32_bf16 v[164:167], v[220:223], v[192:195], v[164:167]
ds_read_b64_tr_b16 v[92:93], v16 offset:57344
v_mfma_f32_16x16x32_bf16 v[172:175], v[220:223], v[196:199], v[172:175]
ds_read_b64_tr_b16 v[94:95], v16 offset:61440
v_mfma_f32_16x16x32_bf16 v[168:171], v[216:219], v[196:199], v[168:171]
ds_read_b128 v[68:71], v18 offset:41984
v_mfma_f32_16x16x32_bf16 v[140:143], v[212:215], v[196:199], v[140:143]
ds_read_b128 v[72:75], v18 offset:43008
v_mfma_f32_16x16x32_bf16 v[136:139], v[208:211], v[196:199], v[136:139]
ds_read_b128 v[76:79], v18 offset:44032
v_mfma_f32_16x16x32_bf16 v[144:147], v[208:211], v[200:203], v[144:147]
v_mfma_f32_16x16x32_bf16 v[148:151], v[212:215], v[200:203], v[148:151]
v_mfma_f32_16x16x32_bf16 v[176:179], v[216:219], v[200:203], v[176:179]
v_mfma_f32_16x16x32_bf16 v[180:183], v[220:223], v[200:203], v[180:183]
v_mfma_f32_16x16x32_bf16 v[188:191], v[220:223], v[204:207], v[188:191]
v_mfma_f32_16x16x32_bf16 v[184:187], v[216:219], v[204:207], v[184:187]
v_mfma_f32_16x16x32_bf16 v[156:159], v[212:215], v[204:207], v[156:159]
v_mfma_f32_16x16x32_bf16 v[152:155], v[208:211], v[204:207], v[152:155]
s_waitcnt lgkmcnt(0)
s_barrier
v_mfma_f32_16x16x32_bf16 v[128:131], v[48:51], v[32:35], v[128:131]
ds_read_b128 v[96:99], v19 offset:0
v_mfma_f32_16x16x32_bf16 v[132:135], v[52:55], v[32:35], v[132:135]
ds_read_b64_tr_b16 v[112:113], v9 offset:0
v_mfma_f32_16x16x32_bf16 v[160:163], v[56:59], v[32:35], v[160:163]
ds_read_b64_tr_b16 v[114:115], v9 offset:4096
v_mfma_f32_16x16x32_bf16 v[164:167], v[60:63], v[32:35], v[164:167]
ds_read_b64_tr_b16 v[116:117], v10 offset:0
v_mfma_f32_16x16x32_bf16 v[172:175], v[60:63], v[36:39], v[172:175]
ds_read_b64_tr_b16 v[118:119], v10 offset:4096
v_mfma_f32_16x16x32_bf16 v[168:171], v[56:59], v[36:39], v[168:171]
ds_read_b64_tr_b16 v[120:121], v11 offset:0
v_mfma_f32_16x16x32_bf16 v[140:143], v[52:55], v[36:39], v[140:143]
ds_read_b64_tr_b16 v[122:123], v11 offset:4096
v_mfma_f32_16x16x32_bf16 v[136:139], v[48:51], v[36:39], v[136:139]
ds_read_b64_tr_b16 v[124:125], v12 offset:0
v_mfma_f32_16x16x32_bf16 v[144:147], v[48:51], v[40:43], v[144:147]
ds_read_b64_tr_b16 v[126:127], v12 offset:4096
v_mfma_f32_16x16x32_bf16 v[148:151], v[52:55], v[40:43], v[148:151]
ds_read_b128 v[100:103], v19 offset:1024
v_mfma_f32_16x16x32_bf16 v[176:179], v[56:59], v[40:43], v[176:179]
ds_read_b128 v[104:107], v19 offset:2048
v_mfma_f32_16x16x32_bf16 v[180:183], v[60:63], v[40:43], v[180:183]
ds_read_b128 v[108:111], v19 offset:3072
v_mfma_f32_16x16x32_bf16 v[188:191], v[60:63], v[44:47], v[188:191]
ds_read_b128 v[192:195], v19 offset:8192
v_mfma_f32_16x16x32_bf16 v[184:187], v[56:59], v[44:47], v[184:187]
ds_read_b64_tr_b16 v[208:209], v9 offset:8192
v_mfma_f32_16x16x32_bf16 v[156:159], v[52:55], v[44:47], v[156:159]
ds_read_b64_tr_b16 v[210:211], v9 offset:12288
v_mfma_f32_16x16x32_bf16 v[152:155], v[48:51], v[44:47], v[152:155]
ds_read_b64_tr_b16 v[212:213], v10 offset:8192
v_mfma_f32_16x16x32_bf16 v[128:131], v[80:83], v[64:67], v[128:131]
ds_read_b64_tr_b16 v[214:215], v10 offset:12288
v_mfma_f32_16x16x32_bf16 v[132:135], v[84:87], v[64:67], v[132:135]
ds_read_b64_tr_b16 v[216:217], v11 offset:8192
v_mfma_f32_16x16x32_bf16 v[160:163], v[88:91], v[64:67], v[160:163]
ds_read_b64_tr_b16 v[218:219], v11 offset:12288
v_mfma_f32_16x16x32_bf16 v[164:167], v[92:95], v[64:67], v[164:167]
ds_read_b64_tr_b16 v[220:221], v12 offset:8192
v_mfma_f32_16x16x32_bf16 v[172:175], v[92:95], v[68:71], v[172:175]
ds_read_b64_tr_b16 v[222:223], v12 offset:12288
v_mfma_f32_16x16x32_bf16 v[168:171], v[88:91], v[68:71], v[168:171]
ds_read_b128 v[196:199], v19 offset:9216
v_mfma_f32_16x16x32_bf16 v[140:143], v[84:87], v[68:71], v[140:143]
ds_read_b128 v[200:203], v19 offset:10240
v_mfma_f32_16x16x32_bf16 v[136:139], v[80:83], v[68:71], v[136:139]
ds_read_b128 v[204:207], v19 offset:11264
v_mfma_f32_16x16x32_bf16 v[144:147], v[80:83], v[72:75], v[144:147]
v_mfma_f32_16x16x32_bf16 v[148:151], v[84:87], v[72:75], v[148:151]
v_mfma_f32_16x16x32_bf16 v[176:179], v[88:91], v[72:75], v[176:179]
v_mfma_f32_16x16x32_bf16 v[180:183], v[92:95], v[72:75], v[180:183]
v_mfma_f32_16x16x32_bf16 v[188:191], v[92:95], v[76:79], v[188:191]
v_mfma_f32_16x16x32_bf16 v[184:187], v[88:91], v[76:79], v[184:187]
v_mfma_f32_16x16x32_bf16 v[156:159], v[84:87], v[76:79], v[156:159]
v_mfma_f32_16x16x32_bf16 v[152:155], v[80:83], v[76:79], v[152:155]
s_sub_u32 s41, s41, 1
s_cmp_lg_u32 s41, 0
s_cbranch_scc1 Lk4_121
s_waitcnt lgkmcnt(0)
s_barrier
v_mfma_f32_16x16x32_bf16 v[128:131], v[112:115], v[96:99], v[128:131]
ds_read_b128 v[32:35], v17 offset:16384
v_mfma_f32_16x16x32_bf16 v[132:135], v[116:119], v[96:99], v[132:135]
ds_read_b64_tr_b16 v[48:49], v224 offset:32768
v_mfma_f32_16x16x32_bf16 v[160:163], v[120:123], v[96:99], v[160:163]
ds_read_b64_tr_b16 v[50:51], v224 offset:34816
v_mfma_f32_16x16x32_bf16 v[164:167], v[124:127], v[96:99], v[164:167]
ds_read_b64_tr_b16 v[52:53], v225 offset:32768
v_mfma_f32_16x16x32_bf16 v[172:175], v[124:127], v[100:103], v[172:175]
ds_read_b64_tr_b16 v[54:55], v225 offset:34816
v_mfma_f32_16x16x32_bf16 v[168:171], v[120:123], v[100:103], v[168:171]
ds_read_b128 v[36:39], v17 offset:17408
v_mfma_f32_16x16x32_bf16 v[140:143], v[116:119], v[100:103], v[140:143]
ds_read_b128 v[40:43], v17 offset:18432
v_mfma_f32_16x16x32_bf16 v[136:139], v[112:115], v[100:103], v[136:139]
ds_read_b128 v[44:47], v17 offset:19456
v_mfma_f32_16x16x32_bf16 v[144:147], v[112:115], v[104:107], v[144:147]
ds_read_b128 v[64:67], v17 offset:24576
v_mfma_f32_16x16x32_bf16 v[148:151], v[116:119], v[104:107], v[148:151]
ds_read_b64_tr_b16 v[80:81], v224 offset:36864
v_mfma_f32_16x16x32_bf16 v[176:179], v[120:123], v[104:107], v[176:179]
ds_read_b64_tr_b16 v[82:83], v224 offset:38912
v_mfma_f32_16x16x32_bf16 v[180:183], v[124:127], v[104:107], v[180:183]
ds_read_b64_tr_b16 v[84:85], v225 offset:36864
v_mfma_f32_16x16x32_bf16 v[188:191], v[124:127], v[108:111], v[188:191]
ds_read_b64_tr_b16 v[86:87], v225 offset:38912
s_branch Lov_12
.p2align 12
.fill 96, 4, 0xbf800000
Lst_12_0:
s_branch Lwr_157
Lst_12_1:
s_branch Lst_16_0
s_nop 0
Lov_12:
v_mfma_f32_16x16x32_bf16 v[184:187], v[120:123], v[108:111], v[184:187]
ds_read_b128 v[68:71], v17 offset:25600
v_mfma_f32_16x16x32_bf16 v[156:159], v[116:119], v[108:111], v[156:159]
ds_read_b128 v[72:75], v17 offset:26624
v_mfma_f32_16x16x32_bf16 v[152:155], v[112:115], v[108:111], v[152:155]
ds_read_b128 v[76:79], v17 offset:27648
v_mfma_f32_16x16x32_bf16 v[128:131], v[208:211], v[192:195], v[128:131]
v_mfma_f32_16x16x32_bf16 v[132:135], v[212:215], v[192:195], v[132:135]
v_mfma_f32_16x16x32_bf16 v[160:163], v[216:219], v[192:195], v[160:163]
v_mfma_f32_16x16x32_bf16 v[164:167], v[220:223], v[192:195], v[164:167]
v_mfma_f32_16x16x32_bf16 v[172:175], v[220:223], v[196:199], v[172:175]
v_mfma_f32_16x16x32_bf16 v[168:171], v[216:219], v[196:199], v[168:171]
v_mfma_f32_16x16x32_bf16 v[140:143], v[212:215], v[196:199], v[140:143]
v_mfma_f32_16x16x32_bf16 v[136:139], v[208:211], v[196:199], v[136:139]
v_mfma_f32_16x16x32_bf16 v[144:147], v[208:211], v[200:203], v[144:147]
v_mfma_f32_16x16x32_bf16 v[148:151], v[212:215], v[200:203], v[148:151]
v_mfma_f32_16x16x32_bf16 v[176:179], v[216:219], v[200:203], v[176:179]
v_mfma_f32_16x16x32_bf16 v[180:183], v[220:223], v[200:203], v[180:183]
v_mfma_f32_16x16x32_bf16 v[188:191], v[220:223], v[204:207], v[188:191]
v_mfma_f32_16x16x32_bf16 v[184:187], v[216:219], v[204:207], v[184:187]
v_mfma_f32_16x16x32_bf16 v[156:159], v[212:215], v[204:207], v[156:159]
v_mfma_f32_16x16x32_bf16 v[152:155], v[208:211], v[204:207], v[152:155]
s_waitcnt lgkmcnt(0)
s_barrier
v_mfma_f32_16x16x32_bf16 v[128:131], v[48:51], v[32:35], v[128:131]
ds_read_b128 v[96:99], v17 offset:49152
ds_read_b64_tr_b16 v[112:113], v226 offset:0
v_mfma_f32_16x16x32_bf16 v[132:135], v[52:55], v[32:35], v[132:135]
ds_read_b64_tr_b16 v[114:115], v226 offset:2048
ds_read_b64_tr_b16 v[116:117], v227 offset:0
v_mfma_f32_16x16x32_bf16 v[140:143], v[52:55], v[36:39], v[140:143]
ds_read_b64_tr_b16 v[118:119], v227 offset:2048
ds_read_b128 v[100:103], v17 offset:50176
v_mfma_f32_16x16x32_bf16 v[136:139], v[48:51], v[36:39], v[136:139]
ds_read_b128 v[104:107], v17 offset:51200
ds_read_b128 v[108:111], v17 offset:52224
v_mfma_f32_16x16x32_bf16 v[144:147], v[48:51], v[40:43], v[144:147]
ds_read_b128 v[192:195], v17 offset:57344
v_mfma_f32_16x16x32_bf16 v[148:151], v[52:55], v[40:43], v[148:151]
ds_read_b64_tr_b16 v[208:209], v226 offset:4096
v_mfma_f32_16x16x32_bf16 v[156:159], v[52:55], v[44:47], v[156:159]
ds_read_b64_tr_b16 v[210:211], v226 offset:6144
v_cvt_pk_bf16_f32 v160, v160, v161
v_cvt_pk_bf16_f32 v161, v162, v163
v_mfma_f32_16x16x32_bf16 v[152:155], v[48:51], v[44:47], v[152:155]
ds_read_b64_tr_b16 v[212:213], v227 offset:4096
v_cvt_pk_bf16_f32 v162, v164, v165
v_cvt_pk_bf16_f32 v163, v166, v167
v_mfma_f32_16x16x32_bf16 v[128:131], v[80:83], v[64:67], v[128:131]
ds_read_b64_tr_b16 v[214:215], v227 offset:6144
v_cvt_pk_bf16_f32 v164, v168, v169
v_cvt_pk_bf16_f32 v165, v170, v171
v_mfma_f32_16x16x32_bf16 v[132:135], v[84:87], v[64:67], v[132:135]
ds_read_b128 v[196:199], v17 offset:58368
v_cvt_pk_bf16_f32 v166, v172, v173
v_cvt_pk_bf16_f32 v167, v174, v175
v_mfma_f32_16x16x32_bf16 v[140:143], v[84:87], v[68:71], v[140:143]
ds_read_b128 v[200:203], v17 offset:59392
v_cvt_pk_bf16_f32 v168, v176, v177
v_cvt_pk_bf16_f32 v169, v178, v179
v_mfma_f32_16x16x32_bf16 v[136:139], v[80:83], v[68:71], v[136:139]
ds_read_b128 v[204:207], v17 offset:60416
v_cvt_pk_bf16_f32 v170, v180, v181
v_cvt_pk_bf16_f32 v171, v182, v183
v_mfma_f32_16x16x32_bf16 v[144:147], v[80:83], v[72:75], v[144:147]
v_cvt_pk_bf16_f32 v172, v184, v185
v_cvt_pk_bf16_f32 v173, v186, v187
v_mfma_f32_16x16x32_bf16 v[148:151], v[84:87], v[72:75], v[148:151]
v_cvt_pk_bf16_f32 v174, v188, v189
v_cvt_pk_bf16_f32 v175, v190, v191
v_mfma_f32_16x16x32_bf16 v[156:159], v[84:87], v[76:79], v[156:159]
v_mfma_f32_16x16x32_bf16 v[152:155], v[80:83], v[76:79], v[152:155]
buffer_store_dwordx4 v[160:163], v2, s[84:87], s45 offen offset:0 sc1
s_waitcnt lgkmcnt(0)
s_barrier
v_mfma_f32_16x16x32_bf16 v[128:131], v[112:115], v[96:99], v[128:131]
ds_read_b128 v[32:35], v18 offset:16384
ds_read_b64_tr_b16 v[48:49], v228 offset:16384
v_mfma_f32_16x16x32_bf16 v[132:135], v[116:119], v[96:99], v[132:135]
ds_read_b64_tr_b16 v[50:51], v228 offset:18432
ds_read_b64_tr_b16 v[52:53], v229 offset:16384
v_mfma_f32_16x16x32_bf16 v[140:143], v[116:119], v[100:103], v[140:143]
ds_read_b64_tr_b16 v[54:55], v229 offset:18432
ds_read_b128 v[36:39], v18 offset:17408
v_mfma_f32_16x16x32_bf16 v[136:139], v[112:115], v[100:103], v[136:139]
ds_read_b128 v[40:43], v18 offset:18432
ds_read_b128 v[44:47], v18 offset:19456
v_mfma_f32_16x16x32_bf16 v[144:147], v[112:115], v[104:107], v[144:147]
ds_read_b128 v[64:67], v18 offset:24576
v_mfma_f32_16x16x32_bf16 v[148:151], v[116:119], v[104:107], v[148:151]
ds_read_b64_tr_b16 v[80:81], v228 offset:20480
v_mfma_f32_16x16x32_bf16 v[156:159], v[116:119], v[108:111], v[156:159]
ds_read_b64_tr_b16 v[82:83], v228 offset:22528
v_mfma_f32_16x16x32_bf16 v[152:155], v[112:115], v[108:111], v[152:155]
ds_read_b64_tr_b16 v[84:85], v229 offset:20480
v_mfma_f32_16x16x32_bf16 v[128:131], v[208:211], v[192:195], v[128:131]
ds_read_b64_tr_b16 v[86:87], v229 offset:22528
buffer_store_dwordx4 v[164:167], v2, s[84:87], s45 offen offset:1024 sc1
v_mfma_f32_16x16x32_bf16 v[132:135], v[212:215], v[192:195], v[132:135]
ds_read_b128 v[68:71], v18 offset:25600
v_mfma_f32_16x16x32_bf16 v[140:143], v[212:215], v[196:199], v[140:143]
ds_read_b128 v[72:75], v18 offset:26624
v_mfma_f32_16x16x32_bf16 v[136:139], v[208:211], v[196:199], v[136:139]
ds_read_b128 v[76:79], v18 offset:27648
v_mfma_f32_16x16x32_bf16 v[144:147], v[208:211], v[200:203], v[144:147]
v_mfma_f32_16x16x32_bf16 v[148:151], v[212:215], v[200:203], v[148:151]
v_mfma_f32_16x16x32_bf16 v[156:159], v[212:215], v[204:207], v[156:159]
v_mfma_f32_16x16x32_bf16 v[152:155], v[208:211], v[204:207], v[152:155]
s_waitcnt lgkmcnt(0)
s_barrier
v_mfma_f32_16x16x32_bf16 v[128:131], v[48:51], v[32:35], v[128:131]
ds_read_b128 v[96:99], v18 offset:32768
ds_read_b64_tr_b16 v[112:113], v226 offset:49152
v_mfma_f32_16x16x32_bf16 v[132:135], v[52:55], v[32:35], v[132:135]
ds_read_b64_tr_b16 v[114:115], v226 offset:51200
ds_read_b64_tr_b16 v[116:117], v227 offset:49152
v_mfma_f32_16x16x32_bf16 v[140:143], v[52:55], v[36:39], v[140:143]
ds_read_b64_tr_b16 v[118:119], v227 offset:51200
ds_read_b128 v[100:103], v18 offset:33792
v_mfma_f32_16x16x32_bf16 v[136:139], v[48:51], v[36:39], v[136:139]
ds_read_b128 v[104:107], v18 offset:34816
ds_read_b128 v[108:111], v18 offset:35840
v_mfma_f32_16x16x32_bf16 v[144:147], v[48:51], v[40:43], v[144:147]
ds_read_b128 v[192:195], v18 offset:40960
v_mfma_f32_16x16x32_bf16 v[148:151], v[52:55], v[40:43], v[148:151]
ds_read_b64_tr_b16 v[208:209], v226 offset:53248
v_mfma_f32_16x16x32_bf16 v[156:159], v[52:55], v[44:47], v[156:159]
ds_read_b64_tr_b16 v[210:211], v226 offset:55296
v_mfma_f32_16x16x32_bf16 v[152:155], v[48:51], v[44:47], v[152:155]
ds_read_b64_tr_b16 v[212:213], v227 offset:53248
v_mfma_f32_16x16x32_bf16 v[128:131], v[80:83], v[64:67], v[128:131]
ds_read_b64_tr_b16 v[214:215], v227 offset:55296
buffer_store_dwordx4 v[168:171], v2, s[84:87], s45 offen offset:2048 sc1
v_mfma_f32_16x16x32_bf16 v[132:135], v[84:87], v[64:67], v[132:135]
ds_read_b128 v[196:199], v18 offset:41984
v_mfma_f32_16x16x32_bf16 v[140:143], v[84:87], v[68:71], v[140:143]
ds_read_b128 v[200:203], v18 offset:43008
v_mfma_f32_16x16x32_bf16 v[136:139], v[80:83], v[68:71], v[136:139]
ds_read_b128 v[204:207], v18 offset:44032
v_mfma_f32_16x16x32_bf16 v[144:147], v[80:83], v[72:75], v[144:147]
v_mfma_f32_16x16x32_bf16 v[148:151], v[84:87], v[72:75], v[148:151]
v_mfma_f32_16x16x32_bf16 v[156:159], v[84:87], v[76:79], v[156:159]
v_mfma_f32_16x16x32_bf16 v[152:155], v[80:83], v[76:79], v[152:155]
s_waitcnt lgkmcnt(0)
s_barrier
v_mfma_f32_16x16x32_bf16 v[128:131], v[112:115], v[96:99], v[128:131]
ds_read_b128 v[32:35], v19 offset:0
ds_read_b64_tr_b16 v[48:49], v224 offset:0
v_mfma_f32_16x16x32_bf16 v[132:135], v[116:119], v[96:99], v[132:135]
ds_read_b64_tr_b16 v[50:51], v224 offset:2048
ds_read_b64_tr_b16 v[52:53], v225 offset:0
v_mfma_f32_16x16x32_bf16 v[140:143], v[116:119], v[100:103], v[140:143]
ds_read_b64_tr_b16 v[54:55], v225 offset:2048
ds_read_b128 v[36:39], v19 offset:1024
v_mfma_f32_16x16x32_bf16 v[136:139], v[112:115], v[100:103], v[136:139]
ds_read_b128 v[40:43], v19 offset:2048
ds_read_b128 v[44:47], v19 offset:3072
v_mfma_f32_16x16x32_bf16 v[144:147], v[112:115], v[104:107], v[144:147]
ds_read_b128 v[64:67], v19 offset:8192
v_mfma_f32_16x16x32_bf16 v[148:151], v[116:119], v[104:107], v[148:151]
ds_read_b64_tr_b16 v[80:81], v224 offset:4096
v_mfma_f32_16x16x32_bf16 v[156:159], v[116:119], v[108:111], v[156:159]
ds_read_b64_tr_b16 v[82:83], v224 offset:6144
v_mfma_f32_16x16x32_bf16 v[152:155], v[112:115], v[108:111], v[152:155]
ds_read_b64_tr_b16 v[84:85], v225 offset:4096
v_mfma_f32_16x16x32_bf16 v[128:131], v[208:211], v[192:195], v[128:131]
ds_read_b64_tr_b16 v[86:87], v225 offset:6144
buffer_store_dwordx4 v[172:175], v2, s[84:87], s45 offen offset:3072 sc1
v_mfma_f32_16x16x32_bf16 v[132:135], v[212:215], v[192:195], v[132:135]
ds_read_b128 v[68:71], v19 offset:9216
v_mfma_f32_16x16x32_bf16 v[140:143], v[212:215], v[196:199], v[140:143]
ds_read_b128 v[72:75], v19 offset:10240
v_mfma_f32_16x16x32_bf16 v[136:139], v[208:211], v[196:199], v[136:139]
ds_read_b128 v[76:79], v19 offset:11264
v_mfma_f32_16x16x32_bf16 v[144:147], v[208:211], v[200:203], v[144:147]
v_mfma_f32_16x16x32_bf16 v[148:151], v[212:215], v[200:203], v[148:151]
v_mfma_f32_16x16x32_bf16 v[156:159], v[212:215], v[204:207], v[156:159]
v_mfma_f32_16x16x32_bf16 v[152:155], v[208:211], v[204:207], v[152:155]
s_waitcnt lgkmcnt(0)
s_barrier
v_mfma_f32_16x16x32_bf16 v[128:131], v[48:51], v[32:35], v[128:131]
ds_read_b128 v[96:99], v17 offset:16384
ds_read_b64_tr_b16 v[112:113], v224 offset:32768
v_mfma_f32_16x16x32_bf16 v[132:135], v[52:55], v[32:35], v[132:135]
ds_read_b64_tr_b16 v[114:115], v224 offset:34816
ds_read_b64_tr_b16 v[116:117], v225 offset:32768
v_mfma_f32_16x16x32_bf16 v[140:143], v[52:55], v[36:39], v[140:143]
ds_read_b64_tr_b16 v[118:119], v225 offset:34816
ds_read_b128 v[100:103], v17 offset:17408
v_mfma_f32_16x16x32_bf16 v[136:139], v[48:51], v[36:39], v[136:139]
ds_read_b128 v[104:107], v17 offset:18432
ds_read_b128 v[108:111], v17 offset:19456
v_mfma_f32_16x16x32_bf16 v[144:147], v[48:51], v[40:43], v[144:147]
ds_read_b128 v[192:195], v17 offset:24576
v_mfma_f32_16x16x32_bf16 v[148:151], v[52:55], v[40:43], v[148:151]
ds_read_b64_tr_b16 v[208:209], v224 offset:36864
v_mfma_f32_16x16x32_bf16 v[156:159], v[52:55], v[44:47], v[156:159]
ds_read_b64_tr_b16 v[210:211], v224 offset:38912
v_mfma_f32_16x16x32_bf16 v[152:155], v[48:51], v[44:47], v[152:155]
ds_read_b64_tr_b16 v[212:213], v225 offset:36864
v_mfma_f32_16x16x32_bf16 v[128:131], v[80:83], v[64:67], v[128:131]
ds_read_b64_tr_b16 v[214:215], v225 offset:38912
v_mfma_f32_16x16x32_bf16 v[132:135], v[84:87], v[64:67], v[132:135]
ds_read_b128 v[196:199], v17 offset:25600
v_mfma_f32_16x16x32_bf16 v[140:143], v[84:87], v[68:71], v[140:143]
ds_read_b128 v[200:203], v17 offset:26624
v_mfma_f32_16x16x32_bf16 v[136:139], v[80:83], v[68:71], v[136:139]
ds_read_b128 v[204:207], v17 offset:27648
v_mfma_f32_16x16x32_bf16 v[144:147], v[80:83], v[72:75], v[144:147]
v_mfma_f32_16x16x32_bf16 v[148:151], v[84:87], v[72:75], v[148:151]
v_mfma_f32_16x16x32_bf16 v[156:159], v[84:87], v[76:79], v[156:159]
v_mfma_f32_16x16x32_bf16 v[152:155], v[80:83], v[76:79], v[152:155]
s_waitcnt vmcnt(0)
s_waitcnt lgkmcnt(0)
s_barrier
v_mfma_f32_16x16x32_bf16 v[128:131], v[112:115], v[96:99], v[128:131]
ds_read_b128 v[32:35], v17 offset:49152
ds_read_b64_tr_b16 v[48:49], v226 offset:0
v_mfma_f32_16x16x32_bf16 v[132:135], v[116:119], v[96:99], v[132:135]
ds_read_b64_tr_b16 v[50:51], v226 offset:2048
ds_read_b64_tr_b16 v[52:53], v227 offset:0
v_mfma_f32_16x16x32_bf16 v[140:143], v[116:119], v[100:103], v[140:143]
ds_read_b64_tr_b16 v[54:55], v227 offset:2048
ds_read_b128 v[36:39], v17 offset:50176
v_mfma_f32_16x16x32_bf16 v[136:139], v[112:115], v[100:103], v[136:139]
ds_read_b128 v[40:43], v17 offset:51200
ds_read_b128 v[44:47], v17 offset:52224
v_mfma_f32_16x16x32_bf16 v[144:147], v[112:115], v[104:107], v[144:147]
ds_read_b128 v[64:67], v17 offset:57344
v_mfma_f32_16x16x32_bf16 v[148:151], v[116:119], v[104:107], v[148:151]
ds_read_b64_tr_b16 v[80:81], v226 offset:4096
v_mfma_f32_16x16x32_bf16 v[156:159], v[116:119], v[108:111], v[156:159]
ds_read_b64_tr_b16 v[82:83], v226 offset:6144
v_mfma_f32_16x16x32_bf16 v[152:155], v[112:115], v[108:111], v[152:155]
ds_read_b64_tr_b16 v[84:85], v227 offset:4096
v_mfma_f32_16x16x32_bf16 v[128:131], v[208:211], v[192:195], v[128:131]
ds_read_b64_tr_b16 v[86:87], v227 offset:6144
v_mfma_f32_16x16x32_bf16 v[132:135], v[212:215], v[192:195], v[132:135]
ds_read_b128 v[68:71], v17 offset:58368
v_mfma_f32_16x16x32_bf16 v[140:143], v[212:215], v[196:199], v[140:143]
ds_read_b128 v[72:75], v17 offset:59392
v_mfma_f32_16x16x32_bf16 v[136:139], v[208:211], v[196:199], v[136:139]
ds_read_b128 v[76:79], v17 offset:60416
v_mfma_f32_16x16x32_bf16 v[144:147], v[208:211], v[200:203], v[144:147]
v_mfma_f32_16x16x32_bf16 v[148:151], v[212:215], v[200:203], v[148:151]
v_mfma_f32_16x16x32_bf16 v[156:159], v[212:215], v[204:207], v[156:159]
v_mfma_f32_16x16x32_bf16 v[152:155], v[208:211], v[204:207], v[152:155]
s_waitcnt lgkmcnt(0)
s_barrier
v_mfma_f32_16x16x32_bf16 v[128:131], v[48:51], v[32:35], v[128:131]
ds_read_b128 v[96:99], v18 offset:16384
ds_read_b64_tr_b16 v[112:113], v228 offset:16384
v_mfma_f32_16x16x32_bf16 v[132:135], v[52:55], v[32:35], v[132:135]
ds_read_b64_tr_b16 v[114:115], v228 offset:18432
ds_read_b64_tr_b16 v[116:117], v229 offset:16384
v_mfma_f32_16x16x32_bf16 v[140:143], v[52:55], v[36:39], v[140:143]
ds_read_b64_tr_b16 v[118:119], v229 offset:18432
ds_read_b128 v[100:103], v18 offset:17408
v_mfma_f32_16x16x32_bf16 v[136:139], v[48:51], v[36:39], v[136:139]
ds_read_b128 v[104:107], v18 offset:18432
ds_read_b128 v[108:111], v18 offset:19456
v_mfma_f32_16x16x32_bf16 v[144:147], v[48:51], v[40:43], v[144:147]
ds_read_b128 v[192:195], v18 offset:24576
v_mfma_f32_16x16x32_bf16 v[148:151], v[52:55], v[40:43], v[148:151]
ds_read_b64_tr_b16 v[208:209], v228 offset:20480
v_mfma_f32_16x16x32_bf16 v[156:159], v[52:55], v[44:47], v[156:159]
ds_read_b64_tr_b16 v[210:211], v228 offset:22528
v_mfma_f32_16x16x32_bf16 v[152:155], v[48:51], v[44:47], v[152:155]
ds_read_b64_tr_b16 v[212:213], v229 offset:20480
v_mfma_f32_16x16x32_bf16 v[128:131], v[80:83], v[64:67], v[128:131]
ds_read_b64_tr_b16 v[214:215], v229 offset:22528
v_mfma_f32_16x16x32_bf16 v[132:135], v[84:87], v[64:67], v[132:135]
ds_read_b128 v[196:199], v18 offset:25600
v_mfma_f32_16x16x32_bf16 v[140:143], v[84:87], v[68:71], v[140:143]
ds_read_b128 v[200:203], v18 offset:26624
v_mfma_f32_16x16x32_bf16 v[136:139], v[80:83], v[68:71], v[136:139]
ds_read_b128 v[204:207], v18 offset:27648
v_mfma_f32_16x16x32_bf16 v[144:147], v[80:83], v[72:75], v[144:147]
v_mfma_f32_16x16x32_bf16 v[148:151], v[84:87], v[72:75], v[148:151]
v_mfma_f32_16x16x32_bf16 v[156:159], v[84:87], v[76:79], v[156:159]
v_mfma_f32_16x16x32_bf16 v[152:155], v[80:83], v[76:79], v[152:155]
s_waitcnt lgkmcnt(0)
s_barrier
v_mfma_f32_16x16x32_bf16 v[128:131], v[112:115], v[96:99], v[128:131]
ds_read_b128 v[32:35], v18 offset:32768
ds_read_b64_tr_b16 v[48:49], v226 offset:49152
v_mfma_f32_16x16x32_bf16 v[132:135], v[116:119], v[96:99], v[132:135]
ds_read_b64_tr_b16 v[50:51], v226 offset:51200
ds_read_b64_tr_b16 v[52:53], v227 offset:49152
v_mfma_f32_16x16x32_bf16 v[140:143], v[116:119], v[100:103], v[140:143]
ds_read_b64_tr_b16 v[54:55], v227 offset:51200
ds_read_b128 v[36:39], v18 offset:33792
v_mfma_f32_16x16x32_bf16 v[136:139], v[112:115], v[100:103], v[136:139]
ds_read_b128 v[40:43], v18 offset:34816
ds_read_b128 v[44:47], v18 offset:35840
v_mfma_f32_16x16x32_bf16 v[144:147], v[112:115], v[104:107], v[144:147]
ds_read_b128 v[64:67], v18 offset:40960
v_mfma_f32_16x16x32_bf16 v[148:151], v[116:119], v[104:107], v[148:151]
ds_read_b64_tr_b16 v[80:81], v226 offset:53248
v_mfma_f32_16x16x32_bf16 v[156:159], v[116:119], v[108:111], v[156:159]
ds_read_b64_tr_b16 v[82:83], v226 offset:55296
v_mfma_f32_16x16x32_bf16 v[152:155], v[112:115], v[108:111], v[152:155]
ds_read_b64_tr_b16 v[84:85], v227 offset:53248
v_mfma_f32_16x16x32_bf16 v[128:131], v[208:211], v[192:195], v[128:131]
ds_read_b64_tr_b16 v[86:87], v227 offset:55296
v_mfma_f32_16x16x32_bf16 v[132:135], v[212:215], v[192:195], v[132:135]
ds_read_b128 v[68:71], v18 offset:41984
v_mfma_f32_16x16x32_bf16 v[140:143], v[212:215], v[196:199], v[140:143]
ds_read_b128 v[72:75], v18 offset:43008
v_mfma_f32_16x16x32_bf16 v[136:139], v[208:211], v[196:199], v[136:139]
ds_read_b128 v[76:79], v18 offset:44032
v_mfma_f32_16x16x32_bf16 v[144:147], v[208:211], v[200:203], v[144:147]
v_mfma_f32_16x16x32_bf16 v[148:151], v[212:215], v[200:203], v[148:151]
v_mfma_f32_16x16x32_bf16 v[156:159], v[212:215], v[204:207], v[156:159]
v_mfma_f32_16x16x32_bf16 v[152:155], v[208:211], v[204:207], v[152:155]
s_waitcnt lgkmcnt(0)
s_barrier
buffer_load_dwordx4 v[232:235], v2, s[84:87], s46 offen offset:0 sc1
buffer_load_dwordx4 v[236:239], v2, s[84:87], s46 offen offset:1024 sc1
buffer_load_dwordx4 v[240:243], v2, s[84:87], s46 offen offset:2048 sc1
buffer_load_dwordx4 v[244:247], v2, s[84:87], s46 offen offset:3072 sc1
v_mfma_f32_16x16x32_bf16 v[128:131], v[48:51], v[32:35], v[128:131]
ds_read_b128 v[96:99], v19 offset:0
ds_read_b64_tr_b16 v[112:113], v224 offset:0
v_mfma_f32_16x16x32_bf16 v[132:135], v[52:55], v[32:35], v[132:135]
ds_read_b64_tr_b16 v[114:115], v224 offset:2048
ds_read_b64_tr_b16 v[116:117], v225 offset:0
v_mfma_f32_16x16x32_bf16 v[140:143], v[52:55], v[36:39], v[140:143]
ds_read_b64_tr_b16 v[118:119], v225 offset:2048
ds_read_b128 v[100:103], v19 offset:1024
v_mfma_f32_16x16x32_bf16 v[136:139], v[48:51], v[36:39], v[136:139]
ds_read_b128 v[104:107], v19 offset:2048
ds_read_b128 v[108:111], v19 offset:3072
v_mfma_f32_16x16x32_bf16 v[144:147], v[48:51], v[40:43], v[144:147]
ds_read_b128 v[192:195], v19 offset:8192
v_mfma_f32_16x16x32_bf16 v[148:151], v[52:55], v[40:43], v[148:151]
ds_read_b64_tr_b16 v[208:209], v224 offset:4096
v_mfma_f32_16x16x32_bf16 v[156:159], v[52:55], v[44:47], v[156:159]
ds_read_b64_tr_b16 v[210:211], v224 offset:6144
v_mfma_f32_16x16x32_bf16 v[152:155], v[48:51], v[44:47], v[152:155]
ds_read_b64_tr_b16 v[212:213], v225 offset:4096
v_mfma_f32_16x16x32_bf16 v[128:131], v[80:83], v[64:67], v[128:131]
ds_read_b64_tr_b16 v[214:215], v225 offset:6144
v_mfma_f32_16x16x32_bf16 v[132:135], v[84:87], v[64:67], v[132:135]
ds_read_b128 v[196:199], v19 offset:9216
v_mfma_f32_16x16x32_bf16 v[140:143], v[84:87], v[68:71], v[140:143]
ds_read_b128 v[200:203], v19 offset:10240
v_mfma_f32_16x16x32_bf16 v[136:139], v[80:83], v[68:71], v[136:139]
ds_read_b128 v[204:207], v19 offset:11264
v_mfma_f32_16x16x32_bf16 v[144:147], v[80:83], v[72:75], v[144:147]
v_mfma_f32_16x16x32_bf16 v[148:151], v[84:87], v[72:75], v[148:151]
v_mfma_f32_16x16x32_bf16 v[156:159], v[84:87], v[76:79], v[156:159]
v_mfma_f32_16x16x32_bf16 v[152:155], v[80:83], v[76:79], v[152:155]
s_waitcnt lgkmcnt(0)
s_barrier
v_mfma_f32_16x16x32_bf16 v[128:131], v[112:115], v[96:99], v[128:131]
ds_read_b128 v[32:35], v17 offset:16384
ds_read_b64_tr_b16 v[48:49], v224 offset:32768
v_mfma_f32_16x16x32_bf16 v[132:135], v[116:119], v[96:99], v[132:135]
ds_read_b64_tr_b16 v[50:51], v224 offset:34816
ds_read_b64_tr_b16 v[52:53], v225 offset:32768
v_mfma_f32_16x16x32_bf16 v[140:143], v[116:119], v[100:103], v[140:143]
ds_read_b64_tr_b16 v[54:55], v225 offset:34816
ds_read_b128 v[36:39], v17 offset:17408
v_mfma_f32_16x16x32_bf16 v[136:139], v[112:115], v[100:103], v[136:139]
ds_read_b128 v[40:43], v17 offset:18432
ds_read_b128 v[44:47], v17 offset:19456
v_mfma_f32_16x16x32_bf16 v[144:147], v[112:115], v[104:107], v[144:147]
ds_read_b128 v[64:67], v17 offset:24576
v_mfma_f32_16x16x32_bf16 v[148:151], v[116:119], v[104:107], v[148:151]
ds_read_b64_tr_b16 v[80:81], v224 offset:36864
v_mfma_f32_16x16x32_bf16 v[156:159], v[116:119], v[108:111], v[156:159]
ds_read_b64_tr_b16 v[82:83], v224 offset:38912
v_mfma_f32_16x16x32_bf16 v[152:155], v[112:115], v[108:111], v[152:155]
ds_read_b64_tr_b16 v[84:85], v225 offset:36864
v_mfma_f32_16x16x32_bf16 v[128:131], v[208:211], v[192:195], v[128:131]
ds_read_b64_tr_b16 v[86:87], v225 offset:38912
v_mfma_f32_16x16x32_bf16 v[132:135], v[212:215], v[192:195], v[132:135]
ds_read_b128 v[68:71], v17 offset:25600
v_mfma_f32_16x16x32_bf16 v[140:143], v[212:215], v[196:199], v[140:143]
ds_read_b128 v[72:75], v17 offset:26624
v_mfma_f32_16x16x32_bf16 v[136:139], v[208:211], v[196:199], v[136:139]
ds_read_b128 v[76:79], v17 offset:27648
v_mfma_f32_16x16x32_bf16 v[144:147], v[208:211], v[200:203], v[144:147]
v_mfma_f32_16x16x32_bf16 v[148:151], v[212:215], v[200:203], v[148:151]
v_mfma_f32_16x16x32_bf16 v[156:159], v[212:215], v[204:207], v[156:159]
v_mfma_f32_16x16x32_bf16 v[152:155], v[208:211], v[204:207], v[152:155]
s_waitcnt lgkmcnt(0)
s_barrier
v_mfma_f32_16x16x32_bf16 v[128:131], v[48:51], v[32:35], v[128:131]
ds_read_b128 v[96:99], v17 offset:49152
ds_read_b64_tr_b16 v[112:113], v226 offset:0
v_mfma_f32_16x16x32_bf16 v[132:135], v[52:55], v[32:35], v[132:135]
ds_read_b64_tr_b16 v[114:115], v226 offset:2048
ds_read_b64_tr_b16 v[116:117], v227 offset:0
v_mfma_f32_16x16x32_bf16 v[140:143], v[52:55], v[36:39], v[140:143]
ds_read_b64_tr_b16 v[118:119], v227 offset:2048
ds_read_b128 v[100:103], v17 offset:50176
v_mfma_f32_16x16x32_bf16 v[136:139], v[48:51], v[36:39], v[136:139]
ds_read_b128 v[104:107], v17 offset:51200
ds_read_b128 v[108:111], v17 offset:52224
v_mfma_f32_16x16x32_bf16 v[144:147], v[48:51], v[40:43], v[144:147]
ds_read_b128 v[192:195], v17 offset:57344
v_mfma_f32_16x16x32_bf16 v[148:151], v[52:55], v[40:43], v[148:151]
ds_read_b64_tr_b16 v[208:209], v226 offset:4096
v_mfma_f32_16x16x32_bf16 v[156:159], v[52:55], v[44:47], v[156:159]
ds_read_b64_tr_b16 v[210:211], v226 offset:6144
v_mfma_f32_16x16x32_bf16 v[152:155], v[48:51], v[44:47], v[152:155]
ds_read_b64_tr_b16 v[212:213], v227 offset:4096
v_mfma_f32_16x16x32_bf16 v[128:131], v[80:83], v[64:67], v[128:131]
ds_read_b64_tr_b16 v[214:215], v227 offset:6144
v_mfma_f32_16x16x32_bf16 v[132:135], v[84:87], v[64:67], v[132:135]
ds_read_b128 v[196:199], v17 offset:58368
v_mfma_f32_16x16x32_bf16 v[140:143], v[84:87], v[68:71], v[140:143]
ds_read_b128 v[200:203], v17 offset:59392
v_mfma_f32_16x16x32_bf16 v[136:139], v[80:83], v[68:71], v[136:139]
ds_read_b128 v[204:207], v17 offset:60416
v_mfma_f32_16x16x32_bf16 v[144:147], v[80:83], v[72:75], v[144:147]
v_mfma_f32_16x16x32_bf16 v[148:151], v[84:87], v[72:75], v[148:151]
v_mfma_f32_16x16x32_bf16 v[156:159], v[84:87], v[76:79], v[156:159]
v_mfma_f32_16x16x32_bf16 v[152:155], v[80:83], v[76:79], v[152:155]
s_waitcnt vmcnt(0)
s_waitcnt lgkmcnt(0)
s_barrier
v_mfma_f32_16x16x32_bf16 v[128:131], v[112:115], v[96:99], v[128:131]
v_lshlrev_b32 v160, 16, v232
v_and_b32 v161, 0xffff0000, v232
v_lshlrev_b32 v162, 16, v233
v_and_b32 v163, 0xffff0000, v233
v_mfma_f32_16x16x32_bf16 v[132:135], v[116:119], v[96:99], v[132:135]
v_lshlrev_b32 v164, 16, v234
v_and_b32 v165, 0xffff0000, v234
v_lshlrev_b32 v166, 16, v235
v_and_b32 v167, 0xffff0000, v235
v_mfma_f32_16x16x32_bf16 v[128:131], v[208:211], v[192:195], v[128:131]
v_lshlrev_b32 v168, 16, v236
v_and_b32 v169, 0xffff0000, v236
v_lshlrev_b32 v170, 16, v237
v_and_b32 v171, 0xffff0000, v237
v_mfma_f32_16x16x32_bf16 v[132:135], v[212:215], v[192:195], v[132:135]
v_lshlrev_b32 v172, 16, v238
v_and_b32 v173, 0xffff0000, v238
v_lshlrev_b32 v174, 16, v239
v_and_b32 v175, 0xffff0000, v239
v_mfma_f32_16x16x32_bf16 v[136:139], v[112:115], v[100:103], v[136:139]
v_lshlrev_b32 v176, 16, v240
v_and_b32 v177, 0xffff0000, v240
v_lshlrev_b32 v178, 16, v241
v_and_b32 v179, 0xffff0000, v241
v_mfma_f32_16x16x32_bf16 v[140:143], v[116:119], v[100:103], v[140:143]
v_lshlrev_b32 v180, 16, v242
v_and_b32 v181, 0xffff0000, v242
v_lshlrev_b32 v182, 16, v243
v_and_b32 v183, 0xffff0000, v243
v_mfma_f32_16x16x32_bf16 v[136:139], v[208:211], v[196:199], v[136:139]
v_lshlrev_b32 v184, 16, v244
v_and_b32 v185, 0xffff0000, v244
v_lshlrev_b32 v186, 16, v245
v_and_b32 v187, 0xffff0000, v245
v_mfma_f32_16x16x32_bf16 v[140:143], v[212:215], v[196:199], v[140:143]
v_lshlrev_b32 v188, 16, v246
v_and_b32 v189, 0xffff0000, v246
v_lshlrev_b32 v190, 16, v247
v_and_b32 v191, 0xffff0000, v247
v_mfma_f32_16x16x32_bf16 v[144:147], v[112:115], v[104:107], v[144:147]
v_add_f32 v128, v128, v160
v_add_f32 v129, v129, v161
v_add_f32 v130, v130, v162
v_mfma_f32_16x16x32_bf16 v[148:151], v[116:119], v[104:107], v[148:151]
v_add_f32 v131, v131, v163
v_add_f32 v132, v132, v164
v_add_f32 v133, v133, v165
v_mfma_f32_16x16x32_bf16 v[144:147], v[208:211], v[200:203], v[144:147]
v_add_f32 v134, v134, v166
v_add_f32 v135, v135, v167
v_cvt_pk_bf16_f32 v232, v128, v129
v_mfma_f32_16x16x32_bf16 v[148:151], v[212:215], v[200:203], v[148:151]
v_cvt_pk_bf16_f32 v233, v130, v131
v_cvt_pk_bf16_f32 v234, v132, v133
v_cvt_pk_bf16_f32 v235, v134, v135
v_mfma_f32_16x16x32_bf16 v[152:155], v[112:115], v[108:111], v[152:155]
v_add_f32 v136, v136, v168
v_add_f32 v137, v137, v169
v_add_f32 v138, v138, v170
v_mfma_f32_16x16x32_bf16 v[156:159], v[116:119], v[108:111], v[156:159]
v_add_f32 v139, v139, v171
v_add_f32 v140, v140, v172
v_add_f32 v141, v141, v173
v_add_f32 v142, v142, v174
v_mfma_f32_16x16x32_bf16 v[152:155], v[208:211], v[204:207], v[152:155]
v_add_f32 v143, v143, v175
s_branch Lov_13
.p2align 12
.fill 96, 4, 0xbf800000
Lst_13_0:
s_branch Lwr_158
Lst_13_1:
s_branch Lst_17_0
s_nop 0
Lov_13:
v_cvt_pk_bf16_f32 v236, v136, v137
v_cvt_pk_bf16_f32 v237, v138, v139
v_cvt_pk_bf16_f32 v238, v140, v141
v_mfma_f32_16x16x32_bf16 v[156:159], v[212:215], v[204:207], v[156:159]
v_cvt_pk_bf16_f32 v239, v142, v143
v_permlane16_swap_b32 v232, v234
v_permlane16_swap_b32 v233, v235
buffer_store_dwordx4 v[232:235], v230, s[20:23], s54 offen offset:0 nt
v_permlane16_swap_b32 v236, v238
v_permlane16_swap_b32 v237, v239
buffer_store_dwordx4 v[236:239], v230, s[20:23], s54 offen offset:2048 nt
v_add_f32 v144, v144, v176
v_add_f32 v145, v145, v177
v_add_f32 v146, v146, v178
v_add_f32 v147, v147, v179
v_add_f32 v148, v148, v180
v_add_f32 v149, v149, v181
v_add_f32 v150, v150, v182
v_add_f32 v151, v151, v183
v_cvt_pk_bf16_f32 v240, v144, v145
v_cvt_pk_bf16_f32 v241, v146, v147
v_cvt_pk_bf16_f32 v242, v148, v149
v_cvt_pk_bf16_f32 v243, v150, v151
s_nop 0
v_add_f32 v152, v152, v184
v_add_f32 v153, v153, v185
v_add_f32 v154, v154, v186
v_add_f32 v155, v155, v187
v_add_f32 v156, v156, v188
v_add_f32 v157, v157, v189
v_add_f32 v158, v158, v190
v_add_f32 v159, v159, v191
v_cvt_pk_bf16_f32 v244, v152, v153
v_cvt_pk_bf16_f32 v245, v154, v155
v_cvt_pk_bf16_f32 v246, v156, v157
v_cvt_pk_bf16_f32 v247, v158, v159
v_permlane16_swap_b32 v240, v242
v_permlane16_swap_b32 v241, v243
buffer_store_dwordx4 v[240:243], v230, s[20:23], s55 offen offset:0 nt
v_permlane16_swap_b32 v244, v246
v_permlane16_swap_b32 v245, v247
buffer_store_dwordx4 v[244:247], v230, s[20:23], s55 offen offset:2048 nt
s_branch Ldone_1
Lgb_97:
s_mul_i32 s43, s34, 262144
s_add_u32 s8, s82, s43
s_addc_u32 s9, s83, 0
s_add_u32 s8, s8, 4194304
s_addc_u32 s9, s9, 0
s_mov_b32 s10, 262144
s_mov_b32 s11, 0x20000
s_lshl_b32 s39, s36, 12
v_lshlrev_b32 v2, 4, v1
v_add_u32 v3, s39, v2
s_add_u32 s37, s35, 0
s_and_b32 s37, s37, 15
s_mul_i32 s37, s37, 16384
s_add_u32 m0, s39, 0
s_nop 0
buffer_load_dwordx4 v3, s[8:11], s37 offen sc1 lds
buffer_load_dwordx4 v3, s[8:11], s37 offen offset:1024 sc1 lds
buffer_load_dwordx4 v3, s[8:11], s37 offen offset:2048 sc1 lds
buffer_load_dwordx4 v3, s[8:11], s37 offen offset:3072 sc1 lds
s_mul_i32 s43, s34, 262144
s_add_u32 s8, s82, s43
s_addc_u32 s9, s83, 0
s_add_u32 s8, s8, 4194304
s_addc_u32 s9, s9, 0
s_mov_b32 s10, 262144
s_mov_b32 s11, 0x20000
s_mul_i32 s43, s34, 917504
s_add_u32 s24, s82, s43
s_addc_u32 s25, s83, 0
s_add_u32 s24, s24, 8388608
s_addc_u32 s25, s25, 0
s_mov_b32 s26, 917504
s_mov_b32 s27, 0x20000
s_add_u32 s84, s82, 27262976
s_addc_u32 s85, s83, 0
s_mov_b32 s86, 229376
s_mov_b32 s87, 0x20000
s_and_b32 s47, s36, 3
s_lshr_b32 s62, s47, 1
s_and_b32 s63, s47, 1
v_lshlrev_b32 v2, 4, v1
s_lshl_b32 s39, s47, 12
v_add_u32 v3, s39, v2
s_bitcmp0_b32 s36, 1
s_cselect_b32 s44, s72, s74
s_cselect_b32 s45, s73, s75
s_mul_i32 s43, s35, 256
s_add_u32 s12, s44, s43
s_addc_u32 s13, s45, 0
s_mov_b32 s14, 7333120
s_mov_b32 s15, 0x20000
s_and_b32 s43, s36, 1
s_mul_i32 s43, s43, 229376
v_lshrrev_b32 v28, 4, v1
v_lshlrev_b32 v29, 1, v28
v_and_b32 v4, 15, v1
v_xor_b32 v4, v4, v29
v_lshlrev_b32 v4, 4, v4
v_mul_u32_u24 v28, 7168, v28
v_add_u32 v4, v4, v28
v_add_u32 v4, s43, v4
v_xor_b32 v5, 128, v4
v_add_u32 v5, 28672, v5
s_and_b32 s43, s36, 3
s_mul_i32 s40, s43, 8192
s_add_u32 s40, s40, 16384
v_mov_b32 v6, v192
v_mov_b32 v7, v193
v_mov_b32 v8, v194
s_lshl_b32 s43, s62, 12
v_add_u32 v9, s43, v2
v_add_u32 v10, 98304, v9
v_mov_b32 v24, v195
s_mul_i32 s43, s34, 16384
s_add_u32 s20, s82, s43
s_addc_u32 s21, s83, 0
s_add_u32 s20, s20, 25165824
s_addc_u32 s21, s21, 0
s_mov_b32 s22, 16384
s_mov_b32 s23, 0x20000
s_add_u32 s38, s35, 2
s_and_b32 s38, s38, 15
s_mul_i32 s38, s38, 458752
s_add_u32 m0, s50, 98304
s_nop 0
buffer_load_dwordx4 v6, s[16:19], s38 offen lds
s_add_u32 m0, s50, 99328
s_nop 0
buffer_load_dwordx4 v7, s[16:19], s38 offen lds
s_add_u32 m0, s50, 100352
s_nop 0
buffer_load_dwordx4 v8, s[16:19], s38 offen lds
s_add_u32 m0, s50, 101376
s_add_u32 s38, s38, 114688
buffer_load_dwordx4 v6, s[16:19], s38 offen lds
s_add_u32 m0, s50, 102400
s_nop 0
buffer_load_dwordx4 v7, s[16:19], s38 offen lds
s_add_u32 m0, s50, 103424
s_nop 0
buffer_load_dwordx4 v8, s[16:19], s38 offen lds
s_cmp_eq_u32 s47, 1
s_cbranch_scc0 Lw_122
s_lshl_b32 s92, s34, 4
s_add_u32 s92, s92, s35
s_lshl_b32 s92, s92, 8
s_add_u32 s92, s92, 49280
s_add_u32 s92, s92, 28311552
s_mov_b32 s41, 0x40000
Lpoll_123:
s_load_dword s93, s[82:83], s92 glc
Lpchk_125:
s_waitcnt lgkmcnt(0)
s_cmp_eq_u32 s93, 16
s_cbranch_scc1 Lpok_124
s_sub_u32 s41, s41, 1
s_cmp_lg_u32 s41, 0
s_cbranch_scc1 Lpoll_123
Lpok_124:
Lw_122:
s_waitcnt vmcnt(0)
s_barrier
s_add_u32 s37, s35, 1
s_and_b32 s37, s37, 15
s_mul_i32 s37, s37, 16384
s_add_u32 m0, s39, 49152
s_nop 0
buffer_load_dwordx4 v3, s[8:11], s37 offen sc1 lds
buffer_load_dwordx4 v3, s[8:11], s37 offen offset:1024 sc1 lds
buffer_load_dwordx4 v3, s[8:11], s37 offen offset:2048 sc1 lds
buffer_load_dwordx4 v3, s[8:11], s37 offen offset:3072 sc1 lds
s_add_u32 s37, s35, 2
s_and_b32 s37, s37, 15
s_mul_i32 s37, s37, 16384
s_add_u32 m0, s39, 98304
s_nop 0
buffer_load_dwordx4 v3, s[8:11], s37 offen sc1 lds
buffer_load_dwordx4 v3, s[8:11], s37 offen offset:1024 sc1 lds
buffer_load_dwordx4 v3, s[8:11], s37 offen offset:2048 sc1 lds
buffer_load_dwordx4 v3, s[8:11], s37 offen offset:3072 sc1 lds
buffer_load_dwordx4 v[96:99], v3, s[20:23], 0 offen offset:0 sc1
buffer_load_dwordx4 v[100:103], v3, s[20:23], 0 offen offset:1024 sc1
buffer_load_dwordx4 v[104:107], v3, s[20:23], 0 offen offset:2048 sc1
buffer_load_dwordx4 v[108:111], v3, s[20:23], 0 offen offset:3072 sc1
s_and_b32 s44, s36, 3
s_mul_i32 s44, s44, 14
s_bfe_u32 s43, s2, 0x30001
s_lshl_b32 s43, s43, 7
s_add_u32 s44, s44, s43
s_add_u32 s44, s44, 72
s_mul_i32 s44, s44, 7168
s_lshr_b32 s43, s2, 4
s_lshl_b32 s43, s43, 8
s_add_u32 s43, s43, s44
s_bitcmp0_b32 s2, 0
s_cselect_b32 s4, s72, s74
s_cselect_b32 s5, s73, s75
s_add_u32 s4, s4, s43
s_addc_u32 s5, s5, 0
s_waitcnt vmcnt(8)
s_barrier
s_cmp_eq_u32 s47, 3
s_cbranch_scc0 Lw_126
v_and_b32 v90, 31, v1
v_lshlrev_b32 v90, 4, v90
v_add_u32 v91, 151552, v90
ds_read_b128 v[112:115], v91 offset:0
ds_read_b128 v[116:119], v91 offset:512
ds_read_b128 v[120:123], v91 offset:1024
ds_read_b128 v[124:127], v91 offset:1536
s_and_b32 s44, s2, 15
s_mul_i32 s44, s44, 14336
s_lshr_b32 s43, s2, 4
s_lshl_b32 s43, s43, 9
s_add_u32 s44, s44, s43
s_add_u32 s44, s44, 8192
s_cmp_lt_u32 s2, 192
s_cselect_b32 s44, s44, 0x7fffffff
s_waitcnt lgkmcnt(0)
v_add_f32 v112, v112, v116
v_add_f32 v120, v120, v124
v_add_f32 v113, v113, v117
v_add_f32 v121, v121, v125
v_add_f32 v114, v114, v118
v_add_f32 v122, v122, v126
v_add_f32 v115, v115, v119
v_add_f32 v123, v123, v127
v_add_f32 v112, v112, v120
v_add_f32 v113, v113, v121
v_add_f32 v114, v114, v122
v_add_f32 v115, v115, v123
s_mov_b64 exec, 0xffffffff
buffer_store_dwordx4 v[112:115], v90, s[84:87], s44 offen sc1
s_mov_b64 exec, -1
Lw_126:
s_add_u32 s37, s35, 3
s_and_b32 s37, s37, 15
s_mul_i32 s37, s37, 16384
s_add_u32 m0, s39, 0
s_nop 0
buffer_load_dwordx4 v3, s[8:11], s37 offen sc1 lds
buffer_load_dwordx4 v3, s[8:11], s37 offen offset:1024 sc1 lds
s_load_dword s3, s[4:5], 78848
buffer_load_dwordx4 v3, s[8:11], s37 offen offset:2048 sc1 lds
buffer_load_dwordx4 v3, s[8:11], s37 offen offset:3072 sc1 lds
s_load_dword s3, s[4:5], 78912
s_add_u32 s38, s35, 3
s_and_b32 s38, s38, 15
s_mul_i32 s38, s38, 458752
s_add_u32 m0, s50, 0
s_nop 0
buffer_load_dwordx4 v6, s[16:19], s38 offen lds
s_load_dword s3, s[4:5], 78976
s_add_u32 m0, s50, 1024
s_nop 0
buffer_load_dwordx4 v7, s[16:19], s38 offen lds
s_add_u32 m0, s50, 2048
s_nop 0
buffer_load_dwordx4 v8, s[16:19], s38 offen lds
s_load_dword s3, s[4:5], 79040
s_add_u32 m0, s50, 3072
s_add_u32 s38, s38, 114688
buffer_load_dwordx4 v6, s[16:19], s38 offen lds
s_load_dword s3, s[4:5], 86016
s_add_u32 m0, s50, 4096
s_nop 0
buffer_load_dwordx4 v7, s[16:19], s38 offen lds
s_add_u32 m0, s50, 5120
s_nop 0
buffer_load_dwordx4 v8, s[16:19], s38 offen lds
s_waitcnt vmcnt(14)
s_barrier
s_add_u32 s37, s35, 4
s_and_b32 s37, s37, 15
s_mul_i32 s37, s37, 16384
s_add_u32 m0, s39, 49152
s_nop 0
buffer_load_dwordx4 v3, s[8:11], s37 offen sc1 lds
buffer_load_dwordx4 v3, s[8:11], s37 offen offset:1024 sc1 lds
s_load_dword s3, s[4:5], 86080
buffer_load_dwordx4 v3, s[8:11], s37 offen offset:2048 sc1 lds
buffer_load_dwordx4 v3, s[8:11], s37 offen offset:3072 sc1 lds
s_load_dword s3, s[4:5], 86144
s_add_u32 s38, s35, 4
s_and_b32 s38, s38, 15
s_mul_i32 s38, s38, 458752
s_add_u32 m0, s50, 49152
s_nop 0
buffer_load_dwordx4 v6, s[16:19], s38 offen lds
s_load_dword s3, s[4:5], 86208
s_add_u32 m0, s50, 50176
s_nop 0
buffer_load_dwordx4 v7, s[16:19], s38 offen lds
s_add_u32 m0, s50, 51200
s_nop 0
buffer_load_dwordx4 v8, s[16:19], s38 offen lds
s_load_dword s3, s[4:5], 93184
s_add_u32 m0, s50, 52224
s_add_u32 s38, s38, 114688
buffer_load_dwordx4 v6, s[16:19], s38 offen lds
s_load_dword s3, s[4:5], 93248
s_add_u32 m0, s50, 53248
s_nop 0
buffer_load_dwordx4 v7, s[16:19], s38 offen lds
s_add_u32 m0, s50, 54272
s_nop 0
buffer_load_dwordx4 v8, s[16:19], s38 offen lds
s_waitcnt vmcnt(10)
s_barrier
s_cmp_eq_u32 s47, 3
s_cbranch_scc0 Lw_127
s_cmp_lt_u32 s2, 192
s_cbranch_scc0 Lw_127
s_lshr_b32 s43, s2, 4
s_add_u32 s43, s43, 96
s_lshl_b32 s43, s43, 7
v_mov_b32 v90, s43
v_mov_b32 v91, 1
s_mov_b64 exec, 1
buffer_atomic_add v91, v90, s[56:59], 0 offen sc1
s_mov_b64 exec, -1
Lw_127:
s_add_u32 s37, s35, 5
s_and_b32 s37, s37, 15
s_mul_i32 s37, s37, 16384
s_add_u32 m0, s39, 98304
s_nop 0
buffer_load_dwordx4 v3, s[8:11], s37 offen sc1 lds
v_add_f32 v96, v96, v100
v_add_f32 v97, v97, v101
v_add_f32 v98, v98, v102
buffer_load_dwordx4 v3, s[8:11], s37 offen offset:1024 sc1 lds
v_add_f32 v99, v99, v103
v_add_f32 v104, v104, v108
v_add_f32 v105, v105, v109
buffer_load_dwordx4 v3, s[8:11], s37 offen offset:2048 sc1 lds
v_add_f32 v106, v106, v110
v_add_f32 v107, v107, v111
s_nop 0
buffer_load_dwordx4 v3, s[8:11], s37 offen offset:3072 sc1 lds
v_permlane32_swap_b32 v96, v104
v_permlane32_swap_b32 v97, v105
v_permlane32_swap_b32 v98, v106
v_permlane32_swap_b32 v99, v107
s_add_u32 s38, s35, 5
s_and_b32 s38, s38, 15
s_mul_i32 s38, s38, 458752
s_add_u32 m0, s50, 98304
s_nop 0
buffer_load_dwordx4 v6, s[16:19], s38 offen lds
v_add_f32 v96, v96, v104
v_add_f32 v97, v97, v105
v_add_f32 v98, v98, v106
s_add_u32 m0, s50, 99328
s_nop 0
buffer_load_dwordx4 v7, s[16:19], s38 offen lds
v_add_f32 v99, v99, v107
v_mov_b32 v100, v96
v_mov_b32 v101, v97
s_add_u32 m0, s50, 100352
s_nop 0
buffer_load_dwordx4 v8, s[16:19], s38 offen lds
v_mov_b32 v102, v98
v_mov_b32 v103, v99
s_nop 0
s_add_u32 m0, s50, 101376
s_add_u32 s38, s38, 114688
buffer_load_dwordx4 v6, s[16:19], s38 offen lds
v_permlane16_swap_b32 v96, v100
v_permlane16_swap_b32 v97, v101
v_permlane16_swap_b32 v98, v102
v_permlane16_swap_b32 v99, v103
s_add_u32 m0, s50, 102400
s_nop 0
buffer_load_dwordx4 v7, s[16:19], s38 offen lds
s_add_u32 m0, s50, 103424
s_nop 0
buffer_load_dwordx4 v8, s[16:19], s38 offen lds
s_waitcnt vmcnt(10)
s_barrier
s_add_u32 s37, s35, 6
s_and_b32 s37, s37, 15
s_mul_i32 s37, s37, 16384
s_add_u32 m0, s39, 0
s_nop 0
buffer_load_dwordx4 v3, s[8:11], s37 offen sc1 lds
v_add_f32 v96, v96, v100
v_add_f32 v97, v97, v101
v_add_f32 v98, v98, v102
buffer_load_dwordx4 v3, s[8:11], s37 offen offset:1024 sc1 lds
v_add_f32 v99, v99, v103
s_nop 0
v_add_f32_dpp v96, v96, v96 row_ror:8 row_mask:0xf bank_mask:0xf
buffer_load_dwordx4 v3, s[8:11], s37 offen offset:2048 sc1 lds
v_add_f32_dpp v97, v97, v97 row_ror:8 row_mask:0xf bank_mask:0xf
v_add_f32_dpp v98, v98, v98 row_ror:8 row_mask:0xf bank_mask:0xf
v_add_f32_dpp v99, v99, v99 row_ror:8 row_mask:0xf bank_mask:0xf
v_mul_f32 v96, 0x3a800000, v96
buffer_load_dwordx4 v3, s[8:11], s37 offen offset:3072 sc1 lds
v_mul_f32 v97, 0x3a800000, v97
v_mul_f32 v98, 0x3a800000, v98
v_mul_f32 v99, 0x3a800000, v99
s_add_u32 s38, s35, 6
s_and_b32 s38, s38, 15
s_mul_i32 s38, s38, 458752
s_add_u32 m0, s50, 0
s_nop 0
buffer_load_dwordx4 v6, s[16:19], s38 offen lds
v_fma_f32 v97, -v96, v96, v97
v_fma_f32 v99, -v98, v98, v99
v_max_f32 v97, 0, v97
s_add_u32 m0, s50, 1024
s_nop 0
buffer_load_dwordx4 v7, s[16:19], s38 offen lds
v_max_f32 v99, 0, v99
v_add_f32 v97, 0x3727c5ac, v97
v_add_f32 v99, 0x3727c5ac, v99
v_rsq_f32 v97, v97
s_add_u32 m0, s50, 2048
s_nop 0
buffer_load_dwordx4 v8, s[16:19], s38 offen lds
v_rsq_f32 v99, v99
v_and_b32 v100, 7, v1
s_lshl_b32 s43, s47, 8
s_add_u32 m0, s50, 3072
s_add_u32 s38, s38, 114688
buffer_load_dwordx4 v6, s[16:19], s38 offen lds
s_add_u32 s43, s43, 147456
v_lshl_add_u32 v100, v100, 4, s43
v_lshrrev_b32 v101, 5, v1
v_lshl_add_u32 v100, v101, 7, v100
s_add_u32 m0, s50, 4096
s_nop 0
buffer_load_dwordx4 v7, s[16:19], s38 offen lds
s_add_u32 m0, s50, 5120
s_nop 0
buffer_load_dwordx4 v8, s[16:19], s38 offen lds
s_waitcnt vmcnt(10)
s_barrier
ds_write_b128 v100, v[96:99]
s_waitcnt lgkmcnt(0)
s_add_u32 s37, s35, 7
s_and_b32 s37, s37, 15
s_mul_i32 s37, s37, 16384
s_add_u32 m0, s39, 49152
s_nop 0
buffer_load_dwordx4 v3, s[8:11], s37 offen sc1 lds
s_load_dword s3, s[4:5], 93312
buffer_load_dwordx4 v3, s[8:11], s37 offen offset:1024 sc1 lds
s_load_dword s3, s[4:5], 93376
s_and_b32 s44, s36, 3
buffer_load_dwordx4 v3, s[8:11], s37 offen offset:2048 sc1 lds
s_mul_i32 s43, s2, 28672
buffer_load_dwordx4 v3, s[8:11], s37 offen offset:3072 sc1 lds
s_mul_i32 s44, s44, 7168
s_add_u32 s43, s43, s44
s_add_u32 s38, s35, 7
s_and_b32 s38, s38, 15
s_mul_i32 s38, s38, 458752
s_add_u32 m0, s50, 49152
s_nop 0
buffer_load_dwordx4 v6, s[16:19], s38 offen lds
s_add_u32 s4, s76, s43
s_add_u32 m0, s50, 50176
s_nop 0
buffer_load_dwordx4 v7, s[16:19], s38 offen lds
s_addc_u32 s5, s77, 0
s_load_dword s3, s[4:5], 0
s_add_u32 m0, s50, 51200
s_nop 0
buffer_load_dwordx4 v8, s[16:19], s38 offen lds
s_load_dword s3, s[4:5], 64
s_add_u32 m0, s50, 52224
s_add_u32 s38, s38, 114688
buffer_load_dwordx4 v6, s[16:19], s38 offen lds
s_load_dword s3, s[4:5], 128
s_load_dword s3, s[4:5], 192
s_add_u32 m0, s50, 53248
s_nop 0
buffer_load_dwordx4 v7, s[16:19], s38 offen lds
s_add_u32 m0, s50, 54272
s_nop 0
buffer_load_dwordx4 v8, s[16:19], s38 offen lds
s_waitcnt vmcnt(10)
s_barrier
s_add_u32 s37, s35, 8
s_and_b32 s37, s37, 15
s_mul_i32 s37, s37, 16384
s_add_u32 m0, s39, 98304
s_nop 0
buffer_load_dwordx4 v3, s[8:11], s37 offen sc1 lds
s_load_dword s3, s[4:5], 256
s_load_dword s3, s[4:5], 320
s_load_dword s3, s[4:5], 384
buffer_load_dwordx4 v3, s[8:11], s37 offen offset:1024 sc1 lds
s_load_dword s3, s[4:5], 448
s_load_dword s3, s[4:5], 512
s_load_dword s3, s[4:5], 576
buffer_load_dwordx4 v3, s[8:11], s37 offen offset:2048 sc1 lds
v_lshrrev_b32 v28, 2, v1
v_and_b32 v29, 7, v28
v_mul_u32_u24 v28, 256, v28
buffer_load_dwordx4 v3, s[8:11], s37 offen offset:3072 sc1 lds
v_lshl_add_u32 v28, v29, 5, v28
v_and_b32 v29, 3, v1
v_lshl_add_u32 v11, v29, 3, v28
s_lshl_b32 s43, s63, 7
s_add_u32 s38, s35, 8
s_and_b32 s38, s38, 15
s_mul_i32 s38, s38, 458752
s_add_u32 m0, s50, 98304
s_nop 0
buffer_load_dwordx4 v6, s[16:19], s38 offen lds
v_xor_b32 v11, s43, v11
v_add_u32 v11, 16384, v11
v_xor_b32 v12, 32, v11
s_add_u32 m0, s50, 99328
s_nop 0
buffer_load_dwordx4 v7, s[16:19], s38 offen lds
v_xor_b32 v13, 64, v11
v_xor_b32 v14, 96, v11
v_add_u32 v15, 49152, v11
s_add_u32 m0, s50, 100352
s_nop 0
buffer_load_dwordx4 v8, s[16:19], s38 offen lds
v_add_u32 v16, 49152, v12
v_add_u32 v17, 49152, v13
v_add_u32 v18, 49152, v14
s_add_u32 m0, s50, 101376
s_add_u32 s38, s38, 114688
buffer_load_dwordx4 v6, s[16:19], s38 offen lds
v_add_u32 v19, 98304, v11
v_add_u32 v20, 98304, v12
v_add_u32 v21, 98304, v13
v_add_u32 v22, 98304, v14
s_add_u32 m0, s50, 102400
s_nop 0
buffer_load_dwordx4 v7, s[16:19], s38 offen lds
s_add_u32 m0, s50, 103424
s_nop 0
buffer_load_dwordx4 v8, s[16:19], s38 offen lds
s_waitcnt vmcnt(10)
s_barrier
s_cmp_eq_u32 s47, 3
s_cbranch_scc0 Lw_128
s_mul_i32 s60, s35, 96
s_add_u32 s61, s60, 95
s_and_b32 s60, s60, 0xff80
s_and_b32 s61, s61, 0xff80
s_add_u32 s60, s60, 28323840
s_add_u32 s61, s61, 28323840
s_load_dword s92, s[82:83], s60 glc
s_load_dword s93, s[82:83], s61 glc
Lw_128:
s_add_u32 s37, s35, 9
s_and_b32 s37, s37, 15
s_mul_i32 s37, s37, 16384
s_add_u32 m0, s39, 0
s_nop 0
buffer_load_dwordx4 v3, s[8:11], s37 offen sc1 lds
buffer_load_dwordx4 v3, s[8:11], s37 offen offset:1024 sc1 lds
buffer_load_dwordx4 v3, s[8:11], s37 offen offset:2048 sc1 lds
buffer_load_dwordx4 v3, s[8:11], s37 offen offset:3072 sc1 lds
s_add_u32 s38, s35, 9
s_and_b32 s38, s38, 15
s_mul_i32 s38, s38, 458752
s_add_u32 m0, s50, 0
s_nop 0
buffer_load_dwordx4 v6, s[16:19], s38 offen lds
s_add_u32 m0, s50, 1024
s_nop 0
buffer_load_dwordx4 v7, s[16:19], s38 offen lds
s_add_u32 m0, s50, 2048
s_nop 0
buffer_load_dwordx4 v8, s[16:19], s38 offen lds
s_add_u32 m0, s50, 3072
s_add_u32 s38, s38, 114688
buffer_load_dwordx4 v6, s[16:19], s38 offen lds
s_add_u32 m0, s50, 4096
s_nop 0
buffer_load_dwordx4 v7, s[16:19], s38 offen lds
s_add_u32 m0, s50, 5120
s_nop 0
buffer_load_dwordx4 v8, s[16:19], s38 offen lds
s_waitcnt vmcnt(10)
s_barrier
s_add_u32 s37, s35, 10
s_and_b32 s37, s37, 15
s_mul_i32 s37, s37, 16384
s_add_u32 m0, s39, 49152
s_nop 0
buffer_load_dwordx4 v3, s[8:11], s37 offen sc1 lds
buffer_load_dwordx4 v3, s[8:11], s37 offen offset:1024 sc1 lds
buffer_load_dwordx4 v3, s[8:11], s37 offen offset:2048 sc1 lds
buffer_load_dwordx4 v3, s[8:11], s37 offen offset:3072 sc1 lds
s_add_u32 s38, s35, 10
s_and_b32 s38, s38, 15
s_mul_i32 s38, s38, 458752
s_add_u32 m0, s50, 49152
s_nop 0
buffer_load_dwordx4 v6, s[16:19], s38 offen lds
s_add_u32 m0, s50, 50176
s_nop 0
buffer_load_dwordx4 v7, s[16:19], s38 offen lds
s_add_u32 m0, s50, 51200
s_nop 0
buffer_load_dwordx4 v8, s[16:19], s38 offen lds
s_add_u32 m0, s50, 52224
s_add_u32 s38, s38, 114688
buffer_load_dwordx4 v6, s[16:19], s38 offen lds
s_add_u32 m0, s50, 53248
s_nop 0
buffer_load_dwordx4 v7, s[16:19], s38 offen lds
s_branch Lov_14
.p2align 12
.fill 112, 4, 0xbf800000
Lst_14_0:
s_branch Lwr_159
Lst_14_1:
s_branch Lst_18_0
s_nop 0
Lov_14:
s_add_u32 m0, s50, 54272
s_nop 0
buffer_load_dwordx4 v8, s[16:19], s38 offen lds
s_mov_b32 s38, 0
buffer_load_dwordx4 v[40:43], v24, s[88:91], s38 offen
s_mov_b32 s38, 28672
buffer_load_dwordx4 v[44:47], v24, s[88:91], s38 offen
s_mov_b32 s38, 57344
buffer_load_dwordx4 v[48:51], v24, s[88:91], s38 offen
s_mov_b32 s38, 86016
buffer_load_dwordx4 v[52:55], v24, s[88:91], s38 offen
s_mov_b32 s38, 114688
buffer_load_dwordx4 v[56:59], v24, s[88:91], s38 offen
s_mov_b32 s38, 143360
buffer_load_dwordx4 v[60:63], v24, s[88:91], s38 offen
s_mov_b32 s38, 172032
buffer_load_dwordx4 v[64:67], v24, s[88:91], s38 offen
s_mov_b32 s38, 200704
buffer_load_dwordx4 v[68:71], v24, s[88:91], s38 offen
s_waitcnt vmcnt(18)
s_cmp_eq_u32 s47, 3
s_cbranch_scc0 Lw_129
s_mov_b32 s41, 0x40000
Lcp_130:
s_waitcnt lgkmcnt(0)
s_and_b32 s92, s92, s93
s_cmp_eq_u32 s92, 16
s_cbranch_scc1 Lco_131
s_load_dword s92, s[82:83], s60 glc
s_load_dword s93, s[82:83], s61 glc
s_sub_u32 s41, s41, 1
s_cmp_lg_u32 s41, 0
s_cbranch_scc1 Lcp_130
s_waitcnt lgkmcnt(0)
Lco_131:
Lw_129:
s_barrier
s_mov_b32 s45, s47
s_cmp_ge_u32 s45, 3
s_cselect_b32 s43, 1, 0
s_mul_i32 s44, s43, 3
s_sub_u32 s45, s45, s44
s_lshl_b32 s45, s45, 7
s_mul_i32 s52, s43, 896
s_add_u32 s52, s52, s45
s_add_u32 s52, s52, 148992
s_mul_i32 s43, s43, 14336
s_add_u32 s43, s43, s45
s_mul_i32 s44, s35, 384
s_add_u32 s43, s43, s44
s_add_u32 s60, s43, 8192
s_add_u32 s45, s47, 4
s_min_u32 s45, s45, 5
s_cmp_ge_u32 s45, 3
s_cselect_b32 s43, 1, 0
s_mul_i32 s44, s43, 3
s_sub_u32 s45, s45, s44
s_lshl_b32 s45, s45, 7
s_mul_i32 s53, s43, 896
s_add_u32 s53, s53, s45
s_add_u32 s53, s53, 148992
s_mul_i32 s43, s43, 14336
s_add_u32 s43, s43, s45
s_mul_i32 s44, s35, 384
s_add_u32 s43, s43, s44
s_add_u32 s61, s43, 8192
v_lshrrev_b32 v104, 3, v1
v_mul_u32_u24 v104, 28672, v104
v_and_b32 v105, 7, v1
v_lshl_add_u32 v104, v105, 4, v104
buffer_load_dwordx4 v[96:99], v104, s[84:87], s60 offen sc1
s_load_dword s3, s[4:5], 640
buffer_load_dwordx4 v[100:103], v104, s[84:87], s61 offen sc1
s_load_dword s3, s[4:5], 704
s_add_u32 s37, s35, 11
s_and_b32 s37, s37, 15
s_mul_i32 s37, s37, 16384
s_add_u32 m0, s39, 98304
s_nop 0
buffer_load_dwordx4 v3, s[8:11], s37 offen sc1 lds
s_load_dword s3, s[4:5], 768
buffer_load_dwordx4 v3, s[8:11], s37 offen offset:1024 sc1 lds
s_load_dword s3, s[4:5], 832
s_load_dword s3, s[4:5], 896
buffer_load_dwordx4 v3, s[8:11], s37 offen offset:2048 sc1 lds
s_load_dword s3, s[4:5], 960
buffer_load_dwordx4 v3, s[8:11], s37 offen offset:3072 sc1 lds
v_cmp_gt_u32 vcc, 32, v1
s_add_u32 s38, s35, 11
s_and_b32 s38, s38, 15
s_mul_i32 s38, s38, 458752
s_add_u32 m0, s50, 98304
s_nop 0
buffer_load_dwordx4 v6, s[16:19], s38 offen lds
v_mov_b32 v104, s52
v_mov_b32 v106, s53
s_add_u32 m0, s50, 99328
s_nop 0
buffer_load_dwordx4 v7, s[16:19], s38 offen lds
v_cndmask_b32 v104, v106, v104, vcc
s_add_u32 m0, s50, 100352
s_nop 0
buffer_load_dwordx4 v8, s[16:19], s38 offen lds
v_lshl_add_u32 v104, v105, 4, v104
s_add_u32 m0, s50, 101376
s_add_u32 s38, s38, 114688
buffer_load_dwordx4 v6, s[16:19], s38 offen lds
v_bfe_u32 v105, v1, 4, 1
v_lshl_add_u32 v104, v105, 2, v104
s_add_u32 m0, s50, 102400
s_nop 0
buffer_load_dwordx4 v7, s[16:19], s38 offen lds
s_add_u32 m0, s50, 103424
s_nop 0
buffer_load_dwordx4 v8, s[16:19], s38 offen lds
s_waitcnt vmcnt(20)
s_barrier
s_add_u32 s37, s35, 12
s_and_b32 s37, s37, 15
s_mul_i32 s37, s37, 16384
s_add_u32 m0, s39, 0
s_nop 0
buffer_load_dwordx4 v3, s[8:11], s37 offen sc1 lds
buffer_load_dwordx4 v3, s[8:11], s37 offen offset:1024 sc1 lds
buffer_load_dwordx4 v3, s[8:11], s37 offen offset:2048 sc1 lds
buffer_load_dwordx4 v3, s[8:11], s37 offen offset:3072 sc1 lds
s_add_u32 s38, s35, 12
s_and_b32 s38, s38, 15
s_mul_i32 s38, s38, 458752
s_add_u32 m0, s50, 0
s_nop 0
buffer_load_dwordx4 v6, s[16:19], s38 offen lds
s_add_u32 m0, s50, 1024
s_nop 0
buffer_load_dwordx4 v7, s[16:19], s38 offen lds
s_add_u32 m0, s50, 2048
s_nop 0
buffer_load_dwordx4 v8, s[16:19], s38 offen lds
s_add_u32 m0, s50, 3072
s_add_u32 s38, s38, 114688
buffer_load_dwordx4 v6, s[16:19], s38 offen lds
s_add_u32 m0, s50, 4096
s_nop 0
buffer_load_dwordx4 v7, s[16:19], s38 offen lds
s_add_u32 m0, s50, 5120
s_nop 0
buffer_load_dwordx4 v8, s[16:19], s38 offen lds
s_waitcnt vmcnt(10)
s_barrier
v_permlane32_swap_b32 v96, v100
v_permlane32_swap_b32 v97, v101
v_permlane32_swap_b32 v98, v102
v_permlane32_swap_b32 v99, v103
v_add_f32 v96, v96, v100
v_add_f32 v97, v97, v101
v_add_f32 v98, v98, v102
v_add_f32 v99, v99, v103
s_nop 1
v_permlane16_swap_b32 v96, v97
v_permlane16_swap_b32 v98, v99
v_add_f32 v96, v96, v97
v_add_f32 v98, v98, v99
s_nop 1
v_add_f32_dpp v96, v96, v96 row_ror:8 row_mask:0xf bank_mask:0xf
v_add_f32_dpp v98, v98, v98 row_ror:8 row_mask:0xf bank_mask:0xf
ds_write_b32 v104, v96
ds_write_b32 v104, v98 offset:8
s_waitcnt lgkmcnt(0)
s_add_u32 s37, s35, 13
s_and_b32 s37, s37, 15
s_mul_i32 s37, s37, 16384
s_add_u32 m0, s39, 49152
s_nop 0
buffer_load_dwordx4 v3, s[8:11], s37 offen sc1 lds
s_load_dword s3, s[4:5], 1024
s_load_dword s3, s[4:5], 1088
s_load_dword s3, s[4:5], 1152
s_load_dword s3, s[4:5], 1216
buffer_load_dwordx4 v3, s[8:11], s37 offen offset:1024 sc1 lds
s_load_dword s3, s[4:5], 1280
s_load_dword s3, s[4:5], 1344
v_lshlrev_b32 v72, 16, v40
v_and_b32 v73, 0xffff0000, v40
v_lshlrev_b32 v74, 16, v41
buffer_load_dwordx4 v3, s[8:11], s37 offen offset:2048 sc1 lds
v_and_b32 v75, 0xffff0000, v41
v_lshlrev_b32 v76, 16, v42
v_and_b32 v77, 0xffff0000, v42
v_lshlrev_b32 v78, 16, v43
v_and_b32 v79, 0xffff0000, v43
buffer_load_dwordx4 v3, s[8:11], s37 offen offset:3072 sc1 lds
v_lshlrev_b32 v80, 16, v44
v_and_b32 v81, 0xffff0000, v44
v_lshlrev_b32 v82, 16, v45
v_and_b32 v83, 0xffff0000, v45
v_lshlrev_b32 v84, 16, v46
s_add_u32 s38, s35, 13
s_and_b32 s38, s38, 15
s_mul_i32 s38, s38, 458752
s_add_u32 m0, s50, 49152
s_nop 0
buffer_load_dwordx4 v6, s[16:19], s38 offen lds
v_and_b32 v85, 0xffff0000, v46
v_lshlrev_b32 v86, 16, v47
v_and_b32 v87, 0xffff0000, v47
v_add_f32 v72, v72, v80
v_add_f32 v73, v73, v81
s_add_u32 m0, s50, 50176
s_nop 0
buffer_load_dwordx4 v7, s[16:19], s38 offen lds
v_add_f32 v74, v74, v82
v_add_f32 v75, v75, v83
v_add_f32 v76, v76, v84
v_add_f32 v77, v77, v85
v_add_f32 v78, v78, v86
s_add_u32 m0, s50, 51200
s_nop 0
buffer_load_dwordx4 v8, s[16:19], s38 offen lds
v_add_f32 v79, v79, v87
v_lshlrev_b32 v80, 16, v48
v_and_b32 v81, 0xffff0000, v48
v_lshlrev_b32 v82, 16, v49
v_and_b32 v83, 0xffff0000, v49
s_add_u32 m0, s50, 52224
s_add_u32 s38, s38, 114688
buffer_load_dwordx4 v6, s[16:19], s38 offen lds
v_lshlrev_b32 v84, 16, v50
v_and_b32 v85, 0xffff0000, v50
v_lshlrev_b32 v86, 16, v51
v_and_b32 v87, 0xffff0000, v51
v_add_f32 v72, v72, v80
s_add_u32 m0, s50, 53248
s_nop 0
buffer_load_dwordx4 v7, s[16:19], s38 offen lds
s_add_u32 m0, s50, 54272
s_nop 0
buffer_load_dwordx4 v8, s[16:19], s38 offen lds
s_waitcnt vmcnt(10)
s_barrier
s_add_u32 s37, s35, 14
s_and_b32 s37, s37, 15
s_mul_i32 s37, s37, 16384
s_add_u32 m0, s39, 98304
s_nop 0
buffer_load_dwordx4 v3, s[8:11], s37 offen sc1 lds
s_load_dword s3, s[4:5], 1408
s_load_dword s3, s[4:5], 1472
s_load_dword s3, s[4:5], 1536
s_load_dword s3, s[4:5], 1600
s_load_dword s3, s[4:5], 1664
buffer_load_dwordx4 v3, s[8:11], s37 offen offset:1024 sc1 lds
s_load_dword s3, s[4:5], 1728
v_add_f32 v73, v73, v81
v_add_f32 v74, v74, v82
v_add_f32 v75, v75, v83
v_add_f32 v76, v76, v84
buffer_load_dwordx4 v3, s[8:11], s37 offen offset:2048 sc1 lds
v_add_f32 v77, v77, v85
v_add_f32 v78, v78, v86
v_add_f32 v79, v79, v87
v_lshlrev_b32 v80, 16, v52
v_and_b32 v81, 0xffff0000, v52
buffer_load_dwordx4 v3, s[8:11], s37 offen offset:3072 sc1 lds
v_lshlrev_b32 v82, 16, v53
v_and_b32 v83, 0xffff0000, v53
v_lshlrev_b32 v84, 16, v54
v_and_b32 v85, 0xffff0000, v54
v_lshlrev_b32 v86, 16, v55
s_add_u32 s38, s35, 14
s_and_b32 s38, s38, 15
s_mul_i32 s38, s38, 458752
s_add_u32 m0, s50, 98304
s_nop 0
buffer_load_dwordx4 v6, s[16:19], s38 offen lds
v_and_b32 v87, 0xffff0000, v55
v_add_f32 v72, v72, v80
v_add_f32 v73, v73, v81
v_add_f32 v74, v74, v82
v_add_f32 v75, v75, v83
s_add_u32 m0, s50, 99328
s_nop 0
buffer_load_dwordx4 v7, s[16:19], s38 offen lds
v_add_f32 v76, v76, v84
v_add_f32 v77, v77, v85
v_add_f32 v78, v78, v86
v_add_f32 v79, v79, v87
v_lshlrev_b32 v80, 16, v56
s_add_u32 m0, s50, 100352
s_nop 0
buffer_load_dwordx4 v8, s[16:19], s38 offen lds
v_and_b32 v81, 0xffff0000, v56
v_lshlrev_b32 v82, 16, v57
v_and_b32 v83, 0xffff0000, v57
v_lshlrev_b32 v84, 16, v58
v_and_b32 v85, 0xffff0000, v58
s_add_u32 m0, s50, 101376
s_add_u32 s38, s38, 114688
buffer_load_dwordx4 v6, s[16:19], s38 offen lds
v_lshlrev_b32 v86, 16, v59
v_and_b32 v87, 0xffff0000, v59
v_add_f32 v72, v72, v80
v_add_f32 v73, v73, v81
v_add_f32 v74, v74, v82
s_add_u32 m0, s50, 102400
s_nop 0
buffer_load_dwordx4 v7, s[16:19], s38 offen lds
s_add_u32 m0, s50, 103424
s_nop 0
buffer_load_dwordx4 v8, s[16:19], s38 offen lds
s_waitcnt vmcnt(10)
s_barrier
s_add_u32 s37, s35, 15
s_and_b32 s37, s37, 15
s_mul_i32 s37, s37, 16384
s_add_u32 m0, s39, 0
s_nop 0
buffer_load_dwordx4 v3, s[8:11], s37 offen sc1 lds
v_add_f32 v75, v75, v83
v_add_f32 v76, v76, v84
v_add_f32 v77, v77, v85
v_add_f32 v78, v78, v86
buffer_load_dwordx4 v3, s[8:11], s37 offen offset:1024 sc1 lds
v_add_f32 v79, v79, v87
v_lshlrev_b32 v80, 16, v60
v_and_b32 v81, 0xffff0000, v60
v_lshlrev_b32 v82, 16, v61
buffer_load_dwordx4 v3, s[8:11], s37 offen offset:2048 sc1 lds
v_and_b32 v83, 0xffff0000, v61
v_lshlrev_b32 v84, 16, v62
v_and_b32 v85, 0xffff0000, v62
v_lshlrev_b32 v86, 16, v63
buffer_load_dwordx4 v3, s[8:11], s37 offen offset:3072 sc1 lds
v_and_b32 v87, 0xffff0000, v63
v_add_f32 v72, v72, v80
v_add_f32 v73, v73, v81
v_add_f32 v74, v74, v82
s_add_u32 s38, s35, 15
s_and_b32 s38, s38, 15
s_mul_i32 s38, s38, 458752
s_add_u32 m0, s50, 0
s_nop 0
buffer_load_dwordx4 v6, s[16:19], s38 offen lds
v_add_f32 v75, v75, v83
v_add_f32 v76, v76, v84
v_add_f32 v77, v77, v85
v_add_f32 v78, v78, v86
s_add_u32 m0, s50, 1024
s_nop 0
buffer_load_dwordx4 v7, s[16:19], s38 offen lds
v_add_f32 v79, v79, v87
v_lshlrev_b32 v80, 16, v64
v_and_b32 v81, 0xffff0000, v64
v_lshlrev_b32 v82, 16, v65
s_add_u32 m0, s50, 2048
s_nop 0
buffer_load_dwordx4 v8, s[16:19], s38 offen lds
v_and_b32 v83, 0xffff0000, v65
v_lshlrev_b32 v84, 16, v66
v_and_b32 v85, 0xffff0000, v66
v_lshlrev_b32 v86, 16, v67
s_add_u32 m0, s50, 3072
s_add_u32 s38, s38, 114688
buffer_load_dwordx4 v6, s[16:19], s38 offen lds
v_and_b32 v87, 0xffff0000, v67
v_add_f32 v72, v72, v80
v_add_f32 v73, v73, v81
v_add_f32 v74, v74, v82
v_add_f32 v75, v75, v83
s_add_u32 m0, s50, 4096
s_nop 0
buffer_load_dwordx4 v7, s[16:19], s38 offen lds
s_add_u32 m0, s50, 5120
s_nop 0
buffer_load_dwordx4 v8, s[16:19], s38 offen lds
s_waitcnt vmcnt(10)
s_barrier
s_add_u32 s37, s35, 0
s_and_b32 s37, s37, 15
s_mul_i32 s37, s37, 16384
s_add_u32 m0, s39, 49152
s_nop 0
buffer_load_dwordx4 v3, s[8:11], s37 offen sc1 lds
v_add_f32 v76, v76, v84
v_add_f32 v77, v77, v85
v_add_f32 v78, v78, v86
buffer_load_dwordx4 v3, s[8:11], s37 offen offset:1024 sc1 lds
v_add_f32 v79, v79, v87
v_lshlrev_b32 v80, 16, v68
v_and_b32 v81, 0xffff0000, v68
buffer_load_dwordx4 v3, s[8:11], s37 offen offset:2048 sc1 lds
v_lshlrev_b32 v82, 16, v69
v_and_b32 v83, 0xffff0000, v69
v_lshlrev_b32 v84, 16, v70
v_and_b32 v85, 0xffff0000, v70
buffer_load_dwordx4 v3, s[8:11], s37 offen offset:3072 sc1 lds
v_lshlrev_b32 v86, 16, v71
v_and_b32 v87, 0xffff0000, v71
v_add_f32 v72, v72, v80
s_add_u32 s38, s35, 0
s_and_b32 s38, s38, 15
s_mul_i32 s38, s38, 458752
s_add_u32 m0, s40, 49152
s_nop 0
buffer_load_dwordx4 v4, s[12:15], s38 offen lds
v_add_f32 v73, v73, v81
v_add_f32 v74, v74, v82
v_add_f32 v75, v75, v83
v_add_f32 v76, v76, v84
s_add_u32 m0, s40, 50176
s_nop 0
buffer_load_dwordx4 v5, s[12:15], s38 offen lds
v_add_f32 v77, v77, v85
v_add_f32 v78, v78, v86
v_add_f32 v79, v79, v87
s_add_u32 m0, s40, 51200
s_add_u32 s38, s38, 57344
buffer_load_dwordx4 v4, s[12:15], s38 offen lds
s_nop 0
v_permlane32_swap_b32 v72, v76
v_permlane32_swap_b32 v73, v77
s_add_u32 m0, s40, 52224
s_nop 0
buffer_load_dwordx4 v5, s[12:15], s38 offen lds
v_permlane32_swap_b32 v74, v78
v_permlane32_swap_b32 v75, v79
v_add_f32 v72, v72, v76
v_add_f32 v73, v73, v77
s_add_u32 m0, s40, 53248
s_add_u32 s38, s38, 57344
buffer_load_dwordx4 v4, s[12:15], s38 offen lds
v_add_f32 v74, v74, v78
v_add_f32 v75, v75, v79
s_nop 0
s_add_u32 m0, s40, 54272
s_nop 0
buffer_load_dwordx4 v5, s[12:15], s38 offen lds
v_permlane16_swap_b32 v72, v74
v_permlane16_swap_b32 v73, v75
v_add_f32 v72, v72, v74
v_add_f32 v73, v73, v75
s_add_u32 m0, s40, 55296
s_add_u32 s38, s38, 57344
buffer_load_dwordx4 v4, s[12:15], s38 offen lds
s_add_u32 m0, s40, 56320
s_nop 0
buffer_load_dwordx4 v5, s[12:15], s38 offen lds
s_waitcnt vmcnt(12)
s_barrier
s_lshl_b32 s43, s47, 9
s_add_u32 s43, s43, 153600
v_and_b32 v80, 15, v1
v_lshl_add_u32 v80, v80, 5, s43
v_lshrrev_b32 v81, 4, v1
v_lshl_add_u32 v80, v81, 3, v80
ds_write_b64 v80, v[72:73]
s_waitcnt lgkmcnt(0)
s_add_u32 s37, s35, 1
s_and_b32 s37, s37, 15
s_mul_i32 s37, s37, 16384
s_add_u32 m0, s39, 98304
s_nop 0
buffer_load_dwordx4 v3, s[8:11], s37 offen sc1 lds
s_bfe_u32 s61, s35, 0x10002
s_lshr_b32 s60, s35, 3
s_lshl_b32 s60, s60, 2
buffer_load_dwordx4 v3, s[8:11], s37 offen offset:1024 sc1 lds
s_and_b32 s43, s35, 3
s_add_u32 s60, s60, s43
s_lshl_b32 s43, s60, 8
buffer_load_dwordx4 v3, s[8:11], s37 offen offset:2048 sc1 lds
s_add_u32 s28, s76, s43
s_addc_u32 s29, s77, 0
s_mov_b32 s30, 7338240
buffer_load_dwordx4 v3, s[8:11], s37 offen offset:3072 sc1 lds
s_mov_b32 s31, 0x20000
s_mul_i32 s52, s61, 196608
s_mul_i32 s53, s61, 1572864
s_add_u32 s38, s35, 1
s_and_b32 s38, s38, 15
s_mul_i32 s38, s38, 458752
s_add_u32 m0, s40, 98304
s_nop 0
buffer_load_dwordx4 v4, s[12:15], s38 offen lds
s_mul_i32 s90, s61, 163840
s_mul_i32 s91, s61, 1310720
s_and_b32 s43, s35, 3
s_add_u32 m0, s40, 99328
s_nop 0
buffer_load_dwordx4 v5, s[12:15], s38 offen lds
s_mul_i32 s32, s43, 3
s_mul_i32 s33, s43, 10
s_lshr_b32 s33, s33, 2
s_add_u32 m0, s40, 100352
s_add_u32 s38, s38, 57344
buffer_load_dwordx4 v4, s[12:15], s38 offen lds
s_lshl_b32 s51, s47, 11
s_lshl_b32 s44, s47, 15
v_lshrrev_b32 v122, 4, v1
s_add_u32 m0, s40, 101376
s_nop 0
buffer_load_dwordx4 v5, s[12:15], s38 offen lds
v_lshlrev_b32 v123, 1, v122
v_and_b32 v23, 15, v1
v_xor_b32 v23, v23, v123
s_add_u32 m0, s40, 102400
s_add_u32 s38, s38, 57344
buffer_load_dwordx4 v4, s[12:15], s38 offen lds
v_lshlrev_b32 v23, 4, v23
v_mul_u32_u24 v122, 2048, v122
v_add_u32 v23, v23, v122
s_add_u32 m0, s40, 103424
s_nop 0
buffer_load_dwordx4 v5, s[12:15], s38 offen lds
v_add_u32 v23, s44, v23
v_xor_b32 v24, 128, v23
v_add_u32 v24, 8192, v24
s_add_u32 m0, s40, 104448
s_add_u32 s38, s38, 57344
buffer_load_dwordx4 v4, s[12:15], s38 offen lds
s_add_u32 m0, s40, 105472
s_nop 0
buffer_load_dwordx4 v5, s[12:15], s38 offen lds
s_waitcnt vmcnt(12)
s_barrier
ds_read_b128 v[28:31], v9 offset:49152
ds_read_b64_tr_b16 v[44:45], v15 offset:0
ds_read_b64_tr_b16 v[46:47], v15 offset:4096
ds_read_b64_tr_b16 v[48:49], v16 offset:0
ds_read_b64_tr_b16 v[50:51], v16 offset:4096
ds_read_b64_tr_b16 v[52:53], v17 offset:0
ds_read_b64_tr_b16 v[54:55], v17 offset:4096
ds_read_b64_tr_b16 v[56:57], v18 offset:0
ds_read_b64_tr_b16 v[58:59], v18 offset:4096
ds_read_b64_tr_b16 v[60:61], v15 offset:16384
ds_read_b64_tr_b16 v[62:63], v15 offset:20480
ds_read_b64_tr_b16 v[64:65], v16 offset:16384
ds_read_b64_tr_b16 v[66:67], v16 offset:20480
ds_read_b64_tr_b16 v[68:69], v17 offset:16384
ds_read_b64_tr_b16 v[70:71], v17 offset:20480
ds_read_b64_tr_b16 v[72:73], v18 offset:16384
ds_read_b64_tr_b16 v[74:75], v18 offset:20480
ds_read_b128 v[32:35], v9 offset:50176
ds_read_b128 v[36:39], v9 offset:51200
ds_read_b128 v[40:43], v9 offset:52224
s_waitcnt lgkmcnt(0)
v_mfma_f32_16x16x32_bf16 v[124:127], v[44:47], v[28:31], 0
ds_read_b128 v[76:79], v9 offset:57344
v_mfma_f32_16x16x32_bf16 v[128:131], v[48:51], v[28:31], 0
ds_read_b64_tr_b16 v[92:93], v15 offset:8192
v_mfma_f32_16x16x32_bf16 v[132:135], v[52:55], v[28:31], 0
ds_read_b64_tr_b16 v[94:95], v15 offset:12288
v_mfma_f32_16x16x32_bf16 v[136:139], v[56:59], v[28:31], 0
ds_read_b64_tr_b16 v[96:97], v16 offset:8192
v_mfma_f32_16x16x32_bf16 v[140:143], v[60:63], v[28:31], 0
ds_read_b64_tr_b16 v[98:99], v16 offset:12288
v_mfma_f32_16x16x32_bf16 v[144:147], v[64:67], v[28:31], 0
ds_read_b64_tr_b16 v[100:101], v17 offset:8192
v_mfma_f32_16x16x32_bf16 v[148:151], v[68:71], v[28:31], 0
ds_read_b64_tr_b16 v[102:103], v17 offset:12288
v_mfma_f32_16x16x32_bf16 v[152:155], v[72:75], v[28:31], 0
ds_read_b64_tr_b16 v[104:105], v18 offset:8192
v_mfma_f32_16x16x32_bf16 v[184:187], v[72:75], v[32:35], 0
ds_read_b64_tr_b16 v[106:107], v18 offset:12288
v_mfma_f32_16x16x32_bf16 v[180:183], v[68:71], v[32:35], 0
ds_read_b64_tr_b16 v[108:109], v15 offset:24576
v_mfma_f32_16x16x32_bf16 v[176:179], v[64:67], v[32:35], 0
ds_read_b64_tr_b16 v[110:111], v15 offset:28672
v_mfma_f32_16x16x32_bf16 v[172:175], v[60:63], v[32:35], 0
ds_read_b64_tr_b16 v[112:113], v16 offset:24576
v_mfma_f32_16x16x32_bf16 v[168:171], v[56:59], v[32:35], 0
ds_read_b64_tr_b16 v[114:115], v16 offset:28672
v_mfma_f32_16x16x32_bf16 v[164:167], v[52:55], v[32:35], 0
ds_read_b64_tr_b16 v[116:117], v17 offset:24576
v_mfma_f32_16x16x32_bf16 v[160:163], v[48:51], v[32:35], 0
ds_read_b64_tr_b16 v[118:119], v17 offset:28672
v_mfma_f32_16x16x32_bf16 v[156:159], v[44:47], v[32:35], 0
ds_read_b64_tr_b16 v[120:121], v18 offset:24576
v_mfma_f32_16x16x32_bf16 v[188:191], v[44:47], v[36:39], 0
ds_read_b64_tr_b16 v[122:123], v18 offset:28672
v_mfma_f32_16x16x32_bf16 v[192:195], v[48:51], v[36:39], 0
ds_read_b128 v[80:83], v9 offset:58368
v_mfma_f32_16x16x32_bf16 v[196:199], v[52:55], v[36:39], 0
ds_read_b128 v[84:87], v9 offset:59392
v_mfma_f32_16x16x32_bf16 v[200:203], v[56:59], v[36:39], 0
ds_read_b128 v[88:91], v9 offset:60416
v_mfma_f32_16x16x32_bf16 v[204:207], v[60:63], v[36:39], 0
v_mfma_f32_16x16x32_bf16 v[208:211], v[64:67], v[36:39], 0
v_mfma_f32_16x16x32_bf16 v[212:215], v[68:71], v[36:39], 0
v_mfma_f32_16x16x32_bf16 v[216:219], v[72:75], v[36:39], 0
v_mfma_f32_16x16x32_bf16 v[248:251], v[72:75], v[40:43], 0
v_mfma_f32_16x16x32_bf16 v[244:247], v[68:71], v[40:43], 0
s_branch Lov_15
.p2align 12
.fill 112, 4, 0xbf800000
Lst_15_0:
s_branch Lwr_168
s_nop 0
s_nop 0
Lov_15:
v_mfma_f32_16x16x32_bf16 v[240:243], v[64:67], v[40:43], 0
v_mfma_f32_16x16x32_bf16 v[236:239], v[60:63], v[40:43], 0
v_mfma_f32_16x16x32_bf16 v[232:235], v[56:59], v[40:43], 0
v_mfma_f32_16x16x32_bf16 v[228:231], v[52:55], v[40:43], 0
v_mfma_f32_16x16x32_bf16 v[224:227], v[48:51], v[40:43], 0
v_mfma_f32_16x16x32_bf16 v[220:223], v[44:47], v[40:43], 0
s_waitcnt vmcnt(0)
s_waitcnt lgkmcnt(0)
s_barrier
v_mfma_f32_16x16x32_bf16 v[124:127], v[92:95], v[76:79], v[124:127]
ds_read_b128 v[28:31], v10 offset:0
v_mfma_f32_16x16x32_bf16 v[128:131], v[96:99], v[76:79], v[128:131]
ds_read_b64_tr_b16 v[44:45], v19 offset:0
v_mfma_f32_16x16x32_bf16 v[132:135], v[100:103], v[76:79], v[132:135]
ds_read_b64_tr_b16 v[46:47], v19 offset:4096
v_mfma_f32_16x16x32_bf16 v[136:139], v[104:107], v[76:79], v[136:139]
ds_read_b64_tr_b16 v[48:49], v20 offset:0
v_mfma_f32_16x16x32_bf16 v[140:143], v[108:111], v[76:79], v[140:143]
ds_read_b64_tr_b16 v[50:51], v20 offset:4096
v_mfma_f32_16x16x32_bf16 v[144:147], v[112:115], v[76:79], v[144:147]
ds_read_b64_tr_b16 v[52:53], v21 offset:0
v_mfma_f32_16x16x32_bf16 v[148:151], v[116:119], v[76:79], v[148:151]
ds_read_b64_tr_b16 v[54:55], v21 offset:4096
v_mfma_f32_16x16x32_bf16 v[152:155], v[120:123], v[76:79], v[152:155]
ds_read_b64_tr_b16 v[56:57], v22 offset:0
v_mfma_f32_16x16x32_bf16 v[184:187], v[120:123], v[80:83], v[184:187]
ds_read_b64_tr_b16 v[58:59], v22 offset:4096
v_mfma_f32_16x16x32_bf16 v[180:183], v[116:119], v[80:83], v[180:183]
ds_read_b64_tr_b16 v[60:61], v19 offset:16384
v_mfma_f32_16x16x32_bf16 v[176:179], v[112:115], v[80:83], v[176:179]
ds_read_b64_tr_b16 v[62:63], v19 offset:20480
v_mfma_f32_16x16x32_bf16 v[172:175], v[108:111], v[80:83], v[172:175]
ds_read_b64_tr_b16 v[64:65], v20 offset:16384
v_mfma_f32_16x16x32_bf16 v[168:171], v[104:107], v[80:83], v[168:171]
ds_read_b64_tr_b16 v[66:67], v20 offset:20480
v_mfma_f32_16x16x32_bf16 v[164:167], v[100:103], v[80:83], v[164:167]
ds_read_b64_tr_b16 v[68:69], v21 offset:16384
v_mfma_f32_16x16x32_bf16 v[160:163], v[96:99], v[80:83], v[160:163]
ds_read_b64_tr_b16 v[70:71], v21 offset:20480
v_mfma_f32_16x16x32_bf16 v[156:159], v[92:95], v[80:83], v[156:159]
ds_read_b64_tr_b16 v[72:73], v22 offset:16384
v_mfma_f32_16x16x32_bf16 v[188:191], v[92:95], v[84:87], v[188:191]
ds_read_b64_tr_b16 v[74:75], v22 offset:20480
v_mfma_f32_16x16x32_bf16 v[192:195], v[96:99], v[84:87], v[192:195]
ds_read_b128 v[32:35], v10 offset:1024
v_mfma_f32_16x16x32_bf16 v[196:199], v[100:103], v[84:87], v[196:199]
ds_read_b128 v[36:39], v10 offset:2048
v_mfma_f32_16x16x32_bf16 v[200:203], v[104:107], v[84:87], v[200:203]
ds_read_b128 v[40:43], v10 offset:3072
v_mfma_f32_16x16x32_bf16 v[204:207], v[108:111], v[84:87], v[204:207]
v_mfma_f32_16x16x32_bf16 v[208:211], v[112:115], v[84:87], v[208:211]
v_mfma_f32_16x16x32_bf16 v[212:215], v[116:119], v[84:87], v[212:215]
v_mfma_f32_16x16x32_bf16 v[216:219], v[120:123], v[84:87], v[216:219]
v_mfma_f32_16x16x32_bf16 v[248:251], v[120:123], v[88:91], v[248:251]
v_mfma_f32_16x16x32_bf16 v[244:247], v[116:119], v[88:91], v[244:247]
v_mfma_f32_16x16x32_bf16 v[240:243], v[112:115], v[88:91], v[240:243]
v_mfma_f32_16x16x32_bf16 v[236:239], v[108:111], v[88:91], v[236:239]
v_mfma_f32_16x16x32_bf16 v[232:235], v[104:107], v[88:91], v[232:235]
v_mfma_f32_16x16x32_bf16 v[228:231], v[100:103], v[88:91], v[228:231]
v_mfma_f32_16x16x32_bf16 v[224:227], v[96:99], v[88:91], v[224:227]
v_mfma_f32_16x16x32_bf16 v[220:223], v[92:95], v[88:91], v[220:223]
s_mov_b32 s41, 5
Lk3l_132:
s_waitcnt lgkmcnt(0)
v_mfma_f32_16x16x32_bf16 v[124:127], v[44:47], v[28:31], v[124:127]
ds_read_b128 v[76:79], v10 offset:8192
v_mfma_f32_16x16x32_bf16 v[128:131], v[48:51], v[28:31], v[128:131]
ds_read_b64_tr_b16 v[92:93], v19 offset:8192
v_mfma_f32_16x16x32_bf16 v[132:135], v[52:55], v[28:31], v[132:135]
ds_read_b64_tr_b16 v[94:95], v19 offset:12288
v_mfma_f32_16x16x32_bf16 v[136:139], v[56:59], v[28:31], v[136:139]
ds_read_b64_tr_b16 v[96:97], v20 offset:8192
v_mfma_f32_16x16x32_bf16 v[140:143], v[60:63], v[28:31], v[140:143]
ds_read_b64_tr_b16 v[98:99], v20 offset:12288
v_mfma_f32_16x16x32_bf16 v[144:147], v[64:67], v[28:31], v[144:147]
ds_read_b64_tr_b16 v[100:101], v21 offset:8192
v_mfma_f32_16x16x32_bf16 v[148:151], v[68:71], v[28:31], v[148:151]
ds_read_b64_tr_b16 v[102:103], v21 offset:12288
v_mfma_f32_16x16x32_bf16 v[152:155], v[72:75], v[28:31], v[152:155]
ds_read_b64_tr_b16 v[104:105], v22 offset:8192
v_mfma_f32_16x16x32_bf16 v[184:187], v[72:75], v[32:35], v[184:187]
ds_read_b64_tr_b16 v[106:107], v22 offset:12288
v_mfma_f32_16x16x32_bf16 v[180:183], v[68:71], v[32:35], v[180:183]
ds_read_b64_tr_b16 v[108:109], v19 offset:24576
v_mfma_f32_16x16x32_bf16 v[176:179], v[64:67], v[32:35], v[176:179]
ds_read_b64_tr_b16 v[110:111], v19 offset:28672
v_mfma_f32_16x16x32_bf16 v[172:175], v[60:63], v[32:35], v[172:175]
ds_read_b64_tr_b16 v[112:113], v20 offset:24576
v_mfma_f32_16x16x32_bf16 v[168:171], v[56:59], v[32:35], v[168:171]
ds_read_b64_tr_b16 v[114:115], v20 offset:28672
v_mfma_f32_16x16x32_bf16 v[164:167], v[52:55], v[32:35], v[164:167]
ds_read_b64_tr_b16 v[116:117], v21 offset:24576
v_mfma_f32_16x16x32_bf16 v[160:163], v[48:51], v[32:35], v[160:163]
ds_read_b64_tr_b16 v[118:119], v21 offset:28672
v_mfma_f32_16x16x32_bf16 v[156:159], v[44:47], v[32:35], v[156:159]
ds_read_b64_tr_b16 v[120:121], v22 offset:24576
v_mfma_f32_16x16x32_bf16 v[188:191], v[44:47], v[36:39], v[188:191]
ds_read_b64_tr_b16 v[122:123], v22 offset:28672
v_mfma_f32_16x16x32_bf16 v[192:195], v[48:51], v[36:39], v[192:195]
ds_read_b128 v[80:83], v10 offset:9216
v_mfma_f32_16x16x32_bf16 v[196:199], v[52:55], v[36:39], v[196:199]
ds_read_b128 v[84:87], v10 offset:10240
v_mfma_f32_16x16x32_bf16 v[200:203], v[56:59], v[36:39], v[200:203]
ds_read_b128 v[88:91], v10 offset:11264
v_mfma_f32_16x16x32_bf16 v[204:207], v[60:63], v[36:39], v[204:207]
v_mfma_f32_16x16x32_bf16 v[208:211], v[64:67], v[36:39], v[208:211]
v_mfma_f32_16x16x32_bf16 v[212:215], v[68:71], v[36:39], v[212:215]
v_mfma_f32_16x16x32_bf16 v[216:219], v[72:75], v[36:39], v[216:219]
v_mfma_f32_16x16x32_bf16 v[248:251], v[72:75], v[40:43], v[248:251]
v_mfma_f32_16x16x32_bf16 v[244:247], v[68:71], v[40:43], v[244:247]
v_mfma_f32_16x16x32_bf16 v[240:243], v[64:67], v[40:43], v[240:243]
v_mfma_f32_16x16x32_bf16 v[236:239], v[60:63], v[40:43], v[236:239]
v_mfma_f32_16x16x32_bf16 v[232:235], v[56:59], v[40:43], v[232:235]
v_mfma_f32_16x16x32_bf16 v[228:231], v[52:55], v[40:43], v[228:231]
v_mfma_f32_16x16x32_bf16 v[224:227], v[48:51], v[40:43], v[224:227]
v_mfma_f32_16x16x32_bf16 v[220:223], v[44:47], v[40:43], v[220:223]
s_waitcnt lgkmcnt(0)
s_barrier
v_mfma_f32_16x16x32_bf16 v[124:127], v[92:95], v[76:79], v[124:127]
ds_read_b128 v[28:31], v9 offset:0
v_mfma_f32_16x16x32_bf16 v[128:131], v[96:99], v[76:79], v[128:131]
ds_read_b64_tr_b16 v[44:45], v11 offset:0
v_mfma_f32_16x16x32_bf16 v[132:135], v[100:103], v[76:79], v[132:135]
ds_read_b64_tr_b16 v[46:47], v11 offset:4096
v_mfma_f32_16x16x32_bf16 v[136:139], v[104:107], v[76:79], v[136:139]
ds_read_b64_tr_b16 v[48:49], v12 offset:0
v_mfma_f32_16x16x32_bf16 v[140:143], v[108:111], v[76:79], v[140:143]
ds_read_b64_tr_b16 v[50:51], v12 offset:4096
v_mfma_f32_16x16x32_bf16 v[144:147], v[112:115], v[76:79], v[144:147]
ds_read_b64_tr_b16 v[52:53], v13 offset:0
v_mfma_f32_16x16x32_bf16 v[148:151], v[116:119], v[76:79], v[148:151]
ds_read_b64_tr_b16 v[54:55], v13 offset:4096
v_mfma_f32_16x16x32_bf16 v[152:155], v[120:123], v[76:79], v[152:155]
ds_read_b64_tr_b16 v[56:57], v14 offset:0
v_mfma_f32_16x16x32_bf16 v[184:187], v[120:123], v[80:83], v[184:187]
ds_read_b64_tr_b16 v[58:59], v14 offset:4096
v_mfma_f32_16x16x32_bf16 v[180:183], v[116:119], v[80:83], v[180:183]
ds_read_b64_tr_b16 v[60:61], v11 offset:16384
v_mfma_f32_16x16x32_bf16 v[176:179], v[112:115], v[80:83], v[176:179]
ds_read_b64_tr_b16 v[62:63], v11 offset:20480
v_mfma_f32_16x16x32_bf16 v[172:175], v[108:111], v[80:83], v[172:175]
ds_read_b64_tr_b16 v[64:65], v12 offset:16384
v_mfma_f32_16x16x32_bf16 v[168:171], v[104:107], v[80:83], v[168:171]
ds_read_b64_tr_b16 v[66:67], v12 offset:20480
v_mfma_f32_16x16x32_bf16 v[164:167], v[100:103], v[80:83], v[164:167]
ds_read_b64_tr_b16 v[68:69], v13 offset:16384
v_mfma_f32_16x16x32_bf16 v[160:163], v[96:99], v[80:83], v[160:163]
ds_read_b64_tr_b16 v[70:71], v13 offset:20480
v_mfma_f32_16x16x32_bf16 v[156:159], v[92:95], v[80:83], v[156:159]
ds_read_b64_tr_b16 v[72:73], v14 offset:16384
v_mfma_f32_16x16x32_bf16 v[188:191], v[92:95], v[84:87], v[188:191]
ds_read_b64_tr_b16 v[74:75], v14 offset:20480
v_mfma_f32_16x16x32_bf16 v[192:195], v[96:99], v[84:87], v[192:195]
ds_read_b128 v[32:35], v9 offset:1024
v_mfma_f32_16x16x32_bf16 v[196:199], v[100:103], v[84:87], v[196:199]
ds_read_b128 v[36:39], v9 offset:2048
v_mfma_f32_16x16x32_bf16 v[200:203], v[104:107], v[84:87], v[200:203]
ds_read_b128 v[40:43], v9 offset:3072
v_mfma_f32_16x16x32_bf16 v[204:207], v[108:111], v[84:87], v[204:207]
v_mfma_f32_16x16x32_bf16 v[208:211], v[112:115], v[84:87], v[208:211]
v_mfma_f32_16x16x32_bf16 v[212:215], v[116:119], v[84:87], v[212:215]
v_mfma_f32_16x16x32_bf16 v[216:219], v[120:123], v[84:87], v[216:219]
v_mfma_f32_16x16x32_bf16 v[248:251], v[120:123], v[88:91], v[248:251]
v_mfma_f32_16x16x32_bf16 v[244:247], v[116:119], v[88:91], v[244:247]
v_mfma_f32_16x16x32_bf16 v[240:243], v[112:115], v[88:91], v[240:243]
v_mfma_f32_16x16x32_bf16 v[236:239], v[108:111], v[88:91], v[236:239]
v_mfma_f32_16x16x32_bf16 v[232:235], v[104:107], v[88:91], v[232:235]
v_mfma_f32_16x16x32_bf16 v[228:231], v[100:103], v[88:91], v[228:231]
v_mfma_f32_16x16x32_bf16 v[224:227], v[96:99], v[88:91], v[224:227]
v_mfma_f32_16x16x32_bf16 v[220:223], v[92:95], v[88:91], v[220:223]
s_waitcnt lgkmcnt(0)
v_mfma_f32_16x16x32_bf16 v[124:127], v[44:47], v[28:31], v[124:127]
ds_read_b128 v[76:79], v9 offset:8192
v_mfma_f32_16x16x32_bf16 v[128:131], v[48:51], v[28:31], v[128:131]
ds_read_b64_tr_b16 v[92:93], v11 offset:8192
v_mfma_f32_16x16x32_bf16 v[132:135], v[52:55], v[28:31], v[132:135]
ds_read_b64_tr_b16 v[94:95], v11 offset:12288
v_mfma_f32_16x16x32_bf16 v[136:139], v[56:59], v[28:31], v[136:139]
ds_read_b64_tr_b16 v[96:97], v12 offset:8192
v_mfma_f32_16x16x32_bf16 v[140:143], v[60:63], v[28:31], v[140:143]
ds_read_b64_tr_b16 v[98:99], v12 offset:12288
v_mfma_f32_16x16x32_bf16 v[144:147], v[64:67], v[28:31], v[144:147]
ds_read_b64_tr_b16 v[100:101], v13 offset:8192
v_mfma_f32_16x16x32_bf16 v[148:151], v[68:71], v[28:31], v[148:151]
ds_read_b64_tr_b16 v[102:103], v13 offset:12288
v_mfma_f32_16x16x32_bf16 v[152:155], v[72:75], v[28:31], v[152:155]
ds_read_b64_tr_b16 v[104:105], v14 offset:8192
v_mfma_f32_16x16x32_bf16 v[184:187], v[72:75], v[32:35], v[184:187]
ds_read_b64_tr_b16 v[106:107], v14 offset:12288
v_mfma_f32_16x16x32_bf16 v[180:183], v[68:71], v[32:35], v[180:183]
ds_read_b64_tr_b16 v[108:109], v11 offset:24576
v_mfma_f32_16x16x32_bf16 v[176:179], v[64:67], v[32:35], v[176:179]
ds_read_b64_tr_b16 v[110:111], v11 offset:28672
v_mfma_f32_16x16x32_bf16 v[172:175], v[60:63], v[32:35], v[172:175]
ds_read_b64_tr_b16 v[112:113], v12 offset:24576
v_mfma_f32_16x16x32_bf16 v[168:171], v[56:59], v[32:35], v[168:171]
ds_read_b64_tr_b16 v[114:115], v12 offset:28672
v_mfma_f32_16x16x32_bf16 v[164:167], v[52:55], v[32:35], v[164:167]
ds_read_b64_tr_b16 v[116:117], v13 offset:24576
v_mfma_f32_16x16x32_bf16 v[160:163], v[48:51], v[32:35], v[160:163]
ds_read_b64_tr_b16 v[118:119], v13 offset:28672
v_mfma_f32_16x16x32_bf16 v[156:159], v[44:47], v[32:35], v[156:159]
ds_read_b64_tr_b16 v[120:121], v14 offset:24576
v_mfma_f32_16x16x32_bf16 v[188:191], v[44:47], v[36:39], v[188:191]
ds_read_b64_tr_b16 v[122:123], v14 offset:28672
v_mfma_f32_16x16x32_bf16 v[192:195], v[48:51], v[36:39], v[192:195]
ds_read_b128 v[80:83], v9 offset:9216
v_mfma_f32_16x16x32_bf16 v[196:199], v[52:55], v[36:39], v[196:199]
ds_read_b128 v[84:87], v9 offset:10240
v_mfma_f32_16x16x32_bf16 v[200:203], v[56:59], v[36:39], v[200:203]
ds_read_b128 v[88:91], v9 offset:11264
v_mfma_f32_16x16x32_bf16 v[204:207], v[60:63], v[36:39], v[204:207]
v_mfma_f32_16x16x32_bf16 v[208:211], v[64:67], v[36:39], v[208:211]
v_mfma_f32_16x16x32_bf16 v[212:215], v[68:71], v[36:39], v[212:215]
v_mfma_f32_16x16x32_bf16 v[216:219], v[72:75], v[36:39], v[216:219]
v_mfma_f32_16x16x32_bf16 v[248:251], v[72:75], v[40:43], v[248:251]
v_mfma_f32_16x16x32_bf16 v[244:247], v[68:71], v[40:43], v[244:247]
v_mfma_f32_16x16x32_bf16 v[240:243], v[64:67], v[40:43], v[240:243]
v_mfma_f32_16x16x32_bf16 v[236:239], v[60:63], v[40:43], v[236:239]
v_mfma_f32_16x16x32_bf16 v[232:235], v[56:59], v[40:43], v[232:235]
v_mfma_f32_16x16x32_bf16 v[228:231], v[52:55], v[40:43], v[228:231]
v_mfma_f32_16x16x32_bf16 v[224:227], v[48:51], v[40:43], v[224:227]
v_mfma_f32_16x16x32_bf16 v[220:223], v[44:47], v[40:43], v[220:223]
s_waitcnt lgkmcnt(0)
s_barrier
v_mfma_f32_16x16x32_bf16 v[124:127], v[92:95], v[76:79], v[124:127]
ds_read_b128 v[28:31], v9 offset:49152
v_mfma_f32_16x16x32_bf16 v[128:131], v[96:99], v[76:79], v[128:131]
ds_read_b64_tr_b16 v[44:45], v15 offset:0
v_mfma_f32_16x16x32_bf16 v[132:135], v[100:103], v[76:79], v[132:135]
ds_read_b64_tr_b16 v[46:47], v15 offset:4096
v_mfma_f32_16x16x32_bf16 v[136:139], v[104:107], v[76:79], v[136:139]
ds_read_b64_tr_b16 v[48:49], v16 offset:0
v_mfma_f32_16x16x32_bf16 v[140:143], v[108:111], v[76:79], v[140:143]
ds_read_b64_tr_b16 v[50:51], v16 offset:4096
v_mfma_f32_16x16x32_bf16 v[144:147], v[112:115], v[76:79], v[144:147]
ds_read_b64_tr_b16 v[52:53], v17 offset:0
v_mfma_f32_16x16x32_bf16 v[148:151], v[116:119], v[76:79], v[148:151]
ds_read_b64_tr_b16 v[54:55], v17 offset:4096
v_mfma_f32_16x16x32_bf16 v[152:155], v[120:123], v[76:79], v[152:155]
ds_read_b64_tr_b16 v[56:57], v18 offset:0
v_mfma_f32_16x16x32_bf16 v[184:187], v[120:123], v[80:83], v[184:187]
ds_read_b64_tr_b16 v[58:59], v18 offset:4096
v_mfma_f32_16x16x32_bf16 v[180:183], v[116:119], v[80:83], v[180:183]
ds_read_b64_tr_b16 v[60:61], v15 offset:16384
v_mfma_f32_16x16x32_bf16 v[176:179], v[112:115], v[80:83], v[176:179]
ds_read_b64_tr_b16 v[62:63], v15 offset:20480
v_mfma_f32_16x16x32_bf16 v[172:175], v[108:111], v[80:83], v[172:175]
ds_read_b64_tr_b16 v[64:65], v16 offset:16384
v_mfma_f32_16x16x32_bf16 v[168:171], v[104:107], v[80:83], v[168:171]
ds_read_b64_tr_b16 v[66:67], v16 offset:20480
v_mfma_f32_16x16x32_bf16 v[164:167], v[100:103], v[80:83], v[164:167]
ds_read_b64_tr_b16 v[68:69], v17 offset:16384
v_mfma_f32_16x16x32_bf16 v[160:163], v[96:99], v[80:83], v[160:163]
ds_read_b64_tr_b16 v[70:71], v17 offset:20480
v_mfma_f32_16x16x32_bf16 v[156:159], v[92:95], v[80:83], v[156:159]
ds_read_b64_tr_b16 v[72:73], v18 offset:16384
v_mfma_f32_16x16x32_bf16 v[188:191], v[92:95], v[84:87], v[188:191]
ds_read_b64_tr_b16 v[74:75], v18 offset:20480
v_mfma_f32_16x16x32_bf16 v[192:195], v[96:99], v[84:87], v[192:195]
ds_read_b128 v[32:35], v9 offset:50176
v_mfma_f32_16x16x32_bf16 v[196:199], v[100:103], v[84:87], v[196:199]
ds_read_b128 v[36:39], v9 offset:51200
v_mfma_f32_16x16x32_bf16 v[200:203], v[104:107], v[84:87], v[200:203]
ds_read_b128 v[40:43], v9 offset:52224
v_mfma_f32_16x16x32_bf16 v[204:207], v[108:111], v[84:87], v[204:207]
v_mfma_f32_16x16x32_bf16 v[208:211], v[112:115], v[84:87], v[208:211]
v_mfma_f32_16x16x32_bf16 v[212:215], v[116:119], v[84:87], v[212:215]
v_mfma_f32_16x16x32_bf16 v[216:219], v[120:123], v[84:87], v[216:219]
v_mfma_f32_16x16x32_bf16 v[248:251], v[120:123], v[88:91], v[248:251]
v_mfma_f32_16x16x32_bf16 v[244:247], v[116:119], v[88:91], v[244:247]
v_mfma_f32_16x16x32_bf16 v[240:243], v[112:115], v[88:91], v[240:243]
v_mfma_f32_16x16x32_bf16 v[236:239], v[108:111], v[88:91], v[236:239]
v_mfma_f32_16x16x32_bf16 v[232:235], v[104:107], v[88:91], v[232:235]
v_mfma_f32_16x16x32_bf16 v[228:231], v[100:103], v[88:91], v[228:231]
v_mfma_f32_16x16x32_bf16 v[224:227], v[96:99], v[88:91], v[224:227]
v_mfma_f32_16x16x32_bf16 v[220:223], v[92:95], v[88:91], v[220:223]
s_waitcnt lgkmcnt(0)
v_mfma_f32_16x16x32_bf16 v[124:127], v[44:47], v[28:31], v[124:127]
ds_read_b128 v[76:79], v9 offset:57344
v_mfma_f32_16x16x32_bf16 v[128:131], v[48:51], v[28:31], v[128:131]
ds_read_b64_tr_b16 v[92:93], v15 offset:8192
v_mfma_f32_16x16x32_bf16 v[132:135], v[52:55], v[28:31], v[132:135]
ds_read_b64_tr_b16 v[94:95], v15 offset:12288
v_mfma_f32_16x16x32_bf16 v[136:139], v[56:59], v[28:31], v[136:139]
ds_read_b64_tr_b16 v[96:97], v16 offset:8192
v_mfma_f32_16x16x32_bf16 v[140:143], v[60:63], v[28:31], v[140:143]
ds_read_b64_tr_b16 v[98:99], v16 offset:12288
v_mfma_f32_16x16x32_bf16 v[144:147], v[64:67], v[28:31], v[144:147]
ds_read_b64_tr_b16 v[100:101], v17 offset:8192
v_mfma_f32_16x16x32_bf16 v[148:151], v[68:71], v[28:31], v[148:151]
ds_read_b64_tr_b16 v[102:103], v17 offset:12288
v_mfma_f32_16x16x32_bf16 v[152:155], v[72:75], v[28:31], v[152:155]
ds_read_b64_tr_b16 v[104:105], v18 offset:8192
v_mfma_f32_16x16x32_bf16 v[184:187], v[72:75], v[32:35], v[184:187]
ds_read_b64_tr_b16 v[106:107], v18 offset:12288
v_mfma_f32_16x16x32_bf16 v[180:183], v[68:71], v[32:35], v[180:183]
ds_read_b64_tr_b16 v[108:109], v15 offset:24576
v_mfma_f32_16x16x32_bf16 v[176:179], v[64:67], v[32:35], v[176:179]
ds_read_b64_tr_b16 v[110:111], v15 offset:28672
v_mfma_f32_16x16x32_bf16 v[172:175], v[60:63], v[32:35], v[172:175]
ds_read_b64_tr_b16 v[112:113], v16 offset:24576
v_mfma_f32_16x16x32_bf16 v[168:171], v[56:59], v[32:35], v[168:171]
ds_read_b64_tr_b16 v[114:115], v16 offset:28672
v_mfma_f32_16x16x32_bf16 v[164:167], v[52:55], v[32:35], v[164:167]
ds_read_b64_tr_b16 v[116:117], v17 offset:24576
v_mfma_f32_16x16x32_bf16 v[160:163], v[48:51], v[32:35], v[160:163]
ds_read_b64_tr_b16 v[118:119], v17 offset:28672
v_mfma_f32_16x16x32_bf16 v[156:159], v[44:47], v[32:35], v[156:159]
ds_read_b64_tr_b16 v[120:121], v18 offset:24576
v_mfma_f32_16x16x32_bf16 v[188:191], v[44:47], v[36:39], v[188:191]
ds_read_b64_tr_b16 v[122:123], v18 offset:28672
v_mfma_f32_16x16x32_bf16 v[192:195], v[48:51], v[36:39], v[192:195]
ds_read_b128 v[80:83], v9 offset:58368
v_mfma_f32_16x16x32_bf16 v[196:199], v[52:55], v[36:39], v[196:199]
ds_read_b128 v[84:87], v9 offset:59392
v_mfma_f32_16x16x32_bf16 v[200:203], v[56:59], v[36:39], v[200:203]
ds_read_b128 v[88:91], v9 offset:60416
v_mfma_f32_16x16x32_bf16 v[204:207], v[60:63], v[36:39], v[204:207]
v_mfma_f32_16x16x32_bf16 v[208:211], v[64:67], v[36:39], v[208:211]
v_mfma_f32_16x16x32_bf16 v[212:215], v[68:71], v[36:39], v[212:215]
v_mfma_f32_16x16x32_bf16 v[216:219], v[72:75], v[36:39], v[216:219]
v_mfma_f32_16x16x32_bf16 v[248:251], v[72:75], v[40:43], v[248:251]
v_mfma_f32_16x16x32_bf16 v[244:247], v[68:71], v[40:43], v[244:247]
v_mfma_f32_16x16x32_bf16 v[240:243], v[64:67], v[40:43], v[240:243]
v_mfma_f32_16x16x32_bf16 v[236:239], v[60:63], v[40:43], v[236:239]
v_mfma_f32_16x16x32_bf16 v[232:235], v[56:59], v[40:43], v[232:235]
v_mfma_f32_16x16x32_bf16 v[228:231], v[52:55], v[40:43], v[228:231]
v_mfma_f32_16x16x32_bf16 v[224:227], v[48:51], v[40:43], v[224:227]
v_mfma_f32_16x16x32_bf16 v[220:223], v[44:47], v[40:43], v[220:223]
s_waitcnt lgkmcnt(0)
s_barrier
v_mfma_f32_16x16x32_bf16 v[124:127], v[92:95], v[76:79], v[124:127]
ds_read_b128 v[28:31], v10 offset:0
v_mfma_f32_16x16x32_bf16 v[128:131], v[96:99], v[76:79], v[128:131]
ds_read_b64_tr_b16 v[44:45], v19 offset:0
v_mfma_f32_16x16x32_bf16 v[132:135], v[100:103], v[76:79], v[132:135]
ds_read_b64_tr_b16 v[46:47], v19 offset:4096
v_mfma_f32_16x16x32_bf16 v[136:139], v[104:107], v[76:79], v[136:139]
ds_read_b64_tr_b16 v[48:49], v20 offset:0
v_mfma_f32_16x16x32_bf16 v[140:143], v[108:111], v[76:79], v[140:143]
ds_read_b64_tr_b16 v[50:51], v20 offset:4096
v_mfma_f32_16x16x32_bf16 v[144:147], v[112:115], v[76:79], v[144:147]
ds_read_b64_tr_b16 v[52:53], v21 offset:0
v_mfma_f32_16x16x32_bf16 v[148:151], v[116:119], v[76:79], v[148:151]
ds_read_b64_tr_b16 v[54:55], v21 offset:4096
v_mfma_f32_16x16x32_bf16 v[152:155], v[120:123], v[76:79], v[152:155]
ds_read_b64_tr_b16 v[56:57], v22 offset:0
v_mfma_f32_16x16x32_bf16 v[184:187], v[120:123], v[80:83], v[184:187]
ds_read_b64_tr_b16 v[58:59], v22 offset:4096
v_mfma_f32_16x16x32_bf16 v[180:183], v[116:119], v[80:83], v[180:183]
ds_read_b64_tr_b16 v[60:61], v19 offset:16384
v_mfma_f32_16x16x32_bf16 v[176:179], v[112:115], v[80:83], v[176:179]
ds_read_b64_tr_b16 v[62:63], v19 offset:20480
v_mfma_f32_16x16x32_bf16 v[172:175], v[108:111], v[80:83], v[172:175]
ds_read_b64_tr_b16 v[64:65], v20 offset:16384
v_mfma_f32_16x16x32_bf16 v[168:171], v[104:107], v[80:83], v[168:171]
ds_read_b64_tr_b16 v[66:67], v20 offset:20480
v_mfma_f32_16x16x32_bf16 v[164:167], v[100:103], v[80:83], v[164:167]
ds_read_b64_tr_b16 v[68:69], v21 offset:16384
v_mfma_f32_16x16x32_bf16 v[160:163], v[96:99], v[80:83], v[160:163]
ds_read_b64_tr_b16 v[70:71], v21 offset:20480
v_mfma_f32_16x16x32_bf16 v[156:159], v[92:95], v[80:83], v[156:159]
ds_read_b64_tr_b16 v[72:73], v22 offset:16384
v_mfma_f32_16x16x32_bf16 v[188:191], v[92:95], v[84:87], v[188:191]
ds_read_b64_tr_b16 v[74:75], v22 offset:20480
v_mfma_f32_16x16x32_bf16 v[192:195], v[96:99], v[84:87], v[192:195]
ds_read_b128 v[32:35], v10 offset:1024
v_mfma_f32_16x16x32_bf16 v[196:199], v[100:103], v[84:87], v[196:199]
ds_read_b128 v[36:39], v10 offset:2048
v_mfma_f32_16x16x32_bf16 v[200:203], v[104:107], v[84:87], v[200:203]
ds_read_b128 v[40:43], v10 offset:3072
v_mfma_f32_16x16x32_bf16 v[204:207], v[108:111], v[84:87], v[204:207]
v_mfma_f32_16x16x32_bf16 v[208:211], v[112:115], v[84:87], v[208:211]
v_mfma_f32_16x16x32_bf16 v[212:215], v[116:119], v[84:87], v[212:215]
v_mfma_f32_16x16x32_bf16 v[216:219], v[120:123], v[84:87], v[216:219]
v_mfma_f32_16x16x32_bf16 v[248:251], v[120:123], v[88:91], v[248:251]
v_mfma_f32_16x16x32_bf16 v[244:247], v[116:119], v[88:91], v[244:247]
v_mfma_f32_16x16x32_bf16 v[240:243], v[112:115], v[88:91], v[240:243]
v_mfma_f32_16x16x32_bf16 v[236:239], v[108:111], v[88:91], v[236:239]
v_mfma_f32_16x16x32_bf16 v[232:235], v[104:107], v[88:91], v[232:235]
v_mfma_f32_16x16x32_bf16 v[228:231], v[100:103], v[88:91], v[228:231]
v_mfma_f32_16x16x32_bf16 v[224:227], v[96:99], v[88:91], v[224:227]
v_mfma_f32_16x16x32_bf16 v[220:223], v[92:95], v[88:91], v[220:223]
s_sub_u32 s41, s41, 1
s_cmp_lg_u32 s41, 0
s_cbranch_scc1 Lk3l_132
s_waitcnt lgkmcnt(0)
s_barrier
v_lshrrev_b32 v84, 4, v1
s_lshl_b32 s43, s63, 8
s_add_u32 s43, s43, 148480
v_lshl_add_u32 v85, v84, 4, s43
v_and_b32 v84, 15, v1
s_lshl_b32 s43, s62, 9
s_add_u32 s43, s43, 147456
v_lshl_add_u32 v84, v84, 3, s43
ds_read_b128 v[28:31], v85 offset:0
ds_read_b128 v[32:35], v85 offset:64
ds_read_b128 v[36:39], v85 offset:128
ds_read_b128 v[40:43], v85 offset:192
ds_read_b128 v[44:47], v85 offset:896
ds_read_b128 v[48:51], v85 offset:960
ds_read_b128 v[52:55], v85 offset:1024
ds_read_b128 v[56:59], v85 offset:1088
ds_read_b64 v[60:61], v84 offset:0
ds_read_b64 v[62:63], v84 offset:128
ds_read_b64 v[64:65], v84 offset:256
ds_read_b64 v[66:67], v84 offset:384
s_lshl_b32 s54, s35, 15
s_lshl_b32 s43, s63, 14
s_add_u32 s54, s54, s43
s_lshl_b32 s43, s62, 12
s_add_u32 s54, s54, s43
s_add_u32 s55, s54, 8192
v_lshrrev_b32 v122, 3, v1
v_and_b32 v123, 6, v122
v_and_b32 v25, 7, v1
v_xor_b32 v25, v25, v123
v_lshlrev_b32 v25, 4, v25
v_mul_u32_u24 v122, 2048, v122
v_add_u32 v25, v25, v122
s_lshl_b32 s43, s61, 7
s_lshl_b32 s44, s47, 15
s_add_u32 s43, s43, s44
v_add_u32 v25, s43, v25
s_waitcnt lgkmcnt(0)
s_add_u32 s37, s52, 589824
s_add_u32 m0, s39, 81920
s_nop 0
buffer_load_dwordx4 v3, s[24:27], s37 offen sc1 lds
v_mul_f32 v70, v61, v61
v_mul_f32 v68, 0xc0135761, v61
v_mul_f32 v69, 0xbdd2d3e8, v61
v_mul_f32 v69, v69, v70
v_rcp_f32 v70, v70
v_mul_f32 v74, v63, v63
v_mul_f32 v72, 0xc0135761, v63
v_mul_f32 v73, 0xbdd2d3e8, v63
v_mul_f32 v73, v73, v74
v_rcp_f32 v74, v74
v_fma_f32 v124, -v60, v28, v124
v_fma_f32 v125, -v60, v29, v125
v_fma_f32 v126, -v60, v30, v126
v_fma_f32 v127, -v60, v31, v127
buffer_load_dwordx4 v3, s[24:27], s37 offen offset:1024 sc1 lds
v_fma_f32 v156, -v62, v28, v156
v_fma_f32 v157, -v62, v29, v157
v_fma_f32 v158, -v62, v30, v158
v_fma_f32 v159, -v62, v31, v159
v_mul_f32 v76, v124, v124
v_mul_f32 v77, v125, v125
v_mul_f32 v78, v126, v126
v_mul_f32 v79, v127, v127
v_mul_f32 v80, v156, v156
v_mul_f32 v81, v157, v157
v_mul_f32 v82, v158, v158
v_mul_f32 v83, v159, v159
v_fma_f32 v76, v76, v69, v68
v_fma_f32 v77, v77, v69, v68
buffer_load_dwordx4 v3, s[24:27], s37 offen offset:2048 sc1 lds
v_fma_f32 v78, v78, v69, v68
v_fma_f32 v79, v79, v69, v68
v_fma_f32 v80, v80, v73, v72
v_fma_f32 v81, v81, v73, v72
v_fma_f32 v82, v82, v73, v72
v_fma_f32 v83, v83, v73, v72
v_mul_f32 v76, v76, v124
v_mul_f32 v77, v77, v125
v_mul_f32 v78, v78, v126
v_mul_f32 v79, v79, v127
v_mul_f32 v80, v80, v156
v_mul_f32 v81, v81, v157
v_mul_f32 v82, v82, v158
v_mul_f32 v83, v83, v159
buffer_load_dwordx4 v3, s[24:27], s37 offen offset:3072 sc1 lds
v_exp_f32 v76, v76
v_exp_f32 v77, v77
v_exp_f32 v78, v78
v_exp_f32 v79, v79
v_exp_f32 v80, v80
v_exp_f32 v81, v81
v_exp_f32 v82, v82
v_exp_f32 v83, v83
v_fma_f32 v140, -v60, v44, v140
v_fma_f32 v141, -v60, v45, v141
v_fma_f32 v142, -v60, v46, v142
v_fma_f32 v143, -v60, v47, v143
v_fma_f32 v172, -v62, v44, v172
s_branch Lov_16
.p2align 12
.fill 128, 4, 0xbf800000
Lst_16_0:
s_branch Lwr_169
s_nop 0
s_nop 0
Lov_16:
v_fma_f32 v173, -v62, v45, v173
s_add_u32 s37, s52, 606208
s_add_u32 m0, s39, 98304
s_nop 0
buffer_load_dwordx4 v3, s[24:27], s37 offen sc1 lds
v_fma_f32 v174, -v62, v46, v174
v_fma_f32 v175, -v62, v47, v175
v_fma_f32 v76, v76, v70, v70
v_fma_f32 v77, v77, v70, v70
v_fma_f32 v78, v78, v70, v70
v_fma_f32 v79, v79, v70, v70
v_fma_f32 v80, v80, v74, v74
v_fma_f32 v81, v81, v74, v74
v_fma_f32 v82, v82, v74, v74
v_fma_f32 v83, v83, v74, v74
v_rcp_f32 v76, v76
v_rcp_f32 v77, v77
v_rcp_f32 v78, v78
v_rcp_f32 v79, v79
buffer_load_dwordx4 v3, s[24:27], s37 offen offset:1024 sc1 lds
v_rcp_f32 v80, v80
v_rcp_f32 v81, v81
v_rcp_f32 v82, v82
v_rcp_f32 v83, v83
v_mul_f32 v140, v124, v140
v_mul_f32 v141, v125, v141
v_mul_f32 v142, v126, v142
v_mul_f32 v143, v127, v143
v_mul_f32 v172, v156, v172
v_mul_f32 v173, v157, v173
v_mul_f32 v174, v158, v174
v_mul_f32 v175, v159, v175
v_mul_f32 v140, v140, v76
v_mul_f32 v141, v141, v77
buffer_load_dwordx4 v3, s[24:27], s37 offen offset:2048 sc1 lds
v_mul_f32 v142, v142, v78
v_mul_f32 v143, v143, v79
v_mul_f32 v172, v172, v80
v_mul_f32 v173, v173, v81
v_mul_f32 v174, v174, v82
v_mul_f32 v175, v175, v83
v_cvt_pk_bf16_f32 v124, v140, v141
v_cvt_pk_bf16_f32 v125, v142, v143
v_cvt_pk_bf16_f32 v156, v172, v173
v_cvt_pk_bf16_f32 v157, v174, v175
v_fma_f32 v128, -v60, v32, v128
v_fma_f32 v129, -v60, v33, v129
v_fma_f32 v130, -v60, v34, v130
v_fma_f32 v131, -v60, v35, v131
buffer_load_dwordx4 v3, s[24:27], s37 offen offset:3072 sc1 lds
v_fma_f32 v160, -v62, v32, v160
v_fma_f32 v161, -v62, v33, v161
v_fma_f32 v162, -v62, v34, v162
v_fma_f32 v163, -v62, v35, v163
v_mul_f32 v76, v128, v128
v_mul_f32 v77, v129, v129
v_mul_f32 v78, v130, v130
v_mul_f32 v79, v131, v131
v_mul_f32 v80, v160, v160
v_mul_f32 v81, v161, v161
v_mul_f32 v82, v162, v162
v_mul_f32 v83, v163, v163
v_fma_f32 v76, v76, v69, v68
v_fma_f32 v77, v77, v69, v68
s_add_u32 s38, s53, 4849664
s_add_u32 m0, s39, 114688
s_nop 0
buffer_load_dwordx4 v23, s[28:31], s38 offen lds
v_fma_f32 v78, v78, v69, v68
v_fma_f32 v79, v79, v69, v68
v_fma_f32 v80, v80, v73, v72
v_fma_f32 v81, v81, v73, v72
v_fma_f32 v82, v82, v73, v72
v_fma_f32 v83, v83, v73, v72
v_mul_f32 v76, v76, v128
v_mul_f32 v77, v77, v129
v_mul_f32 v78, v78, v130
v_mul_f32 v79, v79, v131
v_mul_f32 v80, v80, v160
v_mul_f32 v81, v81, v161
v_mul_f32 v82, v82, v162
v_mul_f32 v83, v83, v163
s_add_u32 m0, s39, 115712
s_nop 0
buffer_load_dwordx4 v24, s[28:31], s38 offen lds
v_exp_f32 v76, v76
v_exp_f32 v77, v77
v_exp_f32 v78, v78
v_exp_f32 v79, v79
v_exp_f32 v80, v80
v_exp_f32 v81, v81
v_exp_f32 v82, v82
v_exp_f32 v83, v83
v_fma_f32 v144, -v60, v48, v144
v_fma_f32 v145, -v60, v49, v145
v_fma_f32 v146, -v60, v50, v146
v_fma_f32 v147, -v60, v51, v147
v_fma_f32 v176, -v62, v48, v176
v_fma_f32 v177, -v62, v49, v177
s_add_u32 m0, s39, 116736
s_add_u32 s38, s38, 16384
buffer_load_dwordx4 v23, s[28:31], s38 offen lds
s_add_u32 m0, s39, 117760
s_nop 0
buffer_load_dwordx4 v24, s[28:31], s38 offen lds
s_barrier
s_add_u32 s38, s53, 4718592
s_add_u32 m0, s39, 147456
s_nop 0
buffer_load_dwordx4 v23, s[28:31], s38 offen lds
v_fma_f32 v178, -v62, v50, v178
v_fma_f32 v179, -v62, v51, v179
v_fma_f32 v76, v76, v70, v70
v_fma_f32 v77, v77, v70, v70
v_fma_f32 v78, v78, v70, v70
v_fma_f32 v79, v79, v70, v70
v_fma_f32 v80, v80, v74, v74
v_fma_f32 v81, v81, v74, v74
v_fma_f32 v82, v82, v74, v74
v_fma_f32 v83, v83, v74, v74
v_rcp_f32 v76, v76
v_rcp_f32 v77, v77
v_rcp_f32 v78, v78
v_rcp_f32 v79, v79
s_add_u32 m0, s39, 148480
s_nop 0
buffer_load_dwordx4 v24, s[28:31], s38 offen lds
v_rcp_f32 v80, v80
v_rcp_f32 v81, v81
v_rcp_f32 v82, v82
v_rcp_f32 v83, v83
v_mul_f32 v144, v128, v144
v_mul_f32 v145, v129, v145
v_mul_f32 v146, v130, v146
v_mul_f32 v147, v131, v147
v_mul_f32 v176, v160, v176
v_mul_f32 v177, v161, v177
v_mul_f32 v178, v162, v178
v_mul_f32 v179, v163, v179
v_mul_f32 v144, v144, v76
v_mul_f32 v145, v145, v77
s_add_u32 m0, s39, 149504
s_add_u32 s38, s38, 16384
buffer_load_dwordx4 v23, s[28:31], s38 offen lds
v_mul_f32 v146, v146, v78
v_mul_f32 v147, v147, v79
v_mul_f32 v176, v176, v80
v_mul_f32 v177, v177, v81
v_mul_f32 v178, v178, v82
v_mul_f32 v179, v179, v83
v_cvt_pk_bf16_f32 v126, v144, v145
v_cvt_pk_bf16_f32 v127, v146, v147
v_cvt_pk_bf16_f32 v158, v176, v177
v_cvt_pk_bf16_f32 v159, v178, v179
buffer_store_dwordx4 v[124:127], v2, s[24:27], s54 offen offset:0 sc1
buffer_store_dwordx4 v[156:159], v2, s[24:27], s54 offen offset:1024 sc1
v_fma_f32 v132, -v60, v36, v132
v_fma_f32 v133, -v60, v37, v133
s_add_u32 m0, s39, 150528
s_nop 0
buffer_load_dwordx4 v24, s[28:31], s38 offen lds
v_fma_f32 v134, -v60, v38, v134
v_fma_f32 v135, -v60, v39, v135
v_fma_f32 v164, -v62, v36, v164
v_fma_f32 v165, -v62, v37, v165
v_fma_f32 v166, -v62, v38, v166
v_fma_f32 v167, -v62, v39, v167
v_mul_f32 v76, v132, v132
v_mul_f32 v77, v133, v133
v_mul_f32 v78, v134, v134
v_mul_f32 v79, v135, v135
v_mul_f32 v80, v164, v164
v_mul_f32 v81, v165, v165
v_mul_f32 v82, v166, v166
v_mul_f32 v83, v167, v167
s_add_u32 s37, s52, 622592
s_add_u32 m0, s39, 131072
s_nop 0
buffer_load_dwordx4 v3, s[24:27], s37 offen sc1 lds
v_fma_f32 v76, v76, v69, v68
v_fma_f32 v77, v77, v69, v68
v_fma_f32 v78, v78, v69, v68
v_fma_f32 v79, v79, v69, v68
v_fma_f32 v80, v80, v73, v72
v_fma_f32 v81, v81, v73, v72
v_fma_f32 v82, v82, v73, v72
v_fma_f32 v83, v83, v73, v72
v_mul_f32 v76, v76, v132
v_mul_f32 v77, v77, v133
v_mul_f32 v78, v78, v134
v_mul_f32 v79, v79, v135
v_mul_f32 v80, v80, v164
v_mul_f32 v81, v81, v165
buffer_load_dwordx4 v3, s[24:27], s37 offen offset:1024 sc1 lds
v_mul_f32 v82, v82, v166
v_mul_f32 v83, v83, v167
v_exp_f32 v76, v76
v_exp_f32 v77, v77
v_exp_f32 v78, v78
v_exp_f32 v79, v79
v_exp_f32 v80, v80
v_exp_f32 v81, v81
v_exp_f32 v82, v82
v_exp_f32 v83, v83
v_fma_f32 v148, -v60, v52, v148
v_fma_f32 v149, -v60, v53, v149
v_fma_f32 v150, -v60, v54, v150
v_fma_f32 v151, -v60, v55, v151
buffer_load_dwordx4 v3, s[24:27], s37 offen offset:2048 sc1 lds
v_fma_f32 v180, -v62, v52, v180
v_fma_f32 v181, -v62, v53, v181
v_fma_f32 v182, -v62, v54, v182
v_fma_f32 v183, -v62, v55, v183
v_fma_f32 v76, v76, v70, v70
v_fma_f32 v77, v77, v70, v70
v_fma_f32 v78, v78, v70, v70
v_fma_f32 v79, v79, v70, v70
v_fma_f32 v80, v80, v74, v74
v_fma_f32 v81, v81, v74, v74
v_fma_f32 v82, v82, v74, v74
v_fma_f32 v83, v83, v74, v74
v_rcp_f32 v76, v76
v_rcp_f32 v77, v77
buffer_load_dwordx4 v3, s[24:27], s37 offen offset:3072 sc1 lds
v_rcp_f32 v78, v78
v_rcp_f32 v79, v79
v_rcp_f32 v80, v80
v_rcp_f32 v81, v81
v_rcp_f32 v82, v82
v_rcp_f32 v83, v83
v_mul_f32 v148, v132, v148
v_mul_f32 v149, v133, v149
v_mul_f32 v150, v134, v150
v_mul_f32 v151, v135, v151
v_mul_f32 v180, v164, v180
v_mul_f32 v181, v165, v181
v_mul_f32 v182, v166, v182
v_mul_f32 v183, v167, v183
s_add_u32 s38, s53, 4980736
s_add_u32 m0, s39, 0
s_nop 0
buffer_load_dwordx4 v23, s[28:31], s38 offen lds
v_mul_f32 v148, v148, v76
v_mul_f32 v149, v149, v77
v_mul_f32 v150, v150, v78
v_mul_f32 v151, v151, v79
v_mul_f32 v180, v180, v80
v_mul_f32 v181, v181, v81
v_mul_f32 v182, v182, v82
v_mul_f32 v183, v183, v83
v_cvt_pk_bf16_f32 v132, v148, v149
v_cvt_pk_bf16_f32 v133, v150, v151
v_cvt_pk_bf16_f32 v164, v180, v181
v_cvt_pk_bf16_f32 v165, v182, v183
v_fma_f32 v136, -v60, v40, v136
v_fma_f32 v137, -v60, v41, v137
s_add_u32 m0, s39, 1024
s_nop 0
buffer_load_dwordx4 v24, s[28:31], s38 offen lds
v_fma_f32 v138, -v60, v42, v138
v_fma_f32 v139, -v60, v43, v139
v_fma_f32 v168, -v62, v40, v168
v_fma_f32 v169, -v62, v41, v169
v_fma_f32 v170, -v62, v42, v170
v_fma_f32 v171, -v62, v43, v171
v_mul_f32 v76, v136, v136
v_mul_f32 v77, v137, v137
v_mul_f32 v78, v138, v138
v_mul_f32 v79, v139, v139
v_mul_f32 v80, v168, v168
v_mul_f32 v81, v169, v169
v_mul_f32 v82, v170, v170
v_mul_f32 v83, v171, v171
s_add_u32 m0, s39, 2048
s_add_u32 s38, s38, 16384
buffer_load_dwordx4 v23, s[28:31], s38 offen lds
s_add_u32 m0, s39, 3072
s_nop 0
buffer_load_dwordx4 v24, s[28:31], s38 offen lds
s_barrier
s_add_u32 s37, s52, 638976
s_add_u32 m0, s39, 16384
s_nop 0
buffer_load_dwordx4 v3, s[24:27], s37 offen sc1 lds
v_fma_f32 v76, v76, v69, v68
v_fma_f32 v77, v77, v69, v68
v_fma_f32 v78, v78, v69, v68
v_fma_f32 v79, v79, v69, v68
v_fma_f32 v80, v80, v73, v72
v_fma_f32 v81, v81, v73, v72
v_fma_f32 v82, v82, v73, v72
v_fma_f32 v83, v83, v73, v72
v_mul_f32 v76, v76, v136
v_mul_f32 v77, v77, v137
v_mul_f32 v78, v78, v138
v_mul_f32 v79, v79, v139
v_mul_f32 v80, v80, v168
v_mul_f32 v81, v81, v169
v_mul_f32 v82, v82, v170
v_mul_f32 v83, v83, v171
v_exp_f32 v76, v76
v_exp_f32 v77, v77
v_exp_f32 v78, v78
v_exp_f32 v79, v79
v_exp_f32 v80, v80
v_exp_f32 v81, v81
v_exp_f32 v82, v82
buffer_load_dwordx4 v3, s[24:27], s37 offen offset:1024 sc1 lds
v_exp_f32 v83, v83
v_fma_f32 v152, -v60, v56, v152
v_fma_f32 v153, -v60, v57, v153
v_fma_f32 v154, -v60, v58, v154
v_fma_f32 v155, -v60, v59, v155
v_fma_f32 v184, -v62, v56, v184
v_fma_f32 v185, -v62, v57, v185
v_fma_f32 v186, -v62, v58, v186
v_fma_f32 v187, -v62, v59, v187
v_fma_f32 v76, v76, v70, v70
v_fma_f32 v77, v77, v70, v70
v_fma_f32 v78, v78, v70, v70
v_fma_f32 v79, v79, v70, v70
v_fma_f32 v80, v80, v74, v74
v_fma_f32 v81, v81, v74, v74
v_fma_f32 v82, v82, v74, v74
v_fma_f32 v83, v83, v74, v74
v_rcp_f32 v76, v76
v_rcp_f32 v77, v77
v_rcp_f32 v78, v78
v_rcp_f32 v79, v79
v_rcp_f32 v80, v80
v_rcp_f32 v81, v81
buffer_load_dwordx4 v3, s[24:27], s37 offen offset:2048 sc1 lds
v_rcp_f32 v82, v82
v_rcp_f32 v83, v83
v_mul_f32 v152, v136, v152
v_mul_f32 v153, v137, v153
v_mul_f32 v154, v138, v154
v_mul_f32 v155, v139, v155
v_mul_f32 v184, v168, v184
v_mul_f32 v185, v169, v185
v_mul_f32 v186, v170, v186
v_mul_f32 v187, v171, v187
v_mul_f32 v152, v152, v76
v_mul_f32 v153, v153, v77
v_mul_f32 v154, v154, v78
v_mul_f32 v155, v155, v79
v_mul_f32 v184, v184, v80
v_mul_f32 v185, v185, v81
v_mul_f32 v186, v186, v82
v_mul_f32 v187, v187, v83
v_cvt_pk_bf16_f32 v134, v152, v153
v_cvt_pk_bf16_f32 v135, v154, v155
v_cvt_pk_bf16_f32 v166, v184, v185
v_cvt_pk_bf16_f32 v167, v186, v187
buffer_store_dwordx4 v[132:135], v2, s[24:27], s55 offen offset:0 sc1
buffer_store_dwordx4 v[164:167], v2, s[24:27], s55 offen offset:1024 sc1
buffer_load_dwordx4 v3, s[24:27], s37 offen offset:3072 sc1 lds
v_mul_f32 v70, v65, v65
v_mul_f32 v68, 0xc0135761, v65
v_mul_f32 v69, 0xbdd2d3e8, v65
v_mul_f32 v69, v69, v70
v_rcp_f32 v70, v70
v_mul_f32 v74, v67, v67
v_mul_f32 v72, 0xc0135761, v67
v_mul_f32 v73, 0xbdd2d3e8, v67
v_mul_f32 v73, v73, v74
v_rcp_f32 v74, v74
v_fma_f32 v188, -v64, v28, v188
v_fma_f32 v189, -v64, v29, v189
v_fma_f32 v190, -v64, v30, v190
v_fma_f32 v191, -v64, v31, v191
v_fma_f32 v220, -v66, v28, v220
v_fma_f32 v221, -v66, v29, v221
v_fma_f32 v222, -v66, v30, v222
v_fma_f32 v223, -v66, v31, v223
v_mul_f32 v76, v188, v188
v_mul_f32 v77, v189, v189
v_mul_f32 v78, v190, v190
v_mul_f32 v79, v191, v191
v_mul_f32 v80, v220, v220
s_add_u32 s38, s53, 5111808
s_add_u32 m0, s39, 32768
s_nop 0
buffer_load_dwordx4 v23, s[28:31], s38 offen lds
v_mul_f32 v81, v221, v221
v_mul_f32 v82, v222, v222
v_mul_f32 v83, v223, v223
v_fma_f32 v76, v76, v69, v68
v_fma_f32 v77, v77, v69, v68
v_fma_f32 v78, v78, v69, v68
v_fma_f32 v79, v79, v69, v68
v_fma_f32 v80, v80, v73, v72
v_fma_f32 v81, v81, v73, v72
v_fma_f32 v82, v82, v73, v72
v_fma_f32 v83, v83, v73, v72
v_mul_f32 v76, v76, v188
v_mul_f32 v77, v77, v189
v_mul_f32 v78, v78, v190
v_mul_f32 v79, v79, v191
v_mul_f32 v80, v80, v220
v_mul_f32 v81, v81, v221
v_mul_f32 v82, v82, v222
v_mul_f32 v83, v83, v223
v_exp_f32 v76, v76
v_exp_f32 v77, v77
v_exp_f32 v78, v78
v_exp_f32 v79, v79
s_add_u32 m0, s39, 33792
s_nop 0
buffer_load_dwordx4 v24, s[28:31], s38 offen lds
v_exp_f32 v80, v80
v_exp_f32 v81, v81
v_exp_f32 v82, v82
v_exp_f32 v83, v83
v_fma_f32 v204, -v64, v44, v204
v_fma_f32 v205, -v64, v45, v205
v_fma_f32 v206, -v64, v46, v206
v_fma_f32 v207, -v64, v47, v207
v_fma_f32 v236, -v66, v44, v236
v_fma_f32 v237, -v66, v45, v237
v_fma_f32 v238, -v66, v46, v238
v_fma_f32 v239, -v66, v47, v239
v_fma_f32 v76, v76, v70, v70
v_fma_f32 v77, v77, v70, v70
v_fma_f32 v78, v78, v70, v70
v_fma_f32 v79, v79, v70, v70
v_fma_f32 v80, v80, v74, v74
v_fma_f32 v81, v81, v74, v74
v_fma_f32 v82, v82, v74, v74
v_fma_f32 v83, v83, v74, v74
v_rcp_f32 v76, v76
v_rcp_f32 v77, v77
v_rcp_f32 v78, v78
v_rcp_f32 v79, v79
s_add_u32 m0, s39, 34816
s_add_u32 s38, s38, 16384
buffer_load_dwordx4 v23, s[28:31], s38 offen lds
s_add_u32 m0, s39, 35840
s_nop 0
buffer_load_dwordx4 v24, s[28:31], s38 offen lds
s_waitcnt vmcnt(18)
s_barrier
s_add_u32 s37, s52, 655360
s_add_u32 m0, s39, 49152
s_nop 0
buffer_load_dwordx4 v3, s[24:27], s37 offen sc1 lds
v_rcp_f32 v80, v80
v_rcp_f32 v81, v81
v_rcp_f32 v82, v82
v_rcp_f32 v83, v83
v_mul_f32 v204, v188, v204
v_mul_f32 v205, v189, v205
v_mul_f32 v206, v190, v206
v_mul_f32 v207, v191, v207
v_mul_f32 v236, v220, v236
v_mul_f32 v237, v221, v237
v_mul_f32 v238, v222, v238
v_mul_f32 v239, v223, v239
v_mul_f32 v204, v204, v76
v_mul_f32 v205, v205, v77
v_mul_f32 v206, v206, v78
v_mul_f32 v207, v207, v79
v_mul_f32 v236, v236, v80
v_mul_f32 v237, v237, v81
v_mul_f32 v238, v238, v82
v_mul_f32 v239, v239, v83
v_cvt_pk_bf16_f32 v188, v204, v205
v_cvt_pk_bf16_f32 v189, v206, v207
v_cvt_pk_bf16_f32 v220, v236, v237
buffer_load_dwordx4 v3, s[24:27], s37 offen offset:1024 sc1 lds
v_cvt_pk_bf16_f32 v221, v238, v239
v_fma_f32 v192, -v64, v32, v192
v_fma_f32 v193, -v64, v33, v193
v_fma_f32 v194, -v64, v34, v194
v_fma_f32 v195, -v64, v35, v195
v_fma_f32 v224, -v66, v32, v224
v_fma_f32 v225, -v66, v33, v225
v_fma_f32 v226, -v66, v34, v226
v_fma_f32 v227, -v66, v35, v227
v_mul_f32 v76, v192, v192
v_mul_f32 v77, v193, v193
v_mul_f32 v78, v194, v194
v_mul_f32 v79, v195, v195
v_mul_f32 v80, v224, v224
v_mul_f32 v81, v225, v225
v_mul_f32 v82, v226, v226
v_mul_f32 v83, v227, v227
v_fma_f32 v76, v76, v69, v68
v_fma_f32 v77, v77, v69, v68
v_fma_f32 v78, v78, v69, v68
v_fma_f32 v79, v79, v69, v68
v_fma_f32 v80, v80, v73, v72
v_fma_f32 v81, v81, v73, v72
buffer_load_dwordx4 v3, s[24:27], s37 offen offset:2048 sc1 lds
v_fma_f32 v82, v82, v73, v72
v_fma_f32 v83, v83, v73, v72
v_mul_f32 v76, v76, v192
v_mul_f32 v77, v77, v193
v_mul_f32 v78, v78, v194
v_mul_f32 v79, v79, v195
v_mul_f32 v80, v80, v224
v_mul_f32 v81, v81, v225
v_mul_f32 v82, v82, v226
v_mul_f32 v83, v83, v227
v_exp_f32 v76, v76
v_exp_f32 v77, v77
v_exp_f32 v78, v78
v_exp_f32 v79, v79
v_exp_f32 v80, v80
v_exp_f32 v81, v81
v_exp_f32 v82, v82
v_exp_f32 v83, v83
v_fma_f32 v208, -v64, v48, v208
v_fma_f32 v209, -v64, v49, v209
v_fma_f32 v210, -v64, v50, v210
v_fma_f32 v211, -v64, v51, v211
v_fma_f32 v240, -v66, v48, v240
v_fma_f32 v241, -v66, v49, v241
buffer_load_dwordx4 v3, s[24:27], s37 offen offset:3072 sc1 lds
v_fma_f32 v242, -v66, v50, v242
v_fma_f32 v243, -v66, v51, v243
v_fma_f32 v76, v76, v70, v70
v_fma_f32 v77, v77, v70, v70
v_fma_f32 v78, v78, v70, v70
v_fma_f32 v79, v79, v70, v70
v_fma_f32 v80, v80, v74, v74
v_fma_f32 v81, v81, v74, v74
v_fma_f32 v82, v82, v74, v74
v_fma_f32 v83, v83, v74, v74
v_rcp_f32 v76, v76
v_rcp_f32 v77, v77
v_rcp_f32 v78, v78
v_rcp_f32 v79, v79
v_rcp_f32 v80, v80
v_rcp_f32 v81, v81
v_rcp_f32 v82, v82
v_rcp_f32 v83, v83
v_mul_f32 v208, v192, v208
v_mul_f32 v209, v193, v209
v_mul_f32 v210, v194, v210
v_mul_f32 v211, v195, v211
v_mul_f32 v240, v224, v240
s_add_u32 s38, s53, 5242880
s_add_u32 m0, s39, 65536
s_nop 0
buffer_load_dwordx4 v23, s[28:31], s38 offen lds
v_mul_f32 v241, v225, v241
v_mul_f32 v242, v226, v242
v_mul_f32 v243, v227, v243
v_mul_f32 v208, v208, v76
v_mul_f32 v209, v209, v77
v_mul_f32 v210, v210, v78
v_mul_f32 v211, v211, v79
v_mul_f32 v240, v240, v80
v_mul_f32 v241, v241, v81
v_mul_f32 v242, v242, v82
v_mul_f32 v243, v243, v83
v_cvt_pk_bf16_f32 v190, v208, v209
v_cvt_pk_bf16_f32 v191, v210, v211
v_cvt_pk_bf16_f32 v222, v240, v241
v_cvt_pk_bf16_f32 v223, v242, v243
buffer_store_dwordx4 v[188:191], v2, s[24:27], s54 offen offset:2048 sc1
buffer_store_dwordx4 v[220:223], v2, s[24:27], s54 offen offset:3072 sc1
v_fma_f32 v196, -v64, v36, v196
v_fma_f32 v197, -v64, v37, v197
v_fma_f32 v198, -v64, v38, v198
v_fma_f32 v199, -v64, v39, v199
v_fma_f32 v228, -v66, v36, v228
v_fma_f32 v229, -v66, v37, v229
s_add_u32 m0, s39, 66560
s_nop 0
buffer_load_dwordx4 v24, s[28:31], s38 offen lds
v_fma_f32 v230, -v66, v38, v230
v_fma_f32 v231, -v66, v39, v231
v_mul_f32 v76, v196, v196
v_mul_f32 v77, v197, v197
v_mul_f32 v78, v198, v198
v_mul_f32 v79, v199, v199
v_mul_f32 v80, v228, v228
v_mul_f32 v81, v229, v229
v_mul_f32 v82, v230, v230
v_mul_f32 v83, v231, v231
v_fma_f32 v76, v76, v69, v68
v_fma_f32 v77, v77, v69, v68
v_fma_f32 v78, v78, v69, v68
v_fma_f32 v79, v79, v69, v68
v_fma_f32 v80, v80, v73, v72
v_fma_f32 v81, v81, v73, v72
v_fma_f32 v82, v82, v73, v72
v_fma_f32 v83, v83, v73, v72
v_mul_f32 v76, v76, v196
v_mul_f32 v77, v77, v197
v_mul_f32 v78, v78, v198
v_mul_f32 v79, v79, v199
v_mul_f32 v80, v80, v228
v_mul_f32 v81, v81, v229
s_add_u32 m0, s39, 67584
s_add_u32 s38, s38, 16384
buffer_load_dwordx4 v23, s[28:31], s38 offen lds
s_branch Lov_17
.p2align 12
.fill 128, 4, 0xbf800000
Lst_17_0:
s_branch Lwr_170
s_nop 0
s_nop 0
Lov_17:
s_add_u32 m0, s39, 68608
s_nop 0
buffer_load_dwordx4 v24, s[28:31], s38 offen lds
s_waitcnt vmcnt(34)
s_barrier
s_add_u32 s37, s52, 671744
s_add_u32 m0, s39, 81920
s_nop 0
buffer_load_dwordx4 v3, s[24:27], s37 offen sc1 lds
v_mul_f32 v82, v82, v230
v_mul_f32 v83, v83, v231
v_exp_f32 v76, v76
v_exp_f32 v77, v77
v_exp_f32 v78, v78
v_exp_f32 v79, v79
v_exp_f32 v80, v80
v_exp_f32 v81, v81
v_exp_f32 v82, v82
v_exp_f32 v83, v83
v_fma_f32 v212, -v64, v52, v212
v_fma_f32 v213, -v64, v53, v213
v_fma_f32 v214, -v64, v54, v214
v_fma_f32 v215, -v64, v55, v215
v_fma_f32 v244, -v66, v52, v244
v_fma_f32 v245, -v66, v53, v245
v_fma_f32 v246, -v66, v54, v246
v_fma_f32 v247, -v66, v55, v247
v_fma_f32 v76, v76, v70, v70
v_fma_f32 v77, v77, v70, v70
v_fma_f32 v78, v78, v70, v70
v_fma_f32 v79, v79, v70, v70
v_fma_f32 v80, v80, v74, v74
buffer_load_dwordx4 v3, s[24:27], s37 offen offset:1024 sc1 lds
v_fma_f32 v81, v81, v74, v74
v_fma_f32 v82, v82, v74, v74
v_fma_f32 v83, v83, v74, v74
v_rcp_f32 v76, v76
v_rcp_f32 v77, v77
v_rcp_f32 v78, v78
v_rcp_f32 v79, v79
v_rcp_f32 v80, v80
v_rcp_f32 v81, v81
v_rcp_f32 v82, v82
v_rcp_f32 v83, v83
v_mul_f32 v212, v196, v212
v_mul_f32 v213, v197, v213
v_mul_f32 v214, v198, v214
v_mul_f32 v215, v199, v215
v_mul_f32 v244, v228, v244
v_mul_f32 v245, v229, v245
v_mul_f32 v246, v230, v246
v_mul_f32 v247, v231, v247
v_mul_f32 v212, v212, v76
v_mul_f32 v213, v213, v77
v_mul_f32 v214, v214, v78
v_mul_f32 v215, v215, v79
buffer_load_dwordx4 v3, s[24:27], s37 offen offset:2048 sc1 lds
v_mul_f32 v244, v244, v80
v_mul_f32 v245, v245, v81
v_mul_f32 v246, v246, v82
v_mul_f32 v247, v247, v83
v_cvt_pk_bf16_f32 v196, v212, v213
v_cvt_pk_bf16_f32 v197, v214, v215
v_cvt_pk_bf16_f32 v228, v244, v245
v_cvt_pk_bf16_f32 v229, v246, v247
v_fma_f32 v200, -v64, v40, v200
v_fma_f32 v201, -v64, v41, v201
v_fma_f32 v202, -v64, v42, v202
v_fma_f32 v203, -v64, v43, v203
v_fma_f32 v232, -v66, v40, v232
v_fma_f32 v233, -v66, v41, v233
v_fma_f32 v234, -v66, v42, v234
v_fma_f32 v235, -v66, v43, v235
v_mul_f32 v76, v200, v200
v_mul_f32 v77, v201, v201
v_mul_f32 v78, v202, v202
v_mul_f32 v79, v203, v203
v_mul_f32 v80, v232, v232
v_mul_f32 v81, v233, v233
v_mul_f32 v82, v234, v234
v_mul_f32 v83, v235, v235
buffer_load_dwordx4 v3, s[24:27], s37 offen offset:3072 sc1 lds
v_fma_f32 v76, v76, v69, v68
v_fma_f32 v77, v77, v69, v68
v_fma_f32 v78, v78, v69, v68
v_fma_f32 v79, v79, v69, v68
v_fma_f32 v80, v80, v73, v72
v_fma_f32 v81, v81, v73, v72
v_fma_f32 v82, v82, v73, v72
v_fma_f32 v83, v83, v73, v72
v_mul_f32 v76, v76, v200
v_mul_f32 v77, v77, v201
v_mul_f32 v78, v78, v202
v_mul_f32 v79, v79, v203
v_mul_f32 v80, v80, v232
v_mul_f32 v81, v81, v233
v_mul_f32 v82, v82, v234
v_mul_f32 v83, v83, v235
v_exp_f32 v76, v76
v_exp_f32 v77, v77
v_exp_f32 v78, v78
v_exp_f32 v79, v79
v_exp_f32 v80, v80
v_exp_f32 v81, v81
v_exp_f32 v82, v82
s_add_u32 s38, s53, 5373952
s_add_u32 m0, s39, 147456
s_nop 0
buffer_load_dwordx4 v23, s[28:31], s38 offen lds
v_exp_f32 v83, v83
v_fma_f32 v216, -v64, v56, v216
v_fma_f32 v217, -v64, v57, v217
v_fma_f32 v218, -v64, v58, v218
v_fma_f32 v219, -v64, v59, v219
v_fma_f32 v248, -v66, v56, v248
v_fma_f32 v249, -v66, v57, v249
v_fma_f32 v250, -v66, v58, v250
v_fma_f32 v251, -v66, v59, v251
v_fma_f32 v76, v76, v70, v70
v_fma_f32 v77, v77, v70, v70
v_fma_f32 v78, v78, v70, v70
v_fma_f32 v79, v79, v70, v70
v_fma_f32 v80, v80, v74, v74
v_fma_f32 v81, v81, v74, v74
v_fma_f32 v82, v82, v74, v74
v_fma_f32 v83, v83, v74, v74
v_rcp_f32 v76, v76
v_rcp_f32 v77, v77
v_rcp_f32 v78, v78
v_rcp_f32 v79, v79
v_rcp_f32 v80, v80
v_rcp_f32 v81, v81
s_add_u32 m0, s39, 148480
s_nop 0
buffer_load_dwordx4 v24, s[28:31], s38 offen lds
v_rcp_f32 v82, v82
v_rcp_f32 v83, v83
v_mul_f32 v216, v200, v216
v_mul_f32 v217, v201, v217
v_mul_f32 v218, v202, v218
v_mul_f32 v219, v203, v219
v_mul_f32 v248, v232, v248
v_mul_f32 v249, v233, v249
v_mul_f32 v250, v234, v250
v_mul_f32 v251, v235, v251
v_mul_f32 v216, v216, v76
v_mul_f32 v217, v217, v77
v_mul_f32 v218, v218, v78
v_mul_f32 v219, v219, v79
v_mul_f32 v248, v248, v80
v_mul_f32 v249, v249, v81
v_mul_f32 v250, v250, v82
v_mul_f32 v251, v251, v83
v_cvt_pk_bf16_f32 v198, v216, v217
v_cvt_pk_bf16_f32 v199, v218, v219
v_cvt_pk_bf16_f32 v230, v248, v249
v_cvt_pk_bf16_f32 v231, v250, v251
buffer_store_dwordx4 v[196:199], v2, s[24:27], s55 offen offset:2048 sc1
buffer_store_dwordx4 v[228:231], v2, s[24:27], s55 offen offset:3072 sc1
s_add_u32 m0, s39, 149504
s_add_u32 s38, s38, 16384
buffer_load_dwordx4 v23, s[28:31], s38 offen lds
s_add_u32 m0, s39, 150528
s_nop 0
buffer_load_dwordx4 v24, s[28:31], s38 offen lds
s_waitcnt vmcnt(30)
s_barrier
s_add_u32 s37, s52, 688128
s_add_u32 m0, s39, 98304
s_nop 0
buffer_load_dwordx4 v3, s[24:27], s37 offen sc1 lds
buffer_load_dwordx4 v3, s[24:27], s37 offen offset:1024 sc1 lds
buffer_load_dwordx4 v3, s[24:27], s37 offen offset:2048 sc1 lds
buffer_load_dwordx4 v3, s[24:27], s37 offen offset:3072 sc1 lds
s_add_u32 s38, s53, 5505024
s_add_u32 m0, s39, 114688
s_nop 0
buffer_load_dwordx4 v23, s[28:31], s38 offen lds
s_add_u32 m0, s39, 115712
s_nop 0
buffer_load_dwordx4 v24, s[28:31], s38 offen lds
s_add_u32 m0, s39, 116736
s_add_u32 s38, s38, 16384
buffer_load_dwordx4 v23, s[28:31], s38 offen lds
s_add_u32 m0, s39, 117760
s_nop 0
buffer_load_dwordx4 v24, s[28:31], s38 offen lds
s_waitcnt vmcnt(10)
s_barrier
s_cmp_eq_u32 s47, 0
s_cbranch_scc0 Lw_133
s_add_u32 s7, s34, 48
s_lshl_b32 s7, s7, 7
v_mov_b32 v26, s7
v_mov_b32 v27, 1
s_mov_b64 exec, 1
buffer_atomic_add v27, v26, s[56:59], 0 offen sc1
s_mov_b64 exec, -1
Lw_133:
s_add_u32 s37, s52, 704512
s_add_u32 m0, s39, 131072
s_nop 0
buffer_load_dwordx4 v3, s[24:27], s37 offen sc1 lds
buffer_load_dwordx4 v3, s[24:27], s37 offen offset:1024 sc1 lds
buffer_load_dwordx4 v3, s[24:27], s37 offen offset:2048 sc1 lds
buffer_load_dwordx4 v3, s[24:27], s37 offen offset:3072 sc1 lds
s_add_u32 s38, s53, 5636096
s_add_u32 m0, s39, 0
s_nop 0
buffer_load_dwordx4 v23, s[28:31], s38 offen lds
s_add_u32 m0, s39, 1024
s_nop 0
buffer_load_dwordx4 v24, s[28:31], s38 offen lds
s_add_u32 m0, s39, 2048
s_add_u32 s38, s38, 16384
buffer_load_dwordx4 v23, s[28:31], s38 offen lds
s_add_u32 m0, s39, 3072
s_nop 0
buffer_load_dwordx4 v24, s[28:31], s38 offen lds
s_waitcnt vmcnt(26)
s_barrier
s_add_u32 s38, s91, 0
s_add_u32 m0, s39, 32768
s_nop 0
buffer_load_dwordx4 v23, s[28:31], s38 offen lds
s_add_u32 m0, s39, 33792
s_nop 0
buffer_load_dwordx4 v24, s[28:31], s38 offen lds
s_add_u32 m0, s39, 34816
s_add_u32 s38, s38, 16384
buffer_load_dwordx4 v23, s[28:31], s38 offen lds
s_add_u32 m0, s39, 35840
s_nop 0
buffer_load_dwordx4 v24, s[28:31], s38 offen lds
s_waitcnt vmcnt(20)
s_barrier
s_add_u32 s38, s91, 131072
s_add_u32 m0, s39, 65536
s_nop 0
buffer_load_dwordx4 v23, s[28:31], s38 offen lds
s_add_u32 m0, s39, 66560
s_nop 0
buffer_load_dwordx4 v24, s[28:31], s38 offen lds
s_add_u32 m0, s39, 67584
s_add_u32 s38, s38, 16384
buffer_load_dwordx4 v23, s[28:31], s38 offen lds
s_add_u32 m0, s39, 68608
s_nop 0
buffer_load_dwordx4 v24, s[28:31], s38 offen lds
s_waitcnt vmcnt(16)
s_barrier
s_cmp_eq_u32 s47, 3
s_cbranch_scc0 Lw_134
s_lshl_b32 s92, s34, 7
s_add_u32 s92, s92, 28317696
s_load_dword s93, s[82:83], s92 glc
Lw_134:
s_add_u32 s38, s91, 262144
s_add_u32 m0, s39, 147456
s_nop 0
buffer_load_dwordx4 v23, s[28:31], s38 offen lds
s_add_u32 m0, s39, 148480
s_nop 0
buffer_load_dwordx4 v24, s[28:31], s38 offen lds
s_add_u32 m0, s39, 149504
s_add_u32 s38, s38, 16384
buffer_load_dwordx4 v23, s[28:31], s38 offen lds
s_add_u32 m0, s39, 150528
s_nop 0
buffer_load_dwordx4 v24, s[28:31], s38 offen lds
s_waitcnt vmcnt(12)
s_cmp_eq_u32 s47, 3
s_cbranch_scc0 Lw_135
s_mov_b32 s41, 0x40000
s_branch Lpchk_138
Lpoll_136:
s_load_dword s93, s[82:83], s92 glc
Lpchk_138:
s_waitcnt lgkmcnt(0)
s_cmp_eq_u32 s93, 16
s_cbranch_scc1 Lpok_137
s_sub_u32 s41, s41, 1
s_cmp_lg_u32 s41, 0
s_cbranch_scc1 Lpoll_136
Lpok_137:
Lw_135:
s_barrier
s_add_u32 s37, s90, 0
s_add_u32 m0, s39, 16384
s_nop 0
buffer_load_dwordx4 v3, s[24:27], s37 offen sc1 lds
buffer_load_dwordx4 v3, s[24:27], s37 offen offset:1024 sc1 lds
buffer_load_dwordx4 v3, s[24:27], s37 offen offset:2048 sc1 lds
buffer_load_dwordx4 v3, s[24:27], s37 offen offset:3072 sc1 lds
s_add_u32 s37, s90, 16384
s_add_u32 m0, s39, 49152
s_nop 0
buffer_load_dwordx4 v3, s[24:27], s37 offen sc1 lds
buffer_load_dwordx4 v3, s[24:27], s37 offen offset:1024 sc1 lds
buffer_load_dwordx4 v3, s[24:27], s37 offen offset:2048 sc1 lds
buffer_load_dwordx4 v3, s[24:27], s37 offen offset:3072 sc1 lds
s_add_u32 s37, s90, 32768
s_add_u32 m0, s39, 81920
s_nop 0
buffer_load_dwordx4 v3, s[24:27], s37 offen sc1 lds
buffer_load_dwordx4 v3, s[24:27], s37 offen offset:1024 sc1 lds
buffer_load_dwordx4 v3, s[24:27], s37 offen offset:2048 sc1 lds
buffer_load_dwordx4 v3, s[24:27], s37 offen offset:3072 sc1 lds
s_add_u32 s37, s90, 49152
s_add_u32 m0, s39, 98304
s_nop 0
buffer_load_dwordx4 v3, s[24:27], s37 offen sc1 lds
buffer_load_dwordx4 v3, s[24:27], s37 offen offset:1024 sc1 lds
buffer_load_dwordx4 v3, s[24:27], s37 offen offset:2048 sc1 lds
buffer_load_dwordx4 v3, s[24:27], s37 offen offset:3072 sc1 lds
s_add_u32 s38, s91, 393216
s_add_u32 m0, s39, 114688
s_nop 0
buffer_load_dwordx4 v23, s[28:31], s38 offen lds
s_add_u32 m0, s39, 115712
s_nop 0
buffer_load_dwordx4 v24, s[28:31], s38 offen lds
s_add_u32 m0, s39, 116736
s_add_u32 s38, s38, 16384
buffer_load_dwordx4 v23, s[28:31], s38 offen lds
s_add_u32 m0, s39, 117760
s_nop 0
buffer_load_dwordx4 v24, s[28:31], s38 offen lds
s_waitcnt vmcnt(16)
s_barrier
s_add_u32 s37, s90, 65536
s_add_u32 m0, s39, 131072
s_nop 0
buffer_load_dwordx4 v3, s[24:27], s37 offen sc1 lds
buffer_load_dwordx4 v3, s[24:27], s37 offen offset:1024 sc1 lds
buffer_load_dwordx4 v3, s[24:27], s37 offen offset:2048 sc1 lds
buffer_load_dwordx4 v3, s[24:27], s37 offen offset:3072 sc1 lds
s_add_u32 s38, s91, 524288
s_add_u32 m0, s39, 0
s_nop 0
buffer_load_dwordx4 v23, s[28:31], s38 offen lds
s_add_u32 m0, s39, 1024
s_nop 0
buffer_load_dwordx4 v24, s[28:31], s38 offen lds
s_add_u32 m0, s39, 2048
s_add_u32 s38, s38, 16384
buffer_load_dwordx4 v23, s[28:31], s38 offen lds
s_add_u32 m0, s39, 3072
s_nop 0
buffer_load_dwordx4 v24, s[28:31], s38 offen lds
s_waitcnt vmcnt(20)
s_barrier
s_add_u32 s37, s90, 81920
s_add_u32 m0, s39, 16384
s_nop 0
buffer_load_dwordx4 v3, s[24:27], s37 offen sc1 lds
buffer_load_dwordx4 v3, s[24:27], s37 offen offset:1024 sc1 lds
buffer_load_dwordx4 v3, s[24:27], s37 offen offset:2048 sc1 lds
buffer_load_dwordx4 v3, s[24:27], s37 offen offset:3072 sc1 lds
s_add_u32 s38, s91, 655360
s_add_u32 m0, s39, 32768
s_nop 0
buffer_load_dwordx4 v23, s[28:31], s38 offen lds
s_add_u32 m0, s39, 33792
s_nop 0
buffer_load_dwordx4 v24, s[28:31], s38 offen lds
s_add_u32 m0, s39, 34816
s_add_u32 s38, s38, 16384
buffer_load_dwordx4 v23, s[28:31], s38 offen lds
s_add_u32 m0, s39, 35840
s_nop 0
buffer_load_dwordx4 v24, s[28:31], s38 offen lds
s_waitcnt vmcnt(24)
s_barrier
s_add_u32 s37, s90, 98304
s_add_u32 m0, s39, 49152
s_nop 0
buffer_load_dwordx4 v3, s[24:27], s37 offen sc1 lds
buffer_load_dwordx4 v3, s[24:27], s37 offen offset:1024 sc1 lds
buffer_load_dwordx4 v3, s[24:27], s37 offen offset:2048 sc1 lds
buffer_load_dwordx4 v3, s[24:27], s37 offen offset:3072 sc1 lds
s_add_u32 s38, s91, 786432
s_add_u32 m0, s39, 65536
s_nop 0
buffer_load_dwordx4 v23, s[28:31], s38 offen lds
s_add_u32 m0, s39, 66560
s_nop 0
buffer_load_dwordx4 v24, s[28:31], s38 offen lds
s_add_u32 m0, s39, 67584
s_add_u32 s38, s38, 16384
buffer_load_dwordx4 v23, s[28:31], s38 offen lds
s_add_u32 m0, s39, 68608
s_nop 0
buffer_load_dwordx4 v24, s[28:31], s38 offen lds
s_waitcnt vmcnt(24)
s_barrier
s_add_u32 s37, s90, 114688
s_add_u32 m0, s39, 81920
s_nop 0
buffer_load_dwordx4 v3, s[24:27], s37 offen sc1 lds
buffer_load_dwordx4 v3, s[24:27], s37 offen offset:1024 sc1 lds
buffer_load_dwordx4 v3, s[24:27], s37 offen offset:2048 sc1 lds
buffer_load_dwordx4 v3, s[24:27], s37 offen offset:3072 sc1 lds
s_add_u32 s38, s91, 917504
s_add_u32 m0, s39, 147456
s_nop 0
buffer_load_dwordx4 v23, s[28:31], s38 offen lds
s_add_u32 m0, s39, 148480
s_nop 0
buffer_load_dwordx4 v24, s[28:31], s38 offen lds
s_add_u32 m0, s39, 149504
s_add_u32 s38, s38, 16384
buffer_load_dwordx4 v23, s[28:31], s38 offen lds
s_add_u32 m0, s39, 150528
s_nop 0
buffer_load_dwordx4 v24, s[28:31], s38 offen lds
s_waitcnt vmcnt(24)
s_barrier
s_add_u32 s37, s90, 131072
s_add_u32 m0, s39, 98304
s_nop 0
buffer_load_dwordx4 v3, s[24:27], s37 offen sc1 lds
buffer_load_dwordx4 v3, s[24:27], s37 offen offset:1024 sc1 lds
buffer_load_dwordx4 v3, s[24:27], s37 offen offset:2048 sc1 lds
buffer_load_dwordx4 v3, s[24:27], s37 offen offset:3072 sc1 lds
s_add_u32 s38, s91, 1048576
s_add_u32 m0, s39, 114688
s_nop 0
buffer_load_dwordx4 v23, s[28:31], s38 offen lds
s_add_u32 m0, s39, 115712
s_nop 0
buffer_load_dwordx4 v24, s[28:31], s38 offen lds
s_add_u32 m0, s39, 116736
s_add_u32 s38, s38, 16384
buffer_load_dwordx4 v23, s[28:31], s38 offen lds
s_add_u32 m0, s39, 117760
s_nop 0
buffer_load_dwordx4 v24, s[28:31], s38 offen lds
s_waitcnt vmcnt(24)
s_barrier
s_add_u32 s37, s90, 147456
s_add_u32 m0, s39, 131072
s_nop 0
buffer_load_dwordx4 v3, s[24:27], s37 offen sc1 lds
buffer_load_dwordx4 v3, s[24:27], s37 offen offset:1024 sc1 lds
buffer_load_dwordx4 v3, s[24:27], s37 offen offset:2048 sc1 lds
buffer_load_dwordx4 v3, s[24:27], s37 offen offset:3072 sc1 lds
s_add_u32 s38, s91, 1179648
s_add_u32 m0, s39, 0
s_nop 0
buffer_load_dwordx4 v23, s[28:31], s38 offen lds
s_add_u32 m0, s39, 1024
s_nop 0
buffer_load_dwordx4 v24, s[28:31], s38 offen lds
s_add_u32 m0, s39, 2048
s_add_u32 s38, s38, 16384
buffer_load_dwordx4 v23, s[28:31], s38 offen lds
s_add_u32 m0, s39, 3072
s_nop 0
buffer_load_dwordx4 v24, s[28:31], s38 offen lds
s_waitcnt vmcnt(24)
s_barrier
s_mov_b32 s37, 327680
s_add_u32 m0, s39, 16384
s_nop 0
buffer_load_dwordx4 v3, s[24:27], s37 offen sc1 lds
buffer_load_dwordx4 v3, s[24:27], s37 offen offset:1024 sc1 lds
buffer_load_dwordx4 v3, s[24:27], s37 offen offset:2048 sc1 lds
buffer_load_dwordx4 v3, s[24:27], s37 offen offset:3072 sc1 lds
s_mov_b32 s38, 2621440
s_add_u32 m0, s51, 32768
s_nop 0
buffer_load_dwordx4 v25, s[28:31], s38 offen lds
s_add_u32 m0, s51, 33792
s_add_u32 s38, s38, 16384
buffer_load_dwordx4 v25, s[28:31], s38 offen lds
s_waitcnt vmcnt(22)
s_barrier
s_mov_b32 s37, 344064
s_add_u32 m0, s39, 49152
s_nop 0
buffer_load_dwordx4 v3, s[24:27], s37 offen sc1 lds
buffer_load_dwordx4 v3, s[24:27], s37 offen offset:1024 sc1 lds
buffer_load_dwordx4 v3, s[24:27], s37 offen offset:2048 sc1 lds
buffer_load_dwordx4 v3, s[24:27], s37 offen offset:3072 sc1 lds
s_mov_b32 s38, 2752512
s_add_u32 m0, s51, 65536
s_nop 0
buffer_load_dwordx4 v25, s[28:31], s38 offen lds
s_add_u32 m0, s51, 66560
s_add_u32 s38, s38, 16384
buffer_load_dwordx4 v25, s[28:31], s38 offen lds
s_waitcnt vmcnt(20)
s_barrier
s_mov_b32 s37, 360448
s_add_u32 m0, s39, 81920
s_nop 0
buffer_load_dwordx4 v3, s[24:27], s37 offen sc1 lds
buffer_load_dwordx4 v3, s[24:27], s37 offen offset:1024 sc1 lds
buffer_load_dwordx4 v3, s[24:27], s37 offen offset:2048 sc1 lds
buffer_load_dwordx4 v3, s[24:27], s37 offen offset:3072 sc1 lds
s_mov_b32 s38, 2883584
s_add_u32 m0, s51, 147456
s_nop 0
buffer_load_dwordx4 v25, s[28:31], s38 offen lds
s_add_u32 m0, s51, 148480
s_add_u32 s38, s38, 16384
buffer_load_dwordx4 v25, s[28:31], s38 offen lds
s_waitcnt vmcnt(18)
s_barrier
s_mov_b32 s37, 376832
s_add_u32 m0, s39, 98304
s_nop 0
buffer_load_dwordx4 v3, s[24:27], s37 offen sc1 lds
buffer_load_dwordx4 v3, s[24:27], s37 offen offset:1024 sc1 lds
buffer_load_dwordx4 v3, s[24:27], s37 offen offset:2048 sc1 lds
buffer_load_dwordx4 v3, s[24:27], s37 offen offset:3072 sc1 lds
s_mov_b32 s38, 3014656
s_add_u32 m0, s51, 114688
s_nop 0
buffer_load_dwordx4 v25, s[28:31], s38 offen lds
s_add_u32 m0, s51, 115712
s_add_u32 s38, s38, 16384
buffer_load_dwordx4 v25, s[28:31], s38 offen lds
s_waitcnt vmcnt(18)
s_barrier
s_mov_b32 s37, 393216
s_add_u32 m0, s39, 131072
s_nop 0
buffer_load_dwordx4 v3, s[24:27], s37 offen sc1 lds
buffer_load_dwordx4 v3, s[24:27], s37 offen offset:1024 sc1 lds
buffer_load_dwordx4 v3, s[24:27], s37 offen offset:2048 sc1 lds
buffer_load_dwordx4 v3, s[24:27], s37 offen offset:3072 sc1 lds
s_mov_b32 s38, 3145728
s_add_u32 m0, s51, 0
s_nop 0
buffer_load_dwordx4 v25, s[28:31], s38 offen lds
s_add_u32 m0, s51, 1024
s_add_u32 s38, s38, 16384
buffer_load_dwordx4 v25, s[28:31], s38 offen lds
s_waitcnt vmcnt(18)
s_barrier
s_mov_b32 s37, 409600
s_add_u32 m0, s39, 16384
s_nop 0
buffer_load_dwordx4 v3, s[24:27], s37 offen sc1 lds
buffer_load_dwordx4 v3, s[24:27], s37 offen offset:1024 sc1 lds
buffer_load_dwordx4 v3, s[24:27], s37 offen offset:2048 sc1 lds
buffer_load_dwordx4 v3, s[24:27], s37 offen offset:3072 sc1 lds
s_mov_b32 s38, 3276800
s_add_u32 m0, s51, 32768
s_nop 0
buffer_load_dwordx4 v25, s[28:31], s38 offen lds
s_add_u32 m0, s51, 33792
s_add_u32 s38, s38, 16384
buffer_load_dwordx4 v25, s[28:31], s38 offen lds
s_waitcnt vmcnt(18)
s_barrier
s_branch Lov_18
.p2align 12
.fill 144, 4, 0xbf800000
Lst_18_0:
s_branch Lwr_171
s_nop 0
s_nop 0
Lov_18:
s_mov_b32 s37, 425984
s_add_u32 m0, s39, 49152
s_nop 0
buffer_load_dwordx4 v3, s[24:27], s37 offen sc1 lds
buffer_load_dwordx4 v3, s[24:27], s37 offen offset:1024 sc1 lds
buffer_load_dwordx4 v3, s[24:27], s37 offen offset:2048 sc1 lds
buffer_load_dwordx4 v3, s[24:27], s37 offen offset:3072 sc1 lds
s_mov_b32 s38, 3407872
s_add_u32 m0, s51, 65536
s_nop 0
buffer_load_dwordx4 v25, s[28:31], s38 offen lds
s_add_u32 m0, s51, 66560
s_add_u32 s38, s38, 16384
buffer_load_dwordx4 v25, s[28:31], s38 offen lds
s_waitcnt vmcnt(18)
s_barrier
s_mov_b32 s37, 442368
s_add_u32 m0, s39, 81920
s_nop 0
buffer_load_dwordx4 v3, s[24:27], s37 offen sc1 lds
buffer_load_dwordx4 v3, s[24:27], s37 offen offset:1024 sc1 lds
buffer_load_dwordx4 v3, s[24:27], s37 offen offset:2048 sc1 lds
buffer_load_dwordx4 v3, s[24:27], s37 offen offset:3072 sc1 lds
s_mov_b32 s38, 3538944
s_add_u32 m0, s51, 147456
s_nop 0
buffer_load_dwordx4 v25, s[28:31], s38 offen lds
s_add_u32 m0, s51, 148480
s_add_u32 s38, s38, 16384
buffer_load_dwordx4 v25, s[28:31], s38 offen lds
s_waitcnt vmcnt(18)
s_barrier
s_mov_b32 s37, 458752
s_add_u32 m0, s39, 98304
s_nop 0
buffer_load_dwordx4 v3, s[24:27], s37 offen sc1 lds
buffer_load_dwordx4 v3, s[24:27], s37 offen offset:1024 sc1 lds
buffer_load_dwordx4 v3, s[24:27], s37 offen offset:2048 sc1 lds
buffer_load_dwordx4 v3, s[24:27], s37 offen offset:3072 sc1 lds
s_mov_b32 s38, 3670016
s_add_u32 m0, s51, 114688
s_nop 0
buffer_load_dwordx4 v25, s[28:31], s38 offen lds
s_add_u32 m0, s51, 115712
s_add_u32 s38, s38, 16384
buffer_load_dwordx4 v25, s[28:31], s38 offen lds
s_waitcnt vmcnt(18)
s_barrier
s_mov_b32 s37, 475136
s_add_u32 m0, s39, 131072
s_nop 0
buffer_load_dwordx4 v3, s[24:27], s37 offen sc1 lds
buffer_load_dwordx4 v3, s[24:27], s37 offen offset:1024 sc1 lds
buffer_load_dwordx4 v3, s[24:27], s37 offen offset:2048 sc1 lds
buffer_load_dwordx4 v3, s[24:27], s37 offen offset:3072 sc1 lds
s_mov_b32 s38, 3801088
s_add_u32 m0, s51, 0
s_nop 0
buffer_load_dwordx4 v25, s[28:31], s38 offen lds
s_add_u32 m0, s51, 1024
s_add_u32 s38, s38, 16384
buffer_load_dwordx4 v25, s[28:31], s38 offen lds
s_waitcnt vmcnt(18)
s_barrier
s_cmp_eq_u32 s47, 0
s_cbranch_scc0 Lw_139
s_xor_b32 s43, s2, 2
s_add_u32 s43, s43, 128
s_lshl_b32 s43, s43, 7
v_mov_b32 v26, s43
v_mov_b32 v27, 1
s_mov_b64 exec, 1
buffer_store_dword v27, v26, s[56:59], 0 offen sc1
s_mov_b64 exec, -1
Lw_139:
s_mov_b32 s37, 491520
s_add_u32 m0, s39, 16384
s_nop 0
buffer_load_dwordx4 v3, s[24:27], s37 offen sc1 lds
buffer_load_dwordx4 v3, s[24:27], s37 offen offset:1024 sc1 lds
buffer_load_dwordx4 v3, s[24:27], s37 offen offset:2048 sc1 lds
buffer_load_dwordx4 v3, s[24:27], s37 offen offset:3072 sc1 lds
s_mov_b32 s38, 3932160
s_add_u32 m0, s51, 32768
s_nop 0
buffer_load_dwordx4 v25, s[28:31], s38 offen lds
s_add_u32 m0, s51, 33792
s_add_u32 s38, s38, 16384
buffer_load_dwordx4 v25, s[28:31], s38 offen lds
s_waitcnt vmcnt(18)
s_barrier
s_mov_b32 s37, 507904
s_add_u32 m0, s39, 49152
s_nop 0
buffer_load_dwordx4 v3, s[24:27], s37 offen sc1 lds
buffer_load_dwordx4 v3, s[24:27], s37 offen offset:1024 sc1 lds
buffer_load_dwordx4 v3, s[24:27], s37 offen offset:2048 sc1 lds
buffer_load_dwordx4 v3, s[24:27], s37 offen offset:3072 sc1 lds
s_mov_b32 s38, 4063232
s_add_u32 m0, s51, 65536
s_nop 0
buffer_load_dwordx4 v25, s[28:31], s38 offen lds
s_add_u32 m0, s51, 66560
s_add_u32 s38, s38, 16384
buffer_load_dwordx4 v25, s[28:31], s38 offen lds
s_waitcnt vmcnt(18)
s_barrier
s_cmp_eq_u32 s47, 3
s_cbranch_scc0 Lw_140
s_lshl_b32 s92, s2, 7
s_add_u32 s92, s92, 28327936
s_load_dword s93, s[82:83], s92 glc
Lw_140:
s_waitcnt vmcnt(12)
s_cmp_eq_u32 s47, 3
s_cbranch_scc0 Lw_141
s_mov_b32 s41, 0x40000
s_branch Lpchk_144
Lpoll_142:
s_load_dword s93, s[82:83], s92 glc
Lpchk_144:
s_waitcnt lgkmcnt(0)
s_cmp_eq_u32 s93, 1
s_cbranch_scc1 Lpok_143
s_sub_u32 s41, s41, 1
s_cmp_lg_u32 s41, 0
s_cbranch_scc1 Lpoll_142
Lpok_143:
Lw_141:
s_barrier
s_waitcnt vmcnt(6)
s_barrier
s_waitcnt vmcnt(0)
s_barrier
s_barrier
s_branch Ldone_1
Ldone_1:
Lfin:
Lexit_2:
s_endpgm
.section .rodata,"a"
.p2align 6
.amdhsa_kernel sequential_preLN__sliding_local_dilated__glu_gated_geglu__prompt_kernel
  .amdhsa_next_free_vgpr 256
  .amdhsa_next_free_sgpr 100
  .amdhsa_accum_offset 256
  .amdhsa_group_segment_fixed_size 0
  .amdhsa_kernarg_size 80
  .amdhsa_user_sgpr_count 2
  .amdhsa_user_sgpr_kernarg_segment_ptr 1
  .amdhsa_system_sgpr_workgroup_id_x 1
  .amdhsa_float_denorm_mode_32 3
  .amdhsa_float_denorm_mode_16_64 3
.end_amdhsa_kernel
```

```asm
; @launch grid=(256,1,1) block=(512,1,1) lds=163840
.amdgcn_target "amdgcn-amd-amdhsa--gfx950"
.text
.globl sequential_preLN__sliding_local_dilated__glu_gated_geglu__prompt_kernel
.p2align 8
.type sequential_preLN__sliding_local_dilated__glu_gated_geglu__prompt_kernel,@function
sequential_preLN__sliding_local_dilated__glu_gated_geglu__prompt_kernel:
s_cmp_ge_u32 s2, 256
s_cbranch_scc1 Lexit_2
s_load_dwordx16 s[64:79], s[0:1], 0
s_load_dwordx4 s[80:83], s[0:1], 64
s_and_b32 s3, s2, 7
s_lshr_b32 s42, s2, 3
s_and_b32 s34, s3, 1
s_lshl_b32 s34, s34, 3
s_and_b32 s48, s42, 7
s_add_u32 s34, s34, s48
s_lshr_b32 s35, s3, 1
s_lshr_b32 s49, s42, 3
s_lshl_b32 s35, s35, 2
s_add_u32 s35, s35, s49
v_lshrrev_b32 v12, 6, v0
v_and_b32 v1, 63, v0
v_readfirstlane_b32 s36, v12
Lbeg:
s_lshl_b32 s50, s34, 7
s_sub_u32 s50, s50, 16
v_and_b32 v12, 15, v1
v_lshrrev_b32 v13, 4, v1
s_cmp_lt_u32 s36, 4
s_cbranch_scc1 Lcons_7
Lprod_3:
s_sub_u32 s47, s36, 4
s_lshl_b32 s43, s34, 7
s_lshl_b32 s44, s35, 3
s_add_u32 s63, s43, s44
s_lshl_b32 s44, s47, 1
s_add_u32 s51, s63, s44
v_lshlrev_b32 v10, 4, v1
s_and_b32 s43, s2, 7
s_lshr_b32 s44, s43, 2
s_lshl_b32 s44, s44, 1
s_and_b32 s45, s43, 1
s_add_u32 s44, s44, s45
s_lshr_b32 s45, s2, 3
s_lshl_b32 s45, s45, 2
s_add_u32 s44, s44, s45
s_add_u32 s44, s44, 96
s_bitcmp1_b32 s43, 1
s_cselect_b32 s44, s44, 0x10000
s_cmp_lt_u32 s2, 192
s_cselect_b32 s33, s2, s44
v_lshrrev_b32 v14, 3, v1
v_and_b32 v15, 7, v1
v_lshl_add_u32 v19, v14, 6, v15
s_lshl_b32 s43, s48, 3
v_add_u32 v19, s43, v19
v_mul_u32_u24 v19, 6144, v19
s_cmp_eq_u32 s47, 3
s_cbranch_scc1 Lpf_4
v_and_b32 v16, 2, v14
v_xor_b32 v16, v15, v16
v_lshlrev_b32 v16, 4, v16
v_mul_u32_u24 v17, 6144, v14
s_lshl_b32 s43, s47, 11
v_add3_u32 v2, v17, v16, s43
v_xor_b32 v3, 64, v2
v_lshrrev_b32 v16, 1, v14
v_xor_b32 v16, v15, v16
v_lshlrev_b32 v16, 4, v16
s_lshl_b32 s43, s47, 3
s_add_u32 s43, s43, s50
v_add_u32 v17, s43, v14
s_and_b32 s44, s47, 1
s_lshl_b32 s44, s44, 6
v_add_u32 v18, 0, v17
v_max_i32 v18, 0, v18
v_lshl_add_u32 v18, v18, 11, v16
v_xor_b32 v18, s44, v18
v_mov_b32 v4, v18
v_add_u32 v18, 24, v17
v_max_i32 v18, 0, v18
v_lshl_add_u32 v18, v18, 11, v16
v_xor_b32 v18, s44, v18
v_xor_b32 v5, 64, v18
v_add_u32 v18, 48, v17
v_max_i32 v18, 0, v18
v_lshl_add_u32 v18, v18, 11, v16
v_xor_b32 v18, s44, v18
v_mov_b32 v6, v18
v_add_u32 v18, 72, v17
v_max_i32 v18, 0, v18
v_lshl_add_u32 v18, v18, 11, v16
v_xor_b32 v18, s44, v18
v_xor_b32 v7, 64, v18
v_add_u32 v18, 96, v17
v_max_i32 v18, 0, v18
v_lshl_add_u32 v18, v18, 11, v16
v_xor_b32 v18, s44, v18
v_mov_b32 v8, v18
v_add_u32 v18, 120, v17
v_max_i32 v18, 0, v18
v_lshl_add_u32 v18, v18, 11, v16
v_xor_b32 v18, s44, v18
v_xor_b32 v9, 64, v18
s_lshl_b32 s39, s47, 10
s_lshl_b32 s40, s47, 13
s_add_u32 s40, s40, 18432
s_mov_b32 s37, 0
s_mov_b32 s38, 0
s_bfm_b64 s[60:61], 56, 8
s_cmp_eq_u32 s47, 0
s_cselect_b64 s[60:61], s[60:61], -1
s_lshl_b32 s43, s35, 7
s_waitcnt lgkmcnt(0)
s_mov_b32 s8, s64
s_mov_b32 s9, s65
s_mov_b32 s10, 4194304
s_mov_b32 s11, 0x20000
s_add_u32 s12, s66, s43
s_addc_u32 s13, s67, 0
s_mov_b32 s14, 6289536
s_mov_b32 s15, 0x20000
s_mov_b32 s28, s66
s_mov_b32 s29, s67
s_mov_b32 s30, 6291456
s_mov_b32 s31, 0x20000
s_mul_i32 s43, s33, 5376
v_lshlrev_b32 v30, 7, v1
s_mul_i32 s44, s47, 1792
s_add_u32 s43, s43, s44
s_bfm_b64 exec, 14, 0
buffer_load_dword v31, v30, s[28:31], s43 offen
s_mov_b64 exec, -1
s_add_u32 m0, s39, 0
s_mov_b64 exec, s[60:61]
buffer_load_dwordx4 v4, s[8:11], s37 offen lds
s_mov_b64 exec, -1
s_add_u32 m0, s39, 3072
s_nop 0
buffer_load_dwordx4 v5, s[8:11], s37 offen lds
s_add_u32 m0, s39, 6144
s_nop 0
buffer_load_dwordx4 v6, s[8:11], s37 offen lds
s_add_u32 m0, s39, 9216
s_nop 0
buffer_load_dwordx4 v7, s[8:11], s37 offen lds
s_add_u32 m0, s39, 12288
s_nop 0
buffer_load_dwordx4 v8, s[8:11], s37 offen lds
s_add_u32 m0, s39, 15360
s_nop 0
buffer_load_dwordx4 v9, s[8:11], s37 offen lds
s_add_u32 m0, s40, 0
s_add_u32 s43, s38, 0
buffer_load_dwordx4 v2, s[12:15], s43 offen lds
s_add_u32 m0, s40, 1024
s_add_u32 s43, s38, 49152
buffer_load_dwordx4 v3, s[12:15], s43 offen lds
s_add_u32 m0, s40, 2048
s_add_u32 s43, s38, 98304
buffer_load_dwordx4 v2, s[12:15], s43 offen lds
s_add_u32 m0, s40, 3072
s_add_u32 s43, s38, 147456
buffer_load_dwordx4 v3, s[12:15], s43 offen lds
s_add_u32 m0, s40, 4096
s_add_u32 s43, s38, 196608
buffer_load_dwordx4 v2, s[12:15], s43 offen lds
s_add_u32 m0, s40, 5120
s_add_u32 s43, s38, 245760
buffer_load_dwordx4 v3, s[12:15], s43 offen lds
s_add_u32 m0, s40, 6144
s_add_u32 s43, s38, 294912
buffer_load_dwordx4 v2, s[12:15], s43 offen lds
s_add_u32 m0, s40, 7168
s_add_u32 s43, s38, 344064
buffer_load_dwordx4 v3, s[12:15], s43 offen lds
s_add_u32 s37, s37, 128
s_add_u32 s38, s38, 393216
s_lshl_b32 s43, s51, 11
buffer_load_dwordx4 v[96:99], v10, s[8:11], s43 offen offset:0
buffer_load_dwordx4 v[100:103], v10, s[8:11], s43 offen offset:1024
buffer_load_dwordx4 v[104:107], v10, s[8:11], s43 offen offset:2048
buffer_load_dwordx4 v[108:111], v10, s[8:11], s43 offen offset:3072
s_add_u32 m0, s39, 43008
s_mov_b64 exec, s[60:61]
buffer_load_dwordx4 v4, s[8:11], s37 offen lds
s_mov_b64 exec, -1
s_add_u32 m0, s39, 46080
s_nop 0
buffer_load_dwordx4 v5, s[8:11], s37 offen lds
s_add_u32 m0, s39, 49152
s_nop 0
buffer_load_dwordx4 v6, s[8:11], s37 offen lds
s_add_u32 m0, s39, 52224
s_nop 0
buffer_load_dwordx4 v7, s[8:11], s37 offen lds
s_add_u32 m0, s39, 55296
s_nop 0
buffer_load_dwordx4 v8, s[8:11], s37 offen lds
s_add_u32 m0, s39, 58368
s_nop 0
buffer_load_dwordx4 v9, s[8:11], s37 offen lds
s_add_u32 m0, s40, 43008
s_add_u32 s43, s38, 0
buffer_load_dwordx4 v2, s[12:15], s43 offen lds
s_add_u32 m0, s40, 44032
s_add_u32 s43, s38, 49152
buffer_load_dwordx4 v3, s[12:15], s43 offen lds
s_add_u32 m0, s40, 45056
s_add_u32 s43, s38, 98304
buffer_load_dwordx4 v2, s[12:15], s43 offen lds
s_add_u32 m0, s40, 46080
s_add_u32 s43, s38, 147456
buffer_load_dwordx4 v3, s[12:15], s43 offen lds
s_add_u32 m0, s40, 47104
s_add_u32 s43, s38, 196608
buffer_load_dwordx4 v2, s[12:15], s43 offen lds
s_add_u32 m0, s40, 48128
s_add_u32 s43, s38, 245760
buffer_load_dwordx4 v3, s[12:15], s43 offen lds
s_add_u32 m0, s40, 49152
s_add_u32 s43, s38, 294912
buffer_load_dwordx4 v2, s[12:15], s43 offen lds
s_add_u32 m0, s40, 50176
s_add_u32 s43, s38, 344064
buffer_load_dwordx4 v3, s[12:15], s43 offen lds
s_add_u32 s37, s37, 128
s_add_u32 s38, s38, 393216
s_waitcnt vmcnt(18)
s_barrier
s_add_u32 m0, s39, 86016
s_mov_b64 exec, s[60:61]
buffer_load_dwordx4 v4, s[8:11], s37 offen lds
s_mov_b64 exec, -1
s_add_u32 m0, s39, 89088
s_nop 0
buffer_load_dwordx4 v5, s[8:11], s37 offen lds
s_add_u32 m0, s39, 92160
s_nop 0
buffer_load_dwordx4 v6, s[8:11], s37 offen lds
s_add_u32 m0, s39, 95232
s_nop 0
buffer_load_dwordx4 v7, s[8:11], s37 offen lds
s_add_u32 m0, s39, 98304
s_nop 0
buffer_load_dwordx4 v8, s[8:11], s37 offen lds
s_add_u32 m0, s39, 101376
s_nop 0
buffer_load_dwordx4 v9, s[8:11], s37 offen lds
s_add_u32 m0, s40, 86016
s_add_u32 s43, s38, 0
buffer_load_dwordx4 v2, s[12:15], s43 offen lds
s_add_u32 m0, s40, 87040
s_add_u32 s43, s38, 49152
buffer_load_dwordx4 v3, s[12:15], s43 offen lds
s_add_u32 m0, s40, 88064
s_add_u32 s43, s38, 98304
buffer_load_dwordx4 v2, s[12:15], s43 offen lds
s_add_u32 m0, s40, 89088
s_add_u32 s43, s38, 147456
buffer_load_dwordx4 v3, s[12:15], s43 offen lds
s_add_u32 m0, s40, 90112
s_add_u32 s43, s38, 196608
buffer_load_dwordx4 v2, s[12:15], s43 offen lds
s_add_u32 m0, s40, 91136
s_add_u32 s43, s38, 245760
buffer_load_dwordx4 v3, s[12:15], s43 offen lds
s_add_u32 m0, s40, 92160
s_add_u32 s43, s38, 294912
buffer_load_dwordx4 v2, s[12:15], s43 offen lds
s_add_u32 m0, s40, 93184
s_add_u32 s43, s38, 344064
buffer_load_dwordx4 v3, s[12:15], s43 offen lds
s_add_u32 s37, s37, 128
s_add_u32 s38, s38, 393216
s_waitcnt vmcnt(28)
s_mov_b32 s43, 0x3f803f80
v_mov_b32 v116, 0
v_mov_b32 v117, 0
v_mov_b32 v118, 0
v_mov_b32 v119, 0
v_mov_b32 v120, 0
v_mov_b32 v121, 0
v_mov_b32 v122, 0
v_mov_b32 v123, 0
v_dot2_f32_bf16 v116, v96, s43, v116
v_dot2_f32_bf16 v120, v96, v96, v120
v_dot2_f32_bf16 v118, v104, s43, v118
v_dot2_f32_bf16 v122, v104, v104, v122
v_dot2_f32_bf16 v117, v97, s43, v117
v_dot2_f32_bf16 v121, v97, v97, v121
v_dot2_f32_bf16 v119, v105, s43, v119
v_dot2_f32_bf16 v123, v105, v105, v123
v_dot2_f32_bf16 v116, v98, s43, v116
v_dot2_f32_bf16 v120, v98, v98, v120
v_dot2_f32_bf16 v118, v106, s43, v118
v_dot2_f32_bf16 v122, v106, v106, v122
v_dot2_f32_bf16 v117, v99, s43, v117
v_dot2_f32_bf16 v121, v99, v99, v121
v_dot2_f32_bf16 v119, v107, s43, v119
v_dot2_f32_bf16 v123, v107, v107, v123
v_dot2_f32_bf16 v116, v100, s43, v116
v_dot2_f32_bf16 v120, v100, v100, v120
v_dot2_f32_bf16 v118, v108, s43, v118
v_dot2_f32_bf16 v122, v108, v108, v122
v_dot2_f32_bf16 v117, v101, s43, v117
v_dot2_f32_bf16 v121, v101, v101, v121
v_dot2_f32_bf16 v119, v109, s43, v119
v_dot2_f32_bf16 v123, v109, v109, v123
v_dot2_f32_bf16 v116, v102, s43, v116
v_dot2_f32_bf16 v120, v102, v102, v120
v_dot2_f32_bf16 v118, v110, s43, v118
v_dot2_f32_bf16 v122, v110, v110, v122
v_dot2_f32_bf16 v117, v103, s43, v117
v_dot2_f32_bf16 v121, v103, v103, v121
v_dot2_f32_bf16 v119, v111, s43, v119
v_dot2_f32_bf16 v123, v111, v111, v123
s_nop 2
v_add_f32 v116, v116, v117
v_add_f32 v118, v118, v119
v_add_f32 v120, v120, v121
v_add_f32 v122, v122, v123
s_nop 1
v_permlane32_swap_b32 v116, v118
v_permlane32_swap_b32 v120, v122
v_add_f32 v116, v116, v118
v_add_f32 v120, v120, v122
s_nop 1
v_permlane16_swap_b32 v116, v120
v_add_f32 v116, v116, v120
s_nop 1
v_add_f32_dpp v116, v116, v116 row_ror:8 row_mask:0xf bank_mask:0xf
s_nop 1
v_add_f32_dpp v116, v116, v116 row_ror:4 row_mask:0xf bank_mask:0xf
s_nop 1
v_add_f32_dpp v116, v116, v116 row_ror:2 row_mask:0xf bank_mask:0xf
s_nop 1
v_add_f32_dpp v116, v116, v116 row_ror:1 row_mask:0xf bank_mask:0xf
v_mov_b32 v117, v116
s_nop 1
v_permlane16_swap_b32 v116, v117
v_mul_f32 v112, 0x3a800000, v116
v_mul_f32 v113, 0x3a800000, v117
v_fma_f32 v113, -v112, v112, v113
v_max_f32 v113, 0, v113
v_add_f32 v113, 0x3727c5ac, v113
v_rsq_f32 v113, v113
v_lshrrev_b32 v11, 5, v1
s_lshl_b32 s43, s47, 4
s_add_u32 s43, s43, 148608
v_lshl_add_u32 v11, v11, 3, s43
ds_write_b64 v11, v[112:113]
s_waitcnt lgkmcnt(0)
s_and_b32 s44, s36, 3
s_mul_i32 s44, s44, 24
s_bfe_u32 s43, s2, 0x30001
s_lshl_b32 s43, s43, 7
s_add_u32 s44, s44, s43
s_mul_i32 s44, s44, 7168
s_lshr_b32 s43, s2, 4
s_lshl_b32 s43, s43, 8
s_add_u32 s43, s43, s44
s_bitcmp0_b32 s2, 0
s_cselect_b32 s4, s72, s74
s_cselect_b32 s5, s73, s75
s_add_u32 s4, s4, s43
s_addc_u32 s5, s5, 0
s_waitcnt vmcnt(14)
s_barrier
s_add_u32 m0, s39, 0
s_mov_b64 exec, s[60:61]
buffer_load_dwordx4 v4, s[8:11], s37 offen lds
s_mov_b64 exec, -1
s_add_u32 m0, s39, 3072
s_nop 0
buffer_load_dwordx4 v5, s[8:11], s37 offen lds
s_add_u32 m0, s39, 6144
s_nop 0
buffer_load_dwordx4 v6, s[8:11], s37 offen lds
s_add_u32 m0, s39, 9216
s_nop 0
buffer_load_dwordx4 v7, s[8:11], s37 offen lds
s_add_u32 m0, s39, 12288
s_nop 0
buffer_load_dwordx4 v8, s[8:11], s37 offen lds
s_add_u32 m0, s39, 15360
s_nop 0
buffer_load_dwordx4 v9, s[8:11], s37 offen lds
s_add_u32 m0, s40, 0
s_add_u32 s43, s38, 0
buffer_load_dwordx4 v2, s[12:15], s43 offen lds
s_add_u32 m0, s40, 1024
s_add_u32 s43, s38, 49152
buffer_load_dwordx4 v3, s[12:15], s43 offen lds
s_add_u32 m0, s40, 2048
s_add_u32 s43, s38, 98304
buffer_load_dwordx4 v2, s[12:15], s43 offen lds
s_add_u32 m0, s40, 3072
s_add_u32 s43, s38, 147456
buffer_load_dwordx4 v3, s[12:15], s43 offen lds
s_add_u32 m0, s40, 4096
s_add_u32 s43, s38, 196608
buffer_load_dwordx4 v2, s[12:15], s43 offen lds
s_add_u32 m0, s40, 5120
s_add_u32 s43, s38, 245760
buffer_load_dwordx4 v3, s[12:15], s43 offen lds
s_add_u32 m0, s40, 6144
s_add_u32 s43, s38, 294912
buffer_load_dwordx4 v2, s[12:15], s43 offen lds
s_add_u32 m0, s40, 7168
s_add_u32 s43, s38, 344064
buffer_load_dwordx4 v3, s[12:15], s43 offen lds
s_add_u32 s37, s37, 128
s_add_u32 s38, s38, 393216
s_waitcnt vmcnt(14)
s_barrier
s_add_u32 m0, s39, 43008
s_mov_b64 exec, s[60:61]
buffer_load_dwordx4 v4, s[8:11], s37 offen lds
s_mov_b64 exec, -1
s_add_u32 m0, s39, 46080
s_nop 0
buffer_load_dwordx4 v5, s[8:11], s37 offen lds
s_add_u32 m0, s39, 49152
s_nop 0
buffer_load_dwordx4 v6, s[8:11], s37 offen lds
s_add_u32 m0, s39, 52224
s_nop 0
buffer_load_dwordx4 v7, s[8:11], s37 offen lds
s_add_u32 m0, s39, 55296
s_nop 0
buffer_load_dwordx4 v8, s[8:11], s37 offen lds
s_add_u32 m0, s39, 58368
s_nop 0
buffer_load_dwordx4 v9, s[8:11], s37 offen lds
s_add_u32 m0, s40, 43008
s_add_u32 s43, s38, 0
buffer_load_dwordx4 v2, s[12:15], s43 offen lds
s_add_u32 m0, s40, 44032
s_add_u32 s43, s38, 49152
buffer_load_dwordx4 v3, s[12:15], s43 offen lds
s_add_u32 m0, s40, 45056
s_add_u32 s43, s38, 98304
buffer_load_dwordx4 v2, s[12:15], s43 offen lds
s_add_u32 m0, s40, 46080
s_add_u32 s43, s38, 147456
buffer_load_dwordx4 v3, s[12:15], s43 offen lds
s_add_u32 m0, s40, 47104
s_add_u32 s43, s38, 196608
buffer_load_dwordx4 v2, s[12:15], s43 offen lds
s_add_u32 m0, s40, 48128
s_add_u32 s43, s38, 245760
buffer_load_dwordx4 v3, s[12:15], s43 offen lds
s_add_u32 m0, s40, 49152
s_add_u32 s43, s38, 294912
buffer_load_dwordx4 v2, s[12:15], s43 offen lds
s_add_u32 m0, s40, 50176
s_add_u32 s43, s38, 344064
buffer_load_dwordx4 v3, s[12:15], s43 offen lds
s_add_u32 s37, s37, 128
s_add_u32 s38, s38, 393216
s_load_dword s3, s[4:5], 0
s_load_dword s3, s[4:5], 64
s_load_dword s3, s[4:5], 128
s_waitcnt vmcnt(14)
s_barrier
s_add_u32 m0, s39, 86016
s_mov_b64 exec, s[60:61]
buffer_load_dwordx4 v4, s[8:11], s37 offen lds
s_mov_b64 exec, -1
s_add_u32 m0, s39, 89088
s_nop 0
buffer_load_dwordx4 v5, s[8:11], s37 offen lds
s_add_u32 m0, s39, 92160
s_nop 0
buffer_load_dwordx4 v6, s[8:11], s37 offen lds
s_add_u32 m0, s39, 95232
s_nop 0
buffer_load_dwordx4 v7, s[8:11], s37 offen lds
s_add_u32 m0, s39, 98304
s_nop 0
buffer_load_dwordx4 v8, s[8:11], s37 offen lds
s_add_u32 m0, s39, 101376
s_nop 0
buffer_load_dwordx4 v9, s[8:11], s37 offen lds
s_add_u32 m0, s40, 86016
s_add_u32 s43, s38, 0
buffer_load_dwordx4 v2, s[12:15], s43 offen lds
s_add_u32 m0, s40, 87040
s_add_u32 s43, s38, 49152
buffer_load_dwordx4 v3, s[12:15], s43 offen lds
s_add_u32 m0, s40, 88064
s_add_u32 s43, s38, 98304
buffer_load_dwordx4 v2, s[12:15], s43 offen lds
s_add_u32 m0, s40, 89088
s_add_u32 s43, s38, 147456
buffer_load_dwordx4 v3, s[12:15], s43 offen lds
s_add_u32 m0, s40, 90112
s_add_u32 s43, s38, 196608
buffer_load_dwordx4 v2, s[12:15], s43 offen lds
s_add_u32 m0, s40, 91136
s_add_u32 s43, s38, 245760
buffer_load_dwordx4 v3, s[12:15], s43 offen lds
s_add_u32 m0, s40, 92160
s_add_u32 s43, s38, 294912
buffer_load_dwordx4 v2, s[12:15], s43 offen lds
s_add_u32 m0, s40, 93184
s_add_u32 s43, s38, 344064
buffer_load_dwordx4 v3, s[12:15], s43 offen lds
s_add_u32 s37, s37, 128
s_add_u32 s38, s38, 393216
s_load_dword s3, s[4:5], 192
s_load_dword s3, s[4:5], 7168
s_load_dword s3, s[4:5], 7232
s_load_dword s3, s[4:5], 7296
s_waitcnt vmcnt(14)
s_barrier
s_add_u32 m0, s39, 0
s_mov_b64 exec, s[60:61]
buffer_load_dwordx4 v4, s[8:11], s37 offen lds
s_mov_b64 exec, -1
s_add_u32 m0, s39, 3072
s_nop 0
buffer_load_dwordx4 v5, s[8:11], s37 offen lds
s_add_u32 m0, s39, 6144
s_nop 0
buffer_load_dwordx4 v6, s[8:11], s37 offen lds
s_add_u32 m0, s39, 9216
s_nop 0
s_branch Lov_0
.p2align 12
Lst_0_0:
s_branch Lst_1_0
s_nop 0
s_nop 0
Lov_0:
buffer_load_dwordx4 v7, s[8:11], s37 offen lds
s_add_u32 m0, s39, 12288
s_nop 0
buffer_load_dwordx4 v8, s[8:11], s37 offen lds
s_add_u32 m0, s39, 15360
s_nop 0
buffer_load_dwordx4 v9, s[8:11], s37 offen lds
s_add_u32 m0, s40, 0
s_add_u32 s43, s38, 0
buffer_load_dwordx4 v2, s[12:15], s43 offen lds
s_add_u32 m0, s40, 1024
s_add_u32 s43, s38, 49152
buffer_load_dwordx4 v3, s[12:15], s43 offen lds
s_add_u32 m0, s40, 2048
s_add_u32 s43, s38, 98304
buffer_load_dwordx4 v2, s[12:15], s43 offen lds
s_add_u32 m0, s40, 3072
s_add_u32 s43, s38, 147456
buffer_load_dwordx4 v3, s[12:15], s43 offen lds
s_add_u32 m0, s40, 4096
s_add_u32 s43, s38, 196608
buffer_load_dwordx4 v2, s[12:15], s43 offen lds
s_add_u32 m0, s40, 5120
s_add_u32 s43, s38, 245760
buffer_load_dwordx4 v3, s[12:15], s43 offen lds
s_add_u32 m0, s40, 6144
s_add_u32 s43, s38, 294912
buffer_load_dwordx4 v2, s[12:15], s43 offen lds
s_add_u32 m0, s40, 7168
s_add_u32 s43, s38, 344064
buffer_load_dwordx4 v3, s[12:15], s43 offen lds
s_add_u32 s37, s37, 128
s_add_u32 s38, s38, 393216
s_load_dword s3, s[4:5], 7360
s_load_dword s3, s[4:5], 14336
s_load_dword s3, s[4:5], 14400
s_load_dword s3, s[4:5], 14464
s_load_dword s3, s[4:5], 14528
s_waitcnt vmcnt(14)
s_barrier
s_add_u32 m0, s39, 43008
s_mov_b64 exec, s[60:61]
buffer_load_dwordx4 v4, s[8:11], s37 offen lds
s_mov_b64 exec, -1
s_add_u32 m0, s39, 46080
s_nop 0
buffer_load_dwordx4 v5, s[8:11], s37 offen lds
s_add_u32 m0, s39, 49152
s_nop 0
buffer_load_dwordx4 v6, s[8:11], s37 offen lds
s_add_u32 m0, s39, 52224
s_nop 0
buffer_load_dwordx4 v7, s[8:11], s37 offen lds
s_add_u32 m0, s39, 55296
s_nop 0
buffer_load_dwordx4 v8, s[8:11], s37 offen lds
s_add_u32 m0, s39, 58368
s_nop 0
buffer_load_dwordx4 v9, s[8:11], s37 offen lds
s_add_u32 m0, s40, 43008
s_add_u32 s43, s38, 0
buffer_load_dwordx4 v2, s[12:15], s43 offen lds
s_add_u32 m0, s40, 44032
s_add_u32 s43, s38, 49152
buffer_load_dwordx4 v3, s[12:15], s43 offen lds
s_add_u32 m0, s40, 45056
s_add_u32 s43, s38, 98304
buffer_load_dwordx4 v2, s[12:15], s43 offen lds
s_add_u32 m0, s40, 46080
s_add_u32 s43, s38, 147456
buffer_load_dwordx4 v3, s[12:15], s43 offen lds
s_add_u32 m0, s40, 47104
s_add_u32 s43, s38, 196608
buffer_load_dwordx4 v2, s[12:15], s43 offen lds
s_add_u32 m0, s40, 48128
s_add_u32 s43, s38, 245760
buffer_load_dwordx4 v3, s[12:15], s43 offen lds
s_add_u32 m0, s40, 49152
s_add_u32 s43, s38, 294912
buffer_load_dwordx4 v2, s[12:15], s43 offen lds
s_add_u32 m0, s40, 50176
s_add_u32 s43, s38, 344064
buffer_load_dwordx4 v3, s[12:15], s43 offen lds
s_add_u32 s37, s37, 128
s_add_u32 s38, s38, 393216
s_load_dword s3, s[4:5], 21504
s_load_dword s3, s[4:5], 21568
s_load_dword s3, s[4:5], 21632
s_load_dword s3, s[4:5], 21696
s_load_dword s3, s[4:5], 28672
s_load_dword s3, s[4:5], 28736
s_waitcnt vmcnt(14)
s_barrier
s_add_u32 m0, s39, 86016
s_mov_b64 exec, s[60:61]
buffer_load_dwordx4 v4, s[8:11], s37 offen lds
s_mov_b64 exec, -1
s_add_u32 m0, s39, 89088
s_nop 0
buffer_load_dwordx4 v5, s[8:11], s37 offen lds
s_add_u32 m0, s39, 92160
s_nop 0
buffer_load_dwordx4 v6, s[8:11], s37 offen lds
s_add_u32 m0, s39, 95232
s_nop 0
buffer_load_dwordx4 v7, s[8:11], s37 offen lds
s_add_u32 m0, s39, 98304
s_nop 0
buffer_load_dwordx4 v8, s[8:11], s37 offen lds
s_add_u32 m0, s39, 101376
s_nop 0
buffer_load_dwordx4 v9, s[8:11], s37 offen lds
s_add_u32 m0, s40, 86016
s_add_u32 s43, s38, 0
buffer_load_dwordx4 v2, s[12:15], s43 offen lds
s_add_u32 m0, s40, 87040
s_add_u32 s43, s38, 49152
buffer_load_dwordx4 v3, s[12:15], s43 offen lds
s_add_u32 m0, s40, 88064
s_add_u32 s43, s38, 98304
buffer_load_dwordx4 v2, s[12:15], s43 offen lds
s_add_u32 m0, s40, 89088
s_add_u32 s43, s38, 147456
buffer_load_dwordx4 v3, s[12:15], s43 offen lds
s_add_u32 m0, s40, 90112
s_add_u32 s43, s38, 196608
buffer_load_dwordx4 v2, s[12:15], s43 offen lds
s_add_u32 m0, s40, 91136
s_add_u32 s43, s38, 245760
buffer_load_dwordx4 v3, s[12:15], s43 offen lds
s_add_u32 m0, s40, 92160
s_add_u32 s43, s38, 294912
buffer_load_dwordx4 v2, s[12:15], s43 offen lds
s_add_u32 m0, s40, 93184
s_add_u32 s43, s38, 344064
buffer_load_dwordx4 v3, s[12:15], s43 offen lds
s_add_u32 s37, s37, 128
s_add_u32 s38, s38, 393216
s_load_dword s3, s[4:5], 28800
s_load_dword s3, s[4:5], 28864
s_load_dword s3, s[4:5], 35840
s_load_dword s3, s[4:5], 35904
s_load_dword s3, s[4:5], 35968
s_load_dword s3, s[4:5], 36032
s_load_dword s3, s[4:5], 43008
s_waitcnt vmcnt(14)
s_barrier
s_add_u32 m0, s39, 0
s_mov_b64 exec, s[60:61]
buffer_load_dwordx4 v4, s[8:11], s37 offen lds
s_mov_b64 exec, -1
s_add_u32 m0, s39, 3072
s_nop 0
buffer_load_dwordx4 v5, s[8:11], s37 offen lds
s_add_u32 m0, s39, 6144
s_nop 0
buffer_load_dwordx4 v6, s[8:11], s37 offen lds
s_add_u32 m0, s39, 9216
s_nop 0
buffer_load_dwordx4 v7, s[8:11], s37 offen lds
s_add_u32 m0, s39, 12288
s_nop 0
buffer_load_dwordx4 v8, s[8:11], s37 offen lds
s_add_u32 m0, s39, 15360
s_nop 0
buffer_load_dwordx4 v9, s[8:11], s37 offen lds
s_add_u32 m0, s40, 0
s_add_u32 s43, s38, 0
buffer_load_dwordx4 v2, s[12:15], s43 offen lds
s_add_u32 m0, s40, 1024
s_add_u32 s43, s38, 49152
buffer_load_dwordx4 v3, s[12:15], s43 offen lds
s_add_u32 m0, s40, 2048
s_add_u32 s43, s38, 98304
buffer_load_dwordx4 v2, s[12:15], s43 offen lds
s_add_u32 m0, s40, 3072
s_add_u32 s43, s38, 147456
buffer_load_dwordx4 v3, s[12:15], s43 offen lds
s_add_u32 m0, s40, 4096
s_add_u32 s43, s38, 196608
buffer_load_dwordx4 v2, s[12:15], s43 offen lds
s_add_u32 m0, s40, 5120
s_add_u32 s43, s38, 245760
buffer_load_dwordx4 v3, s[12:15], s43 offen lds
s_add_u32 m0, s40, 6144
s_add_u32 s43, s38, 294912
buffer_load_dwordx4 v2, s[12:15], s43 offen lds
s_add_u32 m0, s40, 7168
s_add_u32 s43, s38, 344064
buffer_load_dwordx4 v3, s[12:15], s43 offen lds
s_add_u32 s37, s37, 128
s_add_u32 s38, s38, 393216
s_load_dword s3, s[4:5], 43072
s_load_dword s3, s[4:5], 43136
s_load_dword s3, s[4:5], 43200
s_load_dword s3, s[4:5], 50176
s_load_dword s3, s[4:5], 50240
s_load_dword s3, s[4:5], 50304
s_load_dword s3, s[4:5], 50368
s_load_dword s3, s[4:5], 57344
s_waitcnt vmcnt(14)
s_barrier
s_add_u32 m0, s39, 43008
s_mov_b64 exec, s[60:61]
buffer_load_dwordx4 v4, s[8:11], s37 offen lds
s_mov_b64 exec, -1
s_add_u32 m0, s39, 46080
s_nop 0
buffer_load_dwordx4 v5, s[8:11], s37 offen lds
s_add_u32 m0, s39, 49152
s_nop 0
buffer_load_dwordx4 v6, s[8:11], s37 offen lds
s_add_u32 m0, s39, 52224
s_nop 0
buffer_load_dwordx4 v7, s[8:11], s37 offen lds
s_add_u32 m0, s39, 55296
s_nop 0
buffer_load_dwordx4 v8, s[8:11], s37 offen lds
s_add_u32 m0, s39, 58368
s_nop 0
buffer_load_dwordx4 v9, s[8:11], s37 offen lds
s_add_u32 m0, s40, 43008
s_add_u32 s43, s38, 0
buffer_load_dwordx4 v2, s[12:15], s43 offen lds
s_add_u32 m0, s40, 44032
s_add_u32 s43, s38, 49152
buffer_load_dwordx4 v3, s[12:15], s43 offen lds
s_add_u32 m0, s40, 45056
s_add_u32 s43, s38, 98304
buffer_load_dwordx4 v2, s[12:15], s43 offen lds
s_add_u32 m0, s40, 46080
s_add_u32 s43, s38, 147456
buffer_load_dwordx4 v3, s[12:15], s43 offen lds
s_add_u32 m0, s40, 47104
s_add_u32 s43, s38, 196608
buffer_load_dwordx4 v2, s[12:15], s43 offen lds
s_add_u32 m0, s40, 48128
s_add_u32 s43, s38, 245760
buffer_load_dwordx4 v3, s[12:15], s43 offen lds
s_add_u32 m0, s40, 49152
s_add_u32 s43, s38, 294912
buffer_load_dwordx4 v2, s[12:15], s43 offen lds
s_add_u32 m0, s40, 50176
s_add_u32 s43, s38, 344064
buffer_load_dwordx4 v3, s[12:15], s43 offen lds
s_add_u32 s37, s37, 128
s_add_u32 s38, s38, 393216
s_load_dword s3, s[4:5], 57408
s_load_dword s3, s[4:5], 57472
s_load_dword s3, s[4:5], 57536
s_load_dword s3, s[4:5], 64512
s_load_dword s3, s[4:5], 64576
s_load_dword s3, s[4:5], 64640
s_load_dword s3, s[4:5], 64704
s_load_dword s3, s[4:5], 71680
s_load_dword s3, s[4:5], 71744
s_waitcnt vmcnt(14)
s_barrier
s_add_u32 m0, s39, 86016
s_mov_b64 exec, s[60:61]
buffer_load_dwordx4 v4, s[8:11], s37 offen lds
s_mov_b64 exec, -1
s_add_u32 m0, s39, 89088
s_nop 0
buffer_load_dwordx4 v5, s[8:11], s37 offen lds
s_add_u32 m0, s39, 92160
s_nop 0
buffer_load_dwordx4 v6, s[8:11], s37 offen lds
s_add_u32 m0, s39, 95232
s_nop 0
buffer_load_dwordx4 v7, s[8:11], s37 offen lds
s_add_u32 m0, s39, 98304
s_nop 0
buffer_load_dwordx4 v8, s[8:11], s37 offen lds
s_add_u32 m0, s39, 101376
s_nop 0
buffer_load_dwordx4 v9, s[8:11], s37 offen lds
s_add_u32 m0, s40, 86016
s_add_u32 s43, s38, 0
buffer_load_dwordx4 v2, s[12:15], s43 offen lds
s_add_u32 m0, s40, 87040
s_add_u32 s43, s38, 49152
buffer_load_dwordx4 v3, s[12:15], s43 offen lds
s_add_u32 m0, s40, 88064
s_add_u32 s43, s38, 98304
buffer_load_dwordx4 v2, s[12:15], s43 offen lds
s_add_u32 m0, s40, 89088
s_add_u32 s43, s38, 147456
buffer_load_dwordx4 v3, s[12:15], s43 offen lds
s_add_u32 m0, s40, 90112
s_add_u32 s43, s38, 196608
buffer_load_dwordx4 v2, s[12:15], s43 offen lds
s_add_u32 m0, s40, 91136
s_add_u32 s43, s38, 245760
buffer_load_dwordx4 v3, s[12:15], s43 offen lds
s_add_u32 m0, s40, 92160
s_add_u32 s43, s38, 294912
buffer_load_dwordx4 v2, s[12:15], s43 offen lds
s_add_u32 m0, s40, 93184
s_add_u32 s43, s38, 344064
buffer_load_dwordx4 v3, s[12:15], s43 offen lds
s_add_u32 s37, s37, 128
s_add_u32 s38, s38, 393216
s_load_dword s3, s[4:5], 71808
s_load_dword s3, s[4:5], 71872
s_load_dword s3, s[4:5], 78848
s_load_dword s3, s[4:5], 78912
s_load_dword s3, s[4:5], 78976
s_load_dword s3, s[4:5], 79040
s_load_dword s3, s[4:5], 86016
s_load_dword s3, s[4:5], 86080
s_load_dword s3, s[4:5], 86144
s_waitcnt vmcnt(14)
s_barrier
s_add_u32 m0, s39, 0
s_mov_b64 exec, s[60:61]
buffer_load_dwordx4 v4, s[8:11], s37 offen lds
s_mov_b64 exec, -1
s_add_u32 m0, s39, 3072
s_nop 0
buffer_load_dwordx4 v5, s[8:11], s37 offen lds
s_add_u32 m0, s39, 6144
s_nop 0
buffer_load_dwordx4 v6, s[8:11], s37 offen lds
s_add_u32 m0, s39, 9216
s_nop 0
buffer_load_dwordx4 v7, s[8:11], s37 offen lds
s_add_u32 m0, s39, 12288
s_nop 0
buffer_load_dwordx4 v8, s[8:11], s37 offen lds
s_add_u32 m0, s39, 15360
s_nop 0
buffer_load_dwordx4 v9, s[8:11], s37 offen lds
s_add_u32 m0, s40, 0
s_add_u32 s43, s38, 0
buffer_load_dwordx4 v2, s[12:15], s43 offen lds
s_add_u32 m0, s40, 1024
s_add_u32 s43, s38, 49152
buffer_load_dwordx4 v3, s[12:15], s43 offen lds
s_add_u32 m0, s40, 2048
s_add_u32 s43, s38, 98304
buffer_load_dwordx4 v2, s[12:15], s43 offen lds
s_add_u32 m0, s40, 3072
s_add_u32 s43, s38, 147456
buffer_load_dwordx4 v3, s[12:15], s43 offen lds
s_add_u32 m0, s40, 4096
s_add_u32 s43, s38, 196608
buffer_load_dwordx4 v2, s[12:15], s43 offen lds
s_add_u32 m0, s40, 5120
s_add_u32 s43, s38, 245760
buffer_load_dwordx4 v3, s[12:15], s43 offen lds
s_add_u32 m0, s40, 6144
s_add_u32 s43, s38, 294912
buffer_load_dwordx4 v2, s[12:15], s43 offen lds
s_add_u32 m0, s40, 7168
s_add_u32 s43, s38, 344064
buffer_load_dwordx4 v3, s[12:15], s43 offen lds
s_add_u32 s37, s37, 128
s_add_u32 s38, s38, 393216
s_load_dword s3, s[4:5], 86208
s_load_dword s3, s[4:5], 93184
s_load_dword s3, s[4:5], 93248
s_load_dword s3, s[4:5], 93312
s_load_dword s3, s[4:5], 93376
s_load_dword s3, s[4:5], 100352
s_load_dword s3, s[4:5], 100416
s_load_dword s3, s[4:5], 100480
s_load_dword s3, s[4:5], 100544
s_waitcnt vmcnt(14)
s_barrier
s_add_u32 m0, s39, 43008
s_mov_b64 exec, s[60:61]
buffer_load_dwordx4 v4, s[8:11], s37 offen lds
s_mov_b64 exec, -1
s_add_u32 m0, s39, 46080
s_nop 0
buffer_load_dwordx4 v5, s[8:11], s37 offen lds
s_add_u32 m0, s39, 49152
s_nop 0
buffer_load_dwordx4 v6, s[8:11], s37 offen lds
s_add_u32 m0, s39, 52224
s_nop 0
buffer_load_dwordx4 v7, s[8:11], s37 offen lds
s_add_u32 m0, s39, 55296
s_nop 0
buffer_load_dwordx4 v8, s[8:11], s37 offen lds
s_add_u32 m0, s39, 58368
s_nop 0
buffer_load_dwordx4 v9, s[8:11], s37 offen lds
s_add_u32 m0, s40, 43008
s_add_u32 s43, s38, 0
buffer_load_dwordx4 v2, s[12:15], s43 offen lds
s_add_u32 m0, s40, 44032
s_add_u32 s43, s38, 49152
buffer_load_dwordx4 v3, s[12:15], s43 offen lds
s_add_u32 m0, s40, 45056
s_add_u32 s43, s38, 98304
buffer_load_dwordx4 v2, s[12:15], s43 offen lds
s_add_u32 m0, s40, 46080
s_add_u32 s43, s38, 147456
buffer_load_dwordx4 v3, s[12:15], s43 offen lds
s_add_u32 m0, s40, 47104
s_add_u32 s43, s38, 196608
buffer_load_dwordx4 v2, s[12:15], s43 offen lds
s_add_u32 m0, s40, 48128
s_add_u32 s43, s38, 245760
buffer_load_dwordx4 v3, s[12:15], s43 offen lds
s_add_u32 m0, s40, 49152
s_add_u32 s43, s38, 294912
buffer_load_dwordx4 v2, s[12:15], s43 offen lds
s_add_u32 m0, s40, 50176
s_add_u32 s43, s38, 344064
buffer_load_dwordx4 v3, s[12:15], s43 offen lds
s_add_u32 s37, s37, 128
s_add_u32 s38, s38, 393216
s_load_dword s3, s[4:5], 107520
s_load_dword s3, s[4:5], 107584
s_load_dword s3, s[4:5], 107648
s_load_dword s3, s[4:5], 107712
s_load_dword s3, s[4:5], 114688
s_load_dword s3, s[4:5], 114752
s_load_dword s3, s[4:5], 114816
s_load_dword s3, s[4:5], 114880
s_load_dword s3, s[4:5], 121856
s_waitcnt vmcnt(14)
s_barrier
s_add_u32 m0, s39, 86016
s_mov_b64 exec, s[60:61]
buffer_load_dwordx4 v4, s[8:11], s37 offen lds
s_mov_b64 exec, -1
s_add_u32 m0, s39, 89088
s_nop 0
buffer_load_dwordx4 v5, s[8:11], s37 offen lds
s_add_u32 m0, s39, 92160
s_nop 0
buffer_load_dwordx4 v6, s[8:11], s37 offen lds
s_add_u32 m0, s39, 95232
s_nop 0
buffer_load_dwordx4 v7, s[8:11], s37 offen lds
s_add_u32 m0, s39, 98304
s_nop 0
buffer_load_dwordx4 v8, s[8:11], s37 offen lds
s_add_u32 m0, s39, 101376
s_nop 0
buffer_load_dwordx4 v9, s[8:11], s37 offen lds
s_add_u32 m0, s40, 86016
s_add_u32 s43, s38, 0
buffer_load_dwordx4 v2, s[12:15], s43 offen lds
s_add_u32 m0, s40, 87040
s_add_u32 s43, s38, 49152
buffer_load_dwordx4 v3, s[12:15], s43 offen lds
s_add_u32 m0, s40, 88064
s_add_u32 s43, s38, 98304
buffer_load_dwordx4 v2, s[12:15], s43 offen lds
s_add_u32 m0, s40, 89088
s_add_u32 s43, s38, 147456
buffer_load_dwordx4 v3, s[12:15], s43 offen lds
s_add_u32 m0, s40, 90112
s_add_u32 s43, s38, 196608
buffer_load_dwordx4 v2, s[12:15], s43 offen lds
s_add_u32 m0, s40, 91136
s_add_u32 s43, s38, 245760
buffer_load_dwordx4 v3, s[12:15], s43 offen lds
s_add_u32 m0, s40, 92160
s_add_u32 s43, s38, 294912
buffer_load_dwordx4 v2, s[12:15], s43 offen lds
s_add_u32 m0, s40, 93184
s_add_u32 s43, s38, 344064
buffer_load_dwordx4 v3, s[12:15], s43 offen lds
s_add_u32 s37, s37, 128
s_add_u32 s38, s38, 393216
s_load_dword s3, s[4:5], 121920
s_load_dword s3, s[4:5], 121984
s_load_dword s3, s[4:5], 122048
s_load_dword s3, s[4:5], 129024
s_load_dword s3, s[4:5], 129088
s_load_dword s3, s[4:5], 129152
s_load_dword s3, s[4:5], 129216
s_load_dword s3, s[4:5], 136192
s_load_dword s3, s[4:5], 136256
s_waitcnt vmcnt(14)
s_barrier
s_add_u32 m0, s39, 0
s_mov_b64 exec, s[60:61]
buffer_load_dwordx4 v4, s[8:11], s37 offen lds
s_mov_b64 exec, -1
s_add_u32 m0, s39, 3072
s_nop 0
buffer_load_dwordx4 v5, s[8:11], s37 offen lds
s_add_u32 m0, s39, 6144
s_nop 0
buffer_load_dwordx4 v6, s[8:11], s37 offen lds
s_add_u32 m0, s39, 9216
s_nop 0
buffer_load_dwordx4 v7, s[8:11], s37 offen lds
s_add_u32 m0, s39, 12288
s_nop 0
buffer_load_dwordx4 v8, s[8:11], s37 offen lds
s_add_u32 m0, s39, 15360
s_nop 0
buffer_load_dwordx4 v9, s[8:11], s37 offen lds
s_add_u32 m0, s40, 0
s_add_u32 s43, s38, 0
buffer_load_dwordx4 v2, s[12:15], s43 offen lds
s_add_u32 m0, s40, 1024
s_add_u32 s43, s38, 49152
buffer_load_dwordx4 v3, s[12:15], s43 offen lds
s_add_u32 m0, s40, 2048
s_add_u32 s43, s38, 98304
buffer_load_dwordx4 v2, s[12:15], s43 offen lds
s_add_u32 m0, s40, 3072
s_add_u32 s43, s38, 147456
buffer_load_dwordx4 v3, s[12:15], s43 offen lds
s_add_u32 m0, s40, 4096
s_add_u32 s43, s38, 196608
buffer_load_dwordx4 v2, s[12:15], s43 offen lds
s_add_u32 m0, s40, 5120
s_add_u32 s43, s38, 245760
buffer_load_dwordx4 v3, s[12:15], s43 offen lds
s_add_u32 m0, s40, 6144
s_add_u32 s43, s38, 294912
buffer_load_dwordx4 v2, s[12:15], s43 offen lds
s_add_u32 m0, s40, 7168
s_add_u32 s43, s38, 344064
buffer_load_dwordx4 v3, s[12:15], s43 offen lds
s_add_u32 s37, s37, 128
s_add_u32 s38, s38, 393216
s_load_dword s3, s[4:5], 136320
s_load_dword s3, s[4:5], 136384
s_load_dword s3, s[4:5], 143360
s_load_dword s3, s[4:5], 143424
s_load_dword s3, s[4:5], 143488
s_load_dword s3, s[4:5], 143552
s_load_dword s3, s[4:5], 150528
s_load_dword s3, s[4:5], 150592
s_load_dword s3, s[4:5], 150656
s_waitcnt vmcnt(14)
s_barrier
s_load_dword s3, s[4:5], 150720
s_load_dword s3, s[4:5], 157696
s_load_dword s3, s[4:5], 157760
s_load_dword s3, s[4:5], 157824
s_load_dword s3, s[4:5], 157888
s_load_dword s3, s[4:5], 164864
s_load_dword s3, s[4:5], 164928
s_load_dword s3, s[4:5], 164992
s_load_dword s3, s[4:5], 165056
s_waitcnt vmcnt(0)
s_barrier
s_bitcmp0_b32 s2, 0
s_cselect_b32 s88, s72, s74
s_cselect_b32 s89, s73, s75
s_cmp_lt_u32 s2, 192
s_cselect_b32 s90, 7340032, 0
s_mov_b32 s91, 0x20000
s_bfe_u32 s44, s2, 0x30001
s_lshl_b32 s44, s44, 2
s_and_b32 s43, s36, 3
s_add_u32 s44, s44, s43
s_lshl_b32 s44, s44, 5
v_lshrrev_b32 v18, 4, v1
v_add_u32 v18, s44, v18
v_mul_u32_u24 v18, 7168, v18
v_and_b32 v19, 15, v1
v_lshl_add_u32 v18, v19, 4, v18
s_lshr_b32 s43, s2, 4
s_lshl_b32 s43, s43, 8
s_add_u32 s43, s43, 4096
s_branch Lov_1
.p2align 12
Lst_1_0:
s_branch Lwr_145
s_nop 0
s_nop 0
Lov_1:
v_add_u32 v18, s43, v18
s_mov_b32 s43, 0
buffer_load_dwordx4 v[128:131], v18, s[88:91], s43 offen
s_mov_b32 s43, 28672
buffer_load_dwordx4 v[132:135], v18, s[88:91], s43 offen
s_mov_b32 s43, 57344
buffer_load_dwordx4 v[136:139], v18, s[88:91], s43 offen
s_mov_b32 s43, 86016
buffer_load_dwordx4 v[140:143], v18, s[88:91], s43 offen
s_mov_b32 s43, 114688
buffer_load_dwordx4 v[144:147], v18, s[88:91], s43 offen
s_mov_b32 s43, 143360
buffer_load_dwordx4 v[148:151], v18, s[88:91], s43 offen
s_mov_b32 s43, 172032
buffer_load_dwordx4 v[152:155], v18, s[88:91], s43 offen
s_mov_b32 s43, 200704
buffer_load_dwordx4 v[156:159], v18, s[88:91], s43 offen
s_barrier
s_lshl_b32 s43, s35, 7
s_add_u32 s28, s68, s43
s_addc_u32 s29, s69, 0
s_mov_b32 s30, 2095232
s_mov_b32 s31, 0x20000
v_lshrrev_b32 v15, 3, v1
v_and_b32 v16, 6, v15
v_and_b32 v7, 7, v1
v_xor_b32 v7, v7, v16
v_lshlrev_b32 v7, 4, v7
v_mul_u32_u24 v15, 2048, v15
v_add_u32 v7, v7, v15
s_and_b32 s40, s36, 3
s_lshl_b32 s39, s40, 13
s_add_u32 s40, s40, s35
s_add_u32 s42, s40, 0
s_and_b32 s42, s42, 15
s_lshl_b32 s42, s42, 17
s_add_u32 m0, s39, 65536
s_add_u32 s43, s42, 0
buffer_load_dwordx4 v7, s[28:31], s43 offen lds
s_add_u32 m0, s39, 66560
s_add_u32 s43, s42, 16384
buffer_load_dwordx4 v7, s[28:31], s43 offen lds
s_add_u32 m0, s39, 67584
s_add_u32 s43, s42, 32768
buffer_load_dwordx4 v7, s[28:31], s43 offen lds
s_add_u32 m0, s39, 68608
s_add_u32 s43, s42, 49152
buffer_load_dwordx4 v7, s[28:31], s43 offen lds
s_add_u32 m0, s39, 69632
s_add_u32 s43, s42, 65536
buffer_load_dwordx4 v7, s[28:31], s43 offen lds
s_add_u32 m0, s39, 70656
s_add_u32 s43, s42, 81920
buffer_load_dwordx4 v7, s[28:31], s43 offen lds
s_add_u32 m0, s39, 71680
s_add_u32 s43, s42, 98304
buffer_load_dwordx4 v7, s[28:31], s43 offen lds
s_add_u32 m0, s39, 72704
s_add_u32 s43, s42, 114688
buffer_load_dwordx4 v7, s[28:31], s43 offen lds
s_branch Lats_6
Lcons_7:
s_lshl_b32 s43, s35, 7
s_waitcnt lgkmcnt(0)
s_mov_b32 s8, s64
s_mov_b32 s9, s65
s_mov_b32 s10, 4194304
s_mov_b32 s11, 0x20000
s_add_u32 s12, s66, s43
s_addc_u32 s13, s67, 0
s_mov_b32 s14, 6289536
s_mov_b32 s15, 0x20000
s_lshr_b32 s43, s2, 3
s_lshl_b32 s43, s43, 2
s_add_u32 s43, s43, s36
s_sub_u32 s44, s43, 0
s_and_b32 s44, s44, 127
s_cmp_lt_u32 s44, 24
s_cbranch_scc0 Lt_8
s_lshl_b32 s44, s44, 20
s_min_u32 s44, s44, 24117184
s_load_dword s3, s[82:83], s44 glc
Lt_8:
s_sub_u32 s44, s43, 24
s_and_b32 s44, s44, 127
s_cmp_lt_u32 s44, 8
s_cbranch_scc0 Lt_9
s_lshl_b32 s44, s44, 20
s_min_u32 s44, s44, 7339968
s_load_dword s3, s[72:73], s44
Lt_9:
s_sub_u32 s44, s43, 32
s_and_b32 s44, s44, 127
s_cmp_lt_u32 s44, 8
s_cbranch_scc0 Lt_10
s_lshl_b32 s44, s44, 20
s_min_u32 s44, s44, 7339968
s_load_dword s3, s[74:75], s44
Lt_10:
s_sub_u32 s44, s43, 40
s_and_b32 s44, s44, 127
s_cmp_lt_u32 s44, 3
s_cbranch_scc0 Lt_11
s_lshl_b32 s44, s44, 20
s_min_u32 s44, s44, 2097088
s_load_dword s3, s[68:69], s44
Lt_11:
s_sub_u32 s44, s43, 43
s_and_b32 s44, s44, 127
s_cmp_lt_u32 s44, 5
s_cbranch_scc0 Lt_12
s_lshl_b32 s44, s44, 20
s_min_u32 s44, s44, 4194240
s_add_u32 s44, s44, 25165824
s_load_dword s3, s[82:83], s44 glc
Lt_12:
s_sub_u32 s44, s43, 48
s_and_b32 s44, s44, 127
s_cmp_lt_u32 s44, 8
s_cbranch_scc0 Lt_13
s_lshl_b32 s44, s44, 20
s_min_u32 s44, s44, 7339968
s_load_dword s3, s[76:77], s44
Lt_13:
s_sub_u32 s44, s43, 56
s_and_b32 s44, s44, 127
s_cmp_lt_u32 s44, 5
s_cbranch_scc0 Lt_14
s_lshl_b32 s44, s44, 20
s_min_u32 s44, s44, 4194240
s_add_u32 s44, s44, 33554432
s_load_dword s3, s[82:83], s44 glc
Lt_14:
s_sub_u32 s44, s43, 61
s_and_b32 s44, s44, 127
s_cmp_lt_u32 s44, 5
s_cbranch_scc0 Lt_15
s_lshl_b32 s44, s44, 20
s_min_u32 s44, s44, 4194240
s_load_dword s3, s[78:79], s44 glc
Lt_15:
v_lshrrev_b32 v16, 1, v12
v_xor_b32 v15, v13, v16
v_lshlrev_b32 v15, 4, v15
v_lshl_add_u32 v2, v12, 7, v15
v_xor_b32 v3, 64, v2
v_add_u32 v4, 86016, v2
v_add_u32 v5, 86016, v3
v_lshrrev_b32 v15, 2, v12
v_and_b32 v16, 3, v1
v_lshl_add_u32 v19, v13, 3, v15
v_lshlrev_b32 v19, 7, v19
v_and_b32 v15, 2, v15
v_and_b32 v17, 1, v13
v_lshl_add_u32 v15, v17, 2, v15
v_lshrrev_b32 v17, 1, v16
s_lshl_b32 s43, s36, 1
v_add_u32 v17, s43, v17
v_xor_b32 v15, v15, v17
v_lshl_add_u32 v19, v15, 4, v19
v_and_b32 v16, 1, v16
v_lshl_add_u32 v19, v16, 3, v19
v_add_u32 v6, 18432, v19
v_add_u32 v7, 61440, v19
v_add_u32 v8, 104448, v19
s_and_b32 s43, s36, 1
s_bfe_u32 s44, s36, 0x10001
s_lshr_b32 s45, s36, 2
v_lshlrev_b32 v14, 2, v13
v_sub_u32 v14, v12, v14
v_mov_b32 v16, 0xff800000
s_or_b32 s46, s34, s45
s_cmp_lg_u32 s46, 0
s_cselect_b32 s46, 0, 0xff800000
v_subrev_u32 v15, 0, v14
v_cmp_ge_u32 vcc, 7, v15
v_add_u32 v15, 16, v15
s_nop 0
v_cndmask_b32 v248, v16, 0, vcc
v_cmp_ge_u32 vcc, 7, v15
s_nop 1
v_cndmask_b32 v244, v16, 0, vcc
v_or_b32 v240, s46, v244
v_subrev_u32 v15, 1, v14
v_cmp_ge_u32 vcc, 7, v15
v_add_u32 v15, 16, v15
s_nop 0
v_cndmask_b32 v249, v16, 0, vcc
v_cmp_ge_u32 vcc, 7, v15
s_nop 1
v_cndmask_b32 v245, v16, 0, vcc
v_or_b32 v241, s46, v245
v_subrev_u32 v15, 2, v14
v_cmp_ge_u32 vcc, 7, v15
v_add_u32 v15, 16, v15
s_nop 0
v_cndmask_b32 v250, v16, 0, vcc
v_cmp_ge_u32 vcc, 7, v15
s_nop 1
v_cndmask_b32 v246, v16, 0, vcc
v_or_b32 v242, s46, v246
v_subrev_u32 v15, 3, v14
v_cmp_ge_u32 vcc, 7, v15
v_add_u32 v15, 16, v15
s_nop 0
v_cndmask_b32 v251, v16, 0, vcc
v_cmp_ge_u32 vcc, 7, v15
s_nop 1
v_cndmask_b32 v247, v16, 0, vcc
v_or_b32 v243, s46, v247
s_lshl_b32 s46, s45, 6
s_add_u32 s46, s46, s44
s_add_u32 s46, s46, 16
v_lshl_add_u32 v14, v12, 1, s46
s_lshl_b32 s47, s43, 6
v_lshl_add_u32 v15, v13, 4, s47
v_mul_u32_u24 v20, 400, v14
v_add_u32 v20, v20, v15
v_subrev_u32 v16, 32, v14
v_max_i32 v16, 0, v16
v_mul_u32_u24 v21, 400, v16
v_add_u32 v21, v21, v15
v_lshrrev_b32 v16, 2, v12
v_lshl_add_u32 v16, v13, 2, v16
v_lshl_add_u32 v16, v16, 1, s46
v_and_b32 v17, 3, v1
v_lshl_add_u32 v17, v17, 3, s47
v_mul_u32_u24 v22, 400, v16
v_add_u32 v22, v22, v17
v_subrev_u32 v16, 32, v16
v_max_i32 v16, 0, v16
v_mul_u32_u24 v23, 400, v16
v_add_u32 v23, v23, v17
s_mul_i32 s60, s34, 262144
s_add_u32 s16, s82, s60
s_addc_u32 s17, s83, 0
s_mov_b32 s18, 262144
s_mov_b32 s19, 0x20000
s_lshl_b32 s60, s35, 14
s_lshl_b32 s43, s43, 13
s_add_u32 s60, s60, s43
s_lshl_b32 s43, s45, 12
s_add_u32 s60, s60, s43
s_lshl_b32 s43, s44, 10
s_add_u32 s60, s60, s43
v_lshlrev_b32 v24, 4, v1
s_mov_b32 s61, 0x3e8293ee
s_lshl_b32 s38, s35, 7
s_add_u32 s56, s82, 28311552
s_addc_u32 s57, s83, 0
s_mov_b32 s58, 114688
s_mov_b32 s59, 0x20000
s_barrier
ds_read_b128 v[32:35], v2 offset:0
ds_read_b64_tr_b16 v[72:73], v6 offset:8192
ds_read_b64_tr_b16 v[74:75], v6 offset:8704
ds_read_b64_tr_b16 v[76:77], v6 offset:16384
ds_read_b64_tr_b16 v[78:79], v6 offset:16896
ds_read_b64_tr_b16 v[68:69], v6 offset:0
ds_read_b64_tr_b16 v[70:71], v6 offset:512
ds_read_b128 v[36:39], v2 offset:2048
ds_read_b128 v[40:43], v2 offset:4096
ds_read_b128 v[44:47], v2 offset:6144
ds_read_b128 v[48:51], v2 offset:8192
ds_read_b128 v[52:55], v2 offset:10240
ds_read_b128 v[56:59], v2 offset:12288
ds_read_b128 v[60:63], v2 offset:14336
ds_read_b128 v[64:67], v2 offset:16384
s_waitcnt lgkmcnt(0)
v_mfma_f32_16x16x32_bf16 v[164:167], v[72:75], v[32:35], 0
ds_read_b128 v[80:83], v3 offset:0
v_mfma_f32_16x16x32_bf16 v[200:203], v[76:79], v[32:35], 0
ds_read_b64_tr_b16 v[120:121], v6 offset:12288
v_mfma_f32_16x16x32_bf16 v[128:131], v[68:71], v[32:35], 0
ds_read_b64_tr_b16 v[122:123], v6 offset:12800
v_mfma_f32_16x16x32_bf16 v[132:135], v[68:71], v[36:39], 0
ds_read_b64_tr_b16 v[124:125], v6 offset:20480
v_mfma_f32_16x16x32_bf16 v[204:207], v[76:79], v[36:39], 0
ds_read_b64_tr_b16 v[126:127], v6 offset:20992
v_mfma_f32_16x16x32_bf16 v[168:171], v[72:75], v[36:39], 0
ds_read_b64_tr_b16 v[116:117], v6 offset:4096
v_mfma_f32_16x16x32_bf16 v[172:175], v[72:75], v[40:43], 0
ds_read_b64_tr_b16 v[118:119], v6 offset:4608
v_mfma_f32_16x16x32_bf16 v[208:211], v[76:79], v[40:43], 0
ds_read_b128 v[84:87], v3 offset:2048
v_mfma_f32_16x16x32_bf16 v[136:139], v[68:71], v[40:43], 0
ds_read_b128 v[88:91], v3 offset:4096
v_mfma_f32_16x16x32_bf16 v[140:143], v[68:71], v[44:47], 0
ds_read_b128 v[92:95], v3 offset:6144
v_mfma_f32_16x16x32_bf16 v[212:215], v[76:79], v[44:47], 0
ds_read_b128 v[96:99], v3 offset:8192
v_mfma_f32_16x16x32_bf16 v[176:179], v[72:75], v[44:47], 0
ds_read_b128 v[100:103], v3 offset:10240
v_mfma_f32_16x16x32_bf16 v[180:183], v[72:75], v[48:51], 0
ds_read_b128 v[104:107], v3 offset:12288
v_mfma_f32_16x16x32_bf16 v[216:219], v[76:79], v[48:51], 0
ds_read_b128 v[108:111], v3 offset:14336
v_mfma_f32_16x16x32_bf16 v[144:147], v[68:71], v[48:51], 0
ds_read_b128 v[112:115], v3 offset:16384
v_mfma_f32_16x16x32_bf16 v[148:151], v[68:71], v[52:55], 0
v_mfma_f32_16x16x32_bf16 v[220:223], v[76:79], v[52:55], 0
v_mfma_f32_16x16x32_bf16 v[184:187], v[72:75], v[52:55], 0
v_mfma_f32_16x16x32_bf16 v[188:191], v[72:75], v[56:59], 0
v_mfma_f32_16x16x32_bf16 v[224:227], v[76:79], v[56:59], 0
v_mfma_f32_16x16x32_bf16 v[152:155], v[68:71], v[56:59], 0
v_mfma_f32_16x16x32_bf16 v[156:159], v[68:71], v[60:63], 0
v_mfma_f32_16x16x32_bf16 v[228:231], v[76:79], v[60:63], 0
v_mfma_f32_16x16x32_bf16 v[192:195], v[72:75], v[60:63], 0
v_mfma_f32_16x16x32_bf16 v[196:199], v[72:75], v[64:67], 0
v_mfma_f32_16x16x32_bf16 v[232:235], v[76:79], v[64:67], 0
v_mfma_f32_16x16x32_bf16 v[160:163], v[68:71], v[64:67], 0
s_waitcnt lgkmcnt(0)
s_barrier
v_mfma_f32_16x16x32_bf16 v[164:167], v[120:123], v[80:83], v[164:167]
ds_read_b128 v[32:35], v2 offset:43008
v_mfma_f32_16x16x32_bf16 v[200:203], v[124:127], v[80:83], v[200:203]
ds_read_b64_tr_b16 v[72:73], v7 offset:8192
v_mfma_f32_16x16x32_bf16 v[128:131], v[116:119], v[80:83], v[128:131]
ds_read_b64_tr_b16 v[74:75], v7 offset:8704
v_mfma_f32_16x16x32_bf16 v[132:135], v[116:119], v[84:87], v[132:135]
ds_read_b64_tr_b16 v[76:77], v7 offset:16384
v_mfma_f32_16x16x32_bf16 v[204:207], v[124:127], v[84:87], v[204:207]
ds_read_b64_tr_b16 v[78:79], v7 offset:16896
v_mfma_f32_16x16x32_bf16 v[168:171], v[120:123], v[84:87], v[168:171]
ds_read_b64_tr_b16 v[68:69], v7 offset:0
v_mfma_f32_16x16x32_bf16 v[172:175], v[120:123], v[88:91], v[172:175]
ds_read_b64_tr_b16 v[70:71], v7 offset:512
v_mfma_f32_16x16x32_bf16 v[208:211], v[124:127], v[88:91], v[208:211]
ds_read_b128 v[36:39], v2 offset:45056
v_mfma_f32_16x16x32_bf16 v[136:139], v[116:119], v[88:91], v[136:139]
ds_read_b128 v[40:43], v2 offset:47104
v_mfma_f32_16x16x32_bf16 v[140:143], v[116:119], v[92:95], v[140:143]
ds_read_b128 v[44:47], v2 offset:49152
v_mfma_f32_16x16x32_bf16 v[212:215], v[124:127], v[92:95], v[212:215]
ds_read_b128 v[48:51], v2 offset:51200
v_mfma_f32_16x16x32_bf16 v[176:179], v[120:123], v[92:95], v[176:179]
ds_read_b128 v[52:55], v2 offset:53248
v_mfma_f32_16x16x32_bf16 v[180:183], v[120:123], v[96:99], v[180:183]
ds_read_b128 v[56:59], v2 offset:55296
v_mfma_f32_16x16x32_bf16 v[216:219], v[124:127], v[96:99], v[216:219]
ds_read_b128 v[60:63], v2 offset:57344
v_mfma_f32_16x16x32_bf16 v[144:147], v[116:119], v[96:99], v[144:147]
ds_read_b128 v[64:67], v2 offset:59392
v_mfma_f32_16x16x32_bf16 v[148:151], v[116:119], v[100:103], v[148:151]
v_mfma_f32_16x16x32_bf16 v[220:223], v[124:127], v[100:103], v[220:223]
v_mfma_f32_16x16x32_bf16 v[184:187], v[120:123], v[100:103], v[184:187]
v_mfma_f32_16x16x32_bf16 v[188:191], v[120:123], v[104:107], v[188:191]
v_mfma_f32_16x16x32_bf16 v[224:227], v[124:127], v[104:107], v[224:227]
v_mfma_f32_16x16x32_bf16 v[152:155], v[116:119], v[104:107], v[152:155]
v_mfma_f32_16x16x32_bf16 v[156:159], v[116:119], v[108:111], v[156:159]
v_mfma_f32_16x16x32_bf16 v[228:231], v[124:127], v[108:111], v[228:231]
v_mfma_f32_16x16x32_bf16 v[192:195], v[120:123], v[108:111], v[192:195]
v_mfma_f32_16x16x32_bf16 v[196:199], v[120:123], v[112:115], v[196:199]
v_mfma_f32_16x16x32_bf16 v[232:235], v[124:127], v[112:115], v[232:235]
v_mfma_f32_16x16x32_bf16 v[160:163], v[116:119], v[112:115], v[160:163]
s_waitcnt lgkmcnt(0)
v_mfma_f32_16x16x32_bf16 v[164:167], v[72:75], v[32:35], v[164:167]
ds_read_b128 v[80:83], v3 offset:43008
v_mfma_f32_16x16x32_bf16 v[200:203], v[76:79], v[32:35], v[200:203]
ds_read_b64_tr_b16 v[120:121], v7 offset:12288
v_mfma_f32_16x16x32_bf16 v[128:131], v[68:71], v[32:35], v[128:131]
ds_read_b64_tr_b16 v[122:123], v7 offset:12800
v_mfma_f32_16x16x32_bf16 v[132:135], v[68:71], v[36:39], v[132:135]
ds_read_b64_tr_b16 v[124:125], v7 offset:20480
v_mfma_f32_16x16x32_bf16 v[204:207], v[76:79], v[36:39], v[204:207]
ds_read_b64_tr_b16 v[126:127], v7 offset:20992
v_mfma_f32_16x16x32_bf16 v[168:171], v[72:75], v[36:39], v[168:171]
ds_read_b64_tr_b16 v[116:117], v7 offset:4096
v_mfma_f32_16x16x32_bf16 v[172:175], v[72:75], v[40:43], v[172:175]
ds_read_b64_tr_b16 v[118:119], v7 offset:4608
v_mfma_f32_16x16x32_bf16 v[208:211], v[76:79], v[40:43], v[208:211]
ds_read_b128 v[84:87], v3 offset:45056
v_mfma_f32_16x16x32_bf16 v[136:139], v[68:71], v[40:43], v[136:139]
ds_read_b128 v[88:91], v3 offset:47104
v_mfma_f32_16x16x32_bf16 v[140:143], v[68:71], v[44:47], v[140:143]
ds_read_b128 v[92:95], v3 offset:49152
v_mfma_f32_16x16x32_bf16 v[212:215], v[76:79], v[44:47], v[212:215]
ds_read_b128 v[96:99], v3 offset:51200
v_mfma_f32_16x16x32_bf16 v[176:179], v[72:75], v[44:47], v[176:179]
ds_read_b128 v[100:103], v3 offset:53248
v_mfma_f32_16x16x32_bf16 v[180:183], v[72:75], v[48:51], v[180:183]
ds_read_b128 v[104:107], v3 offset:55296
v_mfma_f32_16x16x32_bf16 v[216:219], v[76:79], v[48:51], v[216:219]
ds_read_b128 v[108:111], v3 offset:57344
v_mfma_f32_16x16x32_bf16 v[144:147], v[68:71], v[48:51], v[144:147]
ds_read_b128 v[112:115], v3 offset:59392
v_mfma_f32_16x16x32_bf16 v[148:151], v[68:71], v[52:55], v[148:151]
v_mfma_f32_16x16x32_bf16 v[220:223], v[76:79], v[52:55], v[220:223]
v_mfma_f32_16x16x32_bf16 v[184:187], v[72:75], v[52:55], v[184:187]
v_mfma_f32_16x16x32_bf16 v[188:191], v[72:75], v[56:59], v[188:191]
v_mfma_f32_16x16x32_bf16 v[224:227], v[76:79], v[56:59], v[224:227]
v_mfma_f32_16x16x32_bf16 v[152:155], v[68:71], v[56:59], v[152:155]
v_mfma_f32_16x16x32_bf16 v[156:159], v[68:71], v[60:63], v[156:159]
v_mfma_f32_16x16x32_bf16 v[228:231], v[76:79], v[60:63], v[228:231]
v_mfma_f32_16x16x32_bf16 v[192:195], v[72:75], v[60:63], v[192:195]
v_mfma_f32_16x16x32_bf16 v[196:199], v[72:75], v[64:67], v[196:199]
v_mfma_f32_16x16x32_bf16 v[232:235], v[76:79], v[64:67], v[232:235]
v_mfma_f32_16x16x32_bf16 v[160:163], v[68:71], v[64:67], v[160:163]
s_waitcnt lgkmcnt(0)
s_barrier
v_mfma_f32_16x16x32_bf16 v[164:167], v[120:123], v[80:83], v[164:167]
ds_read_b128 v[32:35], v4 offset:0
v_mfma_f32_16x16x32_bf16 v[200:203], v[124:127], v[80:83], v[200:203]
ds_read_b64_tr_b16 v[72:73], v8 offset:8192
v_mfma_f32_16x16x32_bf16 v[128:131], v[116:119], v[80:83], v[128:131]
ds_read_b64_tr_b16 v[74:75], v8 offset:8704
v_mfma_f32_16x16x32_bf16 v[132:135], v[116:119], v[84:87], v[132:135]
ds_read_b64_tr_b16 v[76:77], v8 offset:16384
v_mfma_f32_16x16x32_bf16 v[204:207], v[124:127], v[84:87], v[204:207]
ds_read_b64_tr_b16 v[78:79], v8 offset:16896
v_mfma_f32_16x16x32_bf16 v[168:171], v[120:123], v[84:87], v[168:171]
ds_read_b64_tr_b16 v[68:69], v8 offset:0
v_mfma_f32_16x16x32_bf16 v[172:175], v[120:123], v[88:91], v[172:175]
ds_read_b64_tr_b16 v[70:71], v8 offset:512
v_mfma_f32_16x16x32_bf16 v[208:211], v[124:127], v[88:91], v[208:211]
ds_read_b128 v[36:39], v4 offset:2048
v_mfma_f32_16x16x32_bf16 v[136:139], v[116:119], v[88:91], v[136:139]
ds_read_b128 v[40:43], v4 offset:4096
v_mfma_f32_16x16x32_bf16 v[140:143], v[116:119], v[92:95], v[140:143]
ds_read_b128 v[44:47], v4 offset:6144
v_mfma_f32_16x16x32_bf16 v[212:215], v[124:127], v[92:95], v[212:215]
ds_read_b128 v[48:51], v4 offset:8192
v_mfma_f32_16x16x32_bf16 v[176:179], v[120:123], v[92:95], v[176:179]
ds_read_b128 v[52:55], v4 offset:10240
v_mfma_f32_16x16x32_bf16 v[180:183], v[120:123], v[96:99], v[180:183]
ds_read_b128 v[56:59], v4 offset:12288
v_mfma_f32_16x16x32_bf16 v[216:219], v[124:127], v[96:99], v[216:219]
ds_read_b128 v[60:63], v4 offset:14336
v_mfma_f32_16x16x32_bf16 v[144:147], v[116:119], v[96:99], v[144:147]
ds_read_b128 v[64:67], v4 offset:16384
v_mfma_f32_16x16x32_bf16 v[148:151], v[116:119], v[100:103], v[148:151]
v_mfma_f32_16x16x32_bf16 v[220:223], v[124:127], v[100:103], v[220:223]
v_mfma_f32_16x16x32_bf16 v[184:187], v[120:123], v[100:103], v[184:187]
v_mfma_f32_16x16x32_bf16 v[188:191], v[120:123], v[104:107], v[188:191]
v_mfma_f32_16x16x32_bf16 v[224:227], v[124:127], v[104:107], v[224:227]
v_mfma_f32_16x16x32_bf16 v[152:155], v[116:119], v[104:107], v[152:155]
v_mfma_f32_16x16x32_bf16 v[156:159], v[116:119], v[108:111], v[156:159]
v_mfma_f32_16x16x32_bf16 v[228:231], v[124:127], v[108:111], v[228:231]
v_mfma_f32_16x16x32_bf16 v[192:195], v[120:123], v[108:111], v[192:195]
v_mfma_f32_16x16x32_bf16 v[196:199], v[120:123], v[112:115], v[196:199]
v_mfma_f32_16x16x32_bf16 v[232:235], v[124:127], v[112:115], v[232:235]
v_mfma_f32_16x16x32_bf16 v[160:163], v[116:119], v[112:115], v[160:163]
s_waitcnt lgkmcnt(0)
v_mfma_f32_16x16x32_bf16 v[164:167], v[72:75], v[32:35], v[164:167]
ds_read_b128 v[80:83], v5 offset:0
v_mfma_f32_16x16x32_bf16 v[200:203], v[76:79], v[32:35], v[200:203]
ds_read_b64_tr_b16 v[120:121], v8 offset:12288
v_mfma_f32_16x16x32_bf16 v[128:131], v[68:71], v[32:35], v[128:131]
ds_read_b64_tr_b16 v[122:123], v8 offset:12800
v_mfma_f32_16x16x32_bf16 v[132:135], v[68:71], v[36:39], v[132:135]
ds_read_b64_tr_b16 v[124:125], v8 offset:20480
v_mfma_f32_16x16x32_bf16 v[204:207], v[76:79], v[36:39], v[204:207]
ds_read_b64_tr_b16 v[126:127], v8 offset:20992
v_mfma_f32_16x16x32_bf16 v[168:171], v[72:75], v[36:39], v[168:171]
ds_read_b64_tr_b16 v[116:117], v8 offset:4096
v_mfma_f32_16x16x32_bf16 v[172:175], v[72:75], v[40:43], v[172:175]
ds_read_b64_tr_b16 v[118:119], v8 offset:4608
v_mfma_f32_16x16x32_bf16 v[208:211], v[76:79], v[40:43], v[208:211]
ds_read_b128 v[84:87], v5 offset:2048
v_mfma_f32_16x16x32_bf16 v[136:139], v[68:71], v[40:43], v[136:139]
ds_read_b128 v[88:91], v5 offset:4096
v_mfma_f32_16x16x32_bf16 v[140:143], v[68:71], v[44:47], v[140:143]
ds_read_b128 v[92:95], v5 offset:6144
v_mfma_f32_16x16x32_bf16 v[212:215], v[76:79], v[44:47], v[212:215]
ds_read_b128 v[96:99], v5 offset:8192
v_mfma_f32_16x16x32_bf16 v[176:179], v[72:75], v[44:47], v[176:179]
ds_read_b128 v[100:103], v5 offset:10240
v_mfma_f32_16x16x32_bf16 v[180:183], v[72:75], v[48:51], v[180:183]
ds_read_b128 v[104:107], v5 offset:12288
v_mfma_f32_16x16x32_bf16 v[216:219], v[76:79], v[48:51], v[216:219]
ds_read_b128 v[108:111], v5 offset:14336
v_mfma_f32_16x16x32_bf16 v[144:147], v[68:71], v[48:51], v[144:147]
ds_read_b128 v[112:115], v5 offset:16384
v_mfma_f32_16x16x32_bf16 v[148:151], v[68:71], v[52:55], v[148:151]
v_mfma_f32_16x16x32_bf16 v[220:223], v[76:79], v[52:55], v[220:223]
v_mfma_f32_16x16x32_bf16 v[184:187], v[72:75], v[52:55], v[184:187]
v_mfma_f32_16x16x32_bf16 v[188:191], v[72:75], v[56:59], v[188:191]
v_mfma_f32_16x16x32_bf16 v[224:227], v[76:79], v[56:59], v[224:227]
v_mfma_f32_16x16x32_bf16 v[152:155], v[68:71], v[56:59], v[152:155]
v_mfma_f32_16x16x32_bf16 v[156:159], v[68:71], v[60:63], v[156:159]
v_mfma_f32_16x16x32_bf16 v[228:231], v[76:79], v[60:63], v[228:231]
v_mfma_f32_16x16x32_bf16 v[192:195], v[72:75], v[60:63], v[192:195]
v_mfma_f32_16x16x32_bf16 v[196:199], v[72:75], v[64:67], v[196:199]
v_mfma_f32_16x16x32_bf16 v[232:235], v[76:79], v[64:67], v[232:235]
v_mfma_f32_16x16x32_bf16 v[160:163], v[68:71], v[64:67], v[160:163]
s_waitcnt lgkmcnt(0)
s_barrier
v_mfma_f32_16x16x32_bf16 v[164:167], v[120:123], v[80:83], v[164:167]
ds_read_b128 v[32:35], v2 offset:0
v_mfma_f32_16x16x32_bf16 v[200:203], v[124:127], v[80:83], v[200:203]
ds_read_b64_tr_b16 v[72:73], v6 offset:8192
v_mfma_f32_16x16x32_bf16 v[128:131], v[116:119], v[80:83], v[128:131]
ds_read_b64_tr_b16 v[74:75], v6 offset:8704
v_mfma_f32_16x16x32_bf16 v[132:135], v[116:119], v[84:87], v[132:135]
ds_read_b64_tr_b16 v[76:77], v6 offset:16384
v_mfma_f32_16x16x32_bf16 v[204:207], v[124:127], v[84:87], v[204:207]
ds_read_b64_tr_b16 v[78:79], v6 offset:16896
v_mfma_f32_16x16x32_bf16 v[168:171], v[120:123], v[84:87], v[168:171]
ds_read_b64_tr_b16 v[68:69], v6 offset:0
v_mfma_f32_16x16x32_bf16 v[172:175], v[120:123], v[88:91], v[172:175]
ds_read_b64_tr_b16 v[70:71], v6 offset:512
v_mfma_f32_16x16x32_bf16 v[208:211], v[124:127], v[88:91], v[208:211]
ds_read_b128 v[36:39], v2 offset:2048
v_mfma_f32_16x16x32_bf16 v[136:139], v[116:119], v[88:91], v[136:139]
ds_read_b128 v[40:43], v2 offset:4096
v_mfma_f32_16x16x32_bf16 v[140:143], v[116:119], v[92:95], v[140:143]
ds_read_b128 v[44:47], v2 offset:6144
v_mfma_f32_16x16x32_bf16 v[212:215], v[124:127], v[92:95], v[212:215]
ds_read_b128 v[48:51], v2 offset:8192
v_mfma_f32_16x16x32_bf16 v[176:179], v[120:123], v[92:95], v[176:179]
ds_read_b128 v[52:55], v2 offset:10240
v_mfma_f32_16x16x32_bf16 v[180:183], v[120:123], v[96:99], v[180:183]
ds_read_b128 v[56:59], v2 offset:12288
v_mfma_f32_16x16x32_bf16 v[216:219], v[124:127], v[96:99], v[216:219]
ds_read_b128 v[60:63], v2 offset:14336
v_mfma_f32_16x16x32_bf16 v[144:147], v[116:119], v[96:99], v[144:147]
ds_read_b128 v[64:67], v2 offset:16384
v_mfma_f32_16x16x32_bf16 v[148:151], v[116:119], v[100:103], v[148:151]
v_mfma_f32_16x16x32_bf16 v[220:223], v[124:127], v[100:103], v[220:223]
v_mfma_f32_16x16x32_bf16 v[184:187], v[120:123], v[100:103], v[184:187]
v_mfma_f32_16x16x32_bf16 v[188:191], v[120:123], v[104:107], v[188:191]
v_mfma_f32_16x16x32_bf16 v[224:227], v[124:127], v[104:107], v[224:227]
v_mfma_f32_16x16x32_bf16 v[152:155], v[116:119], v[104:107], v[152:155]
v_mfma_f32_16x16x32_bf16 v[156:159], v[116:119], v[108:111], v[156:159]
v_mfma_f32_16x16x32_bf16 v[228:231], v[124:127], v[108:111], v[228:231]
v_mfma_f32_16x16x32_bf16 v[192:195], v[120:123], v[108:111], v[192:195]
v_mfma_f32_16x16x32_bf16 v[196:199], v[120:123], v[112:115], v[196:199]
v_mfma_f32_16x16x32_bf16 v[232:235], v[124:127], v[112:115], v[232:235]
v_mfma_f32_16x16x32_bf16 v[160:163], v[116:119], v[112:115], v[160:163]
s_mov_b32 s41, 4
Lcl_16:
s_waitcnt lgkmcnt(0)
v_mfma_f32_16x16x32_bf16 v[164:167], v[72:75], v[32:35], v[164:167]
ds_read_b128 v[80:83], v3 offset:0
v_mfma_f32_16x16x32_bf16 v[200:203], v[76:79], v[32:35], v[200:203]
ds_read_b64_tr_b16 v[120:121], v6 offset:12288
v_mfma_f32_16x16x32_bf16 v[128:131], v[68:71], v[32:35], v[128:131]
ds_read_b64_tr_b16 v[122:123], v6 offset:12800
v_mfma_f32_16x16x32_bf16 v[132:135], v[68:71], v[36:39], v[132:135]
ds_read_b64_tr_b16 v[124:125], v6 offset:20480
v_mfma_f32_16x16x32_bf16 v[204:207], v[76:79], v[36:39], v[204:207]
ds_read_b64_tr_b16 v[126:127], v6 offset:20992
v_mfma_f32_16x16x32_bf16 v[168:171], v[72:75], v[36:39], v[168:171]
ds_read_b64_tr_b16 v[116:117], v6 offset:4096
v_mfma_f32_16x16x32_bf16 v[172:175], v[72:75], v[40:43], v[172:175]
ds_read_b64_tr_b16 v[118:119], v6 offset:4608
v_mfma_f32_16x16x32_bf16 v[208:211], v[76:79], v[40:43], v[208:211]
ds_read_b128 v[84:87], v3 offset:2048
v_mfma_f32_16x16x32_bf16 v[136:139], v[68:71], v[40:43], v[136:139]
ds_read_b128 v[88:91], v3 offset:4096
v_mfma_f32_16x16x32_bf16 v[140:143], v[68:71], v[44:47], v[140:143]
ds_read_b128 v[92:95], v3 offset:6144
v_mfma_f32_16x16x32_bf16 v[212:215], v[76:79], v[44:47], v[212:215]
ds_read_b128 v[96:99], v3 offset:8192
v_mfma_f32_16x16x32_bf16 v[176:179], v[72:75], v[44:47], v[176:179]
ds_read_b128 v[100:103], v3 offset:10240
v_mfma_f32_16x16x32_bf16 v[180:183], v[72:75], v[48:51], v[180:183]
ds_read_b128 v[104:107], v3 offset:12288
v_mfma_f32_16x16x32_bf16 v[216:219], v[76:79], v[48:51], v[216:219]
ds_read_b128 v[108:111], v3 offset:14336
v_mfma_f32_16x16x32_bf16 v[144:147], v[68:71], v[48:51], v[144:147]
ds_read_b128 v[112:115], v3 offset:16384
v_mfma_f32_16x16x32_bf16 v[148:151], v[68:71], v[52:55], v[148:151]
v_mfma_f32_16x16x32_bf16 v[220:223], v[76:79], v[52:55], v[220:223]
v_mfma_f32_16x16x32_bf16 v[184:187], v[72:75], v[52:55], v[184:187]
v_mfma_f32_16x16x32_bf16 v[188:191], v[72:75], v[56:59], v[188:191]
v_mfma_f32_16x16x32_bf16 v[224:227], v[76:79], v[56:59], v[224:227]
v_mfma_f32_16x16x32_bf16 v[152:155], v[68:71], v[56:59], v[152:155]
v_mfma_f32_16x16x32_bf16 v[156:159], v[68:71], v[60:63], v[156:159]
v_mfma_f32_16x16x32_bf16 v[228:231], v[76:79], v[60:63], v[228:231]
v_mfma_f32_16x16x32_bf16 v[192:195], v[72:75], v[60:63], v[192:195]
v_mfma_f32_16x16x32_bf16 v[196:199], v[72:75], v[64:67], v[196:199]
v_mfma_f32_16x16x32_bf16 v[232:235], v[76:79], v[64:67], v[232:235]
v_mfma_f32_16x16x32_bf16 v[160:163], v[68:71], v[64:67], v[160:163]
s_waitcnt lgkmcnt(0)
s_barrier
v_mfma_f32_16x16x32_bf16 v[164:167], v[120:123], v[80:83], v[164:167]
ds_read_b128 v[32:35], v2 offset:43008
v_mfma_f32_16x16x32_bf16 v[200:203], v[124:127], v[80:83], v[200:203]
ds_read_b64_tr_b16 v[72:73], v7 offset:8192
v_mfma_f32_16x16x32_bf16 v[128:131], v[116:119], v[80:83], v[128:131]
ds_read_b64_tr_b16 v[74:75], v7 offset:8704
v_mfma_f32_16x16x32_bf16 v[132:135], v[116:119], v[84:87], v[132:135]
ds_read_b64_tr_b16 v[76:77], v7 offset:16384
v_mfma_f32_16x16x32_bf16 v[204:207], v[124:127], v[84:87], v[204:207]
ds_read_b64_tr_b16 v[78:79], v7 offset:16896
v_mfma_f32_16x16x32_bf16 v[168:171], v[120:123], v[84:87], v[168:171]
ds_read_b64_tr_b16 v[68:69], v7 offset:0
v_mfma_f32_16x16x32_bf16 v[172:175], v[120:123], v[88:91], v[172:175]
ds_read_b64_tr_b16 v[70:71], v7 offset:512
v_mfma_f32_16x16x32_bf16 v[208:211], v[124:127], v[88:91], v[208:211]
ds_read_b128 v[36:39], v2 offset:45056
v_mfma_f32_16x16x32_bf16 v[136:139], v[116:119], v[88:91], v[136:139]
ds_read_b128 v[40:43], v2 offset:47104
s_branch Lov_2
.p2align 12
.fill 16, 4, 0xbf800000
Lst_2_0:
s_branch Lst_3_0
s_nop 0
s_nop 0
Lov_2:
v_mfma_f32_16x16x32_bf16 v[140:143], v[116:119], v[92:95], v[140:143]
ds_read_b128 v[44:47], v2 offset:49152
v_mfma_f32_16x16x32_bf16 v[212:215], v[124:127], v[92:95], v[212:215]
ds_read_b128 v[48:51], v2 offset:51200
v_mfma_f32_16x16x32_bf16 v[176:179], v[120:123], v[92:95], v[176:179]
ds_read_b128 v[52:55], v2 offset:53248
v_mfma_f32_16x16x32_bf16 v[180:183], v[120:123], v[96:99], v[180:183]
ds_read_b128 v[56:59], v2 offset:55296
v_mfma_f32_16x16x32_bf16 v[216:219], v[124:127], v[96:99], v[216:219]
ds_read_b128 v[60:63], v2 offset:57344
v_mfma_f32_16x16x32_bf16 v[144:147], v[116:119], v[96:99], v[144:147]
ds_read_b128 v[64:67], v2 offset:59392
v_mfma_f32_16x16x32_bf16 v[148:151], v[116:119], v[100:103], v[148:151]
v_mfma_f32_16x16x32_bf16 v[220:223], v[124:127], v[100:103], v[220:223]
v_mfma_f32_16x16x32_bf16 v[184:187], v[120:123], v[100:103], v[184:187]
v_mfma_f32_16x16x32_bf16 v[188:191], v[120:123], v[104:107], v[188:191]
v_mfma_f32_16x16x32_bf16 v[224:227], v[124:127], v[104:107], v[224:227]
v_mfma_f32_16x16x32_bf16 v[152:155], v[116:119], v[104:107], v[152:155]
v_mfma_f32_16x16x32_bf16 v[156:159], v[116:119], v[108:111], v[156:159]
v_mfma_f32_16x16x32_bf16 v[228:231], v[124:127], v[108:111], v[228:231]
v_mfma_f32_16x16x32_bf16 v[192:195], v[120:123], v[108:111], v[192:195]
v_mfma_f32_16x16x32_bf16 v[196:199], v[120:123], v[112:115], v[196:199]
v_mfma_f32_16x16x32_bf16 v[232:235], v[124:127], v[112:115], v[232:235]
v_mfma_f32_16x16x32_bf16 v[160:163], v[116:119], v[112:115], v[160:163]
s_waitcnt lgkmcnt(0)
v_mfma_f32_16x16x32_bf16 v[164:167], v[72:75], v[32:35], v[164:167]
ds_read_b128 v[80:83], v3 offset:43008
v_mfma_f32_16x16x32_bf16 v[200:203], v[76:79], v[32:35], v[200:203]
ds_read_b64_tr_b16 v[120:121], v7 offset:12288
v_mfma_f32_16x16x32_bf16 v[128:131], v[68:71], v[32:35], v[128:131]
ds_read_b64_tr_b16 v[122:123], v7 offset:12800
v_mfma_f32_16x16x32_bf16 v[132:135], v[68:71], v[36:39], v[132:135]
ds_read_b64_tr_b16 v[124:125], v7 offset:20480
v_mfma_f32_16x16x32_bf16 v[204:207], v[76:79], v[36:39], v[204:207]
ds_read_b64_tr_b16 v[126:127], v7 offset:20992
v_mfma_f32_16x16x32_bf16 v[168:171], v[72:75], v[36:39], v[168:171]
ds_read_b64_tr_b16 v[116:117], v7 offset:4096
v_mfma_f32_16x16x32_bf16 v[172:175], v[72:75], v[40:43], v[172:175]
ds_read_b64_tr_b16 v[118:119], v7 offset:4608
v_mfma_f32_16x16x32_bf16 v[208:211], v[76:79], v[40:43], v[208:211]
ds_read_b128 v[84:87], v3 offset:45056
v_mfma_f32_16x16x32_bf16 v[136:139], v[68:71], v[40:43], v[136:139]
ds_read_b128 v[88:91], v3 offset:47104
v_mfma_f32_16x16x32_bf16 v[140:143], v[68:71], v[44:47], v[140:143]
ds_read_b128 v[92:95], v3 offset:49152
v_mfma_f32_16x16x32_bf16 v[212:215], v[76:79], v[44:47], v[212:215]
ds_read_b128 v[96:99], v3 offset:51200
v_mfma_f32_16x16x32_bf16 v[176:179], v[72:75], v[44:47], v[176:179]
ds_read_b128 v[100:103], v3 offset:53248
v_mfma_f32_16x16x32_bf16 v[180:183], v[72:75], v[48:51], v[180:183]
ds_read_b128 v[104:107], v3 offset:55296
v_mfma_f32_16x16x32_bf16 v[216:219], v[76:79], v[48:51], v[216:219]
ds_read_b128 v[108:111], v3 offset:57344
v_mfma_f32_16x16x32_bf16 v[144:147], v[68:71], v[48:51], v[144:147]
ds_read_b128 v[112:115], v3 offset:59392
v_mfma_f32_16x16x32_bf16 v[148:151], v[68:71], v[52:55], v[148:151]
v_mfma_f32_16x16x32_bf16 v[220:223], v[76:79], v[52:55], v[220:223]
v_mfma_f32_16x16x32_bf16 v[184:187], v[72:75], v[52:55], v[184:187]
v_mfma_f32_16x16x32_bf16 v[188:191], v[72:75], v[56:59], v[188:191]
v_mfma_f32_16x16x32_bf16 v[224:227], v[76:79], v[56:59], v[224:227]
v_mfma_f32_16x16x32_bf16 v[152:155], v[68:71], v[56:59], v[152:155]
v_mfma_f32_16x16x32_bf16 v[156:159], v[68:71], v[60:63], v[156:159]
v_mfma_f32_16x16x32_bf16 v[228:231], v[76:79], v[60:63], v[228:231]
v_mfma_f32_16x16x32_bf16 v[192:195], v[72:75], v[60:63], v[192:195]
v_mfma_f32_16x16x32_bf16 v[196:199], v[72:75], v[64:67], v[196:199]
v_mfma_f32_16x16x32_bf16 v[232:235], v[76:79], v[64:67], v[232:235]
v_mfma_f32_16x16x32_bf16 v[160:163], v[68:71], v[64:67], v[160:163]
s_waitcnt lgkmcnt(0)
s_barrier
v_mfma_f32_16x16x32_bf16 v[164:167], v[120:123], v[80:83], v[164:167]
ds_read_b128 v[32:35], v4 offset:0
v_mfma_f32_16x16x32_bf16 v[200:203], v[124:127], v[80:83], v[200:203]
ds_read_b64_tr_b16 v[72:73], v8 offset:8192
v_mfma_f32_16x16x32_bf16 v[128:131], v[116:119], v[80:83], v[128:131]
ds_read_b64_tr_b16 v[74:75], v8 offset:8704
v_mfma_f32_16x16x32_bf16 v[132:135], v[116:119], v[84:87], v[132:135]
ds_read_b64_tr_b16 v[76:77], v8 offset:16384
v_mfma_f32_16x16x32_bf16 v[204:207], v[124:127], v[84:87], v[204:207]
ds_read_b64_tr_b16 v[78:79], v8 offset:16896
v_mfma_f32_16x16x32_bf16 v[168:171], v[120:123], v[84:87], v[168:171]
ds_read_b64_tr_b16 v[68:69], v8 offset:0
v_mfma_f32_16x16x32_bf16 v[172:175], v[120:123], v[88:91], v[172:175]
ds_read_b64_tr_b16 v[70:71], v8 offset:512
v_mfma_f32_16x16x32_bf16 v[208:211], v[124:127], v[88:91], v[208:211]
ds_read_b128 v[36:39], v4 offset:2048
v_mfma_f32_16x16x32_bf16 v[136:139], v[116:119], v[88:91], v[136:139]
ds_read_b128 v[40:43], v4 offset:4096
v_mfma_f32_16x16x32_bf16 v[140:143], v[116:119], v[92:95], v[140:143]
ds_read_b128 v[44:47], v4 offset:6144
v_mfma_f32_16x16x32_bf16 v[212:215], v[124:127], v[92:95], v[212:215]
ds_read_b128 v[48:51], v4 offset:8192
v_mfma_f32_16x16x32_bf16 v[176:179], v[120:123], v[92:95], v[176:179]
ds_read_b128 v[52:55], v4 offset:10240
v_mfma_f32_16x16x32_bf16 v[180:183], v[120:123], v[96:99], v[180:183]
ds_read_b128 v[56:59], v4 offset:12288
v_mfma_f32_16x16x32_bf16 v[216:219], v[124:127], v[96:99], v[216:219]
ds_read_b128 v[60:63], v4 offset:14336
v_mfma_f32_16x16x32_bf16 v[144:147], v[116:119], v[96:99], v[144:147]
ds_read_b128 v[64:67], v4 offset:16384
v_mfma_f32_16x16x32_bf16 v[148:151], v[116:119], v[100:103], v[148:151]
v_mfma_f32_16x16x32_bf16 v[220:223], v[124:127], v[100:103], v[220:223]
v_mfma_f32_16x16x32_bf16 v[184:187], v[120:123], v[100:103], v[184:187]
v_mfma_f32_16x16x32_bf16 v[188:191], v[120:123], v[104:107], v[188:191]
v_mfma_f32_16x16x32_bf16 v[224:227], v[124:127], v[104:107], v[224:227]
v_mfma_f32_16x16x32_bf16 v[152:155], v[116:119], v[104:107], v[152:155]
v_mfma_f32_16x16x32_bf16 v[156:159], v[116:119], v[108:111], v[156:159]
v_mfma_f32_16x16x32_bf16 v[228:231], v[124:127], v[108:111], v[228:231]
v_mfma_f32_16x16x32_bf16 v[192:195], v[120:123], v[108:111], v[192:195]
v_mfma_f32_16x16x32_bf16 v[196:199], v[120:123], v[112:115], v[196:199]
v_mfma_f32_16x16x32_bf16 v[232:235], v[124:127], v[112:115], v[232:235]
v_mfma_f32_16x16x32_bf16 v[160:163], v[116:119], v[112:115], v[160:163]
s_waitcnt lgkmcnt(0)
v_mfma_f32_16x16x32_bf16 v[164:167], v[72:75], v[32:35], v[164:167]
ds_read_b128 v[80:83], v5 offset:0
v_mfma_f32_16x16x32_bf16 v[200:203], v[76:79], v[32:35], v[200:203]
ds_read_b64_tr_b16 v[120:121], v8 offset:12288
v_mfma_f32_16x16x32_bf16 v[128:131], v[68:71], v[32:35], v[128:131]
ds_read_b64_tr_b16 v[122:123], v8 offset:12800
v_mfma_f32_16x16x32_bf16 v[132:135], v[68:71], v[36:39], v[132:135]
ds_read_b64_tr_b16 v[124:125], v8 offset:20480
v_mfma_f32_16x16x32_bf16 v[204:207], v[76:79], v[36:39], v[204:207]
ds_read_b64_tr_b16 v[126:127], v8 offset:20992
v_mfma_f32_16x16x32_bf16 v[168:171], v[72:75], v[36:39], v[168:171]
ds_read_b64_tr_b16 v[116:117], v8 offset:4096
v_mfma_f32_16x16x32_bf16 v[172:175], v[72:75], v[40:43], v[172:175]
ds_read_b64_tr_b16 v[118:119], v8 offset:4608
v_mfma_f32_16x16x32_bf16 v[208:211], v[76:79], v[40:43], v[208:211]
ds_read_b128 v[84:87], v5 offset:2048
v_mfma_f32_16x16x32_bf16 v[136:139], v[68:71], v[40:43], v[136:139]
ds_read_b128 v[88:91], v5 offset:4096
v_mfma_f32_16x16x32_bf16 v[140:143], v[68:71], v[44:47], v[140:143]
ds_read_b128 v[92:95], v5 offset:6144
v_mfma_f32_16x16x32_bf16 v[212:215], v[76:79], v[44:47], v[212:215]
ds_read_b128 v[96:99], v5 offset:8192
v_mfma_f32_16x16x32_bf16 v[176:179], v[72:75], v[44:47], v[176:179]
ds_read_b128 v[100:103], v5 offset:10240
v_mfma_f32_16x16x32_bf16 v[180:183], v[72:75], v[48:51], v[180:183]
ds_read_b128 v[104:107], v5 offset:12288
v_mfma_f32_16x16x32_bf16 v[216:219], v[76:79], v[48:51], v[216:219]
ds_read_b128 v[108:111], v5 offset:14336
v_mfma_f32_16x16x32_bf16 v[144:147], v[68:71], v[48:51], v[144:147]
ds_read_b128 v[112:115], v5 offset:16384
v_mfma_f32_16x16x32_bf16 v[148:151], v[68:71], v[52:55], v[148:151]
v_mfma_f32_16x16x32_bf16 v[220:223], v[76:79], v[52:55], v[220:223]
v_mfma_f32_16x16x32_bf16 v[184:187], v[72:75], v[52:55], v[184:187]
v_mfma_f32_16x16x32_bf16 v[188:191], v[72:75], v[56:59], v[188:191]
v_mfma_f32_16x16x32_bf16 v[224:227], v[76:79], v[56:59], v[224:227]
v_mfma_f32_16x16x32_bf16 v[152:155], v[68:71], v[56:59], v[152:155]
v_mfma_f32_16x16x32_bf16 v[156:159], v[68:71], v[60:63], v[156:159]
v_mfma_f32_16x16x32_bf16 v[228:231], v[76:79], v[60:63], v[228:231]
v_mfma_f32_16x16x32_bf16 v[192:195], v[72:75], v[60:63], v[192:195]
v_mfma_f32_16x16x32_bf16 v[196:199], v[72:75], v[64:67], v[196:199]
v_mfma_f32_16x16x32_bf16 v[232:235], v[76:79], v[64:67], v[232:235]
v_mfma_f32_16x16x32_bf16 v[160:163], v[68:71], v[64:67], v[160:163]
s_waitcnt lgkmcnt(0)
s_barrier
v_mfma_f32_16x16x32_bf16 v[164:167], v[120:123], v[80:83], v[164:167]
ds_read_b128 v[32:35], v2 offset:0
v_mfma_f32_16x16x32_bf16 v[200:203], v[124:127], v[80:83], v[200:203]
ds_read_b64_tr_b16 v[72:73], v6 offset:8192
v_mfma_f32_16x16x32_bf16 v[128:131], v[116:119], v[80:83], v[128:131]
ds_read_b64_tr_b16 v[74:75], v6 offset:8704
v_mfma_f32_16x16x32_bf16 v[132:135], v[116:119], v[84:87], v[132:135]
ds_read_b64_tr_b16 v[76:77], v6 offset:16384
v_mfma_f32_16x16x32_bf16 v[204:207], v[124:127], v[84:87], v[204:207]
ds_read_b64_tr_b16 v[78:79], v6 offset:16896
v_mfma_f32_16x16x32_bf16 v[168:171], v[120:123], v[84:87], v[168:171]
ds_read_b64_tr_b16 v[68:69], v6 offset:0
v_mfma_f32_16x16x32_bf16 v[172:175], v[120:123], v[88:91], v[172:175]
ds_read_b64_tr_b16 v[70:71], v6 offset:512
v_mfma_f32_16x16x32_bf16 v[208:211], v[124:127], v[88:91], v[208:211]
ds_read_b128 v[36:39], v2 offset:2048
v_mfma_f32_16x16x32_bf16 v[136:139], v[116:119], v[88:91], v[136:139]
ds_read_b128 v[40:43], v2 offset:4096
v_mfma_f32_16x16x32_bf16 v[140:143], v[116:119], v[92:95], v[140:143]
ds_read_b128 v[44:47], v2 offset:6144
v_mfma_f32_16x16x32_bf16 v[212:215], v[124:127], v[92:95], v[212:215]
ds_read_b128 v[48:51], v2 offset:8192
v_mfma_f32_16x16x32_bf16 v[176:179], v[120:123], v[92:95], v[176:179]
ds_read_b128 v[52:55], v2 offset:10240
v_mfma_f32_16x16x32_bf16 v[180:183], v[120:123], v[96:99], v[180:183]
ds_read_b128 v[56:59], v2 offset:12288
v_mfma_f32_16x16x32_bf16 v[216:219], v[124:127], v[96:99], v[216:219]
ds_read_b128 v[60:63], v2 offset:14336
v_mfma_f32_16x16x32_bf16 v[144:147], v[116:119], v[96:99], v[144:147]
ds_read_b128 v[64:67], v2 offset:16384
v_mfma_f32_16x16x32_bf16 v[148:151], v[116:119], v[100:103], v[148:151]
v_mfma_f32_16x16x32_bf16 v[220:223], v[124:127], v[100:103], v[220:223]
v_mfma_f32_16x16x32_bf16 v[184:187], v[120:123], v[100:103], v[184:187]
v_mfma_f32_16x16x32_bf16 v[188:191], v[120:123], v[104:107], v[188:191]
v_mfma_f32_16x16x32_bf16 v[224:227], v[124:127], v[104:107], v[224:227]
v_mfma_f32_16x16x32_bf16 v[152:155], v[116:119], v[104:107], v[152:155]
v_mfma_f32_16x16x32_bf16 v[156:159], v[116:119], v[108:111], v[156:159]
v_mfma_f32_16x16x32_bf16 v[228:231], v[124:127], v[108:111], v[228:231]
v_mfma_f32_16x16x32_bf16 v[192:195], v[120:123], v[108:111], v[192:195]
v_mfma_f32_16x16x32_bf16 v[196:199], v[120:123], v[112:115], v[196:199]
v_mfma_f32_16x16x32_bf16 v[232:235], v[124:127], v[112:115], v[232:235]
v_mfma_f32_16x16x32_bf16 v[160:163], v[116:119], v[112:115], v[160:163]
s_sub_u32 s41, s41, 1
s_cmp_lg_u32 s41, 0
s_cbranch_scc1 Lcl_16
s_waitcnt lgkmcnt(0)
v_mfma_f32_16x16x32_bf16 v[164:167], v[72:75], v[32:35], v[164:167]
ds_read_b128 v[80:83], v3 offset:0
v_mfma_f32_16x16x32_bf16 v[200:203], v[76:79], v[32:35], v[200:203]
ds_read_b64_tr_b16 v[120:121], v6 offset:12288
v_mfma_f32_16x16x32_bf16 v[128:131], v[68:71], v[32:35], v[128:131]
ds_read_b64_tr_b16 v[122:123], v6 offset:12800
v_mfma_f32_16x16x32_bf16 v[132:135], v[68:71], v[36:39], v[132:135]
ds_read_b64_tr_b16 v[124:125], v6 offset:20480
v_mfma_f32_16x16x32_bf16 v[204:207], v[76:79], v[36:39], v[204:207]
ds_read_b64_tr_b16 v[126:127], v6 offset:20992
v_mfma_f32_16x16x32_bf16 v[168:171], v[72:75], v[36:39], v[168:171]
ds_read_b64_tr_b16 v[116:117], v6 offset:4096
v_mfma_f32_16x16x32_bf16 v[172:175], v[72:75], v[40:43], v[172:175]
ds_read_b64_tr_b16 v[118:119], v6 offset:4608
v_mfma_f32_16x16x32_bf16 v[208:211], v[76:79], v[40:43], v[208:211]
ds_read_b128 v[84:87], v3 offset:2048
v_mfma_f32_16x16x32_bf16 v[136:139], v[68:71], v[40:43], v[136:139]
ds_read_b128 v[88:91], v3 offset:4096
v_mfma_f32_16x16x32_bf16 v[140:143], v[68:71], v[44:47], v[140:143]
ds_read_b128 v[92:95], v3 offset:6144
v_mfma_f32_16x16x32_bf16 v[212:215], v[76:79], v[44:47], v[212:215]
ds_read_b128 v[96:99], v3 offset:8192
v_mfma_f32_16x16x32_bf16 v[176:179], v[72:75], v[44:47], v[176:179]
ds_read_b128 v[100:103], v3 offset:10240
v_mfma_f32_16x16x32_bf16 v[180:183], v[72:75], v[48:51], v[180:183]
ds_read_b128 v[104:107], v3 offset:12288
v_mfma_f32_16x16x32_bf16 v[216:219], v[76:79], v[48:51], v[216:219]
ds_read_b128 v[108:111], v3 offset:14336
v_mfma_f32_16x16x32_bf16 v[144:147], v[68:71], v[48:51], v[144:147]
ds_read_b128 v[112:115], v3 offset:16384
v_mfma_f32_16x16x32_bf16 v[148:151], v[68:71], v[52:55], v[148:151]
v_mfma_f32_16x16x32_bf16 v[220:223], v[76:79], v[52:55], v[220:223]
v_mfma_f32_16x16x32_bf16 v[184:187], v[72:75], v[52:55], v[184:187]
v_mfma_f32_16x16x32_bf16 v[188:191], v[72:75], v[56:59], v[188:191]
v_mfma_f32_16x16x32_bf16 v[224:227], v[76:79], v[56:59], v[224:227]
v_mfma_f32_16x16x32_bf16 v[152:155], v[68:71], v[56:59], v[152:155]
v_mfma_f32_16x16x32_bf16 v[156:159], v[68:71], v[60:63], v[156:159]
v_mfma_f32_16x16x32_bf16 v[228:231], v[76:79], v[60:63], v[228:231]
v_mfma_f32_16x16x32_bf16 v[192:195], v[72:75], v[60:63], v[192:195]
v_mfma_f32_16x16x32_bf16 v[196:199], v[72:75], v[64:67], v[196:199]
v_mfma_f32_16x16x32_bf16 v[232:235], v[76:79], v[64:67], v[232:235]
v_mfma_f32_16x16x32_bf16 v[160:163], v[68:71], v[64:67], v[160:163]
s_waitcnt lgkmcnt(0)
v_mfma_f32_16x16x32_bf16 v[164:167], v[120:123], v[80:83], v[164:167]
v_mfma_f32_16x16x32_bf16 v[200:203], v[124:127], v[80:83], v[200:203]
v_mfma_f32_16x16x32_bf16 v[128:131], v[116:119], v[80:83], v[128:131]
v_mfma_f32_16x16x32_bf16 v[132:135], v[116:119], v[84:87], v[132:135]
v_mfma_f32_16x16x32_bf16 v[204:207], v[124:127], v[84:87], v[204:207]
v_mfma_f32_16x16x32_bf16 v[168:171], v[120:123], v[84:87], v[168:171]
v_mfma_f32_16x16x32_bf16 v[172:175], v[120:123], v[88:91], v[172:175]
v_mfma_f32_16x16x32_bf16 v[208:211], v[124:127], v[88:91], v[208:211]
v_mfma_f32_16x16x32_bf16 v[136:139], v[116:119], v[88:91], v[136:139]
v_mfma_f32_16x16x32_bf16 v[140:143], v[116:119], v[92:95], v[140:143]
v_mfma_f32_16x16x32_bf16 v[212:215], v[124:127], v[92:95], v[212:215]
v_mfma_f32_16x16x32_bf16 v[176:179], v[120:123], v[92:95], v[176:179]
v_mfma_f32_16x16x32_bf16 v[180:183], v[120:123], v[96:99], v[180:183]
v_mfma_f32_16x16x32_bf16 v[216:219], v[124:127], v[96:99], v[216:219]
v_mfma_f32_16x16x32_bf16 v[144:147], v[116:119], v[96:99], v[144:147]
v_mfma_f32_16x16x32_bf16 v[148:151], v[116:119], v[100:103], v[148:151]
v_mfma_f32_16x16x32_bf16 v[220:223], v[124:127], v[100:103], v[220:223]
v_mfma_f32_16x16x32_bf16 v[184:187], v[120:123], v[100:103], v[184:187]
v_mfma_f32_16x16x32_bf16 v[188:191], v[120:123], v[104:107], v[188:191]
v_mfma_f32_16x16x32_bf16 v[224:227], v[124:127], v[104:107], v[224:227]
v_mfma_f32_16x16x32_bf16 v[152:155], v[116:119], v[104:107], v[152:155]
v_mfma_f32_16x16x32_bf16 v[156:159], v[116:119], v[108:111], v[156:159]
v_mfma_f32_16x16x32_bf16 v[228:231], v[124:127], v[108:111], v[228:231]
v_mfma_f32_16x16x32_bf16 v[192:195], v[120:123], v[108:111], v[192:195]
v_mfma_f32_16x16x32_bf16 v[196:199], v[120:123], v[112:115], v[196:199]
v_mfma_f32_16x16x32_bf16 v[232:235], v[124:127], v[112:115], v[232:235]
v_mfma_f32_16x16x32_bf16 v[160:163], v[116:119], v[112:115], v[160:163]
v_lshlrev_b32 v14, 3, v12
v_add_u32 v14, 147456, v14
v_mul_u32_u24 v15, 400, v12
v_lshl_add_u32 v15, v13, 3, v15
s_lshl_b32 s43, s36, 5
v_add_u32 v15, s43, v15
s_barrier
ds_read_b64 v[32:33], v14 offset:0
ds_read_b64 v[34:35], v14 offset:128
ds_read_b64 v[36:37], v14 offset:256
ds_read_b64 v[38:39], v14 offset:384
ds_read_b64 v[40:41], v14 offset:512
ds_read_b64 v[42:43], v14 offset:640
ds_read_b64 v[44:45], v14 offset:768
ds_read_b64 v[46:47], v14 offset:896
ds_read_b64 v[48:49], v14 offset:1024
v_mov_b32_dpp v52, v128 row_newbcast:0 row_mask:0xf bank_mask:0xf
v_mov_b32_dpp v53, v129 row_newbcast:0 row_mask:0xf bank_mask:0xf
v_mov_b32_dpp v54, v130 row_newbcast:0 row_mask:0xf bank_mask:0xf
v_mov_b32_dpp v55, v131 row_newbcast:0 row_mask:0xf bank_mask:0xf
v_mov_b32_dpp v56, v164 row_newbcast:0 row_mask:0xf bank_mask:0xf
v_mov_b32_dpp v57, v165 row_newbcast:0 row_mask:0xf bank_mask:0xf
v_mov_b32_dpp v58, v166 row_newbcast:0 row_mask:0xf bank_mask:0xf
v_mov_b32_dpp v59, v167 row_newbcast:0 row_mask:0xf bank_mask:0xf
v_mov_b32_dpp v60, v200 row_newbcast:0 row_mask:0xf bank_mask:0xf
v_mov_b32_dpp v61, v201 row_newbcast:0 row_mask:0xf bank_mask:0xf
v_mov_b32_dpp v62, v202 row_newbcast:0 row_mask:0xf bank_mask:0xf
v_mov_b32_dpp v63, v203 row_newbcast:0 row_mask:0xf bank_mask:0xf
s_waitcnt lgkmcnt(0)
v_pk_fma_f32 v[164:165], v[32:33], v[56:57], v[164:165] op_sel_hi:[0,1,1] neg_lo:[1,0,0] neg_hi:[1,0,0]
v_pk_fma_f32 v[166:167], v[32:33], v[58:59], v[166:167] op_sel_hi:[0,1,1] neg_lo:[1,0,0] neg_hi:[1,0,0]
v_pk_fma_f32 v[200:201], v[32:33], v[60:61], v[200:201] op_sel_hi:[0,1,1] neg_lo:[1,0,0] neg_hi:[1,0,0]
v_pk_fma_f32 v[202:203], v[32:33], v[62:63], v[202:203] op_sel_hi:[0,1,1] neg_lo:[1,0,0] neg_hi:[1,0,0]
v_pk_mul_f32 v[164:165], v[32:33], v[164:165] op_sel:[1,0] op_sel_hi:[1,1]
v_pk_mul_f32 v[166:167], v[32:33], v[166:167] op_sel:[1,0] op_sel_hi:[1,1]
v_pk_fma_f32 v[132:133], v[34:35], v[52:53], v[132:133] op_sel_hi:[0,1,1] neg_lo:[1,0,0] neg_hi:[1,0,0]
v_pk_fma_f32 v[134:135], v[34:35], v[54:55], v[134:135] op_sel_hi:[0,1,1] neg_lo:[1,0,0] neg_hi:[1,0,0]
v_pk_mul_f32 v[200:201], v[32:33], v[200:201] op_sel:[1,0] op_sel_hi:[1,1]
v_pk_mul_f32 v[202:203], v[32:33], v[202:203] op_sel:[1,0] op_sel_hi:[1,1]
v_cvt_pk_bf16_f32 v164, v164, v165
v_cvt_pk_bf16_f32 v165, v166, v167
ds_write_b64 v15, v[164:165] offset:128
v_pk_fma_f32 v[168:169], v[34:35], v[56:57], v[168:169] op_sel_hi:[0,1,1] neg_lo:[1,0,0] neg_hi:[1,0,0]
v_pk_fma_f32 v[170:171], v[34:35], v[58:59], v[170:171] op_sel_hi:[0,1,1] neg_lo:[1,0,0] neg_hi:[1,0,0]
v_pk_mul_f32 v[132:133], v[34:35], v[132:133] op_sel:[1,0] op_sel_hi:[1,1]
v_pk_mul_f32 v[134:135], v[34:35], v[134:135] op_sel:[1,0] op_sel_hi:[1,1]
v_cvt_pk_bf16_f32 v200, v200, v201
v_cvt_pk_bf16_f32 v201, v202, v203
ds_write_b64 v15, v[200:201] offset:256
v_pk_fma_f32 v[204:205], v[34:35], v[60:61], v[204:205] op_sel_hi:[0,1,1] neg_lo:[1,0,0] neg_hi:[1,0,0]
v_pk_fma_f32 v[206:207], v[34:35], v[62:63], v[206:207] op_sel_hi:[0,1,1] neg_lo:[1,0,0] neg_hi:[1,0,0]
v_pk_mul_f32 v[168:169], v[34:35], v[168:169] op_sel:[1,0] op_sel_hi:[1,1]
v_pk_mul_f32 v[170:171], v[34:35], v[170:171] op_sel:[1,0] op_sel_hi:[1,1]
v_cvt_pk_bf16_f32 v132, v132, v133
v_cvt_pk_bf16_f32 v133, v134, v135
ds_write_b64 v15, v[132:133] offset:6400
v_pk_fma_f32 v[136:137], v[36:37], v[52:53], v[136:137] op_sel_hi:[0,1,1] neg_lo:[1,0,0] neg_hi:[1,0,0]
v_pk_fma_f32 v[138:139], v[36:37], v[54:55], v[138:139] op_sel_hi:[0,1,1] neg_lo:[1,0,0] neg_hi:[1,0,0]
v_pk_mul_f32 v[204:205], v[34:35], v[204:205] op_sel:[1,0] op_sel_hi:[1,1]
v_pk_mul_f32 v[206:207], v[34:35], v[206:207] op_sel:[1,0] op_sel_hi:[1,1]
v_cvt_pk_bf16_f32 v168, v168, v169
v_cvt_pk_bf16_f32 v169, v170, v171
ds_write_b64 v15, v[168:169] offset:6528
v_pk_fma_f32 v[172:173], v[36:37], v[56:57], v[172:173] op_sel_hi:[0,1,1] neg_lo:[1,0,0] neg_hi:[1,0,0]
v_pk_fma_f32 v[174:175], v[36:37], v[58:59], v[174:175] op_sel_hi:[0,1,1] neg_lo:[1,0,0] neg_hi:[1,0,0]
v_pk_mul_f32 v[136:137], v[36:37], v[136:137] op_sel:[1,0] op_sel_hi:[1,1]
v_pk_mul_f32 v[138:139], v[36:37], v[138:139] op_sel:[1,0] op_sel_hi:[1,1]
v_cvt_pk_bf16_f32 v204, v204, v205
v_cvt_pk_bf16_f32 v205, v206, v207
ds_write_b64 v15, v[204:205] offset:6656
v_pk_fma_f32 v[208:209], v[36:37], v[60:61], v[208:209] op_sel_hi:[0,1,1] neg_lo:[1,0,0] neg_hi:[1,0,0]
v_pk_fma_f32 v[210:211], v[36:37], v[62:63], v[210:211] op_sel_hi:[0,1,1] neg_lo:[1,0,0] neg_hi:[1,0,0]
v_pk_mul_f32 v[172:173], v[36:37], v[172:173] op_sel:[1,0] op_sel_hi:[1,1]
v_pk_mul_f32 v[174:175], v[36:37], v[174:175] op_sel:[1,0] op_sel_hi:[1,1]
v_cvt_pk_bf16_f32 v136, v136, v137
v_cvt_pk_bf16_f32 v137, v138, v139
ds_write_b64 v15, v[136:137] offset:12800
v_pk_fma_f32 v[140:141], v[38:39], v[52:53], v[140:141] op_sel_hi:[0,1,1] neg_lo:[1,0,0] neg_hi:[1,0,0]
v_pk_fma_f32 v[142:143], v[38:39], v[54:55], v[142:143] op_sel_hi:[0,1,1] neg_lo:[1,0,0] neg_hi:[1,0,0]
v_pk_mul_f32 v[208:209], v[36:37], v[208:209] op_sel:[1,0] op_sel_hi:[1,1]
v_pk_mul_f32 v[210:211], v[36:37], v[210:211] op_sel:[1,0] op_sel_hi:[1,1]
v_cvt_pk_bf16_f32 v172, v172, v173
v_cvt_pk_bf16_f32 v173, v174, v175
ds_write_b64 v15, v[172:173] offset:12928
v_pk_fma_f32 v[176:177], v[38:39], v[56:57], v[176:177] op_sel_hi:[0,1,1] neg_lo:[1,0,0] neg_hi:[1,0,0]
v_pk_fma_f32 v[178:179], v[38:39], v[58:59], v[178:179] op_sel_hi:[0,1,1] neg_lo:[1,0,0] neg_hi:[1,0,0]
v_pk_mul_f32 v[140:141], v[38:39], v[140:141] op_sel:[1,0] op_sel_hi:[1,1]
v_pk_mul_f32 v[142:143], v[38:39], v[142:143] op_sel:[1,0] op_sel_hi:[1,1]
v_cvt_pk_bf16_f32 v208, v208, v209
v_cvt_pk_bf16_f32 v209, v210, v211
ds_write_b64 v15, v[208:209] offset:13056
v_pk_fma_f32 v[212:213], v[38:39], v[60:61], v[212:213] op_sel_hi:[0,1,1] neg_lo:[1,0,0] neg_hi:[1,0,0]
v_pk_fma_f32 v[214:215], v[38:39], v[62:63], v[214:215] op_sel_hi:[0,1,1] neg_lo:[1,0,0] neg_hi:[1,0,0]
v_pk_mul_f32 v[176:177], v[38:39], v[176:177] op_sel:[1,0] op_sel_hi:[1,1]
v_pk_mul_f32 v[178:179], v[38:39], v[178:179] op_sel:[1,0] op_sel_hi:[1,1]
v_cvt_pk_bf16_f32 v140, v140, v141
v_cvt_pk_bf16_f32 v141, v142, v143
ds_write_b64 v15, v[140:141] offset:19200
v_pk_fma_f32 v[144:145], v[40:41], v[52:53], v[144:145] op_sel_hi:[0,1,1] neg_lo:[1,0,0] neg_hi:[1,0,0]
v_pk_fma_f32 v[146:147], v[40:41], v[54:55], v[146:147] op_sel_hi:[0,1,1] neg_lo:[1,0,0] neg_hi:[1,0,0]
v_pk_mul_f32 v[212:213], v[38:39], v[212:213] op_sel:[1,0] op_sel_hi:[1,1]
v_pk_mul_f32 v[214:215], v[38:39], v[214:215] op_sel:[1,0] op_sel_hi:[1,1]
v_cvt_pk_bf16_f32 v176, v176, v177
v_cvt_pk_bf16_f32 v177, v178, v179
ds_write_b64 v15, v[176:177] offset:19328
v_pk_fma_f32 v[180:181], v[40:41], v[56:57], v[180:181] op_sel_hi:[0,1,1] neg_lo:[1,0,0] neg_hi:[1,0,0]
v_pk_fma_f32 v[182:183], v[40:41], v[58:59], v[182:183] op_sel_hi:[0,1,1] neg_lo:[1,0,0] neg_hi:[1,0,0]
v_pk_mul_f32 v[144:145], v[40:41], v[144:145] op_sel:[1,0] op_sel_hi:[1,1]
v_pk_mul_f32 v[146:147], v[40:41], v[146:147] op_sel:[1,0] op_sel_hi:[1,1]
v_cvt_pk_bf16_f32 v212, v212, v213
v_cvt_pk_bf16_f32 v213, v214, v215
ds_write_b64 v15, v[212:213] offset:19456
v_pk_fma_f32 v[216:217], v[40:41], v[60:61], v[216:217] op_sel_hi:[0,1,1] neg_lo:[1,0,0] neg_hi:[1,0,0]
v_pk_fma_f32 v[218:219], v[40:41], v[62:63], v[218:219] op_sel_hi:[0,1,1] neg_lo:[1,0,0] neg_hi:[1,0,0]
v_pk_mul_f32 v[180:181], v[40:41], v[180:181] op_sel:[1,0] op_sel_hi:[1,1]
v_pk_mul_f32 v[182:183], v[40:41], v[182:183] op_sel:[1,0] op_sel_hi:[1,1]
v_cvt_pk_bf16_f32 v144, v144, v145
v_cvt_pk_bf16_f32 v145, v146, v147
ds_write_b64 v15, v[144:145] offset:25600
v_pk_fma_f32 v[148:149], v[42:43], v[52:53], v[148:149] op_sel_hi:[0,1,1] neg_lo:[1,0,0] neg_hi:[1,0,0]
v_pk_fma_f32 v[150:151], v[42:43], v[54:55], v[150:151] op_sel_hi:[0,1,1] neg_lo:[1,0,0] neg_hi:[1,0,0]
v_pk_mul_f32 v[216:217], v[40:41], v[216:217] op_sel:[1,0] op_sel_hi:[1,1]
v_pk_mul_f32 v[218:219], v[40:41], v[218:219] op_sel:[1,0] op_sel_hi:[1,1]
v_cvt_pk_bf16_f32 v180, v180, v181
v_cvt_pk_bf16_f32 v181, v182, v183
ds_write_b64 v15, v[180:181] offset:25728
v_pk_fma_f32 v[184:185], v[42:43], v[56:57], v[184:185] op_sel_hi:[0,1,1] neg_lo:[1,0,0] neg_hi:[1,0,0]
v_pk_fma_f32 v[186:187], v[42:43], v[58:59], v[186:187] op_sel_hi:[0,1,1] neg_lo:[1,0,0] neg_hi:[1,0,0]
v_pk_mul_f32 v[148:149], v[42:43], v[148:149] op_sel:[1,0] op_sel_hi:[1,1]
v_pk_mul_f32 v[150:151], v[42:43], v[150:151] op_sel:[1,0] op_sel_hi:[1,1]
v_cvt_pk_bf16_f32 v216, v216, v217
v_cvt_pk_bf16_f32 v217, v218, v219
ds_write_b64 v15, v[216:217] offset:25856
v_pk_fma_f32 v[220:221], v[42:43], v[60:61], v[220:221] op_sel_hi:[0,1,1] neg_lo:[1,0,0] neg_hi:[1,0,0]
v_pk_fma_f32 v[222:223], v[42:43], v[62:63], v[222:223] op_sel_hi:[0,1,1] neg_lo:[1,0,0] neg_hi:[1,0,0]
v_pk_mul_f32 v[184:185], v[42:43], v[184:185] op_sel:[1,0] op_sel_hi:[1,1]
v_pk_mul_f32 v[186:187], v[42:43], v[186:187] op_sel:[1,0] op_sel_hi:[1,1]
v_cvt_pk_bf16_f32 v148, v148, v149
v_cvt_pk_bf16_f32 v149, v150, v151
ds_write_b64 v15, v[148:149] offset:32000
v_pk_fma_f32 v[152:153], v[44:45], v[52:53], v[152:153] op_sel_hi:[0,1,1] neg_lo:[1,0,0] neg_hi:[1,0,0]
v_pk_fma_f32 v[154:155], v[44:45], v[54:55], v[154:155] op_sel_hi:[0,1,1] neg_lo:[1,0,0] neg_hi:[1,0,0]
v_pk_mul_f32 v[220:221], v[42:43], v[220:221] op_sel:[1,0] op_sel_hi:[1,1]
v_pk_mul_f32 v[222:223], v[42:43], v[222:223] op_sel:[1,0] op_sel_hi:[1,1]
v_cvt_pk_bf16_f32 v184, v184, v185
v_cvt_pk_bf16_f32 v185, v186, v187
ds_write_b64 v15, v[184:185] offset:32128
v_pk_fma_f32 v[188:189], v[44:45], v[56:57], v[188:189] op_sel_hi:[0,1,1] neg_lo:[1,0,0] neg_hi:[1,0,0]
v_pk_fma_f32 v[190:191], v[44:45], v[58:59], v[190:191] op_sel_hi:[0,1,1] neg_lo:[1,0,0] neg_hi:[1,0,0]
v_pk_mul_f32 v[152:153], v[44:45], v[152:153] op_sel:[1,0] op_sel_hi:[1,1]
v_pk_mul_f32 v[154:155], v[44:45], v[154:155] op_sel:[1,0] op_sel_hi:[1,1]
v_cvt_pk_bf16_f32 v220, v220, v221
v_cvt_pk_bf16_f32 v221, v222, v223
ds_write_b64 v15, v[220:221] offset:32256
v_pk_fma_f32 v[224:225], v[44:45], v[60:61], v[224:225] op_sel_hi:[0,1,1] neg_lo:[1,0,0] neg_hi:[1,0,0]
v_pk_fma_f32 v[226:227], v[44:45], v[62:63], v[226:227] op_sel_hi:[0,1,1] neg_lo:[1,0,0] neg_hi:[1,0,0]
v_pk_mul_f32 v[188:189], v[44:45], v[188:189] op_sel:[1,0] op_sel_hi:[1,1]
v_pk_mul_f32 v[190:191], v[44:45], v[190:191] op_sel:[1,0] op_sel_hi:[1,1]
v_cvt_pk_bf16_f32 v152, v152, v153
v_cvt_pk_bf16_f32 v153, v154, v155
ds_write_b64 v15, v[152:153] offset:38400
v_pk_fma_f32 v[156:157], v[46:47], v[52:53], v[156:157] op_sel_hi:[0,1,1] neg_lo:[1,0,0] neg_hi:[1,0,0]
v_pk_fma_f32 v[158:159], v[46:47], v[54:55], v[158:159] op_sel_hi:[0,1,1] neg_lo:[1,0,0] neg_hi:[1,0,0]
v_pk_mul_f32 v[224:225], v[44:45], v[224:225] op_sel:[1,0] op_sel_hi:[1,1]
v_pk_mul_f32 v[226:227], v[44:45], v[226:227] op_sel:[1,0] op_sel_hi:[1,1]
v_cvt_pk_bf16_f32 v188, v188, v189
v_cvt_pk_bf16_f32 v189, v190, v191
ds_write_b64 v15, v[188:189] offset:38528
v_pk_fma_f32 v[192:193], v[46:47], v[56:57], v[192:193] op_sel_hi:[0,1,1] neg_lo:[1,0,0] neg_hi:[1,0,0]
v_pk_fma_f32 v[194:195], v[46:47], v[58:59], v[194:195] op_sel_hi:[0,1,1] neg_lo:[1,0,0] neg_hi:[1,0,0]
v_pk_mul_f32 v[156:157], v[46:47], v[156:157] op_sel:[1,0] op_sel_hi:[1,1]
v_pk_mul_f32 v[158:159], v[46:47], v[158:159] op_sel:[1,0] op_sel_hi:[1,1]
v_cvt_pk_bf16_f32 v224, v224, v225
v_cvt_pk_bf16_f32 v225, v226, v227
ds_write_b64 v15, v[224:225] offset:38656
v_pk_fma_f32 v[228:229], v[46:47], v[60:61], v[228:229] op_sel_hi:[0,1,1] neg_lo:[1,0,0] neg_hi:[1,0,0]
v_pk_fma_f32 v[230:231], v[46:47], v[62:63], v[230:231] op_sel_hi:[0,1,1] neg_lo:[1,0,0] neg_hi:[1,0,0]
v_pk_mul_f32 v[192:193], v[46:47], v[192:193] op_sel:[1,0] op_sel_hi:[1,1]
v_pk_mul_f32 v[194:195], v[46:47], v[194:195] op_sel:[1,0] op_sel_hi:[1,1]
v_cvt_pk_bf16_f32 v156, v156, v157
v_cvt_pk_bf16_f32 v157, v158, v159
ds_write_b64 v15, v[156:157] offset:44800
v_pk_fma_f32 v[160:161], v[48:49], v[52:53], v[160:161] op_sel_hi:[0,1,1] neg_lo:[1,0,0] neg_hi:[1,0,0]
v_pk_fma_f32 v[162:163], v[48:49], v[54:55], v[162:163] op_sel_hi:[0,1,1] neg_lo:[1,0,0] neg_hi:[1,0,0]
v_pk_mul_f32 v[228:229], v[46:47], v[228:229] op_sel:[1,0] op_sel_hi:[1,1]
v_pk_mul_f32 v[230:231], v[46:47], v[230:231] op_sel:[1,0] op_sel_hi:[1,1]
v_cvt_pk_bf16_f32 v192, v192, v193
v_cvt_pk_bf16_f32 v193, v194, v195
ds_write_b64 v15, v[192:193] offset:44928
v_pk_fma_f32 v[196:197], v[48:49], v[56:57], v[196:197] op_sel_hi:[0,1,1] neg_lo:[1,0,0] neg_hi:[1,0,0]
v_pk_fma_f32 v[198:199], v[48:49], v[58:59], v[198:199] op_sel_hi:[0,1,1] neg_lo:[1,0,0] neg_hi:[1,0,0]
v_pk_mul_f32 v[160:161], v[48:49], v[160:161] op_sel:[1,0] op_sel_hi:[1,1]
v_pk_mul_f32 v[162:163], v[48:49], v[162:163] op_sel:[1,0] op_sel_hi:[1,1]
v_cvt_pk_bf16_f32 v228, v228, v229
v_cvt_pk_bf16_f32 v229, v230, v231
ds_write_b64 v15, v[228:229] offset:45056
v_pk_fma_f32 v[232:233], v[48:49], v[60:61], v[232:233] op_sel_hi:[0,1,1] neg_lo:[1,0,0] neg_hi:[1,0,0]
v_pk_fma_f32 v[234:235], v[48:49], v[62:63], v[234:235] op_sel_hi:[0,1,1] neg_lo:[1,0,0] neg_hi:[1,0,0]
v_pk_mul_f32 v[196:197], v[48:49], v[196:197] op_sel:[1,0] op_sel_hi:[1,1]
v_pk_mul_f32 v[198:199], v[48:49], v[198:199] op_sel:[1,0] op_sel_hi:[1,1]
v_cvt_pk_bf16_f32 v160, v160, v161
v_cvt_pk_bf16_f32 v161, v162, v163
ds_write_b64 v15, v[160:161] offset:51200
v_pk_mul_f32 v[232:233], v[48:49], v[232:233] op_sel:[1,0] op_sel_hi:[1,1]
v_pk_mul_f32 v[234:235], v[48:49], v[234:235] op_sel:[1,0] op_sel_hi:[1,1]
v_cvt_pk_bf16_f32 v196, v196, v197
v_cvt_pk_bf16_f32 v197, v198, v199
ds_write_b64 v15, v[196:197] offset:51328
v_cvt_pk_bf16_f32 v232, v232, v233
v_cvt_pk_bf16_f32 v233, v234, v235
ds_write_b64 v15, v[232:233] offset:51456
s_waitcnt lgkmcnt(0)
s_branch Latt_5
Lpf_4:
s_lshl_b32 s43, s35, 7
s_waitcnt lgkmcnt(0)
s_mov_b32 s8, s64
s_mov_b32 s9, s65
s_mov_b32 s10, 4194304
s_mov_b32 s11, 0x20000
s_add_u32 s12, s66, s43
s_addc_u32 s13, s67, 0
s_mov_b32 s14, 6289536
s_mov_b32 s15, 0x20000
s_add_u32 s84, s82, 28311552
s_addc_u32 s85, s83, 0
s_mov_b32 s86, 114688
s_mov_b32 s87, 0x20000
s_mov_b32 s56, s80
s_mov_b32 s57, s81
s_mov_b32 s58, 256
s_mov_b32 s59, 0x20000
v_mov_b32 v5, 0
v_lshlrev_b32 v14, 7, v1
s_or_b32 s43, s34, s35
s_cmp_lg_u32 s43, 0
s_cbranch_scc1 Lz_17
s_movk_i32 s43, 0x2000
buffer_store_dword v5, v14, s[84:87], 0 offen sc1
s_bfm_b64 exec, 44, 0
buffer_store_dword v5, v14, s[84:87], s43 offen sc1
s_mov_b64 exec, 1
v_mov_b32 v6, 1
s_waitcnt vmcnt(0)
buffer_store_dword v6, v5, s[56:59], 0 offen sc1
s_mov_b64 exec, -1
Lz_17:
s_lshl_b32 s43, s51, 11
buffer_load_dwordx4 v[96:99], v10, s[8:11], s43 offen offset:0
buffer_load_dwordx4 v[100:103], v10, s[8:11], s43 offen offset:1024
buffer_load_dwordx4 v[104:107], v10, s[8:11], s43 offen offset:2048
s_branch Lov_3
.p2align 12
.fill 16, 4, 0xbf800000
Lst_3_0:
s_branch Lwr_146
s_nop 0
s_nop 0
Lov_3:
buffer_load_dwordx4 v[108:111], v10, s[8:11], s43 offen offset:3072
v_min_u32 v14, 23, v1
v_lshrrev_b32 v15, 3, v14
v_mul_u32_u24 v15, 43008, v15
v_and_b32 v14, 7, v14
v_lshl_add_u32 v15, v14, 4, v15
v_mov_b32 v32, 0x3f803f80
v_mov_b32 v33, 0x3f803f80
v_mov_b32 v34, 0x3f803f80
v_mov_b32 v35, 0x3f803f80
ds_write_b128 v15, v[32:35]
s_add_u32 s20, s82, 26214400
s_addc_u32 s21, s83, 0
s_mov_b32 s22, 16384
s_mov_b32 s23, 0x20000
s_add_u32 s43, s2, 128
s_lshl_b32 s43, s43, 7
v_lshlrev_b32 v14, 2, v1
s_mov_b64 exec, 15
buffer_store_dword v5, v14, s[84:87], s43 offen sc1
s_mov_b64 exec, -1
s_lshl_b32 s43, s34, 4
s_add_u32 s43, s43, s35
s_lshl_b32 s43, s43, 8
s_add_u32 s43, s43, 49152
v_lshlrev_b32 v14, 7, v1
s_mov_b64 exec, 3
buffer_store_dword v5, v14, s[84:87], s43 offen sc1
s_mov_b64 exec, -1
s_lshl_b32 s52, s34, 7
s_add_u32 s52, s52, 28319744
s_sub_u32 s53, s52, 128
s_cmp_eq_u32 s34, 0
s_cselect_b32 s53, s52, s53
s_waitcnt lgkmcnt(0)
s_barrier
s_waitcnt vmcnt(2)
s_mov_b32 s43, 0x3f803f80
v_mov_b32 v116, 0
v_mov_b32 v117, 0
v_mov_b32 v118, 0
v_mov_b32 v119, 0
v_mov_b32 v120, 0
v_mov_b32 v121, 0
v_mov_b32 v122, 0
v_mov_b32 v123, 0
v_dot2_f32_bf16 v116, v96, s43, v116
v_dot2_f32_bf16 v120, v96, v96, v120
v_dot2_f32_bf16 v118, v104, s43, v118
v_dot2_f32_bf16 v122, v104, v104, v122
v_dot2_f32_bf16 v117, v97, s43, v117
v_dot2_f32_bf16 v121, v97, v97, v121
v_dot2_f32_bf16 v119, v105, s43, v119
v_dot2_f32_bf16 v123, v105, v105, v123
v_dot2_f32_bf16 v116, v98, s43, v116
v_dot2_f32_bf16 v120, v98, v98, v120
v_dot2_f32_bf16 v118, v106, s43, v118
v_dot2_f32_bf16 v122, v106, v106, v122
v_dot2_f32_bf16 v117, v99, s43, v117
v_dot2_f32_bf16 v121, v99, v99, v121
v_dot2_f32_bf16 v119, v107, s43, v119
v_dot2_f32_bf16 v123, v107, v107, v123
v_dot2_f32_bf16 v116, v100, s43, v116
v_dot2_f32_bf16 v120, v100, v100, v120
v_dot2_f32_bf16 v118, v108, s43, v118
v_dot2_f32_bf16 v122, v108, v108, v122
v_dot2_f32_bf16 v117, v101, s43, v117
v_dot2_f32_bf16 v121, v101, v101, v121
v_dot2_f32_bf16 v119, v109, s43, v119
v_dot2_f32_bf16 v123, v109, v109, v123
v_dot2_f32_bf16 v116, v102, s43, v116
v_dot2_f32_bf16 v120, v102, v102, v120
v_dot2_f32_bf16 v118, v110, s43, v118
v_dot2_f32_bf16 v122, v110, v110, v122
v_dot2_f32_bf16 v117, v103, s43, v117
v_dot2_f32_bf16 v121, v103, v103, v121
v_dot2_f32_bf16 v119, v111, s43, v119
v_dot2_f32_bf16 v123, v111, v111, v123
s_nop 2
v_add_f32 v116, v116, v117
v_add_f32 v118, v118, v119
v_add_f32 v120, v120, v121
v_add_f32 v122, v122, v123
s_nop 1
v_permlane32_swap_b32 v116, v118
v_permlane32_swap_b32 v120, v122
v_add_f32 v116, v116, v118
v_add_f32 v120, v120, v122
s_nop 1
v_permlane16_swap_b32 v116, v120
v_add_f32 v116, v116, v120
s_nop 1
v_add_f32_dpp v116, v116, v116 row_ror:8 row_mask:0xf bank_mask:0xf
s_nop 1
v_add_f32_dpp v116, v116, v116 row_ror:4 row_mask:0xf bank_mask:0xf
s_nop 1
v_add_f32_dpp v116, v116, v116 row_ror:2 row_mask:0xf bank_mask:0xf
s_nop 1
v_add_f32_dpp v116, v116, v116 row_ror:1 row_mask:0xf bank_mask:0xf
v_mov_b32 v117, v116
s_nop 1
v_permlane16_swap_b32 v116, v117
v_mul_f32 v112, 0x3a800000, v116
v_mul_f32 v113, 0x3a800000, v117
v_fma_f32 v113, -v112, v112, v113
v_max_f32 v113, 0, v113
v_add_f32 v113, 0x3727c5ac, v113
v_rsq_f32 v113, v113
v_lshrrev_b32 v11, 5, v1
s_lshl_b32 s43, s47, 4
s_add_u32 s43, s43, 148608
v_lshl_add_u32 v11, v11, 3, s43
ds_write_b64 v11, v[112:113]
s_waitcnt lgkmcnt(0)
s_mov_b32 s28, s66
s_mov_b32 s29, s67
s_mov_b32 s30, 6291456
s_mov_b32 s31, 0x20000
s_mul_i32 s43, s33, 7040
s_add_u32 s43, s43, 1179648
v_lshlrev_b32 v30, 7, v1
s_bfm_b64 exec, 55, 0
buffer_load_dword v31, v30, s[28:31], s43 offen
s_mov_b64 exec, -1
s_branch Lst_0_0
Lwr_145:
s_barrier
v_lshlrev_b32 v5, 4, v1
v_and_b32 v5, 63, v5
v_add_u32 v6, 148608, v5
ds_read_b128 v[112:115], v6
s_lshl_b32 s43, s63, 3
v_add_u32 v5, s43, v5
s_waitcnt lgkmcnt(0)
s_mov_b64 exec, 15
buffer_store_dwordx4 v[112:115], v5, s[20:23], 0 offen sc1
s_mov_b64 exec, -1
v_mov_b32 v4, 0
buffer_load_dword v6, v4, s[56:59], 0 offen sc1
s_mov_b32 s62, 0
s_mov_b32 s28, s66
s_mov_b32 s29, s67
s_mov_b32 s30, 6291456
s_mov_b32 s31, 0x20000
s_mul_i32 s43, s33, 15872
s_add_u32 s43, s43, 2752512
v_lshlrev_b32 v30, 7, v1
buffer_load_dword v31, v30, s[28:31], s43 offen
s_add_u32 s43, s43, 8192
s_bfm_b64 exec, 60, 0
buffer_load_dword v31, v30, s[28:31], s43 offen
s_mov_b64 exec, -1
s_lshl_b32 s43, s35, 7
s_add_u32 s28, s68, s43
s_addc_u32 s29, s69, 0
s_mov_b32 s30, 2095232
s_mov_b32 s31, 0x20000
v_and_b32 v29, 7, v1
v_lshrrev_b32 v30, 3, v1
v_lshl_add_u32 v29, v30, 6, v29
s_lshl_b32 s43, s48, 3
v_add_u32 v29, s43, v29
v_lshlrev_b32 v29, 11, v29
s_mov_b32 s43, 1048576
s_mov_b32 s28, s68
s_mov_b32 s29, s69
s_mov_b32 s30, 2097152
s_mov_b32 s31, 0x20000
s_mul_i32 s43, s33, 9472
v_lshlrev_b32 v30, 7, v1
buffer_load_dword v31, v30, s[28:31], s43 offen
s_add_u32 s43, s43, 8192
s_bfm_b64 exec, 10, 0
buffer_load_dword v31, v30, s[28:31], s43 offen
s_mov_b64 exec, -1
s_branch Lst_2_0
Lwr_146:
s_barrier
s_branch Lst_4_0
Lwr_147:
s_barrier
s_branch Lst_6_0
Lwr_148:
s_barrier
s_branch Lst_8_0
Lwr_149:
s_barrier
s_branch Lst_9_0
Lwr_150:
s_barrier
s_cmp_eq_u32 s62, 3
s_cbranch_scc1 Lste_21
s_cmp_eq_u32 s62, 2
s_cbranch_scc1 Lst2_19
s_cmp_ge_u32 s62, 4
s_cbranch_scc1 Lst4_20
s_cmp_eq_u32 s62, 1
s_cbranch_scc1 Lst1_18
s_waitcnt vmcnt(4)
v_readfirstlane_b32 s54, v6
s_cmp_eq_u32 s54, 0
s_cbranch_scc0 Lrep_22
buffer_load_dword v6, v4, s[56:59], 0 offen sc1
s_branch Lste_21
Lrep_22:
s_add_u32 s7, s34, 64
s_lshl_b32 s7, s7, 7
v_mov_b32 v5, s7
v_mov_b32 v6, 1
s_mov_b64 exec, 1
buffer_atomic_add v6, v5, s[84:87], 0 offen sc1
s_mov_b64 exec, -1
s_mov_b32 s62, 1
s_mov_b32 s54, 0
s_mov_b32 s55, 0
s_branch Lste_21
Lst1_18:
s_and_b32 s43, s54, s55
s_cmp_eq_u32 s43, 16
s_cbranch_scc1 Lg_23
s_load_dword s54, s[82:83], s52 glc
s_load_dword s55, s[82:83], s53 glc
s_branch Lste_21
Lg_23:
v_add_u32 v5, 0, v1
v_min_u32 v5, 143, v5
v_lshlrev_b32 v20, 3, v5
v_add_u32 v5, s50, v5
v_max_i32 v5, 0, v5
v_lshlrev_b32 v5, 3, v5
buffer_load_dwordx2 v[32:33], v5, s[20:23], 0 offen sc1
v_add_u32 v5, 64, v1
v_min_u32 v5, 143, v5
v_lshlrev_b32 v21, 3, v5
v_add_u32 v5, s50, v5
v_max_i32 v5, 0, v5
v_lshlrev_b32 v5, 3, v5
buffer_load_dwordx2 v[34:35], v5, s[20:23], 0 offen sc1
v_add_u32 v5, 128, v1
v_min_u32 v5, 143, v5
v_lshlrev_b32 v22, 3, v5
v_add_u32 v5, s50, v5
v_max_i32 v5, 0, v5
v_lshlrev_b32 v5, 3, v5
buffer_load_dwordx2 v[36:37], v5, s[20:23], 0 offen sc1
s_mov_b32 s62, 4
s_branch Lste_21
Lst4_20:
s_mov_b32 s62, 2
s_branch Lste_21
Lst2_19:
s_waitcnt vmcnt(0)
v_add_u32 v20, 147456, v20
ds_write_b64 v20, v[32:33]
v_add_u32 v21, 147456, v21
ds_write_b64 v21, v[34:35]
v_add_u32 v22, 147456, v22
ds_write_b64 v22, v[36:37]
s_waitcnt lgkmcnt(0)
s_mov_b32 s62, 3
Lste_21:
s_branch Lst_10_0
Lwr_151:
s_barrier
s_cmp_eq_u32 s62, 3
s_cbranch_scc1 Lste_27
s_cmp_eq_u32 s62, 2
s_cbranch_scc1 Lst2_25
s_cmp_ge_u32 s62, 4
s_cbranch_scc1 Lst4_26
s_cmp_eq_u32 s62, 1
s_cbranch_scc1 Lst1_24
s_waitcnt vmcnt(0)
v_readfirstlane_b32 s54, v6
s_cmp_eq_u32 s54, 0
s_cbranch_scc0 Lrep_28
buffer_load_dword v6, v4, s[56:59], 0 offen sc1
s_branch Lste_27
Lrep_28:
s_add_u32 s7, s34, 64
s_lshl_b32 s7, s7, 7
v_mov_b32 v5, s7
v_mov_b32 v6, 1
s_mov_b64 exec, 1
buffer_atomic_add v6, v5, s[84:87], 0 offen sc1
s_mov_b64 exec, -1
s_mov_b32 s62, 1
s_mov_b32 s54, 0
s_mov_b32 s55, 0
s_branch Lste_27
Lst1_24:
s_and_b32 s43, s54, s55
s_cmp_eq_u32 s43, 16
s_cbranch_scc1 Lg_29
s_load_dword s54, s[82:83], s52 glc
s_load_dword s55, s[82:83], s53 glc
s_branch Lste_27
Lg_29:
v_add_u32 v5, 0, v1
v_min_u32 v5, 143, v5
v_lshlrev_b32 v20, 3, v5
v_add_u32 v5, s50, v5
v_max_i32 v5, 0, v5
v_lshlrev_b32 v5, 3, v5
buffer_load_dwordx2 v[32:33], v5, s[20:23], 0 offen sc1
v_add_u32 v5, 64, v1
v_min_u32 v5, 143, v5
v_lshlrev_b32 v21, 3, v5
v_add_u32 v5, s50, v5
v_max_i32 v5, 0, v5
v_lshlrev_b32 v5, 3, v5
buffer_load_dwordx2 v[34:35], v5, s[20:23], 0 offen sc1
v_add_u32 v5, 128, v1
v_min_u32 v5, 143, v5
v_lshlrev_b32 v22, 3, v5
v_add_u32 v5, s50, v5
v_max_i32 v5, 0, v5
v_lshlrev_b32 v5, 3, v5
buffer_load_dwordx2 v[36:37], v5, s[20:23], 0 offen sc1
s_mov_b32 s62, 4
s_branch Lste_27
Lst4_26:
s_mov_b32 s62, 2
s_branch Lste_27
Lst2_25:
s_waitcnt vmcnt(0)
v_add_u32 v20, 147456, v20
ds_write_b64 v20, v[32:33]
v_add_u32 v21, 147456, v21
ds_write_b64 v21, v[34:35]
v_add_u32 v22, 147456, v22
ds_write_b64 v22, v[36:37]
s_waitcnt lgkmcnt(0)
s_mov_b32 s62, 3
Lste_27:
s_branch Lst_11_0
Lwr_152:
s_barrier
s_cmp_eq_u32 s62, 3
s_cbranch_scc1 Lste_33
s_cmp_eq_u32 s62, 2
s_cbranch_scc1 Lst2_31
s_cmp_ge_u32 s62, 4
s_cbranch_scc1 Lst4_32
s_cmp_eq_u32 s62, 1
s_cbranch_scc1 Lst1_30
s_waitcnt vmcnt(0)
v_readfirstlane_b32 s54, v6
s_cmp_eq_u32 s54, 0
s_cbranch_scc0 Lrep_34
buffer_load_dword v6, v4, s[56:59], 0 offen sc1
s_branch Lste_33
Lrep_34:
s_add_u32 s7, s34, 64
s_lshl_b32 s7, s7, 7
v_mov_b32 v5, s7
v_mov_b32 v6, 1
s_mov_b64 exec, 1
buffer_atomic_add v6, v5, s[84:87], 0 offen sc1
s_mov_b64 exec, -1
s_mov_b32 s62, 1
s_mov_b32 s54, 0
s_mov_b32 s55, 0
s_branch Lste_33
Lst1_30:
s_and_b32 s43, s54, s55
s_cmp_eq_u32 s43, 16
s_cbranch_scc1 Lg_35
s_load_dword s54, s[82:83], s52 glc
s_load_dword s55, s[82:83], s53 glc
s_branch Lste_33
Lg_35:
v_add_u32 v5, 0, v1
v_min_u32 v5, 143, v5
v_lshlrev_b32 v20, 3, v5
v_add_u32 v5, s50, v5
v_max_i32 v5, 0, v5
v_lshlrev_b32 v5, 3, v5
buffer_load_dwordx2 v[32:33], v5, s[20:23], 0 offen sc1
v_add_u32 v5, 64, v1
v_min_u32 v5, 143, v5
v_lshlrev_b32 v21, 3, v5
v_add_u32 v5, s50, v5
v_max_i32 v5, 0, v5
v_lshlrev_b32 v5, 3, v5
buffer_load_dwordx2 v[34:35], v5, s[20:23], 0 offen sc1
v_add_u32 v5, 128, v1
v_min_u32 v5, 143, v5
v_lshlrev_b32 v22, 3, v5
v_add_u32 v5, s50, v5
v_max_i32 v5, 0, v5
v_lshlrev_b32 v5, 3, v5
buffer_load_dwordx2 v[36:37], v5, s[20:23], 0 offen sc1
s_mov_b32 s62, 4
s_branch Lste_33
Lst4_32:
s_mov_b32 s62, 2
s_branch Lste_33
Lst2_31:
s_waitcnt vmcnt(0)
v_add_u32 v20, 147456, v20
ds_write_b64 v20, v[32:33]
v_add_u32 v21, 147456, v21
ds_write_b64 v21, v[34:35]
v_add_u32 v22, 147456, v22
ds_write_b64 v22, v[36:37]
s_waitcnt lgkmcnt(0)
s_mov_b32 s62, 3
Lste_33:
s_branch Lst_12_0
Lwr_153:
s_barrier
s_cmp_eq_u32 s62, 3
s_cbranch_scc1 Lste_39
s_cmp_eq_u32 s62, 2
s_cbranch_scc1 Lst2_37
s_cmp_ge_u32 s62, 4
s_cbranch_scc1 Lst4_38
s_cmp_eq_u32 s62, 1
s_cbranch_scc1 Lst1_36
s_waitcnt vmcnt(0)
v_readfirstlane_b32 s54, v6
s_cmp_eq_u32 s54, 0
s_cbranch_scc0 Lrep_40
buffer_load_dword v6, v4, s[56:59], 0 offen sc1
s_branch Lste_39
Lrep_40:
s_add_u32 s7, s34, 64
s_lshl_b32 s7, s7, 7
v_mov_b32 v5, s7
v_mov_b32 v6, 1
s_mov_b64 exec, 1
buffer_atomic_add v6, v5, s[84:87], 0 offen sc1
s_mov_b64 exec, -1
s_mov_b32 s62, 1
s_mov_b32 s54, 0
s_mov_b32 s55, 0
s_branch Lste_39
Lst1_36:
s_and_b32 s43, s54, s55
s_cmp_eq_u32 s43, 16
s_cbranch_scc1 Lg_41
s_load_dword s54, s[82:83], s52 glc
s_load_dword s55, s[82:83], s53 glc
s_branch Lste_39
Lg_41:
v_add_u32 v5, 0, v1
v_min_u32 v5, 143, v5
v_lshlrev_b32 v20, 3, v5
v_add_u32 v5, s50, v5
v_max_i32 v5, 0, v5
v_lshlrev_b32 v5, 3, v5
buffer_load_dwordx2 v[32:33], v5, s[20:23], 0 offen sc1
v_add_u32 v5, 64, v1
v_min_u32 v5, 143, v5
v_lshlrev_b32 v21, 3, v5
v_add_u32 v5, s50, v5
v_max_i32 v5, 0, v5
v_lshlrev_b32 v5, 3, v5
buffer_load_dwordx2 v[34:35], v5, s[20:23], 0 offen sc1
v_add_u32 v5, 128, v1
v_min_u32 v5, 143, v5
v_lshlrev_b32 v22, 3, v5
v_add_u32 v5, s50, v5
v_max_i32 v5, 0, v5
v_lshlrev_b32 v5, 3, v5
buffer_load_dwordx2 v[36:37], v5, s[20:23], 0 offen sc1
s_mov_b32 s62, 4
s_branch Lste_39
Lst4_38:
s_mov_b32 s62, 2
s_branch Lste_39
Lst2_37:
s_waitcnt vmcnt(0)
v_add_u32 v20, 147456, v20
ds_write_b64 v20, v[32:33]
v_add_u32 v21, 147456, v21
ds_write_b64 v21, v[34:35]
v_add_u32 v22, 147456, v22
ds_write_b64 v22, v[36:37]
s_waitcnt lgkmcnt(0)
s_mov_b32 s62, 3
Lste_39:
s_branch Lst_13_0
Lwr_154:
s_barrier
s_cmp_eq_u32 s62, 3
s_cbranch_scc1 Lste_45
s_cmp_eq_u32 s62, 2
s_cbranch_scc1 Lst2_43
s_cmp_ge_u32 s62, 4
s_cbranch_scc1 Lst4_44
s_cmp_eq_u32 s62, 1
s_cbranch_scc1 Lst1_42
s_waitcnt vmcnt(0)
v_readfirstlane_b32 s54, v6
s_cmp_eq_u32 s54, 0
s_cbranch_scc0 Lrep_46
buffer_load_dword v6, v4, s[56:59], 0 offen sc1
s_branch Lste_45
Lrep_46:
s_add_u32 s7, s34, 64
s_lshl_b32 s7, s7, 7
v_mov_b32 v5, s7
v_mov_b32 v6, 1
s_mov_b64 exec, 1
buffer_atomic_add v6, v5, s[84:87], 0 offen sc1
s_mov_b64 exec, -1
s_mov_b32 s62, 1
s_mov_b32 s54, 0
s_mov_b32 s55, 0
s_branch Lste_45
Lst1_42:
s_and_b32 s43, s54, s55
s_cmp_eq_u32 s43, 16
s_cbranch_scc1 Lg_47
s_load_dword s54, s[82:83], s52 glc
s_load_dword s55, s[82:83], s53 glc
s_branch Lste_45
Lg_47:
v_add_u32 v5, 0, v1
v_min_u32 v5, 143, v5
v_lshlrev_b32 v20, 3, v5
v_add_u32 v5, s50, v5
v_max_i32 v5, 0, v5
v_lshlrev_b32 v5, 3, v5
buffer_load_dwordx2 v[32:33], v5, s[20:23], 0 offen sc1
v_add_u32 v5, 64, v1
v_min_u32 v5, 143, v5
v_lshlrev_b32 v21, 3, v5
v_add_u32 v5, s50, v5
v_max_i32 v5, 0, v5
v_lshlrev_b32 v5, 3, v5
buffer_load_dwordx2 v[34:35], v5, s[20:23], 0 offen sc1
v_add_u32 v5, 128, v1
v_min_u32 v5, 143, v5
v_lshlrev_b32 v22, 3, v5
v_add_u32 v5, s50, v5
v_max_i32 v5, 0, v5
v_lshlrev_b32 v5, 3, v5
buffer_load_dwordx2 v[36:37], v5, s[20:23], 0 offen sc1
s_mov_b32 s62, 4
s_branch Lste_45
Lst4_44:
s_mov_b32 s62, 2
s_branch Lste_45
Lst2_43:
s_waitcnt vmcnt(0)
v_add_u32 v20, 147456, v20
ds_write_b64 v20, v[32:33]
v_add_u32 v21, 147456, v21
ds_write_b64 v21, v[34:35]
v_add_u32 v22, 147456, v22
ds_write_b64 v22, v[36:37]
s_waitcnt lgkmcnt(0)
s_mov_b32 s62, 3
Lste_45:
s_branch Lst_14_0
Lwr_155:
s_barrier
s_cmp_eq_u32 s62, 3
s_cbranch_scc1 Lste_51
s_cmp_eq_u32 s62, 2
s_cbranch_scc1 Lst2_49
s_cmp_ge_u32 s62, 4
s_cbranch_scc1 Lst4_50
s_cmp_eq_u32 s62, 1
s_cbranch_scc1 Lst1_48
s_waitcnt vmcnt(0)
v_readfirstlane_b32 s54, v6
s_cmp_eq_u32 s54, 0
s_cbranch_scc0 Lrep_52
buffer_load_dword v6, v4, s[56:59], 0 offen sc1
s_branch Lste_51
Lrep_52:
s_add_u32 s7, s34, 64
s_lshl_b32 s7, s7, 7
v_mov_b32 v5, s7
v_mov_b32 v6, 1
s_mov_b64 exec, 1
buffer_atomic_add v6, v5, s[84:87], 0 offen sc1
s_mov_b64 exec, -1
s_mov_b32 s62, 1
s_mov_b32 s54, 0
s_mov_b32 s55, 0
s_branch Lste_51
Lst1_48:
s_and_b32 s43, s54, s55
s_cmp_eq_u32 s43, 16
s_cbranch_scc1 Lg_53
s_load_dword s54, s[82:83], s52 glc
s_load_dword s55, s[82:83], s53 glc
s_branch Lste_51
Lg_53:
v_add_u32 v5, 0, v1
v_min_u32 v5, 143, v5
v_lshlrev_b32 v20, 3, v5
v_add_u32 v5, s50, v5
v_max_i32 v5, 0, v5
v_lshlrev_b32 v5, 3, v5
buffer_load_dwordx2 v[32:33], v5, s[20:23], 0 offen sc1
v_add_u32 v5, 64, v1
v_min_u32 v5, 143, v5
v_lshlrev_b32 v21, 3, v5
v_add_u32 v5, s50, v5
v_max_i32 v5, 0, v5
v_lshlrev_b32 v5, 3, v5
buffer_load_dwordx2 v[34:35], v5, s[20:23], 0 offen sc1
v_add_u32 v5, 128, v1
v_min_u32 v5, 143, v5
v_lshlrev_b32 v22, 3, v5
v_add_u32 v5, s50, v5
v_max_i32 v5, 0, v5
v_lshlrev_b32 v5, 3, v5
buffer_load_dwordx2 v[36:37], v5, s[20:23], 0 offen sc1
s_mov_b32 s62, 4
s_branch Lste_51
Lst4_50:
s_mov_b32 s62, 2
s_branch Lste_51
Lst2_49:
s_waitcnt vmcnt(0)
v_add_u32 v20, 147456, v20
ds_write_b64 v20, v[32:33]
v_add_u32 v21, 147456, v21
ds_write_b64 v21, v[34:35]
v_add_u32 v22, 147456, v22
ds_write_b64 v22, v[36:37]
s_waitcnt lgkmcnt(0)
s_mov_b32 s62, 3
Lste_51:
s_branch Lst_15_0
Lwr_156:
s_barrier
s_cmp_eq_u32 s62, 3
s_cbranch_scc1 Lste_57
s_cmp_eq_u32 s62, 2
s_cbranch_scc1 Lst2_55
s_cmp_ge_u32 s62, 4
s_cbranch_scc1 Lst4_56
s_cmp_eq_u32 s62, 1
s_cbranch_scc1 Lst1_54
s_waitcnt vmcnt(0)
v_readfirstlane_b32 s54, v6
s_cmp_eq_u32 s54, 0
s_cbranch_scc0 Lrep_58
buffer_load_dword v6, v4, s[56:59], 0 offen sc1
s_branch Lste_57
Lrep_58:
s_add_u32 s7, s34, 64
s_lshl_b32 s7, s7, 7
v_mov_b32 v5, s7
v_mov_b32 v6, 1
s_mov_b64 exec, 1
buffer_atomic_add v6, v5, s[84:87], 0 offen sc1
s_mov_b64 exec, -1
s_mov_b32 s62, 1
s_mov_b32 s54, 0
s_mov_b32 s55, 0
s_branch Lste_57
Lst1_54:
s_and_b32 s43, s54, s55
s_cmp_eq_u32 s43, 16
s_cbranch_scc1 Lg_59
s_load_dword s54, s[82:83], s52 glc
s_load_dword s55, s[82:83], s53 glc
s_branch Lste_57
Lg_59:
v_add_u32 v5, 0, v1
v_min_u32 v5, 143, v5
v_lshlrev_b32 v20, 3, v5
v_add_u32 v5, s50, v5
v_max_i32 v5, 0, v5
v_lshlrev_b32 v5, 3, v5
buffer_load_dwordx2 v[32:33], v5, s[20:23], 0 offen sc1
v_add_u32 v5, 64, v1
v_min_u32 v5, 143, v5
v_lshlrev_b32 v21, 3, v5
v_add_u32 v5, s50, v5
v_max_i32 v5, 0, v5
v_lshlrev_b32 v5, 3, v5
buffer_load_dwordx2 v[34:35], v5, s[20:23], 0 offen sc1
v_add_u32 v5, 128, v1
v_min_u32 v5, 143, v5
v_lshlrev_b32 v22, 3, v5
v_add_u32 v5, s50, v5
v_max_i32 v5, 0, v5
v_lshlrev_b32 v5, 3, v5
buffer_load_dwordx2 v[36:37], v5, s[20:23], 0 offen sc1
s_mov_b32 s62, 4
s_branch Lste_57
Lst4_56:
s_mov_b32 s62, 2
s_branch Lste_57
Lst2_55:
s_waitcnt vmcnt(0)
v_add_u32 v20, 147456, v20
ds_write_b64 v20, v[32:33]
v_add_u32 v21, 147456, v21
ds_write_b64 v21, v[34:35]
v_add_u32 v22, 147456, v22
ds_write_b64 v22, v[36:37]
s_waitcnt lgkmcnt(0)
s_mov_b32 s62, 3
Lste_57:
s_branch Lst_16_0
Lwr_157:
s_barrier
s_cmp_eq_u32 s62, 3
s_cbranch_scc1 Lste_63
s_cmp_eq_u32 s62, 2
s_cbranch_scc1 Lst2_61
s_cmp_ge_u32 s62, 4
s_cbranch_scc1 Lst4_62
s_cmp_eq_u32 s62, 1
s_cbranch_scc1 Lst1_60
s_waitcnt vmcnt(0)
v_readfirstlane_b32 s54, v6
s_cmp_eq_u32 s54, 0
s_cbranch_scc0 Lrep_64
buffer_load_dword v6, v4, s[56:59], 0 offen sc1
s_branch Lste_63
Lrep_64:
s_add_u32 s7, s34, 64
s_lshl_b32 s7, s7, 7
v_mov_b32 v5, s7
v_mov_b32 v6, 1
s_mov_b64 exec, 1
buffer_atomic_add v6, v5, s[84:87], 0 offen sc1
s_mov_b64 exec, -1
s_mov_b32 s62, 1
s_mov_b32 s54, 0
s_mov_b32 s55, 0
s_branch Lste_63
Lst1_60:
s_and_b32 s43, s54, s55
s_cmp_eq_u32 s43, 16
s_cbranch_scc1 Lg_65
s_load_dword s54, s[82:83], s52 glc
s_load_dword s55, s[82:83], s53 glc
s_branch Lste_63
Lg_65:
v_add_u32 v5, 0, v1
v_min_u32 v5, 143, v5
v_lshlrev_b32 v20, 3, v5
v_add_u32 v5, s50, v5
v_max_i32 v5, 0, v5
v_lshlrev_b32 v5, 3, v5
buffer_load_dwordx2 v[32:33], v5, s[20:23], 0 offen sc1
v_add_u32 v5, 64, v1
v_min_u32 v5, 143, v5
v_lshlrev_b32 v21, 3, v5
v_add_u32 v5, s50, v5
v_max_i32 v5, 0, v5
v_lshlrev_b32 v5, 3, v5
buffer_load_dwordx2 v[34:35], v5, s[20:23], 0 offen sc1
v_add_u32 v5, 128, v1
v_min_u32 v5, 143, v5
v_lshlrev_b32 v22, 3, v5
v_add_u32 v5, s50, v5
v_max_i32 v5, 0, v5
v_lshlrev_b32 v5, 3, v5
buffer_load_dwordx2 v[36:37], v5, s[20:23], 0 offen sc1
s_mov_b32 s62, 4
s_branch Lste_63
Lst4_62:
s_mov_b32 s62, 2
s_branch Lste_63
Lst2_61:
s_waitcnt vmcnt(0)
v_add_u32 v20, 147456, v20
ds_write_b64 v20, v[32:33]
v_add_u32 v21, 147456, v21
ds_write_b64 v21, v[34:35]
v_add_u32 v22, 147456, v22
ds_write_b64 v22, v[36:37]
s_waitcnt lgkmcnt(0)
s_mov_b32 s62, 3
Lste_63:
s_branch Lst_17_0
Lwr_158:
s_barrier
s_cmp_eq_u32 s62, 3
s_cbranch_scc1 Lste_69
s_cmp_eq_u32 s62, 2
s_cbranch_scc1 Lst2_67
s_cmp_ge_u32 s62, 4
s_cbranch_scc1 Lst4_68
s_cmp_eq_u32 s62, 1
s_cbranch_scc1 Lst1_66
s_waitcnt vmcnt(0)
v_readfirstlane_b32 s54, v6
s_cmp_eq_u32 s54, 0
s_cbranch_scc0 Lrep_70
buffer_load_dword v6, v4, s[56:59], 0 offen sc1
s_branch Lste_69
Lrep_70:
s_add_u32 s7, s34, 64
s_lshl_b32 s7, s7, 7
v_mov_b32 v5, s7
v_mov_b32 v6, 1
s_mov_b64 exec, 1
buffer_atomic_add v6, v5, s[84:87], 0 offen sc1
s_mov_b64 exec, -1
s_mov_b32 s62, 1
s_mov_b32 s54, 0
s_mov_b32 s55, 0
s_branch Lste_69
Lst1_66:
s_and_b32 s43, s54, s55
s_cmp_eq_u32 s43, 16
s_cbranch_scc1 Lg_71
s_load_dword s54, s[82:83], s52 glc
s_load_dword s55, s[82:83], s53 glc
s_branch Lste_69
Lg_71:
v_add_u32 v5, 0, v1
v_min_u32 v5, 143, v5
v_lshlrev_b32 v20, 3, v5
v_add_u32 v5, s50, v5
v_max_i32 v5, 0, v5
v_lshlrev_b32 v5, 3, v5
buffer_load_dwordx2 v[32:33], v5, s[20:23], 0 offen sc1
v_add_u32 v5, 64, v1
v_min_u32 v5, 143, v5
v_lshlrev_b32 v21, 3, v5
v_add_u32 v5, s50, v5
v_max_i32 v5, 0, v5
v_lshlrev_b32 v5, 3, v5
buffer_load_dwordx2 v[34:35], v5, s[20:23], 0 offen sc1
v_add_u32 v5, 128, v1
v_min_u32 v5, 143, v5
v_lshlrev_b32 v22, 3, v5
v_add_u32 v5, s50, v5
v_max_i32 v5, 0, v5
v_lshlrev_b32 v5, 3, v5
s_branch Lov_4
.p2align 12
.fill 32, 4, 0xbf800000
Lst_4_0:
s_branch Lst_5_0
s_nop 0
s_nop 0
Lov_4:
buffer_load_dwordx2 v[36:37], v5, s[20:23], 0 offen sc1
s_mov_b32 s62, 4
s_branch Lste_69
Lst4_68:
s_mov_b32 s62, 2
s_branch Lste_69
Lst2_67:
s_waitcnt vmcnt(0)
v_add_u32 v20, 147456, v20
ds_write_b64 v20, v[32:33]
v_add_u32 v21, 147456, v21
ds_write_b64 v21, v[34:35]
v_add_u32 v22, 147456, v22
ds_write_b64 v22, v[36:37]
s_waitcnt lgkmcnt(0)
s_mov_b32 s62, 3
Lste_69:
s_branch Lst_18_0
Lwr_159:
s_barrier
s_cmp_eq_u32 s62, 3
s_cbranch_scc1 Lste_74
s_cmp_ge_u32 s62, 5
s_cbranch_scc1 Lg_79
s_cmp_ge_u32 s62, 2
s_cbranch_scc1 Lst2_73
s_cmp_eq_u32 s62, 1
s_cbranch_scc1 Lst1_72
s_mov_b32 s41, 0x40000
Lz0_75:
s_waitcnt vmcnt(0)
v_readfirstlane_b32 s54, v6
s_cmp_eq_u32 s54, 0
s_cbranch_scc0 Lzok_76
buffer_load_dword v6, v4, s[56:59], 0 offen sc1
s_sub_u32 s41, s41, 1
s_cmp_lg_u32 s41, 0
s_cbranch_scc1 Lz0_75
s_waitcnt lgkmcnt(0)
Lzok_76:
s_add_u32 s7, s34, 64
s_lshl_b32 s7, s7, 7
v_mov_b32 v5, s7
v_mov_b32 v6, 1
s_mov_b64 exec, 1
buffer_atomic_add v6, v5, s[84:87], 0 offen sc1
s_mov_b64 exec, -1
Lst1_72:
s_load_dword s54, s[82:83], s52 glc
s_load_dword s55, s[82:83], s53 glc
s_mov_b32 s41, 0x40000
Lpoll_77:
s_waitcnt lgkmcnt(0)
s_and_b32 s54, s54, s55
s_cmp_eq_u32 s54, 16
s_cbranch_scc1 Lg_79
s_load_dword s54, s[82:83], s52 glc
s_load_dword s55, s[82:83], s53 glc
s_sub_u32 s41, s41, 1
s_cmp_lg_u32 s41, 0
s_cbranch_scc1 Lpoll_77
s_waitcnt lgkmcnt(0)
Lg_79:
v_add_u32 v5, 0, v1
v_min_u32 v5, 143, v5
v_lshlrev_b32 v20, 3, v5
v_add_u32 v5, s50, v5
v_max_i32 v5, 0, v5
v_lshlrev_b32 v5, 3, v5
buffer_load_dwordx2 v[32:33], v5, s[20:23], 0 offen sc1
v_add_u32 v5, 64, v1
v_min_u32 v5, 143, v5
v_lshlrev_b32 v21, 3, v5
v_add_u32 v5, s50, v5
v_max_i32 v5, 0, v5
v_lshlrev_b32 v5, 3, v5
buffer_load_dwordx2 v[34:35], v5, s[20:23], 0 offen sc1
v_add_u32 v5, 128, v1
v_min_u32 v5, 143, v5
v_lshlrev_b32 v22, 3, v5
v_add_u32 v5, s50, v5
v_max_i32 v5, 0, v5
v_lshlrev_b32 v5, 3, v5
buffer_load_dwordx2 v[36:37], v5, s[20:23], 0 offen sc1
Lst2_73:
s_waitcnt vmcnt(0)
v_add_u32 v20, 147456, v20
ds_write_b64 v20, v[32:33]
v_add_u32 v21, 147456, v21
ds_write_b64 v21, v[34:35]
v_add_u32 v22, 147456, v22
ds_write_b64 v22, v[36:37]
s_waitcnt lgkmcnt(0)
Lste_74:
s_bitcmp0_b32 s2, 0
s_cselect_b32 s88, s72, s74
s_cselect_b32 s89, s73, s75
s_cmp_lt_u32 s2, 192
s_cselect_b32 s90, 7340032, 0
s_mov_b32 s91, 0x20000
s_bfe_u32 s44, s2, 0x30001
s_lshl_b32 s44, s44, 2
s_and_b32 s43, s36, 3
s_add_u32 s44, s44, s43
s_lshl_b32 s44, s44, 5
v_lshrrev_b32 v18, 4, v1
v_add_u32 v18, s44, v18
v_mul_u32_u24 v18, 7168, v18
v_and_b32 v19, 15, v1
v_lshl_add_u32 v18, v19, 4, v18
s_lshr_b32 s43, s2, 4
s_lshl_b32 s43, s43, 8
s_add_u32 s43, s43, 4096
v_add_u32 v18, s43, v18
s_mov_b32 s43, 0
buffer_load_dwordx4 v[128:131], v18, s[88:91], s43 offen
s_mov_b32 s43, 28672
buffer_load_dwordx4 v[132:135], v18, s[88:91], s43 offen
s_mov_b32 s43, 57344
buffer_load_dwordx4 v[136:139], v18, s[88:91], s43 offen
s_mov_b32 s43, 86016
buffer_load_dwordx4 v[140:143], v18, s[88:91], s43 offen
s_mov_b32 s43, 114688
buffer_load_dwordx4 v[144:147], v18, s[88:91], s43 offen
s_mov_b32 s43, 143360
buffer_load_dwordx4 v[148:151], v18, s[88:91], s43 offen
s_mov_b32 s43, 172032
buffer_load_dwordx4 v[152:155], v18, s[88:91], s43 offen
s_mov_b32 s43, 200704
buffer_load_dwordx4 v[156:159], v18, s[88:91], s43 offen
s_barrier
s_lshl_b32 s43, s35, 7
s_add_u32 s28, s68, s43
s_addc_u32 s29, s69, 0
s_mov_b32 s30, 2095232
s_mov_b32 s31, 0x20000
v_lshrrev_b32 v15, 3, v1
v_and_b32 v16, 6, v15
v_and_b32 v7, 7, v1
v_xor_b32 v7, v7, v16
v_lshlrev_b32 v7, 4, v7
v_mul_u32_u24 v15, 2048, v15
v_add_u32 v7, v7, v15
s_and_b32 s40, s36, 3
s_lshl_b32 s39, s40, 13
s_add_u32 s40, s40, s35
s_add_u32 s42, s40, 0
s_and_b32 s42, s42, 15
s_lshl_b32 s42, s42, 17
s_add_u32 m0, s39, 65536
s_add_u32 s43, s42, 0
buffer_load_dwordx4 v7, s[28:31], s43 offen lds
s_add_u32 m0, s39, 66560
s_add_u32 s43, s42, 16384
buffer_load_dwordx4 v7, s[28:31], s43 offen lds
s_add_u32 m0, s39, 67584
s_add_u32 s43, s42, 32768
buffer_load_dwordx4 v7, s[28:31], s43 offen lds
s_add_u32 m0, s39, 68608
s_add_u32 s43, s42, 49152
buffer_load_dwordx4 v7, s[28:31], s43 offen lds
s_add_u32 m0, s39, 69632
s_add_u32 s43, s42, 65536
buffer_load_dwordx4 v7, s[28:31], s43 offen lds
s_add_u32 m0, s39, 70656
s_add_u32 s43, s42, 81920
buffer_load_dwordx4 v7, s[28:31], s43 offen lds
s_add_u32 m0, s39, 71680
s_add_u32 s43, s42, 98304
buffer_load_dwordx4 v7, s[28:31], s43 offen lds
s_add_u32 m0, s39, 72704
s_add_u32 s43, s42, 114688
buffer_load_dwordx4 v7, s[28:31], s43 offen lds
Lats_6:
s_and_b32 s43, s36, 1
s_bfe_u32 s44, s36, 0x10001
s_lshr_b32 s45, s36, 2
v_lshlrev_b32 v14, 2, v13
v_sub_u32 v14, v12, v14
v_mov_b32 v16, 0xff800000
s_or_b32 s46, s34, s45
s_cmp_lg_u32 s46, 0
s_cselect_b32 s46, 0, 0xff800000
v_subrev_u32 v15, 0, v14
v_cmp_ge_u32 vcc, 7, v15
v_add_u32 v15, 16, v15
s_nop 0
v_cndmask_b32 v248, v16, 0, vcc
v_cmp_ge_u32 vcc, 7, v15
s_nop 1
v_cndmask_b32 v244, v16, 0, vcc
v_or_b32 v240, s46, v244
v_subrev_u32 v15, 1, v14
v_cmp_ge_u32 vcc, 7, v15
v_add_u32 v15, 16, v15
s_nop 0
v_cndmask_b32 v249, v16, 0, vcc
v_cmp_ge_u32 vcc, 7, v15
s_nop 1
v_cndmask_b32 v245, v16, 0, vcc
v_or_b32 v241, s46, v245
v_subrev_u32 v15, 2, v14
v_cmp_ge_u32 vcc, 7, v15
v_add_u32 v15, 16, v15
s_nop 0
v_cndmask_b32 v250, v16, 0, vcc
v_cmp_ge_u32 vcc, 7, v15
s_nop 1
v_cndmask_b32 v246, v16, 0, vcc
v_or_b32 v242, s46, v246
v_subrev_u32 v15, 3, v14
v_cmp_ge_u32 vcc, 7, v15
v_add_u32 v15, 16, v15
s_nop 0
v_cndmask_b32 v251, v16, 0, vcc
v_cmp_ge_u32 vcc, 7, v15
s_nop 1
v_cndmask_b32 v247, v16, 0, vcc
v_or_b32 v243, s46, v247
s_lshl_b32 s46, s45, 6
s_add_u32 s46, s46, s44
s_add_u32 s46, s46, 16
v_lshl_add_u32 v14, v12, 1, s46
s_lshl_b32 s47, s43, 6
v_lshl_add_u32 v15, v13, 4, s47
v_mul_u32_u24 v20, 400, v14
v_add_u32 v20, v20, v15
v_subrev_u32 v16, 32, v14
v_max_i32 v16, 0, v16
v_mul_u32_u24 v21, 400, v16
v_add_u32 v21, v21, v15
v_lshrrev_b32 v16, 2, v12
v_lshl_add_u32 v16, v13, 2, v16
v_lshl_add_u32 v16, v16, 1, s46
v_and_b32 v17, 3, v1
v_lshl_add_u32 v17, v17, 3, s47
v_mul_u32_u24 v22, 400, v16
v_add_u32 v22, v22, v17
v_subrev_u32 v16, 32, v16
v_max_i32 v16, 0, v16
v_mul_u32_u24 v23, 400, v16
v_add_u32 v23, v23, v17
s_mul_i32 s60, s34, 262144
s_add_u32 s16, s82, s60
s_addc_u32 s17, s83, 0
s_mov_b32 s18, 262144
s_mov_b32 s19, 0x20000
s_lshl_b32 s60, s35, 14
s_lshl_b32 s43, s43, 13
s_add_u32 s60, s60, s43
s_lshl_b32 s43, s45, 12
s_add_u32 s60, s60, s43
s_lshl_b32 s43, s44, 10
s_add_u32 s60, s60, s43
v_lshlrev_b32 v24, 4, v1
s_mov_b32 s61, 0x3e8293ee
s_lshl_b32 s38, s35, 7
Latt_5:
s_barrier
ds_read_b128 v[32:35], v20 offset:0
ds_read_b128 v[36:39], v20 offset:128
ds_read_b128 v[40:43], v21 offset:128
ds_read_b128 v[80:83], v20 offset:12800
ds_read_b128 v[84:87], v20 offset:12928
ds_read_b128 v[88:91], v20 offset:128
ds_read_b64_tr_b16 v[44:45], v23 offset:256
ds_read_b64_tr_b16 v[46:47], v22 offset:256
ds_read_b64_tr_b16 v[48:49], v23 offset:288
ds_read_b64_tr_b16 v[50:51], v22 offset:288
ds_read_b64_tr_b16 v[92:93], v22 offset:256
ds_read_b64_tr_b16 v[94:95], v22 offset:13056
ds_read_b64_tr_b16 v[96:97], v22 offset:288
ds_read_b64_tr_b16 v[98:99], v22 offset:13088
s_waitcnt lgkmcnt(11)
v_mfma_f32_16x16x32_bf16 v[52:55], v[40:43], v[32:35], v[240:243]
v_mfma_f32_16x16x32_bf16 v[56:59], v[36:39], v[32:35], v[248:251]
s_waitcnt lgkmcnt(8)
v_mfma_f32_16x16x32_bf16 v[100:103], v[88:91], v[80:83], v[244:247]
v_mfma_f32_16x16x32_bf16 v[104:107], v[84:87], v[80:83], v[248:251]
s_nop 5
v_max3_f32 v60, v52, v53, v54
v_max3_f32 v108, v100, v101, v102
v_max3_f32 v61, v55, v56, v57
v_max3_f32 v109, v103, v104, v105
v_max3_f32 v60, v60, v58, v59
v_max3_f32 v108, v108, v106, v107
v_max_f32 v60, v60, v61
v_max_f32 v108, v108, v109
s_nop 1
v_permlane32_swap_b32 v60, v108
v_max_f32 v60, v60, v108
v_mov_b32 v61, v60
s_nop 1
v_permlane16_swap_b32 v60, v61
v_max_f32 v60, v60, v61
v_mul_f32 v60, s61, v60
s_nop 0
v_mov_b32 v108, v60
s_nop 1
v_permlane32_swap_b32 v60, v108
v_fma_f32 v52, v52, s61, -v60
v_fma_f32 v100, v100, s61, -v108
v_fma_f32 v53, v53, s61, -v60
v_fma_f32 v101, v101, s61, -v108
v_fma_f32 v54, v54, s61, -v60
v_fma_f32 v102, v102, s61, -v108
v_fma_f32 v55, v55, s61, -v60
v_fma_f32 v103, v103, s61, -v108
v_fma_f32 v56, v56, s61, -v60
v_fma_f32 v104, v104, s61, -v108
v_fma_f32 v57, v57, s61, -v60
v_fma_f32 v105, v105, s61, -v108
v_fma_f32 v58, v58, s61, -v60
v_fma_f32 v106, v106, s61, -v108
v_fma_f32 v59, v59, s61, -v60
v_fma_f32 v107, v107, s61, -v108
v_exp_f32 v52, v52
v_exp_f32 v100, v100
v_exp_f32 v53, v53
v_exp_f32 v101, v101
v_exp_f32 v54, v54
v_exp_f32 v102, v102
v_exp_f32 v55, v55
v_exp_f32 v103, v103
v_exp_f32 v56, v56
v_exp_f32 v104, v104
v_exp_f32 v57, v57
v_exp_f32 v105, v105
v_exp_f32 v58, v58
v_exp_f32 v106, v106
v_exp_f32 v59, v59
v_exp_f32 v107, v107
v_cvt_pk_bf16_f32 v64, v52, v53
v_cvt_pk_bf16_f32 v112, v100, v101
v_cvt_pk_bf16_f32 v65, v54, v55
v_cvt_pk_bf16_f32 v113, v102, v103
v_cvt_pk_bf16_f32 v66, v56, v57
v_cvt_pk_bf16_f32 v114, v104, v105
v_cvt_pk_bf16_f32 v67, v58, v59
v_cvt_pk_bf16_f32 v115, v106, v107
v_pk_add_f32 v[52:53], v[52:53], v[54:55]
v_pk_add_f32 v[100:101], v[100:101], v[102:103]
v_pk_add_f32 v[56:57], v[56:57], v[58:59]
v_pk_add_f32 v[104:105], v[104:105], v[106:107]
s_waitcnt lgkmcnt(0)
s_waitcnt lgkmcnt(0)
v_mfma_f32_16x16x32_bf16 v[68:71], v[44:47], v[64:67], 0
v_mfma_f32_16x16x32_bf16 v[116:119], v[92:95], v[112:115], 0
v_mfma_f32_16x16x32_bf16 v[72:75], v[48:51], v[64:67], 0
v_mfma_f32_16x16x32_bf16 v[120:123], v[96:99], v[112:115], 0
v_pk_add_f32 v[52:53], v[52:53], v[56:57]
v_pk_add_f32 v[100:101], v[100:101], v[104:105]
v_add_f32 v60, v52, v53
v_add_f32 v108, v100, v101
s_nop 1
v_permlane32_swap_b32 v60, v108
v_add_f32 v60, v60, v108
v_mov_b32 v61, v60
s_nop 1
v_permlane16_swap_b32 v60, v61
v_add_f32 v60, v60, v61
v_rcp_f32 v60, v60
s_nop 0
v_mov_b32 v108, v60
s_nop 1
v_permlane32_swap_b32 v60, v108
v_pk_mul_f32 v[68:69], v[60:61], v[68:69] op_sel_hi:[0,1]
v_pk_mul_f32 v[116:117], v[108:109], v[116:117] op_sel_hi:[0,1]
v_pk_mul_f32 v[70:71], v[60:61], v[70:71] op_sel_hi:[0,1]
v_pk_mul_f32 v[118:119], v[108:109], v[118:119] op_sel_hi:[0,1]
v_pk_mul_f32 v[72:73], v[60:61], v[72:73] op_sel_hi:[0,1]
v_pk_mul_f32 v[120:121], v[108:109], v[120:121] op_sel_hi:[0,1]
v_pk_mul_f32 v[74:75], v[60:61], v[74:75] op_sel_hi:[0,1]
v_pk_mul_f32 v[122:123], v[108:109], v[122:123] op_sel_hi:[0,1]
v_cvt_pk_bf16_f32 v64, v68, v69
v_cvt_pk_bf16_f32 v112, v116, v117
v_cvt_pk_bf16_f32 v65, v70, v71
v_cvt_pk_bf16_f32 v113, v118, v119
v_cvt_pk_bf16_f32 v66, v72, v73
v_cvt_pk_bf16_f32 v114, v120, v121
v_cvt_pk_bf16_f32 v67, v74, v75
v_cvt_pk_bf16_f32 v115, v122, v123
buffer_store_dwordx4 v[64:67], v24, s[16:19], s60 offen offset:0 sc1
buffer_store_dwordx4 v[112:115], v24, s[16:19], s60 offen offset:2048 sc1
s_add_u32 s56, s82, 28311552
s_addc_u32 s57, s83, 0
s_mov_b32 s58, 114688
s_mov_b32 s59, 0x20000
s_lshl_b32 s7, s34, 12
s_add_u32 s7, s7, 49152
v_lshl_add_u32 v26, v1, 8, s7
v_mov_b32 v27, 1
s_cmp_ge_u32 s36, 4
s_cbranch_scc1 Lh_81
s_waitcnt vmcnt(0)
s_branch Lo_80
Lh_81:
s_waitcnt vmcnt(0)
Lo_80:
s_cmp_lg_u32 s36, 0
s_barrier
s_cbranch_scc1 Lsig_82
s_mov_b64 exec, 0xffff
buffer_atomic_add v27, v26, s[56:59], 0 offen sc1
s_mov_b64 exec, -1
Lsig_82:
s_cmp_ge_u32 s36, 4
s_cbranch_scc1 Lprod_84
v_and_b32 v12, 15, v1
v_lshrrev_b32 v13, 4, v1
v_lshlrev_b32 v10, 12, v12
v_and_b32 v14, 1, v13
v_lshl_add_u32 v10, v14, 5, v10
v_lshrrev_b32 v14, 1, v13
v_lshl_add_u32 v10, v14, 4, v10
s_lshl_b32 s43, s34, 18
s_lshl_b32 s44, s36, 16
s_add_u32 s43, s43, s44
s_lshl_b32 s44, s35, 7
s_add_u32 s43, s43, s44
buffer_load_dwordx4 v[128:131], v10, s[8:11], s43 offen offset:0
buffer_load_dwordx4 v[132:135], v10, s[8:11], s43 offen offset:64
buffer_load_dwordx4 v[136:139], v10, s[8:11], s43 offen offset:2048
buffer_load_dwordx4 v[140:143], v10, s[8:11], s43 offen offset:2112
v_and_b32 v12, 15, v1
v_lshrrev_b32 v13, 4, v1
s_mul_i32 s43, s34, 262144
s_add_u32 s20, s82, s43
s_addc_u32 s21, s83, 0
s_add_u32 s20, s20, 4194304
s_addc_u32 s21, s21, 0
s_mov_b32 s22, 262144
s_mov_b32 s23, 0x20000
s_mul_i32 s43, s34, 16384
s_add_u32 s24, s82, s43
s_addc_u32 s25, s83, 0
s_add_u32 s24, s24, 25165824
s_addc_u32 s25, s25, 0
s_mov_b32 s26, 16384
s_mov_b32 s27, 0x20000
v_lshlrev_b32 v11, 4, v1
s_lshl_b32 s43, s36, 11
v_add_u32 v2, s43, v11
v_add_u32 v3, 98304, v2
v_lshrrev_b32 v14, 2, v1
v_bfe_u32 v15, v14, 1, 2
v_mul_u32_u24 v14, 128, v14
v_lshl_add_u32 v14, v15, 5, v14
v_and_b32 v15, 3, v1
v_lshl_add_u32 v4, v15, 3, v14
v_xor_b32 v5, 32, v4
v_xor_b32 v6, 64, v4
v_xor_b32 v7, 96, v4
v_add_u32 v16, 0x10000, v4
v_add_u32 v20, 0x20000, v4
v_add_u32 v17, 0x10000, v5
v_add_u32 v21, 0x20000, v5
v_add_u32 v18, 0x10000, v6
v_add_u32 v22, 0x20000, v6
v_add_u32 v19, 0x10000, v7
v_add_u32 v23, 0x20000, v7
s_lshl_b32 s44, s35, 14
s_add_u32 s60, s44, s43
v_lshrrev_b32 v14, 1, v13
v_lshlrev_b32 v14, 11, v14
v_lshl_add_u32 v14, v12, 3, v14
v_and_b32 v15, 1, v13
v_lshl_add_u32 v14, v15, 2, v14
s_lshl_b32 s43, s36, 12
s_lshl_b32 s44, s35, 7
s_add_u32 s43, s43, s44
v_add_u32 v9, s43, v14
s_mov_b32 s61, 0x3f803f80
s_waitcnt vmcnt(0)
v_permlane16_swap_b32 v128, v130
v_permlane16_swap_b32 v129, v131
v_permlane16_swap_b32 v132, v134
v_permlane16_swap_b32 v133, v135
v_permlane16_swap_b32 v136, v138
v_permlane16_swap_b32 v137, v139
v_permlane16_swap_b32 v140, v142
v_permlane16_swap_b32 v141, v143
v_lshlrev_b32 v96, 16, v128
v_and_b32 v97, 0xffff0000, v128
v_lshlrev_b32 v98, 16, v129
v_and_b32 v99, 0xffff0000, v129
v_lshlrev_b32 v100, 16, v130
v_and_b32 v101, 0xffff0000, v130
v_lshlrev_b32 v102, 16, v131
v_and_b32 v103, 0xffff0000, v131
v_lshlrev_b32 v104, 16, v132
v_and_b32 v105, 0xffff0000, v132
v_lshlrev_b32 v106, 16, v133
v_and_b32 v107, 0xffff0000, v133
v_lshlrev_b32 v108, 16, v134
v_and_b32 v109, 0xffff0000, v134
v_lshlrev_b32 v110, 16, v135
v_and_b32 v111, 0xffff0000, v135
v_lshlrev_b32 v112, 16, v136
v_and_b32 v113, 0xffff0000, v136
v_lshlrev_b32 v114, 16, v137
v_and_b32 v115, 0xffff0000, v137
v_lshlrev_b32 v116, 16, v138
v_and_b32 v117, 0xffff0000, v138
v_lshlrev_b32 v118, 16, v139
v_and_b32 v119, 0xffff0000, v139
v_lshlrev_b32 v120, 16, v140
v_and_b32 v121, 0xffff0000, v140
v_lshlrev_b32 v122, 16, v141
v_and_b32 v123, 0xffff0000, v141
v_lshlrev_b32 v124, 16, v142
v_and_b32 v125, 0xffff0000, v142
v_lshlrev_b32 v126, 16, v143
v_and_b32 v127, 0xffff0000, v143
s_cmp_lg_u32 s36, 0
s_cbranch_scc1 Lwm_87
s_nop 0
s_branch Lwe_86
Lwm_87:
s_cmp_lg_u32 s36, 1
s_cbranch_scc1 Lwm_88
s_nop 0
s_branch Lwe_86
Lwm_88:
s_cmp_lg_u32 s36, 2
s_cbranch_scc1 Lwm_89
s_nop 0
s_branch Lwe_86
Lwm_89:
s_cmp_lg_u32 s36, 3
s_cbranch_scc1 Lwm_90
s_nop 0
s_branch Lwe_86
Lwm_90:
Lwe_86:
s_barrier
ds_read_b128 v[32:35], v2 offset:0
ds_read_b64_tr_b16 v[40:41], v16 offset:0
ds_read_b64_tr_b16 v[42:43], v16 offset:2048
ds_read_b64_tr_b16 v[44:45], v17 offset:0
ds_read_b64_tr_b16 v[46:47], v17 offset:2048
ds_read_b64_tr_b16 v[48:49], v18 offset:0
ds_read_b64_tr_b16 v[50:51], v18 offset:2048
ds_read_b64_tr_b16 v[52:53], v19 offset:0
ds_read_b64_tr_b16 v[54:55], v19 offset:2048
ds_read_b128 v[36:39], v2 offset:1024
ds_read_b128 v[56:59], v2 offset:8192
ds_read_b64_tr_b16 v[64:65], v16 offset:4096
ds_read_b64_tr_b16 v[66:67], v16 offset:6144
ds_read_b64_tr_b16 v[68:69], v17 offset:4096
ds_read_b64_tr_b16 v[70:71], v17 offset:6144
ds_read_b64_tr_b16 v[72:73], v18 offset:4096
ds_read_b64_tr_b16 v[74:75], v18 offset:6144
ds_read_b64_tr_b16 v[76:77], v19 offset:4096
ds_read_b64_tr_b16 v[78:79], v19 offset:6144
ds_read_b128 v[60:63], v2 offset:9216
s_waitcnt lgkmcnt(0)
s_barrier
v_mfma_f32_16x16x32_bf16 v[96:99], v[40:43], v[32:35], v[96:99]
ds_read_b128 v[144:147], v2 offset:49152
ds_read_b64_tr_b16 v[152:153], v16 offset:8192
v_mfma_f32_16x16x32_bf16 v[100:103], v[44:47], v[32:35], v[100:103]
ds_read_b64_tr_b16 v[154:155], v16 offset:10240
ds_read_b64_tr_b16 v[156:157], v17 offset:8192
v_mfma_f32_16x16x32_bf16 v[104:107], v[48:51], v[32:35], v[104:107]
ds_read_b64_tr_b16 v[158:159], v17 offset:10240
ds_read_b64_tr_b16 v[160:161], v18 offset:8192
v_mfma_f32_16x16x32_bf16 v[108:111], v[52:55], v[32:35], v[108:111]
ds_read_b64_tr_b16 v[162:163], v18 offset:10240
ds_read_b64_tr_b16 v[164:165], v19 offset:8192
v_mfma_f32_16x16x32_bf16 v[124:127], v[52:55], v[36:39], v[124:127]
ds_read_b64_tr_b16 v[166:167], v19 offset:10240
ds_read_b128 v[148:151], v2 offset:50176
v_mfma_f32_16x16x32_bf16 v[120:123], v[48:51], v[36:39], v[120:123]
ds_read_b128 v[168:171], v2 offset:57344
ds_read_b64_tr_b16 v[176:177], v16 offset:12288
v_mfma_f32_16x16x32_bf16 v[116:119], v[44:47], v[36:39], v[116:119]
ds_read_b64_tr_b16 v[178:179], v16 offset:14336
ds_read_b64_tr_b16 v[180:181], v17 offset:12288
v_mfma_f32_16x16x32_bf16 v[112:115], v[40:43], v[36:39], v[112:115]
ds_read_b64_tr_b16 v[182:183], v17 offset:14336
ds_read_b64_tr_b16 v[184:185], v18 offset:12288
v_mfma_f32_16x16x32_bf16 v[96:99], v[64:67], v[56:59], v[96:99]
ds_read_b64_tr_b16 v[186:187], v18 offset:14336
ds_read_b64_tr_b16 v[188:189], v19 offset:12288
v_mfma_f32_16x16x32_bf16 v[100:103], v[68:71], v[56:59], v[100:103]
ds_read_b64_tr_b16 v[190:191], v19 offset:14336
ds_read_b128 v[172:175], v2 offset:58368
v_mfma_f32_16x16x32_bf16 v[104:107], v[72:75], v[56:59], v[104:107]
s_bitcmp0_b32 s36, 1
v_mfma_f32_16x16x32_bf16 v[108:111], v[76:79], v[56:59], v[108:111]
s_cselect_b32 s44, s72, s74
v_mfma_f32_16x16x32_bf16 v[124:127], v[76:79], v[60:63], v[124:127]
s_cselect_b32 s45, s73, s75
v_mfma_f32_16x16x32_bf16 v[120:123], v[72:75], v[60:63], v[120:123]
s_mul_i32 s43, s35, 192
v_mfma_f32_16x16x32_bf16 v[116:119], v[68:71], v[60:63], v[116:119]
s_add_u32 s16, s44, s43
v_mfma_f32_16x16x32_bf16 v[112:115], v[64:67], v[60:63], v[112:115]
s_addc_u32 s17, s45, 0
s_waitcnt lgkmcnt(0)
s_barrier
v_mfma_f32_16x16x32_bf16 v[96:99], v[152:155], v[144:147], v[96:99]
ds_read_b128 v[32:35], v3 offset:0
ds_read_b64_tr_b16 v[40:41], v16 offset:16384
v_mfma_f32_16x16x32_bf16 v[100:103], v[156:159], v[144:147], v[100:103]
ds_read_b64_tr_b16 v[42:43], v16 offset:18432
ds_read_b64_tr_b16 v[44:45], v17 offset:16384
v_mfma_f32_16x16x32_bf16 v[104:107], v[160:163], v[144:147], v[104:107]
ds_read_b64_tr_b16 v[46:47], v17 offset:18432
ds_read_b64_tr_b16 v[48:49], v18 offset:16384
v_mfma_f32_16x16x32_bf16 v[108:111], v[164:167], v[144:147], v[108:111]
ds_read_b64_tr_b16 v[50:51], v18 offset:18432
ds_read_b64_tr_b16 v[52:53], v19 offset:16384
v_mfma_f32_16x16x32_bf16 v[124:127], v[164:167], v[148:151], v[124:127]
ds_read_b64_tr_b16 v[54:55], v19 offset:18432
ds_read_b128 v[36:39], v3 offset:1024
v_mfma_f32_16x16x32_bf16 v[120:123], v[160:163], v[148:151], v[120:123]
ds_read_b128 v[56:59], v3 offset:8192
ds_read_b64_tr_b16 v[64:65], v16 offset:20480
v_mfma_f32_16x16x32_bf16 v[116:119], v[156:159], v[148:151], v[116:119]
ds_read_b64_tr_b16 v[66:67], v16 offset:22528
ds_read_b64_tr_b16 v[68:69], v17 offset:20480
v_mfma_f32_16x16x32_bf16 v[112:115], v[152:155], v[148:151], v[112:115]
ds_read_b64_tr_b16 v[70:71], v17 offset:22528
ds_read_b64_tr_b16 v[72:73], v18 offset:20480
v_mfma_f32_16x16x32_bf16 v[96:99], v[176:179], v[168:171], v[96:99]
ds_read_b64_tr_b16 v[74:75], v18 offset:22528
ds_read_b64_tr_b16 v[76:77], v19 offset:20480
v_mfma_f32_16x16x32_bf16 v[100:103], v[180:183], v[168:171], v[100:103]
ds_read_b64_tr_b16 v[78:79], v19 offset:22528
ds_read_b128 v[60:63], v3 offset:9216
v_mfma_f32_16x16x32_bf16 v[104:107], v[184:187], v[168:171], v[104:107]
s_add_u32 s16, s16, 4096
v_mfma_f32_16x16x32_bf16 v[108:111], v[188:191], v[168:171], v[108:111]
s_addc_u32 s17, s17, 0
v_mfma_f32_16x16x32_bf16 v[124:127], v[188:191], v[172:175], v[124:127]
s_mov_b32 s18, 7333056
v_mfma_f32_16x16x32_bf16 v[120:123], v[184:187], v[172:175], v[120:123]
s_mov_b32 s19, 0x20000
v_mfma_f32_16x16x32_bf16 v[116:119], v[180:183], v[172:175], v[116:119]
s_and_b32 s43, s36, 1
v_mfma_f32_16x16x32_bf16 v[112:115], v[176:179], v[172:175], v[112:115]
s_mul_i32 s43, s43, 229376
s_waitcnt lgkmcnt(0)
s_barrier
v_mfma_f32_16x16x32_bf16 v[96:99], v[40:43], v[32:35], v[96:99]
ds_read_b128 v[144:147], v3 offset:49152
ds_read_b64_tr_b16 v[152:153], v16 offset:24576
v_mfma_f32_16x16x32_bf16 v[100:103], v[44:47], v[32:35], v[100:103]
ds_read_b64_tr_b16 v[154:155], v16 offset:26624
ds_read_b64_tr_b16 v[156:157], v17 offset:24576
v_mfma_f32_16x16x32_bf16 v[104:107], v[48:51], v[32:35], v[104:107]
ds_read_b64_tr_b16 v[158:159], v17 offset:26624
ds_read_b64_tr_b16 v[160:161], v18 offset:24576
v_mfma_f32_16x16x32_bf16 v[108:111], v[52:55], v[32:35], v[108:111]
ds_read_b64_tr_b16 v[162:163], v18 offset:26624
ds_read_b64_tr_b16 v[164:165], v19 offset:24576
v_mfma_f32_16x16x32_bf16 v[124:127], v[52:55], v[36:39], v[124:127]
ds_read_b64_tr_b16 v[166:167], v19 offset:26624
ds_read_b128 v[148:151], v3 offset:50176
v_mfma_f32_16x16x32_bf16 v[120:123], v[48:51], v[36:39], v[120:123]
ds_read_b128 v[168:171], v3 offset:57344
ds_read_b64_tr_b16 v[176:177], v16 offset:28672
s_branch Lov_5
.p2align 12
.fill 32, 4, 0xbf800000
Lst_5_0:
s_branch Lwr_147
s_nop 0
s_nop 0
Lov_5:
v_mfma_f32_16x16x32_bf16 v[116:119], v[44:47], v[36:39], v[116:119]
ds_read_b64_tr_b16 v[178:179], v16 offset:30720
ds_read_b64_tr_b16 v[180:181], v17 offset:28672
v_mfma_f32_16x16x32_bf16 v[112:115], v[40:43], v[36:39], v[112:115]
ds_read_b64_tr_b16 v[182:183], v17 offset:30720
ds_read_b64_tr_b16 v[184:185], v18 offset:28672
v_mfma_f32_16x16x32_bf16 v[96:99], v[64:67], v[56:59], v[96:99]
ds_read_b64_tr_b16 v[186:187], v18 offset:30720
ds_read_b64_tr_b16 v[188:189], v19 offset:28672
v_mfma_f32_16x16x32_bf16 v[100:103], v[68:71], v[56:59], v[100:103]
ds_read_b64_tr_b16 v[190:191], v19 offset:30720
ds_read_b128 v[172:175], v3 offset:58368
v_mfma_f32_16x16x32_bf16 v[104:107], v[72:75], v[56:59], v[104:107]
v_add_u32 v196, 0, v1
v_mfma_f32_16x16x32_bf16 v[108:111], v[76:79], v[56:59], v[108:111]
v_mul_u32_u24 v197, 5462, v196
v_mfma_f32_16x16x32_bf16 v[124:127], v[76:79], v[60:63], v[124:127]
v_lshrrev_b32 v197, 16, v197
v_mfma_f32_16x16x32_bf16 v[120:123], v[72:75], v[60:63], v[120:123]
v_mul_u32_u24 v198, 12, v197
v_mfma_f32_16x16x32_bf16 v[116:119], v[68:71], v[60:63], v[116:119]
v_sub_u32 v198, v196, v198
v_mfma_f32_16x16x32_bf16 v[112:115], v[64:67], v[60:63], v[112:115]
v_bfe_u32 v199, v197, 2, 1
s_waitcnt lgkmcnt(0)
s_barrier
v_mfma_f32_16x16x32_bf16 v[96:99], v[152:155], v[144:147], v[96:99]
ds_read_b128 v[32:35], v2 offset:0
ds_read_b64_tr_b16 v[40:41], v16 offset:49152
v_mfma_f32_16x16x32_bf16 v[100:103], v[156:159], v[144:147], v[100:103]
ds_read_b64_tr_b16 v[42:43], v16 offset:51200
ds_read_b64_tr_b16 v[44:45], v17 offset:49152
v_mfma_f32_16x16x32_bf16 v[104:107], v[160:163], v[144:147], v[104:107]
ds_read_b64_tr_b16 v[46:47], v17 offset:51200
ds_read_b64_tr_b16 v[48:49], v18 offset:49152
v_mfma_f32_16x16x32_bf16 v[108:111], v[164:167], v[144:147], v[108:111]
ds_read_b64_tr_b16 v[50:51], v18 offset:51200
ds_read_b64_tr_b16 v[52:53], v19 offset:49152
v_mfma_f32_16x16x32_bf16 v[124:127], v[164:167], v[148:151], v[124:127]
ds_read_b64_tr_b16 v[54:55], v19 offset:51200
ds_read_b128 v[36:39], v2 offset:1024
v_mfma_f32_16x16x32_bf16 v[120:123], v[160:163], v[148:151], v[120:123]
ds_read_b128 v[56:59], v2 offset:8192
ds_read_b64_tr_b16 v[64:65], v16 offset:53248
v_mfma_f32_16x16x32_bf16 v[116:119], v[156:159], v[148:151], v[116:119]
ds_read_b64_tr_b16 v[66:67], v16 offset:55296
ds_read_b64_tr_b16 v[68:69], v17 offset:53248
v_mfma_f32_16x16x32_bf16 v[112:115], v[152:155], v[148:151], v[112:115]
ds_read_b64_tr_b16 v[70:71], v17 offset:55296
ds_read_b64_tr_b16 v[72:73], v18 offset:53248
v_mfma_f32_16x16x32_bf16 v[96:99], v[176:179], v[168:171], v[96:99]
ds_read_b64_tr_b16 v[74:75], v18 offset:55296
ds_read_b64_tr_b16 v[76:77], v19 offset:53248
v_mfma_f32_16x16x32_bf16 v[100:103], v[180:183], v[168:171], v[100:103]
ds_read_b64_tr_b16 v[78:79], v19 offset:55296
ds_read_b128 v[60:63], v2 offset:9216
v_mfma_f32_16x16x32_bf16 v[104:107], v[184:187], v[168:171], v[104:107]
v_cmp_gt_u32 vcc, 8, v198
v_mfma_f32_16x16x32_bf16 v[108:111], v[188:191], v[168:171], v[108:111]
v_lshlrev_b32 v200, 1, v199
v_mfma_f32_16x16x32_bf16 v[124:127], v[188:191], v[172:175], v[124:127]
v_mul_u32_u24 v197, 7168, v197
v_mfma_f32_16x16x32_bf16 v[120:123], v[184:187], v[172:175], v[120:123]
v_cndmask_b32 v199, v199, v200, vcc
v_mfma_f32_16x16x32_bf16 v[116:119], v[180:183], v[172:175], v[116:119]
v_xor_b32 v198, v198, v199
v_mfma_f32_16x16x32_bf16 v[112:115], v[176:179], v[172:175], v[112:115]
v_lshl_add_u32 v192, v198, 4, v197
s_waitcnt lgkmcnt(0)
s_barrier
v_mfma_f32_16x16x32_bf16 v[96:99], v[40:43], v[32:35], v[96:99]
ds_read_b128 v[144:147], v2 offset:49152
ds_read_b64_tr_b16 v[152:153], v16 offset:57344
v_mfma_f32_16x16x32_bf16 v[100:103], v[44:47], v[32:35], v[100:103]
ds_read_b64_tr_b16 v[154:155], v16 offset:59392
ds_read_b64_tr_b16 v[156:157], v17 offset:57344
v_mfma_f32_16x16x32_bf16 v[104:107], v[48:51], v[32:35], v[104:107]
ds_read_b64_tr_b16 v[158:159], v17 offset:59392
ds_read_b64_tr_b16 v[160:161], v18 offset:57344
v_mfma_f32_16x16x32_bf16 v[108:111], v[52:55], v[32:35], v[108:111]
ds_read_b64_tr_b16 v[162:163], v18 offset:59392
ds_read_b64_tr_b16 v[164:165], v19 offset:57344
v_mfma_f32_16x16x32_bf16 v[124:127], v[52:55], v[36:39], v[124:127]
ds_read_b64_tr_b16 v[166:167], v19 offset:59392
ds_read_b128 v[148:151], v2 offset:50176
v_mfma_f32_16x16x32_bf16 v[120:123], v[48:51], v[36:39], v[120:123]
ds_read_b128 v[168:171], v2 offset:57344
ds_read_b64_tr_b16 v[176:177], v16 offset:61440
v_mfma_f32_16x16x32_bf16 v[116:119], v[44:47], v[36:39], v[116:119]
ds_read_b64_tr_b16 v[178:179], v16 offset:63488
ds_read_b64_tr_b16 v[180:181], v17 offset:61440
v_mfma_f32_16x16x32_bf16 v[112:115], v[40:43], v[36:39], v[112:115]
ds_read_b64_tr_b16 v[182:183], v17 offset:63488
ds_read_b64_tr_b16 v[184:185], v18 offset:61440
v_mfma_f32_16x16x32_bf16 v[96:99], v[64:67], v[56:59], v[96:99]
ds_read_b64_tr_b16 v[186:187], v18 offset:63488
ds_read_b64_tr_b16 v[188:189], v19 offset:61440
v_mfma_f32_16x16x32_bf16 v[100:103], v[68:71], v[56:59], v[100:103]
ds_read_b64_tr_b16 v[190:191], v19 offset:63488
ds_read_b128 v[172:175], v2 offset:58368
v_mfma_f32_16x16x32_bf16 v[104:107], v[72:75], v[56:59], v[104:107]
v_add_u32 v196, 64, v1
v_mfma_f32_16x16x32_bf16 v[108:111], v[76:79], v[56:59], v[108:111]
v_mul_u32_u24 v197, 5462, v196
v_mfma_f32_16x16x32_bf16 v[124:127], v[76:79], v[60:63], v[124:127]
v_lshrrev_b32 v197, 16, v197
v_mfma_f32_16x16x32_bf16 v[120:123], v[72:75], v[60:63], v[120:123]
v_mul_u32_u24 v198, 12, v197
v_mfma_f32_16x16x32_bf16 v[116:119], v[68:71], v[60:63], v[116:119]
v_sub_u32 v198, v196, v198
v_mfma_f32_16x16x32_bf16 v[112:115], v[64:67], v[60:63], v[112:115]
v_bfe_u32 v199, v197, 2, 1
s_waitcnt lgkmcnt(0)
s_barrier
v_mfma_f32_16x16x32_bf16 v[96:99], v[152:155], v[144:147], v[96:99]
ds_read_b128 v[32:35], v3 offset:0
ds_read_b64_tr_b16 v[40:41], v20 offset:0
v_mfma_f32_16x16x32_bf16 v[100:103], v[156:159], v[144:147], v[100:103]
ds_read_b64_tr_b16 v[42:43], v20 offset:2048
ds_read_b64_tr_b16 v[44:45], v21 offset:0
v_mfma_f32_16x16x32_bf16 v[104:107], v[160:163], v[144:147], v[104:107]
ds_read_b64_tr_b16 v[46:47], v21 offset:2048
ds_read_b64_tr_b16 v[48:49], v22 offset:0
v_mfma_f32_16x16x32_bf16 v[108:111], v[164:167], v[144:147], v[108:111]
ds_read_b64_tr_b16 v[50:51], v22 offset:2048
ds_read_b64_tr_b16 v[52:53], v23 offset:0
v_mfma_f32_16x16x32_bf16 v[124:127], v[164:167], v[148:151], v[124:127]
ds_read_b64_tr_b16 v[54:55], v23 offset:2048
ds_read_b128 v[36:39], v3 offset:1024
v_mfma_f32_16x16x32_bf16 v[120:123], v[160:163], v[148:151], v[120:123]
ds_read_b128 v[56:59], v3 offset:8192
ds_read_b64_tr_b16 v[64:65], v20 offset:4096
v_mfma_f32_16x16x32_bf16 v[116:119], v[156:159], v[148:151], v[116:119]
ds_read_b64_tr_b16 v[66:67], v20 offset:6144
ds_read_b64_tr_b16 v[68:69], v21 offset:4096
v_mfma_f32_16x16x32_bf16 v[112:115], v[152:155], v[148:151], v[112:115]
ds_read_b64_tr_b16 v[70:71], v21 offset:6144
ds_read_b64_tr_b16 v[72:73], v22 offset:4096
v_mfma_f32_16x16x32_bf16 v[96:99], v[176:179], v[168:171], v[96:99]
ds_read_b64_tr_b16 v[74:75], v22 offset:6144
ds_read_b64_tr_b16 v[76:77], v23 offset:4096
v_mfma_f32_16x16x32_bf16 v[100:103], v[180:183], v[168:171], v[100:103]
ds_read_b64_tr_b16 v[78:79], v23 offset:6144
ds_read_b128 v[60:63], v3 offset:9216
v_mfma_f32_16x16x32_bf16 v[104:107], v[184:187], v[168:171], v[104:107]
v_cmp_gt_u32 vcc, 8, v198
v_mfma_f32_16x16x32_bf16 v[108:111], v[188:191], v[168:171], v[108:111]
v_lshlrev_b32 v200, 1, v199
v_mfma_f32_16x16x32_bf16 v[124:127], v[188:191], v[172:175], v[124:127]
v_mul_u32_u24 v197, 7168, v197
v_mfma_f32_16x16x32_bf16 v[120:123], v[184:187], v[172:175], v[120:123]
v_cndmask_b32 v199, v199, v200, vcc
v_mfma_f32_16x16x32_bf16 v[116:119], v[180:183], v[172:175], v[116:119]
v_xor_b32 v198, v198, v199
v_mfma_f32_16x16x32_bf16 v[112:115], v[176:179], v[172:175], v[112:115]
v_lshl_add_u32 v193, v198, 4, v197
s_waitcnt lgkmcnt(0)
s_barrier
v_mfma_f32_16x16x32_bf16 v[96:99], v[40:43], v[32:35], v[96:99]
ds_read_b128 v[144:147], v3 offset:49152
ds_read_b64_tr_b16 v[152:153], v20 offset:8192
v_mfma_f32_16x16x32_bf16 v[100:103], v[44:47], v[32:35], v[100:103]
ds_read_b64_tr_b16 v[154:155], v20 offset:10240
ds_read_b64_tr_b16 v[156:157], v21 offset:8192
v_mfma_f32_16x16x32_bf16 v[104:107], v[48:51], v[32:35], v[104:107]
ds_read_b64_tr_b16 v[158:159], v21 offset:10240
ds_read_b64_tr_b16 v[160:161], v22 offset:8192
v_mfma_f32_16x16x32_bf16 v[108:111], v[52:55], v[32:35], v[108:111]
ds_read_b64_tr_b16 v[162:163], v22 offset:10240
ds_read_b64_tr_b16 v[164:165], v23 offset:8192
v_mfma_f32_16x16x32_bf16 v[124:127], v[52:55], v[36:39], v[124:127]
ds_read_b64_tr_b16 v[166:167], v23 offset:10240
ds_read_b128 v[148:151], v3 offset:50176
v_mfma_f32_16x16x32_bf16 v[120:123], v[48:51], v[36:39], v[120:123]
ds_read_b128 v[168:171], v3 offset:57344
ds_read_b64_tr_b16 v[176:177], v20 offset:12288
v_mfma_f32_16x16x32_bf16 v[116:119], v[44:47], v[36:39], v[116:119]
ds_read_b64_tr_b16 v[178:179], v20 offset:14336
ds_read_b64_tr_b16 v[180:181], v21 offset:12288
v_mfma_f32_16x16x32_bf16 v[112:115], v[40:43], v[36:39], v[112:115]
ds_read_b64_tr_b16 v[182:183], v21 offset:14336
ds_read_b64_tr_b16 v[184:185], v22 offset:12288
v_mfma_f32_16x16x32_bf16 v[96:99], v[64:67], v[56:59], v[96:99]
ds_read_b64_tr_b16 v[186:187], v22 offset:14336
ds_read_b64_tr_b16 v[188:189], v23 offset:12288
v_mfma_f32_16x16x32_bf16 v[100:103], v[68:71], v[56:59], v[100:103]
ds_read_b64_tr_b16 v[190:191], v23 offset:14336
ds_read_b128 v[172:175], v3 offset:58368
v_mfma_f32_16x16x32_bf16 v[104:107], v[72:75], v[56:59], v[104:107]
v_add_u32 v196, 128, v1
v_mfma_f32_16x16x32_bf16 v[108:111], v[76:79], v[56:59], v[108:111]
v_mul_u32_u24 v197, 5462, v196
v_mfma_f32_16x16x32_bf16 v[124:127], v[76:79], v[60:63], v[124:127]
v_lshrrev_b32 v197, 16, v197
v_mfma_f32_16x16x32_bf16 v[120:123], v[72:75], v[60:63], v[120:123]
v_mul_u32_u24 v198, 12, v197
v_mfma_f32_16x16x32_bf16 v[116:119], v[68:71], v[60:63], v[116:119]
v_sub_u32 v198, v196, v198
v_mfma_f32_16x16x32_bf16 v[112:115], v[64:67], v[60:63], v[112:115]
v_bfe_u32 v199, v197, 2, 1
s_waitcnt lgkmcnt(0)
s_barrier
v_mfma_f32_16x16x32_bf16 v[96:99], v[152:155], v[144:147], v[96:99]
ds_read_b128 v[32:35], v2 offset:0
ds_read_b64_tr_b16 v[40:41], v4 offset:16384
v_mfma_f32_16x16x32_bf16 v[100:103], v[156:159], v[144:147], v[100:103]
ds_read_b64_tr_b16 v[42:43], v4 offset:18432
ds_read_b64_tr_b16 v[44:45], v5 offset:16384
v_mfma_f32_16x16x32_bf16 v[104:107], v[160:163], v[144:147], v[104:107]
ds_read_b64_tr_b16 v[46:47], v5 offset:18432
ds_read_b64_tr_b16 v[48:49], v6 offset:16384
v_mfma_f32_16x16x32_bf16 v[108:111], v[164:167], v[144:147], v[108:111]
ds_read_b64_tr_b16 v[50:51], v6 offset:18432
ds_read_b64_tr_b16 v[52:53], v7 offset:16384
v_mfma_f32_16x16x32_bf16 v[124:127], v[164:167], v[148:151], v[124:127]
ds_read_b64_tr_b16 v[54:55], v7 offset:18432
ds_read_b128 v[36:39], v2 offset:1024
v_mfma_f32_16x16x32_bf16 v[120:123], v[160:163], v[148:151], v[120:123]
ds_read_b128 v[56:59], v2 offset:8192
ds_read_b64_tr_b16 v[64:65], v4 offset:20480
v_mfma_f32_16x16x32_bf16 v[116:119], v[156:159], v[148:151], v[116:119]
ds_read_b64_tr_b16 v[66:67], v4 offset:22528
ds_read_b64_tr_b16 v[68:69], v5 offset:20480
v_mfma_f32_16x16x32_bf16 v[112:115], v[152:155], v[148:151], v[112:115]
ds_read_b64_tr_b16 v[70:71], v5 offset:22528
ds_read_b64_tr_b16 v[72:73], v6 offset:20480
v_mfma_f32_16x16x32_bf16 v[96:99], v[176:179], v[168:171], v[96:99]
ds_read_b64_tr_b16 v[74:75], v6 offset:22528
ds_read_b64_tr_b16 v[76:77], v7 offset:20480
v_mfma_f32_16x16x32_bf16 v[100:103], v[180:183], v[168:171], v[100:103]
ds_read_b64_tr_b16 v[78:79], v7 offset:22528
ds_read_b128 v[60:63], v2 offset:9216
v_mfma_f32_16x16x32_bf16 v[104:107], v[184:187], v[168:171], v[104:107]
v_cmp_gt_u32 vcc, 8, v198
v_mfma_f32_16x16x32_bf16 v[108:111], v[188:191], v[168:171], v[108:111]
v_lshlrev_b32 v200, 1, v199
v_mfma_f32_16x16x32_bf16 v[124:127], v[188:191], v[172:175], v[124:127]
v_mul_u32_u24 v197, 7168, v197
v_mfma_f32_16x16x32_bf16 v[120:123], v[184:187], v[172:175], v[120:123]
v_cndmask_b32 v199, v199, v200, vcc
v_mfma_f32_16x16x32_bf16 v[116:119], v[180:183], v[172:175], v[116:119]
v_xor_b32 v198, v198, v199
v_mfma_f32_16x16x32_bf16 v[112:115], v[176:179], v[172:175], v[112:115]
v_lshl_add_u32 v194, v198, 4, v197
s_waitcnt lgkmcnt(0)
s_barrier
v_mfma_f32_16x16x32_bf16 v[96:99], v[40:43], v[32:35], v[96:99]
ds_read_b128 v[144:147], v2 offset:49152
ds_read_b64_tr_b16 v[152:153], v4 offset:24576
v_mfma_f32_16x16x32_bf16 v[100:103], v[44:47], v[32:35], v[100:103]
ds_read_b64_tr_b16 v[154:155], v4 offset:26624
ds_read_b64_tr_b16 v[156:157], v5 offset:24576
v_mfma_f32_16x16x32_bf16 v[104:107], v[48:51], v[32:35], v[104:107]
ds_read_b64_tr_b16 v[158:159], v5 offset:26624
ds_read_b64_tr_b16 v[160:161], v6 offset:24576
v_mfma_f32_16x16x32_bf16 v[108:111], v[52:55], v[32:35], v[108:111]
ds_read_b64_tr_b16 v[162:163], v6 offset:26624
ds_read_b64_tr_b16 v[164:165], v7 offset:24576
v_mfma_f32_16x16x32_bf16 v[124:127], v[52:55], v[36:39], v[124:127]
ds_read_b64_tr_b16 v[166:167], v7 offset:26624
ds_read_b128 v[148:151], v2 offset:50176
v_mfma_f32_16x16x32_bf16 v[120:123], v[48:51], v[36:39], v[120:123]
ds_read_b128 v[168:171], v2 offset:57344
ds_read_b64_tr_b16 v[176:177], v4 offset:28672
v_mfma_f32_16x16x32_bf16 v[116:119], v[44:47], v[36:39], v[116:119]
ds_read_b64_tr_b16 v[178:179], v4 offset:30720
ds_read_b64_tr_b16 v[180:181], v5 offset:28672
v_mfma_f32_16x16x32_bf16 v[112:115], v[40:43], v[36:39], v[112:115]
ds_read_b64_tr_b16 v[182:183], v5 offset:30720
ds_read_b64_tr_b16 v[184:185], v6 offset:28672
v_mfma_f32_16x16x32_bf16 v[96:99], v[64:67], v[56:59], v[96:99]
ds_read_b64_tr_b16 v[186:187], v6 offset:30720
ds_read_b64_tr_b16 v[188:189], v7 offset:28672
v_mfma_f32_16x16x32_bf16 v[100:103], v[68:71], v[56:59], v[100:103]
ds_read_b64_tr_b16 v[190:191], v7 offset:30720
ds_read_b128 v[172:175], v2 offset:58368
v_mfma_f32_16x16x32_bf16 v[104:107], v[72:75], v[56:59], v[104:107]
v_add_u32 v192, s43, v192
v_mfma_f32_16x16x32_bf16 v[108:111], v[76:79], v[56:59], v[108:111]
v_add_u32 v193, s43, v193
v_mfma_f32_16x16x32_bf16 v[124:127], v[76:79], v[60:63], v[124:127]
v_add_u32 v194, s43, v194
v_mfma_f32_16x16x32_bf16 v[120:123], v[72:75], v[60:63], v[120:123]
s_and_b32 s43, s36, 3
v_mfma_f32_16x16x32_bf16 v[116:119], v[68:71], v[60:63], v[116:119]
s_mul_i32 s50, s43, 6144
v_mfma_f32_16x16x32_bf16 v[112:115], v[64:67], v[60:63], v[112:115]
s_add_u32 s50, s50, 16384
s_waitcnt lgkmcnt(0)
s_barrier
v_mfma_f32_16x16x32_bf16 v[96:99], v[152:155], v[144:147], v[96:99]
ds_read_b128 v[32:35], v3 offset:0
ds_read_b64_tr_b16 v[40:41], v4 offset:32768
v_mfma_f32_16x16x32_bf16 v[100:103], v[156:159], v[144:147], v[100:103]
ds_read_b64_tr_b16 v[42:43], v4 offset:34816
ds_read_b64_tr_b16 v[44:45], v5 offset:32768
v_mfma_f32_16x16x32_bf16 v[104:107], v[160:163], v[144:147], v[104:107]
ds_read_b64_tr_b16 v[46:47], v5 offset:34816
ds_read_b64_tr_b16 v[48:49], v6 offset:32768
v_mfma_f32_16x16x32_bf16 v[108:111], v[164:167], v[144:147], v[108:111]
ds_read_b64_tr_b16 v[50:51], v6 offset:34816
ds_read_b64_tr_b16 v[52:53], v7 offset:32768
v_mfma_f32_16x16x32_bf16 v[124:127], v[164:167], v[148:151], v[124:127]
ds_read_b64_tr_b16 v[54:55], v7 offset:34816
ds_read_b128 v[36:39], v3 offset:1024
v_mfma_f32_16x16x32_bf16 v[120:123], v[160:163], v[148:151], v[120:123]
ds_read_b128 v[56:59], v3 offset:8192
ds_read_b64_tr_b16 v[64:65], v4 offset:36864
v_mfma_f32_16x16x32_bf16 v[116:119], v[156:159], v[148:151], v[116:119]
ds_read_b64_tr_b16 v[66:67], v4 offset:38912
ds_read_b64_tr_b16 v[68:69], v5 offset:36864
v_mfma_f32_16x16x32_bf16 v[112:115], v[152:155], v[148:151], v[112:115]
ds_read_b64_tr_b16 v[70:71], v5 offset:38912
ds_read_b64_tr_b16 v[72:73], v6 offset:36864
v_mfma_f32_16x16x32_bf16 v[96:99], v[176:179], v[168:171], v[96:99]
ds_read_b64_tr_b16 v[74:75], v6 offset:38912
ds_read_b64_tr_b16 v[76:77], v7 offset:36864
v_mfma_f32_16x16x32_bf16 v[100:103], v[180:183], v[168:171], v[100:103]
ds_read_b64_tr_b16 v[78:79], v7 offset:38912
ds_read_b128 v[60:63], v3 offset:9216
v_mfma_f32_16x16x32_bf16 v[104:107], v[184:187], v[168:171], v[104:107]
s_bitcmp0_b32 s2, 0
v_mfma_f32_16x16x32_bf16 v[108:111], v[188:191], v[168:171], v[108:111]
s_cselect_b32 s88, s72, s74
v_mfma_f32_16x16x32_bf16 v[124:127], v[188:191], v[172:175], v[124:127]
s_cselect_b32 s89, s73, s75
v_mfma_f32_16x16x32_bf16 v[120:123], v[184:187], v[172:175], v[120:123]
s_mov_b32 s90, 7340032
v_mfma_f32_16x16x32_bf16 v[116:119], v[180:183], v[172:175], v[116:119]
s_mov_b32 s91, 0x20000
v_mfma_f32_16x16x32_bf16 v[112:115], v[176:179], v[172:175], v[112:115]
s_bfe_u32 s44, s2, 0x30001
s_waitcnt lgkmcnt(0)
s_barrier
v_mfma_f32_16x16x32_bf16 v[96:99], v[40:43], v[32:35], v[96:99]
ds_read_b128 v[144:147], v3 offset:49152
ds_read_b64_tr_b16 v[152:153], v4 offset:40960
v_mfma_f32_16x16x32_bf16 v[100:103], v[44:47], v[32:35], v[100:103]
ds_read_b64_tr_b16 v[154:155], v4 offset:43008
ds_read_b64_tr_b16 v[156:157], v5 offset:40960
v_mfma_f32_16x16x32_bf16 v[104:107], v[48:51], v[32:35], v[104:107]
ds_read_b64_tr_b16 v[158:159], v5 offset:43008
ds_read_b64_tr_b16 v[160:161], v6 offset:40960
v_mfma_f32_16x16x32_bf16 v[108:111], v[52:55], v[32:35], v[108:111]
ds_read_b64_tr_b16 v[162:163], v6 offset:43008
ds_read_b64_tr_b16 v[164:165], v7 offset:40960
v_mfma_f32_16x16x32_bf16 v[124:127], v[52:55], v[36:39], v[124:127]
ds_read_b64_tr_b16 v[166:167], v7 offset:43008
ds_read_b128 v[148:151], v3 offset:50176
v_mfma_f32_16x16x32_bf16 v[120:123], v[48:51], v[36:39], v[120:123]
ds_read_b128 v[168:171], v3 offset:57344
ds_read_b64_tr_b16 v[176:177], v4 offset:45056
v_mfma_f32_16x16x32_bf16 v[116:119], v[44:47], v[36:39], v[116:119]
ds_read_b64_tr_b16 v[178:179], v4 offset:47104
ds_read_b64_tr_b16 v[180:181], v5 offset:45056
v_mfma_f32_16x16x32_bf16 v[112:115], v[40:43], v[36:39], v[112:115]
ds_read_b64_tr_b16 v[182:183], v5 offset:47104
ds_read_b64_tr_b16 v[184:185], v6 offset:45056
v_mfma_f32_16x16x32_bf16 v[96:99], v[64:67], v[56:59], v[96:99]
ds_read_b64_tr_b16 v[186:187], v6 offset:47104
ds_read_b64_tr_b16 v[188:189], v7 offset:45056
v_mfma_f32_16x16x32_bf16 v[100:103], v[68:71], v[56:59], v[100:103]
ds_read_b64_tr_b16 v[190:191], v7 offset:47104
ds_read_b128 v[172:175], v3 offset:58368
v_mfma_f32_16x16x32_bf16 v[104:107], v[72:75], v[56:59], v[104:107]
s_lshl_b32 s44, s44, 2
v_mfma_f32_16x16x32_bf16 v[108:111], v[76:79], v[56:59], v[108:111]
s_and_b32 s43, s36, 3
v_mfma_f32_16x16x32_bf16 v[124:127], v[76:79], v[60:63], v[124:127]
s_add_u32 s44, s44, s43
v_mfma_f32_16x16x32_bf16 v[120:123], v[72:75], v[60:63], v[120:123]
s_lshl_b32 s44, s44, 5
v_mfma_f32_16x16x32_bf16 v[116:119], v[68:71], v[60:63], v[116:119]
v_lshrrev_b32 v195, 4, v1
v_mfma_f32_16x16x32_bf16 v[112:115], v[64:67], v[60:63], v[112:115]
v_add_u32 v195, s44, v195
s_waitcnt lgkmcnt(0)
s_barrier
v_mfma_f32_16x16x32_bf16 v[96:99], v[152:155], v[144:147], v[96:99]
ds_read_b128 v[32:35], v2 offset:0
ds_read_b64_tr_b16 v[40:41], v16 offset:49152
v_mfma_f32_16x16x32_bf16 v[100:103], v[156:159], v[144:147], v[100:103]
ds_read_b64_tr_b16 v[42:43], v16 offset:51200
ds_read_b64_tr_b16 v[44:45], v17 offset:49152
v_mfma_f32_16x16x32_bf16 v[104:107], v[160:163], v[144:147], v[104:107]
ds_read_b64_tr_b16 v[46:47], v17 offset:51200
ds_read_b64_tr_b16 v[48:49], v18 offset:49152
v_mfma_f32_16x16x32_bf16 v[108:111], v[164:167], v[144:147], v[108:111]
ds_read_b64_tr_b16 v[50:51], v18 offset:51200
ds_read_b64_tr_b16 v[52:53], v19 offset:49152
v_mfma_f32_16x16x32_bf16 v[124:127], v[164:167], v[148:151], v[124:127]
ds_read_b64_tr_b16 v[54:55], v19 offset:51200
ds_read_b128 v[36:39], v2 offset:1024
v_mfma_f32_16x16x32_bf16 v[120:123], v[160:163], v[148:151], v[120:123]
ds_read_b128 v[56:59], v2 offset:8192
ds_read_b64_tr_b16 v[64:65], v16 offset:53248
v_mfma_f32_16x16x32_bf16 v[116:119], v[156:159], v[148:151], v[116:119]
ds_read_b64_tr_b16 v[66:67], v16 offset:55296
ds_read_b64_tr_b16 v[68:69], v17 offset:53248
v_mfma_f32_16x16x32_bf16 v[112:115], v[152:155], v[148:151], v[112:115]
ds_read_b64_tr_b16 v[70:71], v17 offset:55296
ds_read_b64_tr_b16 v[72:73], v18 offset:53248
v_mfma_f32_16x16x32_bf16 v[96:99], v[176:179], v[168:171], v[96:99]
ds_read_b64_tr_b16 v[74:75], v18 offset:55296
ds_read_b64_tr_b16 v[76:77], v19 offset:53248
v_mfma_f32_16x16x32_bf16 v[100:103], v[180:183], v[168:171], v[100:103]
ds_read_b64_tr_b16 v[78:79], v19 offset:55296
ds_read_b128 v[60:63], v2 offset:9216
v_mfma_f32_16x16x32_bf16 v[104:107], v[184:187], v[168:171], v[104:107]
v_mul_u32_u24 v195, 7168, v195
v_mfma_f32_16x16x32_bf16 v[108:111], v[188:191], v[168:171], v[108:111]
v_and_b32 v196, 15, v1
v_mfma_f32_16x16x32_bf16 v[124:127], v[188:191], v[172:175], v[124:127]
v_lshl_add_u32 v195, v196, 4, v195
v_mfma_f32_16x16x32_bf16 v[120:123], v[184:187], v[172:175], v[120:123]
s_lshr_b32 s43, s2, 4
v_mfma_f32_16x16x32_bf16 v[116:119], v[180:183], v[172:175], v[116:119]
s_lshl_b32 s43, s43, 8
v_mfma_f32_16x16x32_bf16 v[112:115], v[176:179], v[172:175], v[112:115]
v_add_u32 v195, s43, v195
s_waitcnt lgkmcnt(0)
s_barrier
v_mfma_f32_16x16x32_bf16 v[96:99], v[40:43], v[32:35], v[96:99]
ds_read_b128 v[144:147], v2 offset:49152
ds_read_b64_tr_b16 v[152:153], v16 offset:57344
v_mfma_f32_16x16x32_bf16 v[100:103], v[44:47], v[32:35], v[100:103]
ds_read_b64_tr_b16 v[154:155], v16 offset:59392
ds_read_b64_tr_b16 v[156:157], v17 offset:57344
v_mfma_f32_16x16x32_bf16 v[104:107], v[48:51], v[32:35], v[104:107]
ds_read_b64_tr_b16 v[158:159], v17 offset:59392
ds_read_b64_tr_b16 v[160:161], v18 offset:57344
v_mfma_f32_16x16x32_bf16 v[108:111], v[52:55], v[32:35], v[108:111]
ds_read_b64_tr_b16 v[162:163], v18 offset:59392
ds_read_b64_tr_b16 v[164:165], v19 offset:57344
v_mfma_f32_16x16x32_bf16 v[124:127], v[52:55], v[36:39], v[124:127]
ds_read_b64_tr_b16 v[166:167], v19 offset:59392
ds_read_b128 v[148:151], v2 offset:50176
v_mfma_f32_16x16x32_bf16 v[120:123], v[48:51], v[36:39], v[120:123]
ds_read_b128 v[168:171], v2 offset:57344
ds_read_b64_tr_b16 v[176:177], v16 offset:61440
v_mfma_f32_16x16x32_bf16 v[116:119], v[44:47], v[36:39], v[116:119]
ds_read_b64_tr_b16 v[178:179], v16 offset:63488
ds_read_b64_tr_b16 v[180:181], v17 offset:61440
v_mfma_f32_16x16x32_bf16 v[112:115], v[40:43], v[36:39], v[112:115]
ds_read_b64_tr_b16 v[182:183], v17 offset:63488
ds_read_b64_tr_b16 v[184:185], v18 offset:61440
v_mfma_f32_16x16x32_bf16 v[96:99], v[64:67], v[56:59], v[96:99]
ds_read_b64_tr_b16 v[186:187], v18 offset:63488
ds_read_b64_tr_b16 v[188:189], v19 offset:61440
v_mfma_f32_16x16x32_bf16 v[100:103], v[68:71], v[56:59], v[100:103]
ds_read_b64_tr_b16 v[190:191], v19 offset:63488
ds_read_b128 v[172:175], v2 offset:58368
v_mfma_f32_16x16x32_bf16 v[104:107], v[72:75], v[56:59], v[104:107]
v_mfma_f32_16x16x32_bf16 v[108:111], v[76:79], v[56:59], v[108:111]
v_mfma_f32_16x16x32_bf16 v[124:127], v[76:79], v[60:63], v[124:127]
v_mfma_f32_16x16x32_bf16 v[120:123], v[72:75], v[60:63], v[120:123]
v_mfma_f32_16x16x32_bf16 v[116:119], v[68:71], v[60:63], v[116:119]
v_mfma_f32_16x16x32_bf16 v[112:115], v[64:67], v[60:63], v[112:115]
s_waitcnt lgkmcnt(0)
s_barrier
v_mfma_f32_16x16x32_bf16 v[96:99], v[152:155], v[144:147], v[96:99]
ds_read_b128 v[32:35], v3 offset:0
ds_read_b64_tr_b16 v[40:41], v20 offset:0
v_mfma_f32_16x16x32_bf16 v[100:103], v[156:159], v[144:147], v[100:103]
ds_read_b64_tr_b16 v[42:43], v20 offset:2048
ds_read_b64_tr_b16 v[44:45], v21 offset:0
v_mfma_f32_16x16x32_bf16 v[104:107], v[160:163], v[144:147], v[104:107]
ds_read_b64_tr_b16 v[46:47], v21 offset:2048
ds_read_b64_tr_b16 v[48:49], v22 offset:0
v_mfma_f32_16x16x32_bf16 v[108:111], v[164:167], v[144:147], v[108:111]
ds_read_b64_tr_b16 v[50:51], v22 offset:2048
ds_read_b64_tr_b16 v[52:53], v23 offset:0
v_mfma_f32_16x16x32_bf16 v[124:127], v[164:167], v[148:151], v[124:127]
ds_read_b64_tr_b16 v[54:55], v23 offset:2048
ds_read_b128 v[36:39], v3 offset:1024
v_mfma_f32_16x16x32_bf16 v[120:123], v[160:163], v[148:151], v[120:123]
ds_read_b128 v[56:59], v3 offset:8192
ds_read_b64_tr_b16 v[64:65], v20 offset:4096
v_mfma_f32_16x16x32_bf16 v[116:119], v[156:159], v[148:151], v[116:119]
ds_read_b64_tr_b16 v[66:67], v20 offset:6144
ds_read_b64_tr_b16 v[68:69], v21 offset:4096
v_mfma_f32_16x16x32_bf16 v[112:115], v[152:155], v[148:151], v[112:115]
ds_read_b64_tr_b16 v[70:71], v21 offset:6144
ds_read_b64_tr_b16 v[72:73], v22 offset:4096
v_mfma_f32_16x16x32_bf16 v[96:99], v[176:179], v[168:171], v[96:99]
ds_read_b64_tr_b16 v[74:75], v22 offset:6144
ds_read_b64_tr_b16 v[76:77], v23 offset:4096
v_mfma_f32_16x16x32_bf16 v[100:103], v[180:183], v[168:171], v[100:103]
ds_read_b64_tr_b16 v[78:79], v23 offset:6144
ds_read_b128 v[60:63], v3 offset:9216
v_mfma_f32_16x16x32_bf16 v[104:107], v[184:187], v[168:171], v[104:107]
v_mfma_f32_16x16x32_bf16 v[108:111], v[188:191], v[168:171], v[108:111]
v_mfma_f32_16x16x32_bf16 v[124:127], v[188:191], v[172:175], v[124:127]
v_mfma_f32_16x16x32_bf16 v[120:123], v[184:187], v[172:175], v[120:123]
v_mfma_f32_16x16x32_bf16 v[116:119], v[180:183], v[172:175], v[116:119]
v_mfma_f32_16x16x32_bf16 v[112:115], v[176:179], v[172:175], v[112:115]
s_waitcnt lgkmcnt(0)
s_barrier
v_mfma_f32_16x16x32_bf16 v[96:99], v[40:43], v[32:35], v[96:99]
ds_read_b128 v[144:147], v3 offset:49152
ds_read_b64_tr_b16 v[152:153], v20 offset:8192
v_mfma_f32_16x16x32_bf16 v[100:103], v[44:47], v[32:35], v[100:103]
ds_read_b64_tr_b16 v[154:155], v20 offset:10240
ds_read_b64_tr_b16 v[156:157], v21 offset:8192
v_mfma_f32_16x16x32_bf16 v[104:107], v[48:51], v[32:35], v[104:107]
ds_read_b64_tr_b16 v[158:159], v21 offset:10240
ds_read_b64_tr_b16 v[160:161], v22 offset:8192
v_mfma_f32_16x16x32_bf16 v[108:111], v[52:55], v[32:35], v[108:111]
ds_read_b64_tr_b16 v[162:163], v22 offset:10240
ds_read_b64_tr_b16 v[164:165], v23 offset:8192
v_mfma_f32_16x16x32_bf16 v[124:127], v[52:55], v[36:39], v[124:127]
ds_read_b64_tr_b16 v[166:167], v23 offset:10240
ds_read_b128 v[148:151], v3 offset:50176
v_mfma_f32_16x16x32_bf16 v[120:123], v[48:51], v[36:39], v[120:123]
ds_read_b128 v[168:171], v3 offset:57344
ds_read_b64_tr_b16 v[176:177], v20 offset:12288
v_mfma_f32_16x16x32_bf16 v[116:119], v[44:47], v[36:39], v[116:119]
ds_read_b64_tr_b16 v[178:179], v20 offset:14336
ds_read_b64_tr_b16 v[180:181], v21 offset:12288
v_mfma_f32_16x16x32_bf16 v[112:115], v[40:43], v[36:39], v[112:115]
ds_read_b64_tr_b16 v[182:183], v21 offset:14336
ds_read_b64_tr_b16 v[184:185], v22 offset:12288
v_mfma_f32_16x16x32_bf16 v[96:99], v[64:67], v[56:59], v[96:99]
ds_read_b64_tr_b16 v[186:187], v22 offset:14336
ds_read_b64_tr_b16 v[188:189], v23 offset:12288
v_mfma_f32_16x16x32_bf16 v[100:103], v[68:71], v[56:59], v[100:103]
s_branch Lov_6
.p2align 12
.fill 48, 4, 0xbf800000
Lst_6_0:
s_branch Lst_7_0
s_nop 0
s_nop 0
Lov_6:
ds_read_b64_tr_b16 v[190:191], v23 offset:14336
ds_read_b128 v[172:175], v3 offset:58368
v_mfma_f32_16x16x32_bf16 v[104:107], v[72:75], v[56:59], v[104:107]
v_mfma_f32_16x16x32_bf16 v[108:111], v[76:79], v[56:59], v[108:111]
v_mfma_f32_16x16x32_bf16 v[124:127], v[76:79], v[60:63], v[124:127]
v_mfma_f32_16x16x32_bf16 v[120:123], v[72:75], v[60:63], v[120:123]
v_mfma_f32_16x16x32_bf16 v[116:119], v[68:71], v[60:63], v[116:119]
v_mfma_f32_16x16x32_bf16 v[112:115], v[64:67], v[60:63], v[112:115]
s_waitcnt lgkmcnt(0)
s_barrier
v_mfma_f32_16x16x32_bf16 v[96:99], v[152:155], v[144:147], v[96:99]
v_mfma_f32_16x16x32_bf16 v[100:103], v[156:159], v[144:147], v[100:103]
v_mfma_f32_16x16x32_bf16 v[104:107], v[160:163], v[144:147], v[104:107]
v_mfma_f32_16x16x32_bf16 v[108:111], v[164:167], v[144:147], v[108:111]
v_mfma_f32_16x16x32_bf16 v[124:127], v[164:167], v[148:151], v[124:127]
v_mfma_f32_16x16x32_bf16 v[120:123], v[160:163], v[148:151], v[120:123]
v_mfma_f32_16x16x32_bf16 v[116:119], v[156:159], v[148:151], v[116:119]
v_mfma_f32_16x16x32_bf16 v[112:115], v[152:155], v[148:151], v[112:115]
v_mfma_f32_16x16x32_bf16 v[96:99], v[176:179], v[168:171], v[96:99]
v_mfma_f32_16x16x32_bf16 v[100:103], v[180:183], v[168:171], v[100:103]
v_mfma_f32_16x16x32_bf16 v[104:107], v[184:187], v[168:171], v[104:107]
v_mfma_f32_16x16x32_bf16 v[108:111], v[188:191], v[168:171], v[108:111]
v_mfma_f32_16x16x32_bf16 v[124:127], v[188:191], v[172:175], v[124:127]
v_mfma_f32_16x16x32_bf16 v[120:123], v[184:187], v[172:175], v[120:123]
v_mfma_f32_16x16x32_bf16 v[116:119], v[180:183], v[172:175], v[116:119]
v_mfma_f32_16x16x32_bf16 v[112:115], v[176:179], v[172:175], v[112:115]
s_nop 3
v_cvt_pk_bf16_f32 v32, v96, v97
v_cvt_pk_bf16_f32 v33, v98, v99
v_cvt_pk_bf16_f32 v34, v100, v101
v_cvt_pk_bf16_f32 v35, v102, v103
s_add_u32 s43, s60, 0
buffer_store_dwordx4 v[32:35], v11, s[20:23], s43 offen offset:0 sc1
v_cvt_pk_bf16_f32 v36, v104, v105
v_cvt_pk_bf16_f32 v37, v106, v107
v_cvt_pk_bf16_f32 v38, v108, v109
v_cvt_pk_bf16_f32 v39, v110, v111
s_add_u32 s43, s60, 8192
buffer_store_dwordx4 v[36:39], v11, s[20:23], s43 offen offset:0 sc1
v_cvt_pk_bf16_f32 v44, v120, v121
v_cvt_pk_bf16_f32 v45, v122, v123
v_cvt_pk_bf16_f32 v46, v124, v125
v_cvt_pk_bf16_f32 v47, v126, v127
s_add_u32 s43, s60, 8192
buffer_store_dwordx4 v[44:47], v11, s[20:23], s43 offen offset:1024 sc1
v_cvt_pk_bf16_f32 v40, v112, v113
v_cvt_pk_bf16_f32 v41, v114, v115
v_cvt_pk_bf16_f32 v42, v116, v117
v_cvt_pk_bf16_f32 v43, v118, v119
s_add_u32 s43, s60, 0
buffer_store_dwordx4 v[40:43], v11, s[20:23], s43 offen offset:1024 sc1
v_mov_b32 v64, 0
v_mov_b32 v65, 0
v_mov_b32 v66, 0
v_mov_b32 v67, 0
v_mov_b32 v68, 0
v_mov_b32 v69, 0
v_mov_b32 v70, 0
v_mov_b32 v71, 0
v_dot2_f32_bf16 v64, v32, s61, v64
v_dot2_f32_bf16 v66, v32, v32, v66
v_dot2_f32_bf16 v68, v40, s61, v68
v_dot2_f32_bf16 v70, v40, v40, v70
v_dot2_f32_bf16 v65, v33, s61, v65
v_dot2_f32_bf16 v67, v33, v33, v67
v_dot2_f32_bf16 v69, v41, s61, v69
v_dot2_f32_bf16 v71, v41, v41, v71
v_dot2_f32_bf16 v64, v34, s61, v64
v_dot2_f32_bf16 v66, v34, v34, v66
v_dot2_f32_bf16 v68, v42, s61, v68
v_dot2_f32_bf16 v70, v42, v42, v70
v_dot2_f32_bf16 v65, v35, s61, v65
v_dot2_f32_bf16 v67, v35, v35, v67
v_dot2_f32_bf16 v69, v43, s61, v69
v_dot2_f32_bf16 v71, v43, v43, v71
v_dot2_f32_bf16 v64, v36, s61, v64
v_dot2_f32_bf16 v66, v36, v36, v66
v_dot2_f32_bf16 v68, v44, s61, v68
v_dot2_f32_bf16 v70, v44, v44, v70
v_dot2_f32_bf16 v65, v37, s61, v65
v_dot2_f32_bf16 v67, v37, v37, v67
v_dot2_f32_bf16 v69, v45, s61, v69
v_dot2_f32_bf16 v71, v45, v45, v71
v_dot2_f32_bf16 v64, v38, s61, v64
v_dot2_f32_bf16 v66, v38, v38, v66
v_dot2_f32_bf16 v68, v46, s61, v68
v_dot2_f32_bf16 v70, v46, v46, v70
v_dot2_f32_bf16 v65, v39, s61, v65
v_dot2_f32_bf16 v67, v39, v39, v67
v_dot2_f32_bf16 v69, v47, s61, v69
v_dot2_f32_bf16 v71, v47, v47, v71
s_nop 2
v_add_f32 v64, v64, v65
v_add_f32 v66, v66, v67
v_add_f32 v68, v68, v69
v_add_f32 v70, v70, v71
s_nop 1
v_permlane32_swap_b32 v64, v68
v_permlane32_swap_b32 v66, v70
v_add_f32 v64, v64, v68
v_add_f32 v66, v66, v70
s_nop 1
v_permlane16_swap_b32 v64, v66
v_add_f32 v64, v64, v66
buffer_store_dword v64, v9, s[24:27], 0 offen sc1
s_lshl_b32 s7, s34, 12
s_add_u32 s7, s7, 49280
v_lshl_add_u32 v4, v1, 8, s7
v_mov_b32 v5, 1
s_waitcnt vmcnt(0)
s_cmp_lg_u32 s36, 0
s_barrier
s_cbranch_scc1 Lk2end_83
s_mov_b64 exec, 0xffff
buffer_atomic_add v5, v4, s[56:59], 0 offen sc1
s_mov_b64 exec, -1
s_branch Lk2end_83
Lprod_84:
s_mul_i32 s43, s34, 262144
s_add_u32 s8, s82, s43
s_addc_u32 s9, s83, 0
s_mov_b32 s10, 262144
s_mov_b32 s11, 0x20000
s_lshl_b32 s43, s35, 7
s_add_u32 s12, s68, s43
s_addc_u32 s13, s69, 0
s_mov_b32 s14, 2095232
s_mov_b32 s15, 0x20000
s_and_b32 s47, s36, 3
s_lshl_b32 s39, s47, 12
v_lshlrev_b32 v2, 4, v1
v_add_u32 v2, s39, v2
v_lshrrev_b32 v12, 3, v1
v_and_b32 v13, 6, v12
v_and_b32 v3, 7, v1
v_xor_b32 v3, v3, v13
v_lshlrev_b32 v3, 4, v3
v_mul_u32_u24 v12, 2048, v12
v_add_u32 v3, v3, v12
s_lshl_b32 s43, s47, 15
v_add_u32 v3, s43, v3
s_lshl_b32 s40, s47, 11
s_add_u32 s37, s35, 0
s_and_b32 s37, s37, 15
s_lshl_b32 s37, s37, 14
s_add_u32 m0, s39, 0
s_nop 0
buffer_load_dwordx4 v2, s[8:11], s37 offen offset:0 sc1 lds
buffer_load_dwordx4 v2, s[8:11], s37 offen offset:1024 sc1 lds
buffer_load_dwordx4 v2, s[8:11], s37 offen offset:2048 sc1 lds
buffer_load_dwordx4 v2, s[8:11], s37 offen offset:3072 sc1 lds
s_add_u32 s38, s35, 4
s_and_b32 s38, s38, 15
s_lshl_b32 s38, s38, 17
s_add_u32 m0, s40, 114688
s_nop 0
buffer_load_dwordx4 v3, s[12:15], s38 offen lds
s_add_u32 m0, s40, 115712
s_add_u32 s38, s38, 16384
buffer_load_dwordx4 v3, s[12:15], s38 offen lds
s_add_u32 s38, s35, 5
s_and_b32 s38, s38, 15
s_lshl_b32 s38, s38, 17
s_add_u32 m0, s40, 122880
s_nop 0
buffer_load_dwordx4 v3, s[12:15], s38 offen lds
s_add_u32 m0, s40, 123904
s_add_u32 s38, s38, 16384
buffer_load_dwordx4 v3, s[12:15], s38 offen lds
s_add_u32 s38, s35, 6
s_and_b32 s38, s38, 15
s_lshl_b32 s38, s38, 17
s_add_u32 m0, s40, 131072
s_nop 0
buffer_load_dwordx4 v3, s[12:15], s38 offen lds
s_add_u32 m0, s40, 132096
s_add_u32 s38, s38, 16384
buffer_load_dwordx4 v3, s[12:15], s38 offen lds
s_add_u32 s38, s35, 7
s_and_b32 s38, s38, 15
s_lshl_b32 s38, s38, 17
s_add_u32 m0, s40, 139264
s_nop 0
buffer_load_dwordx4 v3, s[12:15], s38 offen lds
s_add_u32 m0, s40, 140288
s_add_u32 s38, s38, 16384
buffer_load_dwordx4 v3, s[12:15], s38 offen lds
s_bitcmp0_b32 s36, 1
s_cselect_b32 s44, s72, s74
s_cselect_b32 s45, s73, s75
s_mul_i32 s43, s35, 192
s_add_u32 s16, s44, s43
s_addc_u32 s17, s45, 0
s_add_u32 s16, s16, 4096
s_addc_u32 s17, s17, 0
s_mov_b32 s18, 7333056
s_mov_b32 s19, 0x20000
s_and_b32 s43, s36, 1
s_mul_i32 s43, s43, 229376
v_add_u32 v196, 0, v1
v_mul_u32_u24 v197, 5462, v196
v_lshrrev_b32 v197, 16, v197
v_mul_u32_u24 v198, 12, v197
v_sub_u32 v198, v196, v198
v_bfe_u32 v199, v197, 2, 1
v_cmp_gt_u32 vcc, 8, v198
v_lshlrev_b32 v200, 1, v199
v_mul_u32_u24 v197, 7168, v197
v_cndmask_b32 v199, v199, v200, vcc
v_xor_b32 v198, v198, v199
v_lshl_add_u32 v192, v198, 4, v197
v_add_u32 v196, 64, v1
v_mul_u32_u24 v197, 5462, v196
v_lshrrev_b32 v197, 16, v197
v_mul_u32_u24 v198, 12, v197
v_sub_u32 v198, v196, v198
v_bfe_u32 v199, v197, 2, 1
v_cmp_gt_u32 vcc, 8, v198
v_lshlrev_b32 v200, 1, v199
v_mul_u32_u24 v197, 7168, v197
v_cndmask_b32 v199, v199, v200, vcc
v_xor_b32 v198, v198, v199
v_lshl_add_u32 v193, v198, 4, v197
v_add_u32 v196, 128, v1
v_mul_u32_u24 v197, 5462, v196
v_lshrrev_b32 v197, 16, v197
v_mul_u32_u24 v198, 12, v197
v_sub_u32 v198, v196, v198
v_bfe_u32 v199, v197, 2, 1
v_cmp_gt_u32 vcc, 8, v198
v_lshlrev_b32 v200, 1, v199
v_mul_u32_u24 v197, 7168, v197
v_cndmask_b32 v199, v199, v200, vcc
v_xor_b32 v198, v198, v199
v_lshl_add_u32 v194, v198, 4, v197
v_add_u32 v192, s43, v192
v_add_u32 v193, s43, v193
v_add_u32 v194, s43, v194
s_and_b32 s43, s36, 3
s_mul_i32 s50, s43, 6144
s_add_u32 s50, s50, 16384
s_cmp_eq_u32 s47, 3
s_cbranch_scc0 Lw_91
s_lshl_b32 s92, s34, 4
s_add_u32 s92, s92, s35
s_lshl_b32 s92, s92, 8
s_add_u32 s92, s92, 49152
s_add_u32 s92, s92, 28311552
s_mov_b32 s41, 0x40000
Lpoll_92:
s_load_dword s93, s[82:83], s92 glc
Lpchk_94:
s_waitcnt lgkmcnt(0)
s_cmp_eq_u32 s93, 16
s_cbranch_scc1 Lpok_93
s_sub_u32 s41, s41, 1
s_cmp_lg_u32 s41, 0
s_cbranch_scc1 Lpoll_92
Lpok_93:
Lw_91:
s_and_b32 s44, s36, 3
s_mul_i32 s44, s44, 14
s_bfe_u32 s43, s2, 0x30001
s_lshl_b32 s43, s43, 7
s_add_u32 s44, s44, s43
s_add_u32 s44, s44, 72
s_mul_i32 s44, s44, 7168
s_lshr_b32 s43, s2, 4
s_lshl_b32 s43, s43, 8
s_add_u32 s43, s43, s44
s_bitcmp0_b32 s2, 0
s_cselect_b32 s4, s72, s74
s_cselect_b32 s5, s73, s75
s_add_u32 s4, s4, s43
s_addc_u32 s5, s5, 0
s_cmp_eq_u32 s47, 3
s_cbranch_scc1 Lw_95
s_load_dword s3, s[4:5], 0
s_load_dword s3, s[4:5], 64
s_load_dword s3, s[4:5], 128
s_load_dword s3, s[4:5], 192
s_load_dword s3, s[4:5], 7168
s_load_dword s3, s[4:5], 7232
s_load_dword s3, s[4:5], 7296
s_load_dword s3, s[4:5], 7360
s_load_dword s3, s[4:5], 14336
s_load_dword s3, s[4:5], 14400
s_load_dword s3, s[4:5], 14464
s_load_dword s3, s[4:5], 14528
s_load_dword s3, s[4:5], 21504
s_load_dword s3, s[4:5], 21568
Lw_95:
s_waitcnt vmcnt(8)
s_barrier
s_add_u32 s37, s35, 1
s_and_b32 s37, s37, 15
s_lshl_b32 s37, s37, 14
s_add_u32 m0, s39, 49152
s_nop 0
buffer_load_dwordx4 v2, s[8:11], s37 offen offset:0 sc1 lds
buffer_load_dwordx4 v2, s[8:11], s37 offen offset:1024 sc1 lds
buffer_load_dwordx4 v2, s[8:11], s37 offen offset:2048 sc1 lds
buffer_load_dwordx4 v2, s[8:11], s37 offen offset:3072 sc1 lds
s_add_u32 s37, s35, 2
s_and_b32 s37, s37, 15
s_lshl_b32 s37, s37, 14
s_add_u32 m0, s39, 98304
s_nop 0
buffer_load_dwordx4 v2, s[8:11], s37 offen offset:0 sc1 lds
buffer_load_dwordx4 v2, s[8:11], s37 offen offset:1024 sc1 lds
buffer_load_dwordx4 v2, s[8:11], s37 offen offset:2048 sc1 lds
buffer_load_dwordx4 v2, s[8:11], s37 offen offset:3072 sc1 lds
s_add_u32 s37, s35, 3
s_and_b32 s37, s37, 15
s_lshl_b32 s37, s37, 14
s_add_u32 m0, s39, 147456
s_nop 0
buffer_load_dwordx4 v2, s[8:11], s37 offen offset:0 sc1 lds
buffer_load_dwordx4 v2, s[8:11], s37 offen offset:1024 sc1 lds
buffer_load_dwordx4 v2, s[8:11], s37 offen offset:2048 sc1 lds
buffer_load_dwordx4 v2, s[8:11], s37 offen offset:3072 sc1 lds
s_cmp_eq_u32 s47, 3
s_cbranch_scc0 Lw_96
s_load_dword s3, s[4:5], 0
s_load_dword s3, s[4:5], 64
s_load_dword s3, s[4:5], 128
s_load_dword s3, s[4:5], 192
s_load_dword s3, s[4:5], 7168
s_load_dword s3, s[4:5], 7232
s_load_dword s3, s[4:5], 7296
s_load_dword s3, s[4:5], 7360
s_load_dword s3, s[4:5], 14336
s_load_dword s3, s[4:5], 14400
s_load_dword s3, s[4:5], 14464
s_load_dword s3, s[4:5], 14528
s_load_dword s3, s[4:5], 21504
s_load_dword s3, s[4:5], 21568
Lw_96:
s_waitcnt vmcnt(8)
s_barrier
s_add_u32 s37, s35, 4
s_and_b32 s37, s37, 15
s_lshl_b32 s37, s37, 14
s_add_u32 m0, s39, 0
s_nop 0
buffer_load_dwordx4 v2, s[8:11], s37 offen offset:0 sc1 lds
buffer_load_dwordx4 v2, s[8:11], s37 offen offset:1024 sc1 lds
buffer_load_dwordx4 v2, s[8:11], s37 offen offset:2048 sc1 lds
buffer_load_dwordx4 v2, s[8:11], s37 offen offset:3072 sc1 lds
s_add_u32 s38, s35, 8
s_and_b32 s38, s38, 15
s_lshl_b32 s38, s38, 17
s_add_u32 m0, s40, 16384
s_nop 0
buffer_load_dwordx4 v3, s[12:15], s38 offen lds
s_add_u32 m0, s40, 17408
s_add_u32 s38, s38, 16384
buffer_load_dwordx4 v3, s[12:15], s38 offen lds
v_lshlrev_b32 v240, 16, v128
v_and_b32 v241, 0xffff0000, v128
v_lshlrev_b32 v242, 16, v129
v_and_b32 v243, 0xffff0000, v129
v_lshlrev_b32 v244, 16, v130
v_and_b32 v245, 0xffff0000, v130
v_lshlrev_b32 v246, 16, v131
v_and_b32 v247, 0xffff0000, v131
s_load_dword s3, s[4:5], 21632
s_load_dword s3, s[4:5], 21696
s_load_dword s3, s[4:5], 28672
s_waitcnt vmcnt(10)
s_barrier
s_add_u32 s37, s35, 5
s_and_b32 s37, s37, 15
s_lshl_b32 s37, s37, 14
s_add_u32 m0, s39, 49152
s_nop 0
buffer_load_dwordx4 v2, s[8:11], s37 offen offset:0 sc1 lds
buffer_load_dwordx4 v2, s[8:11], s37 offen offset:1024 sc1 lds
buffer_load_dwordx4 v2, s[8:11], s37 offen offset:2048 sc1 lds
buffer_load_dwordx4 v2, s[8:11], s37 offen offset:3072 sc1 lds
s_add_u32 s38, s35, 9
s_and_b32 s38, s38, 15
s_lshl_b32 s38, s38, 17
s_add_u32 m0, s40, 24576
s_nop 0
buffer_load_dwordx4 v3, s[12:15], s38 offen lds
s_add_u32 m0, s40, 25600
s_add_u32 s38, s38, 16384
buffer_load_dwordx4 v3, s[12:15], s38 offen lds
v_lshlrev_b32 v24, 16, v132
v_and_b32 v25, 0xffff0000, v132
v_lshlrev_b32 v26, 16, v133
v_and_b32 v27, 0xffff0000, v133
v_lshlrev_b32 v28, 16, v134
v_and_b32 v29, 0xffff0000, v134
v_lshlrev_b32 v30, 16, v135
v_and_b32 v31, 0xffff0000, v135
v_add_f32 v240, v240, v24
v_add_f32 v241, v241, v25
v_add_f32 v242, v242, v26
v_add_f32 v243, v243, v27
v_add_f32 v244, v244, v28
v_add_f32 v245, v245, v29
v_add_f32 v246, v246, v30
v_add_f32 v247, v247, v31
s_load_dword s3, s[4:5], 28736
s_load_dword s3, s[4:5], 28800
s_load_dword s3, s[4:5], 28864
s_waitcnt vmcnt(12)
s_barrier
s_add_u32 s37, s35, 6
s_and_b32 s37, s37, 15
s_lshl_b32 s37, s37, 14
s_add_u32 m0, s39, 98304
s_nop 0
buffer_load_dwordx4 v2, s[8:11], s37 offen offset:0 sc1 lds
buffer_load_dwordx4 v2, s[8:11], s37 offen offset:1024 sc1 lds
buffer_load_dwordx4 v2, s[8:11], s37 offen offset:2048 sc1 lds
buffer_load_dwordx4 v2, s[8:11], s37 offen offset:3072 sc1 lds
s_add_u32 s38, s35, 10
s_and_b32 s38, s38, 15
s_lshl_b32 s38, s38, 17
s_add_u32 m0, s40, 32768
s_nop 0
buffer_load_dwordx4 v3, s[12:15], s38 offen lds
s_add_u32 m0, s40, 33792
s_add_u32 s38, s38, 16384
buffer_load_dwordx4 v3, s[12:15], s38 offen lds
v_lshlrev_b32 v24, 16, v136
v_and_b32 v25, 0xffff0000, v136
v_lshlrev_b32 v26, 16, v137
v_and_b32 v27, 0xffff0000, v137
v_lshlrev_b32 v28, 16, v138
v_and_b32 v29, 0xffff0000, v138
v_lshlrev_b32 v30, 16, v139
v_and_b32 v31, 0xffff0000, v139
v_add_f32 v240, v240, v24
v_add_f32 v241, v241, v25
v_add_f32 v242, v242, v26
v_add_f32 v243, v243, v27
v_add_f32 v244, v244, v28
v_add_f32 v245, v245, v29
v_add_f32 v246, v246, v30
v_add_f32 v247, v247, v31
s_load_dword s3, s[4:5], 35840
s_load_dword s3, s[4:5], 35904
s_load_dword s3, s[4:5], 35968
s_waitcnt vmcnt(14)
s_barrier
s_add_u32 s37, s35, 7
s_and_b32 s37, s37, 15
s_lshl_b32 s37, s37, 14
s_add_u32 m0, s39, 147456
s_nop 0
buffer_load_dwordx4 v2, s[8:11], s37 offen offset:0 sc1 lds
buffer_load_dwordx4 v2, s[8:11], s37 offen offset:1024 sc1 lds
buffer_load_dwordx4 v2, s[8:11], s37 offen offset:2048 sc1 lds
buffer_load_dwordx4 v2, s[8:11], s37 offen offset:3072 sc1 lds
s_add_u32 s38, s35, 11
s_and_b32 s38, s38, 15
s_lshl_b32 s38, s38, 17
s_add_u32 m0, s40, 40960
s_nop 0
buffer_load_dwordx4 v3, s[12:15], s38 offen lds
s_add_u32 m0, s40, 41984
s_add_u32 s38, s38, 16384
buffer_load_dwordx4 v3, s[12:15], s38 offen lds
v_lshlrev_b32 v24, 16, v140
v_and_b32 v25, 0xffff0000, v140
v_lshlrev_b32 v26, 16, v141
v_and_b32 v27, 0xffff0000, v141
v_lshlrev_b32 v28, 16, v142
v_and_b32 v29, 0xffff0000, v142
v_lshlrev_b32 v30, 16, v143
v_and_b32 v31, 0xffff0000, v143
v_add_f32 v240, v240, v24
v_add_f32 v241, v241, v25
v_add_f32 v242, v242, v26
v_add_f32 v243, v243, v27
v_add_f32 v244, v244, v28
v_add_f32 v245, v245, v29
v_add_f32 v246, v246, v30
v_add_f32 v247, v247, v31
s_load_dword s3, s[4:5], 36032
s_load_dword s3, s[4:5], 43008
s_load_dword s3, s[4:5], 43072
s_waitcnt vmcnt(14)
s_barrier
s_add_u32 s37, s35, 8
s_and_b32 s37, s37, 15
s_lshl_b32 s37, s37, 14
s_add_u32 m0, s39, 0
s_nop 0
buffer_load_dwordx4 v2, s[8:11], s37 offen offset:0 sc1 lds
buffer_load_dwordx4 v2, s[8:11], s37 offen offset:1024 sc1 lds
buffer_load_dwordx4 v2, s[8:11], s37 offen offset:2048 sc1 lds
buffer_load_dwordx4 v2, s[8:11], s37 offen offset:3072 sc1 lds
s_add_u32 s38, s35, 12
s_and_b32 s38, s38, 15
s_lshl_b32 s38, s38, 17
s_add_u32 m0, s40, 114688
s_nop 0
buffer_load_dwordx4 v3, s[12:15], s38 offen lds
s_add_u32 m0, s40, 115712
s_add_u32 s38, s38, 16384
buffer_load_dwordx4 v3, s[12:15], s38 offen lds
v_lshlrev_b32 v24, 16, v144
v_and_b32 v25, 0xffff0000, v144
v_lshlrev_b32 v26, 16, v145
v_and_b32 v27, 0xffff0000, v145
v_lshlrev_b32 v28, 16, v146
v_and_b32 v29, 0xffff0000, v146
v_lshlrev_b32 v30, 16, v147
v_and_b32 v31, 0xffff0000, v147
v_add_f32 v240, v240, v24
v_add_f32 v241, v241, v25
v_add_f32 v242, v242, v26
v_add_f32 v243, v243, v27
v_add_f32 v244, v244, v28
v_add_f32 v245, v245, v29
v_add_f32 v246, v246, v30
v_add_f32 v247, v247, v31
s_load_dword s3, s[4:5], 43136
s_load_dword s3, s[4:5], 43200
s_load_dword s3, s[4:5], 50176
s_waitcnt vmcnt(14)
s_barrier
s_add_u32 s37, s35, 9
s_and_b32 s37, s37, 15
s_lshl_b32 s37, s37, 14
s_add_u32 m0, s39, 49152
s_nop 0
buffer_load_dwordx4 v2, s[8:11], s37 offen offset:0 sc1 lds
buffer_load_dwordx4 v2, s[8:11], s37 offen offset:1024 sc1 lds
buffer_load_dwordx4 v2, s[8:11], s37 offen offset:2048 sc1 lds
buffer_load_dwordx4 v2, s[8:11], s37 offen offset:3072 sc1 lds
s_add_u32 s38, s35, 13
s_and_b32 s38, s38, 15
s_lshl_b32 s38, s38, 17
s_add_u32 m0, s40, 122880
s_nop 0
buffer_load_dwordx4 v3, s[12:15], s38 offen lds
s_add_u32 m0, s40, 123904
s_add_u32 s38, s38, 16384
buffer_load_dwordx4 v3, s[12:15], s38 offen lds
v_lshlrev_b32 v24, 16, v148
v_and_b32 v25, 0xffff0000, v148
v_lshlrev_b32 v26, 16, v149
v_and_b32 v27, 0xffff0000, v149
v_lshlrev_b32 v28, 16, v150
v_and_b32 v29, 0xffff0000, v150
v_lshlrev_b32 v30, 16, v151
v_and_b32 v31, 0xffff0000, v151
v_add_f32 v240, v240, v24
v_add_f32 v241, v241, v25
v_add_f32 v242, v242, v26
v_add_f32 v243, v243, v27
v_add_f32 v244, v244, v28
v_add_f32 v245, v245, v29
v_add_f32 v246, v246, v30
v_add_f32 v247, v247, v31
s_load_dword s3, s[4:5], 50240
s_load_dword s3, s[4:5], 50304
s_load_dword s3, s[4:5], 50368
s_waitcnt vmcnt(14)
s_barrier
s_add_u32 s37, s35, 10
s_and_b32 s37, s37, 15
s_lshl_b32 s37, s37, 14
s_add_u32 m0, s39, 98304
s_nop 0
buffer_load_dwordx4 v2, s[8:11], s37 offen offset:0 sc1 lds
buffer_load_dwordx4 v2, s[8:11], s37 offen offset:1024 sc1 lds
buffer_load_dwordx4 v2, s[8:11], s37 offen offset:2048 sc1 lds
buffer_load_dwordx4 v2, s[8:11], s37 offen offset:3072 sc1 lds
s_add_u32 s38, s35, 14
s_and_b32 s38, s38, 15
s_lshl_b32 s38, s38, 17
s_add_u32 m0, s40, 131072
s_nop 0
buffer_load_dwordx4 v3, s[12:15], s38 offen lds
s_add_u32 m0, s40, 132096
s_add_u32 s38, s38, 16384
buffer_load_dwordx4 v3, s[12:15], s38 offen lds
v_lshlrev_b32 v24, 16, v152
v_and_b32 v25, 0xffff0000, v152
v_lshlrev_b32 v26, 16, v153
v_and_b32 v27, 0xffff0000, v153
v_lshlrev_b32 v28, 16, v154
v_and_b32 v29, 0xffff0000, v154
v_lshlrev_b32 v30, 16, v155
v_and_b32 v31, 0xffff0000, v155
v_add_f32 v240, v240, v24
v_add_f32 v241, v241, v25
v_add_f32 v242, v242, v26
v_add_f32 v243, v243, v27
v_add_f32 v244, v244, v28
v_add_f32 v245, v245, v29
v_add_f32 v246, v246, v30
v_add_f32 v247, v247, v31
s_load_dword s3, s[4:5], 57344
s_load_dword s3, s[4:5], 57408
s_load_dword s3, s[4:5], 57472
s_waitcnt vmcnt(14)
s_barrier
s_add_u32 s37, s35, 11
s_and_b32 s37, s37, 15
s_lshl_b32 s37, s37, 14
s_add_u32 m0, s39, 147456
s_nop 0
buffer_load_dwordx4 v2, s[8:11], s37 offen offset:0 sc1 lds
buffer_load_dwordx4 v2, s[8:11], s37 offen offset:1024 sc1 lds
buffer_load_dwordx4 v2, s[8:11], s37 offen offset:2048 sc1 lds
buffer_load_dwordx4 v2, s[8:11], s37 offen offset:3072 sc1 lds
s_add_u32 s38, s35, 15
s_and_b32 s38, s38, 15
s_lshl_b32 s38, s38, 17
s_add_u32 m0, s40, 139264
s_nop 0
buffer_load_dwordx4 v3, s[12:15], s38 offen lds
s_add_u32 m0, s40, 140288
s_add_u32 s38, s38, 16384
buffer_load_dwordx4 v3, s[12:15], s38 offen lds
v_lshlrev_b32 v24, 16, v156
v_and_b32 v25, 0xffff0000, v156
v_lshlrev_b32 v26, 16, v157
v_and_b32 v27, 0xffff0000, v157
v_lshlrev_b32 v28, 16, v158
v_and_b32 v29, 0xffff0000, v158
v_lshlrev_b32 v30, 16, v159
v_and_b32 v31, 0xffff0000, v159
v_add_f32 v240, v240, v24
v_add_f32 v241, v241, v25
v_add_f32 v242, v242, v26
v_add_f32 v243, v243, v27
v_add_f32 v244, v244, v28
v_add_f32 v245, v245, v29
v_add_f32 v246, v246, v30
v_add_f32 v247, v247, v31
s_load_dword s3, s[4:5], 57536
s_load_dword s3, s[4:5], 64512
s_load_dword s3, s[4:5], 64576
s_waitcnt vmcnt(14)
s_barrier
s_add_u32 s37, s35, 12
s_and_b32 s37, s37, 15
s_lshl_b32 s37, s37, 14
s_add_u32 m0, s39, 0
s_nop 0
buffer_load_dwordx4 v2, s[8:11], s37 offen offset:0 sc1 lds
buffer_load_dwordx4 v2, s[8:11], s37 offen offset:1024 sc1 lds
buffer_load_dwordx4 v2, s[8:11], s37 offen offset:2048 sc1 lds
buffer_load_dwordx4 v2, s[8:11], s37 offen offset:3072 sc1 lds
s_load_dword s3, s[4:5], 64640
s_load_dword s3, s[4:5], 64704
s_branch Lov_7
.p2align 12
.fill 48, 4, 0xbf800000
Lst_7_0:
s_branch Lwr_148
s_nop 0
s_nop 0
Lov_7:
s_load_dword s3, s[4:5], 71680
s_waitcnt vmcnt(12)
s_barrier
s_add_u32 s37, s35, 13
s_and_b32 s37, s37, 15
s_lshl_b32 s37, s37, 14
s_add_u32 m0, s39, 49152
s_nop 0
buffer_load_dwordx4 v2, s[8:11], s37 offen offset:0 sc1 lds
buffer_load_dwordx4 v2, s[8:11], s37 offen offset:1024 sc1 lds
buffer_load_dwordx4 v2, s[8:11], s37 offen offset:2048 sc1 lds
buffer_load_dwordx4 v2, s[8:11], s37 offen offset:3072 sc1 lds
s_load_dword s3, s[4:5], 71744
s_load_dword s3, s[4:5], 71808
s_load_dword s3, s[4:5], 71872
s_waitcnt vmcnt(10)
s_barrier
s_add_u32 s37, s35, 14
s_and_b32 s37, s37, 15
s_lshl_b32 s37, s37, 14
s_add_u32 m0, s39, 98304
s_nop 0
buffer_load_dwordx4 v2, s[8:11], s37 offen offset:0 sc1 lds
buffer_load_dwordx4 v2, s[8:11], s37 offen offset:1024 sc1 lds
buffer_load_dwordx4 v2, s[8:11], s37 offen offset:2048 sc1 lds
buffer_load_dwordx4 v2, s[8:11], s37 offen offset:3072 sc1 lds
s_waitcnt vmcnt(8)
s_barrier
s_add_u32 s37, s35, 15
s_and_b32 s37, s37, 15
s_lshl_b32 s37, s37, 14
s_add_u32 m0, s39, 147456
s_nop 0
buffer_load_dwordx4 v2, s[8:11], s37 offen offset:0 sc1 lds
buffer_load_dwordx4 v2, s[8:11], s37 offen offset:1024 sc1 lds
buffer_load_dwordx4 v2, s[8:11], s37 offen offset:2048 sc1 lds
buffer_load_dwordx4 v2, s[8:11], s37 offen offset:3072 sc1 lds
s_waitcnt vmcnt(8)
s_barrier
s_nop 0
v_permlane32_swap_b32 v240, v244
v_permlane32_swap_b32 v241, v245
v_permlane32_swap_b32 v242, v246
v_permlane32_swap_b32 v243, v247
v_add_f32 v240, v240, v244
v_add_f32 v241, v241, v245
v_add_f32 v242, v242, v246
v_add_f32 v243, v243, v247
s_nop 0
v_permlane16_swap_b32 v240, v242
v_permlane16_swap_b32 v241, v243
v_add_f32 v240, v240, v242
v_add_f32 v241, v241, v243
s_waitcnt vmcnt(4)
s_barrier
s_add_u32 s38, s35, 0
s_and_b32 s38, s38, 15
s_mul_i32 s38, s38, 458752
s_add_u32 m0, s50, 0
s_nop 0
buffer_load_dwordx4 v192, s[16:19], s38 offen lds
s_add_u32 m0, s50, 1024
s_nop 0
buffer_load_dwordx4 v193, s[16:19], s38 offen lds
s_add_u32 m0, s50, 2048
s_nop 0
buffer_load_dwordx4 v194, s[16:19], s38 offen lds
s_add_u32 m0, s50, 3072
s_add_u32 s38, s38, 114688
buffer_load_dwordx4 v192, s[16:19], s38 offen lds
s_add_u32 m0, s50, 4096
s_nop 0
buffer_load_dwordx4 v193, s[16:19], s38 offen lds
s_add_u32 m0, s50, 5120
s_nop 0
buffer_load_dwordx4 v194, s[16:19], s38 offen lds
s_add_u32 s38, s35, 1
s_and_b32 s38, s38, 15
s_mul_i32 s38, s38, 458752
s_add_u32 m0, s50, 49152
s_nop 0
buffer_load_dwordx4 v192, s[16:19], s38 offen lds
s_add_u32 m0, s50, 50176
s_nop 0
buffer_load_dwordx4 v193, s[16:19], s38 offen lds
s_add_u32 m0, s50, 51200
s_nop 0
buffer_load_dwordx4 v194, s[16:19], s38 offen lds
s_add_u32 m0, s50, 52224
s_add_u32 s38, s38, 114688
buffer_load_dwordx4 v192, s[16:19], s38 offen lds
s_add_u32 m0, s50, 53248
s_nop 0
buffer_load_dwordx4 v193, s[16:19], s38 offen lds
s_add_u32 m0, s50, 54272
s_nop 0
buffer_load_dwordx4 v194, s[16:19], s38 offen lds
s_waitcnt vmcnt(12)
s_barrier
s_barrier
s_branch Lk3a
Lk2end_83:
Lk3:
s_branch Lgb_97
Lk3a:
s_mul_i32 s43, s34, 262144
s_add_u32 s8, s82, s43
s_addc_u32 s9, s83, 0
s_add_u32 s8, s8, 4194304
s_addc_u32 s9, s9, 0
s_mov_b32 s10, 262144
s_mov_b32 s11, 0x20000
s_mul_i32 s43, s34, 917504
s_add_u32 s24, s82, s43
s_addc_u32 s25, s83, 0
s_add_u32 s24, s24, 8388608
s_addc_u32 s25, s25, 0
s_mov_b32 s26, 917504
s_mov_b32 s27, 0x20000
s_add_u32 s84, s82, 27262976
s_addc_u32 s85, s83, 0
s_mov_b32 s86, 229376
s_mov_b32 s87, 0x20000
s_and_b32 s47, s36, 3
s_lshr_b32 s62, s47, 1
s_and_b32 s63, s47, 1
v_lshlrev_b32 v2, 4, v1
s_lshl_b32 s39, s47, 12
v_add_u32 v3, s39, v2
s_bitcmp0_b32 s36, 1
s_cselect_b32 s44, s72, s74
s_cselect_b32 s45, s73, s75
s_mul_i32 s43, s35, 256
s_add_u32 s12, s44, s43
s_addc_u32 s13, s45, 0
s_mov_b32 s14, 7333120
s_mov_b32 s15, 0x20000
s_and_b32 s43, s36, 1
s_mul_i32 s43, s43, 229376
v_lshrrev_b32 v28, 4, v1
v_lshlrev_b32 v29, 1, v28
v_and_b32 v4, 15, v1
v_xor_b32 v4, v4, v29
v_lshlrev_b32 v4, 4, v4
v_mul_u32_u24 v28, 7168, v28
v_add_u32 v4, v4, v28
v_add_u32 v4, s43, v4
v_xor_b32 v5, 128, v4
v_add_u32 v5, 28672, v5
s_and_b32 s43, s36, 3
s_mul_i32 s40, s43, 8192
s_add_u32 s40, s40, 16384
v_mov_b32 v6, v192
v_mov_b32 v7, v193
v_mov_b32 v8, v194
s_lshl_b32 s43, s62, 12
v_add_u32 v9, s43, v2
v_add_u32 v10, 98304, v9
s_lshl_b32 s43, s47, 9
s_add_u32 s43, s43, 151552
v_and_b32 v28, 15, v1
v_lshl_add_u32 v28, v28, 5, s43
v_lshrrev_b32 v29, 4, v1
v_lshl_add_u32 v28, v29, 3, v28
ds_write_b64 v28, v[240:241]
s_waitcnt lgkmcnt(0)
v_lshrrev_b32 v27, 2, v1
v_bfe_u32 v28, v27, 2, 1
v_mul_u32_u24 v27, 192, v27
v_add_u32 v27, 16384, v27
v_and_b32 v29, 3, v1
v_lshl_add_u32 v12, v29, 3, v27
s_lshl_b32 s43, s63, 6
v_add_u32 v12, s43, v12
v_lshl_add_u32 v11, v28, 5, v12
v_xor_b32 v30, 1, v28
v_lshl_add_u32 v12, v30, 5, v12
v_xor_b32 v28, s63, v28
v_lshl_add_u32 v27, v28, 4, v27
v_lshrrev_b32 v28, 1, v29
v_lshl_add_u32 v27, v28, 5, v27
v_and_b32 v28, 1, v29
v_lshl_add_u32 v27, v28, 3, v27
v_add_u32 v13, 128, v27
v_add_u32 v14, 49152, v11
v_add_u32 v15, 49152, v12
v_add_u32 v16, 49152, v13
v_add_u32 v17, 98304, v11
v_add_u32 v18, 98304, v12
v_add_u32 v19, 98304, v13
s_cmp_lg_u32 s36, 4
s_cbranch_scc1 Lwm_99
s_branch Lst_8_1
Lwr_164:
s_branch Lwe_98
Lwm_99:
s_cmp_lg_u32 s36, 5
s_cbranch_scc1 Lwm_100
s_branch Lst_9_1
Lwr_165:
s_branch Lwe_98
Lwm_100:
s_cmp_lg_u32 s36, 6
s_cbranch_scc1 Lwm_101
s_branch Lst_10_1
Lwr_166:
s_branch Lwe_98
Lwm_101:
s_cmp_lg_u32 s36, 7
s_cbranch_scc1 Lwm_102
s_nop 0
s_branch Lwe_98
Lwm_102:
Lwe_98:
s_barrier
s_cmp_lg_u32 s36, 4
s_cbranch_scc1 Lwm_104
s_branch Lst_11_1
Lwr_168:
s_branch Lwe_103
Lwm_104:
s_cmp_lg_u32 s36, 5
s_cbranch_scc1 Lwm_105
s_branch Lst_12_1
Lwr_169:
s_branch Lwe_103
Lwm_105:
s_cmp_lg_u32 s36, 6
s_cbranch_scc1 Lwm_106
s_branch Lst_13_1
Lwr_170:
s_branch Lwe_103
Lwm_106:
s_cmp_lg_u32 s36, 7
s_cbranch_scc1 Lwm_107
s_branch Lst_14_1
Lwr_171:
s_branch Lwe_103
Lwm_107:
Lwe_103:
s_waitcnt vmcnt(0) lgkmcnt(0)
s_barrier
ds_read_b128 v[32:35], v9 offset:0
ds_read_b64_tr_b16 v[48:49], v11 offset:0
ds_read_b64_tr_b16 v[50:51], v11 offset:3072
ds_read_b64_tr_b16 v[52:53], v12 offset:0
ds_read_b64_tr_b16 v[54:55], v12 offset:3072
ds_read_b64_tr_b16 v[56:57], v13 offset:0
ds_read_b64_tr_b16 v[58:59], v13 offset:3072
ds_read_b64_tr_b16 v[60:61], v11 offset:12288
ds_read_b64_tr_b16 v[62:63], v11 offset:15360
ds_read_b64_tr_b16 v[64:65], v12 offset:12288
ds_read_b64_tr_b16 v[66:67], v12 offset:15360
ds_read_b64_tr_b16 v[68:69], v13 offset:12288
ds_read_b64_tr_b16 v[70:71], v13 offset:15360
ds_read_b128 v[36:39], v9 offset:1024
ds_read_b128 v[40:43], v9 offset:2048
ds_read_b128 v[44:47], v9 offset:3072
s_waitcnt lgkmcnt(0)
v_mfma_f32_16x16x32_bf16 v[128:131], v[48:51], v[32:35], 0
ds_read_b128 v[72:75], v9 offset:8192
v_mfma_f32_16x16x32_bf16 v[132:135], v[52:55], v[32:35], 0
ds_read_b64_tr_b16 v[88:89], v11 offset:6144
v_mfma_f32_16x16x32_bf16 v[136:139], v[56:59], v[32:35], 0
ds_read_b64_tr_b16 v[90:91], v11 offset:9216
v_mfma_f32_16x16x32_bf16 v[140:143], v[60:63], v[32:35], 0
ds_read_b64_tr_b16 v[92:93], v12 offset:6144
v_mfma_f32_16x16x32_bf16 v[144:147], v[64:67], v[32:35], 0
ds_read_b64_tr_b16 v[94:95], v12 offset:9216
v_mfma_f32_16x16x32_bf16 v[148:151], v[68:71], v[32:35], 0
ds_read_b64_tr_b16 v[96:97], v13 offset:6144
v_mfma_f32_16x16x32_bf16 v[172:175], v[68:71], v[36:39], 0
ds_read_b64_tr_b16 v[98:99], v13 offset:9216
v_mfma_f32_16x16x32_bf16 v[168:171], v[64:67], v[36:39], 0
ds_read_b64_tr_b16 v[100:101], v11 offset:18432
v_mfma_f32_16x16x32_bf16 v[164:167], v[60:63], v[36:39], 0
ds_read_b64_tr_b16 v[102:103], v11 offset:21504
v_mfma_f32_16x16x32_bf16 v[160:163], v[56:59], v[36:39], 0
ds_read_b64_tr_b16 v[104:105], v12 offset:18432
v_mfma_f32_16x16x32_bf16 v[156:159], v[52:55], v[36:39], 0
ds_read_b64_tr_b16 v[106:107], v12 offset:21504
v_mfma_f32_16x16x32_bf16 v[152:155], v[48:51], v[36:39], 0
ds_read_b64_tr_b16 v[108:109], v13 offset:18432
v_mfma_f32_16x16x32_bf16 v[176:179], v[48:51], v[40:43], 0
ds_read_b64_tr_b16 v[110:111], v13 offset:21504
v_mfma_f32_16x16x32_bf16 v[180:183], v[52:55], v[40:43], 0
ds_read_b128 v[76:79], v9 offset:9216
v_mfma_f32_16x16x32_bf16 v[184:187], v[56:59], v[40:43], 0
ds_read_b128 v[80:83], v9 offset:10240
v_mfma_f32_16x16x32_bf16 v[188:191], v[60:63], v[40:43], 0
ds_read_b128 v[84:87], v9 offset:11264
v_mfma_f32_16x16x32_bf16 v[192:195], v[64:67], v[40:43], 0
v_mfma_f32_16x16x32_bf16 v[196:199], v[68:71], v[40:43], 0
v_mfma_f32_16x16x32_bf16 v[220:223], v[68:71], v[44:47], 0
v_mfma_f32_16x16x32_bf16 v[216:219], v[64:67], v[44:47], 0
v_mfma_f32_16x16x32_bf16 v[212:215], v[60:63], v[44:47], 0
v_mfma_f32_16x16x32_bf16 v[208:211], v[56:59], v[44:47], 0
v_mfma_f32_16x16x32_bf16 v[204:207], v[52:55], v[44:47], 0
v_mfma_f32_16x16x32_bf16 v[200:203], v[48:51], v[44:47], 0
s_waitcnt lgkmcnt(0)
s_barrier
v_mfma_f32_16x16x32_bf16 v[128:131], v[88:91], v[72:75], v[128:131]
ds_read_b128 v[32:35], v9 offset:49152
v_mfma_f32_16x16x32_bf16 v[132:135], v[92:95], v[72:75], v[132:135]
ds_read_b64_tr_b16 v[48:49], v14 offset:0
v_mfma_f32_16x16x32_bf16 v[136:139], v[96:99], v[72:75], v[136:139]
ds_read_b64_tr_b16 v[50:51], v14 offset:3072
v_mfma_f32_16x16x32_bf16 v[140:143], v[100:103], v[72:75], v[140:143]
ds_read_b64_tr_b16 v[52:53], v15 offset:0
v_mfma_f32_16x16x32_bf16 v[144:147], v[104:107], v[72:75], v[144:147]
ds_read_b64_tr_b16 v[54:55], v15 offset:3072
v_mfma_f32_16x16x32_bf16 v[148:151], v[108:111], v[72:75], v[148:151]
ds_read_b64_tr_b16 v[56:57], v16 offset:0
v_mfma_f32_16x16x32_bf16 v[172:175], v[108:111], v[76:79], v[172:175]
ds_read_b64_tr_b16 v[58:59], v16 offset:3072
v_mfma_f32_16x16x32_bf16 v[168:171], v[104:107], v[76:79], v[168:171]
ds_read_b64_tr_b16 v[60:61], v14 offset:12288
v_mfma_f32_16x16x32_bf16 v[164:167], v[100:103], v[76:79], v[164:167]
ds_read_b64_tr_b16 v[62:63], v14 offset:15360
v_mfma_f32_16x16x32_bf16 v[160:163], v[96:99], v[76:79], v[160:163]
ds_read_b64_tr_b16 v[64:65], v15 offset:12288
v_mfma_f32_16x16x32_bf16 v[156:159], v[92:95], v[76:79], v[156:159]
ds_read_b64_tr_b16 v[66:67], v15 offset:15360
v_mfma_f32_16x16x32_bf16 v[152:155], v[88:91], v[76:79], v[152:155]
ds_read_b64_tr_b16 v[68:69], v16 offset:12288
v_mfma_f32_16x16x32_bf16 v[176:179], v[88:91], v[80:83], v[176:179]
ds_read_b64_tr_b16 v[70:71], v16 offset:15360
v_mfma_f32_16x16x32_bf16 v[180:183], v[92:95], v[80:83], v[180:183]
ds_read_b128 v[36:39], v9 offset:50176
v_mfma_f32_16x16x32_bf16 v[184:187], v[96:99], v[80:83], v[184:187]
ds_read_b128 v[40:43], v9 offset:51200
v_mfma_f32_16x16x32_bf16 v[188:191], v[100:103], v[80:83], v[188:191]
ds_read_b128 v[44:47], v9 offset:52224
v_mfma_f32_16x16x32_bf16 v[192:195], v[104:107], v[80:83], v[192:195]
v_mfma_f32_16x16x32_bf16 v[196:199], v[108:111], v[80:83], v[196:199]
v_mfma_f32_16x16x32_bf16 v[220:223], v[108:111], v[84:87], v[220:223]
v_mfma_f32_16x16x32_bf16 v[216:219], v[104:107], v[84:87], v[216:219]
v_mfma_f32_16x16x32_bf16 v[212:215], v[100:103], v[84:87], v[212:215]
v_mfma_f32_16x16x32_bf16 v[208:211], v[96:99], v[84:87], v[208:211]
v_mfma_f32_16x16x32_bf16 v[204:207], v[92:95], v[84:87], v[204:207]
v_mfma_f32_16x16x32_bf16 v[200:203], v[88:91], v[84:87], v[200:203]
s_mov_b32 s41, 5
Lk3l_108:
s_waitcnt lgkmcnt(0)
v_mfma_f32_16x16x32_bf16 v[128:131], v[48:51], v[32:35], v[128:131]
ds_read_b128 v[72:75], v9 offset:57344
v_mfma_f32_16x16x32_bf16 v[132:135], v[52:55], v[32:35], v[132:135]
ds_read_b64_tr_b16 v[88:89], v14 offset:6144
v_mfma_f32_16x16x32_bf16 v[136:139], v[56:59], v[32:35], v[136:139]
ds_read_b64_tr_b16 v[90:91], v14 offset:9216
v_mfma_f32_16x16x32_bf16 v[140:143], v[60:63], v[32:35], v[140:143]
ds_read_b64_tr_b16 v[92:93], v15 offset:6144
v_mfma_f32_16x16x32_bf16 v[144:147], v[64:67], v[32:35], v[144:147]
ds_read_b64_tr_b16 v[94:95], v15 offset:9216
v_mfma_f32_16x16x32_bf16 v[148:151], v[68:71], v[32:35], v[148:151]
ds_read_b64_tr_b16 v[96:97], v16 offset:6144
v_mfma_f32_16x16x32_bf16 v[172:175], v[68:71], v[36:39], v[172:175]
ds_read_b64_tr_b16 v[98:99], v16 offset:9216
v_mfma_f32_16x16x32_bf16 v[168:171], v[64:67], v[36:39], v[168:171]
ds_read_b64_tr_b16 v[100:101], v14 offset:18432
v_mfma_f32_16x16x32_bf16 v[164:167], v[60:63], v[36:39], v[164:167]
ds_read_b64_tr_b16 v[102:103], v14 offset:21504
v_mfma_f32_16x16x32_bf16 v[160:163], v[56:59], v[36:39], v[160:163]
ds_read_b64_tr_b16 v[104:105], v15 offset:18432
v_mfma_f32_16x16x32_bf16 v[156:159], v[52:55], v[36:39], v[156:159]
ds_read_b64_tr_b16 v[106:107], v15 offset:21504
v_mfma_f32_16x16x32_bf16 v[152:155], v[48:51], v[36:39], v[152:155]
ds_read_b64_tr_b16 v[108:109], v16 offset:18432
v_mfma_f32_16x16x32_bf16 v[176:179], v[48:51], v[40:43], v[176:179]
ds_read_b64_tr_b16 v[110:111], v16 offset:21504
v_mfma_f32_16x16x32_bf16 v[180:183], v[52:55], v[40:43], v[180:183]
ds_read_b128 v[76:79], v9 offset:58368
v_mfma_f32_16x16x32_bf16 v[184:187], v[56:59], v[40:43], v[184:187]
ds_read_b128 v[80:83], v9 offset:59392
v_mfma_f32_16x16x32_bf16 v[188:191], v[60:63], v[40:43], v[188:191]
ds_read_b128 v[84:87], v9 offset:60416
v_mfma_f32_16x16x32_bf16 v[192:195], v[64:67], v[40:43], v[192:195]
v_mfma_f32_16x16x32_bf16 v[196:199], v[68:71], v[40:43], v[196:199]
v_mfma_f32_16x16x32_bf16 v[220:223], v[68:71], v[44:47], v[220:223]
v_mfma_f32_16x16x32_bf16 v[216:219], v[64:67], v[44:47], v[216:219]
v_mfma_f32_16x16x32_bf16 v[212:215], v[60:63], v[44:47], v[212:215]
v_mfma_f32_16x16x32_bf16 v[208:211], v[56:59], v[44:47], v[208:211]
v_mfma_f32_16x16x32_bf16 v[204:207], v[52:55], v[44:47], v[204:207]
v_mfma_f32_16x16x32_bf16 v[200:203], v[48:51], v[44:47], v[200:203]
s_waitcnt lgkmcnt(0)
s_barrier
v_mfma_f32_16x16x32_bf16 v[128:131], v[88:91], v[72:75], v[128:131]
ds_read_b128 v[32:35], v10 offset:0
v_mfma_f32_16x16x32_bf16 v[132:135], v[92:95], v[72:75], v[132:135]
ds_read_b64_tr_b16 v[48:49], v17 offset:0
v_mfma_f32_16x16x32_bf16 v[136:139], v[96:99], v[72:75], v[136:139]
ds_read_b64_tr_b16 v[50:51], v17 offset:3072
v_mfma_f32_16x16x32_bf16 v[140:143], v[100:103], v[72:75], v[140:143]
ds_read_b64_tr_b16 v[52:53], v18 offset:0
v_mfma_f32_16x16x32_bf16 v[144:147], v[104:107], v[72:75], v[144:147]
ds_read_b64_tr_b16 v[54:55], v18 offset:3072
v_mfma_f32_16x16x32_bf16 v[148:151], v[108:111], v[72:75], v[148:151]
ds_read_b64_tr_b16 v[56:57], v19 offset:0
v_mfma_f32_16x16x32_bf16 v[172:175], v[108:111], v[76:79], v[172:175]
ds_read_b64_tr_b16 v[58:59], v19 offset:3072
v_mfma_f32_16x16x32_bf16 v[168:171], v[104:107], v[76:79], v[168:171]
ds_read_b64_tr_b16 v[60:61], v17 offset:12288
v_mfma_f32_16x16x32_bf16 v[164:167], v[100:103], v[76:79], v[164:167]
ds_read_b64_tr_b16 v[62:63], v17 offset:15360
v_mfma_f32_16x16x32_bf16 v[160:163], v[96:99], v[76:79], v[160:163]
ds_read_b64_tr_b16 v[64:65], v18 offset:12288
v_mfma_f32_16x16x32_bf16 v[156:159], v[92:95], v[76:79], v[156:159]
ds_read_b64_tr_b16 v[66:67], v18 offset:15360
v_mfma_f32_16x16x32_bf16 v[152:155], v[88:91], v[76:79], v[152:155]
ds_read_b64_tr_b16 v[68:69], v19 offset:12288
v_mfma_f32_16x16x32_bf16 v[176:179], v[88:91], v[80:83], v[176:179]
ds_read_b64_tr_b16 v[70:71], v19 offset:15360
v_mfma_f32_16x16x32_bf16 v[180:183], v[92:95], v[80:83], v[180:183]
ds_read_b128 v[36:39], v10 offset:1024
v_mfma_f32_16x16x32_bf16 v[184:187], v[96:99], v[80:83], v[184:187]
ds_read_b128 v[40:43], v10 offset:2048
v_mfma_f32_16x16x32_bf16 v[188:191], v[100:103], v[80:83], v[188:191]
ds_read_b128 v[44:47], v10 offset:3072
v_mfma_f32_16x16x32_bf16 v[192:195], v[104:107], v[80:83], v[192:195]
v_mfma_f32_16x16x32_bf16 v[196:199], v[108:111], v[80:83], v[196:199]
v_mfma_f32_16x16x32_bf16 v[220:223], v[108:111], v[84:87], v[220:223]
v_mfma_f32_16x16x32_bf16 v[216:219], v[104:107], v[84:87], v[216:219]
v_mfma_f32_16x16x32_bf16 v[212:215], v[100:103], v[84:87], v[212:215]
v_mfma_f32_16x16x32_bf16 v[208:211], v[96:99], v[84:87], v[208:211]
v_mfma_f32_16x16x32_bf16 v[204:207], v[92:95], v[84:87], v[204:207]
v_mfma_f32_16x16x32_bf16 v[200:203], v[88:91], v[84:87], v[200:203]
s_waitcnt lgkmcnt(0)
v_mfma_f32_16x16x32_bf16 v[128:131], v[48:51], v[32:35], v[128:131]
ds_read_b128 v[72:75], v10 offset:8192
v_mfma_f32_16x16x32_bf16 v[132:135], v[52:55], v[32:35], v[132:135]
ds_read_b64_tr_b16 v[88:89], v17 offset:6144
v_mfma_f32_16x16x32_bf16 v[136:139], v[56:59], v[32:35], v[136:139]
ds_read_b64_tr_b16 v[90:91], v17 offset:9216
v_mfma_f32_16x16x32_bf16 v[140:143], v[60:63], v[32:35], v[140:143]
ds_read_b64_tr_b16 v[92:93], v18 offset:6144
v_mfma_f32_16x16x32_bf16 v[144:147], v[64:67], v[32:35], v[144:147]
ds_read_b64_tr_b16 v[94:95], v18 offset:9216
v_mfma_f32_16x16x32_bf16 v[148:151], v[68:71], v[32:35], v[148:151]
ds_read_b64_tr_b16 v[96:97], v19 offset:6144
v_mfma_f32_16x16x32_bf16 v[172:175], v[68:71], v[36:39], v[172:175]
ds_read_b64_tr_b16 v[98:99], v19 offset:9216
v_mfma_f32_16x16x32_bf16 v[168:171], v[64:67], v[36:39], v[168:171]
ds_read_b64_tr_b16 v[100:101], v17 offset:18432
v_mfma_f32_16x16x32_bf16 v[164:167], v[60:63], v[36:39], v[164:167]
ds_read_b64_tr_b16 v[102:103], v17 offset:21504
v_mfma_f32_16x16x32_bf16 v[160:163], v[56:59], v[36:39], v[160:163]
ds_read_b64_tr_b16 v[104:105], v18 offset:18432
v_mfma_f32_16x16x32_bf16 v[156:159], v[52:55], v[36:39], v[156:159]
ds_read_b64_tr_b16 v[106:107], v18 offset:21504
v_mfma_f32_16x16x32_bf16 v[152:155], v[48:51], v[36:39], v[152:155]
ds_read_b64_tr_b16 v[108:109], v19 offset:18432
v_mfma_f32_16x16x32_bf16 v[176:179], v[48:51], v[40:43], v[176:179]
ds_read_b64_tr_b16 v[110:111], v19 offset:21504
v_mfma_f32_16x16x32_bf16 v[180:183], v[52:55], v[40:43], v[180:183]
ds_read_b128 v[76:79], v10 offset:9216
v_mfma_f32_16x16x32_bf16 v[184:187], v[56:59], v[40:43], v[184:187]
ds_read_b128 v[80:83], v10 offset:10240
v_mfma_f32_16x16x32_bf16 v[188:191], v[60:63], v[40:43], v[188:191]
ds_read_b128 v[84:87], v10 offset:11264
v_mfma_f32_16x16x32_bf16 v[192:195], v[64:67], v[40:43], v[192:195]
v_mfma_f32_16x16x32_bf16 v[196:199], v[68:71], v[40:43], v[196:199]
v_mfma_f32_16x16x32_bf16 v[220:223], v[68:71], v[44:47], v[220:223]
v_mfma_f32_16x16x32_bf16 v[216:219], v[64:67], v[44:47], v[216:219]
v_mfma_f32_16x16x32_bf16 v[212:215], v[60:63], v[44:47], v[212:215]
v_mfma_f32_16x16x32_bf16 v[208:211], v[56:59], v[44:47], v[208:211]
v_mfma_f32_16x16x32_bf16 v[204:207], v[52:55], v[44:47], v[204:207]
v_mfma_f32_16x16x32_bf16 v[200:203], v[48:51], v[44:47], v[200:203]
s_waitcnt lgkmcnt(0)
s_barrier
v_mfma_f32_16x16x32_bf16 v[128:131], v[88:91], v[72:75], v[128:131]
ds_read_b128 v[32:35], v9 offset:0
v_mfma_f32_16x16x32_bf16 v[132:135], v[92:95], v[72:75], v[132:135]
ds_read_b64_tr_b16 v[48:49], v11 offset:0
v_mfma_f32_16x16x32_bf16 v[136:139], v[96:99], v[72:75], v[136:139]
ds_read_b64_tr_b16 v[50:51], v11 offset:3072
v_mfma_f32_16x16x32_bf16 v[140:143], v[100:103], v[72:75], v[140:143]
ds_read_b64_tr_b16 v[52:53], v12 offset:0
v_mfma_f32_16x16x32_bf16 v[144:147], v[104:107], v[72:75], v[144:147]
ds_read_b64_tr_b16 v[54:55], v12 offset:3072
v_mfma_f32_16x16x32_bf16 v[148:151], v[108:111], v[72:75], v[148:151]
ds_read_b64_tr_b16 v[56:57], v13 offset:0
v_mfma_f32_16x16x32_bf16 v[172:175], v[108:111], v[76:79], v[172:175]
ds_read_b64_tr_b16 v[58:59], v13 offset:3072
v_mfma_f32_16x16x32_bf16 v[168:171], v[104:107], v[76:79], v[168:171]
ds_read_b64_tr_b16 v[60:61], v11 offset:12288
v_mfma_f32_16x16x32_bf16 v[164:167], v[100:103], v[76:79], v[164:167]
ds_read_b64_tr_b16 v[62:63], v11 offset:15360
v_mfma_f32_16x16x32_bf16 v[160:163], v[96:99], v[76:79], v[160:163]
ds_read_b64_tr_b16 v[64:65], v12 offset:12288
v_mfma_f32_16x16x32_bf16 v[156:159], v[92:95], v[76:79], v[156:159]
ds_read_b64_tr_b16 v[66:67], v12 offset:15360
v_mfma_f32_16x16x32_bf16 v[152:155], v[88:91], v[76:79], v[152:155]
ds_read_b64_tr_b16 v[68:69], v13 offset:12288
v_mfma_f32_16x16x32_bf16 v[176:179], v[88:91], v[80:83], v[176:179]
ds_read_b64_tr_b16 v[70:71], v13 offset:15360
v_mfma_f32_16x16x32_bf16 v[180:183], v[92:95], v[80:83], v[180:183]
ds_read_b128 v[36:39], v9 offset:1024
v_mfma_f32_16x16x32_bf16 v[184:187], v[96:99], v[80:83], v[184:187]
ds_read_b128 v[40:43], v9 offset:2048
v_mfma_f32_16x16x32_bf16 v[188:191], v[100:103], v[80:83], v[188:191]
ds_read_b128 v[44:47], v9 offset:3072
v_mfma_f32_16x16x32_bf16 v[192:195], v[104:107], v[80:83], v[192:195]
v_mfma_f32_16x16x32_bf16 v[196:199], v[108:111], v[80:83], v[196:199]
v_mfma_f32_16x16x32_bf16 v[220:223], v[108:111], v[84:87], v[220:223]
v_mfma_f32_16x16x32_bf16 v[216:219], v[104:107], v[84:87], v[216:219]
v_mfma_f32_16x16x32_bf16 v[212:215], v[100:103], v[84:87], v[212:215]
v_mfma_f32_16x16x32_bf16 v[208:211], v[96:99], v[84:87], v[208:211]
v_mfma_f32_16x16x32_bf16 v[204:207], v[92:95], v[84:87], v[204:207]
v_mfma_f32_16x16x32_bf16 v[200:203], v[88:91], v[84:87], v[200:203]
s_waitcnt lgkmcnt(0)
v_mfma_f32_16x16x32_bf16 v[128:131], v[48:51], v[32:35], v[128:131]
ds_read_b128 v[72:75], v9 offset:8192
v_mfma_f32_16x16x32_bf16 v[132:135], v[52:55], v[32:35], v[132:135]
ds_read_b64_tr_b16 v[88:89], v11 offset:6144
v_mfma_f32_16x16x32_bf16 v[136:139], v[56:59], v[32:35], v[136:139]
ds_read_b64_tr_b16 v[90:91], v11 offset:9216
v_mfma_f32_16x16x32_bf16 v[140:143], v[60:63], v[32:35], v[140:143]
ds_read_b64_tr_b16 v[92:93], v12 offset:6144
v_mfma_f32_16x16x32_bf16 v[144:147], v[64:67], v[32:35], v[144:147]
ds_read_b64_tr_b16 v[94:95], v12 offset:9216
v_mfma_f32_16x16x32_bf16 v[148:151], v[68:71], v[32:35], v[148:151]
ds_read_b64_tr_b16 v[96:97], v13 offset:6144
v_mfma_f32_16x16x32_bf16 v[172:175], v[68:71], v[36:39], v[172:175]
ds_read_b64_tr_b16 v[98:99], v13 offset:9216
v_mfma_f32_16x16x32_bf16 v[168:171], v[64:67], v[36:39], v[168:171]
ds_read_b64_tr_b16 v[100:101], v11 offset:18432
v_mfma_f32_16x16x32_bf16 v[164:167], v[60:63], v[36:39], v[164:167]
ds_read_b64_tr_b16 v[102:103], v11 offset:21504
v_mfma_f32_16x16x32_bf16 v[160:163], v[56:59], v[36:39], v[160:163]
ds_read_b64_tr_b16 v[104:105], v12 offset:18432
v_mfma_f32_16x16x32_bf16 v[156:159], v[52:55], v[36:39], v[156:159]
ds_read_b64_tr_b16 v[106:107], v12 offset:21504
v_mfma_f32_16x16x32_bf16 v[152:155], v[48:51], v[36:39], v[152:155]
ds_read_b64_tr_b16 v[108:109], v13 offset:18432
v_mfma_f32_16x16x32_bf16 v[176:179], v[48:51], v[40:43], v[176:179]
ds_read_b64_tr_b16 v[110:111], v13 offset:21504
v_mfma_f32_16x16x32_bf16 v[180:183], v[52:55], v[40:43], v[180:183]
ds_read_b128 v[76:79], v9 offset:9216
v_mfma_f32_16x16x32_bf16 v[184:187], v[56:59], v[40:43], v[184:187]
ds_read_b128 v[80:83], v9 offset:10240
v_mfma_f32_16x16x32_bf16 v[188:191], v[60:63], v[40:43], v[188:191]
ds_read_b128 v[84:87], v9 offset:11264
v_mfma_f32_16x16x32_bf16 v[192:195], v[64:67], v[40:43], v[192:195]
v_mfma_f32_16x16x32_bf16 v[196:199], v[68:71], v[40:43], v[196:199]
v_mfma_f32_16x16x32_bf16 v[220:223], v[68:71], v[44:47], v[220:223]
v_mfma_f32_16x16x32_bf16 v[216:219], v[64:67], v[44:47], v[216:219]
v_mfma_f32_16x16x32_bf16 v[212:215], v[60:63], v[44:47], v[212:215]
v_mfma_f32_16x16x32_bf16 v[208:211], v[56:59], v[44:47], v[208:211]
v_mfma_f32_16x16x32_bf16 v[204:207], v[52:55], v[44:47], v[204:207]
v_mfma_f32_16x16x32_bf16 v[200:203], v[48:51], v[44:47], v[200:203]
s_waitcnt lgkmcnt(0)
s_barrier
v_mfma_f32_16x16x32_bf16 v[128:131], v[88:91], v[72:75], v[128:131]
ds_read_b128 v[32:35], v9 offset:49152
v_mfma_f32_16x16x32_bf16 v[132:135], v[92:95], v[72:75], v[132:135]
ds_read_b64_tr_b16 v[48:49], v14 offset:0
v_mfma_f32_16x16x32_bf16 v[136:139], v[96:99], v[72:75], v[136:139]
ds_read_b64_tr_b16 v[50:51], v14 offset:3072
v_mfma_f32_16x16x32_bf16 v[140:143], v[100:103], v[72:75], v[140:143]
ds_read_b64_tr_b16 v[52:53], v15 offset:0
v_mfma_f32_16x16x32_bf16 v[144:147], v[104:107], v[72:75], v[144:147]
ds_read_b64_tr_b16 v[54:55], v15 offset:3072
v_mfma_f32_16x16x32_bf16 v[148:151], v[108:111], v[72:75], v[148:151]
ds_read_b64_tr_b16 v[56:57], v16 offset:0
v_mfma_f32_16x16x32_bf16 v[172:175], v[108:111], v[76:79], v[172:175]
ds_read_b64_tr_b16 v[58:59], v16 offset:3072
v_mfma_f32_16x16x32_bf16 v[168:171], v[104:107], v[76:79], v[168:171]
ds_read_b64_tr_b16 v[60:61], v14 offset:12288
v_mfma_f32_16x16x32_bf16 v[164:167], v[100:103], v[76:79], v[164:167]
ds_read_b64_tr_b16 v[62:63], v14 offset:15360
v_mfma_f32_16x16x32_bf16 v[160:163], v[96:99], v[76:79], v[160:163]
ds_read_b64_tr_b16 v[64:65], v15 offset:12288
v_mfma_f32_16x16x32_bf16 v[156:159], v[92:95], v[76:79], v[156:159]
ds_read_b64_tr_b16 v[66:67], v15 offset:15360
v_mfma_f32_16x16x32_bf16 v[152:155], v[88:91], v[76:79], v[152:155]
ds_read_b64_tr_b16 v[68:69], v16 offset:12288
v_mfma_f32_16x16x32_bf16 v[176:179], v[88:91], v[80:83], v[176:179]
ds_read_b64_tr_b16 v[70:71], v16 offset:15360
v_mfma_f32_16x16x32_bf16 v[180:183], v[92:95], v[80:83], v[180:183]
ds_read_b128 v[36:39], v9 offset:50176
v_mfma_f32_16x16x32_bf16 v[184:187], v[96:99], v[80:83], v[184:187]
s_branch Lov_8
.p2align 12
.fill 64, 4, 0xbf800000
Lst_8_0:
s_branch Lwr_149
Lst_8_1:
s_branch Lwr_164
s_nop 0
Lov_8:
ds_read_b128 v[40:43], v9 offset:51200
v_mfma_f32_16x16x32_bf16 v[188:191], v[100:103], v[80:83], v[188:191]
ds_read_b128 v[44:47], v9 offset:52224
v_mfma_f32_16x16x32_bf16 v[192:195], v[104:107], v[80:83], v[192:195]
v_mfma_f32_16x16x32_bf16 v[196:199], v[108:111], v[80:83], v[196:199]
v_mfma_f32_16x16x32_bf16 v[220:223], v[108:111], v[84:87], v[220:223]
v_mfma_f32_16x16x32_bf16 v[216:219], v[104:107], v[84:87], v[216:219]
v_mfma_f32_16x16x32_bf16 v[212:215], v[100:103], v[84:87], v[212:215]
v_mfma_f32_16x16x32_bf16 v[208:211], v[96:99], v[84:87], v[208:211]
v_mfma_f32_16x16x32_bf16 v[204:207], v[92:95], v[84:87], v[204:207]
v_mfma_f32_16x16x32_bf16 v[200:203], v[88:91], v[84:87], v[200:203]
s_sub_u32 s41, s41, 1
s_cmp_lg_u32 s41, 0
s_cbranch_scc1 Lk3l_108
s_waitcnt lgkmcnt(0)
s_add_u32 s37, s35, 2
s_and_b32 s37, s37, 15
s_mul_i32 s37, s37, 16384
s_add_u32 m0, s39, 0
s_nop 0
buffer_load_dwordx4 v3, s[8:11], s37 offen sc1 lds
v_lshrrev_b32 v86, 4, v1
s_lshl_b32 s43, s63, 7
s_add_u32 s43, s43, 148992
buffer_load_dwordx4 v3, s[8:11], s37 offen offset:1024 sc1 lds
v_lshl_add_u32 v87, v86, 4, s43
v_lshrrev_b32 v88, 1, v86
v_and_b32 v86, 1, v86
s_lshl_b32 s43, s63, 5
buffer_load_dwordx4 v3, s[8:11], s37 offen offset:2048 sc1 lds
s_add_u32 s43, s43, 149248
v_lshl_add_u32 v88, v88, 6, s43
v_lshl_add_u32 v88, v86, 4, v88
v_and_b32 v86, 15, v1
buffer_load_dwordx4 v3, s[8:11], s37 offen offset:3072 sc1 lds
s_lshl_b32 s43, s62, 9
s_add_u32 s43, s43, 147456
v_lshl_add_u32 v86, v86, 3, s43
s_add_u32 s38, s35, 2
s_and_b32 s38, s38, 15
s_mul_i32 s38, s38, 458752
s_add_u32 m0, s40, 0
s_nop 0
buffer_load_dwordx4 v4, s[12:15], s38 offen lds
ds_read_b128 v[32:35], v87 offset:0
ds_read_b128 v[36:39], v87 offset:64
ds_read_b128 v[40:43], v88 offset:0
ds_read_b128 v[44:47], v87 offset:896
s_add_u32 m0, s40, 1024
s_nop 0
buffer_load_dwordx4 v5, s[12:15], s38 offen lds
ds_read_b128 v[48:51], v87 offset:960
ds_read_b128 v[52:55], v88 offset:896
ds_read_b64 v[56:57], v86 offset:0
ds_read_b64 v[58:59], v86 offset:128
s_add_u32 m0, s40, 2048
s_add_u32 s38, s38, 57344
buffer_load_dwordx4 v4, s[12:15], s38 offen lds
ds_read_b64 v[60:61], v86 offset:256
ds_read_b64 v[62:63], v86 offset:384
s_mul_i32 s54, s35, 24576
s_add_u32 m0, s40, 3072
s_nop 0
buffer_load_dwordx4 v5, s[12:15], s38 offen lds
s_lshl_b32 s43, s62, 12
s_add_u32 s54, s54, s43
s_add_u32 s54, s54, 524288
s_lshl_b32 s43, s63, 9
s_add_u32 m0, s40, 4096
s_add_u32 s38, s38, 57344
buffer_load_dwordx4 v4, s[12:15], s38 offen lds
s_add_u32 s55, s54, s43
s_add_u32 s55, s55, 16384
s_lshl_b32 s43, s63, 13
s_add_u32 s54, s54, s43
s_add_u32 m0, s40, 5120
s_nop 0
buffer_load_dwordx4 v5, s[12:15], s38 offen lds
v_and_b32 v84, 32, v1
v_lshlrev_b32 v84, 4, v84
v_add_u32 v84, v84, v2
s_waitcnt lgkmcnt(0)
s_add_u32 m0, s40, 6144
s_add_u32 s38, s38, 57344
buffer_load_dwordx4 v4, s[12:15], s38 offen lds
s_add_u32 m0, s40, 7168
s_nop 0
buffer_load_dwordx4 v5, s[12:15], s38 offen lds
s_and_b32 s44, s36, 3
s_mul_i32 s43, s2, 28672
s_mul_i32 s44, s44, 7168
s_add_u32 s43, s43, s44
s_add_u32 s4, s76, s43
s_addc_u32 s5, s77, 0
s_barrier
s_cmp_eq_u32 s47, 3
s_cbranch_scc0 Lw_109
v_and_b32 v90, 31, v1
v_lshlrev_b32 v90, 4, v90
v_add_u32 v91, 153600, v90
ds_read_b128 v[108:111], v91 offset:0
ds_read_b128 v[112:115], v91 offset:512
ds_read_b128 v[116:119], v91 offset:1024
ds_read_b128 v[120:123], v91 offset:1536
s_and_b32 s44, s2, 15
s_mul_i32 s44, s44, 14336
s_lshr_b32 s43, s2, 4
s_lshl_b32 s43, s43, 9
s_add_u32 s44, s44, s43
s_waitcnt lgkmcnt(0)
v_add_f32 v108, v108, v112
v_add_f32 v116, v116, v120
v_add_f32 v109, v109, v113
v_add_f32 v117, v117, v121
v_add_f32 v110, v110, v114
v_add_f32 v118, v118, v122
v_add_f32 v111, v111, v115
v_add_f32 v119, v119, v123
v_add_f32 v108, v108, v116
v_add_f32 v109, v109, v117
v_add_f32 v110, v110, v118
v_add_f32 v111, v111, v119
s_mov_b64 exec, 0xffffffff
buffer_store_dwordx4 v[108:111], v90, s[84:87], s44 offen sc1
s_mov_b64 exec, -1
Lw_109:
s_waitcnt lgkmcnt(0)
s_add_u32 s37, s35, 3
s_and_b32 s37, s37, 15
s_mul_i32 s37, s37, 16384
s_add_u32 m0, s39, 49152
s_nop 0
buffer_load_dwordx4 v3, s[8:11], s37 offen sc1 lds
s_load_dword s3, s[4:5], 1792
s_load_dword s3, s[4:5], 1856
s_load_dword s3, s[4:5], 1920
s_load_dword s3, s[4:5], 1984
s_load_dword s3, s[4:5], 2048
s_load_dword s3, s[4:5], 2112
s_load_dword s3, s[4:5], 2176
buffer_load_dwordx4 v3, s[8:11], s37 offen offset:1024 sc1 lds
s_load_dword s3, s[4:5], 2240
s_load_dword s3, s[4:5], 2304
s_load_dword s3, s[4:5], 2368
s_load_dword s3, s[4:5], 2432
s_load_dword s3, s[4:5], 2496
s_load_dword s3, s[4:5], 2560
s_load_dword s3, s[4:5], 2624
buffer_load_dwordx4 v3, s[8:11], s37 offen offset:2048 sc1 lds
v_mul_f32 v66, v57, v57
v_mul_f32 v64, 0xc0135761, v57
v_mul_f32 v65, 0xbdd2d3e8, v57
v_mul_f32 v65, v65, v66
v_rcp_f32 v66, v66
v_mul_f32 v70, v59, v59
v_mul_f32 v68, 0xc0135761, v59
buffer_load_dwordx4 v3, s[8:11], s37 offen offset:3072 sc1 lds
v_mul_f32 v69, 0xbdd2d3e8, v59
v_mul_f32 v69, v69, v70
v_rcp_f32 v70, v70
v_fma_f32 v128, -v56, v32, v128
v_fma_f32 v129, -v56, v33, v129
v_fma_f32 v130, -v56, v34, v130
v_fma_f32 v131, -v56, v35, v131
v_fma_f32 v152, -v58, v32, v152
s_add_u32 s38, s35, 3
s_and_b32 s38, s38, 15
s_mul_i32 s38, s38, 458752
s_add_u32 m0, s40, 49152
s_nop 0
buffer_load_dwordx4 v4, s[12:15], s38 offen lds
v_fma_f32 v153, -v58, v33, v153
v_fma_f32 v154, -v58, v34, v154
v_fma_f32 v155, -v58, v35, v155
v_mul_f32 v72, v128, v128
v_mul_f32 v73, v129, v129
v_mul_f32 v74, v130, v130
v_mul_f32 v75, v131, v131
s_add_u32 m0, s40, 50176
s_nop 0
buffer_load_dwordx4 v5, s[12:15], s38 offen lds
v_mul_f32 v76, v152, v152
v_mul_f32 v77, v153, v153
v_mul_f32 v78, v154, v154
v_mul_f32 v79, v155, v155
v_fma_f32 v72, v72, v65, v64
v_fma_f32 v73, v73, v65, v64
v_fma_f32 v74, v74, v65, v64
s_add_u32 m0, s40, 51200
s_add_u32 s38, s38, 57344
buffer_load_dwordx4 v4, s[12:15], s38 offen lds
v_fma_f32 v75, v75, v65, v64
v_fma_f32 v76, v76, v69, v68
v_fma_f32 v77, v77, v69, v68
v_fma_f32 v78, v78, v69, v68
v_fma_f32 v79, v79, v69, v68
v_mul_f32 v72, v72, v128
v_mul_f32 v73, v73, v129
v_mul_f32 v74, v74, v130
s_add_u32 m0, s40, 52224
s_nop 0
buffer_load_dwordx4 v5, s[12:15], s38 offen lds
v_mul_f32 v75, v75, v131
v_mul_f32 v76, v76, v152
v_mul_f32 v77, v77, v153
v_mul_f32 v78, v78, v154
v_mul_f32 v79, v79, v155
v_exp_f32 v72, v72
v_exp_f32 v73, v73
s_add_u32 m0, s40, 53248
s_add_u32 s38, s38, 57344
buffer_load_dwordx4 v4, s[12:15], s38 offen lds
v_exp_f32 v74, v74
v_exp_f32 v75, v75
v_exp_f32 v76, v76
v_exp_f32 v77, v77
v_exp_f32 v78, v78
v_exp_f32 v79, v79
v_fma_f32 v140, -v56, v44, v140
s_add_u32 m0, s40, 54272
s_nop 0
buffer_load_dwordx4 v5, s[12:15], s38 offen lds
v_fma_f32 v141, -v56, v45, v141
v_fma_f32 v142, -v56, v46, v142
v_fma_f32 v143, -v56, v47, v143
v_fma_f32 v164, -v58, v44, v164
v_fma_f32 v165, -v58, v45, v165
v_fma_f32 v166, -v58, v46, v166
v_fma_f32 v167, -v58, v47, v167
v_fma_f32 v72, v72, v66, v66
s_add_u32 m0, s40, 55296
s_add_u32 s38, s38, 57344
buffer_load_dwordx4 v4, s[12:15], s38 offen lds
s_add_u32 m0, s40, 56320
s_nop 0
buffer_load_dwordx4 v5, s[12:15], s38 offen lds
s_waitcnt vmcnt(12)
s_barrier
s_add_u32 s37, s35, 4
s_and_b32 s37, s37, 15
s_mul_i32 s37, s37, 16384
s_add_u32 m0, s39, 98304
s_nop 0
buffer_load_dwordx4 v3, s[8:11], s37 offen sc1 lds
v_fma_f32 v73, v73, v66, v66
v_fma_f32 v74, v74, v66, v66
v_fma_f32 v75, v75, v66, v66
v_fma_f32 v76, v76, v70, v70
v_fma_f32 v77, v77, v70, v70
v_fma_f32 v78, v78, v70, v70
buffer_load_dwordx4 v3, s[8:11], s37 offen offset:1024 sc1 lds
v_fma_f32 v79, v79, v70, v70
v_rcp_f32 v72, v72
v_rcp_f32 v73, v73
v_rcp_f32 v74, v74
v_rcp_f32 v75, v75
v_rcp_f32 v76, v76
buffer_load_dwordx4 v3, s[8:11], s37 offen offset:2048 sc1 lds
v_rcp_f32 v77, v77
v_rcp_f32 v78, v78
v_rcp_f32 v79, v79
v_mul_f32 v140, v128, v140
v_mul_f32 v141, v129, v141
v_mul_f32 v142, v130, v142
buffer_load_dwordx4 v3, s[8:11], s37 offen offset:3072 sc1 lds
v_mul_f32 v143, v131, v143
v_mul_f32 v164, v152, v164
v_mul_f32 v165, v153, v165
v_mul_f32 v166, v154, v166
v_mul_f32 v167, v155, v167
v_mul_f32 v140, v140, v72
s_add_u32 s38, s35, 4
s_and_b32 s38, s38, 15
s_mul_i32 s38, s38, 458752
s_add_u32 m0, s40, 98304
s_nop 0
buffer_load_dwordx4 v4, s[12:15], s38 offen lds
v_mul_f32 v141, v141, v73
v_mul_f32 v142, v142, v74
v_mul_f32 v143, v143, v75
v_mul_f32 v164, v164, v76
v_mul_f32 v165, v165, v77
v_mul_f32 v166, v166, v78
s_add_u32 m0, s40, 99328
s_nop 0
buffer_load_dwordx4 v5, s[12:15], s38 offen lds
v_mul_f32 v167, v167, v79
v_cvt_pk_bf16_f32 v128, v140, v141
v_cvt_pk_bf16_f32 v129, v142, v143
v_cvt_pk_bf16_f32 v152, v164, v165
v_cvt_pk_bf16_f32 v153, v166, v167
v_fma_f32 v132, -v56, v36, v132
s_add_u32 m0, s40, 100352
s_add_u32 s38, s38, 57344
buffer_load_dwordx4 v4, s[12:15], s38 offen lds
v_fma_f32 v133, -v56, v37, v133
v_fma_f32 v134, -v56, v38, v134
v_fma_f32 v135, -v56, v39, v135
v_fma_f32 v156, -v58, v36, v156
v_fma_f32 v157, -v58, v37, v157
v_fma_f32 v158, -v58, v38, v158
s_add_u32 m0, s40, 101376
s_nop 0
buffer_load_dwordx4 v5, s[12:15], s38 offen lds
v_fma_f32 v159, -v58, v39, v159
v_mul_f32 v72, v132, v132
v_mul_f32 v73, v133, v133
v_mul_f32 v74, v134, v134
v_mul_f32 v75, v135, v135
v_mul_f32 v76, v156, v156
s_add_u32 m0, s40, 102400
s_add_u32 s38, s38, 57344
buffer_load_dwordx4 v4, s[12:15], s38 offen lds
v_mul_f32 v77, v157, v157
v_mul_f32 v78, v158, v158
v_mul_f32 v79, v159, v159
v_fma_f32 v72, v72, v65, v64
v_fma_f32 v73, v73, v65, v64
v_fma_f32 v74, v74, v65, v64
s_add_u32 m0, s40, 103424
s_nop 0
buffer_load_dwordx4 v5, s[12:15], s38 offen lds
v_fma_f32 v75, v75, v65, v64
v_fma_f32 v76, v76, v69, v68
v_fma_f32 v77, v77, v69, v68
v_fma_f32 v78, v78, v69, v68
v_fma_f32 v79, v79, v69, v68
v_mul_f32 v72, v72, v132
s_add_u32 m0, s40, 104448
s_add_u32 s38, s38, 57344
buffer_load_dwordx4 v4, s[12:15], s38 offen lds
s_add_u32 m0, s40, 105472
s_nop 0
buffer_load_dwordx4 v5, s[12:15], s38 offen lds
s_waitcnt vmcnt(12)
s_barrier
s_cmp_eq_u32 s47, 3
s_cbranch_scc0 Lw_110
s_lshr_b32 s43, s2, 4
s_add_u32 s43, s43, 80
s_lshl_b32 s43, s43, 7
v_mov_b32 v90, s43
v_mov_b32 v91, 1
s_mov_b64 exec, 1
buffer_atomic_add v91, v90, s[56:59], 0 offen sc1
s_mov_b64 exec, -1
Lw_110:
s_waitcnt lgkmcnt(0)
s_add_u32 s37, s35, 5
s_and_b32 s37, s37, 15
s_mul_i32 s37, s37, 16384
s_add_u32 m0, s39, 0
s_nop 0
buffer_load_dwordx4 v3, s[8:11], s37 offen sc1 lds
s_load_dword s3, s[4:5], 2688
s_load_dword s3, s[4:5], 2752
s_load_dword s3, s[4:5], 2816
s_load_dword s3, s[4:5], 2880
s_load_dword s3, s[4:5], 2944
s_load_dword s3, s[4:5], 3008
s_load_dword s3, s[4:5], 3072
buffer_load_dwordx4 v3, s[8:11], s37 offen offset:1024 sc1 lds
s_load_dword s3, s[4:5], 3136
s_load_dword s3, s[4:5], 3200
s_load_dword s3, s[4:5], 3264
s_load_dword s3, s[4:5], 3328
s_load_dword s3, s[4:5], 3392
s_load_dword s3, s[4:5], 3456
s_load_dword s3, s[4:5], 3520
buffer_load_dwordx4 v3, s[8:11], s37 offen offset:2048 sc1 lds
v_mul_f32 v73, v73, v133
v_mul_f32 v74, v74, v134
v_mul_f32 v75, v75, v135
v_mul_f32 v76, v76, v156
v_mul_f32 v77, v77, v157
v_mul_f32 v78, v78, v158
v_mul_f32 v79, v79, v159
v_exp_f32 v72, v72
buffer_load_dwordx4 v3, s[8:11], s37 offen offset:3072 sc1 lds
v_exp_f32 v73, v73
v_exp_f32 v74, v74
v_exp_f32 v75, v75
v_exp_f32 v76, v76
v_exp_f32 v77, v77
v_exp_f32 v78, v78
v_exp_f32 v79, v79
s_add_u32 s38, s35, 5
s_and_b32 s38, s38, 15
s_mul_i32 s38, s38, 458752
s_add_u32 m0, s40, 0
s_nop 0
buffer_load_dwordx4 v4, s[12:15], s38 offen lds
v_fma_f32 v144, -v56, v48, v144
v_fma_f32 v145, -v56, v49, v145
v_fma_f32 v146, -v56, v50, v146
v_fma_f32 v147, -v56, v51, v147
v_fma_f32 v168, -v58, v48, v168
v_fma_f32 v169, -v58, v49, v169
v_fma_f32 v170, -v58, v50, v170
v_fma_f32 v171, -v58, v51, v171
s_add_u32 m0, s40, 1024
s_nop 0
buffer_load_dwordx4 v5, s[12:15], s38 offen lds
v_fma_f32 v72, v72, v66, v66
v_fma_f32 v73, v73, v66, v66
v_fma_f32 v74, v74, v66, v66
v_fma_f32 v75, v75, v66, v66
v_fma_f32 v76, v76, v70, v70
v_fma_f32 v77, v77, v70, v70
v_fma_f32 v78, v78, v70, v70
s_add_u32 m0, s40, 2048
s_add_u32 s38, s38, 57344
buffer_load_dwordx4 v4, s[12:15], s38 offen lds
v_fma_f32 v79, v79, v70, v70
v_rcp_f32 v72, v72
v_rcp_f32 v73, v73
v_rcp_f32 v74, v74
v_rcp_f32 v75, v75
v_rcp_f32 v76, v76
v_rcp_f32 v77, v77
s_add_u32 m0, s40, 3072
s_nop 0
buffer_load_dwordx4 v5, s[12:15], s38 offen lds
v_rcp_f32 v78, v78
v_rcp_f32 v79, v79
v_mul_f32 v144, v132, v144
v_mul_f32 v145, v133, v145
v_mul_f32 v146, v134, v146
v_mul_f32 v147, v135, v147
v_mul_f32 v168, v156, v168
v_mul_f32 v169, v157, v169
s_add_u32 m0, s40, 4096
s_add_u32 s38, s38, 57344
buffer_load_dwordx4 v4, s[12:15], s38 offen lds
v_mul_f32 v170, v158, v170
v_mul_f32 v171, v159, v171
v_mul_f32 v144, v144, v72
v_mul_f32 v145, v145, v73
v_mul_f32 v146, v146, v74
v_mul_f32 v147, v147, v75
v_mul_f32 v168, v168, v76
s_add_u32 m0, s40, 5120
s_nop 0
buffer_load_dwordx4 v5, s[12:15], s38 offen lds
v_mul_f32 v169, v169, v77
v_mul_f32 v170, v170, v78
v_mul_f32 v171, v171, v79
v_cvt_pk_bf16_f32 v130, v144, v145
v_cvt_pk_bf16_f32 v131, v146, v147
v_cvt_pk_bf16_f32 v154, v168, v169
v_cvt_pk_bf16_f32 v155, v170, v171
buffer_store_dwordx4 v[128:131], v2, s[24:27], s54 offen offset:0 sc1
s_add_u32 m0, s40, 6144
s_add_u32 s38, s38, 57344
buffer_load_dwordx4 v4, s[12:15], s38 offen lds
s_add_u32 m0, s40, 7168
s_nop 0
buffer_load_dwordx4 v5, s[12:15], s38 offen lds
s_waitcnt vmcnt(13)
s_barrier
s_add_u32 s37, s35, 6
s_and_b32 s37, s37, 15
s_mul_i32 s37, s37, 16384
s_add_u32 m0, s39, 49152
s_nop 0
buffer_load_dwordx4 v3, s[8:11], s37 offen sc1 lds
buffer_store_dwordx4 v[152:155], v2, s[24:27], s54 offen offset:1024 sc1
v_fma_f32 v136, -v56, v40, v136
v_fma_f32 v137, -v56, v41, v137
v_fma_f32 v138, -v56, v42, v138
v_fma_f32 v139, -v56, v43, v139
v_fma_f32 v160, -v58, v40, v160
buffer_load_dwordx4 v3, s[8:11], s37 offen offset:1024 sc1 lds
v_fma_f32 v161, -v58, v41, v161
v_fma_f32 v162, -v58, v42, v162
v_fma_f32 v163, -v58, v43, v163
v_mul_f32 v72, v136, v136
v_mul_f32 v73, v137, v137
v_mul_f32 v74, v138, v138
buffer_load_dwordx4 v3, s[8:11], s37 offen offset:2048 sc1 lds
v_mul_f32 v75, v139, v139
v_mul_f32 v76, v160, v160
v_mul_f32 v77, v161, v161
v_mul_f32 v78, v162, v162
v_mul_f32 v79, v163, v163
v_fma_f32 v72, v72, v65, v64
buffer_load_dwordx4 v3, s[8:11], s37 offen offset:3072 sc1 lds
v_fma_f32 v73, v73, v65, v64
v_fma_f32 v74, v74, v65, v64
v_fma_f32 v75, v75, v65, v64
v_fma_f32 v76, v76, v69, v68
v_fma_f32 v77, v77, v69, v68
v_fma_f32 v78, v78, v69, v68
s_add_u32 s38, s35, 6
s_and_b32 s38, s38, 15
s_mul_i32 s38, s38, 458752
s_add_u32 m0, s40, 49152
s_nop 0
buffer_load_dwordx4 v4, s[12:15], s38 offen lds
v_fma_f32 v79, v79, v69, v68
v_mul_f32 v72, v72, v136
v_mul_f32 v73, v73, v137
v_mul_f32 v74, v74, v138
v_mul_f32 v75, v75, v139
v_mul_f32 v76, v76, v160
s_add_u32 m0, s40, 50176
s_nop 0
buffer_load_dwordx4 v5, s[12:15], s38 offen lds
v_mul_f32 v77, v77, v161
v_mul_f32 v78, v78, v162
v_mul_f32 v79, v79, v163
v_exp_f32 v72, v72
v_exp_f32 v73, v73
v_exp_f32 v74, v74
s_add_u32 m0, s40, 51200
s_add_u32 s38, s38, 57344
buffer_load_dwordx4 v4, s[12:15], s38 offen lds
v_exp_f32 v75, v75
v_exp_f32 v76, v76
v_exp_f32 v77, v77
v_exp_f32 v78, v78
v_exp_f32 v79, v79
v_fma_f32 v148, -v56, v52, v148
s_add_u32 m0, s40, 52224
s_nop 0
buffer_load_dwordx4 v5, s[12:15], s38 offen lds
v_fma_f32 v149, -v56, v53, v149
v_fma_f32 v150, -v56, v54, v150
v_fma_f32 v151, -v56, v55, v151
v_fma_f32 v172, -v58, v52, v172
v_fma_f32 v173, -v58, v53, v173
v_fma_f32 v174, -v58, v54, v174
s_add_u32 m0, s40, 53248
s_add_u32 s38, s38, 57344
buffer_load_dwordx4 v4, s[12:15], s38 offen lds
v_fma_f32 v175, -v58, v55, v175
v_fma_f32 v72, v72, v66, v66
v_fma_f32 v73, v73, v66, v66
v_fma_f32 v74, v74, v66, v66
v_fma_f32 v75, v75, v66, v66
v_fma_f32 v76, v76, v70, v70
s_add_u32 m0, s40, 54272
s_nop 0
buffer_load_dwordx4 v5, s[12:15], s38 offen lds
v_fma_f32 v77, v77, v70, v70
v_fma_f32 v78, v78, v70, v70
v_fma_f32 v79, v79, v70, v70
v_rcp_f32 v72, v72
v_rcp_f32 v73, v73
v_rcp_f32 v74, v74
s_add_u32 m0, s40, 55296
s_add_u32 s38, s38, 57344
buffer_load_dwordx4 v4, s[12:15], s38 offen lds
s_add_u32 m0, s40, 56320
s_nop 0
buffer_load_dwordx4 v5, s[12:15], s38 offen lds
s_waitcnt vmcnt(13)
s_barrier
s_waitcnt lgkmcnt(0)
s_add_u32 s37, s35, 7
s_and_b32 s37, s37, 15
s_mul_i32 s37, s37, 16384
s_add_u32 m0, s39, 98304
s_nop 0
buffer_load_dwordx4 v3, s[8:11], s37 offen sc1 lds
s_load_dword s3, s[4:5], 3584
s_load_dword s3, s[4:5], 3648
s_load_dword s3, s[4:5], 3712
s_load_dword s3, s[4:5], 3776
s_load_dword s3, s[4:5], 3840
s_load_dword s3, s[4:5], 3904
s_load_dword s3, s[4:5], 3968
buffer_load_dwordx4 v3, s[8:11], s37 offen offset:1024 sc1 lds
s_load_dword s3, s[4:5], 4032
s_load_dword s3, s[4:5], 4096
s_load_dword s3, s[4:5], 4160
s_load_dword s3, s[4:5], 4224
s_load_dword s3, s[4:5], 4288
s_load_dword s3, s[4:5], 4352
s_load_dword s3, s[4:5], 4416
buffer_load_dwordx4 v3, s[8:11], s37 offen offset:2048 sc1 lds
v_rcp_f32 v75, v75
v_rcp_f32 v76, v76
v_rcp_f32 v77, v77
v_rcp_f32 v78, v78
v_rcp_f32 v79, v79
v_mul_f32 v148, v136, v148
v_mul_f32 v149, v137, v149
buffer_load_dwordx4 v3, s[8:11], s37 offen offset:3072 sc1 lds
v_mul_f32 v150, v138, v150
v_mul_f32 v151, v139, v151
v_mul_f32 v172, v160, v172
v_mul_f32 v173, v161, v173
v_mul_f32 v174, v162, v174
v_mul_f32 v175, v163, v175
v_mul_f32 v148, v148, v72
v_mul_f32 v149, v149, v73
s_add_u32 s38, s35, 7
s_and_b32 s38, s38, 15
s_mul_i32 s38, s38, 458752
s_add_u32 m0, s40, 98304
s_nop 0
buffer_load_dwordx4 v4, s[12:15], s38 offen lds
v_mul_f32 v150, v150, v74
v_mul_f32 v151, v151, v75
v_mul_f32 v172, v172, v76
v_mul_f32 v173, v173, v77
v_mul_f32 v174, v174, v78
v_mul_f32 v175, v175, v79
v_cvt_pk_bf16_f32 v80, v148, v149
s_add_u32 m0, s40, 99328
s_nop 0
buffer_load_dwordx4 v5, s[12:15], s38 offen lds
v_cvt_pk_bf16_f32 v81, v150, v151
v_cvt_pk_bf16_f32 v82, v172, v173
v_cvt_pk_bf16_f32 v83, v174, v175
s_nop 1
v_permlane32_swap_b32 v80, v82
v_permlane32_swap_b32 v81, v83
buffer_store_dwordx4 v[80:83], v84, s[24:27], s55 offen offset:0 sc1
s_branch Lov_9
.p2align 12
.fill 64, 4, 0xbf800000
Lst_9_0:
s_branch Lwr_150
Lst_9_1:
s_branch Lwr_165
s_nop 0
Lov_9:
s_add_u32 m0, s40, 100352
s_add_u32 s38, s38, 57344
buffer_load_dwordx4 v4, s[12:15], s38 offen lds
s_nop 1
v_mul_f32 v66, v61, v61
v_mul_f32 v64, 0xc0135761, v61
v_mul_f32 v65, 0xbdd2d3e8, v61
v_mul_f32 v65, v65, v66
v_rcp_f32 v66, v66
v_mul_f32 v70, v63, v63
v_mul_f32 v68, 0xc0135761, v63
s_add_u32 m0, s40, 101376
s_nop 0
buffer_load_dwordx4 v5, s[12:15], s38 offen lds
v_mul_f32 v69, 0xbdd2d3e8, v63
v_mul_f32 v69, v69, v70
v_rcp_f32 v70, v70
v_fma_f32 v176, -v60, v32, v176
v_fma_f32 v177, -v60, v33, v177
v_fma_f32 v178, -v60, v34, v178
v_fma_f32 v179, -v60, v35, v179
s_add_u32 m0, s40, 102400
s_add_u32 s38, s38, 57344
buffer_load_dwordx4 v4, s[12:15], s38 offen lds
v_fma_f32 v200, -v62, v32, v200
v_fma_f32 v201, -v62, v33, v201
v_fma_f32 v202, -v62, v34, v202
v_fma_f32 v203, -v62, v35, v203
v_mul_f32 v72, v176, v176
v_mul_f32 v73, v177, v177
v_mul_f32 v74, v178, v178
s_add_u32 m0, s40, 103424
s_nop 0
buffer_load_dwordx4 v5, s[12:15], s38 offen lds
v_mul_f32 v75, v179, v179
v_mul_f32 v76, v200, v200
v_mul_f32 v77, v201, v201
v_mul_f32 v78, v202, v202
v_mul_f32 v79, v203, v203
v_fma_f32 v72, v72, v65, v64
v_fma_f32 v73, v73, v65, v64
v_fma_f32 v74, v74, v65, v64
s_add_u32 m0, s40, 104448
s_add_u32 s38, s38, 57344
buffer_load_dwordx4 v4, s[12:15], s38 offen lds
s_add_u32 m0, s40, 105472
s_nop 0
buffer_load_dwordx4 v5, s[12:15], s38 offen lds
s_waitcnt vmcnt(13)
s_barrier
s_add_u32 s37, s35, 8
s_and_b32 s37, s37, 15
s_mul_i32 s37, s37, 16384
s_add_u32 m0, s39, 0
s_nop 0
buffer_load_dwordx4 v3, s[8:11], s37 offen sc1 lds
v_fma_f32 v75, v75, v65, v64
v_fma_f32 v76, v76, v69, v68
v_fma_f32 v77, v77, v69, v68
v_fma_f32 v78, v78, v69, v68
v_fma_f32 v79, v79, v69, v68
v_mul_f32 v72, v72, v176
buffer_load_dwordx4 v3, s[8:11], s37 offen offset:1024 sc1 lds
v_mul_f32 v73, v73, v177
v_mul_f32 v74, v74, v178
v_mul_f32 v75, v75, v179
v_mul_f32 v76, v76, v200
v_mul_f32 v77, v77, v201
v_mul_f32 v78, v78, v202
buffer_load_dwordx4 v3, s[8:11], s37 offen offset:2048 sc1 lds
v_mul_f32 v79, v79, v203
v_exp_f32 v72, v72
v_exp_f32 v73, v73
v_exp_f32 v74, v74
v_exp_f32 v75, v75
v_exp_f32 v76, v76
buffer_load_dwordx4 v3, s[8:11], s37 offen offset:3072 sc1 lds
v_exp_f32 v77, v77
v_exp_f32 v78, v78
v_exp_f32 v79, v79
v_fma_f32 v188, -v60, v44, v188
v_fma_f32 v189, -v60, v45, v189
v_fma_f32 v190, -v60, v46, v190
s_add_u32 s38, s35, 8
s_and_b32 s38, s38, 15
s_mul_i32 s38, s38, 458752
s_add_u32 m0, s40, 0
s_nop 0
buffer_load_dwordx4 v4, s[12:15], s38 offen lds
v_fma_f32 v191, -v60, v47, v191
v_fma_f32 v212, -v62, v44, v212
v_fma_f32 v213, -v62, v45, v213
v_fma_f32 v214, -v62, v46, v214
v_fma_f32 v215, -v62, v47, v215
v_fma_f32 v72, v72, v66, v66
s_add_u32 m0, s40, 1024
s_nop 0
buffer_load_dwordx4 v5, s[12:15], s38 offen lds
v_fma_f32 v73, v73, v66, v66
v_fma_f32 v74, v74, v66, v66
v_fma_f32 v75, v75, v66, v66
v_fma_f32 v76, v76, v70, v70
v_fma_f32 v77, v77, v70, v70
v_fma_f32 v78, v78, v70, v70
s_add_u32 m0, s40, 2048
s_add_u32 s38, s38, 57344
buffer_load_dwordx4 v4, s[12:15], s38 offen lds
v_fma_f32 v79, v79, v70, v70
v_rcp_f32 v72, v72
v_rcp_f32 v73, v73
v_rcp_f32 v74, v74
v_rcp_f32 v75, v75
v_rcp_f32 v76, v76
s_add_u32 m0, s40, 3072
s_nop 0
buffer_load_dwordx4 v5, s[12:15], s38 offen lds
v_rcp_f32 v77, v77
v_rcp_f32 v78, v78
v_rcp_f32 v79, v79
v_mul_f32 v188, v176, v188
v_mul_f32 v189, v177, v189
v_mul_f32 v190, v178, v190
s_add_u32 m0, s40, 4096
s_add_u32 s38, s38, 57344
buffer_load_dwordx4 v4, s[12:15], s38 offen lds
v_mul_f32 v191, v179, v191
v_mul_f32 v212, v200, v212
v_mul_f32 v213, v201, v213
v_mul_f32 v214, v202, v214
v_mul_f32 v215, v203, v215
v_mul_f32 v188, v188, v72
s_add_u32 m0, s40, 5120
s_nop 0
buffer_load_dwordx4 v5, s[12:15], s38 offen lds
v_mul_f32 v189, v189, v73
v_mul_f32 v190, v190, v74
v_mul_f32 v191, v191, v75
v_mul_f32 v212, v212, v76
v_mul_f32 v213, v213, v77
v_mul_f32 v214, v214, v78
s_add_u32 m0, s40, 6144
s_add_u32 s38, s38, 57344
buffer_load_dwordx4 v4, s[12:15], s38 offen lds
s_add_u32 m0, s40, 7168
s_nop 0
buffer_load_dwordx4 v5, s[12:15], s38 offen lds
s_waitcnt vmcnt(12)
s_barrier
s_waitcnt lgkmcnt(0)
s_cmp_eq_u32 s47, 3
s_cbranch_scc0 Lw_111
s_lshl_b32 s60, s35, 7
s_add_u32 s60, s60, 28321792
s_mov_b32 s61, s60
s_load_dword s92, s[82:83], s60 glc
s_load_dword s93, s[82:83], s61 glc
Lw_111:
s_add_u32 s37, s35, 9
s_and_b32 s37, s37, 15
s_mul_i32 s37, s37, 16384
s_add_u32 m0, s39, 49152
s_nop 0
buffer_load_dwordx4 v3, s[8:11], s37 offen sc1 lds
s_load_dword s3, s[4:5], 4480
s_load_dword s3, s[4:5], 4544
s_load_dword s3, s[4:5], 4608
s_load_dword s3, s[4:5], 4672
s_load_dword s3, s[4:5], 4736
s_load_dword s3, s[4:5], 4800
s_load_dword s3, s[4:5], 4864
buffer_load_dwordx4 v3, s[8:11], s37 offen offset:1024 sc1 lds
s_load_dword s3, s[4:5], 4928
s_load_dword s3, s[4:5], 4992
s_load_dword s3, s[4:5], 5056
s_load_dword s3, s[4:5], 5120
s_load_dword s3, s[4:5], 5184
s_load_dword s3, s[4:5], 5248
s_load_dword s3, s[4:5], 5312
buffer_load_dwordx4 v3, s[8:11], s37 offen offset:2048 sc1 lds
v_mul_f32 v215, v215, v79
v_cvt_pk_bf16_f32 v176, v188, v189
v_cvt_pk_bf16_f32 v177, v190, v191
v_cvt_pk_bf16_f32 v200, v212, v213
v_cvt_pk_bf16_f32 v201, v214, v215
v_fma_f32 v180, -v60, v36, v180
v_fma_f32 v181, -v60, v37, v181
v_fma_f32 v182, -v60, v38, v182
buffer_load_dwordx4 v3, s[8:11], s37 offen offset:3072 sc1 lds
v_fma_f32 v183, -v60, v39, v183
v_fma_f32 v204, -v62, v36, v204
v_fma_f32 v205, -v62, v37, v205
v_fma_f32 v206, -v62, v38, v206
v_fma_f32 v207, -v62, v39, v207
v_mul_f32 v72, v180, v180
v_mul_f32 v73, v181, v181
s_add_u32 s38, s35, 9
s_and_b32 s38, s38, 15
s_mul_i32 s38, s38, 458752
s_add_u32 m0, s40, 49152
s_nop 0
buffer_load_dwordx4 v4, s[12:15], s38 offen lds
v_mul_f32 v74, v182, v182
v_mul_f32 v75, v183, v183
v_mul_f32 v76, v204, v204
v_mul_f32 v77, v205, v205
v_mul_f32 v78, v206, v206
v_mul_f32 v79, v207, v207
v_fma_f32 v72, v72, v65, v64
v_fma_f32 v73, v73, v65, v64
s_add_u32 m0, s40, 50176
s_nop 0
buffer_load_dwordx4 v5, s[12:15], s38 offen lds
v_fma_f32 v74, v74, v65, v64
v_fma_f32 v75, v75, v65, v64
v_fma_f32 v76, v76, v69, v68
v_fma_f32 v77, v77, v69, v68
v_fma_f32 v78, v78, v69, v68
v_fma_f32 v79, v79, v69, v68
v_mul_f32 v72, v72, v180
s_add_u32 m0, s40, 51200
s_add_u32 s38, s38, 57344
buffer_load_dwordx4 v4, s[12:15], s38 offen lds
v_mul_f32 v73, v73, v181
v_mul_f32 v74, v74, v182
v_mul_f32 v75, v75, v183
v_mul_f32 v76, v76, v204
v_mul_f32 v77, v77, v205
v_mul_f32 v78, v78, v206
v_mul_f32 v79, v79, v207
s_add_u32 m0, s40, 52224
s_nop 0
buffer_load_dwordx4 v5, s[12:15], s38 offen lds
v_exp_f32 v72, v72
v_exp_f32 v73, v73
v_exp_f32 v74, v74
v_exp_f32 v75, v75
v_exp_f32 v76, v76
v_exp_f32 v77, v77
v_exp_f32 v78, v78
v_exp_f32 v79, v79
s_add_u32 m0, s40, 53248
s_add_u32 s38, s38, 57344
buffer_load_dwordx4 v4, s[12:15], s38 offen lds
v_fma_f32 v192, -v60, v48, v192
v_fma_f32 v193, -v60, v49, v193
v_fma_f32 v194, -v60, v50, v194
v_fma_f32 v195, -v60, v51, v195
v_fma_f32 v216, -v62, v48, v216
v_fma_f32 v217, -v62, v49, v217
v_fma_f32 v218, -v62, v50, v218
s_add_u32 m0, s40, 54272
s_nop 0
buffer_load_dwordx4 v5, s[12:15], s38 offen lds
v_fma_f32 v219, -v62, v51, v219
v_fma_f32 v72, v72, v66, v66
v_fma_f32 v73, v73, v66, v66
v_fma_f32 v74, v74, v66, v66
v_fma_f32 v75, v75, v66, v66
v_fma_f32 v76, v76, v70, v70
v_fma_f32 v77, v77, v70, v70
v_fma_f32 v78, v78, v70, v70
s_add_u32 m0, s40, 55296
s_add_u32 s38, s38, 57344
buffer_load_dwordx4 v4, s[12:15], s38 offen lds
s_add_u32 m0, s40, 56320
s_nop 0
buffer_load_dwordx4 v5, s[12:15], s38 offen lds
s_waitcnt vmcnt(12)
s_barrier
s_add_u32 s37, s35, 10
s_and_b32 s37, s37, 15
s_mul_i32 s37, s37, 16384
s_add_u32 m0, s39, 98304
s_nop 0
buffer_load_dwordx4 v3, s[8:11], s37 offen sc1 lds
v_fma_f32 v79, v79, v70, v70
v_rcp_f32 v72, v72
v_rcp_f32 v73, v73
v_rcp_f32 v74, v74
v_rcp_f32 v75, v75
v_rcp_f32 v76, v76
buffer_load_dwordx4 v3, s[8:11], s37 offen offset:1024 sc1 lds
v_rcp_f32 v77, v77
v_rcp_f32 v78, v78
v_rcp_f32 v79, v79
v_mul_f32 v192, v180, v192
v_mul_f32 v193, v181, v193
v_mul_f32 v194, v182, v194
buffer_load_dwordx4 v3, s[8:11], s37 offen offset:2048 sc1 lds
v_mul_f32 v195, v183, v195
v_mul_f32 v216, v204, v216
v_mul_f32 v217, v205, v217
v_mul_f32 v218, v206, v218
v_mul_f32 v219, v207, v219
v_mul_f32 v192, v192, v72
buffer_load_dwordx4 v3, s[8:11], s37 offen offset:3072 sc1 lds
v_mul_f32 v193, v193, v73
v_mul_f32 v194, v194, v74
v_mul_f32 v195, v195, v75
v_mul_f32 v216, v216, v76
v_mul_f32 v217, v217, v77
v_mul_f32 v218, v218, v78
s_add_u32 s38, s35, 10
s_and_b32 s38, s38, 15
s_mul_i32 s38, s38, 458752
s_add_u32 m0, s40, 98304
s_nop 0
buffer_load_dwordx4 v4, s[12:15], s38 offen lds
v_mul_f32 v219, v219, v79
v_cvt_pk_bf16_f32 v178, v192, v193
v_cvt_pk_bf16_f32 v179, v194, v195
v_cvt_pk_bf16_f32 v202, v216, v217
v_cvt_pk_bf16_f32 v203, v218, v219
buffer_store_dwordx4 v[176:179], v2, s[24:27], s54 offen offset:2048 sc1
s_add_u32 m0, s40, 99328
s_nop 0
buffer_load_dwordx4 v5, s[12:15], s38 offen lds
buffer_store_dwordx4 v[200:203], v2, s[24:27], s54 offen offset:3072 sc1
v_fma_f32 v184, -v60, v40, v184
v_fma_f32 v185, -v60, v41, v185
v_fma_f32 v186, -v60, v42, v186
v_fma_f32 v187, -v60, v43, v187
v_fma_f32 v208, -v62, v40, v208
s_add_u32 m0, s40, 100352
s_add_u32 s38, s38, 57344
buffer_load_dwordx4 v4, s[12:15], s38 offen lds
v_fma_f32 v209, -v62, v41, v209
v_fma_f32 v210, -v62, v42, v210
v_fma_f32 v211, -v62, v43, v211
v_mul_f32 v72, v184, v184
v_mul_f32 v73, v185, v185
v_mul_f32 v74, v186, v186
s_add_u32 m0, s40, 101376
s_nop 0
buffer_load_dwordx4 v5, s[12:15], s38 offen lds
v_mul_f32 v75, v187, v187
v_mul_f32 v76, v208, v208
v_mul_f32 v77, v209, v209
v_mul_f32 v78, v210, v210
v_mul_f32 v79, v211, v211
v_fma_f32 v72, v72, v65, v64
s_add_u32 m0, s40, 102400
s_add_u32 s38, s38, 57344
buffer_load_dwordx4 v4, s[12:15], s38 offen lds
v_fma_f32 v73, v73, v65, v64
v_fma_f32 v74, v74, v65, v64
v_fma_f32 v75, v75, v65, v64
v_fma_f32 v76, v76, v69, v68
v_fma_f32 v77, v77, v69, v68
v_fma_f32 v78, v78, v69, v68
s_add_u32 m0, s40, 103424
s_nop 0
buffer_load_dwordx4 v5, s[12:15], s38 offen lds
v_fma_f32 v79, v79, v69, v68
v_mul_f32 v72, v72, v184
v_mul_f32 v73, v73, v185
v_mul_f32 v74, v74, v186
v_mul_f32 v75, v75, v187
v_mul_f32 v76, v76, v208
s_add_u32 m0, s40, 104448
s_add_u32 s38, s38, 57344
buffer_load_dwordx4 v4, s[12:15], s38 offen lds
s_add_u32 m0, s40, 105472
s_nop 0
buffer_load_dwordx4 v5, s[12:15], s38 offen lds
s_waitcnt vmcnt(14)
s_cmp_eq_u32 s47, 3
s_cbranch_scc0 Lw_112
s_mov_b32 s41, 0x40000
Lcp_113:
s_waitcnt lgkmcnt(0)
s_and_b32 s92, s92, s93
s_cmp_eq_u32 s92, 16
s_cbranch_scc1 Lco_114
s_load_dword s92, s[82:83], s60 glc
s_load_dword s93, s[82:83], s61 glc
s_sub_u32 s41, s41, 1
s_cmp_lg_u32 s41, 0
s_cbranch_scc1 Lcp_113
s_waitcnt lgkmcnt(0)
Lco_114:
Lw_112:
s_barrier
s_lshl_b32 s60, s35, 9
s_lshl_b32 s43, s47, 7
s_add_u32 s60, s60, s43
s_add_u32 s61, s60, 14336
s_add_u32 s52, s43, 148480
s_add_u32 s53, s52, 896
v_lshrrev_b32 v104, 3, v1
v_mul_u32_u24 v104, 28672, v104
v_and_b32 v105, 7, v1
v_lshl_add_u32 v104, v105, 4, v104
s_waitcnt lgkmcnt(0)
buffer_load_dwordx4 v[96:99], v104, s[84:87], s60 offen sc1
s_load_dword s3, s[4:5], 5376
s_load_dword s3, s[4:5], 5440
s_load_dword s3, s[4:5], 5504
s_load_dword s3, s[4:5], 5568
s_load_dword s3, s[4:5], 5632
s_load_dword s3, s[4:5], 5696
buffer_load_dwordx4 v[100:103], v104, s[84:87], s61 offen sc1
s_load_dword s3, s[4:5], 5760
s_load_dword s3, s[4:5], 5824
s_load_dword s3, s[4:5], 5888
s_load_dword s3, s[4:5], 5952
s_load_dword s3, s[4:5], 6016
s_load_dword s3, s[4:5], 6080
s_load_dword s3, s[4:5], 6144
s_add_u32 s37, s35, 11
s_and_b32 s37, s37, 15
s_mul_i32 s37, s37, 16384
s_add_u32 m0, s39, 0
s_nop 0
buffer_load_dwordx4 v3, s[8:11], s37 offen sc1 lds
s_load_dword s3, s[4:5], 6208
v_mul_f32 v77, v77, v209
v_mul_f32 v78, v78, v210
v_mul_f32 v79, v79, v211
v_exp_f32 v72, v72
v_exp_f32 v73, v73
v_exp_f32 v74, v74
buffer_load_dwordx4 v3, s[8:11], s37 offen offset:1024 sc1 lds
v_exp_f32 v75, v75
v_exp_f32 v76, v76
v_exp_f32 v77, v77
v_exp_f32 v78, v78
v_exp_f32 v79, v79
v_fma_f32 v196, -v60, v52, v196
v_fma_f32 v197, -v60, v53, v197
buffer_load_dwordx4 v3, s[8:11], s37 offen offset:2048 sc1 lds
v_fma_f32 v198, -v60, v54, v198
v_fma_f32 v199, -v60, v55, v199
v_fma_f32 v220, -v62, v52, v220
v_fma_f32 v221, -v62, v53, v221
v_fma_f32 v222, -v62, v54, v222
v_fma_f32 v223, -v62, v55, v223
buffer_load_dwordx4 v3, s[8:11], s37 offen offset:3072 sc1 lds
v_fma_f32 v72, v72, v66, v66
v_fma_f32 v73, v73, v66, v66
v_fma_f32 v74, v74, v66, v66
v_fma_f32 v75, v75, v66, v66
v_fma_f32 v76, v76, v70, v70
v_fma_f32 v77, v77, v70, v70
v_fma_f32 v78, v78, v70, v70
s_add_u32 s38, s35, 11
s_and_b32 s38, s38, 15
s_mul_i32 s38, s38, 458752
s_add_u32 m0, s40, 0
s_nop 0
buffer_load_dwordx4 v4, s[12:15], s38 offen lds
v_fma_f32 v79, v79, v70, v70
v_rcp_f32 v72, v72
v_rcp_f32 v73, v73
v_rcp_f32 v74, v74
v_rcp_f32 v75, v75
v_rcp_f32 v76, v76
v_rcp_f32 v77, v77
s_add_u32 m0, s40, 1024
s_nop 0
buffer_load_dwordx4 v5, s[12:15], s38 offen lds
v_rcp_f32 v78, v78
v_rcp_f32 v79, v79
v_mul_f32 v196, v184, v196
v_mul_f32 v197, v185, v197
v_mul_f32 v198, v186, v198
v_mul_f32 v199, v187, v199
v_mul_f32 v220, v208, v220
s_add_u32 m0, s40, 2048
s_add_u32 s38, s38, 57344
buffer_load_dwordx4 v4, s[12:15], s38 offen lds
v_mul_f32 v221, v209, v221
v_mul_f32 v222, v210, v222
v_mul_f32 v223, v211, v223
v_mul_f32 v196, v196, v72
v_mul_f32 v197, v197, v73
v_mul_f32 v198, v198, v74
s_add_u32 m0, s40, 3072
s_nop 0
buffer_load_dwordx4 v5, s[12:15], s38 offen lds
v_mul_f32 v199, v199, v75
v_mul_f32 v220, v220, v76
v_mul_f32 v221, v221, v77
v_mul_f32 v222, v222, v78
v_mul_f32 v223, v223, v79
v_cvt_pk_bf16_f32 v80, v196, v197
v_cvt_pk_bf16_f32 v81, v198, v199
s_add_u32 m0, s40, 4096
s_add_u32 s38, s38, 57344
buffer_load_dwordx4 v4, s[12:15], s38 offen lds
v_cvt_pk_bf16_f32 v82, v220, v221
v_cvt_pk_bf16_f32 v83, v222, v223
s_nop 1
v_permlane32_swap_b32 v80, v82
v_permlane32_swap_b32 v81, v83
buffer_store_dwordx4 v[80:83], v84, s[24:27], s55 offen offset:2048 sc1
s_nop 1
s_add_u32 m0, s40, 5120
s_nop 0
buffer_load_dwordx4 v5, s[12:15], s38 offen lds
v_cmp_gt_u32 vcc, 32, v1
v_mov_b32 v104, s52
v_mov_b32 v106, s53
v_cndmask_b32 v104, v106, v104, vcc
v_lshl_add_u32 v104, v105, 4, v104
v_bfe_u32 v105, v1, 4, 1
v_lshl_add_u32 v104, v105, 2, v104
s_add_u32 m0, s40, 6144
s_add_u32 s38, s38, 57344
buffer_load_dwordx4 v4, s[12:15], s38 offen lds
s_add_u32 m0, s40, 7168
s_nop 0
buffer_load_dwordx4 v5, s[12:15], s38 offen lds
s_waitcnt vmcnt(15)
s_barrier
s_add_u32 s37, s35, 12
s_and_b32 s37, s37, 15
s_mul_i32 s37, s37, 16384
s_add_u32 m0, s39, 49152
s_nop 0
buffer_load_dwordx4 v3, s[8:11], s37 offen sc1 lds
buffer_load_dwordx4 v3, s[8:11], s37 offen offset:1024 sc1 lds
buffer_load_dwordx4 v3, s[8:11], s37 offen offset:2048 sc1 lds
buffer_load_dwordx4 v3, s[8:11], s37 offen offset:3072 sc1 lds
s_add_u32 s38, s35, 12
s_and_b32 s38, s38, 15
s_mul_i32 s38, s38, 458752
s_add_u32 m0, s40, 49152
s_nop 0
buffer_load_dwordx4 v4, s[12:15], s38 offen lds
s_add_u32 m0, s40, 50176
s_nop 0
buffer_load_dwordx4 v5, s[12:15], s38 offen lds
s_add_u32 m0, s40, 51200
s_add_u32 s38, s38, 57344
buffer_load_dwordx4 v4, s[12:15], s38 offen lds
s_add_u32 m0, s40, 52224
s_nop 0
buffer_load_dwordx4 v5, s[12:15], s38 offen lds
s_add_u32 m0, s40, 53248
s_add_u32 s38, s38, 57344
buffer_load_dwordx4 v4, s[12:15], s38 offen lds
s_add_u32 m0, s40, 54272
s_nop 0
buffer_load_dwordx4 v5, s[12:15], s38 offen lds
s_add_u32 m0, s40, 55296
s_add_u32 s38, s38, 57344
buffer_load_dwordx4 v4, s[12:15], s38 offen lds
s_add_u32 m0, s40, 56320
s_nop 0
buffer_load_dwordx4 v5, s[12:15], s38 offen lds
s_waitcnt vmcnt(12)
s_barrier
s_cmp_eq_u32 s47, 0
s_cbranch_scc0 Lw_115
s_add_u32 s7, s34, 32
s_lshl_b32 s7, s7, 7
v_mov_b32 v90, s7
v_mov_b32 v91, 1
s_mov_b64 exec, 1
buffer_atomic_add v91, v90, s[56:59], 0 offen sc1
s_mov_b64 exec, -1
Lw_115:
v_permlane32_swap_b32 v96, v100
v_permlane32_swap_b32 v97, v101
v_permlane32_swap_b32 v98, v102
v_permlane32_swap_b32 v99, v103
v_add_f32 v96, v96, v100
v_add_f32 v97, v97, v101
v_add_f32 v98, v98, v102
v_add_f32 v99, v99, v103
s_nop 1
v_permlane16_swap_b32 v96, v97
v_permlane16_swap_b32 v98, v99
v_add_f32 v96, v96, v97
v_add_f32 v98, v98, v99
s_nop 1
v_add_f32_dpp v96, v96, v96 row_ror:8 row_mask:0xf bank_mask:0xf
v_add_f32_dpp v98, v98, v98 row_ror:8 row_mask:0xf bank_mask:0xf
ds_write_b32 v104, v96
ds_write_b32 v104, v98 offset:8
s_waitcnt lgkmcnt(0)
s_add_u32 s37, s35, 13
s_and_b32 s37, s37, 15
s_mul_i32 s37, s37, 16384
s_add_u32 m0, s39, 98304
s_nop 0
buffer_load_dwordx4 v3, s[8:11], s37 offen sc1 lds
s_load_dword s3, s[4:5], 6272
s_load_dword s3, s[4:5], 6336
s_load_dword s3, s[4:5], 6400
s_load_dword s3, s[4:5], 6464
s_load_dword s3, s[4:5], 6528
s_load_dword s3, s[4:5], 6592
buffer_load_dwordx4 v3, s[8:11], s37 offen offset:1024 sc1 lds
s_load_dword s3, s[4:5], 6656
s_load_dword s3, s[4:5], 6720
s_load_dword s3, s[4:5], 6784
s_load_dword s3, s[4:5], 6848
s_load_dword s3, s[4:5], 6912
s_load_dword s3, s[4:5], 6976
s_load_dword s3, s[4:5], 7040
buffer_load_dwordx4 v3, s[8:11], s37 offen offset:2048 sc1 lds
s_load_dword s3, s[4:5], 7104
s_bfe_u32 s61, s35, 0x10002
s_lshr_b32 s60, s35, 3
s_lshl_b32 s60, s60, 2
s_and_b32 s43, s35, 3
s_add_u32 s60, s60, s43
buffer_load_dwordx4 v3, s[8:11], s37 offen offset:3072 sc1 lds
s_lshl_b32 s43, s60, 8
s_add_u32 s28, s76, s43
s_addc_u32 s29, s77, 0
s_mov_b32 s30, 7338240
s_mov_b32 s31, 0x20000
s_mul_i32 s52, s61, 196608
s_mul_i32 s53, s61, 1572864
s_add_u32 s38, s35, 13
s_and_b32 s38, s38, 15
s_mul_i32 s38, s38, 458752
s_add_u32 m0, s40, 98304
s_nop 0
buffer_load_dwordx4 v4, s[12:15], s38 offen lds
s_mul_i32 s90, s61, 163840
s_mul_i32 s91, s61, 1310720
s_and_b32 s43, s35, 3
s_branch Lov_10
.p2align 12
.fill 80, 4, 0xbf800000
Lst_10_0:
s_branch Lwr_151
Lst_10_1:
s_branch Lwr_166
s_nop 0
Lov_10:
s_mul_i32 s32, s43, 3
s_mul_i32 s33, s43, 10
s_lshr_b32 s33, s33, 2
s_add_u32 m0, s40, 99328
s_nop 0
buffer_load_dwordx4 v5, s[12:15], s38 offen lds
s_lshl_b32 s51, s47, 11
s_lshl_b32 s44, s47, 15
v_lshrrev_b32 v122, 4, v1
v_lshlrev_b32 v123, 1, v122
v_and_b32 v23, 15, v1
v_xor_b32 v23, v23, v123
v_lshlrev_b32 v23, 4, v23
s_add_u32 m0, s40, 100352
s_add_u32 s38, s38, 57344
buffer_load_dwordx4 v4, s[12:15], s38 offen lds
v_mul_u32_u24 v122, 2048, v122
v_add_u32 v23, v23, v122
v_add_u32 v23, s44, v23
v_xor_b32 v24, 128, v23
v_add_u32 v24, 8192, v24
s_lshl_b32 s43, s60, 2
s_add_u32 m0, s40, 101376
s_nop 0
buffer_load_dwordx4 v5, s[12:15], s38 offen lds
s_lshl_b32 s44, s61, 1
s_add_u32 s43, s43, s44
s_add_u32 s43, s43, s63
s_lshl_b32 s43, s43, 13
s_lshl_b32 s44, s62, 12
s_add_u32 s50, s43, s44
v_add_u32 v17, s44, v2
s_add_u32 m0, s40, 102400
s_add_u32 s38, s38, 57344
buffer_load_dwordx4 v4, s[12:15], s38 offen lds
v_add_u32 v18, 0x10000, v17
v_add_u32 v19, 0x20000, v17
v_lshrrev_b32 v122, 2, v1
v_and_b32 v123, 7, v122
v_mul_u32_u24 v122, 256, v122
v_lshl_add_u32 v122, v123, 5, v122
s_add_u32 m0, s40, 103424
s_nop 0
buffer_load_dwordx4 v5, s[12:15], s38 offen lds
v_and_b32 v123, 3, v1
v_lshl_add_u32 v9, v123, 3, v122
s_lshl_b32 s43, s61, 7
s_lshl_b32 s44, s63, 6
s_add_u32 s43, s43, s44
v_xor_b32 v9, s43, v9
v_xor_b32 v10, 32, v9
s_add_u32 m0, s40, 104448
s_add_u32 s38, s38, 57344
buffer_load_dwordx4 v4, s[12:15], s38 offen lds
s_add_u32 m0, s40, 105472
s_nop 0
buffer_load_dwordx4 v5, s[12:15], s38 offen lds
s_waitcnt vmcnt(12)
s_barrier
buffer_load_dwordx4 v[160:163], v2, s[8:11], s50 offen offset:0 sc1
v_xor_b32 v11, 128, v9
v_xor_b32 v12, 128, v10
v_add_u32 v13, 65536, v9
buffer_load_dwordx4 v[164:167], v2, s[8:11], s50 offen offset:1024 sc1
v_add_u32 v14, 65536, v10
v_add_u32 v15, 65536, v11
v_add_u32 v16, 65536, v12
v_add_u32 v25, 131072, v9
buffer_load_dwordx4 v[168:171], v2, s[8:11], s50 offen offset:2048 sc1
v_add_u32 v26, 131072, v10
v_add_u32 v27, 131072, v11
v_add_u32 v28, 131072, v12
v_lshrrev_b32 v122, 2, v1
buffer_load_dwordx4 v[172:175], v2, s[8:11], s50 offen offset:3072 sc1
v_bfe_u32 v123, v122, 1, 2
v_mul_u32_u24 v122, 128, v122
v_lshl_add_u32 v122, v123, 5, v122
s_add_u32 s37, s35, 14
s_and_b32 s37, s37, 15
s_mul_i32 s37, s37, 16384
s_add_u32 m0, s39, 0
s_nop 0
buffer_load_dwordx4 v3, s[8:11], s37 offen sc1 lds
v_and_b32 v123, 3, v1
v_lshl_add_u32 v224, v123, 3, v122
v_xor_b32 v224, s44, v224
v_xor_b32 v225, 32, v224
buffer_load_dwordx4 v3, s[8:11], s37 offen offset:1024 sc1 lds
v_add_u32 v226, 65536, v224
v_add_u32 v227, 65536, v225
v_add_u32 v228, 131072, v224
v_add_u32 v229, 131072, v225
buffer_load_dwordx4 v3, s[8:11], s37 offen offset:2048 sc1 lds
s_add_u32 s84, s82, 33554432
s_addc_u32 s85, s83, 0
s_mov_b32 s86, 4194304
s_mov_b32 s87, 0x20000
buffer_load_dwordx4 v3, s[8:11], s37 offen offset:3072 sc1 lds
s_xor_b32 s43, s2, 2
s_lshl_b32 s44, s43, 2
s_add_u32 s44, s44, s47
s_add_u32 s38, s35, 14
s_and_b32 s38, s38, 15
s_mul_i32 s38, s38, 458752
s_add_u32 m0, s40, 0
s_nop 0
buffer_load_dwordx4 v4, s[12:15], s38 offen lds
s_lshl_b32 s45, s44, 12
s_lshl_b32 s46, s2, 2
s_add_u32 s46, s46, s47
s_lshl_b32 s46, s46, 12
s_add_u32 m0, s40, 1024
s_nop 0
buffer_load_dwordx4 v5, s[12:15], s38 offen lds
s_lshl_b32 s43, s34, 18
s_lshl_b32 s42, s60, 8
s_add_u32 s43, s43, s42
s_lshl_b32 s42, s61, 7
s_add_u32 m0, s40, 2048
s_add_u32 s38, s38, 57344
buffer_load_dwordx4 v4, s[12:15], s38 offen lds
s_add_u32 s43, s43, s42
s_lshl_b32 s42, s63, 6
s_add_u32 s43, s43, s42
s_add_u32 m0, s40, 3072
s_nop 0
buffer_load_dwordx4 v5, s[12:15], s38 offen lds
s_add_u32 s20, s78, s43
s_addc_u32 s21, s79, 0
s_mov_b32 s22, 260160
s_mov_b32 s23, 0x20000
s_add_u32 m0, s40, 4096
s_add_u32 s38, s38, 57344
buffer_load_dwordx4 v4, s[12:15], s38 offen lds
v_and_b32 v230, 15, v1
v_lshlrev_b32 v230, 12, v230
v_bfe_u32 v231, v1, 4, 1
v_lshl_add_u32 v230, v231, 5, v230
s_add_u32 m0, s40, 5120
s_nop 0
buffer_load_dwordx4 v5, s[12:15], s38 offen lds
v_bfe_u32 v231, v1, 5, 1
v_lshl_add_u32 v230, v231, 4, v230
s_lshl_b32 s54, s62, 17
s_add_u32 s55, s54, 65536
s_add_u32 m0, s40, 6144
s_add_u32 s38, s38, 57344
buffer_load_dwordx4 v4, s[12:15], s38 offen lds
s_add_u32 m0, s40, 7168
s_nop 0
buffer_load_dwordx4 v5, s[12:15], s38 offen lds
s_waitcnt vmcnt(16)
s_barrier
s_cmp_eq_u32 s47, 3
s_cbranch_scc0 Lw_116
s_lshl_b32 s92, s34, 7
s_add_u32 s92, s92, 28315648
s_load_dword s93, s[82:83], s92 glc
Lw_116:
s_add_u32 s37, s35, 15
s_and_b32 s37, s37, 15
s_mul_i32 s37, s37, 16384
s_add_u32 m0, s39, 49152
s_nop 0
buffer_load_dwordx4 v3, s[8:11], s37 offen sc1 lds
buffer_load_dwordx4 v3, s[8:11], s37 offen offset:1024 sc1 lds
buffer_load_dwordx4 v3, s[8:11], s37 offen offset:2048 sc1 lds
buffer_load_dwordx4 v3, s[8:11], s37 offen offset:3072 sc1 lds
s_add_u32 s38, s35, 15
s_and_b32 s38, s38, 15
s_mul_i32 s38, s38, 458752
s_add_u32 m0, s40, 49152
s_nop 0
buffer_load_dwordx4 v4, s[12:15], s38 offen lds
s_add_u32 m0, s40, 50176
s_nop 0
buffer_load_dwordx4 v5, s[12:15], s38 offen lds
s_add_u32 m0, s40, 51200
s_add_u32 s38, s38, 57344
buffer_load_dwordx4 v4, s[12:15], s38 offen lds
s_add_u32 m0, s40, 52224
s_nop 0
buffer_load_dwordx4 v5, s[12:15], s38 offen lds
s_add_u32 m0, s40, 53248
s_add_u32 s38, s38, 57344
buffer_load_dwordx4 v4, s[12:15], s38 offen lds
s_add_u32 m0, s40, 54272
s_nop 0
buffer_load_dwordx4 v5, s[12:15], s38 offen lds
s_add_u32 m0, s40, 55296
s_add_u32 s38, s38, 57344
buffer_load_dwordx4 v4, s[12:15], s38 offen lds
s_add_u32 m0, s40, 56320
s_nop 0
buffer_load_dwordx4 v5, s[12:15], s38 offen lds
s_waitcnt vmcnt(12)
s_cmp_eq_u32 s47, 3
s_cbranch_scc0 Lw_117
s_mov_b32 s41, 0x40000
s_branch Lpchk_120
Lpoll_118:
s_load_dword s93, s[82:83], s92 glc
Lpchk_120:
s_waitcnt lgkmcnt(0)
s_cmp_eq_u32 s93, 16
s_cbranch_scc1 Lpok_119
s_sub_u32 s41, s41, 1
s_cmp_lg_u32 s41, 0
s_cbranch_scc1 Lpoll_118
Lpok_119:
Lw_117:
s_barrier
s_add_u32 s37, s52, 524288
s_add_u32 m0, s39, 98304
s_nop 0
buffer_load_dwordx4 v3, s[24:27], s37 offen sc1 lds
v_lshlrev_b32 v128, 16, v160
v_and_b32 v129, 0xffff0000, v160
v_lshlrev_b32 v130, 16, v161
v_and_b32 v131, 0xffff0000, v161
v_lshlrev_b32 v132, 16, v162
buffer_load_dwordx4 v3, s[24:27], s37 offen offset:1024 sc1 lds
v_and_b32 v133, 0xffff0000, v162
v_lshlrev_b32 v134, 16, v163
v_and_b32 v135, 0xffff0000, v163
v_lshlrev_b32 v136, 16, v164
v_and_b32 v137, 0xffff0000, v164
buffer_load_dwordx4 v3, s[24:27], s37 offen offset:2048 sc1 lds
v_lshlrev_b32 v138, 16, v165
v_and_b32 v139, 0xffff0000, v165
v_lshlrev_b32 v140, 16, v166
v_and_b32 v141, 0xffff0000, v166
v_lshlrev_b32 v142, 16, v167
v_and_b32 v143, 0xffff0000, v167
buffer_load_dwordx4 v3, s[24:27], s37 offen offset:3072 sc1 lds
v_lshlrev_b32 v144, 16, v168
v_and_b32 v145, 0xffff0000, v168
v_lshlrev_b32 v146, 16, v169
v_and_b32 v147, 0xffff0000, v169
v_lshlrev_b32 v148, 16, v170
s_add_u32 s38, s53, 4194304
s_add_u32 m0, s39, 114688
s_nop 0
buffer_load_dwordx4 v23, s[28:31], s38 offen lds
v_and_b32 v149, 0xffff0000, v170
v_lshlrev_b32 v150, 16, v171
v_and_b32 v151, 0xffff0000, v171
v_lshlrev_b32 v152, 16, v172
v_and_b32 v153, 0xffff0000, v172
s_add_u32 m0, s39, 115712
s_nop 0
buffer_load_dwordx4 v24, s[28:31], s38 offen lds
v_lshlrev_b32 v154, 16, v173
v_and_b32 v155, 0xffff0000, v173
v_lshlrev_b32 v156, 16, v174
v_and_b32 v157, 0xffff0000, v174
v_lshlrev_b32 v158, 16, v175
v_and_b32 v159, 0xffff0000, v175
s_add_u32 m0, s39, 116736
s_add_u32 s38, s38, 16384
buffer_load_dwordx4 v23, s[28:31], s38 offen lds
s_add_u32 m0, s39, 117760
s_nop 0
buffer_load_dwordx4 v24, s[28:31], s38 offen lds
s_waitcnt vmcnt(8)
s_barrier
s_add_u32 s37, s52, 540672
s_add_u32 m0, s39, 131072
s_nop 0
buffer_load_dwordx4 v3, s[24:27], s37 offen sc1 lds
buffer_load_dwordx4 v3, s[24:27], s37 offen offset:1024 sc1 lds
buffer_load_dwordx4 v3, s[24:27], s37 offen offset:2048 sc1 lds
buffer_load_dwordx4 v3, s[24:27], s37 offen offset:3072 sc1 lds
s_add_u32 s38, s53, 4325376
s_add_u32 m0, s39, 0
s_nop 0
buffer_load_dwordx4 v23, s[28:31], s38 offen lds
s_add_u32 m0, s39, 1024
s_nop 0
buffer_load_dwordx4 v24, s[28:31], s38 offen lds
s_add_u32 m0, s39, 2048
s_add_u32 s38, s38, 16384
buffer_load_dwordx4 v23, s[28:31], s38 offen lds
s_add_u32 m0, s39, 3072
s_nop 0
buffer_load_dwordx4 v24, s[28:31], s38 offen lds
s_add_u32 s37, s52, 557056
s_add_u32 m0, s39, 16384
s_nop 0
buffer_load_dwordx4 v3, s[24:27], s37 offen sc1 lds
buffer_load_dwordx4 v3, s[24:27], s37 offen offset:1024 sc1 lds
buffer_load_dwordx4 v3, s[24:27], s37 offen offset:2048 sc1 lds
buffer_load_dwordx4 v3, s[24:27], s37 offen offset:3072 sc1 lds
s_add_u32 s38, s53, 4456448
s_add_u32 m0, s39, 32768
s_nop 0
buffer_load_dwordx4 v23, s[28:31], s38 offen lds
s_add_u32 m0, s39, 33792
s_nop 0
buffer_load_dwordx4 v24, s[28:31], s38 offen lds
s_add_u32 m0, s39, 34816
s_add_u32 s38, s38, 16384
buffer_load_dwordx4 v23, s[28:31], s38 offen lds
s_add_u32 m0, s39, 35840
s_nop 0
buffer_load_dwordx4 v24, s[28:31], s38 offen lds
s_waitcnt vmcnt(16)
s_barrier
ds_read_b128 v[32:35], v18 offset:32768
ds_read_b64_tr_b16 v[48:49], v13 offset:49152
ds_read_b64_tr_b16 v[50:51], v13 offset:53248
ds_read_b64_tr_b16 v[52:53], v14 offset:49152
ds_read_b64_tr_b16 v[54:55], v14 offset:53248
ds_read_b64_tr_b16 v[56:57], v15 offset:49152
ds_read_b64_tr_b16 v[58:59], v15 offset:53248
ds_read_b64_tr_b16 v[60:61], v16 offset:49152
ds_read_b64_tr_b16 v[62:63], v16 offset:53248
ds_read_b128 v[36:39], v18 offset:33792
ds_read_b128 v[40:43], v18 offset:34816
ds_read_b128 v[44:47], v18 offset:35840
ds_read_b128 v[64:67], v18 offset:40960
ds_read_b64_tr_b16 v[80:81], v13 offset:57344
ds_read_b64_tr_b16 v[82:83], v13 offset:61440
ds_read_b64_tr_b16 v[84:85], v14 offset:57344
ds_read_b64_tr_b16 v[86:87], v14 offset:61440
ds_read_b64_tr_b16 v[88:89], v15 offset:57344
ds_read_b64_tr_b16 v[90:91], v15 offset:61440
ds_read_b64_tr_b16 v[92:93], v16 offset:57344
ds_read_b64_tr_b16 v[94:95], v16 offset:61440
ds_read_b128 v[68:71], v18 offset:41984
ds_read_b128 v[72:75], v18 offset:43008
ds_read_b128 v[76:79], v18 offset:44032
s_add_u32 s37, s52, 573440
s_add_u32 m0, s39, 49152
s_nop 0
buffer_load_dwordx4 v3, s[24:27], s37 offen sc1 lds
buffer_load_dwordx4 v3, s[24:27], s37 offen offset:1024 sc1 lds
buffer_load_dwordx4 v3, s[24:27], s37 offen offset:2048 sc1 lds
buffer_load_dwordx4 v3, s[24:27], s37 offen offset:3072 sc1 lds
s_add_u32 s38, s53, 4587520
s_add_u32 m0, s39, 65536
s_nop 0
buffer_load_dwordx4 v23, s[28:31], s38 offen lds
s_add_u32 m0, s39, 66560
s_nop 0
buffer_load_dwordx4 v24, s[28:31], s38 offen lds
s_add_u32 m0, s39, 67584
s_add_u32 s38, s38, 16384
buffer_load_dwordx4 v23, s[28:31], s38 offen lds
s_add_u32 m0, s39, 68608
s_nop 0
buffer_load_dwordx4 v24, s[28:31], s38 offen lds
s_waitcnt vmcnt(16)
s_waitcnt lgkmcnt(0)
s_barrier
v_mfma_f32_16x16x32_bf16 v[128:131], v[48:51], v[32:35], v[128:131]
ds_read_b128 v[96:99], v19 offset:0
v_mfma_f32_16x16x32_bf16 v[132:135], v[52:55], v[32:35], v[132:135]
ds_read_b64_tr_b16 v[112:113], v9 offset:0
v_mfma_f32_16x16x32_bf16 v[160:163], v[56:59], v[32:35], 0
ds_read_b64_tr_b16 v[114:115], v9 offset:4096
v_mfma_f32_16x16x32_bf16 v[164:167], v[60:63], v[32:35], 0
ds_read_b64_tr_b16 v[116:117], v10 offset:0
v_mfma_f32_16x16x32_bf16 v[172:175], v[60:63], v[36:39], 0
ds_read_b64_tr_b16 v[118:119], v10 offset:4096
v_mfma_f32_16x16x32_bf16 v[168:171], v[56:59], v[36:39], 0
ds_read_b64_tr_b16 v[120:121], v11 offset:0
v_mfma_f32_16x16x32_bf16 v[140:143], v[52:55], v[36:39], v[140:143]
ds_read_b64_tr_b16 v[122:123], v11 offset:4096
v_mfma_f32_16x16x32_bf16 v[136:139], v[48:51], v[36:39], v[136:139]
ds_read_b64_tr_b16 v[124:125], v12 offset:0
v_mfma_f32_16x16x32_bf16 v[144:147], v[48:51], v[40:43], v[144:147]
ds_read_b64_tr_b16 v[126:127], v12 offset:4096
v_mfma_f32_16x16x32_bf16 v[148:151], v[52:55], v[40:43], v[148:151]
ds_read_b128 v[100:103], v19 offset:1024
v_mfma_f32_16x16x32_bf16 v[176:179], v[56:59], v[40:43], 0
ds_read_b128 v[104:107], v19 offset:2048
v_mfma_f32_16x16x32_bf16 v[180:183], v[60:63], v[40:43], 0
ds_read_b128 v[108:111], v19 offset:3072
v_mfma_f32_16x16x32_bf16 v[188:191], v[60:63], v[44:47], 0
ds_read_b128 v[192:195], v19 offset:8192
v_mfma_f32_16x16x32_bf16 v[184:187], v[56:59], v[44:47], 0
ds_read_b64_tr_b16 v[208:209], v9 offset:8192
v_mfma_f32_16x16x32_bf16 v[156:159], v[52:55], v[44:47], v[156:159]
ds_read_b64_tr_b16 v[210:211], v9 offset:12288
v_mfma_f32_16x16x32_bf16 v[152:155], v[48:51], v[44:47], v[152:155]
ds_read_b64_tr_b16 v[212:213], v10 offset:8192
v_mfma_f32_16x16x32_bf16 v[128:131], v[80:83], v[64:67], v[128:131]
ds_read_b64_tr_b16 v[214:215], v10 offset:12288
v_mfma_f32_16x16x32_bf16 v[132:135], v[84:87], v[64:67], v[132:135]
ds_read_b64_tr_b16 v[216:217], v11 offset:8192
v_mfma_f32_16x16x32_bf16 v[160:163], v[88:91], v[64:67], v[160:163]
ds_read_b64_tr_b16 v[218:219], v11 offset:12288
v_mfma_f32_16x16x32_bf16 v[164:167], v[92:95], v[64:67], v[164:167]
ds_read_b64_tr_b16 v[220:221], v12 offset:8192
v_mfma_f32_16x16x32_bf16 v[172:175], v[92:95], v[68:71], v[172:175]
ds_read_b64_tr_b16 v[222:223], v12 offset:12288
v_mfma_f32_16x16x32_bf16 v[168:171], v[88:91], v[68:71], v[168:171]
ds_read_b128 v[196:199], v19 offset:9216
v_mfma_f32_16x16x32_bf16 v[140:143], v[84:87], v[68:71], v[140:143]
ds_read_b128 v[200:203], v19 offset:10240
v_mfma_f32_16x16x32_bf16 v[136:139], v[80:83], v[68:71], v[136:139]
ds_read_b128 v[204:207], v19 offset:11264
v_mfma_f32_16x16x32_bf16 v[144:147], v[80:83], v[72:75], v[144:147]
v_mfma_f32_16x16x32_bf16 v[148:151], v[84:87], v[72:75], v[148:151]
v_mfma_f32_16x16x32_bf16 v[176:179], v[88:91], v[72:75], v[176:179]
v_mfma_f32_16x16x32_bf16 v[180:183], v[92:95], v[72:75], v[180:183]
v_mfma_f32_16x16x32_bf16 v[188:191], v[92:95], v[76:79], v[188:191]
v_mfma_f32_16x16x32_bf16 v[184:187], v[88:91], v[76:79], v[184:187]
v_mfma_f32_16x16x32_bf16 v[156:159], v[84:87], v[76:79], v[156:159]
v_mfma_f32_16x16x32_bf16 v[152:155], v[80:83], v[76:79], v[152:155]
s_mov_b32 s41, 2
Lk4_121:
s_waitcnt vmcnt(8)
s_waitcnt lgkmcnt(0)
s_barrier
v_mfma_f32_16x16x32_bf16 v[128:131], v[112:115], v[96:99], v[128:131]
ds_read_b128 v[32:35], v17 offset:16384
v_mfma_f32_16x16x32_bf16 v[132:135], v[116:119], v[96:99], v[132:135]
ds_read_b64_tr_b16 v[48:49], v9 offset:32768
v_mfma_f32_16x16x32_bf16 v[160:163], v[120:123], v[96:99], v[160:163]
ds_read_b64_tr_b16 v[50:51], v9 offset:36864
v_mfma_f32_16x16x32_bf16 v[164:167], v[124:127], v[96:99], v[164:167]
ds_read_b64_tr_b16 v[52:53], v10 offset:32768
v_mfma_f32_16x16x32_bf16 v[172:175], v[124:127], v[100:103], v[172:175]
ds_read_b64_tr_b16 v[54:55], v10 offset:36864
v_mfma_f32_16x16x32_bf16 v[168:171], v[120:123], v[100:103], v[168:171]
ds_read_b64_tr_b16 v[56:57], v11 offset:32768
v_mfma_f32_16x16x32_bf16 v[140:143], v[116:119], v[100:103], v[140:143]
ds_read_b64_tr_b16 v[58:59], v11 offset:36864
v_mfma_f32_16x16x32_bf16 v[136:139], v[112:115], v[100:103], v[136:139]
ds_read_b64_tr_b16 v[60:61], v12 offset:32768
v_mfma_f32_16x16x32_bf16 v[144:147], v[112:115], v[104:107], v[144:147]
ds_read_b64_tr_b16 v[62:63], v12 offset:36864
v_mfma_f32_16x16x32_bf16 v[148:151], v[116:119], v[104:107], v[148:151]
ds_read_b128 v[36:39], v17 offset:17408
v_mfma_f32_16x16x32_bf16 v[176:179], v[120:123], v[104:107], v[176:179]
ds_read_b128 v[40:43], v17 offset:18432
v_mfma_f32_16x16x32_bf16 v[180:183], v[124:127], v[104:107], v[180:183]
ds_read_b128 v[44:47], v17 offset:19456
v_mfma_f32_16x16x32_bf16 v[188:191], v[124:127], v[108:111], v[188:191]
ds_read_b128 v[64:67], v17 offset:24576
v_mfma_f32_16x16x32_bf16 v[184:187], v[120:123], v[108:111], v[184:187]
ds_read_b64_tr_b16 v[80:81], v9 offset:40960
v_mfma_f32_16x16x32_bf16 v[156:159], v[116:119], v[108:111], v[156:159]
ds_read_b64_tr_b16 v[82:83], v9 offset:45056
v_mfma_f32_16x16x32_bf16 v[152:155], v[112:115], v[108:111], v[152:155]
ds_read_b64_tr_b16 v[84:85], v10 offset:40960
v_mfma_f32_16x16x32_bf16 v[128:131], v[208:211], v[192:195], v[128:131]
ds_read_b64_tr_b16 v[86:87], v10 offset:45056
v_mfma_f32_16x16x32_bf16 v[132:135], v[212:215], v[192:195], v[132:135]
ds_read_b64_tr_b16 v[88:89], v11 offset:40960
v_mfma_f32_16x16x32_bf16 v[160:163], v[216:219], v[192:195], v[160:163]
ds_read_b64_tr_b16 v[90:91], v11 offset:45056
v_mfma_f32_16x16x32_bf16 v[164:167], v[220:223], v[192:195], v[164:167]
ds_read_b64_tr_b16 v[92:93], v12 offset:40960
v_mfma_f32_16x16x32_bf16 v[172:175], v[220:223], v[196:199], v[172:175]
ds_read_b64_tr_b16 v[94:95], v12 offset:45056
v_mfma_f32_16x16x32_bf16 v[168:171], v[216:219], v[196:199], v[168:171]
ds_read_b128 v[68:71], v17 offset:25600
v_mfma_f32_16x16x32_bf16 v[140:143], v[212:215], v[196:199], v[140:143]
ds_read_b128 v[72:75], v17 offset:26624
v_mfma_f32_16x16x32_bf16 v[136:139], v[208:211], v[196:199], v[136:139]
ds_read_b128 v[76:79], v17 offset:27648
v_mfma_f32_16x16x32_bf16 v[144:147], v[208:211], v[200:203], v[144:147]
v_mfma_f32_16x16x32_bf16 v[148:151], v[212:215], v[200:203], v[148:151]
v_mfma_f32_16x16x32_bf16 v[176:179], v[216:219], v[200:203], v[176:179]
v_mfma_f32_16x16x32_bf16 v[180:183], v[220:223], v[200:203], v[180:183]
v_mfma_f32_16x16x32_bf16 v[188:191], v[220:223], v[204:207], v[188:191]
v_mfma_f32_16x16x32_bf16 v[184:187], v[216:219], v[204:207], v[184:187]
v_mfma_f32_16x16x32_bf16 v[156:159], v[212:215], v[204:207], v[156:159]
v_mfma_f32_16x16x32_bf16 v[152:155], v[208:211], v[204:207], v[152:155]
s_waitcnt vmcnt(0)
s_waitcnt lgkmcnt(0)
s_barrier
v_mfma_f32_16x16x32_bf16 v[128:131], v[48:51], v[32:35], v[128:131]
ds_read_b128 v[96:99], v17 offset:49152
v_mfma_f32_16x16x32_bf16 v[132:135], v[52:55], v[32:35], v[132:135]
ds_read_b64_tr_b16 v[112:113], v13 offset:0
v_mfma_f32_16x16x32_bf16 v[160:163], v[56:59], v[32:35], v[160:163]
ds_read_b64_tr_b16 v[114:115], v13 offset:4096
v_mfma_f32_16x16x32_bf16 v[164:167], v[60:63], v[32:35], v[164:167]
ds_read_b64_tr_b16 v[116:117], v14 offset:0
v_mfma_f32_16x16x32_bf16 v[172:175], v[60:63], v[36:39], v[172:175]
ds_read_b64_tr_b16 v[118:119], v14 offset:4096
v_mfma_f32_16x16x32_bf16 v[168:171], v[56:59], v[36:39], v[168:171]
ds_read_b64_tr_b16 v[120:121], v15 offset:0
v_mfma_f32_16x16x32_bf16 v[140:143], v[52:55], v[36:39], v[140:143]
ds_read_b64_tr_b16 v[122:123], v15 offset:4096
v_mfma_f32_16x16x32_bf16 v[136:139], v[48:51], v[36:39], v[136:139]
ds_read_b64_tr_b16 v[124:125], v16 offset:0
v_mfma_f32_16x16x32_bf16 v[144:147], v[48:51], v[40:43], v[144:147]
ds_read_b64_tr_b16 v[126:127], v16 offset:4096
v_mfma_f32_16x16x32_bf16 v[148:151], v[52:55], v[40:43], v[148:151]
ds_read_b128 v[100:103], v17 offset:50176
v_mfma_f32_16x16x32_bf16 v[176:179], v[56:59], v[40:43], v[176:179]
ds_read_b128 v[104:107], v17 offset:51200
v_mfma_f32_16x16x32_bf16 v[180:183], v[60:63], v[40:43], v[180:183]
ds_read_b128 v[108:111], v17 offset:52224
v_mfma_f32_16x16x32_bf16 v[188:191], v[60:63], v[44:47], v[188:191]
ds_read_b128 v[192:195], v17 offset:57344
v_mfma_f32_16x16x32_bf16 v[184:187], v[56:59], v[44:47], v[184:187]
ds_read_b64_tr_b16 v[208:209], v13 offset:8192
v_mfma_f32_16x16x32_bf16 v[156:159], v[52:55], v[44:47], v[156:159]
ds_read_b64_tr_b16 v[210:211], v13 offset:12288
v_mfma_f32_16x16x32_bf16 v[152:155], v[48:51], v[44:47], v[152:155]
ds_read_b64_tr_b16 v[212:213], v14 offset:8192
v_mfma_f32_16x16x32_bf16 v[128:131], v[80:83], v[64:67], v[128:131]
ds_read_b64_tr_b16 v[214:215], v14 offset:12288
v_mfma_f32_16x16x32_bf16 v[132:135], v[84:87], v[64:67], v[132:135]
ds_read_b64_tr_b16 v[216:217], v15 offset:8192
v_mfma_f32_16x16x32_bf16 v[160:163], v[88:91], v[64:67], v[160:163]
ds_read_b64_tr_b16 v[218:219], v15 offset:12288
v_mfma_f32_16x16x32_bf16 v[164:167], v[92:95], v[64:67], v[164:167]
ds_read_b64_tr_b16 v[220:221], v16 offset:8192
v_mfma_f32_16x16x32_bf16 v[172:175], v[92:95], v[68:71], v[172:175]
ds_read_b64_tr_b16 v[222:223], v16 offset:12288
v_mfma_f32_16x16x32_bf16 v[168:171], v[88:91], v[68:71], v[168:171]
ds_read_b128 v[196:199], v17 offset:58368
v_mfma_f32_16x16x32_bf16 v[140:143], v[84:87], v[68:71], v[140:143]
ds_read_b128 v[200:203], v17 offset:59392
v_mfma_f32_16x16x32_bf16 v[136:139], v[80:83], v[68:71], v[136:139]
ds_read_b128 v[204:207], v17 offset:60416
v_mfma_f32_16x16x32_bf16 v[144:147], v[80:83], v[72:75], v[144:147]
v_mfma_f32_16x16x32_bf16 v[148:151], v[84:87], v[72:75], v[148:151]
v_mfma_f32_16x16x32_bf16 v[176:179], v[88:91], v[72:75], v[176:179]
v_mfma_f32_16x16x32_bf16 v[180:183], v[92:95], v[72:75], v[180:183]
v_mfma_f32_16x16x32_bf16 v[188:191], v[92:95], v[76:79], v[188:191]
v_mfma_f32_16x16x32_bf16 v[184:187], v[88:91], v[76:79], v[184:187]
v_mfma_f32_16x16x32_bf16 v[156:159], v[84:87], v[76:79], v[156:159]
v_mfma_f32_16x16x32_bf16 v[152:155], v[80:83], v[76:79], v[152:155]
s_waitcnt lgkmcnt(0)
s_barrier
v_mfma_f32_16x16x32_bf16 v[128:131], v[112:115], v[96:99], v[128:131]
ds_read_b128 v[32:35], v18 offset:16384
v_mfma_f32_16x16x32_bf16 v[132:135], v[116:119], v[96:99], v[132:135]
ds_read_b64_tr_b16 v[48:49], v25 offset:16384
v_mfma_f32_16x16x32_bf16 v[160:163], v[120:123], v[96:99], v[160:163]
ds_read_b64_tr_b16 v[50:51], v25 offset:20480
v_mfma_f32_16x16x32_bf16 v[164:167], v[124:127], v[96:99], v[164:167]
ds_read_b64_tr_b16 v[52:53], v26 offset:16384
v_mfma_f32_16x16x32_bf16 v[172:175], v[124:127], v[100:103], v[172:175]
ds_read_b64_tr_b16 v[54:55], v26 offset:20480
v_mfma_f32_16x16x32_bf16 v[168:171], v[120:123], v[100:103], v[168:171]
ds_read_b64_tr_b16 v[56:57], v27 offset:16384
v_mfma_f32_16x16x32_bf16 v[140:143], v[116:119], v[100:103], v[140:143]
ds_read_b64_tr_b16 v[58:59], v27 offset:20480
v_mfma_f32_16x16x32_bf16 v[136:139], v[112:115], v[100:103], v[136:139]
s_branch Lov_11
.p2align 12
.fill 80, 4, 0xbf800000
Lst_11_0:
s_branch Lwr_152
Lst_11_1:
s_branch Lst_15_1
s_nop 0
Lov_11:
ds_read_b64_tr_b16 v[60:61], v28 offset:16384
v_mfma_f32_16x16x32_bf16 v[144:147], v[112:115], v[104:107], v[144:147]
ds_read_b64_tr_b16 v[62:63], v28 offset:20480
v_mfma_f32_16x16x32_bf16 v[148:151], v[116:119], v[104:107], v[148:151]
ds_read_b128 v[36:39], v18 offset:17408
v_mfma_f32_16x16x32_bf16 v[176:179], v[120:123], v[104:107], v[176:179]
ds_read_b128 v[40:43], v18 offset:18432
v_mfma_f32_16x16x32_bf16 v[180:183], v[124:127], v[104:107], v[180:183]
ds_read_b128 v[44:47], v18 offset:19456
v_mfma_f32_16x16x32_bf16 v[188:191], v[124:127], v[108:111], v[188:191]
ds_read_b128 v[64:67], v18 offset:24576
v_mfma_f32_16x16x32_bf16 v[184:187], v[120:123], v[108:111], v[184:187]
ds_read_b64_tr_b16 v[80:81], v25 offset:24576
v_mfma_f32_16x16x32_bf16 v[156:159], v[116:119], v[108:111], v[156:159]
ds_read_b64_tr_b16 v[82:83], v25 offset:28672
v_mfma_f32_16x16x32_bf16 v[152:155], v[112:115], v[108:111], v[152:155]
ds_read_b64_tr_b16 v[84:85], v26 offset:24576
v_mfma_f32_16x16x32_bf16 v[128:131], v[208:211], v[192:195], v[128:131]
ds_read_b64_tr_b16 v[86:87], v26 offset:28672
v_mfma_f32_16x16x32_bf16 v[132:135], v[212:215], v[192:195], v[132:135]
ds_read_b64_tr_b16 v[88:89], v27 offset:24576
v_mfma_f32_16x16x32_bf16 v[160:163], v[216:219], v[192:195], v[160:163]
ds_read_b64_tr_b16 v[90:91], v27 offset:28672
v_mfma_f32_16x16x32_bf16 v[164:167], v[220:223], v[192:195], v[164:167]
ds_read_b64_tr_b16 v[92:93], v28 offset:24576
v_mfma_f32_16x16x32_bf16 v[172:175], v[220:223], v[196:199], v[172:175]
ds_read_b64_tr_b16 v[94:95], v28 offset:28672
v_mfma_f32_16x16x32_bf16 v[168:171], v[216:219], v[196:199], v[168:171]
ds_read_b128 v[68:71], v18 offset:25600
v_mfma_f32_16x16x32_bf16 v[140:143], v[212:215], v[196:199], v[140:143]
ds_read_b128 v[72:75], v18 offset:26624
v_mfma_f32_16x16x32_bf16 v[136:139], v[208:211], v[196:199], v[136:139]
ds_read_b128 v[76:79], v18 offset:27648
v_mfma_f32_16x16x32_bf16 v[144:147], v[208:211], v[200:203], v[144:147]
v_mfma_f32_16x16x32_bf16 v[148:151], v[212:215], v[200:203], v[148:151]
v_mfma_f32_16x16x32_bf16 v[176:179], v[216:219], v[200:203], v[176:179]
v_mfma_f32_16x16x32_bf16 v[180:183], v[220:223], v[200:203], v[180:183]
v_mfma_f32_16x16x32_bf16 v[188:191], v[220:223], v[204:207], v[188:191]
v_mfma_f32_16x16x32_bf16 v[184:187], v[216:219], v[204:207], v[184:187]
v_mfma_f32_16x16x32_bf16 v[156:159], v[212:215], v[204:207], v[156:159]
v_mfma_f32_16x16x32_bf16 v[152:155], v[208:211], v[204:207], v[152:155]
s_waitcnt lgkmcnt(0)
s_barrier
v_mfma_f32_16x16x32_bf16 v[128:131], v[48:51], v[32:35], v[128:131]
ds_read_b128 v[96:99], v18 offset:32768
v_mfma_f32_16x16x32_bf16 v[132:135], v[52:55], v[32:35], v[132:135]
ds_read_b64_tr_b16 v[112:113], v13 offset:49152
v_mfma_f32_16x16x32_bf16 v[160:163], v[56:59], v[32:35], v[160:163]
ds_read_b64_tr_b16 v[114:115], v13 offset:53248
v_mfma_f32_16x16x32_bf16 v[164:167], v[60:63], v[32:35], v[164:167]
ds_read_b64_tr_b16 v[116:117], v14 offset:49152
v_mfma_f32_16x16x32_bf16 v[172:175], v[60:63], v[36:39], v[172:175]
ds_read_b64_tr_b16 v[118:119], v14 offset:53248
v_mfma_f32_16x16x32_bf16 v[168:171], v[56:59], v[36:39], v[168:171]
ds_read_b64_tr_b16 v[120:121], v15 offset:49152
v_mfma_f32_16x16x32_bf16 v[140:143], v[52:55], v[36:39], v[140:143]
ds_read_b64_tr_b16 v[122:123], v15 offset:53248
v_mfma_f32_16x16x32_bf16 v[136:139], v[48:51], v[36:39], v[136:139]
ds_read_b64_tr_b16 v[124:125], v16 offset:49152
v_mfma_f32_16x16x32_bf16 v[144:147], v[48:51], v[40:43], v[144:147]
ds_read_b64_tr_b16 v[126:127], v16 offset:53248
v_mfma_f32_16x16x32_bf16 v[148:151], v[52:55], v[40:43], v[148:151]
ds_read_b128 v[100:103], v18 offset:33792
v_mfma_f32_16x16x32_bf16 v[176:179], v[56:59], v[40:43], v[176:179]
ds_read_b128 v[104:107], v18 offset:34816
v_mfma_f32_16x16x32_bf16 v[180:183], v[60:63], v[40:43], v[180:183]
ds_read_b128 v[108:111], v18 offset:35840
v_mfma_f32_16x16x32_bf16 v[188:191], v[60:63], v[44:47], v[188:191]
ds_read_b128 v[192:195], v18 offset:40960
v_mfma_f32_16x16x32_bf16 v[184:187], v[56:59], v[44:47], v[184:187]
ds_read_b64_tr_b16 v[208:209], v13 offset:57344
v_mfma_f32_16x16x32_bf16 v[156:159], v[52:55], v[44:47], v[156:159]
ds_read_b64_tr_b16 v[210:211], v13 offset:61440
v_mfma_f32_16x16x32_bf16 v[152:155], v[48:51], v[44:47], v[152:155]
ds_read_b64_tr_b16 v[212:213], v14 offset:57344
v_mfma_f32_16x16x32_bf16 v[128:131], v[80:83], v[64:67], v[128:131]
ds_read_b64_tr_b16 v[214:215], v14 offset:61440
v_mfma_f32_16x16x32_bf16 v[132:135], v[84:87], v[64:67], v[132:135]
ds_read_b64_tr_b16 v[216:217], v15 offset:57344
v_mfma_f32_16x16x32_bf16 v[160:163], v[88:91], v[64:67], v[160:163]
ds_read_b64_tr_b16 v[218:219], v15 offset:61440
v_mfma_f32_16x16x32_bf16 v[164:167], v[92:95], v[64:67], v[164:167]
ds_read_b64_tr_b16 v[220:221], v16 offset:57344
v_mfma_f32_16x16x32_bf16 v[172:175], v[92:95], v[68:71], v[172:175]
ds_read_b64_tr_b16 v[222:223], v16 offset:61440
v_mfma_f32_16x16x32_bf16 v[168:171], v[88:91], v[68:71], v[168:171]
ds_read_b128 v[196:199], v18 offset:41984
v_mfma_f32_16x16x32_bf16 v[140:143], v[84:87], v[68:71], v[140:143]
ds_read_b128 v[200:203], v18 offset:43008
v_mfma_f32_16x16x32_bf16 v[136:139], v[80:83], v[68:71], v[136:139]
ds_read_b128 v[204:207], v18 offset:44032
v_mfma_f32_16x16x32_bf16 v[144:147], v[80:83], v[72:75], v[144:147]
v_mfma_f32_16x16x32_bf16 v[148:151], v[84:87], v[72:75], v[148:151]
v_mfma_f32_16x16x32_bf16 v[176:179], v[88:91], v[72:75], v[176:179]
v_mfma_f32_16x16x32_bf16 v[180:183], v[92:95], v[72:75], v[180:183]
v_mfma_f32_16x16x32_bf16 v[188:191], v[92:95], v[76:79], v[188:191]
v_mfma_f32_16x16x32_bf16 v[184:187], v[88:91], v[76:79], v[184:187]
v_mfma_f32_16x16x32_bf16 v[156:159], v[84:87], v[76:79], v[156:159]
v_mfma_f32_16x16x32_bf16 v[152:155], v[80:83], v[76:79], v[152:155]
s_waitcnt lgkmcnt(0)
s_barrier
v_mfma_f32_16x16x32_bf16 v[128:131], v[112:115], v[96:99], v[128:131]
ds_read_b128 v[32:35], v19 offset:0
v_mfma_f32_16x16x32_bf16 v[132:135], v[116:119], v[96:99], v[132:135]
ds_read_b64_tr_b16 v[48:49], v9 offset:0
v_mfma_f32_16x16x32_bf16 v[160:163], v[120:123], v[96:99], v[160:163]
ds_read_b64_tr_b16 v[50:51], v9 offset:4096
v_mfma_f32_16x16x32_bf16 v[164:167], v[124:127], v[96:99], v[164:167]
ds_read_b64_tr_b16 v[52:53], v10 offset:0
v_mfma_f32_16x16x32_bf16 v[172:175], v[124:127], v[100:103], v[172:175]
ds_read_b64_tr_b16 v[54:55], v10 offset:4096
v_mfma_f32_16x16x32_bf16 v[168:171], v[120:123], v[100:103], v[168:171]
ds_read_b64_tr_b16 v[56:57], v11 offset:0
v_mfma_f32_16x16x32_bf16 v[140:143], v[116:119], v[100:103], v[140:143]
ds_read_b64_tr_b16 v[58:59], v11 offset:4096
v_mfma_f32_16x16x32_bf16 v[136:139], v[112:115], v[100:103], v[136:139]
ds_read_b64_tr_b16 v[60:61], v12 offset:0
v_mfma_f32_16x16x32_bf16 v[144:147], v[112:115], v[104:107], v[144:147]
ds_read_b64_tr_b16 v[62:63], v12 offset:4096
v_mfma_f32_16x16x32_bf16 v[148:151], v[116:119], v[104:107], v[148:151]
ds_read_b128 v[36:39], v19 offset:1024
v_mfma_f32_16x16x32_bf16 v[176:179], v[120:123], v[104:107], v[176:179]
ds_read_b128 v[40:43], v19 offset:2048
v_mfma_f32_16x16x32_bf16 v[180:183], v[124:127], v[104:107], v[180:183]
ds_read_b128 v[44:47], v19 offset:3072
v_mfma_f32_16x16x32_bf16 v[188:191], v[124:127], v[108:111], v[188:191]
ds_read_b128 v[64:67], v19 offset:8192
v_mfma_f32_16x16x32_bf16 v[184:187], v[120:123], v[108:111], v[184:187]
ds_read_b64_tr_b16 v[80:81], v9 offset:8192
v_mfma_f32_16x16x32_bf16 v[156:159], v[116:119], v[108:111], v[156:159]
ds_read_b64_tr_b16 v[82:83], v9 offset:12288
v_mfma_f32_16x16x32_bf16 v[152:155], v[112:115], v[108:111], v[152:155]
ds_read_b64_tr_b16 v[84:85], v10 offset:8192
v_mfma_f32_16x16x32_bf16 v[128:131], v[208:211], v[192:195], v[128:131]
ds_read_b64_tr_b16 v[86:87], v10 offset:12288
v_mfma_f32_16x16x32_bf16 v[132:135], v[212:215], v[192:195], v[132:135]
ds_read_b64_tr_b16 v[88:89], v11 offset:8192
v_mfma_f32_16x16x32_bf16 v[160:163], v[216:219], v[192:195], v[160:163]
ds_read_b64_tr_b16 v[90:91], v11 offset:12288
v_mfma_f32_16x16x32_bf16 v[164:167], v[220:223], v[192:195], v[164:167]
ds_read_b64_tr_b16 v[92:93], v12 offset:8192
v_mfma_f32_16x16x32_bf16 v[172:175], v[220:223], v[196:199], v[172:175]
ds_read_b64_tr_b16 v[94:95], v12 offset:12288
v_mfma_f32_16x16x32_bf16 v[168:171], v[216:219], v[196:199], v[168:171]
ds_read_b128 v[68:71], v19 offset:9216
v_mfma_f32_16x16x32_bf16 v[140:143], v[212:215], v[196:199], v[140:143]
ds_read_b128 v[72:75], v19 offset:10240
v_mfma_f32_16x16x32_bf16 v[136:139], v[208:211], v[196:199], v[136:139]
ds_read_b128 v[76:79], v19 offset:11264
v_mfma_f32_16x16x32_bf16 v[144:147], v[208:211], v[200:203], v[144:147]
v_mfma_f32_16x16x32_bf16 v[148:151], v[212:215], v[200:203], v[148:151]
v_mfma_f32_16x16x32_bf16 v[176:179], v[216:219], v[200:203], v[176:179]
v_mfma_f32_16x16x32_bf16 v[180:183], v[220:223], v[200:203], v[180:183]
v_mfma_f32_16x16x32_bf16 v[188:191], v[220:223], v[204:207], v[188:191]
v_mfma_f32_16x16x32_bf16 v[184:187], v[216:219], v[204:207], v[184:187]
v_mfma_f32_16x16x32_bf16 v[156:159], v[212:215], v[204:207], v[156:159]
v_mfma_f32_16x16x32_bf16 v[152:155], v[208:211], v[204:207], v[152:155]
s_waitcnt lgkmcnt(0)
s_barrier
v_mfma_f32_16x16x32_bf16 v[128:131], v[48:51], v[32:35], v[128:131]
ds_read_b128 v[96:99], v17 offset:16384
v_mfma_f32_16x16x32_bf16 v[132:135], v[52:55], v[32:35], v[132:135]
ds_read_b64_tr_b16 v[112:113], v9 offset:32768
v_mfma_f32_16x16x32_bf16 v[160:163], v[56:59], v[32:35], v[160:163]
ds_read_b64_tr_b16 v[114:115], v9 offset:36864
v_mfma_f32_16x16x32_bf16 v[164:167], v[60:63], v[32:35], v[164:167]
ds_read_b64_tr_b16 v[116:117], v10 offset:32768
v_mfma_f32_16x16x32_bf16 v[172:175], v[60:63], v[36:39], v[172:175]
ds_read_b64_tr_b16 v[118:119], v10 offset:36864
v_mfma_f32_16x16x32_bf16 v[168:171], v[56:59], v[36:39], v[168:171]
ds_read_b64_tr_b16 v[120:121], v11 offset:32768
v_mfma_f32_16x16x32_bf16 v[140:143], v[52:55], v[36:39], v[140:143]
ds_read_b64_tr_b16 v[122:123], v11 offset:36864
v_mfma_f32_16x16x32_bf16 v[136:139], v[48:51], v[36:39], v[136:139]
ds_read_b64_tr_b16 v[124:125], v12 offset:32768
v_mfma_f32_16x16x32_bf16 v[144:147], v[48:51], v[40:43], v[144:147]
ds_read_b64_tr_b16 v[126:127], v12 offset:36864
v_mfma_f32_16x16x32_bf16 v[148:151], v[52:55], v[40:43], v[148:151]
ds_read_b128 v[100:103], v17 offset:17408
v_mfma_f32_16x16x32_bf16 v[176:179], v[56:59], v[40:43], v[176:179]
ds_read_b128 v[104:107], v17 offset:18432
v_mfma_f32_16x16x32_bf16 v[180:183], v[60:63], v[40:43], v[180:183]
ds_read_b128 v[108:111], v17 offset:19456
v_mfma_f32_16x16x32_bf16 v[188:191], v[60:63], v[44:47], v[188:191]
ds_read_b128 v[192:195], v17 offset:24576
v_mfma_f32_16x16x32_bf16 v[184:187], v[56:59], v[44:47], v[184:187]
ds_read_b64_tr_b16 v[208:209], v9 offset:40960
v_mfma_f32_16x16x32_bf16 v[156:159], v[52:55], v[44:47], v[156:159]
ds_read_b64_tr_b16 v[210:211], v9 offset:45056
v_mfma_f32_16x16x32_bf16 v[152:155], v[48:51], v[44:47], v[152:155]
ds_read_b64_tr_b16 v[212:213], v10 offset:40960
v_mfma_f32_16x16x32_bf16 v[128:131], v[80:83], v[64:67], v[128:131]
ds_read_b64_tr_b16 v[214:215], v10 offset:45056
v_mfma_f32_16x16x32_bf16 v[132:135], v[84:87], v[64:67], v[132:135]
ds_read_b64_tr_b16 v[216:217], v11 offset:40960
v_mfma_f32_16x16x32_bf16 v[160:163], v[88:91], v[64:67], v[160:163]
ds_read_b64_tr_b16 v[218:219], v11 offset:45056
v_mfma_f32_16x16x32_bf16 v[164:167], v[92:95], v[64:67], v[164:167]
ds_read_b64_tr_b16 v[220:221], v12 offset:40960
v_mfma_f32_16x16x32_bf16 v[172:175], v[92:95], v[68:71], v[172:175]
ds_read_b64_tr_b16 v[222:223], v12 offset:45056
v_mfma_f32_16x16x32_bf16 v[168:171], v[88:91], v[68:71], v[168:171]
ds_read_b128 v[196:199], v17 offset:25600
v_mfma_f32_16x16x32_bf16 v[140:143], v[84:87], v[68:71], v[140:143]
ds_read_b128 v[200:203], v17 offset:26624
v_mfma_f32_16x16x32_bf16 v[136:139], v[80:83], v[68:71], v[136:139]
ds_read_b128 v[204:207], v17 offset:27648
v_mfma_f32_16x16x32_bf16 v[144:147], v[80:83], v[72:75], v[144:147]
v_mfma_f32_16x16x32_bf16 v[148:151], v[84:87], v[72:75], v[148:151]
v_mfma_f32_16x16x32_bf16 v[176:179], v[88:91], v[72:75], v[176:179]
v_mfma_f32_16x16x32_bf16 v[180:183], v[92:95], v[72:75], v[180:183]
v_mfma_f32_16x16x32_bf16 v[188:191], v[92:95], v[76:79], v[188:191]
v_mfma_f32_16x16x32_bf16 v[184:187], v[88:91], v[76:79], v[184:187]
v_mfma_f32_16x16x32_bf16 v[156:159], v[84:87], v[76:79], v[156:159]
v_mfma_f32_16x16x32_bf16 v[152:155], v[80:83], v[76:79], v[152:155]
s_waitcnt lgkmcnt(0)
s_barrier
v_mfma_f32_16x16x32_bf16 v[128:131], v[112:115], v[96:99], v[128:131]
ds_read_b128 v[32:35], v17 offset:49152
v_mfma_f32_16x16x32_bf16 v[132:135], v[116:119], v[96:99], v[132:135]
ds_read_b64_tr_b16 v[48:49], v13 offset:0
v_mfma_f32_16x16x32_bf16 v[160:163], v[120:123], v[96:99], v[160:163]
ds_read_b64_tr_b16 v[50:51], v13 offset:4096
v_mfma_f32_16x16x32_bf16 v[164:167], v[124:127], v[96:99], v[164:167]
ds_read_b64_tr_b16 v[52:53], v14 offset:0
v_mfma_f32_16x16x32_bf16 v[172:175], v[124:127], v[100:103], v[172:175]
ds_read_b64_tr_b16 v[54:55], v14 offset:4096
v_mfma_f32_16x16x32_bf16 v[168:171], v[120:123], v[100:103], v[168:171]
ds_read_b64_tr_b16 v[56:57], v15 offset:0
v_mfma_f32_16x16x32_bf16 v[140:143], v[116:119], v[100:103], v[140:143]
ds_read_b64_tr_b16 v[58:59], v15 offset:4096
v_mfma_f32_16x16x32_bf16 v[136:139], v[112:115], v[100:103], v[136:139]
ds_read_b64_tr_b16 v[60:61], v16 offset:0
v_mfma_f32_16x16x32_bf16 v[144:147], v[112:115], v[104:107], v[144:147]
ds_read_b64_tr_b16 v[62:63], v16 offset:4096
v_mfma_f32_16x16x32_bf16 v[148:151], v[116:119], v[104:107], v[148:151]
ds_read_b128 v[36:39], v17 offset:50176
v_mfma_f32_16x16x32_bf16 v[176:179], v[120:123], v[104:107], v[176:179]
ds_read_b128 v[40:43], v17 offset:51200
v_mfma_f32_16x16x32_bf16 v[180:183], v[124:127], v[104:107], v[180:183]
ds_read_b128 v[44:47], v17 offset:52224
v_mfma_f32_16x16x32_bf16 v[188:191], v[124:127], v[108:111], v[188:191]
ds_read_b128 v[64:67], v17 offset:57344
v_mfma_f32_16x16x32_bf16 v[184:187], v[120:123], v[108:111], v[184:187]
ds_read_b64_tr_b16 v[80:81], v13 offset:8192
v_mfma_f32_16x16x32_bf16 v[156:159], v[116:119], v[108:111], v[156:159]
ds_read_b64_tr_b16 v[82:83], v13 offset:12288
v_mfma_f32_16x16x32_bf16 v[152:155], v[112:115], v[108:111], v[152:155]
ds_read_b64_tr_b16 v[84:85], v14 offset:8192
v_mfma_f32_16x16x32_bf16 v[128:131], v[208:211], v[192:195], v[128:131]
ds_read_b64_tr_b16 v[86:87], v14 offset:12288
v_mfma_f32_16x16x32_bf16 v[132:135], v[212:215], v[192:195], v[132:135]
ds_read_b64_tr_b16 v[88:89], v15 offset:8192
v_mfma_f32_16x16x32_bf16 v[160:163], v[216:219], v[192:195], v[160:163]
ds_read_b64_tr_b16 v[90:91], v15 offset:12288
v_mfma_f32_16x16x32_bf16 v[164:167], v[220:223], v[192:195], v[164:167]
ds_read_b64_tr_b16 v[92:93], v16 offset:8192
v_mfma_f32_16x16x32_bf16 v[172:175], v[220:223], v[196:199], v[172:175]
ds_read_b64_tr_b16 v[94:95], v16 offset:12288
v_mfma_f32_16x16x32_bf16 v[168:171], v[216:219], v[196:199], v[168:171]
ds_read_b128 v[68:71], v17 offset:58368
v_mfma_f32_16x16x32_bf16 v[140:143], v[212:215], v[196:199], v[140:143]
ds_read_b128 v[72:75], v17 offset:59392
v_mfma_f32_16x16x32_bf16 v[136:139], v[208:211], v[196:199], v[136:139]
ds_read_b128 v[76:79], v17 offset:60416
v_mfma_f32_16x16x32_bf16 v[144:147], v[208:211], v[200:203], v[144:147]
v_mfma_f32_16x16x32_bf16 v[148:151], v[212:215], v[200:203], v[148:151]
v_mfma_f32_16x16x32_bf16 v[176:179], v[216:219], v[200:203], v[176:179]
v_mfma_f32_16x16x32_bf16 v[180:183], v[220:223], v[200:203], v[180:183]
v_mfma_f32_16x16x32_bf16 v[188:191], v[220:223], v[204:207], v[188:191]
v_mfma_f32_16x16x32_bf16 v[184:187], v[216:219], v[204:207], v[184:187]
v_mfma_f32_16x16x32_bf16 v[156:159], v[212:215], v[204:207], v[156:159]
v_mfma_f32_16x16x32_bf16 v[152:155], v[208:211], v[204:207], v[152:155]
s_waitcnt lgkmcnt(0)
s_barrier
v_mfma_f32_16x16x32_bf16 v[128:131], v[48:51], v[32:35], v[128:131]
ds_read_b128 v[96:99], v18 offset:16384
v_mfma_f32_16x16x32_bf16 v[132:135], v[52:55], v[32:35], v[132:135]
ds_read_b64_tr_b16 v[112:113], v25 offset:16384
v_mfma_f32_16x16x32_bf16 v[160:163], v[56:59], v[32:35], v[160:163]
ds_read_b64_tr_b16 v[114:115], v25 offset:20480
v_mfma_f32_16x16x32_bf16 v[164:167], v[60:63], v[32:35], v[164:167]
ds_read_b64_tr_b16 v[116:117], v26 offset:16384
v_mfma_f32_16x16x32_bf16 v[172:175], v[60:63], v[36:39], v[172:175]
ds_read_b64_tr_b16 v[118:119], v26 offset:20480
v_mfma_f32_16x16x32_bf16 v[168:171], v[56:59], v[36:39], v[168:171]
ds_read_b64_tr_b16 v[120:121], v27 offset:16384
v_mfma_f32_16x16x32_bf16 v[140:143], v[52:55], v[36:39], v[140:143]
ds_read_b64_tr_b16 v[122:123], v27 offset:20480
v_mfma_f32_16x16x32_bf16 v[136:139], v[48:51], v[36:39], v[136:139]
ds_read_b64_tr_b16 v[124:125], v28 offset:16384
v_mfma_f32_16x16x32_bf16 v[144:147], v[48:51], v[40:43], v[144:147]
ds_read_b64_tr_b16 v[126:127], v28 offset:20480
v_mfma_f32_16x16x32_bf16 v[148:151], v[52:55], v[40:43], v[148:151]
ds_read_b128 v[100:103], v18 offset:17408
v_mfma_f32_16x16x32_bf16 v[176:179], v[56:59], v[40:43], v[176:179]
ds_read_b128 v[104:107], v18 offset:18432
v_mfma_f32_16x16x32_bf16 v[180:183], v[60:63], v[40:43], v[180:183]
ds_read_b128 v[108:111], v18 offset:19456
v_mfma_f32_16x16x32_bf16 v[188:191], v[60:63], v[44:47], v[188:191]
ds_read_b128 v[192:195], v18 offset:24576
v_mfma_f32_16x16x32_bf16 v[184:187], v[56:59], v[44:47], v[184:187]
ds_read_b64_tr_b16 v[208:209], v25 offset:24576
v_mfma_f32_16x16x32_bf16 v[156:159], v[52:55], v[44:47], v[156:159]
ds_read_b64_tr_b16 v[210:211], v25 offset:28672
v_mfma_f32_16x16x32_bf16 v[152:155], v[48:51], v[44:47], v[152:155]
ds_read_b64_tr_b16 v[212:213], v26 offset:24576
v_mfma_f32_16x16x32_bf16 v[128:131], v[80:83], v[64:67], v[128:131]
ds_read_b64_tr_b16 v[214:215], v26 offset:28672
v_mfma_f32_16x16x32_bf16 v[132:135], v[84:87], v[64:67], v[132:135]
ds_read_b64_tr_b16 v[216:217], v27 offset:24576
v_mfma_f32_16x16x32_bf16 v[160:163], v[88:91], v[64:67], v[160:163]
ds_read_b64_tr_b16 v[218:219], v27 offset:28672
v_mfma_f32_16x16x32_bf16 v[164:167], v[92:95], v[64:67], v[164:167]
ds_read_b64_tr_b16 v[220:221], v28 offset:24576
v_mfma_f32_16x16x32_bf16 v[172:175], v[92:95], v[68:71], v[172:175]
ds_read_b64_tr_b16 v[222:223], v28 offset:28672
v_mfma_f32_16x16x32_bf16 v[168:171], v[88:91], v[68:71], v[168:171]
ds_read_b128 v[196:199], v18 offset:25600
v_mfma_f32_16x16x32_bf16 v[140:143], v[84:87], v[68:71], v[140:143]
ds_read_b128 v[200:203], v18 offset:26624
v_mfma_f32_16x16x32_bf16 v[136:139], v[80:83], v[68:71], v[136:139]
ds_read_b128 v[204:207], v18 offset:27648
v_mfma_f32_16x16x32_bf16 v[144:147], v[80:83], v[72:75], v[144:147]
v_mfma_f32_16x16x32_bf16 v[148:151], v[84:87], v[72:75], v[148:151]
v_mfma_f32_16x16x32_bf16 v[176:179], v[88:91], v[72:75], v[176:179]
v_mfma_f32_16x16x32_bf16 v[180:183], v[92:95], v[72:75], v[180:183]
v_mfma_f32_16x16x32_bf16 v[188:191], v[92:95], v[76:79], v[188:191]
v_mfma_f32_16x16x32_bf16 v[184:187], v[88:91], v[76:79], v[184:187]
v_mfma_f32_16x16x32_bf16 v[156:159], v[84:87], v[76:79], v[156:159]
v_mfma_f32_16x16x32_bf16 v[152:155], v[80:83], v[76:79], v[152:155]
s_waitcnt lgkmcnt(0)
s_barrier
v_mfma_f32_16x16x32_bf16 v[128:131], v[112:115], v[96:99], v[128:131]
ds_read_b128 v[32:35], v18 offset:32768
v_mfma_f32_16x16x32_bf16 v[132:135], v[116:119], v[96:99], v[132:135]
ds_read_b64_tr_b16 v[48:49], v13 offset:49152
v_mfma_f32_16x16x32_bf16 v[160:163], v[120:123], v[96:99], v[160:163]
ds_read_b64_tr_b16 v[50:51], v13 offset:53248
v_mfma_f32_16x16x32_bf16 v[164:167], v[124:127], v[96:99], v[164:167]
ds_read_b64_tr_b16 v[52:53], v14 offset:49152
v_mfma_f32_16x16x32_bf16 v[172:175], v[124:127], v[100:103], v[172:175]
ds_read_b64_tr_b16 v[54:55], v14 offset:53248
v_mfma_f32_16x16x32_bf16 v[168:171], v[120:123], v[100:103], v[168:171]
ds_read_b64_tr_b16 v[56:57], v15 offset:49152
v_mfma_f32_16x16x32_bf16 v[140:143], v[116:119], v[100:103], v[140:143]
ds_read_b64_tr_b16 v[58:59], v15 offset:53248
v_mfma_f32_16x16x32_bf16 v[136:139], v[112:115], v[100:103], v[136:139]
ds_read_b64_tr_b16 v[60:61], v16 offset:49152
v_mfma_f32_16x16x32_bf16 v[144:147], v[112:115], v[104:107], v[144:147]
ds_read_b64_tr_b16 v[62:63], v16 offset:53248
v_mfma_f32_16x16x32_bf16 v[148:151], v[116:119], v[104:107], v[148:151]
ds_read_b128 v[36:39], v18 offset:33792
v_mfma_f32_16x16x32_bf16 v[176:179], v[120:123], v[104:107], v[176:179]
ds_read_b128 v[40:43], v18 offset:34816
v_mfma_f32_16x16x32_bf16 v[180:183], v[124:127], v[104:107], v[180:183]
ds_read_b128 v[44:47], v18 offset:35840
v_mfma_f32_16x16x32_bf16 v[188:191], v[124:127], v[108:111], v[188:191]
ds_read_b128 v[64:67], v18 offset:40960
v_mfma_f32_16x16x32_bf16 v[184:187], v[120:123], v[108:111], v[184:187]
ds_read_b64_tr_b16 v[80:81], v13 offset:57344
v_mfma_f32_16x16x32_bf16 v[156:159], v[116:119], v[108:111], v[156:159]
ds_read_b64_tr_b16 v[82:83], v13 offset:61440
v_mfma_f32_16x16x32_bf16 v[152:155], v[112:115], v[108:111], v[152:155]
ds_read_b64_tr_b16 v[84:85], v14 offset:57344
v_mfma_f32_16x16x32_bf16 v[128:131], v[208:211], v[192:195], v[128:131]
ds_read_b64_tr_b16 v[86:87], v14 offset:61440
v_mfma_f32_16x16x32_bf16 v[132:135], v[212:215], v[192:195], v[132:135]
ds_read_b64_tr_b16 v[88:89], v15 offset:57344
v_mfma_f32_16x16x32_bf16 v[160:163], v[216:219], v[192:195], v[160:163]
ds_read_b64_tr_b16 v[90:91], v15 offset:61440
v_mfma_f32_16x16x32_bf16 v[164:167], v[220:223], v[192:195], v[164:167]
ds_read_b64_tr_b16 v[92:93], v16 offset:57344
v_mfma_f32_16x16x32_bf16 v[172:175], v[220:223], v[196:199], v[172:175]
ds_read_b64_tr_b16 v[94:95], v16 offset:61440
v_mfma_f32_16x16x32_bf16 v[168:171], v[216:219], v[196:199], v[168:171]
ds_read_b128 v[68:71], v18 offset:41984
v_mfma_f32_16x16x32_bf16 v[140:143], v[212:215], v[196:199], v[140:143]
ds_read_b128 v[72:75], v18 offset:43008
v_mfma_f32_16x16x32_bf16 v[136:139], v[208:211], v[196:199], v[136:139]
ds_read_b128 v[76:79], v18 offset:44032
v_mfma_f32_16x16x32_bf16 v[144:147], v[208:211], v[200:203], v[144:147]
v_mfma_f32_16x16x32_bf16 v[148:151], v[212:215], v[200:203], v[148:151]
v_mfma_f32_16x16x32_bf16 v[176:179], v[216:219], v[200:203], v[176:179]
v_mfma_f32_16x16x32_bf16 v[180:183], v[220:223], v[200:203], v[180:183]
v_mfma_f32_16x16x32_bf16 v[188:191], v[220:223], v[204:207], v[188:191]
v_mfma_f32_16x16x32_bf16 v[184:187], v[216:219], v[204:207], v[184:187]
v_mfma_f32_16x16x32_bf16 v[156:159], v[212:215], v[204:207], v[156:159]
v_mfma_f32_16x16x32_bf16 v[152:155], v[208:211], v[204:207], v[152:155]
s_waitcnt lgkmcnt(0)
s_barrier
v_mfma_f32_16x16x32_bf16 v[128:131], v[48:51], v[32:35], v[128:131]
ds_read_b128 v[96:99], v19 offset:0
v_mfma_f32_16x16x32_bf16 v[132:135], v[52:55], v[32:35], v[132:135]
ds_read_b64_tr_b16 v[112:113], v9 offset:0
v_mfma_f32_16x16x32_bf16 v[160:163], v[56:59], v[32:35], v[160:163]
ds_read_b64_tr_b16 v[114:115], v9 offset:4096
v_mfma_f32_16x16x32_bf16 v[164:167], v[60:63], v[32:35], v[164:167]
ds_read_b64_tr_b16 v[116:117], v10 offset:0
v_mfma_f32_16x16x32_bf16 v[172:175], v[60:63], v[36:39], v[172:175]
ds_read_b64_tr_b16 v[118:119], v10 offset:4096
v_mfma_f32_16x16x32_bf16 v[168:171], v[56:59], v[36:39], v[168:171]
ds_read_b64_tr_b16 v[120:121], v11 offset:0
v_mfma_f32_16x16x32_bf16 v[140:143], v[52:55], v[36:39], v[140:143]
ds_read_b64_tr_b16 v[122:123], v11 offset:4096
v_mfma_f32_16x16x32_bf16 v[136:139], v[48:51], v[36:39], v[136:139]
ds_read_b64_tr_b16 v[124:125], v12 offset:0
v_mfma_f32_16x16x32_bf16 v[144:147], v[48:51], v[40:43], v[144:147]
ds_read_b64_tr_b16 v[126:127], v12 offset:4096
v_mfma_f32_16x16x32_bf16 v[148:151], v[52:55], v[40:43], v[148:151]
ds_read_b128 v[100:103], v19 offset:1024
v_mfma_f32_16x16x32_bf16 v[176:179], v[56:59], v[40:43], v[176:179]
ds_read_b128 v[104:107], v19 offset:2048
v_mfma_f32_16x16x32_bf16 v[180:183], v[60:63], v[40:43], v[180:183]
ds_read_b128 v[108:111], v19 offset:3072
v_mfma_f32_16x16x32_bf16 v[188:191], v[60:63], v[44:47], v[188:191]
ds_read_b128 v[192:195], v19 offset:8192
v_mfma_f32_16x16x32_bf16 v[184:187], v[56:59], v[44:47], v[184:187]
ds_read_b64_tr_b16 v[208:209], v9 offset:8192
v_mfma_f32_16x16x32_bf16 v[156:159], v[52:55], v[44:47], v[156:159]
ds_read_b64_tr_b16 v[210:211], v9 offset:12288
v_mfma_f32_16x16x32_bf16 v[152:155], v[48:51], v[44:47], v[152:155]
ds_read_b64_tr_b16 v[212:213], v10 offset:8192
v_mfma_f32_16x16x32_bf16 v[128:131], v[80:83], v[64:67], v[128:131]
ds_read_b64_tr_b16 v[214:215], v10 offset:12288
v_mfma_f32_16x16x32_bf16 v[132:135], v[84:87], v[64:67], v[132:135]
ds_read_b64_tr_b16 v[216:217], v11 offset:8192
v_mfma_f32_16x16x32_bf16 v[160:163], v[88:91], v[64:67], v[160:163]
ds_read_b64_tr_b16 v[218:219], v11 offset:12288
v_mfma_f32_16x16x32_bf16 v[164:167], v[92:95], v[64:67], v[164:167]
ds_read_b64_tr_b16 v[220:221], v12 offset:8192
v_mfma_f32_16x16x32_bf16 v[172:175], v[92:95], v[68:71], v[172:175]
ds_read_b64_tr_b16 v[222:223], v12 offset:12288
v_mfma_f32_16x16x32_bf16 v[168:171], v[88:91], v[68:71], v[168:171]
ds_read_b128 v[196:199], v19 offset:9216
v_mfma_f32_16x16x32_bf16 v[140:143], v[84:87], v[68:71], v[140:143]
ds_read_b128 v[200:203], v19 offset:10240
v_mfma_f32_16x16x32_bf16 v[136:139], v[80:83], v[68:71], v[136:139]
ds_read_b128 v[204:207], v19 offset:11264
v_mfma_f32_16x16x32_bf16 v[144:147], v[80:83], v[72:75], v[144:147]
v_mfma_f32_16x16x32_bf16 v[148:151], v[84:87], v[72:75], v[148:151]
v_mfma_f32_16x16x32_bf16 v[176:179], v[88:91], v[72:75], v[176:179]
v_mfma_f32_16x16x32_bf16 v[180:183], v[92:95], v[72:75], v[180:183]
v_mfma_f32_16x16x32_bf16 v[188:191], v[92:95], v[76:79], v[188:191]
v_mfma_f32_16x16x32_bf16 v[184:187], v[88:91], v[76:79], v[184:187]
v_mfma_f32_16x16x32_bf16 v[156:159], v[84:87], v[76:79], v[156:159]
v_mfma_f32_16x16x32_bf16 v[152:155], v[80:83], v[76:79], v[152:155]
s_sub_u32 s41, s41, 1
s_cmp_lg_u32 s41, 0
s_cbranch_scc1 Lk4_121
s_waitcnt lgkmcnt(0)
s_barrier
v_mfma_f32_16x16x32_bf16 v[128:131], v[112:115], v[96:99], v[128:131]
ds_read_b128 v[32:35], v17 offset:16384
v_mfma_f32_16x16x32_bf16 v[132:135], v[116:119], v[96:99], v[132:135]
ds_read_b64_tr_b16 v[48:49], v224 offset:32768
v_mfma_f32_16x16x32_bf16 v[160:163], v[120:123], v[96:99], v[160:163]
ds_read_b64_tr_b16 v[50:51], v224 offset:34816
v_mfma_f32_16x16x32_bf16 v[164:167], v[124:127], v[96:99], v[164:167]
ds_read_b64_tr_b16 v[52:53], v225 offset:32768
v_mfma_f32_16x16x32_bf16 v[172:175], v[124:127], v[100:103], v[172:175]
ds_read_b64_tr_b16 v[54:55], v225 offset:34816
v_mfma_f32_16x16x32_bf16 v[168:171], v[120:123], v[100:103], v[168:171]
ds_read_b128 v[36:39], v17 offset:17408
v_mfma_f32_16x16x32_bf16 v[140:143], v[116:119], v[100:103], v[140:143]
ds_read_b128 v[40:43], v17 offset:18432
v_mfma_f32_16x16x32_bf16 v[136:139], v[112:115], v[100:103], v[136:139]
ds_read_b128 v[44:47], v17 offset:19456
v_mfma_f32_16x16x32_bf16 v[144:147], v[112:115], v[104:107], v[144:147]
ds_read_b128 v[64:67], v17 offset:24576
v_mfma_f32_16x16x32_bf16 v[148:151], v[116:119], v[104:107], v[148:151]
ds_read_b64_tr_b16 v[80:81], v224 offset:36864
v_mfma_f32_16x16x32_bf16 v[176:179], v[120:123], v[104:107], v[176:179]
ds_read_b64_tr_b16 v[82:83], v224 offset:38912
v_mfma_f32_16x16x32_bf16 v[180:183], v[124:127], v[104:107], v[180:183]
ds_read_b64_tr_b16 v[84:85], v225 offset:36864
v_mfma_f32_16x16x32_bf16 v[188:191], v[124:127], v[108:111], v[188:191]
ds_read_b64_tr_b16 v[86:87], v225 offset:38912
v_mfma_f32_16x16x32_bf16 v[184:187], v[120:123], v[108:111], v[184:187]
s_branch Lov_12
.p2align 12
.fill 96, 4, 0xbf800000
Lst_12_0:
s_branch Lwr_153
Lst_12_1:
s_branch Lst_16_1
s_nop 0
Lov_12:
ds_read_b128 v[68:71], v17 offset:25600
v_mfma_f32_16x16x32_bf16 v[156:159], v[116:119], v[108:111], v[156:159]
ds_read_b128 v[72:75], v17 offset:26624
v_mfma_f32_16x16x32_bf16 v[152:155], v[112:115], v[108:111], v[152:155]
ds_read_b128 v[76:79], v17 offset:27648
v_mfma_f32_16x16x32_bf16 v[128:131], v[208:211], v[192:195], v[128:131]
v_mfma_f32_16x16x32_bf16 v[132:135], v[212:215], v[192:195], v[132:135]
v_mfma_f32_16x16x32_bf16 v[160:163], v[216:219], v[192:195], v[160:163]
v_mfma_f32_16x16x32_bf16 v[164:167], v[220:223], v[192:195], v[164:167]
v_mfma_f32_16x16x32_bf16 v[172:175], v[220:223], v[196:199], v[172:175]
v_mfma_f32_16x16x32_bf16 v[168:171], v[216:219], v[196:199], v[168:171]
v_mfma_f32_16x16x32_bf16 v[140:143], v[212:215], v[196:199], v[140:143]
v_mfma_f32_16x16x32_bf16 v[136:139], v[208:211], v[196:199], v[136:139]
v_mfma_f32_16x16x32_bf16 v[144:147], v[208:211], v[200:203], v[144:147]
v_mfma_f32_16x16x32_bf16 v[148:151], v[212:215], v[200:203], v[148:151]
v_mfma_f32_16x16x32_bf16 v[176:179], v[216:219], v[200:203], v[176:179]
v_mfma_f32_16x16x32_bf16 v[180:183], v[220:223], v[200:203], v[180:183]
v_mfma_f32_16x16x32_bf16 v[188:191], v[220:223], v[204:207], v[188:191]
v_mfma_f32_16x16x32_bf16 v[184:187], v[216:219], v[204:207], v[184:187]
v_mfma_f32_16x16x32_bf16 v[156:159], v[212:215], v[204:207], v[156:159]
v_mfma_f32_16x16x32_bf16 v[152:155], v[208:211], v[204:207], v[152:155]
s_waitcnt lgkmcnt(0)
s_barrier
v_mfma_f32_16x16x32_bf16 v[128:131], v[48:51], v[32:35], v[128:131]
ds_read_b128 v[96:99], v17 offset:49152
ds_read_b64_tr_b16 v[112:113], v226 offset:0
v_mfma_f32_16x16x32_bf16 v[132:135], v[52:55], v[32:35], v[132:135]
ds_read_b64_tr_b16 v[114:115], v226 offset:2048
ds_read_b64_tr_b16 v[116:117], v227 offset:0
v_mfma_f32_16x16x32_bf16 v[140:143], v[52:55], v[36:39], v[140:143]
ds_read_b64_tr_b16 v[118:119], v227 offset:2048
ds_read_b128 v[100:103], v17 offset:50176
v_mfma_f32_16x16x32_bf16 v[136:139], v[48:51], v[36:39], v[136:139]
ds_read_b128 v[104:107], v17 offset:51200
ds_read_b128 v[108:111], v17 offset:52224
v_mfma_f32_16x16x32_bf16 v[144:147], v[48:51], v[40:43], v[144:147]
ds_read_b128 v[192:195], v17 offset:57344
v_mfma_f32_16x16x32_bf16 v[148:151], v[52:55], v[40:43], v[148:151]
ds_read_b64_tr_b16 v[208:209], v226 offset:4096
v_mfma_f32_16x16x32_bf16 v[156:159], v[52:55], v[44:47], v[156:159]
ds_read_b64_tr_b16 v[210:211], v226 offset:6144
v_cvt_pk_bf16_f32 v160, v160, v161
v_cvt_pk_bf16_f32 v161, v162, v163
v_mfma_f32_16x16x32_bf16 v[152:155], v[48:51], v[44:47], v[152:155]
ds_read_b64_tr_b16 v[212:213], v227 offset:4096
v_cvt_pk_bf16_f32 v162, v164, v165
v_cvt_pk_bf16_f32 v163, v166, v167
v_mfma_f32_16x16x32_bf16 v[128:131], v[80:83], v[64:67], v[128:131]
ds_read_b64_tr_b16 v[214:215], v227 offset:6144
v_cvt_pk_bf16_f32 v164, v168, v169
v_cvt_pk_bf16_f32 v165, v170, v171
v_mfma_f32_16x16x32_bf16 v[132:135], v[84:87], v[64:67], v[132:135]
ds_read_b128 v[196:199], v17 offset:58368
v_cvt_pk_bf16_f32 v166, v172, v173
v_cvt_pk_bf16_f32 v167, v174, v175
v_mfma_f32_16x16x32_bf16 v[140:143], v[84:87], v[68:71], v[140:143]
ds_read_b128 v[200:203], v17 offset:59392
v_cvt_pk_bf16_f32 v168, v176, v177
v_cvt_pk_bf16_f32 v169, v178, v179
v_mfma_f32_16x16x32_bf16 v[136:139], v[80:83], v[68:71], v[136:139]
ds_read_b128 v[204:207], v17 offset:60416
v_cvt_pk_bf16_f32 v170, v180, v181
v_cvt_pk_bf16_f32 v171, v182, v183
v_mfma_f32_16x16x32_bf16 v[144:147], v[80:83], v[72:75], v[144:147]
v_cvt_pk_bf16_f32 v172, v184, v185
v_cvt_pk_bf16_f32 v173, v186, v187
v_mfma_f32_16x16x32_bf16 v[148:151], v[84:87], v[72:75], v[148:151]
v_cvt_pk_bf16_f32 v174, v188, v189
v_cvt_pk_bf16_f32 v175, v190, v191
v_mfma_f32_16x16x32_bf16 v[156:159], v[84:87], v[76:79], v[156:159]
v_mfma_f32_16x16x32_bf16 v[152:155], v[80:83], v[76:79], v[152:155]
buffer_store_dwordx4 v[160:163], v2, s[84:87], s45 offen offset:0 sc1
s_waitcnt lgkmcnt(0)
s_barrier
v_mfma_f32_16x16x32_bf16 v[128:131], v[112:115], v[96:99], v[128:131]
ds_read_b128 v[32:35], v18 offset:16384
ds_read_b64_tr_b16 v[48:49], v228 offset:16384
v_mfma_f32_16x16x32_bf16 v[132:135], v[116:119], v[96:99], v[132:135]
ds_read_b64_tr_b16 v[50:51], v228 offset:18432
ds_read_b64_tr_b16 v[52:53], v229 offset:16384
v_mfma_f32_16x16x32_bf16 v[140:143], v[116:119], v[100:103], v[140:143]
ds_read_b64_tr_b16 v[54:55], v229 offset:18432
ds_read_b128 v[36:39], v18 offset:17408
v_mfma_f32_16x16x32_bf16 v[136:139], v[112:115], v[100:103], v[136:139]
ds_read_b128 v[40:43], v18 offset:18432
ds_read_b128 v[44:47], v18 offset:19456
v_mfma_f32_16x16x32_bf16 v[144:147], v[112:115], v[104:107], v[144:147]
ds_read_b128 v[64:67], v18 offset:24576
v_mfma_f32_16x16x32_bf16 v[148:151], v[116:119], v[104:107], v[148:151]
ds_read_b64_tr_b16 v[80:81], v228 offset:20480
v_mfma_f32_16x16x32_bf16 v[156:159], v[116:119], v[108:111], v[156:159]
ds_read_b64_tr_b16 v[82:83], v228 offset:22528
v_mfma_f32_16x16x32_bf16 v[152:155], v[112:115], v[108:111], v[152:155]
ds_read_b64_tr_b16 v[84:85], v229 offset:20480
v_mfma_f32_16x16x32_bf16 v[128:131], v[208:211], v[192:195], v[128:131]
ds_read_b64_tr_b16 v[86:87], v229 offset:22528
buffer_store_dwordx4 v[164:167], v2, s[84:87], s45 offen offset:1024 sc1
v_mfma_f32_16x16x32_bf16 v[132:135], v[212:215], v[192:195], v[132:135]
ds_read_b128 v[68:71], v18 offset:25600
v_mfma_f32_16x16x32_bf16 v[140:143], v[212:215], v[196:199], v[140:143]
ds_read_b128 v[72:75], v18 offset:26624
v_mfma_f32_16x16x32_bf16 v[136:139], v[208:211], v[196:199], v[136:139]
ds_read_b128 v[76:79], v18 offset:27648
v_mfma_f32_16x16x32_bf16 v[144:147], v[208:211], v[200:203], v[144:147]
v_mfma_f32_16x16x32_bf16 v[148:151], v[212:215], v[200:203], v[148:151]
v_mfma_f32_16x16x32_bf16 v[156:159], v[212:215], v[204:207], v[156:159]
v_mfma_f32_16x16x32_bf16 v[152:155], v[208:211], v[204:207], v[152:155]
s_waitcnt lgkmcnt(0)
s_barrier
v_mfma_f32_16x16x32_bf16 v[128:131], v[48:51], v[32:35], v[128:131]
ds_read_b128 v[96:99], v18 offset:32768
ds_read_b64_tr_b16 v[112:113], v226 offset:49152
v_mfma_f32_16x16x32_bf16 v[132:135], v[52:55], v[32:35], v[132:135]
ds_read_b64_tr_b16 v[114:115], v226 offset:51200
ds_read_b64_tr_b16 v[116:117], v227 offset:49152
v_mfma_f32_16x16x32_bf16 v[140:143], v[52:55], v[36:39], v[140:143]
ds_read_b64_tr_b16 v[118:119], v227 offset:51200
ds_read_b128 v[100:103], v18 offset:33792
v_mfma_f32_16x16x32_bf16 v[136:139], v[48:51], v[36:39], v[136:139]
ds_read_b128 v[104:107], v18 offset:34816
ds_read_b128 v[108:111], v18 offset:35840
v_mfma_f32_16x16x32_bf16 v[144:147], v[48:51], v[40:43], v[144:147]
ds_read_b128 v[192:195], v18 offset:40960
v_mfma_f32_16x16x32_bf16 v[148:151], v[52:55], v[40:43], v[148:151]
ds_read_b64_tr_b16 v[208:209], v226 offset:53248
v_mfma_f32_16x16x32_bf16 v[156:159], v[52:55], v[44:47], v[156:159]
ds_read_b64_tr_b16 v[210:211], v226 offset:55296
v_mfma_f32_16x16x32_bf16 v[152:155], v[48:51], v[44:47], v[152:155]
ds_read_b64_tr_b16 v[212:213], v227 offset:53248
v_mfma_f32_16x16x32_bf16 v[128:131], v[80:83], v[64:67], v[128:131]
ds_read_b64_tr_b16 v[214:215], v227 offset:55296
buffer_store_dwordx4 v[168:171], v2, s[84:87], s45 offen offset:2048 sc1
v_mfma_f32_16x16x32_bf16 v[132:135], v[84:87], v[64:67], v[132:135]
ds_read_b128 v[196:199], v18 offset:41984
v_mfma_f32_16x16x32_bf16 v[140:143], v[84:87], v[68:71], v[140:143]
ds_read_b128 v[200:203], v18 offset:43008
v_mfma_f32_16x16x32_bf16 v[136:139], v[80:83], v[68:71], v[136:139]
ds_read_b128 v[204:207], v18 offset:44032
v_mfma_f32_16x16x32_bf16 v[144:147], v[80:83], v[72:75], v[144:147]
v_mfma_f32_16x16x32_bf16 v[148:151], v[84:87], v[72:75], v[148:151]
v_mfma_f32_16x16x32_bf16 v[156:159], v[84:87], v[76:79], v[156:159]
v_mfma_f32_16x16x32_bf16 v[152:155], v[80:83], v[76:79], v[152:155]
s_waitcnt lgkmcnt(0)
s_barrier
v_mfma_f32_16x16x32_bf16 v[128:131], v[112:115], v[96:99], v[128:131]
ds_read_b128 v[32:35], v19 offset:0
ds_read_b64_tr_b16 v[48:49], v224 offset:0
v_mfma_f32_16x16x32_bf16 v[132:135], v[116:119], v[96:99], v[132:135]
ds_read_b64_tr_b16 v[50:51], v224 offset:2048
ds_read_b64_tr_b16 v[52:53], v225 offset:0
v_mfma_f32_16x16x32_bf16 v[140:143], v[116:119], v[100:103], v[140:143]
ds_read_b64_tr_b16 v[54:55], v225 offset:2048
ds_read_b128 v[36:39], v19 offset:1024
v_mfma_f32_16x16x32_bf16 v[136:139], v[112:115], v[100:103], v[136:139]
ds_read_b128 v[40:43], v19 offset:2048
ds_read_b128 v[44:47], v19 offset:3072
v_mfma_f32_16x16x32_bf16 v[144:147], v[112:115], v[104:107], v[144:147]
ds_read_b128 v[64:67], v19 offset:8192
v_mfma_f32_16x16x32_bf16 v[148:151], v[116:119], v[104:107], v[148:151]
ds_read_b64_tr_b16 v[80:81], v224 offset:4096
v_mfma_f32_16x16x32_bf16 v[156:159], v[116:119], v[108:111], v[156:159]
ds_read_b64_tr_b16 v[82:83], v224 offset:6144
v_mfma_f32_16x16x32_bf16 v[152:155], v[112:115], v[108:111], v[152:155]
ds_read_b64_tr_b16 v[84:85], v225 offset:4096
v_mfma_f32_16x16x32_bf16 v[128:131], v[208:211], v[192:195], v[128:131]
ds_read_b64_tr_b16 v[86:87], v225 offset:6144
buffer_store_dwordx4 v[172:175], v2, s[84:87], s45 offen offset:3072 sc1
v_mfma_f32_16x16x32_bf16 v[132:135], v[212:215], v[192:195], v[132:135]
ds_read_b128 v[68:71], v19 offset:9216
v_mfma_f32_16x16x32_bf16 v[140:143], v[212:215], v[196:199], v[140:143]
ds_read_b128 v[72:75], v19 offset:10240
v_mfma_f32_16x16x32_bf16 v[136:139], v[208:211], v[196:199], v[136:139]
ds_read_b128 v[76:79], v19 offset:11264
v_mfma_f32_16x16x32_bf16 v[144:147], v[208:211], v[200:203], v[144:147]
v_mfma_f32_16x16x32_bf16 v[148:151], v[212:215], v[200:203], v[148:151]
v_mfma_f32_16x16x32_bf16 v[156:159], v[212:215], v[204:207], v[156:159]
v_mfma_f32_16x16x32_bf16 v[152:155], v[208:211], v[204:207], v[152:155]
s_waitcnt lgkmcnt(0)
s_barrier
v_mfma_f32_16x16x32_bf16 v[128:131], v[48:51], v[32:35], v[128:131]
ds_read_b128 v[96:99], v17 offset:16384
ds_read_b64_tr_b16 v[112:113], v224 offset:32768
v_mfma_f32_16x16x32_bf16 v[132:135], v[52:55], v[32:35], v[132:135]
ds_read_b64_tr_b16 v[114:115], v224 offset:34816
ds_read_b64_tr_b16 v[116:117], v225 offset:32768
v_mfma_f32_16x16x32_bf16 v[140:143], v[52:55], v[36:39], v[140:143]
ds_read_b64_tr_b16 v[118:119], v225 offset:34816
ds_read_b128 v[100:103], v17 offset:17408
v_mfma_f32_16x16x32_bf16 v[136:139], v[48:51], v[36:39], v[136:139]
ds_read_b128 v[104:107], v17 offset:18432
ds_read_b128 v[108:111], v17 offset:19456
v_mfma_f32_16x16x32_bf16 v[144:147], v[48:51], v[40:43], v[144:147]
ds_read_b128 v[192:195], v17 offset:24576
v_mfma_f32_16x16x32_bf16 v[148:151], v[52:55], v[40:43], v[148:151]
ds_read_b64_tr_b16 v[208:209], v224 offset:36864
v_mfma_f32_16x16x32_bf16 v[156:159], v[52:55], v[44:47], v[156:159]
ds_read_b64_tr_b16 v[210:211], v224 offset:38912
v_mfma_f32_16x16x32_bf16 v[152:155], v[48:51], v[44:47], v[152:155]
ds_read_b64_tr_b16 v[212:213], v225 offset:36864
v_mfma_f32_16x16x32_bf16 v[128:131], v[80:83], v[64:67], v[128:131]
ds_read_b64_tr_b16 v[214:215], v225 offset:38912
v_mfma_f32_16x16x32_bf16 v[132:135], v[84:87], v[64:67], v[132:135]
ds_read_b128 v[196:199], v17 offset:25600
v_mfma_f32_16x16x32_bf16 v[140:143], v[84:87], v[68:71], v[140:143]
ds_read_b128 v[200:203], v17 offset:26624
v_mfma_f32_16x16x32_bf16 v[136:139], v[80:83], v[68:71], v[136:139]
ds_read_b128 v[204:207], v17 offset:27648
v_mfma_f32_16x16x32_bf16 v[144:147], v[80:83], v[72:75], v[144:147]
v_mfma_f32_16x16x32_bf16 v[148:151], v[84:87], v[72:75], v[148:151]
v_mfma_f32_16x16x32_bf16 v[156:159], v[84:87], v[76:79], v[156:159]
v_mfma_f32_16x16x32_bf16 v[152:155], v[80:83], v[76:79], v[152:155]
s_waitcnt vmcnt(0)
s_waitcnt lgkmcnt(0)
s_barrier
v_mfma_f32_16x16x32_bf16 v[128:131], v[112:115], v[96:99], v[128:131]
ds_read_b128 v[32:35], v17 offset:49152
ds_read_b64_tr_b16 v[48:49], v226 offset:0
v_mfma_f32_16x16x32_bf16 v[132:135], v[116:119], v[96:99], v[132:135]
ds_read_b64_tr_b16 v[50:51], v226 offset:2048
ds_read_b64_tr_b16 v[52:53], v227 offset:0
v_mfma_f32_16x16x32_bf16 v[140:143], v[116:119], v[100:103], v[140:143]
ds_read_b64_tr_b16 v[54:55], v227 offset:2048
ds_read_b128 v[36:39], v17 offset:50176
v_mfma_f32_16x16x32_bf16 v[136:139], v[112:115], v[100:103], v[136:139]
ds_read_b128 v[40:43], v17 offset:51200
ds_read_b128 v[44:47], v17 offset:52224
v_mfma_f32_16x16x32_bf16 v[144:147], v[112:115], v[104:107], v[144:147]
ds_read_b128 v[64:67], v17 offset:57344
v_mfma_f32_16x16x32_bf16 v[148:151], v[116:119], v[104:107], v[148:151]
ds_read_b64_tr_b16 v[80:81], v226 offset:4096
v_mfma_f32_16x16x32_bf16 v[156:159], v[116:119], v[108:111], v[156:159]
ds_read_b64_tr_b16 v[82:83], v226 offset:6144
v_mfma_f32_16x16x32_bf16 v[152:155], v[112:115], v[108:111], v[152:155]
ds_read_b64_tr_b16 v[84:85], v227 offset:4096
v_mfma_f32_16x16x32_bf16 v[128:131], v[208:211], v[192:195], v[128:131]
ds_read_b64_tr_b16 v[86:87], v227 offset:6144
v_mfma_f32_16x16x32_bf16 v[132:135], v[212:215], v[192:195], v[132:135]
ds_read_b128 v[68:71], v17 offset:58368
v_mfma_f32_16x16x32_bf16 v[140:143], v[212:215], v[196:199], v[140:143]
ds_read_b128 v[72:75], v17 offset:59392
v_mfma_f32_16x16x32_bf16 v[136:139], v[208:211], v[196:199], v[136:139]
ds_read_b128 v[76:79], v17 offset:60416
v_mfma_f32_16x16x32_bf16 v[144:147], v[208:211], v[200:203], v[144:147]
v_mfma_f32_16x16x32_bf16 v[148:151], v[212:215], v[200:203], v[148:151]
v_mfma_f32_16x16x32_bf16 v[156:159], v[212:215], v[204:207], v[156:159]
v_mfma_f32_16x16x32_bf16 v[152:155], v[208:211], v[204:207], v[152:155]
s_waitcnt lgkmcnt(0)
s_barrier
v_mfma_f32_16x16x32_bf16 v[128:131], v[48:51], v[32:35], v[128:131]
ds_read_b128 v[96:99], v18 offset:16384
ds_read_b64_tr_b16 v[112:113], v228 offset:16384
v_mfma_f32_16x16x32_bf16 v[132:135], v[52:55], v[32:35], v[132:135]
ds_read_b64_tr_b16 v[114:115], v228 offset:18432
ds_read_b64_tr_b16 v[116:117], v229 offset:16384
v_mfma_f32_16x16x32_bf16 v[140:143], v[52:55], v[36:39], v[140:143]
ds_read_b64_tr_b16 v[118:119], v229 offset:18432
ds_read_b128 v[100:103], v18 offset:17408
v_mfma_f32_16x16x32_bf16 v[136:139], v[48:51], v[36:39], v[136:139]
ds_read_b128 v[104:107], v18 offset:18432
ds_read_b128 v[108:111], v18 offset:19456
v_mfma_f32_16x16x32_bf16 v[144:147], v[48:51], v[40:43], v[144:147]
ds_read_b128 v[192:195], v18 offset:24576
v_mfma_f32_16x16x32_bf16 v[148:151], v[52:55], v[40:43], v[148:151]
ds_read_b64_tr_b16 v[208:209], v228 offset:20480
v_mfma_f32_16x16x32_bf16 v[156:159], v[52:55], v[44:47], v[156:159]
ds_read_b64_tr_b16 v[210:211], v228 offset:22528
v_mfma_f32_16x16x32_bf16 v[152:155], v[48:51], v[44:47], v[152:155]
ds_read_b64_tr_b16 v[212:213], v229 offset:20480
v_mfma_f32_16x16x32_bf16 v[128:131], v[80:83], v[64:67], v[128:131]
ds_read_b64_tr_b16 v[214:215], v229 offset:22528
v_mfma_f32_16x16x32_bf16 v[132:135], v[84:87], v[64:67], v[132:135]
ds_read_b128 v[196:199], v18 offset:25600
v_mfma_f32_16x16x32_bf16 v[140:143], v[84:87], v[68:71], v[140:143]
ds_read_b128 v[200:203], v18 offset:26624
v_mfma_f32_16x16x32_bf16 v[136:139], v[80:83], v[68:71], v[136:139]
ds_read_b128 v[204:207], v18 offset:27648
v_mfma_f32_16x16x32_bf16 v[144:147], v[80:83], v[72:75], v[144:147]
v_mfma_f32_16x16x32_bf16 v[148:151], v[84:87], v[72:75], v[148:151]
v_mfma_f32_16x16x32_bf16 v[156:159], v[84:87], v[76:79], v[156:159]
v_mfma_f32_16x16x32_bf16 v[152:155], v[80:83], v[76:79], v[152:155]
s_waitcnt lgkmcnt(0)
s_barrier
v_mfma_f32_16x16x32_bf16 v[128:131], v[112:115], v[96:99], v[128:131]
ds_read_b128 v[32:35], v18 offset:32768
ds_read_b64_tr_b16 v[48:49], v226 offset:49152
v_mfma_f32_16x16x32_bf16 v[132:135], v[116:119], v[96:99], v[132:135]
ds_read_b64_tr_b16 v[50:51], v226 offset:51200
ds_read_b64_tr_b16 v[52:53], v227 offset:49152
v_mfma_f32_16x16x32_bf16 v[140:143], v[116:119], v[100:103], v[140:143]
ds_read_b64_tr_b16 v[54:55], v227 offset:51200
ds_read_b128 v[36:39], v18 offset:33792
v_mfma_f32_16x16x32_bf16 v[136:139], v[112:115], v[100:103], v[136:139]
ds_read_b128 v[40:43], v18 offset:34816
ds_read_b128 v[44:47], v18 offset:35840
v_mfma_f32_16x16x32_bf16 v[144:147], v[112:115], v[104:107], v[144:147]
ds_read_b128 v[64:67], v18 offset:40960
v_mfma_f32_16x16x32_bf16 v[148:151], v[116:119], v[104:107], v[148:151]
ds_read_b64_tr_b16 v[80:81], v226 offset:53248
v_mfma_f32_16x16x32_bf16 v[156:159], v[116:119], v[108:111], v[156:159]
ds_read_b64_tr_b16 v[82:83], v226 offset:55296
v_mfma_f32_16x16x32_bf16 v[152:155], v[112:115], v[108:111], v[152:155]
ds_read_b64_tr_b16 v[84:85], v227 offset:53248
v_mfma_f32_16x16x32_bf16 v[128:131], v[208:211], v[192:195], v[128:131]
ds_read_b64_tr_b16 v[86:87], v227 offset:55296
v_mfma_f32_16x16x32_bf16 v[132:135], v[212:215], v[192:195], v[132:135]
ds_read_b128 v[68:71], v18 offset:41984
v_mfma_f32_16x16x32_bf16 v[140:143], v[212:215], v[196:199], v[140:143]
ds_read_b128 v[72:75], v18 offset:43008
v_mfma_f32_16x16x32_bf16 v[136:139], v[208:211], v[196:199], v[136:139]
ds_read_b128 v[76:79], v18 offset:44032
v_mfma_f32_16x16x32_bf16 v[144:147], v[208:211], v[200:203], v[144:147]
v_mfma_f32_16x16x32_bf16 v[148:151], v[212:215], v[200:203], v[148:151]
v_mfma_f32_16x16x32_bf16 v[156:159], v[212:215], v[204:207], v[156:159]
v_mfma_f32_16x16x32_bf16 v[152:155], v[208:211], v[204:207], v[152:155]
s_waitcnt lgkmcnt(0)
s_barrier
buffer_load_dwordx4 v[232:235], v2, s[84:87], s46 offen offset:0 sc1
buffer_load_dwordx4 v[236:239], v2, s[84:87], s46 offen offset:1024 sc1
buffer_load_dwordx4 v[240:243], v2, s[84:87], s46 offen offset:2048 sc1
buffer_load_dwordx4 v[244:247], v2, s[84:87], s46 offen offset:3072 sc1
v_mfma_f32_16x16x32_bf16 v[128:131], v[48:51], v[32:35], v[128:131]
ds_read_b128 v[96:99], v19 offset:0
ds_read_b64_tr_b16 v[112:113], v224 offset:0
v_mfma_f32_16x16x32_bf16 v[132:135], v[52:55], v[32:35], v[132:135]
ds_read_b64_tr_b16 v[114:115], v224 offset:2048
ds_read_b64_tr_b16 v[116:117], v225 offset:0
v_mfma_f32_16x16x32_bf16 v[140:143], v[52:55], v[36:39], v[140:143]
ds_read_b64_tr_b16 v[118:119], v225 offset:2048
ds_read_b128 v[100:103], v19 offset:1024
v_mfma_f32_16x16x32_bf16 v[136:139], v[48:51], v[36:39], v[136:139]
ds_read_b128 v[104:107], v19 offset:2048
ds_read_b128 v[108:111], v19 offset:3072
v_mfma_f32_16x16x32_bf16 v[144:147], v[48:51], v[40:43], v[144:147]
ds_read_b128 v[192:195], v19 offset:8192
v_mfma_f32_16x16x32_bf16 v[148:151], v[52:55], v[40:43], v[148:151]
ds_read_b64_tr_b16 v[208:209], v224 offset:4096
v_mfma_f32_16x16x32_bf16 v[156:159], v[52:55], v[44:47], v[156:159]
ds_read_b64_tr_b16 v[210:211], v224 offset:6144
v_mfma_f32_16x16x32_bf16 v[152:155], v[48:51], v[44:47], v[152:155]
ds_read_b64_tr_b16 v[212:213], v225 offset:4096
v_mfma_f32_16x16x32_bf16 v[128:131], v[80:83], v[64:67], v[128:131]
ds_read_b64_tr_b16 v[214:215], v225 offset:6144
v_mfma_f32_16x16x32_bf16 v[132:135], v[84:87], v[64:67], v[132:135]
ds_read_b128 v[196:199], v19 offset:9216
v_mfma_f32_16x16x32_bf16 v[140:143], v[84:87], v[68:71], v[140:143]
ds_read_b128 v[200:203], v19 offset:10240
v_mfma_f32_16x16x32_bf16 v[136:139], v[80:83], v[68:71], v[136:139]
ds_read_b128 v[204:207], v19 offset:11264
v_mfma_f32_16x16x32_bf16 v[144:147], v[80:83], v[72:75], v[144:147]
v_mfma_f32_16x16x32_bf16 v[148:151], v[84:87], v[72:75], v[148:151]
v_mfma_f32_16x16x32_bf16 v[156:159], v[84:87], v[76:79], v[156:159]
v_mfma_f32_16x16x32_bf16 v[152:155], v[80:83], v[76:79], v[152:155]
s_waitcnt lgkmcnt(0)
s_barrier
v_mfma_f32_16x16x32_bf16 v[128:131], v[112:115], v[96:99], v[128:131]
ds_read_b128 v[32:35], v17 offset:16384
ds_read_b64_tr_b16 v[48:49], v224 offset:32768
v_mfma_f32_16x16x32_bf16 v[132:135], v[116:119], v[96:99], v[132:135]
ds_read_b64_tr_b16 v[50:51], v224 offset:34816
ds_read_b64_tr_b16 v[52:53], v225 offset:32768
v_mfma_f32_16x16x32_bf16 v[140:143], v[116:119], v[100:103], v[140:143]
ds_read_b64_tr_b16 v[54:55], v225 offset:34816
ds_read_b128 v[36:39], v17 offset:17408
v_mfma_f32_16x16x32_bf16 v[136:139], v[112:115], v[100:103], v[136:139]
ds_read_b128 v[40:43], v17 offset:18432
ds_read_b128 v[44:47], v17 offset:19456
v_mfma_f32_16x16x32_bf16 v[144:147], v[112:115], v[104:107], v[144:147]
ds_read_b128 v[64:67], v17 offset:24576
v_mfma_f32_16x16x32_bf16 v[148:151], v[116:119], v[104:107], v[148:151]
ds_read_b64_tr_b16 v[80:81], v224 offset:36864
v_mfma_f32_16x16x32_bf16 v[156:159], v[116:119], v[108:111], v[156:159]
ds_read_b64_tr_b16 v[82:83], v224 offset:38912
v_mfma_f32_16x16x32_bf16 v[152:155], v[112:115], v[108:111], v[152:155]
ds_read_b64_tr_b16 v[84:85], v225 offset:36864
v_mfma_f32_16x16x32_bf16 v[128:131], v[208:211], v[192:195], v[128:131]
ds_read_b64_tr_b16 v[86:87], v225 offset:38912
v_mfma_f32_16x16x32_bf16 v[132:135], v[212:215], v[192:195], v[132:135]
ds_read_b128 v[68:71], v17 offset:25600
v_mfma_f32_16x16x32_bf16 v[140:143], v[212:215], v[196:199], v[140:143]
ds_read_b128 v[72:75], v17 offset:26624
v_mfma_f32_16x16x32_bf16 v[136:139], v[208:211], v[196:199], v[136:139]
ds_read_b128 v[76:79], v17 offset:27648
v_mfma_f32_16x16x32_bf16 v[144:147], v[208:211], v[200:203], v[144:147]
v_mfma_f32_16x16x32_bf16 v[148:151], v[212:215], v[200:203], v[148:151]
v_mfma_f32_16x16x32_bf16 v[156:159], v[212:215], v[204:207], v[156:159]
v_mfma_f32_16x16x32_bf16 v[152:155], v[208:211], v[204:207], v[152:155]
s_waitcnt lgkmcnt(0)
s_barrier
v_mfma_f32_16x16x32_bf16 v[128:131], v[48:51], v[32:35], v[128:131]
ds_read_b128 v[96:99], v17 offset:49152
ds_read_b64_tr_b16 v[112:113], v226 offset:0
v_mfma_f32_16x16x32_bf16 v[132:135], v[52:55], v[32:35], v[132:135]
ds_read_b64_tr_b16 v[114:115], v226 offset:2048
ds_read_b64_tr_b16 v[116:117], v227 offset:0
v_mfma_f32_16x16x32_bf16 v[140:143], v[52:55], v[36:39], v[140:143]
ds_read_b64_tr_b16 v[118:119], v227 offset:2048
ds_read_b128 v[100:103], v17 offset:50176
v_mfma_f32_16x16x32_bf16 v[136:139], v[48:51], v[36:39], v[136:139]
ds_read_b128 v[104:107], v17 offset:51200
ds_read_b128 v[108:111], v17 offset:52224
v_mfma_f32_16x16x32_bf16 v[144:147], v[48:51], v[40:43], v[144:147]
ds_read_b128 v[192:195], v17 offset:57344
v_mfma_f32_16x16x32_bf16 v[148:151], v[52:55], v[40:43], v[148:151]
ds_read_b64_tr_b16 v[208:209], v226 offset:4096
v_mfma_f32_16x16x32_bf16 v[156:159], v[52:55], v[44:47], v[156:159]
ds_read_b64_tr_b16 v[210:211], v226 offset:6144
v_mfma_f32_16x16x32_bf16 v[152:155], v[48:51], v[44:47], v[152:155]
ds_read_b64_tr_b16 v[212:213], v227 offset:4096
v_mfma_f32_16x16x32_bf16 v[128:131], v[80:83], v[64:67], v[128:131]
ds_read_b64_tr_b16 v[214:215], v227 offset:6144
v_mfma_f32_16x16x32_bf16 v[132:135], v[84:87], v[64:67], v[132:135]
ds_read_b128 v[196:199], v17 offset:58368
v_mfma_f32_16x16x32_bf16 v[140:143], v[84:87], v[68:71], v[140:143]
ds_read_b128 v[200:203], v17 offset:59392
v_mfma_f32_16x16x32_bf16 v[136:139], v[80:83], v[68:71], v[136:139]
ds_read_b128 v[204:207], v17 offset:60416
v_mfma_f32_16x16x32_bf16 v[144:147], v[80:83], v[72:75], v[144:147]
v_mfma_f32_16x16x32_bf16 v[148:151], v[84:87], v[72:75], v[148:151]
v_mfma_f32_16x16x32_bf16 v[156:159], v[84:87], v[76:79], v[156:159]
v_mfma_f32_16x16x32_bf16 v[152:155], v[80:83], v[76:79], v[152:155]
s_waitcnt vmcnt(0)
s_waitcnt lgkmcnt(0)
s_barrier
v_mfma_f32_16x16x32_bf16 v[128:131], v[112:115], v[96:99], v[128:131]
v_lshlrev_b32 v160, 16, v232
v_and_b32 v161, 0xffff0000, v232
v_lshlrev_b32 v162, 16, v233
v_and_b32 v163, 0xffff0000, v233
v_mfma_f32_16x16x32_bf16 v[132:135], v[116:119], v[96:99], v[132:135]
v_lshlrev_b32 v164, 16, v234
v_and_b32 v165, 0xffff0000, v234
v_lshlrev_b32 v166, 16, v235
v_and_b32 v167, 0xffff0000, v235
v_mfma_f32_16x16x32_bf16 v[128:131], v[208:211], v[192:195], v[128:131]
v_lshlrev_b32 v168, 16, v236
v_and_b32 v169, 0xffff0000, v236
v_lshlrev_b32 v170, 16, v237
v_and_b32 v171, 0xffff0000, v237
v_mfma_f32_16x16x32_bf16 v[132:135], v[212:215], v[192:195], v[132:135]
v_lshlrev_b32 v172, 16, v238
v_and_b32 v173, 0xffff0000, v238
v_lshlrev_b32 v174, 16, v239
v_and_b32 v175, 0xffff0000, v239
v_mfma_f32_16x16x32_bf16 v[136:139], v[112:115], v[100:103], v[136:139]
v_lshlrev_b32 v176, 16, v240
v_and_b32 v177, 0xffff0000, v240
v_lshlrev_b32 v178, 16, v241
v_and_b32 v179, 0xffff0000, v241
v_mfma_f32_16x16x32_bf16 v[140:143], v[116:119], v[100:103], v[140:143]
v_lshlrev_b32 v180, 16, v242
v_and_b32 v181, 0xffff0000, v242
v_lshlrev_b32 v182, 16, v243
v_and_b32 v183, 0xffff0000, v243
v_mfma_f32_16x16x32_bf16 v[136:139], v[208:211], v[196:199], v[136:139]
v_lshlrev_b32 v184, 16, v244
v_and_b32 v185, 0xffff0000, v244
v_lshlrev_b32 v186, 16, v245
v_and_b32 v187, 0xffff0000, v245
v_mfma_f32_16x16x32_bf16 v[140:143], v[212:215], v[196:199], v[140:143]
v_lshlrev_b32 v188, 16, v246
v_and_b32 v189, 0xffff0000, v246
v_lshlrev_b32 v190, 16, v247
v_and_b32 v191, 0xffff0000, v247
v_mfma_f32_16x16x32_bf16 v[144:147], v[112:115], v[104:107], v[144:147]
v_add_f32 v128, v128, v160
v_add_f32 v129, v129, v161
v_add_f32 v130, v130, v162
v_mfma_f32_16x16x32_bf16 v[148:151], v[116:119], v[104:107], v[148:151]
v_add_f32 v131, v131, v163
v_add_f32 v132, v132, v164
v_add_f32 v133, v133, v165
v_mfma_f32_16x16x32_bf16 v[144:147], v[208:211], v[200:203], v[144:147]
v_add_f32 v134, v134, v166
v_add_f32 v135, v135, v167
v_cvt_pk_bf16_f32 v232, v128, v129
v_mfma_f32_16x16x32_bf16 v[148:151], v[212:215], v[200:203], v[148:151]
v_cvt_pk_bf16_f32 v233, v130, v131
v_cvt_pk_bf16_f32 v234, v132, v133
v_cvt_pk_bf16_f32 v235, v134, v135
v_mfma_f32_16x16x32_bf16 v[152:155], v[112:115], v[108:111], v[152:155]
v_add_f32 v136, v136, v168
v_add_f32 v137, v137, v169
v_add_f32 v138, v138, v170
v_mfma_f32_16x16x32_bf16 v[156:159], v[116:119], v[108:111], v[156:159]
v_add_f32 v139, v139, v171
v_add_f32 v140, v140, v172
v_add_f32 v141, v141, v173
v_add_f32 v142, v142, v174
v_mfma_f32_16x16x32_bf16 v[152:155], v[208:211], v[204:207], v[152:155]
v_add_f32 v143, v143, v175
v_cvt_pk_bf16_f32 v236, v136, v137
s_branch Lov_13
.p2align 12
.fill 96, 4, 0xbf800000
Lst_13_0:
s_branch Lwr_154
Lst_13_1:
s_branch Lst_17_1
s_nop 0
Lov_13:
v_cvt_pk_bf16_f32 v237, v138, v139
v_cvt_pk_bf16_f32 v238, v140, v141
v_mfma_f32_16x16x32_bf16 v[156:159], v[212:215], v[204:207], v[156:159]
v_cvt_pk_bf16_f32 v239, v142, v143
v_permlane16_swap_b32 v232, v234
v_permlane16_swap_b32 v233, v235
buffer_store_dwordx4 v[232:235], v230, s[20:23], s54 offen offset:0 nt
v_permlane16_swap_b32 v236, v238
v_permlane16_swap_b32 v237, v239
buffer_store_dwordx4 v[236:239], v230, s[20:23], s54 offen offset:2048 nt
v_add_f32 v144, v144, v176
v_add_f32 v145, v145, v177
v_add_f32 v146, v146, v178
v_add_f32 v147, v147, v179
v_add_f32 v148, v148, v180
v_add_f32 v149, v149, v181
v_add_f32 v150, v150, v182
v_add_f32 v151, v151, v183
v_cvt_pk_bf16_f32 v240, v144, v145
v_cvt_pk_bf16_f32 v241, v146, v147
v_cvt_pk_bf16_f32 v242, v148, v149
v_cvt_pk_bf16_f32 v243, v150, v151
s_nop 0
v_add_f32 v152, v152, v184
v_add_f32 v153, v153, v185
v_add_f32 v154, v154, v186
v_add_f32 v155, v155, v187
v_add_f32 v156, v156, v188
v_add_f32 v157, v157, v189
v_add_f32 v158, v158, v190
v_add_f32 v159, v159, v191
v_cvt_pk_bf16_f32 v244, v152, v153
v_cvt_pk_bf16_f32 v245, v154, v155
v_cvt_pk_bf16_f32 v246, v156, v157
v_cvt_pk_bf16_f32 v247, v158, v159
v_permlane16_swap_b32 v240, v242
v_permlane16_swap_b32 v241, v243
buffer_store_dwordx4 v[240:243], v230, s[20:23], s55 offen offset:0 nt
v_permlane16_swap_b32 v244, v246
v_permlane16_swap_b32 v245, v247
buffer_store_dwordx4 v[244:247], v230, s[20:23], s55 offen offset:2048 nt
s_branch Ldone_1
Lgb_97:
s_mul_i32 s43, s34, 262144
s_add_u32 s8, s82, s43
s_addc_u32 s9, s83, 0
s_add_u32 s8, s8, 4194304
s_addc_u32 s9, s9, 0
s_mov_b32 s10, 262144
s_mov_b32 s11, 0x20000
s_lshl_b32 s39, s36, 12
v_lshlrev_b32 v2, 4, v1
v_add_u32 v3, s39, v2
s_add_u32 s37, s35, 0
s_and_b32 s37, s37, 15
s_mul_i32 s37, s37, 16384
s_add_u32 m0, s39, 0
s_nop 0
buffer_load_dwordx4 v3, s[8:11], s37 offen sc1 lds
buffer_load_dwordx4 v3, s[8:11], s37 offen offset:1024 sc1 lds
buffer_load_dwordx4 v3, s[8:11], s37 offen offset:2048 sc1 lds
buffer_load_dwordx4 v3, s[8:11], s37 offen offset:3072 sc1 lds
s_mul_i32 s43, s34, 262144
s_add_u32 s8, s82, s43
s_addc_u32 s9, s83, 0
s_add_u32 s8, s8, 4194304
s_addc_u32 s9, s9, 0
s_mov_b32 s10, 262144
s_mov_b32 s11, 0x20000
s_mul_i32 s43, s34, 917504
s_add_u32 s24, s82, s43
s_addc_u32 s25, s83, 0
s_add_u32 s24, s24, 8388608
s_addc_u32 s25, s25, 0
s_mov_b32 s26, 917504
s_mov_b32 s27, 0x20000
s_add_u32 s84, s82, 27262976
s_addc_u32 s85, s83, 0
s_mov_b32 s86, 229376
s_mov_b32 s87, 0x20000
s_and_b32 s47, s36, 3
s_lshr_b32 s62, s47, 1
s_and_b32 s63, s47, 1
v_lshlrev_b32 v2, 4, v1
s_lshl_b32 s39, s47, 12
v_add_u32 v3, s39, v2
s_bitcmp0_b32 s36, 1
s_cselect_b32 s44, s72, s74
s_cselect_b32 s45, s73, s75
s_mul_i32 s43, s35, 256
s_add_u32 s12, s44, s43
s_addc_u32 s13, s45, 0
s_mov_b32 s14, 7333120
s_mov_b32 s15, 0x20000
s_and_b32 s43, s36, 1
s_mul_i32 s43, s43, 229376
v_lshrrev_b32 v28, 4, v1
v_lshlrev_b32 v29, 1, v28
v_and_b32 v4, 15, v1
v_xor_b32 v4, v4, v29
v_lshlrev_b32 v4, 4, v4
v_mul_u32_u24 v28, 7168, v28
v_add_u32 v4, v4, v28
v_add_u32 v4, s43, v4
v_xor_b32 v5, 128, v4
v_add_u32 v5, 28672, v5
s_and_b32 s43, s36, 3
s_mul_i32 s40, s43, 8192
s_add_u32 s40, s40, 16384
v_mov_b32 v6, v192
v_mov_b32 v7, v193
v_mov_b32 v8, v194
s_lshl_b32 s43, s62, 12
v_add_u32 v9, s43, v2
v_add_u32 v10, 98304, v9
v_mov_b32 v24, v195
s_mul_i32 s43, s34, 16384
s_add_u32 s20, s82, s43
s_addc_u32 s21, s83, 0
s_add_u32 s20, s20, 25165824
s_addc_u32 s21, s21, 0
s_mov_b32 s22, 16384
s_mov_b32 s23, 0x20000
s_add_u32 s38, s35, 2
s_and_b32 s38, s38, 15
s_mul_i32 s38, s38, 458752
s_add_u32 m0, s50, 98304
s_nop 0
buffer_load_dwordx4 v6, s[16:19], s38 offen lds
s_add_u32 m0, s50, 99328
s_nop 0
buffer_load_dwordx4 v7, s[16:19], s38 offen lds
s_add_u32 m0, s50, 100352
s_nop 0
buffer_load_dwordx4 v8, s[16:19], s38 offen lds
s_add_u32 m0, s50, 101376
s_add_u32 s38, s38, 114688
buffer_load_dwordx4 v6, s[16:19], s38 offen lds
s_add_u32 m0, s50, 102400
s_nop 0
buffer_load_dwordx4 v7, s[16:19], s38 offen lds
s_add_u32 m0, s50, 103424
s_nop 0
buffer_load_dwordx4 v8, s[16:19], s38 offen lds
s_cmp_eq_u32 s47, 1
s_cbranch_scc0 Lw_122
s_lshl_b32 s92, s34, 4
s_add_u32 s92, s92, s35
s_lshl_b32 s92, s92, 8
s_add_u32 s92, s92, 49280
s_add_u32 s92, s92, 28311552
s_mov_b32 s41, 0x40000
Lpoll_123:
s_load_dword s93, s[82:83], s92 glc
Lpchk_125:
s_waitcnt lgkmcnt(0)
s_cmp_eq_u32 s93, 16
s_cbranch_scc1 Lpok_124
s_sub_u32 s41, s41, 1
s_cmp_lg_u32 s41, 0
s_cbranch_scc1 Lpoll_123
Lpok_124:
Lw_122:
s_waitcnt vmcnt(0)
s_barrier
s_add_u32 s37, s35, 1
s_and_b32 s37, s37, 15
s_mul_i32 s37, s37, 16384
s_add_u32 m0, s39, 49152
s_nop 0
buffer_load_dwordx4 v3, s[8:11], s37 offen sc1 lds
buffer_load_dwordx4 v3, s[8:11], s37 offen offset:1024 sc1 lds
buffer_load_dwordx4 v3, s[8:11], s37 offen offset:2048 sc1 lds
buffer_load_dwordx4 v3, s[8:11], s37 offen offset:3072 sc1 lds
s_add_u32 s37, s35, 2
s_and_b32 s37, s37, 15
s_mul_i32 s37, s37, 16384
s_add_u32 m0, s39, 98304
s_nop 0
buffer_load_dwordx4 v3, s[8:11], s37 offen sc1 lds
buffer_load_dwordx4 v3, s[8:11], s37 offen offset:1024 sc1 lds
buffer_load_dwordx4 v3, s[8:11], s37 offen offset:2048 sc1 lds
buffer_load_dwordx4 v3, s[8:11], s37 offen offset:3072 sc1 lds
buffer_load_dwordx4 v[96:99], v3, s[20:23], 0 offen offset:0 sc1
buffer_load_dwordx4 v[100:103], v3, s[20:23], 0 offen offset:1024 sc1
buffer_load_dwordx4 v[104:107], v3, s[20:23], 0 offen offset:2048 sc1
buffer_load_dwordx4 v[108:111], v3, s[20:23], 0 offen offset:3072 sc1
s_and_b32 s44, s36, 3
s_mul_i32 s44, s44, 14
s_bfe_u32 s43, s2, 0x30001
s_lshl_b32 s43, s43, 7
s_add_u32 s44, s44, s43
s_add_u32 s44, s44, 72
s_mul_i32 s44, s44, 7168
s_lshr_b32 s43, s2, 4
s_lshl_b32 s43, s43, 8
s_add_u32 s43, s43, s44
s_bitcmp0_b32 s2, 0
s_cselect_b32 s4, s72, s74
s_cselect_b32 s5, s73, s75
s_add_u32 s4, s4, s43
s_addc_u32 s5, s5, 0
s_waitcnt vmcnt(8)
s_barrier
s_cmp_eq_u32 s47, 3
s_cbranch_scc0 Lw_126
v_and_b32 v90, 31, v1
v_lshlrev_b32 v90, 4, v90
v_add_u32 v91, 151552, v90
ds_read_b128 v[112:115], v91 offset:0
ds_read_b128 v[116:119], v91 offset:512
ds_read_b128 v[120:123], v91 offset:1024
ds_read_b128 v[124:127], v91 offset:1536
s_and_b32 s44, s2, 15
s_mul_i32 s44, s44, 14336
s_lshr_b32 s43, s2, 4
s_lshl_b32 s43, s43, 9
s_add_u32 s44, s44, s43
s_add_u32 s44, s44, 8192
s_cmp_lt_u32 s2, 192
s_cselect_b32 s44, s44, 0x7fffffff
s_waitcnt lgkmcnt(0)
v_add_f32 v112, v112, v116
v_add_f32 v120, v120, v124
v_add_f32 v113, v113, v117
v_add_f32 v121, v121, v125
v_add_f32 v114, v114, v118
v_add_f32 v122, v122, v126
v_add_f32 v115, v115, v119
v_add_f32 v123, v123, v127
v_add_f32 v112, v112, v120
v_add_f32 v113, v113, v121
v_add_f32 v114, v114, v122
v_add_f32 v115, v115, v123
s_mov_b64 exec, 0xffffffff
buffer_store_dwordx4 v[112:115], v90, s[84:87], s44 offen sc1
s_mov_b64 exec, -1
Lw_126:
s_add_u32 s37, s35, 3
s_and_b32 s37, s37, 15
s_mul_i32 s37, s37, 16384
s_add_u32 m0, s39, 0
s_nop 0
buffer_load_dwordx4 v3, s[8:11], s37 offen sc1 lds
buffer_load_dwordx4 v3, s[8:11], s37 offen offset:1024 sc1 lds
s_load_dword s3, s[4:5], 78848
buffer_load_dwordx4 v3, s[8:11], s37 offen offset:2048 sc1 lds
buffer_load_dwordx4 v3, s[8:11], s37 offen offset:3072 sc1 lds
s_load_dword s3, s[4:5], 78912
s_add_u32 s38, s35, 3
s_and_b32 s38, s38, 15
s_mul_i32 s38, s38, 458752
s_add_u32 m0, s50, 0
s_nop 0
buffer_load_dwordx4 v6, s[16:19], s38 offen lds
s_load_dword s3, s[4:5], 78976
s_add_u32 m0, s50, 1024
s_nop 0
buffer_load_dwordx4 v7, s[16:19], s38 offen lds
s_add_u32 m0, s50, 2048
s_nop 0
buffer_load_dwordx4 v8, s[16:19], s38 offen lds
s_load_dword s3, s[4:5], 79040
s_add_u32 m0, s50, 3072
s_add_u32 s38, s38, 114688
buffer_load_dwordx4 v6, s[16:19], s38 offen lds
s_load_dword s3, s[4:5], 86016
s_add_u32 m0, s50, 4096
s_nop 0
buffer_load_dwordx4 v7, s[16:19], s38 offen lds
s_add_u32 m0, s50, 5120
s_nop 0
buffer_load_dwordx4 v8, s[16:19], s38 offen lds
s_waitcnt vmcnt(14)
s_barrier
s_add_u32 s37, s35, 4
s_and_b32 s37, s37, 15
s_mul_i32 s37, s37, 16384
s_add_u32 m0, s39, 49152
s_nop 0
buffer_load_dwordx4 v3, s[8:11], s37 offen sc1 lds
buffer_load_dwordx4 v3, s[8:11], s37 offen offset:1024 sc1 lds
s_load_dword s3, s[4:5], 86080
buffer_load_dwordx4 v3, s[8:11], s37 offen offset:2048 sc1 lds
buffer_load_dwordx4 v3, s[8:11], s37 offen offset:3072 sc1 lds
s_load_dword s3, s[4:5], 86144
s_add_u32 s38, s35, 4
s_and_b32 s38, s38, 15
s_mul_i32 s38, s38, 458752
s_add_u32 m0, s50, 49152
s_nop 0
buffer_load_dwordx4 v6, s[16:19], s38 offen lds
s_load_dword s3, s[4:5], 86208
s_add_u32 m0, s50, 50176
s_nop 0
buffer_load_dwordx4 v7, s[16:19], s38 offen lds
s_add_u32 m0, s50, 51200
s_nop 0
buffer_load_dwordx4 v8, s[16:19], s38 offen lds
s_load_dword s3, s[4:5], 93184
s_add_u32 m0, s50, 52224
s_add_u32 s38, s38, 114688
buffer_load_dwordx4 v6, s[16:19], s38 offen lds
s_load_dword s3, s[4:5], 93248
s_add_u32 m0, s50, 53248
s_nop 0
buffer_load_dwordx4 v7, s[16:19], s38 offen lds
s_add_u32 m0, s50, 54272
s_nop 0
buffer_load_dwordx4 v8, s[16:19], s38 offen lds
s_waitcnt vmcnt(10)
s_barrier
s_cmp_eq_u32 s47, 3
s_cbranch_scc0 Lw_127
s_cmp_lt_u32 s2, 192
s_cbranch_scc0 Lw_127
s_lshr_b32 s43, s2, 4
s_add_u32 s43, s43, 96
s_lshl_b32 s43, s43, 7
v_mov_b32 v90, s43
v_mov_b32 v91, 1
s_mov_b64 exec, 1
buffer_atomic_add v91, v90, s[56:59], 0 offen sc1
s_mov_b64 exec, -1
Lw_127:
s_add_u32 s37, s35, 5
s_and_b32 s37, s37, 15
s_mul_i32 s37, s37, 16384
s_add_u32 m0, s39, 98304
s_nop 0
buffer_load_dwordx4 v3, s[8:11], s37 offen sc1 lds
v_add_f32 v96, v96, v100
v_add_f32 v97, v97, v101
v_add_f32 v98, v98, v102
buffer_load_dwordx4 v3, s[8:11], s37 offen offset:1024 sc1 lds
v_add_f32 v99, v99, v103
v_add_f32 v104, v104, v108
v_add_f32 v105, v105, v109
buffer_load_dwordx4 v3, s[8:11], s37 offen offset:2048 sc1 lds
v_add_f32 v106, v106, v110
v_add_f32 v107, v107, v111
s_nop 0
buffer_load_dwordx4 v3, s[8:11], s37 offen offset:3072 sc1 lds
v_permlane32_swap_b32 v96, v104
v_permlane32_swap_b32 v97, v105
v_permlane32_swap_b32 v98, v106
v_permlane32_swap_b32 v99, v107
s_add_u32 s38, s35, 5
s_and_b32 s38, s38, 15
s_mul_i32 s38, s38, 458752
s_add_u32 m0, s50, 98304
s_nop 0
buffer_load_dwordx4 v6, s[16:19], s38 offen lds
v_add_f32 v96, v96, v104
v_add_f32 v97, v97, v105
v_add_f32 v98, v98, v106
s_add_u32 m0, s50, 99328
s_nop 0
buffer_load_dwordx4 v7, s[16:19], s38 offen lds
v_add_f32 v99, v99, v107
v_mov_b32 v100, v96
v_mov_b32 v101, v97
s_add_u32 m0, s50, 100352
s_nop 0
buffer_load_dwordx4 v8, s[16:19], s38 offen lds
v_mov_b32 v102, v98
v_mov_b32 v103, v99
s_nop 0
s_add_u32 m0, s50, 101376
s_add_u32 s38, s38, 114688
buffer_load_dwordx4 v6, s[16:19], s38 offen lds
v_permlane16_swap_b32 v96, v100
v_permlane16_swap_b32 v97, v101
v_permlane16_swap_b32 v98, v102
v_permlane16_swap_b32 v99, v103
s_add_u32 m0, s50, 102400
s_nop 0
buffer_load_dwordx4 v7, s[16:19], s38 offen lds
s_add_u32 m0, s50, 103424
s_nop 0
buffer_load_dwordx4 v8, s[16:19], s38 offen lds
s_waitcnt vmcnt(10)
s_barrier
s_add_u32 s37, s35, 6
s_and_b32 s37, s37, 15
s_mul_i32 s37, s37, 16384
s_add_u32 m0, s39, 0
s_nop 0
buffer_load_dwordx4 v3, s[8:11], s37 offen sc1 lds
v_add_f32 v96, v96, v100
v_add_f32 v97, v97, v101
v_add_f32 v98, v98, v102
buffer_load_dwordx4 v3, s[8:11], s37 offen offset:1024 sc1 lds
v_add_f32 v99, v99, v103
s_nop 0
v_add_f32_dpp v96, v96, v96 row_ror:8 row_mask:0xf bank_mask:0xf
buffer_load_dwordx4 v3, s[8:11], s37 offen offset:2048 sc1 lds
v_add_f32_dpp v97, v97, v97 row_ror:8 row_mask:0xf bank_mask:0xf
v_add_f32_dpp v98, v98, v98 row_ror:8 row_mask:0xf bank_mask:0xf
v_add_f32_dpp v99, v99, v99 row_ror:8 row_mask:0xf bank_mask:0xf
v_mul_f32 v96, 0x3a800000, v96
buffer_load_dwordx4 v3, s[8:11], s37 offen offset:3072 sc1 lds
v_mul_f32 v97, 0x3a800000, v97
v_mul_f32 v98, 0x3a800000, v98
v_mul_f32 v99, 0x3a800000, v99
s_add_u32 s38, s35, 6
s_and_b32 s38, s38, 15
s_mul_i32 s38, s38, 458752
s_add_u32 m0, s50, 0
s_nop 0
buffer_load_dwordx4 v6, s[16:19], s38 offen lds
v_fma_f32 v97, -v96, v96, v97
v_fma_f32 v99, -v98, v98, v99
v_max_f32 v97, 0, v97
s_add_u32 m0, s50, 1024
s_nop 0
buffer_load_dwordx4 v7, s[16:19], s38 offen lds
v_max_f32 v99, 0, v99
v_add_f32 v97, 0x3727c5ac, v97
v_add_f32 v99, 0x3727c5ac, v99
v_rsq_f32 v97, v97
s_add_u32 m0, s50, 2048
s_nop 0
buffer_load_dwordx4 v8, s[16:19], s38 offen lds
v_rsq_f32 v99, v99
v_and_b32 v100, 7, v1
s_lshl_b32 s43, s47, 8
s_add_u32 m0, s50, 3072
s_add_u32 s38, s38, 114688
buffer_load_dwordx4 v6, s[16:19], s38 offen lds
s_add_u32 s43, s43, 147456
v_lshl_add_u32 v100, v100, 4, s43
v_lshrrev_b32 v101, 5, v1
v_lshl_add_u32 v100, v101, 7, v100
s_add_u32 m0, s50, 4096
s_nop 0
buffer_load_dwordx4 v7, s[16:19], s38 offen lds
s_add_u32 m0, s50, 5120
s_nop 0
buffer_load_dwordx4 v8, s[16:19], s38 offen lds
s_waitcnt vmcnt(10)
s_barrier
ds_write_b128 v100, v[96:99]
s_waitcnt lgkmcnt(0)
s_add_u32 s37, s35, 7
s_and_b32 s37, s37, 15
s_mul_i32 s37, s37, 16384
s_add_u32 m0, s39, 49152
s_nop 0
buffer_load_dwordx4 v3, s[8:11], s37 offen sc1 lds
s_load_dword s3, s[4:5], 93312
buffer_load_dwordx4 v3, s[8:11], s37 offen offset:1024 sc1 lds
s_load_dword s3, s[4:5], 93376
s_and_b32 s44, s36, 3
buffer_load_dwordx4 v3, s[8:11], s37 offen offset:2048 sc1 lds
s_mul_i32 s43, s2, 28672
buffer_load_dwordx4 v3, s[8:11], s37 offen offset:3072 sc1 lds
s_mul_i32 s44, s44, 7168
s_add_u32 s43, s43, s44
s_add_u32 s38, s35, 7
s_and_b32 s38, s38, 15
s_mul_i32 s38, s38, 458752
s_add_u32 m0, s50, 49152
s_nop 0
buffer_load_dwordx4 v6, s[16:19], s38 offen lds
s_add_u32 s4, s76, s43
s_add_u32 m0, s50, 50176
s_nop 0
buffer_load_dwordx4 v7, s[16:19], s38 offen lds
s_addc_u32 s5, s77, 0
s_load_dword s3, s[4:5], 0
s_add_u32 m0, s50, 51200
s_nop 0
buffer_load_dwordx4 v8, s[16:19], s38 offen lds
s_load_dword s3, s[4:5], 64
s_add_u32 m0, s50, 52224
s_add_u32 s38, s38, 114688
buffer_load_dwordx4 v6, s[16:19], s38 offen lds
s_load_dword s3, s[4:5], 128
s_load_dword s3, s[4:5], 192
s_add_u32 m0, s50, 53248
s_nop 0
buffer_load_dwordx4 v7, s[16:19], s38 offen lds
s_add_u32 m0, s50, 54272
s_nop 0
buffer_load_dwordx4 v8, s[16:19], s38 offen lds
s_waitcnt vmcnt(10)
s_barrier
s_add_u32 s37, s35, 8
s_and_b32 s37, s37, 15
s_mul_i32 s37, s37, 16384
s_add_u32 m0, s39, 98304
s_nop 0
buffer_load_dwordx4 v3, s[8:11], s37 offen sc1 lds
s_load_dword s3, s[4:5], 256
s_load_dword s3, s[4:5], 320
s_load_dword s3, s[4:5], 384
buffer_load_dwordx4 v3, s[8:11], s37 offen offset:1024 sc1 lds
s_load_dword s3, s[4:5], 448
s_load_dword s3, s[4:5], 512
s_load_dword s3, s[4:5], 576
buffer_load_dwordx4 v3, s[8:11], s37 offen offset:2048 sc1 lds
v_lshrrev_b32 v28, 2, v1
v_and_b32 v29, 7, v28
v_mul_u32_u24 v28, 256, v28
buffer_load_dwordx4 v3, s[8:11], s37 offen offset:3072 sc1 lds
v_lshl_add_u32 v28, v29, 5, v28
v_and_b32 v29, 3, v1
v_lshl_add_u32 v11, v29, 3, v28
s_lshl_b32 s43, s63, 7
s_add_u32 s38, s35, 8
s_and_b32 s38, s38, 15
s_mul_i32 s38, s38, 458752
s_add_u32 m0, s50, 98304
s_nop 0
buffer_load_dwordx4 v6, s[16:19], s38 offen lds
v_xor_b32 v11, s43, v11
v_add_u32 v11, 16384, v11
v_xor_b32 v12, 32, v11
s_add_u32 m0, s50, 99328
s_nop 0
buffer_load_dwordx4 v7, s[16:19], s38 offen lds
v_xor_b32 v13, 64, v11
v_xor_b32 v14, 96, v11
v_add_u32 v15, 49152, v11
s_add_u32 m0, s50, 100352
s_nop 0
buffer_load_dwordx4 v8, s[16:19], s38 offen lds
v_add_u32 v16, 49152, v12
v_add_u32 v17, 49152, v13
v_add_u32 v18, 49152, v14
s_add_u32 m0, s50, 101376
s_add_u32 s38, s38, 114688
buffer_load_dwordx4 v6, s[16:19], s38 offen lds
v_add_u32 v19, 98304, v11
v_add_u32 v20, 98304, v12
v_add_u32 v21, 98304, v13
v_add_u32 v22, 98304, v14
s_add_u32 m0, s50, 102400
s_nop 0
buffer_load_dwordx4 v7, s[16:19], s38 offen lds
s_add_u32 m0, s50, 103424
s_nop 0
buffer_load_dwordx4 v8, s[16:19], s38 offen lds
s_waitcnt vmcnt(10)
s_barrier
s_cmp_eq_u32 s47, 3
s_cbranch_scc0 Lw_128
s_mul_i32 s60, s35, 96
s_add_u32 s61, s60, 95
s_and_b32 s60, s60, 0xff80
s_and_b32 s61, s61, 0xff80
s_add_u32 s60, s60, 28323840
s_add_u32 s61, s61, 28323840
s_load_dword s92, s[82:83], s60 glc
s_load_dword s93, s[82:83], s61 glc
Lw_128:
s_add_u32 s37, s35, 9
s_and_b32 s37, s37, 15
s_mul_i32 s37, s37, 16384
s_add_u32 m0, s39, 0
s_nop 0
buffer_load_dwordx4 v3, s[8:11], s37 offen sc1 lds
buffer_load_dwordx4 v3, s[8:11], s37 offen offset:1024 sc1 lds
buffer_load_dwordx4 v3, s[8:11], s37 offen offset:2048 sc1 lds
buffer_load_dwordx4 v3, s[8:11], s37 offen offset:3072 sc1 lds
s_add_u32 s38, s35, 9
s_and_b32 s38, s38, 15
s_mul_i32 s38, s38, 458752
s_add_u32 m0, s50, 0
s_nop 0
buffer_load_dwordx4 v6, s[16:19], s38 offen lds
s_add_u32 m0, s50, 1024
s_nop 0
buffer_load_dwordx4 v7, s[16:19], s38 offen lds
s_add_u32 m0, s50, 2048
s_nop 0
buffer_load_dwordx4 v8, s[16:19], s38 offen lds
s_add_u32 m0, s50, 3072
s_add_u32 s38, s38, 114688
buffer_load_dwordx4 v6, s[16:19], s38 offen lds
s_add_u32 m0, s50, 4096
s_nop 0
buffer_load_dwordx4 v7, s[16:19], s38 offen lds
s_add_u32 m0, s50, 5120
s_nop 0
buffer_load_dwordx4 v8, s[16:19], s38 offen lds
s_waitcnt vmcnt(10)
s_barrier
s_add_u32 s37, s35, 10
s_and_b32 s37, s37, 15
s_mul_i32 s37, s37, 16384
s_add_u32 m0, s39, 49152
s_nop 0
buffer_load_dwordx4 v3, s[8:11], s37 offen sc1 lds
buffer_load_dwordx4 v3, s[8:11], s37 offen offset:1024 sc1 lds
buffer_load_dwordx4 v3, s[8:11], s37 offen offset:2048 sc1 lds
buffer_load_dwordx4 v3, s[8:11], s37 offen offset:3072 sc1 lds
s_add_u32 s38, s35, 10
s_and_b32 s38, s38, 15
s_mul_i32 s38, s38, 458752
s_add_u32 m0, s50, 49152
s_nop 0
buffer_load_dwordx4 v6, s[16:19], s38 offen lds
s_add_u32 m0, s50, 50176
s_nop 0
buffer_load_dwordx4 v7, s[16:19], s38 offen lds
s_add_u32 m0, s50, 51200
s_nop 0
buffer_load_dwordx4 v8, s[16:19], s38 offen lds
s_add_u32 m0, s50, 52224
s_add_u32 s38, s38, 114688
buffer_load_dwordx4 v6, s[16:19], s38 offen lds
s_add_u32 m0, s50, 53248
s_nop 0
buffer_load_dwordx4 v7, s[16:19], s38 offen lds
s_add_u32 m0, s50, 54272
s_branch Lov_14
.p2align 12
.fill 112, 4, 0xbf800000
Lst_14_0:
s_branch Lwr_155
Lst_14_1:
s_branch Lst_18_1
s_nop 0
Lov_14:
s_nop 0
buffer_load_dwordx4 v8, s[16:19], s38 offen lds
s_mov_b32 s38, 0
buffer_load_dwordx4 v[40:43], v24, s[88:91], s38 offen
s_mov_b32 s38, 28672
buffer_load_dwordx4 v[44:47], v24, s[88:91], s38 offen
s_mov_b32 s38, 57344
buffer_load_dwordx4 v[48:51], v24, s[88:91], s38 offen
s_mov_b32 s38, 86016
buffer_load_dwordx4 v[52:55], v24, s[88:91], s38 offen
s_mov_b32 s38, 114688
buffer_load_dwordx4 v[56:59], v24, s[88:91], s38 offen
s_mov_b32 s38, 143360
buffer_load_dwordx4 v[60:63], v24, s[88:91], s38 offen
s_mov_b32 s38, 172032
buffer_load_dwordx4 v[64:67], v24, s[88:91], s38 offen
s_mov_b32 s38, 200704
buffer_load_dwordx4 v[68:71], v24, s[88:91], s38 offen
s_waitcnt vmcnt(18)
s_cmp_eq_u32 s47, 3
s_cbranch_scc0 Lw_129
s_mov_b32 s41, 0x40000
Lcp_130:
s_waitcnt lgkmcnt(0)
s_and_b32 s92, s92, s93
s_cmp_eq_u32 s92, 16
s_cbranch_scc1 Lco_131
s_load_dword s92, s[82:83], s60 glc
s_load_dword s93, s[82:83], s61 glc
s_sub_u32 s41, s41, 1
s_cmp_lg_u32 s41, 0
s_cbranch_scc1 Lcp_130
s_waitcnt lgkmcnt(0)
Lco_131:
Lw_129:
s_barrier
s_mov_b32 s45, s47
s_cmp_ge_u32 s45, 3
s_cselect_b32 s43, 1, 0
s_mul_i32 s44, s43, 3
s_sub_u32 s45, s45, s44
s_lshl_b32 s45, s45, 7
s_mul_i32 s52, s43, 896
s_add_u32 s52, s52, s45
s_add_u32 s52, s52, 148992
s_mul_i32 s43, s43, 14336
s_add_u32 s43, s43, s45
s_mul_i32 s44, s35, 384
s_add_u32 s43, s43, s44
s_add_u32 s60, s43, 8192
s_add_u32 s45, s47, 4
s_min_u32 s45, s45, 5
s_cmp_ge_u32 s45, 3
s_cselect_b32 s43, 1, 0
s_mul_i32 s44, s43, 3
s_sub_u32 s45, s45, s44
s_lshl_b32 s45, s45, 7
s_mul_i32 s53, s43, 896
s_add_u32 s53, s53, s45
s_add_u32 s53, s53, 148992
s_mul_i32 s43, s43, 14336
s_add_u32 s43, s43, s45
s_mul_i32 s44, s35, 384
s_add_u32 s43, s43, s44
s_add_u32 s61, s43, 8192
v_lshrrev_b32 v104, 3, v1
v_mul_u32_u24 v104, 28672, v104
v_and_b32 v105, 7, v1
v_lshl_add_u32 v104, v105, 4, v104
buffer_load_dwordx4 v[96:99], v104, s[84:87], s60 offen sc1
s_load_dword s3, s[4:5], 640
buffer_load_dwordx4 v[100:103], v104, s[84:87], s61 offen sc1
s_load_dword s3, s[4:5], 704
s_add_u32 s37, s35, 11
s_and_b32 s37, s37, 15
s_mul_i32 s37, s37, 16384
s_add_u32 m0, s39, 98304
s_nop 0
buffer_load_dwordx4 v3, s[8:11], s37 offen sc1 lds
s_load_dword s3, s[4:5], 768
buffer_load_dwordx4 v3, s[8:11], s37 offen offset:1024 sc1 lds
s_load_dword s3, s[4:5], 832
s_load_dword s3, s[4:5], 896
buffer_load_dwordx4 v3, s[8:11], s37 offen offset:2048 sc1 lds
s_load_dword s3, s[4:5], 960
buffer_load_dwordx4 v3, s[8:11], s37 offen offset:3072 sc1 lds
v_cmp_gt_u32 vcc, 32, v1
s_add_u32 s38, s35, 11
s_and_b32 s38, s38, 15
s_mul_i32 s38, s38, 458752
s_add_u32 m0, s50, 98304
s_nop 0
buffer_load_dwordx4 v6, s[16:19], s38 offen lds
v_mov_b32 v104, s52
v_mov_b32 v106, s53
s_add_u32 m0, s50, 99328
s_nop 0
buffer_load_dwordx4 v7, s[16:19], s38 offen lds
v_cndmask_b32 v104, v106, v104, vcc
s_add_u32 m0, s50, 100352
s_nop 0
buffer_load_dwordx4 v8, s[16:19], s38 offen lds
v_lshl_add_u32 v104, v105, 4, v104
s_add_u32 m0, s50, 101376
s_add_u32 s38, s38, 114688
buffer_load_dwordx4 v6, s[16:19], s38 offen lds
v_bfe_u32 v105, v1, 4, 1
v_lshl_add_u32 v104, v105, 2, v104
s_add_u32 m0, s50, 102400
s_nop 0
buffer_load_dwordx4 v7, s[16:19], s38 offen lds
s_add_u32 m0, s50, 103424
s_nop 0
buffer_load_dwordx4 v8, s[16:19], s38 offen lds
s_waitcnt vmcnt(20)
s_barrier
s_add_u32 s37, s35, 12
s_and_b32 s37, s37, 15
s_mul_i32 s37, s37, 16384
s_add_u32 m0, s39, 0
s_nop 0
buffer_load_dwordx4 v3, s[8:11], s37 offen sc1 lds
buffer_load_dwordx4 v3, s[8:11], s37 offen offset:1024 sc1 lds
buffer_load_dwordx4 v3, s[8:11], s37 offen offset:2048 sc1 lds
buffer_load_dwordx4 v3, s[8:11], s37 offen offset:3072 sc1 lds
s_add_u32 s38, s35, 12
s_and_b32 s38, s38, 15
s_mul_i32 s38, s38, 458752
s_add_u32 m0, s50, 0
s_nop 0
buffer_load_dwordx4 v6, s[16:19], s38 offen lds
s_add_u32 m0, s50, 1024
s_nop 0
buffer_load_dwordx4 v7, s[16:19], s38 offen lds
s_add_u32 m0, s50, 2048
s_nop 0
buffer_load_dwordx4 v8, s[16:19], s38 offen lds
s_add_u32 m0, s50, 3072
s_add_u32 s38, s38, 114688
buffer_load_dwordx4 v6, s[16:19], s38 offen lds
s_add_u32 m0, s50, 4096
s_nop 0
buffer_load_dwordx4 v7, s[16:19], s38 offen lds
s_add_u32 m0, s50, 5120
s_nop 0
buffer_load_dwordx4 v8, s[16:19], s38 offen lds
s_waitcnt vmcnt(10)
s_barrier
v_permlane32_swap_b32 v96, v100
v_permlane32_swap_b32 v97, v101
v_permlane32_swap_b32 v98, v102
v_permlane32_swap_b32 v99, v103
v_add_f32 v96, v96, v100
v_add_f32 v97, v97, v101
v_add_f32 v98, v98, v102
v_add_f32 v99, v99, v103
s_nop 1
v_permlane16_swap_b32 v96, v97
v_permlane16_swap_b32 v98, v99
v_add_f32 v96, v96, v97
v_add_f32 v98, v98, v99
s_nop 1
v_add_f32_dpp v96, v96, v96 row_ror:8 row_mask:0xf bank_mask:0xf
v_add_f32_dpp v98, v98, v98 row_ror:8 row_mask:0xf bank_mask:0xf
ds_write_b32 v104, v96
ds_write_b32 v104, v98 offset:8
s_waitcnt lgkmcnt(0)
s_add_u32 s37, s35, 13
s_and_b32 s37, s37, 15
s_mul_i32 s37, s37, 16384
s_add_u32 m0, s39, 49152
s_nop 0
buffer_load_dwordx4 v3, s[8:11], s37 offen sc1 lds
s_load_dword s3, s[4:5], 1024
s_load_dword s3, s[4:5], 1088
s_load_dword s3, s[4:5], 1152
s_load_dword s3, s[4:5], 1216
buffer_load_dwordx4 v3, s[8:11], s37 offen offset:1024 sc1 lds
s_load_dword s3, s[4:5], 1280
s_load_dword s3, s[4:5], 1344
v_lshlrev_b32 v72, 16, v40
v_and_b32 v73, 0xffff0000, v40
v_lshlrev_b32 v74, 16, v41
buffer_load_dwordx4 v3, s[8:11], s37 offen offset:2048 sc1 lds
v_and_b32 v75, 0xffff0000, v41
v_lshlrev_b32 v76, 16, v42
v_and_b32 v77, 0xffff0000, v42
v_lshlrev_b32 v78, 16, v43
v_and_b32 v79, 0xffff0000, v43
buffer_load_dwordx4 v3, s[8:11], s37 offen offset:3072 sc1 lds
v_lshlrev_b32 v80, 16, v44
v_and_b32 v81, 0xffff0000, v44
v_lshlrev_b32 v82, 16, v45
v_and_b32 v83, 0xffff0000, v45
v_lshlrev_b32 v84, 16, v46
s_add_u32 s38, s35, 13
s_and_b32 s38, s38, 15
s_mul_i32 s38, s38, 458752
s_add_u32 m0, s50, 49152
s_nop 0
buffer_load_dwordx4 v6, s[16:19], s38 offen lds
v_and_b32 v85, 0xffff0000, v46
v_lshlrev_b32 v86, 16, v47
v_and_b32 v87, 0xffff0000, v47
v_add_f32 v72, v72, v80
v_add_f32 v73, v73, v81
s_add_u32 m0, s50, 50176
s_nop 0
buffer_load_dwordx4 v7, s[16:19], s38 offen lds
v_add_f32 v74, v74, v82
v_add_f32 v75, v75, v83
v_add_f32 v76, v76, v84
v_add_f32 v77, v77, v85
v_add_f32 v78, v78, v86
s_add_u32 m0, s50, 51200
s_nop 0
buffer_load_dwordx4 v8, s[16:19], s38 offen lds
v_add_f32 v79, v79, v87
v_lshlrev_b32 v80, 16, v48
v_and_b32 v81, 0xffff0000, v48
v_lshlrev_b32 v82, 16, v49
v_and_b32 v83, 0xffff0000, v49
s_add_u32 m0, s50, 52224
s_add_u32 s38, s38, 114688
buffer_load_dwordx4 v6, s[16:19], s38 offen lds
v_lshlrev_b32 v84, 16, v50
v_and_b32 v85, 0xffff0000, v50
v_lshlrev_b32 v86, 16, v51
v_and_b32 v87, 0xffff0000, v51
v_add_f32 v72, v72, v80
s_add_u32 m0, s50, 53248
s_nop 0
buffer_load_dwordx4 v7, s[16:19], s38 offen lds
s_add_u32 m0, s50, 54272
s_nop 0
buffer_load_dwordx4 v8, s[16:19], s38 offen lds
s_waitcnt vmcnt(10)
s_barrier
s_add_u32 s37, s35, 14
s_and_b32 s37, s37, 15
s_mul_i32 s37, s37, 16384
s_add_u32 m0, s39, 98304
s_nop 0
buffer_load_dwordx4 v3, s[8:11], s37 offen sc1 lds
s_load_dword s3, s[4:5], 1408
s_load_dword s3, s[4:5], 1472
s_load_dword s3, s[4:5], 1536
s_load_dword s3, s[4:5], 1600
s_load_dword s3, s[4:5], 1664
buffer_load_dwordx4 v3, s[8:11], s37 offen offset:1024 sc1 lds
s_load_dword s3, s[4:5], 1728
v_add_f32 v73, v73, v81
v_add_f32 v74, v74, v82
v_add_f32 v75, v75, v83
v_add_f32 v76, v76, v84
buffer_load_dwordx4 v3, s[8:11], s37 offen offset:2048 sc1 lds
v_add_f32 v77, v77, v85
v_add_f32 v78, v78, v86
v_add_f32 v79, v79, v87
v_lshlrev_b32 v80, 16, v52
v_and_b32 v81, 0xffff0000, v52
buffer_load_dwordx4 v3, s[8:11], s37 offen offset:3072 sc1 lds
v_lshlrev_b32 v82, 16, v53
v_and_b32 v83, 0xffff0000, v53
v_lshlrev_b32 v84, 16, v54
v_and_b32 v85, 0xffff0000, v54
v_lshlrev_b32 v86, 16, v55
s_add_u32 s38, s35, 14
s_and_b32 s38, s38, 15
s_mul_i32 s38, s38, 458752
s_add_u32 m0, s50, 98304
s_nop 0
buffer_load_dwordx4 v6, s[16:19], s38 offen lds
v_and_b32 v87, 0xffff0000, v55
v_add_f32 v72, v72, v80
v_add_f32 v73, v73, v81
v_add_f32 v74, v74, v82
v_add_f32 v75, v75, v83
s_add_u32 m0, s50, 99328
s_nop 0
buffer_load_dwordx4 v7, s[16:19], s38 offen lds
v_add_f32 v76, v76, v84
v_add_f32 v77, v77, v85
v_add_f32 v78, v78, v86
v_add_f32 v79, v79, v87
v_lshlrev_b32 v80, 16, v56
s_add_u32 m0, s50, 100352
s_nop 0
buffer_load_dwordx4 v8, s[16:19], s38 offen lds
v_and_b32 v81, 0xffff0000, v56
v_lshlrev_b32 v82, 16, v57
v_and_b32 v83, 0xffff0000, v57
v_lshlrev_b32 v84, 16, v58
v_and_b32 v85, 0xffff0000, v58
s_add_u32 m0, s50, 101376
s_add_u32 s38, s38, 114688
buffer_load_dwordx4 v6, s[16:19], s38 offen lds
v_lshlrev_b32 v86, 16, v59
v_and_b32 v87, 0xffff0000, v59
v_add_f32 v72, v72, v80
v_add_f32 v73, v73, v81
v_add_f32 v74, v74, v82
s_add_u32 m0, s50, 102400
s_nop 0
buffer_load_dwordx4 v7, s[16:19], s38 offen lds
s_add_u32 m0, s50, 103424
s_nop 0
buffer_load_dwordx4 v8, s[16:19], s38 offen lds
s_waitcnt vmcnt(10)
s_barrier
s_add_u32 s37, s35, 15
s_and_b32 s37, s37, 15
s_mul_i32 s37, s37, 16384
s_add_u32 m0, s39, 0
s_nop 0
buffer_load_dwordx4 v3, s[8:11], s37 offen sc1 lds
v_add_f32 v75, v75, v83
v_add_f32 v76, v76, v84
v_add_f32 v77, v77, v85
v_add_f32 v78, v78, v86
buffer_load_dwordx4 v3, s[8:11], s37 offen offset:1024 sc1 lds
v_add_f32 v79, v79, v87
v_lshlrev_b32 v80, 16, v60
v_and_b32 v81, 0xffff0000, v60
v_lshlrev_b32 v82, 16, v61
buffer_load_dwordx4 v3, s[8:11], s37 offen offset:2048 sc1 lds
v_and_b32 v83, 0xffff0000, v61
v_lshlrev_b32 v84, 16, v62
v_and_b32 v85, 0xffff0000, v62
v_lshlrev_b32 v86, 16, v63
buffer_load_dwordx4 v3, s[8:11], s37 offen offset:3072 sc1 lds
v_and_b32 v87, 0xffff0000, v63
v_add_f32 v72, v72, v80
v_add_f32 v73, v73, v81
v_add_f32 v74, v74, v82
s_add_u32 s38, s35, 15
s_and_b32 s38, s38, 15
s_mul_i32 s38, s38, 458752
s_add_u32 m0, s50, 0
s_nop 0
buffer_load_dwordx4 v6, s[16:19], s38 offen lds
v_add_f32 v75, v75, v83
v_add_f32 v76, v76, v84
v_add_f32 v77, v77, v85
v_add_f32 v78, v78, v86
s_add_u32 m0, s50, 1024
s_nop 0
buffer_load_dwordx4 v7, s[16:19], s38 offen lds
v_add_f32 v79, v79, v87
v_lshlrev_b32 v80, 16, v64
v_and_b32 v81, 0xffff0000, v64
v_lshlrev_b32 v82, 16, v65
s_add_u32 m0, s50, 2048
s_nop 0
buffer_load_dwordx4 v8, s[16:19], s38 offen lds
v_and_b32 v83, 0xffff0000, v65
v_lshlrev_b32 v84, 16, v66
v_and_b32 v85, 0xffff0000, v66
v_lshlrev_b32 v86, 16, v67
s_add_u32 m0, s50, 3072
s_add_u32 s38, s38, 114688
buffer_load_dwordx4 v6, s[16:19], s38 offen lds
v_and_b32 v87, 0xffff0000, v67
v_add_f32 v72, v72, v80
v_add_f32 v73, v73, v81
v_add_f32 v74, v74, v82
v_add_f32 v75, v75, v83
s_add_u32 m0, s50, 4096
s_nop 0
buffer_load_dwordx4 v7, s[16:19], s38 offen lds
s_add_u32 m0, s50, 5120
s_nop 0
buffer_load_dwordx4 v8, s[16:19], s38 offen lds
s_waitcnt vmcnt(10)
s_barrier
s_add_u32 s37, s35, 0
s_and_b32 s37, s37, 15
s_mul_i32 s37, s37, 16384
s_add_u32 m0, s39, 49152
s_nop 0
buffer_load_dwordx4 v3, s[8:11], s37 offen sc1 lds
v_add_f32 v76, v76, v84
v_add_f32 v77, v77, v85
v_add_f32 v78, v78, v86
buffer_load_dwordx4 v3, s[8:11], s37 offen offset:1024 sc1 lds
v_add_f32 v79, v79, v87
v_lshlrev_b32 v80, 16, v68
v_and_b32 v81, 0xffff0000, v68
buffer_load_dwordx4 v3, s[8:11], s37 offen offset:2048 sc1 lds
v_lshlrev_b32 v82, 16, v69
v_and_b32 v83, 0xffff0000, v69
v_lshlrev_b32 v84, 16, v70
v_and_b32 v85, 0xffff0000, v70
buffer_load_dwordx4 v3, s[8:11], s37 offen offset:3072 sc1 lds
v_lshlrev_b32 v86, 16, v71
v_and_b32 v87, 0xffff0000, v71
v_add_f32 v72, v72, v80
s_add_u32 s38, s35, 0
s_and_b32 s38, s38, 15
s_mul_i32 s38, s38, 458752
s_add_u32 m0, s40, 49152
s_nop 0
buffer_load_dwordx4 v4, s[12:15], s38 offen lds
v_add_f32 v73, v73, v81
v_add_f32 v74, v74, v82
v_add_f32 v75, v75, v83
v_add_f32 v76, v76, v84
s_add_u32 m0, s40, 50176
s_nop 0
buffer_load_dwordx4 v5, s[12:15], s38 offen lds
v_add_f32 v77, v77, v85
v_add_f32 v78, v78, v86
v_add_f32 v79, v79, v87
s_add_u32 m0, s40, 51200
s_add_u32 s38, s38, 57344
buffer_load_dwordx4 v4, s[12:15], s38 offen lds
s_nop 0
v_permlane32_swap_b32 v72, v76
v_permlane32_swap_b32 v73, v77
s_add_u32 m0, s40, 52224
s_nop 0
buffer_load_dwordx4 v5, s[12:15], s38 offen lds
v_permlane32_swap_b32 v74, v78
v_permlane32_swap_b32 v75, v79
v_add_f32 v72, v72, v76
v_add_f32 v73, v73, v77
s_add_u32 m0, s40, 53248
s_add_u32 s38, s38, 57344
buffer_load_dwordx4 v4, s[12:15], s38 offen lds
v_add_f32 v74, v74, v78
v_add_f32 v75, v75, v79
s_nop 0
s_add_u32 m0, s40, 54272
s_nop 0
buffer_load_dwordx4 v5, s[12:15], s38 offen lds
v_permlane16_swap_b32 v72, v74
v_permlane16_swap_b32 v73, v75
v_add_f32 v72, v72, v74
v_add_f32 v73, v73, v75
s_add_u32 m0, s40, 55296
s_add_u32 s38, s38, 57344
buffer_load_dwordx4 v4, s[12:15], s38 offen lds
s_add_u32 m0, s40, 56320
s_nop 0
buffer_load_dwordx4 v5, s[12:15], s38 offen lds
s_waitcnt vmcnt(12)
s_barrier
s_lshl_b32 s43, s47, 9
s_add_u32 s43, s43, 153600
v_and_b32 v80, 15, v1
v_lshl_add_u32 v80, v80, 5, s43
v_lshrrev_b32 v81, 4, v1
v_lshl_add_u32 v80, v81, 3, v80
ds_write_b64 v80, v[72:73]
s_waitcnt lgkmcnt(0)
s_add_u32 s37, s35, 1
s_and_b32 s37, s37, 15
s_mul_i32 s37, s37, 16384
s_add_u32 m0, s39, 98304
s_nop 0
buffer_load_dwordx4 v3, s[8:11], s37 offen sc1 lds
s_bfe_u32 s61, s35, 0x10002
s_lshr_b32 s60, s35, 3
s_lshl_b32 s60, s60, 2
buffer_load_dwordx4 v3, s[8:11], s37 offen offset:1024 sc1 lds
s_and_b32 s43, s35, 3
s_add_u32 s60, s60, s43
s_lshl_b32 s43, s60, 8
buffer_load_dwordx4 v3, s[8:11], s37 offen offset:2048 sc1 lds
s_add_u32 s28, s76, s43
s_addc_u32 s29, s77, 0
s_mov_b32 s30, 7338240
buffer_load_dwordx4 v3, s[8:11], s37 offen offset:3072 sc1 lds
s_mov_b32 s31, 0x20000
s_mul_i32 s52, s61, 196608
s_mul_i32 s53, s61, 1572864
s_add_u32 s38, s35, 1
s_and_b32 s38, s38, 15
s_mul_i32 s38, s38, 458752
s_add_u32 m0, s40, 98304
s_nop 0
buffer_load_dwordx4 v4, s[12:15], s38 offen lds
s_mul_i32 s90, s61, 163840
s_mul_i32 s91, s61, 1310720
s_and_b32 s43, s35, 3
s_add_u32 m0, s40, 99328
s_nop 0
buffer_load_dwordx4 v5, s[12:15], s38 offen lds
s_mul_i32 s32, s43, 3
s_mul_i32 s33, s43, 10
s_lshr_b32 s33, s33, 2
s_add_u32 m0, s40, 100352
s_add_u32 s38, s38, 57344
buffer_load_dwordx4 v4, s[12:15], s38 offen lds
s_lshl_b32 s51, s47, 11
s_lshl_b32 s44, s47, 15
v_lshrrev_b32 v122, 4, v1
s_add_u32 m0, s40, 101376
s_nop 0
buffer_load_dwordx4 v5, s[12:15], s38 offen lds
v_lshlrev_b32 v123, 1, v122
v_and_b32 v23, 15, v1
v_xor_b32 v23, v23, v123
s_add_u32 m0, s40, 102400
s_add_u32 s38, s38, 57344
buffer_load_dwordx4 v4, s[12:15], s38 offen lds
v_lshlrev_b32 v23, 4, v23
v_mul_u32_u24 v122, 2048, v122
v_add_u32 v23, v23, v122
s_add_u32 m0, s40, 103424
s_nop 0
buffer_load_dwordx4 v5, s[12:15], s38 offen lds
v_add_u32 v23, s44, v23
v_xor_b32 v24, 128, v23
v_add_u32 v24, 8192, v24
s_add_u32 m0, s40, 104448
s_add_u32 s38, s38, 57344
buffer_load_dwordx4 v4, s[12:15], s38 offen lds
s_add_u32 m0, s40, 105472
s_nop 0
buffer_load_dwordx4 v5, s[12:15], s38 offen lds
s_waitcnt vmcnt(12)
s_barrier
ds_read_b128 v[28:31], v9 offset:49152
ds_read_b64_tr_b16 v[44:45], v15 offset:0
ds_read_b64_tr_b16 v[46:47], v15 offset:4096
ds_read_b64_tr_b16 v[48:49], v16 offset:0
ds_read_b64_tr_b16 v[50:51], v16 offset:4096
ds_read_b64_tr_b16 v[52:53], v17 offset:0
ds_read_b64_tr_b16 v[54:55], v17 offset:4096
ds_read_b64_tr_b16 v[56:57], v18 offset:0
ds_read_b64_tr_b16 v[58:59], v18 offset:4096
ds_read_b64_tr_b16 v[60:61], v15 offset:16384
ds_read_b64_tr_b16 v[62:63], v15 offset:20480
ds_read_b64_tr_b16 v[64:65], v16 offset:16384
ds_read_b64_tr_b16 v[66:67], v16 offset:20480
ds_read_b64_tr_b16 v[68:69], v17 offset:16384
ds_read_b64_tr_b16 v[70:71], v17 offset:20480
ds_read_b64_tr_b16 v[72:73], v18 offset:16384
ds_read_b64_tr_b16 v[74:75], v18 offset:20480
ds_read_b128 v[32:35], v9 offset:50176
ds_read_b128 v[36:39], v9 offset:51200
ds_read_b128 v[40:43], v9 offset:52224
s_waitcnt lgkmcnt(0)
v_mfma_f32_16x16x32_bf16 v[124:127], v[44:47], v[28:31], 0
ds_read_b128 v[76:79], v9 offset:57344
v_mfma_f32_16x16x32_bf16 v[128:131], v[48:51], v[28:31], 0
ds_read_b64_tr_b16 v[92:93], v15 offset:8192
v_mfma_f32_16x16x32_bf16 v[132:135], v[52:55], v[28:31], 0
ds_read_b64_tr_b16 v[94:95], v15 offset:12288
v_mfma_f32_16x16x32_bf16 v[136:139], v[56:59], v[28:31], 0
ds_read_b64_tr_b16 v[96:97], v16 offset:8192
v_mfma_f32_16x16x32_bf16 v[140:143], v[60:63], v[28:31], 0
ds_read_b64_tr_b16 v[98:99], v16 offset:12288
v_mfma_f32_16x16x32_bf16 v[144:147], v[64:67], v[28:31], 0
ds_read_b64_tr_b16 v[100:101], v17 offset:8192
v_mfma_f32_16x16x32_bf16 v[148:151], v[68:71], v[28:31], 0
ds_read_b64_tr_b16 v[102:103], v17 offset:12288
v_mfma_f32_16x16x32_bf16 v[152:155], v[72:75], v[28:31], 0
ds_read_b64_tr_b16 v[104:105], v18 offset:8192
v_mfma_f32_16x16x32_bf16 v[184:187], v[72:75], v[32:35], 0
ds_read_b64_tr_b16 v[106:107], v18 offset:12288
v_mfma_f32_16x16x32_bf16 v[180:183], v[68:71], v[32:35], 0
ds_read_b64_tr_b16 v[108:109], v15 offset:24576
v_mfma_f32_16x16x32_bf16 v[176:179], v[64:67], v[32:35], 0
ds_read_b64_tr_b16 v[110:111], v15 offset:28672
v_mfma_f32_16x16x32_bf16 v[172:175], v[60:63], v[32:35], 0
ds_read_b64_tr_b16 v[112:113], v16 offset:24576
v_mfma_f32_16x16x32_bf16 v[168:171], v[56:59], v[32:35], 0
ds_read_b64_tr_b16 v[114:115], v16 offset:28672
v_mfma_f32_16x16x32_bf16 v[164:167], v[52:55], v[32:35], 0
ds_read_b64_tr_b16 v[116:117], v17 offset:24576
v_mfma_f32_16x16x32_bf16 v[160:163], v[48:51], v[32:35], 0
ds_read_b64_tr_b16 v[118:119], v17 offset:28672
v_mfma_f32_16x16x32_bf16 v[156:159], v[44:47], v[32:35], 0
ds_read_b64_tr_b16 v[120:121], v18 offset:24576
v_mfma_f32_16x16x32_bf16 v[188:191], v[44:47], v[36:39], 0
ds_read_b64_tr_b16 v[122:123], v18 offset:28672
v_mfma_f32_16x16x32_bf16 v[192:195], v[48:51], v[36:39], 0
ds_read_b128 v[80:83], v9 offset:58368
v_mfma_f32_16x16x32_bf16 v[196:199], v[52:55], v[36:39], 0
ds_read_b128 v[84:87], v9 offset:59392
v_mfma_f32_16x16x32_bf16 v[200:203], v[56:59], v[36:39], 0
ds_read_b128 v[88:91], v9 offset:60416
v_mfma_f32_16x16x32_bf16 v[204:207], v[60:63], v[36:39], 0
v_mfma_f32_16x16x32_bf16 v[208:211], v[64:67], v[36:39], 0
v_mfma_f32_16x16x32_bf16 v[212:215], v[68:71], v[36:39], 0
v_mfma_f32_16x16x32_bf16 v[216:219], v[72:75], v[36:39], 0
v_mfma_f32_16x16x32_bf16 v[248:251], v[72:75], v[40:43], 0
v_mfma_f32_16x16x32_bf16 v[244:247], v[68:71], v[40:43], 0
v_mfma_f32_16x16x32_bf16 v[240:243], v[64:67], v[40:43], 0
s_branch Lov_15
.p2align 12
.fill 112, 4, 0xbf800000
Lst_15_0:
s_branch Lwr_156
Lst_15_1:
s_branch Lwr_168
s_nop 0
Lov_15:
v_mfma_f32_16x16x32_bf16 v[236:239], v[60:63], v[40:43], 0
v_mfma_f32_16x16x32_bf16 v[232:235], v[56:59], v[40:43], 0
v_mfma_f32_16x16x32_bf16 v[228:231], v[52:55], v[40:43], 0
v_mfma_f32_16x16x32_bf16 v[224:227], v[48:51], v[40:43], 0
v_mfma_f32_16x16x32_bf16 v[220:223], v[44:47], v[40:43], 0
s_waitcnt vmcnt(0)
s_waitcnt lgkmcnt(0)
s_barrier
v_mfma_f32_16x16x32_bf16 v[124:127], v[92:95], v[76:79], v[124:127]
ds_read_b128 v[28:31], v10 offset:0
v_mfma_f32_16x16x32_bf16 v[128:131], v[96:99], v[76:79], v[128:131]
ds_read_b64_tr_b16 v[44:45], v19 offset:0
v_mfma_f32_16x16x32_bf16 v[132:135], v[100:103], v[76:79], v[132:135]
ds_read_b64_tr_b16 v[46:47], v19 offset:4096
v_mfma_f32_16x16x32_bf16 v[136:139], v[104:107], v[76:79], v[136:139]
ds_read_b64_tr_b16 v[48:49], v20 offset:0
v_mfma_f32_16x16x32_bf16 v[140:143], v[108:111], v[76:79], v[140:143]
ds_read_b64_tr_b16 v[50:51], v20 offset:4096
v_mfma_f32_16x16x32_bf16 v[144:147], v[112:115], v[76:79], v[144:147]
ds_read_b64_tr_b16 v[52:53], v21 offset:0
v_mfma_f32_16x16x32_bf16 v[148:151], v[116:119], v[76:79], v[148:151]
ds_read_b64_tr_b16 v[54:55], v21 offset:4096
v_mfma_f32_16x16x32_bf16 v[152:155], v[120:123], v[76:79], v[152:155]
ds_read_b64_tr_b16 v[56:57], v22 offset:0
v_mfma_f32_16x16x32_bf16 v[184:187], v[120:123], v[80:83], v[184:187]
ds_read_b64_tr_b16 v[58:59], v22 offset:4096
v_mfma_f32_16x16x32_bf16 v[180:183], v[116:119], v[80:83], v[180:183]
ds_read_b64_tr_b16 v[60:61], v19 offset:16384
v_mfma_f32_16x16x32_bf16 v[176:179], v[112:115], v[80:83], v[176:179]
ds_read_b64_tr_b16 v[62:63], v19 offset:20480
v_mfma_f32_16x16x32_bf16 v[172:175], v[108:111], v[80:83], v[172:175]
ds_read_b64_tr_b16 v[64:65], v20 offset:16384
v_mfma_f32_16x16x32_bf16 v[168:171], v[104:107], v[80:83], v[168:171]
ds_read_b64_tr_b16 v[66:67], v20 offset:20480
v_mfma_f32_16x16x32_bf16 v[164:167], v[100:103], v[80:83], v[164:167]
ds_read_b64_tr_b16 v[68:69], v21 offset:16384
v_mfma_f32_16x16x32_bf16 v[160:163], v[96:99], v[80:83], v[160:163]
ds_read_b64_tr_b16 v[70:71], v21 offset:20480
v_mfma_f32_16x16x32_bf16 v[156:159], v[92:95], v[80:83], v[156:159]
ds_read_b64_tr_b16 v[72:73], v22 offset:16384
v_mfma_f32_16x16x32_bf16 v[188:191], v[92:95], v[84:87], v[188:191]
ds_read_b64_tr_b16 v[74:75], v22 offset:20480
v_mfma_f32_16x16x32_bf16 v[192:195], v[96:99], v[84:87], v[192:195]
ds_read_b128 v[32:35], v10 offset:1024
v_mfma_f32_16x16x32_bf16 v[196:199], v[100:103], v[84:87], v[196:199]
ds_read_b128 v[36:39], v10 offset:2048
v_mfma_f32_16x16x32_bf16 v[200:203], v[104:107], v[84:87], v[200:203]
ds_read_b128 v[40:43], v10 offset:3072
v_mfma_f32_16x16x32_bf16 v[204:207], v[108:111], v[84:87], v[204:207]
v_mfma_f32_16x16x32_bf16 v[208:211], v[112:115], v[84:87], v[208:211]
v_mfma_f32_16x16x32_bf16 v[212:215], v[116:119], v[84:87], v[212:215]
v_mfma_f32_16x16x32_bf16 v[216:219], v[120:123], v[84:87], v[216:219]
v_mfma_f32_16x16x32_bf16 v[248:251], v[120:123], v[88:91], v[248:251]
v_mfma_f32_16x16x32_bf16 v[244:247], v[116:119], v[88:91], v[244:247]
v_mfma_f32_16x16x32_bf16 v[240:243], v[112:115], v[88:91], v[240:243]
v_mfma_f32_16x16x32_bf16 v[236:239], v[108:111], v[88:91], v[236:239]
v_mfma_f32_16x16x32_bf16 v[232:235], v[104:107], v[88:91], v[232:235]
v_mfma_f32_16x16x32_bf16 v[228:231], v[100:103], v[88:91], v[228:231]
v_mfma_f32_16x16x32_bf16 v[224:227], v[96:99], v[88:91], v[224:227]
v_mfma_f32_16x16x32_bf16 v[220:223], v[92:95], v[88:91], v[220:223]
s_mov_b32 s41, 5
Lk3l_132:
s_waitcnt lgkmcnt(0)
v_mfma_f32_16x16x32_bf16 v[124:127], v[44:47], v[28:31], v[124:127]
ds_read_b128 v[76:79], v10 offset:8192
v_mfma_f32_16x16x32_bf16 v[128:131], v[48:51], v[28:31], v[128:131]
ds_read_b64_tr_b16 v[92:93], v19 offset:8192
v_mfma_f32_16x16x32_bf16 v[132:135], v[52:55], v[28:31], v[132:135]
ds_read_b64_tr_b16 v[94:95], v19 offset:12288
v_mfma_f32_16x16x32_bf16 v[136:139], v[56:59], v[28:31], v[136:139]
ds_read_b64_tr_b16 v[96:97], v20 offset:8192
v_mfma_f32_16x16x32_bf16 v[140:143], v[60:63], v[28:31], v[140:143]
ds_read_b64_tr_b16 v[98:99], v20 offset:12288
v_mfma_f32_16x16x32_bf16 v[144:147], v[64:67], v[28:31], v[144:147]
ds_read_b64_tr_b16 v[100:101], v21 offset:8192
v_mfma_f32_16x16x32_bf16 v[148:151], v[68:71], v[28:31], v[148:151]
ds_read_b64_tr_b16 v[102:103], v21 offset:12288
v_mfma_f32_16x16x32_bf16 v[152:155], v[72:75], v[28:31], v[152:155]
ds_read_b64_tr_b16 v[104:105], v22 offset:8192
v_mfma_f32_16x16x32_bf16 v[184:187], v[72:75], v[32:35], v[184:187]
ds_read_b64_tr_b16 v[106:107], v22 offset:12288
v_mfma_f32_16x16x32_bf16 v[180:183], v[68:71], v[32:35], v[180:183]
ds_read_b64_tr_b16 v[108:109], v19 offset:24576
v_mfma_f32_16x16x32_bf16 v[176:179], v[64:67], v[32:35], v[176:179]
ds_read_b64_tr_b16 v[110:111], v19 offset:28672
v_mfma_f32_16x16x32_bf16 v[172:175], v[60:63], v[32:35], v[172:175]
ds_read_b64_tr_b16 v[112:113], v20 offset:24576
v_mfma_f32_16x16x32_bf16 v[168:171], v[56:59], v[32:35], v[168:171]
ds_read_b64_tr_b16 v[114:115], v20 offset:28672
v_mfma_f32_16x16x32_bf16 v[164:167], v[52:55], v[32:35], v[164:167]
ds_read_b64_tr_b16 v[116:117], v21 offset:24576
v_mfma_f32_16x16x32_bf16 v[160:163], v[48:51], v[32:35], v[160:163]
ds_read_b64_tr_b16 v[118:119], v21 offset:28672
v_mfma_f32_16x16x32_bf16 v[156:159], v[44:47], v[32:35], v[156:159]
ds_read_b64_tr_b16 v[120:121], v22 offset:24576
v_mfma_f32_16x16x32_bf16 v[188:191], v[44:47], v[36:39], v[188:191]
ds_read_b64_tr_b16 v[122:123], v22 offset:28672
v_mfma_f32_16x16x32_bf16 v[192:195], v[48:51], v[36:39], v[192:195]
ds_read_b128 v[80:83], v10 offset:9216
v_mfma_f32_16x16x32_bf16 v[196:199], v[52:55], v[36:39], v[196:199]
ds_read_b128 v[84:87], v10 offset:10240
v_mfma_f32_16x16x32_bf16 v[200:203], v[56:59], v[36:39], v[200:203]
ds_read_b128 v[88:91], v10 offset:11264
v_mfma_f32_16x16x32_bf16 v[204:207], v[60:63], v[36:39], v[204:207]
v_mfma_f32_16x16x32_bf16 v[208:211], v[64:67], v[36:39], v[208:211]
v_mfma_f32_16x16x32_bf16 v[212:215], v[68:71], v[36:39], v[212:215]
v_mfma_f32_16x16x32_bf16 v[216:219], v[72:75], v[36:39], v[216:219]
v_mfma_f32_16x16x32_bf16 v[248:251], v[72:75], v[40:43], v[248:251]
v_mfma_f32_16x16x32_bf16 v[244:247], v[68:71], v[40:43], v[244:247]
v_mfma_f32_16x16x32_bf16 v[240:243], v[64:67], v[40:43], v[240:243]
v_mfma_f32_16x16x32_bf16 v[236:239], v[60:63], v[40:43], v[236:239]
v_mfma_f32_16x16x32_bf16 v[232:235], v[56:59], v[40:43], v[232:235]
v_mfma_f32_16x16x32_bf16 v[228:231], v[52:55], v[40:43], v[228:231]
v_mfma_f32_16x16x32_bf16 v[224:227], v[48:51], v[40:43], v[224:227]
v_mfma_f32_16x16x32_bf16 v[220:223], v[44:47], v[40:43], v[220:223]
s_waitcnt lgkmcnt(0)
s_barrier
v_mfma_f32_16x16x32_bf16 v[124:127], v[92:95], v[76:79], v[124:127]
ds_read_b128 v[28:31], v9 offset:0
v_mfma_f32_16x16x32_bf16 v[128:131], v[96:99], v[76:79], v[128:131]
ds_read_b64_tr_b16 v[44:45], v11 offset:0
v_mfma_f32_16x16x32_bf16 v[132:135], v[100:103], v[76:79], v[132:135]
ds_read_b64_tr_b16 v[46:47], v11 offset:4096
v_mfma_f32_16x16x32_bf16 v[136:139], v[104:107], v[76:79], v[136:139]
ds_read_b64_tr_b16 v[48:49], v12 offset:0
v_mfma_f32_16x16x32_bf16 v[140:143], v[108:111], v[76:79], v[140:143]
ds_read_b64_tr_b16 v[50:51], v12 offset:4096
v_mfma_f32_16x16x32_bf16 v[144:147], v[112:115], v[76:79], v[144:147]
ds_read_b64_tr_b16 v[52:53], v13 offset:0
v_mfma_f32_16x16x32_bf16 v[148:151], v[116:119], v[76:79], v[148:151]
ds_read_b64_tr_b16 v[54:55], v13 offset:4096
v_mfma_f32_16x16x32_bf16 v[152:155], v[120:123], v[76:79], v[152:155]
ds_read_b64_tr_b16 v[56:57], v14 offset:0
v_mfma_f32_16x16x32_bf16 v[184:187], v[120:123], v[80:83], v[184:187]
ds_read_b64_tr_b16 v[58:59], v14 offset:4096
v_mfma_f32_16x16x32_bf16 v[180:183], v[116:119], v[80:83], v[180:183]
ds_read_b64_tr_b16 v[60:61], v11 offset:16384
v_mfma_f32_16x16x32_bf16 v[176:179], v[112:115], v[80:83], v[176:179]
ds_read_b64_tr_b16 v[62:63], v11 offset:20480
v_mfma_f32_16x16x32_bf16 v[172:175], v[108:111], v[80:83], v[172:175]
ds_read_b64_tr_b16 v[64:65], v12 offset:16384
v_mfma_f32_16x16x32_bf16 v[168:171], v[104:107], v[80:83], v[168:171]
ds_read_b64_tr_b16 v[66:67], v12 offset:20480
v_mfma_f32_16x16x32_bf16 v[164:167], v[100:103], v[80:83], v[164:167]
ds_read_b64_tr_b16 v[68:69], v13 offset:16384
v_mfma_f32_16x16x32_bf16 v[160:163], v[96:99], v[80:83], v[160:163]
ds_read_b64_tr_b16 v[70:71], v13 offset:20480
v_mfma_f32_16x16x32_bf16 v[156:159], v[92:95], v[80:83], v[156:159]
ds_read_b64_tr_b16 v[72:73], v14 offset:16384
v_mfma_f32_16x16x32_bf16 v[188:191], v[92:95], v[84:87], v[188:191]
ds_read_b64_tr_b16 v[74:75], v14 offset:20480
v_mfma_f32_16x16x32_bf16 v[192:195], v[96:99], v[84:87], v[192:195]
ds_read_b128 v[32:35], v9 offset:1024
v_mfma_f32_16x16x32_bf16 v[196:199], v[100:103], v[84:87], v[196:199]
ds_read_b128 v[36:39], v9 offset:2048
v_mfma_f32_16x16x32_bf16 v[200:203], v[104:107], v[84:87], v[200:203]
ds_read_b128 v[40:43], v9 offset:3072
v_mfma_f32_16x16x32_bf16 v[204:207], v[108:111], v[84:87], v[204:207]
v_mfma_f32_16x16x32_bf16 v[208:211], v[112:115], v[84:87], v[208:211]
v_mfma_f32_16x16x32_bf16 v[212:215], v[116:119], v[84:87], v[212:215]
v_mfma_f32_16x16x32_bf16 v[216:219], v[120:123], v[84:87], v[216:219]
v_mfma_f32_16x16x32_bf16 v[248:251], v[120:123], v[88:91], v[248:251]
v_mfma_f32_16x16x32_bf16 v[244:247], v[116:119], v[88:91], v[244:247]
v_mfma_f32_16x16x32_bf16 v[240:243], v[112:115], v[88:91], v[240:243]
v_mfma_f32_16x16x32_bf16 v[236:239], v[108:111], v[88:91], v[236:239]
v_mfma_f32_16x16x32_bf16 v[232:235], v[104:107], v[88:91], v[232:235]
v_mfma_f32_16x16x32_bf16 v[228:231], v[100:103], v[88:91], v[228:231]
v_mfma_f32_16x16x32_bf16 v[224:227], v[96:99], v[88:91], v[224:227]
v_mfma_f32_16x16x32_bf16 v[220:223], v[92:95], v[88:91], v[220:223]
s_waitcnt lgkmcnt(0)
v_mfma_f32_16x16x32_bf16 v[124:127], v[44:47], v[28:31], v[124:127]
ds_read_b128 v[76:79], v9 offset:8192
v_mfma_f32_16x16x32_bf16 v[128:131], v[48:51], v[28:31], v[128:131]
ds_read_b64_tr_b16 v[92:93], v11 offset:8192
v_mfma_f32_16x16x32_bf16 v[132:135], v[52:55], v[28:31], v[132:135]
ds_read_b64_tr_b16 v[94:95], v11 offset:12288
v_mfma_f32_16x16x32_bf16 v[136:139], v[56:59], v[28:31], v[136:139]
ds_read_b64_tr_b16 v[96:97], v12 offset:8192
v_mfma_f32_16x16x32_bf16 v[140:143], v[60:63], v[28:31], v[140:143]
ds_read_b64_tr_b16 v[98:99], v12 offset:12288
v_mfma_f32_16x16x32_bf16 v[144:147], v[64:67], v[28:31], v[144:147]
ds_read_b64_tr_b16 v[100:101], v13 offset:8192
v_mfma_f32_16x16x32_bf16 v[148:151], v[68:71], v[28:31], v[148:151]
ds_read_b64_tr_b16 v[102:103], v13 offset:12288
v_mfma_f32_16x16x32_bf16 v[152:155], v[72:75], v[28:31], v[152:155]
ds_read_b64_tr_b16 v[104:105], v14 offset:8192
v_mfma_f32_16x16x32_bf16 v[184:187], v[72:75], v[32:35], v[184:187]
ds_read_b64_tr_b16 v[106:107], v14 offset:12288
v_mfma_f32_16x16x32_bf16 v[180:183], v[68:71], v[32:35], v[180:183]
ds_read_b64_tr_b16 v[108:109], v11 offset:24576
v_mfma_f32_16x16x32_bf16 v[176:179], v[64:67], v[32:35], v[176:179]
ds_read_b64_tr_b16 v[110:111], v11 offset:28672
v_mfma_f32_16x16x32_bf16 v[172:175], v[60:63], v[32:35], v[172:175]
ds_read_b64_tr_b16 v[112:113], v12 offset:24576
v_mfma_f32_16x16x32_bf16 v[168:171], v[56:59], v[32:35], v[168:171]
ds_read_b64_tr_b16 v[114:115], v12 offset:28672
v_mfma_f32_16x16x32_bf16 v[164:167], v[52:55], v[32:35], v[164:167]
ds_read_b64_tr_b16 v[116:117], v13 offset:24576
v_mfma_f32_16x16x32_bf16 v[160:163], v[48:51], v[32:35], v[160:163]
ds_read_b64_tr_b16 v[118:119], v13 offset:28672
v_mfma_f32_16x16x32_bf16 v[156:159], v[44:47], v[32:35], v[156:159]
ds_read_b64_tr_b16 v[120:121], v14 offset:24576
v_mfma_f32_16x16x32_bf16 v[188:191], v[44:47], v[36:39], v[188:191]
ds_read_b64_tr_b16 v[122:123], v14 offset:28672
v_mfma_f32_16x16x32_bf16 v[192:195], v[48:51], v[36:39], v[192:195]
ds_read_b128 v[80:83], v9 offset:9216
v_mfma_f32_16x16x32_bf16 v[196:199], v[52:55], v[36:39], v[196:199]
ds_read_b128 v[84:87], v9 offset:10240
v_mfma_f32_16x16x32_bf16 v[200:203], v[56:59], v[36:39], v[200:203]
ds_read_b128 v[88:91], v9 offset:11264
v_mfma_f32_16x16x32_bf16 v[204:207], v[60:63], v[36:39], v[204:207]
v_mfma_f32_16x16x32_bf16 v[208:211], v[64:67], v[36:39], v[208:211]
v_mfma_f32_16x16x32_bf16 v[212:215], v[68:71], v[36:39], v[212:215]
v_mfma_f32_16x16x32_bf16 v[216:219], v[72:75], v[36:39], v[216:219]
v_mfma_f32_16x16x32_bf16 v[248:251], v[72:75], v[40:43], v[248:251]
v_mfma_f32_16x16x32_bf16 v[244:247], v[68:71], v[40:43], v[244:247]
v_mfma_f32_16x16x32_bf16 v[240:243], v[64:67], v[40:43], v[240:243]
v_mfma_f32_16x16x32_bf16 v[236:239], v[60:63], v[40:43], v[236:239]
v_mfma_f32_16x16x32_bf16 v[232:235], v[56:59], v[40:43], v[232:235]
v_mfma_f32_16x16x32_bf16 v[228:231], v[52:55], v[40:43], v[228:231]
v_mfma_f32_16x16x32_bf16 v[224:227], v[48:51], v[40:43], v[224:227]
v_mfma_f32_16x16x32_bf16 v[220:223], v[44:47], v[40:43], v[220:223]
s_waitcnt lgkmcnt(0)
s_barrier
v_mfma_f32_16x16x32_bf16 v[124:127], v[92:95], v[76:79], v[124:127]
ds_read_b128 v[28:31], v9 offset:49152
v_mfma_f32_16x16x32_bf16 v[128:131], v[96:99], v[76:79], v[128:131]
ds_read_b64_tr_b16 v[44:45], v15 offset:0
v_mfma_f32_16x16x32_bf16 v[132:135], v[100:103], v[76:79], v[132:135]
ds_read_b64_tr_b16 v[46:47], v15 offset:4096
v_mfma_f32_16x16x32_bf16 v[136:139], v[104:107], v[76:79], v[136:139]
ds_read_b64_tr_b16 v[48:49], v16 offset:0
v_mfma_f32_16x16x32_bf16 v[140:143], v[108:111], v[76:79], v[140:143]
ds_read_b64_tr_b16 v[50:51], v16 offset:4096
v_mfma_f32_16x16x32_bf16 v[144:147], v[112:115], v[76:79], v[144:147]
ds_read_b64_tr_b16 v[52:53], v17 offset:0
v_mfma_f32_16x16x32_bf16 v[148:151], v[116:119], v[76:79], v[148:151]
ds_read_b64_tr_b16 v[54:55], v17 offset:4096
v_mfma_f32_16x16x32_bf16 v[152:155], v[120:123], v[76:79], v[152:155]
ds_read_b64_tr_b16 v[56:57], v18 offset:0
v_mfma_f32_16x16x32_bf16 v[184:187], v[120:123], v[80:83], v[184:187]
ds_read_b64_tr_b16 v[58:59], v18 offset:4096
v_mfma_f32_16x16x32_bf16 v[180:183], v[116:119], v[80:83], v[180:183]
ds_read_b64_tr_b16 v[60:61], v15 offset:16384
v_mfma_f32_16x16x32_bf16 v[176:179], v[112:115], v[80:83], v[176:179]
ds_read_b64_tr_b16 v[62:63], v15 offset:20480
v_mfma_f32_16x16x32_bf16 v[172:175], v[108:111], v[80:83], v[172:175]
ds_read_b64_tr_b16 v[64:65], v16 offset:16384
v_mfma_f32_16x16x32_bf16 v[168:171], v[104:107], v[80:83], v[168:171]
ds_read_b64_tr_b16 v[66:67], v16 offset:20480
v_mfma_f32_16x16x32_bf16 v[164:167], v[100:103], v[80:83], v[164:167]
ds_read_b64_tr_b16 v[68:69], v17 offset:16384
v_mfma_f32_16x16x32_bf16 v[160:163], v[96:99], v[80:83], v[160:163]
ds_read_b64_tr_b16 v[70:71], v17 offset:20480
v_mfma_f32_16x16x32_bf16 v[156:159], v[92:95], v[80:83], v[156:159]
ds_read_b64_tr_b16 v[72:73], v18 offset:16384
v_mfma_f32_16x16x32_bf16 v[188:191], v[92:95], v[84:87], v[188:191]
ds_read_b64_tr_b16 v[74:75], v18 offset:20480
v_mfma_f32_16x16x32_bf16 v[192:195], v[96:99], v[84:87], v[192:195]
ds_read_b128 v[32:35], v9 offset:50176
v_mfma_f32_16x16x32_bf16 v[196:199], v[100:103], v[84:87], v[196:199]
ds_read_b128 v[36:39], v9 offset:51200
v_mfma_f32_16x16x32_bf16 v[200:203], v[104:107], v[84:87], v[200:203]
ds_read_b128 v[40:43], v9 offset:52224
v_mfma_f32_16x16x32_bf16 v[204:207], v[108:111], v[84:87], v[204:207]
v_mfma_f32_16x16x32_bf16 v[208:211], v[112:115], v[84:87], v[208:211]
v_mfma_f32_16x16x32_bf16 v[212:215], v[116:119], v[84:87], v[212:215]
v_mfma_f32_16x16x32_bf16 v[216:219], v[120:123], v[84:87], v[216:219]
v_mfma_f32_16x16x32_bf16 v[248:251], v[120:123], v[88:91], v[248:251]
v_mfma_f32_16x16x32_bf16 v[244:247], v[116:119], v[88:91], v[244:247]
v_mfma_f32_16x16x32_bf16 v[240:243], v[112:115], v[88:91], v[240:243]
v_mfma_f32_16x16x32_bf16 v[236:239], v[108:111], v[88:91], v[236:239]
v_mfma_f32_16x16x32_bf16 v[232:235], v[104:107], v[88:91], v[232:235]
v_mfma_f32_16x16x32_bf16 v[228:231], v[100:103], v[88:91], v[228:231]
v_mfma_f32_16x16x32_bf16 v[224:227], v[96:99], v[88:91], v[224:227]
v_mfma_f32_16x16x32_bf16 v[220:223], v[92:95], v[88:91], v[220:223]
s_waitcnt lgkmcnt(0)
v_mfma_f32_16x16x32_bf16 v[124:127], v[44:47], v[28:31], v[124:127]
ds_read_b128 v[76:79], v9 offset:57344
v_mfma_f32_16x16x32_bf16 v[128:131], v[48:51], v[28:31], v[128:131]
ds_read_b64_tr_b16 v[92:93], v15 offset:8192
v_mfma_f32_16x16x32_bf16 v[132:135], v[52:55], v[28:31], v[132:135]
ds_read_b64_tr_b16 v[94:95], v15 offset:12288
v_mfma_f32_16x16x32_bf16 v[136:139], v[56:59], v[28:31], v[136:139]
ds_read_b64_tr_b16 v[96:97], v16 offset:8192
v_mfma_f32_16x16x32_bf16 v[140:143], v[60:63], v[28:31], v[140:143]
ds_read_b64_tr_b16 v[98:99], v16 offset:12288
v_mfma_f32_16x16x32_bf16 v[144:147], v[64:67], v[28:31], v[144:147]
ds_read_b64_tr_b16 v[100:101], v17 offset:8192
v_mfma_f32_16x16x32_bf16 v[148:151], v[68:71], v[28:31], v[148:151]
ds_read_b64_tr_b16 v[102:103], v17 offset:12288
v_mfma_f32_16x16x32_bf16 v[152:155], v[72:75], v[28:31], v[152:155]
ds_read_b64_tr_b16 v[104:105], v18 offset:8192
v_mfma_f32_16x16x32_bf16 v[184:187], v[72:75], v[32:35], v[184:187]
ds_read_b64_tr_b16 v[106:107], v18 offset:12288
v_mfma_f32_16x16x32_bf16 v[180:183], v[68:71], v[32:35], v[180:183]
ds_read_b64_tr_b16 v[108:109], v15 offset:24576
v_mfma_f32_16x16x32_bf16 v[176:179], v[64:67], v[32:35], v[176:179]
ds_read_b64_tr_b16 v[110:111], v15 offset:28672
v_mfma_f32_16x16x32_bf16 v[172:175], v[60:63], v[32:35], v[172:175]
ds_read_b64_tr_b16 v[112:113], v16 offset:24576
v_mfma_f32_16x16x32_bf16 v[168:171], v[56:59], v[32:35], v[168:171]
ds_read_b64_tr_b16 v[114:115], v16 offset:28672
v_mfma_f32_16x16x32_bf16 v[164:167], v[52:55], v[32:35], v[164:167]
ds_read_b64_tr_b16 v[116:117], v17 offset:24576
v_mfma_f32_16x16x32_bf16 v[160:163], v[48:51], v[32:35], v[160:163]
ds_read_b64_tr_b16 v[118:119], v17 offset:28672
v_mfma_f32_16x16x32_bf16 v[156:159], v[44:47], v[32:35], v[156:159]
ds_read_b64_tr_b16 v[120:121], v18 offset:24576
v_mfma_f32_16x16x32_bf16 v[188:191], v[44:47], v[36:39], v[188:191]
ds_read_b64_tr_b16 v[122:123], v18 offset:28672
v_mfma_f32_16x16x32_bf16 v[192:195], v[48:51], v[36:39], v[192:195]
ds_read_b128 v[80:83], v9 offset:58368
v_mfma_f32_16x16x32_bf16 v[196:199], v[52:55], v[36:39], v[196:199]
ds_read_b128 v[84:87], v9 offset:59392
v_mfma_f32_16x16x32_bf16 v[200:203], v[56:59], v[36:39], v[200:203]
ds_read_b128 v[88:91], v9 offset:60416
v_mfma_f32_16x16x32_bf16 v[204:207], v[60:63], v[36:39], v[204:207]
v_mfma_f32_16x16x32_bf16 v[208:211], v[64:67], v[36:39], v[208:211]
v_mfma_f32_16x16x32_bf16 v[212:215], v[68:71], v[36:39], v[212:215]
v_mfma_f32_16x16x32_bf16 v[216:219], v[72:75], v[36:39], v[216:219]
v_mfma_f32_16x16x32_bf16 v[248:251], v[72:75], v[40:43], v[248:251]
v_mfma_f32_16x16x32_bf16 v[244:247], v[68:71], v[40:43], v[244:247]
v_mfma_f32_16x16x32_bf16 v[240:243], v[64:67], v[40:43], v[240:243]
v_mfma_f32_16x16x32_bf16 v[236:239], v[60:63], v[40:43], v[236:239]
v_mfma_f32_16x16x32_bf16 v[232:235], v[56:59], v[40:43], v[232:235]
v_mfma_f32_16x16x32_bf16 v[228:231], v[52:55], v[40:43], v[228:231]
v_mfma_f32_16x16x32_bf16 v[224:227], v[48:51], v[40:43], v[224:227]
v_mfma_f32_16x16x32_bf16 v[220:223], v[44:47], v[40:43], v[220:223]
s_waitcnt lgkmcnt(0)
s_barrier
v_mfma_f32_16x16x32_bf16 v[124:127], v[92:95], v[76:79], v[124:127]
ds_read_b128 v[28:31], v10 offset:0
v_mfma_f32_16x16x32_bf16 v[128:131], v[96:99], v[76:79], v[128:131]
ds_read_b64_tr_b16 v[44:45], v19 offset:0
v_mfma_f32_16x16x32_bf16 v[132:135], v[100:103], v[76:79], v[132:135]
ds_read_b64_tr_b16 v[46:47], v19 offset:4096
v_mfma_f32_16x16x32_bf16 v[136:139], v[104:107], v[76:79], v[136:139]
ds_read_b64_tr_b16 v[48:49], v20 offset:0
v_mfma_f32_16x16x32_bf16 v[140:143], v[108:111], v[76:79], v[140:143]
ds_read_b64_tr_b16 v[50:51], v20 offset:4096
v_mfma_f32_16x16x32_bf16 v[144:147], v[112:115], v[76:79], v[144:147]
ds_read_b64_tr_b16 v[52:53], v21 offset:0
v_mfma_f32_16x16x32_bf16 v[148:151], v[116:119], v[76:79], v[148:151]
ds_read_b64_tr_b16 v[54:55], v21 offset:4096
v_mfma_f32_16x16x32_bf16 v[152:155], v[120:123], v[76:79], v[152:155]
ds_read_b64_tr_b16 v[56:57], v22 offset:0
v_mfma_f32_16x16x32_bf16 v[184:187], v[120:123], v[80:83], v[184:187]
ds_read_b64_tr_b16 v[58:59], v22 offset:4096
v_mfma_f32_16x16x32_bf16 v[180:183], v[116:119], v[80:83], v[180:183]
ds_read_b64_tr_b16 v[60:61], v19 offset:16384
v_mfma_f32_16x16x32_bf16 v[176:179], v[112:115], v[80:83], v[176:179]
ds_read_b64_tr_b16 v[62:63], v19 offset:20480
v_mfma_f32_16x16x32_bf16 v[172:175], v[108:111], v[80:83], v[172:175]
ds_read_b64_tr_b16 v[64:65], v20 offset:16384
v_mfma_f32_16x16x32_bf16 v[168:171], v[104:107], v[80:83], v[168:171]
ds_read_b64_tr_b16 v[66:67], v20 offset:20480
v_mfma_f32_16x16x32_bf16 v[164:167], v[100:103], v[80:83], v[164:167]
ds_read_b64_tr_b16 v[68:69], v21 offset:16384
v_mfma_f32_16x16x32_bf16 v[160:163], v[96:99], v[80:83], v[160:163]
ds_read_b64_tr_b16 v[70:71], v21 offset:20480
v_mfma_f32_16x16x32_bf16 v[156:159], v[92:95], v[80:83], v[156:159]
ds_read_b64_tr_b16 v[72:73], v22 offset:16384
v_mfma_f32_16x16x32_bf16 v[188:191], v[92:95], v[84:87], v[188:191]
ds_read_b64_tr_b16 v[74:75], v22 offset:20480
v_mfma_f32_16x16x32_bf16 v[192:195], v[96:99], v[84:87], v[192:195]
ds_read_b128 v[32:35], v10 offset:1024
v_mfma_f32_16x16x32_bf16 v[196:199], v[100:103], v[84:87], v[196:199]
ds_read_b128 v[36:39], v10 offset:2048
v_mfma_f32_16x16x32_bf16 v[200:203], v[104:107], v[84:87], v[200:203]
ds_read_b128 v[40:43], v10 offset:3072
v_mfma_f32_16x16x32_bf16 v[204:207], v[108:111], v[84:87], v[204:207]
v_mfma_f32_16x16x32_bf16 v[208:211], v[112:115], v[84:87], v[208:211]
v_mfma_f32_16x16x32_bf16 v[212:215], v[116:119], v[84:87], v[212:215]
v_mfma_f32_16x16x32_bf16 v[216:219], v[120:123], v[84:87], v[216:219]
v_mfma_f32_16x16x32_bf16 v[248:251], v[120:123], v[88:91], v[248:251]
v_mfma_f32_16x16x32_bf16 v[244:247], v[116:119], v[88:91], v[244:247]
v_mfma_f32_16x16x32_bf16 v[240:243], v[112:115], v[88:91], v[240:243]
v_mfma_f32_16x16x32_bf16 v[236:239], v[108:111], v[88:91], v[236:239]
v_mfma_f32_16x16x32_bf16 v[232:235], v[104:107], v[88:91], v[232:235]
v_mfma_f32_16x16x32_bf16 v[228:231], v[100:103], v[88:91], v[228:231]
v_mfma_f32_16x16x32_bf16 v[224:227], v[96:99], v[88:91], v[224:227]
v_mfma_f32_16x16x32_bf16 v[220:223], v[92:95], v[88:91], v[220:223]
s_sub_u32 s41, s41, 1
s_cmp_lg_u32 s41, 0
s_cbranch_scc1 Lk3l_132
s_waitcnt lgkmcnt(0)
s_barrier
v_lshrrev_b32 v84, 4, v1
s_lshl_b32 s43, s63, 8
s_add_u32 s43, s43, 148480
v_lshl_add_u32 v85, v84, 4, s43
v_and_b32 v84, 15, v1
s_lshl_b32 s43, s62, 9
s_add_u32 s43, s43, 147456
v_lshl_add_u32 v84, v84, 3, s43
ds_read_b128 v[28:31], v85 offset:0
ds_read_b128 v[32:35], v85 offset:64
ds_read_b128 v[36:39], v85 offset:128
ds_read_b128 v[40:43], v85 offset:192
ds_read_b128 v[44:47], v85 offset:896
ds_read_b128 v[48:51], v85 offset:960
ds_read_b128 v[52:55], v85 offset:1024
ds_read_b128 v[56:59], v85 offset:1088
ds_read_b64 v[60:61], v84 offset:0
ds_read_b64 v[62:63], v84 offset:128
ds_read_b64 v[64:65], v84 offset:256
ds_read_b64 v[66:67], v84 offset:384
s_lshl_b32 s54, s35, 15
s_lshl_b32 s43, s63, 14
s_add_u32 s54, s54, s43
s_lshl_b32 s43, s62, 12
s_add_u32 s54, s54, s43
s_add_u32 s55, s54, 8192
v_lshrrev_b32 v122, 3, v1
v_and_b32 v123, 6, v122
v_and_b32 v25, 7, v1
v_xor_b32 v25, v25, v123
v_lshlrev_b32 v25, 4, v25
v_mul_u32_u24 v122, 2048, v122
v_add_u32 v25, v25, v122
s_lshl_b32 s43, s61, 7
s_lshl_b32 s44, s47, 15
s_add_u32 s43, s43, s44
v_add_u32 v25, s43, v25
s_waitcnt lgkmcnt(0)
s_add_u32 s37, s52, 589824
s_add_u32 m0, s39, 81920
s_nop 0
buffer_load_dwordx4 v3, s[24:27], s37 offen sc1 lds
v_mul_f32 v70, v61, v61
v_mul_f32 v68, 0xc0135761, v61
v_mul_f32 v69, 0xbdd2d3e8, v61
v_mul_f32 v69, v69, v70
v_rcp_f32 v70, v70
v_mul_f32 v74, v63, v63
v_mul_f32 v72, 0xc0135761, v63
v_mul_f32 v73, 0xbdd2d3e8, v63
v_mul_f32 v73, v73, v74
v_rcp_f32 v74, v74
v_fma_f32 v124, -v60, v28, v124
v_fma_f32 v125, -v60, v29, v125
v_fma_f32 v126, -v60, v30, v126
v_fma_f32 v127, -v60, v31, v127
buffer_load_dwordx4 v3, s[24:27], s37 offen offset:1024 sc1 lds
v_fma_f32 v156, -v62, v28, v156
v_fma_f32 v157, -v62, v29, v157
v_fma_f32 v158, -v62, v30, v158
v_fma_f32 v159, -v62, v31, v159
v_mul_f32 v76, v124, v124
v_mul_f32 v77, v125, v125
v_mul_f32 v78, v126, v126
v_mul_f32 v79, v127, v127
v_mul_f32 v80, v156, v156
v_mul_f32 v81, v157, v157
v_mul_f32 v82, v158, v158
v_mul_f32 v83, v159, v159
v_fma_f32 v76, v76, v69, v68
v_fma_f32 v77, v77, v69, v68
buffer_load_dwordx4 v3, s[24:27], s37 offen offset:2048 sc1 lds
v_fma_f32 v78, v78, v69, v68
v_fma_f32 v79, v79, v69, v68
v_fma_f32 v80, v80, v73, v72
v_fma_f32 v81, v81, v73, v72
v_fma_f32 v82, v82, v73, v72
v_fma_f32 v83, v83, v73, v72
v_mul_f32 v76, v76, v124
v_mul_f32 v77, v77, v125
v_mul_f32 v78, v78, v126
v_mul_f32 v79, v79, v127
v_mul_f32 v80, v80, v156
v_mul_f32 v81, v81, v157
v_mul_f32 v82, v82, v158
v_mul_f32 v83, v83, v159
buffer_load_dwordx4 v3, s[24:27], s37 offen offset:3072 sc1 lds
v_exp_f32 v76, v76
v_exp_f32 v77, v77
v_exp_f32 v78, v78
v_exp_f32 v79, v79
v_exp_f32 v80, v80
v_exp_f32 v81, v81
v_exp_f32 v82, v82
v_exp_f32 v83, v83
v_fma_f32 v140, -v60, v44, v140
v_fma_f32 v141, -v60, v45, v141
v_fma_f32 v142, -v60, v46, v142
v_fma_f32 v143, -v60, v47, v143
v_fma_f32 v172, -v62, v44, v172
v_fma_f32 v173, -v62, v45, v173
s_branch Lov_16
.p2align 12
.fill 128, 4, 0xbf800000
Lst_16_0:
s_branch Lwr_157
Lst_16_1:
s_branch Lwr_169
s_nop 0
Lov_16:
s_add_u32 s37, s52, 606208
s_add_u32 m0, s39, 98304
s_nop 0
buffer_load_dwordx4 v3, s[24:27], s37 offen sc1 lds
v_fma_f32 v174, -v62, v46, v174
v_fma_f32 v175, -v62, v47, v175
v_fma_f32 v76, v76, v70, v70
v_fma_f32 v77, v77, v70, v70
v_fma_f32 v78, v78, v70, v70
v_fma_f32 v79, v79, v70, v70
v_fma_f32 v80, v80, v74, v74
v_fma_f32 v81, v81, v74, v74
v_fma_f32 v82, v82, v74, v74
v_fma_f32 v83, v83, v74, v74
v_rcp_f32 v76, v76
v_rcp_f32 v77, v77
v_rcp_f32 v78, v78
v_rcp_f32 v79, v79
buffer_load_dwordx4 v3, s[24:27], s37 offen offset:1024 sc1 lds
v_rcp_f32 v80, v80
v_rcp_f32 v81, v81
v_rcp_f32 v82, v82
v_rcp_f32 v83, v83
v_mul_f32 v140, v124, v140
v_mul_f32 v141, v125, v141
v_mul_f32 v142, v126, v142
v_mul_f32 v143, v127, v143
v_mul_f32 v172, v156, v172
v_mul_f32 v173, v157, v173
v_mul_f32 v174, v158, v174
v_mul_f32 v175, v159, v175
v_mul_f32 v140, v140, v76
v_mul_f32 v141, v141, v77
buffer_load_dwordx4 v3, s[24:27], s37 offen offset:2048 sc1 lds
v_mul_f32 v142, v142, v78
v_mul_f32 v143, v143, v79
v_mul_f32 v172, v172, v80
v_mul_f32 v173, v173, v81
v_mul_f32 v174, v174, v82
v_mul_f32 v175, v175, v83
v_cvt_pk_bf16_f32 v124, v140, v141
v_cvt_pk_bf16_f32 v125, v142, v143
v_cvt_pk_bf16_f32 v156, v172, v173
v_cvt_pk_bf16_f32 v157, v174, v175
v_fma_f32 v128, -v60, v32, v128
v_fma_f32 v129, -v60, v33, v129
v_fma_f32 v130, -v60, v34, v130
v_fma_f32 v131, -v60, v35, v131
buffer_load_dwordx4 v3, s[24:27], s37 offen offset:3072 sc1 lds
v_fma_f32 v160, -v62, v32, v160
v_fma_f32 v161, -v62, v33, v161
v_fma_f32 v162, -v62, v34, v162
v_fma_f32 v163, -v62, v35, v163
v_mul_f32 v76, v128, v128
v_mul_f32 v77, v129, v129
v_mul_f32 v78, v130, v130
v_mul_f32 v79, v131, v131
v_mul_f32 v80, v160, v160
v_mul_f32 v81, v161, v161
v_mul_f32 v82, v162, v162
v_mul_f32 v83, v163, v163
v_fma_f32 v76, v76, v69, v68
v_fma_f32 v77, v77, v69, v68
s_add_u32 s38, s53, 4849664
s_add_u32 m0, s39, 114688
s_nop 0
buffer_load_dwordx4 v23, s[28:31], s38 offen lds
v_fma_f32 v78, v78, v69, v68
v_fma_f32 v79, v79, v69, v68
v_fma_f32 v80, v80, v73, v72
v_fma_f32 v81, v81, v73, v72
v_fma_f32 v82, v82, v73, v72
v_fma_f32 v83, v83, v73, v72
v_mul_f32 v76, v76, v128
v_mul_f32 v77, v77, v129
v_mul_f32 v78, v78, v130
v_mul_f32 v79, v79, v131
v_mul_f32 v80, v80, v160
v_mul_f32 v81, v81, v161
v_mul_f32 v82, v82, v162
v_mul_f32 v83, v83, v163
s_add_u32 m0, s39, 115712
s_nop 0
buffer_load_dwordx4 v24, s[28:31], s38 offen lds
v_exp_f32 v76, v76
v_exp_f32 v77, v77
v_exp_f32 v78, v78
v_exp_f32 v79, v79
v_exp_f32 v80, v80
v_exp_f32 v81, v81
v_exp_f32 v82, v82
v_exp_f32 v83, v83
v_fma_f32 v144, -v60, v48, v144
v_fma_f32 v145, -v60, v49, v145
v_fma_f32 v146, -v60, v50, v146
v_fma_f32 v147, -v60, v51, v147
v_fma_f32 v176, -v62, v48, v176
v_fma_f32 v177, -v62, v49, v177
s_add_u32 m0, s39, 116736
s_add_u32 s38, s38, 16384
buffer_load_dwordx4 v23, s[28:31], s38 offen lds
s_add_u32 m0, s39, 117760
s_nop 0
buffer_load_dwordx4 v24, s[28:31], s38 offen lds
s_barrier
s_add_u32 s38, s53, 4718592
s_add_u32 m0, s39, 147456
s_nop 0
buffer_load_dwordx4 v23, s[28:31], s38 offen lds
v_fma_f32 v178, -v62, v50, v178
v_fma_f32 v179, -v62, v51, v179
v_fma_f32 v76, v76, v70, v70
v_fma_f32 v77, v77, v70, v70
v_fma_f32 v78, v78, v70, v70
v_fma_f32 v79, v79, v70, v70
v_fma_f32 v80, v80, v74, v74
v_fma_f32 v81, v81, v74, v74
v_fma_f32 v82, v82, v74, v74
v_fma_f32 v83, v83, v74, v74
v_rcp_f32 v76, v76
v_rcp_f32 v77, v77
v_rcp_f32 v78, v78
v_rcp_f32 v79, v79
s_add_u32 m0, s39, 148480
s_nop 0
buffer_load_dwordx4 v24, s[28:31], s38 offen lds
v_rcp_f32 v80, v80
v_rcp_f32 v81, v81
v_rcp_f32 v82, v82
v_rcp_f32 v83, v83
v_mul_f32 v144, v128, v144
v_mul_f32 v145, v129, v145
v_mul_f32 v146, v130, v146
v_mul_f32 v147, v131, v147
v_mul_f32 v176, v160, v176
v_mul_f32 v177, v161, v177
v_mul_f32 v178, v162, v178
v_mul_f32 v179, v163, v179
v_mul_f32 v144, v144, v76
v_mul_f32 v145, v145, v77
s_add_u32 m0, s39, 149504
s_add_u32 s38, s38, 16384
buffer_load_dwordx4 v23, s[28:31], s38 offen lds
v_mul_f32 v146, v146, v78
v_mul_f32 v147, v147, v79
v_mul_f32 v176, v176, v80
v_mul_f32 v177, v177, v81
v_mul_f32 v178, v178, v82
v_mul_f32 v179, v179, v83
v_cvt_pk_bf16_f32 v126, v144, v145
v_cvt_pk_bf16_f32 v127, v146, v147
v_cvt_pk_bf16_f32 v158, v176, v177
v_cvt_pk_bf16_f32 v159, v178, v179
buffer_store_dwordx4 v[124:127], v2, s[24:27], s54 offen offset:0 sc1
buffer_store_dwordx4 v[156:159], v2, s[24:27], s54 offen offset:1024 sc1
v_fma_f32 v132, -v60, v36, v132
v_fma_f32 v133, -v60, v37, v133
s_add_u32 m0, s39, 150528
s_nop 0
buffer_load_dwordx4 v24, s[28:31], s38 offen lds
v_fma_f32 v134, -v60, v38, v134
v_fma_f32 v135, -v60, v39, v135
v_fma_f32 v164, -v62, v36, v164
v_fma_f32 v165, -v62, v37, v165
v_fma_f32 v166, -v62, v38, v166
v_fma_f32 v167, -v62, v39, v167
v_mul_f32 v76, v132, v132
v_mul_f32 v77, v133, v133
v_mul_f32 v78, v134, v134
v_mul_f32 v79, v135, v135
v_mul_f32 v80, v164, v164
v_mul_f32 v81, v165, v165
v_mul_f32 v82, v166, v166
v_mul_f32 v83, v167, v167
s_add_u32 s37, s52, 622592
s_add_u32 m0, s39, 131072
s_nop 0
buffer_load_dwordx4 v3, s[24:27], s37 offen sc1 lds
v_fma_f32 v76, v76, v69, v68
v_fma_f32 v77, v77, v69, v68
v_fma_f32 v78, v78, v69, v68
v_fma_f32 v79, v79, v69, v68
v_fma_f32 v80, v80, v73, v72
v_fma_f32 v81, v81, v73, v72
v_fma_f32 v82, v82, v73, v72
v_fma_f32 v83, v83, v73, v72
v_mul_f32 v76, v76, v132
v_mul_f32 v77, v77, v133
v_mul_f32 v78, v78, v134
v_mul_f32 v79, v79, v135
v_mul_f32 v80, v80, v164
v_mul_f32 v81, v81, v165
buffer_load_dwordx4 v3, s[24:27], s37 offen offset:1024 sc1 lds
v_mul_f32 v82, v82, v166
v_mul_f32 v83, v83, v167
v_exp_f32 v76, v76
v_exp_f32 v77, v77
v_exp_f32 v78, v78
v_exp_f32 v79, v79
v_exp_f32 v80, v80
v_exp_f32 v81, v81
v_exp_f32 v82, v82
v_exp_f32 v83, v83
v_fma_f32 v148, -v60, v52, v148
v_fma_f32 v149, -v60, v53, v149
v_fma_f32 v150, -v60, v54, v150
v_fma_f32 v151, -v60, v55, v151
buffer_load_dwordx4 v3, s[24:27], s37 offen offset:2048 sc1 lds
v_fma_f32 v180, -v62, v52, v180
v_fma_f32 v181, -v62, v53, v181
v_fma_f32 v182, -v62, v54, v182
v_fma_f32 v183, -v62, v55, v183
v_fma_f32 v76, v76, v70, v70
v_fma_f32 v77, v77, v70, v70
v_fma_f32 v78, v78, v70, v70
v_fma_f32 v79, v79, v70, v70
v_fma_f32 v80, v80, v74, v74
v_fma_f32 v81, v81, v74, v74
v_fma_f32 v82, v82, v74, v74
v_fma_f32 v83, v83, v74, v74
v_rcp_f32 v76, v76
v_rcp_f32 v77, v77
buffer_load_dwordx4 v3, s[24:27], s37 offen offset:3072 sc1 lds
v_rcp_f32 v78, v78
v_rcp_f32 v79, v79
v_rcp_f32 v80, v80
v_rcp_f32 v81, v81
v_rcp_f32 v82, v82
v_rcp_f32 v83, v83
v_mul_f32 v148, v132, v148
v_mul_f32 v149, v133, v149
v_mul_f32 v150, v134, v150
v_mul_f32 v151, v135, v151
v_mul_f32 v180, v164, v180
v_mul_f32 v181, v165, v181
v_mul_f32 v182, v166, v182
v_mul_f32 v183, v167, v183
s_add_u32 s38, s53, 4980736
s_add_u32 m0, s39, 0
s_nop 0
buffer_load_dwordx4 v23, s[28:31], s38 offen lds
v_mul_f32 v148, v148, v76
v_mul_f32 v149, v149, v77
v_mul_f32 v150, v150, v78
v_mul_f32 v151, v151, v79
v_mul_f32 v180, v180, v80
v_mul_f32 v181, v181, v81
v_mul_f32 v182, v182, v82
v_mul_f32 v183, v183, v83
v_cvt_pk_bf16_f32 v132, v148, v149
v_cvt_pk_bf16_f32 v133, v150, v151
v_cvt_pk_bf16_f32 v164, v180, v181
v_cvt_pk_bf16_f32 v165, v182, v183
v_fma_f32 v136, -v60, v40, v136
v_fma_f32 v137, -v60, v41, v137
s_add_u32 m0, s39, 1024
s_nop 0
buffer_load_dwordx4 v24, s[28:31], s38 offen lds
v_fma_f32 v138, -v60, v42, v138
v_fma_f32 v139, -v60, v43, v139
v_fma_f32 v168, -v62, v40, v168
v_fma_f32 v169, -v62, v41, v169
v_fma_f32 v170, -v62, v42, v170
v_fma_f32 v171, -v62, v43, v171
v_mul_f32 v76, v136, v136
v_mul_f32 v77, v137, v137
v_mul_f32 v78, v138, v138
v_mul_f32 v79, v139, v139
v_mul_f32 v80, v168, v168
v_mul_f32 v81, v169, v169
v_mul_f32 v82, v170, v170
v_mul_f32 v83, v171, v171
s_add_u32 m0, s39, 2048
s_add_u32 s38, s38, 16384
buffer_load_dwordx4 v23, s[28:31], s38 offen lds
s_add_u32 m0, s39, 3072
s_nop 0
buffer_load_dwordx4 v24, s[28:31], s38 offen lds
s_barrier
s_add_u32 s37, s52, 638976
s_add_u32 m0, s39, 16384
s_nop 0
buffer_load_dwordx4 v3, s[24:27], s37 offen sc1 lds
v_fma_f32 v76, v76, v69, v68
v_fma_f32 v77, v77, v69, v68
v_fma_f32 v78, v78, v69, v68
v_fma_f32 v79, v79, v69, v68
v_fma_f32 v80, v80, v73, v72
v_fma_f32 v81, v81, v73, v72
v_fma_f32 v82, v82, v73, v72
v_fma_f32 v83, v83, v73, v72
v_mul_f32 v76, v76, v136
v_mul_f32 v77, v77, v137
v_mul_f32 v78, v78, v138
v_mul_f32 v79, v79, v139
v_mul_f32 v80, v80, v168
v_mul_f32 v81, v81, v169
v_mul_f32 v82, v82, v170
v_mul_f32 v83, v83, v171
v_exp_f32 v76, v76
v_exp_f32 v77, v77
v_exp_f32 v78, v78
v_exp_f32 v79, v79
v_exp_f32 v80, v80
v_exp_f32 v81, v81
v_exp_f32 v82, v82
buffer_load_dwordx4 v3, s[24:27], s37 offen offset:1024 sc1 lds
v_exp_f32 v83, v83
v_fma_f32 v152, -v60, v56, v152
v_fma_f32 v153, -v60, v57, v153
v_fma_f32 v154, -v60, v58, v154
v_fma_f32 v155, -v60, v59, v155
v_fma_f32 v184, -v62, v56, v184
v_fma_f32 v185, -v62, v57, v185
v_fma_f32 v186, -v62, v58, v186
v_fma_f32 v187, -v62, v59, v187
v_fma_f32 v76, v76, v70, v70
v_fma_f32 v77, v77, v70, v70
v_fma_f32 v78, v78, v70, v70
v_fma_f32 v79, v79, v70, v70
v_fma_f32 v80, v80, v74, v74
v_fma_f32 v81, v81, v74, v74
v_fma_f32 v82, v82, v74, v74
v_fma_f32 v83, v83, v74, v74
v_rcp_f32 v76, v76
v_rcp_f32 v77, v77
v_rcp_f32 v78, v78
v_rcp_f32 v79, v79
v_rcp_f32 v80, v80
v_rcp_f32 v81, v81
buffer_load_dwordx4 v3, s[24:27], s37 offen offset:2048 sc1 lds
v_rcp_f32 v82, v82
v_rcp_f32 v83, v83
v_mul_f32 v152, v136, v152
v_mul_f32 v153, v137, v153
v_mul_f32 v154, v138, v154
v_mul_f32 v155, v139, v155
v_mul_f32 v184, v168, v184
v_mul_f32 v185, v169, v185
v_mul_f32 v186, v170, v186
v_mul_f32 v187, v171, v187
v_mul_f32 v152, v152, v76
v_mul_f32 v153, v153, v77
v_mul_f32 v154, v154, v78
v_mul_f32 v155, v155, v79
v_mul_f32 v184, v184, v80
v_mul_f32 v185, v185, v81
v_mul_f32 v186, v186, v82
v_mul_f32 v187, v187, v83
v_cvt_pk_bf16_f32 v134, v152, v153
v_cvt_pk_bf16_f32 v135, v154, v155
v_cvt_pk_bf16_f32 v166, v184, v185
v_cvt_pk_bf16_f32 v167, v186, v187
buffer_store_dwordx4 v[132:135], v2, s[24:27], s55 offen offset:0 sc1
buffer_store_dwordx4 v[164:167], v2, s[24:27], s55 offen offset:1024 sc1
buffer_load_dwordx4 v3, s[24:27], s37 offen offset:3072 sc1 lds
v_mul_f32 v70, v65, v65
v_mul_f32 v68, 0xc0135761, v65
v_mul_f32 v69, 0xbdd2d3e8, v65
v_mul_f32 v69, v69, v70
v_rcp_f32 v70, v70
v_mul_f32 v74, v67, v67
v_mul_f32 v72, 0xc0135761, v67
v_mul_f32 v73, 0xbdd2d3e8, v67
v_mul_f32 v73, v73, v74
v_rcp_f32 v74, v74
v_fma_f32 v188, -v64, v28, v188
v_fma_f32 v189, -v64, v29, v189
v_fma_f32 v190, -v64, v30, v190
v_fma_f32 v191, -v64, v31, v191
v_fma_f32 v220, -v66, v28, v220
v_fma_f32 v221, -v66, v29, v221
v_fma_f32 v222, -v66, v30, v222
v_fma_f32 v223, -v66, v31, v223
v_mul_f32 v76, v188, v188
v_mul_f32 v77, v189, v189
v_mul_f32 v78, v190, v190
v_mul_f32 v79, v191, v191
v_mul_f32 v80, v220, v220
s_add_u32 s38, s53, 5111808
s_add_u32 m0, s39, 32768
s_nop 0
buffer_load_dwordx4 v23, s[28:31], s38 offen lds
v_mul_f32 v81, v221, v221
v_mul_f32 v82, v222, v222
v_mul_f32 v83, v223, v223
v_fma_f32 v76, v76, v69, v68
v_fma_f32 v77, v77, v69, v68
v_fma_f32 v78, v78, v69, v68
v_fma_f32 v79, v79, v69, v68
v_fma_f32 v80, v80, v73, v72
v_fma_f32 v81, v81, v73, v72
v_fma_f32 v82, v82, v73, v72
v_fma_f32 v83, v83, v73, v72
v_mul_f32 v76, v76, v188
v_mul_f32 v77, v77, v189
v_mul_f32 v78, v78, v190
v_mul_f32 v79, v79, v191
v_mul_f32 v80, v80, v220
v_mul_f32 v81, v81, v221
v_mul_f32 v82, v82, v222
v_mul_f32 v83, v83, v223
v_exp_f32 v76, v76
v_exp_f32 v77, v77
v_exp_f32 v78, v78
v_exp_f32 v79, v79
s_add_u32 m0, s39, 33792
s_nop 0
buffer_load_dwordx4 v24, s[28:31], s38 offen lds
v_exp_f32 v80, v80
v_exp_f32 v81, v81
v_exp_f32 v82, v82
v_exp_f32 v83, v83
v_fma_f32 v204, -v64, v44, v204
v_fma_f32 v205, -v64, v45, v205
v_fma_f32 v206, -v64, v46, v206
v_fma_f32 v207, -v64, v47, v207
v_fma_f32 v236, -v66, v44, v236
v_fma_f32 v237, -v66, v45, v237
v_fma_f32 v238, -v66, v46, v238
v_fma_f32 v239, -v66, v47, v239
v_fma_f32 v76, v76, v70, v70
v_fma_f32 v77, v77, v70, v70
v_fma_f32 v78, v78, v70, v70
v_fma_f32 v79, v79, v70, v70
v_fma_f32 v80, v80, v74, v74
v_fma_f32 v81, v81, v74, v74
v_fma_f32 v82, v82, v74, v74
v_fma_f32 v83, v83, v74, v74
v_rcp_f32 v76, v76
v_rcp_f32 v77, v77
v_rcp_f32 v78, v78
v_rcp_f32 v79, v79
s_add_u32 m0, s39, 34816
s_add_u32 s38, s38, 16384
buffer_load_dwordx4 v23, s[28:31], s38 offen lds
s_add_u32 m0, s39, 35840
s_nop 0
buffer_load_dwordx4 v24, s[28:31], s38 offen lds
s_waitcnt vmcnt(18)
s_barrier
s_add_u32 s37, s52, 655360
s_add_u32 m0, s39, 49152
s_nop 0
buffer_load_dwordx4 v3, s[24:27], s37 offen sc1 lds
v_rcp_f32 v80, v80
v_rcp_f32 v81, v81
v_rcp_f32 v82, v82
v_rcp_f32 v83, v83
v_mul_f32 v204, v188, v204
v_mul_f32 v205, v189, v205
v_mul_f32 v206, v190, v206
v_mul_f32 v207, v191, v207
v_mul_f32 v236, v220, v236
v_mul_f32 v237, v221, v237
v_mul_f32 v238, v222, v238
v_mul_f32 v239, v223, v239
v_mul_f32 v204, v204, v76
v_mul_f32 v205, v205, v77
v_mul_f32 v206, v206, v78
v_mul_f32 v207, v207, v79
v_mul_f32 v236, v236, v80
v_mul_f32 v237, v237, v81
v_mul_f32 v238, v238, v82
v_mul_f32 v239, v239, v83
v_cvt_pk_bf16_f32 v188, v204, v205
v_cvt_pk_bf16_f32 v189, v206, v207
v_cvt_pk_bf16_f32 v220, v236, v237
buffer_load_dwordx4 v3, s[24:27], s37 offen offset:1024 sc1 lds
v_cvt_pk_bf16_f32 v221, v238, v239
v_fma_f32 v192, -v64, v32, v192
v_fma_f32 v193, -v64, v33, v193
v_fma_f32 v194, -v64, v34, v194
v_fma_f32 v195, -v64, v35, v195
v_fma_f32 v224, -v66, v32, v224
v_fma_f32 v225, -v66, v33, v225
v_fma_f32 v226, -v66, v34, v226
v_fma_f32 v227, -v66, v35, v227
v_mul_f32 v76, v192, v192
v_mul_f32 v77, v193, v193
v_mul_f32 v78, v194, v194
v_mul_f32 v79, v195, v195
v_mul_f32 v80, v224, v224
v_mul_f32 v81, v225, v225
v_mul_f32 v82, v226, v226
v_mul_f32 v83, v227, v227
v_fma_f32 v76, v76, v69, v68
v_fma_f32 v77, v77, v69, v68
v_fma_f32 v78, v78, v69, v68
v_fma_f32 v79, v79, v69, v68
v_fma_f32 v80, v80, v73, v72
v_fma_f32 v81, v81, v73, v72
buffer_load_dwordx4 v3, s[24:27], s37 offen offset:2048 sc1 lds
v_fma_f32 v82, v82, v73, v72
v_fma_f32 v83, v83, v73, v72
v_mul_f32 v76, v76, v192
v_mul_f32 v77, v77, v193
v_mul_f32 v78, v78, v194
v_mul_f32 v79, v79, v195
v_mul_f32 v80, v80, v224
v_mul_f32 v81, v81, v225
v_mul_f32 v82, v82, v226
v_mul_f32 v83, v83, v227
v_exp_f32 v76, v76
v_exp_f32 v77, v77
v_exp_f32 v78, v78
v_exp_f32 v79, v79
v_exp_f32 v80, v80
v_exp_f32 v81, v81
v_exp_f32 v82, v82
v_exp_f32 v83, v83
v_fma_f32 v208, -v64, v48, v208
v_fma_f32 v209, -v64, v49, v209
v_fma_f32 v210, -v64, v50, v210
v_fma_f32 v211, -v64, v51, v211
v_fma_f32 v240, -v66, v48, v240
v_fma_f32 v241, -v66, v49, v241
buffer_load_dwordx4 v3, s[24:27], s37 offen offset:3072 sc1 lds
v_fma_f32 v242, -v66, v50, v242
v_fma_f32 v243, -v66, v51, v243
v_fma_f32 v76, v76, v70, v70
v_fma_f32 v77, v77, v70, v70
v_fma_f32 v78, v78, v70, v70
v_fma_f32 v79, v79, v70, v70
v_fma_f32 v80, v80, v74, v74
v_fma_f32 v81, v81, v74, v74
v_fma_f32 v82, v82, v74, v74
v_fma_f32 v83, v83, v74, v74
v_rcp_f32 v76, v76
v_rcp_f32 v77, v77
v_rcp_f32 v78, v78
v_rcp_f32 v79, v79
v_rcp_f32 v80, v80
v_rcp_f32 v81, v81
v_rcp_f32 v82, v82
v_rcp_f32 v83, v83
v_mul_f32 v208, v192, v208
v_mul_f32 v209, v193, v209
v_mul_f32 v210, v194, v210
v_mul_f32 v211, v195, v211
v_mul_f32 v240, v224, v240
s_add_u32 s38, s53, 5242880
s_add_u32 m0, s39, 65536
s_nop 0
buffer_load_dwordx4 v23, s[28:31], s38 offen lds
v_mul_f32 v241, v225, v241
v_mul_f32 v242, v226, v242
v_mul_f32 v243, v227, v243
v_mul_f32 v208, v208, v76
v_mul_f32 v209, v209, v77
v_mul_f32 v210, v210, v78
v_mul_f32 v211, v211, v79
v_mul_f32 v240, v240, v80
v_mul_f32 v241, v241, v81
v_mul_f32 v242, v242, v82
v_mul_f32 v243, v243, v83
v_cvt_pk_bf16_f32 v190, v208, v209
v_cvt_pk_bf16_f32 v191, v210, v211
v_cvt_pk_bf16_f32 v222, v240, v241
v_cvt_pk_bf16_f32 v223, v242, v243
buffer_store_dwordx4 v[188:191], v2, s[24:27], s54 offen offset:2048 sc1
buffer_store_dwordx4 v[220:223], v2, s[24:27], s54 offen offset:3072 sc1
v_fma_f32 v196, -v64, v36, v196
v_fma_f32 v197, -v64, v37, v197
v_fma_f32 v198, -v64, v38, v198
v_fma_f32 v199, -v64, v39, v199
v_fma_f32 v228, -v66, v36, v228
v_fma_f32 v229, -v66, v37, v229
s_add_u32 m0, s39, 66560
s_nop 0
buffer_load_dwordx4 v24, s[28:31], s38 offen lds
v_fma_f32 v230, -v66, v38, v230
v_fma_f32 v231, -v66, v39, v231
v_mul_f32 v76, v196, v196
v_mul_f32 v77, v197, v197
v_mul_f32 v78, v198, v198
v_mul_f32 v79, v199, v199
v_mul_f32 v80, v228, v228
v_mul_f32 v81, v229, v229
v_mul_f32 v82, v230, v230
v_mul_f32 v83, v231, v231
v_fma_f32 v76, v76, v69, v68
v_fma_f32 v77, v77, v69, v68
v_fma_f32 v78, v78, v69, v68
v_fma_f32 v79, v79, v69, v68
v_fma_f32 v80, v80, v73, v72
v_fma_f32 v81, v81, v73, v72
v_fma_f32 v82, v82, v73, v72
v_fma_f32 v83, v83, v73, v72
v_mul_f32 v76, v76, v196
v_mul_f32 v77, v77, v197
v_mul_f32 v78, v78, v198
v_mul_f32 v79, v79, v199
v_mul_f32 v80, v80, v228
v_mul_f32 v81, v81, v229
s_add_u32 m0, s39, 67584
s_add_u32 s38, s38, 16384
buffer_load_dwordx4 v23, s[28:31], s38 offen lds
s_add_u32 m0, s39, 68608
s_nop 0
s_branch Lov_17
.p2align 12
.fill 128, 4, 0xbf800000
Lst_17_0:
s_branch Lwr_158
Lst_17_1:
s_branch Lwr_170
s_nop 0
Lov_17:
buffer_load_dwordx4 v24, s[28:31], s38 offen lds
s_waitcnt vmcnt(34)
s_barrier
s_add_u32 s37, s52, 671744
s_add_u32 m0, s39, 81920
s_nop 0
buffer_load_dwordx4 v3, s[24:27], s37 offen sc1 lds
v_mul_f32 v82, v82, v230
v_mul_f32 v83, v83, v231
v_exp_f32 v76, v76
v_exp_f32 v77, v77
v_exp_f32 v78, v78
v_exp_f32 v79, v79
v_exp_f32 v80, v80
v_exp_f32 v81, v81
v_exp_f32 v82, v82
v_exp_f32 v83, v83
v_fma_f32 v212, -v64, v52, v212
v_fma_f32 v213, -v64, v53, v213
v_fma_f32 v214, -v64, v54, v214
v_fma_f32 v215, -v64, v55, v215
v_fma_f32 v244, -v66, v52, v244
v_fma_f32 v245, -v66, v53, v245
v_fma_f32 v246, -v66, v54, v246
v_fma_f32 v247, -v66, v55, v247
v_fma_f32 v76, v76, v70, v70
v_fma_f32 v77, v77, v70, v70
v_fma_f32 v78, v78, v70, v70
v_fma_f32 v79, v79, v70, v70
v_fma_f32 v80, v80, v74, v74
buffer_load_dwordx4 v3, s[24:27], s37 offen offset:1024 sc1 lds
v_fma_f32 v81, v81, v74, v74
v_fma_f32 v82, v82, v74, v74
v_fma_f32 v83, v83, v74, v74
v_rcp_f32 v76, v76
v_rcp_f32 v77, v77
v_rcp_f32 v78, v78
v_rcp_f32 v79, v79
v_rcp_f32 v80, v80
v_rcp_f32 v81, v81
v_rcp_f32 v82, v82
v_rcp_f32 v83, v83
v_mul_f32 v212, v196, v212
v_mul_f32 v213, v197, v213
v_mul_f32 v214, v198, v214
v_mul_f32 v215, v199, v215
v_mul_f32 v244, v228, v244
v_mul_f32 v245, v229, v245
v_mul_f32 v246, v230, v246
v_mul_f32 v247, v231, v247
v_mul_f32 v212, v212, v76
v_mul_f32 v213, v213, v77
v_mul_f32 v214, v214, v78
v_mul_f32 v215, v215, v79
buffer_load_dwordx4 v3, s[24:27], s37 offen offset:2048 sc1 lds
v_mul_f32 v244, v244, v80
v_mul_f32 v245, v245, v81
v_mul_f32 v246, v246, v82
v_mul_f32 v247, v247, v83
v_cvt_pk_bf16_f32 v196, v212, v213
v_cvt_pk_bf16_f32 v197, v214, v215
v_cvt_pk_bf16_f32 v228, v244, v245
v_cvt_pk_bf16_f32 v229, v246, v247
v_fma_f32 v200, -v64, v40, v200
v_fma_f32 v201, -v64, v41, v201
v_fma_f32 v202, -v64, v42, v202
v_fma_f32 v203, -v64, v43, v203
v_fma_f32 v232, -v66, v40, v232
v_fma_f32 v233, -v66, v41, v233
v_fma_f32 v234, -v66, v42, v234
v_fma_f32 v235, -v66, v43, v235
v_mul_f32 v76, v200, v200
v_mul_f32 v77, v201, v201
v_mul_f32 v78, v202, v202
v_mul_f32 v79, v203, v203
v_mul_f32 v80, v232, v232
v_mul_f32 v81, v233, v233
v_mul_f32 v82, v234, v234
v_mul_f32 v83, v235, v235
buffer_load_dwordx4 v3, s[24:27], s37 offen offset:3072 sc1 lds
v_fma_f32 v76, v76, v69, v68
v_fma_f32 v77, v77, v69, v68
v_fma_f32 v78, v78, v69, v68
v_fma_f32 v79, v79, v69, v68
v_fma_f32 v80, v80, v73, v72
v_fma_f32 v81, v81, v73, v72
v_fma_f32 v82, v82, v73, v72
v_fma_f32 v83, v83, v73, v72
v_mul_f32 v76, v76, v200
v_mul_f32 v77, v77, v201
v_mul_f32 v78, v78, v202
v_mul_f32 v79, v79, v203
v_mul_f32 v80, v80, v232
v_mul_f32 v81, v81, v233
v_mul_f32 v82, v82, v234
v_mul_f32 v83, v83, v235
v_exp_f32 v76, v76
v_exp_f32 v77, v77
v_exp_f32 v78, v78
v_exp_f32 v79, v79
v_exp_f32 v80, v80
v_exp_f32 v81, v81
v_exp_f32 v82, v82
s_add_u32 s38, s53, 5373952
s_add_u32 m0, s39, 147456
s_nop 0
buffer_load_dwordx4 v23, s[28:31], s38 offen lds
v_exp_f32 v83, v83
v_fma_f32 v216, -v64, v56, v216
v_fma_f32 v217, -v64, v57, v217
v_fma_f32 v218, -v64, v58, v218
v_fma_f32 v219, -v64, v59, v219
v_fma_f32 v248, -v66, v56, v248
v_fma_f32 v249, -v66, v57, v249
v_fma_f32 v250, -v66, v58, v250
v_fma_f32 v251, -v66, v59, v251
v_fma_f32 v76, v76, v70, v70
v_fma_f32 v77, v77, v70, v70
v_fma_f32 v78, v78, v70, v70
v_fma_f32 v79, v79, v70, v70
v_fma_f32 v80, v80, v74, v74
v_fma_f32 v81, v81, v74, v74
v_fma_f32 v82, v82, v74, v74
v_fma_f32 v83, v83, v74, v74
v_rcp_f32 v76, v76
v_rcp_f32 v77, v77
v_rcp_f32 v78, v78
v_rcp_f32 v79, v79
v_rcp_f32 v80, v80
v_rcp_f32 v81, v81
s_add_u32 m0, s39, 148480
s_nop 0
buffer_load_dwordx4 v24, s[28:31], s38 offen lds
v_rcp_f32 v82, v82
v_rcp_f32 v83, v83
v_mul_f32 v216, v200, v216
v_mul_f32 v217, v201, v217
v_mul_f32 v218, v202, v218
v_mul_f32 v219, v203, v219
v_mul_f32 v248, v232, v248
v_mul_f32 v249, v233, v249
v_mul_f32 v250, v234, v250
v_mul_f32 v251, v235, v251
v_mul_f32 v216, v216, v76
v_mul_f32 v217, v217, v77
v_mul_f32 v218, v218, v78
v_mul_f32 v219, v219, v79
v_mul_f32 v248, v248, v80
v_mul_f32 v249, v249, v81
v_mul_f32 v250, v250, v82
v_mul_f32 v251, v251, v83
v_cvt_pk_bf16_f32 v198, v216, v217
v_cvt_pk_bf16_f32 v199, v218, v219
v_cvt_pk_bf16_f32 v230, v248, v249
v_cvt_pk_bf16_f32 v231, v250, v251
buffer_store_dwordx4 v[196:199], v2, s[24:27], s55 offen offset:2048 sc1
buffer_store_dwordx4 v[228:231], v2, s[24:27], s55 offen offset:3072 sc1
s_add_u32 m0, s39, 149504
s_add_u32 s38, s38, 16384
buffer_load_dwordx4 v23, s[28:31], s38 offen lds
s_add_u32 m0, s39, 150528
s_nop 0
buffer_load_dwordx4 v24, s[28:31], s38 offen lds
s_waitcnt vmcnt(30)
s_barrier
s_add_u32 s37, s52, 688128
s_add_u32 m0, s39, 98304
s_nop 0
buffer_load_dwordx4 v3, s[24:27], s37 offen sc1 lds
buffer_load_dwordx4 v3, s[24:27], s37 offen offset:1024 sc1 lds
buffer_load_dwordx4 v3, s[24:27], s37 offen offset:2048 sc1 lds
buffer_load_dwordx4 v3, s[24:27], s37 offen offset:3072 sc1 lds
s_add_u32 s38, s53, 5505024
s_add_u32 m0, s39, 114688
s_nop 0
buffer_load_dwordx4 v23, s[28:31], s38 offen lds
s_add_u32 m0, s39, 115712
s_nop 0
buffer_load_dwordx4 v24, s[28:31], s38 offen lds
s_add_u32 m0, s39, 116736
s_add_u32 s38, s38, 16384
buffer_load_dwordx4 v23, s[28:31], s38 offen lds
s_add_u32 m0, s39, 117760
s_nop 0
buffer_load_dwordx4 v24, s[28:31], s38 offen lds
s_waitcnt vmcnt(10)
s_barrier
s_cmp_eq_u32 s47, 0
s_cbranch_scc0 Lw_133
s_add_u32 s7, s34, 48
s_lshl_b32 s7, s7, 7
v_mov_b32 v26, s7
v_mov_b32 v27, 1
s_mov_b64 exec, 1
buffer_atomic_add v27, v26, s[56:59], 0 offen sc1
s_mov_b64 exec, -1
Lw_133:
s_add_u32 s37, s52, 704512
s_add_u32 m0, s39, 131072
s_nop 0
buffer_load_dwordx4 v3, s[24:27], s37 offen sc1 lds
buffer_load_dwordx4 v3, s[24:27], s37 offen offset:1024 sc1 lds
buffer_load_dwordx4 v3, s[24:27], s37 offen offset:2048 sc1 lds
buffer_load_dwordx4 v3, s[24:27], s37 offen offset:3072 sc1 lds
s_add_u32 s38, s53, 5636096
s_add_u32 m0, s39, 0
s_nop 0
buffer_load_dwordx4 v23, s[28:31], s38 offen lds
s_add_u32 m0, s39, 1024
s_nop 0
buffer_load_dwordx4 v24, s[28:31], s38 offen lds
s_add_u32 m0, s39, 2048
s_add_u32 s38, s38, 16384
buffer_load_dwordx4 v23, s[28:31], s38 offen lds
s_add_u32 m0, s39, 3072
s_nop 0
buffer_load_dwordx4 v24, s[28:31], s38 offen lds
s_waitcnt vmcnt(26)
s_barrier
s_add_u32 s38, s91, 0
s_add_u32 m0, s39, 32768
s_nop 0
buffer_load_dwordx4 v23, s[28:31], s38 offen lds
s_add_u32 m0, s39, 33792
s_nop 0
buffer_load_dwordx4 v24, s[28:31], s38 offen lds
s_add_u32 m0, s39, 34816
s_add_u32 s38, s38, 16384
buffer_load_dwordx4 v23, s[28:31], s38 offen lds
s_add_u32 m0, s39, 35840
s_nop 0
buffer_load_dwordx4 v24, s[28:31], s38 offen lds
s_waitcnt vmcnt(20)
s_barrier
s_add_u32 s38, s91, 131072
s_add_u32 m0, s39, 65536
s_nop 0
buffer_load_dwordx4 v23, s[28:31], s38 offen lds
s_add_u32 m0, s39, 66560
s_nop 0
buffer_load_dwordx4 v24, s[28:31], s38 offen lds
s_add_u32 m0, s39, 67584
s_add_u32 s38, s38, 16384
buffer_load_dwordx4 v23, s[28:31], s38 offen lds
s_add_u32 m0, s39, 68608
s_nop 0
buffer_load_dwordx4 v24, s[28:31], s38 offen lds
s_waitcnt vmcnt(16)
s_barrier
s_cmp_eq_u32 s47, 3
s_cbranch_scc0 Lw_134
s_lshl_b32 s92, s34, 7
s_add_u32 s92, s92, 28317696
s_load_dword s93, s[82:83], s92 glc
Lw_134:
s_add_u32 s38, s91, 262144
s_add_u32 m0, s39, 147456
s_nop 0
buffer_load_dwordx4 v23, s[28:31], s38 offen lds
s_add_u32 m0, s39, 148480
s_nop 0
buffer_load_dwordx4 v24, s[28:31], s38 offen lds
s_add_u32 m0, s39, 149504
s_add_u32 s38, s38, 16384
buffer_load_dwordx4 v23, s[28:31], s38 offen lds
s_add_u32 m0, s39, 150528
s_nop 0
buffer_load_dwordx4 v24, s[28:31], s38 offen lds
s_waitcnt vmcnt(12)
s_cmp_eq_u32 s47, 3
s_cbranch_scc0 Lw_135
s_mov_b32 s41, 0x40000
s_branch Lpchk_138
Lpoll_136:
s_load_dword s93, s[82:83], s92 glc
Lpchk_138:
s_waitcnt lgkmcnt(0)
s_cmp_eq_u32 s93, 16
s_cbranch_scc1 Lpok_137
s_sub_u32 s41, s41, 1
s_cmp_lg_u32 s41, 0
s_cbranch_scc1 Lpoll_136
Lpok_137:
Lw_135:
s_barrier
s_add_u32 s37, s90, 0
s_add_u32 m0, s39, 16384
s_nop 0
buffer_load_dwordx4 v3, s[24:27], s37 offen sc1 lds
buffer_load_dwordx4 v3, s[24:27], s37 offen offset:1024 sc1 lds
buffer_load_dwordx4 v3, s[24:27], s37 offen offset:2048 sc1 lds
buffer_load_dwordx4 v3, s[24:27], s37 offen offset:3072 sc1 lds
s_add_u32 s37, s90, 16384
s_add_u32 m0, s39, 49152
s_nop 0
buffer_load_dwordx4 v3, s[24:27], s37 offen sc1 lds
buffer_load_dwordx4 v3, s[24:27], s37 offen offset:1024 sc1 lds
buffer_load_dwordx4 v3, s[24:27], s37 offen offset:2048 sc1 lds
buffer_load_dwordx4 v3, s[24:27], s37 offen offset:3072 sc1 lds
s_add_u32 s37, s90, 32768
s_add_u32 m0, s39, 81920
s_nop 0
buffer_load_dwordx4 v3, s[24:27], s37 offen sc1 lds
buffer_load_dwordx4 v3, s[24:27], s37 offen offset:1024 sc1 lds
buffer_load_dwordx4 v3, s[24:27], s37 offen offset:2048 sc1 lds
buffer_load_dwordx4 v3, s[24:27], s37 offen offset:3072 sc1 lds
s_add_u32 s37, s90, 49152
s_add_u32 m0, s39, 98304
s_nop 0
buffer_load_dwordx4 v3, s[24:27], s37 offen sc1 lds
buffer_load_dwordx4 v3, s[24:27], s37 offen offset:1024 sc1 lds
buffer_load_dwordx4 v3, s[24:27], s37 offen offset:2048 sc1 lds
buffer_load_dwordx4 v3, s[24:27], s37 offen offset:3072 sc1 lds
s_add_u32 s38, s91, 393216
s_add_u32 m0, s39, 114688
s_nop 0
buffer_load_dwordx4 v23, s[28:31], s38 offen lds
s_add_u32 m0, s39, 115712
s_nop 0
buffer_load_dwordx4 v24, s[28:31], s38 offen lds
s_add_u32 m0, s39, 116736
s_add_u32 s38, s38, 16384
buffer_load_dwordx4 v23, s[28:31], s38 offen lds
s_add_u32 m0, s39, 117760
s_nop 0
buffer_load_dwordx4 v24, s[28:31], s38 offen lds
s_waitcnt vmcnt(16)
s_barrier
s_add_u32 s37, s90, 65536
s_add_u32 m0, s39, 131072
s_nop 0
buffer_load_dwordx4 v3, s[24:27], s37 offen sc1 lds
buffer_load_dwordx4 v3, s[24:27], s37 offen offset:1024 sc1 lds
buffer_load_dwordx4 v3, s[24:27], s37 offen offset:2048 sc1 lds
buffer_load_dwordx4 v3, s[24:27], s37 offen offset:3072 sc1 lds
s_add_u32 s38, s91, 524288
s_add_u32 m0, s39, 0
s_nop 0
buffer_load_dwordx4 v23, s[28:31], s38 offen lds
s_add_u32 m0, s39, 1024
s_nop 0
buffer_load_dwordx4 v24, s[28:31], s38 offen lds
s_add_u32 m0, s39, 2048
s_add_u32 s38, s38, 16384
buffer_load_dwordx4 v23, s[28:31], s38 offen lds
s_add_u32 m0, s39, 3072
s_nop 0
buffer_load_dwordx4 v24, s[28:31], s38 offen lds
s_waitcnt vmcnt(20)
s_barrier
s_add_u32 s37, s90, 81920
s_add_u32 m0, s39, 16384
s_nop 0
buffer_load_dwordx4 v3, s[24:27], s37 offen sc1 lds
buffer_load_dwordx4 v3, s[24:27], s37 offen offset:1024 sc1 lds
buffer_load_dwordx4 v3, s[24:27], s37 offen offset:2048 sc1 lds
buffer_load_dwordx4 v3, s[24:27], s37 offen offset:3072 sc1 lds
s_add_u32 s38, s91, 655360
s_add_u32 m0, s39, 32768
s_nop 0
buffer_load_dwordx4 v23, s[28:31], s38 offen lds
s_add_u32 m0, s39, 33792
s_nop 0
buffer_load_dwordx4 v24, s[28:31], s38 offen lds
s_add_u32 m0, s39, 34816
s_add_u32 s38, s38, 16384
buffer_load_dwordx4 v23, s[28:31], s38 offen lds
s_add_u32 m0, s39, 35840
s_nop 0
buffer_load_dwordx4 v24, s[28:31], s38 offen lds
s_waitcnt vmcnt(24)
s_barrier
s_add_u32 s37, s90, 98304
s_add_u32 m0, s39, 49152
s_nop 0
buffer_load_dwordx4 v3, s[24:27], s37 offen sc1 lds
buffer_load_dwordx4 v3, s[24:27], s37 offen offset:1024 sc1 lds
buffer_load_dwordx4 v3, s[24:27], s37 offen offset:2048 sc1 lds
buffer_load_dwordx4 v3, s[24:27], s37 offen offset:3072 sc1 lds
s_add_u32 s38, s91, 786432
s_add_u32 m0, s39, 65536
s_nop 0
buffer_load_dwordx4 v23, s[28:31], s38 offen lds
s_add_u32 m0, s39, 66560
s_nop 0
buffer_load_dwordx4 v24, s[28:31], s38 offen lds
s_add_u32 m0, s39, 67584
s_add_u32 s38, s38, 16384
buffer_load_dwordx4 v23, s[28:31], s38 offen lds
s_add_u32 m0, s39, 68608
s_nop 0
buffer_load_dwordx4 v24, s[28:31], s38 offen lds
s_waitcnt vmcnt(24)
s_barrier
s_add_u32 s37, s90, 114688
s_add_u32 m0, s39, 81920
s_nop 0
buffer_load_dwordx4 v3, s[24:27], s37 offen sc1 lds
buffer_load_dwordx4 v3, s[24:27], s37 offen offset:1024 sc1 lds
buffer_load_dwordx4 v3, s[24:27], s37 offen offset:2048 sc1 lds
buffer_load_dwordx4 v3, s[24:27], s37 offen offset:3072 sc1 lds
s_add_u32 s38, s91, 917504
s_add_u32 m0, s39, 147456
s_nop 0
buffer_load_dwordx4 v23, s[28:31], s38 offen lds
s_add_u32 m0, s39, 148480
s_nop 0
buffer_load_dwordx4 v24, s[28:31], s38 offen lds
s_add_u32 m0, s39, 149504
s_add_u32 s38, s38, 16384
buffer_load_dwordx4 v23, s[28:31], s38 offen lds
s_add_u32 m0, s39, 150528
s_nop 0
buffer_load_dwordx4 v24, s[28:31], s38 offen lds
s_waitcnt vmcnt(24)
s_barrier
s_add_u32 s37, s90, 131072
s_add_u32 m0, s39, 98304
s_nop 0
buffer_load_dwordx4 v3, s[24:27], s37 offen sc1 lds
buffer_load_dwordx4 v3, s[24:27], s37 offen offset:1024 sc1 lds
buffer_load_dwordx4 v3, s[24:27], s37 offen offset:2048 sc1 lds
buffer_load_dwordx4 v3, s[24:27], s37 offen offset:3072 sc1 lds
s_add_u32 s38, s91, 1048576
s_add_u32 m0, s39, 114688
s_nop 0
buffer_load_dwordx4 v23, s[28:31], s38 offen lds
s_add_u32 m0, s39, 115712
s_nop 0
buffer_load_dwordx4 v24, s[28:31], s38 offen lds
s_add_u32 m0, s39, 116736
s_add_u32 s38, s38, 16384
buffer_load_dwordx4 v23, s[28:31], s38 offen lds
s_add_u32 m0, s39, 117760
s_nop 0
buffer_load_dwordx4 v24, s[28:31], s38 offen lds
s_waitcnt vmcnt(24)
s_barrier
s_add_u32 s37, s90, 147456
s_add_u32 m0, s39, 131072
s_nop 0
buffer_load_dwordx4 v3, s[24:27], s37 offen sc1 lds
buffer_load_dwordx4 v3, s[24:27], s37 offen offset:1024 sc1 lds
buffer_load_dwordx4 v3, s[24:27], s37 offen offset:2048 sc1 lds
buffer_load_dwordx4 v3, s[24:27], s37 offen offset:3072 sc1 lds
s_add_u32 s38, s91, 1179648
s_add_u32 m0, s39, 0
s_nop 0
buffer_load_dwordx4 v23, s[28:31], s38 offen lds
s_add_u32 m0, s39, 1024
s_nop 0
buffer_load_dwordx4 v24, s[28:31], s38 offen lds
s_add_u32 m0, s39, 2048
s_add_u32 s38, s38, 16384
buffer_load_dwordx4 v23, s[28:31], s38 offen lds
s_add_u32 m0, s39, 3072
s_nop 0
buffer_load_dwordx4 v24, s[28:31], s38 offen lds
s_waitcnt vmcnt(24)
s_barrier
s_mov_b32 s37, 327680
s_add_u32 m0, s39, 16384
s_nop 0
buffer_load_dwordx4 v3, s[24:27], s37 offen sc1 lds
buffer_load_dwordx4 v3, s[24:27], s37 offen offset:1024 sc1 lds
buffer_load_dwordx4 v3, s[24:27], s37 offen offset:2048 sc1 lds
buffer_load_dwordx4 v3, s[24:27], s37 offen offset:3072 sc1 lds
s_mov_b32 s38, 2621440
s_add_u32 m0, s51, 32768
s_nop 0
buffer_load_dwordx4 v25, s[28:31], s38 offen lds
s_add_u32 m0, s51, 33792
s_add_u32 s38, s38, 16384
buffer_load_dwordx4 v25, s[28:31], s38 offen lds
s_waitcnt vmcnt(22)
s_barrier
s_mov_b32 s37, 344064
s_add_u32 m0, s39, 49152
s_nop 0
buffer_load_dwordx4 v3, s[24:27], s37 offen sc1 lds
buffer_load_dwordx4 v3, s[24:27], s37 offen offset:1024 sc1 lds
buffer_load_dwordx4 v3, s[24:27], s37 offen offset:2048 sc1 lds
buffer_load_dwordx4 v3, s[24:27], s37 offen offset:3072 sc1 lds
s_mov_b32 s38, 2752512
s_add_u32 m0, s51, 65536
s_nop 0
buffer_load_dwordx4 v25, s[28:31], s38 offen lds
s_add_u32 m0, s51, 66560
s_add_u32 s38, s38, 16384
buffer_load_dwordx4 v25, s[28:31], s38 offen lds
s_waitcnt vmcnt(20)
s_barrier
s_mov_b32 s37, 360448
s_add_u32 m0, s39, 81920
s_nop 0
buffer_load_dwordx4 v3, s[24:27], s37 offen sc1 lds
buffer_load_dwordx4 v3, s[24:27], s37 offen offset:1024 sc1 lds
buffer_load_dwordx4 v3, s[24:27], s37 offen offset:2048 sc1 lds
buffer_load_dwordx4 v3, s[24:27], s37 offen offset:3072 sc1 lds
s_mov_b32 s38, 2883584
s_add_u32 m0, s51, 147456
s_nop 0
buffer_load_dwordx4 v25, s[28:31], s38 offen lds
s_add_u32 m0, s51, 148480
s_add_u32 s38, s38, 16384
buffer_load_dwordx4 v25, s[28:31], s38 offen lds
s_waitcnt vmcnt(18)
s_barrier
s_mov_b32 s37, 376832
s_add_u32 m0, s39, 98304
s_nop 0
buffer_load_dwordx4 v3, s[24:27], s37 offen sc1 lds
buffer_load_dwordx4 v3, s[24:27], s37 offen offset:1024 sc1 lds
buffer_load_dwordx4 v3, s[24:27], s37 offen offset:2048 sc1 lds
buffer_load_dwordx4 v3, s[24:27], s37 offen offset:3072 sc1 lds
s_mov_b32 s38, 3014656
s_add_u32 m0, s51, 114688
s_nop 0
buffer_load_dwordx4 v25, s[28:31], s38 offen lds
s_add_u32 m0, s51, 115712
s_add_u32 s38, s38, 16384
buffer_load_dwordx4 v25, s[28:31], s38 offen lds
s_waitcnt vmcnt(18)
s_barrier
s_mov_b32 s37, 393216
s_add_u32 m0, s39, 131072
s_nop 0
buffer_load_dwordx4 v3, s[24:27], s37 offen sc1 lds
buffer_load_dwordx4 v3, s[24:27], s37 offen offset:1024 sc1 lds
buffer_load_dwordx4 v3, s[24:27], s37 offen offset:2048 sc1 lds
buffer_load_dwordx4 v3, s[24:27], s37 offen offset:3072 sc1 lds
s_mov_b32 s38, 3145728
s_add_u32 m0, s51, 0
s_nop 0
buffer_load_dwordx4 v25, s[28:31], s38 offen lds
s_add_u32 m0, s51, 1024
s_add_u32 s38, s38, 16384
buffer_load_dwordx4 v25, s[28:31], s38 offen lds
s_waitcnt vmcnt(18)
s_barrier
s_mov_b32 s37, 409600
s_add_u32 m0, s39, 16384
s_nop 0
buffer_load_dwordx4 v3, s[24:27], s37 offen sc1 lds
buffer_load_dwordx4 v3, s[24:27], s37 offen offset:1024 sc1 lds
buffer_load_dwordx4 v3, s[24:27], s37 offen offset:2048 sc1 lds
buffer_load_dwordx4 v3, s[24:27], s37 offen offset:3072 sc1 lds
s_mov_b32 s38, 3276800
s_add_u32 m0, s51, 32768
s_nop 0
buffer_load_dwordx4 v25, s[28:31], s38 offen lds
s_add_u32 m0, s51, 33792
s_add_u32 s38, s38, 16384
buffer_load_dwordx4 v25, s[28:31], s38 offen lds
s_waitcnt vmcnt(18)
s_barrier
s_mov_b32 s37, 425984
s_add_u32 m0, s39, 49152
s_branch Lov_18
.p2align 12
.fill 144, 4, 0xbf800000
Lst_18_0:
s_branch Lwr_159
Lst_18_1:
s_branch Lwr_171
s_nop 0
Lov_18:
s_nop 0
buffer_load_dwordx4 v3, s[24:27], s37 offen sc1 lds
buffer_load_dwordx4 v3, s[24:27], s37 offen offset:1024 sc1 lds
buffer_load_dwordx4 v3, s[24:27], s37 offen offset:2048 sc1 lds
buffer_load_dwordx4 v3, s[24:27], s37 offen offset:3072 sc1 lds
s_mov_b32 s38, 3407872
s_add_u32 m0, s51, 65536
s_nop 0
buffer_load_dwordx4 v25, s[28:31], s38 offen lds
s_add_u32 m0, s51, 66560
s_add_u32 s38, s38, 16384
buffer_load_dwordx4 v25, s[28:31], s38 offen lds
s_waitcnt vmcnt(18)
s_barrier
s_mov_b32 s37, 442368
s_add_u32 m0, s39, 81920
s_nop 0
buffer_load_dwordx4 v3, s[24:27], s37 offen sc1 lds
buffer_load_dwordx4 v3, s[24:27], s37 offen offset:1024 sc1 lds
buffer_load_dwordx4 v3, s[24:27], s37 offen offset:2048 sc1 lds
buffer_load_dwordx4 v3, s[24:27], s37 offen offset:3072 sc1 lds
s_mov_b32 s38, 3538944
s_add_u32 m0, s51, 147456
s_nop 0
buffer_load_dwordx4 v25, s[28:31], s38 offen lds
s_add_u32 m0, s51, 148480
s_add_u32 s38, s38, 16384
buffer_load_dwordx4 v25, s[28:31], s38 offen lds
s_waitcnt vmcnt(18)
s_barrier
s_mov_b32 s37, 458752
s_add_u32 m0, s39, 98304
s_nop 0
buffer_load_dwordx4 v3, s[24:27], s37 offen sc1 lds
buffer_load_dwordx4 v3, s[24:27], s37 offen offset:1024 sc1 lds
buffer_load_dwordx4 v3, s[24:27], s37 offen offset:2048 sc1 lds
buffer_load_dwordx4 v3, s[24:27], s37 offen offset:3072 sc1 lds
s_mov_b32 s38, 3670016
s_add_u32 m0, s51, 114688
s_nop 0
buffer_load_dwordx4 v25, s[28:31], s38 offen lds
s_add_u32 m0, s51, 115712
s_add_u32 s38, s38, 16384
buffer_load_dwordx4 v25, s[28:31], s38 offen lds
s_waitcnt vmcnt(18)
s_barrier
s_mov_b32 s37, 475136
s_add_u32 m0, s39, 131072
s_nop 0
buffer_load_dwordx4 v3, s[24:27], s37 offen sc1 lds
buffer_load_dwordx4 v3, s[24:27], s37 offen offset:1024 sc1 lds
buffer_load_dwordx4 v3, s[24:27], s37 offen offset:2048 sc1 lds
buffer_load_dwordx4 v3, s[24:27], s37 offen offset:3072 sc1 lds
s_mov_b32 s38, 3801088
s_add_u32 m0, s51, 0
s_nop 0
buffer_load_dwordx4 v25, s[28:31], s38 offen lds
s_add_u32 m0, s51, 1024
s_add_u32 s38, s38, 16384
buffer_load_dwordx4 v25, s[28:31], s38 offen lds
s_waitcnt vmcnt(18)
s_barrier
s_cmp_eq_u32 s47, 0
s_cbranch_scc0 Lw_139
s_xor_b32 s43, s2, 2
s_add_u32 s43, s43, 128
s_lshl_b32 s43, s43, 7
v_mov_b32 v26, s43
v_mov_b32 v27, 1
s_mov_b64 exec, 1
buffer_store_dword v27, v26, s[56:59], 0 offen sc1
s_mov_b64 exec, -1
Lw_139:
s_mov_b32 s37, 491520
s_add_u32 m0, s39, 16384
s_nop 0
buffer_load_dwordx4 v3, s[24:27], s37 offen sc1 lds
buffer_load_dwordx4 v3, s[24:27], s37 offen offset:1024 sc1 lds
buffer_load_dwordx4 v3, s[24:27], s37 offen offset:2048 sc1 lds
buffer_load_dwordx4 v3, s[24:27], s37 offen offset:3072 sc1 lds
s_mov_b32 s38, 3932160
s_add_u32 m0, s51, 32768
s_nop 0
buffer_load_dwordx4 v25, s[28:31], s38 offen lds
s_add_u32 m0, s51, 33792
s_add_u32 s38, s38, 16384
buffer_load_dwordx4 v25, s[28:31], s38 offen lds
s_waitcnt vmcnt(18)
s_barrier
s_mov_b32 s37, 507904
s_add_u32 m0, s39, 49152
s_nop 0
buffer_load_dwordx4 v3, s[24:27], s37 offen sc1 lds
buffer_load_dwordx4 v3, s[24:27], s37 offen offset:1024 sc1 lds
buffer_load_dwordx4 v3, s[24:27], s37 offen offset:2048 sc1 lds
buffer_load_dwordx4 v3, s[24:27], s37 offen offset:3072 sc1 lds
s_mov_b32 s38, 4063232
s_add_u32 m0, s51, 65536
s_nop 0
buffer_load_dwordx4 v25, s[28:31], s38 offen lds
s_add_u32 m0, s51, 66560
s_add_u32 s38, s38, 16384
buffer_load_dwordx4 v25, s[28:31], s38 offen lds
s_waitcnt vmcnt(18)
s_barrier
s_cmp_eq_u32 s47, 3
s_cbranch_scc0 Lw_140
s_lshl_b32 s92, s2, 7
s_add_u32 s92, s92, 28327936
s_load_dword s93, s[82:83], s92 glc
Lw_140:
s_waitcnt vmcnt(12)
s_cmp_eq_u32 s47, 3
s_cbranch_scc0 Lw_141
s_mov_b32 s41, 0x40000
s_branch Lpchk_144
Lpoll_142:
s_load_dword s93, s[82:83], s92 glc
Lpchk_144:
s_waitcnt lgkmcnt(0)
s_cmp_eq_u32 s93, 1
s_cbranch_scc1 Lpok_143
s_sub_u32 s41, s41, 1
s_cmp_lg_u32 s41, 0
s_cbranch_scc1 Lpoll_142
Lpok_143:
Lw_141:
s_barrier
s_waitcnt vmcnt(6)
s_barrier
s_waitcnt vmcnt(0)
s_barrier
s_barrier
s_branch Ldone_1
Ldone_1:
Lfin:
Lexit_2:
s_endpgm
.section .rodata,"a"
.p2align 6
.amdhsa_kernel sequential_preLN__sliding_local_dilated__glu_gated_geglu__prompt_kernel
  .amdhsa_next_free_vgpr 256
  .amdhsa_next_free_sgpr 100
  .amdhsa_accum_offset 256
  .amdhsa_group_segment_fixed_size 0
  .amdhsa_kernarg_size 80
  .amdhsa_user_sgpr_count 2
  .amdhsa_user_sgpr_kernarg_segment_ptr 1
  .amdhsa_system_sgpr_workgroup_id_x 1
  .amdhsa_float_denorm_mode_32 3
  .amdhsa_float_denorm_mode_16_64 3
.end_amdhsa_kernel
```

```asm
; @launch grid=(256,1,1) block=(512,1,1) lds=163840
.amdgcn_target "amdgcn-amd-amdhsa--gfx950"
.text
.globl sequential_preLN__sliding_local_dilated__glu_gated_geglu__prompt_kernel
.p2align 8
.type sequential_preLN__sliding_local_dilated__glu_gated_geglu__prompt_kernel,@function
sequential_preLN__sliding_local_dilated__glu_gated_geglu__prompt_kernel:
s_cmp_ge_u32 s2, 256
s_cbranch_scc1 Lexit_2
s_load_dwordx16 s[64:79], s[0:1], 0
s_load_dwordx4 s[80:83], s[0:1], 64
s_and_b32 s3, s2, 7
s_lshr_b32 s42, s2, 3
s_and_b32 s34, s3, 1
s_lshl_b32 s34, s34, 3
s_and_b32 s48, s42, 7
s_add_u32 s34, s34, s48
s_lshr_b32 s35, s3, 1
s_lshr_b32 s49, s42, 3
s_lshl_b32 s35, s35, 2
s_add_u32 s35, s35, s49
v_lshrrev_b32 v12, 6, v0
v_and_b32 v1, 63, v0
v_readfirstlane_b32 s36, v12
Lbeg:
s_lshl_b32 s50, s34, 7
s_sub_u32 s50, s50, 16
v_and_b32 v12, 15, v1
v_lshrrev_b32 v13, 4, v1
s_cmp_lt_u32 s36, 4
s_cbranch_scc1 Lcons_7
Lprod_3:
s_sub_u32 s47, s36, 4
s_lshl_b32 s43, s34, 7
s_lshl_b32 s44, s35, 3
s_add_u32 s63, s43, s44
s_lshl_b32 s44, s47, 1
s_add_u32 s51, s63, s44
v_lshlrev_b32 v10, 4, v1
s_and_b32 s43, s2, 7
s_lshr_b32 s44, s43, 2
s_lshl_b32 s44, s44, 1
s_and_b32 s45, s43, 1
s_add_u32 s44, s44, s45
s_lshr_b32 s45, s2, 3
s_lshl_b32 s45, s45, 2
s_add_u32 s44, s44, s45
s_add_u32 s44, s44, 96
s_bitcmp1_b32 s43, 1
s_cselect_b32 s44, s44, 0x10000
s_cmp_lt_u32 s2, 192
s_cselect_b32 s33, s2, s44
v_lshrrev_b32 v14, 3, v1
v_and_b32 v15, 7, v1
v_lshl_add_u32 v19, v14, 6, v15
s_lshl_b32 s43, s48, 3
v_add_u32 v19, s43, v19
v_mul_u32_u24 v19, 6144, v19
s_cmp_eq_u32 s47, 3
s_cbranch_scc1 Lpf_4
v_and_b32 v16, 2, v14
v_xor_b32 v16, v15, v16
v_lshlrev_b32 v16, 4, v16
v_mul_u32_u24 v17, 6144, v14
s_lshl_b32 s43, s47, 11
v_add3_u32 v2, v17, v16, s43
v_xor_b32 v3, 64, v2
v_lshrrev_b32 v16, 1, v14
v_xor_b32 v16, v15, v16
v_lshlrev_b32 v16, 4, v16
s_lshl_b32 s43, s47, 3
s_add_u32 s43, s43, s50
v_add_u32 v17, s43, v14
s_and_b32 s44, s47, 1
s_lshl_b32 s44, s44, 6
v_add_u32 v18, 0, v17
v_max_i32 v18, 0, v18
v_lshl_add_u32 v18, v18, 11, v16
v_xor_b32 v18, s44, v18
v_mov_b32 v4, v18
v_add_u32 v18, 24, v17
v_max_i32 v18, 0, v18
v_lshl_add_u32 v18, v18, 11, v16
v_xor_b32 v18, s44, v18
v_xor_b32 v5, 64, v18
v_add_u32 v18, 48, v17
v_max_i32 v18, 0, v18
v_lshl_add_u32 v18, v18, 11, v16
v_xor_b32 v18, s44, v18
v_mov_b32 v6, v18
v_add_u32 v18, 72, v17
v_max_i32 v18, 0, v18
v_lshl_add_u32 v18, v18, 11, v16
v_xor_b32 v18, s44, v18
v_xor_b32 v7, 64, v18
v_add_u32 v18, 96, v17
v_max_i32 v18, 0, v18
v_lshl_add_u32 v18, v18, 11, v16
v_xor_b32 v18, s44, v18
v_mov_b32 v8, v18
v_add_u32 v18, 120, v17
v_max_i32 v18, 0, v18
v_lshl_add_u32 v18, v18, 11, v16
v_xor_b32 v18, s44, v18
v_xor_b32 v9, 64, v18
s_lshl_b32 s39, s47, 10
s_lshl_b32 s40, s47, 13
s_add_u32 s40, s40, 18432
s_mov_b32 s37, 0
s_mov_b32 s38, 0
s_bfm_b64 s[60:61], 56, 8
s_cmp_eq_u32 s47, 0
s_cselect_b64 s[60:61], s[60:61], -1
s_lshl_b32 s43, s35, 7
s_waitcnt lgkmcnt(0)
s_mov_b32 s8, s64
s_mov_b32 s9, s65
s_mov_b32 s10, 4194304
s_mov_b32 s11, 0x20000
s_add_u32 s12, s66, s43
s_addc_u32 s13, s67, 0
s_mov_b32 s14, 6289536
s_mov_b32 s15, 0x20000
s_mov_b32 s28, s66
s_mov_b32 s29, s67
s_mov_b32 s30, 6291456
s_mov_b32 s31, 0x20000
s_mul_i32 s43, s33, 5376
v_lshlrev_b32 v30, 7, v1
s_mul_i32 s44, s47, 1792
s_add_u32 s43, s43, s44
s_bfm_b64 exec, 14, 0
buffer_load_dword v31, v30, s[28:31], s43 offen
s_mov_b64 exec, -1
s_add_u32 m0, s39, 0
s_mov_b64 exec, s[60:61]
buffer_load_dwordx4 v4, s[8:11], s37 offen lds
s_mov_b64 exec, -1
s_add_u32 m0, s39, 3072
s_nop 0
buffer_load_dwordx4 v5, s[8:11], s37 offen lds
s_add_u32 m0, s39, 6144
s_nop 0
buffer_load_dwordx4 v6, s[8:11], s37 offen lds
s_add_u32 m0, s39, 9216
s_nop 0
buffer_load_dwordx4 v7, s[8:11], s37 offen lds
s_add_u32 m0, s39, 12288
s_nop 0
buffer_load_dwordx4 v8, s[8:11], s37 offen lds
s_add_u32 m0, s39, 15360
s_nop 0
buffer_load_dwordx4 v9, s[8:11], s37 offen lds
s_add_u32 m0, s40, 0
s_add_u32 s43, s38, 0
buffer_load_dwordx4 v2, s[12:15], s43 offen lds
s_add_u32 m0, s40, 1024
s_add_u32 s43, s38, 49152
buffer_load_dwordx4 v3, s[12:15], s43 offen lds
s_add_u32 m0, s40, 2048
s_add_u32 s43, s38, 98304
buffer_load_dwordx4 v2, s[12:15], s43 offen lds
s_add_u32 m0, s40, 3072
s_add_u32 s43, s38, 147456
buffer_load_dwordx4 v3, s[12:15], s43 offen lds
s_add_u32 m0, s40, 4096
s_add_u32 s43, s38, 196608
buffer_load_dwordx4 v2, s[12:15], s43 offen lds
s_add_u32 m0, s40, 5120
s_add_u32 s43, s38, 245760
buffer_load_dwordx4 v3, s[12:15], s43 offen lds
s_add_u32 m0, s40, 6144
s_add_u32 s43, s38, 294912
buffer_load_dwordx4 v2, s[12:15], s43 offen lds
s_add_u32 m0, s40, 7168
s_add_u32 s43, s38, 344064
buffer_load_dwordx4 v3, s[12:15], s43 offen lds
s_add_u32 s37, s37, 128
s_add_u32 s38, s38, 393216
s_lshl_b32 s43, s51, 11
buffer_load_dwordx4 v[96:99], v10, s[8:11], s43 offen offset:0
buffer_load_dwordx4 v[100:103], v10, s[8:11], s43 offen offset:1024
buffer_load_dwordx4 v[104:107], v10, s[8:11], s43 offen offset:2048
buffer_load_dwordx4 v[108:111], v10, s[8:11], s43 offen offset:3072
s_add_u32 m0, s39, 43008
s_mov_b64 exec, s[60:61]
buffer_load_dwordx4 v4, s[8:11], s37 offen lds
s_mov_b64 exec, -1
s_add_u32 m0, s39, 46080
s_nop 0
buffer_load_dwordx4 v5, s[8:11], s37 offen lds
s_add_u32 m0, s39, 49152
s_nop 0
buffer_load_dwordx4 v6, s[8:11], s37 offen lds
s_add_u32 m0, s39, 52224
s_nop 0
buffer_load_dwordx4 v7, s[8:11], s37 offen lds
s_add_u32 m0, s39, 55296
s_nop 0
buffer_load_dwordx4 v8, s[8:11], s37 offen lds
s_add_u32 m0, s39, 58368
s_nop 0
buffer_load_dwordx4 v9, s[8:11], s37 offen lds
s_add_u32 m0, s40, 43008
s_add_u32 s43, s38, 0
buffer_load_dwordx4 v2, s[12:15], s43 offen lds
s_add_u32 m0, s40, 44032
s_add_u32 s43, s38, 49152
buffer_load_dwordx4 v3, s[12:15], s43 offen lds
s_add_u32 m0, s40, 45056
s_add_u32 s43, s38, 98304
buffer_load_dwordx4 v2, s[12:15], s43 offen lds
s_add_u32 m0, s40, 46080
s_add_u32 s43, s38, 147456
buffer_load_dwordx4 v3, s[12:15], s43 offen lds
s_add_u32 m0, s40, 47104
s_add_u32 s43, s38, 196608
buffer_load_dwordx4 v2, s[12:15], s43 offen lds
s_add_u32 m0, s40, 48128
s_add_u32 s43, s38, 245760
buffer_load_dwordx4 v3, s[12:15], s43 offen lds
s_add_u32 m0, s40, 49152
s_add_u32 s43, s38, 294912
buffer_load_dwordx4 v2, s[12:15], s43 offen lds
s_add_u32 m0, s40, 50176
s_add_u32 s43, s38, 344064
buffer_load_dwordx4 v3, s[12:15], s43 offen lds
s_add_u32 s37, s37, 128
s_add_u32 s38, s38, 393216
s_waitcnt vmcnt(18)
s_barrier
s_add_u32 m0, s39, 86016
s_mov_b64 exec, s[60:61]
buffer_load_dwordx4 v4, s[8:11], s37 offen lds
s_mov_b64 exec, -1
s_add_u32 m0, s39, 89088
s_nop 0
buffer_load_dwordx4 v5, s[8:11], s37 offen lds
s_add_u32 m0, s39, 92160
s_nop 0
buffer_load_dwordx4 v6, s[8:11], s37 offen lds
s_add_u32 m0, s39, 95232
s_nop 0
buffer_load_dwordx4 v7, s[8:11], s37 offen lds
s_add_u32 m0, s39, 98304
s_nop 0
buffer_load_dwordx4 v8, s[8:11], s37 offen lds
s_add_u32 m0, s39, 101376
s_nop 0
buffer_load_dwordx4 v9, s[8:11], s37 offen lds
s_add_u32 m0, s40, 86016
s_add_u32 s43, s38, 0
buffer_load_dwordx4 v2, s[12:15], s43 offen lds
s_add_u32 m0, s40, 87040
s_add_u32 s43, s38, 49152
buffer_load_dwordx4 v3, s[12:15], s43 offen lds
s_add_u32 m0, s40, 88064
s_add_u32 s43, s38, 98304
buffer_load_dwordx4 v2, s[12:15], s43 offen lds
s_add_u32 m0, s40, 89088
s_add_u32 s43, s38, 147456
buffer_load_dwordx4 v3, s[12:15], s43 offen lds
s_add_u32 m0, s40, 90112
s_add_u32 s43, s38, 196608
buffer_load_dwordx4 v2, s[12:15], s43 offen lds
s_add_u32 m0, s40, 91136
s_add_u32 s43, s38, 245760
buffer_load_dwordx4 v3, s[12:15], s43 offen lds
s_add_u32 m0, s40, 92160
s_add_u32 s43, s38, 294912
buffer_load_dwordx4 v2, s[12:15], s43 offen lds
s_add_u32 m0, s40, 93184
s_add_u32 s43, s38, 344064
buffer_load_dwordx4 v3, s[12:15], s43 offen lds
s_add_u32 s37, s37, 128
s_add_u32 s38, s38, 393216
s_waitcnt vmcnt(28)
s_mov_b32 s43, 0x3f803f80
v_mov_b32 v116, 0
v_mov_b32 v117, 0
v_mov_b32 v118, 0
v_mov_b32 v119, 0
v_mov_b32 v120, 0
v_mov_b32 v121, 0
v_mov_b32 v122, 0
v_mov_b32 v123, 0
v_dot2_f32_bf16 v116, v96, s43, v116
v_dot2_f32_bf16 v120, v96, v96, v120
v_dot2_f32_bf16 v118, v104, s43, v118
v_dot2_f32_bf16 v122, v104, v104, v122
v_dot2_f32_bf16 v117, v97, s43, v117
v_dot2_f32_bf16 v121, v97, v97, v121
v_dot2_f32_bf16 v119, v105, s43, v119
v_dot2_f32_bf16 v123, v105, v105, v123
v_dot2_f32_bf16 v116, v98, s43, v116
v_dot2_f32_bf16 v120, v98, v98, v120
v_dot2_f32_bf16 v118, v106, s43, v118
v_dot2_f32_bf16 v122, v106, v106, v122
v_dot2_f32_bf16 v117, v99, s43, v117
v_dot2_f32_bf16 v121, v99, v99, v121
v_dot2_f32_bf16 v119, v107, s43, v119
v_dot2_f32_bf16 v123, v107, v107, v123
v_dot2_f32_bf16 v116, v100, s43, v116
v_dot2_f32_bf16 v120, v100, v100, v120
v_dot2_f32_bf16 v118, v108, s43, v118
v_dot2_f32_bf16 v122, v108, v108, v122
v_dot2_f32_bf16 v117, v101, s43, v117
v_dot2_f32_bf16 v121, v101, v101, v121
v_dot2_f32_bf16 v119, v109, s43, v119
v_dot2_f32_bf16 v123, v109, v109, v123
v_dot2_f32_bf16 v116, v102, s43, v116
v_dot2_f32_bf16 v120, v102, v102, v120
v_dot2_f32_bf16 v118, v110, s43, v118
v_dot2_f32_bf16 v122, v110, v110, v122
v_dot2_f32_bf16 v117, v103, s43, v117
v_dot2_f32_bf16 v121, v103, v103, v121
v_dot2_f32_bf16 v119, v111, s43, v119
v_dot2_f32_bf16 v123, v111, v111, v123
s_nop 2
v_add_f32 v116, v116, v117
v_add_f32 v118, v118, v119
v_add_f32 v120, v120, v121
v_add_f32 v122, v122, v123
s_nop 1
v_permlane32_swap_b32 v116, v118
v_permlane32_swap_b32 v120, v122
v_add_f32 v116, v116, v118
v_add_f32 v120, v120, v122
s_nop 1
v_permlane16_swap_b32 v116, v120
v_add_f32 v116, v116, v120
s_nop 1
v_add_f32_dpp v116, v116, v116 row_ror:8 row_mask:0xf bank_mask:0xf
s_nop 1
v_add_f32_dpp v116, v116, v116 row_ror:4 row_mask:0xf bank_mask:0xf
s_nop 1
v_add_f32_dpp v116, v116, v116 row_ror:2 row_mask:0xf bank_mask:0xf
s_nop 1
v_add_f32_dpp v116, v116, v116 row_ror:1 row_mask:0xf bank_mask:0xf
v_mov_b32 v117, v116
s_nop 1
v_permlane16_swap_b32 v116, v117
v_mul_f32 v112, 0x3a800000, v116
v_mul_f32 v113, 0x3a800000, v117
v_fma_f32 v113, -v112, v112, v113
v_max_f32 v113, 0, v113
v_add_f32 v113, 0x3727c5ac, v113
v_rsq_f32 v113, v113
v_lshrrev_b32 v11, 5, v1
s_lshl_b32 s43, s47, 4
s_add_u32 s43, s43, 148608
v_lshl_add_u32 v11, v11, 3, s43
ds_write_b64 v11, v[112:113]
s_waitcnt lgkmcnt(0)
s_and_b32 s44, s36, 3
s_mul_i32 s44, s44, 24
s_bfe_u32 s43, s2, 0x30001
s_lshl_b32 s43, s43, 7
s_add_u32 s44, s44, s43
s_mul_i32 s44, s44, 7168
s_lshr_b32 s43, s2, 4
s_lshl_b32 s43, s43, 8
s_add_u32 s43, s43, s44
s_bitcmp0_b32 s2, 0
s_cselect_b32 s4, s72, s74
s_cselect_b32 s5, s73, s75
s_add_u32 s4, s4, s43
s_addc_u32 s5, s5, 0
s_waitcnt vmcnt(14)
s_barrier
s_add_u32 m0, s39, 0
s_mov_b64 exec, s[60:61]
buffer_load_dwordx4 v4, s[8:11], s37 offen lds
s_mov_b64 exec, -1
s_add_u32 m0, s39, 3072
s_nop 0
buffer_load_dwordx4 v5, s[8:11], s37 offen lds
s_add_u32 m0, s39, 6144
s_nop 0
buffer_load_dwordx4 v6, s[8:11], s37 offen lds
s_add_u32 m0, s39, 9216
s_nop 0
buffer_load_dwordx4 v7, s[8:11], s37 offen lds
s_add_u32 m0, s39, 12288
s_nop 0
buffer_load_dwordx4 v8, s[8:11], s37 offen lds
s_add_u32 m0, s39, 15360
s_nop 0
buffer_load_dwordx4 v9, s[8:11], s37 offen lds
s_add_u32 m0, s40, 0
s_add_u32 s43, s38, 0
buffer_load_dwordx4 v2, s[12:15], s43 offen lds
s_add_u32 m0, s40, 1024
s_add_u32 s43, s38, 49152
buffer_load_dwordx4 v3, s[12:15], s43 offen lds
s_add_u32 m0, s40, 2048
s_add_u32 s43, s38, 98304
buffer_load_dwordx4 v2, s[12:15], s43 offen lds
s_add_u32 m0, s40, 3072
s_add_u32 s43, s38, 147456
buffer_load_dwordx4 v3, s[12:15], s43 offen lds
s_add_u32 m0, s40, 4096
s_add_u32 s43, s38, 196608
buffer_load_dwordx4 v2, s[12:15], s43 offen lds
s_add_u32 m0, s40, 5120
s_add_u32 s43, s38, 245760
buffer_load_dwordx4 v3, s[12:15], s43 offen lds
s_add_u32 m0, s40, 6144
s_add_u32 s43, s38, 294912
buffer_load_dwordx4 v2, s[12:15], s43 offen lds
s_add_u32 m0, s40, 7168
s_add_u32 s43, s38, 344064
buffer_load_dwordx4 v3, s[12:15], s43 offen lds
s_add_u32 s37, s37, 128
s_add_u32 s38, s38, 393216
s_waitcnt vmcnt(14)
s_barrier
s_add_u32 m0, s39, 43008
s_mov_b64 exec, s[60:61]
buffer_load_dwordx4 v4, s[8:11], s37 offen lds
s_mov_b64 exec, -1
s_add_u32 m0, s39, 46080
s_nop 0
buffer_load_dwordx4 v5, s[8:11], s37 offen lds
s_add_u32 m0, s39, 49152
s_nop 0
buffer_load_dwordx4 v6, s[8:11], s37 offen lds
s_add_u32 m0, s39, 52224
s_nop 0
buffer_load_dwordx4 v7, s[8:11], s37 offen lds
s_add_u32 m0, s39, 55296
s_nop 0
buffer_load_dwordx4 v8, s[8:11], s37 offen lds
s_add_u32 m0, s39, 58368
s_nop 0
buffer_load_dwordx4 v9, s[8:11], s37 offen lds
s_add_u32 m0, s40, 43008
s_add_u32 s43, s38, 0
buffer_load_dwordx4 v2, s[12:15], s43 offen lds
s_add_u32 m0, s40, 44032
s_add_u32 s43, s38, 49152
buffer_load_dwordx4 v3, s[12:15], s43 offen lds
s_add_u32 m0, s40, 45056
s_add_u32 s43, s38, 98304
buffer_load_dwordx4 v2, s[12:15], s43 offen lds
s_add_u32 m0, s40, 46080
s_add_u32 s43, s38, 147456
buffer_load_dwordx4 v3, s[12:15], s43 offen lds
s_add_u32 m0, s40, 47104
s_add_u32 s43, s38, 196608
buffer_load_dwordx4 v2, s[12:15], s43 offen lds
s_add_u32 m0, s40, 48128
s_add_u32 s43, s38, 245760
buffer_load_dwordx4 v3, s[12:15], s43 offen lds
s_add_u32 m0, s40, 49152
s_add_u32 s43, s38, 294912
buffer_load_dwordx4 v2, s[12:15], s43 offen lds
s_add_u32 m0, s40, 50176
s_add_u32 s43, s38, 344064
buffer_load_dwordx4 v3, s[12:15], s43 offen lds
s_add_u32 s37, s37, 128
s_add_u32 s38, s38, 393216
s_load_dword s3, s[4:5], 0
s_load_dword s3, s[4:5], 64
s_load_dword s3, s[4:5], 128
s_waitcnt vmcnt(14)
s_barrier
s_add_u32 m0, s39, 86016
s_mov_b64 exec, s[60:61]
buffer_load_dwordx4 v4, s[8:11], s37 offen lds
s_mov_b64 exec, -1
s_add_u32 m0, s39, 89088
s_nop 0
buffer_load_dwordx4 v5, s[8:11], s37 offen lds
s_add_u32 m0, s39, 92160
s_nop 0
buffer_load_dwordx4 v6, s[8:11], s37 offen lds
s_add_u32 m0, s39, 95232
s_nop 0
buffer_load_dwordx4 v7, s[8:11], s37 offen lds
s_add_u32 m0, s39, 98304
s_nop 0
buffer_load_dwordx4 v8, s[8:11], s37 offen lds
s_add_u32 m0, s39, 101376
s_nop 0
buffer_load_dwordx4 v9, s[8:11], s37 offen lds
s_add_u32 m0, s40, 86016
s_add_u32 s43, s38, 0
buffer_load_dwordx4 v2, s[12:15], s43 offen lds
s_add_u32 m0, s40, 87040
s_add_u32 s43, s38, 49152
buffer_load_dwordx4 v3, s[12:15], s43 offen lds
s_add_u32 m0, s40, 88064
s_add_u32 s43, s38, 98304
buffer_load_dwordx4 v2, s[12:15], s43 offen lds
s_add_u32 m0, s40, 89088
s_add_u32 s43, s38, 147456
buffer_load_dwordx4 v3, s[12:15], s43 offen lds
s_add_u32 m0, s40, 90112
s_add_u32 s43, s38, 196608
buffer_load_dwordx4 v2, s[12:15], s43 offen lds
s_add_u32 m0, s40, 91136
s_add_u32 s43, s38, 245760
buffer_load_dwordx4 v3, s[12:15], s43 offen lds
s_add_u32 m0, s40, 92160
s_add_u32 s43, s38, 294912
buffer_load_dwordx4 v2, s[12:15], s43 offen lds
s_add_u32 m0, s40, 93184
s_add_u32 s43, s38, 344064
buffer_load_dwordx4 v3, s[12:15], s43 offen lds
s_add_u32 s37, s37, 128
s_add_u32 s38, s38, 393216
s_load_dword s3, s[4:5], 192
s_load_dword s3, s[4:5], 7168
s_load_dword s3, s[4:5], 7232
s_load_dword s3, s[4:5], 7296
s_waitcnt vmcnt(14)
s_barrier
s_add_u32 m0, s39, 0
s_mov_b64 exec, s[60:61]
buffer_load_dwordx4 v4, s[8:11], s37 offen lds
s_mov_b64 exec, -1
s_add_u32 m0, s39, 3072
s_nop 0
buffer_load_dwordx4 v5, s[8:11], s37 offen lds
s_add_u32 m0, s39, 6144
s_nop 0
buffer_load_dwordx4 v6, s[8:11], s37 offen lds
s_add_u32 m0, s39, 9216
s_nop 0
s_branch Lov_0
.p2align 12
Lst_0_0:
s_branch Lst_1_0
s_nop 0
s_nop 0
Lov_0:
buffer_load_dwordx4 v7, s[8:11], s37 offen lds
s_add_u32 m0, s39, 12288
s_nop 0
buffer_load_dwordx4 v8, s[8:11], s37 offen lds
s_add_u32 m0, s39, 15360
s_nop 0
buffer_load_dwordx4 v9, s[8:11], s37 offen lds
s_add_u32 m0, s40, 0
s_add_u32 s43, s38, 0
buffer_load_dwordx4 v2, s[12:15], s43 offen lds
s_add_u32 m0, s40, 1024
s_add_u32 s43, s38, 49152
buffer_load_dwordx4 v3, s[12:15], s43 offen lds
s_add_u32 m0, s40, 2048
s_add_u32 s43, s38, 98304
buffer_load_dwordx4 v2, s[12:15], s43 offen lds
s_add_u32 m0, s40, 3072
s_add_u32 s43, s38, 147456
buffer_load_dwordx4 v3, s[12:15], s43 offen lds
s_add_u32 m0, s40, 4096
s_add_u32 s43, s38, 196608
buffer_load_dwordx4 v2, s[12:15], s43 offen lds
s_add_u32 m0, s40, 5120
s_add_u32 s43, s38, 245760
buffer_load_dwordx4 v3, s[12:15], s43 offen lds
s_add_u32 m0, s40, 6144
s_add_u32 s43, s38, 294912
buffer_load_dwordx4 v2, s[12:15], s43 offen lds
s_add_u32 m0, s40, 7168
s_add_u32 s43, s38, 344064
buffer_load_dwordx4 v3, s[12:15], s43 offen lds
s_add_u32 s37, s37, 128
s_add_u32 s38, s38, 393216
s_load_dword s3, s[4:5], 7360
s_load_dword s3, s[4:5], 14336
s_load_dword s3, s[4:5], 14400
s_load_dword s3, s[4:5], 14464
s_load_dword s3, s[4:5], 14528
s_waitcnt vmcnt(14)
s_barrier
s_add_u32 m0, s39, 43008
s_mov_b64 exec, s[60:61]
buffer_load_dwordx4 v4, s[8:11], s37 offen lds
s_mov_b64 exec, -1
s_add_u32 m0, s39, 46080
s_nop 0
buffer_load_dwordx4 v5, s[8:11], s37 offen lds
s_add_u32 m0, s39, 49152
s_nop 0
buffer_load_dwordx4 v6, s[8:11], s37 offen lds
s_add_u32 m0, s39, 52224
s_nop 0
buffer_load_dwordx4 v7, s[8:11], s37 offen lds
s_add_u32 m0, s39, 55296
s_nop 0
buffer_load_dwordx4 v8, s[8:11], s37 offen lds
s_add_u32 m0, s39, 58368
s_nop 0
buffer_load_dwordx4 v9, s[8:11], s37 offen lds
s_add_u32 m0, s40, 43008
s_add_u32 s43, s38, 0
buffer_load_dwordx4 v2, s[12:15], s43 offen lds
s_add_u32 m0, s40, 44032
s_add_u32 s43, s38, 49152
buffer_load_dwordx4 v3, s[12:15], s43 offen lds
s_add_u32 m0, s40, 45056
s_add_u32 s43, s38, 98304
buffer_load_dwordx4 v2, s[12:15], s43 offen lds
s_add_u32 m0, s40, 46080
s_add_u32 s43, s38, 147456
buffer_load_dwordx4 v3, s[12:15], s43 offen lds
s_add_u32 m0, s40, 47104
s_add_u32 s43, s38, 196608
buffer_load_dwordx4 v2, s[12:15], s43 offen lds
s_add_u32 m0, s40, 48128
s_add_u32 s43, s38, 245760
buffer_load_dwordx4 v3, s[12:15], s43 offen lds
s_add_u32 m0, s40, 49152
s_add_u32 s43, s38, 294912
buffer_load_dwordx4 v2, s[12:15], s43 offen lds
s_add_u32 m0, s40, 50176
s_add_u32 s43, s38, 344064
buffer_load_dwordx4 v3, s[12:15], s43 offen lds
s_add_u32 s37, s37, 128
s_add_u32 s38, s38, 393216
s_load_dword s3, s[4:5], 21504
s_load_dword s3, s[4:5], 21568
s_load_dword s3, s[4:5], 21632
s_load_dword s3, s[4:5], 21696
s_load_dword s3, s[4:5], 28672
s_load_dword s3, s[4:5], 28736
s_waitcnt vmcnt(14)
s_barrier
s_add_u32 m0, s39, 86016
s_mov_b64 exec, s[60:61]
buffer_load_dwordx4 v4, s[8:11], s37 offen lds
s_mov_b64 exec, -1
s_add_u32 m0, s39, 89088
s_nop 0
buffer_load_dwordx4 v5, s[8:11], s37 offen lds
s_add_u32 m0, s39, 92160
s_nop 0
buffer_load_dwordx4 v6, s[8:11], s37 offen lds
s_add_u32 m0, s39, 95232
s_nop 0
buffer_load_dwordx4 v7, s[8:11], s37 offen lds
s_add_u32 m0, s39, 98304
s_nop 0
buffer_load_dwordx4 v8, s[8:11], s37 offen lds
s_add_u32 m0, s39, 101376
s_nop 0
buffer_load_dwordx4 v9, s[8:11], s37 offen lds
s_add_u32 m0, s40, 86016
s_add_u32 s43, s38, 0
buffer_load_dwordx4 v2, s[12:15], s43 offen lds
s_add_u32 m0, s40, 87040
s_add_u32 s43, s38, 49152
buffer_load_dwordx4 v3, s[12:15], s43 offen lds
s_add_u32 m0, s40, 88064
s_add_u32 s43, s38, 98304
buffer_load_dwordx4 v2, s[12:15], s43 offen lds
s_add_u32 m0, s40, 89088
s_add_u32 s43, s38, 147456
buffer_load_dwordx4 v3, s[12:15], s43 offen lds
s_add_u32 m0, s40, 90112
s_add_u32 s43, s38, 196608
buffer_load_dwordx4 v2, s[12:15], s43 offen lds
s_add_u32 m0, s40, 91136
s_add_u32 s43, s38, 245760
buffer_load_dwordx4 v3, s[12:15], s43 offen lds
s_add_u32 m0, s40, 92160
s_add_u32 s43, s38, 294912
buffer_load_dwordx4 v2, s[12:15], s43 offen lds
s_add_u32 m0, s40, 93184
s_add_u32 s43, s38, 344064
buffer_load_dwordx4 v3, s[12:15], s43 offen lds
s_add_u32 s37, s37, 128
s_add_u32 s38, s38, 393216
s_load_dword s3, s[4:5], 28800
s_load_dword s3, s[4:5], 28864
s_load_dword s3, s[4:5], 35840
s_load_dword s3, s[4:5], 35904
s_load_dword s3, s[4:5], 35968
s_load_dword s3, s[4:5], 36032
s_load_dword s3, s[4:5], 43008
s_waitcnt vmcnt(14)
s_barrier
s_add_u32 m0, s39, 0
s_mov_b64 exec, s[60:61]
buffer_load_dwordx4 v4, s[8:11], s37 offen lds
s_mov_b64 exec, -1
s_add_u32 m0, s39, 3072
s_nop 0
buffer_load_dwordx4 v5, s[8:11], s37 offen lds
s_add_u32 m0, s39, 6144
s_nop 0
buffer_load_dwordx4 v6, s[8:11], s37 offen lds
s_add_u32 m0, s39, 9216
s_nop 0
buffer_load_dwordx4 v7, s[8:11], s37 offen lds
s_add_u32 m0, s39, 12288
s_nop 0
buffer_load_dwordx4 v8, s[8:11], s37 offen lds
s_add_u32 m0, s39, 15360
s_nop 0
buffer_load_dwordx4 v9, s[8:11], s37 offen lds
s_add_u32 m0, s40, 0
s_add_u32 s43, s38, 0
buffer_load_dwordx4 v2, s[12:15], s43 offen lds
s_add_u32 m0, s40, 1024
s_add_u32 s43, s38, 49152
buffer_load_dwordx4 v3, s[12:15], s43 offen lds
s_add_u32 m0, s40, 2048
s_add_u32 s43, s38, 98304
buffer_load_dwordx4 v2, s[12:15], s43 offen lds
s_add_u32 m0, s40, 3072
s_add_u32 s43, s38, 147456
buffer_load_dwordx4 v3, s[12:15], s43 offen lds
s_add_u32 m0, s40, 4096
s_add_u32 s43, s38, 196608
buffer_load_dwordx4 v2, s[12:15], s43 offen lds
s_add_u32 m0, s40, 5120
s_add_u32 s43, s38, 245760
buffer_load_dwordx4 v3, s[12:15], s43 offen lds
s_add_u32 m0, s40, 6144
s_add_u32 s43, s38, 294912
buffer_load_dwordx4 v2, s[12:15], s43 offen lds
s_add_u32 m0, s40, 7168
s_add_u32 s43, s38, 344064
buffer_load_dwordx4 v3, s[12:15], s43 offen lds
s_add_u32 s37, s37, 128
s_add_u32 s38, s38, 393216
s_load_dword s3, s[4:5], 43072
s_load_dword s3, s[4:5], 43136
s_load_dword s3, s[4:5], 43200
s_load_dword s3, s[4:5], 50176
s_load_dword s3, s[4:5], 50240
s_load_dword s3, s[4:5], 50304
s_load_dword s3, s[4:5], 50368
s_load_dword s3, s[4:5], 57344
s_waitcnt vmcnt(14)
s_barrier
s_add_u32 m0, s39, 43008
s_mov_b64 exec, s[60:61]
buffer_load_dwordx4 v4, s[8:11], s37 offen lds
s_mov_b64 exec, -1
s_add_u32 m0, s39, 46080
s_nop 0
buffer_load_dwordx4 v5, s[8:11], s37 offen lds
s_add_u32 m0, s39, 49152
s_nop 0
buffer_load_dwordx4 v6, s[8:11], s37 offen lds
s_add_u32 m0, s39, 52224
s_nop 0
buffer_load_dwordx4 v7, s[8:11], s37 offen lds
s_add_u32 m0, s39, 55296
s_nop 0
buffer_load_dwordx4 v8, s[8:11], s37 offen lds
s_add_u32 m0, s39, 58368
s_nop 0
buffer_load_dwordx4 v9, s[8:11], s37 offen lds
s_add_u32 m0, s40, 43008
s_add_u32 s43, s38, 0
buffer_load_dwordx4 v2, s[12:15], s43 offen lds
s_add_u32 m0, s40, 44032
s_add_u32 s43, s38, 49152
buffer_load_dwordx4 v3, s[12:15], s43 offen lds
s_add_u32 m0, s40, 45056
s_add_u32 s43, s38, 98304
buffer_load_dwordx4 v2, s[12:15], s43 offen lds
s_add_u32 m0, s40, 46080
s_add_u32 s43, s38, 147456
buffer_load_dwordx4 v3, s[12:15], s43 offen lds
s_add_u32 m0, s40, 47104
s_add_u32 s43, s38, 196608
buffer_load_dwordx4 v2, s[12:15], s43 offen lds
s_add_u32 m0, s40, 48128
s_add_u32 s43, s38, 245760
buffer_load_dwordx4 v3, s[12:15], s43 offen lds
s_add_u32 m0, s40, 49152
s_add_u32 s43, s38, 294912
buffer_load_dwordx4 v2, s[12:15], s43 offen lds
s_add_u32 m0, s40, 50176
s_add_u32 s43, s38, 344064
buffer_load_dwordx4 v3, s[12:15], s43 offen lds
s_add_u32 s37, s37, 128
s_add_u32 s38, s38, 393216
s_load_dword s3, s[4:5], 57408
s_load_dword s3, s[4:5], 57472
s_load_dword s3, s[4:5], 57536
s_load_dword s3, s[4:5], 64512
s_load_dword s3, s[4:5], 64576
s_load_dword s3, s[4:5], 64640
s_load_dword s3, s[4:5], 64704
s_load_dword s3, s[4:5], 71680
s_load_dword s3, s[4:5], 71744
s_waitcnt vmcnt(14)
s_barrier
s_add_u32 m0, s39, 86016
s_mov_b64 exec, s[60:61]
buffer_load_dwordx4 v4, s[8:11], s37 offen lds
s_mov_b64 exec, -1
s_add_u32 m0, s39, 89088
s_nop 0
buffer_load_dwordx4 v5, s[8:11], s37 offen lds
s_add_u32 m0, s39, 92160
s_nop 0
buffer_load_dwordx4 v6, s[8:11], s37 offen lds
s_add_u32 m0, s39, 95232
s_nop 0
buffer_load_dwordx4 v7, s[8:11], s37 offen lds
s_add_u32 m0, s39, 98304
s_nop 0
buffer_load_dwordx4 v8, s[8:11], s37 offen lds
s_add_u32 m0, s39, 101376
s_nop 0
buffer_load_dwordx4 v9, s[8:11], s37 offen lds
s_add_u32 m0, s40, 86016
s_add_u32 s43, s38, 0
buffer_load_dwordx4 v2, s[12:15], s43 offen lds
s_add_u32 m0, s40, 87040
s_add_u32 s43, s38, 49152
buffer_load_dwordx4 v3, s[12:15], s43 offen lds
s_add_u32 m0, s40, 88064
s_add_u32 s43, s38, 98304
buffer_load_dwordx4 v2, s[12:15], s43 offen lds
s_add_u32 m0, s40, 89088
s_add_u32 s43, s38, 147456
buffer_load_dwordx4 v3, s[12:15], s43 offen lds
s_add_u32 m0, s40, 90112
s_add_u32 s43, s38, 196608
buffer_load_dwordx4 v2, s[12:15], s43 offen lds
s_add_u32 m0, s40, 91136
s_add_u32 s43, s38, 245760
buffer_load_dwordx4 v3, s[12:15], s43 offen lds
s_add_u32 m0, s40, 92160
s_add_u32 s43, s38, 294912
buffer_load_dwordx4 v2, s[12:15], s43 offen lds
s_add_u32 m0, s40, 93184
s_add_u32 s43, s38, 344064
buffer_load_dwordx4 v3, s[12:15], s43 offen lds
s_add_u32 s37, s37, 128
s_add_u32 s38, s38, 393216
s_load_dword s3, s[4:5], 71808
s_load_dword s3, s[4:5], 71872
s_load_dword s3, s[4:5], 78848
s_load_dword s3, s[4:5], 78912
s_load_dword s3, s[4:5], 78976
s_load_dword s3, s[4:5], 79040
s_load_dword s3, s[4:5], 86016
s_load_dword s3, s[4:5], 86080
s_load_dword s3, s[4:5], 86144
s_waitcnt vmcnt(14)
s_barrier
s_add_u32 m0, s39, 0
s_mov_b64 exec, s[60:61]
buffer_load_dwordx4 v4, s[8:11], s37 offen lds
s_mov_b64 exec, -1
s_add_u32 m0, s39, 3072
s_nop 0
buffer_load_dwordx4 v5, s[8:11], s37 offen lds
s_add_u32 m0, s39, 6144
s_nop 0
buffer_load_dwordx4 v6, s[8:11], s37 offen lds
s_add_u32 m0, s39, 9216
s_nop 0
buffer_load_dwordx4 v7, s[8:11], s37 offen lds
s_add_u32 m0, s39, 12288
s_nop 0
buffer_load_dwordx4 v8, s[8:11], s37 offen lds
s_add_u32 m0, s39, 15360
s_nop 0
buffer_load_dwordx4 v9, s[8:11], s37 offen lds
s_add_u32 m0, s40, 0
s_add_u32 s43, s38, 0
buffer_load_dwordx4 v2, s[12:15], s43 offen lds
s_add_u32 m0, s40, 1024
s_add_u32 s43, s38, 49152
buffer_load_dwordx4 v3, s[12:15], s43 offen lds
s_add_u32 m0, s40, 2048
s_add_u32 s43, s38, 98304
buffer_load_dwordx4 v2, s[12:15], s43 offen lds
s_add_u32 m0, s40, 3072
s_add_u32 s43, s38, 147456
buffer_load_dwordx4 v3, s[12:15], s43 offen lds
s_add_u32 m0, s40, 4096
s_add_u32 s43, s38, 196608
buffer_load_dwordx4 v2, s[12:15], s43 offen lds
s_add_u32 m0, s40, 5120
s_add_u32 s43, s38, 245760
buffer_load_dwordx4 v3, s[12:15], s43 offen lds
s_add_u32 m0, s40, 6144
s_add_u32 s43, s38, 294912
buffer_load_dwordx4 v2, s[12:15], s43 offen lds
s_add_u32 m0, s40, 7168
s_add_u32 s43, s38, 344064
buffer_load_dwordx4 v3, s[12:15], s43 offen lds
s_add_u32 s37, s37, 128
s_add_u32 s38, s38, 393216
s_load_dword s3, s[4:5], 86208
s_load_dword s3, s[4:5], 93184
s_load_dword s3, s[4:5], 93248
s_load_dword s3, s[4:5], 93312
s_load_dword s3, s[4:5], 93376
s_load_dword s3, s[4:5], 100352
s_load_dword s3, s[4:5], 100416
s_load_dword s3, s[4:5], 100480
s_load_dword s3, s[4:5], 100544
s_waitcnt vmcnt(14)
s_barrier
s_add_u32 m0, s39, 43008
s_mov_b64 exec, s[60:61]
buffer_load_dwordx4 v4, s[8:11], s37 offen lds
s_mov_b64 exec, -1
s_add_u32 m0, s39, 46080
s_nop 0
buffer_load_dwordx4 v5, s[8:11], s37 offen lds
s_add_u32 m0, s39, 49152
s_nop 0
buffer_load_dwordx4 v6, s[8:11], s37 offen lds
s_add_u32 m0, s39, 52224
s_nop 0
buffer_load_dwordx4 v7, s[8:11], s37 offen lds
s_add_u32 m0, s39, 55296
s_nop 0
buffer_load_dwordx4 v8, s[8:11], s37 offen lds
s_add_u32 m0, s39, 58368
s_nop 0
buffer_load_dwordx4 v9, s[8:11], s37 offen lds
s_add_u32 m0, s40, 43008
s_add_u32 s43, s38, 0
buffer_load_dwordx4 v2, s[12:15], s43 offen lds
s_add_u32 m0, s40, 44032
s_add_u32 s43, s38, 49152
buffer_load_dwordx4 v3, s[12:15], s43 offen lds
s_add_u32 m0, s40, 45056
s_add_u32 s43, s38, 98304
buffer_load_dwordx4 v2, s[12:15], s43 offen lds
s_add_u32 m0, s40, 46080
s_add_u32 s43, s38, 147456
buffer_load_dwordx4 v3, s[12:15], s43 offen lds
s_add_u32 m0, s40, 47104
s_add_u32 s43, s38, 196608
buffer_load_dwordx4 v2, s[12:15], s43 offen lds
s_add_u32 m0, s40, 48128
s_add_u32 s43, s38, 245760
buffer_load_dwordx4 v3, s[12:15], s43 offen lds
s_add_u32 m0, s40, 49152
s_add_u32 s43, s38, 294912
buffer_load_dwordx4 v2, s[12:15], s43 offen lds
s_add_u32 m0, s40, 50176
s_add_u32 s43, s38, 344064
buffer_load_dwordx4 v3, s[12:15], s43 offen lds
s_add_u32 s37, s37, 128
s_add_u32 s38, s38, 393216
s_load_dword s3, s[4:5], 107520
s_load_dword s3, s[4:5], 107584
s_load_dword s3, s[4:5], 107648
s_load_dword s3, s[4:5], 107712
s_load_dword s3, s[4:5], 114688
s_load_dword s3, s[4:5], 114752
s_load_dword s3, s[4:5], 114816
s_load_dword s3, s[4:5], 114880
s_load_dword s3, s[4:5], 121856
s_waitcnt vmcnt(14)
s_barrier
s_add_u32 m0, s39, 86016
s_mov_b64 exec, s[60:61]
buffer_load_dwordx4 v4, s[8:11], s37 offen lds
s_mov_b64 exec, -1
s_add_u32 m0, s39, 89088
s_nop 0
buffer_load_dwordx4 v5, s[8:11], s37 offen lds
s_add_u32 m0, s39, 92160
s_nop 0
buffer_load_dwordx4 v6, s[8:11], s37 offen lds
s_add_u32 m0, s39, 95232
s_nop 0
buffer_load_dwordx4 v7, s[8:11], s37 offen lds
s_add_u32 m0, s39, 98304
s_nop 0
buffer_load_dwordx4 v8, s[8:11], s37 offen lds
s_add_u32 m0, s39, 101376
s_nop 0
buffer_load_dwordx4 v9, s[8:11], s37 offen lds
s_add_u32 m0, s40, 86016
s_add_u32 s43, s38, 0
buffer_load_dwordx4 v2, s[12:15], s43 offen lds
s_add_u32 m0, s40, 87040
s_add_u32 s43, s38, 49152
buffer_load_dwordx4 v3, s[12:15], s43 offen lds
s_add_u32 m0, s40, 88064
s_add_u32 s43, s38, 98304
buffer_load_dwordx4 v2, s[12:15], s43 offen lds
s_add_u32 m0, s40, 89088
s_add_u32 s43, s38, 147456
buffer_load_dwordx4 v3, s[12:15], s43 offen lds
s_add_u32 m0, s40, 90112
s_add_u32 s43, s38, 196608
buffer_load_dwordx4 v2, s[12:15], s43 offen lds
s_add_u32 m0, s40, 91136
s_add_u32 s43, s38, 245760
buffer_load_dwordx4 v3, s[12:15], s43 offen lds
s_add_u32 m0, s40, 92160
s_add_u32 s43, s38, 294912
buffer_load_dwordx4 v2, s[12:15], s43 offen lds
s_add_u32 m0, s40, 93184
s_add_u32 s43, s38, 344064
buffer_load_dwordx4 v3, s[12:15], s43 offen lds
s_add_u32 s37, s37, 128
s_add_u32 s38, s38, 393216
s_load_dword s3, s[4:5], 121920
s_load_dword s3, s[4:5], 121984
s_load_dword s3, s[4:5], 122048
s_load_dword s3, s[4:5], 129024
s_load_dword s3, s[4:5], 129088
s_load_dword s3, s[4:5], 129152
s_load_dword s3, s[4:5], 129216
s_load_dword s3, s[4:5], 136192
s_load_dword s3, s[4:5], 136256
s_waitcnt vmcnt(14)
s_barrier
s_add_u32 m0, s39, 0
s_mov_b64 exec, s[60:61]
buffer_load_dwordx4 v4, s[8:11], s37 offen lds
s_mov_b64 exec, -1
s_add_u32 m0, s39, 3072
s_nop 0
buffer_load_dwordx4 v5, s[8:11], s37 offen lds
s_add_u32 m0, s39, 6144
s_nop 0
buffer_load_dwordx4 v6, s[8:11], s37 offen lds
s_add_u32 m0, s39, 9216
s_nop 0
buffer_load_dwordx4 v7, s[8:11], s37 offen lds
s_add_u32 m0, s39, 12288
s_nop 0
buffer_load_dwordx4 v8, s[8:11], s37 offen lds
s_add_u32 m0, s39, 15360
s_nop 0
buffer_load_dwordx4 v9, s[8:11], s37 offen lds
s_add_u32 m0, s40, 0
s_add_u32 s43, s38, 0
buffer_load_dwordx4 v2, s[12:15], s43 offen lds
s_add_u32 m0, s40, 1024
s_add_u32 s43, s38, 49152
buffer_load_dwordx4 v3, s[12:15], s43 offen lds
s_add_u32 m0, s40, 2048
s_add_u32 s43, s38, 98304
buffer_load_dwordx4 v2, s[12:15], s43 offen lds
s_add_u32 m0, s40, 3072
s_add_u32 s43, s38, 147456
buffer_load_dwordx4 v3, s[12:15], s43 offen lds
s_add_u32 m0, s40, 4096
s_add_u32 s43, s38, 196608
buffer_load_dwordx4 v2, s[12:15], s43 offen lds
s_add_u32 m0, s40, 5120
s_add_u32 s43, s38, 245760
buffer_load_dwordx4 v3, s[12:15], s43 offen lds
s_add_u32 m0, s40, 6144
s_add_u32 s43, s38, 294912
buffer_load_dwordx4 v2, s[12:15], s43 offen lds
s_add_u32 m0, s40, 7168
s_add_u32 s43, s38, 344064
buffer_load_dwordx4 v3, s[12:15], s43 offen lds
s_add_u32 s37, s37, 128
s_add_u32 s38, s38, 393216
s_load_dword s3, s[4:5], 136320
s_load_dword s3, s[4:5], 136384
s_load_dword s3, s[4:5], 143360
s_load_dword s3, s[4:5], 143424
s_load_dword s3, s[4:5], 143488
s_load_dword s3, s[4:5], 143552
s_load_dword s3, s[4:5], 150528
s_load_dword s3, s[4:5], 150592
s_load_dword s3, s[4:5], 150656
s_waitcnt vmcnt(14)
s_barrier
s_load_dword s3, s[4:5], 150720
s_load_dword s3, s[4:5], 157696
s_load_dword s3, s[4:5], 157760
s_load_dword s3, s[4:5], 157824
s_load_dword s3, s[4:5], 157888
s_load_dword s3, s[4:5], 164864
s_load_dword s3, s[4:5], 164928
s_load_dword s3, s[4:5], 164992
s_load_dword s3, s[4:5], 165056
s_waitcnt vmcnt(0)
s_barrier
s_bitcmp0_b32 s2, 0
s_cselect_b32 s88, s72, s74
s_cselect_b32 s89, s73, s75
s_cmp_lt_u32 s2, 192
s_cselect_b32 s90, 7340032, 0
s_mov_b32 s91, 0x20000
s_bfe_u32 s44, s2, 0x30001
s_lshl_b32 s44, s44, 2
s_and_b32 s43, s36, 3
s_add_u32 s44, s44, s43
s_lshl_b32 s44, s44, 5
v_lshrrev_b32 v18, 4, v1
v_add_u32 v18, s44, v18
v_mul_u32_u24 v18, 7168, v18
v_and_b32 v19, 15, v1
v_lshl_add_u32 v18, v19, 4, v18
s_lshr_b32 s43, s2, 4
s_lshl_b32 s43, s43, 8
s_add_u32 s43, s43, 4096
s_branch Lov_1
.p2align 12
Lst_1_0:
s_branch Lwr_145
s_nop 0
s_nop 0
Lov_1:
v_add_u32 v18, s43, v18
s_mov_b32 s43, 0
buffer_load_dwordx4 v[128:131], v18, s[88:91], s43 offen
s_mov_b32 s43, 28672
buffer_load_dwordx4 v[132:135], v18, s[88:91], s43 offen
s_mov_b32 s43, 57344
buffer_load_dwordx4 v[136:139], v18, s[88:91], s43 offen
s_mov_b32 s43, 86016
buffer_load_dwordx4 v[140:143], v18, s[88:91], s43 offen
s_mov_b32 s43, 114688
buffer_load_dwordx4 v[144:147], v18, s[88:91], s43 offen
s_mov_b32 s43, 143360
buffer_load_dwordx4 v[148:151], v18, s[88:91], s43 offen
s_mov_b32 s43, 172032
buffer_load_dwordx4 v[152:155], v18, s[88:91], s43 offen
s_mov_b32 s43, 200704
buffer_load_dwordx4 v[156:159], v18, s[88:91], s43 offen
s_barrier
s_lshl_b32 s43, s35, 7
s_add_u32 s28, s68, s43
s_addc_u32 s29, s69, 0
s_mov_b32 s30, 2095232
s_mov_b32 s31, 0x20000
v_lshrrev_b32 v15, 3, v1
v_and_b32 v16, 6, v15
v_and_b32 v7, 7, v1
v_xor_b32 v7, v7, v16
v_lshlrev_b32 v7, 4, v7
v_mul_u32_u24 v15, 2048, v15
v_add_u32 v7, v7, v15
s_and_b32 s40, s36, 3
s_lshl_b32 s39, s40, 13
s_add_u32 s40, s40, s35
s_add_u32 s42, s40, 0
s_and_b32 s42, s42, 15
s_lshl_b32 s42, s42, 17
s_add_u32 m0, s39, 65536
s_add_u32 s43, s42, 0
buffer_load_dwordx4 v7, s[28:31], s43 offen lds
s_add_u32 m0, s39, 66560
s_add_u32 s43, s42, 16384
buffer_load_dwordx4 v7, s[28:31], s43 offen lds
s_add_u32 m0, s39, 67584
s_add_u32 s43, s42, 32768
buffer_load_dwordx4 v7, s[28:31], s43 offen lds
s_add_u32 m0, s39, 68608
s_add_u32 s43, s42, 49152
buffer_load_dwordx4 v7, s[28:31], s43 offen lds
s_add_u32 m0, s39, 69632
s_add_u32 s43, s42, 65536
buffer_load_dwordx4 v7, s[28:31], s43 offen lds
s_add_u32 m0, s39, 70656
s_add_u32 s43, s42, 81920
buffer_load_dwordx4 v7, s[28:31], s43 offen lds
s_add_u32 m0, s39, 71680
s_add_u32 s43, s42, 98304
buffer_load_dwordx4 v7, s[28:31], s43 offen lds
s_add_u32 m0, s39, 72704
s_add_u32 s43, s42, 114688
buffer_load_dwordx4 v7, s[28:31], s43 offen lds
s_branch Lats_6
Lcons_7:
s_lshl_b32 s43, s35, 7
s_waitcnt lgkmcnt(0)
s_mov_b32 s8, s64
s_mov_b32 s9, s65
s_mov_b32 s10, 4194304
s_mov_b32 s11, 0x20000
s_add_u32 s12, s66, s43
s_addc_u32 s13, s67, 0
s_mov_b32 s14, 6289536
s_mov_b32 s15, 0x20000
s_lshr_b32 s43, s2, 3
s_lshl_b32 s43, s43, 2
s_add_u32 s43, s43, s36
s_sub_u32 s44, s43, 0
s_and_b32 s44, s44, 127
s_cmp_lt_u32 s44, 24
s_cbranch_scc0 Lt_8
s_lshl_b32 s44, s44, 20
s_min_u32 s44, s44, 24117184
s_load_dword s3, s[82:83], s44 glc
Lt_8:
s_sub_u32 s44, s43, 24
s_and_b32 s44, s44, 127
s_cmp_lt_u32 s44, 8
s_cbranch_scc0 Lt_9
s_lshl_b32 s44, s44, 20
s_min_u32 s44, s44, 7339968
s_load_dword s3, s[72:73], s44
Lt_9:
s_sub_u32 s44, s43, 32
s_and_b32 s44, s44, 127
s_cmp_lt_u32 s44, 8
s_cbranch_scc0 Lt_10
s_lshl_b32 s44, s44, 20
s_min_u32 s44, s44, 7339968
s_load_dword s3, s[74:75], s44
Lt_10:
s_sub_u32 s44, s43, 40
s_and_b32 s44, s44, 127
s_cmp_lt_u32 s44, 3
s_cbranch_scc0 Lt_11
s_lshl_b32 s44, s44, 20
s_min_u32 s44, s44, 2097088
s_load_dword s3, s[68:69], s44
Lt_11:
s_sub_u32 s44, s43, 43
s_and_b32 s44, s44, 127
s_cmp_lt_u32 s44, 5
s_cbranch_scc0 Lt_12
s_lshl_b32 s44, s44, 20
s_min_u32 s44, s44, 4194240
s_add_u32 s44, s44, 25165824
s_load_dword s3, s[82:83], s44 glc
Lt_12:
s_sub_u32 s44, s43, 48
s_and_b32 s44, s44, 127
s_cmp_lt_u32 s44, 8
s_cbranch_scc0 Lt_13
s_lshl_b32 s44, s44, 20
s_min_u32 s44, s44, 7339968
s_load_dword s3, s[76:77], s44
Lt_13:
s_sub_u32 s44, s43, 56
s_and_b32 s44, s44, 127
s_cmp_lt_u32 s44, 5
s_cbranch_scc0 Lt_14
s_lshl_b32 s44, s44, 20
s_min_u32 s44, s44, 4194240
s_add_u32 s44, s44, 33554432
s_load_dword s3, s[82:83], s44 glc
Lt_14:
s_sub_u32 s44, s43, 61
s_and_b32 s44, s44, 127
s_cmp_lt_u32 s44, 5
s_cbranch_scc0 Lt_15
s_lshl_b32 s44, s44, 20
s_min_u32 s44, s44, 4194240
s_load_dword s3, s[78:79], s44 glc
Lt_15:
v_lshrrev_b32 v16, 1, v12
v_xor_b32 v15, v13, v16
v_lshlrev_b32 v15, 4, v15
v_lshl_add_u32 v2, v12, 7, v15
v_xor_b32 v3, 64, v2
v_add_u32 v4, 86016, v2
v_add_u32 v5, 86016, v3
v_lshrrev_b32 v15, 2, v12
v_and_b32 v16, 3, v1
v_lshl_add_u32 v19, v13, 3, v15
v_lshlrev_b32 v19, 7, v19
v_and_b32 v15, 2, v15
v_and_b32 v17, 1, v13
v_lshl_add_u32 v15, v17, 2, v15
v_lshrrev_b32 v17, 1, v16
s_lshl_b32 s43, s36, 1
v_add_u32 v17, s43, v17
v_xor_b32 v15, v15, v17
v_lshl_add_u32 v19, v15, 4, v19
v_and_b32 v16, 1, v16
v_lshl_add_u32 v19, v16, 3, v19
v_add_u32 v6, 18432, v19
v_add_u32 v7, 61440, v19
v_add_u32 v8, 104448, v19
s_and_b32 s43, s36, 1
s_bfe_u32 s44, s36, 0x10001
s_lshr_b32 s45, s36, 2
v_lshlrev_b32 v14, 2, v13
v_sub_u32 v14, v12, v14
v_mov_b32 v16, 0xff800000
s_or_b32 s46, s34, s45
s_cmp_lg_u32 s46, 0
s_cselect_b32 s46, 0, 0xff800000
v_subrev_u32 v15, 0, v14
v_cmp_ge_u32 vcc, 7, v15
v_add_u32 v15, 16, v15
s_nop 0
v_cndmask_b32 v248, v16, 0, vcc
v_cmp_ge_u32 vcc, 7, v15
s_nop 1
v_cndmask_b32 v244, v16, 0, vcc
v_or_b32 v240, s46, v244
v_subrev_u32 v15, 1, v14
v_cmp_ge_u32 vcc, 7, v15
v_add_u32 v15, 16, v15
s_nop 0
v_cndmask_b32 v249, v16, 0, vcc
v_cmp_ge_u32 vcc, 7, v15
s_nop 1
v_cndmask_b32 v245, v16, 0, vcc
v_or_b32 v241, s46, v245
v_subrev_u32 v15, 2, v14
v_cmp_ge_u32 vcc, 7, v15
v_add_u32 v15, 16, v15
s_nop 0
v_cndmask_b32 v250, v16, 0, vcc
v_cmp_ge_u32 vcc, 7, v15
s_nop 1
v_cndmask_b32 v246, v16, 0, vcc
v_or_b32 v242, s46, v246
v_subrev_u32 v15, 3, v14
v_cmp_ge_u32 vcc, 7, v15
v_add_u32 v15, 16, v15
s_nop 0
v_cndmask_b32 v251, v16, 0, vcc
v_cmp_ge_u32 vcc, 7, v15
s_nop 1
v_cndmask_b32 v247, v16, 0, vcc
v_or_b32 v243, s46, v247
s_lshl_b32 s46, s45, 6
s_add_u32 s46, s46, s44
s_add_u32 s46, s46, 16
v_lshl_add_u32 v14, v12, 1, s46
s_lshl_b32 s47, s43, 6
v_lshl_add_u32 v15, v13, 4, s47
v_mul_u32_u24 v20, 400, v14
v_add_u32 v20, v20, v15
v_subrev_u32 v16, 32, v14
v_max_i32 v16, 0, v16
v_mul_u32_u24 v21, 400, v16
v_add_u32 v21, v21, v15
v_lshrrev_b32 v16, 2, v12
v_lshl_add_u32 v16, v13, 2, v16
v_lshl_add_u32 v16, v16, 1, s46
v_and_b32 v17, 3, v1
v_lshl_add_u32 v17, v17, 3, s47
v_mul_u32_u24 v22, 400, v16
v_add_u32 v22, v22, v17
v_subrev_u32 v16, 32, v16
v_max_i32 v16, 0, v16
v_mul_u32_u24 v23, 400, v16
v_add_u32 v23, v23, v17
s_mul_i32 s60, s34, 262144
s_add_u32 s16, s82, s60
s_addc_u32 s17, s83, 0
s_mov_b32 s18, 262144
s_mov_b32 s19, 0x20000
s_lshl_b32 s60, s35, 14
s_lshl_b32 s43, s43, 13
s_add_u32 s60, s60, s43
s_lshl_b32 s43, s45, 12
s_add_u32 s60, s60, s43
s_lshl_b32 s43, s44, 10
s_add_u32 s60, s60, s43
v_lshlrev_b32 v24, 4, v1
s_mov_b32 s61, 0x3e8293ee
s_lshl_b32 s38, s35, 7
s_add_u32 s56, s82, 28311552
s_addc_u32 s57, s83, 0
s_mov_b32 s58, 114688
s_mov_b32 s59, 0x20000
s_barrier
ds_read_b128 v[32:35], v2 offset:0
ds_read_b64_tr_b16 v[72:73], v6 offset:8192
ds_read_b64_tr_b16 v[74:75], v6 offset:8704
ds_read_b64_tr_b16 v[76:77], v6 offset:16384
ds_read_b64_tr_b16 v[78:79], v6 offset:16896
ds_read_b64_tr_b16 v[68:69], v6 offset:0
ds_read_b64_tr_b16 v[70:71], v6 offset:512
ds_read_b128 v[36:39], v2 offset:2048
ds_read_b128 v[40:43], v2 offset:4096
ds_read_b128 v[44:47], v2 offset:6144
ds_read_b128 v[48:51], v2 offset:8192
ds_read_b128 v[52:55], v2 offset:10240
ds_read_b128 v[56:59], v2 offset:12288
ds_read_b128 v[60:63], v2 offset:14336
ds_read_b128 v[64:67], v2 offset:16384
s_waitcnt lgkmcnt(0)
v_mfma_f32_16x16x32_bf16 v[128:131], v[68:71], v[32:35], 0
ds_read_b128 v[80:83], v3 offset:0
v_mfma_f32_16x16x32_bf16 v[132:135], v[68:71], v[36:39], 0
ds_read_b64_tr_b16 v[120:121], v6 offset:12288
v_mfma_f32_16x16x32_bf16 v[136:139], v[68:71], v[40:43], 0
ds_read_b64_tr_b16 v[122:123], v6 offset:12800
v_mfma_f32_16x16x32_bf16 v[140:143], v[68:71], v[44:47], 0
ds_read_b64_tr_b16 v[124:125], v6 offset:20480
v_mfma_f32_16x16x32_bf16 v[144:147], v[68:71], v[48:51], 0
ds_read_b64_tr_b16 v[126:127], v6 offset:20992
v_mfma_f32_16x16x32_bf16 v[148:151], v[68:71], v[52:55], 0
ds_read_b64_tr_b16 v[116:117], v6 offset:4096
v_mfma_f32_16x16x32_bf16 v[152:155], v[68:71], v[56:59], 0
ds_read_b64_tr_b16 v[118:119], v6 offset:4608
v_mfma_f32_16x16x32_bf16 v[156:159], v[68:71], v[60:63], 0
ds_read_b128 v[84:87], v3 offset:2048
v_mfma_f32_16x16x32_bf16 v[160:163], v[68:71], v[64:67], 0
ds_read_b128 v[88:91], v3 offset:4096
v_mfma_f32_16x16x32_bf16 v[196:199], v[72:75], v[64:67], 0
ds_read_b128 v[92:95], v3 offset:6144
v_mfma_f32_16x16x32_bf16 v[192:195], v[72:75], v[60:63], 0
ds_read_b128 v[96:99], v3 offset:8192
v_mfma_f32_16x16x32_bf16 v[188:191], v[72:75], v[56:59], 0
ds_read_b128 v[100:103], v3 offset:10240
v_mfma_f32_16x16x32_bf16 v[184:187], v[72:75], v[52:55], 0
ds_read_b128 v[104:107], v3 offset:12288
v_mfma_f32_16x16x32_bf16 v[180:183], v[72:75], v[48:51], 0
ds_read_b128 v[108:111], v3 offset:14336
v_mfma_f32_16x16x32_bf16 v[176:179], v[72:75], v[44:47], 0
ds_read_b128 v[112:115], v3 offset:16384
v_mfma_f32_16x16x32_bf16 v[172:175], v[72:75], v[40:43], 0
v_mfma_f32_16x16x32_bf16 v[168:171], v[72:75], v[36:39], 0
v_mfma_f32_16x16x32_bf16 v[164:167], v[72:75], v[32:35], 0
v_mfma_f32_16x16x32_bf16 v[200:203], v[76:79], v[32:35], 0
v_mfma_f32_16x16x32_bf16 v[204:207], v[76:79], v[36:39], 0
v_mfma_f32_16x16x32_bf16 v[208:211], v[76:79], v[40:43], 0
v_mfma_f32_16x16x32_bf16 v[212:215], v[76:79], v[44:47], 0
v_mfma_f32_16x16x32_bf16 v[216:219], v[76:79], v[48:51], 0
v_mfma_f32_16x16x32_bf16 v[220:223], v[76:79], v[52:55], 0
v_mfma_f32_16x16x32_bf16 v[224:227], v[76:79], v[56:59], 0
v_mfma_f32_16x16x32_bf16 v[228:231], v[76:79], v[60:63], 0
v_mfma_f32_16x16x32_bf16 v[232:235], v[76:79], v[64:67], 0
s_waitcnt lgkmcnt(0)
s_barrier
v_mfma_f32_16x16x32_bf16 v[128:131], v[116:119], v[80:83], v[128:131]
ds_read_b128 v[32:35], v2 offset:43008
v_mfma_f32_16x16x32_bf16 v[132:135], v[116:119], v[84:87], v[132:135]
ds_read_b64_tr_b16 v[72:73], v7 offset:8192
v_mfma_f32_16x16x32_bf16 v[136:139], v[116:119], v[88:91], v[136:139]
ds_read_b64_tr_b16 v[74:75], v7 offset:8704
v_mfma_f32_16x16x32_bf16 v[140:143], v[116:119], v[92:95], v[140:143]
ds_read_b64_tr_b16 v[76:77], v7 offset:16384
v_mfma_f32_16x16x32_bf16 v[144:147], v[116:119], v[96:99], v[144:147]
ds_read_b64_tr_b16 v[78:79], v7 offset:16896
v_mfma_f32_16x16x32_bf16 v[148:151], v[116:119], v[100:103], v[148:151]
ds_read_b64_tr_b16 v[68:69], v7 offset:0
v_mfma_f32_16x16x32_bf16 v[152:155], v[116:119], v[104:107], v[152:155]
ds_read_b64_tr_b16 v[70:71], v7 offset:512
v_mfma_f32_16x16x32_bf16 v[156:159], v[116:119], v[108:111], v[156:159]
ds_read_b128 v[36:39], v2 offset:45056
v_mfma_f32_16x16x32_bf16 v[160:163], v[116:119], v[112:115], v[160:163]
ds_read_b128 v[40:43], v2 offset:47104
v_mfma_f32_16x16x32_bf16 v[196:199], v[120:123], v[112:115], v[196:199]
ds_read_b128 v[44:47], v2 offset:49152
v_mfma_f32_16x16x32_bf16 v[192:195], v[120:123], v[108:111], v[192:195]
ds_read_b128 v[48:51], v2 offset:51200
v_mfma_f32_16x16x32_bf16 v[188:191], v[120:123], v[104:107], v[188:191]
ds_read_b128 v[52:55], v2 offset:53248
v_mfma_f32_16x16x32_bf16 v[184:187], v[120:123], v[100:103], v[184:187]
ds_read_b128 v[56:59], v2 offset:55296
v_mfma_f32_16x16x32_bf16 v[180:183], v[120:123], v[96:99], v[180:183]
ds_read_b128 v[60:63], v2 offset:57344
v_mfma_f32_16x16x32_bf16 v[176:179], v[120:123], v[92:95], v[176:179]
ds_read_b128 v[64:67], v2 offset:59392
v_mfma_f32_16x16x32_bf16 v[172:175], v[120:123], v[88:91], v[172:175]
v_mfma_f32_16x16x32_bf16 v[168:171], v[120:123], v[84:87], v[168:171]
v_mfma_f32_16x16x32_bf16 v[164:167], v[120:123], v[80:83], v[164:167]
v_mfma_f32_16x16x32_bf16 v[200:203], v[124:127], v[80:83], v[200:203]
v_mfma_f32_16x16x32_bf16 v[204:207], v[124:127], v[84:87], v[204:207]
v_mfma_f32_16x16x32_bf16 v[208:211], v[124:127], v[88:91], v[208:211]
v_mfma_f32_16x16x32_bf16 v[212:215], v[124:127], v[92:95], v[212:215]
v_mfma_f32_16x16x32_bf16 v[216:219], v[124:127], v[96:99], v[216:219]
v_mfma_f32_16x16x32_bf16 v[220:223], v[124:127], v[100:103], v[220:223]
v_mfma_f32_16x16x32_bf16 v[224:227], v[124:127], v[104:107], v[224:227]
v_mfma_f32_16x16x32_bf16 v[228:231], v[124:127], v[108:111], v[228:231]
v_mfma_f32_16x16x32_bf16 v[232:235], v[124:127], v[112:115], v[232:235]
s_waitcnt lgkmcnt(0)
v_mfma_f32_16x16x32_bf16 v[128:131], v[68:71], v[32:35], v[128:131]
ds_read_b128 v[80:83], v3 offset:43008
v_mfma_f32_16x16x32_bf16 v[132:135], v[68:71], v[36:39], v[132:135]
ds_read_b64_tr_b16 v[120:121], v7 offset:12288
v_mfma_f32_16x16x32_bf16 v[136:139], v[68:71], v[40:43], v[136:139]
ds_read_b64_tr_b16 v[122:123], v7 offset:12800
v_mfma_f32_16x16x32_bf16 v[140:143], v[68:71], v[44:47], v[140:143]
ds_read_b64_tr_b16 v[124:125], v7 offset:20480
v_mfma_f32_16x16x32_bf16 v[144:147], v[68:71], v[48:51], v[144:147]
ds_read_b64_tr_b16 v[126:127], v7 offset:20992
v_mfma_f32_16x16x32_bf16 v[148:151], v[68:71], v[52:55], v[148:151]
ds_read_b64_tr_b16 v[116:117], v7 offset:4096
v_mfma_f32_16x16x32_bf16 v[152:155], v[68:71], v[56:59], v[152:155]
ds_read_b64_tr_b16 v[118:119], v7 offset:4608
v_mfma_f32_16x16x32_bf16 v[156:159], v[68:71], v[60:63], v[156:159]
ds_read_b128 v[84:87], v3 offset:45056
v_mfma_f32_16x16x32_bf16 v[160:163], v[68:71], v[64:67], v[160:163]
ds_read_b128 v[88:91], v3 offset:47104
v_mfma_f32_16x16x32_bf16 v[196:199], v[72:75], v[64:67], v[196:199]
ds_read_b128 v[92:95], v3 offset:49152
v_mfma_f32_16x16x32_bf16 v[192:195], v[72:75], v[60:63], v[192:195]
ds_read_b128 v[96:99], v3 offset:51200
v_mfma_f32_16x16x32_bf16 v[188:191], v[72:75], v[56:59], v[188:191]
ds_read_b128 v[100:103], v3 offset:53248
v_mfma_f32_16x16x32_bf16 v[184:187], v[72:75], v[52:55], v[184:187]
ds_read_b128 v[104:107], v3 offset:55296
v_mfma_f32_16x16x32_bf16 v[180:183], v[72:75], v[48:51], v[180:183]
ds_read_b128 v[108:111], v3 offset:57344
v_mfma_f32_16x16x32_bf16 v[176:179], v[72:75], v[44:47], v[176:179]
ds_read_b128 v[112:115], v3 offset:59392
v_mfma_f32_16x16x32_bf16 v[172:175], v[72:75], v[40:43], v[172:175]
v_mfma_f32_16x16x32_bf16 v[168:171], v[72:75], v[36:39], v[168:171]
v_mfma_f32_16x16x32_bf16 v[164:167], v[72:75], v[32:35], v[164:167]
v_mfma_f32_16x16x32_bf16 v[200:203], v[76:79], v[32:35], v[200:203]
v_mfma_f32_16x16x32_bf16 v[204:207], v[76:79], v[36:39], v[204:207]
v_mfma_f32_16x16x32_bf16 v[208:211], v[76:79], v[40:43], v[208:211]
v_mfma_f32_16x16x32_bf16 v[212:215], v[76:79], v[44:47], v[212:215]
v_mfma_f32_16x16x32_bf16 v[216:219], v[76:79], v[48:51], v[216:219]
v_mfma_f32_16x16x32_bf16 v[220:223], v[76:79], v[52:55], v[220:223]
v_mfma_f32_16x16x32_bf16 v[224:227], v[76:79], v[56:59], v[224:227]
v_mfma_f32_16x16x32_bf16 v[228:231], v[76:79], v[60:63], v[228:231]
v_mfma_f32_16x16x32_bf16 v[232:235], v[76:79], v[64:67], v[232:235]
s_waitcnt lgkmcnt(0)
s_barrier
v_mfma_f32_16x16x32_bf16 v[128:131], v[116:119], v[80:83], v[128:131]
ds_read_b128 v[32:35], v4 offset:0
v_mfma_f32_16x16x32_bf16 v[132:135], v[116:119], v[84:87], v[132:135]
ds_read_b64_tr_b16 v[72:73], v8 offset:8192
v_mfma_f32_16x16x32_bf16 v[136:139], v[116:119], v[88:91], v[136:139]
ds_read_b64_tr_b16 v[74:75], v8 offset:8704
v_mfma_f32_16x16x32_bf16 v[140:143], v[116:119], v[92:95], v[140:143]
ds_read_b64_tr_b16 v[76:77], v8 offset:16384
v_mfma_f32_16x16x32_bf16 v[144:147], v[116:119], v[96:99], v[144:147]
ds_read_b64_tr_b16 v[78:79], v8 offset:16896
v_mfma_f32_16x16x32_bf16 v[148:151], v[116:119], v[100:103], v[148:151]
ds_read_b64_tr_b16 v[68:69], v8 offset:0
v_mfma_f32_16x16x32_bf16 v[152:155], v[116:119], v[104:107], v[152:155]
ds_read_b64_tr_b16 v[70:71], v8 offset:512
v_mfma_f32_16x16x32_bf16 v[156:159], v[116:119], v[108:111], v[156:159]
ds_read_b128 v[36:39], v4 offset:2048
v_mfma_f32_16x16x32_bf16 v[160:163], v[116:119], v[112:115], v[160:163]
ds_read_b128 v[40:43], v4 offset:4096
v_mfma_f32_16x16x32_bf16 v[196:199], v[120:123], v[112:115], v[196:199]
ds_read_b128 v[44:47], v4 offset:6144
v_mfma_f32_16x16x32_bf16 v[192:195], v[120:123], v[108:111], v[192:195]
ds_read_b128 v[48:51], v4 offset:8192
v_mfma_f32_16x16x32_bf16 v[188:191], v[120:123], v[104:107], v[188:191]
ds_read_b128 v[52:55], v4 offset:10240
v_mfma_f32_16x16x32_bf16 v[184:187], v[120:123], v[100:103], v[184:187]
ds_read_b128 v[56:59], v4 offset:12288
v_mfma_f32_16x16x32_bf16 v[180:183], v[120:123], v[96:99], v[180:183]
ds_read_b128 v[60:63], v4 offset:14336
v_mfma_f32_16x16x32_bf16 v[176:179], v[120:123], v[92:95], v[176:179]
ds_read_b128 v[64:67], v4 offset:16384
v_mfma_f32_16x16x32_bf16 v[172:175], v[120:123], v[88:91], v[172:175]
v_mfma_f32_16x16x32_bf16 v[168:171], v[120:123], v[84:87], v[168:171]
v_mfma_f32_16x16x32_bf16 v[164:167], v[120:123], v[80:83], v[164:167]
v_mfma_f32_16x16x32_bf16 v[200:203], v[124:127], v[80:83], v[200:203]
v_mfma_f32_16x16x32_bf16 v[204:207], v[124:127], v[84:87], v[204:207]
v_mfma_f32_16x16x32_bf16 v[208:211], v[124:127], v[88:91], v[208:211]
v_mfma_f32_16x16x32_bf16 v[212:215], v[124:127], v[92:95], v[212:215]
v_mfma_f32_16x16x32_bf16 v[216:219], v[124:127], v[96:99], v[216:219]
v_mfma_f32_16x16x32_bf16 v[220:223], v[124:127], v[100:103], v[220:223]
v_mfma_f32_16x16x32_bf16 v[224:227], v[124:127], v[104:107], v[224:227]
v_mfma_f32_16x16x32_bf16 v[228:231], v[124:127], v[108:111], v[228:231]
v_mfma_f32_16x16x32_bf16 v[232:235], v[124:127], v[112:115], v[232:235]
s_waitcnt lgkmcnt(0)
v_mfma_f32_16x16x32_bf16 v[128:131], v[68:71], v[32:35], v[128:131]
ds_read_b128 v[80:83], v5 offset:0
v_mfma_f32_16x16x32_bf16 v[132:135], v[68:71], v[36:39], v[132:135]
ds_read_b64_tr_b16 v[120:121], v8 offset:12288
v_mfma_f32_16x16x32_bf16 v[136:139], v[68:71], v[40:43], v[136:139]
ds_read_b64_tr_b16 v[122:123], v8 offset:12800
v_mfma_f32_16x16x32_bf16 v[140:143], v[68:71], v[44:47], v[140:143]
ds_read_b64_tr_b16 v[124:125], v8 offset:20480
v_mfma_f32_16x16x32_bf16 v[144:147], v[68:71], v[48:51], v[144:147]
ds_read_b64_tr_b16 v[126:127], v8 offset:20992
v_mfma_f32_16x16x32_bf16 v[148:151], v[68:71], v[52:55], v[148:151]
ds_read_b64_tr_b16 v[116:117], v8 offset:4096
v_mfma_f32_16x16x32_bf16 v[152:155], v[68:71], v[56:59], v[152:155]
ds_read_b64_tr_b16 v[118:119], v8 offset:4608
v_mfma_f32_16x16x32_bf16 v[156:159], v[68:71], v[60:63], v[156:159]
ds_read_b128 v[84:87], v5 offset:2048
v_mfma_f32_16x16x32_bf16 v[160:163], v[68:71], v[64:67], v[160:163]
ds_read_b128 v[88:91], v5 offset:4096
v_mfma_f32_16x16x32_bf16 v[196:199], v[72:75], v[64:67], v[196:199]
ds_read_b128 v[92:95], v5 offset:6144
v_mfma_f32_16x16x32_bf16 v[192:195], v[72:75], v[60:63], v[192:195]
ds_read_b128 v[96:99], v5 offset:8192
v_mfma_f32_16x16x32_bf16 v[188:191], v[72:75], v[56:59], v[188:191]
ds_read_b128 v[100:103], v5 offset:10240
v_mfma_f32_16x16x32_bf16 v[184:187], v[72:75], v[52:55], v[184:187]
ds_read_b128 v[104:107], v5 offset:12288
v_mfma_f32_16x16x32_bf16 v[180:183], v[72:75], v[48:51], v[180:183]
ds_read_b128 v[108:111], v5 offset:14336
v_mfma_f32_16x16x32_bf16 v[176:179], v[72:75], v[44:47], v[176:179]
ds_read_b128 v[112:115], v5 offset:16384
v_mfma_f32_16x16x32_bf16 v[172:175], v[72:75], v[40:43], v[172:175]
v_mfma_f32_16x16x32_bf16 v[168:171], v[72:75], v[36:39], v[168:171]
v_mfma_f32_16x16x32_bf16 v[164:167], v[72:75], v[32:35], v[164:167]
v_mfma_f32_16x16x32_bf16 v[200:203], v[76:79], v[32:35], v[200:203]
v_mfma_f32_16x16x32_bf16 v[204:207], v[76:79], v[36:39], v[204:207]
v_mfma_f32_16x16x32_bf16 v[208:211], v[76:79], v[40:43], v[208:211]
v_mfma_f32_16x16x32_bf16 v[212:215], v[76:79], v[44:47], v[212:215]
v_mfma_f32_16x16x32_bf16 v[216:219], v[76:79], v[48:51], v[216:219]
v_mfma_f32_16x16x32_bf16 v[220:223], v[76:79], v[52:55], v[220:223]
v_mfma_f32_16x16x32_bf16 v[224:227], v[76:79], v[56:59], v[224:227]
v_mfma_f32_16x16x32_bf16 v[228:231], v[76:79], v[60:63], v[228:231]
v_mfma_f32_16x16x32_bf16 v[232:235], v[76:79], v[64:67], v[232:235]
s_waitcnt lgkmcnt(0)
s_barrier
v_mfma_f32_16x16x32_bf16 v[128:131], v[116:119], v[80:83], v[128:131]
ds_read_b128 v[32:35], v2 offset:0
v_mfma_f32_16x16x32_bf16 v[132:135], v[116:119], v[84:87], v[132:135]
ds_read_b64_tr_b16 v[72:73], v6 offset:8192
v_mfma_f32_16x16x32_bf16 v[136:139], v[116:119], v[88:91], v[136:139]
ds_read_b64_tr_b16 v[74:75], v6 offset:8704
v_mfma_f32_16x16x32_bf16 v[140:143], v[116:119], v[92:95], v[140:143]
ds_read_b64_tr_b16 v[76:77], v6 offset:16384
v_mfma_f32_16x16x32_bf16 v[144:147], v[116:119], v[96:99], v[144:147]
ds_read_b64_tr_b16 v[78:79], v6 offset:16896
v_mfma_f32_16x16x32_bf16 v[148:151], v[116:119], v[100:103], v[148:151]
ds_read_b64_tr_b16 v[68:69], v6 offset:0
v_mfma_f32_16x16x32_bf16 v[152:155], v[116:119], v[104:107], v[152:155]
ds_read_b64_tr_b16 v[70:71], v6 offset:512
v_mfma_f32_16x16x32_bf16 v[156:159], v[116:119], v[108:111], v[156:159]
ds_read_b128 v[36:39], v2 offset:2048
v_mfma_f32_16x16x32_bf16 v[160:163], v[116:119], v[112:115], v[160:163]
ds_read_b128 v[40:43], v2 offset:4096
v_mfma_f32_16x16x32_bf16 v[196:199], v[120:123], v[112:115], v[196:199]
ds_read_b128 v[44:47], v2 offset:6144
v_mfma_f32_16x16x32_bf16 v[192:195], v[120:123], v[108:111], v[192:195]
ds_read_b128 v[48:51], v2 offset:8192
v_mfma_f32_16x16x32_bf16 v[188:191], v[120:123], v[104:107], v[188:191]
ds_read_b128 v[52:55], v2 offset:10240
v_mfma_f32_16x16x32_bf16 v[184:187], v[120:123], v[100:103], v[184:187]
ds_read_b128 v[56:59], v2 offset:12288
v_mfma_f32_16x16x32_bf16 v[180:183], v[120:123], v[96:99], v[180:183]
ds_read_b128 v[60:63], v2 offset:14336
v_mfma_f32_16x16x32_bf16 v[176:179], v[120:123], v[92:95], v[176:179]
ds_read_b128 v[64:67], v2 offset:16384
v_mfma_f32_16x16x32_bf16 v[172:175], v[120:123], v[88:91], v[172:175]
v_mfma_f32_16x16x32_bf16 v[168:171], v[120:123], v[84:87], v[168:171]
v_mfma_f32_16x16x32_bf16 v[164:167], v[120:123], v[80:83], v[164:167]
v_mfma_f32_16x16x32_bf16 v[200:203], v[124:127], v[80:83], v[200:203]
v_mfma_f32_16x16x32_bf16 v[204:207], v[124:127], v[84:87], v[204:207]
v_mfma_f32_16x16x32_bf16 v[208:211], v[124:127], v[88:91], v[208:211]
v_mfma_f32_16x16x32_bf16 v[212:215], v[124:127], v[92:95], v[212:215]
v_mfma_f32_16x16x32_bf16 v[216:219], v[124:127], v[96:99], v[216:219]
v_mfma_f32_16x16x32_bf16 v[220:223], v[124:127], v[100:103], v[220:223]
v_mfma_f32_16x16x32_bf16 v[224:227], v[124:127], v[104:107], v[224:227]
v_mfma_f32_16x16x32_bf16 v[228:231], v[124:127], v[108:111], v[228:231]
v_mfma_f32_16x16x32_bf16 v[232:235], v[124:127], v[112:115], v[232:235]
s_mov_b32 s41, 4
Lcl_16:
s_waitcnt lgkmcnt(0)
v_mfma_f32_16x16x32_bf16 v[128:131], v[68:71], v[32:35], v[128:131]
ds_read_b128 v[80:83], v3 offset:0
v_mfma_f32_16x16x32_bf16 v[132:135], v[68:71], v[36:39], v[132:135]
ds_read_b64_tr_b16 v[120:121], v6 offset:12288
v_mfma_f32_16x16x32_bf16 v[136:139], v[68:71], v[40:43], v[136:139]
ds_read_b64_tr_b16 v[122:123], v6 offset:12800
v_mfma_f32_16x16x32_bf16 v[140:143], v[68:71], v[44:47], v[140:143]
ds_read_b64_tr_b16 v[124:125], v6 offset:20480
v_mfma_f32_16x16x32_bf16 v[144:147], v[68:71], v[48:51], v[144:147]
ds_read_b64_tr_b16 v[126:127], v6 offset:20992
v_mfma_f32_16x16x32_bf16 v[148:151], v[68:71], v[52:55], v[148:151]
ds_read_b64_tr_b16 v[116:117], v6 offset:4096
v_mfma_f32_16x16x32_bf16 v[152:155], v[68:71], v[56:59], v[152:155]
ds_read_b64_tr_b16 v[118:119], v6 offset:4608
v_mfma_f32_16x16x32_bf16 v[156:159], v[68:71], v[60:63], v[156:159]
ds_read_b128 v[84:87], v3 offset:2048
v_mfma_f32_16x16x32_bf16 v[160:163], v[68:71], v[64:67], v[160:163]
ds_read_b128 v[88:91], v3 offset:4096
v_mfma_f32_16x16x32_bf16 v[196:199], v[72:75], v[64:67], v[196:199]
ds_read_b128 v[92:95], v3 offset:6144
v_mfma_f32_16x16x32_bf16 v[192:195], v[72:75], v[60:63], v[192:195]
ds_read_b128 v[96:99], v3 offset:8192
v_mfma_f32_16x16x32_bf16 v[188:191], v[72:75], v[56:59], v[188:191]
ds_read_b128 v[100:103], v3 offset:10240
v_mfma_f32_16x16x32_bf16 v[184:187], v[72:75], v[52:55], v[184:187]
ds_read_b128 v[104:107], v3 offset:12288
v_mfma_f32_16x16x32_bf16 v[180:183], v[72:75], v[48:51], v[180:183]
ds_read_b128 v[108:111], v3 offset:14336
v_mfma_f32_16x16x32_bf16 v[176:179], v[72:75], v[44:47], v[176:179]
ds_read_b128 v[112:115], v3 offset:16384
v_mfma_f32_16x16x32_bf16 v[172:175], v[72:75], v[40:43], v[172:175]
v_mfma_f32_16x16x32_bf16 v[168:171], v[72:75], v[36:39], v[168:171]
v_mfma_f32_16x16x32_bf16 v[164:167], v[72:75], v[32:35], v[164:167]
v_mfma_f32_16x16x32_bf16 v[200:203], v[76:79], v[32:35], v[200:203]
v_mfma_f32_16x16x32_bf16 v[204:207], v[76:79], v[36:39], v[204:207]
v_mfma_f32_16x16x32_bf16 v[208:211], v[76:79], v[40:43], v[208:211]
v_mfma_f32_16x16x32_bf16 v[212:215], v[76:79], v[44:47], v[212:215]
v_mfma_f32_16x16x32_bf16 v[216:219], v[76:79], v[48:51], v[216:219]
v_mfma_f32_16x16x32_bf16 v[220:223], v[76:79], v[52:55], v[220:223]
v_mfma_f32_16x16x32_bf16 v[224:227], v[76:79], v[56:59], v[224:227]
v_mfma_f32_16x16x32_bf16 v[228:231], v[76:79], v[60:63], v[228:231]
v_mfma_f32_16x16x32_bf16 v[232:235], v[76:79], v[64:67], v[232:235]
s_waitcnt lgkmcnt(0)
s_barrier
v_mfma_f32_16x16x32_bf16 v[128:131], v[116:119], v[80:83], v[128:131]
ds_read_b128 v[32:35], v2 offset:43008
v_mfma_f32_16x16x32_bf16 v[132:135], v[116:119], v[84:87], v[132:135]
ds_read_b64_tr_b16 v[72:73], v7 offset:8192
v_mfma_f32_16x16x32_bf16 v[136:139], v[116:119], v[88:91], v[136:139]
ds_read_b64_tr_b16 v[74:75], v7 offset:8704
v_mfma_f32_16x16x32_bf16 v[140:143], v[116:119], v[92:95], v[140:143]
ds_read_b64_tr_b16 v[76:77], v7 offset:16384
v_mfma_f32_16x16x32_bf16 v[144:147], v[116:119], v[96:99], v[144:147]
ds_read_b64_tr_b16 v[78:79], v7 offset:16896
v_mfma_f32_16x16x32_bf16 v[148:151], v[116:119], v[100:103], v[148:151]
ds_read_b64_tr_b16 v[68:69], v7 offset:0
v_mfma_f32_16x16x32_bf16 v[152:155], v[116:119], v[104:107], v[152:155]
ds_read_b64_tr_b16 v[70:71], v7 offset:512
v_mfma_f32_16x16x32_bf16 v[156:159], v[116:119], v[108:111], v[156:159]
ds_read_b128 v[36:39], v2 offset:45056
v_mfma_f32_16x16x32_bf16 v[160:163], v[116:119], v[112:115], v[160:163]
ds_read_b128 v[40:43], v2 offset:47104
s_branch Lov_2
.p2align 12
.fill 16, 4, 0xbf800000
Lst_2_0:
s_branch Lst_3_0
s_nop 0
s_nop 0
Lov_2:
v_mfma_f32_16x16x32_bf16 v[196:199], v[120:123], v[112:115], v[196:199]
ds_read_b128 v[44:47], v2 offset:49152
v_mfma_f32_16x16x32_bf16 v[192:195], v[120:123], v[108:111], v[192:195]
ds_read_b128 v[48:51], v2 offset:51200
v_mfma_f32_16x16x32_bf16 v[188:191], v[120:123], v[104:107], v[188:191]
ds_read_b128 v[52:55], v2 offset:53248
v_mfma_f32_16x16x32_bf16 v[184:187], v[120:123], v[100:103], v[184:187]
ds_read_b128 v[56:59], v2 offset:55296
v_mfma_f32_16x16x32_bf16 v[180:183], v[120:123], v[96:99], v[180:183]
ds_read_b128 v[60:63], v2 offset:57344
v_mfma_f32_16x16x32_bf16 v[176:179], v[120:123], v[92:95], v[176:179]
ds_read_b128 v[64:67], v2 offset:59392
v_mfma_f32_16x16x32_bf16 v[172:175], v[120:123], v[88:91], v[172:175]
v_mfma_f32_16x16x32_bf16 v[168:171], v[120:123], v[84:87], v[168:171]
v_mfma_f32_16x16x32_bf16 v[164:167], v[120:123], v[80:83], v[164:167]
v_mfma_f32_16x16x32_bf16 v[200:203], v[124:127], v[80:83], v[200:203]
v_mfma_f32_16x16x32_bf16 v[204:207], v[124:127], v[84:87], v[204:207]
v_mfma_f32_16x16x32_bf16 v[208:211], v[124:127], v[88:91], v[208:211]
v_mfma_f32_16x16x32_bf16 v[212:215], v[124:127], v[92:95], v[212:215]
v_mfma_f32_16x16x32_bf16 v[216:219], v[124:127], v[96:99], v[216:219]
v_mfma_f32_16x16x32_bf16 v[220:223], v[124:127], v[100:103], v[220:223]
v_mfma_f32_16x16x32_bf16 v[224:227], v[124:127], v[104:107], v[224:227]
v_mfma_f32_16x16x32_bf16 v[228:231], v[124:127], v[108:111], v[228:231]
v_mfma_f32_16x16x32_bf16 v[232:235], v[124:127], v[112:115], v[232:235]
s_waitcnt lgkmcnt(0)
v_mfma_f32_16x16x32_bf16 v[128:131], v[68:71], v[32:35], v[128:131]
ds_read_b128 v[80:83], v3 offset:43008
v_mfma_f32_16x16x32_bf16 v[132:135], v[68:71], v[36:39], v[132:135]
ds_read_b64_tr_b16 v[120:121], v7 offset:12288
v_mfma_f32_16x16x32_bf16 v[136:139], v[68:71], v[40:43], v[136:139]
ds_read_b64_tr_b16 v[122:123], v7 offset:12800
v_mfma_f32_16x16x32_bf16 v[140:143], v[68:71], v[44:47], v[140:143]
ds_read_b64_tr_b16 v[124:125], v7 offset:20480
v_mfma_f32_16x16x32_bf16 v[144:147], v[68:71], v[48:51], v[144:147]
ds_read_b64_tr_b16 v[126:127], v7 offset:20992
v_mfma_f32_16x16x32_bf16 v[148:151], v[68:71], v[52:55], v[148:151]
ds_read_b64_tr_b16 v[116:117], v7 offset:4096
v_mfma_f32_16x16x32_bf16 v[152:155], v[68:71], v[56:59], v[152:155]
ds_read_b64_tr_b16 v[118:119], v7 offset:4608
v_mfma_f32_16x16x32_bf16 v[156:159], v[68:71], v[60:63], v[156:159]
ds_read_b128 v[84:87], v3 offset:45056
v_mfma_f32_16x16x32_bf16 v[160:163], v[68:71], v[64:67], v[160:163]
ds_read_b128 v[88:91], v3 offset:47104
v_mfma_f32_16x16x32_bf16 v[196:199], v[72:75], v[64:67], v[196:199]
ds_read_b128 v[92:95], v3 offset:49152
v_mfma_f32_16x16x32_bf16 v[192:195], v[72:75], v[60:63], v[192:195]
ds_read_b128 v[96:99], v3 offset:51200
v_mfma_f32_16x16x32_bf16 v[188:191], v[72:75], v[56:59], v[188:191]
ds_read_b128 v[100:103], v3 offset:53248
v_mfma_f32_16x16x32_bf16 v[184:187], v[72:75], v[52:55], v[184:187]
ds_read_b128 v[104:107], v3 offset:55296
v_mfma_f32_16x16x32_bf16 v[180:183], v[72:75], v[48:51], v[180:183]
ds_read_b128 v[108:111], v3 offset:57344
v_mfma_f32_16x16x32_bf16 v[176:179], v[72:75], v[44:47], v[176:179]
ds_read_b128 v[112:115], v3 offset:59392
v_mfma_f32_16x16x32_bf16 v[172:175], v[72:75], v[40:43], v[172:175]
v_mfma_f32_16x16x32_bf16 v[168:171], v[72:75], v[36:39], v[168:171]
v_mfma_f32_16x16x32_bf16 v[164:167], v[72:75], v[32:35], v[164:167]
v_mfma_f32_16x16x32_bf16 v[200:203], v[76:79], v[32:35], v[200:203]
v_mfma_f32_16x16x32_bf16 v[204:207], v[76:79], v[36:39], v[204:207]
v_mfma_f32_16x16x32_bf16 v[208:211], v[76:79], v[40:43], v[208:211]
v_mfma_f32_16x16x32_bf16 v[212:215], v[76:79], v[44:47], v[212:215]
v_mfma_f32_16x16x32_bf16 v[216:219], v[76:79], v[48:51], v[216:219]
v_mfma_f32_16x16x32_bf16 v[220:223], v[76:79], v[52:55], v[220:223]
v_mfma_f32_16x16x32_bf16 v[224:227], v[76:79], v[56:59], v[224:227]
v_mfma_f32_16x16x32_bf16 v[228:231], v[76:79], v[60:63], v[228:231]
v_mfma_f32_16x16x32_bf16 v[232:235], v[76:79], v[64:67], v[232:235]
s_waitcnt lgkmcnt(0)
s_barrier
v_mfma_f32_16x16x32_bf16 v[128:131], v[116:119], v[80:83], v[128:131]
ds_read_b128 v[32:35], v4 offset:0
v_mfma_f32_16x16x32_bf16 v[132:135], v[116:119], v[84:87], v[132:135]
ds_read_b64_tr_b16 v[72:73], v8 offset:8192
v_mfma_f32_16x16x32_bf16 v[136:139], v[116:119], v[88:91], v[136:139]
ds_read_b64_tr_b16 v[74:75], v8 offset:8704
v_mfma_f32_16x16x32_bf16 v[140:143], v[116:119], v[92:95], v[140:143]
ds_read_b64_tr_b16 v[76:77], v8 offset:16384
v_mfma_f32_16x16x32_bf16 v[144:147], v[116:119], v[96:99], v[144:147]
ds_read_b64_tr_b16 v[78:79], v8 offset:16896
v_mfma_f32_16x16x32_bf16 v[148:151], v[116:119], v[100:103], v[148:151]
ds_read_b64_tr_b16 v[68:69], v8 offset:0
v_mfma_f32_16x16x32_bf16 v[152:155], v[116:119], v[104:107], v[152:155]
ds_read_b64_tr_b16 v[70:71], v8 offset:512
v_mfma_f32_16x16x32_bf16 v[156:159], v[116:119], v[108:111], v[156:159]
ds_read_b128 v[36:39], v4 offset:2048
v_mfma_f32_16x16x32_bf16 v[160:163], v[116:119], v[112:115], v[160:163]
ds_read_b128 v[40:43], v4 offset:4096
v_mfma_f32_16x16x32_bf16 v[196:199], v[120:123], v[112:115], v[196:199]
ds_read_b128 v[44:47], v4 offset:6144
v_mfma_f32_16x16x32_bf16 v[192:195], v[120:123], v[108:111], v[192:195]
ds_read_b128 v[48:51], v4 offset:8192
v_mfma_f32_16x16x32_bf16 v[188:191], v[120:123], v[104:107], v[188:191]
ds_read_b128 v[52:55], v4 offset:10240
v_mfma_f32_16x16x32_bf16 v[184:187], v[120:123], v[100:103], v[184:187]
ds_read_b128 v[56:59], v4 offset:12288
v_mfma_f32_16x16x32_bf16 v[180:183], v[120:123], v[96:99], v[180:183]
ds_read_b128 v[60:63], v4 offset:14336
v_mfma_f32_16x16x32_bf16 v[176:179], v[120:123], v[92:95], v[176:179]
ds_read_b128 v[64:67], v4 offset:16384
v_mfma_f32_16x16x32_bf16 v[172:175], v[120:123], v[88:91], v[172:175]
v_mfma_f32_16x16x32_bf16 v[168:171], v[120:123], v[84:87], v[168:171]
v_mfma_f32_16x16x32_bf16 v[164:167], v[120:123], v[80:83], v[164:167]
v_mfma_f32_16x16x32_bf16 v[200:203], v[124:127], v[80:83], v[200:203]
v_mfma_f32_16x16x32_bf16 v[204:207], v[124:127], v[84:87], v[204:207]
v_mfma_f32_16x16x32_bf16 v[208:211], v[124:127], v[88:91], v[208:211]
v_mfma_f32_16x16x32_bf16 v[212:215], v[124:127], v[92:95], v[212:215]
v_mfma_f32_16x16x32_bf16 v[216:219], v[124:127], v[96:99], v[216:219]
v_mfma_f32_16x16x32_bf16 v[220:223], v[124:127], v[100:103], v[220:223]
v_mfma_f32_16x16x32_bf16 v[224:227], v[124:127], v[104:107], v[224:227]
v_mfma_f32_16x16x32_bf16 v[228:231], v[124:127], v[108:111], v[228:231]
v_mfma_f32_16x16x32_bf16 v[232:235], v[124:127], v[112:115], v[232:235]
s_waitcnt lgkmcnt(0)
v_mfma_f32_16x16x32_bf16 v[128:131], v[68:71], v[32:35], v[128:131]
ds_read_b128 v[80:83], v5 offset:0
v_mfma_f32_16x16x32_bf16 v[132:135], v[68:71], v[36:39], v[132:135]
ds_read_b64_tr_b16 v[120:121], v8 offset:12288
v_mfma_f32_16x16x32_bf16 v[136:139], v[68:71], v[40:43], v[136:139]
ds_read_b64_tr_b16 v[122:123], v8 offset:12800
v_mfma_f32_16x16x32_bf16 v[140:143], v[68:71], v[44:47], v[140:143]
ds_read_b64_tr_b16 v[124:125], v8 offset:20480
v_mfma_f32_16x16x32_bf16 v[144:147], v[68:71], v[48:51], v[144:147]
ds_read_b64_tr_b16 v[126:127], v8 offset:20992
v_mfma_f32_16x16x32_bf16 v[148:151], v[68:71], v[52:55], v[148:151]
ds_read_b64_tr_b16 v[116:117], v8 offset:4096
v_mfma_f32_16x16x32_bf16 v[152:155], v[68:71], v[56:59], v[152:155]
ds_read_b64_tr_b16 v[118:119], v8 offset:4608
v_mfma_f32_16x16x32_bf16 v[156:159], v[68:71], v[60:63], v[156:159]
ds_read_b128 v[84:87], v5 offset:2048
v_mfma_f32_16x16x32_bf16 v[160:163], v[68:71], v[64:67], v[160:163]
ds_read_b128 v[88:91], v5 offset:4096
v_mfma_f32_16x16x32_bf16 v[196:199], v[72:75], v[64:67], v[196:199]
ds_read_b128 v[92:95], v5 offset:6144
v_mfma_f32_16x16x32_bf16 v[192:195], v[72:75], v[60:63], v[192:195]
ds_read_b128 v[96:99], v5 offset:8192
v_mfma_f32_16x16x32_bf16 v[188:191], v[72:75], v[56:59], v[188:191]
ds_read_b128 v[100:103], v5 offset:10240
v_mfma_f32_16x16x32_bf16 v[184:187], v[72:75], v[52:55], v[184:187]
ds_read_b128 v[104:107], v5 offset:12288
v_mfma_f32_16x16x32_bf16 v[180:183], v[72:75], v[48:51], v[180:183]
ds_read_b128 v[108:111], v5 offset:14336
v_mfma_f32_16x16x32_bf16 v[176:179], v[72:75], v[44:47], v[176:179]
ds_read_b128 v[112:115], v5 offset:16384
v_mfma_f32_16x16x32_bf16 v[172:175], v[72:75], v[40:43], v[172:175]
v_mfma_f32_16x16x32_bf16 v[168:171], v[72:75], v[36:39], v[168:171]
v_mfma_f32_16x16x32_bf16 v[164:167], v[72:75], v[32:35], v[164:167]
v_mfma_f32_16x16x32_bf16 v[200:203], v[76:79], v[32:35], v[200:203]
v_mfma_f32_16x16x32_bf16 v[204:207], v[76:79], v[36:39], v[204:207]
v_mfma_f32_16x16x32_bf16 v[208:211], v[76:79], v[40:43], v[208:211]
v_mfma_f32_16x16x32_bf16 v[212:215], v[76:79], v[44:47], v[212:215]
v_mfma_f32_16x16x32_bf16 v[216:219], v[76:79], v[48:51], v[216:219]
v_mfma_f32_16x16x32_bf16 v[220:223], v[76:79], v[52:55], v[220:223]
v_mfma_f32_16x16x32_bf16 v[224:227], v[76:79], v[56:59], v[224:227]
v_mfma_f32_16x16x32_bf16 v[228:231], v[76:79], v[60:63], v[228:231]
v_mfma_f32_16x16x32_bf16 v[232:235], v[76:79], v[64:67], v[232:235]
s_waitcnt lgkmcnt(0)
s_barrier
v_mfma_f32_16x16x32_bf16 v[128:131], v[116:119], v[80:83], v[128:131]
ds_read_b128 v[32:35], v2 offset:0
v_mfma_f32_16x16x32_bf16 v[132:135], v[116:119], v[84:87], v[132:135]
ds_read_b64_tr_b16 v[72:73], v6 offset:8192
v_mfma_f32_16x16x32_bf16 v[136:139], v[116:119], v[88:91], v[136:139]
ds_read_b64_tr_b16 v[74:75], v6 offset:8704
v_mfma_f32_16x16x32_bf16 v[140:143], v[116:119], v[92:95], v[140:143]
ds_read_b64_tr_b16 v[76:77], v6 offset:16384
v_mfma_f32_16x16x32_bf16 v[144:147], v[116:119], v[96:99], v[144:147]
ds_read_b64_tr_b16 v[78:79], v6 offset:16896
v_mfma_f32_16x16x32_bf16 v[148:151], v[116:119], v[100:103], v[148:151]
ds_read_b64_tr_b16 v[68:69], v6 offset:0
v_mfma_f32_16x16x32_bf16 v[152:155], v[116:119], v[104:107], v[152:155]
ds_read_b64_tr_b16 v[70:71], v6 offset:512
v_mfma_f32_16x16x32_bf16 v[156:159], v[116:119], v[108:111], v[156:159]
ds_read_b128 v[36:39], v2 offset:2048
v_mfma_f32_16x16x32_bf16 v[160:163], v[116:119], v[112:115], v[160:163]
ds_read_b128 v[40:43], v2 offset:4096
v_mfma_f32_16x16x32_bf16 v[196:199], v[120:123], v[112:115], v[196:199]
ds_read_b128 v[44:47], v2 offset:6144
v_mfma_f32_16x16x32_bf16 v[192:195], v[120:123], v[108:111], v[192:195]
ds_read_b128 v[48:51], v2 offset:8192
v_mfma_f32_16x16x32_bf16 v[188:191], v[120:123], v[104:107], v[188:191]
ds_read_b128 v[52:55], v2 offset:10240
v_mfma_f32_16x16x32_bf16 v[184:187], v[120:123], v[100:103], v[184:187]
ds_read_b128 v[56:59], v2 offset:12288
v_mfma_f32_16x16x32_bf16 v[180:183], v[120:123], v[96:99], v[180:183]
ds_read_b128 v[60:63], v2 offset:14336
v_mfma_f32_16x16x32_bf16 v[176:179], v[120:123], v[92:95], v[176:179]
ds_read_b128 v[64:67], v2 offset:16384
v_mfma_f32_16x16x32_bf16 v[172:175], v[120:123], v[88:91], v[172:175]
v_mfma_f32_16x16x32_bf16 v[168:171], v[120:123], v[84:87], v[168:171]
v_mfma_f32_16x16x32_bf16 v[164:167], v[120:123], v[80:83], v[164:167]
v_mfma_f32_16x16x32_bf16 v[200:203], v[124:127], v[80:83], v[200:203]
v_mfma_f32_16x16x32_bf16 v[204:207], v[124:127], v[84:87], v[204:207]
v_mfma_f32_16x16x32_bf16 v[208:211], v[124:127], v[88:91], v[208:211]
v_mfma_f32_16x16x32_bf16 v[212:215], v[124:127], v[92:95], v[212:215]
v_mfma_f32_16x16x32_bf16 v[216:219], v[124:127], v[96:99], v[216:219]
v_mfma_f32_16x16x32_bf16 v[220:223], v[124:127], v[100:103], v[220:223]
v_mfma_f32_16x16x32_bf16 v[224:227], v[124:127], v[104:107], v[224:227]
v_mfma_f32_16x16x32_bf16 v[228:231], v[124:127], v[108:111], v[228:231]
v_mfma_f32_16x16x32_bf16 v[232:235], v[124:127], v[112:115], v[232:235]
s_sub_u32 s41, s41, 1
s_cmp_lg_u32 s41, 0
s_cbranch_scc1 Lcl_16
s_waitcnt lgkmcnt(0)
v_mfma_f32_16x16x32_bf16 v[128:131], v[68:71], v[32:35], v[128:131]
ds_read_b128 v[80:83], v3 offset:0
v_mfma_f32_16x16x32_bf16 v[132:135], v[68:71], v[36:39], v[132:135]
ds_read_b64_tr_b16 v[120:121], v6 offset:12288
v_mfma_f32_16x16x32_bf16 v[136:139], v[68:71], v[40:43], v[136:139]
ds_read_b64_tr_b16 v[122:123], v6 offset:12800
v_mfma_f32_16x16x32_bf16 v[140:143], v[68:71], v[44:47], v[140:143]
ds_read_b64_tr_b16 v[124:125], v6 offset:20480
v_mfma_f32_16x16x32_bf16 v[144:147], v[68:71], v[48:51], v[144:147]
ds_read_b64_tr_b16 v[126:127], v6 offset:20992
v_mfma_f32_16x16x32_bf16 v[148:151], v[68:71], v[52:55], v[148:151]
ds_read_b64_tr_b16 v[116:117], v6 offset:4096
v_mfma_f32_16x16x32_bf16 v[152:155], v[68:71], v[56:59], v[152:155]
ds_read_b64_tr_b16 v[118:119], v6 offset:4608
v_mfma_f32_16x16x32_bf16 v[156:159], v[68:71], v[60:63], v[156:159]
ds_read_b128 v[84:87], v3 offset:2048
v_mfma_f32_16x16x32_bf16 v[160:163], v[68:71], v[64:67], v[160:163]
ds_read_b128 v[88:91], v3 offset:4096
v_mfma_f32_16x16x32_bf16 v[196:199], v[72:75], v[64:67], v[196:199]
ds_read_b128 v[92:95], v3 offset:6144
v_mfma_f32_16x16x32_bf16 v[192:195], v[72:75], v[60:63], v[192:195]
ds_read_b128 v[96:99], v3 offset:8192
v_mfma_f32_16x16x32_bf16 v[188:191], v[72:75], v[56:59], v[188:191]
ds_read_b128 v[100:103], v3 offset:10240
v_mfma_f32_16x16x32_bf16 v[184:187], v[72:75], v[52:55], v[184:187]
ds_read_b128 v[104:107], v3 offset:12288
v_mfma_f32_16x16x32_bf16 v[180:183], v[72:75], v[48:51], v[180:183]
ds_read_b128 v[108:111], v3 offset:14336
v_mfma_f32_16x16x32_bf16 v[176:179], v[72:75], v[44:47], v[176:179]
ds_read_b128 v[112:115], v3 offset:16384
v_mfma_f32_16x16x32_bf16 v[172:175], v[72:75], v[40:43], v[172:175]
v_mfma_f32_16x16x32_bf16 v[168:171], v[72:75], v[36:39], v[168:171]
v_mfma_f32_16x16x32_bf16 v[164:167], v[72:75], v[32:35], v[164:167]
v_mfma_f32_16x16x32_bf16 v[200:203], v[76:79], v[32:35], v[200:203]
v_mfma_f32_16x16x32_bf16 v[204:207], v[76:79], v[36:39], v[204:207]
v_mfma_f32_16x16x32_bf16 v[208:211], v[76:79], v[40:43], v[208:211]
v_mfma_f32_16x16x32_bf16 v[212:215], v[76:79], v[44:47], v[212:215]
v_mfma_f32_16x16x32_bf16 v[216:219], v[76:79], v[48:51], v[216:219]
v_mfma_f32_16x16x32_bf16 v[220:223], v[76:79], v[52:55], v[220:223]
v_mfma_f32_16x16x32_bf16 v[224:227], v[76:79], v[56:59], v[224:227]
v_mfma_f32_16x16x32_bf16 v[228:231], v[76:79], v[60:63], v[228:231]
v_mfma_f32_16x16x32_bf16 v[232:235], v[76:79], v[64:67], v[232:235]
s_waitcnt lgkmcnt(0)
v_mfma_f32_16x16x32_bf16 v[128:131], v[116:119], v[80:83], v[128:131]
v_mfma_f32_16x16x32_bf16 v[132:135], v[116:119], v[84:87], v[132:135]
v_mfma_f32_16x16x32_bf16 v[136:139], v[116:119], v[88:91], v[136:139]
v_mfma_f32_16x16x32_bf16 v[140:143], v[116:119], v[92:95], v[140:143]
v_mfma_f32_16x16x32_bf16 v[144:147], v[116:119], v[96:99], v[144:147]
v_mfma_f32_16x16x32_bf16 v[148:151], v[116:119], v[100:103], v[148:151]
v_mfma_f32_16x16x32_bf16 v[152:155], v[116:119], v[104:107], v[152:155]
v_mfma_f32_16x16x32_bf16 v[156:159], v[116:119], v[108:111], v[156:159]
v_mfma_f32_16x16x32_bf16 v[160:163], v[116:119], v[112:115], v[160:163]
v_mfma_f32_16x16x32_bf16 v[196:199], v[120:123], v[112:115], v[196:199]
v_mfma_f32_16x16x32_bf16 v[192:195], v[120:123], v[108:111], v[192:195]
v_mfma_f32_16x16x32_bf16 v[188:191], v[120:123], v[104:107], v[188:191]
v_mfma_f32_16x16x32_bf16 v[184:187], v[120:123], v[100:103], v[184:187]
v_mfma_f32_16x16x32_bf16 v[180:183], v[120:123], v[96:99], v[180:183]
v_mfma_f32_16x16x32_bf16 v[176:179], v[120:123], v[92:95], v[176:179]
v_mfma_f32_16x16x32_bf16 v[172:175], v[120:123], v[88:91], v[172:175]
v_mfma_f32_16x16x32_bf16 v[168:171], v[120:123], v[84:87], v[168:171]
v_mfma_f32_16x16x32_bf16 v[164:167], v[120:123], v[80:83], v[164:167]
v_mfma_f32_16x16x32_bf16 v[200:203], v[124:127], v[80:83], v[200:203]
v_mfma_f32_16x16x32_bf16 v[204:207], v[124:127], v[84:87], v[204:207]
v_mfma_f32_16x16x32_bf16 v[208:211], v[124:127], v[88:91], v[208:211]
v_mfma_f32_16x16x32_bf16 v[212:215], v[124:127], v[92:95], v[212:215]
v_mfma_f32_16x16x32_bf16 v[216:219], v[124:127], v[96:99], v[216:219]
v_mfma_f32_16x16x32_bf16 v[220:223], v[124:127], v[100:103], v[220:223]
v_mfma_f32_16x16x32_bf16 v[224:227], v[124:127], v[104:107], v[224:227]
v_mfma_f32_16x16x32_bf16 v[228:231], v[124:127], v[108:111], v[228:231]
v_mfma_f32_16x16x32_bf16 v[232:235], v[124:127], v[112:115], v[232:235]
v_lshlrev_b32 v14, 3, v12
v_add_u32 v14, 147456, v14
v_mul_u32_u24 v15, 400, v12
v_lshl_add_u32 v15, v13, 3, v15
s_lshl_b32 s43, s36, 5
v_add_u32 v15, s43, v15
s_barrier
ds_read_b64 v[32:33], v14 offset:0
ds_read_b64 v[34:35], v14 offset:128
ds_read_b64 v[36:37], v14 offset:256
ds_read_b64 v[38:39], v14 offset:384
ds_read_b64 v[40:41], v14 offset:512
ds_read_b64 v[42:43], v14 offset:640
ds_read_b64 v[44:45], v14 offset:768
ds_read_b64 v[46:47], v14 offset:896
ds_read_b64 v[48:49], v14 offset:1024
v_mov_b32_dpp v52, v128 row_newbcast:0 row_mask:0xf bank_mask:0xf
v_mov_b32_dpp v53, v129 row_newbcast:0 row_mask:0xf bank_mask:0xf
v_mov_b32_dpp v54, v130 row_newbcast:0 row_mask:0xf bank_mask:0xf
v_mov_b32_dpp v55, v131 row_newbcast:0 row_mask:0xf bank_mask:0xf
v_mov_b32_dpp v56, v164 row_newbcast:0 row_mask:0xf bank_mask:0xf
v_mov_b32_dpp v57, v165 row_newbcast:0 row_mask:0xf bank_mask:0xf
v_mov_b32_dpp v58, v166 row_newbcast:0 row_mask:0xf bank_mask:0xf
v_mov_b32_dpp v59, v167 row_newbcast:0 row_mask:0xf bank_mask:0xf
v_mov_b32_dpp v60, v200 row_newbcast:0 row_mask:0xf bank_mask:0xf
v_mov_b32_dpp v61, v201 row_newbcast:0 row_mask:0xf bank_mask:0xf
v_mov_b32_dpp v62, v202 row_newbcast:0 row_mask:0xf bank_mask:0xf
v_mov_b32_dpp v63, v203 row_newbcast:0 row_mask:0xf bank_mask:0xf
s_waitcnt lgkmcnt(0)
v_pk_fma_f32 v[164:165], v[32:33], v[56:57], v[164:165] op_sel_hi:[0,1,1] neg_lo:[1,0,0] neg_hi:[1,0,0]
v_pk_fma_f32 v[166:167], v[32:33], v[58:59], v[166:167] op_sel_hi:[0,1,1] neg_lo:[1,0,0] neg_hi:[1,0,0]
v_pk_fma_f32 v[200:201], v[32:33], v[60:61], v[200:201] op_sel_hi:[0,1,1] neg_lo:[1,0,0] neg_hi:[1,0,0]
v_pk_fma_f32 v[202:203], v[32:33], v[62:63], v[202:203] op_sel_hi:[0,1,1] neg_lo:[1,0,0] neg_hi:[1,0,0]
v_pk_mul_f32 v[164:165], v[32:33], v[164:165] op_sel:[1,0] op_sel_hi:[1,1]
v_pk_mul_f32 v[166:167], v[32:33], v[166:167] op_sel:[1,0] op_sel_hi:[1,1]
v_pk_fma_f32 v[132:133], v[34:35], v[52:53], v[132:133] op_sel_hi:[0,1,1] neg_lo:[1,0,0] neg_hi:[1,0,0]
v_pk_fma_f32 v[134:135], v[34:35], v[54:55], v[134:135] op_sel_hi:[0,1,1] neg_lo:[1,0,0] neg_hi:[1,0,0]
v_pk_mul_f32 v[200:201], v[32:33], v[200:201] op_sel:[1,0] op_sel_hi:[1,1]
v_pk_mul_f32 v[202:203], v[32:33], v[202:203] op_sel:[1,0] op_sel_hi:[1,1]
v_cvt_pk_bf16_f32 v164, v164, v165
v_cvt_pk_bf16_f32 v165, v166, v167
ds_write_b64 v15, v[164:165] offset:128
v_pk_fma_f32 v[168:169], v[34:35], v[56:57], v[168:169] op_sel_hi:[0,1,1] neg_lo:[1,0,0] neg_hi:[1,0,0]
v_pk_fma_f32 v[170:171], v[34:35], v[58:59], v[170:171] op_sel_hi:[0,1,1] neg_lo:[1,0,0] neg_hi:[1,0,0]
v_pk_mul_f32 v[132:133], v[34:35], v[132:133] op_sel:[1,0] op_sel_hi:[1,1]
v_pk_mul_f32 v[134:135], v[34:35], v[134:135] op_sel:[1,0] op_sel_hi:[1,1]
v_cvt_pk_bf16_f32 v200, v200, v201
v_cvt_pk_bf16_f32 v201, v202, v203
ds_write_b64 v15, v[200:201] offset:256
v_pk_fma_f32 v[204:205], v[34:35], v[60:61], v[204:205] op_sel_hi:[0,1,1] neg_lo:[1,0,0] neg_hi:[1,0,0]
v_pk_fma_f32 v[206:207], v[34:35], v[62:63], v[206:207] op_sel_hi:[0,1,1] neg_lo:[1,0,0] neg_hi:[1,0,0]
v_pk_mul_f32 v[168:169], v[34:35], v[168:169] op_sel:[1,0] op_sel_hi:[1,1]
v_pk_mul_f32 v[170:171], v[34:35], v[170:171] op_sel:[1,0] op_sel_hi:[1,1]
v_cvt_pk_bf16_f32 v132, v132, v133
v_cvt_pk_bf16_f32 v133, v134, v135
ds_write_b64 v15, v[132:133] offset:6400
v_pk_fma_f32 v[136:137], v[36:37], v[52:53], v[136:137] op_sel_hi:[0,1,1] neg_lo:[1,0,0] neg_hi:[1,0,0]
v_pk_fma_f32 v[138:139], v[36:37], v[54:55], v[138:139] op_sel_hi:[0,1,1] neg_lo:[1,0,0] neg_hi:[1,0,0]
v_pk_mul_f32 v[204:205], v[34:35], v[204:205] op_sel:[1,0] op_sel_hi:[1,1]
v_pk_mul_f32 v[206:207], v[34:35], v[206:207] op_sel:[1,0] op_sel_hi:[1,1]
v_cvt_pk_bf16_f32 v168, v168, v169
v_cvt_pk_bf16_f32 v169, v170, v171
ds_write_b64 v15, v[168:169] offset:6528
v_pk_fma_f32 v[172:173], v[36:37], v[56:57], v[172:173] op_sel_hi:[0,1,1] neg_lo:[1,0,0] neg_hi:[1,0,0]
v_pk_fma_f32 v[174:175], v[36:37], v[58:59], v[174:175] op_sel_hi:[0,1,1] neg_lo:[1,0,0] neg_hi:[1,0,0]
v_pk_mul_f32 v[136:137], v[36:37], v[136:137] op_sel:[1,0] op_sel_hi:[1,1]
v_pk_mul_f32 v[138:139], v[36:37], v[138:139] op_sel:[1,0] op_sel_hi:[1,1]
v_cvt_pk_bf16_f32 v204, v204, v205
v_cvt_pk_bf16_f32 v205, v206, v207
ds_write_b64 v15, v[204:205] offset:6656
v_pk_fma_f32 v[208:209], v[36:37], v[60:61], v[208:209] op_sel_hi:[0,1,1] neg_lo:[1,0,0] neg_hi:[1,0,0]
v_pk_fma_f32 v[210:211], v[36:37], v[62:63], v[210:211] op_sel_hi:[0,1,1] neg_lo:[1,0,0] neg_hi:[1,0,0]
v_pk_mul_f32 v[172:173], v[36:37], v[172:173] op_sel:[1,0] op_sel_hi:[1,1]
v_pk_mul_f32 v[174:175], v[36:37], v[174:175] op_sel:[1,0] op_sel_hi:[1,1]
v_cvt_pk_bf16_f32 v136, v136, v137
v_cvt_pk_bf16_f32 v137, v138, v139
ds_write_b64 v15, v[136:137] offset:12800
v_pk_fma_f32 v[140:141], v[38:39], v[52:53], v[140:141] op_sel_hi:[0,1,1] neg_lo:[1,0,0] neg_hi:[1,0,0]
v_pk_fma_f32 v[142:143], v[38:39], v[54:55], v[142:143] op_sel_hi:[0,1,1] neg_lo:[1,0,0] neg_hi:[1,0,0]
v_pk_mul_f32 v[208:209], v[36:37], v[208:209] op_sel:[1,0] op_sel_hi:[1,1]
v_pk_mul_f32 v[210:211], v[36:37], v[210:211] op_sel:[1,0] op_sel_hi:[1,1]
v_cvt_pk_bf16_f32 v172, v172, v173
v_cvt_pk_bf16_f32 v173, v174, v175
ds_write_b64 v15, v[172:173] offset:12928
v_pk_fma_f32 v[176:177], v[38:39], v[56:57], v[176:177] op_sel_hi:[0,1,1] neg_lo:[1,0,0] neg_hi:[1,0,0]
v_pk_fma_f32 v[178:179], v[38:39], v[58:59], v[178:179] op_sel_hi:[0,1,1] neg_lo:[1,0,0] neg_hi:[1,0,0]
v_pk_mul_f32 v[140:141], v[38:39], v[140:141] op_sel:[1,0] op_sel_hi:[1,1]
v_pk_mul_f32 v[142:143], v[38:39], v[142:143] op_sel:[1,0] op_sel_hi:[1,1]
v_cvt_pk_bf16_f32 v208, v208, v209
v_cvt_pk_bf16_f32 v209, v210, v211
ds_write_b64 v15, v[208:209] offset:13056
v_pk_fma_f32 v[212:213], v[38:39], v[60:61], v[212:213] op_sel_hi:[0,1,1] neg_lo:[1,0,0] neg_hi:[1,0,0]
v_pk_fma_f32 v[214:215], v[38:39], v[62:63], v[214:215] op_sel_hi:[0,1,1] neg_lo:[1,0,0] neg_hi:[1,0,0]
v_pk_mul_f32 v[176:177], v[38:39], v[176:177] op_sel:[1,0] op_sel_hi:[1,1]
v_pk_mul_f32 v[178:179], v[38:39], v[178:179] op_sel:[1,0] op_sel_hi:[1,1]
v_cvt_pk_bf16_f32 v140, v140, v141
v_cvt_pk_bf16_f32 v141, v142, v143
ds_write_b64 v15, v[140:141] offset:19200
v_pk_fma_f32 v[144:145], v[40:41], v[52:53], v[144:145] op_sel_hi:[0,1,1] neg_lo:[1,0,0] neg_hi:[1,0,0]
v_pk_fma_f32 v[146:147], v[40:41], v[54:55], v[146:147] op_sel_hi:[0,1,1] neg_lo:[1,0,0] neg_hi:[1,0,0]
v_pk_mul_f32 v[212:213], v[38:39], v[212:213] op_sel:[1,0] op_sel_hi:[1,1]
v_pk_mul_f32 v[214:215], v[38:39], v[214:215] op_sel:[1,0] op_sel_hi:[1,1]
v_cvt_pk_bf16_f32 v176, v176, v177
v_cvt_pk_bf16_f32 v177, v178, v179
ds_write_b64 v15, v[176:177] offset:19328
v_pk_fma_f32 v[180:181], v[40:41], v[56:57], v[180:181] op_sel_hi:[0,1,1] neg_lo:[1,0,0] neg_hi:[1,0,0]
v_pk_fma_f32 v[182:183], v[40:41], v[58:59], v[182:183] op_sel_hi:[0,1,1] neg_lo:[1,0,0] neg_hi:[1,0,0]
v_pk_mul_f32 v[144:145], v[40:41], v[144:145] op_sel:[1,0] op_sel_hi:[1,1]
v_pk_mul_f32 v[146:147], v[40:41], v[146:147] op_sel:[1,0] op_sel_hi:[1,1]
v_cvt_pk_bf16_f32 v212, v212, v213
v_cvt_pk_bf16_f32 v213, v214, v215
ds_write_b64 v15, v[212:213] offset:19456
v_pk_fma_f32 v[216:217], v[40:41], v[60:61], v[216:217] op_sel_hi:[0,1,1] neg_lo:[1,0,0] neg_hi:[1,0,0]
v_pk_fma_f32 v[218:219], v[40:41], v[62:63], v[218:219] op_sel_hi:[0,1,1] neg_lo:[1,0,0] neg_hi:[1,0,0]
v_pk_mul_f32 v[180:181], v[40:41], v[180:181] op_sel:[1,0] op_sel_hi:[1,1]
v_pk_mul_f32 v[182:183], v[40:41], v[182:183] op_sel:[1,0] op_sel_hi:[1,1]
v_cvt_pk_bf16_f32 v144, v144, v145
v_cvt_pk_bf16_f32 v145, v146, v147
ds_write_b64 v15, v[144:145] offset:25600
v_pk_fma_f32 v[148:149], v[42:43], v[52:53], v[148:149] op_sel_hi:[0,1,1] neg_lo:[1,0,0] neg_hi:[1,0,0]
v_pk_fma_f32 v[150:151], v[42:43], v[54:55], v[150:151] op_sel_hi:[0,1,1] neg_lo:[1,0,0] neg_hi:[1,0,0]
v_pk_mul_f32 v[216:217], v[40:41], v[216:217] op_sel:[1,0] op_sel_hi:[1,1]
v_pk_mul_f32 v[218:219], v[40:41], v[218:219] op_sel:[1,0] op_sel_hi:[1,1]
v_cvt_pk_bf16_f32 v180, v180, v181
v_cvt_pk_bf16_f32 v181, v182, v183
ds_write_b64 v15, v[180:181] offset:25728
v_pk_fma_f32 v[184:185], v[42:43], v[56:57], v[184:185] op_sel_hi:[0,1,1] neg_lo:[1,0,0] neg_hi:[1,0,0]
v_pk_fma_f32 v[186:187], v[42:43], v[58:59], v[186:187] op_sel_hi:[0,1,1] neg_lo:[1,0,0] neg_hi:[1,0,0]
v_pk_mul_f32 v[148:149], v[42:43], v[148:149] op_sel:[1,0] op_sel_hi:[1,1]
v_pk_mul_f32 v[150:151], v[42:43], v[150:151] op_sel:[1,0] op_sel_hi:[1,1]
v_cvt_pk_bf16_f32 v216, v216, v217
v_cvt_pk_bf16_f32 v217, v218, v219
ds_write_b64 v15, v[216:217] offset:25856
v_pk_fma_f32 v[220:221], v[42:43], v[60:61], v[220:221] op_sel_hi:[0,1,1] neg_lo:[1,0,0] neg_hi:[1,0,0]
v_pk_fma_f32 v[222:223], v[42:43], v[62:63], v[222:223] op_sel_hi:[0,1,1] neg_lo:[1,0,0] neg_hi:[1,0,0]
v_pk_mul_f32 v[184:185], v[42:43], v[184:185] op_sel:[1,0] op_sel_hi:[1,1]
v_pk_mul_f32 v[186:187], v[42:43], v[186:187] op_sel:[1,0] op_sel_hi:[1,1]
v_cvt_pk_bf16_f32 v148, v148, v149
v_cvt_pk_bf16_f32 v149, v150, v151
ds_write_b64 v15, v[148:149] offset:32000
v_pk_fma_f32 v[152:153], v[44:45], v[52:53], v[152:153] op_sel_hi:[0,1,1] neg_lo:[1,0,0] neg_hi:[1,0,0]
v_pk_fma_f32 v[154:155], v[44:45], v[54:55], v[154:155] op_sel_hi:[0,1,1] neg_lo:[1,0,0] neg_hi:[1,0,0]
v_pk_mul_f32 v[220:221], v[42:43], v[220:221] op_sel:[1,0] op_sel_hi:[1,1]
v_pk_mul_f32 v[222:223], v[42:43], v[222:223] op_sel:[1,0] op_sel_hi:[1,1]
v_cvt_pk_bf16_f32 v184, v184, v185
v_cvt_pk_bf16_f32 v185, v186, v187
ds_write_b64 v15, v[184:185] offset:32128
v_pk_fma_f32 v[188:189], v[44:45], v[56:57], v[188:189] op_sel_hi:[0,1,1] neg_lo:[1,0,0] neg_hi:[1,0,0]
v_pk_fma_f32 v[190:191], v[44:45], v[58:59], v[190:191] op_sel_hi:[0,1,1] neg_lo:[1,0,0] neg_hi:[1,0,0]
v_pk_mul_f32 v[152:153], v[44:45], v[152:153] op_sel:[1,0] op_sel_hi:[1,1]
v_pk_mul_f32 v[154:155], v[44:45], v[154:155] op_sel:[1,0] op_sel_hi:[1,1]
v_cvt_pk_bf16_f32 v220, v220, v221
v_cvt_pk_bf16_f32 v221, v222, v223
ds_write_b64 v15, v[220:221] offset:32256
v_pk_fma_f32 v[224:225], v[44:45], v[60:61], v[224:225] op_sel_hi:[0,1,1] neg_lo:[1,0,0] neg_hi:[1,0,0]
v_pk_fma_f32 v[226:227], v[44:45], v[62:63], v[226:227] op_sel_hi:[0,1,1] neg_lo:[1,0,0] neg_hi:[1,0,0]
v_pk_mul_f32 v[188:189], v[44:45], v[188:189] op_sel:[1,0] op_sel_hi:[1,1]
v_pk_mul_f32 v[190:191], v[44:45], v[190:191] op_sel:[1,0] op_sel_hi:[1,1]
v_cvt_pk_bf16_f32 v152, v152, v153
v_cvt_pk_bf16_f32 v153, v154, v155
ds_write_b64 v15, v[152:153] offset:38400
v_pk_fma_f32 v[156:157], v[46:47], v[52:53], v[156:157] op_sel_hi:[0,1,1] neg_lo:[1,0,0] neg_hi:[1,0,0]
v_pk_fma_f32 v[158:159], v[46:47], v[54:55], v[158:159] op_sel_hi:[0,1,1] neg_lo:[1,0,0] neg_hi:[1,0,0]
v_pk_mul_f32 v[224:225], v[44:45], v[224:225] op_sel:[1,0] op_sel_hi:[1,1]
v_pk_mul_f32 v[226:227], v[44:45], v[226:227] op_sel:[1,0] op_sel_hi:[1,1]
v_cvt_pk_bf16_f32 v188, v188, v189
v_cvt_pk_bf16_f32 v189, v190, v191
ds_write_b64 v15, v[188:189] offset:38528
v_pk_fma_f32 v[192:193], v[46:47], v[56:57], v[192:193] op_sel_hi:[0,1,1] neg_lo:[1,0,0] neg_hi:[1,0,0]
v_pk_fma_f32 v[194:195], v[46:47], v[58:59], v[194:195] op_sel_hi:[0,1,1] neg_lo:[1,0,0] neg_hi:[1,0,0]
v_pk_mul_f32 v[156:157], v[46:47], v[156:157] op_sel:[1,0] op_sel_hi:[1,1]
v_pk_mul_f32 v[158:159], v[46:47], v[158:159] op_sel:[1,0] op_sel_hi:[1,1]
v_cvt_pk_bf16_f32 v224, v224, v225
v_cvt_pk_bf16_f32 v225, v226, v227
ds_write_b64 v15, v[224:225] offset:38656
v_pk_fma_f32 v[228:229], v[46:47], v[60:61], v[228:229] op_sel_hi:[0,1,1] neg_lo:[1,0,0] neg_hi:[1,0,0]
v_pk_fma_f32 v[230:231], v[46:47], v[62:63], v[230:231] op_sel_hi:[0,1,1] neg_lo:[1,0,0] neg_hi:[1,0,0]
v_pk_mul_f32 v[192:193], v[46:47], v[192:193] op_sel:[1,0] op_sel_hi:[1,1]
v_pk_mul_f32 v[194:195], v[46:47], v[194:195] op_sel:[1,0] op_sel_hi:[1,1]
v_cvt_pk_bf16_f32 v156, v156, v157
v_cvt_pk_bf16_f32 v157, v158, v159
ds_write_b64 v15, v[156:157] offset:44800
v_pk_fma_f32 v[160:161], v[48:49], v[52:53], v[160:161] op_sel_hi:[0,1,1] neg_lo:[1,0,0] neg_hi:[1,0,0]
v_pk_fma_f32 v[162:163], v[48:49], v[54:55], v[162:163] op_sel_hi:[0,1,1] neg_lo:[1,0,0] neg_hi:[1,0,0]
v_pk_mul_f32 v[228:229], v[46:47], v[228:229] op_sel:[1,0] op_sel_hi:[1,1]
v_pk_mul_f32 v[230:231], v[46:47], v[230:231] op_sel:[1,0] op_sel_hi:[1,1]
v_cvt_pk_bf16_f32 v192, v192, v193
v_cvt_pk_bf16_f32 v193, v194, v195
ds_write_b64 v15, v[192:193] offset:44928
v_pk_fma_f32 v[196:197], v[48:49], v[56:57], v[196:197] op_sel_hi:[0,1,1] neg_lo:[1,0,0] neg_hi:[1,0,0]
v_pk_fma_f32 v[198:199], v[48:49], v[58:59], v[198:199] op_sel_hi:[0,1,1] neg_lo:[1,0,0] neg_hi:[1,0,0]
v_pk_mul_f32 v[160:161], v[48:49], v[160:161] op_sel:[1,0] op_sel_hi:[1,1]
v_pk_mul_f32 v[162:163], v[48:49], v[162:163] op_sel:[1,0] op_sel_hi:[1,1]
v_cvt_pk_bf16_f32 v228, v228, v229
v_cvt_pk_bf16_f32 v229, v230, v231
ds_write_b64 v15, v[228:229] offset:45056
v_pk_fma_f32 v[232:233], v[48:49], v[60:61], v[232:233] op_sel_hi:[0,1,1] neg_lo:[1,0,0] neg_hi:[1,0,0]
v_pk_fma_f32 v[234:235], v[48:49], v[62:63], v[234:235] op_sel_hi:[0,1,1] neg_lo:[1,0,0] neg_hi:[1,0,0]
v_pk_mul_f32 v[196:197], v[48:49], v[196:197] op_sel:[1,0] op_sel_hi:[1,1]
v_pk_mul_f32 v[198:199], v[48:49], v[198:199] op_sel:[1,0] op_sel_hi:[1,1]
v_cvt_pk_bf16_f32 v160, v160, v161
v_cvt_pk_bf16_f32 v161, v162, v163
ds_write_b64 v15, v[160:161] offset:51200
v_pk_mul_f32 v[232:233], v[48:49], v[232:233] op_sel:[1,0] op_sel_hi:[1,1]
v_pk_mul_f32 v[234:235], v[48:49], v[234:235] op_sel:[1,0] op_sel_hi:[1,1]
v_cvt_pk_bf16_f32 v196, v196, v197
v_cvt_pk_bf16_f32 v197, v198, v199
ds_write_b64 v15, v[196:197] offset:51328
v_cvt_pk_bf16_f32 v232, v232, v233
v_cvt_pk_bf16_f32 v233, v234, v235
ds_write_b64 v15, v[232:233] offset:51456
s_waitcnt lgkmcnt(0)
s_branch Latt_5
Lpf_4:
s_lshl_b32 s43, s35, 7
s_waitcnt lgkmcnt(0)
s_mov_b32 s8, s64
s_mov_b32 s9, s65
s_mov_b32 s10, 4194304
s_mov_b32 s11, 0x20000
s_add_u32 s12, s66, s43
s_addc_u32 s13, s67, 0
s_mov_b32 s14, 6289536
s_mov_b32 s15, 0x20000
s_add_u32 s84, s82, 28311552
s_addc_u32 s85, s83, 0
s_mov_b32 s86, 114688
s_mov_b32 s87, 0x20000
s_mov_b32 s56, s80
s_mov_b32 s57, s81
s_mov_b32 s58, 256
s_mov_b32 s59, 0x20000
v_mov_b32 v5, 0
v_lshlrev_b32 v14, 7, v1
s_or_b32 s43, s34, s35
s_cmp_lg_u32 s43, 0
s_cbranch_scc1 Lz_17
s_movk_i32 s43, 0x2000
buffer_store_dword v5, v14, s[84:87], 0 offen sc1
s_bfm_b64 exec, 44, 0
buffer_store_dword v5, v14, s[84:87], s43 offen sc1
s_mov_b64 exec, 1
v_mov_b32 v6, 1
s_waitcnt vmcnt(0)
buffer_store_dword v6, v5, s[56:59], 0 offen sc1
s_mov_b64 exec, -1
Lz_17:
s_lshl_b32 s43, s51, 11
buffer_load_dwordx4 v[96:99], v10, s[8:11], s43 offen offset:0
buffer_load_dwordx4 v[100:103], v10, s[8:11], s43 offen offset:1024
buffer_load_dwordx4 v[104:107], v10, s[8:11], s43 offen offset:2048
s_branch Lov_3
.p2align 12
.fill 16, 4, 0xbf800000
Lst_3_0:
s_branch Lwr_146
s_nop 0
s_nop 0
Lov_3:
buffer_load_dwordx4 v[108:111], v10, s[8:11], s43 offen offset:3072
v_min_u32 v14, 23, v1
v_lshrrev_b32 v15, 3, v14
v_mul_u32_u24 v15, 43008, v15
v_and_b32 v14, 7, v14
v_lshl_add_u32 v15, v14, 4, v15
v_mov_b32 v32, 0x3f803f80
v_mov_b32 v33, 0x3f803f80
v_mov_b32 v34, 0x3f803f80
v_mov_b32 v35, 0x3f803f80
ds_write_b128 v15, v[32:35]
s_add_u32 s20, s82, 26214400
s_addc_u32 s21, s83, 0
s_mov_b32 s22, 16384
s_mov_b32 s23, 0x20000
s_add_u32 s43, s2, 128
s_lshl_b32 s43, s43, 7
v_lshlrev_b32 v14, 2, v1
s_mov_b64 exec, 15
buffer_store_dword v5, v14, s[84:87], s43 offen sc1
s_mov_b64 exec, -1
s_lshl_b32 s43, s34, 4
s_add_u32 s43, s43, s35
s_lshl_b32 s43, s43, 8
s_add_u32 s43, s43, 49152
v_lshlrev_b32 v14, 7, v1
s_mov_b64 exec, 3
buffer_store_dword v5, v14, s[84:87], s43 offen sc1
s_mov_b64 exec, -1
s_lshl_b32 s52, s34, 7
s_add_u32 s52, s52, 28319744
s_sub_u32 s53, s52, 128
s_cmp_eq_u32 s34, 0
s_cselect_b32 s53, s52, s53
s_waitcnt lgkmcnt(0)
s_barrier
s_waitcnt vmcnt(2)
s_mov_b32 s43, 0x3f803f80
v_mov_b32 v116, 0
v_mov_b32 v117, 0
v_mov_b32 v118, 0
v_mov_b32 v119, 0
v_mov_b32 v120, 0
v_mov_b32 v121, 0
v_mov_b32 v122, 0
v_mov_b32 v123, 0
v_dot2_f32_bf16 v116, v96, s43, v116
v_dot2_f32_bf16 v120, v96, v96, v120
v_dot2_f32_bf16 v118, v104, s43, v118
v_dot2_f32_bf16 v122, v104, v104, v122
v_dot2_f32_bf16 v117, v97, s43, v117
v_dot2_f32_bf16 v121, v97, v97, v121
v_dot2_f32_bf16 v119, v105, s43, v119
v_dot2_f32_bf16 v123, v105, v105, v123
v_dot2_f32_bf16 v116, v98, s43, v116
v_dot2_f32_bf16 v120, v98, v98, v120
v_dot2_f32_bf16 v118, v106, s43, v118
v_dot2_f32_bf16 v122, v106, v106, v122
v_dot2_f32_bf16 v117, v99, s43, v117
v_dot2_f32_bf16 v121, v99, v99, v121
v_dot2_f32_bf16 v119, v107, s43, v119
v_dot2_f32_bf16 v123, v107, v107, v123
v_dot2_f32_bf16 v116, v100, s43, v116
v_dot2_f32_bf16 v120, v100, v100, v120
v_dot2_f32_bf16 v118, v108, s43, v118
v_dot2_f32_bf16 v122, v108, v108, v122
v_dot2_f32_bf16 v117, v101, s43, v117
v_dot2_f32_bf16 v121, v101, v101, v121
v_dot2_f32_bf16 v119, v109, s43, v119
v_dot2_f32_bf16 v123, v109, v109, v123
v_dot2_f32_bf16 v116, v102, s43, v116
v_dot2_f32_bf16 v120, v102, v102, v120
v_dot2_f32_bf16 v118, v110, s43, v118
v_dot2_f32_bf16 v122, v110, v110, v122
v_dot2_f32_bf16 v117, v103, s43, v117
v_dot2_f32_bf16 v121, v103, v103, v121
v_dot2_f32_bf16 v119, v111, s43, v119
v_dot2_f32_bf16 v123, v111, v111, v123
s_nop 2
v_add_f32 v116, v116, v117
v_add_f32 v118, v118, v119
v_add_f32 v120, v120, v121
v_add_f32 v122, v122, v123
s_nop 1
v_permlane32_swap_b32 v116, v118
v_permlane32_swap_b32 v120, v122
v_add_f32 v116, v116, v118
v_add_f32 v120, v120, v122
s_nop 1
v_permlane16_swap_b32 v116, v120
v_add_f32 v116, v116, v120
s_nop 1
v_add_f32_dpp v116, v116, v116 row_ror:8 row_mask:0xf bank_mask:0xf
s_nop 1
v_add_f32_dpp v116, v116, v116 row_ror:4 row_mask:0xf bank_mask:0xf
s_nop 1
v_add_f32_dpp v116, v116, v116 row_ror:2 row_mask:0xf bank_mask:0xf
s_nop 1
v_add_f32_dpp v116, v116, v116 row_ror:1 row_mask:0xf bank_mask:0xf
v_mov_b32 v117, v116
s_nop 1
v_permlane16_swap_b32 v116, v117
v_mul_f32 v112, 0x3a800000, v116
v_mul_f32 v113, 0x3a800000, v117
v_fma_f32 v113, -v112, v112, v113
v_max_f32 v113, 0, v113
v_add_f32 v113, 0x3727c5ac, v113
v_rsq_f32 v113, v113
v_lshrrev_b32 v11, 5, v1
s_lshl_b32 s43, s47, 4
s_add_u32 s43, s43, 148608
v_lshl_add_u32 v11, v11, 3, s43
ds_write_b64 v11, v[112:113]
s_waitcnt lgkmcnt(0)
s_mov_b32 s28, s66
s_mov_b32 s29, s67
s_mov_b32 s30, 6291456
s_mov_b32 s31, 0x20000
s_mul_i32 s43, s33, 7040
s_add_u32 s43, s43, 1179648
v_lshlrev_b32 v30, 7, v1
s_bfm_b64 exec, 55, 0
buffer_load_dword v31, v30, s[28:31], s43 offen
s_mov_b64 exec, -1
s_branch Lst_0_0
Lwr_145:
s_barrier
v_lshlrev_b32 v5, 4, v1
v_and_b32 v5, 63, v5
v_add_u32 v6, 148608, v5
ds_read_b128 v[112:115], v6
s_lshl_b32 s43, s63, 3
v_add_u32 v5, s43, v5
s_waitcnt lgkmcnt(0)
s_mov_b64 exec, 15
buffer_store_dwordx4 v[112:115], v5, s[20:23], 0 offen sc1
s_mov_b64 exec, -1
v_mov_b32 v4, 0
buffer_load_dword v6, v4, s[56:59], 0 offen sc1
s_mov_b32 s62, 0
s_mov_b32 s28, s66
s_mov_b32 s29, s67
s_mov_b32 s30, 6291456
s_mov_b32 s31, 0x20000
s_mul_i32 s43, s33, 15872
s_add_u32 s43, s43, 2752512
v_lshlrev_b32 v30, 7, v1
buffer_load_dword v31, v30, s[28:31], s43 offen
s_add_u32 s43, s43, 8192
s_bfm_b64 exec, 60, 0
buffer_load_dword v31, v30, s[28:31], s43 offen
s_mov_b64 exec, -1
s_lshl_b32 s43, s35, 7
s_add_u32 s28, s68, s43
s_addc_u32 s29, s69, 0
s_mov_b32 s30, 2095232
s_mov_b32 s31, 0x20000
v_and_b32 v29, 7, v1
v_lshrrev_b32 v30, 3, v1
v_lshl_add_u32 v29, v30, 6, v29
s_lshl_b32 s43, s48, 3
v_add_u32 v29, s43, v29
v_lshlrev_b32 v29, 11, v29
s_mov_b32 s43, 1048576
s_mov_b32 s28, s68
s_mov_b32 s29, s69
s_mov_b32 s30, 2097152
s_mov_b32 s31, 0x20000
s_mul_i32 s43, s33, 9472
v_lshlrev_b32 v30, 7, v1
buffer_load_dword v31, v30, s[28:31], s43 offen
s_add_u32 s43, s43, 8192
s_bfm_b64 exec, 10, 0
buffer_load_dword v31, v30, s[28:31], s43 offen
s_mov_b64 exec, -1
s_branch Lst_2_0
Lwr_146:
s_barrier
s_branch Lst_4_0
Lwr_147:
s_barrier
s_branch Lst_6_0
Lwr_148:
s_barrier
s_branch Lst_8_0
Lwr_149:
s_barrier
s_branch Lst_9_0
Lwr_150:
s_barrier
s_cmp_eq_u32 s62, 3
s_cbranch_scc1 Lste_21
s_cmp_eq_u32 s62, 2
s_cbranch_scc1 Lst2_19
s_cmp_ge_u32 s62, 4
s_cbranch_scc1 Lst4_20
s_cmp_eq_u32 s62, 1
s_cbranch_scc1 Lst1_18
s_waitcnt vmcnt(4)
v_readfirstlane_b32 s54, v6
s_cmp_eq_u32 s54, 0
s_cbranch_scc0 Lrep_22
buffer_load_dword v6, v4, s[56:59], 0 offen sc1
s_branch Lste_21
Lrep_22:
s_add_u32 s7, s34, 64
s_lshl_b32 s7, s7, 7
v_mov_b32 v5, s7
v_mov_b32 v6, 1
s_mov_b64 exec, 1
buffer_atomic_add v6, v5, s[84:87], 0 offen sc1
s_mov_b64 exec, -1
s_mov_b32 s62, 1
s_mov_b32 s54, 0
s_mov_b32 s55, 0
s_branch Lste_21
Lst1_18:
s_and_b32 s43, s54, s55
s_cmp_eq_u32 s43, 16
s_cbranch_scc1 Lg_23
s_load_dword s54, s[82:83], s52 glc
s_load_dword s55, s[82:83], s53 glc
s_branch Lste_21
Lg_23:
v_add_u32 v5, 0, v1
v_min_u32 v5, 143, v5
v_lshlrev_b32 v20, 3, v5
v_add_u32 v5, s50, v5
v_max_i32 v5, 0, v5
v_lshlrev_b32 v5, 3, v5
buffer_load_dwordx2 v[32:33], v5, s[20:23], 0 offen sc1
v_add_u32 v5, 64, v1
v_min_u32 v5, 143, v5
v_lshlrev_b32 v21, 3, v5
v_add_u32 v5, s50, v5
v_max_i32 v5, 0, v5
v_lshlrev_b32 v5, 3, v5
buffer_load_dwordx2 v[34:35], v5, s[20:23], 0 offen sc1
v_add_u32 v5, 128, v1
v_min_u32 v5, 143, v5
v_lshlrev_b32 v22, 3, v5
v_add_u32 v5, s50, v5
v_max_i32 v5, 0, v5
v_lshlrev_b32 v5, 3, v5
buffer_load_dwordx2 v[36:37], v5, s[20:23], 0 offen sc1
s_mov_b32 s62, 4
s_branch Lste_21
Lst4_20:
s_mov_b32 s62, 2
s_branch Lste_21
Lst2_19:
s_waitcnt vmcnt(0)
v_add_u32 v20, 147456, v20
ds_write_b64 v20, v[32:33]
v_add_u32 v21, 147456, v21
ds_write_b64 v21, v[34:35]
v_add_u32 v22, 147456, v22
ds_write_b64 v22, v[36:37]
s_waitcnt lgkmcnt(0)
s_mov_b32 s62, 3
Lste_21:
s_branch Lst_10_0
Lwr_151:
s_barrier
s_cmp_eq_u32 s62, 3
s_cbranch_scc1 Lste_27
s_cmp_eq_u32 s62, 2
s_cbranch_scc1 Lst2_25
s_cmp_ge_u32 s62, 4
s_cbranch_scc1 Lst4_26
s_cmp_eq_u32 s62, 1
s_cbranch_scc1 Lst1_24
s_waitcnt vmcnt(0)
v_readfirstlane_b32 s54, v6
s_cmp_eq_u32 s54, 0
s_cbranch_scc0 Lrep_28
buffer_load_dword v6, v4, s[56:59], 0 offen sc1
s_branch Lste_27
Lrep_28:
s_add_u32 s7, s34, 64
s_lshl_b32 s7, s7, 7
v_mov_b32 v5, s7
v_mov_b32 v6, 1
s_mov_b64 exec, 1
buffer_atomic_add v6, v5, s[84:87], 0 offen sc1
s_mov_b64 exec, -1
s_mov_b32 s62, 1
s_mov_b32 s54, 0
s_mov_b32 s55, 0
s_branch Lste_27
Lst1_24:
s_and_b32 s43, s54, s55
s_cmp_eq_u32 s43, 16
s_cbranch_scc1 Lg_29
s_load_dword s54, s[82:83], s52 glc
s_load_dword s55, s[82:83], s53 glc
s_branch Lste_27
Lg_29:
v_add_u32 v5, 0, v1
v_min_u32 v5, 143, v5
v_lshlrev_b32 v20, 3, v5
v_add_u32 v5, s50, v5
v_max_i32 v5, 0, v5
v_lshlrev_b32 v5, 3, v5
buffer_load_dwordx2 v[32:33], v5, s[20:23], 0 offen sc1
v_add_u32 v5, 64, v1
v_min_u32 v5, 143, v5
v_lshlrev_b32 v21, 3, v5
v_add_u32 v5, s50, v5
v_max_i32 v5, 0, v5
v_lshlrev_b32 v5, 3, v5
buffer_load_dwordx2 v[34:35], v5, s[20:23], 0 offen sc1
v_add_u32 v5, 128, v1
v_min_u32 v5, 143, v5
v_lshlrev_b32 v22, 3, v5
v_add_u32 v5, s50, v5
v_max_i32 v5, 0, v5
v_lshlrev_b32 v5, 3, v5
buffer_load_dwordx2 v[36:37], v5, s[20:23], 0 offen sc1
s_mov_b32 s62, 4
s_branch Lste_27
Lst4_26:
s_mov_b32 s62, 2
s_branch Lste_27
Lst2_25:
s_waitcnt vmcnt(0)
v_add_u32 v20, 147456, v20
ds_write_b64 v20, v[32:33]
v_add_u32 v21, 147456, v21
ds_write_b64 v21, v[34:35]
v_add_u32 v22, 147456, v22
ds_write_b64 v22, v[36:37]
s_waitcnt lgkmcnt(0)
s_mov_b32 s62, 3
Lste_27:
s_branch Lst_11_0
Lwr_152:
s_barrier
s_cmp_eq_u32 s62, 3
s_cbranch_scc1 Lste_33
s_cmp_eq_u32 s62, 2
s_cbranch_scc1 Lst2_31
s_cmp_ge_u32 s62, 4
s_cbranch_scc1 Lst4_32
s_cmp_eq_u32 s62, 1
s_cbranch_scc1 Lst1_30
s_waitcnt vmcnt(0)
v_readfirstlane_b32 s54, v6
s_cmp_eq_u32 s54, 0
s_cbranch_scc0 Lrep_34
buffer_load_dword v6, v4, s[56:59], 0 offen sc1
s_branch Lste_33
Lrep_34:
s_add_u32 s7, s34, 64
s_lshl_b32 s7, s7, 7
v_mov_b32 v5, s7
v_mov_b32 v6, 1
s_mov_b64 exec, 1
buffer_atomic_add v6, v5, s[84:87], 0 offen sc1
s_mov_b64 exec, -1
s_mov_b32 s62, 1
s_mov_b32 s54, 0
s_mov_b32 s55, 0
s_branch Lste_33
Lst1_30:
s_and_b32 s43, s54, s55
s_cmp_eq_u32 s43, 16
s_cbranch_scc1 Lg_35
s_load_dword s54, s[82:83], s52 glc
s_load_dword s55, s[82:83], s53 glc
s_branch Lste_33
Lg_35:
v_add_u32 v5, 0, v1
v_min_u32 v5, 143, v5
v_lshlrev_b32 v20, 3, v5
v_add_u32 v5, s50, v5
v_max_i32 v5, 0, v5
v_lshlrev_b32 v5, 3, v5
buffer_load_dwordx2 v[32:33], v5, s[20:23], 0 offen sc1
v_add_u32 v5, 64, v1
v_min_u32 v5, 143, v5
v_lshlrev_b32 v21, 3, v5
v_add_u32 v5, s50, v5
v_max_i32 v5, 0, v5
v_lshlrev_b32 v5, 3, v5
buffer_load_dwordx2 v[34:35], v5, s[20:23], 0 offen sc1
v_add_u32 v5, 128, v1
v_min_u32 v5, 143, v5
v_lshlrev_b32 v22, 3, v5
v_add_u32 v5, s50, v5
v_max_i32 v5, 0, v5
v_lshlrev_b32 v5, 3, v5
buffer_load_dwordx2 v[36:37], v5, s[20:23], 0 offen sc1
s_mov_b32 s62, 4
s_branch Lste_33
Lst4_32:
s_mov_b32 s62, 2
s_branch Lste_33
Lst2_31:
s_waitcnt vmcnt(0)
v_add_u32 v20, 147456, v20
ds_write_b64 v20, v[32:33]
v_add_u32 v21, 147456, v21
ds_write_b64 v21, v[34:35]
v_add_u32 v22, 147456, v22
ds_write_b64 v22, v[36:37]
s_waitcnt lgkmcnt(0)
s_mov_b32 s62, 3
Lste_33:
s_branch Lst_12_0
Lwr_153:
s_barrier
s_cmp_eq_u32 s62, 3
s_cbranch_scc1 Lste_39
s_cmp_eq_u32 s62, 2
s_cbranch_scc1 Lst2_37
s_cmp_ge_u32 s62, 4
s_cbranch_scc1 Lst4_38
s_cmp_eq_u32 s62, 1
s_cbranch_scc1 Lst1_36
s_waitcnt vmcnt(0)
v_readfirstlane_b32 s54, v6
s_cmp_eq_u32 s54, 0
s_cbranch_scc0 Lrep_40
buffer_load_dword v6, v4, s[56:59], 0 offen sc1
s_branch Lste_39
Lrep_40:
s_add_u32 s7, s34, 64
s_lshl_b32 s7, s7, 7
v_mov_b32 v5, s7
v_mov_b32 v6, 1
s_mov_b64 exec, 1
buffer_atomic_add v6, v5, s[84:87], 0 offen sc1
s_mov_b64 exec, -1
s_mov_b32 s62, 1
s_mov_b32 s54, 0
s_mov_b32 s55, 0
s_branch Lste_39
Lst1_36:
s_and_b32 s43, s54, s55
s_cmp_eq_u32 s43, 16
s_cbranch_scc1 Lg_41
s_load_dword s54, s[82:83], s52 glc
s_load_dword s55, s[82:83], s53 glc
s_branch Lste_39
Lg_41:
v_add_u32 v5, 0, v1
v_min_u32 v5, 143, v5
v_lshlrev_b32 v20, 3, v5
v_add_u32 v5, s50, v5
v_max_i32 v5, 0, v5
v_lshlrev_b32 v5, 3, v5
buffer_load_dwordx2 v[32:33], v5, s[20:23], 0 offen sc1
v_add_u32 v5, 64, v1
v_min_u32 v5, 143, v5
v_lshlrev_b32 v21, 3, v5
v_add_u32 v5, s50, v5
v_max_i32 v5, 0, v5
v_lshlrev_b32 v5, 3, v5
buffer_load_dwordx2 v[34:35], v5, s[20:23], 0 offen sc1
v_add_u32 v5, 128, v1
v_min_u32 v5, 143, v5
v_lshlrev_b32 v22, 3, v5
v_add_u32 v5, s50, v5
v_max_i32 v5, 0, v5
v_lshlrev_b32 v5, 3, v5
buffer_load_dwordx2 v[36:37], v5, s[20:23], 0 offen sc1
s_mov_b32 s62, 4
s_branch Lste_39
Lst4_38:
s_mov_b32 s62, 2
s_branch Lste_39
Lst2_37:
s_waitcnt vmcnt(0)
v_add_u32 v20, 147456, v20
ds_write_b64 v20, v[32:33]
v_add_u32 v21, 147456, v21
ds_write_b64 v21, v[34:35]
v_add_u32 v22, 147456, v22
ds_write_b64 v22, v[36:37]
s_waitcnt lgkmcnt(0)
s_mov_b32 s62, 3
Lste_39:
s_branch Lst_13_0
Lwr_154:
s_barrier
s_cmp_eq_u32 s62, 3
s_cbranch_scc1 Lste_45
s_cmp_eq_u32 s62, 2
s_cbranch_scc1 Lst2_43
s_cmp_ge_u32 s62, 4
s_cbranch_scc1 Lst4_44
s_cmp_eq_u32 s62, 1
s_cbranch_scc1 Lst1_42
s_waitcnt vmcnt(0)
v_readfirstlane_b32 s54, v6
s_cmp_eq_u32 s54, 0
s_cbranch_scc0 Lrep_46
buffer_load_dword v6, v4, s[56:59], 0 offen sc1
s_branch Lste_45
Lrep_46:
s_add_u32 s7, s34, 64
s_lshl_b32 s7, s7, 7
v_mov_b32 v5, s7
v_mov_b32 v6, 1
s_mov_b64 exec, 1
buffer_atomic_add v6, v5, s[84:87], 0 offen sc1
s_mov_b64 exec, -1
s_mov_b32 s62, 1
s_mov_b32 s54, 0
s_mov_b32 s55, 0
s_branch Lste_45
Lst1_42:
s_and_b32 s43, s54, s55
s_cmp_eq_u32 s43, 16
s_cbranch_scc1 Lg_47
s_load_dword s54, s[82:83], s52 glc
s_load_dword s55, s[82:83], s53 glc
s_branch Lste_45
Lg_47:
v_add_u32 v5, 0, v1
v_min_u32 v5, 143, v5
v_lshlrev_b32 v20, 3, v5
v_add_u32 v5, s50, v5
v_max_i32 v5, 0, v5
v_lshlrev_b32 v5, 3, v5
buffer_load_dwordx2 v[32:33], v5, s[20:23], 0 offen sc1
v_add_u32 v5, 64, v1
v_min_u32 v5, 143, v5
v_lshlrev_b32 v21, 3, v5
v_add_u32 v5, s50, v5
v_max_i32 v5, 0, v5
v_lshlrev_b32 v5, 3, v5
buffer_load_dwordx2 v[34:35], v5, s[20:23], 0 offen sc1
v_add_u32 v5, 128, v1
v_min_u32 v5, 143, v5
v_lshlrev_b32 v22, 3, v5
v_add_u32 v5, s50, v5
v_max_i32 v5, 0, v5
v_lshlrev_b32 v5, 3, v5
buffer_load_dwordx2 v[36:37], v5, s[20:23], 0 offen sc1
s_mov_b32 s62, 4
s_branch Lste_45
Lst4_44:
s_mov_b32 s62, 2
s_branch Lste_45
Lst2_43:
s_waitcnt vmcnt(0)
v_add_u32 v20, 147456, v20
ds_write_b64 v20, v[32:33]
v_add_u32 v21, 147456, v21
ds_write_b64 v21, v[34:35]
v_add_u32 v22, 147456, v22
ds_write_b64 v22, v[36:37]
s_waitcnt lgkmcnt(0)
s_mov_b32 s62, 3
Lste_45:
s_branch Lst_14_0
Lwr_155:
s_barrier
s_cmp_eq_u32 s62, 3
s_cbranch_scc1 Lste_51
s_cmp_eq_u32 s62, 2
s_cbranch_scc1 Lst2_49
s_cmp_ge_u32 s62, 4
s_cbranch_scc1 Lst4_50
s_cmp_eq_u32 s62, 1
s_cbranch_scc1 Lst1_48
s_waitcnt vmcnt(0)
v_readfirstlane_b32 s54, v6
s_cmp_eq_u32 s54, 0
s_cbranch_scc0 Lrep_52
buffer_load_dword v6, v4, s[56:59], 0 offen sc1
s_branch Lste_51
Lrep_52:
s_add_u32 s7, s34, 64
s_lshl_b32 s7, s7, 7
v_mov_b32 v5, s7
v_mov_b32 v6, 1
s_mov_b64 exec, 1
buffer_atomic_add v6, v5, s[84:87], 0 offen sc1
s_mov_b64 exec, -1
s_mov_b32 s62, 1
s_mov_b32 s54, 0
s_mov_b32 s55, 0
s_branch Lste_51
Lst1_48:
s_and_b32 s43, s54, s55
s_cmp_eq_u32 s43, 16
s_cbranch_scc1 Lg_53
s_load_dword s54, s[82:83], s52 glc
s_load_dword s55, s[82:83], s53 glc
s_branch Lste_51
Lg_53:
v_add_u32 v5, 0, v1
v_min_u32 v5, 143, v5
v_lshlrev_b32 v20, 3, v5
v_add_u32 v5, s50, v5
v_max_i32 v5, 0, v5
v_lshlrev_b32 v5, 3, v5
buffer_load_dwordx2 v[32:33], v5, s[20:23], 0 offen sc1
v_add_u32 v5, 64, v1
v_min_u32 v5, 143, v5
v_lshlrev_b32 v21, 3, v5
v_add_u32 v5, s50, v5
v_max_i32 v5, 0, v5
v_lshlrev_b32 v5, 3, v5
buffer_load_dwordx2 v[34:35], v5, s[20:23], 0 offen sc1
v_add_u32 v5, 128, v1
v_min_u32 v5, 143, v5
v_lshlrev_b32 v22, 3, v5
v_add_u32 v5, s50, v5
v_max_i32 v5, 0, v5
v_lshlrev_b32 v5, 3, v5
buffer_load_dwordx2 v[36:37], v5, s[20:23], 0 offen sc1
s_mov_b32 s62, 4
s_branch Lste_51
Lst4_50:
s_mov_b32 s62, 2
s_branch Lste_51
Lst2_49:
s_waitcnt vmcnt(0)
v_add_u32 v20, 147456, v20
ds_write_b64 v20, v[32:33]
v_add_u32 v21, 147456, v21
ds_write_b64 v21, v[34:35]
v_add_u32 v22, 147456, v22
ds_write_b64 v22, v[36:37]
s_waitcnt lgkmcnt(0)
s_mov_b32 s62, 3
Lste_51:
s_branch Lst_15_0
Lwr_156:
s_barrier
s_cmp_eq_u32 s62, 3
s_cbranch_scc1 Lste_57
s_cmp_eq_u32 s62, 2
s_cbranch_scc1 Lst2_55
s_cmp_ge_u32 s62, 4
s_cbranch_scc1 Lst4_56
s_cmp_eq_u32 s62, 1
s_cbranch_scc1 Lst1_54
s_waitcnt vmcnt(0)
v_readfirstlane_b32 s54, v6
s_cmp_eq_u32 s54, 0
s_cbranch_scc0 Lrep_58
buffer_load_dword v6, v4, s[56:59], 0 offen sc1
s_branch Lste_57
Lrep_58:
s_add_u32 s7, s34, 64
s_lshl_b32 s7, s7, 7
v_mov_b32 v5, s7
v_mov_b32 v6, 1
s_mov_b64 exec, 1
buffer_atomic_add v6, v5, s[84:87], 0 offen sc1
s_mov_b64 exec, -1
s_mov_b32 s62, 1
s_mov_b32 s54, 0
s_mov_b32 s55, 0
s_branch Lste_57
Lst1_54:
s_and_b32 s43, s54, s55
s_cmp_eq_u32 s43, 16
s_cbranch_scc1 Lg_59
s_load_dword s54, s[82:83], s52 glc
s_load_dword s55, s[82:83], s53 glc
s_branch Lste_57
Lg_59:
v_add_u32 v5, 0, v1
v_min_u32 v5, 143, v5
v_lshlrev_b32 v20, 3, v5
v_add_u32 v5, s50, v5
v_max_i32 v5, 0, v5
v_lshlrev_b32 v5, 3, v5
buffer_load_dwordx2 v[32:33], v5, s[20:23], 0 offen sc1
v_add_u32 v5, 64, v1
v_min_u32 v5, 143, v5
v_lshlrev_b32 v21, 3, v5
v_add_u32 v5, s50, v5
v_max_i32 v5, 0, v5
v_lshlrev_b32 v5, 3, v5
buffer_load_dwordx2 v[34:35], v5, s[20:23], 0 offen sc1
v_add_u32 v5, 128, v1
v_min_u32 v5, 143, v5
v_lshlrev_b32 v22, 3, v5
v_add_u32 v5, s50, v5
v_max_i32 v5, 0, v5
v_lshlrev_b32 v5, 3, v5
buffer_load_dwordx2 v[36:37], v5, s[20:23], 0 offen sc1
s_mov_b32 s62, 4
s_branch Lste_57
Lst4_56:
s_mov_b32 s62, 2
s_branch Lste_57
Lst2_55:
s_waitcnt vmcnt(0)
v_add_u32 v20, 147456, v20
ds_write_b64 v20, v[32:33]
v_add_u32 v21, 147456, v21
ds_write_b64 v21, v[34:35]
v_add_u32 v22, 147456, v22
ds_write_b64 v22, v[36:37]
s_waitcnt lgkmcnt(0)
s_mov_b32 s62, 3
Lste_57:
s_branch Lst_16_0
Lwr_157:
s_barrier
s_cmp_eq_u32 s62, 3
s_cbranch_scc1 Lste_63
s_cmp_eq_u32 s62, 2
s_cbranch_scc1 Lst2_61
s_cmp_ge_u32 s62, 4
s_cbranch_scc1 Lst4_62
s_cmp_eq_u32 s62, 1
s_cbranch_scc1 Lst1_60
s_waitcnt vmcnt(0)
v_readfirstlane_b32 s54, v6
s_cmp_eq_u32 s54, 0
s_cbranch_scc0 Lrep_64
buffer_load_dword v6, v4, s[56:59], 0 offen sc1
s_branch Lste_63
Lrep_64:
s_add_u32 s7, s34, 64
s_lshl_b32 s7, s7, 7
v_mov_b32 v5, s7
v_mov_b32 v6, 1
s_mov_b64 exec, 1
buffer_atomic_add v6, v5, s[84:87], 0 offen sc1
s_mov_b64 exec, -1
s_mov_b32 s62, 1
s_mov_b32 s54, 0
s_mov_b32 s55, 0
s_branch Lste_63
Lst1_60:
s_and_b32 s43, s54, s55
s_cmp_eq_u32 s43, 16
s_cbranch_scc1 Lg_65
s_load_dword s54, s[82:83], s52 glc
s_load_dword s55, s[82:83], s53 glc
s_branch Lste_63
Lg_65:
v_add_u32 v5, 0, v1
v_min_u32 v5, 143, v5
v_lshlrev_b32 v20, 3, v5
v_add_u32 v5, s50, v5
v_max_i32 v5, 0, v5
v_lshlrev_b32 v5, 3, v5
buffer_load_dwordx2 v[32:33], v5, s[20:23], 0 offen sc1
v_add_u32 v5, 64, v1
v_min_u32 v5, 143, v5
v_lshlrev_b32 v21, 3, v5
v_add_u32 v5, s50, v5
v_max_i32 v5, 0, v5
v_lshlrev_b32 v5, 3, v5
buffer_load_dwordx2 v[34:35], v5, s[20:23], 0 offen sc1
v_add_u32 v5, 128, v1
v_min_u32 v5, 143, v5
v_lshlrev_b32 v22, 3, v5
v_add_u32 v5, s50, v5
v_max_i32 v5, 0, v5
v_lshlrev_b32 v5, 3, v5
buffer_load_dwordx2 v[36:37], v5, s[20:23], 0 offen sc1
s_mov_b32 s62, 4
s_branch Lste_63
Lst4_62:
s_mov_b32 s62, 2
s_branch Lste_63
Lst2_61:
s_waitcnt vmcnt(0)
v_add_u32 v20, 147456, v20
ds_write_b64 v20, v[32:33]
v_add_u32 v21, 147456, v21
ds_write_b64 v21, v[34:35]
v_add_u32 v22, 147456, v22
ds_write_b64 v22, v[36:37]
s_waitcnt lgkmcnt(0)
s_mov_b32 s62, 3
Lste_63:
s_branch Lst_17_0
Lwr_158:
s_barrier
s_cmp_eq_u32 s62, 3
s_cbranch_scc1 Lste_69
s_cmp_eq_u32 s62, 2
s_cbranch_scc1 Lst2_67
s_cmp_ge_u32 s62, 4
s_cbranch_scc1 Lst4_68
s_cmp_eq_u32 s62, 1
s_cbranch_scc1 Lst1_66
s_waitcnt vmcnt(0)
v_readfirstlane_b32 s54, v6
s_cmp_eq_u32 s54, 0
s_cbranch_scc0 Lrep_70
buffer_load_dword v6, v4, s[56:59], 0 offen sc1
s_branch Lste_69
Lrep_70:
s_add_u32 s7, s34, 64
s_lshl_b32 s7, s7, 7
v_mov_b32 v5, s7
v_mov_b32 v6, 1
s_mov_b64 exec, 1
buffer_atomic_add v6, v5, s[84:87], 0 offen sc1
s_mov_b64 exec, -1
s_mov_b32 s62, 1
s_mov_b32 s54, 0
s_mov_b32 s55, 0
s_branch Lste_69
Lst1_66:
s_and_b32 s43, s54, s55
s_cmp_eq_u32 s43, 16
s_cbranch_scc1 Lg_71
s_load_dword s54, s[82:83], s52 glc
s_load_dword s55, s[82:83], s53 glc
s_branch Lste_69
Lg_71:
v_add_u32 v5, 0, v1
v_min_u32 v5, 143, v5
v_lshlrev_b32 v20, 3, v5
v_add_u32 v5, s50, v5
v_max_i32 v5, 0, v5
v_lshlrev_b32 v5, 3, v5
buffer_load_dwordx2 v[32:33], v5, s[20:23], 0 offen sc1
v_add_u32 v5, 64, v1
v_min_u32 v5, 143, v5
v_lshlrev_b32 v21, 3, v5
v_add_u32 v5, s50, v5
v_max_i32 v5, 0, v5
v_lshlrev_b32 v5, 3, v5
buffer_load_dwordx2 v[34:35], v5, s[20:23], 0 offen sc1
v_add_u32 v5, 128, v1
v_min_u32 v5, 143, v5
v_lshlrev_b32 v22, 3, v5
v_add_u32 v5, s50, v5
v_max_i32 v5, 0, v5
v_lshlrev_b32 v5, 3, v5
s_branch Lov_4
.p2align 12
.fill 32, 4, 0xbf800000
Lst_4_0:
s_branch Lst_5_0
s_nop 0
s_nop 0
Lov_4:
buffer_load_dwordx2 v[36:37], v5, s[20:23], 0 offen sc1
s_mov_b32 s62, 4
s_branch Lste_69
Lst4_68:
s_mov_b32 s62, 2
s_branch Lste_69
Lst2_67:
s_waitcnt vmcnt(0)
v_add_u32 v20, 147456, v20
ds_write_b64 v20, v[32:33]
v_add_u32 v21, 147456, v21
ds_write_b64 v21, v[34:35]
v_add_u32 v22, 147456, v22
ds_write_b64 v22, v[36:37]
s_waitcnt lgkmcnt(0)
s_mov_b32 s62, 3
Lste_69:
s_branch Lst_18_0
Lwr_159:
s_barrier
s_cmp_eq_u32 s62, 3
s_cbranch_scc1 Lste_74
s_cmp_ge_u32 s62, 5
s_cbranch_scc1 Lg_79
s_cmp_ge_u32 s62, 2
s_cbranch_scc1 Lst2_73
s_cmp_eq_u32 s62, 1
s_cbranch_scc1 Lst1_72
s_mov_b32 s41, 0x40000
Lz0_75:
s_waitcnt vmcnt(0)
v_readfirstlane_b32 s54, v6
s_cmp_eq_u32 s54, 0
s_cbranch_scc0 Lzok_76
buffer_load_dword v6, v4, s[56:59], 0 offen sc1
s_sub_u32 s41, s41, 1
s_cmp_lg_u32 s41, 0
s_cbranch_scc1 Lz0_75
s_waitcnt lgkmcnt(0)
Lzok_76:
s_add_u32 s7, s34, 64
s_lshl_b32 s7, s7, 7
v_mov_b32 v5, s7
v_mov_b32 v6, 1
s_mov_b64 exec, 1
buffer_atomic_add v6, v5, s[84:87], 0 offen sc1
s_mov_b64 exec, -1
Lst1_72:
s_load_dword s54, s[82:83], s52 glc
s_load_dword s55, s[82:83], s53 glc
s_mov_b32 s41, 0x40000
Lpoll_77:
s_waitcnt lgkmcnt(0)
s_and_b32 s54, s54, s55
s_cmp_eq_u32 s54, 16
s_cbranch_scc1 Lg_79
s_load_dword s54, s[82:83], s52 glc
s_load_dword s55, s[82:83], s53 glc
s_sub_u32 s41, s41, 1
s_cmp_lg_u32 s41, 0
s_cbranch_scc1 Lpoll_77
s_waitcnt lgkmcnt(0)
Lg_79:
v_add_u32 v5, 0, v1
v_min_u32 v5, 143, v5
v_lshlrev_b32 v20, 3, v5
v_add_u32 v5, s50, v5
v_max_i32 v5, 0, v5
v_lshlrev_b32 v5, 3, v5
buffer_load_dwordx2 v[32:33], v5, s[20:23], 0 offen sc1
v_add_u32 v5, 64, v1
v_min_u32 v5, 143, v5
v_lshlrev_b32 v21, 3, v5
v_add_u32 v5, s50, v5
v_max_i32 v5, 0, v5
v_lshlrev_b32 v5, 3, v5
buffer_load_dwordx2 v[34:35], v5, s[20:23], 0 offen sc1
v_add_u32 v5, 128, v1
v_min_u32 v5, 143, v5
v_lshlrev_b32 v22, 3, v5
v_add_u32 v5, s50, v5
v_max_i32 v5, 0, v5
v_lshlrev_b32 v5, 3, v5
buffer_load_dwordx2 v[36:37], v5, s[20:23], 0 offen sc1
Lst2_73:
s_waitcnt vmcnt(0)
v_add_u32 v20, 147456, v20
ds_write_b64 v20, v[32:33]
v_add_u32 v21, 147456, v21
ds_write_b64 v21, v[34:35]
v_add_u32 v22, 147456, v22
ds_write_b64 v22, v[36:37]
s_waitcnt lgkmcnt(0)
Lste_74:
s_bitcmp0_b32 s2, 0
s_cselect_b32 s88, s72, s74
s_cselect_b32 s89, s73, s75
s_cmp_lt_u32 s2, 192
s_cselect_b32 s90, 7340032, 0
s_mov_b32 s91, 0x20000
s_bfe_u32 s44, s2, 0x30001
s_lshl_b32 s44, s44, 2
s_and_b32 s43, s36, 3
s_add_u32 s44, s44, s43
s_lshl_b32 s44, s44, 5
v_lshrrev_b32 v18, 4, v1
v_add_u32 v18, s44, v18
v_mul_u32_u24 v18, 7168, v18
v_and_b32 v19, 15, v1
v_lshl_add_u32 v18, v19, 4, v18
s_lshr_b32 s43, s2, 4
s_lshl_b32 s43, s43, 8
s_add_u32 s43, s43, 4096
v_add_u32 v18, s43, v18
s_mov_b32 s43, 0
buffer_load_dwordx4 v[128:131], v18, s[88:91], s43 offen
s_mov_b32 s43, 28672
buffer_load_dwordx4 v[132:135], v18, s[88:91], s43 offen
s_mov_b32 s43, 57344
buffer_load_dwordx4 v[136:139], v18, s[88:91], s43 offen
s_mov_b32 s43, 86016
buffer_load_dwordx4 v[140:143], v18, s[88:91], s43 offen
s_mov_b32 s43, 114688
buffer_load_dwordx4 v[144:147], v18, s[88:91], s43 offen
s_mov_b32 s43, 143360
buffer_load_dwordx4 v[148:151], v18, s[88:91], s43 offen
s_mov_b32 s43, 172032
buffer_load_dwordx4 v[152:155], v18, s[88:91], s43 offen
s_mov_b32 s43, 200704
buffer_load_dwordx4 v[156:159], v18, s[88:91], s43 offen
s_barrier
s_lshl_b32 s43, s35, 7
s_add_u32 s28, s68, s43
s_addc_u32 s29, s69, 0
s_mov_b32 s30, 2095232
s_mov_b32 s31, 0x20000
v_lshrrev_b32 v15, 3, v1
v_and_b32 v16, 6, v15
v_and_b32 v7, 7, v1
v_xor_b32 v7, v7, v16
v_lshlrev_b32 v7, 4, v7
v_mul_u32_u24 v15, 2048, v15
v_add_u32 v7, v7, v15
s_and_b32 s40, s36, 3
s_lshl_b32 s39, s40, 13
s_add_u32 s40, s40, s35
s_add_u32 s42, s40, 0
s_and_b32 s42, s42, 15
s_lshl_b32 s42, s42, 17
s_add_u32 m0, s39, 65536
s_add_u32 s43, s42, 0
buffer_load_dwordx4 v7, s[28:31], s43 offen lds
s_add_u32 m0, s39, 66560
s_add_u32 s43, s42, 16384
buffer_load_dwordx4 v7, s[28:31], s43 offen lds
s_add_u32 m0, s39, 67584
s_add_u32 s43, s42, 32768
buffer_load_dwordx4 v7, s[28:31], s43 offen lds
s_add_u32 m0, s39, 68608
s_add_u32 s43, s42, 49152
buffer_load_dwordx4 v7, s[28:31], s43 offen lds
s_add_u32 m0, s39, 69632
s_add_u32 s43, s42, 65536
buffer_load_dwordx4 v7, s[28:31], s43 offen lds
s_add_u32 m0, s39, 70656
s_add_u32 s43, s42, 81920
buffer_load_dwordx4 v7, s[28:31], s43 offen lds
s_add_u32 m0, s39, 71680
s_add_u32 s43, s42, 98304
buffer_load_dwordx4 v7, s[28:31], s43 offen lds
s_add_u32 m0, s39, 72704
s_add_u32 s43, s42, 114688
buffer_load_dwordx4 v7, s[28:31], s43 offen lds
Lats_6:
s_and_b32 s43, s36, 1
s_bfe_u32 s44, s36, 0x10001
s_lshr_b32 s45, s36, 2
v_lshlrev_b32 v14, 2, v13
v_sub_u32 v14, v12, v14
v_mov_b32 v16, 0xff800000
s_or_b32 s46, s34, s45
s_cmp_lg_u32 s46, 0
s_cselect_b32 s46, 0, 0xff800000
v_subrev_u32 v15, 0, v14
v_cmp_ge_u32 vcc, 7, v15
v_add_u32 v15, 16, v15
s_nop 0
v_cndmask_b32 v248, v16, 0, vcc
v_cmp_ge_u32 vcc, 7, v15
s_nop 1
v_cndmask_b32 v244, v16, 0, vcc
v_or_b32 v240, s46, v244
v_subrev_u32 v15, 1, v14
v_cmp_ge_u32 vcc, 7, v15
v_add_u32 v15, 16, v15
s_nop 0
v_cndmask_b32 v249, v16, 0, vcc
v_cmp_ge_u32 vcc, 7, v15
s_nop 1
v_cndmask_b32 v245, v16, 0, vcc
v_or_b32 v241, s46, v245
v_subrev_u32 v15, 2, v14
v_cmp_ge_u32 vcc, 7, v15
v_add_u32 v15, 16, v15
s_nop 0
v_cndmask_b32 v250, v16, 0, vcc
v_cmp_ge_u32 vcc, 7, v15
s_nop 1
v_cndmask_b32 v246, v16, 0, vcc
v_or_b32 v242, s46, v246
v_subrev_u32 v15, 3, v14
v_cmp_ge_u32 vcc, 7, v15
v_add_u32 v15, 16, v15
s_nop 0
v_cndmask_b32 v251, v16, 0, vcc
v_cmp_ge_u32 vcc, 7, v15
s_nop 1
v_cndmask_b32 v247, v16, 0, vcc
v_or_b32 v243, s46, v247
s_lshl_b32 s46, s45, 6
s_add_u32 s46, s46, s44
s_add_u32 s46, s46, 16
v_lshl_add_u32 v14, v12, 1, s46
s_lshl_b32 s47, s43, 6
v_lshl_add_u32 v15, v13, 4, s47
v_mul_u32_u24 v20, 400, v14
v_add_u32 v20, v20, v15
v_subrev_u32 v16, 32, v14
v_max_i32 v16, 0, v16
v_mul_u32_u24 v21, 400, v16
v_add_u32 v21, v21, v15
v_lshrrev_b32 v16, 2, v12
v_lshl_add_u32 v16, v13, 2, v16
v_lshl_add_u32 v16, v16, 1, s46
v_and_b32 v17, 3, v1
v_lshl_add_u32 v17, v17, 3, s47
v_mul_u32_u24 v22, 400, v16
v_add_u32 v22, v22, v17
v_subrev_u32 v16, 32, v16
v_max_i32 v16, 0, v16
v_mul_u32_u24 v23, 400, v16
v_add_u32 v23, v23, v17
s_mul_i32 s60, s34, 262144
s_add_u32 s16, s82, s60
s_addc_u32 s17, s83, 0
s_mov_b32 s18, 262144
s_mov_b32 s19, 0x20000
s_lshl_b32 s60, s35, 14
s_lshl_b32 s43, s43, 13
s_add_u32 s60, s60, s43
s_lshl_b32 s43, s45, 12
s_add_u32 s60, s60, s43
s_lshl_b32 s43, s44, 10
s_add_u32 s60, s60, s43
v_lshlrev_b32 v24, 4, v1
s_mov_b32 s61, 0x3e8293ee
s_lshl_b32 s38, s35, 7
Latt_5:
s_barrier
ds_read_b128 v[32:35], v20 offset:0
ds_read_b128 v[36:39], v20 offset:128
ds_read_b128 v[40:43], v21 offset:128
ds_read_b128 v[80:83], v20 offset:12800
ds_read_b128 v[84:87], v20 offset:12928
ds_read_b128 v[88:91], v20 offset:128
ds_read_b64_tr_b16 v[44:45], v23 offset:256
ds_read_b64_tr_b16 v[46:47], v22 offset:256
ds_read_b64_tr_b16 v[48:49], v23 offset:288
ds_read_b64_tr_b16 v[50:51], v22 offset:288
ds_read_b64_tr_b16 v[92:93], v22 offset:256
ds_read_b64_tr_b16 v[94:95], v22 offset:13056
ds_read_b64_tr_b16 v[96:97], v22 offset:288
ds_read_b64_tr_b16 v[98:99], v22 offset:13088
s_waitcnt lgkmcnt(11)
v_mfma_f32_16x16x32_bf16 v[52:55], v[40:43], v[32:35], v[240:243]
v_mfma_f32_16x16x32_bf16 v[56:59], v[36:39], v[32:35], v[248:251]
s_waitcnt lgkmcnt(8)
v_mfma_f32_16x16x32_bf16 v[100:103], v[88:91], v[80:83], v[244:247]
v_mfma_f32_16x16x32_bf16 v[104:107], v[84:87], v[80:83], v[248:251]
s_nop 5
v_max3_f32 v60, v52, v53, v54
v_max3_f32 v108, v100, v101, v102
v_max3_f32 v61, v55, v56, v57
v_max3_f32 v109, v103, v104, v105
v_max3_f32 v60, v60, v58, v59
v_max3_f32 v108, v108, v106, v107
v_max_f32 v60, v60, v61
v_max_f32 v108, v108, v109
s_nop 1
v_permlane32_swap_b32 v60, v108
v_max_f32 v60, v60, v108
v_mov_b32 v61, v60
s_nop 1
v_permlane16_swap_b32 v60, v61
v_max_f32 v60, v60, v61
v_mul_f32 v60, s61, v60
s_nop 0
v_mov_b32 v108, v60
s_nop 1
v_permlane32_swap_b32 v60, v108
v_fma_f32 v52, v52, s61, -v60
v_fma_f32 v100, v100, s61, -v108
v_fma_f32 v53, v53, s61, -v60
v_fma_f32 v101, v101, s61, -v108
v_fma_f32 v54, v54, s61, -v60
v_fma_f32 v102, v102, s61, -v108
v_fma_f32 v55, v55, s61, -v60
v_fma_f32 v103, v103, s61, -v108
v_fma_f32 v56, v56, s61, -v60
v_fma_f32 v104, v104, s61, -v108
v_fma_f32 v57, v57, s61, -v60
v_fma_f32 v105, v105, s61, -v108
v_fma_f32 v58, v58, s61, -v60
v_fma_f32 v106, v106, s61, -v108
v_fma_f32 v59, v59, s61, -v60
v_fma_f32 v107, v107, s61, -v108
v_exp_f32 v52, v52
v_exp_f32 v100, v100
v_exp_f32 v53, v53
v_exp_f32 v101, v101
v_exp_f32 v54, v54
v_exp_f32 v102, v102
v_exp_f32 v55, v55
v_exp_f32 v103, v103
v_exp_f32 v56, v56
v_exp_f32 v104, v104
v_exp_f32 v57, v57
v_exp_f32 v105, v105
v_exp_f32 v58, v58
v_exp_f32 v106, v106
v_exp_f32 v59, v59
v_exp_f32 v107, v107
v_cvt_pk_bf16_f32 v64, v52, v53
v_cvt_pk_bf16_f32 v112, v100, v101
v_cvt_pk_bf16_f32 v65, v54, v55
v_cvt_pk_bf16_f32 v113, v102, v103
v_cvt_pk_bf16_f32 v66, v56, v57
v_cvt_pk_bf16_f32 v114, v104, v105
v_cvt_pk_bf16_f32 v67, v58, v59
v_cvt_pk_bf16_f32 v115, v106, v107
v_pk_add_f32 v[52:53], v[52:53], v[54:55]
v_pk_add_f32 v[100:101], v[100:101], v[102:103]
v_pk_add_f32 v[56:57], v[56:57], v[58:59]
v_pk_add_f32 v[104:105], v[104:105], v[106:107]
s_waitcnt lgkmcnt(0)
s_waitcnt lgkmcnt(0)
v_mfma_f32_16x16x32_bf16 v[68:71], v[44:47], v[64:67], 0
v_mfma_f32_16x16x32_bf16 v[116:119], v[92:95], v[112:115], 0
v_mfma_f32_16x16x32_bf16 v[72:75], v[48:51], v[64:67], 0
v_mfma_f32_16x16x32_bf16 v[120:123], v[96:99], v[112:115], 0
v_pk_add_f32 v[52:53], v[52:53], v[56:57]
v_pk_add_f32 v[100:101], v[100:101], v[104:105]
v_add_f32 v60, v52, v53
v_add_f32 v108, v100, v101
s_nop 1
v_permlane32_swap_b32 v60, v108
v_add_f32 v60, v60, v108
v_mov_b32 v61, v60
s_nop 1
v_permlane16_swap_b32 v60, v61
v_add_f32 v60, v60, v61
v_rcp_f32 v60, v60
s_nop 0
v_mov_b32 v108, v60
s_nop 1
v_permlane32_swap_b32 v60, v108
v_pk_mul_f32 v[68:69], v[60:61], v[68:69] op_sel_hi:[0,1]
v_pk_mul_f32 v[116:117], v[108:109], v[116:117] op_sel_hi:[0,1]
v_pk_mul_f32 v[70:71], v[60:61], v[70:71] op_sel_hi:[0,1]
v_pk_mul_f32 v[118:119], v[108:109], v[118:119] op_sel_hi:[0,1]
v_pk_mul_f32 v[72:73], v[60:61], v[72:73] op_sel_hi:[0,1]
v_pk_mul_f32 v[120:121], v[108:109], v[120:121] op_sel_hi:[0,1]
v_pk_mul_f32 v[74:75], v[60:61], v[74:75] op_sel_hi:[0,1]
v_pk_mul_f32 v[122:123], v[108:109], v[122:123] op_sel_hi:[0,1]
v_cvt_pk_bf16_f32 v64, v68, v69
v_cvt_pk_bf16_f32 v112, v116, v117
v_cvt_pk_bf16_f32 v65, v70, v71
v_cvt_pk_bf16_f32 v113, v118, v119
v_cvt_pk_bf16_f32 v66, v72, v73
v_cvt_pk_bf16_f32 v114, v120, v121
v_cvt_pk_bf16_f32 v67, v74, v75
v_cvt_pk_bf16_f32 v115, v122, v123
buffer_store_dwordx4 v[64:67], v24, s[16:19], s60 offen offset:0 sc1
buffer_store_dwordx4 v[112:115], v24, s[16:19], s60 offen offset:2048 sc1
s_add_u32 s56, s82, 28311552
s_addc_u32 s57, s83, 0
s_mov_b32 s58, 114688
s_mov_b32 s59, 0x20000
s_lshl_b32 s7, s34, 12
s_add_u32 s7, s7, 49152
v_lshl_add_u32 v26, v1, 8, s7
v_mov_b32 v27, 1
s_cmp_ge_u32 s36, 4
s_cbranch_scc1 Lh_81
s_waitcnt vmcnt(0)
s_branch Lo_80
Lh_81:
s_waitcnt vmcnt(0)
Lo_80:
s_cmp_lg_u32 s36, 0
s_barrier
s_cbranch_scc1 Lsig_82
s_mov_b64 exec, 0xffff
buffer_atomic_add v27, v26, s[56:59], 0 offen sc1
s_mov_b64 exec, -1
Lsig_82:
s_cmp_ge_u32 s36, 4
s_cbranch_scc1 Lprod_84
v_and_b32 v12, 15, v1
v_lshrrev_b32 v13, 4, v1
v_lshlrev_b32 v10, 12, v12
v_and_b32 v14, 1, v13
v_lshl_add_u32 v10, v14, 5, v10
v_lshrrev_b32 v14, 1, v13
v_lshl_add_u32 v10, v14, 4, v10
s_lshl_b32 s43, s34, 18
s_lshl_b32 s44, s36, 16
s_add_u32 s43, s43, s44
s_lshl_b32 s44, s35, 7
s_add_u32 s43, s43, s44
buffer_load_dwordx4 v[128:131], v10, s[8:11], s43 offen offset:0
buffer_load_dwordx4 v[132:135], v10, s[8:11], s43 offen offset:64
buffer_load_dwordx4 v[136:139], v10, s[8:11], s43 offen offset:2048
buffer_load_dwordx4 v[140:143], v10, s[8:11], s43 offen offset:2112
v_and_b32 v12, 15, v1
v_lshrrev_b32 v13, 4, v1
s_mul_i32 s43, s34, 262144
s_add_u32 s20, s82, s43
s_addc_u32 s21, s83, 0
s_add_u32 s20, s20, 4194304
s_addc_u32 s21, s21, 0
s_mov_b32 s22, 262144
s_mov_b32 s23, 0x20000
s_mul_i32 s43, s34, 16384
s_add_u32 s24, s82, s43
s_addc_u32 s25, s83, 0
s_add_u32 s24, s24, 25165824
s_addc_u32 s25, s25, 0
s_mov_b32 s26, 16384
s_mov_b32 s27, 0x20000
v_lshlrev_b32 v11, 4, v1
s_lshl_b32 s43, s36, 11
v_add_u32 v2, s43, v11
v_add_u32 v3, 98304, v2
v_lshrrev_b32 v14, 2, v1
v_bfe_u32 v15, v14, 1, 2
v_mul_u32_u24 v14, 128, v14
v_lshl_add_u32 v14, v15, 5, v14
v_and_b32 v15, 3, v1
v_lshl_add_u32 v4, v15, 3, v14
v_xor_b32 v5, 32, v4
v_xor_b32 v6, 64, v4
v_xor_b32 v7, 96, v4
v_add_u32 v16, 0x10000, v4
v_add_u32 v20, 0x20000, v4
v_add_u32 v17, 0x10000, v5
v_add_u32 v21, 0x20000, v5
v_add_u32 v18, 0x10000, v6
v_add_u32 v22, 0x20000, v6
v_add_u32 v19, 0x10000, v7
v_add_u32 v23, 0x20000, v7
s_lshl_b32 s44, s35, 14
s_add_u32 s60, s44, s43
v_lshrrev_b32 v14, 1, v13
v_lshlrev_b32 v14, 11, v14
v_lshl_add_u32 v14, v12, 3, v14
v_and_b32 v15, 1, v13
v_lshl_add_u32 v14, v15, 2, v14
s_lshl_b32 s43, s36, 12
s_lshl_b32 s44, s35, 7
s_add_u32 s43, s43, s44
v_add_u32 v9, s43, v14
s_mov_b32 s61, 0x3f803f80
s_waitcnt vmcnt(0)
v_permlane16_swap_b32 v128, v130
v_permlane16_swap_b32 v129, v131
v_permlane16_swap_b32 v132, v134
v_permlane16_swap_b32 v133, v135
v_permlane16_swap_b32 v136, v138
v_permlane16_swap_b32 v137, v139
v_permlane16_swap_b32 v140, v142
v_permlane16_swap_b32 v141, v143
v_lshlrev_b32 v96, 16, v128
v_and_b32 v97, 0xffff0000, v128
v_lshlrev_b32 v98, 16, v129
v_and_b32 v99, 0xffff0000, v129
v_lshlrev_b32 v100, 16, v130
v_and_b32 v101, 0xffff0000, v130
v_lshlrev_b32 v102, 16, v131
v_and_b32 v103, 0xffff0000, v131
v_lshlrev_b32 v104, 16, v132
v_and_b32 v105, 0xffff0000, v132
v_lshlrev_b32 v106, 16, v133
v_and_b32 v107, 0xffff0000, v133
v_lshlrev_b32 v108, 16, v134
v_and_b32 v109, 0xffff0000, v134
v_lshlrev_b32 v110, 16, v135
v_and_b32 v111, 0xffff0000, v135
v_lshlrev_b32 v112, 16, v136
v_and_b32 v113, 0xffff0000, v136
v_lshlrev_b32 v114, 16, v137
v_and_b32 v115, 0xffff0000, v137
v_lshlrev_b32 v116, 16, v138
v_and_b32 v117, 0xffff0000, v138
v_lshlrev_b32 v118, 16, v139
v_and_b32 v119, 0xffff0000, v139
v_lshlrev_b32 v120, 16, v140
v_and_b32 v121, 0xffff0000, v140
v_lshlrev_b32 v122, 16, v141
v_and_b32 v123, 0xffff0000, v141
v_lshlrev_b32 v124, 16, v142
v_and_b32 v125, 0xffff0000, v142
v_lshlrev_b32 v126, 16, v143
v_and_b32 v127, 0xffff0000, v143
s_cmp_lg_u32 s36, 0
s_cbranch_scc1 Lwm_87
s_nop 0
s_branch Lwe_86
Lwm_87:
s_cmp_lg_u32 s36, 1
s_cbranch_scc1 Lwm_88
s_nop 0
s_branch Lwe_86
Lwm_88:
s_cmp_lg_u32 s36, 2
s_cbranch_scc1 Lwm_89
s_nop 0
s_branch Lwe_86
Lwm_89:
s_cmp_lg_u32 s36, 3
s_cbranch_scc1 Lwm_90
s_nop 0
s_branch Lwe_86
Lwm_90:
Lwe_86:
s_barrier
ds_read_b128 v[32:35], v2 offset:0
ds_read_b64_tr_b16 v[40:41], v16 offset:0
ds_read_b64_tr_b16 v[42:43], v16 offset:2048
ds_read_b64_tr_b16 v[44:45], v17 offset:0
ds_read_b64_tr_b16 v[46:47], v17 offset:2048
ds_read_b64_tr_b16 v[48:49], v18 offset:0
ds_read_b64_tr_b16 v[50:51], v18 offset:2048
ds_read_b64_tr_b16 v[52:53], v19 offset:0
ds_read_b64_tr_b16 v[54:55], v19 offset:2048
ds_read_b128 v[36:39], v2 offset:1024
ds_read_b128 v[56:59], v2 offset:8192
ds_read_b64_tr_b16 v[64:65], v16 offset:4096
ds_read_b64_tr_b16 v[66:67], v16 offset:6144
ds_read_b64_tr_b16 v[68:69], v17 offset:4096
ds_read_b64_tr_b16 v[70:71], v17 offset:6144
ds_read_b64_tr_b16 v[72:73], v18 offset:4096
ds_read_b64_tr_b16 v[74:75], v18 offset:6144
ds_read_b64_tr_b16 v[76:77], v19 offset:4096
ds_read_b64_tr_b16 v[78:79], v19 offset:6144
ds_read_b128 v[60:63], v2 offset:9216
s_waitcnt lgkmcnt(0)
s_barrier
v_mfma_f32_16x16x32_bf16 v[96:99], v[40:43], v[32:35], v[96:99]
ds_read_b128 v[144:147], v2 offset:49152
ds_read_b64_tr_b16 v[152:153], v16 offset:8192
v_mfma_f32_16x16x32_bf16 v[100:103], v[44:47], v[32:35], v[100:103]
ds_read_b64_tr_b16 v[154:155], v16 offset:10240
ds_read_b64_tr_b16 v[156:157], v17 offset:8192
v_mfma_f32_16x16x32_bf16 v[104:107], v[48:51], v[32:35], v[104:107]
ds_read_b64_tr_b16 v[158:159], v17 offset:10240
ds_read_b64_tr_b16 v[160:161], v18 offset:8192
v_mfma_f32_16x16x32_bf16 v[108:111], v[52:55], v[32:35], v[108:111]
ds_read_b64_tr_b16 v[162:163], v18 offset:10240
ds_read_b64_tr_b16 v[164:165], v19 offset:8192
v_mfma_f32_16x16x32_bf16 v[124:127], v[52:55], v[36:39], v[124:127]
ds_read_b64_tr_b16 v[166:167], v19 offset:10240
ds_read_b128 v[148:151], v2 offset:50176
v_mfma_f32_16x16x32_bf16 v[120:123], v[48:51], v[36:39], v[120:123]
ds_read_b128 v[168:171], v2 offset:57344
ds_read_b64_tr_b16 v[176:177], v16 offset:12288
v_mfma_f32_16x16x32_bf16 v[116:119], v[44:47], v[36:39], v[116:119]
ds_read_b64_tr_b16 v[178:179], v16 offset:14336
ds_read_b64_tr_b16 v[180:181], v17 offset:12288
v_mfma_f32_16x16x32_bf16 v[112:115], v[40:43], v[36:39], v[112:115]
ds_read_b64_tr_b16 v[182:183], v17 offset:14336
ds_read_b64_tr_b16 v[184:185], v18 offset:12288
v_mfma_f32_16x16x32_bf16 v[96:99], v[64:67], v[56:59], v[96:99]
ds_read_b64_tr_b16 v[186:187], v18 offset:14336
ds_read_b64_tr_b16 v[188:189], v19 offset:12288
v_mfma_f32_16x16x32_bf16 v[100:103], v[68:71], v[56:59], v[100:103]
ds_read_b64_tr_b16 v[190:191], v19 offset:14336
ds_read_b128 v[172:175], v2 offset:58368
v_mfma_f32_16x16x32_bf16 v[104:107], v[72:75], v[56:59], v[104:107]
s_bitcmp0_b32 s36, 1
v_mfma_f32_16x16x32_bf16 v[108:111], v[76:79], v[56:59], v[108:111]
s_cselect_b32 s44, s72, s74
v_mfma_f32_16x16x32_bf16 v[124:127], v[76:79], v[60:63], v[124:127]
s_cselect_b32 s45, s73, s75
v_mfma_f32_16x16x32_bf16 v[120:123], v[72:75], v[60:63], v[120:123]
s_mul_i32 s43, s35, 192
v_mfma_f32_16x16x32_bf16 v[116:119], v[68:71], v[60:63], v[116:119]
s_add_u32 s16, s44, s43
v_mfma_f32_16x16x32_bf16 v[112:115], v[64:67], v[60:63], v[112:115]
s_addc_u32 s17, s45, 0
s_waitcnt lgkmcnt(0)
s_barrier
v_mfma_f32_16x16x32_bf16 v[96:99], v[152:155], v[144:147], v[96:99]
ds_read_b128 v[32:35], v3 offset:0
ds_read_b64_tr_b16 v[40:41], v16 offset:16384
v_mfma_f32_16x16x32_bf16 v[100:103], v[156:159], v[144:147], v[100:103]
ds_read_b64_tr_b16 v[42:43], v16 offset:18432
ds_read_b64_tr_b16 v[44:45], v17 offset:16384
v_mfma_f32_16x16x32_bf16 v[104:107], v[160:163], v[144:147], v[104:107]
ds_read_b64_tr_b16 v[46:47], v17 offset:18432
ds_read_b64_tr_b16 v[48:49], v18 offset:16384
v_mfma_f32_16x16x32_bf16 v[108:111], v[164:167], v[144:147], v[108:111]
ds_read_b64_tr_b16 v[50:51], v18 offset:18432
ds_read_b64_tr_b16 v[52:53], v19 offset:16384
v_mfma_f32_16x16x32_bf16 v[124:127], v[164:167], v[148:151], v[124:127]
ds_read_b64_tr_b16 v[54:55], v19 offset:18432
ds_read_b128 v[36:39], v3 offset:1024
v_mfma_f32_16x16x32_bf16 v[120:123], v[160:163], v[148:151], v[120:123]
ds_read_b128 v[56:59], v3 offset:8192
ds_read_b64_tr_b16 v[64:65], v16 offset:20480
v_mfma_f32_16x16x32_bf16 v[116:119], v[156:159], v[148:151], v[116:119]
ds_read_b64_tr_b16 v[66:67], v16 offset:22528
ds_read_b64_tr_b16 v[68:69], v17 offset:20480
v_mfma_f32_16x16x32_bf16 v[112:115], v[152:155], v[148:151], v[112:115]
ds_read_b64_tr_b16 v[70:71], v17 offset:22528
ds_read_b64_tr_b16 v[72:73], v18 offset:20480
v_mfma_f32_16x16x32_bf16 v[96:99], v[176:179], v[168:171], v[96:99]
ds_read_b64_tr_b16 v[74:75], v18 offset:22528
ds_read_b64_tr_b16 v[76:77], v19 offset:20480
v_mfma_f32_16x16x32_bf16 v[100:103], v[180:183], v[168:171], v[100:103]
ds_read_b64_tr_b16 v[78:79], v19 offset:22528
ds_read_b128 v[60:63], v3 offset:9216
v_mfma_f32_16x16x32_bf16 v[104:107], v[184:187], v[168:171], v[104:107]
s_add_u32 s16, s16, 4096
v_mfma_f32_16x16x32_bf16 v[108:111], v[188:191], v[168:171], v[108:111]
s_addc_u32 s17, s17, 0
v_mfma_f32_16x16x32_bf16 v[124:127], v[188:191], v[172:175], v[124:127]
s_mov_b32 s18, 7333056
v_mfma_f32_16x16x32_bf16 v[120:123], v[184:187], v[172:175], v[120:123]
s_mov_b32 s19, 0x20000
v_mfma_f32_16x16x32_bf16 v[116:119], v[180:183], v[172:175], v[116:119]
s_and_b32 s43, s36, 1
v_mfma_f32_16x16x32_bf16 v[112:115], v[176:179], v[172:175], v[112:115]
s_mul_i32 s43, s43, 229376
s_waitcnt lgkmcnt(0)
s_barrier
v_mfma_f32_16x16x32_bf16 v[96:99], v[40:43], v[32:35], v[96:99]
ds_read_b128 v[144:147], v3 offset:49152
ds_read_b64_tr_b16 v[152:153], v16 offset:24576
v_mfma_f32_16x16x32_bf16 v[100:103], v[44:47], v[32:35], v[100:103]
ds_read_b64_tr_b16 v[154:155], v16 offset:26624
ds_read_b64_tr_b16 v[156:157], v17 offset:24576
v_mfma_f32_16x16x32_bf16 v[104:107], v[48:51], v[32:35], v[104:107]
ds_read_b64_tr_b16 v[158:159], v17 offset:26624
ds_read_b64_tr_b16 v[160:161], v18 offset:24576
v_mfma_f32_16x16x32_bf16 v[108:111], v[52:55], v[32:35], v[108:111]
ds_read_b64_tr_b16 v[162:163], v18 offset:26624
ds_read_b64_tr_b16 v[164:165], v19 offset:24576
v_mfma_f32_16x16x32_bf16 v[124:127], v[52:55], v[36:39], v[124:127]
ds_read_b64_tr_b16 v[166:167], v19 offset:26624
ds_read_b128 v[148:151], v3 offset:50176
v_mfma_f32_16x16x32_bf16 v[120:123], v[48:51], v[36:39], v[120:123]
ds_read_b128 v[168:171], v3 offset:57344
ds_read_b64_tr_b16 v[176:177], v16 offset:28672
s_branch Lov_5
.p2align 12
.fill 32, 4, 0xbf800000
Lst_5_0:
s_branch Lwr_147
s_nop 0
s_nop 0
Lov_5:
v_mfma_f32_16x16x32_bf16 v[116:119], v[44:47], v[36:39], v[116:119]
ds_read_b64_tr_b16 v[178:179], v16 offset:30720
ds_read_b64_tr_b16 v[180:181], v17 offset:28672
v_mfma_f32_16x16x32_bf16 v[112:115], v[40:43], v[36:39], v[112:115]
ds_read_b64_tr_b16 v[182:183], v17 offset:30720
ds_read_b64_tr_b16 v[184:185], v18 offset:28672
v_mfma_f32_16x16x32_bf16 v[96:99], v[64:67], v[56:59], v[96:99]
ds_read_b64_tr_b16 v[186:187], v18 offset:30720
ds_read_b64_tr_b16 v[188:189], v19 offset:28672
v_mfma_f32_16x16x32_bf16 v[100:103], v[68:71], v[56:59], v[100:103]
ds_read_b64_tr_b16 v[190:191], v19 offset:30720
ds_read_b128 v[172:175], v3 offset:58368
v_mfma_f32_16x16x32_bf16 v[104:107], v[72:75], v[56:59], v[104:107]
v_add_u32 v196, 0, v1
v_mfma_f32_16x16x32_bf16 v[108:111], v[76:79], v[56:59], v[108:111]
v_mul_u32_u24 v197, 5462, v196
v_mfma_f32_16x16x32_bf16 v[124:127], v[76:79], v[60:63], v[124:127]
v_lshrrev_b32 v197, 16, v197
v_mfma_f32_16x16x32_bf16 v[120:123], v[72:75], v[60:63], v[120:123]
v_mul_u32_u24 v198, 12, v197
v_mfma_f32_16x16x32_bf16 v[116:119], v[68:71], v[60:63], v[116:119]
v_sub_u32 v198, v196, v198
v_mfma_f32_16x16x32_bf16 v[112:115], v[64:67], v[60:63], v[112:115]
v_bfe_u32 v199, v197, 2, 1
s_waitcnt lgkmcnt(0)
s_barrier
v_mfma_f32_16x16x32_bf16 v[96:99], v[152:155], v[144:147], v[96:99]
ds_read_b128 v[32:35], v2 offset:0
ds_read_b64_tr_b16 v[40:41], v16 offset:49152
v_mfma_f32_16x16x32_bf16 v[100:103], v[156:159], v[144:147], v[100:103]
ds_read_b64_tr_b16 v[42:43], v16 offset:51200
ds_read_b64_tr_b16 v[44:45], v17 offset:49152
v_mfma_f32_16x16x32_bf16 v[104:107], v[160:163], v[144:147], v[104:107]
ds_read_b64_tr_b16 v[46:47], v17 offset:51200
ds_read_b64_tr_b16 v[48:49], v18 offset:49152
v_mfma_f32_16x16x32_bf16 v[108:111], v[164:167], v[144:147], v[108:111]
ds_read_b64_tr_b16 v[50:51], v18 offset:51200
ds_read_b64_tr_b16 v[52:53], v19 offset:49152
v_mfma_f32_16x16x32_bf16 v[124:127], v[164:167], v[148:151], v[124:127]
ds_read_b64_tr_b16 v[54:55], v19 offset:51200
ds_read_b128 v[36:39], v2 offset:1024
v_mfma_f32_16x16x32_bf16 v[120:123], v[160:163], v[148:151], v[120:123]
ds_read_b128 v[56:59], v2 offset:8192
ds_read_b64_tr_b16 v[64:65], v16 offset:53248
v_mfma_f32_16x16x32_bf16 v[116:119], v[156:159], v[148:151], v[116:119]
ds_read_b64_tr_b16 v[66:67], v16 offset:55296
ds_read_b64_tr_b16 v[68:69], v17 offset:53248
v_mfma_f32_16x16x32_bf16 v[112:115], v[152:155], v[148:151], v[112:115]
ds_read_b64_tr_b16 v[70:71], v17 offset:55296
ds_read_b64_tr_b16 v[72:73], v18 offset:53248
v_mfma_f32_16x16x32_bf16 v[96:99], v[176:179], v[168:171], v[96:99]
ds_read_b64_tr_b16 v[74:75], v18 offset:55296
ds_read_b64_tr_b16 v[76:77], v19 offset:53248
v_mfma_f32_16x16x32_bf16 v[100:103], v[180:183], v[168:171], v[100:103]
ds_read_b64_tr_b16 v[78:79], v19 offset:55296
ds_read_b128 v[60:63], v2 offset:9216
v_mfma_f32_16x16x32_bf16 v[104:107], v[184:187], v[168:171], v[104:107]
v_cmp_gt_u32 vcc, 8, v198
v_mfma_f32_16x16x32_bf16 v[108:111], v[188:191], v[168:171], v[108:111]
v_lshlrev_b32 v200, 1, v199
v_mfma_f32_16x16x32_bf16 v[124:127], v[188:191], v[172:175], v[124:127]
v_mul_u32_u24 v197, 7168, v197
v_mfma_f32_16x16x32_bf16 v[120:123], v[184:187], v[172:175], v[120:123]
v_cndmask_b32 v199, v199, v200, vcc
v_mfma_f32_16x16x32_bf16 v[116:119], v[180:183], v[172:175], v[116:119]
v_xor_b32 v198, v198, v199
v_mfma_f32_16x16x32_bf16 v[112:115], v[176:179], v[172:175], v[112:115]
v_lshl_add_u32 v192, v198, 4, v197
s_waitcnt lgkmcnt(0)
s_barrier
v_mfma_f32_16x16x32_bf16 v[96:99], v[40:43], v[32:35], v[96:99]
ds_read_b128 v[144:147], v2 offset:49152
ds_read_b64_tr_b16 v[152:153], v16 offset:57344
v_mfma_f32_16x16x32_bf16 v[100:103], v[44:47], v[32:35], v[100:103]
ds_read_b64_tr_b16 v[154:155], v16 offset:59392
ds_read_b64_tr_b16 v[156:157], v17 offset:57344
v_mfma_f32_16x16x32_bf16 v[104:107], v[48:51], v[32:35], v[104:107]
ds_read_b64_tr_b16 v[158:159], v17 offset:59392
ds_read_b64_tr_b16 v[160:161], v18 offset:57344
v_mfma_f32_16x16x32_bf16 v[108:111], v[52:55], v[32:35], v[108:111]
ds_read_b64_tr_b16 v[162:163], v18 offset:59392
ds_read_b64_tr_b16 v[164:165], v19 offset:57344
v_mfma_f32_16x16x32_bf16 v[124:127], v[52:55], v[36:39], v[124:127]
ds_read_b64_tr_b16 v[166:167], v19 offset:59392
ds_read_b128 v[148:151], v2 offset:50176
v_mfma_f32_16x16x32_bf16 v[120:123], v[48:51], v[36:39], v[120:123]
ds_read_b128 v[168:171], v2 offset:57344
ds_read_b64_tr_b16 v[176:177], v16 offset:61440
v_mfma_f32_16x16x32_bf16 v[116:119], v[44:47], v[36:39], v[116:119]
ds_read_b64_tr_b16 v[178:179], v16 offset:63488
ds_read_b64_tr_b16 v[180:181], v17 offset:61440
v_mfma_f32_16x16x32_bf16 v[112:115], v[40:43], v[36:39], v[112:115]
ds_read_b64_tr_b16 v[182:183], v17 offset:63488
ds_read_b64_tr_b16 v[184:185], v18 offset:61440
v_mfma_f32_16x16x32_bf16 v[96:99], v[64:67], v[56:59], v[96:99]
ds_read_b64_tr_b16 v[186:187], v18 offset:63488
ds_read_b64_tr_b16 v[188:189], v19 offset:61440
v_mfma_f32_16x16x32_bf16 v[100:103], v[68:71], v[56:59], v[100:103]
ds_read_b64_tr_b16 v[190:191], v19 offset:63488
ds_read_b128 v[172:175], v2 offset:58368
v_mfma_f32_16x16x32_bf16 v[104:107], v[72:75], v[56:59], v[104:107]
v_add_u32 v196, 64, v1
v_mfma_f32_16x16x32_bf16 v[108:111], v[76:79], v[56:59], v[108:111]
v_mul_u32_u24 v197, 5462, v196
v_mfma_f32_16x16x32_bf16 v[124:127], v[76:79], v[60:63], v[124:127]
v_lshrrev_b32 v197, 16, v197
v_mfma_f32_16x16x32_bf16 v[120:123], v[72:75], v[60:63], v[120:123]
v_mul_u32_u24 v198, 12, v197
v_mfma_f32_16x16x32_bf16 v[116:119], v[68:71], v[60:63], v[116:119]
v_sub_u32 v198, v196, v198
v_mfma_f32_16x16x32_bf16 v[112:115], v[64:67], v[60:63], v[112:115]
v_bfe_u32 v199, v197, 2, 1
s_waitcnt lgkmcnt(0)
s_barrier
v_mfma_f32_16x16x32_bf16 v[96:99], v[152:155], v[144:147], v[96:99]
ds_read_b128 v[32:35], v3 offset:0
ds_read_b64_tr_b16 v[40:41], v20 offset:0
v_mfma_f32_16x16x32_bf16 v[100:103], v[156:159], v[144:147], v[100:103]
ds_read_b64_tr_b16 v[42:43], v20 offset:2048
ds_read_b64_tr_b16 v[44:45], v21 offset:0
v_mfma_f32_16x16x32_bf16 v[104:107], v[160:163], v[144:147], v[104:107]
ds_read_b64_tr_b16 v[46:47], v21 offset:2048
ds_read_b64_tr_b16 v[48:49], v22 offset:0
v_mfma_f32_16x16x32_bf16 v[108:111], v[164:167], v[144:147], v[108:111]
ds_read_b64_tr_b16 v[50:51], v22 offset:2048
ds_read_b64_tr_b16 v[52:53], v23 offset:0
v_mfma_f32_16x16x32_bf16 v[124:127], v[164:167], v[148:151], v[124:127]
ds_read_b64_tr_b16 v[54:55], v23 offset:2048
ds_read_b128 v[36:39], v3 offset:1024
v_mfma_f32_16x16x32_bf16 v[120:123], v[160:163], v[148:151], v[120:123]
ds_read_b128 v[56:59], v3 offset:8192
ds_read_b64_tr_b16 v[64:65], v20 offset:4096
v_mfma_f32_16x16x32_bf16 v[116:119], v[156:159], v[148:151], v[116:119]
ds_read_b64_tr_b16 v[66:67], v20 offset:6144
ds_read_b64_tr_b16 v[68:69], v21 offset:4096
v_mfma_f32_16x16x32_bf16 v[112:115], v[152:155], v[148:151], v[112:115]
ds_read_b64_tr_b16 v[70:71], v21 offset:6144
ds_read_b64_tr_b16 v[72:73], v22 offset:4096
v_mfma_f32_16x16x32_bf16 v[96:99], v[176:179], v[168:171], v[96:99]
ds_read_b64_tr_b16 v[74:75], v22 offset:6144
ds_read_b64_tr_b16 v[76:77], v23 offset:4096
v_mfma_f32_16x16x32_bf16 v[100:103], v[180:183], v[168:171], v[100:103]
ds_read_b64_tr_b16 v[78:79], v23 offset:6144
ds_read_b128 v[60:63], v3 offset:9216
v_mfma_f32_16x16x32_bf16 v[104:107], v[184:187], v[168:171], v[104:107]
v_cmp_gt_u32 vcc, 8, v198
v_mfma_f32_16x16x32_bf16 v[108:111], v[188:191], v[168:171], v[108:111]
v_lshlrev_b32 v200, 1, v199
v_mfma_f32_16x16x32_bf16 v[124:127], v[188:191], v[172:175], v[124:127]
v_mul_u32_u24 v197, 7168, v197
v_mfma_f32_16x16x32_bf16 v[120:123], v[184:187], v[172:175], v[120:123]
v_cndmask_b32 v199, v199, v200, vcc
v_mfma_f32_16x16x32_bf16 v[116:119], v[180:183], v[172:175], v[116:119]
v_xor_b32 v198, v198, v199
v_mfma_f32_16x16x32_bf16 v[112:115], v[176:179], v[172:175], v[112:115]
v_lshl_add_u32 v193, v198, 4, v197
s_waitcnt lgkmcnt(0)
s_barrier
v_mfma_f32_16x16x32_bf16 v[96:99], v[40:43], v[32:35], v[96:99]
ds_read_b128 v[144:147], v3 offset:49152
ds_read_b64_tr_b16 v[152:153], v20 offset:8192
v_mfma_f32_16x16x32_bf16 v[100:103], v[44:47], v[32:35], v[100:103]
ds_read_b64_tr_b16 v[154:155], v20 offset:10240
ds_read_b64_tr_b16 v[156:157], v21 offset:8192
v_mfma_f32_16x16x32_bf16 v[104:107], v[48:51], v[32:35], v[104:107]
ds_read_b64_tr_b16 v[158:159], v21 offset:10240
ds_read_b64_tr_b16 v[160:161], v22 offset:8192
v_mfma_f32_16x16x32_bf16 v[108:111], v[52:55], v[32:35], v[108:111]
ds_read_b64_tr_b16 v[162:163], v22 offset:10240
ds_read_b64_tr_b16 v[164:165], v23 offset:8192
v_mfma_f32_16x16x32_bf16 v[124:127], v[52:55], v[36:39], v[124:127]
ds_read_b64_tr_b16 v[166:167], v23 offset:10240
ds_read_b128 v[148:151], v3 offset:50176
v_mfma_f32_16x16x32_bf16 v[120:123], v[48:51], v[36:39], v[120:123]
ds_read_b128 v[168:171], v3 offset:57344
ds_read_b64_tr_b16 v[176:177], v20 offset:12288
v_mfma_f32_16x16x32_bf16 v[116:119], v[44:47], v[36:39], v[116:119]
ds_read_b64_tr_b16 v[178:179], v20 offset:14336
ds_read_b64_tr_b16 v[180:181], v21 offset:12288
v_mfma_f32_16x16x32_bf16 v[112:115], v[40:43], v[36:39], v[112:115]
ds_read_b64_tr_b16 v[182:183], v21 offset:14336
ds_read_b64_tr_b16 v[184:185], v22 offset:12288
v_mfma_f32_16x16x32_bf16 v[96:99], v[64:67], v[56:59], v[96:99]
ds_read_b64_tr_b16 v[186:187], v22 offset:14336
ds_read_b64_tr_b16 v[188:189], v23 offset:12288
v_mfma_f32_16x16x32_bf16 v[100:103], v[68:71], v[56:59], v[100:103]
ds_read_b64_tr_b16 v[190:191], v23 offset:14336
ds_read_b128 v[172:175], v3 offset:58368
v_mfma_f32_16x16x32_bf16 v[104:107], v[72:75], v[56:59], v[104:107]
v_add_u32 v196, 128, v1
v_mfma_f32_16x16x32_bf16 v[108:111], v[76:79], v[56:59], v[108:111]
v_mul_u32_u24 v197, 5462, v196
v_mfma_f32_16x16x32_bf16 v[124:127], v[76:79], v[60:63], v[124:127]
v_lshrrev_b32 v197, 16, v197
v_mfma_f32_16x16x32_bf16 v[120:123], v[72:75], v[60:63], v[120:123]
v_mul_u32_u24 v198, 12, v197
v_mfma_f32_16x16x32_bf16 v[116:119], v[68:71], v[60:63], v[116:119]
v_sub_u32 v198, v196, v198
v_mfma_f32_16x16x32_bf16 v[112:115], v[64:67], v[60:63], v[112:115]
v_bfe_u32 v199, v197, 2, 1
s_waitcnt lgkmcnt(0)
s_barrier
v_mfma_f32_16x16x32_bf16 v[96:99], v[152:155], v[144:147], v[96:99]
ds_read_b128 v[32:35], v2 offset:0
ds_read_b64_tr_b16 v[40:41], v4 offset:16384
v_mfma_f32_16x16x32_bf16 v[100:103], v[156:159], v[144:147], v[100:103]
ds_read_b64_tr_b16 v[42:43], v4 offset:18432
ds_read_b64_tr_b16 v[44:45], v5 offset:16384
v_mfma_f32_16x16x32_bf16 v[104:107], v[160:163], v[144:147], v[104:107]
ds_read_b64_tr_b16 v[46:47], v5 offset:18432
ds_read_b64_tr_b16 v[48:49], v6 offset:16384
v_mfma_f32_16x16x32_bf16 v[108:111], v[164:167], v[144:147], v[108:111]
ds_read_b64_tr_b16 v[50:51], v6 offset:18432
ds_read_b64_tr_b16 v[52:53], v7 offset:16384
v_mfma_f32_16x16x32_bf16 v[124:127], v[164:167], v[148:151], v[124:127]
ds_read_b64_tr_b16 v[54:55], v7 offset:18432
ds_read_b128 v[36:39], v2 offset:1024
v_mfma_f32_16x16x32_bf16 v[120:123], v[160:163], v[148:151], v[120:123]
ds_read_b128 v[56:59], v2 offset:8192
ds_read_b64_tr_b16 v[64:65], v4 offset:20480
v_mfma_f32_16x16x32_bf16 v[116:119], v[156:159], v[148:151], v[116:119]
ds_read_b64_tr_b16 v[66:67], v4 offset:22528
ds_read_b64_tr_b16 v[68:69], v5 offset:20480
v_mfma_f32_16x16x32_bf16 v[112:115], v[152:155], v[148:151], v[112:115]
ds_read_b64_tr_b16 v[70:71], v5 offset:22528
ds_read_b64_tr_b16 v[72:73], v6 offset:20480
v_mfma_f32_16x16x32_bf16 v[96:99], v[176:179], v[168:171], v[96:99]
ds_read_b64_tr_b16 v[74:75], v6 offset:22528
ds_read_b64_tr_b16 v[76:77], v7 offset:20480
v_mfma_f32_16x16x32_bf16 v[100:103], v[180:183], v[168:171], v[100:103]
ds_read_b64_tr_b16 v[78:79], v7 offset:22528
ds_read_b128 v[60:63], v2 offset:9216
v_mfma_f32_16x16x32_bf16 v[104:107], v[184:187], v[168:171], v[104:107]
v_cmp_gt_u32 vcc, 8, v198
v_mfma_f32_16x16x32_bf16 v[108:111], v[188:191], v[168:171], v[108:111]
v_lshlrev_b32 v200, 1, v199
v_mfma_f32_16x16x32_bf16 v[124:127], v[188:191], v[172:175], v[124:127]
v_mul_u32_u24 v197, 7168, v197
v_mfma_f32_16x16x32_bf16 v[120:123], v[184:187], v[172:175], v[120:123]
v_cndmask_b32 v199, v199, v200, vcc
v_mfma_f32_16x16x32_bf16 v[116:119], v[180:183], v[172:175], v[116:119]
v_xor_b32 v198, v198, v199
v_mfma_f32_16x16x32_bf16 v[112:115], v[176:179], v[172:175], v[112:115]
v_lshl_add_u32 v194, v198, 4, v197
s_waitcnt lgkmcnt(0)
s_barrier
v_mfma_f32_16x16x32_bf16 v[96:99], v[40:43], v[32:35], v[96:99]
ds_read_b128 v[144:147], v2 offset:49152
ds_read_b64_tr_b16 v[152:153], v4 offset:24576
v_mfma_f32_16x16x32_bf16 v[100:103], v[44:47], v[32:35], v[100:103]
ds_read_b64_tr_b16 v[154:155], v4 offset:26624
ds_read_b64_tr_b16 v[156:157], v5 offset:24576
v_mfma_f32_16x16x32_bf16 v[104:107], v[48:51], v[32:35], v[104:107]
ds_read_b64_tr_b16 v[158:159], v5 offset:26624
ds_read_b64_tr_b16 v[160:161], v6 offset:24576
v_mfma_f32_16x16x32_bf16 v[108:111], v[52:55], v[32:35], v[108:111]
ds_read_b64_tr_b16 v[162:163], v6 offset:26624
ds_read_b64_tr_b16 v[164:165], v7 offset:24576
v_mfma_f32_16x16x32_bf16 v[124:127], v[52:55], v[36:39], v[124:127]
ds_read_b64_tr_b16 v[166:167], v7 offset:26624
ds_read_b128 v[148:151], v2 offset:50176
v_mfma_f32_16x16x32_bf16 v[120:123], v[48:51], v[36:39], v[120:123]
ds_read_b128 v[168:171], v2 offset:57344
ds_read_b64_tr_b16 v[176:177], v4 offset:28672
v_mfma_f32_16x16x32_bf16 v[116:119], v[44:47], v[36:39], v[116:119]
ds_read_b64_tr_b16 v[178:179], v4 offset:30720
ds_read_b64_tr_b16 v[180:181], v5 offset:28672
v_mfma_f32_16x16x32_bf16 v[112:115], v[40:43], v[36:39], v[112:115]
ds_read_b64_tr_b16 v[182:183], v5 offset:30720
ds_read_b64_tr_b16 v[184:185], v6 offset:28672
v_mfma_f32_16x16x32_bf16 v[96:99], v[64:67], v[56:59], v[96:99]
ds_read_b64_tr_b16 v[186:187], v6 offset:30720
ds_read_b64_tr_b16 v[188:189], v7 offset:28672
v_mfma_f32_16x16x32_bf16 v[100:103], v[68:71], v[56:59], v[100:103]
ds_read_b64_tr_b16 v[190:191], v7 offset:30720
ds_read_b128 v[172:175], v2 offset:58368
v_mfma_f32_16x16x32_bf16 v[104:107], v[72:75], v[56:59], v[104:107]
v_add_u32 v192, s43, v192
v_mfma_f32_16x16x32_bf16 v[108:111], v[76:79], v[56:59], v[108:111]
v_add_u32 v193, s43, v193
v_mfma_f32_16x16x32_bf16 v[124:127], v[76:79], v[60:63], v[124:127]
v_add_u32 v194, s43, v194
v_mfma_f32_16x16x32_bf16 v[120:123], v[72:75], v[60:63], v[120:123]
s_and_b32 s43, s36, 3
v_mfma_f32_16x16x32_bf16 v[116:119], v[68:71], v[60:63], v[116:119]
s_mul_i32 s50, s43, 6144
v_mfma_f32_16x16x32_bf16 v[112:115], v[64:67], v[60:63], v[112:115]
s_add_u32 s50, s50, 16384
s_waitcnt lgkmcnt(0)
s_barrier
v_mfma_f32_16x16x32_bf16 v[96:99], v[152:155], v[144:147], v[96:99]
ds_read_b128 v[32:35], v3 offset:0
ds_read_b64_tr_b16 v[40:41], v4 offset:32768
v_mfma_f32_16x16x32_bf16 v[100:103], v[156:159], v[144:147], v[100:103]
ds_read_b64_tr_b16 v[42:43], v4 offset:34816
ds_read_b64_tr_b16 v[44:45], v5 offset:32768
v_mfma_f32_16x16x32_bf16 v[104:107], v[160:163], v[144:147], v[104:107]
ds_read_b64_tr_b16 v[46:47], v5 offset:34816
ds_read_b64_tr_b16 v[48:49], v6 offset:32768
v_mfma_f32_16x16x32_bf16 v[108:111], v[164:167], v[144:147], v[108:111]
ds_read_b64_tr_b16 v[50:51], v6 offset:34816
ds_read_b64_tr_b16 v[52:53], v7 offset:32768
v_mfma_f32_16x16x32_bf16 v[124:127], v[164:167], v[148:151], v[124:127]
ds_read_b64_tr_b16 v[54:55], v7 offset:34816
ds_read_b128 v[36:39], v3 offset:1024
v_mfma_f32_16x16x32_bf16 v[120:123], v[160:163], v[148:151], v[120:123]
ds_read_b128 v[56:59], v3 offset:8192
ds_read_b64_tr_b16 v[64:65], v4 offset:36864
v_mfma_f32_16x16x32_bf16 v[116:119], v[156:159], v[148:151], v[116:119]
ds_read_b64_tr_b16 v[66:67], v4 offset:38912
ds_read_b64_tr_b16 v[68:69], v5 offset:36864
v_mfma_f32_16x16x32_bf16 v[112:115], v[152:155], v[148:151], v[112:115]
ds_read_b64_tr_b16 v[70:71], v5 offset:38912
ds_read_b64_tr_b16 v[72:73], v6 offset:36864
v_mfma_f32_16x16x32_bf16 v[96:99], v[176:179], v[168:171], v[96:99]
ds_read_b64_tr_b16 v[74:75], v6 offset:38912
ds_read_b64_tr_b16 v[76:77], v7 offset:36864
v_mfma_f32_16x16x32_bf16 v[100:103], v[180:183], v[168:171], v[100:103]
ds_read_b64_tr_b16 v[78:79], v7 offset:38912
ds_read_b128 v[60:63], v3 offset:9216
v_mfma_f32_16x16x32_bf16 v[104:107], v[184:187], v[168:171], v[104:107]
s_bitcmp0_b32 s2, 0
v_mfma_f32_16x16x32_bf16 v[108:111], v[188:191], v[168:171], v[108:111]
s_cselect_b32 s88, s72, s74
v_mfma_f32_16x16x32_bf16 v[124:127], v[188:191], v[172:175], v[124:127]
s_cselect_b32 s89, s73, s75
v_mfma_f32_16x16x32_bf16 v[120:123], v[184:187], v[172:175], v[120:123]
s_mov_b32 s90, 7340032
v_mfma_f32_16x16x32_bf16 v[116:119], v[180:183], v[172:175], v[116:119]
s_mov_b32 s91, 0x20000
v_mfma_f32_16x16x32_bf16 v[112:115], v[176:179], v[172:175], v[112:115]
s_bfe_u32 s44, s2, 0x30001
s_waitcnt lgkmcnt(0)
s_barrier
v_mfma_f32_16x16x32_bf16 v[96:99], v[40:43], v[32:35], v[96:99]
ds_read_b128 v[144:147], v3 offset:49152
ds_read_b64_tr_b16 v[152:153], v4 offset:40960
v_mfma_f32_16x16x32_bf16 v[100:103], v[44:47], v[32:35], v[100:103]
ds_read_b64_tr_b16 v[154:155], v4 offset:43008
ds_read_b64_tr_b16 v[156:157], v5 offset:40960
v_mfma_f32_16x16x32_bf16 v[104:107], v[48:51], v[32:35], v[104:107]
ds_read_b64_tr_b16 v[158:159], v5 offset:43008
ds_read_b64_tr_b16 v[160:161], v6 offset:40960
v_mfma_f32_16x16x32_bf16 v[108:111], v[52:55], v[32:35], v[108:111]
ds_read_b64_tr_b16 v[162:163], v6 offset:43008
ds_read_b64_tr_b16 v[164:165], v7 offset:40960
v_mfma_f32_16x16x32_bf16 v[124:127], v[52:55], v[36:39], v[124:127]
ds_read_b64_tr_b16 v[166:167], v7 offset:43008
ds_read_b128 v[148:151], v3 offset:50176
v_mfma_f32_16x16x32_bf16 v[120:123], v[48:51], v[36:39], v[120:123]
ds_read_b128 v[168:171], v3 offset:57344
ds_read_b64_tr_b16 v[176:177], v4 offset:45056
v_mfma_f32_16x16x32_bf16 v[116:119], v[44:47], v[36:39], v[116:119]
ds_read_b64_tr_b16 v[178:179], v4 offset:47104
ds_read_b64_tr_b16 v[180:181], v5 offset:45056
v_mfma_f32_16x16x32_bf16 v[112:115], v[40:43], v[36:39], v[112:115]
ds_read_b64_tr_b16 v[182:183], v5 offset:47104
ds_read_b64_tr_b16 v[184:185], v6 offset:45056
v_mfma_f32_16x16x32_bf16 v[96:99], v[64:67], v[56:59], v[96:99]
ds_read_b64_tr_b16 v[186:187], v6 offset:47104
ds_read_b64_tr_b16 v[188:189], v7 offset:45056
v_mfma_f32_16x16x32_bf16 v[100:103], v[68:71], v[56:59], v[100:103]
ds_read_b64_tr_b16 v[190:191], v7 offset:47104
ds_read_b128 v[172:175], v3 offset:58368
v_mfma_f32_16x16x32_bf16 v[104:107], v[72:75], v[56:59], v[104:107]
s_lshl_b32 s44, s44, 2
v_mfma_f32_16x16x32_bf16 v[108:111], v[76:79], v[56:59], v[108:111]
s_and_b32 s43, s36, 3
v_mfma_f32_16x16x32_bf16 v[124:127], v[76:79], v[60:63], v[124:127]
s_add_u32 s44, s44, s43
v_mfma_f32_16x16x32_bf16 v[120:123], v[72:75], v[60:63], v[120:123]
s_lshl_b32 s44, s44, 5
v_mfma_f32_16x16x32_bf16 v[116:119], v[68:71], v[60:63], v[116:119]
v_lshrrev_b32 v195, 4, v1
v_mfma_f32_16x16x32_bf16 v[112:115], v[64:67], v[60:63], v[112:115]
v_add_u32 v195, s44, v195
s_waitcnt lgkmcnt(0)
s_barrier
v_mfma_f32_16x16x32_bf16 v[96:99], v[152:155], v[144:147], v[96:99]
ds_read_b128 v[32:35], v2 offset:0
ds_read_b64_tr_b16 v[40:41], v16 offset:49152
v_mfma_f32_16x16x32_bf16 v[100:103], v[156:159], v[144:147], v[100:103]
ds_read_b64_tr_b16 v[42:43], v16 offset:51200
ds_read_b64_tr_b16 v[44:45], v17 offset:49152
v_mfma_f32_16x16x32_bf16 v[104:107], v[160:163], v[144:147], v[104:107]
ds_read_b64_tr_b16 v[46:47], v17 offset:51200
ds_read_b64_tr_b16 v[48:49], v18 offset:49152
v_mfma_f32_16x16x32_bf16 v[108:111], v[164:167], v[144:147], v[108:111]
ds_read_b64_tr_b16 v[50:51], v18 offset:51200
ds_read_b64_tr_b16 v[52:53], v19 offset:49152
v_mfma_f32_16x16x32_bf16 v[124:127], v[164:167], v[148:151], v[124:127]
ds_read_b64_tr_b16 v[54:55], v19 offset:51200
ds_read_b128 v[36:39], v2 offset:1024
v_mfma_f32_16x16x32_bf16 v[120:123], v[160:163], v[148:151], v[120:123]
ds_read_b128 v[56:59], v2 offset:8192
ds_read_b64_tr_b16 v[64:65], v16 offset:53248
v_mfma_f32_16x16x32_bf16 v[116:119], v[156:159], v[148:151], v[116:119]
ds_read_b64_tr_b16 v[66:67], v16 offset:55296
ds_read_b64_tr_b16 v[68:69], v17 offset:53248
v_mfma_f32_16x16x32_bf16 v[112:115], v[152:155], v[148:151], v[112:115]
ds_read_b64_tr_b16 v[70:71], v17 offset:55296
ds_read_b64_tr_b16 v[72:73], v18 offset:53248
v_mfma_f32_16x16x32_bf16 v[96:99], v[176:179], v[168:171], v[96:99]
ds_read_b64_tr_b16 v[74:75], v18 offset:55296
ds_read_b64_tr_b16 v[76:77], v19 offset:53248
v_mfma_f32_16x16x32_bf16 v[100:103], v[180:183], v[168:171], v[100:103]
ds_read_b64_tr_b16 v[78:79], v19 offset:55296
ds_read_b128 v[60:63], v2 offset:9216
v_mfma_f32_16x16x32_bf16 v[104:107], v[184:187], v[168:171], v[104:107]
v_mul_u32_u24 v195, 7168, v195
v_mfma_f32_16x16x32_bf16 v[108:111], v[188:191], v[168:171], v[108:111]
v_and_b32 v196, 15, v1
v_mfma_f32_16x16x32_bf16 v[124:127], v[188:191], v[172:175], v[124:127]
v_lshl_add_u32 v195, v196, 4, v195
v_mfma_f32_16x16x32_bf16 v[120:123], v[184:187], v[172:175], v[120:123]
s_lshr_b32 s43, s2, 4
v_mfma_f32_16x16x32_bf16 v[116:119], v[180:183], v[172:175], v[116:119]
s_lshl_b32 s43, s43, 8
v_mfma_f32_16x16x32_bf16 v[112:115], v[176:179], v[172:175], v[112:115]
v_add_u32 v195, s43, v195
s_waitcnt lgkmcnt(0)
s_barrier
v_mfma_f32_16x16x32_bf16 v[96:99], v[40:43], v[32:35], v[96:99]
ds_read_b128 v[144:147], v2 offset:49152
ds_read_b64_tr_b16 v[152:153], v16 offset:57344
v_mfma_f32_16x16x32_bf16 v[100:103], v[44:47], v[32:35], v[100:103]
ds_read_b64_tr_b16 v[154:155], v16 offset:59392
ds_read_b64_tr_b16 v[156:157], v17 offset:57344
v_mfma_f32_16x16x32_bf16 v[104:107], v[48:51], v[32:35], v[104:107]
ds_read_b64_tr_b16 v[158:159], v17 offset:59392
ds_read_b64_tr_b16 v[160:161], v18 offset:57344
v_mfma_f32_16x16x32_bf16 v[108:111], v[52:55], v[32:35], v[108:111]
ds_read_b64_tr_b16 v[162:163], v18 offset:59392
ds_read_b64_tr_b16 v[164:165], v19 offset:57344
v_mfma_f32_16x16x32_bf16 v[124:127], v[52:55], v[36:39], v[124:127]
ds_read_b64_tr_b16 v[166:167], v19 offset:59392
ds_read_b128 v[148:151], v2 offset:50176
v_mfma_f32_16x16x32_bf16 v[120:123], v[48:51], v[36:39], v[120:123]
ds_read_b128 v[168:171], v2 offset:57344
ds_read_b64_tr_b16 v[176:177], v16 offset:61440
v_mfma_f32_16x16x32_bf16 v[116:119], v[44:47], v[36:39], v[116:119]
ds_read_b64_tr_b16 v[178:179], v16 offset:63488
ds_read_b64_tr_b16 v[180:181], v17 offset:61440
v_mfma_f32_16x16x32_bf16 v[112:115], v[40:43], v[36:39], v[112:115]
ds_read_b64_tr_b16 v[182:183], v17 offset:63488
ds_read_b64_tr_b16 v[184:185], v18 offset:61440
v_mfma_f32_16x16x32_bf16 v[96:99], v[64:67], v[56:59], v[96:99]
ds_read_b64_tr_b16 v[186:187], v18 offset:63488
ds_read_b64_tr_b16 v[188:189], v19 offset:61440
v_mfma_f32_16x16x32_bf16 v[100:103], v[68:71], v[56:59], v[100:103]
ds_read_b64_tr_b16 v[190:191], v19 offset:63488
ds_read_b128 v[172:175], v2 offset:58368
v_mfma_f32_16x16x32_bf16 v[104:107], v[72:75], v[56:59], v[104:107]
v_mfma_f32_16x16x32_bf16 v[108:111], v[76:79], v[56:59], v[108:111]
v_mfma_f32_16x16x32_bf16 v[124:127], v[76:79], v[60:63], v[124:127]
v_mfma_f32_16x16x32_bf16 v[120:123], v[72:75], v[60:63], v[120:123]
v_mfma_f32_16x16x32_bf16 v[116:119], v[68:71], v[60:63], v[116:119]
v_mfma_f32_16x16x32_bf16 v[112:115], v[64:67], v[60:63], v[112:115]
s_waitcnt lgkmcnt(0)
s_barrier
v_mfma_f32_16x16x32_bf16 v[96:99], v[152:155], v[144:147], v[96:99]
ds_read_b128 v[32:35], v3 offset:0
ds_read_b64_tr_b16 v[40:41], v20 offset:0
v_mfma_f32_16x16x32_bf16 v[100:103], v[156:159], v[144:147], v[100:103]
ds_read_b64_tr_b16 v[42:43], v20 offset:2048
ds_read_b64_tr_b16 v[44:45], v21 offset:0
v_mfma_f32_16x16x32_bf16 v[104:107], v[160:163], v[144:147], v[104:107]
ds_read_b64_tr_b16 v[46:47], v21 offset:2048
ds_read_b64_tr_b16 v[48:49], v22 offset:0
v_mfma_f32_16x16x32_bf16 v[108:111], v[164:167], v[144:147], v[108:111]
ds_read_b64_tr_b16 v[50:51], v22 offset:2048
ds_read_b64_tr_b16 v[52:53], v23 offset:0
v_mfma_f32_16x16x32_bf16 v[124:127], v[164:167], v[148:151], v[124:127]
ds_read_b64_tr_b16 v[54:55], v23 offset:2048
ds_read_b128 v[36:39], v3 offset:1024
v_mfma_f32_16x16x32_bf16 v[120:123], v[160:163], v[148:151], v[120:123]
ds_read_b128 v[56:59], v3 offset:8192
ds_read_b64_tr_b16 v[64:65], v20 offset:4096
v_mfma_f32_16x16x32_bf16 v[116:119], v[156:159], v[148:151], v[116:119]
ds_read_b64_tr_b16 v[66:67], v20 offset:6144
ds_read_b64_tr_b16 v[68:69], v21 offset:4096
v_mfma_f32_16x16x32_bf16 v[112:115], v[152:155], v[148:151], v[112:115]
ds_read_b64_tr_b16 v[70:71], v21 offset:6144
ds_read_b64_tr_b16 v[72:73], v22 offset:4096
v_mfma_f32_16x16x32_bf16 v[96:99], v[176:179], v[168:171], v[96:99]
ds_read_b64_tr_b16 v[74:75], v22 offset:6144
ds_read_b64_tr_b16 v[76:77], v23 offset:4096
v_mfma_f32_16x16x32_bf16 v[100:103], v[180:183], v[168:171], v[100:103]
ds_read_b64_tr_b16 v[78:79], v23 offset:6144
ds_read_b128 v[60:63], v3 offset:9216
v_mfma_f32_16x16x32_bf16 v[104:107], v[184:187], v[168:171], v[104:107]
v_mfma_f32_16x16x32_bf16 v[108:111], v[188:191], v[168:171], v[108:111]
v_mfma_f32_16x16x32_bf16 v[124:127], v[188:191], v[172:175], v[124:127]
v_mfma_f32_16x16x32_bf16 v[120:123], v[184:187], v[172:175], v[120:123]
v_mfma_f32_16x16x32_bf16 v[116:119], v[180:183], v[172:175], v[116:119]
v_mfma_f32_16x16x32_bf16 v[112:115], v[176:179], v[172:175], v[112:115]
s_waitcnt lgkmcnt(0)
s_barrier
v_mfma_f32_16x16x32_bf16 v[96:99], v[40:43], v[32:35], v[96:99]
ds_read_b128 v[144:147], v3 offset:49152
ds_read_b64_tr_b16 v[152:153], v20 offset:8192
v_mfma_f32_16x16x32_bf16 v[100:103], v[44:47], v[32:35], v[100:103]
ds_read_b64_tr_b16 v[154:155], v20 offset:10240
ds_read_b64_tr_b16 v[156:157], v21 offset:8192
v_mfma_f32_16x16x32_bf16 v[104:107], v[48:51], v[32:35], v[104:107]
ds_read_b64_tr_b16 v[158:159], v21 offset:10240
ds_read_b64_tr_b16 v[160:161], v22 offset:8192
v_mfma_f32_16x16x32_bf16 v[108:111], v[52:55], v[32:35], v[108:111]
ds_read_b64_tr_b16 v[162:163], v22 offset:10240
ds_read_b64_tr_b16 v[164:165], v23 offset:8192
v_mfma_f32_16x16x32_bf16 v[124:127], v[52:55], v[36:39], v[124:127]
ds_read_b64_tr_b16 v[166:167], v23 offset:10240
ds_read_b128 v[148:151], v3 offset:50176
v_mfma_f32_16x16x32_bf16 v[120:123], v[48:51], v[36:39], v[120:123]
ds_read_b128 v[168:171], v3 offset:57344
ds_read_b64_tr_b16 v[176:177], v20 offset:12288
v_mfma_f32_16x16x32_bf16 v[116:119], v[44:47], v[36:39], v[116:119]
ds_read_b64_tr_b16 v[178:179], v20 offset:14336
ds_read_b64_tr_b16 v[180:181], v21 offset:12288
v_mfma_f32_16x16x32_bf16 v[112:115], v[40:43], v[36:39], v[112:115]
ds_read_b64_tr_b16 v[182:183], v21 offset:14336
ds_read_b64_tr_b16 v[184:185], v22 offset:12288
v_mfma_f32_16x16x32_bf16 v[96:99], v[64:67], v[56:59], v[96:99]
ds_read_b64_tr_b16 v[186:187], v22 offset:14336
ds_read_b64_tr_b16 v[188:189], v23 offset:12288
v_mfma_f32_16x16x32_bf16 v[100:103], v[68:71], v[56:59], v[100:103]
s_branch Lov_6
.p2align 12
.fill 48, 4, 0xbf800000
Lst_6_0:
s_branch Lst_7_0
s_nop 0
s_nop 0
Lov_6:
ds_read_b64_tr_b16 v[190:191], v23 offset:14336
ds_read_b128 v[172:175], v3 offset:58368
v_mfma_f32_16x16x32_bf16 v[104:107], v[72:75], v[56:59], v[104:107]
v_mfma_f32_16x16x32_bf16 v[108:111], v[76:79], v[56:59], v[108:111]
v_mfma_f32_16x16x32_bf16 v[124:127], v[76:79], v[60:63], v[124:127]
v_mfma_f32_16x16x32_bf16 v[120:123], v[72:75], v[60:63], v[120:123]
v_mfma_f32_16x16x32_bf16 v[116:119], v[68:71], v[60:63], v[116:119]
v_mfma_f32_16x16x32_bf16 v[112:115], v[64:67], v[60:63], v[112:115]
s_waitcnt lgkmcnt(0)
s_barrier
v_mfma_f32_16x16x32_bf16 v[96:99], v[152:155], v[144:147], v[96:99]
v_mfma_f32_16x16x32_bf16 v[100:103], v[156:159], v[144:147], v[100:103]
v_mfma_f32_16x16x32_bf16 v[104:107], v[160:163], v[144:147], v[104:107]
v_mfma_f32_16x16x32_bf16 v[108:111], v[164:167], v[144:147], v[108:111]
v_mfma_f32_16x16x32_bf16 v[124:127], v[164:167], v[148:151], v[124:127]
v_mfma_f32_16x16x32_bf16 v[120:123], v[160:163], v[148:151], v[120:123]
v_mfma_f32_16x16x32_bf16 v[116:119], v[156:159], v[148:151], v[116:119]
v_mfma_f32_16x16x32_bf16 v[112:115], v[152:155], v[148:151], v[112:115]
v_mfma_f32_16x16x32_bf16 v[96:99], v[176:179], v[168:171], v[96:99]
v_mfma_f32_16x16x32_bf16 v[100:103], v[180:183], v[168:171], v[100:103]
v_mfma_f32_16x16x32_bf16 v[104:107], v[184:187], v[168:171], v[104:107]
v_mfma_f32_16x16x32_bf16 v[108:111], v[188:191], v[168:171], v[108:111]
v_mfma_f32_16x16x32_bf16 v[124:127], v[188:191], v[172:175], v[124:127]
v_mfma_f32_16x16x32_bf16 v[120:123], v[184:187], v[172:175], v[120:123]
v_mfma_f32_16x16x32_bf16 v[116:119], v[180:183], v[172:175], v[116:119]
v_mfma_f32_16x16x32_bf16 v[112:115], v[176:179], v[172:175], v[112:115]
s_nop 3
v_cvt_pk_bf16_f32 v32, v96, v97
v_cvt_pk_bf16_f32 v33, v98, v99
v_cvt_pk_bf16_f32 v34, v100, v101
v_cvt_pk_bf16_f32 v35, v102, v103
s_add_u32 s43, s60, 0
buffer_store_dwordx4 v[32:35], v11, s[20:23], s43 offen offset:0 sc1
v_cvt_pk_bf16_f32 v36, v104, v105
v_cvt_pk_bf16_f32 v37, v106, v107
v_cvt_pk_bf16_f32 v38, v108, v109
v_cvt_pk_bf16_f32 v39, v110, v111
s_add_u32 s43, s60, 8192
buffer_store_dwordx4 v[36:39], v11, s[20:23], s43 offen offset:0 sc1
v_cvt_pk_bf16_f32 v44, v120, v121
v_cvt_pk_bf16_f32 v45, v122, v123
v_cvt_pk_bf16_f32 v46, v124, v125
v_cvt_pk_bf16_f32 v47, v126, v127
s_add_u32 s43, s60, 8192
buffer_store_dwordx4 v[44:47], v11, s[20:23], s43 offen offset:1024 sc1
v_cvt_pk_bf16_f32 v40, v112, v113
v_cvt_pk_bf16_f32 v41, v114, v115
v_cvt_pk_bf16_f32 v42, v116, v117
v_cvt_pk_bf16_f32 v43, v118, v119
s_add_u32 s43, s60, 0
buffer_store_dwordx4 v[40:43], v11, s[20:23], s43 offen offset:1024 sc1
v_mov_b32 v64, 0
v_mov_b32 v65, 0
v_mov_b32 v66, 0
v_mov_b32 v67, 0
v_mov_b32 v68, 0
v_mov_b32 v69, 0
v_mov_b32 v70, 0
v_mov_b32 v71, 0
v_dot2_f32_bf16 v64, v32, s61, v64
v_dot2_f32_bf16 v66, v32, v32, v66
v_dot2_f32_bf16 v68, v40, s61, v68
v_dot2_f32_bf16 v70, v40, v40, v70
v_dot2_f32_bf16 v65, v33, s61, v65
v_dot2_f32_bf16 v67, v33, v33, v67
v_dot2_f32_bf16 v69, v41, s61, v69
v_dot2_f32_bf16 v71, v41, v41, v71
v_dot2_f32_bf16 v64, v34, s61, v64
v_dot2_f32_bf16 v66, v34, v34, v66
v_dot2_f32_bf16 v68, v42, s61, v68
v_dot2_f32_bf16 v70, v42, v42, v70
v_dot2_f32_bf16 v65, v35, s61, v65
v_dot2_f32_bf16 v67, v35, v35, v67
v_dot2_f32_bf16 v69, v43, s61, v69
v_dot2_f32_bf16 v71, v43, v43, v71
v_dot2_f32_bf16 v64, v36, s61, v64
v_dot2_f32_bf16 v66, v36, v36, v66
v_dot2_f32_bf16 v68, v44, s61, v68
v_dot2_f32_bf16 v70, v44, v44, v70
v_dot2_f32_bf16 v65, v37, s61, v65
v_dot2_f32_bf16 v67, v37, v37, v67
v_dot2_f32_bf16 v69, v45, s61, v69
v_dot2_f32_bf16 v71, v45, v45, v71
v_dot2_f32_bf16 v64, v38, s61, v64
v_dot2_f32_bf16 v66, v38, v38, v66
v_dot2_f32_bf16 v68, v46, s61, v68
v_dot2_f32_bf16 v70, v46, v46, v70
v_dot2_f32_bf16 v65, v39, s61, v65
v_dot2_f32_bf16 v67, v39, v39, v67
v_dot2_f32_bf16 v69, v47, s61, v69
v_dot2_f32_bf16 v71, v47, v47, v71
s_nop 2
v_add_f32 v64, v64, v65
v_add_f32 v66, v66, v67
v_add_f32 v68, v68, v69
v_add_f32 v70, v70, v71
s_nop 1
v_permlane32_swap_b32 v64, v68
v_permlane32_swap_b32 v66, v70
v_add_f32 v64, v64, v68
v_add_f32 v66, v66, v70
s_nop 1
v_permlane16_swap_b32 v64, v66
v_add_f32 v64, v64, v66
buffer_store_dword v64, v9, s[24:27], 0 offen sc1
s_lshl_b32 s7, s34, 12
s_add_u32 s7, s7, 49280
v_lshl_add_u32 v4, v1, 8, s7
v_mov_b32 v5, 1
s_waitcnt vmcnt(0)
s_cmp_lg_u32 s36, 0
s_barrier
s_cbranch_scc1 Lk2end_83
s_mov_b64 exec, 0xffff
buffer_atomic_add v5, v4, s[56:59], 0 offen sc1
s_mov_b64 exec, -1
s_branch Lk2end_83
Lprod_84:
s_mul_i32 s43, s34, 262144
s_add_u32 s8, s82, s43
s_addc_u32 s9, s83, 0
s_mov_b32 s10, 262144
s_mov_b32 s11, 0x20000
s_lshl_b32 s43, s35, 7
s_add_u32 s12, s68, s43
s_addc_u32 s13, s69, 0
s_mov_b32 s14, 2095232
s_mov_b32 s15, 0x20000
s_and_b32 s47, s36, 3
s_lshl_b32 s39, s47, 12
v_lshlrev_b32 v2, 4, v1
v_add_u32 v2, s39, v2
v_lshrrev_b32 v12, 3, v1
v_and_b32 v13, 6, v12
v_and_b32 v3, 7, v1
v_xor_b32 v3, v3, v13
v_lshlrev_b32 v3, 4, v3
v_mul_u32_u24 v12, 2048, v12
v_add_u32 v3, v3, v12
s_lshl_b32 s43, s47, 15
v_add_u32 v3, s43, v3
s_lshl_b32 s40, s47, 11
s_add_u32 s37, s35, 0
s_and_b32 s37, s37, 15
s_lshl_b32 s37, s37, 14
s_add_u32 m0, s39, 0
s_nop 0
buffer_load_dwordx4 v2, s[8:11], s37 offen offset:0 sc1 lds
buffer_load_dwordx4 v2, s[8:11], s37 offen offset:1024 sc1 lds
buffer_load_dwordx4 v2, s[8:11], s37 offen offset:2048 sc1 lds
buffer_load_dwordx4 v2, s[8:11], s37 offen offset:3072 sc1 lds
s_add_u32 s38, s35, 4
s_and_b32 s38, s38, 15
s_lshl_b32 s38, s38, 17
s_add_u32 m0, s40, 114688
s_nop 0
buffer_load_dwordx4 v3, s[12:15], s38 offen lds
s_add_u32 m0, s40, 115712
s_add_u32 s38, s38, 16384
buffer_load_dwordx4 v3, s[12:15], s38 offen lds
s_add_u32 s38, s35, 5
s_and_b32 s38, s38, 15
s_lshl_b32 s38, s38, 17
s_add_u32 m0, s40, 122880
s_nop 0
buffer_load_dwordx4 v3, s[12:15], s38 offen lds
s_add_u32 m0, s40, 123904
s_add_u32 s38, s38, 16384
buffer_load_dwordx4 v3, s[12:15], s38 offen lds
s_add_u32 s38, s35, 6
s_and_b32 s38, s38, 15
s_lshl_b32 s38, s38, 17
s_add_u32 m0, s40, 131072
s_nop 0
buffer_load_dwordx4 v3, s[12:15], s38 offen lds
s_add_u32 m0, s40, 132096
s_add_u32 s38, s38, 16384
buffer_load_dwordx4 v3, s[12:15], s38 offen lds
s_add_u32 s38, s35, 7
s_and_b32 s38, s38, 15
s_lshl_b32 s38, s38, 17
s_add_u32 m0, s40, 139264
s_nop 0
buffer_load_dwordx4 v3, s[12:15], s38 offen lds
s_add_u32 m0, s40, 140288
s_add_u32 s38, s38, 16384
buffer_load_dwordx4 v3, s[12:15], s38 offen lds
s_bitcmp0_b32 s36, 1
s_cselect_b32 s44, s72, s74
s_cselect_b32 s45, s73, s75
s_mul_i32 s43, s35, 192
s_add_u32 s16, s44, s43
s_addc_u32 s17, s45, 0
s_add_u32 s16, s16, 4096
s_addc_u32 s17, s17, 0
s_mov_b32 s18, 7333056
s_mov_b32 s19, 0x20000
s_and_b32 s43, s36, 1
s_mul_i32 s43, s43, 229376
v_add_u32 v196, 0, v1
v_mul_u32_u24 v197, 5462, v196
v_lshrrev_b32 v197, 16, v197
v_mul_u32_u24 v198, 12, v197
v_sub_u32 v198, v196, v198
v_bfe_u32 v199, v197, 2, 1
v_cmp_gt_u32 vcc, 8, v198
v_lshlrev_b32 v200, 1, v199
v_mul_u32_u24 v197, 7168, v197
v_cndmask_b32 v199, v199, v200, vcc
v_xor_b32 v198, v198, v199
v_lshl_add_u32 v192, v198, 4, v197
v_add_u32 v196, 64, v1
v_mul_u32_u24 v197, 5462, v196
v_lshrrev_b32 v197, 16, v197
v_mul_u32_u24 v198, 12, v197
v_sub_u32 v198, v196, v198
v_bfe_u32 v199, v197, 2, 1
v_cmp_gt_u32 vcc, 8, v198
v_lshlrev_b32 v200, 1, v199
v_mul_u32_u24 v197, 7168, v197
v_cndmask_b32 v199, v199, v200, vcc
v_xor_b32 v198, v198, v199
v_lshl_add_u32 v193, v198, 4, v197
v_add_u32 v196, 128, v1
v_mul_u32_u24 v197, 5462, v196
v_lshrrev_b32 v197, 16, v197
v_mul_u32_u24 v198, 12, v197
v_sub_u32 v198, v196, v198
v_bfe_u32 v199, v197, 2, 1
v_cmp_gt_u32 vcc, 8, v198
v_lshlrev_b32 v200, 1, v199
v_mul_u32_u24 v197, 7168, v197
v_cndmask_b32 v199, v199, v200, vcc
v_xor_b32 v198, v198, v199
v_lshl_add_u32 v194, v198, 4, v197
v_add_u32 v192, s43, v192
v_add_u32 v193, s43, v193
v_add_u32 v194, s43, v194
s_and_b32 s43, s36, 3
s_mul_i32 s50, s43, 6144
s_add_u32 s50, s50, 16384
s_cmp_eq_u32 s47, 3
s_cbranch_scc0 Lw_91
s_lshl_b32 s92, s34, 4
s_add_u32 s92, s92, s35
s_lshl_b32 s92, s92, 8
s_add_u32 s92, s92, 49152
s_add_u32 s92, s92, 28311552
s_mov_b32 s41, 0x40000
Lpoll_92:
s_load_dword s93, s[82:83], s92 glc
Lpchk_94:
s_waitcnt lgkmcnt(0)
s_cmp_eq_u32 s93, 16
s_cbranch_scc1 Lpok_93
s_sub_u32 s41, s41, 1
s_cmp_lg_u32 s41, 0
s_cbranch_scc1 Lpoll_92
Lpok_93:
Lw_91:
s_and_b32 s44, s36, 3
s_mul_i32 s44, s44, 14
s_bfe_u32 s43, s2, 0x30001
s_lshl_b32 s43, s43, 7
s_add_u32 s44, s44, s43
s_add_u32 s44, s44, 72
s_mul_i32 s44, s44, 7168
s_lshr_b32 s43, s2, 4
s_lshl_b32 s43, s43, 8
s_add_u32 s43, s43, s44
s_bitcmp0_b32 s2, 0
s_cselect_b32 s4, s72, s74
s_cselect_b32 s5, s73, s75
s_add_u32 s4, s4, s43
s_addc_u32 s5, s5, 0
s_cmp_eq_u32 s47, 3
s_cbranch_scc1 Lw_95
s_load_dword s3, s[4:5], 0
s_load_dword s3, s[4:5], 64
s_load_dword s3, s[4:5], 128
s_load_dword s3, s[4:5], 192
s_load_dword s3, s[4:5], 7168
s_load_dword s3, s[4:5], 7232
s_load_dword s3, s[4:5], 7296
s_load_dword s3, s[4:5], 7360
s_load_dword s3, s[4:5], 14336
s_load_dword s3, s[4:5], 14400
s_load_dword s3, s[4:5], 14464
s_load_dword s3, s[4:5], 14528
s_load_dword s3, s[4:5], 21504
s_load_dword s3, s[4:5], 21568
Lw_95:
s_waitcnt vmcnt(8)
s_barrier
s_add_u32 s37, s35, 1
s_and_b32 s37, s37, 15
s_lshl_b32 s37, s37, 14
s_add_u32 m0, s39, 49152
s_nop 0
buffer_load_dwordx4 v2, s[8:11], s37 offen offset:0 sc1 lds
buffer_load_dwordx4 v2, s[8:11], s37 offen offset:1024 sc1 lds
buffer_load_dwordx4 v2, s[8:11], s37 offen offset:2048 sc1 lds
buffer_load_dwordx4 v2, s[8:11], s37 offen offset:3072 sc1 lds
s_add_u32 s37, s35, 2
s_and_b32 s37, s37, 15
s_lshl_b32 s37, s37, 14
s_add_u32 m0, s39, 98304
s_nop 0
buffer_load_dwordx4 v2, s[8:11], s37 offen offset:0 sc1 lds
buffer_load_dwordx4 v2, s[8:11], s37 offen offset:1024 sc1 lds
buffer_load_dwordx4 v2, s[8:11], s37 offen offset:2048 sc1 lds
buffer_load_dwordx4 v2, s[8:11], s37 offen offset:3072 sc1 lds
s_add_u32 s37, s35, 3
s_and_b32 s37, s37, 15
s_lshl_b32 s37, s37, 14
s_add_u32 m0, s39, 147456
s_nop 0
buffer_load_dwordx4 v2, s[8:11], s37 offen offset:0 sc1 lds
buffer_load_dwordx4 v2, s[8:11], s37 offen offset:1024 sc1 lds
buffer_load_dwordx4 v2, s[8:11], s37 offen offset:2048 sc1 lds
buffer_load_dwordx4 v2, s[8:11], s37 offen offset:3072 sc1 lds
s_cmp_eq_u32 s47, 3
s_cbranch_scc0 Lw_96
s_load_dword s3, s[4:5], 0
s_load_dword s3, s[4:5], 64
s_load_dword s3, s[4:5], 128
s_load_dword s3, s[4:5], 192
s_load_dword s3, s[4:5], 7168
s_load_dword s3, s[4:5], 7232
s_load_dword s3, s[4:5], 7296
s_load_dword s3, s[4:5], 7360
s_load_dword s3, s[4:5], 14336
s_load_dword s3, s[4:5], 14400
s_load_dword s3, s[4:5], 14464
s_load_dword s3, s[4:5], 14528
s_load_dword s3, s[4:5], 21504
s_load_dword s3, s[4:5], 21568
Lw_96:
s_waitcnt vmcnt(8)
s_barrier
s_add_u32 s37, s35, 4
s_and_b32 s37, s37, 15
s_lshl_b32 s37, s37, 14
s_add_u32 m0, s39, 0
s_nop 0
buffer_load_dwordx4 v2, s[8:11], s37 offen offset:0 sc1 lds
buffer_load_dwordx4 v2, s[8:11], s37 offen offset:1024 sc1 lds
buffer_load_dwordx4 v2, s[8:11], s37 offen offset:2048 sc1 lds
buffer_load_dwordx4 v2, s[8:11], s37 offen offset:3072 sc1 lds
s_add_u32 s38, s35, 8
s_and_b32 s38, s38, 15
s_lshl_b32 s38, s38, 17
s_add_u32 m0, s40, 16384
s_nop 0
buffer_load_dwordx4 v3, s[12:15], s38 offen lds
s_add_u32 m0, s40, 17408
s_add_u32 s38, s38, 16384
buffer_load_dwordx4 v3, s[12:15], s38 offen lds
v_lshlrev_b32 v240, 16, v128
v_and_b32 v241, 0xffff0000, v128
v_lshlrev_b32 v242, 16, v129
v_and_b32 v243, 0xffff0000, v129
v_lshlrev_b32 v244, 16, v130
v_and_b32 v245, 0xffff0000, v130
v_lshlrev_b32 v246, 16, v131
v_and_b32 v247, 0xffff0000, v131
s_load_dword s3, s[4:5], 21632
s_load_dword s3, s[4:5], 21696
s_load_dword s3, s[4:5], 28672
s_waitcnt vmcnt(10)
s_barrier
s_add_u32 s37, s35, 5
s_and_b32 s37, s37, 15
s_lshl_b32 s37, s37, 14
s_add_u32 m0, s39, 49152
s_nop 0
buffer_load_dwordx4 v2, s[8:11], s37 offen offset:0 sc1 lds
buffer_load_dwordx4 v2, s[8:11], s37 offen offset:1024 sc1 lds
buffer_load_dwordx4 v2, s[8:11], s37 offen offset:2048 sc1 lds
buffer_load_dwordx4 v2, s[8:11], s37 offen offset:3072 sc1 lds
s_add_u32 s38, s35, 9
s_and_b32 s38, s38, 15
s_lshl_b32 s38, s38, 17
s_add_u32 m0, s40, 24576
s_nop 0
buffer_load_dwordx4 v3, s[12:15], s38 offen lds
s_add_u32 m0, s40, 25600
s_add_u32 s38, s38, 16384
buffer_load_dwordx4 v3, s[12:15], s38 offen lds
v_lshlrev_b32 v24, 16, v132
v_and_b32 v25, 0xffff0000, v132
v_lshlrev_b32 v26, 16, v133
v_and_b32 v27, 0xffff0000, v133
v_lshlrev_b32 v28, 16, v134
v_and_b32 v29, 0xffff0000, v134
v_lshlrev_b32 v30, 16, v135
v_and_b32 v31, 0xffff0000, v135
v_add_f32 v240, v240, v24
v_add_f32 v241, v241, v25
v_add_f32 v242, v242, v26
v_add_f32 v243, v243, v27
v_add_f32 v244, v244, v28
v_add_f32 v245, v245, v29
v_add_f32 v246, v246, v30
v_add_f32 v247, v247, v31
s_load_dword s3, s[4:5], 28736
s_load_dword s3, s[4:5], 28800
s_load_dword s3, s[4:5], 28864
s_waitcnt vmcnt(12)
s_barrier
s_add_u32 s37, s35, 6
s_and_b32 s37, s37, 15
s_lshl_b32 s37, s37, 14
s_add_u32 m0, s39, 98304
s_nop 0
buffer_load_dwordx4 v2, s[8:11], s37 offen offset:0 sc1 lds
buffer_load_dwordx4 v2, s[8:11], s37 offen offset:1024 sc1 lds
buffer_load_dwordx4 v2, s[8:11], s37 offen offset:2048 sc1 lds
buffer_load_dwordx4 v2, s[8:11], s37 offen offset:3072 sc1 lds
s_add_u32 s38, s35, 10
s_and_b32 s38, s38, 15
s_lshl_b32 s38, s38, 17
s_add_u32 m0, s40, 32768
s_nop 0
buffer_load_dwordx4 v3, s[12:15], s38 offen lds
s_add_u32 m0, s40, 33792
s_add_u32 s38, s38, 16384
buffer_load_dwordx4 v3, s[12:15], s38 offen lds
v_lshlrev_b32 v24, 16, v136
v_and_b32 v25, 0xffff0000, v136
v_lshlrev_b32 v26, 16, v137
v_and_b32 v27, 0xffff0000, v137
v_lshlrev_b32 v28, 16, v138
v_and_b32 v29, 0xffff0000, v138
v_lshlrev_b32 v30, 16, v139
v_and_b32 v31, 0xffff0000, v139
v_add_f32 v240, v240, v24
v_add_f32 v241, v241, v25
v_add_f32 v242, v242, v26
v_add_f32 v243, v243, v27
v_add_f32 v244, v244, v28
v_add_f32 v245, v245, v29
v_add_f32 v246, v246, v30
v_add_f32 v247, v247, v31
s_load_dword s3, s[4:5], 35840
s_load_dword s3, s[4:5], 35904
s_load_dword s3, s[4:5], 35968
s_waitcnt vmcnt(14)
s_barrier
s_add_u32 s37, s35, 7
s_and_b32 s37, s37, 15
s_lshl_b32 s37, s37, 14
s_add_u32 m0, s39, 147456
s_nop 0
buffer_load_dwordx4 v2, s[8:11], s37 offen offset:0 sc1 lds
buffer_load_dwordx4 v2, s[8:11], s37 offen offset:1024 sc1 lds
buffer_load_dwordx4 v2, s[8:11], s37 offen offset:2048 sc1 lds
buffer_load_dwordx4 v2, s[8:11], s37 offen offset:3072 sc1 lds
s_add_u32 s38, s35, 11
s_and_b32 s38, s38, 15
s_lshl_b32 s38, s38, 17
s_add_u32 m0, s40, 40960
s_nop 0
buffer_load_dwordx4 v3, s[12:15], s38 offen lds
s_add_u32 m0, s40, 41984
s_add_u32 s38, s38, 16384
buffer_load_dwordx4 v3, s[12:15], s38 offen lds
v_lshlrev_b32 v24, 16, v140
v_and_b32 v25, 0xffff0000, v140
v_lshlrev_b32 v26, 16, v141
v_and_b32 v27, 0xffff0000, v141
v_lshlrev_b32 v28, 16, v142
v_and_b32 v29, 0xffff0000, v142
v_lshlrev_b32 v30, 16, v143
v_and_b32 v31, 0xffff0000, v143
v_add_f32 v240, v240, v24
v_add_f32 v241, v241, v25
v_add_f32 v242, v242, v26
v_add_f32 v243, v243, v27
v_add_f32 v244, v244, v28
v_add_f32 v245, v245, v29
v_add_f32 v246, v246, v30
v_add_f32 v247, v247, v31
s_load_dword s3, s[4:5], 36032
s_load_dword s3, s[4:5], 43008
s_load_dword s3, s[4:5], 43072
s_waitcnt vmcnt(14)
s_barrier
s_add_u32 s37, s35, 8
s_and_b32 s37, s37, 15
s_lshl_b32 s37, s37, 14
s_add_u32 m0, s39, 0
s_nop 0
buffer_load_dwordx4 v2, s[8:11], s37 offen offset:0 sc1 lds
buffer_load_dwordx4 v2, s[8:11], s37 offen offset:1024 sc1 lds
buffer_load_dwordx4 v2, s[8:11], s37 offen offset:2048 sc1 lds
buffer_load_dwordx4 v2, s[8:11], s37 offen offset:3072 sc1 lds
s_add_u32 s38, s35, 12
s_and_b32 s38, s38, 15
s_lshl_b32 s38, s38, 17
s_add_u32 m0, s40, 114688
s_nop 0
buffer_load_dwordx4 v3, s[12:15], s38 offen lds
s_add_u32 m0, s40, 115712
s_add_u32 s38, s38, 16384
buffer_load_dwordx4 v3, s[12:15], s38 offen lds
v_lshlrev_b32 v24, 16, v144
v_and_b32 v25, 0xffff0000, v144
v_lshlrev_b32 v26, 16, v145
v_and_b32 v27, 0xffff0000, v145
v_lshlrev_b32 v28, 16, v146
v_and_b32 v29, 0xffff0000, v146
v_lshlrev_b32 v30, 16, v147
v_and_b32 v31, 0xffff0000, v147
v_add_f32 v240, v240, v24
v_add_f32 v241, v241, v25
v_add_f32 v242, v242, v26
v_add_f32 v243, v243, v27
v_add_f32 v244, v244, v28
v_add_f32 v245, v245, v29
v_add_f32 v246, v246, v30
v_add_f32 v247, v247, v31
s_load_dword s3, s[4:5], 43136
s_load_dword s3, s[4:5], 43200
s_load_dword s3, s[4:5], 50176
s_waitcnt vmcnt(14)
s_barrier
s_add_u32 s37, s35, 9
s_and_b32 s37, s37, 15
s_lshl_b32 s37, s37, 14
s_add_u32 m0, s39, 49152
s_nop 0
buffer_load_dwordx4 v2, s[8:11], s37 offen offset:0 sc1 lds
buffer_load_dwordx4 v2, s[8:11], s37 offen offset:1024 sc1 lds
buffer_load_dwordx4 v2, s[8:11], s37 offen offset:2048 sc1 lds
buffer_load_dwordx4 v2, s[8:11], s37 offen offset:3072 sc1 lds
s_add_u32 s38, s35, 13
s_and_b32 s38, s38, 15
s_lshl_b32 s38, s38, 17
s_add_u32 m0, s40, 122880
s_nop 0
buffer_load_dwordx4 v3, s[12:15], s38 offen lds
s_add_u32 m0, s40, 123904
s_add_u32 s38, s38, 16384
buffer_load_dwordx4 v3, s[12:15], s38 offen lds
v_lshlrev_b32 v24, 16, v148
v_and_b32 v25, 0xffff0000, v148
v_lshlrev_b32 v26, 16, v149
v_and_b32 v27, 0xffff0000, v149
v_lshlrev_b32 v28, 16, v150
v_and_b32 v29, 0xffff0000, v150
v_lshlrev_b32 v30, 16, v151
v_and_b32 v31, 0xffff0000, v151
v_add_f32 v240, v240, v24
v_add_f32 v241, v241, v25
v_add_f32 v242, v242, v26
v_add_f32 v243, v243, v27
v_add_f32 v244, v244, v28
v_add_f32 v245, v245, v29
v_add_f32 v246, v246, v30
v_add_f32 v247, v247, v31
s_load_dword s3, s[4:5], 50240
s_load_dword s3, s[4:5], 50304
s_load_dword s3, s[4:5], 50368
s_waitcnt vmcnt(14)
s_barrier
s_add_u32 s37, s35, 10
s_and_b32 s37, s37, 15
s_lshl_b32 s37, s37, 14
s_add_u32 m0, s39, 98304
s_nop 0
buffer_load_dwordx4 v2, s[8:11], s37 offen offset:0 sc1 lds
buffer_load_dwordx4 v2, s[8:11], s37 offen offset:1024 sc1 lds
buffer_load_dwordx4 v2, s[8:11], s37 offen offset:2048 sc1 lds
buffer_load_dwordx4 v2, s[8:11], s37 offen offset:3072 sc1 lds
s_add_u32 s38, s35, 14
s_and_b32 s38, s38, 15
s_lshl_b32 s38, s38, 17
s_add_u32 m0, s40, 131072
s_nop 0
buffer_load_dwordx4 v3, s[12:15], s38 offen lds
s_add_u32 m0, s40, 132096
s_add_u32 s38, s38, 16384
buffer_load_dwordx4 v3, s[12:15], s38 offen lds
v_lshlrev_b32 v24, 16, v152
v_and_b32 v25, 0xffff0000, v152
v_lshlrev_b32 v26, 16, v153
v_and_b32 v27, 0xffff0000, v153
v_lshlrev_b32 v28, 16, v154
v_and_b32 v29, 0xffff0000, v154
v_lshlrev_b32 v30, 16, v155
v_and_b32 v31, 0xffff0000, v155
v_add_f32 v240, v240, v24
v_add_f32 v241, v241, v25
v_add_f32 v242, v242, v26
v_add_f32 v243, v243, v27
v_add_f32 v244, v244, v28
v_add_f32 v245, v245, v29
v_add_f32 v246, v246, v30
v_add_f32 v247, v247, v31
s_load_dword s3, s[4:5], 57344
s_load_dword s3, s[4:5], 57408
s_load_dword s3, s[4:5], 57472
s_waitcnt vmcnt(14)
s_barrier
s_add_u32 s37, s35, 11
s_and_b32 s37, s37, 15
s_lshl_b32 s37, s37, 14
s_add_u32 m0, s39, 147456
s_nop 0
buffer_load_dwordx4 v2, s[8:11], s37 offen offset:0 sc1 lds
buffer_load_dwordx4 v2, s[8:11], s37 offen offset:1024 sc1 lds
buffer_load_dwordx4 v2, s[8:11], s37 offen offset:2048 sc1 lds
buffer_load_dwordx4 v2, s[8:11], s37 offen offset:3072 sc1 lds
s_add_u32 s38, s35, 15
s_and_b32 s38, s38, 15
s_lshl_b32 s38, s38, 17
s_add_u32 m0, s40, 139264
s_nop 0
buffer_load_dwordx4 v3, s[12:15], s38 offen lds
s_add_u32 m0, s40, 140288
s_add_u32 s38, s38, 16384
buffer_load_dwordx4 v3, s[12:15], s38 offen lds
v_lshlrev_b32 v24, 16, v156
v_and_b32 v25, 0xffff0000, v156
v_lshlrev_b32 v26, 16, v157
v_and_b32 v27, 0xffff0000, v157
v_lshlrev_b32 v28, 16, v158
v_and_b32 v29, 0xffff0000, v158
v_lshlrev_b32 v30, 16, v159
v_and_b32 v31, 0xffff0000, v159
v_add_f32 v240, v240, v24
v_add_f32 v241, v241, v25
v_add_f32 v242, v242, v26
v_add_f32 v243, v243, v27
v_add_f32 v244, v244, v28
v_add_f32 v245, v245, v29
v_add_f32 v246, v246, v30
v_add_f32 v247, v247, v31
s_load_dword s3, s[4:5], 57536
s_load_dword s3, s[4:5], 64512
s_load_dword s3, s[4:5], 64576
s_waitcnt vmcnt(14)
s_barrier
s_add_u32 s37, s35, 12
s_and_b32 s37, s37, 15
s_lshl_b32 s37, s37, 14
s_add_u32 m0, s39, 0
s_nop 0
buffer_load_dwordx4 v2, s[8:11], s37 offen offset:0 sc1 lds
buffer_load_dwordx4 v2, s[8:11], s37 offen offset:1024 sc1 lds
buffer_load_dwordx4 v2, s[8:11], s37 offen offset:2048 sc1 lds
buffer_load_dwordx4 v2, s[8:11], s37 offen offset:3072 sc1 lds
s_load_dword s3, s[4:5], 64640
s_load_dword s3, s[4:5], 64704
s_branch Lov_7
.p2align 12
.fill 48, 4, 0xbf800000
Lst_7_0:
s_branch Lwr_148
s_nop 0
s_nop 0
Lov_7:
s_load_dword s3, s[4:5], 71680
s_waitcnt vmcnt(12)
s_barrier
s_add_u32 s37, s35, 13
s_and_b32 s37, s37, 15
s_lshl_b32 s37, s37, 14
s_add_u32 m0, s39, 49152
s_nop 0
buffer_load_dwordx4 v2, s[8:11], s37 offen offset:0 sc1 lds
buffer_load_dwordx4 v2, s[8:11], s37 offen offset:1024 sc1 lds
buffer_load_dwordx4 v2, s[8:11], s37 offen offset:2048 sc1 lds
buffer_load_dwordx4 v2, s[8:11], s37 offen offset:3072 sc1 lds
s_load_dword s3, s[4:5], 71744
s_load_dword s3, s[4:5], 71808
s_load_dword s3, s[4:5], 71872
s_waitcnt vmcnt(10)
s_barrier
s_add_u32 s37, s35, 14
s_and_b32 s37, s37, 15
s_lshl_b32 s37, s37, 14
s_add_u32 m0, s39, 98304
s_nop 0
buffer_load_dwordx4 v2, s[8:11], s37 offen offset:0 sc1 lds
buffer_load_dwordx4 v2, s[8:11], s37 offen offset:1024 sc1 lds
buffer_load_dwordx4 v2, s[8:11], s37 offen offset:2048 sc1 lds
buffer_load_dwordx4 v2, s[8:11], s37 offen offset:3072 sc1 lds
s_waitcnt vmcnt(8)
s_barrier
s_add_u32 s37, s35, 15
s_and_b32 s37, s37, 15
s_lshl_b32 s37, s37, 14
s_add_u32 m0, s39, 147456
s_nop 0
buffer_load_dwordx4 v2, s[8:11], s37 offen offset:0 sc1 lds
buffer_load_dwordx4 v2, s[8:11], s37 offen offset:1024 sc1 lds
buffer_load_dwordx4 v2, s[8:11], s37 offen offset:2048 sc1 lds
buffer_load_dwordx4 v2, s[8:11], s37 offen offset:3072 sc1 lds
s_waitcnt vmcnt(8)
s_barrier
s_nop 0
v_permlane32_swap_b32 v240, v244
v_permlane32_swap_b32 v241, v245
v_permlane32_swap_b32 v242, v246
v_permlane32_swap_b32 v243, v247
v_add_f32 v240, v240, v244
v_add_f32 v241, v241, v245
v_add_f32 v242, v242, v246
v_add_f32 v243, v243, v247
s_nop 0
v_permlane16_swap_b32 v240, v242
v_permlane16_swap_b32 v241, v243
v_add_f32 v240, v240, v242
v_add_f32 v241, v241, v243
s_waitcnt vmcnt(4)
s_barrier
s_add_u32 s38, s35, 0
s_and_b32 s38, s38, 15
s_mul_i32 s38, s38, 458752
s_add_u32 m0, s50, 0
s_nop 0
buffer_load_dwordx4 v192, s[16:19], s38 offen lds
s_add_u32 m0, s50, 1024
s_nop 0
buffer_load_dwordx4 v193, s[16:19], s38 offen lds
s_add_u32 m0, s50, 2048
s_nop 0
buffer_load_dwordx4 v194, s[16:19], s38 offen lds
s_add_u32 m0, s50, 3072
s_add_u32 s38, s38, 114688
buffer_load_dwordx4 v192, s[16:19], s38 offen lds
s_add_u32 m0, s50, 4096
s_nop 0
buffer_load_dwordx4 v193, s[16:19], s38 offen lds
s_add_u32 m0, s50, 5120
s_nop 0
buffer_load_dwordx4 v194, s[16:19], s38 offen lds
s_add_u32 s38, s35, 1
s_and_b32 s38, s38, 15
s_mul_i32 s38, s38, 458752
s_add_u32 m0, s50, 49152
s_nop 0
buffer_load_dwordx4 v192, s[16:19], s38 offen lds
s_add_u32 m0, s50, 50176
s_nop 0
buffer_load_dwordx4 v193, s[16:19], s38 offen lds
s_add_u32 m0, s50, 51200
s_nop 0
buffer_load_dwordx4 v194, s[16:19], s38 offen lds
s_add_u32 m0, s50, 52224
s_add_u32 s38, s38, 114688
buffer_load_dwordx4 v192, s[16:19], s38 offen lds
s_add_u32 m0, s50, 53248
s_nop 0
buffer_load_dwordx4 v193, s[16:19], s38 offen lds
s_add_u32 m0, s50, 54272
s_nop 0
buffer_load_dwordx4 v194, s[16:19], s38 offen lds
s_waitcnt vmcnt(12)
s_barrier
s_barrier
s_branch Lk3a
Lk2end_83:
Lk3:
s_branch Lgb_97
Lk3a:
s_mul_i32 s43, s34, 262144
s_add_u32 s8, s82, s43
s_addc_u32 s9, s83, 0
s_add_u32 s8, s8, 4194304
s_addc_u32 s9, s9, 0
s_mov_b32 s10, 262144
s_mov_b32 s11, 0x20000
s_mul_i32 s43, s34, 917504
s_add_u32 s24, s82, s43
s_addc_u32 s25, s83, 0
s_add_u32 s24, s24, 8388608
s_addc_u32 s25, s25, 0
s_mov_b32 s26, 917504
s_mov_b32 s27, 0x20000
s_add_u32 s84, s82, 27262976
s_addc_u32 s85, s83, 0
s_mov_b32 s86, 229376
s_mov_b32 s87, 0x20000
s_and_b32 s47, s36, 3
s_lshr_b32 s62, s47, 1
s_and_b32 s63, s47, 1
v_lshlrev_b32 v2, 4, v1
s_lshl_b32 s39, s47, 12
v_add_u32 v3, s39, v2
s_bitcmp0_b32 s36, 1
s_cselect_b32 s44, s72, s74
s_cselect_b32 s45, s73, s75
s_mul_i32 s43, s35, 256
s_add_u32 s12, s44, s43
s_addc_u32 s13, s45, 0
s_mov_b32 s14, 7333120
s_mov_b32 s15, 0x20000
s_and_b32 s43, s36, 1
s_mul_i32 s43, s43, 229376
v_lshrrev_b32 v28, 4, v1
v_lshlrev_b32 v29, 1, v28
v_and_b32 v4, 15, v1
v_xor_b32 v4, v4, v29
v_lshlrev_b32 v4, 4, v4
v_mul_u32_u24 v28, 7168, v28
v_add_u32 v4, v4, v28
v_add_u32 v4, s43, v4
v_xor_b32 v5, 128, v4
v_add_u32 v5, 28672, v5
s_and_b32 s43, s36, 3
s_mul_i32 s40, s43, 8192
s_add_u32 s40, s40, 16384
v_mov_b32 v6, v192
v_mov_b32 v7, v193
v_mov_b32 v8, v194
s_lshl_b32 s43, s62, 12
v_add_u32 v9, s43, v2
v_add_u32 v10, 98304, v9
s_lshl_b32 s43, s47, 9
s_add_u32 s43, s43, 151552
v_and_b32 v28, 15, v1
v_lshl_add_u32 v28, v28, 5, s43
v_lshrrev_b32 v29, 4, v1
v_lshl_add_u32 v28, v29, 3, v28
ds_write_b64 v28, v[240:241]
s_waitcnt lgkmcnt(0)
v_lshrrev_b32 v27, 2, v1
v_bfe_u32 v28, v27, 2, 1
v_mul_u32_u24 v27, 192, v27
v_add_u32 v27, 16384, v27
v_and_b32 v29, 3, v1
v_lshl_add_u32 v12, v29, 3, v27
s_lshl_b32 s43, s63, 6
v_add_u32 v12, s43, v12
v_lshl_add_u32 v11, v28, 5, v12
v_xor_b32 v30, 1, v28
v_lshl_add_u32 v12, v30, 5, v12
v_xor_b32 v28, s63, v28
v_lshl_add_u32 v27, v28, 4, v27
v_lshrrev_b32 v28, 1, v29
v_lshl_add_u32 v27, v28, 5, v27
v_and_b32 v28, 1, v29
v_lshl_add_u32 v27, v28, 3, v27
v_add_u32 v13, 128, v27
v_add_u32 v14, 49152, v11
v_add_u32 v15, 49152, v12
v_add_u32 v16, 49152, v13
v_add_u32 v17, 98304, v11
v_add_u32 v18, 98304, v12
v_add_u32 v19, 98304, v13
s_cmp_lg_u32 s36, 4
s_cbranch_scc1 Lwm_99
s_branch Lst_8_1
Lwr_164:
s_branch Lwe_98
Lwm_99:
s_cmp_lg_u32 s36, 5
s_cbranch_scc1 Lwm_100
s_branch Lst_9_1
Lwr_165:
s_branch Lwe_98
Lwm_100:
s_cmp_lg_u32 s36, 6
s_cbranch_scc1 Lwm_101
s_branch Lst_10_1
Lwr_166:
s_branch Lwe_98
Lwm_101:
s_cmp_lg_u32 s36, 7
s_cbranch_scc1 Lwm_102
s_nop 0
s_branch Lwe_98
Lwm_102:
Lwe_98:
s_barrier
s_cmp_lg_u32 s36, 4
s_cbranch_scc1 Lwm_104
s_branch Lst_11_1
Lwr_168:
s_branch Lwe_103
Lwm_104:
s_cmp_lg_u32 s36, 5
s_cbranch_scc1 Lwm_105
s_branch Lst_12_1
Lwr_169:
s_branch Lwe_103
Lwm_105:
s_cmp_lg_u32 s36, 6
s_cbranch_scc1 Lwm_106
s_branch Lst_13_1
Lwr_170:
s_branch Lwe_103
Lwm_106:
s_cmp_lg_u32 s36, 7
s_cbranch_scc1 Lwm_107
s_branch Lst_14_1
Lwr_171:
s_branch Lwe_103
Lwm_107:
Lwe_103:
s_waitcnt vmcnt(0) lgkmcnt(0)
s_barrier
ds_read_b128 v[32:35], v9 offset:0
ds_read_b64_tr_b16 v[48:49], v11 offset:0
ds_read_b64_tr_b16 v[50:51], v11 offset:3072
ds_read_b64_tr_b16 v[52:53], v12 offset:0
ds_read_b64_tr_b16 v[54:55], v12 offset:3072
ds_read_b64_tr_b16 v[56:57], v13 offset:0
ds_read_b64_tr_b16 v[58:59], v13 offset:3072
ds_read_b64_tr_b16 v[60:61], v11 offset:12288
ds_read_b64_tr_b16 v[62:63], v11 offset:15360
ds_read_b64_tr_b16 v[64:65], v12 offset:12288
ds_read_b64_tr_b16 v[66:67], v12 offset:15360
ds_read_b64_tr_b16 v[68:69], v13 offset:12288
ds_read_b64_tr_b16 v[70:71], v13 offset:15360
ds_read_b128 v[36:39], v9 offset:1024
ds_read_b128 v[40:43], v9 offset:2048
ds_read_b128 v[44:47], v9 offset:3072
s_waitcnt lgkmcnt(0)
v_mfma_f32_16x16x32_bf16 v[128:131], v[48:51], v[32:35], 0
ds_read_b128 v[72:75], v9 offset:8192
v_mfma_f32_16x16x32_bf16 v[152:155], v[48:51], v[36:39], 0
ds_read_b64_tr_b16 v[88:89], v11 offset:6144
v_mfma_f32_16x16x32_bf16 v[176:179], v[48:51], v[40:43], 0
ds_read_b64_tr_b16 v[90:91], v11 offset:9216
v_mfma_f32_16x16x32_bf16 v[200:203], v[48:51], v[44:47], 0
ds_read_b64_tr_b16 v[92:93], v12 offset:6144
v_mfma_f32_16x16x32_bf16 v[204:207], v[52:55], v[44:47], 0
ds_read_b64_tr_b16 v[94:95], v12 offset:9216
v_mfma_f32_16x16x32_bf16 v[180:183], v[52:55], v[40:43], 0
ds_read_b64_tr_b16 v[96:97], v13 offset:6144
v_mfma_f32_16x16x32_bf16 v[156:159], v[52:55], v[36:39], 0
ds_read_b64_tr_b16 v[98:99], v13 offset:9216
v_mfma_f32_16x16x32_bf16 v[132:135], v[52:55], v[32:35], 0
ds_read_b64_tr_b16 v[100:101], v11 offset:18432
v_mfma_f32_16x16x32_bf16 v[136:139], v[56:59], v[32:35], 0
ds_read_b64_tr_b16 v[102:103], v11 offset:21504
v_mfma_f32_16x16x32_bf16 v[160:163], v[56:59], v[36:39], 0
ds_read_b64_tr_b16 v[104:105], v12 offset:18432
v_mfma_f32_16x16x32_bf16 v[184:187], v[56:59], v[40:43], 0
ds_read_b64_tr_b16 v[106:107], v12 offset:21504
v_mfma_f32_16x16x32_bf16 v[208:211], v[56:59], v[44:47], 0
ds_read_b64_tr_b16 v[108:109], v13 offset:18432
v_mfma_f32_16x16x32_bf16 v[212:215], v[60:63], v[44:47], 0
ds_read_b64_tr_b16 v[110:111], v13 offset:21504
v_mfma_f32_16x16x32_bf16 v[188:191], v[60:63], v[40:43], 0
ds_read_b128 v[76:79], v9 offset:9216
v_mfma_f32_16x16x32_bf16 v[164:167], v[60:63], v[36:39], 0
ds_read_b128 v[80:83], v9 offset:10240
v_mfma_f32_16x16x32_bf16 v[140:143], v[60:63], v[32:35], 0
ds_read_b128 v[84:87], v9 offset:11264
v_mfma_f32_16x16x32_bf16 v[144:147], v[64:67], v[32:35], 0
v_mfma_f32_16x16x32_bf16 v[168:171], v[64:67], v[36:39], 0
v_mfma_f32_16x16x32_bf16 v[192:195], v[64:67], v[40:43], 0
v_mfma_f32_16x16x32_bf16 v[216:219], v[64:67], v[44:47], 0
v_mfma_f32_16x16x32_bf16 v[220:223], v[68:71], v[44:47], 0
v_mfma_f32_16x16x32_bf16 v[196:199], v[68:71], v[40:43], 0
v_mfma_f32_16x16x32_bf16 v[172:175], v[68:71], v[36:39], 0
v_mfma_f32_16x16x32_bf16 v[148:151], v[68:71], v[32:35], 0
s_waitcnt lgkmcnt(0)
s_barrier
v_mfma_f32_16x16x32_bf16 v[128:131], v[88:91], v[72:75], v[128:131]
ds_read_b128 v[32:35], v9 offset:49152
v_mfma_f32_16x16x32_bf16 v[152:155], v[88:91], v[76:79], v[152:155]
ds_read_b64_tr_b16 v[48:49], v14 offset:0
v_mfma_f32_16x16x32_bf16 v[176:179], v[88:91], v[80:83], v[176:179]
ds_read_b64_tr_b16 v[50:51], v14 offset:3072
v_mfma_f32_16x16x32_bf16 v[200:203], v[88:91], v[84:87], v[200:203]
ds_read_b64_tr_b16 v[52:53], v15 offset:0
v_mfma_f32_16x16x32_bf16 v[204:207], v[92:95], v[84:87], v[204:207]
ds_read_b64_tr_b16 v[54:55], v15 offset:3072
v_mfma_f32_16x16x32_bf16 v[180:183], v[92:95], v[80:83], v[180:183]
ds_read_b64_tr_b16 v[56:57], v16 offset:0
v_mfma_f32_16x16x32_bf16 v[156:159], v[92:95], v[76:79], v[156:159]
ds_read_b64_tr_b16 v[58:59], v16 offset:3072
v_mfma_f32_16x16x32_bf16 v[132:135], v[92:95], v[72:75], v[132:135]
ds_read_b64_tr_b16 v[60:61], v14 offset:12288
v_mfma_f32_16x16x32_bf16 v[136:139], v[96:99], v[72:75], v[136:139]
ds_read_b64_tr_b16 v[62:63], v14 offset:15360
v_mfma_f32_16x16x32_bf16 v[160:163], v[96:99], v[76:79], v[160:163]
ds_read_b64_tr_b16 v[64:65], v15 offset:12288
v_mfma_f32_16x16x32_bf16 v[184:187], v[96:99], v[80:83], v[184:187]
ds_read_b64_tr_b16 v[66:67], v15 offset:15360
v_mfma_f32_16x16x32_bf16 v[208:211], v[96:99], v[84:87], v[208:211]
ds_read_b64_tr_b16 v[68:69], v16 offset:12288
v_mfma_f32_16x16x32_bf16 v[212:215], v[100:103], v[84:87], v[212:215]
ds_read_b64_tr_b16 v[70:71], v16 offset:15360
v_mfma_f32_16x16x32_bf16 v[188:191], v[100:103], v[80:83], v[188:191]
ds_read_b128 v[36:39], v9 offset:50176
v_mfma_f32_16x16x32_bf16 v[164:167], v[100:103], v[76:79], v[164:167]
ds_read_b128 v[40:43], v9 offset:51200
v_mfma_f32_16x16x32_bf16 v[140:143], v[100:103], v[72:75], v[140:143]
ds_read_b128 v[44:47], v9 offset:52224
v_mfma_f32_16x16x32_bf16 v[144:147], v[104:107], v[72:75], v[144:147]
v_mfma_f32_16x16x32_bf16 v[168:171], v[104:107], v[76:79], v[168:171]
v_mfma_f32_16x16x32_bf16 v[192:195], v[104:107], v[80:83], v[192:195]
v_mfma_f32_16x16x32_bf16 v[216:219], v[104:107], v[84:87], v[216:219]
v_mfma_f32_16x16x32_bf16 v[220:223], v[108:111], v[84:87], v[220:223]
v_mfma_f32_16x16x32_bf16 v[196:199], v[108:111], v[80:83], v[196:199]
v_mfma_f32_16x16x32_bf16 v[172:175], v[108:111], v[76:79], v[172:175]
v_mfma_f32_16x16x32_bf16 v[148:151], v[108:111], v[72:75], v[148:151]
s_mov_b32 s41, 5
Lk3l_108:
s_waitcnt lgkmcnt(0)
v_mfma_f32_16x16x32_bf16 v[128:131], v[48:51], v[32:35], v[128:131]
ds_read_b128 v[72:75], v9 offset:57344
v_mfma_f32_16x16x32_bf16 v[152:155], v[48:51], v[36:39], v[152:155]
ds_read_b64_tr_b16 v[88:89], v14 offset:6144
v_mfma_f32_16x16x32_bf16 v[176:179], v[48:51], v[40:43], v[176:179]
ds_read_b64_tr_b16 v[90:91], v14 offset:9216
v_mfma_f32_16x16x32_bf16 v[200:203], v[48:51], v[44:47], v[200:203]
ds_read_b64_tr_b16 v[92:93], v15 offset:6144
v_mfma_f32_16x16x32_bf16 v[204:207], v[52:55], v[44:47], v[204:207]
ds_read_b64_tr_b16 v[94:95], v15 offset:9216
v_mfma_f32_16x16x32_bf16 v[180:183], v[52:55], v[40:43], v[180:183]
ds_read_b64_tr_b16 v[96:97], v16 offset:6144
v_mfma_f32_16x16x32_bf16 v[156:159], v[52:55], v[36:39], v[156:159]
ds_read_b64_tr_b16 v[98:99], v16 offset:9216
v_mfma_f32_16x16x32_bf16 v[132:135], v[52:55], v[32:35], v[132:135]
ds_read_b64_tr_b16 v[100:101], v14 offset:18432
v_mfma_f32_16x16x32_bf16 v[136:139], v[56:59], v[32:35], v[136:139]
ds_read_b64_tr_b16 v[102:103], v14 offset:21504
v_mfma_f32_16x16x32_bf16 v[160:163], v[56:59], v[36:39], v[160:163]
ds_read_b64_tr_b16 v[104:105], v15 offset:18432
v_mfma_f32_16x16x32_bf16 v[184:187], v[56:59], v[40:43], v[184:187]
ds_read_b64_tr_b16 v[106:107], v15 offset:21504
v_mfma_f32_16x16x32_bf16 v[208:211], v[56:59], v[44:47], v[208:211]
ds_read_b64_tr_b16 v[108:109], v16 offset:18432
v_mfma_f32_16x16x32_bf16 v[212:215], v[60:63], v[44:47], v[212:215]
ds_read_b64_tr_b16 v[110:111], v16 offset:21504
v_mfma_f32_16x16x32_bf16 v[188:191], v[60:63], v[40:43], v[188:191]
ds_read_b128 v[76:79], v9 offset:58368
v_mfma_f32_16x16x32_bf16 v[164:167], v[60:63], v[36:39], v[164:167]
ds_read_b128 v[80:83], v9 offset:59392
v_mfma_f32_16x16x32_bf16 v[140:143], v[60:63], v[32:35], v[140:143]
ds_read_b128 v[84:87], v9 offset:60416
v_mfma_f32_16x16x32_bf16 v[144:147], v[64:67], v[32:35], v[144:147]
v_mfma_f32_16x16x32_bf16 v[168:171], v[64:67], v[36:39], v[168:171]
v_mfma_f32_16x16x32_bf16 v[192:195], v[64:67], v[40:43], v[192:195]
v_mfma_f32_16x16x32_bf16 v[216:219], v[64:67], v[44:47], v[216:219]
v_mfma_f32_16x16x32_bf16 v[220:223], v[68:71], v[44:47], v[220:223]
v_mfma_f32_16x16x32_bf16 v[196:199], v[68:71], v[40:43], v[196:199]
v_mfma_f32_16x16x32_bf16 v[172:175], v[68:71], v[36:39], v[172:175]
v_mfma_f32_16x16x32_bf16 v[148:151], v[68:71], v[32:35], v[148:151]
s_waitcnt lgkmcnt(0)
s_barrier
v_mfma_f32_16x16x32_bf16 v[128:131], v[88:91], v[72:75], v[128:131]
ds_read_b128 v[32:35], v10 offset:0
v_mfma_f32_16x16x32_bf16 v[152:155], v[88:91], v[76:79], v[152:155]
ds_read_b64_tr_b16 v[48:49], v17 offset:0
v_mfma_f32_16x16x32_bf16 v[176:179], v[88:91], v[80:83], v[176:179]
ds_read_b64_tr_b16 v[50:51], v17 offset:3072
v_mfma_f32_16x16x32_bf16 v[200:203], v[88:91], v[84:87], v[200:203]
ds_read_b64_tr_b16 v[52:53], v18 offset:0
v_mfma_f32_16x16x32_bf16 v[204:207], v[92:95], v[84:87], v[204:207]
ds_read_b64_tr_b16 v[54:55], v18 offset:3072
v_mfma_f32_16x16x32_bf16 v[180:183], v[92:95], v[80:83], v[180:183]
ds_read_b64_tr_b16 v[56:57], v19 offset:0
v_mfma_f32_16x16x32_bf16 v[156:159], v[92:95], v[76:79], v[156:159]
ds_read_b64_tr_b16 v[58:59], v19 offset:3072
v_mfma_f32_16x16x32_bf16 v[132:135], v[92:95], v[72:75], v[132:135]
ds_read_b64_tr_b16 v[60:61], v17 offset:12288
v_mfma_f32_16x16x32_bf16 v[136:139], v[96:99], v[72:75], v[136:139]
ds_read_b64_tr_b16 v[62:63], v17 offset:15360
v_mfma_f32_16x16x32_bf16 v[160:163], v[96:99], v[76:79], v[160:163]
ds_read_b64_tr_b16 v[64:65], v18 offset:12288
v_mfma_f32_16x16x32_bf16 v[184:187], v[96:99], v[80:83], v[184:187]
ds_read_b64_tr_b16 v[66:67], v18 offset:15360
v_mfma_f32_16x16x32_bf16 v[208:211], v[96:99], v[84:87], v[208:211]
ds_read_b64_tr_b16 v[68:69], v19 offset:12288
v_mfma_f32_16x16x32_bf16 v[212:215], v[100:103], v[84:87], v[212:215]
ds_read_b64_tr_b16 v[70:71], v19 offset:15360
v_mfma_f32_16x16x32_bf16 v[188:191], v[100:103], v[80:83], v[188:191]
ds_read_b128 v[36:39], v10 offset:1024
v_mfma_f32_16x16x32_bf16 v[164:167], v[100:103], v[76:79], v[164:167]
ds_read_b128 v[40:43], v10 offset:2048
v_mfma_f32_16x16x32_bf16 v[140:143], v[100:103], v[72:75], v[140:143]
ds_read_b128 v[44:47], v10 offset:3072
v_mfma_f32_16x16x32_bf16 v[144:147], v[104:107], v[72:75], v[144:147]
v_mfma_f32_16x16x32_bf16 v[168:171], v[104:107], v[76:79], v[168:171]
v_mfma_f32_16x16x32_bf16 v[192:195], v[104:107], v[80:83], v[192:195]
v_mfma_f32_16x16x32_bf16 v[216:219], v[104:107], v[84:87], v[216:219]
v_mfma_f32_16x16x32_bf16 v[220:223], v[108:111], v[84:87], v[220:223]
v_mfma_f32_16x16x32_bf16 v[196:199], v[108:111], v[80:83], v[196:199]
v_mfma_f32_16x16x32_bf16 v[172:175], v[108:111], v[76:79], v[172:175]
v_mfma_f32_16x16x32_bf16 v[148:151], v[108:111], v[72:75], v[148:151]
s_waitcnt lgkmcnt(0)
v_mfma_f32_16x16x32_bf16 v[128:131], v[48:51], v[32:35], v[128:131]
ds_read_b128 v[72:75], v10 offset:8192
v_mfma_f32_16x16x32_bf16 v[152:155], v[48:51], v[36:39], v[152:155]
ds_read_b64_tr_b16 v[88:89], v17 offset:6144
v_mfma_f32_16x16x32_bf16 v[176:179], v[48:51], v[40:43], v[176:179]
ds_read_b64_tr_b16 v[90:91], v17 offset:9216
v_mfma_f32_16x16x32_bf16 v[200:203], v[48:51], v[44:47], v[200:203]
ds_read_b64_tr_b16 v[92:93], v18 offset:6144
v_mfma_f32_16x16x32_bf16 v[204:207], v[52:55], v[44:47], v[204:207]
ds_read_b64_tr_b16 v[94:95], v18 offset:9216
v_mfma_f32_16x16x32_bf16 v[180:183], v[52:55], v[40:43], v[180:183]
ds_read_b64_tr_b16 v[96:97], v19 offset:6144
v_mfma_f32_16x16x32_bf16 v[156:159], v[52:55], v[36:39], v[156:159]
ds_read_b64_tr_b16 v[98:99], v19 offset:9216
v_mfma_f32_16x16x32_bf16 v[132:135], v[52:55], v[32:35], v[132:135]
ds_read_b64_tr_b16 v[100:101], v17 offset:18432
v_mfma_f32_16x16x32_bf16 v[136:139], v[56:59], v[32:35], v[136:139]
ds_read_b64_tr_b16 v[102:103], v17 offset:21504
v_mfma_f32_16x16x32_bf16 v[160:163], v[56:59], v[36:39], v[160:163]
ds_read_b64_tr_b16 v[104:105], v18 offset:18432
v_mfma_f32_16x16x32_bf16 v[184:187], v[56:59], v[40:43], v[184:187]
ds_read_b64_tr_b16 v[106:107], v18 offset:21504
v_mfma_f32_16x16x32_bf16 v[208:211], v[56:59], v[44:47], v[208:211]
ds_read_b64_tr_b16 v[108:109], v19 offset:18432
v_mfma_f32_16x16x32_bf16 v[212:215], v[60:63], v[44:47], v[212:215]
ds_read_b64_tr_b16 v[110:111], v19 offset:21504
v_mfma_f32_16x16x32_bf16 v[188:191], v[60:63], v[40:43], v[188:191]
ds_read_b128 v[76:79], v10 offset:9216
v_mfma_f32_16x16x32_bf16 v[164:167], v[60:63], v[36:39], v[164:167]
ds_read_b128 v[80:83], v10 offset:10240
v_mfma_f32_16x16x32_bf16 v[140:143], v[60:63], v[32:35], v[140:143]
ds_read_b128 v[84:87], v10 offset:11264
v_mfma_f32_16x16x32_bf16 v[144:147], v[64:67], v[32:35], v[144:147]
v_mfma_f32_16x16x32_bf16 v[168:171], v[64:67], v[36:39], v[168:171]
v_mfma_f32_16x16x32_bf16 v[192:195], v[64:67], v[40:43], v[192:195]
v_mfma_f32_16x16x32_bf16 v[216:219], v[64:67], v[44:47], v[216:219]
v_mfma_f32_16x16x32_bf16 v[220:223], v[68:71], v[44:47], v[220:223]
v_mfma_f32_16x16x32_bf16 v[196:199], v[68:71], v[40:43], v[196:199]
v_mfma_f32_16x16x32_bf16 v[172:175], v[68:71], v[36:39], v[172:175]
v_mfma_f32_16x16x32_bf16 v[148:151], v[68:71], v[32:35], v[148:151]
s_waitcnt lgkmcnt(0)
s_barrier
v_mfma_f32_16x16x32_bf16 v[128:131], v[88:91], v[72:75], v[128:131]
ds_read_b128 v[32:35], v9 offset:0
v_mfma_f32_16x16x32_bf16 v[152:155], v[88:91], v[76:79], v[152:155]
ds_read_b64_tr_b16 v[48:49], v11 offset:0
v_mfma_f32_16x16x32_bf16 v[176:179], v[88:91], v[80:83], v[176:179]
ds_read_b64_tr_b16 v[50:51], v11 offset:3072
v_mfma_f32_16x16x32_bf16 v[200:203], v[88:91], v[84:87], v[200:203]
ds_read_b64_tr_b16 v[52:53], v12 offset:0
v_mfma_f32_16x16x32_bf16 v[204:207], v[92:95], v[84:87], v[204:207]
ds_read_b64_tr_b16 v[54:55], v12 offset:3072
v_mfma_f32_16x16x32_bf16 v[180:183], v[92:95], v[80:83], v[180:183]
ds_read_b64_tr_b16 v[56:57], v13 offset:0
v_mfma_f32_16x16x32_bf16 v[156:159], v[92:95], v[76:79], v[156:159]
ds_read_b64_tr_b16 v[58:59], v13 offset:3072
v_mfma_f32_16x16x32_bf16 v[132:135], v[92:95], v[72:75], v[132:135]
ds_read_b64_tr_b16 v[60:61], v11 offset:12288
v_mfma_f32_16x16x32_bf16 v[136:139], v[96:99], v[72:75], v[136:139]
ds_read_b64_tr_b16 v[62:63], v11 offset:15360
v_mfma_f32_16x16x32_bf16 v[160:163], v[96:99], v[76:79], v[160:163]
ds_read_b64_tr_b16 v[64:65], v12 offset:12288
v_mfma_f32_16x16x32_bf16 v[184:187], v[96:99], v[80:83], v[184:187]
ds_read_b64_tr_b16 v[66:67], v12 offset:15360
v_mfma_f32_16x16x32_bf16 v[208:211], v[96:99], v[84:87], v[208:211]
ds_read_b64_tr_b16 v[68:69], v13 offset:12288
v_mfma_f32_16x16x32_bf16 v[212:215], v[100:103], v[84:87], v[212:215]
ds_read_b64_tr_b16 v[70:71], v13 offset:15360
v_mfma_f32_16x16x32_bf16 v[188:191], v[100:103], v[80:83], v[188:191]
ds_read_b128 v[36:39], v9 offset:1024
v_mfma_f32_16x16x32_bf16 v[164:167], v[100:103], v[76:79], v[164:167]
ds_read_b128 v[40:43], v9 offset:2048
v_mfma_f32_16x16x32_bf16 v[140:143], v[100:103], v[72:75], v[140:143]
ds_read_b128 v[44:47], v9 offset:3072
v_mfma_f32_16x16x32_bf16 v[144:147], v[104:107], v[72:75], v[144:147]
v_mfma_f32_16x16x32_bf16 v[168:171], v[104:107], v[76:79], v[168:171]
v_mfma_f32_16x16x32_bf16 v[192:195], v[104:107], v[80:83], v[192:195]
v_mfma_f32_16x16x32_bf16 v[216:219], v[104:107], v[84:87], v[216:219]
v_mfma_f32_16x16x32_bf16 v[220:223], v[108:111], v[84:87], v[220:223]
v_mfma_f32_16x16x32_bf16 v[196:199], v[108:111], v[80:83], v[196:199]
v_mfma_f32_16x16x32_bf16 v[172:175], v[108:111], v[76:79], v[172:175]
v_mfma_f32_16x16x32_bf16 v[148:151], v[108:111], v[72:75], v[148:151]
s_waitcnt lgkmcnt(0)
v_mfma_f32_16x16x32_bf16 v[128:131], v[48:51], v[32:35], v[128:131]
ds_read_b128 v[72:75], v9 offset:8192
v_mfma_f32_16x16x32_bf16 v[152:155], v[48:51], v[36:39], v[152:155]
ds_read_b64_tr_b16 v[88:89], v11 offset:6144
v_mfma_f32_16x16x32_bf16 v[176:179], v[48:51], v[40:43], v[176:179]
ds_read_b64_tr_b16 v[90:91], v11 offset:9216
v_mfma_f32_16x16x32_bf16 v[200:203], v[48:51], v[44:47], v[200:203]
ds_read_b64_tr_b16 v[92:93], v12 offset:6144
v_mfma_f32_16x16x32_bf16 v[204:207], v[52:55], v[44:47], v[204:207]
ds_read_b64_tr_b16 v[94:95], v12 offset:9216
v_mfma_f32_16x16x32_bf16 v[180:183], v[52:55], v[40:43], v[180:183]
ds_read_b64_tr_b16 v[96:97], v13 offset:6144
v_mfma_f32_16x16x32_bf16 v[156:159], v[52:55], v[36:39], v[156:159]
ds_read_b64_tr_b16 v[98:99], v13 offset:9216
v_mfma_f32_16x16x32_bf16 v[132:135], v[52:55], v[32:35], v[132:135]
ds_read_b64_tr_b16 v[100:101], v11 offset:18432
v_mfma_f32_16x16x32_bf16 v[136:139], v[56:59], v[32:35], v[136:139]
ds_read_b64_tr_b16 v[102:103], v11 offset:21504
v_mfma_f32_16x16x32_bf16 v[160:163], v[56:59], v[36:39], v[160:163]
ds_read_b64_tr_b16 v[104:105], v12 offset:18432
v_mfma_f32_16x16x32_bf16 v[184:187], v[56:59], v[40:43], v[184:187]
ds_read_b64_tr_b16 v[106:107], v12 offset:21504
v_mfma_f32_16x16x32_bf16 v[208:211], v[56:59], v[44:47], v[208:211]
ds_read_b64_tr_b16 v[108:109], v13 offset:18432
v_mfma_f32_16x16x32_bf16 v[212:215], v[60:63], v[44:47], v[212:215]
ds_read_b64_tr_b16 v[110:111], v13 offset:21504
v_mfma_f32_16x16x32_bf16 v[188:191], v[60:63], v[40:43], v[188:191]
ds_read_b128 v[76:79], v9 offset:9216
v_mfma_f32_16x16x32_bf16 v[164:167], v[60:63], v[36:39], v[164:167]
ds_read_b128 v[80:83], v9 offset:10240
v_mfma_f32_16x16x32_bf16 v[140:143], v[60:63], v[32:35], v[140:143]
ds_read_b128 v[84:87], v9 offset:11264
v_mfma_f32_16x16x32_bf16 v[144:147], v[64:67], v[32:35], v[144:147]
v_mfma_f32_16x16x32_bf16 v[168:171], v[64:67], v[36:39], v[168:171]
v_mfma_f32_16x16x32_bf16 v[192:195], v[64:67], v[40:43], v[192:195]
v_mfma_f32_16x16x32_bf16 v[216:219], v[64:67], v[44:47], v[216:219]
v_mfma_f32_16x16x32_bf16 v[220:223], v[68:71], v[44:47], v[220:223]
v_mfma_f32_16x16x32_bf16 v[196:199], v[68:71], v[40:43], v[196:199]
v_mfma_f32_16x16x32_bf16 v[172:175], v[68:71], v[36:39], v[172:175]
v_mfma_f32_16x16x32_bf16 v[148:151], v[68:71], v[32:35], v[148:151]
s_waitcnt lgkmcnt(0)
s_barrier
v_mfma_f32_16x16x32_bf16 v[128:131], v[88:91], v[72:75], v[128:131]
ds_read_b128 v[32:35], v9 offset:49152
v_mfma_f32_16x16x32_bf16 v[152:155], v[88:91], v[76:79], v[152:155]
ds_read_b64_tr_b16 v[48:49], v14 offset:0
v_mfma_f32_16x16x32_bf16 v[176:179], v[88:91], v[80:83], v[176:179]
ds_read_b64_tr_b16 v[50:51], v14 offset:3072
v_mfma_f32_16x16x32_bf16 v[200:203], v[88:91], v[84:87], v[200:203]
ds_read_b64_tr_b16 v[52:53], v15 offset:0
v_mfma_f32_16x16x32_bf16 v[204:207], v[92:95], v[84:87], v[204:207]
ds_read_b64_tr_b16 v[54:55], v15 offset:3072
v_mfma_f32_16x16x32_bf16 v[180:183], v[92:95], v[80:83], v[180:183]
ds_read_b64_tr_b16 v[56:57], v16 offset:0
v_mfma_f32_16x16x32_bf16 v[156:159], v[92:95], v[76:79], v[156:159]
ds_read_b64_tr_b16 v[58:59], v16 offset:3072
v_mfma_f32_16x16x32_bf16 v[132:135], v[92:95], v[72:75], v[132:135]
ds_read_b64_tr_b16 v[60:61], v14 offset:12288
v_mfma_f32_16x16x32_bf16 v[136:139], v[96:99], v[72:75], v[136:139]
ds_read_b64_tr_b16 v[62:63], v14 offset:15360
v_mfma_f32_16x16x32_bf16 v[160:163], v[96:99], v[76:79], v[160:163]
ds_read_b64_tr_b16 v[64:65], v15 offset:12288
v_mfma_f32_16x16x32_bf16 v[184:187], v[96:99], v[80:83], v[184:187]
ds_read_b64_tr_b16 v[66:67], v15 offset:15360
v_mfma_f32_16x16x32_bf16 v[208:211], v[96:99], v[84:87], v[208:211]
ds_read_b64_tr_b16 v[68:69], v16 offset:12288
v_mfma_f32_16x16x32_bf16 v[212:215], v[100:103], v[84:87], v[212:215]
ds_read_b64_tr_b16 v[70:71], v16 offset:15360
v_mfma_f32_16x16x32_bf16 v[188:191], v[100:103], v[80:83], v[188:191]
ds_read_b128 v[36:39], v9 offset:50176
v_mfma_f32_16x16x32_bf16 v[164:167], v[100:103], v[76:79], v[164:167]
s_branch Lov_8
.p2align 12
.fill 64, 4, 0xbf800000
Lst_8_0:
s_branch Lwr_149
Lst_8_1:
s_branch Lwr_164
s_nop 0
Lov_8:
ds_read_b128 v[40:43], v9 offset:51200
v_mfma_f32_16x16x32_bf16 v[140:143], v[100:103], v[72:75], v[140:143]
ds_read_b128 v[44:47], v9 offset:52224
v_mfma_f32_16x16x32_bf16 v[144:147], v[104:107], v[72:75], v[144:147]
v_mfma_f32_16x16x32_bf16 v[168:171], v[104:107], v[76:79], v[168:171]
v_mfma_f32_16x16x32_bf16 v[192:195], v[104:107], v[80:83], v[192:195]
v_mfma_f32_16x16x32_bf16 v[216:219], v[104:107], v[84:87], v[216:219]
v_mfma_f32_16x16x32_bf16 v[220:223], v[108:111], v[84:87], v[220:223]
v_mfma_f32_16x16x32_bf16 v[196:199], v[108:111], v[80:83], v[196:199]
v_mfma_f32_16x16x32_bf16 v[172:175], v[108:111], v[76:79], v[172:175]
v_mfma_f32_16x16x32_bf16 v[148:151], v[108:111], v[72:75], v[148:151]
s_sub_u32 s41, s41, 1
s_cmp_lg_u32 s41, 0
s_cbranch_scc1 Lk3l_108
s_waitcnt lgkmcnt(0)
s_add_u32 s38, s35, 15
s_and_b32 s38, s38, 15
s_mul_i32 s38, s38, 458752
s_add_u32 m0, s40, 0
s_nop 0
buffer_load_dwordx4 v4, s[12:15], s38 offen lds
v_lshrrev_b32 v86, 4, v1
s_lshl_b32 s43, s63, 7
s_add_u32 s43, s43, 148992
v_lshl_add_u32 v87, v86, 4, s43
v_lshrrev_b32 v88, 1, v86
v_and_b32 v86, 1, v86
s_add_u32 m0, s40, 1024
s_nop 0
buffer_load_dwordx4 v5, s[12:15], s38 offen lds
s_lshl_b32 s43, s63, 5
s_add_u32 s43, s43, 149248
v_lshl_add_u32 v88, v88, 6, s43
v_lshl_add_u32 v88, v86, 4, v88
v_and_b32 v86, 15, v1
s_lshl_b32 s43, s62, 9
s_add_u32 m0, s40, 2048
s_add_u32 s38, s38, 57344
buffer_load_dwordx4 v4, s[12:15], s38 offen lds
s_add_u32 s43, s43, 147456
v_lshl_add_u32 v86, v86, 3, s43
ds_read_b128 v[32:35], v87 offset:0
ds_read_b128 v[36:39], v87 offset:64
ds_read_b128 v[40:43], v88 offset:0
ds_read_b128 v[44:47], v87 offset:896
s_add_u32 m0, s40, 3072
s_nop 0
buffer_load_dwordx4 v5, s[12:15], s38 offen lds
ds_read_b128 v[48:51], v87 offset:960
ds_read_b128 v[52:55], v88 offset:896
ds_read_b64 v[56:57], v86 offset:0
ds_read_b64 v[58:59], v86 offset:128
ds_read_b64 v[60:61], v86 offset:256
ds_read_b64 v[62:63], v86 offset:384
s_add_u32 m0, s40, 4096
s_add_u32 s38, s38, 57344
buffer_load_dwordx4 v4, s[12:15], s38 offen lds
s_mul_i32 s54, s35, 24576
s_lshl_b32 s43, s62, 12
s_add_u32 s54, s54, s43
s_add_u32 s54, s54, 524288
s_lshl_b32 s43, s63, 9
s_add_u32 s55, s54, s43
s_add_u32 m0, s40, 5120
s_nop 0
buffer_load_dwordx4 v5, s[12:15], s38 offen lds
s_add_u32 s55, s55, 16384
s_lshl_b32 s43, s63, 13
s_add_u32 s54, s54, s43
v_and_b32 v84, 32, v1
v_lshlrev_b32 v84, 4, v84
v_add_u32 v84, v84, v2
s_waitcnt lgkmcnt(0)
s_add_u32 m0, s40, 6144
s_add_u32 s38, s38, 57344
buffer_load_dwordx4 v4, s[12:15], s38 offen lds
s_add_u32 m0, s40, 7168
s_nop 0
buffer_load_dwordx4 v5, s[12:15], s38 offen lds
s_and_b32 s44, s36, 3
s_mul_i32 s43, s2, 28672
s_mul_i32 s44, s44, 7168
s_add_u32 s43, s43, s44
s_add_u32 s4, s76, s43
s_addc_u32 s5, s77, 0
s_barrier
s_cmp_eq_u32 s47, 3
s_cbranch_scc0 Lw_109
v_and_b32 v90, 31, v1
v_lshlrev_b32 v90, 4, v90
v_add_u32 v91, 153600, v90
ds_read_b128 v[108:111], v91 offset:0
ds_read_b128 v[112:115], v91 offset:512
ds_read_b128 v[116:119], v91 offset:1024
ds_read_b128 v[120:123], v91 offset:1536
s_and_b32 s44, s2, 15
s_mul_i32 s44, s44, 14336
s_lshr_b32 s43, s2, 4
s_lshl_b32 s43, s43, 9
s_add_u32 s44, s44, s43
s_waitcnt lgkmcnt(0)
v_add_f32 v108, v108, v112
v_add_f32 v116, v116, v120
v_add_f32 v109, v109, v113
v_add_f32 v117, v117, v121
v_add_f32 v110, v110, v114
v_add_f32 v118, v118, v122
v_add_f32 v111, v111, v115
v_add_f32 v119, v119, v123
v_add_f32 v108, v108, v116
v_add_f32 v109, v109, v117
v_add_f32 v110, v110, v118
v_add_f32 v111, v111, v119
s_mov_b64 exec, 0xffffffff
buffer_store_dwordx4 v[108:111], v90, s[84:87], s44 offen sc1
s_mov_b64 exec, -1
Lw_109:
s_waitcnt lgkmcnt(0)
s_add_u32 s37, s35, 0
s_and_b32 s37, s37, 15
s_mul_i32 s37, s37, 16384
s_add_u32 m0, s39, 49152
s_nop 0
buffer_load_dwordx4 v3, s[8:11], s37 offen sc1 lds
s_load_dword s3, s[4:5], 1792
s_load_dword s3, s[4:5], 1856
s_load_dword s3, s[4:5], 1920
s_load_dword s3, s[4:5], 1984
s_load_dword s3, s[4:5], 2048
s_load_dword s3, s[4:5], 2112
s_load_dword s3, s[4:5], 2176
buffer_load_dwordx4 v3, s[8:11], s37 offen offset:1024 sc1 lds
s_load_dword s3, s[4:5], 2240
s_load_dword s3, s[4:5], 2304
s_load_dword s3, s[4:5], 2368
s_load_dword s3, s[4:5], 2432
s_load_dword s3, s[4:5], 2496
s_load_dword s3, s[4:5], 2560
s_load_dword s3, s[4:5], 2624
buffer_load_dwordx4 v3, s[8:11], s37 offen offset:2048 sc1 lds
v_mul_f32 v66, v57, v57
v_mul_f32 v64, 0xc0135761, v57
v_mul_f32 v65, 0xbdd2d3e8, v57
v_mul_f32 v65, v65, v66
v_rcp_f32 v66, v66
v_mul_f32 v70, v59, v59
v_mul_f32 v68, 0xc0135761, v59
buffer_load_dwordx4 v3, s[8:11], s37 offen offset:3072 sc1 lds
v_mul_f32 v69, 0xbdd2d3e8, v59
v_mul_f32 v69, v69, v70
v_rcp_f32 v70, v70
v_fma_f32 v128, -v56, v32, v128
v_fma_f32 v129, -v56, v33, v129
v_fma_f32 v130, -v56, v34, v130
v_fma_f32 v131, -v56, v35, v131
v_fma_f32 v152, -v58, v32, v152
s_add_u32 s38, s35, 0
s_and_b32 s38, s38, 15
s_mul_i32 s38, s38, 458752
s_add_u32 m0, s40, 49152
s_nop 0
buffer_load_dwordx4 v4, s[12:15], s38 offen lds
v_fma_f32 v153, -v58, v33, v153
v_fma_f32 v154, -v58, v34, v154
v_fma_f32 v155, -v58, v35, v155
v_mul_f32 v72, v128, v128
v_mul_f32 v73, v129, v129
v_mul_f32 v74, v130, v130
v_mul_f32 v75, v131, v131
s_add_u32 m0, s40, 50176
s_nop 0
buffer_load_dwordx4 v5, s[12:15], s38 offen lds
v_mul_f32 v76, v152, v152
v_mul_f32 v77, v153, v153
v_mul_f32 v78, v154, v154
v_mul_f32 v79, v155, v155
v_fma_f32 v72, v72, v65, v64
v_fma_f32 v73, v73, v65, v64
v_fma_f32 v74, v74, v65, v64
s_add_u32 m0, s40, 51200
s_add_u32 s38, s38, 57344
buffer_load_dwordx4 v4, s[12:15], s38 offen lds
v_fma_f32 v75, v75, v65, v64
v_fma_f32 v76, v76, v69, v68
v_fma_f32 v77, v77, v69, v68
v_fma_f32 v78, v78, v69, v68
v_fma_f32 v79, v79, v69, v68
v_mul_f32 v72, v72, v128
v_mul_f32 v73, v73, v129
v_mul_f32 v74, v74, v130
s_add_u32 m0, s40, 52224
s_nop 0
buffer_load_dwordx4 v5, s[12:15], s38 offen lds
v_mul_f32 v75, v75, v131
v_mul_f32 v76, v76, v152
v_mul_f32 v77, v77, v153
v_mul_f32 v78, v78, v154
v_mul_f32 v79, v79, v155
v_exp_f32 v72, v72
v_exp_f32 v73, v73
s_add_u32 m0, s40, 53248
s_add_u32 s38, s38, 57344
buffer_load_dwordx4 v4, s[12:15], s38 offen lds
v_exp_f32 v74, v74
v_exp_f32 v75, v75
v_exp_f32 v76, v76
v_exp_f32 v77, v77
v_exp_f32 v78, v78
v_exp_f32 v79, v79
v_fma_f32 v140, -v56, v44, v140
s_add_u32 m0, s40, 54272
s_nop 0
buffer_load_dwordx4 v5, s[12:15], s38 offen lds
v_fma_f32 v141, -v56, v45, v141
v_fma_f32 v142, -v56, v46, v142
v_fma_f32 v143, -v56, v47, v143
v_fma_f32 v164, -v58, v44, v164
v_fma_f32 v165, -v58, v45, v165
v_fma_f32 v166, -v58, v46, v166
v_fma_f32 v167, -v58, v47, v167
v_fma_f32 v72, v72, v66, v66
s_add_u32 m0, s40, 55296
s_add_u32 s38, s38, 57344
buffer_load_dwordx4 v4, s[12:15], s38 offen lds
s_add_u32 m0, s40, 56320
s_nop 0
buffer_load_dwordx4 v5, s[12:15], s38 offen lds
s_waitcnt vmcnt(12)
s_barrier
s_add_u32 s37, s35, 1
s_and_b32 s37, s37, 15
s_mul_i32 s37, s37, 16384
s_add_u32 m0, s39, 98304
s_nop 0
buffer_load_dwordx4 v3, s[8:11], s37 offen sc1 lds
v_fma_f32 v73, v73, v66, v66
v_fma_f32 v74, v74, v66, v66
v_fma_f32 v75, v75, v66, v66
v_fma_f32 v76, v76, v70, v70
v_fma_f32 v77, v77, v70, v70
v_fma_f32 v78, v78, v70, v70
buffer_load_dwordx4 v3, s[8:11], s37 offen offset:1024 sc1 lds
v_fma_f32 v79, v79, v70, v70
v_rcp_f32 v72, v72
v_rcp_f32 v73, v73
v_rcp_f32 v74, v74
v_rcp_f32 v75, v75
v_rcp_f32 v76, v76
buffer_load_dwordx4 v3, s[8:11], s37 offen offset:2048 sc1 lds
v_rcp_f32 v77, v77
v_rcp_f32 v78, v78
v_rcp_f32 v79, v79
v_mul_f32 v140, v128, v140
v_mul_f32 v141, v129, v141
v_mul_f32 v142, v130, v142
buffer_load_dwordx4 v3, s[8:11], s37 offen offset:3072 sc1 lds
v_mul_f32 v143, v131, v143
v_mul_f32 v164, v152, v164
v_mul_f32 v165, v153, v165
v_mul_f32 v166, v154, v166
v_mul_f32 v167, v155, v167
v_mul_f32 v140, v140, v72
s_add_u32 s38, s35, 1
s_and_b32 s38, s38, 15
s_mul_i32 s38, s38, 458752
s_add_u32 m0, s40, 98304
s_nop 0
buffer_load_dwordx4 v4, s[12:15], s38 offen lds
v_mul_f32 v141, v141, v73
v_mul_f32 v142, v142, v74
v_mul_f32 v143, v143, v75
v_mul_f32 v164, v164, v76
v_mul_f32 v165, v165, v77
v_mul_f32 v166, v166, v78
s_add_u32 m0, s40, 99328
s_nop 0
buffer_load_dwordx4 v5, s[12:15], s38 offen lds
v_mul_f32 v167, v167, v79
v_cvt_pk_bf16_f32 v128, v140, v141
v_cvt_pk_bf16_f32 v129, v142, v143
v_cvt_pk_bf16_f32 v152, v164, v165
v_cvt_pk_bf16_f32 v153, v166, v167
v_fma_f32 v132, -v56, v36, v132
s_add_u32 m0, s40, 100352
s_add_u32 s38, s38, 57344
buffer_load_dwordx4 v4, s[12:15], s38 offen lds
v_fma_f32 v133, -v56, v37, v133
v_fma_f32 v134, -v56, v38, v134
v_fma_f32 v135, -v56, v39, v135
v_fma_f32 v156, -v58, v36, v156
v_fma_f32 v157, -v58, v37, v157
v_fma_f32 v158, -v58, v38, v158
s_add_u32 m0, s40, 101376
s_nop 0
buffer_load_dwordx4 v5, s[12:15], s38 offen lds
v_fma_f32 v159, -v58, v39, v159
v_mul_f32 v72, v132, v132
v_mul_f32 v73, v133, v133
v_mul_f32 v74, v134, v134
v_mul_f32 v75, v135, v135
v_mul_f32 v76, v156, v156
s_add_u32 m0, s40, 102400
s_add_u32 s38, s38, 57344
buffer_load_dwordx4 v4, s[12:15], s38 offen lds
v_mul_f32 v77, v157, v157
v_mul_f32 v78, v158, v158
v_mul_f32 v79, v159, v159
v_fma_f32 v72, v72, v65, v64
v_fma_f32 v73, v73, v65, v64
v_fma_f32 v74, v74, v65, v64
s_add_u32 m0, s40, 103424
s_nop 0
buffer_load_dwordx4 v5, s[12:15], s38 offen lds
v_fma_f32 v75, v75, v65, v64
v_fma_f32 v76, v76, v69, v68
v_fma_f32 v77, v77, v69, v68
v_fma_f32 v78, v78, v69, v68
v_fma_f32 v79, v79, v69, v68
v_mul_f32 v72, v72, v132
s_add_u32 m0, s40, 104448
s_add_u32 s38, s38, 57344
buffer_load_dwordx4 v4, s[12:15], s38 offen lds
s_add_u32 m0, s40, 105472
s_nop 0
buffer_load_dwordx4 v5, s[12:15], s38 offen lds
s_waitcnt vmcnt(12)
s_barrier
s_cmp_eq_u32 s47, 3
s_cbranch_scc0 Lw_110
s_lshr_b32 s43, s2, 4
s_add_u32 s43, s43, 80
s_lshl_b32 s43, s43, 7
v_mov_b32 v90, s43
v_mov_b32 v91, 1
s_mov_b64 exec, 1
buffer_atomic_add v91, v90, s[56:59], 0 offen sc1
s_mov_b64 exec, -1
Lw_110:
s_waitcnt lgkmcnt(0)
s_add_u32 s37, s35, 2
s_and_b32 s37, s37, 15
s_mul_i32 s37, s37, 16384
s_add_u32 m0, s39, 0
s_nop 0
buffer_load_dwordx4 v3, s[8:11], s37 offen sc1 lds
s_load_dword s3, s[4:5], 2688
s_load_dword s3, s[4:5], 2752
s_load_dword s3, s[4:5], 2816
s_load_dword s3, s[4:5], 2880
s_load_dword s3, s[4:5], 2944
s_load_dword s3, s[4:5], 3008
s_load_dword s3, s[4:5], 3072
buffer_load_dwordx4 v3, s[8:11], s37 offen offset:1024 sc1 lds
s_load_dword s3, s[4:5], 3136
s_load_dword s3, s[4:5], 3200
s_load_dword s3, s[4:5], 3264
s_load_dword s3, s[4:5], 3328
s_load_dword s3, s[4:5], 3392
s_load_dword s3, s[4:5], 3456
s_load_dword s3, s[4:5], 3520
buffer_load_dwordx4 v3, s[8:11], s37 offen offset:2048 sc1 lds
v_mul_f32 v73, v73, v133
v_mul_f32 v74, v74, v134
v_mul_f32 v75, v75, v135
v_mul_f32 v76, v76, v156
v_mul_f32 v77, v77, v157
v_mul_f32 v78, v78, v158
v_mul_f32 v79, v79, v159
v_exp_f32 v72, v72
buffer_load_dwordx4 v3, s[8:11], s37 offen offset:3072 sc1 lds
v_exp_f32 v73, v73
v_exp_f32 v74, v74
v_exp_f32 v75, v75
v_exp_f32 v76, v76
v_exp_f32 v77, v77
v_exp_f32 v78, v78
v_exp_f32 v79, v79
s_add_u32 s38, s35, 2
s_and_b32 s38, s38, 15
s_mul_i32 s38, s38, 458752
s_add_u32 m0, s40, 0
s_nop 0
buffer_load_dwordx4 v4, s[12:15], s38 offen lds
v_fma_f32 v144, -v56, v48, v144
v_fma_f32 v145, -v56, v49, v145
v_fma_f32 v146, -v56, v50, v146
v_fma_f32 v147, -v56, v51, v147
v_fma_f32 v168, -v58, v48, v168
v_fma_f32 v169, -v58, v49, v169
v_fma_f32 v170, -v58, v50, v170
v_fma_f32 v171, -v58, v51, v171
s_add_u32 m0, s40, 1024
s_nop 0
buffer_load_dwordx4 v5, s[12:15], s38 offen lds
v_fma_f32 v72, v72, v66, v66
v_fma_f32 v73, v73, v66, v66
v_fma_f32 v74, v74, v66, v66
v_fma_f32 v75, v75, v66, v66
v_fma_f32 v76, v76, v70, v70
v_fma_f32 v77, v77, v70, v70
v_fma_f32 v78, v78, v70, v70
s_add_u32 m0, s40, 2048
s_add_u32 s38, s38, 57344
buffer_load_dwordx4 v4, s[12:15], s38 offen lds
v_fma_f32 v79, v79, v70, v70
v_rcp_f32 v72, v72
v_rcp_f32 v73, v73
v_rcp_f32 v74, v74
v_rcp_f32 v75, v75
v_rcp_f32 v76, v76
v_rcp_f32 v77, v77
s_add_u32 m0, s40, 3072
s_nop 0
buffer_load_dwordx4 v5, s[12:15], s38 offen lds
v_rcp_f32 v78, v78
v_rcp_f32 v79, v79
v_mul_f32 v144, v132, v144
v_mul_f32 v145, v133, v145
v_mul_f32 v146, v134, v146
v_mul_f32 v147, v135, v147
v_mul_f32 v168, v156, v168
v_mul_f32 v169, v157, v169
s_add_u32 m0, s40, 4096
s_add_u32 s38, s38, 57344
buffer_load_dwordx4 v4, s[12:15], s38 offen lds
v_mul_f32 v170, v158, v170
v_mul_f32 v171, v159, v171
v_mul_f32 v144, v144, v72
v_mul_f32 v145, v145, v73
v_mul_f32 v146, v146, v74
v_mul_f32 v147, v147, v75
v_mul_f32 v168, v168, v76
s_add_u32 m0, s40, 5120
s_nop 0
buffer_load_dwordx4 v5, s[12:15], s38 offen lds
v_mul_f32 v169, v169, v77
v_mul_f32 v170, v170, v78
v_mul_f32 v171, v171, v79
v_cvt_pk_bf16_f32 v130, v144, v145
v_cvt_pk_bf16_f32 v131, v146, v147
v_cvt_pk_bf16_f32 v154, v168, v169
v_cvt_pk_bf16_f32 v155, v170, v171
buffer_store_dwordx4 v[128:131], v2, s[24:27], s54 offen offset:0 sc1
s_add_u32 m0, s40, 6144
s_add_u32 s38, s38, 57344
buffer_load_dwordx4 v4, s[12:15], s38 offen lds
s_add_u32 m0, s40, 7168
s_nop 0
buffer_load_dwordx4 v5, s[12:15], s38 offen lds
s_waitcnt vmcnt(13)
s_barrier
s_add_u32 s37, s35, 3
s_and_b32 s37, s37, 15
s_mul_i32 s37, s37, 16384
s_add_u32 m0, s39, 49152
s_nop 0
buffer_load_dwordx4 v3, s[8:11], s37 offen sc1 lds
buffer_store_dwordx4 v[152:155], v2, s[24:27], s54 offen offset:1024 sc1
v_fma_f32 v136, -v56, v40, v136
v_fma_f32 v137, -v56, v41, v137
v_fma_f32 v138, -v56, v42, v138
v_fma_f32 v139, -v56, v43, v139
v_fma_f32 v160, -v58, v40, v160
buffer_load_dwordx4 v3, s[8:11], s37 offen offset:1024 sc1 lds
v_fma_f32 v161, -v58, v41, v161
v_fma_f32 v162, -v58, v42, v162
v_fma_f32 v163, -v58, v43, v163
v_mul_f32 v72, v136, v136
v_mul_f32 v73, v137, v137
v_mul_f32 v74, v138, v138
buffer_load_dwordx4 v3, s[8:11], s37 offen offset:2048 sc1 lds
v_mul_f32 v75, v139, v139
v_mul_f32 v76, v160, v160
v_mul_f32 v77, v161, v161
v_mul_f32 v78, v162, v162
v_mul_f32 v79, v163, v163
v_fma_f32 v72, v72, v65, v64
buffer_load_dwordx4 v3, s[8:11], s37 offen offset:3072 sc1 lds
v_fma_f32 v73, v73, v65, v64
v_fma_f32 v74, v74, v65, v64
v_fma_f32 v75, v75, v65, v64
v_fma_f32 v76, v76, v69, v68
v_fma_f32 v77, v77, v69, v68
v_fma_f32 v78, v78, v69, v68
s_add_u32 s38, s35, 3
s_and_b32 s38, s38, 15
s_mul_i32 s38, s38, 458752
s_add_u32 m0, s40, 49152
s_nop 0
buffer_load_dwordx4 v4, s[12:15], s38 offen lds
v_fma_f32 v79, v79, v69, v68
v_mul_f32 v72, v72, v136
v_mul_f32 v73, v73, v137
v_mul_f32 v74, v74, v138
v_mul_f32 v75, v75, v139
v_mul_f32 v76, v76, v160
s_add_u32 m0, s40, 50176
s_nop 0
buffer_load_dwordx4 v5, s[12:15], s38 offen lds
v_mul_f32 v77, v77, v161
v_mul_f32 v78, v78, v162
v_mul_f32 v79, v79, v163
v_exp_f32 v72, v72
v_exp_f32 v73, v73
v_exp_f32 v74, v74
s_add_u32 m0, s40, 51200
s_add_u32 s38, s38, 57344
buffer_load_dwordx4 v4, s[12:15], s38 offen lds
v_exp_f32 v75, v75
v_exp_f32 v76, v76
v_exp_f32 v77, v77
v_exp_f32 v78, v78
v_exp_f32 v79, v79
v_fma_f32 v148, -v56, v52, v148
s_add_u32 m0, s40, 52224
s_nop 0
buffer_load_dwordx4 v5, s[12:15], s38 offen lds
v_fma_f32 v149, -v56, v53, v149
v_fma_f32 v150, -v56, v54, v150
v_fma_f32 v151, -v56, v55, v151
v_fma_f32 v172, -v58, v52, v172
v_fma_f32 v173, -v58, v53, v173
v_fma_f32 v174, -v58, v54, v174
s_add_u32 m0, s40, 53248
s_add_u32 s38, s38, 57344
buffer_load_dwordx4 v4, s[12:15], s38 offen lds
v_fma_f32 v175, -v58, v55, v175
v_fma_f32 v72, v72, v66, v66
v_fma_f32 v73, v73, v66, v66
v_fma_f32 v74, v74, v66, v66
v_fma_f32 v75, v75, v66, v66
v_fma_f32 v76, v76, v70, v70
s_add_u32 m0, s40, 54272
s_nop 0
buffer_load_dwordx4 v5, s[12:15], s38 offen lds
v_fma_f32 v77, v77, v70, v70
v_fma_f32 v78, v78, v70, v70
v_fma_f32 v79, v79, v70, v70
v_rcp_f32 v72, v72
v_rcp_f32 v73, v73
v_rcp_f32 v74, v74
s_add_u32 m0, s40, 55296
s_add_u32 s38, s38, 57344
buffer_load_dwordx4 v4, s[12:15], s38 offen lds
s_add_u32 m0, s40, 56320
s_nop 0
buffer_load_dwordx4 v5, s[12:15], s38 offen lds
s_waitcnt vmcnt(13)
s_barrier
s_waitcnt lgkmcnt(0)
s_add_u32 s37, s35, 4
s_and_b32 s37, s37, 15
s_mul_i32 s37, s37, 16384
s_add_u32 m0, s39, 98304
s_nop 0
buffer_load_dwordx4 v3, s[8:11], s37 offen sc1 lds
s_load_dword s3, s[4:5], 3584
s_load_dword s3, s[4:5], 3648
s_load_dword s3, s[4:5], 3712
s_load_dword s3, s[4:5], 3776
s_load_dword s3, s[4:5], 3840
s_load_dword s3, s[4:5], 3904
s_load_dword s3, s[4:5], 3968
buffer_load_dwordx4 v3, s[8:11], s37 offen offset:1024 sc1 lds
s_load_dword s3, s[4:5], 4032
s_load_dword s3, s[4:5], 4096
s_load_dword s3, s[4:5], 4160
s_load_dword s3, s[4:5], 4224
s_load_dword s3, s[4:5], 4288
s_load_dword s3, s[4:5], 4352
s_load_dword s3, s[4:5], 4416
buffer_load_dwordx4 v3, s[8:11], s37 offen offset:2048 sc1 lds
v_rcp_f32 v75, v75
v_rcp_f32 v76, v76
v_rcp_f32 v77, v77
v_rcp_f32 v78, v78
v_rcp_f32 v79, v79
v_mul_f32 v148, v136, v148
v_mul_f32 v149, v137, v149
buffer_load_dwordx4 v3, s[8:11], s37 offen offset:3072 sc1 lds
v_mul_f32 v150, v138, v150
v_mul_f32 v151, v139, v151
v_mul_f32 v172, v160, v172
v_mul_f32 v173, v161, v173
v_mul_f32 v174, v162, v174
v_mul_f32 v175, v163, v175
v_mul_f32 v148, v148, v72
v_mul_f32 v149, v149, v73
s_add_u32 s38, s35, 4
s_and_b32 s38, s38, 15
s_mul_i32 s38, s38, 458752
s_add_u32 m0, s40, 98304
s_nop 0
buffer_load_dwordx4 v4, s[12:15], s38 offen lds
v_mul_f32 v150, v150, v74
v_mul_f32 v151, v151, v75
v_mul_f32 v172, v172, v76
v_mul_f32 v173, v173, v77
v_mul_f32 v174, v174, v78
v_mul_f32 v175, v175, v79
v_cvt_pk_bf16_f32 v80, v148, v149
s_add_u32 m0, s40, 99328
s_nop 0
buffer_load_dwordx4 v5, s[12:15], s38 offen lds
v_cvt_pk_bf16_f32 v81, v150, v151
v_cvt_pk_bf16_f32 v82, v172, v173
v_cvt_pk_bf16_f32 v83, v174, v175
s_nop 1
v_permlane32_swap_b32 v80, v82
v_permlane32_swap_b32 v81, v83
buffer_store_dwordx4 v[80:83], v84, s[24:27], s55 offen offset:0 sc1
s_add_u32 m0, s40, 100352
s_add_u32 s38, s38, 57344
buffer_load_dwordx4 v4, s[12:15], s38 offen lds
s_nop 1
v_mul_f32 v66, v61, v61
v_mul_f32 v64, 0xc0135761, v61
v_mul_f32 v65, 0xbdd2d3e8, v61
v_mul_f32 v65, v65, v66
v_rcp_f32 v66, v66
v_mul_f32 v70, v63, v63
s_branch Lov_9
.p2align 12
.fill 64, 4, 0xbf800000
Lst_9_0:
s_branch Lwr_150
Lst_9_1:
s_branch Lwr_165
s_nop 0
Lov_9:
v_mul_f32 v68, 0xc0135761, v63
s_add_u32 m0, s40, 101376
s_nop 0
buffer_load_dwordx4 v5, s[12:15], s38 offen lds
v_mul_f32 v69, 0xbdd2d3e8, v63
v_mul_f32 v69, v69, v70
v_rcp_f32 v70, v70
v_fma_f32 v176, -v60, v32, v176
v_fma_f32 v177, -v60, v33, v177
v_fma_f32 v178, -v60, v34, v178
v_fma_f32 v179, -v60, v35, v179
s_add_u32 m0, s40, 102400
s_add_u32 s38, s38, 57344
buffer_load_dwordx4 v4, s[12:15], s38 offen lds
v_fma_f32 v200, -v62, v32, v200
v_fma_f32 v201, -v62, v33, v201
v_fma_f32 v202, -v62, v34, v202
v_fma_f32 v203, -v62, v35, v203
v_mul_f32 v72, v176, v176
v_mul_f32 v73, v177, v177
v_mul_f32 v74, v178, v178
s_add_u32 m0, s40, 103424
s_nop 0
buffer_load_dwordx4 v5, s[12:15], s38 offen lds
v_mul_f32 v75, v179, v179
v_mul_f32 v76, v200, v200
v_mul_f32 v77, v201, v201
v_mul_f32 v78, v202, v202
v_mul_f32 v79, v203, v203
v_fma_f32 v72, v72, v65, v64
v_fma_f32 v73, v73, v65, v64
v_fma_f32 v74, v74, v65, v64
s_add_u32 m0, s40, 104448
s_add_u32 s38, s38, 57344
buffer_load_dwordx4 v4, s[12:15], s38 offen lds
s_add_u32 m0, s40, 105472
s_nop 0
buffer_load_dwordx4 v5, s[12:15], s38 offen lds
s_waitcnt vmcnt(13)
s_barrier
s_add_u32 s37, s35, 5
s_and_b32 s37, s37, 15
s_mul_i32 s37, s37, 16384
s_add_u32 m0, s39, 0
s_nop 0
buffer_load_dwordx4 v3, s[8:11], s37 offen sc1 lds
v_fma_f32 v75, v75, v65, v64
v_fma_f32 v76, v76, v69, v68
v_fma_f32 v77, v77, v69, v68
v_fma_f32 v78, v78, v69, v68
v_fma_f32 v79, v79, v69, v68
v_mul_f32 v72, v72, v176
buffer_load_dwordx4 v3, s[8:11], s37 offen offset:1024 sc1 lds
v_mul_f32 v73, v73, v177
v_mul_f32 v74, v74, v178
v_mul_f32 v75, v75, v179
v_mul_f32 v76, v76, v200
v_mul_f32 v77, v77, v201
v_mul_f32 v78, v78, v202
buffer_load_dwordx4 v3, s[8:11], s37 offen offset:2048 sc1 lds
v_mul_f32 v79, v79, v203
v_exp_f32 v72, v72
v_exp_f32 v73, v73
v_exp_f32 v74, v74
v_exp_f32 v75, v75
v_exp_f32 v76, v76
buffer_load_dwordx4 v3, s[8:11], s37 offen offset:3072 sc1 lds
v_exp_f32 v77, v77
v_exp_f32 v78, v78
v_exp_f32 v79, v79
v_fma_f32 v188, -v60, v44, v188
v_fma_f32 v189, -v60, v45, v189
v_fma_f32 v190, -v60, v46, v190
s_add_u32 s38, s35, 5
s_and_b32 s38, s38, 15
s_mul_i32 s38, s38, 458752
s_add_u32 m0, s40, 0
s_nop 0
buffer_load_dwordx4 v4, s[12:15], s38 offen lds
v_fma_f32 v191, -v60, v47, v191
v_fma_f32 v212, -v62, v44, v212
v_fma_f32 v213, -v62, v45, v213
v_fma_f32 v214, -v62, v46, v214
v_fma_f32 v215, -v62, v47, v215
v_fma_f32 v72, v72, v66, v66
s_add_u32 m0, s40, 1024
s_nop 0
buffer_load_dwordx4 v5, s[12:15], s38 offen lds
v_fma_f32 v73, v73, v66, v66
v_fma_f32 v74, v74, v66, v66
v_fma_f32 v75, v75, v66, v66
v_fma_f32 v76, v76, v70, v70
v_fma_f32 v77, v77, v70, v70
v_fma_f32 v78, v78, v70, v70
s_add_u32 m0, s40, 2048
s_add_u32 s38, s38, 57344
buffer_load_dwordx4 v4, s[12:15], s38 offen lds
v_fma_f32 v79, v79, v70, v70
v_rcp_f32 v72, v72
v_rcp_f32 v73, v73
v_rcp_f32 v74, v74
v_rcp_f32 v75, v75
v_rcp_f32 v76, v76
s_add_u32 m0, s40, 3072
s_nop 0
buffer_load_dwordx4 v5, s[12:15], s38 offen lds
v_rcp_f32 v77, v77
v_rcp_f32 v78, v78
v_rcp_f32 v79, v79
v_mul_f32 v188, v176, v188
v_mul_f32 v189, v177, v189
v_mul_f32 v190, v178, v190
s_add_u32 m0, s40, 4096
s_add_u32 s38, s38, 57344
buffer_load_dwordx4 v4, s[12:15], s38 offen lds
v_mul_f32 v191, v179, v191
v_mul_f32 v212, v200, v212
v_mul_f32 v213, v201, v213
v_mul_f32 v214, v202, v214
v_mul_f32 v215, v203, v215
v_mul_f32 v188, v188, v72
s_add_u32 m0, s40, 5120
s_nop 0
buffer_load_dwordx4 v5, s[12:15], s38 offen lds
v_mul_f32 v189, v189, v73
v_mul_f32 v190, v190, v74
v_mul_f32 v191, v191, v75
v_mul_f32 v212, v212, v76
v_mul_f32 v213, v213, v77
v_mul_f32 v214, v214, v78
s_add_u32 m0, s40, 6144
s_add_u32 s38, s38, 57344
buffer_load_dwordx4 v4, s[12:15], s38 offen lds
s_add_u32 m0, s40, 7168
s_nop 0
buffer_load_dwordx4 v5, s[12:15], s38 offen lds
s_waitcnt vmcnt(12)
s_barrier
s_waitcnt lgkmcnt(0)
s_cmp_eq_u32 s47, 3
s_cbranch_scc0 Lw_111
s_lshl_b32 s60, s35, 7
s_add_u32 s60, s60, 28321792
s_mov_b32 s61, s60
s_load_dword s92, s[82:83], s60 glc
s_load_dword s93, s[82:83], s61 glc
Lw_111:
s_add_u32 s37, s35, 6
s_and_b32 s37, s37, 15
s_mul_i32 s37, s37, 16384
s_add_u32 m0, s39, 49152
s_nop 0
buffer_load_dwordx4 v3, s[8:11], s37 offen sc1 lds
s_load_dword s3, s[4:5], 4480
s_load_dword s3, s[4:5], 4544
s_load_dword s3, s[4:5], 4608
s_load_dword s3, s[4:5], 4672
s_load_dword s3, s[4:5], 4736
s_load_dword s3, s[4:5], 4800
s_load_dword s3, s[4:5], 4864
buffer_load_dwordx4 v3, s[8:11], s37 offen offset:1024 sc1 lds
s_load_dword s3, s[4:5], 4928
s_load_dword s3, s[4:5], 4992
s_load_dword s3, s[4:5], 5056
s_load_dword s3, s[4:5], 5120
s_load_dword s3, s[4:5], 5184
s_load_dword s3, s[4:5], 5248
s_load_dword s3, s[4:5], 5312
buffer_load_dwordx4 v3, s[8:11], s37 offen offset:2048 sc1 lds
v_mul_f32 v215, v215, v79
v_cvt_pk_bf16_f32 v176, v188, v189
v_cvt_pk_bf16_f32 v177, v190, v191
v_cvt_pk_bf16_f32 v200, v212, v213
v_cvt_pk_bf16_f32 v201, v214, v215
v_fma_f32 v180, -v60, v36, v180
v_fma_f32 v181, -v60, v37, v181
v_fma_f32 v182, -v60, v38, v182
buffer_load_dwordx4 v3, s[8:11], s37 offen offset:3072 sc1 lds
v_fma_f32 v183, -v60, v39, v183
v_fma_f32 v204, -v62, v36, v204
v_fma_f32 v205, -v62, v37, v205
v_fma_f32 v206, -v62, v38, v206
v_fma_f32 v207, -v62, v39, v207
v_mul_f32 v72, v180, v180
v_mul_f32 v73, v181, v181
s_add_u32 s38, s35, 6
s_and_b32 s38, s38, 15
s_mul_i32 s38, s38, 458752
s_add_u32 m0, s40, 49152
s_nop 0
buffer_load_dwordx4 v4, s[12:15], s38 offen lds
v_mul_f32 v74, v182, v182
v_mul_f32 v75, v183, v183
v_mul_f32 v76, v204, v204
v_mul_f32 v77, v205, v205
v_mul_f32 v78, v206, v206
v_mul_f32 v79, v207, v207
v_fma_f32 v72, v72, v65, v64
v_fma_f32 v73, v73, v65, v64
s_add_u32 m0, s40, 50176
s_nop 0
buffer_load_dwordx4 v5, s[12:15], s38 offen lds
v_fma_f32 v74, v74, v65, v64
v_fma_f32 v75, v75, v65, v64
v_fma_f32 v76, v76, v69, v68
v_fma_f32 v77, v77, v69, v68
v_fma_f32 v78, v78, v69, v68
v_fma_f32 v79, v79, v69, v68
v_mul_f32 v72, v72, v180
s_add_u32 m0, s40, 51200
s_add_u32 s38, s38, 57344
buffer_load_dwordx4 v4, s[12:15], s38 offen lds
v_mul_f32 v73, v73, v181
v_mul_f32 v74, v74, v182
v_mul_f32 v75, v75, v183
v_mul_f32 v76, v76, v204
v_mul_f32 v77, v77, v205
v_mul_f32 v78, v78, v206
v_mul_f32 v79, v79, v207
s_add_u32 m0, s40, 52224
s_nop 0
buffer_load_dwordx4 v5, s[12:15], s38 offen lds
v_exp_f32 v72, v72
v_exp_f32 v73, v73
v_exp_f32 v74, v74
v_exp_f32 v75, v75
v_exp_f32 v76, v76
v_exp_f32 v77, v77
v_exp_f32 v78, v78
v_exp_f32 v79, v79
s_add_u32 m0, s40, 53248
s_add_u32 s38, s38, 57344
buffer_load_dwordx4 v4, s[12:15], s38 offen lds
v_fma_f32 v192, -v60, v48, v192
v_fma_f32 v193, -v60, v49, v193
v_fma_f32 v194, -v60, v50, v194
v_fma_f32 v195, -v60, v51, v195
v_fma_f32 v216, -v62, v48, v216
v_fma_f32 v217, -v62, v49, v217
v_fma_f32 v218, -v62, v50, v218
s_add_u32 m0, s40, 54272
s_nop 0
buffer_load_dwordx4 v5, s[12:15], s38 offen lds
v_fma_f32 v219, -v62, v51, v219
v_fma_f32 v72, v72, v66, v66
v_fma_f32 v73, v73, v66, v66
v_fma_f32 v74, v74, v66, v66
v_fma_f32 v75, v75, v66, v66
v_fma_f32 v76, v76, v70, v70
v_fma_f32 v77, v77, v70, v70
v_fma_f32 v78, v78, v70, v70
s_add_u32 m0, s40, 55296
s_add_u32 s38, s38, 57344
buffer_load_dwordx4 v4, s[12:15], s38 offen lds
s_add_u32 m0, s40, 56320
s_nop 0
buffer_load_dwordx4 v5, s[12:15], s38 offen lds
s_waitcnt vmcnt(12)
s_barrier
s_add_u32 s37, s35, 7
s_and_b32 s37, s37, 15
s_mul_i32 s37, s37, 16384
s_add_u32 m0, s39, 98304
s_nop 0
buffer_load_dwordx4 v3, s[8:11], s37 offen sc1 lds
v_fma_f32 v79, v79, v70, v70
v_rcp_f32 v72, v72
v_rcp_f32 v73, v73
v_rcp_f32 v74, v74
v_rcp_f32 v75, v75
v_rcp_f32 v76, v76
buffer_load_dwordx4 v3, s[8:11], s37 offen offset:1024 sc1 lds
v_rcp_f32 v77, v77
v_rcp_f32 v78, v78
v_rcp_f32 v79, v79
v_mul_f32 v192, v180, v192
v_mul_f32 v193, v181, v193
v_mul_f32 v194, v182, v194
buffer_load_dwordx4 v3, s[8:11], s37 offen offset:2048 sc1 lds
v_mul_f32 v195, v183, v195
v_mul_f32 v216, v204, v216
v_mul_f32 v217, v205, v217
v_mul_f32 v218, v206, v218
v_mul_f32 v219, v207, v219
v_mul_f32 v192, v192, v72
buffer_load_dwordx4 v3, s[8:11], s37 offen offset:3072 sc1 lds
v_mul_f32 v193, v193, v73
v_mul_f32 v194, v194, v74
v_mul_f32 v195, v195, v75
v_mul_f32 v216, v216, v76
v_mul_f32 v217, v217, v77
v_mul_f32 v218, v218, v78
s_add_u32 s38, s35, 7
s_and_b32 s38, s38, 15
s_mul_i32 s38, s38, 458752
s_add_u32 m0, s40, 98304
s_nop 0
buffer_load_dwordx4 v4, s[12:15], s38 offen lds
v_mul_f32 v219, v219, v79
v_cvt_pk_bf16_f32 v178, v192, v193
v_cvt_pk_bf16_f32 v179, v194, v195
v_cvt_pk_bf16_f32 v202, v216, v217
v_cvt_pk_bf16_f32 v203, v218, v219
buffer_store_dwordx4 v[176:179], v2, s[24:27], s54 offen offset:2048 sc1
s_add_u32 m0, s40, 99328
s_nop 0
buffer_load_dwordx4 v5, s[12:15], s38 offen lds
buffer_store_dwordx4 v[200:203], v2, s[24:27], s54 offen offset:3072 sc1
v_fma_f32 v184, -v60, v40, v184
v_fma_f32 v185, -v60, v41, v185
v_fma_f32 v186, -v60, v42, v186
v_fma_f32 v187, -v60, v43, v187
v_fma_f32 v208, -v62, v40, v208
s_add_u32 m0, s40, 100352
s_add_u32 s38, s38, 57344
buffer_load_dwordx4 v4, s[12:15], s38 offen lds
v_fma_f32 v209, -v62, v41, v209
v_fma_f32 v210, -v62, v42, v210
v_fma_f32 v211, -v62, v43, v211
v_mul_f32 v72, v184, v184
v_mul_f32 v73, v185, v185
v_mul_f32 v74, v186, v186
s_add_u32 m0, s40, 101376
s_nop 0
buffer_load_dwordx4 v5, s[12:15], s38 offen lds
v_mul_f32 v75, v187, v187
v_mul_f32 v76, v208, v208
v_mul_f32 v77, v209, v209
v_mul_f32 v78, v210, v210
v_mul_f32 v79, v211, v211
v_fma_f32 v72, v72, v65, v64
s_add_u32 m0, s40, 102400
s_add_u32 s38, s38, 57344
buffer_load_dwordx4 v4, s[12:15], s38 offen lds
v_fma_f32 v73, v73, v65, v64
v_fma_f32 v74, v74, v65, v64
v_fma_f32 v75, v75, v65, v64
v_fma_f32 v76, v76, v69, v68
v_fma_f32 v77, v77, v69, v68
v_fma_f32 v78, v78, v69, v68
s_add_u32 m0, s40, 103424
s_nop 0
buffer_load_dwordx4 v5, s[12:15], s38 offen lds
v_fma_f32 v79, v79, v69, v68
v_mul_f32 v72, v72, v184
v_mul_f32 v73, v73, v185
v_mul_f32 v74, v74, v186
v_mul_f32 v75, v75, v187
v_mul_f32 v76, v76, v208
s_add_u32 m0, s40, 104448
s_add_u32 s38, s38, 57344
buffer_load_dwordx4 v4, s[12:15], s38 offen lds
s_add_u32 m0, s40, 105472
s_nop 0
buffer_load_dwordx4 v5, s[12:15], s38 offen lds
s_waitcnt vmcnt(14)
s_cmp_eq_u32 s47, 3
s_cbranch_scc0 Lw_112
s_mov_b32 s41, 0x40000
Lcp_113:
s_waitcnt lgkmcnt(0)
s_and_b32 s92, s92, s93
s_cmp_eq_u32 s92, 16
s_cbranch_scc1 Lco_114
s_load_dword s92, s[82:83], s60 glc
s_load_dword s93, s[82:83], s61 glc
s_sub_u32 s41, s41, 1
s_cmp_lg_u32 s41, 0
s_cbranch_scc1 Lcp_113
s_waitcnt lgkmcnt(0)
Lco_114:
Lw_112:
s_barrier
s_lshl_b32 s60, s35, 9
s_lshl_b32 s43, s47, 7
s_add_u32 s60, s60, s43
s_add_u32 s61, s60, 14336
s_add_u32 s52, s43, 148480
s_add_u32 s53, s52, 896
v_lshrrev_b32 v104, 3, v1
v_mul_u32_u24 v104, 28672, v104
v_and_b32 v105, 7, v1
v_lshl_add_u32 v104, v105, 4, v104
s_waitcnt lgkmcnt(0)
buffer_load_dwordx4 v[96:99], v104, s[84:87], s60 offen sc1
s_load_dword s3, s[4:5], 5376
s_load_dword s3, s[4:5], 5440
s_load_dword s3, s[4:5], 5504
s_load_dword s3, s[4:5], 5568
s_load_dword s3, s[4:5], 5632
s_load_dword s3, s[4:5], 5696
buffer_load_dwordx4 v[100:103], v104, s[84:87], s61 offen sc1
s_load_dword s3, s[4:5], 5760
s_load_dword s3, s[4:5], 5824
s_load_dword s3, s[4:5], 5888
s_load_dword s3, s[4:5], 5952
s_load_dword s3, s[4:5], 6016
s_load_dword s3, s[4:5], 6080
s_load_dword s3, s[4:5], 6144
s_add_u32 s37, s35, 8
s_and_b32 s37, s37, 15
s_mul_i32 s37, s37, 16384
s_add_u32 m0, s39, 0
s_nop 0
buffer_load_dwordx4 v3, s[8:11], s37 offen sc1 lds
s_load_dword s3, s[4:5], 6208
v_mul_f32 v77, v77, v209
v_mul_f32 v78, v78, v210
v_mul_f32 v79, v79, v211
v_exp_f32 v72, v72
v_exp_f32 v73, v73
v_exp_f32 v74, v74
buffer_load_dwordx4 v3, s[8:11], s37 offen offset:1024 sc1 lds
v_exp_f32 v75, v75
v_exp_f32 v76, v76
v_exp_f32 v77, v77
v_exp_f32 v78, v78
v_exp_f32 v79, v79
v_fma_f32 v196, -v60, v52, v196
v_fma_f32 v197, -v60, v53, v197
buffer_load_dwordx4 v3, s[8:11], s37 offen offset:2048 sc1 lds
v_fma_f32 v198, -v60, v54, v198
v_fma_f32 v199, -v60, v55, v199
v_fma_f32 v220, -v62, v52, v220
v_fma_f32 v221, -v62, v53, v221
v_fma_f32 v222, -v62, v54, v222
v_fma_f32 v223, -v62, v55, v223
buffer_load_dwordx4 v3, s[8:11], s37 offen offset:3072 sc1 lds
v_fma_f32 v72, v72, v66, v66
v_fma_f32 v73, v73, v66, v66
v_fma_f32 v74, v74, v66, v66
v_fma_f32 v75, v75, v66, v66
v_fma_f32 v76, v76, v70, v70
v_fma_f32 v77, v77, v70, v70
v_fma_f32 v78, v78, v70, v70
s_add_u32 s38, s35, 8
s_and_b32 s38, s38, 15
s_mul_i32 s38, s38, 458752
s_add_u32 m0, s40, 0
s_nop 0
buffer_load_dwordx4 v4, s[12:15], s38 offen lds
v_fma_f32 v79, v79, v70, v70
v_rcp_f32 v72, v72
v_rcp_f32 v73, v73
v_rcp_f32 v74, v74
v_rcp_f32 v75, v75
v_rcp_f32 v76, v76
v_rcp_f32 v77, v77
s_add_u32 m0, s40, 1024
s_nop 0
buffer_load_dwordx4 v5, s[12:15], s38 offen lds
v_rcp_f32 v78, v78
v_rcp_f32 v79, v79
v_mul_f32 v196, v184, v196
v_mul_f32 v197, v185, v197
v_mul_f32 v198, v186, v198
v_mul_f32 v199, v187, v199
v_mul_f32 v220, v208, v220
s_add_u32 m0, s40, 2048
s_add_u32 s38, s38, 57344
buffer_load_dwordx4 v4, s[12:15], s38 offen lds
v_mul_f32 v221, v209, v221
v_mul_f32 v222, v210, v222
v_mul_f32 v223, v211, v223
v_mul_f32 v196, v196, v72
v_mul_f32 v197, v197, v73
v_mul_f32 v198, v198, v74
s_add_u32 m0, s40, 3072
s_nop 0
buffer_load_dwordx4 v5, s[12:15], s38 offen lds
v_mul_f32 v199, v199, v75
v_mul_f32 v220, v220, v76
v_mul_f32 v221, v221, v77
v_mul_f32 v222, v222, v78
v_mul_f32 v223, v223, v79
v_cvt_pk_bf16_f32 v80, v196, v197
v_cvt_pk_bf16_f32 v81, v198, v199
s_add_u32 m0, s40, 4096
s_add_u32 s38, s38, 57344
buffer_load_dwordx4 v4, s[12:15], s38 offen lds
v_cvt_pk_bf16_f32 v82, v220, v221
v_cvt_pk_bf16_f32 v83, v222, v223
s_nop 1
v_permlane32_swap_b32 v80, v82
v_permlane32_swap_b32 v81, v83
buffer_store_dwordx4 v[80:83], v84, s[24:27], s55 offen offset:2048 sc1
s_nop 1
s_add_u32 m0, s40, 5120
s_nop 0
buffer_load_dwordx4 v5, s[12:15], s38 offen lds
v_cmp_gt_u32 vcc, 32, v1
v_mov_b32 v104, s52
v_mov_b32 v106, s53
v_cndmask_b32 v104, v106, v104, vcc
v_lshl_add_u32 v104, v105, 4, v104
v_bfe_u32 v105, v1, 4, 1
v_lshl_add_u32 v104, v105, 2, v104
s_add_u32 m0, s40, 6144
s_add_u32 s38, s38, 57344
buffer_load_dwordx4 v4, s[12:15], s38 offen lds
s_add_u32 m0, s40, 7168
s_nop 0
buffer_load_dwordx4 v5, s[12:15], s38 offen lds
s_waitcnt vmcnt(15)
s_barrier
s_add_u32 s37, s35, 9
s_and_b32 s37, s37, 15
s_mul_i32 s37, s37, 16384
s_add_u32 m0, s39, 49152
s_nop 0
buffer_load_dwordx4 v3, s[8:11], s37 offen sc1 lds
buffer_load_dwordx4 v3, s[8:11], s37 offen offset:1024 sc1 lds
buffer_load_dwordx4 v3, s[8:11], s37 offen offset:2048 sc1 lds
buffer_load_dwordx4 v3, s[8:11], s37 offen offset:3072 sc1 lds
s_add_u32 s38, s35, 9
s_and_b32 s38, s38, 15
s_mul_i32 s38, s38, 458752
s_add_u32 m0, s40, 49152
s_nop 0
buffer_load_dwordx4 v4, s[12:15], s38 offen lds
s_add_u32 m0, s40, 50176
s_nop 0
buffer_load_dwordx4 v5, s[12:15], s38 offen lds
s_add_u32 m0, s40, 51200
s_add_u32 s38, s38, 57344
buffer_load_dwordx4 v4, s[12:15], s38 offen lds
s_add_u32 m0, s40, 52224
s_nop 0
buffer_load_dwordx4 v5, s[12:15], s38 offen lds
s_add_u32 m0, s40, 53248
s_add_u32 s38, s38, 57344
buffer_load_dwordx4 v4, s[12:15], s38 offen lds
s_add_u32 m0, s40, 54272
s_nop 0
buffer_load_dwordx4 v5, s[12:15], s38 offen lds
s_add_u32 m0, s40, 55296
s_add_u32 s38, s38, 57344
buffer_load_dwordx4 v4, s[12:15], s38 offen lds
s_add_u32 m0, s40, 56320
s_nop 0
buffer_load_dwordx4 v5, s[12:15], s38 offen lds
s_waitcnt vmcnt(12)
s_barrier
s_cmp_eq_u32 s47, 0
s_cbranch_scc0 Lw_115
s_add_u32 s7, s34, 32
s_lshl_b32 s7, s7, 7
v_mov_b32 v90, s7
v_mov_b32 v91, 1
s_mov_b64 exec, 1
buffer_atomic_add v91, v90, s[56:59], 0 offen sc1
s_mov_b64 exec, -1
Lw_115:
v_permlane32_swap_b32 v96, v100
v_permlane32_swap_b32 v97, v101
v_permlane32_swap_b32 v98, v102
v_permlane32_swap_b32 v99, v103
v_add_f32 v96, v96, v100
v_add_f32 v97, v97, v101
v_add_f32 v98, v98, v102
v_add_f32 v99, v99, v103
s_nop 1
v_permlane16_swap_b32 v96, v97
v_permlane16_swap_b32 v98, v99
v_add_f32 v96, v96, v97
v_add_f32 v98, v98, v99
s_nop 1
v_add_f32_dpp v96, v96, v96 row_ror:8 row_mask:0xf bank_mask:0xf
v_add_f32_dpp v98, v98, v98 row_ror:8 row_mask:0xf bank_mask:0xf
ds_write_b32 v104, v96
ds_write_b32 v104, v98 offset:8
s_waitcnt lgkmcnt(0)
s_add_u32 s37, s35, 10
s_and_b32 s37, s37, 15
s_mul_i32 s37, s37, 16384
s_add_u32 m0, s39, 98304
s_nop 0
buffer_load_dwordx4 v3, s[8:11], s37 offen sc1 lds
s_load_dword s3, s[4:5], 6272
s_load_dword s3, s[4:5], 6336
s_load_dword s3, s[4:5], 6400
s_load_dword s3, s[4:5], 6464
s_load_dword s3, s[4:5], 6528
s_load_dword s3, s[4:5], 6592
buffer_load_dwordx4 v3, s[8:11], s37 offen offset:1024 sc1 lds
s_load_dword s3, s[4:5], 6656
s_load_dword s3, s[4:5], 6720
s_load_dword s3, s[4:5], 6784
s_load_dword s3, s[4:5], 6848
s_load_dword s3, s[4:5], 6912
s_load_dword s3, s[4:5], 6976
s_load_dword s3, s[4:5], 7040
buffer_load_dwordx4 v3, s[8:11], s37 offen offset:2048 sc1 lds
s_load_dword s3, s[4:5], 7104
s_bfe_u32 s61, s35, 0x10002
s_lshr_b32 s60, s35, 3
s_lshl_b32 s60, s60, 2
s_and_b32 s43, s35, 3
s_add_u32 s60, s60, s43
buffer_load_dwordx4 v3, s[8:11], s37 offen offset:3072 sc1 lds
s_lshl_b32 s43, s60, 8
s_add_u32 s28, s76, s43
s_addc_u32 s29, s77, 0
s_mov_b32 s30, 7338240
s_mov_b32 s31, 0x20000
s_mul_i32 s52, s61, 196608
s_mul_i32 s53, s61, 1572864
s_add_u32 s38, s35, 10
s_and_b32 s38, s38, 15
s_mul_i32 s38, s38, 458752
s_add_u32 m0, s40, 98304
s_nop 0
buffer_load_dwordx4 v4, s[12:15], s38 offen lds
s_mul_i32 s90, s61, 163840
s_mul_i32 s91, s61, 1310720
s_and_b32 s43, s35, 3
s_mul_i32 s32, s43, 3
s_mul_i32 s33, s43, 10
s_lshr_b32 s33, s33, 2
s_add_u32 m0, s40, 99328
s_nop 0
buffer_load_dwordx4 v5, s[12:15], s38 offen lds
s_lshl_b32 s51, s47, 11
s_lshl_b32 s44, s47, 15
v_lshrrev_b32 v122, 4, v1
v_lshlrev_b32 v123, 1, v122
v_and_b32 v23, 15, v1
v_xor_b32 v23, v23, v123
v_lshlrev_b32 v23, 4, v23
s_branch Lov_10
.p2align 12
.fill 80, 4, 0xbf800000
Lst_10_0:
s_branch Lwr_151
Lst_10_1:
s_branch Lwr_166
s_nop 0
Lov_10:
s_add_u32 m0, s40, 100352
s_add_u32 s38, s38, 57344
buffer_load_dwordx4 v4, s[12:15], s38 offen lds
v_mul_u32_u24 v122, 2048, v122
v_add_u32 v23, v23, v122
v_add_u32 v23, s44, v23
v_xor_b32 v24, 128, v23
v_add_u32 v24, 8192, v24
s_lshl_b32 s43, s60, 2
s_add_u32 m0, s40, 101376
s_nop 0
buffer_load_dwordx4 v5, s[12:15], s38 offen lds
s_lshl_b32 s44, s61, 1
s_add_u32 s43, s43, s44
s_add_u32 s43, s43, s63
s_lshl_b32 s43, s43, 13
s_lshl_b32 s44, s62, 12
s_add_u32 s50, s43, s44
v_add_u32 v17, s44, v2
s_add_u32 m0, s40, 102400
s_add_u32 s38, s38, 57344
buffer_load_dwordx4 v4, s[12:15], s38 offen lds
v_add_u32 v18, 0x10000, v17
v_add_u32 v19, 0x20000, v17
v_lshrrev_b32 v122, 2, v1
v_and_b32 v123, 7, v122
v_mul_u32_u24 v122, 256, v122
v_lshl_add_u32 v122, v123, 5, v122
s_add_u32 m0, s40, 103424
s_nop 0
buffer_load_dwordx4 v5, s[12:15], s38 offen lds
v_and_b32 v123, 3, v1
v_lshl_add_u32 v9, v123, 3, v122
s_lshl_b32 s43, s61, 7
s_lshl_b32 s44, s63, 6
s_add_u32 s43, s43, s44
v_xor_b32 v9, s43, v9
v_xor_b32 v10, 32, v9
s_add_u32 m0, s40, 104448
s_add_u32 s38, s38, 57344
buffer_load_dwordx4 v4, s[12:15], s38 offen lds
s_add_u32 m0, s40, 105472
s_nop 0
buffer_load_dwordx4 v5, s[12:15], s38 offen lds
s_waitcnt vmcnt(12)
s_barrier
buffer_load_dwordx4 v[160:163], v2, s[8:11], s50 offen offset:0 sc1
v_xor_b32 v11, 128, v9
v_xor_b32 v12, 128, v10
v_add_u32 v13, 65536, v9
buffer_load_dwordx4 v[164:167], v2, s[8:11], s50 offen offset:1024 sc1
v_add_u32 v14, 65536, v10
v_add_u32 v15, 65536, v11
v_add_u32 v16, 65536, v12
v_add_u32 v25, 131072, v9
buffer_load_dwordx4 v[168:171], v2, s[8:11], s50 offen offset:2048 sc1
v_add_u32 v26, 131072, v10
v_add_u32 v27, 131072, v11
v_add_u32 v28, 131072, v12
v_lshrrev_b32 v122, 2, v1
buffer_load_dwordx4 v[172:175], v2, s[8:11], s50 offen offset:3072 sc1
v_bfe_u32 v123, v122, 1, 2
v_mul_u32_u24 v122, 128, v122
v_lshl_add_u32 v122, v123, 5, v122
s_add_u32 s37, s35, 11
s_and_b32 s37, s37, 15
s_mul_i32 s37, s37, 16384
s_add_u32 m0, s39, 0
s_nop 0
buffer_load_dwordx4 v3, s[8:11], s37 offen sc1 lds
v_and_b32 v123, 3, v1
v_lshl_add_u32 v224, v123, 3, v122
v_xor_b32 v224, s44, v224
v_xor_b32 v225, 32, v224
buffer_load_dwordx4 v3, s[8:11], s37 offen offset:1024 sc1 lds
v_add_u32 v226, 65536, v224
v_add_u32 v227, 65536, v225
v_add_u32 v228, 131072, v224
v_add_u32 v229, 131072, v225
buffer_load_dwordx4 v3, s[8:11], s37 offen offset:2048 sc1 lds
s_add_u32 s84, s82, 33554432
s_addc_u32 s85, s83, 0
s_mov_b32 s86, 4194304
s_mov_b32 s87, 0x20000
buffer_load_dwordx4 v3, s[8:11], s37 offen offset:3072 sc1 lds
s_xor_b32 s43, s2, 2
s_lshl_b32 s44, s43, 2
s_add_u32 s44, s44, s47
s_add_u32 s38, s35, 11
s_and_b32 s38, s38, 15
s_mul_i32 s38, s38, 458752
s_add_u32 m0, s40, 0
s_nop 0
buffer_load_dwordx4 v4, s[12:15], s38 offen lds
s_lshl_b32 s45, s44, 12
s_lshl_b32 s46, s2, 2
s_add_u32 s46, s46, s47
s_lshl_b32 s46, s46, 12
s_add_u32 m0, s40, 1024
s_nop 0
buffer_load_dwordx4 v5, s[12:15], s38 offen lds
s_lshl_b32 s43, s34, 18
s_lshl_b32 s42, s60, 8
s_add_u32 s43, s43, s42
s_lshl_b32 s42, s61, 7
s_add_u32 m0, s40, 2048
s_add_u32 s38, s38, 57344
buffer_load_dwordx4 v4, s[12:15], s38 offen lds
s_add_u32 s43, s43, s42
s_lshl_b32 s42, s63, 6
s_add_u32 s43, s43, s42
s_add_u32 m0, s40, 3072
s_nop 0
buffer_load_dwordx4 v5, s[12:15], s38 offen lds
s_add_u32 s20, s78, s43
s_addc_u32 s21, s79, 0
s_mov_b32 s22, 260160
s_mov_b32 s23, 0x20000
s_add_u32 m0, s40, 4096
s_add_u32 s38, s38, 57344
buffer_load_dwordx4 v4, s[12:15], s38 offen lds
v_and_b32 v230, 15, v1
v_lshlrev_b32 v230, 12, v230
v_bfe_u32 v231, v1, 4, 1
v_lshl_add_u32 v230, v231, 5, v230
s_add_u32 m0, s40, 5120
s_nop 0
buffer_load_dwordx4 v5, s[12:15], s38 offen lds
v_bfe_u32 v231, v1, 5, 1
v_lshl_add_u32 v230, v231, 4, v230
s_lshl_b32 s54, s62, 17
s_add_u32 s55, s54, 65536
s_add_u32 m0, s40, 6144
s_add_u32 s38, s38, 57344
buffer_load_dwordx4 v4, s[12:15], s38 offen lds
s_add_u32 m0, s40, 7168
s_nop 0
buffer_load_dwordx4 v5, s[12:15], s38 offen lds
s_waitcnt vmcnt(16)
s_barrier
s_cmp_eq_u32 s47, 3
s_cbranch_scc0 Lw_116
s_lshl_b32 s92, s34, 7
s_add_u32 s92, s92, 28315648
s_load_dword s93, s[82:83], s92 glc
Lw_116:
s_add_u32 s37, s35, 12
s_and_b32 s37, s37, 15
s_mul_i32 s37, s37, 16384
s_add_u32 m0, s39, 49152
s_nop 0
buffer_load_dwordx4 v3, s[8:11], s37 offen sc1 lds
buffer_load_dwordx4 v3, s[8:11], s37 offen offset:1024 sc1 lds
buffer_load_dwordx4 v3, s[8:11], s37 offen offset:2048 sc1 lds
buffer_load_dwordx4 v3, s[8:11], s37 offen offset:3072 sc1 lds
s_add_u32 s38, s35, 12
s_and_b32 s38, s38, 15
s_mul_i32 s38, s38, 458752
s_add_u32 m0, s40, 49152
s_nop 0
buffer_load_dwordx4 v4, s[12:15], s38 offen lds
s_add_u32 m0, s40, 50176
s_nop 0
buffer_load_dwordx4 v5, s[12:15], s38 offen lds
s_add_u32 m0, s40, 51200
s_add_u32 s38, s38, 57344
buffer_load_dwordx4 v4, s[12:15], s38 offen lds
s_add_u32 m0, s40, 52224
s_nop 0
buffer_load_dwordx4 v5, s[12:15], s38 offen lds
s_add_u32 m0, s40, 53248
s_add_u32 s38, s38, 57344
buffer_load_dwordx4 v4, s[12:15], s38 offen lds
s_add_u32 m0, s40, 54272
s_nop 0
buffer_load_dwordx4 v5, s[12:15], s38 offen lds
s_add_u32 m0, s40, 55296
s_add_u32 s38, s38, 57344
buffer_load_dwordx4 v4, s[12:15], s38 offen lds
s_add_u32 m0, s40, 56320
s_nop 0
buffer_load_dwordx4 v5, s[12:15], s38 offen lds
s_waitcnt vmcnt(12)
s_cmp_eq_u32 s47, 3
s_cbranch_scc0 Lw_117
s_mov_b32 s41, 0x40000
s_branch Lpchk_120
Lpoll_118:
s_load_dword s93, s[82:83], s92 glc
Lpchk_120:
s_waitcnt lgkmcnt(0)
s_cmp_eq_u32 s93, 16
s_cbranch_scc1 Lpok_119
s_sub_u32 s41, s41, 1
s_cmp_lg_u32 s41, 0
s_cbranch_scc1 Lpoll_118
Lpok_119:
Lw_117:
s_barrier
s_add_u32 s37, s52, 524288
s_add_u32 m0, s39, 98304
s_nop 0
buffer_load_dwordx4 v3, s[24:27], s37 offen sc1 lds
v_lshlrev_b32 v128, 16, v160
v_and_b32 v129, 0xffff0000, v160
v_lshlrev_b32 v130, 16, v161
v_and_b32 v131, 0xffff0000, v161
v_lshlrev_b32 v132, 16, v162
buffer_load_dwordx4 v3, s[24:27], s37 offen offset:1024 sc1 lds
v_and_b32 v133, 0xffff0000, v162
v_lshlrev_b32 v134, 16, v163
v_and_b32 v135, 0xffff0000, v163
v_lshlrev_b32 v136, 16, v164
v_and_b32 v137, 0xffff0000, v164
buffer_load_dwordx4 v3, s[24:27], s37 offen offset:2048 sc1 lds
v_lshlrev_b32 v138, 16, v165
v_and_b32 v139, 0xffff0000, v165
v_lshlrev_b32 v140, 16, v166
v_and_b32 v141, 0xffff0000, v166
v_lshlrev_b32 v142, 16, v167
v_and_b32 v143, 0xffff0000, v167
buffer_load_dwordx4 v3, s[24:27], s37 offen offset:3072 sc1 lds
v_lshlrev_b32 v144, 16, v168
v_and_b32 v145, 0xffff0000, v168
v_lshlrev_b32 v146, 16, v169
v_and_b32 v147, 0xffff0000, v169
v_lshlrev_b32 v148, 16, v170
s_add_u32 s38, s53, 4194304
s_add_u32 m0, s39, 114688
s_nop 0
buffer_load_dwordx4 v23, s[28:31], s38 offen lds
v_and_b32 v149, 0xffff0000, v170
v_lshlrev_b32 v150, 16, v171
v_and_b32 v151, 0xffff0000, v171
v_lshlrev_b32 v152, 16, v172
v_and_b32 v153, 0xffff0000, v172
s_add_u32 m0, s39, 115712
s_nop 0
buffer_load_dwordx4 v24, s[28:31], s38 offen lds
v_lshlrev_b32 v154, 16, v173
v_and_b32 v155, 0xffff0000, v173
v_lshlrev_b32 v156, 16, v174
v_and_b32 v157, 0xffff0000, v174
v_lshlrev_b32 v158, 16, v175
v_and_b32 v159, 0xffff0000, v175
s_add_u32 m0, s39, 116736
s_add_u32 s38, s38, 16384
buffer_load_dwordx4 v23, s[28:31], s38 offen lds
s_add_u32 m0, s39, 117760
s_nop 0
buffer_load_dwordx4 v24, s[28:31], s38 offen lds
s_waitcnt vmcnt(8)
s_barrier
s_add_u32 s37, s52, 540672
s_add_u32 m0, s39, 131072
s_nop 0
buffer_load_dwordx4 v3, s[24:27], s37 offen sc1 lds
buffer_load_dwordx4 v3, s[24:27], s37 offen offset:1024 sc1 lds
buffer_load_dwordx4 v3, s[24:27], s37 offen offset:2048 sc1 lds
buffer_load_dwordx4 v3, s[24:27], s37 offen offset:3072 sc1 lds
s_add_u32 s38, s53, 4325376
s_add_u32 m0, s39, 0
s_nop 0
buffer_load_dwordx4 v23, s[28:31], s38 offen lds
s_add_u32 m0, s39, 1024
s_nop 0
buffer_load_dwordx4 v24, s[28:31], s38 offen lds
s_add_u32 m0, s39, 2048
s_add_u32 s38, s38, 16384
buffer_load_dwordx4 v23, s[28:31], s38 offen lds
s_add_u32 m0, s39, 3072
s_nop 0
buffer_load_dwordx4 v24, s[28:31], s38 offen lds
s_add_u32 s37, s52, 557056
s_add_u32 m0, s39, 16384
s_nop 0
buffer_load_dwordx4 v3, s[24:27], s37 offen sc1 lds
buffer_load_dwordx4 v3, s[24:27], s37 offen offset:1024 sc1 lds
buffer_load_dwordx4 v3, s[24:27], s37 offen offset:2048 sc1 lds
buffer_load_dwordx4 v3, s[24:27], s37 offen offset:3072 sc1 lds
s_add_u32 s38, s53, 4456448
s_add_u32 m0, s39, 32768
s_nop 0
buffer_load_dwordx4 v23, s[28:31], s38 offen lds
s_add_u32 m0, s39, 33792
s_nop 0
buffer_load_dwordx4 v24, s[28:31], s38 offen lds
s_add_u32 m0, s39, 34816
s_add_u32 s38, s38, 16384
buffer_load_dwordx4 v23, s[28:31], s38 offen lds
s_add_u32 m0, s39, 35840
s_nop 0
buffer_load_dwordx4 v24, s[28:31], s38 offen lds
s_waitcnt vmcnt(16)
s_barrier
ds_read_b128 v[32:35], v18 offset:32768
ds_read_b64_tr_b16 v[48:49], v13 offset:49152
ds_read_b64_tr_b16 v[50:51], v13 offset:53248
ds_read_b64_tr_b16 v[52:53], v14 offset:49152
ds_read_b64_tr_b16 v[54:55], v14 offset:53248
ds_read_b64_tr_b16 v[56:57], v15 offset:49152
ds_read_b64_tr_b16 v[58:59], v15 offset:53248
ds_read_b64_tr_b16 v[60:61], v16 offset:49152
ds_read_b64_tr_b16 v[62:63], v16 offset:53248
ds_read_b128 v[36:39], v18 offset:33792
ds_read_b128 v[40:43], v18 offset:34816
ds_read_b128 v[44:47], v18 offset:35840
ds_read_b128 v[64:67], v18 offset:40960
ds_read_b64_tr_b16 v[80:81], v13 offset:57344
ds_read_b64_tr_b16 v[82:83], v13 offset:61440
ds_read_b64_tr_b16 v[84:85], v14 offset:57344
ds_read_b64_tr_b16 v[86:87], v14 offset:61440
ds_read_b64_tr_b16 v[88:89], v15 offset:57344
ds_read_b64_tr_b16 v[90:91], v15 offset:61440
ds_read_b64_tr_b16 v[92:93], v16 offset:57344
ds_read_b64_tr_b16 v[94:95], v16 offset:61440
ds_read_b128 v[68:71], v18 offset:41984
ds_read_b128 v[72:75], v18 offset:43008
ds_read_b128 v[76:79], v18 offset:44032
s_add_u32 s37, s52, 573440
s_add_u32 m0, s39, 49152
s_nop 0
buffer_load_dwordx4 v3, s[24:27], s37 offen sc1 lds
buffer_load_dwordx4 v3, s[24:27], s37 offen offset:1024 sc1 lds
buffer_load_dwordx4 v3, s[24:27], s37 offen offset:2048 sc1 lds
buffer_load_dwordx4 v3, s[24:27], s37 offen offset:3072 sc1 lds
s_add_u32 s38, s53, 4587520
s_add_u32 m0, s39, 65536
s_nop 0
buffer_load_dwordx4 v23, s[28:31], s38 offen lds
s_add_u32 m0, s39, 66560
s_nop 0
buffer_load_dwordx4 v24, s[28:31], s38 offen lds
s_add_u32 m0, s39, 67584
s_add_u32 s38, s38, 16384
buffer_load_dwordx4 v23, s[28:31], s38 offen lds
s_add_u32 m0, s39, 68608
s_nop 0
buffer_load_dwordx4 v24, s[28:31], s38 offen lds
s_waitcnt vmcnt(16)
s_waitcnt lgkmcnt(0)
s_barrier
v_mfma_f32_16x16x32_bf16 v[128:131], v[48:51], v[32:35], v[128:131]
ds_read_b128 v[96:99], v19 offset:0
v_mfma_f32_16x16x32_bf16 v[136:139], v[48:51], v[36:39], v[136:139]
ds_read_b64_tr_b16 v[112:113], v9 offset:0
v_mfma_f32_16x16x32_bf16 v[144:147], v[48:51], v[40:43], v[144:147]
ds_read_b64_tr_b16 v[114:115], v9 offset:4096
v_mfma_f32_16x16x32_bf16 v[152:155], v[48:51], v[44:47], v[152:155]
ds_read_b64_tr_b16 v[116:117], v10 offset:0
v_mfma_f32_16x16x32_bf16 v[156:159], v[52:55], v[44:47], v[156:159]
ds_read_b64_tr_b16 v[118:119], v10 offset:4096
v_mfma_f32_16x16x32_bf16 v[148:151], v[52:55], v[40:43], v[148:151]
ds_read_b64_tr_b16 v[120:121], v11 offset:0
v_mfma_f32_16x16x32_bf16 v[140:143], v[52:55], v[36:39], v[140:143]
ds_read_b64_tr_b16 v[122:123], v11 offset:4096
v_mfma_f32_16x16x32_bf16 v[132:135], v[52:55], v[32:35], v[132:135]
ds_read_b64_tr_b16 v[124:125], v12 offset:0
v_mfma_f32_16x16x32_bf16 v[160:163], v[56:59], v[32:35], 0
ds_read_b64_tr_b16 v[126:127], v12 offset:4096
v_mfma_f32_16x16x32_bf16 v[168:171], v[56:59], v[36:39], 0
ds_read_b128 v[100:103], v19 offset:1024
v_mfma_f32_16x16x32_bf16 v[176:179], v[56:59], v[40:43], 0
ds_read_b128 v[104:107], v19 offset:2048
v_mfma_f32_16x16x32_bf16 v[184:187], v[56:59], v[44:47], 0
ds_read_b128 v[108:111], v19 offset:3072
v_mfma_f32_16x16x32_bf16 v[188:191], v[60:63], v[44:47], 0
ds_read_b128 v[192:195], v19 offset:8192
v_mfma_f32_16x16x32_bf16 v[180:183], v[60:63], v[40:43], 0
ds_read_b64_tr_b16 v[208:209], v9 offset:8192
v_mfma_f32_16x16x32_bf16 v[172:175], v[60:63], v[36:39], 0
ds_read_b64_tr_b16 v[210:211], v9 offset:12288
v_mfma_f32_16x16x32_bf16 v[164:167], v[60:63], v[32:35], 0
ds_read_b64_tr_b16 v[212:213], v10 offset:8192
v_mfma_f32_16x16x32_bf16 v[128:131], v[80:83], v[64:67], v[128:131]
ds_read_b64_tr_b16 v[214:215], v10 offset:12288
v_mfma_f32_16x16x32_bf16 v[136:139], v[80:83], v[68:71], v[136:139]
ds_read_b64_tr_b16 v[216:217], v11 offset:8192
v_mfma_f32_16x16x32_bf16 v[144:147], v[80:83], v[72:75], v[144:147]
ds_read_b64_tr_b16 v[218:219], v11 offset:12288
v_mfma_f32_16x16x32_bf16 v[152:155], v[80:83], v[76:79], v[152:155]
ds_read_b64_tr_b16 v[220:221], v12 offset:8192
v_mfma_f32_16x16x32_bf16 v[156:159], v[84:87], v[76:79], v[156:159]
ds_read_b64_tr_b16 v[222:223], v12 offset:12288
v_mfma_f32_16x16x32_bf16 v[148:151], v[84:87], v[72:75], v[148:151]
ds_read_b128 v[196:199], v19 offset:9216
v_mfma_f32_16x16x32_bf16 v[140:143], v[84:87], v[68:71], v[140:143]
ds_read_b128 v[200:203], v19 offset:10240
v_mfma_f32_16x16x32_bf16 v[132:135], v[84:87], v[64:67], v[132:135]
ds_read_b128 v[204:207], v19 offset:11264
v_mfma_f32_16x16x32_bf16 v[160:163], v[88:91], v[64:67], v[160:163]
v_mfma_f32_16x16x32_bf16 v[168:171], v[88:91], v[68:71], v[168:171]
v_mfma_f32_16x16x32_bf16 v[176:179], v[88:91], v[72:75], v[176:179]
v_mfma_f32_16x16x32_bf16 v[184:187], v[88:91], v[76:79], v[184:187]
v_mfma_f32_16x16x32_bf16 v[188:191], v[92:95], v[76:79], v[188:191]
v_mfma_f32_16x16x32_bf16 v[180:183], v[92:95], v[72:75], v[180:183]
v_mfma_f32_16x16x32_bf16 v[172:175], v[92:95], v[68:71], v[172:175]
v_mfma_f32_16x16x32_bf16 v[164:167], v[92:95], v[64:67], v[164:167]
s_mov_b32 s41, 2
Lk4_121:
s_waitcnt vmcnt(8)
s_waitcnt lgkmcnt(0)
s_barrier
v_mfma_f32_16x16x32_bf16 v[128:131], v[112:115], v[96:99], v[128:131]
ds_read_b128 v[32:35], v17 offset:16384
v_mfma_f32_16x16x32_bf16 v[136:139], v[112:115], v[100:103], v[136:139]
ds_read_b64_tr_b16 v[48:49], v9 offset:32768
v_mfma_f32_16x16x32_bf16 v[144:147], v[112:115], v[104:107], v[144:147]
ds_read_b64_tr_b16 v[50:51], v9 offset:36864
v_mfma_f32_16x16x32_bf16 v[152:155], v[112:115], v[108:111], v[152:155]
ds_read_b64_tr_b16 v[52:53], v10 offset:32768
v_mfma_f32_16x16x32_bf16 v[156:159], v[116:119], v[108:111], v[156:159]
ds_read_b64_tr_b16 v[54:55], v10 offset:36864
v_mfma_f32_16x16x32_bf16 v[148:151], v[116:119], v[104:107], v[148:151]
ds_read_b64_tr_b16 v[56:57], v11 offset:32768
v_mfma_f32_16x16x32_bf16 v[140:143], v[116:119], v[100:103], v[140:143]
ds_read_b64_tr_b16 v[58:59], v11 offset:36864
v_mfma_f32_16x16x32_bf16 v[132:135], v[116:119], v[96:99], v[132:135]
ds_read_b64_tr_b16 v[60:61], v12 offset:32768
v_mfma_f32_16x16x32_bf16 v[160:163], v[120:123], v[96:99], v[160:163]
ds_read_b64_tr_b16 v[62:63], v12 offset:36864
v_mfma_f32_16x16x32_bf16 v[168:171], v[120:123], v[100:103], v[168:171]
ds_read_b128 v[36:39], v17 offset:17408
v_mfma_f32_16x16x32_bf16 v[176:179], v[120:123], v[104:107], v[176:179]
ds_read_b128 v[40:43], v17 offset:18432
v_mfma_f32_16x16x32_bf16 v[184:187], v[120:123], v[108:111], v[184:187]
ds_read_b128 v[44:47], v17 offset:19456
v_mfma_f32_16x16x32_bf16 v[188:191], v[124:127], v[108:111], v[188:191]
ds_read_b128 v[64:67], v17 offset:24576
v_mfma_f32_16x16x32_bf16 v[180:183], v[124:127], v[104:107], v[180:183]
ds_read_b64_tr_b16 v[80:81], v9 offset:40960
v_mfma_f32_16x16x32_bf16 v[172:175], v[124:127], v[100:103], v[172:175]
ds_read_b64_tr_b16 v[82:83], v9 offset:45056
v_mfma_f32_16x16x32_bf16 v[164:167], v[124:127], v[96:99], v[164:167]
ds_read_b64_tr_b16 v[84:85], v10 offset:40960
v_mfma_f32_16x16x32_bf16 v[128:131], v[208:211], v[192:195], v[128:131]
ds_read_b64_tr_b16 v[86:87], v10 offset:45056
v_mfma_f32_16x16x32_bf16 v[136:139], v[208:211], v[196:199], v[136:139]
ds_read_b64_tr_b16 v[88:89], v11 offset:40960
v_mfma_f32_16x16x32_bf16 v[144:147], v[208:211], v[200:203], v[144:147]
ds_read_b64_tr_b16 v[90:91], v11 offset:45056
v_mfma_f32_16x16x32_bf16 v[152:155], v[208:211], v[204:207], v[152:155]
ds_read_b64_tr_b16 v[92:93], v12 offset:40960
v_mfma_f32_16x16x32_bf16 v[156:159], v[212:215], v[204:207], v[156:159]
ds_read_b64_tr_b16 v[94:95], v12 offset:45056
v_mfma_f32_16x16x32_bf16 v[148:151], v[212:215], v[200:203], v[148:151]
ds_read_b128 v[68:71], v17 offset:25600
v_mfma_f32_16x16x32_bf16 v[140:143], v[212:215], v[196:199], v[140:143]
ds_read_b128 v[72:75], v17 offset:26624
v_mfma_f32_16x16x32_bf16 v[132:135], v[212:215], v[192:195], v[132:135]
ds_read_b128 v[76:79], v17 offset:27648
v_mfma_f32_16x16x32_bf16 v[160:163], v[216:219], v[192:195], v[160:163]
v_mfma_f32_16x16x32_bf16 v[168:171], v[216:219], v[196:199], v[168:171]
v_mfma_f32_16x16x32_bf16 v[176:179], v[216:219], v[200:203], v[176:179]
v_mfma_f32_16x16x32_bf16 v[184:187], v[216:219], v[204:207], v[184:187]
v_mfma_f32_16x16x32_bf16 v[188:191], v[220:223], v[204:207], v[188:191]
v_mfma_f32_16x16x32_bf16 v[180:183], v[220:223], v[200:203], v[180:183]
v_mfma_f32_16x16x32_bf16 v[172:175], v[220:223], v[196:199], v[172:175]
v_mfma_f32_16x16x32_bf16 v[164:167], v[220:223], v[192:195], v[164:167]
s_waitcnt vmcnt(0)
s_waitcnt lgkmcnt(0)
s_barrier
v_mfma_f32_16x16x32_bf16 v[128:131], v[48:51], v[32:35], v[128:131]
ds_read_b128 v[96:99], v17 offset:49152
v_mfma_f32_16x16x32_bf16 v[136:139], v[48:51], v[36:39], v[136:139]
ds_read_b64_tr_b16 v[112:113], v13 offset:0
v_mfma_f32_16x16x32_bf16 v[144:147], v[48:51], v[40:43], v[144:147]
ds_read_b64_tr_b16 v[114:115], v13 offset:4096
v_mfma_f32_16x16x32_bf16 v[152:155], v[48:51], v[44:47], v[152:155]
ds_read_b64_tr_b16 v[116:117], v14 offset:0
v_mfma_f32_16x16x32_bf16 v[156:159], v[52:55], v[44:47], v[156:159]
ds_read_b64_tr_b16 v[118:119], v14 offset:4096
v_mfma_f32_16x16x32_bf16 v[148:151], v[52:55], v[40:43], v[148:151]
ds_read_b64_tr_b16 v[120:121], v15 offset:0
v_mfma_f32_16x16x32_bf16 v[140:143], v[52:55], v[36:39], v[140:143]
ds_read_b64_tr_b16 v[122:123], v15 offset:4096
v_mfma_f32_16x16x32_bf16 v[132:135], v[52:55], v[32:35], v[132:135]
ds_read_b64_tr_b16 v[124:125], v16 offset:0
v_mfma_f32_16x16x32_bf16 v[160:163], v[56:59], v[32:35], v[160:163]
ds_read_b64_tr_b16 v[126:127], v16 offset:4096
v_mfma_f32_16x16x32_bf16 v[168:171], v[56:59], v[36:39], v[168:171]
ds_read_b128 v[100:103], v17 offset:50176
v_mfma_f32_16x16x32_bf16 v[176:179], v[56:59], v[40:43], v[176:179]
ds_read_b128 v[104:107], v17 offset:51200
v_mfma_f32_16x16x32_bf16 v[184:187], v[56:59], v[44:47], v[184:187]
ds_read_b128 v[108:111], v17 offset:52224
v_mfma_f32_16x16x32_bf16 v[188:191], v[60:63], v[44:47], v[188:191]
ds_read_b128 v[192:195], v17 offset:57344
v_mfma_f32_16x16x32_bf16 v[180:183], v[60:63], v[40:43], v[180:183]
ds_read_b64_tr_b16 v[208:209], v13 offset:8192
v_mfma_f32_16x16x32_bf16 v[172:175], v[60:63], v[36:39], v[172:175]
ds_read_b64_tr_b16 v[210:211], v13 offset:12288
v_mfma_f32_16x16x32_bf16 v[164:167], v[60:63], v[32:35], v[164:167]
ds_read_b64_tr_b16 v[212:213], v14 offset:8192
v_mfma_f32_16x16x32_bf16 v[128:131], v[80:83], v[64:67], v[128:131]
ds_read_b64_tr_b16 v[214:215], v14 offset:12288
v_mfma_f32_16x16x32_bf16 v[136:139], v[80:83], v[68:71], v[136:139]
ds_read_b64_tr_b16 v[216:217], v15 offset:8192
v_mfma_f32_16x16x32_bf16 v[144:147], v[80:83], v[72:75], v[144:147]
ds_read_b64_tr_b16 v[218:219], v15 offset:12288
v_mfma_f32_16x16x32_bf16 v[152:155], v[80:83], v[76:79], v[152:155]
ds_read_b64_tr_b16 v[220:221], v16 offset:8192
v_mfma_f32_16x16x32_bf16 v[156:159], v[84:87], v[76:79], v[156:159]
ds_read_b64_tr_b16 v[222:223], v16 offset:12288
v_mfma_f32_16x16x32_bf16 v[148:151], v[84:87], v[72:75], v[148:151]
ds_read_b128 v[196:199], v17 offset:58368
v_mfma_f32_16x16x32_bf16 v[140:143], v[84:87], v[68:71], v[140:143]
ds_read_b128 v[200:203], v17 offset:59392
v_mfma_f32_16x16x32_bf16 v[132:135], v[84:87], v[64:67], v[132:135]
ds_read_b128 v[204:207], v17 offset:60416
v_mfma_f32_16x16x32_bf16 v[160:163], v[88:91], v[64:67], v[160:163]
v_mfma_f32_16x16x32_bf16 v[168:171], v[88:91], v[68:71], v[168:171]
v_mfma_f32_16x16x32_bf16 v[176:179], v[88:91], v[72:75], v[176:179]
v_mfma_f32_16x16x32_bf16 v[184:187], v[88:91], v[76:79], v[184:187]
v_mfma_f32_16x16x32_bf16 v[188:191], v[92:95], v[76:79], v[188:191]
v_mfma_f32_16x16x32_bf16 v[180:183], v[92:95], v[72:75], v[180:183]
v_mfma_f32_16x16x32_bf16 v[172:175], v[92:95], v[68:71], v[172:175]
v_mfma_f32_16x16x32_bf16 v[164:167], v[92:95], v[64:67], v[164:167]
s_waitcnt lgkmcnt(0)
s_barrier
v_mfma_f32_16x16x32_bf16 v[128:131], v[112:115], v[96:99], v[128:131]
ds_read_b128 v[32:35], v18 offset:16384
v_mfma_f32_16x16x32_bf16 v[136:139], v[112:115], v[100:103], v[136:139]
ds_read_b64_tr_b16 v[48:49], v25 offset:16384
v_mfma_f32_16x16x32_bf16 v[144:147], v[112:115], v[104:107], v[144:147]
ds_read_b64_tr_b16 v[50:51], v25 offset:20480
v_mfma_f32_16x16x32_bf16 v[152:155], v[112:115], v[108:111], v[152:155]
ds_read_b64_tr_b16 v[52:53], v26 offset:16384
v_mfma_f32_16x16x32_bf16 v[156:159], v[116:119], v[108:111], v[156:159]
ds_read_b64_tr_b16 v[54:55], v26 offset:20480
v_mfma_f32_16x16x32_bf16 v[148:151], v[116:119], v[104:107], v[148:151]
ds_read_b64_tr_b16 v[56:57], v27 offset:16384
v_mfma_f32_16x16x32_bf16 v[140:143], v[116:119], v[100:103], v[140:143]
ds_read_b64_tr_b16 v[58:59], v27 offset:20480
v_mfma_f32_16x16x32_bf16 v[132:135], v[116:119], v[96:99], v[132:135]
ds_read_b64_tr_b16 v[60:61], v28 offset:16384
v_mfma_f32_16x16x32_bf16 v[160:163], v[120:123], v[96:99], v[160:163]
ds_read_b64_tr_b16 v[62:63], v28 offset:20480
v_mfma_f32_16x16x32_bf16 v[168:171], v[120:123], v[100:103], v[168:171]
ds_read_b128 v[36:39], v18 offset:17408
v_mfma_f32_16x16x32_bf16 v[176:179], v[120:123], v[104:107], v[176:179]
ds_read_b128 v[40:43], v18 offset:18432
v_mfma_f32_16x16x32_bf16 v[184:187], v[120:123], v[108:111], v[184:187]
s_branch Lov_11
.p2align 12
.fill 80, 4, 0xbf800000
Lst_11_0:
s_branch Lwr_152
Lst_11_1:
s_branch Lst_15_1
s_nop 0
Lov_11:
ds_read_b128 v[44:47], v18 offset:19456
v_mfma_f32_16x16x32_bf16 v[188:191], v[124:127], v[108:111], v[188:191]
ds_read_b128 v[64:67], v18 offset:24576
v_mfma_f32_16x16x32_bf16 v[180:183], v[124:127], v[104:107], v[180:183]
ds_read_b64_tr_b16 v[80:81], v25 offset:24576
v_mfma_f32_16x16x32_bf16 v[172:175], v[124:127], v[100:103], v[172:175]
ds_read_b64_tr_b16 v[82:83], v25 offset:28672
v_mfma_f32_16x16x32_bf16 v[164:167], v[124:127], v[96:99], v[164:167]
ds_read_b64_tr_b16 v[84:85], v26 offset:24576
v_mfma_f32_16x16x32_bf16 v[128:131], v[208:211], v[192:195], v[128:131]
ds_read_b64_tr_b16 v[86:87], v26 offset:28672
v_mfma_f32_16x16x32_bf16 v[136:139], v[208:211], v[196:199], v[136:139]
ds_read_b64_tr_b16 v[88:89], v27 offset:24576
v_mfma_f32_16x16x32_bf16 v[144:147], v[208:211], v[200:203], v[144:147]
ds_read_b64_tr_b16 v[90:91], v27 offset:28672
v_mfma_f32_16x16x32_bf16 v[152:155], v[208:211], v[204:207], v[152:155]
ds_read_b64_tr_b16 v[92:93], v28 offset:24576
v_mfma_f32_16x16x32_bf16 v[156:159], v[212:215], v[204:207], v[156:159]
ds_read_b64_tr_b16 v[94:95], v28 offset:28672
v_mfma_f32_16x16x32_bf16 v[148:151], v[212:215], v[200:203], v[148:151]
ds_read_b128 v[68:71], v18 offset:25600
v_mfma_f32_16x16x32_bf16 v[140:143], v[212:215], v[196:199], v[140:143]
ds_read_b128 v[72:75], v18 offset:26624
v_mfma_f32_16x16x32_bf16 v[132:135], v[212:215], v[192:195], v[132:135]
ds_read_b128 v[76:79], v18 offset:27648
v_mfma_f32_16x16x32_bf16 v[160:163], v[216:219], v[192:195], v[160:163]
v_mfma_f32_16x16x32_bf16 v[168:171], v[216:219], v[196:199], v[168:171]
v_mfma_f32_16x16x32_bf16 v[176:179], v[216:219], v[200:203], v[176:179]
v_mfma_f32_16x16x32_bf16 v[184:187], v[216:219], v[204:207], v[184:187]
v_mfma_f32_16x16x32_bf16 v[188:191], v[220:223], v[204:207], v[188:191]
v_mfma_f32_16x16x32_bf16 v[180:183], v[220:223], v[200:203], v[180:183]
v_mfma_f32_16x16x32_bf16 v[172:175], v[220:223], v[196:199], v[172:175]
v_mfma_f32_16x16x32_bf16 v[164:167], v[220:223], v[192:195], v[164:167]
s_waitcnt lgkmcnt(0)
s_barrier
v_mfma_f32_16x16x32_bf16 v[128:131], v[48:51], v[32:35], v[128:131]
ds_read_b128 v[96:99], v18 offset:32768
v_mfma_f32_16x16x32_bf16 v[136:139], v[48:51], v[36:39], v[136:139]
ds_read_b64_tr_b16 v[112:113], v13 offset:49152
v_mfma_f32_16x16x32_bf16 v[144:147], v[48:51], v[40:43], v[144:147]
ds_read_b64_tr_b16 v[114:115], v13 offset:53248
v_mfma_f32_16x16x32_bf16 v[152:155], v[48:51], v[44:47], v[152:155]
ds_read_b64_tr_b16 v[116:117], v14 offset:49152
v_mfma_f32_16x16x32_bf16 v[156:159], v[52:55], v[44:47], v[156:159]
ds_read_b64_tr_b16 v[118:119], v14 offset:53248
v_mfma_f32_16x16x32_bf16 v[148:151], v[52:55], v[40:43], v[148:151]
ds_read_b64_tr_b16 v[120:121], v15 offset:49152
v_mfma_f32_16x16x32_bf16 v[140:143], v[52:55], v[36:39], v[140:143]
ds_read_b64_tr_b16 v[122:123], v15 offset:53248
v_mfma_f32_16x16x32_bf16 v[132:135], v[52:55], v[32:35], v[132:135]
ds_read_b64_tr_b16 v[124:125], v16 offset:49152
v_mfma_f32_16x16x32_bf16 v[160:163], v[56:59], v[32:35], v[160:163]
ds_read_b64_tr_b16 v[126:127], v16 offset:53248
v_mfma_f32_16x16x32_bf16 v[168:171], v[56:59], v[36:39], v[168:171]
ds_read_b128 v[100:103], v18 offset:33792
v_mfma_f32_16x16x32_bf16 v[176:179], v[56:59], v[40:43], v[176:179]
ds_read_b128 v[104:107], v18 offset:34816
v_mfma_f32_16x16x32_bf16 v[184:187], v[56:59], v[44:47], v[184:187]
ds_read_b128 v[108:111], v18 offset:35840
v_mfma_f32_16x16x32_bf16 v[188:191], v[60:63], v[44:47], v[188:191]
ds_read_b128 v[192:195], v18 offset:40960
v_mfma_f32_16x16x32_bf16 v[180:183], v[60:63], v[40:43], v[180:183]
ds_read_b64_tr_b16 v[208:209], v13 offset:57344
v_mfma_f32_16x16x32_bf16 v[172:175], v[60:63], v[36:39], v[172:175]
ds_read_b64_tr_b16 v[210:211], v13 offset:61440
v_mfma_f32_16x16x32_bf16 v[164:167], v[60:63], v[32:35], v[164:167]
ds_read_b64_tr_b16 v[212:213], v14 offset:57344
v_mfma_f32_16x16x32_bf16 v[128:131], v[80:83], v[64:67], v[128:131]
ds_read_b64_tr_b16 v[214:215], v14 offset:61440
v_mfma_f32_16x16x32_bf16 v[136:139], v[80:83], v[68:71], v[136:139]
ds_read_b64_tr_b16 v[216:217], v15 offset:57344
v_mfma_f32_16x16x32_bf16 v[144:147], v[80:83], v[72:75], v[144:147]
ds_read_b64_tr_b16 v[218:219], v15 offset:61440
v_mfma_f32_16x16x32_bf16 v[152:155], v[80:83], v[76:79], v[152:155]
ds_read_b64_tr_b16 v[220:221], v16 offset:57344
v_mfma_f32_16x16x32_bf16 v[156:159], v[84:87], v[76:79], v[156:159]
ds_read_b64_tr_b16 v[222:223], v16 offset:61440
v_mfma_f32_16x16x32_bf16 v[148:151], v[84:87], v[72:75], v[148:151]
ds_read_b128 v[196:199], v18 offset:41984
v_mfma_f32_16x16x32_bf16 v[140:143], v[84:87], v[68:71], v[140:143]
ds_read_b128 v[200:203], v18 offset:43008
v_mfma_f32_16x16x32_bf16 v[132:135], v[84:87], v[64:67], v[132:135]
ds_read_b128 v[204:207], v18 offset:44032
v_mfma_f32_16x16x32_bf16 v[160:163], v[88:91], v[64:67], v[160:163]
v_mfma_f32_16x16x32_bf16 v[168:171], v[88:91], v[68:71], v[168:171]
v_mfma_f32_16x16x32_bf16 v[176:179], v[88:91], v[72:75], v[176:179]
v_mfma_f32_16x16x32_bf16 v[184:187], v[88:91], v[76:79], v[184:187]
v_mfma_f32_16x16x32_bf16 v[188:191], v[92:95], v[76:79], v[188:191]
v_mfma_f32_16x16x32_bf16 v[180:183], v[92:95], v[72:75], v[180:183]
v_mfma_f32_16x16x32_bf16 v[172:175], v[92:95], v[68:71], v[172:175]
v_mfma_f32_16x16x32_bf16 v[164:167], v[92:95], v[64:67], v[164:167]
s_waitcnt lgkmcnt(0)
s_barrier
v_mfma_f32_16x16x32_bf16 v[128:131], v[112:115], v[96:99], v[128:131]
ds_read_b128 v[32:35], v19 offset:0
v_mfma_f32_16x16x32_bf16 v[136:139], v[112:115], v[100:103], v[136:139]
ds_read_b64_tr_b16 v[48:49], v9 offset:0
v_mfma_f32_16x16x32_bf16 v[144:147], v[112:115], v[104:107], v[144:147]
ds_read_b64_tr_b16 v[50:51], v9 offset:4096
v_mfma_f32_16x16x32_bf16 v[152:155], v[112:115], v[108:111], v[152:155]
ds_read_b64_tr_b16 v[52:53], v10 offset:0
v_mfma_f32_16x16x32_bf16 v[156:159], v[116:119], v[108:111], v[156:159]
ds_read_b64_tr_b16 v[54:55], v10 offset:4096
v_mfma_f32_16x16x32_bf16 v[148:151], v[116:119], v[104:107], v[148:151]
ds_read_b64_tr_b16 v[56:57], v11 offset:0
v_mfma_f32_16x16x32_bf16 v[140:143], v[116:119], v[100:103], v[140:143]
ds_read_b64_tr_b16 v[58:59], v11 offset:4096
v_mfma_f32_16x16x32_bf16 v[132:135], v[116:119], v[96:99], v[132:135]
ds_read_b64_tr_b16 v[60:61], v12 offset:0
v_mfma_f32_16x16x32_bf16 v[160:163], v[120:123], v[96:99], v[160:163]
ds_read_b64_tr_b16 v[62:63], v12 offset:4096
v_mfma_f32_16x16x32_bf16 v[168:171], v[120:123], v[100:103], v[168:171]
ds_read_b128 v[36:39], v19 offset:1024
v_mfma_f32_16x16x32_bf16 v[176:179], v[120:123], v[104:107], v[176:179]
ds_read_b128 v[40:43], v19 offset:2048
v_mfma_f32_16x16x32_bf16 v[184:187], v[120:123], v[108:111], v[184:187]
ds_read_b128 v[44:47], v19 offset:3072
v_mfma_f32_16x16x32_bf16 v[188:191], v[124:127], v[108:111], v[188:191]
ds_read_b128 v[64:67], v19 offset:8192
v_mfma_f32_16x16x32_bf16 v[180:183], v[124:127], v[104:107], v[180:183]
ds_read_b64_tr_b16 v[80:81], v9 offset:8192
v_mfma_f32_16x16x32_bf16 v[172:175], v[124:127], v[100:103], v[172:175]
ds_read_b64_tr_b16 v[82:83], v9 offset:12288
v_mfma_f32_16x16x32_bf16 v[164:167], v[124:127], v[96:99], v[164:167]
ds_read_b64_tr_b16 v[84:85], v10 offset:8192
v_mfma_f32_16x16x32_bf16 v[128:131], v[208:211], v[192:195], v[128:131]
ds_read_b64_tr_b16 v[86:87], v10 offset:12288
v_mfma_f32_16x16x32_bf16 v[136:139], v[208:211], v[196:199], v[136:139]
ds_read_b64_tr_b16 v[88:89], v11 offset:8192
v_mfma_f32_16x16x32_bf16 v[144:147], v[208:211], v[200:203], v[144:147]
ds_read_b64_tr_b16 v[90:91], v11 offset:12288
v_mfma_f32_16x16x32_bf16 v[152:155], v[208:211], v[204:207], v[152:155]
ds_read_b64_tr_b16 v[92:93], v12 offset:8192
v_mfma_f32_16x16x32_bf16 v[156:159], v[212:215], v[204:207], v[156:159]
ds_read_b64_tr_b16 v[94:95], v12 offset:12288
v_mfma_f32_16x16x32_bf16 v[148:151], v[212:215], v[200:203], v[148:151]
ds_read_b128 v[68:71], v19 offset:9216
v_mfma_f32_16x16x32_bf16 v[140:143], v[212:215], v[196:199], v[140:143]
ds_read_b128 v[72:75], v19 offset:10240
v_mfma_f32_16x16x32_bf16 v[132:135], v[212:215], v[192:195], v[132:135]
ds_read_b128 v[76:79], v19 offset:11264
v_mfma_f32_16x16x32_bf16 v[160:163], v[216:219], v[192:195], v[160:163]
v_mfma_f32_16x16x32_bf16 v[168:171], v[216:219], v[196:199], v[168:171]
v_mfma_f32_16x16x32_bf16 v[176:179], v[216:219], v[200:203], v[176:179]
v_mfma_f32_16x16x32_bf16 v[184:187], v[216:219], v[204:207], v[184:187]
v_mfma_f32_16x16x32_bf16 v[188:191], v[220:223], v[204:207], v[188:191]
v_mfma_f32_16x16x32_bf16 v[180:183], v[220:223], v[200:203], v[180:183]
v_mfma_f32_16x16x32_bf16 v[172:175], v[220:223], v[196:199], v[172:175]
v_mfma_f32_16x16x32_bf16 v[164:167], v[220:223], v[192:195], v[164:167]
s_waitcnt lgkmcnt(0)
s_barrier
v_mfma_f32_16x16x32_bf16 v[128:131], v[48:51], v[32:35], v[128:131]
ds_read_b128 v[96:99], v17 offset:16384
v_mfma_f32_16x16x32_bf16 v[136:139], v[48:51], v[36:39], v[136:139]
ds_read_b64_tr_b16 v[112:113], v9 offset:32768
v_mfma_f32_16x16x32_bf16 v[144:147], v[48:51], v[40:43], v[144:147]
ds_read_b64_tr_b16 v[114:115], v9 offset:36864
v_mfma_f32_16x16x32_bf16 v[152:155], v[48:51], v[44:47], v[152:155]
ds_read_b64_tr_b16 v[116:117], v10 offset:32768
v_mfma_f32_16x16x32_bf16 v[156:159], v[52:55], v[44:47], v[156:159]
ds_read_b64_tr_b16 v[118:119], v10 offset:36864
v_mfma_f32_16x16x32_bf16 v[148:151], v[52:55], v[40:43], v[148:151]
ds_read_b64_tr_b16 v[120:121], v11 offset:32768
v_mfma_f32_16x16x32_bf16 v[140:143], v[52:55], v[36:39], v[140:143]
ds_read_b64_tr_b16 v[122:123], v11 offset:36864
v_mfma_f32_16x16x32_bf16 v[132:135], v[52:55], v[32:35], v[132:135]
ds_read_b64_tr_b16 v[124:125], v12 offset:32768
v_mfma_f32_16x16x32_bf16 v[160:163], v[56:59], v[32:35], v[160:163]
ds_read_b64_tr_b16 v[126:127], v12 offset:36864
v_mfma_f32_16x16x32_bf16 v[168:171], v[56:59], v[36:39], v[168:171]
ds_read_b128 v[100:103], v17 offset:17408
v_mfma_f32_16x16x32_bf16 v[176:179], v[56:59], v[40:43], v[176:179]
ds_read_b128 v[104:107], v17 offset:18432
v_mfma_f32_16x16x32_bf16 v[184:187], v[56:59], v[44:47], v[184:187]
ds_read_b128 v[108:111], v17 offset:19456
v_mfma_f32_16x16x32_bf16 v[188:191], v[60:63], v[44:47], v[188:191]
ds_read_b128 v[192:195], v17 offset:24576
v_mfma_f32_16x16x32_bf16 v[180:183], v[60:63], v[40:43], v[180:183]
ds_read_b64_tr_b16 v[208:209], v9 offset:40960
v_mfma_f32_16x16x32_bf16 v[172:175], v[60:63], v[36:39], v[172:175]
ds_read_b64_tr_b16 v[210:211], v9 offset:45056
v_mfma_f32_16x16x32_bf16 v[164:167], v[60:63], v[32:35], v[164:167]
ds_read_b64_tr_b16 v[212:213], v10 offset:40960
v_mfma_f32_16x16x32_bf16 v[128:131], v[80:83], v[64:67], v[128:131]
ds_read_b64_tr_b16 v[214:215], v10 offset:45056
v_mfma_f32_16x16x32_bf16 v[136:139], v[80:83], v[68:71], v[136:139]
ds_read_b64_tr_b16 v[216:217], v11 offset:40960
v_mfma_f32_16x16x32_bf16 v[144:147], v[80:83], v[72:75], v[144:147]
ds_read_b64_tr_b16 v[218:219], v11 offset:45056
v_mfma_f32_16x16x32_bf16 v[152:155], v[80:83], v[76:79], v[152:155]
ds_read_b64_tr_b16 v[220:221], v12 offset:40960
v_mfma_f32_16x16x32_bf16 v[156:159], v[84:87], v[76:79], v[156:159]
ds_read_b64_tr_b16 v[222:223], v12 offset:45056
v_mfma_f32_16x16x32_bf16 v[148:151], v[84:87], v[72:75], v[148:151]
ds_read_b128 v[196:199], v17 offset:25600
v_mfma_f32_16x16x32_bf16 v[140:143], v[84:87], v[68:71], v[140:143]
ds_read_b128 v[200:203], v17 offset:26624
v_mfma_f32_16x16x32_bf16 v[132:135], v[84:87], v[64:67], v[132:135]
ds_read_b128 v[204:207], v17 offset:27648
v_mfma_f32_16x16x32_bf16 v[160:163], v[88:91], v[64:67], v[160:163]
v_mfma_f32_16x16x32_bf16 v[168:171], v[88:91], v[68:71], v[168:171]
v_mfma_f32_16x16x32_bf16 v[176:179], v[88:91], v[72:75], v[176:179]
v_mfma_f32_16x16x32_bf16 v[184:187], v[88:91], v[76:79], v[184:187]
v_mfma_f32_16x16x32_bf16 v[188:191], v[92:95], v[76:79], v[188:191]
v_mfma_f32_16x16x32_bf16 v[180:183], v[92:95], v[72:75], v[180:183]
v_mfma_f32_16x16x32_bf16 v[172:175], v[92:95], v[68:71], v[172:175]
v_mfma_f32_16x16x32_bf16 v[164:167], v[92:95], v[64:67], v[164:167]
s_waitcnt lgkmcnt(0)
s_barrier
v_mfma_f32_16x16x32_bf16 v[128:131], v[112:115], v[96:99], v[128:131]
ds_read_b128 v[32:35], v17 offset:49152
v_mfma_f32_16x16x32_bf16 v[136:139], v[112:115], v[100:103], v[136:139]
ds_read_b64_tr_b16 v[48:49], v13 offset:0
v_mfma_f32_16x16x32_bf16 v[144:147], v[112:115], v[104:107], v[144:147]
ds_read_b64_tr_b16 v[50:51], v13 offset:4096
v_mfma_f32_16x16x32_bf16 v[152:155], v[112:115], v[108:111], v[152:155]
ds_read_b64_tr_b16 v[52:53], v14 offset:0
v_mfma_f32_16x16x32_bf16 v[156:159], v[116:119], v[108:111], v[156:159]
ds_read_b64_tr_b16 v[54:55], v14 offset:4096
v_mfma_f32_16x16x32_bf16 v[148:151], v[116:119], v[104:107], v[148:151]
ds_read_b64_tr_b16 v[56:57], v15 offset:0
v_mfma_f32_16x16x32_bf16 v[140:143], v[116:119], v[100:103], v[140:143]
ds_read_b64_tr_b16 v[58:59], v15 offset:4096
v_mfma_f32_16x16x32_bf16 v[132:135], v[116:119], v[96:99], v[132:135]
ds_read_b64_tr_b16 v[60:61], v16 offset:0
v_mfma_f32_16x16x32_bf16 v[160:163], v[120:123], v[96:99], v[160:163]
ds_read_b64_tr_b16 v[62:63], v16 offset:4096
v_mfma_f32_16x16x32_bf16 v[168:171], v[120:123], v[100:103], v[168:171]
ds_read_b128 v[36:39], v17 offset:50176
v_mfma_f32_16x16x32_bf16 v[176:179], v[120:123], v[104:107], v[176:179]
ds_read_b128 v[40:43], v17 offset:51200
v_mfma_f32_16x16x32_bf16 v[184:187], v[120:123], v[108:111], v[184:187]
ds_read_b128 v[44:47], v17 offset:52224
v_mfma_f32_16x16x32_bf16 v[188:191], v[124:127], v[108:111], v[188:191]
ds_read_b128 v[64:67], v17 offset:57344
v_mfma_f32_16x16x32_bf16 v[180:183], v[124:127], v[104:107], v[180:183]
ds_read_b64_tr_b16 v[80:81], v13 offset:8192
v_mfma_f32_16x16x32_bf16 v[172:175], v[124:127], v[100:103], v[172:175]
ds_read_b64_tr_b16 v[82:83], v13 offset:12288
v_mfma_f32_16x16x32_bf16 v[164:167], v[124:127], v[96:99], v[164:167]
ds_read_b64_tr_b16 v[84:85], v14 offset:8192
v_mfma_f32_16x16x32_bf16 v[128:131], v[208:211], v[192:195], v[128:131]
ds_read_b64_tr_b16 v[86:87], v14 offset:12288
v_mfma_f32_16x16x32_bf16 v[136:139], v[208:211], v[196:199], v[136:139]
ds_read_b64_tr_b16 v[88:89], v15 offset:8192
v_mfma_f32_16x16x32_bf16 v[144:147], v[208:211], v[200:203], v[144:147]
ds_read_b64_tr_b16 v[90:91], v15 offset:12288
v_mfma_f32_16x16x32_bf16 v[152:155], v[208:211], v[204:207], v[152:155]
ds_read_b64_tr_b16 v[92:93], v16 offset:8192
v_mfma_f32_16x16x32_bf16 v[156:159], v[212:215], v[204:207], v[156:159]
ds_read_b64_tr_b16 v[94:95], v16 offset:12288
v_mfma_f32_16x16x32_bf16 v[148:151], v[212:215], v[200:203], v[148:151]
ds_read_b128 v[68:71], v17 offset:58368
v_mfma_f32_16x16x32_bf16 v[140:143], v[212:215], v[196:199], v[140:143]
ds_read_b128 v[72:75], v17 offset:59392
v_mfma_f32_16x16x32_bf16 v[132:135], v[212:215], v[192:195], v[132:135]
ds_read_b128 v[76:79], v17 offset:60416
v_mfma_f32_16x16x32_bf16 v[160:163], v[216:219], v[192:195], v[160:163]
v_mfma_f32_16x16x32_bf16 v[168:171], v[216:219], v[196:199], v[168:171]
v_mfma_f32_16x16x32_bf16 v[176:179], v[216:219], v[200:203], v[176:179]
v_mfma_f32_16x16x32_bf16 v[184:187], v[216:219], v[204:207], v[184:187]
v_mfma_f32_16x16x32_bf16 v[188:191], v[220:223], v[204:207], v[188:191]
v_mfma_f32_16x16x32_bf16 v[180:183], v[220:223], v[200:203], v[180:183]
v_mfma_f32_16x16x32_bf16 v[172:175], v[220:223], v[196:199], v[172:175]
v_mfma_f32_16x16x32_bf16 v[164:167], v[220:223], v[192:195], v[164:167]
s_waitcnt lgkmcnt(0)
s_barrier
v_mfma_f32_16x16x32_bf16 v[128:131], v[48:51], v[32:35], v[128:131]
ds_read_b128 v[96:99], v18 offset:16384
v_mfma_f32_16x16x32_bf16 v[136:139], v[48:51], v[36:39], v[136:139]
ds_read_b64_tr_b16 v[112:113], v25 offset:16384
v_mfma_f32_16x16x32_bf16 v[144:147], v[48:51], v[40:43], v[144:147]
ds_read_b64_tr_b16 v[114:115], v25 offset:20480
v_mfma_f32_16x16x32_bf16 v[152:155], v[48:51], v[44:47], v[152:155]
ds_read_b64_tr_b16 v[116:117], v26 offset:16384
v_mfma_f32_16x16x32_bf16 v[156:159], v[52:55], v[44:47], v[156:159]
ds_read_b64_tr_b16 v[118:119], v26 offset:20480
v_mfma_f32_16x16x32_bf16 v[148:151], v[52:55], v[40:43], v[148:151]
ds_read_b64_tr_b16 v[120:121], v27 offset:16384
v_mfma_f32_16x16x32_bf16 v[140:143], v[52:55], v[36:39], v[140:143]
ds_read_b64_tr_b16 v[122:123], v27 offset:20480
v_mfma_f32_16x16x32_bf16 v[132:135], v[52:55], v[32:35], v[132:135]
ds_read_b64_tr_b16 v[124:125], v28 offset:16384
v_mfma_f32_16x16x32_bf16 v[160:163], v[56:59], v[32:35], v[160:163]
ds_read_b64_tr_b16 v[126:127], v28 offset:20480
v_mfma_f32_16x16x32_bf16 v[168:171], v[56:59], v[36:39], v[168:171]
ds_read_b128 v[100:103], v18 offset:17408
v_mfma_f32_16x16x32_bf16 v[176:179], v[56:59], v[40:43], v[176:179]
ds_read_b128 v[104:107], v18 offset:18432
v_mfma_f32_16x16x32_bf16 v[184:187], v[56:59], v[44:47], v[184:187]
ds_read_b128 v[108:111], v18 offset:19456
v_mfma_f32_16x16x32_bf16 v[188:191], v[60:63], v[44:47], v[188:191]
ds_read_b128 v[192:195], v18 offset:24576
v_mfma_f32_16x16x32_bf16 v[180:183], v[60:63], v[40:43], v[180:183]
ds_read_b64_tr_b16 v[208:209], v25 offset:24576
v_mfma_f32_16x16x32_bf16 v[172:175], v[60:63], v[36:39], v[172:175]
ds_read_b64_tr_b16 v[210:211], v25 offset:28672
v_mfma_f32_16x16x32_bf16 v[164:167], v[60:63], v[32:35], v[164:167]
ds_read_b64_tr_b16 v[212:213], v26 offset:24576
v_mfma_f32_16x16x32_bf16 v[128:131], v[80:83], v[64:67], v[128:131]
ds_read_b64_tr_b16 v[214:215], v26 offset:28672
v_mfma_f32_16x16x32_bf16 v[136:139], v[80:83], v[68:71], v[136:139]
ds_read_b64_tr_b16 v[216:217], v27 offset:24576
v_mfma_f32_16x16x32_bf16 v[144:147], v[80:83], v[72:75], v[144:147]
ds_read_b64_tr_b16 v[218:219], v27 offset:28672
v_mfma_f32_16x16x32_bf16 v[152:155], v[80:83], v[76:79], v[152:155]
ds_read_b64_tr_b16 v[220:221], v28 offset:24576
v_mfma_f32_16x16x32_bf16 v[156:159], v[84:87], v[76:79], v[156:159]
ds_read_b64_tr_b16 v[222:223], v28 offset:28672
v_mfma_f32_16x16x32_bf16 v[148:151], v[84:87], v[72:75], v[148:151]
ds_read_b128 v[196:199], v18 offset:25600
v_mfma_f32_16x16x32_bf16 v[140:143], v[84:87], v[68:71], v[140:143]
ds_read_b128 v[200:203], v18 offset:26624
v_mfma_f32_16x16x32_bf16 v[132:135], v[84:87], v[64:67], v[132:135]
ds_read_b128 v[204:207], v18 offset:27648
v_mfma_f32_16x16x32_bf16 v[160:163], v[88:91], v[64:67], v[160:163]
v_mfma_f32_16x16x32_bf16 v[168:171], v[88:91], v[68:71], v[168:171]
v_mfma_f32_16x16x32_bf16 v[176:179], v[88:91], v[72:75], v[176:179]
v_mfma_f32_16x16x32_bf16 v[184:187], v[88:91], v[76:79], v[184:187]
v_mfma_f32_16x16x32_bf16 v[188:191], v[92:95], v[76:79], v[188:191]
v_mfma_f32_16x16x32_bf16 v[180:183], v[92:95], v[72:75], v[180:183]
v_mfma_f32_16x16x32_bf16 v[172:175], v[92:95], v[68:71], v[172:175]
v_mfma_f32_16x16x32_bf16 v[164:167], v[92:95], v[64:67], v[164:167]
s_waitcnt lgkmcnt(0)
s_barrier
v_mfma_f32_16x16x32_bf16 v[128:131], v[112:115], v[96:99], v[128:131]
ds_read_b128 v[32:35], v18 offset:32768
v_mfma_f32_16x16x32_bf16 v[136:139], v[112:115], v[100:103], v[136:139]
ds_read_b64_tr_b16 v[48:49], v13 offset:49152
v_mfma_f32_16x16x32_bf16 v[144:147], v[112:115], v[104:107], v[144:147]
ds_read_b64_tr_b16 v[50:51], v13 offset:53248
v_mfma_f32_16x16x32_bf16 v[152:155], v[112:115], v[108:111], v[152:155]
ds_read_b64_tr_b16 v[52:53], v14 offset:49152
v_mfma_f32_16x16x32_bf16 v[156:159], v[116:119], v[108:111], v[156:159]
ds_read_b64_tr_b16 v[54:55], v14 offset:53248
v_mfma_f32_16x16x32_bf16 v[148:151], v[116:119], v[104:107], v[148:151]
ds_read_b64_tr_b16 v[56:57], v15 offset:49152
v_mfma_f32_16x16x32_bf16 v[140:143], v[116:119], v[100:103], v[140:143]
ds_read_b64_tr_b16 v[58:59], v15 offset:53248
v_mfma_f32_16x16x32_bf16 v[132:135], v[116:119], v[96:99], v[132:135]
ds_read_b64_tr_b16 v[60:61], v16 offset:49152
v_mfma_f32_16x16x32_bf16 v[160:163], v[120:123], v[96:99], v[160:163]
ds_read_b64_tr_b16 v[62:63], v16 offset:53248
v_mfma_f32_16x16x32_bf16 v[168:171], v[120:123], v[100:103], v[168:171]
ds_read_b128 v[36:39], v18 offset:33792
v_mfma_f32_16x16x32_bf16 v[176:179], v[120:123], v[104:107], v[176:179]
ds_read_b128 v[40:43], v18 offset:34816
v_mfma_f32_16x16x32_bf16 v[184:187], v[120:123], v[108:111], v[184:187]
ds_read_b128 v[44:47], v18 offset:35840
v_mfma_f32_16x16x32_bf16 v[188:191], v[124:127], v[108:111], v[188:191]
ds_read_b128 v[64:67], v18 offset:40960
v_mfma_f32_16x16x32_bf16 v[180:183], v[124:127], v[104:107], v[180:183]
ds_read_b64_tr_b16 v[80:81], v13 offset:57344
v_mfma_f32_16x16x32_bf16 v[172:175], v[124:127], v[100:103], v[172:175]
ds_read_b64_tr_b16 v[82:83], v13 offset:61440
v_mfma_f32_16x16x32_bf16 v[164:167], v[124:127], v[96:99], v[164:167]
ds_read_b64_tr_b16 v[84:85], v14 offset:57344
v_mfma_f32_16x16x32_bf16 v[128:131], v[208:211], v[192:195], v[128:131]
ds_read_b64_tr_b16 v[86:87], v14 offset:61440
v_mfma_f32_16x16x32_bf16 v[136:139], v[208:211], v[196:199], v[136:139]
ds_read_b64_tr_b16 v[88:89], v15 offset:57344
v_mfma_f32_16x16x32_bf16 v[144:147], v[208:211], v[200:203], v[144:147]
ds_read_b64_tr_b16 v[90:91], v15 offset:61440
v_mfma_f32_16x16x32_bf16 v[152:155], v[208:211], v[204:207], v[152:155]
ds_read_b64_tr_b16 v[92:93], v16 offset:57344
v_mfma_f32_16x16x32_bf16 v[156:159], v[212:215], v[204:207], v[156:159]
ds_read_b64_tr_b16 v[94:95], v16 offset:61440
v_mfma_f32_16x16x32_bf16 v[148:151], v[212:215], v[200:203], v[148:151]
ds_read_b128 v[68:71], v18 offset:41984
v_mfma_f32_16x16x32_bf16 v[140:143], v[212:215], v[196:199], v[140:143]
ds_read_b128 v[72:75], v18 offset:43008
v_mfma_f32_16x16x32_bf16 v[132:135], v[212:215], v[192:195], v[132:135]
ds_read_b128 v[76:79], v18 offset:44032
v_mfma_f32_16x16x32_bf16 v[160:163], v[216:219], v[192:195], v[160:163]
v_mfma_f32_16x16x32_bf16 v[168:171], v[216:219], v[196:199], v[168:171]
v_mfma_f32_16x16x32_bf16 v[176:179], v[216:219], v[200:203], v[176:179]
v_mfma_f32_16x16x32_bf16 v[184:187], v[216:219], v[204:207], v[184:187]
v_mfma_f32_16x16x32_bf16 v[188:191], v[220:223], v[204:207], v[188:191]
v_mfma_f32_16x16x32_bf16 v[180:183], v[220:223], v[200:203], v[180:183]
v_mfma_f32_16x16x32_bf16 v[172:175], v[220:223], v[196:199], v[172:175]
v_mfma_f32_16x16x32_bf16 v[164:167], v[220:223], v[192:195], v[164:167]
s_waitcnt lgkmcnt(0)
s_barrier
v_mfma_f32_16x16x32_bf16 v[128:131], v[48:51], v[32:35], v[128:131]
ds_read_b128 v[96:99], v19 offset:0
v_mfma_f32_16x16x32_bf16 v[136:139], v[48:51], v[36:39], v[136:139]
ds_read_b64_tr_b16 v[112:113], v9 offset:0
v_mfma_f32_16x16x32_bf16 v[144:147], v[48:51], v[40:43], v[144:147]
ds_read_b64_tr_b16 v[114:115], v9 offset:4096
v_mfma_f32_16x16x32_bf16 v[152:155], v[48:51], v[44:47], v[152:155]
ds_read_b64_tr_b16 v[116:117], v10 offset:0
v_mfma_f32_16x16x32_bf16 v[156:159], v[52:55], v[44:47], v[156:159]
ds_read_b64_tr_b16 v[118:119], v10 offset:4096
v_mfma_f32_16x16x32_bf16 v[148:151], v[52:55], v[40:43], v[148:151]
ds_read_b64_tr_b16 v[120:121], v11 offset:0
v_mfma_f32_16x16x32_bf16 v[140:143], v[52:55], v[36:39], v[140:143]
ds_read_b64_tr_b16 v[122:123], v11 offset:4096
v_mfma_f32_16x16x32_bf16 v[132:135], v[52:55], v[32:35], v[132:135]
ds_read_b64_tr_b16 v[124:125], v12 offset:0
v_mfma_f32_16x16x32_bf16 v[160:163], v[56:59], v[32:35], v[160:163]
ds_read_b64_tr_b16 v[126:127], v12 offset:4096
v_mfma_f32_16x16x32_bf16 v[168:171], v[56:59], v[36:39], v[168:171]
ds_read_b128 v[100:103], v19 offset:1024
v_mfma_f32_16x16x32_bf16 v[176:179], v[56:59], v[40:43], v[176:179]
ds_read_b128 v[104:107], v19 offset:2048
v_mfma_f32_16x16x32_bf16 v[184:187], v[56:59], v[44:47], v[184:187]
ds_read_b128 v[108:111], v19 offset:3072
v_mfma_f32_16x16x32_bf16 v[188:191], v[60:63], v[44:47], v[188:191]
ds_read_b128 v[192:195], v19 offset:8192
v_mfma_f32_16x16x32_bf16 v[180:183], v[60:63], v[40:43], v[180:183]
ds_read_b64_tr_b16 v[208:209], v9 offset:8192
v_mfma_f32_16x16x32_bf16 v[172:175], v[60:63], v[36:39], v[172:175]
ds_read_b64_tr_b16 v[210:211], v9 offset:12288
v_mfma_f32_16x16x32_bf16 v[164:167], v[60:63], v[32:35], v[164:167]
ds_read_b64_tr_b16 v[212:213], v10 offset:8192
v_mfma_f32_16x16x32_bf16 v[128:131], v[80:83], v[64:67], v[128:131]
ds_read_b64_tr_b16 v[214:215], v10 offset:12288
v_mfma_f32_16x16x32_bf16 v[136:139], v[80:83], v[68:71], v[136:139]
ds_read_b64_tr_b16 v[216:217], v11 offset:8192
v_mfma_f32_16x16x32_bf16 v[144:147], v[80:83], v[72:75], v[144:147]
ds_read_b64_tr_b16 v[218:219], v11 offset:12288
v_mfma_f32_16x16x32_bf16 v[152:155], v[80:83], v[76:79], v[152:155]
ds_read_b64_tr_b16 v[220:221], v12 offset:8192
v_mfma_f32_16x16x32_bf16 v[156:159], v[84:87], v[76:79], v[156:159]
ds_read_b64_tr_b16 v[222:223], v12 offset:12288
v_mfma_f32_16x16x32_bf16 v[148:151], v[84:87], v[72:75], v[148:151]
ds_read_b128 v[196:199], v19 offset:9216
v_mfma_f32_16x16x32_bf16 v[140:143], v[84:87], v[68:71], v[140:143]
ds_read_b128 v[200:203], v19 offset:10240
v_mfma_f32_16x16x32_bf16 v[132:135], v[84:87], v[64:67], v[132:135]
ds_read_b128 v[204:207], v19 offset:11264
v_mfma_f32_16x16x32_bf16 v[160:163], v[88:91], v[64:67], v[160:163]
v_mfma_f32_16x16x32_bf16 v[168:171], v[88:91], v[68:71], v[168:171]
v_mfma_f32_16x16x32_bf16 v[176:179], v[88:91], v[72:75], v[176:179]
v_mfma_f32_16x16x32_bf16 v[184:187], v[88:91], v[76:79], v[184:187]
v_mfma_f32_16x16x32_bf16 v[188:191], v[92:95], v[76:79], v[188:191]
v_mfma_f32_16x16x32_bf16 v[180:183], v[92:95], v[72:75], v[180:183]
v_mfma_f32_16x16x32_bf16 v[172:175], v[92:95], v[68:71], v[172:175]
v_mfma_f32_16x16x32_bf16 v[164:167], v[92:95], v[64:67], v[164:167]
s_sub_u32 s41, s41, 1
s_cmp_lg_u32 s41, 0
s_cbranch_scc1 Lk4_121
s_waitcnt lgkmcnt(0)
s_barrier
v_mfma_f32_16x16x32_bf16 v[128:131], v[112:115], v[96:99], v[128:131]
ds_read_b128 v[32:35], v17 offset:16384
v_mfma_f32_16x16x32_bf16 v[136:139], v[112:115], v[100:103], v[136:139]
ds_read_b64_tr_b16 v[48:49], v224 offset:32768
v_mfma_f32_16x16x32_bf16 v[144:147], v[112:115], v[104:107], v[144:147]
ds_read_b64_tr_b16 v[50:51], v224 offset:34816
v_mfma_f32_16x16x32_bf16 v[152:155], v[112:115], v[108:111], v[152:155]
ds_read_b64_tr_b16 v[52:53], v225 offset:32768
v_mfma_f32_16x16x32_bf16 v[156:159], v[116:119], v[108:111], v[156:159]
ds_read_b64_tr_b16 v[54:55], v225 offset:34816
v_mfma_f32_16x16x32_bf16 v[148:151], v[116:119], v[104:107], v[148:151]
ds_read_b128 v[36:39], v17 offset:17408
v_mfma_f32_16x16x32_bf16 v[140:143], v[116:119], v[100:103], v[140:143]
ds_read_b128 v[40:43], v17 offset:18432
v_mfma_f32_16x16x32_bf16 v[132:135], v[116:119], v[96:99], v[132:135]
ds_read_b128 v[44:47], v17 offset:19456
v_mfma_f32_16x16x32_bf16 v[160:163], v[120:123], v[96:99], v[160:163]
ds_read_b128 v[64:67], v17 offset:24576
v_mfma_f32_16x16x32_bf16 v[168:171], v[120:123], v[100:103], v[168:171]
ds_read_b64_tr_b16 v[80:81], v224 offset:36864
v_mfma_f32_16x16x32_bf16 v[176:179], v[120:123], v[104:107], v[176:179]
ds_read_b64_tr_b16 v[82:83], v224 offset:38912
v_mfma_f32_16x16x32_bf16 v[184:187], v[120:123], v[108:111], v[184:187]
ds_read_b64_tr_b16 v[84:85], v225 offset:36864
v_mfma_f32_16x16x32_bf16 v[188:191], v[124:127], v[108:111], v[188:191]
ds_read_b64_tr_b16 v[86:87], v225 offset:38912
v_mfma_f32_16x16x32_bf16 v[180:183], v[124:127], v[104:107], v[180:183]
ds_read_b128 v[68:71], v17 offset:25600
v_mfma_f32_16x16x32_bf16 v[172:175], v[124:127], v[100:103], v[172:175]
ds_read_b128 v[72:75], v17 offset:26624
v_mfma_f32_16x16x32_bf16 v[164:167], v[124:127], v[96:99], v[164:167]
ds_read_b128 v[76:79], v17 offset:27648
v_mfma_f32_16x16x32_bf16 v[128:131], v[208:211], v[192:195], v[128:131]
v_mfma_f32_16x16x32_bf16 v[136:139], v[208:211], v[196:199], v[136:139]
v_mfma_f32_16x16x32_bf16 v[144:147], v[208:211], v[200:203], v[144:147]
s_branch Lov_12
.p2align 12
.fill 96, 4, 0xbf800000
Lst_12_0:
s_branch Lwr_153
Lst_12_1:
s_branch Lst_16_1
s_nop 0
Lov_12:
v_mfma_f32_16x16x32_bf16 v[152:155], v[208:211], v[204:207], v[152:155]
v_mfma_f32_16x16x32_bf16 v[156:159], v[212:215], v[204:207], v[156:159]
v_mfma_f32_16x16x32_bf16 v[148:151], v[212:215], v[200:203], v[148:151]
v_mfma_f32_16x16x32_bf16 v[140:143], v[212:215], v[196:199], v[140:143]
v_mfma_f32_16x16x32_bf16 v[132:135], v[212:215], v[192:195], v[132:135]
v_mfma_f32_16x16x32_bf16 v[160:163], v[216:219], v[192:195], v[160:163]
v_mfma_f32_16x16x32_bf16 v[168:171], v[216:219], v[196:199], v[168:171]
v_mfma_f32_16x16x32_bf16 v[176:179], v[216:219], v[200:203], v[176:179]
v_mfma_f32_16x16x32_bf16 v[184:187], v[216:219], v[204:207], v[184:187]
v_mfma_f32_16x16x32_bf16 v[188:191], v[220:223], v[204:207], v[188:191]
v_mfma_f32_16x16x32_bf16 v[180:183], v[220:223], v[200:203], v[180:183]
v_mfma_f32_16x16x32_bf16 v[172:175], v[220:223], v[196:199], v[172:175]
v_mfma_f32_16x16x32_bf16 v[164:167], v[220:223], v[192:195], v[164:167]
s_waitcnt lgkmcnt(0)
s_barrier
v_mfma_f32_16x16x32_bf16 v[128:131], v[48:51], v[32:35], v[128:131]
ds_read_b128 v[96:99], v17 offset:49152
ds_read_b64_tr_b16 v[112:113], v226 offset:0
v_mfma_f32_16x16x32_bf16 v[136:139], v[48:51], v[36:39], v[136:139]
ds_read_b64_tr_b16 v[114:115], v226 offset:2048
ds_read_b64_tr_b16 v[116:117], v227 offset:0
v_mfma_f32_16x16x32_bf16 v[144:147], v[48:51], v[40:43], v[144:147]
ds_read_b64_tr_b16 v[118:119], v227 offset:2048
ds_read_b128 v[100:103], v17 offset:50176
v_mfma_f32_16x16x32_bf16 v[152:155], v[48:51], v[44:47], v[152:155]
ds_read_b128 v[104:107], v17 offset:51200
ds_read_b128 v[108:111], v17 offset:52224
v_mfma_f32_16x16x32_bf16 v[156:159], v[52:55], v[44:47], v[156:159]
ds_read_b128 v[192:195], v17 offset:57344
v_mfma_f32_16x16x32_bf16 v[148:151], v[52:55], v[40:43], v[148:151]
ds_read_b64_tr_b16 v[208:209], v226 offset:4096
v_mfma_f32_16x16x32_bf16 v[140:143], v[52:55], v[36:39], v[140:143]
ds_read_b64_tr_b16 v[210:211], v226 offset:6144
v_cvt_pk_bf16_f32 v160, v160, v161
v_cvt_pk_bf16_f32 v161, v162, v163
v_mfma_f32_16x16x32_bf16 v[132:135], v[52:55], v[32:35], v[132:135]
ds_read_b64_tr_b16 v[212:213], v227 offset:4096
v_cvt_pk_bf16_f32 v162, v164, v165
v_cvt_pk_bf16_f32 v163, v166, v167
v_mfma_f32_16x16x32_bf16 v[128:131], v[80:83], v[64:67], v[128:131]
ds_read_b64_tr_b16 v[214:215], v227 offset:6144
v_cvt_pk_bf16_f32 v164, v168, v169
v_cvt_pk_bf16_f32 v165, v170, v171
v_mfma_f32_16x16x32_bf16 v[136:139], v[80:83], v[68:71], v[136:139]
ds_read_b128 v[196:199], v17 offset:58368
v_cvt_pk_bf16_f32 v166, v172, v173
v_cvt_pk_bf16_f32 v167, v174, v175
v_mfma_f32_16x16x32_bf16 v[144:147], v[80:83], v[72:75], v[144:147]
ds_read_b128 v[200:203], v17 offset:59392
v_cvt_pk_bf16_f32 v168, v176, v177
v_cvt_pk_bf16_f32 v169, v178, v179
v_mfma_f32_16x16x32_bf16 v[152:155], v[80:83], v[76:79], v[152:155]
ds_read_b128 v[204:207], v17 offset:60416
v_cvt_pk_bf16_f32 v170, v180, v181
v_cvt_pk_bf16_f32 v171, v182, v183
v_mfma_f32_16x16x32_bf16 v[156:159], v[84:87], v[76:79], v[156:159]
v_cvt_pk_bf16_f32 v172, v184, v185
v_cvt_pk_bf16_f32 v173, v186, v187
v_mfma_f32_16x16x32_bf16 v[148:151], v[84:87], v[72:75], v[148:151]
v_cvt_pk_bf16_f32 v174, v188, v189
v_cvt_pk_bf16_f32 v175, v190, v191
v_mfma_f32_16x16x32_bf16 v[140:143], v[84:87], v[68:71], v[140:143]
v_mfma_f32_16x16x32_bf16 v[132:135], v[84:87], v[64:67], v[132:135]
buffer_store_dwordx4 v[160:163], v2, s[84:87], s45 offen offset:0 sc1
s_waitcnt lgkmcnt(0)
s_barrier
v_mfma_f32_16x16x32_bf16 v[128:131], v[112:115], v[96:99], v[128:131]
ds_read_b128 v[32:35], v18 offset:16384
ds_read_b64_tr_b16 v[48:49], v228 offset:16384
v_mfma_f32_16x16x32_bf16 v[136:139], v[112:115], v[100:103], v[136:139]
ds_read_b64_tr_b16 v[50:51], v228 offset:18432
ds_read_b64_tr_b16 v[52:53], v229 offset:16384
v_mfma_f32_16x16x32_bf16 v[144:147], v[112:115], v[104:107], v[144:147]
ds_read_b64_tr_b16 v[54:55], v229 offset:18432
ds_read_b128 v[36:39], v18 offset:17408
v_mfma_f32_16x16x32_bf16 v[152:155], v[112:115], v[108:111], v[152:155]
ds_read_b128 v[40:43], v18 offset:18432
ds_read_b128 v[44:47], v18 offset:19456
v_mfma_f32_16x16x32_bf16 v[156:159], v[116:119], v[108:111], v[156:159]
ds_read_b128 v[64:67], v18 offset:24576
v_mfma_f32_16x16x32_bf16 v[148:151], v[116:119], v[104:107], v[148:151]
ds_read_b64_tr_b16 v[80:81], v228 offset:20480
v_mfma_f32_16x16x32_bf16 v[140:143], v[116:119], v[100:103], v[140:143]
ds_read_b64_tr_b16 v[82:83], v228 offset:22528
v_mfma_f32_16x16x32_bf16 v[132:135], v[116:119], v[96:99], v[132:135]
ds_read_b64_tr_b16 v[84:85], v229 offset:20480
v_mfma_f32_16x16x32_bf16 v[128:131], v[208:211], v[192:195], v[128:131]
ds_read_b64_tr_b16 v[86:87], v229 offset:22528
buffer_store_dwordx4 v[164:167], v2, s[84:87], s45 offen offset:1024 sc1
v_mfma_f32_16x16x32_bf16 v[136:139], v[208:211], v[196:199], v[136:139]
ds_read_b128 v[68:71], v18 offset:25600
v_mfma_f32_16x16x32_bf16 v[144:147], v[208:211], v[200:203], v[144:147]
ds_read_b128 v[72:75], v18 offset:26624
v_mfma_f32_16x16x32_bf16 v[152:155], v[208:211], v[204:207], v[152:155]
ds_read_b128 v[76:79], v18 offset:27648
v_mfma_f32_16x16x32_bf16 v[156:159], v[212:215], v[204:207], v[156:159]
v_mfma_f32_16x16x32_bf16 v[148:151], v[212:215], v[200:203], v[148:151]
v_mfma_f32_16x16x32_bf16 v[140:143], v[212:215], v[196:199], v[140:143]
v_mfma_f32_16x16x32_bf16 v[132:135], v[212:215], v[192:195], v[132:135]
s_waitcnt lgkmcnt(0)
s_barrier
v_mfma_f32_16x16x32_bf16 v[128:131], v[48:51], v[32:35], v[128:131]
ds_read_b128 v[96:99], v18 offset:32768
ds_read_b64_tr_b16 v[112:113], v226 offset:49152
v_mfma_f32_16x16x32_bf16 v[136:139], v[48:51], v[36:39], v[136:139]
ds_read_b64_tr_b16 v[114:115], v226 offset:51200
ds_read_b64_tr_b16 v[116:117], v227 offset:49152
v_mfma_f32_16x16x32_bf16 v[144:147], v[48:51], v[40:43], v[144:147]
ds_read_b64_tr_b16 v[118:119], v227 offset:51200
ds_read_b128 v[100:103], v18 offset:33792
v_mfma_f32_16x16x32_bf16 v[152:155], v[48:51], v[44:47], v[152:155]
ds_read_b128 v[104:107], v18 offset:34816
ds_read_b128 v[108:111], v18 offset:35840
v_mfma_f32_16x16x32_bf16 v[156:159], v[52:55], v[44:47], v[156:159]
ds_read_b128 v[192:195], v18 offset:40960
v_mfma_f32_16x16x32_bf16 v[148:151], v[52:55], v[40:43], v[148:151]
ds_read_b64_tr_b16 v[208:209], v226 offset:53248
v_mfma_f32_16x16x32_bf16 v[140:143], v[52:55], v[36:39], v[140:143]
ds_read_b64_tr_b16 v[210:211], v226 offset:55296
v_mfma_f32_16x16x32_bf16 v[132:135], v[52:55], v[32:35], v[132:135]
ds_read_b64_tr_b16 v[212:213], v227 offset:53248
v_mfma_f32_16x16x32_bf16 v[128:131], v[80:83], v[64:67], v[128:131]
ds_read_b64_tr_b16 v[214:215], v227 offset:55296
buffer_store_dwordx4 v[168:171], v2, s[84:87], s45 offen offset:2048 sc1
v_mfma_f32_16x16x32_bf16 v[136:139], v[80:83], v[68:71], v[136:139]
ds_read_b128 v[196:199], v18 offset:41984
v_mfma_f32_16x16x32_bf16 v[144:147], v[80:83], v[72:75], v[144:147]
ds_read_b128 v[200:203], v18 offset:43008
v_mfma_f32_16x16x32_bf16 v[152:155], v[80:83], v[76:79], v[152:155]
ds_read_b128 v[204:207], v18 offset:44032
v_mfma_f32_16x16x32_bf16 v[156:159], v[84:87], v[76:79], v[156:159]
v_mfma_f32_16x16x32_bf16 v[148:151], v[84:87], v[72:75], v[148:151]
v_mfma_f32_16x16x32_bf16 v[140:143], v[84:87], v[68:71], v[140:143]
v_mfma_f32_16x16x32_bf16 v[132:135], v[84:87], v[64:67], v[132:135]
s_waitcnt lgkmcnt(0)
s_barrier
v_mfma_f32_16x16x32_bf16 v[128:131], v[112:115], v[96:99], v[128:131]
ds_read_b128 v[32:35], v19 offset:0
ds_read_b64_tr_b16 v[48:49], v224 offset:0
v_mfma_f32_16x16x32_bf16 v[136:139], v[112:115], v[100:103], v[136:139]
ds_read_b64_tr_b16 v[50:51], v224 offset:2048
ds_read_b64_tr_b16 v[52:53], v225 offset:0
v_mfma_f32_16x16x32_bf16 v[144:147], v[112:115], v[104:107], v[144:147]
ds_read_b64_tr_b16 v[54:55], v225 offset:2048
ds_read_b128 v[36:39], v19 offset:1024
v_mfma_f32_16x16x32_bf16 v[152:155], v[112:115], v[108:111], v[152:155]
ds_read_b128 v[40:43], v19 offset:2048
ds_read_b128 v[44:47], v19 offset:3072
v_mfma_f32_16x16x32_bf16 v[156:159], v[116:119], v[108:111], v[156:159]
ds_read_b128 v[64:67], v19 offset:8192
v_mfma_f32_16x16x32_bf16 v[148:151], v[116:119], v[104:107], v[148:151]
ds_read_b64_tr_b16 v[80:81], v224 offset:4096
v_mfma_f32_16x16x32_bf16 v[140:143], v[116:119], v[100:103], v[140:143]
ds_read_b64_tr_b16 v[82:83], v224 offset:6144
v_mfma_f32_16x16x32_bf16 v[132:135], v[116:119], v[96:99], v[132:135]
ds_read_b64_tr_b16 v[84:85], v225 offset:4096
v_mfma_f32_16x16x32_bf16 v[128:131], v[208:211], v[192:195], v[128:131]
ds_read_b64_tr_b16 v[86:87], v225 offset:6144
buffer_store_dwordx4 v[172:175], v2, s[84:87], s45 offen offset:3072 sc1
v_mfma_f32_16x16x32_bf16 v[136:139], v[208:211], v[196:199], v[136:139]
ds_read_b128 v[68:71], v19 offset:9216
v_mfma_f32_16x16x32_bf16 v[144:147], v[208:211], v[200:203], v[144:147]
ds_read_b128 v[72:75], v19 offset:10240
v_mfma_f32_16x16x32_bf16 v[152:155], v[208:211], v[204:207], v[152:155]
ds_read_b128 v[76:79], v19 offset:11264
v_mfma_f32_16x16x32_bf16 v[156:159], v[212:215], v[204:207], v[156:159]
v_mfma_f32_16x16x32_bf16 v[148:151], v[212:215], v[200:203], v[148:151]
v_mfma_f32_16x16x32_bf16 v[140:143], v[212:215], v[196:199], v[140:143]
v_mfma_f32_16x16x32_bf16 v[132:135], v[212:215], v[192:195], v[132:135]
s_waitcnt lgkmcnt(0)
s_barrier
v_mfma_f32_16x16x32_bf16 v[128:131], v[48:51], v[32:35], v[128:131]
ds_read_b128 v[96:99], v17 offset:16384
ds_read_b64_tr_b16 v[112:113], v224 offset:32768
v_mfma_f32_16x16x32_bf16 v[136:139], v[48:51], v[36:39], v[136:139]
ds_read_b64_tr_b16 v[114:115], v224 offset:34816
ds_read_b64_tr_b16 v[116:117], v225 offset:32768
v_mfma_f32_16x16x32_bf16 v[144:147], v[48:51], v[40:43], v[144:147]
ds_read_b64_tr_b16 v[118:119], v225 offset:34816
ds_read_b128 v[100:103], v17 offset:17408
v_mfma_f32_16x16x32_bf16 v[152:155], v[48:51], v[44:47], v[152:155]
ds_read_b128 v[104:107], v17 offset:18432
ds_read_b128 v[108:111], v17 offset:19456
v_mfma_f32_16x16x32_bf16 v[156:159], v[52:55], v[44:47], v[156:159]
ds_read_b128 v[192:195], v17 offset:24576
v_mfma_f32_16x16x32_bf16 v[148:151], v[52:55], v[40:43], v[148:151]
ds_read_b64_tr_b16 v[208:209], v224 offset:36864
v_mfma_f32_16x16x32_bf16 v[140:143], v[52:55], v[36:39], v[140:143]
ds_read_b64_tr_b16 v[210:211], v224 offset:38912
v_mfma_f32_16x16x32_bf16 v[132:135], v[52:55], v[32:35], v[132:135]
ds_read_b64_tr_b16 v[212:213], v225 offset:36864
v_mfma_f32_16x16x32_bf16 v[128:131], v[80:83], v[64:67], v[128:131]
ds_read_b64_tr_b16 v[214:215], v225 offset:38912
v_mfma_f32_16x16x32_bf16 v[136:139], v[80:83], v[68:71], v[136:139]
ds_read_b128 v[196:199], v17 offset:25600
v_mfma_f32_16x16x32_bf16 v[144:147], v[80:83], v[72:75], v[144:147]
ds_read_b128 v[200:203], v17 offset:26624
v_mfma_f32_16x16x32_bf16 v[152:155], v[80:83], v[76:79], v[152:155]
ds_read_b128 v[204:207], v17 offset:27648
v_mfma_f32_16x16x32_bf16 v[156:159], v[84:87], v[76:79], v[156:159]
v_mfma_f32_16x16x32_bf16 v[148:151], v[84:87], v[72:75], v[148:151]
v_mfma_f32_16x16x32_bf16 v[140:143], v[84:87], v[68:71], v[140:143]
v_mfma_f32_16x16x32_bf16 v[132:135], v[84:87], v[64:67], v[132:135]
s_waitcnt vmcnt(0)
s_waitcnt lgkmcnt(0)
s_barrier
v_mfma_f32_16x16x32_bf16 v[128:131], v[112:115], v[96:99], v[128:131]
ds_read_b128 v[32:35], v17 offset:49152
ds_read_b64_tr_b16 v[48:49], v226 offset:0
v_mfma_f32_16x16x32_bf16 v[136:139], v[112:115], v[100:103], v[136:139]
ds_read_b64_tr_b16 v[50:51], v226 offset:2048
ds_read_b64_tr_b16 v[52:53], v227 offset:0
v_mfma_f32_16x16x32_bf16 v[144:147], v[112:115], v[104:107], v[144:147]
ds_read_b64_tr_b16 v[54:55], v227 offset:2048
ds_read_b128 v[36:39], v17 offset:50176
v_mfma_f32_16x16x32_bf16 v[152:155], v[112:115], v[108:111], v[152:155]
ds_read_b128 v[40:43], v17 offset:51200
ds_read_b128 v[44:47], v17 offset:52224
v_mfma_f32_16x16x32_bf16 v[156:159], v[116:119], v[108:111], v[156:159]
ds_read_b128 v[64:67], v17 offset:57344
v_mfma_f32_16x16x32_bf16 v[148:151], v[116:119], v[104:107], v[148:151]
ds_read_b64_tr_b16 v[80:81], v226 offset:4096
v_mfma_f32_16x16x32_bf16 v[140:143], v[116:119], v[100:103], v[140:143]
ds_read_b64_tr_b16 v[82:83], v226 offset:6144
v_mfma_f32_16x16x32_bf16 v[132:135], v[116:119], v[96:99], v[132:135]
ds_read_b64_tr_b16 v[84:85], v227 offset:4096
v_mfma_f32_16x16x32_bf16 v[128:131], v[208:211], v[192:195], v[128:131]
ds_read_b64_tr_b16 v[86:87], v227 offset:6144
v_mfma_f32_16x16x32_bf16 v[136:139], v[208:211], v[196:199], v[136:139]
ds_read_b128 v[68:71], v17 offset:58368
v_mfma_f32_16x16x32_bf16 v[144:147], v[208:211], v[200:203], v[144:147]
ds_read_b128 v[72:75], v17 offset:59392
v_mfma_f32_16x16x32_bf16 v[152:155], v[208:211], v[204:207], v[152:155]
ds_read_b128 v[76:79], v17 offset:60416
v_mfma_f32_16x16x32_bf16 v[156:159], v[212:215], v[204:207], v[156:159]
v_mfma_f32_16x16x32_bf16 v[148:151], v[212:215], v[200:203], v[148:151]
v_mfma_f32_16x16x32_bf16 v[140:143], v[212:215], v[196:199], v[140:143]
v_mfma_f32_16x16x32_bf16 v[132:135], v[212:215], v[192:195], v[132:135]
s_waitcnt lgkmcnt(0)
s_barrier
v_mfma_f32_16x16x32_bf16 v[128:131], v[48:51], v[32:35], v[128:131]
ds_read_b128 v[96:99], v18 offset:16384
ds_read_b64_tr_b16 v[112:113], v228 offset:16384
v_mfma_f32_16x16x32_bf16 v[136:139], v[48:51], v[36:39], v[136:139]
ds_read_b64_tr_b16 v[114:115], v228 offset:18432
ds_read_b64_tr_b16 v[116:117], v229 offset:16384
v_mfma_f32_16x16x32_bf16 v[144:147], v[48:51], v[40:43], v[144:147]
ds_read_b64_tr_b16 v[118:119], v229 offset:18432
ds_read_b128 v[100:103], v18 offset:17408
v_mfma_f32_16x16x32_bf16 v[152:155], v[48:51], v[44:47], v[152:155]
ds_read_b128 v[104:107], v18 offset:18432
ds_read_b128 v[108:111], v18 offset:19456
v_mfma_f32_16x16x32_bf16 v[156:159], v[52:55], v[44:47], v[156:159]
ds_read_b128 v[192:195], v18 offset:24576
v_mfma_f32_16x16x32_bf16 v[148:151], v[52:55], v[40:43], v[148:151]
ds_read_b64_tr_b16 v[208:209], v228 offset:20480
v_mfma_f32_16x16x32_bf16 v[140:143], v[52:55], v[36:39], v[140:143]
ds_read_b64_tr_b16 v[210:211], v228 offset:22528
v_mfma_f32_16x16x32_bf16 v[132:135], v[52:55], v[32:35], v[132:135]
ds_read_b64_tr_b16 v[212:213], v229 offset:20480
v_mfma_f32_16x16x32_bf16 v[128:131], v[80:83], v[64:67], v[128:131]
ds_read_b64_tr_b16 v[214:215], v229 offset:22528
v_mfma_f32_16x16x32_bf16 v[136:139], v[80:83], v[68:71], v[136:139]
ds_read_b128 v[196:199], v18 offset:25600
v_mfma_f32_16x16x32_bf16 v[144:147], v[80:83], v[72:75], v[144:147]
ds_read_b128 v[200:203], v18 offset:26624
v_mfma_f32_16x16x32_bf16 v[152:155], v[80:83], v[76:79], v[152:155]
ds_read_b128 v[204:207], v18 offset:27648
v_mfma_f32_16x16x32_bf16 v[156:159], v[84:87], v[76:79], v[156:159]
v_mfma_f32_16x16x32_bf16 v[148:151], v[84:87], v[72:75], v[148:151]
v_mfma_f32_16x16x32_bf16 v[140:143], v[84:87], v[68:71], v[140:143]
v_mfma_f32_16x16x32_bf16 v[132:135], v[84:87], v[64:67], v[132:135]
s_waitcnt lgkmcnt(0)
s_barrier
v_mfma_f32_16x16x32_bf16 v[128:131], v[112:115], v[96:99], v[128:131]
ds_read_b128 v[32:35], v18 offset:32768
ds_read_b64_tr_b16 v[48:49], v226 offset:49152
v_mfma_f32_16x16x32_bf16 v[136:139], v[112:115], v[100:103], v[136:139]
ds_read_b64_tr_b16 v[50:51], v226 offset:51200
ds_read_b64_tr_b16 v[52:53], v227 offset:49152
v_mfma_f32_16x16x32_bf16 v[144:147], v[112:115], v[104:107], v[144:147]
ds_read_b64_tr_b16 v[54:55], v227 offset:51200
ds_read_b128 v[36:39], v18 offset:33792
v_mfma_f32_16x16x32_bf16 v[152:155], v[112:115], v[108:111], v[152:155]
ds_read_b128 v[40:43], v18 offset:34816
ds_read_b128 v[44:47], v18 offset:35840
v_mfma_f32_16x16x32_bf16 v[156:159], v[116:119], v[108:111], v[156:159]
ds_read_b128 v[64:67], v18 offset:40960
v_mfma_f32_16x16x32_bf16 v[148:151], v[116:119], v[104:107], v[148:151]
ds_read_b64_tr_b16 v[80:81], v226 offset:53248
v_mfma_f32_16x16x32_bf16 v[140:143], v[116:119], v[100:103], v[140:143]
ds_read_b64_tr_b16 v[82:83], v226 offset:55296
v_mfma_f32_16x16x32_bf16 v[132:135], v[116:119], v[96:99], v[132:135]
ds_read_b64_tr_b16 v[84:85], v227 offset:53248
v_mfma_f32_16x16x32_bf16 v[128:131], v[208:211], v[192:195], v[128:131]
ds_read_b64_tr_b16 v[86:87], v227 offset:55296
v_mfma_f32_16x16x32_bf16 v[136:139], v[208:211], v[196:199], v[136:139]
ds_read_b128 v[68:71], v18 offset:41984
v_mfma_f32_16x16x32_bf16 v[144:147], v[208:211], v[200:203], v[144:147]
ds_read_b128 v[72:75], v18 offset:43008
v_mfma_f32_16x16x32_bf16 v[152:155], v[208:211], v[204:207], v[152:155]
ds_read_b128 v[76:79], v18 offset:44032
v_mfma_f32_16x16x32_bf16 v[156:159], v[212:215], v[204:207], v[156:159]
v_mfma_f32_16x16x32_bf16 v[148:151], v[212:215], v[200:203], v[148:151]
v_mfma_f32_16x16x32_bf16 v[140:143], v[212:215], v[196:199], v[140:143]
v_mfma_f32_16x16x32_bf16 v[132:135], v[212:215], v[192:195], v[132:135]
s_waitcnt lgkmcnt(0)
s_barrier
buffer_load_dwordx4 v[232:235], v2, s[84:87], s46 offen offset:0 sc1
buffer_load_dwordx4 v[236:239], v2, s[84:87], s46 offen offset:1024 sc1
buffer_load_dwordx4 v[240:243], v2, s[84:87], s46 offen offset:2048 sc1
buffer_load_dwordx4 v[244:247], v2, s[84:87], s46 offen offset:3072 sc1
v_mfma_f32_16x16x32_bf16 v[128:131], v[48:51], v[32:35], v[128:131]
ds_read_b128 v[96:99], v19 offset:0
ds_read_b64_tr_b16 v[112:113], v224 offset:0
v_mfma_f32_16x16x32_bf16 v[136:139], v[48:51], v[36:39], v[136:139]
ds_read_b64_tr_b16 v[114:115], v224 offset:2048
ds_read_b64_tr_b16 v[116:117], v225 offset:0
v_mfma_f32_16x16x32_bf16 v[144:147], v[48:51], v[40:43], v[144:147]
ds_read_b64_tr_b16 v[118:119], v225 offset:2048
ds_read_b128 v[100:103], v19 offset:1024
v_mfma_f32_16x16x32_bf16 v[152:155], v[48:51], v[44:47], v[152:155]
ds_read_b128 v[104:107], v19 offset:2048
ds_read_b128 v[108:111], v19 offset:3072
v_mfma_f32_16x16x32_bf16 v[156:159], v[52:55], v[44:47], v[156:159]
ds_read_b128 v[192:195], v19 offset:8192
v_mfma_f32_16x16x32_bf16 v[148:151], v[52:55], v[40:43], v[148:151]
ds_read_b64_tr_b16 v[208:209], v224 offset:4096
v_mfma_f32_16x16x32_bf16 v[140:143], v[52:55], v[36:39], v[140:143]
ds_read_b64_tr_b16 v[210:211], v224 offset:6144
v_mfma_f32_16x16x32_bf16 v[132:135], v[52:55], v[32:35], v[132:135]
ds_read_b64_tr_b16 v[212:213], v225 offset:4096
v_mfma_f32_16x16x32_bf16 v[128:131], v[80:83], v[64:67], v[128:131]
ds_read_b64_tr_b16 v[214:215], v225 offset:6144
v_mfma_f32_16x16x32_bf16 v[136:139], v[80:83], v[68:71], v[136:139]
ds_read_b128 v[196:199], v19 offset:9216
v_mfma_f32_16x16x32_bf16 v[144:147], v[80:83], v[72:75], v[144:147]
ds_read_b128 v[200:203], v19 offset:10240
v_mfma_f32_16x16x32_bf16 v[152:155], v[80:83], v[76:79], v[152:155]
ds_read_b128 v[204:207], v19 offset:11264
v_mfma_f32_16x16x32_bf16 v[156:159], v[84:87], v[76:79], v[156:159]
v_mfma_f32_16x16x32_bf16 v[148:151], v[84:87], v[72:75], v[148:151]
v_mfma_f32_16x16x32_bf16 v[140:143], v[84:87], v[68:71], v[140:143]
v_mfma_f32_16x16x32_bf16 v[132:135], v[84:87], v[64:67], v[132:135]
s_waitcnt lgkmcnt(0)
s_barrier
v_mfma_f32_16x16x32_bf16 v[128:131], v[112:115], v[96:99], v[128:131]
ds_read_b128 v[32:35], v17 offset:16384
ds_read_b64_tr_b16 v[48:49], v224 offset:32768
v_mfma_f32_16x16x32_bf16 v[136:139], v[112:115], v[100:103], v[136:139]
ds_read_b64_tr_b16 v[50:51], v224 offset:34816
ds_read_b64_tr_b16 v[52:53], v225 offset:32768
v_mfma_f32_16x16x32_bf16 v[144:147], v[112:115], v[104:107], v[144:147]
ds_read_b64_tr_b16 v[54:55], v225 offset:34816
ds_read_b128 v[36:39], v17 offset:17408
v_mfma_f32_16x16x32_bf16 v[152:155], v[112:115], v[108:111], v[152:155]
ds_read_b128 v[40:43], v17 offset:18432
ds_read_b128 v[44:47], v17 offset:19456
v_mfma_f32_16x16x32_bf16 v[156:159], v[116:119], v[108:111], v[156:159]
ds_read_b128 v[64:67], v17 offset:24576
v_mfma_f32_16x16x32_bf16 v[148:151], v[116:119], v[104:107], v[148:151]
ds_read_b64_tr_b16 v[80:81], v224 offset:36864
v_mfma_f32_16x16x32_bf16 v[140:143], v[116:119], v[100:103], v[140:143]
ds_read_b64_tr_b16 v[82:83], v224 offset:38912
v_mfma_f32_16x16x32_bf16 v[132:135], v[116:119], v[96:99], v[132:135]
ds_read_b64_tr_b16 v[84:85], v225 offset:36864
v_mfma_f32_16x16x32_bf16 v[128:131], v[208:211], v[192:195], v[128:131]
ds_read_b64_tr_b16 v[86:87], v225 offset:38912
v_mfma_f32_16x16x32_bf16 v[136:139], v[208:211], v[196:199], v[136:139]
ds_read_b128 v[68:71], v17 offset:25600
v_mfma_f32_16x16x32_bf16 v[144:147], v[208:211], v[200:203], v[144:147]
ds_read_b128 v[72:75], v17 offset:26624
v_mfma_f32_16x16x32_bf16 v[152:155], v[208:211], v[204:207], v[152:155]
ds_read_b128 v[76:79], v17 offset:27648
v_mfma_f32_16x16x32_bf16 v[156:159], v[212:215], v[204:207], v[156:159]
v_mfma_f32_16x16x32_bf16 v[148:151], v[212:215], v[200:203], v[148:151]
v_mfma_f32_16x16x32_bf16 v[140:143], v[212:215], v[196:199], v[140:143]
v_mfma_f32_16x16x32_bf16 v[132:135], v[212:215], v[192:195], v[132:135]
s_waitcnt lgkmcnt(0)
s_barrier
v_mfma_f32_16x16x32_bf16 v[128:131], v[48:51], v[32:35], v[128:131]
ds_read_b128 v[96:99], v17 offset:49152
ds_read_b64_tr_b16 v[112:113], v226 offset:0
v_mfma_f32_16x16x32_bf16 v[136:139], v[48:51], v[36:39], v[136:139]
ds_read_b64_tr_b16 v[114:115], v226 offset:2048
ds_read_b64_tr_b16 v[116:117], v227 offset:0
v_mfma_f32_16x16x32_bf16 v[144:147], v[48:51], v[40:43], v[144:147]
ds_read_b64_tr_b16 v[118:119], v227 offset:2048
ds_read_b128 v[100:103], v17 offset:50176
v_mfma_f32_16x16x32_bf16 v[152:155], v[48:51], v[44:47], v[152:155]
ds_read_b128 v[104:107], v17 offset:51200
ds_read_b128 v[108:111], v17 offset:52224
v_mfma_f32_16x16x32_bf16 v[156:159], v[52:55], v[44:47], v[156:159]
ds_read_b128 v[192:195], v17 offset:57344
v_mfma_f32_16x16x32_bf16 v[148:151], v[52:55], v[40:43], v[148:151]
ds_read_b64_tr_b16 v[208:209], v226 offset:4096
v_mfma_f32_16x16x32_bf16 v[140:143], v[52:55], v[36:39], v[140:143]
ds_read_b64_tr_b16 v[210:211], v226 offset:6144
v_mfma_f32_16x16x32_bf16 v[132:135], v[52:55], v[32:35], v[132:135]
ds_read_b64_tr_b16 v[212:213], v227 offset:4096
v_mfma_f32_16x16x32_bf16 v[128:131], v[80:83], v[64:67], v[128:131]
ds_read_b64_tr_b16 v[214:215], v227 offset:6144
v_mfma_f32_16x16x32_bf16 v[136:139], v[80:83], v[68:71], v[136:139]
ds_read_b128 v[196:199], v17 offset:58368
v_mfma_f32_16x16x32_bf16 v[144:147], v[80:83], v[72:75], v[144:147]
ds_read_b128 v[200:203], v17 offset:59392
v_mfma_f32_16x16x32_bf16 v[152:155], v[80:83], v[76:79], v[152:155]
ds_read_b128 v[204:207], v17 offset:60416
v_mfma_f32_16x16x32_bf16 v[156:159], v[84:87], v[76:79], v[156:159]
v_mfma_f32_16x16x32_bf16 v[148:151], v[84:87], v[72:75], v[148:151]
v_mfma_f32_16x16x32_bf16 v[140:143], v[84:87], v[68:71], v[140:143]
v_mfma_f32_16x16x32_bf16 v[132:135], v[84:87], v[64:67], v[132:135]
s_waitcnt vmcnt(0)
s_waitcnt lgkmcnt(0)
s_barrier
v_mfma_f32_16x16x32_bf16 v[128:131], v[112:115], v[96:99], v[128:131]
v_lshlrev_b32 v160, 16, v232
v_and_b32 v161, 0xffff0000, v232
v_lshlrev_b32 v162, 16, v233
v_and_b32 v163, 0xffff0000, v233
v_mfma_f32_16x16x32_bf16 v[132:135], v[116:119], v[96:99], v[132:135]
v_lshlrev_b32 v164, 16, v234
v_and_b32 v165, 0xffff0000, v234
v_lshlrev_b32 v166, 16, v235
v_and_b32 v167, 0xffff0000, v235
v_mfma_f32_16x16x32_bf16 v[128:131], v[208:211], v[192:195], v[128:131]
v_lshlrev_b32 v168, 16, v236
v_and_b32 v169, 0xffff0000, v236
v_lshlrev_b32 v170, 16, v237
v_and_b32 v171, 0xffff0000, v237
v_mfma_f32_16x16x32_bf16 v[132:135], v[212:215], v[192:195], v[132:135]
v_lshlrev_b32 v172, 16, v238
v_and_b32 v173, 0xffff0000, v238
v_lshlrev_b32 v174, 16, v239
v_and_b32 v175, 0xffff0000, v239
v_mfma_f32_16x16x32_bf16 v[136:139], v[112:115], v[100:103], v[136:139]
v_lshlrev_b32 v176, 16, v240
v_and_b32 v177, 0xffff0000, v240
v_lshlrev_b32 v178, 16, v241
v_and_b32 v179, 0xffff0000, v241
v_mfma_f32_16x16x32_bf16 v[140:143], v[116:119], v[100:103], v[140:143]
v_lshlrev_b32 v180, 16, v242
v_and_b32 v181, 0xffff0000, v242
v_lshlrev_b32 v182, 16, v243
v_and_b32 v183, 0xffff0000, v243
v_mfma_f32_16x16x32_bf16 v[136:139], v[208:211], v[196:199], v[136:139]
v_lshlrev_b32 v184, 16, v244
v_and_b32 v185, 0xffff0000, v244
v_lshlrev_b32 v186, 16, v245
v_and_b32 v187, 0xffff0000, v245
v_mfma_f32_16x16x32_bf16 v[140:143], v[212:215], v[196:199], v[140:143]
v_lshlrev_b32 v188, 16, v246
v_and_b32 v189, 0xffff0000, v246
v_lshlrev_b32 v190, 16, v247
v_and_b32 v191, 0xffff0000, v247
v_mfma_f32_16x16x32_bf16 v[144:147], v[112:115], v[104:107], v[144:147]
v_add_f32 v128, v128, v160
v_add_f32 v129, v129, v161
v_add_f32 v130, v130, v162
v_mfma_f32_16x16x32_bf16 v[148:151], v[116:119], v[104:107], v[148:151]
v_add_f32 v131, v131, v163
v_add_f32 v132, v132, v164
v_add_f32 v133, v133, v165
v_mfma_f32_16x16x32_bf16 v[144:147], v[208:211], v[200:203], v[144:147]
v_add_f32 v134, v134, v166
v_add_f32 v135, v135, v167
v_cvt_pk_bf16_f32 v232, v128, v129
v_mfma_f32_16x16x32_bf16 v[148:151], v[212:215], v[200:203], v[148:151]
v_cvt_pk_bf16_f32 v233, v130, v131
v_cvt_pk_bf16_f32 v234, v132, v133
v_cvt_pk_bf16_f32 v235, v134, v135
v_mfma_f32_16x16x32_bf16 v[152:155], v[112:115], v[108:111], v[152:155]
v_add_f32 v136, v136, v168
v_add_f32 v137, v137, v169
v_add_f32 v138, v138, v170
v_mfma_f32_16x16x32_bf16 v[156:159], v[116:119], v[108:111], v[156:159]
v_add_f32 v139, v139, v171
v_add_f32 v140, v140, v172
v_add_f32 v141, v141, v173
v_add_f32 v142, v142, v174
v_mfma_f32_16x16x32_bf16 v[152:155], v[208:211], v[204:207], v[152:155]
v_add_f32 v143, v143, v175
v_cvt_pk_bf16_f32 v236, v136, v137
v_cvt_pk_bf16_f32 v237, v138, v139
v_cvt_pk_bf16_f32 v238, v140, v141
v_mfma_f32_16x16x32_bf16 v[156:159], v[212:215], v[204:207], v[156:159]
v_cvt_pk_bf16_f32 v239, v142, v143
v_permlane16_swap_b32 v232, v234
v_permlane16_swap_b32 v233, v235
buffer_store_dwordx4 v[232:235], v230, s[20:23], s54 offen offset:0 nt
v_permlane16_swap_b32 v236, v238
v_permlane16_swap_b32 v237, v239
buffer_store_dwordx4 v[236:239], v230, s[20:23], s54 offen offset:2048 nt
s_branch Lov_13
.p2align 12
.fill 96, 4, 0xbf800000
Lst_13_0:
s_branch Lwr_154
Lst_13_1:
s_branch Lst_17_1
s_nop 0
Lov_13:
v_add_f32 v144, v144, v176
v_add_f32 v145, v145, v177
v_add_f32 v146, v146, v178
v_add_f32 v147, v147, v179
v_add_f32 v148, v148, v180
v_add_f32 v149, v149, v181
v_add_f32 v150, v150, v182
v_add_f32 v151, v151, v183
v_cvt_pk_bf16_f32 v240, v144, v145
v_cvt_pk_bf16_f32 v241, v146, v147
v_cvt_pk_bf16_f32 v242, v148, v149
v_cvt_pk_bf16_f32 v243, v150, v151
s_nop 0
v_add_f32 v152, v152, v184
v_add_f32 v153, v153, v185
v_add_f32 v154, v154, v186
v_add_f32 v155, v155, v187
v_add_f32 v156, v156, v188
v_add_f32 v157, v157, v189
v_add_f32 v158, v158, v190
v_add_f32 v159, v159, v191
v_cvt_pk_bf16_f32 v244, v152, v153
v_cvt_pk_bf16_f32 v245, v154, v155
v_cvt_pk_bf16_f32 v246, v156, v157
v_cvt_pk_bf16_f32 v247, v158, v159
v_permlane16_swap_b32 v240, v242
v_permlane16_swap_b32 v241, v243
buffer_store_dwordx4 v[240:243], v230, s[20:23], s55 offen offset:0 nt
v_permlane16_swap_b32 v244, v246
v_permlane16_swap_b32 v245, v247
buffer_store_dwordx4 v[244:247], v230, s[20:23], s55 offen offset:2048 nt
s_branch Ldone_1
Lgb_97:
s_mul_i32 s43, s34, 262144
s_add_u32 s8, s82, s43
s_addc_u32 s9, s83, 0
s_add_u32 s8, s8, 4194304
s_addc_u32 s9, s9, 0
s_mov_b32 s10, 262144
s_mov_b32 s11, 0x20000
s_lshl_b32 s39, s36, 12
v_lshlrev_b32 v2, 4, v1
v_add_u32 v3, s39, v2
s_add_u32 s37, s35, 0
s_and_b32 s37, s37, 15
s_mul_i32 s37, s37, 16384
s_add_u32 m0, s39, 0
s_nop 0
buffer_load_dwordx4 v3, s[8:11], s37 offen sc1 lds
buffer_load_dwordx4 v3, s[8:11], s37 offen offset:1024 sc1 lds
buffer_load_dwordx4 v3, s[8:11], s37 offen offset:2048 sc1 lds
buffer_load_dwordx4 v3, s[8:11], s37 offen offset:3072 sc1 lds
s_mul_i32 s43, s34, 262144
s_add_u32 s8, s82, s43
s_addc_u32 s9, s83, 0
s_add_u32 s8, s8, 4194304
s_addc_u32 s9, s9, 0
s_mov_b32 s10, 262144
s_mov_b32 s11, 0x20000
s_mul_i32 s43, s34, 917504
s_add_u32 s24, s82, s43
s_addc_u32 s25, s83, 0
s_add_u32 s24, s24, 8388608
s_addc_u32 s25, s25, 0
s_mov_b32 s26, 917504
s_mov_b32 s27, 0x20000
s_add_u32 s84, s82, 27262976
s_addc_u32 s85, s83, 0
s_mov_b32 s86, 229376
s_mov_b32 s87, 0x20000
s_and_b32 s47, s36, 3
s_lshr_b32 s62, s47, 1
s_and_b32 s63, s47, 1
v_lshlrev_b32 v2, 4, v1
s_lshl_b32 s39, s47, 12
v_add_u32 v3, s39, v2
s_bitcmp0_b32 s36, 1
s_cselect_b32 s44, s72, s74
s_cselect_b32 s45, s73, s75
s_mul_i32 s43, s35, 256
s_add_u32 s12, s44, s43
s_addc_u32 s13, s45, 0
s_mov_b32 s14, 7333120
s_mov_b32 s15, 0x20000
s_and_b32 s43, s36, 1
s_mul_i32 s43, s43, 229376
v_lshrrev_b32 v28, 4, v1
v_lshlrev_b32 v29, 1, v28
v_and_b32 v4, 15, v1
v_xor_b32 v4, v4, v29
v_lshlrev_b32 v4, 4, v4
v_mul_u32_u24 v28, 7168, v28
v_add_u32 v4, v4, v28
v_add_u32 v4, s43, v4
v_xor_b32 v5, 128, v4
v_add_u32 v5, 28672, v5
s_and_b32 s43, s36, 3
s_mul_i32 s40, s43, 8192
s_add_u32 s40, s40, 16384
v_mov_b32 v6, v192
v_mov_b32 v7, v193
v_mov_b32 v8, v194
s_lshl_b32 s43, s62, 12
v_add_u32 v9, s43, v2
v_add_u32 v10, 98304, v9
v_mov_b32 v24, v195
s_mul_i32 s43, s34, 16384
s_add_u32 s20, s82, s43
s_addc_u32 s21, s83, 0
s_add_u32 s20, s20, 25165824
s_addc_u32 s21, s21, 0
s_mov_b32 s22, 16384
s_mov_b32 s23, 0x20000
s_add_u32 s38, s35, 2
s_and_b32 s38, s38, 15
s_mul_i32 s38, s38, 458752
s_add_u32 m0, s50, 98304
s_nop 0
buffer_load_dwordx4 v6, s[16:19], s38 offen lds
s_add_u32 m0, s50, 99328
s_nop 0
buffer_load_dwordx4 v7, s[16:19], s38 offen lds
s_add_u32 m0, s50, 100352
s_nop 0
buffer_load_dwordx4 v8, s[16:19], s38 offen lds
s_add_u32 m0, s50, 101376
s_add_u32 s38, s38, 114688
buffer_load_dwordx4 v6, s[16:19], s38 offen lds
s_add_u32 m0, s50, 102400
s_nop 0
buffer_load_dwordx4 v7, s[16:19], s38 offen lds
s_add_u32 m0, s50, 103424
s_nop 0
buffer_load_dwordx4 v8, s[16:19], s38 offen lds
s_cmp_eq_u32 s47, 1
s_cbranch_scc0 Lw_122
s_lshl_b32 s92, s34, 4
s_add_u32 s92, s92, s35
s_lshl_b32 s92, s92, 8
s_add_u32 s92, s92, 49280
s_add_u32 s92, s92, 28311552
s_mov_b32 s41, 0x40000
Lpoll_123:
s_load_dword s93, s[82:83], s92 glc
Lpchk_125:
s_waitcnt lgkmcnt(0)
s_cmp_eq_u32 s93, 16
s_cbranch_scc1 Lpok_124
s_sub_u32 s41, s41, 1
s_cmp_lg_u32 s41, 0
s_cbranch_scc1 Lpoll_123
Lpok_124:
Lw_122:
s_waitcnt vmcnt(0)
s_barrier
s_add_u32 s37, s35, 1
s_and_b32 s37, s37, 15
s_mul_i32 s37, s37, 16384
s_add_u32 m0, s39, 49152
s_nop 0
buffer_load_dwordx4 v3, s[8:11], s37 offen sc1 lds
buffer_load_dwordx4 v3, s[8:11], s37 offen offset:1024 sc1 lds
buffer_load_dwordx4 v3, s[8:11], s37 offen offset:2048 sc1 lds
buffer_load_dwordx4 v3, s[8:11], s37 offen offset:3072 sc1 lds
s_add_u32 s37, s35, 2
s_and_b32 s37, s37, 15
s_mul_i32 s37, s37, 16384
s_add_u32 m0, s39, 98304
s_nop 0
buffer_load_dwordx4 v3, s[8:11], s37 offen sc1 lds
buffer_load_dwordx4 v3, s[8:11], s37 offen offset:1024 sc1 lds
buffer_load_dwordx4 v3, s[8:11], s37 offen offset:2048 sc1 lds
buffer_load_dwordx4 v3, s[8:11], s37 offen offset:3072 sc1 lds
buffer_load_dwordx4 v[96:99], v3, s[20:23], 0 offen offset:0 sc1
buffer_load_dwordx4 v[100:103], v3, s[20:23], 0 offen offset:1024 sc1
buffer_load_dwordx4 v[104:107], v3, s[20:23], 0 offen offset:2048 sc1
buffer_load_dwordx4 v[108:111], v3, s[20:23], 0 offen offset:3072 sc1
s_and_b32 s44, s36, 3
s_mul_i32 s44, s44, 14
s_bfe_u32 s43, s2, 0x30001
s_lshl_b32 s43, s43, 7
s_add_u32 s44, s44, s43
s_add_u32 s44, s44, 72
s_mul_i32 s44, s44, 7168
s_lshr_b32 s43, s2, 4
s_lshl_b32 s43, s43, 8
s_add_u32 s43, s43, s44
s_bitcmp0_b32 s2, 0
s_cselect_b32 s4, s72, s74
s_cselect_b32 s5, s73, s75
s_add_u32 s4, s4, s43
s_addc_u32 s5, s5, 0
s_waitcnt vmcnt(8)
s_barrier
s_cmp_eq_u32 s47, 3
s_cbranch_scc0 Lw_126
v_and_b32 v90, 31, v1
v_lshlrev_b32 v90, 4, v90
v_add_u32 v91, 151552, v90
ds_read_b128 v[112:115], v91 offset:0
ds_read_b128 v[116:119], v91 offset:512
ds_read_b128 v[120:123], v91 offset:1024
ds_read_b128 v[124:127], v91 offset:1536
s_and_b32 s44, s2, 15
s_mul_i32 s44, s44, 14336
s_lshr_b32 s43, s2, 4
s_lshl_b32 s43, s43, 9
s_add_u32 s44, s44, s43
s_add_u32 s44, s44, 8192
s_cmp_lt_u32 s2, 192
s_cselect_b32 s44, s44, 0x7fffffff
s_waitcnt lgkmcnt(0)
v_add_f32 v112, v112, v116
v_add_f32 v120, v120, v124
v_add_f32 v113, v113, v117
v_add_f32 v121, v121, v125
v_add_f32 v114, v114, v118
v_add_f32 v122, v122, v126
v_add_f32 v115, v115, v119
v_add_f32 v123, v123, v127
v_add_f32 v112, v112, v120
v_add_f32 v113, v113, v121
v_add_f32 v114, v114, v122
v_add_f32 v115, v115, v123
s_mov_b64 exec, 0xffffffff
buffer_store_dwordx4 v[112:115], v90, s[84:87], s44 offen sc1
s_mov_b64 exec, -1
Lw_126:
s_add_u32 s37, s35, 3
s_and_b32 s37, s37, 15
s_mul_i32 s37, s37, 16384
s_add_u32 m0, s39, 0
s_nop 0
buffer_load_dwordx4 v3, s[8:11], s37 offen sc1 lds
buffer_load_dwordx4 v3, s[8:11], s37 offen offset:1024 sc1 lds
s_load_dword s3, s[4:5], 78848
buffer_load_dwordx4 v3, s[8:11], s37 offen offset:2048 sc1 lds
buffer_load_dwordx4 v3, s[8:11], s37 offen offset:3072 sc1 lds
s_load_dword s3, s[4:5], 78912
s_add_u32 s38, s35, 3
s_and_b32 s38, s38, 15
s_mul_i32 s38, s38, 458752
s_add_u32 m0, s50, 0
s_nop 0
buffer_load_dwordx4 v6, s[16:19], s38 offen lds
s_load_dword s3, s[4:5], 78976
s_add_u32 m0, s50, 1024
s_nop 0
buffer_load_dwordx4 v7, s[16:19], s38 offen lds
s_add_u32 m0, s50, 2048
s_nop 0
buffer_load_dwordx4 v8, s[16:19], s38 offen lds
s_load_dword s3, s[4:5], 79040
s_add_u32 m0, s50, 3072
s_add_u32 s38, s38, 114688
buffer_load_dwordx4 v6, s[16:19], s38 offen lds
s_load_dword s3, s[4:5], 86016
s_add_u32 m0, s50, 4096
s_nop 0
buffer_load_dwordx4 v7, s[16:19], s38 offen lds
s_add_u32 m0, s50, 5120
s_nop 0
buffer_load_dwordx4 v8, s[16:19], s38 offen lds
s_waitcnt vmcnt(14)
s_barrier
s_add_u32 s37, s35, 4
s_and_b32 s37, s37, 15
s_mul_i32 s37, s37, 16384
s_add_u32 m0, s39, 49152
s_nop 0
buffer_load_dwordx4 v3, s[8:11], s37 offen sc1 lds
buffer_load_dwordx4 v3, s[8:11], s37 offen offset:1024 sc1 lds
s_load_dword s3, s[4:5], 86080
buffer_load_dwordx4 v3, s[8:11], s37 offen offset:2048 sc1 lds
buffer_load_dwordx4 v3, s[8:11], s37 offen offset:3072 sc1 lds
s_load_dword s3, s[4:5], 86144
s_add_u32 s38, s35, 4
s_and_b32 s38, s38, 15
s_mul_i32 s38, s38, 458752
s_add_u32 m0, s50, 49152
s_nop 0
buffer_load_dwordx4 v6, s[16:19], s38 offen lds
s_load_dword s3, s[4:5], 86208
s_add_u32 m0, s50, 50176
s_nop 0
buffer_load_dwordx4 v7, s[16:19], s38 offen lds
s_add_u32 m0, s50, 51200
s_nop 0
buffer_load_dwordx4 v8, s[16:19], s38 offen lds
s_load_dword s3, s[4:5], 93184
s_add_u32 m0, s50, 52224
s_add_u32 s38, s38, 114688
buffer_load_dwordx4 v6, s[16:19], s38 offen lds
s_load_dword s3, s[4:5], 93248
s_add_u32 m0, s50, 53248
s_nop 0
buffer_load_dwordx4 v7, s[16:19], s38 offen lds
s_add_u32 m0, s50, 54272
s_nop 0
buffer_load_dwordx4 v8, s[16:19], s38 offen lds
s_waitcnt vmcnt(10)
s_barrier
s_cmp_eq_u32 s47, 3
s_cbranch_scc0 Lw_127
s_cmp_lt_u32 s2, 192
s_cbranch_scc0 Lw_127
s_lshr_b32 s43, s2, 4
s_add_u32 s43, s43, 96
s_lshl_b32 s43, s43, 7
v_mov_b32 v90, s43
v_mov_b32 v91, 1
s_mov_b64 exec, 1
buffer_atomic_add v91, v90, s[56:59], 0 offen sc1
s_mov_b64 exec, -1
Lw_127:
s_add_u32 s37, s35, 5
s_and_b32 s37, s37, 15
s_mul_i32 s37, s37, 16384
s_add_u32 m0, s39, 98304
s_nop 0
buffer_load_dwordx4 v3, s[8:11], s37 offen sc1 lds
v_add_f32 v96, v96, v100
v_add_f32 v97, v97, v101
v_add_f32 v98, v98, v102
buffer_load_dwordx4 v3, s[8:11], s37 offen offset:1024 sc1 lds
v_add_f32 v99, v99, v103
v_add_f32 v104, v104, v108
v_add_f32 v105, v105, v109
buffer_load_dwordx4 v3, s[8:11], s37 offen offset:2048 sc1 lds
v_add_f32 v106, v106, v110
v_add_f32 v107, v107, v111
s_nop 0
buffer_load_dwordx4 v3, s[8:11], s37 offen offset:3072 sc1 lds
v_permlane32_swap_b32 v96, v104
v_permlane32_swap_b32 v97, v105
v_permlane32_swap_b32 v98, v106
v_permlane32_swap_b32 v99, v107
s_add_u32 s38, s35, 5
s_and_b32 s38, s38, 15
s_mul_i32 s38, s38, 458752
s_add_u32 m0, s50, 98304
s_nop 0
buffer_load_dwordx4 v6, s[16:19], s38 offen lds
v_add_f32 v96, v96, v104
v_add_f32 v97, v97, v105
v_add_f32 v98, v98, v106
s_add_u32 m0, s50, 99328
s_nop 0
buffer_load_dwordx4 v7, s[16:19], s38 offen lds
v_add_f32 v99, v99, v107
v_mov_b32 v100, v96
v_mov_b32 v101, v97
s_add_u32 m0, s50, 100352
s_nop 0
buffer_load_dwordx4 v8, s[16:19], s38 offen lds
v_mov_b32 v102, v98
v_mov_b32 v103, v99
s_nop 0
s_add_u32 m0, s50, 101376
s_add_u32 s38, s38, 114688
buffer_load_dwordx4 v6, s[16:19], s38 offen lds
v_permlane16_swap_b32 v96, v100
v_permlane16_swap_b32 v97, v101
v_permlane16_swap_b32 v98, v102
v_permlane16_swap_b32 v99, v103
s_add_u32 m0, s50, 102400
s_nop 0
buffer_load_dwordx4 v7, s[16:19], s38 offen lds
s_add_u32 m0, s50, 103424
s_nop 0
buffer_load_dwordx4 v8, s[16:19], s38 offen lds
s_waitcnt vmcnt(10)
s_barrier
s_add_u32 s37, s35, 6
s_and_b32 s37, s37, 15
s_mul_i32 s37, s37, 16384
s_add_u32 m0, s39, 0
s_nop 0
buffer_load_dwordx4 v3, s[8:11], s37 offen sc1 lds
v_add_f32 v96, v96, v100
v_add_f32 v97, v97, v101
v_add_f32 v98, v98, v102
buffer_load_dwordx4 v3, s[8:11], s37 offen offset:1024 sc1 lds
v_add_f32 v99, v99, v103
s_nop 0
v_add_f32_dpp v96, v96, v96 row_ror:8 row_mask:0xf bank_mask:0xf
buffer_load_dwordx4 v3, s[8:11], s37 offen offset:2048 sc1 lds
v_add_f32_dpp v97, v97, v97 row_ror:8 row_mask:0xf bank_mask:0xf
v_add_f32_dpp v98, v98, v98 row_ror:8 row_mask:0xf bank_mask:0xf
v_add_f32_dpp v99, v99, v99 row_ror:8 row_mask:0xf bank_mask:0xf
v_mul_f32 v96, 0x3a800000, v96
buffer_load_dwordx4 v3, s[8:11], s37 offen offset:3072 sc1 lds
v_mul_f32 v97, 0x3a800000, v97
v_mul_f32 v98, 0x3a800000, v98
v_mul_f32 v99, 0x3a800000, v99
s_add_u32 s38, s35, 6
s_and_b32 s38, s38, 15
s_mul_i32 s38, s38, 458752
s_add_u32 m0, s50, 0
s_nop 0
buffer_load_dwordx4 v6, s[16:19], s38 offen lds
v_fma_f32 v97, -v96, v96, v97
v_fma_f32 v99, -v98, v98, v99
v_max_f32 v97, 0, v97
s_add_u32 m0, s50, 1024
s_nop 0
buffer_load_dwordx4 v7, s[16:19], s38 offen lds
v_max_f32 v99, 0, v99
v_add_f32 v97, 0x3727c5ac, v97
v_add_f32 v99, 0x3727c5ac, v99
v_rsq_f32 v97, v97
s_add_u32 m0, s50, 2048
s_nop 0
buffer_load_dwordx4 v8, s[16:19], s38 offen lds
v_rsq_f32 v99, v99
v_and_b32 v100, 7, v1
s_lshl_b32 s43, s47, 8
s_add_u32 m0, s50, 3072
s_add_u32 s38, s38, 114688
buffer_load_dwordx4 v6, s[16:19], s38 offen lds
s_add_u32 s43, s43, 147456
v_lshl_add_u32 v100, v100, 4, s43
v_lshrrev_b32 v101, 5, v1
v_lshl_add_u32 v100, v101, 7, v100
s_add_u32 m0, s50, 4096
s_nop 0
buffer_load_dwordx4 v7, s[16:19], s38 offen lds
s_add_u32 m0, s50, 5120
s_nop 0
buffer_load_dwordx4 v8, s[16:19], s38 offen lds
s_waitcnt vmcnt(10)
s_barrier
ds_write_b128 v100, v[96:99]
s_waitcnt lgkmcnt(0)
s_add_u32 s37, s35, 7
s_and_b32 s37, s37, 15
s_mul_i32 s37, s37, 16384
s_add_u32 m0, s39, 49152
s_nop 0
buffer_load_dwordx4 v3, s[8:11], s37 offen sc1 lds
s_load_dword s3, s[4:5], 93312
buffer_load_dwordx4 v3, s[8:11], s37 offen offset:1024 sc1 lds
s_load_dword s3, s[4:5], 93376
s_and_b32 s44, s36, 3
buffer_load_dwordx4 v3, s[8:11], s37 offen offset:2048 sc1 lds
s_mul_i32 s43, s2, 28672
buffer_load_dwordx4 v3, s[8:11], s37 offen offset:3072 sc1 lds
s_mul_i32 s44, s44, 7168
s_add_u32 s43, s43, s44
s_add_u32 s38, s35, 7
s_and_b32 s38, s38, 15
s_mul_i32 s38, s38, 458752
s_add_u32 m0, s50, 49152
s_nop 0
buffer_load_dwordx4 v6, s[16:19], s38 offen lds
s_add_u32 s4, s76, s43
s_add_u32 m0, s50, 50176
s_nop 0
buffer_load_dwordx4 v7, s[16:19], s38 offen lds
s_addc_u32 s5, s77, 0
s_load_dword s3, s[4:5], 0
s_add_u32 m0, s50, 51200
s_nop 0
buffer_load_dwordx4 v8, s[16:19], s38 offen lds
s_load_dword s3, s[4:5], 64
s_add_u32 m0, s50, 52224
s_add_u32 s38, s38, 114688
buffer_load_dwordx4 v6, s[16:19], s38 offen lds
s_load_dword s3, s[4:5], 128
s_load_dword s3, s[4:5], 192
s_add_u32 m0, s50, 53248
s_nop 0
buffer_load_dwordx4 v7, s[16:19], s38 offen lds
s_add_u32 m0, s50, 54272
s_nop 0
buffer_load_dwordx4 v8, s[16:19], s38 offen lds
s_waitcnt vmcnt(10)
s_barrier
s_add_u32 s37, s35, 8
s_and_b32 s37, s37, 15
s_mul_i32 s37, s37, 16384
s_add_u32 m0, s39, 98304
s_nop 0
buffer_load_dwordx4 v3, s[8:11], s37 offen sc1 lds
s_load_dword s3, s[4:5], 256
s_load_dword s3, s[4:5], 320
s_load_dword s3, s[4:5], 384
buffer_load_dwordx4 v3, s[8:11], s37 offen offset:1024 sc1 lds
s_load_dword s3, s[4:5], 448
s_load_dword s3, s[4:5], 512
s_load_dword s3, s[4:5], 576
buffer_load_dwordx4 v3, s[8:11], s37 offen offset:2048 sc1 lds
v_lshrrev_b32 v28, 2, v1
v_and_b32 v29, 7, v28
v_mul_u32_u24 v28, 256, v28
buffer_load_dwordx4 v3, s[8:11], s37 offen offset:3072 sc1 lds
v_lshl_add_u32 v28, v29, 5, v28
v_and_b32 v29, 3, v1
v_lshl_add_u32 v11, v29, 3, v28
s_lshl_b32 s43, s63, 7
s_add_u32 s38, s35, 8
s_and_b32 s38, s38, 15
s_mul_i32 s38, s38, 458752
s_add_u32 m0, s50, 98304
s_nop 0
buffer_load_dwordx4 v6, s[16:19], s38 offen lds
v_xor_b32 v11, s43, v11
v_add_u32 v11, 16384, v11
v_xor_b32 v12, 32, v11
s_add_u32 m0, s50, 99328
s_nop 0
buffer_load_dwordx4 v7, s[16:19], s38 offen lds
v_xor_b32 v13, 64, v11
v_xor_b32 v14, 96, v11
v_add_u32 v15, 49152, v11
s_add_u32 m0, s50, 100352
s_nop 0
buffer_load_dwordx4 v8, s[16:19], s38 offen lds
v_add_u32 v16, 49152, v12
v_add_u32 v17, 49152, v13
v_add_u32 v18, 49152, v14
s_add_u32 m0, s50, 101376
s_add_u32 s38, s38, 114688
buffer_load_dwordx4 v6, s[16:19], s38 offen lds
v_add_u32 v19, 98304, v11
v_add_u32 v20, 98304, v12
v_add_u32 v21, 98304, v13
v_add_u32 v22, 98304, v14
s_add_u32 m0, s50, 102400
s_nop 0
buffer_load_dwordx4 v7, s[16:19], s38 offen lds
s_add_u32 m0, s50, 103424
s_nop 0
buffer_load_dwordx4 v8, s[16:19], s38 offen lds
s_waitcnt vmcnt(10)
s_barrier
s_cmp_eq_u32 s47, 3
s_cbranch_scc0 Lw_128
s_mul_i32 s60, s35, 96
s_add_u32 s61, s60, 95
s_and_b32 s60, s60, 0xff80
s_and_b32 s61, s61, 0xff80
s_add_u32 s60, s60, 28323840
s_add_u32 s61, s61, 28323840
s_load_dword s92, s[82:83], s60 glc
s_load_dword s93, s[82:83], s61 glc
Lw_128:
s_add_u32 s37, s35, 9
s_and_b32 s37, s37, 15
s_mul_i32 s37, s37, 16384
s_add_u32 m0, s39, 0
s_nop 0
buffer_load_dwordx4 v3, s[8:11], s37 offen sc1 lds
buffer_load_dwordx4 v3, s[8:11], s37 offen offset:1024 sc1 lds
buffer_load_dwordx4 v3, s[8:11], s37 offen offset:2048 sc1 lds
buffer_load_dwordx4 v3, s[8:11], s37 offen offset:3072 sc1 lds
s_add_u32 s38, s35, 9
s_and_b32 s38, s38, 15
s_mul_i32 s38, s38, 458752
s_add_u32 m0, s50, 0
s_nop 0
buffer_load_dwordx4 v6, s[16:19], s38 offen lds
s_add_u32 m0, s50, 1024
s_nop 0
buffer_load_dwordx4 v7, s[16:19], s38 offen lds
s_add_u32 m0, s50, 2048
s_nop 0
buffer_load_dwordx4 v8, s[16:19], s38 offen lds
s_add_u32 m0, s50, 3072
s_add_u32 s38, s38, 114688
buffer_load_dwordx4 v6, s[16:19], s38 offen lds
s_add_u32 m0, s50, 4096
s_nop 0
buffer_load_dwordx4 v7, s[16:19], s38 offen lds
s_add_u32 m0, s50, 5120
s_nop 0
buffer_load_dwordx4 v8, s[16:19], s38 offen lds
s_waitcnt vmcnt(10)
s_barrier
s_add_u32 s37, s35, 10
s_and_b32 s37, s37, 15
s_mul_i32 s37, s37, 16384
s_add_u32 m0, s39, 49152
s_nop 0
buffer_load_dwordx4 v3, s[8:11], s37 offen sc1 lds
buffer_load_dwordx4 v3, s[8:11], s37 offen offset:1024 sc1 lds
buffer_load_dwordx4 v3, s[8:11], s37 offen offset:2048 sc1 lds
buffer_load_dwordx4 v3, s[8:11], s37 offen offset:3072 sc1 lds
s_add_u32 s38, s35, 10
s_and_b32 s38, s38, 15
s_mul_i32 s38, s38, 458752
s_add_u32 m0, s50, 49152
s_nop 0
buffer_load_dwordx4 v6, s[16:19], s38 offen lds
s_add_u32 m0, s50, 50176
s_nop 0
buffer_load_dwordx4 v7, s[16:19], s38 offen lds
s_add_u32 m0, s50, 51200
s_nop 0
buffer_load_dwordx4 v8, s[16:19], s38 offen lds
s_add_u32 m0, s50, 52224
s_add_u32 s38, s38, 114688
buffer_load_dwordx4 v6, s[16:19], s38 offen lds
s_add_u32 m0, s50, 53248
s_nop 0
buffer_load_dwordx4 v7, s[16:19], s38 offen lds
s_add_u32 m0, s50, 54272
s_nop 0
buffer_load_dwordx4 v8, s[16:19], s38 offen lds
s_mov_b32 s38, 0
buffer_load_dwordx4 v[40:43], v24, s[88:91], s38 offen
s_mov_b32 s38, 28672
buffer_load_dwordx4 v[44:47], v24, s[88:91], s38 offen
s_mov_b32 s38, 57344
buffer_load_dwordx4 v[48:51], v24, s[88:91], s38 offen
s_mov_b32 s38, 86016
s_branch Lov_14
.p2align 12
.fill 112, 4, 0xbf800000
Lst_14_0:
s_branch Lwr_155
Lst_14_1:
s_branch Lst_18_1
s_nop 0
Lov_14:
buffer_load_dwordx4 v[52:55], v24, s[88:91], s38 offen
s_mov_b32 s38, 114688
buffer_load_dwordx4 v[56:59], v24, s[88:91], s38 offen
s_mov_b32 s38, 143360
buffer_load_dwordx4 v[60:63], v24, s[88:91], s38 offen
s_mov_b32 s38, 172032
buffer_load_dwordx4 v[64:67], v24, s[88:91], s38 offen
s_mov_b32 s38, 200704
buffer_load_dwordx4 v[68:71], v24, s[88:91], s38 offen
s_waitcnt vmcnt(18)
s_cmp_eq_u32 s47, 3
s_cbranch_scc0 Lw_129
s_mov_b32 s41, 0x40000
Lcp_130:
s_waitcnt lgkmcnt(0)
s_and_b32 s92, s92, s93
s_cmp_eq_u32 s92, 16
s_cbranch_scc1 Lco_131
s_load_dword s92, s[82:83], s60 glc
s_load_dword s93, s[82:83], s61 glc
s_sub_u32 s41, s41, 1
s_cmp_lg_u32 s41, 0
s_cbranch_scc1 Lcp_130
s_waitcnt lgkmcnt(0)
Lco_131:
Lw_129:
s_barrier
s_mov_b32 s45, s47
s_cmp_ge_u32 s45, 3
s_cselect_b32 s43, 1, 0
s_mul_i32 s44, s43, 3
s_sub_u32 s45, s45, s44
s_lshl_b32 s45, s45, 7
s_mul_i32 s52, s43, 896
s_add_u32 s52, s52, s45
s_add_u32 s52, s52, 148992
s_mul_i32 s43, s43, 14336
s_add_u32 s43, s43, s45
s_mul_i32 s44, s35, 384
s_add_u32 s43, s43, s44
s_add_u32 s60, s43, 8192
s_add_u32 s45, s47, 4
s_min_u32 s45, s45, 5
s_cmp_ge_u32 s45, 3
s_cselect_b32 s43, 1, 0
s_mul_i32 s44, s43, 3
s_sub_u32 s45, s45, s44
s_lshl_b32 s45, s45, 7
s_mul_i32 s53, s43, 896
s_add_u32 s53, s53, s45
s_add_u32 s53, s53, 148992
s_mul_i32 s43, s43, 14336
s_add_u32 s43, s43, s45
s_mul_i32 s44, s35, 384
s_add_u32 s43, s43, s44
s_add_u32 s61, s43, 8192
v_lshrrev_b32 v104, 3, v1
v_mul_u32_u24 v104, 28672, v104
v_and_b32 v105, 7, v1
v_lshl_add_u32 v104, v105, 4, v104
buffer_load_dwordx4 v[96:99], v104, s[84:87], s60 offen sc1
s_load_dword s3, s[4:5], 640
buffer_load_dwordx4 v[100:103], v104, s[84:87], s61 offen sc1
s_load_dword s3, s[4:5], 704
s_add_u32 s37, s35, 11
s_and_b32 s37, s37, 15
s_mul_i32 s37, s37, 16384
s_add_u32 m0, s39, 98304
s_nop 0
buffer_load_dwordx4 v3, s[8:11], s37 offen sc1 lds
s_load_dword s3, s[4:5], 768
buffer_load_dwordx4 v3, s[8:11], s37 offen offset:1024 sc1 lds
s_load_dword s3, s[4:5], 832
s_load_dword s3, s[4:5], 896
buffer_load_dwordx4 v3, s[8:11], s37 offen offset:2048 sc1 lds
s_load_dword s3, s[4:5], 960
buffer_load_dwordx4 v3, s[8:11], s37 offen offset:3072 sc1 lds
v_cmp_gt_u32 vcc, 32, v1
s_add_u32 s38, s35, 11
s_and_b32 s38, s38, 15
s_mul_i32 s38, s38, 458752
s_add_u32 m0, s50, 98304
s_nop 0
buffer_load_dwordx4 v6, s[16:19], s38 offen lds
v_mov_b32 v104, s52
v_mov_b32 v106, s53
s_add_u32 m0, s50, 99328
s_nop 0
buffer_load_dwordx4 v7, s[16:19], s38 offen lds
v_cndmask_b32 v104, v106, v104, vcc
s_add_u32 m0, s50, 100352
s_nop 0
buffer_load_dwordx4 v8, s[16:19], s38 offen lds
v_lshl_add_u32 v104, v105, 4, v104
s_add_u32 m0, s50, 101376
s_add_u32 s38, s38, 114688
buffer_load_dwordx4 v6, s[16:19], s38 offen lds
v_bfe_u32 v105, v1, 4, 1
v_lshl_add_u32 v104, v105, 2, v104
s_add_u32 m0, s50, 102400
s_nop 0
buffer_load_dwordx4 v7, s[16:19], s38 offen lds
s_add_u32 m0, s50, 103424
s_nop 0
buffer_load_dwordx4 v8, s[16:19], s38 offen lds
s_waitcnt vmcnt(20)
s_barrier
s_add_u32 s37, s35, 12
s_and_b32 s37, s37, 15
s_mul_i32 s37, s37, 16384
s_add_u32 m0, s39, 0
s_nop 0
buffer_load_dwordx4 v3, s[8:11], s37 offen sc1 lds
buffer_load_dwordx4 v3, s[8:11], s37 offen offset:1024 sc1 lds
buffer_load_dwordx4 v3, s[8:11], s37 offen offset:2048 sc1 lds
buffer_load_dwordx4 v3, s[8:11], s37 offen offset:3072 sc1 lds
s_add_u32 s38, s35, 12
s_and_b32 s38, s38, 15
s_mul_i32 s38, s38, 458752
s_add_u32 m0, s50, 0
s_nop 0
buffer_load_dwordx4 v6, s[16:19], s38 offen lds
s_add_u32 m0, s50, 1024
s_nop 0
buffer_load_dwordx4 v7, s[16:19], s38 offen lds
s_add_u32 m0, s50, 2048
s_nop 0
buffer_load_dwordx4 v8, s[16:19], s38 offen lds
s_add_u32 m0, s50, 3072
s_add_u32 s38, s38, 114688
buffer_load_dwordx4 v6, s[16:19], s38 offen lds
s_add_u32 m0, s50, 4096
s_nop 0
buffer_load_dwordx4 v7, s[16:19], s38 offen lds
s_add_u32 m0, s50, 5120
s_nop 0
buffer_load_dwordx4 v8, s[16:19], s38 offen lds
s_waitcnt vmcnt(10)
s_barrier
v_permlane32_swap_b32 v96, v100
v_permlane32_swap_b32 v97, v101
v_permlane32_swap_b32 v98, v102
v_permlane32_swap_b32 v99, v103
v_add_f32 v96, v96, v100
v_add_f32 v97, v97, v101
v_add_f32 v98, v98, v102
v_add_f32 v99, v99, v103
s_nop 1
v_permlane16_swap_b32 v96, v97
v_permlane16_swap_b32 v98, v99
v_add_f32 v96, v96, v97
v_add_f32 v98, v98, v99
s_nop 1
v_add_f32_dpp v96, v96, v96 row_ror:8 row_mask:0xf bank_mask:0xf
v_add_f32_dpp v98, v98, v98 row_ror:8 row_mask:0xf bank_mask:0xf
ds_write_b32 v104, v96
ds_write_b32 v104, v98 offset:8
s_waitcnt lgkmcnt(0)
s_add_u32 s37, s35, 13
s_and_b32 s37, s37, 15
s_mul_i32 s37, s37, 16384
s_add_u32 m0, s39, 49152
s_nop 0
buffer_load_dwordx4 v3, s[8:11], s37 offen sc1 lds
s_load_dword s3, s[4:5], 1024
s_load_dword s3, s[4:5], 1088
s_load_dword s3, s[4:5], 1152
s_load_dword s3, s[4:5], 1216
buffer_load_dwordx4 v3, s[8:11], s37 offen offset:1024 sc1 lds
s_load_dword s3, s[4:5], 1280
s_load_dword s3, s[4:5], 1344
v_lshlrev_b32 v72, 16, v40
v_and_b32 v73, 0xffff0000, v40
v_lshlrev_b32 v74, 16, v41
buffer_load_dwordx4 v3, s[8:11], s37 offen offset:2048 sc1 lds
v_and_b32 v75, 0xffff0000, v41
v_lshlrev_b32 v76, 16, v42
v_and_b32 v77, 0xffff0000, v42
v_lshlrev_b32 v78, 16, v43
v_and_b32 v79, 0xffff0000, v43
buffer_load_dwordx4 v3, s[8:11], s37 offen offset:3072 sc1 lds
v_lshlrev_b32 v80, 16, v44
v_and_b32 v81, 0xffff0000, v44
v_lshlrev_b32 v82, 16, v45
v_and_b32 v83, 0xffff0000, v45
v_lshlrev_b32 v84, 16, v46
s_add_u32 s38, s35, 13
s_and_b32 s38, s38, 15
s_mul_i32 s38, s38, 458752
s_add_u32 m0, s50, 49152
s_nop 0
buffer_load_dwordx4 v6, s[16:19], s38 offen lds
v_and_b32 v85, 0xffff0000, v46
v_lshlrev_b32 v86, 16, v47
v_and_b32 v87, 0xffff0000, v47
v_add_f32 v72, v72, v80
v_add_f32 v73, v73, v81
s_add_u32 m0, s50, 50176
s_nop 0
buffer_load_dwordx4 v7, s[16:19], s38 offen lds
v_add_f32 v74, v74, v82
v_add_f32 v75, v75, v83
v_add_f32 v76, v76, v84
v_add_f32 v77, v77, v85
v_add_f32 v78, v78, v86
s_add_u32 m0, s50, 51200
s_nop 0
buffer_load_dwordx4 v8, s[16:19], s38 offen lds
v_add_f32 v79, v79, v87
v_lshlrev_b32 v80, 16, v48
v_and_b32 v81, 0xffff0000, v48
v_lshlrev_b32 v82, 16, v49
v_and_b32 v83, 0xffff0000, v49
s_add_u32 m0, s50, 52224
s_add_u32 s38, s38, 114688
buffer_load_dwordx4 v6, s[16:19], s38 offen lds
v_lshlrev_b32 v84, 16, v50
v_and_b32 v85, 0xffff0000, v50
v_lshlrev_b32 v86, 16, v51
v_and_b32 v87, 0xffff0000, v51
v_add_f32 v72, v72, v80
s_add_u32 m0, s50, 53248
s_nop 0
buffer_load_dwordx4 v7, s[16:19], s38 offen lds
s_add_u32 m0, s50, 54272
s_nop 0
buffer_load_dwordx4 v8, s[16:19], s38 offen lds
s_waitcnt vmcnt(10)
s_barrier
s_add_u32 s37, s35, 14
s_and_b32 s37, s37, 15
s_mul_i32 s37, s37, 16384
s_add_u32 m0, s39, 98304
s_nop 0
buffer_load_dwordx4 v3, s[8:11], s37 offen sc1 lds
s_load_dword s3, s[4:5], 1408
s_load_dword s3, s[4:5], 1472
s_load_dword s3, s[4:5], 1536
s_load_dword s3, s[4:5], 1600
s_load_dword s3, s[4:5], 1664
buffer_load_dwordx4 v3, s[8:11], s37 offen offset:1024 sc1 lds
s_load_dword s3, s[4:5], 1728
v_add_f32 v73, v73, v81
v_add_f32 v74, v74, v82
v_add_f32 v75, v75, v83
v_add_f32 v76, v76, v84
buffer_load_dwordx4 v3, s[8:11], s37 offen offset:2048 sc1 lds
v_add_f32 v77, v77, v85
v_add_f32 v78, v78, v86
v_add_f32 v79, v79, v87
v_lshlrev_b32 v80, 16, v52
v_and_b32 v81, 0xffff0000, v52
buffer_load_dwordx4 v3, s[8:11], s37 offen offset:3072 sc1 lds
v_lshlrev_b32 v82, 16, v53
v_and_b32 v83, 0xffff0000, v53
v_lshlrev_b32 v84, 16, v54
v_and_b32 v85, 0xffff0000, v54
v_lshlrev_b32 v86, 16, v55
s_add_u32 s38, s35, 14
s_and_b32 s38, s38, 15
s_mul_i32 s38, s38, 458752
s_add_u32 m0, s50, 98304
s_nop 0
buffer_load_dwordx4 v6, s[16:19], s38 offen lds
v_and_b32 v87, 0xffff0000, v55
v_add_f32 v72, v72, v80
v_add_f32 v73, v73, v81
v_add_f32 v74, v74, v82
v_add_f32 v75, v75, v83
s_add_u32 m0, s50, 99328
s_nop 0
buffer_load_dwordx4 v7, s[16:19], s38 offen lds
v_add_f32 v76, v76, v84
v_add_f32 v77, v77, v85
v_add_f32 v78, v78, v86
v_add_f32 v79, v79, v87
v_lshlrev_b32 v80, 16, v56
s_add_u32 m0, s50, 100352
s_nop 0
buffer_load_dwordx4 v8, s[16:19], s38 offen lds
v_and_b32 v81, 0xffff0000, v56
v_lshlrev_b32 v82, 16, v57
v_and_b32 v83, 0xffff0000, v57
v_lshlrev_b32 v84, 16, v58
v_and_b32 v85, 0xffff0000, v58
s_add_u32 m0, s50, 101376
s_add_u32 s38, s38, 114688
buffer_load_dwordx4 v6, s[16:19], s38 offen lds
v_lshlrev_b32 v86, 16, v59
v_and_b32 v87, 0xffff0000, v59
v_add_f32 v72, v72, v80
v_add_f32 v73, v73, v81
v_add_f32 v74, v74, v82
s_add_u32 m0, s50, 102400
s_nop 0
buffer_load_dwordx4 v7, s[16:19], s38 offen lds
s_add_u32 m0, s50, 103424
s_nop 0
buffer_load_dwordx4 v8, s[16:19], s38 offen lds
s_waitcnt vmcnt(10)
s_barrier
s_add_u32 s37, s35, 15
s_and_b32 s37, s37, 15
s_mul_i32 s37, s37, 16384
s_add_u32 m0, s39, 0
s_nop 0
buffer_load_dwordx4 v3, s[8:11], s37 offen sc1 lds
v_add_f32 v75, v75, v83
v_add_f32 v76, v76, v84
v_add_f32 v77, v77, v85
v_add_f32 v78, v78, v86
buffer_load_dwordx4 v3, s[8:11], s37 offen offset:1024 sc1 lds
v_add_f32 v79, v79, v87
v_lshlrev_b32 v80, 16, v60
v_and_b32 v81, 0xffff0000, v60
v_lshlrev_b32 v82, 16, v61
buffer_load_dwordx4 v3, s[8:11], s37 offen offset:2048 sc1 lds
v_and_b32 v83, 0xffff0000, v61
v_lshlrev_b32 v84, 16, v62
v_and_b32 v85, 0xffff0000, v62
v_lshlrev_b32 v86, 16, v63
buffer_load_dwordx4 v3, s[8:11], s37 offen offset:3072 sc1 lds
v_and_b32 v87, 0xffff0000, v63
v_add_f32 v72, v72, v80
v_add_f32 v73, v73, v81
v_add_f32 v74, v74, v82
s_add_u32 s38, s35, 15
s_and_b32 s38, s38, 15
s_mul_i32 s38, s38, 458752
s_add_u32 m0, s50, 0
s_nop 0
buffer_load_dwordx4 v6, s[16:19], s38 offen lds
v_add_f32 v75, v75, v83
v_add_f32 v76, v76, v84
v_add_f32 v77, v77, v85
v_add_f32 v78, v78, v86
s_add_u32 m0, s50, 1024
s_nop 0
buffer_load_dwordx4 v7, s[16:19], s38 offen lds
v_add_f32 v79, v79, v87
v_lshlrev_b32 v80, 16, v64
v_and_b32 v81, 0xffff0000, v64
v_lshlrev_b32 v82, 16, v65
s_add_u32 m0, s50, 2048
s_nop 0
buffer_load_dwordx4 v8, s[16:19], s38 offen lds
v_and_b32 v83, 0xffff0000, v65
v_lshlrev_b32 v84, 16, v66
v_and_b32 v85, 0xffff0000, v66
v_lshlrev_b32 v86, 16, v67
s_add_u32 m0, s50, 3072
s_add_u32 s38, s38, 114688
buffer_load_dwordx4 v6, s[16:19], s38 offen lds
v_and_b32 v87, 0xffff0000, v67
v_add_f32 v72, v72, v80
v_add_f32 v73, v73, v81
v_add_f32 v74, v74, v82
v_add_f32 v75, v75, v83
s_add_u32 m0, s50, 4096
s_nop 0
buffer_load_dwordx4 v7, s[16:19], s38 offen lds
s_add_u32 m0, s50, 5120
s_nop 0
buffer_load_dwordx4 v8, s[16:19], s38 offen lds
s_waitcnt vmcnt(10)
s_barrier
s_add_u32 s38, s35, 13
s_and_b32 s38, s38, 15
s_mul_i32 s38, s38, 458752
s_add_u32 m0, s40, 49152
s_nop 0
buffer_load_dwordx4 v4, s[12:15], s38 offen lds
v_add_f32 v76, v76, v84
v_add_f32 v77, v77, v85
v_add_f32 v78, v78, v86
v_add_f32 v79, v79, v87
v_lshlrev_b32 v80, 16, v68
s_add_u32 m0, s40, 50176
s_nop 0
buffer_load_dwordx4 v5, s[12:15], s38 offen lds
v_and_b32 v81, 0xffff0000, v68
v_lshlrev_b32 v82, 16, v69
v_and_b32 v83, 0xffff0000, v69
v_lshlrev_b32 v84, 16, v70
v_and_b32 v85, 0xffff0000, v70
v_lshlrev_b32 v86, 16, v71
s_add_u32 m0, s40, 51200
s_add_u32 s38, s38, 57344
buffer_load_dwordx4 v4, s[12:15], s38 offen lds
v_and_b32 v87, 0xffff0000, v71
v_add_f32 v72, v72, v80
v_add_f32 v73, v73, v81
v_add_f32 v74, v74, v82
v_add_f32 v75, v75, v83
v_add_f32 v76, v76, v84
s_add_u32 m0, s40, 52224
s_nop 0
buffer_load_dwordx4 v5, s[12:15], s38 offen lds
v_add_f32 v77, v77, v85
v_add_f32 v78, v78, v86
v_add_f32 v79, v79, v87
s_nop 0
v_permlane32_swap_b32 v72, v76
s_add_u32 m0, s40, 53248
s_add_u32 s38, s38, 57344
buffer_load_dwordx4 v4, s[12:15], s38 offen lds
v_permlane32_swap_b32 v73, v77
v_permlane32_swap_b32 v74, v78
v_permlane32_swap_b32 v75, v79
v_add_f32 v72, v72, v76
v_add_f32 v73, v73, v77
v_add_f32 v74, v74, v78
s_add_u32 m0, s40, 54272
s_nop 0
buffer_load_dwordx4 v5, s[12:15], s38 offen lds
v_add_f32 v75, v75, v79
s_nop 0
v_permlane16_swap_b32 v72, v74
v_permlane16_swap_b32 v73, v75
v_add_f32 v72, v72, v74
v_add_f32 v73, v73, v75
s_add_u32 m0, s40, 55296
s_add_u32 s38, s38, 57344
buffer_load_dwordx4 v4, s[12:15], s38 offen lds
s_add_u32 m0, s40, 56320
s_nop 0
buffer_load_dwordx4 v5, s[12:15], s38 offen lds
s_waitcnt vmcnt(8)
s_barrier
s_lshl_b32 s43, s47, 9
s_add_u32 s43, s43, 153600
v_and_b32 v80, 15, v1
v_lshl_add_u32 v80, v80, 5, s43
v_lshrrev_b32 v81, 4, v1
v_lshl_add_u32 v80, v81, 3, v80
ds_write_b64 v80, v[72:73]
s_waitcnt lgkmcnt(0)
s_add_u32 s38, s35, 14
s_and_b32 s38, s38, 15
s_mul_i32 s38, s38, 458752
s_add_u32 m0, s40, 98304
s_nop 0
buffer_load_dwordx4 v4, s[12:15], s38 offen lds
s_bfe_u32 s61, s35, 0x10002
s_lshr_b32 s60, s35, 3
s_lshl_b32 s60, s60, 2
s_and_b32 s43, s35, 3
s_add_u32 s60, s60, s43
s_add_u32 m0, s40, 99328
s_nop 0
buffer_load_dwordx4 v5, s[12:15], s38 offen lds
s_lshl_b32 s43, s60, 8
s_add_u32 s28, s76, s43
s_addc_u32 s29, s77, 0
s_mov_b32 s30, 7338240
s_mov_b32 s31, 0x20000
s_add_u32 m0, s40, 100352
s_add_u32 s38, s38, 57344
buffer_load_dwordx4 v4, s[12:15], s38 offen lds
s_mul_i32 s52, s61, 196608
s_mul_i32 s53, s61, 1572864
s_mul_i32 s90, s61, 163840
s_mul_i32 s91, s61, 1310720
s_and_b32 s43, s35, 3
s_add_u32 m0, s40, 101376
s_nop 0
buffer_load_dwordx4 v5, s[12:15], s38 offen lds
s_mul_i32 s32, s43, 3
s_mul_i32 s33, s43, 10
s_lshr_b32 s33, s33, 2
s_lshl_b32 s51, s47, 11
s_lshl_b32 s44, s47, 15
s_add_u32 m0, s40, 102400
s_add_u32 s38, s38, 57344
buffer_load_dwordx4 v4, s[12:15], s38 offen lds
v_lshrrev_b32 v122, 4, v1
v_lshlrev_b32 v123, 1, v122
v_and_b32 v23, 15, v1
v_xor_b32 v23, v23, v123
v_lshlrev_b32 v23, 4, v23
s_add_u32 m0, s40, 103424
s_nop 0
buffer_load_dwordx4 v5, s[12:15], s38 offen lds
v_mul_u32_u24 v122, 2048, v122
v_add_u32 v23, v23, v122
v_add_u32 v23, s44, v23
v_xor_b32 v24, 128, v23
v_add_u32 v24, 8192, v24
s_add_u32 m0, s40, 104448
s_add_u32 s38, s38, 57344
buffer_load_dwordx4 v4, s[12:15], s38 offen lds
s_add_u32 m0, s40, 105472
s_nop 0
buffer_load_dwordx4 v5, s[12:15], s38 offen lds
s_waitcnt vmcnt(8)
s_barrier
ds_read_b128 v[28:31], v9 offset:49152
ds_read_b64_tr_b16 v[44:45], v15 offset:0
ds_read_b64_tr_b16 v[46:47], v15 offset:4096
ds_read_b64_tr_b16 v[48:49], v16 offset:0
ds_read_b64_tr_b16 v[50:51], v16 offset:4096
ds_read_b64_tr_b16 v[52:53], v17 offset:0
ds_read_b64_tr_b16 v[54:55], v17 offset:4096
ds_read_b64_tr_b16 v[56:57], v18 offset:0
ds_read_b64_tr_b16 v[58:59], v18 offset:4096
ds_read_b64_tr_b16 v[60:61], v15 offset:16384
ds_read_b64_tr_b16 v[62:63], v15 offset:20480
ds_read_b64_tr_b16 v[64:65], v16 offset:16384
ds_read_b64_tr_b16 v[66:67], v16 offset:20480
ds_read_b64_tr_b16 v[68:69], v17 offset:16384
ds_read_b64_tr_b16 v[70:71], v17 offset:20480
ds_read_b64_tr_b16 v[72:73], v18 offset:16384
ds_read_b64_tr_b16 v[74:75], v18 offset:20480
ds_read_b128 v[32:35], v9 offset:50176
ds_read_b128 v[36:39], v9 offset:51200
ds_read_b128 v[40:43], v9 offset:52224
s_waitcnt lgkmcnt(0)
v_mfma_f32_16x16x32_bf16 v[124:127], v[44:47], v[28:31], 0
ds_read_b128 v[76:79], v9 offset:57344
v_mfma_f32_16x16x32_bf16 v[156:159], v[44:47], v[32:35], 0
ds_read_b64_tr_b16 v[92:93], v15 offset:8192
v_mfma_f32_16x16x32_bf16 v[188:191], v[44:47], v[36:39], 0
ds_read_b64_tr_b16 v[94:95], v15 offset:12288
v_mfma_f32_16x16x32_bf16 v[220:223], v[44:47], v[40:43], 0
ds_read_b64_tr_b16 v[96:97], v16 offset:8192
v_mfma_f32_16x16x32_bf16 v[224:227], v[48:51], v[40:43], 0
ds_read_b64_tr_b16 v[98:99], v16 offset:12288
v_mfma_f32_16x16x32_bf16 v[192:195], v[48:51], v[36:39], 0
ds_read_b64_tr_b16 v[100:101], v17 offset:8192
v_mfma_f32_16x16x32_bf16 v[160:163], v[48:51], v[32:35], 0
ds_read_b64_tr_b16 v[102:103], v17 offset:12288
v_mfma_f32_16x16x32_bf16 v[128:131], v[48:51], v[28:31], 0
ds_read_b64_tr_b16 v[104:105], v18 offset:8192
v_mfma_f32_16x16x32_bf16 v[132:135], v[52:55], v[28:31], 0
ds_read_b64_tr_b16 v[106:107], v18 offset:12288
v_mfma_f32_16x16x32_bf16 v[164:167], v[52:55], v[32:35], 0
ds_read_b64_tr_b16 v[108:109], v15 offset:24576
v_mfma_f32_16x16x32_bf16 v[196:199], v[52:55], v[36:39], 0
ds_read_b64_tr_b16 v[110:111], v15 offset:28672
v_mfma_f32_16x16x32_bf16 v[228:231], v[52:55], v[40:43], 0
ds_read_b64_tr_b16 v[112:113], v16 offset:24576
v_mfma_f32_16x16x32_bf16 v[232:235], v[56:59], v[40:43], 0
ds_read_b64_tr_b16 v[114:115], v16 offset:28672
v_mfma_f32_16x16x32_bf16 v[200:203], v[56:59], v[36:39], 0
ds_read_b64_tr_b16 v[116:117], v17 offset:24576
v_mfma_f32_16x16x32_bf16 v[168:171], v[56:59], v[32:35], 0
ds_read_b64_tr_b16 v[118:119], v17 offset:28672
v_mfma_f32_16x16x32_bf16 v[136:139], v[56:59], v[28:31], 0
ds_read_b64_tr_b16 v[120:121], v18 offset:24576
v_mfma_f32_16x16x32_bf16 v[140:143], v[60:63], v[28:31], 0
ds_read_b64_tr_b16 v[122:123], v18 offset:28672
v_mfma_f32_16x16x32_bf16 v[172:175], v[60:63], v[32:35], 0
ds_read_b128 v[80:83], v9 offset:58368
v_mfma_f32_16x16x32_bf16 v[204:207], v[60:63], v[36:39], 0
ds_read_b128 v[84:87], v9 offset:59392
v_mfma_f32_16x16x32_bf16 v[236:239], v[60:63], v[40:43], 0
ds_read_b128 v[88:91], v9 offset:60416
v_mfma_f32_16x16x32_bf16 v[240:243], v[64:67], v[40:43], 0
v_mfma_f32_16x16x32_bf16 v[208:211], v[64:67], v[36:39], 0
v_mfma_f32_16x16x32_bf16 v[176:179], v[64:67], v[32:35], 0
v_mfma_f32_16x16x32_bf16 v[144:147], v[64:67], v[28:31], 0
v_mfma_f32_16x16x32_bf16 v[148:151], v[68:71], v[28:31], 0
v_mfma_f32_16x16x32_bf16 v[180:183], v[68:71], v[32:35], 0
v_mfma_f32_16x16x32_bf16 v[212:215], v[68:71], v[36:39], 0
v_mfma_f32_16x16x32_bf16 v[244:247], v[68:71], v[40:43], 0
v_mfma_f32_16x16x32_bf16 v[248:251], v[72:75], v[40:43], 0
v_mfma_f32_16x16x32_bf16 v[216:219], v[72:75], v[36:39], 0
v_mfma_f32_16x16x32_bf16 v[184:187], v[72:75], v[32:35], 0
v_mfma_f32_16x16x32_bf16 v[152:155], v[72:75], v[28:31], 0
s_waitcnt vmcnt(0)
s_waitcnt lgkmcnt(0)
s_barrier
v_mfma_f32_16x16x32_bf16 v[124:127], v[92:95], v[76:79], v[124:127]
ds_read_b128 v[28:31], v10 offset:0
v_mfma_f32_16x16x32_bf16 v[156:159], v[92:95], v[80:83], v[156:159]
ds_read_b64_tr_b16 v[44:45], v19 offset:0
v_mfma_f32_16x16x32_bf16 v[188:191], v[92:95], v[84:87], v[188:191]
ds_read_b64_tr_b16 v[46:47], v19 offset:4096
v_mfma_f32_16x16x32_bf16 v[220:223], v[92:95], v[88:91], v[220:223]
ds_read_b64_tr_b16 v[48:49], v20 offset:0
v_mfma_f32_16x16x32_bf16 v[224:227], v[96:99], v[88:91], v[224:227]
ds_read_b64_tr_b16 v[50:51], v20 offset:4096
v_mfma_f32_16x16x32_bf16 v[192:195], v[96:99], v[84:87], v[192:195]
ds_read_b64_tr_b16 v[52:53], v21 offset:0
v_mfma_f32_16x16x32_bf16 v[160:163], v[96:99], v[80:83], v[160:163]
ds_read_b64_tr_b16 v[54:55], v21 offset:4096
v_mfma_f32_16x16x32_bf16 v[128:131], v[96:99], v[76:79], v[128:131]
ds_read_b64_tr_b16 v[56:57], v22 offset:0
v_mfma_f32_16x16x32_bf16 v[132:135], v[100:103], v[76:79], v[132:135]
s_branch Lov_15
.p2align 12
.fill 112, 4, 0xbf800000
Lst_15_0:
s_branch Lwr_156
Lst_15_1:
s_branch Lwr_168
s_nop 0
Lov_15:
ds_read_b64_tr_b16 v[58:59], v22 offset:4096
v_mfma_f32_16x16x32_bf16 v[164:167], v[100:103], v[80:83], v[164:167]
ds_read_b64_tr_b16 v[60:61], v19 offset:16384
v_mfma_f32_16x16x32_bf16 v[196:199], v[100:103], v[84:87], v[196:199]
ds_read_b64_tr_b16 v[62:63], v19 offset:20480
v_mfma_f32_16x16x32_bf16 v[228:231], v[100:103], v[88:91], v[228:231]
ds_read_b64_tr_b16 v[64:65], v20 offset:16384
v_mfma_f32_16x16x32_bf16 v[232:235], v[104:107], v[88:91], v[232:235]
ds_read_b64_tr_b16 v[66:67], v20 offset:20480
v_mfma_f32_16x16x32_bf16 v[200:203], v[104:107], v[84:87], v[200:203]
ds_read_b64_tr_b16 v[68:69], v21 offset:16384
v_mfma_f32_16x16x32_bf16 v[168:171], v[104:107], v[80:83], v[168:171]
ds_read_b64_tr_b16 v[70:71], v21 offset:20480
v_mfma_f32_16x16x32_bf16 v[136:139], v[104:107], v[76:79], v[136:139]
ds_read_b64_tr_b16 v[72:73], v22 offset:16384
v_mfma_f32_16x16x32_bf16 v[140:143], v[108:111], v[76:79], v[140:143]
ds_read_b64_tr_b16 v[74:75], v22 offset:20480
v_mfma_f32_16x16x32_bf16 v[172:175], v[108:111], v[80:83], v[172:175]
ds_read_b128 v[32:35], v10 offset:1024
v_mfma_f32_16x16x32_bf16 v[204:207], v[108:111], v[84:87], v[204:207]
ds_read_b128 v[36:39], v10 offset:2048
v_mfma_f32_16x16x32_bf16 v[236:239], v[108:111], v[88:91], v[236:239]
ds_read_b128 v[40:43], v10 offset:3072
v_mfma_f32_16x16x32_bf16 v[240:243], v[112:115], v[88:91], v[240:243]
v_mfma_f32_16x16x32_bf16 v[208:211], v[112:115], v[84:87], v[208:211]
v_mfma_f32_16x16x32_bf16 v[176:179], v[112:115], v[80:83], v[176:179]
v_mfma_f32_16x16x32_bf16 v[144:147], v[112:115], v[76:79], v[144:147]
v_mfma_f32_16x16x32_bf16 v[148:151], v[116:119], v[76:79], v[148:151]
v_mfma_f32_16x16x32_bf16 v[180:183], v[116:119], v[80:83], v[180:183]
v_mfma_f32_16x16x32_bf16 v[212:215], v[116:119], v[84:87], v[212:215]
v_mfma_f32_16x16x32_bf16 v[244:247], v[116:119], v[88:91], v[244:247]
v_mfma_f32_16x16x32_bf16 v[248:251], v[120:123], v[88:91], v[248:251]
v_mfma_f32_16x16x32_bf16 v[216:219], v[120:123], v[84:87], v[216:219]
v_mfma_f32_16x16x32_bf16 v[184:187], v[120:123], v[80:83], v[184:187]
v_mfma_f32_16x16x32_bf16 v[152:155], v[120:123], v[76:79], v[152:155]
s_mov_b32 s41, 5
Lk3l_132:
s_waitcnt lgkmcnt(0)
v_mfma_f32_16x16x32_bf16 v[124:127], v[44:47], v[28:31], v[124:127]
ds_read_b128 v[76:79], v10 offset:8192
v_mfma_f32_16x16x32_bf16 v[156:159], v[44:47], v[32:35], v[156:159]
ds_read_b64_tr_b16 v[92:93], v19 offset:8192
v_mfma_f32_16x16x32_bf16 v[188:191], v[44:47], v[36:39], v[188:191]
ds_read_b64_tr_b16 v[94:95], v19 offset:12288
v_mfma_f32_16x16x32_bf16 v[220:223], v[44:47], v[40:43], v[220:223]
ds_read_b64_tr_b16 v[96:97], v20 offset:8192
v_mfma_f32_16x16x32_bf16 v[224:227], v[48:51], v[40:43], v[224:227]
ds_read_b64_tr_b16 v[98:99], v20 offset:12288
v_mfma_f32_16x16x32_bf16 v[192:195], v[48:51], v[36:39], v[192:195]
ds_read_b64_tr_b16 v[100:101], v21 offset:8192
v_mfma_f32_16x16x32_bf16 v[160:163], v[48:51], v[32:35], v[160:163]
ds_read_b64_tr_b16 v[102:103], v21 offset:12288
v_mfma_f32_16x16x32_bf16 v[128:131], v[48:51], v[28:31], v[128:131]
ds_read_b64_tr_b16 v[104:105], v22 offset:8192
v_mfma_f32_16x16x32_bf16 v[132:135], v[52:55], v[28:31], v[132:135]
ds_read_b64_tr_b16 v[106:107], v22 offset:12288
v_mfma_f32_16x16x32_bf16 v[164:167], v[52:55], v[32:35], v[164:167]
ds_read_b64_tr_b16 v[108:109], v19 offset:24576
v_mfma_f32_16x16x32_bf16 v[196:199], v[52:55], v[36:39], v[196:199]
ds_read_b64_tr_b16 v[110:111], v19 offset:28672
v_mfma_f32_16x16x32_bf16 v[228:231], v[52:55], v[40:43], v[228:231]
ds_read_b64_tr_b16 v[112:113], v20 offset:24576
v_mfma_f32_16x16x32_bf16 v[232:235], v[56:59], v[40:43], v[232:235]
ds_read_b64_tr_b16 v[114:115], v20 offset:28672
v_mfma_f32_16x16x32_bf16 v[200:203], v[56:59], v[36:39], v[200:203]
ds_read_b64_tr_b16 v[116:117], v21 offset:24576
v_mfma_f32_16x16x32_bf16 v[168:171], v[56:59], v[32:35], v[168:171]
ds_read_b64_tr_b16 v[118:119], v21 offset:28672
v_mfma_f32_16x16x32_bf16 v[136:139], v[56:59], v[28:31], v[136:139]
ds_read_b64_tr_b16 v[120:121], v22 offset:24576
v_mfma_f32_16x16x32_bf16 v[140:143], v[60:63], v[28:31], v[140:143]
ds_read_b64_tr_b16 v[122:123], v22 offset:28672
v_mfma_f32_16x16x32_bf16 v[172:175], v[60:63], v[32:35], v[172:175]
ds_read_b128 v[80:83], v10 offset:9216
v_mfma_f32_16x16x32_bf16 v[204:207], v[60:63], v[36:39], v[204:207]
ds_read_b128 v[84:87], v10 offset:10240
v_mfma_f32_16x16x32_bf16 v[236:239], v[60:63], v[40:43], v[236:239]
ds_read_b128 v[88:91], v10 offset:11264
v_mfma_f32_16x16x32_bf16 v[240:243], v[64:67], v[40:43], v[240:243]
v_mfma_f32_16x16x32_bf16 v[208:211], v[64:67], v[36:39], v[208:211]
v_mfma_f32_16x16x32_bf16 v[176:179], v[64:67], v[32:35], v[176:179]
v_mfma_f32_16x16x32_bf16 v[144:147], v[64:67], v[28:31], v[144:147]
v_mfma_f32_16x16x32_bf16 v[148:151], v[68:71], v[28:31], v[148:151]
v_mfma_f32_16x16x32_bf16 v[180:183], v[68:71], v[32:35], v[180:183]
v_mfma_f32_16x16x32_bf16 v[212:215], v[68:71], v[36:39], v[212:215]
v_mfma_f32_16x16x32_bf16 v[244:247], v[68:71], v[40:43], v[244:247]
v_mfma_f32_16x16x32_bf16 v[248:251], v[72:75], v[40:43], v[248:251]
v_mfma_f32_16x16x32_bf16 v[216:219], v[72:75], v[36:39], v[216:219]
v_mfma_f32_16x16x32_bf16 v[184:187], v[72:75], v[32:35], v[184:187]
v_mfma_f32_16x16x32_bf16 v[152:155], v[72:75], v[28:31], v[152:155]
s_waitcnt lgkmcnt(0)
s_barrier
v_mfma_f32_16x16x32_bf16 v[124:127], v[92:95], v[76:79], v[124:127]
ds_read_b128 v[28:31], v9 offset:0
v_mfma_f32_16x16x32_bf16 v[156:159], v[92:95], v[80:83], v[156:159]
ds_read_b64_tr_b16 v[44:45], v11 offset:0
v_mfma_f32_16x16x32_bf16 v[188:191], v[92:95], v[84:87], v[188:191]
ds_read_b64_tr_b16 v[46:47], v11 offset:4096
v_mfma_f32_16x16x32_bf16 v[220:223], v[92:95], v[88:91], v[220:223]
ds_read_b64_tr_b16 v[48:49], v12 offset:0
v_mfma_f32_16x16x32_bf16 v[224:227], v[96:99], v[88:91], v[224:227]
ds_read_b64_tr_b16 v[50:51], v12 offset:4096
v_mfma_f32_16x16x32_bf16 v[192:195], v[96:99], v[84:87], v[192:195]
ds_read_b64_tr_b16 v[52:53], v13 offset:0
v_mfma_f32_16x16x32_bf16 v[160:163], v[96:99], v[80:83], v[160:163]
ds_read_b64_tr_b16 v[54:55], v13 offset:4096
v_mfma_f32_16x16x32_bf16 v[128:131], v[96:99], v[76:79], v[128:131]
ds_read_b64_tr_b16 v[56:57], v14 offset:0
v_mfma_f32_16x16x32_bf16 v[132:135], v[100:103], v[76:79], v[132:135]
ds_read_b64_tr_b16 v[58:59], v14 offset:4096
v_mfma_f32_16x16x32_bf16 v[164:167], v[100:103], v[80:83], v[164:167]
ds_read_b64_tr_b16 v[60:61], v11 offset:16384
v_mfma_f32_16x16x32_bf16 v[196:199], v[100:103], v[84:87], v[196:199]
ds_read_b64_tr_b16 v[62:63], v11 offset:20480
v_mfma_f32_16x16x32_bf16 v[228:231], v[100:103], v[88:91], v[228:231]
ds_read_b64_tr_b16 v[64:65], v12 offset:16384
v_mfma_f32_16x16x32_bf16 v[232:235], v[104:107], v[88:91], v[232:235]
ds_read_b64_tr_b16 v[66:67], v12 offset:20480
v_mfma_f32_16x16x32_bf16 v[200:203], v[104:107], v[84:87], v[200:203]
ds_read_b64_tr_b16 v[68:69], v13 offset:16384
v_mfma_f32_16x16x32_bf16 v[168:171], v[104:107], v[80:83], v[168:171]
ds_read_b64_tr_b16 v[70:71], v13 offset:20480
v_mfma_f32_16x16x32_bf16 v[136:139], v[104:107], v[76:79], v[136:139]
ds_read_b64_tr_b16 v[72:73], v14 offset:16384
v_mfma_f32_16x16x32_bf16 v[140:143], v[108:111], v[76:79], v[140:143]
ds_read_b64_tr_b16 v[74:75], v14 offset:20480
v_mfma_f32_16x16x32_bf16 v[172:175], v[108:111], v[80:83], v[172:175]
ds_read_b128 v[32:35], v9 offset:1024
v_mfma_f32_16x16x32_bf16 v[204:207], v[108:111], v[84:87], v[204:207]
ds_read_b128 v[36:39], v9 offset:2048
v_mfma_f32_16x16x32_bf16 v[236:239], v[108:111], v[88:91], v[236:239]
ds_read_b128 v[40:43], v9 offset:3072
v_mfma_f32_16x16x32_bf16 v[240:243], v[112:115], v[88:91], v[240:243]
v_mfma_f32_16x16x32_bf16 v[208:211], v[112:115], v[84:87], v[208:211]
v_mfma_f32_16x16x32_bf16 v[176:179], v[112:115], v[80:83], v[176:179]
v_mfma_f32_16x16x32_bf16 v[144:147], v[112:115], v[76:79], v[144:147]
v_mfma_f32_16x16x32_bf16 v[148:151], v[116:119], v[76:79], v[148:151]
v_mfma_f32_16x16x32_bf16 v[180:183], v[116:119], v[80:83], v[180:183]
v_mfma_f32_16x16x32_bf16 v[212:215], v[116:119], v[84:87], v[212:215]
v_mfma_f32_16x16x32_bf16 v[244:247], v[116:119], v[88:91], v[244:247]
v_mfma_f32_16x16x32_bf16 v[248:251], v[120:123], v[88:91], v[248:251]
v_mfma_f32_16x16x32_bf16 v[216:219], v[120:123], v[84:87], v[216:219]
v_mfma_f32_16x16x32_bf16 v[184:187], v[120:123], v[80:83], v[184:187]
v_mfma_f32_16x16x32_bf16 v[152:155], v[120:123], v[76:79], v[152:155]
s_waitcnt lgkmcnt(0)
v_mfma_f32_16x16x32_bf16 v[124:127], v[44:47], v[28:31], v[124:127]
ds_read_b128 v[76:79], v9 offset:8192
v_mfma_f32_16x16x32_bf16 v[156:159], v[44:47], v[32:35], v[156:159]
ds_read_b64_tr_b16 v[92:93], v11 offset:8192
v_mfma_f32_16x16x32_bf16 v[188:191], v[44:47], v[36:39], v[188:191]
ds_read_b64_tr_b16 v[94:95], v11 offset:12288
v_mfma_f32_16x16x32_bf16 v[220:223], v[44:47], v[40:43], v[220:223]
ds_read_b64_tr_b16 v[96:97], v12 offset:8192
v_mfma_f32_16x16x32_bf16 v[224:227], v[48:51], v[40:43], v[224:227]
ds_read_b64_tr_b16 v[98:99], v12 offset:12288
v_mfma_f32_16x16x32_bf16 v[192:195], v[48:51], v[36:39], v[192:195]
ds_read_b64_tr_b16 v[100:101], v13 offset:8192
v_mfma_f32_16x16x32_bf16 v[160:163], v[48:51], v[32:35], v[160:163]
ds_read_b64_tr_b16 v[102:103], v13 offset:12288
v_mfma_f32_16x16x32_bf16 v[128:131], v[48:51], v[28:31], v[128:131]
ds_read_b64_tr_b16 v[104:105], v14 offset:8192
v_mfma_f32_16x16x32_bf16 v[132:135], v[52:55], v[28:31], v[132:135]
ds_read_b64_tr_b16 v[106:107], v14 offset:12288
v_mfma_f32_16x16x32_bf16 v[164:167], v[52:55], v[32:35], v[164:167]
ds_read_b64_tr_b16 v[108:109], v11 offset:24576
v_mfma_f32_16x16x32_bf16 v[196:199], v[52:55], v[36:39], v[196:199]
ds_read_b64_tr_b16 v[110:111], v11 offset:28672
v_mfma_f32_16x16x32_bf16 v[228:231], v[52:55], v[40:43], v[228:231]
ds_read_b64_tr_b16 v[112:113], v12 offset:24576
v_mfma_f32_16x16x32_bf16 v[232:235], v[56:59], v[40:43], v[232:235]
ds_read_b64_tr_b16 v[114:115], v12 offset:28672
v_mfma_f32_16x16x32_bf16 v[200:203], v[56:59], v[36:39], v[200:203]
ds_read_b64_tr_b16 v[116:117], v13 offset:24576
v_mfma_f32_16x16x32_bf16 v[168:171], v[56:59], v[32:35], v[168:171]
ds_read_b64_tr_b16 v[118:119], v13 offset:28672
v_mfma_f32_16x16x32_bf16 v[136:139], v[56:59], v[28:31], v[136:139]
ds_read_b64_tr_b16 v[120:121], v14 offset:24576
v_mfma_f32_16x16x32_bf16 v[140:143], v[60:63], v[28:31], v[140:143]
ds_read_b64_tr_b16 v[122:123], v14 offset:28672
v_mfma_f32_16x16x32_bf16 v[172:175], v[60:63], v[32:35], v[172:175]
ds_read_b128 v[80:83], v9 offset:9216
v_mfma_f32_16x16x32_bf16 v[204:207], v[60:63], v[36:39], v[204:207]
ds_read_b128 v[84:87], v9 offset:10240
v_mfma_f32_16x16x32_bf16 v[236:239], v[60:63], v[40:43], v[236:239]
ds_read_b128 v[88:91], v9 offset:11264
v_mfma_f32_16x16x32_bf16 v[240:243], v[64:67], v[40:43], v[240:243]
v_mfma_f32_16x16x32_bf16 v[208:211], v[64:67], v[36:39], v[208:211]
v_mfma_f32_16x16x32_bf16 v[176:179], v[64:67], v[32:35], v[176:179]
v_mfma_f32_16x16x32_bf16 v[144:147], v[64:67], v[28:31], v[144:147]
v_mfma_f32_16x16x32_bf16 v[148:151], v[68:71], v[28:31], v[148:151]
v_mfma_f32_16x16x32_bf16 v[180:183], v[68:71], v[32:35], v[180:183]
v_mfma_f32_16x16x32_bf16 v[212:215], v[68:71], v[36:39], v[212:215]
v_mfma_f32_16x16x32_bf16 v[244:247], v[68:71], v[40:43], v[244:247]
v_mfma_f32_16x16x32_bf16 v[248:251], v[72:75], v[40:43], v[248:251]
v_mfma_f32_16x16x32_bf16 v[216:219], v[72:75], v[36:39], v[216:219]
v_mfma_f32_16x16x32_bf16 v[184:187], v[72:75], v[32:35], v[184:187]
v_mfma_f32_16x16x32_bf16 v[152:155], v[72:75], v[28:31], v[152:155]
s_waitcnt lgkmcnt(0)
s_barrier
v_mfma_f32_16x16x32_bf16 v[124:127], v[92:95], v[76:79], v[124:127]
ds_read_b128 v[28:31], v9 offset:49152
v_mfma_f32_16x16x32_bf16 v[156:159], v[92:95], v[80:83], v[156:159]
ds_read_b64_tr_b16 v[44:45], v15 offset:0
v_mfma_f32_16x16x32_bf16 v[188:191], v[92:95], v[84:87], v[188:191]
ds_read_b64_tr_b16 v[46:47], v15 offset:4096
v_mfma_f32_16x16x32_bf16 v[220:223], v[92:95], v[88:91], v[220:223]
ds_read_b64_tr_b16 v[48:49], v16 offset:0
v_mfma_f32_16x16x32_bf16 v[224:227], v[96:99], v[88:91], v[224:227]
ds_read_b64_tr_b16 v[50:51], v16 offset:4096
v_mfma_f32_16x16x32_bf16 v[192:195], v[96:99], v[84:87], v[192:195]
ds_read_b64_tr_b16 v[52:53], v17 offset:0
v_mfma_f32_16x16x32_bf16 v[160:163], v[96:99], v[80:83], v[160:163]
ds_read_b64_tr_b16 v[54:55], v17 offset:4096
v_mfma_f32_16x16x32_bf16 v[128:131], v[96:99], v[76:79], v[128:131]
ds_read_b64_tr_b16 v[56:57], v18 offset:0
v_mfma_f32_16x16x32_bf16 v[132:135], v[100:103], v[76:79], v[132:135]
ds_read_b64_tr_b16 v[58:59], v18 offset:4096
v_mfma_f32_16x16x32_bf16 v[164:167], v[100:103], v[80:83], v[164:167]
ds_read_b64_tr_b16 v[60:61], v15 offset:16384
v_mfma_f32_16x16x32_bf16 v[196:199], v[100:103], v[84:87], v[196:199]
ds_read_b64_tr_b16 v[62:63], v15 offset:20480
v_mfma_f32_16x16x32_bf16 v[228:231], v[100:103], v[88:91], v[228:231]
ds_read_b64_tr_b16 v[64:65], v16 offset:16384
v_mfma_f32_16x16x32_bf16 v[232:235], v[104:107], v[88:91], v[232:235]
ds_read_b64_tr_b16 v[66:67], v16 offset:20480
v_mfma_f32_16x16x32_bf16 v[200:203], v[104:107], v[84:87], v[200:203]
ds_read_b64_tr_b16 v[68:69], v17 offset:16384
v_mfma_f32_16x16x32_bf16 v[168:171], v[104:107], v[80:83], v[168:171]
ds_read_b64_tr_b16 v[70:71], v17 offset:20480
v_mfma_f32_16x16x32_bf16 v[136:139], v[104:107], v[76:79], v[136:139]
ds_read_b64_tr_b16 v[72:73], v18 offset:16384
v_mfma_f32_16x16x32_bf16 v[140:143], v[108:111], v[76:79], v[140:143]
ds_read_b64_tr_b16 v[74:75], v18 offset:20480
v_mfma_f32_16x16x32_bf16 v[172:175], v[108:111], v[80:83], v[172:175]
ds_read_b128 v[32:35], v9 offset:50176
v_mfma_f32_16x16x32_bf16 v[204:207], v[108:111], v[84:87], v[204:207]
ds_read_b128 v[36:39], v9 offset:51200
v_mfma_f32_16x16x32_bf16 v[236:239], v[108:111], v[88:91], v[236:239]
ds_read_b128 v[40:43], v9 offset:52224
v_mfma_f32_16x16x32_bf16 v[240:243], v[112:115], v[88:91], v[240:243]
v_mfma_f32_16x16x32_bf16 v[208:211], v[112:115], v[84:87], v[208:211]
v_mfma_f32_16x16x32_bf16 v[176:179], v[112:115], v[80:83], v[176:179]
v_mfma_f32_16x16x32_bf16 v[144:147], v[112:115], v[76:79], v[144:147]
v_mfma_f32_16x16x32_bf16 v[148:151], v[116:119], v[76:79], v[148:151]
v_mfma_f32_16x16x32_bf16 v[180:183], v[116:119], v[80:83], v[180:183]
v_mfma_f32_16x16x32_bf16 v[212:215], v[116:119], v[84:87], v[212:215]
v_mfma_f32_16x16x32_bf16 v[244:247], v[116:119], v[88:91], v[244:247]
v_mfma_f32_16x16x32_bf16 v[248:251], v[120:123], v[88:91], v[248:251]
v_mfma_f32_16x16x32_bf16 v[216:219], v[120:123], v[84:87], v[216:219]
v_mfma_f32_16x16x32_bf16 v[184:187], v[120:123], v[80:83], v[184:187]
v_mfma_f32_16x16x32_bf16 v[152:155], v[120:123], v[76:79], v[152:155]
s_waitcnt lgkmcnt(0)
v_mfma_f32_16x16x32_bf16 v[124:127], v[44:47], v[28:31], v[124:127]
ds_read_b128 v[76:79], v9 offset:57344
v_mfma_f32_16x16x32_bf16 v[156:159], v[44:47], v[32:35], v[156:159]
ds_read_b64_tr_b16 v[92:93], v15 offset:8192
v_mfma_f32_16x16x32_bf16 v[188:191], v[44:47], v[36:39], v[188:191]
ds_read_b64_tr_b16 v[94:95], v15 offset:12288
v_mfma_f32_16x16x32_bf16 v[220:223], v[44:47], v[40:43], v[220:223]
ds_read_b64_tr_b16 v[96:97], v16 offset:8192
v_mfma_f32_16x16x32_bf16 v[224:227], v[48:51], v[40:43], v[224:227]
ds_read_b64_tr_b16 v[98:99], v16 offset:12288
v_mfma_f32_16x16x32_bf16 v[192:195], v[48:51], v[36:39], v[192:195]
ds_read_b64_tr_b16 v[100:101], v17 offset:8192
v_mfma_f32_16x16x32_bf16 v[160:163], v[48:51], v[32:35], v[160:163]
ds_read_b64_tr_b16 v[102:103], v17 offset:12288
v_mfma_f32_16x16x32_bf16 v[128:131], v[48:51], v[28:31], v[128:131]
ds_read_b64_tr_b16 v[104:105], v18 offset:8192
v_mfma_f32_16x16x32_bf16 v[132:135], v[52:55], v[28:31], v[132:135]
ds_read_b64_tr_b16 v[106:107], v18 offset:12288
v_mfma_f32_16x16x32_bf16 v[164:167], v[52:55], v[32:35], v[164:167]
ds_read_b64_tr_b16 v[108:109], v15 offset:24576
v_mfma_f32_16x16x32_bf16 v[196:199], v[52:55], v[36:39], v[196:199]
ds_read_b64_tr_b16 v[110:111], v15 offset:28672
v_mfma_f32_16x16x32_bf16 v[228:231], v[52:55], v[40:43], v[228:231]
ds_read_b64_tr_b16 v[112:113], v16 offset:24576
v_mfma_f32_16x16x32_bf16 v[232:235], v[56:59], v[40:43], v[232:235]
ds_read_b64_tr_b16 v[114:115], v16 offset:28672
v_mfma_f32_16x16x32_bf16 v[200:203], v[56:59], v[36:39], v[200:203]
ds_read_b64_tr_b16 v[116:117], v17 offset:24576
v_mfma_f32_16x16x32_bf16 v[168:171], v[56:59], v[32:35], v[168:171]
ds_read_b64_tr_b16 v[118:119], v17 offset:28672
v_mfma_f32_16x16x32_bf16 v[136:139], v[56:59], v[28:31], v[136:139]
ds_read_b64_tr_b16 v[120:121], v18 offset:24576
v_mfma_f32_16x16x32_bf16 v[140:143], v[60:63], v[28:31], v[140:143]
ds_read_b64_tr_b16 v[122:123], v18 offset:28672
v_mfma_f32_16x16x32_bf16 v[172:175], v[60:63], v[32:35], v[172:175]
ds_read_b128 v[80:83], v9 offset:58368
v_mfma_f32_16x16x32_bf16 v[204:207], v[60:63], v[36:39], v[204:207]
ds_read_b128 v[84:87], v9 offset:59392
v_mfma_f32_16x16x32_bf16 v[236:239], v[60:63], v[40:43], v[236:239]
ds_read_b128 v[88:91], v9 offset:60416
v_mfma_f32_16x16x32_bf16 v[240:243], v[64:67], v[40:43], v[240:243]
v_mfma_f32_16x16x32_bf16 v[208:211], v[64:67], v[36:39], v[208:211]
v_mfma_f32_16x16x32_bf16 v[176:179], v[64:67], v[32:35], v[176:179]
v_mfma_f32_16x16x32_bf16 v[144:147], v[64:67], v[28:31], v[144:147]
v_mfma_f32_16x16x32_bf16 v[148:151], v[68:71], v[28:31], v[148:151]
v_mfma_f32_16x16x32_bf16 v[180:183], v[68:71], v[32:35], v[180:183]
v_mfma_f32_16x16x32_bf16 v[212:215], v[68:71], v[36:39], v[212:215]
v_mfma_f32_16x16x32_bf16 v[244:247], v[68:71], v[40:43], v[244:247]
v_mfma_f32_16x16x32_bf16 v[248:251], v[72:75], v[40:43], v[248:251]
v_mfma_f32_16x16x32_bf16 v[216:219], v[72:75], v[36:39], v[216:219]
v_mfma_f32_16x16x32_bf16 v[184:187], v[72:75], v[32:35], v[184:187]
v_mfma_f32_16x16x32_bf16 v[152:155], v[72:75], v[28:31], v[152:155]
s_waitcnt lgkmcnt(0)
s_barrier
v_mfma_f32_16x16x32_bf16 v[124:127], v[92:95], v[76:79], v[124:127]
ds_read_b128 v[28:31], v10 offset:0
v_mfma_f32_16x16x32_bf16 v[156:159], v[92:95], v[80:83], v[156:159]
ds_read_b64_tr_b16 v[44:45], v19 offset:0
v_mfma_f32_16x16x32_bf16 v[188:191], v[92:95], v[84:87], v[188:191]
ds_read_b64_tr_b16 v[46:47], v19 offset:4096
v_mfma_f32_16x16x32_bf16 v[220:223], v[92:95], v[88:91], v[220:223]
ds_read_b64_tr_b16 v[48:49], v20 offset:0
v_mfma_f32_16x16x32_bf16 v[224:227], v[96:99], v[88:91], v[224:227]
ds_read_b64_tr_b16 v[50:51], v20 offset:4096
v_mfma_f32_16x16x32_bf16 v[192:195], v[96:99], v[84:87], v[192:195]
ds_read_b64_tr_b16 v[52:53], v21 offset:0
v_mfma_f32_16x16x32_bf16 v[160:163], v[96:99], v[80:83], v[160:163]
ds_read_b64_tr_b16 v[54:55], v21 offset:4096
v_mfma_f32_16x16x32_bf16 v[128:131], v[96:99], v[76:79], v[128:131]
ds_read_b64_tr_b16 v[56:57], v22 offset:0
v_mfma_f32_16x16x32_bf16 v[132:135], v[100:103], v[76:79], v[132:135]
ds_read_b64_tr_b16 v[58:59], v22 offset:4096
v_mfma_f32_16x16x32_bf16 v[164:167], v[100:103], v[80:83], v[164:167]
ds_read_b64_tr_b16 v[60:61], v19 offset:16384
v_mfma_f32_16x16x32_bf16 v[196:199], v[100:103], v[84:87], v[196:199]
ds_read_b64_tr_b16 v[62:63], v19 offset:20480
v_mfma_f32_16x16x32_bf16 v[228:231], v[100:103], v[88:91], v[228:231]
ds_read_b64_tr_b16 v[64:65], v20 offset:16384
v_mfma_f32_16x16x32_bf16 v[232:235], v[104:107], v[88:91], v[232:235]
ds_read_b64_tr_b16 v[66:67], v20 offset:20480
v_mfma_f32_16x16x32_bf16 v[200:203], v[104:107], v[84:87], v[200:203]
ds_read_b64_tr_b16 v[68:69], v21 offset:16384
v_mfma_f32_16x16x32_bf16 v[168:171], v[104:107], v[80:83], v[168:171]
ds_read_b64_tr_b16 v[70:71], v21 offset:20480
v_mfma_f32_16x16x32_bf16 v[136:139], v[104:107], v[76:79], v[136:139]
ds_read_b64_tr_b16 v[72:73], v22 offset:16384
v_mfma_f32_16x16x32_bf16 v[140:143], v[108:111], v[76:79], v[140:143]
ds_read_b64_tr_b16 v[74:75], v22 offset:20480
v_mfma_f32_16x16x32_bf16 v[172:175], v[108:111], v[80:83], v[172:175]
ds_read_b128 v[32:35], v10 offset:1024
v_mfma_f32_16x16x32_bf16 v[204:207], v[108:111], v[84:87], v[204:207]
ds_read_b128 v[36:39], v10 offset:2048
v_mfma_f32_16x16x32_bf16 v[236:239], v[108:111], v[88:91], v[236:239]
ds_read_b128 v[40:43], v10 offset:3072
v_mfma_f32_16x16x32_bf16 v[240:243], v[112:115], v[88:91], v[240:243]
v_mfma_f32_16x16x32_bf16 v[208:211], v[112:115], v[84:87], v[208:211]
v_mfma_f32_16x16x32_bf16 v[176:179], v[112:115], v[80:83], v[176:179]
v_mfma_f32_16x16x32_bf16 v[144:147], v[112:115], v[76:79], v[144:147]
v_mfma_f32_16x16x32_bf16 v[148:151], v[116:119], v[76:79], v[148:151]
v_mfma_f32_16x16x32_bf16 v[180:183], v[116:119], v[80:83], v[180:183]
v_mfma_f32_16x16x32_bf16 v[212:215], v[116:119], v[84:87], v[212:215]
v_mfma_f32_16x16x32_bf16 v[244:247], v[116:119], v[88:91], v[244:247]
v_mfma_f32_16x16x32_bf16 v[248:251], v[120:123], v[88:91], v[248:251]
v_mfma_f32_16x16x32_bf16 v[216:219], v[120:123], v[84:87], v[216:219]
v_mfma_f32_16x16x32_bf16 v[184:187], v[120:123], v[80:83], v[184:187]
v_mfma_f32_16x16x32_bf16 v[152:155], v[120:123], v[76:79], v[152:155]
s_sub_u32 s41, s41, 1
s_cmp_lg_u32 s41, 0
s_cbranch_scc1 Lk3l_132
s_waitcnt lgkmcnt(0)
s_barrier
v_lshrrev_b32 v84, 4, v1
s_lshl_b32 s43, s63, 8
s_add_u32 s43, s43, 148480
v_lshl_add_u32 v85, v84, 4, s43
v_and_b32 v84, 15, v1
s_lshl_b32 s43, s62, 9
s_add_u32 s43, s43, 147456
v_lshl_add_u32 v84, v84, 3, s43
ds_read_b128 v[28:31], v85 offset:0
ds_read_b128 v[32:35], v85 offset:64
ds_read_b128 v[36:39], v85 offset:128
ds_read_b128 v[40:43], v85 offset:192
ds_read_b128 v[44:47], v85 offset:896
ds_read_b128 v[48:51], v85 offset:960
ds_read_b128 v[52:55], v85 offset:1024
ds_read_b128 v[56:59], v85 offset:1088
ds_read_b64 v[60:61], v84 offset:0
ds_read_b64 v[62:63], v84 offset:128
ds_read_b64 v[64:65], v84 offset:256
ds_read_b64 v[66:67], v84 offset:384
s_lshl_b32 s54, s35, 15
s_lshl_b32 s43, s63, 14
s_add_u32 s54, s54, s43
s_lshl_b32 s43, s62, 12
s_add_u32 s54, s54, s43
s_add_u32 s55, s54, 8192
v_lshrrev_b32 v122, 3, v1
v_and_b32 v123, 6, v122
v_and_b32 v25, 7, v1
v_xor_b32 v25, v25, v123
v_lshlrev_b32 v25, 4, v25
v_mul_u32_u24 v122, 2048, v122
v_add_u32 v25, v25, v122
s_lshl_b32 s43, s61, 7
s_lshl_b32 s44, s47, 15
s_add_u32 s43, s43, s44
v_add_u32 v25, s43, v25
s_waitcnt lgkmcnt(0)
s_add_u32 s37, s52, 589824
s_add_u32 m0, s39, 81920
s_nop 0
buffer_load_dwordx4 v3, s[24:27], s37 offen sc1 lds
v_mul_f32 v70, v61, v61
v_mul_f32 v68, 0xc0135761, v61
v_mul_f32 v69, 0xbdd2d3e8, v61
v_mul_f32 v69, v69, v70
v_rcp_f32 v70, v70
v_mul_f32 v74, v63, v63
v_mul_f32 v72, 0xc0135761, v63
v_mul_f32 v73, 0xbdd2d3e8, v63
v_mul_f32 v73, v73, v74
v_rcp_f32 v74, v74
v_fma_f32 v124, -v60, v28, v124
v_fma_f32 v125, -v60, v29, v125
v_fma_f32 v126, -v60, v30, v126
v_fma_f32 v127, -v60, v31, v127
buffer_load_dwordx4 v3, s[24:27], s37 offen offset:1024 sc1 lds
v_fma_f32 v156, -v62, v28, v156
v_fma_f32 v157, -v62, v29, v157
v_fma_f32 v158, -v62, v30, v158
v_fma_f32 v159, -v62, v31, v159
v_mul_f32 v76, v124, v124
v_mul_f32 v77, v125, v125
v_mul_f32 v78, v126, v126
v_mul_f32 v79, v127, v127
v_mul_f32 v80, v156, v156
v_mul_f32 v81, v157, v157
v_mul_f32 v82, v158, v158
v_mul_f32 v83, v159, v159
v_fma_f32 v76, v76, v69, v68
v_fma_f32 v77, v77, v69, v68
buffer_load_dwordx4 v3, s[24:27], s37 offen offset:2048 sc1 lds
v_fma_f32 v78, v78, v69, v68
v_fma_f32 v79, v79, v69, v68
v_fma_f32 v80, v80, v73, v72
v_fma_f32 v81, v81, v73, v72
v_fma_f32 v82, v82, v73, v72
v_fma_f32 v83, v83, v73, v72
v_mul_f32 v76, v76, v124
v_mul_f32 v77, v77, v125
v_mul_f32 v78, v78, v126
v_mul_f32 v79, v79, v127
v_mul_f32 v80, v80, v156
v_mul_f32 v81, v81, v157
v_mul_f32 v82, v82, v158
v_mul_f32 v83, v83, v159
buffer_load_dwordx4 v3, s[24:27], s37 offen offset:3072 sc1 lds
v_exp_f32 v76, v76
v_exp_f32 v77, v77
v_exp_f32 v78, v78
v_exp_f32 v79, v79
v_exp_f32 v80, v80
v_exp_f32 v81, v81
v_exp_f32 v82, v82
v_exp_f32 v83, v83
v_fma_f32 v140, -v60, v44, v140
v_fma_f32 v141, -v60, v45, v141
v_fma_f32 v142, -v60, v46, v142
v_fma_f32 v143, -v60, v47, v143
v_fma_f32 v172, -v62, v44, v172
v_fma_f32 v173, -v62, v45, v173
s_add_u32 s37, s52, 606208
s_add_u32 m0, s39, 98304
s_nop 0
buffer_load_dwordx4 v3, s[24:27], s37 offen sc1 lds
v_fma_f32 v174, -v62, v46, v174
v_fma_f32 v175, -v62, v47, v175
v_fma_f32 v76, v76, v70, v70
v_fma_f32 v77, v77, v70, v70
v_fma_f32 v78, v78, v70, v70
v_fma_f32 v79, v79, v70, v70
v_fma_f32 v80, v80, v74, v74
v_fma_f32 v81, v81, v74, v74
v_fma_f32 v82, v82, v74, v74
v_fma_f32 v83, v83, v74, v74
v_rcp_f32 v76, v76
v_rcp_f32 v77, v77
v_rcp_f32 v78, v78
v_rcp_f32 v79, v79
buffer_load_dwordx4 v3, s[24:27], s37 offen offset:1024 sc1 lds
v_rcp_f32 v80, v80
v_rcp_f32 v81, v81
v_rcp_f32 v82, v82
v_rcp_f32 v83, v83
v_mul_f32 v140, v124, v140
v_mul_f32 v141, v125, v141
v_mul_f32 v142, v126, v142
v_mul_f32 v143, v127, v143
v_mul_f32 v172, v156, v172
v_mul_f32 v173, v157, v173
v_mul_f32 v174, v158, v174
v_mul_f32 v175, v159, v175
v_mul_f32 v140, v140, v76
v_mul_f32 v141, v141, v77
s_branch Lov_16
.p2align 12
.fill 128, 4, 0xbf800000
Lst_16_0:
s_branch Lwr_157
Lst_16_1:
s_branch Lwr_169
s_nop 0
Lov_16:
buffer_load_dwordx4 v3, s[24:27], s37 offen offset:2048 sc1 lds
v_mul_f32 v142, v142, v78
v_mul_f32 v143, v143, v79
v_mul_f32 v172, v172, v80
v_mul_f32 v173, v173, v81
v_mul_f32 v174, v174, v82
v_mul_f32 v175, v175, v83
v_cvt_pk_bf16_f32 v124, v140, v141
v_cvt_pk_bf16_f32 v125, v142, v143
v_cvt_pk_bf16_f32 v156, v172, v173
v_cvt_pk_bf16_f32 v157, v174, v175
v_fma_f32 v128, -v60, v32, v128
v_fma_f32 v129, -v60, v33, v129
v_fma_f32 v130, -v60, v34, v130
v_fma_f32 v131, -v60, v35, v131
buffer_load_dwordx4 v3, s[24:27], s37 offen offset:3072 sc1 lds
v_fma_f32 v160, -v62, v32, v160
v_fma_f32 v161, -v62, v33, v161
v_fma_f32 v162, -v62, v34, v162
v_fma_f32 v163, -v62, v35, v163
v_mul_f32 v76, v128, v128
v_mul_f32 v77, v129, v129
v_mul_f32 v78, v130, v130
v_mul_f32 v79, v131, v131
v_mul_f32 v80, v160, v160
v_mul_f32 v81, v161, v161
v_mul_f32 v82, v162, v162
v_mul_f32 v83, v163, v163
v_fma_f32 v76, v76, v69, v68
v_fma_f32 v77, v77, v69, v68
s_add_u32 s38, s53, 4849664
s_add_u32 m0, s39, 114688
s_nop 0
buffer_load_dwordx4 v23, s[28:31], s38 offen lds
v_fma_f32 v78, v78, v69, v68
v_fma_f32 v79, v79, v69, v68
v_fma_f32 v80, v80, v73, v72
v_fma_f32 v81, v81, v73, v72
v_fma_f32 v82, v82, v73, v72
v_fma_f32 v83, v83, v73, v72
v_mul_f32 v76, v76, v128
v_mul_f32 v77, v77, v129
v_mul_f32 v78, v78, v130
v_mul_f32 v79, v79, v131
v_mul_f32 v80, v80, v160
v_mul_f32 v81, v81, v161
v_mul_f32 v82, v82, v162
v_mul_f32 v83, v83, v163
s_add_u32 m0, s39, 115712
s_nop 0
buffer_load_dwordx4 v24, s[28:31], s38 offen lds
v_exp_f32 v76, v76
v_exp_f32 v77, v77
v_exp_f32 v78, v78
v_exp_f32 v79, v79
v_exp_f32 v80, v80
v_exp_f32 v81, v81
v_exp_f32 v82, v82
v_exp_f32 v83, v83
v_fma_f32 v144, -v60, v48, v144
v_fma_f32 v145, -v60, v49, v145
v_fma_f32 v146, -v60, v50, v146
v_fma_f32 v147, -v60, v51, v147
v_fma_f32 v176, -v62, v48, v176
v_fma_f32 v177, -v62, v49, v177
s_add_u32 m0, s39, 116736
s_add_u32 s38, s38, 16384
buffer_load_dwordx4 v23, s[28:31], s38 offen lds
s_add_u32 m0, s39, 117760
s_nop 0
buffer_load_dwordx4 v24, s[28:31], s38 offen lds
s_barrier
s_add_u32 s38, s53, 4718592
s_add_u32 m0, s39, 147456
s_nop 0
buffer_load_dwordx4 v23, s[28:31], s38 offen lds
v_fma_f32 v178, -v62, v50, v178
v_fma_f32 v179, -v62, v51, v179
v_fma_f32 v76, v76, v70, v70
v_fma_f32 v77, v77, v70, v70
v_fma_f32 v78, v78, v70, v70
v_fma_f32 v79, v79, v70, v70
v_fma_f32 v80, v80, v74, v74
v_fma_f32 v81, v81, v74, v74
v_fma_f32 v82, v82, v74, v74
v_fma_f32 v83, v83, v74, v74
v_rcp_f32 v76, v76
v_rcp_f32 v77, v77
v_rcp_f32 v78, v78
v_rcp_f32 v79, v79
s_add_u32 m0, s39, 148480
s_nop 0
buffer_load_dwordx4 v24, s[28:31], s38 offen lds
v_rcp_f32 v80, v80
v_rcp_f32 v81, v81
v_rcp_f32 v82, v82
v_rcp_f32 v83, v83
v_mul_f32 v144, v128, v144
v_mul_f32 v145, v129, v145
v_mul_f32 v146, v130, v146
v_mul_f32 v147, v131, v147
v_mul_f32 v176, v160, v176
v_mul_f32 v177, v161, v177
v_mul_f32 v178, v162, v178
v_mul_f32 v179, v163, v179
v_mul_f32 v144, v144, v76
v_mul_f32 v145, v145, v77
s_add_u32 m0, s39, 149504
s_add_u32 s38, s38, 16384
buffer_load_dwordx4 v23, s[28:31], s38 offen lds
v_mul_f32 v146, v146, v78
v_mul_f32 v147, v147, v79
v_mul_f32 v176, v176, v80
v_mul_f32 v177, v177, v81
v_mul_f32 v178, v178, v82
v_mul_f32 v179, v179, v83
v_cvt_pk_bf16_f32 v126, v144, v145
v_cvt_pk_bf16_f32 v127, v146, v147
v_cvt_pk_bf16_f32 v158, v176, v177
v_cvt_pk_bf16_f32 v159, v178, v179
buffer_store_dwordx4 v[124:127], v2, s[24:27], s54 offen offset:0 sc1
buffer_store_dwordx4 v[156:159], v2, s[24:27], s54 offen offset:1024 sc1
v_fma_f32 v132, -v60, v36, v132
v_fma_f32 v133, -v60, v37, v133
s_add_u32 m0, s39, 150528
s_nop 0
buffer_load_dwordx4 v24, s[28:31], s38 offen lds
v_fma_f32 v134, -v60, v38, v134
v_fma_f32 v135, -v60, v39, v135
v_fma_f32 v164, -v62, v36, v164
v_fma_f32 v165, -v62, v37, v165
v_fma_f32 v166, -v62, v38, v166
v_fma_f32 v167, -v62, v39, v167
v_mul_f32 v76, v132, v132
v_mul_f32 v77, v133, v133
v_mul_f32 v78, v134, v134
v_mul_f32 v79, v135, v135
v_mul_f32 v80, v164, v164
v_mul_f32 v81, v165, v165
v_mul_f32 v82, v166, v166
v_mul_f32 v83, v167, v167
s_add_u32 s37, s52, 622592
s_add_u32 m0, s39, 131072
s_nop 0
buffer_load_dwordx4 v3, s[24:27], s37 offen sc1 lds
v_fma_f32 v76, v76, v69, v68
v_fma_f32 v77, v77, v69, v68
v_fma_f32 v78, v78, v69, v68
v_fma_f32 v79, v79, v69, v68
v_fma_f32 v80, v80, v73, v72
v_fma_f32 v81, v81, v73, v72
v_fma_f32 v82, v82, v73, v72
v_fma_f32 v83, v83, v73, v72
v_mul_f32 v76, v76, v132
v_mul_f32 v77, v77, v133
v_mul_f32 v78, v78, v134
v_mul_f32 v79, v79, v135
v_mul_f32 v80, v80, v164
v_mul_f32 v81, v81, v165
buffer_load_dwordx4 v3, s[24:27], s37 offen offset:1024 sc1 lds
v_mul_f32 v82, v82, v166
v_mul_f32 v83, v83, v167
v_exp_f32 v76, v76
v_exp_f32 v77, v77
v_exp_f32 v78, v78
v_exp_f32 v79, v79
v_exp_f32 v80, v80
v_exp_f32 v81, v81
v_exp_f32 v82, v82
v_exp_f32 v83, v83
v_fma_f32 v148, -v60, v52, v148
v_fma_f32 v149, -v60, v53, v149
v_fma_f32 v150, -v60, v54, v150
v_fma_f32 v151, -v60, v55, v151
buffer_load_dwordx4 v3, s[24:27], s37 offen offset:2048 sc1 lds
v_fma_f32 v180, -v62, v52, v180
v_fma_f32 v181, -v62, v53, v181
v_fma_f32 v182, -v62, v54, v182
v_fma_f32 v183, -v62, v55, v183
v_fma_f32 v76, v76, v70, v70
v_fma_f32 v77, v77, v70, v70
v_fma_f32 v78, v78, v70, v70
v_fma_f32 v79, v79, v70, v70
v_fma_f32 v80, v80, v74, v74
v_fma_f32 v81, v81, v74, v74
v_fma_f32 v82, v82, v74, v74
v_fma_f32 v83, v83, v74, v74
v_rcp_f32 v76, v76
v_rcp_f32 v77, v77
buffer_load_dwordx4 v3, s[24:27], s37 offen offset:3072 sc1 lds
v_rcp_f32 v78, v78
v_rcp_f32 v79, v79
v_rcp_f32 v80, v80
v_rcp_f32 v81, v81
v_rcp_f32 v82, v82
v_rcp_f32 v83, v83
v_mul_f32 v148, v132, v148
v_mul_f32 v149, v133, v149
v_mul_f32 v150, v134, v150
v_mul_f32 v151, v135, v151
v_mul_f32 v180, v164, v180
v_mul_f32 v181, v165, v181
v_mul_f32 v182, v166, v182
v_mul_f32 v183, v167, v183
s_add_u32 s38, s53, 4980736
s_add_u32 m0, s39, 0
s_nop 0
buffer_load_dwordx4 v23, s[28:31], s38 offen lds
v_mul_f32 v148, v148, v76
v_mul_f32 v149, v149, v77
v_mul_f32 v150, v150, v78
v_mul_f32 v151, v151, v79
v_mul_f32 v180, v180, v80
v_mul_f32 v181, v181, v81
v_mul_f32 v182, v182, v82
v_mul_f32 v183, v183, v83
v_cvt_pk_bf16_f32 v132, v148, v149
v_cvt_pk_bf16_f32 v133, v150, v151
v_cvt_pk_bf16_f32 v164, v180, v181
v_cvt_pk_bf16_f32 v165, v182, v183
v_fma_f32 v136, -v60, v40, v136
v_fma_f32 v137, -v60, v41, v137
s_add_u32 m0, s39, 1024
s_nop 0
buffer_load_dwordx4 v24, s[28:31], s38 offen lds
v_fma_f32 v138, -v60, v42, v138
v_fma_f32 v139, -v60, v43, v139
v_fma_f32 v168, -v62, v40, v168
v_fma_f32 v169, -v62, v41, v169
v_fma_f32 v170, -v62, v42, v170
v_fma_f32 v171, -v62, v43, v171
v_mul_f32 v76, v136, v136
v_mul_f32 v77, v137, v137
v_mul_f32 v78, v138, v138
v_mul_f32 v79, v139, v139
v_mul_f32 v80, v168, v168
v_mul_f32 v81, v169, v169
v_mul_f32 v82, v170, v170
v_mul_f32 v83, v171, v171
s_add_u32 m0, s39, 2048
s_add_u32 s38, s38, 16384
buffer_load_dwordx4 v23, s[28:31], s38 offen lds
s_add_u32 m0, s39, 3072
s_nop 0
buffer_load_dwordx4 v24, s[28:31], s38 offen lds
s_barrier
s_add_u32 s37, s52, 638976
s_add_u32 m0, s39, 16384
s_nop 0
buffer_load_dwordx4 v3, s[24:27], s37 offen sc1 lds
v_fma_f32 v76, v76, v69, v68
v_fma_f32 v77, v77, v69, v68
v_fma_f32 v78, v78, v69, v68
v_fma_f32 v79, v79, v69, v68
v_fma_f32 v80, v80, v73, v72
v_fma_f32 v81, v81, v73, v72
v_fma_f32 v82, v82, v73, v72
v_fma_f32 v83, v83, v73, v72
v_mul_f32 v76, v76, v136
v_mul_f32 v77, v77, v137
v_mul_f32 v78, v78, v138
v_mul_f32 v79, v79, v139
v_mul_f32 v80, v80, v168
v_mul_f32 v81, v81, v169
v_mul_f32 v82, v82, v170
v_mul_f32 v83, v83, v171
v_exp_f32 v76, v76
v_exp_f32 v77, v77
v_exp_f32 v78, v78
v_exp_f32 v79, v79
v_exp_f32 v80, v80
v_exp_f32 v81, v81
v_exp_f32 v82, v82
buffer_load_dwordx4 v3, s[24:27], s37 offen offset:1024 sc1 lds
v_exp_f32 v83, v83
v_fma_f32 v152, -v60, v56, v152
v_fma_f32 v153, -v60, v57, v153
v_fma_f32 v154, -v60, v58, v154
v_fma_f32 v155, -v60, v59, v155
v_fma_f32 v184, -v62, v56, v184
v_fma_f32 v185, -v62, v57, v185
v_fma_f32 v186, -v62, v58, v186
v_fma_f32 v187, -v62, v59, v187
v_fma_f32 v76, v76, v70, v70
v_fma_f32 v77, v77, v70, v70
v_fma_f32 v78, v78, v70, v70
v_fma_f32 v79, v79, v70, v70
v_fma_f32 v80, v80, v74, v74
v_fma_f32 v81, v81, v74, v74
v_fma_f32 v82, v82, v74, v74
v_fma_f32 v83, v83, v74, v74
v_rcp_f32 v76, v76
v_rcp_f32 v77, v77
v_rcp_f32 v78, v78
v_rcp_f32 v79, v79
v_rcp_f32 v80, v80
v_rcp_f32 v81, v81
buffer_load_dwordx4 v3, s[24:27], s37 offen offset:2048 sc1 lds
v_rcp_f32 v82, v82
v_rcp_f32 v83, v83
v_mul_f32 v152, v136, v152
v_mul_f32 v153, v137, v153
v_mul_f32 v154, v138, v154
v_mul_f32 v155, v139, v155
v_mul_f32 v184, v168, v184
v_mul_f32 v185, v169, v185
v_mul_f32 v186, v170, v186
v_mul_f32 v187, v171, v187
v_mul_f32 v152, v152, v76
v_mul_f32 v153, v153, v77
v_mul_f32 v154, v154, v78
v_mul_f32 v155, v155, v79
v_mul_f32 v184, v184, v80
v_mul_f32 v185, v185, v81
v_mul_f32 v186, v186, v82
v_mul_f32 v187, v187, v83
v_cvt_pk_bf16_f32 v134, v152, v153
v_cvt_pk_bf16_f32 v135, v154, v155
v_cvt_pk_bf16_f32 v166, v184, v185
v_cvt_pk_bf16_f32 v167, v186, v187
buffer_store_dwordx4 v[132:135], v2, s[24:27], s55 offen offset:0 sc1
buffer_store_dwordx4 v[164:167], v2, s[24:27], s55 offen offset:1024 sc1
buffer_load_dwordx4 v3, s[24:27], s37 offen offset:3072 sc1 lds
v_mul_f32 v70, v65, v65
v_mul_f32 v68, 0xc0135761, v65
v_mul_f32 v69, 0xbdd2d3e8, v65
v_mul_f32 v69, v69, v70
v_rcp_f32 v70, v70
v_mul_f32 v74, v67, v67
v_mul_f32 v72, 0xc0135761, v67
v_mul_f32 v73, 0xbdd2d3e8, v67
v_mul_f32 v73, v73, v74
v_rcp_f32 v74, v74
v_fma_f32 v188, -v64, v28, v188
v_fma_f32 v189, -v64, v29, v189
v_fma_f32 v190, -v64, v30, v190
v_fma_f32 v191, -v64, v31, v191
v_fma_f32 v220, -v66, v28, v220
v_fma_f32 v221, -v66, v29, v221
v_fma_f32 v222, -v66, v30, v222
v_fma_f32 v223, -v66, v31, v223
v_mul_f32 v76, v188, v188
v_mul_f32 v77, v189, v189
v_mul_f32 v78, v190, v190
v_mul_f32 v79, v191, v191
v_mul_f32 v80, v220, v220
s_add_u32 s38, s53, 5111808
s_add_u32 m0, s39, 32768
s_nop 0
buffer_load_dwordx4 v23, s[28:31], s38 offen lds
v_mul_f32 v81, v221, v221
v_mul_f32 v82, v222, v222
v_mul_f32 v83, v223, v223
v_fma_f32 v76, v76, v69, v68
v_fma_f32 v77, v77, v69, v68
v_fma_f32 v78, v78, v69, v68
v_fma_f32 v79, v79, v69, v68
v_fma_f32 v80, v80, v73, v72
v_fma_f32 v81, v81, v73, v72
v_fma_f32 v82, v82, v73, v72
v_fma_f32 v83, v83, v73, v72
v_mul_f32 v76, v76, v188
v_mul_f32 v77, v77, v189
v_mul_f32 v78, v78, v190
v_mul_f32 v79, v79, v191
v_mul_f32 v80, v80, v220
v_mul_f32 v81, v81, v221
v_mul_f32 v82, v82, v222
v_mul_f32 v83, v83, v223
v_exp_f32 v76, v76
v_exp_f32 v77, v77
v_exp_f32 v78, v78
v_exp_f32 v79, v79
s_add_u32 m0, s39, 33792
s_nop 0
buffer_load_dwordx4 v24, s[28:31], s38 offen lds
v_exp_f32 v80, v80
v_exp_f32 v81, v81
v_exp_f32 v82, v82
v_exp_f32 v83, v83
v_fma_f32 v204, -v64, v44, v204
v_fma_f32 v205, -v64, v45, v205
v_fma_f32 v206, -v64, v46, v206
v_fma_f32 v207, -v64, v47, v207
v_fma_f32 v236, -v66, v44, v236
v_fma_f32 v237, -v66, v45, v237
v_fma_f32 v238, -v66, v46, v238
v_fma_f32 v239, -v66, v47, v239
v_fma_f32 v76, v76, v70, v70
v_fma_f32 v77, v77, v70, v70
v_fma_f32 v78, v78, v70, v70
v_fma_f32 v79, v79, v70, v70
v_fma_f32 v80, v80, v74, v74
v_fma_f32 v81, v81, v74, v74
v_fma_f32 v82, v82, v74, v74
v_fma_f32 v83, v83, v74, v74
v_rcp_f32 v76, v76
v_rcp_f32 v77, v77
v_rcp_f32 v78, v78
v_rcp_f32 v79, v79
s_add_u32 m0, s39, 34816
s_add_u32 s38, s38, 16384
buffer_load_dwordx4 v23, s[28:31], s38 offen lds
s_add_u32 m0, s39, 35840
s_nop 0
buffer_load_dwordx4 v24, s[28:31], s38 offen lds
s_waitcnt vmcnt(18)
s_barrier
s_add_u32 s37, s52, 655360
s_add_u32 m0, s39, 49152
s_nop 0
buffer_load_dwordx4 v3, s[24:27], s37 offen sc1 lds
v_rcp_f32 v80, v80
v_rcp_f32 v81, v81
v_rcp_f32 v82, v82
v_rcp_f32 v83, v83
v_mul_f32 v204, v188, v204
v_mul_f32 v205, v189, v205
v_mul_f32 v206, v190, v206
v_mul_f32 v207, v191, v207
v_mul_f32 v236, v220, v236
v_mul_f32 v237, v221, v237
v_mul_f32 v238, v222, v238
v_mul_f32 v239, v223, v239
v_mul_f32 v204, v204, v76
v_mul_f32 v205, v205, v77
v_mul_f32 v206, v206, v78
v_mul_f32 v207, v207, v79
v_mul_f32 v236, v236, v80
v_mul_f32 v237, v237, v81
v_mul_f32 v238, v238, v82
v_mul_f32 v239, v239, v83
v_cvt_pk_bf16_f32 v188, v204, v205
v_cvt_pk_bf16_f32 v189, v206, v207
v_cvt_pk_bf16_f32 v220, v236, v237
buffer_load_dwordx4 v3, s[24:27], s37 offen offset:1024 sc1 lds
v_cvt_pk_bf16_f32 v221, v238, v239
v_fma_f32 v192, -v64, v32, v192
v_fma_f32 v193, -v64, v33, v193
v_fma_f32 v194, -v64, v34, v194
v_fma_f32 v195, -v64, v35, v195
v_fma_f32 v224, -v66, v32, v224
v_fma_f32 v225, -v66, v33, v225
v_fma_f32 v226, -v66, v34, v226
v_fma_f32 v227, -v66, v35, v227
v_mul_f32 v76, v192, v192
v_mul_f32 v77, v193, v193
v_mul_f32 v78, v194, v194
v_mul_f32 v79, v195, v195
v_mul_f32 v80, v224, v224
v_mul_f32 v81, v225, v225
v_mul_f32 v82, v226, v226
v_mul_f32 v83, v227, v227
v_fma_f32 v76, v76, v69, v68
v_fma_f32 v77, v77, v69, v68
v_fma_f32 v78, v78, v69, v68
v_fma_f32 v79, v79, v69, v68
v_fma_f32 v80, v80, v73, v72
v_fma_f32 v81, v81, v73, v72
buffer_load_dwordx4 v3, s[24:27], s37 offen offset:2048 sc1 lds
v_fma_f32 v82, v82, v73, v72
v_fma_f32 v83, v83, v73, v72
v_mul_f32 v76, v76, v192
v_mul_f32 v77, v77, v193
v_mul_f32 v78, v78, v194
v_mul_f32 v79, v79, v195
v_mul_f32 v80, v80, v224
v_mul_f32 v81, v81, v225
v_mul_f32 v82, v82, v226
v_mul_f32 v83, v83, v227
v_exp_f32 v76, v76
v_exp_f32 v77, v77
v_exp_f32 v78, v78
v_exp_f32 v79, v79
v_exp_f32 v80, v80
v_exp_f32 v81, v81
v_exp_f32 v82, v82
v_exp_f32 v83, v83
v_fma_f32 v208, -v64, v48, v208
v_fma_f32 v209, -v64, v49, v209
v_fma_f32 v210, -v64, v50, v210
v_fma_f32 v211, -v64, v51, v211
v_fma_f32 v240, -v66, v48, v240
v_fma_f32 v241, -v66, v49, v241
buffer_load_dwordx4 v3, s[24:27], s37 offen offset:3072 sc1 lds
v_fma_f32 v242, -v66, v50, v242
v_fma_f32 v243, -v66, v51, v243
v_fma_f32 v76, v76, v70, v70
v_fma_f32 v77, v77, v70, v70
v_fma_f32 v78, v78, v70, v70
v_fma_f32 v79, v79, v70, v70
v_fma_f32 v80, v80, v74, v74
v_fma_f32 v81, v81, v74, v74
v_fma_f32 v82, v82, v74, v74
v_fma_f32 v83, v83, v74, v74
v_rcp_f32 v76, v76
v_rcp_f32 v77, v77
v_rcp_f32 v78, v78
v_rcp_f32 v79, v79
v_rcp_f32 v80, v80
v_rcp_f32 v81, v81
v_rcp_f32 v82, v82
v_rcp_f32 v83, v83
v_mul_f32 v208, v192, v208
v_mul_f32 v209, v193, v209
v_mul_f32 v210, v194, v210
v_mul_f32 v211, v195, v211
v_mul_f32 v240, v224, v240
s_add_u32 s38, s53, 5242880
s_add_u32 m0, s39, 65536
s_nop 0
buffer_load_dwordx4 v23, s[28:31], s38 offen lds
v_mul_f32 v241, v225, v241
v_mul_f32 v242, v226, v242
v_mul_f32 v243, v227, v243
v_mul_f32 v208, v208, v76
v_mul_f32 v209, v209, v77
v_mul_f32 v210, v210, v78
v_mul_f32 v211, v211, v79
v_mul_f32 v240, v240, v80
v_mul_f32 v241, v241, v81
v_mul_f32 v242, v242, v82
v_mul_f32 v243, v243, v83
v_cvt_pk_bf16_f32 v190, v208, v209
v_cvt_pk_bf16_f32 v191, v210, v211
v_cvt_pk_bf16_f32 v222, v240, v241
v_cvt_pk_bf16_f32 v223, v242, v243
buffer_store_dwordx4 v[188:191], v2, s[24:27], s54 offen offset:2048 sc1
buffer_store_dwordx4 v[220:223], v2, s[24:27], s54 offen offset:3072 sc1
v_fma_f32 v196, -v64, v36, v196
v_fma_f32 v197, -v64, v37, v197
v_fma_f32 v198, -v64, v38, v198
v_fma_f32 v199, -v64, v39, v199
v_fma_f32 v228, -v66, v36, v228
v_fma_f32 v229, -v66, v37, v229
s_add_u32 m0, s39, 66560
s_nop 0
buffer_load_dwordx4 v24, s[28:31], s38 offen lds
v_fma_f32 v230, -v66, v38, v230
v_fma_f32 v231, -v66, v39, v231
v_mul_f32 v76, v196, v196
v_mul_f32 v77, v197, v197
v_mul_f32 v78, v198, v198
v_mul_f32 v79, v199, v199
v_mul_f32 v80, v228, v228
v_mul_f32 v81, v229, v229
v_mul_f32 v82, v230, v230
v_mul_f32 v83, v231, v231
v_fma_f32 v76, v76, v69, v68
v_fma_f32 v77, v77, v69, v68
v_fma_f32 v78, v78, v69, v68
v_fma_f32 v79, v79, v69, v68
v_fma_f32 v80, v80, v73, v72
v_fma_f32 v81, v81, v73, v72
v_fma_f32 v82, v82, v73, v72
v_fma_f32 v83, v83, v73, v72
v_mul_f32 v76, v76, v196
v_mul_f32 v77, v77, v197
v_mul_f32 v78, v78, v198
v_mul_f32 v79, v79, v199
v_mul_f32 v80, v80, v228
v_mul_f32 v81, v81, v229
s_add_u32 m0, s39, 67584
s_add_u32 s38, s38, 16384
buffer_load_dwordx4 v23, s[28:31], s38 offen lds
s_add_u32 m0, s39, 68608
s_nop 0
buffer_load_dwordx4 v24, s[28:31], s38 offen lds
s_waitcnt vmcnt(34)
s_barrier
s_add_u32 s37, s52, 671744
s_add_u32 m0, s39, 81920
s_nop 0
buffer_load_dwordx4 v3, s[24:27], s37 offen sc1 lds
v_mul_f32 v82, v82, v230
v_mul_f32 v83, v83, v231
v_exp_f32 v76, v76
v_exp_f32 v77, v77
v_exp_f32 v78, v78
v_exp_f32 v79, v79
v_exp_f32 v80, v80
v_exp_f32 v81, v81
v_exp_f32 v82, v82
v_exp_f32 v83, v83
v_fma_f32 v212, -v64, v52, v212
v_fma_f32 v213, -v64, v53, v213
v_fma_f32 v214, -v64, v54, v214
v_fma_f32 v215, -v64, v55, v215
v_fma_f32 v244, -v66, v52, v244
v_fma_f32 v245, -v66, v53, v245
v_fma_f32 v246, -v66, v54, v246
v_fma_f32 v247, -v66, v55, v247
v_fma_f32 v76, v76, v70, v70
v_fma_f32 v77, v77, v70, v70
v_fma_f32 v78, v78, v70, v70
v_fma_f32 v79, v79, v70, v70
v_fma_f32 v80, v80, v74, v74
s_branch Lov_17
.p2align 12
.fill 128, 4, 0xbf800000
Lst_17_0:
s_branch Lwr_158
Lst_17_1:
s_branch Lwr_170
s_nop 0
Lov_17:
buffer_load_dwordx4 v3, s[24:27], s37 offen offset:1024 sc1 lds
v_fma_f32 v81, v81, v74, v74
v_fma_f32 v82, v82, v74, v74
v_fma_f32 v83, v83, v74, v74
v_rcp_f32 v76, v76
v_rcp_f32 v77, v77
v_rcp_f32 v78, v78
v_rcp_f32 v79, v79
v_rcp_f32 v80, v80
v_rcp_f32 v81, v81
v_rcp_f32 v82, v82
v_rcp_f32 v83, v83
v_mul_f32 v212, v196, v212
v_mul_f32 v213, v197, v213
v_mul_f32 v214, v198, v214
v_mul_f32 v215, v199, v215
v_mul_f32 v244, v228, v244
v_mul_f32 v245, v229, v245
v_mul_f32 v246, v230, v246
v_mul_f32 v247, v231, v247
v_mul_f32 v212, v212, v76
v_mul_f32 v213, v213, v77
v_mul_f32 v214, v214, v78
v_mul_f32 v215, v215, v79
buffer_load_dwordx4 v3, s[24:27], s37 offen offset:2048 sc1 lds
v_mul_f32 v244, v244, v80
v_mul_f32 v245, v245, v81
v_mul_f32 v246, v246, v82
v_mul_f32 v247, v247, v83
v_cvt_pk_bf16_f32 v196, v212, v213
v_cvt_pk_bf16_f32 v197, v214, v215
v_cvt_pk_bf16_f32 v228, v244, v245
v_cvt_pk_bf16_f32 v229, v246, v247
v_fma_f32 v200, -v64, v40, v200
v_fma_f32 v201, -v64, v41, v201
v_fma_f32 v202, -v64, v42, v202
v_fma_f32 v203, -v64, v43, v203
v_fma_f32 v232, -v66, v40, v232
v_fma_f32 v233, -v66, v41, v233
v_fma_f32 v234, -v66, v42, v234
v_fma_f32 v235, -v66, v43, v235
v_mul_f32 v76, v200, v200
v_mul_f32 v77, v201, v201
v_mul_f32 v78, v202, v202
v_mul_f32 v79, v203, v203
v_mul_f32 v80, v232, v232
v_mul_f32 v81, v233, v233
v_mul_f32 v82, v234, v234
v_mul_f32 v83, v235, v235
buffer_load_dwordx4 v3, s[24:27], s37 offen offset:3072 sc1 lds
v_fma_f32 v76, v76, v69, v68
v_fma_f32 v77, v77, v69, v68
v_fma_f32 v78, v78, v69, v68
v_fma_f32 v79, v79, v69, v68
v_fma_f32 v80, v80, v73, v72
v_fma_f32 v81, v81, v73, v72
v_fma_f32 v82, v82, v73, v72
v_fma_f32 v83, v83, v73, v72
v_mul_f32 v76, v76, v200
v_mul_f32 v77, v77, v201
v_mul_f32 v78, v78, v202
v_mul_f32 v79, v79, v203
v_mul_f32 v80, v80, v232
v_mul_f32 v81, v81, v233
v_mul_f32 v82, v82, v234
v_mul_f32 v83, v83, v235
v_exp_f32 v76, v76
v_exp_f32 v77, v77
v_exp_f32 v78, v78
v_exp_f32 v79, v79
v_exp_f32 v80, v80
v_exp_f32 v81, v81
v_exp_f32 v82, v82
s_add_u32 s38, s53, 5373952
s_add_u32 m0, s39, 147456
s_nop 0
buffer_load_dwordx4 v23, s[28:31], s38 offen lds
v_exp_f32 v83, v83
v_fma_f32 v216, -v64, v56, v216
v_fma_f32 v217, -v64, v57, v217
v_fma_f32 v218, -v64, v58, v218
v_fma_f32 v219, -v64, v59, v219
v_fma_f32 v248, -v66, v56, v248
v_fma_f32 v249, -v66, v57, v249
v_fma_f32 v250, -v66, v58, v250
v_fma_f32 v251, -v66, v59, v251
v_fma_f32 v76, v76, v70, v70
v_fma_f32 v77, v77, v70, v70
v_fma_f32 v78, v78, v70, v70
v_fma_f32 v79, v79, v70, v70
v_fma_f32 v80, v80, v74, v74
v_fma_f32 v81, v81, v74, v74
v_fma_f32 v82, v82, v74, v74
v_fma_f32 v83, v83, v74, v74
v_rcp_f32 v76, v76
v_rcp_f32 v77, v77
v_rcp_f32 v78, v78
v_rcp_f32 v79, v79
v_rcp_f32 v80, v80
v_rcp_f32 v81, v81
s_add_u32 m0, s39, 148480
s_nop 0
buffer_load_dwordx4 v24, s[28:31], s38 offen lds
v_rcp_f32 v82, v82
v_rcp_f32 v83, v83
v_mul_f32 v216, v200, v216
v_mul_f32 v217, v201, v217
v_mul_f32 v218, v202, v218
v_mul_f32 v219, v203, v219
v_mul_f32 v248, v232, v248
v_mul_f32 v249, v233, v249
v_mul_f32 v250, v234, v250
v_mul_f32 v251, v235, v251
v_mul_f32 v216, v216, v76
v_mul_f32 v217, v217, v77
v_mul_f32 v218, v218, v78
v_mul_f32 v219, v219, v79
v_mul_f32 v248, v248, v80
v_mul_f32 v249, v249, v81
v_mul_f32 v250, v250, v82
v_mul_f32 v251, v251, v83
v_cvt_pk_bf16_f32 v198, v216, v217
v_cvt_pk_bf16_f32 v199, v218, v219
v_cvt_pk_bf16_f32 v230, v248, v249
v_cvt_pk_bf16_f32 v231, v250, v251
buffer_store_dwordx4 v[196:199], v2, s[24:27], s55 offen offset:2048 sc1
buffer_store_dwordx4 v[228:231], v2, s[24:27], s55 offen offset:3072 sc1
s_add_u32 m0, s39, 149504
s_add_u32 s38, s38, 16384
buffer_load_dwordx4 v23, s[28:31], s38 offen lds
s_add_u32 m0, s39, 150528
s_nop 0
buffer_load_dwordx4 v24, s[28:31], s38 offen lds
s_waitcnt vmcnt(30)
s_barrier
s_add_u32 s37, s52, 688128
s_add_u32 m0, s39, 98304
s_nop 0
buffer_load_dwordx4 v3, s[24:27], s37 offen sc1 lds
buffer_load_dwordx4 v3, s[24:27], s37 offen offset:1024 sc1 lds
buffer_load_dwordx4 v3, s[24:27], s37 offen offset:2048 sc1 lds
buffer_load_dwordx4 v3, s[24:27], s37 offen offset:3072 sc1 lds
s_add_u32 s38, s53, 5505024
s_add_u32 m0, s39, 114688
s_nop 0
buffer_load_dwordx4 v23, s[28:31], s38 offen lds
s_add_u32 m0, s39, 115712
s_nop 0
buffer_load_dwordx4 v24, s[28:31], s38 offen lds
s_add_u32 m0, s39, 116736
s_add_u32 s38, s38, 16384
buffer_load_dwordx4 v23, s[28:31], s38 offen lds
s_add_u32 m0, s39, 117760
s_nop 0
buffer_load_dwordx4 v24, s[28:31], s38 offen lds
s_waitcnt vmcnt(10)
s_barrier
s_cmp_eq_u32 s47, 0
s_cbranch_scc0 Lw_133
s_add_u32 s7, s34, 48
s_lshl_b32 s7, s7, 7
v_mov_b32 v26, s7
v_mov_b32 v27, 1
s_mov_b64 exec, 1
buffer_atomic_add v27, v26, s[56:59], 0 offen sc1
s_mov_b64 exec, -1
Lw_133:
s_add_u32 s37, s52, 704512
s_add_u32 m0, s39, 131072
s_nop 0
buffer_load_dwordx4 v3, s[24:27], s37 offen sc1 lds
buffer_load_dwordx4 v3, s[24:27], s37 offen offset:1024 sc1 lds
buffer_load_dwordx4 v3, s[24:27], s37 offen offset:2048 sc1 lds
buffer_load_dwordx4 v3, s[24:27], s37 offen offset:3072 sc1 lds
s_add_u32 s38, s53, 5636096
s_add_u32 m0, s39, 0
s_nop 0
buffer_load_dwordx4 v23, s[28:31], s38 offen lds
s_add_u32 m0, s39, 1024
s_nop 0
buffer_load_dwordx4 v24, s[28:31], s38 offen lds
s_add_u32 m0, s39, 2048
s_add_u32 s38, s38, 16384
buffer_load_dwordx4 v23, s[28:31], s38 offen lds
s_add_u32 m0, s39, 3072
s_nop 0
buffer_load_dwordx4 v24, s[28:31], s38 offen lds
s_waitcnt vmcnt(26)
s_barrier
s_add_u32 s38, s91, 0
s_add_u32 m0, s39, 32768
s_nop 0
buffer_load_dwordx4 v23, s[28:31], s38 offen lds
s_add_u32 m0, s39, 33792
s_nop 0
buffer_load_dwordx4 v24, s[28:31], s38 offen lds
s_add_u32 m0, s39, 34816
s_add_u32 s38, s38, 16384
buffer_load_dwordx4 v23, s[28:31], s38 offen lds
s_add_u32 m0, s39, 35840
s_nop 0
buffer_load_dwordx4 v24, s[28:31], s38 offen lds
s_waitcnt vmcnt(20)
s_barrier
s_add_u32 s38, s91, 131072
s_add_u32 m0, s39, 65536
s_nop 0
buffer_load_dwordx4 v23, s[28:31], s38 offen lds
s_add_u32 m0, s39, 66560
s_nop 0
buffer_load_dwordx4 v24, s[28:31], s38 offen lds
s_add_u32 m0, s39, 67584
s_add_u32 s38, s38, 16384
buffer_load_dwordx4 v23, s[28:31], s38 offen lds
s_add_u32 m0, s39, 68608
s_nop 0
buffer_load_dwordx4 v24, s[28:31], s38 offen lds
s_waitcnt vmcnt(16)
s_barrier
s_cmp_eq_u32 s47, 3
s_cbranch_scc0 Lw_134
s_lshl_b32 s92, s34, 7
s_add_u32 s92, s92, 28317696
s_load_dword s93, s[82:83], s92 glc
Lw_134:
s_add_u32 s38, s91, 262144
s_add_u32 m0, s39, 147456
s_nop 0
buffer_load_dwordx4 v23, s[28:31], s38 offen lds
s_add_u32 m0, s39, 148480
s_nop 0
buffer_load_dwordx4 v24, s[28:31], s38 offen lds
s_add_u32 m0, s39, 149504
s_add_u32 s38, s38, 16384
buffer_load_dwordx4 v23, s[28:31], s38 offen lds
s_add_u32 m0, s39, 150528
s_nop 0
buffer_load_dwordx4 v24, s[28:31], s38 offen lds
s_waitcnt vmcnt(12)
s_cmp_eq_u32 s47, 3
s_cbranch_scc0 Lw_135
s_mov_b32 s41, 0x40000
s_branch Lpchk_138
Lpoll_136:
s_load_dword s93, s[82:83], s92 glc
Lpchk_138:
s_waitcnt lgkmcnt(0)
s_cmp_eq_u32 s93, 16
s_cbranch_scc1 Lpok_137
s_sub_u32 s41, s41, 1
s_cmp_lg_u32 s41, 0
s_cbranch_scc1 Lpoll_136
Lpok_137:
Lw_135:
s_barrier
s_add_u32 s37, s90, 0
s_add_u32 m0, s39, 16384
s_nop 0
buffer_load_dwordx4 v3, s[24:27], s37 offen sc1 lds
buffer_load_dwordx4 v3, s[24:27], s37 offen offset:1024 sc1 lds
buffer_load_dwordx4 v3, s[24:27], s37 offen offset:2048 sc1 lds
buffer_load_dwordx4 v3, s[24:27], s37 offen offset:3072 sc1 lds
s_add_u32 s37, s90, 16384
s_add_u32 m0, s39, 49152
s_nop 0
buffer_load_dwordx4 v3, s[24:27], s37 offen sc1 lds
buffer_load_dwordx4 v3, s[24:27], s37 offen offset:1024 sc1 lds
buffer_load_dwordx4 v3, s[24:27], s37 offen offset:2048 sc1 lds
buffer_load_dwordx4 v3, s[24:27], s37 offen offset:3072 sc1 lds
s_add_u32 s37, s90, 32768
s_add_u32 m0, s39, 81920
s_nop 0
buffer_load_dwordx4 v3, s[24:27], s37 offen sc1 lds
buffer_load_dwordx4 v3, s[24:27], s37 offen offset:1024 sc1 lds
buffer_load_dwordx4 v3, s[24:27], s37 offen offset:2048 sc1 lds
buffer_load_dwordx4 v3, s[24:27], s37 offen offset:3072 sc1 lds
s_add_u32 s37, s90, 49152
s_add_u32 m0, s39, 98304
s_nop 0
buffer_load_dwordx4 v3, s[24:27], s37 offen sc1 lds
buffer_load_dwordx4 v3, s[24:27], s37 offen offset:1024 sc1 lds
buffer_load_dwordx4 v3, s[24:27], s37 offen offset:2048 sc1 lds
buffer_load_dwordx4 v3, s[24:27], s37 offen offset:3072 sc1 lds
s_add_u32 s38, s91, 393216
s_add_u32 m0, s39, 114688
s_nop 0
buffer_load_dwordx4 v23, s[28:31], s38 offen lds
s_add_u32 m0, s39, 115712
s_nop 0
buffer_load_dwordx4 v24, s[28:31], s38 offen lds
s_add_u32 m0, s39, 116736
s_add_u32 s38, s38, 16384
buffer_load_dwordx4 v23, s[28:31], s38 offen lds
s_add_u32 m0, s39, 117760
s_nop 0
buffer_load_dwordx4 v24, s[28:31], s38 offen lds
s_waitcnt vmcnt(16)
s_barrier
s_add_u32 s37, s90, 65536
s_add_u32 m0, s39, 131072
s_nop 0
buffer_load_dwordx4 v3, s[24:27], s37 offen sc1 lds
buffer_load_dwordx4 v3, s[24:27], s37 offen offset:1024 sc1 lds
buffer_load_dwordx4 v3, s[24:27], s37 offen offset:2048 sc1 lds
buffer_load_dwordx4 v3, s[24:27], s37 offen offset:3072 sc1 lds
s_add_u32 s38, s91, 524288
s_add_u32 m0, s39, 0
s_nop 0
buffer_load_dwordx4 v23, s[28:31], s38 offen lds
s_add_u32 m0, s39, 1024
s_nop 0
buffer_load_dwordx4 v24, s[28:31], s38 offen lds
s_add_u32 m0, s39, 2048
s_add_u32 s38, s38, 16384
buffer_load_dwordx4 v23, s[28:31], s38 offen lds
s_add_u32 m0, s39, 3072
s_nop 0
buffer_load_dwordx4 v24, s[28:31], s38 offen lds
s_waitcnt vmcnt(20)
s_barrier
s_add_u32 s37, s90, 81920
s_add_u32 m0, s39, 16384
s_nop 0
buffer_load_dwordx4 v3, s[24:27], s37 offen sc1 lds
buffer_load_dwordx4 v3, s[24:27], s37 offen offset:1024 sc1 lds
buffer_load_dwordx4 v3, s[24:27], s37 offen offset:2048 sc1 lds
buffer_load_dwordx4 v3, s[24:27], s37 offen offset:3072 sc1 lds
s_add_u32 s38, s91, 655360
s_add_u32 m0, s39, 32768
s_nop 0
buffer_load_dwordx4 v23, s[28:31], s38 offen lds
s_add_u32 m0, s39, 33792
s_nop 0
buffer_load_dwordx4 v24, s[28:31], s38 offen lds
s_add_u32 m0, s39, 34816
s_add_u32 s38, s38, 16384
buffer_load_dwordx4 v23, s[28:31], s38 offen lds
s_add_u32 m0, s39, 35840
s_nop 0
buffer_load_dwordx4 v24, s[28:31], s38 offen lds
s_waitcnt vmcnt(24)
s_barrier
s_add_u32 s37, s90, 98304
s_add_u32 m0, s39, 49152
s_nop 0
buffer_load_dwordx4 v3, s[24:27], s37 offen sc1 lds
buffer_load_dwordx4 v3, s[24:27], s37 offen offset:1024 sc1 lds
buffer_load_dwordx4 v3, s[24:27], s37 offen offset:2048 sc1 lds
buffer_load_dwordx4 v3, s[24:27], s37 offen offset:3072 sc1 lds
s_add_u32 s38, s91, 786432
s_add_u32 m0, s39, 65536
s_nop 0
buffer_load_dwordx4 v23, s[28:31], s38 offen lds
s_add_u32 m0, s39, 66560
s_nop 0
buffer_load_dwordx4 v24, s[28:31], s38 offen lds
s_add_u32 m0, s39, 67584
s_add_u32 s38, s38, 16384
buffer_load_dwordx4 v23, s[28:31], s38 offen lds
s_add_u32 m0, s39, 68608
s_nop 0
buffer_load_dwordx4 v24, s[28:31], s38 offen lds
s_waitcnt vmcnt(24)
s_barrier
s_add_u32 s37, s90, 114688
s_add_u32 m0, s39, 81920
s_nop 0
buffer_load_dwordx4 v3, s[24:27], s37 offen sc1 lds
buffer_load_dwordx4 v3, s[24:27], s37 offen offset:1024 sc1 lds
buffer_load_dwordx4 v3, s[24:27], s37 offen offset:2048 sc1 lds
buffer_load_dwordx4 v3, s[24:27], s37 offen offset:3072 sc1 lds
s_add_u32 s38, s91, 917504
s_add_u32 m0, s39, 147456
s_nop 0
buffer_load_dwordx4 v23, s[28:31], s38 offen lds
s_add_u32 m0, s39, 148480
s_nop 0
buffer_load_dwordx4 v24, s[28:31], s38 offen lds
s_add_u32 m0, s39, 149504
s_add_u32 s38, s38, 16384
buffer_load_dwordx4 v23, s[28:31], s38 offen lds
s_add_u32 m0, s39, 150528
s_nop 0
buffer_load_dwordx4 v24, s[28:31], s38 offen lds
s_waitcnt vmcnt(24)
s_barrier
s_add_u32 s37, s90, 131072
s_add_u32 m0, s39, 98304
s_nop 0
buffer_load_dwordx4 v3, s[24:27], s37 offen sc1 lds
buffer_load_dwordx4 v3, s[24:27], s37 offen offset:1024 sc1 lds
buffer_load_dwordx4 v3, s[24:27], s37 offen offset:2048 sc1 lds
buffer_load_dwordx4 v3, s[24:27], s37 offen offset:3072 sc1 lds
s_add_u32 s38, s91, 1048576
s_add_u32 m0, s39, 114688
s_nop 0
buffer_load_dwordx4 v23, s[28:31], s38 offen lds
s_add_u32 m0, s39, 115712
s_nop 0
buffer_load_dwordx4 v24, s[28:31], s38 offen lds
s_add_u32 m0, s39, 116736
s_add_u32 s38, s38, 16384
buffer_load_dwordx4 v23, s[28:31], s38 offen lds
s_add_u32 m0, s39, 117760
s_nop 0
buffer_load_dwordx4 v24, s[28:31], s38 offen lds
s_waitcnt vmcnt(24)
s_barrier
s_add_u32 s37, s90, 147456
s_add_u32 m0, s39, 131072
s_nop 0
buffer_load_dwordx4 v3, s[24:27], s37 offen sc1 lds
buffer_load_dwordx4 v3, s[24:27], s37 offen offset:1024 sc1 lds
buffer_load_dwordx4 v3, s[24:27], s37 offen offset:2048 sc1 lds
buffer_load_dwordx4 v3, s[24:27], s37 offen offset:3072 sc1 lds
s_add_u32 s38, s91, 1179648
s_add_u32 m0, s39, 0
s_nop 0
buffer_load_dwordx4 v23, s[28:31], s38 offen lds
s_add_u32 m0, s39, 1024
s_nop 0
buffer_load_dwordx4 v24, s[28:31], s38 offen lds
s_add_u32 m0, s39, 2048
s_add_u32 s38, s38, 16384
buffer_load_dwordx4 v23, s[28:31], s38 offen lds
s_add_u32 m0, s39, 3072
s_nop 0
buffer_load_dwordx4 v24, s[28:31], s38 offen lds
s_waitcnt vmcnt(24)
s_barrier
s_mov_b32 s37, 327680
s_add_u32 m0, s39, 16384
s_nop 0
buffer_load_dwordx4 v3, s[24:27], s37 offen sc1 lds
buffer_load_dwordx4 v3, s[24:27], s37 offen offset:1024 sc1 lds
buffer_load_dwordx4 v3, s[24:27], s37 offen offset:2048 sc1 lds
buffer_load_dwordx4 v3, s[24:27], s37 offen offset:3072 sc1 lds
s_mov_b32 s38, 2621440
s_add_u32 m0, s51, 32768
s_nop 0
buffer_load_dwordx4 v25, s[28:31], s38 offen lds
s_add_u32 m0, s51, 33792
s_add_u32 s38, s38, 16384
buffer_load_dwordx4 v25, s[28:31], s38 offen lds
s_waitcnt vmcnt(22)
s_barrier
s_mov_b32 s37, 344064
s_add_u32 m0, s39, 49152
s_nop 0
buffer_load_dwordx4 v3, s[24:27], s37 offen sc1 lds
buffer_load_dwordx4 v3, s[24:27], s37 offen offset:1024 sc1 lds
buffer_load_dwordx4 v3, s[24:27], s37 offen offset:2048 sc1 lds
buffer_load_dwordx4 v3, s[24:27], s37 offen offset:3072 sc1 lds
s_mov_b32 s38, 2752512
s_add_u32 m0, s51, 65536
s_nop 0
buffer_load_dwordx4 v25, s[28:31], s38 offen lds
s_add_u32 m0, s51, 66560
s_add_u32 s38, s38, 16384
buffer_load_dwordx4 v25, s[28:31], s38 offen lds
s_waitcnt vmcnt(20)
s_barrier
s_mov_b32 s37, 360448
s_add_u32 m0, s39, 81920
s_nop 0
buffer_load_dwordx4 v3, s[24:27], s37 offen sc1 lds
buffer_load_dwordx4 v3, s[24:27], s37 offen offset:1024 sc1 lds
buffer_load_dwordx4 v3, s[24:27], s37 offen offset:2048 sc1 lds
buffer_load_dwordx4 v3, s[24:27], s37 offen offset:3072 sc1 lds
s_mov_b32 s38, 2883584
s_add_u32 m0, s51, 147456
s_nop 0
buffer_load_dwordx4 v25, s[28:31], s38 offen lds
s_add_u32 m0, s51, 148480
s_add_u32 s38, s38, 16384
buffer_load_dwordx4 v25, s[28:31], s38 offen lds
s_waitcnt vmcnt(18)
s_barrier
s_mov_b32 s37, 376832
s_add_u32 m0, s39, 98304
s_nop 0
buffer_load_dwordx4 v3, s[24:27], s37 offen sc1 lds
buffer_load_dwordx4 v3, s[24:27], s37 offen offset:1024 sc1 lds
buffer_load_dwordx4 v3, s[24:27], s37 offen offset:2048 sc1 lds
buffer_load_dwordx4 v3, s[24:27], s37 offen offset:3072 sc1 lds
s_mov_b32 s38, 3014656
s_add_u32 m0, s51, 114688
s_nop 0
buffer_load_dwordx4 v25, s[28:31], s38 offen lds
s_add_u32 m0, s51, 115712
s_add_u32 s38, s38, 16384
buffer_load_dwordx4 v25, s[28:31], s38 offen lds
s_waitcnt vmcnt(18)
s_barrier
s_mov_b32 s37, 393216
s_add_u32 m0, s39, 131072
s_nop 0
buffer_load_dwordx4 v3, s[24:27], s37 offen sc1 lds
buffer_load_dwordx4 v3, s[24:27], s37 offen offset:1024 sc1 lds
buffer_load_dwordx4 v3, s[24:27], s37 offen offset:2048 sc1 lds
buffer_load_dwordx4 v3, s[24:27], s37 offen offset:3072 sc1 lds
s_mov_b32 s38, 3145728
s_add_u32 m0, s51, 0
s_nop 0
buffer_load_dwordx4 v25, s[28:31], s38 offen lds
s_add_u32 m0, s51, 1024
s_add_u32 s38, s38, 16384
buffer_load_dwordx4 v25, s[28:31], s38 offen lds
s_waitcnt vmcnt(18)
s_barrier
s_mov_b32 s37, 409600
s_add_u32 m0, s39, 16384
s_nop 0
buffer_load_dwordx4 v3, s[24:27], s37 offen sc1 lds
buffer_load_dwordx4 v3, s[24:27], s37 offen offset:1024 sc1 lds
buffer_load_dwordx4 v3, s[24:27], s37 offen offset:2048 sc1 lds
buffer_load_dwordx4 v3, s[24:27], s37 offen offset:3072 sc1 lds
s_mov_b32 s38, 3276800
s_add_u32 m0, s51, 32768
s_nop 0
buffer_load_dwordx4 v25, s[28:31], s38 offen lds
s_add_u32 m0, s51, 33792
s_add_u32 s38, s38, 16384
buffer_load_dwordx4 v25, s[28:31], s38 offen lds
s_waitcnt vmcnt(18)
s_barrier
s_mov_b32 s37, 425984
s_add_u32 m0, s39, 49152
s_nop 0
buffer_load_dwordx4 v3, s[24:27], s37 offen sc1 lds
buffer_load_dwordx4 v3, s[24:27], s37 offen offset:1024 sc1 lds
buffer_load_dwordx4 v3, s[24:27], s37 offen offset:2048 sc1 lds
buffer_load_dwordx4 v3, s[24:27], s37 offen offset:3072 sc1 lds
s_mov_b32 s38, 3407872
s_add_u32 m0, s51, 65536
s_nop 0
buffer_load_dwordx4 v25, s[28:31], s38 offen lds
s_add_u32 m0, s51, 66560
s_add_u32 s38, s38, 16384
buffer_load_dwordx4 v25, s[28:31], s38 offen lds
s_waitcnt vmcnt(18)
s_barrier
s_mov_b32 s37, 442368
s_add_u32 m0, s39, 81920
s_nop 0
buffer_load_dwordx4 v3, s[24:27], s37 offen sc1 lds
buffer_load_dwordx4 v3, s[24:27], s37 offen offset:1024 sc1 lds
buffer_load_dwordx4 v3, s[24:27], s37 offen offset:2048 sc1 lds
buffer_load_dwordx4 v3, s[24:27], s37 offen offset:3072 sc1 lds
s_mov_b32 s38, 3538944
s_add_u32 m0, s51, 147456
s_nop 0
buffer_load_dwordx4 v25, s[28:31], s38 offen lds
s_add_u32 m0, s51, 148480
s_branch Lov_18
.p2align 12
.fill 144, 4, 0xbf800000
Lst_18_0:
s_branch Lwr_159
Lst_18_1:
s_branch Lwr_171
s_nop 0
Lov_18:
s_add_u32 s38, s38, 16384
buffer_load_dwordx4 v25, s[28:31], s38 offen lds
s_waitcnt vmcnt(18)
s_barrier
s_mov_b32 s37, 458752
s_add_u32 m0, s39, 98304
s_nop 0
buffer_load_dwordx4 v3, s[24:27], s37 offen sc1 lds
buffer_load_dwordx4 v3, s[24:27], s37 offen offset:1024 sc1 lds
buffer_load_dwordx4 v3, s[24:27], s37 offen offset:2048 sc1 lds
buffer_load_dwordx4 v3, s[24:27], s37 offen offset:3072 sc1 lds
s_mov_b32 s38, 3670016
s_add_u32 m0, s51, 114688
s_nop 0
buffer_load_dwordx4 v25, s[28:31], s38 offen lds
s_add_u32 m0, s51, 115712
s_add_u32 s38, s38, 16384
buffer_load_dwordx4 v25, s[28:31], s38 offen lds
s_waitcnt vmcnt(18)
s_barrier
s_mov_b32 s37, 475136
s_add_u32 m0, s39, 131072
s_nop 0
buffer_load_dwordx4 v3, s[24:27], s37 offen sc1 lds
buffer_load_dwordx4 v3, s[24:27], s37 offen offset:1024 sc1 lds
buffer_load_dwordx4 v3, s[24:27], s37 offen offset:2048 sc1 lds
buffer_load_dwordx4 v3, s[24:27], s37 offen offset:3072 sc1 lds
s_mov_b32 s38, 3801088
s_add_u32 m0, s51, 0
s_nop 0
buffer_load_dwordx4 v25, s[28:31], s38 offen lds
s_add_u32 m0, s51, 1024
s_add_u32 s38, s38, 16384
buffer_load_dwordx4 v25, s[28:31], s38 offen lds
s_waitcnt vmcnt(18)
s_barrier
s_cmp_eq_u32 s47, 0
s_cbranch_scc0 Lw_139
s_xor_b32 s43, s2, 2
s_add_u32 s43, s43, 128
s_lshl_b32 s43, s43, 7
v_mov_b32 v26, s43
v_mov_b32 v27, 1
s_mov_b64 exec, 1
buffer_store_dword v27, v26, s[56:59], 0 offen sc1
s_mov_b64 exec, -1
Lw_139:
s_mov_b32 s37, 491520
s_add_u32 m0, s39, 16384
s_nop 0
buffer_load_dwordx4 v3, s[24:27], s37 offen sc1 lds
buffer_load_dwordx4 v3, s[24:27], s37 offen offset:1024 sc1 lds
buffer_load_dwordx4 v3, s[24:27], s37 offen offset:2048 sc1 lds
buffer_load_dwordx4 v3, s[24:27], s37 offen offset:3072 sc1 lds
s_mov_b32 s38, 3932160
s_add_u32 m0, s51, 32768
s_nop 0
buffer_load_dwordx4 v25, s[28:31], s38 offen lds
s_add_u32 m0, s51, 33792
s_add_u32 s38, s38, 16384
buffer_load_dwordx4 v25, s[28:31], s38 offen lds
s_waitcnt vmcnt(18)
s_barrier
s_mov_b32 s37, 507904
s_add_u32 m0, s39, 49152
s_nop 0
buffer_load_dwordx4 v3, s[24:27], s37 offen sc1 lds
buffer_load_dwordx4 v3, s[24:27], s37 offen offset:1024 sc1 lds
buffer_load_dwordx4 v3, s[24:27], s37 offen offset:2048 sc1 lds
buffer_load_dwordx4 v3, s[24:27], s37 offen offset:3072 sc1 lds
s_mov_b32 s38, 4063232
s_add_u32 m0, s51, 65536
s_nop 0
buffer_load_dwordx4 v25, s[28:31], s38 offen lds
s_add_u32 m0, s51, 66560
s_add_u32 s38, s38, 16384
buffer_load_dwordx4 v25, s[28:31], s38 offen lds
s_waitcnt vmcnt(18)
s_barrier
s_cmp_eq_u32 s47, 3
s_cbranch_scc0 Lw_140
s_lshl_b32 s92, s2, 7
s_add_u32 s92, s92, 28327936
s_load_dword s93, s[82:83], s92 glc
Lw_140:
s_waitcnt vmcnt(12)
s_cmp_eq_u32 s47, 3
s_cbranch_scc0 Lw_141
s_mov_b32 s41, 0x40000
s_branch Lpchk_144
Lpoll_142:
s_load_dword s93, s[82:83], s92 glc
Lpchk_144:
s_waitcnt lgkmcnt(0)
s_cmp_eq_u32 s93, 1
s_cbranch_scc1 Lpok_143
s_sub_u32 s41, s41, 1
s_cmp_lg_u32 s41, 0
s_cbranch_scc1 Lpoll_142
Lpok_143:
Lw_141:
s_barrier
s_waitcnt vmcnt(6)
s_barrier
s_waitcnt vmcnt(0)
s_barrier
s_barrier
s_branch Ldone_1
Ldone_1:
Lfin:
Lexit_2:
s_endpgm
.section .rodata,"a"
.p2align 6
.amdhsa_kernel sequential_preLN__sliding_local_dilated__glu_gated_geglu__prompt_kernel
  .amdhsa_next_free_vgpr 256
  .amdhsa_next_free_sgpr 100
  .amdhsa_accum_offset 256
  .amdhsa_group_segment_fixed_size 0
  .amdhsa_kernarg_size 80
  .amdhsa_user_sgpr_count 2
  .amdhsa_user_sgpr_kernarg_segment_ptr 1
  .amdhsa_system_sgpr_workgroup_id_x 1
  .amdhsa_float_denorm_mode_32 3
  .amdhsa_float_denorm_mode_16_64 3
.end_amdhsa_kernel
```

```asm
; @launch grid=(256,1,1) block=(512,1,1) lds=163840
.amdgcn_target "amdgcn-amd-amdhsa--gfx950"
.text
.globl sequential_preLN__sliding_local_dilated__glu_gated_geglu__prompt_kernel
.p2align 8
.type sequential_preLN__sliding_local_dilated__glu_gated_geglu__prompt_kernel,@function
sequential_preLN__sliding_local_dilated__glu_gated_geglu__prompt_kernel:
s_cmp_ge_u32 s2, 256
s_cbranch_scc1 Lexit_2
s_load_dwordx16 s[64:79], s[0:1], 0
s_load_dwordx4 s[80:83], s[0:1], 64
s_and_b32 s3, s2, 7
s_lshr_b32 s42, s2, 3
s_and_b32 s34, s3, 1
s_lshl_b32 s34, s34, 3
s_and_b32 s48, s42, 7
s_add_u32 s34, s34, s48
s_lshr_b32 s35, s3, 1
s_lshr_b32 s49, s42, 3
s_lshl_b32 s35, s35, 2
s_add_u32 s35, s35, s49
v_lshrrev_b32 v12, 6, v0
v_and_b32 v1, 63, v0
v_readfirstlane_b32 s36, v12
Lbeg:
s_lshl_b32 s50, s34, 7
s_sub_u32 s50, s50, 16
v_and_b32 v12, 15, v1
v_lshrrev_b32 v13, 4, v1
s_cmp_lt_u32 s36, 4
s_cbranch_scc1 Lcons_7
Lprod_3:
s_sub_u32 s47, s36, 4
s_lshl_b32 s43, s34, 7
s_lshl_b32 s44, s35, 3
s_add_u32 s63, s43, s44
s_lshl_b32 s44, s47, 1
s_add_u32 s51, s63, s44
v_lshlrev_b32 v10, 4, v1
s_and_b32 s43, s2, 7
s_lshr_b32 s44, s43, 2
s_lshl_b32 s44, s44, 1
s_and_b32 s45, s43, 1
s_add_u32 s44, s44, s45
s_lshr_b32 s45, s2, 3
s_lshl_b32 s45, s45, 2
s_add_u32 s44, s44, s45
s_add_u32 s44, s44, 96
s_bitcmp1_b32 s43, 1
s_cselect_b32 s44, s44, 0x10000
s_cmp_lt_u32 s2, 192
s_cselect_b32 s33, s2, s44
v_lshrrev_b32 v14, 3, v1
v_and_b32 v15, 7, v1
v_lshl_add_u32 v19, v14, 6, v15
s_lshl_b32 s43, s48, 3
v_add_u32 v19, s43, v19
v_mul_u32_u24 v19, 6144, v19
s_cmp_eq_u32 s47, 3
s_cbranch_scc1 Lpf_4
v_and_b32 v16, 2, v14
v_xor_b32 v16, v15, v16
v_lshlrev_b32 v16, 4, v16
v_mul_u32_u24 v17, 6144, v14
s_lshl_b32 s43, s47, 11
v_add3_u32 v2, v17, v16, s43
v_xor_b32 v3, 64, v2
v_lshrrev_b32 v16, 1, v14
v_xor_b32 v16, v15, v16
v_lshlrev_b32 v16, 4, v16
s_lshl_b32 s43, s47, 3
s_add_u32 s43, s43, s50
v_add_u32 v17, s43, v14
s_and_b32 s44, s47, 1
s_lshl_b32 s44, s44, 6
v_add_u32 v18, 0, v17
v_max_i32 v18, 0, v18
v_lshl_add_u32 v18, v18, 11, v16
v_xor_b32 v18, s44, v18
v_mov_b32 v4, v18
v_add_u32 v18, 24, v17
v_max_i32 v18, 0, v18
v_lshl_add_u32 v18, v18, 11, v16
v_xor_b32 v18, s44, v18
v_xor_b32 v5, 64, v18
v_add_u32 v18, 48, v17
v_max_i32 v18, 0, v18
v_lshl_add_u32 v18, v18, 11, v16
v_xor_b32 v18, s44, v18
v_mov_b32 v6, v18
v_add_u32 v18, 72, v17
v_max_i32 v18, 0, v18
v_lshl_add_u32 v18, v18, 11, v16
v_xor_b32 v18, s44, v18
v_xor_b32 v7, 64, v18
v_add_u32 v18, 96, v17
v_max_i32 v18, 0, v18
v_lshl_add_u32 v18, v18, 11, v16
v_xor_b32 v18, s44, v18
v_mov_b32 v8, v18
v_add_u32 v18, 120, v17
v_max_i32 v18, 0, v18
v_lshl_add_u32 v18, v18, 11, v16
v_xor_b32 v18, s44, v18
v_xor_b32 v9, 64, v18
s_lshl_b32 s39, s47, 10
s_lshl_b32 s40, s47, 13
s_add_u32 s40, s40, 18432
s_mov_b32 s37, 0
s_mov_b32 s38, 0
s_bfm_b64 s[60:61], 56, 8
s_cmp_eq_u32 s47, 0
s_cselect_b64 s[60:61], s[60:61], -1
s_lshl_b32 s43, s35, 7
s_waitcnt lgkmcnt(0)
s_mov_b32 s8, s64
s_mov_b32 s9, s65
s_mov_b32 s10, 4194304
s_mov_b32 s11, 0x20000
s_add_u32 s12, s66, s43
s_addc_u32 s13, s67, 0
s_mov_b32 s14, 6289536
s_mov_b32 s15, 0x20000
s_mov_b32 s28, s66
s_mov_b32 s29, s67
s_mov_b32 s30, 6291456
s_mov_b32 s31, 0x20000
s_mul_i32 s43, s33, 5376
v_lshlrev_b32 v30, 7, v1
s_mul_i32 s44, s47, 1792
s_add_u32 s43, s43, s44
s_bfm_b64 exec, 14, 0
buffer_load_dword v31, v30, s[28:31], s43 offen
s_mov_b64 exec, -1
s_add_u32 m0, s39, 0
s_mov_b64 exec, s[60:61]
buffer_load_dwordx4 v4, s[8:11], s37 offen lds
s_mov_b64 exec, -1
s_add_u32 m0, s39, 3072
s_nop 0
buffer_load_dwordx4 v5, s[8:11], s37 offen lds
s_add_u32 m0, s39, 6144
s_nop 0
buffer_load_dwordx4 v6, s[8:11], s37 offen lds
s_add_u32 m0, s39, 9216
s_nop 0
buffer_load_dwordx4 v7, s[8:11], s37 offen lds
s_add_u32 m0, s39, 12288
s_nop 0
buffer_load_dwordx4 v8, s[8:11], s37 offen lds
s_add_u32 m0, s39, 15360
s_nop 0
buffer_load_dwordx4 v9, s[8:11], s37 offen lds
s_add_u32 m0, s40, 0
s_add_u32 s43, s38, 0
buffer_load_dwordx4 v2, s[12:15], s43 offen lds
s_add_u32 m0, s40, 1024
s_add_u32 s43, s38, 49152
buffer_load_dwordx4 v3, s[12:15], s43 offen lds
s_add_u32 m0, s40, 2048
s_add_u32 s43, s38, 98304
buffer_load_dwordx4 v2, s[12:15], s43 offen lds
s_add_u32 m0, s40, 3072
s_add_u32 s43, s38, 147456
buffer_load_dwordx4 v3, s[12:15], s43 offen lds
s_add_u32 m0, s40, 4096
s_add_u32 s43, s38, 196608
buffer_load_dwordx4 v2, s[12:15], s43 offen lds
s_add_u32 m0, s40, 5120
s_add_u32 s43, s38, 245760
buffer_load_dwordx4 v3, s[12:15], s43 offen lds
s_add_u32 m0, s40, 6144
s_add_u32 s43, s38, 294912
buffer_load_dwordx4 v2, s[12:15], s43 offen lds
s_add_u32 m0, s40, 7168
s_add_u32 s43, s38, 344064
buffer_load_dwordx4 v3, s[12:15], s43 offen lds
s_add_u32 s37, s37, 128
s_add_u32 s38, s38, 393216
s_lshl_b32 s43, s51, 11
buffer_load_dwordx4 v[96:99], v10, s[8:11], s43 offen offset:0
buffer_load_dwordx4 v[100:103], v10, s[8:11], s43 offen offset:1024
buffer_load_dwordx4 v[104:107], v10, s[8:11], s43 offen offset:2048
buffer_load_dwordx4 v[108:111], v10, s[8:11], s43 offen offset:3072
s_add_u32 m0, s39, 43008
s_mov_b64 exec, s[60:61]
buffer_load_dwordx4 v4, s[8:11], s37 offen lds
s_mov_b64 exec, -1
s_add_u32 m0, s39, 46080
s_nop 0
buffer_load_dwordx4 v5, s[8:11], s37 offen lds
s_add_u32 m0, s39, 49152
s_nop 0
buffer_load_dwordx4 v6, s[8:11], s37 offen lds
s_add_u32 m0, s39, 52224
s_nop 0
buffer_load_dwordx4 v7, s[8:11], s37 offen lds
s_add_u32 m0, s39, 55296
s_nop 0
buffer_load_dwordx4 v8, s[8:11], s37 offen lds
s_add_u32 m0, s39, 58368
s_nop 0
buffer_load_dwordx4 v9, s[8:11], s37 offen lds
s_add_u32 m0, s40, 43008
s_add_u32 s43, s38, 0
buffer_load_dwordx4 v2, s[12:15], s43 offen lds
s_add_u32 m0, s40, 44032
s_add_u32 s43, s38, 49152
buffer_load_dwordx4 v3, s[12:15], s43 offen lds
s_add_u32 m0, s40, 45056
s_add_u32 s43, s38, 98304
buffer_load_dwordx4 v2, s[12:15], s43 offen lds
s_add_u32 m0, s40, 46080
s_add_u32 s43, s38, 147456
buffer_load_dwordx4 v3, s[12:15], s43 offen lds
s_add_u32 m0, s40, 47104
s_add_u32 s43, s38, 196608
buffer_load_dwordx4 v2, s[12:15], s43 offen lds
s_add_u32 m0, s40, 48128
s_add_u32 s43, s38, 245760
buffer_load_dwordx4 v3, s[12:15], s43 offen lds
s_add_u32 m0, s40, 49152
s_add_u32 s43, s38, 294912
buffer_load_dwordx4 v2, s[12:15], s43 offen lds
s_add_u32 m0, s40, 50176
s_add_u32 s43, s38, 344064
buffer_load_dwordx4 v3, s[12:15], s43 offen lds
s_add_u32 s37, s37, 128
s_add_u32 s38, s38, 393216
s_waitcnt vmcnt(18)
s_barrier
s_add_u32 m0, s39, 86016
s_mov_b64 exec, s[60:61]
buffer_load_dwordx4 v4, s[8:11], s37 offen lds
s_mov_b64 exec, -1
s_add_u32 m0, s39, 89088
s_nop 0
buffer_load_dwordx4 v5, s[8:11], s37 offen lds
s_add_u32 m0, s39, 92160
s_nop 0
buffer_load_dwordx4 v6, s[8:11], s37 offen lds
s_add_u32 m0, s39, 95232
s_nop 0
buffer_load_dwordx4 v7, s[8:11], s37 offen lds
s_add_u32 m0, s39, 98304
s_nop 0
buffer_load_dwordx4 v8, s[8:11], s37 offen lds
s_add_u32 m0, s39, 101376
s_nop 0
buffer_load_dwordx4 v9, s[8:11], s37 offen lds
s_add_u32 m0, s40, 86016
s_add_u32 s43, s38, 0
buffer_load_dwordx4 v2, s[12:15], s43 offen lds
s_add_u32 m0, s40, 87040
s_add_u32 s43, s38, 49152
buffer_load_dwordx4 v3, s[12:15], s43 offen lds
s_add_u32 m0, s40, 88064
s_add_u32 s43, s38, 98304
buffer_load_dwordx4 v2, s[12:15], s43 offen lds
s_add_u32 m0, s40, 89088
s_add_u32 s43, s38, 147456
buffer_load_dwordx4 v3, s[12:15], s43 offen lds
s_add_u32 m0, s40, 90112
s_add_u32 s43, s38, 196608
buffer_load_dwordx4 v2, s[12:15], s43 offen lds
s_add_u32 m0, s40, 91136
s_add_u32 s43, s38, 245760
buffer_load_dwordx4 v3, s[12:15], s43 offen lds
s_add_u32 m0, s40, 92160
s_add_u32 s43, s38, 294912
buffer_load_dwordx4 v2, s[12:15], s43 offen lds
s_add_u32 m0, s40, 93184
s_add_u32 s43, s38, 344064
buffer_load_dwordx4 v3, s[12:15], s43 offen lds
s_add_u32 s37, s37, 128
s_add_u32 s38, s38, 393216
s_waitcnt vmcnt(28)
s_mov_b32 s43, 0x3f803f80
v_mov_b32 v116, 0
v_mov_b32 v117, 0
v_mov_b32 v118, 0
v_mov_b32 v119, 0
v_mov_b32 v120, 0
v_mov_b32 v121, 0
v_mov_b32 v122, 0
v_mov_b32 v123, 0
v_dot2_f32_bf16 v116, v96, s43, v116
v_dot2_f32_bf16 v120, v96, v96, v120
v_dot2_f32_bf16 v118, v104, s43, v118
v_dot2_f32_bf16 v122, v104, v104, v122
v_dot2_f32_bf16 v117, v97, s43, v117
v_dot2_f32_bf16 v121, v97, v97, v121
v_dot2_f32_bf16 v119, v105, s43, v119
v_dot2_f32_bf16 v123, v105, v105, v123
v_dot2_f32_bf16 v116, v98, s43, v116
v_dot2_f32_bf16 v120, v98, v98, v120
v_dot2_f32_bf16 v118, v106, s43, v118
v_dot2_f32_bf16 v122, v106, v106, v122
v_dot2_f32_bf16 v117, v99, s43, v117
v_dot2_f32_bf16 v121, v99, v99, v121
v_dot2_f32_bf16 v119, v107, s43, v119
v_dot2_f32_bf16 v123, v107, v107, v123
v_dot2_f32_bf16 v116, v100, s43, v116
v_dot2_f32_bf16 v120, v100, v100, v120
v_dot2_f32_bf16 v118, v108, s43, v118
v_dot2_f32_bf16 v122, v108, v108, v122
v_dot2_f32_bf16 v117, v101, s43, v117
v_dot2_f32_bf16 v121, v101, v101, v121
v_dot2_f32_bf16 v119, v109, s43, v119
v_dot2_f32_bf16 v123, v109, v109, v123
v_dot2_f32_bf16 v116, v102, s43, v116
v_dot2_f32_bf16 v120, v102, v102, v120
v_dot2_f32_bf16 v118, v110, s43, v118
v_dot2_f32_bf16 v122, v110, v110, v122
v_dot2_f32_bf16 v117, v103, s43, v117
v_dot2_f32_bf16 v121, v103, v103, v121
v_dot2_f32_bf16 v119, v111, s43, v119
v_dot2_f32_bf16 v123, v111, v111, v123
s_nop 2
v_add_f32 v116, v116, v117
v_add_f32 v118, v118, v119
v_add_f32 v120, v120, v121
v_add_f32 v122, v122, v123
s_nop 1
v_permlane32_swap_b32 v116, v118
v_permlane32_swap_b32 v120, v122
v_add_f32 v116, v116, v118
v_add_f32 v120, v120, v122
s_nop 1
v_permlane16_swap_b32 v116, v120
v_add_f32 v116, v116, v120
s_nop 1
v_add_f32_dpp v116, v116, v116 row_ror:8 row_mask:0xf bank_mask:0xf
s_nop 1
v_add_f32_dpp v116, v116, v116 row_ror:4 row_mask:0xf bank_mask:0xf
s_nop 1
v_add_f32_dpp v116, v116, v116 row_ror:2 row_mask:0xf bank_mask:0xf
s_nop 1
v_add_f32_dpp v116, v116, v116 row_ror:1 row_mask:0xf bank_mask:0xf
v_mov_b32 v117, v116
s_nop 1
v_permlane16_swap_b32 v116, v117
v_mul_f32 v112, 0x3a800000, v116
v_mul_f32 v113, 0x3a800000, v117
v_fma_f32 v113, -v112, v112, v113
v_max_f32 v113, 0, v113
v_add_f32 v113, 0x3727c5ac, v113
v_rsq_f32 v113, v113
v_lshrrev_b32 v11, 5, v1
s_lshl_b32 s43, s47, 4
s_add_u32 s43, s43, 148608
v_lshl_add_u32 v11, v11, 3, s43
ds_write_b64 v11, v[112:113]
s_waitcnt lgkmcnt(0)
s_and_b32 s44, s36, 3
s_mul_i32 s44, s44, 28
s_bfe_u32 s43, s2, 0x30001
s_lshl_b32 s43, s43, 7
s_add_u32 s44, s44, s43
s_mul_i32 s44, s44, 7168
s_lshr_b32 s43, s2, 4
s_lshl_b32 s43, s43, 8
s_add_u32 s43, s43, s44
s_bitcmp0_b32 s2, 0
s_cselect_b32 s4, s72, s74
s_cselect_b32 s5, s73, s75
s_add_u32 s4, s4, s43
s_addc_u32 s5, s5, 0
s_waitcnt vmcnt(14)
s_barrier
s_add_u32 m0, s39, 0
s_mov_b64 exec, s[60:61]
buffer_load_dwordx4 v4, s[8:11], s37 offen lds
s_mov_b64 exec, -1
s_add_u32 m0, s39, 3072
s_nop 0
buffer_load_dwordx4 v5, s[8:11], s37 offen lds
s_add_u32 m0, s39, 6144
s_nop 0
buffer_load_dwordx4 v6, s[8:11], s37 offen lds
s_add_u32 m0, s39, 9216
s_nop 0
buffer_load_dwordx4 v7, s[8:11], s37 offen lds
s_add_u32 m0, s39, 12288
s_nop 0
buffer_load_dwordx4 v8, s[8:11], s37 offen lds
s_add_u32 m0, s39, 15360
s_nop 0
buffer_load_dwordx4 v9, s[8:11], s37 offen lds
s_add_u32 m0, s40, 0
s_add_u32 s43, s38, 0
buffer_load_dwordx4 v2, s[12:15], s43 offen lds
s_add_u32 m0, s40, 1024
s_add_u32 s43, s38, 49152
buffer_load_dwordx4 v3, s[12:15], s43 offen lds
s_add_u32 m0, s40, 2048
s_add_u32 s43, s38, 98304
buffer_load_dwordx4 v2, s[12:15], s43 offen lds
s_add_u32 m0, s40, 3072
s_add_u32 s43, s38, 147456
buffer_load_dwordx4 v3, s[12:15], s43 offen lds
s_add_u32 m0, s40, 4096
s_add_u32 s43, s38, 196608
buffer_load_dwordx4 v2, s[12:15], s43 offen lds
s_add_u32 m0, s40, 5120
s_add_u32 s43, s38, 245760
buffer_load_dwordx4 v3, s[12:15], s43 offen lds
s_add_u32 m0, s40, 6144
s_add_u32 s43, s38, 294912
buffer_load_dwordx4 v2, s[12:15], s43 offen lds
s_add_u32 m0, s40, 7168
s_add_u32 s43, s38, 344064
buffer_load_dwordx4 v3, s[12:15], s43 offen lds
s_add_u32 s37, s37, 128
s_add_u32 s38, s38, 393216
s_waitcnt vmcnt(14)
s_barrier
s_add_u32 m0, s39, 43008
s_mov_b64 exec, s[60:61]
buffer_load_dwordx4 v4, s[8:11], s37 offen lds
s_mov_b64 exec, -1
s_add_u32 m0, s39, 46080
s_nop 0
buffer_load_dwordx4 v5, s[8:11], s37 offen lds
s_add_u32 m0, s39, 49152
s_nop 0
buffer_load_dwordx4 v6, s[8:11], s37 offen lds
s_add_u32 m0, s39, 52224
s_nop 0
buffer_load_dwordx4 v7, s[8:11], s37 offen lds
s_add_u32 m0, s39, 55296
s_nop 0
buffer_load_dwordx4 v8, s[8:11], s37 offen lds
s_add_u32 m0, s39, 58368
s_nop 0
buffer_load_dwordx4 v9, s[8:11], s37 offen lds
s_add_u32 m0, s40, 43008
s_add_u32 s43, s38, 0
buffer_load_dwordx4 v2, s[12:15], s43 offen lds
s_add_u32 m0, s40, 44032
s_add_u32 s43, s38, 49152
buffer_load_dwordx4 v3, s[12:15], s43 offen lds
s_add_u32 m0, s40, 45056
s_add_u32 s43, s38, 98304
buffer_load_dwordx4 v2, s[12:15], s43 offen lds
s_add_u32 m0, s40, 46080
s_add_u32 s43, s38, 147456
buffer_load_dwordx4 v3, s[12:15], s43 offen lds
s_add_u32 m0, s40, 47104
s_add_u32 s43, s38, 196608
buffer_load_dwordx4 v2, s[12:15], s43 offen lds
s_add_u32 m0, s40, 48128
s_add_u32 s43, s38, 245760
buffer_load_dwordx4 v3, s[12:15], s43 offen lds
s_add_u32 m0, s40, 49152
s_add_u32 s43, s38, 294912
buffer_load_dwordx4 v2, s[12:15], s43 offen lds
s_add_u32 m0, s40, 50176
s_add_u32 s43, s38, 344064
buffer_load_dwordx4 v3, s[12:15], s43 offen lds
s_add_u32 s37, s37, 128
s_add_u32 s38, s38, 393216
s_load_dword s3, s[4:5], 0
s_load_dword s3, s[4:5], 64
s_load_dword s3, s[4:5], 128
s_waitcnt vmcnt(14)
s_barrier
s_add_u32 m0, s39, 86016
s_mov_b64 exec, s[60:61]
buffer_load_dwordx4 v4, s[8:11], s37 offen lds
s_mov_b64 exec, -1
s_add_u32 m0, s39, 89088
s_nop 0
buffer_load_dwordx4 v5, s[8:11], s37 offen lds
s_add_u32 m0, s39, 92160
s_nop 0
buffer_load_dwordx4 v6, s[8:11], s37 offen lds
s_add_u32 m0, s39, 95232
s_nop 0
buffer_load_dwordx4 v7, s[8:11], s37 offen lds
s_add_u32 m0, s39, 98304
s_nop 0
buffer_load_dwordx4 v8, s[8:11], s37 offen lds
s_add_u32 m0, s39, 101376
s_nop 0
buffer_load_dwordx4 v9, s[8:11], s37 offen lds
s_add_u32 m0, s40, 86016
s_add_u32 s43, s38, 0
buffer_load_dwordx4 v2, s[12:15], s43 offen lds
s_add_u32 m0, s40, 87040
s_add_u32 s43, s38, 49152
buffer_load_dwordx4 v3, s[12:15], s43 offen lds
s_add_u32 m0, s40, 88064
s_add_u32 s43, s38, 98304
buffer_load_dwordx4 v2, s[12:15], s43 offen lds
s_add_u32 m0, s40, 89088
s_add_u32 s43, s38, 147456
buffer_load_dwordx4 v3, s[12:15], s43 offen lds
s_add_u32 m0, s40, 90112
s_add_u32 s43, s38, 196608
buffer_load_dwordx4 v2, s[12:15], s43 offen lds
s_add_u32 m0, s40, 91136
s_add_u32 s43, s38, 245760
buffer_load_dwordx4 v3, s[12:15], s43 offen lds
s_add_u32 m0, s40, 92160
s_add_u32 s43, s38, 294912
buffer_load_dwordx4 v2, s[12:15], s43 offen lds
s_add_u32 m0, s40, 93184
s_add_u32 s43, s38, 344064
buffer_load_dwordx4 v3, s[12:15], s43 offen lds
s_add_u32 s37, s37, 128
s_add_u32 s38, s38, 393216
s_load_dword s3, s[4:5], 192
s_load_dword s3, s[4:5], 7168
s_load_dword s3, s[4:5], 7232
s_load_dword s3, s[4:5], 7296
s_load_dword s3, s[4:5], 7360
s_waitcnt vmcnt(14)
s_barrier
s_add_u32 m0, s39, 0
s_mov_b64 exec, s[60:61]
buffer_load_dwordx4 v4, s[8:11], s37 offen lds
s_mov_b64 exec, -1
s_add_u32 m0, s39, 3072
s_nop 0
buffer_load_dwordx4 v5, s[8:11], s37 offen lds
s_add_u32 m0, s39, 6144
s_nop 0
buffer_load_dwordx4 v6, s[8:11], s37 offen lds
s_branch Lov_0
.p2align 12
Lst_0_0:
s_branch Lwr_145
s_nop 0
s_nop 0
Lov_0:
s_add_u32 m0, s39, 9216
s_nop 0
buffer_load_dwordx4 v7, s[8:11], s37 offen lds
s_add_u32 m0, s39, 12288
s_nop 0
buffer_load_dwordx4 v8, s[8:11], s37 offen lds
s_add_u32 m0, s39, 15360
s_nop 0
buffer_load_dwordx4 v9, s[8:11], s37 offen lds
s_add_u32 m0, s40, 0
s_add_u32 s43, s38, 0
buffer_load_dwordx4 v2, s[12:15], s43 offen lds
s_add_u32 m0, s40, 1024
s_add_u32 s43, s38, 49152
buffer_load_dwordx4 v3, s[12:15], s43 offen lds
s_add_u32 m0, s40, 2048
s_add_u32 s43, s38, 98304
buffer_load_dwordx4 v2, s[12:15], s43 offen lds
s_add_u32 m0, s40, 3072
s_add_u32 s43, s38, 147456
buffer_load_dwordx4 v3, s[12:15], s43 offen lds
s_add_u32 m0, s40, 4096
s_add_u32 s43, s38, 196608
buffer_load_dwordx4 v2, s[12:15], s43 offen lds
s_add_u32 m0, s40, 5120
s_add_u32 s43, s38, 245760
buffer_load_dwordx4 v3, s[12:15], s43 offen lds
s_add_u32 m0, s40, 6144
s_add_u32 s43, s38, 294912
buffer_load_dwordx4 v2, s[12:15], s43 offen lds
s_add_u32 m0, s40, 7168
s_add_u32 s43, s38, 344064
buffer_load_dwordx4 v3, s[12:15], s43 offen lds
s_add_u32 s37, s37, 128
s_add_u32 s38, s38, 393216
s_load_dword s3, s[4:5], 14336
s_load_dword s3, s[4:5], 14400
s_load_dword s3, s[4:5], 14464
s_load_dword s3, s[4:5], 14528
s_load_dword s3, s[4:5], 21504
s_load_dword s3, s[4:5], 21568
s_waitcnt vmcnt(14)
s_barrier
s_add_u32 m0, s39, 43008
s_mov_b64 exec, s[60:61]
buffer_load_dwordx4 v4, s[8:11], s37 offen lds
s_mov_b64 exec, -1
s_add_u32 m0, s39, 46080
s_nop 0
buffer_load_dwordx4 v5, s[8:11], s37 offen lds
s_add_u32 m0, s39, 49152
s_nop 0
buffer_load_dwordx4 v6, s[8:11], s37 offen lds
s_add_u32 m0, s39, 52224
s_nop 0
buffer_load_dwordx4 v7, s[8:11], s37 offen lds
s_add_u32 m0, s39, 55296
s_nop 0
buffer_load_dwordx4 v8, s[8:11], s37 offen lds
s_add_u32 m0, s39, 58368
s_nop 0
buffer_load_dwordx4 v9, s[8:11], s37 offen lds
s_add_u32 m0, s40, 43008
s_add_u32 s43, s38, 0
buffer_load_dwordx4 v2, s[12:15], s43 offen lds
s_add_u32 m0, s40, 44032
s_add_u32 s43, s38, 49152
buffer_load_dwordx4 v3, s[12:15], s43 offen lds
s_add_u32 m0, s40, 45056
s_add_u32 s43, s38, 98304
buffer_load_dwordx4 v2, s[12:15], s43 offen lds
s_add_u32 m0, s40, 46080
s_add_u32 s43, s38, 147456
buffer_load_dwordx4 v3, s[12:15], s43 offen lds
s_add_u32 m0, s40, 47104
s_add_u32 s43, s38, 196608
buffer_load_dwordx4 v2, s[12:15], s43 offen lds
s_add_u32 m0, s40, 48128
s_add_u32 s43, s38, 245760
buffer_load_dwordx4 v3, s[12:15], s43 offen lds
s_add_u32 m0, s40, 49152
s_add_u32 s43, s38, 294912
buffer_load_dwordx4 v2, s[12:15], s43 offen lds
s_add_u32 m0, s40, 50176
s_add_u32 s43, s38, 344064
buffer_load_dwordx4 v3, s[12:15], s43 offen lds
s_add_u32 s37, s37, 128
s_add_u32 s38, s38, 393216
s_load_dword s3, s[4:5], 21632
s_load_dword s3, s[4:5], 21696
s_load_dword s3, s[4:5], 28672
s_load_dword s3, s[4:5], 28736
s_load_dword s3, s[4:5], 28800
s_load_dword s3, s[4:5], 28864
s_load_dword s3, s[4:5], 35840
s_waitcnt vmcnt(14)
s_barrier
s_add_u32 m0, s39, 86016
s_mov_b64 exec, s[60:61]
buffer_load_dwordx4 v4, s[8:11], s37 offen lds
s_mov_b64 exec, -1
s_add_u32 m0, s39, 89088
s_nop 0
buffer_load_dwordx4 v5, s[8:11], s37 offen lds
s_add_u32 m0, s39, 92160
s_nop 0
buffer_load_dwordx4 v6, s[8:11], s37 offen lds
s_add_u32 m0, s39, 95232
s_nop 0
buffer_load_dwordx4 v7, s[8:11], s37 offen lds
s_add_u32 m0, s39, 98304
s_nop 0
buffer_load_dwordx4 v8, s[8:11], s37 offen lds
s_add_u32 m0, s39, 101376
s_nop 0
buffer_load_dwordx4 v9, s[8:11], s37 offen lds
s_add_u32 m0, s40, 86016
s_add_u32 s43, s38, 0
buffer_load_dwordx4 v2, s[12:15], s43 offen lds
s_add_u32 m0, s40, 87040
s_add_u32 s43, s38, 49152
buffer_load_dwordx4 v3, s[12:15], s43 offen lds
s_add_u32 m0, s40, 88064
s_add_u32 s43, s38, 98304
buffer_load_dwordx4 v2, s[12:15], s43 offen lds
s_add_u32 m0, s40, 89088
s_add_u32 s43, s38, 147456
buffer_load_dwordx4 v3, s[12:15], s43 offen lds
s_add_u32 m0, s40, 90112
s_add_u32 s43, s38, 196608
buffer_load_dwordx4 v2, s[12:15], s43 offen lds
s_add_u32 m0, s40, 91136
s_add_u32 s43, s38, 245760
buffer_load_dwordx4 v3, s[12:15], s43 offen lds
s_add_u32 m0, s40, 92160
s_add_u32 s43, s38, 294912
buffer_load_dwordx4 v2, s[12:15], s43 offen lds
s_add_u32 m0, s40, 93184
s_add_u32 s43, s38, 344064
buffer_load_dwordx4 v3, s[12:15], s43 offen lds
s_add_u32 s37, s37, 128
s_add_u32 s38, s38, 393216
s_load_dword s3, s[4:5], 35904
s_load_dword s3, s[4:5], 35968
s_load_dword s3, s[4:5], 36032
s_load_dword s3, s[4:5], 43008
s_load_dword s3, s[4:5], 43072
s_load_dword s3, s[4:5], 43136
s_load_dword s3, s[4:5], 43200
s_load_dword s3, s[4:5], 50176
s_waitcnt vmcnt(14)
s_barrier
s_add_u32 m0, s39, 0
s_mov_b64 exec, s[60:61]
buffer_load_dwordx4 v4, s[8:11], s37 offen lds
s_mov_b64 exec, -1
s_add_u32 m0, s39, 3072
s_nop 0
buffer_load_dwordx4 v5, s[8:11], s37 offen lds
s_add_u32 m0, s39, 6144
s_nop 0
buffer_load_dwordx4 v6, s[8:11], s37 offen lds
s_add_u32 m0, s39, 9216
s_nop 0
buffer_load_dwordx4 v7, s[8:11], s37 offen lds
s_add_u32 m0, s39, 12288
s_nop 0
buffer_load_dwordx4 v8, s[8:11], s37 offen lds
s_add_u32 m0, s39, 15360
s_nop 0
buffer_load_dwordx4 v9, s[8:11], s37 offen lds
s_add_u32 m0, s40, 0
s_add_u32 s43, s38, 0
buffer_load_dwordx4 v2, s[12:15], s43 offen lds
s_add_u32 m0, s40, 1024
s_add_u32 s43, s38, 49152
buffer_load_dwordx4 v3, s[12:15], s43 offen lds
s_add_u32 m0, s40, 2048
s_add_u32 s43, s38, 98304
buffer_load_dwordx4 v2, s[12:15], s43 offen lds
s_add_u32 m0, s40, 3072
s_add_u32 s43, s38, 147456
buffer_load_dwordx4 v3, s[12:15], s43 offen lds
s_add_u32 m0, s40, 4096
s_add_u32 s43, s38, 196608
buffer_load_dwordx4 v2, s[12:15], s43 offen lds
s_add_u32 m0, s40, 5120
s_add_u32 s43, s38, 245760
buffer_load_dwordx4 v3, s[12:15], s43 offen lds
s_add_u32 m0, s40, 6144
s_add_u32 s43, s38, 294912
buffer_load_dwordx4 v2, s[12:15], s43 offen lds
s_add_u32 m0, s40, 7168
s_add_u32 s43, s38, 344064
buffer_load_dwordx4 v3, s[12:15], s43 offen lds
s_add_u32 s37, s37, 128
s_add_u32 s38, s38, 393216
s_load_dword s3, s[4:5], 50240
s_load_dword s3, s[4:5], 50304
s_load_dword s3, s[4:5], 50368
s_load_dword s3, s[4:5], 57344
s_load_dword s3, s[4:5], 57408
s_load_dword s3, s[4:5], 57472
s_load_dword s3, s[4:5], 57536
s_load_dword s3, s[4:5], 64512
s_load_dword s3, s[4:5], 64576
s_waitcnt vmcnt(14)
s_barrier
s_add_u32 m0, s39, 43008
s_mov_b64 exec, s[60:61]
buffer_load_dwordx4 v4, s[8:11], s37 offen lds
s_mov_b64 exec, -1
s_add_u32 m0, s39, 46080
s_nop 0
buffer_load_dwordx4 v5, s[8:11], s37 offen lds
s_add_u32 m0, s39, 49152
s_nop 0
buffer_load_dwordx4 v6, s[8:11], s37 offen lds
s_add_u32 m0, s39, 52224
s_nop 0
buffer_load_dwordx4 v7, s[8:11], s37 offen lds
s_add_u32 m0, s39, 55296
s_nop 0
buffer_load_dwordx4 v8, s[8:11], s37 offen lds
s_add_u32 m0, s39, 58368
s_nop 0
buffer_load_dwordx4 v9, s[8:11], s37 offen lds
s_add_u32 m0, s40, 43008
s_add_u32 s43, s38, 0
buffer_load_dwordx4 v2, s[12:15], s43 offen lds
s_add_u32 m0, s40, 44032
s_add_u32 s43, s38, 49152
buffer_load_dwordx4 v3, s[12:15], s43 offen lds
s_add_u32 m0, s40, 45056
s_add_u32 s43, s38, 98304
buffer_load_dwordx4 v2, s[12:15], s43 offen lds
s_add_u32 m0, s40, 46080
s_add_u32 s43, s38, 147456
buffer_load_dwordx4 v3, s[12:15], s43 offen lds
s_add_u32 m0, s40, 47104
s_add_u32 s43, s38, 196608
buffer_load_dwordx4 v2, s[12:15], s43 offen lds
s_add_u32 m0, s40, 48128
s_add_u32 s43, s38, 245760
buffer_load_dwordx4 v3, s[12:15], s43 offen lds
s_add_u32 m0, s40, 49152
s_add_u32 s43, s38, 294912
buffer_load_dwordx4 v2, s[12:15], s43 offen lds
s_add_u32 m0, s40, 50176
s_add_u32 s43, s38, 344064
buffer_load_dwordx4 v3, s[12:15], s43 offen lds
s_add_u32 s37, s37, 128
s_add_u32 s38, s38, 393216
s_load_dword s3, s[4:5], 64640
s_load_dword s3, s[4:5], 64704
s_load_dword s3, s[4:5], 71680
s_load_dword s3, s[4:5], 71744
s_load_dword s3, s[4:5], 71808
s_load_dword s3, s[4:5], 71872
s_load_dword s3, s[4:5], 78848
s_load_dword s3, s[4:5], 78912
s_load_dword s3, s[4:5], 78976
s_load_dword s3, s[4:5], 79040
s_waitcnt vmcnt(14)
s_barrier
s_add_u32 m0, s39, 86016
s_mov_b64 exec, s[60:61]
buffer_load_dwordx4 v4, s[8:11], s37 offen lds
s_mov_b64 exec, -1
s_add_u32 m0, s39, 89088
s_nop 0
buffer_load_dwordx4 v5, s[8:11], s37 offen lds
s_add_u32 m0, s39, 92160
s_nop 0
buffer_load_dwordx4 v6, s[8:11], s37 offen lds
s_add_u32 m0, s39, 95232
s_nop 0
buffer_load_dwordx4 v7, s[8:11], s37 offen lds
s_add_u32 m0, s39, 98304
s_nop 0
buffer_load_dwordx4 v8, s[8:11], s37 offen lds
s_add_u32 m0, s39, 101376
s_nop 0
buffer_load_dwordx4 v9, s[8:11], s37 offen lds
s_add_u32 m0, s40, 86016
s_add_u32 s43, s38, 0
buffer_load_dwordx4 v2, s[12:15], s43 offen lds
s_add_u32 m0, s40, 87040
s_add_u32 s43, s38, 49152
buffer_load_dwordx4 v3, s[12:15], s43 offen lds
s_add_u32 m0, s40, 88064
s_add_u32 s43, s38, 98304
buffer_load_dwordx4 v2, s[12:15], s43 offen lds
s_add_u32 m0, s40, 89088
s_add_u32 s43, s38, 147456
buffer_load_dwordx4 v3, s[12:15], s43 offen lds
s_add_u32 m0, s40, 90112
s_add_u32 s43, s38, 196608
buffer_load_dwordx4 v2, s[12:15], s43 offen lds
s_add_u32 m0, s40, 91136
s_add_u32 s43, s38, 245760
buffer_load_dwordx4 v3, s[12:15], s43 offen lds
s_add_u32 m0, s40, 92160
s_add_u32 s43, s38, 294912
buffer_load_dwordx4 v2, s[12:15], s43 offen lds
s_add_u32 m0, s40, 93184
s_add_u32 s43, s38, 344064
buffer_load_dwordx4 v3, s[12:15], s43 offen lds
s_add_u32 s37, s37, 128
s_add_u32 s38, s38, 393216
s_load_dword s3, s[4:5], 86016
s_load_dword s3, s[4:5], 86080
s_load_dword s3, s[4:5], 86144
s_load_dword s3, s[4:5], 86208
s_load_dword s3, s[4:5], 93184
s_load_dword s3, s[4:5], 93248
s_load_dword s3, s[4:5], 93312
s_load_dword s3, s[4:5], 93376
s_load_dword s3, s[4:5], 100352
s_load_dword s3, s[4:5], 100416
s_waitcnt vmcnt(14)
s_barrier
s_add_u32 m0, s39, 0
s_mov_b64 exec, s[60:61]
buffer_load_dwordx4 v4, s[8:11], s37 offen lds
s_mov_b64 exec, -1
s_add_u32 m0, s39, 3072
s_nop 0
buffer_load_dwordx4 v5, s[8:11], s37 offen lds
s_add_u32 m0, s39, 6144
s_nop 0
buffer_load_dwordx4 v6, s[8:11], s37 offen lds
s_add_u32 m0, s39, 9216
s_nop 0
buffer_load_dwordx4 v7, s[8:11], s37 offen lds
s_add_u32 m0, s39, 12288
s_nop 0
buffer_load_dwordx4 v8, s[8:11], s37 offen lds
s_add_u32 m0, s39, 15360
s_nop 0
buffer_load_dwordx4 v9, s[8:11], s37 offen lds
s_add_u32 m0, s40, 0
s_add_u32 s43, s38, 0
buffer_load_dwordx4 v2, s[12:15], s43 offen lds
s_add_u32 m0, s40, 1024
s_add_u32 s43, s38, 49152
buffer_load_dwordx4 v3, s[12:15], s43 offen lds
s_add_u32 m0, s40, 2048
s_add_u32 s43, s38, 98304
buffer_load_dwordx4 v2, s[12:15], s43 offen lds
s_add_u32 m0, s40, 3072
s_add_u32 s43, s38, 147456
buffer_load_dwordx4 v3, s[12:15], s43 offen lds
s_add_u32 m0, s40, 4096
s_add_u32 s43, s38, 196608
buffer_load_dwordx4 v2, s[12:15], s43 offen lds
s_add_u32 m0, s40, 5120
s_add_u32 s43, s38, 245760
buffer_load_dwordx4 v3, s[12:15], s43 offen lds
s_add_u32 m0, s40, 6144
s_add_u32 s43, s38, 294912
buffer_load_dwordx4 v2, s[12:15], s43 offen lds
s_add_u32 m0, s40, 7168
s_add_u32 s43, s38, 344064
buffer_load_dwordx4 v3, s[12:15], s43 offen lds
s_add_u32 s37, s37, 128
s_add_u32 s38, s38, 393216
s_load_dword s3, s[4:5], 100480
s_load_dword s3, s[4:5], 100544
s_load_dword s3, s[4:5], 107520
s_load_dword s3, s[4:5], 107584
s_load_dword s3, s[4:5], 107648
s_load_dword s3, s[4:5], 107712
s_load_dword s3, s[4:5], 114688
s_load_dword s3, s[4:5], 114752
s_load_dword s3, s[4:5], 114816
s_load_dword s3, s[4:5], 114880
s_load_dword s3, s[4:5], 121856
s_waitcnt vmcnt(14)
s_barrier
s_add_u32 m0, s39, 43008
s_mov_b64 exec, s[60:61]
buffer_load_dwordx4 v4, s[8:11], s37 offen lds
s_mov_b64 exec, -1
s_add_u32 m0, s39, 46080
s_nop 0
buffer_load_dwordx4 v5, s[8:11], s37 offen lds
s_add_u32 m0, s39, 49152
s_nop 0
buffer_load_dwordx4 v6, s[8:11], s37 offen lds
s_add_u32 m0, s39, 52224
s_nop 0
buffer_load_dwordx4 v7, s[8:11], s37 offen lds
s_add_u32 m0, s39, 55296
s_nop 0
buffer_load_dwordx4 v8, s[8:11], s37 offen lds
s_add_u32 m0, s39, 58368
s_nop 0
buffer_load_dwordx4 v9, s[8:11], s37 offen lds
s_add_u32 m0, s40, 43008
s_add_u32 s43, s38, 0
buffer_load_dwordx4 v2, s[12:15], s43 offen lds
s_add_u32 m0, s40, 44032
s_add_u32 s43, s38, 49152
buffer_load_dwordx4 v3, s[12:15], s43 offen lds
s_add_u32 m0, s40, 45056
s_add_u32 s43, s38, 98304
buffer_load_dwordx4 v2, s[12:15], s43 offen lds
s_add_u32 m0, s40, 46080
s_add_u32 s43, s38, 147456
buffer_load_dwordx4 v3, s[12:15], s43 offen lds
s_add_u32 m0, s40, 47104
s_add_u32 s43, s38, 196608
buffer_load_dwordx4 v2, s[12:15], s43 offen lds
s_add_u32 m0, s40, 48128
s_add_u32 s43, s38, 245760
buffer_load_dwordx4 v3, s[12:15], s43 offen lds
s_add_u32 m0, s40, 49152
s_add_u32 s43, s38, 294912
buffer_load_dwordx4 v2, s[12:15], s43 offen lds
s_add_u32 m0, s40, 50176
s_add_u32 s43, s38, 344064
buffer_load_dwordx4 v3, s[12:15], s43 offen lds
s_add_u32 s37, s37, 128
s_add_u32 s38, s38, 393216
s_load_dword s3, s[4:5], 121920
s_load_dword s3, s[4:5], 121984
s_load_dword s3, s[4:5], 122048
s_load_dword s3, s[4:5], 129024
s_load_dword s3, s[4:5], 129088
s_load_dword s3, s[4:5], 129152
s_load_dword s3, s[4:5], 129216
s_load_dword s3, s[4:5], 136192
s_load_dword s3, s[4:5], 136256
s_load_dword s3, s[4:5], 136320
s_load_dword s3, s[4:5], 136384
s_waitcnt vmcnt(14)
s_barrier
s_add_u32 m0, s39, 86016
s_mov_b64 exec, s[60:61]
buffer_load_dwordx4 v4, s[8:11], s37 offen lds
s_mov_b64 exec, -1
s_add_u32 m0, s39, 89088
s_nop 0
buffer_load_dwordx4 v5, s[8:11], s37 offen lds
s_add_u32 m0, s39, 92160
s_nop 0
buffer_load_dwordx4 v6, s[8:11], s37 offen lds
s_add_u32 m0, s39, 95232
s_nop 0
buffer_load_dwordx4 v7, s[8:11], s37 offen lds
s_add_u32 m0, s39, 98304
s_nop 0
buffer_load_dwordx4 v8, s[8:11], s37 offen lds
s_add_u32 m0, s39, 101376
s_nop 0
buffer_load_dwordx4 v9, s[8:11], s37 offen lds
s_add_u32 m0, s40, 86016
s_add_u32 s43, s38, 0
buffer_load_dwordx4 v2, s[12:15], s43 offen lds
s_add_u32 m0, s40, 87040
s_add_u32 s43, s38, 49152
buffer_load_dwordx4 v3, s[12:15], s43 offen lds
s_add_u32 m0, s40, 88064
s_add_u32 s43, s38, 98304
buffer_load_dwordx4 v2, s[12:15], s43 offen lds
s_add_u32 m0, s40, 89088
s_add_u32 s43, s38, 147456
buffer_load_dwordx4 v3, s[12:15], s43 offen lds
s_add_u32 m0, s40, 90112
s_add_u32 s43, s38, 196608
buffer_load_dwordx4 v2, s[12:15], s43 offen lds
s_add_u32 m0, s40, 91136
s_add_u32 s43, s38, 245760
buffer_load_dwordx4 v3, s[12:15], s43 offen lds
s_add_u32 m0, s40, 92160
s_add_u32 s43, s38, 294912
buffer_load_dwordx4 v2, s[12:15], s43 offen lds
s_add_u32 m0, s40, 93184
s_add_u32 s43, s38, 344064
buffer_load_dwordx4 v3, s[12:15], s43 offen lds
s_add_u32 s37, s37, 128
s_add_u32 s38, s38, 393216
s_load_dword s3, s[4:5], 143360
s_load_dword s3, s[4:5], 143424
s_load_dword s3, s[4:5], 143488
s_load_dword s3, s[4:5], 143552
s_load_dword s3, s[4:5], 150528
s_load_dword s3, s[4:5], 150592
s_load_dword s3, s[4:5], 150656
s_load_dword s3, s[4:5], 150720
s_load_dword s3, s[4:5], 157696
s_load_dword s3, s[4:5], 157760
s_load_dword s3, s[4:5], 157824
s_waitcnt vmcnt(14)
s_barrier
s_add_u32 m0, s39, 0
s_mov_b64 exec, s[60:61]
buffer_load_dwordx4 v4, s[8:11], s37 offen lds
s_mov_b64 exec, -1
s_add_u32 m0, s39, 3072
s_nop 0
buffer_load_dwordx4 v5, s[8:11], s37 offen lds
s_add_u32 m0, s39, 6144
s_nop 0
buffer_load_dwordx4 v6, s[8:11], s37 offen lds
s_add_u32 m0, s39, 9216
s_nop 0
buffer_load_dwordx4 v7, s[8:11], s37 offen lds
s_add_u32 m0, s39, 12288
s_nop 0
buffer_load_dwordx4 v8, s[8:11], s37 offen lds
s_add_u32 m0, s39, 15360
s_nop 0
buffer_load_dwordx4 v9, s[8:11], s37 offen lds
s_add_u32 m0, s40, 0
s_add_u32 s43, s38, 0
buffer_load_dwordx4 v2, s[12:15], s43 offen lds
s_add_u32 m0, s40, 1024
s_add_u32 s43, s38, 49152
buffer_load_dwordx4 v3, s[12:15], s43 offen lds
s_add_u32 m0, s40, 2048
s_add_u32 s43, s38, 98304
buffer_load_dwordx4 v2, s[12:15], s43 offen lds
s_add_u32 m0, s40, 3072
s_add_u32 s43, s38, 147456
buffer_load_dwordx4 v3, s[12:15], s43 offen lds
s_add_u32 m0, s40, 4096
s_add_u32 s43, s38, 196608
buffer_load_dwordx4 v2, s[12:15], s43 offen lds
s_add_u32 m0, s40, 5120
s_add_u32 s43, s38, 245760
buffer_load_dwordx4 v3, s[12:15], s43 offen lds
s_add_u32 m0, s40, 6144
s_add_u32 s43, s38, 294912
buffer_load_dwordx4 v2, s[12:15], s43 offen lds
s_add_u32 m0, s40, 7168
s_add_u32 s43, s38, 344064
buffer_load_dwordx4 v3, s[12:15], s43 offen lds
s_add_u32 s37, s37, 128
s_add_u32 s38, s38, 393216
s_load_dword s3, s[4:5], 157888
s_load_dword s3, s[4:5], 164864
s_load_dword s3, s[4:5], 164928
s_load_dword s3, s[4:5], 164992
s_load_dword s3, s[4:5], 165056
s_load_dword s3, s[4:5], 172032
s_load_dword s3, s[4:5], 172096
s_load_dword s3, s[4:5], 172160
s_load_dword s3, s[4:5], 172224
s_load_dword s3, s[4:5], 179200
s_load_dword s3, s[4:5], 179264
s_waitcnt vmcnt(14)
s_barrier
s_load_dword s3, s[4:5], 179328
s_load_dword s3, s[4:5], 179392
s_load_dword s3, s[4:5], 186368
s_load_dword s3, s[4:5], 186432
s_load_dword s3, s[4:5], 186496
s_load_dword s3, s[4:5], 186560
s_load_dword s3, s[4:5], 193536
s_branch Lov_1
.p2align 12
Lst_1_0:
s_branch Lwr_146
s_nop 0
s_nop 0
Lov_1:
s_load_dword s3, s[4:5], 193600
s_load_dword s3, s[4:5], 193664
s_load_dword s3, s[4:5], 193728
s_waitcnt vmcnt(0)
s_barrier
s_bitcmp0_b32 s2, 0
s_cselect_b32 s88, s72, s74
s_cselect_b32 s89, s73, s75
s_cmp_lt_u32 s2, 192
s_cselect_b32 s90, 7340032, 0
s_mov_b32 s91, 0x20000
s_bfe_u32 s44, s2, 0x30001
s_lshl_b32 s44, s44, 2
s_and_b32 s43, s36, 3
s_add_u32 s44, s44, s43
s_lshl_b32 s44, s44, 5
v_lshrrev_b32 v18, 4, v1
v_add_u32 v18, s44, v18
v_mul_u32_u24 v18, 7168, v18
v_and_b32 v19, 15, v1
v_lshl_add_u32 v18, v19, 4, v18
s_lshr_b32 s43, s2, 4
s_lshl_b32 s43, s43, 8
s_add_u32 s43, s43, 4096
v_add_u32 v18, s43, v18
s_mov_b32 s43, 0
buffer_load_dwordx4 v[128:131], v18, s[88:91], s43 offen
s_mov_b32 s43, 28672
buffer_load_dwordx4 v[132:135], v18, s[88:91], s43 offen
s_mov_b32 s43, 57344
buffer_load_dwordx4 v[136:139], v18, s[88:91], s43 offen
s_mov_b32 s43, 86016
buffer_load_dwordx4 v[140:143], v18, s[88:91], s43 offen
s_mov_b32 s43, 114688
buffer_load_dwordx4 v[144:147], v18, s[88:91], s43 offen
s_mov_b32 s43, 143360
buffer_load_dwordx4 v[148:151], v18, s[88:91], s43 offen
s_mov_b32 s43, 172032
buffer_load_dwordx4 v[152:155], v18, s[88:91], s43 offen
s_mov_b32 s43, 200704
buffer_load_dwordx4 v[156:159], v18, s[88:91], s43 offen
s_barrier
s_lshl_b32 s43, s35, 7
s_add_u32 s28, s68, s43
s_addc_u32 s29, s69, 0
s_mov_b32 s30, 2095232
s_mov_b32 s31, 0x20000
v_lshrrev_b32 v15, 3, v1
v_and_b32 v16, 6, v15
v_and_b32 v7, 7, v1
v_xor_b32 v7, v7, v16
v_lshlrev_b32 v7, 4, v7
v_mul_u32_u24 v15, 2048, v15
v_add_u32 v7, v7, v15
s_and_b32 s40, s36, 3
s_lshl_b32 s39, s40, 13
s_add_u32 s40, s40, s35
s_add_u32 s42, s40, 0
s_and_b32 s42, s42, 15
s_lshl_b32 s42, s42, 17
s_add_u32 m0, s39, 65536
s_add_u32 s43, s42, 0
buffer_load_dwordx4 v7, s[28:31], s43 offen lds
s_add_u32 m0, s39, 66560
s_add_u32 s43, s42, 16384
buffer_load_dwordx4 v7, s[28:31], s43 offen lds
s_add_u32 m0, s39, 67584
s_add_u32 s43, s42, 32768
buffer_load_dwordx4 v7, s[28:31], s43 offen lds
s_add_u32 m0, s39, 68608
s_add_u32 s43, s42, 49152
buffer_load_dwordx4 v7, s[28:31], s43 offen lds
s_add_u32 m0, s39, 69632
s_add_u32 s43, s42, 65536
buffer_load_dwordx4 v7, s[28:31], s43 offen lds
s_add_u32 m0, s39, 70656
s_add_u32 s43, s42, 81920
buffer_load_dwordx4 v7, s[28:31], s43 offen lds
s_add_u32 m0, s39, 71680
s_add_u32 s43, s42, 98304
buffer_load_dwordx4 v7, s[28:31], s43 offen lds
s_add_u32 m0, s39, 72704
s_add_u32 s43, s42, 114688
buffer_load_dwordx4 v7, s[28:31], s43 offen lds
s_branch Lats_6
Lcons_7:
s_lshl_b32 s43, s35, 7
s_waitcnt lgkmcnt(0)
s_mov_b32 s8, s64
s_mov_b32 s9, s65
s_mov_b32 s10, 4194304
s_mov_b32 s11, 0x20000
s_add_u32 s12, s66, s43
s_addc_u32 s13, s67, 0
s_mov_b32 s14, 6289536
s_mov_b32 s15, 0x20000
s_lshr_b32 s43, s2, 3
s_lshl_b32 s43, s43, 2
s_add_u32 s43, s43, s36
s_sub_u32 s44, s43, 0
s_and_b32 s44, s44, 127
s_cmp_lt_u32 s44, 24
s_cbranch_scc0 Lt_8
s_lshl_b32 s44, s44, 20
s_min_u32 s44, s44, 24117184
s_load_dword s3, s[82:83], s44 glc
Lt_8:
s_sub_u32 s44, s43, 24
s_and_b32 s44, s44, 127
s_cmp_lt_u32 s44, 8
s_cbranch_scc0 Lt_9
s_lshl_b32 s44, s44, 20
s_min_u32 s44, s44, 7339968
s_load_dword s3, s[72:73], s44
Lt_9:
s_sub_u32 s44, s43, 32
s_and_b32 s44, s44, 127
s_cmp_lt_u32 s44, 8
s_cbranch_scc0 Lt_10
s_lshl_b32 s44, s44, 20
s_min_u32 s44, s44, 7339968
s_load_dword s3, s[74:75], s44
Lt_10:
s_sub_u32 s44, s43, 40
s_and_b32 s44, s44, 127
s_cmp_lt_u32 s44, 3
s_cbranch_scc0 Lt_11
s_lshl_b32 s44, s44, 20
s_min_u32 s44, s44, 2097088
s_load_dword s3, s[68:69], s44
Lt_11:
s_sub_u32 s44, s43, 43
s_and_b32 s44, s44, 127
s_cmp_lt_u32 s44, 5
s_cbranch_scc0 Lt_12
s_lshl_b32 s44, s44, 20
s_min_u32 s44, s44, 4194240
s_add_u32 s44, s44, 25165824
s_load_dword s3, s[82:83], s44 glc
Lt_12:
s_sub_u32 s44, s43, 48
s_and_b32 s44, s44, 127
s_cmp_lt_u32 s44, 8
s_cbranch_scc0 Lt_13
s_lshl_b32 s44, s44, 20
s_min_u32 s44, s44, 7339968
s_load_dword s3, s[76:77], s44
Lt_13:
s_sub_u32 s44, s43, 56
s_and_b32 s44, s44, 127
s_cmp_lt_u32 s44, 5
s_cbranch_scc0 Lt_14
s_lshl_b32 s44, s44, 20
s_min_u32 s44, s44, 4194240
s_add_u32 s44, s44, 33554432
s_load_dword s3, s[82:83], s44 glc
Lt_14:
s_sub_u32 s44, s43, 61
s_and_b32 s44, s44, 127
s_cmp_lt_u32 s44, 5
s_cbranch_scc0 Lt_15
s_lshl_b32 s44, s44, 20
s_min_u32 s44, s44, 4194240
s_load_dword s3, s[78:79], s44 glc
Lt_15:
v_lshrrev_b32 v16, 1, v12
v_xor_b32 v15, v13, v16
v_lshlrev_b32 v15, 4, v15
v_lshl_add_u32 v2, v12, 7, v15
v_xor_b32 v3, 64, v2
v_add_u32 v4, 86016, v2
v_add_u32 v5, 86016, v3
v_lshrrev_b32 v15, 2, v12
v_and_b32 v16, 3, v1
v_lshl_add_u32 v19, v13, 3, v15
v_lshlrev_b32 v19, 7, v19
v_and_b32 v15, 2, v15
v_and_b32 v17, 1, v13
v_lshl_add_u32 v15, v17, 2, v15
v_lshrrev_b32 v17, 1, v16
s_lshl_b32 s43, s36, 1
v_add_u32 v17, s43, v17
v_xor_b32 v15, v15, v17
v_lshl_add_u32 v19, v15, 4, v19
v_and_b32 v16, 1, v16
v_lshl_add_u32 v19, v16, 3, v19
v_add_u32 v6, 18432, v19
v_add_u32 v7, 61440, v19
v_add_u32 v8, 104448, v19
s_and_b32 s43, s36, 1
s_bfe_u32 s44, s36, 0x10001
s_lshr_b32 s45, s36, 2
v_lshlrev_b32 v14, 2, v13
v_sub_u32 v14, v12, v14
v_mov_b32 v16, 0xff800000
s_or_b32 s46, s34, s45
s_cmp_lg_u32 s46, 0
s_cselect_b32 s46, 0, 0xff800000
v_subrev_u32 v15, 0, v14
v_cmp_ge_u32 vcc, 7, v15
v_add_u32 v15, 16, v15
s_nop 0
v_cndmask_b32 v248, v16, 0, vcc
v_cmp_ge_u32 vcc, 7, v15
s_nop 1
v_cndmask_b32 v244, v16, 0, vcc
v_or_b32 v240, s46, v244
v_subrev_u32 v15, 1, v14
v_cmp_ge_u32 vcc, 7, v15
v_add_u32 v15, 16, v15
s_nop 0
v_cndmask_b32 v249, v16, 0, vcc
v_cmp_ge_u32 vcc, 7, v15
s_nop 1
v_cndmask_b32 v245, v16, 0, vcc
v_or_b32 v241, s46, v245
v_subrev_u32 v15, 2, v14
v_cmp_ge_u32 vcc, 7, v15
v_add_u32 v15, 16, v15
s_nop 0
v_cndmask_b32 v250, v16, 0, vcc
v_cmp_ge_u32 vcc, 7, v15
s_nop 1
v_cndmask_b32 v246, v16, 0, vcc
v_or_b32 v242, s46, v246
v_subrev_u32 v15, 3, v14
v_cmp_ge_u32 vcc, 7, v15
v_add_u32 v15, 16, v15
s_nop 0
v_cndmask_b32 v251, v16, 0, vcc
v_cmp_ge_u32 vcc, 7, v15
s_nop 1
v_cndmask_b32 v247, v16, 0, vcc
v_or_b32 v243, s46, v247
s_lshl_b32 s46, s45, 6
s_add_u32 s46, s46, s44
s_add_u32 s46, s46, 16
v_lshl_add_u32 v14, v12, 1, s46
s_lshl_b32 s47, s43, 6
v_lshl_add_u32 v15, v13, 4, s47
v_mul_u32_u24 v20, 400, v14
v_add_u32 v20, v20, v15
v_subrev_u32 v16, 32, v14
v_max_i32 v16, 0, v16
v_mul_u32_u24 v21, 400, v16
v_add_u32 v21, v21, v15
v_lshrrev_b32 v16, 2, v12
v_lshl_add_u32 v16, v13, 2, v16
v_lshl_add_u32 v16, v16, 1, s46
v_and_b32 v17, 3, v1
v_lshl_add_u32 v17, v17, 3, s47
v_mul_u32_u24 v22, 400, v16
v_add_u32 v22, v22, v17
v_subrev_u32 v16, 32, v16
v_max_i32 v16, 0, v16
v_mul_u32_u24 v23, 400, v16
v_add_u32 v23, v23, v17
s_mul_i32 s60, s34, 262144
s_add_u32 s16, s82, s60
s_addc_u32 s17, s83, 0
s_mov_b32 s18, 262144
s_mov_b32 s19, 0x20000
s_lshl_b32 s60, s35, 14
s_lshl_b32 s43, s43, 13
s_add_u32 s60, s60, s43
s_lshl_b32 s43, s45, 12
s_add_u32 s60, s60, s43
s_lshl_b32 s43, s44, 10
s_add_u32 s60, s60, s43
v_lshlrev_b32 v24, 4, v1
s_mov_b32 s61, 0x3e8293ee
s_lshl_b32 s38, s35, 7
s_add_u32 s56, s82, 28311552
s_addc_u32 s57, s83, 0
s_mov_b32 s58, 114688
s_mov_b32 s59, 0x20000
s_barrier
ds_read_b128 v[32:35], v2 offset:0
ds_read_b64_tr_b16 v[72:73], v6 offset:8192
ds_read_b64_tr_b16 v[74:75], v6 offset:8704
ds_read_b64_tr_b16 v[76:77], v6 offset:16384
ds_read_b64_tr_b16 v[78:79], v6 offset:16896
ds_read_b64_tr_b16 v[68:69], v6 offset:0
ds_read_b64_tr_b16 v[70:71], v6 offset:512
ds_read_b128 v[36:39], v2 offset:2048
ds_read_b128 v[40:43], v2 offset:4096
ds_read_b128 v[44:47], v2 offset:6144
ds_read_b128 v[48:51], v2 offset:8192
ds_read_b128 v[52:55], v2 offset:10240
ds_read_b128 v[56:59], v2 offset:12288
ds_read_b128 v[60:63], v2 offset:14336
ds_read_b128 v[64:67], v2 offset:16384
s_waitcnt lgkmcnt(0)
v_mfma_f32_16x16x32_bf16 v[128:131], v[68:71], v[32:35], 0
ds_read_b128 v[80:83], v3 offset:0
v_mfma_f32_16x16x32_bf16 v[132:135], v[68:71], v[36:39], 0
ds_read_b64_tr_b16 v[120:121], v6 offset:12288
v_mfma_f32_16x16x32_bf16 v[136:139], v[68:71], v[40:43], 0
ds_read_b64_tr_b16 v[122:123], v6 offset:12800
v_mfma_f32_16x16x32_bf16 v[140:143], v[68:71], v[44:47], 0
ds_read_b64_tr_b16 v[124:125], v6 offset:20480
v_mfma_f32_16x16x32_bf16 v[144:147], v[68:71], v[48:51], 0
ds_read_b64_tr_b16 v[126:127], v6 offset:20992
v_mfma_f32_16x16x32_bf16 v[148:151], v[68:71], v[52:55], 0
ds_read_b64_tr_b16 v[116:117], v6 offset:4096
v_mfma_f32_16x16x32_bf16 v[152:155], v[68:71], v[56:59], 0
ds_read_b64_tr_b16 v[118:119], v6 offset:4608
v_mfma_f32_16x16x32_bf16 v[156:159], v[68:71], v[60:63], 0
ds_read_b128 v[84:87], v3 offset:2048
v_mfma_f32_16x16x32_bf16 v[160:163], v[68:71], v[64:67], 0
ds_read_b128 v[88:91], v3 offset:4096
v_mfma_f32_16x16x32_bf16 v[196:199], v[72:75], v[64:67], 0
ds_read_b128 v[92:95], v3 offset:6144
v_mfma_f32_16x16x32_bf16 v[192:195], v[72:75], v[60:63], 0
ds_read_b128 v[96:99], v3 offset:8192
v_mfma_f32_16x16x32_bf16 v[188:191], v[72:75], v[56:59], 0
ds_read_b128 v[100:103], v3 offset:10240
v_mfma_f32_16x16x32_bf16 v[184:187], v[72:75], v[52:55], 0
ds_read_b128 v[104:107], v3 offset:12288
v_mfma_f32_16x16x32_bf16 v[180:183], v[72:75], v[48:51], 0
ds_read_b128 v[108:111], v3 offset:14336
v_mfma_f32_16x16x32_bf16 v[176:179], v[72:75], v[44:47], 0
ds_read_b128 v[112:115], v3 offset:16384
v_mfma_f32_16x16x32_bf16 v[172:175], v[72:75], v[40:43], 0
v_mfma_f32_16x16x32_bf16 v[168:171], v[72:75], v[36:39], 0
v_mfma_f32_16x16x32_bf16 v[164:167], v[72:75], v[32:35], 0
v_mfma_f32_16x16x32_bf16 v[200:203], v[76:79], v[32:35], 0
v_mfma_f32_16x16x32_bf16 v[204:207], v[76:79], v[36:39], 0
v_mfma_f32_16x16x32_bf16 v[208:211], v[76:79], v[40:43], 0
v_mfma_f32_16x16x32_bf16 v[212:215], v[76:79], v[44:47], 0
v_mfma_f32_16x16x32_bf16 v[216:219], v[76:79], v[48:51], 0
v_mfma_f32_16x16x32_bf16 v[220:223], v[76:79], v[52:55], 0
v_mfma_f32_16x16x32_bf16 v[224:227], v[76:79], v[56:59], 0
v_mfma_f32_16x16x32_bf16 v[228:231], v[76:79], v[60:63], 0
v_mfma_f32_16x16x32_bf16 v[232:235], v[76:79], v[64:67], 0
s_waitcnt lgkmcnt(0)
s_barrier
v_mfma_f32_16x16x32_bf16 v[128:131], v[116:119], v[80:83], v[128:131]
ds_read_b128 v[32:35], v2 offset:43008
v_mfma_f32_16x16x32_bf16 v[132:135], v[116:119], v[84:87], v[132:135]
ds_read_b64_tr_b16 v[72:73], v7 offset:8192
v_mfma_f32_16x16x32_bf16 v[136:139], v[116:119], v[88:91], v[136:139]
ds_read_b64_tr_b16 v[74:75], v7 offset:8704
v_mfma_f32_16x16x32_bf16 v[140:143], v[116:119], v[92:95], v[140:143]
ds_read_b64_tr_b16 v[76:77], v7 offset:16384
v_mfma_f32_16x16x32_bf16 v[144:147], v[116:119], v[96:99], v[144:147]
ds_read_b64_tr_b16 v[78:79], v7 offset:16896
v_mfma_f32_16x16x32_bf16 v[148:151], v[116:119], v[100:103], v[148:151]
ds_read_b64_tr_b16 v[68:69], v7 offset:0
v_mfma_f32_16x16x32_bf16 v[152:155], v[116:119], v[104:107], v[152:155]
ds_read_b64_tr_b16 v[70:71], v7 offset:512
v_mfma_f32_16x16x32_bf16 v[156:159], v[116:119], v[108:111], v[156:159]
ds_read_b128 v[36:39], v2 offset:45056
v_mfma_f32_16x16x32_bf16 v[160:163], v[116:119], v[112:115], v[160:163]
ds_read_b128 v[40:43], v2 offset:47104
v_mfma_f32_16x16x32_bf16 v[196:199], v[120:123], v[112:115], v[196:199]
ds_read_b128 v[44:47], v2 offset:49152
v_mfma_f32_16x16x32_bf16 v[192:195], v[120:123], v[108:111], v[192:195]
ds_read_b128 v[48:51], v2 offset:51200
v_mfma_f32_16x16x32_bf16 v[188:191], v[120:123], v[104:107], v[188:191]
ds_read_b128 v[52:55], v2 offset:53248
v_mfma_f32_16x16x32_bf16 v[184:187], v[120:123], v[100:103], v[184:187]
ds_read_b128 v[56:59], v2 offset:55296
v_mfma_f32_16x16x32_bf16 v[180:183], v[120:123], v[96:99], v[180:183]
ds_read_b128 v[60:63], v2 offset:57344
v_mfma_f32_16x16x32_bf16 v[176:179], v[120:123], v[92:95], v[176:179]
ds_read_b128 v[64:67], v2 offset:59392
v_mfma_f32_16x16x32_bf16 v[172:175], v[120:123], v[88:91], v[172:175]
v_mfma_f32_16x16x32_bf16 v[168:171], v[120:123], v[84:87], v[168:171]
v_mfma_f32_16x16x32_bf16 v[164:167], v[120:123], v[80:83], v[164:167]
v_mfma_f32_16x16x32_bf16 v[200:203], v[124:127], v[80:83], v[200:203]
v_mfma_f32_16x16x32_bf16 v[204:207], v[124:127], v[84:87], v[204:207]
v_mfma_f32_16x16x32_bf16 v[208:211], v[124:127], v[88:91], v[208:211]
v_mfma_f32_16x16x32_bf16 v[212:215], v[124:127], v[92:95], v[212:215]
v_mfma_f32_16x16x32_bf16 v[216:219], v[124:127], v[96:99], v[216:219]
v_mfma_f32_16x16x32_bf16 v[220:223], v[124:127], v[100:103], v[220:223]
v_mfma_f32_16x16x32_bf16 v[224:227], v[124:127], v[104:107], v[224:227]
v_mfma_f32_16x16x32_bf16 v[228:231], v[124:127], v[108:111], v[228:231]
v_mfma_f32_16x16x32_bf16 v[232:235], v[124:127], v[112:115], v[232:235]
s_waitcnt lgkmcnt(0)
v_mfma_f32_16x16x32_bf16 v[128:131], v[68:71], v[32:35], v[128:131]
ds_read_b128 v[80:83], v3 offset:43008
v_mfma_f32_16x16x32_bf16 v[132:135], v[68:71], v[36:39], v[132:135]
ds_read_b64_tr_b16 v[120:121], v7 offset:12288
v_mfma_f32_16x16x32_bf16 v[136:139], v[68:71], v[40:43], v[136:139]
ds_read_b64_tr_b16 v[122:123], v7 offset:12800
v_mfma_f32_16x16x32_bf16 v[140:143], v[68:71], v[44:47], v[140:143]
ds_read_b64_tr_b16 v[124:125], v7 offset:20480
v_mfma_f32_16x16x32_bf16 v[144:147], v[68:71], v[48:51], v[144:147]
ds_read_b64_tr_b16 v[126:127], v7 offset:20992
v_mfma_f32_16x16x32_bf16 v[148:151], v[68:71], v[52:55], v[148:151]
ds_read_b64_tr_b16 v[116:117], v7 offset:4096
v_mfma_f32_16x16x32_bf16 v[152:155], v[68:71], v[56:59], v[152:155]
ds_read_b64_tr_b16 v[118:119], v7 offset:4608
v_mfma_f32_16x16x32_bf16 v[156:159], v[68:71], v[60:63], v[156:159]
ds_read_b128 v[84:87], v3 offset:45056
v_mfma_f32_16x16x32_bf16 v[160:163], v[68:71], v[64:67], v[160:163]
ds_read_b128 v[88:91], v3 offset:47104
v_mfma_f32_16x16x32_bf16 v[196:199], v[72:75], v[64:67], v[196:199]
ds_read_b128 v[92:95], v3 offset:49152
v_mfma_f32_16x16x32_bf16 v[192:195], v[72:75], v[60:63], v[192:195]
ds_read_b128 v[96:99], v3 offset:51200
v_mfma_f32_16x16x32_bf16 v[188:191], v[72:75], v[56:59], v[188:191]
ds_read_b128 v[100:103], v3 offset:53248
v_mfma_f32_16x16x32_bf16 v[184:187], v[72:75], v[52:55], v[184:187]
ds_read_b128 v[104:107], v3 offset:55296
v_mfma_f32_16x16x32_bf16 v[180:183], v[72:75], v[48:51], v[180:183]
ds_read_b128 v[108:111], v3 offset:57344
v_mfma_f32_16x16x32_bf16 v[176:179], v[72:75], v[44:47], v[176:179]
ds_read_b128 v[112:115], v3 offset:59392
v_mfma_f32_16x16x32_bf16 v[172:175], v[72:75], v[40:43], v[172:175]
v_mfma_f32_16x16x32_bf16 v[168:171], v[72:75], v[36:39], v[168:171]
v_mfma_f32_16x16x32_bf16 v[164:167], v[72:75], v[32:35], v[164:167]
v_mfma_f32_16x16x32_bf16 v[200:203], v[76:79], v[32:35], v[200:203]
v_mfma_f32_16x16x32_bf16 v[204:207], v[76:79], v[36:39], v[204:207]
v_mfma_f32_16x16x32_bf16 v[208:211], v[76:79], v[40:43], v[208:211]
v_mfma_f32_16x16x32_bf16 v[212:215], v[76:79], v[44:47], v[212:215]
v_mfma_f32_16x16x32_bf16 v[216:219], v[76:79], v[48:51], v[216:219]
v_mfma_f32_16x16x32_bf16 v[220:223], v[76:79], v[52:55], v[220:223]
v_mfma_f32_16x16x32_bf16 v[224:227], v[76:79], v[56:59], v[224:227]
v_mfma_f32_16x16x32_bf16 v[228:231], v[76:79], v[60:63], v[228:231]
v_mfma_f32_16x16x32_bf16 v[232:235], v[76:79], v[64:67], v[232:235]
s_waitcnt lgkmcnt(0)
s_barrier
v_mfma_f32_16x16x32_bf16 v[128:131], v[116:119], v[80:83], v[128:131]
ds_read_b128 v[32:35], v4 offset:0
v_mfma_f32_16x16x32_bf16 v[132:135], v[116:119], v[84:87], v[132:135]
ds_read_b64_tr_b16 v[72:73], v8 offset:8192
v_mfma_f32_16x16x32_bf16 v[136:139], v[116:119], v[88:91], v[136:139]
ds_read_b64_tr_b16 v[74:75], v8 offset:8704
v_mfma_f32_16x16x32_bf16 v[140:143], v[116:119], v[92:95], v[140:143]
ds_read_b64_tr_b16 v[76:77], v8 offset:16384
v_mfma_f32_16x16x32_bf16 v[144:147], v[116:119], v[96:99], v[144:147]
ds_read_b64_tr_b16 v[78:79], v8 offset:16896
v_mfma_f32_16x16x32_bf16 v[148:151], v[116:119], v[100:103], v[148:151]
ds_read_b64_tr_b16 v[68:69], v8 offset:0
v_mfma_f32_16x16x32_bf16 v[152:155], v[116:119], v[104:107], v[152:155]
ds_read_b64_tr_b16 v[70:71], v8 offset:512
v_mfma_f32_16x16x32_bf16 v[156:159], v[116:119], v[108:111], v[156:159]
ds_read_b128 v[36:39], v4 offset:2048
v_mfma_f32_16x16x32_bf16 v[160:163], v[116:119], v[112:115], v[160:163]
ds_read_b128 v[40:43], v4 offset:4096
v_mfma_f32_16x16x32_bf16 v[196:199], v[120:123], v[112:115], v[196:199]
ds_read_b128 v[44:47], v4 offset:6144
v_mfma_f32_16x16x32_bf16 v[192:195], v[120:123], v[108:111], v[192:195]
ds_read_b128 v[48:51], v4 offset:8192
v_mfma_f32_16x16x32_bf16 v[188:191], v[120:123], v[104:107], v[188:191]
ds_read_b128 v[52:55], v4 offset:10240
v_mfma_f32_16x16x32_bf16 v[184:187], v[120:123], v[100:103], v[184:187]
ds_read_b128 v[56:59], v4 offset:12288
v_mfma_f32_16x16x32_bf16 v[180:183], v[120:123], v[96:99], v[180:183]
ds_read_b128 v[60:63], v4 offset:14336
v_mfma_f32_16x16x32_bf16 v[176:179], v[120:123], v[92:95], v[176:179]
ds_read_b128 v[64:67], v4 offset:16384
v_mfma_f32_16x16x32_bf16 v[172:175], v[120:123], v[88:91], v[172:175]
v_mfma_f32_16x16x32_bf16 v[168:171], v[120:123], v[84:87], v[168:171]
v_mfma_f32_16x16x32_bf16 v[164:167], v[120:123], v[80:83], v[164:167]
v_mfma_f32_16x16x32_bf16 v[200:203], v[124:127], v[80:83], v[200:203]
v_mfma_f32_16x16x32_bf16 v[204:207], v[124:127], v[84:87], v[204:207]
v_mfma_f32_16x16x32_bf16 v[208:211], v[124:127], v[88:91], v[208:211]
v_mfma_f32_16x16x32_bf16 v[212:215], v[124:127], v[92:95], v[212:215]
v_mfma_f32_16x16x32_bf16 v[216:219], v[124:127], v[96:99], v[216:219]
v_mfma_f32_16x16x32_bf16 v[220:223], v[124:127], v[100:103], v[220:223]
v_mfma_f32_16x16x32_bf16 v[224:227], v[124:127], v[104:107], v[224:227]
v_mfma_f32_16x16x32_bf16 v[228:231], v[124:127], v[108:111], v[228:231]
v_mfma_f32_16x16x32_bf16 v[232:235], v[124:127], v[112:115], v[232:235]
s_waitcnt lgkmcnt(0)
v_mfma_f32_16x16x32_bf16 v[128:131], v[68:71], v[32:35], v[128:131]
ds_read_b128 v[80:83], v5 offset:0
v_mfma_f32_16x16x32_bf16 v[132:135], v[68:71], v[36:39], v[132:135]
ds_read_b64_tr_b16 v[120:121], v8 offset:12288
v_mfma_f32_16x16x32_bf16 v[136:139], v[68:71], v[40:43], v[136:139]
ds_read_b64_tr_b16 v[122:123], v8 offset:12800
v_mfma_f32_16x16x32_bf16 v[140:143], v[68:71], v[44:47], v[140:143]
ds_read_b64_tr_b16 v[124:125], v8 offset:20480
v_mfma_f32_16x16x32_bf16 v[144:147], v[68:71], v[48:51], v[144:147]
ds_read_b64_tr_b16 v[126:127], v8 offset:20992
v_mfma_f32_16x16x32_bf16 v[148:151], v[68:71], v[52:55], v[148:151]
ds_read_b64_tr_b16 v[116:117], v8 offset:4096
v_mfma_f32_16x16x32_bf16 v[152:155], v[68:71], v[56:59], v[152:155]
ds_read_b64_tr_b16 v[118:119], v8 offset:4608
v_mfma_f32_16x16x32_bf16 v[156:159], v[68:71], v[60:63], v[156:159]
ds_read_b128 v[84:87], v5 offset:2048
v_mfma_f32_16x16x32_bf16 v[160:163], v[68:71], v[64:67], v[160:163]
ds_read_b128 v[88:91], v5 offset:4096
v_mfma_f32_16x16x32_bf16 v[196:199], v[72:75], v[64:67], v[196:199]
ds_read_b128 v[92:95], v5 offset:6144
v_mfma_f32_16x16x32_bf16 v[192:195], v[72:75], v[60:63], v[192:195]
ds_read_b128 v[96:99], v5 offset:8192
v_mfma_f32_16x16x32_bf16 v[188:191], v[72:75], v[56:59], v[188:191]
ds_read_b128 v[100:103], v5 offset:10240
v_mfma_f32_16x16x32_bf16 v[184:187], v[72:75], v[52:55], v[184:187]
ds_read_b128 v[104:107], v5 offset:12288
v_mfma_f32_16x16x32_bf16 v[180:183], v[72:75], v[48:51], v[180:183]
ds_read_b128 v[108:111], v5 offset:14336
v_mfma_f32_16x16x32_bf16 v[176:179], v[72:75], v[44:47], v[176:179]
ds_read_b128 v[112:115], v5 offset:16384
v_mfma_f32_16x16x32_bf16 v[172:175], v[72:75], v[40:43], v[172:175]
v_mfma_f32_16x16x32_bf16 v[168:171], v[72:75], v[36:39], v[168:171]
v_mfma_f32_16x16x32_bf16 v[164:167], v[72:75], v[32:35], v[164:167]
v_mfma_f32_16x16x32_bf16 v[200:203], v[76:79], v[32:35], v[200:203]
v_mfma_f32_16x16x32_bf16 v[204:207], v[76:79], v[36:39], v[204:207]
v_mfma_f32_16x16x32_bf16 v[208:211], v[76:79], v[40:43], v[208:211]
v_mfma_f32_16x16x32_bf16 v[212:215], v[76:79], v[44:47], v[212:215]
v_mfma_f32_16x16x32_bf16 v[216:219], v[76:79], v[48:51], v[216:219]
v_mfma_f32_16x16x32_bf16 v[220:223], v[76:79], v[52:55], v[220:223]
v_mfma_f32_16x16x32_bf16 v[224:227], v[76:79], v[56:59], v[224:227]
v_mfma_f32_16x16x32_bf16 v[228:231], v[76:79], v[60:63], v[228:231]
v_mfma_f32_16x16x32_bf16 v[232:235], v[76:79], v[64:67], v[232:235]
s_waitcnt lgkmcnt(0)
s_barrier
v_mfma_f32_16x16x32_bf16 v[128:131], v[116:119], v[80:83], v[128:131]
ds_read_b128 v[32:35], v2 offset:0
v_mfma_f32_16x16x32_bf16 v[132:135], v[116:119], v[84:87], v[132:135]
ds_read_b64_tr_b16 v[72:73], v6 offset:8192
v_mfma_f32_16x16x32_bf16 v[136:139], v[116:119], v[88:91], v[136:139]
ds_read_b64_tr_b16 v[74:75], v6 offset:8704
v_mfma_f32_16x16x32_bf16 v[140:143], v[116:119], v[92:95], v[140:143]
ds_read_b64_tr_b16 v[76:77], v6 offset:16384
v_mfma_f32_16x16x32_bf16 v[144:147], v[116:119], v[96:99], v[144:147]
ds_read_b64_tr_b16 v[78:79], v6 offset:16896
v_mfma_f32_16x16x32_bf16 v[148:151], v[116:119], v[100:103], v[148:151]
ds_read_b64_tr_b16 v[68:69], v6 offset:0
v_mfma_f32_16x16x32_bf16 v[152:155], v[116:119], v[104:107], v[152:155]
ds_read_b64_tr_b16 v[70:71], v6 offset:512
v_mfma_f32_16x16x32_bf16 v[156:159], v[116:119], v[108:111], v[156:159]
ds_read_b128 v[36:39], v2 offset:2048
v_mfma_f32_16x16x32_bf16 v[160:163], v[116:119], v[112:115], v[160:163]
ds_read_b128 v[40:43], v2 offset:4096
v_mfma_f32_16x16x32_bf16 v[196:199], v[120:123], v[112:115], v[196:199]
ds_read_b128 v[44:47], v2 offset:6144
v_mfma_f32_16x16x32_bf16 v[192:195], v[120:123], v[108:111], v[192:195]
ds_read_b128 v[48:51], v2 offset:8192
v_mfma_f32_16x16x32_bf16 v[188:191], v[120:123], v[104:107], v[188:191]
ds_read_b128 v[52:55], v2 offset:10240
v_mfma_f32_16x16x32_bf16 v[184:187], v[120:123], v[100:103], v[184:187]
ds_read_b128 v[56:59], v2 offset:12288
v_mfma_f32_16x16x32_bf16 v[180:183], v[120:123], v[96:99], v[180:183]
ds_read_b128 v[60:63], v2 offset:14336
v_mfma_f32_16x16x32_bf16 v[176:179], v[120:123], v[92:95], v[176:179]
ds_read_b128 v[64:67], v2 offset:16384
v_mfma_f32_16x16x32_bf16 v[172:175], v[120:123], v[88:91], v[172:175]
v_mfma_f32_16x16x32_bf16 v[168:171], v[120:123], v[84:87], v[168:171]
v_mfma_f32_16x16x32_bf16 v[164:167], v[120:123], v[80:83], v[164:167]
v_mfma_f32_16x16x32_bf16 v[200:203], v[124:127], v[80:83], v[200:203]
v_mfma_f32_16x16x32_bf16 v[204:207], v[124:127], v[84:87], v[204:207]
v_mfma_f32_16x16x32_bf16 v[208:211], v[124:127], v[88:91], v[208:211]
v_mfma_f32_16x16x32_bf16 v[212:215], v[124:127], v[92:95], v[212:215]
v_mfma_f32_16x16x32_bf16 v[216:219], v[124:127], v[96:99], v[216:219]
v_mfma_f32_16x16x32_bf16 v[220:223], v[124:127], v[100:103], v[220:223]
v_mfma_f32_16x16x32_bf16 v[224:227], v[124:127], v[104:107], v[224:227]
v_mfma_f32_16x16x32_bf16 v[228:231], v[124:127], v[108:111], v[228:231]
v_mfma_f32_16x16x32_bf16 v[232:235], v[124:127], v[112:115], v[232:235]
s_mov_b32 s41, 4
Lcl_16:
s_waitcnt lgkmcnt(0)
v_mfma_f32_16x16x32_bf16 v[128:131], v[68:71], v[32:35], v[128:131]
ds_read_b128 v[80:83], v3 offset:0
v_mfma_f32_16x16x32_bf16 v[132:135], v[68:71], v[36:39], v[132:135]
ds_read_b64_tr_b16 v[120:121], v6 offset:12288
v_mfma_f32_16x16x32_bf16 v[136:139], v[68:71], v[40:43], v[136:139]
ds_read_b64_tr_b16 v[122:123], v6 offset:12800
v_mfma_f32_16x16x32_bf16 v[140:143], v[68:71], v[44:47], v[140:143]
ds_read_b64_tr_b16 v[124:125], v6 offset:20480
v_mfma_f32_16x16x32_bf16 v[144:147], v[68:71], v[48:51], v[144:147]
ds_read_b64_tr_b16 v[126:127], v6 offset:20992
v_mfma_f32_16x16x32_bf16 v[148:151], v[68:71], v[52:55], v[148:151]
ds_read_b64_tr_b16 v[116:117], v6 offset:4096
v_mfma_f32_16x16x32_bf16 v[152:155], v[68:71], v[56:59], v[152:155]
ds_read_b64_tr_b16 v[118:119], v6 offset:4608
v_mfma_f32_16x16x32_bf16 v[156:159], v[68:71], v[60:63], v[156:159]
ds_read_b128 v[84:87], v3 offset:2048
v_mfma_f32_16x16x32_bf16 v[160:163], v[68:71], v[64:67], v[160:163]
ds_read_b128 v[88:91], v3 offset:4096
v_mfma_f32_16x16x32_bf16 v[196:199], v[72:75], v[64:67], v[196:199]
ds_read_b128 v[92:95], v3 offset:6144
v_mfma_f32_16x16x32_bf16 v[192:195], v[72:75], v[60:63], v[192:195]
ds_read_b128 v[96:99], v3 offset:8192
v_mfma_f32_16x16x32_bf16 v[188:191], v[72:75], v[56:59], v[188:191]
ds_read_b128 v[100:103], v3 offset:10240
v_mfma_f32_16x16x32_bf16 v[184:187], v[72:75], v[52:55], v[184:187]
ds_read_b128 v[104:107], v3 offset:12288
v_mfma_f32_16x16x32_bf16 v[180:183], v[72:75], v[48:51], v[180:183]
ds_read_b128 v[108:111], v3 offset:14336
v_mfma_f32_16x16x32_bf16 v[176:179], v[72:75], v[44:47], v[176:179]
ds_read_b128 v[112:115], v3 offset:16384
v_mfma_f32_16x16x32_bf16 v[172:175], v[72:75], v[40:43], v[172:175]
v_mfma_f32_16x16x32_bf16 v[168:171], v[72:75], v[36:39], v[168:171]
v_mfma_f32_16x16x32_bf16 v[164:167], v[72:75], v[32:35], v[164:167]
v_mfma_f32_16x16x32_bf16 v[200:203], v[76:79], v[32:35], v[200:203]
v_mfma_f32_16x16x32_bf16 v[204:207], v[76:79], v[36:39], v[204:207]
v_mfma_f32_16x16x32_bf16 v[208:211], v[76:79], v[40:43], v[208:211]
v_mfma_f32_16x16x32_bf16 v[212:215], v[76:79], v[44:47], v[212:215]
v_mfma_f32_16x16x32_bf16 v[216:219], v[76:79], v[48:51], v[216:219]
v_mfma_f32_16x16x32_bf16 v[220:223], v[76:79], v[52:55], v[220:223]
v_mfma_f32_16x16x32_bf16 v[224:227], v[76:79], v[56:59], v[224:227]
v_mfma_f32_16x16x32_bf16 v[228:231], v[76:79], v[60:63], v[228:231]
v_mfma_f32_16x16x32_bf16 v[232:235], v[76:79], v[64:67], v[232:235]
s_waitcnt lgkmcnt(0)
s_barrier
v_mfma_f32_16x16x32_bf16 v[128:131], v[116:119], v[80:83], v[128:131]
s_branch Lov_2
.p2align 12
.fill 16, 4, 0xbf800000
Lst_2_0:
s_branch Lwr_147
s_nop 0
s_nop 0
Lov_2:
ds_read_b128 v[32:35], v2 offset:43008
v_mfma_f32_16x16x32_bf16 v[132:135], v[116:119], v[84:87], v[132:135]
ds_read_b64_tr_b16 v[72:73], v7 offset:8192
v_mfma_f32_16x16x32_bf16 v[136:139], v[116:119], v[88:91], v[136:139]
ds_read_b64_tr_b16 v[74:75], v7 offset:8704
v_mfma_f32_16x16x32_bf16 v[140:143], v[116:119], v[92:95], v[140:143]
ds_read_b64_tr_b16 v[76:77], v7 offset:16384
v_mfma_f32_16x16x32_bf16 v[144:147], v[116:119], v[96:99], v[144:147]
ds_read_b64_tr_b16 v[78:79], v7 offset:16896
v_mfma_f32_16x16x32_bf16 v[148:151], v[116:119], v[100:103], v[148:151]
ds_read_b64_tr_b16 v[68:69], v7 offset:0
v_mfma_f32_16x16x32_bf16 v[152:155], v[116:119], v[104:107], v[152:155]
ds_read_b64_tr_b16 v[70:71], v7 offset:512
v_mfma_f32_16x16x32_bf16 v[156:159], v[116:119], v[108:111], v[156:159]
ds_read_b128 v[36:39], v2 offset:45056
v_mfma_f32_16x16x32_bf16 v[160:163], v[116:119], v[112:115], v[160:163]
ds_read_b128 v[40:43], v2 offset:47104
v_mfma_f32_16x16x32_bf16 v[196:199], v[120:123], v[112:115], v[196:199]
ds_read_b128 v[44:47], v2 offset:49152
v_mfma_f32_16x16x32_bf16 v[192:195], v[120:123], v[108:111], v[192:195]
ds_read_b128 v[48:51], v2 offset:51200
v_mfma_f32_16x16x32_bf16 v[188:191], v[120:123], v[104:107], v[188:191]
ds_read_b128 v[52:55], v2 offset:53248
v_mfma_f32_16x16x32_bf16 v[184:187], v[120:123], v[100:103], v[184:187]
ds_read_b128 v[56:59], v2 offset:55296
v_mfma_f32_16x16x32_bf16 v[180:183], v[120:123], v[96:99], v[180:183]
ds_read_b128 v[60:63], v2 offset:57344
v_mfma_f32_16x16x32_bf16 v[176:179], v[120:123], v[92:95], v[176:179]
ds_read_b128 v[64:67], v2 offset:59392
v_mfma_f32_16x16x32_bf16 v[172:175], v[120:123], v[88:91], v[172:175]
v_mfma_f32_16x16x32_bf16 v[168:171], v[120:123], v[84:87], v[168:171]
v_mfma_f32_16x16x32_bf16 v[164:167], v[120:123], v[80:83], v[164:167]
v_mfma_f32_16x16x32_bf16 v[200:203], v[124:127], v[80:83], v[200:203]
v_mfma_f32_16x16x32_bf16 v[204:207], v[124:127], v[84:87], v[204:207]
v_mfma_f32_16x16x32_bf16 v[208:211], v[124:127], v[88:91], v[208:211]
v_mfma_f32_16x16x32_bf16 v[212:215], v[124:127], v[92:95], v[212:215]
v_mfma_f32_16x16x32_bf16 v[216:219], v[124:127], v[96:99], v[216:219]
v_mfma_f32_16x16x32_bf16 v[220:223], v[124:127], v[100:103], v[220:223]
v_mfma_f32_16x16x32_bf16 v[224:227], v[124:127], v[104:107], v[224:227]
v_mfma_f32_16x16x32_bf16 v[228:231], v[124:127], v[108:111], v[228:231]
v_mfma_f32_16x16x32_bf16 v[232:235], v[124:127], v[112:115], v[232:235]
s_waitcnt lgkmcnt(0)
v_mfma_f32_16x16x32_bf16 v[128:131], v[68:71], v[32:35], v[128:131]
ds_read_b128 v[80:83], v3 offset:43008
v_mfma_f32_16x16x32_bf16 v[132:135], v[68:71], v[36:39], v[132:135]
ds_read_b64_tr_b16 v[120:121], v7 offset:12288
v_mfma_f32_16x16x32_bf16 v[136:139], v[68:71], v[40:43], v[136:139]
ds_read_b64_tr_b16 v[122:123], v7 offset:12800
v_mfma_f32_16x16x32_bf16 v[140:143], v[68:71], v[44:47], v[140:143]
ds_read_b64_tr_b16 v[124:125], v7 offset:20480
v_mfma_f32_16x16x32_bf16 v[144:147], v[68:71], v[48:51], v[144:147]
ds_read_b64_tr_b16 v[126:127], v7 offset:20992
v_mfma_f32_16x16x32_bf16 v[148:151], v[68:71], v[52:55], v[148:151]
ds_read_b64_tr_b16 v[116:117], v7 offset:4096
v_mfma_f32_16x16x32_bf16 v[152:155], v[68:71], v[56:59], v[152:155]
ds_read_b64_tr_b16 v[118:119], v7 offset:4608
v_mfma_f32_16x16x32_bf16 v[156:159], v[68:71], v[60:63], v[156:159]
ds_read_b128 v[84:87], v3 offset:45056
v_mfma_f32_16x16x32_bf16 v[160:163], v[68:71], v[64:67], v[160:163]
ds_read_b128 v[88:91], v3 offset:47104
v_mfma_f32_16x16x32_bf16 v[196:199], v[72:75], v[64:67], v[196:199]
ds_read_b128 v[92:95], v3 offset:49152
v_mfma_f32_16x16x32_bf16 v[192:195], v[72:75], v[60:63], v[192:195]
ds_read_b128 v[96:99], v3 offset:51200
v_mfma_f32_16x16x32_bf16 v[188:191], v[72:75], v[56:59], v[188:191]
ds_read_b128 v[100:103], v3 offset:53248
v_mfma_f32_16x16x32_bf16 v[184:187], v[72:75], v[52:55], v[184:187]
ds_read_b128 v[104:107], v3 offset:55296
v_mfma_f32_16x16x32_bf16 v[180:183], v[72:75], v[48:51], v[180:183]
ds_read_b128 v[108:111], v3 offset:57344
v_mfma_f32_16x16x32_bf16 v[176:179], v[72:75], v[44:47], v[176:179]
ds_read_b128 v[112:115], v3 offset:59392
v_mfma_f32_16x16x32_bf16 v[172:175], v[72:75], v[40:43], v[172:175]
v_mfma_f32_16x16x32_bf16 v[168:171], v[72:75], v[36:39], v[168:171]
v_mfma_f32_16x16x32_bf16 v[164:167], v[72:75], v[32:35], v[164:167]
v_mfma_f32_16x16x32_bf16 v[200:203], v[76:79], v[32:35], v[200:203]
v_mfma_f32_16x16x32_bf16 v[204:207], v[76:79], v[36:39], v[204:207]
v_mfma_f32_16x16x32_bf16 v[208:211], v[76:79], v[40:43], v[208:211]
v_mfma_f32_16x16x32_bf16 v[212:215], v[76:79], v[44:47], v[212:215]
v_mfma_f32_16x16x32_bf16 v[216:219], v[76:79], v[48:51], v[216:219]
v_mfma_f32_16x16x32_bf16 v[220:223], v[76:79], v[52:55], v[220:223]
v_mfma_f32_16x16x32_bf16 v[224:227], v[76:79], v[56:59], v[224:227]
v_mfma_f32_16x16x32_bf16 v[228:231], v[76:79], v[60:63], v[228:231]
v_mfma_f32_16x16x32_bf16 v[232:235], v[76:79], v[64:67], v[232:235]
s_waitcnt lgkmcnt(0)
s_barrier
v_mfma_f32_16x16x32_bf16 v[128:131], v[116:119], v[80:83], v[128:131]
ds_read_b128 v[32:35], v4 offset:0
v_mfma_f32_16x16x32_bf16 v[132:135], v[116:119], v[84:87], v[132:135]
ds_read_b64_tr_b16 v[72:73], v8 offset:8192
v_mfma_f32_16x16x32_bf16 v[136:139], v[116:119], v[88:91], v[136:139]
ds_read_b64_tr_b16 v[74:75], v8 offset:8704
v_mfma_f32_16x16x32_bf16 v[140:143], v[116:119], v[92:95], v[140:143]
ds_read_b64_tr_b16 v[76:77], v8 offset:16384
v_mfma_f32_16x16x32_bf16 v[144:147], v[116:119], v[96:99], v[144:147]
ds_read_b64_tr_b16 v[78:79], v8 offset:16896
v_mfma_f32_16x16x32_bf16 v[148:151], v[116:119], v[100:103], v[148:151]
ds_read_b64_tr_b16 v[68:69], v8 offset:0
v_mfma_f32_16x16x32_bf16 v[152:155], v[116:119], v[104:107], v[152:155]
ds_read_b64_tr_b16 v[70:71], v8 offset:512
v_mfma_f32_16x16x32_bf16 v[156:159], v[116:119], v[108:111], v[156:159]
ds_read_b128 v[36:39], v4 offset:2048
v_mfma_f32_16x16x32_bf16 v[160:163], v[116:119], v[112:115], v[160:163]
ds_read_b128 v[40:43], v4 offset:4096
v_mfma_f32_16x16x32_bf16 v[196:199], v[120:123], v[112:115], v[196:199]
ds_read_b128 v[44:47], v4 offset:6144
v_mfma_f32_16x16x32_bf16 v[192:195], v[120:123], v[108:111], v[192:195]
ds_read_b128 v[48:51], v4 offset:8192
v_mfma_f32_16x16x32_bf16 v[188:191], v[120:123], v[104:107], v[188:191]
ds_read_b128 v[52:55], v4 offset:10240
v_mfma_f32_16x16x32_bf16 v[184:187], v[120:123], v[100:103], v[184:187]
ds_read_b128 v[56:59], v4 offset:12288
v_mfma_f32_16x16x32_bf16 v[180:183], v[120:123], v[96:99], v[180:183]
ds_read_b128 v[60:63], v4 offset:14336
v_mfma_f32_16x16x32_bf16 v[176:179], v[120:123], v[92:95], v[176:179]
ds_read_b128 v[64:67], v4 offset:16384
v_mfma_f32_16x16x32_bf16 v[172:175], v[120:123], v[88:91], v[172:175]
v_mfma_f32_16x16x32_bf16 v[168:171], v[120:123], v[84:87], v[168:171]
v_mfma_f32_16x16x32_bf16 v[164:167], v[120:123], v[80:83], v[164:167]
v_mfma_f32_16x16x32_bf16 v[200:203], v[124:127], v[80:83], v[200:203]
v_mfma_f32_16x16x32_bf16 v[204:207], v[124:127], v[84:87], v[204:207]
v_mfma_f32_16x16x32_bf16 v[208:211], v[124:127], v[88:91], v[208:211]
v_mfma_f32_16x16x32_bf16 v[212:215], v[124:127], v[92:95], v[212:215]
v_mfma_f32_16x16x32_bf16 v[216:219], v[124:127], v[96:99], v[216:219]
v_mfma_f32_16x16x32_bf16 v[220:223], v[124:127], v[100:103], v[220:223]
v_mfma_f32_16x16x32_bf16 v[224:227], v[124:127], v[104:107], v[224:227]
v_mfma_f32_16x16x32_bf16 v[228:231], v[124:127], v[108:111], v[228:231]
v_mfma_f32_16x16x32_bf16 v[232:235], v[124:127], v[112:115], v[232:235]
s_waitcnt lgkmcnt(0)
v_mfma_f32_16x16x32_bf16 v[128:131], v[68:71], v[32:35], v[128:131]
ds_read_b128 v[80:83], v5 offset:0
v_mfma_f32_16x16x32_bf16 v[132:135], v[68:71], v[36:39], v[132:135]
ds_read_b64_tr_b16 v[120:121], v8 offset:12288
v_mfma_f32_16x16x32_bf16 v[136:139], v[68:71], v[40:43], v[136:139]
ds_read_b64_tr_b16 v[122:123], v8 offset:12800
v_mfma_f32_16x16x32_bf16 v[140:143], v[68:71], v[44:47], v[140:143]
ds_read_b64_tr_b16 v[124:125], v8 offset:20480
v_mfma_f32_16x16x32_bf16 v[144:147], v[68:71], v[48:51], v[144:147]
ds_read_b64_tr_b16 v[126:127], v8 offset:20992
v_mfma_f32_16x16x32_bf16 v[148:151], v[68:71], v[52:55], v[148:151]
ds_read_b64_tr_b16 v[116:117], v8 offset:4096
v_mfma_f32_16x16x32_bf16 v[152:155], v[68:71], v[56:59], v[152:155]
ds_read_b64_tr_b16 v[118:119], v8 offset:4608
v_mfma_f32_16x16x32_bf16 v[156:159], v[68:71], v[60:63], v[156:159]
ds_read_b128 v[84:87], v5 offset:2048
v_mfma_f32_16x16x32_bf16 v[160:163], v[68:71], v[64:67], v[160:163]
ds_read_b128 v[88:91], v5 offset:4096
v_mfma_f32_16x16x32_bf16 v[196:199], v[72:75], v[64:67], v[196:199]
ds_read_b128 v[92:95], v5 offset:6144
v_mfma_f32_16x16x32_bf16 v[192:195], v[72:75], v[60:63], v[192:195]
ds_read_b128 v[96:99], v5 offset:8192
v_mfma_f32_16x16x32_bf16 v[188:191], v[72:75], v[56:59], v[188:191]
ds_read_b128 v[100:103], v5 offset:10240
v_mfma_f32_16x16x32_bf16 v[184:187], v[72:75], v[52:55], v[184:187]
ds_read_b128 v[104:107], v5 offset:12288
v_mfma_f32_16x16x32_bf16 v[180:183], v[72:75], v[48:51], v[180:183]
ds_read_b128 v[108:111], v5 offset:14336
v_mfma_f32_16x16x32_bf16 v[176:179], v[72:75], v[44:47], v[176:179]
ds_read_b128 v[112:115], v5 offset:16384
v_mfma_f32_16x16x32_bf16 v[172:175], v[72:75], v[40:43], v[172:175]
v_mfma_f32_16x16x32_bf16 v[168:171], v[72:75], v[36:39], v[168:171]
v_mfma_f32_16x16x32_bf16 v[164:167], v[72:75], v[32:35], v[164:167]
v_mfma_f32_16x16x32_bf16 v[200:203], v[76:79], v[32:35], v[200:203]
v_mfma_f32_16x16x32_bf16 v[204:207], v[76:79], v[36:39], v[204:207]
v_mfma_f32_16x16x32_bf16 v[208:211], v[76:79], v[40:43], v[208:211]
v_mfma_f32_16x16x32_bf16 v[212:215], v[76:79], v[44:47], v[212:215]
v_mfma_f32_16x16x32_bf16 v[216:219], v[76:79], v[48:51], v[216:219]
v_mfma_f32_16x16x32_bf16 v[220:223], v[76:79], v[52:55], v[220:223]
v_mfma_f32_16x16x32_bf16 v[224:227], v[76:79], v[56:59], v[224:227]
v_mfma_f32_16x16x32_bf16 v[228:231], v[76:79], v[60:63], v[228:231]
v_mfma_f32_16x16x32_bf16 v[232:235], v[76:79], v[64:67], v[232:235]
s_waitcnt lgkmcnt(0)
s_barrier
v_mfma_f32_16x16x32_bf16 v[128:131], v[116:119], v[80:83], v[128:131]
ds_read_b128 v[32:35], v2 offset:0
v_mfma_f32_16x16x32_bf16 v[132:135], v[116:119], v[84:87], v[132:135]
ds_read_b64_tr_b16 v[72:73], v6 offset:8192
v_mfma_f32_16x16x32_bf16 v[136:139], v[116:119], v[88:91], v[136:139]
ds_read_b64_tr_b16 v[74:75], v6 offset:8704
v_mfma_f32_16x16x32_bf16 v[140:143], v[116:119], v[92:95], v[140:143]
ds_read_b64_tr_b16 v[76:77], v6 offset:16384
v_mfma_f32_16x16x32_bf16 v[144:147], v[116:119], v[96:99], v[144:147]
ds_read_b64_tr_b16 v[78:79], v6 offset:16896
v_mfma_f32_16x16x32_bf16 v[148:151], v[116:119], v[100:103], v[148:151]
ds_read_b64_tr_b16 v[68:69], v6 offset:0
v_mfma_f32_16x16x32_bf16 v[152:155], v[116:119], v[104:107], v[152:155]
ds_read_b64_tr_b16 v[70:71], v6 offset:512
v_mfma_f32_16x16x32_bf16 v[156:159], v[116:119], v[108:111], v[156:159]
ds_read_b128 v[36:39], v2 offset:2048
v_mfma_f32_16x16x32_bf16 v[160:163], v[116:119], v[112:115], v[160:163]
ds_read_b128 v[40:43], v2 offset:4096
v_mfma_f32_16x16x32_bf16 v[196:199], v[120:123], v[112:115], v[196:199]
ds_read_b128 v[44:47], v2 offset:6144
v_mfma_f32_16x16x32_bf16 v[192:195], v[120:123], v[108:111], v[192:195]
ds_read_b128 v[48:51], v2 offset:8192
v_mfma_f32_16x16x32_bf16 v[188:191], v[120:123], v[104:107], v[188:191]
ds_read_b128 v[52:55], v2 offset:10240
v_mfma_f32_16x16x32_bf16 v[184:187], v[120:123], v[100:103], v[184:187]
ds_read_b128 v[56:59], v2 offset:12288
v_mfma_f32_16x16x32_bf16 v[180:183], v[120:123], v[96:99], v[180:183]
ds_read_b128 v[60:63], v2 offset:14336
v_mfma_f32_16x16x32_bf16 v[176:179], v[120:123], v[92:95], v[176:179]
ds_read_b128 v[64:67], v2 offset:16384
v_mfma_f32_16x16x32_bf16 v[172:175], v[120:123], v[88:91], v[172:175]
v_mfma_f32_16x16x32_bf16 v[168:171], v[120:123], v[84:87], v[168:171]
v_mfma_f32_16x16x32_bf16 v[164:167], v[120:123], v[80:83], v[164:167]
v_mfma_f32_16x16x32_bf16 v[200:203], v[124:127], v[80:83], v[200:203]
v_mfma_f32_16x16x32_bf16 v[204:207], v[124:127], v[84:87], v[204:207]
v_mfma_f32_16x16x32_bf16 v[208:211], v[124:127], v[88:91], v[208:211]
v_mfma_f32_16x16x32_bf16 v[212:215], v[124:127], v[92:95], v[212:215]
v_mfma_f32_16x16x32_bf16 v[216:219], v[124:127], v[96:99], v[216:219]
v_mfma_f32_16x16x32_bf16 v[220:223], v[124:127], v[100:103], v[220:223]
v_mfma_f32_16x16x32_bf16 v[224:227], v[124:127], v[104:107], v[224:227]
v_mfma_f32_16x16x32_bf16 v[228:231], v[124:127], v[108:111], v[228:231]
v_mfma_f32_16x16x32_bf16 v[232:235], v[124:127], v[112:115], v[232:235]
s_sub_u32 s41, s41, 1
s_cmp_lg_u32 s41, 0
s_cbranch_scc1 Lcl_16
s_waitcnt lgkmcnt(0)
v_mfma_f32_16x16x32_bf16 v[128:131], v[68:71], v[32:35], v[128:131]
ds_read_b128 v[80:83], v3 offset:0
v_mfma_f32_16x16x32_bf16 v[132:135], v[68:71], v[36:39], v[132:135]
ds_read_b64_tr_b16 v[120:121], v6 offset:12288
v_mfma_f32_16x16x32_bf16 v[136:139], v[68:71], v[40:43], v[136:139]
ds_read_b64_tr_b16 v[122:123], v6 offset:12800
v_mfma_f32_16x16x32_bf16 v[140:143], v[68:71], v[44:47], v[140:143]
ds_read_b64_tr_b16 v[124:125], v6 offset:20480
v_mfma_f32_16x16x32_bf16 v[144:147], v[68:71], v[48:51], v[144:147]
ds_read_b64_tr_b16 v[126:127], v6 offset:20992
v_mfma_f32_16x16x32_bf16 v[148:151], v[68:71], v[52:55], v[148:151]
ds_read_b64_tr_b16 v[116:117], v6 offset:4096
v_mfma_f32_16x16x32_bf16 v[152:155], v[68:71], v[56:59], v[152:155]
ds_read_b64_tr_b16 v[118:119], v6 offset:4608
v_mfma_f32_16x16x32_bf16 v[156:159], v[68:71], v[60:63], v[156:159]
ds_read_b128 v[84:87], v3 offset:2048
v_mfma_f32_16x16x32_bf16 v[160:163], v[68:71], v[64:67], v[160:163]
ds_read_b128 v[88:91], v3 offset:4096
v_mfma_f32_16x16x32_bf16 v[196:199], v[72:75], v[64:67], v[196:199]
ds_read_b128 v[92:95], v3 offset:6144
v_mfma_f32_16x16x32_bf16 v[192:195], v[72:75], v[60:63], v[192:195]
ds_read_b128 v[96:99], v3 offset:8192
v_mfma_f32_16x16x32_bf16 v[188:191], v[72:75], v[56:59], v[188:191]
ds_read_b128 v[100:103], v3 offset:10240
v_mfma_f32_16x16x32_bf16 v[184:187], v[72:75], v[52:55], v[184:187]
ds_read_b128 v[104:107], v3 offset:12288
v_mfma_f32_16x16x32_bf16 v[180:183], v[72:75], v[48:51], v[180:183]
ds_read_b128 v[108:111], v3 offset:14336
v_mfma_f32_16x16x32_bf16 v[176:179], v[72:75], v[44:47], v[176:179]
ds_read_b128 v[112:115], v3 offset:16384
v_mfma_f32_16x16x32_bf16 v[172:175], v[72:75], v[40:43], v[172:175]
v_mfma_f32_16x16x32_bf16 v[168:171], v[72:75], v[36:39], v[168:171]
v_mfma_f32_16x16x32_bf16 v[164:167], v[72:75], v[32:35], v[164:167]
v_mfma_f32_16x16x32_bf16 v[200:203], v[76:79], v[32:35], v[200:203]
v_mfma_f32_16x16x32_bf16 v[204:207], v[76:79], v[36:39], v[204:207]
v_mfma_f32_16x16x32_bf16 v[208:211], v[76:79], v[40:43], v[208:211]
v_mfma_f32_16x16x32_bf16 v[212:215], v[76:79], v[44:47], v[212:215]
v_mfma_f32_16x16x32_bf16 v[216:219], v[76:79], v[48:51], v[216:219]
v_mfma_f32_16x16x32_bf16 v[220:223], v[76:79], v[52:55], v[220:223]
v_mfma_f32_16x16x32_bf16 v[224:227], v[76:79], v[56:59], v[224:227]
v_mfma_f32_16x16x32_bf16 v[228:231], v[76:79], v[60:63], v[228:231]
v_mfma_f32_16x16x32_bf16 v[232:235], v[76:79], v[64:67], v[232:235]
s_waitcnt lgkmcnt(0)
v_mfma_f32_16x16x32_bf16 v[128:131], v[116:119], v[80:83], v[128:131]
v_mfma_f32_16x16x32_bf16 v[132:135], v[116:119], v[84:87], v[132:135]
v_mfma_f32_16x16x32_bf16 v[136:139], v[116:119], v[88:91], v[136:139]
v_mfma_f32_16x16x32_bf16 v[140:143], v[116:119], v[92:95], v[140:143]
v_mfma_f32_16x16x32_bf16 v[144:147], v[116:119], v[96:99], v[144:147]
v_mfma_f32_16x16x32_bf16 v[148:151], v[116:119], v[100:103], v[148:151]
v_mfma_f32_16x16x32_bf16 v[152:155], v[116:119], v[104:107], v[152:155]
v_mfma_f32_16x16x32_bf16 v[156:159], v[116:119], v[108:111], v[156:159]
v_mfma_f32_16x16x32_bf16 v[160:163], v[116:119], v[112:115], v[160:163]
v_mfma_f32_16x16x32_bf16 v[196:199], v[120:123], v[112:115], v[196:199]
v_mfma_f32_16x16x32_bf16 v[192:195], v[120:123], v[108:111], v[192:195]
v_mfma_f32_16x16x32_bf16 v[188:191], v[120:123], v[104:107], v[188:191]
v_mfma_f32_16x16x32_bf16 v[184:187], v[120:123], v[100:103], v[184:187]
v_mfma_f32_16x16x32_bf16 v[180:183], v[120:123], v[96:99], v[180:183]
v_mfma_f32_16x16x32_bf16 v[176:179], v[120:123], v[92:95], v[176:179]
v_mfma_f32_16x16x32_bf16 v[172:175], v[120:123], v[88:91], v[172:175]
v_mfma_f32_16x16x32_bf16 v[168:171], v[120:123], v[84:87], v[168:171]
v_mfma_f32_16x16x32_bf16 v[164:167], v[120:123], v[80:83], v[164:167]
v_mfma_f32_16x16x32_bf16 v[200:203], v[124:127], v[80:83], v[200:203]
v_mfma_f32_16x16x32_bf16 v[204:207], v[124:127], v[84:87], v[204:207]
v_mfma_f32_16x16x32_bf16 v[208:211], v[124:127], v[88:91], v[208:211]
v_mfma_f32_16x16x32_bf16 v[212:215], v[124:127], v[92:95], v[212:215]
v_mfma_f32_16x16x32_bf16 v[216:219], v[124:127], v[96:99], v[216:219]
v_mfma_f32_16x16x32_bf16 v[220:223], v[124:127], v[100:103], v[220:223]
v_mfma_f32_16x16x32_bf16 v[224:227], v[124:127], v[104:107], v[224:227]
v_mfma_f32_16x16x32_bf16 v[228:231], v[124:127], v[108:111], v[228:231]
v_mfma_f32_16x16x32_bf16 v[232:235], v[124:127], v[112:115], v[232:235]
Lepi:
v_lshlrev_b32 v14, 3, v12
v_add_u32 v14, 147456, v14
v_mul_u32_u24 v15, 400, v12
v_lshl_add_u32 v15, v13, 3, v15
s_lshl_b32 s43, s36, 5
v_add_u32 v15, s43, v15
s_barrier
ds_read_b64 v[32:33], v14 offset:0
ds_read_b64 v[34:35], v14 offset:128
ds_read_b64 v[36:37], v14 offset:256
ds_read_b64 v[38:39], v14 offset:384
ds_read_b64 v[40:41], v14 offset:512
ds_read_b64 v[42:43], v14 offset:640
ds_read_b64 v[44:45], v14 offset:768
ds_read_b64 v[46:47], v14 offset:896
ds_read_b64 v[48:49], v14 offset:1024
v_mov_b32_dpp v52, v128 row_newbcast:0 row_mask:0xf bank_mask:0xf
v_mov_b32_dpp v53, v129 row_newbcast:0 row_mask:0xf bank_mask:0xf
v_mov_b32_dpp v54, v130 row_newbcast:0 row_mask:0xf bank_mask:0xf
v_mov_b32_dpp v55, v131 row_newbcast:0 row_mask:0xf bank_mask:0xf
v_mov_b32_dpp v56, v164 row_newbcast:0 row_mask:0xf bank_mask:0xf
v_mov_b32_dpp v57, v165 row_newbcast:0 row_mask:0xf bank_mask:0xf
v_mov_b32_dpp v58, v166 row_newbcast:0 row_mask:0xf bank_mask:0xf
v_mov_b32_dpp v59, v167 row_newbcast:0 row_mask:0xf bank_mask:0xf
v_mov_b32_dpp v60, v200 row_newbcast:0 row_mask:0xf bank_mask:0xf
v_mov_b32_dpp v61, v201 row_newbcast:0 row_mask:0xf bank_mask:0xf
v_mov_b32_dpp v62, v202 row_newbcast:0 row_mask:0xf bank_mask:0xf
v_mov_b32_dpp v63, v203 row_newbcast:0 row_mask:0xf bank_mask:0xf
s_waitcnt lgkmcnt(0)
v_pk_fma_f32 v[164:165], v[32:33], v[56:57], v[164:165] op_sel_hi:[0,1,1] neg_lo:[1,0,0] neg_hi:[1,0,0]
v_pk_fma_f32 v[166:167], v[32:33], v[58:59], v[166:167] op_sel_hi:[0,1,1] neg_lo:[1,0,0] neg_hi:[1,0,0]
v_pk_fma_f32 v[200:201], v[32:33], v[60:61], v[200:201] op_sel_hi:[0,1,1] neg_lo:[1,0,0] neg_hi:[1,0,0]
v_pk_fma_f32 v[202:203], v[32:33], v[62:63], v[202:203] op_sel_hi:[0,1,1] neg_lo:[1,0,0] neg_hi:[1,0,0]
v_pk_mul_f32 v[164:165], v[32:33], v[164:165] op_sel:[1,0] op_sel_hi:[1,1]
v_pk_mul_f32 v[166:167], v[32:33], v[166:167] op_sel:[1,0] op_sel_hi:[1,1]
v_pk_fma_f32 v[132:133], v[34:35], v[52:53], v[132:133] op_sel_hi:[0,1,1] neg_lo:[1,0,0] neg_hi:[1,0,0]
v_pk_fma_f32 v[134:135], v[34:35], v[54:55], v[134:135] op_sel_hi:[0,1,1] neg_lo:[1,0,0] neg_hi:[1,0,0]
v_pk_mul_f32 v[200:201], v[32:33], v[200:201] op_sel:[1,0] op_sel_hi:[1,1]
v_pk_mul_f32 v[202:203], v[32:33], v[202:203] op_sel:[1,0] op_sel_hi:[1,1]
v_cvt_pk_bf16_f32 v164, v164, v165
v_cvt_pk_bf16_f32 v165, v166, v167
ds_write_b64 v15, v[164:165] offset:128
v_pk_fma_f32 v[168:169], v[34:35], v[56:57], v[168:169] op_sel_hi:[0,1,1] neg_lo:[1,0,0] neg_hi:[1,0,0]
v_pk_fma_f32 v[170:171], v[34:35], v[58:59], v[170:171] op_sel_hi:[0,1,1] neg_lo:[1,0,0] neg_hi:[1,0,0]
v_pk_mul_f32 v[132:133], v[34:35], v[132:133] op_sel:[1,0] op_sel_hi:[1,1]
v_pk_mul_f32 v[134:135], v[34:35], v[134:135] op_sel:[1,0] op_sel_hi:[1,1]
v_cvt_pk_bf16_f32 v200, v200, v201
v_cvt_pk_bf16_f32 v201, v202, v203
ds_write_b64 v15, v[200:201] offset:256
v_pk_fma_f32 v[204:205], v[34:35], v[60:61], v[204:205] op_sel_hi:[0,1,1] neg_lo:[1,0,0] neg_hi:[1,0,0]
v_pk_fma_f32 v[206:207], v[34:35], v[62:63], v[206:207] op_sel_hi:[0,1,1] neg_lo:[1,0,0] neg_hi:[1,0,0]
v_pk_mul_f32 v[168:169], v[34:35], v[168:169] op_sel:[1,0] op_sel_hi:[1,1]
v_pk_mul_f32 v[170:171], v[34:35], v[170:171] op_sel:[1,0] op_sel_hi:[1,1]
v_cvt_pk_bf16_f32 v132, v132, v133
v_cvt_pk_bf16_f32 v133, v134, v135
ds_write_b64 v15, v[132:133] offset:6400
v_pk_fma_f32 v[136:137], v[36:37], v[52:53], v[136:137] op_sel_hi:[0,1,1] neg_lo:[1,0,0] neg_hi:[1,0,0]
v_pk_fma_f32 v[138:139], v[36:37], v[54:55], v[138:139] op_sel_hi:[0,1,1] neg_lo:[1,0,0] neg_hi:[1,0,0]
v_pk_mul_f32 v[204:205], v[34:35], v[204:205] op_sel:[1,0] op_sel_hi:[1,1]
v_pk_mul_f32 v[206:207], v[34:35], v[206:207] op_sel:[1,0] op_sel_hi:[1,1]
v_cvt_pk_bf16_f32 v168, v168, v169
v_cvt_pk_bf16_f32 v169, v170, v171
ds_write_b64 v15, v[168:169] offset:6528
v_pk_fma_f32 v[172:173], v[36:37], v[56:57], v[172:173] op_sel_hi:[0,1,1] neg_lo:[1,0,0] neg_hi:[1,0,0]
v_pk_fma_f32 v[174:175], v[36:37], v[58:59], v[174:175] op_sel_hi:[0,1,1] neg_lo:[1,0,0] neg_hi:[1,0,0]
v_pk_mul_f32 v[136:137], v[36:37], v[136:137] op_sel:[1,0] op_sel_hi:[1,1]
v_pk_mul_f32 v[138:139], v[36:37], v[138:139] op_sel:[1,0] op_sel_hi:[1,1]
v_cvt_pk_bf16_f32 v204, v204, v205
v_cvt_pk_bf16_f32 v205, v206, v207
ds_write_b64 v15, v[204:205] offset:6656
v_pk_fma_f32 v[208:209], v[36:37], v[60:61], v[208:209] op_sel_hi:[0,1,1] neg_lo:[1,0,0] neg_hi:[1,0,0]
v_pk_fma_f32 v[210:211], v[36:37], v[62:63], v[210:211] op_sel_hi:[0,1,1] neg_lo:[1,0,0] neg_hi:[1,0,0]
v_pk_mul_f32 v[172:173], v[36:37], v[172:173] op_sel:[1,0] op_sel_hi:[1,1]
v_pk_mul_f32 v[174:175], v[36:37], v[174:175] op_sel:[1,0] op_sel_hi:[1,1]
v_cvt_pk_bf16_f32 v136, v136, v137
v_cvt_pk_bf16_f32 v137, v138, v139
ds_write_b64 v15, v[136:137] offset:12800
v_pk_fma_f32 v[140:141], v[38:39], v[52:53], v[140:141] op_sel_hi:[0,1,1] neg_lo:[1,0,0] neg_hi:[1,0,0]
v_pk_fma_f32 v[142:143], v[38:39], v[54:55], v[142:143] op_sel_hi:[0,1,1] neg_lo:[1,0,0] neg_hi:[1,0,0]
v_pk_mul_f32 v[208:209], v[36:37], v[208:209] op_sel:[1,0] op_sel_hi:[1,1]
v_pk_mul_f32 v[210:211], v[36:37], v[210:211] op_sel:[1,0] op_sel_hi:[1,1]
v_cvt_pk_bf16_f32 v172, v172, v173
v_cvt_pk_bf16_f32 v173, v174, v175
ds_write_b64 v15, v[172:173] offset:12928
v_pk_fma_f32 v[176:177], v[38:39], v[56:57], v[176:177] op_sel_hi:[0,1,1] neg_lo:[1,0,0] neg_hi:[1,0,0]
v_pk_fma_f32 v[178:179], v[38:39], v[58:59], v[178:179] op_sel_hi:[0,1,1] neg_lo:[1,0,0] neg_hi:[1,0,0]
v_pk_mul_f32 v[140:141], v[38:39], v[140:141] op_sel:[1,0] op_sel_hi:[1,1]
v_pk_mul_f32 v[142:143], v[38:39], v[142:143] op_sel:[1,0] op_sel_hi:[1,1]
v_cvt_pk_bf16_f32 v208, v208, v209
v_cvt_pk_bf16_f32 v209, v210, v211
ds_write_b64 v15, v[208:209] offset:13056
v_pk_fma_f32 v[212:213], v[38:39], v[60:61], v[212:213] op_sel_hi:[0,1,1] neg_lo:[1,0,0] neg_hi:[1,0,0]
v_pk_fma_f32 v[214:215], v[38:39], v[62:63], v[214:215] op_sel_hi:[0,1,1] neg_lo:[1,0,0] neg_hi:[1,0,0]
v_pk_mul_f32 v[176:177], v[38:39], v[176:177] op_sel:[1,0] op_sel_hi:[1,1]
v_pk_mul_f32 v[178:179], v[38:39], v[178:179] op_sel:[1,0] op_sel_hi:[1,1]
v_cvt_pk_bf16_f32 v140, v140, v141
v_cvt_pk_bf16_f32 v141, v142, v143
ds_write_b64 v15, v[140:141] offset:19200
v_pk_fma_f32 v[144:145], v[40:41], v[52:53], v[144:145] op_sel_hi:[0,1,1] neg_lo:[1,0,0] neg_hi:[1,0,0]
v_pk_fma_f32 v[146:147], v[40:41], v[54:55], v[146:147] op_sel_hi:[0,1,1] neg_lo:[1,0,0] neg_hi:[1,0,0]
v_pk_mul_f32 v[212:213], v[38:39], v[212:213] op_sel:[1,0] op_sel_hi:[1,1]
v_pk_mul_f32 v[214:215], v[38:39], v[214:215] op_sel:[1,0] op_sel_hi:[1,1]
v_cvt_pk_bf16_f32 v176, v176, v177
v_cvt_pk_bf16_f32 v177, v178, v179
ds_write_b64 v15, v[176:177] offset:19328
v_pk_fma_f32 v[180:181], v[40:41], v[56:57], v[180:181] op_sel_hi:[0,1,1] neg_lo:[1,0,0] neg_hi:[1,0,0]
v_pk_fma_f32 v[182:183], v[40:41], v[58:59], v[182:183] op_sel_hi:[0,1,1] neg_lo:[1,0,0] neg_hi:[1,0,0]
v_pk_mul_f32 v[144:145], v[40:41], v[144:145] op_sel:[1,0] op_sel_hi:[1,1]
v_pk_mul_f32 v[146:147], v[40:41], v[146:147] op_sel:[1,0] op_sel_hi:[1,1]
v_cvt_pk_bf16_f32 v212, v212, v213
v_cvt_pk_bf16_f32 v213, v214, v215
ds_write_b64 v15, v[212:213] offset:19456
v_pk_fma_f32 v[216:217], v[40:41], v[60:61], v[216:217] op_sel_hi:[0,1,1] neg_lo:[1,0,0] neg_hi:[1,0,0]
v_pk_fma_f32 v[218:219], v[40:41], v[62:63], v[218:219] op_sel_hi:[0,1,1] neg_lo:[1,0,0] neg_hi:[1,0,0]
v_pk_mul_f32 v[180:181], v[40:41], v[180:181] op_sel:[1,0] op_sel_hi:[1,1]
v_pk_mul_f32 v[182:183], v[40:41], v[182:183] op_sel:[1,0] op_sel_hi:[1,1]
v_cvt_pk_bf16_f32 v144, v144, v145
v_cvt_pk_bf16_f32 v145, v146, v147
ds_write_b64 v15, v[144:145] offset:25600
v_pk_fma_f32 v[148:149], v[42:43], v[52:53], v[148:149] op_sel_hi:[0,1,1] neg_lo:[1,0,0] neg_hi:[1,0,0]
v_pk_fma_f32 v[150:151], v[42:43], v[54:55], v[150:151] op_sel_hi:[0,1,1] neg_lo:[1,0,0] neg_hi:[1,0,0]
v_pk_mul_f32 v[216:217], v[40:41], v[216:217] op_sel:[1,0] op_sel_hi:[1,1]
v_pk_mul_f32 v[218:219], v[40:41], v[218:219] op_sel:[1,0] op_sel_hi:[1,1]
v_cvt_pk_bf16_f32 v180, v180, v181
v_cvt_pk_bf16_f32 v181, v182, v183
ds_write_b64 v15, v[180:181] offset:25728
v_pk_fma_f32 v[184:185], v[42:43], v[56:57], v[184:185] op_sel_hi:[0,1,1] neg_lo:[1,0,0] neg_hi:[1,0,0]
v_pk_fma_f32 v[186:187], v[42:43], v[58:59], v[186:187] op_sel_hi:[0,1,1] neg_lo:[1,0,0] neg_hi:[1,0,0]
v_pk_mul_f32 v[148:149], v[42:43], v[148:149] op_sel:[1,0] op_sel_hi:[1,1]
v_pk_mul_f32 v[150:151], v[42:43], v[150:151] op_sel:[1,0] op_sel_hi:[1,1]
v_cvt_pk_bf16_f32 v216, v216, v217
v_cvt_pk_bf16_f32 v217, v218, v219
ds_write_b64 v15, v[216:217] offset:25856
v_pk_fma_f32 v[220:221], v[42:43], v[60:61], v[220:221] op_sel_hi:[0,1,1] neg_lo:[1,0,0] neg_hi:[1,0,0]
v_pk_fma_f32 v[222:223], v[42:43], v[62:63], v[222:223] op_sel_hi:[0,1,1] neg_lo:[1,0,0] neg_hi:[1,0,0]
v_pk_mul_f32 v[184:185], v[42:43], v[184:185] op_sel:[1,0] op_sel_hi:[1,1]
v_pk_mul_f32 v[186:187], v[42:43], v[186:187] op_sel:[1,0] op_sel_hi:[1,1]
v_cvt_pk_bf16_f32 v148, v148, v149
v_cvt_pk_bf16_f32 v149, v150, v151
ds_write_b64 v15, v[148:149] offset:32000
v_pk_fma_f32 v[152:153], v[44:45], v[52:53], v[152:153] op_sel_hi:[0,1,1] neg_lo:[1,0,0] neg_hi:[1,0,0]
v_pk_fma_f32 v[154:155], v[44:45], v[54:55], v[154:155] op_sel_hi:[0,1,1] neg_lo:[1,0,0] neg_hi:[1,0,0]
v_pk_mul_f32 v[220:221], v[42:43], v[220:221] op_sel:[1,0] op_sel_hi:[1,1]
v_pk_mul_f32 v[222:223], v[42:43], v[222:223] op_sel:[1,0] op_sel_hi:[1,1]
v_cvt_pk_bf16_f32 v184, v184, v185
v_cvt_pk_bf16_f32 v185, v186, v187
ds_write_b64 v15, v[184:185] offset:32128
v_pk_fma_f32 v[188:189], v[44:45], v[56:57], v[188:189] op_sel_hi:[0,1,1] neg_lo:[1,0,0] neg_hi:[1,0,0]
v_pk_fma_f32 v[190:191], v[44:45], v[58:59], v[190:191] op_sel_hi:[0,1,1] neg_lo:[1,0,0] neg_hi:[1,0,0]
v_pk_mul_f32 v[152:153], v[44:45], v[152:153] op_sel:[1,0] op_sel_hi:[1,1]
v_pk_mul_f32 v[154:155], v[44:45], v[154:155] op_sel:[1,0] op_sel_hi:[1,1]
v_cvt_pk_bf16_f32 v220, v220, v221
v_cvt_pk_bf16_f32 v221, v222, v223
ds_write_b64 v15, v[220:221] offset:32256
v_pk_fma_f32 v[224:225], v[44:45], v[60:61], v[224:225] op_sel_hi:[0,1,1] neg_lo:[1,0,0] neg_hi:[1,0,0]
v_pk_fma_f32 v[226:227], v[44:45], v[62:63], v[226:227] op_sel_hi:[0,1,1] neg_lo:[1,0,0] neg_hi:[1,0,0]
v_pk_mul_f32 v[188:189], v[44:45], v[188:189] op_sel:[1,0] op_sel_hi:[1,1]
v_pk_mul_f32 v[190:191], v[44:45], v[190:191] op_sel:[1,0] op_sel_hi:[1,1]
v_cvt_pk_bf16_f32 v152, v152, v153
v_cvt_pk_bf16_f32 v153, v154, v155
ds_write_b64 v15, v[152:153] offset:38400
v_pk_fma_f32 v[156:157], v[46:47], v[52:53], v[156:157] op_sel_hi:[0,1,1] neg_lo:[1,0,0] neg_hi:[1,0,0]
v_pk_fma_f32 v[158:159], v[46:47], v[54:55], v[158:159] op_sel_hi:[0,1,1] neg_lo:[1,0,0] neg_hi:[1,0,0]
v_pk_mul_f32 v[224:225], v[44:45], v[224:225] op_sel:[1,0] op_sel_hi:[1,1]
v_pk_mul_f32 v[226:227], v[44:45], v[226:227] op_sel:[1,0] op_sel_hi:[1,1]
v_cvt_pk_bf16_f32 v188, v188, v189
v_cvt_pk_bf16_f32 v189, v190, v191
ds_write_b64 v15, v[188:189] offset:38528
v_pk_fma_f32 v[192:193], v[46:47], v[56:57], v[192:193] op_sel_hi:[0,1,1] neg_lo:[1,0,0] neg_hi:[1,0,0]
v_pk_fma_f32 v[194:195], v[46:47], v[58:59], v[194:195] op_sel_hi:[0,1,1] neg_lo:[1,0,0] neg_hi:[1,0,0]
v_pk_mul_f32 v[156:157], v[46:47], v[156:157] op_sel:[1,0] op_sel_hi:[1,1]
v_pk_mul_f32 v[158:159], v[46:47], v[158:159] op_sel:[1,0] op_sel_hi:[1,1]
v_cvt_pk_bf16_f32 v224, v224, v225
v_cvt_pk_bf16_f32 v225, v226, v227
ds_write_b64 v15, v[224:225] offset:38656
v_pk_fma_f32 v[228:229], v[46:47], v[60:61], v[228:229] op_sel_hi:[0,1,1] neg_lo:[1,0,0] neg_hi:[1,0,0]
v_pk_fma_f32 v[230:231], v[46:47], v[62:63], v[230:231] op_sel_hi:[0,1,1] neg_lo:[1,0,0] neg_hi:[1,0,0]
v_pk_mul_f32 v[192:193], v[46:47], v[192:193] op_sel:[1,0] op_sel_hi:[1,1]
v_pk_mul_f32 v[194:195], v[46:47], v[194:195] op_sel:[1,0] op_sel_hi:[1,1]
v_cvt_pk_bf16_f32 v156, v156, v157
v_cvt_pk_bf16_f32 v157, v158, v159
ds_write_b64 v15, v[156:157] offset:44800
v_pk_fma_f32 v[160:161], v[48:49], v[52:53], v[160:161] op_sel_hi:[0,1,1] neg_lo:[1,0,0] neg_hi:[1,0,0]
v_pk_fma_f32 v[162:163], v[48:49], v[54:55], v[162:163] op_sel_hi:[0,1,1] neg_lo:[1,0,0] neg_hi:[1,0,0]
v_pk_mul_f32 v[228:229], v[46:47], v[228:229] op_sel:[1,0] op_sel_hi:[1,1]
v_pk_mul_f32 v[230:231], v[46:47], v[230:231] op_sel:[1,0] op_sel_hi:[1,1]
v_cvt_pk_bf16_f32 v192, v192, v193
v_cvt_pk_bf16_f32 v193, v194, v195
ds_write_b64 v15, v[192:193] offset:44928
v_pk_fma_f32 v[196:197], v[48:49], v[56:57], v[196:197] op_sel_hi:[0,1,1] neg_lo:[1,0,0] neg_hi:[1,0,0]
v_pk_fma_f32 v[198:199], v[48:49], v[58:59], v[198:199] op_sel_hi:[0,1,1] neg_lo:[1,0,0] neg_hi:[1,0,0]
v_pk_mul_f32 v[160:161], v[48:49], v[160:161] op_sel:[1,0] op_sel_hi:[1,1]
v_pk_mul_f32 v[162:163], v[48:49], v[162:163] op_sel:[1,0] op_sel_hi:[1,1]
v_cvt_pk_bf16_f32 v228, v228, v229
v_cvt_pk_bf16_f32 v229, v230, v231
ds_write_b64 v15, v[228:229] offset:45056
v_pk_fma_f32 v[232:233], v[48:49], v[60:61], v[232:233] op_sel_hi:[0,1,1] neg_lo:[1,0,0] neg_hi:[1,0,0]
v_pk_fma_f32 v[234:235], v[48:49], v[62:63], v[234:235] op_sel_hi:[0,1,1] neg_lo:[1,0,0] neg_hi:[1,0,0]
v_pk_mul_f32 v[196:197], v[48:49], v[196:197] op_sel:[1,0] op_sel_hi:[1,1]
v_pk_mul_f32 v[198:199], v[48:49], v[198:199] op_sel:[1,0] op_sel_hi:[1,1]
v_cvt_pk_bf16_f32 v160, v160, v161
v_cvt_pk_bf16_f32 v161, v162, v163
ds_write_b64 v15, v[160:161] offset:51200
v_pk_mul_f32 v[232:233], v[48:49], v[232:233] op_sel:[1,0] op_sel_hi:[1,1]
v_pk_mul_f32 v[234:235], v[48:49], v[234:235] op_sel:[1,0] op_sel_hi:[1,1]
v_cvt_pk_bf16_f32 v196, v196, v197
v_cvt_pk_bf16_f32 v197, v198, v199
ds_write_b64 v15, v[196:197] offset:51328
v_cvt_pk_bf16_f32 v232, v232, v233
v_cvt_pk_bf16_f32 v233, v234, v235
ds_write_b64 v15, v[232:233] offset:51456
s_waitcnt lgkmcnt(0)
s_branch Latt_5
Lpf_4:
s_lshl_b32 s43, s35, 7
s_waitcnt lgkmcnt(0)
s_mov_b32 s8, s64
s_mov_b32 s9, s65
s_mov_b32 s10, 4194304
s_mov_b32 s11, 0x20000
s_add_u32 s12, s66, s43
s_addc_u32 s13, s67, 0
s_mov_b32 s14, 6289536
s_mov_b32 s15, 0x20000
s_add_u32 s84, s82, 28311552
s_addc_u32 s85, s83, 0
s_branch Lov_3
.p2align 12
.fill 16, 4, 0xbf800000
Lst_3_0:
s_branch Lwr_148
s_nop 0
s_nop 0
Lov_3:
s_mov_b32 s86, 114688
s_mov_b32 s87, 0x20000
s_mov_b32 s56, s80
s_mov_b32 s57, s81
s_mov_b32 s58, 256
s_mov_b32 s59, 0x20000
v_mov_b32 v5, 0
v_lshlrev_b32 v14, 7, v1
s_or_b32 s43, s34, s35
s_cmp_lg_u32 s43, 0
s_cbranch_scc1 Lz_17
s_movk_i32 s43, 0x2000
buffer_store_dword v5, v14, s[84:87], 0 offen sc1
s_bfm_b64 exec, 44, 0
buffer_store_dword v5, v14, s[84:87], s43 offen sc1
s_mov_b64 exec, 1
v_mov_b32 v6, 1
s_waitcnt vmcnt(0)
buffer_store_dword v6, v5, s[56:59], 0 offen sc1
s_mov_b64 exec, -1
Lz_17:
s_lshl_b32 s43, s51, 11
buffer_load_dwordx4 v[96:99], v10, s[8:11], s43 offen offset:0
buffer_load_dwordx4 v[100:103], v10, s[8:11], s43 offen offset:1024
buffer_load_dwordx4 v[104:107], v10, s[8:11], s43 offen offset:2048
buffer_load_dwordx4 v[108:111], v10, s[8:11], s43 offen offset:3072
v_min_u32 v14, 23, v1
v_lshrrev_b32 v15, 3, v14
v_mul_u32_u24 v15, 43008, v15
v_and_b32 v14, 7, v14
v_lshl_add_u32 v15, v14, 4, v15
v_mov_b32 v32, 0x3f803f80
v_mov_b32 v33, 0x3f803f80
v_mov_b32 v34, 0x3f803f80
v_mov_b32 v35, 0x3f803f80
ds_write_b128 v15, v[32:35]
s_add_u32 s20, s82, 26214400
s_addc_u32 s21, s83, 0
s_mov_b32 s22, 16384
s_mov_b32 s23, 0x20000
s_add_u32 s43, s2, 128
s_lshl_b32 s43, s43, 7
v_lshlrev_b32 v14, 2, v1
s_mov_b64 exec, 15
buffer_store_dword v5, v14, s[84:87], s43 offen sc1
s_mov_b64 exec, -1
s_lshl_b32 s43, s34, 4
s_add_u32 s43, s43, s35
s_lshl_b32 s43, s43, 8
s_add_u32 s43, s43, 49152
v_lshlrev_b32 v14, 7, v1
s_mov_b64 exec, 3
buffer_store_dword v5, v14, s[84:87], s43 offen sc1
s_mov_b64 exec, -1
s_lshl_b32 s52, s34, 7
s_add_u32 s52, s52, 28319744
s_sub_u32 s53, s52, 128
s_cmp_eq_u32 s34, 0
s_cselect_b32 s53, s52, s53
s_waitcnt lgkmcnt(0)
s_barrier
s_waitcnt vmcnt(2)
s_mov_b32 s43, 0x3f803f80
v_mov_b32 v116, 0
v_mov_b32 v117, 0
v_mov_b32 v118, 0
v_mov_b32 v119, 0
v_mov_b32 v120, 0
v_mov_b32 v121, 0
v_mov_b32 v122, 0
v_mov_b32 v123, 0
v_dot2_f32_bf16 v116, v96, s43, v116
v_dot2_f32_bf16 v120, v96, v96, v120
v_dot2_f32_bf16 v118, v104, s43, v118
v_dot2_f32_bf16 v122, v104, v104, v122
v_dot2_f32_bf16 v117, v97, s43, v117
v_dot2_f32_bf16 v121, v97, v97, v121
v_dot2_f32_bf16 v119, v105, s43, v119
v_dot2_f32_bf16 v123, v105, v105, v123
v_dot2_f32_bf16 v116, v98, s43, v116
v_dot2_f32_bf16 v120, v98, v98, v120
v_dot2_f32_bf16 v118, v106, s43, v118
v_dot2_f32_bf16 v122, v106, v106, v122
v_dot2_f32_bf16 v117, v99, s43, v117
v_dot2_f32_bf16 v121, v99, v99, v121
v_dot2_f32_bf16 v119, v107, s43, v119
v_dot2_f32_bf16 v123, v107, v107, v123
v_dot2_f32_bf16 v116, v100, s43, v116
v_dot2_f32_bf16 v120, v100, v100, v120
v_dot2_f32_bf16 v118, v108, s43, v118
v_dot2_f32_bf16 v122, v108, v108, v122
v_dot2_f32_bf16 v117, v101, s43, v117
v_dot2_f32_bf16 v121, v101, v101, v121
v_dot2_f32_bf16 v119, v109, s43, v119
v_dot2_f32_bf16 v123, v109, v109, v123
v_dot2_f32_bf16 v116, v102, s43, v116
v_dot2_f32_bf16 v120, v102, v102, v120
v_dot2_f32_bf16 v118, v110, s43, v118
v_dot2_f32_bf16 v122, v110, v110, v122
v_dot2_f32_bf16 v117, v103, s43, v117
v_dot2_f32_bf16 v121, v103, v103, v121
v_dot2_f32_bf16 v119, v111, s43, v119
v_dot2_f32_bf16 v123, v111, v111, v123
s_nop 2
v_add_f32 v116, v116, v117
v_add_f32 v118, v118, v119
v_add_f32 v120, v120, v121
v_add_f32 v122, v122, v123
s_nop 1
v_permlane32_swap_b32 v116, v118
v_permlane32_swap_b32 v120, v122
v_add_f32 v116, v116, v118
v_add_f32 v120, v120, v122
s_nop 1
v_permlane16_swap_b32 v116, v120
v_add_f32 v116, v116, v120
s_nop 1
v_add_f32_dpp v116, v116, v116 row_ror:8 row_mask:0xf bank_mask:0xf
s_nop 1
v_add_f32_dpp v116, v116, v116 row_ror:4 row_mask:0xf bank_mask:0xf
s_nop 1
v_add_f32_dpp v116, v116, v116 row_ror:2 row_mask:0xf bank_mask:0xf
s_nop 1
v_add_f32_dpp v116, v116, v116 row_ror:1 row_mask:0xf bank_mask:0xf
v_mov_b32 v117, v116
s_nop 1
v_permlane16_swap_b32 v116, v117
v_mul_f32 v112, 0x3a800000, v116
v_mul_f32 v113, 0x3a800000, v117
v_fma_f32 v113, -v112, v112, v113
v_max_f32 v113, 0, v113
v_add_f32 v113, 0x3727c5ac, v113
v_rsq_f32 v113, v113
v_lshrrev_b32 v11, 5, v1
s_lshl_b32 s43, s47, 4
s_add_u32 s43, s43, 148608
v_lshl_add_u32 v11, v11, 3, s43
ds_write_b64 v11, v[112:113]
s_waitcnt lgkmcnt(0)
s_mov_b32 s28, s66
s_mov_b32 s29, s67
s_mov_b32 s30, 6291456
s_mov_b32 s31, 0x20000
s_mul_i32 s43, s33, 7040
s_add_u32 s43, s43, 1179648
v_lshlrev_b32 v30, 7, v1
s_bfm_b64 exec, 55, 0
buffer_load_dword v31, v30, s[28:31], s43 offen
s_mov_b64 exec, -1
s_branch Lst_0_0
Lwr_145:
s_barrier
v_lshlrev_b32 v5, 4, v1
v_and_b32 v5, 63, v5
v_add_u32 v6, 148608, v5
ds_read_b128 v[112:115], v6
s_lshl_b32 s43, s63, 3
v_add_u32 v5, s43, v5
s_waitcnt lgkmcnt(0)
s_mov_b64 exec, 15
buffer_store_dwordx4 v[112:115], v5, s[20:23], 0 offen sc1
s_mov_b64 exec, -1
v_mov_b32 v4, 0
buffer_load_dword v6, v4, s[56:59], 0 offen sc1
s_mov_b32 s62, 0
s_mov_b32 s28, s66
s_mov_b32 s29, s67
s_mov_b32 s30, 6291456
s_mov_b32 s31, 0x20000
s_mul_i32 s43, s33, 15872
s_add_u32 s43, s43, 2752512
v_lshlrev_b32 v30, 7, v1
buffer_load_dword v31, v30, s[28:31], s43 offen
s_add_u32 s43, s43, 8192
s_bfm_b64 exec, 60, 0
buffer_load_dword v31, v30, s[28:31], s43 offen
s_mov_b64 exec, -1
s_lshl_b32 s43, s35, 7
s_add_u32 s28, s68, s43
s_addc_u32 s29, s69, 0
s_mov_b32 s30, 2095232
s_mov_b32 s31, 0x20000
v_and_b32 v29, 7, v1
v_lshrrev_b32 v30, 3, v1
v_lshl_add_u32 v29, v30, 6, v29
s_lshl_b32 s43, s48, 3
v_add_u32 v29, s43, v29
v_lshlrev_b32 v29, 11, v29
s_mov_b32 s43, 1048576
s_mov_b32 s28, s68
s_mov_b32 s29, s69
s_mov_b32 s30, 2097152
s_mov_b32 s31, 0x20000
s_mul_i32 s43, s33, 9472
v_lshlrev_b32 v30, 7, v1
buffer_load_dword v31, v30, s[28:31], s43 offen
s_add_u32 s43, s43, 8192
s_bfm_b64 exec, 10, 0
buffer_load_dword v31, v30, s[28:31], s43 offen
s_mov_b64 exec, -1
s_branch Lst_1_0
Lwr_146:
s_barrier
s_branch Lst_2_0
Lwr_147:
s_barrier
s_branch Lst_3_0
Lwr_148:
s_barrier
s_branch Lst_4_0
Lwr_149:
s_barrier
s_branch Lst_5_0
Lwr_150:
s_barrier
s_cmp_eq_u32 s62, 3
s_cbranch_scc1 Lste_21
s_cmp_eq_u32 s62, 2
s_cbranch_scc1 Lst2_19
s_cmp_ge_u32 s62, 4
s_cbranch_scc1 Lst4_20
s_cmp_eq_u32 s62, 1
s_cbranch_scc1 Lst1_18
s_waitcnt vmcnt(4)
v_readfirstlane_b32 s54, v6
s_cmp_eq_u32 s54, 0
s_cbranch_scc0 Lrep_22
buffer_load_dword v6, v4, s[56:59], 0 offen sc1
s_branch Lste_21
Lrep_22:
s_add_u32 s7, s34, 64
s_lshl_b32 s7, s7, 7
v_mov_b32 v5, s7
v_mov_b32 v6, 1
s_mov_b64 exec, 1
buffer_atomic_add v6, v5, s[84:87], 0 offen sc1
s_mov_b64 exec, -1
s_mov_b32 s62, 1
s_mov_b32 s54, 0
s_mov_b32 s55, 0
s_branch Lste_21
Lst1_18:
s_and_b32 s43, s54, s55
s_cmp_eq_u32 s43, 16
s_cbranch_scc1 Lg_23
s_load_dword s54, s[82:83], s52 glc
s_load_dword s55, s[82:83], s53 glc
s_branch Lste_21
Lg_23:
v_add_u32 v5, 0, v1
v_min_u32 v5, 143, v5
v_lshlrev_b32 v20, 3, v5
v_add_u32 v5, s50, v5
v_max_i32 v5, 0, v5
v_lshlrev_b32 v5, 3, v5
buffer_load_dwordx2 v[32:33], v5, s[20:23], 0 offen sc1
v_add_u32 v5, 64, v1
v_min_u32 v5, 143, v5
v_lshlrev_b32 v21, 3, v5
v_add_u32 v5, s50, v5
v_max_i32 v5, 0, v5
v_lshlrev_b32 v5, 3, v5
buffer_load_dwordx2 v[34:35], v5, s[20:23], 0 offen sc1
v_add_u32 v5, 128, v1
v_min_u32 v5, 143, v5
v_lshlrev_b32 v22, 3, v5
v_add_u32 v5, s50, v5
v_max_i32 v5, 0, v5
v_lshlrev_b32 v5, 3, v5
buffer_load_dwordx2 v[36:37], v5, s[20:23], 0 offen sc1
s_mov_b32 s62, 4
s_branch Lste_21
Lst4_20:
s_mov_b32 s62, 2
s_branch Lste_21
Lst2_19:
s_waitcnt vmcnt(0)
v_add_u32 v20, 147456, v20
ds_write_b64 v20, v[32:33]
v_add_u32 v21, 147456, v21
ds_write_b64 v21, v[34:35]
v_add_u32 v22, 147456, v22
ds_write_b64 v22, v[36:37]
s_waitcnt lgkmcnt(0)
s_mov_b32 s62, 3
Lste_21:
s_branch Lst_6_0
Lwr_151:
s_barrier
s_cmp_eq_u32 s62, 3
s_cbranch_scc1 Lste_27
s_cmp_eq_u32 s62, 2
s_cbranch_scc1 Lst2_25
s_cmp_ge_u32 s62, 4
s_cbranch_scc1 Lst4_26
s_cmp_eq_u32 s62, 1
s_cbranch_scc1 Lst1_24
s_waitcnt vmcnt(0)
v_readfirstlane_b32 s54, v6
s_cmp_eq_u32 s54, 0
s_cbranch_scc0 Lrep_28
buffer_load_dword v6, v4, s[56:59], 0 offen sc1
s_branch Lste_27
Lrep_28:
s_add_u32 s7, s34, 64
s_lshl_b32 s7, s7, 7
v_mov_b32 v5, s7
v_mov_b32 v6, 1
s_mov_b64 exec, 1
buffer_atomic_add v6, v5, s[84:87], 0 offen sc1
s_mov_b64 exec, -1
s_mov_b32 s62, 1
s_mov_b32 s54, 0
s_mov_b32 s55, 0
s_branch Lste_27
Lst1_24:
s_and_b32 s43, s54, s55
s_cmp_eq_u32 s43, 16
s_cbranch_scc1 Lg_29
s_load_dword s54, s[82:83], s52 glc
s_load_dword s55, s[82:83], s53 glc
s_branch Lste_27
Lg_29:
v_add_u32 v5, 0, v1
v_min_u32 v5, 143, v5
v_lshlrev_b32 v20, 3, v5
v_add_u32 v5, s50, v5
v_max_i32 v5, 0, v5
v_lshlrev_b32 v5, 3, v5
buffer_load_dwordx2 v[32:33], v5, s[20:23], 0 offen sc1
v_add_u32 v5, 64, v1
v_min_u32 v5, 143, v5
v_lshlrev_b32 v21, 3, v5
v_add_u32 v5, s50, v5
v_max_i32 v5, 0, v5
v_lshlrev_b32 v5, 3, v5
buffer_load_dwordx2 v[34:35], v5, s[20:23], 0 offen sc1
v_add_u32 v5, 128, v1
v_min_u32 v5, 143, v5
v_lshlrev_b32 v22, 3, v5
v_add_u32 v5, s50, v5
v_max_i32 v5, 0, v5
v_lshlrev_b32 v5, 3, v5
buffer_load_dwordx2 v[36:37], v5, s[20:23], 0 offen sc1
s_mov_b32 s62, 4
s_branch Lste_27
Lst4_26:
s_mov_b32 s62, 2
s_branch Lste_27
Lst2_25:
s_waitcnt vmcnt(0)
v_add_u32 v20, 147456, v20
ds_write_b64 v20, v[32:33]
v_add_u32 v21, 147456, v21
ds_write_b64 v21, v[34:35]
v_add_u32 v22, 147456, v22
ds_write_b64 v22, v[36:37]
s_waitcnt lgkmcnt(0)
s_mov_b32 s62, 3
Lste_27:
s_branch Lst_7_0
Lwr_152:
s_barrier
s_cmp_eq_u32 s62, 3
s_cbranch_scc1 Lste_33
s_cmp_eq_u32 s62, 2
s_cbranch_scc1 Lst2_31
s_cmp_ge_u32 s62, 4
s_cbranch_scc1 Lst4_32
s_cmp_eq_u32 s62, 1
s_cbranch_scc1 Lst1_30
s_waitcnt vmcnt(0)
v_readfirstlane_b32 s54, v6
s_cmp_eq_u32 s54, 0
s_cbranch_scc0 Lrep_34
buffer_load_dword v6, v4, s[56:59], 0 offen sc1
s_branch Lste_33
Lrep_34:
s_add_u32 s7, s34, 64
s_lshl_b32 s7, s7, 7
v_mov_b32 v5, s7
v_mov_b32 v6, 1
s_mov_b64 exec, 1
buffer_atomic_add v6, v5, s[84:87], 0 offen sc1
s_mov_b64 exec, -1
s_mov_b32 s62, 1
s_mov_b32 s54, 0
s_mov_b32 s55, 0
s_branch Lste_33
Lst1_30:
s_and_b32 s43, s54, s55
s_cmp_eq_u32 s43, 16
s_cbranch_scc1 Lg_35
s_load_dword s54, s[82:83], s52 glc
s_load_dword s55, s[82:83], s53 glc
s_branch Lste_33
Lg_35:
v_add_u32 v5, 0, v1
v_min_u32 v5, 143, v5
v_lshlrev_b32 v20, 3, v5
v_add_u32 v5, s50, v5
v_max_i32 v5, 0, v5
v_lshlrev_b32 v5, 3, v5
buffer_load_dwordx2 v[32:33], v5, s[20:23], 0 offen sc1
v_add_u32 v5, 64, v1
v_min_u32 v5, 143, v5
v_lshlrev_b32 v21, 3, v5
v_add_u32 v5, s50, v5
v_max_i32 v5, 0, v5
v_lshlrev_b32 v5, 3, v5
buffer_load_dwordx2 v[34:35], v5, s[20:23], 0 offen sc1
v_add_u32 v5, 128, v1
v_min_u32 v5, 143, v5
v_lshlrev_b32 v22, 3, v5
v_add_u32 v5, s50, v5
v_max_i32 v5, 0, v5
v_lshlrev_b32 v5, 3, v5
buffer_load_dwordx2 v[36:37], v5, s[20:23], 0 offen sc1
s_mov_b32 s62, 4
s_branch Lste_33
Lst4_32:
s_mov_b32 s62, 2
s_branch Lste_33
Lst2_31:
s_waitcnt vmcnt(0)
v_add_u32 v20, 147456, v20
ds_write_b64 v20, v[32:33]
v_add_u32 v21, 147456, v21
ds_write_b64 v21, v[34:35]
v_add_u32 v22, 147456, v22
ds_write_b64 v22, v[36:37]
s_waitcnt lgkmcnt(0)
s_mov_b32 s62, 3
Lste_33:
s_branch Lst_8_0
Lwr_153:
s_barrier
s_cmp_eq_u32 s62, 3
s_cbranch_scc1 Lste_39
s_cmp_eq_u32 s62, 2
s_cbranch_scc1 Lst2_37
s_cmp_ge_u32 s62, 4
s_cbranch_scc1 Lst4_38
s_cmp_eq_u32 s62, 1
s_cbranch_scc1 Lst1_36
s_waitcnt vmcnt(0)
v_readfirstlane_b32 s54, v6
s_cmp_eq_u32 s54, 0
s_cbranch_scc0 Lrep_40
buffer_load_dword v6, v4, s[56:59], 0 offen sc1
s_branch Lste_39
Lrep_40:
s_add_u32 s7, s34, 64
s_lshl_b32 s7, s7, 7
v_mov_b32 v5, s7
v_mov_b32 v6, 1
s_mov_b64 exec, 1
buffer_atomic_add v6, v5, s[84:87], 0 offen sc1
s_mov_b64 exec, -1
s_mov_b32 s62, 1
s_mov_b32 s54, 0
s_mov_b32 s55, 0
s_branch Lste_39
Lst1_36:
s_and_b32 s43, s54, s55
s_cmp_eq_u32 s43, 16
s_cbranch_scc1 Lg_41
s_load_dword s54, s[82:83], s52 glc
s_load_dword s55, s[82:83], s53 glc
s_branch Lste_39
Lg_41:
v_add_u32 v5, 0, v1
v_min_u32 v5, 143, v5
v_lshlrev_b32 v20, 3, v5
v_add_u32 v5, s50, v5
v_max_i32 v5, 0, v5
v_lshlrev_b32 v5, 3, v5
buffer_load_dwordx2 v[32:33], v5, s[20:23], 0 offen sc1
v_add_u32 v5, 64, v1
v_min_u32 v5, 143, v5
v_lshlrev_b32 v21, 3, v5
v_add_u32 v5, s50, v5
v_max_i32 v5, 0, v5
v_lshlrev_b32 v5, 3, v5
buffer_load_dwordx2 v[34:35], v5, s[20:23], 0 offen sc1
v_add_u32 v5, 128, v1
v_min_u32 v5, 143, v5
v_lshlrev_b32 v22, 3, v5
v_add_u32 v5, s50, v5
v_max_i32 v5, 0, v5
v_lshlrev_b32 v5, 3, v5
buffer_load_dwordx2 v[36:37], v5, s[20:23], 0 offen sc1
s_mov_b32 s62, 4
s_branch Lste_39
Lst4_38:
s_mov_b32 s62, 2
s_branch Lste_39
Lst2_37:
s_waitcnt vmcnt(0)
v_add_u32 v20, 147456, v20
ds_write_b64 v20, v[32:33]
v_add_u32 v21, 147456, v21
ds_write_b64 v21, v[34:35]
v_add_u32 v22, 147456, v22
ds_write_b64 v22, v[36:37]
s_waitcnt lgkmcnt(0)
s_mov_b32 s62, 3
Lste_39:
s_branch Lst_9_0
Lwr_154:
s_barrier
s_getpc_b64 s[100:101]
s_and_b32 s100, s100, 0xfffff000
s_sub_u32 s100, s100, 1064960
s_subb_u32 s101, s101, 0
s_lshr_b32 s6, s2, 3
s_mul_i32 s6, s6, 1
s_and_b32 s7, s36, 0
s_add_u32 s6, s6, s7
s_mulk_i32 s6, 640
s_add_u32 s6, s6, 1063168
s_load_dword s3, s[100:101], s6 offset:0
s_load_dword s3, s[100:101], s6 offset:64
s_load_dword s3, s[100:101], s6 offset:128
s_load_dword s3, s[100:101], s6 offset:192
s_load_dword s3, s[100:101], s6 offset:256
s_load_dword s3, s[100:101], s6 offset:320
s_load_dword s3, s[100:101], s6 offset:384
s_load_dword s3, s[100:101], s6 offset:448
s_load_dword s3, s[100:101], s6 offset:512
s_load_dword s3, s[100:101], s6 offset:576
s_nop 0
s_nop 0
s_nop 0
s_nop 0
s_nop 0
s_nop 0
s_nop 0
s_nop 0
s_nop 0
s_nop 0
s_cmp_eq_u32 s62, 3
s_cbranch_scc1 Lste_45
s_cmp_eq_u32 s62, 2
s_cbranch_scc1 Lst2_43
s_cmp_ge_u32 s62, 4
s_cbranch_scc1 Lst4_44
s_cmp_eq_u32 s62, 1
s_cbranch_scc1 Lst1_42
s_waitcnt vmcnt(0)
v_readfirstlane_b32 s54, v6
s_cmp_eq_u32 s54, 0
s_cbranch_scc0 Lrep_46
buffer_load_dword v6, v4, s[56:59], 0 offen sc1
s_branch Lste_45
Lrep_46:
s_add_u32 s7, s34, 64
s_lshl_b32 s7, s7, 7
v_mov_b32 v5, s7
v_mov_b32 v6, 1
s_mov_b64 exec, 1
buffer_atomic_add v6, v5, s[84:87], 0 offen sc1
s_mov_b64 exec, -1
s_mov_b32 s62, 1
s_mov_b32 s54, 0
s_mov_b32 s55, 0
s_branch Lste_45
Lst1_42:
s_and_b32 s43, s54, s55
s_cmp_eq_u32 s43, 16
s_cbranch_scc1 Lg_47
s_load_dword s54, s[82:83], s52 glc
s_load_dword s55, s[82:83], s53 glc
s_branch Lste_45
Lg_47:
v_add_u32 v5, 0, v1
v_min_u32 v5, 143, v5
v_lshlrev_b32 v20, 3, v5
v_add_u32 v5, s50, v5
v_max_i32 v5, 0, v5
v_lshlrev_b32 v5, 3, v5
buffer_load_dwordx2 v[32:33], v5, s[20:23], 0 offen sc1
v_add_u32 v5, 64, v1
v_min_u32 v5, 143, v5
v_lshlrev_b32 v21, 3, v5
v_add_u32 v5, s50, v5
v_max_i32 v5, 0, v5
v_lshlrev_b32 v5, 3, v5
buffer_load_dwordx2 v[34:35], v5, s[20:23], 0 offen sc1
v_add_u32 v5, 128, v1
v_min_u32 v5, 143, v5
v_lshlrev_b32 v22, 3, v5
v_add_u32 v5, s50, v5
v_max_i32 v5, 0, v5
v_lshlrev_b32 v5, 3, v5
buffer_load_dwordx2 v[36:37], v5, s[20:23], 0 offen sc1
s_mov_b32 s62, 4
s_branch Lste_45
Lst4_44:
s_mov_b32 s62, 2
s_branch Lste_45
Lst2_43:
s_waitcnt vmcnt(0)
v_add_u32 v20, 147456, v20
ds_write_b64 v20, v[32:33]
v_add_u32 v21, 147456, v21
ds_write_b64 v21, v[34:35]
v_add_u32 v22, 147456, v22
ds_write_b64 v22, v[36:37]
s_waitcnt lgkmcnt(0)
s_mov_b32 s62, 3
Lste_45:
s_branch Lst_10_0
Lwr_155:
s_barrier
s_cmp_eq_u32 s62, 3
s_cbranch_scc1 Lste_51
s_cmp_eq_u32 s62, 2
s_cbranch_scc1 Lst2_49
s_cmp_ge_u32 s62, 4
s_cbranch_scc1 Lst4_50
s_cmp_eq_u32 s62, 1
s_cbranch_scc1 Lst1_48
s_waitcnt vmcnt(0)
v_readfirstlane_b32 s54, v6
s_cmp_eq_u32 s54, 0
s_cbranch_scc0 Lrep_52
buffer_load_dword v6, v4, s[56:59], 0 offen sc1
s_branch Lste_51
Lrep_52:
s_add_u32 s7, s34, 64
s_lshl_b32 s7, s7, 7
v_mov_b32 v5, s7
v_mov_b32 v6, 1
s_mov_b64 exec, 1
buffer_atomic_add v6, v5, s[84:87], 0 offen sc1
s_mov_b64 exec, -1
s_mov_b32 s62, 1
s_mov_b32 s54, 0
s_mov_b32 s55, 0
s_branch Lste_51
Lst1_48:
s_and_b32 s43, s54, s55
s_cmp_eq_u32 s43, 16
s_cbranch_scc1 Lg_53
s_load_dword s54, s[82:83], s52 glc
s_load_dword s55, s[82:83], s53 glc
s_branch Lste_51
Lg_53:
v_add_u32 v5, 0, v1
v_min_u32 v5, 143, v5
v_lshlrev_b32 v20, 3, v5
v_add_u32 v5, s50, v5
v_max_i32 v5, 0, v5
v_lshlrev_b32 v5, 3, v5
buffer_load_dwordx2 v[32:33], v5, s[20:23], 0 offen sc1
v_add_u32 v5, 64, v1
v_min_u32 v5, 143, v5
v_lshlrev_b32 v21, 3, v5
v_add_u32 v5, s50, v5
v_max_i32 v5, 0, v5
v_lshlrev_b32 v5, 3, v5
buffer_load_dwordx2 v[34:35], v5, s[20:23], 0 offen sc1
v_add_u32 v5, 128, v1
v_min_u32 v5, 143, v5
v_lshlrev_b32 v22, 3, v5
v_add_u32 v5, s50, v5
v_max_i32 v5, 0, v5
v_lshlrev_b32 v5, 3, v5
buffer_load_dwordx2 v[36:37], v5, s[20:23], 0 offen sc1
s_mov_b32 s62, 4
s_branch Lste_51
Lst4_50:
s_mov_b32 s62, 2
s_branch Lste_51
Lst2_49:
s_waitcnt vmcnt(0)
v_add_u32 v20, 147456, v20
ds_write_b64 v20, v[32:33]
v_add_u32 v21, 147456, v21
ds_write_b64 v21, v[34:35]
v_add_u32 v22, 147456, v22
ds_write_b64 v22, v[36:37]
s_waitcnt lgkmcnt(0)
s_mov_b32 s62, 3
Lste_51:
s_branch Lst_11_0
Lwr_156:
s_barrier
s_cmp_eq_u32 s62, 3
s_cbranch_scc1 Lste_57
s_cmp_eq_u32 s62, 2
s_cbranch_scc1 Lst2_55
s_cmp_ge_u32 s62, 4
s_cbranch_scc1 Lst4_56
s_cmp_eq_u32 s62, 1
s_cbranch_scc1 Lst1_54
s_waitcnt vmcnt(0)
v_readfirstlane_b32 s54, v6
s_cmp_eq_u32 s54, 0
s_cbranch_scc0 Lrep_58
buffer_load_dword v6, v4, s[56:59], 0 offen sc1
s_branch Lste_57
Lrep_58:
s_add_u32 s7, s34, 64
s_lshl_b32 s7, s7, 7
v_mov_b32 v5, s7
v_mov_b32 v6, 1
s_mov_b64 exec, 1
buffer_atomic_add v6, v5, s[84:87], 0 offen sc1
s_mov_b64 exec, -1
s_mov_b32 s62, 1
s_mov_b32 s54, 0
s_mov_b32 s55, 0
s_branch Lste_57
Lst1_54:
s_and_b32 s43, s54, s55
s_cmp_eq_u32 s43, 16
s_cbranch_scc1 Lg_59
s_load_dword s54, s[82:83], s52 glc
s_load_dword s55, s[82:83], s53 glc
s_branch Lste_57
Lg_59:
v_add_u32 v5, 0, v1
v_min_u32 v5, 143, v5
v_lshlrev_b32 v20, 3, v5
v_add_u32 v5, s50, v5
v_max_i32 v5, 0, v5
v_lshlrev_b32 v5, 3, v5
buffer_load_dwordx2 v[32:33], v5, s[20:23], 0 offen sc1
v_add_u32 v5, 64, v1
v_min_u32 v5, 143, v5
v_lshlrev_b32 v21, 3, v5
v_add_u32 v5, s50, v5
v_max_i32 v5, 0, v5
v_lshlrev_b32 v5, 3, v5
buffer_load_dwordx2 v[34:35], v5, s[20:23], 0 offen sc1
v_add_u32 v5, 128, v1
v_min_u32 v5, 143, v5
v_lshlrev_b32 v22, 3, v5
v_add_u32 v5, s50, v5
v_max_i32 v5, 0, v5
v_lshlrev_b32 v5, 3, v5
buffer_load_dwordx2 v[36:37], v5, s[20:23], 0 offen sc1
s_mov_b32 s62, 4
s_branch Lste_57
Lst4_56:
s_mov_b32 s62, 2
s_branch Lste_57
Lst2_55:
s_waitcnt vmcnt(0)
v_add_u32 v20, 147456, v20
ds_write_b64 v20, v[32:33]
v_add_u32 v21, 147456, v21
ds_write_b64 v21, v[34:35]
v_add_u32 v22, 147456, v22
ds_write_b64 v22, v[36:37]
s_waitcnt lgkmcnt(0)
s_mov_b32 s62, 3
Lste_57:
s_branch Lst_12_0
Lwr_157:
s_barrier
s_cmp_eq_u32 s62, 3
s_cbranch_scc1 Lste_63
s_cmp_eq_u32 s62, 2
s_cbranch_scc1 Lst2_61
s_cmp_ge_u32 s62, 4
s_cbranch_scc1 Lst4_62
s_cmp_eq_u32 s62, 1
s_cbranch_scc1 Lst1_60
s_waitcnt vmcnt(0)
v_readfirstlane_b32 s54, v6
s_cmp_eq_u32 s54, 0
s_cbranch_scc0 Lrep_64
buffer_load_dword v6, v4, s[56:59], 0 offen sc1
s_branch Lste_63
Lrep_64:
s_add_u32 s7, s34, 64
s_lshl_b32 s7, s7, 7
v_mov_b32 v5, s7
v_mov_b32 v6, 1
s_mov_b64 exec, 1
buffer_atomic_add v6, v5, s[84:87], 0 offen sc1
s_mov_b64 exec, -1
s_mov_b32 s62, 1
s_mov_b32 s54, 0
s_mov_b32 s55, 0
s_branch Lste_63
Lst1_60:
s_and_b32 s43, s54, s55
s_cmp_eq_u32 s43, 16
s_cbranch_scc1 Lg_65
s_load_dword s54, s[82:83], s52 glc
s_load_dword s55, s[82:83], s53 glc
s_branch Lste_63
Lg_65:
v_add_u32 v5, 0, v1
v_min_u32 v5, 143, v5
v_lshlrev_b32 v20, 3, v5
v_add_u32 v5, s50, v5
v_max_i32 v5, 0, v5
v_lshlrev_b32 v5, 3, v5
buffer_load_dwordx2 v[32:33], v5, s[20:23], 0 offen sc1
v_add_u32 v5, 64, v1
v_min_u32 v5, 143, v5
v_lshlrev_b32 v21, 3, v5
v_add_u32 v5, s50, v5
v_max_i32 v5, 0, v5
v_lshlrev_b32 v5, 3, v5
buffer_load_dwordx2 v[34:35], v5, s[20:23], 0 offen sc1
v_add_u32 v5, 128, v1
v_min_u32 v5, 143, v5
v_lshlrev_b32 v22, 3, v5
v_add_u32 v5, s50, v5
v_max_i32 v5, 0, v5
v_lshlrev_b32 v5, 3, v5
buffer_load_dwordx2 v[36:37], v5, s[20:23], 0 offen sc1
s_mov_b32 s62, 4
s_branch Lste_63
Lst4_62:
s_mov_b32 s62, 2
s_branch Lste_63
Lst2_61:
s_waitcnt vmcnt(0)
s_branch Lov_4
.p2align 12
.fill 32, 4, 0xbf800000
Lst_4_0:
s_branch Lwr_149
s_nop 0
s_nop 0
Lov_4:
v_add_u32 v20, 147456, v20
ds_write_b64 v20, v[32:33]
v_add_u32 v21, 147456, v21
ds_write_b64 v21, v[34:35]
v_add_u32 v22, 147456, v22
ds_write_b64 v22, v[36:37]
s_waitcnt lgkmcnt(0)
s_mov_b32 s62, 3
Lste_63:
s_branch Lst_13_0
Lwr_158:
s_barrier
s_cmp_eq_u32 s62, 3
s_cbranch_scc1 Lste_69
s_cmp_eq_u32 s62, 2
s_cbranch_scc1 Lst2_67
s_cmp_ge_u32 s62, 4
s_cbranch_scc1 Lst4_68
s_cmp_eq_u32 s62, 1
s_cbranch_scc1 Lst1_66
s_waitcnt vmcnt(0)
v_readfirstlane_b32 s54, v6
s_cmp_eq_u32 s54, 0
s_cbranch_scc0 Lrep_70
buffer_load_dword v6, v4, s[56:59], 0 offen sc1
s_branch Lste_69
Lrep_70:
s_add_u32 s7, s34, 64
s_lshl_b32 s7, s7, 7
v_mov_b32 v5, s7
v_mov_b32 v6, 1
s_mov_b64 exec, 1
buffer_atomic_add v6, v5, s[84:87], 0 offen sc1
s_mov_b64 exec, -1
s_mov_b32 s62, 1
s_mov_b32 s54, 0
s_mov_b32 s55, 0
s_branch Lste_69
Lst1_66:
s_and_b32 s43, s54, s55
s_cmp_eq_u32 s43, 16
s_cbranch_scc1 Lg_71
s_load_dword s54, s[82:83], s52 glc
s_load_dword s55, s[82:83], s53 glc
s_branch Lste_69
Lg_71:
v_add_u32 v5, 0, v1
v_min_u32 v5, 143, v5
v_lshlrev_b32 v20, 3, v5
v_add_u32 v5, s50, v5
v_max_i32 v5, 0, v5
v_lshlrev_b32 v5, 3, v5
buffer_load_dwordx2 v[32:33], v5, s[20:23], 0 offen sc1
v_add_u32 v5, 64, v1
v_min_u32 v5, 143, v5
v_lshlrev_b32 v21, 3, v5
v_add_u32 v5, s50, v5
v_max_i32 v5, 0, v5
v_lshlrev_b32 v5, 3, v5
buffer_load_dwordx2 v[34:35], v5, s[20:23], 0 offen sc1
v_add_u32 v5, 128, v1
v_min_u32 v5, 143, v5
v_lshlrev_b32 v22, 3, v5
v_add_u32 v5, s50, v5
v_max_i32 v5, 0, v5
v_lshlrev_b32 v5, 3, v5
buffer_load_dwordx2 v[36:37], v5, s[20:23], 0 offen sc1
s_mov_b32 s62, 4
s_branch Lste_69
Lst4_68:
s_mov_b32 s62, 2
s_branch Lste_69
Lst2_67:
s_waitcnt vmcnt(0)
v_add_u32 v20, 147456, v20
ds_write_b64 v20, v[32:33]
v_add_u32 v21, 147456, v21
ds_write_b64 v21, v[34:35]
v_add_u32 v22, 147456, v22
ds_write_b64 v22, v[36:37]
s_waitcnt lgkmcnt(0)
s_mov_b32 s62, 3
Lste_69:
s_branch Lst_14_0
Lwr_159:
s_barrier
s_cmp_eq_u32 s62, 3
s_cbranch_scc1 Lste_74
s_cmp_ge_u32 s62, 5
s_cbranch_scc1 Lg_79
s_cmp_ge_u32 s62, 2
s_cbranch_scc1 Lst2_73
s_cmp_eq_u32 s62, 1
s_cbranch_scc1 Lst1_72
s_mov_b32 s41, 0x40000
Lz0_75:
s_waitcnt vmcnt(0)
v_readfirstlane_b32 s54, v6
s_cmp_eq_u32 s54, 0
s_cbranch_scc0 Lzok_76
buffer_load_dword v6, v4, s[56:59], 0 offen sc1
s_sub_u32 s41, s41, 1
s_cmp_lg_u32 s41, 0
s_cbranch_scc1 Lz0_75
s_waitcnt lgkmcnt(0)
Lzok_76:
s_add_u32 s7, s34, 64
s_lshl_b32 s7, s7, 7
v_mov_b32 v5, s7
v_mov_b32 v6, 1
s_mov_b64 exec, 1
buffer_atomic_add v6, v5, s[84:87], 0 offen sc1
s_mov_b64 exec, -1
Lst1_72:
s_load_dword s54, s[82:83], s52 glc
s_load_dword s55, s[82:83], s53 glc
s_mov_b32 s41, 0x40000
Lpoll_77:
s_waitcnt lgkmcnt(0)
s_and_b32 s54, s54, s55
s_cmp_eq_u32 s54, 16
s_cbranch_scc1 Lg_79
s_load_dword s54, s[82:83], s52 glc
s_load_dword s55, s[82:83], s53 glc
s_sub_u32 s41, s41, 1
s_cmp_lg_u32 s41, 0
s_cbranch_scc1 Lpoll_77
s_waitcnt lgkmcnt(0)
Lg_79:
v_add_u32 v5, 0, v1
v_min_u32 v5, 143, v5
v_lshlrev_b32 v20, 3, v5
v_add_u32 v5, s50, v5
v_max_i32 v5, 0, v5
v_lshlrev_b32 v5, 3, v5
buffer_load_dwordx2 v[32:33], v5, s[20:23], 0 offen sc1
v_add_u32 v5, 64, v1
v_min_u32 v5, 143, v5
v_lshlrev_b32 v21, 3, v5
v_add_u32 v5, s50, v5
v_max_i32 v5, 0, v5
v_lshlrev_b32 v5, 3, v5
buffer_load_dwordx2 v[34:35], v5, s[20:23], 0 offen sc1
v_add_u32 v5, 128, v1
v_min_u32 v5, 143, v5
v_lshlrev_b32 v22, 3, v5
v_add_u32 v5, s50, v5
v_max_i32 v5, 0, v5
v_lshlrev_b32 v5, 3, v5
buffer_load_dwordx2 v[36:37], v5, s[20:23], 0 offen sc1
Lst2_73:
s_waitcnt vmcnt(0)
v_add_u32 v20, 147456, v20
ds_write_b64 v20, v[32:33]
v_add_u32 v21, 147456, v21
ds_write_b64 v21, v[34:35]
v_add_u32 v22, 147456, v22
ds_write_b64 v22, v[36:37]
s_waitcnt lgkmcnt(0)
Lste_74:
s_bitcmp0_b32 s2, 0
s_cselect_b32 s88, s72, s74
s_cselect_b32 s89, s73, s75
s_cmp_lt_u32 s2, 192
s_cselect_b32 s90, 7340032, 0
s_mov_b32 s91, 0x20000
s_bfe_u32 s44, s2, 0x30001
s_lshl_b32 s44, s44, 2
s_and_b32 s43, s36, 3
s_add_u32 s44, s44, s43
s_lshl_b32 s44, s44, 5
v_lshrrev_b32 v18, 4, v1
v_add_u32 v18, s44, v18
v_mul_u32_u24 v18, 7168, v18
v_and_b32 v19, 15, v1
v_lshl_add_u32 v18, v19, 4, v18
s_lshr_b32 s43, s2, 4
s_lshl_b32 s43, s43, 8
s_add_u32 s43, s43, 4096
v_add_u32 v18, s43, v18
s_mov_b32 s43, 0
buffer_load_dwordx4 v[128:131], v18, s[88:91], s43 offen
s_mov_b32 s43, 28672
buffer_load_dwordx4 v[132:135], v18, s[88:91], s43 offen
s_mov_b32 s43, 57344
buffer_load_dwordx4 v[136:139], v18, s[88:91], s43 offen
s_mov_b32 s43, 86016
buffer_load_dwordx4 v[140:143], v18, s[88:91], s43 offen
s_mov_b32 s43, 114688
buffer_load_dwordx4 v[144:147], v18, s[88:91], s43 offen
s_mov_b32 s43, 143360
buffer_load_dwordx4 v[148:151], v18, s[88:91], s43 offen
s_mov_b32 s43, 172032
buffer_load_dwordx4 v[152:155], v18, s[88:91], s43 offen
s_mov_b32 s43, 200704
buffer_load_dwordx4 v[156:159], v18, s[88:91], s43 offen
s_barrier
s_lshl_b32 s43, s35, 7
s_add_u32 s28, s68, s43
s_addc_u32 s29, s69, 0
s_mov_b32 s30, 2095232
s_mov_b32 s31, 0x20000
v_lshrrev_b32 v15, 3, v1
v_and_b32 v16, 6, v15
v_and_b32 v7, 7, v1
v_xor_b32 v7, v7, v16
v_lshlrev_b32 v7, 4, v7
v_mul_u32_u24 v15, 2048, v15
v_add_u32 v7, v7, v15
s_and_b32 s40, s36, 3
s_lshl_b32 s39, s40, 13
s_add_u32 s40, s40, s35
s_add_u32 s42, s40, 0
s_and_b32 s42, s42, 15
s_lshl_b32 s42, s42, 17
s_add_u32 m0, s39, 65536
s_add_u32 s43, s42, 0
buffer_load_dwordx4 v7, s[28:31], s43 offen lds
s_add_u32 m0, s39, 66560
s_add_u32 s43, s42, 16384
buffer_load_dwordx4 v7, s[28:31], s43 offen lds
s_add_u32 m0, s39, 67584
s_add_u32 s43, s42, 32768
buffer_load_dwordx4 v7, s[28:31], s43 offen lds
s_add_u32 m0, s39, 68608
s_add_u32 s43, s42, 49152
buffer_load_dwordx4 v7, s[28:31], s43 offen lds
s_add_u32 m0, s39, 69632
s_add_u32 s43, s42, 65536
buffer_load_dwordx4 v7, s[28:31], s43 offen lds
s_add_u32 m0, s39, 70656
s_add_u32 s43, s42, 81920
buffer_load_dwordx4 v7, s[28:31], s43 offen lds
s_add_u32 m0, s39, 71680
s_add_u32 s43, s42, 98304
buffer_load_dwordx4 v7, s[28:31], s43 offen lds
s_add_u32 m0, s39, 72704
s_add_u32 s43, s42, 114688
buffer_load_dwordx4 v7, s[28:31], s43 offen lds
Lats_6:
s_and_b32 s43, s36, 1
s_bfe_u32 s44, s36, 0x10001
s_lshr_b32 s45, s36, 2
v_lshlrev_b32 v14, 2, v13
v_sub_u32 v14, v12, v14
v_mov_b32 v16, 0xff800000
s_or_b32 s46, s34, s45
s_cmp_lg_u32 s46, 0
s_cselect_b32 s46, 0, 0xff800000
v_subrev_u32 v15, 0, v14
v_cmp_ge_u32 vcc, 7, v15
v_add_u32 v15, 16, v15
s_nop 0
v_cndmask_b32 v248, v16, 0, vcc
v_cmp_ge_u32 vcc, 7, v15
s_nop 1
v_cndmask_b32 v244, v16, 0, vcc
v_or_b32 v240, s46, v244
v_subrev_u32 v15, 1, v14
v_cmp_ge_u32 vcc, 7, v15
v_add_u32 v15, 16, v15
s_nop 0
v_cndmask_b32 v249, v16, 0, vcc
v_cmp_ge_u32 vcc, 7, v15
s_nop 1
v_cndmask_b32 v245, v16, 0, vcc
v_or_b32 v241, s46, v245
v_subrev_u32 v15, 2, v14
v_cmp_ge_u32 vcc, 7, v15
v_add_u32 v15, 16, v15
s_nop 0
v_cndmask_b32 v250, v16, 0, vcc
v_cmp_ge_u32 vcc, 7, v15
s_nop 1
v_cndmask_b32 v246, v16, 0, vcc
v_or_b32 v242, s46, v246
v_subrev_u32 v15, 3, v14
v_cmp_ge_u32 vcc, 7, v15
v_add_u32 v15, 16, v15
s_nop 0
v_cndmask_b32 v251, v16, 0, vcc
v_cmp_ge_u32 vcc, 7, v15
s_nop 1
v_cndmask_b32 v247, v16, 0, vcc
v_or_b32 v243, s46, v247
s_lshl_b32 s46, s45, 6
s_add_u32 s46, s46, s44
s_add_u32 s46, s46, 16
v_lshl_add_u32 v14, v12, 1, s46
s_lshl_b32 s47, s43, 6
v_lshl_add_u32 v15, v13, 4, s47
v_mul_u32_u24 v20, 400, v14
v_add_u32 v20, v20, v15
v_subrev_u32 v16, 32, v14
v_max_i32 v16, 0, v16
v_mul_u32_u24 v21, 400, v16
v_add_u32 v21, v21, v15
v_lshrrev_b32 v16, 2, v12
v_lshl_add_u32 v16, v13, 2, v16
v_lshl_add_u32 v16, v16, 1, s46
v_and_b32 v17, 3, v1
v_lshl_add_u32 v17, v17, 3, s47
v_mul_u32_u24 v22, 400, v16
v_add_u32 v22, v22, v17
v_subrev_u32 v16, 32, v16
v_max_i32 v16, 0, v16
v_mul_u32_u24 v23, 400, v16
v_add_u32 v23, v23, v17
s_mul_i32 s60, s34, 262144
s_add_u32 s16, s82, s60
s_addc_u32 s17, s83, 0
s_mov_b32 s18, 262144
s_mov_b32 s19, 0x20000
s_lshl_b32 s60, s35, 14
s_lshl_b32 s43, s43, 13
s_add_u32 s60, s60, s43
s_lshl_b32 s43, s45, 12
s_add_u32 s60, s60, s43
s_lshl_b32 s43, s44, 10
s_add_u32 s60, s60, s43
v_lshlrev_b32 v24, 4, v1
s_mov_b32 s61, 0x3e8293ee
s_lshl_b32 s38, s35, 7
Latt_5:
s_barrier
ds_read_b128 v[32:35], v20 offset:0
ds_read_b128 v[36:39], v20 offset:128
ds_read_b128 v[40:43], v21 offset:128
ds_read_b128 v[80:83], v20 offset:12800
ds_read_b128 v[84:87], v20 offset:12928
ds_read_b128 v[88:91], v20 offset:128
ds_read_b64_tr_b16 v[44:45], v23 offset:256
ds_read_b64_tr_b16 v[46:47], v22 offset:256
ds_read_b64_tr_b16 v[48:49], v23 offset:288
ds_read_b64_tr_b16 v[50:51], v22 offset:288
ds_read_b64_tr_b16 v[92:93], v22 offset:256
ds_read_b64_tr_b16 v[94:95], v22 offset:13056
ds_read_b64_tr_b16 v[96:97], v22 offset:288
ds_read_b64_tr_b16 v[98:99], v22 offset:13088
s_waitcnt lgkmcnt(11)
v_mfma_f32_16x16x32_bf16 v[52:55], v[40:43], v[32:35], v[240:243]
v_mfma_f32_16x16x32_bf16 v[56:59], v[36:39], v[32:35], v[248:251]
s_waitcnt lgkmcnt(8)
v_mfma_f32_16x16x32_bf16 v[100:103], v[88:91], v[80:83], v[244:247]
v_mfma_f32_16x16x32_bf16 v[104:107], v[84:87], v[80:83], v[248:251]
s_nop 5
v_max3_f32 v60, v52, v53, v54
v_max3_f32 v108, v100, v101, v102
v_max3_f32 v61, v55, v56, v57
v_max3_f32 v109, v103, v104, v105
v_max3_f32 v60, v60, v58, v59
v_max3_f32 v108, v108, v106, v107
v_max_f32 v60, v60, v61
v_max_f32 v108, v108, v109
s_nop 1
v_permlane32_swap_b32 v60, v108
v_max_f32 v60, v60, v108
v_mov_b32 v61, v60
s_nop 1
v_permlane16_swap_b32 v60, v61
v_max_f32 v60, v60, v61
v_mul_f32 v60, s61, v60
s_nop 0
v_mov_b32 v108, v60
s_nop 1
v_permlane32_swap_b32 v60, v108
v_fma_f32 v52, v52, s61, -v60
v_fma_f32 v100, v100, s61, -v108
v_fma_f32 v53, v53, s61, -v60
v_fma_f32 v101, v101, s61, -v108
v_fma_f32 v54, v54, s61, -v60
v_fma_f32 v102, v102, s61, -v108
v_fma_f32 v55, v55, s61, -v60
v_fma_f32 v103, v103, s61, -v108
v_fma_f32 v56, v56, s61, -v60
v_fma_f32 v104, v104, s61, -v108
v_fma_f32 v57, v57, s61, -v60
v_fma_f32 v105, v105, s61, -v108
v_fma_f32 v58, v58, s61, -v60
v_fma_f32 v106, v106, s61, -v108
v_fma_f32 v59, v59, s61, -v60
v_fma_f32 v107, v107, s61, -v108
v_exp_f32 v52, v52
v_exp_f32 v100, v100
v_exp_f32 v53, v53
v_exp_f32 v101, v101
v_exp_f32 v54, v54
v_exp_f32 v102, v102
v_exp_f32 v55, v55
v_exp_f32 v103, v103
v_exp_f32 v56, v56
v_exp_f32 v104, v104
v_exp_f32 v57, v57
v_exp_f32 v105, v105
v_exp_f32 v58, v58
v_exp_f32 v106, v106
v_exp_f32 v59, v59
v_exp_f32 v107, v107
v_cvt_pk_bf16_f32 v64, v52, v53
v_cvt_pk_bf16_f32 v112, v100, v101
v_cvt_pk_bf16_f32 v65, v54, v55
v_cvt_pk_bf16_f32 v113, v102, v103
v_cvt_pk_bf16_f32 v66, v56, v57
v_cvt_pk_bf16_f32 v114, v104, v105
v_cvt_pk_bf16_f32 v67, v58, v59
v_cvt_pk_bf16_f32 v115, v106, v107
v_pk_add_f32 v[52:53], v[52:53], v[54:55]
v_pk_add_f32 v[100:101], v[100:101], v[102:103]
v_pk_add_f32 v[56:57], v[56:57], v[58:59]
v_pk_add_f32 v[104:105], v[104:105], v[106:107]
s_waitcnt lgkmcnt(0)
s_waitcnt lgkmcnt(0)
v_mfma_f32_16x16x32_bf16 v[68:71], v[44:47], v[64:67], 0
v_mfma_f32_16x16x32_bf16 v[116:119], v[92:95], v[112:115], 0
v_mfma_f32_16x16x32_bf16 v[72:75], v[48:51], v[64:67], 0
v_mfma_f32_16x16x32_bf16 v[120:123], v[96:99], v[112:115], 0
v_pk_add_f32 v[52:53], v[52:53], v[56:57]
v_pk_add_f32 v[100:101], v[100:101], v[104:105]
v_add_f32 v60, v52, v53
v_add_f32 v108, v100, v101
s_nop 1
v_permlane32_swap_b32 v60, v108
v_add_f32 v60, v60, v108
v_mov_b32 v61, v60
s_nop 1
v_permlane16_swap_b32 v60, v61
v_add_f32 v60, v60, v61
v_rcp_f32 v60, v60
s_nop 0
v_mov_b32 v108, v60
s_nop 1
v_permlane32_swap_b32 v60, v108
v_pk_mul_f32 v[68:69], v[60:61], v[68:69] op_sel_hi:[0,1]
v_pk_mul_f32 v[116:117], v[108:109], v[116:117] op_sel_hi:[0,1]
v_pk_mul_f32 v[70:71], v[60:61], v[70:71] op_sel_hi:[0,1]
v_pk_mul_f32 v[118:119], v[108:109], v[118:119] op_sel_hi:[0,1]
v_pk_mul_f32 v[72:73], v[60:61], v[72:73] op_sel_hi:[0,1]
v_pk_mul_f32 v[120:121], v[108:109], v[120:121] op_sel_hi:[0,1]
v_pk_mul_f32 v[74:75], v[60:61], v[74:75] op_sel_hi:[0,1]
v_pk_mul_f32 v[122:123], v[108:109], v[122:123] op_sel_hi:[0,1]
v_cvt_pk_bf16_f32 v64, v68, v69
v_cvt_pk_bf16_f32 v112, v116, v117
v_cvt_pk_bf16_f32 v65, v70, v71
v_cvt_pk_bf16_f32 v113, v118, v119
v_cvt_pk_bf16_f32 v66, v72, v73
v_cvt_pk_bf16_f32 v114, v120, v121
v_cvt_pk_bf16_f32 v67, v74, v75
v_cvt_pk_bf16_f32 v115, v122, v123
buffer_store_dwordx4 v[64:67], v24, s[16:19], s60 offen offset:0 sc1
buffer_store_dwordx4 v[112:115], v24, s[16:19], s60 offen offset:2048 sc1
s_add_u32 s56, s82, 28311552
s_addc_u32 s57, s83, 0
s_mov_b32 s58, 114688
s_mov_b32 s59, 0x20000
s_lshl_b32 s7, s34, 12
s_add_u32 s7, s7, 49152
v_lshl_add_u32 v26, v1, 8, s7
v_mov_b32 v27, 1
s_cmp_ge_u32 s36, 4
s_cbranch_scc1 Lh_81
s_waitcnt vmcnt(0)
s_branch Lo_80
Lh_81:
s_waitcnt vmcnt(0)
Lo_80:
s_cmp_lg_u32 s36, 0
s_barrier
s_cbranch_scc1 Lsig_82
s_mov_b64 exec, 0xffff
buffer_atomic_add v27, v26, s[56:59], 0 offen sc1
s_mov_b64 exec, -1
Lsig_82:
s_cmp_ge_u32 s36, 4
s_cbranch_scc1 Lprod_84
v_and_b32 v12, 15, v1
v_lshrrev_b32 v13, 4, v1
v_lshlrev_b32 v10, 12, v12
v_and_b32 v14, 1, v13
v_lshl_add_u32 v10, v14, 5, v10
v_lshrrev_b32 v14, 1, v13
v_lshl_add_u32 v10, v14, 4, v10
s_lshl_b32 s43, s34, 18
s_lshl_b32 s44, s36, 16
s_add_u32 s43, s43, s44
s_lshl_b32 s44, s35, 7
s_add_u32 s43, s43, s44
buffer_load_dwordx4 v[128:131], v10, s[8:11], s43 offen offset:0
buffer_load_dwordx4 v[132:135], v10, s[8:11], s43 offen offset:64
buffer_load_dwordx4 v[136:139], v10, s[8:11], s43 offen offset:2048
buffer_load_dwordx4 v[140:143], v10, s[8:11], s43 offen offset:2112
v_and_b32 v12, 15, v1
v_lshrrev_b32 v13, 4, v1
s_mul_i32 s43, s34, 262144
s_add_u32 s20, s82, s43
s_addc_u32 s21, s83, 0
s_add_u32 s20, s20, 4194304
s_addc_u32 s21, s21, 0
s_mov_b32 s22, 262144
s_mov_b32 s23, 0x20000
s_mul_i32 s43, s34, 16384
s_add_u32 s24, s82, s43
s_addc_u32 s25, s83, 0
s_add_u32 s24, s24, 25165824
s_addc_u32 s25, s25, 0
s_mov_b32 s26, 16384
s_mov_b32 s27, 0x20000
v_lshlrev_b32 v11, 4, v1
s_lshl_b32 s43, s36, 11
v_add_u32 v2, s43, v11
v_add_u32 v3, 98304, v2
v_lshrrev_b32 v14, 2, v1
v_bfe_u32 v15, v14, 1, 2
v_mul_u32_u24 v14, 128, v14
v_lshl_add_u32 v14, v15, 5, v14
v_and_b32 v15, 3, v1
v_lshl_add_u32 v4, v15, 3, v14
v_xor_b32 v5, 32, v4
v_xor_b32 v6, 64, v4
v_xor_b32 v7, 96, v4
v_add_u32 v16, 0x10000, v4
v_add_u32 v20, 0x20000, v4
v_add_u32 v17, 0x10000, v5
v_add_u32 v21, 0x20000, v5
v_add_u32 v18, 0x10000, v6
v_add_u32 v22, 0x20000, v6
v_add_u32 v19, 0x10000, v7
v_add_u32 v23, 0x20000, v7
s_lshl_b32 s44, s35, 14
s_add_u32 s60, s44, s43
v_lshrrev_b32 v14, 1, v13
v_lshlrev_b32 v14, 11, v14
v_lshl_add_u32 v14, v12, 3, v14
v_and_b32 v15, 1, v13
v_lshl_add_u32 v14, v15, 2, v14
s_lshl_b32 s43, s36, 12
s_lshl_b32 s44, s35, 7
s_add_u32 s43, s43, s44
v_add_u32 v9, s43, v14
s_mov_b32 s61, 0x3f803f80
s_cmp_lg_u32 s36, 0
s_cbranch_scc1 Lwm_87
s_nop 0
s_branch Lwe_86
Lwm_87:
s_cmp_lg_u32 s36, 1
s_cbranch_scc1 Lwm_88
s_nop 0
s_branch Lwe_86
Lwm_88:
s_cmp_lg_u32 s36, 2
s_cbranch_scc1 Lwm_89
s_nop 0
s_branch Lwe_86
Lwm_89:
s_cmp_lg_u32 s36, 3
s_cbranch_scc1 Lwm_90
s_nop 0
s_branch Lwe_86
Lwm_90:
Lwe_86:
s_barrier
ds_read_b128 v[32:35], v2 offset:0
ds_read_b64_tr_b16 v[40:41], v16 offset:0
ds_read_b64_tr_b16 v[42:43], v16 offset:2048
ds_read_b64_tr_b16 v[44:45], v17 offset:0
ds_read_b64_tr_b16 v[46:47], v17 offset:2048
ds_read_b64_tr_b16 v[48:49], v18 offset:0
ds_read_b64_tr_b16 v[50:51], v18 offset:2048
ds_read_b64_tr_b16 v[52:53], v19 offset:0
ds_read_b64_tr_b16 v[54:55], v19 offset:2048
ds_read_b128 v[36:39], v2 offset:1024
ds_read_b128 v[56:59], v2 offset:8192
ds_read_b64_tr_b16 v[64:65], v16 offset:4096
ds_read_b64_tr_b16 v[66:67], v16 offset:6144
ds_read_b64_tr_b16 v[68:69], v17 offset:4096
ds_read_b64_tr_b16 v[70:71], v17 offset:6144
ds_read_b64_tr_b16 v[72:73], v18 offset:4096
ds_read_b64_tr_b16 v[74:75], v18 offset:6144
ds_read_b64_tr_b16 v[76:77], v19 offset:4096
ds_read_b64_tr_b16 v[78:79], v19 offset:6144
ds_read_b128 v[60:63], v2 offset:9216
s_waitcnt lgkmcnt(0)
s_barrier
v_mfma_f32_16x16x32_bf16 v[96:99], v[40:43], v[32:35], 0
ds_read_b128 v[144:147], v2 offset:49152
ds_read_b64_tr_b16 v[152:153], v16 offset:8192
v_mfma_f32_16x16x32_bf16 v[100:103], v[44:47], v[32:35], 0
ds_read_b64_tr_b16 v[154:155], v16 offset:10240
ds_read_b64_tr_b16 v[156:157], v17 offset:8192
v_mfma_f32_16x16x32_bf16 v[104:107], v[48:51], v[32:35], 0
ds_read_b64_tr_b16 v[158:159], v17 offset:10240
ds_read_b64_tr_b16 v[160:161], v18 offset:8192
v_mfma_f32_16x16x32_bf16 v[108:111], v[52:55], v[32:35], 0
ds_read_b64_tr_b16 v[162:163], v18 offset:10240
ds_read_b64_tr_b16 v[164:165], v19 offset:8192
v_mfma_f32_16x16x32_bf16 v[124:127], v[52:55], v[36:39], 0
ds_read_b64_tr_b16 v[166:167], v19 offset:10240
ds_read_b128 v[148:151], v2 offset:50176
v_mfma_f32_16x16x32_bf16 v[120:123], v[48:51], v[36:39], 0
ds_read_b128 v[168:171], v2 offset:57344
ds_read_b64_tr_b16 v[176:177], v16 offset:12288
v_mfma_f32_16x16x32_bf16 v[116:119], v[44:47], v[36:39], 0
ds_read_b64_tr_b16 v[178:179], v16 offset:14336
ds_read_b64_tr_b16 v[180:181], v17 offset:12288
v_mfma_f32_16x16x32_bf16 v[112:115], v[40:43], v[36:39], 0
ds_read_b64_tr_b16 v[182:183], v17 offset:14336
ds_read_b64_tr_b16 v[184:185], v18 offset:12288
v_mfma_f32_16x16x32_bf16 v[96:99], v[64:67], v[56:59], v[96:99]
ds_read_b64_tr_b16 v[186:187], v18 offset:14336
ds_read_b64_tr_b16 v[188:189], v19 offset:12288
s_bitcmp0_b32 s36, 1
v_mfma_f32_16x16x32_bf16 v[100:103], v[68:71], v[56:59], v[100:103]
ds_read_b64_tr_b16 v[190:191], v19 offset:14336
ds_read_b128 v[172:175], v2 offset:58368
s_cselect_b32 s44, s72, s74
v_mfma_f32_16x16x32_bf16 v[104:107], v[72:75], v[56:59], v[104:107]
s_cselect_b32 s45, s73, s75
v_mfma_f32_16x16x32_bf16 v[108:111], v[76:79], v[56:59], v[108:111]
s_mul_i32 s43, s35, 192
v_mfma_f32_16x16x32_bf16 v[124:127], v[76:79], v[60:63], v[124:127]
s_add_u32 s16, s44, s43
v_mfma_f32_16x16x32_bf16 v[120:123], v[72:75], v[60:63], v[120:123]
s_addc_u32 s17, s45, 0
v_mfma_f32_16x16x32_bf16 v[116:119], v[68:71], v[60:63], v[116:119]
s_add_u32 s16, s16, 4096
v_mfma_f32_16x16x32_bf16 v[112:115], v[64:67], v[60:63], v[112:115]
s_addc_u32 s17, s17, 0
s_waitcnt lgkmcnt(0)
s_barrier
v_mfma_f32_16x16x32_bf16 v[96:99], v[152:155], v[144:147], v[96:99]
ds_read_b128 v[32:35], v3 offset:0
ds_read_b64_tr_b16 v[40:41], v16 offset:16384
v_mfma_f32_16x16x32_bf16 v[100:103], v[156:159], v[144:147], v[100:103]
ds_read_b64_tr_b16 v[42:43], v16 offset:18432
ds_read_b64_tr_b16 v[44:45], v17 offset:16384
v_mfma_f32_16x16x32_bf16 v[104:107], v[160:163], v[144:147], v[104:107]
ds_read_b64_tr_b16 v[46:47], v17 offset:18432
ds_read_b64_tr_b16 v[48:49], v18 offset:16384
v_mfma_f32_16x16x32_bf16 v[108:111], v[164:167], v[144:147], v[108:111]
ds_read_b64_tr_b16 v[50:51], v18 offset:18432
ds_read_b64_tr_b16 v[52:53], v19 offset:16384
v_mfma_f32_16x16x32_bf16 v[124:127], v[164:167], v[148:151], v[124:127]
ds_read_b64_tr_b16 v[54:55], v19 offset:18432
ds_read_b128 v[36:39], v3 offset:1024
v_mfma_f32_16x16x32_bf16 v[120:123], v[160:163], v[148:151], v[120:123]
ds_read_b128 v[56:59], v3 offset:8192
ds_read_b64_tr_b16 v[64:65], v16 offset:20480
v_mfma_f32_16x16x32_bf16 v[116:119], v[156:159], v[148:151], v[116:119]
ds_read_b64_tr_b16 v[66:67], v16 offset:22528
ds_read_b64_tr_b16 v[68:69], v17 offset:20480
v_mfma_f32_16x16x32_bf16 v[112:115], v[152:155], v[148:151], v[112:115]
ds_read_b64_tr_b16 v[70:71], v17 offset:22528
ds_read_b64_tr_b16 v[72:73], v18 offset:20480
v_mfma_f32_16x16x32_bf16 v[96:99], v[176:179], v[168:171], v[96:99]
ds_read_b64_tr_b16 v[74:75], v18 offset:22528
ds_read_b64_tr_b16 v[76:77], v19 offset:20480
s_mov_b32 s18, 7333056
v_mfma_f32_16x16x32_bf16 v[100:103], v[180:183], v[168:171], v[100:103]
ds_read_b64_tr_b16 v[78:79], v19 offset:22528
ds_read_b128 v[60:63], v3 offset:9216
s_mov_b32 s19, 0x20000
v_mfma_f32_16x16x32_bf16 v[104:107], v[184:187], v[168:171], v[104:107]
s_and_b32 s43, s36, 1
v_mfma_f32_16x16x32_bf16 v[108:111], v[188:191], v[168:171], v[108:111]
s_mul_i32 s43, s43, 229376
v_mfma_f32_16x16x32_bf16 v[124:127], v[188:191], v[172:175], v[124:127]
v_add_u32 v196, 0, v1
v_mfma_f32_16x16x32_bf16 v[120:123], v[184:187], v[172:175], v[120:123]
v_mul_u32_u24 v197, 5462, v196
v_mfma_f32_16x16x32_bf16 v[116:119], v[180:183], v[172:175], v[116:119]
v_lshrrev_b32 v197, 16, v197
v_mfma_f32_16x16x32_bf16 v[112:115], v[176:179], v[172:175], v[112:115]
v_mul_u32_u24 v198, 12, v197
s_waitcnt lgkmcnt(0)
s_barrier
v_mfma_f32_16x16x32_bf16 v[96:99], v[40:43], v[32:35], v[96:99]
ds_read_b128 v[144:147], v3 offset:49152
ds_read_b64_tr_b16 v[152:153], v16 offset:24576
v_mfma_f32_16x16x32_bf16 v[100:103], v[44:47], v[32:35], v[100:103]
ds_read_b64_tr_b16 v[154:155], v16 offset:26624
s_branch Lov_5
.p2align 12
.fill 32, 4, 0xbf800000
Lst_5_0:
s_branch Lwr_150
s_nop 0
s_nop 0
Lov_5:
ds_read_b64_tr_b16 v[156:157], v17 offset:24576
v_mfma_f32_16x16x32_bf16 v[104:107], v[48:51], v[32:35], v[104:107]
ds_read_b64_tr_b16 v[158:159], v17 offset:26624
ds_read_b64_tr_b16 v[160:161], v18 offset:24576
v_mfma_f32_16x16x32_bf16 v[108:111], v[52:55], v[32:35], v[108:111]
ds_read_b64_tr_b16 v[162:163], v18 offset:26624
ds_read_b64_tr_b16 v[164:165], v19 offset:24576
v_mfma_f32_16x16x32_bf16 v[124:127], v[52:55], v[36:39], v[124:127]
ds_read_b64_tr_b16 v[166:167], v19 offset:26624
ds_read_b128 v[148:151], v3 offset:50176
v_mfma_f32_16x16x32_bf16 v[120:123], v[48:51], v[36:39], v[120:123]
ds_read_b128 v[168:171], v3 offset:57344
ds_read_b64_tr_b16 v[176:177], v16 offset:28672
v_mfma_f32_16x16x32_bf16 v[116:119], v[44:47], v[36:39], v[116:119]
ds_read_b64_tr_b16 v[178:179], v16 offset:30720
ds_read_b64_tr_b16 v[180:181], v17 offset:28672
v_mfma_f32_16x16x32_bf16 v[112:115], v[40:43], v[36:39], v[112:115]
ds_read_b64_tr_b16 v[182:183], v17 offset:30720
ds_read_b64_tr_b16 v[184:185], v18 offset:28672
v_mfma_f32_16x16x32_bf16 v[96:99], v[64:67], v[56:59], v[96:99]
ds_read_b64_tr_b16 v[186:187], v18 offset:30720
ds_read_b64_tr_b16 v[188:189], v19 offset:28672
v_sub_u32 v198, v196, v198
v_mfma_f32_16x16x32_bf16 v[100:103], v[68:71], v[56:59], v[100:103]
ds_read_b64_tr_b16 v[190:191], v19 offset:30720
ds_read_b128 v[172:175], v3 offset:58368
v_bfe_u32 v199, v197, 2, 1
v_mfma_f32_16x16x32_bf16 v[104:107], v[72:75], v[56:59], v[104:107]
v_cmp_gt_u32 vcc, 8, v198
v_mfma_f32_16x16x32_bf16 v[108:111], v[76:79], v[56:59], v[108:111]
v_lshlrev_b32 v200, 1, v199
v_mfma_f32_16x16x32_bf16 v[124:127], v[76:79], v[60:63], v[124:127]
v_mul_u32_u24 v197, 7168, v197
v_mfma_f32_16x16x32_bf16 v[120:123], v[72:75], v[60:63], v[120:123]
v_cndmask_b32 v199, v199, v200, vcc
v_mfma_f32_16x16x32_bf16 v[116:119], v[68:71], v[60:63], v[116:119]
v_xor_b32 v198, v198, v199
v_mfma_f32_16x16x32_bf16 v[112:115], v[64:67], v[60:63], v[112:115]
v_lshl_add_u32 v192, v198, 4, v197
s_waitcnt lgkmcnt(0)
s_barrier
v_mfma_f32_16x16x32_bf16 v[96:99], v[152:155], v[144:147], v[96:99]
ds_read_b128 v[32:35], v2 offset:0
ds_read_b64_tr_b16 v[40:41], v16 offset:49152
v_mfma_f32_16x16x32_bf16 v[100:103], v[156:159], v[144:147], v[100:103]
ds_read_b64_tr_b16 v[42:43], v16 offset:51200
ds_read_b64_tr_b16 v[44:45], v17 offset:49152
v_mfma_f32_16x16x32_bf16 v[104:107], v[160:163], v[144:147], v[104:107]
ds_read_b64_tr_b16 v[46:47], v17 offset:51200
ds_read_b64_tr_b16 v[48:49], v18 offset:49152
v_mfma_f32_16x16x32_bf16 v[108:111], v[164:167], v[144:147], v[108:111]
ds_read_b64_tr_b16 v[50:51], v18 offset:51200
ds_read_b64_tr_b16 v[52:53], v19 offset:49152
v_mfma_f32_16x16x32_bf16 v[124:127], v[164:167], v[148:151], v[124:127]
ds_read_b64_tr_b16 v[54:55], v19 offset:51200
ds_read_b128 v[36:39], v2 offset:1024
v_mfma_f32_16x16x32_bf16 v[120:123], v[160:163], v[148:151], v[120:123]
ds_read_b128 v[56:59], v2 offset:8192
ds_read_b64_tr_b16 v[64:65], v16 offset:53248
v_mfma_f32_16x16x32_bf16 v[116:119], v[156:159], v[148:151], v[116:119]
ds_read_b64_tr_b16 v[66:67], v16 offset:55296
ds_read_b64_tr_b16 v[68:69], v17 offset:53248
v_mfma_f32_16x16x32_bf16 v[112:115], v[152:155], v[148:151], v[112:115]
ds_read_b64_tr_b16 v[70:71], v17 offset:55296
ds_read_b64_tr_b16 v[72:73], v18 offset:53248
v_mfma_f32_16x16x32_bf16 v[96:99], v[176:179], v[168:171], v[96:99]
ds_read_b64_tr_b16 v[74:75], v18 offset:55296
ds_read_b64_tr_b16 v[76:77], v19 offset:53248
v_add_u32 v196, 64, v1
v_mfma_f32_16x16x32_bf16 v[100:103], v[180:183], v[168:171], v[100:103]
ds_read_b64_tr_b16 v[78:79], v19 offset:55296
ds_read_b128 v[60:63], v2 offset:9216
v_mul_u32_u24 v197, 5462, v196
v_mfma_f32_16x16x32_bf16 v[104:107], v[184:187], v[168:171], v[104:107]
v_lshrrev_b32 v197, 16, v197
v_mfma_f32_16x16x32_bf16 v[108:111], v[188:191], v[168:171], v[108:111]
v_mul_u32_u24 v198, 12, v197
v_mfma_f32_16x16x32_bf16 v[124:127], v[188:191], v[172:175], v[124:127]
v_sub_u32 v198, v196, v198
v_mfma_f32_16x16x32_bf16 v[120:123], v[184:187], v[172:175], v[120:123]
v_bfe_u32 v199, v197, 2, 1
v_mfma_f32_16x16x32_bf16 v[116:119], v[180:183], v[172:175], v[116:119]
v_cmp_gt_u32 vcc, 8, v198
v_mfma_f32_16x16x32_bf16 v[112:115], v[176:179], v[172:175], v[112:115]
v_lshlrev_b32 v200, 1, v199
s_waitcnt lgkmcnt(0)
s_barrier
v_mfma_f32_16x16x32_bf16 v[96:99], v[40:43], v[32:35], v[96:99]
ds_read_b128 v[144:147], v2 offset:49152
ds_read_b64_tr_b16 v[152:153], v16 offset:57344
v_mfma_f32_16x16x32_bf16 v[100:103], v[44:47], v[32:35], v[100:103]
ds_read_b64_tr_b16 v[154:155], v16 offset:59392
ds_read_b64_tr_b16 v[156:157], v17 offset:57344
v_mfma_f32_16x16x32_bf16 v[104:107], v[48:51], v[32:35], v[104:107]
ds_read_b64_tr_b16 v[158:159], v17 offset:59392
ds_read_b64_tr_b16 v[160:161], v18 offset:57344
v_mfma_f32_16x16x32_bf16 v[108:111], v[52:55], v[32:35], v[108:111]
ds_read_b64_tr_b16 v[162:163], v18 offset:59392
ds_read_b64_tr_b16 v[164:165], v19 offset:57344
v_mfma_f32_16x16x32_bf16 v[124:127], v[52:55], v[36:39], v[124:127]
ds_read_b64_tr_b16 v[166:167], v19 offset:59392
ds_read_b128 v[148:151], v2 offset:50176
v_mfma_f32_16x16x32_bf16 v[120:123], v[48:51], v[36:39], v[120:123]
ds_read_b128 v[168:171], v2 offset:57344
ds_read_b64_tr_b16 v[176:177], v16 offset:61440
v_mfma_f32_16x16x32_bf16 v[116:119], v[44:47], v[36:39], v[116:119]
ds_read_b64_tr_b16 v[178:179], v16 offset:63488
ds_read_b64_tr_b16 v[180:181], v17 offset:61440
v_mfma_f32_16x16x32_bf16 v[112:115], v[40:43], v[36:39], v[112:115]
ds_read_b64_tr_b16 v[182:183], v17 offset:63488
ds_read_b64_tr_b16 v[184:185], v18 offset:61440
v_mfma_f32_16x16x32_bf16 v[96:99], v[64:67], v[56:59], v[96:99]
ds_read_b64_tr_b16 v[186:187], v18 offset:63488
ds_read_b64_tr_b16 v[188:189], v19 offset:61440
v_mul_u32_u24 v197, 7168, v197
v_mfma_f32_16x16x32_bf16 v[100:103], v[68:71], v[56:59], v[100:103]
ds_read_b64_tr_b16 v[190:191], v19 offset:63488
ds_read_b128 v[172:175], v2 offset:58368
v_cndmask_b32 v199, v199, v200, vcc
v_mfma_f32_16x16x32_bf16 v[104:107], v[72:75], v[56:59], v[104:107]
v_xor_b32 v198, v198, v199
v_mfma_f32_16x16x32_bf16 v[108:111], v[76:79], v[56:59], v[108:111]
v_lshl_add_u32 v193, v198, 4, v197
v_mfma_f32_16x16x32_bf16 v[124:127], v[76:79], v[60:63], v[124:127]
v_add_u32 v196, 128, v1
v_mfma_f32_16x16x32_bf16 v[120:123], v[72:75], v[60:63], v[120:123]
v_mul_u32_u24 v197, 5462, v196
v_mfma_f32_16x16x32_bf16 v[116:119], v[68:71], v[60:63], v[116:119]
v_lshrrev_b32 v197, 16, v197
v_mfma_f32_16x16x32_bf16 v[112:115], v[64:67], v[60:63], v[112:115]
v_mul_u32_u24 v198, 12, v197
s_waitcnt lgkmcnt(0)
s_barrier
v_mfma_f32_16x16x32_bf16 v[96:99], v[152:155], v[144:147], v[96:99]
ds_read_b128 v[32:35], v3 offset:0
ds_read_b64_tr_b16 v[40:41], v20 offset:0
v_mfma_f32_16x16x32_bf16 v[100:103], v[156:159], v[144:147], v[100:103]
ds_read_b64_tr_b16 v[42:43], v20 offset:2048
ds_read_b64_tr_b16 v[44:45], v21 offset:0
v_mfma_f32_16x16x32_bf16 v[104:107], v[160:163], v[144:147], v[104:107]
ds_read_b64_tr_b16 v[46:47], v21 offset:2048
ds_read_b64_tr_b16 v[48:49], v22 offset:0
v_mfma_f32_16x16x32_bf16 v[108:111], v[164:167], v[144:147], v[108:111]
ds_read_b64_tr_b16 v[50:51], v22 offset:2048
ds_read_b64_tr_b16 v[52:53], v23 offset:0
v_mfma_f32_16x16x32_bf16 v[124:127], v[164:167], v[148:151], v[124:127]
ds_read_b64_tr_b16 v[54:55], v23 offset:2048
ds_read_b128 v[36:39], v3 offset:1024
v_mfma_f32_16x16x32_bf16 v[120:123], v[160:163], v[148:151], v[120:123]
ds_read_b128 v[56:59], v3 offset:8192
ds_read_b64_tr_b16 v[64:65], v20 offset:4096
v_mfma_f32_16x16x32_bf16 v[116:119], v[156:159], v[148:151], v[116:119]
ds_read_b64_tr_b16 v[66:67], v20 offset:6144
ds_read_b64_tr_b16 v[68:69], v21 offset:4096
v_mfma_f32_16x16x32_bf16 v[112:115], v[152:155], v[148:151], v[112:115]
ds_read_b64_tr_b16 v[70:71], v21 offset:6144
ds_read_b64_tr_b16 v[72:73], v22 offset:4096
v_mfma_f32_16x16x32_bf16 v[96:99], v[176:179], v[168:171], v[96:99]
ds_read_b64_tr_b16 v[74:75], v22 offset:6144
ds_read_b64_tr_b16 v[76:77], v23 offset:4096
v_sub_u32 v198, v196, v198
v_mfma_f32_16x16x32_bf16 v[100:103], v[180:183], v[168:171], v[100:103]
ds_read_b64_tr_b16 v[78:79], v23 offset:6144
ds_read_b128 v[60:63], v3 offset:9216
v_bfe_u32 v199, v197, 2, 1
v_mfma_f32_16x16x32_bf16 v[104:107], v[184:187], v[168:171], v[104:107]
v_cmp_gt_u32 vcc, 8, v198
v_mfma_f32_16x16x32_bf16 v[108:111], v[188:191], v[168:171], v[108:111]
v_lshlrev_b32 v200, 1, v199
v_mfma_f32_16x16x32_bf16 v[124:127], v[188:191], v[172:175], v[124:127]
v_mul_u32_u24 v197, 7168, v197
v_mfma_f32_16x16x32_bf16 v[120:123], v[184:187], v[172:175], v[120:123]
v_cndmask_b32 v199, v199, v200, vcc
v_mfma_f32_16x16x32_bf16 v[116:119], v[180:183], v[172:175], v[116:119]
v_xor_b32 v198, v198, v199
v_mfma_f32_16x16x32_bf16 v[112:115], v[176:179], v[172:175], v[112:115]
v_lshl_add_u32 v194, v198, 4, v197
s_waitcnt lgkmcnt(0)
s_barrier
v_mfma_f32_16x16x32_bf16 v[96:99], v[40:43], v[32:35], v[96:99]
ds_read_b128 v[144:147], v3 offset:49152
ds_read_b64_tr_b16 v[152:153], v20 offset:8192
v_mfma_f32_16x16x32_bf16 v[100:103], v[44:47], v[32:35], v[100:103]
ds_read_b64_tr_b16 v[154:155], v20 offset:10240
ds_read_b64_tr_b16 v[156:157], v21 offset:8192
v_mfma_f32_16x16x32_bf16 v[104:107], v[48:51], v[32:35], v[104:107]
ds_read_b64_tr_b16 v[158:159], v21 offset:10240
ds_read_b64_tr_b16 v[160:161], v22 offset:8192
v_mfma_f32_16x16x32_bf16 v[108:111], v[52:55], v[32:35], v[108:111]
ds_read_b64_tr_b16 v[162:163], v22 offset:10240
ds_read_b64_tr_b16 v[164:165], v23 offset:8192
v_mfma_f32_16x16x32_bf16 v[124:127], v[52:55], v[36:39], v[124:127]
ds_read_b64_tr_b16 v[166:167], v23 offset:10240
ds_read_b128 v[148:151], v3 offset:50176
v_mfma_f32_16x16x32_bf16 v[120:123], v[48:51], v[36:39], v[120:123]
ds_read_b128 v[168:171], v3 offset:57344
ds_read_b64_tr_b16 v[176:177], v20 offset:12288
v_mfma_f32_16x16x32_bf16 v[116:119], v[44:47], v[36:39], v[116:119]
ds_read_b64_tr_b16 v[178:179], v20 offset:14336
ds_read_b64_tr_b16 v[180:181], v21 offset:12288
v_mfma_f32_16x16x32_bf16 v[112:115], v[40:43], v[36:39], v[112:115]
ds_read_b64_tr_b16 v[182:183], v21 offset:14336
ds_read_b64_tr_b16 v[184:185], v22 offset:12288
v_mfma_f32_16x16x32_bf16 v[96:99], v[64:67], v[56:59], v[96:99]
ds_read_b64_tr_b16 v[186:187], v22 offset:14336
ds_read_b64_tr_b16 v[188:189], v23 offset:12288
v_add_u32 v192, s43, v192
v_mfma_f32_16x16x32_bf16 v[100:103], v[68:71], v[56:59], v[100:103]
ds_read_b64_tr_b16 v[190:191], v23 offset:14336
ds_read_b128 v[172:175], v3 offset:58368
v_add_u32 v193, s43, v193
v_mfma_f32_16x16x32_bf16 v[104:107], v[72:75], v[56:59], v[104:107]
v_add_u32 v194, s43, v194
v_mfma_f32_16x16x32_bf16 v[108:111], v[76:79], v[56:59], v[108:111]
s_and_b32 s43, s36, 3
v_mfma_f32_16x16x32_bf16 v[124:127], v[76:79], v[60:63], v[124:127]
s_mul_i32 s50, s43, 6144
v_mfma_f32_16x16x32_bf16 v[120:123], v[72:75], v[60:63], v[120:123]
s_add_u32 s50, s50, 16384
v_mfma_f32_16x16x32_bf16 v[116:119], v[68:71], v[60:63], v[116:119]
s_bitcmp0_b32 s2, 0
v_mfma_f32_16x16x32_bf16 v[112:115], v[64:67], v[60:63], v[112:115]
s_cselect_b32 s88, s72, s74
s_waitcnt lgkmcnt(0)
s_barrier
v_mfma_f32_16x16x32_bf16 v[96:99], v[152:155], v[144:147], v[96:99]
ds_read_b128 v[32:35], v2 offset:0
ds_read_b64_tr_b16 v[40:41], v4 offset:16384
v_mfma_f32_16x16x32_bf16 v[100:103], v[156:159], v[144:147], v[100:103]
ds_read_b64_tr_b16 v[42:43], v4 offset:18432
ds_read_b64_tr_b16 v[44:45], v5 offset:16384
v_mfma_f32_16x16x32_bf16 v[104:107], v[160:163], v[144:147], v[104:107]
ds_read_b64_tr_b16 v[46:47], v5 offset:18432
ds_read_b64_tr_b16 v[48:49], v6 offset:16384
v_mfma_f32_16x16x32_bf16 v[108:111], v[164:167], v[144:147], v[108:111]
ds_read_b64_tr_b16 v[50:51], v6 offset:18432
ds_read_b64_tr_b16 v[52:53], v7 offset:16384
v_mfma_f32_16x16x32_bf16 v[124:127], v[164:167], v[148:151], v[124:127]
ds_read_b64_tr_b16 v[54:55], v7 offset:18432
ds_read_b128 v[36:39], v2 offset:1024
v_mfma_f32_16x16x32_bf16 v[120:123], v[160:163], v[148:151], v[120:123]
ds_read_b128 v[56:59], v2 offset:8192
ds_read_b64_tr_b16 v[64:65], v4 offset:20480
v_mfma_f32_16x16x32_bf16 v[116:119], v[156:159], v[148:151], v[116:119]
ds_read_b64_tr_b16 v[66:67], v4 offset:22528
ds_read_b64_tr_b16 v[68:69], v5 offset:20480
v_mfma_f32_16x16x32_bf16 v[112:115], v[152:155], v[148:151], v[112:115]
ds_read_b64_tr_b16 v[70:71], v5 offset:22528
ds_read_b64_tr_b16 v[72:73], v6 offset:20480
v_mfma_f32_16x16x32_bf16 v[96:99], v[176:179], v[168:171], v[96:99]
ds_read_b64_tr_b16 v[74:75], v6 offset:22528
ds_read_b64_tr_b16 v[76:77], v7 offset:20480
s_cselect_b32 s89, s73, s75
v_mfma_f32_16x16x32_bf16 v[100:103], v[180:183], v[168:171], v[100:103]
ds_read_b64_tr_b16 v[78:79], v7 offset:22528
ds_read_b128 v[60:63], v2 offset:9216
s_mov_b32 s90, 7340032
v_mfma_f32_16x16x32_bf16 v[104:107], v[184:187], v[168:171], v[104:107]
s_mov_b32 s91, 0x20000
v_mfma_f32_16x16x32_bf16 v[108:111], v[188:191], v[168:171], v[108:111]
s_bfe_u32 s44, s2, 0x30001
v_mfma_f32_16x16x32_bf16 v[124:127], v[188:191], v[172:175], v[124:127]
s_lshl_b32 s44, s44, 2
v_mfma_f32_16x16x32_bf16 v[120:123], v[184:187], v[172:175], v[120:123]
s_and_b32 s43, s36, 3
v_mfma_f32_16x16x32_bf16 v[116:119], v[180:183], v[172:175], v[116:119]
s_add_u32 s44, s44, s43
v_mfma_f32_16x16x32_bf16 v[112:115], v[176:179], v[172:175], v[112:115]
s_lshl_b32 s44, s44, 5
s_waitcnt lgkmcnt(0)
s_barrier
v_mfma_f32_16x16x32_bf16 v[96:99], v[40:43], v[32:35], v[96:99]
ds_read_b128 v[144:147], v2 offset:49152
ds_read_b64_tr_b16 v[152:153], v4 offset:24576
v_mfma_f32_16x16x32_bf16 v[100:103], v[44:47], v[32:35], v[100:103]
ds_read_b64_tr_b16 v[154:155], v4 offset:26624
ds_read_b64_tr_b16 v[156:157], v5 offset:24576
v_mfma_f32_16x16x32_bf16 v[104:107], v[48:51], v[32:35], v[104:107]
ds_read_b64_tr_b16 v[158:159], v5 offset:26624
ds_read_b64_tr_b16 v[160:161], v6 offset:24576
v_mfma_f32_16x16x32_bf16 v[108:111], v[52:55], v[32:35], v[108:111]
ds_read_b64_tr_b16 v[162:163], v6 offset:26624
ds_read_b64_tr_b16 v[164:165], v7 offset:24576
v_mfma_f32_16x16x32_bf16 v[124:127], v[52:55], v[36:39], v[124:127]
ds_read_b64_tr_b16 v[166:167], v7 offset:26624
ds_read_b128 v[148:151], v2 offset:50176
v_mfma_f32_16x16x32_bf16 v[120:123], v[48:51], v[36:39], v[120:123]
ds_read_b128 v[168:171], v2 offset:57344
ds_read_b64_tr_b16 v[176:177], v4 offset:28672
v_mfma_f32_16x16x32_bf16 v[116:119], v[44:47], v[36:39], v[116:119]
ds_read_b64_tr_b16 v[178:179], v4 offset:30720
ds_read_b64_tr_b16 v[180:181], v5 offset:28672
v_mfma_f32_16x16x32_bf16 v[112:115], v[40:43], v[36:39], v[112:115]
ds_read_b64_tr_b16 v[182:183], v5 offset:30720
ds_read_b64_tr_b16 v[184:185], v6 offset:28672
v_mfma_f32_16x16x32_bf16 v[96:99], v[64:67], v[56:59], v[96:99]
ds_read_b64_tr_b16 v[186:187], v6 offset:30720
ds_read_b64_tr_b16 v[188:189], v7 offset:28672
v_lshrrev_b32 v195, 4, v1
v_mfma_f32_16x16x32_bf16 v[100:103], v[68:71], v[56:59], v[100:103]
ds_read_b64_tr_b16 v[190:191], v7 offset:30720
ds_read_b128 v[172:175], v2 offset:58368
v_add_u32 v195, s44, v195
v_mfma_f32_16x16x32_bf16 v[104:107], v[72:75], v[56:59], v[104:107]
v_mul_u32_u24 v195, 7168, v195
v_mfma_f32_16x16x32_bf16 v[108:111], v[76:79], v[56:59], v[108:111]
v_and_b32 v196, 15, v1
v_mfma_f32_16x16x32_bf16 v[124:127], v[76:79], v[60:63], v[124:127]
v_lshl_add_u32 v195, v196, 4, v195
v_mfma_f32_16x16x32_bf16 v[120:123], v[72:75], v[60:63], v[120:123]
s_lshr_b32 s43, s2, 4
v_mfma_f32_16x16x32_bf16 v[116:119], v[68:71], v[60:63], v[116:119]
s_lshl_b32 s43, s43, 8
v_mfma_f32_16x16x32_bf16 v[112:115], v[64:67], v[60:63], v[112:115]
v_add_u32 v195, s43, v195
s_waitcnt lgkmcnt(0)
s_barrier
v_mfma_f32_16x16x32_bf16 v[96:99], v[152:155], v[144:147], v[96:99]
ds_read_b128 v[32:35], v3 offset:0
ds_read_b64_tr_b16 v[40:41], v4 offset:32768
v_mfma_f32_16x16x32_bf16 v[100:103], v[156:159], v[144:147], v[100:103]
ds_read_b64_tr_b16 v[42:43], v4 offset:34816
ds_read_b64_tr_b16 v[44:45], v5 offset:32768
v_mfma_f32_16x16x32_bf16 v[104:107], v[160:163], v[144:147], v[104:107]
ds_read_b64_tr_b16 v[46:47], v5 offset:34816
ds_read_b64_tr_b16 v[48:49], v6 offset:32768
v_mfma_f32_16x16x32_bf16 v[108:111], v[164:167], v[144:147], v[108:111]
ds_read_b64_tr_b16 v[50:51], v6 offset:34816
ds_read_b64_tr_b16 v[52:53], v7 offset:32768
v_mfma_f32_16x16x32_bf16 v[124:127], v[164:167], v[148:151], v[124:127]
ds_read_b64_tr_b16 v[54:55], v7 offset:34816
ds_read_b128 v[36:39], v3 offset:1024
v_mfma_f32_16x16x32_bf16 v[120:123], v[160:163], v[148:151], v[120:123]
ds_read_b128 v[56:59], v3 offset:8192
ds_read_b64_tr_b16 v[64:65], v4 offset:36864
v_mfma_f32_16x16x32_bf16 v[116:119], v[156:159], v[148:151], v[116:119]
ds_read_b64_tr_b16 v[66:67], v4 offset:38912
ds_read_b64_tr_b16 v[68:69], v5 offset:36864
v_mfma_f32_16x16x32_bf16 v[112:115], v[152:155], v[148:151], v[112:115]
ds_read_b64_tr_b16 v[70:71], v5 offset:38912
ds_read_b64_tr_b16 v[72:73], v6 offset:36864
v_mfma_f32_16x16x32_bf16 v[96:99], v[176:179], v[168:171], v[96:99]
ds_read_b64_tr_b16 v[74:75], v6 offset:38912
ds_read_b64_tr_b16 v[76:77], v7 offset:36864
s_waitcnt vmcnt(0)
v_mfma_f32_16x16x32_bf16 v[100:103], v[180:183], v[168:171], v[100:103]
ds_read_b64_tr_b16 v[78:79], v7 offset:38912
ds_read_b128 v[60:63], v3 offset:9216
v_permlane16_swap_b32 v128, v130
v_mfma_f32_16x16x32_bf16 v[104:107], v[184:187], v[168:171], v[104:107]
v_permlane16_swap_b32 v129, v131
v_mfma_f32_16x16x32_bf16 v[108:111], v[188:191], v[168:171], v[108:111]
v_permlane16_swap_b32 v132, v134
v_mfma_f32_16x16x32_bf16 v[124:127], v[188:191], v[172:175], v[124:127]
v_permlane16_swap_b32 v133, v135
v_mfma_f32_16x16x32_bf16 v[120:123], v[184:187], v[172:175], v[120:123]
v_permlane16_swap_b32 v136, v138
v_mfma_f32_16x16x32_bf16 v[116:119], v[180:183], v[172:175], v[116:119]
v_permlane16_swap_b32 v137, v139
v_mfma_f32_16x16x32_bf16 v[112:115], v[176:179], v[172:175], v[112:115]
v_permlane16_swap_b32 v140, v142
s_waitcnt lgkmcnt(0)
s_barrier
v_mfma_f32_16x16x32_bf16 v[96:99], v[40:43], v[32:35], v[96:99]
ds_read_b128 v[144:147], v3 offset:49152
ds_read_b64_tr_b16 v[152:153], v4 offset:40960
v_mfma_f32_16x16x32_bf16 v[100:103], v[44:47], v[32:35], v[100:103]
ds_read_b64_tr_b16 v[154:155], v4 offset:43008
ds_read_b64_tr_b16 v[156:157], v5 offset:40960
v_mfma_f32_16x16x32_bf16 v[104:107], v[48:51], v[32:35], v[104:107]
ds_read_b64_tr_b16 v[158:159], v5 offset:43008
ds_read_b64_tr_b16 v[160:161], v6 offset:40960
v_mfma_f32_16x16x32_bf16 v[108:111], v[52:55], v[32:35], v[108:111]
ds_read_b64_tr_b16 v[162:163], v6 offset:43008
ds_read_b64_tr_b16 v[164:165], v7 offset:40960
v_mfma_f32_16x16x32_bf16 v[124:127], v[52:55], v[36:39], v[124:127]
ds_read_b64_tr_b16 v[166:167], v7 offset:43008
ds_read_b128 v[148:151], v3 offset:50176
v_mfma_f32_16x16x32_bf16 v[120:123], v[48:51], v[36:39], v[120:123]
ds_read_b128 v[168:171], v3 offset:57344
ds_read_b64_tr_b16 v[176:177], v4 offset:45056
v_mfma_f32_16x16x32_bf16 v[116:119], v[44:47], v[36:39], v[116:119]
ds_read_b64_tr_b16 v[178:179], v4 offset:47104
ds_read_b64_tr_b16 v[180:181], v5 offset:45056
v_mfma_f32_16x16x32_bf16 v[112:115], v[40:43], v[36:39], v[112:115]
ds_read_b64_tr_b16 v[182:183], v5 offset:47104
ds_read_b64_tr_b16 v[184:185], v6 offset:45056
v_mfma_f32_16x16x32_bf16 v[96:99], v[64:67], v[56:59], v[96:99]
ds_read_b64_tr_b16 v[186:187], v6 offset:47104
ds_read_b64_tr_b16 v[188:189], v7 offset:45056
v_permlane16_swap_b32 v141, v143
v_mfma_f32_16x16x32_bf16 v[100:103], v[68:71], v[56:59], v[100:103]
ds_read_b64_tr_b16 v[190:191], v7 offset:47104
ds_read_b128 v[172:175], v3 offset:58368
v_lshlrev_b32 v204, 16, v128
v_mfma_f32_16x16x32_bf16 v[104:107], v[72:75], v[56:59], v[104:107]
v_and_b32 v205, 0xffff0000, v128
v_mfma_f32_16x16x32_bf16 v[108:111], v[76:79], v[56:59], v[108:111]
v_lshlrev_b32 v206, 16, v129
v_mfma_f32_16x16x32_bf16 v[124:127], v[76:79], v[60:63], v[124:127]
v_and_b32 v207, 0xffff0000, v129
v_mfma_f32_16x16x32_bf16 v[120:123], v[72:75], v[60:63], v[120:123]
v_lshlrev_b32 v208, 16, v130
v_mfma_f32_16x16x32_bf16 v[116:119], v[68:71], v[60:63], v[116:119]
v_and_b32 v209, 0xffff0000, v130
v_mfma_f32_16x16x32_bf16 v[112:115], v[64:67], v[60:63], v[112:115]
v_lshlrev_b32 v210, 16, v131
s_waitcnt lgkmcnt(0)
s_barrier
v_mfma_f32_16x16x32_bf16 v[96:99], v[152:155], v[144:147], v[96:99]
ds_read_b128 v[32:35], v2 offset:0
ds_read_b64_tr_b16 v[40:41], v16 offset:49152
v_mfma_f32_16x16x32_bf16 v[100:103], v[156:159], v[144:147], v[100:103]
ds_read_b64_tr_b16 v[42:43], v16 offset:51200
ds_read_b64_tr_b16 v[44:45], v17 offset:49152
v_mfma_f32_16x16x32_bf16 v[104:107], v[160:163], v[144:147], v[104:107]
ds_read_b64_tr_b16 v[46:47], v17 offset:51200
ds_read_b64_tr_b16 v[48:49], v18 offset:49152
v_mfma_f32_16x16x32_bf16 v[108:111], v[164:167], v[144:147], v[108:111]
ds_read_b64_tr_b16 v[50:51], v18 offset:51200
ds_read_b64_tr_b16 v[52:53], v19 offset:49152
v_mfma_f32_16x16x32_bf16 v[124:127], v[164:167], v[148:151], v[124:127]
ds_read_b64_tr_b16 v[54:55], v19 offset:51200
ds_read_b128 v[36:39], v2 offset:1024
v_mfma_f32_16x16x32_bf16 v[120:123], v[160:163], v[148:151], v[120:123]
ds_read_b128 v[56:59], v2 offset:8192
ds_read_b64_tr_b16 v[64:65], v16 offset:53248
v_mfma_f32_16x16x32_bf16 v[116:119], v[156:159], v[148:151], v[116:119]
ds_read_b64_tr_b16 v[66:67], v16 offset:55296
ds_read_b64_tr_b16 v[68:69], v17 offset:53248
v_mfma_f32_16x16x32_bf16 v[112:115], v[152:155], v[148:151], v[112:115]
ds_read_b64_tr_b16 v[70:71], v17 offset:55296
ds_read_b64_tr_b16 v[72:73], v18 offset:53248
v_mfma_f32_16x16x32_bf16 v[96:99], v[176:179], v[168:171], v[96:99]
ds_read_b64_tr_b16 v[74:75], v18 offset:55296
ds_read_b64_tr_b16 v[76:77], v19 offset:53248
v_and_b32 v211, 0xffff0000, v131
v_mfma_f32_16x16x32_bf16 v[100:103], v[180:183], v[168:171], v[100:103]
ds_read_b64_tr_b16 v[78:79], v19 offset:55296
ds_read_b128 v[60:63], v2 offset:9216
v_lshlrev_b32 v212, 16, v132
v_mfma_f32_16x16x32_bf16 v[104:107], v[184:187], v[168:171], v[104:107]
v_and_b32 v213, 0xffff0000, v132
v_mfma_f32_16x16x32_bf16 v[108:111], v[188:191], v[168:171], v[108:111]
v_lshlrev_b32 v214, 16, v133
v_mfma_f32_16x16x32_bf16 v[124:127], v[188:191], v[172:175], v[124:127]
v_and_b32 v215, 0xffff0000, v133
v_mfma_f32_16x16x32_bf16 v[120:123], v[184:187], v[172:175], v[120:123]
v_lshlrev_b32 v216, 16, v134
v_mfma_f32_16x16x32_bf16 v[116:119], v[180:183], v[172:175], v[116:119]
v_and_b32 v217, 0xffff0000, v134
v_mfma_f32_16x16x32_bf16 v[112:115], v[176:179], v[172:175], v[112:115]
v_lshlrev_b32 v218, 16, v135
s_waitcnt lgkmcnt(0)
s_barrier
v_mfma_f32_16x16x32_bf16 v[96:99], v[40:43], v[32:35], v[96:99]
ds_read_b128 v[144:147], v2 offset:49152
ds_read_b64_tr_b16 v[152:153], v16 offset:57344
v_mfma_f32_16x16x32_bf16 v[100:103], v[44:47], v[32:35], v[100:103]
ds_read_b64_tr_b16 v[154:155], v16 offset:59392
ds_read_b64_tr_b16 v[156:157], v17 offset:57344
v_mfma_f32_16x16x32_bf16 v[104:107], v[48:51], v[32:35], v[104:107]
ds_read_b64_tr_b16 v[158:159], v17 offset:59392
ds_read_b64_tr_b16 v[160:161], v18 offset:57344
v_mfma_f32_16x16x32_bf16 v[108:111], v[52:55], v[32:35], v[108:111]
ds_read_b64_tr_b16 v[162:163], v18 offset:59392
ds_read_b64_tr_b16 v[164:165], v19 offset:57344
v_mfma_f32_16x16x32_bf16 v[124:127], v[52:55], v[36:39], v[124:127]
ds_read_b64_tr_b16 v[166:167], v19 offset:59392
ds_read_b128 v[148:151], v2 offset:50176
v_mfma_f32_16x16x32_bf16 v[120:123], v[48:51], v[36:39], v[120:123]
ds_read_b128 v[168:171], v2 offset:57344
ds_read_b64_tr_b16 v[176:177], v16 offset:61440
v_mfma_f32_16x16x32_bf16 v[116:119], v[44:47], v[36:39], v[116:119]
ds_read_b64_tr_b16 v[178:179], v16 offset:63488
ds_read_b64_tr_b16 v[180:181], v17 offset:61440
v_mfma_f32_16x16x32_bf16 v[112:115], v[40:43], v[36:39], v[112:115]
ds_read_b64_tr_b16 v[182:183], v17 offset:63488
ds_read_b64_tr_b16 v[184:185], v18 offset:61440
v_mfma_f32_16x16x32_bf16 v[96:99], v[64:67], v[56:59], v[96:99]
ds_read_b64_tr_b16 v[186:187], v18 offset:63488
ds_read_b64_tr_b16 v[188:189], v19 offset:61440
v_and_b32 v219, 0xffff0000, v135
v_mfma_f32_16x16x32_bf16 v[100:103], v[68:71], v[56:59], v[100:103]
ds_read_b64_tr_b16 v[190:191], v19 offset:63488
ds_read_b128 v[172:175], v2 offset:58368
v_lshlrev_b32 v220, 16, v136
v_mfma_f32_16x16x32_bf16 v[104:107], v[72:75], v[56:59], v[104:107]
v_and_b32 v221, 0xffff0000, v136
v_mfma_f32_16x16x32_bf16 v[108:111], v[76:79], v[56:59], v[108:111]
v_lshlrev_b32 v222, 16, v137
v_mfma_f32_16x16x32_bf16 v[124:127], v[76:79], v[60:63], v[124:127]
v_and_b32 v223, 0xffff0000, v137
v_mfma_f32_16x16x32_bf16 v[120:123], v[72:75], v[60:63], v[120:123]
v_lshlrev_b32 v224, 16, v138
v_mfma_f32_16x16x32_bf16 v[116:119], v[68:71], v[60:63], v[116:119]
v_and_b32 v225, 0xffff0000, v138
v_mfma_f32_16x16x32_bf16 v[112:115], v[64:67], v[60:63], v[112:115]
v_lshlrev_b32 v226, 16, v139
s_waitcnt lgkmcnt(0)
s_barrier
v_mfma_f32_16x16x32_bf16 v[96:99], v[152:155], v[144:147], v[96:99]
ds_read_b128 v[32:35], v3 offset:0
ds_read_b64_tr_b16 v[40:41], v20 offset:0
v_mfma_f32_16x16x32_bf16 v[100:103], v[156:159], v[144:147], v[100:103]
ds_read_b64_tr_b16 v[42:43], v20 offset:2048
ds_read_b64_tr_b16 v[44:45], v21 offset:0
v_mfma_f32_16x16x32_bf16 v[104:107], v[160:163], v[144:147], v[104:107]
ds_read_b64_tr_b16 v[46:47], v21 offset:2048
ds_read_b64_tr_b16 v[48:49], v22 offset:0
v_mfma_f32_16x16x32_bf16 v[108:111], v[164:167], v[144:147], v[108:111]
ds_read_b64_tr_b16 v[50:51], v22 offset:2048
ds_read_b64_tr_b16 v[52:53], v23 offset:0
v_mfma_f32_16x16x32_bf16 v[124:127], v[164:167], v[148:151], v[124:127]
ds_read_b64_tr_b16 v[54:55], v23 offset:2048
ds_read_b128 v[36:39], v3 offset:1024
v_mfma_f32_16x16x32_bf16 v[120:123], v[160:163], v[148:151], v[120:123]
ds_read_b128 v[56:59], v3 offset:8192
ds_read_b64_tr_b16 v[64:65], v20 offset:4096
v_mfma_f32_16x16x32_bf16 v[116:119], v[156:159], v[148:151], v[116:119]
ds_read_b64_tr_b16 v[66:67], v20 offset:6144
ds_read_b64_tr_b16 v[68:69], v21 offset:4096
v_mfma_f32_16x16x32_bf16 v[112:115], v[152:155], v[148:151], v[112:115]
ds_read_b64_tr_b16 v[70:71], v21 offset:6144
ds_read_b64_tr_b16 v[72:73], v22 offset:4096
v_mfma_f32_16x16x32_bf16 v[96:99], v[176:179], v[168:171], v[96:99]
ds_read_b64_tr_b16 v[74:75], v22 offset:6144
ds_read_b64_tr_b16 v[76:77], v23 offset:4096
v_and_b32 v227, 0xffff0000, v139
v_mfma_f32_16x16x32_bf16 v[100:103], v[180:183], v[168:171], v[100:103]
ds_read_b64_tr_b16 v[78:79], v23 offset:6144
ds_read_b128 v[60:63], v3 offset:9216
v_lshlrev_b32 v228, 16, v140
v_mfma_f32_16x16x32_bf16 v[104:107], v[184:187], v[168:171], v[104:107]
s_branch Lov_6
.p2align 12
.fill 48, 4, 0xbf800000
Lst_6_0:
s_branch Lwr_151
s_nop 0
s_nop 0
Lov_6:
v_and_b32 v229, 0xffff0000, v140
v_mfma_f32_16x16x32_bf16 v[108:111], v[188:191], v[168:171], v[108:111]
v_lshlrev_b32 v230, 16, v141
v_mfma_f32_16x16x32_bf16 v[124:127], v[188:191], v[172:175], v[124:127]
v_and_b32 v231, 0xffff0000, v141
v_mfma_f32_16x16x32_bf16 v[120:123], v[184:187], v[172:175], v[120:123]
v_lshlrev_b32 v232, 16, v142
v_mfma_f32_16x16x32_bf16 v[116:119], v[180:183], v[172:175], v[116:119]
v_and_b32 v233, 0xffff0000, v142
v_mfma_f32_16x16x32_bf16 v[112:115], v[176:179], v[172:175], v[112:115]
v_lshlrev_b32 v234, 16, v143
s_waitcnt lgkmcnt(0)
s_barrier
v_mfma_f32_16x16x32_bf16 v[96:99], v[40:43], v[32:35], v[96:99]
ds_read_b128 v[144:147], v3 offset:49152
ds_read_b64_tr_b16 v[152:153], v20 offset:8192
v_mfma_f32_16x16x32_bf16 v[100:103], v[44:47], v[32:35], v[100:103]
ds_read_b64_tr_b16 v[154:155], v20 offset:10240
ds_read_b64_tr_b16 v[156:157], v21 offset:8192
v_mfma_f32_16x16x32_bf16 v[104:107], v[48:51], v[32:35], v[104:107]
ds_read_b64_tr_b16 v[158:159], v21 offset:10240
ds_read_b64_tr_b16 v[160:161], v22 offset:8192
v_mfma_f32_16x16x32_bf16 v[108:111], v[52:55], v[32:35], v[108:111]
ds_read_b64_tr_b16 v[162:163], v22 offset:10240
ds_read_b64_tr_b16 v[164:165], v23 offset:8192
v_mfma_f32_16x16x32_bf16 v[124:127], v[52:55], v[36:39], v[124:127]
ds_read_b64_tr_b16 v[166:167], v23 offset:10240
ds_read_b128 v[148:151], v3 offset:50176
v_mfma_f32_16x16x32_bf16 v[120:123], v[48:51], v[36:39], v[120:123]
ds_read_b128 v[168:171], v3 offset:57344
ds_read_b64_tr_b16 v[176:177], v20 offset:12288
v_mfma_f32_16x16x32_bf16 v[116:119], v[44:47], v[36:39], v[116:119]
ds_read_b64_tr_b16 v[178:179], v20 offset:14336
ds_read_b64_tr_b16 v[180:181], v21 offset:12288
v_mfma_f32_16x16x32_bf16 v[112:115], v[40:43], v[36:39], v[112:115]
ds_read_b64_tr_b16 v[182:183], v21 offset:14336
ds_read_b64_tr_b16 v[184:185], v22 offset:12288
v_mfma_f32_16x16x32_bf16 v[96:99], v[64:67], v[56:59], v[96:99]
ds_read_b64_tr_b16 v[186:187], v22 offset:14336
ds_read_b64_tr_b16 v[188:189], v23 offset:12288
v_and_b32 v235, 0xffff0000, v143
v_mfma_f32_16x16x32_bf16 v[100:103], v[68:71], v[56:59], v[100:103]
ds_read_b64_tr_b16 v[190:191], v23 offset:14336
ds_read_b128 v[172:175], v3 offset:58368
v_mfma_f32_16x16x32_bf16 v[104:107], v[72:75], v[56:59], v[104:107]
v_mfma_f32_16x16x32_bf16 v[108:111], v[76:79], v[56:59], v[108:111]
v_mfma_f32_16x16x32_bf16 v[124:127], v[76:79], v[60:63], v[124:127]
v_mfma_f32_16x16x32_bf16 v[120:123], v[72:75], v[60:63], v[120:123]
v_mfma_f32_16x16x32_bf16 v[116:119], v[68:71], v[60:63], v[116:119]
v_mfma_f32_16x16x32_bf16 v[112:115], v[64:67], v[60:63], v[112:115]
s_waitcnt lgkmcnt(0)
s_barrier
v_mfma_f32_16x16x32_bf16 v[96:99], v[152:155], v[144:147], v[96:99]
v_mfma_f32_16x16x32_bf16 v[100:103], v[156:159], v[144:147], v[100:103]
v_mfma_f32_16x16x32_bf16 v[104:107], v[160:163], v[144:147], v[104:107]
v_mfma_f32_16x16x32_bf16 v[108:111], v[164:167], v[144:147], v[108:111]
v_mfma_f32_16x16x32_bf16 v[124:127], v[164:167], v[148:151], v[124:127]
v_mfma_f32_16x16x32_bf16 v[120:123], v[160:163], v[148:151], v[120:123]
v_mfma_f32_16x16x32_bf16 v[116:119], v[156:159], v[148:151], v[116:119]
v_mfma_f32_16x16x32_bf16 v[112:115], v[152:155], v[148:151], v[112:115]
v_mfma_f32_16x16x32_bf16 v[96:99], v[176:179], v[168:171], v[96:99]
v_mfma_f32_16x16x32_bf16 v[100:103], v[180:183], v[168:171], v[100:103]
v_mfma_f32_16x16x32_bf16 v[104:107], v[184:187], v[168:171], v[104:107]
v_mfma_f32_16x16x32_bf16 v[108:111], v[188:191], v[168:171], v[108:111]
v_mfma_f32_16x16x32_bf16 v[124:127], v[188:191], v[172:175], v[124:127]
v_mfma_f32_16x16x32_bf16 v[120:123], v[184:187], v[172:175], v[120:123]
v_mfma_f32_16x16x32_bf16 v[116:119], v[180:183], v[172:175], v[116:119]
v_mfma_f32_16x16x32_bf16 v[112:115], v[176:179], v[172:175], v[112:115]
s_nop 3
v_pk_add_f32 v[96:97], v[96:97], v[204:205]
v_pk_add_f32 v[98:99], v[98:99], v[206:207]
v_pk_add_f32 v[100:101], v[100:101], v[208:209]
v_pk_add_f32 v[102:103], v[102:103], v[210:211]
v_cvt_pk_bf16_f32 v32, v96, v97
v_cvt_pk_bf16_f32 v33, v98, v99
v_cvt_pk_bf16_f32 v34, v100, v101
v_cvt_pk_bf16_f32 v35, v102, v103
s_add_u32 s43, s60, 0
buffer_store_dwordx4 v[32:35], v11, s[20:23], s43 offen offset:0 sc1
v_pk_add_f32 v[104:105], v[104:105], v[212:213]
v_pk_add_f32 v[106:107], v[106:107], v[214:215]
v_pk_add_f32 v[108:109], v[108:109], v[216:217]
v_pk_add_f32 v[110:111], v[110:111], v[218:219]
v_cvt_pk_bf16_f32 v36, v104, v105
v_cvt_pk_bf16_f32 v37, v106, v107
v_cvt_pk_bf16_f32 v38, v108, v109
v_cvt_pk_bf16_f32 v39, v110, v111
s_add_u32 s43, s60, 8192
buffer_store_dwordx4 v[36:39], v11, s[20:23], s43 offen offset:0 sc1
v_pk_add_f32 v[120:121], v[120:121], v[228:229]
v_pk_add_f32 v[122:123], v[122:123], v[230:231]
v_pk_add_f32 v[124:125], v[124:125], v[232:233]
v_pk_add_f32 v[126:127], v[126:127], v[234:235]
v_cvt_pk_bf16_f32 v44, v120, v121
v_cvt_pk_bf16_f32 v45, v122, v123
v_cvt_pk_bf16_f32 v46, v124, v125
v_cvt_pk_bf16_f32 v47, v126, v127
s_add_u32 s43, s60, 8192
buffer_store_dwordx4 v[44:47], v11, s[20:23], s43 offen offset:1024 sc1
v_pk_add_f32 v[112:113], v[112:113], v[220:221]
v_pk_add_f32 v[114:115], v[114:115], v[222:223]
v_pk_add_f32 v[116:117], v[116:117], v[224:225]
v_pk_add_f32 v[118:119], v[118:119], v[226:227]
v_cvt_pk_bf16_f32 v40, v112, v113
v_cvt_pk_bf16_f32 v41, v114, v115
v_cvt_pk_bf16_f32 v42, v116, v117
v_cvt_pk_bf16_f32 v43, v118, v119
s_add_u32 s43, s60, 0
buffer_store_dwordx4 v[40:43], v11, s[20:23], s43 offen offset:1024 sc1
v_mov_b32 v64, 0
v_mov_b32 v65, 0
v_mov_b32 v66, 0
v_mov_b32 v67, 0
v_mov_b32 v68, 0
v_mov_b32 v69, 0
v_mov_b32 v70, 0
v_mov_b32 v71, 0
v_dot2_f32_bf16 v64, v32, s61, v64
v_dot2_f32_bf16 v66, v32, v32, v66
v_dot2_f32_bf16 v68, v40, s61, v68
v_dot2_f32_bf16 v70, v40, v40, v70
v_dot2_f32_bf16 v65, v33, s61, v65
v_dot2_f32_bf16 v67, v33, v33, v67
v_dot2_f32_bf16 v69, v41, s61, v69
v_dot2_f32_bf16 v71, v41, v41, v71
v_dot2_f32_bf16 v64, v34, s61, v64
v_dot2_f32_bf16 v66, v34, v34, v66
v_dot2_f32_bf16 v68, v42, s61, v68
v_dot2_f32_bf16 v70, v42, v42, v70
v_dot2_f32_bf16 v65, v35, s61, v65
v_dot2_f32_bf16 v67, v35, v35, v67
v_dot2_f32_bf16 v69, v43, s61, v69
v_dot2_f32_bf16 v71, v43, v43, v71
v_dot2_f32_bf16 v64, v36, s61, v64
v_dot2_f32_bf16 v66, v36, v36, v66
v_dot2_f32_bf16 v68, v44, s61, v68
v_dot2_f32_bf16 v70, v44, v44, v70
v_dot2_f32_bf16 v65, v37, s61, v65
v_dot2_f32_bf16 v67, v37, v37, v67
v_dot2_f32_bf16 v69, v45, s61, v69
v_dot2_f32_bf16 v71, v45, v45, v71
v_dot2_f32_bf16 v64, v38, s61, v64
v_dot2_f32_bf16 v66, v38, v38, v66
v_dot2_f32_bf16 v68, v46, s61, v68
v_dot2_f32_bf16 v70, v46, v46, v70
v_dot2_f32_bf16 v65, v39, s61, v65
v_dot2_f32_bf16 v67, v39, v39, v67
v_dot2_f32_bf16 v69, v47, s61, v69
v_dot2_f32_bf16 v71, v47, v47, v71
s_nop 2
v_add_f32 v64, v64, v65
v_add_f32 v66, v66, v67
v_add_f32 v68, v68, v69
v_add_f32 v70, v70, v71
s_nop 1
v_permlane32_swap_b32 v64, v68
v_permlane32_swap_b32 v66, v70
v_add_f32 v64, v64, v68
v_add_f32 v66, v66, v70
s_nop 1
v_permlane16_swap_b32 v64, v66
v_add_f32 v64, v64, v66
buffer_store_dword v64, v9, s[24:27], 0 offen sc1
s_lshl_b32 s7, s34, 12
s_add_u32 s7, s7, 49280
v_lshl_add_u32 v4, v1, 8, s7
v_mov_b32 v5, 1
s_waitcnt vmcnt(0)
s_cmp_lg_u32 s36, 0
s_barrier
s_cbranch_scc1 Lk2end_83
s_mov_b64 exec, 0xffff
buffer_atomic_add v5, v4, s[56:59], 0 offen sc1
s_mov_b64 exec, -1
s_branch Lk2end_83
Lprod_84:
s_mul_i32 s43, s34, 262144
s_add_u32 s8, s82, s43
s_addc_u32 s9, s83, 0
s_mov_b32 s10, 262144
s_mov_b32 s11, 0x20000
s_lshl_b32 s43, s35, 7
s_add_u32 s12, s68, s43
s_addc_u32 s13, s69, 0
s_mov_b32 s14, 2095232
s_mov_b32 s15, 0x20000
s_and_b32 s47, s36, 3
s_lshl_b32 s39, s47, 12
v_lshlrev_b32 v2, 4, v1
v_add_u32 v2, s39, v2
v_lshrrev_b32 v12, 3, v1
v_and_b32 v13, 6, v12
v_and_b32 v3, 7, v1
v_xor_b32 v3, v3, v13
v_lshlrev_b32 v3, 4, v3
v_mul_u32_u24 v12, 2048, v12
v_add_u32 v3, v3, v12
s_lshl_b32 s43, s47, 15
v_add_u32 v3, s43, v3
s_lshl_b32 s40, s47, 11
s_add_u32 s37, s35, 0
s_and_b32 s37, s37, 15
s_lshl_b32 s37, s37, 14
s_add_u32 m0, s39, 0
s_nop 0
buffer_load_dwordx4 v2, s[8:11], s37 offen offset:0 sc1 lds
buffer_load_dwordx4 v2, s[8:11], s37 offen offset:1024 sc1 lds
buffer_load_dwordx4 v2, s[8:11], s37 offen offset:2048 sc1 lds
buffer_load_dwordx4 v2, s[8:11], s37 offen offset:3072 sc1 lds
s_add_u32 s38, s35, 4
s_and_b32 s38, s38, 15
s_lshl_b32 s38, s38, 17
s_add_u32 m0, s40, 114688
s_nop 0
buffer_load_dwordx4 v3, s[12:15], s38 offen lds
s_add_u32 m0, s40, 115712
s_add_u32 s38, s38, 16384
buffer_load_dwordx4 v3, s[12:15], s38 offen lds
s_add_u32 s38, s35, 5
s_and_b32 s38, s38, 15
s_lshl_b32 s38, s38, 17
s_add_u32 m0, s40, 122880
s_nop 0
buffer_load_dwordx4 v3, s[12:15], s38 offen lds
s_add_u32 m0, s40, 123904
s_add_u32 s38, s38, 16384
buffer_load_dwordx4 v3, s[12:15], s38 offen lds
s_add_u32 s38, s35, 6
s_and_b32 s38, s38, 15
s_lshl_b32 s38, s38, 17
s_add_u32 m0, s40, 131072
s_nop 0
buffer_load_dwordx4 v3, s[12:15], s38 offen lds
s_add_u32 m0, s40, 132096
s_add_u32 s38, s38, 16384
buffer_load_dwordx4 v3, s[12:15], s38 offen lds
s_add_u32 s38, s35, 7
s_and_b32 s38, s38, 15
s_lshl_b32 s38, s38, 17
s_add_u32 m0, s40, 139264
s_nop 0
buffer_load_dwordx4 v3, s[12:15], s38 offen lds
s_add_u32 m0, s40, 140288
s_add_u32 s38, s38, 16384
buffer_load_dwordx4 v3, s[12:15], s38 offen lds
s_bitcmp0_b32 s36, 1
s_cselect_b32 s44, s72, s74
s_cselect_b32 s45, s73, s75
s_mul_i32 s43, s35, 192
s_add_u32 s16, s44, s43
s_addc_u32 s17, s45, 0
s_add_u32 s16, s16, 4096
s_addc_u32 s17, s17, 0
s_mov_b32 s18, 7333056
s_mov_b32 s19, 0x20000
s_and_b32 s43, s36, 1
s_mul_i32 s43, s43, 229376
v_add_u32 v196, 0, v1
v_mul_u32_u24 v197, 5462, v196
v_lshrrev_b32 v197, 16, v197
v_mul_u32_u24 v198, 12, v197
v_sub_u32 v198, v196, v198
v_bfe_u32 v199, v197, 2, 1
v_cmp_gt_u32 vcc, 8, v198
v_lshlrev_b32 v200, 1, v199
v_mul_u32_u24 v197, 7168, v197
v_cndmask_b32 v199, v199, v200, vcc
v_xor_b32 v198, v198, v199
v_lshl_add_u32 v192, v198, 4, v197
v_add_u32 v196, 64, v1
v_mul_u32_u24 v197, 5462, v196
v_lshrrev_b32 v197, 16, v197
v_mul_u32_u24 v198, 12, v197
v_sub_u32 v198, v196, v198
v_bfe_u32 v199, v197, 2, 1
v_cmp_gt_u32 vcc, 8, v198
v_lshlrev_b32 v200, 1, v199
v_mul_u32_u24 v197, 7168, v197
v_cndmask_b32 v199, v199, v200, vcc
v_xor_b32 v198, v198, v199
v_lshl_add_u32 v193, v198, 4, v197
v_add_u32 v196, 128, v1
v_mul_u32_u24 v197, 5462, v196
v_lshrrev_b32 v197, 16, v197
v_mul_u32_u24 v198, 12, v197
v_sub_u32 v198, v196, v198
v_bfe_u32 v199, v197, 2, 1
v_cmp_gt_u32 vcc, 8, v198
v_lshlrev_b32 v200, 1, v199
v_mul_u32_u24 v197, 7168, v197
v_cndmask_b32 v199, v199, v200, vcc
v_xor_b32 v198, v198, v199
v_lshl_add_u32 v194, v198, 4, v197
v_add_u32 v192, s43, v192
v_add_u32 v193, s43, v193
v_add_u32 v194, s43, v194
s_and_b32 s43, s36, 3
s_mul_i32 s50, s43, 6144
s_add_u32 s50, s50, 16384
s_cmp_eq_u32 s47, 3
s_cbranch_scc0 Lw_91
s_lshl_b32 s92, s34, 4
s_add_u32 s92, s92, s35
s_lshl_b32 s92, s92, 8
s_add_u32 s92, s92, 49152
s_add_u32 s92, s92, 28311552
s_mov_b32 s41, 0x40000
Lpoll_92:
s_load_dword s93, s[82:83], s92 glc
Lpchk_94:
s_waitcnt lgkmcnt(0)
s_cmp_eq_u32 s93, 16
s_cbranch_scc1 Lpok_93
s_sub_u32 s41, s41, 1
s_cmp_lg_u32 s41, 0
s_cbranch_scc1 Lpoll_92
Lpok_93:
Lw_91:
s_and_b32 s44, s36, 3
s_mul_i32 s44, s44, 11
s_bfe_u32 s43, s2, 0x30001
s_lshl_b32 s43, s43, 7
s_add_u32 s44, s44, s43
s_add_u32 s44, s44, 84
s_mul_i32 s44, s44, 7168
s_lshr_b32 s43, s2, 4
s_lshl_b32 s43, s43, 8
s_add_u32 s43, s43, s44
s_bitcmp0_b32 s2, 0
s_cselect_b32 s4, s72, s74
s_cselect_b32 s5, s73, s75
s_add_u32 s4, s4, s43
s_addc_u32 s5, s5, 0
s_cmp_eq_u32 s47, 3
s_cbranch_scc1 Lw_95
Lw_95:
s_waitcnt vmcnt(8)
s_barrier
s_add_u32 s37, s35, 1
s_and_b32 s37, s37, 15
s_lshl_b32 s37, s37, 14
s_add_u32 m0, s39, 49152
s_nop 0
buffer_load_dwordx4 v2, s[8:11], s37 offen offset:0 sc1 lds
buffer_load_dwordx4 v2, s[8:11], s37 offen offset:1024 sc1 lds
buffer_load_dwordx4 v2, s[8:11], s37 offen offset:2048 sc1 lds
buffer_load_dwordx4 v2, s[8:11], s37 offen offset:3072 sc1 lds
s_add_u32 s37, s35, 2
s_and_b32 s37, s37, 15
s_lshl_b32 s37, s37, 14
s_add_u32 m0, s39, 98304
s_nop 0
buffer_load_dwordx4 v2, s[8:11], s37 offen offset:0 sc1 lds
buffer_load_dwordx4 v2, s[8:11], s37 offen offset:1024 sc1 lds
buffer_load_dwordx4 v2, s[8:11], s37 offen offset:2048 sc1 lds
buffer_load_dwordx4 v2, s[8:11], s37 offen offset:3072 sc1 lds
s_add_u32 s37, s35, 3
s_and_b32 s37, s37, 15
s_lshl_b32 s37, s37, 14
s_add_u32 m0, s39, 147456
s_nop 0
buffer_load_dwordx4 v2, s[8:11], s37 offen offset:0 sc1 lds
buffer_load_dwordx4 v2, s[8:11], s37 offen offset:1024 sc1 lds
buffer_load_dwordx4 v2, s[8:11], s37 offen offset:2048 sc1 lds
buffer_load_dwordx4 v2, s[8:11], s37 offen offset:3072 sc1 lds
s_cmp_eq_u32 s47, 3
s_cbranch_scc0 Lw_96
Lw_96:
s_waitcnt vmcnt(8)
s_barrier
s_add_u32 s37, s35, 4
s_and_b32 s37, s37, 15
s_lshl_b32 s37, s37, 14
s_add_u32 m0, s39, 0
s_nop 0
buffer_load_dwordx4 v2, s[8:11], s37 offen offset:0 sc1 lds
buffer_load_dwordx4 v2, s[8:11], s37 offen offset:1024 sc1 lds
buffer_load_dwordx4 v2, s[8:11], s37 offen offset:2048 sc1 lds
buffer_load_dwordx4 v2, s[8:11], s37 offen offset:3072 sc1 lds
s_add_u32 s38, s35, 8
s_and_b32 s38, s38, 15
s_lshl_b32 s38, s38, 17
s_add_u32 m0, s40, 16384
s_nop 0
buffer_load_dwordx4 v3, s[12:15], s38 offen lds
s_add_u32 m0, s40, 17408
s_add_u32 s38, s38, 16384
buffer_load_dwordx4 v3, s[12:15], s38 offen lds
v_lshlrev_b32 v240, 16, v128
v_and_b32 v241, 0xffff0000, v128
v_lshlrev_b32 v242, 16, v129
v_and_b32 v243, 0xffff0000, v129
v_lshlrev_b32 v244, 16, v130
v_and_b32 v245, 0xffff0000, v130
v_lshlrev_b32 v246, 16, v131
v_and_b32 v247, 0xffff0000, v131
s_waitcnt vmcnt(10)
s_barrier
s_add_u32 s37, s35, 5
s_and_b32 s37, s37, 15
s_lshl_b32 s37, s37, 14
s_add_u32 m0, s39, 49152
s_nop 0
buffer_load_dwordx4 v2, s[8:11], s37 offen offset:0 sc1 lds
buffer_load_dwordx4 v2, s[8:11], s37 offen offset:1024 sc1 lds
buffer_load_dwordx4 v2, s[8:11], s37 offen offset:2048 sc1 lds
buffer_load_dwordx4 v2, s[8:11], s37 offen offset:3072 sc1 lds
s_add_u32 s38, s35, 9
s_and_b32 s38, s38, 15
s_lshl_b32 s38, s38, 17
s_add_u32 m0, s40, 24576
s_nop 0
buffer_load_dwordx4 v3, s[12:15], s38 offen lds
s_add_u32 m0, s40, 25600
s_add_u32 s38, s38, 16384
buffer_load_dwordx4 v3, s[12:15], s38 offen lds
v_lshlrev_b32 v24, 16, v132
v_and_b32 v25, 0xffff0000, v132
v_lshlrev_b32 v26, 16, v133
v_and_b32 v27, 0xffff0000, v133
v_lshlrev_b32 v28, 16, v134
v_and_b32 v29, 0xffff0000, v134
v_lshlrev_b32 v30, 16, v135
v_and_b32 v31, 0xffff0000, v135
v_add_f32 v240, v240, v24
v_add_f32 v241, v241, v25
v_add_f32 v242, v242, v26
v_add_f32 v243, v243, v27
v_add_f32 v244, v244, v28
v_add_f32 v245, v245, v29
v_add_f32 v246, v246, v30
v_add_f32 v247, v247, v31
s_waitcnt vmcnt(12)
s_barrier
s_add_u32 s37, s35, 6
s_and_b32 s37, s37, 15
s_lshl_b32 s37, s37, 14
s_add_u32 m0, s39, 98304
s_nop 0
buffer_load_dwordx4 v2, s[8:11], s37 offen offset:0 sc1 lds
buffer_load_dwordx4 v2, s[8:11], s37 offen offset:1024 sc1 lds
buffer_load_dwordx4 v2, s[8:11], s37 offen offset:2048 sc1 lds
buffer_load_dwordx4 v2, s[8:11], s37 offen offset:3072 sc1 lds
s_add_u32 s38, s35, 10
s_and_b32 s38, s38, 15
s_lshl_b32 s38, s38, 17
s_add_u32 m0, s40, 32768
s_nop 0
buffer_load_dwordx4 v3, s[12:15], s38 offen lds
s_add_u32 m0, s40, 33792
s_add_u32 s38, s38, 16384
buffer_load_dwordx4 v3, s[12:15], s38 offen lds
v_lshlrev_b32 v24, 16, v136
v_and_b32 v25, 0xffff0000, v136
v_lshlrev_b32 v26, 16, v137
v_and_b32 v27, 0xffff0000, v137
v_lshlrev_b32 v28, 16, v138
v_and_b32 v29, 0xffff0000, v138
v_lshlrev_b32 v30, 16, v139
v_and_b32 v31, 0xffff0000, v139
v_add_f32 v240, v240, v24
v_add_f32 v241, v241, v25
v_add_f32 v242, v242, v26
v_add_f32 v243, v243, v27
v_add_f32 v244, v244, v28
v_add_f32 v245, v245, v29
v_add_f32 v246, v246, v30
v_add_f32 v247, v247, v31
s_waitcnt vmcnt(14)
s_barrier
s_add_u32 s37, s35, 7
s_and_b32 s37, s37, 15
s_lshl_b32 s37, s37, 14
s_add_u32 m0, s39, 147456
s_nop 0
buffer_load_dwordx4 v2, s[8:11], s37 offen offset:0 sc1 lds
buffer_load_dwordx4 v2, s[8:11], s37 offen offset:1024 sc1 lds
buffer_load_dwordx4 v2, s[8:11], s37 offen offset:2048 sc1 lds
buffer_load_dwordx4 v2, s[8:11], s37 offen offset:3072 sc1 lds
s_add_u32 s38, s35, 11
s_and_b32 s38, s38, 15
s_lshl_b32 s38, s38, 17
s_add_u32 m0, s40, 40960
s_nop 0
buffer_load_dwordx4 v3, s[12:15], s38 offen lds
s_add_u32 m0, s40, 41984
s_add_u32 s38, s38, 16384
buffer_load_dwordx4 v3, s[12:15], s38 offen lds
v_lshlrev_b32 v24, 16, v140
v_and_b32 v25, 0xffff0000, v140
v_lshlrev_b32 v26, 16, v141
v_and_b32 v27, 0xffff0000, v141
v_lshlrev_b32 v28, 16, v142
v_and_b32 v29, 0xffff0000, v142
v_lshlrev_b32 v30, 16, v143
v_and_b32 v31, 0xffff0000, v143
v_add_f32 v240, v240, v24
v_add_f32 v241, v241, v25
v_add_f32 v242, v242, v26
v_add_f32 v243, v243, v27
v_add_f32 v244, v244, v28
v_add_f32 v245, v245, v29
v_add_f32 v246, v246, v30
v_add_f32 v247, v247, v31
s_waitcnt vmcnt(14)
s_barrier
s_add_u32 s37, s35, 8
s_and_b32 s37, s37, 15
s_lshl_b32 s37, s37, 14
s_add_u32 m0, s39, 0
s_nop 0
buffer_load_dwordx4 v2, s[8:11], s37 offen offset:0 sc1 lds
buffer_load_dwordx4 v2, s[8:11], s37 offen offset:1024 sc1 lds
buffer_load_dwordx4 v2, s[8:11], s37 offen offset:2048 sc1 lds
buffer_load_dwordx4 v2, s[8:11], s37 offen offset:3072 sc1 lds
s_add_u32 s38, s35, 12
s_and_b32 s38, s38, 15
s_lshl_b32 s38, s38, 17
s_add_u32 m0, s40, 114688
s_nop 0
buffer_load_dwordx4 v3, s[12:15], s38 offen lds
s_add_u32 m0, s40, 115712
s_add_u32 s38, s38, 16384
buffer_load_dwordx4 v3, s[12:15], s38 offen lds
v_lshlrev_b32 v24, 16, v144
v_and_b32 v25, 0xffff0000, v144
v_lshlrev_b32 v26, 16, v145
v_and_b32 v27, 0xffff0000, v145
v_lshlrev_b32 v28, 16, v146
v_and_b32 v29, 0xffff0000, v146
v_lshlrev_b32 v30, 16, v147
v_and_b32 v31, 0xffff0000, v147
v_add_f32 v240, v240, v24
v_add_f32 v241, v241, v25
v_add_f32 v242, v242, v26
v_add_f32 v243, v243, v27
v_add_f32 v244, v244, v28
v_add_f32 v245, v245, v29
v_add_f32 v246, v246, v30
v_add_f32 v247, v247, v31
s_waitcnt vmcnt(14)
s_barrier
s_add_u32 s37, s35, 9
s_and_b32 s37, s37, 15
s_lshl_b32 s37, s37, 14
s_add_u32 m0, s39, 49152
s_nop 0
buffer_load_dwordx4 v2, s[8:11], s37 offen offset:0 sc1 lds
buffer_load_dwordx4 v2, s[8:11], s37 offen offset:1024 sc1 lds
buffer_load_dwordx4 v2, s[8:11], s37 offen offset:2048 sc1 lds
buffer_load_dwordx4 v2, s[8:11], s37 offen offset:3072 sc1 lds
s_add_u32 s38, s35, 13
s_and_b32 s38, s38, 15
s_lshl_b32 s38, s38, 17
s_add_u32 m0, s40, 122880
s_nop 0
buffer_load_dwordx4 v3, s[12:15], s38 offen lds
s_add_u32 m0, s40, 123904
s_add_u32 s38, s38, 16384
buffer_load_dwordx4 v3, s[12:15], s38 offen lds
v_lshlrev_b32 v24, 16, v148
v_and_b32 v25, 0xffff0000, v148
v_lshlrev_b32 v26, 16, v149
v_and_b32 v27, 0xffff0000, v149
v_lshlrev_b32 v28, 16, v150
v_and_b32 v29, 0xffff0000, v150
v_lshlrev_b32 v30, 16, v151
v_and_b32 v31, 0xffff0000, v151
v_add_f32 v240, v240, v24
v_add_f32 v241, v241, v25
v_add_f32 v242, v242, v26
v_add_f32 v243, v243, v27
v_add_f32 v244, v244, v28
v_add_f32 v245, v245, v29
v_add_f32 v246, v246, v30
v_add_f32 v247, v247, v31
s_waitcnt vmcnt(14)
s_barrier
s_add_u32 s37, s35, 10
s_and_b32 s37, s37, 15
s_lshl_b32 s37, s37, 14
s_add_u32 m0, s39, 98304
s_nop 0
buffer_load_dwordx4 v2, s[8:11], s37 offen offset:0 sc1 lds
buffer_load_dwordx4 v2, s[8:11], s37 offen offset:1024 sc1 lds
buffer_load_dwordx4 v2, s[8:11], s37 offen offset:2048 sc1 lds
buffer_load_dwordx4 v2, s[8:11], s37 offen offset:3072 sc1 lds
s_add_u32 s38, s35, 14
s_and_b32 s38, s38, 15
s_lshl_b32 s38, s38, 17
s_add_u32 m0, s40, 131072
s_nop 0
buffer_load_dwordx4 v3, s[12:15], s38 offen lds
s_add_u32 m0, s40, 132096
s_add_u32 s38, s38, 16384
buffer_load_dwordx4 v3, s[12:15], s38 offen lds
v_lshlrev_b32 v24, 16, v152
v_and_b32 v25, 0xffff0000, v152
v_lshlrev_b32 v26, 16, v153
v_and_b32 v27, 0xffff0000, v153
v_lshlrev_b32 v28, 16, v154
v_and_b32 v29, 0xffff0000, v154
v_lshlrev_b32 v30, 16, v155
v_and_b32 v31, 0xffff0000, v155
v_add_f32 v240, v240, v24
v_add_f32 v241, v241, v25
v_add_f32 v242, v242, v26
v_add_f32 v243, v243, v27
v_add_f32 v244, v244, v28
v_add_f32 v245, v245, v29
v_add_f32 v246, v246, v30
v_add_f32 v247, v247, v31
s_waitcnt vmcnt(14)
s_barrier
s_add_u32 s37, s35, 11
s_and_b32 s37, s37, 15
s_lshl_b32 s37, s37, 14
s_add_u32 m0, s39, 147456
s_nop 0
buffer_load_dwordx4 v2, s[8:11], s37 offen offset:0 sc1 lds
buffer_load_dwordx4 v2, s[8:11], s37 offen offset:1024 sc1 lds
buffer_load_dwordx4 v2, s[8:11], s37 offen offset:2048 sc1 lds
buffer_load_dwordx4 v2, s[8:11], s37 offen offset:3072 sc1 lds
s_add_u32 s38, s35, 15
s_and_b32 s38, s38, 15
s_lshl_b32 s38, s38, 17
s_add_u32 m0, s40, 139264
s_nop 0
buffer_load_dwordx4 v3, s[12:15], s38 offen lds
s_add_u32 m0, s40, 140288
s_add_u32 s38, s38, 16384
buffer_load_dwordx4 v3, s[12:15], s38 offen lds
v_lshlrev_b32 v24, 16, v156
v_and_b32 v25, 0xffff0000, v156
v_lshlrev_b32 v26, 16, v157
v_and_b32 v27, 0xffff0000, v157
v_lshlrev_b32 v28, 16, v158
v_and_b32 v29, 0xffff0000, v158
v_lshlrev_b32 v30, 16, v159
v_and_b32 v31, 0xffff0000, v159
v_add_f32 v240, v240, v24
v_add_f32 v241, v241, v25
v_add_f32 v242, v242, v26
v_add_f32 v243, v243, v27
v_add_f32 v244, v244, v28
v_add_f32 v245, v245, v29
v_add_f32 v246, v246, v30
v_add_f32 v247, v247, v31
s_waitcnt vmcnt(14)
s_barrier
s_add_u32 s37, s35, 12
s_and_b32 s37, s37, 15
s_lshl_b32 s37, s37, 14
s_add_u32 m0, s39, 0
s_nop 0
buffer_load_dwordx4 v2, s[8:11], s37 offen offset:0 sc1 lds
buffer_load_dwordx4 v2, s[8:11], s37 offen offset:1024 sc1 lds
buffer_load_dwordx4 v2, s[8:11], s37 offen offset:2048 sc1 lds
s_branch Lov_7
.p2align 12
.fill 48, 4, 0xbf800000
Lst_7_0:
s_branch Lwr_152
s_nop 0
s_nop 0
Lov_7:
buffer_load_dwordx4 v2, s[8:11], s37 offen offset:3072 sc1 lds
s_waitcnt vmcnt(12)
s_barrier
s_add_u32 s37, s35, 13
s_and_b32 s37, s37, 15
s_lshl_b32 s37, s37, 14
s_add_u32 m0, s39, 49152
s_nop 0
buffer_load_dwordx4 v2, s[8:11], s37 offen offset:0 sc1 lds
buffer_load_dwordx4 v2, s[8:11], s37 offen offset:1024 sc1 lds
buffer_load_dwordx4 v2, s[8:11], s37 offen offset:2048 sc1 lds
buffer_load_dwordx4 v2, s[8:11], s37 offen offset:3072 sc1 lds
s_waitcnt vmcnt(10)
s_barrier
s_add_u32 s37, s35, 14
s_and_b32 s37, s37, 15
s_lshl_b32 s37, s37, 14
s_add_u32 m0, s39, 98304
s_nop 0
buffer_load_dwordx4 v2, s[8:11], s37 offen offset:0 sc1 lds
buffer_load_dwordx4 v2, s[8:11], s37 offen offset:1024 sc1 lds
buffer_load_dwordx4 v2, s[8:11], s37 offen offset:2048 sc1 lds
buffer_load_dwordx4 v2, s[8:11], s37 offen offset:3072 sc1 lds
s_getpc_b64 s[100:101]
s_and_b32 s100, s100, 0xfffff000
s_sub_u32 s100, s100, 1081344
s_subb_u32 s101, s101, 0
s_lshr_b32 s6, s2, 3
s_mul_i32 s6, s6, 4
s_and_b32 s7, s36, 3
s_add_u32 s6, s6, s7
s_mulk_i32 s6, 384
s_add_u32 s6, s6, 1082176
s_load_dword s3, s[100:101], s6 offset:0
s_load_dword s3, s[100:101], s6 offset:64
s_load_dword s3, s[100:101], s6 offset:128
s_load_dword s3, s[100:101], s6 offset:192
s_load_dword s3, s[100:101], s6 offset:256
s_load_dword s3, s[100:101], s6 offset:320
s_nop 0
s_nop 0
s_waitcnt vmcnt(8)
s_barrier
s_add_u32 s37, s35, 15
s_and_b32 s37, s37, 15
s_lshl_b32 s37, s37, 14
s_add_u32 m0, s39, 147456
s_nop 0
buffer_load_dwordx4 v2, s[8:11], s37 offen offset:0 sc1 lds
buffer_load_dwordx4 v2, s[8:11], s37 offen offset:1024 sc1 lds
buffer_load_dwordx4 v2, s[8:11], s37 offen offset:2048 sc1 lds
buffer_load_dwordx4 v2, s[8:11], s37 offen offset:3072 sc1 lds
s_waitcnt vmcnt(8)
s_barrier
s_nop 0
v_permlane32_swap_b32 v240, v244
v_permlane32_swap_b32 v241, v245
v_permlane32_swap_b32 v242, v246
v_permlane32_swap_b32 v243, v247
v_add_f32 v240, v240, v244
v_add_f32 v241, v241, v245
v_add_f32 v242, v242, v246
v_add_f32 v243, v243, v247
s_nop 0
v_permlane16_swap_b32 v240, v242
v_permlane16_swap_b32 v241, v243
v_add_f32 v240, v240, v242
v_add_f32 v241, v241, v243
s_waitcnt vmcnt(4)
s_barrier
s_add_u32 s38, s35, 0
s_and_b32 s38, s38, 15
s_mul_i32 s38, s38, 458752
s_add_u32 m0, s50, 0
s_nop 0
buffer_load_dwordx4 v192, s[16:19], s38 offen lds
s_add_u32 m0, s50, 1024
s_nop 0
buffer_load_dwordx4 v193, s[16:19], s38 offen lds
s_add_u32 m0, s50, 2048
s_nop 0
buffer_load_dwordx4 v194, s[16:19], s38 offen lds
s_add_u32 m0, s50, 3072
s_add_u32 s38, s38, 114688
buffer_load_dwordx4 v192, s[16:19], s38 offen lds
s_add_u32 m0, s50, 4096
s_nop 0
buffer_load_dwordx4 v193, s[16:19], s38 offen lds
s_add_u32 m0, s50, 5120
s_nop 0
buffer_load_dwordx4 v194, s[16:19], s38 offen lds
s_add_u32 s38, s35, 1
s_and_b32 s38, s38, 15
s_mul_i32 s38, s38, 458752
s_add_u32 m0, s50, 49152
s_nop 0
buffer_load_dwordx4 v192, s[16:19], s38 offen lds
s_add_u32 m0, s50, 50176
s_nop 0
buffer_load_dwordx4 v193, s[16:19], s38 offen lds
s_add_u32 m0, s50, 51200
s_nop 0
buffer_load_dwordx4 v194, s[16:19], s38 offen lds
s_add_u32 m0, s50, 52224
s_add_u32 s38, s38, 114688
buffer_load_dwordx4 v192, s[16:19], s38 offen lds
s_add_u32 m0, s50, 53248
s_nop 0
buffer_load_dwordx4 v193, s[16:19], s38 offen lds
s_add_u32 m0, s50, 54272
s_nop 0
buffer_load_dwordx4 v194, s[16:19], s38 offen lds
s_waitcnt vmcnt(12)
s_barrier
s_barrier
s_branch Lk3a
Lk2end_83:
Lk3:
s_branch Lgb_97
Lk3a:
s_mul_i32 s43, s34, 262144
s_add_u32 s8, s82, s43
s_addc_u32 s9, s83, 0
s_add_u32 s8, s8, 4194304
s_addc_u32 s9, s9, 0
s_mov_b32 s10, 262144
s_mov_b32 s11, 0x20000
s_mul_i32 s43, s34, 917504
s_add_u32 s24, s82, s43
s_addc_u32 s25, s83, 0
s_add_u32 s24, s24, 8388608
s_addc_u32 s25, s25, 0
s_mov_b32 s26, 917504
s_mov_b32 s27, 0x20000
s_add_u32 s84, s82, 27262976
s_addc_u32 s85, s83, 0
s_mov_b32 s86, 229376
s_mov_b32 s87, 0x20000
s_and_b32 s47, s36, 3
s_lshr_b32 s62, s47, 1
s_and_b32 s63, s47, 1
v_lshlrev_b32 v2, 4, v1
s_lshl_b32 s39, s47, 12
v_add_u32 v3, s39, v2
s_bitcmp0_b32 s36, 1
s_cselect_b32 s44, s72, s74
s_cselect_b32 s45, s73, s75
s_mul_i32 s43, s35, 256
s_add_u32 s12, s44, s43
s_addc_u32 s13, s45, 0
s_mov_b32 s14, 7333120
s_mov_b32 s15, 0x20000
s_and_b32 s43, s36, 1
s_mul_i32 s43, s43, 229376
v_lshrrev_b32 v28, 4, v1
v_lshlrev_b32 v29, 1, v28
v_and_b32 v4, 15, v1
v_xor_b32 v4, v4, v29
v_lshlrev_b32 v4, 4, v4
v_mul_u32_u24 v28, 7168, v28
v_add_u32 v4, v4, v28
v_add_u32 v4, s43, v4
v_xor_b32 v5, 128, v4
v_add_u32 v5, 28672, v5
s_and_b32 s43, s36, 3
s_mul_i32 s40, s43, 8192
s_add_u32 s40, s40, 16384
v_mov_b32 v6, v192
v_mov_b32 v7, v193
v_mov_b32 v8, v194
s_lshl_b32 s43, s62, 12
v_add_u32 v9, s43, v2
v_add_u32 v10, 98304, v9
s_lshl_b32 s43, s47, 9
s_add_u32 s43, s43, 151552
v_and_b32 v28, 15, v1
v_lshl_add_u32 v28, v28, 5, s43
v_lshrrev_b32 v29, 4, v1
v_lshl_add_u32 v28, v29, 3, v28
ds_write_b64 v28, v[240:241]
s_waitcnt lgkmcnt(0)
v_lshrrev_b32 v27, 2, v1
v_bfe_u32 v28, v27, 2, 1
v_mul_u32_u24 v27, 192, v27
v_add_u32 v27, 16384, v27
v_and_b32 v29, 3, v1
v_lshl_add_u32 v12, v29, 3, v27
s_lshl_b32 s43, s63, 6
v_add_u32 v12, s43, v12
v_lshl_add_u32 v11, v28, 5, v12
v_xor_b32 v30, 1, v28
v_lshl_add_u32 v12, v30, 5, v12
v_xor_b32 v28, s63, v28
v_lshl_add_u32 v27, v28, 4, v27
v_lshrrev_b32 v28, 1, v29
v_lshl_add_u32 v27, v28, 5, v27
v_and_b32 v28, 1, v29
v_lshl_add_u32 v27, v28, 3, v27
v_add_u32 v13, 128, v27
v_add_u32 v14, 49152, v11
v_add_u32 v15, 49152, v12
v_add_u32 v16, 49152, v13
v_add_u32 v17, 98304, v11
v_add_u32 v18, 98304, v12
v_add_u32 v19, 98304, v13
s_cmp_lg_u32 s36, 4
s_cbranch_scc1 Lwm_99
s_branch Lst_8_1
Lwr_164:
s_branch Lwe_98
Lwm_99:
s_cmp_lg_u32 s36, 5
s_cbranch_scc1 Lwm_100
s_branch Lst_9_1
Lwr_165:
s_branch Lwe_98
Lwm_100:
s_cmp_lg_u32 s36, 6
s_cbranch_scc1 Lwm_101
s_branch Lst_10_1
Lwr_166:
s_branch Lwe_98
Lwm_101:
s_cmp_lg_u32 s36, 7
s_cbranch_scc1 Lwm_102
s_nop 0
s_branch Lwe_98
Lwm_102:
Lwe_98:
s_barrier
s_cmp_lg_u32 s36, 4
s_cbranch_scc1 Lwm_104
s_branch Lst_11_1
Lwr_168:
s_branch Lwe_103
Lwm_104:
s_cmp_lg_u32 s36, 5
s_cbranch_scc1 Lwm_105
s_branch Lst_12_1
Lwr_169:
s_branch Lwe_103
Lwm_105:
s_cmp_lg_u32 s36, 6
s_cbranch_scc1 Lwm_106
s_branch Lst_13_1
Lwr_170:
s_branch Lwe_103
Lwm_106:
s_cmp_lg_u32 s36, 7
s_cbranch_scc1 Lwm_107
s_branch Lst_14_1
Lwr_171:
s_branch Lwe_103
Lwm_107:
Lwe_103:
s_waitcnt vmcnt(0) lgkmcnt(0)
s_barrier
ds_read_b128 v[32:35], v9 offset:0
ds_read_b64_tr_b16 v[48:49], v11 offset:0
ds_read_b64_tr_b16 v[50:51], v11 offset:3072
ds_read_b64_tr_b16 v[52:53], v12 offset:0
ds_read_b64_tr_b16 v[54:55], v12 offset:3072
ds_read_b64_tr_b16 v[56:57], v13 offset:0
ds_read_b64_tr_b16 v[58:59], v13 offset:3072
ds_read_b64_tr_b16 v[60:61], v11 offset:12288
ds_read_b64_tr_b16 v[62:63], v11 offset:15360
ds_read_b64_tr_b16 v[64:65], v12 offset:12288
ds_read_b64_tr_b16 v[66:67], v12 offset:15360
ds_read_b64_tr_b16 v[68:69], v13 offset:12288
ds_read_b64_tr_b16 v[70:71], v13 offset:15360
ds_read_b128 v[36:39], v9 offset:1024
ds_read_b128 v[40:43], v9 offset:2048
ds_read_b128 v[44:47], v9 offset:3072
s_waitcnt lgkmcnt(0)
v_mfma_f32_16x16x32_bf16 v[128:131], v[48:51], v[32:35], 0
ds_read_b128 v[72:75], v9 offset:8192
v_mfma_f32_16x16x32_bf16 v[152:155], v[48:51], v[36:39], 0
ds_read_b64_tr_b16 v[88:89], v11 offset:6144
v_mfma_f32_16x16x32_bf16 v[176:179], v[48:51], v[40:43], 0
ds_read_b64_tr_b16 v[90:91], v11 offset:9216
v_mfma_f32_16x16x32_bf16 v[200:203], v[48:51], v[44:47], 0
ds_read_b64_tr_b16 v[92:93], v12 offset:6144
v_mfma_f32_16x16x32_bf16 v[204:207], v[52:55], v[44:47], 0
ds_read_b64_tr_b16 v[94:95], v12 offset:9216
v_mfma_f32_16x16x32_bf16 v[180:183], v[52:55], v[40:43], 0
ds_read_b64_tr_b16 v[96:97], v13 offset:6144
v_mfma_f32_16x16x32_bf16 v[156:159], v[52:55], v[36:39], 0
ds_read_b64_tr_b16 v[98:99], v13 offset:9216
v_mfma_f32_16x16x32_bf16 v[132:135], v[52:55], v[32:35], 0
ds_read_b64_tr_b16 v[100:101], v11 offset:18432
v_mfma_f32_16x16x32_bf16 v[136:139], v[56:59], v[32:35], 0
ds_read_b64_tr_b16 v[102:103], v11 offset:21504
v_mfma_f32_16x16x32_bf16 v[160:163], v[56:59], v[36:39], 0
ds_read_b64_tr_b16 v[104:105], v12 offset:18432
v_mfma_f32_16x16x32_bf16 v[184:187], v[56:59], v[40:43], 0
ds_read_b64_tr_b16 v[106:107], v12 offset:21504
v_mfma_f32_16x16x32_bf16 v[208:211], v[56:59], v[44:47], 0
ds_read_b64_tr_b16 v[108:109], v13 offset:18432
v_mfma_f32_16x16x32_bf16 v[212:215], v[60:63], v[44:47], 0
ds_read_b64_tr_b16 v[110:111], v13 offset:21504
v_mfma_f32_16x16x32_bf16 v[188:191], v[60:63], v[40:43], 0
ds_read_b128 v[76:79], v9 offset:9216
v_mfma_f32_16x16x32_bf16 v[164:167], v[60:63], v[36:39], 0
ds_read_b128 v[80:83], v9 offset:10240
v_mfma_f32_16x16x32_bf16 v[140:143], v[60:63], v[32:35], 0
ds_read_b128 v[84:87], v9 offset:11264
v_mfma_f32_16x16x32_bf16 v[144:147], v[64:67], v[32:35], 0
v_mfma_f32_16x16x32_bf16 v[168:171], v[64:67], v[36:39], 0
v_mfma_f32_16x16x32_bf16 v[192:195], v[64:67], v[40:43], 0
v_mfma_f32_16x16x32_bf16 v[216:219], v[64:67], v[44:47], 0
v_mfma_f32_16x16x32_bf16 v[220:223], v[68:71], v[44:47], 0
v_mfma_f32_16x16x32_bf16 v[196:199], v[68:71], v[40:43], 0
v_mfma_f32_16x16x32_bf16 v[172:175], v[68:71], v[36:39], 0
v_mfma_f32_16x16x32_bf16 v[148:151], v[68:71], v[32:35], 0
s_waitcnt lgkmcnt(0)
s_barrier
v_mfma_f32_16x16x32_bf16 v[128:131], v[88:91], v[72:75], v[128:131]
ds_read_b128 v[32:35], v9 offset:49152
v_mfma_f32_16x16x32_bf16 v[152:155], v[88:91], v[76:79], v[152:155]
ds_read_b64_tr_b16 v[48:49], v14 offset:0
v_mfma_f32_16x16x32_bf16 v[176:179], v[88:91], v[80:83], v[176:179]
ds_read_b64_tr_b16 v[50:51], v14 offset:3072
v_mfma_f32_16x16x32_bf16 v[200:203], v[88:91], v[84:87], v[200:203]
ds_read_b64_tr_b16 v[52:53], v15 offset:0
v_mfma_f32_16x16x32_bf16 v[204:207], v[92:95], v[84:87], v[204:207]
ds_read_b64_tr_b16 v[54:55], v15 offset:3072
v_mfma_f32_16x16x32_bf16 v[180:183], v[92:95], v[80:83], v[180:183]
ds_read_b64_tr_b16 v[56:57], v16 offset:0
v_mfma_f32_16x16x32_bf16 v[156:159], v[92:95], v[76:79], v[156:159]
ds_read_b64_tr_b16 v[58:59], v16 offset:3072
v_mfma_f32_16x16x32_bf16 v[132:135], v[92:95], v[72:75], v[132:135]
ds_read_b64_tr_b16 v[60:61], v14 offset:12288
v_mfma_f32_16x16x32_bf16 v[136:139], v[96:99], v[72:75], v[136:139]
ds_read_b64_tr_b16 v[62:63], v14 offset:15360
v_mfma_f32_16x16x32_bf16 v[160:163], v[96:99], v[76:79], v[160:163]
ds_read_b64_tr_b16 v[64:65], v15 offset:12288
v_mfma_f32_16x16x32_bf16 v[184:187], v[96:99], v[80:83], v[184:187]
ds_read_b64_tr_b16 v[66:67], v15 offset:15360
v_mfma_f32_16x16x32_bf16 v[208:211], v[96:99], v[84:87], v[208:211]
ds_read_b64_tr_b16 v[68:69], v16 offset:12288
v_mfma_f32_16x16x32_bf16 v[212:215], v[100:103], v[84:87], v[212:215]
ds_read_b64_tr_b16 v[70:71], v16 offset:15360
v_mfma_f32_16x16x32_bf16 v[188:191], v[100:103], v[80:83], v[188:191]
ds_read_b128 v[36:39], v9 offset:50176
v_mfma_f32_16x16x32_bf16 v[164:167], v[100:103], v[76:79], v[164:167]
ds_read_b128 v[40:43], v9 offset:51200
v_mfma_f32_16x16x32_bf16 v[140:143], v[100:103], v[72:75], v[140:143]
ds_read_b128 v[44:47], v9 offset:52224
v_mfma_f32_16x16x32_bf16 v[144:147], v[104:107], v[72:75], v[144:147]
v_mfma_f32_16x16x32_bf16 v[168:171], v[104:107], v[76:79], v[168:171]
v_mfma_f32_16x16x32_bf16 v[192:195], v[104:107], v[80:83], v[192:195]
v_mfma_f32_16x16x32_bf16 v[216:219], v[104:107], v[84:87], v[216:219]
v_mfma_f32_16x16x32_bf16 v[220:223], v[108:111], v[84:87], v[220:223]
v_mfma_f32_16x16x32_bf16 v[196:199], v[108:111], v[80:83], v[196:199]
v_mfma_f32_16x16x32_bf16 v[172:175], v[108:111], v[76:79], v[172:175]
v_mfma_f32_16x16x32_bf16 v[148:151], v[108:111], v[72:75], v[148:151]
s_mov_b32 s41, 5
Lk3l_108:
s_waitcnt lgkmcnt(0)
v_mfma_f32_16x16x32_bf16 v[128:131], v[48:51], v[32:35], v[128:131]
ds_read_b128 v[72:75], v9 offset:57344
v_mfma_f32_16x16x32_bf16 v[152:155], v[48:51], v[36:39], v[152:155]
ds_read_b64_tr_b16 v[88:89], v14 offset:6144
v_mfma_f32_16x16x32_bf16 v[176:179], v[48:51], v[40:43], v[176:179]
ds_read_b64_tr_b16 v[90:91], v14 offset:9216
v_mfma_f32_16x16x32_bf16 v[200:203], v[48:51], v[44:47], v[200:203]
ds_read_b64_tr_b16 v[92:93], v15 offset:6144
v_mfma_f32_16x16x32_bf16 v[204:207], v[52:55], v[44:47], v[204:207]
ds_read_b64_tr_b16 v[94:95], v15 offset:9216
v_mfma_f32_16x16x32_bf16 v[180:183], v[52:55], v[40:43], v[180:183]
ds_read_b64_tr_b16 v[96:97], v16 offset:6144
v_mfma_f32_16x16x32_bf16 v[156:159], v[52:55], v[36:39], v[156:159]
ds_read_b64_tr_b16 v[98:99], v16 offset:9216
v_mfma_f32_16x16x32_bf16 v[132:135], v[52:55], v[32:35], v[132:135]
ds_read_b64_tr_b16 v[100:101], v14 offset:18432
v_mfma_f32_16x16x32_bf16 v[136:139], v[56:59], v[32:35], v[136:139]
ds_read_b64_tr_b16 v[102:103], v14 offset:21504
v_mfma_f32_16x16x32_bf16 v[160:163], v[56:59], v[36:39], v[160:163]
ds_read_b64_tr_b16 v[104:105], v15 offset:18432
v_mfma_f32_16x16x32_bf16 v[184:187], v[56:59], v[40:43], v[184:187]
ds_read_b64_tr_b16 v[106:107], v15 offset:21504
v_mfma_f32_16x16x32_bf16 v[208:211], v[56:59], v[44:47], v[208:211]
ds_read_b64_tr_b16 v[108:109], v16 offset:18432
v_mfma_f32_16x16x32_bf16 v[212:215], v[60:63], v[44:47], v[212:215]
ds_read_b64_tr_b16 v[110:111], v16 offset:21504
v_mfma_f32_16x16x32_bf16 v[188:191], v[60:63], v[40:43], v[188:191]
ds_read_b128 v[76:79], v9 offset:58368
v_mfma_f32_16x16x32_bf16 v[164:167], v[60:63], v[36:39], v[164:167]
ds_read_b128 v[80:83], v9 offset:59392
v_mfma_f32_16x16x32_bf16 v[140:143], v[60:63], v[32:35], v[140:143]
ds_read_b128 v[84:87], v9 offset:60416
v_mfma_f32_16x16x32_bf16 v[144:147], v[64:67], v[32:35], v[144:147]
v_mfma_f32_16x16x32_bf16 v[168:171], v[64:67], v[36:39], v[168:171]
v_mfma_f32_16x16x32_bf16 v[192:195], v[64:67], v[40:43], v[192:195]
v_mfma_f32_16x16x32_bf16 v[216:219], v[64:67], v[44:47], v[216:219]
v_mfma_f32_16x16x32_bf16 v[220:223], v[68:71], v[44:47], v[220:223]
v_mfma_f32_16x16x32_bf16 v[196:199], v[68:71], v[40:43], v[196:199]
v_mfma_f32_16x16x32_bf16 v[172:175], v[68:71], v[36:39], v[172:175]
v_mfma_f32_16x16x32_bf16 v[148:151], v[68:71], v[32:35], v[148:151]
s_waitcnt lgkmcnt(0)
s_barrier
v_mfma_f32_16x16x32_bf16 v[128:131], v[88:91], v[72:75], v[128:131]
ds_read_b128 v[32:35], v10 offset:0
v_mfma_f32_16x16x32_bf16 v[152:155], v[88:91], v[76:79], v[152:155]
ds_read_b64_tr_b16 v[48:49], v17 offset:0
v_mfma_f32_16x16x32_bf16 v[176:179], v[88:91], v[80:83], v[176:179]
ds_read_b64_tr_b16 v[50:51], v17 offset:3072
v_mfma_f32_16x16x32_bf16 v[200:203], v[88:91], v[84:87], v[200:203]
ds_read_b64_tr_b16 v[52:53], v18 offset:0
v_mfma_f32_16x16x32_bf16 v[204:207], v[92:95], v[84:87], v[204:207]
ds_read_b64_tr_b16 v[54:55], v18 offset:3072
v_mfma_f32_16x16x32_bf16 v[180:183], v[92:95], v[80:83], v[180:183]
ds_read_b64_tr_b16 v[56:57], v19 offset:0
v_mfma_f32_16x16x32_bf16 v[156:159], v[92:95], v[76:79], v[156:159]
ds_read_b64_tr_b16 v[58:59], v19 offset:3072
v_mfma_f32_16x16x32_bf16 v[132:135], v[92:95], v[72:75], v[132:135]
ds_read_b64_tr_b16 v[60:61], v17 offset:12288
v_mfma_f32_16x16x32_bf16 v[136:139], v[96:99], v[72:75], v[136:139]
ds_read_b64_tr_b16 v[62:63], v17 offset:15360
v_mfma_f32_16x16x32_bf16 v[160:163], v[96:99], v[76:79], v[160:163]
ds_read_b64_tr_b16 v[64:65], v18 offset:12288
v_mfma_f32_16x16x32_bf16 v[184:187], v[96:99], v[80:83], v[184:187]
ds_read_b64_tr_b16 v[66:67], v18 offset:15360
v_mfma_f32_16x16x32_bf16 v[208:211], v[96:99], v[84:87], v[208:211]
ds_read_b64_tr_b16 v[68:69], v19 offset:12288
v_mfma_f32_16x16x32_bf16 v[212:215], v[100:103], v[84:87], v[212:215]
ds_read_b64_tr_b16 v[70:71], v19 offset:15360
v_mfma_f32_16x16x32_bf16 v[188:191], v[100:103], v[80:83], v[188:191]
ds_read_b128 v[36:39], v10 offset:1024
v_mfma_f32_16x16x32_bf16 v[164:167], v[100:103], v[76:79], v[164:167]
ds_read_b128 v[40:43], v10 offset:2048
v_mfma_f32_16x16x32_bf16 v[140:143], v[100:103], v[72:75], v[140:143]
ds_read_b128 v[44:47], v10 offset:3072
v_mfma_f32_16x16x32_bf16 v[144:147], v[104:107], v[72:75], v[144:147]
v_mfma_f32_16x16x32_bf16 v[168:171], v[104:107], v[76:79], v[168:171]
v_mfma_f32_16x16x32_bf16 v[192:195], v[104:107], v[80:83], v[192:195]
v_mfma_f32_16x16x32_bf16 v[216:219], v[104:107], v[84:87], v[216:219]
v_mfma_f32_16x16x32_bf16 v[220:223], v[108:111], v[84:87], v[220:223]
v_mfma_f32_16x16x32_bf16 v[196:199], v[108:111], v[80:83], v[196:199]
v_mfma_f32_16x16x32_bf16 v[172:175], v[108:111], v[76:79], v[172:175]
v_mfma_f32_16x16x32_bf16 v[148:151], v[108:111], v[72:75], v[148:151]
s_waitcnt lgkmcnt(0)
v_mfma_f32_16x16x32_bf16 v[128:131], v[48:51], v[32:35], v[128:131]
ds_read_b128 v[72:75], v10 offset:8192
v_mfma_f32_16x16x32_bf16 v[152:155], v[48:51], v[36:39], v[152:155]
ds_read_b64_tr_b16 v[88:89], v17 offset:6144
v_mfma_f32_16x16x32_bf16 v[176:179], v[48:51], v[40:43], v[176:179]
ds_read_b64_tr_b16 v[90:91], v17 offset:9216
v_mfma_f32_16x16x32_bf16 v[200:203], v[48:51], v[44:47], v[200:203]
ds_read_b64_tr_b16 v[92:93], v18 offset:6144
v_mfma_f32_16x16x32_bf16 v[204:207], v[52:55], v[44:47], v[204:207]
ds_read_b64_tr_b16 v[94:95], v18 offset:9216
v_mfma_f32_16x16x32_bf16 v[180:183], v[52:55], v[40:43], v[180:183]
ds_read_b64_tr_b16 v[96:97], v19 offset:6144
v_mfma_f32_16x16x32_bf16 v[156:159], v[52:55], v[36:39], v[156:159]
ds_read_b64_tr_b16 v[98:99], v19 offset:9216
v_mfma_f32_16x16x32_bf16 v[132:135], v[52:55], v[32:35], v[132:135]
ds_read_b64_tr_b16 v[100:101], v17 offset:18432
v_mfma_f32_16x16x32_bf16 v[136:139], v[56:59], v[32:35], v[136:139]
ds_read_b64_tr_b16 v[102:103], v17 offset:21504
v_mfma_f32_16x16x32_bf16 v[160:163], v[56:59], v[36:39], v[160:163]
ds_read_b64_tr_b16 v[104:105], v18 offset:18432
v_mfma_f32_16x16x32_bf16 v[184:187], v[56:59], v[40:43], v[184:187]
ds_read_b64_tr_b16 v[106:107], v18 offset:21504
v_mfma_f32_16x16x32_bf16 v[208:211], v[56:59], v[44:47], v[208:211]
ds_read_b64_tr_b16 v[108:109], v19 offset:18432
v_mfma_f32_16x16x32_bf16 v[212:215], v[60:63], v[44:47], v[212:215]
ds_read_b64_tr_b16 v[110:111], v19 offset:21504
v_mfma_f32_16x16x32_bf16 v[188:191], v[60:63], v[40:43], v[188:191]
ds_read_b128 v[76:79], v10 offset:9216
v_mfma_f32_16x16x32_bf16 v[164:167], v[60:63], v[36:39], v[164:167]
ds_read_b128 v[80:83], v10 offset:10240
v_mfma_f32_16x16x32_bf16 v[140:143], v[60:63], v[32:35], v[140:143]
ds_read_b128 v[84:87], v10 offset:11264
v_mfma_f32_16x16x32_bf16 v[144:147], v[64:67], v[32:35], v[144:147]
v_mfma_f32_16x16x32_bf16 v[168:171], v[64:67], v[36:39], v[168:171]
v_mfma_f32_16x16x32_bf16 v[192:195], v[64:67], v[40:43], v[192:195]
v_mfma_f32_16x16x32_bf16 v[216:219], v[64:67], v[44:47], v[216:219]
v_mfma_f32_16x16x32_bf16 v[220:223], v[68:71], v[44:47], v[220:223]
v_mfma_f32_16x16x32_bf16 v[196:199], v[68:71], v[40:43], v[196:199]
v_mfma_f32_16x16x32_bf16 v[172:175], v[68:71], v[36:39], v[172:175]
v_mfma_f32_16x16x32_bf16 v[148:151], v[68:71], v[32:35], v[148:151]
s_waitcnt lgkmcnt(0)
s_barrier
v_mfma_f32_16x16x32_bf16 v[128:131], v[88:91], v[72:75], v[128:131]
ds_read_b128 v[32:35], v9 offset:0
v_mfma_f32_16x16x32_bf16 v[152:155], v[88:91], v[76:79], v[152:155]
ds_read_b64_tr_b16 v[48:49], v11 offset:0
v_mfma_f32_16x16x32_bf16 v[176:179], v[88:91], v[80:83], v[176:179]
ds_read_b64_tr_b16 v[50:51], v11 offset:3072
v_mfma_f32_16x16x32_bf16 v[200:203], v[88:91], v[84:87], v[200:203]
ds_read_b64_tr_b16 v[52:53], v12 offset:0
v_mfma_f32_16x16x32_bf16 v[204:207], v[92:95], v[84:87], v[204:207]
ds_read_b64_tr_b16 v[54:55], v12 offset:3072
v_mfma_f32_16x16x32_bf16 v[180:183], v[92:95], v[80:83], v[180:183]
ds_read_b64_tr_b16 v[56:57], v13 offset:0
v_mfma_f32_16x16x32_bf16 v[156:159], v[92:95], v[76:79], v[156:159]
ds_read_b64_tr_b16 v[58:59], v13 offset:3072
v_mfma_f32_16x16x32_bf16 v[132:135], v[92:95], v[72:75], v[132:135]
ds_read_b64_tr_b16 v[60:61], v11 offset:12288
v_mfma_f32_16x16x32_bf16 v[136:139], v[96:99], v[72:75], v[136:139]
ds_read_b64_tr_b16 v[62:63], v11 offset:15360
v_mfma_f32_16x16x32_bf16 v[160:163], v[96:99], v[76:79], v[160:163]
ds_read_b64_tr_b16 v[64:65], v12 offset:12288
v_mfma_f32_16x16x32_bf16 v[184:187], v[96:99], v[80:83], v[184:187]
ds_read_b64_tr_b16 v[66:67], v12 offset:15360
v_mfma_f32_16x16x32_bf16 v[208:211], v[96:99], v[84:87], v[208:211]
ds_read_b64_tr_b16 v[68:69], v13 offset:12288
v_mfma_f32_16x16x32_bf16 v[212:215], v[100:103], v[84:87], v[212:215]
ds_read_b64_tr_b16 v[70:71], v13 offset:15360
v_mfma_f32_16x16x32_bf16 v[188:191], v[100:103], v[80:83], v[188:191]
ds_read_b128 v[36:39], v9 offset:1024
v_mfma_f32_16x16x32_bf16 v[164:167], v[100:103], v[76:79], v[164:167]
ds_read_b128 v[40:43], v9 offset:2048
v_mfma_f32_16x16x32_bf16 v[140:143], v[100:103], v[72:75], v[140:143]
ds_read_b128 v[44:47], v9 offset:3072
v_mfma_f32_16x16x32_bf16 v[144:147], v[104:107], v[72:75], v[144:147]
v_mfma_f32_16x16x32_bf16 v[168:171], v[104:107], v[76:79], v[168:171]
v_mfma_f32_16x16x32_bf16 v[192:195], v[104:107], v[80:83], v[192:195]
v_mfma_f32_16x16x32_bf16 v[216:219], v[104:107], v[84:87], v[216:219]
v_mfma_f32_16x16x32_bf16 v[220:223], v[108:111], v[84:87], v[220:223]
v_mfma_f32_16x16x32_bf16 v[196:199], v[108:111], v[80:83], v[196:199]
v_mfma_f32_16x16x32_bf16 v[172:175], v[108:111], v[76:79], v[172:175]
v_mfma_f32_16x16x32_bf16 v[148:151], v[108:111], v[72:75], v[148:151]
s_waitcnt lgkmcnt(0)
v_mfma_f32_16x16x32_bf16 v[128:131], v[48:51], v[32:35], v[128:131]
ds_read_b128 v[72:75], v9 offset:8192
v_mfma_f32_16x16x32_bf16 v[152:155], v[48:51], v[36:39], v[152:155]
ds_read_b64_tr_b16 v[88:89], v11 offset:6144
v_mfma_f32_16x16x32_bf16 v[176:179], v[48:51], v[40:43], v[176:179]
ds_read_b64_tr_b16 v[90:91], v11 offset:9216
v_mfma_f32_16x16x32_bf16 v[200:203], v[48:51], v[44:47], v[200:203]
ds_read_b64_tr_b16 v[92:93], v12 offset:6144
v_mfma_f32_16x16x32_bf16 v[204:207], v[52:55], v[44:47], v[204:207]
ds_read_b64_tr_b16 v[94:95], v12 offset:9216
v_mfma_f32_16x16x32_bf16 v[180:183], v[52:55], v[40:43], v[180:183]
ds_read_b64_tr_b16 v[96:97], v13 offset:6144
v_mfma_f32_16x16x32_bf16 v[156:159], v[52:55], v[36:39], v[156:159]
ds_read_b64_tr_b16 v[98:99], v13 offset:9216
v_mfma_f32_16x16x32_bf16 v[132:135], v[52:55], v[32:35], v[132:135]
ds_read_b64_tr_b16 v[100:101], v11 offset:18432
v_mfma_f32_16x16x32_bf16 v[136:139], v[56:59], v[32:35], v[136:139]
ds_read_b64_tr_b16 v[102:103], v11 offset:21504
v_mfma_f32_16x16x32_bf16 v[160:163], v[56:59], v[36:39], v[160:163]
ds_read_b64_tr_b16 v[104:105], v12 offset:18432
v_mfma_f32_16x16x32_bf16 v[184:187], v[56:59], v[40:43], v[184:187]
ds_read_b64_tr_b16 v[106:107], v12 offset:21504
v_mfma_f32_16x16x32_bf16 v[208:211], v[56:59], v[44:47], v[208:211]
ds_read_b64_tr_b16 v[108:109], v13 offset:18432
v_mfma_f32_16x16x32_bf16 v[212:215], v[60:63], v[44:47], v[212:215]
ds_read_b64_tr_b16 v[110:111], v13 offset:21504
v_mfma_f32_16x16x32_bf16 v[188:191], v[60:63], v[40:43], v[188:191]
ds_read_b128 v[76:79], v9 offset:9216
v_mfma_f32_16x16x32_bf16 v[164:167], v[60:63], v[36:39], v[164:167]
ds_read_b128 v[80:83], v9 offset:10240
v_mfma_f32_16x16x32_bf16 v[140:143], v[60:63], v[32:35], v[140:143]
ds_read_b128 v[84:87], v9 offset:11264
v_mfma_f32_16x16x32_bf16 v[144:147], v[64:67], v[32:35], v[144:147]
v_mfma_f32_16x16x32_bf16 v[168:171], v[64:67], v[36:39], v[168:171]
v_mfma_f32_16x16x32_bf16 v[192:195], v[64:67], v[40:43], v[192:195]
v_mfma_f32_16x16x32_bf16 v[216:219], v[64:67], v[44:47], v[216:219]
v_mfma_f32_16x16x32_bf16 v[220:223], v[68:71], v[44:47], v[220:223]
v_mfma_f32_16x16x32_bf16 v[196:199], v[68:71], v[40:43], v[196:199]
v_mfma_f32_16x16x32_bf16 v[172:175], v[68:71], v[36:39], v[172:175]
v_mfma_f32_16x16x32_bf16 v[148:151], v[68:71], v[32:35], v[148:151]
s_waitcnt lgkmcnt(0)
s_barrier
v_mfma_f32_16x16x32_bf16 v[128:131], v[88:91], v[72:75], v[128:131]
ds_read_b128 v[32:35], v9 offset:49152
v_mfma_f32_16x16x32_bf16 v[152:155], v[88:91], v[76:79], v[152:155]
ds_read_b64_tr_b16 v[48:49], v14 offset:0
v_mfma_f32_16x16x32_bf16 v[176:179], v[88:91], v[80:83], v[176:179]
ds_read_b64_tr_b16 v[50:51], v14 offset:3072
v_mfma_f32_16x16x32_bf16 v[200:203], v[88:91], v[84:87], v[200:203]
ds_read_b64_tr_b16 v[52:53], v15 offset:0
v_mfma_f32_16x16x32_bf16 v[204:207], v[92:95], v[84:87], v[204:207]
ds_read_b64_tr_b16 v[54:55], v15 offset:3072
v_mfma_f32_16x16x32_bf16 v[180:183], v[92:95], v[80:83], v[180:183]
ds_read_b64_tr_b16 v[56:57], v16 offset:0
v_mfma_f32_16x16x32_bf16 v[156:159], v[92:95], v[76:79], v[156:159]
ds_read_b64_tr_b16 v[58:59], v16 offset:3072
v_mfma_f32_16x16x32_bf16 v[132:135], v[92:95], v[72:75], v[132:135]
ds_read_b64_tr_b16 v[60:61], v14 offset:12288
v_mfma_f32_16x16x32_bf16 v[136:139], v[96:99], v[72:75], v[136:139]
ds_read_b64_tr_b16 v[62:63], v14 offset:15360
s_branch Lov_8
.p2align 12
.fill 64, 4, 0xbf800000
Lst_8_0:
s_branch Lwr_153
Lst_8_1:
s_branch Lwr_164
s_nop 0
Lov_8:
v_mfma_f32_16x16x32_bf16 v[160:163], v[96:99], v[76:79], v[160:163]
ds_read_b64_tr_b16 v[64:65], v15 offset:12288
v_mfma_f32_16x16x32_bf16 v[184:187], v[96:99], v[80:83], v[184:187]
ds_read_b64_tr_b16 v[66:67], v15 offset:15360
v_mfma_f32_16x16x32_bf16 v[208:211], v[96:99], v[84:87], v[208:211]
ds_read_b64_tr_b16 v[68:69], v16 offset:12288
v_mfma_f32_16x16x32_bf16 v[212:215], v[100:103], v[84:87], v[212:215]
ds_read_b64_tr_b16 v[70:71], v16 offset:15360
v_mfma_f32_16x16x32_bf16 v[188:191], v[100:103], v[80:83], v[188:191]
ds_read_b128 v[36:39], v9 offset:50176
v_mfma_f32_16x16x32_bf16 v[164:167], v[100:103], v[76:79], v[164:167]
ds_read_b128 v[40:43], v9 offset:51200
v_mfma_f32_16x16x32_bf16 v[140:143], v[100:103], v[72:75], v[140:143]
ds_read_b128 v[44:47], v9 offset:52224
v_mfma_f32_16x16x32_bf16 v[144:147], v[104:107], v[72:75], v[144:147]
v_mfma_f32_16x16x32_bf16 v[168:171], v[104:107], v[76:79], v[168:171]
v_mfma_f32_16x16x32_bf16 v[192:195], v[104:107], v[80:83], v[192:195]
v_mfma_f32_16x16x32_bf16 v[216:219], v[104:107], v[84:87], v[216:219]
v_mfma_f32_16x16x32_bf16 v[220:223], v[108:111], v[84:87], v[220:223]
v_mfma_f32_16x16x32_bf16 v[196:199], v[108:111], v[80:83], v[196:199]
v_mfma_f32_16x16x32_bf16 v[172:175], v[108:111], v[76:79], v[172:175]
v_mfma_f32_16x16x32_bf16 v[148:151], v[108:111], v[72:75], v[148:151]
s_sub_u32 s41, s41, 1
s_cmp_lg_u32 s41, 0
s_cbranch_scc1 Lk3l_108
s_waitcnt lgkmcnt(0)
s_add_u32 s38, s35, 15
s_and_b32 s38, s38, 15
s_mul_i32 s38, s38, 458752
s_add_u32 m0, s40, 0
s_nop 0
buffer_load_dwordx4 v4, s[12:15], s38 offen lds
v_lshrrev_b32 v86, 4, v1
s_lshl_b32 s43, s63, 7
s_add_u32 s43, s43, 148992
v_lshl_add_u32 v87, v86, 4, s43
v_lshrrev_b32 v88, 1, v86
v_and_b32 v86, 1, v86
s_add_u32 m0, s40, 1024
s_nop 0
buffer_load_dwordx4 v5, s[12:15], s38 offen lds
s_lshl_b32 s43, s63, 5
s_add_u32 s43, s43, 149248
v_lshl_add_u32 v88, v88, 6, s43
v_lshl_add_u32 v88, v86, 4, v88
v_and_b32 v86, 15, v1
s_lshl_b32 s43, s62, 9
s_add_u32 m0, s40, 2048
s_add_u32 s38, s38, 57344
buffer_load_dwordx4 v4, s[12:15], s38 offen lds
s_add_u32 s43, s43, 147456
v_lshl_add_u32 v86, v86, 3, s43
ds_read_b128 v[32:35], v87 offset:0
ds_read_b128 v[36:39], v87 offset:64
ds_read_b128 v[40:43], v88 offset:0
ds_read_b128 v[44:47], v87 offset:896
s_add_u32 m0, s40, 3072
s_nop 0
buffer_load_dwordx4 v5, s[12:15], s38 offen lds
ds_read_b128 v[48:51], v87 offset:960
ds_read_b128 v[52:55], v88 offset:896
ds_read_b64 v[56:57], v86 offset:0
ds_read_b64 v[58:59], v86 offset:128
ds_read_b64 v[60:61], v86 offset:256
ds_read_b64 v[62:63], v86 offset:384
s_add_u32 m0, s40, 4096
s_add_u32 s38, s38, 57344
buffer_load_dwordx4 v4, s[12:15], s38 offen lds
s_mul_i32 s54, s35, 24576
s_lshl_b32 s43, s62, 12
s_add_u32 s54, s54, s43
s_add_u32 s54, s54, 524288
s_lshl_b32 s43, s63, 9
s_add_u32 s55, s54, s43
s_add_u32 m0, s40, 5120
s_nop 0
buffer_load_dwordx4 v5, s[12:15], s38 offen lds
s_add_u32 s55, s55, 16384
s_lshl_b32 s43, s63, 13
s_add_u32 s54, s54, s43
v_and_b32 v84, 32, v1
v_lshlrev_b32 v84, 4, v84
v_add_u32 v84, v84, v2
s_waitcnt lgkmcnt(0)
s_add_u32 m0, s40, 6144
s_add_u32 s38, s38, 57344
buffer_load_dwordx4 v4, s[12:15], s38 offen lds
s_add_u32 m0, s40, 7168
s_nop 0
buffer_load_dwordx4 v5, s[12:15], s38 offen lds
s_and_b32 s44, s36, 3
s_mul_i32 s43, s2, 28672
s_mul_i32 s44, s44, 7168
s_add_u32 s43, s43, s44
s_add_u32 s4, s76, s43
s_addc_u32 s5, s77, 0
s_barrier
s_cmp_eq_u32 s47, 3
s_cbranch_scc0 Lw_109
v_and_b32 v90, 31, v1
v_lshlrev_b32 v90, 4, v90
v_add_u32 v91, 153600, v90
ds_read_b128 v[108:111], v91 offset:0
ds_read_b128 v[112:115], v91 offset:512
ds_read_b128 v[116:119], v91 offset:1024
ds_read_b128 v[120:123], v91 offset:1536
s_and_b32 s44, s2, 15
s_mul_i32 s44, s44, 14336
s_lshr_b32 s43, s2, 4
s_lshl_b32 s43, s43, 9
s_add_u32 s44, s44, s43
s_waitcnt lgkmcnt(0)
v_add_f32 v108, v108, v112
v_add_f32 v116, v116, v120
v_add_f32 v109, v109, v113
v_add_f32 v117, v117, v121
v_add_f32 v110, v110, v114
v_add_f32 v118, v118, v122
v_add_f32 v111, v111, v115
v_add_f32 v119, v119, v123
v_add_f32 v108, v108, v116
v_add_f32 v109, v109, v117
v_add_f32 v110, v110, v118
v_add_f32 v111, v111, v119
s_mov_b64 exec, 0xffffffff
buffer_store_dwordx4 v[108:111], v90, s[84:87], s44 offen sc1
s_mov_b64 exec, -1
Lw_109:
s_waitcnt lgkmcnt(0)
s_add_u32 s37, s35, 0
s_and_b32 s37, s37, 15
s_mul_i32 s37, s37, 16384
s_add_u32 m0, s39, 49152
s_nop 0
buffer_load_dwordx4 v3, s[8:11], s37 offen sc1 lds
s_load_dword s3, s[4:5], 1792
s_load_dword s3, s[4:5], 1856
s_load_dword s3, s[4:5], 1920
s_load_dword s3, s[4:5], 1984
s_load_dword s3, s[4:5], 2048
s_load_dword s3, s[4:5], 2112
s_load_dword s3, s[4:5], 2176
buffer_load_dwordx4 v3, s[8:11], s37 offen offset:1024 sc1 lds
s_load_dword s3, s[4:5], 2240
s_load_dword s3, s[4:5], 2304
s_load_dword s3, s[4:5], 2368
s_load_dword s3, s[4:5], 2432
s_load_dword s3, s[4:5], 2496
s_load_dword s3, s[4:5], 2560
s_load_dword s3, s[4:5], 2624
buffer_load_dwordx4 v3, s[8:11], s37 offen offset:2048 sc1 lds
v_mul_f32 v66, v57, v57
v_mul_f32 v64, 0xc0135761, v57
v_mul_f32 v65, 0xbdd2d3e8, v57
v_mul_f32 v65, v65, v66
v_rcp_f32 v66, v66
v_mul_f32 v70, v59, v59
v_mul_f32 v68, 0xc0135761, v59
buffer_load_dwordx4 v3, s[8:11], s37 offen offset:3072 sc1 lds
v_mul_f32 v69, 0xbdd2d3e8, v59
v_mul_f32 v69, v69, v70
v_rcp_f32 v70, v70
v_fma_f32 v128, -v56, v32, v128
v_fma_f32 v129, -v56, v33, v129
v_fma_f32 v130, -v56, v34, v130
v_fma_f32 v131, -v56, v35, v131
v_fma_f32 v152, -v58, v32, v152
s_add_u32 s38, s35, 0
s_and_b32 s38, s38, 15
s_mul_i32 s38, s38, 458752
s_add_u32 m0, s40, 49152
s_nop 0
buffer_load_dwordx4 v4, s[12:15], s38 offen lds
v_fma_f32 v153, -v58, v33, v153
v_fma_f32 v154, -v58, v34, v154
v_fma_f32 v155, -v58, v35, v155
v_mul_f32 v72, v128, v128
v_mul_f32 v73, v129, v129
v_mul_f32 v74, v130, v130
v_mul_f32 v75, v131, v131
s_add_u32 m0, s40, 50176
s_nop 0
buffer_load_dwordx4 v5, s[12:15], s38 offen lds
v_mul_f32 v76, v152, v152
v_mul_f32 v77, v153, v153
v_mul_f32 v78, v154, v154
v_mul_f32 v79, v155, v155
v_fma_f32 v72, v72, v65, v64
v_fma_f32 v73, v73, v65, v64
v_fma_f32 v74, v74, v65, v64
s_add_u32 m0, s40, 51200
s_add_u32 s38, s38, 57344
buffer_load_dwordx4 v4, s[12:15], s38 offen lds
v_fma_f32 v75, v75, v65, v64
v_fma_f32 v76, v76, v69, v68
v_fma_f32 v77, v77, v69, v68
v_fma_f32 v78, v78, v69, v68
v_fma_f32 v79, v79, v69, v68
v_mul_f32 v72, v72, v128
v_mul_f32 v73, v73, v129
v_mul_f32 v74, v74, v130
s_add_u32 m0, s40, 52224
s_nop 0
buffer_load_dwordx4 v5, s[12:15], s38 offen lds
v_mul_f32 v75, v75, v131
v_mul_f32 v76, v76, v152
v_mul_f32 v77, v77, v153
v_mul_f32 v78, v78, v154
v_mul_f32 v79, v79, v155
v_exp_f32 v72, v72
v_exp_f32 v73, v73
s_add_u32 m0, s40, 53248
s_add_u32 s38, s38, 57344
buffer_load_dwordx4 v4, s[12:15], s38 offen lds
v_exp_f32 v74, v74
v_exp_f32 v75, v75
v_exp_f32 v76, v76
v_exp_f32 v77, v77
v_exp_f32 v78, v78
v_exp_f32 v79, v79
v_fma_f32 v140, -v56, v44, v140
s_add_u32 m0, s40, 54272
s_nop 0
buffer_load_dwordx4 v5, s[12:15], s38 offen lds
v_fma_f32 v141, -v56, v45, v141
v_fma_f32 v142, -v56, v46, v142
v_fma_f32 v143, -v56, v47, v143
v_fma_f32 v164, -v58, v44, v164
v_fma_f32 v165, -v58, v45, v165
v_fma_f32 v166, -v58, v46, v166
v_fma_f32 v167, -v58, v47, v167
v_fma_f32 v72, v72, v66, v66
s_add_u32 m0, s40, 55296
s_add_u32 s38, s38, 57344
buffer_load_dwordx4 v4, s[12:15], s38 offen lds
s_add_u32 m0, s40, 56320
s_nop 0
buffer_load_dwordx4 v5, s[12:15], s38 offen lds
s_waitcnt vmcnt(12)
s_barrier
s_add_u32 s37, s35, 1
s_and_b32 s37, s37, 15
s_mul_i32 s37, s37, 16384
s_add_u32 m0, s39, 98304
s_nop 0
buffer_load_dwordx4 v3, s[8:11], s37 offen sc1 lds
v_fma_f32 v73, v73, v66, v66
v_fma_f32 v74, v74, v66, v66
v_fma_f32 v75, v75, v66, v66
v_fma_f32 v76, v76, v70, v70
v_fma_f32 v77, v77, v70, v70
v_fma_f32 v78, v78, v70, v70
buffer_load_dwordx4 v3, s[8:11], s37 offen offset:1024 sc1 lds
v_fma_f32 v79, v79, v70, v70
v_rcp_f32 v72, v72
v_rcp_f32 v73, v73
v_rcp_f32 v74, v74
v_rcp_f32 v75, v75
v_rcp_f32 v76, v76
buffer_load_dwordx4 v3, s[8:11], s37 offen offset:2048 sc1 lds
v_rcp_f32 v77, v77
v_rcp_f32 v78, v78
v_rcp_f32 v79, v79
v_mul_f32 v140, v128, v140
v_mul_f32 v141, v129, v141
v_mul_f32 v142, v130, v142
buffer_load_dwordx4 v3, s[8:11], s37 offen offset:3072 sc1 lds
v_mul_f32 v143, v131, v143
v_mul_f32 v164, v152, v164
v_mul_f32 v165, v153, v165
v_mul_f32 v166, v154, v166
v_mul_f32 v167, v155, v167
v_mul_f32 v140, v140, v72
s_add_u32 s38, s35, 1
s_and_b32 s38, s38, 15
s_mul_i32 s38, s38, 458752
s_add_u32 m0, s40, 98304
s_nop 0
buffer_load_dwordx4 v4, s[12:15], s38 offen lds
v_mul_f32 v141, v141, v73
v_mul_f32 v142, v142, v74
v_mul_f32 v143, v143, v75
v_mul_f32 v164, v164, v76
v_mul_f32 v165, v165, v77
v_mul_f32 v166, v166, v78
s_add_u32 m0, s40, 99328
s_nop 0
buffer_load_dwordx4 v5, s[12:15], s38 offen lds
v_mul_f32 v167, v167, v79
v_cvt_pk_bf16_f32 v128, v140, v141
v_cvt_pk_bf16_f32 v129, v142, v143
v_cvt_pk_bf16_f32 v152, v164, v165
v_cvt_pk_bf16_f32 v153, v166, v167
v_fma_f32 v132, -v56, v36, v132
s_add_u32 m0, s40, 100352
s_add_u32 s38, s38, 57344
buffer_load_dwordx4 v4, s[12:15], s38 offen lds
v_fma_f32 v133, -v56, v37, v133
v_fma_f32 v134, -v56, v38, v134
v_fma_f32 v135, -v56, v39, v135
v_fma_f32 v156, -v58, v36, v156
v_fma_f32 v157, -v58, v37, v157
v_fma_f32 v158, -v58, v38, v158
s_add_u32 m0, s40, 101376
s_nop 0
buffer_load_dwordx4 v5, s[12:15], s38 offen lds
v_fma_f32 v159, -v58, v39, v159
v_mul_f32 v72, v132, v132
v_mul_f32 v73, v133, v133
v_mul_f32 v74, v134, v134
v_mul_f32 v75, v135, v135
v_mul_f32 v76, v156, v156
s_add_u32 m0, s40, 102400
s_add_u32 s38, s38, 57344
buffer_load_dwordx4 v4, s[12:15], s38 offen lds
v_mul_f32 v77, v157, v157
v_mul_f32 v78, v158, v158
v_mul_f32 v79, v159, v159
v_fma_f32 v72, v72, v65, v64
v_fma_f32 v73, v73, v65, v64
v_fma_f32 v74, v74, v65, v64
s_add_u32 m0, s40, 103424
s_nop 0
buffer_load_dwordx4 v5, s[12:15], s38 offen lds
v_fma_f32 v75, v75, v65, v64
v_fma_f32 v76, v76, v69, v68
v_fma_f32 v77, v77, v69, v68
v_fma_f32 v78, v78, v69, v68
v_fma_f32 v79, v79, v69, v68
v_mul_f32 v72, v72, v132
s_add_u32 m0, s40, 104448
s_add_u32 s38, s38, 57344
buffer_load_dwordx4 v4, s[12:15], s38 offen lds
s_add_u32 m0, s40, 105472
s_nop 0
buffer_load_dwordx4 v5, s[12:15], s38 offen lds
s_waitcnt vmcnt(12)
s_barrier
s_cmp_eq_u32 s47, 3
s_cbranch_scc0 Lw_110
s_lshr_b32 s43, s2, 4
s_add_u32 s43, s43, 80
s_lshl_b32 s43, s43, 7
v_mov_b32 v90, s43
v_mov_b32 v91, 1
s_mov_b64 exec, 1
buffer_atomic_add v91, v90, s[56:59], 0 offen sc1
s_mov_b64 exec, -1
Lw_110:
s_waitcnt lgkmcnt(0)
s_add_u32 s37, s35, 2
s_and_b32 s37, s37, 15
s_mul_i32 s37, s37, 16384
s_add_u32 m0, s39, 0
s_nop 0
buffer_load_dwordx4 v3, s[8:11], s37 offen sc1 lds
s_load_dword s3, s[4:5], 2688
s_load_dword s3, s[4:5], 2752
s_load_dword s3, s[4:5], 2816
s_load_dword s3, s[4:5], 2880
s_load_dword s3, s[4:5], 2944
s_load_dword s3, s[4:5], 3008
s_load_dword s3, s[4:5], 3072
buffer_load_dwordx4 v3, s[8:11], s37 offen offset:1024 sc1 lds
s_load_dword s3, s[4:5], 3136
s_load_dword s3, s[4:5], 3200
s_load_dword s3, s[4:5], 3264
s_load_dword s3, s[4:5], 3328
s_load_dword s3, s[4:5], 3392
s_load_dword s3, s[4:5], 3456
s_load_dword s3, s[4:5], 3520
buffer_load_dwordx4 v3, s[8:11], s37 offen offset:2048 sc1 lds
v_mul_f32 v73, v73, v133
v_mul_f32 v74, v74, v134
v_mul_f32 v75, v75, v135
v_mul_f32 v76, v76, v156
v_mul_f32 v77, v77, v157
v_mul_f32 v78, v78, v158
v_mul_f32 v79, v79, v159
v_exp_f32 v72, v72
buffer_load_dwordx4 v3, s[8:11], s37 offen offset:3072 sc1 lds
v_exp_f32 v73, v73
v_exp_f32 v74, v74
v_exp_f32 v75, v75
v_exp_f32 v76, v76
v_exp_f32 v77, v77
v_exp_f32 v78, v78
v_exp_f32 v79, v79
s_add_u32 s38, s35, 2
s_and_b32 s38, s38, 15
s_mul_i32 s38, s38, 458752
s_add_u32 m0, s40, 0
s_nop 0
buffer_load_dwordx4 v4, s[12:15], s38 offen lds
v_fma_f32 v144, -v56, v48, v144
v_fma_f32 v145, -v56, v49, v145
v_fma_f32 v146, -v56, v50, v146
v_fma_f32 v147, -v56, v51, v147
v_fma_f32 v168, -v58, v48, v168
v_fma_f32 v169, -v58, v49, v169
v_fma_f32 v170, -v58, v50, v170
v_fma_f32 v171, -v58, v51, v171
s_add_u32 m0, s40, 1024
s_nop 0
buffer_load_dwordx4 v5, s[12:15], s38 offen lds
v_fma_f32 v72, v72, v66, v66
v_fma_f32 v73, v73, v66, v66
v_fma_f32 v74, v74, v66, v66
v_fma_f32 v75, v75, v66, v66
v_fma_f32 v76, v76, v70, v70
v_fma_f32 v77, v77, v70, v70
v_fma_f32 v78, v78, v70, v70
s_add_u32 m0, s40, 2048
s_add_u32 s38, s38, 57344
buffer_load_dwordx4 v4, s[12:15], s38 offen lds
v_fma_f32 v79, v79, v70, v70
v_rcp_f32 v72, v72
v_rcp_f32 v73, v73
v_rcp_f32 v74, v74
v_rcp_f32 v75, v75
v_rcp_f32 v76, v76
v_rcp_f32 v77, v77
s_add_u32 m0, s40, 3072
s_nop 0
buffer_load_dwordx4 v5, s[12:15], s38 offen lds
v_rcp_f32 v78, v78
v_rcp_f32 v79, v79
v_mul_f32 v144, v132, v144
v_mul_f32 v145, v133, v145
v_mul_f32 v146, v134, v146
v_mul_f32 v147, v135, v147
v_mul_f32 v168, v156, v168
v_mul_f32 v169, v157, v169
s_add_u32 m0, s40, 4096
s_add_u32 s38, s38, 57344
buffer_load_dwordx4 v4, s[12:15], s38 offen lds
v_mul_f32 v170, v158, v170
v_mul_f32 v171, v159, v171
v_mul_f32 v144, v144, v72
v_mul_f32 v145, v145, v73
v_mul_f32 v146, v146, v74
v_mul_f32 v147, v147, v75
v_mul_f32 v168, v168, v76
s_add_u32 m0, s40, 5120
s_nop 0
buffer_load_dwordx4 v5, s[12:15], s38 offen lds
v_mul_f32 v169, v169, v77
v_mul_f32 v170, v170, v78
v_mul_f32 v171, v171, v79
v_cvt_pk_bf16_f32 v130, v144, v145
v_cvt_pk_bf16_f32 v131, v146, v147
v_cvt_pk_bf16_f32 v154, v168, v169
v_cvt_pk_bf16_f32 v155, v170, v171
buffer_store_dwordx4 v[128:131], v2, s[24:27], s54 offen offset:0 sc1
s_add_u32 m0, s40, 6144
s_add_u32 s38, s38, 57344
buffer_load_dwordx4 v4, s[12:15], s38 offen lds
s_add_u32 m0, s40, 7168
s_nop 0
buffer_load_dwordx4 v5, s[12:15], s38 offen lds
s_waitcnt vmcnt(13)
s_barrier
s_add_u32 s37, s35, 3
s_and_b32 s37, s37, 15
s_mul_i32 s37, s37, 16384
s_add_u32 m0, s39, 49152
s_nop 0
buffer_load_dwordx4 v3, s[8:11], s37 offen sc1 lds
buffer_store_dwordx4 v[152:155], v2, s[24:27], s54 offen offset:1024 sc1
v_fma_f32 v136, -v56, v40, v136
v_fma_f32 v137, -v56, v41, v137
v_fma_f32 v138, -v56, v42, v138
v_fma_f32 v139, -v56, v43, v139
v_fma_f32 v160, -v58, v40, v160
buffer_load_dwordx4 v3, s[8:11], s37 offen offset:1024 sc1 lds
v_fma_f32 v161, -v58, v41, v161
v_fma_f32 v162, -v58, v42, v162
v_fma_f32 v163, -v58, v43, v163
v_mul_f32 v72, v136, v136
v_mul_f32 v73, v137, v137
v_mul_f32 v74, v138, v138
buffer_load_dwordx4 v3, s[8:11], s37 offen offset:2048 sc1 lds
v_mul_f32 v75, v139, v139
v_mul_f32 v76, v160, v160
v_mul_f32 v77, v161, v161
v_mul_f32 v78, v162, v162
v_mul_f32 v79, v163, v163
v_fma_f32 v72, v72, v65, v64
buffer_load_dwordx4 v3, s[8:11], s37 offen offset:3072 sc1 lds
v_fma_f32 v73, v73, v65, v64
v_fma_f32 v74, v74, v65, v64
v_fma_f32 v75, v75, v65, v64
v_fma_f32 v76, v76, v69, v68
v_fma_f32 v77, v77, v69, v68
v_fma_f32 v78, v78, v69, v68
s_add_u32 s38, s35, 3
s_and_b32 s38, s38, 15
s_mul_i32 s38, s38, 458752
s_add_u32 m0, s40, 49152
s_nop 0
buffer_load_dwordx4 v4, s[12:15], s38 offen lds
v_fma_f32 v79, v79, v69, v68
v_mul_f32 v72, v72, v136
v_mul_f32 v73, v73, v137
v_mul_f32 v74, v74, v138
v_mul_f32 v75, v75, v139
v_mul_f32 v76, v76, v160
s_add_u32 m0, s40, 50176
s_nop 0
buffer_load_dwordx4 v5, s[12:15], s38 offen lds
v_mul_f32 v77, v77, v161
v_mul_f32 v78, v78, v162
v_mul_f32 v79, v79, v163
v_exp_f32 v72, v72
v_exp_f32 v73, v73
v_exp_f32 v74, v74
s_add_u32 m0, s40, 51200
s_add_u32 s38, s38, 57344
buffer_load_dwordx4 v4, s[12:15], s38 offen lds
v_exp_f32 v75, v75
v_exp_f32 v76, v76
v_exp_f32 v77, v77
v_exp_f32 v78, v78
v_exp_f32 v79, v79
v_fma_f32 v148, -v56, v52, v148
s_add_u32 m0, s40, 52224
s_nop 0
buffer_load_dwordx4 v5, s[12:15], s38 offen lds
v_fma_f32 v149, -v56, v53, v149
v_fma_f32 v150, -v56, v54, v150
v_fma_f32 v151, -v56, v55, v151
v_fma_f32 v172, -v58, v52, v172
v_fma_f32 v173, -v58, v53, v173
v_fma_f32 v174, -v58, v54, v174
s_add_u32 m0, s40, 53248
s_add_u32 s38, s38, 57344
buffer_load_dwordx4 v4, s[12:15], s38 offen lds
v_fma_f32 v175, -v58, v55, v175
v_fma_f32 v72, v72, v66, v66
v_fma_f32 v73, v73, v66, v66
v_fma_f32 v74, v74, v66, v66
v_fma_f32 v75, v75, v66, v66
v_fma_f32 v76, v76, v70, v70
s_add_u32 m0, s40, 54272
s_nop 0
buffer_load_dwordx4 v5, s[12:15], s38 offen lds
v_fma_f32 v77, v77, v70, v70
v_fma_f32 v78, v78, v70, v70
v_fma_f32 v79, v79, v70, v70
v_rcp_f32 v72, v72
v_rcp_f32 v73, v73
v_rcp_f32 v74, v74
s_add_u32 m0, s40, 55296
s_add_u32 s38, s38, 57344
buffer_load_dwordx4 v4, s[12:15], s38 offen lds
s_add_u32 m0, s40, 56320
s_nop 0
buffer_load_dwordx4 v5, s[12:15], s38 offen lds
s_waitcnt vmcnt(13)
s_barrier
s_waitcnt lgkmcnt(0)
s_add_u32 s37, s35, 4
s_and_b32 s37, s37, 15
s_mul_i32 s37, s37, 16384
s_add_u32 m0, s39, 98304
s_nop 0
buffer_load_dwordx4 v3, s[8:11], s37 offen sc1 lds
s_load_dword s3, s[4:5], 3584
s_load_dword s3, s[4:5], 3648
s_load_dword s3, s[4:5], 3712
s_load_dword s3, s[4:5], 3776
s_load_dword s3, s[4:5], 3840
s_load_dword s3, s[4:5], 3904
s_load_dword s3, s[4:5], 3968
buffer_load_dwordx4 v3, s[8:11], s37 offen offset:1024 sc1 lds
s_load_dword s3, s[4:5], 4032
s_load_dword s3, s[4:5], 4096
s_load_dword s3, s[4:5], 4160
s_load_dword s3, s[4:5], 4224
s_load_dword s3, s[4:5], 4288
s_load_dword s3, s[4:5], 4352
s_load_dword s3, s[4:5], 4416
buffer_load_dwordx4 v3, s[8:11], s37 offen offset:2048 sc1 lds
v_rcp_f32 v75, v75
v_rcp_f32 v76, v76
v_rcp_f32 v77, v77
v_rcp_f32 v78, v78
v_rcp_f32 v79, v79
v_mul_f32 v148, v136, v148
v_mul_f32 v149, v137, v149
buffer_load_dwordx4 v3, s[8:11], s37 offen offset:3072 sc1 lds
v_mul_f32 v150, v138, v150
v_mul_f32 v151, v139, v151
v_mul_f32 v172, v160, v172
v_mul_f32 v173, v161, v173
v_mul_f32 v174, v162, v174
v_mul_f32 v175, v163, v175
v_mul_f32 v148, v148, v72
v_mul_f32 v149, v149, v73
s_add_u32 s38, s35, 4
s_and_b32 s38, s38, 15
s_mul_i32 s38, s38, 458752
s_add_u32 m0, s40, 98304
s_nop 0
buffer_load_dwordx4 v4, s[12:15], s38 offen lds
v_mul_f32 v150, v150, v74
v_mul_f32 v151, v151, v75
v_mul_f32 v172, v172, v76
v_mul_f32 v173, v173, v77
v_mul_f32 v174, v174, v78
v_mul_f32 v175, v175, v79
v_cvt_pk_bf16_f32 v80, v148, v149
s_add_u32 m0, s40, 99328
s_nop 0
buffer_load_dwordx4 v5, s[12:15], s38 offen lds
v_cvt_pk_bf16_f32 v81, v150, v151
v_cvt_pk_bf16_f32 v82, v172, v173
s_branch Lov_9
.p2align 12
.fill 64, 4, 0xbf800000
Lst_9_0:
s_branch Lwr_154
Lst_9_1:
s_branch Lwr_165
s_nop 0
Lov_9:
v_cvt_pk_bf16_f32 v83, v174, v175
s_nop 1
v_permlane32_swap_b32 v80, v82
v_permlane32_swap_b32 v81, v83
buffer_store_dwordx4 v[80:83], v84, s[24:27], s55 offen offset:0 sc1
s_add_u32 m0, s40, 100352
s_add_u32 s38, s38, 57344
buffer_load_dwordx4 v4, s[12:15], s38 offen lds
s_nop 1
v_mul_f32 v66, v61, v61
v_mul_f32 v64, 0xc0135761, v61
v_mul_f32 v65, 0xbdd2d3e8, v61
v_mul_f32 v65, v65, v66
v_rcp_f32 v66, v66
v_mul_f32 v70, v63, v63
v_mul_f32 v68, 0xc0135761, v63
s_add_u32 m0, s40, 101376
s_nop 0
buffer_load_dwordx4 v5, s[12:15], s38 offen lds
v_mul_f32 v69, 0xbdd2d3e8, v63
v_mul_f32 v69, v69, v70
v_rcp_f32 v70, v70
v_fma_f32 v176, -v60, v32, v176
v_fma_f32 v177, -v60, v33, v177
v_fma_f32 v178, -v60, v34, v178
v_fma_f32 v179, -v60, v35, v179
s_add_u32 m0, s40, 102400
s_add_u32 s38, s38, 57344
buffer_load_dwordx4 v4, s[12:15], s38 offen lds
v_fma_f32 v200, -v62, v32, v200
v_fma_f32 v201, -v62, v33, v201
v_fma_f32 v202, -v62, v34, v202
v_fma_f32 v203, -v62, v35, v203
v_mul_f32 v72, v176, v176
v_mul_f32 v73, v177, v177
v_mul_f32 v74, v178, v178
s_add_u32 m0, s40, 103424
s_nop 0
buffer_load_dwordx4 v5, s[12:15], s38 offen lds
v_mul_f32 v75, v179, v179
v_mul_f32 v76, v200, v200
v_mul_f32 v77, v201, v201
v_mul_f32 v78, v202, v202
v_mul_f32 v79, v203, v203
v_fma_f32 v72, v72, v65, v64
v_fma_f32 v73, v73, v65, v64
v_fma_f32 v74, v74, v65, v64
s_add_u32 m0, s40, 104448
s_add_u32 s38, s38, 57344
buffer_load_dwordx4 v4, s[12:15], s38 offen lds
s_add_u32 m0, s40, 105472
s_nop 0
buffer_load_dwordx4 v5, s[12:15], s38 offen lds
s_waitcnt vmcnt(13)
s_barrier
s_add_u32 s37, s35, 5
s_and_b32 s37, s37, 15
s_mul_i32 s37, s37, 16384
s_add_u32 m0, s39, 0
s_nop 0
buffer_load_dwordx4 v3, s[8:11], s37 offen sc1 lds
v_fma_f32 v75, v75, v65, v64
v_fma_f32 v76, v76, v69, v68
v_fma_f32 v77, v77, v69, v68
v_fma_f32 v78, v78, v69, v68
v_fma_f32 v79, v79, v69, v68
v_mul_f32 v72, v72, v176
buffer_load_dwordx4 v3, s[8:11], s37 offen offset:1024 sc1 lds
v_mul_f32 v73, v73, v177
v_mul_f32 v74, v74, v178
v_mul_f32 v75, v75, v179
v_mul_f32 v76, v76, v200
v_mul_f32 v77, v77, v201
v_mul_f32 v78, v78, v202
buffer_load_dwordx4 v3, s[8:11], s37 offen offset:2048 sc1 lds
v_mul_f32 v79, v79, v203
v_exp_f32 v72, v72
v_exp_f32 v73, v73
v_exp_f32 v74, v74
v_exp_f32 v75, v75
v_exp_f32 v76, v76
buffer_load_dwordx4 v3, s[8:11], s37 offen offset:3072 sc1 lds
v_exp_f32 v77, v77
v_exp_f32 v78, v78
v_exp_f32 v79, v79
v_fma_f32 v188, -v60, v44, v188
v_fma_f32 v189, -v60, v45, v189
v_fma_f32 v190, -v60, v46, v190
s_add_u32 s38, s35, 5
s_and_b32 s38, s38, 15
s_mul_i32 s38, s38, 458752
s_add_u32 m0, s40, 0
s_nop 0
buffer_load_dwordx4 v4, s[12:15], s38 offen lds
v_fma_f32 v191, -v60, v47, v191
v_fma_f32 v212, -v62, v44, v212
v_fma_f32 v213, -v62, v45, v213
v_fma_f32 v214, -v62, v46, v214
v_fma_f32 v215, -v62, v47, v215
v_fma_f32 v72, v72, v66, v66
s_add_u32 m0, s40, 1024
s_nop 0
buffer_load_dwordx4 v5, s[12:15], s38 offen lds
v_fma_f32 v73, v73, v66, v66
v_fma_f32 v74, v74, v66, v66
v_fma_f32 v75, v75, v66, v66
v_fma_f32 v76, v76, v70, v70
v_fma_f32 v77, v77, v70, v70
v_fma_f32 v78, v78, v70, v70
s_add_u32 m0, s40, 2048
s_add_u32 s38, s38, 57344
buffer_load_dwordx4 v4, s[12:15], s38 offen lds
v_fma_f32 v79, v79, v70, v70
v_rcp_f32 v72, v72
v_rcp_f32 v73, v73
v_rcp_f32 v74, v74
v_rcp_f32 v75, v75
v_rcp_f32 v76, v76
s_add_u32 m0, s40, 3072
s_nop 0
buffer_load_dwordx4 v5, s[12:15], s38 offen lds
v_rcp_f32 v77, v77
v_rcp_f32 v78, v78
v_rcp_f32 v79, v79
v_mul_f32 v188, v176, v188
v_mul_f32 v189, v177, v189
v_mul_f32 v190, v178, v190
s_add_u32 m0, s40, 4096
s_add_u32 s38, s38, 57344
buffer_load_dwordx4 v4, s[12:15], s38 offen lds
v_mul_f32 v191, v179, v191
v_mul_f32 v212, v200, v212
v_mul_f32 v213, v201, v213
v_mul_f32 v214, v202, v214
v_mul_f32 v215, v203, v215
v_mul_f32 v188, v188, v72
s_add_u32 m0, s40, 5120
s_nop 0
buffer_load_dwordx4 v5, s[12:15], s38 offen lds
v_mul_f32 v189, v189, v73
v_mul_f32 v190, v190, v74
v_mul_f32 v191, v191, v75
v_mul_f32 v212, v212, v76
v_mul_f32 v213, v213, v77
v_mul_f32 v214, v214, v78
s_add_u32 m0, s40, 6144
s_add_u32 s38, s38, 57344
buffer_load_dwordx4 v4, s[12:15], s38 offen lds
s_add_u32 m0, s40, 7168
s_nop 0
buffer_load_dwordx4 v5, s[12:15], s38 offen lds
s_waitcnt vmcnt(12)
s_barrier
s_waitcnt lgkmcnt(0)
s_cmp_eq_u32 s47, 3
s_cbranch_scc0 Lw_111
s_lshl_b32 s60, s35, 7
s_add_u32 s60, s60, 28321792
s_mov_b32 s61, s60
s_load_dword s92, s[82:83], s60 glc
s_load_dword s93, s[82:83], s61 glc
Lw_111:
s_add_u32 s37, s35, 6
s_and_b32 s37, s37, 15
s_mul_i32 s37, s37, 16384
s_add_u32 m0, s39, 49152
s_nop 0
buffer_load_dwordx4 v3, s[8:11], s37 offen sc1 lds
s_load_dword s3, s[4:5], 4480
s_load_dword s3, s[4:5], 4544
s_load_dword s3, s[4:5], 4608
s_load_dword s3, s[4:5], 4672
s_load_dword s3, s[4:5], 4736
s_load_dword s3, s[4:5], 4800
s_load_dword s3, s[4:5], 4864
buffer_load_dwordx4 v3, s[8:11], s37 offen offset:1024 sc1 lds
s_load_dword s3, s[4:5], 4928
s_load_dword s3, s[4:5], 4992
s_load_dword s3, s[4:5], 5056
s_load_dword s3, s[4:5], 5120
s_load_dword s3, s[4:5], 5184
s_load_dword s3, s[4:5], 5248
s_load_dword s3, s[4:5], 5312
buffer_load_dwordx4 v3, s[8:11], s37 offen offset:2048 sc1 lds
v_mul_f32 v215, v215, v79
v_cvt_pk_bf16_f32 v176, v188, v189
v_cvt_pk_bf16_f32 v177, v190, v191
v_cvt_pk_bf16_f32 v200, v212, v213
v_cvt_pk_bf16_f32 v201, v214, v215
v_fma_f32 v180, -v60, v36, v180
v_fma_f32 v181, -v60, v37, v181
v_fma_f32 v182, -v60, v38, v182
buffer_load_dwordx4 v3, s[8:11], s37 offen offset:3072 sc1 lds
v_fma_f32 v183, -v60, v39, v183
v_fma_f32 v204, -v62, v36, v204
v_fma_f32 v205, -v62, v37, v205
v_fma_f32 v206, -v62, v38, v206
v_fma_f32 v207, -v62, v39, v207
v_mul_f32 v72, v180, v180
v_mul_f32 v73, v181, v181
s_add_u32 s38, s35, 6
s_and_b32 s38, s38, 15
s_mul_i32 s38, s38, 458752
s_add_u32 m0, s40, 49152
s_nop 0
buffer_load_dwordx4 v4, s[12:15], s38 offen lds
v_mul_f32 v74, v182, v182
v_mul_f32 v75, v183, v183
v_mul_f32 v76, v204, v204
v_mul_f32 v77, v205, v205
v_mul_f32 v78, v206, v206
v_mul_f32 v79, v207, v207
v_fma_f32 v72, v72, v65, v64
v_fma_f32 v73, v73, v65, v64
s_add_u32 m0, s40, 50176
s_nop 0
buffer_load_dwordx4 v5, s[12:15], s38 offen lds
v_fma_f32 v74, v74, v65, v64
v_fma_f32 v75, v75, v65, v64
v_fma_f32 v76, v76, v69, v68
v_fma_f32 v77, v77, v69, v68
v_fma_f32 v78, v78, v69, v68
v_fma_f32 v79, v79, v69, v68
v_mul_f32 v72, v72, v180
s_add_u32 m0, s40, 51200
s_add_u32 s38, s38, 57344
buffer_load_dwordx4 v4, s[12:15], s38 offen lds
v_mul_f32 v73, v73, v181
v_mul_f32 v74, v74, v182
v_mul_f32 v75, v75, v183
v_mul_f32 v76, v76, v204
v_mul_f32 v77, v77, v205
v_mul_f32 v78, v78, v206
v_mul_f32 v79, v79, v207
s_add_u32 m0, s40, 52224
s_nop 0
buffer_load_dwordx4 v5, s[12:15], s38 offen lds
v_exp_f32 v72, v72
v_exp_f32 v73, v73
v_exp_f32 v74, v74
v_exp_f32 v75, v75
v_exp_f32 v76, v76
v_exp_f32 v77, v77
v_exp_f32 v78, v78
v_exp_f32 v79, v79
s_add_u32 m0, s40, 53248
s_add_u32 s38, s38, 57344
buffer_load_dwordx4 v4, s[12:15], s38 offen lds
v_fma_f32 v192, -v60, v48, v192
v_fma_f32 v193, -v60, v49, v193
v_fma_f32 v194, -v60, v50, v194
v_fma_f32 v195, -v60, v51, v195
v_fma_f32 v216, -v62, v48, v216
v_fma_f32 v217, -v62, v49, v217
v_fma_f32 v218, -v62, v50, v218
s_add_u32 m0, s40, 54272
s_nop 0
buffer_load_dwordx4 v5, s[12:15], s38 offen lds
v_fma_f32 v219, -v62, v51, v219
v_fma_f32 v72, v72, v66, v66
v_fma_f32 v73, v73, v66, v66
v_fma_f32 v74, v74, v66, v66
v_fma_f32 v75, v75, v66, v66
v_fma_f32 v76, v76, v70, v70
v_fma_f32 v77, v77, v70, v70
v_fma_f32 v78, v78, v70, v70
s_add_u32 m0, s40, 55296
s_add_u32 s38, s38, 57344
buffer_load_dwordx4 v4, s[12:15], s38 offen lds
s_add_u32 m0, s40, 56320
s_nop 0
buffer_load_dwordx4 v5, s[12:15], s38 offen lds
s_waitcnt vmcnt(12)
s_barrier
s_add_u32 s37, s35, 7
s_and_b32 s37, s37, 15
s_mul_i32 s37, s37, 16384
s_add_u32 m0, s39, 98304
s_nop 0
buffer_load_dwordx4 v3, s[8:11], s37 offen sc1 lds
v_fma_f32 v79, v79, v70, v70
v_rcp_f32 v72, v72
v_rcp_f32 v73, v73
v_rcp_f32 v74, v74
v_rcp_f32 v75, v75
v_rcp_f32 v76, v76
buffer_load_dwordx4 v3, s[8:11], s37 offen offset:1024 sc1 lds
v_rcp_f32 v77, v77
v_rcp_f32 v78, v78
v_rcp_f32 v79, v79
v_mul_f32 v192, v180, v192
v_mul_f32 v193, v181, v193
v_mul_f32 v194, v182, v194
buffer_load_dwordx4 v3, s[8:11], s37 offen offset:2048 sc1 lds
v_mul_f32 v195, v183, v195
v_mul_f32 v216, v204, v216
v_mul_f32 v217, v205, v217
v_mul_f32 v218, v206, v218
v_mul_f32 v219, v207, v219
v_mul_f32 v192, v192, v72
buffer_load_dwordx4 v3, s[8:11], s37 offen offset:3072 sc1 lds
v_mul_f32 v193, v193, v73
v_mul_f32 v194, v194, v74
v_mul_f32 v195, v195, v75
v_mul_f32 v216, v216, v76
v_mul_f32 v217, v217, v77
v_mul_f32 v218, v218, v78
s_add_u32 s38, s35, 7
s_and_b32 s38, s38, 15
s_mul_i32 s38, s38, 458752
s_add_u32 m0, s40, 98304
s_nop 0
buffer_load_dwordx4 v4, s[12:15], s38 offen lds
v_mul_f32 v219, v219, v79
v_cvt_pk_bf16_f32 v178, v192, v193
v_cvt_pk_bf16_f32 v179, v194, v195
v_cvt_pk_bf16_f32 v202, v216, v217
v_cvt_pk_bf16_f32 v203, v218, v219
buffer_store_dwordx4 v[176:179], v2, s[24:27], s54 offen offset:2048 sc1
s_add_u32 m0, s40, 99328
s_nop 0
buffer_load_dwordx4 v5, s[12:15], s38 offen lds
buffer_store_dwordx4 v[200:203], v2, s[24:27], s54 offen offset:3072 sc1
v_fma_f32 v184, -v60, v40, v184
v_fma_f32 v185, -v60, v41, v185
v_fma_f32 v186, -v60, v42, v186
v_fma_f32 v187, -v60, v43, v187
v_fma_f32 v208, -v62, v40, v208
s_add_u32 m0, s40, 100352
s_add_u32 s38, s38, 57344
buffer_load_dwordx4 v4, s[12:15], s38 offen lds
v_fma_f32 v209, -v62, v41, v209
v_fma_f32 v210, -v62, v42, v210
v_fma_f32 v211, -v62, v43, v211
v_mul_f32 v72, v184, v184
v_mul_f32 v73, v185, v185
v_mul_f32 v74, v186, v186
s_add_u32 m0, s40, 101376
s_nop 0
buffer_load_dwordx4 v5, s[12:15], s38 offen lds
v_mul_f32 v75, v187, v187
v_mul_f32 v76, v208, v208
v_mul_f32 v77, v209, v209
v_mul_f32 v78, v210, v210
v_mul_f32 v79, v211, v211
v_fma_f32 v72, v72, v65, v64
s_add_u32 m0, s40, 102400
s_add_u32 s38, s38, 57344
buffer_load_dwordx4 v4, s[12:15], s38 offen lds
v_fma_f32 v73, v73, v65, v64
v_fma_f32 v74, v74, v65, v64
v_fma_f32 v75, v75, v65, v64
v_fma_f32 v76, v76, v69, v68
v_fma_f32 v77, v77, v69, v68
v_fma_f32 v78, v78, v69, v68
s_add_u32 m0, s40, 103424
s_nop 0
buffer_load_dwordx4 v5, s[12:15], s38 offen lds
v_fma_f32 v79, v79, v69, v68
v_mul_f32 v72, v72, v184
v_mul_f32 v73, v73, v185
v_mul_f32 v74, v74, v186
v_mul_f32 v75, v75, v187
v_mul_f32 v76, v76, v208
s_add_u32 m0, s40, 104448
s_add_u32 s38, s38, 57344
buffer_load_dwordx4 v4, s[12:15], s38 offen lds
s_add_u32 m0, s40, 105472
s_nop 0
buffer_load_dwordx4 v5, s[12:15], s38 offen lds
s_waitcnt vmcnt(14)
s_cmp_eq_u32 s47, 3
s_cbranch_scc0 Lw_112
s_mov_b32 s41, 0x40000
Lcp_113:
s_waitcnt lgkmcnt(0)
s_and_b32 s92, s92, s93
s_cmp_eq_u32 s92, 16
s_cbranch_scc1 Lco_114
s_load_dword s92, s[82:83], s60 glc
s_load_dword s93, s[82:83], s61 glc
s_sub_u32 s41, s41, 1
s_cmp_lg_u32 s41, 0
s_cbranch_scc1 Lcp_113
s_waitcnt lgkmcnt(0)
Lco_114:
Lw_112:
s_barrier
s_lshl_b32 s60, s35, 9
s_lshl_b32 s43, s47, 7
s_add_u32 s60, s60, s43
s_add_u32 s61, s60, 14336
s_add_u32 s52, s43, 148480
s_add_u32 s53, s52, 896
v_lshrrev_b32 v104, 3, v1
v_mul_u32_u24 v104, 28672, v104
v_and_b32 v105, 7, v1
v_lshl_add_u32 v104, v105, 4, v104
s_waitcnt lgkmcnt(0)
buffer_load_dwordx4 v[96:99], v104, s[84:87], s60 offen sc1
s_load_dword s3, s[4:5], 5376
s_load_dword s3, s[4:5], 5440
s_load_dword s3, s[4:5], 5504
s_load_dword s3, s[4:5], 5568
s_load_dword s3, s[4:5], 5632
s_load_dword s3, s[4:5], 5696
buffer_load_dwordx4 v[100:103], v104, s[84:87], s61 offen sc1
s_load_dword s3, s[4:5], 5760
s_load_dword s3, s[4:5], 5824
s_load_dword s3, s[4:5], 5888
s_load_dword s3, s[4:5], 5952
s_load_dword s3, s[4:5], 6016
s_load_dword s3, s[4:5], 6080
s_load_dword s3, s[4:5], 6144
s_add_u32 s37, s35, 8
s_and_b32 s37, s37, 15
s_mul_i32 s37, s37, 16384
s_add_u32 m0, s39, 0
s_nop 0
buffer_load_dwordx4 v3, s[8:11], s37 offen sc1 lds
s_load_dword s3, s[4:5], 6208
v_mul_f32 v77, v77, v209
v_mul_f32 v78, v78, v210
v_mul_f32 v79, v79, v211
v_exp_f32 v72, v72
v_exp_f32 v73, v73
v_exp_f32 v74, v74
buffer_load_dwordx4 v3, s[8:11], s37 offen offset:1024 sc1 lds
v_exp_f32 v75, v75
v_exp_f32 v76, v76
v_exp_f32 v77, v77
v_exp_f32 v78, v78
v_exp_f32 v79, v79
v_fma_f32 v196, -v60, v52, v196
v_fma_f32 v197, -v60, v53, v197
buffer_load_dwordx4 v3, s[8:11], s37 offen offset:2048 sc1 lds
v_fma_f32 v198, -v60, v54, v198
v_fma_f32 v199, -v60, v55, v199
v_fma_f32 v220, -v62, v52, v220
v_fma_f32 v221, -v62, v53, v221
v_fma_f32 v222, -v62, v54, v222
v_fma_f32 v223, -v62, v55, v223
buffer_load_dwordx4 v3, s[8:11], s37 offen offset:3072 sc1 lds
v_fma_f32 v72, v72, v66, v66
v_fma_f32 v73, v73, v66, v66
v_fma_f32 v74, v74, v66, v66
v_fma_f32 v75, v75, v66, v66
v_fma_f32 v76, v76, v70, v70
v_fma_f32 v77, v77, v70, v70
v_fma_f32 v78, v78, v70, v70
s_add_u32 s38, s35, 8
s_and_b32 s38, s38, 15
s_mul_i32 s38, s38, 458752
s_add_u32 m0, s40, 0
s_nop 0
buffer_load_dwordx4 v4, s[12:15], s38 offen lds
v_fma_f32 v79, v79, v70, v70
v_rcp_f32 v72, v72
v_rcp_f32 v73, v73
v_rcp_f32 v74, v74
v_rcp_f32 v75, v75
v_rcp_f32 v76, v76
v_rcp_f32 v77, v77
s_add_u32 m0, s40, 1024
s_nop 0
buffer_load_dwordx4 v5, s[12:15], s38 offen lds
v_rcp_f32 v78, v78
v_rcp_f32 v79, v79
v_mul_f32 v196, v184, v196
v_mul_f32 v197, v185, v197
v_mul_f32 v198, v186, v198
v_mul_f32 v199, v187, v199
v_mul_f32 v220, v208, v220
s_add_u32 m0, s40, 2048
s_add_u32 s38, s38, 57344
buffer_load_dwordx4 v4, s[12:15], s38 offen lds
v_mul_f32 v221, v209, v221
v_mul_f32 v222, v210, v222
v_mul_f32 v223, v211, v223
v_mul_f32 v196, v196, v72
v_mul_f32 v197, v197, v73
v_mul_f32 v198, v198, v74
s_add_u32 m0, s40, 3072
s_nop 0
buffer_load_dwordx4 v5, s[12:15], s38 offen lds
v_mul_f32 v199, v199, v75
v_mul_f32 v220, v220, v76
v_mul_f32 v221, v221, v77
v_mul_f32 v222, v222, v78
v_mul_f32 v223, v223, v79
v_cvt_pk_bf16_f32 v80, v196, v197
v_cvt_pk_bf16_f32 v81, v198, v199
s_add_u32 m0, s40, 4096
s_add_u32 s38, s38, 57344
buffer_load_dwordx4 v4, s[12:15], s38 offen lds
v_cvt_pk_bf16_f32 v82, v220, v221
v_cvt_pk_bf16_f32 v83, v222, v223
s_nop 1
v_permlane32_swap_b32 v80, v82
v_permlane32_swap_b32 v81, v83
buffer_store_dwordx4 v[80:83], v84, s[24:27], s55 offen offset:2048 sc1
s_nop 1
s_add_u32 m0, s40, 5120
s_nop 0
buffer_load_dwordx4 v5, s[12:15], s38 offen lds
v_cmp_gt_u32 vcc, 32, v1
v_mov_b32 v104, s52
v_mov_b32 v106, s53
v_cndmask_b32 v104, v106, v104, vcc
v_lshl_add_u32 v104, v105, 4, v104
v_bfe_u32 v105, v1, 4, 1
v_lshl_add_u32 v104, v105, 2, v104
s_add_u32 m0, s40, 6144
s_add_u32 s38, s38, 57344
buffer_load_dwordx4 v4, s[12:15], s38 offen lds
s_add_u32 m0, s40, 7168
s_nop 0
buffer_load_dwordx4 v5, s[12:15], s38 offen lds
s_waitcnt vmcnt(15)
s_barrier
s_add_u32 s37, s35, 9
s_and_b32 s37, s37, 15
s_mul_i32 s37, s37, 16384
s_add_u32 m0, s39, 49152
s_nop 0
buffer_load_dwordx4 v3, s[8:11], s37 offen sc1 lds
buffer_load_dwordx4 v3, s[8:11], s37 offen offset:1024 sc1 lds
buffer_load_dwordx4 v3, s[8:11], s37 offen offset:2048 sc1 lds
buffer_load_dwordx4 v3, s[8:11], s37 offen offset:3072 sc1 lds
s_add_u32 s38, s35, 9
s_and_b32 s38, s38, 15
s_mul_i32 s38, s38, 458752
s_add_u32 m0, s40, 49152
s_nop 0
buffer_load_dwordx4 v4, s[12:15], s38 offen lds
s_add_u32 m0, s40, 50176
s_nop 0
buffer_load_dwordx4 v5, s[12:15], s38 offen lds
s_add_u32 m0, s40, 51200
s_add_u32 s38, s38, 57344
buffer_load_dwordx4 v4, s[12:15], s38 offen lds
s_add_u32 m0, s40, 52224
s_nop 0
buffer_load_dwordx4 v5, s[12:15], s38 offen lds
s_add_u32 m0, s40, 53248
s_add_u32 s38, s38, 57344
buffer_load_dwordx4 v4, s[12:15], s38 offen lds
s_add_u32 m0, s40, 54272
s_nop 0
buffer_load_dwordx4 v5, s[12:15], s38 offen lds
s_add_u32 m0, s40, 55296
s_add_u32 s38, s38, 57344
buffer_load_dwordx4 v4, s[12:15], s38 offen lds
s_add_u32 m0, s40, 56320
s_nop 0
buffer_load_dwordx4 v5, s[12:15], s38 offen lds
s_waitcnt vmcnt(12)
s_barrier
s_cmp_eq_u32 s47, 0
s_cbranch_scc0 Lw_115
s_add_u32 s7, s34, 32
s_lshl_b32 s7, s7, 7
v_mov_b32 v90, s7
v_mov_b32 v91, 1
s_mov_b64 exec, 1
buffer_atomic_add v91, v90, s[56:59], 0 offen sc1
s_mov_b64 exec, -1
Lw_115:
v_permlane32_swap_b32 v96, v100
v_permlane32_swap_b32 v97, v101
v_permlane32_swap_b32 v98, v102
v_permlane32_swap_b32 v99, v103
v_add_f32 v96, v96, v100
v_add_f32 v97, v97, v101
v_add_f32 v98, v98, v102
v_add_f32 v99, v99, v103
s_nop 1
v_permlane16_swap_b32 v96, v97
v_permlane16_swap_b32 v98, v99
v_add_f32 v96, v96, v97
v_add_f32 v98, v98, v99
s_nop 1
v_add_f32_dpp v96, v96, v96 row_ror:8 row_mask:0xf bank_mask:0xf
v_add_f32_dpp v98, v98, v98 row_ror:8 row_mask:0xf bank_mask:0xf
ds_write_b32 v104, v96
ds_write_b32 v104, v98 offset:8
s_waitcnt lgkmcnt(0)
s_add_u32 s37, s35, 10
s_and_b32 s37, s37, 15
s_mul_i32 s37, s37, 16384
s_add_u32 m0, s39, 98304
s_nop 0
buffer_load_dwordx4 v3, s[8:11], s37 offen sc1 lds
s_load_dword s3, s[4:5], 6272
s_load_dword s3, s[4:5], 6336
s_load_dword s3, s[4:5], 6400
s_load_dword s3, s[4:5], 6464
s_load_dword s3, s[4:5], 6528
s_load_dword s3, s[4:5], 6592
buffer_load_dwordx4 v3, s[8:11], s37 offen offset:1024 sc1 lds
s_load_dword s3, s[4:5], 6656
s_load_dword s3, s[4:5], 6720
s_load_dword s3, s[4:5], 6784
s_load_dword s3, s[4:5], 6848
s_load_dword s3, s[4:5], 6912
s_load_dword s3, s[4:5], 6976
s_load_dword s3, s[4:5], 7040
buffer_load_dwordx4 v3, s[8:11], s37 offen offset:2048 sc1 lds
s_load_dword s3, s[4:5], 7104
s_bfe_u32 s61, s35, 0x10002
s_lshr_b32 s60, s35, 3
s_lshl_b32 s60, s60, 2
s_and_b32 s43, s35, 3
s_add_u32 s60, s60, s43
buffer_load_dwordx4 v3, s[8:11], s37 offen offset:3072 sc1 lds
s_lshl_b32 s43, s60, 8
s_add_u32 s28, s76, s43
s_addc_u32 s29, s77, 0
s_mov_b32 s30, 7338240
s_mov_b32 s31, 0x20000
s_mul_i32 s52, s61, 196608
s_mul_i32 s53, s61, 1572864
s_add_u32 s38, s35, 10
s_and_b32 s38, s38, 15
s_mul_i32 s38, s38, 458752
s_add_u32 m0, s40, 98304
s_nop 0
s_branch Lov_10
.p2align 12
.fill 80, 4, 0xbf800000
Lst_10_0:
s_branch Lwr_155
Lst_10_1:
s_branch Lwr_166
s_nop 0
Lov_10:
buffer_load_dwordx4 v4, s[12:15], s38 offen lds
s_mul_i32 s90, s61, 163840
s_mul_i32 s91, s61, 1310720
s_and_b32 s43, s35, 3
s_mul_i32 s32, s43, 3
s_mul_i32 s33, s43, 10
s_lshr_b32 s33, s33, 2
s_add_u32 m0, s40, 99328
s_nop 0
buffer_load_dwordx4 v5, s[12:15], s38 offen lds
s_lshl_b32 s51, s47, 11
s_lshl_b32 s44, s47, 15
v_lshrrev_b32 v122, 4, v1
v_lshlrev_b32 v123, 1, v122
v_and_b32 v23, 15, v1
v_xor_b32 v23, v23, v123
v_lshlrev_b32 v23, 4, v23
s_add_u32 m0, s40, 100352
s_add_u32 s38, s38, 57344
buffer_load_dwordx4 v4, s[12:15], s38 offen lds
v_mul_u32_u24 v122, 2048, v122
v_add_u32 v23, v23, v122
v_add_u32 v23, s44, v23
v_xor_b32 v24, 128, v23
v_add_u32 v24, 8192, v24
s_lshl_b32 s43, s60, 2
s_add_u32 m0, s40, 101376
s_nop 0
buffer_load_dwordx4 v5, s[12:15], s38 offen lds
s_lshl_b32 s44, s61, 1
s_add_u32 s43, s43, s44
s_add_u32 s43, s43, s63
s_lshl_b32 s43, s43, 13
s_lshl_b32 s44, s62, 12
s_add_u32 s50, s43, s44
v_add_u32 v17, s44, v2
s_add_u32 m0, s40, 102400
s_add_u32 s38, s38, 57344
buffer_load_dwordx4 v4, s[12:15], s38 offen lds
v_add_u32 v18, 0x10000, v17
v_add_u32 v19, 0x20000, v17
v_lshrrev_b32 v122, 2, v1
v_and_b32 v123, 7, v122
v_mul_u32_u24 v122, 256, v122
v_lshl_add_u32 v122, v123, 5, v122
s_add_u32 m0, s40, 103424
s_nop 0
buffer_load_dwordx4 v5, s[12:15], s38 offen lds
v_and_b32 v123, 3, v1
v_lshl_add_u32 v9, v123, 3, v122
s_lshl_b32 s43, s61, 7
s_lshl_b32 s44, s63, 6
s_add_u32 s43, s43, s44
v_xor_b32 v9, s43, v9
v_xor_b32 v10, 32, v9
s_add_u32 m0, s40, 104448
s_add_u32 s38, s38, 57344
buffer_load_dwordx4 v4, s[12:15], s38 offen lds
s_add_u32 m0, s40, 105472
s_nop 0
buffer_load_dwordx4 v5, s[12:15], s38 offen lds
s_waitcnt vmcnt(12)
s_barrier
buffer_load_dwordx4 v[160:163], v2, s[8:11], s50 offen offset:0 sc1
v_xor_b32 v11, 128, v9
v_xor_b32 v12, 128, v10
v_add_u32 v13, 65536, v9
buffer_load_dwordx4 v[164:167], v2, s[8:11], s50 offen offset:1024 sc1
v_add_u32 v14, 65536, v10
v_add_u32 v15, 65536, v11
v_add_u32 v16, 65536, v12
v_add_u32 v25, 131072, v9
buffer_load_dwordx4 v[168:171], v2, s[8:11], s50 offen offset:2048 sc1
v_add_u32 v26, 131072, v10
v_add_u32 v27, 131072, v11
v_add_u32 v28, 131072, v12
v_lshrrev_b32 v122, 2, v1
buffer_load_dwordx4 v[172:175], v2, s[8:11], s50 offen offset:3072 sc1
v_bfe_u32 v123, v122, 1, 2
v_mul_u32_u24 v122, 128, v122
v_lshl_add_u32 v122, v123, 5, v122
s_add_u32 s37, s35, 11
s_and_b32 s37, s37, 15
s_mul_i32 s37, s37, 16384
s_add_u32 m0, s39, 0
s_nop 0
buffer_load_dwordx4 v3, s[8:11], s37 offen sc1 lds
v_and_b32 v123, 3, v1
v_lshl_add_u32 v224, v123, 3, v122
v_xor_b32 v224, s44, v224
v_xor_b32 v225, 32, v224
buffer_load_dwordx4 v3, s[8:11], s37 offen offset:1024 sc1 lds
v_add_u32 v226, 65536, v224
v_add_u32 v227, 65536, v225
v_add_u32 v228, 131072, v224
v_add_u32 v229, 131072, v225
buffer_load_dwordx4 v3, s[8:11], s37 offen offset:2048 sc1 lds
s_add_u32 s84, s82, 33554432
s_addc_u32 s85, s83, 0
s_mov_b32 s86, 4194304
s_mov_b32 s87, 0x20000
buffer_load_dwordx4 v3, s[8:11], s37 offen offset:3072 sc1 lds
s_xor_b32 s43, s2, 2
s_lshl_b32 s44, s43, 2
s_add_u32 s44, s44, s47
s_add_u32 s38, s35, 11
s_and_b32 s38, s38, 15
s_mul_i32 s38, s38, 458752
s_add_u32 m0, s40, 0
s_nop 0
buffer_load_dwordx4 v4, s[12:15], s38 offen lds
s_lshl_b32 s45, s44, 12
s_lshl_b32 s46, s2, 2
s_add_u32 s46, s46, s47
s_lshl_b32 s46, s46, 12
s_add_u32 m0, s40, 1024
s_nop 0
buffer_load_dwordx4 v5, s[12:15], s38 offen lds
s_lshl_b32 s43, s34, 18
s_lshl_b32 s42, s60, 8
s_add_u32 s43, s43, s42
s_lshl_b32 s42, s61, 7
s_add_u32 m0, s40, 2048
s_add_u32 s38, s38, 57344
buffer_load_dwordx4 v4, s[12:15], s38 offen lds
s_add_u32 s43, s43, s42
s_lshl_b32 s42, s63, 6
s_add_u32 s43, s43, s42
s_add_u32 m0, s40, 3072
s_nop 0
buffer_load_dwordx4 v5, s[12:15], s38 offen lds
s_add_u32 s20, s78, s43
s_addc_u32 s21, s79, 0
s_mov_b32 s22, 260160
s_mov_b32 s23, 0x20000
s_add_u32 m0, s40, 4096
s_add_u32 s38, s38, 57344
buffer_load_dwordx4 v4, s[12:15], s38 offen lds
v_and_b32 v230, 15, v1
v_lshlrev_b32 v230, 12, v230
v_bfe_u32 v231, v1, 4, 1
v_lshl_add_u32 v230, v231, 5, v230
s_add_u32 m0, s40, 5120
s_nop 0
buffer_load_dwordx4 v5, s[12:15], s38 offen lds
v_bfe_u32 v231, v1, 5, 1
v_lshl_add_u32 v230, v231, 4, v230
s_lshl_b32 s54, s62, 17
s_add_u32 s55, s54, 65536
s_add_u32 m0, s40, 6144
s_add_u32 s38, s38, 57344
buffer_load_dwordx4 v4, s[12:15], s38 offen lds
s_add_u32 m0, s40, 7168
s_nop 0
buffer_load_dwordx4 v5, s[12:15], s38 offen lds
s_waitcnt vmcnt(16)
s_barrier
s_cmp_eq_u32 s47, 3
s_cbranch_scc0 Lw_116
s_lshl_b32 s92, s34, 7
s_add_u32 s92, s92, 28315648
s_load_dword s93, s[82:83], s92 glc
Lw_116:
s_add_u32 s37, s35, 12
s_and_b32 s37, s37, 15
s_mul_i32 s37, s37, 16384
s_add_u32 m0, s39, 49152
s_nop 0
buffer_load_dwordx4 v3, s[8:11], s37 offen sc1 lds
buffer_load_dwordx4 v3, s[8:11], s37 offen offset:1024 sc1 lds
buffer_load_dwordx4 v3, s[8:11], s37 offen offset:2048 sc1 lds
buffer_load_dwordx4 v3, s[8:11], s37 offen offset:3072 sc1 lds
s_add_u32 s38, s35, 12
s_and_b32 s38, s38, 15
s_mul_i32 s38, s38, 458752
s_add_u32 m0, s40, 49152
s_nop 0
buffer_load_dwordx4 v4, s[12:15], s38 offen lds
s_add_u32 m0, s40, 50176
s_nop 0
buffer_load_dwordx4 v5, s[12:15], s38 offen lds
s_add_u32 m0, s40, 51200
s_add_u32 s38, s38, 57344
buffer_load_dwordx4 v4, s[12:15], s38 offen lds
s_add_u32 m0, s40, 52224
s_nop 0
buffer_load_dwordx4 v5, s[12:15], s38 offen lds
s_add_u32 m0, s40, 53248
s_add_u32 s38, s38, 57344
buffer_load_dwordx4 v4, s[12:15], s38 offen lds
s_add_u32 m0, s40, 54272
s_nop 0
buffer_load_dwordx4 v5, s[12:15], s38 offen lds
s_add_u32 m0, s40, 55296
s_add_u32 s38, s38, 57344
buffer_load_dwordx4 v4, s[12:15], s38 offen lds
s_add_u32 m0, s40, 56320
s_nop 0
buffer_load_dwordx4 v5, s[12:15], s38 offen lds
s_waitcnt vmcnt(12)
s_cmp_eq_u32 s47, 3
s_cbranch_scc0 Lw_117
s_mov_b32 s41, 0x40000
s_branch Lpchk_120
Lpoll_118:
s_load_dword s93, s[82:83], s92 glc
Lpchk_120:
s_waitcnt lgkmcnt(0)
s_cmp_eq_u32 s93, 16
s_cbranch_scc1 Lpok_119
s_sub_u32 s41, s41, 1
s_cmp_lg_u32 s41, 0
s_cbranch_scc1 Lpoll_118
Lpok_119:
Lw_117:
s_barrier
s_add_u32 s37, s52, 524288
s_add_u32 m0, s39, 98304
s_nop 0
buffer_load_dwordx4 v3, s[24:27], s37 offen sc1 lds
v_lshlrev_b32 v128, 16, v160
v_and_b32 v129, 0xffff0000, v160
v_lshlrev_b32 v130, 16, v161
v_and_b32 v131, 0xffff0000, v161
v_lshlrev_b32 v132, 16, v162
buffer_load_dwordx4 v3, s[24:27], s37 offen offset:1024 sc1 lds
v_and_b32 v133, 0xffff0000, v162
v_lshlrev_b32 v134, 16, v163
v_and_b32 v135, 0xffff0000, v163
v_lshlrev_b32 v136, 16, v164
v_and_b32 v137, 0xffff0000, v164
buffer_load_dwordx4 v3, s[24:27], s37 offen offset:2048 sc1 lds
v_lshlrev_b32 v138, 16, v165
v_and_b32 v139, 0xffff0000, v165
v_lshlrev_b32 v140, 16, v166
v_and_b32 v141, 0xffff0000, v166
v_lshlrev_b32 v142, 16, v167
v_and_b32 v143, 0xffff0000, v167
buffer_load_dwordx4 v3, s[24:27], s37 offen offset:3072 sc1 lds
v_lshlrev_b32 v144, 16, v168
v_and_b32 v145, 0xffff0000, v168
v_lshlrev_b32 v146, 16, v169
v_and_b32 v147, 0xffff0000, v169
v_lshlrev_b32 v148, 16, v170
s_add_u32 s38, s53, 4194304
s_add_u32 m0, s39, 114688
s_nop 0
buffer_load_dwordx4 v23, s[28:31], s38 offen lds
v_and_b32 v149, 0xffff0000, v170
v_lshlrev_b32 v150, 16, v171
v_and_b32 v151, 0xffff0000, v171
v_lshlrev_b32 v152, 16, v172
v_and_b32 v153, 0xffff0000, v172
s_add_u32 m0, s39, 115712
s_nop 0
buffer_load_dwordx4 v24, s[28:31], s38 offen lds
v_lshlrev_b32 v154, 16, v173
v_and_b32 v155, 0xffff0000, v173
v_lshlrev_b32 v156, 16, v174
v_and_b32 v157, 0xffff0000, v174
v_lshlrev_b32 v158, 16, v175
v_and_b32 v159, 0xffff0000, v175
s_add_u32 m0, s39, 116736
s_add_u32 s38, s38, 16384
buffer_load_dwordx4 v23, s[28:31], s38 offen lds
s_add_u32 m0, s39, 117760
s_nop 0
buffer_load_dwordx4 v24, s[28:31], s38 offen lds
s_waitcnt vmcnt(8)
s_barrier
s_add_u32 s37, s52, 540672
s_add_u32 m0, s39, 131072
s_nop 0
buffer_load_dwordx4 v3, s[24:27], s37 offen sc1 lds
buffer_load_dwordx4 v3, s[24:27], s37 offen offset:1024 sc1 lds
buffer_load_dwordx4 v3, s[24:27], s37 offen offset:2048 sc1 lds
buffer_load_dwordx4 v3, s[24:27], s37 offen offset:3072 sc1 lds
s_add_u32 s38, s53, 4325376
s_add_u32 m0, s39, 0
s_nop 0
buffer_load_dwordx4 v23, s[28:31], s38 offen lds
s_add_u32 m0, s39, 1024
s_nop 0
buffer_load_dwordx4 v24, s[28:31], s38 offen lds
s_add_u32 m0, s39, 2048
s_add_u32 s38, s38, 16384
buffer_load_dwordx4 v23, s[28:31], s38 offen lds
s_add_u32 m0, s39, 3072
s_nop 0
buffer_load_dwordx4 v24, s[28:31], s38 offen lds
s_add_u32 s37, s52, 557056
s_add_u32 m0, s39, 16384
s_nop 0
buffer_load_dwordx4 v3, s[24:27], s37 offen sc1 lds
buffer_load_dwordx4 v3, s[24:27], s37 offen offset:1024 sc1 lds
buffer_load_dwordx4 v3, s[24:27], s37 offen offset:2048 sc1 lds
buffer_load_dwordx4 v3, s[24:27], s37 offen offset:3072 sc1 lds
s_add_u32 s38, s53, 4456448
s_add_u32 m0, s39, 32768
s_nop 0
buffer_load_dwordx4 v23, s[28:31], s38 offen lds
s_add_u32 m0, s39, 33792
s_nop 0
buffer_load_dwordx4 v24, s[28:31], s38 offen lds
s_add_u32 m0, s39, 34816
s_add_u32 s38, s38, 16384
buffer_load_dwordx4 v23, s[28:31], s38 offen lds
s_add_u32 m0, s39, 35840
s_nop 0
buffer_load_dwordx4 v24, s[28:31], s38 offen lds
s_waitcnt vmcnt(16)
s_barrier
ds_read_b128 v[32:35], v18 offset:32768
ds_read_b64_tr_b16 v[48:49], v13 offset:49152
ds_read_b64_tr_b16 v[50:51], v13 offset:53248
ds_read_b64_tr_b16 v[52:53], v14 offset:49152
ds_read_b64_tr_b16 v[54:55], v14 offset:53248
ds_read_b64_tr_b16 v[56:57], v15 offset:49152
ds_read_b64_tr_b16 v[58:59], v15 offset:53248
ds_read_b64_tr_b16 v[60:61], v16 offset:49152
ds_read_b64_tr_b16 v[62:63], v16 offset:53248
ds_read_b128 v[36:39], v18 offset:33792
ds_read_b128 v[40:43], v18 offset:34816
ds_read_b128 v[44:47], v18 offset:35840
ds_read_b128 v[64:67], v18 offset:40960
ds_read_b64_tr_b16 v[80:81], v13 offset:57344
ds_read_b64_tr_b16 v[82:83], v13 offset:61440
ds_read_b64_tr_b16 v[84:85], v14 offset:57344
ds_read_b64_tr_b16 v[86:87], v14 offset:61440
ds_read_b64_tr_b16 v[88:89], v15 offset:57344
ds_read_b64_tr_b16 v[90:91], v15 offset:61440
ds_read_b64_tr_b16 v[92:93], v16 offset:57344
ds_read_b64_tr_b16 v[94:95], v16 offset:61440
ds_read_b128 v[68:71], v18 offset:41984
ds_read_b128 v[72:75], v18 offset:43008
ds_read_b128 v[76:79], v18 offset:44032
s_add_u32 s37, s52, 573440
s_add_u32 m0, s39, 49152
s_nop 0
buffer_load_dwordx4 v3, s[24:27], s37 offen sc1 lds
buffer_load_dwordx4 v3, s[24:27], s37 offen offset:1024 sc1 lds
buffer_load_dwordx4 v3, s[24:27], s37 offen offset:2048 sc1 lds
buffer_load_dwordx4 v3, s[24:27], s37 offen offset:3072 sc1 lds
s_add_u32 s38, s53, 4587520
s_add_u32 m0, s39, 65536
s_nop 0
buffer_load_dwordx4 v23, s[28:31], s38 offen lds
s_add_u32 m0, s39, 66560
s_nop 0
buffer_load_dwordx4 v24, s[28:31], s38 offen lds
s_add_u32 m0, s39, 67584
s_add_u32 s38, s38, 16384
buffer_load_dwordx4 v23, s[28:31], s38 offen lds
s_add_u32 m0, s39, 68608
s_nop 0
buffer_load_dwordx4 v24, s[28:31], s38 offen lds
Lk4c:
s_waitcnt vmcnt(16)
s_waitcnt lgkmcnt(0)
s_barrier
v_mfma_f32_16x16x32_bf16 v[128:131], v[48:51], v[32:35], v[128:131]
ds_read_b128 v[96:99], v19 offset:0
v_mfma_f32_16x16x32_bf16 v[136:139], v[48:51], v[36:39], v[136:139]
ds_read_b64_tr_b16 v[112:113], v9 offset:0
v_mfma_f32_16x16x32_bf16 v[144:147], v[48:51], v[40:43], v[144:147]
ds_read_b64_tr_b16 v[114:115], v9 offset:4096
v_mfma_f32_16x16x32_bf16 v[152:155], v[48:51], v[44:47], v[152:155]
ds_read_b64_tr_b16 v[116:117], v10 offset:0
v_mfma_f32_16x16x32_bf16 v[156:159], v[52:55], v[44:47], v[156:159]
ds_read_b64_tr_b16 v[118:119], v10 offset:4096
v_mfma_f32_16x16x32_bf16 v[148:151], v[52:55], v[40:43], v[148:151]
ds_read_b64_tr_b16 v[120:121], v11 offset:0
v_mfma_f32_16x16x32_bf16 v[140:143], v[52:55], v[36:39], v[140:143]
ds_read_b64_tr_b16 v[122:123], v11 offset:4096
v_mfma_f32_16x16x32_bf16 v[132:135], v[52:55], v[32:35], v[132:135]
ds_read_b64_tr_b16 v[124:125], v12 offset:0
v_mfma_f32_16x16x32_bf16 v[160:163], v[56:59], v[32:35], 0
ds_read_b64_tr_b16 v[126:127], v12 offset:4096
v_mfma_f32_16x16x32_bf16 v[168:171], v[56:59], v[36:39], 0
ds_read_b128 v[100:103], v19 offset:1024
v_mfma_f32_16x16x32_bf16 v[176:179], v[56:59], v[40:43], 0
ds_read_b128 v[104:107], v19 offset:2048
v_mfma_f32_16x16x32_bf16 v[184:187], v[56:59], v[44:47], 0
ds_read_b128 v[108:111], v19 offset:3072
v_mfma_f32_16x16x32_bf16 v[188:191], v[60:63], v[44:47], 0
ds_read_b128 v[192:195], v19 offset:8192
v_mfma_f32_16x16x32_bf16 v[180:183], v[60:63], v[40:43], 0
ds_read_b64_tr_b16 v[208:209], v9 offset:8192
v_mfma_f32_16x16x32_bf16 v[172:175], v[60:63], v[36:39], 0
ds_read_b64_tr_b16 v[210:211], v9 offset:12288
v_mfma_f32_16x16x32_bf16 v[164:167], v[60:63], v[32:35], 0
ds_read_b64_tr_b16 v[212:213], v10 offset:8192
v_mfma_f32_16x16x32_bf16 v[128:131], v[80:83], v[64:67], v[128:131]
ds_read_b64_tr_b16 v[214:215], v10 offset:12288
v_mfma_f32_16x16x32_bf16 v[136:139], v[80:83], v[68:71], v[136:139]
ds_read_b64_tr_b16 v[216:217], v11 offset:8192
v_mfma_f32_16x16x32_bf16 v[144:147], v[80:83], v[72:75], v[144:147]
ds_read_b64_tr_b16 v[218:219], v11 offset:12288
v_mfma_f32_16x16x32_bf16 v[152:155], v[80:83], v[76:79], v[152:155]
ds_read_b64_tr_b16 v[220:221], v12 offset:8192
v_mfma_f32_16x16x32_bf16 v[156:159], v[84:87], v[76:79], v[156:159]
ds_read_b64_tr_b16 v[222:223], v12 offset:12288
v_mfma_f32_16x16x32_bf16 v[148:151], v[84:87], v[72:75], v[148:151]
ds_read_b128 v[196:199], v19 offset:9216
v_mfma_f32_16x16x32_bf16 v[140:143], v[84:87], v[68:71], v[140:143]
ds_read_b128 v[200:203], v19 offset:10240
v_mfma_f32_16x16x32_bf16 v[132:135], v[84:87], v[64:67], v[132:135]
ds_read_b128 v[204:207], v19 offset:11264
v_mfma_f32_16x16x32_bf16 v[160:163], v[88:91], v[64:67], v[160:163]
v_mfma_f32_16x16x32_bf16 v[168:171], v[88:91], v[68:71], v[168:171]
v_mfma_f32_16x16x32_bf16 v[176:179], v[88:91], v[72:75], v[176:179]
v_mfma_f32_16x16x32_bf16 v[184:187], v[88:91], v[76:79], v[184:187]
v_mfma_f32_16x16x32_bf16 v[188:191], v[92:95], v[76:79], v[188:191]
v_mfma_f32_16x16x32_bf16 v[180:183], v[92:95], v[72:75], v[180:183]
v_mfma_f32_16x16x32_bf16 v[172:175], v[92:95], v[68:71], v[172:175]
v_mfma_f32_16x16x32_bf16 v[164:167], v[92:95], v[64:67], v[164:167]
s_mov_b32 s41, 2
Lk4_121:
s_waitcnt vmcnt(8)
s_waitcnt lgkmcnt(0)
s_barrier
v_mfma_f32_16x16x32_bf16 v[128:131], v[112:115], v[96:99], v[128:131]
ds_read_b128 v[32:35], v17 offset:16384
v_mfma_f32_16x16x32_bf16 v[136:139], v[112:115], v[100:103], v[136:139]
ds_read_b64_tr_b16 v[48:49], v9 offset:32768
v_mfma_f32_16x16x32_bf16 v[144:147], v[112:115], v[104:107], v[144:147]
ds_read_b64_tr_b16 v[50:51], v9 offset:36864
v_mfma_f32_16x16x32_bf16 v[152:155], v[112:115], v[108:111], v[152:155]
ds_read_b64_tr_b16 v[52:53], v10 offset:32768
v_mfma_f32_16x16x32_bf16 v[156:159], v[116:119], v[108:111], v[156:159]
ds_read_b64_tr_b16 v[54:55], v10 offset:36864
v_mfma_f32_16x16x32_bf16 v[148:151], v[116:119], v[104:107], v[148:151]
ds_read_b64_tr_b16 v[56:57], v11 offset:32768
v_mfma_f32_16x16x32_bf16 v[140:143], v[116:119], v[100:103], v[140:143]
ds_read_b64_tr_b16 v[58:59], v11 offset:36864
v_mfma_f32_16x16x32_bf16 v[132:135], v[116:119], v[96:99], v[132:135]
ds_read_b64_tr_b16 v[60:61], v12 offset:32768
v_mfma_f32_16x16x32_bf16 v[160:163], v[120:123], v[96:99], v[160:163]
ds_read_b64_tr_b16 v[62:63], v12 offset:36864
v_mfma_f32_16x16x32_bf16 v[168:171], v[120:123], v[100:103], v[168:171]
ds_read_b128 v[36:39], v17 offset:17408
v_mfma_f32_16x16x32_bf16 v[176:179], v[120:123], v[104:107], v[176:179]
ds_read_b128 v[40:43], v17 offset:18432
v_mfma_f32_16x16x32_bf16 v[184:187], v[120:123], v[108:111], v[184:187]
ds_read_b128 v[44:47], v17 offset:19456
v_mfma_f32_16x16x32_bf16 v[188:191], v[124:127], v[108:111], v[188:191]
ds_read_b128 v[64:67], v17 offset:24576
v_mfma_f32_16x16x32_bf16 v[180:183], v[124:127], v[104:107], v[180:183]
ds_read_b64_tr_b16 v[80:81], v9 offset:40960
v_mfma_f32_16x16x32_bf16 v[172:175], v[124:127], v[100:103], v[172:175]
ds_read_b64_tr_b16 v[82:83], v9 offset:45056
v_mfma_f32_16x16x32_bf16 v[164:167], v[124:127], v[96:99], v[164:167]
ds_read_b64_tr_b16 v[84:85], v10 offset:40960
v_mfma_f32_16x16x32_bf16 v[128:131], v[208:211], v[192:195], v[128:131]
ds_read_b64_tr_b16 v[86:87], v10 offset:45056
v_mfma_f32_16x16x32_bf16 v[136:139], v[208:211], v[196:199], v[136:139]
ds_read_b64_tr_b16 v[88:89], v11 offset:40960
v_mfma_f32_16x16x32_bf16 v[144:147], v[208:211], v[200:203], v[144:147]
ds_read_b64_tr_b16 v[90:91], v11 offset:45056
v_mfma_f32_16x16x32_bf16 v[152:155], v[208:211], v[204:207], v[152:155]
ds_read_b64_tr_b16 v[92:93], v12 offset:40960
v_mfma_f32_16x16x32_bf16 v[156:159], v[212:215], v[204:207], v[156:159]
ds_read_b64_tr_b16 v[94:95], v12 offset:45056
v_mfma_f32_16x16x32_bf16 v[148:151], v[212:215], v[200:203], v[148:151]
ds_read_b128 v[68:71], v17 offset:25600
v_mfma_f32_16x16x32_bf16 v[140:143], v[212:215], v[196:199], v[140:143]
ds_read_b128 v[72:75], v17 offset:26624
v_mfma_f32_16x16x32_bf16 v[132:135], v[212:215], v[192:195], v[132:135]
ds_read_b128 v[76:79], v17 offset:27648
v_mfma_f32_16x16x32_bf16 v[160:163], v[216:219], v[192:195], v[160:163]
v_mfma_f32_16x16x32_bf16 v[168:171], v[216:219], v[196:199], v[168:171]
v_mfma_f32_16x16x32_bf16 v[176:179], v[216:219], v[200:203], v[176:179]
v_mfma_f32_16x16x32_bf16 v[184:187], v[216:219], v[204:207], v[184:187]
v_mfma_f32_16x16x32_bf16 v[188:191], v[220:223], v[204:207], v[188:191]
v_mfma_f32_16x16x32_bf16 v[180:183], v[220:223], v[200:203], v[180:183]
v_mfma_f32_16x16x32_bf16 v[172:175], v[220:223], v[196:199], v[172:175]
v_mfma_f32_16x16x32_bf16 v[164:167], v[220:223], v[192:195], v[164:167]
s_waitcnt vmcnt(0)
s_waitcnt lgkmcnt(0)
s_barrier
v_mfma_f32_16x16x32_bf16 v[128:131], v[48:51], v[32:35], v[128:131]
ds_read_b128 v[96:99], v17 offset:49152
v_mfma_f32_16x16x32_bf16 v[136:139], v[48:51], v[36:39], v[136:139]
ds_read_b64_tr_b16 v[112:113], v13 offset:0
v_mfma_f32_16x16x32_bf16 v[144:147], v[48:51], v[40:43], v[144:147]
ds_read_b64_tr_b16 v[114:115], v13 offset:4096
v_mfma_f32_16x16x32_bf16 v[152:155], v[48:51], v[44:47], v[152:155]
ds_read_b64_tr_b16 v[116:117], v14 offset:0
v_mfma_f32_16x16x32_bf16 v[156:159], v[52:55], v[44:47], v[156:159]
ds_read_b64_tr_b16 v[118:119], v14 offset:4096
v_mfma_f32_16x16x32_bf16 v[148:151], v[52:55], v[40:43], v[148:151]
ds_read_b64_tr_b16 v[120:121], v15 offset:0
v_mfma_f32_16x16x32_bf16 v[140:143], v[52:55], v[36:39], v[140:143]
ds_read_b64_tr_b16 v[122:123], v15 offset:4096
v_mfma_f32_16x16x32_bf16 v[132:135], v[52:55], v[32:35], v[132:135]
ds_read_b64_tr_b16 v[124:125], v16 offset:0
v_mfma_f32_16x16x32_bf16 v[160:163], v[56:59], v[32:35], v[160:163]
ds_read_b64_tr_b16 v[126:127], v16 offset:4096
v_mfma_f32_16x16x32_bf16 v[168:171], v[56:59], v[36:39], v[168:171]
ds_read_b128 v[100:103], v17 offset:50176
v_mfma_f32_16x16x32_bf16 v[176:179], v[56:59], v[40:43], v[176:179]
ds_read_b128 v[104:107], v17 offset:51200
v_mfma_f32_16x16x32_bf16 v[184:187], v[56:59], v[44:47], v[184:187]
ds_read_b128 v[108:111], v17 offset:52224
v_mfma_f32_16x16x32_bf16 v[188:191], v[60:63], v[44:47], v[188:191]
ds_read_b128 v[192:195], v17 offset:57344
v_mfma_f32_16x16x32_bf16 v[180:183], v[60:63], v[40:43], v[180:183]
ds_read_b64_tr_b16 v[208:209], v13 offset:8192
v_mfma_f32_16x16x32_bf16 v[172:175], v[60:63], v[36:39], v[172:175]
ds_read_b64_tr_b16 v[210:211], v13 offset:12288
v_mfma_f32_16x16x32_bf16 v[164:167], v[60:63], v[32:35], v[164:167]
ds_read_b64_tr_b16 v[212:213], v14 offset:8192
v_mfma_f32_16x16x32_bf16 v[128:131], v[80:83], v[64:67], v[128:131]
ds_read_b64_tr_b16 v[214:215], v14 offset:12288
v_mfma_f32_16x16x32_bf16 v[136:139], v[80:83], v[68:71], v[136:139]
ds_read_b64_tr_b16 v[216:217], v15 offset:8192
v_mfma_f32_16x16x32_bf16 v[144:147], v[80:83], v[72:75], v[144:147]
ds_read_b64_tr_b16 v[218:219], v15 offset:12288
v_mfma_f32_16x16x32_bf16 v[152:155], v[80:83], v[76:79], v[152:155]
ds_read_b64_tr_b16 v[220:221], v16 offset:8192
v_mfma_f32_16x16x32_bf16 v[156:159], v[84:87], v[76:79], v[156:159]
ds_read_b64_tr_b16 v[222:223], v16 offset:12288
v_mfma_f32_16x16x32_bf16 v[148:151], v[84:87], v[72:75], v[148:151]
ds_read_b128 v[196:199], v17 offset:58368
v_mfma_f32_16x16x32_bf16 v[140:143], v[84:87], v[68:71], v[140:143]
ds_read_b128 v[200:203], v17 offset:59392
v_mfma_f32_16x16x32_bf16 v[132:135], v[84:87], v[64:67], v[132:135]
ds_read_b128 v[204:207], v17 offset:60416
v_mfma_f32_16x16x32_bf16 v[160:163], v[88:91], v[64:67], v[160:163]
v_mfma_f32_16x16x32_bf16 v[168:171], v[88:91], v[68:71], v[168:171]
v_mfma_f32_16x16x32_bf16 v[176:179], v[88:91], v[72:75], v[176:179]
v_mfma_f32_16x16x32_bf16 v[184:187], v[88:91], v[76:79], v[184:187]
v_mfma_f32_16x16x32_bf16 v[188:191], v[92:95], v[76:79], v[188:191]
v_mfma_f32_16x16x32_bf16 v[180:183], v[92:95], v[72:75], v[180:183]
v_mfma_f32_16x16x32_bf16 v[172:175], v[92:95], v[68:71], v[172:175]
v_mfma_f32_16x16x32_bf16 v[164:167], v[92:95], v[64:67], v[164:167]
s_waitcnt lgkmcnt(0)
s_barrier
v_mfma_f32_16x16x32_bf16 v[128:131], v[112:115], v[96:99], v[128:131]
ds_read_b128 v[32:35], v18 offset:16384
v_mfma_f32_16x16x32_bf16 v[136:139], v[112:115], v[100:103], v[136:139]
ds_read_b64_tr_b16 v[48:49], v25 offset:16384
v_mfma_f32_16x16x32_bf16 v[144:147], v[112:115], v[104:107], v[144:147]
ds_read_b64_tr_b16 v[50:51], v25 offset:20480
v_mfma_f32_16x16x32_bf16 v[152:155], v[112:115], v[108:111], v[152:155]
ds_read_b64_tr_b16 v[52:53], v26 offset:16384
v_mfma_f32_16x16x32_bf16 v[156:159], v[116:119], v[108:111], v[156:159]
ds_read_b64_tr_b16 v[54:55], v26 offset:20480
v_mfma_f32_16x16x32_bf16 v[148:151], v[116:119], v[104:107], v[148:151]
ds_read_b64_tr_b16 v[56:57], v27 offset:16384
s_branch Lov_11
.p2align 12
.fill 80, 4, 0xbf800000
Lst_11_0:
s_branch Lwr_156
Lst_11_1:
s_branch Lst_15_0
s_nop 0
Lov_11:
v_mfma_f32_16x16x32_bf16 v[140:143], v[116:119], v[100:103], v[140:143]
ds_read_b64_tr_b16 v[58:59], v27 offset:20480
v_mfma_f32_16x16x32_bf16 v[132:135], v[116:119], v[96:99], v[132:135]
ds_read_b64_tr_b16 v[60:61], v28 offset:16384
v_mfma_f32_16x16x32_bf16 v[160:163], v[120:123], v[96:99], v[160:163]
ds_read_b64_tr_b16 v[62:63], v28 offset:20480
v_mfma_f32_16x16x32_bf16 v[168:171], v[120:123], v[100:103], v[168:171]
ds_read_b128 v[36:39], v18 offset:17408
v_mfma_f32_16x16x32_bf16 v[176:179], v[120:123], v[104:107], v[176:179]
ds_read_b128 v[40:43], v18 offset:18432
v_mfma_f32_16x16x32_bf16 v[184:187], v[120:123], v[108:111], v[184:187]
ds_read_b128 v[44:47], v18 offset:19456
v_mfma_f32_16x16x32_bf16 v[188:191], v[124:127], v[108:111], v[188:191]
ds_read_b128 v[64:67], v18 offset:24576
v_mfma_f32_16x16x32_bf16 v[180:183], v[124:127], v[104:107], v[180:183]
ds_read_b64_tr_b16 v[80:81], v25 offset:24576
v_mfma_f32_16x16x32_bf16 v[172:175], v[124:127], v[100:103], v[172:175]
ds_read_b64_tr_b16 v[82:83], v25 offset:28672
v_mfma_f32_16x16x32_bf16 v[164:167], v[124:127], v[96:99], v[164:167]
ds_read_b64_tr_b16 v[84:85], v26 offset:24576
v_mfma_f32_16x16x32_bf16 v[128:131], v[208:211], v[192:195], v[128:131]
ds_read_b64_tr_b16 v[86:87], v26 offset:28672
v_mfma_f32_16x16x32_bf16 v[136:139], v[208:211], v[196:199], v[136:139]
ds_read_b64_tr_b16 v[88:89], v27 offset:24576
v_mfma_f32_16x16x32_bf16 v[144:147], v[208:211], v[200:203], v[144:147]
ds_read_b64_tr_b16 v[90:91], v27 offset:28672
v_mfma_f32_16x16x32_bf16 v[152:155], v[208:211], v[204:207], v[152:155]
ds_read_b64_tr_b16 v[92:93], v28 offset:24576
v_mfma_f32_16x16x32_bf16 v[156:159], v[212:215], v[204:207], v[156:159]
ds_read_b64_tr_b16 v[94:95], v28 offset:28672
v_mfma_f32_16x16x32_bf16 v[148:151], v[212:215], v[200:203], v[148:151]
ds_read_b128 v[68:71], v18 offset:25600
v_mfma_f32_16x16x32_bf16 v[140:143], v[212:215], v[196:199], v[140:143]
ds_read_b128 v[72:75], v18 offset:26624
v_mfma_f32_16x16x32_bf16 v[132:135], v[212:215], v[192:195], v[132:135]
ds_read_b128 v[76:79], v18 offset:27648
v_mfma_f32_16x16x32_bf16 v[160:163], v[216:219], v[192:195], v[160:163]
v_mfma_f32_16x16x32_bf16 v[168:171], v[216:219], v[196:199], v[168:171]
v_mfma_f32_16x16x32_bf16 v[176:179], v[216:219], v[200:203], v[176:179]
v_mfma_f32_16x16x32_bf16 v[184:187], v[216:219], v[204:207], v[184:187]
v_mfma_f32_16x16x32_bf16 v[188:191], v[220:223], v[204:207], v[188:191]
v_mfma_f32_16x16x32_bf16 v[180:183], v[220:223], v[200:203], v[180:183]
v_mfma_f32_16x16x32_bf16 v[172:175], v[220:223], v[196:199], v[172:175]
v_mfma_f32_16x16x32_bf16 v[164:167], v[220:223], v[192:195], v[164:167]
s_waitcnt lgkmcnt(0)
s_barrier
v_mfma_f32_16x16x32_bf16 v[128:131], v[48:51], v[32:35], v[128:131]
ds_read_b128 v[96:99], v18 offset:32768
v_mfma_f32_16x16x32_bf16 v[136:139], v[48:51], v[36:39], v[136:139]
ds_read_b64_tr_b16 v[112:113], v13 offset:49152
v_mfma_f32_16x16x32_bf16 v[144:147], v[48:51], v[40:43], v[144:147]
ds_read_b64_tr_b16 v[114:115], v13 offset:53248
v_mfma_f32_16x16x32_bf16 v[152:155], v[48:51], v[44:47], v[152:155]
ds_read_b64_tr_b16 v[116:117], v14 offset:49152
v_mfma_f32_16x16x32_bf16 v[156:159], v[52:55], v[44:47], v[156:159]
ds_read_b64_tr_b16 v[118:119], v14 offset:53248
v_mfma_f32_16x16x32_bf16 v[148:151], v[52:55], v[40:43], v[148:151]
ds_read_b64_tr_b16 v[120:121], v15 offset:49152
v_mfma_f32_16x16x32_bf16 v[140:143], v[52:55], v[36:39], v[140:143]
ds_read_b64_tr_b16 v[122:123], v15 offset:53248
v_mfma_f32_16x16x32_bf16 v[132:135], v[52:55], v[32:35], v[132:135]
ds_read_b64_tr_b16 v[124:125], v16 offset:49152
v_mfma_f32_16x16x32_bf16 v[160:163], v[56:59], v[32:35], v[160:163]
ds_read_b64_tr_b16 v[126:127], v16 offset:53248
v_mfma_f32_16x16x32_bf16 v[168:171], v[56:59], v[36:39], v[168:171]
ds_read_b128 v[100:103], v18 offset:33792
v_mfma_f32_16x16x32_bf16 v[176:179], v[56:59], v[40:43], v[176:179]
ds_read_b128 v[104:107], v18 offset:34816
v_mfma_f32_16x16x32_bf16 v[184:187], v[56:59], v[44:47], v[184:187]
ds_read_b128 v[108:111], v18 offset:35840
v_mfma_f32_16x16x32_bf16 v[188:191], v[60:63], v[44:47], v[188:191]
ds_read_b128 v[192:195], v18 offset:40960
v_mfma_f32_16x16x32_bf16 v[180:183], v[60:63], v[40:43], v[180:183]
ds_read_b64_tr_b16 v[208:209], v13 offset:57344
v_mfma_f32_16x16x32_bf16 v[172:175], v[60:63], v[36:39], v[172:175]
ds_read_b64_tr_b16 v[210:211], v13 offset:61440
v_mfma_f32_16x16x32_bf16 v[164:167], v[60:63], v[32:35], v[164:167]
ds_read_b64_tr_b16 v[212:213], v14 offset:57344
v_mfma_f32_16x16x32_bf16 v[128:131], v[80:83], v[64:67], v[128:131]
ds_read_b64_tr_b16 v[214:215], v14 offset:61440
v_mfma_f32_16x16x32_bf16 v[136:139], v[80:83], v[68:71], v[136:139]
ds_read_b64_tr_b16 v[216:217], v15 offset:57344
v_mfma_f32_16x16x32_bf16 v[144:147], v[80:83], v[72:75], v[144:147]
ds_read_b64_tr_b16 v[218:219], v15 offset:61440
v_mfma_f32_16x16x32_bf16 v[152:155], v[80:83], v[76:79], v[152:155]
ds_read_b64_tr_b16 v[220:221], v16 offset:57344
v_mfma_f32_16x16x32_bf16 v[156:159], v[84:87], v[76:79], v[156:159]
ds_read_b64_tr_b16 v[222:223], v16 offset:61440
v_mfma_f32_16x16x32_bf16 v[148:151], v[84:87], v[72:75], v[148:151]
ds_read_b128 v[196:199], v18 offset:41984
v_mfma_f32_16x16x32_bf16 v[140:143], v[84:87], v[68:71], v[140:143]
ds_read_b128 v[200:203], v18 offset:43008
v_mfma_f32_16x16x32_bf16 v[132:135], v[84:87], v[64:67], v[132:135]
ds_read_b128 v[204:207], v18 offset:44032
v_mfma_f32_16x16x32_bf16 v[160:163], v[88:91], v[64:67], v[160:163]
v_mfma_f32_16x16x32_bf16 v[168:171], v[88:91], v[68:71], v[168:171]
v_mfma_f32_16x16x32_bf16 v[176:179], v[88:91], v[72:75], v[176:179]
v_mfma_f32_16x16x32_bf16 v[184:187], v[88:91], v[76:79], v[184:187]
v_mfma_f32_16x16x32_bf16 v[188:191], v[92:95], v[76:79], v[188:191]
v_mfma_f32_16x16x32_bf16 v[180:183], v[92:95], v[72:75], v[180:183]
v_mfma_f32_16x16x32_bf16 v[172:175], v[92:95], v[68:71], v[172:175]
v_mfma_f32_16x16x32_bf16 v[164:167], v[92:95], v[64:67], v[164:167]
s_waitcnt lgkmcnt(0)
s_barrier
v_mfma_f32_16x16x32_bf16 v[128:131], v[112:115], v[96:99], v[128:131]
ds_read_b128 v[32:35], v19 offset:0
v_mfma_f32_16x16x32_bf16 v[136:139], v[112:115], v[100:103], v[136:139]
ds_read_b64_tr_b16 v[48:49], v9 offset:0
v_mfma_f32_16x16x32_bf16 v[144:147], v[112:115], v[104:107], v[144:147]
ds_read_b64_tr_b16 v[50:51], v9 offset:4096
v_mfma_f32_16x16x32_bf16 v[152:155], v[112:115], v[108:111], v[152:155]
ds_read_b64_tr_b16 v[52:53], v10 offset:0
v_mfma_f32_16x16x32_bf16 v[156:159], v[116:119], v[108:111], v[156:159]
ds_read_b64_tr_b16 v[54:55], v10 offset:4096
v_mfma_f32_16x16x32_bf16 v[148:151], v[116:119], v[104:107], v[148:151]
ds_read_b64_tr_b16 v[56:57], v11 offset:0
v_mfma_f32_16x16x32_bf16 v[140:143], v[116:119], v[100:103], v[140:143]
ds_read_b64_tr_b16 v[58:59], v11 offset:4096
v_mfma_f32_16x16x32_bf16 v[132:135], v[116:119], v[96:99], v[132:135]
ds_read_b64_tr_b16 v[60:61], v12 offset:0
v_mfma_f32_16x16x32_bf16 v[160:163], v[120:123], v[96:99], v[160:163]
ds_read_b64_tr_b16 v[62:63], v12 offset:4096
v_mfma_f32_16x16x32_bf16 v[168:171], v[120:123], v[100:103], v[168:171]
ds_read_b128 v[36:39], v19 offset:1024
v_mfma_f32_16x16x32_bf16 v[176:179], v[120:123], v[104:107], v[176:179]
ds_read_b128 v[40:43], v19 offset:2048
v_mfma_f32_16x16x32_bf16 v[184:187], v[120:123], v[108:111], v[184:187]
ds_read_b128 v[44:47], v19 offset:3072
v_mfma_f32_16x16x32_bf16 v[188:191], v[124:127], v[108:111], v[188:191]
ds_read_b128 v[64:67], v19 offset:8192
v_mfma_f32_16x16x32_bf16 v[180:183], v[124:127], v[104:107], v[180:183]
ds_read_b64_tr_b16 v[80:81], v9 offset:8192
v_mfma_f32_16x16x32_bf16 v[172:175], v[124:127], v[100:103], v[172:175]
ds_read_b64_tr_b16 v[82:83], v9 offset:12288
v_mfma_f32_16x16x32_bf16 v[164:167], v[124:127], v[96:99], v[164:167]
ds_read_b64_tr_b16 v[84:85], v10 offset:8192
v_mfma_f32_16x16x32_bf16 v[128:131], v[208:211], v[192:195], v[128:131]
ds_read_b64_tr_b16 v[86:87], v10 offset:12288
v_mfma_f32_16x16x32_bf16 v[136:139], v[208:211], v[196:199], v[136:139]
ds_read_b64_tr_b16 v[88:89], v11 offset:8192
v_mfma_f32_16x16x32_bf16 v[144:147], v[208:211], v[200:203], v[144:147]
ds_read_b64_tr_b16 v[90:91], v11 offset:12288
v_mfma_f32_16x16x32_bf16 v[152:155], v[208:211], v[204:207], v[152:155]
ds_read_b64_tr_b16 v[92:93], v12 offset:8192
v_mfma_f32_16x16x32_bf16 v[156:159], v[212:215], v[204:207], v[156:159]
ds_read_b64_tr_b16 v[94:95], v12 offset:12288
v_mfma_f32_16x16x32_bf16 v[148:151], v[212:215], v[200:203], v[148:151]
ds_read_b128 v[68:71], v19 offset:9216
v_mfma_f32_16x16x32_bf16 v[140:143], v[212:215], v[196:199], v[140:143]
ds_read_b128 v[72:75], v19 offset:10240
v_mfma_f32_16x16x32_bf16 v[132:135], v[212:215], v[192:195], v[132:135]
ds_read_b128 v[76:79], v19 offset:11264
v_mfma_f32_16x16x32_bf16 v[160:163], v[216:219], v[192:195], v[160:163]
v_mfma_f32_16x16x32_bf16 v[168:171], v[216:219], v[196:199], v[168:171]
v_mfma_f32_16x16x32_bf16 v[176:179], v[216:219], v[200:203], v[176:179]
v_mfma_f32_16x16x32_bf16 v[184:187], v[216:219], v[204:207], v[184:187]
v_mfma_f32_16x16x32_bf16 v[188:191], v[220:223], v[204:207], v[188:191]
v_mfma_f32_16x16x32_bf16 v[180:183], v[220:223], v[200:203], v[180:183]
v_mfma_f32_16x16x32_bf16 v[172:175], v[220:223], v[196:199], v[172:175]
v_mfma_f32_16x16x32_bf16 v[164:167], v[220:223], v[192:195], v[164:167]
s_waitcnt lgkmcnt(0)
s_barrier
v_mfma_f32_16x16x32_bf16 v[128:131], v[48:51], v[32:35], v[128:131]
ds_read_b128 v[96:99], v17 offset:16384
v_mfma_f32_16x16x32_bf16 v[136:139], v[48:51], v[36:39], v[136:139]
ds_read_b64_tr_b16 v[112:113], v9 offset:32768
v_mfma_f32_16x16x32_bf16 v[144:147], v[48:51], v[40:43], v[144:147]
ds_read_b64_tr_b16 v[114:115], v9 offset:36864
v_mfma_f32_16x16x32_bf16 v[152:155], v[48:51], v[44:47], v[152:155]
ds_read_b64_tr_b16 v[116:117], v10 offset:32768
v_mfma_f32_16x16x32_bf16 v[156:159], v[52:55], v[44:47], v[156:159]
ds_read_b64_tr_b16 v[118:119], v10 offset:36864
v_mfma_f32_16x16x32_bf16 v[148:151], v[52:55], v[40:43], v[148:151]
ds_read_b64_tr_b16 v[120:121], v11 offset:32768
v_mfma_f32_16x16x32_bf16 v[140:143], v[52:55], v[36:39], v[140:143]
ds_read_b64_tr_b16 v[122:123], v11 offset:36864
v_mfma_f32_16x16x32_bf16 v[132:135], v[52:55], v[32:35], v[132:135]
ds_read_b64_tr_b16 v[124:125], v12 offset:32768
v_mfma_f32_16x16x32_bf16 v[160:163], v[56:59], v[32:35], v[160:163]
ds_read_b64_tr_b16 v[126:127], v12 offset:36864
v_mfma_f32_16x16x32_bf16 v[168:171], v[56:59], v[36:39], v[168:171]
ds_read_b128 v[100:103], v17 offset:17408
v_mfma_f32_16x16x32_bf16 v[176:179], v[56:59], v[40:43], v[176:179]
ds_read_b128 v[104:107], v17 offset:18432
v_mfma_f32_16x16x32_bf16 v[184:187], v[56:59], v[44:47], v[184:187]
ds_read_b128 v[108:111], v17 offset:19456
v_mfma_f32_16x16x32_bf16 v[188:191], v[60:63], v[44:47], v[188:191]
ds_read_b128 v[192:195], v17 offset:24576
v_mfma_f32_16x16x32_bf16 v[180:183], v[60:63], v[40:43], v[180:183]
ds_read_b64_tr_b16 v[208:209], v9 offset:40960
v_mfma_f32_16x16x32_bf16 v[172:175], v[60:63], v[36:39], v[172:175]
ds_read_b64_tr_b16 v[210:211], v9 offset:45056
v_mfma_f32_16x16x32_bf16 v[164:167], v[60:63], v[32:35], v[164:167]
ds_read_b64_tr_b16 v[212:213], v10 offset:40960
v_mfma_f32_16x16x32_bf16 v[128:131], v[80:83], v[64:67], v[128:131]
ds_read_b64_tr_b16 v[214:215], v10 offset:45056
v_mfma_f32_16x16x32_bf16 v[136:139], v[80:83], v[68:71], v[136:139]
ds_read_b64_tr_b16 v[216:217], v11 offset:40960
v_mfma_f32_16x16x32_bf16 v[144:147], v[80:83], v[72:75], v[144:147]
ds_read_b64_tr_b16 v[218:219], v11 offset:45056
v_mfma_f32_16x16x32_bf16 v[152:155], v[80:83], v[76:79], v[152:155]
ds_read_b64_tr_b16 v[220:221], v12 offset:40960
v_mfma_f32_16x16x32_bf16 v[156:159], v[84:87], v[76:79], v[156:159]
ds_read_b64_tr_b16 v[222:223], v12 offset:45056
v_mfma_f32_16x16x32_bf16 v[148:151], v[84:87], v[72:75], v[148:151]
ds_read_b128 v[196:199], v17 offset:25600
v_mfma_f32_16x16x32_bf16 v[140:143], v[84:87], v[68:71], v[140:143]
ds_read_b128 v[200:203], v17 offset:26624
v_mfma_f32_16x16x32_bf16 v[132:135], v[84:87], v[64:67], v[132:135]
ds_read_b128 v[204:207], v17 offset:27648
v_mfma_f32_16x16x32_bf16 v[160:163], v[88:91], v[64:67], v[160:163]
v_mfma_f32_16x16x32_bf16 v[168:171], v[88:91], v[68:71], v[168:171]
v_mfma_f32_16x16x32_bf16 v[176:179], v[88:91], v[72:75], v[176:179]
v_mfma_f32_16x16x32_bf16 v[184:187], v[88:91], v[76:79], v[184:187]
v_mfma_f32_16x16x32_bf16 v[188:191], v[92:95], v[76:79], v[188:191]
v_mfma_f32_16x16x32_bf16 v[180:183], v[92:95], v[72:75], v[180:183]
v_mfma_f32_16x16x32_bf16 v[172:175], v[92:95], v[68:71], v[172:175]
v_mfma_f32_16x16x32_bf16 v[164:167], v[92:95], v[64:67], v[164:167]
s_waitcnt lgkmcnt(0)
s_barrier
v_mfma_f32_16x16x32_bf16 v[128:131], v[112:115], v[96:99], v[128:131]
ds_read_b128 v[32:35], v17 offset:49152
v_mfma_f32_16x16x32_bf16 v[136:139], v[112:115], v[100:103], v[136:139]
ds_read_b64_tr_b16 v[48:49], v13 offset:0
v_mfma_f32_16x16x32_bf16 v[144:147], v[112:115], v[104:107], v[144:147]
ds_read_b64_tr_b16 v[50:51], v13 offset:4096
v_mfma_f32_16x16x32_bf16 v[152:155], v[112:115], v[108:111], v[152:155]
ds_read_b64_tr_b16 v[52:53], v14 offset:0
v_mfma_f32_16x16x32_bf16 v[156:159], v[116:119], v[108:111], v[156:159]
ds_read_b64_tr_b16 v[54:55], v14 offset:4096
v_mfma_f32_16x16x32_bf16 v[148:151], v[116:119], v[104:107], v[148:151]
ds_read_b64_tr_b16 v[56:57], v15 offset:0
v_mfma_f32_16x16x32_bf16 v[140:143], v[116:119], v[100:103], v[140:143]
ds_read_b64_tr_b16 v[58:59], v15 offset:4096
v_mfma_f32_16x16x32_bf16 v[132:135], v[116:119], v[96:99], v[132:135]
ds_read_b64_tr_b16 v[60:61], v16 offset:0
v_mfma_f32_16x16x32_bf16 v[160:163], v[120:123], v[96:99], v[160:163]
ds_read_b64_tr_b16 v[62:63], v16 offset:4096
v_mfma_f32_16x16x32_bf16 v[168:171], v[120:123], v[100:103], v[168:171]
ds_read_b128 v[36:39], v17 offset:50176
v_mfma_f32_16x16x32_bf16 v[176:179], v[120:123], v[104:107], v[176:179]
ds_read_b128 v[40:43], v17 offset:51200
v_mfma_f32_16x16x32_bf16 v[184:187], v[120:123], v[108:111], v[184:187]
ds_read_b128 v[44:47], v17 offset:52224
v_mfma_f32_16x16x32_bf16 v[188:191], v[124:127], v[108:111], v[188:191]
ds_read_b128 v[64:67], v17 offset:57344
v_mfma_f32_16x16x32_bf16 v[180:183], v[124:127], v[104:107], v[180:183]
ds_read_b64_tr_b16 v[80:81], v13 offset:8192
v_mfma_f32_16x16x32_bf16 v[172:175], v[124:127], v[100:103], v[172:175]
ds_read_b64_tr_b16 v[82:83], v13 offset:12288
v_mfma_f32_16x16x32_bf16 v[164:167], v[124:127], v[96:99], v[164:167]
ds_read_b64_tr_b16 v[84:85], v14 offset:8192
v_mfma_f32_16x16x32_bf16 v[128:131], v[208:211], v[192:195], v[128:131]
ds_read_b64_tr_b16 v[86:87], v14 offset:12288
v_mfma_f32_16x16x32_bf16 v[136:139], v[208:211], v[196:199], v[136:139]
ds_read_b64_tr_b16 v[88:89], v15 offset:8192
v_mfma_f32_16x16x32_bf16 v[144:147], v[208:211], v[200:203], v[144:147]
ds_read_b64_tr_b16 v[90:91], v15 offset:12288
v_mfma_f32_16x16x32_bf16 v[152:155], v[208:211], v[204:207], v[152:155]
ds_read_b64_tr_b16 v[92:93], v16 offset:8192
v_mfma_f32_16x16x32_bf16 v[156:159], v[212:215], v[204:207], v[156:159]
ds_read_b64_tr_b16 v[94:95], v16 offset:12288
v_mfma_f32_16x16x32_bf16 v[148:151], v[212:215], v[200:203], v[148:151]
ds_read_b128 v[68:71], v17 offset:58368
v_mfma_f32_16x16x32_bf16 v[140:143], v[212:215], v[196:199], v[140:143]
ds_read_b128 v[72:75], v17 offset:59392
v_mfma_f32_16x16x32_bf16 v[132:135], v[212:215], v[192:195], v[132:135]
ds_read_b128 v[76:79], v17 offset:60416
v_mfma_f32_16x16x32_bf16 v[160:163], v[216:219], v[192:195], v[160:163]
v_mfma_f32_16x16x32_bf16 v[168:171], v[216:219], v[196:199], v[168:171]
v_mfma_f32_16x16x32_bf16 v[176:179], v[216:219], v[200:203], v[176:179]
v_mfma_f32_16x16x32_bf16 v[184:187], v[216:219], v[204:207], v[184:187]
v_mfma_f32_16x16x32_bf16 v[188:191], v[220:223], v[204:207], v[188:191]
v_mfma_f32_16x16x32_bf16 v[180:183], v[220:223], v[200:203], v[180:183]
v_mfma_f32_16x16x32_bf16 v[172:175], v[220:223], v[196:199], v[172:175]
v_mfma_f32_16x16x32_bf16 v[164:167], v[220:223], v[192:195], v[164:167]
s_waitcnt lgkmcnt(0)
s_barrier
v_mfma_f32_16x16x32_bf16 v[128:131], v[48:51], v[32:35], v[128:131]
ds_read_b128 v[96:99], v18 offset:16384
v_mfma_f32_16x16x32_bf16 v[136:139], v[48:51], v[36:39], v[136:139]
ds_read_b64_tr_b16 v[112:113], v25 offset:16384
v_mfma_f32_16x16x32_bf16 v[144:147], v[48:51], v[40:43], v[144:147]
ds_read_b64_tr_b16 v[114:115], v25 offset:20480
v_mfma_f32_16x16x32_bf16 v[152:155], v[48:51], v[44:47], v[152:155]
ds_read_b64_tr_b16 v[116:117], v26 offset:16384
v_mfma_f32_16x16x32_bf16 v[156:159], v[52:55], v[44:47], v[156:159]
ds_read_b64_tr_b16 v[118:119], v26 offset:20480
v_mfma_f32_16x16x32_bf16 v[148:151], v[52:55], v[40:43], v[148:151]
ds_read_b64_tr_b16 v[120:121], v27 offset:16384
v_mfma_f32_16x16x32_bf16 v[140:143], v[52:55], v[36:39], v[140:143]
ds_read_b64_tr_b16 v[122:123], v27 offset:20480
v_mfma_f32_16x16x32_bf16 v[132:135], v[52:55], v[32:35], v[132:135]
ds_read_b64_tr_b16 v[124:125], v28 offset:16384
v_mfma_f32_16x16x32_bf16 v[160:163], v[56:59], v[32:35], v[160:163]
ds_read_b64_tr_b16 v[126:127], v28 offset:20480
v_mfma_f32_16x16x32_bf16 v[168:171], v[56:59], v[36:39], v[168:171]
ds_read_b128 v[100:103], v18 offset:17408
v_mfma_f32_16x16x32_bf16 v[176:179], v[56:59], v[40:43], v[176:179]
ds_read_b128 v[104:107], v18 offset:18432
v_mfma_f32_16x16x32_bf16 v[184:187], v[56:59], v[44:47], v[184:187]
ds_read_b128 v[108:111], v18 offset:19456
v_mfma_f32_16x16x32_bf16 v[188:191], v[60:63], v[44:47], v[188:191]
ds_read_b128 v[192:195], v18 offset:24576
v_mfma_f32_16x16x32_bf16 v[180:183], v[60:63], v[40:43], v[180:183]
ds_read_b64_tr_b16 v[208:209], v25 offset:24576
v_mfma_f32_16x16x32_bf16 v[172:175], v[60:63], v[36:39], v[172:175]
ds_read_b64_tr_b16 v[210:211], v25 offset:28672
v_mfma_f32_16x16x32_bf16 v[164:167], v[60:63], v[32:35], v[164:167]
ds_read_b64_tr_b16 v[212:213], v26 offset:24576
v_mfma_f32_16x16x32_bf16 v[128:131], v[80:83], v[64:67], v[128:131]
ds_read_b64_tr_b16 v[214:215], v26 offset:28672
v_mfma_f32_16x16x32_bf16 v[136:139], v[80:83], v[68:71], v[136:139]
ds_read_b64_tr_b16 v[216:217], v27 offset:24576
v_mfma_f32_16x16x32_bf16 v[144:147], v[80:83], v[72:75], v[144:147]
ds_read_b64_tr_b16 v[218:219], v27 offset:28672
v_mfma_f32_16x16x32_bf16 v[152:155], v[80:83], v[76:79], v[152:155]
ds_read_b64_tr_b16 v[220:221], v28 offset:24576
v_mfma_f32_16x16x32_bf16 v[156:159], v[84:87], v[76:79], v[156:159]
ds_read_b64_tr_b16 v[222:223], v28 offset:28672
v_mfma_f32_16x16x32_bf16 v[148:151], v[84:87], v[72:75], v[148:151]
ds_read_b128 v[196:199], v18 offset:25600
v_mfma_f32_16x16x32_bf16 v[140:143], v[84:87], v[68:71], v[140:143]
ds_read_b128 v[200:203], v18 offset:26624
v_mfma_f32_16x16x32_bf16 v[132:135], v[84:87], v[64:67], v[132:135]
ds_read_b128 v[204:207], v18 offset:27648
v_mfma_f32_16x16x32_bf16 v[160:163], v[88:91], v[64:67], v[160:163]
v_mfma_f32_16x16x32_bf16 v[168:171], v[88:91], v[68:71], v[168:171]
v_mfma_f32_16x16x32_bf16 v[176:179], v[88:91], v[72:75], v[176:179]
v_mfma_f32_16x16x32_bf16 v[184:187], v[88:91], v[76:79], v[184:187]
v_mfma_f32_16x16x32_bf16 v[188:191], v[92:95], v[76:79], v[188:191]
v_mfma_f32_16x16x32_bf16 v[180:183], v[92:95], v[72:75], v[180:183]
v_mfma_f32_16x16x32_bf16 v[172:175], v[92:95], v[68:71], v[172:175]
v_mfma_f32_16x16x32_bf16 v[164:167], v[92:95], v[64:67], v[164:167]
s_waitcnt lgkmcnt(0)
s_barrier
v_mfma_f32_16x16x32_bf16 v[128:131], v[112:115], v[96:99], v[128:131]
ds_read_b128 v[32:35], v18 offset:32768
v_mfma_f32_16x16x32_bf16 v[136:139], v[112:115], v[100:103], v[136:139]
ds_read_b64_tr_b16 v[48:49], v13 offset:49152
v_mfma_f32_16x16x32_bf16 v[144:147], v[112:115], v[104:107], v[144:147]
ds_read_b64_tr_b16 v[50:51], v13 offset:53248
v_mfma_f32_16x16x32_bf16 v[152:155], v[112:115], v[108:111], v[152:155]
ds_read_b64_tr_b16 v[52:53], v14 offset:49152
v_mfma_f32_16x16x32_bf16 v[156:159], v[116:119], v[108:111], v[156:159]
ds_read_b64_tr_b16 v[54:55], v14 offset:53248
v_mfma_f32_16x16x32_bf16 v[148:151], v[116:119], v[104:107], v[148:151]
ds_read_b64_tr_b16 v[56:57], v15 offset:49152
v_mfma_f32_16x16x32_bf16 v[140:143], v[116:119], v[100:103], v[140:143]
ds_read_b64_tr_b16 v[58:59], v15 offset:53248
v_mfma_f32_16x16x32_bf16 v[132:135], v[116:119], v[96:99], v[132:135]
ds_read_b64_tr_b16 v[60:61], v16 offset:49152
v_mfma_f32_16x16x32_bf16 v[160:163], v[120:123], v[96:99], v[160:163]
ds_read_b64_tr_b16 v[62:63], v16 offset:53248
v_mfma_f32_16x16x32_bf16 v[168:171], v[120:123], v[100:103], v[168:171]
ds_read_b128 v[36:39], v18 offset:33792
v_mfma_f32_16x16x32_bf16 v[176:179], v[120:123], v[104:107], v[176:179]
ds_read_b128 v[40:43], v18 offset:34816
v_mfma_f32_16x16x32_bf16 v[184:187], v[120:123], v[108:111], v[184:187]
ds_read_b128 v[44:47], v18 offset:35840
v_mfma_f32_16x16x32_bf16 v[188:191], v[124:127], v[108:111], v[188:191]
ds_read_b128 v[64:67], v18 offset:40960
v_mfma_f32_16x16x32_bf16 v[180:183], v[124:127], v[104:107], v[180:183]
ds_read_b64_tr_b16 v[80:81], v13 offset:57344
v_mfma_f32_16x16x32_bf16 v[172:175], v[124:127], v[100:103], v[172:175]
ds_read_b64_tr_b16 v[82:83], v13 offset:61440
v_mfma_f32_16x16x32_bf16 v[164:167], v[124:127], v[96:99], v[164:167]
ds_read_b64_tr_b16 v[84:85], v14 offset:57344
v_mfma_f32_16x16x32_bf16 v[128:131], v[208:211], v[192:195], v[128:131]
ds_read_b64_tr_b16 v[86:87], v14 offset:61440
v_mfma_f32_16x16x32_bf16 v[136:139], v[208:211], v[196:199], v[136:139]
ds_read_b64_tr_b16 v[88:89], v15 offset:57344
v_mfma_f32_16x16x32_bf16 v[144:147], v[208:211], v[200:203], v[144:147]
ds_read_b64_tr_b16 v[90:91], v15 offset:61440
v_mfma_f32_16x16x32_bf16 v[152:155], v[208:211], v[204:207], v[152:155]
ds_read_b64_tr_b16 v[92:93], v16 offset:57344
v_mfma_f32_16x16x32_bf16 v[156:159], v[212:215], v[204:207], v[156:159]
ds_read_b64_tr_b16 v[94:95], v16 offset:61440
v_mfma_f32_16x16x32_bf16 v[148:151], v[212:215], v[200:203], v[148:151]
ds_read_b128 v[68:71], v18 offset:41984
v_mfma_f32_16x16x32_bf16 v[140:143], v[212:215], v[196:199], v[140:143]
ds_read_b128 v[72:75], v18 offset:43008
v_mfma_f32_16x16x32_bf16 v[132:135], v[212:215], v[192:195], v[132:135]
ds_read_b128 v[76:79], v18 offset:44032
v_mfma_f32_16x16x32_bf16 v[160:163], v[216:219], v[192:195], v[160:163]
v_mfma_f32_16x16x32_bf16 v[168:171], v[216:219], v[196:199], v[168:171]
v_mfma_f32_16x16x32_bf16 v[176:179], v[216:219], v[200:203], v[176:179]
v_mfma_f32_16x16x32_bf16 v[184:187], v[216:219], v[204:207], v[184:187]
v_mfma_f32_16x16x32_bf16 v[188:191], v[220:223], v[204:207], v[188:191]
v_mfma_f32_16x16x32_bf16 v[180:183], v[220:223], v[200:203], v[180:183]
v_mfma_f32_16x16x32_bf16 v[172:175], v[220:223], v[196:199], v[172:175]
v_mfma_f32_16x16x32_bf16 v[164:167], v[220:223], v[192:195], v[164:167]
s_waitcnt lgkmcnt(0)
s_barrier
v_mfma_f32_16x16x32_bf16 v[128:131], v[48:51], v[32:35], v[128:131]
ds_read_b128 v[96:99], v19 offset:0
v_mfma_f32_16x16x32_bf16 v[136:139], v[48:51], v[36:39], v[136:139]
ds_read_b64_tr_b16 v[112:113], v9 offset:0
v_mfma_f32_16x16x32_bf16 v[144:147], v[48:51], v[40:43], v[144:147]
ds_read_b64_tr_b16 v[114:115], v9 offset:4096
v_mfma_f32_16x16x32_bf16 v[152:155], v[48:51], v[44:47], v[152:155]
ds_read_b64_tr_b16 v[116:117], v10 offset:0
v_mfma_f32_16x16x32_bf16 v[156:159], v[52:55], v[44:47], v[156:159]
ds_read_b64_tr_b16 v[118:119], v10 offset:4096
v_mfma_f32_16x16x32_bf16 v[148:151], v[52:55], v[40:43], v[148:151]
ds_read_b64_tr_b16 v[120:121], v11 offset:0
v_mfma_f32_16x16x32_bf16 v[140:143], v[52:55], v[36:39], v[140:143]
ds_read_b64_tr_b16 v[122:123], v11 offset:4096
v_mfma_f32_16x16x32_bf16 v[132:135], v[52:55], v[32:35], v[132:135]
ds_read_b64_tr_b16 v[124:125], v12 offset:0
v_mfma_f32_16x16x32_bf16 v[160:163], v[56:59], v[32:35], v[160:163]
ds_read_b64_tr_b16 v[126:127], v12 offset:4096
v_mfma_f32_16x16x32_bf16 v[168:171], v[56:59], v[36:39], v[168:171]
ds_read_b128 v[100:103], v19 offset:1024
v_mfma_f32_16x16x32_bf16 v[176:179], v[56:59], v[40:43], v[176:179]
ds_read_b128 v[104:107], v19 offset:2048
v_mfma_f32_16x16x32_bf16 v[184:187], v[56:59], v[44:47], v[184:187]
ds_read_b128 v[108:111], v19 offset:3072
v_mfma_f32_16x16x32_bf16 v[188:191], v[60:63], v[44:47], v[188:191]
ds_read_b128 v[192:195], v19 offset:8192
v_mfma_f32_16x16x32_bf16 v[180:183], v[60:63], v[40:43], v[180:183]
ds_read_b64_tr_b16 v[208:209], v9 offset:8192
v_mfma_f32_16x16x32_bf16 v[172:175], v[60:63], v[36:39], v[172:175]
ds_read_b64_tr_b16 v[210:211], v9 offset:12288
v_mfma_f32_16x16x32_bf16 v[164:167], v[60:63], v[32:35], v[164:167]
ds_read_b64_tr_b16 v[212:213], v10 offset:8192
v_mfma_f32_16x16x32_bf16 v[128:131], v[80:83], v[64:67], v[128:131]
ds_read_b64_tr_b16 v[214:215], v10 offset:12288
v_mfma_f32_16x16x32_bf16 v[136:139], v[80:83], v[68:71], v[136:139]
ds_read_b64_tr_b16 v[216:217], v11 offset:8192
v_mfma_f32_16x16x32_bf16 v[144:147], v[80:83], v[72:75], v[144:147]
ds_read_b64_tr_b16 v[218:219], v11 offset:12288
v_mfma_f32_16x16x32_bf16 v[152:155], v[80:83], v[76:79], v[152:155]
ds_read_b64_tr_b16 v[220:221], v12 offset:8192
v_mfma_f32_16x16x32_bf16 v[156:159], v[84:87], v[76:79], v[156:159]
ds_read_b64_tr_b16 v[222:223], v12 offset:12288
v_mfma_f32_16x16x32_bf16 v[148:151], v[84:87], v[72:75], v[148:151]
ds_read_b128 v[196:199], v19 offset:9216
v_mfma_f32_16x16x32_bf16 v[140:143], v[84:87], v[68:71], v[140:143]
ds_read_b128 v[200:203], v19 offset:10240
v_mfma_f32_16x16x32_bf16 v[132:135], v[84:87], v[64:67], v[132:135]
ds_read_b128 v[204:207], v19 offset:11264
v_mfma_f32_16x16x32_bf16 v[160:163], v[88:91], v[64:67], v[160:163]
v_mfma_f32_16x16x32_bf16 v[168:171], v[88:91], v[68:71], v[168:171]
v_mfma_f32_16x16x32_bf16 v[176:179], v[88:91], v[72:75], v[176:179]
v_mfma_f32_16x16x32_bf16 v[184:187], v[88:91], v[76:79], v[184:187]
v_mfma_f32_16x16x32_bf16 v[188:191], v[92:95], v[76:79], v[188:191]
v_mfma_f32_16x16x32_bf16 v[180:183], v[92:95], v[72:75], v[180:183]
v_mfma_f32_16x16x32_bf16 v[172:175], v[92:95], v[68:71], v[172:175]
v_mfma_f32_16x16x32_bf16 v[164:167], v[92:95], v[64:67], v[164:167]
s_sub_u32 s41, s41, 1
s_cmp_lg_u32 s41, 0
s_cbranch_scc1 Lk4_121
s_waitcnt lgkmcnt(0)
s_barrier
v_mfma_f32_16x16x32_bf16 v[128:131], v[112:115], v[96:99], v[128:131]
ds_read_b128 v[32:35], v17 offset:16384
v_mfma_f32_16x16x32_bf16 v[136:139], v[112:115], v[100:103], v[136:139]
ds_read_b64_tr_b16 v[48:49], v224 offset:32768
v_mfma_f32_16x16x32_bf16 v[144:147], v[112:115], v[104:107], v[144:147]
ds_read_b64_tr_b16 v[50:51], v224 offset:34816
v_mfma_f32_16x16x32_bf16 v[152:155], v[112:115], v[108:111], v[152:155]
ds_read_b64_tr_b16 v[52:53], v225 offset:32768
v_mfma_f32_16x16x32_bf16 v[156:159], v[116:119], v[108:111], v[156:159]
ds_read_b64_tr_b16 v[54:55], v225 offset:34816
v_mfma_f32_16x16x32_bf16 v[148:151], v[116:119], v[104:107], v[148:151]
ds_read_b128 v[36:39], v17 offset:17408
v_mfma_f32_16x16x32_bf16 v[140:143], v[116:119], v[100:103], v[140:143]
ds_read_b128 v[40:43], v17 offset:18432
v_mfma_f32_16x16x32_bf16 v[132:135], v[116:119], v[96:99], v[132:135]
ds_read_b128 v[44:47], v17 offset:19456
v_mfma_f32_16x16x32_bf16 v[160:163], v[120:123], v[96:99], v[160:163]
ds_read_b128 v[64:67], v17 offset:24576
v_mfma_f32_16x16x32_bf16 v[168:171], v[120:123], v[100:103], v[168:171]
ds_read_b64_tr_b16 v[80:81], v224 offset:36864
v_mfma_f32_16x16x32_bf16 v[176:179], v[120:123], v[104:107], v[176:179]
ds_read_b64_tr_b16 v[82:83], v224 offset:38912
v_mfma_f32_16x16x32_bf16 v[184:187], v[120:123], v[108:111], v[184:187]
ds_read_b64_tr_b16 v[84:85], v225 offset:36864
s_branch Lov_12
.p2align 12
.fill 96, 4, 0xbf800000
Lst_12_0:
s_branch Lwr_157
Lst_12_1:
s_branch Lst_16_0
s_nop 0
Lov_12:
v_mfma_f32_16x16x32_bf16 v[188:191], v[124:127], v[108:111], v[188:191]
ds_read_b64_tr_b16 v[86:87], v225 offset:38912
v_mfma_f32_16x16x32_bf16 v[180:183], v[124:127], v[104:107], v[180:183]
ds_read_b128 v[68:71], v17 offset:25600
v_mfma_f32_16x16x32_bf16 v[172:175], v[124:127], v[100:103], v[172:175]
ds_read_b128 v[72:75], v17 offset:26624
v_mfma_f32_16x16x32_bf16 v[164:167], v[124:127], v[96:99], v[164:167]
ds_read_b128 v[76:79], v17 offset:27648
v_mfma_f32_16x16x32_bf16 v[128:131], v[208:211], v[192:195], v[128:131]
v_mfma_f32_16x16x32_bf16 v[136:139], v[208:211], v[196:199], v[136:139]
v_mfma_f32_16x16x32_bf16 v[144:147], v[208:211], v[200:203], v[144:147]
v_mfma_f32_16x16x32_bf16 v[152:155], v[208:211], v[204:207], v[152:155]
v_mfma_f32_16x16x32_bf16 v[156:159], v[212:215], v[204:207], v[156:159]
v_mfma_f32_16x16x32_bf16 v[148:151], v[212:215], v[200:203], v[148:151]
v_mfma_f32_16x16x32_bf16 v[140:143], v[212:215], v[196:199], v[140:143]
v_mfma_f32_16x16x32_bf16 v[132:135], v[212:215], v[192:195], v[132:135]
v_mfma_f32_16x16x32_bf16 v[160:163], v[216:219], v[192:195], v[160:163]
v_mfma_f32_16x16x32_bf16 v[168:171], v[216:219], v[196:199], v[168:171]
v_mfma_f32_16x16x32_bf16 v[176:179], v[216:219], v[200:203], v[176:179]
v_mfma_f32_16x16x32_bf16 v[184:187], v[216:219], v[204:207], v[184:187]
v_mfma_f32_16x16x32_bf16 v[188:191], v[220:223], v[204:207], v[188:191]
v_mfma_f32_16x16x32_bf16 v[180:183], v[220:223], v[200:203], v[180:183]
v_mfma_f32_16x16x32_bf16 v[172:175], v[220:223], v[196:199], v[172:175]
v_mfma_f32_16x16x32_bf16 v[164:167], v[220:223], v[192:195], v[164:167]
s_waitcnt lgkmcnt(0)
s_barrier
v_mfma_f32_16x16x32_bf16 v[128:131], v[48:51], v[32:35], v[128:131]
ds_read_b128 v[96:99], v17 offset:49152
ds_read_b64_tr_b16 v[112:113], v226 offset:0
v_mfma_f32_16x16x32_bf16 v[136:139], v[48:51], v[36:39], v[136:139]
ds_read_b64_tr_b16 v[114:115], v226 offset:2048
ds_read_b64_tr_b16 v[116:117], v227 offset:0
v_mfma_f32_16x16x32_bf16 v[144:147], v[48:51], v[40:43], v[144:147]
ds_read_b64_tr_b16 v[118:119], v227 offset:2048
ds_read_b128 v[100:103], v17 offset:50176
v_mfma_f32_16x16x32_bf16 v[152:155], v[48:51], v[44:47], v[152:155]
ds_read_b128 v[104:107], v17 offset:51200
ds_read_b128 v[108:111], v17 offset:52224
v_mfma_f32_16x16x32_bf16 v[156:159], v[52:55], v[44:47], v[156:159]
ds_read_b128 v[192:195], v17 offset:57344
v_mfma_f32_16x16x32_bf16 v[148:151], v[52:55], v[40:43], v[148:151]
ds_read_b64_tr_b16 v[208:209], v226 offset:4096
v_mfma_f32_16x16x32_bf16 v[140:143], v[52:55], v[36:39], v[140:143]
ds_read_b64_tr_b16 v[210:211], v226 offset:6144
v_cvt_pk_bf16_f32 v160, v160, v161
v_cvt_pk_bf16_f32 v161, v162, v163
v_mfma_f32_16x16x32_bf16 v[132:135], v[52:55], v[32:35], v[132:135]
ds_read_b64_tr_b16 v[212:213], v227 offset:4096
v_cvt_pk_bf16_f32 v162, v164, v165
v_cvt_pk_bf16_f32 v163, v166, v167
v_mfma_f32_16x16x32_bf16 v[128:131], v[80:83], v[64:67], v[128:131]
ds_read_b64_tr_b16 v[214:215], v227 offset:6144
v_cvt_pk_bf16_f32 v164, v168, v169
v_cvt_pk_bf16_f32 v165, v170, v171
v_mfma_f32_16x16x32_bf16 v[136:139], v[80:83], v[68:71], v[136:139]
ds_read_b128 v[196:199], v17 offset:58368
v_cvt_pk_bf16_f32 v166, v172, v173
v_cvt_pk_bf16_f32 v167, v174, v175
v_mfma_f32_16x16x32_bf16 v[144:147], v[80:83], v[72:75], v[144:147]
ds_read_b128 v[200:203], v17 offset:59392
v_cvt_pk_bf16_f32 v168, v176, v177
v_cvt_pk_bf16_f32 v169, v178, v179
v_mfma_f32_16x16x32_bf16 v[152:155], v[80:83], v[76:79], v[152:155]
ds_read_b128 v[204:207], v17 offset:60416
v_cvt_pk_bf16_f32 v170, v180, v181
v_cvt_pk_bf16_f32 v171, v182, v183
v_mfma_f32_16x16x32_bf16 v[156:159], v[84:87], v[76:79], v[156:159]
v_cvt_pk_bf16_f32 v172, v184, v185
v_cvt_pk_bf16_f32 v173, v186, v187
v_mfma_f32_16x16x32_bf16 v[148:151], v[84:87], v[72:75], v[148:151]
v_cvt_pk_bf16_f32 v174, v188, v189
v_cvt_pk_bf16_f32 v175, v190, v191
v_mfma_f32_16x16x32_bf16 v[140:143], v[84:87], v[68:71], v[140:143]
v_mfma_f32_16x16x32_bf16 v[132:135], v[84:87], v[64:67], v[132:135]
buffer_store_dwordx4 v[160:163], v2, s[84:87], s45 offen offset:0 sc1
s_waitcnt lgkmcnt(0)
s_barrier
v_mfma_f32_16x16x32_bf16 v[128:131], v[112:115], v[96:99], v[128:131]
ds_read_b128 v[32:35], v18 offset:16384
ds_read_b64_tr_b16 v[48:49], v228 offset:16384
v_mfma_f32_16x16x32_bf16 v[136:139], v[112:115], v[100:103], v[136:139]
ds_read_b64_tr_b16 v[50:51], v228 offset:18432
ds_read_b64_tr_b16 v[52:53], v229 offset:16384
v_mfma_f32_16x16x32_bf16 v[144:147], v[112:115], v[104:107], v[144:147]
ds_read_b64_tr_b16 v[54:55], v229 offset:18432
ds_read_b128 v[36:39], v18 offset:17408
v_mfma_f32_16x16x32_bf16 v[152:155], v[112:115], v[108:111], v[152:155]
ds_read_b128 v[40:43], v18 offset:18432
ds_read_b128 v[44:47], v18 offset:19456
v_mfma_f32_16x16x32_bf16 v[156:159], v[116:119], v[108:111], v[156:159]
ds_read_b128 v[64:67], v18 offset:24576
v_mfma_f32_16x16x32_bf16 v[148:151], v[116:119], v[104:107], v[148:151]
ds_read_b64_tr_b16 v[80:81], v228 offset:20480
v_mfma_f32_16x16x32_bf16 v[140:143], v[116:119], v[100:103], v[140:143]
ds_read_b64_tr_b16 v[82:83], v228 offset:22528
v_mfma_f32_16x16x32_bf16 v[132:135], v[116:119], v[96:99], v[132:135]
ds_read_b64_tr_b16 v[84:85], v229 offset:20480
v_mfma_f32_16x16x32_bf16 v[128:131], v[208:211], v[192:195], v[128:131]
ds_read_b64_tr_b16 v[86:87], v229 offset:22528
buffer_store_dwordx4 v[164:167], v2, s[84:87], s45 offen offset:1024 sc1
v_mfma_f32_16x16x32_bf16 v[136:139], v[208:211], v[196:199], v[136:139]
ds_read_b128 v[68:71], v18 offset:25600
v_mfma_f32_16x16x32_bf16 v[144:147], v[208:211], v[200:203], v[144:147]
ds_read_b128 v[72:75], v18 offset:26624
v_mfma_f32_16x16x32_bf16 v[152:155], v[208:211], v[204:207], v[152:155]
ds_read_b128 v[76:79], v18 offset:27648
v_mfma_f32_16x16x32_bf16 v[156:159], v[212:215], v[204:207], v[156:159]
v_mfma_f32_16x16x32_bf16 v[148:151], v[212:215], v[200:203], v[148:151]
v_mfma_f32_16x16x32_bf16 v[140:143], v[212:215], v[196:199], v[140:143]
v_mfma_f32_16x16x32_bf16 v[132:135], v[212:215], v[192:195], v[132:135]
s_waitcnt lgkmcnt(0)
s_barrier
v_mfma_f32_16x16x32_bf16 v[128:131], v[48:51], v[32:35], v[128:131]
ds_read_b128 v[96:99], v18 offset:32768
ds_read_b64_tr_b16 v[112:113], v226 offset:49152
v_mfma_f32_16x16x32_bf16 v[136:139], v[48:51], v[36:39], v[136:139]
ds_read_b64_tr_b16 v[114:115], v226 offset:51200
ds_read_b64_tr_b16 v[116:117], v227 offset:49152
v_mfma_f32_16x16x32_bf16 v[144:147], v[48:51], v[40:43], v[144:147]
ds_read_b64_tr_b16 v[118:119], v227 offset:51200
ds_read_b128 v[100:103], v18 offset:33792
v_mfma_f32_16x16x32_bf16 v[152:155], v[48:51], v[44:47], v[152:155]
ds_read_b128 v[104:107], v18 offset:34816
ds_read_b128 v[108:111], v18 offset:35840
v_mfma_f32_16x16x32_bf16 v[156:159], v[52:55], v[44:47], v[156:159]
ds_read_b128 v[192:195], v18 offset:40960
v_mfma_f32_16x16x32_bf16 v[148:151], v[52:55], v[40:43], v[148:151]
ds_read_b64_tr_b16 v[208:209], v226 offset:53248
v_mfma_f32_16x16x32_bf16 v[140:143], v[52:55], v[36:39], v[140:143]
ds_read_b64_tr_b16 v[210:211], v226 offset:55296
v_mfma_f32_16x16x32_bf16 v[132:135], v[52:55], v[32:35], v[132:135]
ds_read_b64_tr_b16 v[212:213], v227 offset:53248
v_mfma_f32_16x16x32_bf16 v[128:131], v[80:83], v[64:67], v[128:131]
ds_read_b64_tr_b16 v[214:215], v227 offset:55296
buffer_store_dwordx4 v[168:171], v2, s[84:87], s45 offen offset:2048 sc1
v_mfma_f32_16x16x32_bf16 v[136:139], v[80:83], v[68:71], v[136:139]
ds_read_b128 v[196:199], v18 offset:41984
v_mfma_f32_16x16x32_bf16 v[144:147], v[80:83], v[72:75], v[144:147]
ds_read_b128 v[200:203], v18 offset:43008
v_mfma_f32_16x16x32_bf16 v[152:155], v[80:83], v[76:79], v[152:155]
ds_read_b128 v[204:207], v18 offset:44032
v_mfma_f32_16x16x32_bf16 v[156:159], v[84:87], v[76:79], v[156:159]
v_mfma_f32_16x16x32_bf16 v[148:151], v[84:87], v[72:75], v[148:151]
v_mfma_f32_16x16x32_bf16 v[140:143], v[84:87], v[68:71], v[140:143]
v_mfma_f32_16x16x32_bf16 v[132:135], v[84:87], v[64:67], v[132:135]
s_waitcnt lgkmcnt(0)
s_barrier
v_mfma_f32_16x16x32_bf16 v[128:131], v[112:115], v[96:99], v[128:131]
ds_read_b128 v[32:35], v19 offset:0
ds_read_b64_tr_b16 v[48:49], v224 offset:0
v_mfma_f32_16x16x32_bf16 v[136:139], v[112:115], v[100:103], v[136:139]
ds_read_b64_tr_b16 v[50:51], v224 offset:2048
ds_read_b64_tr_b16 v[52:53], v225 offset:0
v_mfma_f32_16x16x32_bf16 v[144:147], v[112:115], v[104:107], v[144:147]
ds_read_b64_tr_b16 v[54:55], v225 offset:2048
ds_read_b128 v[36:39], v19 offset:1024
v_mfma_f32_16x16x32_bf16 v[152:155], v[112:115], v[108:111], v[152:155]
ds_read_b128 v[40:43], v19 offset:2048
ds_read_b128 v[44:47], v19 offset:3072
v_mfma_f32_16x16x32_bf16 v[156:159], v[116:119], v[108:111], v[156:159]
ds_read_b128 v[64:67], v19 offset:8192
v_mfma_f32_16x16x32_bf16 v[148:151], v[116:119], v[104:107], v[148:151]
ds_read_b64_tr_b16 v[80:81], v224 offset:4096
v_mfma_f32_16x16x32_bf16 v[140:143], v[116:119], v[100:103], v[140:143]
ds_read_b64_tr_b16 v[82:83], v224 offset:6144
v_mfma_f32_16x16x32_bf16 v[132:135], v[116:119], v[96:99], v[132:135]
ds_read_b64_tr_b16 v[84:85], v225 offset:4096
v_mfma_f32_16x16x32_bf16 v[128:131], v[208:211], v[192:195], v[128:131]
ds_read_b64_tr_b16 v[86:87], v225 offset:6144
buffer_store_dwordx4 v[172:175], v2, s[84:87], s45 offen offset:3072 sc1
v_mfma_f32_16x16x32_bf16 v[136:139], v[208:211], v[196:199], v[136:139]
ds_read_b128 v[68:71], v19 offset:9216
v_mfma_f32_16x16x32_bf16 v[144:147], v[208:211], v[200:203], v[144:147]
ds_read_b128 v[72:75], v19 offset:10240
v_mfma_f32_16x16x32_bf16 v[152:155], v[208:211], v[204:207], v[152:155]
ds_read_b128 v[76:79], v19 offset:11264
v_mfma_f32_16x16x32_bf16 v[156:159], v[212:215], v[204:207], v[156:159]
v_mfma_f32_16x16x32_bf16 v[148:151], v[212:215], v[200:203], v[148:151]
v_mfma_f32_16x16x32_bf16 v[140:143], v[212:215], v[196:199], v[140:143]
v_mfma_f32_16x16x32_bf16 v[132:135], v[212:215], v[192:195], v[132:135]
s_waitcnt lgkmcnt(0)
s_barrier
v_mfma_f32_16x16x32_bf16 v[128:131], v[48:51], v[32:35], v[128:131]
ds_read_b128 v[96:99], v17 offset:16384
ds_read_b64_tr_b16 v[112:113], v224 offset:32768
v_mfma_f32_16x16x32_bf16 v[136:139], v[48:51], v[36:39], v[136:139]
ds_read_b64_tr_b16 v[114:115], v224 offset:34816
ds_read_b64_tr_b16 v[116:117], v225 offset:32768
v_mfma_f32_16x16x32_bf16 v[144:147], v[48:51], v[40:43], v[144:147]
ds_read_b64_tr_b16 v[118:119], v225 offset:34816
ds_read_b128 v[100:103], v17 offset:17408
v_mfma_f32_16x16x32_bf16 v[152:155], v[48:51], v[44:47], v[152:155]
ds_read_b128 v[104:107], v17 offset:18432
ds_read_b128 v[108:111], v17 offset:19456
v_mfma_f32_16x16x32_bf16 v[156:159], v[52:55], v[44:47], v[156:159]
ds_read_b128 v[192:195], v17 offset:24576
v_mfma_f32_16x16x32_bf16 v[148:151], v[52:55], v[40:43], v[148:151]
ds_read_b64_tr_b16 v[208:209], v224 offset:36864
v_mfma_f32_16x16x32_bf16 v[140:143], v[52:55], v[36:39], v[140:143]
ds_read_b64_tr_b16 v[210:211], v224 offset:38912
v_mfma_f32_16x16x32_bf16 v[132:135], v[52:55], v[32:35], v[132:135]
ds_read_b64_tr_b16 v[212:213], v225 offset:36864
v_mfma_f32_16x16x32_bf16 v[128:131], v[80:83], v[64:67], v[128:131]
ds_read_b64_tr_b16 v[214:215], v225 offset:38912
v_mfma_f32_16x16x32_bf16 v[136:139], v[80:83], v[68:71], v[136:139]
ds_read_b128 v[196:199], v17 offset:25600
v_mfma_f32_16x16x32_bf16 v[144:147], v[80:83], v[72:75], v[144:147]
ds_read_b128 v[200:203], v17 offset:26624
v_mfma_f32_16x16x32_bf16 v[152:155], v[80:83], v[76:79], v[152:155]
ds_read_b128 v[204:207], v17 offset:27648
v_mfma_f32_16x16x32_bf16 v[156:159], v[84:87], v[76:79], v[156:159]
v_mfma_f32_16x16x32_bf16 v[148:151], v[84:87], v[72:75], v[148:151]
v_mfma_f32_16x16x32_bf16 v[140:143], v[84:87], v[68:71], v[140:143]
v_mfma_f32_16x16x32_bf16 v[132:135], v[84:87], v[64:67], v[132:135]
s_waitcnt vmcnt(0)
s_waitcnt lgkmcnt(0)
s_barrier
v_mfma_f32_16x16x32_bf16 v[128:131], v[112:115], v[96:99], v[128:131]
ds_read_b128 v[32:35], v17 offset:49152
ds_read_b64_tr_b16 v[48:49], v226 offset:0
v_mfma_f32_16x16x32_bf16 v[136:139], v[112:115], v[100:103], v[136:139]
ds_read_b64_tr_b16 v[50:51], v226 offset:2048
ds_read_b64_tr_b16 v[52:53], v227 offset:0
v_mfma_f32_16x16x32_bf16 v[144:147], v[112:115], v[104:107], v[144:147]
ds_read_b64_tr_b16 v[54:55], v227 offset:2048
ds_read_b128 v[36:39], v17 offset:50176
v_mfma_f32_16x16x32_bf16 v[152:155], v[112:115], v[108:111], v[152:155]
ds_read_b128 v[40:43], v17 offset:51200
ds_read_b128 v[44:47], v17 offset:52224
v_mfma_f32_16x16x32_bf16 v[156:159], v[116:119], v[108:111], v[156:159]
ds_read_b128 v[64:67], v17 offset:57344
v_mfma_f32_16x16x32_bf16 v[148:151], v[116:119], v[104:107], v[148:151]
ds_read_b64_tr_b16 v[80:81], v226 offset:4096
v_mfma_f32_16x16x32_bf16 v[140:143], v[116:119], v[100:103], v[140:143]
ds_read_b64_tr_b16 v[82:83], v226 offset:6144
v_mfma_f32_16x16x32_bf16 v[132:135], v[116:119], v[96:99], v[132:135]
ds_read_b64_tr_b16 v[84:85], v227 offset:4096
v_mfma_f32_16x16x32_bf16 v[128:131], v[208:211], v[192:195], v[128:131]
ds_read_b64_tr_b16 v[86:87], v227 offset:6144
v_mfma_f32_16x16x32_bf16 v[136:139], v[208:211], v[196:199], v[136:139]
ds_read_b128 v[68:71], v17 offset:58368
v_mfma_f32_16x16x32_bf16 v[144:147], v[208:211], v[200:203], v[144:147]
ds_read_b128 v[72:75], v17 offset:59392
v_mfma_f32_16x16x32_bf16 v[152:155], v[208:211], v[204:207], v[152:155]
ds_read_b128 v[76:79], v17 offset:60416
v_mfma_f32_16x16x32_bf16 v[156:159], v[212:215], v[204:207], v[156:159]
v_mfma_f32_16x16x32_bf16 v[148:151], v[212:215], v[200:203], v[148:151]
v_mfma_f32_16x16x32_bf16 v[140:143], v[212:215], v[196:199], v[140:143]
v_mfma_f32_16x16x32_bf16 v[132:135], v[212:215], v[192:195], v[132:135]
s_waitcnt lgkmcnt(0)
s_barrier
v_mfma_f32_16x16x32_bf16 v[128:131], v[48:51], v[32:35], v[128:131]
ds_read_b128 v[96:99], v18 offset:16384
ds_read_b64_tr_b16 v[112:113], v228 offset:16384
v_mfma_f32_16x16x32_bf16 v[136:139], v[48:51], v[36:39], v[136:139]
ds_read_b64_tr_b16 v[114:115], v228 offset:18432
ds_read_b64_tr_b16 v[116:117], v229 offset:16384
v_mfma_f32_16x16x32_bf16 v[144:147], v[48:51], v[40:43], v[144:147]
ds_read_b64_tr_b16 v[118:119], v229 offset:18432
ds_read_b128 v[100:103], v18 offset:17408
v_mfma_f32_16x16x32_bf16 v[152:155], v[48:51], v[44:47], v[152:155]
ds_read_b128 v[104:107], v18 offset:18432
ds_read_b128 v[108:111], v18 offset:19456
v_mfma_f32_16x16x32_bf16 v[156:159], v[52:55], v[44:47], v[156:159]
ds_read_b128 v[192:195], v18 offset:24576
v_mfma_f32_16x16x32_bf16 v[148:151], v[52:55], v[40:43], v[148:151]
ds_read_b64_tr_b16 v[208:209], v228 offset:20480
v_mfma_f32_16x16x32_bf16 v[140:143], v[52:55], v[36:39], v[140:143]
ds_read_b64_tr_b16 v[210:211], v228 offset:22528
v_mfma_f32_16x16x32_bf16 v[132:135], v[52:55], v[32:35], v[132:135]
ds_read_b64_tr_b16 v[212:213], v229 offset:20480
v_mfma_f32_16x16x32_bf16 v[128:131], v[80:83], v[64:67], v[128:131]
ds_read_b64_tr_b16 v[214:215], v229 offset:22528
v_mfma_f32_16x16x32_bf16 v[136:139], v[80:83], v[68:71], v[136:139]
ds_read_b128 v[196:199], v18 offset:25600
v_mfma_f32_16x16x32_bf16 v[144:147], v[80:83], v[72:75], v[144:147]
ds_read_b128 v[200:203], v18 offset:26624
v_mfma_f32_16x16x32_bf16 v[152:155], v[80:83], v[76:79], v[152:155]
ds_read_b128 v[204:207], v18 offset:27648
v_mfma_f32_16x16x32_bf16 v[156:159], v[84:87], v[76:79], v[156:159]
v_mfma_f32_16x16x32_bf16 v[148:151], v[84:87], v[72:75], v[148:151]
v_mfma_f32_16x16x32_bf16 v[140:143], v[84:87], v[68:71], v[140:143]
v_mfma_f32_16x16x32_bf16 v[132:135], v[84:87], v[64:67], v[132:135]
s_waitcnt lgkmcnt(0)
s_barrier
v_mfma_f32_16x16x32_bf16 v[128:131], v[112:115], v[96:99], v[128:131]
ds_read_b128 v[32:35], v18 offset:32768
ds_read_b64_tr_b16 v[48:49], v226 offset:49152
v_mfma_f32_16x16x32_bf16 v[136:139], v[112:115], v[100:103], v[136:139]
ds_read_b64_tr_b16 v[50:51], v226 offset:51200
ds_read_b64_tr_b16 v[52:53], v227 offset:49152
v_mfma_f32_16x16x32_bf16 v[144:147], v[112:115], v[104:107], v[144:147]
ds_read_b64_tr_b16 v[54:55], v227 offset:51200
ds_read_b128 v[36:39], v18 offset:33792
v_mfma_f32_16x16x32_bf16 v[152:155], v[112:115], v[108:111], v[152:155]
ds_read_b128 v[40:43], v18 offset:34816
ds_read_b128 v[44:47], v18 offset:35840
v_mfma_f32_16x16x32_bf16 v[156:159], v[116:119], v[108:111], v[156:159]
ds_read_b128 v[64:67], v18 offset:40960
v_mfma_f32_16x16x32_bf16 v[148:151], v[116:119], v[104:107], v[148:151]
ds_read_b64_tr_b16 v[80:81], v226 offset:53248
v_mfma_f32_16x16x32_bf16 v[140:143], v[116:119], v[100:103], v[140:143]
ds_read_b64_tr_b16 v[82:83], v226 offset:55296
v_mfma_f32_16x16x32_bf16 v[132:135], v[116:119], v[96:99], v[132:135]
ds_read_b64_tr_b16 v[84:85], v227 offset:53248
v_mfma_f32_16x16x32_bf16 v[128:131], v[208:211], v[192:195], v[128:131]
ds_read_b64_tr_b16 v[86:87], v227 offset:55296
v_mfma_f32_16x16x32_bf16 v[136:139], v[208:211], v[196:199], v[136:139]
ds_read_b128 v[68:71], v18 offset:41984
v_mfma_f32_16x16x32_bf16 v[144:147], v[208:211], v[200:203], v[144:147]
ds_read_b128 v[72:75], v18 offset:43008
v_mfma_f32_16x16x32_bf16 v[152:155], v[208:211], v[204:207], v[152:155]
ds_read_b128 v[76:79], v18 offset:44032
v_mfma_f32_16x16x32_bf16 v[156:159], v[212:215], v[204:207], v[156:159]
v_mfma_f32_16x16x32_bf16 v[148:151], v[212:215], v[200:203], v[148:151]
v_mfma_f32_16x16x32_bf16 v[140:143], v[212:215], v[196:199], v[140:143]
v_mfma_f32_16x16x32_bf16 v[132:135], v[212:215], v[192:195], v[132:135]
s_waitcnt lgkmcnt(0)
s_barrier
buffer_load_dwordx4 v[232:235], v2, s[84:87], s46 offen offset:0 sc1
buffer_load_dwordx4 v[236:239], v2, s[84:87], s46 offen offset:1024 sc1
buffer_load_dwordx4 v[240:243], v2, s[84:87], s46 offen offset:2048 sc1
buffer_load_dwordx4 v[244:247], v2, s[84:87], s46 offen offset:3072 sc1
v_mfma_f32_16x16x32_bf16 v[128:131], v[48:51], v[32:35], v[128:131]
ds_read_b128 v[96:99], v19 offset:0
ds_read_b64_tr_b16 v[112:113], v224 offset:0
v_mfma_f32_16x16x32_bf16 v[136:139], v[48:51], v[36:39], v[136:139]
ds_read_b64_tr_b16 v[114:115], v224 offset:2048
ds_read_b64_tr_b16 v[116:117], v225 offset:0
v_mfma_f32_16x16x32_bf16 v[144:147], v[48:51], v[40:43], v[144:147]
ds_read_b64_tr_b16 v[118:119], v225 offset:2048
ds_read_b128 v[100:103], v19 offset:1024
v_mfma_f32_16x16x32_bf16 v[152:155], v[48:51], v[44:47], v[152:155]
ds_read_b128 v[104:107], v19 offset:2048
ds_read_b128 v[108:111], v19 offset:3072
v_mfma_f32_16x16x32_bf16 v[156:159], v[52:55], v[44:47], v[156:159]
ds_read_b128 v[192:195], v19 offset:8192
v_mfma_f32_16x16x32_bf16 v[148:151], v[52:55], v[40:43], v[148:151]
ds_read_b64_tr_b16 v[208:209], v224 offset:4096
v_mfma_f32_16x16x32_bf16 v[140:143], v[52:55], v[36:39], v[140:143]
ds_read_b64_tr_b16 v[210:211], v224 offset:6144
v_mfma_f32_16x16x32_bf16 v[132:135], v[52:55], v[32:35], v[132:135]
ds_read_b64_tr_b16 v[212:213], v225 offset:4096
v_mfma_f32_16x16x32_bf16 v[128:131], v[80:83], v[64:67], v[128:131]
ds_read_b64_tr_b16 v[214:215], v225 offset:6144
v_mfma_f32_16x16x32_bf16 v[136:139], v[80:83], v[68:71], v[136:139]
ds_read_b128 v[196:199], v19 offset:9216
v_mfma_f32_16x16x32_bf16 v[144:147], v[80:83], v[72:75], v[144:147]
ds_read_b128 v[200:203], v19 offset:10240
v_mfma_f32_16x16x32_bf16 v[152:155], v[80:83], v[76:79], v[152:155]
ds_read_b128 v[204:207], v19 offset:11264
v_mfma_f32_16x16x32_bf16 v[156:159], v[84:87], v[76:79], v[156:159]
v_mfma_f32_16x16x32_bf16 v[148:151], v[84:87], v[72:75], v[148:151]
v_mfma_f32_16x16x32_bf16 v[140:143], v[84:87], v[68:71], v[140:143]
v_mfma_f32_16x16x32_bf16 v[132:135], v[84:87], v[64:67], v[132:135]
s_waitcnt lgkmcnt(0)
s_barrier
v_mfma_f32_16x16x32_bf16 v[128:131], v[112:115], v[96:99], v[128:131]
ds_read_b128 v[32:35], v17 offset:16384
ds_read_b64_tr_b16 v[48:49], v224 offset:32768
v_mfma_f32_16x16x32_bf16 v[136:139], v[112:115], v[100:103], v[136:139]
ds_read_b64_tr_b16 v[50:51], v224 offset:34816
ds_read_b64_tr_b16 v[52:53], v225 offset:32768
v_mfma_f32_16x16x32_bf16 v[144:147], v[112:115], v[104:107], v[144:147]
ds_read_b64_tr_b16 v[54:55], v225 offset:34816
ds_read_b128 v[36:39], v17 offset:17408
v_mfma_f32_16x16x32_bf16 v[152:155], v[112:115], v[108:111], v[152:155]
ds_read_b128 v[40:43], v17 offset:18432
ds_read_b128 v[44:47], v17 offset:19456
v_mfma_f32_16x16x32_bf16 v[156:159], v[116:119], v[108:111], v[156:159]
ds_read_b128 v[64:67], v17 offset:24576
v_mfma_f32_16x16x32_bf16 v[148:151], v[116:119], v[104:107], v[148:151]
ds_read_b64_tr_b16 v[80:81], v224 offset:36864
v_mfma_f32_16x16x32_bf16 v[140:143], v[116:119], v[100:103], v[140:143]
ds_read_b64_tr_b16 v[82:83], v224 offset:38912
v_mfma_f32_16x16x32_bf16 v[132:135], v[116:119], v[96:99], v[132:135]
ds_read_b64_tr_b16 v[84:85], v225 offset:36864
v_mfma_f32_16x16x32_bf16 v[128:131], v[208:211], v[192:195], v[128:131]
ds_read_b64_tr_b16 v[86:87], v225 offset:38912
v_mfma_f32_16x16x32_bf16 v[136:139], v[208:211], v[196:199], v[136:139]
ds_read_b128 v[68:71], v17 offset:25600
v_mfma_f32_16x16x32_bf16 v[144:147], v[208:211], v[200:203], v[144:147]
ds_read_b128 v[72:75], v17 offset:26624
v_mfma_f32_16x16x32_bf16 v[152:155], v[208:211], v[204:207], v[152:155]
ds_read_b128 v[76:79], v17 offset:27648
v_mfma_f32_16x16x32_bf16 v[156:159], v[212:215], v[204:207], v[156:159]
v_mfma_f32_16x16x32_bf16 v[148:151], v[212:215], v[200:203], v[148:151]
v_mfma_f32_16x16x32_bf16 v[140:143], v[212:215], v[196:199], v[140:143]
v_mfma_f32_16x16x32_bf16 v[132:135], v[212:215], v[192:195], v[132:135]
s_waitcnt lgkmcnt(0)
s_barrier
v_mfma_f32_16x16x32_bf16 v[128:131], v[48:51], v[32:35], v[128:131]
ds_read_b128 v[96:99], v17 offset:49152
ds_read_b64_tr_b16 v[112:113], v226 offset:0
v_mfma_f32_16x16x32_bf16 v[136:139], v[48:51], v[36:39], v[136:139]
ds_read_b64_tr_b16 v[114:115], v226 offset:2048
ds_read_b64_tr_b16 v[116:117], v227 offset:0
v_mfma_f32_16x16x32_bf16 v[144:147], v[48:51], v[40:43], v[144:147]
ds_read_b64_tr_b16 v[118:119], v227 offset:2048
ds_read_b128 v[100:103], v17 offset:50176
v_mfma_f32_16x16x32_bf16 v[152:155], v[48:51], v[44:47], v[152:155]
ds_read_b128 v[104:107], v17 offset:51200
ds_read_b128 v[108:111], v17 offset:52224
v_mfma_f32_16x16x32_bf16 v[156:159], v[52:55], v[44:47], v[156:159]
ds_read_b128 v[192:195], v17 offset:57344
v_mfma_f32_16x16x32_bf16 v[148:151], v[52:55], v[40:43], v[148:151]
ds_read_b64_tr_b16 v[208:209], v226 offset:4096
v_mfma_f32_16x16x32_bf16 v[140:143], v[52:55], v[36:39], v[140:143]
ds_read_b64_tr_b16 v[210:211], v226 offset:6144
v_mfma_f32_16x16x32_bf16 v[132:135], v[52:55], v[32:35], v[132:135]
ds_read_b64_tr_b16 v[212:213], v227 offset:4096
v_mfma_f32_16x16x32_bf16 v[128:131], v[80:83], v[64:67], v[128:131]
ds_read_b64_tr_b16 v[214:215], v227 offset:6144
v_mfma_f32_16x16x32_bf16 v[136:139], v[80:83], v[68:71], v[136:139]
ds_read_b128 v[196:199], v17 offset:58368
v_mfma_f32_16x16x32_bf16 v[144:147], v[80:83], v[72:75], v[144:147]
ds_read_b128 v[200:203], v17 offset:59392
v_mfma_f32_16x16x32_bf16 v[152:155], v[80:83], v[76:79], v[152:155]
ds_read_b128 v[204:207], v17 offset:60416
v_mfma_f32_16x16x32_bf16 v[156:159], v[84:87], v[76:79], v[156:159]
v_mfma_f32_16x16x32_bf16 v[148:151], v[84:87], v[72:75], v[148:151]
v_mfma_f32_16x16x32_bf16 v[140:143], v[84:87], v[68:71], v[140:143]
v_mfma_f32_16x16x32_bf16 v[132:135], v[84:87], v[64:67], v[132:135]
s_waitcnt vmcnt(0)
s_waitcnt lgkmcnt(0)
s_barrier
v_mfma_f32_16x16x32_bf16 v[128:131], v[112:115], v[96:99], v[128:131]
v_lshlrev_b32 v160, 16, v232
v_and_b32 v161, 0xffff0000, v232
v_lshlrev_b32 v162, 16, v233
v_and_b32 v163, 0xffff0000, v233
v_mfma_f32_16x16x32_bf16 v[132:135], v[116:119], v[96:99], v[132:135]
v_lshlrev_b32 v164, 16, v234
v_and_b32 v165, 0xffff0000, v234
v_lshlrev_b32 v166, 16, v235
v_and_b32 v167, 0xffff0000, v235
v_mfma_f32_16x16x32_bf16 v[128:131], v[208:211], v[192:195], v[128:131]
v_lshlrev_b32 v168, 16, v236
v_and_b32 v169, 0xffff0000, v236
v_lshlrev_b32 v170, 16, v237
v_and_b32 v171, 0xffff0000, v237
v_mfma_f32_16x16x32_bf16 v[132:135], v[212:215], v[192:195], v[132:135]
v_lshlrev_b32 v172, 16, v238
v_and_b32 v173, 0xffff0000, v238
v_lshlrev_b32 v174, 16, v239
v_and_b32 v175, 0xffff0000, v239
v_mfma_f32_16x16x32_bf16 v[136:139], v[112:115], v[100:103], v[136:139]
v_lshlrev_b32 v176, 16, v240
v_and_b32 v177, 0xffff0000, v240
v_lshlrev_b32 v178, 16, v241
v_and_b32 v179, 0xffff0000, v241
v_mfma_f32_16x16x32_bf16 v[140:143], v[116:119], v[100:103], v[140:143]
v_lshlrev_b32 v180, 16, v242
v_and_b32 v181, 0xffff0000, v242
v_lshlrev_b32 v182, 16, v243
v_and_b32 v183, 0xffff0000, v243
v_mfma_f32_16x16x32_bf16 v[136:139], v[208:211], v[196:199], v[136:139]
v_lshlrev_b32 v184, 16, v244
v_and_b32 v185, 0xffff0000, v244
v_lshlrev_b32 v186, 16, v245
v_and_b32 v187, 0xffff0000, v245
v_mfma_f32_16x16x32_bf16 v[140:143], v[212:215], v[196:199], v[140:143]
v_lshlrev_b32 v188, 16, v246
v_and_b32 v189, 0xffff0000, v246
v_lshlrev_b32 v190, 16, v247
v_and_b32 v191, 0xffff0000, v247
v_mfma_f32_16x16x32_bf16 v[144:147], v[112:115], v[104:107], v[144:147]
v_add_f32 v128, v128, v160
v_add_f32 v129, v129, v161
v_add_f32 v130, v130, v162
v_mfma_f32_16x16x32_bf16 v[148:151], v[116:119], v[104:107], v[148:151]
v_add_f32 v131, v131, v163
v_add_f32 v132, v132, v164
v_add_f32 v133, v133, v165
v_mfma_f32_16x16x32_bf16 v[144:147], v[208:211], v[200:203], v[144:147]
v_add_f32 v134, v134, v166
v_add_f32 v135, v135, v167
v_cvt_pk_bf16_f32 v232, v128, v129
v_mfma_f32_16x16x32_bf16 v[148:151], v[212:215], v[200:203], v[148:151]
v_cvt_pk_bf16_f32 v233, v130, v131
v_cvt_pk_bf16_f32 v234, v132, v133
v_cvt_pk_bf16_f32 v235, v134, v135
v_mfma_f32_16x16x32_bf16 v[152:155], v[112:115], v[108:111], v[152:155]
v_add_f32 v136, v136, v168
v_add_f32 v137, v137, v169
v_add_f32 v138, v138, v170
v_mfma_f32_16x16x32_bf16 v[156:159], v[116:119], v[108:111], v[156:159]
v_add_f32 v139, v139, v171
v_add_f32 v140, v140, v172
v_add_f32 v141, v141, v173
s_branch Lov_13
.p2align 12
.fill 96, 4, 0xbf800000
Lst_13_0:
s_branch Lwr_158
Lst_13_1:
s_branch Lst_17_0
s_nop 0
Lov_13:
v_add_f32 v142, v142, v174
v_mfma_f32_16x16x32_bf16 v[152:155], v[208:211], v[204:207], v[152:155]
v_add_f32 v143, v143, v175
v_cvt_pk_bf16_f32 v236, v136, v137
v_cvt_pk_bf16_f32 v237, v138, v139
v_cvt_pk_bf16_f32 v238, v140, v141
v_mfma_f32_16x16x32_bf16 v[156:159], v[212:215], v[204:207], v[156:159]
v_cvt_pk_bf16_f32 v239, v142, v143
v_permlane16_swap_b32 v232, v234
v_permlane16_swap_b32 v233, v235
buffer_store_dwordx4 v[232:235], v230, s[20:23], s54 offen offset:0 nt
v_permlane16_swap_b32 v236, v238
v_permlane16_swap_b32 v237, v239
buffer_store_dwordx4 v[236:239], v230, s[20:23], s54 offen offset:2048 nt
v_add_f32 v144, v144, v176
v_add_f32 v145, v145, v177
v_add_f32 v146, v146, v178
v_add_f32 v147, v147, v179
v_add_f32 v148, v148, v180
v_add_f32 v149, v149, v181
v_add_f32 v150, v150, v182
v_add_f32 v151, v151, v183
v_cvt_pk_bf16_f32 v240, v144, v145
v_cvt_pk_bf16_f32 v241, v146, v147
v_cvt_pk_bf16_f32 v242, v148, v149
v_cvt_pk_bf16_f32 v243, v150, v151
s_nop 0
v_add_f32 v152, v152, v184
v_add_f32 v153, v153, v185
v_add_f32 v154, v154, v186
v_add_f32 v155, v155, v187
v_add_f32 v156, v156, v188
v_add_f32 v157, v157, v189
v_add_f32 v158, v158, v190
v_add_f32 v159, v159, v191
v_cvt_pk_bf16_f32 v244, v152, v153
v_cvt_pk_bf16_f32 v245, v154, v155
v_cvt_pk_bf16_f32 v246, v156, v157
v_cvt_pk_bf16_f32 v247, v158, v159
v_permlane16_swap_b32 v240, v242
v_permlane16_swap_b32 v241, v243
buffer_store_dwordx4 v[240:243], v230, s[20:23], s55 offen offset:0 nt
v_permlane16_swap_b32 v244, v246
v_permlane16_swap_b32 v245, v247
buffer_store_dwordx4 v[244:247], v230, s[20:23], s55 offen offset:2048 nt
s_branch Ldone_1
Lgb_97:
s_mul_i32 s43, s34, 262144
s_add_u32 s8, s82, s43
s_addc_u32 s9, s83, 0
s_add_u32 s8, s8, 4194304
s_addc_u32 s9, s9, 0
s_mov_b32 s10, 262144
s_mov_b32 s11, 0x20000
s_lshl_b32 s39, s36, 12
v_lshlrev_b32 v2, 4, v1
v_add_u32 v3, s39, v2
s_add_u32 s37, s35, 0
s_and_b32 s37, s37, 15
s_mul_i32 s37, s37, 16384
s_add_u32 m0, s39, 0
s_nop 0
buffer_load_dwordx4 v3, s[8:11], s37 offen sc1 lds
buffer_load_dwordx4 v3, s[8:11], s37 offen offset:1024 sc1 lds
buffer_load_dwordx4 v3, s[8:11], s37 offen offset:2048 sc1 lds
buffer_load_dwordx4 v3, s[8:11], s37 offen offset:3072 sc1 lds
s_mul_i32 s43, s34, 262144
s_add_u32 s8, s82, s43
s_addc_u32 s9, s83, 0
s_add_u32 s8, s8, 4194304
s_addc_u32 s9, s9, 0
s_mov_b32 s10, 262144
s_mov_b32 s11, 0x20000
s_mul_i32 s43, s34, 917504
s_add_u32 s24, s82, s43
s_addc_u32 s25, s83, 0
s_add_u32 s24, s24, 8388608
s_addc_u32 s25, s25, 0
s_mov_b32 s26, 917504
s_mov_b32 s27, 0x20000
s_add_u32 s84, s82, 27262976
s_addc_u32 s85, s83, 0
s_mov_b32 s86, 229376
s_mov_b32 s87, 0x20000
s_and_b32 s47, s36, 3
s_lshr_b32 s62, s47, 1
s_and_b32 s63, s47, 1
v_lshlrev_b32 v2, 4, v1
s_lshl_b32 s39, s47, 12
v_add_u32 v3, s39, v2
s_bitcmp0_b32 s36, 1
s_cselect_b32 s44, s72, s74
s_cselect_b32 s45, s73, s75
s_mul_i32 s43, s35, 256
s_add_u32 s12, s44, s43
s_addc_u32 s13, s45, 0
s_mov_b32 s14, 7333120
s_mov_b32 s15, 0x20000
s_and_b32 s43, s36, 1
s_mul_i32 s43, s43, 229376
v_lshrrev_b32 v28, 4, v1
v_lshlrev_b32 v29, 1, v28
v_and_b32 v4, 15, v1
v_xor_b32 v4, v4, v29
v_lshlrev_b32 v4, 4, v4
v_mul_u32_u24 v28, 7168, v28
v_add_u32 v4, v4, v28
v_add_u32 v4, s43, v4
v_xor_b32 v5, 128, v4
v_add_u32 v5, 28672, v5
s_and_b32 s43, s36, 3
s_mul_i32 s40, s43, 8192
s_add_u32 s40, s40, 16384
v_mov_b32 v6, v192
v_mov_b32 v7, v193
v_mov_b32 v8, v194
s_lshl_b32 s43, s62, 12
v_add_u32 v9, s43, v2
v_add_u32 v10, 98304, v9
v_mov_b32 v24, v195
s_mul_i32 s43, s34, 16384
s_add_u32 s20, s82, s43
s_addc_u32 s21, s83, 0
s_add_u32 s20, s20, 25165824
s_addc_u32 s21, s21, 0
s_mov_b32 s22, 16384
s_mov_b32 s23, 0x20000
s_add_u32 s38, s35, 2
s_and_b32 s38, s38, 15
s_mul_i32 s38, s38, 458752
s_add_u32 m0, s50, 98304
s_nop 0
buffer_load_dwordx4 v6, s[16:19], s38 offen lds
s_add_u32 m0, s50, 99328
s_nop 0
buffer_load_dwordx4 v7, s[16:19], s38 offen lds
s_add_u32 m0, s50, 100352
s_nop 0
buffer_load_dwordx4 v8, s[16:19], s38 offen lds
s_add_u32 m0, s50, 101376
s_add_u32 s38, s38, 114688
buffer_load_dwordx4 v6, s[16:19], s38 offen lds
s_add_u32 m0, s50, 102400
s_nop 0
buffer_load_dwordx4 v7, s[16:19], s38 offen lds
s_add_u32 m0, s50, 103424
s_nop 0
buffer_load_dwordx4 v8, s[16:19], s38 offen lds
s_cmp_eq_u32 s47, 1
s_cbranch_scc0 Lw_122
s_lshl_b32 s92, s34, 4
s_add_u32 s92, s92, s35
s_lshl_b32 s92, s92, 8
s_add_u32 s92, s92, 49280
s_add_u32 s92, s92, 28311552
s_mov_b32 s41, 0x40000
Lpoll_123:
s_load_dword s93, s[82:83], s92 glc
Lpchk_125:
s_waitcnt lgkmcnt(0)
s_cmp_eq_u32 s93, 16
s_cbranch_scc1 Lpok_124
s_sub_u32 s41, s41, 1
s_cmp_lg_u32 s41, 0
s_cbranch_scc1 Lpoll_123
Lpok_124:
Lw_122:
s_waitcnt vmcnt(0)
s_barrier
s_add_u32 s37, s35, 1
s_and_b32 s37, s37, 15
s_mul_i32 s37, s37, 16384
s_add_u32 m0, s39, 49152
s_nop 0
buffer_load_dwordx4 v3, s[8:11], s37 offen sc1 lds
buffer_load_dwordx4 v3, s[8:11], s37 offen offset:1024 sc1 lds
buffer_load_dwordx4 v3, s[8:11], s37 offen offset:2048 sc1 lds
buffer_load_dwordx4 v3, s[8:11], s37 offen offset:3072 sc1 lds
s_add_u32 s37, s35, 2
s_and_b32 s37, s37, 15
s_mul_i32 s37, s37, 16384
s_add_u32 m0, s39, 98304
s_nop 0
buffer_load_dwordx4 v3, s[8:11], s37 offen sc1 lds
buffer_load_dwordx4 v3, s[8:11], s37 offen offset:1024 sc1 lds
buffer_load_dwordx4 v3, s[8:11], s37 offen offset:2048 sc1 lds
buffer_load_dwordx4 v3, s[8:11], s37 offen offset:3072 sc1 lds
buffer_load_dwordx4 v[96:99], v3, s[20:23], 0 offen offset:0 sc1
buffer_load_dwordx4 v[100:103], v3, s[20:23], 0 offen offset:1024 sc1
buffer_load_dwordx4 v[104:107], v3, s[20:23], 0 offen offset:2048 sc1
buffer_load_dwordx4 v[108:111], v3, s[20:23], 0 offen offset:3072 sc1
s_and_b32 s44, s36, 3
s_mul_i32 s44, s44, 11
s_bfe_u32 s43, s2, 0x30001
s_lshl_b32 s43, s43, 7
s_add_u32 s44, s44, s43
s_add_u32 s44, s44, 84
s_mul_i32 s44, s44, 7168
s_lshr_b32 s43, s2, 4
s_lshl_b32 s43, s43, 8
s_add_u32 s43, s43, s44
s_bitcmp0_b32 s2, 0
s_cselect_b32 s4, s72, s74
s_cselect_b32 s5, s73, s75
s_add_u32 s4, s4, s43
s_addc_u32 s5, s5, 0
s_waitcnt vmcnt(8)
s_barrier
s_cmp_eq_u32 s47, 3
s_cbranch_scc0 Lw_126
v_and_b32 v90, 31, v1
v_lshlrev_b32 v90, 4, v90
v_add_u32 v91, 151552, v90
ds_read_b128 v[112:115], v91 offset:0
ds_read_b128 v[116:119], v91 offset:512
ds_read_b128 v[120:123], v91 offset:1024
ds_read_b128 v[124:127], v91 offset:1536
s_and_b32 s44, s2, 15
s_mul_i32 s44, s44, 14336
s_lshr_b32 s43, s2, 4
s_lshl_b32 s43, s43, 9
s_add_u32 s44, s44, s43
s_add_u32 s44, s44, 8192
s_cmp_lt_u32 s2, 192
s_cselect_b32 s44, s44, 0x7fffffff
s_waitcnt lgkmcnt(0)
v_add_f32 v112, v112, v116
v_add_f32 v120, v120, v124
v_add_f32 v113, v113, v117
v_add_f32 v121, v121, v125
v_add_f32 v114, v114, v118
v_add_f32 v122, v122, v126
v_add_f32 v115, v115, v119
v_add_f32 v123, v123, v127
v_add_f32 v112, v112, v120
v_add_f32 v113, v113, v121
v_add_f32 v114, v114, v122
v_add_f32 v115, v115, v123
s_mov_b64 exec, 0xffffffff
buffer_store_dwordx4 v[112:115], v90, s[84:87], s44 offen sc1
s_mov_b64 exec, -1
Lw_126:
s_add_u32 s37, s35, 3
s_and_b32 s37, s37, 15
s_mul_i32 s37, s37, 16384
s_add_u32 m0, s39, 0
s_nop 0
buffer_load_dwordx4 v3, s[8:11], s37 offen sc1 lds
s_load_dword s3, s[4:5], 0
buffer_load_dwordx4 v3, s[8:11], s37 offen offset:1024 sc1 lds
s_load_dword s3, s[4:5], 64
buffer_load_dwordx4 v3, s[8:11], s37 offen offset:2048 sc1 lds
s_load_dword s3, s[4:5], 128
buffer_load_dwordx4 v3, s[8:11], s37 offen offset:3072 sc1 lds
s_load_dword s3, s[4:5], 192
s_load_dword s3, s[4:5], 7168
s_add_u32 s38, s35, 3
s_and_b32 s38, s38, 15
s_mul_i32 s38, s38, 458752
s_add_u32 m0, s50, 0
s_nop 0
buffer_load_dwordx4 v6, s[16:19], s38 offen lds
s_load_dword s3, s[4:5], 7232
s_add_u32 m0, s50, 1024
s_nop 0
buffer_load_dwordx4 v7, s[16:19], s38 offen lds
s_load_dword s3, s[4:5], 7296
s_add_u32 m0, s50, 2048
s_nop 0
buffer_load_dwordx4 v8, s[16:19], s38 offen lds
s_load_dword s3, s[4:5], 7360
s_add_u32 m0, s50, 3072
s_add_u32 s38, s38, 114688
buffer_load_dwordx4 v6, s[16:19], s38 offen lds
s_load_dword s3, s[4:5], 14336
s_load_dword s3, s[4:5], 14400
s_add_u32 m0, s50, 4096
s_nop 0
buffer_load_dwordx4 v7, s[16:19], s38 offen lds
s_add_u32 m0, s50, 5120
s_nop 0
buffer_load_dwordx4 v8, s[16:19], s38 offen lds
s_waitcnt vmcnt(14)
s_barrier
s_add_u32 s37, s35, 4
s_and_b32 s37, s37, 15
s_mul_i32 s37, s37, 16384
s_add_u32 m0, s39, 49152
s_nop 0
buffer_load_dwordx4 v3, s[8:11], s37 offen sc1 lds
s_load_dword s3, s[4:5], 14464
buffer_load_dwordx4 v3, s[8:11], s37 offen offset:1024 sc1 lds
s_load_dword s3, s[4:5], 14528
buffer_load_dwordx4 v3, s[8:11], s37 offen offset:2048 sc1 lds
s_load_dword s3, s[4:5], 21504
buffer_load_dwordx4 v3, s[8:11], s37 offen offset:3072 sc1 lds
s_load_dword s3, s[4:5], 21568
s_load_dword s3, s[4:5], 21632
s_add_u32 s38, s35, 4
s_and_b32 s38, s38, 15
s_mul_i32 s38, s38, 458752
s_add_u32 m0, s50, 49152
s_nop 0
buffer_load_dwordx4 v6, s[16:19], s38 offen lds
s_load_dword s3, s[4:5], 21696
s_add_u32 m0, s50, 50176
s_nop 0
buffer_load_dwordx4 v7, s[16:19], s38 offen lds
s_load_dword s3, s[4:5], 28672
s_add_u32 m0, s50, 51200
s_nop 0
buffer_load_dwordx4 v8, s[16:19], s38 offen lds
s_load_dword s3, s[4:5], 28736
s_add_u32 m0, s50, 52224
s_add_u32 s38, s38, 114688
buffer_load_dwordx4 v6, s[16:19], s38 offen lds
s_load_dword s3, s[4:5], 28800
s_load_dword s3, s[4:5], 28864
s_add_u32 m0, s50, 53248
s_nop 0
buffer_load_dwordx4 v7, s[16:19], s38 offen lds
s_add_u32 m0, s50, 54272
s_nop 0
buffer_load_dwordx4 v8, s[16:19], s38 offen lds
s_waitcnt vmcnt(10)
s_barrier
s_cmp_eq_u32 s47, 3
s_cbranch_scc0 Lw_127
s_cmp_lt_u32 s2, 192
s_cbranch_scc0 Lw_127
s_lshr_b32 s43, s2, 4
s_add_u32 s43, s43, 96
s_lshl_b32 s43, s43, 7
v_mov_b32 v90, s43
v_mov_b32 v91, 1
s_mov_b64 exec, 1
buffer_atomic_add v91, v90, s[56:59], 0 offen sc1
s_mov_b64 exec, -1
Lw_127:
s_add_u32 s37, s35, 5
s_and_b32 s37, s37, 15
s_mul_i32 s37, s37, 16384
s_add_u32 m0, s39, 98304
s_nop 0
buffer_load_dwordx4 v3, s[8:11], s37 offen sc1 lds
v_add_f32 v96, v96, v100
v_add_f32 v97, v97, v101
v_add_f32 v98, v98, v102
buffer_load_dwordx4 v3, s[8:11], s37 offen offset:1024 sc1 lds
v_add_f32 v99, v99, v103
v_add_f32 v104, v104, v108
v_add_f32 v105, v105, v109
buffer_load_dwordx4 v3, s[8:11], s37 offen offset:2048 sc1 lds
v_add_f32 v106, v106, v110
v_add_f32 v107, v107, v111
s_nop 0
buffer_load_dwordx4 v3, s[8:11], s37 offen offset:3072 sc1 lds
v_permlane32_swap_b32 v96, v104
v_permlane32_swap_b32 v97, v105
v_permlane32_swap_b32 v98, v106
v_permlane32_swap_b32 v99, v107
s_add_u32 s38, s35, 5
s_and_b32 s38, s38, 15
s_mul_i32 s38, s38, 458752
s_add_u32 m0, s50, 98304
s_nop 0
buffer_load_dwordx4 v6, s[16:19], s38 offen lds
v_add_f32 v96, v96, v104
v_add_f32 v97, v97, v105
v_add_f32 v98, v98, v106
s_add_u32 m0, s50, 99328
s_nop 0
buffer_load_dwordx4 v7, s[16:19], s38 offen lds
v_add_f32 v99, v99, v107
v_mov_b32 v100, v96
v_mov_b32 v101, v97
s_add_u32 m0, s50, 100352
s_nop 0
buffer_load_dwordx4 v8, s[16:19], s38 offen lds
v_mov_b32 v102, v98
v_mov_b32 v103, v99
s_nop 0
s_add_u32 m0, s50, 101376
s_add_u32 s38, s38, 114688
buffer_load_dwordx4 v6, s[16:19], s38 offen lds
v_permlane16_swap_b32 v96, v100
v_permlane16_swap_b32 v97, v101
v_permlane16_swap_b32 v98, v102
v_permlane16_swap_b32 v99, v103
s_add_u32 m0, s50, 102400
s_nop 0
buffer_load_dwordx4 v7, s[16:19], s38 offen lds
s_add_u32 m0, s50, 103424
s_nop 0
buffer_load_dwordx4 v8, s[16:19], s38 offen lds
s_waitcnt vmcnt(10)
s_barrier
s_add_u32 s37, s35, 6
s_and_b32 s37, s37, 15
s_mul_i32 s37, s37, 16384
s_add_u32 m0, s39, 0
s_nop 0
buffer_load_dwordx4 v3, s[8:11], s37 offen sc1 lds
v_add_f32 v96, v96, v100
v_add_f32 v97, v97, v101
v_add_f32 v98, v98, v102
buffer_load_dwordx4 v3, s[8:11], s37 offen offset:1024 sc1 lds
v_add_f32 v99, v99, v103
s_nop 0
v_add_f32_dpp v96, v96, v96 row_ror:8 row_mask:0xf bank_mask:0xf
buffer_load_dwordx4 v3, s[8:11], s37 offen offset:2048 sc1 lds
v_add_f32_dpp v97, v97, v97 row_ror:8 row_mask:0xf bank_mask:0xf
v_add_f32_dpp v98, v98, v98 row_ror:8 row_mask:0xf bank_mask:0xf
v_add_f32_dpp v99, v99, v99 row_ror:8 row_mask:0xf bank_mask:0xf
v_mul_f32 v96, 0x3a800000, v96
buffer_load_dwordx4 v3, s[8:11], s37 offen offset:3072 sc1 lds
v_mul_f32 v97, 0x3a800000, v97
v_mul_f32 v98, 0x3a800000, v98
v_mul_f32 v99, 0x3a800000, v99
s_add_u32 s38, s35, 6
s_and_b32 s38, s38, 15
s_mul_i32 s38, s38, 458752
s_add_u32 m0, s50, 0
s_nop 0
buffer_load_dwordx4 v6, s[16:19], s38 offen lds
v_fma_f32 v97, -v96, v96, v97
v_fma_f32 v99, -v98, v98, v99
v_max_f32 v97, 0, v97
s_add_u32 m0, s50, 1024
s_nop 0
buffer_load_dwordx4 v7, s[16:19], s38 offen lds
v_max_f32 v99, 0, v99
v_add_f32 v97, 0x3727c5ac, v97
v_add_f32 v99, 0x3727c5ac, v99
v_rsq_f32 v97, v97
s_add_u32 m0, s50, 2048
s_nop 0
buffer_load_dwordx4 v8, s[16:19], s38 offen lds
v_rsq_f32 v99, v99
v_and_b32 v100, 7, v1
s_lshl_b32 s43, s47, 8
s_add_u32 m0, s50, 3072
s_add_u32 s38, s38, 114688
buffer_load_dwordx4 v6, s[16:19], s38 offen lds
s_add_u32 s43, s43, 147456
v_lshl_add_u32 v100, v100, 4, s43
v_lshrrev_b32 v101, 5, v1
v_lshl_add_u32 v100, v101, 7, v100
s_add_u32 m0, s50, 4096
s_nop 0
buffer_load_dwordx4 v7, s[16:19], s38 offen lds
s_add_u32 m0, s50, 5120
s_nop 0
buffer_load_dwordx4 v8, s[16:19], s38 offen lds
s_waitcnt vmcnt(10)
s_barrier
ds_write_b128 v100, v[96:99]
s_waitcnt lgkmcnt(0)
s_add_u32 s37, s35, 7
s_and_b32 s37, s37, 15
s_mul_i32 s37, s37, 16384
s_add_u32 m0, s39, 49152
s_nop 0
buffer_load_dwordx4 v3, s[8:11], s37 offen sc1 lds
s_load_dword s3, s[4:5], 35840
buffer_load_dwordx4 v3, s[8:11], s37 offen offset:1024 sc1 lds
s_load_dword s3, s[4:5], 35904
buffer_load_dwordx4 v3, s[8:11], s37 offen offset:2048 sc1 lds
s_load_dword s3, s[4:5], 35968
s_load_dword s3, s[4:5], 36032
buffer_load_dwordx4 v3, s[8:11], s37 offen offset:3072 sc1 lds
s_load_dword s3, s[4:5], 43008
s_add_u32 s38, s35, 7
s_and_b32 s38, s38, 15
s_mul_i32 s38, s38, 458752
s_add_u32 m0, s50, 49152
s_nop 0
buffer_load_dwordx4 v6, s[16:19], s38 offen lds
s_load_dword s3, s[4:5], 43072
s_add_u32 m0, s50, 50176
s_nop 0
buffer_load_dwordx4 v7, s[16:19], s38 offen lds
s_load_dword s3, s[4:5], 43136
s_load_dword s3, s[4:5], 43200
s_add_u32 m0, s50, 51200
s_nop 0
buffer_load_dwordx4 v8, s[16:19], s38 offen lds
s_load_dword s3, s[4:5], 50176
s_add_u32 m0, s50, 52224
s_add_u32 s38, s38, 114688
buffer_load_dwordx4 v6, s[16:19], s38 offen lds
s_load_dword s3, s[4:5], 50240
s_load_dword s3, s[4:5], 50304
s_add_u32 m0, s50, 53248
s_nop 0
buffer_load_dwordx4 v7, s[16:19], s38 offen lds
s_add_u32 m0, s50, 54272
s_nop 0
buffer_load_dwordx4 v8, s[16:19], s38 offen lds
s_waitcnt vmcnt(10)
s_barrier
s_add_u32 s37, s35, 8
s_and_b32 s37, s37, 15
s_mul_i32 s37, s37, 16384
s_add_u32 m0, s39, 98304
s_nop 0
buffer_load_dwordx4 v3, s[8:11], s37 offen sc1 lds
s_load_dword s3, s[4:5], 50368
s_load_dword s3, s[4:5], 57344
s_load_dword s3, s[4:5], 57408
buffer_load_dwordx4 v3, s[8:11], s37 offen offset:1024 sc1 lds
s_load_dword s3, s[4:5], 57472
s_load_dword s3, s[4:5], 57536
s_load_dword s3, s[4:5], 64512
s_load_dword s3, s[4:5], 64576
buffer_load_dwordx4 v3, s[8:11], s37 offen offset:2048 sc1 lds
s_load_dword s3, s[4:5], 64640
s_load_dword s3, s[4:5], 64704
s_load_dword s3, s[4:5], 71680
s_load_dword s3, s[4:5], 71744
buffer_load_dwordx4 v3, s[8:11], s37 offen offset:3072 sc1 lds
v_lshrrev_b32 v28, 2, v1
v_and_b32 v29, 7, v28
v_mul_u32_u24 v28, 256, v28
v_lshl_add_u32 v28, v29, 5, v28
s_add_u32 s38, s35, 8
s_and_b32 s38, s38, 15
s_mul_i32 s38, s38, 458752
s_add_u32 m0, s50, 98304
s_nop 0
buffer_load_dwordx4 v6, s[16:19], s38 offen lds
v_and_b32 v29, 3, v1
v_lshl_add_u32 v11, v29, 3, v28
s_lshl_b32 s43, s63, 7
v_xor_b32 v11, s43, v11
s_add_u32 m0, s50, 99328
s_nop 0
buffer_load_dwordx4 v7, s[16:19], s38 offen lds
v_add_u32 v11, 16384, v11
v_xor_b32 v12, 32, v11
v_xor_b32 v13, 64, v11
v_xor_b32 v14, 96, v11
s_add_u32 m0, s50, 100352
s_nop 0
buffer_load_dwordx4 v8, s[16:19], s38 offen lds
v_add_u32 v15, 49152, v11
v_add_u32 v16, 49152, v12
v_add_u32 v17, 49152, v13
v_add_u32 v18, 49152, v14
s_add_u32 m0, s50, 101376
s_add_u32 s38, s38, 114688
buffer_load_dwordx4 v6, s[16:19], s38 offen lds
v_add_u32 v19, 98304, v11
v_add_u32 v20, 98304, v12
v_add_u32 v21, 98304, v13
v_add_u32 v22, 98304, v14
s_add_u32 m0, s50, 102400
s_nop 0
buffer_load_dwordx4 v7, s[16:19], s38 offen lds
s_add_u32 m0, s50, 103424
s_nop 0
buffer_load_dwordx4 v8, s[16:19], s38 offen lds
s_waitcnt vmcnt(10)
s_barrier
s_cmp_eq_u32 s47, 3
s_cbranch_scc0 Lw_128
s_mul_i32 s60, s35, 96
s_add_u32 s61, s60, 95
s_and_b32 s60, s60, 0xff80
s_and_b32 s61, s61, 0xff80
s_add_u32 s60, s60, 28323840
s_add_u32 s61, s61, 28323840
s_load_dword s92, s[82:83], s60 glc
s_load_dword s93, s[82:83], s61 glc
Lw_128:
s_add_u32 s37, s35, 9
s_and_b32 s37, s37, 15
s_mul_i32 s37, s37, 16384
s_add_u32 m0, s39, 0
s_nop 0
buffer_load_dwordx4 v3, s[8:11], s37 offen sc1 lds
buffer_load_dwordx4 v3, s[8:11], s37 offen offset:1024 sc1 lds
buffer_load_dwordx4 v3, s[8:11], s37 offen offset:2048 sc1 lds
buffer_load_dwordx4 v3, s[8:11], s37 offen offset:3072 sc1 lds
s_add_u32 s38, s35, 9
s_and_b32 s38, s38, 15
s_mul_i32 s38, s38, 458752
s_add_u32 m0, s50, 0
s_nop 0
buffer_load_dwordx4 v6, s[16:19], s38 offen lds
s_add_u32 m0, s50, 1024
s_nop 0
buffer_load_dwordx4 v7, s[16:19], s38 offen lds
s_add_u32 m0, s50, 2048
s_nop 0
buffer_load_dwordx4 v8, s[16:19], s38 offen lds
s_add_u32 m0, s50, 3072
s_add_u32 s38, s38, 114688
buffer_load_dwordx4 v6, s[16:19], s38 offen lds
s_add_u32 m0, s50, 4096
s_nop 0
buffer_load_dwordx4 v7, s[16:19], s38 offen lds
s_add_u32 m0, s50, 5120
s_nop 0
buffer_load_dwordx4 v8, s[16:19], s38 offen lds
s_waitcnt vmcnt(10)
s_barrier
s_add_u32 s37, s35, 10
s_and_b32 s37, s37, 15
s_mul_i32 s37, s37, 16384
s_add_u32 m0, s39, 49152
s_nop 0
buffer_load_dwordx4 v3, s[8:11], s37 offen sc1 lds
s_branch Lov_14
.p2align 12
.fill 112, 4, 0xbf800000
Lst_14_0:
s_branch Lwr_159
Lst_14_1:
s_branch Lst_18_0
s_nop 0
Lov_14:
buffer_load_dwordx4 v3, s[8:11], s37 offen offset:1024 sc1 lds
buffer_load_dwordx4 v3, s[8:11], s37 offen offset:2048 sc1 lds
buffer_load_dwordx4 v3, s[8:11], s37 offen offset:3072 sc1 lds
s_add_u32 s38, s35, 10
s_and_b32 s38, s38, 15
s_mul_i32 s38, s38, 458752
s_add_u32 m0, s50, 49152
s_nop 0
buffer_load_dwordx4 v6, s[16:19], s38 offen lds
s_add_u32 m0, s50, 50176
s_nop 0
buffer_load_dwordx4 v7, s[16:19], s38 offen lds
s_add_u32 m0, s50, 51200
s_nop 0
buffer_load_dwordx4 v8, s[16:19], s38 offen lds
s_add_u32 m0, s50, 52224
s_add_u32 s38, s38, 114688
buffer_load_dwordx4 v6, s[16:19], s38 offen lds
s_add_u32 m0, s50, 53248
s_nop 0
buffer_load_dwordx4 v7, s[16:19], s38 offen lds
s_add_u32 m0, s50, 54272
s_nop 0
buffer_load_dwordx4 v8, s[16:19], s38 offen lds
s_mov_b32 s38, 0
buffer_load_dwordx4 v[40:43], v24, s[88:91], s38 offen
s_mov_b32 s38, 28672
buffer_load_dwordx4 v[44:47], v24, s[88:91], s38 offen
s_mov_b32 s38, 57344
buffer_load_dwordx4 v[48:51], v24, s[88:91], s38 offen
s_mov_b32 s38, 86016
buffer_load_dwordx4 v[52:55], v24, s[88:91], s38 offen
s_mov_b32 s38, 114688
buffer_load_dwordx4 v[56:59], v24, s[88:91], s38 offen
s_mov_b32 s38, 143360
buffer_load_dwordx4 v[60:63], v24, s[88:91], s38 offen
s_mov_b32 s38, 172032
buffer_load_dwordx4 v[64:67], v24, s[88:91], s38 offen
s_mov_b32 s38, 200704
buffer_load_dwordx4 v[68:71], v24, s[88:91], s38 offen
s_waitcnt vmcnt(18)
s_cmp_eq_u32 s47, 3
s_cbranch_scc0 Lw_129
s_mov_b32 s41, 0x40000
Lcp_130:
s_waitcnt lgkmcnt(0)
s_and_b32 s92, s92, s93
s_cmp_eq_u32 s92, 16
s_cbranch_scc1 Lco_131
s_load_dword s92, s[82:83], s60 glc
s_load_dword s93, s[82:83], s61 glc
s_sub_u32 s41, s41, 1
s_cmp_lg_u32 s41, 0
s_cbranch_scc1 Lcp_130
s_waitcnt lgkmcnt(0)
Lco_131:
Lw_129:
s_barrier
s_mov_b32 s45, s47
s_cmp_ge_u32 s45, 3
s_cselect_b32 s43, 1, 0
s_mul_i32 s44, s43, 3
s_sub_u32 s45, s45, s44
s_lshl_b32 s45, s45, 7
s_mul_i32 s52, s43, 896
s_add_u32 s52, s52, s45
s_add_u32 s52, s52, 148992
s_mul_i32 s43, s43, 14336
s_add_u32 s43, s43, s45
s_mul_i32 s44, s35, 384
s_add_u32 s43, s43, s44
s_add_u32 s60, s43, 8192
s_add_u32 s45, s47, 4
s_min_u32 s45, s45, 5
s_cmp_ge_u32 s45, 3
s_cselect_b32 s43, 1, 0
s_mul_i32 s44, s43, 3
s_sub_u32 s45, s45, s44
s_lshl_b32 s45, s45, 7
s_mul_i32 s53, s43, 896
s_add_u32 s53, s53, s45
s_add_u32 s53, s53, 148992
s_mul_i32 s43, s43, 14336
s_add_u32 s43, s43, s45
s_mul_i32 s44, s35, 384
s_add_u32 s43, s43, s44
s_add_u32 s61, s43, 8192
v_lshrrev_b32 v104, 3, v1
v_mul_u32_u24 v104, 28672, v104
v_and_b32 v105, 7, v1
v_lshl_add_u32 v104, v105, 4, v104
buffer_load_dwordx4 v[96:99], v104, s[84:87], s60 offen sc1
s_load_dword s3, s[4:5], 71808
s_load_dword s3, s[4:5], 71872
buffer_load_dwordx4 v[100:103], v104, s[84:87], s61 offen sc1
s_and_b32 s44, s36, 3
s_mul_i32 s43, s2, 28672
s_add_u32 s37, s35, 11
s_and_b32 s37, s37, 15
s_mul_i32 s37, s37, 16384
s_add_u32 m0, s39, 98304
s_nop 0
buffer_load_dwordx4 v3, s[8:11], s37 offen sc1 lds
s_mul_i32 s44, s44, 7168
s_add_u32 s43, s43, s44
buffer_load_dwordx4 v3, s[8:11], s37 offen offset:1024 sc1 lds
s_add_u32 s4, s76, s43
s_addc_u32 s5, s77, 0
s_load_dword s3, s[4:5], 0
buffer_load_dwordx4 v3, s[8:11], s37 offen offset:2048 sc1 lds
s_load_dword s3, s[4:5], 64
s_load_dword s3, s[4:5], 128
buffer_load_dwordx4 v3, s[8:11], s37 offen offset:3072 sc1 lds
s_load_dword s3, s[4:5], 192
s_load_dword s3, s[4:5], 256
s_add_u32 s38, s35, 11
s_and_b32 s38, s38, 15
s_mul_i32 s38, s38, 458752
s_add_u32 m0, s50, 98304
s_nop 0
buffer_load_dwordx4 v6, s[16:19], s38 offen lds
s_load_dword s3, s[4:5], 320
s_load_dword s3, s[4:5], 384
s_load_dword s3, s[4:5], 448
s_add_u32 m0, s50, 99328
s_nop 0
buffer_load_dwordx4 v7, s[16:19], s38 offen lds
v_cmp_gt_u32 vcc, 32, v1
v_mov_b32 v104, s52
s_add_u32 m0, s50, 100352
s_nop 0
buffer_load_dwordx4 v8, s[16:19], s38 offen lds
v_mov_b32 v106, s53
v_cndmask_b32 v104, v106, v104, vcc
s_add_u32 m0, s50, 101376
s_add_u32 s38, s38, 114688
buffer_load_dwordx4 v6, s[16:19], s38 offen lds
v_lshl_add_u32 v104, v105, 4, v104
v_bfe_u32 v105, v1, 4, 1
v_lshl_add_u32 v104, v105, 2, v104
s_add_u32 m0, s50, 102400
s_nop 0
buffer_load_dwordx4 v7, s[16:19], s38 offen lds
s_add_u32 m0, s50, 103424
s_nop 0
buffer_load_dwordx4 v8, s[16:19], s38 offen lds
s_waitcnt vmcnt(20)
s_barrier
s_add_u32 s37, s35, 12
s_and_b32 s37, s37, 15
s_mul_i32 s37, s37, 16384
s_add_u32 m0, s39, 0
s_nop 0
buffer_load_dwordx4 v3, s[8:11], s37 offen sc1 lds
buffer_load_dwordx4 v3, s[8:11], s37 offen offset:1024 sc1 lds
buffer_load_dwordx4 v3, s[8:11], s37 offen offset:2048 sc1 lds
buffer_load_dwordx4 v3, s[8:11], s37 offen offset:3072 sc1 lds
s_add_u32 s38, s35, 12
s_and_b32 s38, s38, 15
s_mul_i32 s38, s38, 458752
s_add_u32 m0, s50, 0
s_nop 0
buffer_load_dwordx4 v6, s[16:19], s38 offen lds
s_add_u32 m0, s50, 1024
s_nop 0
buffer_load_dwordx4 v7, s[16:19], s38 offen lds
s_add_u32 m0, s50, 2048
s_nop 0
buffer_load_dwordx4 v8, s[16:19], s38 offen lds
s_add_u32 m0, s50, 3072
s_add_u32 s38, s38, 114688
buffer_load_dwordx4 v6, s[16:19], s38 offen lds
s_add_u32 m0, s50, 4096
s_nop 0
buffer_load_dwordx4 v7, s[16:19], s38 offen lds
s_add_u32 m0, s50, 5120
s_nop 0
buffer_load_dwordx4 v8, s[16:19], s38 offen lds
s_waitcnt vmcnt(10)
s_barrier
v_permlane32_swap_b32 v96, v100
v_permlane32_swap_b32 v97, v101
v_permlane32_swap_b32 v98, v102
v_permlane32_swap_b32 v99, v103
v_add_f32 v96, v96, v100
v_add_f32 v97, v97, v101
v_add_f32 v98, v98, v102
v_add_f32 v99, v99, v103
s_nop 1
v_permlane16_swap_b32 v96, v97
v_permlane16_swap_b32 v98, v99
v_add_f32 v96, v96, v97
v_add_f32 v98, v98, v99
s_nop 1
v_add_f32_dpp v96, v96, v96 row_ror:8 row_mask:0xf bank_mask:0xf
v_add_f32_dpp v98, v98, v98 row_ror:8 row_mask:0xf bank_mask:0xf
ds_write_b32 v104, v96
ds_write_b32 v104, v98 offset:8
s_waitcnt lgkmcnt(0)
s_add_u32 s37, s35, 13
s_and_b32 s37, s37, 15
s_mul_i32 s37, s37, 16384
s_add_u32 m0, s39, 49152
s_nop 0
buffer_load_dwordx4 v3, s[8:11], s37 offen sc1 lds
s_load_dword s3, s[4:5], 512
s_load_dword s3, s[4:5], 576
s_load_dword s3, s[4:5], 640
s_load_dword s3, s[4:5], 704
s_load_dword s3, s[4:5], 768
buffer_load_dwordx4 v3, s[8:11], s37 offen offset:1024 sc1 lds
s_load_dword s3, s[4:5], 832
s_load_dword s3, s[4:5], 896
s_load_dword s3, s[4:5], 960
s_load_dword s3, s[4:5], 1024
s_load_dword s3, s[4:5], 1088
buffer_load_dwordx4 v3, s[8:11], s37 offen offset:2048 sc1 lds
v_lshlrev_b32 v72, 16, v40
v_and_b32 v73, 0xffff0000, v40
v_lshlrev_b32 v74, 16, v41
v_and_b32 v75, 0xffff0000, v41
v_lshlrev_b32 v76, 16, v42
v_and_b32 v77, 0xffff0000, v42
buffer_load_dwordx4 v3, s[8:11], s37 offen offset:3072 sc1 lds
v_lshlrev_b32 v78, 16, v43
v_and_b32 v79, 0xffff0000, v43
v_lshlrev_b32 v80, 16, v44
v_and_b32 v81, 0xffff0000, v44
v_lshlrev_b32 v82, 16, v45
s_add_u32 s38, s35, 13
s_and_b32 s38, s38, 15
s_mul_i32 s38, s38, 458752
s_add_u32 m0, s50, 49152
s_nop 0
buffer_load_dwordx4 v6, s[16:19], s38 offen lds
v_and_b32 v83, 0xffff0000, v45
v_lshlrev_b32 v84, 16, v46
v_and_b32 v85, 0xffff0000, v46
v_lshlrev_b32 v86, 16, v47
v_and_b32 v87, 0xffff0000, v47
s_add_u32 m0, s50, 50176
s_nop 0
buffer_load_dwordx4 v7, s[16:19], s38 offen lds
v_add_f32 v72, v72, v80
v_add_f32 v73, v73, v81
v_add_f32 v74, v74, v82
v_add_f32 v75, v75, v83
v_add_f32 v76, v76, v84
v_add_f32 v77, v77, v85
s_add_u32 m0, s50, 51200
s_nop 0
buffer_load_dwordx4 v8, s[16:19], s38 offen lds
v_add_f32 v78, v78, v86
v_add_f32 v79, v79, v87
v_lshlrev_b32 v80, 16, v48
v_and_b32 v81, 0xffff0000, v48
v_lshlrev_b32 v82, 16, v49
s_add_u32 m0, s50, 52224
s_add_u32 s38, s38, 114688
buffer_load_dwordx4 v6, s[16:19], s38 offen lds
v_and_b32 v83, 0xffff0000, v49
v_lshlrev_b32 v84, 16, v50
v_and_b32 v85, 0xffff0000, v50
v_lshlrev_b32 v86, 16, v51
v_and_b32 v87, 0xffff0000, v51
v_add_f32 v72, v72, v80
s_add_u32 m0, s50, 53248
s_nop 0
buffer_load_dwordx4 v7, s[16:19], s38 offen lds
s_add_u32 m0, s50, 54272
s_nop 0
buffer_load_dwordx4 v8, s[16:19], s38 offen lds
s_waitcnt vmcnt(10)
s_barrier
s_add_u32 s37, s35, 14
s_and_b32 s37, s37, 15
s_mul_i32 s37, s37, 16384
s_add_u32 m0, s39, 98304
s_nop 0
buffer_load_dwordx4 v3, s[8:11], s37 offen sc1 lds
s_load_dword s3, s[4:5], 1152
s_load_dword s3, s[4:5], 1216
s_load_dword s3, s[4:5], 1280
s_load_dword s3, s[4:5], 1344
s_load_dword s3, s[4:5], 1408
buffer_load_dwordx4 v3, s[8:11], s37 offen offset:1024 sc1 lds
s_load_dword s3, s[4:5], 1472
s_load_dword s3, s[4:5], 1536
s_load_dword s3, s[4:5], 1600
s_load_dword s3, s[4:5], 1664
s_load_dword s3, s[4:5], 1728
v_add_f32 v73, v73, v81
buffer_load_dwordx4 v3, s[8:11], s37 offen offset:2048 sc1 lds
v_add_f32 v74, v74, v82
v_add_f32 v75, v75, v83
v_add_f32 v76, v76, v84
v_add_f32 v77, v77, v85
v_add_f32 v78, v78, v86
buffer_load_dwordx4 v3, s[8:11], s37 offen offset:3072 sc1 lds
v_add_f32 v79, v79, v87
v_lshlrev_b32 v80, 16, v52
v_and_b32 v81, 0xffff0000, v52
v_lshlrev_b32 v82, 16, v53
v_and_b32 v83, 0xffff0000, v53
v_lshlrev_b32 v84, 16, v54
s_add_u32 s38, s35, 14
s_and_b32 s38, s38, 15
s_mul_i32 s38, s38, 458752
s_add_u32 m0, s50, 98304
s_nop 0
buffer_load_dwordx4 v6, s[16:19], s38 offen lds
v_and_b32 v85, 0xffff0000, v54
v_lshlrev_b32 v86, 16, v55
v_and_b32 v87, 0xffff0000, v55
v_add_f32 v72, v72, v80
v_add_f32 v73, v73, v81
s_add_u32 m0, s50, 99328
s_nop 0
buffer_load_dwordx4 v7, s[16:19], s38 offen lds
v_add_f32 v74, v74, v82
v_add_f32 v75, v75, v83
v_add_f32 v76, v76, v84
v_add_f32 v77, v77, v85
v_add_f32 v78, v78, v86
v_add_f32 v79, v79, v87
s_add_u32 m0, s50, 100352
s_nop 0
buffer_load_dwordx4 v8, s[16:19], s38 offen lds
v_lshlrev_b32 v80, 16, v56
v_and_b32 v81, 0xffff0000, v56
v_lshlrev_b32 v82, 16, v57
v_and_b32 v83, 0xffff0000, v57
v_lshlrev_b32 v84, 16, v58
s_add_u32 m0, s50, 101376
s_add_u32 s38, s38, 114688
buffer_load_dwordx4 v6, s[16:19], s38 offen lds
v_and_b32 v85, 0xffff0000, v58
v_lshlrev_b32 v86, 16, v59
v_and_b32 v87, 0xffff0000, v59
v_add_f32 v72, v72, v80
v_add_f32 v73, v73, v81
v_add_f32 v74, v74, v82
s_add_u32 m0, s50, 102400
s_nop 0
buffer_load_dwordx4 v7, s[16:19], s38 offen lds
s_add_u32 m0, s50, 103424
s_nop 0
buffer_load_dwordx4 v8, s[16:19], s38 offen lds
s_waitcnt vmcnt(10)
s_barrier
s_add_u32 s37, s35, 15
s_and_b32 s37, s37, 15
s_mul_i32 s37, s37, 16384
s_add_u32 m0, s39, 0
s_nop 0
buffer_load_dwordx4 v3, s[8:11], s37 offen sc1 lds
v_add_f32 v75, v75, v83
v_add_f32 v76, v76, v84
v_add_f32 v77, v77, v85
v_add_f32 v78, v78, v86
buffer_load_dwordx4 v3, s[8:11], s37 offen offset:1024 sc1 lds
v_add_f32 v79, v79, v87
v_lshlrev_b32 v80, 16, v60
v_and_b32 v81, 0xffff0000, v60
v_lshlrev_b32 v82, 16, v61
buffer_load_dwordx4 v3, s[8:11], s37 offen offset:2048 sc1 lds
v_and_b32 v83, 0xffff0000, v61
v_lshlrev_b32 v84, 16, v62
v_and_b32 v85, 0xffff0000, v62
v_lshlrev_b32 v86, 16, v63
buffer_load_dwordx4 v3, s[8:11], s37 offen offset:3072 sc1 lds
v_and_b32 v87, 0xffff0000, v63
v_add_f32 v72, v72, v80
v_add_f32 v73, v73, v81
v_add_f32 v74, v74, v82
s_add_u32 s38, s35, 15
s_and_b32 s38, s38, 15
s_mul_i32 s38, s38, 458752
s_add_u32 m0, s50, 0
s_nop 0
buffer_load_dwordx4 v6, s[16:19], s38 offen lds
v_add_f32 v75, v75, v83
v_add_f32 v76, v76, v84
v_add_f32 v77, v77, v85
v_add_f32 v78, v78, v86
s_add_u32 m0, s50, 1024
s_nop 0
buffer_load_dwordx4 v7, s[16:19], s38 offen lds
v_add_f32 v79, v79, v87
v_lshlrev_b32 v80, 16, v64
v_and_b32 v81, 0xffff0000, v64
v_lshlrev_b32 v82, 16, v65
s_add_u32 m0, s50, 2048
s_nop 0
buffer_load_dwordx4 v8, s[16:19], s38 offen lds
v_and_b32 v83, 0xffff0000, v65
v_lshlrev_b32 v84, 16, v66
v_and_b32 v85, 0xffff0000, v66
v_lshlrev_b32 v86, 16, v67
s_add_u32 m0, s50, 3072
s_add_u32 s38, s38, 114688
buffer_load_dwordx4 v6, s[16:19], s38 offen lds
v_and_b32 v87, 0xffff0000, v67
v_add_f32 v72, v72, v80
v_add_f32 v73, v73, v81
v_add_f32 v74, v74, v82
v_add_f32 v75, v75, v83
s_add_u32 m0, s50, 4096
s_nop 0
buffer_load_dwordx4 v7, s[16:19], s38 offen lds
s_add_u32 m0, s50, 5120
s_nop 0
buffer_load_dwordx4 v8, s[16:19], s38 offen lds
s_waitcnt vmcnt(10)
s_barrier
s_add_u32 s38, s35, 13
s_and_b32 s38, s38, 15
s_mul_i32 s38, s38, 458752
s_add_u32 m0, s40, 49152
s_nop 0
buffer_load_dwordx4 v4, s[12:15], s38 offen lds
v_add_f32 v76, v76, v84
v_add_f32 v77, v77, v85
v_add_f32 v78, v78, v86
v_add_f32 v79, v79, v87
v_lshlrev_b32 v80, 16, v68
s_add_u32 m0, s40, 50176
s_nop 0
buffer_load_dwordx4 v5, s[12:15], s38 offen lds
v_and_b32 v81, 0xffff0000, v68
v_lshlrev_b32 v82, 16, v69
v_and_b32 v83, 0xffff0000, v69
v_lshlrev_b32 v84, 16, v70
v_and_b32 v85, 0xffff0000, v70
v_lshlrev_b32 v86, 16, v71
s_add_u32 m0, s40, 51200
s_add_u32 s38, s38, 57344
buffer_load_dwordx4 v4, s[12:15], s38 offen lds
v_and_b32 v87, 0xffff0000, v71
v_add_f32 v72, v72, v80
v_add_f32 v73, v73, v81
v_add_f32 v74, v74, v82
v_add_f32 v75, v75, v83
v_add_f32 v76, v76, v84
s_add_u32 m0, s40, 52224
s_nop 0
buffer_load_dwordx4 v5, s[12:15], s38 offen lds
v_add_f32 v77, v77, v85
v_add_f32 v78, v78, v86
v_add_f32 v79, v79, v87
s_nop 0
v_permlane32_swap_b32 v72, v76
s_add_u32 m0, s40, 53248
s_add_u32 s38, s38, 57344
buffer_load_dwordx4 v4, s[12:15], s38 offen lds
v_permlane32_swap_b32 v73, v77
v_permlane32_swap_b32 v74, v78
v_permlane32_swap_b32 v75, v79
v_add_f32 v72, v72, v76
v_add_f32 v73, v73, v77
v_add_f32 v74, v74, v78
s_add_u32 m0, s40, 54272
s_nop 0
buffer_load_dwordx4 v5, s[12:15], s38 offen lds
v_add_f32 v75, v75, v79
s_nop 0
v_permlane16_swap_b32 v72, v74
v_permlane16_swap_b32 v73, v75
v_add_f32 v72, v72, v74
v_add_f32 v73, v73, v75
s_add_u32 m0, s40, 55296
s_add_u32 s38, s38, 57344
buffer_load_dwordx4 v4, s[12:15], s38 offen lds
s_add_u32 m0, s40, 56320
s_nop 0
buffer_load_dwordx4 v5, s[12:15], s38 offen lds
s_waitcnt vmcnt(8)
s_barrier
s_lshl_b32 s43, s47, 9
s_add_u32 s43, s43, 153600
v_and_b32 v80, 15, v1
v_lshl_add_u32 v80, v80, 5, s43
v_lshrrev_b32 v81, 4, v1
v_lshl_add_u32 v80, v81, 3, v80
ds_write_b64 v80, v[72:73]
s_waitcnt lgkmcnt(0)
s_add_u32 s38, s35, 14
s_and_b32 s38, s38, 15
s_mul_i32 s38, s38, 458752
s_add_u32 m0, s40, 98304
s_nop 0
buffer_load_dwordx4 v4, s[12:15], s38 offen lds
s_bfe_u32 s61, s35, 0x10002
s_lshr_b32 s60, s35, 3
s_lshl_b32 s60, s60, 2
s_and_b32 s43, s35, 3
s_add_u32 s60, s60, s43
s_add_u32 m0, s40, 99328
s_nop 0
buffer_load_dwordx4 v5, s[12:15], s38 offen lds
s_lshl_b32 s43, s60, 8
s_add_u32 s28, s76, s43
s_addc_u32 s29, s77, 0
s_mov_b32 s30, 7338240
s_mov_b32 s31, 0x20000
s_add_u32 m0, s40, 100352
s_add_u32 s38, s38, 57344
buffer_load_dwordx4 v4, s[12:15], s38 offen lds
s_mul_i32 s52, s61, 196608
s_mul_i32 s53, s61, 1572864
s_mul_i32 s90, s61, 163840
s_mul_i32 s91, s61, 1310720
s_and_b32 s43, s35, 3
s_add_u32 m0, s40, 101376
s_nop 0
buffer_load_dwordx4 v5, s[12:15], s38 offen lds
s_mul_i32 s32, s43, 3
s_mul_i32 s33, s43, 10
s_lshr_b32 s33, s33, 2
s_lshl_b32 s51, s47, 11
s_lshl_b32 s44, s47, 15
s_add_u32 m0, s40, 102400
s_add_u32 s38, s38, 57344
buffer_load_dwordx4 v4, s[12:15], s38 offen lds
v_lshrrev_b32 v122, 4, v1
v_lshlrev_b32 v123, 1, v122
v_and_b32 v23, 15, v1
v_xor_b32 v23, v23, v123
v_lshlrev_b32 v23, 4, v23
s_add_u32 m0, s40, 103424
s_nop 0
buffer_load_dwordx4 v5, s[12:15], s38 offen lds
v_mul_u32_u24 v122, 2048, v122
v_add_u32 v23, v23, v122
v_add_u32 v23, s44, v23
v_xor_b32 v24, 128, v23
v_add_u32 v24, 8192, v24
s_add_u32 m0, s40, 104448
s_add_u32 s38, s38, 57344
buffer_load_dwordx4 v4, s[12:15], s38 offen lds
s_add_u32 m0, s40, 105472
s_nop 0
buffer_load_dwordx4 v5, s[12:15], s38 offen lds
s_waitcnt vmcnt(8)
s_barrier
ds_read_b128 v[28:31], v9 offset:49152
ds_read_b64_tr_b16 v[44:45], v15 offset:0
ds_read_b64_tr_b16 v[46:47], v15 offset:4096
ds_read_b64_tr_b16 v[48:49], v16 offset:0
ds_read_b64_tr_b16 v[50:51], v16 offset:4096
ds_read_b64_tr_b16 v[52:53], v17 offset:0
ds_read_b64_tr_b16 v[54:55], v17 offset:4096
ds_read_b64_tr_b16 v[56:57], v18 offset:0
ds_read_b64_tr_b16 v[58:59], v18 offset:4096
ds_read_b64_tr_b16 v[60:61], v15 offset:16384
ds_read_b64_tr_b16 v[62:63], v15 offset:20480
ds_read_b64_tr_b16 v[64:65], v16 offset:16384
ds_read_b64_tr_b16 v[66:67], v16 offset:20480
ds_read_b64_tr_b16 v[68:69], v17 offset:16384
ds_read_b64_tr_b16 v[70:71], v17 offset:20480
ds_read_b64_tr_b16 v[72:73], v18 offset:16384
ds_read_b64_tr_b16 v[74:75], v18 offset:20480
ds_read_b128 v[32:35], v9 offset:50176
ds_read_b128 v[36:39], v9 offset:51200
ds_read_b128 v[40:43], v9 offset:52224
s_waitcnt lgkmcnt(0)
v_mfma_f32_16x16x32_bf16 v[124:127], v[44:47], v[28:31], 0
ds_read_b128 v[76:79], v9 offset:57344
v_mfma_f32_16x16x32_bf16 v[156:159], v[44:47], v[32:35], 0
ds_read_b64_tr_b16 v[92:93], v15 offset:8192
v_mfma_f32_16x16x32_bf16 v[188:191], v[44:47], v[36:39], 0
ds_read_b64_tr_b16 v[94:95], v15 offset:12288
v_mfma_f32_16x16x32_bf16 v[220:223], v[44:47], v[40:43], 0
ds_read_b64_tr_b16 v[96:97], v16 offset:8192
v_mfma_f32_16x16x32_bf16 v[224:227], v[48:51], v[40:43], 0
ds_read_b64_tr_b16 v[98:99], v16 offset:12288
v_mfma_f32_16x16x32_bf16 v[192:195], v[48:51], v[36:39], 0
ds_read_b64_tr_b16 v[100:101], v17 offset:8192
v_mfma_f32_16x16x32_bf16 v[160:163], v[48:51], v[32:35], 0
ds_read_b64_tr_b16 v[102:103], v17 offset:12288
v_mfma_f32_16x16x32_bf16 v[128:131], v[48:51], v[28:31], 0
ds_read_b64_tr_b16 v[104:105], v18 offset:8192
v_mfma_f32_16x16x32_bf16 v[132:135], v[52:55], v[28:31], 0
ds_read_b64_tr_b16 v[106:107], v18 offset:12288
v_mfma_f32_16x16x32_bf16 v[164:167], v[52:55], v[32:35], 0
ds_read_b64_tr_b16 v[108:109], v15 offset:24576
v_mfma_f32_16x16x32_bf16 v[196:199], v[52:55], v[36:39], 0
ds_read_b64_tr_b16 v[110:111], v15 offset:28672
v_mfma_f32_16x16x32_bf16 v[228:231], v[52:55], v[40:43], 0
ds_read_b64_tr_b16 v[112:113], v16 offset:24576
v_mfma_f32_16x16x32_bf16 v[232:235], v[56:59], v[40:43], 0
ds_read_b64_tr_b16 v[114:115], v16 offset:28672
v_mfma_f32_16x16x32_bf16 v[200:203], v[56:59], v[36:39], 0
s_branch Lov_15
.p2align 12
.fill 112, 4, 0xbf800000
Lst_15_0:
s_branch Lwr_168
s_nop 0
s_nop 0
Lov_15:
ds_read_b64_tr_b16 v[116:117], v17 offset:24576
v_mfma_f32_16x16x32_bf16 v[168:171], v[56:59], v[32:35], 0
ds_read_b64_tr_b16 v[118:119], v17 offset:28672
v_mfma_f32_16x16x32_bf16 v[136:139], v[56:59], v[28:31], 0
ds_read_b64_tr_b16 v[120:121], v18 offset:24576
v_mfma_f32_16x16x32_bf16 v[140:143], v[60:63], v[28:31], 0
ds_read_b64_tr_b16 v[122:123], v18 offset:28672
v_mfma_f32_16x16x32_bf16 v[172:175], v[60:63], v[32:35], 0
ds_read_b128 v[80:83], v9 offset:58368
v_mfma_f32_16x16x32_bf16 v[204:207], v[60:63], v[36:39], 0
ds_read_b128 v[84:87], v9 offset:59392
v_mfma_f32_16x16x32_bf16 v[236:239], v[60:63], v[40:43], 0
ds_read_b128 v[88:91], v9 offset:60416
v_mfma_f32_16x16x32_bf16 v[240:243], v[64:67], v[40:43], 0
v_mfma_f32_16x16x32_bf16 v[208:211], v[64:67], v[36:39], 0
v_mfma_f32_16x16x32_bf16 v[176:179], v[64:67], v[32:35], 0
v_mfma_f32_16x16x32_bf16 v[144:147], v[64:67], v[28:31], 0
v_mfma_f32_16x16x32_bf16 v[148:151], v[68:71], v[28:31], 0
v_mfma_f32_16x16x32_bf16 v[180:183], v[68:71], v[32:35], 0
v_mfma_f32_16x16x32_bf16 v[212:215], v[68:71], v[36:39], 0
v_mfma_f32_16x16x32_bf16 v[244:247], v[68:71], v[40:43], 0
v_mfma_f32_16x16x32_bf16 v[248:251], v[72:75], v[40:43], 0
v_mfma_f32_16x16x32_bf16 v[216:219], v[72:75], v[36:39], 0
v_mfma_f32_16x16x32_bf16 v[184:187], v[72:75], v[32:35], 0
v_mfma_f32_16x16x32_bf16 v[152:155], v[72:75], v[28:31], 0
s_waitcnt vmcnt(0)
s_waitcnt lgkmcnt(0)
s_barrier
v_mfma_f32_16x16x32_bf16 v[124:127], v[92:95], v[76:79], v[124:127]
ds_read_b128 v[28:31], v10 offset:0
v_mfma_f32_16x16x32_bf16 v[156:159], v[92:95], v[80:83], v[156:159]
ds_read_b64_tr_b16 v[44:45], v19 offset:0
v_mfma_f32_16x16x32_bf16 v[188:191], v[92:95], v[84:87], v[188:191]
ds_read_b64_tr_b16 v[46:47], v19 offset:4096
v_mfma_f32_16x16x32_bf16 v[220:223], v[92:95], v[88:91], v[220:223]
ds_read_b64_tr_b16 v[48:49], v20 offset:0
v_mfma_f32_16x16x32_bf16 v[224:227], v[96:99], v[88:91], v[224:227]
ds_read_b64_tr_b16 v[50:51], v20 offset:4096
v_mfma_f32_16x16x32_bf16 v[192:195], v[96:99], v[84:87], v[192:195]
ds_read_b64_tr_b16 v[52:53], v21 offset:0
v_mfma_f32_16x16x32_bf16 v[160:163], v[96:99], v[80:83], v[160:163]
ds_read_b64_tr_b16 v[54:55], v21 offset:4096
v_mfma_f32_16x16x32_bf16 v[128:131], v[96:99], v[76:79], v[128:131]
ds_read_b64_tr_b16 v[56:57], v22 offset:0
v_mfma_f32_16x16x32_bf16 v[132:135], v[100:103], v[76:79], v[132:135]
ds_read_b64_tr_b16 v[58:59], v22 offset:4096
v_mfma_f32_16x16x32_bf16 v[164:167], v[100:103], v[80:83], v[164:167]
ds_read_b64_tr_b16 v[60:61], v19 offset:16384
v_mfma_f32_16x16x32_bf16 v[196:199], v[100:103], v[84:87], v[196:199]
ds_read_b64_tr_b16 v[62:63], v19 offset:20480
v_mfma_f32_16x16x32_bf16 v[228:231], v[100:103], v[88:91], v[228:231]
ds_read_b64_tr_b16 v[64:65], v20 offset:16384
v_mfma_f32_16x16x32_bf16 v[232:235], v[104:107], v[88:91], v[232:235]
ds_read_b64_tr_b16 v[66:67], v20 offset:20480
v_mfma_f32_16x16x32_bf16 v[200:203], v[104:107], v[84:87], v[200:203]
ds_read_b64_tr_b16 v[68:69], v21 offset:16384
v_mfma_f32_16x16x32_bf16 v[168:171], v[104:107], v[80:83], v[168:171]
ds_read_b64_tr_b16 v[70:71], v21 offset:20480
v_mfma_f32_16x16x32_bf16 v[136:139], v[104:107], v[76:79], v[136:139]
ds_read_b64_tr_b16 v[72:73], v22 offset:16384
v_mfma_f32_16x16x32_bf16 v[140:143], v[108:111], v[76:79], v[140:143]
ds_read_b64_tr_b16 v[74:75], v22 offset:20480
v_mfma_f32_16x16x32_bf16 v[172:175], v[108:111], v[80:83], v[172:175]
ds_read_b128 v[32:35], v10 offset:1024
v_mfma_f32_16x16x32_bf16 v[204:207], v[108:111], v[84:87], v[204:207]
ds_read_b128 v[36:39], v10 offset:2048
v_mfma_f32_16x16x32_bf16 v[236:239], v[108:111], v[88:91], v[236:239]
ds_read_b128 v[40:43], v10 offset:3072
v_mfma_f32_16x16x32_bf16 v[240:243], v[112:115], v[88:91], v[240:243]
v_mfma_f32_16x16x32_bf16 v[208:211], v[112:115], v[84:87], v[208:211]
v_mfma_f32_16x16x32_bf16 v[176:179], v[112:115], v[80:83], v[176:179]
v_mfma_f32_16x16x32_bf16 v[144:147], v[112:115], v[76:79], v[144:147]
v_mfma_f32_16x16x32_bf16 v[148:151], v[116:119], v[76:79], v[148:151]
v_mfma_f32_16x16x32_bf16 v[180:183], v[116:119], v[80:83], v[180:183]
v_mfma_f32_16x16x32_bf16 v[212:215], v[116:119], v[84:87], v[212:215]
v_mfma_f32_16x16x32_bf16 v[244:247], v[116:119], v[88:91], v[244:247]
v_mfma_f32_16x16x32_bf16 v[248:251], v[120:123], v[88:91], v[248:251]
v_mfma_f32_16x16x32_bf16 v[216:219], v[120:123], v[84:87], v[216:219]
v_mfma_f32_16x16x32_bf16 v[184:187], v[120:123], v[80:83], v[184:187]
v_mfma_f32_16x16x32_bf16 v[152:155], v[120:123], v[76:79], v[152:155]
s_mov_b32 s41, 5
Lk3l_132:
s_waitcnt lgkmcnt(0)
v_mfma_f32_16x16x32_bf16 v[124:127], v[44:47], v[28:31], v[124:127]
ds_read_b128 v[76:79], v10 offset:8192
v_mfma_f32_16x16x32_bf16 v[156:159], v[44:47], v[32:35], v[156:159]
ds_read_b64_tr_b16 v[92:93], v19 offset:8192
v_mfma_f32_16x16x32_bf16 v[188:191], v[44:47], v[36:39], v[188:191]
ds_read_b64_tr_b16 v[94:95], v19 offset:12288
v_mfma_f32_16x16x32_bf16 v[220:223], v[44:47], v[40:43], v[220:223]
ds_read_b64_tr_b16 v[96:97], v20 offset:8192
v_mfma_f32_16x16x32_bf16 v[224:227], v[48:51], v[40:43], v[224:227]
ds_read_b64_tr_b16 v[98:99], v20 offset:12288
v_mfma_f32_16x16x32_bf16 v[192:195], v[48:51], v[36:39], v[192:195]
ds_read_b64_tr_b16 v[100:101], v21 offset:8192
v_mfma_f32_16x16x32_bf16 v[160:163], v[48:51], v[32:35], v[160:163]
ds_read_b64_tr_b16 v[102:103], v21 offset:12288
v_mfma_f32_16x16x32_bf16 v[128:131], v[48:51], v[28:31], v[128:131]
ds_read_b64_tr_b16 v[104:105], v22 offset:8192
v_mfma_f32_16x16x32_bf16 v[132:135], v[52:55], v[28:31], v[132:135]
ds_read_b64_tr_b16 v[106:107], v22 offset:12288
v_mfma_f32_16x16x32_bf16 v[164:167], v[52:55], v[32:35], v[164:167]
ds_read_b64_tr_b16 v[108:109], v19 offset:24576
v_mfma_f32_16x16x32_bf16 v[196:199], v[52:55], v[36:39], v[196:199]
ds_read_b64_tr_b16 v[110:111], v19 offset:28672
v_mfma_f32_16x16x32_bf16 v[228:231], v[52:55], v[40:43], v[228:231]
ds_read_b64_tr_b16 v[112:113], v20 offset:24576
v_mfma_f32_16x16x32_bf16 v[232:235], v[56:59], v[40:43], v[232:235]
ds_read_b64_tr_b16 v[114:115], v20 offset:28672
v_mfma_f32_16x16x32_bf16 v[200:203], v[56:59], v[36:39], v[200:203]
ds_read_b64_tr_b16 v[116:117], v21 offset:24576
v_mfma_f32_16x16x32_bf16 v[168:171], v[56:59], v[32:35], v[168:171]
ds_read_b64_tr_b16 v[118:119], v21 offset:28672
v_mfma_f32_16x16x32_bf16 v[136:139], v[56:59], v[28:31], v[136:139]
ds_read_b64_tr_b16 v[120:121], v22 offset:24576
v_mfma_f32_16x16x32_bf16 v[140:143], v[60:63], v[28:31], v[140:143]
ds_read_b64_tr_b16 v[122:123], v22 offset:28672
v_mfma_f32_16x16x32_bf16 v[172:175], v[60:63], v[32:35], v[172:175]
ds_read_b128 v[80:83], v10 offset:9216
v_mfma_f32_16x16x32_bf16 v[204:207], v[60:63], v[36:39], v[204:207]
ds_read_b128 v[84:87], v10 offset:10240
v_mfma_f32_16x16x32_bf16 v[236:239], v[60:63], v[40:43], v[236:239]
ds_read_b128 v[88:91], v10 offset:11264
v_mfma_f32_16x16x32_bf16 v[240:243], v[64:67], v[40:43], v[240:243]
v_mfma_f32_16x16x32_bf16 v[208:211], v[64:67], v[36:39], v[208:211]
v_mfma_f32_16x16x32_bf16 v[176:179], v[64:67], v[32:35], v[176:179]
v_mfma_f32_16x16x32_bf16 v[144:147], v[64:67], v[28:31], v[144:147]
v_mfma_f32_16x16x32_bf16 v[148:151], v[68:71], v[28:31], v[148:151]
v_mfma_f32_16x16x32_bf16 v[180:183], v[68:71], v[32:35], v[180:183]
v_mfma_f32_16x16x32_bf16 v[212:215], v[68:71], v[36:39], v[212:215]
v_mfma_f32_16x16x32_bf16 v[244:247], v[68:71], v[40:43], v[244:247]
v_mfma_f32_16x16x32_bf16 v[248:251], v[72:75], v[40:43], v[248:251]
v_mfma_f32_16x16x32_bf16 v[216:219], v[72:75], v[36:39], v[216:219]
v_mfma_f32_16x16x32_bf16 v[184:187], v[72:75], v[32:35], v[184:187]
v_mfma_f32_16x16x32_bf16 v[152:155], v[72:75], v[28:31], v[152:155]
s_waitcnt lgkmcnt(0)
s_barrier
v_mfma_f32_16x16x32_bf16 v[124:127], v[92:95], v[76:79], v[124:127]
ds_read_b128 v[28:31], v9 offset:0
v_mfma_f32_16x16x32_bf16 v[156:159], v[92:95], v[80:83], v[156:159]
ds_read_b64_tr_b16 v[44:45], v11 offset:0
v_mfma_f32_16x16x32_bf16 v[188:191], v[92:95], v[84:87], v[188:191]
ds_read_b64_tr_b16 v[46:47], v11 offset:4096
v_mfma_f32_16x16x32_bf16 v[220:223], v[92:95], v[88:91], v[220:223]
ds_read_b64_tr_b16 v[48:49], v12 offset:0
v_mfma_f32_16x16x32_bf16 v[224:227], v[96:99], v[88:91], v[224:227]
ds_read_b64_tr_b16 v[50:51], v12 offset:4096
v_mfma_f32_16x16x32_bf16 v[192:195], v[96:99], v[84:87], v[192:195]
ds_read_b64_tr_b16 v[52:53], v13 offset:0
v_mfma_f32_16x16x32_bf16 v[160:163], v[96:99], v[80:83], v[160:163]
ds_read_b64_tr_b16 v[54:55], v13 offset:4096
v_mfma_f32_16x16x32_bf16 v[128:131], v[96:99], v[76:79], v[128:131]
ds_read_b64_tr_b16 v[56:57], v14 offset:0
v_mfma_f32_16x16x32_bf16 v[132:135], v[100:103], v[76:79], v[132:135]
ds_read_b64_tr_b16 v[58:59], v14 offset:4096
v_mfma_f32_16x16x32_bf16 v[164:167], v[100:103], v[80:83], v[164:167]
ds_read_b64_tr_b16 v[60:61], v11 offset:16384
v_mfma_f32_16x16x32_bf16 v[196:199], v[100:103], v[84:87], v[196:199]
ds_read_b64_tr_b16 v[62:63], v11 offset:20480
v_mfma_f32_16x16x32_bf16 v[228:231], v[100:103], v[88:91], v[228:231]
ds_read_b64_tr_b16 v[64:65], v12 offset:16384
v_mfma_f32_16x16x32_bf16 v[232:235], v[104:107], v[88:91], v[232:235]
ds_read_b64_tr_b16 v[66:67], v12 offset:20480
v_mfma_f32_16x16x32_bf16 v[200:203], v[104:107], v[84:87], v[200:203]
ds_read_b64_tr_b16 v[68:69], v13 offset:16384
v_mfma_f32_16x16x32_bf16 v[168:171], v[104:107], v[80:83], v[168:171]
ds_read_b64_tr_b16 v[70:71], v13 offset:20480
v_mfma_f32_16x16x32_bf16 v[136:139], v[104:107], v[76:79], v[136:139]
ds_read_b64_tr_b16 v[72:73], v14 offset:16384
v_mfma_f32_16x16x32_bf16 v[140:143], v[108:111], v[76:79], v[140:143]
ds_read_b64_tr_b16 v[74:75], v14 offset:20480
v_mfma_f32_16x16x32_bf16 v[172:175], v[108:111], v[80:83], v[172:175]
ds_read_b128 v[32:35], v9 offset:1024
v_mfma_f32_16x16x32_bf16 v[204:207], v[108:111], v[84:87], v[204:207]
ds_read_b128 v[36:39], v9 offset:2048
v_mfma_f32_16x16x32_bf16 v[236:239], v[108:111], v[88:91], v[236:239]
ds_read_b128 v[40:43], v9 offset:3072
v_mfma_f32_16x16x32_bf16 v[240:243], v[112:115], v[88:91], v[240:243]
v_mfma_f32_16x16x32_bf16 v[208:211], v[112:115], v[84:87], v[208:211]
v_mfma_f32_16x16x32_bf16 v[176:179], v[112:115], v[80:83], v[176:179]
v_mfma_f32_16x16x32_bf16 v[144:147], v[112:115], v[76:79], v[144:147]
v_mfma_f32_16x16x32_bf16 v[148:151], v[116:119], v[76:79], v[148:151]
v_mfma_f32_16x16x32_bf16 v[180:183], v[116:119], v[80:83], v[180:183]
v_mfma_f32_16x16x32_bf16 v[212:215], v[116:119], v[84:87], v[212:215]
v_mfma_f32_16x16x32_bf16 v[244:247], v[116:119], v[88:91], v[244:247]
v_mfma_f32_16x16x32_bf16 v[248:251], v[120:123], v[88:91], v[248:251]
v_mfma_f32_16x16x32_bf16 v[216:219], v[120:123], v[84:87], v[216:219]
v_mfma_f32_16x16x32_bf16 v[184:187], v[120:123], v[80:83], v[184:187]
v_mfma_f32_16x16x32_bf16 v[152:155], v[120:123], v[76:79], v[152:155]
s_waitcnt lgkmcnt(0)
v_mfma_f32_16x16x32_bf16 v[124:127], v[44:47], v[28:31], v[124:127]
ds_read_b128 v[76:79], v9 offset:8192
v_mfma_f32_16x16x32_bf16 v[156:159], v[44:47], v[32:35], v[156:159]
ds_read_b64_tr_b16 v[92:93], v11 offset:8192
v_mfma_f32_16x16x32_bf16 v[188:191], v[44:47], v[36:39], v[188:191]
ds_read_b64_tr_b16 v[94:95], v11 offset:12288
v_mfma_f32_16x16x32_bf16 v[220:223], v[44:47], v[40:43], v[220:223]
ds_read_b64_tr_b16 v[96:97], v12 offset:8192
v_mfma_f32_16x16x32_bf16 v[224:227], v[48:51], v[40:43], v[224:227]
ds_read_b64_tr_b16 v[98:99], v12 offset:12288
v_mfma_f32_16x16x32_bf16 v[192:195], v[48:51], v[36:39], v[192:195]
ds_read_b64_tr_b16 v[100:101], v13 offset:8192
v_mfma_f32_16x16x32_bf16 v[160:163], v[48:51], v[32:35], v[160:163]
ds_read_b64_tr_b16 v[102:103], v13 offset:12288
v_mfma_f32_16x16x32_bf16 v[128:131], v[48:51], v[28:31], v[128:131]
ds_read_b64_tr_b16 v[104:105], v14 offset:8192
v_mfma_f32_16x16x32_bf16 v[132:135], v[52:55], v[28:31], v[132:135]
ds_read_b64_tr_b16 v[106:107], v14 offset:12288
v_mfma_f32_16x16x32_bf16 v[164:167], v[52:55], v[32:35], v[164:167]
ds_read_b64_tr_b16 v[108:109], v11 offset:24576
v_mfma_f32_16x16x32_bf16 v[196:199], v[52:55], v[36:39], v[196:199]
ds_read_b64_tr_b16 v[110:111], v11 offset:28672
v_mfma_f32_16x16x32_bf16 v[228:231], v[52:55], v[40:43], v[228:231]
ds_read_b64_tr_b16 v[112:113], v12 offset:24576
v_mfma_f32_16x16x32_bf16 v[232:235], v[56:59], v[40:43], v[232:235]
ds_read_b64_tr_b16 v[114:115], v12 offset:28672
v_mfma_f32_16x16x32_bf16 v[200:203], v[56:59], v[36:39], v[200:203]
ds_read_b64_tr_b16 v[116:117], v13 offset:24576
v_mfma_f32_16x16x32_bf16 v[168:171], v[56:59], v[32:35], v[168:171]
ds_read_b64_tr_b16 v[118:119], v13 offset:28672
v_mfma_f32_16x16x32_bf16 v[136:139], v[56:59], v[28:31], v[136:139]
ds_read_b64_tr_b16 v[120:121], v14 offset:24576
v_mfma_f32_16x16x32_bf16 v[140:143], v[60:63], v[28:31], v[140:143]
ds_read_b64_tr_b16 v[122:123], v14 offset:28672
v_mfma_f32_16x16x32_bf16 v[172:175], v[60:63], v[32:35], v[172:175]
ds_read_b128 v[80:83], v9 offset:9216
v_mfma_f32_16x16x32_bf16 v[204:207], v[60:63], v[36:39], v[204:207]
ds_read_b128 v[84:87], v9 offset:10240
v_mfma_f32_16x16x32_bf16 v[236:239], v[60:63], v[40:43], v[236:239]
ds_read_b128 v[88:91], v9 offset:11264
v_mfma_f32_16x16x32_bf16 v[240:243], v[64:67], v[40:43], v[240:243]
v_mfma_f32_16x16x32_bf16 v[208:211], v[64:67], v[36:39], v[208:211]
v_mfma_f32_16x16x32_bf16 v[176:179], v[64:67], v[32:35], v[176:179]
v_mfma_f32_16x16x32_bf16 v[144:147], v[64:67], v[28:31], v[144:147]
v_mfma_f32_16x16x32_bf16 v[148:151], v[68:71], v[28:31], v[148:151]
v_mfma_f32_16x16x32_bf16 v[180:183], v[68:71], v[32:35], v[180:183]
v_mfma_f32_16x16x32_bf16 v[212:215], v[68:71], v[36:39], v[212:215]
v_mfma_f32_16x16x32_bf16 v[244:247], v[68:71], v[40:43], v[244:247]
v_mfma_f32_16x16x32_bf16 v[248:251], v[72:75], v[40:43], v[248:251]
v_mfma_f32_16x16x32_bf16 v[216:219], v[72:75], v[36:39], v[216:219]
v_mfma_f32_16x16x32_bf16 v[184:187], v[72:75], v[32:35], v[184:187]
v_mfma_f32_16x16x32_bf16 v[152:155], v[72:75], v[28:31], v[152:155]
s_waitcnt lgkmcnt(0)
s_barrier
v_mfma_f32_16x16x32_bf16 v[124:127], v[92:95], v[76:79], v[124:127]
ds_read_b128 v[28:31], v9 offset:49152
v_mfma_f32_16x16x32_bf16 v[156:159], v[92:95], v[80:83], v[156:159]
ds_read_b64_tr_b16 v[44:45], v15 offset:0
v_mfma_f32_16x16x32_bf16 v[188:191], v[92:95], v[84:87], v[188:191]
ds_read_b64_tr_b16 v[46:47], v15 offset:4096
v_mfma_f32_16x16x32_bf16 v[220:223], v[92:95], v[88:91], v[220:223]
ds_read_b64_tr_b16 v[48:49], v16 offset:0
v_mfma_f32_16x16x32_bf16 v[224:227], v[96:99], v[88:91], v[224:227]
ds_read_b64_tr_b16 v[50:51], v16 offset:4096
v_mfma_f32_16x16x32_bf16 v[192:195], v[96:99], v[84:87], v[192:195]
ds_read_b64_tr_b16 v[52:53], v17 offset:0
v_mfma_f32_16x16x32_bf16 v[160:163], v[96:99], v[80:83], v[160:163]
ds_read_b64_tr_b16 v[54:55], v17 offset:4096
v_mfma_f32_16x16x32_bf16 v[128:131], v[96:99], v[76:79], v[128:131]
ds_read_b64_tr_b16 v[56:57], v18 offset:0
v_mfma_f32_16x16x32_bf16 v[132:135], v[100:103], v[76:79], v[132:135]
ds_read_b64_tr_b16 v[58:59], v18 offset:4096
v_mfma_f32_16x16x32_bf16 v[164:167], v[100:103], v[80:83], v[164:167]
ds_read_b64_tr_b16 v[60:61], v15 offset:16384
v_mfma_f32_16x16x32_bf16 v[196:199], v[100:103], v[84:87], v[196:199]
ds_read_b64_tr_b16 v[62:63], v15 offset:20480
v_mfma_f32_16x16x32_bf16 v[228:231], v[100:103], v[88:91], v[228:231]
ds_read_b64_tr_b16 v[64:65], v16 offset:16384
v_mfma_f32_16x16x32_bf16 v[232:235], v[104:107], v[88:91], v[232:235]
ds_read_b64_tr_b16 v[66:67], v16 offset:20480
v_mfma_f32_16x16x32_bf16 v[200:203], v[104:107], v[84:87], v[200:203]
ds_read_b64_tr_b16 v[68:69], v17 offset:16384
v_mfma_f32_16x16x32_bf16 v[168:171], v[104:107], v[80:83], v[168:171]
ds_read_b64_tr_b16 v[70:71], v17 offset:20480
v_mfma_f32_16x16x32_bf16 v[136:139], v[104:107], v[76:79], v[136:139]
ds_read_b64_tr_b16 v[72:73], v18 offset:16384
v_mfma_f32_16x16x32_bf16 v[140:143], v[108:111], v[76:79], v[140:143]
ds_read_b64_tr_b16 v[74:75], v18 offset:20480
v_mfma_f32_16x16x32_bf16 v[172:175], v[108:111], v[80:83], v[172:175]
ds_read_b128 v[32:35], v9 offset:50176
v_mfma_f32_16x16x32_bf16 v[204:207], v[108:111], v[84:87], v[204:207]
ds_read_b128 v[36:39], v9 offset:51200
v_mfma_f32_16x16x32_bf16 v[236:239], v[108:111], v[88:91], v[236:239]
ds_read_b128 v[40:43], v9 offset:52224
v_mfma_f32_16x16x32_bf16 v[240:243], v[112:115], v[88:91], v[240:243]
v_mfma_f32_16x16x32_bf16 v[208:211], v[112:115], v[84:87], v[208:211]
v_mfma_f32_16x16x32_bf16 v[176:179], v[112:115], v[80:83], v[176:179]
v_mfma_f32_16x16x32_bf16 v[144:147], v[112:115], v[76:79], v[144:147]
v_mfma_f32_16x16x32_bf16 v[148:151], v[116:119], v[76:79], v[148:151]
v_mfma_f32_16x16x32_bf16 v[180:183], v[116:119], v[80:83], v[180:183]
v_mfma_f32_16x16x32_bf16 v[212:215], v[116:119], v[84:87], v[212:215]
v_mfma_f32_16x16x32_bf16 v[244:247], v[116:119], v[88:91], v[244:247]
v_mfma_f32_16x16x32_bf16 v[248:251], v[120:123], v[88:91], v[248:251]
v_mfma_f32_16x16x32_bf16 v[216:219], v[120:123], v[84:87], v[216:219]
v_mfma_f32_16x16x32_bf16 v[184:187], v[120:123], v[80:83], v[184:187]
v_mfma_f32_16x16x32_bf16 v[152:155], v[120:123], v[76:79], v[152:155]
s_waitcnt lgkmcnt(0)
v_mfma_f32_16x16x32_bf16 v[124:127], v[44:47], v[28:31], v[124:127]
ds_read_b128 v[76:79], v9 offset:57344
v_mfma_f32_16x16x32_bf16 v[156:159], v[44:47], v[32:35], v[156:159]
ds_read_b64_tr_b16 v[92:93], v15 offset:8192
v_mfma_f32_16x16x32_bf16 v[188:191], v[44:47], v[36:39], v[188:191]
ds_read_b64_tr_b16 v[94:95], v15 offset:12288
v_mfma_f32_16x16x32_bf16 v[220:223], v[44:47], v[40:43], v[220:223]
ds_read_b64_tr_b16 v[96:97], v16 offset:8192
v_mfma_f32_16x16x32_bf16 v[224:227], v[48:51], v[40:43], v[224:227]
ds_read_b64_tr_b16 v[98:99], v16 offset:12288
v_mfma_f32_16x16x32_bf16 v[192:195], v[48:51], v[36:39], v[192:195]
ds_read_b64_tr_b16 v[100:101], v17 offset:8192
v_mfma_f32_16x16x32_bf16 v[160:163], v[48:51], v[32:35], v[160:163]
ds_read_b64_tr_b16 v[102:103], v17 offset:12288
v_mfma_f32_16x16x32_bf16 v[128:131], v[48:51], v[28:31], v[128:131]
ds_read_b64_tr_b16 v[104:105], v18 offset:8192
v_mfma_f32_16x16x32_bf16 v[132:135], v[52:55], v[28:31], v[132:135]
ds_read_b64_tr_b16 v[106:107], v18 offset:12288
v_mfma_f32_16x16x32_bf16 v[164:167], v[52:55], v[32:35], v[164:167]
ds_read_b64_tr_b16 v[108:109], v15 offset:24576
v_mfma_f32_16x16x32_bf16 v[196:199], v[52:55], v[36:39], v[196:199]
ds_read_b64_tr_b16 v[110:111], v15 offset:28672
v_mfma_f32_16x16x32_bf16 v[228:231], v[52:55], v[40:43], v[228:231]
ds_read_b64_tr_b16 v[112:113], v16 offset:24576
v_mfma_f32_16x16x32_bf16 v[232:235], v[56:59], v[40:43], v[232:235]
ds_read_b64_tr_b16 v[114:115], v16 offset:28672
v_mfma_f32_16x16x32_bf16 v[200:203], v[56:59], v[36:39], v[200:203]
ds_read_b64_tr_b16 v[116:117], v17 offset:24576
v_mfma_f32_16x16x32_bf16 v[168:171], v[56:59], v[32:35], v[168:171]
ds_read_b64_tr_b16 v[118:119], v17 offset:28672
v_mfma_f32_16x16x32_bf16 v[136:139], v[56:59], v[28:31], v[136:139]
ds_read_b64_tr_b16 v[120:121], v18 offset:24576
v_mfma_f32_16x16x32_bf16 v[140:143], v[60:63], v[28:31], v[140:143]
ds_read_b64_tr_b16 v[122:123], v18 offset:28672
v_mfma_f32_16x16x32_bf16 v[172:175], v[60:63], v[32:35], v[172:175]
ds_read_b128 v[80:83], v9 offset:58368
v_mfma_f32_16x16x32_bf16 v[204:207], v[60:63], v[36:39], v[204:207]
ds_read_b128 v[84:87], v9 offset:59392
v_mfma_f32_16x16x32_bf16 v[236:239], v[60:63], v[40:43], v[236:239]
ds_read_b128 v[88:91], v9 offset:60416
v_mfma_f32_16x16x32_bf16 v[240:243], v[64:67], v[40:43], v[240:243]
v_mfma_f32_16x16x32_bf16 v[208:211], v[64:67], v[36:39], v[208:211]
v_mfma_f32_16x16x32_bf16 v[176:179], v[64:67], v[32:35], v[176:179]
v_mfma_f32_16x16x32_bf16 v[144:147], v[64:67], v[28:31], v[144:147]
v_mfma_f32_16x16x32_bf16 v[148:151], v[68:71], v[28:31], v[148:151]
v_mfma_f32_16x16x32_bf16 v[180:183], v[68:71], v[32:35], v[180:183]
v_mfma_f32_16x16x32_bf16 v[212:215], v[68:71], v[36:39], v[212:215]
v_mfma_f32_16x16x32_bf16 v[244:247], v[68:71], v[40:43], v[244:247]
v_mfma_f32_16x16x32_bf16 v[248:251], v[72:75], v[40:43], v[248:251]
v_mfma_f32_16x16x32_bf16 v[216:219], v[72:75], v[36:39], v[216:219]
v_mfma_f32_16x16x32_bf16 v[184:187], v[72:75], v[32:35], v[184:187]
v_mfma_f32_16x16x32_bf16 v[152:155], v[72:75], v[28:31], v[152:155]
s_waitcnt lgkmcnt(0)
s_barrier
v_mfma_f32_16x16x32_bf16 v[124:127], v[92:95], v[76:79], v[124:127]
ds_read_b128 v[28:31], v10 offset:0
v_mfma_f32_16x16x32_bf16 v[156:159], v[92:95], v[80:83], v[156:159]
ds_read_b64_tr_b16 v[44:45], v19 offset:0
v_mfma_f32_16x16x32_bf16 v[188:191], v[92:95], v[84:87], v[188:191]
ds_read_b64_tr_b16 v[46:47], v19 offset:4096
v_mfma_f32_16x16x32_bf16 v[220:223], v[92:95], v[88:91], v[220:223]
ds_read_b64_tr_b16 v[48:49], v20 offset:0
v_mfma_f32_16x16x32_bf16 v[224:227], v[96:99], v[88:91], v[224:227]
ds_read_b64_tr_b16 v[50:51], v20 offset:4096
v_mfma_f32_16x16x32_bf16 v[192:195], v[96:99], v[84:87], v[192:195]
ds_read_b64_tr_b16 v[52:53], v21 offset:0
v_mfma_f32_16x16x32_bf16 v[160:163], v[96:99], v[80:83], v[160:163]
ds_read_b64_tr_b16 v[54:55], v21 offset:4096
v_mfma_f32_16x16x32_bf16 v[128:131], v[96:99], v[76:79], v[128:131]
ds_read_b64_tr_b16 v[56:57], v22 offset:0
v_mfma_f32_16x16x32_bf16 v[132:135], v[100:103], v[76:79], v[132:135]
ds_read_b64_tr_b16 v[58:59], v22 offset:4096
v_mfma_f32_16x16x32_bf16 v[164:167], v[100:103], v[80:83], v[164:167]
ds_read_b64_tr_b16 v[60:61], v19 offset:16384
v_mfma_f32_16x16x32_bf16 v[196:199], v[100:103], v[84:87], v[196:199]
ds_read_b64_tr_b16 v[62:63], v19 offset:20480
v_mfma_f32_16x16x32_bf16 v[228:231], v[100:103], v[88:91], v[228:231]
ds_read_b64_tr_b16 v[64:65], v20 offset:16384
v_mfma_f32_16x16x32_bf16 v[232:235], v[104:107], v[88:91], v[232:235]
ds_read_b64_tr_b16 v[66:67], v20 offset:20480
v_mfma_f32_16x16x32_bf16 v[200:203], v[104:107], v[84:87], v[200:203]
ds_read_b64_tr_b16 v[68:69], v21 offset:16384
v_mfma_f32_16x16x32_bf16 v[168:171], v[104:107], v[80:83], v[168:171]
ds_read_b64_tr_b16 v[70:71], v21 offset:20480
v_mfma_f32_16x16x32_bf16 v[136:139], v[104:107], v[76:79], v[136:139]
ds_read_b64_tr_b16 v[72:73], v22 offset:16384
v_mfma_f32_16x16x32_bf16 v[140:143], v[108:111], v[76:79], v[140:143]
ds_read_b64_tr_b16 v[74:75], v22 offset:20480
v_mfma_f32_16x16x32_bf16 v[172:175], v[108:111], v[80:83], v[172:175]
ds_read_b128 v[32:35], v10 offset:1024
v_mfma_f32_16x16x32_bf16 v[204:207], v[108:111], v[84:87], v[204:207]
ds_read_b128 v[36:39], v10 offset:2048
v_mfma_f32_16x16x32_bf16 v[236:239], v[108:111], v[88:91], v[236:239]
ds_read_b128 v[40:43], v10 offset:3072
v_mfma_f32_16x16x32_bf16 v[240:243], v[112:115], v[88:91], v[240:243]
v_mfma_f32_16x16x32_bf16 v[208:211], v[112:115], v[84:87], v[208:211]
v_mfma_f32_16x16x32_bf16 v[176:179], v[112:115], v[80:83], v[176:179]
v_mfma_f32_16x16x32_bf16 v[144:147], v[112:115], v[76:79], v[144:147]
v_mfma_f32_16x16x32_bf16 v[148:151], v[116:119], v[76:79], v[148:151]
v_mfma_f32_16x16x32_bf16 v[180:183], v[116:119], v[80:83], v[180:183]
v_mfma_f32_16x16x32_bf16 v[212:215], v[116:119], v[84:87], v[212:215]
v_mfma_f32_16x16x32_bf16 v[244:247], v[116:119], v[88:91], v[244:247]
v_mfma_f32_16x16x32_bf16 v[248:251], v[120:123], v[88:91], v[248:251]
v_mfma_f32_16x16x32_bf16 v[216:219], v[120:123], v[84:87], v[216:219]
v_mfma_f32_16x16x32_bf16 v[184:187], v[120:123], v[80:83], v[184:187]
v_mfma_f32_16x16x32_bf16 v[152:155], v[120:123], v[76:79], v[152:155]
s_sub_u32 s41, s41, 1
s_cmp_lg_u32 s41, 0
s_cbranch_scc1 Lk3l_132
s_waitcnt lgkmcnt(0)
s_barrier
v_lshrrev_b32 v84, 4, v1
s_lshl_b32 s43, s63, 8
s_add_u32 s43, s43, 148480
v_lshl_add_u32 v85, v84, 4, s43
v_and_b32 v84, 15, v1
s_lshl_b32 s43, s62, 9
s_add_u32 s43, s43, 147456
v_lshl_add_u32 v84, v84, 3, s43
ds_read_b128 v[28:31], v85 offset:0
ds_read_b128 v[32:35], v85 offset:64
ds_read_b128 v[36:39], v85 offset:128
ds_read_b128 v[40:43], v85 offset:192
ds_read_b128 v[44:47], v85 offset:896
ds_read_b128 v[48:51], v85 offset:960
ds_read_b128 v[52:55], v85 offset:1024
ds_read_b128 v[56:59], v85 offset:1088
ds_read_b64 v[60:61], v84 offset:0
ds_read_b64 v[62:63], v84 offset:128
ds_read_b64 v[64:65], v84 offset:256
ds_read_b64 v[66:67], v84 offset:384
s_lshl_b32 s54, s35, 15
s_lshl_b32 s43, s63, 14
s_add_u32 s54, s54, s43
s_lshl_b32 s43, s62, 12
s_add_u32 s54, s54, s43
s_add_u32 s55, s54, 8192
v_lshrrev_b32 v122, 3, v1
v_and_b32 v123, 6, v122
v_and_b32 v25, 7, v1
v_xor_b32 v25, v25, v123
v_lshlrev_b32 v25, 4, v25
v_mul_u32_u24 v122, 2048, v122
v_add_u32 v25, v25, v122
s_lshl_b32 s43, s61, 7
s_lshl_b32 s44, s47, 15
s_add_u32 s43, s43, s44
v_add_u32 v25, s43, v25
s_waitcnt lgkmcnt(0)
s_add_u32 s37, s52, 589824
s_add_u32 m0, s39, 81920
s_nop 0
buffer_load_dwordx4 v3, s[24:27], s37 offen sc1 lds
v_mul_f32 v70, v61, v61
v_mul_f32 v68, 0xc0135761, v61
v_mul_f32 v69, 0xbdd2d3e8, v61
v_mul_f32 v69, v69, v70
v_rcp_f32 v70, v70
v_mul_f32 v74, v63, v63
v_mul_f32 v72, 0xc0135761, v63
v_mul_f32 v73, 0xbdd2d3e8, v63
v_mul_f32 v73, v73, v74
v_rcp_f32 v74, v74
v_fma_f32 v124, -v60, v28, v124
v_fma_f32 v125, -v60, v29, v125
v_fma_f32 v126, -v60, v30, v126
v_fma_f32 v127, -v60, v31, v127
buffer_load_dwordx4 v3, s[24:27], s37 offen offset:1024 sc1 lds
v_fma_f32 v156, -v62, v28, v156
v_fma_f32 v157, -v62, v29, v157
v_fma_f32 v158, -v62, v30, v158
v_fma_f32 v159, -v62, v31, v159
v_mul_f32 v76, v124, v124
v_mul_f32 v77, v125, v125
v_mul_f32 v78, v126, v126
v_mul_f32 v79, v127, v127
v_mul_f32 v80, v156, v156
v_mul_f32 v81, v157, v157
v_mul_f32 v82, v158, v158
v_mul_f32 v83, v159, v159
v_fma_f32 v76, v76, v69, v68
v_fma_f32 v77, v77, v69, v68
buffer_load_dwordx4 v3, s[24:27], s37 offen offset:2048 sc1 lds
v_fma_f32 v78, v78, v69, v68
s_branch Lov_16
.p2align 12
.fill 128, 4, 0xbf800000
Lst_16_0:
s_branch Lwr_169
s_nop 0
s_nop 0
Lov_16:
v_fma_f32 v79, v79, v69, v68
v_fma_f32 v80, v80, v73, v72
v_fma_f32 v81, v81, v73, v72
v_fma_f32 v82, v82, v73, v72
v_fma_f32 v83, v83, v73, v72
v_mul_f32 v76, v76, v124
v_mul_f32 v77, v77, v125
v_mul_f32 v78, v78, v126
v_mul_f32 v79, v79, v127
v_mul_f32 v80, v80, v156
v_mul_f32 v81, v81, v157
v_mul_f32 v82, v82, v158
v_mul_f32 v83, v83, v159
buffer_load_dwordx4 v3, s[24:27], s37 offen offset:3072 sc1 lds
v_exp_f32 v76, v76
v_exp_f32 v77, v77
v_exp_f32 v78, v78
v_exp_f32 v79, v79
v_exp_f32 v80, v80
v_exp_f32 v81, v81
v_exp_f32 v82, v82
v_exp_f32 v83, v83
v_fma_f32 v140, -v60, v44, v140
v_fma_f32 v141, -v60, v45, v141
v_fma_f32 v142, -v60, v46, v142
v_fma_f32 v143, -v60, v47, v143
v_fma_f32 v172, -v62, v44, v172
v_fma_f32 v173, -v62, v45, v173
s_add_u32 s37, s52, 606208
s_add_u32 m0, s39, 98304
s_nop 0
buffer_load_dwordx4 v3, s[24:27], s37 offen sc1 lds
v_fma_f32 v174, -v62, v46, v174
v_fma_f32 v175, -v62, v47, v175
v_fma_f32 v76, v76, v70, v70
v_fma_f32 v77, v77, v70, v70
v_fma_f32 v78, v78, v70, v70
v_fma_f32 v79, v79, v70, v70
v_fma_f32 v80, v80, v74, v74
v_fma_f32 v81, v81, v74, v74
v_fma_f32 v82, v82, v74, v74
v_fma_f32 v83, v83, v74, v74
v_rcp_f32 v76, v76
v_rcp_f32 v77, v77
v_rcp_f32 v78, v78
v_rcp_f32 v79, v79
buffer_load_dwordx4 v3, s[24:27], s37 offen offset:1024 sc1 lds
v_rcp_f32 v80, v80
v_rcp_f32 v81, v81
v_rcp_f32 v82, v82
v_rcp_f32 v83, v83
v_mul_f32 v140, v124, v140
v_mul_f32 v141, v125, v141
v_mul_f32 v142, v126, v142
v_mul_f32 v143, v127, v143
v_mul_f32 v172, v156, v172
v_mul_f32 v173, v157, v173
v_mul_f32 v174, v158, v174
v_mul_f32 v175, v159, v175
v_mul_f32 v140, v140, v76
v_mul_f32 v141, v141, v77
buffer_load_dwordx4 v3, s[24:27], s37 offen offset:2048 sc1 lds
v_mul_f32 v142, v142, v78
v_mul_f32 v143, v143, v79
v_mul_f32 v172, v172, v80
v_mul_f32 v173, v173, v81
v_mul_f32 v174, v174, v82
v_mul_f32 v175, v175, v83
v_cvt_pk_bf16_f32 v124, v140, v141
v_cvt_pk_bf16_f32 v125, v142, v143
v_cvt_pk_bf16_f32 v156, v172, v173
v_cvt_pk_bf16_f32 v157, v174, v175
v_fma_f32 v128, -v60, v32, v128
v_fma_f32 v129, -v60, v33, v129
v_fma_f32 v130, -v60, v34, v130
v_fma_f32 v131, -v60, v35, v131
buffer_load_dwordx4 v3, s[24:27], s37 offen offset:3072 sc1 lds
v_fma_f32 v160, -v62, v32, v160
v_fma_f32 v161, -v62, v33, v161
v_fma_f32 v162, -v62, v34, v162
v_fma_f32 v163, -v62, v35, v163
v_mul_f32 v76, v128, v128
v_mul_f32 v77, v129, v129
v_mul_f32 v78, v130, v130
v_mul_f32 v79, v131, v131
v_mul_f32 v80, v160, v160
v_mul_f32 v81, v161, v161
v_mul_f32 v82, v162, v162
v_mul_f32 v83, v163, v163
v_fma_f32 v76, v76, v69, v68
v_fma_f32 v77, v77, v69, v68
s_add_u32 s38, s53, 4849664
s_add_u32 m0, s39, 114688
s_nop 0
buffer_load_dwordx4 v23, s[28:31], s38 offen lds
v_fma_f32 v78, v78, v69, v68
v_fma_f32 v79, v79, v69, v68
v_fma_f32 v80, v80, v73, v72
v_fma_f32 v81, v81, v73, v72
v_fma_f32 v82, v82, v73, v72
v_fma_f32 v83, v83, v73, v72
v_mul_f32 v76, v76, v128
v_mul_f32 v77, v77, v129
v_mul_f32 v78, v78, v130
v_mul_f32 v79, v79, v131
v_mul_f32 v80, v80, v160
v_mul_f32 v81, v81, v161
v_mul_f32 v82, v82, v162
v_mul_f32 v83, v83, v163
s_add_u32 m0, s39, 115712
s_nop 0
buffer_load_dwordx4 v24, s[28:31], s38 offen lds
v_exp_f32 v76, v76
v_exp_f32 v77, v77
v_exp_f32 v78, v78
v_exp_f32 v79, v79
v_exp_f32 v80, v80
v_exp_f32 v81, v81
v_exp_f32 v82, v82
v_exp_f32 v83, v83
v_fma_f32 v144, -v60, v48, v144
v_fma_f32 v145, -v60, v49, v145
v_fma_f32 v146, -v60, v50, v146
v_fma_f32 v147, -v60, v51, v147
v_fma_f32 v176, -v62, v48, v176
v_fma_f32 v177, -v62, v49, v177
s_add_u32 m0, s39, 116736
s_add_u32 s38, s38, 16384
buffer_load_dwordx4 v23, s[28:31], s38 offen lds
s_add_u32 m0, s39, 117760
s_nop 0
buffer_load_dwordx4 v24, s[28:31], s38 offen lds
s_barrier
s_add_u32 s38, s53, 4718592
s_add_u32 m0, s39, 147456
s_nop 0
buffer_load_dwordx4 v23, s[28:31], s38 offen lds
v_fma_f32 v178, -v62, v50, v178
v_fma_f32 v179, -v62, v51, v179
v_fma_f32 v76, v76, v70, v70
v_fma_f32 v77, v77, v70, v70
v_fma_f32 v78, v78, v70, v70
v_fma_f32 v79, v79, v70, v70
v_fma_f32 v80, v80, v74, v74
v_fma_f32 v81, v81, v74, v74
v_fma_f32 v82, v82, v74, v74
v_fma_f32 v83, v83, v74, v74
v_rcp_f32 v76, v76
v_rcp_f32 v77, v77
v_rcp_f32 v78, v78
v_rcp_f32 v79, v79
s_add_u32 m0, s39, 148480
s_nop 0
buffer_load_dwordx4 v24, s[28:31], s38 offen lds
v_rcp_f32 v80, v80
v_rcp_f32 v81, v81
v_rcp_f32 v82, v82
v_rcp_f32 v83, v83
v_mul_f32 v144, v128, v144
v_mul_f32 v145, v129, v145
v_mul_f32 v146, v130, v146
v_mul_f32 v147, v131, v147
v_mul_f32 v176, v160, v176
v_mul_f32 v177, v161, v177
v_mul_f32 v178, v162, v178
v_mul_f32 v179, v163, v179
v_mul_f32 v144, v144, v76
v_mul_f32 v145, v145, v77
s_add_u32 m0, s39, 149504
s_add_u32 s38, s38, 16384
buffer_load_dwordx4 v23, s[28:31], s38 offen lds
v_mul_f32 v146, v146, v78
v_mul_f32 v147, v147, v79
v_mul_f32 v176, v176, v80
v_mul_f32 v177, v177, v81
v_mul_f32 v178, v178, v82
v_mul_f32 v179, v179, v83
v_cvt_pk_bf16_f32 v126, v144, v145
v_cvt_pk_bf16_f32 v127, v146, v147
v_cvt_pk_bf16_f32 v158, v176, v177
v_cvt_pk_bf16_f32 v159, v178, v179
buffer_store_dwordx4 v[124:127], v2, s[24:27], s54 offen offset:0 sc1
buffer_store_dwordx4 v[156:159], v2, s[24:27], s54 offen offset:1024 sc1
v_fma_f32 v132, -v60, v36, v132
v_fma_f32 v133, -v60, v37, v133
s_add_u32 m0, s39, 150528
s_nop 0
buffer_load_dwordx4 v24, s[28:31], s38 offen lds
v_fma_f32 v134, -v60, v38, v134
v_fma_f32 v135, -v60, v39, v135
v_fma_f32 v164, -v62, v36, v164
v_fma_f32 v165, -v62, v37, v165
v_fma_f32 v166, -v62, v38, v166
v_fma_f32 v167, -v62, v39, v167
v_mul_f32 v76, v132, v132
v_mul_f32 v77, v133, v133
v_mul_f32 v78, v134, v134
v_mul_f32 v79, v135, v135
v_mul_f32 v80, v164, v164
v_mul_f32 v81, v165, v165
v_mul_f32 v82, v166, v166
v_mul_f32 v83, v167, v167
s_add_u32 s37, s52, 622592
s_add_u32 m0, s39, 131072
s_nop 0
buffer_load_dwordx4 v3, s[24:27], s37 offen sc1 lds
v_fma_f32 v76, v76, v69, v68
v_fma_f32 v77, v77, v69, v68
v_fma_f32 v78, v78, v69, v68
v_fma_f32 v79, v79, v69, v68
v_fma_f32 v80, v80, v73, v72
v_fma_f32 v81, v81, v73, v72
v_fma_f32 v82, v82, v73, v72
v_fma_f32 v83, v83, v73, v72
v_mul_f32 v76, v76, v132
v_mul_f32 v77, v77, v133
v_mul_f32 v78, v78, v134
v_mul_f32 v79, v79, v135
v_mul_f32 v80, v80, v164
v_mul_f32 v81, v81, v165
buffer_load_dwordx4 v3, s[24:27], s37 offen offset:1024 sc1 lds
v_mul_f32 v82, v82, v166
v_mul_f32 v83, v83, v167
v_exp_f32 v76, v76
v_exp_f32 v77, v77
v_exp_f32 v78, v78
v_exp_f32 v79, v79
v_exp_f32 v80, v80
v_exp_f32 v81, v81
v_exp_f32 v82, v82
v_exp_f32 v83, v83
v_fma_f32 v148, -v60, v52, v148
v_fma_f32 v149, -v60, v53, v149
v_fma_f32 v150, -v60, v54, v150
v_fma_f32 v151, -v60, v55, v151
buffer_load_dwordx4 v3, s[24:27], s37 offen offset:2048 sc1 lds
v_fma_f32 v180, -v62, v52, v180
v_fma_f32 v181, -v62, v53, v181
v_fma_f32 v182, -v62, v54, v182
v_fma_f32 v183, -v62, v55, v183
v_fma_f32 v76, v76, v70, v70
v_fma_f32 v77, v77, v70, v70
v_fma_f32 v78, v78, v70, v70
v_fma_f32 v79, v79, v70, v70
v_fma_f32 v80, v80, v74, v74
v_fma_f32 v81, v81, v74, v74
v_fma_f32 v82, v82, v74, v74
v_fma_f32 v83, v83, v74, v74
v_rcp_f32 v76, v76
v_rcp_f32 v77, v77
buffer_load_dwordx4 v3, s[24:27], s37 offen offset:3072 sc1 lds
v_rcp_f32 v78, v78
v_rcp_f32 v79, v79
v_rcp_f32 v80, v80
v_rcp_f32 v81, v81
v_rcp_f32 v82, v82
v_rcp_f32 v83, v83
v_mul_f32 v148, v132, v148
v_mul_f32 v149, v133, v149
v_mul_f32 v150, v134, v150
v_mul_f32 v151, v135, v151
v_mul_f32 v180, v164, v180
v_mul_f32 v181, v165, v181
v_mul_f32 v182, v166, v182
v_mul_f32 v183, v167, v183
s_add_u32 s38, s53, 4980736
s_add_u32 m0, s39, 0
s_nop 0
buffer_load_dwordx4 v23, s[28:31], s38 offen lds
v_mul_f32 v148, v148, v76
v_mul_f32 v149, v149, v77
v_mul_f32 v150, v150, v78
v_mul_f32 v151, v151, v79
v_mul_f32 v180, v180, v80
v_mul_f32 v181, v181, v81
v_mul_f32 v182, v182, v82
v_mul_f32 v183, v183, v83
v_cvt_pk_bf16_f32 v132, v148, v149
v_cvt_pk_bf16_f32 v133, v150, v151
v_cvt_pk_bf16_f32 v164, v180, v181
v_cvt_pk_bf16_f32 v165, v182, v183
v_fma_f32 v136, -v60, v40, v136
v_fma_f32 v137, -v60, v41, v137
s_add_u32 m0, s39, 1024
s_nop 0
buffer_load_dwordx4 v24, s[28:31], s38 offen lds
v_fma_f32 v138, -v60, v42, v138
v_fma_f32 v139, -v60, v43, v139
v_fma_f32 v168, -v62, v40, v168
v_fma_f32 v169, -v62, v41, v169
v_fma_f32 v170, -v62, v42, v170
v_fma_f32 v171, -v62, v43, v171
v_mul_f32 v76, v136, v136
v_mul_f32 v77, v137, v137
v_mul_f32 v78, v138, v138
v_mul_f32 v79, v139, v139
v_mul_f32 v80, v168, v168
v_mul_f32 v81, v169, v169
v_mul_f32 v82, v170, v170
v_mul_f32 v83, v171, v171
s_add_u32 m0, s39, 2048
s_add_u32 s38, s38, 16384
buffer_load_dwordx4 v23, s[28:31], s38 offen lds
s_add_u32 m0, s39, 3072
s_nop 0
buffer_load_dwordx4 v24, s[28:31], s38 offen lds
s_barrier
s_add_u32 s37, s52, 638976
s_add_u32 m0, s39, 16384
s_nop 0
buffer_load_dwordx4 v3, s[24:27], s37 offen sc1 lds
v_fma_f32 v76, v76, v69, v68
v_fma_f32 v77, v77, v69, v68
v_fma_f32 v78, v78, v69, v68
v_fma_f32 v79, v79, v69, v68
v_fma_f32 v80, v80, v73, v72
v_fma_f32 v81, v81, v73, v72
v_fma_f32 v82, v82, v73, v72
v_fma_f32 v83, v83, v73, v72
v_mul_f32 v76, v76, v136
v_mul_f32 v77, v77, v137
v_mul_f32 v78, v78, v138
v_mul_f32 v79, v79, v139
v_mul_f32 v80, v80, v168
v_mul_f32 v81, v81, v169
v_mul_f32 v82, v82, v170
v_mul_f32 v83, v83, v171
v_exp_f32 v76, v76
v_exp_f32 v77, v77
v_exp_f32 v78, v78
v_exp_f32 v79, v79
v_exp_f32 v80, v80
v_exp_f32 v81, v81
v_exp_f32 v82, v82
buffer_load_dwordx4 v3, s[24:27], s37 offen offset:1024 sc1 lds
v_exp_f32 v83, v83
v_fma_f32 v152, -v60, v56, v152
v_fma_f32 v153, -v60, v57, v153
v_fma_f32 v154, -v60, v58, v154
v_fma_f32 v155, -v60, v59, v155
v_fma_f32 v184, -v62, v56, v184
v_fma_f32 v185, -v62, v57, v185
v_fma_f32 v186, -v62, v58, v186
v_fma_f32 v187, -v62, v59, v187
v_fma_f32 v76, v76, v70, v70
v_fma_f32 v77, v77, v70, v70
v_fma_f32 v78, v78, v70, v70
v_fma_f32 v79, v79, v70, v70
v_fma_f32 v80, v80, v74, v74
v_fma_f32 v81, v81, v74, v74
v_fma_f32 v82, v82, v74, v74
v_fma_f32 v83, v83, v74, v74
v_rcp_f32 v76, v76
v_rcp_f32 v77, v77
v_rcp_f32 v78, v78
v_rcp_f32 v79, v79
v_rcp_f32 v80, v80
v_rcp_f32 v81, v81
buffer_load_dwordx4 v3, s[24:27], s37 offen offset:2048 sc1 lds
v_rcp_f32 v82, v82
v_rcp_f32 v83, v83
v_mul_f32 v152, v136, v152
v_mul_f32 v153, v137, v153
v_mul_f32 v154, v138, v154
v_mul_f32 v155, v139, v155
v_mul_f32 v184, v168, v184
v_mul_f32 v185, v169, v185
v_mul_f32 v186, v170, v186
v_mul_f32 v187, v171, v187
v_mul_f32 v152, v152, v76
v_mul_f32 v153, v153, v77
v_mul_f32 v154, v154, v78
v_mul_f32 v155, v155, v79
v_mul_f32 v184, v184, v80
v_mul_f32 v185, v185, v81
v_mul_f32 v186, v186, v82
v_mul_f32 v187, v187, v83
v_cvt_pk_bf16_f32 v134, v152, v153
v_cvt_pk_bf16_f32 v135, v154, v155
v_cvt_pk_bf16_f32 v166, v184, v185
v_cvt_pk_bf16_f32 v167, v186, v187
buffer_store_dwordx4 v[132:135], v2, s[24:27], s55 offen offset:0 sc1
buffer_store_dwordx4 v[164:167], v2, s[24:27], s55 offen offset:1024 sc1
buffer_load_dwordx4 v3, s[24:27], s37 offen offset:3072 sc1 lds
v_mul_f32 v70, v65, v65
v_mul_f32 v68, 0xc0135761, v65
v_mul_f32 v69, 0xbdd2d3e8, v65
v_mul_f32 v69, v69, v70
v_rcp_f32 v70, v70
v_mul_f32 v74, v67, v67
v_mul_f32 v72, 0xc0135761, v67
v_mul_f32 v73, 0xbdd2d3e8, v67
v_mul_f32 v73, v73, v74
v_rcp_f32 v74, v74
v_fma_f32 v188, -v64, v28, v188
v_fma_f32 v189, -v64, v29, v189
v_fma_f32 v190, -v64, v30, v190
v_fma_f32 v191, -v64, v31, v191
v_fma_f32 v220, -v66, v28, v220
v_fma_f32 v221, -v66, v29, v221
v_fma_f32 v222, -v66, v30, v222
v_fma_f32 v223, -v66, v31, v223
v_mul_f32 v76, v188, v188
v_mul_f32 v77, v189, v189
v_mul_f32 v78, v190, v190
v_mul_f32 v79, v191, v191
v_mul_f32 v80, v220, v220
s_add_u32 s38, s53, 5111808
s_add_u32 m0, s39, 32768
s_nop 0
buffer_load_dwordx4 v23, s[28:31], s38 offen lds
v_mul_f32 v81, v221, v221
v_mul_f32 v82, v222, v222
v_mul_f32 v83, v223, v223
v_fma_f32 v76, v76, v69, v68
v_fma_f32 v77, v77, v69, v68
v_fma_f32 v78, v78, v69, v68
v_fma_f32 v79, v79, v69, v68
v_fma_f32 v80, v80, v73, v72
v_fma_f32 v81, v81, v73, v72
v_fma_f32 v82, v82, v73, v72
v_fma_f32 v83, v83, v73, v72
v_mul_f32 v76, v76, v188
v_mul_f32 v77, v77, v189
v_mul_f32 v78, v78, v190
v_mul_f32 v79, v79, v191
v_mul_f32 v80, v80, v220
v_mul_f32 v81, v81, v221
v_mul_f32 v82, v82, v222
v_mul_f32 v83, v83, v223
v_exp_f32 v76, v76
v_exp_f32 v77, v77
v_exp_f32 v78, v78
v_exp_f32 v79, v79
s_add_u32 m0, s39, 33792
s_nop 0
buffer_load_dwordx4 v24, s[28:31], s38 offen lds
v_exp_f32 v80, v80
v_exp_f32 v81, v81
v_exp_f32 v82, v82
v_exp_f32 v83, v83
v_fma_f32 v204, -v64, v44, v204
v_fma_f32 v205, -v64, v45, v205
v_fma_f32 v206, -v64, v46, v206
v_fma_f32 v207, -v64, v47, v207
v_fma_f32 v236, -v66, v44, v236
v_fma_f32 v237, -v66, v45, v237
v_fma_f32 v238, -v66, v46, v238
v_fma_f32 v239, -v66, v47, v239
v_fma_f32 v76, v76, v70, v70
v_fma_f32 v77, v77, v70, v70
v_fma_f32 v78, v78, v70, v70
v_fma_f32 v79, v79, v70, v70
v_fma_f32 v80, v80, v74, v74
v_fma_f32 v81, v81, v74, v74
v_fma_f32 v82, v82, v74, v74
v_fma_f32 v83, v83, v74, v74
v_rcp_f32 v76, v76
v_rcp_f32 v77, v77
v_rcp_f32 v78, v78
v_rcp_f32 v79, v79
s_add_u32 m0, s39, 34816
s_add_u32 s38, s38, 16384
buffer_load_dwordx4 v23, s[28:31], s38 offen lds
s_add_u32 m0, s39, 35840
s_nop 0
buffer_load_dwordx4 v24, s[28:31], s38 offen lds
s_waitcnt vmcnt(18)
s_barrier
s_add_u32 s37, s52, 655360
s_add_u32 m0, s39, 49152
s_nop 0
buffer_load_dwordx4 v3, s[24:27], s37 offen sc1 lds
v_rcp_f32 v80, v80
v_rcp_f32 v81, v81
v_rcp_f32 v82, v82
v_rcp_f32 v83, v83
v_mul_f32 v204, v188, v204
v_mul_f32 v205, v189, v205
v_mul_f32 v206, v190, v206
v_mul_f32 v207, v191, v207
v_mul_f32 v236, v220, v236
v_mul_f32 v237, v221, v237
v_mul_f32 v238, v222, v238
v_mul_f32 v239, v223, v239
v_mul_f32 v204, v204, v76
v_mul_f32 v205, v205, v77
v_mul_f32 v206, v206, v78
v_mul_f32 v207, v207, v79
v_mul_f32 v236, v236, v80
v_mul_f32 v237, v237, v81
v_mul_f32 v238, v238, v82
v_mul_f32 v239, v239, v83
v_cvt_pk_bf16_f32 v188, v204, v205
v_cvt_pk_bf16_f32 v189, v206, v207
v_cvt_pk_bf16_f32 v220, v236, v237
buffer_load_dwordx4 v3, s[24:27], s37 offen offset:1024 sc1 lds
v_cvt_pk_bf16_f32 v221, v238, v239
v_fma_f32 v192, -v64, v32, v192
v_fma_f32 v193, -v64, v33, v193
v_fma_f32 v194, -v64, v34, v194
v_fma_f32 v195, -v64, v35, v195
v_fma_f32 v224, -v66, v32, v224
v_fma_f32 v225, -v66, v33, v225
v_fma_f32 v226, -v66, v34, v226
v_fma_f32 v227, -v66, v35, v227
v_mul_f32 v76, v192, v192
v_mul_f32 v77, v193, v193
v_mul_f32 v78, v194, v194
v_mul_f32 v79, v195, v195
v_mul_f32 v80, v224, v224
v_mul_f32 v81, v225, v225
v_mul_f32 v82, v226, v226
v_mul_f32 v83, v227, v227
v_fma_f32 v76, v76, v69, v68
v_fma_f32 v77, v77, v69, v68
v_fma_f32 v78, v78, v69, v68
v_fma_f32 v79, v79, v69, v68
v_fma_f32 v80, v80, v73, v72
v_fma_f32 v81, v81, v73, v72
buffer_load_dwordx4 v3, s[24:27], s37 offen offset:2048 sc1 lds
v_fma_f32 v82, v82, v73, v72
v_fma_f32 v83, v83, v73, v72
v_mul_f32 v76, v76, v192
v_mul_f32 v77, v77, v193
v_mul_f32 v78, v78, v194
v_mul_f32 v79, v79, v195
v_mul_f32 v80, v80, v224
v_mul_f32 v81, v81, v225
v_mul_f32 v82, v82, v226
v_mul_f32 v83, v83, v227
v_exp_f32 v76, v76
v_exp_f32 v77, v77
v_exp_f32 v78, v78
v_exp_f32 v79, v79
v_exp_f32 v80, v80
v_exp_f32 v81, v81
v_exp_f32 v82, v82
v_exp_f32 v83, v83
v_fma_f32 v208, -v64, v48, v208
v_fma_f32 v209, -v64, v49, v209
v_fma_f32 v210, -v64, v50, v210
v_fma_f32 v211, -v64, v51, v211
v_fma_f32 v240, -v66, v48, v240
v_fma_f32 v241, -v66, v49, v241
buffer_load_dwordx4 v3, s[24:27], s37 offen offset:3072 sc1 lds
v_fma_f32 v242, -v66, v50, v242
v_fma_f32 v243, -v66, v51, v243
v_fma_f32 v76, v76, v70, v70
v_fma_f32 v77, v77, v70, v70
v_fma_f32 v78, v78, v70, v70
v_fma_f32 v79, v79, v70, v70
v_fma_f32 v80, v80, v74, v74
v_fma_f32 v81, v81, v74, v74
v_fma_f32 v82, v82, v74, v74
v_fma_f32 v83, v83, v74, v74
v_rcp_f32 v76, v76
v_rcp_f32 v77, v77
v_rcp_f32 v78, v78
v_rcp_f32 v79, v79
v_rcp_f32 v80, v80
v_rcp_f32 v81, v81
v_rcp_f32 v82, v82
v_rcp_f32 v83, v83
v_mul_f32 v208, v192, v208
v_mul_f32 v209, v193, v209
v_mul_f32 v210, v194, v210
v_mul_f32 v211, v195, v211
v_mul_f32 v240, v224, v240
s_add_u32 s38, s53, 5242880
s_add_u32 m0, s39, 65536
s_nop 0
buffer_load_dwordx4 v23, s[28:31], s38 offen lds
v_mul_f32 v241, v225, v241
v_mul_f32 v242, v226, v242
v_mul_f32 v243, v227, v243
v_mul_f32 v208, v208, v76
v_mul_f32 v209, v209, v77
v_mul_f32 v210, v210, v78
v_mul_f32 v211, v211, v79
v_mul_f32 v240, v240, v80
v_mul_f32 v241, v241, v81
v_mul_f32 v242, v242, v82
v_mul_f32 v243, v243, v83
v_cvt_pk_bf16_f32 v190, v208, v209
v_cvt_pk_bf16_f32 v191, v210, v211
v_cvt_pk_bf16_f32 v222, v240, v241
v_cvt_pk_bf16_f32 v223, v242, v243
buffer_store_dwordx4 v[188:191], v2, s[24:27], s54 offen offset:2048 sc1
buffer_store_dwordx4 v[220:223], v2, s[24:27], s54 offen offset:3072 sc1
v_fma_f32 v196, -v64, v36, v196
v_fma_f32 v197, -v64, v37, v197
v_fma_f32 v198, -v64, v38, v198
v_fma_f32 v199, -v64, v39, v199
v_fma_f32 v228, -v66, v36, v228
v_fma_f32 v229, -v66, v37, v229
s_add_u32 m0, s39, 66560
s_nop 0
buffer_load_dwordx4 v24, s[28:31], s38 offen lds
v_fma_f32 v230, -v66, v38, v230
s_branch Lov_17
.p2align 12
.fill 128, 4, 0xbf800000
Lst_17_0:
s_branch Lwr_170
s_nop 0
s_nop 0
Lov_17:
v_fma_f32 v231, -v66, v39, v231
v_mul_f32 v76, v196, v196
v_mul_f32 v77, v197, v197
v_mul_f32 v78, v198, v198
v_mul_f32 v79, v199, v199
v_mul_f32 v80, v228, v228
v_mul_f32 v81, v229, v229
v_mul_f32 v82, v230, v230
v_mul_f32 v83, v231, v231
v_fma_f32 v76, v76, v69, v68
v_fma_f32 v77, v77, v69, v68
v_fma_f32 v78, v78, v69, v68
v_fma_f32 v79, v79, v69, v68
v_fma_f32 v80, v80, v73, v72
v_fma_f32 v81, v81, v73, v72
v_fma_f32 v82, v82, v73, v72
v_fma_f32 v83, v83, v73, v72
v_mul_f32 v76, v76, v196
v_mul_f32 v77, v77, v197
v_mul_f32 v78, v78, v198
v_mul_f32 v79, v79, v199
v_mul_f32 v80, v80, v228
v_mul_f32 v81, v81, v229
s_add_u32 m0, s39, 67584
s_add_u32 s38, s38, 16384
buffer_load_dwordx4 v23, s[28:31], s38 offen lds
s_add_u32 m0, s39, 68608
s_nop 0
buffer_load_dwordx4 v24, s[28:31], s38 offen lds
s_waitcnt vmcnt(34)
s_barrier
s_add_u32 s37, s52, 671744
s_add_u32 m0, s39, 81920
s_nop 0
buffer_load_dwordx4 v3, s[24:27], s37 offen sc1 lds
v_mul_f32 v82, v82, v230
v_mul_f32 v83, v83, v231
v_exp_f32 v76, v76
v_exp_f32 v77, v77
v_exp_f32 v78, v78
v_exp_f32 v79, v79
v_exp_f32 v80, v80
v_exp_f32 v81, v81
v_exp_f32 v82, v82
v_exp_f32 v83, v83
v_fma_f32 v212, -v64, v52, v212
v_fma_f32 v213, -v64, v53, v213
v_fma_f32 v214, -v64, v54, v214
v_fma_f32 v215, -v64, v55, v215
v_fma_f32 v244, -v66, v52, v244
v_fma_f32 v245, -v66, v53, v245
v_fma_f32 v246, -v66, v54, v246
v_fma_f32 v247, -v66, v55, v247
v_fma_f32 v76, v76, v70, v70
v_fma_f32 v77, v77, v70, v70
v_fma_f32 v78, v78, v70, v70
v_fma_f32 v79, v79, v70, v70
v_fma_f32 v80, v80, v74, v74
buffer_load_dwordx4 v3, s[24:27], s37 offen offset:1024 sc1 lds
v_fma_f32 v81, v81, v74, v74
v_fma_f32 v82, v82, v74, v74
v_fma_f32 v83, v83, v74, v74
v_rcp_f32 v76, v76
v_rcp_f32 v77, v77
v_rcp_f32 v78, v78
v_rcp_f32 v79, v79
v_rcp_f32 v80, v80
v_rcp_f32 v81, v81
v_rcp_f32 v82, v82
v_rcp_f32 v83, v83
v_mul_f32 v212, v196, v212
v_mul_f32 v213, v197, v213
v_mul_f32 v214, v198, v214
v_mul_f32 v215, v199, v215
v_mul_f32 v244, v228, v244
v_mul_f32 v245, v229, v245
v_mul_f32 v246, v230, v246
v_mul_f32 v247, v231, v247
v_mul_f32 v212, v212, v76
v_mul_f32 v213, v213, v77
v_mul_f32 v214, v214, v78
v_mul_f32 v215, v215, v79
buffer_load_dwordx4 v3, s[24:27], s37 offen offset:2048 sc1 lds
v_mul_f32 v244, v244, v80
v_mul_f32 v245, v245, v81
v_mul_f32 v246, v246, v82
v_mul_f32 v247, v247, v83
v_cvt_pk_bf16_f32 v196, v212, v213
v_cvt_pk_bf16_f32 v197, v214, v215
v_cvt_pk_bf16_f32 v228, v244, v245
v_cvt_pk_bf16_f32 v229, v246, v247
v_fma_f32 v200, -v64, v40, v200
v_fma_f32 v201, -v64, v41, v201
v_fma_f32 v202, -v64, v42, v202
v_fma_f32 v203, -v64, v43, v203
v_fma_f32 v232, -v66, v40, v232
v_fma_f32 v233, -v66, v41, v233
v_fma_f32 v234, -v66, v42, v234
v_fma_f32 v235, -v66, v43, v235
v_mul_f32 v76, v200, v200
v_mul_f32 v77, v201, v201
v_mul_f32 v78, v202, v202
v_mul_f32 v79, v203, v203
v_mul_f32 v80, v232, v232
v_mul_f32 v81, v233, v233
v_mul_f32 v82, v234, v234
v_mul_f32 v83, v235, v235
buffer_load_dwordx4 v3, s[24:27], s37 offen offset:3072 sc1 lds
v_fma_f32 v76, v76, v69, v68
v_fma_f32 v77, v77, v69, v68
v_fma_f32 v78, v78, v69, v68
v_fma_f32 v79, v79, v69, v68
v_fma_f32 v80, v80, v73, v72
v_fma_f32 v81, v81, v73, v72
v_fma_f32 v82, v82, v73, v72
v_fma_f32 v83, v83, v73, v72
v_mul_f32 v76, v76, v200
v_mul_f32 v77, v77, v201
v_mul_f32 v78, v78, v202
v_mul_f32 v79, v79, v203
v_mul_f32 v80, v80, v232
v_mul_f32 v81, v81, v233
v_mul_f32 v82, v82, v234
v_mul_f32 v83, v83, v235
v_exp_f32 v76, v76
v_exp_f32 v77, v77
v_exp_f32 v78, v78
v_exp_f32 v79, v79
v_exp_f32 v80, v80
v_exp_f32 v81, v81
v_exp_f32 v82, v82
s_add_u32 s38, s53, 5373952
s_add_u32 m0, s39, 147456
s_nop 0
buffer_load_dwordx4 v23, s[28:31], s38 offen lds
v_exp_f32 v83, v83
v_fma_f32 v216, -v64, v56, v216
v_fma_f32 v217, -v64, v57, v217
v_fma_f32 v218, -v64, v58, v218
v_fma_f32 v219, -v64, v59, v219
v_fma_f32 v248, -v66, v56, v248
v_fma_f32 v249, -v66, v57, v249
v_fma_f32 v250, -v66, v58, v250
v_fma_f32 v251, -v66, v59, v251
v_fma_f32 v76, v76, v70, v70
v_fma_f32 v77, v77, v70, v70
v_fma_f32 v78, v78, v70, v70
v_fma_f32 v79, v79, v70, v70
v_fma_f32 v80, v80, v74, v74
v_fma_f32 v81, v81, v74, v74
v_fma_f32 v82, v82, v74, v74
v_fma_f32 v83, v83, v74, v74
v_rcp_f32 v76, v76
v_rcp_f32 v77, v77
v_rcp_f32 v78, v78
v_rcp_f32 v79, v79
v_rcp_f32 v80, v80
v_rcp_f32 v81, v81
s_add_u32 m0, s39, 148480
s_nop 0
buffer_load_dwordx4 v24, s[28:31], s38 offen lds
v_rcp_f32 v82, v82
v_rcp_f32 v83, v83
v_mul_f32 v216, v200, v216
v_mul_f32 v217, v201, v217
v_mul_f32 v218, v202, v218
v_mul_f32 v219, v203, v219
v_mul_f32 v248, v232, v248
v_mul_f32 v249, v233, v249
v_mul_f32 v250, v234, v250
v_mul_f32 v251, v235, v251
v_mul_f32 v216, v216, v76
v_mul_f32 v217, v217, v77
v_mul_f32 v218, v218, v78
v_mul_f32 v219, v219, v79
v_mul_f32 v248, v248, v80
v_mul_f32 v249, v249, v81
v_mul_f32 v250, v250, v82
v_mul_f32 v251, v251, v83
v_cvt_pk_bf16_f32 v198, v216, v217
v_cvt_pk_bf16_f32 v199, v218, v219
v_cvt_pk_bf16_f32 v230, v248, v249
v_cvt_pk_bf16_f32 v231, v250, v251
buffer_store_dwordx4 v[196:199], v2, s[24:27], s55 offen offset:2048 sc1
buffer_store_dwordx4 v[228:231], v2, s[24:27], s55 offen offset:3072 sc1
s_add_u32 m0, s39, 149504
s_add_u32 s38, s38, 16384
buffer_load_dwordx4 v23, s[28:31], s38 offen lds
s_add_u32 m0, s39, 150528
s_nop 0
buffer_load_dwordx4 v24, s[28:31], s38 offen lds
s_waitcnt vmcnt(30)
s_barrier
s_add_u32 s37, s52, 688128
s_add_u32 m0, s39, 98304
s_nop 0
buffer_load_dwordx4 v3, s[24:27], s37 offen sc1 lds
buffer_load_dwordx4 v3, s[24:27], s37 offen offset:1024 sc1 lds
buffer_load_dwordx4 v3, s[24:27], s37 offen offset:2048 sc1 lds
buffer_load_dwordx4 v3, s[24:27], s37 offen offset:3072 sc1 lds
s_add_u32 s38, s53, 5505024
s_add_u32 m0, s39, 114688
s_nop 0
buffer_load_dwordx4 v23, s[28:31], s38 offen lds
s_add_u32 m0, s39, 115712
s_nop 0
buffer_load_dwordx4 v24, s[28:31], s38 offen lds
s_add_u32 m0, s39, 116736
s_add_u32 s38, s38, 16384
buffer_load_dwordx4 v23, s[28:31], s38 offen lds
s_add_u32 m0, s39, 117760
s_nop 0
buffer_load_dwordx4 v24, s[28:31], s38 offen lds
s_waitcnt vmcnt(10)
s_barrier
s_cmp_eq_u32 s47, 0
s_cbranch_scc0 Lw_133
s_add_u32 s7, s34, 48
s_lshl_b32 s7, s7, 7
v_mov_b32 v26, s7
v_mov_b32 v27, 1
s_mov_b64 exec, 1
buffer_atomic_add v27, v26, s[56:59], 0 offen sc1
s_mov_b64 exec, -1
Lw_133:
s_add_u32 s37, s52, 704512
s_add_u32 m0, s39, 131072
s_nop 0
buffer_load_dwordx4 v3, s[24:27], s37 offen sc1 lds
buffer_load_dwordx4 v3, s[24:27], s37 offen offset:1024 sc1 lds
buffer_load_dwordx4 v3, s[24:27], s37 offen offset:2048 sc1 lds
buffer_load_dwordx4 v3, s[24:27], s37 offen offset:3072 sc1 lds
s_add_u32 s38, s53, 5636096
s_add_u32 m0, s39, 0
s_nop 0
buffer_load_dwordx4 v23, s[28:31], s38 offen lds
s_add_u32 m0, s39, 1024
s_nop 0
buffer_load_dwordx4 v24, s[28:31], s38 offen lds
s_add_u32 m0, s39, 2048
s_add_u32 s38, s38, 16384
buffer_load_dwordx4 v23, s[28:31], s38 offen lds
s_add_u32 m0, s39, 3072
s_nop 0
buffer_load_dwordx4 v24, s[28:31], s38 offen lds
s_waitcnt vmcnt(26)
s_barrier
s_add_u32 s38, s91, 0
s_add_u32 m0, s39, 32768
s_nop 0
buffer_load_dwordx4 v23, s[28:31], s38 offen lds
s_add_u32 m0, s39, 33792
s_nop 0
buffer_load_dwordx4 v24, s[28:31], s38 offen lds
s_add_u32 m0, s39, 34816
s_add_u32 s38, s38, 16384
buffer_load_dwordx4 v23, s[28:31], s38 offen lds
s_add_u32 m0, s39, 35840
s_nop 0
buffer_load_dwordx4 v24, s[28:31], s38 offen lds
s_waitcnt vmcnt(20)
s_barrier
s_add_u32 s38, s91, 131072
s_add_u32 m0, s39, 65536
s_nop 0
buffer_load_dwordx4 v23, s[28:31], s38 offen lds
s_add_u32 m0, s39, 66560
s_nop 0
buffer_load_dwordx4 v24, s[28:31], s38 offen lds
s_add_u32 m0, s39, 67584
s_add_u32 s38, s38, 16384
buffer_load_dwordx4 v23, s[28:31], s38 offen lds
s_add_u32 m0, s39, 68608
s_nop 0
buffer_load_dwordx4 v24, s[28:31], s38 offen lds
s_waitcnt vmcnt(16)
s_barrier
s_cmp_eq_u32 s47, 3
s_cbranch_scc0 Lw_134
s_lshl_b32 s92, s34, 7
s_add_u32 s92, s92, 28317696
s_load_dword s93, s[82:83], s92 glc
Lw_134:
s_add_u32 s38, s91, 262144
s_add_u32 m0, s39, 147456
s_nop 0
buffer_load_dwordx4 v23, s[28:31], s38 offen lds
s_add_u32 m0, s39, 148480
s_nop 0
buffer_load_dwordx4 v24, s[28:31], s38 offen lds
s_add_u32 m0, s39, 149504
s_add_u32 s38, s38, 16384
buffer_load_dwordx4 v23, s[28:31], s38 offen lds
s_add_u32 m0, s39, 150528
s_nop 0
buffer_load_dwordx4 v24, s[28:31], s38 offen lds
s_waitcnt vmcnt(12)
s_cmp_eq_u32 s47, 3
s_cbranch_scc0 Lw_135
s_mov_b32 s41, 0x40000
s_branch Lpchk_138
Lpoll_136:
s_load_dword s93, s[82:83], s92 glc
Lpchk_138:
s_waitcnt lgkmcnt(0)
s_cmp_eq_u32 s93, 16
s_cbranch_scc1 Lpok_137
s_sub_u32 s41, s41, 1
s_cmp_lg_u32 s41, 0
s_cbranch_scc1 Lpoll_136
Lpok_137:
Lw_135:
s_barrier
s_add_u32 s37, s90, 0
s_add_u32 m0, s39, 16384
s_nop 0
buffer_load_dwordx4 v3, s[24:27], s37 offen sc1 lds
buffer_load_dwordx4 v3, s[24:27], s37 offen offset:1024 sc1 lds
buffer_load_dwordx4 v3, s[24:27], s37 offen offset:2048 sc1 lds
buffer_load_dwordx4 v3, s[24:27], s37 offen offset:3072 sc1 lds
s_add_u32 s37, s90, 16384
s_add_u32 m0, s39, 49152
s_nop 0
buffer_load_dwordx4 v3, s[24:27], s37 offen sc1 lds
buffer_load_dwordx4 v3, s[24:27], s37 offen offset:1024 sc1 lds
buffer_load_dwordx4 v3, s[24:27], s37 offen offset:2048 sc1 lds
buffer_load_dwordx4 v3, s[24:27], s37 offen offset:3072 sc1 lds
s_add_u32 s37, s90, 32768
s_add_u32 m0, s39, 81920
s_nop 0
buffer_load_dwordx4 v3, s[24:27], s37 offen sc1 lds
buffer_load_dwordx4 v3, s[24:27], s37 offen offset:1024 sc1 lds
buffer_load_dwordx4 v3, s[24:27], s37 offen offset:2048 sc1 lds
buffer_load_dwordx4 v3, s[24:27], s37 offen offset:3072 sc1 lds
s_add_u32 s37, s90, 49152
s_add_u32 m0, s39, 98304
s_nop 0
buffer_load_dwordx4 v3, s[24:27], s37 offen sc1 lds
buffer_load_dwordx4 v3, s[24:27], s37 offen offset:1024 sc1 lds
buffer_load_dwordx4 v3, s[24:27], s37 offen offset:2048 sc1 lds
buffer_load_dwordx4 v3, s[24:27], s37 offen offset:3072 sc1 lds
s_add_u32 s38, s91, 393216
s_add_u32 m0, s39, 114688
s_nop 0
buffer_load_dwordx4 v23, s[28:31], s38 offen lds
s_add_u32 m0, s39, 115712
s_nop 0
buffer_load_dwordx4 v24, s[28:31], s38 offen lds
s_add_u32 m0, s39, 116736
s_add_u32 s38, s38, 16384
buffer_load_dwordx4 v23, s[28:31], s38 offen lds
s_add_u32 m0, s39, 117760
s_nop 0
buffer_load_dwordx4 v24, s[28:31], s38 offen lds
s_waitcnt vmcnt(16)
s_barrier
s_add_u32 s37, s90, 65536
s_add_u32 m0, s39, 131072
s_nop 0
buffer_load_dwordx4 v3, s[24:27], s37 offen sc1 lds
buffer_load_dwordx4 v3, s[24:27], s37 offen offset:1024 sc1 lds
buffer_load_dwordx4 v3, s[24:27], s37 offen offset:2048 sc1 lds
buffer_load_dwordx4 v3, s[24:27], s37 offen offset:3072 sc1 lds
s_add_u32 s38, s91, 524288
s_add_u32 m0, s39, 0
s_nop 0
buffer_load_dwordx4 v23, s[28:31], s38 offen lds
s_add_u32 m0, s39, 1024
s_nop 0
buffer_load_dwordx4 v24, s[28:31], s38 offen lds
s_add_u32 m0, s39, 2048
s_add_u32 s38, s38, 16384
buffer_load_dwordx4 v23, s[28:31], s38 offen lds
s_add_u32 m0, s39, 3072
s_nop 0
buffer_load_dwordx4 v24, s[28:31], s38 offen lds
s_waitcnt vmcnt(20)
s_barrier
s_add_u32 s37, s90, 81920
s_add_u32 m0, s39, 16384
s_nop 0
buffer_load_dwordx4 v3, s[24:27], s37 offen sc1 lds
buffer_load_dwordx4 v3, s[24:27], s37 offen offset:1024 sc1 lds
buffer_load_dwordx4 v3, s[24:27], s37 offen offset:2048 sc1 lds
buffer_load_dwordx4 v3, s[24:27], s37 offen offset:3072 sc1 lds
s_add_u32 s38, s91, 655360
s_add_u32 m0, s39, 32768
s_nop 0
buffer_load_dwordx4 v23, s[28:31], s38 offen lds
s_add_u32 m0, s39, 33792
s_nop 0
buffer_load_dwordx4 v24, s[28:31], s38 offen lds
s_add_u32 m0, s39, 34816
s_add_u32 s38, s38, 16384
buffer_load_dwordx4 v23, s[28:31], s38 offen lds
s_add_u32 m0, s39, 35840
s_nop 0
buffer_load_dwordx4 v24, s[28:31], s38 offen lds
s_waitcnt vmcnt(24)
s_barrier
s_add_u32 s37, s90, 98304
s_add_u32 m0, s39, 49152
s_nop 0
buffer_load_dwordx4 v3, s[24:27], s37 offen sc1 lds
buffer_load_dwordx4 v3, s[24:27], s37 offen offset:1024 sc1 lds
buffer_load_dwordx4 v3, s[24:27], s37 offen offset:2048 sc1 lds
buffer_load_dwordx4 v3, s[24:27], s37 offen offset:3072 sc1 lds
s_add_u32 s38, s91, 786432
s_add_u32 m0, s39, 65536
s_nop 0
buffer_load_dwordx4 v23, s[28:31], s38 offen lds
s_add_u32 m0, s39, 66560
s_nop 0
buffer_load_dwordx4 v24, s[28:31], s38 offen lds
s_add_u32 m0, s39, 67584
s_add_u32 s38, s38, 16384
buffer_load_dwordx4 v23, s[28:31], s38 offen lds
s_add_u32 m0, s39, 68608
s_nop 0
buffer_load_dwordx4 v24, s[28:31], s38 offen lds
s_waitcnt vmcnt(24)
s_barrier
s_add_u32 s37, s90, 114688
s_add_u32 m0, s39, 81920
s_nop 0
buffer_load_dwordx4 v3, s[24:27], s37 offen sc1 lds
buffer_load_dwordx4 v3, s[24:27], s37 offen offset:1024 sc1 lds
buffer_load_dwordx4 v3, s[24:27], s37 offen offset:2048 sc1 lds
buffer_load_dwordx4 v3, s[24:27], s37 offen offset:3072 sc1 lds
s_add_u32 s38, s91, 917504
s_add_u32 m0, s39, 147456
s_nop 0
buffer_load_dwordx4 v23, s[28:31], s38 offen lds
s_add_u32 m0, s39, 148480
s_nop 0
buffer_load_dwordx4 v24, s[28:31], s38 offen lds
s_add_u32 m0, s39, 149504
s_add_u32 s38, s38, 16384
buffer_load_dwordx4 v23, s[28:31], s38 offen lds
s_add_u32 m0, s39, 150528
s_nop 0
buffer_load_dwordx4 v24, s[28:31], s38 offen lds
s_waitcnt vmcnt(24)
s_barrier
s_add_u32 s37, s90, 131072
s_add_u32 m0, s39, 98304
s_nop 0
buffer_load_dwordx4 v3, s[24:27], s37 offen sc1 lds
buffer_load_dwordx4 v3, s[24:27], s37 offen offset:1024 sc1 lds
buffer_load_dwordx4 v3, s[24:27], s37 offen offset:2048 sc1 lds
buffer_load_dwordx4 v3, s[24:27], s37 offen offset:3072 sc1 lds
s_add_u32 s38, s91, 1048576
s_add_u32 m0, s39, 114688
s_nop 0
buffer_load_dwordx4 v23, s[28:31], s38 offen lds
s_add_u32 m0, s39, 115712
s_nop 0
buffer_load_dwordx4 v24, s[28:31], s38 offen lds
s_add_u32 m0, s39, 116736
s_add_u32 s38, s38, 16384
buffer_load_dwordx4 v23, s[28:31], s38 offen lds
s_add_u32 m0, s39, 117760
s_nop 0
buffer_load_dwordx4 v24, s[28:31], s38 offen lds
s_waitcnt vmcnt(24)
s_barrier
s_add_u32 s37, s90, 147456
s_add_u32 m0, s39, 131072
s_nop 0
buffer_load_dwordx4 v3, s[24:27], s37 offen sc1 lds
buffer_load_dwordx4 v3, s[24:27], s37 offen offset:1024 sc1 lds
buffer_load_dwordx4 v3, s[24:27], s37 offen offset:2048 sc1 lds
buffer_load_dwordx4 v3, s[24:27], s37 offen offset:3072 sc1 lds
s_add_u32 s38, s91, 1179648
s_add_u32 m0, s39, 0
s_nop 0
buffer_load_dwordx4 v23, s[28:31], s38 offen lds
s_add_u32 m0, s39, 1024
s_nop 0
buffer_load_dwordx4 v24, s[28:31], s38 offen lds
s_add_u32 m0, s39, 2048
s_add_u32 s38, s38, 16384
buffer_load_dwordx4 v23, s[28:31], s38 offen lds
s_add_u32 m0, s39, 3072
s_nop 0
buffer_load_dwordx4 v24, s[28:31], s38 offen lds
s_waitcnt vmcnt(24)
s_barrier
s_mov_b32 s37, 327680
s_add_u32 m0, s39, 16384
s_nop 0
buffer_load_dwordx4 v3, s[24:27], s37 offen sc1 lds
buffer_load_dwordx4 v3, s[24:27], s37 offen offset:1024 sc1 lds
buffer_load_dwordx4 v3, s[24:27], s37 offen offset:2048 sc1 lds
buffer_load_dwordx4 v3, s[24:27], s37 offen offset:3072 sc1 lds
s_mov_b32 s38, 2621440
s_add_u32 m0, s51, 32768
s_nop 0
buffer_load_dwordx4 v25, s[28:31], s38 offen lds
s_add_u32 m0, s51, 33792
s_add_u32 s38, s38, 16384
buffer_load_dwordx4 v25, s[28:31], s38 offen lds
s_waitcnt vmcnt(22)
s_barrier
s_mov_b32 s37, 344064
s_add_u32 m0, s39, 49152
s_nop 0
buffer_load_dwordx4 v3, s[24:27], s37 offen sc1 lds
buffer_load_dwordx4 v3, s[24:27], s37 offen offset:1024 sc1 lds
buffer_load_dwordx4 v3, s[24:27], s37 offen offset:2048 sc1 lds
buffer_load_dwordx4 v3, s[24:27], s37 offen offset:3072 sc1 lds
s_mov_b32 s38, 2752512
s_add_u32 m0, s51, 65536
s_nop 0
buffer_load_dwordx4 v25, s[28:31], s38 offen lds
s_add_u32 m0, s51, 66560
s_add_u32 s38, s38, 16384
buffer_load_dwordx4 v25, s[28:31], s38 offen lds
s_waitcnt vmcnt(20)
s_barrier
s_mov_b32 s37, 360448
s_add_u32 m0, s39, 81920
s_nop 0
buffer_load_dwordx4 v3, s[24:27], s37 offen sc1 lds
buffer_load_dwordx4 v3, s[24:27], s37 offen offset:1024 sc1 lds
buffer_load_dwordx4 v3, s[24:27], s37 offen offset:2048 sc1 lds
buffer_load_dwordx4 v3, s[24:27], s37 offen offset:3072 sc1 lds
s_mov_b32 s38, 2883584
s_add_u32 m0, s51, 147456
s_nop 0
buffer_load_dwordx4 v25, s[28:31], s38 offen lds
s_add_u32 m0, s51, 148480
s_add_u32 s38, s38, 16384
buffer_load_dwordx4 v25, s[28:31], s38 offen lds
s_waitcnt vmcnt(18)
s_barrier
s_mov_b32 s37, 376832
s_add_u32 m0, s39, 98304
s_nop 0
buffer_load_dwordx4 v3, s[24:27], s37 offen sc1 lds
buffer_load_dwordx4 v3, s[24:27], s37 offen offset:1024 sc1 lds
buffer_load_dwordx4 v3, s[24:27], s37 offen offset:2048 sc1 lds
buffer_load_dwordx4 v3, s[24:27], s37 offen offset:3072 sc1 lds
s_mov_b32 s38, 3014656
s_add_u32 m0, s51, 114688
s_nop 0
buffer_load_dwordx4 v25, s[28:31], s38 offen lds
s_add_u32 m0, s51, 115712
s_add_u32 s38, s38, 16384
buffer_load_dwordx4 v25, s[28:31], s38 offen lds
s_waitcnt vmcnt(18)
s_barrier
s_mov_b32 s37, 393216
s_add_u32 m0, s39, 131072
s_nop 0
buffer_load_dwordx4 v3, s[24:27], s37 offen sc1 lds
buffer_load_dwordx4 v3, s[24:27], s37 offen offset:1024 sc1 lds
buffer_load_dwordx4 v3, s[24:27], s37 offen offset:2048 sc1 lds
buffer_load_dwordx4 v3, s[24:27], s37 offen offset:3072 sc1 lds
s_mov_b32 s38, 3145728
s_add_u32 m0, s51, 0
s_nop 0
s_branch Lov_18
.p2align 12
.fill 144, 4, 0xbf800000
Lst_18_0:
s_branch Lwr_171
s_nop 0
s_nop 0
Lov_18:
buffer_load_dwordx4 v25, s[28:31], s38 offen lds
s_add_u32 m0, s51, 1024
s_add_u32 s38, s38, 16384
buffer_load_dwordx4 v25, s[28:31], s38 offen lds
s_waitcnt vmcnt(18)
s_barrier
s_mov_b32 s37, 409600
s_add_u32 m0, s39, 16384
s_nop 0
buffer_load_dwordx4 v3, s[24:27], s37 offen sc1 lds
buffer_load_dwordx4 v3, s[24:27], s37 offen offset:1024 sc1 lds
buffer_load_dwordx4 v3, s[24:27], s37 offen offset:2048 sc1 lds
buffer_load_dwordx4 v3, s[24:27], s37 offen offset:3072 sc1 lds
s_mov_b32 s38, 3276800
s_add_u32 m0, s51, 32768
s_nop 0
buffer_load_dwordx4 v25, s[28:31], s38 offen lds
s_add_u32 m0, s51, 33792
s_add_u32 s38, s38, 16384
buffer_load_dwordx4 v25, s[28:31], s38 offen lds
s_waitcnt vmcnt(18)
s_barrier
s_mov_b32 s37, 425984
s_add_u32 m0, s39, 49152
s_nop 0
buffer_load_dwordx4 v3, s[24:27], s37 offen sc1 lds
buffer_load_dwordx4 v3, s[24:27], s37 offen offset:1024 sc1 lds
buffer_load_dwordx4 v3, s[24:27], s37 offen offset:2048 sc1 lds
buffer_load_dwordx4 v3, s[24:27], s37 offen offset:3072 sc1 lds
s_mov_b32 s38, 3407872
s_add_u32 m0, s51, 65536
s_nop 0
buffer_load_dwordx4 v25, s[28:31], s38 offen lds
s_add_u32 m0, s51, 66560
s_add_u32 s38, s38, 16384
buffer_load_dwordx4 v25, s[28:31], s38 offen lds
s_waitcnt vmcnt(18)
s_barrier
s_mov_b32 s37, 442368
s_add_u32 m0, s39, 81920
s_nop 0
buffer_load_dwordx4 v3, s[24:27], s37 offen sc1 lds
buffer_load_dwordx4 v3, s[24:27], s37 offen offset:1024 sc1 lds
buffer_load_dwordx4 v3, s[24:27], s37 offen offset:2048 sc1 lds
buffer_load_dwordx4 v3, s[24:27], s37 offen offset:3072 sc1 lds
s_mov_b32 s38, 3538944
s_add_u32 m0, s51, 147456
s_nop 0
buffer_load_dwordx4 v25, s[28:31], s38 offen lds
s_add_u32 m0, s51, 148480
s_add_u32 s38, s38, 16384
buffer_load_dwordx4 v25, s[28:31], s38 offen lds
s_waitcnt vmcnt(18)
s_barrier
s_mov_b32 s37, 458752
s_add_u32 m0, s39, 98304
s_nop 0
buffer_load_dwordx4 v3, s[24:27], s37 offen sc1 lds
buffer_load_dwordx4 v3, s[24:27], s37 offen offset:1024 sc1 lds
buffer_load_dwordx4 v3, s[24:27], s37 offen offset:2048 sc1 lds
buffer_load_dwordx4 v3, s[24:27], s37 offen offset:3072 sc1 lds
s_mov_b32 s38, 3670016
s_add_u32 m0, s51, 114688
s_nop 0
buffer_load_dwordx4 v25, s[28:31], s38 offen lds
s_add_u32 m0, s51, 115712
s_add_u32 s38, s38, 16384
buffer_load_dwordx4 v25, s[28:31], s38 offen lds
s_waitcnt vmcnt(18)
s_barrier
s_mov_b32 s37, 475136
s_add_u32 m0, s39, 131072
s_nop 0
buffer_load_dwordx4 v3, s[24:27], s37 offen sc1 lds
buffer_load_dwordx4 v3, s[24:27], s37 offen offset:1024 sc1 lds
buffer_load_dwordx4 v3, s[24:27], s37 offen offset:2048 sc1 lds
buffer_load_dwordx4 v3, s[24:27], s37 offen offset:3072 sc1 lds
s_mov_b32 s38, 3801088
s_add_u32 m0, s51, 0
s_nop 0
buffer_load_dwordx4 v25, s[28:31], s38 offen lds
s_add_u32 m0, s51, 1024
s_add_u32 s38, s38, 16384
buffer_load_dwordx4 v25, s[28:31], s38 offen lds
s_waitcnt vmcnt(18)
s_barrier
s_cmp_eq_u32 s47, 0
s_cbranch_scc0 Lw_139
s_xor_b32 s43, s2, 2
s_add_u32 s43, s43, 128
s_lshl_b32 s43, s43, 7
v_mov_b32 v26, s43
v_mov_b32 v27, 1
s_mov_b64 exec, 1
buffer_store_dword v27, v26, s[56:59], 0 offen sc1
s_mov_b64 exec, -1
Lw_139:
s_mov_b32 s37, 491520
s_add_u32 m0, s39, 16384
s_nop 0
buffer_load_dwordx4 v3, s[24:27], s37 offen sc1 lds
buffer_load_dwordx4 v3, s[24:27], s37 offen offset:1024 sc1 lds
buffer_load_dwordx4 v3, s[24:27], s37 offen offset:2048 sc1 lds
buffer_load_dwordx4 v3, s[24:27], s37 offen offset:3072 sc1 lds
s_mov_b32 s38, 3932160
s_add_u32 m0, s51, 32768
s_nop 0
buffer_load_dwordx4 v25, s[28:31], s38 offen lds
s_add_u32 m0, s51, 33792
s_add_u32 s38, s38, 16384
buffer_load_dwordx4 v25, s[28:31], s38 offen lds
s_waitcnt vmcnt(18)
s_barrier
s_mov_b32 s37, 507904
s_add_u32 m0, s39, 49152
s_nop 0
buffer_load_dwordx4 v3, s[24:27], s37 offen sc1 lds
buffer_load_dwordx4 v3, s[24:27], s37 offen offset:1024 sc1 lds
buffer_load_dwordx4 v3, s[24:27], s37 offen offset:2048 sc1 lds
buffer_load_dwordx4 v3, s[24:27], s37 offen offset:3072 sc1 lds
s_mov_b32 s38, 4063232
s_add_u32 m0, s51, 65536
s_nop 0
buffer_load_dwordx4 v25, s[28:31], s38 offen lds
s_add_u32 m0, s51, 66560
s_add_u32 s38, s38, 16384
buffer_load_dwordx4 v25, s[28:31], s38 offen lds
s_waitcnt vmcnt(18)
s_barrier
s_cmp_eq_u32 s47, 3
s_cbranch_scc0 Lw_140
s_lshl_b32 s92, s2, 7
s_add_u32 s92, s92, 28327936
s_load_dword s93, s[82:83], s92 glc
Lw_140:
s_waitcnt vmcnt(12)
s_cmp_eq_u32 s47, 3
s_cbranch_scc0 Lw_141
s_mov_b32 s41, 0x40000
s_branch Lpchk_144
Lpoll_142:
s_load_dword s93, s[82:83], s92 glc
Lpchk_144:
s_waitcnt lgkmcnt(0)
s_cmp_eq_u32 s93, 1
s_cbranch_scc1 Lpok_143
s_sub_u32 s41, s41, 1
s_cmp_lg_u32 s41, 0
s_cbranch_scc1 Lpoll_142
Lpok_143:
Lw_141:
s_barrier
s_waitcnt vmcnt(6)
s_barrier
s_waitcnt vmcnt(0)
s_barrier
s_barrier
s_branch Ldone_1
Ldone_1:
Lfin:
Lexit_2:
s_endpgm
.fill 1024, 4, 0xbf800000
.section .rodata,"a"
.p2align 6
.amdhsa_kernel sequential_preLN__sliding_local_dilated__glu_gated_geglu__prompt_kernel
  .amdhsa_next_free_vgpr 256
  .amdhsa_next_free_sgpr 102
  .amdhsa_accum_offset 256
  .amdhsa_group_segment_fixed_size 0
  .amdhsa_kernarg_size 80
  .amdhsa_user_sgpr_count 2
  .amdhsa_user_sgpr_kernarg_segment_ptr 1
  .amdhsa_system_sgpr_workgroup_id_x 1
  .amdhsa_float_denorm_mode_32 3
  .amdhsa_float_denorm_mode_16_64 3
.end_amdhsa_kernel
```

```asm
; @launch grid=(256,1,1) block=(512,1,1) lds=163840
.amdgcn_target "amdgcn-amd-amdhsa--gfx950"
.text
.globl sequential_preLN__sliding_local_dilated__glu_gated_geglu__prompt_kernel
.p2align 8
.type sequential_preLN__sliding_local_dilated__glu_gated_geglu__prompt_kernel,@function
sequential_preLN__sliding_local_dilated__glu_gated_geglu__prompt_kernel:
s_cmp_ge_u32 s2, 256
s_cbranch_scc1 Lexit_2
s_load_dwordx16 s[64:79], s[0:1], 0
s_load_dwordx4 s[80:83], s[0:1], 64
s_and_b32 s3, s2, 7
s_lshr_b32 s42, s2, 3
s_and_b32 s34, s3, 1
s_lshl_b32 s34, s34, 3
s_and_b32 s48, s42, 7
s_add_u32 s34, s34, s48
s_lshr_b32 s35, s3, 1
s_lshr_b32 s49, s42, 3
s_lshl_b32 s35, s35, 2
s_add_u32 s35, s35, s49
v_lshrrev_b32 v12, 6, v0
v_and_b32 v1, 63, v0
v_readfirstlane_b32 s36, v12
Lbeg:
s_lshl_b32 s50, s34, 7
s_sub_u32 s50, s50, 16
v_and_b32 v12, 15, v1
v_lshrrev_b32 v13, 4, v1
s_cmp_lt_u32 s36, 4
s_cbranch_scc1 Lcons_7
Lprod_3:
s_sub_u32 s47, s36, 4
s_lshl_b32 s43, s34, 7
s_lshl_b32 s44, s35, 3
s_add_u32 s63, s43, s44
s_lshl_b32 s44, s47, 1
s_add_u32 s51, s63, s44
v_lshlrev_b32 v10, 4, v1
s_and_b32 s43, s2, 7
s_lshr_b32 s44, s43, 2
s_lshl_b32 s44, s44, 1
s_and_b32 s45, s43, 1
s_add_u32 s44, s44, s45
s_lshr_b32 s45, s2, 3
s_lshl_b32 s45, s45, 2
s_add_u32 s44, s44, s45
s_add_u32 s44, s44, 96
s_bitcmp1_b32 s43, 1
s_cselect_b32 s44, s44, 0x10000
s_cmp_lt_u32 s2, 192
s_cselect_b32 s33, s2, s44
v_lshrrev_b32 v14, 3, v1
v_and_b32 v15, 7, v1
v_lshl_add_u32 v19, v14, 6, v15
s_lshl_b32 s43, s48, 3
v_add_u32 v19, s43, v19
v_mul_u32_u24 v19, 6144, v19
s_cmp_eq_u32 s47, 3
s_cbranch_scc1 Lpf_4
v_and_b32 v16, 2, v14
v_xor_b32 v16, v15, v16
v_lshlrev_b32 v16, 4, v16
v_mul_u32_u24 v17, 6144, v14
s_lshl_b32 s43, s47, 11
v_add3_u32 v2, v17, v16, s43
v_xor_b32 v3, 64, v2
v_lshrrev_b32 v16, 1, v14
v_xor_b32 v16, v15, v16
v_lshlrev_b32 v16, 4, v16
s_lshl_b32 s43, s47, 3
s_add_u32 s43, s43, s50
v_add_u32 v17, s43, v14
s_and_b32 s44, s47, 1
s_lshl_b32 s44, s44, 6
v_add_u32 v18, 0, v17
v_max_i32 v18, 0, v18
v_lshl_add_u32 v18, v18, 11, v16
v_xor_b32 v18, s44, v18
v_mov_b32 v4, v18
v_add_u32 v18, 24, v17
v_max_i32 v18, 0, v18
v_lshl_add_u32 v18, v18, 11, v16
v_xor_b32 v18, s44, v18
v_xor_b32 v5, 64, v18
v_add_u32 v18, 48, v17
v_max_i32 v18, 0, v18
v_lshl_add_u32 v18, v18, 11, v16
v_xor_b32 v18, s44, v18
v_mov_b32 v6, v18
v_add_u32 v18, 72, v17
v_max_i32 v18, 0, v18
v_lshl_add_u32 v18, v18, 11, v16
v_xor_b32 v18, s44, v18
v_xor_b32 v7, 64, v18
v_add_u32 v18, 96, v17
v_max_i32 v18, 0, v18
v_lshl_add_u32 v18, v18, 11, v16
v_xor_b32 v18, s44, v18
v_mov_b32 v8, v18
v_add_u32 v18, 120, v17
v_max_i32 v18, 0, v18
v_lshl_add_u32 v18, v18, 11, v16
v_xor_b32 v18, s44, v18
v_xor_b32 v9, 64, v18
s_lshl_b32 s39, s47, 10
s_lshl_b32 s40, s47, 13
s_add_u32 s40, s40, 18432
s_mov_b32 s37, 0
s_mov_b32 s38, 0
s_bfm_b64 s[60:61], 56, 8
s_cmp_eq_u32 s47, 0
s_cselect_b64 s[60:61], s[60:61], -1
s_lshl_b32 s43, s35, 7
s_waitcnt lgkmcnt(0)
s_mov_b32 s8, s64
s_mov_b32 s9, s65
s_mov_b32 s10, 4194304
s_mov_b32 s11, 0x20000
s_add_u32 s12, s66, s43
s_addc_u32 s13, s67, 0
s_mov_b32 s14, 6289536
s_mov_b32 s15, 0x20000
s_mov_b32 s28, s66
s_mov_b32 s29, s67
s_mov_b32 s30, 6291456
s_mov_b32 s31, 0x20000
s_mul_i32 s43, s33, 5376
v_lshlrev_b32 v30, 7, v1
s_mul_i32 s44, s47, 1792
s_add_u32 s43, s43, s44
s_bfm_b64 exec, 14, 0
buffer_load_dword v31, v30, s[28:31], s43 offen
s_mov_b64 exec, -1
s_add_u32 m0, s39, 0
s_mov_b64 exec, s[60:61]
buffer_load_dwordx4 v4, s[8:11], s37 offen lds
s_mov_b64 exec, -1
s_add_u32 m0, s39, 3072
s_nop 0
buffer_load_dwordx4 v5, s[8:11], s37 offen lds
s_add_u32 m0, s39, 6144
s_nop 0
buffer_load_dwordx4 v6, s[8:11], s37 offen lds
s_add_u32 m0, s39, 9216
s_nop 0
buffer_load_dwordx4 v7, s[8:11], s37 offen lds
s_add_u32 m0, s39, 12288
s_nop 0
buffer_load_dwordx4 v8, s[8:11], s37 offen lds
s_add_u32 m0, s39, 15360
s_nop 0
buffer_load_dwordx4 v9, s[8:11], s37 offen lds
s_add_u32 m0, s40, 0
s_add_u32 s43, s38, 0
buffer_load_dwordx4 v2, s[12:15], s43 offen lds
s_add_u32 m0, s40, 1024
s_add_u32 s43, s38, 49152
buffer_load_dwordx4 v3, s[12:15], s43 offen lds
s_add_u32 m0, s40, 2048
s_add_u32 s43, s38, 98304
buffer_load_dwordx4 v2, s[12:15], s43 offen lds
s_add_u32 m0, s40, 3072
s_add_u32 s43, s38, 147456
buffer_load_dwordx4 v3, s[12:15], s43 offen lds
s_add_u32 m0, s40, 4096
s_add_u32 s43, s38, 196608
buffer_load_dwordx4 v2, s[12:15], s43 offen lds
s_add_u32 m0, s40, 5120
s_add_u32 s43, s38, 245760
buffer_load_dwordx4 v3, s[12:15], s43 offen lds
s_add_u32 m0, s40, 6144
s_add_u32 s43, s38, 294912
buffer_load_dwordx4 v2, s[12:15], s43 offen lds
s_add_u32 m0, s40, 7168
s_add_u32 s43, s38, 344064
buffer_load_dwordx4 v3, s[12:15], s43 offen lds
s_add_u32 s37, s37, 128
s_add_u32 s38, s38, 393216
s_lshl_b32 s43, s51, 11
buffer_load_dwordx4 v[96:99], v10, s[8:11], s43 offen offset:0
buffer_load_dwordx4 v[100:103], v10, s[8:11], s43 offen offset:1024
buffer_load_dwordx4 v[104:107], v10, s[8:11], s43 offen offset:2048
buffer_load_dwordx4 v[108:111], v10, s[8:11], s43 offen offset:3072
s_add_u32 m0, s39, 43008
s_mov_b64 exec, s[60:61]
buffer_load_dwordx4 v4, s[8:11], s37 offen lds
s_mov_b64 exec, -1
s_add_u32 m0, s39, 46080
s_nop 0
buffer_load_dwordx4 v5, s[8:11], s37 offen lds
s_add_u32 m0, s39, 49152
s_nop 0
buffer_load_dwordx4 v6, s[8:11], s37 offen lds
s_add_u32 m0, s39, 52224
s_nop 0
buffer_load_dwordx4 v7, s[8:11], s37 offen lds
s_add_u32 m0, s39, 55296
s_nop 0
buffer_load_dwordx4 v8, s[8:11], s37 offen lds
s_add_u32 m0, s39, 58368
s_nop 0
buffer_load_dwordx4 v9, s[8:11], s37 offen lds
s_add_u32 m0, s40, 43008
s_add_u32 s43, s38, 0
buffer_load_dwordx4 v2, s[12:15], s43 offen lds
s_add_u32 m0, s40, 44032
s_add_u32 s43, s38, 49152
buffer_load_dwordx4 v3, s[12:15], s43 offen lds
s_add_u32 m0, s40, 45056
s_add_u32 s43, s38, 98304
buffer_load_dwordx4 v2, s[12:15], s43 offen lds
s_add_u32 m0, s40, 46080
s_add_u32 s43, s38, 147456
buffer_load_dwordx4 v3, s[12:15], s43 offen lds
s_add_u32 m0, s40, 47104
s_add_u32 s43, s38, 196608
buffer_load_dwordx4 v2, s[12:15], s43 offen lds
s_add_u32 m0, s40, 48128
s_add_u32 s43, s38, 245760
buffer_load_dwordx4 v3, s[12:15], s43 offen lds
s_add_u32 m0, s40, 49152
s_add_u32 s43, s38, 294912
buffer_load_dwordx4 v2, s[12:15], s43 offen lds
s_add_u32 m0, s40, 50176
s_add_u32 s43, s38, 344064
buffer_load_dwordx4 v3, s[12:15], s43 offen lds
s_add_u32 s37, s37, 128
s_add_u32 s38, s38, 393216
s_waitcnt vmcnt(18)
s_barrier
s_add_u32 m0, s39, 86016
s_mov_b64 exec, s[60:61]
buffer_load_dwordx4 v4, s[8:11], s37 offen lds
s_mov_b64 exec, -1
s_add_u32 m0, s39, 89088
s_nop 0
buffer_load_dwordx4 v5, s[8:11], s37 offen lds
s_add_u32 m0, s39, 92160
s_nop 0
buffer_load_dwordx4 v6, s[8:11], s37 offen lds
s_add_u32 m0, s39, 95232
s_nop 0
buffer_load_dwordx4 v7, s[8:11], s37 offen lds
s_add_u32 m0, s39, 98304
s_nop 0
buffer_load_dwordx4 v8, s[8:11], s37 offen lds
s_add_u32 m0, s39, 101376
s_nop 0
buffer_load_dwordx4 v9, s[8:11], s37 offen lds
s_add_u32 m0, s40, 86016
s_add_u32 s43, s38, 0
buffer_load_dwordx4 v2, s[12:15], s43 offen lds
s_add_u32 m0, s40, 87040
s_add_u32 s43, s38, 49152
buffer_load_dwordx4 v3, s[12:15], s43 offen lds
s_add_u32 m0, s40, 88064
s_add_u32 s43, s38, 98304
buffer_load_dwordx4 v2, s[12:15], s43 offen lds
s_add_u32 m0, s40, 89088
s_add_u32 s43, s38, 147456
buffer_load_dwordx4 v3, s[12:15], s43 offen lds
s_add_u32 m0, s40, 90112
s_add_u32 s43, s38, 196608
buffer_load_dwordx4 v2, s[12:15], s43 offen lds
s_add_u32 m0, s40, 91136
s_add_u32 s43, s38, 245760
buffer_load_dwordx4 v3, s[12:15], s43 offen lds
s_add_u32 m0, s40, 92160
s_add_u32 s43, s38, 294912
buffer_load_dwordx4 v2, s[12:15], s43 offen lds
s_add_u32 m0, s40, 93184
s_add_u32 s43, s38, 344064
buffer_load_dwordx4 v3, s[12:15], s43 offen lds
s_add_u32 s37, s37, 128
s_add_u32 s38, s38, 393216
s_waitcnt vmcnt(28)
s_mov_b32 s43, 0x3f803f80
v_mov_b32 v116, 0
v_mov_b32 v117, 0
v_mov_b32 v118, 0
v_mov_b32 v119, 0
v_mov_b32 v120, 0
v_mov_b32 v121, 0
v_mov_b32 v122, 0
v_mov_b32 v123, 0
v_dot2_f32_bf16 v116, v96, s43, v116
v_dot2_f32_bf16 v120, v96, v96, v120
v_dot2_f32_bf16 v118, v104, s43, v118
v_dot2_f32_bf16 v122, v104, v104, v122
v_dot2_f32_bf16 v117, v97, s43, v117
v_dot2_f32_bf16 v121, v97, v97, v121
v_dot2_f32_bf16 v119, v105, s43, v119
v_dot2_f32_bf16 v123, v105, v105, v123
v_dot2_f32_bf16 v116, v98, s43, v116
v_dot2_f32_bf16 v120, v98, v98, v120
v_dot2_f32_bf16 v118, v106, s43, v118
v_dot2_f32_bf16 v122, v106, v106, v122
v_dot2_f32_bf16 v117, v99, s43, v117
v_dot2_f32_bf16 v121, v99, v99, v121
v_dot2_f32_bf16 v119, v107, s43, v119
v_dot2_f32_bf16 v123, v107, v107, v123
v_dot2_f32_bf16 v116, v100, s43, v116
v_dot2_f32_bf16 v120, v100, v100, v120
v_dot2_f32_bf16 v118, v108, s43, v118
v_dot2_f32_bf16 v122, v108, v108, v122
v_dot2_f32_bf16 v117, v101, s43, v117
v_dot2_f32_bf16 v121, v101, v101, v121
v_dot2_f32_bf16 v119, v109, s43, v119
v_dot2_f32_bf16 v123, v109, v109, v123
v_dot2_f32_bf16 v116, v102, s43, v116
v_dot2_f32_bf16 v120, v102, v102, v120
v_dot2_f32_bf16 v118, v110, s43, v118
v_dot2_f32_bf16 v122, v110, v110, v122
v_dot2_f32_bf16 v117, v103, s43, v117
v_dot2_f32_bf16 v121, v103, v103, v121
v_dot2_f32_bf16 v119, v111, s43, v119
v_dot2_f32_bf16 v123, v111, v111, v123
s_nop 2
v_add_f32 v116, v116, v117
v_add_f32 v118, v118, v119
v_add_f32 v120, v120, v121
v_add_f32 v122, v122, v123
s_nop 1
v_permlane32_swap_b32 v116, v118
v_permlane32_swap_b32 v120, v122
v_add_f32 v116, v116, v118
v_add_f32 v120, v120, v122
s_nop 1
v_permlane16_swap_b32 v116, v120
v_add_f32 v116, v116, v120
s_nop 1
v_add_f32_dpp v116, v116, v116 row_ror:8 row_mask:0xf bank_mask:0xf
s_nop 1
v_add_f32_dpp v116, v116, v116 row_ror:4 row_mask:0xf bank_mask:0xf
s_nop 1
v_add_f32_dpp v116, v116, v116 row_ror:2 row_mask:0xf bank_mask:0xf
s_nop 1
v_add_f32_dpp v116, v116, v116 row_ror:1 row_mask:0xf bank_mask:0xf
v_mov_b32 v117, v116
s_nop 1
v_permlane16_swap_b32 v116, v117
v_mul_f32 v112, 0x3a800000, v116
v_mul_f32 v113, 0x3a800000, v117
v_fma_f32 v113, -v112, v112, v113
v_max_f32 v113, 0, v113
v_add_f32 v113, 0x3727c5ac, v113
v_rsq_f32 v113, v113
v_lshrrev_b32 v11, 5, v1
s_lshl_b32 s43, s47, 4
s_add_u32 s43, s43, 148608
v_lshl_add_u32 v11, v11, 3, s43
ds_write_b64 v11, v[112:113]
s_waitcnt lgkmcnt(0)
s_and_b32 s44, s36, 3
s_mul_i32 s44, s44, 28
s_bfe_u32 s43, s2, 0x30001
s_lshl_b32 s43, s43, 7
s_add_u32 s44, s44, s43
s_mul_i32 s44, s44, 7168
s_lshr_b32 s43, s2, 4
s_lshl_b32 s43, s43, 8
s_add_u32 s43, s43, s44
s_bitcmp0_b32 s2, 0
s_cselect_b32 s4, s72, s74
s_cselect_b32 s5, s73, s75
s_add_u32 s4, s4, s43
s_addc_u32 s5, s5, 0
s_waitcnt vmcnt(14)
s_barrier
s_add_u32 m0, s39, 0
s_mov_b64 exec, s[60:61]
buffer_load_dwordx4 v4, s[8:11], s37 offen lds
s_mov_b64 exec, -1
s_add_u32 m0, s39, 3072
s_nop 0
buffer_load_dwordx4 v5, s[8:11], s37 offen lds
s_add_u32 m0, s39, 6144
s_nop 0
buffer_load_dwordx4 v6, s[8:11], s37 offen lds
s_add_u32 m0, s39, 9216
s_nop 0
buffer_load_dwordx4 v7, s[8:11], s37 offen lds
s_add_u32 m0, s39, 12288
s_nop 0
buffer_load_dwordx4 v8, s[8:11], s37 offen lds
s_add_u32 m0, s39, 15360
s_nop 0
buffer_load_dwordx4 v9, s[8:11], s37 offen lds
s_add_u32 m0, s40, 0
s_add_u32 s43, s38, 0
buffer_load_dwordx4 v2, s[12:15], s43 offen lds
s_add_u32 m0, s40, 1024
s_add_u32 s43, s38, 49152
buffer_load_dwordx4 v3, s[12:15], s43 offen lds
s_add_u32 m0, s40, 2048
s_add_u32 s43, s38, 98304
buffer_load_dwordx4 v2, s[12:15], s43 offen lds
s_add_u32 m0, s40, 3072
s_add_u32 s43, s38, 147456
buffer_load_dwordx4 v3, s[12:15], s43 offen lds
s_add_u32 m0, s40, 4096
s_add_u32 s43, s38, 196608
buffer_load_dwordx4 v2, s[12:15], s43 offen lds
s_add_u32 m0, s40, 5120
s_add_u32 s43, s38, 245760
buffer_load_dwordx4 v3, s[12:15], s43 offen lds
s_add_u32 m0, s40, 6144
s_add_u32 s43, s38, 294912
buffer_load_dwordx4 v2, s[12:15], s43 offen lds
s_add_u32 m0, s40, 7168
s_add_u32 s43, s38, 344064
buffer_load_dwordx4 v3, s[12:15], s43 offen lds
s_add_u32 s37, s37, 128
s_add_u32 s38, s38, 393216
s_waitcnt vmcnt(14)
s_barrier
s_add_u32 m0, s39, 43008
s_mov_b64 exec, s[60:61]
buffer_load_dwordx4 v4, s[8:11], s37 offen lds
s_mov_b64 exec, -1
s_add_u32 m0, s39, 46080
s_nop 0
buffer_load_dwordx4 v5, s[8:11], s37 offen lds
s_add_u32 m0, s39, 49152
s_nop 0
buffer_load_dwordx4 v6, s[8:11], s37 offen lds
s_add_u32 m0, s39, 52224
s_nop 0
buffer_load_dwordx4 v7, s[8:11], s37 offen lds
s_add_u32 m0, s39, 55296
s_nop 0
buffer_load_dwordx4 v8, s[8:11], s37 offen lds
s_add_u32 m0, s39, 58368
s_nop 0
buffer_load_dwordx4 v9, s[8:11], s37 offen lds
s_add_u32 m0, s40, 43008
s_add_u32 s43, s38, 0
buffer_load_dwordx4 v2, s[12:15], s43 offen lds
s_add_u32 m0, s40, 44032
s_add_u32 s43, s38, 49152
buffer_load_dwordx4 v3, s[12:15], s43 offen lds
s_add_u32 m0, s40, 45056
s_add_u32 s43, s38, 98304
buffer_load_dwordx4 v2, s[12:15], s43 offen lds
s_add_u32 m0, s40, 46080
s_add_u32 s43, s38, 147456
buffer_load_dwordx4 v3, s[12:15], s43 offen lds
s_add_u32 m0, s40, 47104
s_add_u32 s43, s38, 196608
buffer_load_dwordx4 v2, s[12:15], s43 offen lds
s_add_u32 m0, s40, 48128
s_add_u32 s43, s38, 245760
buffer_load_dwordx4 v3, s[12:15], s43 offen lds
s_add_u32 m0, s40, 49152
s_add_u32 s43, s38, 294912
buffer_load_dwordx4 v2, s[12:15], s43 offen lds
s_add_u32 m0, s40, 50176
s_add_u32 s43, s38, 344064
buffer_load_dwordx4 v3, s[12:15], s43 offen lds
s_add_u32 s37, s37, 128
s_add_u32 s38, s38, 393216
s_load_dword s3, s[4:5], 0
s_load_dword s3, s[4:5], 64
s_load_dword s3, s[4:5], 128
s_waitcnt vmcnt(14)
s_barrier
s_add_u32 m0, s39, 86016
s_mov_b64 exec, s[60:61]
buffer_load_dwordx4 v4, s[8:11], s37 offen lds
s_mov_b64 exec, -1
s_add_u32 m0, s39, 89088
s_nop 0
buffer_load_dwordx4 v5, s[8:11], s37 offen lds
s_add_u32 m0, s39, 92160
s_nop 0
buffer_load_dwordx4 v6, s[8:11], s37 offen lds
s_add_u32 m0, s39, 95232
s_nop 0
buffer_load_dwordx4 v7, s[8:11], s37 offen lds
s_add_u32 m0, s39, 98304
s_nop 0
buffer_load_dwordx4 v8, s[8:11], s37 offen lds
s_add_u32 m0, s39, 101376
s_nop 0
buffer_load_dwordx4 v9, s[8:11], s37 offen lds
s_add_u32 m0, s40, 86016
s_add_u32 s43, s38, 0
buffer_load_dwordx4 v2, s[12:15], s43 offen lds
s_add_u32 m0, s40, 87040
s_add_u32 s43, s38, 49152
buffer_load_dwordx4 v3, s[12:15], s43 offen lds
s_add_u32 m0, s40, 88064
s_add_u32 s43, s38, 98304
buffer_load_dwordx4 v2, s[12:15], s43 offen lds
s_add_u32 m0, s40, 89088
s_add_u32 s43, s38, 147456
buffer_load_dwordx4 v3, s[12:15], s43 offen lds
s_add_u32 m0, s40, 90112
s_add_u32 s43, s38, 196608
buffer_load_dwordx4 v2, s[12:15], s43 offen lds
s_add_u32 m0, s40, 91136
s_add_u32 s43, s38, 245760
buffer_load_dwordx4 v3, s[12:15], s43 offen lds
s_add_u32 m0, s40, 92160
s_add_u32 s43, s38, 294912
buffer_load_dwordx4 v2, s[12:15], s43 offen lds
s_add_u32 m0, s40, 93184
s_add_u32 s43, s38, 344064
buffer_load_dwordx4 v3, s[12:15], s43 offen lds
s_add_u32 s37, s37, 128
s_add_u32 s38, s38, 393216
s_load_dword s3, s[4:5], 192
s_load_dword s3, s[4:5], 7168
s_load_dword s3, s[4:5], 7232
s_load_dword s3, s[4:5], 7296
s_load_dword s3, s[4:5], 7360
s_waitcnt vmcnt(14)
s_barrier
s_add_u32 m0, s39, 0
s_mov_b64 exec, s[60:61]
buffer_load_dwordx4 v4, s[8:11], s37 offen lds
s_mov_b64 exec, -1
s_add_u32 m0, s39, 3072
s_nop 0
buffer_load_dwordx4 v5, s[8:11], s37 offen lds
s_add_u32 m0, s39, 6144
s_nop 0
buffer_load_dwordx4 v6, s[8:11], s37 offen lds
s_branch Lov_0
.p2align 12
Lst_0_0:
s_branch Lwr_145
s_nop 0
s_nop 0
Lov_0:
s_add_u32 m0, s39, 9216
s_nop 0
buffer_load_dwordx4 v7, s[8:11], s37 offen lds
s_add_u32 m0, s39, 12288
s_nop 0
buffer_load_dwordx4 v8, s[8:11], s37 offen lds
s_add_u32 m0, s39, 15360
s_nop 0
buffer_load_dwordx4 v9, s[8:11], s37 offen lds
s_add_u32 m0, s40, 0
s_add_u32 s43, s38, 0
buffer_load_dwordx4 v2, s[12:15], s43 offen lds
s_add_u32 m0, s40, 1024
s_add_u32 s43, s38, 49152
buffer_load_dwordx4 v3, s[12:15], s43 offen lds
s_add_u32 m0, s40, 2048
s_add_u32 s43, s38, 98304
buffer_load_dwordx4 v2, s[12:15], s43 offen lds
s_add_u32 m0, s40, 3072
s_add_u32 s43, s38, 147456
buffer_load_dwordx4 v3, s[12:15], s43 offen lds
s_add_u32 m0, s40, 4096
s_add_u32 s43, s38, 196608
buffer_load_dwordx4 v2, s[12:15], s43 offen lds
s_add_u32 m0, s40, 5120
s_add_u32 s43, s38, 245760
buffer_load_dwordx4 v3, s[12:15], s43 offen lds
s_add_u32 m0, s40, 6144
s_add_u32 s43, s38, 294912
buffer_load_dwordx4 v2, s[12:15], s43 offen lds
s_add_u32 m0, s40, 7168
s_add_u32 s43, s38, 344064
buffer_load_dwordx4 v3, s[12:15], s43 offen lds
s_add_u32 s37, s37, 128
s_add_u32 s38, s38, 393216
s_load_dword s3, s[4:5], 14336
s_load_dword s3, s[4:5], 14400
s_load_dword s3, s[4:5], 14464
s_load_dword s3, s[4:5], 14528
s_load_dword s3, s[4:5], 21504
s_load_dword s3, s[4:5], 21568
s_waitcnt vmcnt(14)
s_barrier
s_add_u32 m0, s39, 43008
s_mov_b64 exec, s[60:61]
buffer_load_dwordx4 v4, s[8:11], s37 offen lds
s_mov_b64 exec, -1
s_add_u32 m0, s39, 46080
s_nop 0
buffer_load_dwordx4 v5, s[8:11], s37 offen lds
s_add_u32 m0, s39, 49152
s_nop 0
buffer_load_dwordx4 v6, s[8:11], s37 offen lds
s_add_u32 m0, s39, 52224
s_nop 0
buffer_load_dwordx4 v7, s[8:11], s37 offen lds
s_add_u32 m0, s39, 55296
s_nop 0
buffer_load_dwordx4 v8, s[8:11], s37 offen lds
s_add_u32 m0, s39, 58368
s_nop 0
buffer_load_dwordx4 v9, s[8:11], s37 offen lds
s_add_u32 m0, s40, 43008
s_add_u32 s43, s38, 0
buffer_load_dwordx4 v2, s[12:15], s43 offen lds
s_add_u32 m0, s40, 44032
s_add_u32 s43, s38, 49152
buffer_load_dwordx4 v3, s[12:15], s43 offen lds
s_add_u32 m0, s40, 45056
s_add_u32 s43, s38, 98304
buffer_load_dwordx4 v2, s[12:15], s43 offen lds
s_add_u32 m0, s40, 46080
s_add_u32 s43, s38, 147456
buffer_load_dwordx4 v3, s[12:15], s43 offen lds
s_add_u32 m0, s40, 47104
s_add_u32 s43, s38, 196608
buffer_load_dwordx4 v2, s[12:15], s43 offen lds
s_add_u32 m0, s40, 48128
s_add_u32 s43, s38, 245760
buffer_load_dwordx4 v3, s[12:15], s43 offen lds
s_add_u32 m0, s40, 49152
s_add_u32 s43, s38, 294912
buffer_load_dwordx4 v2, s[12:15], s43 offen lds
s_add_u32 m0, s40, 50176
s_add_u32 s43, s38, 344064
buffer_load_dwordx4 v3, s[12:15], s43 offen lds
s_add_u32 s37, s37, 128
s_add_u32 s38, s38, 393216
s_load_dword s3, s[4:5], 21632
s_load_dword s3, s[4:5], 21696
s_load_dword s3, s[4:5], 28672
s_load_dword s3, s[4:5], 28736
s_load_dword s3, s[4:5], 28800
s_load_dword s3, s[4:5], 28864
s_load_dword s3, s[4:5], 35840
s_waitcnt vmcnt(14)
s_barrier
s_add_u32 m0, s39, 86016
s_mov_b64 exec, s[60:61]
buffer_load_dwordx4 v4, s[8:11], s37 offen lds
s_mov_b64 exec, -1
s_add_u32 m0, s39, 89088
s_nop 0
buffer_load_dwordx4 v5, s[8:11], s37 offen lds
s_add_u32 m0, s39, 92160
s_nop 0
buffer_load_dwordx4 v6, s[8:11], s37 offen lds
s_add_u32 m0, s39, 95232
s_nop 0
buffer_load_dwordx4 v7, s[8:11], s37 offen lds
s_add_u32 m0, s39, 98304
s_nop 0
buffer_load_dwordx4 v8, s[8:11], s37 offen lds
s_add_u32 m0, s39, 101376
s_nop 0
buffer_load_dwordx4 v9, s[8:11], s37 offen lds
s_add_u32 m0, s40, 86016
s_add_u32 s43, s38, 0
buffer_load_dwordx4 v2, s[12:15], s43 offen lds
s_add_u32 m0, s40, 87040
s_add_u32 s43, s38, 49152
buffer_load_dwordx4 v3, s[12:15], s43 offen lds
s_add_u32 m0, s40, 88064
s_add_u32 s43, s38, 98304
buffer_load_dwordx4 v2, s[12:15], s43 offen lds
s_add_u32 m0, s40, 89088
s_add_u32 s43, s38, 147456
buffer_load_dwordx4 v3, s[12:15], s43 offen lds
s_add_u32 m0, s40, 90112
s_add_u32 s43, s38, 196608
buffer_load_dwordx4 v2, s[12:15], s43 offen lds
s_add_u32 m0, s40, 91136
s_add_u32 s43, s38, 245760
buffer_load_dwordx4 v3, s[12:15], s43 offen lds
s_add_u32 m0, s40, 92160
s_add_u32 s43, s38, 294912
buffer_load_dwordx4 v2, s[12:15], s43 offen lds
s_add_u32 m0, s40, 93184
s_add_u32 s43, s38, 344064
buffer_load_dwordx4 v3, s[12:15], s43 offen lds
s_add_u32 s37, s37, 128
s_add_u32 s38, s38, 393216
s_load_dword s3, s[4:5], 35904
s_load_dword s3, s[4:5], 35968
s_load_dword s3, s[4:5], 36032
s_load_dword s3, s[4:5], 43008
s_load_dword s3, s[4:5], 43072
s_load_dword s3, s[4:5], 43136
s_load_dword s3, s[4:5], 43200
s_load_dword s3, s[4:5], 50176
s_waitcnt vmcnt(14)
s_barrier
s_add_u32 m0, s39, 0
s_mov_b64 exec, s[60:61]
buffer_load_dwordx4 v4, s[8:11], s37 offen lds
s_mov_b64 exec, -1
s_add_u32 m0, s39, 3072
s_nop 0
buffer_load_dwordx4 v5, s[8:11], s37 offen lds
s_add_u32 m0, s39, 6144
s_nop 0
buffer_load_dwordx4 v6, s[8:11], s37 offen lds
s_add_u32 m0, s39, 9216
s_nop 0
buffer_load_dwordx4 v7, s[8:11], s37 offen lds
s_add_u32 m0, s39, 12288
s_nop 0
buffer_load_dwordx4 v8, s[8:11], s37 offen lds
s_add_u32 m0, s39, 15360
s_nop 0
buffer_load_dwordx4 v9, s[8:11], s37 offen lds
s_add_u32 m0, s40, 0
s_add_u32 s43, s38, 0
buffer_load_dwordx4 v2, s[12:15], s43 offen lds
s_add_u32 m0, s40, 1024
s_add_u32 s43, s38, 49152
buffer_load_dwordx4 v3, s[12:15], s43 offen lds
s_add_u32 m0, s40, 2048
s_add_u32 s43, s38, 98304
buffer_load_dwordx4 v2, s[12:15], s43 offen lds
s_add_u32 m0, s40, 3072
s_add_u32 s43, s38, 147456
buffer_load_dwordx4 v3, s[12:15], s43 offen lds
s_add_u32 m0, s40, 4096
s_add_u32 s43, s38, 196608
buffer_load_dwordx4 v2, s[12:15], s43 offen lds
s_add_u32 m0, s40, 5120
s_add_u32 s43, s38, 245760
buffer_load_dwordx4 v3, s[12:15], s43 offen lds
s_add_u32 m0, s40, 6144
s_add_u32 s43, s38, 294912
buffer_load_dwordx4 v2, s[12:15], s43 offen lds
s_add_u32 m0, s40, 7168
s_add_u32 s43, s38, 344064
buffer_load_dwordx4 v3, s[12:15], s43 offen lds
s_add_u32 s37, s37, 128
s_add_u32 s38, s38, 393216
s_load_dword s3, s[4:5], 50240
s_load_dword s3, s[4:5], 50304
s_load_dword s3, s[4:5], 50368
s_load_dword s3, s[4:5], 57344
s_load_dword s3, s[4:5], 57408
s_load_dword s3, s[4:5], 57472
s_load_dword s3, s[4:5], 57536
s_load_dword s3, s[4:5], 64512
s_load_dword s3, s[4:5], 64576
s_waitcnt vmcnt(14)
s_barrier
s_add_u32 m0, s39, 43008
s_mov_b64 exec, s[60:61]
buffer_load_dwordx4 v4, s[8:11], s37 offen lds
s_mov_b64 exec, -1
s_add_u32 m0, s39, 46080
s_nop 0
buffer_load_dwordx4 v5, s[8:11], s37 offen lds
s_add_u32 m0, s39, 49152
s_nop 0
buffer_load_dwordx4 v6, s[8:11], s37 offen lds
s_add_u32 m0, s39, 52224
s_nop 0
buffer_load_dwordx4 v7, s[8:11], s37 offen lds
s_add_u32 m0, s39, 55296
s_nop 0
buffer_load_dwordx4 v8, s[8:11], s37 offen lds
s_add_u32 m0, s39, 58368
s_nop 0
buffer_load_dwordx4 v9, s[8:11], s37 offen lds
s_add_u32 m0, s40, 43008
s_add_u32 s43, s38, 0
buffer_load_dwordx4 v2, s[12:15], s43 offen lds
s_add_u32 m0, s40, 44032
s_add_u32 s43, s38, 49152
buffer_load_dwordx4 v3, s[12:15], s43 offen lds
s_add_u32 m0, s40, 45056
s_add_u32 s43, s38, 98304
buffer_load_dwordx4 v2, s[12:15], s43 offen lds
s_add_u32 m0, s40, 46080
s_add_u32 s43, s38, 147456
buffer_load_dwordx4 v3, s[12:15], s43 offen lds
s_add_u32 m0, s40, 47104
s_add_u32 s43, s38, 196608
buffer_load_dwordx4 v2, s[12:15], s43 offen lds
s_add_u32 m0, s40, 48128
s_add_u32 s43, s38, 245760
buffer_load_dwordx4 v3, s[12:15], s43 offen lds
s_add_u32 m0, s40, 49152
s_add_u32 s43, s38, 294912
buffer_load_dwordx4 v2, s[12:15], s43 offen lds
s_add_u32 m0, s40, 50176
s_add_u32 s43, s38, 344064
buffer_load_dwordx4 v3, s[12:15], s43 offen lds
s_add_u32 s37, s37, 128
s_add_u32 s38, s38, 393216
s_load_dword s3, s[4:5], 64640
s_load_dword s3, s[4:5], 64704
s_load_dword s3, s[4:5], 71680
s_load_dword s3, s[4:5], 71744
s_load_dword s3, s[4:5], 71808
s_load_dword s3, s[4:5], 71872
s_load_dword s3, s[4:5], 78848
s_load_dword s3, s[4:5], 78912
s_load_dword s3, s[4:5], 78976
s_load_dword s3, s[4:5], 79040
s_waitcnt vmcnt(14)
s_barrier
s_add_u32 m0, s39, 86016
s_mov_b64 exec, s[60:61]
buffer_load_dwordx4 v4, s[8:11], s37 offen lds
s_mov_b64 exec, -1
s_add_u32 m0, s39, 89088
s_nop 0
buffer_load_dwordx4 v5, s[8:11], s37 offen lds
s_add_u32 m0, s39, 92160
s_nop 0
buffer_load_dwordx4 v6, s[8:11], s37 offen lds
s_add_u32 m0, s39, 95232
s_nop 0
buffer_load_dwordx4 v7, s[8:11], s37 offen lds
s_add_u32 m0, s39, 98304
s_nop 0
buffer_load_dwordx4 v8, s[8:11], s37 offen lds
s_add_u32 m0, s39, 101376
s_nop 0
buffer_load_dwordx4 v9, s[8:11], s37 offen lds
s_add_u32 m0, s40, 86016
s_add_u32 s43, s38, 0
buffer_load_dwordx4 v2, s[12:15], s43 offen lds
s_add_u32 m0, s40, 87040
s_add_u32 s43, s38, 49152
buffer_load_dwordx4 v3, s[12:15], s43 offen lds
s_add_u32 m0, s40, 88064
s_add_u32 s43, s38, 98304
buffer_load_dwordx4 v2, s[12:15], s43 offen lds
s_add_u32 m0, s40, 89088
s_add_u32 s43, s38, 147456
buffer_load_dwordx4 v3, s[12:15], s43 offen lds
s_add_u32 m0, s40, 90112
s_add_u32 s43, s38, 196608
buffer_load_dwordx4 v2, s[12:15], s43 offen lds
s_add_u32 m0, s40, 91136
s_add_u32 s43, s38, 245760
buffer_load_dwordx4 v3, s[12:15], s43 offen lds
s_add_u32 m0, s40, 92160
s_add_u32 s43, s38, 294912
buffer_load_dwordx4 v2, s[12:15], s43 offen lds
s_add_u32 m0, s40, 93184
s_add_u32 s43, s38, 344064
buffer_load_dwordx4 v3, s[12:15], s43 offen lds
s_add_u32 s37, s37, 128
s_add_u32 s38, s38, 393216
s_load_dword s3, s[4:5], 86016
s_load_dword s3, s[4:5], 86080
s_load_dword s3, s[4:5], 86144
s_load_dword s3, s[4:5], 86208
s_load_dword s3, s[4:5], 93184
s_load_dword s3, s[4:5], 93248
s_load_dword s3, s[4:5], 93312
s_load_dword s3, s[4:5], 93376
s_load_dword s3, s[4:5], 100352
s_load_dword s3, s[4:5], 100416
s_waitcnt vmcnt(14)
s_barrier
s_add_u32 m0, s39, 0
s_mov_b64 exec, s[60:61]
buffer_load_dwordx4 v4, s[8:11], s37 offen lds
s_mov_b64 exec, -1
s_add_u32 m0, s39, 3072
s_nop 0
buffer_load_dwordx4 v5, s[8:11], s37 offen lds
s_add_u32 m0, s39, 6144
s_nop 0
buffer_load_dwordx4 v6, s[8:11], s37 offen lds
s_add_u32 m0, s39, 9216
s_nop 0
buffer_load_dwordx4 v7, s[8:11], s37 offen lds
s_add_u32 m0, s39, 12288
s_nop 0
buffer_load_dwordx4 v8, s[8:11], s37 offen lds
s_add_u32 m0, s39, 15360
s_nop 0
buffer_load_dwordx4 v9, s[8:11], s37 offen lds
s_add_u32 m0, s40, 0
s_add_u32 s43, s38, 0
buffer_load_dwordx4 v2, s[12:15], s43 offen lds
s_add_u32 m0, s40, 1024
s_add_u32 s43, s38, 49152
buffer_load_dwordx4 v3, s[12:15], s43 offen lds
s_add_u32 m0, s40, 2048
s_add_u32 s43, s38, 98304
buffer_load_dwordx4 v2, s[12:15], s43 offen lds
s_add_u32 m0, s40, 3072
s_add_u32 s43, s38, 147456
buffer_load_dwordx4 v3, s[12:15], s43 offen lds
s_add_u32 m0, s40, 4096
s_add_u32 s43, s38, 196608
buffer_load_dwordx4 v2, s[12:15], s43 offen lds
s_add_u32 m0, s40, 5120
s_add_u32 s43, s38, 245760
buffer_load_dwordx4 v3, s[12:15], s43 offen lds
s_add_u32 m0, s40, 6144
s_add_u32 s43, s38, 294912
buffer_load_dwordx4 v2, s[12:15], s43 offen lds
s_add_u32 m0, s40, 7168
s_add_u32 s43, s38, 344064
buffer_load_dwordx4 v3, s[12:15], s43 offen lds
s_add_u32 s37, s37, 128
s_add_u32 s38, s38, 393216
s_load_dword s3, s[4:5], 100480
s_load_dword s3, s[4:5], 100544
s_load_dword s3, s[4:5], 107520
s_load_dword s3, s[4:5], 107584
s_load_dword s3, s[4:5], 107648
s_load_dword s3, s[4:5], 107712
s_load_dword s3, s[4:5], 114688
s_load_dword s3, s[4:5], 114752
s_load_dword s3, s[4:5], 114816
s_load_dword s3, s[4:5], 114880
s_load_dword s3, s[4:5], 121856
s_waitcnt vmcnt(14)
s_barrier
s_add_u32 m0, s39, 43008
s_mov_b64 exec, s[60:61]
buffer_load_dwordx4 v4, s[8:11], s37 offen lds
s_mov_b64 exec, -1
s_add_u32 m0, s39, 46080
s_nop 0
buffer_load_dwordx4 v5, s[8:11], s37 offen lds
s_add_u32 m0, s39, 49152
s_nop 0
buffer_load_dwordx4 v6, s[8:11], s37 offen lds
s_add_u32 m0, s39, 52224
s_nop 0
buffer_load_dwordx4 v7, s[8:11], s37 offen lds
s_add_u32 m0, s39, 55296
s_nop 0
buffer_load_dwordx4 v8, s[8:11], s37 offen lds
s_add_u32 m0, s39, 58368
s_nop 0
buffer_load_dwordx4 v9, s[8:11], s37 offen lds
s_add_u32 m0, s40, 43008
s_add_u32 s43, s38, 0
buffer_load_dwordx4 v2, s[12:15], s43 offen lds
s_add_u32 m0, s40, 44032
s_add_u32 s43, s38, 49152
buffer_load_dwordx4 v3, s[12:15], s43 offen lds
s_add_u32 m0, s40, 45056
s_add_u32 s43, s38, 98304
buffer_load_dwordx4 v2, s[12:15], s43 offen lds
s_add_u32 m0, s40, 46080
s_add_u32 s43, s38, 147456
buffer_load_dwordx4 v3, s[12:15], s43 offen lds
s_add_u32 m0, s40, 47104
s_add_u32 s43, s38, 196608
buffer_load_dwordx4 v2, s[12:15], s43 offen lds
s_add_u32 m0, s40, 48128
s_add_u32 s43, s38, 245760
buffer_load_dwordx4 v3, s[12:15], s43 offen lds
s_add_u32 m0, s40, 49152
s_add_u32 s43, s38, 294912
buffer_load_dwordx4 v2, s[12:15], s43 offen lds
s_add_u32 m0, s40, 50176
s_add_u32 s43, s38, 344064
buffer_load_dwordx4 v3, s[12:15], s43 offen lds
s_add_u32 s37, s37, 128
s_add_u32 s38, s38, 393216
s_load_dword s3, s[4:5], 121920
s_load_dword s3, s[4:5], 121984
s_load_dword s3, s[4:5], 122048
s_load_dword s3, s[4:5], 129024
s_load_dword s3, s[4:5], 129088
s_load_dword s3, s[4:5], 129152
s_load_dword s3, s[4:5], 129216
s_load_dword s3, s[4:5], 136192
s_load_dword s3, s[4:5], 136256
s_load_dword s3, s[4:5], 136320
s_load_dword s3, s[4:5], 136384
s_waitcnt vmcnt(14)
s_barrier
s_add_u32 m0, s39, 86016
s_mov_b64 exec, s[60:61]
buffer_load_dwordx4 v4, s[8:11], s37 offen lds
s_mov_b64 exec, -1
s_add_u32 m0, s39, 89088
s_nop 0
buffer_load_dwordx4 v5, s[8:11], s37 offen lds
s_add_u32 m0, s39, 92160
s_nop 0
buffer_load_dwordx4 v6, s[8:11], s37 offen lds
s_add_u32 m0, s39, 95232
s_nop 0
buffer_load_dwordx4 v7, s[8:11], s37 offen lds
s_add_u32 m0, s39, 98304
s_nop 0
buffer_load_dwordx4 v8, s[8:11], s37 offen lds
s_add_u32 m0, s39, 101376
s_nop 0
buffer_load_dwordx4 v9, s[8:11], s37 offen lds
s_add_u32 m0, s40, 86016
s_add_u32 s43, s38, 0
buffer_load_dwordx4 v2, s[12:15], s43 offen lds
s_add_u32 m0, s40, 87040
s_add_u32 s43, s38, 49152
buffer_load_dwordx4 v3, s[12:15], s43 offen lds
s_add_u32 m0, s40, 88064
s_add_u32 s43, s38, 98304
buffer_load_dwordx4 v2, s[12:15], s43 offen lds
s_add_u32 m0, s40, 89088
s_add_u32 s43, s38, 147456
buffer_load_dwordx4 v3, s[12:15], s43 offen lds
s_add_u32 m0, s40, 90112
s_add_u32 s43, s38, 196608
buffer_load_dwordx4 v2, s[12:15], s43 offen lds
s_add_u32 m0, s40, 91136
s_add_u32 s43, s38, 245760
buffer_load_dwordx4 v3, s[12:15], s43 offen lds
s_add_u32 m0, s40, 92160
s_add_u32 s43, s38, 294912
buffer_load_dwordx4 v2, s[12:15], s43 offen lds
s_add_u32 m0, s40, 93184
s_add_u32 s43, s38, 344064
buffer_load_dwordx4 v3, s[12:15], s43 offen lds
s_add_u32 s37, s37, 128
s_add_u32 s38, s38, 393216
s_load_dword s3, s[4:5], 143360
s_load_dword s3, s[4:5], 143424
s_load_dword s3, s[4:5], 143488
s_load_dword s3, s[4:5], 143552
s_load_dword s3, s[4:5], 150528
s_load_dword s3, s[4:5], 150592
s_load_dword s3, s[4:5], 150656
s_load_dword s3, s[4:5], 150720
s_load_dword s3, s[4:5], 157696
s_load_dword s3, s[4:5], 157760
s_load_dword s3, s[4:5], 157824
s_waitcnt vmcnt(14)
s_barrier
s_add_u32 m0, s39, 0
s_mov_b64 exec, s[60:61]
buffer_load_dwordx4 v4, s[8:11], s37 offen lds
s_mov_b64 exec, -1
s_add_u32 m0, s39, 3072
s_nop 0
buffer_load_dwordx4 v5, s[8:11], s37 offen lds
s_add_u32 m0, s39, 6144
s_nop 0
buffer_load_dwordx4 v6, s[8:11], s37 offen lds
s_add_u32 m0, s39, 9216
s_nop 0
buffer_load_dwordx4 v7, s[8:11], s37 offen lds
s_add_u32 m0, s39, 12288
s_nop 0
buffer_load_dwordx4 v8, s[8:11], s37 offen lds
s_add_u32 m0, s39, 15360
s_nop 0
buffer_load_dwordx4 v9, s[8:11], s37 offen lds
s_add_u32 m0, s40, 0
s_add_u32 s43, s38, 0
buffer_load_dwordx4 v2, s[12:15], s43 offen lds
s_add_u32 m0, s40, 1024
s_add_u32 s43, s38, 49152
buffer_load_dwordx4 v3, s[12:15], s43 offen lds
s_add_u32 m0, s40, 2048
s_add_u32 s43, s38, 98304
buffer_load_dwordx4 v2, s[12:15], s43 offen lds
s_add_u32 m0, s40, 3072
s_add_u32 s43, s38, 147456
buffer_load_dwordx4 v3, s[12:15], s43 offen lds
s_add_u32 m0, s40, 4096
s_add_u32 s43, s38, 196608
buffer_load_dwordx4 v2, s[12:15], s43 offen lds
s_add_u32 m0, s40, 5120
s_add_u32 s43, s38, 245760
buffer_load_dwordx4 v3, s[12:15], s43 offen lds
s_add_u32 m0, s40, 6144
s_add_u32 s43, s38, 294912
buffer_load_dwordx4 v2, s[12:15], s43 offen lds
s_add_u32 m0, s40, 7168
s_add_u32 s43, s38, 344064
buffer_load_dwordx4 v3, s[12:15], s43 offen lds
s_add_u32 s37, s37, 128
s_add_u32 s38, s38, 393216
s_load_dword s3, s[4:5], 157888
s_load_dword s3, s[4:5], 164864
s_load_dword s3, s[4:5], 164928
s_load_dword s3, s[4:5], 164992
s_load_dword s3, s[4:5], 165056
s_load_dword s3, s[4:5], 172032
s_load_dword s3, s[4:5], 172096
s_load_dword s3, s[4:5], 172160
s_load_dword s3, s[4:5], 172224
s_load_dword s3, s[4:5], 179200
s_load_dword s3, s[4:5], 179264
s_waitcnt vmcnt(14)
s_barrier
s_load_dword s3, s[4:5], 179328
s_load_dword s3, s[4:5], 179392
s_load_dword s3, s[4:5], 186368
s_load_dword s3, s[4:5], 186432
s_load_dword s3, s[4:5], 186496
s_load_dword s3, s[4:5], 186560
s_load_dword s3, s[4:5], 193536
s_branch Lov_1
.p2align 12
Lst_1_0:
s_branch Lwr_146
s_nop 0
s_nop 0
Lov_1:
s_load_dword s3, s[4:5], 193600
s_load_dword s3, s[4:5], 193664
s_load_dword s3, s[4:5], 193728
s_waitcnt vmcnt(0)
s_barrier
s_bitcmp0_b32 s2, 0
s_cselect_b32 s88, s72, s74
s_cselect_b32 s89, s73, s75
s_cmp_lt_u32 s2, 192
s_cselect_b32 s90, 7340032, 0
s_mov_b32 s91, 0x20000
s_bfe_u32 s44, s2, 0x30001
s_lshl_b32 s44, s44, 2
s_and_b32 s43, s36, 3
s_add_u32 s44, s44, s43
s_lshl_b32 s44, s44, 5
v_lshrrev_b32 v18, 4, v1
v_add_u32 v18, s44, v18
v_mul_u32_u24 v18, 7168, v18
v_and_b32 v19, 15, v1
v_lshl_add_u32 v18, v19, 4, v18
s_lshr_b32 s43, s2, 4
s_lshl_b32 s43, s43, 8
s_add_u32 s43, s43, 4096
v_add_u32 v18, s43, v18
s_mov_b32 s43, 0
buffer_load_dwordx4 v[128:131], v18, s[88:91], s43 offen
s_mov_b32 s43, 28672
buffer_load_dwordx4 v[132:135], v18, s[88:91], s43 offen
s_mov_b32 s43, 57344
buffer_load_dwordx4 v[136:139], v18, s[88:91], s43 offen
s_mov_b32 s43, 86016
buffer_load_dwordx4 v[140:143], v18, s[88:91], s43 offen
s_mov_b32 s43, 114688
buffer_load_dwordx4 v[144:147], v18, s[88:91], s43 offen
s_mov_b32 s43, 143360
buffer_load_dwordx4 v[148:151], v18, s[88:91], s43 offen
s_mov_b32 s43, 172032
buffer_load_dwordx4 v[152:155], v18, s[88:91], s43 offen
s_mov_b32 s43, 200704
buffer_load_dwordx4 v[156:159], v18, s[88:91], s43 offen
s_barrier
s_lshl_b32 s43, s35, 7
s_add_u32 s28, s68, s43
s_addc_u32 s29, s69, 0
s_mov_b32 s30, 2095232
s_mov_b32 s31, 0x20000
v_lshrrev_b32 v15, 3, v1
v_and_b32 v16, 6, v15
v_and_b32 v7, 7, v1
v_xor_b32 v7, v7, v16
v_lshlrev_b32 v7, 4, v7
v_mul_u32_u24 v15, 2048, v15
v_add_u32 v7, v7, v15
s_and_b32 s40, s36, 3
s_lshl_b32 s39, s40, 13
s_add_u32 s40, s40, s35
s_add_u32 s42, s40, 0
s_and_b32 s42, s42, 15
s_lshl_b32 s42, s42, 17
s_add_u32 m0, s39, 65536
s_add_u32 s43, s42, 0
buffer_load_dwordx4 v7, s[28:31], s43 offen lds
s_add_u32 m0, s39, 66560
s_add_u32 s43, s42, 16384
buffer_load_dwordx4 v7, s[28:31], s43 offen lds
s_add_u32 m0, s39, 67584
s_add_u32 s43, s42, 32768
buffer_load_dwordx4 v7, s[28:31], s43 offen lds
s_add_u32 m0, s39, 68608
s_add_u32 s43, s42, 49152
buffer_load_dwordx4 v7, s[28:31], s43 offen lds
s_add_u32 m0, s39, 69632
s_add_u32 s43, s42, 65536
buffer_load_dwordx4 v7, s[28:31], s43 offen lds
s_add_u32 m0, s39, 70656
s_add_u32 s43, s42, 81920
buffer_load_dwordx4 v7, s[28:31], s43 offen lds
s_add_u32 m0, s39, 71680
s_add_u32 s43, s42, 98304
buffer_load_dwordx4 v7, s[28:31], s43 offen lds
s_add_u32 m0, s39, 72704
s_add_u32 s43, s42, 114688
buffer_load_dwordx4 v7, s[28:31], s43 offen lds
s_branch Lats_6
Lcons_7:
s_lshl_b32 s43, s35, 7
s_waitcnt lgkmcnt(0)
s_mov_b32 s8, s64
s_mov_b32 s9, s65
s_mov_b32 s10, 4194304
s_mov_b32 s11, 0x20000
s_add_u32 s12, s66, s43
s_addc_u32 s13, s67, 0
s_mov_b32 s14, 6289536
s_mov_b32 s15, 0x20000
s_lshr_b32 s43, s2, 3
s_lshl_b32 s43, s43, 2
s_add_u32 s43, s43, s36
s_sub_u32 s44, s43, 0
s_and_b32 s44, s44, 127
s_cmp_lt_u32 s44, 24
s_cbranch_scc0 Lt_8
s_lshl_b32 s44, s44, 20
s_min_u32 s44, s44, 24117184
s_load_dword s3, s[82:83], s44 glc
Lt_8:
s_sub_u32 s44, s43, 24
s_and_b32 s44, s44, 127
s_cmp_lt_u32 s44, 8
s_cbranch_scc0 Lt_9
s_lshl_b32 s44, s44, 20
s_min_u32 s44, s44, 7339968
s_load_dword s3, s[72:73], s44
Lt_9:
s_sub_u32 s44, s43, 32
s_and_b32 s44, s44, 127
s_cmp_lt_u32 s44, 8
s_cbranch_scc0 Lt_10
s_lshl_b32 s44, s44, 20
s_min_u32 s44, s44, 7339968
s_load_dword s3, s[74:75], s44
Lt_10:
s_sub_u32 s44, s43, 40
s_and_b32 s44, s44, 127
s_cmp_lt_u32 s44, 3
s_cbranch_scc0 Lt_11
s_lshl_b32 s44, s44, 20
s_min_u32 s44, s44, 2097088
s_load_dword s3, s[68:69], s44
Lt_11:
s_sub_u32 s44, s43, 43
s_and_b32 s44, s44, 127
s_cmp_lt_u32 s44, 5
s_cbranch_scc0 Lt_12
s_lshl_b32 s44, s44, 20
s_min_u32 s44, s44, 4194240
s_add_u32 s44, s44, 25165824
s_load_dword s3, s[82:83], s44 glc
Lt_12:
s_sub_u32 s44, s43, 48
s_and_b32 s44, s44, 127
s_cmp_lt_u32 s44, 8
s_cbranch_scc0 Lt_13
s_lshl_b32 s44, s44, 20
s_min_u32 s44, s44, 7339968
s_load_dword s3, s[76:77], s44
Lt_13:
s_sub_u32 s44, s43, 56
s_and_b32 s44, s44, 127
s_cmp_lt_u32 s44, 5
s_cbranch_scc0 Lt_14
s_lshl_b32 s44, s44, 20
s_min_u32 s44, s44, 4194240
s_add_u32 s44, s44, 33554432
s_load_dword s3, s[82:83], s44 glc
Lt_14:
s_sub_u32 s44, s43, 61
s_and_b32 s44, s44, 127
s_cmp_lt_u32 s44, 5
s_cbranch_scc0 Lt_15
s_lshl_b32 s44, s44, 20
s_min_u32 s44, s44, 4194240
s_load_dword s3, s[78:79], s44 glc
Lt_15:
v_lshrrev_b32 v16, 1, v12
v_xor_b32 v15, v13, v16
v_lshlrev_b32 v15, 4, v15
v_lshl_add_u32 v2, v12, 7, v15
v_xor_b32 v3, 64, v2
v_add_u32 v4, 86016, v2
v_add_u32 v5, 86016, v3
v_lshrrev_b32 v15, 2, v12
v_and_b32 v16, 3, v1
v_lshl_add_u32 v19, v13, 3, v15
v_lshlrev_b32 v19, 7, v19
v_and_b32 v15, 2, v15
v_and_b32 v17, 1, v13
v_lshl_add_u32 v15, v17, 2, v15
v_lshrrev_b32 v17, 1, v16
s_lshl_b32 s43, s36, 1
v_add_u32 v17, s43, v17
v_xor_b32 v15, v15, v17
v_lshl_add_u32 v19, v15, 4, v19
v_and_b32 v16, 1, v16
v_lshl_add_u32 v19, v16, 3, v19
v_add_u32 v6, 18432, v19
v_add_u32 v7, 61440, v19
v_add_u32 v8, 104448, v19
s_and_b32 s43, s36, 1
s_bfe_u32 s44, s36, 0x10001
s_lshr_b32 s45, s36, 2
v_lshlrev_b32 v14, 2, v13
v_sub_u32 v14, v12, v14
v_mov_b32 v16, 0xff800000
s_or_b32 s46, s34, s45
s_cmp_lg_u32 s46, 0
s_cselect_b32 s46, 0, 0xff800000
v_subrev_u32 v15, 0, v14
v_cmp_ge_u32 vcc, 7, v15
v_add_u32 v15, 16, v15
s_nop 0
v_cndmask_b32 v248, v16, 0, vcc
v_cmp_ge_u32 vcc, 7, v15
s_nop 1
v_cndmask_b32 v244, v16, 0, vcc
v_or_b32 v240, s46, v244
v_subrev_u32 v15, 1, v14
v_cmp_ge_u32 vcc, 7, v15
v_add_u32 v15, 16, v15
s_nop 0
v_cndmask_b32 v249, v16, 0, vcc
v_cmp_ge_u32 vcc, 7, v15
s_nop 1
v_cndmask_b32 v245, v16, 0, vcc
v_or_b32 v241, s46, v245
v_subrev_u32 v15, 2, v14
v_cmp_ge_u32 vcc, 7, v15
v_add_u32 v15, 16, v15
s_nop 0
v_cndmask_b32 v250, v16, 0, vcc
v_cmp_ge_u32 vcc, 7, v15
s_nop 1
v_cndmask_b32 v246, v16, 0, vcc
v_or_b32 v242, s46, v246
v_subrev_u32 v15, 3, v14
v_cmp_ge_u32 vcc, 7, v15
v_add_u32 v15, 16, v15
s_nop 0
v_cndmask_b32 v251, v16, 0, vcc
v_cmp_ge_u32 vcc, 7, v15
s_nop 1
v_cndmask_b32 v247, v16, 0, vcc
v_or_b32 v243, s46, v247
s_lshl_b32 s46, s45, 6
s_add_u32 s46, s46, s44
s_add_u32 s46, s46, 16
v_lshl_add_u32 v14, v12, 1, s46
s_lshl_b32 s47, s43, 6
v_lshl_add_u32 v15, v13, 4, s47
v_mul_u32_u24 v20, 400, v14
v_add_u32 v20, v20, v15
v_subrev_u32 v16, 32, v14
v_max_i32 v16, 0, v16
v_mul_u32_u24 v21, 400, v16
v_add_u32 v21, v21, v15
v_lshrrev_b32 v16, 2, v12
v_lshl_add_u32 v16, v13, 2, v16
v_lshl_add_u32 v16, v16, 1, s46
v_and_b32 v17, 3, v1
v_lshl_add_u32 v17, v17, 3, s47
v_mul_u32_u24 v22, 400, v16
v_add_u32 v22, v22, v17
v_subrev_u32 v16, 32, v16
v_max_i32 v16, 0, v16
v_mul_u32_u24 v23, 400, v16
v_add_u32 v23, v23, v17
s_mul_i32 s60, s34, 262144
s_add_u32 s16, s82, s60
s_addc_u32 s17, s83, 0
s_mov_b32 s18, 262144
s_mov_b32 s19, 0x20000
s_lshl_b32 s60, s35, 14
s_lshl_b32 s43, s43, 13
s_add_u32 s60, s60, s43
s_lshl_b32 s43, s45, 12
s_add_u32 s60, s60, s43
s_lshl_b32 s43, s44, 10
s_add_u32 s60, s60, s43
v_lshlrev_b32 v24, 4, v1
s_mov_b32 s61, 0x3e8293ee
s_lshl_b32 s38, s35, 7
s_add_u32 s56, s82, 28311552
s_addc_u32 s57, s83, 0
s_mov_b32 s58, 114688
s_mov_b32 s59, 0x20000
s_barrier
ds_read_b128 v[32:35], v2 offset:0
ds_read_b64_tr_b16 v[72:73], v6 offset:8192
ds_read_b64_tr_b16 v[74:75], v6 offset:8704
ds_read_b64_tr_b16 v[76:77], v6 offset:16384
ds_read_b64_tr_b16 v[78:79], v6 offset:16896
ds_read_b64_tr_b16 v[68:69], v6 offset:0
ds_read_b64_tr_b16 v[70:71], v6 offset:512
ds_read_b128 v[36:39], v2 offset:2048
ds_read_b128 v[40:43], v2 offset:4096
ds_read_b128 v[44:47], v2 offset:6144
ds_read_b128 v[48:51], v2 offset:8192
ds_read_b128 v[52:55], v2 offset:10240
ds_read_b128 v[56:59], v2 offset:12288
ds_read_b128 v[60:63], v2 offset:14336
ds_read_b128 v[64:67], v2 offset:16384
s_waitcnt lgkmcnt(0)
v_mfma_f32_16x16x32_bf16 v[128:131], v[68:71], v[32:35], 0
ds_read_b128 v[80:83], v3 offset:0
v_mfma_f32_16x16x32_bf16 v[132:135], v[68:71], v[36:39], 0
ds_read_b64_tr_b16 v[120:121], v6 offset:12288
v_mfma_f32_16x16x32_bf16 v[136:139], v[68:71], v[40:43], 0
ds_read_b64_tr_b16 v[122:123], v6 offset:12800
v_mfma_f32_16x16x32_bf16 v[140:143], v[68:71], v[44:47], 0
ds_read_b64_tr_b16 v[124:125], v6 offset:20480
v_mfma_f32_16x16x32_bf16 v[144:147], v[68:71], v[48:51], 0
ds_read_b64_tr_b16 v[126:127], v6 offset:20992
v_mfma_f32_16x16x32_bf16 v[148:151], v[68:71], v[52:55], 0
ds_read_b64_tr_b16 v[116:117], v6 offset:4096
v_mfma_f32_16x16x32_bf16 v[152:155], v[68:71], v[56:59], 0
ds_read_b64_tr_b16 v[118:119], v6 offset:4608
v_mfma_f32_16x16x32_bf16 v[156:159], v[68:71], v[60:63], 0
ds_read_b128 v[84:87], v3 offset:2048
v_mfma_f32_16x16x32_bf16 v[160:163], v[68:71], v[64:67], 0
ds_read_b128 v[88:91], v3 offset:4096
v_mfma_f32_16x16x32_bf16 v[196:199], v[72:75], v[64:67], 0
ds_read_b128 v[92:95], v3 offset:6144
v_mfma_f32_16x16x32_bf16 v[192:195], v[72:75], v[60:63], 0
ds_read_b128 v[96:99], v3 offset:8192
v_mfma_f32_16x16x32_bf16 v[188:191], v[72:75], v[56:59], 0
ds_read_b128 v[100:103], v3 offset:10240
v_mfma_f32_16x16x32_bf16 v[184:187], v[72:75], v[52:55], 0
ds_read_b128 v[104:107], v3 offset:12288
v_mfma_f32_16x16x32_bf16 v[180:183], v[72:75], v[48:51], 0
ds_read_b128 v[108:111], v3 offset:14336
v_mfma_f32_16x16x32_bf16 v[176:179], v[72:75], v[44:47], 0
ds_read_b128 v[112:115], v3 offset:16384
v_mfma_f32_16x16x32_bf16 v[172:175], v[72:75], v[40:43], 0
v_mfma_f32_16x16x32_bf16 v[168:171], v[72:75], v[36:39], 0
v_mfma_f32_16x16x32_bf16 v[164:167], v[72:75], v[32:35], 0
v_mfma_f32_16x16x32_bf16 v[200:203], v[76:79], v[32:35], 0
v_mfma_f32_16x16x32_bf16 v[204:207], v[76:79], v[36:39], 0
v_mfma_f32_16x16x32_bf16 v[208:211], v[76:79], v[40:43], 0
v_mfma_f32_16x16x32_bf16 v[212:215], v[76:79], v[44:47], 0
v_mfma_f32_16x16x32_bf16 v[216:219], v[76:79], v[48:51], 0
v_mfma_f32_16x16x32_bf16 v[220:223], v[76:79], v[52:55], 0
v_mfma_f32_16x16x32_bf16 v[224:227], v[76:79], v[56:59], 0
v_mfma_f32_16x16x32_bf16 v[228:231], v[76:79], v[60:63], 0
v_mfma_f32_16x16x32_bf16 v[232:235], v[76:79], v[64:67], 0
s_waitcnt lgkmcnt(0)
s_barrier
v_mfma_f32_16x16x32_bf16 v[128:131], v[116:119], v[80:83], v[128:131]
ds_read_b128 v[32:35], v2 offset:43008
v_mfma_f32_16x16x32_bf16 v[132:135], v[116:119], v[84:87], v[132:135]
ds_read_b64_tr_b16 v[72:73], v7 offset:8192
v_mfma_f32_16x16x32_bf16 v[136:139], v[116:119], v[88:91], v[136:139]
ds_read_b64_tr_b16 v[74:75], v7 offset:8704
v_mfma_f32_16x16x32_bf16 v[140:143], v[116:119], v[92:95], v[140:143]
ds_read_b64_tr_b16 v[76:77], v7 offset:16384
v_mfma_f32_16x16x32_bf16 v[144:147], v[116:119], v[96:99], v[144:147]
ds_read_b64_tr_b16 v[78:79], v7 offset:16896
v_mfma_f32_16x16x32_bf16 v[148:151], v[116:119], v[100:103], v[148:151]
ds_read_b64_tr_b16 v[68:69], v7 offset:0
v_mfma_f32_16x16x32_bf16 v[152:155], v[116:119], v[104:107], v[152:155]
ds_read_b64_tr_b16 v[70:71], v7 offset:512
v_mfma_f32_16x16x32_bf16 v[156:159], v[116:119], v[108:111], v[156:159]
ds_read_b128 v[36:39], v2 offset:45056
v_mfma_f32_16x16x32_bf16 v[160:163], v[116:119], v[112:115], v[160:163]
ds_read_b128 v[40:43], v2 offset:47104
v_mfma_f32_16x16x32_bf16 v[196:199], v[120:123], v[112:115], v[196:199]
ds_read_b128 v[44:47], v2 offset:49152
v_mfma_f32_16x16x32_bf16 v[192:195], v[120:123], v[108:111], v[192:195]
ds_read_b128 v[48:51], v2 offset:51200
v_mfma_f32_16x16x32_bf16 v[188:191], v[120:123], v[104:107], v[188:191]
ds_read_b128 v[52:55], v2 offset:53248
v_mfma_f32_16x16x32_bf16 v[184:187], v[120:123], v[100:103], v[184:187]
ds_read_b128 v[56:59], v2 offset:55296
v_mfma_f32_16x16x32_bf16 v[180:183], v[120:123], v[96:99], v[180:183]
ds_read_b128 v[60:63], v2 offset:57344
v_mfma_f32_16x16x32_bf16 v[176:179], v[120:123], v[92:95], v[176:179]
ds_read_b128 v[64:67], v2 offset:59392
v_mfma_f32_16x16x32_bf16 v[172:175], v[120:123], v[88:91], v[172:175]
v_mfma_f32_16x16x32_bf16 v[168:171], v[120:123], v[84:87], v[168:171]
v_mfma_f32_16x16x32_bf16 v[164:167], v[120:123], v[80:83], v[164:167]
v_mfma_f32_16x16x32_bf16 v[200:203], v[124:127], v[80:83], v[200:203]
v_mfma_f32_16x16x32_bf16 v[204:207], v[124:127], v[84:87], v[204:207]
v_mfma_f32_16x16x32_bf16 v[208:211], v[124:127], v[88:91], v[208:211]
v_mfma_f32_16x16x32_bf16 v[212:215], v[124:127], v[92:95], v[212:215]
v_mfma_f32_16x16x32_bf16 v[216:219], v[124:127], v[96:99], v[216:219]
v_mfma_f32_16x16x32_bf16 v[220:223], v[124:127], v[100:103], v[220:223]
v_mfma_f32_16x16x32_bf16 v[224:227], v[124:127], v[104:107], v[224:227]
v_mfma_f32_16x16x32_bf16 v[228:231], v[124:127], v[108:111], v[228:231]
v_mfma_f32_16x16x32_bf16 v[232:235], v[124:127], v[112:115], v[232:235]
s_waitcnt lgkmcnt(0)
v_mfma_f32_16x16x32_bf16 v[128:131], v[68:71], v[32:35], v[128:131]
ds_read_b128 v[80:83], v3 offset:43008
v_mfma_f32_16x16x32_bf16 v[132:135], v[68:71], v[36:39], v[132:135]
ds_read_b64_tr_b16 v[120:121], v7 offset:12288
v_mfma_f32_16x16x32_bf16 v[136:139], v[68:71], v[40:43], v[136:139]
ds_read_b64_tr_b16 v[122:123], v7 offset:12800
v_mfma_f32_16x16x32_bf16 v[140:143], v[68:71], v[44:47], v[140:143]
ds_read_b64_tr_b16 v[124:125], v7 offset:20480
v_mfma_f32_16x16x32_bf16 v[144:147], v[68:71], v[48:51], v[144:147]
ds_read_b64_tr_b16 v[126:127], v7 offset:20992
v_mfma_f32_16x16x32_bf16 v[148:151], v[68:71], v[52:55], v[148:151]
ds_read_b64_tr_b16 v[116:117], v7 offset:4096
v_mfma_f32_16x16x32_bf16 v[152:155], v[68:71], v[56:59], v[152:155]
ds_read_b64_tr_b16 v[118:119], v7 offset:4608
v_mfma_f32_16x16x32_bf16 v[156:159], v[68:71], v[60:63], v[156:159]
ds_read_b128 v[84:87], v3 offset:45056
v_mfma_f32_16x16x32_bf16 v[160:163], v[68:71], v[64:67], v[160:163]
ds_read_b128 v[88:91], v3 offset:47104
v_mfma_f32_16x16x32_bf16 v[196:199], v[72:75], v[64:67], v[196:199]
ds_read_b128 v[92:95], v3 offset:49152
v_mfma_f32_16x16x32_bf16 v[192:195], v[72:75], v[60:63], v[192:195]
ds_read_b128 v[96:99], v3 offset:51200
v_mfma_f32_16x16x32_bf16 v[188:191], v[72:75], v[56:59], v[188:191]
ds_read_b128 v[100:103], v3 offset:53248
v_mfma_f32_16x16x32_bf16 v[184:187], v[72:75], v[52:55], v[184:187]
ds_read_b128 v[104:107], v3 offset:55296
v_mfma_f32_16x16x32_bf16 v[180:183], v[72:75], v[48:51], v[180:183]
ds_read_b128 v[108:111], v3 offset:57344
v_mfma_f32_16x16x32_bf16 v[176:179], v[72:75], v[44:47], v[176:179]
ds_read_b128 v[112:115], v3 offset:59392
v_mfma_f32_16x16x32_bf16 v[172:175], v[72:75], v[40:43], v[172:175]
v_mfma_f32_16x16x32_bf16 v[168:171], v[72:75], v[36:39], v[168:171]
v_mfma_f32_16x16x32_bf16 v[164:167], v[72:75], v[32:35], v[164:167]
v_mfma_f32_16x16x32_bf16 v[200:203], v[76:79], v[32:35], v[200:203]
v_mfma_f32_16x16x32_bf16 v[204:207], v[76:79], v[36:39], v[204:207]
v_mfma_f32_16x16x32_bf16 v[208:211], v[76:79], v[40:43], v[208:211]
v_mfma_f32_16x16x32_bf16 v[212:215], v[76:79], v[44:47], v[212:215]
v_mfma_f32_16x16x32_bf16 v[216:219], v[76:79], v[48:51], v[216:219]
v_mfma_f32_16x16x32_bf16 v[220:223], v[76:79], v[52:55], v[220:223]
v_mfma_f32_16x16x32_bf16 v[224:227], v[76:79], v[56:59], v[224:227]
v_mfma_f32_16x16x32_bf16 v[228:231], v[76:79], v[60:63], v[228:231]
v_mfma_f32_16x16x32_bf16 v[232:235], v[76:79], v[64:67], v[232:235]
s_waitcnt lgkmcnt(0)
s_barrier
v_mfma_f32_16x16x32_bf16 v[128:131], v[116:119], v[80:83], v[128:131]
ds_read_b128 v[32:35], v4 offset:0
v_mfma_f32_16x16x32_bf16 v[132:135], v[116:119], v[84:87], v[132:135]
ds_read_b64_tr_b16 v[72:73], v8 offset:8192
v_mfma_f32_16x16x32_bf16 v[136:139], v[116:119], v[88:91], v[136:139]
ds_read_b64_tr_b16 v[74:75], v8 offset:8704
v_mfma_f32_16x16x32_bf16 v[140:143], v[116:119], v[92:95], v[140:143]
ds_read_b64_tr_b16 v[76:77], v8 offset:16384
v_mfma_f32_16x16x32_bf16 v[144:147], v[116:119], v[96:99], v[144:147]
ds_read_b64_tr_b16 v[78:79], v8 offset:16896
v_mfma_f32_16x16x32_bf16 v[148:151], v[116:119], v[100:103], v[148:151]
ds_read_b64_tr_b16 v[68:69], v8 offset:0
v_mfma_f32_16x16x32_bf16 v[152:155], v[116:119], v[104:107], v[152:155]
ds_read_b64_tr_b16 v[70:71], v8 offset:512
v_mfma_f32_16x16x32_bf16 v[156:159], v[116:119], v[108:111], v[156:159]
ds_read_b128 v[36:39], v4 offset:2048
v_mfma_f32_16x16x32_bf16 v[160:163], v[116:119], v[112:115], v[160:163]
ds_read_b128 v[40:43], v4 offset:4096
v_mfma_f32_16x16x32_bf16 v[196:199], v[120:123], v[112:115], v[196:199]
ds_read_b128 v[44:47], v4 offset:6144
v_mfma_f32_16x16x32_bf16 v[192:195], v[120:123], v[108:111], v[192:195]
ds_read_b128 v[48:51], v4 offset:8192
v_mfma_f32_16x16x32_bf16 v[188:191], v[120:123], v[104:107], v[188:191]
ds_read_b128 v[52:55], v4 offset:10240
v_mfma_f32_16x16x32_bf16 v[184:187], v[120:123], v[100:103], v[184:187]
ds_read_b128 v[56:59], v4 offset:12288
v_mfma_f32_16x16x32_bf16 v[180:183], v[120:123], v[96:99], v[180:183]
ds_read_b128 v[60:63], v4 offset:14336
v_mfma_f32_16x16x32_bf16 v[176:179], v[120:123], v[92:95], v[176:179]
ds_read_b128 v[64:67], v4 offset:16384
v_mfma_f32_16x16x32_bf16 v[172:175], v[120:123], v[88:91], v[172:175]
v_mfma_f32_16x16x32_bf16 v[168:171], v[120:123], v[84:87], v[168:171]
v_mfma_f32_16x16x32_bf16 v[164:167], v[120:123], v[80:83], v[164:167]
v_mfma_f32_16x16x32_bf16 v[200:203], v[124:127], v[80:83], v[200:203]
v_mfma_f32_16x16x32_bf16 v[204:207], v[124:127], v[84:87], v[204:207]
v_mfma_f32_16x16x32_bf16 v[208:211], v[124:127], v[88:91], v[208:211]
v_mfma_f32_16x16x32_bf16 v[212:215], v[124:127], v[92:95], v[212:215]
v_mfma_f32_16x16x32_bf16 v[216:219], v[124:127], v[96:99], v[216:219]
v_mfma_f32_16x16x32_bf16 v[220:223], v[124:127], v[100:103], v[220:223]
v_mfma_f32_16x16x32_bf16 v[224:227], v[124:127], v[104:107], v[224:227]
v_mfma_f32_16x16x32_bf16 v[228:231], v[124:127], v[108:111], v[228:231]
v_mfma_f32_16x16x32_bf16 v[232:235], v[124:127], v[112:115], v[232:235]
s_waitcnt lgkmcnt(0)
v_mfma_f32_16x16x32_bf16 v[128:131], v[68:71], v[32:35], v[128:131]
ds_read_b128 v[80:83], v5 offset:0
v_mfma_f32_16x16x32_bf16 v[132:135], v[68:71], v[36:39], v[132:135]
ds_read_b64_tr_b16 v[120:121], v8 offset:12288
v_mfma_f32_16x16x32_bf16 v[136:139], v[68:71], v[40:43], v[136:139]
ds_read_b64_tr_b16 v[122:123], v8 offset:12800
v_mfma_f32_16x16x32_bf16 v[140:143], v[68:71], v[44:47], v[140:143]
ds_read_b64_tr_b16 v[124:125], v8 offset:20480
v_mfma_f32_16x16x32_bf16 v[144:147], v[68:71], v[48:51], v[144:147]
ds_read_b64_tr_b16 v[126:127], v8 offset:20992
v_mfma_f32_16x16x32_bf16 v[148:151], v[68:71], v[52:55], v[148:151]
ds_read_b64_tr_b16 v[116:117], v8 offset:4096
v_mfma_f32_16x16x32_bf16 v[152:155], v[68:71], v[56:59], v[152:155]
ds_read_b64_tr_b16 v[118:119], v8 offset:4608
v_mfma_f32_16x16x32_bf16 v[156:159], v[68:71], v[60:63], v[156:159]
ds_read_b128 v[84:87], v5 offset:2048
v_mfma_f32_16x16x32_bf16 v[160:163], v[68:71], v[64:67], v[160:163]
ds_read_b128 v[88:91], v5 offset:4096
v_mfma_f32_16x16x32_bf16 v[196:199], v[72:75], v[64:67], v[196:199]
ds_read_b128 v[92:95], v5 offset:6144
v_mfma_f32_16x16x32_bf16 v[192:195], v[72:75], v[60:63], v[192:195]
ds_read_b128 v[96:99], v5 offset:8192
v_mfma_f32_16x16x32_bf16 v[188:191], v[72:75], v[56:59], v[188:191]
ds_read_b128 v[100:103], v5 offset:10240
v_mfma_f32_16x16x32_bf16 v[184:187], v[72:75], v[52:55], v[184:187]
ds_read_b128 v[104:107], v5 offset:12288
v_mfma_f32_16x16x32_bf16 v[180:183], v[72:75], v[48:51], v[180:183]
ds_read_b128 v[108:111], v5 offset:14336
v_mfma_f32_16x16x32_bf16 v[176:179], v[72:75], v[44:47], v[176:179]
ds_read_b128 v[112:115], v5 offset:16384
v_mfma_f32_16x16x32_bf16 v[172:175], v[72:75], v[40:43], v[172:175]
v_mfma_f32_16x16x32_bf16 v[168:171], v[72:75], v[36:39], v[168:171]
v_mfma_f32_16x16x32_bf16 v[164:167], v[72:75], v[32:35], v[164:167]
v_mfma_f32_16x16x32_bf16 v[200:203], v[76:79], v[32:35], v[200:203]
v_mfma_f32_16x16x32_bf16 v[204:207], v[76:79], v[36:39], v[204:207]
v_mfma_f32_16x16x32_bf16 v[208:211], v[76:79], v[40:43], v[208:211]
v_mfma_f32_16x16x32_bf16 v[212:215], v[76:79], v[44:47], v[212:215]
v_mfma_f32_16x16x32_bf16 v[216:219], v[76:79], v[48:51], v[216:219]
v_mfma_f32_16x16x32_bf16 v[220:223], v[76:79], v[52:55], v[220:223]
v_mfma_f32_16x16x32_bf16 v[224:227], v[76:79], v[56:59], v[224:227]
v_mfma_f32_16x16x32_bf16 v[228:231], v[76:79], v[60:63], v[228:231]
v_mfma_f32_16x16x32_bf16 v[232:235], v[76:79], v[64:67], v[232:235]
s_waitcnt lgkmcnt(0)
s_barrier
v_mfma_f32_16x16x32_bf16 v[128:131], v[116:119], v[80:83], v[128:131]
ds_read_b128 v[32:35], v2 offset:0
v_mfma_f32_16x16x32_bf16 v[132:135], v[116:119], v[84:87], v[132:135]
ds_read_b64_tr_b16 v[72:73], v6 offset:8192
v_mfma_f32_16x16x32_bf16 v[136:139], v[116:119], v[88:91], v[136:139]
ds_read_b64_tr_b16 v[74:75], v6 offset:8704
v_mfma_f32_16x16x32_bf16 v[140:143], v[116:119], v[92:95], v[140:143]
ds_read_b64_tr_b16 v[76:77], v6 offset:16384
v_mfma_f32_16x16x32_bf16 v[144:147], v[116:119], v[96:99], v[144:147]
ds_read_b64_tr_b16 v[78:79], v6 offset:16896
v_mfma_f32_16x16x32_bf16 v[148:151], v[116:119], v[100:103], v[148:151]
ds_read_b64_tr_b16 v[68:69], v6 offset:0
v_mfma_f32_16x16x32_bf16 v[152:155], v[116:119], v[104:107], v[152:155]
ds_read_b64_tr_b16 v[70:71], v6 offset:512
v_mfma_f32_16x16x32_bf16 v[156:159], v[116:119], v[108:111], v[156:159]
ds_read_b128 v[36:39], v2 offset:2048
v_mfma_f32_16x16x32_bf16 v[160:163], v[116:119], v[112:115], v[160:163]
ds_read_b128 v[40:43], v2 offset:4096
v_mfma_f32_16x16x32_bf16 v[196:199], v[120:123], v[112:115], v[196:199]
ds_read_b128 v[44:47], v2 offset:6144
v_mfma_f32_16x16x32_bf16 v[192:195], v[120:123], v[108:111], v[192:195]
ds_read_b128 v[48:51], v2 offset:8192
v_mfma_f32_16x16x32_bf16 v[188:191], v[120:123], v[104:107], v[188:191]
ds_read_b128 v[52:55], v2 offset:10240
v_mfma_f32_16x16x32_bf16 v[184:187], v[120:123], v[100:103], v[184:187]
ds_read_b128 v[56:59], v2 offset:12288
v_mfma_f32_16x16x32_bf16 v[180:183], v[120:123], v[96:99], v[180:183]
ds_read_b128 v[60:63], v2 offset:14336
v_mfma_f32_16x16x32_bf16 v[176:179], v[120:123], v[92:95], v[176:179]
ds_read_b128 v[64:67], v2 offset:16384
v_mfma_f32_16x16x32_bf16 v[172:175], v[120:123], v[88:91], v[172:175]
v_mfma_f32_16x16x32_bf16 v[168:171], v[120:123], v[84:87], v[168:171]
v_mfma_f32_16x16x32_bf16 v[164:167], v[120:123], v[80:83], v[164:167]
v_mfma_f32_16x16x32_bf16 v[200:203], v[124:127], v[80:83], v[200:203]
v_mfma_f32_16x16x32_bf16 v[204:207], v[124:127], v[84:87], v[204:207]
v_mfma_f32_16x16x32_bf16 v[208:211], v[124:127], v[88:91], v[208:211]
v_mfma_f32_16x16x32_bf16 v[212:215], v[124:127], v[92:95], v[212:215]
v_mfma_f32_16x16x32_bf16 v[216:219], v[124:127], v[96:99], v[216:219]
v_mfma_f32_16x16x32_bf16 v[220:223], v[124:127], v[100:103], v[220:223]
v_mfma_f32_16x16x32_bf16 v[224:227], v[124:127], v[104:107], v[224:227]
v_mfma_f32_16x16x32_bf16 v[228:231], v[124:127], v[108:111], v[228:231]
v_mfma_f32_16x16x32_bf16 v[232:235], v[124:127], v[112:115], v[232:235]
s_mov_b32 s41, 4
Lcl_16:
s_waitcnt lgkmcnt(0)
v_mfma_f32_16x16x32_bf16 v[128:131], v[68:71], v[32:35], v[128:131]
ds_read_b128 v[80:83], v3 offset:0
v_mfma_f32_16x16x32_bf16 v[132:135], v[68:71], v[36:39], v[132:135]
ds_read_b64_tr_b16 v[120:121], v6 offset:12288
v_mfma_f32_16x16x32_bf16 v[136:139], v[68:71], v[40:43], v[136:139]
ds_read_b64_tr_b16 v[122:123], v6 offset:12800
v_mfma_f32_16x16x32_bf16 v[140:143], v[68:71], v[44:47], v[140:143]
ds_read_b64_tr_b16 v[124:125], v6 offset:20480
v_mfma_f32_16x16x32_bf16 v[144:147], v[68:71], v[48:51], v[144:147]
ds_read_b64_tr_b16 v[126:127], v6 offset:20992
v_mfma_f32_16x16x32_bf16 v[148:151], v[68:71], v[52:55], v[148:151]
ds_read_b64_tr_b16 v[116:117], v6 offset:4096
v_mfma_f32_16x16x32_bf16 v[152:155], v[68:71], v[56:59], v[152:155]
ds_read_b64_tr_b16 v[118:119], v6 offset:4608
v_mfma_f32_16x16x32_bf16 v[156:159], v[68:71], v[60:63], v[156:159]
ds_read_b128 v[84:87], v3 offset:2048
v_mfma_f32_16x16x32_bf16 v[160:163], v[68:71], v[64:67], v[160:163]
ds_read_b128 v[88:91], v3 offset:4096
v_mfma_f32_16x16x32_bf16 v[196:199], v[72:75], v[64:67], v[196:199]
ds_read_b128 v[92:95], v3 offset:6144
v_mfma_f32_16x16x32_bf16 v[192:195], v[72:75], v[60:63], v[192:195]
ds_read_b128 v[96:99], v3 offset:8192
v_mfma_f32_16x16x32_bf16 v[188:191], v[72:75], v[56:59], v[188:191]
ds_read_b128 v[100:103], v3 offset:10240
v_mfma_f32_16x16x32_bf16 v[184:187], v[72:75], v[52:55], v[184:187]
ds_read_b128 v[104:107], v3 offset:12288
v_mfma_f32_16x16x32_bf16 v[180:183], v[72:75], v[48:51], v[180:183]
ds_read_b128 v[108:111], v3 offset:14336
v_mfma_f32_16x16x32_bf16 v[176:179], v[72:75], v[44:47], v[176:179]
ds_read_b128 v[112:115], v3 offset:16384
v_mfma_f32_16x16x32_bf16 v[172:175], v[72:75], v[40:43], v[172:175]
v_mfma_f32_16x16x32_bf16 v[168:171], v[72:75], v[36:39], v[168:171]
v_mfma_f32_16x16x32_bf16 v[164:167], v[72:75], v[32:35], v[164:167]
v_mfma_f32_16x16x32_bf16 v[200:203], v[76:79], v[32:35], v[200:203]
v_mfma_f32_16x16x32_bf16 v[204:207], v[76:79], v[36:39], v[204:207]
v_mfma_f32_16x16x32_bf16 v[208:211], v[76:79], v[40:43], v[208:211]
v_mfma_f32_16x16x32_bf16 v[212:215], v[76:79], v[44:47], v[212:215]
v_mfma_f32_16x16x32_bf16 v[216:219], v[76:79], v[48:51], v[216:219]
v_mfma_f32_16x16x32_bf16 v[220:223], v[76:79], v[52:55], v[220:223]
v_mfma_f32_16x16x32_bf16 v[224:227], v[76:79], v[56:59], v[224:227]
v_mfma_f32_16x16x32_bf16 v[228:231], v[76:79], v[60:63], v[228:231]
v_mfma_f32_16x16x32_bf16 v[232:235], v[76:79], v[64:67], v[232:235]
s_waitcnt lgkmcnt(0)
s_barrier
v_mfma_f32_16x16x32_bf16 v[128:131], v[116:119], v[80:83], v[128:131]
s_branch Lov_2
.p2align 12
.fill 16, 4, 0xbf800000
Lst_2_0:
s_branch Lwr_147
s_nop 0
s_nop 0
Lov_2:
ds_read_b128 v[32:35], v2 offset:43008
v_mfma_f32_16x16x32_bf16 v[132:135], v[116:119], v[84:87], v[132:135]
ds_read_b64_tr_b16 v[72:73], v7 offset:8192
v_mfma_f32_16x16x32_bf16 v[136:139], v[116:119], v[88:91], v[136:139]
ds_read_b64_tr_b16 v[74:75], v7 offset:8704
v_mfma_f32_16x16x32_bf16 v[140:143], v[116:119], v[92:95], v[140:143]
ds_read_b64_tr_b16 v[76:77], v7 offset:16384
v_mfma_f32_16x16x32_bf16 v[144:147], v[116:119], v[96:99], v[144:147]
ds_read_b64_tr_b16 v[78:79], v7 offset:16896
v_mfma_f32_16x16x32_bf16 v[148:151], v[116:119], v[100:103], v[148:151]
ds_read_b64_tr_b16 v[68:69], v7 offset:0
v_mfma_f32_16x16x32_bf16 v[152:155], v[116:119], v[104:107], v[152:155]
ds_read_b64_tr_b16 v[70:71], v7 offset:512
v_mfma_f32_16x16x32_bf16 v[156:159], v[116:119], v[108:111], v[156:159]
ds_read_b128 v[36:39], v2 offset:45056
v_mfma_f32_16x16x32_bf16 v[160:163], v[116:119], v[112:115], v[160:163]
ds_read_b128 v[40:43], v2 offset:47104
v_mfma_f32_16x16x32_bf16 v[196:199], v[120:123], v[112:115], v[196:199]
ds_read_b128 v[44:47], v2 offset:49152
v_mfma_f32_16x16x32_bf16 v[192:195], v[120:123], v[108:111], v[192:195]
ds_read_b128 v[48:51], v2 offset:51200
v_mfma_f32_16x16x32_bf16 v[188:191], v[120:123], v[104:107], v[188:191]
ds_read_b128 v[52:55], v2 offset:53248
v_mfma_f32_16x16x32_bf16 v[184:187], v[120:123], v[100:103], v[184:187]
ds_read_b128 v[56:59], v2 offset:55296
v_mfma_f32_16x16x32_bf16 v[180:183], v[120:123], v[96:99], v[180:183]
ds_read_b128 v[60:63], v2 offset:57344
v_mfma_f32_16x16x32_bf16 v[176:179], v[120:123], v[92:95], v[176:179]
ds_read_b128 v[64:67], v2 offset:59392
v_mfma_f32_16x16x32_bf16 v[172:175], v[120:123], v[88:91], v[172:175]
v_mfma_f32_16x16x32_bf16 v[168:171], v[120:123], v[84:87], v[168:171]
v_mfma_f32_16x16x32_bf16 v[164:167], v[120:123], v[80:83], v[164:167]
v_mfma_f32_16x16x32_bf16 v[200:203], v[124:127], v[80:83], v[200:203]
v_mfma_f32_16x16x32_bf16 v[204:207], v[124:127], v[84:87], v[204:207]
v_mfma_f32_16x16x32_bf16 v[208:211], v[124:127], v[88:91], v[208:211]
v_mfma_f32_16x16x32_bf16 v[212:215], v[124:127], v[92:95], v[212:215]
v_mfma_f32_16x16x32_bf16 v[216:219], v[124:127], v[96:99], v[216:219]
v_mfma_f32_16x16x32_bf16 v[220:223], v[124:127], v[100:103], v[220:223]
v_mfma_f32_16x16x32_bf16 v[224:227], v[124:127], v[104:107], v[224:227]
v_mfma_f32_16x16x32_bf16 v[228:231], v[124:127], v[108:111], v[228:231]
v_mfma_f32_16x16x32_bf16 v[232:235], v[124:127], v[112:115], v[232:235]
s_waitcnt lgkmcnt(0)
v_mfma_f32_16x16x32_bf16 v[128:131], v[68:71], v[32:35], v[128:131]
ds_read_b128 v[80:83], v3 offset:43008
v_mfma_f32_16x16x32_bf16 v[132:135], v[68:71], v[36:39], v[132:135]
ds_read_b64_tr_b16 v[120:121], v7 offset:12288
v_mfma_f32_16x16x32_bf16 v[136:139], v[68:71], v[40:43], v[136:139]
ds_read_b64_tr_b16 v[122:123], v7 offset:12800
v_mfma_f32_16x16x32_bf16 v[140:143], v[68:71], v[44:47], v[140:143]
ds_read_b64_tr_b16 v[124:125], v7 offset:20480
v_mfma_f32_16x16x32_bf16 v[144:147], v[68:71], v[48:51], v[144:147]
ds_read_b64_tr_b16 v[126:127], v7 offset:20992
v_mfma_f32_16x16x32_bf16 v[148:151], v[68:71], v[52:55], v[148:151]
ds_read_b64_tr_b16 v[116:117], v7 offset:4096
v_mfma_f32_16x16x32_bf16 v[152:155], v[68:71], v[56:59], v[152:155]
ds_read_b64_tr_b16 v[118:119], v7 offset:4608
v_mfma_f32_16x16x32_bf16 v[156:159], v[68:71], v[60:63], v[156:159]
ds_read_b128 v[84:87], v3 offset:45056
v_mfma_f32_16x16x32_bf16 v[160:163], v[68:71], v[64:67], v[160:163]
ds_read_b128 v[88:91], v3 offset:47104
v_mfma_f32_16x16x32_bf16 v[196:199], v[72:75], v[64:67], v[196:199]
ds_read_b128 v[92:95], v3 offset:49152
v_mfma_f32_16x16x32_bf16 v[192:195], v[72:75], v[60:63], v[192:195]
ds_read_b128 v[96:99], v3 offset:51200
v_mfma_f32_16x16x32_bf16 v[188:191], v[72:75], v[56:59], v[188:191]
ds_read_b128 v[100:103], v3 offset:53248
v_mfma_f32_16x16x32_bf16 v[184:187], v[72:75], v[52:55], v[184:187]
ds_read_b128 v[104:107], v3 offset:55296
v_mfma_f32_16x16x32_bf16 v[180:183], v[72:75], v[48:51], v[180:183]
ds_read_b128 v[108:111], v3 offset:57344
v_mfma_f32_16x16x32_bf16 v[176:179], v[72:75], v[44:47], v[176:179]
ds_read_b128 v[112:115], v3 offset:59392
v_mfma_f32_16x16x32_bf16 v[172:175], v[72:75], v[40:43], v[172:175]
v_mfma_f32_16x16x32_bf16 v[168:171], v[72:75], v[36:39], v[168:171]
v_mfma_f32_16x16x32_bf16 v[164:167], v[72:75], v[32:35], v[164:167]
v_mfma_f32_16x16x32_bf16 v[200:203], v[76:79], v[32:35], v[200:203]
v_mfma_f32_16x16x32_bf16 v[204:207], v[76:79], v[36:39], v[204:207]
v_mfma_f32_16x16x32_bf16 v[208:211], v[76:79], v[40:43], v[208:211]
v_mfma_f32_16x16x32_bf16 v[212:215], v[76:79], v[44:47], v[212:215]
v_mfma_f32_16x16x32_bf16 v[216:219], v[76:79], v[48:51], v[216:219]
v_mfma_f32_16x16x32_bf16 v[220:223], v[76:79], v[52:55], v[220:223]
v_mfma_f32_16x16x32_bf16 v[224:227], v[76:79], v[56:59], v[224:227]
v_mfma_f32_16x16x32_bf16 v[228:231], v[76:79], v[60:63], v[228:231]
v_mfma_f32_16x16x32_bf16 v[232:235], v[76:79], v[64:67], v[232:235]
s_waitcnt lgkmcnt(0)
s_barrier
v_mfma_f32_16x16x32_bf16 v[128:131], v[116:119], v[80:83], v[128:131]
ds_read_b128 v[32:35], v4 offset:0
v_mfma_f32_16x16x32_bf16 v[132:135], v[116:119], v[84:87], v[132:135]
ds_read_b64_tr_b16 v[72:73], v8 offset:8192
v_mfma_f32_16x16x32_bf16 v[136:139], v[116:119], v[88:91], v[136:139]
ds_read_b64_tr_b16 v[74:75], v8 offset:8704
v_mfma_f32_16x16x32_bf16 v[140:143], v[116:119], v[92:95], v[140:143]
ds_read_b64_tr_b16 v[76:77], v8 offset:16384
v_mfma_f32_16x16x32_bf16 v[144:147], v[116:119], v[96:99], v[144:147]
ds_read_b64_tr_b16 v[78:79], v8 offset:16896
v_mfma_f32_16x16x32_bf16 v[148:151], v[116:119], v[100:103], v[148:151]
ds_read_b64_tr_b16 v[68:69], v8 offset:0
v_mfma_f32_16x16x32_bf16 v[152:155], v[116:119], v[104:107], v[152:155]
ds_read_b64_tr_b16 v[70:71], v8 offset:512
v_mfma_f32_16x16x32_bf16 v[156:159], v[116:119], v[108:111], v[156:159]
ds_read_b128 v[36:39], v4 offset:2048
v_mfma_f32_16x16x32_bf16 v[160:163], v[116:119], v[112:115], v[160:163]
ds_read_b128 v[40:43], v4 offset:4096
v_mfma_f32_16x16x32_bf16 v[196:199], v[120:123], v[112:115], v[196:199]
ds_read_b128 v[44:47], v4 offset:6144
v_mfma_f32_16x16x32_bf16 v[192:195], v[120:123], v[108:111], v[192:195]
ds_read_b128 v[48:51], v4 offset:8192
v_mfma_f32_16x16x32_bf16 v[188:191], v[120:123], v[104:107], v[188:191]
ds_read_b128 v[52:55], v4 offset:10240
v_mfma_f32_16x16x32_bf16 v[184:187], v[120:123], v[100:103], v[184:187]
ds_read_b128 v[56:59], v4 offset:12288
v_mfma_f32_16x16x32_bf16 v[180:183], v[120:123], v[96:99], v[180:183]
ds_read_b128 v[60:63], v4 offset:14336
v_mfma_f32_16x16x32_bf16 v[176:179], v[120:123], v[92:95], v[176:179]
ds_read_b128 v[64:67], v4 offset:16384
v_mfma_f32_16x16x32_bf16 v[172:175], v[120:123], v[88:91], v[172:175]
v_mfma_f32_16x16x32_bf16 v[168:171], v[120:123], v[84:87], v[168:171]
v_mfma_f32_16x16x32_bf16 v[164:167], v[120:123], v[80:83], v[164:167]
v_mfma_f32_16x16x32_bf16 v[200:203], v[124:127], v[80:83], v[200:203]
v_mfma_f32_16x16x32_bf16 v[204:207], v[124:127], v[84:87], v[204:207]
v_mfma_f32_16x16x32_bf16 v[208:211], v[124:127], v[88:91], v[208:211]
v_mfma_f32_16x16x32_bf16 v[212:215], v[124:127], v[92:95], v[212:215]
v_mfma_f32_16x16x32_bf16 v[216:219], v[124:127], v[96:99], v[216:219]
v_mfma_f32_16x16x32_bf16 v[220:223], v[124:127], v[100:103], v[220:223]
v_mfma_f32_16x16x32_bf16 v[224:227], v[124:127], v[104:107], v[224:227]
v_mfma_f32_16x16x32_bf16 v[228:231], v[124:127], v[108:111], v[228:231]
v_mfma_f32_16x16x32_bf16 v[232:235], v[124:127], v[112:115], v[232:235]
s_waitcnt lgkmcnt(0)
v_mfma_f32_16x16x32_bf16 v[128:131], v[68:71], v[32:35], v[128:131]
ds_read_b128 v[80:83], v5 offset:0
v_mfma_f32_16x16x32_bf16 v[132:135], v[68:71], v[36:39], v[132:135]
ds_read_b64_tr_b16 v[120:121], v8 offset:12288
v_mfma_f32_16x16x32_bf16 v[136:139], v[68:71], v[40:43], v[136:139]
ds_read_b64_tr_b16 v[122:123], v8 offset:12800
v_mfma_f32_16x16x32_bf16 v[140:143], v[68:71], v[44:47], v[140:143]
ds_read_b64_tr_b16 v[124:125], v8 offset:20480
v_mfma_f32_16x16x32_bf16 v[144:147], v[68:71], v[48:51], v[144:147]
ds_read_b64_tr_b16 v[126:127], v8 offset:20992
v_mfma_f32_16x16x32_bf16 v[148:151], v[68:71], v[52:55], v[148:151]
ds_read_b64_tr_b16 v[116:117], v8 offset:4096
v_mfma_f32_16x16x32_bf16 v[152:155], v[68:71], v[56:59], v[152:155]
ds_read_b64_tr_b16 v[118:119], v8 offset:4608
v_mfma_f32_16x16x32_bf16 v[156:159], v[68:71], v[60:63], v[156:159]
ds_read_b128 v[84:87], v5 offset:2048
v_mfma_f32_16x16x32_bf16 v[160:163], v[68:71], v[64:67], v[160:163]
ds_read_b128 v[88:91], v5 offset:4096
v_mfma_f32_16x16x32_bf16 v[196:199], v[72:75], v[64:67], v[196:199]
ds_read_b128 v[92:95], v5 offset:6144
v_mfma_f32_16x16x32_bf16 v[192:195], v[72:75], v[60:63], v[192:195]
ds_read_b128 v[96:99], v5 offset:8192
v_mfma_f32_16x16x32_bf16 v[188:191], v[72:75], v[56:59], v[188:191]
ds_read_b128 v[100:103], v5 offset:10240
v_mfma_f32_16x16x32_bf16 v[184:187], v[72:75], v[52:55], v[184:187]
ds_read_b128 v[104:107], v5 offset:12288
v_mfma_f32_16x16x32_bf16 v[180:183], v[72:75], v[48:51], v[180:183]
ds_read_b128 v[108:111], v5 offset:14336
v_mfma_f32_16x16x32_bf16 v[176:179], v[72:75], v[44:47], v[176:179]
ds_read_b128 v[112:115], v5 offset:16384
v_mfma_f32_16x16x32_bf16 v[172:175], v[72:75], v[40:43], v[172:175]
v_mfma_f32_16x16x32_bf16 v[168:171], v[72:75], v[36:39], v[168:171]
v_mfma_f32_16x16x32_bf16 v[164:167], v[72:75], v[32:35], v[164:167]
v_mfma_f32_16x16x32_bf16 v[200:203], v[76:79], v[32:35], v[200:203]
v_mfma_f32_16x16x32_bf16 v[204:207], v[76:79], v[36:39], v[204:207]
v_mfma_f32_16x16x32_bf16 v[208:211], v[76:79], v[40:43], v[208:211]
v_mfma_f32_16x16x32_bf16 v[212:215], v[76:79], v[44:47], v[212:215]
v_mfma_f32_16x16x32_bf16 v[216:219], v[76:79], v[48:51], v[216:219]
v_mfma_f32_16x16x32_bf16 v[220:223], v[76:79], v[52:55], v[220:223]
v_mfma_f32_16x16x32_bf16 v[224:227], v[76:79], v[56:59], v[224:227]
v_mfma_f32_16x16x32_bf16 v[228:231], v[76:79], v[60:63], v[228:231]
v_mfma_f32_16x16x32_bf16 v[232:235], v[76:79], v[64:67], v[232:235]
s_waitcnt lgkmcnt(0)
s_barrier
v_mfma_f32_16x16x32_bf16 v[128:131], v[116:119], v[80:83], v[128:131]
ds_read_b128 v[32:35], v2 offset:0
v_mfma_f32_16x16x32_bf16 v[132:135], v[116:119], v[84:87], v[132:135]
ds_read_b64_tr_b16 v[72:73], v6 offset:8192
v_mfma_f32_16x16x32_bf16 v[136:139], v[116:119], v[88:91], v[136:139]
ds_read_b64_tr_b16 v[74:75], v6 offset:8704
v_mfma_f32_16x16x32_bf16 v[140:143], v[116:119], v[92:95], v[140:143]
ds_read_b64_tr_b16 v[76:77], v6 offset:16384
v_mfma_f32_16x16x32_bf16 v[144:147], v[116:119], v[96:99], v[144:147]
ds_read_b64_tr_b16 v[78:79], v6 offset:16896
v_mfma_f32_16x16x32_bf16 v[148:151], v[116:119], v[100:103], v[148:151]
ds_read_b64_tr_b16 v[68:69], v6 offset:0
v_mfma_f32_16x16x32_bf16 v[152:155], v[116:119], v[104:107], v[152:155]
ds_read_b64_tr_b16 v[70:71], v6 offset:512
v_mfma_f32_16x16x32_bf16 v[156:159], v[116:119], v[108:111], v[156:159]
ds_read_b128 v[36:39], v2 offset:2048
v_mfma_f32_16x16x32_bf16 v[160:163], v[116:119], v[112:115], v[160:163]
ds_read_b128 v[40:43], v2 offset:4096
v_mfma_f32_16x16x32_bf16 v[196:199], v[120:123], v[112:115], v[196:199]
ds_read_b128 v[44:47], v2 offset:6144
v_mfma_f32_16x16x32_bf16 v[192:195], v[120:123], v[108:111], v[192:195]
ds_read_b128 v[48:51], v2 offset:8192
v_mfma_f32_16x16x32_bf16 v[188:191], v[120:123], v[104:107], v[188:191]
ds_read_b128 v[52:55], v2 offset:10240
v_mfma_f32_16x16x32_bf16 v[184:187], v[120:123], v[100:103], v[184:187]
ds_read_b128 v[56:59], v2 offset:12288
v_mfma_f32_16x16x32_bf16 v[180:183], v[120:123], v[96:99], v[180:183]
ds_read_b128 v[60:63], v2 offset:14336
v_mfma_f32_16x16x32_bf16 v[176:179], v[120:123], v[92:95], v[176:179]
ds_read_b128 v[64:67], v2 offset:16384
v_mfma_f32_16x16x32_bf16 v[172:175], v[120:123], v[88:91], v[172:175]
v_mfma_f32_16x16x32_bf16 v[168:171], v[120:123], v[84:87], v[168:171]
v_mfma_f32_16x16x32_bf16 v[164:167], v[120:123], v[80:83], v[164:167]
v_mfma_f32_16x16x32_bf16 v[200:203], v[124:127], v[80:83], v[200:203]
v_mfma_f32_16x16x32_bf16 v[204:207], v[124:127], v[84:87], v[204:207]
v_mfma_f32_16x16x32_bf16 v[208:211], v[124:127], v[88:91], v[208:211]
v_mfma_f32_16x16x32_bf16 v[212:215], v[124:127], v[92:95], v[212:215]
v_mfma_f32_16x16x32_bf16 v[216:219], v[124:127], v[96:99], v[216:219]
v_mfma_f32_16x16x32_bf16 v[220:223], v[124:127], v[100:103], v[220:223]
v_mfma_f32_16x16x32_bf16 v[224:227], v[124:127], v[104:107], v[224:227]
v_mfma_f32_16x16x32_bf16 v[228:231], v[124:127], v[108:111], v[228:231]
v_mfma_f32_16x16x32_bf16 v[232:235], v[124:127], v[112:115], v[232:235]
s_sub_u32 s41, s41, 1
s_cmp_lg_u32 s41, 0
s_cbranch_scc1 Lcl_16
s_waitcnt lgkmcnt(0)
v_mfma_f32_16x16x32_bf16 v[128:131], v[68:71], v[32:35], v[128:131]
ds_read_b128 v[80:83], v3 offset:0
v_mfma_f32_16x16x32_bf16 v[132:135], v[68:71], v[36:39], v[132:135]
ds_read_b64_tr_b16 v[120:121], v6 offset:12288
v_mfma_f32_16x16x32_bf16 v[136:139], v[68:71], v[40:43], v[136:139]
ds_read_b64_tr_b16 v[122:123], v6 offset:12800
v_mfma_f32_16x16x32_bf16 v[140:143], v[68:71], v[44:47], v[140:143]
ds_read_b64_tr_b16 v[124:125], v6 offset:20480
v_mfma_f32_16x16x32_bf16 v[144:147], v[68:71], v[48:51], v[144:147]
ds_read_b64_tr_b16 v[126:127], v6 offset:20992
v_mfma_f32_16x16x32_bf16 v[148:151], v[68:71], v[52:55], v[148:151]
ds_read_b64_tr_b16 v[116:117], v6 offset:4096
v_mfma_f32_16x16x32_bf16 v[152:155], v[68:71], v[56:59], v[152:155]
ds_read_b64_tr_b16 v[118:119], v6 offset:4608
v_mfma_f32_16x16x32_bf16 v[156:159], v[68:71], v[60:63], v[156:159]
ds_read_b128 v[84:87], v3 offset:2048
v_mfma_f32_16x16x32_bf16 v[160:163], v[68:71], v[64:67], v[160:163]
ds_read_b128 v[88:91], v3 offset:4096
v_mfma_f32_16x16x32_bf16 v[196:199], v[72:75], v[64:67], v[196:199]
ds_read_b128 v[92:95], v3 offset:6144
v_mfma_f32_16x16x32_bf16 v[192:195], v[72:75], v[60:63], v[192:195]
ds_read_b128 v[96:99], v3 offset:8192
v_mfma_f32_16x16x32_bf16 v[188:191], v[72:75], v[56:59], v[188:191]
ds_read_b128 v[100:103], v3 offset:10240
v_mfma_f32_16x16x32_bf16 v[184:187], v[72:75], v[52:55], v[184:187]
ds_read_b128 v[104:107], v3 offset:12288
v_mfma_f32_16x16x32_bf16 v[180:183], v[72:75], v[48:51], v[180:183]
ds_read_b128 v[108:111], v3 offset:14336
v_mfma_f32_16x16x32_bf16 v[176:179], v[72:75], v[44:47], v[176:179]
ds_read_b128 v[112:115], v3 offset:16384
v_mfma_f32_16x16x32_bf16 v[172:175], v[72:75], v[40:43], v[172:175]
v_mfma_f32_16x16x32_bf16 v[168:171], v[72:75], v[36:39], v[168:171]
v_mfma_f32_16x16x32_bf16 v[164:167], v[72:75], v[32:35], v[164:167]
v_mfma_f32_16x16x32_bf16 v[200:203], v[76:79], v[32:35], v[200:203]
v_mfma_f32_16x16x32_bf16 v[204:207], v[76:79], v[36:39], v[204:207]
v_mfma_f32_16x16x32_bf16 v[208:211], v[76:79], v[40:43], v[208:211]
v_mfma_f32_16x16x32_bf16 v[212:215], v[76:79], v[44:47], v[212:215]
v_mfma_f32_16x16x32_bf16 v[216:219], v[76:79], v[48:51], v[216:219]
v_mfma_f32_16x16x32_bf16 v[220:223], v[76:79], v[52:55], v[220:223]
v_mfma_f32_16x16x32_bf16 v[224:227], v[76:79], v[56:59], v[224:227]
v_mfma_f32_16x16x32_bf16 v[228:231], v[76:79], v[60:63], v[228:231]
v_mfma_f32_16x16x32_bf16 v[232:235], v[76:79], v[64:67], v[232:235]
s_waitcnt lgkmcnt(0)
v_mfma_f32_16x16x32_bf16 v[128:131], v[116:119], v[80:83], v[128:131]
v_mfma_f32_16x16x32_bf16 v[132:135], v[116:119], v[84:87], v[132:135]
v_mfma_f32_16x16x32_bf16 v[136:139], v[116:119], v[88:91], v[136:139]
v_mfma_f32_16x16x32_bf16 v[140:143], v[116:119], v[92:95], v[140:143]
v_mfma_f32_16x16x32_bf16 v[144:147], v[116:119], v[96:99], v[144:147]
v_mfma_f32_16x16x32_bf16 v[148:151], v[116:119], v[100:103], v[148:151]
v_mfma_f32_16x16x32_bf16 v[152:155], v[116:119], v[104:107], v[152:155]
v_mfma_f32_16x16x32_bf16 v[156:159], v[116:119], v[108:111], v[156:159]
v_mfma_f32_16x16x32_bf16 v[160:163], v[116:119], v[112:115], v[160:163]
v_mfma_f32_16x16x32_bf16 v[196:199], v[120:123], v[112:115], v[196:199]
v_mfma_f32_16x16x32_bf16 v[192:195], v[120:123], v[108:111], v[192:195]
v_mfma_f32_16x16x32_bf16 v[188:191], v[120:123], v[104:107], v[188:191]
v_mfma_f32_16x16x32_bf16 v[184:187], v[120:123], v[100:103], v[184:187]
v_mfma_f32_16x16x32_bf16 v[180:183], v[120:123], v[96:99], v[180:183]
v_mfma_f32_16x16x32_bf16 v[176:179], v[120:123], v[92:95], v[176:179]
v_mfma_f32_16x16x32_bf16 v[172:175], v[120:123], v[88:91], v[172:175]
v_mfma_f32_16x16x32_bf16 v[168:171], v[120:123], v[84:87], v[168:171]
v_mfma_f32_16x16x32_bf16 v[164:167], v[120:123], v[80:83], v[164:167]
v_mfma_f32_16x16x32_bf16 v[200:203], v[124:127], v[80:83], v[200:203]
v_mfma_f32_16x16x32_bf16 v[204:207], v[124:127], v[84:87], v[204:207]
v_mfma_f32_16x16x32_bf16 v[208:211], v[124:127], v[88:91], v[208:211]
v_mfma_f32_16x16x32_bf16 v[212:215], v[124:127], v[92:95], v[212:215]
v_mfma_f32_16x16x32_bf16 v[216:219], v[124:127], v[96:99], v[216:219]
v_mfma_f32_16x16x32_bf16 v[220:223], v[124:127], v[100:103], v[220:223]
v_mfma_f32_16x16x32_bf16 v[224:227], v[124:127], v[104:107], v[224:227]
v_mfma_f32_16x16x32_bf16 v[228:231], v[124:127], v[108:111], v[228:231]
v_mfma_f32_16x16x32_bf16 v[232:235], v[124:127], v[112:115], v[232:235]
Lepi:
v_lshlrev_b32 v14, 3, v12
v_add_u32 v14, 147456, v14
v_mul_u32_u24 v15, 400, v12
v_lshl_add_u32 v15, v13, 3, v15
s_lshl_b32 s43, s36, 5
v_add_u32 v15, s43, v15
s_barrier
ds_read_b64 v[32:33], v14 offset:0
ds_read_b64 v[34:35], v14 offset:128
ds_read_b64 v[36:37], v14 offset:256
ds_read_b64 v[38:39], v14 offset:384
ds_read_b64 v[40:41], v14 offset:512
ds_read_b64 v[42:43], v14 offset:640
ds_read_b64 v[44:45], v14 offset:768
ds_read_b64 v[46:47], v14 offset:896
ds_read_b64 v[48:49], v14 offset:1024
v_mov_b32_dpp v52, v128 row_newbcast:0 row_mask:0xf bank_mask:0xf
v_mov_b32_dpp v53, v129 row_newbcast:0 row_mask:0xf bank_mask:0xf
v_mov_b32_dpp v54, v130 row_newbcast:0 row_mask:0xf bank_mask:0xf
v_mov_b32_dpp v55, v131 row_newbcast:0 row_mask:0xf bank_mask:0xf
v_mov_b32_dpp v56, v164 row_newbcast:0 row_mask:0xf bank_mask:0xf
v_mov_b32_dpp v57, v165 row_newbcast:0 row_mask:0xf bank_mask:0xf
v_mov_b32_dpp v58, v166 row_newbcast:0 row_mask:0xf bank_mask:0xf
v_mov_b32_dpp v59, v167 row_newbcast:0 row_mask:0xf bank_mask:0xf
v_mov_b32_dpp v60, v200 row_newbcast:0 row_mask:0xf bank_mask:0xf
v_mov_b32_dpp v61, v201 row_newbcast:0 row_mask:0xf bank_mask:0xf
v_mov_b32_dpp v62, v202 row_newbcast:0 row_mask:0xf bank_mask:0xf
v_mov_b32_dpp v63, v203 row_newbcast:0 row_mask:0xf bank_mask:0xf
s_waitcnt lgkmcnt(0)
v_pk_fma_f32 v[164:165], v[32:33], v[56:57], v[164:165] op_sel_hi:[0,1,1] neg_lo:[1,0,0] neg_hi:[1,0,0]
v_pk_fma_f32 v[166:167], v[32:33], v[58:59], v[166:167] op_sel_hi:[0,1,1] neg_lo:[1,0,0] neg_hi:[1,0,0]
v_pk_fma_f32 v[200:201], v[32:33], v[60:61], v[200:201] op_sel_hi:[0,1,1] neg_lo:[1,0,0] neg_hi:[1,0,0]
v_pk_fma_f32 v[202:203], v[32:33], v[62:63], v[202:203] op_sel_hi:[0,1,1] neg_lo:[1,0,0] neg_hi:[1,0,0]
v_pk_mul_f32 v[164:165], v[32:33], v[164:165] op_sel:[1,0] op_sel_hi:[1,1]
v_pk_mul_f32 v[166:167], v[32:33], v[166:167] op_sel:[1,0] op_sel_hi:[1,1]
v_pk_fma_f32 v[132:133], v[34:35], v[52:53], v[132:133] op_sel_hi:[0,1,1] neg_lo:[1,0,0] neg_hi:[1,0,0]
v_pk_fma_f32 v[134:135], v[34:35], v[54:55], v[134:135] op_sel_hi:[0,1,1] neg_lo:[1,0,0] neg_hi:[1,0,0]
v_pk_mul_f32 v[200:201], v[32:33], v[200:201] op_sel:[1,0] op_sel_hi:[1,1]
v_pk_mul_f32 v[202:203], v[32:33], v[202:203] op_sel:[1,0] op_sel_hi:[1,1]
v_cvt_pk_bf16_f32 v164, v164, v165
v_cvt_pk_bf16_f32 v165, v166, v167
ds_write_b64 v15, v[164:165] offset:128
v_pk_fma_f32 v[168:169], v[34:35], v[56:57], v[168:169] op_sel_hi:[0,1,1] neg_lo:[1,0,0] neg_hi:[1,0,0]
v_pk_fma_f32 v[170:171], v[34:35], v[58:59], v[170:171] op_sel_hi:[0,1,1] neg_lo:[1,0,0] neg_hi:[1,0,0]
v_pk_mul_f32 v[132:133], v[34:35], v[132:133] op_sel:[1,0] op_sel_hi:[1,1]
v_pk_mul_f32 v[134:135], v[34:35], v[134:135] op_sel:[1,0] op_sel_hi:[1,1]
v_cvt_pk_bf16_f32 v200, v200, v201
v_cvt_pk_bf16_f32 v201, v202, v203
ds_write_b64 v15, v[200:201] offset:256
v_pk_fma_f32 v[204:205], v[34:35], v[60:61], v[204:205] op_sel_hi:[0,1,1] neg_lo:[1,0,0] neg_hi:[1,0,0]
v_pk_fma_f32 v[206:207], v[34:35], v[62:63], v[206:207] op_sel_hi:[0,1,1] neg_lo:[1,0,0] neg_hi:[1,0,0]
v_pk_mul_f32 v[168:169], v[34:35], v[168:169] op_sel:[1,0] op_sel_hi:[1,1]
v_pk_mul_f32 v[170:171], v[34:35], v[170:171] op_sel:[1,0] op_sel_hi:[1,1]
v_cvt_pk_bf16_f32 v132, v132, v133
v_cvt_pk_bf16_f32 v133, v134, v135
ds_write_b64 v15, v[132:133] offset:6400
v_pk_fma_f32 v[136:137], v[36:37], v[52:53], v[136:137] op_sel_hi:[0,1,1] neg_lo:[1,0,0] neg_hi:[1,0,0]
v_pk_fma_f32 v[138:139], v[36:37], v[54:55], v[138:139] op_sel_hi:[0,1,1] neg_lo:[1,0,0] neg_hi:[1,0,0]
v_pk_mul_f32 v[204:205], v[34:35], v[204:205] op_sel:[1,0] op_sel_hi:[1,1]
v_pk_mul_f32 v[206:207], v[34:35], v[206:207] op_sel:[1,0] op_sel_hi:[1,1]
v_cvt_pk_bf16_f32 v168, v168, v169
v_cvt_pk_bf16_f32 v169, v170, v171
ds_write_b64 v15, v[168:169] offset:6528
v_pk_fma_f32 v[172:173], v[36:37], v[56:57], v[172:173] op_sel_hi:[0,1,1] neg_lo:[1,0,0] neg_hi:[1,0,0]
v_pk_fma_f32 v[174:175], v[36:37], v[58:59], v[174:175] op_sel_hi:[0,1,1] neg_lo:[1,0,0] neg_hi:[1,0,0]
v_pk_mul_f32 v[136:137], v[36:37], v[136:137] op_sel:[1,0] op_sel_hi:[1,1]
v_pk_mul_f32 v[138:139], v[36:37], v[138:139] op_sel:[1,0] op_sel_hi:[1,1]
v_cvt_pk_bf16_f32 v204, v204, v205
v_cvt_pk_bf16_f32 v205, v206, v207
ds_write_b64 v15, v[204:205] offset:6656
v_pk_fma_f32 v[208:209], v[36:37], v[60:61], v[208:209] op_sel_hi:[0,1,1] neg_lo:[1,0,0] neg_hi:[1,0,0]
v_pk_fma_f32 v[210:211], v[36:37], v[62:63], v[210:211] op_sel_hi:[0,1,1] neg_lo:[1,0,0] neg_hi:[1,0,0]
v_pk_mul_f32 v[172:173], v[36:37], v[172:173] op_sel:[1,0] op_sel_hi:[1,1]
v_pk_mul_f32 v[174:175], v[36:37], v[174:175] op_sel:[1,0] op_sel_hi:[1,1]
v_cvt_pk_bf16_f32 v136, v136, v137
v_cvt_pk_bf16_f32 v137, v138, v139
ds_write_b64 v15, v[136:137] offset:12800
v_pk_fma_f32 v[140:141], v[38:39], v[52:53], v[140:141] op_sel_hi:[0,1,1] neg_lo:[1,0,0] neg_hi:[1,0,0]
v_pk_fma_f32 v[142:143], v[38:39], v[54:55], v[142:143] op_sel_hi:[0,1,1] neg_lo:[1,0,0] neg_hi:[1,0,0]
v_pk_mul_f32 v[208:209], v[36:37], v[208:209] op_sel:[1,0] op_sel_hi:[1,1]
v_pk_mul_f32 v[210:211], v[36:37], v[210:211] op_sel:[1,0] op_sel_hi:[1,1]
v_cvt_pk_bf16_f32 v172, v172, v173
v_cvt_pk_bf16_f32 v173, v174, v175
ds_write_b64 v15, v[172:173] offset:12928
v_pk_fma_f32 v[176:177], v[38:39], v[56:57], v[176:177] op_sel_hi:[0,1,1] neg_lo:[1,0,0] neg_hi:[1,0,0]
v_pk_fma_f32 v[178:179], v[38:39], v[58:59], v[178:179] op_sel_hi:[0,1,1] neg_lo:[1,0,0] neg_hi:[1,0,0]
v_pk_mul_f32 v[140:141], v[38:39], v[140:141] op_sel:[1,0] op_sel_hi:[1,1]
v_pk_mul_f32 v[142:143], v[38:39], v[142:143] op_sel:[1,0] op_sel_hi:[1,1]
v_cvt_pk_bf16_f32 v208, v208, v209
v_cvt_pk_bf16_f32 v209, v210, v211
ds_write_b64 v15, v[208:209] offset:13056
v_pk_fma_f32 v[212:213], v[38:39], v[60:61], v[212:213] op_sel_hi:[0,1,1] neg_lo:[1,0,0] neg_hi:[1,0,0]
v_pk_fma_f32 v[214:215], v[38:39], v[62:63], v[214:215] op_sel_hi:[0,1,1] neg_lo:[1,0,0] neg_hi:[1,0,0]
v_pk_mul_f32 v[176:177], v[38:39], v[176:177] op_sel:[1,0] op_sel_hi:[1,1]
v_pk_mul_f32 v[178:179], v[38:39], v[178:179] op_sel:[1,0] op_sel_hi:[1,1]
v_cvt_pk_bf16_f32 v140, v140, v141
v_cvt_pk_bf16_f32 v141, v142, v143
ds_write_b64 v15, v[140:141] offset:19200
v_pk_fma_f32 v[144:145], v[40:41], v[52:53], v[144:145] op_sel_hi:[0,1,1] neg_lo:[1,0,0] neg_hi:[1,0,0]
v_pk_fma_f32 v[146:147], v[40:41], v[54:55], v[146:147] op_sel_hi:[0,1,1] neg_lo:[1,0,0] neg_hi:[1,0,0]
v_pk_mul_f32 v[212:213], v[38:39], v[212:213] op_sel:[1,0] op_sel_hi:[1,1]
v_pk_mul_f32 v[214:215], v[38:39], v[214:215] op_sel:[1,0] op_sel_hi:[1,1]
v_cvt_pk_bf16_f32 v176, v176, v177
v_cvt_pk_bf16_f32 v177, v178, v179
ds_write_b64 v15, v[176:177] offset:19328
v_pk_fma_f32 v[180:181], v[40:41], v[56:57], v[180:181] op_sel_hi:[0,1,1] neg_lo:[1,0,0] neg_hi:[1,0,0]
v_pk_fma_f32 v[182:183], v[40:41], v[58:59], v[182:183] op_sel_hi:[0,1,1] neg_lo:[1,0,0] neg_hi:[1,0,0]
v_pk_mul_f32 v[144:145], v[40:41], v[144:145] op_sel:[1,0] op_sel_hi:[1,1]
v_pk_mul_f32 v[146:147], v[40:41], v[146:147] op_sel:[1,0] op_sel_hi:[1,1]
v_cvt_pk_bf16_f32 v212, v212, v213
v_cvt_pk_bf16_f32 v213, v214, v215
ds_write_b64 v15, v[212:213] offset:19456
v_pk_fma_f32 v[216:217], v[40:41], v[60:61], v[216:217] op_sel_hi:[0,1,1] neg_lo:[1,0,0] neg_hi:[1,0,0]
v_pk_fma_f32 v[218:219], v[40:41], v[62:63], v[218:219] op_sel_hi:[0,1,1] neg_lo:[1,0,0] neg_hi:[1,0,0]
v_pk_mul_f32 v[180:181], v[40:41], v[180:181] op_sel:[1,0] op_sel_hi:[1,1]
v_pk_mul_f32 v[182:183], v[40:41], v[182:183] op_sel:[1,0] op_sel_hi:[1,1]
v_cvt_pk_bf16_f32 v144, v144, v145
v_cvt_pk_bf16_f32 v145, v146, v147
ds_write_b64 v15, v[144:145] offset:25600
v_pk_fma_f32 v[148:149], v[42:43], v[52:53], v[148:149] op_sel_hi:[0,1,1] neg_lo:[1,0,0] neg_hi:[1,0,0]
v_pk_fma_f32 v[150:151], v[42:43], v[54:55], v[150:151] op_sel_hi:[0,1,1] neg_lo:[1,0,0] neg_hi:[1,0,0]
v_pk_mul_f32 v[216:217], v[40:41], v[216:217] op_sel:[1,0] op_sel_hi:[1,1]
v_pk_mul_f32 v[218:219], v[40:41], v[218:219] op_sel:[1,0] op_sel_hi:[1,1]
v_cvt_pk_bf16_f32 v180, v180, v181
v_cvt_pk_bf16_f32 v181, v182, v183
ds_write_b64 v15, v[180:181] offset:25728
v_pk_fma_f32 v[184:185], v[42:43], v[56:57], v[184:185] op_sel_hi:[0,1,1] neg_lo:[1,0,0] neg_hi:[1,0,0]
v_pk_fma_f32 v[186:187], v[42:43], v[58:59], v[186:187] op_sel_hi:[0,1,1] neg_lo:[1,0,0] neg_hi:[1,0,0]
v_pk_mul_f32 v[148:149], v[42:43], v[148:149] op_sel:[1,0] op_sel_hi:[1,1]
v_pk_mul_f32 v[150:151], v[42:43], v[150:151] op_sel:[1,0] op_sel_hi:[1,1]
v_cvt_pk_bf16_f32 v216, v216, v217
v_cvt_pk_bf16_f32 v217, v218, v219
ds_write_b64 v15, v[216:217] offset:25856
v_pk_fma_f32 v[220:221], v[42:43], v[60:61], v[220:221] op_sel_hi:[0,1,1] neg_lo:[1,0,0] neg_hi:[1,0,0]
v_pk_fma_f32 v[222:223], v[42:43], v[62:63], v[222:223] op_sel_hi:[0,1,1] neg_lo:[1,0,0] neg_hi:[1,0,0]
v_pk_mul_f32 v[184:185], v[42:43], v[184:185] op_sel:[1,0] op_sel_hi:[1,1]
v_pk_mul_f32 v[186:187], v[42:43], v[186:187] op_sel:[1,0] op_sel_hi:[1,1]
v_cvt_pk_bf16_f32 v148, v148, v149
v_cvt_pk_bf16_f32 v149, v150, v151
ds_write_b64 v15, v[148:149] offset:32000
v_pk_fma_f32 v[152:153], v[44:45], v[52:53], v[152:153] op_sel_hi:[0,1,1] neg_lo:[1,0,0] neg_hi:[1,0,0]
v_pk_fma_f32 v[154:155], v[44:45], v[54:55], v[154:155] op_sel_hi:[0,1,1] neg_lo:[1,0,0] neg_hi:[1,0,0]
v_pk_mul_f32 v[220:221], v[42:43], v[220:221] op_sel:[1,0] op_sel_hi:[1,1]
v_pk_mul_f32 v[222:223], v[42:43], v[222:223] op_sel:[1,0] op_sel_hi:[1,1]
v_cvt_pk_bf16_f32 v184, v184, v185
v_cvt_pk_bf16_f32 v185, v186, v187
ds_write_b64 v15, v[184:185] offset:32128
v_pk_fma_f32 v[188:189], v[44:45], v[56:57], v[188:189] op_sel_hi:[0,1,1] neg_lo:[1,0,0] neg_hi:[1,0,0]
v_pk_fma_f32 v[190:191], v[44:45], v[58:59], v[190:191] op_sel_hi:[0,1,1] neg_lo:[1,0,0] neg_hi:[1,0,0]
v_pk_mul_f32 v[152:153], v[44:45], v[152:153] op_sel:[1,0] op_sel_hi:[1,1]
v_pk_mul_f32 v[154:155], v[44:45], v[154:155] op_sel:[1,0] op_sel_hi:[1,1]
v_cvt_pk_bf16_f32 v220, v220, v221
v_cvt_pk_bf16_f32 v221, v222, v223
ds_write_b64 v15, v[220:221] offset:32256
v_pk_fma_f32 v[224:225], v[44:45], v[60:61], v[224:225] op_sel_hi:[0,1,1] neg_lo:[1,0,0] neg_hi:[1,0,0]
v_pk_fma_f32 v[226:227], v[44:45], v[62:63], v[226:227] op_sel_hi:[0,1,1] neg_lo:[1,0,0] neg_hi:[1,0,0]
v_pk_mul_f32 v[188:189], v[44:45], v[188:189] op_sel:[1,0] op_sel_hi:[1,1]
v_pk_mul_f32 v[190:191], v[44:45], v[190:191] op_sel:[1,0] op_sel_hi:[1,1]
v_cvt_pk_bf16_f32 v152, v152, v153
v_cvt_pk_bf16_f32 v153, v154, v155
ds_write_b64 v15, v[152:153] offset:38400
v_pk_fma_f32 v[156:157], v[46:47], v[52:53], v[156:157] op_sel_hi:[0,1,1] neg_lo:[1,0,0] neg_hi:[1,0,0]
v_pk_fma_f32 v[158:159], v[46:47], v[54:55], v[158:159] op_sel_hi:[0,1,1] neg_lo:[1,0,0] neg_hi:[1,0,0]
v_pk_mul_f32 v[224:225], v[44:45], v[224:225] op_sel:[1,0] op_sel_hi:[1,1]
v_pk_mul_f32 v[226:227], v[44:45], v[226:227] op_sel:[1,0] op_sel_hi:[1,1]
v_cvt_pk_bf16_f32 v188, v188, v189
v_cvt_pk_bf16_f32 v189, v190, v191
ds_write_b64 v15, v[188:189] offset:38528
v_pk_fma_f32 v[192:193], v[46:47], v[56:57], v[192:193] op_sel_hi:[0,1,1] neg_lo:[1,0,0] neg_hi:[1,0,0]
v_pk_fma_f32 v[194:195], v[46:47], v[58:59], v[194:195] op_sel_hi:[0,1,1] neg_lo:[1,0,0] neg_hi:[1,0,0]
v_pk_mul_f32 v[156:157], v[46:47], v[156:157] op_sel:[1,0] op_sel_hi:[1,1]
v_pk_mul_f32 v[158:159], v[46:47], v[158:159] op_sel:[1,0] op_sel_hi:[1,1]
v_cvt_pk_bf16_f32 v224, v224, v225
v_cvt_pk_bf16_f32 v225, v226, v227
ds_write_b64 v15, v[224:225] offset:38656
v_pk_fma_f32 v[228:229], v[46:47], v[60:61], v[228:229] op_sel_hi:[0,1,1] neg_lo:[1,0,0] neg_hi:[1,0,0]
v_pk_fma_f32 v[230:231], v[46:47], v[62:63], v[230:231] op_sel_hi:[0,1,1] neg_lo:[1,0,0] neg_hi:[1,0,0]
v_pk_mul_f32 v[192:193], v[46:47], v[192:193] op_sel:[1,0] op_sel_hi:[1,1]
v_pk_mul_f32 v[194:195], v[46:47], v[194:195] op_sel:[1,0] op_sel_hi:[1,1]
v_cvt_pk_bf16_f32 v156, v156, v157
v_cvt_pk_bf16_f32 v157, v158, v159
ds_write_b64 v15, v[156:157] offset:44800
v_pk_fma_f32 v[160:161], v[48:49], v[52:53], v[160:161] op_sel_hi:[0,1,1] neg_lo:[1,0,0] neg_hi:[1,0,0]
v_pk_fma_f32 v[162:163], v[48:49], v[54:55], v[162:163] op_sel_hi:[0,1,1] neg_lo:[1,0,0] neg_hi:[1,0,0]
v_pk_mul_f32 v[228:229], v[46:47], v[228:229] op_sel:[1,0] op_sel_hi:[1,1]
v_pk_mul_f32 v[230:231], v[46:47], v[230:231] op_sel:[1,0] op_sel_hi:[1,1]
v_cvt_pk_bf16_f32 v192, v192, v193
v_cvt_pk_bf16_f32 v193, v194, v195
ds_write_b64 v15, v[192:193] offset:44928
v_pk_fma_f32 v[196:197], v[48:49], v[56:57], v[196:197] op_sel_hi:[0,1,1] neg_lo:[1,0,0] neg_hi:[1,0,0]
v_pk_fma_f32 v[198:199], v[48:49], v[58:59], v[198:199] op_sel_hi:[0,1,1] neg_lo:[1,0,0] neg_hi:[1,0,0]
v_pk_mul_f32 v[160:161], v[48:49], v[160:161] op_sel:[1,0] op_sel_hi:[1,1]
v_pk_mul_f32 v[162:163], v[48:49], v[162:163] op_sel:[1,0] op_sel_hi:[1,1]
v_cvt_pk_bf16_f32 v228, v228, v229
v_cvt_pk_bf16_f32 v229, v230, v231
ds_write_b64 v15, v[228:229] offset:45056
v_pk_fma_f32 v[232:233], v[48:49], v[60:61], v[232:233] op_sel_hi:[0,1,1] neg_lo:[1,0,0] neg_hi:[1,0,0]
v_pk_fma_f32 v[234:235], v[48:49], v[62:63], v[234:235] op_sel_hi:[0,1,1] neg_lo:[1,0,0] neg_hi:[1,0,0]
v_pk_mul_f32 v[196:197], v[48:49], v[196:197] op_sel:[1,0] op_sel_hi:[1,1]
v_pk_mul_f32 v[198:199], v[48:49], v[198:199] op_sel:[1,0] op_sel_hi:[1,1]
v_cvt_pk_bf16_f32 v160, v160, v161
v_cvt_pk_bf16_f32 v161, v162, v163
ds_write_b64 v15, v[160:161] offset:51200
v_pk_mul_f32 v[232:233], v[48:49], v[232:233] op_sel:[1,0] op_sel_hi:[1,1]
v_pk_mul_f32 v[234:235], v[48:49], v[234:235] op_sel:[1,0] op_sel_hi:[1,1]
v_cvt_pk_bf16_f32 v196, v196, v197
v_cvt_pk_bf16_f32 v197, v198, v199
ds_write_b64 v15, v[196:197] offset:51328
v_cvt_pk_bf16_f32 v232, v232, v233
v_cvt_pk_bf16_f32 v233, v234, v235
ds_write_b64 v15, v[232:233] offset:51456
s_waitcnt lgkmcnt(0)
s_branch Latt_5
Lpf_4:
s_lshl_b32 s43, s35, 7
s_waitcnt lgkmcnt(0)
s_mov_b32 s8, s64
s_mov_b32 s9, s65
s_mov_b32 s10, 4194304
s_mov_b32 s11, 0x20000
s_add_u32 s12, s66, s43
s_addc_u32 s13, s67, 0
s_mov_b32 s14, 6289536
s_mov_b32 s15, 0x20000
s_add_u32 s84, s82, 28311552
s_addc_u32 s85, s83, 0
s_branch Lov_3
.p2align 12
.fill 16, 4, 0xbf800000
Lst_3_0:
s_branch Lwr_148
s_nop 0
s_nop 0
Lov_3:
s_mov_b32 s86, 114688
s_mov_b32 s87, 0x20000
s_mov_b32 s56, s80
s_mov_b32 s57, s81
s_mov_b32 s58, 256
s_mov_b32 s59, 0x20000
v_mov_b32 v5, 0
v_lshlrev_b32 v14, 7, v1
s_or_b32 s43, s34, s35
s_cmp_lg_u32 s43, 0
s_cbranch_scc1 Lz_17
s_movk_i32 s43, 0x2000
buffer_store_dword v5, v14, s[84:87], 0 offen sc1
s_bfm_b64 exec, 44, 0
buffer_store_dword v5, v14, s[84:87], s43 offen sc1
s_mov_b64 exec, 1
v_mov_b32 v6, 1
s_waitcnt vmcnt(0)
buffer_store_dword v6, v5, s[56:59], 0 offen sc1
s_mov_b64 exec, -1
Lz_17:
s_lshl_b32 s43, s51, 11
buffer_load_dwordx4 v[96:99], v10, s[8:11], s43 offen offset:0
buffer_load_dwordx4 v[100:103], v10, s[8:11], s43 offen offset:1024
buffer_load_dwordx4 v[104:107], v10, s[8:11], s43 offen offset:2048
buffer_load_dwordx4 v[108:111], v10, s[8:11], s43 offen offset:3072
v_min_u32 v14, 23, v1
v_lshrrev_b32 v15, 3, v14
v_mul_u32_u24 v15, 43008, v15
v_and_b32 v14, 7, v14
v_lshl_add_u32 v15, v14, 4, v15
v_mov_b32 v32, 0x3f803f80
v_mov_b32 v33, 0x3f803f80
v_mov_b32 v34, 0x3f803f80
v_mov_b32 v35, 0x3f803f80
ds_write_b128 v15, v[32:35]
s_add_u32 s20, s82, 26214400
s_addc_u32 s21, s83, 0
s_mov_b32 s22, 16384
s_mov_b32 s23, 0x20000
s_add_u32 s43, s2, 128
s_lshl_b32 s43, s43, 7
v_lshlrev_b32 v14, 2, v1
s_mov_b64 exec, 15
buffer_store_dword v5, v14, s[84:87], s43 offen sc1
s_mov_b64 exec, -1
s_lshl_b32 s43, s34, 4
s_add_u32 s43, s43, s35
s_lshl_b32 s43, s43, 8
s_add_u32 s43, s43, 49152
v_lshlrev_b32 v14, 7, v1
s_mov_b64 exec, 3
buffer_store_dword v5, v14, s[84:87], s43 offen sc1
s_mov_b64 exec, -1
s_lshl_b32 s52, s34, 7
s_add_u32 s52, s52, 28319744
s_sub_u32 s53, s52, 128
s_cmp_eq_u32 s34, 0
s_cselect_b32 s53, s52, s53
s_waitcnt lgkmcnt(0)
s_barrier
s_waitcnt vmcnt(2)
s_mov_b32 s43, 0x3f803f80
v_mov_b32 v116, 0
v_mov_b32 v117, 0
v_mov_b32 v118, 0
v_mov_b32 v119, 0
v_mov_b32 v120, 0
v_mov_b32 v121, 0
v_mov_b32 v122, 0
v_mov_b32 v123, 0
v_dot2_f32_bf16 v116, v96, s43, v116
v_dot2_f32_bf16 v120, v96, v96, v120
v_dot2_f32_bf16 v118, v104, s43, v118
v_dot2_f32_bf16 v122, v104, v104, v122
v_dot2_f32_bf16 v117, v97, s43, v117
v_dot2_f32_bf16 v121, v97, v97, v121
v_dot2_f32_bf16 v119, v105, s43, v119
v_dot2_f32_bf16 v123, v105, v105, v123
v_dot2_f32_bf16 v116, v98, s43, v116
v_dot2_f32_bf16 v120, v98, v98, v120
v_dot2_f32_bf16 v118, v106, s43, v118
v_dot2_f32_bf16 v122, v106, v106, v122
v_dot2_f32_bf16 v117, v99, s43, v117
v_dot2_f32_bf16 v121, v99, v99, v121
v_dot2_f32_bf16 v119, v107, s43, v119
v_dot2_f32_bf16 v123, v107, v107, v123
v_dot2_f32_bf16 v116, v100, s43, v116
v_dot2_f32_bf16 v120, v100, v100, v120
v_dot2_f32_bf16 v118, v108, s43, v118
v_dot2_f32_bf16 v122, v108, v108, v122
v_dot2_f32_bf16 v117, v101, s43, v117
v_dot2_f32_bf16 v121, v101, v101, v121
v_dot2_f32_bf16 v119, v109, s43, v119
v_dot2_f32_bf16 v123, v109, v109, v123
v_dot2_f32_bf16 v116, v102, s43, v116
v_dot2_f32_bf16 v120, v102, v102, v120
v_dot2_f32_bf16 v118, v110, s43, v118
v_dot2_f32_bf16 v122, v110, v110, v122
v_dot2_f32_bf16 v117, v103, s43, v117
v_dot2_f32_bf16 v121, v103, v103, v121
v_dot2_f32_bf16 v119, v111, s43, v119
v_dot2_f32_bf16 v123, v111, v111, v123
s_nop 2
v_add_f32 v116, v116, v117
v_add_f32 v118, v118, v119
v_add_f32 v120, v120, v121
v_add_f32 v122, v122, v123
s_nop 1
v_permlane32_swap_b32 v116, v118
v_permlane32_swap_b32 v120, v122
v_add_f32 v116, v116, v118
v_add_f32 v120, v120, v122
s_nop 1
v_permlane16_swap_b32 v116, v120
v_add_f32 v116, v116, v120
s_nop 1
v_add_f32_dpp v116, v116, v116 row_ror:8 row_mask:0xf bank_mask:0xf
s_nop 1
v_add_f32_dpp v116, v116, v116 row_ror:4 row_mask:0xf bank_mask:0xf
s_nop 1
v_add_f32_dpp v116, v116, v116 row_ror:2 row_mask:0xf bank_mask:0xf
s_nop 1
v_add_f32_dpp v116, v116, v116 row_ror:1 row_mask:0xf bank_mask:0xf
v_mov_b32 v117, v116
s_nop 1
v_permlane16_swap_b32 v116, v117
v_mul_f32 v112, 0x3a800000, v116
v_mul_f32 v113, 0x3a800000, v117
v_fma_f32 v113, -v112, v112, v113
v_max_f32 v113, 0, v113
v_add_f32 v113, 0x3727c5ac, v113
v_rsq_f32 v113, v113
v_lshrrev_b32 v11, 5, v1
s_lshl_b32 s43, s47, 4
s_add_u32 s43, s43, 148608
v_lshl_add_u32 v11, v11, 3, s43
ds_write_b64 v11, v[112:113]
s_waitcnt lgkmcnt(0)
s_mov_b32 s28, s66
s_mov_b32 s29, s67
s_mov_b32 s30, 6291456
s_mov_b32 s31, 0x20000
s_mul_i32 s43, s33, 7040
s_add_u32 s43, s43, 1179648
v_lshlrev_b32 v30, 7, v1
s_bfm_b64 exec, 55, 0
buffer_load_dword v31, v30, s[28:31], s43 offen
s_mov_b64 exec, -1
s_branch Lst_0_0
Lwr_145:
s_barrier
v_lshlrev_b32 v5, 4, v1
v_and_b32 v5, 63, v5
v_add_u32 v6, 148608, v5
ds_read_b128 v[112:115], v6
s_lshl_b32 s43, s63, 3
v_add_u32 v5, s43, v5
s_waitcnt lgkmcnt(0)
s_mov_b64 exec, 15
buffer_store_dwordx4 v[112:115], v5, s[20:23], 0 offen sc1
s_mov_b64 exec, -1
v_mov_b32 v4, 0
buffer_load_dword v6, v4, s[56:59], 0 offen sc1
s_mov_b32 s62, 0
s_mov_b32 s28, s66
s_mov_b32 s29, s67
s_mov_b32 s30, 6291456
s_mov_b32 s31, 0x20000
s_mul_i32 s43, s33, 15872
s_add_u32 s43, s43, 2752512
v_lshlrev_b32 v30, 7, v1
buffer_load_dword v31, v30, s[28:31], s43 offen
s_add_u32 s43, s43, 8192
s_bfm_b64 exec, 60, 0
buffer_load_dword v31, v30, s[28:31], s43 offen
s_mov_b64 exec, -1
s_lshl_b32 s43, s35, 7
s_add_u32 s28, s68, s43
s_addc_u32 s29, s69, 0
s_mov_b32 s30, 2095232
s_mov_b32 s31, 0x20000
v_and_b32 v29, 7, v1
v_lshrrev_b32 v30, 3, v1
v_lshl_add_u32 v29, v30, 6, v29
s_lshl_b32 s43, s48, 3
v_add_u32 v29, s43, v29
v_lshlrev_b32 v29, 11, v29
s_mov_b32 s43, 1048576
s_mov_b32 s28, s68
s_mov_b32 s29, s69
s_mov_b32 s30, 2097152
s_mov_b32 s31, 0x20000
s_mul_i32 s43, s33, 9472
v_lshlrev_b32 v30, 7, v1
buffer_load_dword v31, v30, s[28:31], s43 offen
s_add_u32 s43, s43, 8192
s_bfm_b64 exec, 10, 0
buffer_load_dword v31, v30, s[28:31], s43 offen
s_mov_b64 exec, -1
s_branch Lst_1_0
Lwr_146:
s_barrier
s_branch Lst_2_0
Lwr_147:
s_barrier
s_branch Lst_3_0
Lwr_148:
s_barrier
s_branch Lst_4_0
Lwr_149:
s_barrier
s_branch Lst_5_0
Lwr_150:
s_barrier
s_cmp_eq_u32 s62, 3
s_cbranch_scc1 Lste_21
s_cmp_eq_u32 s62, 2
s_cbranch_scc1 Lst2_19
s_cmp_ge_u32 s62, 4
s_cbranch_scc1 Lst4_20
s_cmp_eq_u32 s62, 1
s_cbranch_scc1 Lst1_18
s_waitcnt vmcnt(4)
v_readfirstlane_b32 s54, v6
s_cmp_eq_u32 s54, 0
s_cbranch_scc0 Lrep_22
buffer_load_dword v6, v4, s[56:59], 0 offen sc1
s_branch Lste_21
Lrep_22:
s_add_u32 s7, s34, 64
s_lshl_b32 s7, s7, 7
v_mov_b32 v5, s7
v_mov_b32 v6, 1
s_mov_b64 exec, 1
buffer_atomic_add v6, v5, s[84:87], 0 offen sc1
s_mov_b64 exec, -1
s_mov_b32 s62, 1
s_mov_b32 s54, 0
s_mov_b32 s55, 0
s_branch Lste_21
Lst1_18:
s_and_b32 s43, s54, s55
s_cmp_eq_u32 s43, 16
s_cbranch_scc1 Lg_23
s_load_dword s54, s[82:83], s52 glc
s_load_dword s55, s[82:83], s53 glc
s_branch Lste_21
Lg_23:
v_add_u32 v5, 0, v1
v_min_u32 v5, 143, v5
v_lshlrev_b32 v20, 3, v5
v_add_u32 v5, s50, v5
v_max_i32 v5, 0, v5
v_lshlrev_b32 v5, 3, v5
buffer_load_dwordx2 v[32:33], v5, s[20:23], 0 offen sc1
v_add_u32 v5, 64, v1
v_min_u32 v5, 143, v5
v_lshlrev_b32 v21, 3, v5
v_add_u32 v5, s50, v5
v_max_i32 v5, 0, v5
v_lshlrev_b32 v5, 3, v5
buffer_load_dwordx2 v[34:35], v5, s[20:23], 0 offen sc1
v_add_u32 v5, 128, v1
v_min_u32 v5, 143, v5
v_lshlrev_b32 v22, 3, v5
v_add_u32 v5, s50, v5
v_max_i32 v5, 0, v5
v_lshlrev_b32 v5, 3, v5
buffer_load_dwordx2 v[36:37], v5, s[20:23], 0 offen sc1
s_mov_b32 s62, 4
s_branch Lste_21
Lst4_20:
s_mov_b32 s62, 2
s_branch Lste_21
Lst2_19:
s_waitcnt vmcnt(0)
v_add_u32 v20, 147456, v20
ds_write_b64 v20, v[32:33]
v_add_u32 v21, 147456, v21
ds_write_b64 v21, v[34:35]
v_add_u32 v22, 147456, v22
ds_write_b64 v22, v[36:37]
s_waitcnt lgkmcnt(0)
s_mov_b32 s62, 3
Lste_21:
s_branch Lst_6_0
Lwr_151:
s_barrier
s_cmp_eq_u32 s62, 3
s_cbranch_scc1 Lste_27
s_cmp_eq_u32 s62, 2
s_cbranch_scc1 Lst2_25
s_cmp_ge_u32 s62, 4
s_cbranch_scc1 Lst4_26
s_cmp_eq_u32 s62, 1
s_cbranch_scc1 Lst1_24
s_waitcnt vmcnt(0)
v_readfirstlane_b32 s54, v6
s_cmp_eq_u32 s54, 0
s_cbranch_scc0 Lrep_28
buffer_load_dword v6, v4, s[56:59], 0 offen sc1
s_branch Lste_27
Lrep_28:
s_add_u32 s7, s34, 64
s_lshl_b32 s7, s7, 7
v_mov_b32 v5, s7
v_mov_b32 v6, 1
s_mov_b64 exec, 1
buffer_atomic_add v6, v5, s[84:87], 0 offen sc1
s_mov_b64 exec, -1
s_mov_b32 s62, 1
s_mov_b32 s54, 0
s_mov_b32 s55, 0
s_branch Lste_27
Lst1_24:
s_and_b32 s43, s54, s55
s_cmp_eq_u32 s43, 16
s_cbranch_scc1 Lg_29
s_load_dword s54, s[82:83], s52 glc
s_load_dword s55, s[82:83], s53 glc
s_branch Lste_27
Lg_29:
v_add_u32 v5, 0, v1
v_min_u32 v5, 143, v5
v_lshlrev_b32 v20, 3, v5
v_add_u32 v5, s50, v5
v_max_i32 v5, 0, v5
v_lshlrev_b32 v5, 3, v5
buffer_load_dwordx2 v[32:33], v5, s[20:23], 0 offen sc1
v_add_u32 v5, 64, v1
v_min_u32 v5, 143, v5
v_lshlrev_b32 v21, 3, v5
v_add_u32 v5, s50, v5
v_max_i32 v5, 0, v5
v_lshlrev_b32 v5, 3, v5
buffer_load_dwordx2 v[34:35], v5, s[20:23], 0 offen sc1
v_add_u32 v5, 128, v1
v_min_u32 v5, 143, v5
v_lshlrev_b32 v22, 3, v5
v_add_u32 v5, s50, v5
v_max_i32 v5, 0, v5
v_lshlrev_b32 v5, 3, v5
buffer_load_dwordx2 v[36:37], v5, s[20:23], 0 offen sc1
s_mov_b32 s62, 4
s_branch Lste_27
Lst4_26:
s_mov_b32 s62, 2
s_branch Lste_27
Lst2_25:
s_waitcnt vmcnt(0)
v_add_u32 v20, 147456, v20
ds_write_b64 v20, v[32:33]
v_add_u32 v21, 147456, v21
ds_write_b64 v21, v[34:35]
v_add_u32 v22, 147456, v22
ds_write_b64 v22, v[36:37]
s_waitcnt lgkmcnt(0)
s_mov_b32 s62, 3
Lste_27:
s_branch Lst_7_0
Lwr_152:
s_barrier
s_cmp_eq_u32 s62, 3
s_cbranch_scc1 Lste_33
s_cmp_eq_u32 s62, 2
s_cbranch_scc1 Lst2_31
s_cmp_ge_u32 s62, 4
s_cbranch_scc1 Lst4_32
s_cmp_eq_u32 s62, 1
s_cbranch_scc1 Lst1_30
s_waitcnt vmcnt(0)
v_readfirstlane_b32 s54, v6
s_cmp_eq_u32 s54, 0
s_cbranch_scc0 Lrep_34
buffer_load_dword v6, v4, s[56:59], 0 offen sc1
s_branch Lste_33
Lrep_34:
s_add_u32 s7, s34, 64
s_lshl_b32 s7, s7, 7
v_mov_b32 v5, s7
v_mov_b32 v6, 1
s_mov_b64 exec, 1
buffer_atomic_add v6, v5, s[84:87], 0 offen sc1
s_mov_b64 exec, -1
s_mov_b32 s62, 1
s_mov_b32 s54, 0
s_mov_b32 s55, 0
s_branch Lste_33
Lst1_30:
s_and_b32 s43, s54, s55
s_cmp_eq_u32 s43, 16
s_cbranch_scc1 Lg_35
s_load_dword s54, s[82:83], s52 glc
s_load_dword s55, s[82:83], s53 glc
s_branch Lste_33
Lg_35:
v_add_u32 v5, 0, v1
v_min_u32 v5, 143, v5
v_lshlrev_b32 v20, 3, v5
v_add_u32 v5, s50, v5
v_max_i32 v5, 0, v5
v_lshlrev_b32 v5, 3, v5
buffer_load_dwordx2 v[32:33], v5, s[20:23], 0 offen sc1
v_add_u32 v5, 64, v1
v_min_u32 v5, 143, v5
v_lshlrev_b32 v21, 3, v5
v_add_u32 v5, s50, v5
v_max_i32 v5, 0, v5
v_lshlrev_b32 v5, 3, v5
buffer_load_dwordx2 v[34:35], v5, s[20:23], 0 offen sc1
v_add_u32 v5, 128, v1
v_min_u32 v5, 143, v5
v_lshlrev_b32 v22, 3, v5
v_add_u32 v5, s50, v5
v_max_i32 v5, 0, v5
v_lshlrev_b32 v5, 3, v5
buffer_load_dwordx2 v[36:37], v5, s[20:23], 0 offen sc1
s_mov_b32 s62, 4
s_branch Lste_33
Lst4_32:
s_mov_b32 s62, 2
s_branch Lste_33
Lst2_31:
s_waitcnt vmcnt(0)
v_add_u32 v20, 147456, v20
ds_write_b64 v20, v[32:33]
v_add_u32 v21, 147456, v21
ds_write_b64 v21, v[34:35]
v_add_u32 v22, 147456, v22
ds_write_b64 v22, v[36:37]
s_waitcnt lgkmcnt(0)
s_mov_b32 s62, 3
Lste_33:
s_branch Lst_8_0
Lwr_153:
s_barrier
s_cmp_eq_u32 s62, 3
s_cbranch_scc1 Lste_39
s_cmp_eq_u32 s62, 2
s_cbranch_scc1 Lst2_37
s_cmp_ge_u32 s62, 4
s_cbranch_scc1 Lst4_38
s_cmp_eq_u32 s62, 1
s_cbranch_scc1 Lst1_36
s_waitcnt vmcnt(0)
v_readfirstlane_b32 s54, v6
s_cmp_eq_u32 s54, 0
s_cbranch_scc0 Lrep_40
buffer_load_dword v6, v4, s[56:59], 0 offen sc1
s_branch Lste_39
Lrep_40:
s_add_u32 s7, s34, 64
s_lshl_b32 s7, s7, 7
v_mov_b32 v5, s7
v_mov_b32 v6, 1
s_mov_b64 exec, 1
buffer_atomic_add v6, v5, s[84:87], 0 offen sc1
s_mov_b64 exec, -1
s_mov_b32 s62, 1
s_mov_b32 s54, 0
s_mov_b32 s55, 0
s_branch Lste_39
Lst1_36:
s_and_b32 s43, s54, s55
s_cmp_eq_u32 s43, 16
s_cbranch_scc1 Lg_41
s_load_dword s54, s[82:83], s52 glc
s_load_dword s55, s[82:83], s53 glc
s_branch Lste_39
Lg_41:
v_add_u32 v5, 0, v1
v_min_u32 v5, 143, v5
v_lshlrev_b32 v20, 3, v5
v_add_u32 v5, s50, v5
v_max_i32 v5, 0, v5
v_lshlrev_b32 v5, 3, v5
buffer_load_dwordx2 v[32:33], v5, s[20:23], 0 offen sc1
v_add_u32 v5, 64, v1
v_min_u32 v5, 143, v5
v_lshlrev_b32 v21, 3, v5
v_add_u32 v5, s50, v5
v_max_i32 v5, 0, v5
v_lshlrev_b32 v5, 3, v5
buffer_load_dwordx2 v[34:35], v5, s[20:23], 0 offen sc1
v_add_u32 v5, 128, v1
v_min_u32 v5, 143, v5
v_lshlrev_b32 v22, 3, v5
v_add_u32 v5, s50, v5
v_max_i32 v5, 0, v5
v_lshlrev_b32 v5, 3, v5
buffer_load_dwordx2 v[36:37], v5, s[20:23], 0 offen sc1
s_mov_b32 s62, 4
s_branch Lste_39
Lst4_38:
s_mov_b32 s62, 2
s_branch Lste_39
Lst2_37:
s_waitcnt vmcnt(0)
v_add_u32 v20, 147456, v20
ds_write_b64 v20, v[32:33]
v_add_u32 v21, 147456, v21
ds_write_b64 v21, v[34:35]
v_add_u32 v22, 147456, v22
ds_write_b64 v22, v[36:37]
s_waitcnt lgkmcnt(0)
s_mov_b32 s62, 3
Lste_39:
s_branch Lst_9_0
Lwr_154:
s_barrier
s_getpc_b64 s[100:101]
s_and_b32 s100, s100, 0xfffff000
s_sub_u32 s100, s100, 1064960
s_subb_u32 s101, s101, 0
s_lshr_b32 s6, s2, 3
s_mul_i32 s6, s6, 1
s_and_b32 s7, s36, 0
s_add_u32 s6, s6, s7
s_mulk_i32 s6, 640
s_add_u32 s6, s6, 1063168
s_load_dword s3, s[100:101], s6 offset:0
s_load_dword s3, s[100:101], s6 offset:64
s_load_dword s3, s[100:101], s6 offset:128
s_load_dword s3, s[100:101], s6 offset:192
s_load_dword s3, s[100:101], s6 offset:256
s_load_dword s3, s[100:101], s6 offset:320
s_load_dword s3, s[100:101], s6 offset:384
s_load_dword s3, s[100:101], s6 offset:448
s_load_dword s3, s[100:101], s6 offset:512
s_load_dword s3, s[100:101], s6 offset:576
s_nop 0
s_nop 0
s_nop 0
s_nop 0
s_nop 0
s_nop 0
s_nop 0
s_nop 0
s_nop 0
s_nop 0
s_cmp_eq_u32 s62, 3
s_cbranch_scc1 Lste_45
s_cmp_eq_u32 s62, 2
s_cbranch_scc1 Lst2_43
s_cmp_ge_u32 s62, 4
s_cbranch_scc1 Lst4_44
s_cmp_eq_u32 s62, 1
s_cbranch_scc1 Lst1_42
s_waitcnt vmcnt(0)
v_readfirstlane_b32 s54, v6
s_cmp_eq_u32 s54, 0
s_cbranch_scc0 Lrep_46
buffer_load_dword v6, v4, s[56:59], 0 offen sc1
s_branch Lste_45
Lrep_46:
s_add_u32 s7, s34, 64
s_lshl_b32 s7, s7, 7
v_mov_b32 v5, s7
v_mov_b32 v6, 1
s_mov_b64 exec, 1
buffer_atomic_add v6, v5, s[84:87], 0 offen sc1
s_mov_b64 exec, -1
s_mov_b32 s62, 1
s_mov_b32 s54, 0
s_mov_b32 s55, 0
s_branch Lste_45
Lst1_42:
s_and_b32 s43, s54, s55
s_cmp_eq_u32 s43, 16
s_cbranch_scc1 Lg_47
s_load_dword s54, s[82:83], s52 glc
s_load_dword s55, s[82:83], s53 glc
s_branch Lste_45
Lg_47:
v_add_u32 v5, 0, v1
v_min_u32 v5, 143, v5
v_lshlrev_b32 v20, 3, v5
v_add_u32 v5, s50, v5
v_max_i32 v5, 0, v5
v_lshlrev_b32 v5, 3, v5
buffer_load_dwordx2 v[32:33], v5, s[20:23], 0 offen sc1
v_add_u32 v5, 64, v1
v_min_u32 v5, 143, v5
v_lshlrev_b32 v21, 3, v5
v_add_u32 v5, s50, v5
v_max_i32 v5, 0, v5
v_lshlrev_b32 v5, 3, v5
buffer_load_dwordx2 v[34:35], v5, s[20:23], 0 offen sc1
v_add_u32 v5, 128, v1
v_min_u32 v5, 143, v5
v_lshlrev_b32 v22, 3, v5
v_add_u32 v5, s50, v5
v_max_i32 v5, 0, v5
v_lshlrev_b32 v5, 3, v5
buffer_load_dwordx2 v[36:37], v5, s[20:23], 0 offen sc1
s_mov_b32 s62, 4
s_branch Lste_45
Lst4_44:
s_mov_b32 s62, 2
s_branch Lste_45
Lst2_43:
s_waitcnt vmcnt(0)
v_add_u32 v20, 147456, v20
ds_write_b64 v20, v[32:33]
v_add_u32 v21, 147456, v21
ds_write_b64 v21, v[34:35]
v_add_u32 v22, 147456, v22
ds_write_b64 v22, v[36:37]
s_waitcnt lgkmcnt(0)
s_mov_b32 s62, 3
Lste_45:
s_branch Lst_10_0
Lwr_155:
s_barrier
s_cmp_eq_u32 s62, 3
s_cbranch_scc1 Lste_51
s_cmp_eq_u32 s62, 2
s_cbranch_scc1 Lst2_49
s_cmp_ge_u32 s62, 4
s_cbranch_scc1 Lst4_50
s_cmp_eq_u32 s62, 1
s_cbranch_scc1 Lst1_48
s_waitcnt vmcnt(0)
v_readfirstlane_b32 s54, v6
s_cmp_eq_u32 s54, 0
s_cbranch_scc0 Lrep_52
buffer_load_dword v6, v4, s[56:59], 0 offen sc1
s_branch Lste_51
Lrep_52:
s_add_u32 s7, s34, 64
s_lshl_b32 s7, s7, 7
v_mov_b32 v5, s7
v_mov_b32 v6, 1
s_mov_b64 exec, 1
buffer_atomic_add v6, v5, s[84:87], 0 offen sc1
s_mov_b64 exec, -1
s_mov_b32 s62, 1
s_mov_b32 s54, 0
s_mov_b32 s55, 0
s_branch Lste_51
Lst1_48:
s_and_b32 s43, s54, s55
s_cmp_eq_u32 s43, 16
s_cbranch_scc1 Lg_53
s_load_dword s54, s[82:83], s52 glc
s_load_dword s55, s[82:83], s53 glc
s_branch Lste_51
Lg_53:
v_add_u32 v5, 0, v1
v_min_u32 v5, 143, v5
v_lshlrev_b32 v20, 3, v5
v_add_u32 v5, s50, v5
v_max_i32 v5, 0, v5
v_lshlrev_b32 v5, 3, v5
buffer_load_dwordx2 v[32:33], v5, s[20:23], 0 offen sc1
v_add_u32 v5, 64, v1
v_min_u32 v5, 143, v5
v_lshlrev_b32 v21, 3, v5
v_add_u32 v5, s50, v5
v_max_i32 v5, 0, v5
v_lshlrev_b32 v5, 3, v5
buffer_load_dwordx2 v[34:35], v5, s[20:23], 0 offen sc1
v_add_u32 v5, 128, v1
v_min_u32 v5, 143, v5
v_lshlrev_b32 v22, 3, v5
v_add_u32 v5, s50, v5
v_max_i32 v5, 0, v5
v_lshlrev_b32 v5, 3, v5
buffer_load_dwordx2 v[36:37], v5, s[20:23], 0 offen sc1
s_mov_b32 s62, 4
s_branch Lste_51
Lst4_50:
s_mov_b32 s62, 2
s_branch Lste_51
Lst2_49:
s_waitcnt vmcnt(0)
v_add_u32 v20, 147456, v20
ds_write_b64 v20, v[32:33]
v_add_u32 v21, 147456, v21
ds_write_b64 v21, v[34:35]
v_add_u32 v22, 147456, v22
ds_write_b64 v22, v[36:37]
s_waitcnt lgkmcnt(0)
s_mov_b32 s62, 3
Lste_51:
s_branch Lst_11_0
Lwr_156:
s_barrier
s_cmp_eq_u32 s62, 3
s_cbranch_scc1 Lste_57
s_cmp_eq_u32 s62, 2
s_cbranch_scc1 Lst2_55
s_cmp_ge_u32 s62, 4
s_cbranch_scc1 Lst4_56
s_cmp_eq_u32 s62, 1
s_cbranch_scc1 Lst1_54
s_waitcnt vmcnt(0)
v_readfirstlane_b32 s54, v6
s_cmp_eq_u32 s54, 0
s_cbranch_scc0 Lrep_58
buffer_load_dword v6, v4, s[56:59], 0 offen sc1
s_branch Lste_57
Lrep_58:
s_add_u32 s7, s34, 64
s_lshl_b32 s7, s7, 7
v_mov_b32 v5, s7
v_mov_b32 v6, 1
s_mov_b64 exec, 1
buffer_atomic_add v6, v5, s[84:87], 0 offen sc1
s_mov_b64 exec, -1
s_mov_b32 s62, 1
s_mov_b32 s54, 0
s_mov_b32 s55, 0
s_branch Lste_57
Lst1_54:
s_and_b32 s43, s54, s55
s_cmp_eq_u32 s43, 16
s_cbranch_scc1 Lg_59
s_load_dword s54, s[82:83], s52 glc
s_load_dword s55, s[82:83], s53 glc
s_branch Lste_57
Lg_59:
v_add_u32 v5, 0, v1
v_min_u32 v5, 143, v5
v_lshlrev_b32 v20, 3, v5
v_add_u32 v5, s50, v5
v_max_i32 v5, 0, v5
v_lshlrev_b32 v5, 3, v5
buffer_load_dwordx2 v[32:33], v5, s[20:23], 0 offen sc1
v_add_u32 v5, 64, v1
v_min_u32 v5, 143, v5
v_lshlrev_b32 v21, 3, v5
v_add_u32 v5, s50, v5
v_max_i32 v5, 0, v5
v_lshlrev_b32 v5, 3, v5
buffer_load_dwordx2 v[34:35], v5, s[20:23], 0 offen sc1
v_add_u32 v5, 128, v1
v_min_u32 v5, 143, v5
v_lshlrev_b32 v22, 3, v5
v_add_u32 v5, s50, v5
v_max_i32 v5, 0, v5
v_lshlrev_b32 v5, 3, v5
buffer_load_dwordx2 v[36:37], v5, s[20:23], 0 offen sc1
s_mov_b32 s62, 4
s_branch Lste_57
Lst4_56:
s_mov_b32 s62, 2
s_branch Lste_57
Lst2_55:
s_waitcnt vmcnt(0)
v_add_u32 v20, 147456, v20
ds_write_b64 v20, v[32:33]
v_add_u32 v21, 147456, v21
ds_write_b64 v21, v[34:35]
v_add_u32 v22, 147456, v22
ds_write_b64 v22, v[36:37]
s_waitcnt lgkmcnt(0)
s_mov_b32 s62, 3
Lste_57:
s_branch Lst_12_0
Lwr_157:
s_barrier
s_cmp_eq_u32 s62, 3
s_cbranch_scc1 Lste_63
s_cmp_eq_u32 s62, 2
s_cbranch_scc1 Lst2_61
s_cmp_ge_u32 s62, 4
s_cbranch_scc1 Lst4_62
s_cmp_eq_u32 s62, 1
s_cbranch_scc1 Lst1_60
s_waitcnt vmcnt(0)
v_readfirstlane_b32 s54, v6
s_cmp_eq_u32 s54, 0
s_cbranch_scc0 Lrep_64
buffer_load_dword v6, v4, s[56:59], 0 offen sc1
s_branch Lste_63
Lrep_64:
s_add_u32 s7, s34, 64
s_lshl_b32 s7, s7, 7
v_mov_b32 v5, s7
v_mov_b32 v6, 1
s_mov_b64 exec, 1
buffer_atomic_add v6, v5, s[84:87], 0 offen sc1
s_mov_b64 exec, -1
s_mov_b32 s62, 1
s_mov_b32 s54, 0
s_mov_b32 s55, 0
s_branch Lste_63
Lst1_60:
s_and_b32 s43, s54, s55
s_cmp_eq_u32 s43, 16
s_cbranch_scc1 Lg_65
s_load_dword s54, s[82:83], s52 glc
s_load_dword s55, s[82:83], s53 glc
s_branch Lste_63
Lg_65:
v_add_u32 v5, 0, v1
v_min_u32 v5, 143, v5
v_lshlrev_b32 v20, 3, v5
v_add_u32 v5, s50, v5
v_max_i32 v5, 0, v5
v_lshlrev_b32 v5, 3, v5
buffer_load_dwordx2 v[32:33], v5, s[20:23], 0 offen sc1
v_add_u32 v5, 64, v1
v_min_u32 v5, 143, v5
v_lshlrev_b32 v21, 3, v5
v_add_u32 v5, s50, v5
v_max_i32 v5, 0, v5
v_lshlrev_b32 v5, 3, v5
buffer_load_dwordx2 v[34:35], v5, s[20:23], 0 offen sc1
v_add_u32 v5, 128, v1
v_min_u32 v5, 143, v5
v_lshlrev_b32 v22, 3, v5
v_add_u32 v5, s50, v5
v_max_i32 v5, 0, v5
v_lshlrev_b32 v5, 3, v5
buffer_load_dwordx2 v[36:37], v5, s[20:23], 0 offen sc1
s_mov_b32 s62, 4
s_branch Lste_63
Lst4_62:
s_mov_b32 s62, 2
s_branch Lste_63
Lst2_61:
s_waitcnt vmcnt(0)
s_branch Lov_4
.p2align 12
.fill 32, 4, 0xbf800000
Lst_4_0:
s_branch Lwr_149
s_nop 0
s_nop 0
Lov_4:
v_add_u32 v20, 147456, v20
ds_write_b64 v20, v[32:33]
v_add_u32 v21, 147456, v21
ds_write_b64 v21, v[34:35]
v_add_u32 v22, 147456, v22
ds_write_b64 v22, v[36:37]
s_waitcnt lgkmcnt(0)
s_mov_b32 s62, 3
Lste_63:
s_branch Lst_13_0
Lwr_158:
s_barrier
s_cmp_eq_u32 s62, 3
s_cbranch_scc1 Lste_69
s_cmp_eq_u32 s62, 2
s_cbranch_scc1 Lst2_67
s_cmp_ge_u32 s62, 4
s_cbranch_scc1 Lst4_68
s_cmp_eq_u32 s62, 1
s_cbranch_scc1 Lst1_66
s_waitcnt vmcnt(0)
v_readfirstlane_b32 s54, v6
s_cmp_eq_u32 s54, 0
s_cbranch_scc0 Lrep_70
buffer_load_dword v6, v4, s[56:59], 0 offen sc1
s_branch Lste_69
Lrep_70:
s_add_u32 s7, s34, 64
s_lshl_b32 s7, s7, 7
v_mov_b32 v5, s7
v_mov_b32 v6, 1
s_mov_b64 exec, 1
buffer_atomic_add v6, v5, s[84:87], 0 offen sc1
s_mov_b64 exec, -1
s_mov_b32 s62, 1
s_mov_b32 s54, 0
s_mov_b32 s55, 0
s_branch Lste_69
Lst1_66:
s_and_b32 s43, s54, s55
s_cmp_eq_u32 s43, 16
s_cbranch_scc1 Lg_71
s_load_dword s54, s[82:83], s52 glc
s_load_dword s55, s[82:83], s53 glc
s_branch Lste_69
Lg_71:
v_add_u32 v5, 0, v1
v_min_u32 v5, 143, v5
v_lshlrev_b32 v20, 3, v5
v_add_u32 v5, s50, v5
v_max_i32 v5, 0, v5
v_lshlrev_b32 v5, 3, v5
buffer_load_dwordx2 v[32:33], v5, s[20:23], 0 offen sc1
v_add_u32 v5, 64, v1
v_min_u32 v5, 143, v5
v_lshlrev_b32 v21, 3, v5
v_add_u32 v5, s50, v5
v_max_i32 v5, 0, v5
v_lshlrev_b32 v5, 3, v5
buffer_load_dwordx2 v[34:35], v5, s[20:23], 0 offen sc1
v_add_u32 v5, 128, v1
v_min_u32 v5, 143, v5
v_lshlrev_b32 v22, 3, v5
v_add_u32 v5, s50, v5
v_max_i32 v5, 0, v5
v_lshlrev_b32 v5, 3, v5
buffer_load_dwordx2 v[36:37], v5, s[20:23], 0 offen sc1
s_mov_b32 s62, 4
s_branch Lste_69
Lst4_68:
s_mov_b32 s62, 2
s_branch Lste_69
Lst2_67:
s_waitcnt vmcnt(0)
v_add_u32 v20, 147456, v20
ds_write_b64 v20, v[32:33]
v_add_u32 v21, 147456, v21
ds_write_b64 v21, v[34:35]
v_add_u32 v22, 147456, v22
ds_write_b64 v22, v[36:37]
s_waitcnt lgkmcnt(0)
s_mov_b32 s62, 3
Lste_69:
s_branch Lst_14_0
Lwr_159:
s_barrier
s_cmp_eq_u32 s62, 3
s_cbranch_scc1 Lste_74
s_cmp_ge_u32 s62, 5
s_cbranch_scc1 Lg_79
s_cmp_ge_u32 s62, 2
s_cbranch_scc1 Lst2_73
s_cmp_eq_u32 s62, 1
s_cbranch_scc1 Lst1_72
s_mov_b32 s41, 0x40000
Lz0_75:
s_waitcnt vmcnt(0)
v_readfirstlane_b32 s54, v6
s_cmp_eq_u32 s54, 0
s_cbranch_scc0 Lzok_76
buffer_load_dword v6, v4, s[56:59], 0 offen sc1
s_sub_u32 s41, s41, 1
s_cmp_lg_u32 s41, 0
s_cbranch_scc1 Lz0_75
s_waitcnt lgkmcnt(0)
Lzok_76:
s_add_u32 s7, s34, 64
s_lshl_b32 s7, s7, 7
v_mov_b32 v5, s7
v_mov_b32 v6, 1
s_mov_b64 exec, 1
buffer_atomic_add v6, v5, s[84:87], 0 offen sc1
s_mov_b64 exec, -1
Lst1_72:
s_load_dword s54, s[82:83], s52 glc
s_load_dword s55, s[82:83], s53 glc
s_mov_b32 s41, 0x40000
Lpoll_77:
s_waitcnt lgkmcnt(0)
s_and_b32 s54, s54, s55
s_cmp_eq_u32 s54, 16
s_cbranch_scc1 Lg_79
s_load_dword s54, s[82:83], s52 glc
s_load_dword s55, s[82:83], s53 glc
s_sub_u32 s41, s41, 1
s_cmp_lg_u32 s41, 0
s_cbranch_scc1 Lpoll_77
s_waitcnt lgkmcnt(0)
Lg_79:
v_add_u32 v5, 0, v1
v_min_u32 v5, 143, v5
v_lshlrev_b32 v20, 3, v5
v_add_u32 v5, s50, v5
v_max_i32 v5, 0, v5
v_lshlrev_b32 v5, 3, v5
buffer_load_dwordx2 v[32:33], v5, s[20:23], 0 offen sc1
v_add_u32 v5, 64, v1
v_min_u32 v5, 143, v5
v_lshlrev_b32 v21, 3, v5
v_add_u32 v5, s50, v5
v_max_i32 v5, 0, v5
v_lshlrev_b32 v5, 3, v5
buffer_load_dwordx2 v[34:35], v5, s[20:23], 0 offen sc1
v_add_u32 v5, 128, v1
v_min_u32 v5, 143, v5
v_lshlrev_b32 v22, 3, v5
v_add_u32 v5, s50, v5
v_max_i32 v5, 0, v5
v_lshlrev_b32 v5, 3, v5
buffer_load_dwordx2 v[36:37], v5, s[20:23], 0 offen sc1
Lst2_73:
s_waitcnt vmcnt(0)
v_add_u32 v20, 147456, v20
ds_write_b64 v20, v[32:33]
v_add_u32 v21, 147456, v21
ds_write_b64 v21, v[34:35]
v_add_u32 v22, 147456, v22
ds_write_b64 v22, v[36:37]
s_waitcnt lgkmcnt(0)
Lste_74:
s_bitcmp0_b32 s2, 0
s_cselect_b32 s88, s72, s74
s_cselect_b32 s89, s73, s75
s_cmp_lt_u32 s2, 192
s_cselect_b32 s90, 7340032, 0
s_mov_b32 s91, 0x20000
s_bfe_u32 s44, s2, 0x30001
s_lshl_b32 s44, s44, 2
s_and_b32 s43, s36, 3
s_add_u32 s44, s44, s43
s_lshl_b32 s44, s44, 5
v_lshrrev_b32 v18, 4, v1
v_add_u32 v18, s44, v18
v_mul_u32_u24 v18, 7168, v18
v_and_b32 v19, 15, v1
v_lshl_add_u32 v18, v19, 4, v18
s_lshr_b32 s43, s2, 4
s_lshl_b32 s43, s43, 8
s_add_u32 s43, s43, 4096
v_add_u32 v18, s43, v18
s_mov_b32 s43, 0
buffer_load_dwordx4 v[128:131], v18, s[88:91], s43 offen
s_mov_b32 s43, 28672
buffer_load_dwordx4 v[132:135], v18, s[88:91], s43 offen
s_mov_b32 s43, 57344
buffer_load_dwordx4 v[136:139], v18, s[88:91], s43 offen
s_mov_b32 s43, 86016
buffer_load_dwordx4 v[140:143], v18, s[88:91], s43 offen
s_mov_b32 s43, 114688
buffer_load_dwordx4 v[144:147], v18, s[88:91], s43 offen
s_mov_b32 s43, 143360
buffer_load_dwordx4 v[148:151], v18, s[88:91], s43 offen
s_mov_b32 s43, 172032
buffer_load_dwordx4 v[152:155], v18, s[88:91], s43 offen
s_mov_b32 s43, 200704
buffer_load_dwordx4 v[156:159], v18, s[88:91], s43 offen
s_barrier
s_lshl_b32 s43, s35, 7
s_add_u32 s28, s68, s43
s_addc_u32 s29, s69, 0
s_mov_b32 s30, 2095232
s_mov_b32 s31, 0x20000
v_lshrrev_b32 v15, 3, v1
v_and_b32 v16, 6, v15
v_and_b32 v7, 7, v1
v_xor_b32 v7, v7, v16
v_lshlrev_b32 v7, 4, v7
v_mul_u32_u24 v15, 2048, v15
v_add_u32 v7, v7, v15
s_and_b32 s40, s36, 3
s_lshl_b32 s39, s40, 13
s_add_u32 s40, s40, s35
s_add_u32 s42, s40, 0
s_and_b32 s42, s42, 15
s_lshl_b32 s42, s42, 17
s_add_u32 m0, s39, 65536
s_add_u32 s43, s42, 0
buffer_load_dwordx4 v7, s[28:31], s43 offen lds
s_add_u32 m0, s39, 66560
s_add_u32 s43, s42, 16384
buffer_load_dwordx4 v7, s[28:31], s43 offen lds
s_add_u32 m0, s39, 67584
s_add_u32 s43, s42, 32768
buffer_load_dwordx4 v7, s[28:31], s43 offen lds
s_add_u32 m0, s39, 68608
s_add_u32 s43, s42, 49152
buffer_load_dwordx4 v7, s[28:31], s43 offen lds
s_add_u32 m0, s39, 69632
s_add_u32 s43, s42, 65536
buffer_load_dwordx4 v7, s[28:31], s43 offen lds
s_add_u32 m0, s39, 70656
s_add_u32 s43, s42, 81920
buffer_load_dwordx4 v7, s[28:31], s43 offen lds
s_add_u32 m0, s39, 71680
s_add_u32 s43, s42, 98304
buffer_load_dwordx4 v7, s[28:31], s43 offen lds
s_add_u32 m0, s39, 72704
s_add_u32 s43, s42, 114688
buffer_load_dwordx4 v7, s[28:31], s43 offen lds
Lats_6:
s_and_b32 s43, s36, 1
s_bfe_u32 s44, s36, 0x10001
s_lshr_b32 s45, s36, 2
v_lshlrev_b32 v14, 2, v13
v_sub_u32 v14, v12, v14
v_mov_b32 v16, 0xff800000
s_or_b32 s46, s34, s45
s_cmp_lg_u32 s46, 0
s_cselect_b32 s46, 0, 0xff800000
v_subrev_u32 v15, 0, v14
v_cmp_ge_u32 vcc, 7, v15
v_add_u32 v15, 16, v15
s_nop 0
v_cndmask_b32 v248, v16, 0, vcc
v_cmp_ge_u32 vcc, 7, v15
s_nop 1
v_cndmask_b32 v244, v16, 0, vcc
v_or_b32 v240, s46, v244
v_subrev_u32 v15, 1, v14
v_cmp_ge_u32 vcc, 7, v15
v_add_u32 v15, 16, v15
s_nop 0
v_cndmask_b32 v249, v16, 0, vcc
v_cmp_ge_u32 vcc, 7, v15
s_nop 1
v_cndmask_b32 v245, v16, 0, vcc
v_or_b32 v241, s46, v245
v_subrev_u32 v15, 2, v14
v_cmp_ge_u32 vcc, 7, v15
v_add_u32 v15, 16, v15
s_nop 0
v_cndmask_b32 v250, v16, 0, vcc
v_cmp_ge_u32 vcc, 7, v15
s_nop 1
v_cndmask_b32 v246, v16, 0, vcc
v_or_b32 v242, s46, v246
v_subrev_u32 v15, 3, v14
v_cmp_ge_u32 vcc, 7, v15
v_add_u32 v15, 16, v15
s_nop 0
v_cndmask_b32 v251, v16, 0, vcc
v_cmp_ge_u32 vcc, 7, v15
s_nop 1
v_cndmask_b32 v247, v16, 0, vcc
v_or_b32 v243, s46, v247
s_lshl_b32 s46, s45, 6
s_add_u32 s46, s46, s44
s_add_u32 s46, s46, 16
v_lshl_add_u32 v14, v12, 1, s46
s_lshl_b32 s47, s43, 6
v_lshl_add_u32 v15, v13, 4, s47
v_mul_u32_u24 v20, 400, v14
v_add_u32 v20, v20, v15
v_subrev_u32 v16, 32, v14
v_max_i32 v16, 0, v16
v_mul_u32_u24 v21, 400, v16
v_add_u32 v21, v21, v15
v_lshrrev_b32 v16, 2, v12
v_lshl_add_u32 v16, v13, 2, v16
v_lshl_add_u32 v16, v16, 1, s46
v_and_b32 v17, 3, v1
v_lshl_add_u32 v17, v17, 3, s47
v_mul_u32_u24 v22, 400, v16
v_add_u32 v22, v22, v17
v_subrev_u32 v16, 32, v16
v_max_i32 v16, 0, v16
v_mul_u32_u24 v23, 400, v16
v_add_u32 v23, v23, v17
s_mul_i32 s60, s34, 262144
s_add_u32 s16, s82, s60
s_addc_u32 s17, s83, 0
s_mov_b32 s18, 262144
s_mov_b32 s19, 0x20000
s_lshl_b32 s60, s35, 14
s_lshl_b32 s43, s43, 13
s_add_u32 s60, s60, s43
s_lshl_b32 s43, s45, 12
s_add_u32 s60, s60, s43
s_lshl_b32 s43, s44, 10
s_add_u32 s60, s60, s43
v_lshlrev_b32 v24, 4, v1
s_mov_b32 s61, 0x3e8293ee
s_lshl_b32 s38, s35, 7
Latt_5:
s_barrier
ds_read_b128 v[32:35], v20 offset:0
ds_read_b128 v[36:39], v20 offset:128
ds_read_b128 v[40:43], v21 offset:128
ds_read_b128 v[80:83], v20 offset:12800
ds_read_b128 v[84:87], v20 offset:12928
ds_read_b128 v[88:91], v20 offset:128
ds_read_b64_tr_b16 v[44:45], v23 offset:256
ds_read_b64_tr_b16 v[46:47], v22 offset:256
ds_read_b64_tr_b16 v[48:49], v23 offset:288
ds_read_b64_tr_b16 v[50:51], v22 offset:288
ds_read_b64_tr_b16 v[92:93], v22 offset:256
ds_read_b64_tr_b16 v[94:95], v22 offset:13056
ds_read_b64_tr_b16 v[96:97], v22 offset:288
ds_read_b64_tr_b16 v[98:99], v22 offset:13088
s_waitcnt lgkmcnt(11)
v_mfma_f32_16x16x32_bf16 v[52:55], v[40:43], v[32:35], v[240:243]
v_mfma_f32_16x16x32_bf16 v[56:59], v[36:39], v[32:35], v[248:251]
s_waitcnt lgkmcnt(8)
v_mfma_f32_16x16x32_bf16 v[100:103], v[88:91], v[80:83], v[244:247]
v_mfma_f32_16x16x32_bf16 v[104:107], v[84:87], v[80:83], v[248:251]
s_nop 5
v_max3_f32 v60, v52, v53, v54
v_max3_f32 v108, v100, v101, v102
v_max3_f32 v61, v55, v56, v57
v_max3_f32 v109, v103, v104, v105
v_max3_f32 v60, v60, v58, v59
v_max3_f32 v108, v108, v106, v107
v_max_f32 v60, v60, v61
v_max_f32 v108, v108, v109
s_nop 1
v_permlane32_swap_b32 v60, v108
v_max_f32 v60, v60, v108
v_mov_b32 v61, v60
s_nop 1
v_permlane16_swap_b32 v60, v61
v_max_f32 v60, v60, v61
v_mul_f32 v60, s61, v60
s_nop 0
v_mov_b32 v108, v60
s_nop 1
v_permlane32_swap_b32 v60, v108
v_fma_f32 v52, v52, s61, -v60
v_fma_f32 v100, v100, s61, -v108
v_fma_f32 v53, v53, s61, -v60
v_fma_f32 v101, v101, s61, -v108
v_fma_f32 v54, v54, s61, -v60
v_fma_f32 v102, v102, s61, -v108
v_fma_f32 v55, v55, s61, -v60
v_fma_f32 v103, v103, s61, -v108
v_fma_f32 v56, v56, s61, -v60
v_fma_f32 v104, v104, s61, -v108
v_fma_f32 v57, v57, s61, -v60
v_fma_f32 v105, v105, s61, -v108
v_fma_f32 v58, v58, s61, -v60
v_fma_f32 v106, v106, s61, -v108
v_fma_f32 v59, v59, s61, -v60
v_fma_f32 v107, v107, s61, -v108
v_exp_f32 v52, v52
v_exp_f32 v100, v100
v_exp_f32 v53, v53
v_exp_f32 v101, v101
v_exp_f32 v54, v54
v_exp_f32 v102, v102
v_exp_f32 v55, v55
v_exp_f32 v103, v103
v_exp_f32 v56, v56
v_exp_f32 v104, v104
v_exp_f32 v57, v57
v_exp_f32 v105, v105
v_exp_f32 v58, v58
v_exp_f32 v106, v106
v_exp_f32 v59, v59
v_exp_f32 v107, v107
v_cvt_pk_bf16_f32 v64, v52, v53
v_cvt_pk_bf16_f32 v112, v100, v101
v_cvt_pk_bf16_f32 v65, v54, v55
v_cvt_pk_bf16_f32 v113, v102, v103
v_cvt_pk_bf16_f32 v66, v56, v57
v_cvt_pk_bf16_f32 v114, v104, v105
v_cvt_pk_bf16_f32 v67, v58, v59
v_cvt_pk_bf16_f32 v115, v106, v107
v_pk_add_f32 v[52:53], v[52:53], v[54:55]
v_pk_add_f32 v[100:101], v[100:101], v[102:103]
v_pk_add_f32 v[56:57], v[56:57], v[58:59]
v_pk_add_f32 v[104:105], v[104:105], v[106:107]
s_waitcnt lgkmcnt(0)
s_waitcnt lgkmcnt(0)
v_mfma_f32_16x16x32_bf16 v[68:71], v[44:47], v[64:67], 0
v_mfma_f32_16x16x32_bf16 v[116:119], v[92:95], v[112:115], 0
v_mfma_f32_16x16x32_bf16 v[72:75], v[48:51], v[64:67], 0
v_mfma_f32_16x16x32_bf16 v[120:123], v[96:99], v[112:115], 0
v_pk_add_f32 v[52:53], v[52:53], v[56:57]
v_pk_add_f32 v[100:101], v[100:101], v[104:105]
v_add_f32 v60, v52, v53
v_add_f32 v108, v100, v101
s_nop 1
v_permlane32_swap_b32 v60, v108
v_add_f32 v60, v60, v108
v_mov_b32 v61, v60
s_nop 1
v_permlane16_swap_b32 v60, v61
v_add_f32 v60, v60, v61
v_rcp_f32 v60, v60
s_nop 0
v_mov_b32 v108, v60
s_nop 1
v_permlane32_swap_b32 v60, v108
v_pk_mul_f32 v[68:69], v[60:61], v[68:69] op_sel_hi:[0,1]
v_pk_mul_f32 v[116:117], v[108:109], v[116:117] op_sel_hi:[0,1]
v_pk_mul_f32 v[70:71], v[60:61], v[70:71] op_sel_hi:[0,1]
v_pk_mul_f32 v[118:119], v[108:109], v[118:119] op_sel_hi:[0,1]
v_pk_mul_f32 v[72:73], v[60:61], v[72:73] op_sel_hi:[0,1]
v_pk_mul_f32 v[120:121], v[108:109], v[120:121] op_sel_hi:[0,1]
v_pk_mul_f32 v[74:75], v[60:61], v[74:75] op_sel_hi:[0,1]
v_pk_mul_f32 v[122:123], v[108:109], v[122:123] op_sel_hi:[0,1]
v_cvt_pk_bf16_f32 v64, v68, v69
v_cvt_pk_bf16_f32 v112, v116, v117
v_cvt_pk_bf16_f32 v65, v70, v71
v_cvt_pk_bf16_f32 v113, v118, v119
v_cvt_pk_bf16_f32 v66, v72, v73
v_cvt_pk_bf16_f32 v114, v120, v121
v_cvt_pk_bf16_f32 v67, v74, v75
v_cvt_pk_bf16_f32 v115, v122, v123
buffer_store_dwordx4 v[64:67], v24, s[16:19], s60 offen offset:0 sc1
buffer_store_dwordx4 v[112:115], v24, s[16:19], s60 offen offset:2048 sc1
s_add_u32 s56, s82, 28311552
s_addc_u32 s57, s83, 0
s_mov_b32 s58, 114688
s_mov_b32 s59, 0x20000
s_lshl_b32 s7, s34, 12
s_add_u32 s7, s7, 49152
v_lshl_add_u32 v26, v1, 8, s7
v_mov_b32 v27, 1
s_cmp_ge_u32 s36, 4
s_cbranch_scc1 Lh_81
s_waitcnt vmcnt(0)
s_branch Lo_80
Lh_81:
s_add_u32 s28, s68, s38
s_addc_u32 s29, s69, 0
s_mov_b32 s30, 2095232
s_mov_b32 s31, 0x20000
s_add_u32 s42, s40, 4
s_and_b32 s42, s42, 15
s_lshl_b32 s42, s42, 17
s_add_u32 m0, s39, 114688
s_add_u32 s43, s42, 0
buffer_load_dwordx4 v7, s[28:31], s43 offen lds
s_add_u32 m0, s39, 115712
s_add_u32 s43, s42, 16384
buffer_load_dwordx4 v7, s[28:31], s43 offen lds
s_add_u32 m0, s39, 116736
s_add_u32 s43, s42, 32768
buffer_load_dwordx4 v7, s[28:31], s43 offen lds
s_add_u32 m0, s39, 117760
s_add_u32 s43, s42, 49152
buffer_load_dwordx4 v7, s[28:31], s43 offen lds
s_add_u32 m0, s39, 118784
s_add_u32 s43, s42, 65536
buffer_load_dwordx4 v7, s[28:31], s43 offen lds
s_add_u32 m0, s39, 119808
s_add_u32 s43, s42, 81920
buffer_load_dwordx4 v7, s[28:31], s43 offen lds
s_add_u32 m0, s39, 120832
s_add_u32 s43, s42, 98304
buffer_load_dwordx4 v7, s[28:31], s43 offen lds
s_add_u32 m0, s39, 121856
s_add_u32 s43, s42, 114688
buffer_load_dwordx4 v7, s[28:31], s43 offen lds
s_waitcnt vmcnt(8)
Lo_80:
s_cmp_lg_u32 s36, 0
s_barrier
s_cbranch_scc1 Lsig_82
s_mov_b64 exec, 0xffff
buffer_atomic_add v27, v26, s[56:59], 0 offen sc1
s_mov_b64 exec, -1
Lsig_82:
s_cmp_ge_u32 s36, 4
s_cbranch_scc1 Lprod_84
v_and_b32 v12, 15, v1
v_lshrrev_b32 v13, 4, v1
v_lshlrev_b32 v10, 12, v12
v_and_b32 v14, 1, v13
v_lshl_add_u32 v10, v14, 5, v10
v_lshrrev_b32 v14, 1, v13
v_lshl_add_u32 v10, v14, 4, v10
s_lshl_b32 s43, s34, 18
s_lshl_b32 s44, s36, 16
s_add_u32 s43, s43, s44
s_lshl_b32 s44, s35, 7
s_add_u32 s43, s43, s44
buffer_load_dwordx4 v[128:131], v10, s[8:11], s43 offen offset:0
buffer_load_dwordx4 v[132:135], v10, s[8:11], s43 offen offset:64
buffer_load_dwordx4 v[136:139], v10, s[8:11], s43 offen offset:2048
buffer_load_dwordx4 v[140:143], v10, s[8:11], s43 offen offset:2112
v_and_b32 v12, 15, v1
v_lshrrev_b32 v13, 4, v1
s_mul_i32 s43, s34, 262144
s_add_u32 s20, s82, s43
s_addc_u32 s21, s83, 0
s_add_u32 s20, s20, 4194304
s_addc_u32 s21, s21, 0
s_mov_b32 s22, 262144
s_mov_b32 s23, 0x20000
s_mul_i32 s43, s34, 16384
s_add_u32 s24, s82, s43
s_addc_u32 s25, s83, 0
s_add_u32 s24, s24, 25165824
s_addc_u32 s25, s25, 0
s_mov_b32 s26, 16384
s_mov_b32 s27, 0x20000
v_lshlrev_b32 v11, 4, v1
s_lshl_b32 s43, s36, 11
v_add_u32 v2, s43, v11
v_add_u32 v3, 98304, v2
v_lshrrev_b32 v14, 2, v1
v_bfe_u32 v15, v14, 1, 2
v_mul_u32_u24 v14, 128, v14
v_lshl_add_u32 v14, v15, 5, v14
v_and_b32 v15, 3, v1
v_lshl_add_u32 v4, v15, 3, v14
v_xor_b32 v5, 32, v4
v_xor_b32 v6, 64, v4
v_xor_b32 v7, 96, v4
v_add_u32 v16, 0x10000, v4
v_add_u32 v20, 0x20000, v4
v_add_u32 v17, 0x10000, v5
v_add_u32 v21, 0x20000, v5
v_add_u32 v18, 0x10000, v6
v_add_u32 v22, 0x20000, v6
v_add_u32 v19, 0x10000, v7
v_add_u32 v23, 0x20000, v7
s_lshl_b32 s44, s35, 14
s_add_u32 s60, s44, s43
v_lshrrev_b32 v14, 1, v13
v_lshlrev_b32 v14, 11, v14
v_lshl_add_u32 v14, v12, 3, v14
v_and_b32 v15, 1, v13
v_lshl_add_u32 v14, v15, 2, v14
s_lshl_b32 s43, s36, 12
s_lshl_b32 s44, s35, 7
s_add_u32 s43, s43, s44
v_add_u32 v9, s43, v14
s_mov_b32 s61, 0x3f803f80
s_waitcnt vmcnt(0)
v_permlane16_swap_b32 v128, v130
v_permlane16_swap_b32 v129, v131
v_permlane16_swap_b32 v132, v134
v_permlane16_swap_b32 v133, v135
v_permlane16_swap_b32 v136, v138
v_permlane16_swap_b32 v137, v139
v_permlane16_swap_b32 v140, v142
v_permlane16_swap_b32 v141, v143
v_lshlrev_b32 v96, 16, v128
v_and_b32 v97, 0xffff0000, v128
v_lshlrev_b32 v98, 16, v129
v_and_b32 v99, 0xffff0000, v129
v_lshlrev_b32 v100, 16, v130
v_and_b32 v101, 0xffff0000, v130
v_lshlrev_b32 v102, 16, v131
v_and_b32 v103, 0xffff0000, v131
v_lshlrev_b32 v104, 16, v132
v_and_b32 v105, 0xffff0000, v132
v_lshlrev_b32 v106, 16, v133
v_and_b32 v107, 0xffff0000, v133
v_lshlrev_b32 v108, 16, v134
v_and_b32 v109, 0xffff0000, v134
v_lshlrev_b32 v110, 16, v135
v_and_b32 v111, 0xffff0000, v135
v_lshlrev_b32 v112, 16, v136
v_and_b32 v113, 0xffff0000, v136
v_lshlrev_b32 v114, 16, v137
v_and_b32 v115, 0xffff0000, v137
v_lshlrev_b32 v116, 16, v138
v_and_b32 v117, 0xffff0000, v138
v_lshlrev_b32 v118, 16, v139
v_and_b32 v119, 0xffff0000, v139
v_lshlrev_b32 v120, 16, v140
v_and_b32 v121, 0xffff0000, v140
v_lshlrev_b32 v122, 16, v141
v_and_b32 v123, 0xffff0000, v141
v_lshlrev_b32 v124, 16, v142
v_and_b32 v125, 0xffff0000, v142
v_lshlrev_b32 v126, 16, v143
v_and_b32 v127, 0xffff0000, v143
s_cmp_lg_u32 s36, 0
s_cbranch_scc1 Lwm_87
s_nop 0
s_branch Lwe_86
Lwm_87:
s_cmp_lg_u32 s36, 1
s_cbranch_scc1 Lwm_88
s_nop 0
s_branch Lwe_86
Lwm_88:
s_cmp_lg_u32 s36, 2
s_cbranch_scc1 Lwm_89
s_nop 0
s_branch Lwe_86
Lwm_89:
s_cmp_lg_u32 s36, 3
s_cbranch_scc1 Lwm_90
s_nop 0
s_branch Lwe_86
Lwm_90:
Lwe_86:
s_barrier
ds_read_b128 v[32:35], v2 offset:0
ds_read_b64_tr_b16 v[40:41], v16 offset:0
ds_read_b64_tr_b16 v[42:43], v16 offset:2048
ds_read_b64_tr_b16 v[44:45], v17 offset:0
ds_read_b64_tr_b16 v[46:47], v17 offset:2048
ds_read_b64_tr_b16 v[48:49], v18 offset:0
ds_read_b64_tr_b16 v[50:51], v18 offset:2048
ds_read_b64_tr_b16 v[52:53], v19 offset:0
ds_read_b64_tr_b16 v[54:55], v19 offset:2048
ds_read_b128 v[36:39], v2 offset:1024
ds_read_b128 v[56:59], v2 offset:8192
ds_read_b64_tr_b16 v[64:65], v16 offset:4096
ds_read_b64_tr_b16 v[66:67], v16 offset:6144
ds_read_b64_tr_b16 v[68:69], v17 offset:4096
ds_read_b64_tr_b16 v[70:71], v17 offset:6144
ds_read_b64_tr_b16 v[72:73], v18 offset:4096
ds_read_b64_tr_b16 v[74:75], v18 offset:6144
ds_read_b64_tr_b16 v[76:77], v19 offset:4096
ds_read_b64_tr_b16 v[78:79], v19 offset:6144
ds_read_b128 v[60:63], v2 offset:9216
s_waitcnt lgkmcnt(0)
s_barrier
v_mfma_f32_16x16x32_bf16 v[96:99], v[40:43], v[32:35], v[96:99]
ds_read_b128 v[144:147], v2 offset:49152
ds_read_b64_tr_b16 v[152:153], v16 offset:8192
v_mfma_f32_16x16x32_bf16 v[100:103], v[44:47], v[32:35], v[100:103]
ds_read_b64_tr_b16 v[154:155], v16 offset:10240
ds_read_b64_tr_b16 v[156:157], v17 offset:8192
v_mfma_f32_16x16x32_bf16 v[104:107], v[48:51], v[32:35], v[104:107]
ds_read_b64_tr_b16 v[158:159], v17 offset:10240
ds_read_b64_tr_b16 v[160:161], v18 offset:8192
v_mfma_f32_16x16x32_bf16 v[108:111], v[52:55], v[32:35], v[108:111]
ds_read_b64_tr_b16 v[162:163], v18 offset:10240
ds_read_b64_tr_b16 v[164:165], v19 offset:8192
v_mfma_f32_16x16x32_bf16 v[124:127], v[52:55], v[36:39], v[124:127]
ds_read_b64_tr_b16 v[166:167], v19 offset:10240
ds_read_b128 v[148:151], v2 offset:50176
v_mfma_f32_16x16x32_bf16 v[120:123], v[48:51], v[36:39], v[120:123]
ds_read_b128 v[168:171], v2 offset:57344
ds_read_b64_tr_b16 v[176:177], v16 offset:12288
v_mfma_f32_16x16x32_bf16 v[116:119], v[44:47], v[36:39], v[116:119]
ds_read_b64_tr_b16 v[178:179], v16 offset:14336
ds_read_b64_tr_b16 v[180:181], v17 offset:12288
v_mfma_f32_16x16x32_bf16 v[112:115], v[40:43], v[36:39], v[112:115]
ds_read_b64_tr_b16 v[182:183], v17 offset:14336
ds_read_b64_tr_b16 v[184:185], v18 offset:12288
v_mfma_f32_16x16x32_bf16 v[96:99], v[64:67], v[56:59], v[96:99]
ds_read_b64_tr_b16 v[186:187], v18 offset:14336
ds_read_b64_tr_b16 v[188:189], v19 offset:12288
v_mfma_f32_16x16x32_bf16 v[100:103], v[68:71], v[56:59], v[100:103]
ds_read_b64_tr_b16 v[190:191], v19 offset:14336
ds_read_b128 v[172:175], v2 offset:58368
v_mfma_f32_16x16x32_bf16 v[104:107], v[72:75], v[56:59], v[104:107]
s_bitcmp0_b32 s36, 1
v_mfma_f32_16x16x32_bf16 v[108:111], v[76:79], v[56:59], v[108:111]
s_cselect_b32 s44, s72, s74
v_mfma_f32_16x16x32_bf16 v[124:127], v[76:79], v[60:63], v[124:127]
s_branch Lov_5
.p2align 12
.fill 32, 4, 0xbf800000
Lst_5_0:
s_branch Lwr_150
s_nop 0
s_nop 0
Lov_5:
s_cselect_b32 s45, s73, s75
v_mfma_f32_16x16x32_bf16 v[120:123], v[72:75], v[60:63], v[120:123]
s_mul_i32 s43, s35, 192
v_mfma_f32_16x16x32_bf16 v[116:119], v[68:71], v[60:63], v[116:119]
s_add_u32 s16, s44, s43
v_mfma_f32_16x16x32_bf16 v[112:115], v[64:67], v[60:63], v[112:115]
s_addc_u32 s17, s45, 0
s_waitcnt lgkmcnt(0)
s_barrier
v_mfma_f32_16x16x32_bf16 v[96:99], v[152:155], v[144:147], v[96:99]
ds_read_b128 v[32:35], v3 offset:0
ds_read_b64_tr_b16 v[40:41], v16 offset:16384
v_mfma_f32_16x16x32_bf16 v[100:103], v[156:159], v[144:147], v[100:103]
ds_read_b64_tr_b16 v[42:43], v16 offset:18432
ds_read_b64_tr_b16 v[44:45], v17 offset:16384
v_mfma_f32_16x16x32_bf16 v[104:107], v[160:163], v[144:147], v[104:107]
ds_read_b64_tr_b16 v[46:47], v17 offset:18432
ds_read_b64_tr_b16 v[48:49], v18 offset:16384
v_mfma_f32_16x16x32_bf16 v[108:111], v[164:167], v[144:147], v[108:111]
ds_read_b64_tr_b16 v[50:51], v18 offset:18432
ds_read_b64_tr_b16 v[52:53], v19 offset:16384
v_mfma_f32_16x16x32_bf16 v[124:127], v[164:167], v[148:151], v[124:127]
ds_read_b64_tr_b16 v[54:55], v19 offset:18432
ds_read_b128 v[36:39], v3 offset:1024
v_mfma_f32_16x16x32_bf16 v[120:123], v[160:163], v[148:151], v[120:123]
ds_read_b128 v[56:59], v3 offset:8192
ds_read_b64_tr_b16 v[64:65], v16 offset:20480
v_mfma_f32_16x16x32_bf16 v[116:119], v[156:159], v[148:151], v[116:119]
ds_read_b64_tr_b16 v[66:67], v16 offset:22528
ds_read_b64_tr_b16 v[68:69], v17 offset:20480
v_mfma_f32_16x16x32_bf16 v[112:115], v[152:155], v[148:151], v[112:115]
ds_read_b64_tr_b16 v[70:71], v17 offset:22528
ds_read_b64_tr_b16 v[72:73], v18 offset:20480
v_mfma_f32_16x16x32_bf16 v[96:99], v[176:179], v[168:171], v[96:99]
ds_read_b64_tr_b16 v[74:75], v18 offset:22528
ds_read_b64_tr_b16 v[76:77], v19 offset:20480
v_mfma_f32_16x16x32_bf16 v[100:103], v[180:183], v[168:171], v[100:103]
ds_read_b64_tr_b16 v[78:79], v19 offset:22528
ds_read_b128 v[60:63], v3 offset:9216
v_mfma_f32_16x16x32_bf16 v[104:107], v[184:187], v[168:171], v[104:107]
s_add_u32 s16, s16, 4096
v_mfma_f32_16x16x32_bf16 v[108:111], v[188:191], v[168:171], v[108:111]
s_addc_u32 s17, s17, 0
v_mfma_f32_16x16x32_bf16 v[124:127], v[188:191], v[172:175], v[124:127]
s_mov_b32 s18, 7333056
v_mfma_f32_16x16x32_bf16 v[120:123], v[184:187], v[172:175], v[120:123]
s_mov_b32 s19, 0x20000
v_mfma_f32_16x16x32_bf16 v[116:119], v[180:183], v[172:175], v[116:119]
s_and_b32 s43, s36, 1
v_mfma_f32_16x16x32_bf16 v[112:115], v[176:179], v[172:175], v[112:115]
s_mul_i32 s43, s43, 229376
s_waitcnt lgkmcnt(0)
s_barrier
v_mfma_f32_16x16x32_bf16 v[96:99], v[40:43], v[32:35], v[96:99]
ds_read_b128 v[144:147], v3 offset:49152
ds_read_b64_tr_b16 v[152:153], v16 offset:24576
v_mfma_f32_16x16x32_bf16 v[100:103], v[44:47], v[32:35], v[100:103]
ds_read_b64_tr_b16 v[154:155], v16 offset:26624
ds_read_b64_tr_b16 v[156:157], v17 offset:24576
v_mfma_f32_16x16x32_bf16 v[104:107], v[48:51], v[32:35], v[104:107]
ds_read_b64_tr_b16 v[158:159], v17 offset:26624
ds_read_b64_tr_b16 v[160:161], v18 offset:24576
v_mfma_f32_16x16x32_bf16 v[108:111], v[52:55], v[32:35], v[108:111]
ds_read_b64_tr_b16 v[162:163], v18 offset:26624
ds_read_b64_tr_b16 v[164:165], v19 offset:24576
v_mfma_f32_16x16x32_bf16 v[124:127], v[52:55], v[36:39], v[124:127]
ds_read_b64_tr_b16 v[166:167], v19 offset:26624
ds_read_b128 v[148:151], v3 offset:50176
v_mfma_f32_16x16x32_bf16 v[120:123], v[48:51], v[36:39], v[120:123]
ds_read_b128 v[168:171], v3 offset:57344
ds_read_b64_tr_b16 v[176:177], v16 offset:28672
v_mfma_f32_16x16x32_bf16 v[116:119], v[44:47], v[36:39], v[116:119]
ds_read_b64_tr_b16 v[178:179], v16 offset:30720
ds_read_b64_tr_b16 v[180:181], v17 offset:28672
v_mfma_f32_16x16x32_bf16 v[112:115], v[40:43], v[36:39], v[112:115]
ds_read_b64_tr_b16 v[182:183], v17 offset:30720
ds_read_b64_tr_b16 v[184:185], v18 offset:28672
v_mfma_f32_16x16x32_bf16 v[96:99], v[64:67], v[56:59], v[96:99]
ds_read_b64_tr_b16 v[186:187], v18 offset:30720
ds_read_b64_tr_b16 v[188:189], v19 offset:28672
v_mfma_f32_16x16x32_bf16 v[100:103], v[68:71], v[56:59], v[100:103]
ds_read_b64_tr_b16 v[190:191], v19 offset:30720
ds_read_b128 v[172:175], v3 offset:58368
v_mfma_f32_16x16x32_bf16 v[104:107], v[72:75], v[56:59], v[104:107]
v_add_u32 v196, 0, v1
v_mfma_f32_16x16x32_bf16 v[108:111], v[76:79], v[56:59], v[108:111]
v_mul_u32_u24 v197, 5462, v196
v_mfma_f32_16x16x32_bf16 v[124:127], v[76:79], v[60:63], v[124:127]
v_lshrrev_b32 v197, 16, v197
v_mfma_f32_16x16x32_bf16 v[120:123], v[72:75], v[60:63], v[120:123]
v_mul_u32_u24 v198, 12, v197
v_mfma_f32_16x16x32_bf16 v[116:119], v[68:71], v[60:63], v[116:119]
v_sub_u32 v198, v196, v198
v_mfma_f32_16x16x32_bf16 v[112:115], v[64:67], v[60:63], v[112:115]
v_bfe_u32 v199, v197, 2, 1
s_waitcnt lgkmcnt(0)
s_barrier
v_mfma_f32_16x16x32_bf16 v[96:99], v[152:155], v[144:147], v[96:99]
ds_read_b128 v[32:35], v2 offset:0
ds_read_b64_tr_b16 v[40:41], v16 offset:49152
v_mfma_f32_16x16x32_bf16 v[100:103], v[156:159], v[144:147], v[100:103]
ds_read_b64_tr_b16 v[42:43], v16 offset:51200
ds_read_b64_tr_b16 v[44:45], v17 offset:49152
v_mfma_f32_16x16x32_bf16 v[104:107], v[160:163], v[144:147], v[104:107]
ds_read_b64_tr_b16 v[46:47], v17 offset:51200
ds_read_b64_tr_b16 v[48:49], v18 offset:49152
v_mfma_f32_16x16x32_bf16 v[108:111], v[164:167], v[144:147], v[108:111]
ds_read_b64_tr_b16 v[50:51], v18 offset:51200
ds_read_b64_tr_b16 v[52:53], v19 offset:49152
v_mfma_f32_16x16x32_bf16 v[124:127], v[164:167], v[148:151], v[124:127]
ds_read_b64_tr_b16 v[54:55], v19 offset:51200
ds_read_b128 v[36:39], v2 offset:1024
v_mfma_f32_16x16x32_bf16 v[120:123], v[160:163], v[148:151], v[120:123]
ds_read_b128 v[56:59], v2 offset:8192
ds_read_b64_tr_b16 v[64:65], v16 offset:53248
v_mfma_f32_16x16x32_bf16 v[116:119], v[156:159], v[148:151], v[116:119]
ds_read_b64_tr_b16 v[66:67], v16 offset:55296
ds_read_b64_tr_b16 v[68:69], v17 offset:53248
v_mfma_f32_16x16x32_bf16 v[112:115], v[152:155], v[148:151], v[112:115]
ds_read_b64_tr_b16 v[70:71], v17 offset:55296
ds_read_b64_tr_b16 v[72:73], v18 offset:53248
v_mfma_f32_16x16x32_bf16 v[96:99], v[176:179], v[168:171], v[96:99]
ds_read_b64_tr_b16 v[74:75], v18 offset:55296
ds_read_b64_tr_b16 v[76:77], v19 offset:53248
v_mfma_f32_16x16x32_bf16 v[100:103], v[180:183], v[168:171], v[100:103]
ds_read_b64_tr_b16 v[78:79], v19 offset:55296
ds_read_b128 v[60:63], v2 offset:9216
v_mfma_f32_16x16x32_bf16 v[104:107], v[184:187], v[168:171], v[104:107]
v_cmp_gt_u32 vcc, 8, v198
v_mfma_f32_16x16x32_bf16 v[108:111], v[188:191], v[168:171], v[108:111]
v_lshlrev_b32 v200, 1, v199
v_mfma_f32_16x16x32_bf16 v[124:127], v[188:191], v[172:175], v[124:127]
v_mul_u32_u24 v197, 7168, v197
v_mfma_f32_16x16x32_bf16 v[120:123], v[184:187], v[172:175], v[120:123]
v_cndmask_b32 v199, v199, v200, vcc
v_mfma_f32_16x16x32_bf16 v[116:119], v[180:183], v[172:175], v[116:119]
v_xor_b32 v198, v198, v199
v_mfma_f32_16x16x32_bf16 v[112:115], v[176:179], v[172:175], v[112:115]
v_lshl_add_u32 v192, v198, 4, v197
s_waitcnt lgkmcnt(0)
s_barrier
v_mfma_f32_16x16x32_bf16 v[96:99], v[40:43], v[32:35], v[96:99]
ds_read_b128 v[144:147], v2 offset:49152
ds_read_b64_tr_b16 v[152:153], v16 offset:57344
v_mfma_f32_16x16x32_bf16 v[100:103], v[44:47], v[32:35], v[100:103]
ds_read_b64_tr_b16 v[154:155], v16 offset:59392
ds_read_b64_tr_b16 v[156:157], v17 offset:57344
v_mfma_f32_16x16x32_bf16 v[104:107], v[48:51], v[32:35], v[104:107]
ds_read_b64_tr_b16 v[158:159], v17 offset:59392
ds_read_b64_tr_b16 v[160:161], v18 offset:57344
v_mfma_f32_16x16x32_bf16 v[108:111], v[52:55], v[32:35], v[108:111]
ds_read_b64_tr_b16 v[162:163], v18 offset:59392
ds_read_b64_tr_b16 v[164:165], v19 offset:57344
v_mfma_f32_16x16x32_bf16 v[124:127], v[52:55], v[36:39], v[124:127]
ds_read_b64_tr_b16 v[166:167], v19 offset:59392
ds_read_b128 v[148:151], v2 offset:50176
v_mfma_f32_16x16x32_bf16 v[120:123], v[48:51], v[36:39], v[120:123]
ds_read_b128 v[168:171], v2 offset:57344
ds_read_b64_tr_b16 v[176:177], v16 offset:61440
v_mfma_f32_16x16x32_bf16 v[116:119], v[44:47], v[36:39], v[116:119]
ds_read_b64_tr_b16 v[178:179], v16 offset:63488
ds_read_b64_tr_b16 v[180:181], v17 offset:61440
v_mfma_f32_16x16x32_bf16 v[112:115], v[40:43], v[36:39], v[112:115]
ds_read_b64_tr_b16 v[182:183], v17 offset:63488
ds_read_b64_tr_b16 v[184:185], v18 offset:61440
v_mfma_f32_16x16x32_bf16 v[96:99], v[64:67], v[56:59], v[96:99]
ds_read_b64_tr_b16 v[186:187], v18 offset:63488
ds_read_b64_tr_b16 v[188:189], v19 offset:61440
v_mfma_f32_16x16x32_bf16 v[100:103], v[68:71], v[56:59], v[100:103]
ds_read_b64_tr_b16 v[190:191], v19 offset:63488
ds_read_b128 v[172:175], v2 offset:58368
v_mfma_f32_16x16x32_bf16 v[104:107], v[72:75], v[56:59], v[104:107]
v_add_u32 v196, 64, v1
v_mfma_f32_16x16x32_bf16 v[108:111], v[76:79], v[56:59], v[108:111]
v_mul_u32_u24 v197, 5462, v196
v_mfma_f32_16x16x32_bf16 v[124:127], v[76:79], v[60:63], v[124:127]
v_lshrrev_b32 v197, 16, v197
v_mfma_f32_16x16x32_bf16 v[120:123], v[72:75], v[60:63], v[120:123]
v_mul_u32_u24 v198, 12, v197
v_mfma_f32_16x16x32_bf16 v[116:119], v[68:71], v[60:63], v[116:119]
v_sub_u32 v198, v196, v198
v_mfma_f32_16x16x32_bf16 v[112:115], v[64:67], v[60:63], v[112:115]
v_bfe_u32 v199, v197, 2, 1
s_waitcnt lgkmcnt(0)
s_barrier
v_mfma_f32_16x16x32_bf16 v[96:99], v[152:155], v[144:147], v[96:99]
ds_read_b128 v[32:35], v3 offset:0
ds_read_b64_tr_b16 v[40:41], v20 offset:0
v_mfma_f32_16x16x32_bf16 v[100:103], v[156:159], v[144:147], v[100:103]
ds_read_b64_tr_b16 v[42:43], v20 offset:2048
ds_read_b64_tr_b16 v[44:45], v21 offset:0
v_mfma_f32_16x16x32_bf16 v[104:107], v[160:163], v[144:147], v[104:107]
ds_read_b64_tr_b16 v[46:47], v21 offset:2048
ds_read_b64_tr_b16 v[48:49], v22 offset:0
v_mfma_f32_16x16x32_bf16 v[108:111], v[164:167], v[144:147], v[108:111]
ds_read_b64_tr_b16 v[50:51], v22 offset:2048
ds_read_b64_tr_b16 v[52:53], v23 offset:0
v_mfma_f32_16x16x32_bf16 v[124:127], v[164:167], v[148:151], v[124:127]
ds_read_b64_tr_b16 v[54:55], v23 offset:2048
ds_read_b128 v[36:39], v3 offset:1024
v_mfma_f32_16x16x32_bf16 v[120:123], v[160:163], v[148:151], v[120:123]
ds_read_b128 v[56:59], v3 offset:8192
ds_read_b64_tr_b16 v[64:65], v20 offset:4096
v_mfma_f32_16x16x32_bf16 v[116:119], v[156:159], v[148:151], v[116:119]
ds_read_b64_tr_b16 v[66:67], v20 offset:6144
ds_read_b64_tr_b16 v[68:69], v21 offset:4096
v_mfma_f32_16x16x32_bf16 v[112:115], v[152:155], v[148:151], v[112:115]
ds_read_b64_tr_b16 v[70:71], v21 offset:6144
ds_read_b64_tr_b16 v[72:73], v22 offset:4096
v_mfma_f32_16x16x32_bf16 v[96:99], v[176:179], v[168:171], v[96:99]
ds_read_b64_tr_b16 v[74:75], v22 offset:6144
ds_read_b64_tr_b16 v[76:77], v23 offset:4096
v_mfma_f32_16x16x32_bf16 v[100:103], v[180:183], v[168:171], v[100:103]
ds_read_b64_tr_b16 v[78:79], v23 offset:6144
ds_read_b128 v[60:63], v3 offset:9216
v_mfma_f32_16x16x32_bf16 v[104:107], v[184:187], v[168:171], v[104:107]
v_cmp_gt_u32 vcc, 8, v198
v_mfma_f32_16x16x32_bf16 v[108:111], v[188:191], v[168:171], v[108:111]
v_lshlrev_b32 v200, 1, v199
v_mfma_f32_16x16x32_bf16 v[124:127], v[188:191], v[172:175], v[124:127]
v_mul_u32_u24 v197, 7168, v197
v_mfma_f32_16x16x32_bf16 v[120:123], v[184:187], v[172:175], v[120:123]
v_cndmask_b32 v199, v199, v200, vcc
v_mfma_f32_16x16x32_bf16 v[116:119], v[180:183], v[172:175], v[116:119]
v_xor_b32 v198, v198, v199
v_mfma_f32_16x16x32_bf16 v[112:115], v[176:179], v[172:175], v[112:115]
v_lshl_add_u32 v193, v198, 4, v197
s_waitcnt lgkmcnt(0)
s_barrier
v_mfma_f32_16x16x32_bf16 v[96:99], v[40:43], v[32:35], v[96:99]
ds_read_b128 v[144:147], v3 offset:49152
ds_read_b64_tr_b16 v[152:153], v20 offset:8192
v_mfma_f32_16x16x32_bf16 v[100:103], v[44:47], v[32:35], v[100:103]
ds_read_b64_tr_b16 v[154:155], v20 offset:10240
ds_read_b64_tr_b16 v[156:157], v21 offset:8192
v_mfma_f32_16x16x32_bf16 v[104:107], v[48:51], v[32:35], v[104:107]
ds_read_b64_tr_b16 v[158:159], v21 offset:10240
ds_read_b64_tr_b16 v[160:161], v22 offset:8192
v_mfma_f32_16x16x32_bf16 v[108:111], v[52:55], v[32:35], v[108:111]
ds_read_b64_tr_b16 v[162:163], v22 offset:10240
ds_read_b64_tr_b16 v[164:165], v23 offset:8192
v_mfma_f32_16x16x32_bf16 v[124:127], v[52:55], v[36:39], v[124:127]
ds_read_b64_tr_b16 v[166:167], v23 offset:10240
ds_read_b128 v[148:151], v3 offset:50176
v_mfma_f32_16x16x32_bf16 v[120:123], v[48:51], v[36:39], v[120:123]
ds_read_b128 v[168:171], v3 offset:57344
ds_read_b64_tr_b16 v[176:177], v20 offset:12288
v_mfma_f32_16x16x32_bf16 v[116:119], v[44:47], v[36:39], v[116:119]
ds_read_b64_tr_b16 v[178:179], v20 offset:14336
ds_read_b64_tr_b16 v[180:181], v21 offset:12288
v_mfma_f32_16x16x32_bf16 v[112:115], v[40:43], v[36:39], v[112:115]
ds_read_b64_tr_b16 v[182:183], v21 offset:14336
ds_read_b64_tr_b16 v[184:185], v22 offset:12288
v_mfma_f32_16x16x32_bf16 v[96:99], v[64:67], v[56:59], v[96:99]
ds_read_b64_tr_b16 v[186:187], v22 offset:14336
ds_read_b64_tr_b16 v[188:189], v23 offset:12288
v_mfma_f32_16x16x32_bf16 v[100:103], v[68:71], v[56:59], v[100:103]
ds_read_b64_tr_b16 v[190:191], v23 offset:14336
ds_read_b128 v[172:175], v3 offset:58368
v_mfma_f32_16x16x32_bf16 v[104:107], v[72:75], v[56:59], v[104:107]
v_add_u32 v196, 128, v1
v_mfma_f32_16x16x32_bf16 v[108:111], v[76:79], v[56:59], v[108:111]
v_mul_u32_u24 v197, 5462, v196
v_mfma_f32_16x16x32_bf16 v[124:127], v[76:79], v[60:63], v[124:127]
v_lshrrev_b32 v197, 16, v197
v_mfma_f32_16x16x32_bf16 v[120:123], v[72:75], v[60:63], v[120:123]
v_mul_u32_u24 v198, 12, v197
v_mfma_f32_16x16x32_bf16 v[116:119], v[68:71], v[60:63], v[116:119]
v_sub_u32 v198, v196, v198
v_mfma_f32_16x16x32_bf16 v[112:115], v[64:67], v[60:63], v[112:115]
v_bfe_u32 v199, v197, 2, 1
s_waitcnt lgkmcnt(0)
s_barrier
v_mfma_f32_16x16x32_bf16 v[96:99], v[152:155], v[144:147], v[96:99]
ds_read_b128 v[32:35], v2 offset:0
ds_read_b64_tr_b16 v[40:41], v4 offset:16384
v_mfma_f32_16x16x32_bf16 v[100:103], v[156:159], v[144:147], v[100:103]
ds_read_b64_tr_b16 v[42:43], v4 offset:18432
ds_read_b64_tr_b16 v[44:45], v5 offset:16384
v_mfma_f32_16x16x32_bf16 v[104:107], v[160:163], v[144:147], v[104:107]
ds_read_b64_tr_b16 v[46:47], v5 offset:18432
ds_read_b64_tr_b16 v[48:49], v6 offset:16384
v_mfma_f32_16x16x32_bf16 v[108:111], v[164:167], v[144:147], v[108:111]
ds_read_b64_tr_b16 v[50:51], v6 offset:18432
ds_read_b64_tr_b16 v[52:53], v7 offset:16384
v_mfma_f32_16x16x32_bf16 v[124:127], v[164:167], v[148:151], v[124:127]
ds_read_b64_tr_b16 v[54:55], v7 offset:18432
ds_read_b128 v[36:39], v2 offset:1024
v_mfma_f32_16x16x32_bf16 v[120:123], v[160:163], v[148:151], v[120:123]
ds_read_b128 v[56:59], v2 offset:8192
ds_read_b64_tr_b16 v[64:65], v4 offset:20480
v_mfma_f32_16x16x32_bf16 v[116:119], v[156:159], v[148:151], v[116:119]
ds_read_b64_tr_b16 v[66:67], v4 offset:22528
ds_read_b64_tr_b16 v[68:69], v5 offset:20480
v_mfma_f32_16x16x32_bf16 v[112:115], v[152:155], v[148:151], v[112:115]
ds_read_b64_tr_b16 v[70:71], v5 offset:22528
ds_read_b64_tr_b16 v[72:73], v6 offset:20480
v_mfma_f32_16x16x32_bf16 v[96:99], v[176:179], v[168:171], v[96:99]
ds_read_b64_tr_b16 v[74:75], v6 offset:22528
ds_read_b64_tr_b16 v[76:77], v7 offset:20480
v_mfma_f32_16x16x32_bf16 v[100:103], v[180:183], v[168:171], v[100:103]
ds_read_b64_tr_b16 v[78:79], v7 offset:22528
ds_read_b128 v[60:63], v2 offset:9216
v_mfma_f32_16x16x32_bf16 v[104:107], v[184:187], v[168:171], v[104:107]
v_cmp_gt_u32 vcc, 8, v198
v_mfma_f32_16x16x32_bf16 v[108:111], v[188:191], v[168:171], v[108:111]
v_lshlrev_b32 v200, 1, v199
v_mfma_f32_16x16x32_bf16 v[124:127], v[188:191], v[172:175], v[124:127]
v_mul_u32_u24 v197, 7168, v197
v_mfma_f32_16x16x32_bf16 v[120:123], v[184:187], v[172:175], v[120:123]
v_cndmask_b32 v199, v199, v200, vcc
v_mfma_f32_16x16x32_bf16 v[116:119], v[180:183], v[172:175], v[116:119]
v_xor_b32 v198, v198, v199
v_mfma_f32_16x16x32_bf16 v[112:115], v[176:179], v[172:175], v[112:115]
v_lshl_add_u32 v194, v198, 4, v197
s_waitcnt lgkmcnt(0)
s_barrier
v_mfma_f32_16x16x32_bf16 v[96:99], v[40:43], v[32:35], v[96:99]
ds_read_b128 v[144:147], v2 offset:49152
ds_read_b64_tr_b16 v[152:153], v4 offset:24576
v_mfma_f32_16x16x32_bf16 v[100:103], v[44:47], v[32:35], v[100:103]
ds_read_b64_tr_b16 v[154:155], v4 offset:26624
ds_read_b64_tr_b16 v[156:157], v5 offset:24576
v_mfma_f32_16x16x32_bf16 v[104:107], v[48:51], v[32:35], v[104:107]
ds_read_b64_tr_b16 v[158:159], v5 offset:26624
ds_read_b64_tr_b16 v[160:161], v6 offset:24576
v_mfma_f32_16x16x32_bf16 v[108:111], v[52:55], v[32:35], v[108:111]
ds_read_b64_tr_b16 v[162:163], v6 offset:26624
ds_read_b64_tr_b16 v[164:165], v7 offset:24576
v_mfma_f32_16x16x32_bf16 v[124:127], v[52:55], v[36:39], v[124:127]
ds_read_b64_tr_b16 v[166:167], v7 offset:26624
ds_read_b128 v[148:151], v2 offset:50176
v_mfma_f32_16x16x32_bf16 v[120:123], v[48:51], v[36:39], v[120:123]
ds_read_b128 v[168:171], v2 offset:57344
ds_read_b64_tr_b16 v[176:177], v4 offset:28672
v_mfma_f32_16x16x32_bf16 v[116:119], v[44:47], v[36:39], v[116:119]
ds_read_b64_tr_b16 v[178:179], v4 offset:30720
ds_read_b64_tr_b16 v[180:181], v5 offset:28672
v_mfma_f32_16x16x32_bf16 v[112:115], v[40:43], v[36:39], v[112:115]
ds_read_b64_tr_b16 v[182:183], v5 offset:30720
ds_read_b64_tr_b16 v[184:185], v6 offset:28672
v_mfma_f32_16x16x32_bf16 v[96:99], v[64:67], v[56:59], v[96:99]
ds_read_b64_tr_b16 v[186:187], v6 offset:30720
ds_read_b64_tr_b16 v[188:189], v7 offset:28672
v_mfma_f32_16x16x32_bf16 v[100:103], v[68:71], v[56:59], v[100:103]
ds_read_b64_tr_b16 v[190:191], v7 offset:30720
ds_read_b128 v[172:175], v2 offset:58368
v_mfma_f32_16x16x32_bf16 v[104:107], v[72:75], v[56:59], v[104:107]
v_add_u32 v192, s43, v192
v_mfma_f32_16x16x32_bf16 v[108:111], v[76:79], v[56:59], v[108:111]
v_add_u32 v193, s43, v193
v_mfma_f32_16x16x32_bf16 v[124:127], v[76:79], v[60:63], v[124:127]
v_add_u32 v194, s43, v194
v_mfma_f32_16x16x32_bf16 v[120:123], v[72:75], v[60:63], v[120:123]
s_and_b32 s43, s36, 3
v_mfma_f32_16x16x32_bf16 v[116:119], v[68:71], v[60:63], v[116:119]
s_mul_i32 s50, s43, 6144
v_mfma_f32_16x16x32_bf16 v[112:115], v[64:67], v[60:63], v[112:115]
s_add_u32 s50, s50, 16384
s_waitcnt lgkmcnt(0)
s_barrier
v_mfma_f32_16x16x32_bf16 v[96:99], v[152:155], v[144:147], v[96:99]
ds_read_b128 v[32:35], v3 offset:0
ds_read_b64_tr_b16 v[40:41], v4 offset:32768
v_mfma_f32_16x16x32_bf16 v[100:103], v[156:159], v[144:147], v[100:103]
ds_read_b64_tr_b16 v[42:43], v4 offset:34816
ds_read_b64_tr_b16 v[44:45], v5 offset:32768
v_mfma_f32_16x16x32_bf16 v[104:107], v[160:163], v[144:147], v[104:107]
ds_read_b64_tr_b16 v[46:47], v5 offset:34816
ds_read_b64_tr_b16 v[48:49], v6 offset:32768
v_mfma_f32_16x16x32_bf16 v[108:111], v[164:167], v[144:147], v[108:111]
ds_read_b64_tr_b16 v[50:51], v6 offset:34816
ds_read_b64_tr_b16 v[52:53], v7 offset:32768
v_mfma_f32_16x16x32_bf16 v[124:127], v[164:167], v[148:151], v[124:127]
ds_read_b64_tr_b16 v[54:55], v7 offset:34816
ds_read_b128 v[36:39], v3 offset:1024
v_mfma_f32_16x16x32_bf16 v[120:123], v[160:163], v[148:151], v[120:123]
ds_read_b128 v[56:59], v3 offset:8192
ds_read_b64_tr_b16 v[64:65], v4 offset:36864
v_mfma_f32_16x16x32_bf16 v[116:119], v[156:159], v[148:151], v[116:119]
ds_read_b64_tr_b16 v[66:67], v4 offset:38912
ds_read_b64_tr_b16 v[68:69], v5 offset:36864
v_mfma_f32_16x16x32_bf16 v[112:115], v[152:155], v[148:151], v[112:115]
ds_read_b64_tr_b16 v[70:71], v5 offset:38912
ds_read_b64_tr_b16 v[72:73], v6 offset:36864
v_mfma_f32_16x16x32_bf16 v[96:99], v[176:179], v[168:171], v[96:99]
ds_read_b64_tr_b16 v[74:75], v6 offset:38912
ds_read_b64_tr_b16 v[76:77], v7 offset:36864
v_mfma_f32_16x16x32_bf16 v[100:103], v[180:183], v[168:171], v[100:103]
ds_read_b64_tr_b16 v[78:79], v7 offset:38912
ds_read_b128 v[60:63], v3 offset:9216
v_mfma_f32_16x16x32_bf16 v[104:107], v[184:187], v[168:171], v[104:107]
s_bitcmp0_b32 s2, 0
v_mfma_f32_16x16x32_bf16 v[108:111], v[188:191], v[168:171], v[108:111]
s_cselect_b32 s88, s72, s74
v_mfma_f32_16x16x32_bf16 v[124:127], v[188:191], v[172:175], v[124:127]
s_cselect_b32 s89, s73, s75
v_mfma_f32_16x16x32_bf16 v[120:123], v[184:187], v[172:175], v[120:123]
s_mov_b32 s90, 7340032
v_mfma_f32_16x16x32_bf16 v[116:119], v[180:183], v[172:175], v[116:119]
s_mov_b32 s91, 0x20000
v_mfma_f32_16x16x32_bf16 v[112:115], v[176:179], v[172:175], v[112:115]
s_bfe_u32 s44, s2, 0x30001
s_waitcnt lgkmcnt(0)
s_barrier
v_mfma_f32_16x16x32_bf16 v[96:99], v[40:43], v[32:35], v[96:99]
ds_read_b128 v[144:147], v3 offset:49152
ds_read_b64_tr_b16 v[152:153], v4 offset:40960
v_mfma_f32_16x16x32_bf16 v[100:103], v[44:47], v[32:35], v[100:103]
ds_read_b64_tr_b16 v[154:155], v4 offset:43008
ds_read_b64_tr_b16 v[156:157], v5 offset:40960
v_mfma_f32_16x16x32_bf16 v[104:107], v[48:51], v[32:35], v[104:107]
ds_read_b64_tr_b16 v[158:159], v5 offset:43008
ds_read_b64_tr_b16 v[160:161], v6 offset:40960
v_mfma_f32_16x16x32_bf16 v[108:111], v[52:55], v[32:35], v[108:111]
ds_read_b64_tr_b16 v[162:163], v6 offset:43008
ds_read_b64_tr_b16 v[164:165], v7 offset:40960
v_mfma_f32_16x16x32_bf16 v[124:127], v[52:55], v[36:39], v[124:127]
ds_read_b64_tr_b16 v[166:167], v7 offset:43008
ds_read_b128 v[148:151], v3 offset:50176
v_mfma_f32_16x16x32_bf16 v[120:123], v[48:51], v[36:39], v[120:123]
ds_read_b128 v[168:171], v3 offset:57344
ds_read_b64_tr_b16 v[176:177], v4 offset:45056
v_mfma_f32_16x16x32_bf16 v[116:119], v[44:47], v[36:39], v[116:119]
ds_read_b64_tr_b16 v[178:179], v4 offset:47104
ds_read_b64_tr_b16 v[180:181], v5 offset:45056
v_mfma_f32_16x16x32_bf16 v[112:115], v[40:43], v[36:39], v[112:115]
ds_read_b64_tr_b16 v[182:183], v5 offset:47104
ds_read_b64_tr_b16 v[184:185], v6 offset:45056
v_mfma_f32_16x16x32_bf16 v[96:99], v[64:67], v[56:59], v[96:99]
ds_read_b64_tr_b16 v[186:187], v6 offset:47104
ds_read_b64_tr_b16 v[188:189], v7 offset:45056
v_mfma_f32_16x16x32_bf16 v[100:103], v[68:71], v[56:59], v[100:103]
ds_read_b64_tr_b16 v[190:191], v7 offset:47104
ds_read_b128 v[172:175], v3 offset:58368
v_mfma_f32_16x16x32_bf16 v[104:107], v[72:75], v[56:59], v[104:107]
s_lshl_b32 s44, s44, 2
v_mfma_f32_16x16x32_bf16 v[108:111], v[76:79], v[56:59], v[108:111]
s_and_b32 s43, s36, 3
v_mfma_f32_16x16x32_bf16 v[124:127], v[76:79], v[60:63], v[124:127]
s_add_u32 s44, s44, s43
v_mfma_f32_16x16x32_bf16 v[120:123], v[72:75], v[60:63], v[120:123]
s_lshl_b32 s44, s44, 5
v_mfma_f32_16x16x32_bf16 v[116:119], v[68:71], v[60:63], v[116:119]
v_lshrrev_b32 v195, 4, v1
v_mfma_f32_16x16x32_bf16 v[112:115], v[64:67], v[60:63], v[112:115]
v_add_u32 v195, s44, v195
s_waitcnt lgkmcnt(0)
s_barrier
v_mfma_f32_16x16x32_bf16 v[96:99], v[152:155], v[144:147], v[96:99]
ds_read_b128 v[32:35], v2 offset:0
ds_read_b64_tr_b16 v[40:41], v16 offset:49152
v_mfma_f32_16x16x32_bf16 v[100:103], v[156:159], v[144:147], v[100:103]
ds_read_b64_tr_b16 v[42:43], v16 offset:51200
ds_read_b64_tr_b16 v[44:45], v17 offset:49152
v_mfma_f32_16x16x32_bf16 v[104:107], v[160:163], v[144:147], v[104:107]
ds_read_b64_tr_b16 v[46:47], v17 offset:51200
ds_read_b64_tr_b16 v[48:49], v18 offset:49152
v_mfma_f32_16x16x32_bf16 v[108:111], v[164:167], v[144:147], v[108:111]
ds_read_b64_tr_b16 v[50:51], v18 offset:51200
ds_read_b64_tr_b16 v[52:53], v19 offset:49152
v_mfma_f32_16x16x32_bf16 v[124:127], v[164:167], v[148:151], v[124:127]
ds_read_b64_tr_b16 v[54:55], v19 offset:51200
ds_read_b128 v[36:39], v2 offset:1024
v_mfma_f32_16x16x32_bf16 v[120:123], v[160:163], v[148:151], v[120:123]
ds_read_b128 v[56:59], v2 offset:8192
ds_read_b64_tr_b16 v[64:65], v16 offset:53248
v_mfma_f32_16x16x32_bf16 v[116:119], v[156:159], v[148:151], v[116:119]
ds_read_b64_tr_b16 v[66:67], v16 offset:55296
ds_read_b64_tr_b16 v[68:69], v17 offset:53248
v_mfma_f32_16x16x32_bf16 v[112:115], v[152:155], v[148:151], v[112:115]
ds_read_b64_tr_b16 v[70:71], v17 offset:55296
ds_read_b64_tr_b16 v[72:73], v18 offset:53248
v_mfma_f32_16x16x32_bf16 v[96:99], v[176:179], v[168:171], v[96:99]
ds_read_b64_tr_b16 v[74:75], v18 offset:55296
ds_read_b64_tr_b16 v[76:77], v19 offset:53248
v_mfma_f32_16x16x32_bf16 v[100:103], v[180:183], v[168:171], v[100:103]
ds_read_b64_tr_b16 v[78:79], v19 offset:55296
ds_read_b128 v[60:63], v2 offset:9216
v_mfma_f32_16x16x32_bf16 v[104:107], v[184:187], v[168:171], v[104:107]
v_mul_u32_u24 v195, 7168, v195
v_mfma_f32_16x16x32_bf16 v[108:111], v[188:191], v[168:171], v[108:111]
v_and_b32 v196, 15, v1
v_mfma_f32_16x16x32_bf16 v[124:127], v[188:191], v[172:175], v[124:127]
v_lshl_add_u32 v195, v196, 4, v195
v_mfma_f32_16x16x32_bf16 v[120:123], v[184:187], v[172:175], v[120:123]
s_lshr_b32 s43, s2, 4
v_mfma_f32_16x16x32_bf16 v[116:119], v[180:183], v[172:175], v[116:119]
s_lshl_b32 s43, s43, 8
v_mfma_f32_16x16x32_bf16 v[112:115], v[176:179], v[172:175], v[112:115]
v_add_u32 v195, s43, v195
s_waitcnt lgkmcnt(0)
s_barrier
v_mfma_f32_16x16x32_bf16 v[96:99], v[40:43], v[32:35], v[96:99]
ds_read_b128 v[144:147], v2 offset:49152
ds_read_b64_tr_b16 v[152:153], v16 offset:57344
v_mfma_f32_16x16x32_bf16 v[100:103], v[44:47], v[32:35], v[100:103]
ds_read_b64_tr_b16 v[154:155], v16 offset:59392
ds_read_b64_tr_b16 v[156:157], v17 offset:57344
v_mfma_f32_16x16x32_bf16 v[104:107], v[48:51], v[32:35], v[104:107]
ds_read_b64_tr_b16 v[158:159], v17 offset:59392
ds_read_b64_tr_b16 v[160:161], v18 offset:57344
v_mfma_f32_16x16x32_bf16 v[108:111], v[52:55], v[32:35], v[108:111]
ds_read_b64_tr_b16 v[162:163], v18 offset:59392
ds_read_b64_tr_b16 v[164:165], v19 offset:57344
v_mfma_f32_16x16x32_bf16 v[124:127], v[52:55], v[36:39], v[124:127]
ds_read_b64_tr_b16 v[166:167], v19 offset:59392
ds_read_b128 v[148:151], v2 offset:50176
v_mfma_f32_16x16x32_bf16 v[120:123], v[48:51], v[36:39], v[120:123]
ds_read_b128 v[168:171], v2 offset:57344
ds_read_b64_tr_b16 v[176:177], v16 offset:61440
v_mfma_f32_16x16x32_bf16 v[116:119], v[44:47], v[36:39], v[116:119]
ds_read_b64_tr_b16 v[178:179], v16 offset:63488
ds_read_b64_tr_b16 v[180:181], v17 offset:61440
v_mfma_f32_16x16x32_bf16 v[112:115], v[40:43], v[36:39], v[112:115]
ds_read_b64_tr_b16 v[182:183], v17 offset:63488
ds_read_b64_tr_b16 v[184:185], v18 offset:61440
v_mfma_f32_16x16x32_bf16 v[96:99], v[64:67], v[56:59], v[96:99]
ds_read_b64_tr_b16 v[186:187], v18 offset:63488
ds_read_b64_tr_b16 v[188:189], v19 offset:61440
v_mfma_f32_16x16x32_bf16 v[100:103], v[68:71], v[56:59], v[100:103]
ds_read_b64_tr_b16 v[190:191], v19 offset:63488
ds_read_b128 v[172:175], v2 offset:58368
v_mfma_f32_16x16x32_bf16 v[104:107], v[72:75], v[56:59], v[104:107]
v_mfma_f32_16x16x32_bf16 v[108:111], v[76:79], v[56:59], v[108:111]
v_mfma_f32_16x16x32_bf16 v[124:127], v[76:79], v[60:63], v[124:127]
v_mfma_f32_16x16x32_bf16 v[120:123], v[72:75], v[60:63], v[120:123]
v_mfma_f32_16x16x32_bf16 v[116:119], v[68:71], v[60:63], v[116:119]
s_branch Lov_6
.p2align 12
.fill 48, 4, 0xbf800000
Lst_6_0:
s_branch Lwr_151
s_nop 0
s_nop 0
Lov_6:
v_mfma_f32_16x16x32_bf16 v[112:115], v[64:67], v[60:63], v[112:115]
s_waitcnt lgkmcnt(0)
s_barrier
v_mfma_f32_16x16x32_bf16 v[96:99], v[152:155], v[144:147], v[96:99]
ds_read_b128 v[32:35], v3 offset:0
ds_read_b64_tr_b16 v[40:41], v20 offset:0
v_mfma_f32_16x16x32_bf16 v[100:103], v[156:159], v[144:147], v[100:103]
ds_read_b64_tr_b16 v[42:43], v20 offset:2048
ds_read_b64_tr_b16 v[44:45], v21 offset:0
v_mfma_f32_16x16x32_bf16 v[104:107], v[160:163], v[144:147], v[104:107]
ds_read_b64_tr_b16 v[46:47], v21 offset:2048
ds_read_b64_tr_b16 v[48:49], v22 offset:0
v_mfma_f32_16x16x32_bf16 v[108:111], v[164:167], v[144:147], v[108:111]
ds_read_b64_tr_b16 v[50:51], v22 offset:2048
ds_read_b64_tr_b16 v[52:53], v23 offset:0
v_mfma_f32_16x16x32_bf16 v[124:127], v[164:167], v[148:151], v[124:127]
ds_read_b64_tr_b16 v[54:55], v23 offset:2048
ds_read_b128 v[36:39], v3 offset:1024
v_mfma_f32_16x16x32_bf16 v[120:123], v[160:163], v[148:151], v[120:123]
ds_read_b128 v[56:59], v3 offset:8192
ds_read_b64_tr_b16 v[64:65], v20 offset:4096
v_mfma_f32_16x16x32_bf16 v[116:119], v[156:159], v[148:151], v[116:119]
ds_read_b64_tr_b16 v[66:67], v20 offset:6144
ds_read_b64_tr_b16 v[68:69], v21 offset:4096
v_mfma_f32_16x16x32_bf16 v[112:115], v[152:155], v[148:151], v[112:115]
ds_read_b64_tr_b16 v[70:71], v21 offset:6144
ds_read_b64_tr_b16 v[72:73], v22 offset:4096
v_mfma_f32_16x16x32_bf16 v[96:99], v[176:179], v[168:171], v[96:99]
ds_read_b64_tr_b16 v[74:75], v22 offset:6144
ds_read_b64_tr_b16 v[76:77], v23 offset:4096
v_mfma_f32_16x16x32_bf16 v[100:103], v[180:183], v[168:171], v[100:103]
ds_read_b64_tr_b16 v[78:79], v23 offset:6144
ds_read_b128 v[60:63], v3 offset:9216
v_mfma_f32_16x16x32_bf16 v[104:107], v[184:187], v[168:171], v[104:107]
v_mfma_f32_16x16x32_bf16 v[108:111], v[188:191], v[168:171], v[108:111]
v_mfma_f32_16x16x32_bf16 v[124:127], v[188:191], v[172:175], v[124:127]
v_mfma_f32_16x16x32_bf16 v[120:123], v[184:187], v[172:175], v[120:123]
v_mfma_f32_16x16x32_bf16 v[116:119], v[180:183], v[172:175], v[116:119]
v_mfma_f32_16x16x32_bf16 v[112:115], v[176:179], v[172:175], v[112:115]
s_waitcnt lgkmcnt(0)
s_barrier
v_mfma_f32_16x16x32_bf16 v[96:99], v[40:43], v[32:35], v[96:99]
ds_read_b128 v[144:147], v3 offset:49152
ds_read_b64_tr_b16 v[152:153], v20 offset:8192
v_mfma_f32_16x16x32_bf16 v[100:103], v[44:47], v[32:35], v[100:103]
ds_read_b64_tr_b16 v[154:155], v20 offset:10240
ds_read_b64_tr_b16 v[156:157], v21 offset:8192
v_mfma_f32_16x16x32_bf16 v[104:107], v[48:51], v[32:35], v[104:107]
ds_read_b64_tr_b16 v[158:159], v21 offset:10240
ds_read_b64_tr_b16 v[160:161], v22 offset:8192
v_mfma_f32_16x16x32_bf16 v[108:111], v[52:55], v[32:35], v[108:111]
ds_read_b64_tr_b16 v[162:163], v22 offset:10240
ds_read_b64_tr_b16 v[164:165], v23 offset:8192
v_mfma_f32_16x16x32_bf16 v[124:127], v[52:55], v[36:39], v[124:127]
ds_read_b64_tr_b16 v[166:167], v23 offset:10240
ds_read_b128 v[148:151], v3 offset:50176
v_mfma_f32_16x16x32_bf16 v[120:123], v[48:51], v[36:39], v[120:123]
ds_read_b128 v[168:171], v3 offset:57344
ds_read_b64_tr_b16 v[176:177], v20 offset:12288
v_mfma_f32_16x16x32_bf16 v[116:119], v[44:47], v[36:39], v[116:119]
ds_read_b64_tr_b16 v[178:179], v20 offset:14336
ds_read_b64_tr_b16 v[180:181], v21 offset:12288
v_mfma_f32_16x16x32_bf16 v[112:115], v[40:43], v[36:39], v[112:115]
ds_read_b64_tr_b16 v[182:183], v21 offset:14336
ds_read_b64_tr_b16 v[184:185], v22 offset:12288
v_mfma_f32_16x16x32_bf16 v[96:99], v[64:67], v[56:59], v[96:99]
ds_read_b64_tr_b16 v[186:187], v22 offset:14336
ds_read_b64_tr_b16 v[188:189], v23 offset:12288
v_mfma_f32_16x16x32_bf16 v[100:103], v[68:71], v[56:59], v[100:103]
ds_read_b64_tr_b16 v[190:191], v23 offset:14336
ds_read_b128 v[172:175], v3 offset:58368
v_mfma_f32_16x16x32_bf16 v[104:107], v[72:75], v[56:59], v[104:107]
v_mfma_f32_16x16x32_bf16 v[108:111], v[76:79], v[56:59], v[108:111]
v_mfma_f32_16x16x32_bf16 v[124:127], v[76:79], v[60:63], v[124:127]
v_mfma_f32_16x16x32_bf16 v[120:123], v[72:75], v[60:63], v[120:123]
v_mfma_f32_16x16x32_bf16 v[116:119], v[68:71], v[60:63], v[116:119]
v_mfma_f32_16x16x32_bf16 v[112:115], v[64:67], v[60:63], v[112:115]
s_waitcnt lgkmcnt(0)
s_barrier
v_mfma_f32_16x16x32_bf16 v[96:99], v[152:155], v[144:147], v[96:99]
v_mfma_f32_16x16x32_bf16 v[100:103], v[156:159], v[144:147], v[100:103]
v_mfma_f32_16x16x32_bf16 v[104:107], v[160:163], v[144:147], v[104:107]
v_mfma_f32_16x16x32_bf16 v[108:111], v[164:167], v[144:147], v[108:111]
v_mfma_f32_16x16x32_bf16 v[124:127], v[164:167], v[148:151], v[124:127]
v_mfma_f32_16x16x32_bf16 v[120:123], v[160:163], v[148:151], v[120:123]
v_mfma_f32_16x16x32_bf16 v[116:119], v[156:159], v[148:151], v[116:119]
v_mfma_f32_16x16x32_bf16 v[112:115], v[152:155], v[148:151], v[112:115]
v_mfma_f32_16x16x32_bf16 v[96:99], v[176:179], v[168:171], v[96:99]
v_mfma_f32_16x16x32_bf16 v[100:103], v[180:183], v[168:171], v[100:103]
v_mfma_f32_16x16x32_bf16 v[104:107], v[184:187], v[168:171], v[104:107]
v_mfma_f32_16x16x32_bf16 v[108:111], v[188:191], v[168:171], v[108:111]
v_mfma_f32_16x16x32_bf16 v[124:127], v[188:191], v[172:175], v[124:127]
v_mfma_f32_16x16x32_bf16 v[120:123], v[184:187], v[172:175], v[120:123]
v_mfma_f32_16x16x32_bf16 v[116:119], v[180:183], v[172:175], v[116:119]
v_mfma_f32_16x16x32_bf16 v[112:115], v[176:179], v[172:175], v[112:115]
s_nop 3
v_cvt_pk_bf16_f32 v32, v96, v97
v_cvt_pk_bf16_f32 v33, v98, v99
v_cvt_pk_bf16_f32 v34, v100, v101
v_cvt_pk_bf16_f32 v35, v102, v103
s_add_u32 s43, s60, 0
buffer_store_dwordx4 v[32:35], v11, s[20:23], s43 offen offset:0 sc1
v_cvt_pk_bf16_f32 v36, v104, v105
v_cvt_pk_bf16_f32 v37, v106, v107
v_cvt_pk_bf16_f32 v38, v108, v109
v_cvt_pk_bf16_f32 v39, v110, v111
s_add_u32 s43, s60, 8192
buffer_store_dwordx4 v[36:39], v11, s[20:23], s43 offen offset:0 sc1
v_cvt_pk_bf16_f32 v44, v120, v121
v_cvt_pk_bf16_f32 v45, v122, v123
v_cvt_pk_bf16_f32 v46, v124, v125
v_cvt_pk_bf16_f32 v47, v126, v127
s_add_u32 s43, s60, 8192
buffer_store_dwordx4 v[44:47], v11, s[20:23], s43 offen offset:1024 sc1
v_cvt_pk_bf16_f32 v40, v112, v113
v_cvt_pk_bf16_f32 v41, v114, v115
v_cvt_pk_bf16_f32 v42, v116, v117
v_cvt_pk_bf16_f32 v43, v118, v119
s_add_u32 s43, s60, 0
buffer_store_dwordx4 v[40:43], v11, s[20:23], s43 offen offset:1024 sc1
v_mov_b32 v64, 0
v_mov_b32 v65, 0
v_mov_b32 v66, 0
v_mov_b32 v67, 0
v_mov_b32 v68, 0
v_mov_b32 v69, 0
v_mov_b32 v70, 0
v_mov_b32 v71, 0
v_dot2_f32_bf16 v64, v32, s61, v64
v_dot2_f32_bf16 v66, v32, v32, v66
v_dot2_f32_bf16 v68, v40, s61, v68
v_dot2_f32_bf16 v70, v40, v40, v70
v_dot2_f32_bf16 v65, v33, s61, v65
v_dot2_f32_bf16 v67, v33, v33, v67
v_dot2_f32_bf16 v69, v41, s61, v69
v_dot2_f32_bf16 v71, v41, v41, v71
v_dot2_f32_bf16 v64, v34, s61, v64
v_dot2_f32_bf16 v66, v34, v34, v66
v_dot2_f32_bf16 v68, v42, s61, v68
v_dot2_f32_bf16 v70, v42, v42, v70
v_dot2_f32_bf16 v65, v35, s61, v65
v_dot2_f32_bf16 v67, v35, v35, v67
v_dot2_f32_bf16 v69, v43, s61, v69
v_dot2_f32_bf16 v71, v43, v43, v71
v_dot2_f32_bf16 v64, v36, s61, v64
v_dot2_f32_bf16 v66, v36, v36, v66
v_dot2_f32_bf16 v68, v44, s61, v68
v_dot2_f32_bf16 v70, v44, v44, v70
v_dot2_f32_bf16 v65, v37, s61, v65
v_dot2_f32_bf16 v67, v37, v37, v67
v_dot2_f32_bf16 v69, v45, s61, v69
v_dot2_f32_bf16 v71, v45, v45, v71
v_dot2_f32_bf16 v64, v38, s61, v64
v_dot2_f32_bf16 v66, v38, v38, v66
v_dot2_f32_bf16 v68, v46, s61, v68
v_dot2_f32_bf16 v70, v46, v46, v70
v_dot2_f32_bf16 v65, v39, s61, v65
v_dot2_f32_bf16 v67, v39, v39, v67
v_dot2_f32_bf16 v69, v47, s61, v69
v_dot2_f32_bf16 v71, v47, v47, v71
s_nop 2
v_add_f32 v64, v64, v65
v_add_f32 v66, v66, v67
v_add_f32 v68, v68, v69
v_add_f32 v70, v70, v71
s_nop 1
v_permlane32_swap_b32 v64, v68
v_permlane32_swap_b32 v66, v70
v_add_f32 v64, v64, v68
v_add_f32 v66, v66, v70
s_nop 1
v_permlane16_swap_b32 v64, v66
v_add_f32 v64, v64, v66
buffer_store_dword v64, v9, s[24:27], 0 offen sc1
s_lshl_b32 s7, s34, 12
s_add_u32 s7, s7, 49280
v_lshl_add_u32 v4, v1, 8, s7
v_mov_b32 v5, 1
s_waitcnt vmcnt(0)
s_cmp_lg_u32 s36, 0
s_barrier
s_cbranch_scc1 Lk2end_83
s_mov_b64 exec, 0xffff
buffer_atomic_add v5, v4, s[56:59], 0 offen sc1
s_mov_b64 exec, -1
s_branch Lk2end_83
Lprod_84:
s_mul_i32 s43, s34, 262144
s_add_u32 s8, s82, s43
s_addc_u32 s9, s83, 0
s_mov_b32 s10, 262144
s_mov_b32 s11, 0x20000
s_lshl_b32 s43, s35, 7
s_add_u32 s12, s68, s43
s_addc_u32 s13, s69, 0
s_mov_b32 s14, 2095232
s_mov_b32 s15, 0x20000
s_and_b32 s47, s36, 3
s_lshl_b32 s39, s47, 12
v_lshlrev_b32 v2, 4, v1
v_add_u32 v2, s39, v2
v_lshrrev_b32 v12, 3, v1
v_and_b32 v13, 6, v12
v_and_b32 v3, 7, v1
v_xor_b32 v3, v3, v13
v_lshlrev_b32 v3, 4, v3
v_mul_u32_u24 v12, 2048, v12
v_add_u32 v3, v3, v12
s_lshl_b32 s43, s47, 15
v_add_u32 v3, s43, v3
s_lshl_b32 s40, s47, 11
s_add_u32 s37, s35, 0
s_and_b32 s37, s37, 15
s_lshl_b32 s37, s37, 14
s_add_u32 m0, s39, 0
s_nop 0
buffer_load_dwordx4 v2, s[8:11], s37 offen offset:0 sc1 lds
buffer_load_dwordx4 v2, s[8:11], s37 offen offset:1024 sc1 lds
buffer_load_dwordx4 v2, s[8:11], s37 offen offset:2048 sc1 lds
buffer_load_dwordx4 v2, s[8:11], s37 offen offset:3072 sc1 lds
s_add_u32 s38, s35, 8
s_and_b32 s38, s38, 15
s_lshl_b32 s38, s38, 17
s_add_u32 m0, s40, 16384
s_nop 0
buffer_load_dwordx4 v3, s[12:15], s38 offen lds
s_add_u32 m0, s40, 17408
s_add_u32 s38, s38, 16384
buffer_load_dwordx4 v3, s[12:15], s38 offen lds
s_add_u32 s38, s35, 9
s_and_b32 s38, s38, 15
s_lshl_b32 s38, s38, 17
s_add_u32 m0, s40, 24576
s_nop 0
buffer_load_dwordx4 v3, s[12:15], s38 offen lds
s_add_u32 m0, s40, 25600
s_add_u32 s38, s38, 16384
buffer_load_dwordx4 v3, s[12:15], s38 offen lds
s_add_u32 s38, s35, 10
s_and_b32 s38, s38, 15
s_lshl_b32 s38, s38, 17
s_add_u32 m0, s40, 32768
s_nop 0
buffer_load_dwordx4 v3, s[12:15], s38 offen lds
s_add_u32 m0, s40, 33792
s_add_u32 s38, s38, 16384
buffer_load_dwordx4 v3, s[12:15], s38 offen lds
s_add_u32 s38, s35, 11
s_and_b32 s38, s38, 15
s_lshl_b32 s38, s38, 17
s_add_u32 m0, s40, 40960
s_nop 0
buffer_load_dwordx4 v3, s[12:15], s38 offen lds
s_add_u32 m0, s40, 41984
s_add_u32 s38, s38, 16384
buffer_load_dwordx4 v3, s[12:15], s38 offen lds
s_bitcmp0_b32 s36, 1
s_cselect_b32 s44, s72, s74
s_cselect_b32 s45, s73, s75
s_mul_i32 s43, s35, 192
s_add_u32 s16, s44, s43
s_addc_u32 s17, s45, 0
s_add_u32 s16, s16, 4096
s_addc_u32 s17, s17, 0
s_mov_b32 s18, 7333056
s_mov_b32 s19, 0x20000
s_and_b32 s43, s36, 1
s_mul_i32 s43, s43, 229376
v_add_u32 v196, 0, v1
v_mul_u32_u24 v197, 5462, v196
v_lshrrev_b32 v197, 16, v197
v_mul_u32_u24 v198, 12, v197
v_sub_u32 v198, v196, v198
v_bfe_u32 v199, v197, 2, 1
v_cmp_gt_u32 vcc, 8, v198
v_lshlrev_b32 v200, 1, v199
v_mul_u32_u24 v197, 7168, v197
v_cndmask_b32 v199, v199, v200, vcc
v_xor_b32 v198, v198, v199
v_lshl_add_u32 v192, v198, 4, v197
v_add_u32 v196, 64, v1
v_mul_u32_u24 v197, 5462, v196
v_lshrrev_b32 v197, 16, v197
v_mul_u32_u24 v198, 12, v197
v_sub_u32 v198, v196, v198
v_bfe_u32 v199, v197, 2, 1
v_cmp_gt_u32 vcc, 8, v198
v_lshlrev_b32 v200, 1, v199
v_mul_u32_u24 v197, 7168, v197
v_cndmask_b32 v199, v199, v200, vcc
v_xor_b32 v198, v198, v199
v_lshl_add_u32 v193, v198, 4, v197
v_add_u32 v196, 128, v1
v_mul_u32_u24 v197, 5462, v196
v_lshrrev_b32 v197, 16, v197
v_mul_u32_u24 v198, 12, v197
v_sub_u32 v198, v196, v198
v_bfe_u32 v199, v197, 2, 1
v_cmp_gt_u32 vcc, 8, v198
v_lshlrev_b32 v200, 1, v199
v_mul_u32_u24 v197, 7168, v197
v_cndmask_b32 v199, v199, v200, vcc
v_xor_b32 v198, v198, v199
v_lshl_add_u32 v194, v198, 4, v197
v_add_u32 v192, s43, v192
v_add_u32 v193, s43, v193
v_add_u32 v194, s43, v194
s_and_b32 s43, s36, 3
s_mul_i32 s50, s43, 6144
s_add_u32 s50, s50, 16384
s_cmp_eq_u32 s47, 3
s_cbranch_scc0 Lw_91
s_lshl_b32 s92, s34, 4
s_add_u32 s92, s92, s35
s_lshl_b32 s92, s92, 8
s_add_u32 s92, s92, 49152
s_add_u32 s92, s92, 28311552
s_mov_b32 s41, 0x40000
Lpoll_92:
s_load_dword s93, s[82:83], s92 glc
Lpchk_94:
s_waitcnt lgkmcnt(0)
s_cmp_eq_u32 s93, 16
s_cbranch_scc1 Lpok_93
s_sub_u32 s41, s41, 1
s_cmp_lg_u32 s41, 0
s_cbranch_scc1 Lpoll_92
Lpok_93:
Lw_91:
s_and_b32 s44, s36, 3
s_mul_i32 s44, s44, 11
s_bfe_u32 s43, s2, 0x30001
s_lshl_b32 s43, s43, 7
s_add_u32 s44, s44, s43
s_add_u32 s44, s44, 84
s_mul_i32 s44, s44, 7168
s_lshr_b32 s43, s2, 4
s_lshl_b32 s43, s43, 8
s_add_u32 s43, s43, s44
s_bitcmp0_b32 s2, 0
s_cselect_b32 s4, s72, s74
s_cselect_b32 s5, s73, s75
s_add_u32 s4, s4, s43
s_addc_u32 s5, s5, 0
s_cmp_eq_u32 s47, 3
s_cbranch_scc1 Lw_95
Lw_95:
s_waitcnt vmcnt(8)
s_barrier
s_add_u32 s37, s35, 1
s_and_b32 s37, s37, 15
s_lshl_b32 s37, s37, 14
s_add_u32 m0, s39, 49152
s_nop 0
buffer_load_dwordx4 v2, s[8:11], s37 offen offset:0 sc1 lds
buffer_load_dwordx4 v2, s[8:11], s37 offen offset:1024 sc1 lds
buffer_load_dwordx4 v2, s[8:11], s37 offen offset:2048 sc1 lds
buffer_load_dwordx4 v2, s[8:11], s37 offen offset:3072 sc1 lds
s_add_u32 s37, s35, 2
s_and_b32 s37, s37, 15
s_lshl_b32 s37, s37, 14
s_add_u32 m0, s39, 98304
s_nop 0
buffer_load_dwordx4 v2, s[8:11], s37 offen offset:0 sc1 lds
buffer_load_dwordx4 v2, s[8:11], s37 offen offset:1024 sc1 lds
buffer_load_dwordx4 v2, s[8:11], s37 offen offset:2048 sc1 lds
buffer_load_dwordx4 v2, s[8:11], s37 offen offset:3072 sc1 lds
s_add_u32 s37, s35, 3
s_and_b32 s37, s37, 15
s_lshl_b32 s37, s37, 14
s_add_u32 m0, s39, 147456
s_nop 0
buffer_load_dwordx4 v2, s[8:11], s37 offen offset:0 sc1 lds
buffer_load_dwordx4 v2, s[8:11], s37 offen offset:1024 sc1 lds
buffer_load_dwordx4 v2, s[8:11], s37 offen offset:2048 sc1 lds
buffer_load_dwordx4 v2, s[8:11], s37 offen offset:3072 sc1 lds
s_cmp_eq_u32 s47, 3
s_cbranch_scc0 Lw_96
Lw_96:
s_waitcnt vmcnt(8)
s_barrier
s_add_u32 s37, s35, 4
s_and_b32 s37, s37, 15
s_lshl_b32 s37, s37, 14
s_add_u32 m0, s39, 0
s_nop 0
buffer_load_dwordx4 v2, s[8:11], s37 offen offset:0 sc1 lds
buffer_load_dwordx4 v2, s[8:11], s37 offen offset:1024 sc1 lds
buffer_load_dwordx4 v2, s[8:11], s37 offen offset:2048 sc1 lds
buffer_load_dwordx4 v2, s[8:11], s37 offen offset:3072 sc1 lds
v_lshlrev_b32 v240, 16, v128
v_and_b32 v241, 0xffff0000, v128
v_lshlrev_b32 v242, 16, v129
v_and_b32 v243, 0xffff0000, v129
v_lshlrev_b32 v244, 16, v130
v_and_b32 v245, 0xffff0000, v130
v_lshlrev_b32 v246, 16, v131
v_and_b32 v247, 0xffff0000, v131
s_waitcnt vmcnt(8)
s_barrier
s_add_u32 s37, s35, 5
s_and_b32 s37, s37, 15
s_lshl_b32 s37, s37, 14
s_add_u32 m0, s39, 49152
s_nop 0
buffer_load_dwordx4 v2, s[8:11], s37 offen offset:0 sc1 lds
buffer_load_dwordx4 v2, s[8:11], s37 offen offset:1024 sc1 lds
buffer_load_dwordx4 v2, s[8:11], s37 offen offset:2048 sc1 lds
buffer_load_dwordx4 v2, s[8:11], s37 offen offset:3072 sc1 lds
v_lshlrev_b32 v24, 16, v132
v_and_b32 v25, 0xffff0000, v132
v_lshlrev_b32 v26, 16, v133
v_and_b32 v27, 0xffff0000, v133
v_lshlrev_b32 v28, 16, v134
v_and_b32 v29, 0xffff0000, v134
v_lshlrev_b32 v30, 16, v135
v_and_b32 v31, 0xffff0000, v135
v_add_f32 v240, v240, v24
v_add_f32 v241, v241, v25
v_add_f32 v242, v242, v26
v_add_f32 v243, v243, v27
v_add_f32 v244, v244, v28
v_add_f32 v245, v245, v29
v_add_f32 v246, v246, v30
v_add_f32 v247, v247, v31
s_waitcnt vmcnt(8)
s_barrier
s_add_u32 s37, s35, 6
s_and_b32 s37, s37, 15
s_lshl_b32 s37, s37, 14
s_add_u32 m0, s39, 98304
s_nop 0
buffer_load_dwordx4 v2, s[8:11], s37 offen offset:0 sc1 lds
buffer_load_dwordx4 v2, s[8:11], s37 offen offset:1024 sc1 lds
buffer_load_dwordx4 v2, s[8:11], s37 offen offset:2048 sc1 lds
buffer_load_dwordx4 v2, s[8:11], s37 offen offset:3072 sc1 lds
v_lshlrev_b32 v24, 16, v136
v_and_b32 v25, 0xffff0000, v136
v_lshlrev_b32 v26, 16, v137
v_and_b32 v27, 0xffff0000, v137
v_lshlrev_b32 v28, 16, v138
v_and_b32 v29, 0xffff0000, v138
v_lshlrev_b32 v30, 16, v139
v_and_b32 v31, 0xffff0000, v139
v_add_f32 v240, v240, v24
v_add_f32 v241, v241, v25
v_add_f32 v242, v242, v26
v_add_f32 v243, v243, v27
v_add_f32 v244, v244, v28
v_add_f32 v245, v245, v29
v_add_f32 v246, v246, v30
v_add_f32 v247, v247, v31
s_waitcnt vmcnt(8)
s_barrier
s_add_u32 s37, s35, 7
s_and_b32 s37, s37, 15
s_lshl_b32 s37, s37, 14
s_add_u32 m0, s39, 147456
s_nop 0
buffer_load_dwordx4 v2, s[8:11], s37 offen offset:0 sc1 lds
buffer_load_dwordx4 v2, s[8:11], s37 offen offset:1024 sc1 lds
buffer_load_dwordx4 v2, s[8:11], s37 offen offset:2048 sc1 lds
buffer_load_dwordx4 v2, s[8:11], s37 offen offset:3072 sc1 lds
v_lshlrev_b32 v24, 16, v140
v_and_b32 v25, 0xffff0000, v140
v_lshlrev_b32 v26, 16, v141
v_and_b32 v27, 0xffff0000, v141
v_lshlrev_b32 v28, 16, v142
v_and_b32 v29, 0xffff0000, v142
v_lshlrev_b32 v30, 16, v143
v_and_b32 v31, 0xffff0000, v143
v_add_f32 v240, v240, v24
v_add_f32 v241, v241, v25
v_add_f32 v242, v242, v26
v_add_f32 v243, v243, v27
v_add_f32 v244, v244, v28
v_add_f32 v245, v245, v29
v_add_f32 v246, v246, v30
v_add_f32 v247, v247, v31
s_waitcnt vmcnt(8)
s_barrier
s_add_u32 s37, s35, 8
s_and_b32 s37, s37, 15
s_lshl_b32 s37, s37, 14
s_add_u32 m0, s39, 0
s_nop 0
buffer_load_dwordx4 v2, s[8:11], s37 offen offset:0 sc1 lds
buffer_load_dwordx4 v2, s[8:11], s37 offen offset:1024 sc1 lds
buffer_load_dwordx4 v2, s[8:11], s37 offen offset:2048 sc1 lds
buffer_load_dwordx4 v2, s[8:11], s37 offen offset:3072 sc1 lds
s_add_u32 s38, s35, 12
s_and_b32 s38, s38, 15
s_lshl_b32 s38, s38, 17
s_add_u32 m0, s40, 114688
s_nop 0
buffer_load_dwordx4 v3, s[12:15], s38 offen lds
s_add_u32 m0, s40, 115712
s_add_u32 s38, s38, 16384
buffer_load_dwordx4 v3, s[12:15], s38 offen lds
v_lshlrev_b32 v24, 16, v144
v_and_b32 v25, 0xffff0000, v144
v_lshlrev_b32 v26, 16, v145
v_and_b32 v27, 0xffff0000, v145
v_lshlrev_b32 v28, 16, v146
v_and_b32 v29, 0xffff0000, v146
v_lshlrev_b32 v30, 16, v147
v_and_b32 v31, 0xffff0000, v147
v_add_f32 v240, v240, v24
v_add_f32 v241, v241, v25
v_add_f32 v242, v242, v26
v_add_f32 v243, v243, v27
v_add_f32 v244, v244, v28
v_add_f32 v245, v245, v29
v_add_f32 v246, v246, v30
v_add_f32 v247, v247, v31
s_waitcnt vmcnt(10)
s_barrier
s_add_u32 s37, s35, 9
s_and_b32 s37, s37, 15
s_lshl_b32 s37, s37, 14
s_add_u32 m0, s39, 49152
s_nop 0
buffer_load_dwordx4 v2, s[8:11], s37 offen offset:0 sc1 lds
buffer_load_dwordx4 v2, s[8:11], s37 offen offset:1024 sc1 lds
buffer_load_dwordx4 v2, s[8:11], s37 offen offset:2048 sc1 lds
buffer_load_dwordx4 v2, s[8:11], s37 offen offset:3072 sc1 lds
s_add_u32 s38, s35, 13
s_and_b32 s38, s38, 15
s_lshl_b32 s38, s38, 17
s_add_u32 m0, s40, 122880
s_nop 0
buffer_load_dwordx4 v3, s[12:15], s38 offen lds
s_add_u32 m0, s40, 123904
s_add_u32 s38, s38, 16384
buffer_load_dwordx4 v3, s[12:15], s38 offen lds
v_lshlrev_b32 v24, 16, v148
v_and_b32 v25, 0xffff0000, v148
v_lshlrev_b32 v26, 16, v149
v_and_b32 v27, 0xffff0000, v149
v_lshlrev_b32 v28, 16, v150
v_and_b32 v29, 0xffff0000, v150
v_lshlrev_b32 v30, 16, v151
v_and_b32 v31, 0xffff0000, v151
v_add_f32 v240, v240, v24
v_add_f32 v241, v241, v25
v_add_f32 v242, v242, v26
v_add_f32 v243, v243, v27
v_add_f32 v244, v244, v28
v_add_f32 v245, v245, v29
v_add_f32 v246, v246, v30
v_add_f32 v247, v247, v31
s_waitcnt vmcnt(12)
s_barrier
s_add_u32 s37, s35, 10
s_and_b32 s37, s37, 15
s_lshl_b32 s37, s37, 14
s_add_u32 m0, s39, 98304
s_nop 0
buffer_load_dwordx4 v2, s[8:11], s37 offen offset:0 sc1 lds
buffer_load_dwordx4 v2, s[8:11], s37 offen offset:1024 sc1 lds
buffer_load_dwordx4 v2, s[8:11], s37 offen offset:2048 sc1 lds
buffer_load_dwordx4 v2, s[8:11], s37 offen offset:3072 sc1 lds
s_add_u32 s38, s35, 14
s_and_b32 s38, s38, 15
s_lshl_b32 s38, s38, 17
s_add_u32 m0, s40, 131072
s_nop 0
buffer_load_dwordx4 v3, s[12:15], s38 offen lds
s_add_u32 m0, s40, 132096
s_add_u32 s38, s38, 16384
buffer_load_dwordx4 v3, s[12:15], s38 offen lds
v_lshlrev_b32 v24, 16, v152
v_and_b32 v25, 0xffff0000, v152
v_lshlrev_b32 v26, 16, v153
v_and_b32 v27, 0xffff0000, v153
v_lshlrev_b32 v28, 16, v154
v_and_b32 v29, 0xffff0000, v154
v_lshlrev_b32 v30, 16, v155
v_and_b32 v31, 0xffff0000, v155
v_add_f32 v240, v240, v24
v_add_f32 v241, v241, v25
v_add_f32 v242, v242, v26
v_add_f32 v243, v243, v27
v_add_f32 v244, v244, v28
v_add_f32 v245, v245, v29
v_add_f32 v246, v246, v30
v_add_f32 v247, v247, v31
s_waitcnt vmcnt(14)
s_barrier
s_add_u32 s37, s35, 11
s_and_b32 s37, s37, 15
s_lshl_b32 s37, s37, 14
s_add_u32 m0, s39, 147456
s_nop 0
buffer_load_dwordx4 v2, s[8:11], s37 offen offset:0 sc1 lds
buffer_load_dwordx4 v2, s[8:11], s37 offen offset:1024 sc1 lds
buffer_load_dwordx4 v2, s[8:11], s37 offen offset:2048 sc1 lds
buffer_load_dwordx4 v2, s[8:11], s37 offen offset:3072 sc1 lds
s_add_u32 s38, s35, 15
s_and_b32 s38, s38, 15
s_lshl_b32 s38, s38, 17
s_add_u32 m0, s40, 139264
s_nop 0
buffer_load_dwordx4 v3, s[12:15], s38 offen lds
s_add_u32 m0, s40, 140288
s_add_u32 s38, s38, 16384
buffer_load_dwordx4 v3, s[12:15], s38 offen lds
v_lshlrev_b32 v24, 16, v156
v_and_b32 v25, 0xffff0000, v156
v_lshlrev_b32 v26, 16, v157
v_and_b32 v27, 0xffff0000, v157
v_lshlrev_b32 v28, 16, v158
v_and_b32 v29, 0xffff0000, v158
v_lshlrev_b32 v30, 16, v159
v_and_b32 v31, 0xffff0000, v159
v_add_f32 v240, v240, v24
v_add_f32 v241, v241, v25
v_add_f32 v242, v242, v26
v_add_f32 v243, v243, v27
v_add_f32 v244, v244, v28
v_add_f32 v245, v245, v29
v_add_f32 v246, v246, v30
v_add_f32 v247, v247, v31
s_waitcnt vmcnt(14)
s_barrier
s_add_u32 s37, s35, 12
s_and_b32 s37, s37, 15
s_lshl_b32 s37, s37, 14
s_add_u32 m0, s39, 0
s_nop 0
buffer_load_dwordx4 v2, s[8:11], s37 offen offset:0 sc1 lds
buffer_load_dwordx4 v2, s[8:11], s37 offen offset:1024 sc1 lds
buffer_load_dwordx4 v2, s[8:11], s37 offen offset:2048 sc1 lds
buffer_load_dwordx4 v2, s[8:11], s37 offen offset:3072 sc1 lds
s_waitcnt vmcnt(12)
s_barrier
s_add_u32 s37, s35, 13
s_and_b32 s37, s37, 15
s_lshl_b32 s37, s37, 14
s_add_u32 m0, s39, 49152
s_nop 0
buffer_load_dwordx4 v2, s[8:11], s37 offen offset:0 sc1 lds
buffer_load_dwordx4 v2, s[8:11], s37 offen offset:1024 sc1 lds
buffer_load_dwordx4 v2, s[8:11], s37 offen offset:2048 sc1 lds
buffer_load_dwordx4 v2, s[8:11], s37 offen offset:3072 sc1 lds
s_waitcnt vmcnt(10)
s_barrier
s_add_u32 s37, s35, 14
s_and_b32 s37, s37, 15
s_lshl_b32 s37, s37, 14
s_add_u32 m0, s39, 98304
s_nop 0
buffer_load_dwordx4 v2, s[8:11], s37 offen offset:0 sc1 lds
buffer_load_dwordx4 v2, s[8:11], s37 offen offset:1024 sc1 lds
buffer_load_dwordx4 v2, s[8:11], s37 offen offset:2048 sc1 lds
s_branch Lov_7
.p2align 12
.fill 48, 4, 0xbf800000
Lst_7_0:
s_branch Lwr_152
s_nop 0
s_nop 0
Lov_7:
buffer_load_dwordx4 v2, s[8:11], s37 offen offset:3072 sc1 lds
s_getpc_b64 s[100:101]
s_and_b32 s100, s100, 0xfffff000
s_sub_u32 s100, s100, 1081344
s_subb_u32 s101, s101, 0
s_lshr_b32 s6, s2, 3
s_mul_i32 s6, s6, 4
s_and_b32 s7, s36, 3
s_add_u32 s6, s6, s7
s_mulk_i32 s6, 384
s_add_u32 s6, s6, 1082048
s_load_dword s3, s[100:101], s6 offset:0
s_load_dword s3, s[100:101], s6 offset:64
s_load_dword s3, s[100:101], s6 offset:128
s_load_dword s3, s[100:101], s6 offset:192
s_load_dword s3, s[100:101], s6 offset:256
s_load_dword s3, s[100:101], s6 offset:320
s_nop 0
s_nop 0
s_waitcnt vmcnt(8)
s_barrier
s_add_u32 s37, s35, 15
s_and_b32 s37, s37, 15
s_lshl_b32 s37, s37, 14
s_add_u32 m0, s39, 147456
s_nop 0
buffer_load_dwordx4 v2, s[8:11], s37 offen offset:0 sc1 lds
buffer_load_dwordx4 v2, s[8:11], s37 offen offset:1024 sc1 lds
buffer_load_dwordx4 v2, s[8:11], s37 offen offset:2048 sc1 lds
buffer_load_dwordx4 v2, s[8:11], s37 offen offset:3072 sc1 lds
s_waitcnt vmcnt(8)
s_barrier
s_nop 0
v_permlane32_swap_b32 v240, v244
v_permlane32_swap_b32 v241, v245
v_permlane32_swap_b32 v242, v246
v_permlane32_swap_b32 v243, v247
v_add_f32 v240, v240, v244
v_add_f32 v241, v241, v245
v_add_f32 v242, v242, v246
v_add_f32 v243, v243, v247
s_nop 0
v_permlane16_swap_b32 v240, v242
v_permlane16_swap_b32 v241, v243
v_add_f32 v240, v240, v242
v_add_f32 v241, v241, v243
s_waitcnt vmcnt(4)
s_barrier
s_add_u32 s38, s35, 0
s_and_b32 s38, s38, 15
s_mul_i32 s38, s38, 458752
s_add_u32 m0, s50, 0
s_nop 0
buffer_load_dwordx4 v192, s[16:19], s38 offen lds
s_add_u32 m0, s50, 1024
s_nop 0
buffer_load_dwordx4 v193, s[16:19], s38 offen lds
s_add_u32 m0, s50, 2048
s_nop 0
buffer_load_dwordx4 v194, s[16:19], s38 offen lds
s_add_u32 m0, s50, 3072
s_add_u32 s38, s38, 114688
buffer_load_dwordx4 v192, s[16:19], s38 offen lds
s_add_u32 m0, s50, 4096
s_nop 0
buffer_load_dwordx4 v193, s[16:19], s38 offen lds
s_add_u32 m0, s50, 5120
s_nop 0
buffer_load_dwordx4 v194, s[16:19], s38 offen lds
s_add_u32 s38, s35, 1
s_and_b32 s38, s38, 15
s_mul_i32 s38, s38, 458752
s_add_u32 m0, s50, 49152
s_nop 0
buffer_load_dwordx4 v192, s[16:19], s38 offen lds
s_add_u32 m0, s50, 50176
s_nop 0
buffer_load_dwordx4 v193, s[16:19], s38 offen lds
s_add_u32 m0, s50, 51200
s_nop 0
buffer_load_dwordx4 v194, s[16:19], s38 offen lds
s_add_u32 m0, s50, 52224
s_add_u32 s38, s38, 114688
buffer_load_dwordx4 v192, s[16:19], s38 offen lds
s_add_u32 m0, s50, 53248
s_nop 0
buffer_load_dwordx4 v193, s[16:19], s38 offen lds
s_add_u32 m0, s50, 54272
s_nop 0
buffer_load_dwordx4 v194, s[16:19], s38 offen lds
s_waitcnt vmcnt(12)
s_barrier
s_barrier
s_branch Lk3a
Lk2end_83:
Lk3:
s_branch Lgb_97
Lk3a:
s_mul_i32 s43, s34, 262144
s_add_u32 s8, s82, s43
s_addc_u32 s9, s83, 0
s_add_u32 s8, s8, 4194304
s_addc_u32 s9, s9, 0
s_mov_b32 s10, 262144
s_mov_b32 s11, 0x20000
s_mul_i32 s43, s34, 917504
s_add_u32 s24, s82, s43
s_addc_u32 s25, s83, 0
s_add_u32 s24, s24, 8388608
s_addc_u32 s25, s25, 0
s_mov_b32 s26, 917504
s_mov_b32 s27, 0x20000
s_add_u32 s84, s82, 27262976
s_addc_u32 s85, s83, 0
s_mov_b32 s86, 229376
s_mov_b32 s87, 0x20000
s_and_b32 s47, s36, 3
s_lshr_b32 s62, s47, 1
s_and_b32 s63, s47, 1
v_lshlrev_b32 v2, 4, v1
s_lshl_b32 s39, s47, 12
v_add_u32 v3, s39, v2
s_bitcmp0_b32 s36, 1
s_cselect_b32 s44, s72, s74
s_cselect_b32 s45, s73, s75
s_mul_i32 s43, s35, 256
s_add_u32 s12, s44, s43
s_addc_u32 s13, s45, 0
s_mov_b32 s14, 7333120
s_mov_b32 s15, 0x20000
s_and_b32 s43, s36, 1
s_mul_i32 s43, s43, 229376
v_lshrrev_b32 v28, 4, v1
v_lshlrev_b32 v29, 1, v28
v_and_b32 v4, 15, v1
v_xor_b32 v4, v4, v29
v_lshlrev_b32 v4, 4, v4
v_mul_u32_u24 v28, 7168, v28
v_add_u32 v4, v4, v28
v_add_u32 v4, s43, v4
v_xor_b32 v5, 128, v4
v_add_u32 v5, 28672, v5
s_and_b32 s43, s36, 3
s_mul_i32 s40, s43, 8192
s_add_u32 s40, s40, 16384
v_mov_b32 v6, v192
v_mov_b32 v7, v193
v_mov_b32 v8, v194
s_lshl_b32 s43, s62, 12
v_add_u32 v9, s43, v2
v_add_u32 v10, 98304, v9
v_lshrrev_b32 v27, 2, v1
v_bfe_u32 v28, v27, 2, 1
v_mul_u32_u24 v27, 192, v27
v_add_u32 v27, 16384, v27
v_and_b32 v29, 3, v1
v_lshl_add_u32 v12, v29, 3, v27
s_lshl_b32 s43, s63, 6
v_add_u32 v12, s43, v12
v_lshl_add_u32 v11, v28, 5, v12
v_xor_b32 v30, 1, v28
v_lshl_add_u32 v12, v30, 5, v12
v_xor_b32 v28, s63, v28
v_lshl_add_u32 v27, v28, 4, v27
v_lshrrev_b32 v28, 1, v29
v_lshl_add_u32 v27, v28, 5, v27
v_and_b32 v28, 1, v29
v_lshl_add_u32 v27, v28, 3, v27
v_add_u32 v13, 128, v27
v_add_u32 v14, 49152, v11
v_add_u32 v15, 49152, v12
v_add_u32 v16, 49152, v13
v_add_u32 v17, 98304, v11
v_add_u32 v18, 98304, v12
v_add_u32 v19, 98304, v13
s_cmp_lg_u32 s36, 4
s_cbranch_scc1 Lwm_99
s_branch Lst_8_1
Lwr_164:
s_branch Lwe_98
Lwm_99:
s_cmp_lg_u32 s36, 5
s_cbranch_scc1 Lwm_100
s_branch Lst_9_1
Lwr_165:
s_branch Lwe_98
Lwm_100:
s_cmp_lg_u32 s36, 6
s_cbranch_scc1 Lwm_101
s_branch Lst_10_1
Lwr_166:
s_branch Lwe_98
Lwm_101:
s_cmp_lg_u32 s36, 7
s_cbranch_scc1 Lwm_102
s_nop 0
s_branch Lwe_98
Lwm_102:
Lwe_98:
s_barrier
s_lshl_b32 s43, s47, 9
s_add_u32 s43, s43, 151552
v_and_b32 v28, 15, v1
v_lshl_add_u32 v28, v28, 5, s43
v_lshrrev_b32 v29, 4, v1
v_lshl_add_u32 v28, v29, 3, v28
ds_write_b64 v28, v[240:241]
s_waitcnt lgkmcnt(0)
s_cmp_lg_u32 s36, 4
s_cbranch_scc1 Lwm_104
s_branch Lst_11_1
Lwr_168:
s_branch Lwe_103
Lwm_104:
s_cmp_lg_u32 s36, 5
s_cbranch_scc1 Lwm_105
s_branch Lst_12_1
Lwr_169:
s_branch Lwe_103
Lwm_105:
s_cmp_lg_u32 s36, 6
s_cbranch_scc1 Lwm_106
s_branch Lst_13_1
Lwr_170:
s_branch Lwe_103
Lwm_106:
s_cmp_lg_u32 s36, 7
s_cbranch_scc1 Lwm_107
s_branch Lst_14_1
Lwr_171:
s_branch Lwe_103
Lwm_107:
Lwe_103:
s_waitcnt vmcnt(0) lgkmcnt(0)
s_barrier
ds_read_b128 v[32:35], v9 offset:0
ds_read_b64_tr_b16 v[48:49], v11 offset:0
ds_read_b64_tr_b16 v[50:51], v11 offset:3072
ds_read_b64_tr_b16 v[52:53], v12 offset:0
ds_read_b64_tr_b16 v[54:55], v12 offset:3072
ds_read_b64_tr_b16 v[56:57], v13 offset:0
ds_read_b64_tr_b16 v[58:59], v13 offset:3072
ds_read_b64_tr_b16 v[60:61], v11 offset:12288
ds_read_b64_tr_b16 v[62:63], v11 offset:15360
ds_read_b64_tr_b16 v[64:65], v12 offset:12288
ds_read_b64_tr_b16 v[66:67], v12 offset:15360
ds_read_b64_tr_b16 v[68:69], v13 offset:12288
ds_read_b64_tr_b16 v[70:71], v13 offset:15360
ds_read_b128 v[36:39], v9 offset:1024
ds_read_b128 v[40:43], v9 offset:2048
ds_read_b128 v[44:47], v9 offset:3072
s_waitcnt lgkmcnt(0)
v_mfma_f32_16x16x32_bf16 v[128:131], v[48:51], v[32:35], 0
ds_read_b128 v[72:75], v9 offset:8192
v_mfma_f32_16x16x32_bf16 v[152:155], v[48:51], v[36:39], 0
ds_read_b64_tr_b16 v[88:89], v11 offset:6144
v_mfma_f32_16x16x32_bf16 v[176:179], v[48:51], v[40:43], 0
ds_read_b64_tr_b16 v[90:91], v11 offset:9216
v_mfma_f32_16x16x32_bf16 v[200:203], v[48:51], v[44:47], 0
ds_read_b64_tr_b16 v[92:93], v12 offset:6144
v_mfma_f32_16x16x32_bf16 v[204:207], v[52:55], v[44:47], 0
ds_read_b64_tr_b16 v[94:95], v12 offset:9216
v_mfma_f32_16x16x32_bf16 v[180:183], v[52:55], v[40:43], 0
ds_read_b64_tr_b16 v[96:97], v13 offset:6144
v_mfma_f32_16x16x32_bf16 v[156:159], v[52:55], v[36:39], 0
ds_read_b64_tr_b16 v[98:99], v13 offset:9216
v_mfma_f32_16x16x32_bf16 v[132:135], v[52:55], v[32:35], 0
ds_read_b64_tr_b16 v[100:101], v11 offset:18432
v_mfma_f32_16x16x32_bf16 v[136:139], v[56:59], v[32:35], 0
ds_read_b64_tr_b16 v[102:103], v11 offset:21504
v_mfma_f32_16x16x32_bf16 v[160:163], v[56:59], v[36:39], 0
ds_read_b64_tr_b16 v[104:105], v12 offset:18432
v_mfma_f32_16x16x32_bf16 v[184:187], v[56:59], v[40:43], 0
ds_read_b64_tr_b16 v[106:107], v12 offset:21504
v_mfma_f32_16x16x32_bf16 v[208:211], v[56:59], v[44:47], 0
ds_read_b64_tr_b16 v[108:109], v13 offset:18432
v_mfma_f32_16x16x32_bf16 v[212:215], v[60:63], v[44:47], 0
ds_read_b64_tr_b16 v[110:111], v13 offset:21504
v_mfma_f32_16x16x32_bf16 v[188:191], v[60:63], v[40:43], 0
ds_read_b128 v[76:79], v9 offset:9216
v_mfma_f32_16x16x32_bf16 v[164:167], v[60:63], v[36:39], 0
ds_read_b128 v[80:83], v9 offset:10240
v_mfma_f32_16x16x32_bf16 v[140:143], v[60:63], v[32:35], 0
ds_read_b128 v[84:87], v9 offset:11264
v_mfma_f32_16x16x32_bf16 v[144:147], v[64:67], v[32:35], 0
v_mfma_f32_16x16x32_bf16 v[168:171], v[64:67], v[36:39], 0
v_mfma_f32_16x16x32_bf16 v[192:195], v[64:67], v[40:43], 0
v_mfma_f32_16x16x32_bf16 v[216:219], v[64:67], v[44:47], 0
v_mfma_f32_16x16x32_bf16 v[220:223], v[68:71], v[44:47], 0
v_mfma_f32_16x16x32_bf16 v[196:199], v[68:71], v[40:43], 0
v_mfma_f32_16x16x32_bf16 v[172:175], v[68:71], v[36:39], 0
v_mfma_f32_16x16x32_bf16 v[148:151], v[68:71], v[32:35], 0
s_waitcnt lgkmcnt(0)
s_barrier
v_mfma_f32_16x16x32_bf16 v[128:131], v[88:91], v[72:75], v[128:131]
ds_read_b128 v[32:35], v9 offset:49152
v_mfma_f32_16x16x32_bf16 v[152:155], v[88:91], v[76:79], v[152:155]
ds_read_b64_tr_b16 v[48:49], v14 offset:0
v_mfma_f32_16x16x32_bf16 v[176:179], v[88:91], v[80:83], v[176:179]
ds_read_b64_tr_b16 v[50:51], v14 offset:3072
v_mfma_f32_16x16x32_bf16 v[200:203], v[88:91], v[84:87], v[200:203]
ds_read_b64_tr_b16 v[52:53], v15 offset:0
v_mfma_f32_16x16x32_bf16 v[204:207], v[92:95], v[84:87], v[204:207]
ds_read_b64_tr_b16 v[54:55], v15 offset:3072
v_mfma_f32_16x16x32_bf16 v[180:183], v[92:95], v[80:83], v[180:183]
ds_read_b64_tr_b16 v[56:57], v16 offset:0
v_mfma_f32_16x16x32_bf16 v[156:159], v[92:95], v[76:79], v[156:159]
ds_read_b64_tr_b16 v[58:59], v16 offset:3072
v_mfma_f32_16x16x32_bf16 v[132:135], v[92:95], v[72:75], v[132:135]
ds_read_b64_tr_b16 v[60:61], v14 offset:12288
v_mfma_f32_16x16x32_bf16 v[136:139], v[96:99], v[72:75], v[136:139]
ds_read_b64_tr_b16 v[62:63], v14 offset:15360
v_mfma_f32_16x16x32_bf16 v[160:163], v[96:99], v[76:79], v[160:163]
ds_read_b64_tr_b16 v[64:65], v15 offset:12288
v_mfma_f32_16x16x32_bf16 v[184:187], v[96:99], v[80:83], v[184:187]
ds_read_b64_tr_b16 v[66:67], v15 offset:15360
v_mfma_f32_16x16x32_bf16 v[208:211], v[96:99], v[84:87], v[208:211]
ds_read_b64_tr_b16 v[68:69], v16 offset:12288
v_mfma_f32_16x16x32_bf16 v[212:215], v[100:103], v[84:87], v[212:215]
ds_read_b64_tr_b16 v[70:71], v16 offset:15360
v_mfma_f32_16x16x32_bf16 v[188:191], v[100:103], v[80:83], v[188:191]
ds_read_b128 v[36:39], v9 offset:50176
v_mfma_f32_16x16x32_bf16 v[164:167], v[100:103], v[76:79], v[164:167]
ds_read_b128 v[40:43], v9 offset:51200
v_mfma_f32_16x16x32_bf16 v[140:143], v[100:103], v[72:75], v[140:143]
ds_read_b128 v[44:47], v9 offset:52224
v_mfma_f32_16x16x32_bf16 v[144:147], v[104:107], v[72:75], v[144:147]
v_mfma_f32_16x16x32_bf16 v[168:171], v[104:107], v[76:79], v[168:171]
v_mfma_f32_16x16x32_bf16 v[192:195], v[104:107], v[80:83], v[192:195]
v_mfma_f32_16x16x32_bf16 v[216:219], v[104:107], v[84:87], v[216:219]
v_mfma_f32_16x16x32_bf16 v[220:223], v[108:111], v[84:87], v[220:223]
v_mfma_f32_16x16x32_bf16 v[196:199], v[108:111], v[80:83], v[196:199]
v_mfma_f32_16x16x32_bf16 v[172:175], v[108:111], v[76:79], v[172:175]
v_mfma_f32_16x16x32_bf16 v[148:151], v[108:111], v[72:75], v[148:151]
s_mov_b32 s41, 5
Lk3l_108:
s_waitcnt lgkmcnt(0)
v_mfma_f32_16x16x32_bf16 v[128:131], v[48:51], v[32:35], v[128:131]
ds_read_b128 v[72:75], v9 offset:57344
v_mfma_f32_16x16x32_bf16 v[152:155], v[48:51], v[36:39], v[152:155]
ds_read_b64_tr_b16 v[88:89], v14 offset:6144
v_mfma_f32_16x16x32_bf16 v[176:179], v[48:51], v[40:43], v[176:179]
ds_read_b64_tr_b16 v[90:91], v14 offset:9216
v_mfma_f32_16x16x32_bf16 v[200:203], v[48:51], v[44:47], v[200:203]
ds_read_b64_tr_b16 v[92:93], v15 offset:6144
v_mfma_f32_16x16x32_bf16 v[204:207], v[52:55], v[44:47], v[204:207]
ds_read_b64_tr_b16 v[94:95], v15 offset:9216
v_mfma_f32_16x16x32_bf16 v[180:183], v[52:55], v[40:43], v[180:183]
ds_read_b64_tr_b16 v[96:97], v16 offset:6144
v_mfma_f32_16x16x32_bf16 v[156:159], v[52:55], v[36:39], v[156:159]
ds_read_b64_tr_b16 v[98:99], v16 offset:9216
v_mfma_f32_16x16x32_bf16 v[132:135], v[52:55], v[32:35], v[132:135]
ds_read_b64_tr_b16 v[100:101], v14 offset:18432
v_mfma_f32_16x16x32_bf16 v[136:139], v[56:59], v[32:35], v[136:139]
ds_read_b64_tr_b16 v[102:103], v14 offset:21504
v_mfma_f32_16x16x32_bf16 v[160:163], v[56:59], v[36:39], v[160:163]
ds_read_b64_tr_b16 v[104:105], v15 offset:18432
v_mfma_f32_16x16x32_bf16 v[184:187], v[56:59], v[40:43], v[184:187]
ds_read_b64_tr_b16 v[106:107], v15 offset:21504
v_mfma_f32_16x16x32_bf16 v[208:211], v[56:59], v[44:47], v[208:211]
ds_read_b64_tr_b16 v[108:109], v16 offset:18432
v_mfma_f32_16x16x32_bf16 v[212:215], v[60:63], v[44:47], v[212:215]
ds_read_b64_tr_b16 v[110:111], v16 offset:21504
v_mfma_f32_16x16x32_bf16 v[188:191], v[60:63], v[40:43], v[188:191]
ds_read_b128 v[76:79], v9 offset:58368
v_mfma_f32_16x16x32_bf16 v[164:167], v[60:63], v[36:39], v[164:167]
ds_read_b128 v[80:83], v9 offset:59392
v_mfma_f32_16x16x32_bf16 v[140:143], v[60:63], v[32:35], v[140:143]
ds_read_b128 v[84:87], v9 offset:60416
v_mfma_f32_16x16x32_bf16 v[144:147], v[64:67], v[32:35], v[144:147]
v_mfma_f32_16x16x32_bf16 v[168:171], v[64:67], v[36:39], v[168:171]
v_mfma_f32_16x16x32_bf16 v[192:195], v[64:67], v[40:43], v[192:195]
v_mfma_f32_16x16x32_bf16 v[216:219], v[64:67], v[44:47], v[216:219]
v_mfma_f32_16x16x32_bf16 v[220:223], v[68:71], v[44:47], v[220:223]
v_mfma_f32_16x16x32_bf16 v[196:199], v[68:71], v[40:43], v[196:199]
v_mfma_f32_16x16x32_bf16 v[172:175], v[68:71], v[36:39], v[172:175]
v_mfma_f32_16x16x32_bf16 v[148:151], v[68:71], v[32:35], v[148:151]
s_waitcnt lgkmcnt(0)
s_barrier
v_mfma_f32_16x16x32_bf16 v[128:131], v[88:91], v[72:75], v[128:131]
ds_read_b128 v[32:35], v10 offset:0
v_mfma_f32_16x16x32_bf16 v[152:155], v[88:91], v[76:79], v[152:155]
ds_read_b64_tr_b16 v[48:49], v17 offset:0
v_mfma_f32_16x16x32_bf16 v[176:179], v[88:91], v[80:83], v[176:179]
ds_read_b64_tr_b16 v[50:51], v17 offset:3072
v_mfma_f32_16x16x32_bf16 v[200:203], v[88:91], v[84:87], v[200:203]
ds_read_b64_tr_b16 v[52:53], v18 offset:0
v_mfma_f32_16x16x32_bf16 v[204:207], v[92:95], v[84:87], v[204:207]
ds_read_b64_tr_b16 v[54:55], v18 offset:3072
v_mfma_f32_16x16x32_bf16 v[180:183], v[92:95], v[80:83], v[180:183]
ds_read_b64_tr_b16 v[56:57], v19 offset:0
v_mfma_f32_16x16x32_bf16 v[156:159], v[92:95], v[76:79], v[156:159]
ds_read_b64_tr_b16 v[58:59], v19 offset:3072
v_mfma_f32_16x16x32_bf16 v[132:135], v[92:95], v[72:75], v[132:135]
ds_read_b64_tr_b16 v[60:61], v17 offset:12288
v_mfma_f32_16x16x32_bf16 v[136:139], v[96:99], v[72:75], v[136:139]
ds_read_b64_tr_b16 v[62:63], v17 offset:15360
v_mfma_f32_16x16x32_bf16 v[160:163], v[96:99], v[76:79], v[160:163]
ds_read_b64_tr_b16 v[64:65], v18 offset:12288
v_mfma_f32_16x16x32_bf16 v[184:187], v[96:99], v[80:83], v[184:187]
ds_read_b64_tr_b16 v[66:67], v18 offset:15360
v_mfma_f32_16x16x32_bf16 v[208:211], v[96:99], v[84:87], v[208:211]
ds_read_b64_tr_b16 v[68:69], v19 offset:12288
v_mfma_f32_16x16x32_bf16 v[212:215], v[100:103], v[84:87], v[212:215]
ds_read_b64_tr_b16 v[70:71], v19 offset:15360
v_mfma_f32_16x16x32_bf16 v[188:191], v[100:103], v[80:83], v[188:191]
ds_read_b128 v[36:39], v10 offset:1024
v_mfma_f32_16x16x32_bf16 v[164:167], v[100:103], v[76:79], v[164:167]
ds_read_b128 v[40:43], v10 offset:2048
v_mfma_f32_16x16x32_bf16 v[140:143], v[100:103], v[72:75], v[140:143]
ds_read_b128 v[44:47], v10 offset:3072
v_mfma_f32_16x16x32_bf16 v[144:147], v[104:107], v[72:75], v[144:147]
v_mfma_f32_16x16x32_bf16 v[168:171], v[104:107], v[76:79], v[168:171]
v_mfma_f32_16x16x32_bf16 v[192:195], v[104:107], v[80:83], v[192:195]
v_mfma_f32_16x16x32_bf16 v[216:219], v[104:107], v[84:87], v[216:219]
v_mfma_f32_16x16x32_bf16 v[220:223], v[108:111], v[84:87], v[220:223]
v_mfma_f32_16x16x32_bf16 v[196:199], v[108:111], v[80:83], v[196:199]
v_mfma_f32_16x16x32_bf16 v[172:175], v[108:111], v[76:79], v[172:175]
v_mfma_f32_16x16x32_bf16 v[148:151], v[108:111], v[72:75], v[148:151]
s_waitcnt lgkmcnt(0)
v_mfma_f32_16x16x32_bf16 v[128:131], v[48:51], v[32:35], v[128:131]
ds_read_b128 v[72:75], v10 offset:8192
v_mfma_f32_16x16x32_bf16 v[152:155], v[48:51], v[36:39], v[152:155]
ds_read_b64_tr_b16 v[88:89], v17 offset:6144
v_mfma_f32_16x16x32_bf16 v[176:179], v[48:51], v[40:43], v[176:179]
ds_read_b64_tr_b16 v[90:91], v17 offset:9216
v_mfma_f32_16x16x32_bf16 v[200:203], v[48:51], v[44:47], v[200:203]
ds_read_b64_tr_b16 v[92:93], v18 offset:6144
v_mfma_f32_16x16x32_bf16 v[204:207], v[52:55], v[44:47], v[204:207]
ds_read_b64_tr_b16 v[94:95], v18 offset:9216
v_mfma_f32_16x16x32_bf16 v[180:183], v[52:55], v[40:43], v[180:183]
ds_read_b64_tr_b16 v[96:97], v19 offset:6144
v_mfma_f32_16x16x32_bf16 v[156:159], v[52:55], v[36:39], v[156:159]
ds_read_b64_tr_b16 v[98:99], v19 offset:9216
v_mfma_f32_16x16x32_bf16 v[132:135], v[52:55], v[32:35], v[132:135]
ds_read_b64_tr_b16 v[100:101], v17 offset:18432
v_mfma_f32_16x16x32_bf16 v[136:139], v[56:59], v[32:35], v[136:139]
ds_read_b64_tr_b16 v[102:103], v17 offset:21504
v_mfma_f32_16x16x32_bf16 v[160:163], v[56:59], v[36:39], v[160:163]
ds_read_b64_tr_b16 v[104:105], v18 offset:18432
v_mfma_f32_16x16x32_bf16 v[184:187], v[56:59], v[40:43], v[184:187]
ds_read_b64_tr_b16 v[106:107], v18 offset:21504
v_mfma_f32_16x16x32_bf16 v[208:211], v[56:59], v[44:47], v[208:211]
ds_read_b64_tr_b16 v[108:109], v19 offset:18432
v_mfma_f32_16x16x32_bf16 v[212:215], v[60:63], v[44:47], v[212:215]
ds_read_b64_tr_b16 v[110:111], v19 offset:21504
v_mfma_f32_16x16x32_bf16 v[188:191], v[60:63], v[40:43], v[188:191]
ds_read_b128 v[76:79], v10 offset:9216
v_mfma_f32_16x16x32_bf16 v[164:167], v[60:63], v[36:39], v[164:167]
ds_read_b128 v[80:83], v10 offset:10240
v_mfma_f32_16x16x32_bf16 v[140:143], v[60:63], v[32:35], v[140:143]
ds_read_b128 v[84:87], v10 offset:11264
v_mfma_f32_16x16x32_bf16 v[144:147], v[64:67], v[32:35], v[144:147]
v_mfma_f32_16x16x32_bf16 v[168:171], v[64:67], v[36:39], v[168:171]
v_mfma_f32_16x16x32_bf16 v[192:195], v[64:67], v[40:43], v[192:195]
v_mfma_f32_16x16x32_bf16 v[216:219], v[64:67], v[44:47], v[216:219]
v_mfma_f32_16x16x32_bf16 v[220:223], v[68:71], v[44:47], v[220:223]
v_mfma_f32_16x16x32_bf16 v[196:199], v[68:71], v[40:43], v[196:199]
v_mfma_f32_16x16x32_bf16 v[172:175], v[68:71], v[36:39], v[172:175]
v_mfma_f32_16x16x32_bf16 v[148:151], v[68:71], v[32:35], v[148:151]
s_waitcnt lgkmcnt(0)
s_barrier
v_mfma_f32_16x16x32_bf16 v[128:131], v[88:91], v[72:75], v[128:131]
ds_read_b128 v[32:35], v9 offset:0
v_mfma_f32_16x16x32_bf16 v[152:155], v[88:91], v[76:79], v[152:155]
ds_read_b64_tr_b16 v[48:49], v11 offset:0
v_mfma_f32_16x16x32_bf16 v[176:179], v[88:91], v[80:83], v[176:179]
ds_read_b64_tr_b16 v[50:51], v11 offset:3072
v_mfma_f32_16x16x32_bf16 v[200:203], v[88:91], v[84:87], v[200:203]
ds_read_b64_tr_b16 v[52:53], v12 offset:0
v_mfma_f32_16x16x32_bf16 v[204:207], v[92:95], v[84:87], v[204:207]
ds_read_b64_tr_b16 v[54:55], v12 offset:3072
v_mfma_f32_16x16x32_bf16 v[180:183], v[92:95], v[80:83], v[180:183]
ds_read_b64_tr_b16 v[56:57], v13 offset:0
v_mfma_f32_16x16x32_bf16 v[156:159], v[92:95], v[76:79], v[156:159]
ds_read_b64_tr_b16 v[58:59], v13 offset:3072
v_mfma_f32_16x16x32_bf16 v[132:135], v[92:95], v[72:75], v[132:135]
ds_read_b64_tr_b16 v[60:61], v11 offset:12288
v_mfma_f32_16x16x32_bf16 v[136:139], v[96:99], v[72:75], v[136:139]
ds_read_b64_tr_b16 v[62:63], v11 offset:15360
v_mfma_f32_16x16x32_bf16 v[160:163], v[96:99], v[76:79], v[160:163]
ds_read_b64_tr_b16 v[64:65], v12 offset:12288
v_mfma_f32_16x16x32_bf16 v[184:187], v[96:99], v[80:83], v[184:187]
ds_read_b64_tr_b16 v[66:67], v12 offset:15360
v_mfma_f32_16x16x32_bf16 v[208:211], v[96:99], v[84:87], v[208:211]
ds_read_b64_tr_b16 v[68:69], v13 offset:12288
v_mfma_f32_16x16x32_bf16 v[212:215], v[100:103], v[84:87], v[212:215]
ds_read_b64_tr_b16 v[70:71], v13 offset:15360
v_mfma_f32_16x16x32_bf16 v[188:191], v[100:103], v[80:83], v[188:191]
ds_read_b128 v[36:39], v9 offset:1024
v_mfma_f32_16x16x32_bf16 v[164:167], v[100:103], v[76:79], v[164:167]
ds_read_b128 v[40:43], v9 offset:2048
v_mfma_f32_16x16x32_bf16 v[140:143], v[100:103], v[72:75], v[140:143]
ds_read_b128 v[44:47], v9 offset:3072
v_mfma_f32_16x16x32_bf16 v[144:147], v[104:107], v[72:75], v[144:147]
v_mfma_f32_16x16x32_bf16 v[168:171], v[104:107], v[76:79], v[168:171]
v_mfma_f32_16x16x32_bf16 v[192:195], v[104:107], v[80:83], v[192:195]
v_mfma_f32_16x16x32_bf16 v[216:219], v[104:107], v[84:87], v[216:219]
v_mfma_f32_16x16x32_bf16 v[220:223], v[108:111], v[84:87], v[220:223]
v_mfma_f32_16x16x32_bf16 v[196:199], v[108:111], v[80:83], v[196:199]
v_mfma_f32_16x16x32_bf16 v[172:175], v[108:111], v[76:79], v[172:175]
v_mfma_f32_16x16x32_bf16 v[148:151], v[108:111], v[72:75], v[148:151]
s_waitcnt lgkmcnt(0)
v_mfma_f32_16x16x32_bf16 v[128:131], v[48:51], v[32:35], v[128:131]
ds_read_b128 v[72:75], v9 offset:8192
v_mfma_f32_16x16x32_bf16 v[152:155], v[48:51], v[36:39], v[152:155]
ds_read_b64_tr_b16 v[88:89], v11 offset:6144
v_mfma_f32_16x16x32_bf16 v[176:179], v[48:51], v[40:43], v[176:179]
ds_read_b64_tr_b16 v[90:91], v11 offset:9216
v_mfma_f32_16x16x32_bf16 v[200:203], v[48:51], v[44:47], v[200:203]
ds_read_b64_tr_b16 v[92:93], v12 offset:6144
v_mfma_f32_16x16x32_bf16 v[204:207], v[52:55], v[44:47], v[204:207]
ds_read_b64_tr_b16 v[94:95], v12 offset:9216
v_mfma_f32_16x16x32_bf16 v[180:183], v[52:55], v[40:43], v[180:183]
ds_read_b64_tr_b16 v[96:97], v13 offset:6144
v_mfma_f32_16x16x32_bf16 v[156:159], v[52:55], v[36:39], v[156:159]
ds_read_b64_tr_b16 v[98:99], v13 offset:9216
v_mfma_f32_16x16x32_bf16 v[132:135], v[52:55], v[32:35], v[132:135]
ds_read_b64_tr_b16 v[100:101], v11 offset:18432
v_mfma_f32_16x16x32_bf16 v[136:139], v[56:59], v[32:35], v[136:139]
ds_read_b64_tr_b16 v[102:103], v11 offset:21504
v_mfma_f32_16x16x32_bf16 v[160:163], v[56:59], v[36:39], v[160:163]
ds_read_b64_tr_b16 v[104:105], v12 offset:18432
v_mfma_f32_16x16x32_bf16 v[184:187], v[56:59], v[40:43], v[184:187]
ds_read_b64_tr_b16 v[106:107], v12 offset:21504
v_mfma_f32_16x16x32_bf16 v[208:211], v[56:59], v[44:47], v[208:211]
ds_read_b64_tr_b16 v[108:109], v13 offset:18432
v_mfma_f32_16x16x32_bf16 v[212:215], v[60:63], v[44:47], v[212:215]
ds_read_b64_tr_b16 v[110:111], v13 offset:21504
v_mfma_f32_16x16x32_bf16 v[188:191], v[60:63], v[40:43], v[188:191]
ds_read_b128 v[76:79], v9 offset:9216
v_mfma_f32_16x16x32_bf16 v[164:167], v[60:63], v[36:39], v[164:167]
ds_read_b128 v[80:83], v9 offset:10240
v_mfma_f32_16x16x32_bf16 v[140:143], v[60:63], v[32:35], v[140:143]
ds_read_b128 v[84:87], v9 offset:11264
v_mfma_f32_16x16x32_bf16 v[144:147], v[64:67], v[32:35], v[144:147]
v_mfma_f32_16x16x32_bf16 v[168:171], v[64:67], v[36:39], v[168:171]
v_mfma_f32_16x16x32_bf16 v[192:195], v[64:67], v[40:43], v[192:195]
v_mfma_f32_16x16x32_bf16 v[216:219], v[64:67], v[44:47], v[216:219]
v_mfma_f32_16x16x32_bf16 v[220:223], v[68:71], v[44:47], v[220:223]
v_mfma_f32_16x16x32_bf16 v[196:199], v[68:71], v[40:43], v[196:199]
v_mfma_f32_16x16x32_bf16 v[172:175], v[68:71], v[36:39], v[172:175]
v_mfma_f32_16x16x32_bf16 v[148:151], v[68:71], v[32:35], v[148:151]
s_waitcnt lgkmcnt(0)
s_barrier
v_mfma_f32_16x16x32_bf16 v[128:131], v[88:91], v[72:75], v[128:131]
ds_read_b128 v[32:35], v9 offset:49152
v_mfma_f32_16x16x32_bf16 v[152:155], v[88:91], v[76:79], v[152:155]
ds_read_b64_tr_b16 v[48:49], v14 offset:0
v_mfma_f32_16x16x32_bf16 v[176:179], v[88:91], v[80:83], v[176:179]
ds_read_b64_tr_b16 v[50:51], v14 offset:3072
v_mfma_f32_16x16x32_bf16 v[200:203], v[88:91], v[84:87], v[200:203]
ds_read_b64_tr_b16 v[52:53], v15 offset:0
v_mfma_f32_16x16x32_bf16 v[204:207], v[92:95], v[84:87], v[204:207]
ds_read_b64_tr_b16 v[54:55], v15 offset:3072
v_mfma_f32_16x16x32_bf16 v[180:183], v[92:95], v[80:83], v[180:183]
ds_read_b64_tr_b16 v[56:57], v16 offset:0
v_mfma_f32_16x16x32_bf16 v[156:159], v[92:95], v[76:79], v[156:159]
ds_read_b64_tr_b16 v[58:59], v16 offset:3072
v_mfma_f32_16x16x32_bf16 v[132:135], v[92:95], v[72:75], v[132:135]
ds_read_b64_tr_b16 v[60:61], v14 offset:12288
v_mfma_f32_16x16x32_bf16 v[136:139], v[96:99], v[72:75], v[136:139]
ds_read_b64_tr_b16 v[62:63], v14 offset:15360
v_mfma_f32_16x16x32_bf16 v[160:163], v[96:99], v[76:79], v[160:163]
ds_read_b64_tr_b16 v[64:65], v15 offset:12288
v_mfma_f32_16x16x32_bf16 v[184:187], v[96:99], v[80:83], v[184:187]
ds_read_b64_tr_b16 v[66:67], v15 offset:15360
v_mfma_f32_16x16x32_bf16 v[208:211], v[96:99], v[84:87], v[208:211]
ds_read_b64_tr_b16 v[68:69], v16 offset:12288
v_mfma_f32_16x16x32_bf16 v[212:215], v[100:103], v[84:87], v[212:215]
ds_read_b64_tr_b16 v[70:71], v16 offset:15360
v_mfma_f32_16x16x32_bf16 v[188:191], v[100:103], v[80:83], v[188:191]
ds_read_b128 v[36:39], v9 offset:50176
v_mfma_f32_16x16x32_bf16 v[164:167], v[100:103], v[76:79], v[164:167]
ds_read_b128 v[40:43], v9 offset:51200
v_mfma_f32_16x16x32_bf16 v[140:143], v[100:103], v[72:75], v[140:143]
ds_read_b128 v[44:47], v9 offset:52224
v_mfma_f32_16x16x32_bf16 v[144:147], v[104:107], v[72:75], v[144:147]
v_mfma_f32_16x16x32_bf16 v[168:171], v[104:107], v[76:79], v[168:171]
s_branch Lov_8
.p2align 12
.fill 64, 4, 0xbf800000
Lst_8_0:
s_branch Lwr_153
Lst_8_1:
s_branch Lwr_164
s_nop 0
Lov_8:
v_mfma_f32_16x16x32_bf16 v[192:195], v[104:107], v[80:83], v[192:195]
v_mfma_f32_16x16x32_bf16 v[216:219], v[104:107], v[84:87], v[216:219]
v_mfma_f32_16x16x32_bf16 v[220:223], v[108:111], v[84:87], v[220:223]
v_mfma_f32_16x16x32_bf16 v[196:199], v[108:111], v[80:83], v[196:199]
v_mfma_f32_16x16x32_bf16 v[172:175], v[108:111], v[76:79], v[172:175]
v_mfma_f32_16x16x32_bf16 v[148:151], v[108:111], v[72:75], v[148:151]
s_sub_u32 s41, s41, 1
s_cmp_lg_u32 s41, 0
s_cbranch_scc1 Lk3l_108
s_waitcnt lgkmcnt(0)
s_add_u32 s38, s35, 15
s_and_b32 s38, s38, 15
s_mul_i32 s38, s38, 458752
s_add_u32 m0, s40, 0
s_nop 0
buffer_load_dwordx4 v4, s[12:15], s38 offen lds
v_lshrrev_b32 v86, 4, v1
s_lshl_b32 s43, s63, 7
s_add_u32 s43, s43, 148992
v_lshl_add_u32 v87, v86, 4, s43
v_lshrrev_b32 v88, 1, v86
v_and_b32 v86, 1, v86
s_add_u32 m0, s40, 1024
s_nop 0
buffer_load_dwordx4 v5, s[12:15], s38 offen lds
s_lshl_b32 s43, s63, 5
s_add_u32 s43, s43, 149248
v_lshl_add_u32 v88, v88, 6, s43
v_lshl_add_u32 v88, v86, 4, v88
v_and_b32 v86, 15, v1
s_lshl_b32 s43, s62, 9
s_add_u32 m0, s40, 2048
s_add_u32 s38, s38, 57344
buffer_load_dwordx4 v4, s[12:15], s38 offen lds
s_add_u32 s43, s43, 147456
v_lshl_add_u32 v86, v86, 3, s43
ds_read_b128 v[32:35], v87 offset:0
ds_read_b128 v[36:39], v87 offset:64
ds_read_b128 v[40:43], v88 offset:0
ds_read_b128 v[44:47], v87 offset:896
s_add_u32 m0, s40, 3072
s_nop 0
buffer_load_dwordx4 v5, s[12:15], s38 offen lds
ds_read_b128 v[48:51], v87 offset:960
ds_read_b128 v[52:55], v88 offset:896
ds_read_b64 v[56:57], v86 offset:0
ds_read_b64 v[58:59], v86 offset:128
ds_read_b64 v[60:61], v86 offset:256
ds_read_b64 v[62:63], v86 offset:384
s_add_u32 m0, s40, 4096
s_add_u32 s38, s38, 57344
buffer_load_dwordx4 v4, s[12:15], s38 offen lds
s_mul_i32 s54, s35, 24576
s_lshl_b32 s43, s62, 12
s_add_u32 s54, s54, s43
s_add_u32 s54, s54, 524288
s_lshl_b32 s43, s63, 9
s_add_u32 s55, s54, s43
s_add_u32 m0, s40, 5120
s_nop 0
buffer_load_dwordx4 v5, s[12:15], s38 offen lds
s_add_u32 s55, s55, 16384
s_lshl_b32 s43, s63, 13
s_add_u32 s54, s54, s43
v_and_b32 v84, 32, v1
v_lshlrev_b32 v84, 4, v84
v_add_u32 v84, v84, v2
s_waitcnt lgkmcnt(0)
s_add_u32 m0, s40, 6144
s_add_u32 s38, s38, 57344
buffer_load_dwordx4 v4, s[12:15], s38 offen lds
s_add_u32 m0, s40, 7168
s_nop 0
buffer_load_dwordx4 v5, s[12:15], s38 offen lds
s_and_b32 s44, s36, 3
s_mul_i32 s43, s2, 28672
s_mul_i32 s44, s44, 7168
s_add_u32 s43, s43, s44
s_add_u32 s4, s76, s43
s_addc_u32 s5, s77, 0
s_barrier
s_cmp_eq_u32 s47, 3
s_cbranch_scc0 Lw_109
v_and_b32 v90, 31, v1
v_lshlrev_b32 v90, 4, v90
v_add_u32 v91, 153600, v90
ds_read_b128 v[108:111], v91 offset:0
ds_read_b128 v[112:115], v91 offset:512
ds_read_b128 v[116:119], v91 offset:1024
ds_read_b128 v[120:123], v91 offset:1536
s_and_b32 s44, s2, 15
s_mul_i32 s44, s44, 14336
s_lshr_b32 s43, s2, 4
s_lshl_b32 s43, s43, 9
s_add_u32 s44, s44, s43
s_waitcnt lgkmcnt(0)
v_add_f32 v108, v108, v112
v_add_f32 v116, v116, v120
v_add_f32 v109, v109, v113
v_add_f32 v117, v117, v121
v_add_f32 v110, v110, v114
v_add_f32 v118, v118, v122
v_add_f32 v111, v111, v115
v_add_f32 v119, v119, v123
v_add_f32 v108, v108, v116
v_add_f32 v109, v109, v117
v_add_f32 v110, v110, v118
v_add_f32 v111, v111, v119
s_mov_b64 exec, 0xffffffff
buffer_store_dwordx4 v[108:111], v90, s[84:87], s44 offen sc1
s_mov_b64 exec, -1
Lw_109:
s_waitcnt lgkmcnt(0)
s_add_u32 s37, s35, 0
s_and_b32 s37, s37, 15
s_mul_i32 s37, s37, 16384
s_add_u32 m0, s39, 49152
s_nop 0
buffer_load_dwordx4 v3, s[8:11], s37 offen sc1 lds
s_load_dword s3, s[4:5], 1792
s_load_dword s3, s[4:5], 1856
s_load_dword s3, s[4:5], 1920
s_load_dword s3, s[4:5], 1984
s_load_dword s3, s[4:5], 2048
s_load_dword s3, s[4:5], 2112
s_load_dword s3, s[4:5], 2176
buffer_load_dwordx4 v3, s[8:11], s37 offen offset:1024 sc1 lds
s_load_dword s3, s[4:5], 2240
s_load_dword s3, s[4:5], 2304
s_load_dword s3, s[4:5], 2368
s_load_dword s3, s[4:5], 2432
s_load_dword s3, s[4:5], 2496
s_load_dword s3, s[4:5], 2560
s_load_dword s3, s[4:5], 2624
buffer_load_dwordx4 v3, s[8:11], s37 offen offset:2048 sc1 lds
v_mul_f32 v66, v57, v57
v_mul_f32 v64, 0xc0135761, v57
v_mul_f32 v65, 0xbdd2d3e8, v57
v_mul_f32 v65, v65, v66
v_rcp_f32 v66, v66
v_mul_f32 v70, v59, v59
v_mul_f32 v68, 0xc0135761, v59
buffer_load_dwordx4 v3, s[8:11], s37 offen offset:3072 sc1 lds
v_mul_f32 v69, 0xbdd2d3e8, v59
v_mul_f32 v69, v69, v70
v_rcp_f32 v70, v70
v_fma_f32 v128, -v56, v32, v128
v_fma_f32 v129, -v56, v33, v129
v_fma_f32 v130, -v56, v34, v130
v_fma_f32 v131, -v56, v35, v131
v_fma_f32 v152, -v58, v32, v152
s_add_u32 s38, s35, 0
s_and_b32 s38, s38, 15
s_mul_i32 s38, s38, 458752
s_add_u32 m0, s40, 49152
s_nop 0
buffer_load_dwordx4 v4, s[12:15], s38 offen lds
v_fma_f32 v153, -v58, v33, v153
v_fma_f32 v154, -v58, v34, v154
v_fma_f32 v155, -v58, v35, v155
v_mul_f32 v72, v128, v128
v_mul_f32 v73, v129, v129
v_mul_f32 v74, v130, v130
v_mul_f32 v75, v131, v131
s_add_u32 m0, s40, 50176
s_nop 0
buffer_load_dwordx4 v5, s[12:15], s38 offen lds
v_mul_f32 v76, v152, v152
v_mul_f32 v77, v153, v153
v_mul_f32 v78, v154, v154
v_mul_f32 v79, v155, v155
v_fma_f32 v72, v72, v65, v64
v_fma_f32 v73, v73, v65, v64
v_fma_f32 v74, v74, v65, v64
s_add_u32 m0, s40, 51200
s_add_u32 s38, s38, 57344
buffer_load_dwordx4 v4, s[12:15], s38 offen lds
v_fma_f32 v75, v75, v65, v64
v_fma_f32 v76, v76, v69, v68
v_fma_f32 v77, v77, v69, v68
v_fma_f32 v78, v78, v69, v68
v_fma_f32 v79, v79, v69, v68
v_mul_f32 v72, v72, v128
v_mul_f32 v73, v73, v129
v_mul_f32 v74, v74, v130
s_add_u32 m0, s40, 52224
s_nop 0
buffer_load_dwordx4 v5, s[12:15], s38 offen lds
v_mul_f32 v75, v75, v131
v_mul_f32 v76, v76, v152
v_mul_f32 v77, v77, v153
v_mul_f32 v78, v78, v154
v_mul_f32 v79, v79, v155
v_exp_f32 v72, v72
v_exp_f32 v73, v73
s_add_u32 m0, s40, 53248
s_add_u32 s38, s38, 57344
buffer_load_dwordx4 v4, s[12:15], s38 offen lds
v_exp_f32 v74, v74
v_exp_f32 v75, v75
v_exp_f32 v76, v76
v_exp_f32 v77, v77
v_exp_f32 v78, v78
v_exp_f32 v79, v79
v_fma_f32 v140, -v56, v44, v140
s_add_u32 m0, s40, 54272
s_nop 0
buffer_load_dwordx4 v5, s[12:15], s38 offen lds
v_fma_f32 v141, -v56, v45, v141
v_fma_f32 v142, -v56, v46, v142
v_fma_f32 v143, -v56, v47, v143
v_fma_f32 v164, -v58, v44, v164
v_fma_f32 v165, -v58, v45, v165
v_fma_f32 v166, -v58, v46, v166
v_fma_f32 v167, -v58, v47, v167
v_fma_f32 v72, v72, v66, v66
s_add_u32 m0, s40, 55296
s_add_u32 s38, s38, 57344
buffer_load_dwordx4 v4, s[12:15], s38 offen lds
s_add_u32 m0, s40, 56320
s_nop 0
buffer_load_dwordx4 v5, s[12:15], s38 offen lds
s_waitcnt vmcnt(12)
s_barrier
s_add_u32 s37, s35, 1
s_and_b32 s37, s37, 15
s_mul_i32 s37, s37, 16384
s_add_u32 m0, s39, 98304
s_nop 0
buffer_load_dwordx4 v3, s[8:11], s37 offen sc1 lds
v_fma_f32 v73, v73, v66, v66
v_fma_f32 v74, v74, v66, v66
v_fma_f32 v75, v75, v66, v66
v_fma_f32 v76, v76, v70, v70
v_fma_f32 v77, v77, v70, v70
v_fma_f32 v78, v78, v70, v70
buffer_load_dwordx4 v3, s[8:11], s37 offen offset:1024 sc1 lds
v_fma_f32 v79, v79, v70, v70
v_rcp_f32 v72, v72
v_rcp_f32 v73, v73
v_rcp_f32 v74, v74
v_rcp_f32 v75, v75
v_rcp_f32 v76, v76
buffer_load_dwordx4 v3, s[8:11], s37 offen offset:2048 sc1 lds
v_rcp_f32 v77, v77
v_rcp_f32 v78, v78
v_rcp_f32 v79, v79
v_mul_f32 v140, v128, v140
v_mul_f32 v141, v129, v141
v_mul_f32 v142, v130, v142
buffer_load_dwordx4 v3, s[8:11], s37 offen offset:3072 sc1 lds
v_mul_f32 v143, v131, v143
v_mul_f32 v164, v152, v164
v_mul_f32 v165, v153, v165
v_mul_f32 v166, v154, v166
v_mul_f32 v167, v155, v167
v_mul_f32 v140, v140, v72
s_add_u32 s38, s35, 1
s_and_b32 s38, s38, 15
s_mul_i32 s38, s38, 458752
s_add_u32 m0, s40, 98304
s_nop 0
buffer_load_dwordx4 v4, s[12:15], s38 offen lds
v_mul_f32 v141, v141, v73
v_mul_f32 v142, v142, v74
v_mul_f32 v143, v143, v75
v_mul_f32 v164, v164, v76
v_mul_f32 v165, v165, v77
v_mul_f32 v166, v166, v78
s_add_u32 m0, s40, 99328
s_nop 0
buffer_load_dwordx4 v5, s[12:15], s38 offen lds
v_mul_f32 v167, v167, v79
v_cvt_pk_bf16_f32 v128, v140, v141
v_cvt_pk_bf16_f32 v129, v142, v143
v_cvt_pk_bf16_f32 v152, v164, v165
v_cvt_pk_bf16_f32 v153, v166, v167
v_fma_f32 v132, -v56, v36, v132
s_add_u32 m0, s40, 100352
s_add_u32 s38, s38, 57344
buffer_load_dwordx4 v4, s[12:15], s38 offen lds
v_fma_f32 v133, -v56, v37, v133
v_fma_f32 v134, -v56, v38, v134
v_fma_f32 v135, -v56, v39, v135
v_fma_f32 v156, -v58, v36, v156
v_fma_f32 v157, -v58, v37, v157
v_fma_f32 v158, -v58, v38, v158
s_add_u32 m0, s40, 101376
s_nop 0
buffer_load_dwordx4 v5, s[12:15], s38 offen lds
v_fma_f32 v159, -v58, v39, v159
v_mul_f32 v72, v132, v132
v_mul_f32 v73, v133, v133
v_mul_f32 v74, v134, v134
v_mul_f32 v75, v135, v135
v_mul_f32 v76, v156, v156
s_add_u32 m0, s40, 102400
s_add_u32 s38, s38, 57344
buffer_load_dwordx4 v4, s[12:15], s38 offen lds
v_mul_f32 v77, v157, v157
v_mul_f32 v78, v158, v158
v_mul_f32 v79, v159, v159
v_fma_f32 v72, v72, v65, v64
v_fma_f32 v73, v73, v65, v64
v_fma_f32 v74, v74, v65, v64
s_add_u32 m0, s40, 103424
s_nop 0
buffer_load_dwordx4 v5, s[12:15], s38 offen lds
v_fma_f32 v75, v75, v65, v64
v_fma_f32 v76, v76, v69, v68
v_fma_f32 v77, v77, v69, v68
v_fma_f32 v78, v78, v69, v68
v_fma_f32 v79, v79, v69, v68
v_mul_f32 v72, v72, v132
s_add_u32 m0, s40, 104448
s_add_u32 s38, s38, 57344
buffer_load_dwordx4 v4, s[12:15], s38 offen lds
s_add_u32 m0, s40, 105472
s_nop 0
buffer_load_dwordx4 v5, s[12:15], s38 offen lds
s_waitcnt vmcnt(12)
s_barrier
s_cmp_eq_u32 s47, 3
s_cbranch_scc0 Lw_110
s_lshr_b32 s43, s2, 4
s_add_u32 s43, s43, 80
s_lshl_b32 s43, s43, 7
v_mov_b32 v90, s43
v_mov_b32 v91, 1
s_mov_b64 exec, 1
buffer_atomic_add v91, v90, s[56:59], 0 offen sc1
s_mov_b64 exec, -1
Lw_110:
s_waitcnt lgkmcnt(0)
s_add_u32 s37, s35, 2
s_and_b32 s37, s37, 15
s_mul_i32 s37, s37, 16384
s_add_u32 m0, s39, 0
s_nop 0
buffer_load_dwordx4 v3, s[8:11], s37 offen sc1 lds
s_load_dword s3, s[4:5], 2688
s_load_dword s3, s[4:5], 2752
s_load_dword s3, s[4:5], 2816
s_load_dword s3, s[4:5], 2880
s_load_dword s3, s[4:5], 2944
s_load_dword s3, s[4:5], 3008
s_load_dword s3, s[4:5], 3072
buffer_load_dwordx4 v3, s[8:11], s37 offen offset:1024 sc1 lds
s_load_dword s3, s[4:5], 3136
s_load_dword s3, s[4:5], 3200
s_load_dword s3, s[4:5], 3264
s_load_dword s3, s[4:5], 3328
s_load_dword s3, s[4:5], 3392
s_load_dword s3, s[4:5], 3456
s_load_dword s3, s[4:5], 3520
buffer_load_dwordx4 v3, s[8:11], s37 offen offset:2048 sc1 lds
v_mul_f32 v73, v73, v133
v_mul_f32 v74, v74, v134
v_mul_f32 v75, v75, v135
v_mul_f32 v76, v76, v156
v_mul_f32 v77, v77, v157
v_mul_f32 v78, v78, v158
v_mul_f32 v79, v79, v159
v_exp_f32 v72, v72
buffer_load_dwordx4 v3, s[8:11], s37 offen offset:3072 sc1 lds
v_exp_f32 v73, v73
v_exp_f32 v74, v74
v_exp_f32 v75, v75
v_exp_f32 v76, v76
v_exp_f32 v77, v77
v_exp_f32 v78, v78
v_exp_f32 v79, v79
s_add_u32 s38, s35, 2
s_and_b32 s38, s38, 15
s_mul_i32 s38, s38, 458752
s_add_u32 m0, s40, 0
s_nop 0
buffer_load_dwordx4 v4, s[12:15], s38 offen lds
v_fma_f32 v144, -v56, v48, v144
v_fma_f32 v145, -v56, v49, v145
v_fma_f32 v146, -v56, v50, v146
v_fma_f32 v147, -v56, v51, v147
v_fma_f32 v168, -v58, v48, v168
v_fma_f32 v169, -v58, v49, v169
v_fma_f32 v170, -v58, v50, v170
v_fma_f32 v171, -v58, v51, v171
s_add_u32 m0, s40, 1024
s_nop 0
buffer_load_dwordx4 v5, s[12:15], s38 offen lds
v_fma_f32 v72, v72, v66, v66
v_fma_f32 v73, v73, v66, v66
v_fma_f32 v74, v74, v66, v66
v_fma_f32 v75, v75, v66, v66
v_fma_f32 v76, v76, v70, v70
v_fma_f32 v77, v77, v70, v70
v_fma_f32 v78, v78, v70, v70
s_add_u32 m0, s40, 2048
s_add_u32 s38, s38, 57344
buffer_load_dwordx4 v4, s[12:15], s38 offen lds
v_fma_f32 v79, v79, v70, v70
v_rcp_f32 v72, v72
v_rcp_f32 v73, v73
v_rcp_f32 v74, v74
v_rcp_f32 v75, v75
v_rcp_f32 v76, v76
v_rcp_f32 v77, v77
s_add_u32 m0, s40, 3072
s_nop 0
buffer_load_dwordx4 v5, s[12:15], s38 offen lds
v_rcp_f32 v78, v78
v_rcp_f32 v79, v79
v_mul_f32 v144, v132, v144
v_mul_f32 v145, v133, v145
v_mul_f32 v146, v134, v146
v_mul_f32 v147, v135, v147
v_mul_f32 v168, v156, v168
v_mul_f32 v169, v157, v169
s_add_u32 m0, s40, 4096
s_add_u32 s38, s38, 57344
buffer_load_dwordx4 v4, s[12:15], s38 offen lds
v_mul_f32 v170, v158, v170
v_mul_f32 v171, v159, v171
v_mul_f32 v144, v144, v72
v_mul_f32 v145, v145, v73
v_mul_f32 v146, v146, v74
v_mul_f32 v147, v147, v75
v_mul_f32 v168, v168, v76
s_add_u32 m0, s40, 5120
s_nop 0
buffer_load_dwordx4 v5, s[12:15], s38 offen lds
v_mul_f32 v169, v169, v77
v_mul_f32 v170, v170, v78
v_mul_f32 v171, v171, v79
v_cvt_pk_bf16_f32 v130, v144, v145
v_cvt_pk_bf16_f32 v131, v146, v147
v_cvt_pk_bf16_f32 v154, v168, v169
v_cvt_pk_bf16_f32 v155, v170, v171
buffer_store_dwordx4 v[128:131], v2, s[24:27], s54 offen offset:0 sc1
s_add_u32 m0, s40, 6144
s_add_u32 s38, s38, 57344
buffer_load_dwordx4 v4, s[12:15], s38 offen lds
s_add_u32 m0, s40, 7168
s_nop 0
buffer_load_dwordx4 v5, s[12:15], s38 offen lds
s_waitcnt vmcnt(13)
s_barrier
s_add_u32 s37, s35, 3
s_and_b32 s37, s37, 15
s_mul_i32 s37, s37, 16384
s_add_u32 m0, s39, 49152
s_nop 0
buffer_load_dwordx4 v3, s[8:11], s37 offen sc1 lds
buffer_store_dwordx4 v[152:155], v2, s[24:27], s54 offen offset:1024 sc1
v_fma_f32 v136, -v56, v40, v136
v_fma_f32 v137, -v56, v41, v137
v_fma_f32 v138, -v56, v42, v138
v_fma_f32 v139, -v56, v43, v139
v_fma_f32 v160, -v58, v40, v160
buffer_load_dwordx4 v3, s[8:11], s37 offen offset:1024 sc1 lds
v_fma_f32 v161, -v58, v41, v161
v_fma_f32 v162, -v58, v42, v162
v_fma_f32 v163, -v58, v43, v163
v_mul_f32 v72, v136, v136
v_mul_f32 v73, v137, v137
v_mul_f32 v74, v138, v138
buffer_load_dwordx4 v3, s[8:11], s37 offen offset:2048 sc1 lds
v_mul_f32 v75, v139, v139
v_mul_f32 v76, v160, v160
v_mul_f32 v77, v161, v161
v_mul_f32 v78, v162, v162
v_mul_f32 v79, v163, v163
v_fma_f32 v72, v72, v65, v64
buffer_load_dwordx4 v3, s[8:11], s37 offen offset:3072 sc1 lds
v_fma_f32 v73, v73, v65, v64
v_fma_f32 v74, v74, v65, v64
v_fma_f32 v75, v75, v65, v64
v_fma_f32 v76, v76, v69, v68
v_fma_f32 v77, v77, v69, v68
v_fma_f32 v78, v78, v69, v68
s_add_u32 s38, s35, 3
s_and_b32 s38, s38, 15
s_mul_i32 s38, s38, 458752
s_add_u32 m0, s40, 49152
s_nop 0
buffer_load_dwordx4 v4, s[12:15], s38 offen lds
v_fma_f32 v79, v79, v69, v68
v_mul_f32 v72, v72, v136
v_mul_f32 v73, v73, v137
v_mul_f32 v74, v74, v138
v_mul_f32 v75, v75, v139
v_mul_f32 v76, v76, v160
s_add_u32 m0, s40, 50176
s_nop 0
buffer_load_dwordx4 v5, s[12:15], s38 offen lds
v_mul_f32 v77, v77, v161
v_mul_f32 v78, v78, v162
v_mul_f32 v79, v79, v163
v_exp_f32 v72, v72
v_exp_f32 v73, v73
v_exp_f32 v74, v74
s_add_u32 m0, s40, 51200
s_add_u32 s38, s38, 57344
buffer_load_dwordx4 v4, s[12:15], s38 offen lds
v_exp_f32 v75, v75
v_exp_f32 v76, v76
v_exp_f32 v77, v77
v_exp_f32 v78, v78
v_exp_f32 v79, v79
v_fma_f32 v148, -v56, v52, v148
s_add_u32 m0, s40, 52224
s_nop 0
buffer_load_dwordx4 v5, s[12:15], s38 offen lds
v_fma_f32 v149, -v56, v53, v149
v_fma_f32 v150, -v56, v54, v150
v_fma_f32 v151, -v56, v55, v151
v_fma_f32 v172, -v58, v52, v172
v_fma_f32 v173, -v58, v53, v173
v_fma_f32 v174, -v58, v54, v174
s_add_u32 m0, s40, 53248
s_add_u32 s38, s38, 57344
buffer_load_dwordx4 v4, s[12:15], s38 offen lds
v_fma_f32 v175, -v58, v55, v175
v_fma_f32 v72, v72, v66, v66
v_fma_f32 v73, v73, v66, v66
v_fma_f32 v74, v74, v66, v66
v_fma_f32 v75, v75, v66, v66
v_fma_f32 v76, v76, v70, v70
s_add_u32 m0, s40, 54272
s_nop 0
buffer_load_dwordx4 v5, s[12:15], s38 offen lds
v_fma_f32 v77, v77, v70, v70
v_fma_f32 v78, v78, v70, v70
v_fma_f32 v79, v79, v70, v70
v_rcp_f32 v72, v72
v_rcp_f32 v73, v73
v_rcp_f32 v74, v74
s_add_u32 m0, s40, 55296
s_add_u32 s38, s38, 57344
buffer_load_dwordx4 v4, s[12:15], s38 offen lds
s_add_u32 m0, s40, 56320
s_nop 0
buffer_load_dwordx4 v5, s[12:15], s38 offen lds
s_waitcnt vmcnt(13)
s_barrier
s_waitcnt lgkmcnt(0)
s_add_u32 s37, s35, 4
s_and_b32 s37, s37, 15
s_mul_i32 s37, s37, 16384
s_add_u32 m0, s39, 98304
s_nop 0
buffer_load_dwordx4 v3, s[8:11], s37 offen sc1 lds
s_load_dword s3, s[4:5], 3584
s_load_dword s3, s[4:5], 3648
s_load_dword s3, s[4:5], 3712
s_load_dword s3, s[4:5], 3776
s_load_dword s3, s[4:5], 3840
s_load_dword s3, s[4:5], 3904
s_load_dword s3, s[4:5], 3968
buffer_load_dwordx4 v3, s[8:11], s37 offen offset:1024 sc1 lds
s_load_dword s3, s[4:5], 4032
s_load_dword s3, s[4:5], 4096
s_load_dword s3, s[4:5], 4160
s_load_dword s3, s[4:5], 4224
s_load_dword s3, s[4:5], 4288
s_load_dword s3, s[4:5], 4352
s_load_dword s3, s[4:5], 4416
buffer_load_dwordx4 v3, s[8:11], s37 offen offset:2048 sc1 lds
v_rcp_f32 v75, v75
v_rcp_f32 v76, v76
v_rcp_f32 v77, v77
v_rcp_f32 v78, v78
v_rcp_f32 v79, v79
v_mul_f32 v148, v136, v148
v_mul_f32 v149, v137, v149
buffer_load_dwordx4 v3, s[8:11], s37 offen offset:3072 sc1 lds
v_mul_f32 v150, v138, v150
v_mul_f32 v151, v139, v151
v_mul_f32 v172, v160, v172
v_mul_f32 v173, v161, v173
v_mul_f32 v174, v162, v174
v_mul_f32 v175, v163, v175
v_mul_f32 v148, v148, v72
v_mul_f32 v149, v149, v73
s_add_u32 s38, s35, 4
s_and_b32 s38, s38, 15
s_mul_i32 s38, s38, 458752
s_add_u32 m0, s40, 98304
s_nop 0
buffer_load_dwordx4 v4, s[12:15], s38 offen lds
v_mul_f32 v150, v150, v74
v_mul_f32 v151, v151, v75
v_mul_f32 v172, v172, v76
v_mul_f32 v173, v173, v77
v_mul_f32 v174, v174, v78
v_mul_f32 v175, v175, v79
v_cvt_pk_bf16_f32 v80, v148, v149
s_add_u32 m0, s40, 99328
s_nop 0
buffer_load_dwordx4 v5, s[12:15], s38 offen lds
v_cvt_pk_bf16_f32 v81, v150, v151
v_cvt_pk_bf16_f32 v82, v172, v173
v_cvt_pk_bf16_f32 v83, v174, v175
s_nop 1
v_permlane32_swap_b32 v80, v82
v_permlane32_swap_b32 v81, v83
buffer_store_dwordx4 v[80:83], v84, s[24:27], s55 offen offset:0 sc1
s_add_u32 m0, s40, 100352
s_add_u32 s38, s38, 57344
buffer_load_dwordx4 v4, s[12:15], s38 offen lds
s_nop 1
v_mul_f32 v66, v61, v61
v_mul_f32 v64, 0xc0135761, v61
v_mul_f32 v65, 0xbdd2d3e8, v61
v_mul_f32 v65, v65, v66
v_rcp_f32 v66, v66
v_mul_f32 v70, v63, v63
v_mul_f32 v68, 0xc0135761, v63
s_add_u32 m0, s40, 101376
s_nop 0
buffer_load_dwordx4 v5, s[12:15], s38 offen lds
v_mul_f32 v69, 0xbdd2d3e8, v63
v_mul_f32 v69, v69, v70
s_branch Lov_9
.p2align 12
.fill 64, 4, 0xbf800000
Lst_9_0:
s_branch Lwr_154
Lst_9_1:
s_branch Lwr_165
s_nop 0
Lov_9:
v_rcp_f32 v70, v70
v_fma_f32 v176, -v60, v32, v176
v_fma_f32 v177, -v60, v33, v177
v_fma_f32 v178, -v60, v34, v178
v_fma_f32 v179, -v60, v35, v179
s_add_u32 m0, s40, 102400
s_add_u32 s38, s38, 57344
buffer_load_dwordx4 v4, s[12:15], s38 offen lds
v_fma_f32 v200, -v62, v32, v200
v_fma_f32 v201, -v62, v33, v201
v_fma_f32 v202, -v62, v34, v202
v_fma_f32 v203, -v62, v35, v203
v_mul_f32 v72, v176, v176
v_mul_f32 v73, v177, v177
v_mul_f32 v74, v178, v178
s_add_u32 m0, s40, 103424
s_nop 0
buffer_load_dwordx4 v5, s[12:15], s38 offen lds
v_mul_f32 v75, v179, v179
v_mul_f32 v76, v200, v200
v_mul_f32 v77, v201, v201
v_mul_f32 v78, v202, v202
v_mul_f32 v79, v203, v203
v_fma_f32 v72, v72, v65, v64
v_fma_f32 v73, v73, v65, v64
v_fma_f32 v74, v74, v65, v64
s_add_u32 m0, s40, 104448
s_add_u32 s38, s38, 57344
buffer_load_dwordx4 v4, s[12:15], s38 offen lds
s_add_u32 m0, s40, 105472
s_nop 0
buffer_load_dwordx4 v5, s[12:15], s38 offen lds
s_waitcnt vmcnt(13)
s_barrier
s_add_u32 s37, s35, 5
s_and_b32 s37, s37, 15
s_mul_i32 s37, s37, 16384
s_add_u32 m0, s39, 0
s_nop 0
buffer_load_dwordx4 v3, s[8:11], s37 offen sc1 lds
v_fma_f32 v75, v75, v65, v64
v_fma_f32 v76, v76, v69, v68
v_fma_f32 v77, v77, v69, v68
v_fma_f32 v78, v78, v69, v68
v_fma_f32 v79, v79, v69, v68
v_mul_f32 v72, v72, v176
buffer_load_dwordx4 v3, s[8:11], s37 offen offset:1024 sc1 lds
v_mul_f32 v73, v73, v177
v_mul_f32 v74, v74, v178
v_mul_f32 v75, v75, v179
v_mul_f32 v76, v76, v200
v_mul_f32 v77, v77, v201
v_mul_f32 v78, v78, v202
buffer_load_dwordx4 v3, s[8:11], s37 offen offset:2048 sc1 lds
v_mul_f32 v79, v79, v203
v_exp_f32 v72, v72
v_exp_f32 v73, v73
v_exp_f32 v74, v74
v_exp_f32 v75, v75
v_exp_f32 v76, v76
buffer_load_dwordx4 v3, s[8:11], s37 offen offset:3072 sc1 lds
v_exp_f32 v77, v77
v_exp_f32 v78, v78
v_exp_f32 v79, v79
v_fma_f32 v188, -v60, v44, v188
v_fma_f32 v189, -v60, v45, v189
v_fma_f32 v190, -v60, v46, v190
s_add_u32 s38, s35, 5
s_and_b32 s38, s38, 15
s_mul_i32 s38, s38, 458752
s_add_u32 m0, s40, 0
s_nop 0
buffer_load_dwordx4 v4, s[12:15], s38 offen lds
v_fma_f32 v191, -v60, v47, v191
v_fma_f32 v212, -v62, v44, v212
v_fma_f32 v213, -v62, v45, v213
v_fma_f32 v214, -v62, v46, v214
v_fma_f32 v215, -v62, v47, v215
v_fma_f32 v72, v72, v66, v66
s_add_u32 m0, s40, 1024
s_nop 0
buffer_load_dwordx4 v5, s[12:15], s38 offen lds
v_fma_f32 v73, v73, v66, v66
v_fma_f32 v74, v74, v66, v66
v_fma_f32 v75, v75, v66, v66
v_fma_f32 v76, v76, v70, v70
v_fma_f32 v77, v77, v70, v70
v_fma_f32 v78, v78, v70, v70
s_add_u32 m0, s40, 2048
s_add_u32 s38, s38, 57344
buffer_load_dwordx4 v4, s[12:15], s38 offen lds
v_fma_f32 v79, v79, v70, v70
v_rcp_f32 v72, v72
v_rcp_f32 v73, v73
v_rcp_f32 v74, v74
v_rcp_f32 v75, v75
v_rcp_f32 v76, v76
s_add_u32 m0, s40, 3072
s_nop 0
buffer_load_dwordx4 v5, s[12:15], s38 offen lds
v_rcp_f32 v77, v77
v_rcp_f32 v78, v78
v_rcp_f32 v79, v79
v_mul_f32 v188, v176, v188
v_mul_f32 v189, v177, v189
v_mul_f32 v190, v178, v190
s_add_u32 m0, s40, 4096
s_add_u32 s38, s38, 57344
buffer_load_dwordx4 v4, s[12:15], s38 offen lds
v_mul_f32 v191, v179, v191
v_mul_f32 v212, v200, v212
v_mul_f32 v213, v201, v213
v_mul_f32 v214, v202, v214
v_mul_f32 v215, v203, v215
v_mul_f32 v188, v188, v72
s_add_u32 m0, s40, 5120
s_nop 0
buffer_load_dwordx4 v5, s[12:15], s38 offen lds
v_mul_f32 v189, v189, v73
v_mul_f32 v190, v190, v74
v_mul_f32 v191, v191, v75
v_mul_f32 v212, v212, v76
v_mul_f32 v213, v213, v77
v_mul_f32 v214, v214, v78
s_add_u32 m0, s40, 6144
s_add_u32 s38, s38, 57344
buffer_load_dwordx4 v4, s[12:15], s38 offen lds
s_add_u32 m0, s40, 7168
s_nop 0
buffer_load_dwordx4 v5, s[12:15], s38 offen lds
s_waitcnt vmcnt(12)
s_barrier
s_waitcnt lgkmcnt(0)
s_cmp_eq_u32 s47, 3
s_cbranch_scc0 Lw_111
s_lshl_b32 s60, s35, 7
s_add_u32 s60, s60, 28321792
s_mov_b32 s61, s60
s_load_dword s92, s[82:83], s60 glc
s_load_dword s93, s[82:83], s61 glc
Lw_111:
s_add_u32 s37, s35, 6
s_and_b32 s37, s37, 15
s_mul_i32 s37, s37, 16384
s_add_u32 m0, s39, 49152
s_nop 0
buffer_load_dwordx4 v3, s[8:11], s37 offen sc1 lds
s_load_dword s3, s[4:5], 4480
s_load_dword s3, s[4:5], 4544
s_load_dword s3, s[4:5], 4608
s_load_dword s3, s[4:5], 4672
s_load_dword s3, s[4:5], 4736
s_load_dword s3, s[4:5], 4800
s_load_dword s3, s[4:5], 4864
buffer_load_dwordx4 v3, s[8:11], s37 offen offset:1024 sc1 lds
s_load_dword s3, s[4:5], 4928
s_load_dword s3, s[4:5], 4992
s_load_dword s3, s[4:5], 5056
s_load_dword s3, s[4:5], 5120
s_load_dword s3, s[4:5], 5184
s_load_dword s3, s[4:5], 5248
s_load_dword s3, s[4:5], 5312
buffer_load_dwordx4 v3, s[8:11], s37 offen offset:2048 sc1 lds
v_mul_f32 v215, v215, v79
v_cvt_pk_bf16_f32 v176, v188, v189
v_cvt_pk_bf16_f32 v177, v190, v191
v_cvt_pk_bf16_f32 v200, v212, v213
v_cvt_pk_bf16_f32 v201, v214, v215
v_fma_f32 v180, -v60, v36, v180
v_fma_f32 v181, -v60, v37, v181
v_fma_f32 v182, -v60, v38, v182
buffer_load_dwordx4 v3, s[8:11], s37 offen offset:3072 sc1 lds
v_fma_f32 v183, -v60, v39, v183
v_fma_f32 v204, -v62, v36, v204
v_fma_f32 v205, -v62, v37, v205
v_fma_f32 v206, -v62, v38, v206
v_fma_f32 v207, -v62, v39, v207
v_mul_f32 v72, v180, v180
v_mul_f32 v73, v181, v181
s_add_u32 s38, s35, 6
s_and_b32 s38, s38, 15
s_mul_i32 s38, s38, 458752
s_add_u32 m0, s40, 49152
s_nop 0
buffer_load_dwordx4 v4, s[12:15], s38 offen lds
v_mul_f32 v74, v182, v182
v_mul_f32 v75, v183, v183
v_mul_f32 v76, v204, v204
v_mul_f32 v77, v205, v205
v_mul_f32 v78, v206, v206
v_mul_f32 v79, v207, v207
v_fma_f32 v72, v72, v65, v64
v_fma_f32 v73, v73, v65, v64
s_add_u32 m0, s40, 50176
s_nop 0
buffer_load_dwordx4 v5, s[12:15], s38 offen lds
v_fma_f32 v74, v74, v65, v64
v_fma_f32 v75, v75, v65, v64
v_fma_f32 v76, v76, v69, v68
v_fma_f32 v77, v77, v69, v68
v_fma_f32 v78, v78, v69, v68
v_fma_f32 v79, v79, v69, v68
v_mul_f32 v72, v72, v180
s_add_u32 m0, s40, 51200
s_add_u32 s38, s38, 57344
buffer_load_dwordx4 v4, s[12:15], s38 offen lds
v_mul_f32 v73, v73, v181
v_mul_f32 v74, v74, v182
v_mul_f32 v75, v75, v183
v_mul_f32 v76, v76, v204
v_mul_f32 v77, v77, v205
v_mul_f32 v78, v78, v206
v_mul_f32 v79, v79, v207
s_add_u32 m0, s40, 52224
s_nop 0
buffer_load_dwordx4 v5, s[12:15], s38 offen lds
v_exp_f32 v72, v72
v_exp_f32 v73, v73
v_exp_f32 v74, v74
v_exp_f32 v75, v75
v_exp_f32 v76, v76
v_exp_f32 v77, v77
v_exp_f32 v78, v78
v_exp_f32 v79, v79
s_add_u32 m0, s40, 53248
s_add_u32 s38, s38, 57344
buffer_load_dwordx4 v4, s[12:15], s38 offen lds
v_fma_f32 v192, -v60, v48, v192
v_fma_f32 v193, -v60, v49, v193
v_fma_f32 v194, -v60, v50, v194
v_fma_f32 v195, -v60, v51, v195
v_fma_f32 v216, -v62, v48, v216
v_fma_f32 v217, -v62, v49, v217
v_fma_f32 v218, -v62, v50, v218
s_add_u32 m0, s40, 54272
s_nop 0
buffer_load_dwordx4 v5, s[12:15], s38 offen lds
v_fma_f32 v219, -v62, v51, v219
v_fma_f32 v72, v72, v66, v66
v_fma_f32 v73, v73, v66, v66
v_fma_f32 v74, v74, v66, v66
v_fma_f32 v75, v75, v66, v66
v_fma_f32 v76, v76, v70, v70
v_fma_f32 v77, v77, v70, v70
v_fma_f32 v78, v78, v70, v70
s_add_u32 m0, s40, 55296
s_add_u32 s38, s38, 57344
buffer_load_dwordx4 v4, s[12:15], s38 offen lds
s_add_u32 m0, s40, 56320
s_nop 0
buffer_load_dwordx4 v5, s[12:15], s38 offen lds
s_waitcnt vmcnt(12)
s_barrier
s_add_u32 s37, s35, 7
s_and_b32 s37, s37, 15
s_mul_i32 s37, s37, 16384
s_add_u32 m0, s39, 98304
s_nop 0
buffer_load_dwordx4 v3, s[8:11], s37 offen sc1 lds
v_fma_f32 v79, v79, v70, v70
v_rcp_f32 v72, v72
v_rcp_f32 v73, v73
v_rcp_f32 v74, v74
v_rcp_f32 v75, v75
v_rcp_f32 v76, v76
buffer_load_dwordx4 v3, s[8:11], s37 offen offset:1024 sc1 lds
v_rcp_f32 v77, v77
v_rcp_f32 v78, v78
v_rcp_f32 v79, v79
v_mul_f32 v192, v180, v192
v_mul_f32 v193, v181, v193
v_mul_f32 v194, v182, v194
buffer_load_dwordx4 v3, s[8:11], s37 offen offset:2048 sc1 lds
v_mul_f32 v195, v183, v195
v_mul_f32 v216, v204, v216
v_mul_f32 v217, v205, v217
v_mul_f32 v218, v206, v218
v_mul_f32 v219, v207, v219
v_mul_f32 v192, v192, v72
buffer_load_dwordx4 v3, s[8:11], s37 offen offset:3072 sc1 lds
v_mul_f32 v193, v193, v73
v_mul_f32 v194, v194, v74
v_mul_f32 v195, v195, v75
v_mul_f32 v216, v216, v76
v_mul_f32 v217, v217, v77
v_mul_f32 v218, v218, v78
s_add_u32 s38, s35, 7
s_and_b32 s38, s38, 15
s_mul_i32 s38, s38, 458752
s_add_u32 m0, s40, 98304
s_nop 0
buffer_load_dwordx4 v4, s[12:15], s38 offen lds
v_mul_f32 v219, v219, v79
v_cvt_pk_bf16_f32 v178, v192, v193
v_cvt_pk_bf16_f32 v179, v194, v195
v_cvt_pk_bf16_f32 v202, v216, v217
v_cvt_pk_bf16_f32 v203, v218, v219
buffer_store_dwordx4 v[176:179], v2, s[24:27], s54 offen offset:2048 sc1
s_add_u32 m0, s40, 99328
s_nop 0
buffer_load_dwordx4 v5, s[12:15], s38 offen lds
buffer_store_dwordx4 v[200:203], v2, s[24:27], s54 offen offset:3072 sc1
v_fma_f32 v184, -v60, v40, v184
v_fma_f32 v185, -v60, v41, v185
v_fma_f32 v186, -v60, v42, v186
v_fma_f32 v187, -v60, v43, v187
v_fma_f32 v208, -v62, v40, v208
s_add_u32 m0, s40, 100352
s_add_u32 s38, s38, 57344
buffer_load_dwordx4 v4, s[12:15], s38 offen lds
v_fma_f32 v209, -v62, v41, v209
v_fma_f32 v210, -v62, v42, v210
v_fma_f32 v211, -v62, v43, v211
v_mul_f32 v72, v184, v184
v_mul_f32 v73, v185, v185
v_mul_f32 v74, v186, v186
s_add_u32 m0, s40, 101376
s_nop 0
buffer_load_dwordx4 v5, s[12:15], s38 offen lds
v_mul_f32 v75, v187, v187
v_mul_f32 v76, v208, v208
v_mul_f32 v77, v209, v209
v_mul_f32 v78, v210, v210
v_mul_f32 v79, v211, v211
v_fma_f32 v72, v72, v65, v64
s_add_u32 m0, s40, 102400
s_add_u32 s38, s38, 57344
buffer_load_dwordx4 v4, s[12:15], s38 offen lds
v_fma_f32 v73, v73, v65, v64
v_fma_f32 v74, v74, v65, v64
v_fma_f32 v75, v75, v65, v64
v_fma_f32 v76, v76, v69, v68
v_fma_f32 v77, v77, v69, v68
v_fma_f32 v78, v78, v69, v68
s_add_u32 m0, s40, 103424
s_nop 0
buffer_load_dwordx4 v5, s[12:15], s38 offen lds
v_fma_f32 v79, v79, v69, v68
v_mul_f32 v72, v72, v184
v_mul_f32 v73, v73, v185
v_mul_f32 v74, v74, v186
v_mul_f32 v75, v75, v187
v_mul_f32 v76, v76, v208
s_add_u32 m0, s40, 104448
s_add_u32 s38, s38, 57344
buffer_load_dwordx4 v4, s[12:15], s38 offen lds
s_add_u32 m0, s40, 105472
s_nop 0
buffer_load_dwordx4 v5, s[12:15], s38 offen lds
s_waitcnt vmcnt(14)
s_cmp_eq_u32 s47, 3
s_cbranch_scc0 Lw_112
s_mov_b32 s41, 0x40000
Lcp_113:
s_waitcnt lgkmcnt(0)
s_and_b32 s92, s92, s93
s_cmp_eq_u32 s92, 16
s_cbranch_scc1 Lco_114
s_load_dword s92, s[82:83], s60 glc
s_load_dword s93, s[82:83], s61 glc
s_sub_u32 s41, s41, 1
s_cmp_lg_u32 s41, 0
s_cbranch_scc1 Lcp_113
s_waitcnt lgkmcnt(0)
Lco_114:
Lw_112:
s_barrier
s_lshl_b32 s60, s35, 9
s_lshl_b32 s43, s47, 7
s_add_u32 s60, s60, s43
s_add_u32 s61, s60, 14336
s_add_u32 s52, s43, 148480
s_add_u32 s53, s52, 896
v_lshrrev_b32 v104, 3, v1
v_mul_u32_u24 v104, 28672, v104
v_and_b32 v105, 7, v1
v_lshl_add_u32 v104, v105, 4, v104
s_waitcnt lgkmcnt(0)
buffer_load_dwordx4 v[96:99], v104, s[84:87], s60 offen sc1
s_load_dword s3, s[4:5], 5376
s_load_dword s3, s[4:5], 5440
s_load_dword s3, s[4:5], 5504
s_load_dword s3, s[4:5], 5568
s_load_dword s3, s[4:5], 5632
s_load_dword s3, s[4:5], 5696
buffer_load_dwordx4 v[100:103], v104, s[84:87], s61 offen sc1
s_load_dword s3, s[4:5], 5760
s_load_dword s3, s[4:5], 5824
s_load_dword s3, s[4:5], 5888
s_load_dword s3, s[4:5], 5952
s_load_dword s3, s[4:5], 6016
s_load_dword s3, s[4:5], 6080
s_load_dword s3, s[4:5], 6144
s_add_u32 s37, s35, 8
s_and_b32 s37, s37, 15
s_mul_i32 s37, s37, 16384
s_add_u32 m0, s39, 0
s_nop 0
buffer_load_dwordx4 v3, s[8:11], s37 offen sc1 lds
s_load_dword s3, s[4:5], 6208
v_mul_f32 v77, v77, v209
v_mul_f32 v78, v78, v210
v_mul_f32 v79, v79, v211
v_exp_f32 v72, v72
v_exp_f32 v73, v73
v_exp_f32 v74, v74
buffer_load_dwordx4 v3, s[8:11], s37 offen offset:1024 sc1 lds
v_exp_f32 v75, v75
v_exp_f32 v76, v76
v_exp_f32 v77, v77
v_exp_f32 v78, v78
v_exp_f32 v79, v79
v_fma_f32 v196, -v60, v52, v196
v_fma_f32 v197, -v60, v53, v197
buffer_load_dwordx4 v3, s[8:11], s37 offen offset:2048 sc1 lds
v_fma_f32 v198, -v60, v54, v198
v_fma_f32 v199, -v60, v55, v199
v_fma_f32 v220, -v62, v52, v220
v_fma_f32 v221, -v62, v53, v221
v_fma_f32 v222, -v62, v54, v222
v_fma_f32 v223, -v62, v55, v223
buffer_load_dwordx4 v3, s[8:11], s37 offen offset:3072 sc1 lds
v_fma_f32 v72, v72, v66, v66
v_fma_f32 v73, v73, v66, v66
v_fma_f32 v74, v74, v66, v66
v_fma_f32 v75, v75, v66, v66
v_fma_f32 v76, v76, v70, v70
v_fma_f32 v77, v77, v70, v70
v_fma_f32 v78, v78, v70, v70
s_add_u32 s38, s35, 8
s_and_b32 s38, s38, 15
s_mul_i32 s38, s38, 458752
s_add_u32 m0, s40, 0
s_nop 0
buffer_load_dwordx4 v4, s[12:15], s38 offen lds
v_fma_f32 v79, v79, v70, v70
v_rcp_f32 v72, v72
v_rcp_f32 v73, v73
v_rcp_f32 v74, v74
v_rcp_f32 v75, v75
v_rcp_f32 v76, v76
v_rcp_f32 v77, v77
s_add_u32 m0, s40, 1024
s_nop 0
buffer_load_dwordx4 v5, s[12:15], s38 offen lds
v_rcp_f32 v78, v78
v_rcp_f32 v79, v79
v_mul_f32 v196, v184, v196
v_mul_f32 v197, v185, v197
v_mul_f32 v198, v186, v198
v_mul_f32 v199, v187, v199
v_mul_f32 v220, v208, v220
s_add_u32 m0, s40, 2048
s_add_u32 s38, s38, 57344
buffer_load_dwordx4 v4, s[12:15], s38 offen lds
v_mul_f32 v221, v209, v221
v_mul_f32 v222, v210, v222
v_mul_f32 v223, v211, v223
v_mul_f32 v196, v196, v72
v_mul_f32 v197, v197, v73
v_mul_f32 v198, v198, v74
s_add_u32 m0, s40, 3072
s_nop 0
buffer_load_dwordx4 v5, s[12:15], s38 offen lds
v_mul_f32 v199, v199, v75
v_mul_f32 v220, v220, v76
v_mul_f32 v221, v221, v77
v_mul_f32 v222, v222, v78
v_mul_f32 v223, v223, v79
v_cvt_pk_bf16_f32 v80, v196, v197
v_cvt_pk_bf16_f32 v81, v198, v199
s_add_u32 m0, s40, 4096
s_add_u32 s38, s38, 57344
buffer_load_dwordx4 v4, s[12:15], s38 offen lds
v_cvt_pk_bf16_f32 v82, v220, v221
v_cvt_pk_bf16_f32 v83, v222, v223
s_nop 1
v_permlane32_swap_b32 v80, v82
v_permlane32_swap_b32 v81, v83
buffer_store_dwordx4 v[80:83], v84, s[24:27], s55 offen offset:2048 sc1
s_nop 1
s_add_u32 m0, s40, 5120
s_nop 0
buffer_load_dwordx4 v5, s[12:15], s38 offen lds
v_cmp_gt_u32 vcc, 32, v1
v_mov_b32 v104, s52
v_mov_b32 v106, s53
v_cndmask_b32 v104, v106, v104, vcc
v_lshl_add_u32 v104, v105, 4, v104
v_bfe_u32 v105, v1, 4, 1
v_lshl_add_u32 v104, v105, 2, v104
s_add_u32 m0, s40, 6144
s_add_u32 s38, s38, 57344
buffer_load_dwordx4 v4, s[12:15], s38 offen lds
s_add_u32 m0, s40, 7168
s_nop 0
buffer_load_dwordx4 v5, s[12:15], s38 offen lds
s_waitcnt vmcnt(15)
s_barrier
s_add_u32 s37, s35, 9
s_and_b32 s37, s37, 15
s_mul_i32 s37, s37, 16384
s_add_u32 m0, s39, 49152
s_nop 0
buffer_load_dwordx4 v3, s[8:11], s37 offen sc1 lds
buffer_load_dwordx4 v3, s[8:11], s37 offen offset:1024 sc1 lds
buffer_load_dwordx4 v3, s[8:11], s37 offen offset:2048 sc1 lds
buffer_load_dwordx4 v3, s[8:11], s37 offen offset:3072 sc1 lds
s_add_u32 s38, s35, 9
s_and_b32 s38, s38, 15
s_mul_i32 s38, s38, 458752
s_add_u32 m0, s40, 49152
s_nop 0
buffer_load_dwordx4 v4, s[12:15], s38 offen lds
s_add_u32 m0, s40, 50176
s_nop 0
buffer_load_dwordx4 v5, s[12:15], s38 offen lds
s_add_u32 m0, s40, 51200
s_add_u32 s38, s38, 57344
buffer_load_dwordx4 v4, s[12:15], s38 offen lds
s_add_u32 m0, s40, 52224
s_nop 0
buffer_load_dwordx4 v5, s[12:15], s38 offen lds
s_add_u32 m0, s40, 53248
s_add_u32 s38, s38, 57344
buffer_load_dwordx4 v4, s[12:15], s38 offen lds
s_add_u32 m0, s40, 54272
s_nop 0
buffer_load_dwordx4 v5, s[12:15], s38 offen lds
s_add_u32 m0, s40, 55296
s_add_u32 s38, s38, 57344
buffer_load_dwordx4 v4, s[12:15], s38 offen lds
s_add_u32 m0, s40, 56320
s_nop 0
buffer_load_dwordx4 v5, s[12:15], s38 offen lds
s_waitcnt vmcnt(12)
s_barrier
s_cmp_eq_u32 s47, 0
s_cbranch_scc0 Lw_115
s_add_u32 s7, s34, 32
s_lshl_b32 s7, s7, 7
v_mov_b32 v90, s7
v_mov_b32 v91, 1
s_mov_b64 exec, 1
buffer_atomic_add v91, v90, s[56:59], 0 offen sc1
s_mov_b64 exec, -1
Lw_115:
v_permlane32_swap_b32 v96, v100
v_permlane32_swap_b32 v97, v101
v_permlane32_swap_b32 v98, v102
v_permlane32_swap_b32 v99, v103
v_add_f32 v96, v96, v100
v_add_f32 v97, v97, v101
v_add_f32 v98, v98, v102
v_add_f32 v99, v99, v103
s_nop 1
v_permlane16_swap_b32 v96, v97
v_permlane16_swap_b32 v98, v99
v_add_f32 v96, v96, v97
v_add_f32 v98, v98, v99
s_nop 1
v_add_f32_dpp v96, v96, v96 row_ror:8 row_mask:0xf bank_mask:0xf
v_add_f32_dpp v98, v98, v98 row_ror:8 row_mask:0xf bank_mask:0xf
ds_write_b32 v104, v96
ds_write_b32 v104, v98 offset:8
s_waitcnt lgkmcnt(0)
s_add_u32 s37, s35, 10
s_and_b32 s37, s37, 15
s_mul_i32 s37, s37, 16384
s_add_u32 m0, s39, 98304
s_nop 0
buffer_load_dwordx4 v3, s[8:11], s37 offen sc1 lds
s_load_dword s3, s[4:5], 6272
s_load_dword s3, s[4:5], 6336
s_load_dword s3, s[4:5], 6400
s_load_dword s3, s[4:5], 6464
s_load_dword s3, s[4:5], 6528
s_load_dword s3, s[4:5], 6592
buffer_load_dwordx4 v3, s[8:11], s37 offen offset:1024 sc1 lds
s_load_dword s3, s[4:5], 6656
s_load_dword s3, s[4:5], 6720
s_load_dword s3, s[4:5], 6784
s_load_dword s3, s[4:5], 6848
s_load_dword s3, s[4:5], 6912
s_load_dword s3, s[4:5], 6976
s_load_dword s3, s[4:5], 7040
buffer_load_dwordx4 v3, s[8:11], s37 offen offset:2048 sc1 lds
s_load_dword s3, s[4:5], 7104
s_bfe_u32 s61, s35, 0x10002
s_lshr_b32 s60, s35, 3
s_lshl_b32 s60, s60, 2
s_and_b32 s43, s35, 3
s_add_u32 s60, s60, s43
buffer_load_dwordx4 v3, s[8:11], s37 offen offset:3072 sc1 lds
s_lshl_b32 s43, s60, 8
s_add_u32 s28, s76, s43
s_addc_u32 s29, s77, 0
s_mov_b32 s30, 7338240
s_mov_b32 s31, 0x20000
s_mul_i32 s52, s61, 196608
s_mul_i32 s53, s61, 1572864
s_add_u32 s38, s35, 10
s_and_b32 s38, s38, 15
s_mul_i32 s38, s38, 458752
s_add_u32 m0, s40, 98304
s_nop 0
buffer_load_dwordx4 v4, s[12:15], s38 offen lds
s_mul_i32 s90, s61, 163840
s_mul_i32 s91, s61, 1310720
s_and_b32 s43, s35, 3
s_mul_i32 s32, s43, 3
s_mul_i32 s33, s43, 10
s_lshr_b32 s33, s33, 2
s_add_u32 m0, s40, 99328
s_nop 0
buffer_load_dwordx4 v5, s[12:15], s38 offen lds
s_lshl_b32 s51, s47, 11
s_lshl_b32 s44, s47, 15
v_lshrrev_b32 v122, 4, v1
v_lshlrev_b32 v123, 1, v122
v_and_b32 v23, 15, v1
v_xor_b32 v23, v23, v123
v_lshlrev_b32 v23, 4, v23
s_add_u32 m0, s40, 100352
s_add_u32 s38, s38, 57344
buffer_load_dwordx4 v4, s[12:15], s38 offen lds
v_mul_u32_u24 v122, 2048, v122
v_add_u32 v23, v23, v122
v_add_u32 v23, s44, v23
s_branch Lov_10
.p2align 12
.fill 80, 4, 0xbf800000
Lst_10_0:
s_branch Lwr_155
Lst_10_1:
s_branch Lwr_166
s_nop 0
Lov_10:
v_xor_b32 v24, 128, v23
v_add_u32 v24, 8192, v24
s_lshl_b32 s43, s60, 2
s_add_u32 m0, s40, 101376
s_nop 0
buffer_load_dwordx4 v5, s[12:15], s38 offen lds
s_lshl_b32 s44, s61, 1
s_add_u32 s43, s43, s44
s_add_u32 s43, s43, s63
s_lshl_b32 s43, s43, 13
s_lshl_b32 s44, s62, 12
s_add_u32 s50, s43, s44
v_add_u32 v17, s44, v2
s_add_u32 m0, s40, 102400
s_add_u32 s38, s38, 57344
buffer_load_dwordx4 v4, s[12:15], s38 offen lds
v_add_u32 v18, 0x10000, v17
v_add_u32 v19, 0x20000, v17
v_lshrrev_b32 v122, 2, v1
v_and_b32 v123, 7, v122
v_mul_u32_u24 v122, 256, v122
v_lshl_add_u32 v122, v123, 5, v122
s_add_u32 m0, s40, 103424
s_nop 0
buffer_load_dwordx4 v5, s[12:15], s38 offen lds
v_and_b32 v123, 3, v1
v_lshl_add_u32 v9, v123, 3, v122
s_lshl_b32 s43, s61, 7
s_lshl_b32 s44, s63, 6
s_add_u32 s43, s43, s44
v_xor_b32 v9, s43, v9
v_xor_b32 v10, 32, v9
s_add_u32 m0, s40, 104448
s_add_u32 s38, s38, 57344
buffer_load_dwordx4 v4, s[12:15], s38 offen lds
s_add_u32 m0, s40, 105472
s_nop 0
buffer_load_dwordx4 v5, s[12:15], s38 offen lds
s_waitcnt vmcnt(12)
s_barrier
buffer_load_dwordx4 v[160:163], v2, s[8:11], s50 offen offset:0 sc1
v_xor_b32 v11, 128, v9
v_xor_b32 v12, 128, v10
v_add_u32 v13, 65536, v9
buffer_load_dwordx4 v[164:167], v2, s[8:11], s50 offen offset:1024 sc1
v_add_u32 v14, 65536, v10
v_add_u32 v15, 65536, v11
v_add_u32 v16, 65536, v12
v_add_u32 v25, 131072, v9
buffer_load_dwordx4 v[168:171], v2, s[8:11], s50 offen offset:2048 sc1
v_add_u32 v26, 131072, v10
v_add_u32 v27, 131072, v11
v_add_u32 v28, 131072, v12
v_lshrrev_b32 v122, 2, v1
buffer_load_dwordx4 v[172:175], v2, s[8:11], s50 offen offset:3072 sc1
v_bfe_u32 v123, v122, 1, 2
v_mul_u32_u24 v122, 128, v122
v_lshl_add_u32 v122, v123, 5, v122
s_add_u32 s37, s35, 11
s_and_b32 s37, s37, 15
s_mul_i32 s37, s37, 16384
s_add_u32 m0, s39, 0
s_nop 0
buffer_load_dwordx4 v3, s[8:11], s37 offen sc1 lds
v_and_b32 v123, 3, v1
v_lshl_add_u32 v224, v123, 3, v122
v_xor_b32 v224, s44, v224
v_xor_b32 v225, 32, v224
buffer_load_dwordx4 v3, s[8:11], s37 offen offset:1024 sc1 lds
v_add_u32 v226, 65536, v224
v_add_u32 v227, 65536, v225
v_add_u32 v228, 131072, v224
v_add_u32 v229, 131072, v225
buffer_load_dwordx4 v3, s[8:11], s37 offen offset:2048 sc1 lds
s_add_u32 s84, s82, 33554432
s_addc_u32 s85, s83, 0
s_mov_b32 s86, 4194304
s_mov_b32 s87, 0x20000
buffer_load_dwordx4 v3, s[8:11], s37 offen offset:3072 sc1 lds
s_xor_b32 s43, s2, 2
s_lshl_b32 s44, s43, 2
s_add_u32 s44, s44, s47
s_add_u32 s38, s35, 11
s_and_b32 s38, s38, 15
s_mul_i32 s38, s38, 458752
s_add_u32 m0, s40, 0
s_nop 0
buffer_load_dwordx4 v4, s[12:15], s38 offen lds
s_lshl_b32 s45, s44, 12
s_lshl_b32 s46, s2, 2
s_add_u32 s46, s46, s47
s_lshl_b32 s46, s46, 12
s_add_u32 m0, s40, 1024
s_nop 0
buffer_load_dwordx4 v5, s[12:15], s38 offen lds
s_lshl_b32 s43, s34, 18
s_lshl_b32 s42, s60, 8
s_add_u32 s43, s43, s42
s_lshl_b32 s42, s61, 7
s_add_u32 m0, s40, 2048
s_add_u32 s38, s38, 57344
buffer_load_dwordx4 v4, s[12:15], s38 offen lds
s_add_u32 s43, s43, s42
s_lshl_b32 s42, s63, 6
s_add_u32 s43, s43, s42
s_add_u32 m0, s40, 3072
s_nop 0
buffer_load_dwordx4 v5, s[12:15], s38 offen lds
s_add_u32 s20, s78, s43
s_addc_u32 s21, s79, 0
s_mov_b32 s22, 260160
s_mov_b32 s23, 0x20000
s_add_u32 m0, s40, 4096
s_add_u32 s38, s38, 57344
buffer_load_dwordx4 v4, s[12:15], s38 offen lds
v_and_b32 v230, 15, v1
v_lshlrev_b32 v230, 12, v230
v_bfe_u32 v231, v1, 4, 1
v_lshl_add_u32 v230, v231, 5, v230
s_add_u32 m0, s40, 5120
s_nop 0
buffer_load_dwordx4 v5, s[12:15], s38 offen lds
v_bfe_u32 v231, v1, 5, 1
v_lshl_add_u32 v230, v231, 4, v230
s_lshl_b32 s54, s62, 17
s_add_u32 s55, s54, 65536
s_add_u32 m0, s40, 6144
s_add_u32 s38, s38, 57344
buffer_load_dwordx4 v4, s[12:15], s38 offen lds
s_add_u32 m0, s40, 7168
s_nop 0
buffer_load_dwordx4 v5, s[12:15], s38 offen lds
s_waitcnt vmcnt(16)
s_barrier
s_cmp_eq_u32 s47, 3
s_cbranch_scc0 Lw_116
s_lshl_b32 s92, s34, 7
s_add_u32 s92, s92, 28315648
s_load_dword s93, s[82:83], s92 glc
Lw_116:
s_add_u32 s37, s35, 12
s_and_b32 s37, s37, 15
s_mul_i32 s37, s37, 16384
s_add_u32 m0, s39, 49152
s_nop 0
buffer_load_dwordx4 v3, s[8:11], s37 offen sc1 lds
buffer_load_dwordx4 v3, s[8:11], s37 offen offset:1024 sc1 lds
buffer_load_dwordx4 v3, s[8:11], s37 offen offset:2048 sc1 lds
buffer_load_dwordx4 v3, s[8:11], s37 offen offset:3072 sc1 lds
s_add_u32 s38, s35, 12
s_and_b32 s38, s38, 15
s_mul_i32 s38, s38, 458752
s_add_u32 m0, s40, 49152
s_nop 0
buffer_load_dwordx4 v4, s[12:15], s38 offen lds
s_add_u32 m0, s40, 50176
s_nop 0
buffer_load_dwordx4 v5, s[12:15], s38 offen lds
s_add_u32 m0, s40, 51200
s_add_u32 s38, s38, 57344
buffer_load_dwordx4 v4, s[12:15], s38 offen lds
s_add_u32 m0, s40, 52224
s_nop 0
buffer_load_dwordx4 v5, s[12:15], s38 offen lds
s_add_u32 m0, s40, 53248
s_add_u32 s38, s38, 57344
buffer_load_dwordx4 v4, s[12:15], s38 offen lds
s_add_u32 m0, s40, 54272
s_nop 0
buffer_load_dwordx4 v5, s[12:15], s38 offen lds
s_add_u32 m0, s40, 55296
s_add_u32 s38, s38, 57344
buffer_load_dwordx4 v4, s[12:15], s38 offen lds
s_add_u32 m0, s40, 56320
s_nop 0
buffer_load_dwordx4 v5, s[12:15], s38 offen lds
s_waitcnt vmcnt(12)
s_cmp_eq_u32 s47, 3
s_cbranch_scc0 Lw_117
s_mov_b32 s41, 0x40000
s_branch Lpchk_120
Lpoll_118:
s_load_dword s93, s[82:83], s92 glc
Lpchk_120:
s_waitcnt lgkmcnt(0)
s_cmp_eq_u32 s93, 16
s_cbranch_scc1 Lpok_119
s_sub_u32 s41, s41, 1
s_cmp_lg_u32 s41, 0
s_cbranch_scc1 Lpoll_118
Lpok_119:
Lw_117:
s_barrier
s_add_u32 s37, s52, 524288
s_add_u32 m0, s39, 98304
s_nop 0
buffer_load_dwordx4 v3, s[24:27], s37 offen sc1 lds
v_lshlrev_b32 v128, 16, v160
v_and_b32 v129, 0xffff0000, v160
v_lshlrev_b32 v130, 16, v161
v_and_b32 v131, 0xffff0000, v161
v_lshlrev_b32 v132, 16, v162
buffer_load_dwordx4 v3, s[24:27], s37 offen offset:1024 sc1 lds
v_and_b32 v133, 0xffff0000, v162
v_lshlrev_b32 v134, 16, v163
v_and_b32 v135, 0xffff0000, v163
v_lshlrev_b32 v136, 16, v164
v_and_b32 v137, 0xffff0000, v164
buffer_load_dwordx4 v3, s[24:27], s37 offen offset:2048 sc1 lds
v_lshlrev_b32 v138, 16, v165
v_and_b32 v139, 0xffff0000, v165
v_lshlrev_b32 v140, 16, v166
v_and_b32 v141, 0xffff0000, v166
v_lshlrev_b32 v142, 16, v167
v_and_b32 v143, 0xffff0000, v167
buffer_load_dwordx4 v3, s[24:27], s37 offen offset:3072 sc1 lds
v_lshlrev_b32 v144, 16, v168
v_and_b32 v145, 0xffff0000, v168
v_lshlrev_b32 v146, 16, v169
v_and_b32 v147, 0xffff0000, v169
v_lshlrev_b32 v148, 16, v170
s_add_u32 s38, s53, 4194304
s_add_u32 m0, s39, 114688
s_nop 0
buffer_load_dwordx4 v23, s[28:31], s38 offen lds
v_and_b32 v149, 0xffff0000, v170
v_lshlrev_b32 v150, 16, v171
v_and_b32 v151, 0xffff0000, v171
v_lshlrev_b32 v152, 16, v172
v_and_b32 v153, 0xffff0000, v172
s_add_u32 m0, s39, 115712
s_nop 0
buffer_load_dwordx4 v24, s[28:31], s38 offen lds
v_lshlrev_b32 v154, 16, v173
v_and_b32 v155, 0xffff0000, v173
v_lshlrev_b32 v156, 16, v174
v_and_b32 v157, 0xffff0000, v174
v_lshlrev_b32 v158, 16, v175
v_and_b32 v159, 0xffff0000, v175
s_add_u32 m0, s39, 116736
s_add_u32 s38, s38, 16384
buffer_load_dwordx4 v23, s[28:31], s38 offen lds
s_add_u32 m0, s39, 117760
s_nop 0
buffer_load_dwordx4 v24, s[28:31], s38 offen lds
s_waitcnt vmcnt(8)
s_barrier
s_add_u32 s37, s52, 540672
s_add_u32 m0, s39, 131072
s_nop 0
buffer_load_dwordx4 v3, s[24:27], s37 offen sc1 lds
buffer_load_dwordx4 v3, s[24:27], s37 offen offset:1024 sc1 lds
buffer_load_dwordx4 v3, s[24:27], s37 offen offset:2048 sc1 lds
buffer_load_dwordx4 v3, s[24:27], s37 offen offset:3072 sc1 lds
s_add_u32 s38, s53, 4325376
s_add_u32 m0, s39, 0
s_nop 0
buffer_load_dwordx4 v23, s[28:31], s38 offen lds
s_add_u32 m0, s39, 1024
s_nop 0
buffer_load_dwordx4 v24, s[28:31], s38 offen lds
s_add_u32 m0, s39, 2048
s_add_u32 s38, s38, 16384
buffer_load_dwordx4 v23, s[28:31], s38 offen lds
s_add_u32 m0, s39, 3072
s_nop 0
buffer_load_dwordx4 v24, s[28:31], s38 offen lds
s_add_u32 s37, s52, 557056
s_add_u32 m0, s39, 16384
s_nop 0
buffer_load_dwordx4 v3, s[24:27], s37 offen sc1 lds
buffer_load_dwordx4 v3, s[24:27], s37 offen offset:1024 sc1 lds
buffer_load_dwordx4 v3, s[24:27], s37 offen offset:2048 sc1 lds
buffer_load_dwordx4 v3, s[24:27], s37 offen offset:3072 sc1 lds
s_add_u32 s38, s53, 4456448
s_add_u32 m0, s39, 32768
s_nop 0
buffer_load_dwordx4 v23, s[28:31], s38 offen lds
s_add_u32 m0, s39, 33792
s_nop 0
buffer_load_dwordx4 v24, s[28:31], s38 offen lds
s_add_u32 m0, s39, 34816
s_add_u32 s38, s38, 16384
buffer_load_dwordx4 v23, s[28:31], s38 offen lds
s_add_u32 m0, s39, 35840
s_nop 0
buffer_load_dwordx4 v24, s[28:31], s38 offen lds
s_waitcnt vmcnt(16)
s_barrier
ds_read_b128 v[32:35], v18 offset:32768
ds_read_b64_tr_b16 v[48:49], v13 offset:49152
ds_read_b64_tr_b16 v[50:51], v13 offset:53248
ds_read_b64_tr_b16 v[52:53], v14 offset:49152
ds_read_b64_tr_b16 v[54:55], v14 offset:53248
ds_read_b64_tr_b16 v[56:57], v15 offset:49152
ds_read_b64_tr_b16 v[58:59], v15 offset:53248
ds_read_b64_tr_b16 v[60:61], v16 offset:49152
ds_read_b64_tr_b16 v[62:63], v16 offset:53248
ds_read_b128 v[36:39], v18 offset:33792
ds_read_b128 v[40:43], v18 offset:34816
ds_read_b128 v[44:47], v18 offset:35840
ds_read_b128 v[64:67], v18 offset:40960
ds_read_b64_tr_b16 v[80:81], v13 offset:57344
ds_read_b64_tr_b16 v[82:83], v13 offset:61440
ds_read_b64_tr_b16 v[84:85], v14 offset:57344
ds_read_b64_tr_b16 v[86:87], v14 offset:61440
ds_read_b64_tr_b16 v[88:89], v15 offset:57344
ds_read_b64_tr_b16 v[90:91], v15 offset:61440
ds_read_b64_tr_b16 v[92:93], v16 offset:57344
ds_read_b64_tr_b16 v[94:95], v16 offset:61440
ds_read_b128 v[68:71], v18 offset:41984
ds_read_b128 v[72:75], v18 offset:43008
ds_read_b128 v[76:79], v18 offset:44032
s_add_u32 s37, s52, 573440
s_add_u32 m0, s39, 49152
s_nop 0
buffer_load_dwordx4 v3, s[24:27], s37 offen sc1 lds
buffer_load_dwordx4 v3, s[24:27], s37 offen offset:1024 sc1 lds
buffer_load_dwordx4 v3, s[24:27], s37 offen offset:2048 sc1 lds
buffer_load_dwordx4 v3, s[24:27], s37 offen offset:3072 sc1 lds
s_add_u32 s38, s53, 4587520
s_add_u32 m0, s39, 65536
s_nop 0
buffer_load_dwordx4 v23, s[28:31], s38 offen lds
s_add_u32 m0, s39, 66560
s_nop 0
buffer_load_dwordx4 v24, s[28:31], s38 offen lds
s_add_u32 m0, s39, 67584
s_add_u32 s38, s38, 16384
buffer_load_dwordx4 v23, s[28:31], s38 offen lds
s_add_u32 m0, s39, 68608
s_nop 0
buffer_load_dwordx4 v24, s[28:31], s38 offen lds
Lk4c:
s_waitcnt vmcnt(16)
s_waitcnt lgkmcnt(0)
s_barrier
v_mfma_f32_16x16x32_bf16 v[128:131], v[48:51], v[32:35], v[128:131]
ds_read_b128 v[96:99], v19 offset:0
v_mfma_f32_16x16x32_bf16 v[136:139], v[48:51], v[36:39], v[136:139]
ds_read_b64_tr_b16 v[112:113], v9 offset:0
v_mfma_f32_16x16x32_bf16 v[144:147], v[48:51], v[40:43], v[144:147]
ds_read_b64_tr_b16 v[114:115], v9 offset:4096
v_mfma_f32_16x16x32_bf16 v[152:155], v[48:51], v[44:47], v[152:155]
ds_read_b64_tr_b16 v[116:117], v10 offset:0
v_mfma_f32_16x16x32_bf16 v[156:159], v[52:55], v[44:47], v[156:159]
ds_read_b64_tr_b16 v[118:119], v10 offset:4096
v_mfma_f32_16x16x32_bf16 v[148:151], v[52:55], v[40:43], v[148:151]
ds_read_b64_tr_b16 v[120:121], v11 offset:0
v_mfma_f32_16x16x32_bf16 v[140:143], v[52:55], v[36:39], v[140:143]
ds_read_b64_tr_b16 v[122:123], v11 offset:4096
v_mfma_f32_16x16x32_bf16 v[132:135], v[52:55], v[32:35], v[132:135]
ds_read_b64_tr_b16 v[124:125], v12 offset:0
v_mfma_f32_16x16x32_bf16 v[160:163], v[56:59], v[32:35], 0
ds_read_b64_tr_b16 v[126:127], v12 offset:4096
v_mfma_f32_16x16x32_bf16 v[168:171], v[56:59], v[36:39], 0
ds_read_b128 v[100:103], v19 offset:1024
v_mfma_f32_16x16x32_bf16 v[176:179], v[56:59], v[40:43], 0
ds_read_b128 v[104:107], v19 offset:2048
v_mfma_f32_16x16x32_bf16 v[184:187], v[56:59], v[44:47], 0
ds_read_b128 v[108:111], v19 offset:3072
v_mfma_f32_16x16x32_bf16 v[188:191], v[60:63], v[44:47], 0
ds_read_b128 v[192:195], v19 offset:8192
v_mfma_f32_16x16x32_bf16 v[180:183], v[60:63], v[40:43], 0
ds_read_b64_tr_b16 v[208:209], v9 offset:8192
v_mfma_f32_16x16x32_bf16 v[172:175], v[60:63], v[36:39], 0
ds_read_b64_tr_b16 v[210:211], v9 offset:12288
v_mfma_f32_16x16x32_bf16 v[164:167], v[60:63], v[32:35], 0
ds_read_b64_tr_b16 v[212:213], v10 offset:8192
v_mfma_f32_16x16x32_bf16 v[128:131], v[80:83], v[64:67], v[128:131]
ds_read_b64_tr_b16 v[214:215], v10 offset:12288
v_mfma_f32_16x16x32_bf16 v[136:139], v[80:83], v[68:71], v[136:139]
ds_read_b64_tr_b16 v[216:217], v11 offset:8192
v_mfma_f32_16x16x32_bf16 v[144:147], v[80:83], v[72:75], v[144:147]
ds_read_b64_tr_b16 v[218:219], v11 offset:12288
v_mfma_f32_16x16x32_bf16 v[152:155], v[80:83], v[76:79], v[152:155]
ds_read_b64_tr_b16 v[220:221], v12 offset:8192
v_mfma_f32_16x16x32_bf16 v[156:159], v[84:87], v[76:79], v[156:159]
ds_read_b64_tr_b16 v[222:223], v12 offset:12288
v_mfma_f32_16x16x32_bf16 v[148:151], v[84:87], v[72:75], v[148:151]
ds_read_b128 v[196:199], v19 offset:9216
v_mfma_f32_16x16x32_bf16 v[140:143], v[84:87], v[68:71], v[140:143]
ds_read_b128 v[200:203], v19 offset:10240
v_mfma_f32_16x16x32_bf16 v[132:135], v[84:87], v[64:67], v[132:135]
ds_read_b128 v[204:207], v19 offset:11264
v_mfma_f32_16x16x32_bf16 v[160:163], v[88:91], v[64:67], v[160:163]
v_mfma_f32_16x16x32_bf16 v[168:171], v[88:91], v[68:71], v[168:171]
v_mfma_f32_16x16x32_bf16 v[176:179], v[88:91], v[72:75], v[176:179]
v_mfma_f32_16x16x32_bf16 v[184:187], v[88:91], v[76:79], v[184:187]
v_mfma_f32_16x16x32_bf16 v[188:191], v[92:95], v[76:79], v[188:191]
v_mfma_f32_16x16x32_bf16 v[180:183], v[92:95], v[72:75], v[180:183]
v_mfma_f32_16x16x32_bf16 v[172:175], v[92:95], v[68:71], v[172:175]
v_mfma_f32_16x16x32_bf16 v[164:167], v[92:95], v[64:67], v[164:167]
s_mov_b32 s41, 2
Lk4_121:
s_waitcnt vmcnt(8)
s_waitcnt lgkmcnt(0)
s_barrier
v_mfma_f32_16x16x32_bf16 v[128:131], v[112:115], v[96:99], v[128:131]
ds_read_b128 v[32:35], v17 offset:16384
v_mfma_f32_16x16x32_bf16 v[136:139], v[112:115], v[100:103], v[136:139]
ds_read_b64_tr_b16 v[48:49], v9 offset:32768
v_mfma_f32_16x16x32_bf16 v[144:147], v[112:115], v[104:107], v[144:147]
ds_read_b64_tr_b16 v[50:51], v9 offset:36864
v_mfma_f32_16x16x32_bf16 v[152:155], v[112:115], v[108:111], v[152:155]
ds_read_b64_tr_b16 v[52:53], v10 offset:32768
v_mfma_f32_16x16x32_bf16 v[156:159], v[116:119], v[108:111], v[156:159]
ds_read_b64_tr_b16 v[54:55], v10 offset:36864
v_mfma_f32_16x16x32_bf16 v[148:151], v[116:119], v[104:107], v[148:151]
ds_read_b64_tr_b16 v[56:57], v11 offset:32768
v_mfma_f32_16x16x32_bf16 v[140:143], v[116:119], v[100:103], v[140:143]
ds_read_b64_tr_b16 v[58:59], v11 offset:36864
v_mfma_f32_16x16x32_bf16 v[132:135], v[116:119], v[96:99], v[132:135]
ds_read_b64_tr_b16 v[60:61], v12 offset:32768
v_mfma_f32_16x16x32_bf16 v[160:163], v[120:123], v[96:99], v[160:163]
ds_read_b64_tr_b16 v[62:63], v12 offset:36864
v_mfma_f32_16x16x32_bf16 v[168:171], v[120:123], v[100:103], v[168:171]
ds_read_b128 v[36:39], v17 offset:17408
v_mfma_f32_16x16x32_bf16 v[176:179], v[120:123], v[104:107], v[176:179]
ds_read_b128 v[40:43], v17 offset:18432
v_mfma_f32_16x16x32_bf16 v[184:187], v[120:123], v[108:111], v[184:187]
ds_read_b128 v[44:47], v17 offset:19456
v_mfma_f32_16x16x32_bf16 v[188:191], v[124:127], v[108:111], v[188:191]
ds_read_b128 v[64:67], v17 offset:24576
v_mfma_f32_16x16x32_bf16 v[180:183], v[124:127], v[104:107], v[180:183]
ds_read_b64_tr_b16 v[80:81], v9 offset:40960
v_mfma_f32_16x16x32_bf16 v[172:175], v[124:127], v[100:103], v[172:175]
ds_read_b64_tr_b16 v[82:83], v9 offset:45056
v_mfma_f32_16x16x32_bf16 v[164:167], v[124:127], v[96:99], v[164:167]
ds_read_b64_tr_b16 v[84:85], v10 offset:40960
v_mfma_f32_16x16x32_bf16 v[128:131], v[208:211], v[192:195], v[128:131]
ds_read_b64_tr_b16 v[86:87], v10 offset:45056
v_mfma_f32_16x16x32_bf16 v[136:139], v[208:211], v[196:199], v[136:139]
ds_read_b64_tr_b16 v[88:89], v11 offset:40960
v_mfma_f32_16x16x32_bf16 v[144:147], v[208:211], v[200:203], v[144:147]
ds_read_b64_tr_b16 v[90:91], v11 offset:45056
v_mfma_f32_16x16x32_bf16 v[152:155], v[208:211], v[204:207], v[152:155]
ds_read_b64_tr_b16 v[92:93], v12 offset:40960
v_mfma_f32_16x16x32_bf16 v[156:159], v[212:215], v[204:207], v[156:159]
ds_read_b64_tr_b16 v[94:95], v12 offset:45056
v_mfma_f32_16x16x32_bf16 v[148:151], v[212:215], v[200:203], v[148:151]
ds_read_b128 v[68:71], v17 offset:25600
v_mfma_f32_16x16x32_bf16 v[140:143], v[212:215], v[196:199], v[140:143]
ds_read_b128 v[72:75], v17 offset:26624
v_mfma_f32_16x16x32_bf16 v[132:135], v[212:215], v[192:195], v[132:135]
ds_read_b128 v[76:79], v17 offset:27648
v_mfma_f32_16x16x32_bf16 v[160:163], v[216:219], v[192:195], v[160:163]
v_mfma_f32_16x16x32_bf16 v[168:171], v[216:219], v[196:199], v[168:171]
v_mfma_f32_16x16x32_bf16 v[176:179], v[216:219], v[200:203], v[176:179]
v_mfma_f32_16x16x32_bf16 v[184:187], v[216:219], v[204:207], v[184:187]
v_mfma_f32_16x16x32_bf16 v[188:191], v[220:223], v[204:207], v[188:191]
v_mfma_f32_16x16x32_bf16 v[180:183], v[220:223], v[200:203], v[180:183]
v_mfma_f32_16x16x32_bf16 v[172:175], v[220:223], v[196:199], v[172:175]
v_mfma_f32_16x16x32_bf16 v[164:167], v[220:223], v[192:195], v[164:167]
s_waitcnt vmcnt(0)
s_waitcnt lgkmcnt(0)
s_barrier
v_mfma_f32_16x16x32_bf16 v[128:131], v[48:51], v[32:35], v[128:131]
ds_read_b128 v[96:99], v17 offset:49152
v_mfma_f32_16x16x32_bf16 v[136:139], v[48:51], v[36:39], v[136:139]
ds_read_b64_tr_b16 v[112:113], v13 offset:0
v_mfma_f32_16x16x32_bf16 v[144:147], v[48:51], v[40:43], v[144:147]
ds_read_b64_tr_b16 v[114:115], v13 offset:4096
v_mfma_f32_16x16x32_bf16 v[152:155], v[48:51], v[44:47], v[152:155]
ds_read_b64_tr_b16 v[116:117], v14 offset:0
v_mfma_f32_16x16x32_bf16 v[156:159], v[52:55], v[44:47], v[156:159]
ds_read_b64_tr_b16 v[118:119], v14 offset:4096
v_mfma_f32_16x16x32_bf16 v[148:151], v[52:55], v[40:43], v[148:151]
ds_read_b64_tr_b16 v[120:121], v15 offset:0
v_mfma_f32_16x16x32_bf16 v[140:143], v[52:55], v[36:39], v[140:143]
ds_read_b64_tr_b16 v[122:123], v15 offset:4096
v_mfma_f32_16x16x32_bf16 v[132:135], v[52:55], v[32:35], v[132:135]
ds_read_b64_tr_b16 v[124:125], v16 offset:0
v_mfma_f32_16x16x32_bf16 v[160:163], v[56:59], v[32:35], v[160:163]
ds_read_b64_tr_b16 v[126:127], v16 offset:4096
v_mfma_f32_16x16x32_bf16 v[168:171], v[56:59], v[36:39], v[168:171]
ds_read_b128 v[100:103], v17 offset:50176
v_mfma_f32_16x16x32_bf16 v[176:179], v[56:59], v[40:43], v[176:179]
ds_read_b128 v[104:107], v17 offset:51200
v_mfma_f32_16x16x32_bf16 v[184:187], v[56:59], v[44:47], v[184:187]
ds_read_b128 v[108:111], v17 offset:52224
v_mfma_f32_16x16x32_bf16 v[188:191], v[60:63], v[44:47], v[188:191]
ds_read_b128 v[192:195], v17 offset:57344
v_mfma_f32_16x16x32_bf16 v[180:183], v[60:63], v[40:43], v[180:183]
ds_read_b64_tr_b16 v[208:209], v13 offset:8192
v_mfma_f32_16x16x32_bf16 v[172:175], v[60:63], v[36:39], v[172:175]
ds_read_b64_tr_b16 v[210:211], v13 offset:12288
v_mfma_f32_16x16x32_bf16 v[164:167], v[60:63], v[32:35], v[164:167]
ds_read_b64_tr_b16 v[212:213], v14 offset:8192
v_mfma_f32_16x16x32_bf16 v[128:131], v[80:83], v[64:67], v[128:131]
ds_read_b64_tr_b16 v[214:215], v14 offset:12288
v_mfma_f32_16x16x32_bf16 v[136:139], v[80:83], v[68:71], v[136:139]
ds_read_b64_tr_b16 v[216:217], v15 offset:8192
v_mfma_f32_16x16x32_bf16 v[144:147], v[80:83], v[72:75], v[144:147]
ds_read_b64_tr_b16 v[218:219], v15 offset:12288
v_mfma_f32_16x16x32_bf16 v[152:155], v[80:83], v[76:79], v[152:155]
ds_read_b64_tr_b16 v[220:221], v16 offset:8192
v_mfma_f32_16x16x32_bf16 v[156:159], v[84:87], v[76:79], v[156:159]
ds_read_b64_tr_b16 v[222:223], v16 offset:12288
v_mfma_f32_16x16x32_bf16 v[148:151], v[84:87], v[72:75], v[148:151]
ds_read_b128 v[196:199], v17 offset:58368
v_mfma_f32_16x16x32_bf16 v[140:143], v[84:87], v[68:71], v[140:143]
ds_read_b128 v[200:203], v17 offset:59392
v_mfma_f32_16x16x32_bf16 v[132:135], v[84:87], v[64:67], v[132:135]
ds_read_b128 v[204:207], v17 offset:60416
v_mfma_f32_16x16x32_bf16 v[160:163], v[88:91], v[64:67], v[160:163]
v_mfma_f32_16x16x32_bf16 v[168:171], v[88:91], v[68:71], v[168:171]
v_mfma_f32_16x16x32_bf16 v[176:179], v[88:91], v[72:75], v[176:179]
v_mfma_f32_16x16x32_bf16 v[184:187], v[88:91], v[76:79], v[184:187]
v_mfma_f32_16x16x32_bf16 v[188:191], v[92:95], v[76:79], v[188:191]
v_mfma_f32_16x16x32_bf16 v[180:183], v[92:95], v[72:75], v[180:183]
v_mfma_f32_16x16x32_bf16 v[172:175], v[92:95], v[68:71], v[172:175]
v_mfma_f32_16x16x32_bf16 v[164:167], v[92:95], v[64:67], v[164:167]
s_waitcnt lgkmcnt(0)
s_barrier
v_mfma_f32_16x16x32_bf16 v[128:131], v[112:115], v[96:99], v[128:131]
ds_read_b128 v[32:35], v18 offset:16384
v_mfma_f32_16x16x32_bf16 v[136:139], v[112:115], v[100:103], v[136:139]
ds_read_b64_tr_b16 v[48:49], v25 offset:16384
v_mfma_f32_16x16x32_bf16 v[144:147], v[112:115], v[104:107], v[144:147]
ds_read_b64_tr_b16 v[50:51], v25 offset:20480
v_mfma_f32_16x16x32_bf16 v[152:155], v[112:115], v[108:111], v[152:155]
ds_read_b64_tr_b16 v[52:53], v26 offset:16384
v_mfma_f32_16x16x32_bf16 v[156:159], v[116:119], v[108:111], v[156:159]
ds_read_b64_tr_b16 v[54:55], v26 offset:20480
v_mfma_f32_16x16x32_bf16 v[148:151], v[116:119], v[104:107], v[148:151]
ds_read_b64_tr_b16 v[56:57], v27 offset:16384
v_mfma_f32_16x16x32_bf16 v[140:143], v[116:119], v[100:103], v[140:143]
ds_read_b64_tr_b16 v[58:59], v27 offset:20480
v_mfma_f32_16x16x32_bf16 v[132:135], v[116:119], v[96:99], v[132:135]
ds_read_b64_tr_b16 v[60:61], v28 offset:16384
v_mfma_f32_16x16x32_bf16 v[160:163], v[120:123], v[96:99], v[160:163]
ds_read_b64_tr_b16 v[62:63], v28 offset:20480
v_mfma_f32_16x16x32_bf16 v[168:171], v[120:123], v[100:103], v[168:171]
ds_read_b128 v[36:39], v18 offset:17408
v_mfma_f32_16x16x32_bf16 v[176:179], v[120:123], v[104:107], v[176:179]
ds_read_b128 v[40:43], v18 offset:18432
v_mfma_f32_16x16x32_bf16 v[184:187], v[120:123], v[108:111], v[184:187]
ds_read_b128 v[44:47], v18 offset:19456
v_mfma_f32_16x16x32_bf16 v[188:191], v[124:127], v[108:111], v[188:191]
ds_read_b128 v[64:67], v18 offset:24576
v_mfma_f32_16x16x32_bf16 v[180:183], v[124:127], v[104:107], v[180:183]
ds_read_b64_tr_b16 v[80:81], v25 offset:24576
s_branch Lov_11
.p2align 12
.fill 80, 4, 0xbf800000
Lst_11_0:
s_branch Lwr_156
Lst_11_1:
s_branch Lst_15_0
s_nop 0
Lov_11:
v_mfma_f32_16x16x32_bf16 v[172:175], v[124:127], v[100:103], v[172:175]
ds_read_b64_tr_b16 v[82:83], v25 offset:28672
v_mfma_f32_16x16x32_bf16 v[164:167], v[124:127], v[96:99], v[164:167]
ds_read_b64_tr_b16 v[84:85], v26 offset:24576
v_mfma_f32_16x16x32_bf16 v[128:131], v[208:211], v[192:195], v[128:131]
ds_read_b64_tr_b16 v[86:87], v26 offset:28672
v_mfma_f32_16x16x32_bf16 v[136:139], v[208:211], v[196:199], v[136:139]
ds_read_b64_tr_b16 v[88:89], v27 offset:24576
v_mfma_f32_16x16x32_bf16 v[144:147], v[208:211], v[200:203], v[144:147]
ds_read_b64_tr_b16 v[90:91], v27 offset:28672
v_mfma_f32_16x16x32_bf16 v[152:155], v[208:211], v[204:207], v[152:155]
ds_read_b64_tr_b16 v[92:93], v28 offset:24576
v_mfma_f32_16x16x32_bf16 v[156:159], v[212:215], v[204:207], v[156:159]
ds_read_b64_tr_b16 v[94:95], v28 offset:28672
v_mfma_f32_16x16x32_bf16 v[148:151], v[212:215], v[200:203], v[148:151]
ds_read_b128 v[68:71], v18 offset:25600
v_mfma_f32_16x16x32_bf16 v[140:143], v[212:215], v[196:199], v[140:143]
ds_read_b128 v[72:75], v18 offset:26624
v_mfma_f32_16x16x32_bf16 v[132:135], v[212:215], v[192:195], v[132:135]
ds_read_b128 v[76:79], v18 offset:27648
v_mfma_f32_16x16x32_bf16 v[160:163], v[216:219], v[192:195], v[160:163]
v_mfma_f32_16x16x32_bf16 v[168:171], v[216:219], v[196:199], v[168:171]
v_mfma_f32_16x16x32_bf16 v[176:179], v[216:219], v[200:203], v[176:179]
v_mfma_f32_16x16x32_bf16 v[184:187], v[216:219], v[204:207], v[184:187]
v_mfma_f32_16x16x32_bf16 v[188:191], v[220:223], v[204:207], v[188:191]
v_mfma_f32_16x16x32_bf16 v[180:183], v[220:223], v[200:203], v[180:183]
v_mfma_f32_16x16x32_bf16 v[172:175], v[220:223], v[196:199], v[172:175]
v_mfma_f32_16x16x32_bf16 v[164:167], v[220:223], v[192:195], v[164:167]
s_waitcnt lgkmcnt(0)
s_barrier
v_mfma_f32_16x16x32_bf16 v[128:131], v[48:51], v[32:35], v[128:131]
ds_read_b128 v[96:99], v18 offset:32768
v_mfma_f32_16x16x32_bf16 v[136:139], v[48:51], v[36:39], v[136:139]
ds_read_b64_tr_b16 v[112:113], v13 offset:49152
v_mfma_f32_16x16x32_bf16 v[144:147], v[48:51], v[40:43], v[144:147]
ds_read_b64_tr_b16 v[114:115], v13 offset:53248
v_mfma_f32_16x16x32_bf16 v[152:155], v[48:51], v[44:47], v[152:155]
ds_read_b64_tr_b16 v[116:117], v14 offset:49152
v_mfma_f32_16x16x32_bf16 v[156:159], v[52:55], v[44:47], v[156:159]
ds_read_b64_tr_b16 v[118:119], v14 offset:53248
v_mfma_f32_16x16x32_bf16 v[148:151], v[52:55], v[40:43], v[148:151]
ds_read_b64_tr_b16 v[120:121], v15 offset:49152
v_mfma_f32_16x16x32_bf16 v[140:143], v[52:55], v[36:39], v[140:143]
ds_read_b64_tr_b16 v[122:123], v15 offset:53248
v_mfma_f32_16x16x32_bf16 v[132:135], v[52:55], v[32:35], v[132:135]
ds_read_b64_tr_b16 v[124:125], v16 offset:49152
v_mfma_f32_16x16x32_bf16 v[160:163], v[56:59], v[32:35], v[160:163]
ds_read_b64_tr_b16 v[126:127], v16 offset:53248
v_mfma_f32_16x16x32_bf16 v[168:171], v[56:59], v[36:39], v[168:171]
ds_read_b128 v[100:103], v18 offset:33792
v_mfma_f32_16x16x32_bf16 v[176:179], v[56:59], v[40:43], v[176:179]
ds_read_b128 v[104:107], v18 offset:34816
v_mfma_f32_16x16x32_bf16 v[184:187], v[56:59], v[44:47], v[184:187]
ds_read_b128 v[108:111], v18 offset:35840
v_mfma_f32_16x16x32_bf16 v[188:191], v[60:63], v[44:47], v[188:191]
ds_read_b128 v[192:195], v18 offset:40960
v_mfma_f32_16x16x32_bf16 v[180:183], v[60:63], v[40:43], v[180:183]
ds_read_b64_tr_b16 v[208:209], v13 offset:57344
v_mfma_f32_16x16x32_bf16 v[172:175], v[60:63], v[36:39], v[172:175]
ds_read_b64_tr_b16 v[210:211], v13 offset:61440
v_mfma_f32_16x16x32_bf16 v[164:167], v[60:63], v[32:35], v[164:167]
ds_read_b64_tr_b16 v[212:213], v14 offset:57344
v_mfma_f32_16x16x32_bf16 v[128:131], v[80:83], v[64:67], v[128:131]
ds_read_b64_tr_b16 v[214:215], v14 offset:61440
v_mfma_f32_16x16x32_bf16 v[136:139], v[80:83], v[68:71], v[136:139]
ds_read_b64_tr_b16 v[216:217], v15 offset:57344
v_mfma_f32_16x16x32_bf16 v[144:147], v[80:83], v[72:75], v[144:147]
ds_read_b64_tr_b16 v[218:219], v15 offset:61440
v_mfma_f32_16x16x32_bf16 v[152:155], v[80:83], v[76:79], v[152:155]
ds_read_b64_tr_b16 v[220:221], v16 offset:57344
v_mfma_f32_16x16x32_bf16 v[156:159], v[84:87], v[76:79], v[156:159]
ds_read_b64_tr_b16 v[222:223], v16 offset:61440
v_mfma_f32_16x16x32_bf16 v[148:151], v[84:87], v[72:75], v[148:151]
ds_read_b128 v[196:199], v18 offset:41984
v_mfma_f32_16x16x32_bf16 v[140:143], v[84:87], v[68:71], v[140:143]
ds_read_b128 v[200:203], v18 offset:43008
v_mfma_f32_16x16x32_bf16 v[132:135], v[84:87], v[64:67], v[132:135]
ds_read_b128 v[204:207], v18 offset:44032
v_mfma_f32_16x16x32_bf16 v[160:163], v[88:91], v[64:67], v[160:163]
v_mfma_f32_16x16x32_bf16 v[168:171], v[88:91], v[68:71], v[168:171]
v_mfma_f32_16x16x32_bf16 v[176:179], v[88:91], v[72:75], v[176:179]
v_mfma_f32_16x16x32_bf16 v[184:187], v[88:91], v[76:79], v[184:187]
v_mfma_f32_16x16x32_bf16 v[188:191], v[92:95], v[76:79], v[188:191]
v_mfma_f32_16x16x32_bf16 v[180:183], v[92:95], v[72:75], v[180:183]
v_mfma_f32_16x16x32_bf16 v[172:175], v[92:95], v[68:71], v[172:175]
v_mfma_f32_16x16x32_bf16 v[164:167], v[92:95], v[64:67], v[164:167]
s_waitcnt lgkmcnt(0)
s_barrier
v_mfma_f32_16x16x32_bf16 v[128:131], v[112:115], v[96:99], v[128:131]
ds_read_b128 v[32:35], v19 offset:0
v_mfma_f32_16x16x32_bf16 v[136:139], v[112:115], v[100:103], v[136:139]
ds_read_b64_tr_b16 v[48:49], v9 offset:0
v_mfma_f32_16x16x32_bf16 v[144:147], v[112:115], v[104:107], v[144:147]
ds_read_b64_tr_b16 v[50:51], v9 offset:4096
v_mfma_f32_16x16x32_bf16 v[152:155], v[112:115], v[108:111], v[152:155]
ds_read_b64_tr_b16 v[52:53], v10 offset:0
v_mfma_f32_16x16x32_bf16 v[156:159], v[116:119], v[108:111], v[156:159]
ds_read_b64_tr_b16 v[54:55], v10 offset:4096
v_mfma_f32_16x16x32_bf16 v[148:151], v[116:119], v[104:107], v[148:151]
ds_read_b64_tr_b16 v[56:57], v11 offset:0
v_mfma_f32_16x16x32_bf16 v[140:143], v[116:119], v[100:103], v[140:143]
ds_read_b64_tr_b16 v[58:59], v11 offset:4096
v_mfma_f32_16x16x32_bf16 v[132:135], v[116:119], v[96:99], v[132:135]
ds_read_b64_tr_b16 v[60:61], v12 offset:0
v_mfma_f32_16x16x32_bf16 v[160:163], v[120:123], v[96:99], v[160:163]
ds_read_b64_tr_b16 v[62:63], v12 offset:4096
v_mfma_f32_16x16x32_bf16 v[168:171], v[120:123], v[100:103], v[168:171]
ds_read_b128 v[36:39], v19 offset:1024
v_mfma_f32_16x16x32_bf16 v[176:179], v[120:123], v[104:107], v[176:179]
ds_read_b128 v[40:43], v19 offset:2048
v_mfma_f32_16x16x32_bf16 v[184:187], v[120:123], v[108:111], v[184:187]
ds_read_b128 v[44:47], v19 offset:3072
v_mfma_f32_16x16x32_bf16 v[188:191], v[124:127], v[108:111], v[188:191]
ds_read_b128 v[64:67], v19 offset:8192
v_mfma_f32_16x16x32_bf16 v[180:183], v[124:127], v[104:107], v[180:183]
ds_read_b64_tr_b16 v[80:81], v9 offset:8192
v_mfma_f32_16x16x32_bf16 v[172:175], v[124:127], v[100:103], v[172:175]
ds_read_b64_tr_b16 v[82:83], v9 offset:12288
v_mfma_f32_16x16x32_bf16 v[164:167], v[124:127], v[96:99], v[164:167]
ds_read_b64_tr_b16 v[84:85], v10 offset:8192
v_mfma_f32_16x16x32_bf16 v[128:131], v[208:211], v[192:195], v[128:131]
ds_read_b64_tr_b16 v[86:87], v10 offset:12288
v_mfma_f32_16x16x32_bf16 v[136:139], v[208:211], v[196:199], v[136:139]
ds_read_b64_tr_b16 v[88:89], v11 offset:8192
v_mfma_f32_16x16x32_bf16 v[144:147], v[208:211], v[200:203], v[144:147]
ds_read_b64_tr_b16 v[90:91], v11 offset:12288
v_mfma_f32_16x16x32_bf16 v[152:155], v[208:211], v[204:207], v[152:155]
ds_read_b64_tr_b16 v[92:93], v12 offset:8192
v_mfma_f32_16x16x32_bf16 v[156:159], v[212:215], v[204:207], v[156:159]
ds_read_b64_tr_b16 v[94:95], v12 offset:12288
v_mfma_f32_16x16x32_bf16 v[148:151], v[212:215], v[200:203], v[148:151]
ds_read_b128 v[68:71], v19 offset:9216
v_mfma_f32_16x16x32_bf16 v[140:143], v[212:215], v[196:199], v[140:143]
ds_read_b128 v[72:75], v19 offset:10240
v_mfma_f32_16x16x32_bf16 v[132:135], v[212:215], v[192:195], v[132:135]
ds_read_b128 v[76:79], v19 offset:11264
v_mfma_f32_16x16x32_bf16 v[160:163], v[216:219], v[192:195], v[160:163]
v_mfma_f32_16x16x32_bf16 v[168:171], v[216:219], v[196:199], v[168:171]
v_mfma_f32_16x16x32_bf16 v[176:179], v[216:219], v[200:203], v[176:179]
v_mfma_f32_16x16x32_bf16 v[184:187], v[216:219], v[204:207], v[184:187]
v_mfma_f32_16x16x32_bf16 v[188:191], v[220:223], v[204:207], v[188:191]
v_mfma_f32_16x16x32_bf16 v[180:183], v[220:223], v[200:203], v[180:183]
v_mfma_f32_16x16x32_bf16 v[172:175], v[220:223], v[196:199], v[172:175]
v_mfma_f32_16x16x32_bf16 v[164:167], v[220:223], v[192:195], v[164:167]
s_waitcnt lgkmcnt(0)
s_barrier
v_mfma_f32_16x16x32_bf16 v[128:131], v[48:51], v[32:35], v[128:131]
ds_read_b128 v[96:99], v17 offset:16384
v_mfma_f32_16x16x32_bf16 v[136:139], v[48:51], v[36:39], v[136:139]
ds_read_b64_tr_b16 v[112:113], v9 offset:32768
v_mfma_f32_16x16x32_bf16 v[144:147], v[48:51], v[40:43], v[144:147]
ds_read_b64_tr_b16 v[114:115], v9 offset:36864
v_mfma_f32_16x16x32_bf16 v[152:155], v[48:51], v[44:47], v[152:155]
ds_read_b64_tr_b16 v[116:117], v10 offset:32768
v_mfma_f32_16x16x32_bf16 v[156:159], v[52:55], v[44:47], v[156:159]
ds_read_b64_tr_b16 v[118:119], v10 offset:36864
v_mfma_f32_16x16x32_bf16 v[148:151], v[52:55], v[40:43], v[148:151]
ds_read_b64_tr_b16 v[120:121], v11 offset:32768
v_mfma_f32_16x16x32_bf16 v[140:143], v[52:55], v[36:39], v[140:143]
ds_read_b64_tr_b16 v[122:123], v11 offset:36864
v_mfma_f32_16x16x32_bf16 v[132:135], v[52:55], v[32:35], v[132:135]
ds_read_b64_tr_b16 v[124:125], v12 offset:32768
v_mfma_f32_16x16x32_bf16 v[160:163], v[56:59], v[32:35], v[160:163]
ds_read_b64_tr_b16 v[126:127], v12 offset:36864
v_mfma_f32_16x16x32_bf16 v[168:171], v[56:59], v[36:39], v[168:171]
ds_read_b128 v[100:103], v17 offset:17408
v_mfma_f32_16x16x32_bf16 v[176:179], v[56:59], v[40:43], v[176:179]
ds_read_b128 v[104:107], v17 offset:18432
v_mfma_f32_16x16x32_bf16 v[184:187], v[56:59], v[44:47], v[184:187]
ds_read_b128 v[108:111], v17 offset:19456
v_mfma_f32_16x16x32_bf16 v[188:191], v[60:63], v[44:47], v[188:191]
ds_read_b128 v[192:195], v17 offset:24576
v_mfma_f32_16x16x32_bf16 v[180:183], v[60:63], v[40:43], v[180:183]
ds_read_b64_tr_b16 v[208:209], v9 offset:40960
v_mfma_f32_16x16x32_bf16 v[172:175], v[60:63], v[36:39], v[172:175]
ds_read_b64_tr_b16 v[210:211], v9 offset:45056
v_mfma_f32_16x16x32_bf16 v[164:167], v[60:63], v[32:35], v[164:167]
ds_read_b64_tr_b16 v[212:213], v10 offset:40960
v_mfma_f32_16x16x32_bf16 v[128:131], v[80:83], v[64:67], v[128:131]
ds_read_b64_tr_b16 v[214:215], v10 offset:45056
v_mfma_f32_16x16x32_bf16 v[136:139], v[80:83], v[68:71], v[136:139]
ds_read_b64_tr_b16 v[216:217], v11 offset:40960
v_mfma_f32_16x16x32_bf16 v[144:147], v[80:83], v[72:75], v[144:147]
ds_read_b64_tr_b16 v[218:219], v11 offset:45056
v_mfma_f32_16x16x32_bf16 v[152:155], v[80:83], v[76:79], v[152:155]
ds_read_b64_tr_b16 v[220:221], v12 offset:40960
v_mfma_f32_16x16x32_bf16 v[156:159], v[84:87], v[76:79], v[156:159]
ds_read_b64_tr_b16 v[222:223], v12 offset:45056
v_mfma_f32_16x16x32_bf16 v[148:151], v[84:87], v[72:75], v[148:151]
ds_read_b128 v[196:199], v17 offset:25600
v_mfma_f32_16x16x32_bf16 v[140:143], v[84:87], v[68:71], v[140:143]
ds_read_b128 v[200:203], v17 offset:26624
v_mfma_f32_16x16x32_bf16 v[132:135], v[84:87], v[64:67], v[132:135]
ds_read_b128 v[204:207], v17 offset:27648
v_mfma_f32_16x16x32_bf16 v[160:163], v[88:91], v[64:67], v[160:163]
v_mfma_f32_16x16x32_bf16 v[168:171], v[88:91], v[68:71], v[168:171]
v_mfma_f32_16x16x32_bf16 v[176:179], v[88:91], v[72:75], v[176:179]
v_mfma_f32_16x16x32_bf16 v[184:187], v[88:91], v[76:79], v[184:187]
v_mfma_f32_16x16x32_bf16 v[188:191], v[92:95], v[76:79], v[188:191]
v_mfma_f32_16x16x32_bf16 v[180:183], v[92:95], v[72:75], v[180:183]
v_mfma_f32_16x16x32_bf16 v[172:175], v[92:95], v[68:71], v[172:175]
v_mfma_f32_16x16x32_bf16 v[164:167], v[92:95], v[64:67], v[164:167]
s_waitcnt lgkmcnt(0)
s_barrier
v_mfma_f32_16x16x32_bf16 v[128:131], v[112:115], v[96:99], v[128:131]
ds_read_b128 v[32:35], v17 offset:49152
v_mfma_f32_16x16x32_bf16 v[136:139], v[112:115], v[100:103], v[136:139]
ds_read_b64_tr_b16 v[48:49], v13 offset:0
v_mfma_f32_16x16x32_bf16 v[144:147], v[112:115], v[104:107], v[144:147]
ds_read_b64_tr_b16 v[50:51], v13 offset:4096
v_mfma_f32_16x16x32_bf16 v[152:155], v[112:115], v[108:111], v[152:155]
ds_read_b64_tr_b16 v[52:53], v14 offset:0
v_mfma_f32_16x16x32_bf16 v[156:159], v[116:119], v[108:111], v[156:159]
ds_read_b64_tr_b16 v[54:55], v14 offset:4096
v_mfma_f32_16x16x32_bf16 v[148:151], v[116:119], v[104:107], v[148:151]
ds_read_b64_tr_b16 v[56:57], v15 offset:0
v_mfma_f32_16x16x32_bf16 v[140:143], v[116:119], v[100:103], v[140:143]
ds_read_b64_tr_b16 v[58:59], v15 offset:4096
v_mfma_f32_16x16x32_bf16 v[132:135], v[116:119], v[96:99], v[132:135]
ds_read_b64_tr_b16 v[60:61], v16 offset:0
v_mfma_f32_16x16x32_bf16 v[160:163], v[120:123], v[96:99], v[160:163]
ds_read_b64_tr_b16 v[62:63], v16 offset:4096
v_mfma_f32_16x16x32_bf16 v[168:171], v[120:123], v[100:103], v[168:171]
ds_read_b128 v[36:39], v17 offset:50176
v_mfma_f32_16x16x32_bf16 v[176:179], v[120:123], v[104:107], v[176:179]
ds_read_b128 v[40:43], v17 offset:51200
v_mfma_f32_16x16x32_bf16 v[184:187], v[120:123], v[108:111], v[184:187]
ds_read_b128 v[44:47], v17 offset:52224
v_mfma_f32_16x16x32_bf16 v[188:191], v[124:127], v[108:111], v[188:191]
ds_read_b128 v[64:67], v17 offset:57344
v_mfma_f32_16x16x32_bf16 v[180:183], v[124:127], v[104:107], v[180:183]
ds_read_b64_tr_b16 v[80:81], v13 offset:8192
v_mfma_f32_16x16x32_bf16 v[172:175], v[124:127], v[100:103], v[172:175]
ds_read_b64_tr_b16 v[82:83], v13 offset:12288
v_mfma_f32_16x16x32_bf16 v[164:167], v[124:127], v[96:99], v[164:167]
ds_read_b64_tr_b16 v[84:85], v14 offset:8192
v_mfma_f32_16x16x32_bf16 v[128:131], v[208:211], v[192:195], v[128:131]
ds_read_b64_tr_b16 v[86:87], v14 offset:12288
v_mfma_f32_16x16x32_bf16 v[136:139], v[208:211], v[196:199], v[136:139]
ds_read_b64_tr_b16 v[88:89], v15 offset:8192
v_mfma_f32_16x16x32_bf16 v[144:147], v[208:211], v[200:203], v[144:147]
ds_read_b64_tr_b16 v[90:91], v15 offset:12288
v_mfma_f32_16x16x32_bf16 v[152:155], v[208:211], v[204:207], v[152:155]
ds_read_b64_tr_b16 v[92:93], v16 offset:8192
v_mfma_f32_16x16x32_bf16 v[156:159], v[212:215], v[204:207], v[156:159]
ds_read_b64_tr_b16 v[94:95], v16 offset:12288
v_mfma_f32_16x16x32_bf16 v[148:151], v[212:215], v[200:203], v[148:151]
ds_read_b128 v[68:71], v17 offset:58368
v_mfma_f32_16x16x32_bf16 v[140:143], v[212:215], v[196:199], v[140:143]
ds_read_b128 v[72:75], v17 offset:59392
v_mfma_f32_16x16x32_bf16 v[132:135], v[212:215], v[192:195], v[132:135]
ds_read_b128 v[76:79], v17 offset:60416
v_mfma_f32_16x16x32_bf16 v[160:163], v[216:219], v[192:195], v[160:163]
v_mfma_f32_16x16x32_bf16 v[168:171], v[216:219], v[196:199], v[168:171]
v_mfma_f32_16x16x32_bf16 v[176:179], v[216:219], v[200:203], v[176:179]
v_mfma_f32_16x16x32_bf16 v[184:187], v[216:219], v[204:207], v[184:187]
v_mfma_f32_16x16x32_bf16 v[188:191], v[220:223], v[204:207], v[188:191]
v_mfma_f32_16x16x32_bf16 v[180:183], v[220:223], v[200:203], v[180:183]
v_mfma_f32_16x16x32_bf16 v[172:175], v[220:223], v[196:199], v[172:175]
v_mfma_f32_16x16x32_bf16 v[164:167], v[220:223], v[192:195], v[164:167]
s_waitcnt lgkmcnt(0)
s_barrier
v_mfma_f32_16x16x32_bf16 v[128:131], v[48:51], v[32:35], v[128:131]
ds_read_b128 v[96:99], v18 offset:16384
v_mfma_f32_16x16x32_bf16 v[136:139], v[48:51], v[36:39], v[136:139]
ds_read_b64_tr_b16 v[112:113], v25 offset:16384
v_mfma_f32_16x16x32_bf16 v[144:147], v[48:51], v[40:43], v[144:147]
ds_read_b64_tr_b16 v[114:115], v25 offset:20480
v_mfma_f32_16x16x32_bf16 v[152:155], v[48:51], v[44:47], v[152:155]
ds_read_b64_tr_b16 v[116:117], v26 offset:16384
v_mfma_f32_16x16x32_bf16 v[156:159], v[52:55], v[44:47], v[156:159]
ds_read_b64_tr_b16 v[118:119], v26 offset:20480
v_mfma_f32_16x16x32_bf16 v[148:151], v[52:55], v[40:43], v[148:151]
ds_read_b64_tr_b16 v[120:121], v27 offset:16384
v_mfma_f32_16x16x32_bf16 v[140:143], v[52:55], v[36:39], v[140:143]
ds_read_b64_tr_b16 v[122:123], v27 offset:20480
v_mfma_f32_16x16x32_bf16 v[132:135], v[52:55], v[32:35], v[132:135]
ds_read_b64_tr_b16 v[124:125], v28 offset:16384
v_mfma_f32_16x16x32_bf16 v[160:163], v[56:59], v[32:35], v[160:163]
ds_read_b64_tr_b16 v[126:127], v28 offset:20480
v_mfma_f32_16x16x32_bf16 v[168:171], v[56:59], v[36:39], v[168:171]
ds_read_b128 v[100:103], v18 offset:17408
v_mfma_f32_16x16x32_bf16 v[176:179], v[56:59], v[40:43], v[176:179]
ds_read_b128 v[104:107], v18 offset:18432
v_mfma_f32_16x16x32_bf16 v[184:187], v[56:59], v[44:47], v[184:187]
ds_read_b128 v[108:111], v18 offset:19456
v_mfma_f32_16x16x32_bf16 v[188:191], v[60:63], v[44:47], v[188:191]
ds_read_b128 v[192:195], v18 offset:24576
v_mfma_f32_16x16x32_bf16 v[180:183], v[60:63], v[40:43], v[180:183]
ds_read_b64_tr_b16 v[208:209], v25 offset:24576
v_mfma_f32_16x16x32_bf16 v[172:175], v[60:63], v[36:39], v[172:175]
ds_read_b64_tr_b16 v[210:211], v25 offset:28672
v_mfma_f32_16x16x32_bf16 v[164:167], v[60:63], v[32:35], v[164:167]
ds_read_b64_tr_b16 v[212:213], v26 offset:24576
v_mfma_f32_16x16x32_bf16 v[128:131], v[80:83], v[64:67], v[128:131]
ds_read_b64_tr_b16 v[214:215], v26 offset:28672
v_mfma_f32_16x16x32_bf16 v[136:139], v[80:83], v[68:71], v[136:139]
ds_read_b64_tr_b16 v[216:217], v27 offset:24576
v_mfma_f32_16x16x32_bf16 v[144:147], v[80:83], v[72:75], v[144:147]
ds_read_b64_tr_b16 v[218:219], v27 offset:28672
v_mfma_f32_16x16x32_bf16 v[152:155], v[80:83], v[76:79], v[152:155]
ds_read_b64_tr_b16 v[220:221], v28 offset:24576
v_mfma_f32_16x16x32_bf16 v[156:159], v[84:87], v[76:79], v[156:159]
ds_read_b64_tr_b16 v[222:223], v28 offset:28672
v_mfma_f32_16x16x32_bf16 v[148:151], v[84:87], v[72:75], v[148:151]
ds_read_b128 v[196:199], v18 offset:25600
v_mfma_f32_16x16x32_bf16 v[140:143], v[84:87], v[68:71], v[140:143]
ds_read_b128 v[200:203], v18 offset:26624
v_mfma_f32_16x16x32_bf16 v[132:135], v[84:87], v[64:67], v[132:135]
ds_read_b128 v[204:207], v18 offset:27648
v_mfma_f32_16x16x32_bf16 v[160:163], v[88:91], v[64:67], v[160:163]
v_mfma_f32_16x16x32_bf16 v[168:171], v[88:91], v[68:71], v[168:171]
v_mfma_f32_16x16x32_bf16 v[176:179], v[88:91], v[72:75], v[176:179]
v_mfma_f32_16x16x32_bf16 v[184:187], v[88:91], v[76:79], v[184:187]
v_mfma_f32_16x16x32_bf16 v[188:191], v[92:95], v[76:79], v[188:191]
v_mfma_f32_16x16x32_bf16 v[180:183], v[92:95], v[72:75], v[180:183]
v_mfma_f32_16x16x32_bf16 v[172:175], v[92:95], v[68:71], v[172:175]
v_mfma_f32_16x16x32_bf16 v[164:167], v[92:95], v[64:67], v[164:167]
s_waitcnt lgkmcnt(0)
s_barrier
v_mfma_f32_16x16x32_bf16 v[128:131], v[112:115], v[96:99], v[128:131]
ds_read_b128 v[32:35], v18 offset:32768
v_mfma_f32_16x16x32_bf16 v[136:139], v[112:115], v[100:103], v[136:139]
ds_read_b64_tr_b16 v[48:49], v13 offset:49152
v_mfma_f32_16x16x32_bf16 v[144:147], v[112:115], v[104:107], v[144:147]
ds_read_b64_tr_b16 v[50:51], v13 offset:53248
v_mfma_f32_16x16x32_bf16 v[152:155], v[112:115], v[108:111], v[152:155]
ds_read_b64_tr_b16 v[52:53], v14 offset:49152
v_mfma_f32_16x16x32_bf16 v[156:159], v[116:119], v[108:111], v[156:159]
ds_read_b64_tr_b16 v[54:55], v14 offset:53248
v_mfma_f32_16x16x32_bf16 v[148:151], v[116:119], v[104:107], v[148:151]
ds_read_b64_tr_b16 v[56:57], v15 offset:49152
v_mfma_f32_16x16x32_bf16 v[140:143], v[116:119], v[100:103], v[140:143]
ds_read_b64_tr_b16 v[58:59], v15 offset:53248
v_mfma_f32_16x16x32_bf16 v[132:135], v[116:119], v[96:99], v[132:135]
ds_read_b64_tr_b16 v[60:61], v16 offset:49152
v_mfma_f32_16x16x32_bf16 v[160:163], v[120:123], v[96:99], v[160:163]
ds_read_b64_tr_b16 v[62:63], v16 offset:53248
v_mfma_f32_16x16x32_bf16 v[168:171], v[120:123], v[100:103], v[168:171]
ds_read_b128 v[36:39], v18 offset:33792
v_mfma_f32_16x16x32_bf16 v[176:179], v[120:123], v[104:107], v[176:179]
ds_read_b128 v[40:43], v18 offset:34816
v_mfma_f32_16x16x32_bf16 v[184:187], v[120:123], v[108:111], v[184:187]
ds_read_b128 v[44:47], v18 offset:35840
v_mfma_f32_16x16x32_bf16 v[188:191], v[124:127], v[108:111], v[188:191]
ds_read_b128 v[64:67], v18 offset:40960
v_mfma_f32_16x16x32_bf16 v[180:183], v[124:127], v[104:107], v[180:183]
ds_read_b64_tr_b16 v[80:81], v13 offset:57344
v_mfma_f32_16x16x32_bf16 v[172:175], v[124:127], v[100:103], v[172:175]
ds_read_b64_tr_b16 v[82:83], v13 offset:61440
v_mfma_f32_16x16x32_bf16 v[164:167], v[124:127], v[96:99], v[164:167]
ds_read_b64_tr_b16 v[84:85], v14 offset:57344
v_mfma_f32_16x16x32_bf16 v[128:131], v[208:211], v[192:195], v[128:131]
ds_read_b64_tr_b16 v[86:87], v14 offset:61440
v_mfma_f32_16x16x32_bf16 v[136:139], v[208:211], v[196:199], v[136:139]
ds_read_b64_tr_b16 v[88:89], v15 offset:57344
v_mfma_f32_16x16x32_bf16 v[144:147], v[208:211], v[200:203], v[144:147]
ds_read_b64_tr_b16 v[90:91], v15 offset:61440
v_mfma_f32_16x16x32_bf16 v[152:155], v[208:211], v[204:207], v[152:155]
ds_read_b64_tr_b16 v[92:93], v16 offset:57344
v_mfma_f32_16x16x32_bf16 v[156:159], v[212:215], v[204:207], v[156:159]
ds_read_b64_tr_b16 v[94:95], v16 offset:61440
v_mfma_f32_16x16x32_bf16 v[148:151], v[212:215], v[200:203], v[148:151]
ds_read_b128 v[68:71], v18 offset:41984
v_mfma_f32_16x16x32_bf16 v[140:143], v[212:215], v[196:199], v[140:143]
ds_read_b128 v[72:75], v18 offset:43008
v_mfma_f32_16x16x32_bf16 v[132:135], v[212:215], v[192:195], v[132:135]
ds_read_b128 v[76:79], v18 offset:44032
v_mfma_f32_16x16x32_bf16 v[160:163], v[216:219], v[192:195], v[160:163]
v_mfma_f32_16x16x32_bf16 v[168:171], v[216:219], v[196:199], v[168:171]
v_mfma_f32_16x16x32_bf16 v[176:179], v[216:219], v[200:203], v[176:179]
v_mfma_f32_16x16x32_bf16 v[184:187], v[216:219], v[204:207], v[184:187]
v_mfma_f32_16x16x32_bf16 v[188:191], v[220:223], v[204:207], v[188:191]
v_mfma_f32_16x16x32_bf16 v[180:183], v[220:223], v[200:203], v[180:183]
v_mfma_f32_16x16x32_bf16 v[172:175], v[220:223], v[196:199], v[172:175]
v_mfma_f32_16x16x32_bf16 v[164:167], v[220:223], v[192:195], v[164:167]
s_waitcnt lgkmcnt(0)
s_barrier
v_mfma_f32_16x16x32_bf16 v[128:131], v[48:51], v[32:35], v[128:131]
ds_read_b128 v[96:99], v19 offset:0
v_mfma_f32_16x16x32_bf16 v[136:139], v[48:51], v[36:39], v[136:139]
ds_read_b64_tr_b16 v[112:113], v9 offset:0
v_mfma_f32_16x16x32_bf16 v[144:147], v[48:51], v[40:43], v[144:147]
ds_read_b64_tr_b16 v[114:115], v9 offset:4096
v_mfma_f32_16x16x32_bf16 v[152:155], v[48:51], v[44:47], v[152:155]
ds_read_b64_tr_b16 v[116:117], v10 offset:0
v_mfma_f32_16x16x32_bf16 v[156:159], v[52:55], v[44:47], v[156:159]
ds_read_b64_tr_b16 v[118:119], v10 offset:4096
v_mfma_f32_16x16x32_bf16 v[148:151], v[52:55], v[40:43], v[148:151]
ds_read_b64_tr_b16 v[120:121], v11 offset:0
v_mfma_f32_16x16x32_bf16 v[140:143], v[52:55], v[36:39], v[140:143]
ds_read_b64_tr_b16 v[122:123], v11 offset:4096
v_mfma_f32_16x16x32_bf16 v[132:135], v[52:55], v[32:35], v[132:135]
ds_read_b64_tr_b16 v[124:125], v12 offset:0
v_mfma_f32_16x16x32_bf16 v[160:163], v[56:59], v[32:35], v[160:163]
ds_read_b64_tr_b16 v[126:127], v12 offset:4096
v_mfma_f32_16x16x32_bf16 v[168:171], v[56:59], v[36:39], v[168:171]
ds_read_b128 v[100:103], v19 offset:1024
v_mfma_f32_16x16x32_bf16 v[176:179], v[56:59], v[40:43], v[176:179]
ds_read_b128 v[104:107], v19 offset:2048
v_mfma_f32_16x16x32_bf16 v[184:187], v[56:59], v[44:47], v[184:187]
ds_read_b128 v[108:111], v19 offset:3072
v_mfma_f32_16x16x32_bf16 v[188:191], v[60:63], v[44:47], v[188:191]
ds_read_b128 v[192:195], v19 offset:8192
v_mfma_f32_16x16x32_bf16 v[180:183], v[60:63], v[40:43], v[180:183]
ds_read_b64_tr_b16 v[208:209], v9 offset:8192
v_mfma_f32_16x16x32_bf16 v[172:175], v[60:63], v[36:39], v[172:175]
ds_read_b64_tr_b16 v[210:211], v9 offset:12288
v_mfma_f32_16x16x32_bf16 v[164:167], v[60:63], v[32:35], v[164:167]
ds_read_b64_tr_b16 v[212:213], v10 offset:8192
v_mfma_f32_16x16x32_bf16 v[128:131], v[80:83], v[64:67], v[128:131]
ds_read_b64_tr_b16 v[214:215], v10 offset:12288
v_mfma_f32_16x16x32_bf16 v[136:139], v[80:83], v[68:71], v[136:139]
ds_read_b64_tr_b16 v[216:217], v11 offset:8192
v_mfma_f32_16x16x32_bf16 v[144:147], v[80:83], v[72:75], v[144:147]
ds_read_b64_tr_b16 v[218:219], v11 offset:12288
v_mfma_f32_16x16x32_bf16 v[152:155], v[80:83], v[76:79], v[152:155]
ds_read_b64_tr_b16 v[220:221], v12 offset:8192
v_mfma_f32_16x16x32_bf16 v[156:159], v[84:87], v[76:79], v[156:159]
ds_read_b64_tr_b16 v[222:223], v12 offset:12288
v_mfma_f32_16x16x32_bf16 v[148:151], v[84:87], v[72:75], v[148:151]
ds_read_b128 v[196:199], v19 offset:9216
v_mfma_f32_16x16x32_bf16 v[140:143], v[84:87], v[68:71], v[140:143]
ds_read_b128 v[200:203], v19 offset:10240
v_mfma_f32_16x16x32_bf16 v[132:135], v[84:87], v[64:67], v[132:135]
ds_read_b128 v[204:207], v19 offset:11264
v_mfma_f32_16x16x32_bf16 v[160:163], v[88:91], v[64:67], v[160:163]
v_mfma_f32_16x16x32_bf16 v[168:171], v[88:91], v[68:71], v[168:171]
v_mfma_f32_16x16x32_bf16 v[176:179], v[88:91], v[72:75], v[176:179]
v_mfma_f32_16x16x32_bf16 v[184:187], v[88:91], v[76:79], v[184:187]
v_mfma_f32_16x16x32_bf16 v[188:191], v[92:95], v[76:79], v[188:191]
v_mfma_f32_16x16x32_bf16 v[180:183], v[92:95], v[72:75], v[180:183]
v_mfma_f32_16x16x32_bf16 v[172:175], v[92:95], v[68:71], v[172:175]
v_mfma_f32_16x16x32_bf16 v[164:167], v[92:95], v[64:67], v[164:167]
s_sub_u32 s41, s41, 1
s_cmp_lg_u32 s41, 0
s_cbranch_scc1 Lk4_121
s_waitcnt lgkmcnt(0)
s_barrier
v_mfma_f32_16x16x32_bf16 v[128:131], v[112:115], v[96:99], v[128:131]
ds_read_b128 v[32:35], v17 offset:16384
v_mfma_f32_16x16x32_bf16 v[136:139], v[112:115], v[100:103], v[136:139]
ds_read_b64_tr_b16 v[48:49], v224 offset:32768
v_mfma_f32_16x16x32_bf16 v[144:147], v[112:115], v[104:107], v[144:147]
ds_read_b64_tr_b16 v[50:51], v224 offset:34816
v_mfma_f32_16x16x32_bf16 v[152:155], v[112:115], v[108:111], v[152:155]
ds_read_b64_tr_b16 v[52:53], v225 offset:32768
v_mfma_f32_16x16x32_bf16 v[156:159], v[116:119], v[108:111], v[156:159]
ds_read_b64_tr_b16 v[54:55], v225 offset:34816
v_mfma_f32_16x16x32_bf16 v[148:151], v[116:119], v[104:107], v[148:151]
ds_read_b128 v[36:39], v17 offset:17408
v_mfma_f32_16x16x32_bf16 v[140:143], v[116:119], v[100:103], v[140:143]
ds_read_b128 v[40:43], v17 offset:18432
v_mfma_f32_16x16x32_bf16 v[132:135], v[116:119], v[96:99], v[132:135]
ds_read_b128 v[44:47], v17 offset:19456
v_mfma_f32_16x16x32_bf16 v[160:163], v[120:123], v[96:99], v[160:163]
ds_read_b128 v[64:67], v17 offset:24576
v_mfma_f32_16x16x32_bf16 v[168:171], v[120:123], v[100:103], v[168:171]
ds_read_b64_tr_b16 v[80:81], v224 offset:36864
v_mfma_f32_16x16x32_bf16 v[176:179], v[120:123], v[104:107], v[176:179]
ds_read_b64_tr_b16 v[82:83], v224 offset:38912
v_mfma_f32_16x16x32_bf16 v[184:187], v[120:123], v[108:111], v[184:187]
ds_read_b64_tr_b16 v[84:85], v225 offset:36864
v_mfma_f32_16x16x32_bf16 v[188:191], v[124:127], v[108:111], v[188:191]
ds_read_b64_tr_b16 v[86:87], v225 offset:38912
v_mfma_f32_16x16x32_bf16 v[180:183], v[124:127], v[104:107], v[180:183]
ds_read_b128 v[68:71], v17 offset:25600
v_mfma_f32_16x16x32_bf16 v[172:175], v[124:127], v[100:103], v[172:175]
ds_read_b128 v[72:75], v17 offset:26624
v_mfma_f32_16x16x32_bf16 v[164:167], v[124:127], v[96:99], v[164:167]
ds_read_b128 v[76:79], v17 offset:27648
v_mfma_f32_16x16x32_bf16 v[128:131], v[208:211], v[192:195], v[128:131]
v_mfma_f32_16x16x32_bf16 v[136:139], v[208:211], v[196:199], v[136:139]
v_mfma_f32_16x16x32_bf16 v[144:147], v[208:211], v[200:203], v[144:147]
v_mfma_f32_16x16x32_bf16 v[152:155], v[208:211], v[204:207], v[152:155]
v_mfma_f32_16x16x32_bf16 v[156:159], v[212:215], v[204:207], v[156:159]
v_mfma_f32_16x16x32_bf16 v[148:151], v[212:215], v[200:203], v[148:151]
v_mfma_f32_16x16x32_bf16 v[140:143], v[212:215], v[196:199], v[140:143]
v_mfma_f32_16x16x32_bf16 v[132:135], v[212:215], v[192:195], v[132:135]
s_branch Lov_12
.p2align 12
.fill 96, 4, 0xbf800000
Lst_12_0:
s_branch Lwr_157
Lst_12_1:
s_branch Lst_16_0
s_nop 0
Lov_12:
v_mfma_f32_16x16x32_bf16 v[160:163], v[216:219], v[192:195], v[160:163]
v_mfma_f32_16x16x32_bf16 v[168:171], v[216:219], v[196:199], v[168:171]
v_mfma_f32_16x16x32_bf16 v[176:179], v[216:219], v[200:203], v[176:179]
v_mfma_f32_16x16x32_bf16 v[184:187], v[216:219], v[204:207], v[184:187]
v_mfma_f32_16x16x32_bf16 v[188:191], v[220:223], v[204:207], v[188:191]
v_mfma_f32_16x16x32_bf16 v[180:183], v[220:223], v[200:203], v[180:183]
v_mfma_f32_16x16x32_bf16 v[172:175], v[220:223], v[196:199], v[172:175]
v_mfma_f32_16x16x32_bf16 v[164:167], v[220:223], v[192:195], v[164:167]
s_waitcnt lgkmcnt(0)
s_barrier
v_mfma_f32_16x16x32_bf16 v[128:131], v[48:51], v[32:35], v[128:131]
ds_read_b128 v[96:99], v17 offset:49152
ds_read_b64_tr_b16 v[112:113], v226 offset:0
v_mfma_f32_16x16x32_bf16 v[136:139], v[48:51], v[36:39], v[136:139]
ds_read_b64_tr_b16 v[114:115], v226 offset:2048
ds_read_b64_tr_b16 v[116:117], v227 offset:0
v_mfma_f32_16x16x32_bf16 v[144:147], v[48:51], v[40:43], v[144:147]
ds_read_b64_tr_b16 v[118:119], v227 offset:2048
ds_read_b128 v[100:103], v17 offset:50176
v_mfma_f32_16x16x32_bf16 v[152:155], v[48:51], v[44:47], v[152:155]
ds_read_b128 v[104:107], v17 offset:51200
ds_read_b128 v[108:111], v17 offset:52224
v_mfma_f32_16x16x32_bf16 v[156:159], v[52:55], v[44:47], v[156:159]
ds_read_b128 v[192:195], v17 offset:57344
v_mfma_f32_16x16x32_bf16 v[148:151], v[52:55], v[40:43], v[148:151]
ds_read_b64_tr_b16 v[208:209], v226 offset:4096
v_mfma_f32_16x16x32_bf16 v[140:143], v[52:55], v[36:39], v[140:143]
ds_read_b64_tr_b16 v[210:211], v226 offset:6144
v_cvt_pk_bf16_f32 v160, v160, v161
v_cvt_pk_bf16_f32 v161, v162, v163
v_mfma_f32_16x16x32_bf16 v[132:135], v[52:55], v[32:35], v[132:135]
ds_read_b64_tr_b16 v[212:213], v227 offset:4096
v_cvt_pk_bf16_f32 v162, v164, v165
v_cvt_pk_bf16_f32 v163, v166, v167
v_mfma_f32_16x16x32_bf16 v[128:131], v[80:83], v[64:67], v[128:131]
ds_read_b64_tr_b16 v[214:215], v227 offset:6144
v_cvt_pk_bf16_f32 v164, v168, v169
v_cvt_pk_bf16_f32 v165, v170, v171
v_mfma_f32_16x16x32_bf16 v[136:139], v[80:83], v[68:71], v[136:139]
ds_read_b128 v[196:199], v17 offset:58368
v_cvt_pk_bf16_f32 v166, v172, v173
v_cvt_pk_bf16_f32 v167, v174, v175
v_mfma_f32_16x16x32_bf16 v[144:147], v[80:83], v[72:75], v[144:147]
ds_read_b128 v[200:203], v17 offset:59392
v_cvt_pk_bf16_f32 v168, v176, v177
v_cvt_pk_bf16_f32 v169, v178, v179
v_mfma_f32_16x16x32_bf16 v[152:155], v[80:83], v[76:79], v[152:155]
ds_read_b128 v[204:207], v17 offset:60416
v_cvt_pk_bf16_f32 v170, v180, v181
v_cvt_pk_bf16_f32 v171, v182, v183
v_mfma_f32_16x16x32_bf16 v[156:159], v[84:87], v[76:79], v[156:159]
v_cvt_pk_bf16_f32 v172, v184, v185
v_cvt_pk_bf16_f32 v173, v186, v187
v_mfma_f32_16x16x32_bf16 v[148:151], v[84:87], v[72:75], v[148:151]
v_cvt_pk_bf16_f32 v174, v188, v189
v_cvt_pk_bf16_f32 v175, v190, v191
v_mfma_f32_16x16x32_bf16 v[140:143], v[84:87], v[68:71], v[140:143]
v_mfma_f32_16x16x32_bf16 v[132:135], v[84:87], v[64:67], v[132:135]
buffer_store_dwordx4 v[160:163], v2, s[84:87], s45 offen offset:0 sc1
s_waitcnt lgkmcnt(0)
s_barrier
v_mfma_f32_16x16x32_bf16 v[128:131], v[112:115], v[96:99], v[128:131]
ds_read_b128 v[32:35], v18 offset:16384
ds_read_b64_tr_b16 v[48:49], v228 offset:16384
v_mfma_f32_16x16x32_bf16 v[136:139], v[112:115], v[100:103], v[136:139]
ds_read_b64_tr_b16 v[50:51], v228 offset:18432
ds_read_b64_tr_b16 v[52:53], v229 offset:16384
v_mfma_f32_16x16x32_bf16 v[144:147], v[112:115], v[104:107], v[144:147]
ds_read_b64_tr_b16 v[54:55], v229 offset:18432
ds_read_b128 v[36:39], v18 offset:17408
v_mfma_f32_16x16x32_bf16 v[152:155], v[112:115], v[108:111], v[152:155]
ds_read_b128 v[40:43], v18 offset:18432
ds_read_b128 v[44:47], v18 offset:19456
v_mfma_f32_16x16x32_bf16 v[156:159], v[116:119], v[108:111], v[156:159]
ds_read_b128 v[64:67], v18 offset:24576
v_mfma_f32_16x16x32_bf16 v[148:151], v[116:119], v[104:107], v[148:151]
ds_read_b64_tr_b16 v[80:81], v228 offset:20480
v_mfma_f32_16x16x32_bf16 v[140:143], v[116:119], v[100:103], v[140:143]
ds_read_b64_tr_b16 v[82:83], v228 offset:22528
v_mfma_f32_16x16x32_bf16 v[132:135], v[116:119], v[96:99], v[132:135]
ds_read_b64_tr_b16 v[84:85], v229 offset:20480
v_mfma_f32_16x16x32_bf16 v[128:131], v[208:211], v[192:195], v[128:131]
ds_read_b64_tr_b16 v[86:87], v229 offset:22528
buffer_store_dwordx4 v[164:167], v2, s[84:87], s45 offen offset:1024 sc1
v_mfma_f32_16x16x32_bf16 v[136:139], v[208:211], v[196:199], v[136:139]
ds_read_b128 v[68:71], v18 offset:25600
v_mfma_f32_16x16x32_bf16 v[144:147], v[208:211], v[200:203], v[144:147]
ds_read_b128 v[72:75], v18 offset:26624
v_mfma_f32_16x16x32_bf16 v[152:155], v[208:211], v[204:207], v[152:155]
ds_read_b128 v[76:79], v18 offset:27648
v_mfma_f32_16x16x32_bf16 v[156:159], v[212:215], v[204:207], v[156:159]
v_mfma_f32_16x16x32_bf16 v[148:151], v[212:215], v[200:203], v[148:151]
v_mfma_f32_16x16x32_bf16 v[140:143], v[212:215], v[196:199], v[140:143]
v_mfma_f32_16x16x32_bf16 v[132:135], v[212:215], v[192:195], v[132:135]
s_waitcnt lgkmcnt(0)
s_barrier
v_mfma_f32_16x16x32_bf16 v[128:131], v[48:51], v[32:35], v[128:131]
ds_read_b128 v[96:99], v18 offset:32768
ds_read_b64_tr_b16 v[112:113], v226 offset:49152
v_mfma_f32_16x16x32_bf16 v[136:139], v[48:51], v[36:39], v[136:139]
ds_read_b64_tr_b16 v[114:115], v226 offset:51200
ds_read_b64_tr_b16 v[116:117], v227 offset:49152
v_mfma_f32_16x16x32_bf16 v[144:147], v[48:51], v[40:43], v[144:147]
ds_read_b64_tr_b16 v[118:119], v227 offset:51200
ds_read_b128 v[100:103], v18 offset:33792
v_mfma_f32_16x16x32_bf16 v[152:155], v[48:51], v[44:47], v[152:155]
ds_read_b128 v[104:107], v18 offset:34816
ds_read_b128 v[108:111], v18 offset:35840
v_mfma_f32_16x16x32_bf16 v[156:159], v[52:55], v[44:47], v[156:159]
ds_read_b128 v[192:195], v18 offset:40960
v_mfma_f32_16x16x32_bf16 v[148:151], v[52:55], v[40:43], v[148:151]
ds_read_b64_tr_b16 v[208:209], v226 offset:53248
v_mfma_f32_16x16x32_bf16 v[140:143], v[52:55], v[36:39], v[140:143]
ds_read_b64_tr_b16 v[210:211], v226 offset:55296
v_mfma_f32_16x16x32_bf16 v[132:135], v[52:55], v[32:35], v[132:135]
ds_read_b64_tr_b16 v[212:213], v227 offset:53248
v_mfma_f32_16x16x32_bf16 v[128:131], v[80:83], v[64:67], v[128:131]
ds_read_b64_tr_b16 v[214:215], v227 offset:55296
buffer_store_dwordx4 v[168:171], v2, s[84:87], s45 offen offset:2048 sc1
v_mfma_f32_16x16x32_bf16 v[136:139], v[80:83], v[68:71], v[136:139]
ds_read_b128 v[196:199], v18 offset:41984
v_mfma_f32_16x16x32_bf16 v[144:147], v[80:83], v[72:75], v[144:147]
ds_read_b128 v[200:203], v18 offset:43008
v_mfma_f32_16x16x32_bf16 v[152:155], v[80:83], v[76:79], v[152:155]
ds_read_b128 v[204:207], v18 offset:44032
v_mfma_f32_16x16x32_bf16 v[156:159], v[84:87], v[76:79], v[156:159]
v_mfma_f32_16x16x32_bf16 v[148:151], v[84:87], v[72:75], v[148:151]
v_mfma_f32_16x16x32_bf16 v[140:143], v[84:87], v[68:71], v[140:143]
v_mfma_f32_16x16x32_bf16 v[132:135], v[84:87], v[64:67], v[132:135]
s_waitcnt lgkmcnt(0)
s_barrier
v_mfma_f32_16x16x32_bf16 v[128:131], v[112:115], v[96:99], v[128:131]
ds_read_b128 v[32:35], v19 offset:0
ds_read_b64_tr_b16 v[48:49], v224 offset:0
v_mfma_f32_16x16x32_bf16 v[136:139], v[112:115], v[100:103], v[136:139]
ds_read_b64_tr_b16 v[50:51], v224 offset:2048
ds_read_b64_tr_b16 v[52:53], v225 offset:0
v_mfma_f32_16x16x32_bf16 v[144:147], v[112:115], v[104:107], v[144:147]
ds_read_b64_tr_b16 v[54:55], v225 offset:2048
ds_read_b128 v[36:39], v19 offset:1024
v_mfma_f32_16x16x32_bf16 v[152:155], v[112:115], v[108:111], v[152:155]
ds_read_b128 v[40:43], v19 offset:2048
ds_read_b128 v[44:47], v19 offset:3072
v_mfma_f32_16x16x32_bf16 v[156:159], v[116:119], v[108:111], v[156:159]
ds_read_b128 v[64:67], v19 offset:8192
v_mfma_f32_16x16x32_bf16 v[148:151], v[116:119], v[104:107], v[148:151]
ds_read_b64_tr_b16 v[80:81], v224 offset:4096
v_mfma_f32_16x16x32_bf16 v[140:143], v[116:119], v[100:103], v[140:143]
ds_read_b64_tr_b16 v[82:83], v224 offset:6144
v_mfma_f32_16x16x32_bf16 v[132:135], v[116:119], v[96:99], v[132:135]
ds_read_b64_tr_b16 v[84:85], v225 offset:4096
v_mfma_f32_16x16x32_bf16 v[128:131], v[208:211], v[192:195], v[128:131]
ds_read_b64_tr_b16 v[86:87], v225 offset:6144
buffer_store_dwordx4 v[172:175], v2, s[84:87], s45 offen offset:3072 sc1
v_mfma_f32_16x16x32_bf16 v[136:139], v[208:211], v[196:199], v[136:139]
ds_read_b128 v[68:71], v19 offset:9216
v_mfma_f32_16x16x32_bf16 v[144:147], v[208:211], v[200:203], v[144:147]
ds_read_b128 v[72:75], v19 offset:10240
v_mfma_f32_16x16x32_bf16 v[152:155], v[208:211], v[204:207], v[152:155]
ds_read_b128 v[76:79], v19 offset:11264
v_mfma_f32_16x16x32_bf16 v[156:159], v[212:215], v[204:207], v[156:159]
v_mfma_f32_16x16x32_bf16 v[148:151], v[212:215], v[200:203], v[148:151]
v_mfma_f32_16x16x32_bf16 v[140:143], v[212:215], v[196:199], v[140:143]
v_mfma_f32_16x16x32_bf16 v[132:135], v[212:215], v[192:195], v[132:135]
s_waitcnt lgkmcnt(0)
s_barrier
v_mfma_f32_16x16x32_bf16 v[128:131], v[48:51], v[32:35], v[128:131]
ds_read_b128 v[96:99], v17 offset:16384
ds_read_b64_tr_b16 v[112:113], v224 offset:32768
v_mfma_f32_16x16x32_bf16 v[136:139], v[48:51], v[36:39], v[136:139]
ds_read_b64_tr_b16 v[114:115], v224 offset:34816
ds_read_b64_tr_b16 v[116:117], v225 offset:32768
v_mfma_f32_16x16x32_bf16 v[144:147], v[48:51], v[40:43], v[144:147]
ds_read_b64_tr_b16 v[118:119], v225 offset:34816
ds_read_b128 v[100:103], v17 offset:17408
v_mfma_f32_16x16x32_bf16 v[152:155], v[48:51], v[44:47], v[152:155]
ds_read_b128 v[104:107], v17 offset:18432
ds_read_b128 v[108:111], v17 offset:19456
v_mfma_f32_16x16x32_bf16 v[156:159], v[52:55], v[44:47], v[156:159]
ds_read_b128 v[192:195], v17 offset:24576
v_mfma_f32_16x16x32_bf16 v[148:151], v[52:55], v[40:43], v[148:151]
ds_read_b64_tr_b16 v[208:209], v224 offset:36864
v_mfma_f32_16x16x32_bf16 v[140:143], v[52:55], v[36:39], v[140:143]
ds_read_b64_tr_b16 v[210:211], v224 offset:38912
v_mfma_f32_16x16x32_bf16 v[132:135], v[52:55], v[32:35], v[132:135]
ds_read_b64_tr_b16 v[212:213], v225 offset:36864
v_mfma_f32_16x16x32_bf16 v[128:131], v[80:83], v[64:67], v[128:131]
ds_read_b64_tr_b16 v[214:215], v225 offset:38912
v_mfma_f32_16x16x32_bf16 v[136:139], v[80:83], v[68:71], v[136:139]
ds_read_b128 v[196:199], v17 offset:25600
v_mfma_f32_16x16x32_bf16 v[144:147], v[80:83], v[72:75], v[144:147]
ds_read_b128 v[200:203], v17 offset:26624
v_mfma_f32_16x16x32_bf16 v[152:155], v[80:83], v[76:79], v[152:155]
ds_read_b128 v[204:207], v17 offset:27648
v_mfma_f32_16x16x32_bf16 v[156:159], v[84:87], v[76:79], v[156:159]
v_mfma_f32_16x16x32_bf16 v[148:151], v[84:87], v[72:75], v[148:151]
v_mfma_f32_16x16x32_bf16 v[140:143], v[84:87], v[68:71], v[140:143]
v_mfma_f32_16x16x32_bf16 v[132:135], v[84:87], v[64:67], v[132:135]
s_waitcnt vmcnt(0)
s_waitcnt lgkmcnt(0)
s_barrier
v_mfma_f32_16x16x32_bf16 v[128:131], v[112:115], v[96:99], v[128:131]
ds_read_b128 v[32:35], v17 offset:49152
ds_read_b64_tr_b16 v[48:49], v226 offset:0
v_mfma_f32_16x16x32_bf16 v[136:139], v[112:115], v[100:103], v[136:139]
ds_read_b64_tr_b16 v[50:51], v226 offset:2048
ds_read_b64_tr_b16 v[52:53], v227 offset:0
v_mfma_f32_16x16x32_bf16 v[144:147], v[112:115], v[104:107], v[144:147]
ds_read_b64_tr_b16 v[54:55], v227 offset:2048
ds_read_b128 v[36:39], v17 offset:50176
v_mfma_f32_16x16x32_bf16 v[152:155], v[112:115], v[108:111], v[152:155]
ds_read_b128 v[40:43], v17 offset:51200
ds_read_b128 v[44:47], v17 offset:52224
v_mfma_f32_16x16x32_bf16 v[156:159], v[116:119], v[108:111], v[156:159]
ds_read_b128 v[64:67], v17 offset:57344
v_mfma_f32_16x16x32_bf16 v[148:151], v[116:119], v[104:107], v[148:151]
ds_read_b64_tr_b16 v[80:81], v226 offset:4096
v_mfma_f32_16x16x32_bf16 v[140:143], v[116:119], v[100:103], v[140:143]
ds_read_b64_tr_b16 v[82:83], v226 offset:6144
v_mfma_f32_16x16x32_bf16 v[132:135], v[116:119], v[96:99], v[132:135]
ds_read_b64_tr_b16 v[84:85], v227 offset:4096
v_mfma_f32_16x16x32_bf16 v[128:131], v[208:211], v[192:195], v[128:131]
ds_read_b64_tr_b16 v[86:87], v227 offset:6144
v_mfma_f32_16x16x32_bf16 v[136:139], v[208:211], v[196:199], v[136:139]
ds_read_b128 v[68:71], v17 offset:58368
v_mfma_f32_16x16x32_bf16 v[144:147], v[208:211], v[200:203], v[144:147]
ds_read_b128 v[72:75], v17 offset:59392
v_mfma_f32_16x16x32_bf16 v[152:155], v[208:211], v[204:207], v[152:155]
ds_read_b128 v[76:79], v17 offset:60416
v_mfma_f32_16x16x32_bf16 v[156:159], v[212:215], v[204:207], v[156:159]
v_mfma_f32_16x16x32_bf16 v[148:151], v[212:215], v[200:203], v[148:151]
v_mfma_f32_16x16x32_bf16 v[140:143], v[212:215], v[196:199], v[140:143]
v_mfma_f32_16x16x32_bf16 v[132:135], v[212:215], v[192:195], v[132:135]
s_waitcnt lgkmcnt(0)
s_barrier
v_mfma_f32_16x16x32_bf16 v[128:131], v[48:51], v[32:35], v[128:131]
ds_read_b128 v[96:99], v18 offset:16384
ds_read_b64_tr_b16 v[112:113], v228 offset:16384
v_mfma_f32_16x16x32_bf16 v[136:139], v[48:51], v[36:39], v[136:139]
ds_read_b64_tr_b16 v[114:115], v228 offset:18432
ds_read_b64_tr_b16 v[116:117], v229 offset:16384
v_mfma_f32_16x16x32_bf16 v[144:147], v[48:51], v[40:43], v[144:147]
ds_read_b64_tr_b16 v[118:119], v229 offset:18432
ds_read_b128 v[100:103], v18 offset:17408
v_mfma_f32_16x16x32_bf16 v[152:155], v[48:51], v[44:47], v[152:155]
ds_read_b128 v[104:107], v18 offset:18432
ds_read_b128 v[108:111], v18 offset:19456
v_mfma_f32_16x16x32_bf16 v[156:159], v[52:55], v[44:47], v[156:159]
ds_read_b128 v[192:195], v18 offset:24576
v_mfma_f32_16x16x32_bf16 v[148:151], v[52:55], v[40:43], v[148:151]
ds_read_b64_tr_b16 v[208:209], v228 offset:20480
v_mfma_f32_16x16x32_bf16 v[140:143], v[52:55], v[36:39], v[140:143]
ds_read_b64_tr_b16 v[210:211], v228 offset:22528
v_mfma_f32_16x16x32_bf16 v[132:135], v[52:55], v[32:35], v[132:135]
ds_read_b64_tr_b16 v[212:213], v229 offset:20480
v_mfma_f32_16x16x32_bf16 v[128:131], v[80:83], v[64:67], v[128:131]
ds_read_b64_tr_b16 v[214:215], v229 offset:22528
v_mfma_f32_16x16x32_bf16 v[136:139], v[80:83], v[68:71], v[136:139]
ds_read_b128 v[196:199], v18 offset:25600
v_mfma_f32_16x16x32_bf16 v[144:147], v[80:83], v[72:75], v[144:147]
ds_read_b128 v[200:203], v18 offset:26624
v_mfma_f32_16x16x32_bf16 v[152:155], v[80:83], v[76:79], v[152:155]
ds_read_b128 v[204:207], v18 offset:27648
v_mfma_f32_16x16x32_bf16 v[156:159], v[84:87], v[76:79], v[156:159]
v_mfma_f32_16x16x32_bf16 v[148:151], v[84:87], v[72:75], v[148:151]
v_mfma_f32_16x16x32_bf16 v[140:143], v[84:87], v[68:71], v[140:143]
v_mfma_f32_16x16x32_bf16 v[132:135], v[84:87], v[64:67], v[132:135]
s_waitcnt lgkmcnt(0)
s_barrier
v_mfma_f32_16x16x32_bf16 v[128:131], v[112:115], v[96:99], v[128:131]
ds_read_b128 v[32:35], v18 offset:32768
ds_read_b64_tr_b16 v[48:49], v226 offset:49152
v_mfma_f32_16x16x32_bf16 v[136:139], v[112:115], v[100:103], v[136:139]
ds_read_b64_tr_b16 v[50:51], v226 offset:51200
ds_read_b64_tr_b16 v[52:53], v227 offset:49152
v_mfma_f32_16x16x32_bf16 v[144:147], v[112:115], v[104:107], v[144:147]
ds_read_b64_tr_b16 v[54:55], v227 offset:51200
ds_read_b128 v[36:39], v18 offset:33792
v_mfma_f32_16x16x32_bf16 v[152:155], v[112:115], v[108:111], v[152:155]
ds_read_b128 v[40:43], v18 offset:34816
ds_read_b128 v[44:47], v18 offset:35840
v_mfma_f32_16x16x32_bf16 v[156:159], v[116:119], v[108:111], v[156:159]
ds_read_b128 v[64:67], v18 offset:40960
v_mfma_f32_16x16x32_bf16 v[148:151], v[116:119], v[104:107], v[148:151]
ds_read_b64_tr_b16 v[80:81], v226 offset:53248
v_mfma_f32_16x16x32_bf16 v[140:143], v[116:119], v[100:103], v[140:143]
ds_read_b64_tr_b16 v[82:83], v226 offset:55296
v_mfma_f32_16x16x32_bf16 v[132:135], v[116:119], v[96:99], v[132:135]
ds_read_b64_tr_b16 v[84:85], v227 offset:53248
v_mfma_f32_16x16x32_bf16 v[128:131], v[208:211], v[192:195], v[128:131]
ds_read_b64_tr_b16 v[86:87], v227 offset:55296
v_mfma_f32_16x16x32_bf16 v[136:139], v[208:211], v[196:199], v[136:139]
ds_read_b128 v[68:71], v18 offset:41984
v_mfma_f32_16x16x32_bf16 v[144:147], v[208:211], v[200:203], v[144:147]
ds_read_b128 v[72:75], v18 offset:43008
v_mfma_f32_16x16x32_bf16 v[152:155], v[208:211], v[204:207], v[152:155]
ds_read_b128 v[76:79], v18 offset:44032
v_mfma_f32_16x16x32_bf16 v[156:159], v[212:215], v[204:207], v[156:159]
v_mfma_f32_16x16x32_bf16 v[148:151], v[212:215], v[200:203], v[148:151]
v_mfma_f32_16x16x32_bf16 v[140:143], v[212:215], v[196:199], v[140:143]
v_mfma_f32_16x16x32_bf16 v[132:135], v[212:215], v[192:195], v[132:135]
s_waitcnt lgkmcnt(0)
s_barrier
buffer_load_dwordx4 v[232:235], v2, s[84:87], s46 offen offset:0 sc1
buffer_load_dwordx4 v[236:239], v2, s[84:87], s46 offen offset:1024 sc1
buffer_load_dwordx4 v[240:243], v2, s[84:87], s46 offen offset:2048 sc1
buffer_load_dwordx4 v[244:247], v2, s[84:87], s46 offen offset:3072 sc1
v_mfma_f32_16x16x32_bf16 v[128:131], v[48:51], v[32:35], v[128:131]
ds_read_b128 v[96:99], v19 offset:0
ds_read_b64_tr_b16 v[112:113], v224 offset:0
v_mfma_f32_16x16x32_bf16 v[136:139], v[48:51], v[36:39], v[136:139]
ds_read_b64_tr_b16 v[114:115], v224 offset:2048
ds_read_b64_tr_b16 v[116:117], v225 offset:0
v_mfma_f32_16x16x32_bf16 v[144:147], v[48:51], v[40:43], v[144:147]
ds_read_b64_tr_b16 v[118:119], v225 offset:2048
ds_read_b128 v[100:103], v19 offset:1024
v_mfma_f32_16x16x32_bf16 v[152:155], v[48:51], v[44:47], v[152:155]
ds_read_b128 v[104:107], v19 offset:2048
ds_read_b128 v[108:111], v19 offset:3072
v_mfma_f32_16x16x32_bf16 v[156:159], v[52:55], v[44:47], v[156:159]
ds_read_b128 v[192:195], v19 offset:8192
v_mfma_f32_16x16x32_bf16 v[148:151], v[52:55], v[40:43], v[148:151]
ds_read_b64_tr_b16 v[208:209], v224 offset:4096
v_mfma_f32_16x16x32_bf16 v[140:143], v[52:55], v[36:39], v[140:143]
ds_read_b64_tr_b16 v[210:211], v224 offset:6144
v_mfma_f32_16x16x32_bf16 v[132:135], v[52:55], v[32:35], v[132:135]
ds_read_b64_tr_b16 v[212:213], v225 offset:4096
v_mfma_f32_16x16x32_bf16 v[128:131], v[80:83], v[64:67], v[128:131]
ds_read_b64_tr_b16 v[214:215], v225 offset:6144
v_mfma_f32_16x16x32_bf16 v[136:139], v[80:83], v[68:71], v[136:139]
ds_read_b128 v[196:199], v19 offset:9216
v_mfma_f32_16x16x32_bf16 v[144:147], v[80:83], v[72:75], v[144:147]
ds_read_b128 v[200:203], v19 offset:10240
v_mfma_f32_16x16x32_bf16 v[152:155], v[80:83], v[76:79], v[152:155]
ds_read_b128 v[204:207], v19 offset:11264
v_mfma_f32_16x16x32_bf16 v[156:159], v[84:87], v[76:79], v[156:159]
v_mfma_f32_16x16x32_bf16 v[148:151], v[84:87], v[72:75], v[148:151]
v_mfma_f32_16x16x32_bf16 v[140:143], v[84:87], v[68:71], v[140:143]
v_mfma_f32_16x16x32_bf16 v[132:135], v[84:87], v[64:67], v[132:135]
s_waitcnt lgkmcnt(0)
s_barrier
v_mfma_f32_16x16x32_bf16 v[128:131], v[112:115], v[96:99], v[128:131]
ds_read_b128 v[32:35], v17 offset:16384
ds_read_b64_tr_b16 v[48:49], v224 offset:32768
v_mfma_f32_16x16x32_bf16 v[136:139], v[112:115], v[100:103], v[136:139]
ds_read_b64_tr_b16 v[50:51], v224 offset:34816
ds_read_b64_tr_b16 v[52:53], v225 offset:32768
v_mfma_f32_16x16x32_bf16 v[144:147], v[112:115], v[104:107], v[144:147]
ds_read_b64_tr_b16 v[54:55], v225 offset:34816
ds_read_b128 v[36:39], v17 offset:17408
v_mfma_f32_16x16x32_bf16 v[152:155], v[112:115], v[108:111], v[152:155]
ds_read_b128 v[40:43], v17 offset:18432
ds_read_b128 v[44:47], v17 offset:19456
v_mfma_f32_16x16x32_bf16 v[156:159], v[116:119], v[108:111], v[156:159]
ds_read_b128 v[64:67], v17 offset:24576
v_mfma_f32_16x16x32_bf16 v[148:151], v[116:119], v[104:107], v[148:151]
ds_read_b64_tr_b16 v[80:81], v224 offset:36864
v_mfma_f32_16x16x32_bf16 v[140:143], v[116:119], v[100:103], v[140:143]
ds_read_b64_tr_b16 v[82:83], v224 offset:38912
v_mfma_f32_16x16x32_bf16 v[132:135], v[116:119], v[96:99], v[132:135]
ds_read_b64_tr_b16 v[84:85], v225 offset:36864
v_mfma_f32_16x16x32_bf16 v[128:131], v[208:211], v[192:195], v[128:131]
ds_read_b64_tr_b16 v[86:87], v225 offset:38912
v_mfma_f32_16x16x32_bf16 v[136:139], v[208:211], v[196:199], v[136:139]
ds_read_b128 v[68:71], v17 offset:25600
v_mfma_f32_16x16x32_bf16 v[144:147], v[208:211], v[200:203], v[144:147]
ds_read_b128 v[72:75], v17 offset:26624
v_mfma_f32_16x16x32_bf16 v[152:155], v[208:211], v[204:207], v[152:155]
ds_read_b128 v[76:79], v17 offset:27648
v_mfma_f32_16x16x32_bf16 v[156:159], v[212:215], v[204:207], v[156:159]
v_mfma_f32_16x16x32_bf16 v[148:151], v[212:215], v[200:203], v[148:151]
v_mfma_f32_16x16x32_bf16 v[140:143], v[212:215], v[196:199], v[140:143]
v_mfma_f32_16x16x32_bf16 v[132:135], v[212:215], v[192:195], v[132:135]
s_waitcnt lgkmcnt(0)
s_barrier
v_mfma_f32_16x16x32_bf16 v[128:131], v[48:51], v[32:35], v[128:131]
ds_read_b128 v[96:99], v17 offset:49152
ds_read_b64_tr_b16 v[112:113], v226 offset:0
v_mfma_f32_16x16x32_bf16 v[136:139], v[48:51], v[36:39], v[136:139]
ds_read_b64_tr_b16 v[114:115], v226 offset:2048
ds_read_b64_tr_b16 v[116:117], v227 offset:0
v_mfma_f32_16x16x32_bf16 v[144:147], v[48:51], v[40:43], v[144:147]
ds_read_b64_tr_b16 v[118:119], v227 offset:2048
ds_read_b128 v[100:103], v17 offset:50176
v_mfma_f32_16x16x32_bf16 v[152:155], v[48:51], v[44:47], v[152:155]
ds_read_b128 v[104:107], v17 offset:51200
ds_read_b128 v[108:111], v17 offset:52224
v_mfma_f32_16x16x32_bf16 v[156:159], v[52:55], v[44:47], v[156:159]
ds_read_b128 v[192:195], v17 offset:57344
v_mfma_f32_16x16x32_bf16 v[148:151], v[52:55], v[40:43], v[148:151]
ds_read_b64_tr_b16 v[208:209], v226 offset:4096
v_mfma_f32_16x16x32_bf16 v[140:143], v[52:55], v[36:39], v[140:143]
ds_read_b64_tr_b16 v[210:211], v226 offset:6144
v_mfma_f32_16x16x32_bf16 v[132:135], v[52:55], v[32:35], v[132:135]
ds_read_b64_tr_b16 v[212:213], v227 offset:4096
v_mfma_f32_16x16x32_bf16 v[128:131], v[80:83], v[64:67], v[128:131]
ds_read_b64_tr_b16 v[214:215], v227 offset:6144
v_mfma_f32_16x16x32_bf16 v[136:139], v[80:83], v[68:71], v[136:139]
ds_read_b128 v[196:199], v17 offset:58368
v_mfma_f32_16x16x32_bf16 v[144:147], v[80:83], v[72:75], v[144:147]
ds_read_b128 v[200:203], v17 offset:59392
v_mfma_f32_16x16x32_bf16 v[152:155], v[80:83], v[76:79], v[152:155]
ds_read_b128 v[204:207], v17 offset:60416
v_mfma_f32_16x16x32_bf16 v[156:159], v[84:87], v[76:79], v[156:159]
v_mfma_f32_16x16x32_bf16 v[148:151], v[84:87], v[72:75], v[148:151]
v_mfma_f32_16x16x32_bf16 v[140:143], v[84:87], v[68:71], v[140:143]
v_mfma_f32_16x16x32_bf16 v[132:135], v[84:87], v[64:67], v[132:135]
s_waitcnt vmcnt(0)
s_waitcnt lgkmcnt(0)
s_barrier
v_mfma_f32_16x16x32_bf16 v[128:131], v[112:115], v[96:99], v[128:131]
v_lshlrev_b32 v160, 16, v232
v_and_b32 v161, 0xffff0000, v232
v_lshlrev_b32 v162, 16, v233
v_and_b32 v163, 0xffff0000, v233
v_mfma_f32_16x16x32_bf16 v[132:135], v[116:119], v[96:99], v[132:135]
v_lshlrev_b32 v164, 16, v234
v_and_b32 v165, 0xffff0000, v234
v_lshlrev_b32 v166, 16, v235
v_and_b32 v167, 0xffff0000, v235
v_mfma_f32_16x16x32_bf16 v[128:131], v[208:211], v[192:195], v[128:131]
v_lshlrev_b32 v168, 16, v236
v_and_b32 v169, 0xffff0000, v236
v_lshlrev_b32 v170, 16, v237
v_and_b32 v171, 0xffff0000, v237
v_mfma_f32_16x16x32_bf16 v[132:135], v[212:215], v[192:195], v[132:135]
v_lshlrev_b32 v172, 16, v238
v_and_b32 v173, 0xffff0000, v238
v_lshlrev_b32 v174, 16, v239
v_and_b32 v175, 0xffff0000, v239
v_mfma_f32_16x16x32_bf16 v[136:139], v[112:115], v[100:103], v[136:139]
v_lshlrev_b32 v176, 16, v240
v_and_b32 v177, 0xffff0000, v240
v_lshlrev_b32 v178, 16, v241
v_and_b32 v179, 0xffff0000, v241
v_mfma_f32_16x16x32_bf16 v[140:143], v[116:119], v[100:103], v[140:143]
v_lshlrev_b32 v180, 16, v242
v_and_b32 v181, 0xffff0000, v242
v_lshlrev_b32 v182, 16, v243
v_and_b32 v183, 0xffff0000, v243
v_mfma_f32_16x16x32_bf16 v[136:139], v[208:211], v[196:199], v[136:139]
v_lshlrev_b32 v184, 16, v244
v_and_b32 v185, 0xffff0000, v244
v_lshlrev_b32 v186, 16, v245
v_and_b32 v187, 0xffff0000, v245
v_mfma_f32_16x16x32_bf16 v[140:143], v[212:215], v[196:199], v[140:143]
v_lshlrev_b32 v188, 16, v246
v_and_b32 v189, 0xffff0000, v246
v_lshlrev_b32 v190, 16, v247
v_and_b32 v191, 0xffff0000, v247
v_mfma_f32_16x16x32_bf16 v[144:147], v[112:115], v[104:107], v[144:147]
v_add_f32 v128, v128, v160
v_add_f32 v129, v129, v161
v_add_f32 v130, v130, v162
v_mfma_f32_16x16x32_bf16 v[148:151], v[116:119], v[104:107], v[148:151]
v_add_f32 v131, v131, v163
v_add_f32 v132, v132, v164
v_add_f32 v133, v133, v165
v_mfma_f32_16x16x32_bf16 v[144:147], v[208:211], v[200:203], v[144:147]
v_add_f32 v134, v134, v166
v_add_f32 v135, v135, v167
v_cvt_pk_bf16_f32 v232, v128, v129
v_mfma_f32_16x16x32_bf16 v[148:151], v[212:215], v[200:203], v[148:151]
v_cvt_pk_bf16_f32 v233, v130, v131
v_cvt_pk_bf16_f32 v234, v132, v133
v_cvt_pk_bf16_f32 v235, v134, v135
v_mfma_f32_16x16x32_bf16 v[152:155], v[112:115], v[108:111], v[152:155]
v_add_f32 v136, v136, v168
v_add_f32 v137, v137, v169
v_add_f32 v138, v138, v170
v_mfma_f32_16x16x32_bf16 v[156:159], v[116:119], v[108:111], v[156:159]
v_add_f32 v139, v139, v171
v_add_f32 v140, v140, v172
v_add_f32 v141, v141, v173
v_add_f32 v142, v142, v174
v_mfma_f32_16x16x32_bf16 v[152:155], v[208:211], v[204:207], v[152:155]
v_add_f32 v143, v143, v175
v_cvt_pk_bf16_f32 v236, v136, v137
v_cvt_pk_bf16_f32 v237, v138, v139
v_cvt_pk_bf16_f32 v238, v140, v141
v_mfma_f32_16x16x32_bf16 v[156:159], v[212:215], v[204:207], v[156:159]
v_cvt_pk_bf16_f32 v239, v142, v143
v_permlane16_swap_b32 v232, v234
v_permlane16_swap_b32 v233, v235
buffer_store_dwordx4 v[232:235], v230, s[20:23], s54 offen offset:0 nt
v_permlane16_swap_b32 v236, v238
v_permlane16_swap_b32 v237, v239
buffer_store_dwordx4 v[236:239], v230, s[20:23], s54 offen offset:2048 nt
v_add_f32 v144, v144, v176
v_add_f32 v145, v145, v177
v_add_f32 v146, v146, v178
v_add_f32 v147, v147, v179
v_add_f32 v148, v148, v180
v_add_f32 v149, v149, v181
v_add_f32 v150, v150, v182
v_add_f32 v151, v151, v183
v_cvt_pk_bf16_f32 v240, v144, v145
s_branch Lov_13
.p2align 12
.fill 96, 4, 0xbf800000
Lst_13_0:
s_branch Lwr_158
Lst_13_1:
s_branch Lst_17_0
s_nop 0
Lov_13:
v_cvt_pk_bf16_f32 v241, v146, v147
v_cvt_pk_bf16_f32 v242, v148, v149
v_cvt_pk_bf16_f32 v243, v150, v151
s_nop 0
v_add_f32 v152, v152, v184
v_add_f32 v153, v153, v185
v_add_f32 v154, v154, v186
v_add_f32 v155, v155, v187
v_add_f32 v156, v156, v188
v_add_f32 v157, v157, v189
v_add_f32 v158, v158, v190
v_add_f32 v159, v159, v191
v_cvt_pk_bf16_f32 v244, v152, v153
v_cvt_pk_bf16_f32 v245, v154, v155
v_cvt_pk_bf16_f32 v246, v156, v157
v_cvt_pk_bf16_f32 v247, v158, v159
v_permlane16_swap_b32 v240, v242
v_permlane16_swap_b32 v241, v243
buffer_store_dwordx4 v[240:243], v230, s[20:23], s55 offen offset:0 nt
v_permlane16_swap_b32 v244, v246
v_permlane16_swap_b32 v245, v247
buffer_store_dwordx4 v[244:247], v230, s[20:23], s55 offen offset:2048 nt
s_branch Ldone_1
Lgb_97:
s_mul_i32 s43, s34, 262144
s_add_u32 s8, s82, s43
s_addc_u32 s9, s83, 0
s_add_u32 s8, s8, 4194304
s_addc_u32 s9, s9, 0
s_mov_b32 s10, 262144
s_mov_b32 s11, 0x20000
s_lshl_b32 s39, s36, 12
v_lshlrev_b32 v2, 4, v1
v_add_u32 v3, s39, v2
s_add_u32 s37, s35, 0
s_and_b32 s37, s37, 15
s_mul_i32 s37, s37, 16384
s_add_u32 m0, s39, 0
s_nop 0
buffer_load_dwordx4 v3, s[8:11], s37 offen sc1 lds
buffer_load_dwordx4 v3, s[8:11], s37 offen offset:1024 sc1 lds
buffer_load_dwordx4 v3, s[8:11], s37 offen offset:2048 sc1 lds
buffer_load_dwordx4 v3, s[8:11], s37 offen offset:3072 sc1 lds
s_mul_i32 s43, s34, 262144
s_add_u32 s8, s82, s43
s_addc_u32 s9, s83, 0
s_add_u32 s8, s8, 4194304
s_addc_u32 s9, s9, 0
s_mov_b32 s10, 262144
s_mov_b32 s11, 0x20000
s_mul_i32 s43, s34, 917504
s_add_u32 s24, s82, s43
s_addc_u32 s25, s83, 0
s_add_u32 s24, s24, 8388608
s_addc_u32 s25, s25, 0
s_mov_b32 s26, 917504
s_mov_b32 s27, 0x20000
s_add_u32 s84, s82, 27262976
s_addc_u32 s85, s83, 0
s_mov_b32 s86, 229376
s_mov_b32 s87, 0x20000
s_and_b32 s47, s36, 3
s_lshr_b32 s62, s47, 1
s_and_b32 s63, s47, 1
v_lshlrev_b32 v2, 4, v1
s_lshl_b32 s39, s47, 12
v_add_u32 v3, s39, v2
s_bitcmp0_b32 s36, 1
s_cselect_b32 s44, s72, s74
s_cselect_b32 s45, s73, s75
s_mul_i32 s43, s35, 256
s_add_u32 s12, s44, s43
s_addc_u32 s13, s45, 0
s_mov_b32 s14, 7333120
s_mov_b32 s15, 0x20000
s_and_b32 s43, s36, 1
s_mul_i32 s43, s43, 229376
v_lshrrev_b32 v28, 4, v1
v_lshlrev_b32 v29, 1, v28
v_and_b32 v4, 15, v1
v_xor_b32 v4, v4, v29
v_lshlrev_b32 v4, 4, v4
v_mul_u32_u24 v28, 7168, v28
v_add_u32 v4, v4, v28
v_add_u32 v4, s43, v4
v_xor_b32 v5, 128, v4
v_add_u32 v5, 28672, v5
s_and_b32 s43, s36, 3
s_mul_i32 s40, s43, 8192
s_add_u32 s40, s40, 16384
v_mov_b32 v6, v192
v_mov_b32 v7, v193
v_mov_b32 v8, v194
s_lshl_b32 s43, s62, 12
v_add_u32 v9, s43, v2
v_add_u32 v10, 98304, v9
v_mov_b32 v24, v195
s_mul_i32 s43, s34, 16384
s_add_u32 s20, s82, s43
s_addc_u32 s21, s83, 0
s_add_u32 s20, s20, 25165824
s_addc_u32 s21, s21, 0
s_mov_b32 s22, 16384
s_mov_b32 s23, 0x20000
s_add_u32 s38, s35, 2
s_and_b32 s38, s38, 15
s_mul_i32 s38, s38, 458752
s_add_u32 m0, s50, 98304
s_nop 0
buffer_load_dwordx4 v6, s[16:19], s38 offen lds
s_add_u32 m0, s50, 99328
s_nop 0
buffer_load_dwordx4 v7, s[16:19], s38 offen lds
s_add_u32 m0, s50, 100352
s_nop 0
buffer_load_dwordx4 v8, s[16:19], s38 offen lds
s_add_u32 m0, s50, 101376
s_add_u32 s38, s38, 114688
buffer_load_dwordx4 v6, s[16:19], s38 offen lds
s_add_u32 m0, s50, 102400
s_nop 0
buffer_load_dwordx4 v7, s[16:19], s38 offen lds
s_add_u32 m0, s50, 103424
s_nop 0
buffer_load_dwordx4 v8, s[16:19], s38 offen lds
s_cmp_eq_u32 s47, 1
s_cbranch_scc0 Lw_122
s_lshl_b32 s92, s34, 4
s_add_u32 s92, s92, s35
s_lshl_b32 s92, s92, 8
s_add_u32 s92, s92, 49280
s_add_u32 s92, s92, 28311552
s_mov_b32 s41, 0x40000
Lpoll_123:
s_load_dword s93, s[82:83], s92 glc
Lpchk_125:
s_waitcnt lgkmcnt(0)
s_cmp_eq_u32 s93, 16
s_cbranch_scc1 Lpok_124
s_sub_u32 s41, s41, 1
s_cmp_lg_u32 s41, 0
s_cbranch_scc1 Lpoll_123
Lpok_124:
Lw_122:
s_waitcnt vmcnt(0)
s_barrier
s_add_u32 s37, s35, 1
s_and_b32 s37, s37, 15
s_mul_i32 s37, s37, 16384
s_add_u32 m0, s39, 49152
s_nop 0
buffer_load_dwordx4 v3, s[8:11], s37 offen sc1 lds
buffer_load_dwordx4 v3, s[8:11], s37 offen offset:1024 sc1 lds
buffer_load_dwordx4 v3, s[8:11], s37 offen offset:2048 sc1 lds
buffer_load_dwordx4 v3, s[8:11], s37 offen offset:3072 sc1 lds
s_add_u32 s37, s35, 2
s_and_b32 s37, s37, 15
s_mul_i32 s37, s37, 16384
s_add_u32 m0, s39, 98304
s_nop 0
buffer_load_dwordx4 v3, s[8:11], s37 offen sc1 lds
buffer_load_dwordx4 v3, s[8:11], s37 offen offset:1024 sc1 lds
buffer_load_dwordx4 v3, s[8:11], s37 offen offset:2048 sc1 lds
buffer_load_dwordx4 v3, s[8:11], s37 offen offset:3072 sc1 lds
buffer_load_dwordx4 v[96:99], v3, s[20:23], 0 offen offset:0 sc1
buffer_load_dwordx4 v[100:103], v3, s[20:23], 0 offen offset:1024 sc1
buffer_load_dwordx4 v[104:107], v3, s[20:23], 0 offen offset:2048 sc1
buffer_load_dwordx4 v[108:111], v3, s[20:23], 0 offen offset:3072 sc1
s_and_b32 s44, s36, 3
s_mul_i32 s44, s44, 11
s_bfe_u32 s43, s2, 0x30001
s_lshl_b32 s43, s43, 7
s_add_u32 s44, s44, s43
s_add_u32 s44, s44, 84
s_mul_i32 s44, s44, 7168
s_lshr_b32 s43, s2, 4
s_lshl_b32 s43, s43, 8
s_add_u32 s43, s43, s44
s_bitcmp0_b32 s2, 0
s_cselect_b32 s4, s72, s74
s_cselect_b32 s5, s73, s75
s_add_u32 s4, s4, s43
s_addc_u32 s5, s5, 0
s_waitcnt vmcnt(8)
s_barrier
s_cmp_eq_u32 s47, 3
s_cbranch_scc0 Lw_126
v_and_b32 v90, 31, v1
v_lshlrev_b32 v90, 4, v90
v_add_u32 v91, 151552, v90
ds_read_b128 v[112:115], v91 offset:0
ds_read_b128 v[116:119], v91 offset:512
ds_read_b128 v[120:123], v91 offset:1024
ds_read_b128 v[124:127], v91 offset:1536
s_and_b32 s44, s2, 15
s_mul_i32 s44, s44, 14336
s_lshr_b32 s43, s2, 4
s_lshl_b32 s43, s43, 9
s_add_u32 s44, s44, s43
s_add_u32 s44, s44, 8192
s_cmp_lt_u32 s2, 192
s_cselect_b32 s44, s44, 0x7fffffff
s_waitcnt lgkmcnt(0)
v_add_f32 v112, v112, v116
v_add_f32 v120, v120, v124
v_add_f32 v113, v113, v117
v_add_f32 v121, v121, v125
v_add_f32 v114, v114, v118
v_add_f32 v122, v122, v126
v_add_f32 v115, v115, v119
v_add_f32 v123, v123, v127
v_add_f32 v112, v112, v120
v_add_f32 v113, v113, v121
v_add_f32 v114, v114, v122
v_add_f32 v115, v115, v123
s_mov_b64 exec, 0xffffffff
buffer_store_dwordx4 v[112:115], v90, s[84:87], s44 offen sc1
s_mov_b64 exec, -1
Lw_126:
s_add_u32 s37, s35, 3
s_and_b32 s37, s37, 15
s_mul_i32 s37, s37, 16384
s_add_u32 m0, s39, 0
s_nop 0
buffer_load_dwordx4 v3, s[8:11], s37 offen sc1 lds
s_load_dword s3, s[4:5], 0
buffer_load_dwordx4 v3, s[8:11], s37 offen offset:1024 sc1 lds
s_load_dword s3, s[4:5], 64
buffer_load_dwordx4 v3, s[8:11], s37 offen offset:2048 sc1 lds
s_load_dword s3, s[4:5], 128
buffer_load_dwordx4 v3, s[8:11], s37 offen offset:3072 sc1 lds
s_load_dword s3, s[4:5], 192
s_load_dword s3, s[4:5], 7168
s_add_u32 s38, s35, 3
s_and_b32 s38, s38, 15
s_mul_i32 s38, s38, 458752
s_add_u32 m0, s50, 0
s_nop 0
buffer_load_dwordx4 v6, s[16:19], s38 offen lds
s_load_dword s3, s[4:5], 7232
s_add_u32 m0, s50, 1024
s_nop 0
buffer_load_dwordx4 v7, s[16:19], s38 offen lds
s_load_dword s3, s[4:5], 7296
s_add_u32 m0, s50, 2048
s_nop 0
buffer_load_dwordx4 v8, s[16:19], s38 offen lds
s_load_dword s3, s[4:5], 7360
s_add_u32 m0, s50, 3072
s_add_u32 s38, s38, 114688
buffer_load_dwordx4 v6, s[16:19], s38 offen lds
s_load_dword s3, s[4:5], 14336
s_load_dword s3, s[4:5], 14400
s_add_u32 m0, s50, 4096
s_nop 0
buffer_load_dwordx4 v7, s[16:19], s38 offen lds
s_add_u32 m0, s50, 5120
s_nop 0
buffer_load_dwordx4 v8, s[16:19], s38 offen lds
s_waitcnt vmcnt(14)
s_barrier
s_add_u32 s37, s35, 4
s_and_b32 s37, s37, 15
s_mul_i32 s37, s37, 16384
s_add_u32 m0, s39, 49152
s_nop 0
buffer_load_dwordx4 v3, s[8:11], s37 offen sc1 lds
s_load_dword s3, s[4:5], 14464
buffer_load_dwordx4 v3, s[8:11], s37 offen offset:1024 sc1 lds
s_load_dword s3, s[4:5], 14528
buffer_load_dwordx4 v3, s[8:11], s37 offen offset:2048 sc1 lds
s_load_dword s3, s[4:5], 21504
buffer_load_dwordx4 v3, s[8:11], s37 offen offset:3072 sc1 lds
s_load_dword s3, s[4:5], 21568
s_load_dword s3, s[4:5], 21632
s_add_u32 s38, s35, 4
s_and_b32 s38, s38, 15
s_mul_i32 s38, s38, 458752
s_add_u32 m0, s50, 49152
s_nop 0
buffer_load_dwordx4 v6, s[16:19], s38 offen lds
s_load_dword s3, s[4:5], 21696
s_add_u32 m0, s50, 50176
s_nop 0
buffer_load_dwordx4 v7, s[16:19], s38 offen lds
s_load_dword s3, s[4:5], 28672
s_add_u32 m0, s50, 51200
s_nop 0
buffer_load_dwordx4 v8, s[16:19], s38 offen lds
s_load_dword s3, s[4:5], 28736
s_add_u32 m0, s50, 52224
s_add_u32 s38, s38, 114688
buffer_load_dwordx4 v6, s[16:19], s38 offen lds
s_load_dword s3, s[4:5], 28800
s_load_dword s3, s[4:5], 28864
s_add_u32 m0, s50, 53248
s_nop 0
buffer_load_dwordx4 v7, s[16:19], s38 offen lds
s_add_u32 m0, s50, 54272
s_nop 0
buffer_load_dwordx4 v8, s[16:19], s38 offen lds
s_waitcnt vmcnt(10)
s_barrier
s_cmp_eq_u32 s47, 3
s_cbranch_scc0 Lw_127
s_cmp_lt_u32 s2, 192
s_cbranch_scc0 Lw_127
s_lshr_b32 s43, s2, 4
s_add_u32 s43, s43, 96
s_lshl_b32 s43, s43, 7
v_mov_b32 v90, s43
v_mov_b32 v91, 1
s_mov_b64 exec, 1
buffer_atomic_add v91, v90, s[56:59], 0 offen sc1
s_mov_b64 exec, -1
Lw_127:
s_add_u32 s37, s35, 5
s_and_b32 s37, s37, 15
s_mul_i32 s37, s37, 16384
s_add_u32 m0, s39, 98304
s_nop 0
buffer_load_dwordx4 v3, s[8:11], s37 offen sc1 lds
v_add_f32 v96, v96, v100
v_add_f32 v97, v97, v101
v_add_f32 v98, v98, v102
buffer_load_dwordx4 v3, s[8:11], s37 offen offset:1024 sc1 lds
v_add_f32 v99, v99, v103
v_add_f32 v104, v104, v108
v_add_f32 v105, v105, v109
buffer_load_dwordx4 v3, s[8:11], s37 offen offset:2048 sc1 lds
v_add_f32 v106, v106, v110
v_add_f32 v107, v107, v111
s_nop 0
buffer_load_dwordx4 v3, s[8:11], s37 offen offset:3072 sc1 lds
v_permlane32_swap_b32 v96, v104
v_permlane32_swap_b32 v97, v105
v_permlane32_swap_b32 v98, v106
v_permlane32_swap_b32 v99, v107
s_add_u32 s38, s35, 5
s_and_b32 s38, s38, 15
s_mul_i32 s38, s38, 458752
s_add_u32 m0, s50, 98304
s_nop 0
buffer_load_dwordx4 v6, s[16:19], s38 offen lds
v_add_f32 v96, v96, v104
v_add_f32 v97, v97, v105
v_add_f32 v98, v98, v106
s_add_u32 m0, s50, 99328
s_nop 0
buffer_load_dwordx4 v7, s[16:19], s38 offen lds
v_add_f32 v99, v99, v107
v_mov_b32 v100, v96
v_mov_b32 v101, v97
s_add_u32 m0, s50, 100352
s_nop 0
buffer_load_dwordx4 v8, s[16:19], s38 offen lds
v_mov_b32 v102, v98
v_mov_b32 v103, v99
s_nop 0
s_add_u32 m0, s50, 101376
s_add_u32 s38, s38, 114688
buffer_load_dwordx4 v6, s[16:19], s38 offen lds
v_permlane16_swap_b32 v96, v100
v_permlane16_swap_b32 v97, v101
v_permlane16_swap_b32 v98, v102
v_permlane16_swap_b32 v99, v103
s_add_u32 m0, s50, 102400
s_nop 0
buffer_load_dwordx4 v7, s[16:19], s38 offen lds
s_add_u32 m0, s50, 103424
s_nop 0
buffer_load_dwordx4 v8, s[16:19], s38 offen lds
s_waitcnt vmcnt(10)
s_barrier
s_add_u32 s37, s35, 6
s_and_b32 s37, s37, 15
s_mul_i32 s37, s37, 16384
s_add_u32 m0, s39, 0
s_nop 0
buffer_load_dwordx4 v3, s[8:11], s37 offen sc1 lds
v_add_f32 v96, v96, v100
v_add_f32 v97, v97, v101
v_add_f32 v98, v98, v102
buffer_load_dwordx4 v3, s[8:11], s37 offen offset:1024 sc1 lds
v_add_f32 v99, v99, v103
s_nop 0
v_add_f32_dpp v96, v96, v96 row_ror:8 row_mask:0xf bank_mask:0xf
buffer_load_dwordx4 v3, s[8:11], s37 offen offset:2048 sc1 lds
v_add_f32_dpp v97, v97, v97 row_ror:8 row_mask:0xf bank_mask:0xf
v_add_f32_dpp v98, v98, v98 row_ror:8 row_mask:0xf bank_mask:0xf
v_add_f32_dpp v99, v99, v99 row_ror:8 row_mask:0xf bank_mask:0xf
v_mul_f32 v96, 0x3a800000, v96
buffer_load_dwordx4 v3, s[8:11], s37 offen offset:3072 sc1 lds
v_mul_f32 v97, 0x3a800000, v97
v_mul_f32 v98, 0x3a800000, v98
v_mul_f32 v99, 0x3a800000, v99
s_add_u32 s38, s35, 6
s_and_b32 s38, s38, 15
s_mul_i32 s38, s38, 458752
s_add_u32 m0, s50, 0
s_nop 0
buffer_load_dwordx4 v6, s[16:19], s38 offen lds
v_fma_f32 v97, -v96, v96, v97
v_fma_f32 v99, -v98, v98, v99
v_max_f32 v97, 0, v97
s_add_u32 m0, s50, 1024
s_nop 0
buffer_load_dwordx4 v7, s[16:19], s38 offen lds
v_max_f32 v99, 0, v99
v_add_f32 v97, 0x3727c5ac, v97
v_add_f32 v99, 0x3727c5ac, v99
v_rsq_f32 v97, v97
s_add_u32 m0, s50, 2048
s_nop 0
buffer_load_dwordx4 v8, s[16:19], s38 offen lds
v_rsq_f32 v99, v99
v_and_b32 v100, 7, v1
s_lshl_b32 s43, s47, 8
s_add_u32 m0, s50, 3072
s_add_u32 s38, s38, 114688
buffer_load_dwordx4 v6, s[16:19], s38 offen lds
s_add_u32 s43, s43, 147456
v_lshl_add_u32 v100, v100, 4, s43
v_lshrrev_b32 v101, 5, v1
v_lshl_add_u32 v100, v101, 7, v100
s_add_u32 m0, s50, 4096
s_nop 0
buffer_load_dwordx4 v7, s[16:19], s38 offen lds
s_add_u32 m0, s50, 5120
s_nop 0
buffer_load_dwordx4 v8, s[16:19], s38 offen lds
s_waitcnt vmcnt(10)
s_barrier
ds_write_b128 v100, v[96:99]
s_waitcnt lgkmcnt(0)
s_add_u32 s37, s35, 7
s_and_b32 s37, s37, 15
s_mul_i32 s37, s37, 16384
s_add_u32 m0, s39, 49152
s_nop 0
buffer_load_dwordx4 v3, s[8:11], s37 offen sc1 lds
s_load_dword s3, s[4:5], 35840
buffer_load_dwordx4 v3, s[8:11], s37 offen offset:1024 sc1 lds
s_load_dword s3, s[4:5], 35904
buffer_load_dwordx4 v3, s[8:11], s37 offen offset:2048 sc1 lds
s_load_dword s3, s[4:5], 35968
s_load_dword s3, s[4:5], 36032
buffer_load_dwordx4 v3, s[8:11], s37 offen offset:3072 sc1 lds
s_load_dword s3, s[4:5], 43008
s_add_u32 s38, s35, 7
s_and_b32 s38, s38, 15
s_mul_i32 s38, s38, 458752
s_add_u32 m0, s50, 49152
s_nop 0
buffer_load_dwordx4 v6, s[16:19], s38 offen lds
s_load_dword s3, s[4:5], 43072
s_add_u32 m0, s50, 50176
s_nop 0
buffer_load_dwordx4 v7, s[16:19], s38 offen lds
s_load_dword s3, s[4:5], 43136
s_load_dword s3, s[4:5], 43200
s_add_u32 m0, s50, 51200
s_nop 0
buffer_load_dwordx4 v8, s[16:19], s38 offen lds
s_load_dword s3, s[4:5], 50176
s_add_u32 m0, s50, 52224
s_add_u32 s38, s38, 114688
buffer_load_dwordx4 v6, s[16:19], s38 offen lds
s_load_dword s3, s[4:5], 50240
s_load_dword s3, s[4:5], 50304
s_add_u32 m0, s50, 53248
s_nop 0
buffer_load_dwordx4 v7, s[16:19], s38 offen lds
s_add_u32 m0, s50, 54272
s_nop 0
buffer_load_dwordx4 v8, s[16:19], s38 offen lds
s_waitcnt vmcnt(10)
s_barrier
s_add_u32 s37, s35, 8
s_and_b32 s37, s37, 15
s_mul_i32 s37, s37, 16384
s_add_u32 m0, s39, 98304
s_nop 0
buffer_load_dwordx4 v3, s[8:11], s37 offen sc1 lds
s_load_dword s3, s[4:5], 50368
s_load_dword s3, s[4:5], 57344
s_load_dword s3, s[4:5], 57408
buffer_load_dwordx4 v3, s[8:11], s37 offen offset:1024 sc1 lds
s_load_dword s3, s[4:5], 57472
s_load_dword s3, s[4:5], 57536
s_load_dword s3, s[4:5], 64512
s_load_dword s3, s[4:5], 64576
buffer_load_dwordx4 v3, s[8:11], s37 offen offset:2048 sc1 lds
s_load_dword s3, s[4:5], 64640
s_load_dword s3, s[4:5], 64704
s_load_dword s3, s[4:5], 71680
s_load_dword s3, s[4:5], 71744
buffer_load_dwordx4 v3, s[8:11], s37 offen offset:3072 sc1 lds
v_lshrrev_b32 v28, 2, v1
v_and_b32 v29, 7, v28
v_mul_u32_u24 v28, 256, v28
v_lshl_add_u32 v28, v29, 5, v28
s_add_u32 s38, s35, 8
s_and_b32 s38, s38, 15
s_mul_i32 s38, s38, 458752
s_add_u32 m0, s50, 98304
s_nop 0
buffer_load_dwordx4 v6, s[16:19], s38 offen lds
v_and_b32 v29, 3, v1
v_lshl_add_u32 v11, v29, 3, v28
s_lshl_b32 s43, s63, 7
v_xor_b32 v11, s43, v11
s_add_u32 m0, s50, 99328
s_nop 0
buffer_load_dwordx4 v7, s[16:19], s38 offen lds
v_add_u32 v11, 16384, v11
v_xor_b32 v12, 32, v11
v_xor_b32 v13, 64, v11
v_xor_b32 v14, 96, v11
s_add_u32 m0, s50, 100352
s_nop 0
buffer_load_dwordx4 v8, s[16:19], s38 offen lds
v_add_u32 v15, 49152, v11
v_add_u32 v16, 49152, v12
v_add_u32 v17, 49152, v13
v_add_u32 v18, 49152, v14
s_add_u32 m0, s50, 101376
s_add_u32 s38, s38, 114688
buffer_load_dwordx4 v6, s[16:19], s38 offen lds
v_add_u32 v19, 98304, v11
v_add_u32 v20, 98304, v12
v_add_u32 v21, 98304, v13
v_add_u32 v22, 98304, v14
s_add_u32 m0, s50, 102400
s_nop 0
buffer_load_dwordx4 v7, s[16:19], s38 offen lds
s_add_u32 m0, s50, 103424
s_nop 0
buffer_load_dwordx4 v8, s[16:19], s38 offen lds
s_waitcnt vmcnt(10)
s_barrier
s_cmp_eq_u32 s47, 3
s_cbranch_scc0 Lw_128
s_mul_i32 s60, s35, 96
s_add_u32 s61, s60, 95
s_and_b32 s60, s60, 0xff80
s_and_b32 s61, s61, 0xff80
s_add_u32 s60, s60, 28323840
s_add_u32 s61, s61, 28323840
s_load_dword s92, s[82:83], s60 glc
s_load_dword s93, s[82:83], s61 glc
Lw_128:
s_add_u32 s37, s35, 9
s_and_b32 s37, s37, 15
s_mul_i32 s37, s37, 16384
s_add_u32 m0, s39, 0
s_nop 0
buffer_load_dwordx4 v3, s[8:11], s37 offen sc1 lds
buffer_load_dwordx4 v3, s[8:11], s37 offen offset:1024 sc1 lds
buffer_load_dwordx4 v3, s[8:11], s37 offen offset:2048 sc1 lds
buffer_load_dwordx4 v3, s[8:11], s37 offen offset:3072 sc1 lds
s_add_u32 s38, s35, 9
s_and_b32 s38, s38, 15
s_mul_i32 s38, s38, 458752
s_add_u32 m0, s50, 0
s_nop 0
buffer_load_dwordx4 v6, s[16:19], s38 offen lds
s_add_u32 m0, s50, 1024
s_nop 0
buffer_load_dwordx4 v7, s[16:19], s38 offen lds
s_add_u32 m0, s50, 2048
s_nop 0
buffer_load_dwordx4 v8, s[16:19], s38 offen lds
s_add_u32 m0, s50, 3072
s_add_u32 s38, s38, 114688
buffer_load_dwordx4 v6, s[16:19], s38 offen lds
s_add_u32 m0, s50, 4096
s_nop 0
buffer_load_dwordx4 v7, s[16:19], s38 offen lds
s_add_u32 m0, s50, 5120
s_nop 0
buffer_load_dwordx4 v8, s[16:19], s38 offen lds
s_waitcnt vmcnt(10)
s_barrier
s_add_u32 s37, s35, 10
s_and_b32 s37, s37, 15
s_mul_i32 s37, s37, 16384
s_add_u32 m0, s39, 49152
s_nop 0
buffer_load_dwordx4 v3, s[8:11], s37 offen sc1 lds
buffer_load_dwordx4 v3, s[8:11], s37 offen offset:1024 sc1 lds
buffer_load_dwordx4 v3, s[8:11], s37 offen offset:2048 sc1 lds
buffer_load_dwordx4 v3, s[8:11], s37 offen offset:3072 sc1 lds
s_add_u32 s38, s35, 10
s_and_b32 s38, s38, 15
s_mul_i32 s38, s38, 458752
s_add_u32 m0, s50, 49152
s_nop 0
buffer_load_dwordx4 v6, s[16:19], s38 offen lds
s_add_u32 m0, s50, 50176
s_nop 0
buffer_load_dwordx4 v7, s[16:19], s38 offen lds
s_add_u32 m0, s50, 51200
s_nop 0
buffer_load_dwordx4 v8, s[16:19], s38 offen lds
s_add_u32 m0, s50, 52224
s_add_u32 s38, s38, 114688
buffer_load_dwordx4 v6, s[16:19], s38 offen lds
s_branch Lov_14
.p2align 12
.fill 112, 4, 0xbf800000
Lst_14_0:
s_branch Lwr_159
Lst_14_1:
s_branch Lst_18_0
s_nop 0
Lov_14:
s_add_u32 m0, s50, 53248
s_nop 0
buffer_load_dwordx4 v7, s[16:19], s38 offen lds
s_add_u32 m0, s50, 54272
s_nop 0
buffer_load_dwordx4 v8, s[16:19], s38 offen lds
s_mov_b32 s38, 0
buffer_load_dwordx4 v[40:43], v24, s[88:91], s38 offen
s_mov_b32 s38, 28672
buffer_load_dwordx4 v[44:47], v24, s[88:91], s38 offen
s_mov_b32 s38, 57344
buffer_load_dwordx4 v[48:51], v24, s[88:91], s38 offen
s_mov_b32 s38, 86016
buffer_load_dwordx4 v[52:55], v24, s[88:91], s38 offen
s_mov_b32 s38, 114688
buffer_load_dwordx4 v[56:59], v24, s[88:91], s38 offen
s_mov_b32 s38, 143360
buffer_load_dwordx4 v[60:63], v24, s[88:91], s38 offen
s_mov_b32 s38, 172032
buffer_load_dwordx4 v[64:67], v24, s[88:91], s38 offen
s_mov_b32 s38, 200704
buffer_load_dwordx4 v[68:71], v24, s[88:91], s38 offen
s_waitcnt vmcnt(18)
s_cmp_eq_u32 s47, 3
s_cbranch_scc0 Lw_129
s_mov_b32 s41, 0x40000
Lcp_130:
s_waitcnt lgkmcnt(0)
s_and_b32 s92, s92, s93
s_cmp_eq_u32 s92, 16
s_cbranch_scc1 Lco_131
s_load_dword s92, s[82:83], s60 glc
s_load_dword s93, s[82:83], s61 glc
s_sub_u32 s41, s41, 1
s_cmp_lg_u32 s41, 0
s_cbranch_scc1 Lcp_130
s_waitcnt lgkmcnt(0)
Lco_131:
Lw_129:
s_barrier
s_mov_b32 s45, s47
s_cmp_ge_u32 s45, 3
s_cselect_b32 s43, 1, 0
s_mul_i32 s44, s43, 3
s_sub_u32 s45, s45, s44
s_lshl_b32 s45, s45, 7
s_mul_i32 s52, s43, 896
s_add_u32 s52, s52, s45
s_add_u32 s52, s52, 148992
s_mul_i32 s43, s43, 14336
s_add_u32 s43, s43, s45
s_mul_i32 s44, s35, 384
s_add_u32 s43, s43, s44
s_add_u32 s60, s43, 8192
s_add_u32 s45, s47, 4
s_min_u32 s45, s45, 5
s_cmp_ge_u32 s45, 3
s_cselect_b32 s43, 1, 0
s_mul_i32 s44, s43, 3
s_sub_u32 s45, s45, s44
s_lshl_b32 s45, s45, 7
s_mul_i32 s53, s43, 896
s_add_u32 s53, s53, s45
s_add_u32 s53, s53, 148992
s_mul_i32 s43, s43, 14336
s_add_u32 s43, s43, s45
s_mul_i32 s44, s35, 384
s_add_u32 s43, s43, s44
s_add_u32 s61, s43, 8192
v_lshrrev_b32 v104, 3, v1
v_mul_u32_u24 v104, 28672, v104
v_and_b32 v105, 7, v1
v_lshl_add_u32 v104, v105, 4, v104
buffer_load_dwordx4 v[96:99], v104, s[84:87], s60 offen sc1
s_load_dword s3, s[4:5], 71808
s_load_dword s3, s[4:5], 71872
buffer_load_dwordx4 v[100:103], v104, s[84:87], s61 offen sc1
s_and_b32 s44, s36, 3
s_mul_i32 s43, s2, 28672
s_add_u32 s37, s35, 11
s_and_b32 s37, s37, 15
s_mul_i32 s37, s37, 16384
s_add_u32 m0, s39, 98304
s_nop 0
buffer_load_dwordx4 v3, s[8:11], s37 offen sc1 lds
s_mul_i32 s44, s44, 7168
s_add_u32 s43, s43, s44
buffer_load_dwordx4 v3, s[8:11], s37 offen offset:1024 sc1 lds
s_add_u32 s4, s76, s43
s_addc_u32 s5, s77, 0
s_load_dword s3, s[4:5], 0
buffer_load_dwordx4 v3, s[8:11], s37 offen offset:2048 sc1 lds
s_load_dword s3, s[4:5], 64
s_load_dword s3, s[4:5], 128
buffer_load_dwordx4 v3, s[8:11], s37 offen offset:3072 sc1 lds
s_load_dword s3, s[4:5], 192
s_load_dword s3, s[4:5], 256
s_add_u32 s38, s35, 11
s_and_b32 s38, s38, 15
s_mul_i32 s38, s38, 458752
s_add_u32 m0, s50, 98304
s_nop 0
buffer_load_dwordx4 v6, s[16:19], s38 offen lds
s_load_dword s3, s[4:5], 320
s_load_dword s3, s[4:5], 384
s_load_dword s3, s[4:5], 448
s_add_u32 m0, s50, 99328
s_nop 0
buffer_load_dwordx4 v7, s[16:19], s38 offen lds
v_cmp_gt_u32 vcc, 32, v1
v_mov_b32 v104, s52
s_add_u32 m0, s50, 100352
s_nop 0
buffer_load_dwordx4 v8, s[16:19], s38 offen lds
v_mov_b32 v106, s53
v_cndmask_b32 v104, v106, v104, vcc
s_add_u32 m0, s50, 101376
s_add_u32 s38, s38, 114688
buffer_load_dwordx4 v6, s[16:19], s38 offen lds
v_lshl_add_u32 v104, v105, 4, v104
v_bfe_u32 v105, v1, 4, 1
v_lshl_add_u32 v104, v105, 2, v104
s_add_u32 m0, s50, 102400
s_nop 0
buffer_load_dwordx4 v7, s[16:19], s38 offen lds
s_add_u32 m0, s50, 103424
s_nop 0
buffer_load_dwordx4 v8, s[16:19], s38 offen lds
s_waitcnt vmcnt(20)
s_barrier
s_add_u32 s37, s35, 12
s_and_b32 s37, s37, 15
s_mul_i32 s37, s37, 16384
s_add_u32 m0, s39, 0
s_nop 0
buffer_load_dwordx4 v3, s[8:11], s37 offen sc1 lds
buffer_load_dwordx4 v3, s[8:11], s37 offen offset:1024 sc1 lds
buffer_load_dwordx4 v3, s[8:11], s37 offen offset:2048 sc1 lds
buffer_load_dwordx4 v3, s[8:11], s37 offen offset:3072 sc1 lds
s_add_u32 s38, s35, 12
s_and_b32 s38, s38, 15
s_mul_i32 s38, s38, 458752
s_add_u32 m0, s50, 0
s_nop 0
buffer_load_dwordx4 v6, s[16:19], s38 offen lds
s_add_u32 m0, s50, 1024
s_nop 0
buffer_load_dwordx4 v7, s[16:19], s38 offen lds
s_add_u32 m0, s50, 2048
s_nop 0
buffer_load_dwordx4 v8, s[16:19], s38 offen lds
s_add_u32 m0, s50, 3072
s_add_u32 s38, s38, 114688
buffer_load_dwordx4 v6, s[16:19], s38 offen lds
s_add_u32 m0, s50, 4096
s_nop 0
buffer_load_dwordx4 v7, s[16:19], s38 offen lds
s_add_u32 m0, s50, 5120
s_nop 0
buffer_load_dwordx4 v8, s[16:19], s38 offen lds
s_waitcnt vmcnt(10)
s_barrier
v_permlane32_swap_b32 v96, v100
v_permlane32_swap_b32 v97, v101
v_permlane32_swap_b32 v98, v102
v_permlane32_swap_b32 v99, v103
v_add_f32 v96, v96, v100
v_add_f32 v97, v97, v101
v_add_f32 v98, v98, v102
v_add_f32 v99, v99, v103
s_nop 1
v_permlane16_swap_b32 v96, v97
v_permlane16_swap_b32 v98, v99
v_add_f32 v96, v96, v97
v_add_f32 v98, v98, v99
s_nop 1
v_add_f32_dpp v96, v96, v96 row_ror:8 row_mask:0xf bank_mask:0xf
v_add_f32_dpp v98, v98, v98 row_ror:8 row_mask:0xf bank_mask:0xf
ds_write_b32 v104, v96
ds_write_b32 v104, v98 offset:8
s_waitcnt lgkmcnt(0)
s_add_u32 s37, s35, 13
s_and_b32 s37, s37, 15
s_mul_i32 s37, s37, 16384
s_add_u32 m0, s39, 49152
s_nop 0
buffer_load_dwordx4 v3, s[8:11], s37 offen sc1 lds
s_load_dword s3, s[4:5], 512
s_load_dword s3, s[4:5], 576
s_load_dword s3, s[4:5], 640
s_load_dword s3, s[4:5], 704
s_load_dword s3, s[4:5], 768
buffer_load_dwordx4 v3, s[8:11], s37 offen offset:1024 sc1 lds
s_load_dword s3, s[4:5], 832
s_load_dword s3, s[4:5], 896
s_load_dword s3, s[4:5], 960
s_load_dword s3, s[4:5], 1024
s_load_dword s3, s[4:5], 1088
buffer_load_dwordx4 v3, s[8:11], s37 offen offset:2048 sc1 lds
v_lshlrev_b32 v72, 16, v40
v_and_b32 v73, 0xffff0000, v40
v_lshlrev_b32 v74, 16, v41
v_and_b32 v75, 0xffff0000, v41
v_lshlrev_b32 v76, 16, v42
v_and_b32 v77, 0xffff0000, v42
buffer_load_dwordx4 v3, s[8:11], s37 offen offset:3072 sc1 lds
v_lshlrev_b32 v78, 16, v43
v_and_b32 v79, 0xffff0000, v43
v_lshlrev_b32 v80, 16, v44
v_and_b32 v81, 0xffff0000, v44
v_lshlrev_b32 v82, 16, v45
s_add_u32 s38, s35, 13
s_and_b32 s38, s38, 15
s_mul_i32 s38, s38, 458752
s_add_u32 m0, s50, 49152
s_nop 0
buffer_load_dwordx4 v6, s[16:19], s38 offen lds
v_and_b32 v83, 0xffff0000, v45
v_lshlrev_b32 v84, 16, v46
v_and_b32 v85, 0xffff0000, v46
v_lshlrev_b32 v86, 16, v47
v_and_b32 v87, 0xffff0000, v47
s_add_u32 m0, s50, 50176
s_nop 0
buffer_load_dwordx4 v7, s[16:19], s38 offen lds
v_add_f32 v72, v72, v80
v_add_f32 v73, v73, v81
v_add_f32 v74, v74, v82
v_add_f32 v75, v75, v83
v_add_f32 v76, v76, v84
v_add_f32 v77, v77, v85
s_add_u32 m0, s50, 51200
s_nop 0
buffer_load_dwordx4 v8, s[16:19], s38 offen lds
v_add_f32 v78, v78, v86
v_add_f32 v79, v79, v87
v_lshlrev_b32 v80, 16, v48
v_and_b32 v81, 0xffff0000, v48
v_lshlrev_b32 v82, 16, v49
s_add_u32 m0, s50, 52224
s_add_u32 s38, s38, 114688
buffer_load_dwordx4 v6, s[16:19], s38 offen lds
v_and_b32 v83, 0xffff0000, v49
v_lshlrev_b32 v84, 16, v50
v_and_b32 v85, 0xffff0000, v50
v_lshlrev_b32 v86, 16, v51
v_and_b32 v87, 0xffff0000, v51
v_add_f32 v72, v72, v80
s_add_u32 m0, s50, 53248
s_nop 0
buffer_load_dwordx4 v7, s[16:19], s38 offen lds
s_add_u32 m0, s50, 54272
s_nop 0
buffer_load_dwordx4 v8, s[16:19], s38 offen lds
s_waitcnt vmcnt(10)
s_barrier
s_add_u32 s37, s35, 14
s_and_b32 s37, s37, 15
s_mul_i32 s37, s37, 16384
s_add_u32 m0, s39, 98304
s_nop 0
buffer_load_dwordx4 v3, s[8:11], s37 offen sc1 lds
s_load_dword s3, s[4:5], 1152
s_load_dword s3, s[4:5], 1216
s_load_dword s3, s[4:5], 1280
s_load_dword s3, s[4:5], 1344
s_load_dword s3, s[4:5], 1408
buffer_load_dwordx4 v3, s[8:11], s37 offen offset:1024 sc1 lds
s_load_dword s3, s[4:5], 1472
s_load_dword s3, s[4:5], 1536
s_load_dword s3, s[4:5], 1600
s_load_dword s3, s[4:5], 1664
s_load_dword s3, s[4:5], 1728
v_add_f32 v73, v73, v81
buffer_load_dwordx4 v3, s[8:11], s37 offen offset:2048 sc1 lds
v_add_f32 v74, v74, v82
v_add_f32 v75, v75, v83
v_add_f32 v76, v76, v84
v_add_f32 v77, v77, v85
v_add_f32 v78, v78, v86
buffer_load_dwordx4 v3, s[8:11], s37 offen offset:3072 sc1 lds
v_add_f32 v79, v79, v87
v_lshlrev_b32 v80, 16, v52
v_and_b32 v81, 0xffff0000, v52
v_lshlrev_b32 v82, 16, v53
v_and_b32 v83, 0xffff0000, v53
v_lshlrev_b32 v84, 16, v54
s_add_u32 s38, s35, 14
s_and_b32 s38, s38, 15
s_mul_i32 s38, s38, 458752
s_add_u32 m0, s50, 98304
s_nop 0
buffer_load_dwordx4 v6, s[16:19], s38 offen lds
v_and_b32 v85, 0xffff0000, v54
v_lshlrev_b32 v86, 16, v55
v_and_b32 v87, 0xffff0000, v55
v_add_f32 v72, v72, v80
v_add_f32 v73, v73, v81
s_add_u32 m0, s50, 99328
s_nop 0
buffer_load_dwordx4 v7, s[16:19], s38 offen lds
v_add_f32 v74, v74, v82
v_add_f32 v75, v75, v83
v_add_f32 v76, v76, v84
v_add_f32 v77, v77, v85
v_add_f32 v78, v78, v86
v_add_f32 v79, v79, v87
s_add_u32 m0, s50, 100352
s_nop 0
buffer_load_dwordx4 v8, s[16:19], s38 offen lds
v_lshlrev_b32 v80, 16, v56
v_and_b32 v81, 0xffff0000, v56
v_lshlrev_b32 v82, 16, v57
v_and_b32 v83, 0xffff0000, v57
v_lshlrev_b32 v84, 16, v58
s_add_u32 m0, s50, 101376
s_add_u32 s38, s38, 114688
buffer_load_dwordx4 v6, s[16:19], s38 offen lds
v_and_b32 v85, 0xffff0000, v58
v_lshlrev_b32 v86, 16, v59
v_and_b32 v87, 0xffff0000, v59
v_add_f32 v72, v72, v80
v_add_f32 v73, v73, v81
v_add_f32 v74, v74, v82
s_add_u32 m0, s50, 102400
s_nop 0
buffer_load_dwordx4 v7, s[16:19], s38 offen lds
s_add_u32 m0, s50, 103424
s_nop 0
buffer_load_dwordx4 v8, s[16:19], s38 offen lds
s_waitcnt vmcnt(10)
s_barrier
s_add_u32 s37, s35, 15
s_and_b32 s37, s37, 15
s_mul_i32 s37, s37, 16384
s_add_u32 m0, s39, 0
s_nop 0
buffer_load_dwordx4 v3, s[8:11], s37 offen sc1 lds
v_add_f32 v75, v75, v83
v_add_f32 v76, v76, v84
v_add_f32 v77, v77, v85
v_add_f32 v78, v78, v86
buffer_load_dwordx4 v3, s[8:11], s37 offen offset:1024 sc1 lds
v_add_f32 v79, v79, v87
v_lshlrev_b32 v80, 16, v60
v_and_b32 v81, 0xffff0000, v60
v_lshlrev_b32 v82, 16, v61
buffer_load_dwordx4 v3, s[8:11], s37 offen offset:2048 sc1 lds
v_and_b32 v83, 0xffff0000, v61
v_lshlrev_b32 v84, 16, v62
v_and_b32 v85, 0xffff0000, v62
v_lshlrev_b32 v86, 16, v63
buffer_load_dwordx4 v3, s[8:11], s37 offen offset:3072 sc1 lds
v_and_b32 v87, 0xffff0000, v63
v_add_f32 v72, v72, v80
v_add_f32 v73, v73, v81
v_add_f32 v74, v74, v82
s_add_u32 s38, s35, 15
s_and_b32 s38, s38, 15
s_mul_i32 s38, s38, 458752
s_add_u32 m0, s50, 0
s_nop 0
buffer_load_dwordx4 v6, s[16:19], s38 offen lds
v_add_f32 v75, v75, v83
v_add_f32 v76, v76, v84
v_add_f32 v77, v77, v85
v_add_f32 v78, v78, v86
s_add_u32 m0, s50, 1024
s_nop 0
buffer_load_dwordx4 v7, s[16:19], s38 offen lds
v_add_f32 v79, v79, v87
v_lshlrev_b32 v80, 16, v64
v_and_b32 v81, 0xffff0000, v64
v_lshlrev_b32 v82, 16, v65
s_add_u32 m0, s50, 2048
s_nop 0
buffer_load_dwordx4 v8, s[16:19], s38 offen lds
v_and_b32 v83, 0xffff0000, v65
v_lshlrev_b32 v84, 16, v66
v_and_b32 v85, 0xffff0000, v66
v_lshlrev_b32 v86, 16, v67
s_add_u32 m0, s50, 3072
s_add_u32 s38, s38, 114688
buffer_load_dwordx4 v6, s[16:19], s38 offen lds
v_and_b32 v87, 0xffff0000, v67
v_add_f32 v72, v72, v80
v_add_f32 v73, v73, v81
v_add_f32 v74, v74, v82
v_add_f32 v75, v75, v83
s_add_u32 m0, s50, 4096
s_nop 0
buffer_load_dwordx4 v7, s[16:19], s38 offen lds
s_add_u32 m0, s50, 5120
s_nop 0
buffer_load_dwordx4 v8, s[16:19], s38 offen lds
s_waitcnt vmcnt(10)
s_barrier
s_add_u32 s38, s35, 13
s_and_b32 s38, s38, 15
s_mul_i32 s38, s38, 458752
s_add_u32 m0, s40, 49152
s_nop 0
buffer_load_dwordx4 v4, s[12:15], s38 offen lds
v_add_f32 v76, v76, v84
v_add_f32 v77, v77, v85
v_add_f32 v78, v78, v86
v_add_f32 v79, v79, v87
v_lshlrev_b32 v80, 16, v68
s_add_u32 m0, s40, 50176
s_nop 0
buffer_load_dwordx4 v5, s[12:15], s38 offen lds
v_and_b32 v81, 0xffff0000, v68
v_lshlrev_b32 v82, 16, v69
v_and_b32 v83, 0xffff0000, v69
v_lshlrev_b32 v84, 16, v70
v_and_b32 v85, 0xffff0000, v70
v_lshlrev_b32 v86, 16, v71
s_add_u32 m0, s40, 51200
s_add_u32 s38, s38, 57344
buffer_load_dwordx4 v4, s[12:15], s38 offen lds
v_and_b32 v87, 0xffff0000, v71
v_add_f32 v72, v72, v80
v_add_f32 v73, v73, v81
v_add_f32 v74, v74, v82
v_add_f32 v75, v75, v83
v_add_f32 v76, v76, v84
s_add_u32 m0, s40, 52224
s_nop 0
buffer_load_dwordx4 v5, s[12:15], s38 offen lds
v_add_f32 v77, v77, v85
v_add_f32 v78, v78, v86
v_add_f32 v79, v79, v87
s_nop 0
v_permlane32_swap_b32 v72, v76
s_add_u32 m0, s40, 53248
s_add_u32 s38, s38, 57344
buffer_load_dwordx4 v4, s[12:15], s38 offen lds
v_permlane32_swap_b32 v73, v77
v_permlane32_swap_b32 v74, v78
v_permlane32_swap_b32 v75, v79
v_add_f32 v72, v72, v76
v_add_f32 v73, v73, v77
v_add_f32 v74, v74, v78
s_add_u32 m0, s40, 54272
s_nop 0
buffer_load_dwordx4 v5, s[12:15], s38 offen lds
v_add_f32 v75, v75, v79
s_nop 0
v_permlane16_swap_b32 v72, v74
v_permlane16_swap_b32 v73, v75
v_add_f32 v72, v72, v74
v_add_f32 v73, v73, v75
s_add_u32 m0, s40, 55296
s_add_u32 s38, s38, 57344
buffer_load_dwordx4 v4, s[12:15], s38 offen lds
s_add_u32 m0, s40, 56320
s_nop 0
buffer_load_dwordx4 v5, s[12:15], s38 offen lds
s_waitcnt vmcnt(8)
s_barrier
s_lshl_b32 s43, s47, 9
s_add_u32 s43, s43, 153600
v_and_b32 v80, 15, v1
v_lshl_add_u32 v80, v80, 5, s43
v_lshrrev_b32 v81, 4, v1
v_lshl_add_u32 v80, v81, 3, v80
ds_write_b64 v80, v[72:73]
s_waitcnt lgkmcnt(0)
s_add_u32 s38, s35, 14
s_and_b32 s38, s38, 15
s_mul_i32 s38, s38, 458752
s_add_u32 m0, s40, 98304
s_nop 0
buffer_load_dwordx4 v4, s[12:15], s38 offen lds
s_bfe_u32 s61, s35, 0x10002
s_lshr_b32 s60, s35, 3
s_lshl_b32 s60, s60, 2
s_and_b32 s43, s35, 3
s_add_u32 s60, s60, s43
s_add_u32 m0, s40, 99328
s_nop 0
buffer_load_dwordx4 v5, s[12:15], s38 offen lds
s_lshl_b32 s43, s60, 8
s_add_u32 s28, s76, s43
s_addc_u32 s29, s77, 0
s_mov_b32 s30, 7338240
s_mov_b32 s31, 0x20000
s_add_u32 m0, s40, 100352
s_add_u32 s38, s38, 57344
buffer_load_dwordx4 v4, s[12:15], s38 offen lds
s_mul_i32 s52, s61, 196608
s_mul_i32 s53, s61, 1572864
s_mul_i32 s90, s61, 163840
s_mul_i32 s91, s61, 1310720
s_and_b32 s43, s35, 3
s_add_u32 m0, s40, 101376
s_nop 0
buffer_load_dwordx4 v5, s[12:15], s38 offen lds
s_mul_i32 s32, s43, 3
s_mul_i32 s33, s43, 10
s_lshr_b32 s33, s33, 2
s_lshl_b32 s51, s47, 11
s_lshl_b32 s44, s47, 15
s_add_u32 m0, s40, 102400
s_add_u32 s38, s38, 57344
buffer_load_dwordx4 v4, s[12:15], s38 offen lds
v_lshrrev_b32 v122, 4, v1
v_lshlrev_b32 v123, 1, v122
v_and_b32 v23, 15, v1
v_xor_b32 v23, v23, v123
v_lshlrev_b32 v23, 4, v23
s_add_u32 m0, s40, 103424
s_nop 0
buffer_load_dwordx4 v5, s[12:15], s38 offen lds
v_mul_u32_u24 v122, 2048, v122
v_add_u32 v23, v23, v122
v_add_u32 v23, s44, v23
v_xor_b32 v24, 128, v23
v_add_u32 v24, 8192, v24
s_add_u32 m0, s40, 104448
s_add_u32 s38, s38, 57344
buffer_load_dwordx4 v4, s[12:15], s38 offen lds
s_add_u32 m0, s40, 105472
s_nop 0
buffer_load_dwordx4 v5, s[12:15], s38 offen lds
s_waitcnt vmcnt(8)
s_barrier
ds_read_b128 v[28:31], v9 offset:49152
ds_read_b64_tr_b16 v[44:45], v15 offset:0
ds_read_b64_tr_b16 v[46:47], v15 offset:4096
ds_read_b64_tr_b16 v[48:49], v16 offset:0
ds_read_b64_tr_b16 v[50:51], v16 offset:4096
ds_read_b64_tr_b16 v[52:53], v17 offset:0
ds_read_b64_tr_b16 v[54:55], v17 offset:4096
ds_read_b64_tr_b16 v[56:57], v18 offset:0
ds_read_b64_tr_b16 v[58:59], v18 offset:4096
ds_read_b64_tr_b16 v[60:61], v15 offset:16384
ds_read_b64_tr_b16 v[62:63], v15 offset:20480
ds_read_b64_tr_b16 v[64:65], v16 offset:16384
ds_read_b64_tr_b16 v[66:67], v16 offset:20480
ds_read_b64_tr_b16 v[68:69], v17 offset:16384
ds_read_b64_tr_b16 v[70:71], v17 offset:20480
ds_read_b64_tr_b16 v[72:73], v18 offset:16384
ds_read_b64_tr_b16 v[74:75], v18 offset:20480
ds_read_b128 v[32:35], v9 offset:50176
ds_read_b128 v[36:39], v9 offset:51200
ds_read_b128 v[40:43], v9 offset:52224
s_waitcnt lgkmcnt(0)
v_mfma_f32_16x16x32_bf16 v[124:127], v[44:47], v[28:31], 0
ds_read_b128 v[76:79], v9 offset:57344
v_mfma_f32_16x16x32_bf16 v[156:159], v[44:47], v[32:35], 0
ds_read_b64_tr_b16 v[92:93], v15 offset:8192
v_mfma_f32_16x16x32_bf16 v[188:191], v[44:47], v[36:39], 0
ds_read_b64_tr_b16 v[94:95], v15 offset:12288
v_mfma_f32_16x16x32_bf16 v[220:223], v[44:47], v[40:43], 0
ds_read_b64_tr_b16 v[96:97], v16 offset:8192
v_mfma_f32_16x16x32_bf16 v[224:227], v[48:51], v[40:43], 0
ds_read_b64_tr_b16 v[98:99], v16 offset:12288
v_mfma_f32_16x16x32_bf16 v[192:195], v[48:51], v[36:39], 0
ds_read_b64_tr_b16 v[100:101], v17 offset:8192
v_mfma_f32_16x16x32_bf16 v[160:163], v[48:51], v[32:35], 0
ds_read_b64_tr_b16 v[102:103], v17 offset:12288
v_mfma_f32_16x16x32_bf16 v[128:131], v[48:51], v[28:31], 0
ds_read_b64_tr_b16 v[104:105], v18 offset:8192
v_mfma_f32_16x16x32_bf16 v[132:135], v[52:55], v[28:31], 0
ds_read_b64_tr_b16 v[106:107], v18 offset:12288
v_mfma_f32_16x16x32_bf16 v[164:167], v[52:55], v[32:35], 0
ds_read_b64_tr_b16 v[108:109], v15 offset:24576
v_mfma_f32_16x16x32_bf16 v[196:199], v[52:55], v[36:39], 0
ds_read_b64_tr_b16 v[110:111], v15 offset:28672
v_mfma_f32_16x16x32_bf16 v[228:231], v[52:55], v[40:43], 0
ds_read_b64_tr_b16 v[112:113], v16 offset:24576
v_mfma_f32_16x16x32_bf16 v[232:235], v[56:59], v[40:43], 0
ds_read_b64_tr_b16 v[114:115], v16 offset:28672
v_mfma_f32_16x16x32_bf16 v[200:203], v[56:59], v[36:39], 0
ds_read_b64_tr_b16 v[116:117], v17 offset:24576
v_mfma_f32_16x16x32_bf16 v[168:171], v[56:59], v[32:35], 0
ds_read_b64_tr_b16 v[118:119], v17 offset:28672
v_mfma_f32_16x16x32_bf16 v[136:139], v[56:59], v[28:31], 0
ds_read_b64_tr_b16 v[120:121], v18 offset:24576
v_mfma_f32_16x16x32_bf16 v[140:143], v[60:63], v[28:31], 0
ds_read_b64_tr_b16 v[122:123], v18 offset:28672
v_mfma_f32_16x16x32_bf16 v[172:175], v[60:63], v[32:35], 0
ds_read_b128 v[80:83], v9 offset:58368
v_mfma_f32_16x16x32_bf16 v[204:207], v[60:63], v[36:39], 0
ds_read_b128 v[84:87], v9 offset:59392
v_mfma_f32_16x16x32_bf16 v[236:239], v[60:63], v[40:43], 0
ds_read_b128 v[88:91], v9 offset:60416
v_mfma_f32_16x16x32_bf16 v[240:243], v[64:67], v[40:43], 0
v_mfma_f32_16x16x32_bf16 v[208:211], v[64:67], v[36:39], 0
v_mfma_f32_16x16x32_bf16 v[176:179], v[64:67], v[32:35], 0
s_branch Lov_15
.p2align 12
.fill 112, 4, 0xbf800000
Lst_15_0:
s_branch Lwr_168
s_nop 0
s_nop 0
Lov_15:
v_mfma_f32_16x16x32_bf16 v[144:147], v[64:67], v[28:31], 0
v_mfma_f32_16x16x32_bf16 v[148:151], v[68:71], v[28:31], 0
v_mfma_f32_16x16x32_bf16 v[180:183], v[68:71], v[32:35], 0
v_mfma_f32_16x16x32_bf16 v[212:215], v[68:71], v[36:39], 0
v_mfma_f32_16x16x32_bf16 v[244:247], v[68:71], v[40:43], 0
v_mfma_f32_16x16x32_bf16 v[248:251], v[72:75], v[40:43], 0
v_mfma_f32_16x16x32_bf16 v[216:219], v[72:75], v[36:39], 0
v_mfma_f32_16x16x32_bf16 v[184:187], v[72:75], v[32:35], 0
v_mfma_f32_16x16x32_bf16 v[152:155], v[72:75], v[28:31], 0
s_waitcnt vmcnt(0)
s_waitcnt lgkmcnt(0)
s_barrier
v_mfma_f32_16x16x32_bf16 v[124:127], v[92:95], v[76:79], v[124:127]
ds_read_b128 v[28:31], v10 offset:0
v_mfma_f32_16x16x32_bf16 v[156:159], v[92:95], v[80:83], v[156:159]
ds_read_b64_tr_b16 v[44:45], v19 offset:0
v_mfma_f32_16x16x32_bf16 v[188:191], v[92:95], v[84:87], v[188:191]
ds_read_b64_tr_b16 v[46:47], v19 offset:4096
v_mfma_f32_16x16x32_bf16 v[220:223], v[92:95], v[88:91], v[220:223]
ds_read_b64_tr_b16 v[48:49], v20 offset:0
v_mfma_f32_16x16x32_bf16 v[224:227], v[96:99], v[88:91], v[224:227]
ds_read_b64_tr_b16 v[50:51], v20 offset:4096
v_mfma_f32_16x16x32_bf16 v[192:195], v[96:99], v[84:87], v[192:195]
ds_read_b64_tr_b16 v[52:53], v21 offset:0
v_mfma_f32_16x16x32_bf16 v[160:163], v[96:99], v[80:83], v[160:163]
ds_read_b64_tr_b16 v[54:55], v21 offset:4096
v_mfma_f32_16x16x32_bf16 v[128:131], v[96:99], v[76:79], v[128:131]
ds_read_b64_tr_b16 v[56:57], v22 offset:0
v_mfma_f32_16x16x32_bf16 v[132:135], v[100:103], v[76:79], v[132:135]
ds_read_b64_tr_b16 v[58:59], v22 offset:4096
v_mfma_f32_16x16x32_bf16 v[164:167], v[100:103], v[80:83], v[164:167]
ds_read_b64_tr_b16 v[60:61], v19 offset:16384
v_mfma_f32_16x16x32_bf16 v[196:199], v[100:103], v[84:87], v[196:199]
ds_read_b64_tr_b16 v[62:63], v19 offset:20480
v_mfma_f32_16x16x32_bf16 v[228:231], v[100:103], v[88:91], v[228:231]
ds_read_b64_tr_b16 v[64:65], v20 offset:16384
v_mfma_f32_16x16x32_bf16 v[232:235], v[104:107], v[88:91], v[232:235]
ds_read_b64_tr_b16 v[66:67], v20 offset:20480
v_mfma_f32_16x16x32_bf16 v[200:203], v[104:107], v[84:87], v[200:203]
ds_read_b64_tr_b16 v[68:69], v21 offset:16384
v_mfma_f32_16x16x32_bf16 v[168:171], v[104:107], v[80:83], v[168:171]
ds_read_b64_tr_b16 v[70:71], v21 offset:20480
v_mfma_f32_16x16x32_bf16 v[136:139], v[104:107], v[76:79], v[136:139]
ds_read_b64_tr_b16 v[72:73], v22 offset:16384
v_mfma_f32_16x16x32_bf16 v[140:143], v[108:111], v[76:79], v[140:143]
ds_read_b64_tr_b16 v[74:75], v22 offset:20480
v_mfma_f32_16x16x32_bf16 v[172:175], v[108:111], v[80:83], v[172:175]
ds_read_b128 v[32:35], v10 offset:1024
v_mfma_f32_16x16x32_bf16 v[204:207], v[108:111], v[84:87], v[204:207]
ds_read_b128 v[36:39], v10 offset:2048
v_mfma_f32_16x16x32_bf16 v[236:239], v[108:111], v[88:91], v[236:239]
ds_read_b128 v[40:43], v10 offset:3072
v_mfma_f32_16x16x32_bf16 v[240:243], v[112:115], v[88:91], v[240:243]
v_mfma_f32_16x16x32_bf16 v[208:211], v[112:115], v[84:87], v[208:211]
v_mfma_f32_16x16x32_bf16 v[176:179], v[112:115], v[80:83], v[176:179]
v_mfma_f32_16x16x32_bf16 v[144:147], v[112:115], v[76:79], v[144:147]
v_mfma_f32_16x16x32_bf16 v[148:151], v[116:119], v[76:79], v[148:151]
v_mfma_f32_16x16x32_bf16 v[180:183], v[116:119], v[80:83], v[180:183]
v_mfma_f32_16x16x32_bf16 v[212:215], v[116:119], v[84:87], v[212:215]
v_mfma_f32_16x16x32_bf16 v[244:247], v[116:119], v[88:91], v[244:247]
v_mfma_f32_16x16x32_bf16 v[248:251], v[120:123], v[88:91], v[248:251]
v_mfma_f32_16x16x32_bf16 v[216:219], v[120:123], v[84:87], v[216:219]
v_mfma_f32_16x16x32_bf16 v[184:187], v[120:123], v[80:83], v[184:187]
v_mfma_f32_16x16x32_bf16 v[152:155], v[120:123], v[76:79], v[152:155]
s_mov_b32 s41, 5
Lk3l_132:
s_waitcnt lgkmcnt(0)
v_mfma_f32_16x16x32_bf16 v[124:127], v[44:47], v[28:31], v[124:127]
ds_read_b128 v[76:79], v10 offset:8192
v_mfma_f32_16x16x32_bf16 v[156:159], v[44:47], v[32:35], v[156:159]
ds_read_b64_tr_b16 v[92:93], v19 offset:8192
v_mfma_f32_16x16x32_bf16 v[188:191], v[44:47], v[36:39], v[188:191]
ds_read_b64_tr_b16 v[94:95], v19 offset:12288
v_mfma_f32_16x16x32_bf16 v[220:223], v[44:47], v[40:43], v[220:223]
ds_read_b64_tr_b16 v[96:97], v20 offset:8192
v_mfma_f32_16x16x32_bf16 v[224:227], v[48:51], v[40:43], v[224:227]
ds_read_b64_tr_b16 v[98:99], v20 offset:12288
v_mfma_f32_16x16x32_bf16 v[192:195], v[48:51], v[36:39], v[192:195]
ds_read_b64_tr_b16 v[100:101], v21 offset:8192
v_mfma_f32_16x16x32_bf16 v[160:163], v[48:51], v[32:35], v[160:163]
ds_read_b64_tr_b16 v[102:103], v21 offset:12288
v_mfma_f32_16x16x32_bf16 v[128:131], v[48:51], v[28:31], v[128:131]
ds_read_b64_tr_b16 v[104:105], v22 offset:8192
v_mfma_f32_16x16x32_bf16 v[132:135], v[52:55], v[28:31], v[132:135]
ds_read_b64_tr_b16 v[106:107], v22 offset:12288
v_mfma_f32_16x16x32_bf16 v[164:167], v[52:55], v[32:35], v[164:167]
ds_read_b64_tr_b16 v[108:109], v19 offset:24576
v_mfma_f32_16x16x32_bf16 v[196:199], v[52:55], v[36:39], v[196:199]
ds_read_b64_tr_b16 v[110:111], v19 offset:28672
v_mfma_f32_16x16x32_bf16 v[228:231], v[52:55], v[40:43], v[228:231]
ds_read_b64_tr_b16 v[112:113], v20 offset:24576
v_mfma_f32_16x16x32_bf16 v[232:235], v[56:59], v[40:43], v[232:235]
ds_read_b64_tr_b16 v[114:115], v20 offset:28672
v_mfma_f32_16x16x32_bf16 v[200:203], v[56:59], v[36:39], v[200:203]
ds_read_b64_tr_b16 v[116:117], v21 offset:24576
v_mfma_f32_16x16x32_bf16 v[168:171], v[56:59], v[32:35], v[168:171]
ds_read_b64_tr_b16 v[118:119], v21 offset:28672
v_mfma_f32_16x16x32_bf16 v[136:139], v[56:59], v[28:31], v[136:139]
ds_read_b64_tr_b16 v[120:121], v22 offset:24576
v_mfma_f32_16x16x32_bf16 v[140:143], v[60:63], v[28:31], v[140:143]
ds_read_b64_tr_b16 v[122:123], v22 offset:28672
v_mfma_f32_16x16x32_bf16 v[172:175], v[60:63], v[32:35], v[172:175]
ds_read_b128 v[80:83], v10 offset:9216
v_mfma_f32_16x16x32_bf16 v[204:207], v[60:63], v[36:39], v[204:207]
ds_read_b128 v[84:87], v10 offset:10240
v_mfma_f32_16x16x32_bf16 v[236:239], v[60:63], v[40:43], v[236:239]
ds_read_b128 v[88:91], v10 offset:11264
v_mfma_f32_16x16x32_bf16 v[240:243], v[64:67], v[40:43], v[240:243]
v_mfma_f32_16x16x32_bf16 v[208:211], v[64:67], v[36:39], v[208:211]
v_mfma_f32_16x16x32_bf16 v[176:179], v[64:67], v[32:35], v[176:179]
v_mfma_f32_16x16x32_bf16 v[144:147], v[64:67], v[28:31], v[144:147]
v_mfma_f32_16x16x32_bf16 v[148:151], v[68:71], v[28:31], v[148:151]
v_mfma_f32_16x16x32_bf16 v[180:183], v[68:71], v[32:35], v[180:183]
v_mfma_f32_16x16x32_bf16 v[212:215], v[68:71], v[36:39], v[212:215]
v_mfma_f32_16x16x32_bf16 v[244:247], v[68:71], v[40:43], v[244:247]
v_mfma_f32_16x16x32_bf16 v[248:251], v[72:75], v[40:43], v[248:251]
v_mfma_f32_16x16x32_bf16 v[216:219], v[72:75], v[36:39], v[216:219]
v_mfma_f32_16x16x32_bf16 v[184:187], v[72:75], v[32:35], v[184:187]
v_mfma_f32_16x16x32_bf16 v[152:155], v[72:75], v[28:31], v[152:155]
s_waitcnt lgkmcnt(0)
s_barrier
v_mfma_f32_16x16x32_bf16 v[124:127], v[92:95], v[76:79], v[124:127]
ds_read_b128 v[28:31], v9 offset:0
v_mfma_f32_16x16x32_bf16 v[156:159], v[92:95], v[80:83], v[156:159]
ds_read_b64_tr_b16 v[44:45], v11 offset:0
v_mfma_f32_16x16x32_bf16 v[188:191], v[92:95], v[84:87], v[188:191]
ds_read_b64_tr_b16 v[46:47], v11 offset:4096
v_mfma_f32_16x16x32_bf16 v[220:223], v[92:95], v[88:91], v[220:223]
ds_read_b64_tr_b16 v[48:49], v12 offset:0
v_mfma_f32_16x16x32_bf16 v[224:227], v[96:99], v[88:91], v[224:227]
ds_read_b64_tr_b16 v[50:51], v12 offset:4096
v_mfma_f32_16x16x32_bf16 v[192:195], v[96:99], v[84:87], v[192:195]
ds_read_b64_tr_b16 v[52:53], v13 offset:0
v_mfma_f32_16x16x32_bf16 v[160:163], v[96:99], v[80:83], v[160:163]
ds_read_b64_tr_b16 v[54:55], v13 offset:4096
v_mfma_f32_16x16x32_bf16 v[128:131], v[96:99], v[76:79], v[128:131]
ds_read_b64_tr_b16 v[56:57], v14 offset:0
v_mfma_f32_16x16x32_bf16 v[132:135], v[100:103], v[76:79], v[132:135]
ds_read_b64_tr_b16 v[58:59], v14 offset:4096
v_mfma_f32_16x16x32_bf16 v[164:167], v[100:103], v[80:83], v[164:167]
ds_read_b64_tr_b16 v[60:61], v11 offset:16384
v_mfma_f32_16x16x32_bf16 v[196:199], v[100:103], v[84:87], v[196:199]
ds_read_b64_tr_b16 v[62:63], v11 offset:20480
v_mfma_f32_16x16x32_bf16 v[228:231], v[100:103], v[88:91], v[228:231]
ds_read_b64_tr_b16 v[64:65], v12 offset:16384
v_mfma_f32_16x16x32_bf16 v[232:235], v[104:107], v[88:91], v[232:235]
ds_read_b64_tr_b16 v[66:67], v12 offset:20480
v_mfma_f32_16x16x32_bf16 v[200:203], v[104:107], v[84:87], v[200:203]
ds_read_b64_tr_b16 v[68:69], v13 offset:16384
v_mfma_f32_16x16x32_bf16 v[168:171], v[104:107], v[80:83], v[168:171]
ds_read_b64_tr_b16 v[70:71], v13 offset:20480
v_mfma_f32_16x16x32_bf16 v[136:139], v[104:107], v[76:79], v[136:139]
ds_read_b64_tr_b16 v[72:73], v14 offset:16384
v_mfma_f32_16x16x32_bf16 v[140:143], v[108:111], v[76:79], v[140:143]
ds_read_b64_tr_b16 v[74:75], v14 offset:20480
v_mfma_f32_16x16x32_bf16 v[172:175], v[108:111], v[80:83], v[172:175]
ds_read_b128 v[32:35], v9 offset:1024
v_mfma_f32_16x16x32_bf16 v[204:207], v[108:111], v[84:87], v[204:207]
ds_read_b128 v[36:39], v9 offset:2048
v_mfma_f32_16x16x32_bf16 v[236:239], v[108:111], v[88:91], v[236:239]
ds_read_b128 v[40:43], v9 offset:3072
v_mfma_f32_16x16x32_bf16 v[240:243], v[112:115], v[88:91], v[240:243]
v_mfma_f32_16x16x32_bf16 v[208:211], v[112:115], v[84:87], v[208:211]
v_mfma_f32_16x16x32_bf16 v[176:179], v[112:115], v[80:83], v[176:179]
v_mfma_f32_16x16x32_bf16 v[144:147], v[112:115], v[76:79], v[144:147]
v_mfma_f32_16x16x32_bf16 v[148:151], v[116:119], v[76:79], v[148:151]
v_mfma_f32_16x16x32_bf16 v[180:183], v[116:119], v[80:83], v[180:183]
v_mfma_f32_16x16x32_bf16 v[212:215], v[116:119], v[84:87], v[212:215]
v_mfma_f32_16x16x32_bf16 v[244:247], v[116:119], v[88:91], v[244:247]
v_mfma_f32_16x16x32_bf16 v[248:251], v[120:123], v[88:91], v[248:251]
v_mfma_f32_16x16x32_bf16 v[216:219], v[120:123], v[84:87], v[216:219]
v_mfma_f32_16x16x32_bf16 v[184:187], v[120:123], v[80:83], v[184:187]
v_mfma_f32_16x16x32_bf16 v[152:155], v[120:123], v[76:79], v[152:155]
s_waitcnt lgkmcnt(0)
v_mfma_f32_16x16x32_bf16 v[124:127], v[44:47], v[28:31], v[124:127]
ds_read_b128 v[76:79], v9 offset:8192
v_mfma_f32_16x16x32_bf16 v[156:159], v[44:47], v[32:35], v[156:159]
ds_read_b64_tr_b16 v[92:93], v11 offset:8192
v_mfma_f32_16x16x32_bf16 v[188:191], v[44:47], v[36:39], v[188:191]
ds_read_b64_tr_b16 v[94:95], v11 offset:12288
v_mfma_f32_16x16x32_bf16 v[220:223], v[44:47], v[40:43], v[220:223]
ds_read_b64_tr_b16 v[96:97], v12 offset:8192
v_mfma_f32_16x16x32_bf16 v[224:227], v[48:51], v[40:43], v[224:227]
ds_read_b64_tr_b16 v[98:99], v12 offset:12288
v_mfma_f32_16x16x32_bf16 v[192:195], v[48:51], v[36:39], v[192:195]
ds_read_b64_tr_b16 v[100:101], v13 offset:8192
v_mfma_f32_16x16x32_bf16 v[160:163], v[48:51], v[32:35], v[160:163]
ds_read_b64_tr_b16 v[102:103], v13 offset:12288
v_mfma_f32_16x16x32_bf16 v[128:131], v[48:51], v[28:31], v[128:131]
ds_read_b64_tr_b16 v[104:105], v14 offset:8192
v_mfma_f32_16x16x32_bf16 v[132:135], v[52:55], v[28:31], v[132:135]
ds_read_b64_tr_b16 v[106:107], v14 offset:12288
v_mfma_f32_16x16x32_bf16 v[164:167], v[52:55], v[32:35], v[164:167]
ds_read_b64_tr_b16 v[108:109], v11 offset:24576
v_mfma_f32_16x16x32_bf16 v[196:199], v[52:55], v[36:39], v[196:199]
ds_read_b64_tr_b16 v[110:111], v11 offset:28672
v_mfma_f32_16x16x32_bf16 v[228:231], v[52:55], v[40:43], v[228:231]
ds_read_b64_tr_b16 v[112:113], v12 offset:24576
v_mfma_f32_16x16x32_bf16 v[232:235], v[56:59], v[40:43], v[232:235]
ds_read_b64_tr_b16 v[114:115], v12 offset:28672
v_mfma_f32_16x16x32_bf16 v[200:203], v[56:59], v[36:39], v[200:203]
ds_read_b64_tr_b16 v[116:117], v13 offset:24576
v_mfma_f32_16x16x32_bf16 v[168:171], v[56:59], v[32:35], v[168:171]
ds_read_b64_tr_b16 v[118:119], v13 offset:28672
v_mfma_f32_16x16x32_bf16 v[136:139], v[56:59], v[28:31], v[136:139]
ds_read_b64_tr_b16 v[120:121], v14 offset:24576
v_mfma_f32_16x16x32_bf16 v[140:143], v[60:63], v[28:31], v[140:143]
ds_read_b64_tr_b16 v[122:123], v14 offset:28672
v_mfma_f32_16x16x32_bf16 v[172:175], v[60:63], v[32:35], v[172:175]
ds_read_b128 v[80:83], v9 offset:9216
v_mfma_f32_16x16x32_bf16 v[204:207], v[60:63], v[36:39], v[204:207]
ds_read_b128 v[84:87], v9 offset:10240
v_mfma_f32_16x16x32_bf16 v[236:239], v[60:63], v[40:43], v[236:239]
ds_read_b128 v[88:91], v9 offset:11264
v_mfma_f32_16x16x32_bf16 v[240:243], v[64:67], v[40:43], v[240:243]
v_mfma_f32_16x16x32_bf16 v[208:211], v[64:67], v[36:39], v[208:211]
v_mfma_f32_16x16x32_bf16 v[176:179], v[64:67], v[32:35], v[176:179]
v_mfma_f32_16x16x32_bf16 v[144:147], v[64:67], v[28:31], v[144:147]
v_mfma_f32_16x16x32_bf16 v[148:151], v[68:71], v[28:31], v[148:151]
v_mfma_f32_16x16x32_bf16 v[180:183], v[68:71], v[32:35], v[180:183]
v_mfma_f32_16x16x32_bf16 v[212:215], v[68:71], v[36:39], v[212:215]
v_mfma_f32_16x16x32_bf16 v[244:247], v[68:71], v[40:43], v[244:247]
v_mfma_f32_16x16x32_bf16 v[248:251], v[72:75], v[40:43], v[248:251]
v_mfma_f32_16x16x32_bf16 v[216:219], v[72:75], v[36:39], v[216:219]
v_mfma_f32_16x16x32_bf16 v[184:187], v[72:75], v[32:35], v[184:187]
v_mfma_f32_16x16x32_bf16 v[152:155], v[72:75], v[28:31], v[152:155]
s_waitcnt lgkmcnt(0)
s_barrier
v_mfma_f32_16x16x32_bf16 v[124:127], v[92:95], v[76:79], v[124:127]
ds_read_b128 v[28:31], v9 offset:49152
v_mfma_f32_16x16x32_bf16 v[156:159], v[92:95], v[80:83], v[156:159]
ds_read_b64_tr_b16 v[44:45], v15 offset:0
v_mfma_f32_16x16x32_bf16 v[188:191], v[92:95], v[84:87], v[188:191]
ds_read_b64_tr_b16 v[46:47], v15 offset:4096
v_mfma_f32_16x16x32_bf16 v[220:223], v[92:95], v[88:91], v[220:223]
ds_read_b64_tr_b16 v[48:49], v16 offset:0
v_mfma_f32_16x16x32_bf16 v[224:227], v[96:99], v[88:91], v[224:227]
ds_read_b64_tr_b16 v[50:51], v16 offset:4096
v_mfma_f32_16x16x32_bf16 v[192:195], v[96:99], v[84:87], v[192:195]
ds_read_b64_tr_b16 v[52:53], v17 offset:0
v_mfma_f32_16x16x32_bf16 v[160:163], v[96:99], v[80:83], v[160:163]
ds_read_b64_tr_b16 v[54:55], v17 offset:4096
v_mfma_f32_16x16x32_bf16 v[128:131], v[96:99], v[76:79], v[128:131]
ds_read_b64_tr_b16 v[56:57], v18 offset:0
v_mfma_f32_16x16x32_bf16 v[132:135], v[100:103], v[76:79], v[132:135]
ds_read_b64_tr_b16 v[58:59], v18 offset:4096
v_mfma_f32_16x16x32_bf16 v[164:167], v[100:103], v[80:83], v[164:167]
ds_read_b64_tr_b16 v[60:61], v15 offset:16384
v_mfma_f32_16x16x32_bf16 v[196:199], v[100:103], v[84:87], v[196:199]
ds_read_b64_tr_b16 v[62:63], v15 offset:20480
v_mfma_f32_16x16x32_bf16 v[228:231], v[100:103], v[88:91], v[228:231]
ds_read_b64_tr_b16 v[64:65], v16 offset:16384
v_mfma_f32_16x16x32_bf16 v[232:235], v[104:107], v[88:91], v[232:235]
ds_read_b64_tr_b16 v[66:67], v16 offset:20480
v_mfma_f32_16x16x32_bf16 v[200:203], v[104:107], v[84:87], v[200:203]
ds_read_b64_tr_b16 v[68:69], v17 offset:16384
v_mfma_f32_16x16x32_bf16 v[168:171], v[104:107], v[80:83], v[168:171]
ds_read_b64_tr_b16 v[70:71], v17 offset:20480
v_mfma_f32_16x16x32_bf16 v[136:139], v[104:107], v[76:79], v[136:139]
ds_read_b64_tr_b16 v[72:73], v18 offset:16384
v_mfma_f32_16x16x32_bf16 v[140:143], v[108:111], v[76:79], v[140:143]
ds_read_b64_tr_b16 v[74:75], v18 offset:20480
v_mfma_f32_16x16x32_bf16 v[172:175], v[108:111], v[80:83], v[172:175]
ds_read_b128 v[32:35], v9 offset:50176
v_mfma_f32_16x16x32_bf16 v[204:207], v[108:111], v[84:87], v[204:207]
ds_read_b128 v[36:39], v9 offset:51200
v_mfma_f32_16x16x32_bf16 v[236:239], v[108:111], v[88:91], v[236:239]
ds_read_b128 v[40:43], v9 offset:52224
v_mfma_f32_16x16x32_bf16 v[240:243], v[112:115], v[88:91], v[240:243]
v_mfma_f32_16x16x32_bf16 v[208:211], v[112:115], v[84:87], v[208:211]
v_mfma_f32_16x16x32_bf16 v[176:179], v[112:115], v[80:83], v[176:179]
v_mfma_f32_16x16x32_bf16 v[144:147], v[112:115], v[76:79], v[144:147]
v_mfma_f32_16x16x32_bf16 v[148:151], v[116:119], v[76:79], v[148:151]
v_mfma_f32_16x16x32_bf16 v[180:183], v[116:119], v[80:83], v[180:183]
v_mfma_f32_16x16x32_bf16 v[212:215], v[116:119], v[84:87], v[212:215]
v_mfma_f32_16x16x32_bf16 v[244:247], v[116:119], v[88:91], v[244:247]
v_mfma_f32_16x16x32_bf16 v[248:251], v[120:123], v[88:91], v[248:251]
v_mfma_f32_16x16x32_bf16 v[216:219], v[120:123], v[84:87], v[216:219]
v_mfma_f32_16x16x32_bf16 v[184:187], v[120:123], v[80:83], v[184:187]
v_mfma_f32_16x16x32_bf16 v[152:155], v[120:123], v[76:79], v[152:155]
s_waitcnt lgkmcnt(0)
v_mfma_f32_16x16x32_bf16 v[124:127], v[44:47], v[28:31], v[124:127]
ds_read_b128 v[76:79], v9 offset:57344
v_mfma_f32_16x16x32_bf16 v[156:159], v[44:47], v[32:35], v[156:159]
ds_read_b64_tr_b16 v[92:93], v15 offset:8192
v_mfma_f32_16x16x32_bf16 v[188:191], v[44:47], v[36:39], v[188:191]
ds_read_b64_tr_b16 v[94:95], v15 offset:12288
v_mfma_f32_16x16x32_bf16 v[220:223], v[44:47], v[40:43], v[220:223]
ds_read_b64_tr_b16 v[96:97], v16 offset:8192
v_mfma_f32_16x16x32_bf16 v[224:227], v[48:51], v[40:43], v[224:227]
ds_read_b64_tr_b16 v[98:99], v16 offset:12288
v_mfma_f32_16x16x32_bf16 v[192:195], v[48:51], v[36:39], v[192:195]
ds_read_b64_tr_b16 v[100:101], v17 offset:8192
v_mfma_f32_16x16x32_bf16 v[160:163], v[48:51], v[32:35], v[160:163]
ds_read_b64_tr_b16 v[102:103], v17 offset:12288
v_mfma_f32_16x16x32_bf16 v[128:131], v[48:51], v[28:31], v[128:131]
ds_read_b64_tr_b16 v[104:105], v18 offset:8192
v_mfma_f32_16x16x32_bf16 v[132:135], v[52:55], v[28:31], v[132:135]
ds_read_b64_tr_b16 v[106:107], v18 offset:12288
v_mfma_f32_16x16x32_bf16 v[164:167], v[52:55], v[32:35], v[164:167]
ds_read_b64_tr_b16 v[108:109], v15 offset:24576
v_mfma_f32_16x16x32_bf16 v[196:199], v[52:55], v[36:39], v[196:199]
ds_read_b64_tr_b16 v[110:111], v15 offset:28672
v_mfma_f32_16x16x32_bf16 v[228:231], v[52:55], v[40:43], v[228:231]
ds_read_b64_tr_b16 v[112:113], v16 offset:24576
v_mfma_f32_16x16x32_bf16 v[232:235], v[56:59], v[40:43], v[232:235]
ds_read_b64_tr_b16 v[114:115], v16 offset:28672
v_mfma_f32_16x16x32_bf16 v[200:203], v[56:59], v[36:39], v[200:203]
ds_read_b64_tr_b16 v[116:117], v17 offset:24576
v_mfma_f32_16x16x32_bf16 v[168:171], v[56:59], v[32:35], v[168:171]
ds_read_b64_tr_b16 v[118:119], v17 offset:28672
v_mfma_f32_16x16x32_bf16 v[136:139], v[56:59], v[28:31], v[136:139]
ds_read_b64_tr_b16 v[120:121], v18 offset:24576
v_mfma_f32_16x16x32_bf16 v[140:143], v[60:63], v[28:31], v[140:143]
ds_read_b64_tr_b16 v[122:123], v18 offset:28672
v_mfma_f32_16x16x32_bf16 v[172:175], v[60:63], v[32:35], v[172:175]
ds_read_b128 v[80:83], v9 offset:58368
v_mfma_f32_16x16x32_bf16 v[204:207], v[60:63], v[36:39], v[204:207]
ds_read_b128 v[84:87], v9 offset:59392
v_mfma_f32_16x16x32_bf16 v[236:239], v[60:63], v[40:43], v[236:239]
ds_read_b128 v[88:91], v9 offset:60416
v_mfma_f32_16x16x32_bf16 v[240:243], v[64:67], v[40:43], v[240:243]
v_mfma_f32_16x16x32_bf16 v[208:211], v[64:67], v[36:39], v[208:211]
v_mfma_f32_16x16x32_bf16 v[176:179], v[64:67], v[32:35], v[176:179]
v_mfma_f32_16x16x32_bf16 v[144:147], v[64:67], v[28:31], v[144:147]
v_mfma_f32_16x16x32_bf16 v[148:151], v[68:71], v[28:31], v[148:151]
v_mfma_f32_16x16x32_bf16 v[180:183], v[68:71], v[32:35], v[180:183]
v_mfma_f32_16x16x32_bf16 v[212:215], v[68:71], v[36:39], v[212:215]
v_mfma_f32_16x16x32_bf16 v[244:247], v[68:71], v[40:43], v[244:247]
v_mfma_f32_16x16x32_bf16 v[248:251], v[72:75], v[40:43], v[248:251]
v_mfma_f32_16x16x32_bf16 v[216:219], v[72:75], v[36:39], v[216:219]
v_mfma_f32_16x16x32_bf16 v[184:187], v[72:75], v[32:35], v[184:187]
v_mfma_f32_16x16x32_bf16 v[152:155], v[72:75], v[28:31], v[152:155]
s_waitcnt lgkmcnt(0)
s_barrier
v_mfma_f32_16x16x32_bf16 v[124:127], v[92:95], v[76:79], v[124:127]
ds_read_b128 v[28:31], v10 offset:0
v_mfma_f32_16x16x32_bf16 v[156:159], v[92:95], v[80:83], v[156:159]
ds_read_b64_tr_b16 v[44:45], v19 offset:0
v_mfma_f32_16x16x32_bf16 v[188:191], v[92:95], v[84:87], v[188:191]
ds_read_b64_tr_b16 v[46:47], v19 offset:4096
v_mfma_f32_16x16x32_bf16 v[220:223], v[92:95], v[88:91], v[220:223]
ds_read_b64_tr_b16 v[48:49], v20 offset:0
v_mfma_f32_16x16x32_bf16 v[224:227], v[96:99], v[88:91], v[224:227]
ds_read_b64_tr_b16 v[50:51], v20 offset:4096
v_mfma_f32_16x16x32_bf16 v[192:195], v[96:99], v[84:87], v[192:195]
ds_read_b64_tr_b16 v[52:53], v21 offset:0
v_mfma_f32_16x16x32_bf16 v[160:163], v[96:99], v[80:83], v[160:163]
ds_read_b64_tr_b16 v[54:55], v21 offset:4096
v_mfma_f32_16x16x32_bf16 v[128:131], v[96:99], v[76:79], v[128:131]
ds_read_b64_tr_b16 v[56:57], v22 offset:0
v_mfma_f32_16x16x32_bf16 v[132:135], v[100:103], v[76:79], v[132:135]
ds_read_b64_tr_b16 v[58:59], v22 offset:4096
v_mfma_f32_16x16x32_bf16 v[164:167], v[100:103], v[80:83], v[164:167]
ds_read_b64_tr_b16 v[60:61], v19 offset:16384
v_mfma_f32_16x16x32_bf16 v[196:199], v[100:103], v[84:87], v[196:199]
ds_read_b64_tr_b16 v[62:63], v19 offset:20480
v_mfma_f32_16x16x32_bf16 v[228:231], v[100:103], v[88:91], v[228:231]
ds_read_b64_tr_b16 v[64:65], v20 offset:16384
v_mfma_f32_16x16x32_bf16 v[232:235], v[104:107], v[88:91], v[232:235]
ds_read_b64_tr_b16 v[66:67], v20 offset:20480
v_mfma_f32_16x16x32_bf16 v[200:203], v[104:107], v[84:87], v[200:203]
ds_read_b64_tr_b16 v[68:69], v21 offset:16384
v_mfma_f32_16x16x32_bf16 v[168:171], v[104:107], v[80:83], v[168:171]
ds_read_b64_tr_b16 v[70:71], v21 offset:20480
v_mfma_f32_16x16x32_bf16 v[136:139], v[104:107], v[76:79], v[136:139]
ds_read_b64_tr_b16 v[72:73], v22 offset:16384
v_mfma_f32_16x16x32_bf16 v[140:143], v[108:111], v[76:79], v[140:143]
ds_read_b64_tr_b16 v[74:75], v22 offset:20480
v_mfma_f32_16x16x32_bf16 v[172:175], v[108:111], v[80:83], v[172:175]
ds_read_b128 v[32:35], v10 offset:1024
v_mfma_f32_16x16x32_bf16 v[204:207], v[108:111], v[84:87], v[204:207]
ds_read_b128 v[36:39], v10 offset:2048
v_mfma_f32_16x16x32_bf16 v[236:239], v[108:111], v[88:91], v[236:239]
ds_read_b128 v[40:43], v10 offset:3072
v_mfma_f32_16x16x32_bf16 v[240:243], v[112:115], v[88:91], v[240:243]
v_mfma_f32_16x16x32_bf16 v[208:211], v[112:115], v[84:87], v[208:211]
v_mfma_f32_16x16x32_bf16 v[176:179], v[112:115], v[80:83], v[176:179]
v_mfma_f32_16x16x32_bf16 v[144:147], v[112:115], v[76:79], v[144:147]
v_mfma_f32_16x16x32_bf16 v[148:151], v[116:119], v[76:79], v[148:151]
v_mfma_f32_16x16x32_bf16 v[180:183], v[116:119], v[80:83], v[180:183]
v_mfma_f32_16x16x32_bf16 v[212:215], v[116:119], v[84:87], v[212:215]
v_mfma_f32_16x16x32_bf16 v[244:247], v[116:119], v[88:91], v[244:247]
v_mfma_f32_16x16x32_bf16 v[248:251], v[120:123], v[88:91], v[248:251]
v_mfma_f32_16x16x32_bf16 v[216:219], v[120:123], v[84:87], v[216:219]
v_mfma_f32_16x16x32_bf16 v[184:187], v[120:123], v[80:83], v[184:187]
v_mfma_f32_16x16x32_bf16 v[152:155], v[120:123], v[76:79], v[152:155]
s_sub_u32 s41, s41, 1
s_cmp_lg_u32 s41, 0
s_cbranch_scc1 Lk3l_132
s_waitcnt lgkmcnt(0)
s_barrier
v_lshrrev_b32 v84, 4, v1
s_lshl_b32 s43, s63, 8
s_add_u32 s43, s43, 148480
v_lshl_add_u32 v85, v84, 4, s43
v_and_b32 v84, 15, v1
s_lshl_b32 s43, s62, 9
s_add_u32 s43, s43, 147456
v_lshl_add_u32 v84, v84, 3, s43
ds_read_b128 v[28:31], v85 offset:0
ds_read_b128 v[32:35], v85 offset:64
ds_read_b128 v[36:39], v85 offset:128
ds_read_b128 v[40:43], v85 offset:192
ds_read_b128 v[44:47], v85 offset:896
ds_read_b128 v[48:51], v85 offset:960
ds_read_b128 v[52:55], v85 offset:1024
ds_read_b128 v[56:59], v85 offset:1088
ds_read_b64 v[60:61], v84 offset:0
ds_read_b64 v[62:63], v84 offset:128
ds_read_b64 v[64:65], v84 offset:256
ds_read_b64 v[66:67], v84 offset:384
s_lshl_b32 s54, s35, 15
s_lshl_b32 s43, s63, 14
s_add_u32 s54, s54, s43
s_lshl_b32 s43, s62, 12
s_add_u32 s54, s54, s43
s_add_u32 s55, s54, 8192
v_lshrrev_b32 v122, 3, v1
v_and_b32 v123, 6, v122
v_and_b32 v25, 7, v1
v_xor_b32 v25, v25, v123
v_lshlrev_b32 v25, 4, v25
v_mul_u32_u24 v122, 2048, v122
v_add_u32 v25, v25, v122
s_lshl_b32 s43, s61, 7
s_lshl_b32 s44, s47, 15
s_add_u32 s43, s43, s44
v_add_u32 v25, s43, v25
s_waitcnt lgkmcnt(0)
s_add_u32 s37, s52, 589824
s_add_u32 m0, s39, 81920
s_nop 0
buffer_load_dwordx4 v3, s[24:27], s37 offen sc1 lds
v_mul_f32 v70, v61, v61
v_mul_f32 v68, 0xc0135761, v61
v_mul_f32 v69, 0xbdd2d3e8, v61
v_mul_f32 v69, v69, v70
v_rcp_f32 v70, v70
v_mul_f32 v74, v63, v63
v_mul_f32 v72, 0xc0135761, v63
v_mul_f32 v73, 0xbdd2d3e8, v63
v_mul_f32 v73, v73, v74
v_rcp_f32 v74, v74
v_fma_f32 v124, -v60, v28, v124
v_fma_f32 v125, -v60, v29, v125
v_fma_f32 v126, -v60, v30, v126
v_fma_f32 v127, -v60, v31, v127
buffer_load_dwordx4 v3, s[24:27], s37 offen offset:1024 sc1 lds
v_fma_f32 v156, -v62, v28, v156
v_fma_f32 v157, -v62, v29, v157
v_fma_f32 v158, -v62, v30, v158
v_fma_f32 v159, -v62, v31, v159
v_mul_f32 v76, v124, v124
v_mul_f32 v77, v125, v125
v_mul_f32 v78, v126, v126
v_mul_f32 v79, v127, v127
v_mul_f32 v80, v156, v156
v_mul_f32 v81, v157, v157
v_mul_f32 v82, v158, v158
v_mul_f32 v83, v159, v159
v_fma_f32 v76, v76, v69, v68
v_fma_f32 v77, v77, v69, v68
buffer_load_dwordx4 v3, s[24:27], s37 offen offset:2048 sc1 lds
v_fma_f32 v78, v78, v69, v68
v_fma_f32 v79, v79, v69, v68
v_fma_f32 v80, v80, v73, v72
v_fma_f32 v81, v81, v73, v72
v_fma_f32 v82, v82, v73, v72
v_fma_f32 v83, v83, v73, v72
v_mul_f32 v76, v76, v124
v_mul_f32 v77, v77, v125
v_mul_f32 v78, v78, v126
v_mul_f32 v79, v79, v127
v_mul_f32 v80, v80, v156
v_mul_f32 v81, v81, v157
v_mul_f32 v82, v82, v158
v_mul_f32 v83, v83, v159
buffer_load_dwordx4 v3, s[24:27], s37 offen offset:3072 sc1 lds
v_exp_f32 v76, v76
v_exp_f32 v77, v77
v_exp_f32 v78, v78
v_exp_f32 v79, v79
v_exp_f32 v80, v80
v_exp_f32 v81, v81
v_exp_f32 v82, v82
v_exp_f32 v83, v83
v_fma_f32 v140, -v60, v44, v140
v_fma_f32 v141, -v60, v45, v141
s_branch Lov_16
.p2align 12
.fill 128, 4, 0xbf800000
Lst_16_0:
s_branch Lwr_169
s_nop 0
s_nop 0
Lov_16:
v_fma_f32 v142, -v60, v46, v142
v_fma_f32 v143, -v60, v47, v143
v_fma_f32 v172, -v62, v44, v172
v_fma_f32 v173, -v62, v45, v173
s_add_u32 s37, s52, 606208
s_add_u32 m0, s39, 98304
s_nop 0
buffer_load_dwordx4 v3, s[24:27], s37 offen sc1 lds
v_fma_f32 v174, -v62, v46, v174
v_fma_f32 v175, -v62, v47, v175
v_fma_f32 v76, v76, v70, v70
v_fma_f32 v77, v77, v70, v70
v_fma_f32 v78, v78, v70, v70
v_fma_f32 v79, v79, v70, v70
v_fma_f32 v80, v80, v74, v74
v_fma_f32 v81, v81, v74, v74
v_fma_f32 v82, v82, v74, v74
v_fma_f32 v83, v83, v74, v74
v_rcp_f32 v76, v76
v_rcp_f32 v77, v77
v_rcp_f32 v78, v78
v_rcp_f32 v79, v79
buffer_load_dwordx4 v3, s[24:27], s37 offen offset:1024 sc1 lds
v_rcp_f32 v80, v80
v_rcp_f32 v81, v81
v_rcp_f32 v82, v82
v_rcp_f32 v83, v83
v_mul_f32 v140, v124, v140
v_mul_f32 v141, v125, v141
v_mul_f32 v142, v126, v142
v_mul_f32 v143, v127, v143
v_mul_f32 v172, v156, v172
v_mul_f32 v173, v157, v173
v_mul_f32 v174, v158, v174
v_mul_f32 v175, v159, v175
v_mul_f32 v140, v140, v76
v_mul_f32 v141, v141, v77
buffer_load_dwordx4 v3, s[24:27], s37 offen offset:2048 sc1 lds
v_mul_f32 v142, v142, v78
v_mul_f32 v143, v143, v79
v_mul_f32 v172, v172, v80
v_mul_f32 v173, v173, v81
v_mul_f32 v174, v174, v82
v_mul_f32 v175, v175, v83
v_cvt_pk_bf16_f32 v124, v140, v141
v_cvt_pk_bf16_f32 v125, v142, v143
v_cvt_pk_bf16_f32 v156, v172, v173
v_cvt_pk_bf16_f32 v157, v174, v175
v_fma_f32 v128, -v60, v32, v128
v_fma_f32 v129, -v60, v33, v129
v_fma_f32 v130, -v60, v34, v130
v_fma_f32 v131, -v60, v35, v131
buffer_load_dwordx4 v3, s[24:27], s37 offen offset:3072 sc1 lds
v_fma_f32 v160, -v62, v32, v160
v_fma_f32 v161, -v62, v33, v161
v_fma_f32 v162, -v62, v34, v162
v_fma_f32 v163, -v62, v35, v163
v_mul_f32 v76, v128, v128
v_mul_f32 v77, v129, v129
v_mul_f32 v78, v130, v130
v_mul_f32 v79, v131, v131
v_mul_f32 v80, v160, v160
v_mul_f32 v81, v161, v161
v_mul_f32 v82, v162, v162
v_mul_f32 v83, v163, v163
v_fma_f32 v76, v76, v69, v68
v_fma_f32 v77, v77, v69, v68
s_add_u32 s38, s53, 4849664
s_add_u32 m0, s39, 114688
s_nop 0
buffer_load_dwordx4 v23, s[28:31], s38 offen lds
v_fma_f32 v78, v78, v69, v68
v_fma_f32 v79, v79, v69, v68
v_fma_f32 v80, v80, v73, v72
v_fma_f32 v81, v81, v73, v72
v_fma_f32 v82, v82, v73, v72
v_fma_f32 v83, v83, v73, v72
v_mul_f32 v76, v76, v128
v_mul_f32 v77, v77, v129
v_mul_f32 v78, v78, v130
v_mul_f32 v79, v79, v131
v_mul_f32 v80, v80, v160
v_mul_f32 v81, v81, v161
v_mul_f32 v82, v82, v162
v_mul_f32 v83, v83, v163
s_add_u32 m0, s39, 115712
s_nop 0
buffer_load_dwordx4 v24, s[28:31], s38 offen lds
v_exp_f32 v76, v76
v_exp_f32 v77, v77
v_exp_f32 v78, v78
v_exp_f32 v79, v79
v_exp_f32 v80, v80
v_exp_f32 v81, v81
v_exp_f32 v82, v82
v_exp_f32 v83, v83
v_fma_f32 v144, -v60, v48, v144
v_fma_f32 v145, -v60, v49, v145
v_fma_f32 v146, -v60, v50, v146
v_fma_f32 v147, -v60, v51, v147
v_fma_f32 v176, -v62, v48, v176
v_fma_f32 v177, -v62, v49, v177
s_add_u32 m0, s39, 116736
s_add_u32 s38, s38, 16384
buffer_load_dwordx4 v23, s[28:31], s38 offen lds
s_add_u32 m0, s39, 117760
s_nop 0
buffer_load_dwordx4 v24, s[28:31], s38 offen lds
s_barrier
s_add_u32 s38, s53, 4718592
s_add_u32 m0, s39, 147456
s_nop 0
buffer_load_dwordx4 v23, s[28:31], s38 offen lds
v_fma_f32 v178, -v62, v50, v178
v_fma_f32 v179, -v62, v51, v179
v_fma_f32 v76, v76, v70, v70
v_fma_f32 v77, v77, v70, v70
v_fma_f32 v78, v78, v70, v70
v_fma_f32 v79, v79, v70, v70
v_fma_f32 v80, v80, v74, v74
v_fma_f32 v81, v81, v74, v74
v_fma_f32 v82, v82, v74, v74
v_fma_f32 v83, v83, v74, v74
v_rcp_f32 v76, v76
v_rcp_f32 v77, v77
v_rcp_f32 v78, v78
v_rcp_f32 v79, v79
s_add_u32 m0, s39, 148480
s_nop 0
buffer_load_dwordx4 v24, s[28:31], s38 offen lds
v_rcp_f32 v80, v80
v_rcp_f32 v81, v81
v_rcp_f32 v82, v82
v_rcp_f32 v83, v83
v_mul_f32 v144, v128, v144
v_mul_f32 v145, v129, v145
v_mul_f32 v146, v130, v146
v_mul_f32 v147, v131, v147
v_mul_f32 v176, v160, v176
v_mul_f32 v177, v161, v177
v_mul_f32 v178, v162, v178
v_mul_f32 v179, v163, v179
v_mul_f32 v144, v144, v76
v_mul_f32 v145, v145, v77
s_add_u32 m0, s39, 149504
s_add_u32 s38, s38, 16384
buffer_load_dwordx4 v23, s[28:31], s38 offen lds
v_mul_f32 v146, v146, v78
v_mul_f32 v147, v147, v79
v_mul_f32 v176, v176, v80
v_mul_f32 v177, v177, v81
v_mul_f32 v178, v178, v82
v_mul_f32 v179, v179, v83
v_cvt_pk_bf16_f32 v126, v144, v145
v_cvt_pk_bf16_f32 v127, v146, v147
v_cvt_pk_bf16_f32 v158, v176, v177
v_cvt_pk_bf16_f32 v159, v178, v179
buffer_store_dwordx4 v[124:127], v2, s[24:27], s54 offen offset:0 sc1
buffer_store_dwordx4 v[156:159], v2, s[24:27], s54 offen offset:1024 sc1
v_fma_f32 v132, -v60, v36, v132
v_fma_f32 v133, -v60, v37, v133
s_add_u32 m0, s39, 150528
s_nop 0
buffer_load_dwordx4 v24, s[28:31], s38 offen lds
v_fma_f32 v134, -v60, v38, v134
v_fma_f32 v135, -v60, v39, v135
v_fma_f32 v164, -v62, v36, v164
v_fma_f32 v165, -v62, v37, v165
v_fma_f32 v166, -v62, v38, v166
v_fma_f32 v167, -v62, v39, v167
v_mul_f32 v76, v132, v132
v_mul_f32 v77, v133, v133
v_mul_f32 v78, v134, v134
v_mul_f32 v79, v135, v135
v_mul_f32 v80, v164, v164
v_mul_f32 v81, v165, v165
v_mul_f32 v82, v166, v166
v_mul_f32 v83, v167, v167
s_add_u32 s37, s52, 622592
s_add_u32 m0, s39, 131072
s_nop 0
buffer_load_dwordx4 v3, s[24:27], s37 offen sc1 lds
v_fma_f32 v76, v76, v69, v68
v_fma_f32 v77, v77, v69, v68
v_fma_f32 v78, v78, v69, v68
v_fma_f32 v79, v79, v69, v68
v_fma_f32 v80, v80, v73, v72
v_fma_f32 v81, v81, v73, v72
v_fma_f32 v82, v82, v73, v72
v_fma_f32 v83, v83, v73, v72
v_mul_f32 v76, v76, v132
v_mul_f32 v77, v77, v133
v_mul_f32 v78, v78, v134
v_mul_f32 v79, v79, v135
v_mul_f32 v80, v80, v164
v_mul_f32 v81, v81, v165
buffer_load_dwordx4 v3, s[24:27], s37 offen offset:1024 sc1 lds
v_mul_f32 v82, v82, v166
v_mul_f32 v83, v83, v167
v_exp_f32 v76, v76
v_exp_f32 v77, v77
v_exp_f32 v78, v78
v_exp_f32 v79, v79
v_exp_f32 v80, v80
v_exp_f32 v81, v81
v_exp_f32 v82, v82
v_exp_f32 v83, v83
v_fma_f32 v148, -v60, v52, v148
v_fma_f32 v149, -v60, v53, v149
v_fma_f32 v150, -v60, v54, v150
v_fma_f32 v151, -v60, v55, v151
buffer_load_dwordx4 v3, s[24:27], s37 offen offset:2048 sc1 lds
v_fma_f32 v180, -v62, v52, v180
v_fma_f32 v181, -v62, v53, v181
v_fma_f32 v182, -v62, v54, v182
v_fma_f32 v183, -v62, v55, v183
v_fma_f32 v76, v76, v70, v70
v_fma_f32 v77, v77, v70, v70
v_fma_f32 v78, v78, v70, v70
v_fma_f32 v79, v79, v70, v70
v_fma_f32 v80, v80, v74, v74
v_fma_f32 v81, v81, v74, v74
v_fma_f32 v82, v82, v74, v74
v_fma_f32 v83, v83, v74, v74
v_rcp_f32 v76, v76
v_rcp_f32 v77, v77
buffer_load_dwordx4 v3, s[24:27], s37 offen offset:3072 sc1 lds
v_rcp_f32 v78, v78
v_rcp_f32 v79, v79
v_rcp_f32 v80, v80
v_rcp_f32 v81, v81
v_rcp_f32 v82, v82
v_rcp_f32 v83, v83
v_mul_f32 v148, v132, v148
v_mul_f32 v149, v133, v149
v_mul_f32 v150, v134, v150
v_mul_f32 v151, v135, v151
v_mul_f32 v180, v164, v180
v_mul_f32 v181, v165, v181
v_mul_f32 v182, v166, v182
v_mul_f32 v183, v167, v183
s_add_u32 s38, s53, 4980736
s_add_u32 m0, s39, 0
s_nop 0
buffer_load_dwordx4 v23, s[28:31], s38 offen lds
v_mul_f32 v148, v148, v76
v_mul_f32 v149, v149, v77
v_mul_f32 v150, v150, v78
v_mul_f32 v151, v151, v79
v_mul_f32 v180, v180, v80
v_mul_f32 v181, v181, v81
v_mul_f32 v182, v182, v82
v_mul_f32 v183, v183, v83
v_cvt_pk_bf16_f32 v132, v148, v149
v_cvt_pk_bf16_f32 v133, v150, v151
v_cvt_pk_bf16_f32 v164, v180, v181
v_cvt_pk_bf16_f32 v165, v182, v183
v_fma_f32 v136, -v60, v40, v136
v_fma_f32 v137, -v60, v41, v137
s_add_u32 m0, s39, 1024
s_nop 0
buffer_load_dwordx4 v24, s[28:31], s38 offen lds
v_fma_f32 v138, -v60, v42, v138
v_fma_f32 v139, -v60, v43, v139
v_fma_f32 v168, -v62, v40, v168
v_fma_f32 v169, -v62, v41, v169
v_fma_f32 v170, -v62, v42, v170
v_fma_f32 v171, -v62, v43, v171
v_mul_f32 v76, v136, v136
v_mul_f32 v77, v137, v137
v_mul_f32 v78, v138, v138
v_mul_f32 v79, v139, v139
v_mul_f32 v80, v168, v168
v_mul_f32 v81, v169, v169
v_mul_f32 v82, v170, v170
v_mul_f32 v83, v171, v171
s_add_u32 m0, s39, 2048
s_add_u32 s38, s38, 16384
buffer_load_dwordx4 v23, s[28:31], s38 offen lds
s_add_u32 m0, s39, 3072
s_nop 0
buffer_load_dwordx4 v24, s[28:31], s38 offen lds
s_barrier
s_add_u32 s37, s52, 638976
s_add_u32 m0, s39, 16384
s_nop 0
buffer_load_dwordx4 v3, s[24:27], s37 offen sc1 lds
v_fma_f32 v76, v76, v69, v68
v_fma_f32 v77, v77, v69, v68
v_fma_f32 v78, v78, v69, v68
v_fma_f32 v79, v79, v69, v68
v_fma_f32 v80, v80, v73, v72
v_fma_f32 v81, v81, v73, v72
v_fma_f32 v82, v82, v73, v72
v_fma_f32 v83, v83, v73, v72
v_mul_f32 v76, v76, v136
v_mul_f32 v77, v77, v137
v_mul_f32 v78, v78, v138
v_mul_f32 v79, v79, v139
v_mul_f32 v80, v80, v168
v_mul_f32 v81, v81, v169
v_mul_f32 v82, v82, v170
v_mul_f32 v83, v83, v171
v_exp_f32 v76, v76
v_exp_f32 v77, v77
v_exp_f32 v78, v78
v_exp_f32 v79, v79
v_exp_f32 v80, v80
v_exp_f32 v81, v81
v_exp_f32 v82, v82
buffer_load_dwordx4 v3, s[24:27], s37 offen offset:1024 sc1 lds
v_exp_f32 v83, v83
v_fma_f32 v152, -v60, v56, v152
v_fma_f32 v153, -v60, v57, v153
v_fma_f32 v154, -v60, v58, v154
v_fma_f32 v155, -v60, v59, v155
v_fma_f32 v184, -v62, v56, v184
v_fma_f32 v185, -v62, v57, v185
v_fma_f32 v186, -v62, v58, v186
v_fma_f32 v187, -v62, v59, v187
v_fma_f32 v76, v76, v70, v70
v_fma_f32 v77, v77, v70, v70
v_fma_f32 v78, v78, v70, v70
v_fma_f32 v79, v79, v70, v70
v_fma_f32 v80, v80, v74, v74
v_fma_f32 v81, v81, v74, v74
v_fma_f32 v82, v82, v74, v74
v_fma_f32 v83, v83, v74, v74
v_rcp_f32 v76, v76
v_rcp_f32 v77, v77
v_rcp_f32 v78, v78
v_rcp_f32 v79, v79
v_rcp_f32 v80, v80
v_rcp_f32 v81, v81
buffer_load_dwordx4 v3, s[24:27], s37 offen offset:2048 sc1 lds
v_rcp_f32 v82, v82
v_rcp_f32 v83, v83
v_mul_f32 v152, v136, v152
v_mul_f32 v153, v137, v153
v_mul_f32 v154, v138, v154
v_mul_f32 v155, v139, v155
v_mul_f32 v184, v168, v184
v_mul_f32 v185, v169, v185
v_mul_f32 v186, v170, v186
v_mul_f32 v187, v171, v187
v_mul_f32 v152, v152, v76
v_mul_f32 v153, v153, v77
v_mul_f32 v154, v154, v78
v_mul_f32 v155, v155, v79
v_mul_f32 v184, v184, v80
v_mul_f32 v185, v185, v81
v_mul_f32 v186, v186, v82
v_mul_f32 v187, v187, v83
v_cvt_pk_bf16_f32 v134, v152, v153
v_cvt_pk_bf16_f32 v135, v154, v155
v_cvt_pk_bf16_f32 v166, v184, v185
v_cvt_pk_bf16_f32 v167, v186, v187
buffer_store_dwordx4 v[132:135], v2, s[24:27], s55 offen offset:0 sc1
buffer_store_dwordx4 v[164:167], v2, s[24:27], s55 offen offset:1024 sc1
buffer_load_dwordx4 v3, s[24:27], s37 offen offset:3072 sc1 lds
v_mul_f32 v70, v65, v65
v_mul_f32 v68, 0xc0135761, v65
v_mul_f32 v69, 0xbdd2d3e8, v65
v_mul_f32 v69, v69, v70
v_rcp_f32 v70, v70
v_mul_f32 v74, v67, v67
v_mul_f32 v72, 0xc0135761, v67
v_mul_f32 v73, 0xbdd2d3e8, v67
v_mul_f32 v73, v73, v74
v_rcp_f32 v74, v74
v_fma_f32 v188, -v64, v28, v188
v_fma_f32 v189, -v64, v29, v189
v_fma_f32 v190, -v64, v30, v190
v_fma_f32 v191, -v64, v31, v191
v_fma_f32 v220, -v66, v28, v220
v_fma_f32 v221, -v66, v29, v221
v_fma_f32 v222, -v66, v30, v222
v_fma_f32 v223, -v66, v31, v223
v_mul_f32 v76, v188, v188
v_mul_f32 v77, v189, v189
v_mul_f32 v78, v190, v190
v_mul_f32 v79, v191, v191
v_mul_f32 v80, v220, v220
s_add_u32 s38, s53, 5111808
s_add_u32 m0, s39, 32768
s_nop 0
buffer_load_dwordx4 v23, s[28:31], s38 offen lds
v_mul_f32 v81, v221, v221
v_mul_f32 v82, v222, v222
v_mul_f32 v83, v223, v223
v_fma_f32 v76, v76, v69, v68
v_fma_f32 v77, v77, v69, v68
v_fma_f32 v78, v78, v69, v68
v_fma_f32 v79, v79, v69, v68
v_fma_f32 v80, v80, v73, v72
v_fma_f32 v81, v81, v73, v72
v_fma_f32 v82, v82, v73, v72
v_fma_f32 v83, v83, v73, v72
v_mul_f32 v76, v76, v188
v_mul_f32 v77, v77, v189
v_mul_f32 v78, v78, v190
v_mul_f32 v79, v79, v191
v_mul_f32 v80, v80, v220
v_mul_f32 v81, v81, v221
v_mul_f32 v82, v82, v222
v_mul_f32 v83, v83, v223
v_exp_f32 v76, v76
v_exp_f32 v77, v77
v_exp_f32 v78, v78
v_exp_f32 v79, v79
s_add_u32 m0, s39, 33792
s_nop 0
buffer_load_dwordx4 v24, s[28:31], s38 offen lds
v_exp_f32 v80, v80
v_exp_f32 v81, v81
v_exp_f32 v82, v82
v_exp_f32 v83, v83
v_fma_f32 v204, -v64, v44, v204
v_fma_f32 v205, -v64, v45, v205
v_fma_f32 v206, -v64, v46, v206
v_fma_f32 v207, -v64, v47, v207
v_fma_f32 v236, -v66, v44, v236
v_fma_f32 v237, -v66, v45, v237
v_fma_f32 v238, -v66, v46, v238
v_fma_f32 v239, -v66, v47, v239
v_fma_f32 v76, v76, v70, v70
v_fma_f32 v77, v77, v70, v70
v_fma_f32 v78, v78, v70, v70
v_fma_f32 v79, v79, v70, v70
v_fma_f32 v80, v80, v74, v74
v_fma_f32 v81, v81, v74, v74
v_fma_f32 v82, v82, v74, v74
v_fma_f32 v83, v83, v74, v74
v_rcp_f32 v76, v76
v_rcp_f32 v77, v77
v_rcp_f32 v78, v78
v_rcp_f32 v79, v79
s_add_u32 m0, s39, 34816
s_add_u32 s38, s38, 16384
buffer_load_dwordx4 v23, s[28:31], s38 offen lds
s_add_u32 m0, s39, 35840
s_nop 0
buffer_load_dwordx4 v24, s[28:31], s38 offen lds
s_waitcnt vmcnt(18)
s_barrier
s_add_u32 s37, s52, 655360
s_add_u32 m0, s39, 49152
s_nop 0
buffer_load_dwordx4 v3, s[24:27], s37 offen sc1 lds
v_rcp_f32 v80, v80
v_rcp_f32 v81, v81
v_rcp_f32 v82, v82
v_rcp_f32 v83, v83
v_mul_f32 v204, v188, v204
v_mul_f32 v205, v189, v205
v_mul_f32 v206, v190, v206
v_mul_f32 v207, v191, v207
v_mul_f32 v236, v220, v236
v_mul_f32 v237, v221, v237
v_mul_f32 v238, v222, v238
v_mul_f32 v239, v223, v239
v_mul_f32 v204, v204, v76
v_mul_f32 v205, v205, v77
v_mul_f32 v206, v206, v78
v_mul_f32 v207, v207, v79
v_mul_f32 v236, v236, v80
v_mul_f32 v237, v237, v81
v_mul_f32 v238, v238, v82
v_mul_f32 v239, v239, v83
v_cvt_pk_bf16_f32 v188, v204, v205
v_cvt_pk_bf16_f32 v189, v206, v207
v_cvt_pk_bf16_f32 v220, v236, v237
buffer_load_dwordx4 v3, s[24:27], s37 offen offset:1024 sc1 lds
v_cvt_pk_bf16_f32 v221, v238, v239
v_fma_f32 v192, -v64, v32, v192
v_fma_f32 v193, -v64, v33, v193
v_fma_f32 v194, -v64, v34, v194
v_fma_f32 v195, -v64, v35, v195
v_fma_f32 v224, -v66, v32, v224
v_fma_f32 v225, -v66, v33, v225
v_fma_f32 v226, -v66, v34, v226
v_fma_f32 v227, -v66, v35, v227
v_mul_f32 v76, v192, v192
v_mul_f32 v77, v193, v193
v_mul_f32 v78, v194, v194
v_mul_f32 v79, v195, v195
v_mul_f32 v80, v224, v224
v_mul_f32 v81, v225, v225
v_mul_f32 v82, v226, v226
v_mul_f32 v83, v227, v227
v_fma_f32 v76, v76, v69, v68
v_fma_f32 v77, v77, v69, v68
v_fma_f32 v78, v78, v69, v68
v_fma_f32 v79, v79, v69, v68
v_fma_f32 v80, v80, v73, v72
v_fma_f32 v81, v81, v73, v72
buffer_load_dwordx4 v3, s[24:27], s37 offen offset:2048 sc1 lds
v_fma_f32 v82, v82, v73, v72
v_fma_f32 v83, v83, v73, v72
v_mul_f32 v76, v76, v192
v_mul_f32 v77, v77, v193
v_mul_f32 v78, v78, v194
v_mul_f32 v79, v79, v195
v_mul_f32 v80, v80, v224
v_mul_f32 v81, v81, v225
v_mul_f32 v82, v82, v226
v_mul_f32 v83, v83, v227
v_exp_f32 v76, v76
v_exp_f32 v77, v77
v_exp_f32 v78, v78
v_exp_f32 v79, v79
v_exp_f32 v80, v80
v_exp_f32 v81, v81
v_exp_f32 v82, v82
v_exp_f32 v83, v83
v_fma_f32 v208, -v64, v48, v208
v_fma_f32 v209, -v64, v49, v209
v_fma_f32 v210, -v64, v50, v210
v_fma_f32 v211, -v64, v51, v211
v_fma_f32 v240, -v66, v48, v240
v_fma_f32 v241, -v66, v49, v241
buffer_load_dwordx4 v3, s[24:27], s37 offen offset:3072 sc1 lds
v_fma_f32 v242, -v66, v50, v242
v_fma_f32 v243, -v66, v51, v243
v_fma_f32 v76, v76, v70, v70
v_fma_f32 v77, v77, v70, v70
v_fma_f32 v78, v78, v70, v70
v_fma_f32 v79, v79, v70, v70
v_fma_f32 v80, v80, v74, v74
v_fma_f32 v81, v81, v74, v74
v_fma_f32 v82, v82, v74, v74
v_fma_f32 v83, v83, v74, v74
v_rcp_f32 v76, v76
v_rcp_f32 v77, v77
v_rcp_f32 v78, v78
v_rcp_f32 v79, v79
v_rcp_f32 v80, v80
v_rcp_f32 v81, v81
v_rcp_f32 v82, v82
v_rcp_f32 v83, v83
v_mul_f32 v208, v192, v208
v_mul_f32 v209, v193, v209
v_mul_f32 v210, v194, v210
v_mul_f32 v211, v195, v211
v_mul_f32 v240, v224, v240
s_add_u32 s38, s53, 5242880
s_add_u32 m0, s39, 65536
s_nop 0
buffer_load_dwordx4 v23, s[28:31], s38 offen lds
v_mul_f32 v241, v225, v241
v_mul_f32 v242, v226, v242
v_mul_f32 v243, v227, v243
v_mul_f32 v208, v208, v76
v_mul_f32 v209, v209, v77
v_mul_f32 v210, v210, v78
v_mul_f32 v211, v211, v79
v_mul_f32 v240, v240, v80
v_mul_f32 v241, v241, v81
v_mul_f32 v242, v242, v82
v_mul_f32 v243, v243, v83
v_cvt_pk_bf16_f32 v190, v208, v209
v_cvt_pk_bf16_f32 v191, v210, v211
v_cvt_pk_bf16_f32 v222, v240, v241
v_cvt_pk_bf16_f32 v223, v242, v243
buffer_store_dwordx4 v[188:191], v2, s[24:27], s54 offen offset:2048 sc1
buffer_store_dwordx4 v[220:223], v2, s[24:27], s54 offen offset:3072 sc1
v_fma_f32 v196, -v64, v36, v196
v_fma_f32 v197, -v64, v37, v197
v_fma_f32 v198, -v64, v38, v198
v_fma_f32 v199, -v64, v39, v199
v_fma_f32 v228, -v66, v36, v228
v_fma_f32 v229, -v66, v37, v229
s_add_u32 m0, s39, 66560
s_nop 0
buffer_load_dwordx4 v24, s[28:31], s38 offen lds
v_fma_f32 v230, -v66, v38, v230
v_fma_f32 v231, -v66, v39, v231
v_mul_f32 v76, v196, v196
v_mul_f32 v77, v197, v197
v_mul_f32 v78, v198, v198
v_mul_f32 v79, v199, v199
v_mul_f32 v80, v228, v228
v_mul_f32 v81, v229, v229
v_mul_f32 v82, v230, v230
v_mul_f32 v83, v231, v231
v_fma_f32 v76, v76, v69, v68
v_fma_f32 v77, v77, v69, v68
v_fma_f32 v78, v78, v69, v68
v_fma_f32 v79, v79, v69, v68
v_fma_f32 v80, v80, v73, v72
v_fma_f32 v81, v81, v73, v72
v_fma_f32 v82, v82, v73, v72
v_fma_f32 v83, v83, v73, v72
v_mul_f32 v76, v76, v196
v_mul_f32 v77, v77, v197
v_mul_f32 v78, v78, v198
v_mul_f32 v79, v79, v199
v_mul_f32 v80, v80, v228
v_mul_f32 v81, v81, v229
s_branch Lov_17
.p2align 12
.fill 128, 4, 0xbf800000
Lst_17_0:
s_branch Lwr_170
s_nop 0
s_nop 0
Lov_17:
s_add_u32 m0, s39, 67584
s_add_u32 s38, s38, 16384
buffer_load_dwordx4 v23, s[28:31], s38 offen lds
s_add_u32 m0, s39, 68608
s_nop 0
buffer_load_dwordx4 v24, s[28:31], s38 offen lds
s_waitcnt vmcnt(34)
s_barrier
s_add_u32 s37, s52, 671744
s_add_u32 m0, s39, 81920
s_nop 0
buffer_load_dwordx4 v3, s[24:27], s37 offen sc1 lds
v_mul_f32 v82, v82, v230
v_mul_f32 v83, v83, v231
v_exp_f32 v76, v76
v_exp_f32 v77, v77
v_exp_f32 v78, v78
v_exp_f32 v79, v79
v_exp_f32 v80, v80
v_exp_f32 v81, v81
v_exp_f32 v82, v82
v_exp_f32 v83, v83
v_fma_f32 v212, -v64, v52, v212
v_fma_f32 v213, -v64, v53, v213
v_fma_f32 v214, -v64, v54, v214
v_fma_f32 v215, -v64, v55, v215
v_fma_f32 v244, -v66, v52, v244
v_fma_f32 v245, -v66, v53, v245
v_fma_f32 v246, -v66, v54, v246
v_fma_f32 v247, -v66, v55, v247
v_fma_f32 v76, v76, v70, v70
v_fma_f32 v77, v77, v70, v70
v_fma_f32 v78, v78, v70, v70
v_fma_f32 v79, v79, v70, v70
v_fma_f32 v80, v80, v74, v74
buffer_load_dwordx4 v3, s[24:27], s37 offen offset:1024 sc1 lds
v_fma_f32 v81, v81, v74, v74
v_fma_f32 v82, v82, v74, v74
v_fma_f32 v83, v83, v74, v74
v_rcp_f32 v76, v76
v_rcp_f32 v77, v77
v_rcp_f32 v78, v78
v_rcp_f32 v79, v79
v_rcp_f32 v80, v80
v_rcp_f32 v81, v81
v_rcp_f32 v82, v82
v_rcp_f32 v83, v83
v_mul_f32 v212, v196, v212
v_mul_f32 v213, v197, v213
v_mul_f32 v214, v198, v214
v_mul_f32 v215, v199, v215
v_mul_f32 v244, v228, v244
v_mul_f32 v245, v229, v245
v_mul_f32 v246, v230, v246
v_mul_f32 v247, v231, v247
v_mul_f32 v212, v212, v76
v_mul_f32 v213, v213, v77
v_mul_f32 v214, v214, v78
v_mul_f32 v215, v215, v79
buffer_load_dwordx4 v3, s[24:27], s37 offen offset:2048 sc1 lds
v_mul_f32 v244, v244, v80
v_mul_f32 v245, v245, v81
v_mul_f32 v246, v246, v82
v_mul_f32 v247, v247, v83
v_cvt_pk_bf16_f32 v196, v212, v213
v_cvt_pk_bf16_f32 v197, v214, v215
v_cvt_pk_bf16_f32 v228, v244, v245
v_cvt_pk_bf16_f32 v229, v246, v247
v_fma_f32 v200, -v64, v40, v200
v_fma_f32 v201, -v64, v41, v201
v_fma_f32 v202, -v64, v42, v202
v_fma_f32 v203, -v64, v43, v203
v_fma_f32 v232, -v66, v40, v232
v_fma_f32 v233, -v66, v41, v233
v_fma_f32 v234, -v66, v42, v234
v_fma_f32 v235, -v66, v43, v235
v_mul_f32 v76, v200, v200
v_mul_f32 v77, v201, v201
v_mul_f32 v78, v202, v202
v_mul_f32 v79, v203, v203
v_mul_f32 v80, v232, v232
v_mul_f32 v81, v233, v233
v_mul_f32 v82, v234, v234
v_mul_f32 v83, v235, v235
buffer_load_dwordx4 v3, s[24:27], s37 offen offset:3072 sc1 lds
v_fma_f32 v76, v76, v69, v68
v_fma_f32 v77, v77, v69, v68
v_fma_f32 v78, v78, v69, v68
v_fma_f32 v79, v79, v69, v68
v_fma_f32 v80, v80, v73, v72
v_fma_f32 v81, v81, v73, v72
v_fma_f32 v82, v82, v73, v72
v_fma_f32 v83, v83, v73, v72
v_mul_f32 v76, v76, v200
v_mul_f32 v77, v77, v201
v_mul_f32 v78, v78, v202
v_mul_f32 v79, v79, v203
v_mul_f32 v80, v80, v232
v_mul_f32 v81, v81, v233
v_mul_f32 v82, v82, v234
v_mul_f32 v83, v83, v235
v_exp_f32 v76, v76
v_exp_f32 v77, v77
v_exp_f32 v78, v78
v_exp_f32 v79, v79
v_exp_f32 v80, v80
v_exp_f32 v81, v81
v_exp_f32 v82, v82
s_add_u32 s38, s53, 5373952
s_add_u32 m0, s39, 147456
s_nop 0
buffer_load_dwordx4 v23, s[28:31], s38 offen lds
v_exp_f32 v83, v83
v_fma_f32 v216, -v64, v56, v216
v_fma_f32 v217, -v64, v57, v217
v_fma_f32 v218, -v64, v58, v218
v_fma_f32 v219, -v64, v59, v219
v_fma_f32 v248, -v66, v56, v248
v_fma_f32 v249, -v66, v57, v249
v_fma_f32 v250, -v66, v58, v250
v_fma_f32 v251, -v66, v59, v251
v_fma_f32 v76, v76, v70, v70
v_fma_f32 v77, v77, v70, v70
v_fma_f32 v78, v78, v70, v70
v_fma_f32 v79, v79, v70, v70
v_fma_f32 v80, v80, v74, v74
v_fma_f32 v81, v81, v74, v74
v_fma_f32 v82, v82, v74, v74
v_fma_f32 v83, v83, v74, v74
v_rcp_f32 v76, v76
v_rcp_f32 v77, v77
v_rcp_f32 v78, v78
v_rcp_f32 v79, v79
v_rcp_f32 v80, v80
v_rcp_f32 v81, v81
s_add_u32 m0, s39, 148480
s_nop 0
buffer_load_dwordx4 v24, s[28:31], s38 offen lds
v_rcp_f32 v82, v82
v_rcp_f32 v83, v83
v_mul_f32 v216, v200, v216
v_mul_f32 v217, v201, v217
v_mul_f32 v218, v202, v218
v_mul_f32 v219, v203, v219
v_mul_f32 v248, v232, v248
v_mul_f32 v249, v233, v249
v_mul_f32 v250, v234, v250
v_mul_f32 v251, v235, v251
v_mul_f32 v216, v216, v76
v_mul_f32 v217, v217, v77
v_mul_f32 v218, v218, v78
v_mul_f32 v219, v219, v79
v_mul_f32 v248, v248, v80
v_mul_f32 v249, v249, v81
v_mul_f32 v250, v250, v82
v_mul_f32 v251, v251, v83
v_cvt_pk_bf16_f32 v198, v216, v217
v_cvt_pk_bf16_f32 v199, v218, v219
v_cvt_pk_bf16_f32 v230, v248, v249
v_cvt_pk_bf16_f32 v231, v250, v251
buffer_store_dwordx4 v[196:199], v2, s[24:27], s55 offen offset:2048 sc1
buffer_store_dwordx4 v[228:231], v2, s[24:27], s55 offen offset:3072 sc1
s_add_u32 m0, s39, 149504
s_add_u32 s38, s38, 16384
buffer_load_dwordx4 v23, s[28:31], s38 offen lds
s_add_u32 m0, s39, 150528
s_nop 0
buffer_load_dwordx4 v24, s[28:31], s38 offen lds
s_waitcnt vmcnt(30)
s_barrier
s_add_u32 s37, s52, 688128
s_add_u32 m0, s39, 98304
s_nop 0
buffer_load_dwordx4 v3, s[24:27], s37 offen sc1 lds
buffer_load_dwordx4 v3, s[24:27], s37 offen offset:1024 sc1 lds
buffer_load_dwordx4 v3, s[24:27], s37 offen offset:2048 sc1 lds
buffer_load_dwordx4 v3, s[24:27], s37 offen offset:3072 sc1 lds
s_add_u32 s38, s53, 5505024
s_add_u32 m0, s39, 114688
s_nop 0
buffer_load_dwordx4 v23, s[28:31], s38 offen lds
s_add_u32 m0, s39, 115712
s_nop 0
buffer_load_dwordx4 v24, s[28:31], s38 offen lds
s_add_u32 m0, s39, 116736
s_add_u32 s38, s38, 16384
buffer_load_dwordx4 v23, s[28:31], s38 offen lds
s_add_u32 m0, s39, 117760
s_nop 0
buffer_load_dwordx4 v24, s[28:31], s38 offen lds
s_waitcnt vmcnt(10)
s_barrier
s_cmp_eq_u32 s47, 0
s_cbranch_scc0 Lw_133
s_add_u32 s7, s34, 48
s_lshl_b32 s7, s7, 7
v_mov_b32 v26, s7
v_mov_b32 v27, 1
s_mov_b64 exec, 1
buffer_atomic_add v27, v26, s[56:59], 0 offen sc1
s_mov_b64 exec, -1
Lw_133:
s_add_u32 s37, s52, 704512
s_add_u32 m0, s39, 131072
s_nop 0
buffer_load_dwordx4 v3, s[24:27], s37 offen sc1 lds
buffer_load_dwordx4 v3, s[24:27], s37 offen offset:1024 sc1 lds
buffer_load_dwordx4 v3, s[24:27], s37 offen offset:2048 sc1 lds
buffer_load_dwordx4 v3, s[24:27], s37 offen offset:3072 sc1 lds
s_add_u32 s38, s53, 5636096
s_add_u32 m0, s39, 0
s_nop 0
buffer_load_dwordx4 v23, s[28:31], s38 offen lds
s_add_u32 m0, s39, 1024
s_nop 0
buffer_load_dwordx4 v24, s[28:31], s38 offen lds
s_add_u32 m0, s39, 2048
s_add_u32 s38, s38, 16384
buffer_load_dwordx4 v23, s[28:31], s38 offen lds
s_add_u32 m0, s39, 3072
s_nop 0
buffer_load_dwordx4 v24, s[28:31], s38 offen lds
s_waitcnt vmcnt(26)
s_barrier
s_add_u32 s38, s91, 0
s_add_u32 m0, s39, 32768
s_nop 0
buffer_load_dwordx4 v23, s[28:31], s38 offen lds
s_add_u32 m0, s39, 33792
s_nop 0
buffer_load_dwordx4 v24, s[28:31], s38 offen lds
s_add_u32 m0, s39, 34816
s_add_u32 s38, s38, 16384
buffer_load_dwordx4 v23, s[28:31], s38 offen lds
s_add_u32 m0, s39, 35840
s_nop 0
buffer_load_dwordx4 v24, s[28:31], s38 offen lds
s_waitcnt vmcnt(20)
s_barrier
s_add_u32 s38, s91, 131072
s_add_u32 m0, s39, 65536
s_nop 0
buffer_load_dwordx4 v23, s[28:31], s38 offen lds
s_add_u32 m0, s39, 66560
s_nop 0
buffer_load_dwordx4 v24, s[28:31], s38 offen lds
s_add_u32 m0, s39, 67584
s_add_u32 s38, s38, 16384
buffer_load_dwordx4 v23, s[28:31], s38 offen lds
s_add_u32 m0, s39, 68608
s_nop 0
buffer_load_dwordx4 v24, s[28:31], s38 offen lds
s_waitcnt vmcnt(16)
s_barrier
s_cmp_eq_u32 s47, 3
s_cbranch_scc0 Lw_134
s_lshl_b32 s92, s34, 7
s_add_u32 s92, s92, 28317696
s_load_dword s93, s[82:83], s92 glc
Lw_134:
s_add_u32 s38, s91, 262144
s_add_u32 m0, s39, 147456
s_nop 0
buffer_load_dwordx4 v23, s[28:31], s38 offen lds
s_add_u32 m0, s39, 148480
s_nop 0
buffer_load_dwordx4 v24, s[28:31], s38 offen lds
s_add_u32 m0, s39, 149504
s_add_u32 s38, s38, 16384
buffer_load_dwordx4 v23, s[28:31], s38 offen lds
s_add_u32 m0, s39, 150528
s_nop 0
buffer_load_dwordx4 v24, s[28:31], s38 offen lds
s_waitcnt vmcnt(12)
s_cmp_eq_u32 s47, 3
s_cbranch_scc0 Lw_135
s_mov_b32 s41, 0x40000
s_branch Lpchk_138
Lpoll_136:
s_load_dword s93, s[82:83], s92 glc
Lpchk_138:
s_waitcnt lgkmcnt(0)
s_cmp_eq_u32 s93, 16
s_cbranch_scc1 Lpok_137
s_sub_u32 s41, s41, 1
s_cmp_lg_u32 s41, 0
s_cbranch_scc1 Lpoll_136
Lpok_137:
Lw_135:
s_barrier
s_add_u32 s37, s90, 0
s_add_u32 m0, s39, 16384
s_nop 0
buffer_load_dwordx4 v3, s[24:27], s37 offen sc1 lds
buffer_load_dwordx4 v3, s[24:27], s37 offen offset:1024 sc1 lds
buffer_load_dwordx4 v3, s[24:27], s37 offen offset:2048 sc1 lds
buffer_load_dwordx4 v3, s[24:27], s37 offen offset:3072 sc1 lds
s_add_u32 s37, s90, 16384
s_add_u32 m0, s39, 49152
s_nop 0
buffer_load_dwordx4 v3, s[24:27], s37 offen sc1 lds
buffer_load_dwordx4 v3, s[24:27], s37 offen offset:1024 sc1 lds
buffer_load_dwordx4 v3, s[24:27], s37 offen offset:2048 sc1 lds
buffer_load_dwordx4 v3, s[24:27], s37 offen offset:3072 sc1 lds
s_add_u32 s37, s90, 32768
s_add_u32 m0, s39, 81920
s_nop 0
buffer_load_dwordx4 v3, s[24:27], s37 offen sc1 lds
buffer_load_dwordx4 v3, s[24:27], s37 offen offset:1024 sc1 lds
buffer_load_dwordx4 v3, s[24:27], s37 offen offset:2048 sc1 lds
buffer_load_dwordx4 v3, s[24:27], s37 offen offset:3072 sc1 lds
s_add_u32 s37, s90, 49152
s_add_u32 m0, s39, 98304
s_nop 0
buffer_load_dwordx4 v3, s[24:27], s37 offen sc1 lds
buffer_load_dwordx4 v3, s[24:27], s37 offen offset:1024 sc1 lds
buffer_load_dwordx4 v3, s[24:27], s37 offen offset:2048 sc1 lds
buffer_load_dwordx4 v3, s[24:27], s37 offen offset:3072 sc1 lds
s_add_u32 s38, s91, 393216
s_add_u32 m0, s39, 114688
s_nop 0
buffer_load_dwordx4 v23, s[28:31], s38 offen lds
s_add_u32 m0, s39, 115712
s_nop 0
buffer_load_dwordx4 v24, s[28:31], s38 offen lds
s_add_u32 m0, s39, 116736
s_add_u32 s38, s38, 16384
buffer_load_dwordx4 v23, s[28:31], s38 offen lds
s_add_u32 m0, s39, 117760
s_nop 0
buffer_load_dwordx4 v24, s[28:31], s38 offen lds
s_waitcnt vmcnt(16)
s_barrier
s_add_u32 s37, s90, 65536
s_add_u32 m0, s39, 131072
s_nop 0
buffer_load_dwordx4 v3, s[24:27], s37 offen sc1 lds
buffer_load_dwordx4 v3, s[24:27], s37 offen offset:1024 sc1 lds
buffer_load_dwordx4 v3, s[24:27], s37 offen offset:2048 sc1 lds
buffer_load_dwordx4 v3, s[24:27], s37 offen offset:3072 sc1 lds
s_add_u32 s38, s91, 524288
s_add_u32 m0, s39, 0
s_nop 0
buffer_load_dwordx4 v23, s[28:31], s38 offen lds
s_add_u32 m0, s39, 1024
s_nop 0
buffer_load_dwordx4 v24, s[28:31], s38 offen lds
s_add_u32 m0, s39, 2048
s_add_u32 s38, s38, 16384
buffer_load_dwordx4 v23, s[28:31], s38 offen lds
s_add_u32 m0, s39, 3072
s_nop 0
buffer_load_dwordx4 v24, s[28:31], s38 offen lds
s_waitcnt vmcnt(20)
s_barrier
s_add_u32 s37, s90, 81920
s_add_u32 m0, s39, 16384
s_nop 0
buffer_load_dwordx4 v3, s[24:27], s37 offen sc1 lds
buffer_load_dwordx4 v3, s[24:27], s37 offen offset:1024 sc1 lds
buffer_load_dwordx4 v3, s[24:27], s37 offen offset:2048 sc1 lds
buffer_load_dwordx4 v3, s[24:27], s37 offen offset:3072 sc1 lds
s_add_u32 s38, s91, 655360
s_add_u32 m0, s39, 32768
s_nop 0
buffer_load_dwordx4 v23, s[28:31], s38 offen lds
s_add_u32 m0, s39, 33792
s_nop 0
buffer_load_dwordx4 v24, s[28:31], s38 offen lds
s_add_u32 m0, s39, 34816
s_add_u32 s38, s38, 16384
buffer_load_dwordx4 v23, s[28:31], s38 offen lds
s_add_u32 m0, s39, 35840
s_nop 0
buffer_load_dwordx4 v24, s[28:31], s38 offen lds
s_waitcnt vmcnt(24)
s_barrier
s_add_u32 s37, s90, 98304
s_add_u32 m0, s39, 49152
s_nop 0
buffer_load_dwordx4 v3, s[24:27], s37 offen sc1 lds
buffer_load_dwordx4 v3, s[24:27], s37 offen offset:1024 sc1 lds
buffer_load_dwordx4 v3, s[24:27], s37 offen offset:2048 sc1 lds
buffer_load_dwordx4 v3, s[24:27], s37 offen offset:3072 sc1 lds
s_add_u32 s38, s91, 786432
s_add_u32 m0, s39, 65536
s_nop 0
buffer_load_dwordx4 v23, s[28:31], s38 offen lds
s_add_u32 m0, s39, 66560
s_nop 0
buffer_load_dwordx4 v24, s[28:31], s38 offen lds
s_add_u32 m0, s39, 67584
s_add_u32 s38, s38, 16384
buffer_load_dwordx4 v23, s[28:31], s38 offen lds
s_add_u32 m0, s39, 68608
s_nop 0
buffer_load_dwordx4 v24, s[28:31], s38 offen lds
s_waitcnt vmcnt(24)
s_barrier
s_add_u32 s37, s90, 114688
s_add_u32 m0, s39, 81920
s_nop 0
buffer_load_dwordx4 v3, s[24:27], s37 offen sc1 lds
buffer_load_dwordx4 v3, s[24:27], s37 offen offset:1024 sc1 lds
buffer_load_dwordx4 v3, s[24:27], s37 offen offset:2048 sc1 lds
buffer_load_dwordx4 v3, s[24:27], s37 offen offset:3072 sc1 lds
s_add_u32 s38, s91, 917504
s_add_u32 m0, s39, 147456
s_nop 0
buffer_load_dwordx4 v23, s[28:31], s38 offen lds
s_add_u32 m0, s39, 148480
s_nop 0
buffer_load_dwordx4 v24, s[28:31], s38 offen lds
s_add_u32 m0, s39, 149504
s_add_u32 s38, s38, 16384
buffer_load_dwordx4 v23, s[28:31], s38 offen lds
s_add_u32 m0, s39, 150528
s_nop 0
buffer_load_dwordx4 v24, s[28:31], s38 offen lds
s_waitcnt vmcnt(24)
s_barrier
s_add_u32 s37, s90, 131072
s_add_u32 m0, s39, 98304
s_nop 0
buffer_load_dwordx4 v3, s[24:27], s37 offen sc1 lds
buffer_load_dwordx4 v3, s[24:27], s37 offen offset:1024 sc1 lds
buffer_load_dwordx4 v3, s[24:27], s37 offen offset:2048 sc1 lds
buffer_load_dwordx4 v3, s[24:27], s37 offen offset:3072 sc1 lds
s_add_u32 s38, s91, 1048576
s_add_u32 m0, s39, 114688
s_nop 0
buffer_load_dwordx4 v23, s[28:31], s38 offen lds
s_add_u32 m0, s39, 115712
s_nop 0
buffer_load_dwordx4 v24, s[28:31], s38 offen lds
s_add_u32 m0, s39, 116736
s_add_u32 s38, s38, 16384
buffer_load_dwordx4 v23, s[28:31], s38 offen lds
s_add_u32 m0, s39, 117760
s_nop 0
buffer_load_dwordx4 v24, s[28:31], s38 offen lds
s_waitcnt vmcnt(24)
s_barrier
s_add_u32 s37, s90, 147456
s_add_u32 m0, s39, 131072
s_nop 0
buffer_load_dwordx4 v3, s[24:27], s37 offen sc1 lds
buffer_load_dwordx4 v3, s[24:27], s37 offen offset:1024 sc1 lds
buffer_load_dwordx4 v3, s[24:27], s37 offen offset:2048 sc1 lds
buffer_load_dwordx4 v3, s[24:27], s37 offen offset:3072 sc1 lds
s_add_u32 s38, s91, 1179648
s_add_u32 m0, s39, 0
s_nop 0
buffer_load_dwordx4 v23, s[28:31], s38 offen lds
s_add_u32 m0, s39, 1024
s_nop 0
buffer_load_dwordx4 v24, s[28:31], s38 offen lds
s_add_u32 m0, s39, 2048
s_add_u32 s38, s38, 16384
buffer_load_dwordx4 v23, s[28:31], s38 offen lds
s_add_u32 m0, s39, 3072
s_nop 0
buffer_load_dwordx4 v24, s[28:31], s38 offen lds
s_waitcnt vmcnt(24)
s_barrier
s_mov_b32 s37, 327680
s_add_u32 m0, s39, 16384
s_nop 0
buffer_load_dwordx4 v3, s[24:27], s37 offen sc1 lds
buffer_load_dwordx4 v3, s[24:27], s37 offen offset:1024 sc1 lds
buffer_load_dwordx4 v3, s[24:27], s37 offen offset:2048 sc1 lds
buffer_load_dwordx4 v3, s[24:27], s37 offen offset:3072 sc1 lds
s_mov_b32 s38, 2621440
s_add_u32 m0, s51, 32768
s_nop 0
buffer_load_dwordx4 v25, s[28:31], s38 offen lds
s_add_u32 m0, s51, 33792
s_add_u32 s38, s38, 16384
buffer_load_dwordx4 v25, s[28:31], s38 offen lds
s_waitcnt vmcnt(22)
s_barrier
s_mov_b32 s37, 344064
s_add_u32 m0, s39, 49152
s_nop 0
buffer_load_dwordx4 v3, s[24:27], s37 offen sc1 lds
buffer_load_dwordx4 v3, s[24:27], s37 offen offset:1024 sc1 lds
buffer_load_dwordx4 v3, s[24:27], s37 offen offset:2048 sc1 lds
buffer_load_dwordx4 v3, s[24:27], s37 offen offset:3072 sc1 lds
s_mov_b32 s38, 2752512
s_add_u32 m0, s51, 65536
s_nop 0
buffer_load_dwordx4 v25, s[28:31], s38 offen lds
s_add_u32 m0, s51, 66560
s_add_u32 s38, s38, 16384
buffer_load_dwordx4 v25, s[28:31], s38 offen lds
s_waitcnt vmcnt(20)
s_barrier
s_mov_b32 s37, 360448
s_add_u32 m0, s39, 81920
s_nop 0
buffer_load_dwordx4 v3, s[24:27], s37 offen sc1 lds
buffer_load_dwordx4 v3, s[24:27], s37 offen offset:1024 sc1 lds
buffer_load_dwordx4 v3, s[24:27], s37 offen offset:2048 sc1 lds
buffer_load_dwordx4 v3, s[24:27], s37 offen offset:3072 sc1 lds
s_mov_b32 s38, 2883584
s_add_u32 m0, s51, 147456
s_nop 0
buffer_load_dwordx4 v25, s[28:31], s38 offen lds
s_add_u32 m0, s51, 148480
s_add_u32 s38, s38, 16384
buffer_load_dwordx4 v25, s[28:31], s38 offen lds
s_waitcnt vmcnt(18)
s_barrier
s_mov_b32 s37, 376832
s_add_u32 m0, s39, 98304
s_nop 0
buffer_load_dwordx4 v3, s[24:27], s37 offen sc1 lds
buffer_load_dwordx4 v3, s[24:27], s37 offen offset:1024 sc1 lds
buffer_load_dwordx4 v3, s[24:27], s37 offen offset:2048 sc1 lds
buffer_load_dwordx4 v3, s[24:27], s37 offen offset:3072 sc1 lds
s_mov_b32 s38, 3014656
s_add_u32 m0, s51, 114688
s_nop 0
buffer_load_dwordx4 v25, s[28:31], s38 offen lds
s_add_u32 m0, s51, 115712
s_add_u32 s38, s38, 16384
buffer_load_dwordx4 v25, s[28:31], s38 offen lds
s_waitcnt vmcnt(18)
s_barrier
s_mov_b32 s37, 393216
s_add_u32 m0, s39, 131072
s_nop 0
buffer_load_dwordx4 v3, s[24:27], s37 offen sc1 lds
buffer_load_dwordx4 v3, s[24:27], s37 offen offset:1024 sc1 lds
buffer_load_dwordx4 v3, s[24:27], s37 offen offset:2048 sc1 lds
buffer_load_dwordx4 v3, s[24:27], s37 offen offset:3072 sc1 lds
s_mov_b32 s38, 3145728
s_add_u32 m0, s51, 0
s_nop 0
buffer_load_dwordx4 v25, s[28:31], s38 offen lds
s_add_u32 m0, s51, 1024
s_add_u32 s38, s38, 16384
buffer_load_dwordx4 v25, s[28:31], s38 offen lds
s_waitcnt vmcnt(18)
s_barrier
s_mov_b32 s37, 409600
s_add_u32 m0, s39, 16384
s_nop 0
buffer_load_dwordx4 v3, s[24:27], s37 offen sc1 lds
buffer_load_dwordx4 v3, s[24:27], s37 offen offset:1024 sc1 lds
buffer_load_dwordx4 v3, s[24:27], s37 offen offset:2048 sc1 lds
buffer_load_dwordx4 v3, s[24:27], s37 offen offset:3072 sc1 lds
s_mov_b32 s38, 3276800
s_add_u32 m0, s51, 32768
s_nop 0
buffer_load_dwordx4 v25, s[28:31], s38 offen lds
s_add_u32 m0, s51, 33792
s_branch Lov_18
.p2align 12
.fill 144, 4, 0xbf800000
Lst_18_0:
s_branch Lwr_171
s_nop 0
s_nop 0
Lov_18:
s_add_u32 s38, s38, 16384
buffer_load_dwordx4 v25, s[28:31], s38 offen lds
s_waitcnt vmcnt(18)
s_barrier
s_mov_b32 s37, 425984
s_add_u32 m0, s39, 49152
s_nop 0
buffer_load_dwordx4 v3, s[24:27], s37 offen sc1 lds
buffer_load_dwordx4 v3, s[24:27], s37 offen offset:1024 sc1 lds
buffer_load_dwordx4 v3, s[24:27], s37 offen offset:2048 sc1 lds
buffer_load_dwordx4 v3, s[24:27], s37 offen offset:3072 sc1 lds
s_mov_b32 s38, 3407872
s_add_u32 m0, s51, 65536
s_nop 0
buffer_load_dwordx4 v25, s[28:31], s38 offen lds
s_add_u32 m0, s51, 66560
s_add_u32 s38, s38, 16384
buffer_load_dwordx4 v25, s[28:31], s38 offen lds
s_waitcnt vmcnt(18)
s_barrier
s_mov_b32 s37, 442368
s_add_u32 m0, s39, 81920
s_nop 0
buffer_load_dwordx4 v3, s[24:27], s37 offen sc1 lds
buffer_load_dwordx4 v3, s[24:27], s37 offen offset:1024 sc1 lds
buffer_load_dwordx4 v3, s[24:27], s37 offen offset:2048 sc1 lds
buffer_load_dwordx4 v3, s[24:27], s37 offen offset:3072 sc1 lds
s_mov_b32 s38, 3538944
s_add_u32 m0, s51, 147456
s_nop 0
buffer_load_dwordx4 v25, s[28:31], s38 offen lds
s_add_u32 m0, s51, 148480
s_add_u32 s38, s38, 16384
buffer_load_dwordx4 v25, s[28:31], s38 offen lds
s_waitcnt vmcnt(18)
s_barrier
s_mov_b32 s37, 458752
s_add_u32 m0, s39, 98304
s_nop 0
buffer_load_dwordx4 v3, s[24:27], s37 offen sc1 lds
buffer_load_dwordx4 v3, s[24:27], s37 offen offset:1024 sc1 lds
buffer_load_dwordx4 v3, s[24:27], s37 offen offset:2048 sc1 lds
buffer_load_dwordx4 v3, s[24:27], s37 offen offset:3072 sc1 lds
s_mov_b32 s38, 3670016
s_add_u32 m0, s51, 114688
s_nop 0
buffer_load_dwordx4 v25, s[28:31], s38 offen lds
s_add_u32 m0, s51, 115712
s_add_u32 s38, s38, 16384
buffer_load_dwordx4 v25, s[28:31], s38 offen lds
s_waitcnt vmcnt(18)
s_barrier
s_mov_b32 s37, 475136
s_add_u32 m0, s39, 131072
s_nop 0
buffer_load_dwordx4 v3, s[24:27], s37 offen sc1 lds
buffer_load_dwordx4 v3, s[24:27], s37 offen offset:1024 sc1 lds
buffer_load_dwordx4 v3, s[24:27], s37 offen offset:2048 sc1 lds
buffer_load_dwordx4 v3, s[24:27], s37 offen offset:3072 sc1 lds
s_mov_b32 s38, 3801088
s_add_u32 m0, s51, 0
s_nop 0
buffer_load_dwordx4 v25, s[28:31], s38 offen lds
s_add_u32 m0, s51, 1024
s_add_u32 s38, s38, 16384
buffer_load_dwordx4 v25, s[28:31], s38 offen lds
s_waitcnt vmcnt(18)
s_barrier
s_cmp_eq_u32 s47, 0
s_cbranch_scc0 Lw_139
s_xor_b32 s43, s2, 2
s_add_u32 s43, s43, 128
s_lshl_b32 s43, s43, 7
v_mov_b32 v26, s43
v_mov_b32 v27, 1
s_mov_b64 exec, 1
buffer_store_dword v27, v26, s[56:59], 0 offen sc1
s_mov_b64 exec, -1
Lw_139:
s_mov_b32 s37, 491520
s_add_u32 m0, s39, 16384
s_nop 0
buffer_load_dwordx4 v3, s[24:27], s37 offen sc1 lds
buffer_load_dwordx4 v3, s[24:27], s37 offen offset:1024 sc1 lds
buffer_load_dwordx4 v3, s[24:27], s37 offen offset:2048 sc1 lds
buffer_load_dwordx4 v3, s[24:27], s37 offen offset:3072 sc1 lds
s_mov_b32 s38, 3932160
s_add_u32 m0, s51, 32768
s_nop 0
buffer_load_dwordx4 v25, s[28:31], s38 offen lds
s_add_u32 m0, s51, 33792
s_add_u32 s38, s38, 16384
buffer_load_dwordx4 v25, s[28:31], s38 offen lds
s_waitcnt vmcnt(18)
s_barrier
s_mov_b32 s37, 507904
s_add_u32 m0, s39, 49152
s_nop 0
buffer_load_dwordx4 v3, s[24:27], s37 offen sc1 lds
buffer_load_dwordx4 v3, s[24:27], s37 offen offset:1024 sc1 lds
buffer_load_dwordx4 v3, s[24:27], s37 offen offset:2048 sc1 lds
buffer_load_dwordx4 v3, s[24:27], s37 offen offset:3072 sc1 lds
s_mov_b32 s38, 4063232
s_add_u32 m0, s51, 65536
s_nop 0
buffer_load_dwordx4 v25, s[28:31], s38 offen lds
s_add_u32 m0, s51, 66560
s_add_u32 s38, s38, 16384
buffer_load_dwordx4 v25, s[28:31], s38 offen lds
s_waitcnt vmcnt(18)
s_barrier
s_cmp_eq_u32 s47, 3
s_cbranch_scc0 Lw_140
s_lshl_b32 s92, s2, 7
s_add_u32 s92, s92, 28327936
s_load_dword s93, s[82:83], s92 glc
Lw_140:
s_waitcnt vmcnt(12)
s_cmp_eq_u32 s47, 3
s_cbranch_scc0 Lw_141
s_mov_b32 s41, 0x40000
s_branch Lpchk_144
Lpoll_142:
s_load_dword s93, s[82:83], s92 glc
Lpchk_144:
s_waitcnt lgkmcnt(0)
s_cmp_eq_u32 s93, 1
s_cbranch_scc1 Lpok_143
s_sub_u32 s41, s41, 1
s_cmp_lg_u32 s41, 0
s_cbranch_scc1 Lpoll_142
Lpok_143:
Lw_141:
s_barrier
s_waitcnt vmcnt(6)
s_barrier
s_waitcnt vmcnt(0)
s_barrier
s_barrier
s_branch Ldone_1
Ldone_1:
Lfin:
Lexit_2:
s_endpgm
.fill 1024, 4, 0xbf800000
.section .rodata,"a"
.p2align 6
.amdhsa_kernel sequential_preLN__sliding_local_dilated__glu_gated_geglu__prompt_kernel
  .amdhsa_next_free_vgpr 256
  .amdhsa_next_free_sgpr 102
  .amdhsa_accum_offset 256
  .amdhsa_group_segment_fixed_size 0
  .amdhsa_kernarg_size 80
  .amdhsa_user_sgpr_count 2
  .amdhsa_user_sgpr_kernarg_segment_ptr 1
  .amdhsa_system_sgpr_workgroup_id_x 1
  .amdhsa_float_denorm_mode_32 3
  .amdhsa_float_denorm_mode_16_64 3
.end_amdhsa_kernel
```

```asm
; @launch grid=(256,1,1) block=(512,1,1) lds=163840
.amdgcn_target "amdgcn-amd-amdhsa--gfx950"
.text
.globl sequential_preLN__sliding_local_dilated__glu_gated_geglu__prompt_kernel
.p2align 8
.type sequential_preLN__sliding_local_dilated__glu_gated_geglu__prompt_kernel,@function
sequential_preLN__sliding_local_dilated__glu_gated_geglu__prompt_kernel:
s_cmp_ge_u32 s2, 256
s_cbranch_scc1 Lexit_2
s_load_dwordx16 s[64:79], s[0:1], 0
s_load_dwordx4 s[80:83], s[0:1], 64
s_and_b32 s3, s2, 7
s_lshr_b32 s42, s2, 3
s_and_b32 s34, s3, 1
s_lshl_b32 s34, s34, 3
s_and_b32 s48, s42, 7
s_add_u32 s34, s34, s48
s_lshr_b32 s35, s3, 1
s_lshr_b32 s49, s42, 3
s_lshl_b32 s35, s35, 2
s_add_u32 s35, s35, s49
v_lshrrev_b32 v12, 6, v0
v_and_b32 v1, 63, v0
v_readfirstlane_b32 s36, v12
Lbeg:
s_lshl_b32 s50, s34, 7
s_sub_u32 s50, s50, 16
v_and_b32 v12, 15, v1
v_lshrrev_b32 v13, 4, v1
s_cmp_lt_u32 s36, 4
s_cbranch_scc1 Lcons_7
Lprod_3:
s_sub_u32 s47, s36, 4
s_lshl_b32 s43, s34, 7
s_lshl_b32 s44, s35, 3
s_add_u32 s63, s43, s44
s_lshl_b32 s44, s47, 1
s_add_u32 s51, s63, s44
v_lshlrev_b32 v10, 4, v1
s_and_b32 s43, s2, 7
s_lshr_b32 s44, s43, 2
s_lshl_b32 s44, s44, 1
s_and_b32 s45, s43, 1
s_add_u32 s44, s44, s45
s_lshr_b32 s45, s2, 3
s_lshl_b32 s45, s45, 2
s_add_u32 s44, s44, s45
s_add_u32 s44, s44, 96
s_bitcmp1_b32 s43, 1
s_cselect_b32 s44, s44, 0x10000
s_cmp_lt_u32 s2, 192
s_cselect_b32 s33, s2, s44
v_lshrrev_b32 v14, 3, v1
v_and_b32 v15, 7, v1
v_lshl_add_u32 v19, v14, 6, v15
s_lshl_b32 s43, s48, 3
v_add_u32 v19, s43, v19
v_mul_u32_u24 v19, 6144, v19
s_cmp_eq_u32 s47, 3
s_cbranch_scc1 Lpf_4
v_and_b32 v16, 2, v14
v_xor_b32 v16, v15, v16
v_lshlrev_b32 v16, 4, v16
v_mul_u32_u24 v17, 6144, v14
s_lshl_b32 s43, s47, 11
v_add3_u32 v2, v17, v16, s43
v_xor_b32 v3, 64, v2
v_lshrrev_b32 v16, 1, v14
v_xor_b32 v16, v15, v16
v_lshlrev_b32 v16, 4, v16
s_lshl_b32 s43, s47, 3
s_add_u32 s43, s43, s50
v_add_u32 v17, s43, v14
s_and_b32 s44, s47, 1
s_lshl_b32 s44, s44, 6
v_add_u32 v18, 0, v17
v_max_i32 v18, 0, v18
v_lshl_add_u32 v18, v18, 11, v16
v_xor_b32 v18, s44, v18
v_mov_b32 v4, v18
v_add_u32 v18, 24, v17
v_max_i32 v18, 0, v18
v_lshl_add_u32 v18, v18, 11, v16
v_xor_b32 v18, s44, v18
v_xor_b32 v5, 64, v18
v_add_u32 v18, 48, v17
v_max_i32 v18, 0, v18
v_lshl_add_u32 v18, v18, 11, v16
v_xor_b32 v18, s44, v18
v_mov_b32 v6, v18
v_add_u32 v18, 72, v17
v_max_i32 v18, 0, v18
v_lshl_add_u32 v18, v18, 11, v16
v_xor_b32 v18, s44, v18
v_xor_b32 v7, 64, v18
v_add_u32 v18, 96, v17
v_max_i32 v18, 0, v18
v_lshl_add_u32 v18, v18, 11, v16
v_xor_b32 v18, s44, v18
v_mov_b32 v8, v18
v_add_u32 v18, 120, v17
v_max_i32 v18, 0, v18
v_lshl_add_u32 v18, v18, 11, v16
v_xor_b32 v18, s44, v18
v_xor_b32 v9, 64, v18
s_lshl_b32 s39, s47, 10
s_lshl_b32 s40, s47, 13
s_add_u32 s40, s40, 18432
s_mov_b32 s37, 0
s_mov_b32 s38, 0
s_bfm_b64 s[60:61], 56, 8
s_cmp_eq_u32 s47, 0
s_cselect_b64 s[60:61], s[60:61], -1
s_lshl_b32 s43, s35, 7
s_waitcnt lgkmcnt(0)
s_mov_b32 s8, s64
s_mov_b32 s9, s65
s_mov_b32 s10, 4194304
s_mov_b32 s11, 0x20000
s_add_u32 s12, s66, s43
s_addc_u32 s13, s67, 0
s_mov_b32 s14, 6289536
s_mov_b32 s15, 0x20000
s_mov_b32 s28, s66
s_mov_b32 s29, s67
s_mov_b32 s30, 6291456
s_mov_b32 s31, 0x20000
s_mul_i32 s43, s33, 7296
v_lshlrev_b32 v30, 7, v1
s_mul_i32 s44, s47, 2432
s_add_u32 s43, s43, s44
s_bfm_b64 exec, 19, 0
buffer_load_dword v31, v30, s[28:31], s43 offen
s_mov_b64 exec, -1
s_add_u32 m0, s39, 0
s_mov_b64 exec, s[60:61]
buffer_load_dwordx4 v4, s[8:11], s37 offen lds
s_mov_b64 exec, -1
s_add_u32 m0, s39, 3072
s_nop 0
buffer_load_dwordx4 v5, s[8:11], s37 offen lds
s_add_u32 m0, s39, 6144
s_nop 0
buffer_load_dwordx4 v6, s[8:11], s37 offen lds
s_add_u32 m0, s39, 9216
s_nop 0
buffer_load_dwordx4 v7, s[8:11], s37 offen lds
s_add_u32 m0, s39, 12288
s_nop 0
buffer_load_dwordx4 v8, s[8:11], s37 offen lds
s_add_u32 m0, s39, 15360
s_nop 0
buffer_load_dwordx4 v9, s[8:11], s37 offen lds
s_add_u32 m0, s40, 0
s_add_u32 s43, s38, 0
buffer_load_dwordx4 v2, s[12:15], s43 offen lds
s_add_u32 m0, s40, 1024
s_add_u32 s43, s38, 49152
buffer_load_dwordx4 v3, s[12:15], s43 offen lds
s_add_u32 m0, s40, 2048
s_add_u32 s43, s38, 98304
buffer_load_dwordx4 v2, s[12:15], s43 offen lds
s_add_u32 m0, s40, 3072
s_add_u32 s43, s38, 147456
buffer_load_dwordx4 v3, s[12:15], s43 offen lds
s_add_u32 m0, s40, 4096
s_add_u32 s43, s38, 196608
buffer_load_dwordx4 v2, s[12:15], s43 offen lds
s_add_u32 m0, s40, 5120
s_add_u32 s43, s38, 245760
buffer_load_dwordx4 v3, s[12:15], s43 offen lds
s_add_u32 m0, s40, 6144
s_add_u32 s43, s38, 294912
buffer_load_dwordx4 v2, s[12:15], s43 offen lds
s_add_u32 m0, s40, 7168
s_add_u32 s43, s38, 344064
buffer_load_dwordx4 v3, s[12:15], s43 offen lds
s_add_u32 s37, s37, 128
s_add_u32 s38, s38, 393216
s_lshl_b32 s43, s51, 11
buffer_load_dwordx4 v[96:99], v10, s[8:11], s43 offen offset:0
buffer_load_dwordx4 v[100:103], v10, s[8:11], s43 offen offset:1024
buffer_load_dwordx4 v[104:107], v10, s[8:11], s43 offen offset:2048
buffer_load_dwordx4 v[108:111], v10, s[8:11], s43 offen offset:3072
s_add_u32 m0, s39, 43008
s_mov_b64 exec, s[60:61]
buffer_load_dwordx4 v4, s[8:11], s37 offen lds
s_mov_b64 exec, -1
s_add_u32 m0, s39, 46080
s_nop 0
buffer_load_dwordx4 v5, s[8:11], s37 offen lds
s_add_u32 m0, s39, 49152
s_nop 0
buffer_load_dwordx4 v6, s[8:11], s37 offen lds
s_add_u32 m0, s39, 52224
s_nop 0
buffer_load_dwordx4 v7, s[8:11], s37 offen lds
s_add_u32 m0, s39, 55296
s_nop 0
buffer_load_dwordx4 v8, s[8:11], s37 offen lds
s_add_u32 m0, s39, 58368
s_nop 0
buffer_load_dwordx4 v9, s[8:11], s37 offen lds
s_add_u32 m0, s40, 43008
s_add_u32 s43, s38, 0
buffer_load_dwordx4 v2, s[12:15], s43 offen lds
s_add_u32 m0, s40, 44032
s_add_u32 s43, s38, 49152
buffer_load_dwordx4 v3, s[12:15], s43 offen lds
s_add_u32 m0, s40, 45056
s_add_u32 s43, s38, 98304
buffer_load_dwordx4 v2, s[12:15], s43 offen lds
s_add_u32 m0, s40, 46080
s_add_u32 s43, s38, 147456
buffer_load_dwordx4 v3, s[12:15], s43 offen lds
s_add_u32 m0, s40, 47104
s_add_u32 s43, s38, 196608
buffer_load_dwordx4 v2, s[12:15], s43 offen lds
s_add_u32 m0, s40, 48128
s_add_u32 s43, s38, 245760
buffer_load_dwordx4 v3, s[12:15], s43 offen lds
s_add_u32 m0, s40, 49152
s_add_u32 s43, s38, 294912
buffer_load_dwordx4 v2, s[12:15], s43 offen lds
s_add_u32 m0, s40, 50176
s_add_u32 s43, s38, 344064
buffer_load_dwordx4 v3, s[12:15], s43 offen lds
s_add_u32 s37, s37, 128
s_add_u32 s38, s38, 393216
s_waitcnt vmcnt(18)
s_barrier
s_add_u32 m0, s39, 86016
s_mov_b64 exec, s[60:61]
buffer_load_dwordx4 v4, s[8:11], s37 offen lds
s_mov_b64 exec, -1
s_add_u32 m0, s39, 89088
s_nop 0
buffer_load_dwordx4 v5, s[8:11], s37 offen lds
s_add_u32 m0, s39, 92160
s_nop 0
buffer_load_dwordx4 v6, s[8:11], s37 offen lds
s_add_u32 m0, s39, 95232
s_nop 0
buffer_load_dwordx4 v7, s[8:11], s37 offen lds
s_add_u32 m0, s39, 98304
s_nop 0
buffer_load_dwordx4 v8, s[8:11], s37 offen lds
s_add_u32 m0, s39, 101376
s_nop 0
buffer_load_dwordx4 v9, s[8:11], s37 offen lds
s_add_u32 m0, s40, 86016
s_add_u32 s43, s38, 0
buffer_load_dwordx4 v2, s[12:15], s43 offen lds
s_add_u32 m0, s40, 87040
s_add_u32 s43, s38, 49152
buffer_load_dwordx4 v3, s[12:15], s43 offen lds
s_add_u32 m0, s40, 88064
s_add_u32 s43, s38, 98304
buffer_load_dwordx4 v2, s[12:15], s43 offen lds
s_add_u32 m0, s40, 89088
s_add_u32 s43, s38, 147456
buffer_load_dwordx4 v3, s[12:15], s43 offen lds
s_add_u32 m0, s40, 90112
s_add_u32 s43, s38, 196608
buffer_load_dwordx4 v2, s[12:15], s43 offen lds
s_add_u32 m0, s40, 91136
s_add_u32 s43, s38, 245760
buffer_load_dwordx4 v3, s[12:15], s43 offen lds
s_add_u32 m0, s40, 92160
s_add_u32 s43, s38, 294912
buffer_load_dwordx4 v2, s[12:15], s43 offen lds
s_add_u32 m0, s40, 93184
s_add_u32 s43, s38, 344064
buffer_load_dwordx4 v3, s[12:15], s43 offen lds
s_add_u32 s37, s37, 128
s_add_u32 s38, s38, 393216
s_waitcnt vmcnt(28)
s_mov_b32 s43, 0x3f803f80
v_mov_b32 v116, 0
v_mov_b32 v117, 0
v_mov_b32 v118, 0
v_mov_b32 v119, 0
v_mov_b32 v120, 0
v_mov_b32 v121, 0
v_mov_b32 v122, 0
v_mov_b32 v123, 0
v_dot2_f32_bf16 v116, v96, s43, v116
v_dot2_f32_bf16 v120, v96, v96, v120
v_dot2_f32_bf16 v118, v104, s43, v118
v_dot2_f32_bf16 v122, v104, v104, v122
v_dot2_f32_bf16 v117, v97, s43, v117
v_dot2_f32_bf16 v121, v97, v97, v121
v_dot2_f32_bf16 v119, v105, s43, v119
v_dot2_f32_bf16 v123, v105, v105, v123
v_dot2_f32_bf16 v116, v98, s43, v116
v_dot2_f32_bf16 v120, v98, v98, v120
v_dot2_f32_bf16 v118, v106, s43, v118
v_dot2_f32_bf16 v122, v106, v106, v122
v_dot2_f32_bf16 v117, v99, s43, v117
v_dot2_f32_bf16 v121, v99, v99, v121
v_dot2_f32_bf16 v119, v107, s43, v119
v_dot2_f32_bf16 v123, v107, v107, v123
v_dot2_f32_bf16 v116, v100, s43, v116
v_dot2_f32_bf16 v120, v100, v100, v120
v_dot2_f32_bf16 v118, v108, s43, v118
v_dot2_f32_bf16 v122, v108, v108, v122
v_dot2_f32_bf16 v117, v101, s43, v117
v_dot2_f32_bf16 v121, v101, v101, v121
v_dot2_f32_bf16 v119, v109, s43, v119
v_dot2_f32_bf16 v123, v109, v109, v123
v_dot2_f32_bf16 v116, v102, s43, v116
v_dot2_f32_bf16 v120, v102, v102, v120
v_dot2_f32_bf16 v118, v110, s43, v118
v_dot2_f32_bf16 v122, v110, v110, v122
v_dot2_f32_bf16 v117, v103, s43, v117
v_dot2_f32_bf16 v121, v103, v103, v121
v_dot2_f32_bf16 v119, v111, s43, v119
v_dot2_f32_bf16 v123, v111, v111, v123
s_nop 2
v_add_f32 v116, v116, v117
v_add_f32 v118, v118, v119
v_add_f32 v120, v120, v121
v_add_f32 v122, v122, v123
s_nop 1
v_permlane32_swap_b32 v116, v118
v_permlane32_swap_b32 v120, v122
v_add_f32 v116, v116, v118
v_add_f32 v120, v120, v122
s_nop 1
v_permlane16_swap_b32 v116, v120
v_add_f32 v116, v116, v120
s_nop 1
v_add_f32_dpp v116, v116, v116 row_ror:8 row_mask:0xf bank_mask:0xf
s_nop 1
v_add_f32_dpp v116, v116, v116 row_ror:4 row_mask:0xf bank_mask:0xf
s_nop 1
v_add_f32_dpp v116, v116, v116 row_ror:2 row_mask:0xf bank_mask:0xf
s_nop 1
v_add_f32_dpp v116, v116, v116 row_ror:1 row_mask:0xf bank_mask:0xf
v_mov_b32 v117, v116
s_nop 1
v_permlane16_swap_b32 v116, v117
v_mul_f32 v112, 0x3a800000, v116
v_mul_f32 v113, 0x3a800000, v117
v_fma_f32 v113, -v112, v112, v113
v_max_f32 v113, 0, v113
v_add_f32 v113, 0x3727c5ac, v113
v_rsq_f32 v113, v113
v_lshrrev_b32 v11, 5, v1
s_lshl_b32 s43, s47, 4
s_add_u32 s43, s43, 148608
v_lshl_add_u32 v11, v11, 3, s43
ds_write_b64 v11, v[112:113]
s_waitcnt lgkmcnt(0)
s_and_b32 s44, s36, 3
s_mul_i32 s44, s44, 28
s_bfe_u32 s43, s2, 0x30001
s_lshl_b32 s43, s43, 7
s_add_u32 s44, s44, s43
s_mul_i32 s44, s44, 7168
s_lshr_b32 s43, s2, 4
s_lshl_b32 s43, s43, 8
s_add_u32 s43, s43, s44
s_bitcmp0_b32 s2, 0
s_cselect_b32 s4, s72, s74
s_cselect_b32 s5, s73, s75
s_add_u32 s4, s4, s43
s_addc_u32 s5, s5, 0
Lsp_8:
s_waitcnt vmcnt(14)
s_barrier
s_add_u32 m0, s39, 0
s_mov_b64 exec, s[60:61]
buffer_load_dwordx4 v4, s[8:11], s37 offen lds
s_mov_b64 exec, -1
s_add_u32 m0, s39, 3072
s_nop 0
buffer_load_dwordx4 v5, s[8:11], s37 offen lds
s_add_u32 m0, s39, 6144
s_nop 0
buffer_load_dwordx4 v6, s[8:11], s37 offen lds
s_add_u32 m0, s39, 9216
s_nop 0
buffer_load_dwordx4 v7, s[8:11], s37 offen lds
s_add_u32 m0, s39, 12288
s_nop 0
buffer_load_dwordx4 v8, s[8:11], s37 offen lds
s_add_u32 m0, s39, 15360
s_nop 0
buffer_load_dwordx4 v9, s[8:11], s37 offen lds
s_add_u32 m0, s40, 0
s_add_u32 s43, s38, 0
buffer_load_dwordx4 v2, s[12:15], s43 offen lds
s_add_u32 m0, s40, 1024
s_add_u32 s43, s38, 49152
buffer_load_dwordx4 v3, s[12:15], s43 offen lds
s_add_u32 m0, s40, 2048
s_add_u32 s43, s38, 98304
buffer_load_dwordx4 v2, s[12:15], s43 offen lds
s_add_u32 m0, s40, 3072
s_add_u32 s43, s38, 147456
buffer_load_dwordx4 v3, s[12:15], s43 offen lds
s_add_u32 m0, s40, 4096
s_add_u32 s43, s38, 196608
buffer_load_dwordx4 v2, s[12:15], s43 offen lds
s_add_u32 m0, s40, 5120
s_add_u32 s43, s38, 245760
buffer_load_dwordx4 v3, s[12:15], s43 offen lds
s_add_u32 m0, s40, 6144
s_add_u32 s43, s38, 294912
buffer_load_dwordx4 v2, s[12:15], s43 offen lds
s_add_u32 m0, s40, 7168
s_add_u32 s43, s38, 344064
buffer_load_dwordx4 v3, s[12:15], s43 offen lds
s_add_u32 s37, s37, 128
s_add_u32 s38, s38, 393216
Lsp_9:
s_waitcnt vmcnt(14)
s_barrier
s_add_u32 m0, s39, 43008
s_mov_b64 exec, s[60:61]
buffer_load_dwordx4 v4, s[8:11], s37 offen lds
s_mov_b64 exec, -1
s_add_u32 m0, s39, 46080
s_nop 0
buffer_load_dwordx4 v5, s[8:11], s37 offen lds
s_add_u32 m0, s39, 49152
s_nop 0
buffer_load_dwordx4 v6, s[8:11], s37 offen lds
s_add_u32 m0, s39, 52224
s_nop 0
buffer_load_dwordx4 v7, s[8:11], s37 offen lds
s_add_u32 m0, s39, 55296
s_nop 0
buffer_load_dwordx4 v8, s[8:11], s37 offen lds
s_add_u32 m0, s39, 58368
s_nop 0
buffer_load_dwordx4 v9, s[8:11], s37 offen lds
s_add_u32 m0, s40, 43008
s_add_u32 s43, s38, 0
buffer_load_dwordx4 v2, s[12:15], s43 offen lds
s_add_u32 m0, s40, 44032
s_add_u32 s43, s38, 49152
buffer_load_dwordx4 v3, s[12:15], s43 offen lds
s_add_u32 m0, s40, 45056
s_add_u32 s43, s38, 98304
buffer_load_dwordx4 v2, s[12:15], s43 offen lds
s_add_u32 m0, s40, 46080
s_add_u32 s43, s38, 147456
buffer_load_dwordx4 v3, s[12:15], s43 offen lds
s_add_u32 m0, s40, 47104
s_add_u32 s43, s38, 196608
buffer_load_dwordx4 v2, s[12:15], s43 offen lds
s_add_u32 m0, s40, 48128
s_add_u32 s43, s38, 245760
buffer_load_dwordx4 v3, s[12:15], s43 offen lds
s_add_u32 m0, s40, 49152
s_add_u32 s43, s38, 294912
buffer_load_dwordx4 v2, s[12:15], s43 offen lds
s_add_u32 m0, s40, 50176
s_add_u32 s43, s38, 344064
buffer_load_dwordx4 v3, s[12:15], s43 offen lds
s_add_u32 s37, s37, 128
s_add_u32 s38, s38, 393216
s_load_dword s3, s[4:5], 0
s_load_dword s3, s[4:5], 64
s_load_dword s3, s[4:5], 128
Lsp_10:
s_waitcnt vmcnt(14)
s_barrier
s_add_u32 m0, s39, 86016
s_mov_b64 exec, s[60:61]
buffer_load_dwordx4 v4, s[8:11], s37 offen lds
s_mov_b64 exec, -1
s_add_u32 m0, s39, 89088
s_nop 0
buffer_load_dwordx4 v5, s[8:11], s37 offen lds
s_add_u32 m0, s39, 92160
s_nop 0
buffer_load_dwordx4 v6, s[8:11], s37 offen lds
s_add_u32 m0, s39, 95232
s_nop 0
buffer_load_dwordx4 v7, s[8:11], s37 offen lds
s_add_u32 m0, s39, 98304
s_nop 0
buffer_load_dwordx4 v8, s[8:11], s37 offen lds
s_add_u32 m0, s39, 101376
s_nop 0
buffer_load_dwordx4 v9, s[8:11], s37 offen lds
s_add_u32 m0, s40, 86016
s_add_u32 s43, s38, 0
buffer_load_dwordx4 v2, s[12:15], s43 offen lds
s_add_u32 m0, s40, 87040
s_add_u32 s43, s38, 49152
buffer_load_dwordx4 v3, s[12:15], s43 offen lds
s_add_u32 m0, s40, 88064
s_add_u32 s43, s38, 98304
buffer_load_dwordx4 v2, s[12:15], s43 offen lds
s_add_u32 m0, s40, 89088
s_add_u32 s43, s38, 147456
buffer_load_dwordx4 v3, s[12:15], s43 offen lds
s_add_u32 m0, s40, 90112
s_add_u32 s43, s38, 196608
buffer_load_dwordx4 v2, s[12:15], s43 offen lds
s_add_u32 m0, s40, 91136
s_add_u32 s43, s38, 245760
buffer_load_dwordx4 v3, s[12:15], s43 offen lds
s_add_u32 m0, s40, 92160
s_add_u32 s43, s38, 294912
buffer_load_dwordx4 v2, s[12:15], s43 offen lds
s_add_u32 m0, s40, 93184
s_add_u32 s43, s38, 344064
buffer_load_dwordx4 v3, s[12:15], s43 offen lds
s_add_u32 s37, s37, 128
s_add_u32 s38, s38, 393216
s_load_dword s3, s[4:5], 192
s_load_dword s3, s[4:5], 7168
s_load_dword s3, s[4:5], 7232
s_load_dword s3, s[4:5], 7296
s_load_dword s3, s[4:5], 7360
Lsp_11:
s_waitcnt vmcnt(14)
s_barrier
s_add_u32 m0, s39, 0
s_mov_b64 exec, s[60:61]
buffer_load_dwordx4 v4, s[8:11], s37 offen lds
s_mov_b64 exec, -1
s_add_u32 m0, s39, 3072
s_nop 0
buffer_load_dwordx4 v5, s[8:11], s37 offen lds
s_add_u32 m0, s39, 6144
s_nop 0
buffer_load_dwordx4 v6, s[8:11], s37 offen lds
s_branch Lov_0
.p2align 12
Lst_0_0:
s_branch Lwr_160
s_nop 0
s_nop 0
Lov_0:
s_add_u32 m0, s39, 9216
s_nop 0
buffer_load_dwordx4 v7, s[8:11], s37 offen lds
s_add_u32 m0, s39, 12288
s_nop 0
buffer_load_dwordx4 v8, s[8:11], s37 offen lds
s_add_u32 m0, s39, 15360
s_nop 0
buffer_load_dwordx4 v9, s[8:11], s37 offen lds
s_add_u32 m0, s40, 0
s_add_u32 s43, s38, 0
buffer_load_dwordx4 v2, s[12:15], s43 offen lds
s_add_u32 m0, s40, 1024
s_add_u32 s43, s38, 49152
buffer_load_dwordx4 v3, s[12:15], s43 offen lds
s_add_u32 m0, s40, 2048
s_add_u32 s43, s38, 98304
buffer_load_dwordx4 v2, s[12:15], s43 offen lds
s_add_u32 m0, s40, 3072
s_add_u32 s43, s38, 147456
buffer_load_dwordx4 v3, s[12:15], s43 offen lds
s_add_u32 m0, s40, 4096
s_add_u32 s43, s38, 196608
buffer_load_dwordx4 v2, s[12:15], s43 offen lds
s_add_u32 m0, s40, 5120
s_add_u32 s43, s38, 245760
buffer_load_dwordx4 v3, s[12:15], s43 offen lds
s_add_u32 m0, s40, 6144
s_add_u32 s43, s38, 294912
buffer_load_dwordx4 v2, s[12:15], s43 offen lds
s_add_u32 m0, s40, 7168
s_add_u32 s43, s38, 344064
buffer_load_dwordx4 v3, s[12:15], s43 offen lds
s_add_u32 s37, s37, 128
s_add_u32 s38, s38, 393216
s_load_dword s3, s[4:5], 14336
s_load_dword s3, s[4:5], 14400
s_load_dword s3, s[4:5], 14464
s_load_dword s3, s[4:5], 14528
s_load_dword s3, s[4:5], 21504
s_load_dword s3, s[4:5], 21568
Lsp_12:
s_waitcnt vmcnt(14)
s_barrier
s_add_u32 m0, s39, 43008
s_mov_b64 exec, s[60:61]
buffer_load_dwordx4 v4, s[8:11], s37 offen lds
s_mov_b64 exec, -1
s_add_u32 m0, s39, 46080
s_nop 0
buffer_load_dwordx4 v5, s[8:11], s37 offen lds
s_add_u32 m0, s39, 49152
s_nop 0
buffer_load_dwordx4 v6, s[8:11], s37 offen lds
s_add_u32 m0, s39, 52224
s_nop 0
buffer_load_dwordx4 v7, s[8:11], s37 offen lds
s_add_u32 m0, s39, 55296
s_nop 0
buffer_load_dwordx4 v8, s[8:11], s37 offen lds
s_add_u32 m0, s39, 58368
s_nop 0
buffer_load_dwordx4 v9, s[8:11], s37 offen lds
s_add_u32 m0, s40, 43008
s_add_u32 s43, s38, 0
buffer_load_dwordx4 v2, s[12:15], s43 offen lds
s_add_u32 m0, s40, 44032
s_add_u32 s43, s38, 49152
buffer_load_dwordx4 v3, s[12:15], s43 offen lds
s_add_u32 m0, s40, 45056
s_add_u32 s43, s38, 98304
buffer_load_dwordx4 v2, s[12:15], s43 offen lds
s_add_u32 m0, s40, 46080
s_add_u32 s43, s38, 147456
buffer_load_dwordx4 v3, s[12:15], s43 offen lds
s_add_u32 m0, s40, 47104
s_add_u32 s43, s38, 196608
buffer_load_dwordx4 v2, s[12:15], s43 offen lds
s_add_u32 m0, s40, 48128
s_add_u32 s43, s38, 245760
buffer_load_dwordx4 v3, s[12:15], s43 offen lds
s_add_u32 m0, s40, 49152
s_add_u32 s43, s38, 294912
buffer_load_dwordx4 v2, s[12:15], s43 offen lds
s_add_u32 m0, s40, 50176
s_add_u32 s43, s38, 344064
buffer_load_dwordx4 v3, s[12:15], s43 offen lds
s_add_u32 s37, s37, 128
s_add_u32 s38, s38, 393216
s_load_dword s3, s[4:5], 21632
s_load_dword s3, s[4:5], 21696
s_load_dword s3, s[4:5], 28672
s_load_dword s3, s[4:5], 28736
s_load_dword s3, s[4:5], 28800
s_load_dword s3, s[4:5], 28864
s_load_dword s3, s[4:5], 35840
Lsp_13:
s_waitcnt vmcnt(14)
s_barrier
s_add_u32 m0, s39, 86016
s_mov_b64 exec, s[60:61]
buffer_load_dwordx4 v4, s[8:11], s37 offen lds
s_mov_b64 exec, -1
s_add_u32 m0, s39, 89088
s_nop 0
buffer_load_dwordx4 v5, s[8:11], s37 offen lds
s_add_u32 m0, s39, 92160
s_nop 0
buffer_load_dwordx4 v6, s[8:11], s37 offen lds
s_add_u32 m0, s39, 95232
s_nop 0
buffer_load_dwordx4 v7, s[8:11], s37 offen lds
s_add_u32 m0, s39, 98304
s_nop 0
buffer_load_dwordx4 v8, s[8:11], s37 offen lds
s_add_u32 m0, s39, 101376
s_nop 0
buffer_load_dwordx4 v9, s[8:11], s37 offen lds
s_add_u32 m0, s40, 86016
s_add_u32 s43, s38, 0
buffer_load_dwordx4 v2, s[12:15], s43 offen lds
s_add_u32 m0, s40, 87040
s_add_u32 s43, s38, 49152
buffer_load_dwordx4 v3, s[12:15], s43 offen lds
s_add_u32 m0, s40, 88064
s_add_u32 s43, s38, 98304
buffer_load_dwordx4 v2, s[12:15], s43 offen lds
s_add_u32 m0, s40, 89088
s_add_u32 s43, s38, 147456
buffer_load_dwordx4 v3, s[12:15], s43 offen lds
s_add_u32 m0, s40, 90112
s_add_u32 s43, s38, 196608
buffer_load_dwordx4 v2, s[12:15], s43 offen lds
s_add_u32 m0, s40, 91136
s_add_u32 s43, s38, 245760
buffer_load_dwordx4 v3, s[12:15], s43 offen lds
s_add_u32 m0, s40, 92160
s_add_u32 s43, s38, 294912
buffer_load_dwordx4 v2, s[12:15], s43 offen lds
s_add_u32 m0, s40, 93184
s_add_u32 s43, s38, 344064
buffer_load_dwordx4 v3, s[12:15], s43 offen lds
s_add_u32 s37, s37, 128
s_add_u32 s38, s38, 393216
s_load_dword s3, s[4:5], 35904
s_load_dword s3, s[4:5], 35968
s_load_dword s3, s[4:5], 36032
s_load_dword s3, s[4:5], 43008
s_load_dword s3, s[4:5], 43072
s_load_dword s3, s[4:5], 43136
s_load_dword s3, s[4:5], 43200
s_load_dword s3, s[4:5], 50176
Lsp_14:
s_waitcnt vmcnt(14)
s_barrier
s_add_u32 m0, s39, 0
s_mov_b64 exec, s[60:61]
buffer_load_dwordx4 v4, s[8:11], s37 offen lds
s_mov_b64 exec, -1
s_add_u32 m0, s39, 3072
s_nop 0
buffer_load_dwordx4 v5, s[8:11], s37 offen lds
s_add_u32 m0, s39, 6144
s_nop 0
buffer_load_dwordx4 v6, s[8:11], s37 offen lds
s_add_u32 m0, s39, 9216
s_nop 0
buffer_load_dwordx4 v7, s[8:11], s37 offen lds
s_add_u32 m0, s39, 12288
s_nop 0
buffer_load_dwordx4 v8, s[8:11], s37 offen lds
s_add_u32 m0, s39, 15360
s_nop 0
buffer_load_dwordx4 v9, s[8:11], s37 offen lds
s_add_u32 m0, s40, 0
s_add_u32 s43, s38, 0
buffer_load_dwordx4 v2, s[12:15], s43 offen lds
s_add_u32 m0, s40, 1024
s_add_u32 s43, s38, 49152
buffer_load_dwordx4 v3, s[12:15], s43 offen lds
s_add_u32 m0, s40, 2048
s_add_u32 s43, s38, 98304
buffer_load_dwordx4 v2, s[12:15], s43 offen lds
s_add_u32 m0, s40, 3072
s_add_u32 s43, s38, 147456
buffer_load_dwordx4 v3, s[12:15], s43 offen lds
s_add_u32 m0, s40, 4096
s_add_u32 s43, s38, 196608
buffer_load_dwordx4 v2, s[12:15], s43 offen lds
s_add_u32 m0, s40, 5120
s_add_u32 s43, s38, 245760
buffer_load_dwordx4 v3, s[12:15], s43 offen lds
s_add_u32 m0, s40, 6144
s_add_u32 s43, s38, 294912
buffer_load_dwordx4 v2, s[12:15], s43 offen lds
s_add_u32 m0, s40, 7168
s_add_u32 s43, s38, 344064
buffer_load_dwordx4 v3, s[12:15], s43 offen lds
s_add_u32 s37, s37, 128
s_add_u32 s38, s38, 393216
s_load_dword s3, s[4:5], 50240
s_load_dword s3, s[4:5], 50304
s_load_dword s3, s[4:5], 50368
s_load_dword s3, s[4:5], 57344
s_load_dword s3, s[4:5], 57408
s_load_dword s3, s[4:5], 57472
s_load_dword s3, s[4:5], 57536
s_load_dword s3, s[4:5], 64512
s_load_dword s3, s[4:5], 64576
Lsp_15:
s_waitcnt vmcnt(14)
s_barrier
s_add_u32 m0, s39, 43008
s_mov_b64 exec, s[60:61]
buffer_load_dwordx4 v4, s[8:11], s37 offen lds
s_mov_b64 exec, -1
s_add_u32 m0, s39, 46080
s_nop 0
buffer_load_dwordx4 v5, s[8:11], s37 offen lds
s_add_u32 m0, s39, 49152
s_nop 0
buffer_load_dwordx4 v6, s[8:11], s37 offen lds
s_add_u32 m0, s39, 52224
s_nop 0
buffer_load_dwordx4 v7, s[8:11], s37 offen lds
s_add_u32 m0, s39, 55296
s_nop 0
buffer_load_dwordx4 v8, s[8:11], s37 offen lds
s_add_u32 m0, s39, 58368
s_nop 0
buffer_load_dwordx4 v9, s[8:11], s37 offen lds
s_add_u32 m0, s40, 43008
s_add_u32 s43, s38, 0
buffer_load_dwordx4 v2, s[12:15], s43 offen lds
s_add_u32 m0, s40, 44032
s_add_u32 s43, s38, 49152
buffer_load_dwordx4 v3, s[12:15], s43 offen lds
s_add_u32 m0, s40, 45056
s_add_u32 s43, s38, 98304
buffer_load_dwordx4 v2, s[12:15], s43 offen lds
s_add_u32 m0, s40, 46080
s_add_u32 s43, s38, 147456
buffer_load_dwordx4 v3, s[12:15], s43 offen lds
s_add_u32 m0, s40, 47104
s_add_u32 s43, s38, 196608
buffer_load_dwordx4 v2, s[12:15], s43 offen lds
s_add_u32 m0, s40, 48128
s_add_u32 s43, s38, 245760
buffer_load_dwordx4 v3, s[12:15], s43 offen lds
s_add_u32 m0, s40, 49152
s_add_u32 s43, s38, 294912
buffer_load_dwordx4 v2, s[12:15], s43 offen lds
s_add_u32 m0, s40, 50176
s_add_u32 s43, s38, 344064
buffer_load_dwordx4 v3, s[12:15], s43 offen lds
s_add_u32 s37, s37, 128
s_add_u32 s38, s38, 393216
s_load_dword s3, s[4:5], 64640
s_load_dword s3, s[4:5], 64704
s_load_dword s3, s[4:5], 71680
s_load_dword s3, s[4:5], 71744
s_load_dword s3, s[4:5], 71808
s_load_dword s3, s[4:5], 71872
s_load_dword s3, s[4:5], 78848
s_load_dword s3, s[4:5], 78912
s_load_dword s3, s[4:5], 78976
s_load_dword s3, s[4:5], 79040
Lsp_16:
s_waitcnt vmcnt(14)
s_barrier
s_add_u32 m0, s39, 86016
s_mov_b64 exec, s[60:61]
buffer_load_dwordx4 v4, s[8:11], s37 offen lds
s_mov_b64 exec, -1
s_add_u32 m0, s39, 89088
s_nop 0
buffer_load_dwordx4 v5, s[8:11], s37 offen lds
s_add_u32 m0, s39, 92160
s_nop 0
buffer_load_dwordx4 v6, s[8:11], s37 offen lds
s_add_u32 m0, s39, 95232
s_nop 0
buffer_load_dwordx4 v7, s[8:11], s37 offen lds
s_add_u32 m0, s39, 98304
s_nop 0
buffer_load_dwordx4 v8, s[8:11], s37 offen lds
s_add_u32 m0, s39, 101376
s_nop 0
buffer_load_dwordx4 v9, s[8:11], s37 offen lds
s_add_u32 m0, s40, 86016
s_add_u32 s43, s38, 0
buffer_load_dwordx4 v2, s[12:15], s43 offen lds
s_add_u32 m0, s40, 87040
s_add_u32 s43, s38, 49152
buffer_load_dwordx4 v3, s[12:15], s43 offen lds
s_add_u32 m0, s40, 88064
s_add_u32 s43, s38, 98304
buffer_load_dwordx4 v2, s[12:15], s43 offen lds
s_add_u32 m0, s40, 89088
s_add_u32 s43, s38, 147456
buffer_load_dwordx4 v3, s[12:15], s43 offen lds
s_add_u32 m0, s40, 90112
s_add_u32 s43, s38, 196608
buffer_load_dwordx4 v2, s[12:15], s43 offen lds
s_add_u32 m0, s40, 91136
s_add_u32 s43, s38, 245760
buffer_load_dwordx4 v3, s[12:15], s43 offen lds
s_add_u32 m0, s40, 92160
s_add_u32 s43, s38, 294912
buffer_load_dwordx4 v2, s[12:15], s43 offen lds
s_add_u32 m0, s40, 93184
s_add_u32 s43, s38, 344064
buffer_load_dwordx4 v3, s[12:15], s43 offen lds
s_add_u32 s37, s37, 128
s_add_u32 s38, s38, 393216
s_load_dword s3, s[4:5], 86016
s_load_dword s3, s[4:5], 86080
s_load_dword s3, s[4:5], 86144
s_load_dword s3, s[4:5], 86208
s_load_dword s3, s[4:5], 93184
s_load_dword s3, s[4:5], 93248
s_load_dword s3, s[4:5], 93312
s_load_dword s3, s[4:5], 93376
s_load_dword s3, s[4:5], 100352
s_load_dword s3, s[4:5], 100416
Lsp_17:
s_waitcnt vmcnt(14)
s_barrier
s_add_u32 m0, s39, 0
s_mov_b64 exec, s[60:61]
buffer_load_dwordx4 v4, s[8:11], s37 offen lds
s_mov_b64 exec, -1
s_add_u32 m0, s39, 3072
s_nop 0
buffer_load_dwordx4 v5, s[8:11], s37 offen lds
s_add_u32 m0, s39, 6144
s_nop 0
buffer_load_dwordx4 v6, s[8:11], s37 offen lds
s_add_u32 m0, s39, 9216
s_nop 0
buffer_load_dwordx4 v7, s[8:11], s37 offen lds
s_add_u32 m0, s39, 12288
s_nop 0
buffer_load_dwordx4 v8, s[8:11], s37 offen lds
s_add_u32 m0, s39, 15360
s_nop 0
buffer_load_dwordx4 v9, s[8:11], s37 offen lds
s_add_u32 m0, s40, 0
s_add_u32 s43, s38, 0
buffer_load_dwordx4 v2, s[12:15], s43 offen lds
s_add_u32 m0, s40, 1024
s_add_u32 s43, s38, 49152
buffer_load_dwordx4 v3, s[12:15], s43 offen lds
s_add_u32 m0, s40, 2048
s_add_u32 s43, s38, 98304
buffer_load_dwordx4 v2, s[12:15], s43 offen lds
s_add_u32 m0, s40, 3072
s_add_u32 s43, s38, 147456
buffer_load_dwordx4 v3, s[12:15], s43 offen lds
s_add_u32 m0, s40, 4096
s_add_u32 s43, s38, 196608
buffer_load_dwordx4 v2, s[12:15], s43 offen lds
s_add_u32 m0, s40, 5120
s_add_u32 s43, s38, 245760
buffer_load_dwordx4 v3, s[12:15], s43 offen lds
s_add_u32 m0, s40, 6144
s_add_u32 s43, s38, 294912
buffer_load_dwordx4 v2, s[12:15], s43 offen lds
s_add_u32 m0, s40, 7168
s_add_u32 s43, s38, 344064
buffer_load_dwordx4 v3, s[12:15], s43 offen lds
s_add_u32 s37, s37, 128
s_add_u32 s38, s38, 393216
s_load_dword s3, s[4:5], 100480
s_load_dword s3, s[4:5], 100544
s_load_dword s3, s[4:5], 107520
s_load_dword s3, s[4:5], 107584
s_load_dword s3, s[4:5], 107648
s_load_dword s3, s[4:5], 107712
s_load_dword s3, s[4:5], 114688
s_load_dword s3, s[4:5], 114752
s_load_dword s3, s[4:5], 114816
s_load_dword s3, s[4:5], 114880
s_load_dword s3, s[4:5], 121856
Lsp_18:
s_waitcnt vmcnt(14)
s_barrier
s_add_u32 m0, s39, 43008
s_mov_b64 exec, s[60:61]
buffer_load_dwordx4 v4, s[8:11], s37 offen lds
s_mov_b64 exec, -1
s_add_u32 m0, s39, 46080
s_nop 0
buffer_load_dwordx4 v5, s[8:11], s37 offen lds
s_add_u32 m0, s39, 49152
s_nop 0
buffer_load_dwordx4 v6, s[8:11], s37 offen lds
s_add_u32 m0, s39, 52224
s_nop 0
buffer_load_dwordx4 v7, s[8:11], s37 offen lds
s_add_u32 m0, s39, 55296
s_nop 0
buffer_load_dwordx4 v8, s[8:11], s37 offen lds
s_add_u32 m0, s39, 58368
s_nop 0
buffer_load_dwordx4 v9, s[8:11], s37 offen lds
s_add_u32 m0, s40, 43008
s_add_u32 s43, s38, 0
buffer_load_dwordx4 v2, s[12:15], s43 offen lds
s_add_u32 m0, s40, 44032
s_add_u32 s43, s38, 49152
buffer_load_dwordx4 v3, s[12:15], s43 offen lds
s_add_u32 m0, s40, 45056
s_add_u32 s43, s38, 98304
buffer_load_dwordx4 v2, s[12:15], s43 offen lds
s_add_u32 m0, s40, 46080
s_add_u32 s43, s38, 147456
buffer_load_dwordx4 v3, s[12:15], s43 offen lds
s_add_u32 m0, s40, 47104
s_add_u32 s43, s38, 196608
buffer_load_dwordx4 v2, s[12:15], s43 offen lds
s_add_u32 m0, s40, 48128
s_add_u32 s43, s38, 245760
buffer_load_dwordx4 v3, s[12:15], s43 offen lds
s_add_u32 m0, s40, 49152
s_add_u32 s43, s38, 294912
buffer_load_dwordx4 v2, s[12:15], s43 offen lds
s_add_u32 m0, s40, 50176
s_add_u32 s43, s38, 344064
buffer_load_dwordx4 v3, s[12:15], s43 offen lds
s_add_u32 s37, s37, 128
s_add_u32 s38, s38, 393216
s_load_dword s3, s[4:5], 121920
s_load_dword s3, s[4:5], 121984
s_load_dword s3, s[4:5], 122048
s_load_dword s3, s[4:5], 129024
s_load_dword s3, s[4:5], 129088
s_load_dword s3, s[4:5], 129152
s_load_dword s3, s[4:5], 129216
s_load_dword s3, s[4:5], 136192
s_load_dword s3, s[4:5], 136256
s_load_dword s3, s[4:5], 136320
s_load_dword s3, s[4:5], 136384
Lsp_19:
s_waitcnt vmcnt(14)
s_barrier
s_add_u32 m0, s39, 86016
s_mov_b64 exec, s[60:61]
buffer_load_dwordx4 v4, s[8:11], s37 offen lds
s_mov_b64 exec, -1
s_add_u32 m0, s39, 89088
s_nop 0
buffer_load_dwordx4 v5, s[8:11], s37 offen lds
s_add_u32 m0, s39, 92160
s_nop 0
buffer_load_dwordx4 v6, s[8:11], s37 offen lds
s_add_u32 m0, s39, 95232
s_nop 0
buffer_load_dwordx4 v7, s[8:11], s37 offen lds
s_add_u32 m0, s39, 98304
s_nop 0
buffer_load_dwordx4 v8, s[8:11], s37 offen lds
s_add_u32 m0, s39, 101376
s_nop 0
buffer_load_dwordx4 v9, s[8:11], s37 offen lds
s_add_u32 m0, s40, 86016
s_add_u32 s43, s38, 0
buffer_load_dwordx4 v2, s[12:15], s43 offen lds
s_add_u32 m0, s40, 87040
s_add_u32 s43, s38, 49152
buffer_load_dwordx4 v3, s[12:15], s43 offen lds
s_add_u32 m0, s40, 88064
s_add_u32 s43, s38, 98304
buffer_load_dwordx4 v2, s[12:15], s43 offen lds
s_add_u32 m0, s40, 89088
s_add_u32 s43, s38, 147456
buffer_load_dwordx4 v3, s[12:15], s43 offen lds
s_add_u32 m0, s40, 90112
s_add_u32 s43, s38, 196608
buffer_load_dwordx4 v2, s[12:15], s43 offen lds
s_add_u32 m0, s40, 91136
s_add_u32 s43, s38, 245760
buffer_load_dwordx4 v3, s[12:15], s43 offen lds
s_add_u32 m0, s40, 92160
s_add_u32 s43, s38, 294912
buffer_load_dwordx4 v2, s[12:15], s43 offen lds
s_add_u32 m0, s40, 93184
s_add_u32 s43, s38, 344064
buffer_load_dwordx4 v3, s[12:15], s43 offen lds
s_add_u32 s37, s37, 128
s_add_u32 s38, s38, 393216
s_load_dword s3, s[4:5], 143360
s_load_dword s3, s[4:5], 143424
s_load_dword s3, s[4:5], 143488
s_load_dword s3, s[4:5], 143552
s_load_dword s3, s[4:5], 150528
s_load_dword s3, s[4:5], 150592
s_load_dword s3, s[4:5], 150656
s_load_dword s3, s[4:5], 150720
s_load_dword s3, s[4:5], 157696
s_load_dword s3, s[4:5], 157760
s_load_dword s3, s[4:5], 157824
Lsp_20:
s_waitcnt vmcnt(14)
s_barrier
s_add_u32 m0, s39, 0
s_mov_b64 exec, s[60:61]
buffer_load_dwordx4 v4, s[8:11], s37 offen lds
s_mov_b64 exec, -1
s_add_u32 m0, s39, 3072
s_nop 0
buffer_load_dwordx4 v5, s[8:11], s37 offen lds
s_add_u32 m0, s39, 6144
s_nop 0
buffer_load_dwordx4 v6, s[8:11], s37 offen lds
s_add_u32 m0, s39, 9216
s_nop 0
buffer_load_dwordx4 v7, s[8:11], s37 offen lds
s_add_u32 m0, s39, 12288
s_nop 0
buffer_load_dwordx4 v8, s[8:11], s37 offen lds
s_add_u32 m0, s39, 15360
s_nop 0
buffer_load_dwordx4 v9, s[8:11], s37 offen lds
s_add_u32 m0, s40, 0
s_add_u32 s43, s38, 0
buffer_load_dwordx4 v2, s[12:15], s43 offen lds
s_add_u32 m0, s40, 1024
s_add_u32 s43, s38, 49152
buffer_load_dwordx4 v3, s[12:15], s43 offen lds
s_add_u32 m0, s40, 2048
s_add_u32 s43, s38, 98304
buffer_load_dwordx4 v2, s[12:15], s43 offen lds
s_add_u32 m0, s40, 3072
s_add_u32 s43, s38, 147456
buffer_load_dwordx4 v3, s[12:15], s43 offen lds
s_add_u32 m0, s40, 4096
s_add_u32 s43, s38, 196608
buffer_load_dwordx4 v2, s[12:15], s43 offen lds
s_add_u32 m0, s40, 5120
s_add_u32 s43, s38, 245760
buffer_load_dwordx4 v3, s[12:15], s43 offen lds
s_add_u32 m0, s40, 6144
s_add_u32 s43, s38, 294912
buffer_load_dwordx4 v2, s[12:15], s43 offen lds
s_add_u32 m0, s40, 7168
s_add_u32 s43, s38, 344064
buffer_load_dwordx4 v3, s[12:15], s43 offen lds
s_add_u32 s37, s37, 128
s_add_u32 s38, s38, 393216
s_load_dword s3, s[4:5], 157888
s_load_dword s3, s[4:5], 164864
s_load_dword s3, s[4:5], 164928
s_load_dword s3, s[4:5], 164992
s_load_dword s3, s[4:5], 165056
s_load_dword s3, s[4:5], 172032
s_load_dword s3, s[4:5], 172096
s_load_dword s3, s[4:5], 172160
s_load_dword s3, s[4:5], 172224
s_load_dword s3, s[4:5], 179200
s_load_dword s3, s[4:5], 179264
Lsp_21:
s_waitcnt vmcnt(14)
s_barrier
s_load_dword s3, s[4:5], 179328
s_load_dword s3, s[4:5], 179392
s_load_dword s3, s[4:5], 186368
s_load_dword s3, s[4:5], 186432
s_load_dword s3, s[4:5], 186496
s_load_dword s3, s[4:5], 186560
s_load_dword s3, s[4:5], 193536
s_branch Lov_1
.p2align 12
Lst_1_0:
s_branch Lwr_161
s_nop 0
s_nop 0
Lov_1:
s_load_dword s3, s[4:5], 193600
s_load_dword s3, s[4:5], 193664
s_load_dword s3, s[4:5], 193728
Lsp_22:
s_waitcnt vmcnt(0)
s_barrier
s_bitcmp0_b32 s2, 0
s_cselect_b32 s88, s72, s74
s_cselect_b32 s89, s73, s75
s_cmp_lt_u32 s2, 192
s_cselect_b32 s90, 7340032, 0
s_mov_b32 s91, 0x20000
s_bfe_u32 s44, s2, 0x30001
s_lshl_b32 s44, s44, 2
s_and_b32 s43, s36, 3
s_add_u32 s44, s44, s43
s_lshl_b32 s44, s44, 5
v_lshrrev_b32 v18, 4, v1
v_add_u32 v18, s44, v18
v_mul_u32_u24 v18, 7168, v18
v_and_b32 v19, 15, v1
v_lshl_add_u32 v18, v19, 4, v18
s_lshr_b32 s43, s2, 4
s_lshl_b32 s43, s43, 8
s_add_u32 s43, s43, 4096
v_add_u32 v18, s43, v18
s_mov_b32 s43, 0
buffer_load_dwordx4 v[128:131], v18, s[88:91], s43 offen
s_mov_b32 s43, 28672
buffer_load_dwordx4 v[132:135], v18, s[88:91], s43 offen
s_mov_b32 s43, 57344
buffer_load_dwordx4 v[136:139], v18, s[88:91], s43 offen
s_mov_b32 s43, 86016
buffer_load_dwordx4 v[140:143], v18, s[88:91], s43 offen
s_mov_b32 s43, 114688
buffer_load_dwordx4 v[144:147], v18, s[88:91], s43 offen
s_mov_b32 s43, 143360
buffer_load_dwordx4 v[148:151], v18, s[88:91], s43 offen
s_mov_b32 s43, 172032
buffer_load_dwordx4 v[152:155], v18, s[88:91], s43 offen
s_mov_b32 s43, 200704
buffer_load_dwordx4 v[156:159], v18, s[88:91], s43 offen
s_barrier
s_lshl_b32 s43, s35, 7
s_add_u32 s28, s68, s43
s_addc_u32 s29, s69, 0
s_mov_b32 s30, 2095232
s_mov_b32 s31, 0x20000
v_lshrrev_b32 v15, 3, v1
v_and_b32 v16, 6, v15
v_and_b32 v7, 7, v1
v_xor_b32 v7, v7, v16
v_lshlrev_b32 v7, 4, v7
v_mul_u32_u24 v15, 2048, v15
v_add_u32 v7, v7, v15
s_and_b32 s40, s36, 3
s_lshl_b32 s39, s40, 13
s_add_u32 s40, s40, s35
s_add_u32 s42, s40, 0
s_and_b32 s42, s42, 15
s_lshl_b32 s42, s42, 17
s_add_u32 m0, s39, 65536
s_add_u32 s43, s42, 0
buffer_load_dwordx4 v7, s[28:31], s43 offen lds
s_add_u32 m0, s39, 66560
s_add_u32 s43, s42, 16384
buffer_load_dwordx4 v7, s[28:31], s43 offen lds
s_add_u32 m0, s39, 67584
s_add_u32 s43, s42, 32768
buffer_load_dwordx4 v7, s[28:31], s43 offen lds
s_add_u32 m0, s39, 68608
s_add_u32 s43, s42, 49152
buffer_load_dwordx4 v7, s[28:31], s43 offen lds
s_add_u32 m0, s39, 69632
s_add_u32 s43, s42, 65536
buffer_load_dwordx4 v7, s[28:31], s43 offen lds
s_add_u32 m0, s39, 70656
s_add_u32 s43, s42, 81920
buffer_load_dwordx4 v7, s[28:31], s43 offen lds
s_add_u32 m0, s39, 71680
s_add_u32 s43, s42, 98304
buffer_load_dwordx4 v7, s[28:31], s43 offen lds
s_add_u32 m0, s39, 72704
s_add_u32 s43, s42, 114688
buffer_load_dwordx4 v7, s[28:31], s43 offen lds
s_branch Lats_6
Lcons_7:
s_lshl_b32 s43, s35, 7
s_waitcnt lgkmcnt(0)
s_mov_b32 s8, s64
s_mov_b32 s9, s65
s_mov_b32 s10, 4194304
s_mov_b32 s11, 0x20000
s_add_u32 s12, s66, s43
s_addc_u32 s13, s67, 0
s_mov_b32 s14, 6289536
s_mov_b32 s15, 0x20000
s_lshr_b32 s43, s2, 3
s_lshl_b32 s43, s43, 2
s_add_u32 s43, s43, s36
s_sub_u32 s44, s43, 0
s_and_b32 s44, s44, 127
s_cmp_lt_u32 s44, 24
s_cbranch_scc0 Lt_23
s_lshl_b32 s44, s44, 20
s_min_u32 s44, s44, 24117184
s_load_dword s3, s[82:83], s44 glc
Lt_23:
s_sub_u32 s44, s43, 24
s_and_b32 s44, s44, 127
s_cmp_lt_u32 s44, 8
s_cbranch_scc0 Lt_24
s_lshl_b32 s44, s44, 20
s_min_u32 s44, s44, 7339968
s_load_dword s3, s[72:73], s44
Lt_24:
s_sub_u32 s44, s43, 32
s_and_b32 s44, s44, 127
s_cmp_lt_u32 s44, 8
s_cbranch_scc0 Lt_25
s_lshl_b32 s44, s44, 20
s_min_u32 s44, s44, 7339968
s_load_dword s3, s[74:75], s44
Lt_25:
s_sub_u32 s44, s43, 40
s_and_b32 s44, s44, 127
s_cmp_lt_u32 s44, 3
s_cbranch_scc0 Lt_26
s_lshl_b32 s44, s44, 20
s_min_u32 s44, s44, 2097088
s_load_dword s3, s[68:69], s44
Lt_26:
s_sub_u32 s44, s43, 43
s_and_b32 s44, s44, 127
s_cmp_lt_u32 s44, 5
s_cbranch_scc0 Lt_27
s_lshl_b32 s44, s44, 20
s_min_u32 s44, s44, 4194240
s_add_u32 s44, s44, 25165824
s_load_dword s3, s[82:83], s44 glc
Lt_27:
s_sub_u32 s44, s43, 48
s_and_b32 s44, s44, 127
s_cmp_lt_u32 s44, 8
s_cbranch_scc0 Lt_28
s_lshl_b32 s44, s44, 20
s_min_u32 s44, s44, 7339968
s_load_dword s3, s[76:77], s44
Lt_28:
s_sub_u32 s44, s43, 56
s_and_b32 s44, s44, 127
s_cmp_lt_u32 s44, 5
s_cbranch_scc0 Lt_29
s_lshl_b32 s44, s44, 20
s_min_u32 s44, s44, 4194240
s_add_u32 s44, s44, 33554432
s_load_dword s3, s[82:83], s44 glc
Lt_29:
s_sub_u32 s44, s43, 61
s_and_b32 s44, s44, 127
s_cmp_lt_u32 s44, 5
s_cbranch_scc0 Lt_30
s_lshl_b32 s44, s44, 20
s_min_u32 s44, s44, 4194240
s_load_dword s3, s[78:79], s44 glc
Lt_30:
v_lshrrev_b32 v16, 1, v12
v_xor_b32 v15, v13, v16
v_lshlrev_b32 v15, 4, v15
v_lshl_add_u32 v2, v12, 7, v15
v_xor_b32 v3, 64, v2
v_add_u32 v4, 86016, v2
v_add_u32 v5, 86016, v3
v_lshrrev_b32 v15, 2, v12
v_and_b32 v16, 3, v1
v_lshl_add_u32 v19, v13, 3, v15
v_lshlrev_b32 v19, 7, v19
v_and_b32 v15, 2, v15
v_and_b32 v17, 1, v13
v_lshl_add_u32 v15, v17, 2, v15
v_lshrrev_b32 v17, 1, v16
s_lshl_b32 s43, s36, 1
v_add_u32 v17, s43, v17
v_xor_b32 v15, v15, v17
v_lshl_add_u32 v19, v15, 4, v19
v_and_b32 v16, 1, v16
v_lshl_add_u32 v19, v16, 3, v19
v_add_u32 v6, 18432, v19
v_add_u32 v7, 61440, v19
v_add_u32 v8, 104448, v19
s_and_b32 s43, s36, 1
s_bfe_u32 s44, s36, 0x10001
s_lshr_b32 s45, s36, 2
v_lshlrev_b32 v14, 2, v13
v_sub_u32 v14, v12, v14
v_mov_b32 v16, 0xff800000
s_or_b32 s46, s34, s45
s_cmp_lg_u32 s46, 0
s_cselect_b32 s46, 0, 0xff800000
v_subrev_u32 v15, 0, v14
v_cmp_ge_u32 vcc, 7, v15
v_add_u32 v15, 16, v15
s_nop 0
v_cndmask_b32 v248, v16, 0, vcc
v_cmp_ge_u32 vcc, 7, v15
s_nop 1
v_cndmask_b32 v244, v16, 0, vcc
v_or_b32 v240, s46, v244
v_subrev_u32 v15, 1, v14
v_cmp_ge_u32 vcc, 7, v15
v_add_u32 v15, 16, v15
s_nop 0
v_cndmask_b32 v249, v16, 0, vcc
v_cmp_ge_u32 vcc, 7, v15
s_nop 1
v_cndmask_b32 v245, v16, 0, vcc
v_or_b32 v241, s46, v245
v_subrev_u32 v15, 2, v14
v_cmp_ge_u32 vcc, 7, v15
v_add_u32 v15, 16, v15
s_nop 0
v_cndmask_b32 v250, v16, 0, vcc
v_cmp_ge_u32 vcc, 7, v15
s_nop 1
v_cndmask_b32 v246, v16, 0, vcc
v_or_b32 v242, s46, v246
v_subrev_u32 v15, 3, v14
v_cmp_ge_u32 vcc, 7, v15
v_add_u32 v15, 16, v15
s_nop 0
v_cndmask_b32 v251, v16, 0, vcc
v_cmp_ge_u32 vcc, 7, v15
s_nop 1
v_cndmask_b32 v247, v16, 0, vcc
v_or_b32 v243, s46, v247
s_lshl_b32 s46, s45, 6
s_add_u32 s46, s46, s44
s_add_u32 s46, s46, 16
v_lshl_add_u32 v14, v12, 1, s46
s_lshl_b32 s47, s43, 6
v_lshl_add_u32 v15, v13, 4, s47
v_mul_u32_u24 v20, 400, v14
v_add_u32 v20, v20, v15
v_subrev_u32 v16, 32, v14
v_max_i32 v16, 0, v16
v_mul_u32_u24 v21, 400, v16
v_add_u32 v21, v21, v15
v_lshrrev_b32 v16, 2, v12
v_lshl_add_u32 v16, v13, 2, v16
v_lshl_add_u32 v16, v16, 1, s46
v_and_b32 v17, 3, v1
v_lshl_add_u32 v17, v17, 3, s47
v_mul_u32_u24 v22, 400, v16
v_add_u32 v22, v22, v17
v_subrev_u32 v16, 32, v16
v_max_i32 v16, 0, v16
v_mul_u32_u24 v23, 400, v16
v_add_u32 v23, v23, v17
s_mul_i32 s60, s34, 262144
s_add_u32 s16, s82, s60
s_addc_u32 s17, s83, 0
s_mov_b32 s18, 262144
s_mov_b32 s19, 0x20000
s_lshl_b32 s60, s35, 14
s_lshl_b32 s43, s43, 13
s_add_u32 s60, s60, s43
s_lshl_b32 s43, s45, 12
s_add_u32 s60, s60, s43
s_lshl_b32 s43, s44, 10
s_add_u32 s60, s60, s43
v_lshlrev_b32 v24, 4, v1
s_mov_b32 s61, 0x3e8293ee
s_lshl_b32 s38, s35, 7
s_add_u32 s56, s82, 28311552
s_addc_u32 s57, s83, 0
s_mov_b32 s58, 114688
s_mov_b32 s59, 0x20000
s_barrier
ds_read_b128 v[32:35], v2 offset:0
ds_read_b64_tr_b16 v[72:73], v6 offset:8192
ds_read_b64_tr_b16 v[74:75], v6 offset:8704
ds_read_b64_tr_b16 v[76:77], v6 offset:16384
ds_read_b64_tr_b16 v[78:79], v6 offset:16896
ds_read_b64_tr_b16 v[68:69], v6 offset:0
ds_read_b64_tr_b16 v[70:71], v6 offset:512
ds_read_b128 v[36:39], v2 offset:2048
ds_read_b128 v[40:43], v2 offset:4096
ds_read_b128 v[44:47], v2 offset:6144
ds_read_b128 v[48:51], v2 offset:8192
ds_read_b128 v[52:55], v2 offset:10240
ds_read_b128 v[56:59], v2 offset:12288
ds_read_b128 v[60:63], v2 offset:14336
ds_read_b128 v[64:67], v2 offset:16384
s_waitcnt lgkmcnt(0)
v_mfma_f32_16x16x32_bf16 v[128:131], v[68:71], v[32:35], 0
ds_read_b128 v[80:83], v3 offset:0
v_mfma_f32_16x16x32_bf16 v[132:135], v[68:71], v[36:39], 0
ds_read_b64_tr_b16 v[120:121], v6 offset:12288
v_mfma_f32_16x16x32_bf16 v[136:139], v[68:71], v[40:43], 0
ds_read_b64_tr_b16 v[122:123], v6 offset:12800
v_mfma_f32_16x16x32_bf16 v[140:143], v[68:71], v[44:47], 0
ds_read_b64_tr_b16 v[124:125], v6 offset:20480
v_mfma_f32_16x16x32_bf16 v[144:147], v[68:71], v[48:51], 0
ds_read_b64_tr_b16 v[126:127], v6 offset:20992
v_mfma_f32_16x16x32_bf16 v[148:151], v[68:71], v[52:55], 0
ds_read_b64_tr_b16 v[116:117], v6 offset:4096
v_mfma_f32_16x16x32_bf16 v[152:155], v[68:71], v[56:59], 0
ds_read_b64_tr_b16 v[118:119], v6 offset:4608
v_mfma_f32_16x16x32_bf16 v[156:159], v[68:71], v[60:63], 0
ds_read_b128 v[84:87], v3 offset:2048
v_mfma_f32_16x16x32_bf16 v[160:163], v[68:71], v[64:67], 0
ds_read_b128 v[88:91], v3 offset:4096
v_mfma_f32_16x16x32_bf16 v[196:199], v[72:75], v[64:67], 0
ds_read_b128 v[92:95], v3 offset:6144
v_mfma_f32_16x16x32_bf16 v[192:195], v[72:75], v[60:63], 0
ds_read_b128 v[96:99], v3 offset:8192
v_mfma_f32_16x16x32_bf16 v[188:191], v[72:75], v[56:59], 0
ds_read_b128 v[100:103], v3 offset:10240
v_mfma_f32_16x16x32_bf16 v[184:187], v[72:75], v[52:55], 0
ds_read_b128 v[104:107], v3 offset:12288
v_mfma_f32_16x16x32_bf16 v[180:183], v[72:75], v[48:51], 0
ds_read_b128 v[108:111], v3 offset:14336
v_mfma_f32_16x16x32_bf16 v[176:179], v[72:75], v[44:47], 0
ds_read_b128 v[112:115], v3 offset:16384
v_mfma_f32_16x16x32_bf16 v[172:175], v[72:75], v[40:43], 0
v_mfma_f32_16x16x32_bf16 v[168:171], v[72:75], v[36:39], 0
v_mfma_f32_16x16x32_bf16 v[164:167], v[72:75], v[32:35], 0
v_mfma_f32_16x16x32_bf16 v[200:203], v[76:79], v[32:35], 0
v_mfma_f32_16x16x32_bf16 v[204:207], v[76:79], v[36:39], 0
v_mfma_f32_16x16x32_bf16 v[208:211], v[76:79], v[40:43], 0
v_mfma_f32_16x16x32_bf16 v[212:215], v[76:79], v[44:47], 0
v_mfma_f32_16x16x32_bf16 v[216:219], v[76:79], v[48:51], 0
v_mfma_f32_16x16x32_bf16 v[220:223], v[76:79], v[52:55], 0
v_mfma_f32_16x16x32_bf16 v[224:227], v[76:79], v[56:59], 0
v_mfma_f32_16x16x32_bf16 v[228:231], v[76:79], v[60:63], 0
v_mfma_f32_16x16x32_bf16 v[232:235], v[76:79], v[64:67], 0
s_waitcnt lgkmcnt(0)
s_barrier
v_mfma_f32_16x16x32_bf16 v[128:131], v[116:119], v[80:83], v[128:131]
ds_read_b128 v[32:35], v2 offset:43008
v_mfma_f32_16x16x32_bf16 v[132:135], v[116:119], v[84:87], v[132:135]
ds_read_b64_tr_b16 v[72:73], v7 offset:8192
v_mfma_f32_16x16x32_bf16 v[136:139], v[116:119], v[88:91], v[136:139]
ds_read_b64_tr_b16 v[74:75], v7 offset:8704
v_mfma_f32_16x16x32_bf16 v[140:143], v[116:119], v[92:95], v[140:143]
ds_read_b64_tr_b16 v[76:77], v7 offset:16384
v_mfma_f32_16x16x32_bf16 v[144:147], v[116:119], v[96:99], v[144:147]
ds_read_b64_tr_b16 v[78:79], v7 offset:16896
v_mfma_f32_16x16x32_bf16 v[148:151], v[116:119], v[100:103], v[148:151]
ds_read_b64_tr_b16 v[68:69], v7 offset:0
v_mfma_f32_16x16x32_bf16 v[152:155], v[116:119], v[104:107], v[152:155]
ds_read_b64_tr_b16 v[70:71], v7 offset:512
v_mfma_f32_16x16x32_bf16 v[156:159], v[116:119], v[108:111], v[156:159]
ds_read_b128 v[36:39], v2 offset:45056
v_mfma_f32_16x16x32_bf16 v[160:163], v[116:119], v[112:115], v[160:163]
ds_read_b128 v[40:43], v2 offset:47104
v_mfma_f32_16x16x32_bf16 v[196:199], v[120:123], v[112:115], v[196:199]
ds_read_b128 v[44:47], v2 offset:49152
v_mfma_f32_16x16x32_bf16 v[192:195], v[120:123], v[108:111], v[192:195]
ds_read_b128 v[48:51], v2 offset:51200
v_mfma_f32_16x16x32_bf16 v[188:191], v[120:123], v[104:107], v[188:191]
ds_read_b128 v[52:55], v2 offset:53248
v_mfma_f32_16x16x32_bf16 v[184:187], v[120:123], v[100:103], v[184:187]
ds_read_b128 v[56:59], v2 offset:55296
v_mfma_f32_16x16x32_bf16 v[180:183], v[120:123], v[96:99], v[180:183]
ds_read_b128 v[60:63], v2 offset:57344
v_mfma_f32_16x16x32_bf16 v[176:179], v[120:123], v[92:95], v[176:179]
ds_read_b128 v[64:67], v2 offset:59392
v_mfma_f32_16x16x32_bf16 v[172:175], v[120:123], v[88:91], v[172:175]
v_mfma_f32_16x16x32_bf16 v[168:171], v[120:123], v[84:87], v[168:171]
v_mfma_f32_16x16x32_bf16 v[164:167], v[120:123], v[80:83], v[164:167]
v_mfma_f32_16x16x32_bf16 v[200:203], v[124:127], v[80:83], v[200:203]
v_mfma_f32_16x16x32_bf16 v[204:207], v[124:127], v[84:87], v[204:207]
v_mfma_f32_16x16x32_bf16 v[208:211], v[124:127], v[88:91], v[208:211]
v_mfma_f32_16x16x32_bf16 v[212:215], v[124:127], v[92:95], v[212:215]
v_mfma_f32_16x16x32_bf16 v[216:219], v[124:127], v[96:99], v[216:219]
v_mfma_f32_16x16x32_bf16 v[220:223], v[124:127], v[100:103], v[220:223]
v_mfma_f32_16x16x32_bf16 v[224:227], v[124:127], v[104:107], v[224:227]
v_mfma_f32_16x16x32_bf16 v[228:231], v[124:127], v[108:111], v[228:231]
v_mfma_f32_16x16x32_bf16 v[232:235], v[124:127], v[112:115], v[232:235]
s_waitcnt lgkmcnt(0)
v_mfma_f32_16x16x32_bf16 v[128:131], v[68:71], v[32:35], v[128:131]
ds_read_b128 v[80:83], v3 offset:43008
v_mfma_f32_16x16x32_bf16 v[132:135], v[68:71], v[36:39], v[132:135]
ds_read_b64_tr_b16 v[120:121], v7 offset:12288
v_mfma_f32_16x16x32_bf16 v[136:139], v[68:71], v[40:43], v[136:139]
ds_read_b64_tr_b16 v[122:123], v7 offset:12800
v_mfma_f32_16x16x32_bf16 v[140:143], v[68:71], v[44:47], v[140:143]
ds_read_b64_tr_b16 v[124:125], v7 offset:20480
v_mfma_f32_16x16x32_bf16 v[144:147], v[68:71], v[48:51], v[144:147]
ds_read_b64_tr_b16 v[126:127], v7 offset:20992
v_mfma_f32_16x16x32_bf16 v[148:151], v[68:71], v[52:55], v[148:151]
ds_read_b64_tr_b16 v[116:117], v7 offset:4096
v_mfma_f32_16x16x32_bf16 v[152:155], v[68:71], v[56:59], v[152:155]
ds_read_b64_tr_b16 v[118:119], v7 offset:4608
v_mfma_f32_16x16x32_bf16 v[156:159], v[68:71], v[60:63], v[156:159]
ds_read_b128 v[84:87], v3 offset:45056
v_mfma_f32_16x16x32_bf16 v[160:163], v[68:71], v[64:67], v[160:163]
ds_read_b128 v[88:91], v3 offset:47104
v_mfma_f32_16x16x32_bf16 v[196:199], v[72:75], v[64:67], v[196:199]
ds_read_b128 v[92:95], v3 offset:49152
v_mfma_f32_16x16x32_bf16 v[192:195], v[72:75], v[60:63], v[192:195]
ds_read_b128 v[96:99], v3 offset:51200
v_mfma_f32_16x16x32_bf16 v[188:191], v[72:75], v[56:59], v[188:191]
ds_read_b128 v[100:103], v3 offset:53248
v_mfma_f32_16x16x32_bf16 v[184:187], v[72:75], v[52:55], v[184:187]
ds_read_b128 v[104:107], v3 offset:55296
v_mfma_f32_16x16x32_bf16 v[180:183], v[72:75], v[48:51], v[180:183]
ds_read_b128 v[108:111], v3 offset:57344
v_mfma_f32_16x16x32_bf16 v[176:179], v[72:75], v[44:47], v[176:179]
ds_read_b128 v[112:115], v3 offset:59392
v_mfma_f32_16x16x32_bf16 v[172:175], v[72:75], v[40:43], v[172:175]
v_mfma_f32_16x16x32_bf16 v[168:171], v[72:75], v[36:39], v[168:171]
v_mfma_f32_16x16x32_bf16 v[164:167], v[72:75], v[32:35], v[164:167]
v_mfma_f32_16x16x32_bf16 v[200:203], v[76:79], v[32:35], v[200:203]
v_mfma_f32_16x16x32_bf16 v[204:207], v[76:79], v[36:39], v[204:207]
v_mfma_f32_16x16x32_bf16 v[208:211], v[76:79], v[40:43], v[208:211]
v_mfma_f32_16x16x32_bf16 v[212:215], v[76:79], v[44:47], v[212:215]
v_mfma_f32_16x16x32_bf16 v[216:219], v[76:79], v[48:51], v[216:219]
v_mfma_f32_16x16x32_bf16 v[220:223], v[76:79], v[52:55], v[220:223]
v_mfma_f32_16x16x32_bf16 v[224:227], v[76:79], v[56:59], v[224:227]
v_mfma_f32_16x16x32_bf16 v[228:231], v[76:79], v[60:63], v[228:231]
v_mfma_f32_16x16x32_bf16 v[232:235], v[76:79], v[64:67], v[232:235]
s_waitcnt lgkmcnt(0)
s_barrier
v_mfma_f32_16x16x32_bf16 v[128:131], v[116:119], v[80:83], v[128:131]
ds_read_b128 v[32:35], v4 offset:0
v_mfma_f32_16x16x32_bf16 v[132:135], v[116:119], v[84:87], v[132:135]
ds_read_b64_tr_b16 v[72:73], v8 offset:8192
v_mfma_f32_16x16x32_bf16 v[136:139], v[116:119], v[88:91], v[136:139]
ds_read_b64_tr_b16 v[74:75], v8 offset:8704
v_mfma_f32_16x16x32_bf16 v[140:143], v[116:119], v[92:95], v[140:143]
ds_read_b64_tr_b16 v[76:77], v8 offset:16384
v_mfma_f32_16x16x32_bf16 v[144:147], v[116:119], v[96:99], v[144:147]
ds_read_b64_tr_b16 v[78:79], v8 offset:16896
v_mfma_f32_16x16x32_bf16 v[148:151], v[116:119], v[100:103], v[148:151]
ds_read_b64_tr_b16 v[68:69], v8 offset:0
v_mfma_f32_16x16x32_bf16 v[152:155], v[116:119], v[104:107], v[152:155]
ds_read_b64_tr_b16 v[70:71], v8 offset:512
v_mfma_f32_16x16x32_bf16 v[156:159], v[116:119], v[108:111], v[156:159]
ds_read_b128 v[36:39], v4 offset:2048
v_mfma_f32_16x16x32_bf16 v[160:163], v[116:119], v[112:115], v[160:163]
ds_read_b128 v[40:43], v4 offset:4096
v_mfma_f32_16x16x32_bf16 v[196:199], v[120:123], v[112:115], v[196:199]
ds_read_b128 v[44:47], v4 offset:6144
v_mfma_f32_16x16x32_bf16 v[192:195], v[120:123], v[108:111], v[192:195]
ds_read_b128 v[48:51], v4 offset:8192
v_mfma_f32_16x16x32_bf16 v[188:191], v[120:123], v[104:107], v[188:191]
ds_read_b128 v[52:55], v4 offset:10240
v_mfma_f32_16x16x32_bf16 v[184:187], v[120:123], v[100:103], v[184:187]
ds_read_b128 v[56:59], v4 offset:12288
v_mfma_f32_16x16x32_bf16 v[180:183], v[120:123], v[96:99], v[180:183]
ds_read_b128 v[60:63], v4 offset:14336
v_mfma_f32_16x16x32_bf16 v[176:179], v[120:123], v[92:95], v[176:179]
ds_read_b128 v[64:67], v4 offset:16384
v_mfma_f32_16x16x32_bf16 v[172:175], v[120:123], v[88:91], v[172:175]
v_mfma_f32_16x16x32_bf16 v[168:171], v[120:123], v[84:87], v[168:171]
v_mfma_f32_16x16x32_bf16 v[164:167], v[120:123], v[80:83], v[164:167]
v_mfma_f32_16x16x32_bf16 v[200:203], v[124:127], v[80:83], v[200:203]
v_mfma_f32_16x16x32_bf16 v[204:207], v[124:127], v[84:87], v[204:207]
v_mfma_f32_16x16x32_bf16 v[208:211], v[124:127], v[88:91], v[208:211]
v_mfma_f32_16x16x32_bf16 v[212:215], v[124:127], v[92:95], v[212:215]
v_mfma_f32_16x16x32_bf16 v[216:219], v[124:127], v[96:99], v[216:219]
v_mfma_f32_16x16x32_bf16 v[220:223], v[124:127], v[100:103], v[220:223]
v_mfma_f32_16x16x32_bf16 v[224:227], v[124:127], v[104:107], v[224:227]
v_mfma_f32_16x16x32_bf16 v[228:231], v[124:127], v[108:111], v[228:231]
v_mfma_f32_16x16x32_bf16 v[232:235], v[124:127], v[112:115], v[232:235]
s_waitcnt lgkmcnt(0)
v_mfma_f32_16x16x32_bf16 v[128:131], v[68:71], v[32:35], v[128:131]
ds_read_b128 v[80:83], v5 offset:0
v_mfma_f32_16x16x32_bf16 v[132:135], v[68:71], v[36:39], v[132:135]
ds_read_b64_tr_b16 v[120:121], v8 offset:12288
v_mfma_f32_16x16x32_bf16 v[136:139], v[68:71], v[40:43], v[136:139]
ds_read_b64_tr_b16 v[122:123], v8 offset:12800
v_mfma_f32_16x16x32_bf16 v[140:143], v[68:71], v[44:47], v[140:143]
ds_read_b64_tr_b16 v[124:125], v8 offset:20480
v_mfma_f32_16x16x32_bf16 v[144:147], v[68:71], v[48:51], v[144:147]
ds_read_b64_tr_b16 v[126:127], v8 offset:20992
v_mfma_f32_16x16x32_bf16 v[148:151], v[68:71], v[52:55], v[148:151]
ds_read_b64_tr_b16 v[116:117], v8 offset:4096
v_mfma_f32_16x16x32_bf16 v[152:155], v[68:71], v[56:59], v[152:155]
ds_read_b64_tr_b16 v[118:119], v8 offset:4608
v_mfma_f32_16x16x32_bf16 v[156:159], v[68:71], v[60:63], v[156:159]
ds_read_b128 v[84:87], v5 offset:2048
v_mfma_f32_16x16x32_bf16 v[160:163], v[68:71], v[64:67], v[160:163]
ds_read_b128 v[88:91], v5 offset:4096
v_mfma_f32_16x16x32_bf16 v[196:199], v[72:75], v[64:67], v[196:199]
ds_read_b128 v[92:95], v5 offset:6144
v_mfma_f32_16x16x32_bf16 v[192:195], v[72:75], v[60:63], v[192:195]
ds_read_b128 v[96:99], v5 offset:8192
v_mfma_f32_16x16x32_bf16 v[188:191], v[72:75], v[56:59], v[188:191]
ds_read_b128 v[100:103], v5 offset:10240
v_mfma_f32_16x16x32_bf16 v[184:187], v[72:75], v[52:55], v[184:187]
ds_read_b128 v[104:107], v5 offset:12288
v_mfma_f32_16x16x32_bf16 v[180:183], v[72:75], v[48:51], v[180:183]
ds_read_b128 v[108:111], v5 offset:14336
v_mfma_f32_16x16x32_bf16 v[176:179], v[72:75], v[44:47], v[176:179]
ds_read_b128 v[112:115], v5 offset:16384
v_mfma_f32_16x16x32_bf16 v[172:175], v[72:75], v[40:43], v[172:175]
v_mfma_f32_16x16x32_bf16 v[168:171], v[72:75], v[36:39], v[168:171]
v_mfma_f32_16x16x32_bf16 v[164:167], v[72:75], v[32:35], v[164:167]
v_mfma_f32_16x16x32_bf16 v[200:203], v[76:79], v[32:35], v[200:203]
v_mfma_f32_16x16x32_bf16 v[204:207], v[76:79], v[36:39], v[204:207]
v_mfma_f32_16x16x32_bf16 v[208:211], v[76:79], v[40:43], v[208:211]
v_mfma_f32_16x16x32_bf16 v[212:215], v[76:79], v[44:47], v[212:215]
v_mfma_f32_16x16x32_bf16 v[216:219], v[76:79], v[48:51], v[216:219]
v_mfma_f32_16x16x32_bf16 v[220:223], v[76:79], v[52:55], v[220:223]
v_mfma_f32_16x16x32_bf16 v[224:227], v[76:79], v[56:59], v[224:227]
v_mfma_f32_16x16x32_bf16 v[228:231], v[76:79], v[60:63], v[228:231]
v_mfma_f32_16x16x32_bf16 v[232:235], v[76:79], v[64:67], v[232:235]
s_waitcnt lgkmcnt(0)
s_barrier
v_mfma_f32_16x16x32_bf16 v[128:131], v[116:119], v[80:83], v[128:131]
ds_read_b128 v[32:35], v2 offset:0
v_mfma_f32_16x16x32_bf16 v[132:135], v[116:119], v[84:87], v[132:135]
ds_read_b64_tr_b16 v[72:73], v6 offset:8192
v_mfma_f32_16x16x32_bf16 v[136:139], v[116:119], v[88:91], v[136:139]
ds_read_b64_tr_b16 v[74:75], v6 offset:8704
v_mfma_f32_16x16x32_bf16 v[140:143], v[116:119], v[92:95], v[140:143]
ds_read_b64_tr_b16 v[76:77], v6 offset:16384
v_mfma_f32_16x16x32_bf16 v[144:147], v[116:119], v[96:99], v[144:147]
ds_read_b64_tr_b16 v[78:79], v6 offset:16896
v_mfma_f32_16x16x32_bf16 v[148:151], v[116:119], v[100:103], v[148:151]
ds_read_b64_tr_b16 v[68:69], v6 offset:0
v_mfma_f32_16x16x32_bf16 v[152:155], v[116:119], v[104:107], v[152:155]
ds_read_b64_tr_b16 v[70:71], v6 offset:512
v_mfma_f32_16x16x32_bf16 v[156:159], v[116:119], v[108:111], v[156:159]
ds_read_b128 v[36:39], v2 offset:2048
v_mfma_f32_16x16x32_bf16 v[160:163], v[116:119], v[112:115], v[160:163]
ds_read_b128 v[40:43], v2 offset:4096
v_mfma_f32_16x16x32_bf16 v[196:199], v[120:123], v[112:115], v[196:199]
ds_read_b128 v[44:47], v2 offset:6144
v_mfma_f32_16x16x32_bf16 v[192:195], v[120:123], v[108:111], v[192:195]
ds_read_b128 v[48:51], v2 offset:8192
v_mfma_f32_16x16x32_bf16 v[188:191], v[120:123], v[104:107], v[188:191]
ds_read_b128 v[52:55], v2 offset:10240
v_mfma_f32_16x16x32_bf16 v[184:187], v[120:123], v[100:103], v[184:187]
ds_read_b128 v[56:59], v2 offset:12288
v_mfma_f32_16x16x32_bf16 v[180:183], v[120:123], v[96:99], v[180:183]
ds_read_b128 v[60:63], v2 offset:14336
v_mfma_f32_16x16x32_bf16 v[176:179], v[120:123], v[92:95], v[176:179]
ds_read_b128 v[64:67], v2 offset:16384
v_mfma_f32_16x16x32_bf16 v[172:175], v[120:123], v[88:91], v[172:175]
v_mfma_f32_16x16x32_bf16 v[168:171], v[120:123], v[84:87], v[168:171]
v_mfma_f32_16x16x32_bf16 v[164:167], v[120:123], v[80:83], v[164:167]
v_mfma_f32_16x16x32_bf16 v[200:203], v[124:127], v[80:83], v[200:203]
v_mfma_f32_16x16x32_bf16 v[204:207], v[124:127], v[84:87], v[204:207]
v_mfma_f32_16x16x32_bf16 v[208:211], v[124:127], v[88:91], v[208:211]
v_mfma_f32_16x16x32_bf16 v[212:215], v[124:127], v[92:95], v[212:215]
v_mfma_f32_16x16x32_bf16 v[216:219], v[124:127], v[96:99], v[216:219]
v_mfma_f32_16x16x32_bf16 v[220:223], v[124:127], v[100:103], v[220:223]
v_mfma_f32_16x16x32_bf16 v[224:227], v[124:127], v[104:107], v[224:227]
v_mfma_f32_16x16x32_bf16 v[228:231], v[124:127], v[108:111], v[228:231]
v_mfma_f32_16x16x32_bf16 v[232:235], v[124:127], v[112:115], v[232:235]
s_mov_b32 s41, 4
Lcl_31:
s_waitcnt lgkmcnt(0)
v_mfma_f32_16x16x32_bf16 v[128:131], v[68:71], v[32:35], v[128:131]
ds_read_b128 v[80:83], v3 offset:0
v_mfma_f32_16x16x32_bf16 v[132:135], v[68:71], v[36:39], v[132:135]
ds_read_b64_tr_b16 v[120:121], v6 offset:12288
v_mfma_f32_16x16x32_bf16 v[136:139], v[68:71], v[40:43], v[136:139]
ds_read_b64_tr_b16 v[122:123], v6 offset:12800
v_mfma_f32_16x16x32_bf16 v[140:143], v[68:71], v[44:47], v[140:143]
ds_read_b64_tr_b16 v[124:125], v6 offset:20480
v_mfma_f32_16x16x32_bf16 v[144:147], v[68:71], v[48:51], v[144:147]
ds_read_b64_tr_b16 v[126:127], v6 offset:20992
v_mfma_f32_16x16x32_bf16 v[148:151], v[68:71], v[52:55], v[148:151]
ds_read_b64_tr_b16 v[116:117], v6 offset:4096
v_mfma_f32_16x16x32_bf16 v[152:155], v[68:71], v[56:59], v[152:155]
ds_read_b64_tr_b16 v[118:119], v6 offset:4608
v_mfma_f32_16x16x32_bf16 v[156:159], v[68:71], v[60:63], v[156:159]
ds_read_b128 v[84:87], v3 offset:2048
v_mfma_f32_16x16x32_bf16 v[160:163], v[68:71], v[64:67], v[160:163]
ds_read_b128 v[88:91], v3 offset:4096
v_mfma_f32_16x16x32_bf16 v[196:199], v[72:75], v[64:67], v[196:199]
ds_read_b128 v[92:95], v3 offset:6144
v_mfma_f32_16x16x32_bf16 v[192:195], v[72:75], v[60:63], v[192:195]
ds_read_b128 v[96:99], v3 offset:8192
v_mfma_f32_16x16x32_bf16 v[188:191], v[72:75], v[56:59], v[188:191]
ds_read_b128 v[100:103], v3 offset:10240
v_mfma_f32_16x16x32_bf16 v[184:187], v[72:75], v[52:55], v[184:187]
ds_read_b128 v[104:107], v3 offset:12288
v_mfma_f32_16x16x32_bf16 v[180:183], v[72:75], v[48:51], v[180:183]
ds_read_b128 v[108:111], v3 offset:14336
v_mfma_f32_16x16x32_bf16 v[176:179], v[72:75], v[44:47], v[176:179]
ds_read_b128 v[112:115], v3 offset:16384
v_mfma_f32_16x16x32_bf16 v[172:175], v[72:75], v[40:43], v[172:175]
v_mfma_f32_16x16x32_bf16 v[168:171], v[72:75], v[36:39], v[168:171]
v_mfma_f32_16x16x32_bf16 v[164:167], v[72:75], v[32:35], v[164:167]
v_mfma_f32_16x16x32_bf16 v[200:203], v[76:79], v[32:35], v[200:203]
v_mfma_f32_16x16x32_bf16 v[204:207], v[76:79], v[36:39], v[204:207]
v_mfma_f32_16x16x32_bf16 v[208:211], v[76:79], v[40:43], v[208:211]
v_mfma_f32_16x16x32_bf16 v[212:215], v[76:79], v[44:47], v[212:215]
v_mfma_f32_16x16x32_bf16 v[216:219], v[76:79], v[48:51], v[216:219]
v_mfma_f32_16x16x32_bf16 v[220:223], v[76:79], v[52:55], v[220:223]
v_mfma_f32_16x16x32_bf16 v[224:227], v[76:79], v[56:59], v[224:227]
v_mfma_f32_16x16x32_bf16 v[228:231], v[76:79], v[60:63], v[228:231]
v_mfma_f32_16x16x32_bf16 v[232:235], v[76:79], v[64:67], v[232:235]
s_waitcnt lgkmcnt(0)
s_barrier
v_mfma_f32_16x16x32_bf16 v[128:131], v[116:119], v[80:83], v[128:131]
s_branch Lov_2
.p2align 12
.fill 16, 4, 0xbf800000
Lst_2_0:
s_branch Lwr_162
s_nop 0
s_nop 0
Lov_2:
ds_read_b128 v[32:35], v2 offset:43008
v_mfma_f32_16x16x32_bf16 v[132:135], v[116:119], v[84:87], v[132:135]
ds_read_b64_tr_b16 v[72:73], v7 offset:8192
v_mfma_f32_16x16x32_bf16 v[136:139], v[116:119], v[88:91], v[136:139]
ds_read_b64_tr_b16 v[74:75], v7 offset:8704
v_mfma_f32_16x16x32_bf16 v[140:143], v[116:119], v[92:95], v[140:143]
ds_read_b64_tr_b16 v[76:77], v7 offset:16384
v_mfma_f32_16x16x32_bf16 v[144:147], v[116:119], v[96:99], v[144:147]
ds_read_b64_tr_b16 v[78:79], v7 offset:16896
v_mfma_f32_16x16x32_bf16 v[148:151], v[116:119], v[100:103], v[148:151]
ds_read_b64_tr_b16 v[68:69], v7 offset:0
v_mfma_f32_16x16x32_bf16 v[152:155], v[116:119], v[104:107], v[152:155]
ds_read_b64_tr_b16 v[70:71], v7 offset:512
v_mfma_f32_16x16x32_bf16 v[156:159], v[116:119], v[108:111], v[156:159]
ds_read_b128 v[36:39], v2 offset:45056
v_mfma_f32_16x16x32_bf16 v[160:163], v[116:119], v[112:115], v[160:163]
ds_read_b128 v[40:43], v2 offset:47104
v_mfma_f32_16x16x32_bf16 v[196:199], v[120:123], v[112:115], v[196:199]
ds_read_b128 v[44:47], v2 offset:49152
v_mfma_f32_16x16x32_bf16 v[192:195], v[120:123], v[108:111], v[192:195]
ds_read_b128 v[48:51], v2 offset:51200
v_mfma_f32_16x16x32_bf16 v[188:191], v[120:123], v[104:107], v[188:191]
ds_read_b128 v[52:55], v2 offset:53248
v_mfma_f32_16x16x32_bf16 v[184:187], v[120:123], v[100:103], v[184:187]
ds_read_b128 v[56:59], v2 offset:55296
v_mfma_f32_16x16x32_bf16 v[180:183], v[120:123], v[96:99], v[180:183]
ds_read_b128 v[60:63], v2 offset:57344
v_mfma_f32_16x16x32_bf16 v[176:179], v[120:123], v[92:95], v[176:179]
ds_read_b128 v[64:67], v2 offset:59392
v_mfma_f32_16x16x32_bf16 v[172:175], v[120:123], v[88:91], v[172:175]
v_mfma_f32_16x16x32_bf16 v[168:171], v[120:123], v[84:87], v[168:171]
v_mfma_f32_16x16x32_bf16 v[164:167], v[120:123], v[80:83], v[164:167]
v_mfma_f32_16x16x32_bf16 v[200:203], v[124:127], v[80:83], v[200:203]
v_mfma_f32_16x16x32_bf16 v[204:207], v[124:127], v[84:87], v[204:207]
v_mfma_f32_16x16x32_bf16 v[208:211], v[124:127], v[88:91], v[208:211]
v_mfma_f32_16x16x32_bf16 v[212:215], v[124:127], v[92:95], v[212:215]
v_mfma_f32_16x16x32_bf16 v[216:219], v[124:127], v[96:99], v[216:219]
v_mfma_f32_16x16x32_bf16 v[220:223], v[124:127], v[100:103], v[220:223]
v_mfma_f32_16x16x32_bf16 v[224:227], v[124:127], v[104:107], v[224:227]
v_mfma_f32_16x16x32_bf16 v[228:231], v[124:127], v[108:111], v[228:231]
v_mfma_f32_16x16x32_bf16 v[232:235], v[124:127], v[112:115], v[232:235]
s_waitcnt lgkmcnt(0)
v_mfma_f32_16x16x32_bf16 v[128:131], v[68:71], v[32:35], v[128:131]
ds_read_b128 v[80:83], v3 offset:43008
v_mfma_f32_16x16x32_bf16 v[132:135], v[68:71], v[36:39], v[132:135]
ds_read_b64_tr_b16 v[120:121], v7 offset:12288
v_mfma_f32_16x16x32_bf16 v[136:139], v[68:71], v[40:43], v[136:139]
ds_read_b64_tr_b16 v[122:123], v7 offset:12800
v_mfma_f32_16x16x32_bf16 v[140:143], v[68:71], v[44:47], v[140:143]
ds_read_b64_tr_b16 v[124:125], v7 offset:20480
v_mfma_f32_16x16x32_bf16 v[144:147], v[68:71], v[48:51], v[144:147]
ds_read_b64_tr_b16 v[126:127], v7 offset:20992
v_mfma_f32_16x16x32_bf16 v[148:151], v[68:71], v[52:55], v[148:151]
ds_read_b64_tr_b16 v[116:117], v7 offset:4096
v_mfma_f32_16x16x32_bf16 v[152:155], v[68:71], v[56:59], v[152:155]
ds_read_b64_tr_b16 v[118:119], v7 offset:4608
v_mfma_f32_16x16x32_bf16 v[156:159], v[68:71], v[60:63], v[156:159]
ds_read_b128 v[84:87], v3 offset:45056
v_mfma_f32_16x16x32_bf16 v[160:163], v[68:71], v[64:67], v[160:163]
ds_read_b128 v[88:91], v3 offset:47104
v_mfma_f32_16x16x32_bf16 v[196:199], v[72:75], v[64:67], v[196:199]
ds_read_b128 v[92:95], v3 offset:49152
v_mfma_f32_16x16x32_bf16 v[192:195], v[72:75], v[60:63], v[192:195]
ds_read_b128 v[96:99], v3 offset:51200
v_mfma_f32_16x16x32_bf16 v[188:191], v[72:75], v[56:59], v[188:191]
ds_read_b128 v[100:103], v3 offset:53248
v_mfma_f32_16x16x32_bf16 v[184:187], v[72:75], v[52:55], v[184:187]
ds_read_b128 v[104:107], v3 offset:55296
v_mfma_f32_16x16x32_bf16 v[180:183], v[72:75], v[48:51], v[180:183]
ds_read_b128 v[108:111], v3 offset:57344
v_mfma_f32_16x16x32_bf16 v[176:179], v[72:75], v[44:47], v[176:179]
ds_read_b128 v[112:115], v3 offset:59392
v_mfma_f32_16x16x32_bf16 v[172:175], v[72:75], v[40:43], v[172:175]
v_mfma_f32_16x16x32_bf16 v[168:171], v[72:75], v[36:39], v[168:171]
v_mfma_f32_16x16x32_bf16 v[164:167], v[72:75], v[32:35], v[164:167]
v_mfma_f32_16x16x32_bf16 v[200:203], v[76:79], v[32:35], v[200:203]
v_mfma_f32_16x16x32_bf16 v[204:207], v[76:79], v[36:39], v[204:207]
v_mfma_f32_16x16x32_bf16 v[208:211], v[76:79], v[40:43], v[208:211]
v_mfma_f32_16x16x32_bf16 v[212:215], v[76:79], v[44:47], v[212:215]
v_mfma_f32_16x16x32_bf16 v[216:219], v[76:79], v[48:51], v[216:219]
v_mfma_f32_16x16x32_bf16 v[220:223], v[76:79], v[52:55], v[220:223]
v_mfma_f32_16x16x32_bf16 v[224:227], v[76:79], v[56:59], v[224:227]
v_mfma_f32_16x16x32_bf16 v[228:231], v[76:79], v[60:63], v[228:231]
v_mfma_f32_16x16x32_bf16 v[232:235], v[76:79], v[64:67], v[232:235]
s_waitcnt lgkmcnt(0)
s_barrier
v_mfma_f32_16x16x32_bf16 v[128:131], v[116:119], v[80:83], v[128:131]
ds_read_b128 v[32:35], v4 offset:0
v_mfma_f32_16x16x32_bf16 v[132:135], v[116:119], v[84:87], v[132:135]
ds_read_b64_tr_b16 v[72:73], v8 offset:8192
v_mfma_f32_16x16x32_bf16 v[136:139], v[116:119], v[88:91], v[136:139]
ds_read_b64_tr_b16 v[74:75], v8 offset:8704
v_mfma_f32_16x16x32_bf16 v[140:143], v[116:119], v[92:95], v[140:143]
ds_read_b64_tr_b16 v[76:77], v8 offset:16384
v_mfma_f32_16x16x32_bf16 v[144:147], v[116:119], v[96:99], v[144:147]
ds_read_b64_tr_b16 v[78:79], v8 offset:16896
v_mfma_f32_16x16x32_bf16 v[148:151], v[116:119], v[100:103], v[148:151]
ds_read_b64_tr_b16 v[68:69], v8 offset:0
v_mfma_f32_16x16x32_bf16 v[152:155], v[116:119], v[104:107], v[152:155]
ds_read_b64_tr_b16 v[70:71], v8 offset:512
v_mfma_f32_16x16x32_bf16 v[156:159], v[116:119], v[108:111], v[156:159]
ds_read_b128 v[36:39], v4 offset:2048
v_mfma_f32_16x16x32_bf16 v[160:163], v[116:119], v[112:115], v[160:163]
ds_read_b128 v[40:43], v4 offset:4096
v_mfma_f32_16x16x32_bf16 v[196:199], v[120:123], v[112:115], v[196:199]
ds_read_b128 v[44:47], v4 offset:6144
v_mfma_f32_16x16x32_bf16 v[192:195], v[120:123], v[108:111], v[192:195]
ds_read_b128 v[48:51], v4 offset:8192
v_mfma_f32_16x16x32_bf16 v[188:191], v[120:123], v[104:107], v[188:191]
ds_read_b128 v[52:55], v4 offset:10240
v_mfma_f32_16x16x32_bf16 v[184:187], v[120:123], v[100:103], v[184:187]
ds_read_b128 v[56:59], v4 offset:12288
v_mfma_f32_16x16x32_bf16 v[180:183], v[120:123], v[96:99], v[180:183]
ds_read_b128 v[60:63], v4 offset:14336
v_mfma_f32_16x16x32_bf16 v[176:179], v[120:123], v[92:95], v[176:179]
ds_read_b128 v[64:67], v4 offset:16384
v_mfma_f32_16x16x32_bf16 v[172:175], v[120:123], v[88:91], v[172:175]
v_mfma_f32_16x16x32_bf16 v[168:171], v[120:123], v[84:87], v[168:171]
v_mfma_f32_16x16x32_bf16 v[164:167], v[120:123], v[80:83], v[164:167]
v_mfma_f32_16x16x32_bf16 v[200:203], v[124:127], v[80:83], v[200:203]
v_mfma_f32_16x16x32_bf16 v[204:207], v[124:127], v[84:87], v[204:207]
v_mfma_f32_16x16x32_bf16 v[208:211], v[124:127], v[88:91], v[208:211]
v_mfma_f32_16x16x32_bf16 v[212:215], v[124:127], v[92:95], v[212:215]
v_mfma_f32_16x16x32_bf16 v[216:219], v[124:127], v[96:99], v[216:219]
v_mfma_f32_16x16x32_bf16 v[220:223], v[124:127], v[100:103], v[220:223]
v_mfma_f32_16x16x32_bf16 v[224:227], v[124:127], v[104:107], v[224:227]
v_mfma_f32_16x16x32_bf16 v[228:231], v[124:127], v[108:111], v[228:231]
v_mfma_f32_16x16x32_bf16 v[232:235], v[124:127], v[112:115], v[232:235]
s_waitcnt lgkmcnt(0)
v_mfma_f32_16x16x32_bf16 v[128:131], v[68:71], v[32:35], v[128:131]
ds_read_b128 v[80:83], v5 offset:0
v_mfma_f32_16x16x32_bf16 v[132:135], v[68:71], v[36:39], v[132:135]
ds_read_b64_tr_b16 v[120:121], v8 offset:12288
v_mfma_f32_16x16x32_bf16 v[136:139], v[68:71], v[40:43], v[136:139]
ds_read_b64_tr_b16 v[122:123], v8 offset:12800
v_mfma_f32_16x16x32_bf16 v[140:143], v[68:71], v[44:47], v[140:143]
ds_read_b64_tr_b16 v[124:125], v8 offset:20480
v_mfma_f32_16x16x32_bf16 v[144:147], v[68:71], v[48:51], v[144:147]
ds_read_b64_tr_b16 v[126:127], v8 offset:20992
v_mfma_f32_16x16x32_bf16 v[148:151], v[68:71], v[52:55], v[148:151]
ds_read_b64_tr_b16 v[116:117], v8 offset:4096
v_mfma_f32_16x16x32_bf16 v[152:155], v[68:71], v[56:59], v[152:155]
ds_read_b64_tr_b16 v[118:119], v8 offset:4608
v_mfma_f32_16x16x32_bf16 v[156:159], v[68:71], v[60:63], v[156:159]
ds_read_b128 v[84:87], v5 offset:2048
v_mfma_f32_16x16x32_bf16 v[160:163], v[68:71], v[64:67], v[160:163]
ds_read_b128 v[88:91], v5 offset:4096
v_mfma_f32_16x16x32_bf16 v[196:199], v[72:75], v[64:67], v[196:199]
ds_read_b128 v[92:95], v5 offset:6144
v_mfma_f32_16x16x32_bf16 v[192:195], v[72:75], v[60:63], v[192:195]
ds_read_b128 v[96:99], v5 offset:8192
v_mfma_f32_16x16x32_bf16 v[188:191], v[72:75], v[56:59], v[188:191]
ds_read_b128 v[100:103], v5 offset:10240
v_mfma_f32_16x16x32_bf16 v[184:187], v[72:75], v[52:55], v[184:187]
ds_read_b128 v[104:107], v5 offset:12288
v_mfma_f32_16x16x32_bf16 v[180:183], v[72:75], v[48:51], v[180:183]
ds_read_b128 v[108:111], v5 offset:14336
v_mfma_f32_16x16x32_bf16 v[176:179], v[72:75], v[44:47], v[176:179]
ds_read_b128 v[112:115], v5 offset:16384
v_mfma_f32_16x16x32_bf16 v[172:175], v[72:75], v[40:43], v[172:175]
v_mfma_f32_16x16x32_bf16 v[168:171], v[72:75], v[36:39], v[168:171]
v_mfma_f32_16x16x32_bf16 v[164:167], v[72:75], v[32:35], v[164:167]
v_mfma_f32_16x16x32_bf16 v[200:203], v[76:79], v[32:35], v[200:203]
v_mfma_f32_16x16x32_bf16 v[204:207], v[76:79], v[36:39], v[204:207]
v_mfma_f32_16x16x32_bf16 v[208:211], v[76:79], v[40:43], v[208:211]
v_mfma_f32_16x16x32_bf16 v[212:215], v[76:79], v[44:47], v[212:215]
v_mfma_f32_16x16x32_bf16 v[216:219], v[76:79], v[48:51], v[216:219]
v_mfma_f32_16x16x32_bf16 v[220:223], v[76:79], v[52:55], v[220:223]
v_mfma_f32_16x16x32_bf16 v[224:227], v[76:79], v[56:59], v[224:227]
v_mfma_f32_16x16x32_bf16 v[228:231], v[76:79], v[60:63], v[228:231]
v_mfma_f32_16x16x32_bf16 v[232:235], v[76:79], v[64:67], v[232:235]
s_waitcnt lgkmcnt(0)
s_barrier
v_mfma_f32_16x16x32_bf16 v[128:131], v[116:119], v[80:83], v[128:131]
ds_read_b128 v[32:35], v2 offset:0
v_mfma_f32_16x16x32_bf16 v[132:135], v[116:119], v[84:87], v[132:135]
ds_read_b64_tr_b16 v[72:73], v6 offset:8192
v_mfma_f32_16x16x32_bf16 v[136:139], v[116:119], v[88:91], v[136:139]
ds_read_b64_tr_b16 v[74:75], v6 offset:8704
v_mfma_f32_16x16x32_bf16 v[140:143], v[116:119], v[92:95], v[140:143]
ds_read_b64_tr_b16 v[76:77], v6 offset:16384
v_mfma_f32_16x16x32_bf16 v[144:147], v[116:119], v[96:99], v[144:147]
ds_read_b64_tr_b16 v[78:79], v6 offset:16896
v_mfma_f32_16x16x32_bf16 v[148:151], v[116:119], v[100:103], v[148:151]
ds_read_b64_tr_b16 v[68:69], v6 offset:0
v_mfma_f32_16x16x32_bf16 v[152:155], v[116:119], v[104:107], v[152:155]
ds_read_b64_tr_b16 v[70:71], v6 offset:512
v_mfma_f32_16x16x32_bf16 v[156:159], v[116:119], v[108:111], v[156:159]
ds_read_b128 v[36:39], v2 offset:2048
v_mfma_f32_16x16x32_bf16 v[160:163], v[116:119], v[112:115], v[160:163]
ds_read_b128 v[40:43], v2 offset:4096
v_mfma_f32_16x16x32_bf16 v[196:199], v[120:123], v[112:115], v[196:199]
ds_read_b128 v[44:47], v2 offset:6144
v_mfma_f32_16x16x32_bf16 v[192:195], v[120:123], v[108:111], v[192:195]
ds_read_b128 v[48:51], v2 offset:8192
v_mfma_f32_16x16x32_bf16 v[188:191], v[120:123], v[104:107], v[188:191]
ds_read_b128 v[52:55], v2 offset:10240
v_mfma_f32_16x16x32_bf16 v[184:187], v[120:123], v[100:103], v[184:187]
ds_read_b128 v[56:59], v2 offset:12288
v_mfma_f32_16x16x32_bf16 v[180:183], v[120:123], v[96:99], v[180:183]
ds_read_b128 v[60:63], v2 offset:14336
v_mfma_f32_16x16x32_bf16 v[176:179], v[120:123], v[92:95], v[176:179]
ds_read_b128 v[64:67], v2 offset:16384
v_mfma_f32_16x16x32_bf16 v[172:175], v[120:123], v[88:91], v[172:175]
v_mfma_f32_16x16x32_bf16 v[168:171], v[120:123], v[84:87], v[168:171]
v_mfma_f32_16x16x32_bf16 v[164:167], v[120:123], v[80:83], v[164:167]
v_mfma_f32_16x16x32_bf16 v[200:203], v[124:127], v[80:83], v[200:203]
v_mfma_f32_16x16x32_bf16 v[204:207], v[124:127], v[84:87], v[204:207]
v_mfma_f32_16x16x32_bf16 v[208:211], v[124:127], v[88:91], v[208:211]
v_mfma_f32_16x16x32_bf16 v[212:215], v[124:127], v[92:95], v[212:215]
v_mfma_f32_16x16x32_bf16 v[216:219], v[124:127], v[96:99], v[216:219]
v_mfma_f32_16x16x32_bf16 v[220:223], v[124:127], v[100:103], v[220:223]
v_mfma_f32_16x16x32_bf16 v[224:227], v[124:127], v[104:107], v[224:227]
v_mfma_f32_16x16x32_bf16 v[228:231], v[124:127], v[108:111], v[228:231]
v_mfma_f32_16x16x32_bf16 v[232:235], v[124:127], v[112:115], v[232:235]
s_sub_u32 s41, s41, 1
s_cmp_lg_u32 s41, 0
s_cbranch_scc1 Lcl_31
s_waitcnt lgkmcnt(0)
v_mfma_f32_16x16x32_bf16 v[128:131], v[68:71], v[32:35], v[128:131]
ds_read_b128 v[80:83], v3 offset:0
v_mfma_f32_16x16x32_bf16 v[132:135], v[68:71], v[36:39], v[132:135]
ds_read_b64_tr_b16 v[120:121], v6 offset:12288
v_mfma_f32_16x16x32_bf16 v[136:139], v[68:71], v[40:43], v[136:139]
ds_read_b64_tr_b16 v[122:123], v6 offset:12800
v_mfma_f32_16x16x32_bf16 v[140:143], v[68:71], v[44:47], v[140:143]
ds_read_b64_tr_b16 v[124:125], v6 offset:20480
v_mfma_f32_16x16x32_bf16 v[144:147], v[68:71], v[48:51], v[144:147]
ds_read_b64_tr_b16 v[126:127], v6 offset:20992
v_mfma_f32_16x16x32_bf16 v[148:151], v[68:71], v[52:55], v[148:151]
ds_read_b64_tr_b16 v[116:117], v6 offset:4096
v_mfma_f32_16x16x32_bf16 v[152:155], v[68:71], v[56:59], v[152:155]
ds_read_b64_tr_b16 v[118:119], v6 offset:4608
v_mfma_f32_16x16x32_bf16 v[156:159], v[68:71], v[60:63], v[156:159]
ds_read_b128 v[84:87], v3 offset:2048
v_mfma_f32_16x16x32_bf16 v[160:163], v[68:71], v[64:67], v[160:163]
ds_read_b128 v[88:91], v3 offset:4096
v_mfma_f32_16x16x32_bf16 v[196:199], v[72:75], v[64:67], v[196:199]
ds_read_b128 v[92:95], v3 offset:6144
v_mfma_f32_16x16x32_bf16 v[192:195], v[72:75], v[60:63], v[192:195]
ds_read_b128 v[96:99], v3 offset:8192
v_mfma_f32_16x16x32_bf16 v[188:191], v[72:75], v[56:59], v[188:191]
ds_read_b128 v[100:103], v3 offset:10240
v_mfma_f32_16x16x32_bf16 v[184:187], v[72:75], v[52:55], v[184:187]
ds_read_b128 v[104:107], v3 offset:12288
v_mfma_f32_16x16x32_bf16 v[180:183], v[72:75], v[48:51], v[180:183]
ds_read_b128 v[108:111], v3 offset:14336
v_mfma_f32_16x16x32_bf16 v[176:179], v[72:75], v[44:47], v[176:179]
ds_read_b128 v[112:115], v3 offset:16384
v_mfma_f32_16x16x32_bf16 v[172:175], v[72:75], v[40:43], v[172:175]
v_mfma_f32_16x16x32_bf16 v[168:171], v[72:75], v[36:39], v[168:171]
v_mfma_f32_16x16x32_bf16 v[164:167], v[72:75], v[32:35], v[164:167]
v_mfma_f32_16x16x32_bf16 v[200:203], v[76:79], v[32:35], v[200:203]
v_mfma_f32_16x16x32_bf16 v[204:207], v[76:79], v[36:39], v[204:207]
v_mfma_f32_16x16x32_bf16 v[208:211], v[76:79], v[40:43], v[208:211]
v_mfma_f32_16x16x32_bf16 v[212:215], v[76:79], v[44:47], v[212:215]
v_mfma_f32_16x16x32_bf16 v[216:219], v[76:79], v[48:51], v[216:219]
v_mfma_f32_16x16x32_bf16 v[220:223], v[76:79], v[52:55], v[220:223]
v_mfma_f32_16x16x32_bf16 v[224:227], v[76:79], v[56:59], v[224:227]
v_mfma_f32_16x16x32_bf16 v[228:231], v[76:79], v[60:63], v[228:231]
v_mfma_f32_16x16x32_bf16 v[232:235], v[76:79], v[64:67], v[232:235]
s_waitcnt lgkmcnt(0)
v_mfma_f32_16x16x32_bf16 v[128:131], v[116:119], v[80:83], v[128:131]
v_mfma_f32_16x16x32_bf16 v[132:135], v[116:119], v[84:87], v[132:135]
v_mfma_f32_16x16x32_bf16 v[136:139], v[116:119], v[88:91], v[136:139]
v_mfma_f32_16x16x32_bf16 v[140:143], v[116:119], v[92:95], v[140:143]
v_mfma_f32_16x16x32_bf16 v[144:147], v[116:119], v[96:99], v[144:147]
v_mfma_f32_16x16x32_bf16 v[148:151], v[116:119], v[100:103], v[148:151]
v_mfma_f32_16x16x32_bf16 v[152:155], v[116:119], v[104:107], v[152:155]
v_mfma_f32_16x16x32_bf16 v[156:159], v[116:119], v[108:111], v[156:159]
v_mfma_f32_16x16x32_bf16 v[160:163], v[116:119], v[112:115], v[160:163]
v_mfma_f32_16x16x32_bf16 v[196:199], v[120:123], v[112:115], v[196:199]
v_mfma_f32_16x16x32_bf16 v[192:195], v[120:123], v[108:111], v[192:195]
v_mfma_f32_16x16x32_bf16 v[188:191], v[120:123], v[104:107], v[188:191]
v_mfma_f32_16x16x32_bf16 v[184:187], v[120:123], v[100:103], v[184:187]
v_mfma_f32_16x16x32_bf16 v[180:183], v[120:123], v[96:99], v[180:183]
v_mfma_f32_16x16x32_bf16 v[176:179], v[120:123], v[92:95], v[176:179]
v_mfma_f32_16x16x32_bf16 v[172:175], v[120:123], v[88:91], v[172:175]
v_mfma_f32_16x16x32_bf16 v[168:171], v[120:123], v[84:87], v[168:171]
v_mfma_f32_16x16x32_bf16 v[164:167], v[120:123], v[80:83], v[164:167]
v_mfma_f32_16x16x32_bf16 v[200:203], v[124:127], v[80:83], v[200:203]
v_mfma_f32_16x16x32_bf16 v[204:207], v[124:127], v[84:87], v[204:207]
v_mfma_f32_16x16x32_bf16 v[208:211], v[124:127], v[88:91], v[208:211]
v_mfma_f32_16x16x32_bf16 v[212:215], v[124:127], v[92:95], v[212:215]
v_mfma_f32_16x16x32_bf16 v[216:219], v[124:127], v[96:99], v[216:219]
v_mfma_f32_16x16x32_bf16 v[220:223], v[124:127], v[100:103], v[220:223]
v_mfma_f32_16x16x32_bf16 v[224:227], v[124:127], v[104:107], v[224:227]
v_mfma_f32_16x16x32_bf16 v[228:231], v[124:127], v[108:111], v[228:231]
v_mfma_f32_16x16x32_bf16 v[232:235], v[124:127], v[112:115], v[232:235]
Lepi:
v_lshlrev_b32 v14, 3, v12
v_add_u32 v14, 147456, v14
v_mul_u32_u24 v15, 400, v12
v_lshl_add_u32 v15, v13, 3, v15
s_lshl_b32 s43, s36, 5
v_add_u32 v15, s43, v15
s_barrier
ds_read_b64 v[32:33], v14 offset:0
ds_read_b64 v[34:35], v14 offset:128
ds_read_b64 v[36:37], v14 offset:256
ds_read_b64 v[38:39], v14 offset:384
ds_read_b64 v[40:41], v14 offset:512
ds_read_b64 v[42:43], v14 offset:640
ds_read_b64 v[44:45], v14 offset:768
ds_read_b64 v[46:47], v14 offset:896
ds_read_b64 v[48:49], v14 offset:1024
v_mov_b32_dpp v52, v128 row_newbcast:0 row_mask:0xf bank_mask:0xf
v_mov_b32_dpp v53, v129 row_newbcast:0 row_mask:0xf bank_mask:0xf
v_mov_b32_dpp v54, v130 row_newbcast:0 row_mask:0xf bank_mask:0xf
v_mov_b32_dpp v55, v131 row_newbcast:0 row_mask:0xf bank_mask:0xf
v_mov_b32_dpp v56, v164 row_newbcast:0 row_mask:0xf bank_mask:0xf
v_mov_b32_dpp v57, v165 row_newbcast:0 row_mask:0xf bank_mask:0xf
v_mov_b32_dpp v58, v166 row_newbcast:0 row_mask:0xf bank_mask:0xf
v_mov_b32_dpp v59, v167 row_newbcast:0 row_mask:0xf bank_mask:0xf
v_mov_b32_dpp v60, v200 row_newbcast:0 row_mask:0xf bank_mask:0xf
v_mov_b32_dpp v61, v201 row_newbcast:0 row_mask:0xf bank_mask:0xf
v_mov_b32_dpp v62, v202 row_newbcast:0 row_mask:0xf bank_mask:0xf
v_mov_b32_dpp v63, v203 row_newbcast:0 row_mask:0xf bank_mask:0xf
s_waitcnt lgkmcnt(0)
v_pk_fma_f32 v[164:165], v[32:33], v[56:57], v[164:165] op_sel_hi:[0,1,1] neg_lo:[1,0,0] neg_hi:[1,0,0]
v_pk_fma_f32 v[166:167], v[32:33], v[58:59], v[166:167] op_sel_hi:[0,1,1] neg_lo:[1,0,0] neg_hi:[1,0,0]
v_pk_fma_f32 v[200:201], v[32:33], v[60:61], v[200:201] op_sel_hi:[0,1,1] neg_lo:[1,0,0] neg_hi:[1,0,0]
v_pk_fma_f32 v[202:203], v[32:33], v[62:63], v[202:203] op_sel_hi:[0,1,1] neg_lo:[1,0,0] neg_hi:[1,0,0]
v_pk_mul_f32 v[164:165], v[32:33], v[164:165] op_sel:[1,0] op_sel_hi:[1,1]
v_pk_mul_f32 v[166:167], v[32:33], v[166:167] op_sel:[1,0] op_sel_hi:[1,1]
v_pk_fma_f32 v[132:133], v[34:35], v[52:53], v[132:133] op_sel_hi:[0,1,1] neg_lo:[1,0,0] neg_hi:[1,0,0]
v_pk_fma_f32 v[134:135], v[34:35], v[54:55], v[134:135] op_sel_hi:[0,1,1] neg_lo:[1,0,0] neg_hi:[1,0,0]
v_pk_mul_f32 v[200:201], v[32:33], v[200:201] op_sel:[1,0] op_sel_hi:[1,1]
v_pk_mul_f32 v[202:203], v[32:33], v[202:203] op_sel:[1,0] op_sel_hi:[1,1]
v_cvt_pk_bf16_f32 v164, v164, v165
v_cvt_pk_bf16_f32 v165, v166, v167
ds_write_b64 v15, v[164:165] offset:128
v_pk_fma_f32 v[168:169], v[34:35], v[56:57], v[168:169] op_sel_hi:[0,1,1] neg_lo:[1,0,0] neg_hi:[1,0,0]
v_pk_fma_f32 v[170:171], v[34:35], v[58:59], v[170:171] op_sel_hi:[0,1,1] neg_lo:[1,0,0] neg_hi:[1,0,0]
v_pk_mul_f32 v[132:133], v[34:35], v[132:133] op_sel:[1,0] op_sel_hi:[1,1]
v_pk_mul_f32 v[134:135], v[34:35], v[134:135] op_sel:[1,0] op_sel_hi:[1,1]
v_cvt_pk_bf16_f32 v200, v200, v201
v_cvt_pk_bf16_f32 v201, v202, v203
ds_write_b64 v15, v[200:201] offset:256
v_pk_fma_f32 v[204:205], v[34:35], v[60:61], v[204:205] op_sel_hi:[0,1,1] neg_lo:[1,0,0] neg_hi:[1,0,0]
v_pk_fma_f32 v[206:207], v[34:35], v[62:63], v[206:207] op_sel_hi:[0,1,1] neg_lo:[1,0,0] neg_hi:[1,0,0]
v_pk_mul_f32 v[168:169], v[34:35], v[168:169] op_sel:[1,0] op_sel_hi:[1,1]
v_pk_mul_f32 v[170:171], v[34:35], v[170:171] op_sel:[1,0] op_sel_hi:[1,1]
v_cvt_pk_bf16_f32 v132, v132, v133
v_cvt_pk_bf16_f32 v133, v134, v135
ds_write_b64 v15, v[132:133] offset:6400
v_pk_fma_f32 v[136:137], v[36:37], v[52:53], v[136:137] op_sel_hi:[0,1,1] neg_lo:[1,0,0] neg_hi:[1,0,0]
v_pk_fma_f32 v[138:139], v[36:37], v[54:55], v[138:139] op_sel_hi:[0,1,1] neg_lo:[1,0,0] neg_hi:[1,0,0]
v_pk_mul_f32 v[204:205], v[34:35], v[204:205] op_sel:[1,0] op_sel_hi:[1,1]
v_pk_mul_f32 v[206:207], v[34:35], v[206:207] op_sel:[1,0] op_sel_hi:[1,1]
v_cvt_pk_bf16_f32 v168, v168, v169
v_cvt_pk_bf16_f32 v169, v170, v171
ds_write_b64 v15, v[168:169] offset:6528
v_pk_fma_f32 v[172:173], v[36:37], v[56:57], v[172:173] op_sel_hi:[0,1,1] neg_lo:[1,0,0] neg_hi:[1,0,0]
v_pk_fma_f32 v[174:175], v[36:37], v[58:59], v[174:175] op_sel_hi:[0,1,1] neg_lo:[1,0,0] neg_hi:[1,0,0]
v_pk_mul_f32 v[136:137], v[36:37], v[136:137] op_sel:[1,0] op_sel_hi:[1,1]
v_pk_mul_f32 v[138:139], v[36:37], v[138:139] op_sel:[1,0] op_sel_hi:[1,1]
v_cvt_pk_bf16_f32 v204, v204, v205
v_cvt_pk_bf16_f32 v205, v206, v207
ds_write_b64 v15, v[204:205] offset:6656
v_pk_fma_f32 v[208:209], v[36:37], v[60:61], v[208:209] op_sel_hi:[0,1,1] neg_lo:[1,0,0] neg_hi:[1,0,0]
v_pk_fma_f32 v[210:211], v[36:37], v[62:63], v[210:211] op_sel_hi:[0,1,1] neg_lo:[1,0,0] neg_hi:[1,0,0]
v_pk_mul_f32 v[172:173], v[36:37], v[172:173] op_sel:[1,0] op_sel_hi:[1,1]
v_pk_mul_f32 v[174:175], v[36:37], v[174:175] op_sel:[1,0] op_sel_hi:[1,1]
v_cvt_pk_bf16_f32 v136, v136, v137
v_cvt_pk_bf16_f32 v137, v138, v139
ds_write_b64 v15, v[136:137] offset:12800
v_pk_fma_f32 v[140:141], v[38:39], v[52:53], v[140:141] op_sel_hi:[0,1,1] neg_lo:[1,0,0] neg_hi:[1,0,0]
v_pk_fma_f32 v[142:143], v[38:39], v[54:55], v[142:143] op_sel_hi:[0,1,1] neg_lo:[1,0,0] neg_hi:[1,0,0]
v_pk_mul_f32 v[208:209], v[36:37], v[208:209] op_sel:[1,0] op_sel_hi:[1,1]
v_pk_mul_f32 v[210:211], v[36:37], v[210:211] op_sel:[1,0] op_sel_hi:[1,1]
v_cvt_pk_bf16_f32 v172, v172, v173
v_cvt_pk_bf16_f32 v173, v174, v175
ds_write_b64 v15, v[172:173] offset:12928
v_pk_fma_f32 v[176:177], v[38:39], v[56:57], v[176:177] op_sel_hi:[0,1,1] neg_lo:[1,0,0] neg_hi:[1,0,0]
v_pk_fma_f32 v[178:179], v[38:39], v[58:59], v[178:179] op_sel_hi:[0,1,1] neg_lo:[1,0,0] neg_hi:[1,0,0]
v_pk_mul_f32 v[140:141], v[38:39], v[140:141] op_sel:[1,0] op_sel_hi:[1,1]
v_pk_mul_f32 v[142:143], v[38:39], v[142:143] op_sel:[1,0] op_sel_hi:[1,1]
v_cvt_pk_bf16_f32 v208, v208, v209
v_cvt_pk_bf16_f32 v209, v210, v211
ds_write_b64 v15, v[208:209] offset:13056
v_pk_fma_f32 v[212:213], v[38:39], v[60:61], v[212:213] op_sel_hi:[0,1,1] neg_lo:[1,0,0] neg_hi:[1,0,0]
v_pk_fma_f32 v[214:215], v[38:39], v[62:63], v[214:215] op_sel_hi:[0,1,1] neg_lo:[1,0,0] neg_hi:[1,0,0]
v_pk_mul_f32 v[176:177], v[38:39], v[176:177] op_sel:[1,0] op_sel_hi:[1,1]
v_pk_mul_f32 v[178:179], v[38:39], v[178:179] op_sel:[1,0] op_sel_hi:[1,1]
v_cvt_pk_bf16_f32 v140, v140, v141
v_cvt_pk_bf16_f32 v141, v142, v143
ds_write_b64 v15, v[140:141] offset:19200
v_pk_fma_f32 v[144:145], v[40:41], v[52:53], v[144:145] op_sel_hi:[0,1,1] neg_lo:[1,0,0] neg_hi:[1,0,0]
v_pk_fma_f32 v[146:147], v[40:41], v[54:55], v[146:147] op_sel_hi:[0,1,1] neg_lo:[1,0,0] neg_hi:[1,0,0]
v_pk_mul_f32 v[212:213], v[38:39], v[212:213] op_sel:[1,0] op_sel_hi:[1,1]
v_pk_mul_f32 v[214:215], v[38:39], v[214:215] op_sel:[1,0] op_sel_hi:[1,1]
v_cvt_pk_bf16_f32 v176, v176, v177
v_cvt_pk_bf16_f32 v177, v178, v179
ds_write_b64 v15, v[176:177] offset:19328
v_pk_fma_f32 v[180:181], v[40:41], v[56:57], v[180:181] op_sel_hi:[0,1,1] neg_lo:[1,0,0] neg_hi:[1,0,0]
v_pk_fma_f32 v[182:183], v[40:41], v[58:59], v[182:183] op_sel_hi:[0,1,1] neg_lo:[1,0,0] neg_hi:[1,0,0]
v_pk_mul_f32 v[144:145], v[40:41], v[144:145] op_sel:[1,0] op_sel_hi:[1,1]
v_pk_mul_f32 v[146:147], v[40:41], v[146:147] op_sel:[1,0] op_sel_hi:[1,1]
v_cvt_pk_bf16_f32 v212, v212, v213
v_cvt_pk_bf16_f32 v213, v214, v215
ds_write_b64 v15, v[212:213] offset:19456
v_pk_fma_f32 v[216:217], v[40:41], v[60:61], v[216:217] op_sel_hi:[0,1,1] neg_lo:[1,0,0] neg_hi:[1,0,0]
v_pk_fma_f32 v[218:219], v[40:41], v[62:63], v[218:219] op_sel_hi:[0,1,1] neg_lo:[1,0,0] neg_hi:[1,0,0]
v_pk_mul_f32 v[180:181], v[40:41], v[180:181] op_sel:[1,0] op_sel_hi:[1,1]
v_pk_mul_f32 v[182:183], v[40:41], v[182:183] op_sel:[1,0] op_sel_hi:[1,1]
v_cvt_pk_bf16_f32 v144, v144, v145
v_cvt_pk_bf16_f32 v145, v146, v147
ds_write_b64 v15, v[144:145] offset:25600
v_pk_fma_f32 v[148:149], v[42:43], v[52:53], v[148:149] op_sel_hi:[0,1,1] neg_lo:[1,0,0] neg_hi:[1,0,0]
v_pk_fma_f32 v[150:151], v[42:43], v[54:55], v[150:151] op_sel_hi:[0,1,1] neg_lo:[1,0,0] neg_hi:[1,0,0]
v_pk_mul_f32 v[216:217], v[40:41], v[216:217] op_sel:[1,0] op_sel_hi:[1,1]
v_pk_mul_f32 v[218:219], v[40:41], v[218:219] op_sel:[1,0] op_sel_hi:[1,1]
v_cvt_pk_bf16_f32 v180, v180, v181
v_cvt_pk_bf16_f32 v181, v182, v183
ds_write_b64 v15, v[180:181] offset:25728
v_pk_fma_f32 v[184:185], v[42:43], v[56:57], v[184:185] op_sel_hi:[0,1,1] neg_lo:[1,0,0] neg_hi:[1,0,0]
v_pk_fma_f32 v[186:187], v[42:43], v[58:59], v[186:187] op_sel_hi:[0,1,1] neg_lo:[1,0,0] neg_hi:[1,0,0]
v_pk_mul_f32 v[148:149], v[42:43], v[148:149] op_sel:[1,0] op_sel_hi:[1,1]
v_pk_mul_f32 v[150:151], v[42:43], v[150:151] op_sel:[1,0] op_sel_hi:[1,1]
v_cvt_pk_bf16_f32 v216, v216, v217
v_cvt_pk_bf16_f32 v217, v218, v219
ds_write_b64 v15, v[216:217] offset:25856
v_pk_fma_f32 v[220:221], v[42:43], v[60:61], v[220:221] op_sel_hi:[0,1,1] neg_lo:[1,0,0] neg_hi:[1,0,0]
v_pk_fma_f32 v[222:223], v[42:43], v[62:63], v[222:223] op_sel_hi:[0,1,1] neg_lo:[1,0,0] neg_hi:[1,0,0]
v_pk_mul_f32 v[184:185], v[42:43], v[184:185] op_sel:[1,0] op_sel_hi:[1,1]
v_pk_mul_f32 v[186:187], v[42:43], v[186:187] op_sel:[1,0] op_sel_hi:[1,1]
v_cvt_pk_bf16_f32 v148, v148, v149
v_cvt_pk_bf16_f32 v149, v150, v151
ds_write_b64 v15, v[148:149] offset:32000
v_pk_fma_f32 v[152:153], v[44:45], v[52:53], v[152:153] op_sel_hi:[0,1,1] neg_lo:[1,0,0] neg_hi:[1,0,0]
v_pk_fma_f32 v[154:155], v[44:45], v[54:55], v[154:155] op_sel_hi:[0,1,1] neg_lo:[1,0,0] neg_hi:[1,0,0]
v_pk_mul_f32 v[220:221], v[42:43], v[220:221] op_sel:[1,0] op_sel_hi:[1,1]
v_pk_mul_f32 v[222:223], v[42:43], v[222:223] op_sel:[1,0] op_sel_hi:[1,1]
v_cvt_pk_bf16_f32 v184, v184, v185
v_cvt_pk_bf16_f32 v185, v186, v187
ds_write_b64 v15, v[184:185] offset:32128
v_pk_fma_f32 v[188:189], v[44:45], v[56:57], v[188:189] op_sel_hi:[0,1,1] neg_lo:[1,0,0] neg_hi:[1,0,0]
v_pk_fma_f32 v[190:191], v[44:45], v[58:59], v[190:191] op_sel_hi:[0,1,1] neg_lo:[1,0,0] neg_hi:[1,0,0]
v_pk_mul_f32 v[152:153], v[44:45], v[152:153] op_sel:[1,0] op_sel_hi:[1,1]
v_pk_mul_f32 v[154:155], v[44:45], v[154:155] op_sel:[1,0] op_sel_hi:[1,1]
v_cvt_pk_bf16_f32 v220, v220, v221
v_cvt_pk_bf16_f32 v221, v222, v223
ds_write_b64 v15, v[220:221] offset:32256
v_pk_fma_f32 v[224:225], v[44:45], v[60:61], v[224:225] op_sel_hi:[0,1,1] neg_lo:[1,0,0] neg_hi:[1,0,0]
v_pk_fma_f32 v[226:227], v[44:45], v[62:63], v[226:227] op_sel_hi:[0,1,1] neg_lo:[1,0,0] neg_hi:[1,0,0]
v_pk_mul_f32 v[188:189], v[44:45], v[188:189] op_sel:[1,0] op_sel_hi:[1,1]
v_pk_mul_f32 v[190:191], v[44:45], v[190:191] op_sel:[1,0] op_sel_hi:[1,1]
v_cvt_pk_bf16_f32 v152, v152, v153
v_cvt_pk_bf16_f32 v153, v154, v155
ds_write_b64 v15, v[152:153] offset:38400
v_pk_fma_f32 v[156:157], v[46:47], v[52:53], v[156:157] op_sel_hi:[0,1,1] neg_lo:[1,0,0] neg_hi:[1,0,0]
v_pk_fma_f32 v[158:159], v[46:47], v[54:55], v[158:159] op_sel_hi:[0,1,1] neg_lo:[1,0,0] neg_hi:[1,0,0]
v_pk_mul_f32 v[224:225], v[44:45], v[224:225] op_sel:[1,0] op_sel_hi:[1,1]
v_pk_mul_f32 v[226:227], v[44:45], v[226:227] op_sel:[1,0] op_sel_hi:[1,1]
v_cvt_pk_bf16_f32 v188, v188, v189
v_cvt_pk_bf16_f32 v189, v190, v191
ds_write_b64 v15, v[188:189] offset:38528
v_pk_fma_f32 v[192:193], v[46:47], v[56:57], v[192:193] op_sel_hi:[0,1,1] neg_lo:[1,0,0] neg_hi:[1,0,0]
v_pk_fma_f32 v[194:195], v[46:47], v[58:59], v[194:195] op_sel_hi:[0,1,1] neg_lo:[1,0,0] neg_hi:[1,0,0]
v_pk_mul_f32 v[156:157], v[46:47], v[156:157] op_sel:[1,0] op_sel_hi:[1,1]
v_pk_mul_f32 v[158:159], v[46:47], v[158:159] op_sel:[1,0] op_sel_hi:[1,1]
v_cvt_pk_bf16_f32 v224, v224, v225
v_cvt_pk_bf16_f32 v225, v226, v227
ds_write_b64 v15, v[224:225] offset:38656
v_pk_fma_f32 v[228:229], v[46:47], v[60:61], v[228:229] op_sel_hi:[0,1,1] neg_lo:[1,0,0] neg_hi:[1,0,0]
v_pk_fma_f32 v[230:231], v[46:47], v[62:63], v[230:231] op_sel_hi:[0,1,1] neg_lo:[1,0,0] neg_hi:[1,0,0]
v_pk_mul_f32 v[192:193], v[46:47], v[192:193] op_sel:[1,0] op_sel_hi:[1,1]
v_pk_mul_f32 v[194:195], v[46:47], v[194:195] op_sel:[1,0] op_sel_hi:[1,1]
v_cvt_pk_bf16_f32 v156, v156, v157
v_cvt_pk_bf16_f32 v157, v158, v159
ds_write_b64 v15, v[156:157] offset:44800
v_pk_fma_f32 v[160:161], v[48:49], v[52:53], v[160:161] op_sel_hi:[0,1,1] neg_lo:[1,0,0] neg_hi:[1,0,0]
v_pk_fma_f32 v[162:163], v[48:49], v[54:55], v[162:163] op_sel_hi:[0,1,1] neg_lo:[1,0,0] neg_hi:[1,0,0]
v_pk_mul_f32 v[228:229], v[46:47], v[228:229] op_sel:[1,0] op_sel_hi:[1,1]
v_pk_mul_f32 v[230:231], v[46:47], v[230:231] op_sel:[1,0] op_sel_hi:[1,1]
v_cvt_pk_bf16_f32 v192, v192, v193
v_cvt_pk_bf16_f32 v193, v194, v195
ds_write_b64 v15, v[192:193] offset:44928
v_pk_fma_f32 v[196:197], v[48:49], v[56:57], v[196:197] op_sel_hi:[0,1,1] neg_lo:[1,0,0] neg_hi:[1,0,0]
v_pk_fma_f32 v[198:199], v[48:49], v[58:59], v[198:199] op_sel_hi:[0,1,1] neg_lo:[1,0,0] neg_hi:[1,0,0]
v_pk_mul_f32 v[160:161], v[48:49], v[160:161] op_sel:[1,0] op_sel_hi:[1,1]
v_pk_mul_f32 v[162:163], v[48:49], v[162:163] op_sel:[1,0] op_sel_hi:[1,1]
v_cvt_pk_bf16_f32 v228, v228, v229
v_cvt_pk_bf16_f32 v229, v230, v231
ds_write_b64 v15, v[228:229] offset:45056
v_pk_fma_f32 v[232:233], v[48:49], v[60:61], v[232:233] op_sel_hi:[0,1,1] neg_lo:[1,0,0] neg_hi:[1,0,0]
v_pk_fma_f32 v[234:235], v[48:49], v[62:63], v[234:235] op_sel_hi:[0,1,1] neg_lo:[1,0,0] neg_hi:[1,0,0]
v_pk_mul_f32 v[196:197], v[48:49], v[196:197] op_sel:[1,0] op_sel_hi:[1,1]
v_pk_mul_f32 v[198:199], v[48:49], v[198:199] op_sel:[1,0] op_sel_hi:[1,1]
v_cvt_pk_bf16_f32 v160, v160, v161
v_cvt_pk_bf16_f32 v161, v162, v163
ds_write_b64 v15, v[160:161] offset:51200
v_pk_mul_f32 v[232:233], v[48:49], v[232:233] op_sel:[1,0] op_sel_hi:[1,1]
v_pk_mul_f32 v[234:235], v[48:49], v[234:235] op_sel:[1,0] op_sel_hi:[1,1]
v_cvt_pk_bf16_f32 v196, v196, v197
v_cvt_pk_bf16_f32 v197, v198, v199
ds_write_b64 v15, v[196:197] offset:51328
v_cvt_pk_bf16_f32 v232, v232, v233
v_cvt_pk_bf16_f32 v233, v234, v235
ds_write_b64 v15, v[232:233] offset:51456
s_waitcnt lgkmcnt(0)
s_branch Latt_5
Lpf_4:
s_lshl_b32 s43, s35, 7
s_waitcnt lgkmcnt(0)
s_mov_b32 s8, s64
s_mov_b32 s9, s65
s_mov_b32 s10, 4194304
s_mov_b32 s11, 0x20000
s_add_u32 s12, s66, s43
s_addc_u32 s13, s67, 0
s_mov_b32 s14, 6289536
s_mov_b32 s15, 0x20000
s_add_u32 s84, s82, 28311552
s_addc_u32 s85, s83, 0
s_branch Lov_3
.p2align 12
.fill 16, 4, 0xbf800000
Lst_3_0:
s_branch Lwr_163
s_nop 0
s_nop 0
Lov_3:
s_mov_b32 s86, 114688
s_mov_b32 s87, 0x20000
s_mov_b32 s56, s80
s_mov_b32 s57, s81
s_mov_b32 s58, 256
s_mov_b32 s59, 0x20000
v_mov_b32 v5, 0
v_lshlrev_b32 v14, 7, v1
s_or_b32 s43, s34, s35
s_cmp_lg_u32 s43, 0
s_cbranch_scc1 Lz_32
s_movk_i32 s43, 0x2000
buffer_store_dword v5, v14, s[84:87], 0 offen sc1
s_bfm_b64 exec, 44, 0
buffer_store_dword v5, v14, s[84:87], s43 offen sc1
s_mov_b64 exec, 1
v_mov_b32 v6, 1
s_waitcnt vmcnt(0)
buffer_store_dword v6, v5, s[56:59], 0 offen sc1
s_mov_b64 exec, -1
Lz_32:
s_lshl_b32 s43, s51, 11
buffer_load_dwordx4 v[96:99], v10, s[8:11], s43 offen offset:0
buffer_load_dwordx4 v[100:103], v10, s[8:11], s43 offen offset:1024
buffer_load_dwordx4 v[104:107], v10, s[8:11], s43 offen offset:2048
buffer_load_dwordx4 v[108:111], v10, s[8:11], s43 offen offset:3072
v_min_u32 v14, 23, v1
v_lshrrev_b32 v15, 3, v14
v_mul_u32_u24 v15, 43008, v15
v_and_b32 v14, 7, v14
v_lshl_add_u32 v15, v14, 4, v15
v_mov_b32 v32, 0x3f803f80
v_mov_b32 v33, 0x3f803f80
v_mov_b32 v34, 0x3f803f80
v_mov_b32 v35, 0x3f803f80
ds_write_b128 v15, v[32:35]
s_add_u32 s20, s82, 26214400
s_addc_u32 s21, s83, 0
s_mov_b32 s22, 16384
s_mov_b32 s23, 0x20000
s_add_u32 s43, s2, 128
s_lshl_b32 s43, s43, 7
v_lshlrev_b32 v14, 2, v1
s_mov_b64 exec, 15
buffer_store_dword v5, v14, s[84:87], s43 offen sc1
s_mov_b64 exec, -1
s_lshl_b32 s43, s34, 4
s_add_u32 s43, s43, s35
s_lshl_b32 s43, s43, 8
s_add_u32 s43, s43, 49152
v_lshlrev_b32 v14, 7, v1
s_mov_b64 exec, 3
buffer_store_dword v5, v14, s[84:87], s43 offen sc1
s_mov_b64 exec, -1
s_lshl_b32 s52, s34, 7
s_add_u32 s52, s52, 28319744
s_sub_u32 s53, s52, 128
s_cmp_eq_u32 s34, 0
s_cselect_b32 s53, s52, s53
s_waitcnt lgkmcnt(0)
s_barrier
s_waitcnt vmcnt(2)
s_mov_b32 s43, 0x3f803f80
v_mov_b32 v116, 0
v_mov_b32 v117, 0
v_mov_b32 v118, 0
v_mov_b32 v119, 0
v_mov_b32 v120, 0
v_mov_b32 v121, 0
v_mov_b32 v122, 0
v_mov_b32 v123, 0
v_dot2_f32_bf16 v116, v96, s43, v116
v_dot2_f32_bf16 v120, v96, v96, v120
v_dot2_f32_bf16 v118, v104, s43, v118
v_dot2_f32_bf16 v122, v104, v104, v122
v_dot2_f32_bf16 v117, v97, s43, v117
v_dot2_f32_bf16 v121, v97, v97, v121
v_dot2_f32_bf16 v119, v105, s43, v119
v_dot2_f32_bf16 v123, v105, v105, v123
v_dot2_f32_bf16 v116, v98, s43, v116
v_dot2_f32_bf16 v120, v98, v98, v120
v_dot2_f32_bf16 v118, v106, s43, v118
v_dot2_f32_bf16 v122, v106, v106, v122
v_dot2_f32_bf16 v117, v99, s43, v117
v_dot2_f32_bf16 v121, v99, v99, v121
v_dot2_f32_bf16 v119, v107, s43, v119
v_dot2_f32_bf16 v123, v107, v107, v123
v_dot2_f32_bf16 v116, v100, s43, v116
v_dot2_f32_bf16 v120, v100, v100, v120
v_dot2_f32_bf16 v118, v108, s43, v118
v_dot2_f32_bf16 v122, v108, v108, v122
v_dot2_f32_bf16 v117, v101, s43, v117
v_dot2_f32_bf16 v121, v101, v101, v121
v_dot2_f32_bf16 v119, v109, s43, v119
v_dot2_f32_bf16 v123, v109, v109, v123
v_dot2_f32_bf16 v116, v102, s43, v116
v_dot2_f32_bf16 v120, v102, v102, v120
v_dot2_f32_bf16 v118, v110, s43, v118
v_dot2_f32_bf16 v122, v110, v110, v122
v_dot2_f32_bf16 v117, v103, s43, v117
v_dot2_f32_bf16 v121, v103, v103, v121
v_dot2_f32_bf16 v119, v111, s43, v119
v_dot2_f32_bf16 v123, v111, v111, v123
s_nop 2
v_add_f32 v116, v116, v117
v_add_f32 v118, v118, v119
v_add_f32 v120, v120, v121
v_add_f32 v122, v122, v123
s_nop 1
v_permlane32_swap_b32 v116, v118
v_permlane32_swap_b32 v120, v122
v_add_f32 v116, v116, v118
v_add_f32 v120, v120, v122
s_nop 1
v_permlane16_swap_b32 v116, v120
v_add_f32 v116, v116, v120
s_nop 1
v_add_f32_dpp v116, v116, v116 row_ror:8 row_mask:0xf bank_mask:0xf
s_nop 1
v_add_f32_dpp v116, v116, v116 row_ror:4 row_mask:0xf bank_mask:0xf
s_nop 1
v_add_f32_dpp v116, v116, v116 row_ror:2 row_mask:0xf bank_mask:0xf
s_nop 1
v_add_f32_dpp v116, v116, v116 row_ror:1 row_mask:0xf bank_mask:0xf
v_mov_b32 v117, v116
s_nop 1
v_permlane16_swap_b32 v116, v117
v_mul_f32 v112, 0x3a800000, v116
v_mul_f32 v113, 0x3a800000, v117
v_fma_f32 v113, -v112, v112, v113
v_max_f32 v113, 0, v113
v_add_f32 v113, 0x3727c5ac, v113
v_rsq_f32 v113, v113
v_lshrrev_b32 v11, 5, v1
s_lshl_b32 s43, s47, 4
s_add_u32 s43, s43, 148608
v_lshl_add_u32 v11, v11, 3, s43
ds_write_b64 v11, v[112:113]
s_waitcnt lgkmcnt(0)
s_mov_b32 s28, s66
s_mov_b32 s29, s67
s_mov_b32 s30, 6291456
s_mov_b32 s31, 0x20000
s_mul_i32 s43, s33, 8832
s_add_u32 s43, s43, 1572864
v_lshlrev_b32 v30, 7, v1
buffer_load_dword v31, v30, s[28:31], s43 offen
s_add_u32 s43, s43, 8192
s_bfm_b64 exec, 5, 0
buffer_load_dword v31, v30, s[28:31], s43 offen
s_mov_b64 exec, -1
s_branch Lst_0_0
Lwr_160:
s_barrier
v_lshlrev_b32 v5, 4, v1
v_and_b32 v5, 63, v5
v_add_u32 v6, 148608, v5
ds_read_b128 v[112:115], v6
s_lshl_b32 s43, s63, 3
v_add_u32 v5, s43, v5
s_waitcnt lgkmcnt(0)
s_mov_b64 exec, 15
buffer_store_dwordx4 v[112:115], v5, s[20:23], 0 offen sc1
s_mov_b64 exec, -1
v_mov_b32 v4, 0
buffer_load_dword v6, v4, s[56:59], 0 offen sc1
s_mov_b32 s62, 0
s_mov_b32 s28, s66
s_mov_b32 s29, s67
s_mov_b32 s30, 6291456
s_mov_b32 s31, 0x20000
s_mul_i32 s43, s33, 12288
s_add_u32 s43, s43, 3538944
v_lshlrev_b32 v30, 7, v1
buffer_load_dword v31, v30, s[28:31], s43 offen
s_add_u32 s43, s43, 8192
s_bfm_b64 exec, 32, 0
buffer_load_dword v31, v30, s[28:31], s43 offen
s_mov_b64 exec, -1
s_branch Lst_1_0
Lwr_161:
s_barrier
s_lshl_b32 s43, s35, 7
s_add_u32 s28, s68, s43
s_addc_u32 s29, s69, 0
s_mov_b32 s30, 2095232
s_mov_b32 s31, 0x20000
v_and_b32 v29, 7, v1
v_lshrrev_b32 v30, 3, v1
v_lshl_add_u32 v29, v30, 6, v29
s_lshl_b32 s43, s48, 3
v_add_u32 v29, s43, v29
v_lshlrev_b32 v29, 11, v29
s_mov_b32 s43, 1048576
s_mov_b32 s28, s68
s_mov_b32 s29, s69
s_mov_b32 s30, 2097152
s_mov_b32 s31, 0x20000
s_mul_i32 s43, s33, 9472
v_lshlrev_b32 v30, 7, v1
buffer_load_dword v31, v30, s[28:31], s43 offen
s_add_u32 s43, s43, 8192
s_bfm_b64 exec, 10, 0
buffer_load_dword v31, v30, s[28:31], s43 offen
s_mov_b64 exec, -1
s_branch Lst_2_0
Lwr_162:
s_barrier
s_branch Lst_3_0
Lwr_163:
s_barrier
s_branch Lst_4_0
Lwr_164:
s_barrier
s_branch Lst_5_0
Lwr_165:
s_barrier
s_cmp_eq_u32 s62, 3
s_cbranch_scc1 Lste_36
s_cmp_eq_u32 s62, 2
s_cbranch_scc1 Lst2_34
s_cmp_ge_u32 s62, 4
s_cbranch_scc1 Lst4_35
s_cmp_eq_u32 s62, 1
s_cbranch_scc1 Lst1_33
s_waitcnt vmcnt(4)
v_readfirstlane_b32 s54, v6
s_cmp_eq_u32 s54, 0
s_cbranch_scc0 Lrep_37
buffer_load_dword v6, v4, s[56:59], 0 offen sc1
s_branch Lste_36
Lrep_37:
s_add_u32 s7, s34, 64
s_lshl_b32 s7, s7, 7
v_mov_b32 v5, s7
v_mov_b32 v6, 1
s_mov_b64 exec, 1
buffer_atomic_add v6, v5, s[84:87], 0 offen sc1
s_mov_b64 exec, -1
s_mov_b32 s62, 1
s_mov_b32 s54, 0
s_mov_b32 s55, 0
s_branch Lste_36
Lst1_33:
s_and_b32 s43, s54, s55
s_cmp_eq_u32 s43, 16
s_cbranch_scc1 Lg_38
s_load_dword s54, s[82:83], s52 glc
s_load_dword s55, s[82:83], s53 glc
s_branch Lste_36
Lg_38:
v_add_u32 v5, 0, v1
v_min_u32 v5, 143, v5
v_lshlrev_b32 v20, 3, v5
v_add_u32 v5, s50, v5
v_max_i32 v5, 0, v5
v_lshlrev_b32 v5, 3, v5
buffer_load_dwordx2 v[32:33], v5, s[20:23], 0 offen sc1
v_add_u32 v5, 64, v1
v_min_u32 v5, 143, v5
v_lshlrev_b32 v21, 3, v5
v_add_u32 v5, s50, v5
v_max_i32 v5, 0, v5
v_lshlrev_b32 v5, 3, v5
buffer_load_dwordx2 v[34:35], v5, s[20:23], 0 offen sc1
v_add_u32 v5, 128, v1
v_min_u32 v5, 143, v5
v_lshlrev_b32 v22, 3, v5
v_add_u32 v5, s50, v5
v_max_i32 v5, 0, v5
v_lshlrev_b32 v5, 3, v5
buffer_load_dwordx2 v[36:37], v5, s[20:23], 0 offen sc1
s_mov_b32 s62, 4
s_branch Lste_36
Lst4_35:
s_mov_b32 s62, 2
s_branch Lste_36
Lst2_34:
s_waitcnt vmcnt(0)
v_add_u32 v20, 147456, v20
ds_write_b64 v20, v[32:33]
v_add_u32 v21, 147456, v21
ds_write_b64 v21, v[34:35]
v_add_u32 v22, 147456, v22
ds_write_b64 v22, v[36:37]
s_waitcnt lgkmcnt(0)
s_mov_b32 s62, 3
Lste_36:
s_branch Lst_6_0
Lwr_166:
s_barrier
s_cmp_eq_u32 s62, 3
s_cbranch_scc1 Lste_42
s_cmp_eq_u32 s62, 2
s_cbranch_scc1 Lst2_40
s_cmp_ge_u32 s62, 4
s_cbranch_scc1 Lst4_41
s_cmp_eq_u32 s62, 1
s_cbranch_scc1 Lst1_39
s_waitcnt vmcnt(0)
v_readfirstlane_b32 s54, v6
s_cmp_eq_u32 s54, 0
s_cbranch_scc0 Lrep_43
buffer_load_dword v6, v4, s[56:59], 0 offen sc1
s_branch Lste_42
Lrep_43:
s_add_u32 s7, s34, 64
s_lshl_b32 s7, s7, 7
v_mov_b32 v5, s7
v_mov_b32 v6, 1
s_mov_b64 exec, 1
buffer_atomic_add v6, v5, s[84:87], 0 offen sc1
s_mov_b64 exec, -1
s_mov_b32 s62, 1
s_mov_b32 s54, 0
s_mov_b32 s55, 0
s_branch Lste_42
Lst1_39:
s_and_b32 s43, s54, s55
s_cmp_eq_u32 s43, 16
s_cbranch_scc1 Lg_44
s_load_dword s54, s[82:83], s52 glc
s_load_dword s55, s[82:83], s53 glc
s_branch Lste_42
Lg_44:
v_add_u32 v5, 0, v1
v_min_u32 v5, 143, v5
v_lshlrev_b32 v20, 3, v5
v_add_u32 v5, s50, v5
v_max_i32 v5, 0, v5
v_lshlrev_b32 v5, 3, v5
buffer_load_dwordx2 v[32:33], v5, s[20:23], 0 offen sc1
v_add_u32 v5, 64, v1
v_min_u32 v5, 143, v5
v_lshlrev_b32 v21, 3, v5
v_add_u32 v5, s50, v5
v_max_i32 v5, 0, v5
v_lshlrev_b32 v5, 3, v5
buffer_load_dwordx2 v[34:35], v5, s[20:23], 0 offen sc1
v_add_u32 v5, 128, v1
v_min_u32 v5, 143, v5
v_lshlrev_b32 v22, 3, v5
v_add_u32 v5, s50, v5
v_max_i32 v5, 0, v5
v_lshlrev_b32 v5, 3, v5
buffer_load_dwordx2 v[36:37], v5, s[20:23], 0 offen sc1
s_mov_b32 s62, 4
s_branch Lste_42
Lst4_41:
s_mov_b32 s62, 2
s_branch Lste_42
Lst2_40:
s_waitcnt vmcnt(0)
v_add_u32 v20, 147456, v20
ds_write_b64 v20, v[32:33]
v_add_u32 v21, 147456, v21
ds_write_b64 v21, v[34:35]
v_add_u32 v22, 147456, v22
ds_write_b64 v22, v[36:37]
s_waitcnt lgkmcnt(0)
s_mov_b32 s62, 3
Lste_42:
s_branch Lst_7_0
Lwr_167:
s_barrier
s_cmp_eq_u32 s62, 3
s_cbranch_scc1 Lste_48
s_cmp_eq_u32 s62, 2
s_cbranch_scc1 Lst2_46
s_cmp_ge_u32 s62, 4
s_cbranch_scc1 Lst4_47
s_cmp_eq_u32 s62, 1
s_cbranch_scc1 Lst1_45
s_waitcnt vmcnt(0)
v_readfirstlane_b32 s54, v6
s_cmp_eq_u32 s54, 0
s_cbranch_scc0 Lrep_49
buffer_load_dword v6, v4, s[56:59], 0 offen sc1
s_branch Lste_48
Lrep_49:
s_add_u32 s7, s34, 64
s_lshl_b32 s7, s7, 7
v_mov_b32 v5, s7
v_mov_b32 v6, 1
s_mov_b64 exec, 1
buffer_atomic_add v6, v5, s[84:87], 0 offen sc1
s_mov_b64 exec, -1
s_mov_b32 s62, 1
s_mov_b32 s54, 0
s_mov_b32 s55, 0
s_branch Lste_48
Lst1_45:
s_and_b32 s43, s54, s55
s_cmp_eq_u32 s43, 16
s_cbranch_scc1 Lg_50
s_load_dword s54, s[82:83], s52 glc
s_load_dword s55, s[82:83], s53 glc
s_branch Lste_48
Lg_50:
v_add_u32 v5, 0, v1
v_min_u32 v5, 143, v5
v_lshlrev_b32 v20, 3, v5
v_add_u32 v5, s50, v5
v_max_i32 v5, 0, v5
v_lshlrev_b32 v5, 3, v5
buffer_load_dwordx2 v[32:33], v5, s[20:23], 0 offen sc1
v_add_u32 v5, 64, v1
v_min_u32 v5, 143, v5
v_lshlrev_b32 v21, 3, v5
v_add_u32 v5, s50, v5
v_max_i32 v5, 0, v5
v_lshlrev_b32 v5, 3, v5
buffer_load_dwordx2 v[34:35], v5, s[20:23], 0 offen sc1
v_add_u32 v5, 128, v1
v_min_u32 v5, 143, v5
v_lshlrev_b32 v22, 3, v5
v_add_u32 v5, s50, v5
v_max_i32 v5, 0, v5
v_lshlrev_b32 v5, 3, v5
buffer_load_dwordx2 v[36:37], v5, s[20:23], 0 offen sc1
s_mov_b32 s62, 4
s_branch Lste_48
Lst4_47:
s_mov_b32 s62, 2
s_branch Lste_48
Lst2_46:
s_waitcnt vmcnt(0)
v_add_u32 v20, 147456, v20
ds_write_b64 v20, v[32:33]
v_add_u32 v21, 147456, v21
ds_write_b64 v21, v[34:35]
v_add_u32 v22, 147456, v22
ds_write_b64 v22, v[36:37]
s_waitcnt lgkmcnt(0)
s_mov_b32 s62, 3
Lste_48:
s_branch Lst_8_0
Lwr_168:
s_barrier
s_cmp_eq_u32 s62, 3
s_cbranch_scc1 Lste_54
s_cmp_eq_u32 s62, 2
s_cbranch_scc1 Lst2_52
s_cmp_ge_u32 s62, 4
s_cbranch_scc1 Lst4_53
s_cmp_eq_u32 s62, 1
s_cbranch_scc1 Lst1_51
s_waitcnt vmcnt(0)
v_readfirstlane_b32 s54, v6
s_cmp_eq_u32 s54, 0
s_cbranch_scc0 Lrep_55
buffer_load_dword v6, v4, s[56:59], 0 offen sc1
s_branch Lste_54
Lrep_55:
s_add_u32 s7, s34, 64
s_lshl_b32 s7, s7, 7
v_mov_b32 v5, s7
v_mov_b32 v6, 1
s_mov_b64 exec, 1
buffer_atomic_add v6, v5, s[84:87], 0 offen sc1
s_mov_b64 exec, -1
s_mov_b32 s62, 1
s_mov_b32 s54, 0
s_mov_b32 s55, 0
s_branch Lste_54
Lst1_51:
s_and_b32 s43, s54, s55
s_cmp_eq_u32 s43, 16
s_cbranch_scc1 Lg_56
s_load_dword s54, s[82:83], s52 glc
s_load_dword s55, s[82:83], s53 glc
s_branch Lste_54
Lg_56:
v_add_u32 v5, 0, v1
v_min_u32 v5, 143, v5
v_lshlrev_b32 v20, 3, v5
v_add_u32 v5, s50, v5
v_max_i32 v5, 0, v5
v_lshlrev_b32 v5, 3, v5
buffer_load_dwordx2 v[32:33], v5, s[20:23], 0 offen sc1
v_add_u32 v5, 64, v1
v_min_u32 v5, 143, v5
v_lshlrev_b32 v21, 3, v5
v_add_u32 v5, s50, v5
v_max_i32 v5, 0, v5
v_lshlrev_b32 v5, 3, v5
buffer_load_dwordx2 v[34:35], v5, s[20:23], 0 offen sc1
v_add_u32 v5, 128, v1
v_min_u32 v5, 143, v5
v_lshlrev_b32 v22, 3, v5
v_add_u32 v5, s50, v5
v_max_i32 v5, 0, v5
v_lshlrev_b32 v5, 3, v5
buffer_load_dwordx2 v[36:37], v5, s[20:23], 0 offen sc1
s_mov_b32 s62, 4
s_branch Lste_54
Lst4_53:
s_mov_b32 s62, 2
s_branch Lste_54
Lst2_52:
s_waitcnt vmcnt(0)
v_add_u32 v20, 147456, v20
ds_write_b64 v20, v[32:33]
v_add_u32 v21, 147456, v21
ds_write_b64 v21, v[34:35]
v_add_u32 v22, 147456, v22
ds_write_b64 v22, v[36:37]
s_waitcnt lgkmcnt(0)
s_mov_b32 s62, 3
Lste_54:
s_branch Lst_9_0
Lwr_169:
s_barrier
s_getpc_b64 s[100:101]
s_and_b32 s100, s100, 0xfffff000
s_sub_u32 s100, s100, 1064960
s_subb_u32 s101, s101, 0
s_lshr_b32 s6, s2, 3
s_mul_i32 s6, s6, 1
s_and_b32 s7, s36, 0
s_add_u32 s6, s6, s7
s_mulk_i32 s6, 640
s_add_u32 s6, s6, 1063168
s_load_dword s3, s[100:101], s6 offset:0
s_load_dword s3, s[100:101], s6 offset:64
s_load_dword s3, s[100:101], s6 offset:128
s_load_dword s3, s[100:101], s6 offset:192
s_load_dword s3, s[100:101], s6 offset:256
s_load_dword s3, s[100:101], s6 offset:320
s_load_dword s3, s[100:101], s6 offset:384
s_load_dword s3, s[100:101], s6 offset:448
s_load_dword s3, s[100:101], s6 offset:512
s_load_dword s3, s[100:101], s6 offset:576
s_nop 0
s_nop 0
s_nop 0
s_nop 0
s_nop 0
s_nop 0
s_nop 0
s_nop 0
s_nop 0
s_nop 0
s_cmp_eq_u32 s62, 3
s_cbranch_scc1 Lste_60
s_cmp_eq_u32 s62, 2
s_cbranch_scc1 Lst2_58
s_cmp_ge_u32 s62, 4
s_cbranch_scc1 Lst4_59
s_cmp_eq_u32 s62, 1
s_cbranch_scc1 Lst1_57
s_waitcnt vmcnt(0)
v_readfirstlane_b32 s54, v6
s_cmp_eq_u32 s54, 0
s_cbranch_scc0 Lrep_61
buffer_load_dword v6, v4, s[56:59], 0 offen sc1
s_branch Lste_60
Lrep_61:
s_add_u32 s7, s34, 64
s_lshl_b32 s7, s7, 7
v_mov_b32 v5, s7
v_mov_b32 v6, 1
s_mov_b64 exec, 1
buffer_atomic_add v6, v5, s[84:87], 0 offen sc1
s_mov_b64 exec, -1
s_mov_b32 s62, 1
s_mov_b32 s54, 0
s_mov_b32 s55, 0
s_branch Lste_60
Lst1_57:
s_and_b32 s43, s54, s55
s_cmp_eq_u32 s43, 16
s_cbranch_scc1 Lg_62
s_load_dword s54, s[82:83], s52 glc
s_load_dword s55, s[82:83], s53 glc
s_branch Lste_60
Lg_62:
v_add_u32 v5, 0, v1
v_min_u32 v5, 143, v5
v_lshlrev_b32 v20, 3, v5
v_add_u32 v5, s50, v5
v_max_i32 v5, 0, v5
v_lshlrev_b32 v5, 3, v5
buffer_load_dwordx2 v[32:33], v5, s[20:23], 0 offen sc1
v_add_u32 v5, 64, v1
v_min_u32 v5, 143, v5
v_lshlrev_b32 v21, 3, v5
v_add_u32 v5, s50, v5
v_max_i32 v5, 0, v5
v_lshlrev_b32 v5, 3, v5
buffer_load_dwordx2 v[34:35], v5, s[20:23], 0 offen sc1
v_add_u32 v5, 128, v1
v_min_u32 v5, 143, v5
v_lshlrev_b32 v22, 3, v5
v_add_u32 v5, s50, v5
v_max_i32 v5, 0, v5
v_lshlrev_b32 v5, 3, v5
buffer_load_dwordx2 v[36:37], v5, s[20:23], 0 offen sc1
s_mov_b32 s62, 4
s_branch Lste_60
Lst4_59:
s_mov_b32 s62, 2
s_branch Lste_60
Lst2_58:
s_waitcnt vmcnt(0)
v_add_u32 v20, 147456, v20
ds_write_b64 v20, v[32:33]
v_add_u32 v21, 147456, v21
ds_write_b64 v21, v[34:35]
v_add_u32 v22, 147456, v22
ds_write_b64 v22, v[36:37]
s_waitcnt lgkmcnt(0)
s_mov_b32 s62, 3
Lste_60:
s_branch Lst_10_0
Lwr_170:
s_barrier
s_cmp_eq_u32 s62, 3
s_cbranch_scc1 Lste_66
s_cmp_eq_u32 s62, 2
s_cbranch_scc1 Lst2_64
s_cmp_ge_u32 s62, 4
s_cbranch_scc1 Lst4_65
s_cmp_eq_u32 s62, 1
s_cbranch_scc1 Lst1_63
s_waitcnt vmcnt(0)
v_readfirstlane_b32 s54, v6
s_cmp_eq_u32 s54, 0
s_cbranch_scc0 Lrep_67
buffer_load_dword v6, v4, s[56:59], 0 offen sc1
s_branch Lste_66
Lrep_67:
s_add_u32 s7, s34, 64
s_lshl_b32 s7, s7, 7
v_mov_b32 v5, s7
v_mov_b32 v6, 1
s_mov_b64 exec, 1
buffer_atomic_add v6, v5, s[84:87], 0 offen sc1
s_mov_b64 exec, -1
s_mov_b32 s62, 1
s_mov_b32 s54, 0
s_mov_b32 s55, 0
s_branch Lste_66
Lst1_63:
s_and_b32 s43, s54, s55
s_cmp_eq_u32 s43, 16
s_cbranch_scc1 Lg_68
s_load_dword s54, s[82:83], s52 glc
s_load_dword s55, s[82:83], s53 glc
s_branch Lste_66
Lg_68:
v_add_u32 v5, 0, v1
v_min_u32 v5, 143, v5
v_lshlrev_b32 v20, 3, v5
v_add_u32 v5, s50, v5
v_max_i32 v5, 0, v5
v_lshlrev_b32 v5, 3, v5
buffer_load_dwordx2 v[32:33], v5, s[20:23], 0 offen sc1
v_add_u32 v5, 64, v1
v_min_u32 v5, 143, v5
v_lshlrev_b32 v21, 3, v5
v_add_u32 v5, s50, v5
v_max_i32 v5, 0, v5
v_lshlrev_b32 v5, 3, v5
buffer_load_dwordx2 v[34:35], v5, s[20:23], 0 offen sc1
v_add_u32 v5, 128, v1
v_min_u32 v5, 143, v5
v_lshlrev_b32 v22, 3, v5
v_add_u32 v5, s50, v5
v_max_i32 v5, 0, v5
v_lshlrev_b32 v5, 3, v5
buffer_load_dwordx2 v[36:37], v5, s[20:23], 0 offen sc1
s_mov_b32 s62, 4
s_branch Lste_66
Lst4_65:
s_mov_b32 s62, 2
s_branch Lste_66
Lst2_64:
s_waitcnt vmcnt(0)
v_add_u32 v20, 147456, v20
ds_write_b64 v20, v[32:33]
v_add_u32 v21, 147456, v21
ds_write_b64 v21, v[34:35]
v_add_u32 v22, 147456, v22
ds_write_b64 v22, v[36:37]
s_waitcnt lgkmcnt(0)
s_mov_b32 s62, 3
Lste_66:
s_branch Lst_11_0
Lwr_171:
s_barrier
s_cmp_eq_u32 s62, 3
s_cbranch_scc1 Lste_72
s_cmp_eq_u32 s62, 2
s_cbranch_scc1 Lst2_70
s_cmp_ge_u32 s62, 4
s_cbranch_scc1 Lst4_71
s_cmp_eq_u32 s62, 1
s_cbranch_scc1 Lst1_69
s_waitcnt vmcnt(0)
v_readfirstlane_b32 s54, v6
s_cmp_eq_u32 s54, 0
s_cbranch_scc0 Lrep_73
buffer_load_dword v6, v4, s[56:59], 0 offen sc1
s_branch Lste_72
Lrep_73:
s_add_u32 s7, s34, 64
s_lshl_b32 s7, s7, 7
v_mov_b32 v5, s7
v_mov_b32 v6, 1
s_mov_b64 exec, 1
buffer_atomic_add v6, v5, s[84:87], 0 offen sc1
s_mov_b64 exec, -1
s_mov_b32 s62, 1
s_mov_b32 s54, 0
s_mov_b32 s55, 0
s_branch Lste_72
Lst1_69:
s_and_b32 s43, s54, s55
s_cmp_eq_u32 s43, 16
s_cbranch_scc1 Lg_74
s_load_dword s54, s[82:83], s52 glc
s_load_dword s55, s[82:83], s53 glc
s_branch Lste_72
Lg_74:
v_add_u32 v5, 0, v1
v_min_u32 v5, 143, v5
v_lshlrev_b32 v20, 3, v5
v_add_u32 v5, s50, v5
v_max_i32 v5, 0, v5
v_lshlrev_b32 v5, 3, v5
buffer_load_dwordx2 v[32:33], v5, s[20:23], 0 offen sc1
v_add_u32 v5, 64, v1
v_min_u32 v5, 143, v5
v_lshlrev_b32 v21, 3, v5
v_add_u32 v5, s50, v5
v_max_i32 v5, 0, v5
v_lshlrev_b32 v5, 3, v5
buffer_load_dwordx2 v[34:35], v5, s[20:23], 0 offen sc1
v_add_u32 v5, 128, v1
v_min_u32 v5, 143, v5
v_lshlrev_b32 v22, 3, v5
v_add_u32 v5, s50, v5
v_max_i32 v5, 0, v5
v_lshlrev_b32 v5, 3, v5
buffer_load_dwordx2 v[36:37], v5, s[20:23], 0 offen sc1
s_mov_b32 s62, 4
s_branch Lste_72
Lst4_71:
s_mov_b32 s62, 2
s_branch Lste_72
Lst2_70:
s_waitcnt vmcnt(0)
v_add_u32 v20, 147456, v20
ds_write_b64 v20, v[32:33]
v_add_u32 v21, 147456, v21
ds_write_b64 v21, v[34:35]
v_add_u32 v22, 147456, v22
ds_write_b64 v22, v[36:37]
s_waitcnt lgkmcnt(0)
s_mov_b32 s62, 3
Lste_72:
s_branch Lst_12_0
Lwr_172:
s_barrier
s_cmp_eq_u32 s62, 3
s_cbranch_scc1 Lste_78
s_cmp_eq_u32 s62, 2
s_cbranch_scc1 Lst2_76
s_cmp_ge_u32 s62, 4
s_cbranch_scc1 Lst4_77
s_cmp_eq_u32 s62, 1
s_cbranch_scc1 Lst1_75
s_waitcnt vmcnt(0)
v_readfirstlane_b32 s54, v6
s_cmp_eq_u32 s54, 0
s_cbranch_scc0 Lrep_79
buffer_load_dword v6, v4, s[56:59], 0 offen sc1
s_branch Lste_78
Lrep_79:
s_add_u32 s7, s34, 64
s_lshl_b32 s7, s7, 7
v_mov_b32 v5, s7
v_mov_b32 v6, 1
s_mov_b64 exec, 1
buffer_atomic_add v6, v5, s[84:87], 0 offen sc1
s_mov_b64 exec, -1
s_mov_b32 s62, 1
s_mov_b32 s54, 0
s_mov_b32 s55, 0
s_branch Lste_78
Lst1_75:
s_and_b32 s43, s54, s55
s_cmp_eq_u32 s43, 16
s_cbranch_scc1 Lg_80
s_load_dword s54, s[82:83], s52 glc
s_load_dword s55, s[82:83], s53 glc
s_branch Lste_78
Lg_80:
v_add_u32 v5, 0, v1
v_min_u32 v5, 143, v5
v_lshlrev_b32 v20, 3, v5
v_add_u32 v5, s50, v5
v_max_i32 v5, 0, v5
v_lshlrev_b32 v5, 3, v5
buffer_load_dwordx2 v[32:33], v5, s[20:23], 0 offen sc1
v_add_u32 v5, 64, v1
v_min_u32 v5, 143, v5
v_lshlrev_b32 v21, 3, v5
v_add_u32 v5, s50, v5
v_max_i32 v5, 0, v5
v_lshlrev_b32 v5, 3, v5
buffer_load_dwordx2 v[34:35], v5, s[20:23], 0 offen sc1
v_add_u32 v5, 128, v1
v_min_u32 v5, 143, v5
v_lshlrev_b32 v22, 3, v5
v_add_u32 v5, s50, v5
v_max_i32 v5, 0, v5
v_lshlrev_b32 v5, 3, v5
buffer_load_dwordx2 v[36:37], v5, s[20:23], 0 offen sc1
s_mov_b32 s62, 4
s_branch Lov_4
.p2align 12
.fill 32, 4, 0xbf800000
Lst_4_0:
s_branch Lwr_164
s_nop 0
s_nop 0
Lov_4:
s_branch Lste_78
Lst4_77:
s_mov_b32 s62, 2
s_branch Lste_78
Lst2_76:
s_waitcnt vmcnt(0)
v_add_u32 v20, 147456, v20
ds_write_b64 v20, v[32:33]
v_add_u32 v21, 147456, v21
ds_write_b64 v21, v[34:35]
v_add_u32 v22, 147456, v22
ds_write_b64 v22, v[36:37]
s_waitcnt lgkmcnt(0)
s_mov_b32 s62, 3
Lste_78:
s_branch Lst_13_0
Lwr_173:
s_barrier
s_cmp_eq_u32 s62, 3
s_cbranch_scc1 Lste_84
s_cmp_eq_u32 s62, 2
s_cbranch_scc1 Lst2_82
s_cmp_ge_u32 s62, 4
s_cbranch_scc1 Lst4_83
s_cmp_eq_u32 s62, 1
s_cbranch_scc1 Lst1_81
s_waitcnt vmcnt(0)
v_readfirstlane_b32 s54, v6
s_cmp_eq_u32 s54, 0
s_cbranch_scc0 Lrep_85
buffer_load_dword v6, v4, s[56:59], 0 offen sc1
s_branch Lste_84
Lrep_85:
s_add_u32 s7, s34, 64
s_lshl_b32 s7, s7, 7
v_mov_b32 v5, s7
v_mov_b32 v6, 1
s_mov_b64 exec, 1
buffer_atomic_add v6, v5, s[84:87], 0 offen sc1
s_mov_b64 exec, -1
s_mov_b32 s62, 1
s_mov_b32 s54, 0
s_mov_b32 s55, 0
s_branch Lste_84
Lst1_81:
s_and_b32 s43, s54, s55
s_cmp_eq_u32 s43, 16
s_cbranch_scc1 Lg_86
s_load_dword s54, s[82:83], s52 glc
s_load_dword s55, s[82:83], s53 glc
s_branch Lste_84
Lg_86:
v_add_u32 v5, 0, v1
v_min_u32 v5, 143, v5
v_lshlrev_b32 v20, 3, v5
v_add_u32 v5, s50, v5
v_max_i32 v5, 0, v5
v_lshlrev_b32 v5, 3, v5
buffer_load_dwordx2 v[32:33], v5, s[20:23], 0 offen sc1
v_add_u32 v5, 64, v1
v_min_u32 v5, 143, v5
v_lshlrev_b32 v21, 3, v5
v_add_u32 v5, s50, v5
v_max_i32 v5, 0, v5
v_lshlrev_b32 v5, 3, v5
buffer_load_dwordx2 v[34:35], v5, s[20:23], 0 offen sc1
v_add_u32 v5, 128, v1
v_min_u32 v5, 143, v5
v_lshlrev_b32 v22, 3, v5
v_add_u32 v5, s50, v5
v_max_i32 v5, 0, v5
v_lshlrev_b32 v5, 3, v5
buffer_load_dwordx2 v[36:37], v5, s[20:23], 0 offen sc1
s_mov_b32 s62, 4
s_branch Lste_84
Lst4_83:
s_mov_b32 s62, 2
s_branch Lste_84
Lst2_82:
s_waitcnt vmcnt(0)
v_add_u32 v20, 147456, v20
ds_write_b64 v20, v[32:33]
v_add_u32 v21, 147456, v21
ds_write_b64 v21, v[34:35]
v_add_u32 v22, 147456, v22
ds_write_b64 v22, v[36:37]
s_waitcnt lgkmcnt(0)
s_mov_b32 s62, 3
Lste_84:
s_branch Lst_14_0
Lwr_174:
s_barrier
s_cmp_eq_u32 s62, 3
s_cbranch_scc1 Lste_89
s_cmp_ge_u32 s62, 5
s_cbranch_scc1 Lg_94
s_cmp_ge_u32 s62, 2
s_cbranch_scc1 Lst2_88
s_cmp_eq_u32 s62, 1
s_cbranch_scc1 Lst1_87
s_mov_b32 s41, 0x40000
Lz0_90:
s_waitcnt vmcnt(0)
v_readfirstlane_b32 s54, v6
s_cmp_eq_u32 s54, 0
s_cbranch_scc0 Lzok_91
buffer_load_dword v6, v4, s[56:59], 0 offen sc1
s_sub_u32 s41, s41, 1
s_cmp_lg_u32 s41, 0
s_cbranch_scc1 Lz0_90
s_waitcnt lgkmcnt(0)
Lzok_91:
s_add_u32 s7, s34, 64
s_lshl_b32 s7, s7, 7
v_mov_b32 v5, s7
v_mov_b32 v6, 1
s_mov_b64 exec, 1
buffer_atomic_add v6, v5, s[84:87], 0 offen sc1
s_mov_b64 exec, -1
Lst1_87:
s_load_dword s54, s[82:83], s52 glc
s_load_dword s55, s[82:83], s53 glc
s_mov_b32 s41, 0x40000
Lpoll_92:
s_waitcnt lgkmcnt(0)
s_and_b32 s54, s54, s55
s_cmp_eq_u32 s54, 16
s_cbranch_scc1 Lg_94
s_load_dword s54, s[82:83], s52 glc
s_load_dword s55, s[82:83], s53 glc
s_sub_u32 s41, s41, 1
s_cmp_lg_u32 s41, 0
s_cbranch_scc1 Lpoll_92
s_waitcnt lgkmcnt(0)
Lg_94:
v_add_u32 v5, 0, v1
v_min_u32 v5, 143, v5
v_lshlrev_b32 v20, 3, v5
v_add_u32 v5, s50, v5
v_max_i32 v5, 0, v5
v_lshlrev_b32 v5, 3, v5
buffer_load_dwordx2 v[32:33], v5, s[20:23], 0 offen sc1
v_add_u32 v5, 64, v1
v_min_u32 v5, 143, v5
v_lshlrev_b32 v21, 3, v5
v_add_u32 v5, s50, v5
v_max_i32 v5, 0, v5
v_lshlrev_b32 v5, 3, v5
buffer_load_dwordx2 v[34:35], v5, s[20:23], 0 offen sc1
v_add_u32 v5, 128, v1
v_min_u32 v5, 143, v5
v_lshlrev_b32 v22, 3, v5
v_add_u32 v5, s50, v5
v_max_i32 v5, 0, v5
v_lshlrev_b32 v5, 3, v5
buffer_load_dwordx2 v[36:37], v5, s[20:23], 0 offen sc1
Lst2_88:
s_waitcnt vmcnt(0)
v_add_u32 v20, 147456, v20
ds_write_b64 v20, v[32:33]
v_add_u32 v21, 147456, v21
ds_write_b64 v21, v[34:35]
v_add_u32 v22, 147456, v22
ds_write_b64 v22, v[36:37]
s_waitcnt lgkmcnt(0)
Lste_89:
s_bitcmp0_b32 s2, 0
s_cselect_b32 s88, s72, s74
s_cselect_b32 s89, s73, s75
s_cmp_lt_u32 s2, 192
s_cselect_b32 s90, 7340032, 0
s_mov_b32 s91, 0x20000
s_bfe_u32 s44, s2, 0x30001
s_lshl_b32 s44, s44, 2
s_and_b32 s43, s36, 3
s_add_u32 s44, s44, s43
s_lshl_b32 s44, s44, 5
v_lshrrev_b32 v18, 4, v1
v_add_u32 v18, s44, v18
v_mul_u32_u24 v18, 7168, v18
v_and_b32 v19, 15, v1
v_lshl_add_u32 v18, v19, 4, v18
s_lshr_b32 s43, s2, 4
s_lshl_b32 s43, s43, 8
s_add_u32 s43, s43, 4096
v_add_u32 v18, s43, v18
s_mov_b32 s43, 0
buffer_load_dwordx4 v[128:131], v18, s[88:91], s43 offen
s_mov_b32 s43, 28672
buffer_load_dwordx4 v[132:135], v18, s[88:91], s43 offen
s_mov_b32 s43, 57344
buffer_load_dwordx4 v[136:139], v18, s[88:91], s43 offen
s_mov_b32 s43, 86016
buffer_load_dwordx4 v[140:143], v18, s[88:91], s43 offen
s_mov_b32 s43, 114688
buffer_load_dwordx4 v[144:147], v18, s[88:91], s43 offen
s_mov_b32 s43, 143360
buffer_load_dwordx4 v[148:151], v18, s[88:91], s43 offen
s_mov_b32 s43, 172032
buffer_load_dwordx4 v[152:155], v18, s[88:91], s43 offen
s_mov_b32 s43, 200704
buffer_load_dwordx4 v[156:159], v18, s[88:91], s43 offen
s_barrier
s_lshl_b32 s43, s35, 7
s_add_u32 s28, s68, s43
s_addc_u32 s29, s69, 0
s_mov_b32 s30, 2095232
s_mov_b32 s31, 0x20000
v_lshrrev_b32 v15, 3, v1
v_and_b32 v16, 6, v15
v_and_b32 v7, 7, v1
v_xor_b32 v7, v7, v16
v_lshlrev_b32 v7, 4, v7
v_mul_u32_u24 v15, 2048, v15
v_add_u32 v7, v7, v15
s_and_b32 s40, s36, 3
s_lshl_b32 s39, s40, 13
s_add_u32 s40, s40, s35
s_add_u32 s42, s40, 0
s_and_b32 s42, s42, 15
s_lshl_b32 s42, s42, 17
s_add_u32 m0, s39, 65536
s_add_u32 s43, s42, 0
buffer_load_dwordx4 v7, s[28:31], s43 offen lds
s_add_u32 m0, s39, 66560
s_add_u32 s43, s42, 16384
buffer_load_dwordx4 v7, s[28:31], s43 offen lds
s_add_u32 m0, s39, 67584
s_add_u32 s43, s42, 32768
buffer_load_dwordx4 v7, s[28:31], s43 offen lds
s_add_u32 m0, s39, 68608
s_add_u32 s43, s42, 49152
buffer_load_dwordx4 v7, s[28:31], s43 offen lds
s_add_u32 m0, s39, 69632
s_add_u32 s43, s42, 65536
buffer_load_dwordx4 v7, s[28:31], s43 offen lds
s_add_u32 m0, s39, 70656
s_add_u32 s43, s42, 81920
buffer_load_dwordx4 v7, s[28:31], s43 offen lds
s_add_u32 m0, s39, 71680
s_add_u32 s43, s42, 98304
buffer_load_dwordx4 v7, s[28:31], s43 offen lds
s_add_u32 m0, s39, 72704
s_add_u32 s43, s42, 114688
buffer_load_dwordx4 v7, s[28:31], s43 offen lds
Lats_6:
s_and_b32 s43, s36, 1
s_bfe_u32 s44, s36, 0x10001
s_lshr_b32 s45, s36, 2
v_lshlrev_b32 v14, 2, v13
v_sub_u32 v14, v12, v14
v_mov_b32 v16, 0xff800000
s_or_b32 s46, s34, s45
s_cmp_lg_u32 s46, 0
s_cselect_b32 s46, 0, 0xff800000
v_subrev_u32 v15, 0, v14
v_cmp_ge_u32 vcc, 7, v15
v_add_u32 v15, 16, v15
s_nop 0
v_cndmask_b32 v248, v16, 0, vcc
v_cmp_ge_u32 vcc, 7, v15
s_nop 1
v_cndmask_b32 v244, v16, 0, vcc
v_or_b32 v240, s46, v244
v_subrev_u32 v15, 1, v14
v_cmp_ge_u32 vcc, 7, v15
v_add_u32 v15, 16, v15
s_nop 0
v_cndmask_b32 v249, v16, 0, vcc
v_cmp_ge_u32 vcc, 7, v15
s_nop 1
v_cndmask_b32 v245, v16, 0, vcc
v_or_b32 v241, s46, v245
v_subrev_u32 v15, 2, v14
v_cmp_ge_u32 vcc, 7, v15
v_add_u32 v15, 16, v15
s_nop 0
v_cndmask_b32 v250, v16, 0, vcc
v_cmp_ge_u32 vcc, 7, v15
s_nop 1
v_cndmask_b32 v246, v16, 0, vcc
v_or_b32 v242, s46, v246
v_subrev_u32 v15, 3, v14
v_cmp_ge_u32 vcc, 7, v15
v_add_u32 v15, 16, v15
s_nop 0
v_cndmask_b32 v251, v16, 0, vcc
v_cmp_ge_u32 vcc, 7, v15
s_nop 1
v_cndmask_b32 v247, v16, 0, vcc
v_or_b32 v243, s46, v247
s_lshl_b32 s46, s45, 6
s_add_u32 s46, s46, s44
s_add_u32 s46, s46, 16
v_lshl_add_u32 v14, v12, 1, s46
s_lshl_b32 s47, s43, 6
v_lshl_add_u32 v15, v13, 4, s47
v_mul_u32_u24 v20, 400, v14
v_add_u32 v20, v20, v15
v_subrev_u32 v16, 32, v14
v_max_i32 v16, 0, v16
v_mul_u32_u24 v21, 400, v16
v_add_u32 v21, v21, v15
v_lshrrev_b32 v16, 2, v12
v_lshl_add_u32 v16, v13, 2, v16
v_lshl_add_u32 v16, v16, 1, s46
v_and_b32 v17, 3, v1
v_lshl_add_u32 v17, v17, 3, s47
v_mul_u32_u24 v22, 400, v16
v_add_u32 v22, v22, v17
v_subrev_u32 v16, 32, v16
v_max_i32 v16, 0, v16
v_mul_u32_u24 v23, 400, v16
v_add_u32 v23, v23, v17
s_mul_i32 s60, s34, 262144
s_add_u32 s16, s82, s60
s_addc_u32 s17, s83, 0
s_mov_b32 s18, 262144
s_mov_b32 s19, 0x20000
s_lshl_b32 s60, s35, 14
s_lshl_b32 s43, s43, 13
s_add_u32 s60, s60, s43
s_lshl_b32 s43, s45, 12
s_add_u32 s60, s60, s43
s_lshl_b32 s43, s44, 10
s_add_u32 s60, s60, s43
v_lshlrev_b32 v24, 4, v1
s_mov_b32 s61, 0x3e8293ee
s_lshl_b32 s38, s35, 7
Latt_5:
s_barrier
ds_read_b128 v[32:35], v20 offset:0
ds_read_b128 v[36:39], v20 offset:128
ds_read_b128 v[40:43], v21 offset:128
ds_read_b128 v[80:83], v20 offset:12800
ds_read_b128 v[84:87], v20 offset:12928
ds_read_b128 v[88:91], v20 offset:128
ds_read_b64_tr_b16 v[44:45], v23 offset:256
ds_read_b64_tr_b16 v[46:47], v22 offset:256
ds_read_b64_tr_b16 v[48:49], v23 offset:288
ds_read_b64_tr_b16 v[50:51], v22 offset:288
ds_read_b64_tr_b16 v[92:93], v22 offset:256
ds_read_b64_tr_b16 v[94:95], v22 offset:13056
ds_read_b64_tr_b16 v[96:97], v22 offset:288
ds_read_b64_tr_b16 v[98:99], v22 offset:13088
s_waitcnt lgkmcnt(11)
v_mfma_f32_16x16x32_bf16 v[52:55], v[40:43], v[32:35], v[240:243]
v_mfma_f32_16x16x32_bf16 v[56:59], v[36:39], v[32:35], v[248:251]
s_waitcnt lgkmcnt(8)
v_mfma_f32_16x16x32_bf16 v[100:103], v[88:91], v[80:83], v[244:247]
v_mfma_f32_16x16x32_bf16 v[104:107], v[84:87], v[80:83], v[248:251]
s_nop 5
v_max3_f32 v60, v52, v53, v54
v_max3_f32 v108, v100, v101, v102
v_max3_f32 v61, v55, v56, v57
v_max3_f32 v109, v103, v104, v105
v_max3_f32 v60, v60, v58, v59
v_max3_f32 v108, v108, v106, v107
v_max_f32 v60, v60, v61
v_max_f32 v108, v108, v109
s_nop 1
v_permlane32_swap_b32 v60, v108
v_max_f32 v60, v60, v108
v_mov_b32 v61, v60
s_nop 1
v_permlane16_swap_b32 v60, v61
v_max_f32 v60, v60, v61
v_mul_f32 v60, s61, v60
s_nop 0
v_mov_b32 v108, v60
s_nop 1
v_permlane32_swap_b32 v60, v108
v_fma_f32 v52, v52, s61, -v60
v_fma_f32 v100, v100, s61, -v108
v_fma_f32 v53, v53, s61, -v60
v_fma_f32 v101, v101, s61, -v108
v_fma_f32 v54, v54, s61, -v60
v_fma_f32 v102, v102, s61, -v108
v_fma_f32 v55, v55, s61, -v60
v_fma_f32 v103, v103, s61, -v108
v_fma_f32 v56, v56, s61, -v60
v_fma_f32 v104, v104, s61, -v108
v_fma_f32 v57, v57, s61, -v60
v_fma_f32 v105, v105, s61, -v108
v_fma_f32 v58, v58, s61, -v60
v_fma_f32 v106, v106, s61, -v108
v_fma_f32 v59, v59, s61, -v60
v_fma_f32 v107, v107, s61, -v108
v_exp_f32 v52, v52
v_exp_f32 v100, v100
v_exp_f32 v53, v53
v_exp_f32 v101, v101
v_exp_f32 v54, v54
v_exp_f32 v102, v102
v_exp_f32 v55, v55
v_exp_f32 v103, v103
v_exp_f32 v56, v56
v_exp_f32 v104, v104
v_exp_f32 v57, v57
v_exp_f32 v105, v105
v_exp_f32 v58, v58
v_exp_f32 v106, v106
v_exp_f32 v59, v59
v_exp_f32 v107, v107
v_cvt_pk_bf16_f32 v64, v52, v53
v_cvt_pk_bf16_f32 v112, v100, v101
v_cvt_pk_bf16_f32 v65, v54, v55
v_cvt_pk_bf16_f32 v113, v102, v103
v_cvt_pk_bf16_f32 v66, v56, v57
v_cvt_pk_bf16_f32 v114, v104, v105
v_cvt_pk_bf16_f32 v67, v58, v59
v_cvt_pk_bf16_f32 v115, v106, v107
v_pk_add_f32 v[52:53], v[52:53], v[54:55]
v_pk_add_f32 v[100:101], v[100:101], v[102:103]
v_pk_add_f32 v[56:57], v[56:57], v[58:59]
v_pk_add_f32 v[104:105], v[104:105], v[106:107]
s_waitcnt lgkmcnt(0)
s_waitcnt lgkmcnt(0)
v_mfma_f32_16x16x32_bf16 v[68:71], v[44:47], v[64:67], 0
v_mfma_f32_16x16x32_bf16 v[116:119], v[92:95], v[112:115], 0
v_mfma_f32_16x16x32_bf16 v[72:75], v[48:51], v[64:67], 0
v_mfma_f32_16x16x32_bf16 v[120:123], v[96:99], v[112:115], 0
v_pk_add_f32 v[52:53], v[52:53], v[56:57]
v_pk_add_f32 v[100:101], v[100:101], v[104:105]
v_add_f32 v60, v52, v53
v_add_f32 v108, v100, v101
s_nop 1
v_permlane32_swap_b32 v60, v108
v_add_f32 v60, v60, v108
v_mov_b32 v61, v60
s_nop 1
v_permlane16_swap_b32 v60, v61
v_add_f32 v60, v60, v61
v_rcp_f32 v60, v60
s_nop 0
v_mov_b32 v108, v60
s_nop 1
v_permlane32_swap_b32 v60, v108
v_pk_mul_f32 v[68:69], v[60:61], v[68:69] op_sel_hi:[0,1]
v_pk_mul_f32 v[116:117], v[108:109], v[116:117] op_sel_hi:[0,1]
v_pk_mul_f32 v[70:71], v[60:61], v[70:71] op_sel_hi:[0,1]
v_pk_mul_f32 v[118:119], v[108:109], v[118:119] op_sel_hi:[0,1]
v_pk_mul_f32 v[72:73], v[60:61], v[72:73] op_sel_hi:[0,1]
v_pk_mul_f32 v[120:121], v[108:109], v[120:121] op_sel_hi:[0,1]
v_pk_mul_f32 v[74:75], v[60:61], v[74:75] op_sel_hi:[0,1]
v_pk_mul_f32 v[122:123], v[108:109], v[122:123] op_sel_hi:[0,1]
v_cvt_pk_bf16_f32 v64, v68, v69
v_cvt_pk_bf16_f32 v112, v116, v117
v_cvt_pk_bf16_f32 v65, v70, v71
v_cvt_pk_bf16_f32 v113, v118, v119
v_cvt_pk_bf16_f32 v66, v72, v73
v_cvt_pk_bf16_f32 v114, v120, v121
v_cvt_pk_bf16_f32 v67, v74, v75
v_cvt_pk_bf16_f32 v115, v122, v123
buffer_store_dwordx4 v[64:67], v24, s[16:19], s60 offen offset:0 sc1
buffer_store_dwordx4 v[112:115], v24, s[16:19], s60 offen offset:2048 sc1
s_add_u32 s56, s82, 28311552
s_addc_u32 s57, s83, 0
s_mov_b32 s58, 114688
s_mov_b32 s59, 0x20000
s_lshl_b32 s7, s34, 12
s_add_u32 s7, s7, 49152
v_lshl_add_u32 v26, v1, 8, s7
v_mov_b32 v27, 1
s_cmp_ge_u32 s36, 4
s_cbranch_scc1 Lh_96
s_waitcnt vmcnt(0)
s_branch Lo_95
Lh_96:
s_add_u32 s28, s68, s38
s_addc_u32 s29, s69, 0
s_mov_b32 s30, 2095232
s_mov_b32 s31, 0x20000
s_add_u32 s42, s40, 4
s_and_b32 s42, s42, 15
s_lshl_b32 s42, s42, 17
s_add_u32 m0, s39, 114688
s_add_u32 s43, s42, 0
buffer_load_dwordx4 v7, s[28:31], s43 offen lds
s_add_u32 m0, s39, 115712
s_add_u32 s43, s42, 16384
buffer_load_dwordx4 v7, s[28:31], s43 offen lds
s_add_u32 m0, s39, 116736
s_add_u32 s43, s42, 32768
buffer_load_dwordx4 v7, s[28:31], s43 offen lds
s_add_u32 m0, s39, 117760
s_add_u32 s43, s42, 49152
buffer_load_dwordx4 v7, s[28:31], s43 offen lds
s_add_u32 m0, s39, 118784
s_add_u32 s43, s42, 65536
buffer_load_dwordx4 v7, s[28:31], s43 offen lds
s_add_u32 m0, s39, 119808
s_add_u32 s43, s42, 81920
buffer_load_dwordx4 v7, s[28:31], s43 offen lds
s_add_u32 m0, s39, 120832
s_add_u32 s43, s42, 98304
buffer_load_dwordx4 v7, s[28:31], s43 offen lds
s_add_u32 m0, s39, 121856
s_add_u32 s43, s42, 114688
buffer_load_dwordx4 v7, s[28:31], s43 offen lds
s_waitcnt vmcnt(8)
Lo_95:
s_cmp_lg_u32 s36, 0
s_barrier
s_cbranch_scc1 Lsig_97
s_mov_b64 exec, 0xffff
buffer_atomic_add v27, v26, s[56:59], 0 offen sc1
s_mov_b64 exec, -1
Lsig_97:
s_cmp_ge_u32 s36, 4
s_cbranch_scc1 Lprod_99
v_and_b32 v12, 15, v1
v_lshrrev_b32 v13, 4, v1
v_lshlrev_b32 v10, 12, v12
v_and_b32 v14, 1, v13
v_lshl_add_u32 v10, v14, 5, v10
v_lshrrev_b32 v14, 1, v13
v_lshl_add_u32 v10, v14, 4, v10
s_lshl_b32 s43, s34, 18
s_lshl_b32 s44, s36, 16
s_add_u32 s43, s43, s44
s_lshl_b32 s44, s35, 7
s_add_u32 s43, s43, s44
buffer_load_dwordx4 v[128:131], v10, s[8:11], s43 offen offset:0
buffer_load_dwordx4 v[132:135], v10, s[8:11], s43 offen offset:64
buffer_load_dwordx4 v[136:139], v10, s[8:11], s43 offen offset:2048
buffer_load_dwordx4 v[140:143], v10, s[8:11], s43 offen offset:2112
v_and_b32 v12, 15, v1
v_lshrrev_b32 v13, 4, v1
s_mul_i32 s43, s34, 262144
s_add_u32 s20, s82, s43
s_addc_u32 s21, s83, 0
s_add_u32 s20, s20, 4194304
s_addc_u32 s21, s21, 0
s_mov_b32 s22, 262144
s_mov_b32 s23, 0x20000
s_mul_i32 s43, s34, 16384
s_add_u32 s24, s82, s43
s_addc_u32 s25, s83, 0
s_add_u32 s24, s24, 25165824
s_addc_u32 s25, s25, 0
s_mov_b32 s26, 16384
s_mov_b32 s27, 0x20000
v_lshlrev_b32 v11, 4, v1
s_lshl_b32 s43, s36, 11
v_add_u32 v2, s43, v11
v_add_u32 v3, 98304, v2
v_lshrrev_b32 v14, 2, v1
v_bfe_u32 v15, v14, 1, 2
v_mul_u32_u24 v14, 128, v14
v_lshl_add_u32 v14, v15, 5, v14
v_and_b32 v15, 3, v1
v_lshl_add_u32 v4, v15, 3, v14
v_xor_b32 v5, 32, v4
v_xor_b32 v6, 64, v4
v_xor_b32 v7, 96, v4
v_add_u32 v16, 0x10000, v4
v_add_u32 v20, 0x20000, v4
v_add_u32 v17, 0x10000, v5
v_add_u32 v21, 0x20000, v5
v_add_u32 v18, 0x10000, v6
v_add_u32 v22, 0x20000, v6
v_add_u32 v19, 0x10000, v7
v_add_u32 v23, 0x20000, v7
s_lshl_b32 s44, s35, 14
s_add_u32 s60, s44, s43
v_lshrrev_b32 v14, 1, v13
v_lshlrev_b32 v14, 11, v14
v_lshl_add_u32 v14, v12, 3, v14
v_and_b32 v15, 1, v13
v_lshl_add_u32 v14, v15, 2, v14
s_lshl_b32 s43, s36, 12
s_lshl_b32 s44, s35, 7
s_add_u32 s43, s43, s44
v_add_u32 v9, s43, v14
s_mov_b32 s61, 0x3f803f80
s_waitcnt vmcnt(0)
v_permlane16_swap_b32 v128, v130
v_permlane16_swap_b32 v129, v131
v_permlane16_swap_b32 v132, v134
v_permlane16_swap_b32 v133, v135
v_permlane16_swap_b32 v136, v138
v_permlane16_swap_b32 v137, v139
v_permlane16_swap_b32 v140, v142
v_permlane16_swap_b32 v141, v143
v_lshlrev_b32 v96, 16, v128
v_and_b32 v97, 0xffff0000, v128
v_lshlrev_b32 v98, 16, v129
v_and_b32 v99, 0xffff0000, v129
v_lshlrev_b32 v100, 16, v130
v_and_b32 v101, 0xffff0000, v130
v_lshlrev_b32 v102, 16, v131
v_and_b32 v103, 0xffff0000, v131
v_lshlrev_b32 v104, 16, v132
v_and_b32 v105, 0xffff0000, v132
v_lshlrev_b32 v106, 16, v133
v_and_b32 v107, 0xffff0000, v133
v_lshlrev_b32 v108, 16, v134
v_and_b32 v109, 0xffff0000, v134
v_lshlrev_b32 v110, 16, v135
v_and_b32 v111, 0xffff0000, v135
v_lshlrev_b32 v112, 16, v136
v_and_b32 v113, 0xffff0000, v136
v_lshlrev_b32 v114, 16, v137
v_and_b32 v115, 0xffff0000, v137
v_lshlrev_b32 v116, 16, v138
v_and_b32 v117, 0xffff0000, v138
v_lshlrev_b32 v118, 16, v139
v_and_b32 v119, 0xffff0000, v139
v_lshlrev_b32 v120, 16, v140
v_and_b32 v121, 0xffff0000, v140
v_lshlrev_b32 v122, 16, v141
v_and_b32 v123, 0xffff0000, v141
v_lshlrev_b32 v124, 16, v142
v_and_b32 v125, 0xffff0000, v142
v_lshlrev_b32 v126, 16, v143
v_and_b32 v127, 0xffff0000, v143
s_cmp_lg_u32 s36, 0
s_cbranch_scc1 Lwm_102
s_nop 0
s_branch Lwe_101
Lwm_102:
s_cmp_lg_u32 s36, 1
s_cbranch_scc1 Lwm_103
s_nop 0
s_branch Lwe_101
Lwm_103:
s_cmp_lg_u32 s36, 2
s_cbranch_scc1 Lwm_104
s_nop 0
s_branch Lwe_101
Lwm_104:
s_cmp_lg_u32 s36, 3
s_cbranch_scc1 Lwm_105
s_nop 0
s_branch Lwe_101
Lwm_105:
Lwe_101:
s_barrier
ds_read_b128 v[32:35], v2 offset:0
ds_read_b64_tr_b16 v[40:41], v16 offset:0
ds_read_b64_tr_b16 v[42:43], v16 offset:2048
ds_read_b64_tr_b16 v[44:45], v17 offset:0
ds_read_b64_tr_b16 v[46:47], v17 offset:2048
ds_read_b64_tr_b16 v[48:49], v18 offset:0
ds_read_b64_tr_b16 v[50:51], v18 offset:2048
ds_read_b64_tr_b16 v[52:53], v19 offset:0
ds_read_b64_tr_b16 v[54:55], v19 offset:2048
ds_read_b128 v[36:39], v2 offset:1024
ds_read_b128 v[56:59], v2 offset:8192
ds_read_b64_tr_b16 v[64:65], v16 offset:4096
ds_read_b64_tr_b16 v[66:67], v16 offset:6144
ds_read_b64_tr_b16 v[68:69], v17 offset:4096
ds_read_b64_tr_b16 v[70:71], v17 offset:6144
ds_read_b64_tr_b16 v[72:73], v18 offset:4096
ds_read_b64_tr_b16 v[74:75], v18 offset:6144
ds_read_b64_tr_b16 v[76:77], v19 offset:4096
ds_read_b64_tr_b16 v[78:79], v19 offset:6144
ds_read_b128 v[60:63], v2 offset:9216
s_waitcnt lgkmcnt(0)
s_barrier
v_mfma_f32_16x16x32_bf16 v[96:99], v[40:43], v[32:35], v[96:99]
ds_read_b128 v[144:147], v2 offset:49152
ds_read_b64_tr_b16 v[152:153], v16 offset:8192
v_mfma_f32_16x16x32_bf16 v[100:103], v[44:47], v[32:35], v[100:103]
ds_read_b64_tr_b16 v[154:155], v16 offset:10240
ds_read_b64_tr_b16 v[156:157], v17 offset:8192
v_mfma_f32_16x16x32_bf16 v[104:107], v[48:51], v[32:35], v[104:107]
ds_read_b64_tr_b16 v[158:159], v17 offset:10240
ds_read_b64_tr_b16 v[160:161], v18 offset:8192
v_mfma_f32_16x16x32_bf16 v[108:111], v[52:55], v[32:35], v[108:111]
ds_read_b64_tr_b16 v[162:163], v18 offset:10240
ds_read_b64_tr_b16 v[164:165], v19 offset:8192
v_mfma_f32_16x16x32_bf16 v[124:127], v[52:55], v[36:39], v[124:127]
ds_read_b64_tr_b16 v[166:167], v19 offset:10240
ds_read_b128 v[148:151], v2 offset:50176
v_mfma_f32_16x16x32_bf16 v[120:123], v[48:51], v[36:39], v[120:123]
ds_read_b128 v[168:171], v2 offset:57344
ds_read_b64_tr_b16 v[176:177], v16 offset:12288
v_mfma_f32_16x16x32_bf16 v[116:119], v[44:47], v[36:39], v[116:119]
ds_read_b64_tr_b16 v[178:179], v16 offset:14336
ds_read_b64_tr_b16 v[180:181], v17 offset:12288
v_mfma_f32_16x16x32_bf16 v[112:115], v[40:43], v[36:39], v[112:115]
ds_read_b64_tr_b16 v[182:183], v17 offset:14336
ds_read_b64_tr_b16 v[184:185], v18 offset:12288
v_mfma_f32_16x16x32_bf16 v[96:99], v[64:67], v[56:59], v[96:99]
ds_read_b64_tr_b16 v[186:187], v18 offset:14336
ds_read_b64_tr_b16 v[188:189], v19 offset:12288
v_mfma_f32_16x16x32_bf16 v[100:103], v[68:71], v[56:59], v[100:103]
ds_read_b64_tr_b16 v[190:191], v19 offset:14336
ds_read_b128 v[172:175], v2 offset:58368
v_mfma_f32_16x16x32_bf16 v[104:107], v[72:75], v[56:59], v[104:107]
s_bitcmp0_b32 s36, 1
s_branch Lov_5
.p2align 12
.fill 32, 4, 0xbf800000
Lst_5_0:
s_branch Lwr_165
s_nop 0
s_nop 0
Lov_5:
v_mfma_f32_16x16x32_bf16 v[108:111], v[76:79], v[56:59], v[108:111]
s_cselect_b32 s44, s72, s74
v_mfma_f32_16x16x32_bf16 v[124:127], v[76:79], v[60:63], v[124:127]
s_cselect_b32 s45, s73, s75
v_mfma_f32_16x16x32_bf16 v[120:123], v[72:75], v[60:63], v[120:123]
s_mul_i32 s43, s35, 192
v_mfma_f32_16x16x32_bf16 v[116:119], v[68:71], v[60:63], v[116:119]
s_add_u32 s16, s44, s43
v_mfma_f32_16x16x32_bf16 v[112:115], v[64:67], v[60:63], v[112:115]
s_addc_u32 s17, s45, 0
s_waitcnt lgkmcnt(0)
s_barrier
v_mfma_f32_16x16x32_bf16 v[96:99], v[152:155], v[144:147], v[96:99]
ds_read_b128 v[32:35], v3 offset:0
ds_read_b64_tr_b16 v[40:41], v16 offset:16384
v_mfma_f32_16x16x32_bf16 v[100:103], v[156:159], v[144:147], v[100:103]
ds_read_b64_tr_b16 v[42:43], v16 offset:18432
ds_read_b64_tr_b16 v[44:45], v17 offset:16384
v_mfma_f32_16x16x32_bf16 v[104:107], v[160:163], v[144:147], v[104:107]
ds_read_b64_tr_b16 v[46:47], v17 offset:18432
ds_read_b64_tr_b16 v[48:49], v18 offset:16384
v_mfma_f32_16x16x32_bf16 v[108:111], v[164:167], v[144:147], v[108:111]
ds_read_b64_tr_b16 v[50:51], v18 offset:18432
ds_read_b64_tr_b16 v[52:53], v19 offset:16384
v_mfma_f32_16x16x32_bf16 v[124:127], v[164:167], v[148:151], v[124:127]
ds_read_b64_tr_b16 v[54:55], v19 offset:18432
ds_read_b128 v[36:39], v3 offset:1024
v_mfma_f32_16x16x32_bf16 v[120:123], v[160:163], v[148:151], v[120:123]
ds_read_b128 v[56:59], v3 offset:8192
ds_read_b64_tr_b16 v[64:65], v16 offset:20480
v_mfma_f32_16x16x32_bf16 v[116:119], v[156:159], v[148:151], v[116:119]
ds_read_b64_tr_b16 v[66:67], v16 offset:22528
ds_read_b64_tr_b16 v[68:69], v17 offset:20480
v_mfma_f32_16x16x32_bf16 v[112:115], v[152:155], v[148:151], v[112:115]
ds_read_b64_tr_b16 v[70:71], v17 offset:22528
ds_read_b64_tr_b16 v[72:73], v18 offset:20480
v_mfma_f32_16x16x32_bf16 v[96:99], v[176:179], v[168:171], v[96:99]
ds_read_b64_tr_b16 v[74:75], v18 offset:22528
ds_read_b64_tr_b16 v[76:77], v19 offset:20480
v_mfma_f32_16x16x32_bf16 v[100:103], v[180:183], v[168:171], v[100:103]
ds_read_b64_tr_b16 v[78:79], v19 offset:22528
ds_read_b128 v[60:63], v3 offset:9216
v_mfma_f32_16x16x32_bf16 v[104:107], v[184:187], v[168:171], v[104:107]
s_add_u32 s16, s16, 4096
v_mfma_f32_16x16x32_bf16 v[108:111], v[188:191], v[168:171], v[108:111]
s_addc_u32 s17, s17, 0
v_mfma_f32_16x16x32_bf16 v[124:127], v[188:191], v[172:175], v[124:127]
s_mov_b32 s18, 7333056
v_mfma_f32_16x16x32_bf16 v[120:123], v[184:187], v[172:175], v[120:123]
s_mov_b32 s19, 0x20000
v_mfma_f32_16x16x32_bf16 v[116:119], v[180:183], v[172:175], v[116:119]
s_and_b32 s43, s36, 1
v_mfma_f32_16x16x32_bf16 v[112:115], v[176:179], v[172:175], v[112:115]
s_mul_i32 s43, s43, 229376
s_waitcnt lgkmcnt(0)
s_barrier
v_mfma_f32_16x16x32_bf16 v[96:99], v[40:43], v[32:35], v[96:99]
ds_read_b128 v[144:147], v3 offset:49152
ds_read_b64_tr_b16 v[152:153], v16 offset:24576
v_mfma_f32_16x16x32_bf16 v[100:103], v[44:47], v[32:35], v[100:103]
ds_read_b64_tr_b16 v[154:155], v16 offset:26624
ds_read_b64_tr_b16 v[156:157], v17 offset:24576
v_mfma_f32_16x16x32_bf16 v[104:107], v[48:51], v[32:35], v[104:107]
ds_read_b64_tr_b16 v[158:159], v17 offset:26624
ds_read_b64_tr_b16 v[160:161], v18 offset:24576
v_mfma_f32_16x16x32_bf16 v[108:111], v[52:55], v[32:35], v[108:111]
ds_read_b64_tr_b16 v[162:163], v18 offset:26624
ds_read_b64_tr_b16 v[164:165], v19 offset:24576
v_mfma_f32_16x16x32_bf16 v[124:127], v[52:55], v[36:39], v[124:127]
ds_read_b64_tr_b16 v[166:167], v19 offset:26624
ds_read_b128 v[148:151], v3 offset:50176
v_mfma_f32_16x16x32_bf16 v[120:123], v[48:51], v[36:39], v[120:123]
ds_read_b128 v[168:171], v3 offset:57344
ds_read_b64_tr_b16 v[176:177], v16 offset:28672
v_mfma_f32_16x16x32_bf16 v[116:119], v[44:47], v[36:39], v[116:119]
ds_read_b64_tr_b16 v[178:179], v16 offset:30720
ds_read_b64_tr_b16 v[180:181], v17 offset:28672
v_mfma_f32_16x16x32_bf16 v[112:115], v[40:43], v[36:39], v[112:115]
ds_read_b64_tr_b16 v[182:183], v17 offset:30720
ds_read_b64_tr_b16 v[184:185], v18 offset:28672
v_mfma_f32_16x16x32_bf16 v[96:99], v[64:67], v[56:59], v[96:99]
ds_read_b64_tr_b16 v[186:187], v18 offset:30720
ds_read_b64_tr_b16 v[188:189], v19 offset:28672
v_mfma_f32_16x16x32_bf16 v[100:103], v[68:71], v[56:59], v[100:103]
ds_read_b64_tr_b16 v[190:191], v19 offset:30720
ds_read_b128 v[172:175], v3 offset:58368
v_mfma_f32_16x16x32_bf16 v[104:107], v[72:75], v[56:59], v[104:107]
v_add_u32 v196, 0, v1
v_mfma_f32_16x16x32_bf16 v[108:111], v[76:79], v[56:59], v[108:111]
v_mul_u32_u24 v197, 5462, v196
v_mfma_f32_16x16x32_bf16 v[124:127], v[76:79], v[60:63], v[124:127]
v_lshrrev_b32 v197, 16, v197
v_mfma_f32_16x16x32_bf16 v[120:123], v[72:75], v[60:63], v[120:123]
v_mul_u32_u24 v198, 12, v197
v_mfma_f32_16x16x32_bf16 v[116:119], v[68:71], v[60:63], v[116:119]
v_sub_u32 v198, v196, v198
v_mfma_f32_16x16x32_bf16 v[112:115], v[64:67], v[60:63], v[112:115]
v_bfe_u32 v199, v197, 2, 1
s_waitcnt lgkmcnt(0)
s_barrier
v_mfma_f32_16x16x32_bf16 v[96:99], v[152:155], v[144:147], v[96:99]
ds_read_b128 v[32:35], v2 offset:0
ds_read_b64_tr_b16 v[40:41], v16 offset:49152
v_mfma_f32_16x16x32_bf16 v[100:103], v[156:159], v[144:147], v[100:103]
ds_read_b64_tr_b16 v[42:43], v16 offset:51200
ds_read_b64_tr_b16 v[44:45], v17 offset:49152
v_mfma_f32_16x16x32_bf16 v[104:107], v[160:163], v[144:147], v[104:107]
ds_read_b64_tr_b16 v[46:47], v17 offset:51200
ds_read_b64_tr_b16 v[48:49], v18 offset:49152
v_mfma_f32_16x16x32_bf16 v[108:111], v[164:167], v[144:147], v[108:111]
ds_read_b64_tr_b16 v[50:51], v18 offset:51200
ds_read_b64_tr_b16 v[52:53], v19 offset:49152
v_mfma_f32_16x16x32_bf16 v[124:127], v[164:167], v[148:151], v[124:127]
ds_read_b64_tr_b16 v[54:55], v19 offset:51200
ds_read_b128 v[36:39], v2 offset:1024
v_mfma_f32_16x16x32_bf16 v[120:123], v[160:163], v[148:151], v[120:123]
ds_read_b128 v[56:59], v2 offset:8192
ds_read_b64_tr_b16 v[64:65], v16 offset:53248
v_mfma_f32_16x16x32_bf16 v[116:119], v[156:159], v[148:151], v[116:119]
ds_read_b64_tr_b16 v[66:67], v16 offset:55296
ds_read_b64_tr_b16 v[68:69], v17 offset:53248
v_mfma_f32_16x16x32_bf16 v[112:115], v[152:155], v[148:151], v[112:115]
ds_read_b64_tr_b16 v[70:71], v17 offset:55296
ds_read_b64_tr_b16 v[72:73], v18 offset:53248
v_mfma_f32_16x16x32_bf16 v[96:99], v[176:179], v[168:171], v[96:99]
ds_read_b64_tr_b16 v[74:75], v18 offset:55296
ds_read_b64_tr_b16 v[76:77], v19 offset:53248
v_mfma_f32_16x16x32_bf16 v[100:103], v[180:183], v[168:171], v[100:103]
ds_read_b64_tr_b16 v[78:79], v19 offset:55296
ds_read_b128 v[60:63], v2 offset:9216
v_mfma_f32_16x16x32_bf16 v[104:107], v[184:187], v[168:171], v[104:107]
v_cmp_gt_u32 vcc, 8, v198
v_mfma_f32_16x16x32_bf16 v[108:111], v[188:191], v[168:171], v[108:111]
v_lshlrev_b32 v200, 1, v199
v_mfma_f32_16x16x32_bf16 v[124:127], v[188:191], v[172:175], v[124:127]
v_mul_u32_u24 v197, 7168, v197
v_mfma_f32_16x16x32_bf16 v[120:123], v[184:187], v[172:175], v[120:123]
v_cndmask_b32 v199, v199, v200, vcc
v_mfma_f32_16x16x32_bf16 v[116:119], v[180:183], v[172:175], v[116:119]
v_xor_b32 v198, v198, v199
v_mfma_f32_16x16x32_bf16 v[112:115], v[176:179], v[172:175], v[112:115]
v_lshl_add_u32 v192, v198, 4, v197
s_waitcnt lgkmcnt(0)
s_barrier
v_mfma_f32_16x16x32_bf16 v[96:99], v[40:43], v[32:35], v[96:99]
ds_read_b128 v[144:147], v2 offset:49152
ds_read_b64_tr_b16 v[152:153], v16 offset:57344
v_mfma_f32_16x16x32_bf16 v[100:103], v[44:47], v[32:35], v[100:103]
ds_read_b64_tr_b16 v[154:155], v16 offset:59392
ds_read_b64_tr_b16 v[156:157], v17 offset:57344
v_mfma_f32_16x16x32_bf16 v[104:107], v[48:51], v[32:35], v[104:107]
ds_read_b64_tr_b16 v[158:159], v17 offset:59392
ds_read_b64_tr_b16 v[160:161], v18 offset:57344
v_mfma_f32_16x16x32_bf16 v[108:111], v[52:55], v[32:35], v[108:111]
ds_read_b64_tr_b16 v[162:163], v18 offset:59392
ds_read_b64_tr_b16 v[164:165], v19 offset:57344
v_mfma_f32_16x16x32_bf16 v[124:127], v[52:55], v[36:39], v[124:127]
ds_read_b64_tr_b16 v[166:167], v19 offset:59392
ds_read_b128 v[148:151], v2 offset:50176
v_mfma_f32_16x16x32_bf16 v[120:123], v[48:51], v[36:39], v[120:123]
ds_read_b128 v[168:171], v2 offset:57344
ds_read_b64_tr_b16 v[176:177], v16 offset:61440
v_mfma_f32_16x16x32_bf16 v[116:119], v[44:47], v[36:39], v[116:119]
ds_read_b64_tr_b16 v[178:179], v16 offset:63488
ds_read_b64_tr_b16 v[180:181], v17 offset:61440
v_mfma_f32_16x16x32_bf16 v[112:115], v[40:43], v[36:39], v[112:115]
ds_read_b64_tr_b16 v[182:183], v17 offset:63488
ds_read_b64_tr_b16 v[184:185], v18 offset:61440
v_mfma_f32_16x16x32_bf16 v[96:99], v[64:67], v[56:59], v[96:99]
ds_read_b64_tr_b16 v[186:187], v18 offset:63488
ds_read_b64_tr_b16 v[188:189], v19 offset:61440
v_mfma_f32_16x16x32_bf16 v[100:103], v[68:71], v[56:59], v[100:103]
ds_read_b64_tr_b16 v[190:191], v19 offset:63488
ds_read_b128 v[172:175], v2 offset:58368
v_mfma_f32_16x16x32_bf16 v[104:107], v[72:75], v[56:59], v[104:107]
v_add_u32 v196, 64, v1
v_mfma_f32_16x16x32_bf16 v[108:111], v[76:79], v[56:59], v[108:111]
v_mul_u32_u24 v197, 5462, v196
v_mfma_f32_16x16x32_bf16 v[124:127], v[76:79], v[60:63], v[124:127]
v_lshrrev_b32 v197, 16, v197
v_mfma_f32_16x16x32_bf16 v[120:123], v[72:75], v[60:63], v[120:123]
v_mul_u32_u24 v198, 12, v197
v_mfma_f32_16x16x32_bf16 v[116:119], v[68:71], v[60:63], v[116:119]
v_sub_u32 v198, v196, v198
v_mfma_f32_16x16x32_bf16 v[112:115], v[64:67], v[60:63], v[112:115]
v_bfe_u32 v199, v197, 2, 1
s_waitcnt lgkmcnt(0)
s_barrier
v_mfma_f32_16x16x32_bf16 v[96:99], v[152:155], v[144:147], v[96:99]
ds_read_b128 v[32:35], v3 offset:0
ds_read_b64_tr_b16 v[40:41], v20 offset:0
v_mfma_f32_16x16x32_bf16 v[100:103], v[156:159], v[144:147], v[100:103]
ds_read_b64_tr_b16 v[42:43], v20 offset:2048
ds_read_b64_tr_b16 v[44:45], v21 offset:0
v_mfma_f32_16x16x32_bf16 v[104:107], v[160:163], v[144:147], v[104:107]
ds_read_b64_tr_b16 v[46:47], v21 offset:2048
ds_read_b64_tr_b16 v[48:49], v22 offset:0
v_mfma_f32_16x16x32_bf16 v[108:111], v[164:167], v[144:147], v[108:111]
ds_read_b64_tr_b16 v[50:51], v22 offset:2048
ds_read_b64_tr_b16 v[52:53], v23 offset:0
v_mfma_f32_16x16x32_bf16 v[124:127], v[164:167], v[148:151], v[124:127]
ds_read_b64_tr_b16 v[54:55], v23 offset:2048
ds_read_b128 v[36:39], v3 offset:1024
v_mfma_f32_16x16x32_bf16 v[120:123], v[160:163], v[148:151], v[120:123]
ds_read_b128 v[56:59], v3 offset:8192
ds_read_b64_tr_b16 v[64:65], v20 offset:4096
v_mfma_f32_16x16x32_bf16 v[116:119], v[156:159], v[148:151], v[116:119]
ds_read_b64_tr_b16 v[66:67], v20 offset:6144
ds_read_b64_tr_b16 v[68:69], v21 offset:4096
v_mfma_f32_16x16x32_bf16 v[112:115], v[152:155], v[148:151], v[112:115]
ds_read_b64_tr_b16 v[70:71], v21 offset:6144
ds_read_b64_tr_b16 v[72:73], v22 offset:4096
v_mfma_f32_16x16x32_bf16 v[96:99], v[176:179], v[168:171], v[96:99]
ds_read_b64_tr_b16 v[74:75], v22 offset:6144
ds_read_b64_tr_b16 v[76:77], v23 offset:4096
v_mfma_f32_16x16x32_bf16 v[100:103], v[180:183], v[168:171], v[100:103]
ds_read_b64_tr_b16 v[78:79], v23 offset:6144
ds_read_b128 v[60:63], v3 offset:9216
v_mfma_f32_16x16x32_bf16 v[104:107], v[184:187], v[168:171], v[104:107]
v_cmp_gt_u32 vcc, 8, v198
v_mfma_f32_16x16x32_bf16 v[108:111], v[188:191], v[168:171], v[108:111]
v_lshlrev_b32 v200, 1, v199
v_mfma_f32_16x16x32_bf16 v[124:127], v[188:191], v[172:175], v[124:127]
v_mul_u32_u24 v197, 7168, v197
v_mfma_f32_16x16x32_bf16 v[120:123], v[184:187], v[172:175], v[120:123]
v_cndmask_b32 v199, v199, v200, vcc
v_mfma_f32_16x16x32_bf16 v[116:119], v[180:183], v[172:175], v[116:119]
v_xor_b32 v198, v198, v199
v_mfma_f32_16x16x32_bf16 v[112:115], v[176:179], v[172:175], v[112:115]
v_lshl_add_u32 v193, v198, 4, v197
s_waitcnt lgkmcnt(0)
s_barrier
v_mfma_f32_16x16x32_bf16 v[96:99], v[40:43], v[32:35], v[96:99]
ds_read_b128 v[144:147], v3 offset:49152
ds_read_b64_tr_b16 v[152:153], v20 offset:8192
v_mfma_f32_16x16x32_bf16 v[100:103], v[44:47], v[32:35], v[100:103]
ds_read_b64_tr_b16 v[154:155], v20 offset:10240
ds_read_b64_tr_b16 v[156:157], v21 offset:8192
v_mfma_f32_16x16x32_bf16 v[104:107], v[48:51], v[32:35], v[104:107]
ds_read_b64_tr_b16 v[158:159], v21 offset:10240
ds_read_b64_tr_b16 v[160:161], v22 offset:8192
v_mfma_f32_16x16x32_bf16 v[108:111], v[52:55], v[32:35], v[108:111]
ds_read_b64_tr_b16 v[162:163], v22 offset:10240
ds_read_b64_tr_b16 v[164:165], v23 offset:8192
v_mfma_f32_16x16x32_bf16 v[124:127], v[52:55], v[36:39], v[124:127]
ds_read_b64_tr_b16 v[166:167], v23 offset:10240
ds_read_b128 v[148:151], v3 offset:50176
v_mfma_f32_16x16x32_bf16 v[120:123], v[48:51], v[36:39], v[120:123]
ds_read_b128 v[168:171], v3 offset:57344
ds_read_b64_tr_b16 v[176:177], v20 offset:12288
v_mfma_f32_16x16x32_bf16 v[116:119], v[44:47], v[36:39], v[116:119]
ds_read_b64_tr_b16 v[178:179], v20 offset:14336
ds_read_b64_tr_b16 v[180:181], v21 offset:12288
v_mfma_f32_16x16x32_bf16 v[112:115], v[40:43], v[36:39], v[112:115]
ds_read_b64_tr_b16 v[182:183], v21 offset:14336
ds_read_b64_tr_b16 v[184:185], v22 offset:12288
v_mfma_f32_16x16x32_bf16 v[96:99], v[64:67], v[56:59], v[96:99]
ds_read_b64_tr_b16 v[186:187], v22 offset:14336
ds_read_b64_tr_b16 v[188:189], v23 offset:12288
v_mfma_f32_16x16x32_bf16 v[100:103], v[68:71], v[56:59], v[100:103]
ds_read_b64_tr_b16 v[190:191], v23 offset:14336
ds_read_b128 v[172:175], v3 offset:58368
v_mfma_f32_16x16x32_bf16 v[104:107], v[72:75], v[56:59], v[104:107]
v_add_u32 v196, 128, v1
v_mfma_f32_16x16x32_bf16 v[108:111], v[76:79], v[56:59], v[108:111]
v_mul_u32_u24 v197, 5462, v196
v_mfma_f32_16x16x32_bf16 v[124:127], v[76:79], v[60:63], v[124:127]
v_lshrrev_b32 v197, 16, v197
v_mfma_f32_16x16x32_bf16 v[120:123], v[72:75], v[60:63], v[120:123]
v_mul_u32_u24 v198, 12, v197
v_mfma_f32_16x16x32_bf16 v[116:119], v[68:71], v[60:63], v[116:119]
v_sub_u32 v198, v196, v198
v_mfma_f32_16x16x32_bf16 v[112:115], v[64:67], v[60:63], v[112:115]
v_bfe_u32 v199, v197, 2, 1
s_waitcnt lgkmcnt(0)
s_barrier
v_mfma_f32_16x16x32_bf16 v[96:99], v[152:155], v[144:147], v[96:99]
ds_read_b128 v[32:35], v2 offset:0
ds_read_b64_tr_b16 v[40:41], v4 offset:16384
v_mfma_f32_16x16x32_bf16 v[100:103], v[156:159], v[144:147], v[100:103]
ds_read_b64_tr_b16 v[42:43], v4 offset:18432
ds_read_b64_tr_b16 v[44:45], v5 offset:16384
v_mfma_f32_16x16x32_bf16 v[104:107], v[160:163], v[144:147], v[104:107]
ds_read_b64_tr_b16 v[46:47], v5 offset:18432
ds_read_b64_tr_b16 v[48:49], v6 offset:16384
v_mfma_f32_16x16x32_bf16 v[108:111], v[164:167], v[144:147], v[108:111]
ds_read_b64_tr_b16 v[50:51], v6 offset:18432
ds_read_b64_tr_b16 v[52:53], v7 offset:16384
v_mfma_f32_16x16x32_bf16 v[124:127], v[164:167], v[148:151], v[124:127]
ds_read_b64_tr_b16 v[54:55], v7 offset:18432
ds_read_b128 v[36:39], v2 offset:1024
v_mfma_f32_16x16x32_bf16 v[120:123], v[160:163], v[148:151], v[120:123]
ds_read_b128 v[56:59], v2 offset:8192
ds_read_b64_tr_b16 v[64:65], v4 offset:20480
v_mfma_f32_16x16x32_bf16 v[116:119], v[156:159], v[148:151], v[116:119]
ds_read_b64_tr_b16 v[66:67], v4 offset:22528
ds_read_b64_tr_b16 v[68:69], v5 offset:20480
v_mfma_f32_16x16x32_bf16 v[112:115], v[152:155], v[148:151], v[112:115]
ds_read_b64_tr_b16 v[70:71], v5 offset:22528
ds_read_b64_tr_b16 v[72:73], v6 offset:20480
v_mfma_f32_16x16x32_bf16 v[96:99], v[176:179], v[168:171], v[96:99]
ds_read_b64_tr_b16 v[74:75], v6 offset:22528
ds_read_b64_tr_b16 v[76:77], v7 offset:20480
v_mfma_f32_16x16x32_bf16 v[100:103], v[180:183], v[168:171], v[100:103]
ds_read_b64_tr_b16 v[78:79], v7 offset:22528
ds_read_b128 v[60:63], v2 offset:9216
v_mfma_f32_16x16x32_bf16 v[104:107], v[184:187], v[168:171], v[104:107]
v_cmp_gt_u32 vcc, 8, v198
v_mfma_f32_16x16x32_bf16 v[108:111], v[188:191], v[168:171], v[108:111]
v_lshlrev_b32 v200, 1, v199
v_mfma_f32_16x16x32_bf16 v[124:127], v[188:191], v[172:175], v[124:127]
v_mul_u32_u24 v197, 7168, v197
v_mfma_f32_16x16x32_bf16 v[120:123], v[184:187], v[172:175], v[120:123]
v_cndmask_b32 v199, v199, v200, vcc
v_mfma_f32_16x16x32_bf16 v[116:119], v[180:183], v[172:175], v[116:119]
v_xor_b32 v198, v198, v199
v_mfma_f32_16x16x32_bf16 v[112:115], v[176:179], v[172:175], v[112:115]
v_lshl_add_u32 v194, v198, 4, v197
s_waitcnt lgkmcnt(0)
s_barrier
v_mfma_f32_16x16x32_bf16 v[96:99], v[40:43], v[32:35], v[96:99]
ds_read_b128 v[144:147], v2 offset:49152
ds_read_b64_tr_b16 v[152:153], v4 offset:24576
v_mfma_f32_16x16x32_bf16 v[100:103], v[44:47], v[32:35], v[100:103]
ds_read_b64_tr_b16 v[154:155], v4 offset:26624
ds_read_b64_tr_b16 v[156:157], v5 offset:24576
v_mfma_f32_16x16x32_bf16 v[104:107], v[48:51], v[32:35], v[104:107]
ds_read_b64_tr_b16 v[158:159], v5 offset:26624
ds_read_b64_tr_b16 v[160:161], v6 offset:24576
v_mfma_f32_16x16x32_bf16 v[108:111], v[52:55], v[32:35], v[108:111]
ds_read_b64_tr_b16 v[162:163], v6 offset:26624
ds_read_b64_tr_b16 v[164:165], v7 offset:24576
v_mfma_f32_16x16x32_bf16 v[124:127], v[52:55], v[36:39], v[124:127]
ds_read_b64_tr_b16 v[166:167], v7 offset:26624
ds_read_b128 v[148:151], v2 offset:50176
v_mfma_f32_16x16x32_bf16 v[120:123], v[48:51], v[36:39], v[120:123]
ds_read_b128 v[168:171], v2 offset:57344
ds_read_b64_tr_b16 v[176:177], v4 offset:28672
v_mfma_f32_16x16x32_bf16 v[116:119], v[44:47], v[36:39], v[116:119]
ds_read_b64_tr_b16 v[178:179], v4 offset:30720
ds_read_b64_tr_b16 v[180:181], v5 offset:28672
v_mfma_f32_16x16x32_bf16 v[112:115], v[40:43], v[36:39], v[112:115]
ds_read_b64_tr_b16 v[182:183], v5 offset:30720
ds_read_b64_tr_b16 v[184:185], v6 offset:28672
v_mfma_f32_16x16x32_bf16 v[96:99], v[64:67], v[56:59], v[96:99]
ds_read_b64_tr_b16 v[186:187], v6 offset:30720
ds_read_b64_tr_b16 v[188:189], v7 offset:28672
v_mfma_f32_16x16x32_bf16 v[100:103], v[68:71], v[56:59], v[100:103]
ds_read_b64_tr_b16 v[190:191], v7 offset:30720
ds_read_b128 v[172:175], v2 offset:58368
v_mfma_f32_16x16x32_bf16 v[104:107], v[72:75], v[56:59], v[104:107]
v_add_u32 v192, s43, v192
v_mfma_f32_16x16x32_bf16 v[108:111], v[76:79], v[56:59], v[108:111]
v_add_u32 v193, s43, v193
v_mfma_f32_16x16x32_bf16 v[124:127], v[76:79], v[60:63], v[124:127]
v_add_u32 v194, s43, v194
v_mfma_f32_16x16x32_bf16 v[120:123], v[72:75], v[60:63], v[120:123]
s_and_b32 s43, s36, 3
v_mfma_f32_16x16x32_bf16 v[116:119], v[68:71], v[60:63], v[116:119]
s_mul_i32 s50, s43, 6144
v_mfma_f32_16x16x32_bf16 v[112:115], v[64:67], v[60:63], v[112:115]
s_add_u32 s50, s50, 16384
s_waitcnt lgkmcnt(0)
s_barrier
v_mfma_f32_16x16x32_bf16 v[96:99], v[152:155], v[144:147], v[96:99]
ds_read_b128 v[32:35], v3 offset:0
ds_read_b64_tr_b16 v[40:41], v4 offset:32768
v_mfma_f32_16x16x32_bf16 v[100:103], v[156:159], v[144:147], v[100:103]
ds_read_b64_tr_b16 v[42:43], v4 offset:34816
ds_read_b64_tr_b16 v[44:45], v5 offset:32768
v_mfma_f32_16x16x32_bf16 v[104:107], v[160:163], v[144:147], v[104:107]
ds_read_b64_tr_b16 v[46:47], v5 offset:34816
ds_read_b64_tr_b16 v[48:49], v6 offset:32768
v_mfma_f32_16x16x32_bf16 v[108:111], v[164:167], v[144:147], v[108:111]
ds_read_b64_tr_b16 v[50:51], v6 offset:34816
ds_read_b64_tr_b16 v[52:53], v7 offset:32768
v_mfma_f32_16x16x32_bf16 v[124:127], v[164:167], v[148:151], v[124:127]
ds_read_b64_tr_b16 v[54:55], v7 offset:34816
ds_read_b128 v[36:39], v3 offset:1024
v_mfma_f32_16x16x32_bf16 v[120:123], v[160:163], v[148:151], v[120:123]
ds_read_b128 v[56:59], v3 offset:8192
ds_read_b64_tr_b16 v[64:65], v4 offset:36864
v_mfma_f32_16x16x32_bf16 v[116:119], v[156:159], v[148:151], v[116:119]
ds_read_b64_tr_b16 v[66:67], v4 offset:38912
ds_read_b64_tr_b16 v[68:69], v5 offset:36864
v_mfma_f32_16x16x32_bf16 v[112:115], v[152:155], v[148:151], v[112:115]
ds_read_b64_tr_b16 v[70:71], v5 offset:38912
ds_read_b64_tr_b16 v[72:73], v6 offset:36864
v_mfma_f32_16x16x32_bf16 v[96:99], v[176:179], v[168:171], v[96:99]
ds_read_b64_tr_b16 v[74:75], v6 offset:38912
ds_read_b64_tr_b16 v[76:77], v7 offset:36864
v_mfma_f32_16x16x32_bf16 v[100:103], v[180:183], v[168:171], v[100:103]
ds_read_b64_tr_b16 v[78:79], v7 offset:38912
ds_read_b128 v[60:63], v3 offset:9216
v_mfma_f32_16x16x32_bf16 v[104:107], v[184:187], v[168:171], v[104:107]
s_bitcmp0_b32 s2, 0
v_mfma_f32_16x16x32_bf16 v[108:111], v[188:191], v[168:171], v[108:111]
s_cselect_b32 s88, s72, s74
v_mfma_f32_16x16x32_bf16 v[124:127], v[188:191], v[172:175], v[124:127]
s_cselect_b32 s89, s73, s75
v_mfma_f32_16x16x32_bf16 v[120:123], v[184:187], v[172:175], v[120:123]
s_mov_b32 s90, 7340032
v_mfma_f32_16x16x32_bf16 v[116:119], v[180:183], v[172:175], v[116:119]
s_mov_b32 s91, 0x20000
v_mfma_f32_16x16x32_bf16 v[112:115], v[176:179], v[172:175], v[112:115]
s_bfe_u32 s44, s2, 0x30001
s_waitcnt lgkmcnt(0)
s_barrier
v_mfma_f32_16x16x32_bf16 v[96:99], v[40:43], v[32:35], v[96:99]
ds_read_b128 v[144:147], v3 offset:49152
ds_read_b64_tr_b16 v[152:153], v4 offset:40960
v_mfma_f32_16x16x32_bf16 v[100:103], v[44:47], v[32:35], v[100:103]
ds_read_b64_tr_b16 v[154:155], v4 offset:43008
ds_read_b64_tr_b16 v[156:157], v5 offset:40960
v_mfma_f32_16x16x32_bf16 v[104:107], v[48:51], v[32:35], v[104:107]
ds_read_b64_tr_b16 v[158:159], v5 offset:43008
ds_read_b64_tr_b16 v[160:161], v6 offset:40960
v_mfma_f32_16x16x32_bf16 v[108:111], v[52:55], v[32:35], v[108:111]
ds_read_b64_tr_b16 v[162:163], v6 offset:43008
ds_read_b64_tr_b16 v[164:165], v7 offset:40960
v_mfma_f32_16x16x32_bf16 v[124:127], v[52:55], v[36:39], v[124:127]
ds_read_b64_tr_b16 v[166:167], v7 offset:43008
ds_read_b128 v[148:151], v3 offset:50176
v_mfma_f32_16x16x32_bf16 v[120:123], v[48:51], v[36:39], v[120:123]
ds_read_b128 v[168:171], v3 offset:57344
ds_read_b64_tr_b16 v[176:177], v4 offset:45056
v_mfma_f32_16x16x32_bf16 v[116:119], v[44:47], v[36:39], v[116:119]
ds_read_b64_tr_b16 v[178:179], v4 offset:47104
ds_read_b64_tr_b16 v[180:181], v5 offset:45056
v_mfma_f32_16x16x32_bf16 v[112:115], v[40:43], v[36:39], v[112:115]
ds_read_b64_tr_b16 v[182:183], v5 offset:47104
ds_read_b64_tr_b16 v[184:185], v6 offset:45056
v_mfma_f32_16x16x32_bf16 v[96:99], v[64:67], v[56:59], v[96:99]
ds_read_b64_tr_b16 v[186:187], v6 offset:47104
ds_read_b64_tr_b16 v[188:189], v7 offset:45056
v_mfma_f32_16x16x32_bf16 v[100:103], v[68:71], v[56:59], v[100:103]
ds_read_b64_tr_b16 v[190:191], v7 offset:47104
ds_read_b128 v[172:175], v3 offset:58368
v_mfma_f32_16x16x32_bf16 v[104:107], v[72:75], v[56:59], v[104:107]
s_lshl_b32 s44, s44, 2
v_mfma_f32_16x16x32_bf16 v[108:111], v[76:79], v[56:59], v[108:111]
s_and_b32 s43, s36, 3
v_mfma_f32_16x16x32_bf16 v[124:127], v[76:79], v[60:63], v[124:127]
s_add_u32 s44, s44, s43
v_mfma_f32_16x16x32_bf16 v[120:123], v[72:75], v[60:63], v[120:123]
s_lshl_b32 s44, s44, 5
v_mfma_f32_16x16x32_bf16 v[116:119], v[68:71], v[60:63], v[116:119]
v_lshrrev_b32 v195, 4, v1
v_mfma_f32_16x16x32_bf16 v[112:115], v[64:67], v[60:63], v[112:115]
v_add_u32 v195, s44, v195
s_waitcnt lgkmcnt(0)
s_barrier
v_mfma_f32_16x16x32_bf16 v[96:99], v[152:155], v[144:147], v[96:99]
ds_read_b128 v[32:35], v2 offset:0
ds_read_b64_tr_b16 v[40:41], v16 offset:49152
v_mfma_f32_16x16x32_bf16 v[100:103], v[156:159], v[144:147], v[100:103]
ds_read_b64_tr_b16 v[42:43], v16 offset:51200
ds_read_b64_tr_b16 v[44:45], v17 offset:49152
v_mfma_f32_16x16x32_bf16 v[104:107], v[160:163], v[144:147], v[104:107]
ds_read_b64_tr_b16 v[46:47], v17 offset:51200
ds_read_b64_tr_b16 v[48:49], v18 offset:49152
v_mfma_f32_16x16x32_bf16 v[108:111], v[164:167], v[144:147], v[108:111]
ds_read_b64_tr_b16 v[50:51], v18 offset:51200
ds_read_b64_tr_b16 v[52:53], v19 offset:49152
v_mfma_f32_16x16x32_bf16 v[124:127], v[164:167], v[148:151], v[124:127]
ds_read_b64_tr_b16 v[54:55], v19 offset:51200
ds_read_b128 v[36:39], v2 offset:1024
v_mfma_f32_16x16x32_bf16 v[120:123], v[160:163], v[148:151], v[120:123]
ds_read_b128 v[56:59], v2 offset:8192
ds_read_b64_tr_b16 v[64:65], v16 offset:53248
v_mfma_f32_16x16x32_bf16 v[116:119], v[156:159], v[148:151], v[116:119]
ds_read_b64_tr_b16 v[66:67], v16 offset:55296
ds_read_b64_tr_b16 v[68:69], v17 offset:53248
v_mfma_f32_16x16x32_bf16 v[112:115], v[152:155], v[148:151], v[112:115]
ds_read_b64_tr_b16 v[70:71], v17 offset:55296
ds_read_b64_tr_b16 v[72:73], v18 offset:53248
v_mfma_f32_16x16x32_bf16 v[96:99], v[176:179], v[168:171], v[96:99]
ds_read_b64_tr_b16 v[74:75], v18 offset:55296
ds_read_b64_tr_b16 v[76:77], v19 offset:53248
v_mfma_f32_16x16x32_bf16 v[100:103], v[180:183], v[168:171], v[100:103]
ds_read_b64_tr_b16 v[78:79], v19 offset:55296
ds_read_b128 v[60:63], v2 offset:9216
v_mfma_f32_16x16x32_bf16 v[104:107], v[184:187], v[168:171], v[104:107]
v_mul_u32_u24 v195, 7168, v195
v_mfma_f32_16x16x32_bf16 v[108:111], v[188:191], v[168:171], v[108:111]
v_and_b32 v196, 15, v1
v_mfma_f32_16x16x32_bf16 v[124:127], v[188:191], v[172:175], v[124:127]
v_lshl_add_u32 v195, v196, 4, v195
v_mfma_f32_16x16x32_bf16 v[120:123], v[184:187], v[172:175], v[120:123]
s_lshr_b32 s43, s2, 4
v_mfma_f32_16x16x32_bf16 v[116:119], v[180:183], v[172:175], v[116:119]
s_lshl_b32 s43, s43, 8
v_mfma_f32_16x16x32_bf16 v[112:115], v[176:179], v[172:175], v[112:115]
v_add_u32 v195, s43, v195
s_waitcnt lgkmcnt(0)
s_barrier
v_mfma_f32_16x16x32_bf16 v[96:99], v[40:43], v[32:35], v[96:99]
ds_read_b128 v[144:147], v2 offset:49152
ds_read_b64_tr_b16 v[152:153], v16 offset:57344
v_mfma_f32_16x16x32_bf16 v[100:103], v[44:47], v[32:35], v[100:103]
ds_read_b64_tr_b16 v[154:155], v16 offset:59392
ds_read_b64_tr_b16 v[156:157], v17 offset:57344
v_mfma_f32_16x16x32_bf16 v[104:107], v[48:51], v[32:35], v[104:107]
ds_read_b64_tr_b16 v[158:159], v17 offset:59392
ds_read_b64_tr_b16 v[160:161], v18 offset:57344
v_mfma_f32_16x16x32_bf16 v[108:111], v[52:55], v[32:35], v[108:111]
ds_read_b64_tr_b16 v[162:163], v18 offset:59392
ds_read_b64_tr_b16 v[164:165], v19 offset:57344
v_mfma_f32_16x16x32_bf16 v[124:127], v[52:55], v[36:39], v[124:127]
ds_read_b64_tr_b16 v[166:167], v19 offset:59392
ds_read_b128 v[148:151], v2 offset:50176
v_mfma_f32_16x16x32_bf16 v[120:123], v[48:51], v[36:39], v[120:123]
ds_read_b128 v[168:171], v2 offset:57344
ds_read_b64_tr_b16 v[176:177], v16 offset:61440
v_mfma_f32_16x16x32_bf16 v[116:119], v[44:47], v[36:39], v[116:119]
ds_read_b64_tr_b16 v[178:179], v16 offset:63488
ds_read_b64_tr_b16 v[180:181], v17 offset:61440
v_mfma_f32_16x16x32_bf16 v[112:115], v[40:43], v[36:39], v[112:115]
ds_read_b64_tr_b16 v[182:183], v17 offset:63488
ds_read_b64_tr_b16 v[184:185], v18 offset:61440
v_mfma_f32_16x16x32_bf16 v[96:99], v[64:67], v[56:59], v[96:99]
ds_read_b64_tr_b16 v[186:187], v18 offset:63488
ds_read_b64_tr_b16 v[188:189], v19 offset:61440
v_mfma_f32_16x16x32_bf16 v[100:103], v[68:71], v[56:59], v[100:103]
ds_read_b64_tr_b16 v[190:191], v19 offset:63488
ds_read_b128 v[172:175], v2 offset:58368
v_mfma_f32_16x16x32_bf16 v[104:107], v[72:75], v[56:59], v[104:107]
v_mfma_f32_16x16x32_bf16 v[108:111], v[76:79], v[56:59], v[108:111]
v_mfma_f32_16x16x32_bf16 v[124:127], v[76:79], v[60:63], v[124:127]
s_branch Lov_6
.p2align 12
.fill 48, 4, 0xbf800000
Lst_6_0:
s_branch Lwr_166
s_nop 0
s_nop 0
Lov_6:
v_mfma_f32_16x16x32_bf16 v[120:123], v[72:75], v[60:63], v[120:123]
v_mfma_f32_16x16x32_bf16 v[116:119], v[68:71], v[60:63], v[116:119]
v_mfma_f32_16x16x32_bf16 v[112:115], v[64:67], v[60:63], v[112:115]
s_waitcnt lgkmcnt(0)
s_barrier
v_mfma_f32_16x16x32_bf16 v[96:99], v[152:155], v[144:147], v[96:99]
ds_read_b128 v[32:35], v3 offset:0
ds_read_b64_tr_b16 v[40:41], v20 offset:0
v_mfma_f32_16x16x32_bf16 v[100:103], v[156:159], v[144:147], v[100:103]
ds_read_b64_tr_b16 v[42:43], v20 offset:2048
ds_read_b64_tr_b16 v[44:45], v21 offset:0
v_mfma_f32_16x16x32_bf16 v[104:107], v[160:163], v[144:147], v[104:107]
ds_read_b64_tr_b16 v[46:47], v21 offset:2048
ds_read_b64_tr_b16 v[48:49], v22 offset:0
v_mfma_f32_16x16x32_bf16 v[108:111], v[164:167], v[144:147], v[108:111]
ds_read_b64_tr_b16 v[50:51], v22 offset:2048
ds_read_b64_tr_b16 v[52:53], v23 offset:0
v_mfma_f32_16x16x32_bf16 v[124:127], v[164:167], v[148:151], v[124:127]
ds_read_b64_tr_b16 v[54:55], v23 offset:2048
ds_read_b128 v[36:39], v3 offset:1024
v_mfma_f32_16x16x32_bf16 v[120:123], v[160:163], v[148:151], v[120:123]
ds_read_b128 v[56:59], v3 offset:8192
ds_read_b64_tr_b16 v[64:65], v20 offset:4096
v_mfma_f32_16x16x32_bf16 v[116:119], v[156:159], v[148:151], v[116:119]
ds_read_b64_tr_b16 v[66:67], v20 offset:6144
ds_read_b64_tr_b16 v[68:69], v21 offset:4096
v_mfma_f32_16x16x32_bf16 v[112:115], v[152:155], v[148:151], v[112:115]
ds_read_b64_tr_b16 v[70:71], v21 offset:6144
ds_read_b64_tr_b16 v[72:73], v22 offset:4096
v_mfma_f32_16x16x32_bf16 v[96:99], v[176:179], v[168:171], v[96:99]
ds_read_b64_tr_b16 v[74:75], v22 offset:6144
ds_read_b64_tr_b16 v[76:77], v23 offset:4096
v_mfma_f32_16x16x32_bf16 v[100:103], v[180:183], v[168:171], v[100:103]
ds_read_b64_tr_b16 v[78:79], v23 offset:6144
ds_read_b128 v[60:63], v3 offset:9216
v_mfma_f32_16x16x32_bf16 v[104:107], v[184:187], v[168:171], v[104:107]
v_mfma_f32_16x16x32_bf16 v[108:111], v[188:191], v[168:171], v[108:111]
v_mfma_f32_16x16x32_bf16 v[124:127], v[188:191], v[172:175], v[124:127]
v_mfma_f32_16x16x32_bf16 v[120:123], v[184:187], v[172:175], v[120:123]
v_mfma_f32_16x16x32_bf16 v[116:119], v[180:183], v[172:175], v[116:119]
v_mfma_f32_16x16x32_bf16 v[112:115], v[176:179], v[172:175], v[112:115]
s_waitcnt lgkmcnt(0)
s_barrier
v_mfma_f32_16x16x32_bf16 v[96:99], v[40:43], v[32:35], v[96:99]
ds_read_b128 v[144:147], v3 offset:49152
ds_read_b64_tr_b16 v[152:153], v20 offset:8192
v_mfma_f32_16x16x32_bf16 v[100:103], v[44:47], v[32:35], v[100:103]
ds_read_b64_tr_b16 v[154:155], v20 offset:10240
ds_read_b64_tr_b16 v[156:157], v21 offset:8192
v_mfma_f32_16x16x32_bf16 v[104:107], v[48:51], v[32:35], v[104:107]
ds_read_b64_tr_b16 v[158:159], v21 offset:10240
ds_read_b64_tr_b16 v[160:161], v22 offset:8192
v_mfma_f32_16x16x32_bf16 v[108:111], v[52:55], v[32:35], v[108:111]
ds_read_b64_tr_b16 v[162:163], v22 offset:10240
ds_read_b64_tr_b16 v[164:165], v23 offset:8192
v_mfma_f32_16x16x32_bf16 v[124:127], v[52:55], v[36:39], v[124:127]
ds_read_b64_tr_b16 v[166:167], v23 offset:10240
ds_read_b128 v[148:151], v3 offset:50176
v_mfma_f32_16x16x32_bf16 v[120:123], v[48:51], v[36:39], v[120:123]
ds_read_b128 v[168:171], v3 offset:57344
ds_read_b64_tr_b16 v[176:177], v20 offset:12288
v_mfma_f32_16x16x32_bf16 v[116:119], v[44:47], v[36:39], v[116:119]
ds_read_b64_tr_b16 v[178:179], v20 offset:14336
ds_read_b64_tr_b16 v[180:181], v21 offset:12288
v_mfma_f32_16x16x32_bf16 v[112:115], v[40:43], v[36:39], v[112:115]
ds_read_b64_tr_b16 v[182:183], v21 offset:14336
ds_read_b64_tr_b16 v[184:185], v22 offset:12288
v_mfma_f32_16x16x32_bf16 v[96:99], v[64:67], v[56:59], v[96:99]
ds_read_b64_tr_b16 v[186:187], v22 offset:14336
ds_read_b64_tr_b16 v[188:189], v23 offset:12288
v_mfma_f32_16x16x32_bf16 v[100:103], v[68:71], v[56:59], v[100:103]
ds_read_b64_tr_b16 v[190:191], v23 offset:14336
ds_read_b128 v[172:175], v3 offset:58368
v_mfma_f32_16x16x32_bf16 v[104:107], v[72:75], v[56:59], v[104:107]
v_mfma_f32_16x16x32_bf16 v[108:111], v[76:79], v[56:59], v[108:111]
v_mfma_f32_16x16x32_bf16 v[124:127], v[76:79], v[60:63], v[124:127]
v_mfma_f32_16x16x32_bf16 v[120:123], v[72:75], v[60:63], v[120:123]
v_mfma_f32_16x16x32_bf16 v[116:119], v[68:71], v[60:63], v[116:119]
v_mfma_f32_16x16x32_bf16 v[112:115], v[64:67], v[60:63], v[112:115]
s_waitcnt lgkmcnt(0)
s_barrier
v_mfma_f32_16x16x32_bf16 v[96:99], v[152:155], v[144:147], v[96:99]
v_mfma_f32_16x16x32_bf16 v[100:103], v[156:159], v[144:147], v[100:103]
v_mfma_f32_16x16x32_bf16 v[104:107], v[160:163], v[144:147], v[104:107]
v_mfma_f32_16x16x32_bf16 v[108:111], v[164:167], v[144:147], v[108:111]
v_mfma_f32_16x16x32_bf16 v[124:127], v[164:167], v[148:151], v[124:127]
v_mfma_f32_16x16x32_bf16 v[120:123], v[160:163], v[148:151], v[120:123]
v_mfma_f32_16x16x32_bf16 v[116:119], v[156:159], v[148:151], v[116:119]
v_mfma_f32_16x16x32_bf16 v[112:115], v[152:155], v[148:151], v[112:115]
v_mfma_f32_16x16x32_bf16 v[96:99], v[176:179], v[168:171], v[96:99]
v_mfma_f32_16x16x32_bf16 v[100:103], v[180:183], v[168:171], v[100:103]
v_mfma_f32_16x16x32_bf16 v[104:107], v[184:187], v[168:171], v[104:107]
v_mfma_f32_16x16x32_bf16 v[108:111], v[188:191], v[168:171], v[108:111]
v_mfma_f32_16x16x32_bf16 v[124:127], v[188:191], v[172:175], v[124:127]
v_mfma_f32_16x16x32_bf16 v[120:123], v[184:187], v[172:175], v[120:123]
v_mfma_f32_16x16x32_bf16 v[116:119], v[180:183], v[172:175], v[116:119]
v_mfma_f32_16x16x32_bf16 v[112:115], v[176:179], v[172:175], v[112:115]
s_nop 3
v_cvt_pk_bf16_f32 v32, v96, v97
v_cvt_pk_bf16_f32 v33, v98, v99
v_cvt_pk_bf16_f32 v34, v100, v101
v_cvt_pk_bf16_f32 v35, v102, v103
s_add_u32 s43, s60, 0
buffer_store_dwordx4 v[32:35], v11, s[20:23], s43 offen offset:0 sc1
v_cvt_pk_bf16_f32 v36, v104, v105
v_cvt_pk_bf16_f32 v37, v106, v107
v_cvt_pk_bf16_f32 v38, v108, v109
v_cvt_pk_bf16_f32 v39, v110, v111
s_add_u32 s43, s60, 8192
buffer_store_dwordx4 v[36:39], v11, s[20:23], s43 offen offset:0 sc1
v_cvt_pk_bf16_f32 v44, v120, v121
v_cvt_pk_bf16_f32 v45, v122, v123
v_cvt_pk_bf16_f32 v46, v124, v125
v_cvt_pk_bf16_f32 v47, v126, v127
s_add_u32 s43, s60, 8192
buffer_store_dwordx4 v[44:47], v11, s[20:23], s43 offen offset:1024 sc1
v_cvt_pk_bf16_f32 v40, v112, v113
v_cvt_pk_bf16_f32 v41, v114, v115
v_cvt_pk_bf16_f32 v42, v116, v117
v_cvt_pk_bf16_f32 v43, v118, v119
s_add_u32 s43, s60, 0
buffer_store_dwordx4 v[40:43], v11, s[20:23], s43 offen offset:1024 sc1
v_mov_b32 v64, 0
v_mov_b32 v65, 0
v_mov_b32 v66, 0
v_mov_b32 v67, 0
v_mov_b32 v68, 0
v_mov_b32 v69, 0
v_mov_b32 v70, 0
v_mov_b32 v71, 0
v_dot2_f32_bf16 v64, v32, s61, v64
v_dot2_f32_bf16 v66, v32, v32, v66
v_dot2_f32_bf16 v68, v40, s61, v68
v_dot2_f32_bf16 v70, v40, v40, v70
v_dot2_f32_bf16 v65, v33, s61, v65
v_dot2_f32_bf16 v67, v33, v33, v67
v_dot2_f32_bf16 v69, v41, s61, v69
v_dot2_f32_bf16 v71, v41, v41, v71
v_dot2_f32_bf16 v64, v34, s61, v64
v_dot2_f32_bf16 v66, v34, v34, v66
v_dot2_f32_bf16 v68, v42, s61, v68
v_dot2_f32_bf16 v70, v42, v42, v70
v_dot2_f32_bf16 v65, v35, s61, v65
v_dot2_f32_bf16 v67, v35, v35, v67
v_dot2_f32_bf16 v69, v43, s61, v69
v_dot2_f32_bf16 v71, v43, v43, v71
v_dot2_f32_bf16 v64, v36, s61, v64
v_dot2_f32_bf16 v66, v36, v36, v66
v_dot2_f32_bf16 v68, v44, s61, v68
v_dot2_f32_bf16 v70, v44, v44, v70
v_dot2_f32_bf16 v65, v37, s61, v65
v_dot2_f32_bf16 v67, v37, v37, v67
v_dot2_f32_bf16 v69, v45, s61, v69
v_dot2_f32_bf16 v71, v45, v45, v71
v_dot2_f32_bf16 v64, v38, s61, v64
v_dot2_f32_bf16 v66, v38, v38, v66
v_dot2_f32_bf16 v68, v46, s61, v68
v_dot2_f32_bf16 v70, v46, v46, v70
v_dot2_f32_bf16 v65, v39, s61, v65
v_dot2_f32_bf16 v67, v39, v39, v67
v_dot2_f32_bf16 v69, v47, s61, v69
v_dot2_f32_bf16 v71, v47, v47, v71
s_nop 2
v_add_f32 v64, v64, v65
v_add_f32 v66, v66, v67
v_add_f32 v68, v68, v69
v_add_f32 v70, v70, v71
s_nop 1
v_permlane32_swap_b32 v64, v68
v_permlane32_swap_b32 v66, v70
v_add_f32 v64, v64, v68
v_add_f32 v66, v66, v70
s_nop 1
v_permlane16_swap_b32 v64, v66
v_add_f32 v64, v64, v66
buffer_store_dword v64, v9, s[24:27], 0 offen sc1
s_lshl_b32 s7, s34, 12
s_add_u32 s7, s7, 49280
v_lshl_add_u32 v4, v1, 8, s7
v_mov_b32 v5, 1
s_waitcnt vmcnt(0)
s_cmp_lg_u32 s36, 0
s_barrier
s_cbranch_scc1 Lk2end_98
s_mov_b64 exec, 0xffff
buffer_atomic_add v5, v4, s[56:59], 0 offen sc1
s_mov_b64 exec, -1
s_branch Lk2end_98
Lprod_99:
s_mul_i32 s43, s34, 262144
s_add_u32 s8, s82, s43
s_addc_u32 s9, s83, 0
s_mov_b32 s10, 262144
s_mov_b32 s11, 0x20000
s_lshl_b32 s43, s35, 7
s_add_u32 s12, s68, s43
s_addc_u32 s13, s69, 0
s_mov_b32 s14, 2095232
s_mov_b32 s15, 0x20000
s_and_b32 s47, s36, 3
s_lshl_b32 s39, s47, 12
v_lshlrev_b32 v2, 4, v1
v_add_u32 v2, s39, v2
v_lshrrev_b32 v12, 3, v1
v_and_b32 v13, 6, v12
v_and_b32 v3, 7, v1
v_xor_b32 v3, v3, v13
v_lshlrev_b32 v3, 4, v3
v_mul_u32_u24 v12, 2048, v12
v_add_u32 v3, v3, v12
s_lshl_b32 s43, s47, 15
v_add_u32 v3, s43, v3
s_lshl_b32 s40, s47, 11
s_add_u32 s37, s35, 0
s_and_b32 s37, s37, 15
s_lshl_b32 s37, s37, 14
s_add_u32 m0, s39, 0
s_nop 0
buffer_load_dwordx4 v2, s[8:11], s37 offen offset:0 sc1 lds
buffer_load_dwordx4 v2, s[8:11], s37 offen offset:1024 sc1 lds
buffer_load_dwordx4 v2, s[8:11], s37 offen offset:2048 sc1 lds
buffer_load_dwordx4 v2, s[8:11], s37 offen offset:3072 sc1 lds
s_add_u32 s38, s35, 8
s_and_b32 s38, s38, 15
s_lshl_b32 s38, s38, 17
s_add_u32 m0, s40, 16384
s_nop 0
buffer_load_dwordx4 v3, s[12:15], s38 offen lds
s_add_u32 m0, s40, 17408
s_add_u32 s38, s38, 16384
buffer_load_dwordx4 v3, s[12:15], s38 offen lds
s_add_u32 s38, s35, 9
s_and_b32 s38, s38, 15
s_lshl_b32 s38, s38, 17
s_add_u32 m0, s40, 24576
s_nop 0
buffer_load_dwordx4 v3, s[12:15], s38 offen lds
s_add_u32 m0, s40, 25600
s_add_u32 s38, s38, 16384
buffer_load_dwordx4 v3, s[12:15], s38 offen lds
s_add_u32 s38, s35, 10
s_and_b32 s38, s38, 15
s_lshl_b32 s38, s38, 17
s_add_u32 m0, s40, 32768
s_nop 0
buffer_load_dwordx4 v3, s[12:15], s38 offen lds
s_add_u32 m0, s40, 33792
s_add_u32 s38, s38, 16384
buffer_load_dwordx4 v3, s[12:15], s38 offen lds
s_add_u32 s38, s35, 11
s_and_b32 s38, s38, 15
s_lshl_b32 s38, s38, 17
s_add_u32 m0, s40, 40960
s_nop 0
buffer_load_dwordx4 v3, s[12:15], s38 offen lds
s_add_u32 m0, s40, 41984
s_add_u32 s38, s38, 16384
buffer_load_dwordx4 v3, s[12:15], s38 offen lds
s_bitcmp0_b32 s36, 1
s_cselect_b32 s44, s72, s74
s_cselect_b32 s45, s73, s75
s_mul_i32 s43, s35, 192
s_add_u32 s16, s44, s43
s_addc_u32 s17, s45, 0
s_add_u32 s16, s16, 4096
s_addc_u32 s17, s17, 0
s_mov_b32 s18, 7333056
s_mov_b32 s19, 0x20000
s_and_b32 s43, s36, 1
s_mul_i32 s43, s43, 229376
v_add_u32 v196, 0, v1
v_mul_u32_u24 v197, 5462, v196
v_lshrrev_b32 v197, 16, v197
v_mul_u32_u24 v198, 12, v197
v_sub_u32 v198, v196, v198
v_bfe_u32 v199, v197, 2, 1
v_cmp_gt_u32 vcc, 8, v198
v_lshlrev_b32 v200, 1, v199
v_mul_u32_u24 v197, 7168, v197
v_cndmask_b32 v199, v199, v200, vcc
v_xor_b32 v198, v198, v199
v_lshl_add_u32 v192, v198, 4, v197
v_add_u32 v196, 64, v1
v_mul_u32_u24 v197, 5462, v196
v_lshrrev_b32 v197, 16, v197
v_mul_u32_u24 v198, 12, v197
v_sub_u32 v198, v196, v198
v_bfe_u32 v199, v197, 2, 1
v_cmp_gt_u32 vcc, 8, v198
v_lshlrev_b32 v200, 1, v199
v_mul_u32_u24 v197, 7168, v197
v_cndmask_b32 v199, v199, v200, vcc
v_xor_b32 v198, v198, v199
v_lshl_add_u32 v193, v198, 4, v197
v_add_u32 v196, 128, v1
v_mul_u32_u24 v197, 5462, v196
v_lshrrev_b32 v197, 16, v197
v_mul_u32_u24 v198, 12, v197
v_sub_u32 v198, v196, v198
v_bfe_u32 v199, v197, 2, 1
v_cmp_gt_u32 vcc, 8, v198
v_lshlrev_b32 v200, 1, v199
v_mul_u32_u24 v197, 7168, v197
v_cndmask_b32 v199, v199, v200, vcc
v_xor_b32 v198, v198, v199
v_lshl_add_u32 v194, v198, 4, v197
v_add_u32 v192, s43, v192
v_add_u32 v193, s43, v193
v_add_u32 v194, s43, v194
s_and_b32 s43, s36, 3
s_mul_i32 s50, s43, 6144
s_add_u32 s50, s50, 16384
s_cmp_eq_u32 s47, 3
s_cbranch_scc0 Lw_106
s_lshl_b32 s92, s34, 4
s_add_u32 s92, s92, s35
s_lshl_b32 s92, s92, 8
s_add_u32 s92, s92, 49152
s_add_u32 s92, s92, 28311552
s_mov_b32 s41, 0x40000
Lpoll_107:
s_load_dword s93, s[82:83], s92 glc
Lpchk_109:
s_waitcnt lgkmcnt(0)
s_cmp_eq_u32 s93, 16
s_cbranch_scc1 Lpok_108
s_sub_u32 s41, s41, 1
s_cmp_lg_u32 s41, 0
s_cbranch_scc1 Lpoll_107
Lpok_108:
Lw_106:
s_and_b32 s44, s36, 3
s_mul_i32 s44, s44, 11
s_bfe_u32 s43, s2, 0x30001
s_lshl_b32 s43, s43, 7
s_add_u32 s44, s44, s43
s_add_u32 s44, s44, 84
s_mul_i32 s44, s44, 7168
s_lshr_b32 s43, s2, 4
s_lshl_b32 s43, s43, 8
s_add_u32 s43, s43, s44
s_bitcmp0_b32 s2, 0
s_cselect_b32 s4, s72, s74
s_cselect_b32 s5, s73, s75
s_add_u32 s4, s4, s43
s_addc_u32 s5, s5, 0
s_cmp_eq_u32 s47, 3
s_cbranch_scc1 Lw_110
Lw_110:
s_waitcnt vmcnt(8)
s_barrier
s_add_u32 s37, s35, 1
s_and_b32 s37, s37, 15
s_lshl_b32 s37, s37, 14
s_add_u32 m0, s39, 49152
s_nop 0
buffer_load_dwordx4 v2, s[8:11], s37 offen offset:0 sc1 lds
buffer_load_dwordx4 v2, s[8:11], s37 offen offset:1024 sc1 lds
buffer_load_dwordx4 v2, s[8:11], s37 offen offset:2048 sc1 lds
buffer_load_dwordx4 v2, s[8:11], s37 offen offset:3072 sc1 lds
s_add_u32 s37, s35, 2
s_and_b32 s37, s37, 15
s_lshl_b32 s37, s37, 14
s_add_u32 m0, s39, 98304
s_nop 0
buffer_load_dwordx4 v2, s[8:11], s37 offen offset:0 sc1 lds
buffer_load_dwordx4 v2, s[8:11], s37 offen offset:1024 sc1 lds
buffer_load_dwordx4 v2, s[8:11], s37 offen offset:2048 sc1 lds
buffer_load_dwordx4 v2, s[8:11], s37 offen offset:3072 sc1 lds
s_add_u32 s37, s35, 3
s_and_b32 s37, s37, 15
s_lshl_b32 s37, s37, 14
s_add_u32 m0, s39, 147456
s_nop 0
buffer_load_dwordx4 v2, s[8:11], s37 offen offset:0 sc1 lds
buffer_load_dwordx4 v2, s[8:11], s37 offen offset:1024 sc1 lds
buffer_load_dwordx4 v2, s[8:11], s37 offen offset:2048 sc1 lds
buffer_load_dwordx4 v2, s[8:11], s37 offen offset:3072 sc1 lds
s_cmp_eq_u32 s47, 3
s_cbranch_scc0 Lw_111
Lw_111:
s_waitcnt vmcnt(8)
s_barrier
s_add_u32 s37, s35, 4
s_and_b32 s37, s37, 15
s_lshl_b32 s37, s37, 14
s_add_u32 m0, s39, 0
s_nop 0
buffer_load_dwordx4 v2, s[8:11], s37 offen offset:0 sc1 lds
buffer_load_dwordx4 v2, s[8:11], s37 offen offset:1024 sc1 lds
buffer_load_dwordx4 v2, s[8:11], s37 offen offset:2048 sc1 lds
buffer_load_dwordx4 v2, s[8:11], s37 offen offset:3072 sc1 lds
v_lshlrev_b32 v240, 16, v128
v_and_b32 v241, 0xffff0000, v128
v_lshlrev_b32 v242, 16, v129
v_and_b32 v243, 0xffff0000, v129
v_lshlrev_b32 v244, 16, v130
v_and_b32 v245, 0xffff0000, v130
v_lshlrev_b32 v246, 16, v131
v_and_b32 v247, 0xffff0000, v131
s_waitcnt vmcnt(8)
s_barrier
s_add_u32 s37, s35, 5
s_and_b32 s37, s37, 15
s_lshl_b32 s37, s37, 14
s_add_u32 m0, s39, 49152
s_nop 0
buffer_load_dwordx4 v2, s[8:11], s37 offen offset:0 sc1 lds
buffer_load_dwordx4 v2, s[8:11], s37 offen offset:1024 sc1 lds
buffer_load_dwordx4 v2, s[8:11], s37 offen offset:2048 sc1 lds
buffer_load_dwordx4 v2, s[8:11], s37 offen offset:3072 sc1 lds
v_lshlrev_b32 v24, 16, v132
v_and_b32 v25, 0xffff0000, v132
v_lshlrev_b32 v26, 16, v133
v_and_b32 v27, 0xffff0000, v133
v_lshlrev_b32 v28, 16, v134
v_and_b32 v29, 0xffff0000, v134
v_lshlrev_b32 v30, 16, v135
v_and_b32 v31, 0xffff0000, v135
v_add_f32 v240, v240, v24
v_add_f32 v241, v241, v25
v_add_f32 v242, v242, v26
v_add_f32 v243, v243, v27
v_add_f32 v244, v244, v28
v_add_f32 v245, v245, v29
v_add_f32 v246, v246, v30
v_add_f32 v247, v247, v31
s_waitcnt vmcnt(8)
s_barrier
s_add_u32 s37, s35, 6
s_and_b32 s37, s37, 15
s_lshl_b32 s37, s37, 14
s_add_u32 m0, s39, 98304
s_nop 0
buffer_load_dwordx4 v2, s[8:11], s37 offen offset:0 sc1 lds
buffer_load_dwordx4 v2, s[8:11], s37 offen offset:1024 sc1 lds
buffer_load_dwordx4 v2, s[8:11], s37 offen offset:2048 sc1 lds
buffer_load_dwordx4 v2, s[8:11], s37 offen offset:3072 sc1 lds
v_lshlrev_b32 v24, 16, v136
v_and_b32 v25, 0xffff0000, v136
v_lshlrev_b32 v26, 16, v137
v_and_b32 v27, 0xffff0000, v137
v_lshlrev_b32 v28, 16, v138
v_and_b32 v29, 0xffff0000, v138
v_lshlrev_b32 v30, 16, v139
v_and_b32 v31, 0xffff0000, v139
v_add_f32 v240, v240, v24
v_add_f32 v241, v241, v25
v_add_f32 v242, v242, v26
v_add_f32 v243, v243, v27
v_add_f32 v244, v244, v28
v_add_f32 v245, v245, v29
v_add_f32 v246, v246, v30
v_add_f32 v247, v247, v31
s_waitcnt vmcnt(8)
s_barrier
s_add_u32 s37, s35, 7
s_and_b32 s37, s37, 15
s_lshl_b32 s37, s37, 14
s_add_u32 m0, s39, 147456
s_nop 0
buffer_load_dwordx4 v2, s[8:11], s37 offen offset:0 sc1 lds
buffer_load_dwordx4 v2, s[8:11], s37 offen offset:1024 sc1 lds
buffer_load_dwordx4 v2, s[8:11], s37 offen offset:2048 sc1 lds
buffer_load_dwordx4 v2, s[8:11], s37 offen offset:3072 sc1 lds
v_lshlrev_b32 v24, 16, v140
v_and_b32 v25, 0xffff0000, v140
v_lshlrev_b32 v26, 16, v141
v_and_b32 v27, 0xffff0000, v141
v_lshlrev_b32 v28, 16, v142
v_and_b32 v29, 0xffff0000, v142
v_lshlrev_b32 v30, 16, v143
v_and_b32 v31, 0xffff0000, v143
v_add_f32 v240, v240, v24
v_add_f32 v241, v241, v25
v_add_f32 v242, v242, v26
v_add_f32 v243, v243, v27
v_add_f32 v244, v244, v28
v_add_f32 v245, v245, v29
v_add_f32 v246, v246, v30
v_add_f32 v247, v247, v31
s_waitcnt vmcnt(8)
s_barrier
s_add_u32 s37, s35, 8
s_and_b32 s37, s37, 15
s_lshl_b32 s37, s37, 14
s_add_u32 m0, s39, 0
s_nop 0
buffer_load_dwordx4 v2, s[8:11], s37 offen offset:0 sc1 lds
buffer_load_dwordx4 v2, s[8:11], s37 offen offset:1024 sc1 lds
buffer_load_dwordx4 v2, s[8:11], s37 offen offset:2048 sc1 lds
buffer_load_dwordx4 v2, s[8:11], s37 offen offset:3072 sc1 lds
s_add_u32 s38, s35, 12
s_and_b32 s38, s38, 15
s_lshl_b32 s38, s38, 17
s_add_u32 m0, s40, 114688
s_nop 0
buffer_load_dwordx4 v3, s[12:15], s38 offen lds
s_add_u32 m0, s40, 115712
s_add_u32 s38, s38, 16384
buffer_load_dwordx4 v3, s[12:15], s38 offen lds
v_lshlrev_b32 v24, 16, v144
v_and_b32 v25, 0xffff0000, v144
v_lshlrev_b32 v26, 16, v145
v_and_b32 v27, 0xffff0000, v145
v_lshlrev_b32 v28, 16, v146
v_and_b32 v29, 0xffff0000, v146
v_lshlrev_b32 v30, 16, v147
v_and_b32 v31, 0xffff0000, v147
v_add_f32 v240, v240, v24
v_add_f32 v241, v241, v25
v_add_f32 v242, v242, v26
v_add_f32 v243, v243, v27
v_add_f32 v244, v244, v28
v_add_f32 v245, v245, v29
v_add_f32 v246, v246, v30
v_add_f32 v247, v247, v31
s_waitcnt vmcnt(10)
s_barrier
s_add_u32 s37, s35, 9
s_and_b32 s37, s37, 15
s_lshl_b32 s37, s37, 14
s_add_u32 m0, s39, 49152
s_nop 0
buffer_load_dwordx4 v2, s[8:11], s37 offen offset:0 sc1 lds
buffer_load_dwordx4 v2, s[8:11], s37 offen offset:1024 sc1 lds
buffer_load_dwordx4 v2, s[8:11], s37 offen offset:2048 sc1 lds
buffer_load_dwordx4 v2, s[8:11], s37 offen offset:3072 sc1 lds
s_add_u32 s38, s35, 13
s_and_b32 s38, s38, 15
s_lshl_b32 s38, s38, 17
s_add_u32 m0, s40, 122880
s_nop 0
buffer_load_dwordx4 v3, s[12:15], s38 offen lds
s_add_u32 m0, s40, 123904
s_add_u32 s38, s38, 16384
buffer_load_dwordx4 v3, s[12:15], s38 offen lds
v_lshlrev_b32 v24, 16, v148
v_and_b32 v25, 0xffff0000, v148
v_lshlrev_b32 v26, 16, v149
v_and_b32 v27, 0xffff0000, v149
v_lshlrev_b32 v28, 16, v150
v_and_b32 v29, 0xffff0000, v150
v_lshlrev_b32 v30, 16, v151
v_and_b32 v31, 0xffff0000, v151
v_add_f32 v240, v240, v24
v_add_f32 v241, v241, v25
v_add_f32 v242, v242, v26
v_add_f32 v243, v243, v27
v_add_f32 v244, v244, v28
v_add_f32 v245, v245, v29
v_add_f32 v246, v246, v30
v_add_f32 v247, v247, v31
s_waitcnt vmcnt(12)
s_barrier
s_add_u32 s37, s35, 10
s_and_b32 s37, s37, 15
s_lshl_b32 s37, s37, 14
s_add_u32 m0, s39, 98304
s_nop 0
buffer_load_dwordx4 v2, s[8:11], s37 offen offset:0 sc1 lds
buffer_load_dwordx4 v2, s[8:11], s37 offen offset:1024 sc1 lds
buffer_load_dwordx4 v2, s[8:11], s37 offen offset:2048 sc1 lds
buffer_load_dwordx4 v2, s[8:11], s37 offen offset:3072 sc1 lds
s_add_u32 s38, s35, 14
s_and_b32 s38, s38, 15
s_lshl_b32 s38, s38, 17
s_add_u32 m0, s40, 131072
s_nop 0
buffer_load_dwordx4 v3, s[12:15], s38 offen lds
s_add_u32 m0, s40, 132096
s_add_u32 s38, s38, 16384
buffer_load_dwordx4 v3, s[12:15], s38 offen lds
v_lshlrev_b32 v24, 16, v152
v_and_b32 v25, 0xffff0000, v152
v_lshlrev_b32 v26, 16, v153
v_and_b32 v27, 0xffff0000, v153
v_lshlrev_b32 v28, 16, v154
v_and_b32 v29, 0xffff0000, v154
v_lshlrev_b32 v30, 16, v155
v_and_b32 v31, 0xffff0000, v155
v_add_f32 v240, v240, v24
v_add_f32 v241, v241, v25
v_add_f32 v242, v242, v26
v_add_f32 v243, v243, v27
v_add_f32 v244, v244, v28
v_add_f32 v245, v245, v29
v_add_f32 v246, v246, v30
v_add_f32 v247, v247, v31
s_waitcnt vmcnt(14)
s_barrier
s_add_u32 s37, s35, 11
s_and_b32 s37, s37, 15
s_lshl_b32 s37, s37, 14
s_add_u32 m0, s39, 147456
s_nop 0
buffer_load_dwordx4 v2, s[8:11], s37 offen offset:0 sc1 lds
buffer_load_dwordx4 v2, s[8:11], s37 offen offset:1024 sc1 lds
buffer_load_dwordx4 v2, s[8:11], s37 offen offset:2048 sc1 lds
buffer_load_dwordx4 v2, s[8:11], s37 offen offset:3072 sc1 lds
s_add_u32 s38, s35, 15
s_and_b32 s38, s38, 15
s_lshl_b32 s38, s38, 17
s_add_u32 m0, s40, 139264
s_nop 0
buffer_load_dwordx4 v3, s[12:15], s38 offen lds
s_add_u32 m0, s40, 140288
s_add_u32 s38, s38, 16384
buffer_load_dwordx4 v3, s[12:15], s38 offen lds
v_lshlrev_b32 v24, 16, v156
v_and_b32 v25, 0xffff0000, v156
v_lshlrev_b32 v26, 16, v157
v_and_b32 v27, 0xffff0000, v157
v_lshlrev_b32 v28, 16, v158
v_and_b32 v29, 0xffff0000, v158
v_lshlrev_b32 v30, 16, v159
v_and_b32 v31, 0xffff0000, v159
v_add_f32 v240, v240, v24
v_add_f32 v241, v241, v25
v_add_f32 v242, v242, v26
v_add_f32 v243, v243, v27
v_add_f32 v244, v244, v28
v_add_f32 v245, v245, v29
v_add_f32 v246, v246, v30
v_add_f32 v247, v247, v31
s_waitcnt vmcnt(14)
s_barrier
s_add_u32 s37, s35, 12
s_and_b32 s37, s37, 15
s_lshl_b32 s37, s37, 14
s_add_u32 m0, s39, 0
s_nop 0
buffer_load_dwordx4 v2, s[8:11], s37 offen offset:0 sc1 lds
buffer_load_dwordx4 v2, s[8:11], s37 offen offset:1024 sc1 lds
buffer_load_dwordx4 v2, s[8:11], s37 offen offset:2048 sc1 lds
buffer_load_dwordx4 v2, s[8:11], s37 offen offset:3072 sc1 lds
s_waitcnt vmcnt(12)
s_barrier
s_add_u32 s37, s35, 13
s_and_b32 s37, s37, 15
s_lshl_b32 s37, s37, 14
s_add_u32 m0, s39, 49152
s_nop 0
buffer_load_dwordx4 v2, s[8:11], s37 offen offset:0 sc1 lds
buffer_load_dwordx4 v2, s[8:11], s37 offen offset:1024 sc1 lds
buffer_load_dwordx4 v2, s[8:11], s37 offen offset:2048 sc1 lds
buffer_load_dwordx4 v2, s[8:11], s37 offen offset:3072 sc1 lds
s_waitcnt vmcnt(10)
s_barrier
s_add_u32 s37, s35, 14
s_and_b32 s37, s37, 15
s_lshl_b32 s37, s37, 14
s_add_u32 m0, s39, 98304
s_nop 0
buffer_load_dwordx4 v2, s[8:11], s37 offen offset:0 sc1 lds
s_branch Lov_7
.p2align 12
.fill 48, 4, 0xbf800000
Lst_7_0:
s_branch Lwr_167
s_nop 0
s_nop 0
Lov_7:
buffer_load_dwordx4 v2, s[8:11], s37 offen offset:1024 sc1 lds
buffer_load_dwordx4 v2, s[8:11], s37 offen offset:2048 sc1 lds
buffer_load_dwordx4 v2, s[8:11], s37 offen offset:3072 sc1 lds
s_getpc_b64 s[100:101]
s_and_b32 s100, s100, 0xfffff000
s_sub_u32 s100, s100, 1081344
s_subb_u32 s101, s101, 0
s_lshr_b32 s6, s2, 3
s_mul_i32 s6, s6, 4
s_and_b32 s7, s36, 3
s_add_u32 s6, s6, s7
s_mulk_i32 s6, 384
s_add_u32 s6, s6, 1082048
s_load_dword s3, s[100:101], s6 offset:0
s_load_dword s3, s[100:101], s6 offset:64
s_load_dword s3, s[100:101], s6 offset:128
s_load_dword s3, s[100:101], s6 offset:192
s_load_dword s3, s[100:101], s6 offset:256
s_load_dword s3, s[100:101], s6 offset:320
s_nop 0
s_nop 0
s_waitcnt vmcnt(8)
s_barrier
s_add_u32 s37, s35, 15
s_and_b32 s37, s37, 15
s_lshl_b32 s37, s37, 14
s_add_u32 m0, s39, 147456
s_nop 0
buffer_load_dwordx4 v2, s[8:11], s37 offen offset:0 sc1 lds
buffer_load_dwordx4 v2, s[8:11], s37 offen offset:1024 sc1 lds
buffer_load_dwordx4 v2, s[8:11], s37 offen offset:2048 sc1 lds
buffer_load_dwordx4 v2, s[8:11], s37 offen offset:3072 sc1 lds
s_waitcnt vmcnt(8)
s_barrier
s_nop 0
v_permlane32_swap_b32 v240, v244
v_permlane32_swap_b32 v241, v245
v_permlane32_swap_b32 v242, v246
v_permlane32_swap_b32 v243, v247
v_add_f32 v240, v240, v244
v_add_f32 v241, v241, v245
v_add_f32 v242, v242, v246
v_add_f32 v243, v243, v247
s_nop 0
v_permlane16_swap_b32 v240, v242
v_permlane16_swap_b32 v241, v243
v_add_f32 v240, v240, v242
v_add_f32 v241, v241, v243
s_waitcnt vmcnt(4)
s_barrier
s_add_u32 s38, s35, 0
s_and_b32 s38, s38, 15
s_mul_i32 s38, s38, 458752
s_add_u32 m0, s50, 0
s_nop 0
buffer_load_dwordx4 v192, s[16:19], s38 offen lds
s_add_u32 m0, s50, 1024
s_nop 0
buffer_load_dwordx4 v193, s[16:19], s38 offen lds
s_add_u32 m0, s50, 2048
s_nop 0
buffer_load_dwordx4 v194, s[16:19], s38 offen lds
s_add_u32 m0, s50, 3072
s_add_u32 s38, s38, 114688
buffer_load_dwordx4 v192, s[16:19], s38 offen lds
s_add_u32 m0, s50, 4096
s_nop 0
buffer_load_dwordx4 v193, s[16:19], s38 offen lds
s_add_u32 m0, s50, 5120
s_nop 0
buffer_load_dwordx4 v194, s[16:19], s38 offen lds
s_add_u32 s38, s35, 1
s_and_b32 s38, s38, 15
s_mul_i32 s38, s38, 458752
s_add_u32 m0, s50, 49152
s_nop 0
buffer_load_dwordx4 v192, s[16:19], s38 offen lds
s_add_u32 m0, s50, 50176
s_nop 0
buffer_load_dwordx4 v193, s[16:19], s38 offen lds
s_add_u32 m0, s50, 51200
s_nop 0
buffer_load_dwordx4 v194, s[16:19], s38 offen lds
s_add_u32 m0, s50, 52224
s_add_u32 s38, s38, 114688
buffer_load_dwordx4 v192, s[16:19], s38 offen lds
s_add_u32 m0, s50, 53248
s_nop 0
buffer_load_dwordx4 v193, s[16:19], s38 offen lds
s_add_u32 m0, s50, 54272
s_nop 0
buffer_load_dwordx4 v194, s[16:19], s38 offen lds
s_waitcnt vmcnt(12)
s_barrier
s_barrier
s_branch Lk3a
Lk2end_98:
Lk3:
s_branch Lgb_112
Lk3a:
s_mul_i32 s43, s34, 262144
s_add_u32 s8, s82, s43
s_addc_u32 s9, s83, 0
s_add_u32 s8, s8, 4194304
s_addc_u32 s9, s9, 0
s_mov_b32 s10, 262144
s_mov_b32 s11, 0x20000
s_mul_i32 s43, s34, 917504
s_add_u32 s24, s82, s43
s_addc_u32 s25, s83, 0
s_add_u32 s24, s24, 8388608
s_addc_u32 s25, s25, 0
s_mov_b32 s26, 917504
s_mov_b32 s27, 0x20000
s_add_u32 s84, s82, 27262976
s_addc_u32 s85, s83, 0
s_mov_b32 s86, 229376
s_mov_b32 s87, 0x20000
s_and_b32 s47, s36, 3
s_lshr_b32 s62, s47, 1
s_and_b32 s63, s47, 1
v_lshlrev_b32 v2, 4, v1
s_lshl_b32 s39, s47, 12
v_add_u32 v3, s39, v2
s_bitcmp0_b32 s36, 1
s_cselect_b32 s44, s72, s74
s_cselect_b32 s45, s73, s75
s_mul_i32 s43, s35, 256
s_add_u32 s12, s44, s43
s_addc_u32 s13, s45, 0
s_mov_b32 s14, 7333120
s_mov_b32 s15, 0x20000
s_and_b32 s43, s36, 1
s_mul_i32 s43, s43, 229376
v_lshrrev_b32 v28, 4, v1
v_lshlrev_b32 v29, 1, v28
v_and_b32 v4, 15, v1
v_xor_b32 v4, v4, v29
v_lshlrev_b32 v4, 4, v4
v_mul_u32_u24 v28, 7168, v28
v_add_u32 v4, v4, v28
v_add_u32 v4, s43, v4
v_xor_b32 v5, 128, v4
v_add_u32 v5, 28672, v5
s_and_b32 s43, s36, 3
s_mul_i32 s40, s43, 8192
s_add_u32 s40, s40, 16384
v_mov_b32 v6, v192
v_mov_b32 v7, v193
v_mov_b32 v8, v194
s_lshl_b32 s43, s62, 12
v_add_u32 v9, s43, v2
v_add_u32 v10, 98304, v9
v_lshrrev_b32 v27, 2, v1
v_bfe_u32 v28, v27, 2, 1
v_mul_u32_u24 v27, 192, v27
v_add_u32 v27, 16384, v27
v_and_b32 v29, 3, v1
v_lshl_add_u32 v12, v29, 3, v27
s_lshl_b32 s43, s63, 6
v_add_u32 v12, s43, v12
v_lshl_add_u32 v11, v28, 5, v12
v_xor_b32 v30, 1, v28
v_lshl_add_u32 v12, v30, 5, v12
v_xor_b32 v28, s63, v28
v_lshl_add_u32 v27, v28, 4, v27
v_lshrrev_b32 v28, 1, v29
v_lshl_add_u32 v27, v28, 5, v27
v_and_b32 v28, 1, v29
v_lshl_add_u32 v27, v28, 3, v27
v_add_u32 v13, 128, v27
v_add_u32 v14, 49152, v11
v_add_u32 v15, 49152, v12
v_add_u32 v16, 49152, v13
v_add_u32 v17, 98304, v11
v_add_u32 v18, 98304, v12
v_add_u32 v19, 98304, v13
s_cmp_lg_u32 s36, 4
s_cbranch_scc1 Lwm_114
s_branch Lst_8_1
Lwr_179:
s_branch Lwe_113
Lwm_114:
s_cmp_lg_u32 s36, 5
s_cbranch_scc1 Lwm_115
s_branch Lst_9_1
Lwr_180:
s_branch Lwe_113
Lwm_115:
s_cmp_lg_u32 s36, 6
s_cbranch_scc1 Lwm_116
s_branch Lst_10_1
Lwr_181:
s_branch Lwe_113
Lwm_116:
s_cmp_lg_u32 s36, 7
s_cbranch_scc1 Lwm_117
s_nop 0
s_branch Lwe_113
Lwm_117:
Lwe_113:
s_barrier
s_lshl_b32 s43, s47, 9
s_add_u32 s43, s43, 151552
v_and_b32 v28, 15, v1
v_lshl_add_u32 v28, v28, 5, s43
v_lshrrev_b32 v29, 4, v1
v_lshl_add_u32 v28, v29, 3, v28
ds_write_b64 v28, v[240:241]
s_waitcnt lgkmcnt(0)
s_cmp_lg_u32 s36, 4
s_cbranch_scc1 Lwm_119
s_branch Lst_11_1
Lwr_183:
s_branch Lwe_118
Lwm_119:
s_cmp_lg_u32 s36, 5
s_cbranch_scc1 Lwm_120
s_branch Lst_12_1
Lwr_184:
s_branch Lwe_118
Lwm_120:
s_cmp_lg_u32 s36, 6
s_cbranch_scc1 Lwm_121
s_branch Lst_13_1
Lwr_185:
s_branch Lwe_118
Lwm_121:
s_cmp_lg_u32 s36, 7
s_cbranch_scc1 Lwm_122
s_branch Lst_14_1
Lwr_186:
s_branch Lwe_118
Lwm_122:
Lwe_118:
s_waitcnt vmcnt(0) lgkmcnt(0)
s_barrier
ds_read_b128 v[32:35], v9 offset:0
ds_read_b64_tr_b16 v[48:49], v11 offset:0
ds_read_b64_tr_b16 v[50:51], v11 offset:3072
ds_read_b64_tr_b16 v[52:53], v12 offset:0
ds_read_b64_tr_b16 v[54:55], v12 offset:3072
ds_read_b64_tr_b16 v[56:57], v13 offset:0
ds_read_b64_tr_b16 v[58:59], v13 offset:3072
ds_read_b64_tr_b16 v[60:61], v11 offset:12288
ds_read_b64_tr_b16 v[62:63], v11 offset:15360
ds_read_b64_tr_b16 v[64:65], v12 offset:12288
ds_read_b64_tr_b16 v[66:67], v12 offset:15360
ds_read_b64_tr_b16 v[68:69], v13 offset:12288
ds_read_b64_tr_b16 v[70:71], v13 offset:15360
ds_read_b128 v[36:39], v9 offset:1024
ds_read_b128 v[40:43], v9 offset:2048
ds_read_b128 v[44:47], v9 offset:3072
s_waitcnt lgkmcnt(0)
v_mfma_f32_16x16x32_bf16 v[128:131], v[48:51], v[32:35], 0
ds_read_b128 v[72:75], v9 offset:8192
v_mfma_f32_16x16x32_bf16 v[152:155], v[48:51], v[36:39], 0
ds_read_b64_tr_b16 v[88:89], v11 offset:6144
v_mfma_f32_16x16x32_bf16 v[176:179], v[48:51], v[40:43], 0
ds_read_b64_tr_b16 v[90:91], v11 offset:9216
v_mfma_f32_16x16x32_bf16 v[200:203], v[48:51], v[44:47], 0
ds_read_b64_tr_b16 v[92:93], v12 offset:6144
v_mfma_f32_16x16x32_bf16 v[204:207], v[52:55], v[44:47], 0
ds_read_b64_tr_b16 v[94:95], v12 offset:9216
v_mfma_f32_16x16x32_bf16 v[180:183], v[52:55], v[40:43], 0
ds_read_b64_tr_b16 v[96:97], v13 offset:6144
v_mfma_f32_16x16x32_bf16 v[156:159], v[52:55], v[36:39], 0
ds_read_b64_tr_b16 v[98:99], v13 offset:9216
v_mfma_f32_16x16x32_bf16 v[132:135], v[52:55], v[32:35], 0
ds_read_b64_tr_b16 v[100:101], v11 offset:18432
v_mfma_f32_16x16x32_bf16 v[136:139], v[56:59], v[32:35], 0
ds_read_b64_tr_b16 v[102:103], v11 offset:21504
v_mfma_f32_16x16x32_bf16 v[160:163], v[56:59], v[36:39], 0
ds_read_b64_tr_b16 v[104:105], v12 offset:18432
v_mfma_f32_16x16x32_bf16 v[184:187], v[56:59], v[40:43], 0
ds_read_b64_tr_b16 v[106:107], v12 offset:21504
v_mfma_f32_16x16x32_bf16 v[208:211], v[56:59], v[44:47], 0
ds_read_b64_tr_b16 v[108:109], v13 offset:18432
v_mfma_f32_16x16x32_bf16 v[212:215], v[60:63], v[44:47], 0
ds_read_b64_tr_b16 v[110:111], v13 offset:21504
v_mfma_f32_16x16x32_bf16 v[188:191], v[60:63], v[40:43], 0
ds_read_b128 v[76:79], v9 offset:9216
v_mfma_f32_16x16x32_bf16 v[164:167], v[60:63], v[36:39], 0
ds_read_b128 v[80:83], v9 offset:10240
v_mfma_f32_16x16x32_bf16 v[140:143], v[60:63], v[32:35], 0
ds_read_b128 v[84:87], v9 offset:11264
v_mfma_f32_16x16x32_bf16 v[144:147], v[64:67], v[32:35], 0
v_mfma_f32_16x16x32_bf16 v[168:171], v[64:67], v[36:39], 0
v_mfma_f32_16x16x32_bf16 v[192:195], v[64:67], v[40:43], 0
v_mfma_f32_16x16x32_bf16 v[216:219], v[64:67], v[44:47], 0
v_mfma_f32_16x16x32_bf16 v[220:223], v[68:71], v[44:47], 0
v_mfma_f32_16x16x32_bf16 v[196:199], v[68:71], v[40:43], 0
v_mfma_f32_16x16x32_bf16 v[172:175], v[68:71], v[36:39], 0
v_mfma_f32_16x16x32_bf16 v[148:151], v[68:71], v[32:35], 0
s_waitcnt lgkmcnt(0)
s_barrier
v_mfma_f32_16x16x32_bf16 v[128:131], v[88:91], v[72:75], v[128:131]
ds_read_b128 v[32:35], v9 offset:49152
v_mfma_f32_16x16x32_bf16 v[152:155], v[88:91], v[76:79], v[152:155]
ds_read_b64_tr_b16 v[48:49], v14 offset:0
v_mfma_f32_16x16x32_bf16 v[176:179], v[88:91], v[80:83], v[176:179]
ds_read_b64_tr_b16 v[50:51], v14 offset:3072
v_mfma_f32_16x16x32_bf16 v[200:203], v[88:91], v[84:87], v[200:203]
ds_read_b64_tr_b16 v[52:53], v15 offset:0
v_mfma_f32_16x16x32_bf16 v[204:207], v[92:95], v[84:87], v[204:207]
ds_read_b64_tr_b16 v[54:55], v15 offset:3072
v_mfma_f32_16x16x32_bf16 v[180:183], v[92:95], v[80:83], v[180:183]
ds_read_b64_tr_b16 v[56:57], v16 offset:0
v_mfma_f32_16x16x32_bf16 v[156:159], v[92:95], v[76:79], v[156:159]
ds_read_b64_tr_b16 v[58:59], v16 offset:3072
v_mfma_f32_16x16x32_bf16 v[132:135], v[92:95], v[72:75], v[132:135]
ds_read_b64_tr_b16 v[60:61], v14 offset:12288
v_mfma_f32_16x16x32_bf16 v[136:139], v[96:99], v[72:75], v[136:139]
ds_read_b64_tr_b16 v[62:63], v14 offset:15360
v_mfma_f32_16x16x32_bf16 v[160:163], v[96:99], v[76:79], v[160:163]
ds_read_b64_tr_b16 v[64:65], v15 offset:12288
v_mfma_f32_16x16x32_bf16 v[184:187], v[96:99], v[80:83], v[184:187]
ds_read_b64_tr_b16 v[66:67], v15 offset:15360
v_mfma_f32_16x16x32_bf16 v[208:211], v[96:99], v[84:87], v[208:211]
ds_read_b64_tr_b16 v[68:69], v16 offset:12288
v_mfma_f32_16x16x32_bf16 v[212:215], v[100:103], v[84:87], v[212:215]
ds_read_b64_tr_b16 v[70:71], v16 offset:15360
v_mfma_f32_16x16x32_bf16 v[188:191], v[100:103], v[80:83], v[188:191]
ds_read_b128 v[36:39], v9 offset:50176
v_mfma_f32_16x16x32_bf16 v[164:167], v[100:103], v[76:79], v[164:167]
ds_read_b128 v[40:43], v9 offset:51200
v_mfma_f32_16x16x32_bf16 v[140:143], v[100:103], v[72:75], v[140:143]
ds_read_b128 v[44:47], v9 offset:52224
v_mfma_f32_16x16x32_bf16 v[144:147], v[104:107], v[72:75], v[144:147]
v_mfma_f32_16x16x32_bf16 v[168:171], v[104:107], v[76:79], v[168:171]
v_mfma_f32_16x16x32_bf16 v[192:195], v[104:107], v[80:83], v[192:195]
v_mfma_f32_16x16x32_bf16 v[216:219], v[104:107], v[84:87], v[216:219]
v_mfma_f32_16x16x32_bf16 v[220:223], v[108:111], v[84:87], v[220:223]
v_mfma_f32_16x16x32_bf16 v[196:199], v[108:111], v[80:83], v[196:199]
v_mfma_f32_16x16x32_bf16 v[172:175], v[108:111], v[76:79], v[172:175]
v_mfma_f32_16x16x32_bf16 v[148:151], v[108:111], v[72:75], v[148:151]
s_mov_b32 s41, 5
Lk3l_123:
s_waitcnt lgkmcnt(0)
v_mfma_f32_16x16x32_bf16 v[128:131], v[48:51], v[32:35], v[128:131]
ds_read_b128 v[72:75], v9 offset:57344
v_mfma_f32_16x16x32_bf16 v[152:155], v[48:51], v[36:39], v[152:155]
ds_read_b64_tr_b16 v[88:89], v14 offset:6144
v_mfma_f32_16x16x32_bf16 v[176:179], v[48:51], v[40:43], v[176:179]
ds_read_b64_tr_b16 v[90:91], v14 offset:9216
v_mfma_f32_16x16x32_bf16 v[200:203], v[48:51], v[44:47], v[200:203]
ds_read_b64_tr_b16 v[92:93], v15 offset:6144
v_mfma_f32_16x16x32_bf16 v[204:207], v[52:55], v[44:47], v[204:207]
ds_read_b64_tr_b16 v[94:95], v15 offset:9216
v_mfma_f32_16x16x32_bf16 v[180:183], v[52:55], v[40:43], v[180:183]
ds_read_b64_tr_b16 v[96:97], v16 offset:6144
v_mfma_f32_16x16x32_bf16 v[156:159], v[52:55], v[36:39], v[156:159]
ds_read_b64_tr_b16 v[98:99], v16 offset:9216
v_mfma_f32_16x16x32_bf16 v[132:135], v[52:55], v[32:35], v[132:135]
ds_read_b64_tr_b16 v[100:101], v14 offset:18432
v_mfma_f32_16x16x32_bf16 v[136:139], v[56:59], v[32:35], v[136:139]
ds_read_b64_tr_b16 v[102:103], v14 offset:21504
v_mfma_f32_16x16x32_bf16 v[160:163], v[56:59], v[36:39], v[160:163]
ds_read_b64_tr_b16 v[104:105], v15 offset:18432
v_mfma_f32_16x16x32_bf16 v[184:187], v[56:59], v[40:43], v[184:187]
ds_read_b64_tr_b16 v[106:107], v15 offset:21504
v_mfma_f32_16x16x32_bf16 v[208:211], v[56:59], v[44:47], v[208:211]
ds_read_b64_tr_b16 v[108:109], v16 offset:18432
v_mfma_f32_16x16x32_bf16 v[212:215], v[60:63], v[44:47], v[212:215]
ds_read_b64_tr_b16 v[110:111], v16 offset:21504
v_mfma_f32_16x16x32_bf16 v[188:191], v[60:63], v[40:43], v[188:191]
ds_read_b128 v[76:79], v9 offset:58368
v_mfma_f32_16x16x32_bf16 v[164:167], v[60:63], v[36:39], v[164:167]
ds_read_b128 v[80:83], v9 offset:59392
v_mfma_f32_16x16x32_bf16 v[140:143], v[60:63], v[32:35], v[140:143]
ds_read_b128 v[84:87], v9 offset:60416
v_mfma_f32_16x16x32_bf16 v[144:147], v[64:67], v[32:35], v[144:147]
v_mfma_f32_16x16x32_bf16 v[168:171], v[64:67], v[36:39], v[168:171]
v_mfma_f32_16x16x32_bf16 v[192:195], v[64:67], v[40:43], v[192:195]
v_mfma_f32_16x16x32_bf16 v[216:219], v[64:67], v[44:47], v[216:219]
v_mfma_f32_16x16x32_bf16 v[220:223], v[68:71], v[44:47], v[220:223]
v_mfma_f32_16x16x32_bf16 v[196:199], v[68:71], v[40:43], v[196:199]
v_mfma_f32_16x16x32_bf16 v[172:175], v[68:71], v[36:39], v[172:175]
v_mfma_f32_16x16x32_bf16 v[148:151], v[68:71], v[32:35], v[148:151]
s_waitcnt lgkmcnt(0)
s_barrier
v_mfma_f32_16x16x32_bf16 v[128:131], v[88:91], v[72:75], v[128:131]
ds_read_b128 v[32:35], v10 offset:0
v_mfma_f32_16x16x32_bf16 v[152:155], v[88:91], v[76:79], v[152:155]
ds_read_b64_tr_b16 v[48:49], v17 offset:0
v_mfma_f32_16x16x32_bf16 v[176:179], v[88:91], v[80:83], v[176:179]
ds_read_b64_tr_b16 v[50:51], v17 offset:3072
v_mfma_f32_16x16x32_bf16 v[200:203], v[88:91], v[84:87], v[200:203]
ds_read_b64_tr_b16 v[52:53], v18 offset:0
v_mfma_f32_16x16x32_bf16 v[204:207], v[92:95], v[84:87], v[204:207]
ds_read_b64_tr_b16 v[54:55], v18 offset:3072
v_mfma_f32_16x16x32_bf16 v[180:183], v[92:95], v[80:83], v[180:183]
ds_read_b64_tr_b16 v[56:57], v19 offset:0
v_mfma_f32_16x16x32_bf16 v[156:159], v[92:95], v[76:79], v[156:159]
ds_read_b64_tr_b16 v[58:59], v19 offset:3072
v_mfma_f32_16x16x32_bf16 v[132:135], v[92:95], v[72:75], v[132:135]
ds_read_b64_tr_b16 v[60:61], v17 offset:12288
v_mfma_f32_16x16x32_bf16 v[136:139], v[96:99], v[72:75], v[136:139]
ds_read_b64_tr_b16 v[62:63], v17 offset:15360
v_mfma_f32_16x16x32_bf16 v[160:163], v[96:99], v[76:79], v[160:163]
ds_read_b64_tr_b16 v[64:65], v18 offset:12288
v_mfma_f32_16x16x32_bf16 v[184:187], v[96:99], v[80:83], v[184:187]
ds_read_b64_tr_b16 v[66:67], v18 offset:15360
v_mfma_f32_16x16x32_bf16 v[208:211], v[96:99], v[84:87], v[208:211]
ds_read_b64_tr_b16 v[68:69], v19 offset:12288
v_mfma_f32_16x16x32_bf16 v[212:215], v[100:103], v[84:87], v[212:215]
ds_read_b64_tr_b16 v[70:71], v19 offset:15360
v_mfma_f32_16x16x32_bf16 v[188:191], v[100:103], v[80:83], v[188:191]
ds_read_b128 v[36:39], v10 offset:1024
v_mfma_f32_16x16x32_bf16 v[164:167], v[100:103], v[76:79], v[164:167]
ds_read_b128 v[40:43], v10 offset:2048
v_mfma_f32_16x16x32_bf16 v[140:143], v[100:103], v[72:75], v[140:143]
ds_read_b128 v[44:47], v10 offset:3072
v_mfma_f32_16x16x32_bf16 v[144:147], v[104:107], v[72:75], v[144:147]
v_mfma_f32_16x16x32_bf16 v[168:171], v[104:107], v[76:79], v[168:171]
v_mfma_f32_16x16x32_bf16 v[192:195], v[104:107], v[80:83], v[192:195]
v_mfma_f32_16x16x32_bf16 v[216:219], v[104:107], v[84:87], v[216:219]
v_mfma_f32_16x16x32_bf16 v[220:223], v[108:111], v[84:87], v[220:223]
v_mfma_f32_16x16x32_bf16 v[196:199], v[108:111], v[80:83], v[196:199]
v_mfma_f32_16x16x32_bf16 v[172:175], v[108:111], v[76:79], v[172:175]
v_mfma_f32_16x16x32_bf16 v[148:151], v[108:111], v[72:75], v[148:151]
s_waitcnt lgkmcnt(0)
v_mfma_f32_16x16x32_bf16 v[128:131], v[48:51], v[32:35], v[128:131]
ds_read_b128 v[72:75], v10 offset:8192
v_mfma_f32_16x16x32_bf16 v[152:155], v[48:51], v[36:39], v[152:155]
ds_read_b64_tr_b16 v[88:89], v17 offset:6144
v_mfma_f32_16x16x32_bf16 v[176:179], v[48:51], v[40:43], v[176:179]
ds_read_b64_tr_b16 v[90:91], v17 offset:9216
v_mfma_f32_16x16x32_bf16 v[200:203], v[48:51], v[44:47], v[200:203]
ds_read_b64_tr_b16 v[92:93], v18 offset:6144
v_mfma_f32_16x16x32_bf16 v[204:207], v[52:55], v[44:47], v[204:207]
ds_read_b64_tr_b16 v[94:95], v18 offset:9216
v_mfma_f32_16x16x32_bf16 v[180:183], v[52:55], v[40:43], v[180:183]
ds_read_b64_tr_b16 v[96:97], v19 offset:6144
v_mfma_f32_16x16x32_bf16 v[156:159], v[52:55], v[36:39], v[156:159]
ds_read_b64_tr_b16 v[98:99], v19 offset:9216
v_mfma_f32_16x16x32_bf16 v[132:135], v[52:55], v[32:35], v[132:135]
ds_read_b64_tr_b16 v[100:101], v17 offset:18432
v_mfma_f32_16x16x32_bf16 v[136:139], v[56:59], v[32:35], v[136:139]
ds_read_b64_tr_b16 v[102:103], v17 offset:21504
v_mfma_f32_16x16x32_bf16 v[160:163], v[56:59], v[36:39], v[160:163]
ds_read_b64_tr_b16 v[104:105], v18 offset:18432
v_mfma_f32_16x16x32_bf16 v[184:187], v[56:59], v[40:43], v[184:187]
ds_read_b64_tr_b16 v[106:107], v18 offset:21504
v_mfma_f32_16x16x32_bf16 v[208:211], v[56:59], v[44:47], v[208:211]
ds_read_b64_tr_b16 v[108:109], v19 offset:18432
v_mfma_f32_16x16x32_bf16 v[212:215], v[60:63], v[44:47], v[212:215]
ds_read_b64_tr_b16 v[110:111], v19 offset:21504
v_mfma_f32_16x16x32_bf16 v[188:191], v[60:63], v[40:43], v[188:191]
ds_read_b128 v[76:79], v10 offset:9216
v_mfma_f32_16x16x32_bf16 v[164:167], v[60:63], v[36:39], v[164:167]
ds_read_b128 v[80:83], v10 offset:10240
v_mfma_f32_16x16x32_bf16 v[140:143], v[60:63], v[32:35], v[140:143]
ds_read_b128 v[84:87], v10 offset:11264
v_mfma_f32_16x16x32_bf16 v[144:147], v[64:67], v[32:35], v[144:147]
v_mfma_f32_16x16x32_bf16 v[168:171], v[64:67], v[36:39], v[168:171]
v_mfma_f32_16x16x32_bf16 v[192:195], v[64:67], v[40:43], v[192:195]
v_mfma_f32_16x16x32_bf16 v[216:219], v[64:67], v[44:47], v[216:219]
v_mfma_f32_16x16x32_bf16 v[220:223], v[68:71], v[44:47], v[220:223]
v_mfma_f32_16x16x32_bf16 v[196:199], v[68:71], v[40:43], v[196:199]
v_mfma_f32_16x16x32_bf16 v[172:175], v[68:71], v[36:39], v[172:175]
v_mfma_f32_16x16x32_bf16 v[148:151], v[68:71], v[32:35], v[148:151]
s_waitcnt lgkmcnt(0)
s_barrier
v_mfma_f32_16x16x32_bf16 v[128:131], v[88:91], v[72:75], v[128:131]
ds_read_b128 v[32:35], v9 offset:0
v_mfma_f32_16x16x32_bf16 v[152:155], v[88:91], v[76:79], v[152:155]
ds_read_b64_tr_b16 v[48:49], v11 offset:0
v_mfma_f32_16x16x32_bf16 v[176:179], v[88:91], v[80:83], v[176:179]
ds_read_b64_tr_b16 v[50:51], v11 offset:3072
v_mfma_f32_16x16x32_bf16 v[200:203], v[88:91], v[84:87], v[200:203]
ds_read_b64_tr_b16 v[52:53], v12 offset:0
v_mfma_f32_16x16x32_bf16 v[204:207], v[92:95], v[84:87], v[204:207]
ds_read_b64_tr_b16 v[54:55], v12 offset:3072
v_mfma_f32_16x16x32_bf16 v[180:183], v[92:95], v[80:83], v[180:183]
ds_read_b64_tr_b16 v[56:57], v13 offset:0
v_mfma_f32_16x16x32_bf16 v[156:159], v[92:95], v[76:79], v[156:159]
ds_read_b64_tr_b16 v[58:59], v13 offset:3072
v_mfma_f32_16x16x32_bf16 v[132:135], v[92:95], v[72:75], v[132:135]
ds_read_b64_tr_b16 v[60:61], v11 offset:12288
v_mfma_f32_16x16x32_bf16 v[136:139], v[96:99], v[72:75], v[136:139]
ds_read_b64_tr_b16 v[62:63], v11 offset:15360
v_mfma_f32_16x16x32_bf16 v[160:163], v[96:99], v[76:79], v[160:163]
ds_read_b64_tr_b16 v[64:65], v12 offset:12288
v_mfma_f32_16x16x32_bf16 v[184:187], v[96:99], v[80:83], v[184:187]
ds_read_b64_tr_b16 v[66:67], v12 offset:15360
v_mfma_f32_16x16x32_bf16 v[208:211], v[96:99], v[84:87], v[208:211]
ds_read_b64_tr_b16 v[68:69], v13 offset:12288
v_mfma_f32_16x16x32_bf16 v[212:215], v[100:103], v[84:87], v[212:215]
ds_read_b64_tr_b16 v[70:71], v13 offset:15360
v_mfma_f32_16x16x32_bf16 v[188:191], v[100:103], v[80:83], v[188:191]
ds_read_b128 v[36:39], v9 offset:1024
v_mfma_f32_16x16x32_bf16 v[164:167], v[100:103], v[76:79], v[164:167]
ds_read_b128 v[40:43], v9 offset:2048
v_mfma_f32_16x16x32_bf16 v[140:143], v[100:103], v[72:75], v[140:143]
ds_read_b128 v[44:47], v9 offset:3072
v_mfma_f32_16x16x32_bf16 v[144:147], v[104:107], v[72:75], v[144:147]
v_mfma_f32_16x16x32_bf16 v[168:171], v[104:107], v[76:79], v[168:171]
v_mfma_f32_16x16x32_bf16 v[192:195], v[104:107], v[80:83], v[192:195]
v_mfma_f32_16x16x32_bf16 v[216:219], v[104:107], v[84:87], v[216:219]
v_mfma_f32_16x16x32_bf16 v[220:223], v[108:111], v[84:87], v[220:223]
v_mfma_f32_16x16x32_bf16 v[196:199], v[108:111], v[80:83], v[196:199]
v_mfma_f32_16x16x32_bf16 v[172:175], v[108:111], v[76:79], v[172:175]
v_mfma_f32_16x16x32_bf16 v[148:151], v[108:111], v[72:75], v[148:151]
s_waitcnt lgkmcnt(0)
v_mfma_f32_16x16x32_bf16 v[128:131], v[48:51], v[32:35], v[128:131]
ds_read_b128 v[72:75], v9 offset:8192
v_mfma_f32_16x16x32_bf16 v[152:155], v[48:51], v[36:39], v[152:155]
ds_read_b64_tr_b16 v[88:89], v11 offset:6144
v_mfma_f32_16x16x32_bf16 v[176:179], v[48:51], v[40:43], v[176:179]
ds_read_b64_tr_b16 v[90:91], v11 offset:9216
v_mfma_f32_16x16x32_bf16 v[200:203], v[48:51], v[44:47], v[200:203]
ds_read_b64_tr_b16 v[92:93], v12 offset:6144
v_mfma_f32_16x16x32_bf16 v[204:207], v[52:55], v[44:47], v[204:207]
ds_read_b64_tr_b16 v[94:95], v12 offset:9216
v_mfma_f32_16x16x32_bf16 v[180:183], v[52:55], v[40:43], v[180:183]
ds_read_b64_tr_b16 v[96:97], v13 offset:6144
v_mfma_f32_16x16x32_bf16 v[156:159], v[52:55], v[36:39], v[156:159]
ds_read_b64_tr_b16 v[98:99], v13 offset:9216
v_mfma_f32_16x16x32_bf16 v[132:135], v[52:55], v[32:35], v[132:135]
ds_read_b64_tr_b16 v[100:101], v11 offset:18432
v_mfma_f32_16x16x32_bf16 v[136:139], v[56:59], v[32:35], v[136:139]
ds_read_b64_tr_b16 v[102:103], v11 offset:21504
v_mfma_f32_16x16x32_bf16 v[160:163], v[56:59], v[36:39], v[160:163]
ds_read_b64_tr_b16 v[104:105], v12 offset:18432
v_mfma_f32_16x16x32_bf16 v[184:187], v[56:59], v[40:43], v[184:187]
ds_read_b64_tr_b16 v[106:107], v12 offset:21504
v_mfma_f32_16x16x32_bf16 v[208:211], v[56:59], v[44:47], v[208:211]
ds_read_b64_tr_b16 v[108:109], v13 offset:18432
v_mfma_f32_16x16x32_bf16 v[212:215], v[60:63], v[44:47], v[212:215]
ds_read_b64_tr_b16 v[110:111], v13 offset:21504
v_mfma_f32_16x16x32_bf16 v[188:191], v[60:63], v[40:43], v[188:191]
ds_read_b128 v[76:79], v9 offset:9216
v_mfma_f32_16x16x32_bf16 v[164:167], v[60:63], v[36:39], v[164:167]
ds_read_b128 v[80:83], v9 offset:10240
v_mfma_f32_16x16x32_bf16 v[140:143], v[60:63], v[32:35], v[140:143]
ds_read_b128 v[84:87], v9 offset:11264
v_mfma_f32_16x16x32_bf16 v[144:147], v[64:67], v[32:35], v[144:147]
v_mfma_f32_16x16x32_bf16 v[168:171], v[64:67], v[36:39], v[168:171]
v_mfma_f32_16x16x32_bf16 v[192:195], v[64:67], v[40:43], v[192:195]
v_mfma_f32_16x16x32_bf16 v[216:219], v[64:67], v[44:47], v[216:219]
v_mfma_f32_16x16x32_bf16 v[220:223], v[68:71], v[44:47], v[220:223]
v_mfma_f32_16x16x32_bf16 v[196:199], v[68:71], v[40:43], v[196:199]
v_mfma_f32_16x16x32_bf16 v[172:175], v[68:71], v[36:39], v[172:175]
v_mfma_f32_16x16x32_bf16 v[148:151], v[68:71], v[32:35], v[148:151]
s_waitcnt lgkmcnt(0)
s_barrier
v_mfma_f32_16x16x32_bf16 v[128:131], v[88:91], v[72:75], v[128:131]
ds_read_b128 v[32:35], v9 offset:49152
v_mfma_f32_16x16x32_bf16 v[152:155], v[88:91], v[76:79], v[152:155]
ds_read_b64_tr_b16 v[48:49], v14 offset:0
v_mfma_f32_16x16x32_bf16 v[176:179], v[88:91], v[80:83], v[176:179]
ds_read_b64_tr_b16 v[50:51], v14 offset:3072
v_mfma_f32_16x16x32_bf16 v[200:203], v[88:91], v[84:87], v[200:203]
ds_read_b64_tr_b16 v[52:53], v15 offset:0
v_mfma_f32_16x16x32_bf16 v[204:207], v[92:95], v[84:87], v[204:207]
ds_read_b64_tr_b16 v[54:55], v15 offset:3072
v_mfma_f32_16x16x32_bf16 v[180:183], v[92:95], v[80:83], v[180:183]
ds_read_b64_tr_b16 v[56:57], v16 offset:0
v_mfma_f32_16x16x32_bf16 v[156:159], v[92:95], v[76:79], v[156:159]
ds_read_b64_tr_b16 v[58:59], v16 offset:3072
v_mfma_f32_16x16x32_bf16 v[132:135], v[92:95], v[72:75], v[132:135]
ds_read_b64_tr_b16 v[60:61], v14 offset:12288
v_mfma_f32_16x16x32_bf16 v[136:139], v[96:99], v[72:75], v[136:139]
ds_read_b64_tr_b16 v[62:63], v14 offset:15360
v_mfma_f32_16x16x32_bf16 v[160:163], v[96:99], v[76:79], v[160:163]
ds_read_b64_tr_b16 v[64:65], v15 offset:12288
v_mfma_f32_16x16x32_bf16 v[184:187], v[96:99], v[80:83], v[184:187]
ds_read_b64_tr_b16 v[66:67], v15 offset:15360
v_mfma_f32_16x16x32_bf16 v[208:211], v[96:99], v[84:87], v[208:211]
ds_read_b64_tr_b16 v[68:69], v16 offset:12288
v_mfma_f32_16x16x32_bf16 v[212:215], v[100:103], v[84:87], v[212:215]
ds_read_b64_tr_b16 v[70:71], v16 offset:15360
v_mfma_f32_16x16x32_bf16 v[188:191], v[100:103], v[80:83], v[188:191]
ds_read_b128 v[36:39], v9 offset:50176
v_mfma_f32_16x16x32_bf16 v[164:167], v[100:103], v[76:79], v[164:167]
ds_read_b128 v[40:43], v9 offset:51200
v_mfma_f32_16x16x32_bf16 v[140:143], v[100:103], v[72:75], v[140:143]
ds_read_b128 v[44:47], v9 offset:52224
s_branch Lov_8
.p2align 12
.fill 64, 4, 0xbf800000
Lst_8_0:
s_branch Lwr_168
Lst_8_1:
s_branch Lwr_179
s_nop 0
Lov_8:
v_mfma_f32_16x16x32_bf16 v[144:147], v[104:107], v[72:75], v[144:147]
v_mfma_f32_16x16x32_bf16 v[168:171], v[104:107], v[76:79], v[168:171]
v_mfma_f32_16x16x32_bf16 v[192:195], v[104:107], v[80:83], v[192:195]
v_mfma_f32_16x16x32_bf16 v[216:219], v[104:107], v[84:87], v[216:219]
v_mfma_f32_16x16x32_bf16 v[220:223], v[108:111], v[84:87], v[220:223]
v_mfma_f32_16x16x32_bf16 v[196:199], v[108:111], v[80:83], v[196:199]
v_mfma_f32_16x16x32_bf16 v[172:175], v[108:111], v[76:79], v[172:175]
v_mfma_f32_16x16x32_bf16 v[148:151], v[108:111], v[72:75], v[148:151]
s_sub_u32 s41, s41, 1
s_cmp_lg_u32 s41, 0
s_cbranch_scc1 Lk3l_123
s_waitcnt lgkmcnt(0)
s_add_u32 s38, s35, 15
s_and_b32 s38, s38, 15
s_mul_i32 s38, s38, 458752
s_add_u32 m0, s40, 0
s_nop 0
buffer_load_dwordx4 v4, s[12:15], s38 offen lds
v_lshrrev_b32 v86, 4, v1
s_lshl_b32 s43, s63, 7
s_add_u32 s43, s43, 148992
v_lshl_add_u32 v87, v86, 4, s43
v_lshrrev_b32 v88, 1, v86
v_and_b32 v86, 1, v86
s_add_u32 m0, s40, 1024
s_nop 0
buffer_load_dwordx4 v5, s[12:15], s38 offen lds
s_lshl_b32 s43, s63, 5
s_add_u32 s43, s43, 149248
v_lshl_add_u32 v88, v88, 6, s43
v_lshl_add_u32 v88, v86, 4, v88
v_and_b32 v86, 15, v1
s_lshl_b32 s43, s62, 9
s_add_u32 m0, s40, 2048
s_add_u32 s38, s38, 57344
buffer_load_dwordx4 v4, s[12:15], s38 offen lds
s_add_u32 s43, s43, 147456
v_lshl_add_u32 v86, v86, 3, s43
ds_read_b128 v[32:35], v87 offset:0
ds_read_b128 v[36:39], v87 offset:64
ds_read_b128 v[40:43], v88 offset:0
ds_read_b128 v[44:47], v87 offset:896
s_add_u32 m0, s40, 3072
s_nop 0
buffer_load_dwordx4 v5, s[12:15], s38 offen lds
ds_read_b128 v[48:51], v87 offset:960
ds_read_b128 v[52:55], v88 offset:896
ds_read_b64 v[56:57], v86 offset:0
ds_read_b64 v[58:59], v86 offset:128
ds_read_b64 v[60:61], v86 offset:256
ds_read_b64 v[62:63], v86 offset:384
s_add_u32 m0, s40, 4096
s_add_u32 s38, s38, 57344
buffer_load_dwordx4 v4, s[12:15], s38 offen lds
s_mul_i32 s54, s35, 24576
s_lshl_b32 s43, s62, 12
s_add_u32 s54, s54, s43
s_add_u32 s54, s54, 524288
s_lshl_b32 s43, s63, 9
s_add_u32 s55, s54, s43
s_add_u32 m0, s40, 5120
s_nop 0
buffer_load_dwordx4 v5, s[12:15], s38 offen lds
s_add_u32 s55, s55, 16384
s_lshl_b32 s43, s63, 13
s_add_u32 s54, s54, s43
v_and_b32 v84, 32, v1
v_lshlrev_b32 v84, 4, v84
v_add_u32 v84, v84, v2
s_waitcnt lgkmcnt(0)
s_add_u32 m0, s40, 6144
s_add_u32 s38, s38, 57344
buffer_load_dwordx4 v4, s[12:15], s38 offen lds
s_add_u32 m0, s40, 7168
s_nop 0
buffer_load_dwordx4 v5, s[12:15], s38 offen lds
s_and_b32 s44, s36, 3
s_mul_i32 s43, s2, 28672
s_mul_i32 s44, s44, 7168
s_add_u32 s43, s43, s44
s_add_u32 s4, s76, s43
s_addc_u32 s5, s77, 0
s_barrier
s_cmp_eq_u32 s47, 3
s_cbranch_scc0 Lw_124
v_and_b32 v90, 31, v1
v_lshlrev_b32 v90, 4, v90
v_add_u32 v91, 153600, v90
ds_read_b128 v[108:111], v91 offset:0
ds_read_b128 v[112:115], v91 offset:512
ds_read_b128 v[116:119], v91 offset:1024
ds_read_b128 v[120:123], v91 offset:1536
s_and_b32 s44, s2, 15
s_mul_i32 s44, s44, 14336
s_lshr_b32 s43, s2, 4
s_lshl_b32 s43, s43, 9
s_add_u32 s44, s44, s43
s_waitcnt lgkmcnt(0)
v_add_f32 v108, v108, v112
v_add_f32 v116, v116, v120
v_add_f32 v109, v109, v113
v_add_f32 v117, v117, v121
v_add_f32 v110, v110, v114
v_add_f32 v118, v118, v122
v_add_f32 v111, v111, v115
v_add_f32 v119, v119, v123
v_add_f32 v108, v108, v116
v_add_f32 v109, v109, v117
v_add_f32 v110, v110, v118
v_add_f32 v111, v111, v119
s_mov_b64 exec, 0xffffffff
buffer_store_dwordx4 v[108:111], v90, s[84:87], s44 offen sc1
s_mov_b64 exec, -1
Lw_124:
s_waitcnt lgkmcnt(0)
s_add_u32 s37, s35, 0
s_and_b32 s37, s37, 15
s_mul_i32 s37, s37, 16384
s_add_u32 m0, s39, 49152
s_nop 0
buffer_load_dwordx4 v3, s[8:11], s37 offen sc1 lds
s_load_dword s3, s[4:5], 1792
s_load_dword s3, s[4:5], 1856
s_load_dword s3, s[4:5], 1920
s_load_dword s3, s[4:5], 1984
s_load_dword s3, s[4:5], 2048
s_load_dword s3, s[4:5], 2112
s_load_dword s3, s[4:5], 2176
buffer_load_dwordx4 v3, s[8:11], s37 offen offset:1024 sc1 lds
s_load_dword s3, s[4:5], 2240
s_load_dword s3, s[4:5], 2304
s_load_dword s3, s[4:5], 2368
s_load_dword s3, s[4:5], 2432
s_load_dword s3, s[4:5], 2496
s_load_dword s3, s[4:5], 2560
s_load_dword s3, s[4:5], 2624
buffer_load_dwordx4 v3, s[8:11], s37 offen offset:2048 sc1 lds
v_mul_f32 v66, v57, v57
v_mul_f32 v64, 0xc0135761, v57
v_mul_f32 v65, 0xbdd2d3e8, v57
v_mul_f32 v65, v65, v66
v_rcp_f32 v66, v66
v_mul_f32 v70, v59, v59
v_mul_f32 v68, 0xc0135761, v59
buffer_load_dwordx4 v3, s[8:11], s37 offen offset:3072 sc1 lds
v_mul_f32 v69, 0xbdd2d3e8, v59
v_mul_f32 v69, v69, v70
v_rcp_f32 v70, v70
v_fma_f32 v128, -v56, v32, v128
v_fma_f32 v129, -v56, v33, v129
v_fma_f32 v130, -v56, v34, v130
v_fma_f32 v131, -v56, v35, v131
v_fma_f32 v152, -v58, v32, v152
s_add_u32 s38, s35, 0
s_and_b32 s38, s38, 15
s_mul_i32 s38, s38, 458752
s_add_u32 m0, s40, 49152
s_nop 0
buffer_load_dwordx4 v4, s[12:15], s38 offen lds
v_fma_f32 v153, -v58, v33, v153
v_fma_f32 v154, -v58, v34, v154
v_fma_f32 v155, -v58, v35, v155
v_mul_f32 v72, v128, v128
v_mul_f32 v73, v129, v129
v_mul_f32 v74, v130, v130
v_mul_f32 v75, v131, v131
s_add_u32 m0, s40, 50176
s_nop 0
buffer_load_dwordx4 v5, s[12:15], s38 offen lds
v_mul_f32 v76, v152, v152
v_mul_f32 v77, v153, v153
v_mul_f32 v78, v154, v154
v_mul_f32 v79, v155, v155
v_fma_f32 v72, v72, v65, v64
v_fma_f32 v73, v73, v65, v64
v_fma_f32 v74, v74, v65, v64
s_add_u32 m0, s40, 51200
s_add_u32 s38, s38, 57344
buffer_load_dwordx4 v4, s[12:15], s38 offen lds
v_fma_f32 v75, v75, v65, v64
v_fma_f32 v76, v76, v69, v68
v_fma_f32 v77, v77, v69, v68
v_fma_f32 v78, v78, v69, v68
v_fma_f32 v79, v79, v69, v68
v_mul_f32 v72, v72, v128
v_mul_f32 v73, v73, v129
v_mul_f32 v74, v74, v130
s_add_u32 m0, s40, 52224
s_nop 0
buffer_load_dwordx4 v5, s[12:15], s38 offen lds
v_mul_f32 v75, v75, v131
v_mul_f32 v76, v76, v152
v_mul_f32 v77, v77, v153
v_mul_f32 v78, v78, v154
v_mul_f32 v79, v79, v155
v_exp_f32 v72, v72
v_exp_f32 v73, v73
s_add_u32 m0, s40, 53248
s_add_u32 s38, s38, 57344
buffer_load_dwordx4 v4, s[12:15], s38 offen lds
v_exp_f32 v74, v74
v_exp_f32 v75, v75
v_exp_f32 v76, v76
v_exp_f32 v77, v77
v_exp_f32 v78, v78
v_exp_f32 v79, v79
v_fma_f32 v140, -v56, v44, v140
s_add_u32 m0, s40, 54272
s_nop 0
buffer_load_dwordx4 v5, s[12:15], s38 offen lds
v_fma_f32 v141, -v56, v45, v141
v_fma_f32 v142, -v56, v46, v142
v_fma_f32 v143, -v56, v47, v143
v_fma_f32 v164, -v58, v44, v164
v_fma_f32 v165, -v58, v45, v165
v_fma_f32 v166, -v58, v46, v166
v_fma_f32 v167, -v58, v47, v167
v_fma_f32 v72, v72, v66, v66
s_add_u32 m0, s40, 55296
s_add_u32 s38, s38, 57344
buffer_load_dwordx4 v4, s[12:15], s38 offen lds
s_add_u32 m0, s40, 56320
s_nop 0
buffer_load_dwordx4 v5, s[12:15], s38 offen lds
s_waitcnt vmcnt(12)
s_barrier
s_add_u32 s37, s35, 1
s_and_b32 s37, s37, 15
s_mul_i32 s37, s37, 16384
s_add_u32 m0, s39, 98304
s_nop 0
buffer_load_dwordx4 v3, s[8:11], s37 offen sc1 lds
v_fma_f32 v73, v73, v66, v66
v_fma_f32 v74, v74, v66, v66
v_fma_f32 v75, v75, v66, v66
v_fma_f32 v76, v76, v70, v70
v_fma_f32 v77, v77, v70, v70
v_fma_f32 v78, v78, v70, v70
buffer_load_dwordx4 v3, s[8:11], s37 offen offset:1024 sc1 lds
v_fma_f32 v79, v79, v70, v70
v_rcp_f32 v72, v72
v_rcp_f32 v73, v73
v_rcp_f32 v74, v74
v_rcp_f32 v75, v75
v_rcp_f32 v76, v76
buffer_load_dwordx4 v3, s[8:11], s37 offen offset:2048 sc1 lds
v_rcp_f32 v77, v77
v_rcp_f32 v78, v78
v_rcp_f32 v79, v79
v_mul_f32 v140, v128, v140
v_mul_f32 v141, v129, v141
v_mul_f32 v142, v130, v142
buffer_load_dwordx4 v3, s[8:11], s37 offen offset:3072 sc1 lds
v_mul_f32 v143, v131, v143
v_mul_f32 v164, v152, v164
v_mul_f32 v165, v153, v165
v_mul_f32 v166, v154, v166
v_mul_f32 v167, v155, v167
v_mul_f32 v140, v140, v72
s_add_u32 s38, s35, 1
s_and_b32 s38, s38, 15
s_mul_i32 s38, s38, 458752
s_add_u32 m0, s40, 98304
s_nop 0
buffer_load_dwordx4 v4, s[12:15], s38 offen lds
v_mul_f32 v141, v141, v73
v_mul_f32 v142, v142, v74
v_mul_f32 v143, v143, v75
v_mul_f32 v164, v164, v76
v_mul_f32 v165, v165, v77
v_mul_f32 v166, v166, v78
s_add_u32 m0, s40, 99328
s_nop 0
buffer_load_dwordx4 v5, s[12:15], s38 offen lds
v_mul_f32 v167, v167, v79
v_cvt_pk_bf16_f32 v128, v140, v141
v_cvt_pk_bf16_f32 v129, v142, v143
v_cvt_pk_bf16_f32 v152, v164, v165
v_cvt_pk_bf16_f32 v153, v166, v167
v_fma_f32 v132, -v56, v36, v132
s_add_u32 m0, s40, 100352
s_add_u32 s38, s38, 57344
buffer_load_dwordx4 v4, s[12:15], s38 offen lds
v_fma_f32 v133, -v56, v37, v133
v_fma_f32 v134, -v56, v38, v134
v_fma_f32 v135, -v56, v39, v135
v_fma_f32 v156, -v58, v36, v156
v_fma_f32 v157, -v58, v37, v157
v_fma_f32 v158, -v58, v38, v158
s_add_u32 m0, s40, 101376
s_nop 0
buffer_load_dwordx4 v5, s[12:15], s38 offen lds
v_fma_f32 v159, -v58, v39, v159
v_mul_f32 v72, v132, v132
v_mul_f32 v73, v133, v133
v_mul_f32 v74, v134, v134
v_mul_f32 v75, v135, v135
v_mul_f32 v76, v156, v156
s_add_u32 m0, s40, 102400
s_add_u32 s38, s38, 57344
buffer_load_dwordx4 v4, s[12:15], s38 offen lds
v_mul_f32 v77, v157, v157
v_mul_f32 v78, v158, v158
v_mul_f32 v79, v159, v159
v_fma_f32 v72, v72, v65, v64
v_fma_f32 v73, v73, v65, v64
v_fma_f32 v74, v74, v65, v64
s_add_u32 m0, s40, 103424
s_nop 0
buffer_load_dwordx4 v5, s[12:15], s38 offen lds
v_fma_f32 v75, v75, v65, v64
v_fma_f32 v76, v76, v69, v68
v_fma_f32 v77, v77, v69, v68
v_fma_f32 v78, v78, v69, v68
v_fma_f32 v79, v79, v69, v68
v_mul_f32 v72, v72, v132
s_add_u32 m0, s40, 104448
s_add_u32 s38, s38, 57344
buffer_load_dwordx4 v4, s[12:15], s38 offen lds
s_add_u32 m0, s40, 105472
s_nop 0
buffer_load_dwordx4 v5, s[12:15], s38 offen lds
s_waitcnt vmcnt(12)
s_barrier
s_cmp_eq_u32 s47, 3
s_cbranch_scc0 Lw_125
s_lshr_b32 s43, s2, 4
s_add_u32 s43, s43, 80
s_lshl_b32 s43, s43, 7
v_mov_b32 v90, s43
v_mov_b32 v91, 1
s_mov_b64 exec, 1
buffer_atomic_add v91, v90, s[56:59], 0 offen sc1
s_mov_b64 exec, -1
Lw_125:
s_waitcnt lgkmcnt(0)
s_add_u32 s37, s35, 2
s_and_b32 s37, s37, 15
s_mul_i32 s37, s37, 16384
s_add_u32 m0, s39, 0
s_nop 0
buffer_load_dwordx4 v3, s[8:11], s37 offen sc1 lds
s_load_dword s3, s[4:5], 2688
s_load_dword s3, s[4:5], 2752
s_load_dword s3, s[4:5], 2816
s_load_dword s3, s[4:5], 2880
s_load_dword s3, s[4:5], 2944
s_load_dword s3, s[4:5], 3008
s_load_dword s3, s[4:5], 3072
buffer_load_dwordx4 v3, s[8:11], s37 offen offset:1024 sc1 lds
s_load_dword s3, s[4:5], 3136
s_load_dword s3, s[4:5], 3200
s_load_dword s3, s[4:5], 3264
s_load_dword s3, s[4:5], 3328
s_load_dword s3, s[4:5], 3392
s_load_dword s3, s[4:5], 3456
s_load_dword s3, s[4:5], 3520
buffer_load_dwordx4 v3, s[8:11], s37 offen offset:2048 sc1 lds
v_mul_f32 v73, v73, v133
v_mul_f32 v74, v74, v134
v_mul_f32 v75, v75, v135
v_mul_f32 v76, v76, v156
v_mul_f32 v77, v77, v157
v_mul_f32 v78, v78, v158
v_mul_f32 v79, v79, v159
v_exp_f32 v72, v72
buffer_load_dwordx4 v3, s[8:11], s37 offen offset:3072 sc1 lds
v_exp_f32 v73, v73
v_exp_f32 v74, v74
v_exp_f32 v75, v75
v_exp_f32 v76, v76
v_exp_f32 v77, v77
v_exp_f32 v78, v78
v_exp_f32 v79, v79
s_add_u32 s38, s35, 2
s_and_b32 s38, s38, 15
s_mul_i32 s38, s38, 458752
s_add_u32 m0, s40, 0
s_nop 0
buffer_load_dwordx4 v4, s[12:15], s38 offen lds
v_fma_f32 v144, -v56, v48, v144
v_fma_f32 v145, -v56, v49, v145
v_fma_f32 v146, -v56, v50, v146
v_fma_f32 v147, -v56, v51, v147
v_fma_f32 v168, -v58, v48, v168
v_fma_f32 v169, -v58, v49, v169
v_fma_f32 v170, -v58, v50, v170
v_fma_f32 v171, -v58, v51, v171
s_add_u32 m0, s40, 1024
s_nop 0
buffer_load_dwordx4 v5, s[12:15], s38 offen lds
v_fma_f32 v72, v72, v66, v66
v_fma_f32 v73, v73, v66, v66
v_fma_f32 v74, v74, v66, v66
v_fma_f32 v75, v75, v66, v66
v_fma_f32 v76, v76, v70, v70
v_fma_f32 v77, v77, v70, v70
v_fma_f32 v78, v78, v70, v70
s_add_u32 m0, s40, 2048
s_add_u32 s38, s38, 57344
buffer_load_dwordx4 v4, s[12:15], s38 offen lds
v_fma_f32 v79, v79, v70, v70
v_rcp_f32 v72, v72
v_rcp_f32 v73, v73
v_rcp_f32 v74, v74
v_rcp_f32 v75, v75
v_rcp_f32 v76, v76
v_rcp_f32 v77, v77
s_add_u32 m0, s40, 3072
s_nop 0
buffer_load_dwordx4 v5, s[12:15], s38 offen lds
v_rcp_f32 v78, v78
v_rcp_f32 v79, v79
v_mul_f32 v144, v132, v144
v_mul_f32 v145, v133, v145
v_mul_f32 v146, v134, v146
v_mul_f32 v147, v135, v147
v_mul_f32 v168, v156, v168
v_mul_f32 v169, v157, v169
s_add_u32 m0, s40, 4096
s_add_u32 s38, s38, 57344
buffer_load_dwordx4 v4, s[12:15], s38 offen lds
v_mul_f32 v170, v158, v170
v_mul_f32 v171, v159, v171
v_mul_f32 v144, v144, v72
v_mul_f32 v145, v145, v73
v_mul_f32 v146, v146, v74
v_mul_f32 v147, v147, v75
v_mul_f32 v168, v168, v76
s_add_u32 m0, s40, 5120
s_nop 0
buffer_load_dwordx4 v5, s[12:15], s38 offen lds
v_mul_f32 v169, v169, v77
v_mul_f32 v170, v170, v78
v_mul_f32 v171, v171, v79
v_cvt_pk_bf16_f32 v130, v144, v145
v_cvt_pk_bf16_f32 v131, v146, v147
v_cvt_pk_bf16_f32 v154, v168, v169
v_cvt_pk_bf16_f32 v155, v170, v171
buffer_store_dwordx4 v[128:131], v2, s[24:27], s54 offen offset:0 sc1
s_add_u32 m0, s40, 6144
s_add_u32 s38, s38, 57344
buffer_load_dwordx4 v4, s[12:15], s38 offen lds
s_add_u32 m0, s40, 7168
s_nop 0
buffer_load_dwordx4 v5, s[12:15], s38 offen lds
s_waitcnt vmcnt(13)
s_barrier
s_add_u32 s37, s35, 3
s_and_b32 s37, s37, 15
s_mul_i32 s37, s37, 16384
s_add_u32 m0, s39, 49152
s_nop 0
buffer_load_dwordx4 v3, s[8:11], s37 offen sc1 lds
buffer_store_dwordx4 v[152:155], v2, s[24:27], s54 offen offset:1024 sc1
v_fma_f32 v136, -v56, v40, v136
v_fma_f32 v137, -v56, v41, v137
v_fma_f32 v138, -v56, v42, v138
v_fma_f32 v139, -v56, v43, v139
v_fma_f32 v160, -v58, v40, v160
buffer_load_dwordx4 v3, s[8:11], s37 offen offset:1024 sc1 lds
v_fma_f32 v161, -v58, v41, v161
v_fma_f32 v162, -v58, v42, v162
v_fma_f32 v163, -v58, v43, v163
v_mul_f32 v72, v136, v136
v_mul_f32 v73, v137, v137
v_mul_f32 v74, v138, v138
buffer_load_dwordx4 v3, s[8:11], s37 offen offset:2048 sc1 lds
v_mul_f32 v75, v139, v139
v_mul_f32 v76, v160, v160
v_mul_f32 v77, v161, v161
v_mul_f32 v78, v162, v162
v_mul_f32 v79, v163, v163
v_fma_f32 v72, v72, v65, v64
buffer_load_dwordx4 v3, s[8:11], s37 offen offset:3072 sc1 lds
v_fma_f32 v73, v73, v65, v64
v_fma_f32 v74, v74, v65, v64
v_fma_f32 v75, v75, v65, v64
v_fma_f32 v76, v76, v69, v68
v_fma_f32 v77, v77, v69, v68
v_fma_f32 v78, v78, v69, v68
s_add_u32 s38, s35, 3
s_and_b32 s38, s38, 15
s_mul_i32 s38, s38, 458752
s_add_u32 m0, s40, 49152
s_nop 0
buffer_load_dwordx4 v4, s[12:15], s38 offen lds
v_fma_f32 v79, v79, v69, v68
v_mul_f32 v72, v72, v136
v_mul_f32 v73, v73, v137
v_mul_f32 v74, v74, v138
v_mul_f32 v75, v75, v139
v_mul_f32 v76, v76, v160
s_add_u32 m0, s40, 50176
s_nop 0
buffer_load_dwordx4 v5, s[12:15], s38 offen lds
v_mul_f32 v77, v77, v161
v_mul_f32 v78, v78, v162
v_mul_f32 v79, v79, v163
v_exp_f32 v72, v72
v_exp_f32 v73, v73
v_exp_f32 v74, v74
s_add_u32 m0, s40, 51200
s_add_u32 s38, s38, 57344
buffer_load_dwordx4 v4, s[12:15], s38 offen lds
v_exp_f32 v75, v75
v_exp_f32 v76, v76
v_exp_f32 v77, v77
v_exp_f32 v78, v78
v_exp_f32 v79, v79
v_fma_f32 v148, -v56, v52, v148
s_add_u32 m0, s40, 52224
s_nop 0
buffer_load_dwordx4 v5, s[12:15], s38 offen lds
v_fma_f32 v149, -v56, v53, v149
v_fma_f32 v150, -v56, v54, v150
v_fma_f32 v151, -v56, v55, v151
v_fma_f32 v172, -v58, v52, v172
v_fma_f32 v173, -v58, v53, v173
v_fma_f32 v174, -v58, v54, v174
s_add_u32 m0, s40, 53248
s_add_u32 s38, s38, 57344
buffer_load_dwordx4 v4, s[12:15], s38 offen lds
v_fma_f32 v175, -v58, v55, v175
v_fma_f32 v72, v72, v66, v66
v_fma_f32 v73, v73, v66, v66
v_fma_f32 v74, v74, v66, v66
v_fma_f32 v75, v75, v66, v66
v_fma_f32 v76, v76, v70, v70
s_add_u32 m0, s40, 54272
s_nop 0
buffer_load_dwordx4 v5, s[12:15], s38 offen lds
v_fma_f32 v77, v77, v70, v70
v_fma_f32 v78, v78, v70, v70
v_fma_f32 v79, v79, v70, v70
v_rcp_f32 v72, v72
v_rcp_f32 v73, v73
v_rcp_f32 v74, v74
s_add_u32 m0, s40, 55296
s_add_u32 s38, s38, 57344
buffer_load_dwordx4 v4, s[12:15], s38 offen lds
s_add_u32 m0, s40, 56320
s_nop 0
buffer_load_dwordx4 v5, s[12:15], s38 offen lds
s_waitcnt vmcnt(13)
s_barrier
s_waitcnt lgkmcnt(0)
s_add_u32 s37, s35, 4
s_and_b32 s37, s37, 15
s_mul_i32 s37, s37, 16384
s_add_u32 m0, s39, 98304
s_nop 0
buffer_load_dwordx4 v3, s[8:11], s37 offen sc1 lds
s_load_dword s3, s[4:5], 3584
s_load_dword s3, s[4:5], 3648
s_load_dword s3, s[4:5], 3712
s_load_dword s3, s[4:5], 3776
s_load_dword s3, s[4:5], 3840
s_load_dword s3, s[4:5], 3904
s_load_dword s3, s[4:5], 3968
buffer_load_dwordx4 v3, s[8:11], s37 offen offset:1024 sc1 lds
s_load_dword s3, s[4:5], 4032
s_load_dword s3, s[4:5], 4096
s_load_dword s3, s[4:5], 4160
s_load_dword s3, s[4:5], 4224
s_load_dword s3, s[4:5], 4288
s_load_dword s3, s[4:5], 4352
s_load_dword s3, s[4:5], 4416
buffer_load_dwordx4 v3, s[8:11], s37 offen offset:2048 sc1 lds
v_rcp_f32 v75, v75
v_rcp_f32 v76, v76
v_rcp_f32 v77, v77
v_rcp_f32 v78, v78
v_rcp_f32 v79, v79
v_mul_f32 v148, v136, v148
v_mul_f32 v149, v137, v149
buffer_load_dwordx4 v3, s[8:11], s37 offen offset:3072 sc1 lds
v_mul_f32 v150, v138, v150
v_mul_f32 v151, v139, v151
v_mul_f32 v172, v160, v172
v_mul_f32 v173, v161, v173
v_mul_f32 v174, v162, v174
v_mul_f32 v175, v163, v175
v_mul_f32 v148, v148, v72
v_mul_f32 v149, v149, v73
s_add_u32 s38, s35, 4
s_and_b32 s38, s38, 15
s_mul_i32 s38, s38, 458752
s_add_u32 m0, s40, 98304
s_nop 0
buffer_load_dwordx4 v4, s[12:15], s38 offen lds
v_mul_f32 v150, v150, v74
v_mul_f32 v151, v151, v75
v_mul_f32 v172, v172, v76
v_mul_f32 v173, v173, v77
v_mul_f32 v174, v174, v78
v_mul_f32 v175, v175, v79
v_cvt_pk_bf16_f32 v80, v148, v149
s_add_u32 m0, s40, 99328
s_nop 0
buffer_load_dwordx4 v5, s[12:15], s38 offen lds
v_cvt_pk_bf16_f32 v81, v150, v151
v_cvt_pk_bf16_f32 v82, v172, v173
v_cvt_pk_bf16_f32 v83, v174, v175
s_nop 1
v_permlane32_swap_b32 v80, v82
v_permlane32_swap_b32 v81, v83
buffer_store_dwordx4 v[80:83], v84, s[24:27], s55 offen offset:0 sc1
s_add_u32 m0, s40, 100352
s_add_u32 s38, s38, 57344
buffer_load_dwordx4 v4, s[12:15], s38 offen lds
s_nop 1
v_mul_f32 v66, v61, v61
v_mul_f32 v64, 0xc0135761, v61
v_mul_f32 v65, 0xbdd2d3e8, v61
v_mul_f32 v65, v65, v66
v_rcp_f32 v66, v66
v_mul_f32 v70, v63, v63
v_mul_f32 v68, 0xc0135761, v63
s_add_u32 m0, s40, 101376
s_nop 0
s_branch Lov_9
.p2align 12
.fill 64, 4, 0xbf800000
Lst_9_0:
s_branch Lwr_169
Lst_9_1:
s_branch Lwr_180
s_nop 0
Lov_9:
buffer_load_dwordx4 v5, s[12:15], s38 offen lds
v_mul_f32 v69, 0xbdd2d3e8, v63
v_mul_f32 v69, v69, v70
v_rcp_f32 v70, v70
v_fma_f32 v176, -v60, v32, v176
v_fma_f32 v177, -v60, v33, v177
v_fma_f32 v178, -v60, v34, v178
v_fma_f32 v179, -v60, v35, v179
s_add_u32 m0, s40, 102400
s_add_u32 s38, s38, 57344
buffer_load_dwordx4 v4, s[12:15], s38 offen lds
v_fma_f32 v200, -v62, v32, v200
v_fma_f32 v201, -v62, v33, v201
v_fma_f32 v202, -v62, v34, v202
v_fma_f32 v203, -v62, v35, v203
v_mul_f32 v72, v176, v176
v_mul_f32 v73, v177, v177
v_mul_f32 v74, v178, v178
s_add_u32 m0, s40, 103424
s_nop 0
buffer_load_dwordx4 v5, s[12:15], s38 offen lds
v_mul_f32 v75, v179, v179
v_mul_f32 v76, v200, v200
v_mul_f32 v77, v201, v201
v_mul_f32 v78, v202, v202
v_mul_f32 v79, v203, v203
v_fma_f32 v72, v72, v65, v64
v_fma_f32 v73, v73, v65, v64
v_fma_f32 v74, v74, v65, v64
s_add_u32 m0, s40, 104448
s_add_u32 s38, s38, 57344
buffer_load_dwordx4 v4, s[12:15], s38 offen lds
s_add_u32 m0, s40, 105472
s_nop 0
buffer_load_dwordx4 v5, s[12:15], s38 offen lds
s_waitcnt vmcnt(13)
s_barrier
s_add_u32 s37, s35, 5
s_and_b32 s37, s37, 15
s_mul_i32 s37, s37, 16384
s_add_u32 m0, s39, 0
s_nop 0
buffer_load_dwordx4 v3, s[8:11], s37 offen sc1 lds
v_fma_f32 v75, v75, v65, v64
v_fma_f32 v76, v76, v69, v68
v_fma_f32 v77, v77, v69, v68
v_fma_f32 v78, v78, v69, v68
v_fma_f32 v79, v79, v69, v68
v_mul_f32 v72, v72, v176
buffer_load_dwordx4 v3, s[8:11], s37 offen offset:1024 sc1 lds
v_mul_f32 v73, v73, v177
v_mul_f32 v74, v74, v178
v_mul_f32 v75, v75, v179
v_mul_f32 v76, v76, v200
v_mul_f32 v77, v77, v201
v_mul_f32 v78, v78, v202
buffer_load_dwordx4 v3, s[8:11], s37 offen offset:2048 sc1 lds
v_mul_f32 v79, v79, v203
v_exp_f32 v72, v72
v_exp_f32 v73, v73
v_exp_f32 v74, v74
v_exp_f32 v75, v75
v_exp_f32 v76, v76
buffer_load_dwordx4 v3, s[8:11], s37 offen offset:3072 sc1 lds
v_exp_f32 v77, v77
v_exp_f32 v78, v78
v_exp_f32 v79, v79
v_fma_f32 v188, -v60, v44, v188
v_fma_f32 v189, -v60, v45, v189
v_fma_f32 v190, -v60, v46, v190
s_add_u32 s38, s35, 5
s_and_b32 s38, s38, 15
s_mul_i32 s38, s38, 458752
s_add_u32 m0, s40, 0
s_nop 0
buffer_load_dwordx4 v4, s[12:15], s38 offen lds
v_fma_f32 v191, -v60, v47, v191
v_fma_f32 v212, -v62, v44, v212
v_fma_f32 v213, -v62, v45, v213
v_fma_f32 v214, -v62, v46, v214
v_fma_f32 v215, -v62, v47, v215
v_fma_f32 v72, v72, v66, v66
s_add_u32 m0, s40, 1024
s_nop 0
buffer_load_dwordx4 v5, s[12:15], s38 offen lds
v_fma_f32 v73, v73, v66, v66
v_fma_f32 v74, v74, v66, v66
v_fma_f32 v75, v75, v66, v66
v_fma_f32 v76, v76, v70, v70
v_fma_f32 v77, v77, v70, v70
v_fma_f32 v78, v78, v70, v70
s_add_u32 m0, s40, 2048
s_add_u32 s38, s38, 57344
buffer_load_dwordx4 v4, s[12:15], s38 offen lds
v_fma_f32 v79, v79, v70, v70
v_rcp_f32 v72, v72
v_rcp_f32 v73, v73
v_rcp_f32 v74, v74
v_rcp_f32 v75, v75
v_rcp_f32 v76, v76
s_add_u32 m0, s40, 3072
s_nop 0
buffer_load_dwordx4 v5, s[12:15], s38 offen lds
v_rcp_f32 v77, v77
v_rcp_f32 v78, v78
v_rcp_f32 v79, v79
v_mul_f32 v188, v176, v188
v_mul_f32 v189, v177, v189
v_mul_f32 v190, v178, v190
s_add_u32 m0, s40, 4096
s_add_u32 s38, s38, 57344
buffer_load_dwordx4 v4, s[12:15], s38 offen lds
v_mul_f32 v191, v179, v191
v_mul_f32 v212, v200, v212
v_mul_f32 v213, v201, v213
v_mul_f32 v214, v202, v214
v_mul_f32 v215, v203, v215
v_mul_f32 v188, v188, v72
s_add_u32 m0, s40, 5120
s_nop 0
buffer_load_dwordx4 v5, s[12:15], s38 offen lds
v_mul_f32 v189, v189, v73
v_mul_f32 v190, v190, v74
v_mul_f32 v191, v191, v75
v_mul_f32 v212, v212, v76
v_mul_f32 v213, v213, v77
v_mul_f32 v214, v214, v78
s_add_u32 m0, s40, 6144
s_add_u32 s38, s38, 57344
buffer_load_dwordx4 v4, s[12:15], s38 offen lds
s_add_u32 m0, s40, 7168
s_nop 0
buffer_load_dwordx4 v5, s[12:15], s38 offen lds
s_waitcnt vmcnt(12)
s_barrier
s_waitcnt lgkmcnt(0)
s_cmp_eq_u32 s47, 3
s_cbranch_scc0 Lw_126
s_lshl_b32 s60, s35, 7
s_add_u32 s60, s60, 28321792
s_mov_b32 s61, s60
s_load_dword s92, s[82:83], s60 glc
s_load_dword s93, s[82:83], s61 glc
Lw_126:
s_add_u32 s37, s35, 6
s_and_b32 s37, s37, 15
s_mul_i32 s37, s37, 16384
s_add_u32 m0, s39, 49152
s_nop 0
buffer_load_dwordx4 v3, s[8:11], s37 offen sc1 lds
s_load_dword s3, s[4:5], 4480
s_load_dword s3, s[4:5], 4544
s_load_dword s3, s[4:5], 4608
s_load_dword s3, s[4:5], 4672
s_load_dword s3, s[4:5], 4736
s_load_dword s3, s[4:5], 4800
s_load_dword s3, s[4:5], 4864
buffer_load_dwordx4 v3, s[8:11], s37 offen offset:1024 sc1 lds
s_load_dword s3, s[4:5], 4928
s_load_dword s3, s[4:5], 4992
s_load_dword s3, s[4:5], 5056
s_load_dword s3, s[4:5], 5120
s_load_dword s3, s[4:5], 5184
s_load_dword s3, s[4:5], 5248
s_load_dword s3, s[4:5], 5312
buffer_load_dwordx4 v3, s[8:11], s37 offen offset:2048 sc1 lds
v_mul_f32 v215, v215, v79
v_cvt_pk_bf16_f32 v176, v188, v189
v_cvt_pk_bf16_f32 v177, v190, v191
v_cvt_pk_bf16_f32 v200, v212, v213
v_cvt_pk_bf16_f32 v201, v214, v215
v_fma_f32 v180, -v60, v36, v180
v_fma_f32 v181, -v60, v37, v181
v_fma_f32 v182, -v60, v38, v182
buffer_load_dwordx4 v3, s[8:11], s37 offen offset:3072 sc1 lds
v_fma_f32 v183, -v60, v39, v183
v_fma_f32 v204, -v62, v36, v204
v_fma_f32 v205, -v62, v37, v205
v_fma_f32 v206, -v62, v38, v206
v_fma_f32 v207, -v62, v39, v207
v_mul_f32 v72, v180, v180
v_mul_f32 v73, v181, v181
s_add_u32 s38, s35, 6
s_and_b32 s38, s38, 15
s_mul_i32 s38, s38, 458752
s_add_u32 m0, s40, 49152
s_nop 0
buffer_load_dwordx4 v4, s[12:15], s38 offen lds
v_mul_f32 v74, v182, v182
v_mul_f32 v75, v183, v183
v_mul_f32 v76, v204, v204
v_mul_f32 v77, v205, v205
v_mul_f32 v78, v206, v206
v_mul_f32 v79, v207, v207
v_fma_f32 v72, v72, v65, v64
v_fma_f32 v73, v73, v65, v64
s_add_u32 m0, s40, 50176
s_nop 0
buffer_load_dwordx4 v5, s[12:15], s38 offen lds
v_fma_f32 v74, v74, v65, v64
v_fma_f32 v75, v75, v65, v64
v_fma_f32 v76, v76, v69, v68
v_fma_f32 v77, v77, v69, v68
v_fma_f32 v78, v78, v69, v68
v_fma_f32 v79, v79, v69, v68
v_mul_f32 v72, v72, v180
s_add_u32 m0, s40, 51200
s_add_u32 s38, s38, 57344
buffer_load_dwordx4 v4, s[12:15], s38 offen lds
v_mul_f32 v73, v73, v181
v_mul_f32 v74, v74, v182
v_mul_f32 v75, v75, v183
v_mul_f32 v76, v76, v204
v_mul_f32 v77, v77, v205
v_mul_f32 v78, v78, v206
v_mul_f32 v79, v79, v207
s_add_u32 m0, s40, 52224
s_nop 0
buffer_load_dwordx4 v5, s[12:15], s38 offen lds
v_exp_f32 v72, v72
v_exp_f32 v73, v73
v_exp_f32 v74, v74
v_exp_f32 v75, v75
v_exp_f32 v76, v76
v_exp_f32 v77, v77
v_exp_f32 v78, v78
v_exp_f32 v79, v79
s_add_u32 m0, s40, 53248
s_add_u32 s38, s38, 57344
buffer_load_dwordx4 v4, s[12:15], s38 offen lds
v_fma_f32 v192, -v60, v48, v192
v_fma_f32 v193, -v60, v49, v193
v_fma_f32 v194, -v60, v50, v194
v_fma_f32 v195, -v60, v51, v195
v_fma_f32 v216, -v62, v48, v216
v_fma_f32 v217, -v62, v49, v217
v_fma_f32 v218, -v62, v50, v218
s_add_u32 m0, s40, 54272
s_nop 0
buffer_load_dwordx4 v5, s[12:15], s38 offen lds
v_fma_f32 v219, -v62, v51, v219
v_fma_f32 v72, v72, v66, v66
v_fma_f32 v73, v73, v66, v66
v_fma_f32 v74, v74, v66, v66
v_fma_f32 v75, v75, v66, v66
v_fma_f32 v76, v76, v70, v70
v_fma_f32 v77, v77, v70, v70
v_fma_f32 v78, v78, v70, v70
s_add_u32 m0, s40, 55296
s_add_u32 s38, s38, 57344
buffer_load_dwordx4 v4, s[12:15], s38 offen lds
s_add_u32 m0, s40, 56320
s_nop 0
buffer_load_dwordx4 v5, s[12:15], s38 offen lds
s_waitcnt vmcnt(12)
s_barrier
s_add_u32 s37, s35, 7
s_and_b32 s37, s37, 15
s_mul_i32 s37, s37, 16384
s_add_u32 m0, s39, 98304
s_nop 0
buffer_load_dwordx4 v3, s[8:11], s37 offen sc1 lds
v_fma_f32 v79, v79, v70, v70
v_rcp_f32 v72, v72
v_rcp_f32 v73, v73
v_rcp_f32 v74, v74
v_rcp_f32 v75, v75
v_rcp_f32 v76, v76
buffer_load_dwordx4 v3, s[8:11], s37 offen offset:1024 sc1 lds
v_rcp_f32 v77, v77
v_rcp_f32 v78, v78
v_rcp_f32 v79, v79
v_mul_f32 v192, v180, v192
v_mul_f32 v193, v181, v193
v_mul_f32 v194, v182, v194
buffer_load_dwordx4 v3, s[8:11], s37 offen offset:2048 sc1 lds
v_mul_f32 v195, v183, v195
v_mul_f32 v216, v204, v216
v_mul_f32 v217, v205, v217
v_mul_f32 v218, v206, v218
v_mul_f32 v219, v207, v219
v_mul_f32 v192, v192, v72
buffer_load_dwordx4 v3, s[8:11], s37 offen offset:3072 sc1 lds
v_mul_f32 v193, v193, v73
v_mul_f32 v194, v194, v74
v_mul_f32 v195, v195, v75
v_mul_f32 v216, v216, v76
v_mul_f32 v217, v217, v77
v_mul_f32 v218, v218, v78
s_add_u32 s38, s35, 7
s_and_b32 s38, s38, 15
s_mul_i32 s38, s38, 458752
s_add_u32 m0, s40, 98304
s_nop 0
buffer_load_dwordx4 v4, s[12:15], s38 offen lds
v_mul_f32 v219, v219, v79
v_cvt_pk_bf16_f32 v178, v192, v193
v_cvt_pk_bf16_f32 v179, v194, v195
v_cvt_pk_bf16_f32 v202, v216, v217
v_cvt_pk_bf16_f32 v203, v218, v219
buffer_store_dwordx4 v[176:179], v2, s[24:27], s54 offen offset:2048 sc1
s_add_u32 m0, s40, 99328
s_nop 0
buffer_load_dwordx4 v5, s[12:15], s38 offen lds
buffer_store_dwordx4 v[200:203], v2, s[24:27], s54 offen offset:3072 sc1
v_fma_f32 v184, -v60, v40, v184
v_fma_f32 v185, -v60, v41, v185
v_fma_f32 v186, -v60, v42, v186
v_fma_f32 v187, -v60, v43, v187
v_fma_f32 v208, -v62, v40, v208
s_add_u32 m0, s40, 100352
s_add_u32 s38, s38, 57344
buffer_load_dwordx4 v4, s[12:15], s38 offen lds
v_fma_f32 v209, -v62, v41, v209
v_fma_f32 v210, -v62, v42, v210
v_fma_f32 v211, -v62, v43, v211
v_mul_f32 v72, v184, v184
v_mul_f32 v73, v185, v185
v_mul_f32 v74, v186, v186
s_add_u32 m0, s40, 101376
s_nop 0
buffer_load_dwordx4 v5, s[12:15], s38 offen lds
v_mul_f32 v75, v187, v187
v_mul_f32 v76, v208, v208
v_mul_f32 v77, v209, v209
v_mul_f32 v78, v210, v210
v_mul_f32 v79, v211, v211
v_fma_f32 v72, v72, v65, v64
s_add_u32 m0, s40, 102400
s_add_u32 s38, s38, 57344
buffer_load_dwordx4 v4, s[12:15], s38 offen lds
v_fma_f32 v73, v73, v65, v64
v_fma_f32 v74, v74, v65, v64
v_fma_f32 v75, v75, v65, v64
v_fma_f32 v76, v76, v69, v68
v_fma_f32 v77, v77, v69, v68
v_fma_f32 v78, v78, v69, v68
s_add_u32 m0, s40, 103424
s_nop 0
buffer_load_dwordx4 v5, s[12:15], s38 offen lds
v_fma_f32 v79, v79, v69, v68
v_mul_f32 v72, v72, v184
v_mul_f32 v73, v73, v185
v_mul_f32 v74, v74, v186
v_mul_f32 v75, v75, v187
v_mul_f32 v76, v76, v208
s_add_u32 m0, s40, 104448
s_add_u32 s38, s38, 57344
buffer_load_dwordx4 v4, s[12:15], s38 offen lds
s_add_u32 m0, s40, 105472
s_nop 0
buffer_load_dwordx4 v5, s[12:15], s38 offen lds
s_waitcnt vmcnt(14)
s_cmp_eq_u32 s47, 3
s_cbranch_scc0 Lw_127
s_mov_b32 s41, 0x40000
Lcp_128:
s_waitcnt lgkmcnt(0)
s_and_b32 s92, s92, s93
s_cmp_eq_u32 s92, 16
s_cbranch_scc1 Lco_129
s_load_dword s92, s[82:83], s60 glc
s_load_dword s93, s[82:83], s61 glc
s_sub_u32 s41, s41, 1
s_cmp_lg_u32 s41, 0
s_cbranch_scc1 Lcp_128
s_waitcnt lgkmcnt(0)
Lco_129:
Lw_127:
s_barrier
s_lshl_b32 s60, s35, 9
s_lshl_b32 s43, s47, 7
s_add_u32 s60, s60, s43
s_add_u32 s61, s60, 14336
s_add_u32 s52, s43, 148480
s_add_u32 s53, s52, 896
v_lshrrev_b32 v104, 3, v1
v_mul_u32_u24 v104, 28672, v104
v_and_b32 v105, 7, v1
v_lshl_add_u32 v104, v105, 4, v104
s_waitcnt lgkmcnt(0)
buffer_load_dwordx4 v[96:99], v104, s[84:87], s60 offen sc1
s_load_dword s3, s[4:5], 5376
s_load_dword s3, s[4:5], 5440
s_load_dword s3, s[4:5], 5504
s_load_dword s3, s[4:5], 5568
s_load_dword s3, s[4:5], 5632
s_load_dword s3, s[4:5], 5696
buffer_load_dwordx4 v[100:103], v104, s[84:87], s61 offen sc1
s_load_dword s3, s[4:5], 5760
s_load_dword s3, s[4:5], 5824
s_load_dword s3, s[4:5], 5888
s_load_dword s3, s[4:5], 5952
s_load_dword s3, s[4:5], 6016
s_load_dword s3, s[4:5], 6080
s_load_dword s3, s[4:5], 6144
s_add_u32 s37, s35, 8
s_and_b32 s37, s37, 15
s_mul_i32 s37, s37, 16384
s_add_u32 m0, s39, 0
s_nop 0
buffer_load_dwordx4 v3, s[8:11], s37 offen sc1 lds
s_load_dword s3, s[4:5], 6208
v_mul_f32 v77, v77, v209
v_mul_f32 v78, v78, v210
v_mul_f32 v79, v79, v211
v_exp_f32 v72, v72
v_exp_f32 v73, v73
v_exp_f32 v74, v74
buffer_load_dwordx4 v3, s[8:11], s37 offen offset:1024 sc1 lds
v_exp_f32 v75, v75
v_exp_f32 v76, v76
v_exp_f32 v77, v77
v_exp_f32 v78, v78
v_exp_f32 v79, v79
v_fma_f32 v196, -v60, v52, v196
v_fma_f32 v197, -v60, v53, v197
buffer_load_dwordx4 v3, s[8:11], s37 offen offset:2048 sc1 lds
v_fma_f32 v198, -v60, v54, v198
v_fma_f32 v199, -v60, v55, v199
v_fma_f32 v220, -v62, v52, v220
v_fma_f32 v221, -v62, v53, v221
v_fma_f32 v222, -v62, v54, v222
v_fma_f32 v223, -v62, v55, v223
buffer_load_dwordx4 v3, s[8:11], s37 offen offset:3072 sc1 lds
v_fma_f32 v72, v72, v66, v66
v_fma_f32 v73, v73, v66, v66
v_fma_f32 v74, v74, v66, v66
v_fma_f32 v75, v75, v66, v66
v_fma_f32 v76, v76, v70, v70
v_fma_f32 v77, v77, v70, v70
v_fma_f32 v78, v78, v70, v70
s_add_u32 s38, s35, 8
s_and_b32 s38, s38, 15
s_mul_i32 s38, s38, 458752
s_add_u32 m0, s40, 0
s_nop 0
buffer_load_dwordx4 v4, s[12:15], s38 offen lds
v_fma_f32 v79, v79, v70, v70
v_rcp_f32 v72, v72
v_rcp_f32 v73, v73
v_rcp_f32 v74, v74
v_rcp_f32 v75, v75
v_rcp_f32 v76, v76
v_rcp_f32 v77, v77
s_add_u32 m0, s40, 1024
s_nop 0
buffer_load_dwordx4 v5, s[12:15], s38 offen lds
v_rcp_f32 v78, v78
v_rcp_f32 v79, v79
v_mul_f32 v196, v184, v196
v_mul_f32 v197, v185, v197
v_mul_f32 v198, v186, v198
v_mul_f32 v199, v187, v199
v_mul_f32 v220, v208, v220
s_add_u32 m0, s40, 2048
s_add_u32 s38, s38, 57344
buffer_load_dwordx4 v4, s[12:15], s38 offen lds
v_mul_f32 v221, v209, v221
v_mul_f32 v222, v210, v222
v_mul_f32 v223, v211, v223
v_mul_f32 v196, v196, v72
v_mul_f32 v197, v197, v73
v_mul_f32 v198, v198, v74
s_add_u32 m0, s40, 3072
s_nop 0
buffer_load_dwordx4 v5, s[12:15], s38 offen lds
v_mul_f32 v199, v199, v75
v_mul_f32 v220, v220, v76
v_mul_f32 v221, v221, v77
v_mul_f32 v222, v222, v78
v_mul_f32 v223, v223, v79
v_cvt_pk_bf16_f32 v80, v196, v197
v_cvt_pk_bf16_f32 v81, v198, v199
s_add_u32 m0, s40, 4096
s_add_u32 s38, s38, 57344
buffer_load_dwordx4 v4, s[12:15], s38 offen lds
v_cvt_pk_bf16_f32 v82, v220, v221
v_cvt_pk_bf16_f32 v83, v222, v223
s_nop 1
v_permlane32_swap_b32 v80, v82
v_permlane32_swap_b32 v81, v83
buffer_store_dwordx4 v[80:83], v84, s[24:27], s55 offen offset:2048 sc1
s_nop 1
s_add_u32 m0, s40, 5120
s_nop 0
buffer_load_dwordx4 v5, s[12:15], s38 offen lds
v_cmp_gt_u32 vcc, 32, v1
v_mov_b32 v104, s52
v_mov_b32 v106, s53
v_cndmask_b32 v104, v106, v104, vcc
v_lshl_add_u32 v104, v105, 4, v104
v_bfe_u32 v105, v1, 4, 1
v_lshl_add_u32 v104, v105, 2, v104
s_add_u32 m0, s40, 6144
s_add_u32 s38, s38, 57344
buffer_load_dwordx4 v4, s[12:15], s38 offen lds
s_add_u32 m0, s40, 7168
s_nop 0
buffer_load_dwordx4 v5, s[12:15], s38 offen lds
s_waitcnt vmcnt(15)
s_barrier
s_add_u32 s37, s35, 9
s_and_b32 s37, s37, 15
s_mul_i32 s37, s37, 16384
s_add_u32 m0, s39, 49152
s_nop 0
buffer_load_dwordx4 v3, s[8:11], s37 offen sc1 lds
buffer_load_dwordx4 v3, s[8:11], s37 offen offset:1024 sc1 lds
buffer_load_dwordx4 v3, s[8:11], s37 offen offset:2048 sc1 lds
buffer_load_dwordx4 v3, s[8:11], s37 offen offset:3072 sc1 lds
s_add_u32 s38, s35, 9
s_and_b32 s38, s38, 15
s_mul_i32 s38, s38, 458752
s_add_u32 m0, s40, 49152
s_nop 0
buffer_load_dwordx4 v4, s[12:15], s38 offen lds
s_add_u32 m0, s40, 50176
s_nop 0
buffer_load_dwordx4 v5, s[12:15], s38 offen lds
s_add_u32 m0, s40, 51200
s_add_u32 s38, s38, 57344
buffer_load_dwordx4 v4, s[12:15], s38 offen lds
s_add_u32 m0, s40, 52224
s_nop 0
buffer_load_dwordx4 v5, s[12:15], s38 offen lds
s_add_u32 m0, s40, 53248
s_add_u32 s38, s38, 57344
buffer_load_dwordx4 v4, s[12:15], s38 offen lds
s_add_u32 m0, s40, 54272
s_nop 0
buffer_load_dwordx4 v5, s[12:15], s38 offen lds
s_add_u32 m0, s40, 55296
s_add_u32 s38, s38, 57344
buffer_load_dwordx4 v4, s[12:15], s38 offen lds
s_add_u32 m0, s40, 56320
s_nop 0
buffer_load_dwordx4 v5, s[12:15], s38 offen lds
s_waitcnt vmcnt(12)
s_barrier
s_cmp_eq_u32 s47, 0
s_cbranch_scc0 Lw_130
s_add_u32 s7, s34, 32
s_lshl_b32 s7, s7, 7
v_mov_b32 v90, s7
v_mov_b32 v91, 1
s_mov_b64 exec, 1
buffer_atomic_add v91, v90, s[56:59], 0 offen sc1
s_mov_b64 exec, -1
Lw_130:
v_permlane32_swap_b32 v96, v100
v_permlane32_swap_b32 v97, v101
v_permlane32_swap_b32 v98, v102
v_permlane32_swap_b32 v99, v103
v_add_f32 v96, v96, v100
v_add_f32 v97, v97, v101
v_add_f32 v98, v98, v102
v_add_f32 v99, v99, v103
s_nop 1
v_permlane16_swap_b32 v96, v97
v_permlane16_swap_b32 v98, v99
v_add_f32 v96, v96, v97
v_add_f32 v98, v98, v99
s_nop 1
v_add_f32_dpp v96, v96, v96 row_ror:8 row_mask:0xf bank_mask:0xf
v_add_f32_dpp v98, v98, v98 row_ror:8 row_mask:0xf bank_mask:0xf
ds_write_b32 v104, v96
ds_write_b32 v104, v98 offset:8
s_waitcnt lgkmcnt(0)
s_add_u32 s37, s35, 10
s_and_b32 s37, s37, 15
s_mul_i32 s37, s37, 16384
s_add_u32 m0, s39, 98304
s_nop 0
buffer_load_dwordx4 v3, s[8:11], s37 offen sc1 lds
s_load_dword s3, s[4:5], 6272
s_load_dword s3, s[4:5], 6336
s_load_dword s3, s[4:5], 6400
s_load_dword s3, s[4:5], 6464
s_load_dword s3, s[4:5], 6528
s_load_dword s3, s[4:5], 6592
buffer_load_dwordx4 v3, s[8:11], s37 offen offset:1024 sc1 lds
s_load_dword s3, s[4:5], 6656
s_load_dword s3, s[4:5], 6720
s_load_dword s3, s[4:5], 6784
s_load_dword s3, s[4:5], 6848
s_load_dword s3, s[4:5], 6912
s_load_dword s3, s[4:5], 6976
s_load_dword s3, s[4:5], 7040
buffer_load_dwordx4 v3, s[8:11], s37 offen offset:2048 sc1 lds
s_load_dword s3, s[4:5], 7104
s_bfe_u32 s61, s35, 0x10002
s_lshr_b32 s60, s35, 3
s_lshl_b32 s60, s60, 2
s_and_b32 s43, s35, 3
s_add_u32 s60, s60, s43
buffer_load_dwordx4 v3, s[8:11], s37 offen offset:3072 sc1 lds
s_lshl_b32 s43, s60, 8
s_add_u32 s28, s76, s43
s_addc_u32 s29, s77, 0
s_mov_b32 s30, 7338240
s_mov_b32 s31, 0x20000
s_mul_i32 s52, s61, 196608
s_mul_i32 s53, s61, 1572864
s_add_u32 s38, s35, 10
s_and_b32 s38, s38, 15
s_mul_i32 s38, s38, 458752
s_add_u32 m0, s40, 98304
s_nop 0
buffer_load_dwordx4 v4, s[12:15], s38 offen lds
s_mul_i32 s90, s61, 163840
s_mul_i32 s91, s61, 1310720
s_and_b32 s43, s35, 3
s_mul_i32 s32, s43, 3
s_mul_i32 s33, s43, 10
s_lshr_b32 s33, s33, 2
s_add_u32 m0, s40, 99328
s_nop 0
buffer_load_dwordx4 v5, s[12:15], s38 offen lds
s_lshl_b32 s51, s47, 11
s_lshl_b32 s44, s47, 15
v_lshrrev_b32 v122, 4, v1
v_lshlrev_b32 v123, 1, v122
v_and_b32 v23, 15, v1
v_xor_b32 v23, v23, v123
v_lshlrev_b32 v23, 4, v23
s_add_u32 m0, s40, 100352
s_add_u32 s38, s38, 57344
s_branch Lov_10
.p2align 12
.fill 80, 4, 0xbf800000
Lst_10_0:
s_branch Lwr_170
Lst_10_1:
s_branch Lwr_181
s_nop 0
Lov_10:
buffer_load_dwordx4 v4, s[12:15], s38 offen lds
v_mul_u32_u24 v122, 2048, v122
v_add_u32 v23, v23, v122
v_add_u32 v23, s44, v23
v_xor_b32 v24, 128, v23
v_add_u32 v24, 8192, v24
s_lshl_b32 s43, s60, 2
s_add_u32 m0, s40, 101376
s_nop 0
buffer_load_dwordx4 v5, s[12:15], s38 offen lds
s_lshl_b32 s44, s61, 1
s_add_u32 s43, s43, s44
s_add_u32 s43, s43, s63
s_lshl_b32 s43, s43, 13
s_lshl_b32 s44, s62, 12
s_add_u32 s50, s43, s44
v_add_u32 v17, s44, v2
s_add_u32 m0, s40, 102400
s_add_u32 s38, s38, 57344
buffer_load_dwordx4 v4, s[12:15], s38 offen lds
v_add_u32 v18, 0x10000, v17
v_add_u32 v19, 0x20000, v17
v_lshrrev_b32 v122, 2, v1
v_and_b32 v123, 7, v122
v_mul_u32_u24 v122, 256, v122
v_lshl_add_u32 v122, v123, 5, v122
s_add_u32 m0, s40, 103424
s_nop 0
buffer_load_dwordx4 v5, s[12:15], s38 offen lds
v_and_b32 v123, 3, v1
v_lshl_add_u32 v9, v123, 3, v122
s_lshl_b32 s43, s61, 7
s_lshl_b32 s44, s63, 6
s_add_u32 s43, s43, s44
v_xor_b32 v9, s43, v9
v_xor_b32 v10, 32, v9
s_add_u32 m0, s40, 104448
s_add_u32 s38, s38, 57344
buffer_load_dwordx4 v4, s[12:15], s38 offen lds
s_add_u32 m0, s40, 105472
s_nop 0
buffer_load_dwordx4 v5, s[12:15], s38 offen lds
s_waitcnt vmcnt(12)
s_barrier
buffer_load_dwordx4 v[160:163], v2, s[8:11], s50 offen offset:0 sc1
v_xor_b32 v11, 128, v9
v_xor_b32 v12, 128, v10
v_add_u32 v13, 65536, v9
buffer_load_dwordx4 v[164:167], v2, s[8:11], s50 offen offset:1024 sc1
v_add_u32 v14, 65536, v10
v_add_u32 v15, 65536, v11
v_add_u32 v16, 65536, v12
v_add_u32 v25, 131072, v9
buffer_load_dwordx4 v[168:171], v2, s[8:11], s50 offen offset:2048 sc1
v_add_u32 v26, 131072, v10
v_add_u32 v27, 131072, v11
v_add_u32 v28, 131072, v12
v_lshrrev_b32 v122, 2, v1
buffer_load_dwordx4 v[172:175], v2, s[8:11], s50 offen offset:3072 sc1
v_bfe_u32 v123, v122, 1, 2
v_mul_u32_u24 v122, 128, v122
v_lshl_add_u32 v122, v123, 5, v122
s_add_u32 s37, s35, 11
s_and_b32 s37, s37, 15
s_mul_i32 s37, s37, 16384
s_add_u32 m0, s39, 0
s_nop 0
buffer_load_dwordx4 v3, s[8:11], s37 offen sc1 lds
v_and_b32 v123, 3, v1
v_lshl_add_u32 v224, v123, 3, v122
v_xor_b32 v224, s44, v224
v_xor_b32 v225, 32, v224
buffer_load_dwordx4 v3, s[8:11], s37 offen offset:1024 sc1 lds
v_add_u32 v226, 65536, v224
v_add_u32 v227, 65536, v225
v_add_u32 v228, 131072, v224
v_add_u32 v229, 131072, v225
buffer_load_dwordx4 v3, s[8:11], s37 offen offset:2048 sc1 lds
s_add_u32 s84, s82, 33554432
s_addc_u32 s85, s83, 0
s_mov_b32 s86, 4194304
s_mov_b32 s87, 0x20000
buffer_load_dwordx4 v3, s[8:11], s37 offen offset:3072 sc1 lds
s_xor_b32 s43, s2, 2
s_lshl_b32 s44, s43, 2
s_add_u32 s44, s44, s47
s_add_u32 s38, s35, 11
s_and_b32 s38, s38, 15
s_mul_i32 s38, s38, 458752
s_add_u32 m0, s40, 0
s_nop 0
buffer_load_dwordx4 v4, s[12:15], s38 offen lds
s_lshl_b32 s45, s44, 12
s_lshl_b32 s46, s2, 2
s_add_u32 s46, s46, s47
s_lshl_b32 s46, s46, 12
s_add_u32 m0, s40, 1024
s_nop 0
buffer_load_dwordx4 v5, s[12:15], s38 offen lds
s_lshl_b32 s43, s34, 18
s_lshl_b32 s42, s60, 8
s_add_u32 s43, s43, s42
s_lshl_b32 s42, s61, 7
s_add_u32 m0, s40, 2048
s_add_u32 s38, s38, 57344
buffer_load_dwordx4 v4, s[12:15], s38 offen lds
s_add_u32 s43, s43, s42
s_lshl_b32 s42, s63, 6
s_add_u32 s43, s43, s42
s_add_u32 m0, s40, 3072
s_nop 0
buffer_load_dwordx4 v5, s[12:15], s38 offen lds
s_add_u32 s20, s78, s43
s_addc_u32 s21, s79, 0
s_mov_b32 s22, 260160
s_mov_b32 s23, 0x20000
s_add_u32 m0, s40, 4096
s_add_u32 s38, s38, 57344
buffer_load_dwordx4 v4, s[12:15], s38 offen lds
v_and_b32 v230, 15, v1
v_lshlrev_b32 v230, 12, v230
v_bfe_u32 v231, v1, 4, 1
v_lshl_add_u32 v230, v231, 5, v230
s_add_u32 m0, s40, 5120
s_nop 0
buffer_load_dwordx4 v5, s[12:15], s38 offen lds
v_bfe_u32 v231, v1, 5, 1
v_lshl_add_u32 v230, v231, 4, v230
s_lshl_b32 s54, s62, 17
s_add_u32 s55, s54, 65536
s_add_u32 m0, s40, 6144
s_add_u32 s38, s38, 57344
buffer_load_dwordx4 v4, s[12:15], s38 offen lds
s_add_u32 m0, s40, 7168
s_nop 0
buffer_load_dwordx4 v5, s[12:15], s38 offen lds
s_waitcnt vmcnt(16)
s_barrier
s_cmp_eq_u32 s47, 3
s_cbranch_scc0 Lw_131
s_lshl_b32 s92, s34, 7
s_add_u32 s92, s92, 28315648
s_load_dword s93, s[82:83], s92 glc
Lw_131:
s_add_u32 s37, s35, 12
s_and_b32 s37, s37, 15
s_mul_i32 s37, s37, 16384
s_add_u32 m0, s39, 49152
s_nop 0
buffer_load_dwordx4 v3, s[8:11], s37 offen sc1 lds
buffer_load_dwordx4 v3, s[8:11], s37 offen offset:1024 sc1 lds
buffer_load_dwordx4 v3, s[8:11], s37 offen offset:2048 sc1 lds
buffer_load_dwordx4 v3, s[8:11], s37 offen offset:3072 sc1 lds
s_add_u32 s38, s35, 12
s_and_b32 s38, s38, 15
s_mul_i32 s38, s38, 458752
s_add_u32 m0, s40, 49152
s_nop 0
buffer_load_dwordx4 v4, s[12:15], s38 offen lds
s_add_u32 m0, s40, 50176
s_nop 0
buffer_load_dwordx4 v5, s[12:15], s38 offen lds
s_add_u32 m0, s40, 51200
s_add_u32 s38, s38, 57344
buffer_load_dwordx4 v4, s[12:15], s38 offen lds
s_add_u32 m0, s40, 52224
s_nop 0
buffer_load_dwordx4 v5, s[12:15], s38 offen lds
s_add_u32 m0, s40, 53248
s_add_u32 s38, s38, 57344
buffer_load_dwordx4 v4, s[12:15], s38 offen lds
s_add_u32 m0, s40, 54272
s_nop 0
buffer_load_dwordx4 v5, s[12:15], s38 offen lds
s_add_u32 m0, s40, 55296
s_add_u32 s38, s38, 57344
buffer_load_dwordx4 v4, s[12:15], s38 offen lds
s_add_u32 m0, s40, 56320
s_nop 0
buffer_load_dwordx4 v5, s[12:15], s38 offen lds
s_waitcnt vmcnt(12)
s_cmp_eq_u32 s47, 3
s_cbranch_scc0 Lw_132
s_mov_b32 s41, 0x40000
s_branch Lpchk_135
Lpoll_133:
s_load_dword s93, s[82:83], s92 glc
Lpchk_135:
s_waitcnt lgkmcnt(0)
s_cmp_eq_u32 s93, 16
s_cbranch_scc1 Lpok_134
s_sub_u32 s41, s41, 1
s_cmp_lg_u32 s41, 0
s_cbranch_scc1 Lpoll_133
Lpok_134:
Lw_132:
s_barrier
s_add_u32 s37, s52, 524288
s_add_u32 m0, s39, 98304
s_nop 0
buffer_load_dwordx4 v3, s[24:27], s37 offen sc1 lds
v_lshlrev_b32 v128, 16, v160
v_and_b32 v129, 0xffff0000, v160
v_lshlrev_b32 v130, 16, v161
v_and_b32 v131, 0xffff0000, v161
v_lshlrev_b32 v132, 16, v162
buffer_load_dwordx4 v3, s[24:27], s37 offen offset:1024 sc1 lds
v_and_b32 v133, 0xffff0000, v162
v_lshlrev_b32 v134, 16, v163
v_and_b32 v135, 0xffff0000, v163
v_lshlrev_b32 v136, 16, v164
v_and_b32 v137, 0xffff0000, v164
buffer_load_dwordx4 v3, s[24:27], s37 offen offset:2048 sc1 lds
v_lshlrev_b32 v138, 16, v165
v_and_b32 v139, 0xffff0000, v165
v_lshlrev_b32 v140, 16, v166
v_and_b32 v141, 0xffff0000, v166
v_lshlrev_b32 v142, 16, v167
v_and_b32 v143, 0xffff0000, v167
buffer_load_dwordx4 v3, s[24:27], s37 offen offset:3072 sc1 lds
v_lshlrev_b32 v144, 16, v168
v_and_b32 v145, 0xffff0000, v168
v_lshlrev_b32 v146, 16, v169
v_and_b32 v147, 0xffff0000, v169
v_lshlrev_b32 v148, 16, v170
s_add_u32 s38, s53, 4194304
s_add_u32 m0, s39, 114688
s_nop 0
buffer_load_dwordx4 v23, s[28:31], s38 offen lds
v_and_b32 v149, 0xffff0000, v170
v_lshlrev_b32 v150, 16, v171
v_and_b32 v151, 0xffff0000, v171
v_lshlrev_b32 v152, 16, v172
v_and_b32 v153, 0xffff0000, v172
s_add_u32 m0, s39, 115712
s_nop 0
buffer_load_dwordx4 v24, s[28:31], s38 offen lds
v_lshlrev_b32 v154, 16, v173
v_and_b32 v155, 0xffff0000, v173
v_lshlrev_b32 v156, 16, v174
v_and_b32 v157, 0xffff0000, v174
v_lshlrev_b32 v158, 16, v175
v_and_b32 v159, 0xffff0000, v175
s_add_u32 m0, s39, 116736
s_add_u32 s38, s38, 16384
buffer_load_dwordx4 v23, s[28:31], s38 offen lds
s_add_u32 m0, s39, 117760
s_nop 0
buffer_load_dwordx4 v24, s[28:31], s38 offen lds
s_waitcnt vmcnt(8)
s_barrier
s_add_u32 s37, s52, 540672
s_add_u32 m0, s39, 131072
s_nop 0
buffer_load_dwordx4 v3, s[24:27], s37 offen sc1 lds
buffer_load_dwordx4 v3, s[24:27], s37 offen offset:1024 sc1 lds
buffer_load_dwordx4 v3, s[24:27], s37 offen offset:2048 sc1 lds
buffer_load_dwordx4 v3, s[24:27], s37 offen offset:3072 sc1 lds
s_add_u32 s38, s53, 4325376
s_add_u32 m0, s39, 0
s_nop 0
buffer_load_dwordx4 v23, s[28:31], s38 offen lds
s_add_u32 m0, s39, 1024
s_nop 0
buffer_load_dwordx4 v24, s[28:31], s38 offen lds
s_add_u32 m0, s39, 2048
s_add_u32 s38, s38, 16384
buffer_load_dwordx4 v23, s[28:31], s38 offen lds
s_add_u32 m0, s39, 3072
s_nop 0
buffer_load_dwordx4 v24, s[28:31], s38 offen lds
s_add_u32 s37, s52, 557056
s_add_u32 m0, s39, 16384
s_nop 0
buffer_load_dwordx4 v3, s[24:27], s37 offen sc1 lds
buffer_load_dwordx4 v3, s[24:27], s37 offen offset:1024 sc1 lds
buffer_load_dwordx4 v3, s[24:27], s37 offen offset:2048 sc1 lds
buffer_load_dwordx4 v3, s[24:27], s37 offen offset:3072 sc1 lds
s_add_u32 s38, s53, 4456448
s_add_u32 m0, s39, 32768
s_nop 0
buffer_load_dwordx4 v23, s[28:31], s38 offen lds
s_add_u32 m0, s39, 33792
s_nop 0
buffer_load_dwordx4 v24, s[28:31], s38 offen lds
s_add_u32 m0, s39, 34816
s_add_u32 s38, s38, 16384
buffer_load_dwordx4 v23, s[28:31], s38 offen lds
s_add_u32 m0, s39, 35840
s_nop 0
buffer_load_dwordx4 v24, s[28:31], s38 offen lds
s_waitcnt vmcnt(16)
s_barrier
ds_read_b128 v[32:35], v18 offset:32768
ds_read_b64_tr_b16 v[48:49], v13 offset:49152
ds_read_b64_tr_b16 v[50:51], v13 offset:53248
ds_read_b64_tr_b16 v[52:53], v14 offset:49152
ds_read_b64_tr_b16 v[54:55], v14 offset:53248
ds_read_b64_tr_b16 v[56:57], v15 offset:49152
ds_read_b64_tr_b16 v[58:59], v15 offset:53248
ds_read_b64_tr_b16 v[60:61], v16 offset:49152
ds_read_b64_tr_b16 v[62:63], v16 offset:53248
ds_read_b128 v[36:39], v18 offset:33792
ds_read_b128 v[40:43], v18 offset:34816
ds_read_b128 v[44:47], v18 offset:35840
ds_read_b128 v[64:67], v18 offset:40960
ds_read_b64_tr_b16 v[80:81], v13 offset:57344
ds_read_b64_tr_b16 v[82:83], v13 offset:61440
ds_read_b64_tr_b16 v[84:85], v14 offset:57344
ds_read_b64_tr_b16 v[86:87], v14 offset:61440
ds_read_b64_tr_b16 v[88:89], v15 offset:57344
ds_read_b64_tr_b16 v[90:91], v15 offset:61440
ds_read_b64_tr_b16 v[92:93], v16 offset:57344
ds_read_b64_tr_b16 v[94:95], v16 offset:61440
ds_read_b128 v[68:71], v18 offset:41984
ds_read_b128 v[72:75], v18 offset:43008
ds_read_b128 v[76:79], v18 offset:44032
s_add_u32 s37, s52, 573440
s_add_u32 m0, s39, 49152
s_nop 0
buffer_load_dwordx4 v3, s[24:27], s37 offen sc1 lds
buffer_load_dwordx4 v3, s[24:27], s37 offen offset:1024 sc1 lds
buffer_load_dwordx4 v3, s[24:27], s37 offen offset:2048 sc1 lds
buffer_load_dwordx4 v3, s[24:27], s37 offen offset:3072 sc1 lds
s_add_u32 s38, s53, 4587520
s_add_u32 m0, s39, 65536
s_nop 0
buffer_load_dwordx4 v23, s[28:31], s38 offen lds
s_add_u32 m0, s39, 66560
s_nop 0
buffer_load_dwordx4 v24, s[28:31], s38 offen lds
s_add_u32 m0, s39, 67584
s_add_u32 s38, s38, 16384
buffer_load_dwordx4 v23, s[28:31], s38 offen lds
s_add_u32 m0, s39, 68608
s_nop 0
buffer_load_dwordx4 v24, s[28:31], s38 offen lds
Lk4c:
s_waitcnt vmcnt(16)
s_waitcnt lgkmcnt(0)
s_barrier
v_mfma_f32_16x16x32_bf16 v[128:131], v[48:51], v[32:35], v[128:131]
ds_read_b128 v[96:99], v19 offset:0
v_mfma_f32_16x16x32_bf16 v[136:139], v[48:51], v[36:39], v[136:139]
ds_read_b64_tr_b16 v[112:113], v9 offset:0
v_mfma_f32_16x16x32_bf16 v[144:147], v[48:51], v[40:43], v[144:147]
ds_read_b64_tr_b16 v[114:115], v9 offset:4096
v_mfma_f32_16x16x32_bf16 v[152:155], v[48:51], v[44:47], v[152:155]
ds_read_b64_tr_b16 v[116:117], v10 offset:0
v_mfma_f32_16x16x32_bf16 v[156:159], v[52:55], v[44:47], v[156:159]
ds_read_b64_tr_b16 v[118:119], v10 offset:4096
v_mfma_f32_16x16x32_bf16 v[148:151], v[52:55], v[40:43], v[148:151]
ds_read_b64_tr_b16 v[120:121], v11 offset:0
v_mfma_f32_16x16x32_bf16 v[140:143], v[52:55], v[36:39], v[140:143]
ds_read_b64_tr_b16 v[122:123], v11 offset:4096
v_mfma_f32_16x16x32_bf16 v[132:135], v[52:55], v[32:35], v[132:135]
ds_read_b64_tr_b16 v[124:125], v12 offset:0
v_mfma_f32_16x16x32_bf16 v[160:163], v[56:59], v[32:35], 0
ds_read_b64_tr_b16 v[126:127], v12 offset:4096
v_mfma_f32_16x16x32_bf16 v[168:171], v[56:59], v[36:39], 0
ds_read_b128 v[100:103], v19 offset:1024
v_mfma_f32_16x16x32_bf16 v[176:179], v[56:59], v[40:43], 0
ds_read_b128 v[104:107], v19 offset:2048
v_mfma_f32_16x16x32_bf16 v[184:187], v[56:59], v[44:47], 0
ds_read_b128 v[108:111], v19 offset:3072
v_mfma_f32_16x16x32_bf16 v[188:191], v[60:63], v[44:47], 0
ds_read_b128 v[192:195], v19 offset:8192
v_mfma_f32_16x16x32_bf16 v[180:183], v[60:63], v[40:43], 0
ds_read_b64_tr_b16 v[208:209], v9 offset:8192
v_mfma_f32_16x16x32_bf16 v[172:175], v[60:63], v[36:39], 0
ds_read_b64_tr_b16 v[210:211], v9 offset:12288
v_mfma_f32_16x16x32_bf16 v[164:167], v[60:63], v[32:35], 0
ds_read_b64_tr_b16 v[212:213], v10 offset:8192
v_mfma_f32_16x16x32_bf16 v[128:131], v[80:83], v[64:67], v[128:131]
ds_read_b64_tr_b16 v[214:215], v10 offset:12288
v_mfma_f32_16x16x32_bf16 v[136:139], v[80:83], v[68:71], v[136:139]
ds_read_b64_tr_b16 v[216:217], v11 offset:8192
v_mfma_f32_16x16x32_bf16 v[144:147], v[80:83], v[72:75], v[144:147]
ds_read_b64_tr_b16 v[218:219], v11 offset:12288
v_mfma_f32_16x16x32_bf16 v[152:155], v[80:83], v[76:79], v[152:155]
ds_read_b64_tr_b16 v[220:221], v12 offset:8192
v_mfma_f32_16x16x32_bf16 v[156:159], v[84:87], v[76:79], v[156:159]
ds_read_b64_tr_b16 v[222:223], v12 offset:12288
v_mfma_f32_16x16x32_bf16 v[148:151], v[84:87], v[72:75], v[148:151]
ds_read_b128 v[196:199], v19 offset:9216
v_mfma_f32_16x16x32_bf16 v[140:143], v[84:87], v[68:71], v[140:143]
ds_read_b128 v[200:203], v19 offset:10240
v_mfma_f32_16x16x32_bf16 v[132:135], v[84:87], v[64:67], v[132:135]
ds_read_b128 v[204:207], v19 offset:11264
v_mfma_f32_16x16x32_bf16 v[160:163], v[88:91], v[64:67], v[160:163]
v_mfma_f32_16x16x32_bf16 v[168:171], v[88:91], v[68:71], v[168:171]
v_mfma_f32_16x16x32_bf16 v[176:179], v[88:91], v[72:75], v[176:179]
v_mfma_f32_16x16x32_bf16 v[184:187], v[88:91], v[76:79], v[184:187]
v_mfma_f32_16x16x32_bf16 v[188:191], v[92:95], v[76:79], v[188:191]
v_mfma_f32_16x16x32_bf16 v[180:183], v[92:95], v[72:75], v[180:183]
v_mfma_f32_16x16x32_bf16 v[172:175], v[92:95], v[68:71], v[172:175]
v_mfma_f32_16x16x32_bf16 v[164:167], v[92:95], v[64:67], v[164:167]
s_mov_b32 s41, 2
Lk4_136:
s_waitcnt vmcnt(8)
s_waitcnt lgkmcnt(0)
s_barrier
v_mfma_f32_16x16x32_bf16 v[128:131], v[112:115], v[96:99], v[128:131]
ds_read_b128 v[32:35], v17 offset:16384
v_mfma_f32_16x16x32_bf16 v[136:139], v[112:115], v[100:103], v[136:139]
ds_read_b64_tr_b16 v[48:49], v9 offset:32768
v_mfma_f32_16x16x32_bf16 v[144:147], v[112:115], v[104:107], v[144:147]
ds_read_b64_tr_b16 v[50:51], v9 offset:36864
v_mfma_f32_16x16x32_bf16 v[152:155], v[112:115], v[108:111], v[152:155]
ds_read_b64_tr_b16 v[52:53], v10 offset:32768
v_mfma_f32_16x16x32_bf16 v[156:159], v[116:119], v[108:111], v[156:159]
ds_read_b64_tr_b16 v[54:55], v10 offset:36864
v_mfma_f32_16x16x32_bf16 v[148:151], v[116:119], v[104:107], v[148:151]
ds_read_b64_tr_b16 v[56:57], v11 offset:32768
v_mfma_f32_16x16x32_bf16 v[140:143], v[116:119], v[100:103], v[140:143]
ds_read_b64_tr_b16 v[58:59], v11 offset:36864
v_mfma_f32_16x16x32_bf16 v[132:135], v[116:119], v[96:99], v[132:135]
ds_read_b64_tr_b16 v[60:61], v12 offset:32768
v_mfma_f32_16x16x32_bf16 v[160:163], v[120:123], v[96:99], v[160:163]
ds_read_b64_tr_b16 v[62:63], v12 offset:36864
v_mfma_f32_16x16x32_bf16 v[168:171], v[120:123], v[100:103], v[168:171]
ds_read_b128 v[36:39], v17 offset:17408
v_mfma_f32_16x16x32_bf16 v[176:179], v[120:123], v[104:107], v[176:179]
ds_read_b128 v[40:43], v17 offset:18432
v_mfma_f32_16x16x32_bf16 v[184:187], v[120:123], v[108:111], v[184:187]
ds_read_b128 v[44:47], v17 offset:19456
v_mfma_f32_16x16x32_bf16 v[188:191], v[124:127], v[108:111], v[188:191]
ds_read_b128 v[64:67], v17 offset:24576
v_mfma_f32_16x16x32_bf16 v[180:183], v[124:127], v[104:107], v[180:183]
ds_read_b64_tr_b16 v[80:81], v9 offset:40960
v_mfma_f32_16x16x32_bf16 v[172:175], v[124:127], v[100:103], v[172:175]
ds_read_b64_tr_b16 v[82:83], v9 offset:45056
v_mfma_f32_16x16x32_bf16 v[164:167], v[124:127], v[96:99], v[164:167]
ds_read_b64_tr_b16 v[84:85], v10 offset:40960
v_mfma_f32_16x16x32_bf16 v[128:131], v[208:211], v[192:195], v[128:131]
ds_read_b64_tr_b16 v[86:87], v10 offset:45056
v_mfma_f32_16x16x32_bf16 v[136:139], v[208:211], v[196:199], v[136:139]
ds_read_b64_tr_b16 v[88:89], v11 offset:40960
v_mfma_f32_16x16x32_bf16 v[144:147], v[208:211], v[200:203], v[144:147]
ds_read_b64_tr_b16 v[90:91], v11 offset:45056
v_mfma_f32_16x16x32_bf16 v[152:155], v[208:211], v[204:207], v[152:155]
ds_read_b64_tr_b16 v[92:93], v12 offset:40960
v_mfma_f32_16x16x32_bf16 v[156:159], v[212:215], v[204:207], v[156:159]
ds_read_b64_tr_b16 v[94:95], v12 offset:45056
v_mfma_f32_16x16x32_bf16 v[148:151], v[212:215], v[200:203], v[148:151]
ds_read_b128 v[68:71], v17 offset:25600
v_mfma_f32_16x16x32_bf16 v[140:143], v[212:215], v[196:199], v[140:143]
ds_read_b128 v[72:75], v17 offset:26624
v_mfma_f32_16x16x32_bf16 v[132:135], v[212:215], v[192:195], v[132:135]
ds_read_b128 v[76:79], v17 offset:27648
v_mfma_f32_16x16x32_bf16 v[160:163], v[216:219], v[192:195], v[160:163]
v_mfma_f32_16x16x32_bf16 v[168:171], v[216:219], v[196:199], v[168:171]
v_mfma_f32_16x16x32_bf16 v[176:179], v[216:219], v[200:203], v[176:179]
v_mfma_f32_16x16x32_bf16 v[184:187], v[216:219], v[204:207], v[184:187]
v_mfma_f32_16x16x32_bf16 v[188:191], v[220:223], v[204:207], v[188:191]
v_mfma_f32_16x16x32_bf16 v[180:183], v[220:223], v[200:203], v[180:183]
v_mfma_f32_16x16x32_bf16 v[172:175], v[220:223], v[196:199], v[172:175]
v_mfma_f32_16x16x32_bf16 v[164:167], v[220:223], v[192:195], v[164:167]
s_waitcnt vmcnt(0)
s_waitcnt lgkmcnt(0)
s_barrier
v_mfma_f32_16x16x32_bf16 v[128:131], v[48:51], v[32:35], v[128:131]
ds_read_b128 v[96:99], v17 offset:49152
v_mfma_f32_16x16x32_bf16 v[136:139], v[48:51], v[36:39], v[136:139]
ds_read_b64_tr_b16 v[112:113], v13 offset:0
v_mfma_f32_16x16x32_bf16 v[144:147], v[48:51], v[40:43], v[144:147]
ds_read_b64_tr_b16 v[114:115], v13 offset:4096
v_mfma_f32_16x16x32_bf16 v[152:155], v[48:51], v[44:47], v[152:155]
ds_read_b64_tr_b16 v[116:117], v14 offset:0
v_mfma_f32_16x16x32_bf16 v[156:159], v[52:55], v[44:47], v[156:159]
ds_read_b64_tr_b16 v[118:119], v14 offset:4096
v_mfma_f32_16x16x32_bf16 v[148:151], v[52:55], v[40:43], v[148:151]
ds_read_b64_tr_b16 v[120:121], v15 offset:0
v_mfma_f32_16x16x32_bf16 v[140:143], v[52:55], v[36:39], v[140:143]
ds_read_b64_tr_b16 v[122:123], v15 offset:4096
v_mfma_f32_16x16x32_bf16 v[132:135], v[52:55], v[32:35], v[132:135]
ds_read_b64_tr_b16 v[124:125], v16 offset:0
v_mfma_f32_16x16x32_bf16 v[160:163], v[56:59], v[32:35], v[160:163]
ds_read_b64_tr_b16 v[126:127], v16 offset:4096
v_mfma_f32_16x16x32_bf16 v[168:171], v[56:59], v[36:39], v[168:171]
ds_read_b128 v[100:103], v17 offset:50176
v_mfma_f32_16x16x32_bf16 v[176:179], v[56:59], v[40:43], v[176:179]
ds_read_b128 v[104:107], v17 offset:51200
v_mfma_f32_16x16x32_bf16 v[184:187], v[56:59], v[44:47], v[184:187]
ds_read_b128 v[108:111], v17 offset:52224
v_mfma_f32_16x16x32_bf16 v[188:191], v[60:63], v[44:47], v[188:191]
ds_read_b128 v[192:195], v17 offset:57344
v_mfma_f32_16x16x32_bf16 v[180:183], v[60:63], v[40:43], v[180:183]
ds_read_b64_tr_b16 v[208:209], v13 offset:8192
v_mfma_f32_16x16x32_bf16 v[172:175], v[60:63], v[36:39], v[172:175]
ds_read_b64_tr_b16 v[210:211], v13 offset:12288
v_mfma_f32_16x16x32_bf16 v[164:167], v[60:63], v[32:35], v[164:167]
ds_read_b64_tr_b16 v[212:213], v14 offset:8192
v_mfma_f32_16x16x32_bf16 v[128:131], v[80:83], v[64:67], v[128:131]
ds_read_b64_tr_b16 v[214:215], v14 offset:12288
v_mfma_f32_16x16x32_bf16 v[136:139], v[80:83], v[68:71], v[136:139]
ds_read_b64_tr_b16 v[216:217], v15 offset:8192
v_mfma_f32_16x16x32_bf16 v[144:147], v[80:83], v[72:75], v[144:147]
ds_read_b64_tr_b16 v[218:219], v15 offset:12288
v_mfma_f32_16x16x32_bf16 v[152:155], v[80:83], v[76:79], v[152:155]
ds_read_b64_tr_b16 v[220:221], v16 offset:8192
v_mfma_f32_16x16x32_bf16 v[156:159], v[84:87], v[76:79], v[156:159]
ds_read_b64_tr_b16 v[222:223], v16 offset:12288
v_mfma_f32_16x16x32_bf16 v[148:151], v[84:87], v[72:75], v[148:151]
ds_read_b128 v[196:199], v17 offset:58368
v_mfma_f32_16x16x32_bf16 v[140:143], v[84:87], v[68:71], v[140:143]
ds_read_b128 v[200:203], v17 offset:59392
v_mfma_f32_16x16x32_bf16 v[132:135], v[84:87], v[64:67], v[132:135]
ds_read_b128 v[204:207], v17 offset:60416
v_mfma_f32_16x16x32_bf16 v[160:163], v[88:91], v[64:67], v[160:163]
v_mfma_f32_16x16x32_bf16 v[168:171], v[88:91], v[68:71], v[168:171]
v_mfma_f32_16x16x32_bf16 v[176:179], v[88:91], v[72:75], v[176:179]
v_mfma_f32_16x16x32_bf16 v[184:187], v[88:91], v[76:79], v[184:187]
v_mfma_f32_16x16x32_bf16 v[188:191], v[92:95], v[76:79], v[188:191]
v_mfma_f32_16x16x32_bf16 v[180:183], v[92:95], v[72:75], v[180:183]
v_mfma_f32_16x16x32_bf16 v[172:175], v[92:95], v[68:71], v[172:175]
v_mfma_f32_16x16x32_bf16 v[164:167], v[92:95], v[64:67], v[164:167]
s_waitcnt lgkmcnt(0)
s_barrier
v_mfma_f32_16x16x32_bf16 v[128:131], v[112:115], v[96:99], v[128:131]
ds_read_b128 v[32:35], v18 offset:16384
v_mfma_f32_16x16x32_bf16 v[136:139], v[112:115], v[100:103], v[136:139]
ds_read_b64_tr_b16 v[48:49], v25 offset:16384
v_mfma_f32_16x16x32_bf16 v[144:147], v[112:115], v[104:107], v[144:147]
ds_read_b64_tr_b16 v[50:51], v25 offset:20480
v_mfma_f32_16x16x32_bf16 v[152:155], v[112:115], v[108:111], v[152:155]
ds_read_b64_tr_b16 v[52:53], v26 offset:16384
v_mfma_f32_16x16x32_bf16 v[156:159], v[116:119], v[108:111], v[156:159]
ds_read_b64_tr_b16 v[54:55], v26 offset:20480
v_mfma_f32_16x16x32_bf16 v[148:151], v[116:119], v[104:107], v[148:151]
ds_read_b64_tr_b16 v[56:57], v27 offset:16384
v_mfma_f32_16x16x32_bf16 v[140:143], v[116:119], v[100:103], v[140:143]
ds_read_b64_tr_b16 v[58:59], v27 offset:20480
v_mfma_f32_16x16x32_bf16 v[132:135], v[116:119], v[96:99], v[132:135]
ds_read_b64_tr_b16 v[60:61], v28 offset:16384
v_mfma_f32_16x16x32_bf16 v[160:163], v[120:123], v[96:99], v[160:163]
ds_read_b64_tr_b16 v[62:63], v28 offset:20480
v_mfma_f32_16x16x32_bf16 v[168:171], v[120:123], v[100:103], v[168:171]
ds_read_b128 v[36:39], v18 offset:17408
v_mfma_f32_16x16x32_bf16 v[176:179], v[120:123], v[104:107], v[176:179]
ds_read_b128 v[40:43], v18 offset:18432
v_mfma_f32_16x16x32_bf16 v[184:187], v[120:123], v[108:111], v[184:187]
ds_read_b128 v[44:47], v18 offset:19456
v_mfma_f32_16x16x32_bf16 v[188:191], v[124:127], v[108:111], v[188:191]
s_branch Lov_11
.p2align 12
.fill 80, 4, 0xbf800000
Lst_11_0:
s_branch Lwr_171
Lst_11_1:
s_branch Lst_15_0
s_nop 0
Lov_11:
ds_read_b128 v[64:67], v18 offset:24576
v_mfma_f32_16x16x32_bf16 v[180:183], v[124:127], v[104:107], v[180:183]
ds_read_b64_tr_b16 v[80:81], v25 offset:24576
v_mfma_f32_16x16x32_bf16 v[172:175], v[124:127], v[100:103], v[172:175]
ds_read_b64_tr_b16 v[82:83], v25 offset:28672
v_mfma_f32_16x16x32_bf16 v[164:167], v[124:127], v[96:99], v[164:167]
ds_read_b64_tr_b16 v[84:85], v26 offset:24576
v_mfma_f32_16x16x32_bf16 v[128:131], v[208:211], v[192:195], v[128:131]
ds_read_b64_tr_b16 v[86:87], v26 offset:28672
v_mfma_f32_16x16x32_bf16 v[136:139], v[208:211], v[196:199], v[136:139]
ds_read_b64_tr_b16 v[88:89], v27 offset:24576
v_mfma_f32_16x16x32_bf16 v[144:147], v[208:211], v[200:203], v[144:147]
ds_read_b64_tr_b16 v[90:91], v27 offset:28672
v_mfma_f32_16x16x32_bf16 v[152:155], v[208:211], v[204:207], v[152:155]
ds_read_b64_tr_b16 v[92:93], v28 offset:24576
v_mfma_f32_16x16x32_bf16 v[156:159], v[212:215], v[204:207], v[156:159]
ds_read_b64_tr_b16 v[94:95], v28 offset:28672
v_mfma_f32_16x16x32_bf16 v[148:151], v[212:215], v[200:203], v[148:151]
ds_read_b128 v[68:71], v18 offset:25600
v_mfma_f32_16x16x32_bf16 v[140:143], v[212:215], v[196:199], v[140:143]
ds_read_b128 v[72:75], v18 offset:26624
v_mfma_f32_16x16x32_bf16 v[132:135], v[212:215], v[192:195], v[132:135]
ds_read_b128 v[76:79], v18 offset:27648
v_mfma_f32_16x16x32_bf16 v[160:163], v[216:219], v[192:195], v[160:163]
v_mfma_f32_16x16x32_bf16 v[168:171], v[216:219], v[196:199], v[168:171]
v_mfma_f32_16x16x32_bf16 v[176:179], v[216:219], v[200:203], v[176:179]
v_mfma_f32_16x16x32_bf16 v[184:187], v[216:219], v[204:207], v[184:187]
v_mfma_f32_16x16x32_bf16 v[188:191], v[220:223], v[204:207], v[188:191]
v_mfma_f32_16x16x32_bf16 v[180:183], v[220:223], v[200:203], v[180:183]
v_mfma_f32_16x16x32_bf16 v[172:175], v[220:223], v[196:199], v[172:175]
v_mfma_f32_16x16x32_bf16 v[164:167], v[220:223], v[192:195], v[164:167]
s_waitcnt lgkmcnt(0)
s_barrier
v_mfma_f32_16x16x32_bf16 v[128:131], v[48:51], v[32:35], v[128:131]
ds_read_b128 v[96:99], v18 offset:32768
v_mfma_f32_16x16x32_bf16 v[136:139], v[48:51], v[36:39], v[136:139]
ds_read_b64_tr_b16 v[112:113], v13 offset:49152
v_mfma_f32_16x16x32_bf16 v[144:147], v[48:51], v[40:43], v[144:147]
ds_read_b64_tr_b16 v[114:115], v13 offset:53248
v_mfma_f32_16x16x32_bf16 v[152:155], v[48:51], v[44:47], v[152:155]
ds_read_b64_tr_b16 v[116:117], v14 offset:49152
v_mfma_f32_16x16x32_bf16 v[156:159], v[52:55], v[44:47], v[156:159]
ds_read_b64_tr_b16 v[118:119], v14 offset:53248
v_mfma_f32_16x16x32_bf16 v[148:151], v[52:55], v[40:43], v[148:151]
ds_read_b64_tr_b16 v[120:121], v15 offset:49152
v_mfma_f32_16x16x32_bf16 v[140:143], v[52:55], v[36:39], v[140:143]
ds_read_b64_tr_b16 v[122:123], v15 offset:53248
v_mfma_f32_16x16x32_bf16 v[132:135], v[52:55], v[32:35], v[132:135]
ds_read_b64_tr_b16 v[124:125], v16 offset:49152
v_mfma_f32_16x16x32_bf16 v[160:163], v[56:59], v[32:35], v[160:163]
ds_read_b64_tr_b16 v[126:127], v16 offset:53248
v_mfma_f32_16x16x32_bf16 v[168:171], v[56:59], v[36:39], v[168:171]
ds_read_b128 v[100:103], v18 offset:33792
v_mfma_f32_16x16x32_bf16 v[176:179], v[56:59], v[40:43], v[176:179]
ds_read_b128 v[104:107], v18 offset:34816
v_mfma_f32_16x16x32_bf16 v[184:187], v[56:59], v[44:47], v[184:187]
ds_read_b128 v[108:111], v18 offset:35840
v_mfma_f32_16x16x32_bf16 v[188:191], v[60:63], v[44:47], v[188:191]
ds_read_b128 v[192:195], v18 offset:40960
v_mfma_f32_16x16x32_bf16 v[180:183], v[60:63], v[40:43], v[180:183]
ds_read_b64_tr_b16 v[208:209], v13 offset:57344
v_mfma_f32_16x16x32_bf16 v[172:175], v[60:63], v[36:39], v[172:175]
ds_read_b64_tr_b16 v[210:211], v13 offset:61440
v_mfma_f32_16x16x32_bf16 v[164:167], v[60:63], v[32:35], v[164:167]
ds_read_b64_tr_b16 v[212:213], v14 offset:57344
v_mfma_f32_16x16x32_bf16 v[128:131], v[80:83], v[64:67], v[128:131]
ds_read_b64_tr_b16 v[214:215], v14 offset:61440
v_mfma_f32_16x16x32_bf16 v[136:139], v[80:83], v[68:71], v[136:139]
ds_read_b64_tr_b16 v[216:217], v15 offset:57344
v_mfma_f32_16x16x32_bf16 v[144:147], v[80:83], v[72:75], v[144:147]
ds_read_b64_tr_b16 v[218:219], v15 offset:61440
v_mfma_f32_16x16x32_bf16 v[152:155], v[80:83], v[76:79], v[152:155]
ds_read_b64_tr_b16 v[220:221], v16 offset:57344
v_mfma_f32_16x16x32_bf16 v[156:159], v[84:87], v[76:79], v[156:159]
ds_read_b64_tr_b16 v[222:223], v16 offset:61440
v_mfma_f32_16x16x32_bf16 v[148:151], v[84:87], v[72:75], v[148:151]
ds_read_b128 v[196:199], v18 offset:41984
v_mfma_f32_16x16x32_bf16 v[140:143], v[84:87], v[68:71], v[140:143]
ds_read_b128 v[200:203], v18 offset:43008
v_mfma_f32_16x16x32_bf16 v[132:135], v[84:87], v[64:67], v[132:135]
ds_read_b128 v[204:207], v18 offset:44032
v_mfma_f32_16x16x32_bf16 v[160:163], v[88:91], v[64:67], v[160:163]
v_mfma_f32_16x16x32_bf16 v[168:171], v[88:91], v[68:71], v[168:171]
v_mfma_f32_16x16x32_bf16 v[176:179], v[88:91], v[72:75], v[176:179]
v_mfma_f32_16x16x32_bf16 v[184:187], v[88:91], v[76:79], v[184:187]
v_mfma_f32_16x16x32_bf16 v[188:191], v[92:95], v[76:79], v[188:191]
v_mfma_f32_16x16x32_bf16 v[180:183], v[92:95], v[72:75], v[180:183]
v_mfma_f32_16x16x32_bf16 v[172:175], v[92:95], v[68:71], v[172:175]
v_mfma_f32_16x16x32_bf16 v[164:167], v[92:95], v[64:67], v[164:167]
s_waitcnt lgkmcnt(0)
s_barrier
v_mfma_f32_16x16x32_bf16 v[128:131], v[112:115], v[96:99], v[128:131]
ds_read_b128 v[32:35], v19 offset:0
v_mfma_f32_16x16x32_bf16 v[136:139], v[112:115], v[100:103], v[136:139]
ds_read_b64_tr_b16 v[48:49], v9 offset:0
v_mfma_f32_16x16x32_bf16 v[144:147], v[112:115], v[104:107], v[144:147]
ds_read_b64_tr_b16 v[50:51], v9 offset:4096
v_mfma_f32_16x16x32_bf16 v[152:155], v[112:115], v[108:111], v[152:155]
ds_read_b64_tr_b16 v[52:53], v10 offset:0
v_mfma_f32_16x16x32_bf16 v[156:159], v[116:119], v[108:111], v[156:159]
ds_read_b64_tr_b16 v[54:55], v10 offset:4096
v_mfma_f32_16x16x32_bf16 v[148:151], v[116:119], v[104:107], v[148:151]
ds_read_b64_tr_b16 v[56:57], v11 offset:0
v_mfma_f32_16x16x32_bf16 v[140:143], v[116:119], v[100:103], v[140:143]
ds_read_b64_tr_b16 v[58:59], v11 offset:4096
v_mfma_f32_16x16x32_bf16 v[132:135], v[116:119], v[96:99], v[132:135]
ds_read_b64_tr_b16 v[60:61], v12 offset:0
v_mfma_f32_16x16x32_bf16 v[160:163], v[120:123], v[96:99], v[160:163]
ds_read_b64_tr_b16 v[62:63], v12 offset:4096
v_mfma_f32_16x16x32_bf16 v[168:171], v[120:123], v[100:103], v[168:171]
ds_read_b128 v[36:39], v19 offset:1024
v_mfma_f32_16x16x32_bf16 v[176:179], v[120:123], v[104:107], v[176:179]
ds_read_b128 v[40:43], v19 offset:2048
v_mfma_f32_16x16x32_bf16 v[184:187], v[120:123], v[108:111], v[184:187]
ds_read_b128 v[44:47], v19 offset:3072
v_mfma_f32_16x16x32_bf16 v[188:191], v[124:127], v[108:111], v[188:191]
ds_read_b128 v[64:67], v19 offset:8192
v_mfma_f32_16x16x32_bf16 v[180:183], v[124:127], v[104:107], v[180:183]
ds_read_b64_tr_b16 v[80:81], v9 offset:8192
v_mfma_f32_16x16x32_bf16 v[172:175], v[124:127], v[100:103], v[172:175]
ds_read_b64_tr_b16 v[82:83], v9 offset:12288
v_mfma_f32_16x16x32_bf16 v[164:167], v[124:127], v[96:99], v[164:167]
ds_read_b64_tr_b16 v[84:85], v10 offset:8192
v_mfma_f32_16x16x32_bf16 v[128:131], v[208:211], v[192:195], v[128:131]
ds_read_b64_tr_b16 v[86:87], v10 offset:12288
v_mfma_f32_16x16x32_bf16 v[136:139], v[208:211], v[196:199], v[136:139]
ds_read_b64_tr_b16 v[88:89], v11 offset:8192
v_mfma_f32_16x16x32_bf16 v[144:147], v[208:211], v[200:203], v[144:147]
ds_read_b64_tr_b16 v[90:91], v11 offset:12288
v_mfma_f32_16x16x32_bf16 v[152:155], v[208:211], v[204:207], v[152:155]
ds_read_b64_tr_b16 v[92:93], v12 offset:8192
v_mfma_f32_16x16x32_bf16 v[156:159], v[212:215], v[204:207], v[156:159]
ds_read_b64_tr_b16 v[94:95], v12 offset:12288
v_mfma_f32_16x16x32_bf16 v[148:151], v[212:215], v[200:203], v[148:151]
ds_read_b128 v[68:71], v19 offset:9216
v_mfma_f32_16x16x32_bf16 v[140:143], v[212:215], v[196:199], v[140:143]
ds_read_b128 v[72:75], v19 offset:10240
v_mfma_f32_16x16x32_bf16 v[132:135], v[212:215], v[192:195], v[132:135]
ds_read_b128 v[76:79], v19 offset:11264
v_mfma_f32_16x16x32_bf16 v[160:163], v[216:219], v[192:195], v[160:163]
v_mfma_f32_16x16x32_bf16 v[168:171], v[216:219], v[196:199], v[168:171]
v_mfma_f32_16x16x32_bf16 v[176:179], v[216:219], v[200:203], v[176:179]
v_mfma_f32_16x16x32_bf16 v[184:187], v[216:219], v[204:207], v[184:187]
v_mfma_f32_16x16x32_bf16 v[188:191], v[220:223], v[204:207], v[188:191]
v_mfma_f32_16x16x32_bf16 v[180:183], v[220:223], v[200:203], v[180:183]
v_mfma_f32_16x16x32_bf16 v[172:175], v[220:223], v[196:199], v[172:175]
v_mfma_f32_16x16x32_bf16 v[164:167], v[220:223], v[192:195], v[164:167]
s_waitcnt lgkmcnt(0)
s_barrier
v_mfma_f32_16x16x32_bf16 v[128:131], v[48:51], v[32:35], v[128:131]
ds_read_b128 v[96:99], v17 offset:16384
v_mfma_f32_16x16x32_bf16 v[136:139], v[48:51], v[36:39], v[136:139]
ds_read_b64_tr_b16 v[112:113], v9 offset:32768
v_mfma_f32_16x16x32_bf16 v[144:147], v[48:51], v[40:43], v[144:147]
ds_read_b64_tr_b16 v[114:115], v9 offset:36864
v_mfma_f32_16x16x32_bf16 v[152:155], v[48:51], v[44:47], v[152:155]
ds_read_b64_tr_b16 v[116:117], v10 offset:32768
v_mfma_f32_16x16x32_bf16 v[156:159], v[52:55], v[44:47], v[156:159]
ds_read_b64_tr_b16 v[118:119], v10 offset:36864
v_mfma_f32_16x16x32_bf16 v[148:151], v[52:55], v[40:43], v[148:151]
ds_read_b64_tr_b16 v[120:121], v11 offset:32768
v_mfma_f32_16x16x32_bf16 v[140:143], v[52:55], v[36:39], v[140:143]
ds_read_b64_tr_b16 v[122:123], v11 offset:36864
v_mfma_f32_16x16x32_bf16 v[132:135], v[52:55], v[32:35], v[132:135]
ds_read_b64_tr_b16 v[124:125], v12 offset:32768
v_mfma_f32_16x16x32_bf16 v[160:163], v[56:59], v[32:35], v[160:163]
ds_read_b64_tr_b16 v[126:127], v12 offset:36864
v_mfma_f32_16x16x32_bf16 v[168:171], v[56:59], v[36:39], v[168:171]
ds_read_b128 v[100:103], v17 offset:17408
v_mfma_f32_16x16x32_bf16 v[176:179], v[56:59], v[40:43], v[176:179]
ds_read_b128 v[104:107], v17 offset:18432
v_mfma_f32_16x16x32_bf16 v[184:187], v[56:59], v[44:47], v[184:187]
ds_read_b128 v[108:111], v17 offset:19456
v_mfma_f32_16x16x32_bf16 v[188:191], v[60:63], v[44:47], v[188:191]
ds_read_b128 v[192:195], v17 offset:24576
v_mfma_f32_16x16x32_bf16 v[180:183], v[60:63], v[40:43], v[180:183]
ds_read_b64_tr_b16 v[208:209], v9 offset:40960
v_mfma_f32_16x16x32_bf16 v[172:175], v[60:63], v[36:39], v[172:175]
ds_read_b64_tr_b16 v[210:211], v9 offset:45056
v_mfma_f32_16x16x32_bf16 v[164:167], v[60:63], v[32:35], v[164:167]
ds_read_b64_tr_b16 v[212:213], v10 offset:40960
v_mfma_f32_16x16x32_bf16 v[128:131], v[80:83], v[64:67], v[128:131]
ds_read_b64_tr_b16 v[214:215], v10 offset:45056
v_mfma_f32_16x16x32_bf16 v[136:139], v[80:83], v[68:71], v[136:139]
ds_read_b64_tr_b16 v[216:217], v11 offset:40960
v_mfma_f32_16x16x32_bf16 v[144:147], v[80:83], v[72:75], v[144:147]
ds_read_b64_tr_b16 v[218:219], v11 offset:45056
v_mfma_f32_16x16x32_bf16 v[152:155], v[80:83], v[76:79], v[152:155]
ds_read_b64_tr_b16 v[220:221], v12 offset:40960
v_mfma_f32_16x16x32_bf16 v[156:159], v[84:87], v[76:79], v[156:159]
ds_read_b64_tr_b16 v[222:223], v12 offset:45056
v_mfma_f32_16x16x32_bf16 v[148:151], v[84:87], v[72:75], v[148:151]
ds_read_b128 v[196:199], v17 offset:25600
v_mfma_f32_16x16x32_bf16 v[140:143], v[84:87], v[68:71], v[140:143]
ds_read_b128 v[200:203], v17 offset:26624
v_mfma_f32_16x16x32_bf16 v[132:135], v[84:87], v[64:67], v[132:135]
ds_read_b128 v[204:207], v17 offset:27648
v_mfma_f32_16x16x32_bf16 v[160:163], v[88:91], v[64:67], v[160:163]
v_mfma_f32_16x16x32_bf16 v[168:171], v[88:91], v[68:71], v[168:171]
v_mfma_f32_16x16x32_bf16 v[176:179], v[88:91], v[72:75], v[176:179]
v_mfma_f32_16x16x32_bf16 v[184:187], v[88:91], v[76:79], v[184:187]
v_mfma_f32_16x16x32_bf16 v[188:191], v[92:95], v[76:79], v[188:191]
v_mfma_f32_16x16x32_bf16 v[180:183], v[92:95], v[72:75], v[180:183]
v_mfma_f32_16x16x32_bf16 v[172:175], v[92:95], v[68:71], v[172:175]
v_mfma_f32_16x16x32_bf16 v[164:167], v[92:95], v[64:67], v[164:167]
s_waitcnt lgkmcnt(0)
s_barrier
v_mfma_f32_16x16x32_bf16 v[128:131], v[112:115], v[96:99], v[128:131]
ds_read_b128 v[32:35], v17 offset:49152
v_mfma_f32_16x16x32_bf16 v[136:139], v[112:115], v[100:103], v[136:139]
ds_read_b64_tr_b16 v[48:49], v13 offset:0
v_mfma_f32_16x16x32_bf16 v[144:147], v[112:115], v[104:107], v[144:147]
ds_read_b64_tr_b16 v[50:51], v13 offset:4096
v_mfma_f32_16x16x32_bf16 v[152:155], v[112:115], v[108:111], v[152:155]
ds_read_b64_tr_b16 v[52:53], v14 offset:0
v_mfma_f32_16x16x32_bf16 v[156:159], v[116:119], v[108:111], v[156:159]
ds_read_b64_tr_b16 v[54:55], v14 offset:4096
v_mfma_f32_16x16x32_bf16 v[148:151], v[116:119], v[104:107], v[148:151]
ds_read_b64_tr_b16 v[56:57], v15 offset:0
v_mfma_f32_16x16x32_bf16 v[140:143], v[116:119], v[100:103], v[140:143]
ds_read_b64_tr_b16 v[58:59], v15 offset:4096
v_mfma_f32_16x16x32_bf16 v[132:135], v[116:119], v[96:99], v[132:135]
ds_read_b64_tr_b16 v[60:61], v16 offset:0
v_mfma_f32_16x16x32_bf16 v[160:163], v[120:123], v[96:99], v[160:163]
ds_read_b64_tr_b16 v[62:63], v16 offset:4096
v_mfma_f32_16x16x32_bf16 v[168:171], v[120:123], v[100:103], v[168:171]
ds_read_b128 v[36:39], v17 offset:50176
v_mfma_f32_16x16x32_bf16 v[176:179], v[120:123], v[104:107], v[176:179]
ds_read_b128 v[40:43], v17 offset:51200
v_mfma_f32_16x16x32_bf16 v[184:187], v[120:123], v[108:111], v[184:187]
ds_read_b128 v[44:47], v17 offset:52224
v_mfma_f32_16x16x32_bf16 v[188:191], v[124:127], v[108:111], v[188:191]
ds_read_b128 v[64:67], v17 offset:57344
v_mfma_f32_16x16x32_bf16 v[180:183], v[124:127], v[104:107], v[180:183]
ds_read_b64_tr_b16 v[80:81], v13 offset:8192
v_mfma_f32_16x16x32_bf16 v[172:175], v[124:127], v[100:103], v[172:175]
ds_read_b64_tr_b16 v[82:83], v13 offset:12288
v_mfma_f32_16x16x32_bf16 v[164:167], v[124:127], v[96:99], v[164:167]
ds_read_b64_tr_b16 v[84:85], v14 offset:8192
v_mfma_f32_16x16x32_bf16 v[128:131], v[208:211], v[192:195], v[128:131]
ds_read_b64_tr_b16 v[86:87], v14 offset:12288
v_mfma_f32_16x16x32_bf16 v[136:139], v[208:211], v[196:199], v[136:139]
ds_read_b64_tr_b16 v[88:89], v15 offset:8192
v_mfma_f32_16x16x32_bf16 v[144:147], v[208:211], v[200:203], v[144:147]
ds_read_b64_tr_b16 v[90:91], v15 offset:12288
v_mfma_f32_16x16x32_bf16 v[152:155], v[208:211], v[204:207], v[152:155]
ds_read_b64_tr_b16 v[92:93], v16 offset:8192
v_mfma_f32_16x16x32_bf16 v[156:159], v[212:215], v[204:207], v[156:159]
ds_read_b64_tr_b16 v[94:95], v16 offset:12288
v_mfma_f32_16x16x32_bf16 v[148:151], v[212:215], v[200:203], v[148:151]
ds_read_b128 v[68:71], v17 offset:58368
v_mfma_f32_16x16x32_bf16 v[140:143], v[212:215], v[196:199], v[140:143]
ds_read_b128 v[72:75], v17 offset:59392
v_mfma_f32_16x16x32_bf16 v[132:135], v[212:215], v[192:195], v[132:135]
ds_read_b128 v[76:79], v17 offset:60416
v_mfma_f32_16x16x32_bf16 v[160:163], v[216:219], v[192:195], v[160:163]
v_mfma_f32_16x16x32_bf16 v[168:171], v[216:219], v[196:199], v[168:171]
v_mfma_f32_16x16x32_bf16 v[176:179], v[216:219], v[200:203], v[176:179]
v_mfma_f32_16x16x32_bf16 v[184:187], v[216:219], v[204:207], v[184:187]
v_mfma_f32_16x16x32_bf16 v[188:191], v[220:223], v[204:207], v[188:191]
v_mfma_f32_16x16x32_bf16 v[180:183], v[220:223], v[200:203], v[180:183]
v_mfma_f32_16x16x32_bf16 v[172:175], v[220:223], v[196:199], v[172:175]
v_mfma_f32_16x16x32_bf16 v[164:167], v[220:223], v[192:195], v[164:167]
s_waitcnt lgkmcnt(0)
s_barrier
v_mfma_f32_16x16x32_bf16 v[128:131], v[48:51], v[32:35], v[128:131]
ds_read_b128 v[96:99], v18 offset:16384
v_mfma_f32_16x16x32_bf16 v[136:139], v[48:51], v[36:39], v[136:139]
ds_read_b64_tr_b16 v[112:113], v25 offset:16384
v_mfma_f32_16x16x32_bf16 v[144:147], v[48:51], v[40:43], v[144:147]
ds_read_b64_tr_b16 v[114:115], v25 offset:20480
v_mfma_f32_16x16x32_bf16 v[152:155], v[48:51], v[44:47], v[152:155]
ds_read_b64_tr_b16 v[116:117], v26 offset:16384
v_mfma_f32_16x16x32_bf16 v[156:159], v[52:55], v[44:47], v[156:159]
ds_read_b64_tr_b16 v[118:119], v26 offset:20480
v_mfma_f32_16x16x32_bf16 v[148:151], v[52:55], v[40:43], v[148:151]
ds_read_b64_tr_b16 v[120:121], v27 offset:16384
v_mfma_f32_16x16x32_bf16 v[140:143], v[52:55], v[36:39], v[140:143]
ds_read_b64_tr_b16 v[122:123], v27 offset:20480
v_mfma_f32_16x16x32_bf16 v[132:135], v[52:55], v[32:35], v[132:135]
ds_read_b64_tr_b16 v[124:125], v28 offset:16384
v_mfma_f32_16x16x32_bf16 v[160:163], v[56:59], v[32:35], v[160:163]
ds_read_b64_tr_b16 v[126:127], v28 offset:20480
v_mfma_f32_16x16x32_bf16 v[168:171], v[56:59], v[36:39], v[168:171]
ds_read_b128 v[100:103], v18 offset:17408
v_mfma_f32_16x16x32_bf16 v[176:179], v[56:59], v[40:43], v[176:179]
ds_read_b128 v[104:107], v18 offset:18432
v_mfma_f32_16x16x32_bf16 v[184:187], v[56:59], v[44:47], v[184:187]
ds_read_b128 v[108:111], v18 offset:19456
v_mfma_f32_16x16x32_bf16 v[188:191], v[60:63], v[44:47], v[188:191]
ds_read_b128 v[192:195], v18 offset:24576
v_mfma_f32_16x16x32_bf16 v[180:183], v[60:63], v[40:43], v[180:183]
ds_read_b64_tr_b16 v[208:209], v25 offset:24576
v_mfma_f32_16x16x32_bf16 v[172:175], v[60:63], v[36:39], v[172:175]
ds_read_b64_tr_b16 v[210:211], v25 offset:28672
v_mfma_f32_16x16x32_bf16 v[164:167], v[60:63], v[32:35], v[164:167]
ds_read_b64_tr_b16 v[212:213], v26 offset:24576
v_mfma_f32_16x16x32_bf16 v[128:131], v[80:83], v[64:67], v[128:131]
ds_read_b64_tr_b16 v[214:215], v26 offset:28672
v_mfma_f32_16x16x32_bf16 v[136:139], v[80:83], v[68:71], v[136:139]
ds_read_b64_tr_b16 v[216:217], v27 offset:24576
v_mfma_f32_16x16x32_bf16 v[144:147], v[80:83], v[72:75], v[144:147]
ds_read_b64_tr_b16 v[218:219], v27 offset:28672
v_mfma_f32_16x16x32_bf16 v[152:155], v[80:83], v[76:79], v[152:155]
ds_read_b64_tr_b16 v[220:221], v28 offset:24576
v_mfma_f32_16x16x32_bf16 v[156:159], v[84:87], v[76:79], v[156:159]
ds_read_b64_tr_b16 v[222:223], v28 offset:28672
v_mfma_f32_16x16x32_bf16 v[148:151], v[84:87], v[72:75], v[148:151]
ds_read_b128 v[196:199], v18 offset:25600
v_mfma_f32_16x16x32_bf16 v[140:143], v[84:87], v[68:71], v[140:143]
ds_read_b128 v[200:203], v18 offset:26624
v_mfma_f32_16x16x32_bf16 v[132:135], v[84:87], v[64:67], v[132:135]
ds_read_b128 v[204:207], v18 offset:27648
v_mfma_f32_16x16x32_bf16 v[160:163], v[88:91], v[64:67], v[160:163]
v_mfma_f32_16x16x32_bf16 v[168:171], v[88:91], v[68:71], v[168:171]
v_mfma_f32_16x16x32_bf16 v[176:179], v[88:91], v[72:75], v[176:179]
v_mfma_f32_16x16x32_bf16 v[184:187], v[88:91], v[76:79], v[184:187]
v_mfma_f32_16x16x32_bf16 v[188:191], v[92:95], v[76:79], v[188:191]
v_mfma_f32_16x16x32_bf16 v[180:183], v[92:95], v[72:75], v[180:183]
v_mfma_f32_16x16x32_bf16 v[172:175], v[92:95], v[68:71], v[172:175]
v_mfma_f32_16x16x32_bf16 v[164:167], v[92:95], v[64:67], v[164:167]
s_waitcnt lgkmcnt(0)
s_barrier
v_mfma_f32_16x16x32_bf16 v[128:131], v[112:115], v[96:99], v[128:131]
ds_read_b128 v[32:35], v18 offset:32768
v_mfma_f32_16x16x32_bf16 v[136:139], v[112:115], v[100:103], v[136:139]
ds_read_b64_tr_b16 v[48:49], v13 offset:49152
v_mfma_f32_16x16x32_bf16 v[144:147], v[112:115], v[104:107], v[144:147]
ds_read_b64_tr_b16 v[50:51], v13 offset:53248
v_mfma_f32_16x16x32_bf16 v[152:155], v[112:115], v[108:111], v[152:155]
ds_read_b64_tr_b16 v[52:53], v14 offset:49152
v_mfma_f32_16x16x32_bf16 v[156:159], v[116:119], v[108:111], v[156:159]
ds_read_b64_tr_b16 v[54:55], v14 offset:53248
v_mfma_f32_16x16x32_bf16 v[148:151], v[116:119], v[104:107], v[148:151]
ds_read_b64_tr_b16 v[56:57], v15 offset:49152
v_mfma_f32_16x16x32_bf16 v[140:143], v[116:119], v[100:103], v[140:143]
ds_read_b64_tr_b16 v[58:59], v15 offset:53248
v_mfma_f32_16x16x32_bf16 v[132:135], v[116:119], v[96:99], v[132:135]
ds_read_b64_tr_b16 v[60:61], v16 offset:49152
v_mfma_f32_16x16x32_bf16 v[160:163], v[120:123], v[96:99], v[160:163]
ds_read_b64_tr_b16 v[62:63], v16 offset:53248
v_mfma_f32_16x16x32_bf16 v[168:171], v[120:123], v[100:103], v[168:171]
ds_read_b128 v[36:39], v18 offset:33792
v_mfma_f32_16x16x32_bf16 v[176:179], v[120:123], v[104:107], v[176:179]
ds_read_b128 v[40:43], v18 offset:34816
v_mfma_f32_16x16x32_bf16 v[184:187], v[120:123], v[108:111], v[184:187]
ds_read_b128 v[44:47], v18 offset:35840
v_mfma_f32_16x16x32_bf16 v[188:191], v[124:127], v[108:111], v[188:191]
ds_read_b128 v[64:67], v18 offset:40960
v_mfma_f32_16x16x32_bf16 v[180:183], v[124:127], v[104:107], v[180:183]
ds_read_b64_tr_b16 v[80:81], v13 offset:57344
v_mfma_f32_16x16x32_bf16 v[172:175], v[124:127], v[100:103], v[172:175]
ds_read_b64_tr_b16 v[82:83], v13 offset:61440
v_mfma_f32_16x16x32_bf16 v[164:167], v[124:127], v[96:99], v[164:167]
ds_read_b64_tr_b16 v[84:85], v14 offset:57344
v_mfma_f32_16x16x32_bf16 v[128:131], v[208:211], v[192:195], v[128:131]
ds_read_b64_tr_b16 v[86:87], v14 offset:61440
v_mfma_f32_16x16x32_bf16 v[136:139], v[208:211], v[196:199], v[136:139]
ds_read_b64_tr_b16 v[88:89], v15 offset:57344
v_mfma_f32_16x16x32_bf16 v[144:147], v[208:211], v[200:203], v[144:147]
ds_read_b64_tr_b16 v[90:91], v15 offset:61440
v_mfma_f32_16x16x32_bf16 v[152:155], v[208:211], v[204:207], v[152:155]
ds_read_b64_tr_b16 v[92:93], v16 offset:57344
v_mfma_f32_16x16x32_bf16 v[156:159], v[212:215], v[204:207], v[156:159]
ds_read_b64_tr_b16 v[94:95], v16 offset:61440
v_mfma_f32_16x16x32_bf16 v[148:151], v[212:215], v[200:203], v[148:151]
ds_read_b128 v[68:71], v18 offset:41984
v_mfma_f32_16x16x32_bf16 v[140:143], v[212:215], v[196:199], v[140:143]
ds_read_b128 v[72:75], v18 offset:43008
v_mfma_f32_16x16x32_bf16 v[132:135], v[212:215], v[192:195], v[132:135]
ds_read_b128 v[76:79], v18 offset:44032
v_mfma_f32_16x16x32_bf16 v[160:163], v[216:219], v[192:195], v[160:163]
v_mfma_f32_16x16x32_bf16 v[168:171], v[216:219], v[196:199], v[168:171]
v_mfma_f32_16x16x32_bf16 v[176:179], v[216:219], v[200:203], v[176:179]
v_mfma_f32_16x16x32_bf16 v[184:187], v[216:219], v[204:207], v[184:187]
v_mfma_f32_16x16x32_bf16 v[188:191], v[220:223], v[204:207], v[188:191]
v_mfma_f32_16x16x32_bf16 v[180:183], v[220:223], v[200:203], v[180:183]
v_mfma_f32_16x16x32_bf16 v[172:175], v[220:223], v[196:199], v[172:175]
v_mfma_f32_16x16x32_bf16 v[164:167], v[220:223], v[192:195], v[164:167]
s_waitcnt lgkmcnt(0)
s_barrier
v_mfma_f32_16x16x32_bf16 v[128:131], v[48:51], v[32:35], v[128:131]
ds_read_b128 v[96:99], v19 offset:0
v_mfma_f32_16x16x32_bf16 v[136:139], v[48:51], v[36:39], v[136:139]
ds_read_b64_tr_b16 v[112:113], v9 offset:0
v_mfma_f32_16x16x32_bf16 v[144:147], v[48:51], v[40:43], v[144:147]
ds_read_b64_tr_b16 v[114:115], v9 offset:4096
v_mfma_f32_16x16x32_bf16 v[152:155], v[48:51], v[44:47], v[152:155]
ds_read_b64_tr_b16 v[116:117], v10 offset:0
v_mfma_f32_16x16x32_bf16 v[156:159], v[52:55], v[44:47], v[156:159]
ds_read_b64_tr_b16 v[118:119], v10 offset:4096
v_mfma_f32_16x16x32_bf16 v[148:151], v[52:55], v[40:43], v[148:151]
ds_read_b64_tr_b16 v[120:121], v11 offset:0
v_mfma_f32_16x16x32_bf16 v[140:143], v[52:55], v[36:39], v[140:143]
ds_read_b64_tr_b16 v[122:123], v11 offset:4096
v_mfma_f32_16x16x32_bf16 v[132:135], v[52:55], v[32:35], v[132:135]
ds_read_b64_tr_b16 v[124:125], v12 offset:0
v_mfma_f32_16x16x32_bf16 v[160:163], v[56:59], v[32:35], v[160:163]
ds_read_b64_tr_b16 v[126:127], v12 offset:4096
v_mfma_f32_16x16x32_bf16 v[168:171], v[56:59], v[36:39], v[168:171]
ds_read_b128 v[100:103], v19 offset:1024
v_mfma_f32_16x16x32_bf16 v[176:179], v[56:59], v[40:43], v[176:179]
ds_read_b128 v[104:107], v19 offset:2048
v_mfma_f32_16x16x32_bf16 v[184:187], v[56:59], v[44:47], v[184:187]
ds_read_b128 v[108:111], v19 offset:3072
v_mfma_f32_16x16x32_bf16 v[188:191], v[60:63], v[44:47], v[188:191]
ds_read_b128 v[192:195], v19 offset:8192
v_mfma_f32_16x16x32_bf16 v[180:183], v[60:63], v[40:43], v[180:183]
ds_read_b64_tr_b16 v[208:209], v9 offset:8192
v_mfma_f32_16x16x32_bf16 v[172:175], v[60:63], v[36:39], v[172:175]
ds_read_b64_tr_b16 v[210:211], v9 offset:12288
v_mfma_f32_16x16x32_bf16 v[164:167], v[60:63], v[32:35], v[164:167]
ds_read_b64_tr_b16 v[212:213], v10 offset:8192
v_mfma_f32_16x16x32_bf16 v[128:131], v[80:83], v[64:67], v[128:131]
ds_read_b64_tr_b16 v[214:215], v10 offset:12288
v_mfma_f32_16x16x32_bf16 v[136:139], v[80:83], v[68:71], v[136:139]
ds_read_b64_tr_b16 v[216:217], v11 offset:8192
v_mfma_f32_16x16x32_bf16 v[144:147], v[80:83], v[72:75], v[144:147]
ds_read_b64_tr_b16 v[218:219], v11 offset:12288
v_mfma_f32_16x16x32_bf16 v[152:155], v[80:83], v[76:79], v[152:155]
ds_read_b64_tr_b16 v[220:221], v12 offset:8192
v_mfma_f32_16x16x32_bf16 v[156:159], v[84:87], v[76:79], v[156:159]
ds_read_b64_tr_b16 v[222:223], v12 offset:12288
v_mfma_f32_16x16x32_bf16 v[148:151], v[84:87], v[72:75], v[148:151]
ds_read_b128 v[196:199], v19 offset:9216
v_mfma_f32_16x16x32_bf16 v[140:143], v[84:87], v[68:71], v[140:143]
ds_read_b128 v[200:203], v19 offset:10240
v_mfma_f32_16x16x32_bf16 v[132:135], v[84:87], v[64:67], v[132:135]
ds_read_b128 v[204:207], v19 offset:11264
v_mfma_f32_16x16x32_bf16 v[160:163], v[88:91], v[64:67], v[160:163]
v_mfma_f32_16x16x32_bf16 v[168:171], v[88:91], v[68:71], v[168:171]
v_mfma_f32_16x16x32_bf16 v[176:179], v[88:91], v[72:75], v[176:179]
v_mfma_f32_16x16x32_bf16 v[184:187], v[88:91], v[76:79], v[184:187]
v_mfma_f32_16x16x32_bf16 v[188:191], v[92:95], v[76:79], v[188:191]
v_mfma_f32_16x16x32_bf16 v[180:183], v[92:95], v[72:75], v[180:183]
v_mfma_f32_16x16x32_bf16 v[172:175], v[92:95], v[68:71], v[172:175]
v_mfma_f32_16x16x32_bf16 v[164:167], v[92:95], v[64:67], v[164:167]
s_sub_u32 s41, s41, 1
s_cmp_lg_u32 s41, 0
s_cbranch_scc1 Lk4_136
s_waitcnt lgkmcnt(0)
s_barrier
v_mfma_f32_16x16x32_bf16 v[128:131], v[112:115], v[96:99], v[128:131]
ds_read_b128 v[32:35], v17 offset:16384
v_mfma_f32_16x16x32_bf16 v[136:139], v[112:115], v[100:103], v[136:139]
ds_read_b64_tr_b16 v[48:49], v224 offset:32768
v_mfma_f32_16x16x32_bf16 v[144:147], v[112:115], v[104:107], v[144:147]
ds_read_b64_tr_b16 v[50:51], v224 offset:34816
v_mfma_f32_16x16x32_bf16 v[152:155], v[112:115], v[108:111], v[152:155]
ds_read_b64_tr_b16 v[52:53], v225 offset:32768
v_mfma_f32_16x16x32_bf16 v[156:159], v[116:119], v[108:111], v[156:159]
ds_read_b64_tr_b16 v[54:55], v225 offset:34816
v_mfma_f32_16x16x32_bf16 v[148:151], v[116:119], v[104:107], v[148:151]
ds_read_b128 v[36:39], v17 offset:17408
v_mfma_f32_16x16x32_bf16 v[140:143], v[116:119], v[100:103], v[140:143]
ds_read_b128 v[40:43], v17 offset:18432
v_mfma_f32_16x16x32_bf16 v[132:135], v[116:119], v[96:99], v[132:135]
ds_read_b128 v[44:47], v17 offset:19456
v_mfma_f32_16x16x32_bf16 v[160:163], v[120:123], v[96:99], v[160:163]
ds_read_b128 v[64:67], v17 offset:24576
v_mfma_f32_16x16x32_bf16 v[168:171], v[120:123], v[100:103], v[168:171]
ds_read_b64_tr_b16 v[80:81], v224 offset:36864
v_mfma_f32_16x16x32_bf16 v[176:179], v[120:123], v[104:107], v[176:179]
ds_read_b64_tr_b16 v[82:83], v224 offset:38912
v_mfma_f32_16x16x32_bf16 v[184:187], v[120:123], v[108:111], v[184:187]
ds_read_b64_tr_b16 v[84:85], v225 offset:36864
v_mfma_f32_16x16x32_bf16 v[188:191], v[124:127], v[108:111], v[188:191]
ds_read_b64_tr_b16 v[86:87], v225 offset:38912
v_mfma_f32_16x16x32_bf16 v[180:183], v[124:127], v[104:107], v[180:183]
ds_read_b128 v[68:71], v17 offset:25600
v_mfma_f32_16x16x32_bf16 v[172:175], v[124:127], v[100:103], v[172:175]
ds_read_b128 v[72:75], v17 offset:26624
v_mfma_f32_16x16x32_bf16 v[164:167], v[124:127], v[96:99], v[164:167]
ds_read_b128 v[76:79], v17 offset:27648
v_mfma_f32_16x16x32_bf16 v[128:131], v[208:211], v[192:195], v[128:131]
v_mfma_f32_16x16x32_bf16 v[136:139], v[208:211], v[196:199], v[136:139]
v_mfma_f32_16x16x32_bf16 v[144:147], v[208:211], v[200:203], v[144:147]
v_mfma_f32_16x16x32_bf16 v[152:155], v[208:211], v[204:207], v[152:155]
v_mfma_f32_16x16x32_bf16 v[156:159], v[212:215], v[204:207], v[156:159]
s_branch Lov_12
.p2align 12
.fill 96, 4, 0xbf800000
Lst_12_0:
s_branch Lwr_172
Lst_12_1:
s_branch Lst_16_0
s_nop 0
Lov_12:
v_mfma_f32_16x16x32_bf16 v[148:151], v[212:215], v[200:203], v[148:151]
v_mfma_f32_16x16x32_bf16 v[140:143], v[212:215], v[196:199], v[140:143]
v_mfma_f32_16x16x32_bf16 v[132:135], v[212:215], v[192:195], v[132:135]
v_mfma_f32_16x16x32_bf16 v[160:163], v[216:219], v[192:195], v[160:163]
v_mfma_f32_16x16x32_bf16 v[168:171], v[216:219], v[196:199], v[168:171]
v_mfma_f32_16x16x32_bf16 v[176:179], v[216:219], v[200:203], v[176:179]
v_mfma_f32_16x16x32_bf16 v[184:187], v[216:219], v[204:207], v[184:187]
v_mfma_f32_16x16x32_bf16 v[188:191], v[220:223], v[204:207], v[188:191]
v_mfma_f32_16x16x32_bf16 v[180:183], v[220:223], v[200:203], v[180:183]
v_mfma_f32_16x16x32_bf16 v[172:175], v[220:223], v[196:199], v[172:175]
v_mfma_f32_16x16x32_bf16 v[164:167], v[220:223], v[192:195], v[164:167]
s_waitcnt lgkmcnt(0)
s_barrier
v_mfma_f32_16x16x32_bf16 v[128:131], v[48:51], v[32:35], v[128:131]
ds_read_b128 v[96:99], v17 offset:49152
ds_read_b64_tr_b16 v[112:113], v226 offset:0
v_mfma_f32_16x16x32_bf16 v[136:139], v[48:51], v[36:39], v[136:139]
ds_read_b64_tr_b16 v[114:115], v226 offset:2048
ds_read_b64_tr_b16 v[116:117], v227 offset:0
v_mfma_f32_16x16x32_bf16 v[144:147], v[48:51], v[40:43], v[144:147]
ds_read_b64_tr_b16 v[118:119], v227 offset:2048
ds_read_b128 v[100:103], v17 offset:50176
v_mfma_f32_16x16x32_bf16 v[152:155], v[48:51], v[44:47], v[152:155]
ds_read_b128 v[104:107], v17 offset:51200
ds_read_b128 v[108:111], v17 offset:52224
v_mfma_f32_16x16x32_bf16 v[156:159], v[52:55], v[44:47], v[156:159]
ds_read_b128 v[192:195], v17 offset:57344
v_mfma_f32_16x16x32_bf16 v[148:151], v[52:55], v[40:43], v[148:151]
ds_read_b64_tr_b16 v[208:209], v226 offset:4096
v_mfma_f32_16x16x32_bf16 v[140:143], v[52:55], v[36:39], v[140:143]
ds_read_b64_tr_b16 v[210:211], v226 offset:6144
v_cvt_pk_bf16_f32 v160, v160, v161
v_cvt_pk_bf16_f32 v161, v162, v163
v_mfma_f32_16x16x32_bf16 v[132:135], v[52:55], v[32:35], v[132:135]
ds_read_b64_tr_b16 v[212:213], v227 offset:4096
v_cvt_pk_bf16_f32 v162, v164, v165
v_cvt_pk_bf16_f32 v163, v166, v167
v_mfma_f32_16x16x32_bf16 v[128:131], v[80:83], v[64:67], v[128:131]
ds_read_b64_tr_b16 v[214:215], v227 offset:6144
v_cvt_pk_bf16_f32 v164, v168, v169
v_cvt_pk_bf16_f32 v165, v170, v171
v_mfma_f32_16x16x32_bf16 v[136:139], v[80:83], v[68:71], v[136:139]
ds_read_b128 v[196:199], v17 offset:58368
v_cvt_pk_bf16_f32 v166, v172, v173
v_cvt_pk_bf16_f32 v167, v174, v175
v_mfma_f32_16x16x32_bf16 v[144:147], v[80:83], v[72:75], v[144:147]
ds_read_b128 v[200:203], v17 offset:59392
v_cvt_pk_bf16_f32 v168, v176, v177
v_cvt_pk_bf16_f32 v169, v178, v179
v_mfma_f32_16x16x32_bf16 v[152:155], v[80:83], v[76:79], v[152:155]
ds_read_b128 v[204:207], v17 offset:60416
v_cvt_pk_bf16_f32 v170, v180, v181
v_cvt_pk_bf16_f32 v171, v182, v183
v_mfma_f32_16x16x32_bf16 v[156:159], v[84:87], v[76:79], v[156:159]
v_cvt_pk_bf16_f32 v172, v184, v185
v_cvt_pk_bf16_f32 v173, v186, v187
v_mfma_f32_16x16x32_bf16 v[148:151], v[84:87], v[72:75], v[148:151]
v_cvt_pk_bf16_f32 v174, v188, v189
v_cvt_pk_bf16_f32 v175, v190, v191
v_mfma_f32_16x16x32_bf16 v[140:143], v[84:87], v[68:71], v[140:143]
v_mfma_f32_16x16x32_bf16 v[132:135], v[84:87], v[64:67], v[132:135]
buffer_store_dwordx4 v[160:163], v2, s[84:87], s45 offen offset:0 sc1
s_waitcnt lgkmcnt(0)
s_barrier
v_mfma_f32_16x16x32_bf16 v[128:131], v[112:115], v[96:99], v[128:131]
ds_read_b128 v[32:35], v18 offset:16384
ds_read_b64_tr_b16 v[48:49], v228 offset:16384
v_mfma_f32_16x16x32_bf16 v[136:139], v[112:115], v[100:103], v[136:139]
ds_read_b64_tr_b16 v[50:51], v228 offset:18432
ds_read_b64_tr_b16 v[52:53], v229 offset:16384
v_mfma_f32_16x16x32_bf16 v[144:147], v[112:115], v[104:107], v[144:147]
ds_read_b64_tr_b16 v[54:55], v229 offset:18432
ds_read_b128 v[36:39], v18 offset:17408
v_mfma_f32_16x16x32_bf16 v[152:155], v[112:115], v[108:111], v[152:155]
ds_read_b128 v[40:43], v18 offset:18432
ds_read_b128 v[44:47], v18 offset:19456
v_mfma_f32_16x16x32_bf16 v[156:159], v[116:119], v[108:111], v[156:159]
ds_read_b128 v[64:67], v18 offset:24576
v_mfma_f32_16x16x32_bf16 v[148:151], v[116:119], v[104:107], v[148:151]
ds_read_b64_tr_b16 v[80:81], v228 offset:20480
v_mfma_f32_16x16x32_bf16 v[140:143], v[116:119], v[100:103], v[140:143]
ds_read_b64_tr_b16 v[82:83], v228 offset:22528
v_mfma_f32_16x16x32_bf16 v[132:135], v[116:119], v[96:99], v[132:135]
ds_read_b64_tr_b16 v[84:85], v229 offset:20480
v_mfma_f32_16x16x32_bf16 v[128:131], v[208:211], v[192:195], v[128:131]
ds_read_b64_tr_b16 v[86:87], v229 offset:22528
buffer_store_dwordx4 v[164:167], v2, s[84:87], s45 offen offset:1024 sc1
v_mfma_f32_16x16x32_bf16 v[136:139], v[208:211], v[196:199], v[136:139]
ds_read_b128 v[68:71], v18 offset:25600
v_mfma_f32_16x16x32_bf16 v[144:147], v[208:211], v[200:203], v[144:147]
ds_read_b128 v[72:75], v18 offset:26624
v_mfma_f32_16x16x32_bf16 v[152:155], v[208:211], v[204:207], v[152:155]
ds_read_b128 v[76:79], v18 offset:27648
v_mfma_f32_16x16x32_bf16 v[156:159], v[212:215], v[204:207], v[156:159]
v_mfma_f32_16x16x32_bf16 v[148:151], v[212:215], v[200:203], v[148:151]
v_mfma_f32_16x16x32_bf16 v[140:143], v[212:215], v[196:199], v[140:143]
v_mfma_f32_16x16x32_bf16 v[132:135], v[212:215], v[192:195], v[132:135]
s_waitcnt lgkmcnt(0)
s_barrier
v_mfma_f32_16x16x32_bf16 v[128:131], v[48:51], v[32:35], v[128:131]
ds_read_b128 v[96:99], v18 offset:32768
ds_read_b64_tr_b16 v[112:113], v226 offset:49152
v_mfma_f32_16x16x32_bf16 v[136:139], v[48:51], v[36:39], v[136:139]
ds_read_b64_tr_b16 v[114:115], v226 offset:51200
ds_read_b64_tr_b16 v[116:117], v227 offset:49152
v_mfma_f32_16x16x32_bf16 v[144:147], v[48:51], v[40:43], v[144:147]
ds_read_b64_tr_b16 v[118:119], v227 offset:51200
ds_read_b128 v[100:103], v18 offset:33792
v_mfma_f32_16x16x32_bf16 v[152:155], v[48:51], v[44:47], v[152:155]
ds_read_b128 v[104:107], v18 offset:34816
ds_read_b128 v[108:111], v18 offset:35840
v_mfma_f32_16x16x32_bf16 v[156:159], v[52:55], v[44:47], v[156:159]
ds_read_b128 v[192:195], v18 offset:40960
v_mfma_f32_16x16x32_bf16 v[148:151], v[52:55], v[40:43], v[148:151]
ds_read_b64_tr_b16 v[208:209], v226 offset:53248
v_mfma_f32_16x16x32_bf16 v[140:143], v[52:55], v[36:39], v[140:143]
ds_read_b64_tr_b16 v[210:211], v226 offset:55296
v_mfma_f32_16x16x32_bf16 v[132:135], v[52:55], v[32:35], v[132:135]
ds_read_b64_tr_b16 v[212:213], v227 offset:53248
v_mfma_f32_16x16x32_bf16 v[128:131], v[80:83], v[64:67], v[128:131]
ds_read_b64_tr_b16 v[214:215], v227 offset:55296
buffer_store_dwordx4 v[168:171], v2, s[84:87], s45 offen offset:2048 sc1
v_mfma_f32_16x16x32_bf16 v[136:139], v[80:83], v[68:71], v[136:139]
ds_read_b128 v[196:199], v18 offset:41984
v_mfma_f32_16x16x32_bf16 v[144:147], v[80:83], v[72:75], v[144:147]
ds_read_b128 v[200:203], v18 offset:43008
v_mfma_f32_16x16x32_bf16 v[152:155], v[80:83], v[76:79], v[152:155]
ds_read_b128 v[204:207], v18 offset:44032
v_mfma_f32_16x16x32_bf16 v[156:159], v[84:87], v[76:79], v[156:159]
v_mfma_f32_16x16x32_bf16 v[148:151], v[84:87], v[72:75], v[148:151]
v_mfma_f32_16x16x32_bf16 v[140:143], v[84:87], v[68:71], v[140:143]
v_mfma_f32_16x16x32_bf16 v[132:135], v[84:87], v[64:67], v[132:135]
s_waitcnt lgkmcnt(0)
s_barrier
v_mfma_f32_16x16x32_bf16 v[128:131], v[112:115], v[96:99], v[128:131]
ds_read_b128 v[32:35], v19 offset:0
ds_read_b64_tr_b16 v[48:49], v224 offset:0
v_mfma_f32_16x16x32_bf16 v[136:139], v[112:115], v[100:103], v[136:139]
ds_read_b64_tr_b16 v[50:51], v224 offset:2048
ds_read_b64_tr_b16 v[52:53], v225 offset:0
v_mfma_f32_16x16x32_bf16 v[144:147], v[112:115], v[104:107], v[144:147]
ds_read_b64_tr_b16 v[54:55], v225 offset:2048
ds_read_b128 v[36:39], v19 offset:1024
v_mfma_f32_16x16x32_bf16 v[152:155], v[112:115], v[108:111], v[152:155]
ds_read_b128 v[40:43], v19 offset:2048
ds_read_b128 v[44:47], v19 offset:3072
v_mfma_f32_16x16x32_bf16 v[156:159], v[116:119], v[108:111], v[156:159]
ds_read_b128 v[64:67], v19 offset:8192
v_mfma_f32_16x16x32_bf16 v[148:151], v[116:119], v[104:107], v[148:151]
ds_read_b64_tr_b16 v[80:81], v224 offset:4096
v_mfma_f32_16x16x32_bf16 v[140:143], v[116:119], v[100:103], v[140:143]
ds_read_b64_tr_b16 v[82:83], v224 offset:6144
v_mfma_f32_16x16x32_bf16 v[132:135], v[116:119], v[96:99], v[132:135]
ds_read_b64_tr_b16 v[84:85], v225 offset:4096
v_mfma_f32_16x16x32_bf16 v[128:131], v[208:211], v[192:195], v[128:131]
ds_read_b64_tr_b16 v[86:87], v225 offset:6144
buffer_store_dwordx4 v[172:175], v2, s[84:87], s45 offen offset:3072 sc1
v_mfma_f32_16x16x32_bf16 v[136:139], v[208:211], v[196:199], v[136:139]
ds_read_b128 v[68:71], v19 offset:9216
v_mfma_f32_16x16x32_bf16 v[144:147], v[208:211], v[200:203], v[144:147]
ds_read_b128 v[72:75], v19 offset:10240
v_mfma_f32_16x16x32_bf16 v[152:155], v[208:211], v[204:207], v[152:155]
ds_read_b128 v[76:79], v19 offset:11264
v_mfma_f32_16x16x32_bf16 v[156:159], v[212:215], v[204:207], v[156:159]
v_mfma_f32_16x16x32_bf16 v[148:151], v[212:215], v[200:203], v[148:151]
v_mfma_f32_16x16x32_bf16 v[140:143], v[212:215], v[196:199], v[140:143]
v_mfma_f32_16x16x32_bf16 v[132:135], v[212:215], v[192:195], v[132:135]
s_waitcnt lgkmcnt(0)
s_barrier
v_mfma_f32_16x16x32_bf16 v[128:131], v[48:51], v[32:35], v[128:131]
ds_read_b128 v[96:99], v17 offset:16384
ds_read_b64_tr_b16 v[112:113], v224 offset:32768
v_mfma_f32_16x16x32_bf16 v[136:139], v[48:51], v[36:39], v[136:139]
ds_read_b64_tr_b16 v[114:115], v224 offset:34816
ds_read_b64_tr_b16 v[116:117], v225 offset:32768
v_mfma_f32_16x16x32_bf16 v[144:147], v[48:51], v[40:43], v[144:147]
ds_read_b64_tr_b16 v[118:119], v225 offset:34816
ds_read_b128 v[100:103], v17 offset:17408
v_mfma_f32_16x16x32_bf16 v[152:155], v[48:51], v[44:47], v[152:155]
ds_read_b128 v[104:107], v17 offset:18432
ds_read_b128 v[108:111], v17 offset:19456
v_mfma_f32_16x16x32_bf16 v[156:159], v[52:55], v[44:47], v[156:159]
ds_read_b128 v[192:195], v17 offset:24576
v_mfma_f32_16x16x32_bf16 v[148:151], v[52:55], v[40:43], v[148:151]
ds_read_b64_tr_b16 v[208:209], v224 offset:36864
v_mfma_f32_16x16x32_bf16 v[140:143], v[52:55], v[36:39], v[140:143]
ds_read_b64_tr_b16 v[210:211], v224 offset:38912
v_mfma_f32_16x16x32_bf16 v[132:135], v[52:55], v[32:35], v[132:135]
ds_read_b64_tr_b16 v[212:213], v225 offset:36864
v_mfma_f32_16x16x32_bf16 v[128:131], v[80:83], v[64:67], v[128:131]
ds_read_b64_tr_b16 v[214:215], v225 offset:38912
v_mfma_f32_16x16x32_bf16 v[136:139], v[80:83], v[68:71], v[136:139]
ds_read_b128 v[196:199], v17 offset:25600
v_mfma_f32_16x16x32_bf16 v[144:147], v[80:83], v[72:75], v[144:147]
ds_read_b128 v[200:203], v17 offset:26624
v_mfma_f32_16x16x32_bf16 v[152:155], v[80:83], v[76:79], v[152:155]
ds_read_b128 v[204:207], v17 offset:27648
v_mfma_f32_16x16x32_bf16 v[156:159], v[84:87], v[76:79], v[156:159]
v_mfma_f32_16x16x32_bf16 v[148:151], v[84:87], v[72:75], v[148:151]
v_mfma_f32_16x16x32_bf16 v[140:143], v[84:87], v[68:71], v[140:143]
v_mfma_f32_16x16x32_bf16 v[132:135], v[84:87], v[64:67], v[132:135]
s_waitcnt vmcnt(0)
s_waitcnt lgkmcnt(0)
s_barrier
v_mfma_f32_16x16x32_bf16 v[128:131], v[112:115], v[96:99], v[128:131]
ds_read_b128 v[32:35], v17 offset:49152
ds_read_b64_tr_b16 v[48:49], v226 offset:0
v_mfma_f32_16x16x32_bf16 v[136:139], v[112:115], v[100:103], v[136:139]
ds_read_b64_tr_b16 v[50:51], v226 offset:2048
ds_read_b64_tr_b16 v[52:53], v227 offset:0
v_mfma_f32_16x16x32_bf16 v[144:147], v[112:115], v[104:107], v[144:147]
ds_read_b64_tr_b16 v[54:55], v227 offset:2048
ds_read_b128 v[36:39], v17 offset:50176
v_mfma_f32_16x16x32_bf16 v[152:155], v[112:115], v[108:111], v[152:155]
ds_read_b128 v[40:43], v17 offset:51200
ds_read_b128 v[44:47], v17 offset:52224
v_mfma_f32_16x16x32_bf16 v[156:159], v[116:119], v[108:111], v[156:159]
ds_read_b128 v[64:67], v17 offset:57344
v_mfma_f32_16x16x32_bf16 v[148:151], v[116:119], v[104:107], v[148:151]
ds_read_b64_tr_b16 v[80:81], v226 offset:4096
v_mfma_f32_16x16x32_bf16 v[140:143], v[116:119], v[100:103], v[140:143]
ds_read_b64_tr_b16 v[82:83], v226 offset:6144
v_mfma_f32_16x16x32_bf16 v[132:135], v[116:119], v[96:99], v[132:135]
ds_read_b64_tr_b16 v[84:85], v227 offset:4096
v_mfma_f32_16x16x32_bf16 v[128:131], v[208:211], v[192:195], v[128:131]
ds_read_b64_tr_b16 v[86:87], v227 offset:6144
v_mfma_f32_16x16x32_bf16 v[136:139], v[208:211], v[196:199], v[136:139]
ds_read_b128 v[68:71], v17 offset:58368
v_mfma_f32_16x16x32_bf16 v[144:147], v[208:211], v[200:203], v[144:147]
ds_read_b128 v[72:75], v17 offset:59392
v_mfma_f32_16x16x32_bf16 v[152:155], v[208:211], v[204:207], v[152:155]
ds_read_b128 v[76:79], v17 offset:60416
v_mfma_f32_16x16x32_bf16 v[156:159], v[212:215], v[204:207], v[156:159]
v_mfma_f32_16x16x32_bf16 v[148:151], v[212:215], v[200:203], v[148:151]
v_mfma_f32_16x16x32_bf16 v[140:143], v[212:215], v[196:199], v[140:143]
v_mfma_f32_16x16x32_bf16 v[132:135], v[212:215], v[192:195], v[132:135]
s_waitcnt lgkmcnt(0)
s_barrier
v_mfma_f32_16x16x32_bf16 v[128:131], v[48:51], v[32:35], v[128:131]
ds_read_b128 v[96:99], v18 offset:16384
ds_read_b64_tr_b16 v[112:113], v228 offset:16384
v_mfma_f32_16x16x32_bf16 v[136:139], v[48:51], v[36:39], v[136:139]
ds_read_b64_tr_b16 v[114:115], v228 offset:18432
ds_read_b64_tr_b16 v[116:117], v229 offset:16384
v_mfma_f32_16x16x32_bf16 v[144:147], v[48:51], v[40:43], v[144:147]
ds_read_b64_tr_b16 v[118:119], v229 offset:18432
ds_read_b128 v[100:103], v18 offset:17408
v_mfma_f32_16x16x32_bf16 v[152:155], v[48:51], v[44:47], v[152:155]
ds_read_b128 v[104:107], v18 offset:18432
ds_read_b128 v[108:111], v18 offset:19456
v_mfma_f32_16x16x32_bf16 v[156:159], v[52:55], v[44:47], v[156:159]
ds_read_b128 v[192:195], v18 offset:24576
v_mfma_f32_16x16x32_bf16 v[148:151], v[52:55], v[40:43], v[148:151]
ds_read_b64_tr_b16 v[208:209], v228 offset:20480
v_mfma_f32_16x16x32_bf16 v[140:143], v[52:55], v[36:39], v[140:143]
ds_read_b64_tr_b16 v[210:211], v228 offset:22528
v_mfma_f32_16x16x32_bf16 v[132:135], v[52:55], v[32:35], v[132:135]
ds_read_b64_tr_b16 v[212:213], v229 offset:20480
v_mfma_f32_16x16x32_bf16 v[128:131], v[80:83], v[64:67], v[128:131]
ds_read_b64_tr_b16 v[214:215], v229 offset:22528
v_mfma_f32_16x16x32_bf16 v[136:139], v[80:83], v[68:71], v[136:139]
ds_read_b128 v[196:199], v18 offset:25600
v_mfma_f32_16x16x32_bf16 v[144:147], v[80:83], v[72:75], v[144:147]
ds_read_b128 v[200:203], v18 offset:26624
v_mfma_f32_16x16x32_bf16 v[152:155], v[80:83], v[76:79], v[152:155]
ds_read_b128 v[204:207], v18 offset:27648
v_mfma_f32_16x16x32_bf16 v[156:159], v[84:87], v[76:79], v[156:159]
v_mfma_f32_16x16x32_bf16 v[148:151], v[84:87], v[72:75], v[148:151]
v_mfma_f32_16x16x32_bf16 v[140:143], v[84:87], v[68:71], v[140:143]
v_mfma_f32_16x16x32_bf16 v[132:135], v[84:87], v[64:67], v[132:135]
s_waitcnt lgkmcnt(0)
s_barrier
v_mfma_f32_16x16x32_bf16 v[128:131], v[112:115], v[96:99], v[128:131]
ds_read_b128 v[32:35], v18 offset:32768
ds_read_b64_tr_b16 v[48:49], v226 offset:49152
v_mfma_f32_16x16x32_bf16 v[136:139], v[112:115], v[100:103], v[136:139]
ds_read_b64_tr_b16 v[50:51], v226 offset:51200
ds_read_b64_tr_b16 v[52:53], v227 offset:49152
v_mfma_f32_16x16x32_bf16 v[144:147], v[112:115], v[104:107], v[144:147]
ds_read_b64_tr_b16 v[54:55], v227 offset:51200
ds_read_b128 v[36:39], v18 offset:33792
v_mfma_f32_16x16x32_bf16 v[152:155], v[112:115], v[108:111], v[152:155]
ds_read_b128 v[40:43], v18 offset:34816
ds_read_b128 v[44:47], v18 offset:35840
v_mfma_f32_16x16x32_bf16 v[156:159], v[116:119], v[108:111], v[156:159]
ds_read_b128 v[64:67], v18 offset:40960
v_mfma_f32_16x16x32_bf16 v[148:151], v[116:119], v[104:107], v[148:151]
ds_read_b64_tr_b16 v[80:81], v226 offset:53248
v_mfma_f32_16x16x32_bf16 v[140:143], v[116:119], v[100:103], v[140:143]
ds_read_b64_tr_b16 v[82:83], v226 offset:55296
v_mfma_f32_16x16x32_bf16 v[132:135], v[116:119], v[96:99], v[132:135]
ds_read_b64_tr_b16 v[84:85], v227 offset:53248
v_mfma_f32_16x16x32_bf16 v[128:131], v[208:211], v[192:195], v[128:131]
ds_read_b64_tr_b16 v[86:87], v227 offset:55296
v_mfma_f32_16x16x32_bf16 v[136:139], v[208:211], v[196:199], v[136:139]
ds_read_b128 v[68:71], v18 offset:41984
v_mfma_f32_16x16x32_bf16 v[144:147], v[208:211], v[200:203], v[144:147]
ds_read_b128 v[72:75], v18 offset:43008
v_mfma_f32_16x16x32_bf16 v[152:155], v[208:211], v[204:207], v[152:155]
ds_read_b128 v[76:79], v18 offset:44032
v_mfma_f32_16x16x32_bf16 v[156:159], v[212:215], v[204:207], v[156:159]
v_mfma_f32_16x16x32_bf16 v[148:151], v[212:215], v[200:203], v[148:151]
v_mfma_f32_16x16x32_bf16 v[140:143], v[212:215], v[196:199], v[140:143]
v_mfma_f32_16x16x32_bf16 v[132:135], v[212:215], v[192:195], v[132:135]
s_waitcnt lgkmcnt(0)
s_barrier
buffer_load_dwordx4 v[232:235], v2, s[84:87], s46 offen offset:0 sc1
buffer_load_dwordx4 v[236:239], v2, s[84:87], s46 offen offset:1024 sc1
buffer_load_dwordx4 v[240:243], v2, s[84:87], s46 offen offset:2048 sc1
buffer_load_dwordx4 v[244:247], v2, s[84:87], s46 offen offset:3072 sc1
v_mfma_f32_16x16x32_bf16 v[128:131], v[48:51], v[32:35], v[128:131]
ds_read_b128 v[96:99], v19 offset:0
ds_read_b64_tr_b16 v[112:113], v224 offset:0
v_mfma_f32_16x16x32_bf16 v[136:139], v[48:51], v[36:39], v[136:139]
ds_read_b64_tr_b16 v[114:115], v224 offset:2048
ds_read_b64_tr_b16 v[116:117], v225 offset:0
v_mfma_f32_16x16x32_bf16 v[144:147], v[48:51], v[40:43], v[144:147]
ds_read_b64_tr_b16 v[118:119], v225 offset:2048
ds_read_b128 v[100:103], v19 offset:1024
v_mfma_f32_16x16x32_bf16 v[152:155], v[48:51], v[44:47], v[152:155]
ds_read_b128 v[104:107], v19 offset:2048
ds_read_b128 v[108:111], v19 offset:3072
v_mfma_f32_16x16x32_bf16 v[156:159], v[52:55], v[44:47], v[156:159]
ds_read_b128 v[192:195], v19 offset:8192
v_mfma_f32_16x16x32_bf16 v[148:151], v[52:55], v[40:43], v[148:151]
ds_read_b64_tr_b16 v[208:209], v224 offset:4096
v_mfma_f32_16x16x32_bf16 v[140:143], v[52:55], v[36:39], v[140:143]
ds_read_b64_tr_b16 v[210:211], v224 offset:6144
v_mfma_f32_16x16x32_bf16 v[132:135], v[52:55], v[32:35], v[132:135]
ds_read_b64_tr_b16 v[212:213], v225 offset:4096
v_mfma_f32_16x16x32_bf16 v[128:131], v[80:83], v[64:67], v[128:131]
ds_read_b64_tr_b16 v[214:215], v225 offset:6144
v_mfma_f32_16x16x32_bf16 v[136:139], v[80:83], v[68:71], v[136:139]
ds_read_b128 v[196:199], v19 offset:9216
v_mfma_f32_16x16x32_bf16 v[144:147], v[80:83], v[72:75], v[144:147]
ds_read_b128 v[200:203], v19 offset:10240
v_mfma_f32_16x16x32_bf16 v[152:155], v[80:83], v[76:79], v[152:155]
ds_read_b128 v[204:207], v19 offset:11264
v_mfma_f32_16x16x32_bf16 v[156:159], v[84:87], v[76:79], v[156:159]
v_mfma_f32_16x16x32_bf16 v[148:151], v[84:87], v[72:75], v[148:151]
v_mfma_f32_16x16x32_bf16 v[140:143], v[84:87], v[68:71], v[140:143]
v_mfma_f32_16x16x32_bf16 v[132:135], v[84:87], v[64:67], v[132:135]
s_waitcnt lgkmcnt(0)
s_barrier
v_mfma_f32_16x16x32_bf16 v[128:131], v[112:115], v[96:99], v[128:131]
ds_read_b128 v[32:35], v17 offset:16384
ds_read_b64_tr_b16 v[48:49], v224 offset:32768
v_mfma_f32_16x16x32_bf16 v[136:139], v[112:115], v[100:103], v[136:139]
ds_read_b64_tr_b16 v[50:51], v224 offset:34816
ds_read_b64_tr_b16 v[52:53], v225 offset:32768
v_mfma_f32_16x16x32_bf16 v[144:147], v[112:115], v[104:107], v[144:147]
ds_read_b64_tr_b16 v[54:55], v225 offset:34816
ds_read_b128 v[36:39], v17 offset:17408
v_mfma_f32_16x16x32_bf16 v[152:155], v[112:115], v[108:111], v[152:155]
ds_read_b128 v[40:43], v17 offset:18432
ds_read_b128 v[44:47], v17 offset:19456
v_mfma_f32_16x16x32_bf16 v[156:159], v[116:119], v[108:111], v[156:159]
ds_read_b128 v[64:67], v17 offset:24576
v_mfma_f32_16x16x32_bf16 v[148:151], v[116:119], v[104:107], v[148:151]
ds_read_b64_tr_b16 v[80:81], v224 offset:36864
v_mfma_f32_16x16x32_bf16 v[140:143], v[116:119], v[100:103], v[140:143]
ds_read_b64_tr_b16 v[82:83], v224 offset:38912
v_mfma_f32_16x16x32_bf16 v[132:135], v[116:119], v[96:99], v[132:135]
ds_read_b64_tr_b16 v[84:85], v225 offset:36864
v_mfma_f32_16x16x32_bf16 v[128:131], v[208:211], v[192:195], v[128:131]
ds_read_b64_tr_b16 v[86:87], v225 offset:38912
v_mfma_f32_16x16x32_bf16 v[136:139], v[208:211], v[196:199], v[136:139]
ds_read_b128 v[68:71], v17 offset:25600
v_mfma_f32_16x16x32_bf16 v[144:147], v[208:211], v[200:203], v[144:147]
ds_read_b128 v[72:75], v17 offset:26624
v_mfma_f32_16x16x32_bf16 v[152:155], v[208:211], v[204:207], v[152:155]
ds_read_b128 v[76:79], v17 offset:27648
v_mfma_f32_16x16x32_bf16 v[156:159], v[212:215], v[204:207], v[156:159]
v_mfma_f32_16x16x32_bf16 v[148:151], v[212:215], v[200:203], v[148:151]
v_mfma_f32_16x16x32_bf16 v[140:143], v[212:215], v[196:199], v[140:143]
v_mfma_f32_16x16x32_bf16 v[132:135], v[212:215], v[192:195], v[132:135]
s_waitcnt lgkmcnt(0)
s_barrier
v_mfma_f32_16x16x32_bf16 v[128:131], v[48:51], v[32:35], v[128:131]
ds_read_b128 v[96:99], v17 offset:49152
ds_read_b64_tr_b16 v[112:113], v226 offset:0
v_mfma_f32_16x16x32_bf16 v[136:139], v[48:51], v[36:39], v[136:139]
ds_read_b64_tr_b16 v[114:115], v226 offset:2048
ds_read_b64_tr_b16 v[116:117], v227 offset:0
v_mfma_f32_16x16x32_bf16 v[144:147], v[48:51], v[40:43], v[144:147]
ds_read_b64_tr_b16 v[118:119], v227 offset:2048
ds_read_b128 v[100:103], v17 offset:50176
v_mfma_f32_16x16x32_bf16 v[152:155], v[48:51], v[44:47], v[152:155]
ds_read_b128 v[104:107], v17 offset:51200
ds_read_b128 v[108:111], v17 offset:52224
v_mfma_f32_16x16x32_bf16 v[156:159], v[52:55], v[44:47], v[156:159]
ds_read_b128 v[192:195], v17 offset:57344
v_mfma_f32_16x16x32_bf16 v[148:151], v[52:55], v[40:43], v[148:151]
ds_read_b64_tr_b16 v[208:209], v226 offset:4096
v_mfma_f32_16x16x32_bf16 v[140:143], v[52:55], v[36:39], v[140:143]
ds_read_b64_tr_b16 v[210:211], v226 offset:6144
v_mfma_f32_16x16x32_bf16 v[132:135], v[52:55], v[32:35], v[132:135]
ds_read_b64_tr_b16 v[212:213], v227 offset:4096
v_mfma_f32_16x16x32_bf16 v[128:131], v[80:83], v[64:67], v[128:131]
ds_read_b64_tr_b16 v[214:215], v227 offset:6144
v_mfma_f32_16x16x32_bf16 v[136:139], v[80:83], v[68:71], v[136:139]
ds_read_b128 v[196:199], v17 offset:58368
v_mfma_f32_16x16x32_bf16 v[144:147], v[80:83], v[72:75], v[144:147]
ds_read_b128 v[200:203], v17 offset:59392
v_mfma_f32_16x16x32_bf16 v[152:155], v[80:83], v[76:79], v[152:155]
ds_read_b128 v[204:207], v17 offset:60416
v_mfma_f32_16x16x32_bf16 v[156:159], v[84:87], v[76:79], v[156:159]
v_mfma_f32_16x16x32_bf16 v[148:151], v[84:87], v[72:75], v[148:151]
v_mfma_f32_16x16x32_bf16 v[140:143], v[84:87], v[68:71], v[140:143]
v_mfma_f32_16x16x32_bf16 v[132:135], v[84:87], v[64:67], v[132:135]
s_waitcnt vmcnt(0)
s_waitcnt lgkmcnt(0)
s_barrier
v_mfma_f32_16x16x32_bf16 v[128:131], v[112:115], v[96:99], v[128:131]
v_lshlrev_b32 v160, 16, v232
v_and_b32 v161, 0xffff0000, v232
v_lshlrev_b32 v162, 16, v233
v_and_b32 v163, 0xffff0000, v233
v_mfma_f32_16x16x32_bf16 v[132:135], v[116:119], v[96:99], v[132:135]
v_lshlrev_b32 v164, 16, v234
v_and_b32 v165, 0xffff0000, v234
v_lshlrev_b32 v166, 16, v235
v_and_b32 v167, 0xffff0000, v235
v_mfma_f32_16x16x32_bf16 v[128:131], v[208:211], v[192:195], v[128:131]
v_lshlrev_b32 v168, 16, v236
v_and_b32 v169, 0xffff0000, v236
v_lshlrev_b32 v170, 16, v237
v_and_b32 v171, 0xffff0000, v237
v_mfma_f32_16x16x32_bf16 v[132:135], v[212:215], v[192:195], v[132:135]
v_lshlrev_b32 v172, 16, v238
v_and_b32 v173, 0xffff0000, v238
v_lshlrev_b32 v174, 16, v239
v_and_b32 v175, 0xffff0000, v239
v_mfma_f32_16x16x32_bf16 v[136:139], v[112:115], v[100:103], v[136:139]
v_lshlrev_b32 v176, 16, v240
v_and_b32 v177, 0xffff0000, v240
v_lshlrev_b32 v178, 16, v241
v_and_b32 v179, 0xffff0000, v241
v_mfma_f32_16x16x32_bf16 v[140:143], v[116:119], v[100:103], v[140:143]
v_lshlrev_b32 v180, 16, v242
v_and_b32 v181, 0xffff0000, v242
v_lshlrev_b32 v182, 16, v243
v_and_b32 v183, 0xffff0000, v243
v_mfma_f32_16x16x32_bf16 v[136:139], v[208:211], v[196:199], v[136:139]
v_lshlrev_b32 v184, 16, v244
v_and_b32 v185, 0xffff0000, v244
v_lshlrev_b32 v186, 16, v245
v_and_b32 v187, 0xffff0000, v245
v_mfma_f32_16x16x32_bf16 v[140:143], v[212:215], v[196:199], v[140:143]
v_lshlrev_b32 v188, 16, v246
v_and_b32 v189, 0xffff0000, v246
v_lshlrev_b32 v190, 16, v247
v_and_b32 v191, 0xffff0000, v247
v_mfma_f32_16x16x32_bf16 v[144:147], v[112:115], v[104:107], v[144:147]
v_add_f32 v128, v128, v160
v_add_f32 v129, v129, v161
v_add_f32 v130, v130, v162
v_mfma_f32_16x16x32_bf16 v[148:151], v[116:119], v[104:107], v[148:151]
v_add_f32 v131, v131, v163
v_add_f32 v132, v132, v164
v_add_f32 v133, v133, v165
v_mfma_f32_16x16x32_bf16 v[144:147], v[208:211], v[200:203], v[144:147]
v_add_f32 v134, v134, v166
v_add_f32 v135, v135, v167
v_cvt_pk_bf16_f32 v232, v128, v129
v_mfma_f32_16x16x32_bf16 v[148:151], v[212:215], v[200:203], v[148:151]
v_cvt_pk_bf16_f32 v233, v130, v131
v_cvt_pk_bf16_f32 v234, v132, v133
v_cvt_pk_bf16_f32 v235, v134, v135
v_mfma_f32_16x16x32_bf16 v[152:155], v[112:115], v[108:111], v[152:155]
v_add_f32 v136, v136, v168
v_add_f32 v137, v137, v169
v_add_f32 v138, v138, v170
v_mfma_f32_16x16x32_bf16 v[156:159], v[116:119], v[108:111], v[156:159]
v_add_f32 v139, v139, v171
v_add_f32 v140, v140, v172
v_add_f32 v141, v141, v173
v_add_f32 v142, v142, v174
v_mfma_f32_16x16x32_bf16 v[152:155], v[208:211], v[204:207], v[152:155]
v_add_f32 v143, v143, v175
v_cvt_pk_bf16_f32 v236, v136, v137
v_cvt_pk_bf16_f32 v237, v138, v139
v_cvt_pk_bf16_f32 v238, v140, v141
v_mfma_f32_16x16x32_bf16 v[156:159], v[212:215], v[204:207], v[156:159]
v_cvt_pk_bf16_f32 v239, v142, v143
v_permlane16_swap_b32 v232, v234
v_permlane16_swap_b32 v233, v235
buffer_store_dwordx4 v[232:235], v230, s[20:23], s54 offen offset:0 nt
v_permlane16_swap_b32 v236, v238
v_permlane16_swap_b32 v237, v239
buffer_store_dwordx4 v[236:239], v230, s[20:23], s54 offen offset:2048 nt
v_add_f32 v144, v144, v176
v_add_f32 v145, v145, v177
v_add_f32 v146, v146, v178
v_add_f32 v147, v147, v179
s_branch Lov_13
.p2align 12
.fill 96, 4, 0xbf800000
Lst_13_0:
s_branch Lwr_173
Lst_13_1:
s_branch Lst_17_0
s_nop 0
Lov_13:
v_add_f32 v148, v148, v180
v_add_f32 v149, v149, v181
v_add_f32 v150, v150, v182
v_add_f32 v151, v151, v183
v_cvt_pk_bf16_f32 v240, v144, v145
v_cvt_pk_bf16_f32 v241, v146, v147
v_cvt_pk_bf16_f32 v242, v148, v149
v_cvt_pk_bf16_f32 v243, v150, v151
s_nop 0
v_add_f32 v152, v152, v184
v_add_f32 v153, v153, v185
v_add_f32 v154, v154, v186
v_add_f32 v155, v155, v187
v_add_f32 v156, v156, v188
v_add_f32 v157, v157, v189
v_add_f32 v158, v158, v190
v_add_f32 v159, v159, v191
v_cvt_pk_bf16_f32 v244, v152, v153
v_cvt_pk_bf16_f32 v245, v154, v155
v_cvt_pk_bf16_f32 v246, v156, v157
v_cvt_pk_bf16_f32 v247, v158, v159
v_permlane16_swap_b32 v240, v242
v_permlane16_swap_b32 v241, v243
buffer_store_dwordx4 v[240:243], v230, s[20:23], s55 offen offset:0 nt
v_permlane16_swap_b32 v244, v246
v_permlane16_swap_b32 v245, v247
buffer_store_dwordx4 v[244:247], v230, s[20:23], s55 offen offset:2048 nt
s_branch Ldone_1
Lgb_112:
s_mul_i32 s43, s34, 262144
s_add_u32 s8, s82, s43
s_addc_u32 s9, s83, 0
s_add_u32 s8, s8, 4194304
s_addc_u32 s9, s9, 0
s_mov_b32 s10, 262144
s_mov_b32 s11, 0x20000
s_lshl_b32 s39, s36, 12
v_lshlrev_b32 v2, 4, v1
v_add_u32 v3, s39, v2
s_add_u32 s37, s35, 0
s_and_b32 s37, s37, 15
s_mul_i32 s37, s37, 16384
s_add_u32 m0, s39, 0
s_nop 0
buffer_load_dwordx4 v3, s[8:11], s37 offen sc1 lds
buffer_load_dwordx4 v3, s[8:11], s37 offen offset:1024 sc1 lds
buffer_load_dwordx4 v3, s[8:11], s37 offen offset:2048 sc1 lds
buffer_load_dwordx4 v3, s[8:11], s37 offen offset:3072 sc1 lds
s_mul_i32 s43, s34, 262144
s_add_u32 s8, s82, s43
s_addc_u32 s9, s83, 0
s_add_u32 s8, s8, 4194304
s_addc_u32 s9, s9, 0
s_mov_b32 s10, 262144
s_mov_b32 s11, 0x20000
s_mul_i32 s43, s34, 917504
s_add_u32 s24, s82, s43
s_addc_u32 s25, s83, 0
s_add_u32 s24, s24, 8388608
s_addc_u32 s25, s25, 0
s_mov_b32 s26, 917504
s_mov_b32 s27, 0x20000
s_add_u32 s84, s82, 27262976
s_addc_u32 s85, s83, 0
s_mov_b32 s86, 229376
s_mov_b32 s87, 0x20000
s_and_b32 s47, s36, 3
s_lshr_b32 s62, s47, 1
s_and_b32 s63, s47, 1
v_lshlrev_b32 v2, 4, v1
s_lshl_b32 s39, s47, 12
v_add_u32 v3, s39, v2
s_bitcmp0_b32 s36, 1
s_cselect_b32 s44, s72, s74
s_cselect_b32 s45, s73, s75
s_mul_i32 s43, s35, 256
s_add_u32 s12, s44, s43
s_addc_u32 s13, s45, 0
s_mov_b32 s14, 7333120
s_mov_b32 s15, 0x20000
s_and_b32 s43, s36, 1
s_mul_i32 s43, s43, 229376
v_lshrrev_b32 v28, 4, v1
v_lshlrev_b32 v29, 1, v28
v_and_b32 v4, 15, v1
v_xor_b32 v4, v4, v29
v_lshlrev_b32 v4, 4, v4
v_mul_u32_u24 v28, 7168, v28
v_add_u32 v4, v4, v28
v_add_u32 v4, s43, v4
v_xor_b32 v5, 128, v4
v_add_u32 v5, 28672, v5
s_and_b32 s43, s36, 3
s_mul_i32 s40, s43, 8192
s_add_u32 s40, s40, 16384
v_mov_b32 v6, v192
v_mov_b32 v7, v193
v_mov_b32 v8, v194
s_lshl_b32 s43, s62, 12
v_add_u32 v9, s43, v2
v_add_u32 v10, 98304, v9
v_mov_b32 v24, v195
s_mul_i32 s43, s34, 16384
s_add_u32 s20, s82, s43
s_addc_u32 s21, s83, 0
s_add_u32 s20, s20, 25165824
s_addc_u32 s21, s21, 0
s_mov_b32 s22, 16384
s_mov_b32 s23, 0x20000
s_add_u32 s38, s35, 2
s_and_b32 s38, s38, 15
s_mul_i32 s38, s38, 458752
s_add_u32 m0, s50, 98304
s_nop 0
buffer_load_dwordx4 v6, s[16:19], s38 offen lds
s_add_u32 m0, s50, 99328
s_nop 0
buffer_load_dwordx4 v7, s[16:19], s38 offen lds
s_add_u32 m0, s50, 100352
s_nop 0
buffer_load_dwordx4 v8, s[16:19], s38 offen lds
s_add_u32 m0, s50, 101376
s_add_u32 s38, s38, 114688
buffer_load_dwordx4 v6, s[16:19], s38 offen lds
s_add_u32 m0, s50, 102400
s_nop 0
buffer_load_dwordx4 v7, s[16:19], s38 offen lds
s_add_u32 m0, s50, 103424
s_nop 0
buffer_load_dwordx4 v8, s[16:19], s38 offen lds
s_cmp_eq_u32 s47, 1
s_cbranch_scc0 Lw_137
s_lshl_b32 s92, s34, 4
s_add_u32 s92, s92, s35
s_lshl_b32 s92, s92, 8
s_add_u32 s92, s92, 49280
s_add_u32 s92, s92, 28311552
s_mov_b32 s41, 0x40000
Lpoll_138:
s_load_dword s93, s[82:83], s92 glc
Lpchk_140:
s_waitcnt lgkmcnt(0)
s_cmp_eq_u32 s93, 16
s_cbranch_scc1 Lpok_139
s_sub_u32 s41, s41, 1
s_cmp_lg_u32 s41, 0
s_cbranch_scc1 Lpoll_138
Lpok_139:
Lw_137:
s_waitcnt vmcnt(0)
s_barrier
s_add_u32 s37, s35, 1
s_and_b32 s37, s37, 15
s_mul_i32 s37, s37, 16384
s_add_u32 m0, s39, 49152
s_nop 0
buffer_load_dwordx4 v3, s[8:11], s37 offen sc1 lds
buffer_load_dwordx4 v3, s[8:11], s37 offen offset:1024 sc1 lds
buffer_load_dwordx4 v3, s[8:11], s37 offen offset:2048 sc1 lds
buffer_load_dwordx4 v3, s[8:11], s37 offen offset:3072 sc1 lds
s_add_u32 s37, s35, 2
s_and_b32 s37, s37, 15
s_mul_i32 s37, s37, 16384
s_add_u32 m0, s39, 98304
s_nop 0
buffer_load_dwordx4 v3, s[8:11], s37 offen sc1 lds
buffer_load_dwordx4 v3, s[8:11], s37 offen offset:1024 sc1 lds
buffer_load_dwordx4 v3, s[8:11], s37 offen offset:2048 sc1 lds
buffer_load_dwordx4 v3, s[8:11], s37 offen offset:3072 sc1 lds
buffer_load_dwordx4 v[96:99], v3, s[20:23], 0 offen offset:0 sc1
buffer_load_dwordx4 v[100:103], v3, s[20:23], 0 offen offset:1024 sc1
buffer_load_dwordx4 v[104:107], v3, s[20:23], 0 offen offset:2048 sc1
buffer_load_dwordx4 v[108:111], v3, s[20:23], 0 offen offset:3072 sc1
s_and_b32 s44, s36, 3
s_mul_i32 s44, s44, 11
s_bfe_u32 s43, s2, 0x30001
s_lshl_b32 s43, s43, 7
s_add_u32 s44, s44, s43
s_add_u32 s44, s44, 84
s_mul_i32 s44, s44, 7168
s_lshr_b32 s43, s2, 4
s_lshl_b32 s43, s43, 8
s_add_u32 s43, s43, s44
s_bitcmp0_b32 s2, 0
s_cselect_b32 s4, s72, s74
s_cselect_b32 s5, s73, s75
s_add_u32 s4, s4, s43
s_addc_u32 s5, s5, 0
s_waitcnt vmcnt(8)
s_barrier
s_cmp_eq_u32 s47, 3
s_cbranch_scc0 Lw_141
v_and_b32 v90, 31, v1
v_lshlrev_b32 v90, 4, v90
v_add_u32 v91, 151552, v90
ds_read_b128 v[112:115], v91 offset:0
ds_read_b128 v[116:119], v91 offset:512
ds_read_b128 v[120:123], v91 offset:1024
ds_read_b128 v[124:127], v91 offset:1536
s_and_b32 s44, s2, 15
s_mul_i32 s44, s44, 14336
s_lshr_b32 s43, s2, 4
s_lshl_b32 s43, s43, 9
s_add_u32 s44, s44, s43
s_add_u32 s44, s44, 8192
s_cmp_lt_u32 s2, 192
s_cselect_b32 s44, s44, 0x7fffffff
s_waitcnt lgkmcnt(0)
v_add_f32 v112, v112, v116
v_add_f32 v120, v120, v124
v_add_f32 v113, v113, v117
v_add_f32 v121, v121, v125
v_add_f32 v114, v114, v118
v_add_f32 v122, v122, v126
v_add_f32 v115, v115, v119
v_add_f32 v123, v123, v127
v_add_f32 v112, v112, v120
v_add_f32 v113, v113, v121
v_add_f32 v114, v114, v122
v_add_f32 v115, v115, v123
s_mov_b64 exec, 0xffffffff
buffer_store_dwordx4 v[112:115], v90, s[84:87], s44 offen sc1
s_mov_b64 exec, -1
Lw_141:
s_add_u32 s37, s35, 3
s_and_b32 s37, s37, 15
s_mul_i32 s37, s37, 16384
s_add_u32 m0, s39, 0
s_nop 0
buffer_load_dwordx4 v3, s[8:11], s37 offen sc1 lds
s_load_dword s3, s[4:5], 0
buffer_load_dwordx4 v3, s[8:11], s37 offen offset:1024 sc1 lds
s_load_dword s3, s[4:5], 64
buffer_load_dwordx4 v3, s[8:11], s37 offen offset:2048 sc1 lds
s_load_dword s3, s[4:5], 128
buffer_load_dwordx4 v3, s[8:11], s37 offen offset:3072 sc1 lds
s_load_dword s3, s[4:5], 192
s_load_dword s3, s[4:5], 7168
s_add_u32 s38, s35, 3
s_and_b32 s38, s38, 15
s_mul_i32 s38, s38, 458752
s_add_u32 m0, s50, 0
s_nop 0
buffer_load_dwordx4 v6, s[16:19], s38 offen lds
s_load_dword s3, s[4:5], 7232
s_add_u32 m0, s50, 1024
s_nop 0
buffer_load_dwordx4 v7, s[16:19], s38 offen lds
s_load_dword s3, s[4:5], 7296
s_add_u32 m0, s50, 2048
s_nop 0
buffer_load_dwordx4 v8, s[16:19], s38 offen lds
s_load_dword s3, s[4:5], 7360
s_add_u32 m0, s50, 3072
s_add_u32 s38, s38, 114688
buffer_load_dwordx4 v6, s[16:19], s38 offen lds
s_load_dword s3, s[4:5], 14336
s_load_dword s3, s[4:5], 14400
s_add_u32 m0, s50, 4096
s_nop 0
buffer_load_dwordx4 v7, s[16:19], s38 offen lds
s_add_u32 m0, s50, 5120
s_nop 0
buffer_load_dwordx4 v8, s[16:19], s38 offen lds
s_waitcnt vmcnt(14)
s_barrier
s_add_u32 s37, s35, 4
s_and_b32 s37, s37, 15
s_mul_i32 s37, s37, 16384
s_add_u32 m0, s39, 49152
s_nop 0
buffer_load_dwordx4 v3, s[8:11], s37 offen sc1 lds
s_load_dword s3, s[4:5], 14464
buffer_load_dwordx4 v3, s[8:11], s37 offen offset:1024 sc1 lds
s_load_dword s3, s[4:5], 14528
buffer_load_dwordx4 v3, s[8:11], s37 offen offset:2048 sc1 lds
s_load_dword s3, s[4:5], 21504
buffer_load_dwordx4 v3, s[8:11], s37 offen offset:3072 sc1 lds
s_load_dword s3, s[4:5], 21568
s_load_dword s3, s[4:5], 21632
s_add_u32 s38, s35, 4
s_and_b32 s38, s38, 15
s_mul_i32 s38, s38, 458752
s_add_u32 m0, s50, 49152
s_nop 0
buffer_load_dwordx4 v6, s[16:19], s38 offen lds
s_load_dword s3, s[4:5], 21696
s_add_u32 m0, s50, 50176
s_nop 0
buffer_load_dwordx4 v7, s[16:19], s38 offen lds
s_load_dword s3, s[4:5], 28672
s_add_u32 m0, s50, 51200
s_nop 0
buffer_load_dwordx4 v8, s[16:19], s38 offen lds
s_load_dword s3, s[4:5], 28736
s_add_u32 m0, s50, 52224
s_add_u32 s38, s38, 114688
buffer_load_dwordx4 v6, s[16:19], s38 offen lds
s_load_dword s3, s[4:5], 28800
s_load_dword s3, s[4:5], 28864
s_add_u32 m0, s50, 53248
s_nop 0
buffer_load_dwordx4 v7, s[16:19], s38 offen lds
s_add_u32 m0, s50, 54272
s_nop 0
buffer_load_dwordx4 v8, s[16:19], s38 offen lds
s_waitcnt vmcnt(10)
s_barrier
s_cmp_eq_u32 s47, 3
s_cbranch_scc0 Lw_142
s_cmp_lt_u32 s2, 192
s_cbranch_scc0 Lw_142
s_lshr_b32 s43, s2, 4
s_add_u32 s43, s43, 96
s_lshl_b32 s43, s43, 7
v_mov_b32 v90, s43
v_mov_b32 v91, 1
s_mov_b64 exec, 1
buffer_atomic_add v91, v90, s[56:59], 0 offen sc1
s_mov_b64 exec, -1
Lw_142:
s_add_u32 s37, s35, 5
s_and_b32 s37, s37, 15
s_mul_i32 s37, s37, 16384
s_add_u32 m0, s39, 98304
s_nop 0
buffer_load_dwordx4 v3, s[8:11], s37 offen sc1 lds
v_add_f32 v96, v96, v100
v_add_f32 v97, v97, v101
v_add_f32 v98, v98, v102
buffer_load_dwordx4 v3, s[8:11], s37 offen offset:1024 sc1 lds
v_add_f32 v99, v99, v103
v_add_f32 v104, v104, v108
v_add_f32 v105, v105, v109
buffer_load_dwordx4 v3, s[8:11], s37 offen offset:2048 sc1 lds
v_add_f32 v106, v106, v110
v_add_f32 v107, v107, v111
s_nop 0
buffer_load_dwordx4 v3, s[8:11], s37 offen offset:3072 sc1 lds
v_permlane32_swap_b32 v96, v104
v_permlane32_swap_b32 v97, v105
v_permlane32_swap_b32 v98, v106
v_permlane32_swap_b32 v99, v107
s_add_u32 s38, s35, 5
s_and_b32 s38, s38, 15
s_mul_i32 s38, s38, 458752
s_add_u32 m0, s50, 98304
s_nop 0
buffer_load_dwordx4 v6, s[16:19], s38 offen lds
v_add_f32 v96, v96, v104
v_add_f32 v97, v97, v105
v_add_f32 v98, v98, v106
s_add_u32 m0, s50, 99328
s_nop 0
buffer_load_dwordx4 v7, s[16:19], s38 offen lds
v_add_f32 v99, v99, v107
v_mov_b32 v100, v96
v_mov_b32 v101, v97
s_add_u32 m0, s50, 100352
s_nop 0
buffer_load_dwordx4 v8, s[16:19], s38 offen lds
v_mov_b32 v102, v98
v_mov_b32 v103, v99
s_nop 0
s_add_u32 m0, s50, 101376
s_add_u32 s38, s38, 114688
buffer_load_dwordx4 v6, s[16:19], s38 offen lds
v_permlane16_swap_b32 v96, v100
v_permlane16_swap_b32 v97, v101
v_permlane16_swap_b32 v98, v102
v_permlane16_swap_b32 v99, v103
s_add_u32 m0, s50, 102400
s_nop 0
buffer_load_dwordx4 v7, s[16:19], s38 offen lds
s_add_u32 m0, s50, 103424
s_nop 0
buffer_load_dwordx4 v8, s[16:19], s38 offen lds
s_waitcnt vmcnt(10)
s_barrier
s_add_u32 s37, s35, 6
s_and_b32 s37, s37, 15
s_mul_i32 s37, s37, 16384
s_add_u32 m0, s39, 0
s_nop 0
buffer_load_dwordx4 v3, s[8:11], s37 offen sc1 lds
v_add_f32 v96, v96, v100
v_add_f32 v97, v97, v101
v_add_f32 v98, v98, v102
buffer_load_dwordx4 v3, s[8:11], s37 offen offset:1024 sc1 lds
v_add_f32 v99, v99, v103
s_nop 0
v_add_f32_dpp v96, v96, v96 row_ror:8 row_mask:0xf bank_mask:0xf
buffer_load_dwordx4 v3, s[8:11], s37 offen offset:2048 sc1 lds
v_add_f32_dpp v97, v97, v97 row_ror:8 row_mask:0xf bank_mask:0xf
v_add_f32_dpp v98, v98, v98 row_ror:8 row_mask:0xf bank_mask:0xf
v_add_f32_dpp v99, v99, v99 row_ror:8 row_mask:0xf bank_mask:0xf
v_mul_f32 v96, 0x3a800000, v96
buffer_load_dwordx4 v3, s[8:11], s37 offen offset:3072 sc1 lds
v_mul_f32 v97, 0x3a800000, v97
v_mul_f32 v98, 0x3a800000, v98
v_mul_f32 v99, 0x3a800000, v99
s_add_u32 s38, s35, 6
s_and_b32 s38, s38, 15
s_mul_i32 s38, s38, 458752
s_add_u32 m0, s50, 0
s_nop 0
buffer_load_dwordx4 v6, s[16:19], s38 offen lds
v_fma_f32 v97, -v96, v96, v97
v_fma_f32 v99, -v98, v98, v99
v_max_f32 v97, 0, v97
s_add_u32 m0, s50, 1024
s_nop 0
buffer_load_dwordx4 v7, s[16:19], s38 offen lds
v_max_f32 v99, 0, v99
v_add_f32 v97, 0x3727c5ac, v97
v_add_f32 v99, 0x3727c5ac, v99
v_rsq_f32 v97, v97
s_add_u32 m0, s50, 2048
s_nop 0
buffer_load_dwordx4 v8, s[16:19], s38 offen lds
v_rsq_f32 v99, v99
v_and_b32 v100, 7, v1
s_lshl_b32 s43, s47, 8
s_add_u32 m0, s50, 3072
s_add_u32 s38, s38, 114688
buffer_load_dwordx4 v6, s[16:19], s38 offen lds
s_add_u32 s43, s43, 147456
v_lshl_add_u32 v100, v100, 4, s43
v_lshrrev_b32 v101, 5, v1
v_lshl_add_u32 v100, v101, 7, v100
s_add_u32 m0, s50, 4096
s_nop 0
buffer_load_dwordx4 v7, s[16:19], s38 offen lds
s_add_u32 m0, s50, 5120
s_nop 0
buffer_load_dwordx4 v8, s[16:19], s38 offen lds
s_waitcnt vmcnt(10)
s_barrier
ds_write_b128 v100, v[96:99]
s_waitcnt lgkmcnt(0)
s_add_u32 s37, s35, 7
s_and_b32 s37, s37, 15
s_mul_i32 s37, s37, 16384
s_add_u32 m0, s39, 49152
s_nop 0
buffer_load_dwordx4 v3, s[8:11], s37 offen sc1 lds
s_load_dword s3, s[4:5], 35840
buffer_load_dwordx4 v3, s[8:11], s37 offen offset:1024 sc1 lds
s_load_dword s3, s[4:5], 35904
buffer_load_dwordx4 v3, s[8:11], s37 offen offset:2048 sc1 lds
s_load_dword s3, s[4:5], 35968
s_load_dword s3, s[4:5], 36032
buffer_load_dwordx4 v3, s[8:11], s37 offen offset:3072 sc1 lds
s_load_dword s3, s[4:5], 43008
s_add_u32 s38, s35, 7
s_and_b32 s38, s38, 15
s_mul_i32 s38, s38, 458752
s_add_u32 m0, s50, 49152
s_nop 0
buffer_load_dwordx4 v6, s[16:19], s38 offen lds
s_load_dword s3, s[4:5], 43072
s_add_u32 m0, s50, 50176
s_nop 0
buffer_load_dwordx4 v7, s[16:19], s38 offen lds
s_load_dword s3, s[4:5], 43136
s_load_dword s3, s[4:5], 43200
s_add_u32 m0, s50, 51200
s_nop 0
buffer_load_dwordx4 v8, s[16:19], s38 offen lds
s_load_dword s3, s[4:5], 50176
s_add_u32 m0, s50, 52224
s_add_u32 s38, s38, 114688
buffer_load_dwordx4 v6, s[16:19], s38 offen lds
s_load_dword s3, s[4:5], 50240
s_load_dword s3, s[4:5], 50304
s_add_u32 m0, s50, 53248
s_nop 0
buffer_load_dwordx4 v7, s[16:19], s38 offen lds
s_add_u32 m0, s50, 54272
s_nop 0
buffer_load_dwordx4 v8, s[16:19], s38 offen lds
s_waitcnt vmcnt(10)
s_barrier
s_add_u32 s37, s35, 8
s_and_b32 s37, s37, 15
s_mul_i32 s37, s37, 16384
s_add_u32 m0, s39, 98304
s_nop 0
buffer_load_dwordx4 v3, s[8:11], s37 offen sc1 lds
s_load_dword s3, s[4:5], 50368
s_load_dword s3, s[4:5], 57344
s_load_dword s3, s[4:5], 57408
buffer_load_dwordx4 v3, s[8:11], s37 offen offset:1024 sc1 lds
s_load_dword s3, s[4:5], 57472
s_load_dword s3, s[4:5], 57536
s_load_dword s3, s[4:5], 64512
s_load_dword s3, s[4:5], 64576
buffer_load_dwordx4 v3, s[8:11], s37 offen offset:2048 sc1 lds
s_load_dword s3, s[4:5], 64640
s_load_dword s3, s[4:5], 64704
s_load_dword s3, s[4:5], 71680
s_load_dword s3, s[4:5], 71744
buffer_load_dwordx4 v3, s[8:11], s37 offen offset:3072 sc1 lds
v_lshrrev_b32 v28, 2, v1
v_and_b32 v29, 7, v28
v_mul_u32_u24 v28, 256, v28
v_lshl_add_u32 v28, v29, 5, v28
s_add_u32 s38, s35, 8
s_and_b32 s38, s38, 15
s_mul_i32 s38, s38, 458752
s_add_u32 m0, s50, 98304
s_nop 0
buffer_load_dwordx4 v6, s[16:19], s38 offen lds
v_and_b32 v29, 3, v1
v_lshl_add_u32 v11, v29, 3, v28
s_lshl_b32 s43, s63, 7
v_xor_b32 v11, s43, v11
s_add_u32 m0, s50, 99328
s_nop 0
buffer_load_dwordx4 v7, s[16:19], s38 offen lds
v_add_u32 v11, 16384, v11
v_xor_b32 v12, 32, v11
v_xor_b32 v13, 64, v11
v_xor_b32 v14, 96, v11
s_add_u32 m0, s50, 100352
s_nop 0
buffer_load_dwordx4 v8, s[16:19], s38 offen lds
v_add_u32 v15, 49152, v11
v_add_u32 v16, 49152, v12
v_add_u32 v17, 49152, v13
v_add_u32 v18, 49152, v14
s_add_u32 m0, s50, 101376
s_add_u32 s38, s38, 114688
buffer_load_dwordx4 v6, s[16:19], s38 offen lds
v_add_u32 v19, 98304, v11
v_add_u32 v20, 98304, v12
v_add_u32 v21, 98304, v13
v_add_u32 v22, 98304, v14
s_add_u32 m0, s50, 102400
s_nop 0
buffer_load_dwordx4 v7, s[16:19], s38 offen lds
s_add_u32 m0, s50, 103424
s_nop 0
buffer_load_dwordx4 v8, s[16:19], s38 offen lds
s_waitcnt vmcnt(10)
s_barrier
s_cmp_eq_u32 s47, 3
s_cbranch_scc0 Lw_143
s_mul_i32 s60, s35, 96
s_add_u32 s61, s60, 95
s_and_b32 s60, s60, 0xff80
s_and_b32 s61, s61, 0xff80
s_add_u32 s60, s60, 28323840
s_add_u32 s61, s61, 28323840
s_load_dword s92, s[82:83], s60 glc
s_load_dword s93, s[82:83], s61 glc
Lw_143:
s_add_u32 s37, s35, 9
s_and_b32 s37, s37, 15
s_mul_i32 s37, s37, 16384
s_add_u32 m0, s39, 0
s_nop 0
buffer_load_dwordx4 v3, s[8:11], s37 offen sc1 lds
buffer_load_dwordx4 v3, s[8:11], s37 offen offset:1024 sc1 lds
buffer_load_dwordx4 v3, s[8:11], s37 offen offset:2048 sc1 lds
buffer_load_dwordx4 v3, s[8:11], s37 offen offset:3072 sc1 lds
s_add_u32 s38, s35, 9
s_and_b32 s38, s38, 15
s_mul_i32 s38, s38, 458752
s_add_u32 m0, s50, 0
s_nop 0
buffer_load_dwordx4 v6, s[16:19], s38 offen lds
s_add_u32 m0, s50, 1024
s_nop 0
buffer_load_dwordx4 v7, s[16:19], s38 offen lds
s_add_u32 m0, s50, 2048
s_nop 0
buffer_load_dwordx4 v8, s[16:19], s38 offen lds
s_add_u32 m0, s50, 3072
s_add_u32 s38, s38, 114688
buffer_load_dwordx4 v6, s[16:19], s38 offen lds
s_add_u32 m0, s50, 4096
s_nop 0
buffer_load_dwordx4 v7, s[16:19], s38 offen lds
s_add_u32 m0, s50, 5120
s_nop 0
buffer_load_dwordx4 v8, s[16:19], s38 offen lds
s_waitcnt vmcnt(10)
s_barrier
s_add_u32 s37, s35, 10
s_and_b32 s37, s37, 15
s_mul_i32 s37, s37, 16384
s_add_u32 m0, s39, 49152
s_nop 0
buffer_load_dwordx4 v3, s[8:11], s37 offen sc1 lds
buffer_load_dwordx4 v3, s[8:11], s37 offen offset:1024 sc1 lds
buffer_load_dwordx4 v3, s[8:11], s37 offen offset:2048 sc1 lds
buffer_load_dwordx4 v3, s[8:11], s37 offen offset:3072 sc1 lds
s_add_u32 s38, s35, 10
s_and_b32 s38, s38, 15
s_mul_i32 s38, s38, 458752
s_add_u32 m0, s50, 49152
s_nop 0
buffer_load_dwordx4 v6, s[16:19], s38 offen lds
s_add_u32 m0, s50, 50176
s_nop 0
buffer_load_dwordx4 v7, s[16:19], s38 offen lds
s_add_u32 m0, s50, 51200
s_nop 0
buffer_load_dwordx4 v8, s[16:19], s38 offen lds
s_branch Lov_14
.p2align 12
.fill 112, 4, 0xbf800000
Lst_14_0:
s_branch Lwr_174
Lst_14_1:
s_branch Lst_18_0
s_nop 0
Lov_14:
s_add_u32 m0, s50, 52224
s_add_u32 s38, s38, 114688
buffer_load_dwordx4 v6, s[16:19], s38 offen lds
s_add_u32 m0, s50, 53248
s_nop 0
buffer_load_dwordx4 v7, s[16:19], s38 offen lds
s_add_u32 m0, s50, 54272
s_nop 0
buffer_load_dwordx4 v8, s[16:19], s38 offen lds
s_mov_b32 s38, 0
buffer_load_dwordx4 v[40:43], v24, s[88:91], s38 offen
s_mov_b32 s38, 28672
buffer_load_dwordx4 v[44:47], v24, s[88:91], s38 offen
s_mov_b32 s38, 57344
buffer_load_dwordx4 v[48:51], v24, s[88:91], s38 offen
s_mov_b32 s38, 86016
buffer_load_dwordx4 v[52:55], v24, s[88:91], s38 offen
s_mov_b32 s38, 114688
buffer_load_dwordx4 v[56:59], v24, s[88:91], s38 offen
s_mov_b32 s38, 143360
buffer_load_dwordx4 v[60:63], v24, s[88:91], s38 offen
s_mov_b32 s38, 172032
buffer_load_dwordx4 v[64:67], v24, s[88:91], s38 offen
s_mov_b32 s38, 200704
buffer_load_dwordx4 v[68:71], v24, s[88:91], s38 offen
s_waitcnt vmcnt(18)
s_cmp_eq_u32 s47, 3
s_cbranch_scc0 Lw_144
s_mov_b32 s41, 0x40000
Lcp_145:
s_waitcnt lgkmcnt(0)
s_and_b32 s92, s92, s93
s_cmp_eq_u32 s92, 16
s_cbranch_scc1 Lco_146
s_load_dword s92, s[82:83], s60 glc
s_load_dword s93, s[82:83], s61 glc
s_sub_u32 s41, s41, 1
s_cmp_lg_u32 s41, 0
s_cbranch_scc1 Lcp_145
s_waitcnt lgkmcnt(0)
Lco_146:
Lw_144:
s_barrier
s_mov_b32 s45, s47
s_cmp_ge_u32 s45, 3
s_cselect_b32 s43, 1, 0
s_mul_i32 s44, s43, 3
s_sub_u32 s45, s45, s44
s_lshl_b32 s45, s45, 7
s_mul_i32 s52, s43, 896
s_add_u32 s52, s52, s45
s_add_u32 s52, s52, 148992
s_mul_i32 s43, s43, 14336
s_add_u32 s43, s43, s45
s_mul_i32 s44, s35, 384
s_add_u32 s43, s43, s44
s_add_u32 s60, s43, 8192
s_add_u32 s45, s47, 4
s_min_u32 s45, s45, 5
s_cmp_ge_u32 s45, 3
s_cselect_b32 s43, 1, 0
s_mul_i32 s44, s43, 3
s_sub_u32 s45, s45, s44
s_lshl_b32 s45, s45, 7
s_mul_i32 s53, s43, 896
s_add_u32 s53, s53, s45
s_add_u32 s53, s53, 148992
s_mul_i32 s43, s43, 14336
s_add_u32 s43, s43, s45
s_mul_i32 s44, s35, 384
s_add_u32 s43, s43, s44
s_add_u32 s61, s43, 8192
v_lshrrev_b32 v104, 3, v1
v_mul_u32_u24 v104, 28672, v104
v_and_b32 v105, 7, v1
v_lshl_add_u32 v104, v105, 4, v104
buffer_load_dwordx4 v[96:99], v104, s[84:87], s60 offen sc1
s_load_dword s3, s[4:5], 71808
s_load_dword s3, s[4:5], 71872
buffer_load_dwordx4 v[100:103], v104, s[84:87], s61 offen sc1
s_and_b32 s44, s36, 3
s_mul_i32 s43, s2, 28672
s_add_u32 s37, s35, 11
s_and_b32 s37, s37, 15
s_mul_i32 s37, s37, 16384
s_add_u32 m0, s39, 98304
s_nop 0
buffer_load_dwordx4 v3, s[8:11], s37 offen sc1 lds
s_mul_i32 s44, s44, 7168
s_add_u32 s43, s43, s44
buffer_load_dwordx4 v3, s[8:11], s37 offen offset:1024 sc1 lds
s_add_u32 s4, s76, s43
s_addc_u32 s5, s77, 0
s_load_dword s3, s[4:5], 0
buffer_load_dwordx4 v3, s[8:11], s37 offen offset:2048 sc1 lds
s_load_dword s3, s[4:5], 64
s_load_dword s3, s[4:5], 128
buffer_load_dwordx4 v3, s[8:11], s37 offen offset:3072 sc1 lds
s_load_dword s3, s[4:5], 192
s_load_dword s3, s[4:5], 256
s_add_u32 s38, s35, 11
s_and_b32 s38, s38, 15
s_mul_i32 s38, s38, 458752
s_add_u32 m0, s50, 98304
s_nop 0
buffer_load_dwordx4 v6, s[16:19], s38 offen lds
s_load_dword s3, s[4:5], 320
s_load_dword s3, s[4:5], 384
s_load_dword s3, s[4:5], 448
s_add_u32 m0, s50, 99328
s_nop 0
buffer_load_dwordx4 v7, s[16:19], s38 offen lds
v_cmp_gt_u32 vcc, 32, v1
v_mov_b32 v104, s52
s_add_u32 m0, s50, 100352
s_nop 0
buffer_load_dwordx4 v8, s[16:19], s38 offen lds
v_mov_b32 v106, s53
v_cndmask_b32 v104, v106, v104, vcc
s_add_u32 m0, s50, 101376
s_add_u32 s38, s38, 114688
buffer_load_dwordx4 v6, s[16:19], s38 offen lds
v_lshl_add_u32 v104, v105, 4, v104
v_bfe_u32 v105, v1, 4, 1
v_lshl_add_u32 v104, v105, 2, v104
s_add_u32 m0, s50, 102400
s_nop 0
buffer_load_dwordx4 v7, s[16:19], s38 offen lds
s_add_u32 m0, s50, 103424
s_nop 0
buffer_load_dwordx4 v8, s[16:19], s38 offen lds
s_waitcnt vmcnt(20)
s_barrier
s_add_u32 s37, s35, 12
s_and_b32 s37, s37, 15
s_mul_i32 s37, s37, 16384
s_add_u32 m0, s39, 0
s_nop 0
buffer_load_dwordx4 v3, s[8:11], s37 offen sc1 lds
buffer_load_dwordx4 v3, s[8:11], s37 offen offset:1024 sc1 lds
buffer_load_dwordx4 v3, s[8:11], s37 offen offset:2048 sc1 lds
buffer_load_dwordx4 v3, s[8:11], s37 offen offset:3072 sc1 lds
s_add_u32 s38, s35, 12
s_and_b32 s38, s38, 15
s_mul_i32 s38, s38, 458752
s_add_u32 m0, s50, 0
s_nop 0
buffer_load_dwordx4 v6, s[16:19], s38 offen lds
s_add_u32 m0, s50, 1024
s_nop 0
buffer_load_dwordx4 v7, s[16:19], s38 offen lds
s_add_u32 m0, s50, 2048
s_nop 0
buffer_load_dwordx4 v8, s[16:19], s38 offen lds
s_add_u32 m0, s50, 3072
s_add_u32 s38, s38, 114688
buffer_load_dwordx4 v6, s[16:19], s38 offen lds
s_add_u32 m0, s50, 4096
s_nop 0
buffer_load_dwordx4 v7, s[16:19], s38 offen lds
s_add_u32 m0, s50, 5120
s_nop 0
buffer_load_dwordx4 v8, s[16:19], s38 offen lds
s_waitcnt vmcnt(10)
s_barrier
v_permlane32_swap_b32 v96, v100
v_permlane32_swap_b32 v97, v101
v_permlane32_swap_b32 v98, v102
v_permlane32_swap_b32 v99, v103
v_add_f32 v96, v96, v100
v_add_f32 v97, v97, v101
v_add_f32 v98, v98, v102
v_add_f32 v99, v99, v103
s_nop 1
v_permlane16_swap_b32 v96, v97
v_permlane16_swap_b32 v98, v99
v_add_f32 v96, v96, v97
v_add_f32 v98, v98, v99
s_nop 1
v_add_f32_dpp v96, v96, v96 row_ror:8 row_mask:0xf bank_mask:0xf
v_add_f32_dpp v98, v98, v98 row_ror:8 row_mask:0xf bank_mask:0xf
ds_write_b32 v104, v96
ds_write_b32 v104, v98 offset:8
s_waitcnt lgkmcnt(0)
s_add_u32 s37, s35, 13
s_and_b32 s37, s37, 15
s_mul_i32 s37, s37, 16384
s_add_u32 m0, s39, 49152
s_nop 0
buffer_load_dwordx4 v3, s[8:11], s37 offen sc1 lds
s_load_dword s3, s[4:5], 512
s_load_dword s3, s[4:5], 576
s_load_dword s3, s[4:5], 640
s_load_dword s3, s[4:5], 704
s_load_dword s3, s[4:5], 768
buffer_load_dwordx4 v3, s[8:11], s37 offen offset:1024 sc1 lds
s_load_dword s3, s[4:5], 832
s_load_dword s3, s[4:5], 896
s_load_dword s3, s[4:5], 960
s_load_dword s3, s[4:5], 1024
s_load_dword s3, s[4:5], 1088
buffer_load_dwordx4 v3, s[8:11], s37 offen offset:2048 sc1 lds
v_lshlrev_b32 v72, 16, v40
v_and_b32 v73, 0xffff0000, v40
v_lshlrev_b32 v74, 16, v41
v_and_b32 v75, 0xffff0000, v41
v_lshlrev_b32 v76, 16, v42
v_and_b32 v77, 0xffff0000, v42
buffer_load_dwordx4 v3, s[8:11], s37 offen offset:3072 sc1 lds
v_lshlrev_b32 v78, 16, v43
v_and_b32 v79, 0xffff0000, v43
v_lshlrev_b32 v80, 16, v44
v_and_b32 v81, 0xffff0000, v44
v_lshlrev_b32 v82, 16, v45
s_add_u32 s38, s35, 13
s_and_b32 s38, s38, 15
s_mul_i32 s38, s38, 458752
s_add_u32 m0, s50, 49152
s_nop 0
buffer_load_dwordx4 v6, s[16:19], s38 offen lds
v_and_b32 v83, 0xffff0000, v45
v_lshlrev_b32 v84, 16, v46
v_and_b32 v85, 0xffff0000, v46
v_lshlrev_b32 v86, 16, v47
v_and_b32 v87, 0xffff0000, v47
s_add_u32 m0, s50, 50176
s_nop 0
buffer_load_dwordx4 v7, s[16:19], s38 offen lds
v_add_f32 v72, v72, v80
v_add_f32 v73, v73, v81
v_add_f32 v74, v74, v82
v_add_f32 v75, v75, v83
v_add_f32 v76, v76, v84
v_add_f32 v77, v77, v85
s_add_u32 m0, s50, 51200
s_nop 0
buffer_load_dwordx4 v8, s[16:19], s38 offen lds
v_add_f32 v78, v78, v86
v_add_f32 v79, v79, v87
v_lshlrev_b32 v80, 16, v48
v_and_b32 v81, 0xffff0000, v48
v_lshlrev_b32 v82, 16, v49
s_add_u32 m0, s50, 52224
s_add_u32 s38, s38, 114688
buffer_load_dwordx4 v6, s[16:19], s38 offen lds
v_and_b32 v83, 0xffff0000, v49
v_lshlrev_b32 v84, 16, v50
v_and_b32 v85, 0xffff0000, v50
v_lshlrev_b32 v86, 16, v51
v_and_b32 v87, 0xffff0000, v51
v_add_f32 v72, v72, v80
s_add_u32 m0, s50, 53248
s_nop 0
buffer_load_dwordx4 v7, s[16:19], s38 offen lds
s_add_u32 m0, s50, 54272
s_nop 0
buffer_load_dwordx4 v8, s[16:19], s38 offen lds
s_waitcnt vmcnt(10)
s_barrier
s_add_u32 s37, s35, 14
s_and_b32 s37, s37, 15
s_mul_i32 s37, s37, 16384
s_add_u32 m0, s39, 98304
s_nop 0
buffer_load_dwordx4 v3, s[8:11], s37 offen sc1 lds
s_load_dword s3, s[4:5], 1152
s_load_dword s3, s[4:5], 1216
s_load_dword s3, s[4:5], 1280
s_load_dword s3, s[4:5], 1344
s_load_dword s3, s[4:5], 1408
buffer_load_dwordx4 v3, s[8:11], s37 offen offset:1024 sc1 lds
s_load_dword s3, s[4:5], 1472
s_load_dword s3, s[4:5], 1536
s_load_dword s3, s[4:5], 1600
s_load_dword s3, s[4:5], 1664
s_load_dword s3, s[4:5], 1728
v_add_f32 v73, v73, v81
buffer_load_dwordx4 v3, s[8:11], s37 offen offset:2048 sc1 lds
v_add_f32 v74, v74, v82
v_add_f32 v75, v75, v83
v_add_f32 v76, v76, v84
v_add_f32 v77, v77, v85
v_add_f32 v78, v78, v86
buffer_load_dwordx4 v3, s[8:11], s37 offen offset:3072 sc1 lds
v_add_f32 v79, v79, v87
v_lshlrev_b32 v80, 16, v52
v_and_b32 v81, 0xffff0000, v52
v_lshlrev_b32 v82, 16, v53
v_and_b32 v83, 0xffff0000, v53
v_lshlrev_b32 v84, 16, v54
s_add_u32 s38, s35, 14
s_and_b32 s38, s38, 15
s_mul_i32 s38, s38, 458752
s_add_u32 m0, s50, 98304
s_nop 0
buffer_load_dwordx4 v6, s[16:19], s38 offen lds
v_and_b32 v85, 0xffff0000, v54
v_lshlrev_b32 v86, 16, v55
v_and_b32 v87, 0xffff0000, v55
v_add_f32 v72, v72, v80
v_add_f32 v73, v73, v81
s_add_u32 m0, s50, 99328
s_nop 0
buffer_load_dwordx4 v7, s[16:19], s38 offen lds
v_add_f32 v74, v74, v82
v_add_f32 v75, v75, v83
v_add_f32 v76, v76, v84
v_add_f32 v77, v77, v85
v_add_f32 v78, v78, v86
v_add_f32 v79, v79, v87
s_add_u32 m0, s50, 100352
s_nop 0
buffer_load_dwordx4 v8, s[16:19], s38 offen lds
v_lshlrev_b32 v80, 16, v56
v_and_b32 v81, 0xffff0000, v56
v_lshlrev_b32 v82, 16, v57
v_and_b32 v83, 0xffff0000, v57
v_lshlrev_b32 v84, 16, v58
s_add_u32 m0, s50, 101376
s_add_u32 s38, s38, 114688
buffer_load_dwordx4 v6, s[16:19], s38 offen lds
v_and_b32 v85, 0xffff0000, v58
v_lshlrev_b32 v86, 16, v59
v_and_b32 v87, 0xffff0000, v59
v_add_f32 v72, v72, v80
v_add_f32 v73, v73, v81
v_add_f32 v74, v74, v82
s_add_u32 m0, s50, 102400
s_nop 0
buffer_load_dwordx4 v7, s[16:19], s38 offen lds
s_add_u32 m0, s50, 103424
s_nop 0
buffer_load_dwordx4 v8, s[16:19], s38 offen lds
s_waitcnt vmcnt(10)
s_barrier
s_add_u32 s37, s35, 15
s_and_b32 s37, s37, 15
s_mul_i32 s37, s37, 16384
s_add_u32 m0, s39, 0
s_nop 0
buffer_load_dwordx4 v3, s[8:11], s37 offen sc1 lds
v_add_f32 v75, v75, v83
v_add_f32 v76, v76, v84
v_add_f32 v77, v77, v85
v_add_f32 v78, v78, v86
buffer_load_dwordx4 v3, s[8:11], s37 offen offset:1024 sc1 lds
v_add_f32 v79, v79, v87
v_lshlrev_b32 v80, 16, v60
v_and_b32 v81, 0xffff0000, v60
v_lshlrev_b32 v82, 16, v61
buffer_load_dwordx4 v3, s[8:11], s37 offen offset:2048 sc1 lds
v_and_b32 v83, 0xffff0000, v61
v_lshlrev_b32 v84, 16, v62
v_and_b32 v85, 0xffff0000, v62
v_lshlrev_b32 v86, 16, v63
buffer_load_dwordx4 v3, s[8:11], s37 offen offset:3072 sc1 lds
v_and_b32 v87, 0xffff0000, v63
v_add_f32 v72, v72, v80
v_add_f32 v73, v73, v81
v_add_f32 v74, v74, v82
s_add_u32 s38, s35, 15
s_and_b32 s38, s38, 15
s_mul_i32 s38, s38, 458752
s_add_u32 m0, s50, 0
s_nop 0
buffer_load_dwordx4 v6, s[16:19], s38 offen lds
v_add_f32 v75, v75, v83
v_add_f32 v76, v76, v84
v_add_f32 v77, v77, v85
v_add_f32 v78, v78, v86
s_add_u32 m0, s50, 1024
s_nop 0
buffer_load_dwordx4 v7, s[16:19], s38 offen lds
v_add_f32 v79, v79, v87
v_lshlrev_b32 v80, 16, v64
v_and_b32 v81, 0xffff0000, v64
v_lshlrev_b32 v82, 16, v65
s_add_u32 m0, s50, 2048
s_nop 0
buffer_load_dwordx4 v8, s[16:19], s38 offen lds
v_and_b32 v83, 0xffff0000, v65
v_lshlrev_b32 v84, 16, v66
v_and_b32 v85, 0xffff0000, v66
v_lshlrev_b32 v86, 16, v67
s_add_u32 m0, s50, 3072
s_add_u32 s38, s38, 114688
buffer_load_dwordx4 v6, s[16:19], s38 offen lds
v_and_b32 v87, 0xffff0000, v67
v_add_f32 v72, v72, v80
v_add_f32 v73, v73, v81
v_add_f32 v74, v74, v82
v_add_f32 v75, v75, v83
s_add_u32 m0, s50, 4096
s_nop 0
buffer_load_dwordx4 v7, s[16:19], s38 offen lds
s_add_u32 m0, s50, 5120
s_nop 0
buffer_load_dwordx4 v8, s[16:19], s38 offen lds
s_waitcnt vmcnt(10)
s_barrier
s_add_u32 s38, s35, 13
s_and_b32 s38, s38, 15
s_mul_i32 s38, s38, 458752
s_add_u32 m0, s40, 49152
s_nop 0
buffer_load_dwordx4 v4, s[12:15], s38 offen lds
v_add_f32 v76, v76, v84
v_add_f32 v77, v77, v85
v_add_f32 v78, v78, v86
v_add_f32 v79, v79, v87
v_lshlrev_b32 v80, 16, v68
s_add_u32 m0, s40, 50176
s_nop 0
buffer_load_dwordx4 v5, s[12:15], s38 offen lds
v_and_b32 v81, 0xffff0000, v68
v_lshlrev_b32 v82, 16, v69
v_and_b32 v83, 0xffff0000, v69
v_lshlrev_b32 v84, 16, v70
v_and_b32 v85, 0xffff0000, v70
v_lshlrev_b32 v86, 16, v71
s_add_u32 m0, s40, 51200
s_add_u32 s38, s38, 57344
buffer_load_dwordx4 v4, s[12:15], s38 offen lds
v_and_b32 v87, 0xffff0000, v71
v_add_f32 v72, v72, v80
v_add_f32 v73, v73, v81
v_add_f32 v74, v74, v82
v_add_f32 v75, v75, v83
v_add_f32 v76, v76, v84
s_add_u32 m0, s40, 52224
s_nop 0
buffer_load_dwordx4 v5, s[12:15], s38 offen lds
v_add_f32 v77, v77, v85
v_add_f32 v78, v78, v86
v_add_f32 v79, v79, v87
s_nop 0
v_permlane32_swap_b32 v72, v76
s_add_u32 m0, s40, 53248
s_add_u32 s38, s38, 57344
buffer_load_dwordx4 v4, s[12:15], s38 offen lds
v_permlane32_swap_b32 v73, v77
v_permlane32_swap_b32 v74, v78
v_permlane32_swap_b32 v75, v79
v_add_f32 v72, v72, v76
v_add_f32 v73, v73, v77
v_add_f32 v74, v74, v78
s_add_u32 m0, s40, 54272
s_nop 0
buffer_load_dwordx4 v5, s[12:15], s38 offen lds
v_add_f32 v75, v75, v79
s_nop 0
v_permlane16_swap_b32 v72, v74
v_permlane16_swap_b32 v73, v75
v_add_f32 v72, v72, v74
v_add_f32 v73, v73, v75
s_add_u32 m0, s40, 55296
s_add_u32 s38, s38, 57344
buffer_load_dwordx4 v4, s[12:15], s38 offen lds
s_add_u32 m0, s40, 56320
s_nop 0
buffer_load_dwordx4 v5, s[12:15], s38 offen lds
s_waitcnt vmcnt(8)
s_barrier
s_lshl_b32 s43, s47, 9
s_add_u32 s43, s43, 153600
v_and_b32 v80, 15, v1
v_lshl_add_u32 v80, v80, 5, s43
v_lshrrev_b32 v81, 4, v1
v_lshl_add_u32 v80, v81, 3, v80
ds_write_b64 v80, v[72:73]
s_waitcnt lgkmcnt(0)
s_add_u32 s38, s35, 14
s_and_b32 s38, s38, 15
s_mul_i32 s38, s38, 458752
s_add_u32 m0, s40, 98304
s_nop 0
buffer_load_dwordx4 v4, s[12:15], s38 offen lds
s_bfe_u32 s61, s35, 0x10002
s_lshr_b32 s60, s35, 3
s_lshl_b32 s60, s60, 2
s_and_b32 s43, s35, 3
s_add_u32 s60, s60, s43
s_add_u32 m0, s40, 99328
s_nop 0
buffer_load_dwordx4 v5, s[12:15], s38 offen lds
s_lshl_b32 s43, s60, 8
s_add_u32 s28, s76, s43
s_addc_u32 s29, s77, 0
s_mov_b32 s30, 7338240
s_mov_b32 s31, 0x20000
s_add_u32 m0, s40, 100352
s_add_u32 s38, s38, 57344
buffer_load_dwordx4 v4, s[12:15], s38 offen lds
s_mul_i32 s52, s61, 196608
s_mul_i32 s53, s61, 1572864
s_mul_i32 s90, s61, 163840
s_mul_i32 s91, s61, 1310720
s_and_b32 s43, s35, 3
s_add_u32 m0, s40, 101376
s_nop 0
buffer_load_dwordx4 v5, s[12:15], s38 offen lds
s_mul_i32 s32, s43, 3
s_mul_i32 s33, s43, 10
s_lshr_b32 s33, s33, 2
s_lshl_b32 s51, s47, 11
s_lshl_b32 s44, s47, 15
s_add_u32 m0, s40, 102400
s_add_u32 s38, s38, 57344
buffer_load_dwordx4 v4, s[12:15], s38 offen lds
v_lshrrev_b32 v122, 4, v1
v_lshlrev_b32 v123, 1, v122
v_and_b32 v23, 15, v1
v_xor_b32 v23, v23, v123
v_lshlrev_b32 v23, 4, v23
s_add_u32 m0, s40, 103424
s_nop 0
buffer_load_dwordx4 v5, s[12:15], s38 offen lds
v_mul_u32_u24 v122, 2048, v122
v_add_u32 v23, v23, v122
v_add_u32 v23, s44, v23
v_xor_b32 v24, 128, v23
v_add_u32 v24, 8192, v24
s_add_u32 m0, s40, 104448
s_add_u32 s38, s38, 57344
buffer_load_dwordx4 v4, s[12:15], s38 offen lds
s_add_u32 m0, s40, 105472
s_nop 0
buffer_load_dwordx4 v5, s[12:15], s38 offen lds
s_waitcnt vmcnt(8)
s_barrier
ds_read_b128 v[28:31], v9 offset:49152
ds_read_b64_tr_b16 v[44:45], v15 offset:0
ds_read_b64_tr_b16 v[46:47], v15 offset:4096
ds_read_b64_tr_b16 v[48:49], v16 offset:0
ds_read_b64_tr_b16 v[50:51], v16 offset:4096
ds_read_b64_tr_b16 v[52:53], v17 offset:0
ds_read_b64_tr_b16 v[54:55], v17 offset:4096
ds_read_b64_tr_b16 v[56:57], v18 offset:0
ds_read_b64_tr_b16 v[58:59], v18 offset:4096
ds_read_b64_tr_b16 v[60:61], v15 offset:16384
ds_read_b64_tr_b16 v[62:63], v15 offset:20480
ds_read_b64_tr_b16 v[64:65], v16 offset:16384
ds_read_b64_tr_b16 v[66:67], v16 offset:20480
ds_read_b64_tr_b16 v[68:69], v17 offset:16384
ds_read_b64_tr_b16 v[70:71], v17 offset:20480
ds_read_b64_tr_b16 v[72:73], v18 offset:16384
ds_read_b64_tr_b16 v[74:75], v18 offset:20480
ds_read_b128 v[32:35], v9 offset:50176
ds_read_b128 v[36:39], v9 offset:51200
ds_read_b128 v[40:43], v9 offset:52224
s_waitcnt lgkmcnt(0)
v_mfma_f32_16x16x32_bf16 v[124:127], v[44:47], v[28:31], 0
ds_read_b128 v[76:79], v9 offset:57344
v_mfma_f32_16x16x32_bf16 v[156:159], v[44:47], v[32:35], 0
ds_read_b64_tr_b16 v[92:93], v15 offset:8192
v_mfma_f32_16x16x32_bf16 v[188:191], v[44:47], v[36:39], 0
ds_read_b64_tr_b16 v[94:95], v15 offset:12288
v_mfma_f32_16x16x32_bf16 v[220:223], v[44:47], v[40:43], 0
ds_read_b64_tr_b16 v[96:97], v16 offset:8192
v_mfma_f32_16x16x32_bf16 v[224:227], v[48:51], v[40:43], 0
ds_read_b64_tr_b16 v[98:99], v16 offset:12288
v_mfma_f32_16x16x32_bf16 v[192:195], v[48:51], v[36:39], 0
ds_read_b64_tr_b16 v[100:101], v17 offset:8192
v_mfma_f32_16x16x32_bf16 v[160:163], v[48:51], v[32:35], 0
ds_read_b64_tr_b16 v[102:103], v17 offset:12288
v_mfma_f32_16x16x32_bf16 v[128:131], v[48:51], v[28:31], 0
ds_read_b64_tr_b16 v[104:105], v18 offset:8192
v_mfma_f32_16x16x32_bf16 v[132:135], v[52:55], v[28:31], 0
ds_read_b64_tr_b16 v[106:107], v18 offset:12288
v_mfma_f32_16x16x32_bf16 v[164:167], v[52:55], v[32:35], 0
ds_read_b64_tr_b16 v[108:109], v15 offset:24576
v_mfma_f32_16x16x32_bf16 v[196:199], v[52:55], v[36:39], 0
ds_read_b64_tr_b16 v[110:111], v15 offset:28672
v_mfma_f32_16x16x32_bf16 v[228:231], v[52:55], v[40:43], 0
ds_read_b64_tr_b16 v[112:113], v16 offset:24576
v_mfma_f32_16x16x32_bf16 v[232:235], v[56:59], v[40:43], 0
ds_read_b64_tr_b16 v[114:115], v16 offset:28672
v_mfma_f32_16x16x32_bf16 v[200:203], v[56:59], v[36:39], 0
ds_read_b64_tr_b16 v[116:117], v17 offset:24576
v_mfma_f32_16x16x32_bf16 v[168:171], v[56:59], v[32:35], 0
ds_read_b64_tr_b16 v[118:119], v17 offset:28672
v_mfma_f32_16x16x32_bf16 v[136:139], v[56:59], v[28:31], 0
ds_read_b64_tr_b16 v[120:121], v18 offset:24576
v_mfma_f32_16x16x32_bf16 v[140:143], v[60:63], v[28:31], 0
ds_read_b64_tr_b16 v[122:123], v18 offset:28672
v_mfma_f32_16x16x32_bf16 v[172:175], v[60:63], v[32:35], 0
ds_read_b128 v[80:83], v9 offset:58368
v_mfma_f32_16x16x32_bf16 v[204:207], v[60:63], v[36:39], 0
ds_read_b128 v[84:87], v9 offset:59392
v_mfma_f32_16x16x32_bf16 v[236:239], v[60:63], v[40:43], 0
ds_read_b128 v[88:91], v9 offset:60416
s_branch Lov_15
.p2align 12
.fill 112, 4, 0xbf800000
Lst_15_0:
s_branch Lwr_183
s_nop 0
s_nop 0
Lov_15:
v_mfma_f32_16x16x32_bf16 v[240:243], v[64:67], v[40:43], 0
v_mfma_f32_16x16x32_bf16 v[208:211], v[64:67], v[36:39], 0
v_mfma_f32_16x16x32_bf16 v[176:179], v[64:67], v[32:35], 0
v_mfma_f32_16x16x32_bf16 v[144:147], v[64:67], v[28:31], 0
v_mfma_f32_16x16x32_bf16 v[148:151], v[68:71], v[28:31], 0
v_mfma_f32_16x16x32_bf16 v[180:183], v[68:71], v[32:35], 0
v_mfma_f32_16x16x32_bf16 v[212:215], v[68:71], v[36:39], 0
v_mfma_f32_16x16x32_bf16 v[244:247], v[68:71], v[40:43], 0
v_mfma_f32_16x16x32_bf16 v[248:251], v[72:75], v[40:43], 0
v_mfma_f32_16x16x32_bf16 v[216:219], v[72:75], v[36:39], 0
v_mfma_f32_16x16x32_bf16 v[184:187], v[72:75], v[32:35], 0
v_mfma_f32_16x16x32_bf16 v[152:155], v[72:75], v[28:31], 0
s_waitcnt vmcnt(0)
s_waitcnt lgkmcnt(0)
s_barrier
v_mfma_f32_16x16x32_bf16 v[124:127], v[92:95], v[76:79], v[124:127]
ds_read_b128 v[28:31], v10 offset:0
v_mfma_f32_16x16x32_bf16 v[156:159], v[92:95], v[80:83], v[156:159]
ds_read_b64_tr_b16 v[44:45], v19 offset:0
v_mfma_f32_16x16x32_bf16 v[188:191], v[92:95], v[84:87], v[188:191]
ds_read_b64_tr_b16 v[46:47], v19 offset:4096
v_mfma_f32_16x16x32_bf16 v[220:223], v[92:95], v[88:91], v[220:223]
ds_read_b64_tr_b16 v[48:49], v20 offset:0
v_mfma_f32_16x16x32_bf16 v[224:227], v[96:99], v[88:91], v[224:227]
ds_read_b64_tr_b16 v[50:51], v20 offset:4096
v_mfma_f32_16x16x32_bf16 v[192:195], v[96:99], v[84:87], v[192:195]
ds_read_b64_tr_b16 v[52:53], v21 offset:0
v_mfma_f32_16x16x32_bf16 v[160:163], v[96:99], v[80:83], v[160:163]
ds_read_b64_tr_b16 v[54:55], v21 offset:4096
v_mfma_f32_16x16x32_bf16 v[128:131], v[96:99], v[76:79], v[128:131]
ds_read_b64_tr_b16 v[56:57], v22 offset:0
v_mfma_f32_16x16x32_bf16 v[132:135], v[100:103], v[76:79], v[132:135]
ds_read_b64_tr_b16 v[58:59], v22 offset:4096
v_mfma_f32_16x16x32_bf16 v[164:167], v[100:103], v[80:83], v[164:167]
ds_read_b64_tr_b16 v[60:61], v19 offset:16384
v_mfma_f32_16x16x32_bf16 v[196:199], v[100:103], v[84:87], v[196:199]
ds_read_b64_tr_b16 v[62:63], v19 offset:20480
v_mfma_f32_16x16x32_bf16 v[228:231], v[100:103], v[88:91], v[228:231]
ds_read_b64_tr_b16 v[64:65], v20 offset:16384
v_mfma_f32_16x16x32_bf16 v[232:235], v[104:107], v[88:91], v[232:235]
ds_read_b64_tr_b16 v[66:67], v20 offset:20480
v_mfma_f32_16x16x32_bf16 v[200:203], v[104:107], v[84:87], v[200:203]
ds_read_b64_tr_b16 v[68:69], v21 offset:16384
v_mfma_f32_16x16x32_bf16 v[168:171], v[104:107], v[80:83], v[168:171]
ds_read_b64_tr_b16 v[70:71], v21 offset:20480
v_mfma_f32_16x16x32_bf16 v[136:139], v[104:107], v[76:79], v[136:139]
ds_read_b64_tr_b16 v[72:73], v22 offset:16384
v_mfma_f32_16x16x32_bf16 v[140:143], v[108:111], v[76:79], v[140:143]
ds_read_b64_tr_b16 v[74:75], v22 offset:20480
v_mfma_f32_16x16x32_bf16 v[172:175], v[108:111], v[80:83], v[172:175]
ds_read_b128 v[32:35], v10 offset:1024
v_mfma_f32_16x16x32_bf16 v[204:207], v[108:111], v[84:87], v[204:207]
ds_read_b128 v[36:39], v10 offset:2048
v_mfma_f32_16x16x32_bf16 v[236:239], v[108:111], v[88:91], v[236:239]
ds_read_b128 v[40:43], v10 offset:3072
v_mfma_f32_16x16x32_bf16 v[240:243], v[112:115], v[88:91], v[240:243]
v_mfma_f32_16x16x32_bf16 v[208:211], v[112:115], v[84:87], v[208:211]
v_mfma_f32_16x16x32_bf16 v[176:179], v[112:115], v[80:83], v[176:179]
v_mfma_f32_16x16x32_bf16 v[144:147], v[112:115], v[76:79], v[144:147]
v_mfma_f32_16x16x32_bf16 v[148:151], v[116:119], v[76:79], v[148:151]
v_mfma_f32_16x16x32_bf16 v[180:183], v[116:119], v[80:83], v[180:183]
v_mfma_f32_16x16x32_bf16 v[212:215], v[116:119], v[84:87], v[212:215]
v_mfma_f32_16x16x32_bf16 v[244:247], v[116:119], v[88:91], v[244:247]
v_mfma_f32_16x16x32_bf16 v[248:251], v[120:123], v[88:91], v[248:251]
v_mfma_f32_16x16x32_bf16 v[216:219], v[120:123], v[84:87], v[216:219]
v_mfma_f32_16x16x32_bf16 v[184:187], v[120:123], v[80:83], v[184:187]
v_mfma_f32_16x16x32_bf16 v[152:155], v[120:123], v[76:79], v[152:155]
s_mov_b32 s41, 5
Lk3l_147:
s_waitcnt lgkmcnt(0)
v_mfma_f32_16x16x32_bf16 v[124:127], v[44:47], v[28:31], v[124:127]
ds_read_b128 v[76:79], v10 offset:8192
v_mfma_f32_16x16x32_bf16 v[156:159], v[44:47], v[32:35], v[156:159]
ds_read_b64_tr_b16 v[92:93], v19 offset:8192
v_mfma_f32_16x16x32_bf16 v[188:191], v[44:47], v[36:39], v[188:191]
ds_read_b64_tr_b16 v[94:95], v19 offset:12288
v_mfma_f32_16x16x32_bf16 v[220:223], v[44:47], v[40:43], v[220:223]
ds_read_b64_tr_b16 v[96:97], v20 offset:8192
v_mfma_f32_16x16x32_bf16 v[224:227], v[48:51], v[40:43], v[224:227]
ds_read_b64_tr_b16 v[98:99], v20 offset:12288
v_mfma_f32_16x16x32_bf16 v[192:195], v[48:51], v[36:39], v[192:195]
ds_read_b64_tr_b16 v[100:101], v21 offset:8192
v_mfma_f32_16x16x32_bf16 v[160:163], v[48:51], v[32:35], v[160:163]
ds_read_b64_tr_b16 v[102:103], v21 offset:12288
v_mfma_f32_16x16x32_bf16 v[128:131], v[48:51], v[28:31], v[128:131]
ds_read_b64_tr_b16 v[104:105], v22 offset:8192
v_mfma_f32_16x16x32_bf16 v[132:135], v[52:55], v[28:31], v[132:135]
ds_read_b64_tr_b16 v[106:107], v22 offset:12288
v_mfma_f32_16x16x32_bf16 v[164:167], v[52:55], v[32:35], v[164:167]
ds_read_b64_tr_b16 v[108:109], v19 offset:24576
v_mfma_f32_16x16x32_bf16 v[196:199], v[52:55], v[36:39], v[196:199]
ds_read_b64_tr_b16 v[110:111], v19 offset:28672
v_mfma_f32_16x16x32_bf16 v[228:231], v[52:55], v[40:43], v[228:231]
ds_read_b64_tr_b16 v[112:113], v20 offset:24576
v_mfma_f32_16x16x32_bf16 v[232:235], v[56:59], v[40:43], v[232:235]
ds_read_b64_tr_b16 v[114:115], v20 offset:28672
v_mfma_f32_16x16x32_bf16 v[200:203], v[56:59], v[36:39], v[200:203]
ds_read_b64_tr_b16 v[116:117], v21 offset:24576
v_mfma_f32_16x16x32_bf16 v[168:171], v[56:59], v[32:35], v[168:171]
ds_read_b64_tr_b16 v[118:119], v21 offset:28672
v_mfma_f32_16x16x32_bf16 v[136:139], v[56:59], v[28:31], v[136:139]
ds_read_b64_tr_b16 v[120:121], v22 offset:24576
v_mfma_f32_16x16x32_bf16 v[140:143], v[60:63], v[28:31], v[140:143]
ds_read_b64_tr_b16 v[122:123], v22 offset:28672
v_mfma_f32_16x16x32_bf16 v[172:175], v[60:63], v[32:35], v[172:175]
ds_read_b128 v[80:83], v10 offset:9216
v_mfma_f32_16x16x32_bf16 v[204:207], v[60:63], v[36:39], v[204:207]
ds_read_b128 v[84:87], v10 offset:10240
v_mfma_f32_16x16x32_bf16 v[236:239], v[60:63], v[40:43], v[236:239]
ds_read_b128 v[88:91], v10 offset:11264
v_mfma_f32_16x16x32_bf16 v[240:243], v[64:67], v[40:43], v[240:243]
v_mfma_f32_16x16x32_bf16 v[208:211], v[64:67], v[36:39], v[208:211]
v_mfma_f32_16x16x32_bf16 v[176:179], v[64:67], v[32:35], v[176:179]
v_mfma_f32_16x16x32_bf16 v[144:147], v[64:67], v[28:31], v[144:147]
v_mfma_f32_16x16x32_bf16 v[148:151], v[68:71], v[28:31], v[148:151]
v_mfma_f32_16x16x32_bf16 v[180:183], v[68:71], v[32:35], v[180:183]
v_mfma_f32_16x16x32_bf16 v[212:215], v[68:71], v[36:39], v[212:215]
v_mfma_f32_16x16x32_bf16 v[244:247], v[68:71], v[40:43], v[244:247]
v_mfma_f32_16x16x32_bf16 v[248:251], v[72:75], v[40:43], v[248:251]
v_mfma_f32_16x16x32_bf16 v[216:219], v[72:75], v[36:39], v[216:219]
v_mfma_f32_16x16x32_bf16 v[184:187], v[72:75], v[32:35], v[184:187]
v_mfma_f32_16x16x32_bf16 v[152:155], v[72:75], v[28:31], v[152:155]
s_waitcnt lgkmcnt(0)
s_barrier
v_mfma_f32_16x16x32_bf16 v[124:127], v[92:95], v[76:79], v[124:127]
ds_read_b128 v[28:31], v9 offset:0
v_mfma_f32_16x16x32_bf16 v[156:159], v[92:95], v[80:83], v[156:159]
ds_read_b64_tr_b16 v[44:45], v11 offset:0
v_mfma_f32_16x16x32_bf16 v[188:191], v[92:95], v[84:87], v[188:191]
ds_read_b64_tr_b16 v[46:47], v11 offset:4096
v_mfma_f32_16x16x32_bf16 v[220:223], v[92:95], v[88:91], v[220:223]
ds_read_b64_tr_b16 v[48:49], v12 offset:0
v_mfma_f32_16x16x32_bf16 v[224:227], v[96:99], v[88:91], v[224:227]
ds_read_b64_tr_b16 v[50:51], v12 offset:4096
v_mfma_f32_16x16x32_bf16 v[192:195], v[96:99], v[84:87], v[192:195]
ds_read_b64_tr_b16 v[52:53], v13 offset:0
v_mfma_f32_16x16x32_bf16 v[160:163], v[96:99], v[80:83], v[160:163]
ds_read_b64_tr_b16 v[54:55], v13 offset:4096
v_mfma_f32_16x16x32_bf16 v[128:131], v[96:99], v[76:79], v[128:131]
ds_read_b64_tr_b16 v[56:57], v14 offset:0
v_mfma_f32_16x16x32_bf16 v[132:135], v[100:103], v[76:79], v[132:135]
ds_read_b64_tr_b16 v[58:59], v14 offset:4096
v_mfma_f32_16x16x32_bf16 v[164:167], v[100:103], v[80:83], v[164:167]
ds_read_b64_tr_b16 v[60:61], v11 offset:16384
v_mfma_f32_16x16x32_bf16 v[196:199], v[100:103], v[84:87], v[196:199]
ds_read_b64_tr_b16 v[62:63], v11 offset:20480
v_mfma_f32_16x16x32_bf16 v[228:231], v[100:103], v[88:91], v[228:231]
ds_read_b64_tr_b16 v[64:65], v12 offset:16384
v_mfma_f32_16x16x32_bf16 v[232:235], v[104:107], v[88:91], v[232:235]
ds_read_b64_tr_b16 v[66:67], v12 offset:20480
v_mfma_f32_16x16x32_bf16 v[200:203], v[104:107], v[84:87], v[200:203]
ds_read_b64_tr_b16 v[68:69], v13 offset:16384
v_mfma_f32_16x16x32_bf16 v[168:171], v[104:107], v[80:83], v[168:171]
ds_read_b64_tr_b16 v[70:71], v13 offset:20480
v_mfma_f32_16x16x32_bf16 v[136:139], v[104:107], v[76:79], v[136:139]
ds_read_b64_tr_b16 v[72:73], v14 offset:16384
v_mfma_f32_16x16x32_bf16 v[140:143], v[108:111], v[76:79], v[140:143]
ds_read_b64_tr_b16 v[74:75], v14 offset:20480
v_mfma_f32_16x16x32_bf16 v[172:175], v[108:111], v[80:83], v[172:175]
ds_read_b128 v[32:35], v9 offset:1024
v_mfma_f32_16x16x32_bf16 v[204:207], v[108:111], v[84:87], v[204:207]
ds_read_b128 v[36:39], v9 offset:2048
v_mfma_f32_16x16x32_bf16 v[236:239], v[108:111], v[88:91], v[236:239]
ds_read_b128 v[40:43], v9 offset:3072
v_mfma_f32_16x16x32_bf16 v[240:243], v[112:115], v[88:91], v[240:243]
v_mfma_f32_16x16x32_bf16 v[208:211], v[112:115], v[84:87], v[208:211]
v_mfma_f32_16x16x32_bf16 v[176:179], v[112:115], v[80:83], v[176:179]
v_mfma_f32_16x16x32_bf16 v[144:147], v[112:115], v[76:79], v[144:147]
v_mfma_f32_16x16x32_bf16 v[148:151], v[116:119], v[76:79], v[148:151]
v_mfma_f32_16x16x32_bf16 v[180:183], v[116:119], v[80:83], v[180:183]
v_mfma_f32_16x16x32_bf16 v[212:215], v[116:119], v[84:87], v[212:215]
v_mfma_f32_16x16x32_bf16 v[244:247], v[116:119], v[88:91], v[244:247]
v_mfma_f32_16x16x32_bf16 v[248:251], v[120:123], v[88:91], v[248:251]
v_mfma_f32_16x16x32_bf16 v[216:219], v[120:123], v[84:87], v[216:219]
v_mfma_f32_16x16x32_bf16 v[184:187], v[120:123], v[80:83], v[184:187]
v_mfma_f32_16x16x32_bf16 v[152:155], v[120:123], v[76:79], v[152:155]
s_waitcnt lgkmcnt(0)
v_mfma_f32_16x16x32_bf16 v[124:127], v[44:47], v[28:31], v[124:127]
ds_read_b128 v[76:79], v9 offset:8192
v_mfma_f32_16x16x32_bf16 v[156:159], v[44:47], v[32:35], v[156:159]
ds_read_b64_tr_b16 v[92:93], v11 offset:8192
v_mfma_f32_16x16x32_bf16 v[188:191], v[44:47], v[36:39], v[188:191]
ds_read_b64_tr_b16 v[94:95], v11 offset:12288
v_mfma_f32_16x16x32_bf16 v[220:223], v[44:47], v[40:43], v[220:223]
ds_read_b64_tr_b16 v[96:97], v12 offset:8192
v_mfma_f32_16x16x32_bf16 v[224:227], v[48:51], v[40:43], v[224:227]
ds_read_b64_tr_b16 v[98:99], v12 offset:12288
v_mfma_f32_16x16x32_bf16 v[192:195], v[48:51], v[36:39], v[192:195]
ds_read_b64_tr_b16 v[100:101], v13 offset:8192
v_mfma_f32_16x16x32_bf16 v[160:163], v[48:51], v[32:35], v[160:163]
ds_read_b64_tr_b16 v[102:103], v13 offset:12288
v_mfma_f32_16x16x32_bf16 v[128:131], v[48:51], v[28:31], v[128:131]
ds_read_b64_tr_b16 v[104:105], v14 offset:8192
v_mfma_f32_16x16x32_bf16 v[132:135], v[52:55], v[28:31], v[132:135]
ds_read_b64_tr_b16 v[106:107], v14 offset:12288
v_mfma_f32_16x16x32_bf16 v[164:167], v[52:55], v[32:35], v[164:167]
ds_read_b64_tr_b16 v[108:109], v11 offset:24576
v_mfma_f32_16x16x32_bf16 v[196:199], v[52:55], v[36:39], v[196:199]
ds_read_b64_tr_b16 v[110:111], v11 offset:28672
v_mfma_f32_16x16x32_bf16 v[228:231], v[52:55], v[40:43], v[228:231]
ds_read_b64_tr_b16 v[112:113], v12 offset:24576
v_mfma_f32_16x16x32_bf16 v[232:235], v[56:59], v[40:43], v[232:235]
ds_read_b64_tr_b16 v[114:115], v12 offset:28672
v_mfma_f32_16x16x32_bf16 v[200:203], v[56:59], v[36:39], v[200:203]
ds_read_b64_tr_b16 v[116:117], v13 offset:24576
v_mfma_f32_16x16x32_bf16 v[168:171], v[56:59], v[32:35], v[168:171]
ds_read_b64_tr_b16 v[118:119], v13 offset:28672
v_mfma_f32_16x16x32_bf16 v[136:139], v[56:59], v[28:31], v[136:139]
ds_read_b64_tr_b16 v[120:121], v14 offset:24576
v_mfma_f32_16x16x32_bf16 v[140:143], v[60:63], v[28:31], v[140:143]
ds_read_b64_tr_b16 v[122:123], v14 offset:28672
v_mfma_f32_16x16x32_bf16 v[172:175], v[60:63], v[32:35], v[172:175]
ds_read_b128 v[80:83], v9 offset:9216
v_mfma_f32_16x16x32_bf16 v[204:207], v[60:63], v[36:39], v[204:207]
ds_read_b128 v[84:87], v9 offset:10240
v_mfma_f32_16x16x32_bf16 v[236:239], v[60:63], v[40:43], v[236:239]
ds_read_b128 v[88:91], v9 offset:11264
v_mfma_f32_16x16x32_bf16 v[240:243], v[64:67], v[40:43], v[240:243]
v_mfma_f32_16x16x32_bf16 v[208:211], v[64:67], v[36:39], v[208:211]
v_mfma_f32_16x16x32_bf16 v[176:179], v[64:67], v[32:35], v[176:179]
v_mfma_f32_16x16x32_bf16 v[144:147], v[64:67], v[28:31], v[144:147]
v_mfma_f32_16x16x32_bf16 v[148:151], v[68:71], v[28:31], v[148:151]
v_mfma_f32_16x16x32_bf16 v[180:183], v[68:71], v[32:35], v[180:183]
v_mfma_f32_16x16x32_bf16 v[212:215], v[68:71], v[36:39], v[212:215]
v_mfma_f32_16x16x32_bf16 v[244:247], v[68:71], v[40:43], v[244:247]
v_mfma_f32_16x16x32_bf16 v[248:251], v[72:75], v[40:43], v[248:251]
v_mfma_f32_16x16x32_bf16 v[216:219], v[72:75], v[36:39], v[216:219]
v_mfma_f32_16x16x32_bf16 v[184:187], v[72:75], v[32:35], v[184:187]
v_mfma_f32_16x16x32_bf16 v[152:155], v[72:75], v[28:31], v[152:155]
s_waitcnt lgkmcnt(0)
s_barrier
v_mfma_f32_16x16x32_bf16 v[124:127], v[92:95], v[76:79], v[124:127]
ds_read_b128 v[28:31], v9 offset:49152
v_mfma_f32_16x16x32_bf16 v[156:159], v[92:95], v[80:83], v[156:159]
ds_read_b64_tr_b16 v[44:45], v15 offset:0
v_mfma_f32_16x16x32_bf16 v[188:191], v[92:95], v[84:87], v[188:191]
ds_read_b64_tr_b16 v[46:47], v15 offset:4096
v_mfma_f32_16x16x32_bf16 v[220:223], v[92:95], v[88:91], v[220:223]
ds_read_b64_tr_b16 v[48:49], v16 offset:0
v_mfma_f32_16x16x32_bf16 v[224:227], v[96:99], v[88:91], v[224:227]
ds_read_b64_tr_b16 v[50:51], v16 offset:4096
v_mfma_f32_16x16x32_bf16 v[192:195], v[96:99], v[84:87], v[192:195]
ds_read_b64_tr_b16 v[52:53], v17 offset:0
v_mfma_f32_16x16x32_bf16 v[160:163], v[96:99], v[80:83], v[160:163]
ds_read_b64_tr_b16 v[54:55], v17 offset:4096
v_mfma_f32_16x16x32_bf16 v[128:131], v[96:99], v[76:79], v[128:131]
ds_read_b64_tr_b16 v[56:57], v18 offset:0
v_mfma_f32_16x16x32_bf16 v[132:135], v[100:103], v[76:79], v[132:135]
ds_read_b64_tr_b16 v[58:59], v18 offset:4096
v_mfma_f32_16x16x32_bf16 v[164:167], v[100:103], v[80:83], v[164:167]
ds_read_b64_tr_b16 v[60:61], v15 offset:16384
v_mfma_f32_16x16x32_bf16 v[196:199], v[100:103], v[84:87], v[196:199]
ds_read_b64_tr_b16 v[62:63], v15 offset:20480
v_mfma_f32_16x16x32_bf16 v[228:231], v[100:103], v[88:91], v[228:231]
ds_read_b64_tr_b16 v[64:65], v16 offset:16384
v_mfma_f32_16x16x32_bf16 v[232:235], v[104:107], v[88:91], v[232:235]
ds_read_b64_tr_b16 v[66:67], v16 offset:20480
v_mfma_f32_16x16x32_bf16 v[200:203], v[104:107], v[84:87], v[200:203]
ds_read_b64_tr_b16 v[68:69], v17 offset:16384
v_mfma_f32_16x16x32_bf16 v[168:171], v[104:107], v[80:83], v[168:171]
ds_read_b64_tr_b16 v[70:71], v17 offset:20480
v_mfma_f32_16x16x32_bf16 v[136:139], v[104:107], v[76:79], v[136:139]
ds_read_b64_tr_b16 v[72:73], v18 offset:16384
v_mfma_f32_16x16x32_bf16 v[140:143], v[108:111], v[76:79], v[140:143]
ds_read_b64_tr_b16 v[74:75], v18 offset:20480
v_mfma_f32_16x16x32_bf16 v[172:175], v[108:111], v[80:83], v[172:175]
ds_read_b128 v[32:35], v9 offset:50176
v_mfma_f32_16x16x32_bf16 v[204:207], v[108:111], v[84:87], v[204:207]
ds_read_b128 v[36:39], v9 offset:51200
v_mfma_f32_16x16x32_bf16 v[236:239], v[108:111], v[88:91], v[236:239]
ds_read_b128 v[40:43], v9 offset:52224
v_mfma_f32_16x16x32_bf16 v[240:243], v[112:115], v[88:91], v[240:243]
v_mfma_f32_16x16x32_bf16 v[208:211], v[112:115], v[84:87], v[208:211]
v_mfma_f32_16x16x32_bf16 v[176:179], v[112:115], v[80:83], v[176:179]
v_mfma_f32_16x16x32_bf16 v[144:147], v[112:115], v[76:79], v[144:147]
v_mfma_f32_16x16x32_bf16 v[148:151], v[116:119], v[76:79], v[148:151]
v_mfma_f32_16x16x32_bf16 v[180:183], v[116:119], v[80:83], v[180:183]
v_mfma_f32_16x16x32_bf16 v[212:215], v[116:119], v[84:87], v[212:215]
v_mfma_f32_16x16x32_bf16 v[244:247], v[116:119], v[88:91], v[244:247]
v_mfma_f32_16x16x32_bf16 v[248:251], v[120:123], v[88:91], v[248:251]
v_mfma_f32_16x16x32_bf16 v[216:219], v[120:123], v[84:87], v[216:219]
v_mfma_f32_16x16x32_bf16 v[184:187], v[120:123], v[80:83], v[184:187]
v_mfma_f32_16x16x32_bf16 v[152:155], v[120:123], v[76:79], v[152:155]
s_waitcnt lgkmcnt(0)
v_mfma_f32_16x16x32_bf16 v[124:127], v[44:47], v[28:31], v[124:127]
ds_read_b128 v[76:79], v9 offset:57344
v_mfma_f32_16x16x32_bf16 v[156:159], v[44:47], v[32:35], v[156:159]
ds_read_b64_tr_b16 v[92:93], v15 offset:8192
v_mfma_f32_16x16x32_bf16 v[188:191], v[44:47], v[36:39], v[188:191]
ds_read_b64_tr_b16 v[94:95], v15 offset:12288
v_mfma_f32_16x16x32_bf16 v[220:223], v[44:47], v[40:43], v[220:223]
ds_read_b64_tr_b16 v[96:97], v16 offset:8192
v_mfma_f32_16x16x32_bf16 v[224:227], v[48:51], v[40:43], v[224:227]
ds_read_b64_tr_b16 v[98:99], v16 offset:12288
v_mfma_f32_16x16x32_bf16 v[192:195], v[48:51], v[36:39], v[192:195]
ds_read_b64_tr_b16 v[100:101], v17 offset:8192
v_mfma_f32_16x16x32_bf16 v[160:163], v[48:51], v[32:35], v[160:163]
ds_read_b64_tr_b16 v[102:103], v17 offset:12288
v_mfma_f32_16x16x32_bf16 v[128:131], v[48:51], v[28:31], v[128:131]
ds_read_b64_tr_b16 v[104:105], v18 offset:8192
v_mfma_f32_16x16x32_bf16 v[132:135], v[52:55], v[28:31], v[132:135]
ds_read_b64_tr_b16 v[106:107], v18 offset:12288
v_mfma_f32_16x16x32_bf16 v[164:167], v[52:55], v[32:35], v[164:167]
ds_read_b64_tr_b16 v[108:109], v15 offset:24576
v_mfma_f32_16x16x32_bf16 v[196:199], v[52:55], v[36:39], v[196:199]
ds_read_b64_tr_b16 v[110:111], v15 offset:28672
v_mfma_f32_16x16x32_bf16 v[228:231], v[52:55], v[40:43], v[228:231]
ds_read_b64_tr_b16 v[112:113], v16 offset:24576
v_mfma_f32_16x16x32_bf16 v[232:235], v[56:59], v[40:43], v[232:235]
ds_read_b64_tr_b16 v[114:115], v16 offset:28672
v_mfma_f32_16x16x32_bf16 v[200:203], v[56:59], v[36:39], v[200:203]
ds_read_b64_tr_b16 v[116:117], v17 offset:24576
v_mfma_f32_16x16x32_bf16 v[168:171], v[56:59], v[32:35], v[168:171]
ds_read_b64_tr_b16 v[118:119], v17 offset:28672
v_mfma_f32_16x16x32_bf16 v[136:139], v[56:59], v[28:31], v[136:139]
ds_read_b64_tr_b16 v[120:121], v18 offset:24576
v_mfma_f32_16x16x32_bf16 v[140:143], v[60:63], v[28:31], v[140:143]
ds_read_b64_tr_b16 v[122:123], v18 offset:28672
v_mfma_f32_16x16x32_bf16 v[172:175], v[60:63], v[32:35], v[172:175]
ds_read_b128 v[80:83], v9 offset:58368
v_mfma_f32_16x16x32_bf16 v[204:207], v[60:63], v[36:39], v[204:207]
ds_read_b128 v[84:87], v9 offset:59392
v_mfma_f32_16x16x32_bf16 v[236:239], v[60:63], v[40:43], v[236:239]
ds_read_b128 v[88:91], v9 offset:60416
v_mfma_f32_16x16x32_bf16 v[240:243], v[64:67], v[40:43], v[240:243]
v_mfma_f32_16x16x32_bf16 v[208:211], v[64:67], v[36:39], v[208:211]
v_mfma_f32_16x16x32_bf16 v[176:179], v[64:67], v[32:35], v[176:179]
v_mfma_f32_16x16x32_bf16 v[144:147], v[64:67], v[28:31], v[144:147]
v_mfma_f32_16x16x32_bf16 v[148:151], v[68:71], v[28:31], v[148:151]
v_mfma_f32_16x16x32_bf16 v[180:183], v[68:71], v[32:35], v[180:183]
v_mfma_f32_16x16x32_bf16 v[212:215], v[68:71], v[36:39], v[212:215]
v_mfma_f32_16x16x32_bf16 v[244:247], v[68:71], v[40:43], v[244:247]
v_mfma_f32_16x16x32_bf16 v[248:251], v[72:75], v[40:43], v[248:251]
v_mfma_f32_16x16x32_bf16 v[216:219], v[72:75], v[36:39], v[216:219]
v_mfma_f32_16x16x32_bf16 v[184:187], v[72:75], v[32:35], v[184:187]
v_mfma_f32_16x16x32_bf16 v[152:155], v[72:75], v[28:31], v[152:155]
s_waitcnt lgkmcnt(0)
s_barrier
v_mfma_f32_16x16x32_bf16 v[124:127], v[92:95], v[76:79], v[124:127]
ds_read_b128 v[28:31], v10 offset:0
v_mfma_f32_16x16x32_bf16 v[156:159], v[92:95], v[80:83], v[156:159]
ds_read_b64_tr_b16 v[44:45], v19 offset:0
v_mfma_f32_16x16x32_bf16 v[188:191], v[92:95], v[84:87], v[188:191]
ds_read_b64_tr_b16 v[46:47], v19 offset:4096
v_mfma_f32_16x16x32_bf16 v[220:223], v[92:95], v[88:91], v[220:223]
ds_read_b64_tr_b16 v[48:49], v20 offset:0
v_mfma_f32_16x16x32_bf16 v[224:227], v[96:99], v[88:91], v[224:227]
ds_read_b64_tr_b16 v[50:51], v20 offset:4096
v_mfma_f32_16x16x32_bf16 v[192:195], v[96:99], v[84:87], v[192:195]
ds_read_b64_tr_b16 v[52:53], v21 offset:0
v_mfma_f32_16x16x32_bf16 v[160:163], v[96:99], v[80:83], v[160:163]
ds_read_b64_tr_b16 v[54:55], v21 offset:4096
v_mfma_f32_16x16x32_bf16 v[128:131], v[96:99], v[76:79], v[128:131]
ds_read_b64_tr_b16 v[56:57], v22 offset:0
v_mfma_f32_16x16x32_bf16 v[132:135], v[100:103], v[76:79], v[132:135]
ds_read_b64_tr_b16 v[58:59], v22 offset:4096
v_mfma_f32_16x16x32_bf16 v[164:167], v[100:103], v[80:83], v[164:167]
ds_read_b64_tr_b16 v[60:61], v19 offset:16384
v_mfma_f32_16x16x32_bf16 v[196:199], v[100:103], v[84:87], v[196:199]
ds_read_b64_tr_b16 v[62:63], v19 offset:20480
v_mfma_f32_16x16x32_bf16 v[228:231], v[100:103], v[88:91], v[228:231]
ds_read_b64_tr_b16 v[64:65], v20 offset:16384
v_mfma_f32_16x16x32_bf16 v[232:235], v[104:107], v[88:91], v[232:235]
ds_read_b64_tr_b16 v[66:67], v20 offset:20480
v_mfma_f32_16x16x32_bf16 v[200:203], v[104:107], v[84:87], v[200:203]
ds_read_b64_tr_b16 v[68:69], v21 offset:16384
v_mfma_f32_16x16x32_bf16 v[168:171], v[104:107], v[80:83], v[168:171]
ds_read_b64_tr_b16 v[70:71], v21 offset:20480
v_mfma_f32_16x16x32_bf16 v[136:139], v[104:107], v[76:79], v[136:139]
ds_read_b64_tr_b16 v[72:73], v22 offset:16384
v_mfma_f32_16x16x32_bf16 v[140:143], v[108:111], v[76:79], v[140:143]
ds_read_b64_tr_b16 v[74:75], v22 offset:20480
v_mfma_f32_16x16x32_bf16 v[172:175], v[108:111], v[80:83], v[172:175]
ds_read_b128 v[32:35], v10 offset:1024
v_mfma_f32_16x16x32_bf16 v[204:207], v[108:111], v[84:87], v[204:207]
ds_read_b128 v[36:39], v10 offset:2048
v_mfma_f32_16x16x32_bf16 v[236:239], v[108:111], v[88:91], v[236:239]
ds_read_b128 v[40:43], v10 offset:3072
v_mfma_f32_16x16x32_bf16 v[240:243], v[112:115], v[88:91], v[240:243]
v_mfma_f32_16x16x32_bf16 v[208:211], v[112:115], v[84:87], v[208:211]
v_mfma_f32_16x16x32_bf16 v[176:179], v[112:115], v[80:83], v[176:179]
v_mfma_f32_16x16x32_bf16 v[144:147], v[112:115], v[76:79], v[144:147]
v_mfma_f32_16x16x32_bf16 v[148:151], v[116:119], v[76:79], v[148:151]
v_mfma_f32_16x16x32_bf16 v[180:183], v[116:119], v[80:83], v[180:183]
v_mfma_f32_16x16x32_bf16 v[212:215], v[116:119], v[84:87], v[212:215]
v_mfma_f32_16x16x32_bf16 v[244:247], v[116:119], v[88:91], v[244:247]
v_mfma_f32_16x16x32_bf16 v[248:251], v[120:123], v[88:91], v[248:251]
v_mfma_f32_16x16x32_bf16 v[216:219], v[120:123], v[84:87], v[216:219]
v_mfma_f32_16x16x32_bf16 v[184:187], v[120:123], v[80:83], v[184:187]
v_mfma_f32_16x16x32_bf16 v[152:155], v[120:123], v[76:79], v[152:155]
s_sub_u32 s41, s41, 1
s_cmp_lg_u32 s41, 0
s_cbranch_scc1 Lk3l_147
s_waitcnt lgkmcnt(0)
s_barrier
v_lshrrev_b32 v84, 4, v1
s_lshl_b32 s43, s63, 8
s_add_u32 s43, s43, 148480
v_lshl_add_u32 v85, v84, 4, s43
v_and_b32 v84, 15, v1
s_lshl_b32 s43, s62, 9
s_add_u32 s43, s43, 147456
v_lshl_add_u32 v84, v84, 3, s43
ds_read_b128 v[28:31], v85 offset:0
ds_read_b128 v[32:35], v85 offset:64
ds_read_b128 v[36:39], v85 offset:128
ds_read_b128 v[40:43], v85 offset:192
ds_read_b128 v[44:47], v85 offset:896
ds_read_b128 v[48:51], v85 offset:960
ds_read_b128 v[52:55], v85 offset:1024
ds_read_b128 v[56:59], v85 offset:1088
ds_read_b64 v[60:61], v84 offset:0
ds_read_b64 v[62:63], v84 offset:128
ds_read_b64 v[64:65], v84 offset:256
ds_read_b64 v[66:67], v84 offset:384
s_lshl_b32 s54, s35, 15
s_lshl_b32 s43, s63, 14
s_add_u32 s54, s54, s43
s_lshl_b32 s43, s62, 12
s_add_u32 s54, s54, s43
s_add_u32 s55, s54, 8192
v_lshrrev_b32 v122, 3, v1
v_and_b32 v123, 6, v122
v_and_b32 v25, 7, v1
v_xor_b32 v25, v25, v123
v_lshlrev_b32 v25, 4, v25
v_mul_u32_u24 v122, 2048, v122
v_add_u32 v25, v25, v122
s_lshl_b32 s43, s61, 7
s_lshl_b32 s44, s47, 15
s_add_u32 s43, s43, s44
v_add_u32 v25, s43, v25
s_waitcnt lgkmcnt(0)
s_add_u32 s37, s52, 589824
s_add_u32 m0, s39, 81920
s_nop 0
buffer_load_dwordx4 v3, s[24:27], s37 offen sc1 lds
v_mul_f32 v70, v61, v61
v_mul_f32 v68, 0xc0135761, v61
v_mul_f32 v69, 0xbdd2d3e8, v61
v_mul_f32 v69, v69, v70
v_rcp_f32 v70, v70
v_mul_f32 v74, v63, v63
v_mul_f32 v72, 0xc0135761, v63
v_mul_f32 v73, 0xbdd2d3e8, v63
v_mul_f32 v73, v73, v74
v_rcp_f32 v74, v74
v_fma_f32 v124, -v60, v28, v124
v_fma_f32 v125, -v60, v29, v125
v_fma_f32 v126, -v60, v30, v126
v_fma_f32 v127, -v60, v31, v127
buffer_load_dwordx4 v3, s[24:27], s37 offen offset:1024 sc1 lds
v_fma_f32 v156, -v62, v28, v156
v_fma_f32 v157, -v62, v29, v157
v_fma_f32 v158, -v62, v30, v158
v_fma_f32 v159, -v62, v31, v159
v_mul_f32 v76, v124, v124
v_mul_f32 v77, v125, v125
v_mul_f32 v78, v126, v126
v_mul_f32 v79, v127, v127
v_mul_f32 v80, v156, v156
v_mul_f32 v81, v157, v157
v_mul_f32 v82, v158, v158
v_mul_f32 v83, v159, v159
v_fma_f32 v76, v76, v69, v68
v_fma_f32 v77, v77, v69, v68
buffer_load_dwordx4 v3, s[24:27], s37 offen offset:2048 sc1 lds
v_fma_f32 v78, v78, v69, v68
v_fma_f32 v79, v79, v69, v68
v_fma_f32 v80, v80, v73, v72
v_fma_f32 v81, v81, v73, v72
v_fma_f32 v82, v82, v73, v72
v_fma_f32 v83, v83, v73, v72
v_mul_f32 v76, v76, v124
v_mul_f32 v77, v77, v125
v_mul_f32 v78, v78, v126
v_mul_f32 v79, v79, v127
v_mul_f32 v80, v80, v156
v_mul_f32 v81, v81, v157
v_mul_f32 v82, v82, v158
v_mul_f32 v83, v83, v159
buffer_load_dwordx4 v3, s[24:27], s37 offen offset:3072 sc1 lds
v_exp_f32 v76, v76
v_exp_f32 v77, v77
v_exp_f32 v78, v78
v_exp_f32 v79, v79
v_exp_f32 v80, v80
v_exp_f32 v81, v81
v_exp_f32 v82, v82
s_branch Lov_16
.p2align 12
.fill 128, 4, 0xbf800000
Lst_16_0:
s_branch Lwr_184
s_nop 0
s_nop 0
Lov_16:
v_exp_f32 v83, v83
v_fma_f32 v140, -v60, v44, v140
v_fma_f32 v141, -v60, v45, v141
v_fma_f32 v142, -v60, v46, v142
v_fma_f32 v143, -v60, v47, v143
v_fma_f32 v172, -v62, v44, v172
v_fma_f32 v173, -v62, v45, v173
s_add_u32 s37, s52, 606208
s_add_u32 m0, s39, 98304
s_nop 0
buffer_load_dwordx4 v3, s[24:27], s37 offen sc1 lds
v_fma_f32 v174, -v62, v46, v174
v_fma_f32 v175, -v62, v47, v175
v_fma_f32 v76, v76, v70, v70
v_fma_f32 v77, v77, v70, v70
v_fma_f32 v78, v78, v70, v70
v_fma_f32 v79, v79, v70, v70
v_fma_f32 v80, v80, v74, v74
v_fma_f32 v81, v81, v74, v74
v_fma_f32 v82, v82, v74, v74
v_fma_f32 v83, v83, v74, v74
v_rcp_f32 v76, v76
v_rcp_f32 v77, v77
v_rcp_f32 v78, v78
v_rcp_f32 v79, v79
buffer_load_dwordx4 v3, s[24:27], s37 offen offset:1024 sc1 lds
v_rcp_f32 v80, v80
v_rcp_f32 v81, v81
v_rcp_f32 v82, v82
v_rcp_f32 v83, v83
v_mul_f32 v140, v124, v140
v_mul_f32 v141, v125, v141
v_mul_f32 v142, v126, v142
v_mul_f32 v143, v127, v143
v_mul_f32 v172, v156, v172
v_mul_f32 v173, v157, v173
v_mul_f32 v174, v158, v174
v_mul_f32 v175, v159, v175
v_mul_f32 v140, v140, v76
v_mul_f32 v141, v141, v77
buffer_load_dwordx4 v3, s[24:27], s37 offen offset:2048 sc1 lds
v_mul_f32 v142, v142, v78
v_mul_f32 v143, v143, v79
v_mul_f32 v172, v172, v80
v_mul_f32 v173, v173, v81
v_mul_f32 v174, v174, v82
v_mul_f32 v175, v175, v83
v_cvt_pk_bf16_f32 v124, v140, v141
v_cvt_pk_bf16_f32 v125, v142, v143
v_cvt_pk_bf16_f32 v156, v172, v173
v_cvt_pk_bf16_f32 v157, v174, v175
v_fma_f32 v128, -v60, v32, v128
v_fma_f32 v129, -v60, v33, v129
v_fma_f32 v130, -v60, v34, v130
v_fma_f32 v131, -v60, v35, v131
buffer_load_dwordx4 v3, s[24:27], s37 offen offset:3072 sc1 lds
v_fma_f32 v160, -v62, v32, v160
v_fma_f32 v161, -v62, v33, v161
v_fma_f32 v162, -v62, v34, v162
v_fma_f32 v163, -v62, v35, v163
v_mul_f32 v76, v128, v128
v_mul_f32 v77, v129, v129
v_mul_f32 v78, v130, v130
v_mul_f32 v79, v131, v131
v_mul_f32 v80, v160, v160
v_mul_f32 v81, v161, v161
v_mul_f32 v82, v162, v162
v_mul_f32 v83, v163, v163
v_fma_f32 v76, v76, v69, v68
v_fma_f32 v77, v77, v69, v68
s_add_u32 s38, s53, 4849664
s_add_u32 m0, s39, 114688
s_nop 0
buffer_load_dwordx4 v23, s[28:31], s38 offen lds
v_fma_f32 v78, v78, v69, v68
v_fma_f32 v79, v79, v69, v68
v_fma_f32 v80, v80, v73, v72
v_fma_f32 v81, v81, v73, v72
v_fma_f32 v82, v82, v73, v72
v_fma_f32 v83, v83, v73, v72
v_mul_f32 v76, v76, v128
v_mul_f32 v77, v77, v129
v_mul_f32 v78, v78, v130
v_mul_f32 v79, v79, v131
v_mul_f32 v80, v80, v160
v_mul_f32 v81, v81, v161
v_mul_f32 v82, v82, v162
v_mul_f32 v83, v83, v163
s_add_u32 m0, s39, 115712
s_nop 0
buffer_load_dwordx4 v24, s[28:31], s38 offen lds
v_exp_f32 v76, v76
v_exp_f32 v77, v77
v_exp_f32 v78, v78
v_exp_f32 v79, v79
v_exp_f32 v80, v80
v_exp_f32 v81, v81
v_exp_f32 v82, v82
v_exp_f32 v83, v83
v_fma_f32 v144, -v60, v48, v144
v_fma_f32 v145, -v60, v49, v145
v_fma_f32 v146, -v60, v50, v146
v_fma_f32 v147, -v60, v51, v147
v_fma_f32 v176, -v62, v48, v176
v_fma_f32 v177, -v62, v49, v177
s_add_u32 m0, s39, 116736
s_add_u32 s38, s38, 16384
buffer_load_dwordx4 v23, s[28:31], s38 offen lds
s_add_u32 m0, s39, 117760
s_nop 0
buffer_load_dwordx4 v24, s[28:31], s38 offen lds
s_barrier
s_add_u32 s38, s53, 4718592
s_add_u32 m0, s39, 147456
s_nop 0
buffer_load_dwordx4 v23, s[28:31], s38 offen lds
v_fma_f32 v178, -v62, v50, v178
v_fma_f32 v179, -v62, v51, v179
v_fma_f32 v76, v76, v70, v70
v_fma_f32 v77, v77, v70, v70
v_fma_f32 v78, v78, v70, v70
v_fma_f32 v79, v79, v70, v70
v_fma_f32 v80, v80, v74, v74
v_fma_f32 v81, v81, v74, v74
v_fma_f32 v82, v82, v74, v74
v_fma_f32 v83, v83, v74, v74
v_rcp_f32 v76, v76
v_rcp_f32 v77, v77
v_rcp_f32 v78, v78
v_rcp_f32 v79, v79
s_add_u32 m0, s39, 148480
s_nop 0
buffer_load_dwordx4 v24, s[28:31], s38 offen lds
v_rcp_f32 v80, v80
v_rcp_f32 v81, v81
v_rcp_f32 v82, v82
v_rcp_f32 v83, v83
v_mul_f32 v144, v128, v144
v_mul_f32 v145, v129, v145
v_mul_f32 v146, v130, v146
v_mul_f32 v147, v131, v147
v_mul_f32 v176, v160, v176
v_mul_f32 v177, v161, v177
v_mul_f32 v178, v162, v178
v_mul_f32 v179, v163, v179
v_mul_f32 v144, v144, v76
v_mul_f32 v145, v145, v77
s_add_u32 m0, s39, 149504
s_add_u32 s38, s38, 16384
buffer_load_dwordx4 v23, s[28:31], s38 offen lds
v_mul_f32 v146, v146, v78
v_mul_f32 v147, v147, v79
v_mul_f32 v176, v176, v80
v_mul_f32 v177, v177, v81
v_mul_f32 v178, v178, v82
v_mul_f32 v179, v179, v83
v_cvt_pk_bf16_f32 v126, v144, v145
v_cvt_pk_bf16_f32 v127, v146, v147
v_cvt_pk_bf16_f32 v158, v176, v177
v_cvt_pk_bf16_f32 v159, v178, v179
buffer_store_dwordx4 v[124:127], v2, s[24:27], s54 offen offset:0 sc1
buffer_store_dwordx4 v[156:159], v2, s[24:27], s54 offen offset:1024 sc1
v_fma_f32 v132, -v60, v36, v132
v_fma_f32 v133, -v60, v37, v133
s_add_u32 m0, s39, 150528
s_nop 0
buffer_load_dwordx4 v24, s[28:31], s38 offen lds
v_fma_f32 v134, -v60, v38, v134
v_fma_f32 v135, -v60, v39, v135
v_fma_f32 v164, -v62, v36, v164
v_fma_f32 v165, -v62, v37, v165
v_fma_f32 v166, -v62, v38, v166
v_fma_f32 v167, -v62, v39, v167
v_mul_f32 v76, v132, v132
v_mul_f32 v77, v133, v133
v_mul_f32 v78, v134, v134
v_mul_f32 v79, v135, v135
v_mul_f32 v80, v164, v164
v_mul_f32 v81, v165, v165
v_mul_f32 v82, v166, v166
v_mul_f32 v83, v167, v167
s_add_u32 s37, s52, 622592
s_add_u32 m0, s39, 131072
s_nop 0
buffer_load_dwordx4 v3, s[24:27], s37 offen sc1 lds
v_fma_f32 v76, v76, v69, v68
v_fma_f32 v77, v77, v69, v68
v_fma_f32 v78, v78, v69, v68
v_fma_f32 v79, v79, v69, v68
v_fma_f32 v80, v80, v73, v72
v_fma_f32 v81, v81, v73, v72
v_fma_f32 v82, v82, v73, v72
v_fma_f32 v83, v83, v73, v72
v_mul_f32 v76, v76, v132
v_mul_f32 v77, v77, v133
v_mul_f32 v78, v78, v134
v_mul_f32 v79, v79, v135
v_mul_f32 v80, v80, v164
v_mul_f32 v81, v81, v165
buffer_load_dwordx4 v3, s[24:27], s37 offen offset:1024 sc1 lds
v_mul_f32 v82, v82, v166
v_mul_f32 v83, v83, v167
v_exp_f32 v76, v76
v_exp_f32 v77, v77
v_exp_f32 v78, v78
v_exp_f32 v79, v79
v_exp_f32 v80, v80
v_exp_f32 v81, v81
v_exp_f32 v82, v82
v_exp_f32 v83, v83
v_fma_f32 v148, -v60, v52, v148
v_fma_f32 v149, -v60, v53, v149
v_fma_f32 v150, -v60, v54, v150
v_fma_f32 v151, -v60, v55, v151
buffer_load_dwordx4 v3, s[24:27], s37 offen offset:2048 sc1 lds
v_fma_f32 v180, -v62, v52, v180
v_fma_f32 v181, -v62, v53, v181
v_fma_f32 v182, -v62, v54, v182
v_fma_f32 v183, -v62, v55, v183
v_fma_f32 v76, v76, v70, v70
v_fma_f32 v77, v77, v70, v70
v_fma_f32 v78, v78, v70, v70
v_fma_f32 v79, v79, v70, v70
v_fma_f32 v80, v80, v74, v74
v_fma_f32 v81, v81, v74, v74
v_fma_f32 v82, v82, v74, v74
v_fma_f32 v83, v83, v74, v74
v_rcp_f32 v76, v76
v_rcp_f32 v77, v77
buffer_load_dwordx4 v3, s[24:27], s37 offen offset:3072 sc1 lds
v_rcp_f32 v78, v78
v_rcp_f32 v79, v79
v_rcp_f32 v80, v80
v_rcp_f32 v81, v81
v_rcp_f32 v82, v82
v_rcp_f32 v83, v83
v_mul_f32 v148, v132, v148
v_mul_f32 v149, v133, v149
v_mul_f32 v150, v134, v150
v_mul_f32 v151, v135, v151
v_mul_f32 v180, v164, v180
v_mul_f32 v181, v165, v181
v_mul_f32 v182, v166, v182
v_mul_f32 v183, v167, v183
s_add_u32 s38, s53, 4980736
s_add_u32 m0, s39, 0
s_nop 0
buffer_load_dwordx4 v23, s[28:31], s38 offen lds
v_mul_f32 v148, v148, v76
v_mul_f32 v149, v149, v77
v_mul_f32 v150, v150, v78
v_mul_f32 v151, v151, v79
v_mul_f32 v180, v180, v80
v_mul_f32 v181, v181, v81
v_mul_f32 v182, v182, v82
v_mul_f32 v183, v183, v83
v_cvt_pk_bf16_f32 v132, v148, v149
v_cvt_pk_bf16_f32 v133, v150, v151
v_cvt_pk_bf16_f32 v164, v180, v181
v_cvt_pk_bf16_f32 v165, v182, v183
v_fma_f32 v136, -v60, v40, v136
v_fma_f32 v137, -v60, v41, v137
s_add_u32 m0, s39, 1024
s_nop 0
buffer_load_dwordx4 v24, s[28:31], s38 offen lds
v_fma_f32 v138, -v60, v42, v138
v_fma_f32 v139, -v60, v43, v139
v_fma_f32 v168, -v62, v40, v168
v_fma_f32 v169, -v62, v41, v169
v_fma_f32 v170, -v62, v42, v170
v_fma_f32 v171, -v62, v43, v171
v_mul_f32 v76, v136, v136
v_mul_f32 v77, v137, v137
v_mul_f32 v78, v138, v138
v_mul_f32 v79, v139, v139
v_mul_f32 v80, v168, v168
v_mul_f32 v81, v169, v169
v_mul_f32 v82, v170, v170
v_mul_f32 v83, v171, v171
s_add_u32 m0, s39, 2048
s_add_u32 s38, s38, 16384
buffer_load_dwordx4 v23, s[28:31], s38 offen lds
s_add_u32 m0, s39, 3072
s_nop 0
buffer_load_dwordx4 v24, s[28:31], s38 offen lds
s_barrier
s_add_u32 s37, s52, 638976
s_add_u32 m0, s39, 16384
s_nop 0
buffer_load_dwordx4 v3, s[24:27], s37 offen sc1 lds
v_fma_f32 v76, v76, v69, v68
v_fma_f32 v77, v77, v69, v68
v_fma_f32 v78, v78, v69, v68
v_fma_f32 v79, v79, v69, v68
v_fma_f32 v80, v80, v73, v72
v_fma_f32 v81, v81, v73, v72
v_fma_f32 v82, v82, v73, v72
v_fma_f32 v83, v83, v73, v72
v_mul_f32 v76, v76, v136
v_mul_f32 v77, v77, v137
v_mul_f32 v78, v78, v138
v_mul_f32 v79, v79, v139
v_mul_f32 v80, v80, v168
v_mul_f32 v81, v81, v169
v_mul_f32 v82, v82, v170
v_mul_f32 v83, v83, v171
v_exp_f32 v76, v76
v_exp_f32 v77, v77
v_exp_f32 v78, v78
v_exp_f32 v79, v79
v_exp_f32 v80, v80
v_exp_f32 v81, v81
v_exp_f32 v82, v82
buffer_load_dwordx4 v3, s[24:27], s37 offen offset:1024 sc1 lds
v_exp_f32 v83, v83
v_fma_f32 v152, -v60, v56, v152
v_fma_f32 v153, -v60, v57, v153
v_fma_f32 v154, -v60, v58, v154
v_fma_f32 v155, -v60, v59, v155
v_fma_f32 v184, -v62, v56, v184
v_fma_f32 v185, -v62, v57, v185
v_fma_f32 v186, -v62, v58, v186
v_fma_f32 v187, -v62, v59, v187
v_fma_f32 v76, v76, v70, v70
v_fma_f32 v77, v77, v70, v70
v_fma_f32 v78, v78, v70, v70
v_fma_f32 v79, v79, v70, v70
v_fma_f32 v80, v80, v74, v74
v_fma_f32 v81, v81, v74, v74
v_fma_f32 v82, v82, v74, v74
v_fma_f32 v83, v83, v74, v74
v_rcp_f32 v76, v76
v_rcp_f32 v77, v77
v_rcp_f32 v78, v78
v_rcp_f32 v79, v79
v_rcp_f32 v80, v80
v_rcp_f32 v81, v81
buffer_load_dwordx4 v3, s[24:27], s37 offen offset:2048 sc1 lds
v_rcp_f32 v82, v82
v_rcp_f32 v83, v83
v_mul_f32 v152, v136, v152
v_mul_f32 v153, v137, v153
v_mul_f32 v154, v138, v154
v_mul_f32 v155, v139, v155
v_mul_f32 v184, v168, v184
v_mul_f32 v185, v169, v185
v_mul_f32 v186, v170, v186
v_mul_f32 v187, v171, v187
v_mul_f32 v152, v152, v76
v_mul_f32 v153, v153, v77
v_mul_f32 v154, v154, v78
v_mul_f32 v155, v155, v79
v_mul_f32 v184, v184, v80
v_mul_f32 v185, v185, v81
v_mul_f32 v186, v186, v82
v_mul_f32 v187, v187, v83
v_cvt_pk_bf16_f32 v134, v152, v153
v_cvt_pk_bf16_f32 v135, v154, v155
v_cvt_pk_bf16_f32 v166, v184, v185
v_cvt_pk_bf16_f32 v167, v186, v187
buffer_store_dwordx4 v[132:135], v2, s[24:27], s55 offen offset:0 sc1
buffer_store_dwordx4 v[164:167], v2, s[24:27], s55 offen offset:1024 sc1
buffer_load_dwordx4 v3, s[24:27], s37 offen offset:3072 sc1 lds
v_mul_f32 v70, v65, v65
v_mul_f32 v68, 0xc0135761, v65
v_mul_f32 v69, 0xbdd2d3e8, v65
v_mul_f32 v69, v69, v70
v_rcp_f32 v70, v70
v_mul_f32 v74, v67, v67
v_mul_f32 v72, 0xc0135761, v67
v_mul_f32 v73, 0xbdd2d3e8, v67
v_mul_f32 v73, v73, v74
v_rcp_f32 v74, v74
v_fma_f32 v188, -v64, v28, v188
v_fma_f32 v189, -v64, v29, v189
v_fma_f32 v190, -v64, v30, v190
v_fma_f32 v191, -v64, v31, v191
v_fma_f32 v220, -v66, v28, v220
v_fma_f32 v221, -v66, v29, v221
v_fma_f32 v222, -v66, v30, v222
v_fma_f32 v223, -v66, v31, v223
v_mul_f32 v76, v188, v188
v_mul_f32 v77, v189, v189
v_mul_f32 v78, v190, v190
v_mul_f32 v79, v191, v191
v_mul_f32 v80, v220, v220
s_add_u32 s38, s53, 5111808
s_add_u32 m0, s39, 32768
s_nop 0
buffer_load_dwordx4 v23, s[28:31], s38 offen lds
v_mul_f32 v81, v221, v221
v_mul_f32 v82, v222, v222
v_mul_f32 v83, v223, v223
v_fma_f32 v76, v76, v69, v68
v_fma_f32 v77, v77, v69, v68
v_fma_f32 v78, v78, v69, v68
v_fma_f32 v79, v79, v69, v68
v_fma_f32 v80, v80, v73, v72
v_fma_f32 v81, v81, v73, v72
v_fma_f32 v82, v82, v73, v72
v_fma_f32 v83, v83, v73, v72
v_mul_f32 v76, v76, v188
v_mul_f32 v77, v77, v189
v_mul_f32 v78, v78, v190
v_mul_f32 v79, v79, v191
v_mul_f32 v80, v80, v220
v_mul_f32 v81, v81, v221
v_mul_f32 v82, v82, v222
v_mul_f32 v83, v83, v223
v_exp_f32 v76, v76
v_exp_f32 v77, v77
v_exp_f32 v78, v78
v_exp_f32 v79, v79
s_add_u32 m0, s39, 33792
s_nop 0
buffer_load_dwordx4 v24, s[28:31], s38 offen lds
v_exp_f32 v80, v80
v_exp_f32 v81, v81
v_exp_f32 v82, v82
v_exp_f32 v83, v83
v_fma_f32 v204, -v64, v44, v204
v_fma_f32 v205, -v64, v45, v205
v_fma_f32 v206, -v64, v46, v206
v_fma_f32 v207, -v64, v47, v207
v_fma_f32 v236, -v66, v44, v236
v_fma_f32 v237, -v66, v45, v237
v_fma_f32 v238, -v66, v46, v238
v_fma_f32 v239, -v66, v47, v239
v_fma_f32 v76, v76, v70, v70
v_fma_f32 v77, v77, v70, v70
v_fma_f32 v78, v78, v70, v70
v_fma_f32 v79, v79, v70, v70
v_fma_f32 v80, v80, v74, v74
v_fma_f32 v81, v81, v74, v74
v_fma_f32 v82, v82, v74, v74
v_fma_f32 v83, v83, v74, v74
v_rcp_f32 v76, v76
v_rcp_f32 v77, v77
v_rcp_f32 v78, v78
v_rcp_f32 v79, v79
s_add_u32 m0, s39, 34816
s_add_u32 s38, s38, 16384
buffer_load_dwordx4 v23, s[28:31], s38 offen lds
s_add_u32 m0, s39, 35840
s_nop 0
buffer_load_dwordx4 v24, s[28:31], s38 offen lds
s_waitcnt vmcnt(18)
s_barrier
s_add_u32 s37, s52, 655360
s_add_u32 m0, s39, 49152
s_nop 0
buffer_load_dwordx4 v3, s[24:27], s37 offen sc1 lds
v_rcp_f32 v80, v80
v_rcp_f32 v81, v81
v_rcp_f32 v82, v82
v_rcp_f32 v83, v83
v_mul_f32 v204, v188, v204
v_mul_f32 v205, v189, v205
v_mul_f32 v206, v190, v206
v_mul_f32 v207, v191, v207
v_mul_f32 v236, v220, v236
v_mul_f32 v237, v221, v237
v_mul_f32 v238, v222, v238
v_mul_f32 v239, v223, v239
v_mul_f32 v204, v204, v76
v_mul_f32 v205, v205, v77
v_mul_f32 v206, v206, v78
v_mul_f32 v207, v207, v79
v_mul_f32 v236, v236, v80
v_mul_f32 v237, v237, v81
v_mul_f32 v238, v238, v82
v_mul_f32 v239, v239, v83
v_cvt_pk_bf16_f32 v188, v204, v205
v_cvt_pk_bf16_f32 v189, v206, v207
v_cvt_pk_bf16_f32 v220, v236, v237
buffer_load_dwordx4 v3, s[24:27], s37 offen offset:1024 sc1 lds
v_cvt_pk_bf16_f32 v221, v238, v239
v_fma_f32 v192, -v64, v32, v192
v_fma_f32 v193, -v64, v33, v193
v_fma_f32 v194, -v64, v34, v194
v_fma_f32 v195, -v64, v35, v195
v_fma_f32 v224, -v66, v32, v224
v_fma_f32 v225, -v66, v33, v225
v_fma_f32 v226, -v66, v34, v226
v_fma_f32 v227, -v66, v35, v227
v_mul_f32 v76, v192, v192
v_mul_f32 v77, v193, v193
v_mul_f32 v78, v194, v194
v_mul_f32 v79, v195, v195
v_mul_f32 v80, v224, v224
v_mul_f32 v81, v225, v225
v_mul_f32 v82, v226, v226
v_mul_f32 v83, v227, v227
v_fma_f32 v76, v76, v69, v68
v_fma_f32 v77, v77, v69, v68
v_fma_f32 v78, v78, v69, v68
v_fma_f32 v79, v79, v69, v68
v_fma_f32 v80, v80, v73, v72
v_fma_f32 v81, v81, v73, v72
buffer_load_dwordx4 v3, s[24:27], s37 offen offset:2048 sc1 lds
v_fma_f32 v82, v82, v73, v72
v_fma_f32 v83, v83, v73, v72
v_mul_f32 v76, v76, v192
v_mul_f32 v77, v77, v193
v_mul_f32 v78, v78, v194
v_mul_f32 v79, v79, v195
v_mul_f32 v80, v80, v224
v_mul_f32 v81, v81, v225
v_mul_f32 v82, v82, v226
v_mul_f32 v83, v83, v227
v_exp_f32 v76, v76
v_exp_f32 v77, v77
v_exp_f32 v78, v78
v_exp_f32 v79, v79
v_exp_f32 v80, v80
v_exp_f32 v81, v81
v_exp_f32 v82, v82
v_exp_f32 v83, v83
v_fma_f32 v208, -v64, v48, v208
v_fma_f32 v209, -v64, v49, v209
v_fma_f32 v210, -v64, v50, v210
v_fma_f32 v211, -v64, v51, v211
v_fma_f32 v240, -v66, v48, v240
v_fma_f32 v241, -v66, v49, v241
buffer_load_dwordx4 v3, s[24:27], s37 offen offset:3072 sc1 lds
v_fma_f32 v242, -v66, v50, v242
v_fma_f32 v243, -v66, v51, v243
v_fma_f32 v76, v76, v70, v70
v_fma_f32 v77, v77, v70, v70
v_fma_f32 v78, v78, v70, v70
v_fma_f32 v79, v79, v70, v70
v_fma_f32 v80, v80, v74, v74
v_fma_f32 v81, v81, v74, v74
v_fma_f32 v82, v82, v74, v74
v_fma_f32 v83, v83, v74, v74
v_rcp_f32 v76, v76
v_rcp_f32 v77, v77
v_rcp_f32 v78, v78
v_rcp_f32 v79, v79
v_rcp_f32 v80, v80
v_rcp_f32 v81, v81
v_rcp_f32 v82, v82
v_rcp_f32 v83, v83
v_mul_f32 v208, v192, v208
v_mul_f32 v209, v193, v209
v_mul_f32 v210, v194, v210
v_mul_f32 v211, v195, v211
v_mul_f32 v240, v224, v240
s_add_u32 s38, s53, 5242880
s_add_u32 m0, s39, 65536
s_nop 0
buffer_load_dwordx4 v23, s[28:31], s38 offen lds
v_mul_f32 v241, v225, v241
v_mul_f32 v242, v226, v242
v_mul_f32 v243, v227, v243
v_mul_f32 v208, v208, v76
v_mul_f32 v209, v209, v77
v_mul_f32 v210, v210, v78
v_mul_f32 v211, v211, v79
v_mul_f32 v240, v240, v80
v_mul_f32 v241, v241, v81
v_mul_f32 v242, v242, v82
v_mul_f32 v243, v243, v83
v_cvt_pk_bf16_f32 v190, v208, v209
v_cvt_pk_bf16_f32 v191, v210, v211
v_cvt_pk_bf16_f32 v222, v240, v241
v_cvt_pk_bf16_f32 v223, v242, v243
buffer_store_dwordx4 v[188:191], v2, s[24:27], s54 offen offset:2048 sc1
buffer_store_dwordx4 v[220:223], v2, s[24:27], s54 offen offset:3072 sc1
v_fma_f32 v196, -v64, v36, v196
v_fma_f32 v197, -v64, v37, v197
v_fma_f32 v198, -v64, v38, v198
v_fma_f32 v199, -v64, v39, v199
v_fma_f32 v228, -v66, v36, v228
v_fma_f32 v229, -v66, v37, v229
s_add_u32 m0, s39, 66560
s_nop 0
buffer_load_dwordx4 v24, s[28:31], s38 offen lds
v_fma_f32 v230, -v66, v38, v230
v_fma_f32 v231, -v66, v39, v231
v_mul_f32 v76, v196, v196
v_mul_f32 v77, v197, v197
v_mul_f32 v78, v198, v198
v_mul_f32 v79, v199, v199
v_mul_f32 v80, v228, v228
v_mul_f32 v81, v229, v229
v_mul_f32 v82, v230, v230
v_mul_f32 v83, v231, v231
v_fma_f32 v76, v76, v69, v68
v_fma_f32 v77, v77, v69, v68
v_fma_f32 v78, v78, v69, v68
v_fma_f32 v79, v79, v69, v68
v_fma_f32 v80, v80, v73, v72
v_fma_f32 v81, v81, v73, v72
v_fma_f32 v82, v82, v73, v72
v_fma_f32 v83, v83, v73, v72
v_mul_f32 v76, v76, v196
v_mul_f32 v77, v77, v197
s_branch Lov_17
.p2align 12
.fill 128, 4, 0xbf800000
Lst_17_0:
s_branch Lwr_185
s_nop 0
s_nop 0
Lov_17:
v_mul_f32 v78, v78, v198
v_mul_f32 v79, v79, v199
v_mul_f32 v80, v80, v228
v_mul_f32 v81, v81, v229
s_add_u32 m0, s39, 67584
s_add_u32 s38, s38, 16384
buffer_load_dwordx4 v23, s[28:31], s38 offen lds
s_add_u32 m0, s39, 68608
s_nop 0
buffer_load_dwordx4 v24, s[28:31], s38 offen lds
s_waitcnt vmcnt(34)
s_barrier
s_add_u32 s37, s52, 671744
s_add_u32 m0, s39, 81920
s_nop 0
buffer_load_dwordx4 v3, s[24:27], s37 offen sc1 lds
v_mul_f32 v82, v82, v230
v_mul_f32 v83, v83, v231
v_exp_f32 v76, v76
v_exp_f32 v77, v77
v_exp_f32 v78, v78
v_exp_f32 v79, v79
v_exp_f32 v80, v80
v_exp_f32 v81, v81
v_exp_f32 v82, v82
v_exp_f32 v83, v83
v_fma_f32 v212, -v64, v52, v212
v_fma_f32 v213, -v64, v53, v213
v_fma_f32 v214, -v64, v54, v214
v_fma_f32 v215, -v64, v55, v215
v_fma_f32 v244, -v66, v52, v244
v_fma_f32 v245, -v66, v53, v245
v_fma_f32 v246, -v66, v54, v246
v_fma_f32 v247, -v66, v55, v247
v_fma_f32 v76, v76, v70, v70
v_fma_f32 v77, v77, v70, v70
v_fma_f32 v78, v78, v70, v70
v_fma_f32 v79, v79, v70, v70
v_fma_f32 v80, v80, v74, v74
buffer_load_dwordx4 v3, s[24:27], s37 offen offset:1024 sc1 lds
v_fma_f32 v81, v81, v74, v74
v_fma_f32 v82, v82, v74, v74
v_fma_f32 v83, v83, v74, v74
v_rcp_f32 v76, v76
v_rcp_f32 v77, v77
v_rcp_f32 v78, v78
v_rcp_f32 v79, v79
v_rcp_f32 v80, v80
v_rcp_f32 v81, v81
v_rcp_f32 v82, v82
v_rcp_f32 v83, v83
v_mul_f32 v212, v196, v212
v_mul_f32 v213, v197, v213
v_mul_f32 v214, v198, v214
v_mul_f32 v215, v199, v215
v_mul_f32 v244, v228, v244
v_mul_f32 v245, v229, v245
v_mul_f32 v246, v230, v246
v_mul_f32 v247, v231, v247
v_mul_f32 v212, v212, v76
v_mul_f32 v213, v213, v77
v_mul_f32 v214, v214, v78
v_mul_f32 v215, v215, v79
buffer_load_dwordx4 v3, s[24:27], s37 offen offset:2048 sc1 lds
v_mul_f32 v244, v244, v80
v_mul_f32 v245, v245, v81
v_mul_f32 v246, v246, v82
v_mul_f32 v247, v247, v83
v_cvt_pk_bf16_f32 v196, v212, v213
v_cvt_pk_bf16_f32 v197, v214, v215
v_cvt_pk_bf16_f32 v228, v244, v245
v_cvt_pk_bf16_f32 v229, v246, v247
v_fma_f32 v200, -v64, v40, v200
v_fma_f32 v201, -v64, v41, v201
v_fma_f32 v202, -v64, v42, v202
v_fma_f32 v203, -v64, v43, v203
v_fma_f32 v232, -v66, v40, v232
v_fma_f32 v233, -v66, v41, v233
v_fma_f32 v234, -v66, v42, v234
v_fma_f32 v235, -v66, v43, v235
v_mul_f32 v76, v200, v200
v_mul_f32 v77, v201, v201
v_mul_f32 v78, v202, v202
v_mul_f32 v79, v203, v203
v_mul_f32 v80, v232, v232
v_mul_f32 v81, v233, v233
v_mul_f32 v82, v234, v234
v_mul_f32 v83, v235, v235
buffer_load_dwordx4 v3, s[24:27], s37 offen offset:3072 sc1 lds
v_fma_f32 v76, v76, v69, v68
v_fma_f32 v77, v77, v69, v68
v_fma_f32 v78, v78, v69, v68
v_fma_f32 v79, v79, v69, v68
v_fma_f32 v80, v80, v73, v72
v_fma_f32 v81, v81, v73, v72
v_fma_f32 v82, v82, v73, v72
v_fma_f32 v83, v83, v73, v72
v_mul_f32 v76, v76, v200
v_mul_f32 v77, v77, v201
v_mul_f32 v78, v78, v202
v_mul_f32 v79, v79, v203
v_mul_f32 v80, v80, v232
v_mul_f32 v81, v81, v233
v_mul_f32 v82, v82, v234
v_mul_f32 v83, v83, v235
v_exp_f32 v76, v76
v_exp_f32 v77, v77
v_exp_f32 v78, v78
v_exp_f32 v79, v79
v_exp_f32 v80, v80
v_exp_f32 v81, v81
v_exp_f32 v82, v82
s_add_u32 s38, s53, 5373952
s_add_u32 m0, s39, 147456
s_nop 0
buffer_load_dwordx4 v23, s[28:31], s38 offen lds
v_exp_f32 v83, v83
v_fma_f32 v216, -v64, v56, v216
v_fma_f32 v217, -v64, v57, v217
v_fma_f32 v218, -v64, v58, v218
v_fma_f32 v219, -v64, v59, v219
v_fma_f32 v248, -v66, v56, v248
v_fma_f32 v249, -v66, v57, v249
v_fma_f32 v250, -v66, v58, v250
v_fma_f32 v251, -v66, v59, v251
v_fma_f32 v76, v76, v70, v70
v_fma_f32 v77, v77, v70, v70
v_fma_f32 v78, v78, v70, v70
v_fma_f32 v79, v79, v70, v70
v_fma_f32 v80, v80, v74, v74
v_fma_f32 v81, v81, v74, v74
v_fma_f32 v82, v82, v74, v74
v_fma_f32 v83, v83, v74, v74
v_rcp_f32 v76, v76
v_rcp_f32 v77, v77
v_rcp_f32 v78, v78
v_rcp_f32 v79, v79
v_rcp_f32 v80, v80
v_rcp_f32 v81, v81
s_add_u32 m0, s39, 148480
s_nop 0
buffer_load_dwordx4 v24, s[28:31], s38 offen lds
v_rcp_f32 v82, v82
v_rcp_f32 v83, v83
v_mul_f32 v216, v200, v216
v_mul_f32 v217, v201, v217
v_mul_f32 v218, v202, v218
v_mul_f32 v219, v203, v219
v_mul_f32 v248, v232, v248
v_mul_f32 v249, v233, v249
v_mul_f32 v250, v234, v250
v_mul_f32 v251, v235, v251
v_mul_f32 v216, v216, v76
v_mul_f32 v217, v217, v77
v_mul_f32 v218, v218, v78
v_mul_f32 v219, v219, v79
v_mul_f32 v248, v248, v80
v_mul_f32 v249, v249, v81
v_mul_f32 v250, v250, v82
v_mul_f32 v251, v251, v83
v_cvt_pk_bf16_f32 v198, v216, v217
v_cvt_pk_bf16_f32 v199, v218, v219
v_cvt_pk_bf16_f32 v230, v248, v249
v_cvt_pk_bf16_f32 v231, v250, v251
buffer_store_dwordx4 v[196:199], v2, s[24:27], s55 offen offset:2048 sc1
buffer_store_dwordx4 v[228:231], v2, s[24:27], s55 offen offset:3072 sc1
s_add_u32 m0, s39, 149504
s_add_u32 s38, s38, 16384
buffer_load_dwordx4 v23, s[28:31], s38 offen lds
s_add_u32 m0, s39, 150528
s_nop 0
buffer_load_dwordx4 v24, s[28:31], s38 offen lds
s_waitcnt vmcnt(30)
s_barrier
s_add_u32 s37, s52, 688128
s_add_u32 m0, s39, 98304
s_nop 0
buffer_load_dwordx4 v3, s[24:27], s37 offen sc1 lds
buffer_load_dwordx4 v3, s[24:27], s37 offen offset:1024 sc1 lds
buffer_load_dwordx4 v3, s[24:27], s37 offen offset:2048 sc1 lds
buffer_load_dwordx4 v3, s[24:27], s37 offen offset:3072 sc1 lds
s_add_u32 s38, s53, 5505024
s_add_u32 m0, s39, 114688
s_nop 0
buffer_load_dwordx4 v23, s[28:31], s38 offen lds
s_add_u32 m0, s39, 115712
s_nop 0
buffer_load_dwordx4 v24, s[28:31], s38 offen lds
s_add_u32 m0, s39, 116736
s_add_u32 s38, s38, 16384
buffer_load_dwordx4 v23, s[28:31], s38 offen lds
s_add_u32 m0, s39, 117760
s_nop 0
buffer_load_dwordx4 v24, s[28:31], s38 offen lds
s_waitcnt vmcnt(10)
s_barrier
s_cmp_eq_u32 s47, 0
s_cbranch_scc0 Lw_148
s_add_u32 s7, s34, 48
s_lshl_b32 s7, s7, 7
v_mov_b32 v26, s7
v_mov_b32 v27, 1
s_mov_b64 exec, 1
buffer_atomic_add v27, v26, s[56:59], 0 offen sc1
s_mov_b64 exec, -1
Lw_148:
s_add_u32 s37, s52, 704512
s_add_u32 m0, s39, 131072
s_nop 0
buffer_load_dwordx4 v3, s[24:27], s37 offen sc1 lds
buffer_load_dwordx4 v3, s[24:27], s37 offen offset:1024 sc1 lds
buffer_load_dwordx4 v3, s[24:27], s37 offen offset:2048 sc1 lds
buffer_load_dwordx4 v3, s[24:27], s37 offen offset:3072 sc1 lds
s_add_u32 s38, s53, 5636096
s_add_u32 m0, s39, 0
s_nop 0
buffer_load_dwordx4 v23, s[28:31], s38 offen lds
s_add_u32 m0, s39, 1024
s_nop 0
buffer_load_dwordx4 v24, s[28:31], s38 offen lds
s_add_u32 m0, s39, 2048
s_add_u32 s38, s38, 16384
buffer_load_dwordx4 v23, s[28:31], s38 offen lds
s_add_u32 m0, s39, 3072
s_nop 0
buffer_load_dwordx4 v24, s[28:31], s38 offen lds
s_waitcnt vmcnt(26)
s_barrier
s_add_u32 s38, s91, 0
s_add_u32 m0, s39, 32768
s_nop 0
buffer_load_dwordx4 v23, s[28:31], s38 offen lds
s_add_u32 m0, s39, 33792
s_nop 0
buffer_load_dwordx4 v24, s[28:31], s38 offen lds
s_add_u32 m0, s39, 34816
s_add_u32 s38, s38, 16384
buffer_load_dwordx4 v23, s[28:31], s38 offen lds
s_add_u32 m0, s39, 35840
s_nop 0
buffer_load_dwordx4 v24, s[28:31], s38 offen lds
s_waitcnt vmcnt(20)
s_barrier
s_add_u32 s38, s91, 131072
s_add_u32 m0, s39, 65536
s_nop 0
buffer_load_dwordx4 v23, s[28:31], s38 offen lds
s_add_u32 m0, s39, 66560
s_nop 0
buffer_load_dwordx4 v24, s[28:31], s38 offen lds
s_add_u32 m0, s39, 67584
s_add_u32 s38, s38, 16384
buffer_load_dwordx4 v23, s[28:31], s38 offen lds
s_add_u32 m0, s39, 68608
s_nop 0
buffer_load_dwordx4 v24, s[28:31], s38 offen lds
s_waitcnt vmcnt(16)
s_barrier
s_cmp_eq_u32 s47, 3
s_cbranch_scc0 Lw_149
s_lshl_b32 s92, s34, 7
s_add_u32 s92, s92, 28317696
s_load_dword s93, s[82:83], s92 glc
Lw_149:
s_add_u32 s38, s91, 262144
s_add_u32 m0, s39, 147456
s_nop 0
buffer_load_dwordx4 v23, s[28:31], s38 offen lds
s_add_u32 m0, s39, 148480
s_nop 0
buffer_load_dwordx4 v24, s[28:31], s38 offen lds
s_add_u32 m0, s39, 149504
s_add_u32 s38, s38, 16384
buffer_load_dwordx4 v23, s[28:31], s38 offen lds
s_add_u32 m0, s39, 150528
s_nop 0
buffer_load_dwordx4 v24, s[28:31], s38 offen lds
s_waitcnt vmcnt(12)
s_cmp_eq_u32 s47, 3
s_cbranch_scc0 Lw_150
s_mov_b32 s41, 0x40000
s_branch Lpchk_153
Lpoll_151:
s_load_dword s93, s[82:83], s92 glc
Lpchk_153:
s_waitcnt lgkmcnt(0)
s_cmp_eq_u32 s93, 16
s_cbranch_scc1 Lpok_152
s_sub_u32 s41, s41, 1
s_cmp_lg_u32 s41, 0
s_cbranch_scc1 Lpoll_151
Lpok_152:
Lw_150:
s_barrier
s_add_u32 s37, s90, 0
s_add_u32 m0, s39, 16384
s_nop 0
buffer_load_dwordx4 v3, s[24:27], s37 offen sc1 lds
buffer_load_dwordx4 v3, s[24:27], s37 offen offset:1024 sc1 lds
buffer_load_dwordx4 v3, s[24:27], s37 offen offset:2048 sc1 lds
buffer_load_dwordx4 v3, s[24:27], s37 offen offset:3072 sc1 lds
s_add_u32 s37, s90, 16384
s_add_u32 m0, s39, 49152
s_nop 0
buffer_load_dwordx4 v3, s[24:27], s37 offen sc1 lds
buffer_load_dwordx4 v3, s[24:27], s37 offen offset:1024 sc1 lds
buffer_load_dwordx4 v3, s[24:27], s37 offen offset:2048 sc1 lds
buffer_load_dwordx4 v3, s[24:27], s37 offen offset:3072 sc1 lds
s_add_u32 s37, s90, 32768
s_add_u32 m0, s39, 81920
s_nop 0
buffer_load_dwordx4 v3, s[24:27], s37 offen sc1 lds
buffer_load_dwordx4 v3, s[24:27], s37 offen offset:1024 sc1 lds
buffer_load_dwordx4 v3, s[24:27], s37 offen offset:2048 sc1 lds
buffer_load_dwordx4 v3, s[24:27], s37 offen offset:3072 sc1 lds
s_add_u32 s37, s90, 49152
s_add_u32 m0, s39, 98304
s_nop 0
buffer_load_dwordx4 v3, s[24:27], s37 offen sc1 lds
buffer_load_dwordx4 v3, s[24:27], s37 offen offset:1024 sc1 lds
buffer_load_dwordx4 v3, s[24:27], s37 offen offset:2048 sc1 lds
buffer_load_dwordx4 v3, s[24:27], s37 offen offset:3072 sc1 lds
s_add_u32 s38, s91, 393216
s_add_u32 m0, s39, 114688
s_nop 0
buffer_load_dwordx4 v23, s[28:31], s38 offen lds
s_add_u32 m0, s39, 115712
s_nop 0
buffer_load_dwordx4 v24, s[28:31], s38 offen lds
s_add_u32 m0, s39, 116736
s_add_u32 s38, s38, 16384
buffer_load_dwordx4 v23, s[28:31], s38 offen lds
s_add_u32 m0, s39, 117760
s_nop 0
buffer_load_dwordx4 v24, s[28:31], s38 offen lds
s_waitcnt vmcnt(16)
s_barrier
s_add_u32 s37, s90, 65536
s_add_u32 m0, s39, 131072
s_nop 0
buffer_load_dwordx4 v3, s[24:27], s37 offen sc1 lds
buffer_load_dwordx4 v3, s[24:27], s37 offen offset:1024 sc1 lds
buffer_load_dwordx4 v3, s[24:27], s37 offen offset:2048 sc1 lds
buffer_load_dwordx4 v3, s[24:27], s37 offen offset:3072 sc1 lds
s_add_u32 s38, s91, 524288
s_add_u32 m0, s39, 0
s_nop 0
buffer_load_dwordx4 v23, s[28:31], s38 offen lds
s_add_u32 m0, s39, 1024
s_nop 0
buffer_load_dwordx4 v24, s[28:31], s38 offen lds
s_add_u32 m0, s39, 2048
s_add_u32 s38, s38, 16384
buffer_load_dwordx4 v23, s[28:31], s38 offen lds
s_add_u32 m0, s39, 3072
s_nop 0
buffer_load_dwordx4 v24, s[28:31], s38 offen lds
s_waitcnt vmcnt(20)
s_barrier
s_add_u32 s37, s90, 81920
s_add_u32 m0, s39, 16384
s_nop 0
buffer_load_dwordx4 v3, s[24:27], s37 offen sc1 lds
buffer_load_dwordx4 v3, s[24:27], s37 offen offset:1024 sc1 lds
buffer_load_dwordx4 v3, s[24:27], s37 offen offset:2048 sc1 lds
buffer_load_dwordx4 v3, s[24:27], s37 offen offset:3072 sc1 lds
s_add_u32 s38, s91, 655360
s_add_u32 m0, s39, 32768
s_nop 0
buffer_load_dwordx4 v23, s[28:31], s38 offen lds
s_add_u32 m0, s39, 33792
s_nop 0
buffer_load_dwordx4 v24, s[28:31], s38 offen lds
s_add_u32 m0, s39, 34816
s_add_u32 s38, s38, 16384
buffer_load_dwordx4 v23, s[28:31], s38 offen lds
s_add_u32 m0, s39, 35840
s_nop 0
buffer_load_dwordx4 v24, s[28:31], s38 offen lds
s_waitcnt vmcnt(24)
s_barrier
s_add_u32 s37, s90, 98304
s_add_u32 m0, s39, 49152
s_nop 0
buffer_load_dwordx4 v3, s[24:27], s37 offen sc1 lds
buffer_load_dwordx4 v3, s[24:27], s37 offen offset:1024 sc1 lds
buffer_load_dwordx4 v3, s[24:27], s37 offen offset:2048 sc1 lds
buffer_load_dwordx4 v3, s[24:27], s37 offen offset:3072 sc1 lds
s_add_u32 s38, s91, 786432
s_add_u32 m0, s39, 65536
s_nop 0
buffer_load_dwordx4 v23, s[28:31], s38 offen lds
s_add_u32 m0, s39, 66560
s_nop 0
buffer_load_dwordx4 v24, s[28:31], s38 offen lds
s_add_u32 m0, s39, 67584
s_add_u32 s38, s38, 16384
buffer_load_dwordx4 v23, s[28:31], s38 offen lds
s_add_u32 m0, s39, 68608
s_nop 0
buffer_load_dwordx4 v24, s[28:31], s38 offen lds
s_waitcnt vmcnt(24)
s_barrier
s_add_u32 s37, s90, 114688
s_add_u32 m0, s39, 81920
s_nop 0
buffer_load_dwordx4 v3, s[24:27], s37 offen sc1 lds
buffer_load_dwordx4 v3, s[24:27], s37 offen offset:1024 sc1 lds
buffer_load_dwordx4 v3, s[24:27], s37 offen offset:2048 sc1 lds
buffer_load_dwordx4 v3, s[24:27], s37 offen offset:3072 sc1 lds
s_add_u32 s38, s91, 917504
s_add_u32 m0, s39, 147456
s_nop 0
buffer_load_dwordx4 v23, s[28:31], s38 offen lds
s_add_u32 m0, s39, 148480
s_nop 0
buffer_load_dwordx4 v24, s[28:31], s38 offen lds
s_add_u32 m0, s39, 149504
s_add_u32 s38, s38, 16384
buffer_load_dwordx4 v23, s[28:31], s38 offen lds
s_add_u32 m0, s39, 150528
s_nop 0
buffer_load_dwordx4 v24, s[28:31], s38 offen lds
s_waitcnt vmcnt(24)
s_barrier
s_add_u32 s37, s90, 131072
s_add_u32 m0, s39, 98304
s_nop 0
buffer_load_dwordx4 v3, s[24:27], s37 offen sc1 lds
buffer_load_dwordx4 v3, s[24:27], s37 offen offset:1024 sc1 lds
buffer_load_dwordx4 v3, s[24:27], s37 offen offset:2048 sc1 lds
buffer_load_dwordx4 v3, s[24:27], s37 offen offset:3072 sc1 lds
s_add_u32 s38, s91, 1048576
s_add_u32 m0, s39, 114688
s_nop 0
buffer_load_dwordx4 v23, s[28:31], s38 offen lds
s_add_u32 m0, s39, 115712
s_nop 0
buffer_load_dwordx4 v24, s[28:31], s38 offen lds
s_add_u32 m0, s39, 116736
s_add_u32 s38, s38, 16384
buffer_load_dwordx4 v23, s[28:31], s38 offen lds
s_add_u32 m0, s39, 117760
s_nop 0
buffer_load_dwordx4 v24, s[28:31], s38 offen lds
s_waitcnt vmcnt(24)
s_barrier
s_add_u32 s37, s90, 147456
s_add_u32 m0, s39, 131072
s_nop 0
buffer_load_dwordx4 v3, s[24:27], s37 offen sc1 lds
buffer_load_dwordx4 v3, s[24:27], s37 offen offset:1024 sc1 lds
buffer_load_dwordx4 v3, s[24:27], s37 offen offset:2048 sc1 lds
buffer_load_dwordx4 v3, s[24:27], s37 offen offset:3072 sc1 lds
s_add_u32 s38, s91, 1179648
s_add_u32 m0, s39, 0
s_nop 0
buffer_load_dwordx4 v23, s[28:31], s38 offen lds
s_add_u32 m0, s39, 1024
s_nop 0
buffer_load_dwordx4 v24, s[28:31], s38 offen lds
s_add_u32 m0, s39, 2048
s_add_u32 s38, s38, 16384
buffer_load_dwordx4 v23, s[28:31], s38 offen lds
s_add_u32 m0, s39, 3072
s_nop 0
buffer_load_dwordx4 v24, s[28:31], s38 offen lds
s_waitcnt vmcnt(24)
s_barrier
s_mov_b32 s37, 327680
s_add_u32 m0, s39, 16384
s_nop 0
buffer_load_dwordx4 v3, s[24:27], s37 offen sc1 lds
buffer_load_dwordx4 v3, s[24:27], s37 offen offset:1024 sc1 lds
buffer_load_dwordx4 v3, s[24:27], s37 offen offset:2048 sc1 lds
buffer_load_dwordx4 v3, s[24:27], s37 offen offset:3072 sc1 lds
s_mov_b32 s38, 2621440
s_add_u32 m0, s51, 32768
s_nop 0
buffer_load_dwordx4 v25, s[28:31], s38 offen lds
s_add_u32 m0, s51, 33792
s_add_u32 s38, s38, 16384
buffer_load_dwordx4 v25, s[28:31], s38 offen lds
s_waitcnt vmcnt(22)
s_barrier
s_mov_b32 s37, 344064
s_add_u32 m0, s39, 49152
s_nop 0
buffer_load_dwordx4 v3, s[24:27], s37 offen sc1 lds
buffer_load_dwordx4 v3, s[24:27], s37 offen offset:1024 sc1 lds
buffer_load_dwordx4 v3, s[24:27], s37 offen offset:2048 sc1 lds
buffer_load_dwordx4 v3, s[24:27], s37 offen offset:3072 sc1 lds
s_mov_b32 s38, 2752512
s_add_u32 m0, s51, 65536
s_nop 0
buffer_load_dwordx4 v25, s[28:31], s38 offen lds
s_add_u32 m0, s51, 66560
s_add_u32 s38, s38, 16384
buffer_load_dwordx4 v25, s[28:31], s38 offen lds
s_waitcnt vmcnt(20)
s_barrier
s_mov_b32 s37, 360448
s_add_u32 m0, s39, 81920
s_nop 0
buffer_load_dwordx4 v3, s[24:27], s37 offen sc1 lds
buffer_load_dwordx4 v3, s[24:27], s37 offen offset:1024 sc1 lds
buffer_load_dwordx4 v3, s[24:27], s37 offen offset:2048 sc1 lds
buffer_load_dwordx4 v3, s[24:27], s37 offen offset:3072 sc1 lds
s_mov_b32 s38, 2883584
s_add_u32 m0, s51, 147456
s_nop 0
buffer_load_dwordx4 v25, s[28:31], s38 offen lds
s_add_u32 m0, s51, 148480
s_add_u32 s38, s38, 16384
buffer_load_dwordx4 v25, s[28:31], s38 offen lds
s_waitcnt vmcnt(18)
s_barrier
s_mov_b32 s37, 376832
s_add_u32 m0, s39, 98304
s_nop 0
buffer_load_dwordx4 v3, s[24:27], s37 offen sc1 lds
buffer_load_dwordx4 v3, s[24:27], s37 offen offset:1024 sc1 lds
buffer_load_dwordx4 v3, s[24:27], s37 offen offset:2048 sc1 lds
buffer_load_dwordx4 v3, s[24:27], s37 offen offset:3072 sc1 lds
s_mov_b32 s38, 3014656
s_add_u32 m0, s51, 114688
s_nop 0
buffer_load_dwordx4 v25, s[28:31], s38 offen lds
s_add_u32 m0, s51, 115712
s_add_u32 s38, s38, 16384
buffer_load_dwordx4 v25, s[28:31], s38 offen lds
s_waitcnt vmcnt(18)
s_barrier
s_mov_b32 s37, 393216
s_add_u32 m0, s39, 131072
s_nop 0
buffer_load_dwordx4 v3, s[24:27], s37 offen sc1 lds
buffer_load_dwordx4 v3, s[24:27], s37 offen offset:1024 sc1 lds
buffer_load_dwordx4 v3, s[24:27], s37 offen offset:2048 sc1 lds
buffer_load_dwordx4 v3, s[24:27], s37 offen offset:3072 sc1 lds
s_mov_b32 s38, 3145728
s_add_u32 m0, s51, 0
s_nop 0
buffer_load_dwordx4 v25, s[28:31], s38 offen lds
s_add_u32 m0, s51, 1024
s_add_u32 s38, s38, 16384
buffer_load_dwordx4 v25, s[28:31], s38 offen lds
s_waitcnt vmcnt(18)
s_barrier
s_mov_b32 s37, 409600
s_add_u32 m0, s39, 16384
s_nop 0
buffer_load_dwordx4 v3, s[24:27], s37 offen sc1 lds
buffer_load_dwordx4 v3, s[24:27], s37 offen offset:1024 sc1 lds
buffer_load_dwordx4 v3, s[24:27], s37 offen offset:2048 sc1 lds
buffer_load_dwordx4 v3, s[24:27], s37 offen offset:3072 sc1 lds
s_mov_b32 s38, 3276800
s_add_u32 m0, s51, 32768
s_nop 0
s_branch Lov_18
.p2align 12
.fill 144, 4, 0xbf800000
Lst_18_0:
s_branch Lwr_186
s_nop 0
s_nop 0
Lov_18:
buffer_load_dwordx4 v25, s[28:31], s38 offen lds
s_add_u32 m0, s51, 33792
s_add_u32 s38, s38, 16384
buffer_load_dwordx4 v25, s[28:31], s38 offen lds
s_waitcnt vmcnt(18)
s_barrier
s_mov_b32 s37, 425984
s_add_u32 m0, s39, 49152
s_nop 0
buffer_load_dwordx4 v3, s[24:27], s37 offen sc1 lds
buffer_load_dwordx4 v3, s[24:27], s37 offen offset:1024 sc1 lds
buffer_load_dwordx4 v3, s[24:27], s37 offen offset:2048 sc1 lds
buffer_load_dwordx4 v3, s[24:27], s37 offen offset:3072 sc1 lds
s_mov_b32 s38, 3407872
s_add_u32 m0, s51, 65536
s_nop 0
buffer_load_dwordx4 v25, s[28:31], s38 offen lds
s_add_u32 m0, s51, 66560
s_add_u32 s38, s38, 16384
buffer_load_dwordx4 v25, s[28:31], s38 offen lds
s_waitcnt vmcnt(18)
s_barrier
s_mov_b32 s37, 442368
s_add_u32 m0, s39, 81920
s_nop 0
buffer_load_dwordx4 v3, s[24:27], s37 offen sc1 lds
buffer_load_dwordx4 v3, s[24:27], s37 offen offset:1024 sc1 lds
buffer_load_dwordx4 v3, s[24:27], s37 offen offset:2048 sc1 lds
buffer_load_dwordx4 v3, s[24:27], s37 offen offset:3072 sc1 lds
s_mov_b32 s38, 3538944
s_add_u32 m0, s51, 147456
s_nop 0
buffer_load_dwordx4 v25, s[28:31], s38 offen lds
s_add_u32 m0, s51, 148480
s_add_u32 s38, s38, 16384
buffer_load_dwordx4 v25, s[28:31], s38 offen lds
s_waitcnt vmcnt(18)
s_barrier
s_mov_b32 s37, 458752
s_add_u32 m0, s39, 98304
s_nop 0
buffer_load_dwordx4 v3, s[24:27], s37 offen sc1 lds
buffer_load_dwordx4 v3, s[24:27], s37 offen offset:1024 sc1 lds
buffer_load_dwordx4 v3, s[24:27], s37 offen offset:2048 sc1 lds
buffer_load_dwordx4 v3, s[24:27], s37 offen offset:3072 sc1 lds
s_mov_b32 s38, 3670016
s_add_u32 m0, s51, 114688
s_nop 0
buffer_load_dwordx4 v25, s[28:31], s38 offen lds
s_add_u32 m0, s51, 115712
s_add_u32 s38, s38, 16384
buffer_load_dwordx4 v25, s[28:31], s38 offen lds
s_waitcnt vmcnt(18)
s_barrier
s_mov_b32 s37, 475136
s_add_u32 m0, s39, 131072
s_nop 0
buffer_load_dwordx4 v3, s[24:27], s37 offen sc1 lds
buffer_load_dwordx4 v3, s[24:27], s37 offen offset:1024 sc1 lds
buffer_load_dwordx4 v3, s[24:27], s37 offen offset:2048 sc1 lds
buffer_load_dwordx4 v3, s[24:27], s37 offen offset:3072 sc1 lds
s_mov_b32 s38, 3801088
s_add_u32 m0, s51, 0
s_nop 0
buffer_load_dwordx4 v25, s[28:31], s38 offen lds
s_add_u32 m0, s51, 1024
s_add_u32 s38, s38, 16384
buffer_load_dwordx4 v25, s[28:31], s38 offen lds
s_waitcnt vmcnt(18)
s_barrier
s_cmp_eq_u32 s47, 0
s_cbranch_scc0 Lw_154
s_xor_b32 s43, s2, 2
s_add_u32 s43, s43, 128
s_lshl_b32 s43, s43, 7
v_mov_b32 v26, s43
v_mov_b32 v27, 1
s_mov_b64 exec, 1
buffer_store_dword v27, v26, s[56:59], 0 offen sc1
s_mov_b64 exec, -1
Lw_154:
s_mov_b32 s37, 491520
s_add_u32 m0, s39, 16384
s_nop 0
buffer_load_dwordx4 v3, s[24:27], s37 offen sc1 lds
buffer_load_dwordx4 v3, s[24:27], s37 offen offset:1024 sc1 lds
buffer_load_dwordx4 v3, s[24:27], s37 offen offset:2048 sc1 lds
buffer_load_dwordx4 v3, s[24:27], s37 offen offset:3072 sc1 lds
s_mov_b32 s38, 3932160
s_add_u32 m0, s51, 32768
s_nop 0
buffer_load_dwordx4 v25, s[28:31], s38 offen lds
s_add_u32 m0, s51, 33792
s_add_u32 s38, s38, 16384
buffer_load_dwordx4 v25, s[28:31], s38 offen lds
s_waitcnt vmcnt(18)
s_barrier
s_mov_b32 s37, 507904
s_add_u32 m0, s39, 49152
s_nop 0
buffer_load_dwordx4 v3, s[24:27], s37 offen sc1 lds
buffer_load_dwordx4 v3, s[24:27], s37 offen offset:1024 sc1 lds
buffer_load_dwordx4 v3, s[24:27], s37 offen offset:2048 sc1 lds
buffer_load_dwordx4 v3, s[24:27], s37 offen offset:3072 sc1 lds
s_mov_b32 s38, 4063232
s_add_u32 m0, s51, 65536
s_nop 0
buffer_load_dwordx4 v25, s[28:31], s38 offen lds
s_add_u32 m0, s51, 66560
s_add_u32 s38, s38, 16384
buffer_load_dwordx4 v25, s[28:31], s38 offen lds
s_waitcnt vmcnt(18)
s_barrier
s_cmp_eq_u32 s47, 3
s_cbranch_scc0 Lw_155
s_lshl_b32 s92, s2, 7
s_add_u32 s92, s92, 28327936
s_load_dword s93, s[82:83], s92 glc
Lw_155:
s_waitcnt vmcnt(12)
s_cmp_eq_u32 s47, 3
s_cbranch_scc0 Lw_156
s_mov_b32 s41, 0x40000
s_branch Lpchk_159
Lpoll_157:
s_load_dword s93, s[82:83], s92 glc
Lpchk_159:
s_waitcnt lgkmcnt(0)
s_cmp_eq_u32 s93, 1
s_cbranch_scc1 Lpok_158
s_sub_u32 s41, s41, 1
s_cmp_lg_u32 s41, 0
s_cbranch_scc1 Lpoll_157
Lpok_158:
Lw_156:
s_barrier
s_waitcnt vmcnt(6)
s_barrier
s_waitcnt vmcnt(0)
s_barrier
s_barrier
s_branch Ldone_1
Ldone_1:
Lfin:
Lexit_2:
s_endpgm
.fill 1024, 4, 0xbf800000
.section .rodata,"a"
.p2align 6
.amdhsa_kernel sequential_preLN__sliding_local_dilated__glu_gated_geglu__prompt_kernel
  .amdhsa_next_free_vgpr 256
  .amdhsa_next_free_sgpr 102
  .amdhsa_accum_offset 256
  .amdhsa_group_segment_fixed_size 0
  .amdhsa_kernarg_size 80
  .amdhsa_user_sgpr_count 2
  .amdhsa_user_sgpr_kernarg_segment_ptr 1
  .amdhsa_system_sgpr_workgroup_id_x 1
  .amdhsa_float_denorm_mode_32 3
  .amdhsa_float_denorm_mode_16_64 3
.end_amdhsa_kernel
```

```asm
; @launch grid=(256,1,1) block=(512,1,1) lds=163840
.amdgcn_target "amdgcn-amd-amdhsa--gfx950"
.text
.globl sequential_preLN__sliding_local_dilated__glu_gated_geglu__prompt_kernel
.p2align 8
.type sequential_preLN__sliding_local_dilated__glu_gated_geglu__prompt_kernel,@function
sequential_preLN__sliding_local_dilated__glu_gated_geglu__prompt_kernel:
s_cmp_ge_u32 s2, 256
s_cbranch_scc1 Lexit_2
s_load_dwordx16 s[64:79], s[0:1], 0
s_load_dwordx4 s[80:83], s[0:1], 64
s_and_b32 s3, s2, 7
s_lshr_b32 s42, s2, 3
s_and_b32 s34, s3, 1
s_lshl_b32 s34, s34, 3
s_and_b32 s48, s42, 7
s_add_u32 s34, s34, s48
s_lshr_b32 s35, s3, 1
s_lshr_b32 s49, s42, 3
s_lshl_b32 s35, s35, 2
s_add_u32 s35, s35, s49
v_lshrrev_b32 v12, 6, v0
v_and_b32 v1, 63, v0
v_readfirstlane_b32 s36, v12
Lbeg:
s_lshl_b32 s50, s34, 7
s_sub_u32 s50, s50, 16
v_and_b32 v12, 15, v1
v_lshrrev_b32 v13, 4, v1
s_cmp_lt_u32 s36, 4
s_cbranch_scc1 Lcons_7
Lprod_3:
s_sub_u32 s47, s36, 4
s_lshl_b32 s43, s34, 7
s_lshl_b32 s44, s35, 3
s_add_u32 s63, s43, s44
s_lshl_b32 s44, s47, 1
s_add_u32 s51, s63, s44
v_lshlrev_b32 v10, 4, v1
s_and_b32 s43, s2, 7
s_lshr_b32 s44, s43, 2
s_lshl_b32 s44, s44, 1
s_and_b32 s45, s43, 1
s_add_u32 s44, s44, s45
s_lshr_b32 s45, s2, 3
s_lshl_b32 s45, s45, 2
s_add_u32 s44, s44, s45
s_add_u32 s44, s44, 96
s_bitcmp1_b32 s43, 1
s_cselect_b32 s44, s44, 0x10000
s_cmp_lt_u32 s2, 192
s_cselect_b32 s33, s2, s44
v_lshrrev_b32 v14, 3, v1
v_and_b32 v15, 7, v1
v_lshl_add_u32 v19, v14, 6, v15
s_lshl_b32 s43, s48, 3
v_add_u32 v19, s43, v19
v_mul_u32_u24 v19, 6144, v19
s_cmp_eq_u32 s47, 3
s_cbranch_scc1 Lpf_4
v_and_b32 v16, 2, v14
v_xor_b32 v16, v15, v16
v_lshlrev_b32 v16, 4, v16
v_mul_u32_u24 v17, 6144, v14
s_lshl_b32 s43, s47, 11
v_add3_u32 v2, v17, v16, s43
v_xor_b32 v3, 64, v2
v_lshrrev_b32 v16, 1, v14
v_xor_b32 v16, v15, v16
v_lshlrev_b32 v16, 4, v16
s_lshl_b32 s43, s47, 3
s_add_u32 s43, s43, s50
v_add_u32 v17, s43, v14
s_and_b32 s44, s47, 1
s_lshl_b32 s44, s44, 6
v_add_u32 v18, 0, v17
v_max_i32 v18, 0, v18
v_lshl_add_u32 v18, v18, 11, v16
v_xor_b32 v18, s44, v18
v_mov_b32 v4, v18
v_add_u32 v18, 24, v17
v_max_i32 v18, 0, v18
v_lshl_add_u32 v18, v18, 11, v16
v_xor_b32 v18, s44, v18
v_xor_b32 v5, 64, v18
v_add_u32 v18, 48, v17
v_max_i32 v18, 0, v18
v_lshl_add_u32 v18, v18, 11, v16
v_xor_b32 v18, s44, v18
v_mov_b32 v6, v18
v_add_u32 v18, 72, v17
v_max_i32 v18, 0, v18
v_lshl_add_u32 v18, v18, 11, v16
v_xor_b32 v18, s44, v18
v_xor_b32 v7, 64, v18
v_add_u32 v18, 96, v17
v_max_i32 v18, 0, v18
v_lshl_add_u32 v18, v18, 11, v16
v_xor_b32 v18, s44, v18
v_mov_b32 v8, v18
v_add_u32 v18, 120, v17
v_max_i32 v18, 0, v18
v_lshl_add_u32 v18, v18, 11, v16
v_xor_b32 v18, s44, v18
v_xor_b32 v9, 64, v18
s_lshl_b32 s39, s47, 10
s_lshl_b32 s40, s47, 13
s_add_u32 s40, s40, 18432
s_mov_b32 s37, 0
s_mov_b32 s38, 0
s_bfm_b64 s[60:61], 56, 8
s_cmp_eq_u32 s47, 0
s_cselect_b64 s[60:61], s[60:61], -1
s_lshl_b32 s43, s35, 7
s_waitcnt lgkmcnt(0)
s_mov_b32 s8, s64
s_mov_b32 s9, s65
s_mov_b32 s10, 4194304
s_mov_b32 s11, 0x20000
s_add_u32 s12, s66, s43
s_addc_u32 s13, s67, 0
s_mov_b32 s14, 6289536
s_mov_b32 s15, 0x20000
s_mov_b32 s28, s66
s_mov_b32 s29, s67
s_mov_b32 s30, 6291456
s_mov_b32 s31, 0x20000
s_mul_i32 s43, s33, 7296
v_lshlrev_b32 v30, 7, v1
s_mul_i32 s44, s47, 2432
s_add_u32 s43, s43, s44
s_bfm_b64 exec, 19, 0
buffer_load_dword v31, v30, s[28:31], s43 offen
s_mov_b64 exec, -1
s_add_u32 m0, s39, 0
s_mov_b64 exec, s[60:61]
buffer_load_dwordx4 v4, s[8:11], s37 offen lds
s_mov_b64 exec, -1
s_add_u32 m0, s39, 3072
s_nop 0
buffer_load_dwordx4 v5, s[8:11], s37 offen lds
s_add_u32 m0, s39, 6144
s_nop 0
buffer_load_dwordx4 v6, s[8:11], s37 offen lds
s_add_u32 m0, s39, 9216
s_nop 0
buffer_load_dwordx4 v7, s[8:11], s37 offen lds
s_add_u32 m0, s39, 12288
s_nop 0
buffer_load_dwordx4 v8, s[8:11], s37 offen lds
s_add_u32 m0, s39, 15360
s_nop 0
buffer_load_dwordx4 v9, s[8:11], s37 offen lds
s_add_u32 m0, s40, 0
s_add_u32 s43, s38, 0
buffer_load_dwordx4 v2, s[12:15], s43 offen lds
s_add_u32 m0, s40, 1024
s_add_u32 s43, s38, 49152
buffer_load_dwordx4 v3, s[12:15], s43 offen lds
s_add_u32 m0, s40, 2048
s_add_u32 s43, s38, 98304
buffer_load_dwordx4 v2, s[12:15], s43 offen lds
s_add_u32 m0, s40, 3072
s_add_u32 s43, s38, 147456
buffer_load_dwordx4 v3, s[12:15], s43 offen lds
s_add_u32 m0, s40, 4096
s_add_u32 s43, s38, 196608
buffer_load_dwordx4 v2, s[12:15], s43 offen lds
s_add_u32 m0, s40, 5120
s_add_u32 s43, s38, 245760
buffer_load_dwordx4 v3, s[12:15], s43 offen lds
s_add_u32 m0, s40, 6144
s_add_u32 s43, s38, 294912
buffer_load_dwordx4 v2, s[12:15], s43 offen lds
s_add_u32 m0, s40, 7168
s_add_u32 s43, s38, 344064
buffer_load_dwordx4 v3, s[12:15], s43 offen lds
s_add_u32 s37, s37, 128
s_add_u32 s38, s38, 393216
s_lshl_b32 s43, s51, 11
buffer_load_dwordx4 v[96:99], v10, s[8:11], s43 offen offset:0
buffer_load_dwordx4 v[100:103], v10, s[8:11], s43 offen offset:1024
buffer_load_dwordx4 v[104:107], v10, s[8:11], s43 offen offset:2048
buffer_load_dwordx4 v[108:111], v10, s[8:11], s43 offen offset:3072
s_add_u32 m0, s39, 43008
s_mov_b64 exec, s[60:61]
buffer_load_dwordx4 v4, s[8:11], s37 offen lds
s_mov_b64 exec, -1
s_add_u32 m0, s39, 46080
s_nop 0
buffer_load_dwordx4 v5, s[8:11], s37 offen lds
s_add_u32 m0, s39, 49152
s_nop 0
buffer_load_dwordx4 v6, s[8:11], s37 offen lds
s_add_u32 m0, s39, 52224
s_nop 0
buffer_load_dwordx4 v7, s[8:11], s37 offen lds
s_add_u32 m0, s39, 55296
s_nop 0
buffer_load_dwordx4 v8, s[8:11], s37 offen lds
s_add_u32 m0, s39, 58368
s_nop 0
buffer_load_dwordx4 v9, s[8:11], s37 offen lds
s_add_u32 m0, s40, 43008
s_add_u32 s43, s38, 0
buffer_load_dwordx4 v2, s[12:15], s43 offen lds
s_add_u32 m0, s40, 44032
s_add_u32 s43, s38, 49152
buffer_load_dwordx4 v3, s[12:15], s43 offen lds
s_add_u32 m0, s40, 45056
s_add_u32 s43, s38, 98304
buffer_load_dwordx4 v2, s[12:15], s43 offen lds
s_add_u32 m0, s40, 46080
s_add_u32 s43, s38, 147456
buffer_load_dwordx4 v3, s[12:15], s43 offen lds
s_add_u32 m0, s40, 47104
s_add_u32 s43, s38, 196608
buffer_load_dwordx4 v2, s[12:15], s43 offen lds
s_add_u32 m0, s40, 48128
s_add_u32 s43, s38, 245760
buffer_load_dwordx4 v3, s[12:15], s43 offen lds
s_add_u32 m0, s40, 49152
s_add_u32 s43, s38, 294912
buffer_load_dwordx4 v2, s[12:15], s43 offen lds
s_add_u32 m0, s40, 50176
s_add_u32 s43, s38, 344064
buffer_load_dwordx4 v3, s[12:15], s43 offen lds
s_add_u32 s37, s37, 128
s_add_u32 s38, s38, 393216
s_waitcnt vmcnt(18)
s_barrier
s_add_u32 m0, s39, 86016
s_mov_b64 exec, s[60:61]
buffer_load_dwordx4 v4, s[8:11], s37 offen lds
s_mov_b64 exec, -1
s_add_u32 m0, s39, 89088
s_nop 0
buffer_load_dwordx4 v5, s[8:11], s37 offen lds
s_add_u32 m0, s39, 92160
s_nop 0
buffer_load_dwordx4 v6, s[8:11], s37 offen lds
s_add_u32 m0, s39, 95232
s_nop 0
buffer_load_dwordx4 v7, s[8:11], s37 offen lds
s_add_u32 m0, s39, 98304
s_nop 0
buffer_load_dwordx4 v8, s[8:11], s37 offen lds
s_add_u32 m0, s39, 101376
s_nop 0
buffer_load_dwordx4 v9, s[8:11], s37 offen lds
s_add_u32 m0, s40, 86016
s_add_u32 s43, s38, 0
buffer_load_dwordx4 v2, s[12:15], s43 offen lds
s_add_u32 m0, s40, 87040
s_add_u32 s43, s38, 49152
buffer_load_dwordx4 v3, s[12:15], s43 offen lds
s_add_u32 m0, s40, 88064
s_add_u32 s43, s38, 98304
buffer_load_dwordx4 v2, s[12:15], s43 offen lds
s_add_u32 m0, s40, 89088
s_add_u32 s43, s38, 147456
buffer_load_dwordx4 v3, s[12:15], s43 offen lds
s_add_u32 m0, s40, 90112
s_add_u32 s43, s38, 196608
buffer_load_dwordx4 v2, s[12:15], s43 offen lds
s_add_u32 m0, s40, 91136
s_add_u32 s43, s38, 245760
buffer_load_dwordx4 v3, s[12:15], s43 offen lds
s_add_u32 m0, s40, 92160
s_add_u32 s43, s38, 294912
buffer_load_dwordx4 v2, s[12:15], s43 offen lds
s_add_u32 m0, s40, 93184
s_add_u32 s43, s38, 344064
buffer_load_dwordx4 v3, s[12:15], s43 offen lds
s_add_u32 s37, s37, 128
s_add_u32 s38, s38, 393216
s_waitcnt vmcnt(28)
s_mov_b32 s43, 0x3f803f80
v_mov_b32 v116, 0
v_mov_b32 v117, 0
v_mov_b32 v118, 0
v_mov_b32 v119, 0
v_mov_b32 v120, 0
v_mov_b32 v121, 0
v_mov_b32 v122, 0
v_mov_b32 v123, 0
v_dot2_f32_bf16 v116, v96, s43, v116
v_dot2_f32_bf16 v120, v96, v96, v120
v_dot2_f32_bf16 v118, v104, s43, v118
v_dot2_f32_bf16 v122, v104, v104, v122
v_dot2_f32_bf16 v117, v97, s43, v117
v_dot2_f32_bf16 v121, v97, v97, v121
v_dot2_f32_bf16 v119, v105, s43, v119
v_dot2_f32_bf16 v123, v105, v105, v123
v_dot2_f32_bf16 v116, v98, s43, v116
v_dot2_f32_bf16 v120, v98, v98, v120
v_dot2_f32_bf16 v118, v106, s43, v118
v_dot2_f32_bf16 v122, v106, v106, v122
v_dot2_f32_bf16 v117, v99, s43, v117
v_dot2_f32_bf16 v121, v99, v99, v121
v_dot2_f32_bf16 v119, v107, s43, v119
v_dot2_f32_bf16 v123, v107, v107, v123
v_dot2_f32_bf16 v116, v100, s43, v116
v_dot2_f32_bf16 v120, v100, v100, v120
v_dot2_f32_bf16 v118, v108, s43, v118
v_dot2_f32_bf16 v122, v108, v108, v122
v_dot2_f32_bf16 v117, v101, s43, v117
v_dot2_f32_bf16 v121, v101, v101, v121
v_dot2_f32_bf16 v119, v109, s43, v119
v_dot2_f32_bf16 v123, v109, v109, v123
v_dot2_f32_bf16 v116, v102, s43, v116
v_dot2_f32_bf16 v120, v102, v102, v120
v_dot2_f32_bf16 v118, v110, s43, v118
v_dot2_f32_bf16 v122, v110, v110, v122
v_dot2_f32_bf16 v117, v103, s43, v117
v_dot2_f32_bf16 v121, v103, v103, v121
v_dot2_f32_bf16 v119, v111, s43, v119
v_dot2_f32_bf16 v123, v111, v111, v123
s_nop 2
v_add_f32 v116, v116, v117
v_add_f32 v118, v118, v119
v_add_f32 v120, v120, v121
v_add_f32 v122, v122, v123
s_nop 1
v_permlane32_swap_b32 v116, v118
v_permlane32_swap_b32 v120, v122
v_add_f32 v116, v116, v118
v_add_f32 v120, v120, v122
s_nop 1
v_permlane16_swap_b32 v116, v120
v_add_f32 v116, v116, v120
s_nop 1
v_add_f32_dpp v116, v116, v116 row_ror:8 row_mask:0xf bank_mask:0xf
s_nop 1
v_add_f32_dpp v116, v116, v116 row_ror:4 row_mask:0xf bank_mask:0xf
s_nop 1
v_add_f32_dpp v116, v116, v116 row_ror:2 row_mask:0xf bank_mask:0xf
s_nop 1
v_add_f32_dpp v116, v116, v116 row_ror:1 row_mask:0xf bank_mask:0xf
v_mov_b32 v117, v116
s_nop 1
v_permlane16_swap_b32 v116, v117
v_mul_f32 v112, 0x3a800000, v116
v_mul_f32 v113, 0x3a800000, v117
v_fma_f32 v113, -v112, v112, v113
v_max_f32 v113, 0, v113
v_add_f32 v113, 0x3727c5ac, v113
v_rsq_f32 v113, v113
v_lshrrev_b32 v11, 5, v1
s_lshl_b32 s43, s47, 4
s_add_u32 s43, s43, 148608
v_lshl_add_u32 v11, v11, 3, s43
ds_write_b64 v11, v[112:113]
s_waitcnt lgkmcnt(0)
s_and_b32 s44, s36, 3
s_mul_i32 s44, s44, 28
s_bfe_u32 s43, s2, 0x30001
s_lshl_b32 s43, s43, 7
s_add_u32 s44, s44, s43
s_mul_i32 s44, s44, 7168
s_lshr_b32 s43, s2, 4
s_lshl_b32 s43, s43, 8
s_add_u32 s43, s43, s44
s_bitcmp0_b32 s2, 0
s_cselect_b32 s4, s72, s74
s_cselect_b32 s5, s73, s75
s_add_u32 s4, s4, s43
s_addc_u32 s5, s5, 0
Lsp_8:
s_waitcnt vmcnt(14)
s_barrier
s_add_u32 m0, s39, 0
s_mov_b64 exec, s[60:61]
buffer_load_dwordx4 v4, s[8:11], s37 offen lds
s_mov_b64 exec, -1
s_add_u32 m0, s39, 3072
s_nop 0
buffer_load_dwordx4 v5, s[8:11], s37 offen lds
s_add_u32 m0, s39, 6144
s_nop 0
buffer_load_dwordx4 v6, s[8:11], s37 offen lds
s_add_u32 m0, s39, 9216
s_nop 0
buffer_load_dwordx4 v7, s[8:11], s37 offen lds
s_add_u32 m0, s39, 12288
s_nop 0
buffer_load_dwordx4 v8, s[8:11], s37 offen lds
s_add_u32 m0, s39, 15360
s_nop 0
buffer_load_dwordx4 v9, s[8:11], s37 offen lds
s_add_u32 m0, s40, 0
s_add_u32 s43, s38, 0
buffer_load_dwordx4 v2, s[12:15], s43 offen lds
s_add_u32 m0, s40, 1024
s_add_u32 s43, s38, 49152
buffer_load_dwordx4 v3, s[12:15], s43 offen lds
s_add_u32 m0, s40, 2048
s_add_u32 s43, s38, 98304
buffer_load_dwordx4 v2, s[12:15], s43 offen lds
s_add_u32 m0, s40, 3072
s_add_u32 s43, s38, 147456
buffer_load_dwordx4 v3, s[12:15], s43 offen lds
s_add_u32 m0, s40, 4096
s_add_u32 s43, s38, 196608
buffer_load_dwordx4 v2, s[12:15], s43 offen lds
s_add_u32 m0, s40, 5120
s_add_u32 s43, s38, 245760
buffer_load_dwordx4 v3, s[12:15], s43 offen lds
s_add_u32 m0, s40, 6144
s_add_u32 s43, s38, 294912
buffer_load_dwordx4 v2, s[12:15], s43 offen lds
s_add_u32 m0, s40, 7168
s_add_u32 s43, s38, 344064
buffer_load_dwordx4 v3, s[12:15], s43 offen lds
s_add_u32 s37, s37, 128
s_add_u32 s38, s38, 393216
Lsp_9:
s_waitcnt vmcnt(14)
s_barrier
s_add_u32 m0, s39, 43008
s_mov_b64 exec, s[60:61]
buffer_load_dwordx4 v4, s[8:11], s37 offen lds
s_mov_b64 exec, -1
s_add_u32 m0, s39, 46080
s_nop 0
buffer_load_dwordx4 v5, s[8:11], s37 offen lds
s_add_u32 m0, s39, 49152
s_nop 0
buffer_load_dwordx4 v6, s[8:11], s37 offen lds
s_add_u32 m0, s39, 52224
s_nop 0
buffer_load_dwordx4 v7, s[8:11], s37 offen lds
s_add_u32 m0, s39, 55296
s_nop 0
buffer_load_dwordx4 v8, s[8:11], s37 offen lds
s_add_u32 m0, s39, 58368
s_nop 0
buffer_load_dwordx4 v9, s[8:11], s37 offen lds
s_add_u32 m0, s40, 43008
s_add_u32 s43, s38, 0
buffer_load_dwordx4 v2, s[12:15], s43 offen lds
s_add_u32 m0, s40, 44032
s_add_u32 s43, s38, 49152
buffer_load_dwordx4 v3, s[12:15], s43 offen lds
s_add_u32 m0, s40, 45056
s_add_u32 s43, s38, 98304
buffer_load_dwordx4 v2, s[12:15], s43 offen lds
s_add_u32 m0, s40, 46080
s_add_u32 s43, s38, 147456
buffer_load_dwordx4 v3, s[12:15], s43 offen lds
s_add_u32 m0, s40, 47104
s_add_u32 s43, s38, 196608
buffer_load_dwordx4 v2, s[12:15], s43 offen lds
s_add_u32 m0, s40, 48128
s_add_u32 s43, s38, 245760
buffer_load_dwordx4 v3, s[12:15], s43 offen lds
s_add_u32 m0, s40, 49152
s_add_u32 s43, s38, 294912
buffer_load_dwordx4 v2, s[12:15], s43 offen lds
s_add_u32 m0, s40, 50176
s_add_u32 s43, s38, 344064
buffer_load_dwordx4 v3, s[12:15], s43 offen lds
s_add_u32 s37, s37, 128
s_add_u32 s38, s38, 393216
s_load_dword s3, s[4:5], 0
s_load_dword s3, s[4:5], 64
s_load_dword s3, s[4:5], 128
Lsp_10:
s_waitcnt vmcnt(14)
s_barrier
s_add_u32 m0, s39, 86016
s_mov_b64 exec, s[60:61]
buffer_load_dwordx4 v4, s[8:11], s37 offen lds
s_mov_b64 exec, -1
s_add_u32 m0, s39, 89088
s_nop 0
buffer_load_dwordx4 v5, s[8:11], s37 offen lds
s_add_u32 m0, s39, 92160
s_nop 0
buffer_load_dwordx4 v6, s[8:11], s37 offen lds
s_add_u32 m0, s39, 95232
s_nop 0
buffer_load_dwordx4 v7, s[8:11], s37 offen lds
s_add_u32 m0, s39, 98304
s_nop 0
buffer_load_dwordx4 v8, s[8:11], s37 offen lds
s_add_u32 m0, s39, 101376
s_nop 0
buffer_load_dwordx4 v9, s[8:11], s37 offen lds
s_add_u32 m0, s40, 86016
s_add_u32 s43, s38, 0
buffer_load_dwordx4 v2, s[12:15], s43 offen lds
s_add_u32 m0, s40, 87040
s_add_u32 s43, s38, 49152
buffer_load_dwordx4 v3, s[12:15], s43 offen lds
s_add_u32 m0, s40, 88064
s_add_u32 s43, s38, 98304
buffer_load_dwordx4 v2, s[12:15], s43 offen lds
s_add_u32 m0, s40, 89088
s_add_u32 s43, s38, 147456
buffer_load_dwordx4 v3, s[12:15], s43 offen lds
s_add_u32 m0, s40, 90112
s_add_u32 s43, s38, 196608
buffer_load_dwordx4 v2, s[12:15], s43 offen lds
s_add_u32 m0, s40, 91136
s_add_u32 s43, s38, 245760
buffer_load_dwordx4 v3, s[12:15], s43 offen lds
s_add_u32 m0, s40, 92160
s_add_u32 s43, s38, 294912
buffer_load_dwordx4 v2, s[12:15], s43 offen lds
s_add_u32 m0, s40, 93184
s_add_u32 s43, s38, 344064
buffer_load_dwordx4 v3, s[12:15], s43 offen lds
s_add_u32 s37, s37, 128
s_add_u32 s38, s38, 393216
s_load_dword s3, s[4:5], 192
s_load_dword s3, s[4:5], 7168
s_load_dword s3, s[4:5], 7232
s_load_dword s3, s[4:5], 7296
s_load_dword s3, s[4:5], 7360
Lsp_11:
s_waitcnt vmcnt(14)
s_barrier
s_add_u32 m0, s39, 0
s_mov_b64 exec, s[60:61]
buffer_load_dwordx4 v4, s[8:11], s37 offen lds
s_mov_b64 exec, -1
s_add_u32 m0, s39, 3072
s_nop 0
buffer_load_dwordx4 v5, s[8:11], s37 offen lds
s_add_u32 m0, s39, 6144
s_nop 0
buffer_load_dwordx4 v6, s[8:11], s37 offen lds
s_branch Lov_0
.p2align 12
Lst_0_0:
s_branch Lwr_160
s_nop 0
s_nop 0
Lov_0:
s_add_u32 m0, s39, 9216
s_nop 0
buffer_load_dwordx4 v7, s[8:11], s37 offen lds
s_add_u32 m0, s39, 12288
s_nop 0
buffer_load_dwordx4 v8, s[8:11], s37 offen lds
s_add_u32 m0, s39, 15360
s_nop 0
buffer_load_dwordx4 v9, s[8:11], s37 offen lds
s_add_u32 m0, s40, 0
s_add_u32 s43, s38, 0
buffer_load_dwordx4 v2, s[12:15], s43 offen lds
s_add_u32 m0, s40, 1024
s_add_u32 s43, s38, 49152
buffer_load_dwordx4 v3, s[12:15], s43 offen lds
s_add_u32 m0, s40, 2048
s_add_u32 s43, s38, 98304
buffer_load_dwordx4 v2, s[12:15], s43 offen lds
s_add_u32 m0, s40, 3072
s_add_u32 s43, s38, 147456
buffer_load_dwordx4 v3, s[12:15], s43 offen lds
s_add_u32 m0, s40, 4096
s_add_u32 s43, s38, 196608
buffer_load_dwordx4 v2, s[12:15], s43 offen lds
s_add_u32 m0, s40, 5120
s_add_u32 s43, s38, 245760
buffer_load_dwordx4 v3, s[12:15], s43 offen lds
s_add_u32 m0, s40, 6144
s_add_u32 s43, s38, 294912
buffer_load_dwordx4 v2, s[12:15], s43 offen lds
s_add_u32 m0, s40, 7168
s_add_u32 s43, s38, 344064
buffer_load_dwordx4 v3, s[12:15], s43 offen lds
s_add_u32 s37, s37, 128
s_add_u32 s38, s38, 393216
s_load_dword s3, s[4:5], 14336
s_load_dword s3, s[4:5], 14400
s_load_dword s3, s[4:5], 14464
s_load_dword s3, s[4:5], 14528
s_load_dword s3, s[4:5], 21504
s_load_dword s3, s[4:5], 21568
Lsp_12:
s_waitcnt vmcnt(14)
s_barrier
s_add_u32 m0, s39, 43008
s_mov_b64 exec, s[60:61]
buffer_load_dwordx4 v4, s[8:11], s37 offen lds
s_mov_b64 exec, -1
s_add_u32 m0, s39, 46080
s_nop 0
buffer_load_dwordx4 v5, s[8:11], s37 offen lds
s_add_u32 m0, s39, 49152
s_nop 0
buffer_load_dwordx4 v6, s[8:11], s37 offen lds
s_add_u32 m0, s39, 52224
s_nop 0
buffer_load_dwordx4 v7, s[8:11], s37 offen lds
s_add_u32 m0, s39, 55296
s_nop 0
buffer_load_dwordx4 v8, s[8:11], s37 offen lds
s_add_u32 m0, s39, 58368
s_nop 0
buffer_load_dwordx4 v9, s[8:11], s37 offen lds
s_add_u32 m0, s40, 43008
s_add_u32 s43, s38, 0
buffer_load_dwordx4 v2, s[12:15], s43 offen lds
s_add_u32 m0, s40, 44032
s_add_u32 s43, s38, 49152
buffer_load_dwordx4 v3, s[12:15], s43 offen lds
s_add_u32 m0, s40, 45056
s_add_u32 s43, s38, 98304
buffer_load_dwordx4 v2, s[12:15], s43 offen lds
s_add_u32 m0, s40, 46080
s_add_u32 s43, s38, 147456
buffer_load_dwordx4 v3, s[12:15], s43 offen lds
s_add_u32 m0, s40, 47104
s_add_u32 s43, s38, 196608
buffer_load_dwordx4 v2, s[12:15], s43 offen lds
s_add_u32 m0, s40, 48128
s_add_u32 s43, s38, 245760
buffer_load_dwordx4 v3, s[12:15], s43 offen lds
s_add_u32 m0, s40, 49152
s_add_u32 s43, s38, 294912
buffer_load_dwordx4 v2, s[12:15], s43 offen lds
s_add_u32 m0, s40, 50176
s_add_u32 s43, s38, 344064
buffer_load_dwordx4 v3, s[12:15], s43 offen lds
s_add_u32 s37, s37, 128
s_add_u32 s38, s38, 393216
s_load_dword s3, s[4:5], 21632
s_load_dword s3, s[4:5], 21696
s_load_dword s3, s[4:5], 28672
s_load_dword s3, s[4:5], 28736
s_load_dword s3, s[4:5], 28800
s_load_dword s3, s[4:5], 28864
s_load_dword s3, s[4:5], 35840
Lsp_13:
s_waitcnt vmcnt(14)
s_barrier
s_add_u32 m0, s39, 86016
s_mov_b64 exec, s[60:61]
buffer_load_dwordx4 v4, s[8:11], s37 offen lds
s_mov_b64 exec, -1
s_add_u32 m0, s39, 89088
s_nop 0
buffer_load_dwordx4 v5, s[8:11], s37 offen lds
s_add_u32 m0, s39, 92160
s_nop 0
buffer_load_dwordx4 v6, s[8:11], s37 offen lds
s_add_u32 m0, s39, 95232
s_nop 0
buffer_load_dwordx4 v7, s[8:11], s37 offen lds
s_add_u32 m0, s39, 98304
s_nop 0
buffer_load_dwordx4 v8, s[8:11], s37 offen lds
s_add_u32 m0, s39, 101376
s_nop 0
buffer_load_dwordx4 v9, s[8:11], s37 offen lds
s_add_u32 m0, s40, 86016
s_add_u32 s43, s38, 0
buffer_load_dwordx4 v2, s[12:15], s43 offen lds
s_add_u32 m0, s40, 87040
s_add_u32 s43, s38, 49152
buffer_load_dwordx4 v3, s[12:15], s43 offen lds
s_add_u32 m0, s40, 88064
s_add_u32 s43, s38, 98304
buffer_load_dwordx4 v2, s[12:15], s43 offen lds
s_add_u32 m0, s40, 89088
s_add_u32 s43, s38, 147456
buffer_load_dwordx4 v3, s[12:15], s43 offen lds
s_add_u32 m0, s40, 90112
s_add_u32 s43, s38, 196608
buffer_load_dwordx4 v2, s[12:15], s43 offen lds
s_add_u32 m0, s40, 91136
s_add_u32 s43, s38, 245760
buffer_load_dwordx4 v3, s[12:15], s43 offen lds
s_add_u32 m0, s40, 92160
s_add_u32 s43, s38, 294912
buffer_load_dwordx4 v2, s[12:15], s43 offen lds
s_add_u32 m0, s40, 93184
s_add_u32 s43, s38, 344064
buffer_load_dwordx4 v3, s[12:15], s43 offen lds
s_add_u32 s37, s37, 128
s_add_u32 s38, s38, 393216
s_load_dword s3, s[4:5], 35904
s_load_dword s3, s[4:5], 35968
s_load_dword s3, s[4:5], 36032
s_load_dword s3, s[4:5], 43008
s_load_dword s3, s[4:5], 43072
s_load_dword s3, s[4:5], 43136
s_load_dword s3, s[4:5], 43200
s_load_dword s3, s[4:5], 50176
Lsp_14:
s_waitcnt vmcnt(14)
s_barrier
s_add_u32 m0, s39, 0
s_mov_b64 exec, s[60:61]
buffer_load_dwordx4 v4, s[8:11], s37 offen lds
s_mov_b64 exec, -1
s_add_u32 m0, s39, 3072
s_nop 0
buffer_load_dwordx4 v5, s[8:11], s37 offen lds
s_add_u32 m0, s39, 6144
s_nop 0
buffer_load_dwordx4 v6, s[8:11], s37 offen lds
s_add_u32 m0, s39, 9216
s_nop 0
buffer_load_dwordx4 v7, s[8:11], s37 offen lds
s_add_u32 m0, s39, 12288
s_nop 0
buffer_load_dwordx4 v8, s[8:11], s37 offen lds
s_add_u32 m0, s39, 15360
s_nop 0
buffer_load_dwordx4 v9, s[8:11], s37 offen lds
s_add_u32 m0, s40, 0
s_add_u32 s43, s38, 0
buffer_load_dwordx4 v2, s[12:15], s43 offen lds
s_add_u32 m0, s40, 1024
s_add_u32 s43, s38, 49152
buffer_load_dwordx4 v3, s[12:15], s43 offen lds
s_add_u32 m0, s40, 2048
s_add_u32 s43, s38, 98304
buffer_load_dwordx4 v2, s[12:15], s43 offen lds
s_add_u32 m0, s40, 3072
s_add_u32 s43, s38, 147456
buffer_load_dwordx4 v3, s[12:15], s43 offen lds
s_add_u32 m0, s40, 4096
s_add_u32 s43, s38, 196608
buffer_load_dwordx4 v2, s[12:15], s43 offen lds
s_add_u32 m0, s40, 5120
s_add_u32 s43, s38, 245760
buffer_load_dwordx4 v3, s[12:15], s43 offen lds
s_add_u32 m0, s40, 6144
s_add_u32 s43, s38, 294912
buffer_load_dwordx4 v2, s[12:15], s43 offen lds
s_add_u32 m0, s40, 7168
s_add_u32 s43, s38, 344064
buffer_load_dwordx4 v3, s[12:15], s43 offen lds
s_add_u32 s37, s37, 128
s_add_u32 s38, s38, 393216
s_load_dword s3, s[4:5], 50240
s_load_dword s3, s[4:5], 50304
s_load_dword s3, s[4:5], 50368
s_load_dword s3, s[4:5], 57344
s_load_dword s3, s[4:5], 57408
s_load_dword s3, s[4:5], 57472
s_load_dword s3, s[4:5], 57536
s_load_dword s3, s[4:5], 64512
s_load_dword s3, s[4:5], 64576
Lsp_15:
s_waitcnt vmcnt(14)
s_barrier
s_add_u32 m0, s39, 43008
s_mov_b64 exec, s[60:61]
buffer_load_dwordx4 v4, s[8:11], s37 offen lds
s_mov_b64 exec, -1
s_add_u32 m0, s39, 46080
s_nop 0
buffer_load_dwordx4 v5, s[8:11], s37 offen lds
s_add_u32 m0, s39, 49152
s_nop 0
buffer_load_dwordx4 v6, s[8:11], s37 offen lds
s_add_u32 m0, s39, 52224
s_nop 0
buffer_load_dwordx4 v7, s[8:11], s37 offen lds
s_add_u32 m0, s39, 55296
s_nop 0
buffer_load_dwordx4 v8, s[8:11], s37 offen lds
s_add_u32 m0, s39, 58368
s_nop 0
buffer_load_dwordx4 v9, s[8:11], s37 offen lds
s_add_u32 m0, s40, 43008
s_add_u32 s43, s38, 0
buffer_load_dwordx4 v2, s[12:15], s43 offen lds
s_add_u32 m0, s40, 44032
s_add_u32 s43, s38, 49152
buffer_load_dwordx4 v3, s[12:15], s43 offen lds
s_add_u32 m0, s40, 45056
s_add_u32 s43, s38, 98304
buffer_load_dwordx4 v2, s[12:15], s43 offen lds
s_add_u32 m0, s40, 46080
s_add_u32 s43, s38, 147456
buffer_load_dwordx4 v3, s[12:15], s43 offen lds
s_add_u32 m0, s40, 47104
s_add_u32 s43, s38, 196608
buffer_load_dwordx4 v2, s[12:15], s43 offen lds
s_add_u32 m0, s40, 48128
s_add_u32 s43, s38, 245760
buffer_load_dwordx4 v3, s[12:15], s43 offen lds
s_add_u32 m0, s40, 49152
s_add_u32 s43, s38, 294912
buffer_load_dwordx4 v2, s[12:15], s43 offen lds
s_add_u32 m0, s40, 50176
s_add_u32 s43, s38, 344064
buffer_load_dwordx4 v3, s[12:15], s43 offen lds
s_add_u32 s37, s37, 128
s_add_u32 s38, s38, 393216
s_load_dword s3, s[4:5], 64640
s_load_dword s3, s[4:5], 64704
s_load_dword s3, s[4:5], 71680
s_load_dword s3, s[4:5], 71744
s_load_dword s3, s[4:5], 71808
s_load_dword s3, s[4:5], 71872
s_load_dword s3, s[4:5], 78848
s_load_dword s3, s[4:5], 78912
s_load_dword s3, s[4:5], 78976
s_load_dword s3, s[4:5], 79040
Lsp_16:
s_waitcnt vmcnt(14)
s_barrier
s_add_u32 m0, s39, 86016
s_mov_b64 exec, s[60:61]
buffer_load_dwordx4 v4, s[8:11], s37 offen lds
s_mov_b64 exec, -1
s_add_u32 m0, s39, 89088
s_nop 0
buffer_load_dwordx4 v5, s[8:11], s37 offen lds
s_add_u32 m0, s39, 92160
s_nop 0
buffer_load_dwordx4 v6, s[8:11], s37 offen lds
s_add_u32 m0, s39, 95232
s_nop 0
buffer_load_dwordx4 v7, s[8:11], s37 offen lds
s_add_u32 m0, s39, 98304
s_nop 0
buffer_load_dwordx4 v8, s[8:11], s37 offen lds
s_add_u32 m0, s39, 101376
s_nop 0
buffer_load_dwordx4 v9, s[8:11], s37 offen lds
s_add_u32 m0, s40, 86016
s_add_u32 s43, s38, 0
buffer_load_dwordx4 v2, s[12:15], s43 offen lds
s_add_u32 m0, s40, 87040
s_add_u32 s43, s38, 49152
buffer_load_dwordx4 v3, s[12:15], s43 offen lds
s_add_u32 m0, s40, 88064
s_add_u32 s43, s38, 98304
buffer_load_dwordx4 v2, s[12:15], s43 offen lds
s_add_u32 m0, s40, 89088
s_add_u32 s43, s38, 147456
buffer_load_dwordx4 v3, s[12:15], s43 offen lds
s_add_u32 m0, s40, 90112
s_add_u32 s43, s38, 196608
buffer_load_dwordx4 v2, s[12:15], s43 offen lds
s_add_u32 m0, s40, 91136
s_add_u32 s43, s38, 245760
buffer_load_dwordx4 v3, s[12:15], s43 offen lds
s_add_u32 m0, s40, 92160
s_add_u32 s43, s38, 294912
buffer_load_dwordx4 v2, s[12:15], s43 offen lds
s_add_u32 m0, s40, 93184
s_add_u32 s43, s38, 344064
buffer_load_dwordx4 v3, s[12:15], s43 offen lds
s_add_u32 s37, s37, 128
s_add_u32 s38, s38, 393216
s_load_dword s3, s[4:5], 86016
s_load_dword s3, s[4:5], 86080
s_load_dword s3, s[4:5], 86144
s_load_dword s3, s[4:5], 86208
s_load_dword s3, s[4:5], 93184
s_load_dword s3, s[4:5], 93248
s_load_dword s3, s[4:5], 93312
s_load_dword s3, s[4:5], 93376
s_load_dword s3, s[4:5], 100352
s_load_dword s3, s[4:5], 100416
Lsp_17:
s_waitcnt vmcnt(14)
s_barrier
s_add_u32 m0, s39, 0
s_mov_b64 exec, s[60:61]
buffer_load_dwordx4 v4, s[8:11], s37 offen lds
s_mov_b64 exec, -1
s_add_u32 m0, s39, 3072
s_nop 0
buffer_load_dwordx4 v5, s[8:11], s37 offen lds
s_add_u32 m0, s39, 6144
s_nop 0
buffer_load_dwordx4 v6, s[8:11], s37 offen lds
s_add_u32 m0, s39, 9216
s_nop 0
buffer_load_dwordx4 v7, s[8:11], s37 offen lds
s_add_u32 m0, s39, 12288
s_nop 0
buffer_load_dwordx4 v8, s[8:11], s37 offen lds
s_add_u32 m0, s39, 15360
s_nop 0
buffer_load_dwordx4 v9, s[8:11], s37 offen lds
s_add_u32 m0, s40, 0
s_add_u32 s43, s38, 0
buffer_load_dwordx4 v2, s[12:15], s43 offen lds
s_add_u32 m0, s40, 1024
s_add_u32 s43, s38, 49152
buffer_load_dwordx4 v3, s[12:15], s43 offen lds
s_add_u32 m0, s40, 2048
s_add_u32 s43, s38, 98304
buffer_load_dwordx4 v2, s[12:15], s43 offen lds
s_add_u32 m0, s40, 3072
s_add_u32 s43, s38, 147456
buffer_load_dwordx4 v3, s[12:15], s43 offen lds
s_add_u32 m0, s40, 4096
s_add_u32 s43, s38, 196608
buffer_load_dwordx4 v2, s[12:15], s43 offen lds
s_add_u32 m0, s40, 5120
s_add_u32 s43, s38, 245760
buffer_load_dwordx4 v3, s[12:15], s43 offen lds
s_add_u32 m0, s40, 6144
s_add_u32 s43, s38, 294912
buffer_load_dwordx4 v2, s[12:15], s43 offen lds
s_add_u32 m0, s40, 7168
s_add_u32 s43, s38, 344064
buffer_load_dwordx4 v3, s[12:15], s43 offen lds
s_add_u32 s37, s37, 128
s_add_u32 s38, s38, 393216
s_load_dword s3, s[4:5], 100480
s_load_dword s3, s[4:5], 100544
s_load_dword s3, s[4:5], 107520
s_load_dword s3, s[4:5], 107584
s_load_dword s3, s[4:5], 107648
s_load_dword s3, s[4:5], 107712
s_load_dword s3, s[4:5], 114688
s_load_dword s3, s[4:5], 114752
s_load_dword s3, s[4:5], 114816
s_load_dword s3, s[4:5], 114880
s_load_dword s3, s[4:5], 121856
Lsp_18:
s_waitcnt vmcnt(14)
s_barrier
s_add_u32 m0, s39, 43008
s_mov_b64 exec, s[60:61]
buffer_load_dwordx4 v4, s[8:11], s37 offen lds
s_mov_b64 exec, -1
s_add_u32 m0, s39, 46080
s_nop 0
buffer_load_dwordx4 v5, s[8:11], s37 offen lds
s_add_u32 m0, s39, 49152
s_nop 0
buffer_load_dwordx4 v6, s[8:11], s37 offen lds
s_add_u32 m0, s39, 52224
s_nop 0
buffer_load_dwordx4 v7, s[8:11], s37 offen lds
s_add_u32 m0, s39, 55296
s_nop 0
buffer_load_dwordx4 v8, s[8:11], s37 offen lds
s_add_u32 m0, s39, 58368
s_nop 0
buffer_load_dwordx4 v9, s[8:11], s37 offen lds
s_add_u32 m0, s40, 43008
s_add_u32 s43, s38, 0
buffer_load_dwordx4 v2, s[12:15], s43 offen lds
s_add_u32 m0, s40, 44032
s_add_u32 s43, s38, 49152
buffer_load_dwordx4 v3, s[12:15], s43 offen lds
s_add_u32 m0, s40, 45056
s_add_u32 s43, s38, 98304
buffer_load_dwordx4 v2, s[12:15], s43 offen lds
s_add_u32 m0, s40, 46080
s_add_u32 s43, s38, 147456
buffer_load_dwordx4 v3, s[12:15], s43 offen lds
s_add_u32 m0, s40, 47104
s_add_u32 s43, s38, 196608
buffer_load_dwordx4 v2, s[12:15], s43 offen lds
s_add_u32 m0, s40, 48128
s_add_u32 s43, s38, 245760
buffer_load_dwordx4 v3, s[12:15], s43 offen lds
s_add_u32 m0, s40, 49152
s_add_u32 s43, s38, 294912
buffer_load_dwordx4 v2, s[12:15], s43 offen lds
s_add_u32 m0, s40, 50176
s_add_u32 s43, s38, 344064
buffer_load_dwordx4 v3, s[12:15], s43 offen lds
s_add_u32 s37, s37, 128
s_add_u32 s38, s38, 393216
s_load_dword s3, s[4:5], 121920
s_load_dword s3, s[4:5], 121984
s_load_dword s3, s[4:5], 122048
s_load_dword s3, s[4:5], 129024
s_load_dword s3, s[4:5], 129088
s_load_dword s3, s[4:5], 129152
s_load_dword s3, s[4:5], 129216
s_load_dword s3, s[4:5], 136192
s_load_dword s3, s[4:5], 136256
s_load_dword s3, s[4:5], 136320
s_load_dword s3, s[4:5], 136384
Lsp_19:
s_waitcnt vmcnt(14)
s_barrier
s_add_u32 m0, s39, 86016
s_mov_b64 exec, s[60:61]
buffer_load_dwordx4 v4, s[8:11], s37 offen lds
s_mov_b64 exec, -1
s_add_u32 m0, s39, 89088
s_nop 0
buffer_load_dwordx4 v5, s[8:11], s37 offen lds
s_add_u32 m0, s39, 92160
s_nop 0
buffer_load_dwordx4 v6, s[8:11], s37 offen lds
s_add_u32 m0, s39, 95232
s_nop 0
buffer_load_dwordx4 v7, s[8:11], s37 offen lds
s_add_u32 m0, s39, 98304
s_nop 0
buffer_load_dwordx4 v8, s[8:11], s37 offen lds
s_add_u32 m0, s39, 101376
s_nop 0
buffer_load_dwordx4 v9, s[8:11], s37 offen lds
s_add_u32 m0, s40, 86016
s_add_u32 s43, s38, 0
buffer_load_dwordx4 v2, s[12:15], s43 offen lds
s_add_u32 m0, s40, 87040
s_add_u32 s43, s38, 49152
buffer_load_dwordx4 v3, s[12:15], s43 offen lds
s_add_u32 m0, s40, 88064
s_add_u32 s43, s38, 98304
buffer_load_dwordx4 v2, s[12:15], s43 offen lds
s_add_u32 m0, s40, 89088
s_add_u32 s43, s38, 147456
buffer_load_dwordx4 v3, s[12:15], s43 offen lds
s_add_u32 m0, s40, 90112
s_add_u32 s43, s38, 196608
buffer_load_dwordx4 v2, s[12:15], s43 offen lds
s_add_u32 m0, s40, 91136
s_add_u32 s43, s38, 245760
buffer_load_dwordx4 v3, s[12:15], s43 offen lds
s_add_u32 m0, s40, 92160
s_add_u32 s43, s38, 294912
buffer_load_dwordx4 v2, s[12:15], s43 offen lds
s_add_u32 m0, s40, 93184
s_add_u32 s43, s38, 344064
buffer_load_dwordx4 v3, s[12:15], s43 offen lds
s_add_u32 s37, s37, 128
s_add_u32 s38, s38, 393216
s_load_dword s3, s[4:5], 143360
s_load_dword s3, s[4:5], 143424
s_load_dword s3, s[4:5], 143488
s_load_dword s3, s[4:5], 143552
s_load_dword s3, s[4:5], 150528
s_load_dword s3, s[4:5], 150592
s_load_dword s3, s[4:5], 150656
s_load_dword s3, s[4:5], 150720
s_load_dword s3, s[4:5], 157696
s_load_dword s3, s[4:5], 157760
s_load_dword s3, s[4:5], 157824
Lsp_20:
s_waitcnt vmcnt(14)
s_barrier
s_add_u32 m0, s39, 0
s_mov_b64 exec, s[60:61]
buffer_load_dwordx4 v4, s[8:11], s37 offen lds
s_mov_b64 exec, -1
s_add_u32 m0, s39, 3072
s_nop 0
buffer_load_dwordx4 v5, s[8:11], s37 offen lds
s_add_u32 m0, s39, 6144
s_nop 0
buffer_load_dwordx4 v6, s[8:11], s37 offen lds
s_add_u32 m0, s39, 9216
s_nop 0
buffer_load_dwordx4 v7, s[8:11], s37 offen lds
s_add_u32 m0, s39, 12288
s_nop 0
buffer_load_dwordx4 v8, s[8:11], s37 offen lds
s_add_u32 m0, s39, 15360
s_nop 0
buffer_load_dwordx4 v9, s[8:11], s37 offen lds
s_add_u32 m0, s40, 0
s_add_u32 s43, s38, 0
buffer_load_dwordx4 v2, s[12:15], s43 offen lds
s_add_u32 m0, s40, 1024
s_add_u32 s43, s38, 49152
buffer_load_dwordx4 v3, s[12:15], s43 offen lds
s_add_u32 m0, s40, 2048
s_add_u32 s43, s38, 98304
buffer_load_dwordx4 v2, s[12:15], s43 offen lds
s_add_u32 m0, s40, 3072
s_add_u32 s43, s38, 147456
buffer_load_dwordx4 v3, s[12:15], s43 offen lds
s_add_u32 m0, s40, 4096
s_add_u32 s43, s38, 196608
buffer_load_dwordx4 v2, s[12:15], s43 offen lds
s_add_u32 m0, s40, 5120
s_add_u32 s43, s38, 245760
buffer_load_dwordx4 v3, s[12:15], s43 offen lds
s_add_u32 m0, s40, 6144
s_add_u32 s43, s38, 294912
buffer_load_dwordx4 v2, s[12:15], s43 offen lds
s_add_u32 m0, s40, 7168
s_add_u32 s43, s38, 344064
buffer_load_dwordx4 v3, s[12:15], s43 offen lds
s_add_u32 s37, s37, 128
s_add_u32 s38, s38, 393216
s_load_dword s3, s[4:5], 157888
s_load_dword s3, s[4:5], 164864
s_load_dword s3, s[4:5], 164928
s_load_dword s3, s[4:5], 164992
s_load_dword s3, s[4:5], 165056
s_load_dword s3, s[4:5], 172032
s_load_dword s3, s[4:5], 172096
s_load_dword s3, s[4:5], 172160
s_load_dword s3, s[4:5], 172224
s_load_dword s3, s[4:5], 179200
s_load_dword s3, s[4:5], 179264
Lsp_21:
s_waitcnt vmcnt(14)
s_barrier
s_load_dword s3, s[4:5], 179328
s_load_dword s3, s[4:5], 179392
s_load_dword s3, s[4:5], 186368
s_load_dword s3, s[4:5], 186432
s_load_dword s3, s[4:5], 186496
s_load_dword s3, s[4:5], 186560
s_load_dword s3, s[4:5], 193536
s_branch Lov_1
.p2align 12
Lst_1_0:
s_branch Lwr_161
s_nop 0
s_nop 0
Lov_1:
s_load_dword s3, s[4:5], 193600
s_load_dword s3, s[4:5], 193664
s_load_dword s3, s[4:5], 193728
Lsp_22:
s_waitcnt vmcnt(0)
s_barrier
s_bitcmp0_b32 s2, 0
s_cselect_b32 s88, s72, s74
s_cselect_b32 s89, s73, s75
s_cmp_lt_u32 s2, 192
s_cselect_b32 s90, 7340032, 0
s_mov_b32 s91, 0x20000
s_bfe_u32 s44, s2, 0x30001
s_lshl_b32 s44, s44, 2
s_and_b32 s43, s36, 3
s_add_u32 s44, s44, s43
s_lshl_b32 s44, s44, 5
v_lshrrev_b32 v18, 4, v1
v_add_u32 v18, s44, v18
v_mul_u32_u24 v18, 7168, v18
v_and_b32 v19, 15, v1
v_lshl_add_u32 v18, v19, 4, v18
s_lshr_b32 s43, s2, 4
s_lshl_b32 s43, s43, 8
s_add_u32 s43, s43, 4096
v_add_u32 v18, s43, v18
s_mov_b32 s43, 0
buffer_load_dwordx4 v[128:131], v18, s[88:91], s43 offen
s_mov_b32 s43, 28672
buffer_load_dwordx4 v[132:135], v18, s[88:91], s43 offen
s_mov_b32 s43, 57344
buffer_load_dwordx4 v[136:139], v18, s[88:91], s43 offen
s_mov_b32 s43, 86016
buffer_load_dwordx4 v[140:143], v18, s[88:91], s43 offen
s_mov_b32 s43, 114688
buffer_load_dwordx4 v[144:147], v18, s[88:91], s43 offen
s_mov_b32 s43, 143360
buffer_load_dwordx4 v[148:151], v18, s[88:91], s43 offen
s_mov_b32 s43, 172032
buffer_load_dwordx4 v[152:155], v18, s[88:91], s43 offen
s_mov_b32 s43, 200704
buffer_load_dwordx4 v[156:159], v18, s[88:91], s43 offen
s_barrier
s_lshl_b32 s43, s35, 7
s_add_u32 s28, s68, s43
s_addc_u32 s29, s69, 0
s_mov_b32 s30, 2095232
s_mov_b32 s31, 0x20000
v_lshrrev_b32 v15, 3, v1
v_and_b32 v16, 6, v15
v_and_b32 v7, 7, v1
v_xor_b32 v7, v7, v16
v_lshlrev_b32 v7, 4, v7
v_mul_u32_u24 v15, 2048, v15
v_add_u32 v7, v7, v15
s_and_b32 s40, s36, 3
s_lshl_b32 s39, s40, 13
s_add_u32 s40, s40, s35
s_add_u32 s42, s40, 0
s_and_b32 s42, s42, 15
s_lshl_b32 s42, s42, 17
s_add_u32 m0, s39, 65536
s_add_u32 s43, s42, 0
buffer_load_dwordx4 v7, s[28:31], s43 offen lds
s_add_u32 m0, s39, 66560
s_add_u32 s43, s42, 16384
buffer_load_dwordx4 v7, s[28:31], s43 offen lds
s_add_u32 m0, s39, 67584
s_add_u32 s43, s42, 32768
buffer_load_dwordx4 v7, s[28:31], s43 offen lds
s_add_u32 m0, s39, 68608
s_add_u32 s43, s42, 49152
buffer_load_dwordx4 v7, s[28:31], s43 offen lds
s_add_u32 m0, s39, 69632
s_add_u32 s43, s42, 65536
buffer_load_dwordx4 v7, s[28:31], s43 offen lds
s_add_u32 m0, s39, 70656
s_add_u32 s43, s42, 81920
buffer_load_dwordx4 v7, s[28:31], s43 offen lds
s_add_u32 m0, s39, 71680
s_add_u32 s43, s42, 98304
buffer_load_dwordx4 v7, s[28:31], s43 offen lds
s_add_u32 m0, s39, 72704
s_add_u32 s43, s42, 114688
buffer_load_dwordx4 v7, s[28:31], s43 offen lds
s_branch Lats_6
Lcons_7:
s_lshl_b32 s43, s35, 7
s_waitcnt lgkmcnt(0)
s_mov_b32 s8, s64
s_mov_b32 s9, s65
s_mov_b32 s10, 4194304
s_mov_b32 s11, 0x20000
s_add_u32 s12, s66, s43
s_addc_u32 s13, s67, 0
s_mov_b32 s14, 6289536
s_mov_b32 s15, 0x20000
s_lshr_b32 s43, s2, 3
s_lshl_b32 s43, s43, 2
s_add_u32 s43, s43, s36
s_sub_u32 s44, s43, 0
s_and_b32 s44, s44, 127
s_cmp_lt_u32 s44, 24
s_cbranch_scc0 Lt_23
s_lshl_b32 s44, s44, 20
s_min_u32 s44, s44, 24117184
s_load_dword s3, s[82:83], s44 glc
Lt_23:
s_sub_u32 s44, s43, 24
s_and_b32 s44, s44, 127
s_cmp_lt_u32 s44, 8
s_cbranch_scc0 Lt_24
s_lshl_b32 s44, s44, 20
s_min_u32 s44, s44, 7339968
s_load_dword s3, s[72:73], s44
Lt_24:
s_sub_u32 s44, s43, 32
s_and_b32 s44, s44, 127
s_cmp_lt_u32 s44, 8
s_cbranch_scc0 Lt_25
s_lshl_b32 s44, s44, 20
s_min_u32 s44, s44, 7339968
s_load_dword s3, s[74:75], s44
Lt_25:
s_sub_u32 s44, s43, 40
s_and_b32 s44, s44, 127
s_cmp_lt_u32 s44, 3
s_cbranch_scc0 Lt_26
s_lshl_b32 s44, s44, 20
s_min_u32 s44, s44, 2097088
s_load_dword s3, s[68:69], s44
Lt_26:
s_sub_u32 s44, s43, 43
s_and_b32 s44, s44, 127
s_cmp_lt_u32 s44, 5
s_cbranch_scc0 Lt_27
s_lshl_b32 s44, s44, 20
s_min_u32 s44, s44, 4194240
s_add_u32 s44, s44, 25165824
s_load_dword s3, s[82:83], s44 glc
Lt_27:
s_sub_u32 s44, s43, 48
s_and_b32 s44, s44, 127
s_cmp_lt_u32 s44, 8
s_cbranch_scc0 Lt_28
s_lshl_b32 s44, s44, 20
s_min_u32 s44, s44, 7339968
s_load_dword s3, s[76:77], s44
Lt_28:
s_sub_u32 s44, s43, 56
s_and_b32 s44, s44, 127
s_cmp_lt_u32 s44, 5
s_cbranch_scc0 Lt_29
s_lshl_b32 s44, s44, 20
s_min_u32 s44, s44, 4194240
s_add_u32 s44, s44, 33554432
s_load_dword s3, s[82:83], s44 glc
Lt_29:
s_sub_u32 s44, s43, 61
s_and_b32 s44, s44, 127
s_cmp_lt_u32 s44, 5
s_cbranch_scc0 Lt_30
s_lshl_b32 s44, s44, 20
s_min_u32 s44, s44, 4194240
s_load_dword s3, s[78:79], s44 glc
Lt_30:
v_lshrrev_b32 v16, 1, v12
v_xor_b32 v15, v13, v16
v_lshlrev_b32 v15, 4, v15
v_lshl_add_u32 v2, v12, 7, v15
v_xor_b32 v3, 64, v2
v_add_u32 v4, 86016, v2
v_add_u32 v5, 86016, v3
v_lshrrev_b32 v15, 2, v12
v_and_b32 v16, 3, v1
v_lshl_add_u32 v19, v13, 3, v15
v_lshlrev_b32 v19, 7, v19
v_and_b32 v15, 2, v15
v_and_b32 v17, 1, v13
v_lshl_add_u32 v15, v17, 2, v15
v_lshrrev_b32 v17, 1, v16
s_lshl_b32 s43, s36, 1
v_add_u32 v17, s43, v17
v_xor_b32 v15, v15, v17
v_lshl_add_u32 v19, v15, 4, v19
v_and_b32 v16, 1, v16
v_lshl_add_u32 v19, v16, 3, v19
v_add_u32 v6, 18432, v19
v_add_u32 v7, 61440, v19
v_add_u32 v8, 104448, v19
s_and_b32 s43, s36, 1
s_bfe_u32 s44, s36, 0x10001
s_lshr_b32 s45, s36, 2
v_lshlrev_b32 v14, 2, v13
v_sub_u32 v14, v12, v14
v_mov_b32 v16, 0xff800000
s_or_b32 s46, s34, s45
s_cmp_lg_u32 s46, 0
s_cselect_b32 s46, 0, 0xff800000
v_subrev_u32 v15, 0, v14
v_cmp_ge_u32 vcc, 7, v15
v_add_u32 v15, 16, v15
s_nop 0
v_cndmask_b32 v248, v16, 0, vcc
v_cmp_ge_u32 vcc, 7, v15
s_nop 1
v_cndmask_b32 v244, v16, 0, vcc
v_or_b32 v240, s46, v244
v_subrev_u32 v15, 1, v14
v_cmp_ge_u32 vcc, 7, v15
v_add_u32 v15, 16, v15
s_nop 0
v_cndmask_b32 v249, v16, 0, vcc
v_cmp_ge_u32 vcc, 7, v15
s_nop 1
v_cndmask_b32 v245, v16, 0, vcc
v_or_b32 v241, s46, v245
v_subrev_u32 v15, 2, v14
v_cmp_ge_u32 vcc, 7, v15
v_add_u32 v15, 16, v15
s_nop 0
v_cndmask_b32 v250, v16, 0, vcc
v_cmp_ge_u32 vcc, 7, v15
s_nop 1
v_cndmask_b32 v246, v16, 0, vcc
v_or_b32 v242, s46, v246
v_subrev_u32 v15, 3, v14
v_cmp_ge_u32 vcc, 7, v15
v_add_u32 v15, 16, v15
s_nop 0
v_cndmask_b32 v251, v16, 0, vcc
v_cmp_ge_u32 vcc, 7, v15
s_nop 1
v_cndmask_b32 v247, v16, 0, vcc
v_or_b32 v243, s46, v247
s_lshl_b32 s46, s45, 6
s_add_u32 s46, s46, s44
s_add_u32 s46, s46, 16
v_lshl_add_u32 v14, v12, 1, s46
s_lshl_b32 s47, s43, 6
v_lshl_add_u32 v15, v13, 4, s47
v_mul_u32_u24 v20, 400, v14
v_add_u32 v20, v20, v15
v_subrev_u32 v16, 32, v14
v_max_i32 v16, 0, v16
v_mul_u32_u24 v21, 400, v16
v_add_u32 v21, v21, v15
v_lshrrev_b32 v16, 2, v12
v_lshl_add_u32 v16, v13, 2, v16
v_lshl_add_u32 v16, v16, 1, s46
v_and_b32 v17, 3, v1
v_lshl_add_u32 v17, v17, 3, s47
v_mul_u32_u24 v22, 400, v16
v_add_u32 v22, v22, v17
v_subrev_u32 v16, 32, v16
v_max_i32 v16, 0, v16
v_mul_u32_u24 v23, 400, v16
v_add_u32 v23, v23, v17
s_mul_i32 s60, s34, 262144
s_add_u32 s16, s82, s60
s_addc_u32 s17, s83, 0
s_mov_b32 s18, 262144
s_mov_b32 s19, 0x20000
s_lshl_b32 s60, s35, 14
s_lshl_b32 s43, s43, 13
s_add_u32 s60, s60, s43
s_lshl_b32 s43, s45, 12
s_add_u32 s60, s60, s43
s_lshl_b32 s43, s44, 10
s_add_u32 s60, s60, s43
v_lshlrev_b32 v24, 4, v1
s_mov_b32 s61, 0x3e8293ee
s_lshl_b32 s38, s35, 7
s_add_u32 s56, s82, 28311552
s_addc_u32 s57, s83, 0
s_mov_b32 s58, 114688
s_mov_b32 s59, 0x20000
s_barrier
ds_read_b128 v[32:35], v2 offset:0
ds_read_b64_tr_b16 v[72:73], v6 offset:8192
ds_read_b64_tr_b16 v[74:75], v6 offset:8704
ds_read_b64_tr_b16 v[76:77], v6 offset:16384
ds_read_b64_tr_b16 v[78:79], v6 offset:16896
ds_read_b64_tr_b16 v[68:69], v6 offset:0
ds_read_b64_tr_b16 v[70:71], v6 offset:512
ds_read_b128 v[36:39], v2 offset:2048
ds_read_b128 v[40:43], v2 offset:4096
ds_read_b128 v[44:47], v2 offset:6144
ds_read_b128 v[48:51], v2 offset:8192
ds_read_b128 v[52:55], v2 offset:10240
ds_read_b128 v[56:59], v2 offset:12288
ds_read_b128 v[60:63], v2 offset:14336
ds_read_b128 v[64:67], v2 offset:16384
s_waitcnt lgkmcnt(0)
v_mfma_f32_16x16x32_bf16 v[128:131], v[68:71], v[32:35], 0
ds_read_b128 v[80:83], v3 offset:0
v_mfma_f32_16x16x32_bf16 v[132:135], v[68:71], v[36:39], 0
ds_read_b64_tr_b16 v[120:121], v6 offset:12288
v_mfma_f32_16x16x32_bf16 v[136:139], v[68:71], v[40:43], 0
ds_read_b64_tr_b16 v[122:123], v6 offset:12800
v_mfma_f32_16x16x32_bf16 v[140:143], v[68:71], v[44:47], 0
ds_read_b64_tr_b16 v[124:125], v6 offset:20480
v_mfma_f32_16x16x32_bf16 v[144:147], v[68:71], v[48:51], 0
ds_read_b64_tr_b16 v[126:127], v6 offset:20992
v_mfma_f32_16x16x32_bf16 v[148:151], v[68:71], v[52:55], 0
ds_read_b64_tr_b16 v[116:117], v6 offset:4096
v_mfma_f32_16x16x32_bf16 v[152:155], v[68:71], v[56:59], 0
ds_read_b64_tr_b16 v[118:119], v6 offset:4608
v_mfma_f32_16x16x32_bf16 v[156:159], v[68:71], v[60:63], 0
ds_read_b128 v[84:87], v3 offset:2048
v_mfma_f32_16x16x32_bf16 v[160:163], v[68:71], v[64:67], 0
ds_read_b128 v[88:91], v3 offset:4096
v_mfma_f32_16x16x32_bf16 v[196:199], v[72:75], v[64:67], 0
ds_read_b128 v[92:95], v3 offset:6144
v_mfma_f32_16x16x32_bf16 v[192:195], v[72:75], v[60:63], 0
ds_read_b128 v[96:99], v3 offset:8192
v_mfma_f32_16x16x32_bf16 v[188:191], v[72:75], v[56:59], 0
ds_read_b128 v[100:103], v3 offset:10240
v_mfma_f32_16x16x32_bf16 v[184:187], v[72:75], v[52:55], 0
ds_read_b128 v[104:107], v3 offset:12288
v_mfma_f32_16x16x32_bf16 v[180:183], v[72:75], v[48:51], 0
ds_read_b128 v[108:111], v3 offset:14336
v_mfma_f32_16x16x32_bf16 v[176:179], v[72:75], v[44:47], 0
ds_read_b128 v[112:115], v3 offset:16384
v_mfma_f32_16x16x32_bf16 v[172:175], v[72:75], v[40:43], 0
v_mfma_f32_16x16x32_bf16 v[168:171], v[72:75], v[36:39], 0
v_mfma_f32_16x16x32_bf16 v[164:167], v[72:75], v[32:35], 0
v_mfma_f32_16x16x32_bf16 v[200:203], v[76:79], v[32:35], 0
v_mfma_f32_16x16x32_bf16 v[204:207], v[76:79], v[36:39], 0
v_mfma_f32_16x16x32_bf16 v[208:211], v[76:79], v[40:43], 0
v_mfma_f32_16x16x32_bf16 v[212:215], v[76:79], v[44:47], 0
v_mfma_f32_16x16x32_bf16 v[216:219], v[76:79], v[48:51], 0
v_mfma_f32_16x16x32_bf16 v[220:223], v[76:79], v[52:55], 0
v_mfma_f32_16x16x32_bf16 v[224:227], v[76:79], v[56:59], 0
v_mfma_f32_16x16x32_bf16 v[228:231], v[76:79], v[60:63], 0
v_mfma_f32_16x16x32_bf16 v[232:235], v[76:79], v[64:67], 0
s_waitcnt lgkmcnt(0)
s_barrier
v_mfma_f32_16x16x32_bf16 v[128:131], v[116:119], v[80:83], v[128:131]
ds_read_b128 v[32:35], v2 offset:43008
v_mfma_f32_16x16x32_bf16 v[132:135], v[116:119], v[84:87], v[132:135]
ds_read_b64_tr_b16 v[72:73], v7 offset:8192
v_mfma_f32_16x16x32_bf16 v[136:139], v[116:119], v[88:91], v[136:139]
ds_read_b64_tr_b16 v[74:75], v7 offset:8704
v_mfma_f32_16x16x32_bf16 v[140:143], v[116:119], v[92:95], v[140:143]
ds_read_b64_tr_b16 v[76:77], v7 offset:16384
v_mfma_f32_16x16x32_bf16 v[144:147], v[116:119], v[96:99], v[144:147]
ds_read_b64_tr_b16 v[78:79], v7 offset:16896
v_mfma_f32_16x16x32_bf16 v[148:151], v[116:119], v[100:103], v[148:151]
ds_read_b64_tr_b16 v[68:69], v7 offset:0
v_mfma_f32_16x16x32_bf16 v[152:155], v[116:119], v[104:107], v[152:155]
ds_read_b64_tr_b16 v[70:71], v7 offset:512
v_mfma_f32_16x16x32_bf16 v[156:159], v[116:119], v[108:111], v[156:159]
ds_read_b128 v[36:39], v2 offset:45056
v_mfma_f32_16x16x32_bf16 v[160:163], v[116:119], v[112:115], v[160:163]
ds_read_b128 v[40:43], v2 offset:47104
v_mfma_f32_16x16x32_bf16 v[196:199], v[120:123], v[112:115], v[196:199]
ds_read_b128 v[44:47], v2 offset:49152
v_mfma_f32_16x16x32_bf16 v[192:195], v[120:123], v[108:111], v[192:195]
ds_read_b128 v[48:51], v2 offset:51200
v_mfma_f32_16x16x32_bf16 v[188:191], v[120:123], v[104:107], v[188:191]
ds_read_b128 v[52:55], v2 offset:53248
v_mfma_f32_16x16x32_bf16 v[184:187], v[120:123], v[100:103], v[184:187]
ds_read_b128 v[56:59], v2 offset:55296
v_mfma_f32_16x16x32_bf16 v[180:183], v[120:123], v[96:99], v[180:183]
ds_read_b128 v[60:63], v2 offset:57344
v_mfma_f32_16x16x32_bf16 v[176:179], v[120:123], v[92:95], v[176:179]
ds_read_b128 v[64:67], v2 offset:59392
v_mfma_f32_16x16x32_bf16 v[172:175], v[120:123], v[88:91], v[172:175]
v_mfma_f32_16x16x32_bf16 v[168:171], v[120:123], v[84:87], v[168:171]
v_mfma_f32_16x16x32_bf16 v[164:167], v[120:123], v[80:83], v[164:167]
v_mfma_f32_16x16x32_bf16 v[200:203], v[124:127], v[80:83], v[200:203]
v_mfma_f32_16x16x32_bf16 v[204:207], v[124:127], v[84:87], v[204:207]
v_mfma_f32_16x16x32_bf16 v[208:211], v[124:127], v[88:91], v[208:211]
v_mfma_f32_16x16x32_bf16 v[212:215], v[124:127], v[92:95], v[212:215]
v_mfma_f32_16x16x32_bf16 v[216:219], v[124:127], v[96:99], v[216:219]
v_mfma_f32_16x16x32_bf16 v[220:223], v[124:127], v[100:103], v[220:223]
v_mfma_f32_16x16x32_bf16 v[224:227], v[124:127], v[104:107], v[224:227]
v_mfma_f32_16x16x32_bf16 v[228:231], v[124:127], v[108:111], v[228:231]
v_mfma_f32_16x16x32_bf16 v[232:235], v[124:127], v[112:115], v[232:235]
s_waitcnt lgkmcnt(0)
v_mfma_f32_16x16x32_bf16 v[128:131], v[68:71], v[32:35], v[128:131]
ds_read_b128 v[80:83], v3 offset:43008
v_mfma_f32_16x16x32_bf16 v[132:135], v[68:71], v[36:39], v[132:135]
ds_read_b64_tr_b16 v[120:121], v7 offset:12288
v_mfma_f32_16x16x32_bf16 v[136:139], v[68:71], v[40:43], v[136:139]
ds_read_b64_tr_b16 v[122:123], v7 offset:12800
v_mfma_f32_16x16x32_bf16 v[140:143], v[68:71], v[44:47], v[140:143]
ds_read_b64_tr_b16 v[124:125], v7 offset:20480
v_mfma_f32_16x16x32_bf16 v[144:147], v[68:71], v[48:51], v[144:147]
ds_read_b64_tr_b16 v[126:127], v7 offset:20992
v_mfma_f32_16x16x32_bf16 v[148:151], v[68:71], v[52:55], v[148:151]
ds_read_b64_tr_b16 v[116:117], v7 offset:4096
v_mfma_f32_16x16x32_bf16 v[152:155], v[68:71], v[56:59], v[152:155]
ds_read_b64_tr_b16 v[118:119], v7 offset:4608
v_mfma_f32_16x16x32_bf16 v[156:159], v[68:71], v[60:63], v[156:159]
ds_read_b128 v[84:87], v3 offset:45056
v_mfma_f32_16x16x32_bf16 v[160:163], v[68:71], v[64:67], v[160:163]
ds_read_b128 v[88:91], v3 offset:47104
v_mfma_f32_16x16x32_bf16 v[196:199], v[72:75], v[64:67], v[196:199]
ds_read_b128 v[92:95], v3 offset:49152
v_mfma_f32_16x16x32_bf16 v[192:195], v[72:75], v[60:63], v[192:195]
ds_read_b128 v[96:99], v3 offset:51200
v_mfma_f32_16x16x32_bf16 v[188:191], v[72:75], v[56:59], v[188:191]
ds_read_b128 v[100:103], v3 offset:53248
v_mfma_f32_16x16x32_bf16 v[184:187], v[72:75], v[52:55], v[184:187]
ds_read_b128 v[104:107], v3 offset:55296
v_mfma_f32_16x16x32_bf16 v[180:183], v[72:75], v[48:51], v[180:183]
ds_read_b128 v[108:111], v3 offset:57344
v_mfma_f32_16x16x32_bf16 v[176:179], v[72:75], v[44:47], v[176:179]
ds_read_b128 v[112:115], v3 offset:59392
v_mfma_f32_16x16x32_bf16 v[172:175], v[72:75], v[40:43], v[172:175]
v_mfma_f32_16x16x32_bf16 v[168:171], v[72:75], v[36:39], v[168:171]
v_mfma_f32_16x16x32_bf16 v[164:167], v[72:75], v[32:35], v[164:167]
v_mfma_f32_16x16x32_bf16 v[200:203], v[76:79], v[32:35], v[200:203]
v_mfma_f32_16x16x32_bf16 v[204:207], v[76:79], v[36:39], v[204:207]
v_mfma_f32_16x16x32_bf16 v[208:211], v[76:79], v[40:43], v[208:211]
v_mfma_f32_16x16x32_bf16 v[212:215], v[76:79], v[44:47], v[212:215]
v_mfma_f32_16x16x32_bf16 v[216:219], v[76:79], v[48:51], v[216:219]
v_mfma_f32_16x16x32_bf16 v[220:223], v[76:79], v[52:55], v[220:223]
v_mfma_f32_16x16x32_bf16 v[224:227], v[76:79], v[56:59], v[224:227]
v_mfma_f32_16x16x32_bf16 v[228:231], v[76:79], v[60:63], v[228:231]
v_mfma_f32_16x16x32_bf16 v[232:235], v[76:79], v[64:67], v[232:235]
s_waitcnt lgkmcnt(0)
s_barrier
v_mfma_f32_16x16x32_bf16 v[128:131], v[116:119], v[80:83], v[128:131]
ds_read_b128 v[32:35], v4 offset:0
v_mfma_f32_16x16x32_bf16 v[132:135], v[116:119], v[84:87], v[132:135]
ds_read_b64_tr_b16 v[72:73], v8 offset:8192
v_mfma_f32_16x16x32_bf16 v[136:139], v[116:119], v[88:91], v[136:139]
ds_read_b64_tr_b16 v[74:75], v8 offset:8704
v_mfma_f32_16x16x32_bf16 v[140:143], v[116:119], v[92:95], v[140:143]
ds_read_b64_tr_b16 v[76:77], v8 offset:16384
v_mfma_f32_16x16x32_bf16 v[144:147], v[116:119], v[96:99], v[144:147]
ds_read_b64_tr_b16 v[78:79], v8 offset:16896
v_mfma_f32_16x16x32_bf16 v[148:151], v[116:119], v[100:103], v[148:151]
ds_read_b64_tr_b16 v[68:69], v8 offset:0
v_mfma_f32_16x16x32_bf16 v[152:155], v[116:119], v[104:107], v[152:155]
ds_read_b64_tr_b16 v[70:71], v8 offset:512
v_mfma_f32_16x16x32_bf16 v[156:159], v[116:119], v[108:111], v[156:159]
ds_read_b128 v[36:39], v4 offset:2048
v_mfma_f32_16x16x32_bf16 v[160:163], v[116:119], v[112:115], v[160:163]
ds_read_b128 v[40:43], v4 offset:4096
v_mfma_f32_16x16x32_bf16 v[196:199], v[120:123], v[112:115], v[196:199]
ds_read_b128 v[44:47], v4 offset:6144
v_mfma_f32_16x16x32_bf16 v[192:195], v[120:123], v[108:111], v[192:195]
ds_read_b128 v[48:51], v4 offset:8192
v_mfma_f32_16x16x32_bf16 v[188:191], v[120:123], v[104:107], v[188:191]
ds_read_b128 v[52:55], v4 offset:10240
v_mfma_f32_16x16x32_bf16 v[184:187], v[120:123], v[100:103], v[184:187]
ds_read_b128 v[56:59], v4 offset:12288
v_mfma_f32_16x16x32_bf16 v[180:183], v[120:123], v[96:99], v[180:183]
ds_read_b128 v[60:63], v4 offset:14336
v_mfma_f32_16x16x32_bf16 v[176:179], v[120:123], v[92:95], v[176:179]
ds_read_b128 v[64:67], v4 offset:16384
v_mfma_f32_16x16x32_bf16 v[172:175], v[120:123], v[88:91], v[172:175]
v_mfma_f32_16x16x32_bf16 v[168:171], v[120:123], v[84:87], v[168:171]
v_mfma_f32_16x16x32_bf16 v[164:167], v[120:123], v[80:83], v[164:167]
v_mfma_f32_16x16x32_bf16 v[200:203], v[124:127], v[80:83], v[200:203]
v_mfma_f32_16x16x32_bf16 v[204:207], v[124:127], v[84:87], v[204:207]
v_mfma_f32_16x16x32_bf16 v[208:211], v[124:127], v[88:91], v[208:211]
v_mfma_f32_16x16x32_bf16 v[212:215], v[124:127], v[92:95], v[212:215]
v_mfma_f32_16x16x32_bf16 v[216:219], v[124:127], v[96:99], v[216:219]
v_mfma_f32_16x16x32_bf16 v[220:223], v[124:127], v[100:103], v[220:223]
v_mfma_f32_16x16x32_bf16 v[224:227], v[124:127], v[104:107], v[224:227]
v_mfma_f32_16x16x32_bf16 v[228:231], v[124:127], v[108:111], v[228:231]
v_mfma_f32_16x16x32_bf16 v[232:235], v[124:127], v[112:115], v[232:235]
s_waitcnt lgkmcnt(0)
v_mfma_f32_16x16x32_bf16 v[128:131], v[68:71], v[32:35], v[128:131]
ds_read_b128 v[80:83], v5 offset:0
v_mfma_f32_16x16x32_bf16 v[132:135], v[68:71], v[36:39], v[132:135]
ds_read_b64_tr_b16 v[120:121], v8 offset:12288
v_mfma_f32_16x16x32_bf16 v[136:139], v[68:71], v[40:43], v[136:139]
ds_read_b64_tr_b16 v[122:123], v8 offset:12800
v_mfma_f32_16x16x32_bf16 v[140:143], v[68:71], v[44:47], v[140:143]
ds_read_b64_tr_b16 v[124:125], v8 offset:20480
v_mfma_f32_16x16x32_bf16 v[144:147], v[68:71], v[48:51], v[144:147]
ds_read_b64_tr_b16 v[126:127], v8 offset:20992
v_mfma_f32_16x16x32_bf16 v[148:151], v[68:71], v[52:55], v[148:151]
ds_read_b64_tr_b16 v[116:117], v8 offset:4096
v_mfma_f32_16x16x32_bf16 v[152:155], v[68:71], v[56:59], v[152:155]
ds_read_b64_tr_b16 v[118:119], v8 offset:4608
v_mfma_f32_16x16x32_bf16 v[156:159], v[68:71], v[60:63], v[156:159]
ds_read_b128 v[84:87], v5 offset:2048
v_mfma_f32_16x16x32_bf16 v[160:163], v[68:71], v[64:67], v[160:163]
ds_read_b128 v[88:91], v5 offset:4096
v_mfma_f32_16x16x32_bf16 v[196:199], v[72:75], v[64:67], v[196:199]
ds_read_b128 v[92:95], v5 offset:6144
v_mfma_f32_16x16x32_bf16 v[192:195], v[72:75], v[60:63], v[192:195]
ds_read_b128 v[96:99], v5 offset:8192
v_mfma_f32_16x16x32_bf16 v[188:191], v[72:75], v[56:59], v[188:191]
ds_read_b128 v[100:103], v5 offset:10240
v_mfma_f32_16x16x32_bf16 v[184:187], v[72:75], v[52:55], v[184:187]
ds_read_b128 v[104:107], v5 offset:12288
v_mfma_f32_16x16x32_bf16 v[180:183], v[72:75], v[48:51], v[180:183]
ds_read_b128 v[108:111], v5 offset:14336
v_mfma_f32_16x16x32_bf16 v[176:179], v[72:75], v[44:47], v[176:179]
ds_read_b128 v[112:115], v5 offset:16384
v_mfma_f32_16x16x32_bf16 v[172:175], v[72:75], v[40:43], v[172:175]
v_mfma_f32_16x16x32_bf16 v[168:171], v[72:75], v[36:39], v[168:171]
v_mfma_f32_16x16x32_bf16 v[164:167], v[72:75], v[32:35], v[164:167]
v_mfma_f32_16x16x32_bf16 v[200:203], v[76:79], v[32:35], v[200:203]
v_mfma_f32_16x16x32_bf16 v[204:207], v[76:79], v[36:39], v[204:207]
v_mfma_f32_16x16x32_bf16 v[208:211], v[76:79], v[40:43], v[208:211]
v_mfma_f32_16x16x32_bf16 v[212:215], v[76:79], v[44:47], v[212:215]
v_mfma_f32_16x16x32_bf16 v[216:219], v[76:79], v[48:51], v[216:219]
v_mfma_f32_16x16x32_bf16 v[220:223], v[76:79], v[52:55], v[220:223]
v_mfma_f32_16x16x32_bf16 v[224:227], v[76:79], v[56:59], v[224:227]
v_mfma_f32_16x16x32_bf16 v[228:231], v[76:79], v[60:63], v[228:231]
v_mfma_f32_16x16x32_bf16 v[232:235], v[76:79], v[64:67], v[232:235]
s_waitcnt lgkmcnt(0)
s_barrier
v_mfma_f32_16x16x32_bf16 v[128:131], v[116:119], v[80:83], v[128:131]
ds_read_b128 v[32:35], v2 offset:0
v_mfma_f32_16x16x32_bf16 v[132:135], v[116:119], v[84:87], v[132:135]
ds_read_b64_tr_b16 v[72:73], v6 offset:8192
v_mfma_f32_16x16x32_bf16 v[136:139], v[116:119], v[88:91], v[136:139]
ds_read_b64_tr_b16 v[74:75], v6 offset:8704
v_mfma_f32_16x16x32_bf16 v[140:143], v[116:119], v[92:95], v[140:143]
ds_read_b64_tr_b16 v[76:77], v6 offset:16384
v_mfma_f32_16x16x32_bf16 v[144:147], v[116:119], v[96:99], v[144:147]
ds_read_b64_tr_b16 v[78:79], v6 offset:16896
v_mfma_f32_16x16x32_bf16 v[148:151], v[116:119], v[100:103], v[148:151]
ds_read_b64_tr_b16 v[68:69], v6 offset:0
v_mfma_f32_16x16x32_bf16 v[152:155], v[116:119], v[104:107], v[152:155]
ds_read_b64_tr_b16 v[70:71], v6 offset:512
v_mfma_f32_16x16x32_bf16 v[156:159], v[116:119], v[108:111], v[156:159]
ds_read_b128 v[36:39], v2 offset:2048
v_mfma_f32_16x16x32_bf16 v[160:163], v[116:119], v[112:115], v[160:163]
ds_read_b128 v[40:43], v2 offset:4096
v_mfma_f32_16x16x32_bf16 v[196:199], v[120:123], v[112:115], v[196:199]
ds_read_b128 v[44:47], v2 offset:6144
v_mfma_f32_16x16x32_bf16 v[192:195], v[120:123], v[108:111], v[192:195]
ds_read_b128 v[48:51], v2 offset:8192
v_mfma_f32_16x16x32_bf16 v[188:191], v[120:123], v[104:107], v[188:191]
ds_read_b128 v[52:55], v2 offset:10240
v_mfma_f32_16x16x32_bf16 v[184:187], v[120:123], v[100:103], v[184:187]
ds_read_b128 v[56:59], v2 offset:12288
v_mfma_f32_16x16x32_bf16 v[180:183], v[120:123], v[96:99], v[180:183]
ds_read_b128 v[60:63], v2 offset:14336
v_mfma_f32_16x16x32_bf16 v[176:179], v[120:123], v[92:95], v[176:179]
ds_read_b128 v[64:67], v2 offset:16384
v_mfma_f32_16x16x32_bf16 v[172:175], v[120:123], v[88:91], v[172:175]
v_mfma_f32_16x16x32_bf16 v[168:171], v[120:123], v[84:87], v[168:171]
v_mfma_f32_16x16x32_bf16 v[164:167], v[120:123], v[80:83], v[164:167]
v_mfma_f32_16x16x32_bf16 v[200:203], v[124:127], v[80:83], v[200:203]
v_mfma_f32_16x16x32_bf16 v[204:207], v[124:127], v[84:87], v[204:207]
v_mfma_f32_16x16x32_bf16 v[208:211], v[124:127], v[88:91], v[208:211]
v_mfma_f32_16x16x32_bf16 v[212:215], v[124:127], v[92:95], v[212:215]
v_mfma_f32_16x16x32_bf16 v[216:219], v[124:127], v[96:99], v[216:219]
v_mfma_f32_16x16x32_bf16 v[220:223], v[124:127], v[100:103], v[220:223]
v_mfma_f32_16x16x32_bf16 v[224:227], v[124:127], v[104:107], v[224:227]
v_mfma_f32_16x16x32_bf16 v[228:231], v[124:127], v[108:111], v[228:231]
v_mfma_f32_16x16x32_bf16 v[232:235], v[124:127], v[112:115], v[232:235]
s_mov_b32 s41, 4
Lcl_31:
s_waitcnt lgkmcnt(0)
v_mfma_f32_16x16x32_bf16 v[128:131], v[68:71], v[32:35], v[128:131]
ds_read_b128 v[80:83], v3 offset:0
v_mfma_f32_16x16x32_bf16 v[132:135], v[68:71], v[36:39], v[132:135]
ds_read_b64_tr_b16 v[120:121], v6 offset:12288
v_mfma_f32_16x16x32_bf16 v[136:139], v[68:71], v[40:43], v[136:139]
ds_read_b64_tr_b16 v[122:123], v6 offset:12800
v_mfma_f32_16x16x32_bf16 v[140:143], v[68:71], v[44:47], v[140:143]
ds_read_b64_tr_b16 v[124:125], v6 offset:20480
v_mfma_f32_16x16x32_bf16 v[144:147], v[68:71], v[48:51], v[144:147]
ds_read_b64_tr_b16 v[126:127], v6 offset:20992
v_mfma_f32_16x16x32_bf16 v[148:151], v[68:71], v[52:55], v[148:151]
ds_read_b64_tr_b16 v[116:117], v6 offset:4096
v_mfma_f32_16x16x32_bf16 v[152:155], v[68:71], v[56:59], v[152:155]
ds_read_b64_tr_b16 v[118:119], v6 offset:4608
v_mfma_f32_16x16x32_bf16 v[156:159], v[68:71], v[60:63], v[156:159]
ds_read_b128 v[84:87], v3 offset:2048
v_mfma_f32_16x16x32_bf16 v[160:163], v[68:71], v[64:67], v[160:163]
ds_read_b128 v[88:91], v3 offset:4096
v_mfma_f32_16x16x32_bf16 v[196:199], v[72:75], v[64:67], v[196:199]
ds_read_b128 v[92:95], v3 offset:6144
v_mfma_f32_16x16x32_bf16 v[192:195], v[72:75], v[60:63], v[192:195]
ds_read_b128 v[96:99], v3 offset:8192
v_mfma_f32_16x16x32_bf16 v[188:191], v[72:75], v[56:59], v[188:191]
ds_read_b128 v[100:103], v3 offset:10240
v_mfma_f32_16x16x32_bf16 v[184:187], v[72:75], v[52:55], v[184:187]
ds_read_b128 v[104:107], v3 offset:12288
v_mfma_f32_16x16x32_bf16 v[180:183], v[72:75], v[48:51], v[180:183]
ds_read_b128 v[108:111], v3 offset:14336
v_mfma_f32_16x16x32_bf16 v[176:179], v[72:75], v[44:47], v[176:179]
ds_read_b128 v[112:115], v3 offset:16384
v_mfma_f32_16x16x32_bf16 v[172:175], v[72:75], v[40:43], v[172:175]
v_mfma_f32_16x16x32_bf16 v[168:171], v[72:75], v[36:39], v[168:171]
v_mfma_f32_16x16x32_bf16 v[164:167], v[72:75], v[32:35], v[164:167]
v_mfma_f32_16x16x32_bf16 v[200:203], v[76:79], v[32:35], v[200:203]
v_mfma_f32_16x16x32_bf16 v[204:207], v[76:79], v[36:39], v[204:207]
v_mfma_f32_16x16x32_bf16 v[208:211], v[76:79], v[40:43], v[208:211]
v_mfma_f32_16x16x32_bf16 v[212:215], v[76:79], v[44:47], v[212:215]
v_mfma_f32_16x16x32_bf16 v[216:219], v[76:79], v[48:51], v[216:219]
v_mfma_f32_16x16x32_bf16 v[220:223], v[76:79], v[52:55], v[220:223]
v_mfma_f32_16x16x32_bf16 v[224:227], v[76:79], v[56:59], v[224:227]
v_mfma_f32_16x16x32_bf16 v[228:231], v[76:79], v[60:63], v[228:231]
v_mfma_f32_16x16x32_bf16 v[232:235], v[76:79], v[64:67], v[232:235]
s_waitcnt lgkmcnt(0)
s_barrier
v_mfma_f32_16x16x32_bf16 v[128:131], v[116:119], v[80:83], v[128:131]
s_branch Lov_2
.p2align 12
.fill 16, 4, 0xbf800000
Lst_2_0:
s_branch Lwr_162
s_nop 0
s_nop 0
Lov_2:
ds_read_b128 v[32:35], v2 offset:43008
v_mfma_f32_16x16x32_bf16 v[132:135], v[116:119], v[84:87], v[132:135]
ds_read_b64_tr_b16 v[72:73], v7 offset:8192
v_mfma_f32_16x16x32_bf16 v[136:139], v[116:119], v[88:91], v[136:139]
ds_read_b64_tr_b16 v[74:75], v7 offset:8704
v_mfma_f32_16x16x32_bf16 v[140:143], v[116:119], v[92:95], v[140:143]
ds_read_b64_tr_b16 v[76:77], v7 offset:16384
v_mfma_f32_16x16x32_bf16 v[144:147], v[116:119], v[96:99], v[144:147]
ds_read_b64_tr_b16 v[78:79], v7 offset:16896
v_mfma_f32_16x16x32_bf16 v[148:151], v[116:119], v[100:103], v[148:151]
ds_read_b64_tr_b16 v[68:69], v7 offset:0
v_mfma_f32_16x16x32_bf16 v[152:155], v[116:119], v[104:107], v[152:155]
ds_read_b64_tr_b16 v[70:71], v7 offset:512
v_mfma_f32_16x16x32_bf16 v[156:159], v[116:119], v[108:111], v[156:159]
ds_read_b128 v[36:39], v2 offset:45056
v_mfma_f32_16x16x32_bf16 v[160:163], v[116:119], v[112:115], v[160:163]
ds_read_b128 v[40:43], v2 offset:47104
v_mfma_f32_16x16x32_bf16 v[196:199], v[120:123], v[112:115], v[196:199]
ds_read_b128 v[44:47], v2 offset:49152
v_mfma_f32_16x16x32_bf16 v[192:195], v[120:123], v[108:111], v[192:195]
ds_read_b128 v[48:51], v2 offset:51200
v_mfma_f32_16x16x32_bf16 v[188:191], v[120:123], v[104:107], v[188:191]
ds_read_b128 v[52:55], v2 offset:53248
v_mfma_f32_16x16x32_bf16 v[184:187], v[120:123], v[100:103], v[184:187]
ds_read_b128 v[56:59], v2 offset:55296
v_mfma_f32_16x16x32_bf16 v[180:183], v[120:123], v[96:99], v[180:183]
ds_read_b128 v[60:63], v2 offset:57344
v_mfma_f32_16x16x32_bf16 v[176:179], v[120:123], v[92:95], v[176:179]
ds_read_b128 v[64:67], v2 offset:59392
v_mfma_f32_16x16x32_bf16 v[172:175], v[120:123], v[88:91], v[172:175]
v_mfma_f32_16x16x32_bf16 v[168:171], v[120:123], v[84:87], v[168:171]
v_mfma_f32_16x16x32_bf16 v[164:167], v[120:123], v[80:83], v[164:167]
v_mfma_f32_16x16x32_bf16 v[200:203], v[124:127], v[80:83], v[200:203]
v_mfma_f32_16x16x32_bf16 v[204:207], v[124:127], v[84:87], v[204:207]
v_mfma_f32_16x16x32_bf16 v[208:211], v[124:127], v[88:91], v[208:211]
v_mfma_f32_16x16x32_bf16 v[212:215], v[124:127], v[92:95], v[212:215]
v_mfma_f32_16x16x32_bf16 v[216:219], v[124:127], v[96:99], v[216:219]
v_mfma_f32_16x16x32_bf16 v[220:223], v[124:127], v[100:103], v[220:223]
v_mfma_f32_16x16x32_bf16 v[224:227], v[124:127], v[104:107], v[224:227]
v_mfma_f32_16x16x32_bf16 v[228:231], v[124:127], v[108:111], v[228:231]
v_mfma_f32_16x16x32_bf16 v[232:235], v[124:127], v[112:115], v[232:235]
s_waitcnt lgkmcnt(0)
v_mfma_f32_16x16x32_bf16 v[128:131], v[68:71], v[32:35], v[128:131]
ds_read_b128 v[80:83], v3 offset:43008
v_mfma_f32_16x16x32_bf16 v[132:135], v[68:71], v[36:39], v[132:135]
ds_read_b64_tr_b16 v[120:121], v7 offset:12288
v_mfma_f32_16x16x32_bf16 v[136:139], v[68:71], v[40:43], v[136:139]
ds_read_b64_tr_b16 v[122:123], v7 offset:12800
v_mfma_f32_16x16x32_bf16 v[140:143], v[68:71], v[44:47], v[140:143]
ds_read_b64_tr_b16 v[124:125], v7 offset:20480
v_mfma_f32_16x16x32_bf16 v[144:147], v[68:71], v[48:51], v[144:147]
ds_read_b64_tr_b16 v[126:127], v7 offset:20992
v_mfma_f32_16x16x32_bf16 v[148:151], v[68:71], v[52:55], v[148:151]
ds_read_b64_tr_b16 v[116:117], v7 offset:4096
v_mfma_f32_16x16x32_bf16 v[152:155], v[68:71], v[56:59], v[152:155]
ds_read_b64_tr_b16 v[118:119], v7 offset:4608
v_mfma_f32_16x16x32_bf16 v[156:159], v[68:71], v[60:63], v[156:159]
ds_read_b128 v[84:87], v3 offset:45056
v_mfma_f32_16x16x32_bf16 v[160:163], v[68:71], v[64:67], v[160:163]
ds_read_b128 v[88:91], v3 offset:47104
v_mfma_f32_16x16x32_bf16 v[196:199], v[72:75], v[64:67], v[196:199]
ds_read_b128 v[92:95], v3 offset:49152
v_mfma_f32_16x16x32_bf16 v[192:195], v[72:75], v[60:63], v[192:195]
ds_read_b128 v[96:99], v3 offset:51200
v_mfma_f32_16x16x32_bf16 v[188:191], v[72:75], v[56:59], v[188:191]
ds_read_b128 v[100:103], v3 offset:53248
v_mfma_f32_16x16x32_bf16 v[184:187], v[72:75], v[52:55], v[184:187]
ds_read_b128 v[104:107], v3 offset:55296
v_mfma_f32_16x16x32_bf16 v[180:183], v[72:75], v[48:51], v[180:183]
ds_read_b128 v[108:111], v3 offset:57344
v_mfma_f32_16x16x32_bf16 v[176:179], v[72:75], v[44:47], v[176:179]
ds_read_b128 v[112:115], v3 offset:59392
v_mfma_f32_16x16x32_bf16 v[172:175], v[72:75], v[40:43], v[172:175]
v_mfma_f32_16x16x32_bf16 v[168:171], v[72:75], v[36:39], v[168:171]
v_mfma_f32_16x16x32_bf16 v[164:167], v[72:75], v[32:35], v[164:167]
v_mfma_f32_16x16x32_bf16 v[200:203], v[76:79], v[32:35], v[200:203]
v_mfma_f32_16x16x32_bf16 v[204:207], v[76:79], v[36:39], v[204:207]
v_mfma_f32_16x16x32_bf16 v[208:211], v[76:79], v[40:43], v[208:211]
v_mfma_f32_16x16x32_bf16 v[212:215], v[76:79], v[44:47], v[212:215]
v_mfma_f32_16x16x32_bf16 v[216:219], v[76:79], v[48:51], v[216:219]
v_mfma_f32_16x16x32_bf16 v[220:223], v[76:79], v[52:55], v[220:223]
v_mfma_f32_16x16x32_bf16 v[224:227], v[76:79], v[56:59], v[224:227]
v_mfma_f32_16x16x32_bf16 v[228:231], v[76:79], v[60:63], v[228:231]
v_mfma_f32_16x16x32_bf16 v[232:235], v[76:79], v[64:67], v[232:235]
s_waitcnt lgkmcnt(0)
s_barrier
v_mfma_f32_16x16x32_bf16 v[128:131], v[116:119], v[80:83], v[128:131]
ds_read_b128 v[32:35], v4 offset:0
v_mfma_f32_16x16x32_bf16 v[132:135], v[116:119], v[84:87], v[132:135]
ds_read_b64_tr_b16 v[72:73], v8 offset:8192
v_mfma_f32_16x16x32_bf16 v[136:139], v[116:119], v[88:91], v[136:139]
ds_read_b64_tr_b16 v[74:75], v8 offset:8704
v_mfma_f32_16x16x32_bf16 v[140:143], v[116:119], v[92:95], v[140:143]
ds_read_b64_tr_b16 v[76:77], v8 offset:16384
v_mfma_f32_16x16x32_bf16 v[144:147], v[116:119], v[96:99], v[144:147]
ds_read_b64_tr_b16 v[78:79], v8 offset:16896
v_mfma_f32_16x16x32_bf16 v[148:151], v[116:119], v[100:103], v[148:151]
ds_read_b64_tr_b16 v[68:69], v8 offset:0
v_mfma_f32_16x16x32_bf16 v[152:155], v[116:119], v[104:107], v[152:155]
ds_read_b64_tr_b16 v[70:71], v8 offset:512
v_mfma_f32_16x16x32_bf16 v[156:159], v[116:119], v[108:111], v[156:159]
ds_read_b128 v[36:39], v4 offset:2048
v_mfma_f32_16x16x32_bf16 v[160:163], v[116:119], v[112:115], v[160:163]
ds_read_b128 v[40:43], v4 offset:4096
v_mfma_f32_16x16x32_bf16 v[196:199], v[120:123], v[112:115], v[196:199]
ds_read_b128 v[44:47], v4 offset:6144
v_mfma_f32_16x16x32_bf16 v[192:195], v[120:123], v[108:111], v[192:195]
ds_read_b128 v[48:51], v4 offset:8192
v_mfma_f32_16x16x32_bf16 v[188:191], v[120:123], v[104:107], v[188:191]
ds_read_b128 v[52:55], v4 offset:10240
v_mfma_f32_16x16x32_bf16 v[184:187], v[120:123], v[100:103], v[184:187]
ds_read_b128 v[56:59], v4 offset:12288
v_mfma_f32_16x16x32_bf16 v[180:183], v[120:123], v[96:99], v[180:183]
ds_read_b128 v[60:63], v4 offset:14336
v_mfma_f32_16x16x32_bf16 v[176:179], v[120:123], v[92:95], v[176:179]
ds_read_b128 v[64:67], v4 offset:16384
v_mfma_f32_16x16x32_bf16 v[172:175], v[120:123], v[88:91], v[172:175]
v_mfma_f32_16x16x32_bf16 v[168:171], v[120:123], v[84:87], v[168:171]
v_mfma_f32_16x16x32_bf16 v[164:167], v[120:123], v[80:83], v[164:167]
v_mfma_f32_16x16x32_bf16 v[200:203], v[124:127], v[80:83], v[200:203]
v_mfma_f32_16x16x32_bf16 v[204:207], v[124:127], v[84:87], v[204:207]
v_mfma_f32_16x16x32_bf16 v[208:211], v[124:127], v[88:91], v[208:211]
v_mfma_f32_16x16x32_bf16 v[212:215], v[124:127], v[92:95], v[212:215]
v_mfma_f32_16x16x32_bf16 v[216:219], v[124:127], v[96:99], v[216:219]
v_mfma_f32_16x16x32_bf16 v[220:223], v[124:127], v[100:103], v[220:223]
v_mfma_f32_16x16x32_bf16 v[224:227], v[124:127], v[104:107], v[224:227]
v_mfma_f32_16x16x32_bf16 v[228:231], v[124:127], v[108:111], v[228:231]
v_mfma_f32_16x16x32_bf16 v[232:235], v[124:127], v[112:115], v[232:235]
s_waitcnt lgkmcnt(0)
v_mfma_f32_16x16x32_bf16 v[128:131], v[68:71], v[32:35], v[128:131]
ds_read_b128 v[80:83], v5 offset:0
v_mfma_f32_16x16x32_bf16 v[132:135], v[68:71], v[36:39], v[132:135]
ds_read_b64_tr_b16 v[120:121], v8 offset:12288
v_mfma_f32_16x16x32_bf16 v[136:139], v[68:71], v[40:43], v[136:139]
ds_read_b64_tr_b16 v[122:123], v8 offset:12800
v_mfma_f32_16x16x32_bf16 v[140:143], v[68:71], v[44:47], v[140:143]
ds_read_b64_tr_b16 v[124:125], v8 offset:20480
v_mfma_f32_16x16x32_bf16 v[144:147], v[68:71], v[48:51], v[144:147]
ds_read_b64_tr_b16 v[126:127], v8 offset:20992
v_mfma_f32_16x16x32_bf16 v[148:151], v[68:71], v[52:55], v[148:151]
ds_read_b64_tr_b16 v[116:117], v8 offset:4096
v_mfma_f32_16x16x32_bf16 v[152:155], v[68:71], v[56:59], v[152:155]
ds_read_b64_tr_b16 v[118:119], v8 offset:4608
v_mfma_f32_16x16x32_bf16 v[156:159], v[68:71], v[60:63], v[156:159]
ds_read_b128 v[84:87], v5 offset:2048
v_mfma_f32_16x16x32_bf16 v[160:163], v[68:71], v[64:67], v[160:163]
ds_read_b128 v[88:91], v5 offset:4096
v_mfma_f32_16x16x32_bf16 v[196:199], v[72:75], v[64:67], v[196:199]
ds_read_b128 v[92:95], v5 offset:6144
v_mfma_f32_16x16x32_bf16 v[192:195], v[72:75], v[60:63], v[192:195]
ds_read_b128 v[96:99], v5 offset:8192
v_mfma_f32_16x16x32_bf16 v[188:191], v[72:75], v[56:59], v[188:191]
ds_read_b128 v[100:103], v5 offset:10240
v_mfma_f32_16x16x32_bf16 v[184:187], v[72:75], v[52:55], v[184:187]
ds_read_b128 v[104:107], v5 offset:12288
v_mfma_f32_16x16x32_bf16 v[180:183], v[72:75], v[48:51], v[180:183]
ds_read_b128 v[108:111], v5 offset:14336
v_mfma_f32_16x16x32_bf16 v[176:179], v[72:75], v[44:47], v[176:179]
ds_read_b128 v[112:115], v5 offset:16384
v_mfma_f32_16x16x32_bf16 v[172:175], v[72:75], v[40:43], v[172:175]
v_mfma_f32_16x16x32_bf16 v[168:171], v[72:75], v[36:39], v[168:171]
v_mfma_f32_16x16x32_bf16 v[164:167], v[72:75], v[32:35], v[164:167]
v_mfma_f32_16x16x32_bf16 v[200:203], v[76:79], v[32:35], v[200:203]
v_mfma_f32_16x16x32_bf16 v[204:207], v[76:79], v[36:39], v[204:207]
v_mfma_f32_16x16x32_bf16 v[208:211], v[76:79], v[40:43], v[208:211]
v_mfma_f32_16x16x32_bf16 v[212:215], v[76:79], v[44:47], v[212:215]
v_mfma_f32_16x16x32_bf16 v[216:219], v[76:79], v[48:51], v[216:219]
v_mfma_f32_16x16x32_bf16 v[220:223], v[76:79], v[52:55], v[220:223]
v_mfma_f32_16x16x32_bf16 v[224:227], v[76:79], v[56:59], v[224:227]
v_mfma_f32_16x16x32_bf16 v[228:231], v[76:79], v[60:63], v[228:231]
v_mfma_f32_16x16x32_bf16 v[232:235], v[76:79], v[64:67], v[232:235]
s_waitcnt lgkmcnt(0)
s_barrier
v_mfma_f32_16x16x32_bf16 v[128:131], v[116:119], v[80:83], v[128:131]
ds_read_b128 v[32:35], v2 offset:0
v_mfma_f32_16x16x32_bf16 v[132:135], v[116:119], v[84:87], v[132:135]
ds_read_b64_tr_b16 v[72:73], v6 offset:8192
v_mfma_f32_16x16x32_bf16 v[136:139], v[116:119], v[88:91], v[136:139]
ds_read_b64_tr_b16 v[74:75], v6 offset:8704
v_mfma_f32_16x16x32_bf16 v[140:143], v[116:119], v[92:95], v[140:143]
ds_read_b64_tr_b16 v[76:77], v6 offset:16384
v_mfma_f32_16x16x32_bf16 v[144:147], v[116:119], v[96:99], v[144:147]
ds_read_b64_tr_b16 v[78:79], v6 offset:16896
v_mfma_f32_16x16x32_bf16 v[148:151], v[116:119], v[100:103], v[148:151]
ds_read_b64_tr_b16 v[68:69], v6 offset:0
v_mfma_f32_16x16x32_bf16 v[152:155], v[116:119], v[104:107], v[152:155]
ds_read_b64_tr_b16 v[70:71], v6 offset:512
v_mfma_f32_16x16x32_bf16 v[156:159], v[116:119], v[108:111], v[156:159]
ds_read_b128 v[36:39], v2 offset:2048
v_mfma_f32_16x16x32_bf16 v[160:163], v[116:119], v[112:115], v[160:163]
ds_read_b128 v[40:43], v2 offset:4096
v_mfma_f32_16x16x32_bf16 v[196:199], v[120:123], v[112:115], v[196:199]
ds_read_b128 v[44:47], v2 offset:6144
v_mfma_f32_16x16x32_bf16 v[192:195], v[120:123], v[108:111], v[192:195]
ds_read_b128 v[48:51], v2 offset:8192
v_mfma_f32_16x16x32_bf16 v[188:191], v[120:123], v[104:107], v[188:191]
ds_read_b128 v[52:55], v2 offset:10240
v_mfma_f32_16x16x32_bf16 v[184:187], v[120:123], v[100:103], v[184:187]
ds_read_b128 v[56:59], v2 offset:12288
v_mfma_f32_16x16x32_bf16 v[180:183], v[120:123], v[96:99], v[180:183]
ds_read_b128 v[60:63], v2 offset:14336
v_mfma_f32_16x16x32_bf16 v[176:179], v[120:123], v[92:95], v[176:179]
ds_read_b128 v[64:67], v2 offset:16384
v_mfma_f32_16x16x32_bf16 v[172:175], v[120:123], v[88:91], v[172:175]
v_mfma_f32_16x16x32_bf16 v[168:171], v[120:123], v[84:87], v[168:171]
v_mfma_f32_16x16x32_bf16 v[164:167], v[120:123], v[80:83], v[164:167]
v_mfma_f32_16x16x32_bf16 v[200:203], v[124:127], v[80:83], v[200:203]
v_mfma_f32_16x16x32_bf16 v[204:207], v[124:127], v[84:87], v[204:207]
v_mfma_f32_16x16x32_bf16 v[208:211], v[124:127], v[88:91], v[208:211]
v_mfma_f32_16x16x32_bf16 v[212:215], v[124:127], v[92:95], v[212:215]
v_mfma_f32_16x16x32_bf16 v[216:219], v[124:127], v[96:99], v[216:219]
v_mfma_f32_16x16x32_bf16 v[220:223], v[124:127], v[100:103], v[220:223]
v_mfma_f32_16x16x32_bf16 v[224:227], v[124:127], v[104:107], v[224:227]
v_mfma_f32_16x16x32_bf16 v[228:231], v[124:127], v[108:111], v[228:231]
v_mfma_f32_16x16x32_bf16 v[232:235], v[124:127], v[112:115], v[232:235]
s_sub_u32 s41, s41, 1
s_cmp_lg_u32 s41, 0
s_cbranch_scc1 Lcl_31
s_waitcnt lgkmcnt(0)
v_mfma_f32_16x16x32_bf16 v[128:131], v[68:71], v[32:35], v[128:131]
ds_read_b128 v[80:83], v3 offset:0
v_mfma_f32_16x16x32_bf16 v[132:135], v[68:71], v[36:39], v[132:135]
ds_read_b64_tr_b16 v[120:121], v6 offset:12288
v_mfma_f32_16x16x32_bf16 v[136:139], v[68:71], v[40:43], v[136:139]
ds_read_b64_tr_b16 v[122:123], v6 offset:12800
v_mfma_f32_16x16x32_bf16 v[140:143], v[68:71], v[44:47], v[140:143]
ds_read_b64_tr_b16 v[124:125], v6 offset:20480
v_mfma_f32_16x16x32_bf16 v[144:147], v[68:71], v[48:51], v[144:147]
ds_read_b64_tr_b16 v[126:127], v6 offset:20992
v_mfma_f32_16x16x32_bf16 v[148:151], v[68:71], v[52:55], v[148:151]
ds_read_b64_tr_b16 v[116:117], v6 offset:4096
v_mfma_f32_16x16x32_bf16 v[152:155], v[68:71], v[56:59], v[152:155]
ds_read_b64_tr_b16 v[118:119], v6 offset:4608
v_mfma_f32_16x16x32_bf16 v[156:159], v[68:71], v[60:63], v[156:159]
ds_read_b128 v[84:87], v3 offset:2048
v_mfma_f32_16x16x32_bf16 v[160:163], v[68:71], v[64:67], v[160:163]
ds_read_b128 v[88:91], v3 offset:4096
v_mfma_f32_16x16x32_bf16 v[196:199], v[72:75], v[64:67], v[196:199]
ds_read_b128 v[92:95], v3 offset:6144
v_mfma_f32_16x16x32_bf16 v[192:195], v[72:75], v[60:63], v[192:195]
ds_read_b128 v[96:99], v3 offset:8192
v_mfma_f32_16x16x32_bf16 v[188:191], v[72:75], v[56:59], v[188:191]
ds_read_b128 v[100:103], v3 offset:10240
v_mfma_f32_16x16x32_bf16 v[184:187], v[72:75], v[52:55], v[184:187]
ds_read_b128 v[104:107], v3 offset:12288
v_mfma_f32_16x16x32_bf16 v[180:183], v[72:75], v[48:51], v[180:183]
ds_read_b128 v[108:111], v3 offset:14336
v_mfma_f32_16x16x32_bf16 v[176:179], v[72:75], v[44:47], v[176:179]
ds_read_b128 v[112:115], v3 offset:16384
v_mfma_f32_16x16x32_bf16 v[172:175], v[72:75], v[40:43], v[172:175]
v_mfma_f32_16x16x32_bf16 v[168:171], v[72:75], v[36:39], v[168:171]
v_mfma_f32_16x16x32_bf16 v[164:167], v[72:75], v[32:35], v[164:167]
v_mfma_f32_16x16x32_bf16 v[200:203], v[76:79], v[32:35], v[200:203]
v_mfma_f32_16x16x32_bf16 v[204:207], v[76:79], v[36:39], v[204:207]
v_mfma_f32_16x16x32_bf16 v[208:211], v[76:79], v[40:43], v[208:211]
v_mfma_f32_16x16x32_bf16 v[212:215], v[76:79], v[44:47], v[212:215]
v_mfma_f32_16x16x32_bf16 v[216:219], v[76:79], v[48:51], v[216:219]
v_mfma_f32_16x16x32_bf16 v[220:223], v[76:79], v[52:55], v[220:223]
v_mfma_f32_16x16x32_bf16 v[224:227], v[76:79], v[56:59], v[224:227]
v_mfma_f32_16x16x32_bf16 v[228:231], v[76:79], v[60:63], v[228:231]
v_mfma_f32_16x16x32_bf16 v[232:235], v[76:79], v[64:67], v[232:235]
s_waitcnt lgkmcnt(0)
v_mfma_f32_16x16x32_bf16 v[128:131], v[116:119], v[80:83], v[128:131]
v_mfma_f32_16x16x32_bf16 v[132:135], v[116:119], v[84:87], v[132:135]
v_mfma_f32_16x16x32_bf16 v[136:139], v[116:119], v[88:91], v[136:139]
v_mfma_f32_16x16x32_bf16 v[140:143], v[116:119], v[92:95], v[140:143]
v_mfma_f32_16x16x32_bf16 v[144:147], v[116:119], v[96:99], v[144:147]
v_mfma_f32_16x16x32_bf16 v[148:151], v[116:119], v[100:103], v[148:151]
v_mfma_f32_16x16x32_bf16 v[152:155], v[116:119], v[104:107], v[152:155]
v_mfma_f32_16x16x32_bf16 v[156:159], v[116:119], v[108:111], v[156:159]
v_mfma_f32_16x16x32_bf16 v[160:163], v[116:119], v[112:115], v[160:163]
v_mfma_f32_16x16x32_bf16 v[196:199], v[120:123], v[112:115], v[196:199]
v_mfma_f32_16x16x32_bf16 v[192:195], v[120:123], v[108:111], v[192:195]
v_mfma_f32_16x16x32_bf16 v[188:191], v[120:123], v[104:107], v[188:191]
v_mfma_f32_16x16x32_bf16 v[184:187], v[120:123], v[100:103], v[184:187]
v_mfma_f32_16x16x32_bf16 v[180:183], v[120:123], v[96:99], v[180:183]
v_mfma_f32_16x16x32_bf16 v[176:179], v[120:123], v[92:95], v[176:179]
v_mfma_f32_16x16x32_bf16 v[172:175], v[120:123], v[88:91], v[172:175]
v_mfma_f32_16x16x32_bf16 v[168:171], v[120:123], v[84:87], v[168:171]
v_mfma_f32_16x16x32_bf16 v[164:167], v[120:123], v[80:83], v[164:167]
v_mfma_f32_16x16x32_bf16 v[200:203], v[124:127], v[80:83], v[200:203]
v_mfma_f32_16x16x32_bf16 v[204:207], v[124:127], v[84:87], v[204:207]
v_mfma_f32_16x16x32_bf16 v[208:211], v[124:127], v[88:91], v[208:211]
v_mfma_f32_16x16x32_bf16 v[212:215], v[124:127], v[92:95], v[212:215]
v_mfma_f32_16x16x32_bf16 v[216:219], v[124:127], v[96:99], v[216:219]
v_mfma_f32_16x16x32_bf16 v[220:223], v[124:127], v[100:103], v[220:223]
v_mfma_f32_16x16x32_bf16 v[224:227], v[124:127], v[104:107], v[224:227]
v_mfma_f32_16x16x32_bf16 v[228:231], v[124:127], v[108:111], v[228:231]
v_mfma_f32_16x16x32_bf16 v[232:235], v[124:127], v[112:115], v[232:235]
Lepi:
v_lshlrev_b32 v14, 3, v12
v_add_u32 v14, 147456, v14
v_mul_u32_u24 v15, 400, v12
v_lshl_add_u32 v15, v13, 3, v15
s_lshl_b32 s43, s36, 5
v_add_u32 v15, s43, v15
s_barrier
ds_read_b64 v[32:33], v14 offset:0
ds_read_b64 v[34:35], v14 offset:128
ds_read_b64 v[36:37], v14 offset:256
ds_read_b64 v[38:39], v14 offset:384
ds_read_b64 v[40:41], v14 offset:512
ds_read_b64 v[42:43], v14 offset:640
ds_read_b64 v[44:45], v14 offset:768
ds_read_b64 v[46:47], v14 offset:896
ds_read_b64 v[48:49], v14 offset:1024
v_mov_b32_dpp v52, v128 row_newbcast:0 row_mask:0xf bank_mask:0xf
v_mov_b32_dpp v53, v129 row_newbcast:0 row_mask:0xf bank_mask:0xf
v_mov_b32_dpp v54, v130 row_newbcast:0 row_mask:0xf bank_mask:0xf
v_mov_b32_dpp v55, v131 row_newbcast:0 row_mask:0xf bank_mask:0xf
v_mov_b32_dpp v56, v164 row_newbcast:0 row_mask:0xf bank_mask:0xf
v_mov_b32_dpp v57, v165 row_newbcast:0 row_mask:0xf bank_mask:0xf
v_mov_b32_dpp v58, v166 row_newbcast:0 row_mask:0xf bank_mask:0xf
v_mov_b32_dpp v59, v167 row_newbcast:0 row_mask:0xf bank_mask:0xf
v_mov_b32_dpp v60, v200 row_newbcast:0 row_mask:0xf bank_mask:0xf
v_mov_b32_dpp v61, v201 row_newbcast:0 row_mask:0xf bank_mask:0xf
v_mov_b32_dpp v62, v202 row_newbcast:0 row_mask:0xf bank_mask:0xf
v_mov_b32_dpp v63, v203 row_newbcast:0 row_mask:0xf bank_mask:0xf
s_waitcnt lgkmcnt(0)
v_pk_fma_f32 v[164:165], v[32:33], v[56:57], v[164:165] op_sel_hi:[0,1,1] neg_lo:[1,0,0] neg_hi:[1,0,0]
v_pk_fma_f32 v[166:167], v[32:33], v[58:59], v[166:167] op_sel_hi:[0,1,1] neg_lo:[1,0,0] neg_hi:[1,0,0]
v_pk_fma_f32 v[200:201], v[32:33], v[60:61], v[200:201] op_sel_hi:[0,1,1] neg_lo:[1,0,0] neg_hi:[1,0,0]
v_pk_fma_f32 v[202:203], v[32:33], v[62:63], v[202:203] op_sel_hi:[0,1,1] neg_lo:[1,0,0] neg_hi:[1,0,0]
v_pk_mul_f32 v[164:165], v[32:33], v[164:165] op_sel:[1,0] op_sel_hi:[1,1]
v_pk_mul_f32 v[166:167], v[32:33], v[166:167] op_sel:[1,0] op_sel_hi:[1,1]
v_pk_fma_f32 v[132:133], v[34:35], v[52:53], v[132:133] op_sel_hi:[0,1,1] neg_lo:[1,0,0] neg_hi:[1,0,0]
v_pk_fma_f32 v[134:135], v[34:35], v[54:55], v[134:135] op_sel_hi:[0,1,1] neg_lo:[1,0,0] neg_hi:[1,0,0]
v_pk_mul_f32 v[200:201], v[32:33], v[200:201] op_sel:[1,0] op_sel_hi:[1,1]
v_pk_mul_f32 v[202:203], v[32:33], v[202:203] op_sel:[1,0] op_sel_hi:[1,1]
v_cvt_pk_bf16_f32 v164, v164, v165
v_cvt_pk_bf16_f32 v165, v166, v167
ds_write_b64 v15, v[164:165] offset:128
v_pk_fma_f32 v[168:169], v[34:35], v[56:57], v[168:169] op_sel_hi:[0,1,1] neg_lo:[1,0,0] neg_hi:[1,0,0]
v_pk_fma_f32 v[170:171], v[34:35], v[58:59], v[170:171] op_sel_hi:[0,1,1] neg_lo:[1,0,0] neg_hi:[1,0,0]
v_pk_mul_f32 v[132:133], v[34:35], v[132:133] op_sel:[1,0] op_sel_hi:[1,1]
v_pk_mul_f32 v[134:135], v[34:35], v[134:135] op_sel:[1,0] op_sel_hi:[1,1]
v_cvt_pk_bf16_f32 v200, v200, v201
v_cvt_pk_bf16_f32 v201, v202, v203
ds_write_b64 v15, v[200:201] offset:256
v_pk_fma_f32 v[204:205], v[34:35], v[60:61], v[204:205] op_sel_hi:[0,1,1] neg_lo:[1,0,0] neg_hi:[1,0,0]
v_pk_fma_f32 v[206:207], v[34:35], v[62:63], v[206:207] op_sel_hi:[0,1,1] neg_lo:[1,0,0] neg_hi:[1,0,0]
v_pk_mul_f32 v[168:169], v[34:35], v[168:169] op_sel:[1,0] op_sel_hi:[1,1]
v_pk_mul_f32 v[170:171], v[34:35], v[170:171] op_sel:[1,0] op_sel_hi:[1,1]
v_cvt_pk_bf16_f32 v132, v132, v133
v_cvt_pk_bf16_f32 v133, v134, v135
ds_write_b64 v15, v[132:133] offset:6400
v_pk_fma_f32 v[136:137], v[36:37], v[52:53], v[136:137] op_sel_hi:[0,1,1] neg_lo:[1,0,0] neg_hi:[1,0,0]
v_pk_fma_f32 v[138:139], v[36:37], v[54:55], v[138:139] op_sel_hi:[0,1,1] neg_lo:[1,0,0] neg_hi:[1,0,0]
v_pk_mul_f32 v[204:205], v[34:35], v[204:205] op_sel:[1,0] op_sel_hi:[1,1]
v_pk_mul_f32 v[206:207], v[34:35], v[206:207] op_sel:[1,0] op_sel_hi:[1,1]
v_cvt_pk_bf16_f32 v168, v168, v169
v_cvt_pk_bf16_f32 v169, v170, v171
ds_write_b64 v15, v[168:169] offset:6528
v_pk_fma_f32 v[172:173], v[36:37], v[56:57], v[172:173] op_sel_hi:[0,1,1] neg_lo:[1,0,0] neg_hi:[1,0,0]
v_pk_fma_f32 v[174:175], v[36:37], v[58:59], v[174:175] op_sel_hi:[0,1,1] neg_lo:[1,0,0] neg_hi:[1,0,0]
v_pk_mul_f32 v[136:137], v[36:37], v[136:137] op_sel:[1,0] op_sel_hi:[1,1]
v_pk_mul_f32 v[138:139], v[36:37], v[138:139] op_sel:[1,0] op_sel_hi:[1,1]
v_cvt_pk_bf16_f32 v204, v204, v205
v_cvt_pk_bf16_f32 v205, v206, v207
ds_write_b64 v15, v[204:205] offset:6656
v_pk_fma_f32 v[208:209], v[36:37], v[60:61], v[208:209] op_sel_hi:[0,1,1] neg_lo:[1,0,0] neg_hi:[1,0,0]
v_pk_fma_f32 v[210:211], v[36:37], v[62:63], v[210:211] op_sel_hi:[0,1,1] neg_lo:[1,0,0] neg_hi:[1,0,0]
v_pk_mul_f32 v[172:173], v[36:37], v[172:173] op_sel:[1,0] op_sel_hi:[1,1]
v_pk_mul_f32 v[174:175], v[36:37], v[174:175] op_sel:[1,0] op_sel_hi:[1,1]
v_cvt_pk_bf16_f32 v136, v136, v137
v_cvt_pk_bf16_f32 v137, v138, v139
ds_write_b64 v15, v[136:137] offset:12800
v_pk_fma_f32 v[140:141], v[38:39], v[52:53], v[140:141] op_sel_hi:[0,1,1] neg_lo:[1,0,0] neg_hi:[1,0,0]
v_pk_fma_f32 v[142:143], v[38:39], v[54:55], v[142:143] op_sel_hi:[0,1,1] neg_lo:[1,0,0] neg_hi:[1,0,0]
v_pk_mul_f32 v[208:209], v[36:37], v[208:209] op_sel:[1,0] op_sel_hi:[1,1]
v_pk_mul_f32 v[210:211], v[36:37], v[210:211] op_sel:[1,0] op_sel_hi:[1,1]
v_cvt_pk_bf16_f32 v172, v172, v173
v_cvt_pk_bf16_f32 v173, v174, v175
ds_write_b64 v15, v[172:173] offset:12928
v_pk_fma_f32 v[176:177], v[38:39], v[56:57], v[176:177] op_sel_hi:[0,1,1] neg_lo:[1,0,0] neg_hi:[1,0,0]
v_pk_fma_f32 v[178:179], v[38:39], v[58:59], v[178:179] op_sel_hi:[0,1,1] neg_lo:[1,0,0] neg_hi:[1,0,0]
v_pk_mul_f32 v[140:141], v[38:39], v[140:141] op_sel:[1,0] op_sel_hi:[1,1]
v_pk_mul_f32 v[142:143], v[38:39], v[142:143] op_sel:[1,0] op_sel_hi:[1,1]
v_cvt_pk_bf16_f32 v208, v208, v209
v_cvt_pk_bf16_f32 v209, v210, v211
ds_write_b64 v15, v[208:209] offset:13056
v_pk_fma_f32 v[212:213], v[38:39], v[60:61], v[212:213] op_sel_hi:[0,1,1] neg_lo:[1,0,0] neg_hi:[1,0,0]
v_pk_fma_f32 v[214:215], v[38:39], v[62:63], v[214:215] op_sel_hi:[0,1,1] neg_lo:[1,0,0] neg_hi:[1,0,0]
v_pk_mul_f32 v[176:177], v[38:39], v[176:177] op_sel:[1,0] op_sel_hi:[1,1]
v_pk_mul_f32 v[178:179], v[38:39], v[178:179] op_sel:[1,0] op_sel_hi:[1,1]
v_cvt_pk_bf16_f32 v140, v140, v141
v_cvt_pk_bf16_f32 v141, v142, v143
ds_write_b64 v15, v[140:141] offset:19200
v_pk_fma_f32 v[144:145], v[40:41], v[52:53], v[144:145] op_sel_hi:[0,1,1] neg_lo:[1,0,0] neg_hi:[1,0,0]
v_pk_fma_f32 v[146:147], v[40:41], v[54:55], v[146:147] op_sel_hi:[0,1,1] neg_lo:[1,0,0] neg_hi:[1,0,0]
v_pk_mul_f32 v[212:213], v[38:39], v[212:213] op_sel:[1,0] op_sel_hi:[1,1]
v_pk_mul_f32 v[214:215], v[38:39], v[214:215] op_sel:[1,0] op_sel_hi:[1,1]
v_cvt_pk_bf16_f32 v176, v176, v177
v_cvt_pk_bf16_f32 v177, v178, v179
ds_write_b64 v15, v[176:177] offset:19328
v_pk_fma_f32 v[180:181], v[40:41], v[56:57], v[180:181] op_sel_hi:[0,1,1] neg_lo:[1,0,0] neg_hi:[1,0,0]
v_pk_fma_f32 v[182:183], v[40:41], v[58:59], v[182:183] op_sel_hi:[0,1,1] neg_lo:[1,0,0] neg_hi:[1,0,0]
v_pk_mul_f32 v[144:145], v[40:41], v[144:145] op_sel:[1,0] op_sel_hi:[1,1]
v_pk_mul_f32 v[146:147], v[40:41], v[146:147] op_sel:[1,0] op_sel_hi:[1,1]
v_cvt_pk_bf16_f32 v212, v212, v213
v_cvt_pk_bf16_f32 v213, v214, v215
ds_write_b64 v15, v[212:213] offset:19456
v_pk_fma_f32 v[216:217], v[40:41], v[60:61], v[216:217] op_sel_hi:[0,1,1] neg_lo:[1,0,0] neg_hi:[1,0,0]
v_pk_fma_f32 v[218:219], v[40:41], v[62:63], v[218:219] op_sel_hi:[0,1,1] neg_lo:[1,0,0] neg_hi:[1,0,0]
v_pk_mul_f32 v[180:181], v[40:41], v[180:181] op_sel:[1,0] op_sel_hi:[1,1]
v_pk_mul_f32 v[182:183], v[40:41], v[182:183] op_sel:[1,0] op_sel_hi:[1,1]
v_cvt_pk_bf16_f32 v144, v144, v145
v_cvt_pk_bf16_f32 v145, v146, v147
ds_write_b64 v15, v[144:145] offset:25600
v_pk_fma_f32 v[148:149], v[42:43], v[52:53], v[148:149] op_sel_hi:[0,1,1] neg_lo:[1,0,0] neg_hi:[1,0,0]
v_pk_fma_f32 v[150:151], v[42:43], v[54:55], v[150:151] op_sel_hi:[0,1,1] neg_lo:[1,0,0] neg_hi:[1,0,0]
v_pk_mul_f32 v[216:217], v[40:41], v[216:217] op_sel:[1,0] op_sel_hi:[1,1]
v_pk_mul_f32 v[218:219], v[40:41], v[218:219] op_sel:[1,0] op_sel_hi:[1,1]
v_cvt_pk_bf16_f32 v180, v180, v181
v_cvt_pk_bf16_f32 v181, v182, v183
ds_write_b64 v15, v[180:181] offset:25728
v_pk_fma_f32 v[184:185], v[42:43], v[56:57], v[184:185] op_sel_hi:[0,1,1] neg_lo:[1,0,0] neg_hi:[1,0,0]
v_pk_fma_f32 v[186:187], v[42:43], v[58:59], v[186:187] op_sel_hi:[0,1,1] neg_lo:[1,0,0] neg_hi:[1,0,0]
v_pk_mul_f32 v[148:149], v[42:43], v[148:149] op_sel:[1,0] op_sel_hi:[1,1]
v_pk_mul_f32 v[150:151], v[42:43], v[150:151] op_sel:[1,0] op_sel_hi:[1,1]
v_cvt_pk_bf16_f32 v216, v216, v217
v_cvt_pk_bf16_f32 v217, v218, v219
ds_write_b64 v15, v[216:217] offset:25856
v_pk_fma_f32 v[220:221], v[42:43], v[60:61], v[220:221] op_sel_hi:[0,1,1] neg_lo:[1,0,0] neg_hi:[1,0,0]
v_pk_fma_f32 v[222:223], v[42:43], v[62:63], v[222:223] op_sel_hi:[0,1,1] neg_lo:[1,0,0] neg_hi:[1,0,0]
v_pk_mul_f32 v[184:185], v[42:43], v[184:185] op_sel:[1,0] op_sel_hi:[1,1]
v_pk_mul_f32 v[186:187], v[42:43], v[186:187] op_sel:[1,0] op_sel_hi:[1,1]
v_cvt_pk_bf16_f32 v148, v148, v149
v_cvt_pk_bf16_f32 v149, v150, v151
ds_write_b64 v15, v[148:149] offset:32000
v_pk_fma_f32 v[152:153], v[44:45], v[52:53], v[152:153] op_sel_hi:[0,1,1] neg_lo:[1,0,0] neg_hi:[1,0,0]
v_pk_fma_f32 v[154:155], v[44:45], v[54:55], v[154:155] op_sel_hi:[0,1,1] neg_lo:[1,0,0] neg_hi:[1,0,0]
v_pk_mul_f32 v[220:221], v[42:43], v[220:221] op_sel:[1,0] op_sel_hi:[1,1]
v_pk_mul_f32 v[222:223], v[42:43], v[222:223] op_sel:[1,0] op_sel_hi:[1,1]
v_cvt_pk_bf16_f32 v184, v184, v185
v_cvt_pk_bf16_f32 v185, v186, v187
ds_write_b64 v15, v[184:185] offset:32128
v_pk_fma_f32 v[188:189], v[44:45], v[56:57], v[188:189] op_sel_hi:[0,1,1] neg_lo:[1,0,0] neg_hi:[1,0,0]
v_pk_fma_f32 v[190:191], v[44:45], v[58:59], v[190:191] op_sel_hi:[0,1,1] neg_lo:[1,0,0] neg_hi:[1,0,0]
v_pk_mul_f32 v[152:153], v[44:45], v[152:153] op_sel:[1,0] op_sel_hi:[1,1]
v_pk_mul_f32 v[154:155], v[44:45], v[154:155] op_sel:[1,0] op_sel_hi:[1,1]
v_cvt_pk_bf16_f32 v220, v220, v221
v_cvt_pk_bf16_f32 v221, v222, v223
ds_write_b64 v15, v[220:221] offset:32256
v_pk_fma_f32 v[224:225], v[44:45], v[60:61], v[224:225] op_sel_hi:[0,1,1] neg_lo:[1,0,0] neg_hi:[1,0,0]
v_pk_fma_f32 v[226:227], v[44:45], v[62:63], v[226:227] op_sel_hi:[0,1,1] neg_lo:[1,0,0] neg_hi:[1,0,0]
v_pk_mul_f32 v[188:189], v[44:45], v[188:189] op_sel:[1,0] op_sel_hi:[1,1]
v_pk_mul_f32 v[190:191], v[44:45], v[190:191] op_sel:[1,0] op_sel_hi:[1,1]
v_cvt_pk_bf16_f32 v152, v152, v153
v_cvt_pk_bf16_f32 v153, v154, v155
ds_write_b64 v15, v[152:153] offset:38400
v_pk_fma_f32 v[156:157], v[46:47], v[52:53], v[156:157] op_sel_hi:[0,1,1] neg_lo:[1,0,0] neg_hi:[1,0,0]
v_pk_fma_f32 v[158:159], v[46:47], v[54:55], v[158:159] op_sel_hi:[0,1,1] neg_lo:[1,0,0] neg_hi:[1,0,0]
v_pk_mul_f32 v[224:225], v[44:45], v[224:225] op_sel:[1,0] op_sel_hi:[1,1]
v_pk_mul_f32 v[226:227], v[44:45], v[226:227] op_sel:[1,0] op_sel_hi:[1,1]
v_cvt_pk_bf16_f32 v188, v188, v189
v_cvt_pk_bf16_f32 v189, v190, v191
ds_write_b64 v15, v[188:189] offset:38528
v_pk_fma_f32 v[192:193], v[46:47], v[56:57], v[192:193] op_sel_hi:[0,1,1] neg_lo:[1,0,0] neg_hi:[1,0,0]
v_pk_fma_f32 v[194:195], v[46:47], v[58:59], v[194:195] op_sel_hi:[0,1,1] neg_lo:[1,0,0] neg_hi:[1,0,0]
v_pk_mul_f32 v[156:157], v[46:47], v[156:157] op_sel:[1,0] op_sel_hi:[1,1]
v_pk_mul_f32 v[158:159], v[46:47], v[158:159] op_sel:[1,0] op_sel_hi:[1,1]
v_cvt_pk_bf16_f32 v224, v224, v225
v_cvt_pk_bf16_f32 v225, v226, v227
ds_write_b64 v15, v[224:225] offset:38656
v_pk_fma_f32 v[228:229], v[46:47], v[60:61], v[228:229] op_sel_hi:[0,1,1] neg_lo:[1,0,0] neg_hi:[1,0,0]
v_pk_fma_f32 v[230:231], v[46:47], v[62:63], v[230:231] op_sel_hi:[0,1,1] neg_lo:[1,0,0] neg_hi:[1,0,0]
v_pk_mul_f32 v[192:193], v[46:47], v[192:193] op_sel:[1,0] op_sel_hi:[1,1]
v_pk_mul_f32 v[194:195], v[46:47], v[194:195] op_sel:[1,0] op_sel_hi:[1,1]
v_cvt_pk_bf16_f32 v156, v156, v157
v_cvt_pk_bf16_f32 v157, v158, v159
ds_write_b64 v15, v[156:157] offset:44800
v_pk_fma_f32 v[160:161], v[48:49], v[52:53], v[160:161] op_sel_hi:[0,1,1] neg_lo:[1,0,0] neg_hi:[1,0,0]
v_pk_fma_f32 v[162:163], v[48:49], v[54:55], v[162:163] op_sel_hi:[0,1,1] neg_lo:[1,0,0] neg_hi:[1,0,0]
v_pk_mul_f32 v[228:229], v[46:47], v[228:229] op_sel:[1,0] op_sel_hi:[1,1]
v_pk_mul_f32 v[230:231], v[46:47], v[230:231] op_sel:[1,0] op_sel_hi:[1,1]
v_cvt_pk_bf16_f32 v192, v192, v193
v_cvt_pk_bf16_f32 v193, v194, v195
ds_write_b64 v15, v[192:193] offset:44928
v_pk_fma_f32 v[196:197], v[48:49], v[56:57], v[196:197] op_sel_hi:[0,1,1] neg_lo:[1,0,0] neg_hi:[1,0,0]
v_pk_fma_f32 v[198:199], v[48:49], v[58:59], v[198:199] op_sel_hi:[0,1,1] neg_lo:[1,0,0] neg_hi:[1,0,0]
v_pk_mul_f32 v[160:161], v[48:49], v[160:161] op_sel:[1,0] op_sel_hi:[1,1]
v_pk_mul_f32 v[162:163], v[48:49], v[162:163] op_sel:[1,0] op_sel_hi:[1,1]
v_cvt_pk_bf16_f32 v228, v228, v229
v_cvt_pk_bf16_f32 v229, v230, v231
ds_write_b64 v15, v[228:229] offset:45056
v_pk_fma_f32 v[232:233], v[48:49], v[60:61], v[232:233] op_sel_hi:[0,1,1] neg_lo:[1,0,0] neg_hi:[1,0,0]
v_pk_fma_f32 v[234:235], v[48:49], v[62:63], v[234:235] op_sel_hi:[0,1,1] neg_lo:[1,0,0] neg_hi:[1,0,0]
v_pk_mul_f32 v[196:197], v[48:49], v[196:197] op_sel:[1,0] op_sel_hi:[1,1]
v_pk_mul_f32 v[198:199], v[48:49], v[198:199] op_sel:[1,0] op_sel_hi:[1,1]
v_cvt_pk_bf16_f32 v160, v160, v161
v_cvt_pk_bf16_f32 v161, v162, v163
ds_write_b64 v15, v[160:161] offset:51200
v_pk_mul_f32 v[232:233], v[48:49], v[232:233] op_sel:[1,0] op_sel_hi:[1,1]
v_pk_mul_f32 v[234:235], v[48:49], v[234:235] op_sel:[1,0] op_sel_hi:[1,1]
v_cvt_pk_bf16_f32 v196, v196, v197
v_cvt_pk_bf16_f32 v197, v198, v199
ds_write_b64 v15, v[196:197] offset:51328
v_cvt_pk_bf16_f32 v232, v232, v233
v_cvt_pk_bf16_f32 v233, v234, v235
ds_write_b64 v15, v[232:233] offset:51456
s_waitcnt lgkmcnt(0)
s_branch Latt_5
Lpf_4:
s_lshl_b32 s43, s35, 7
s_waitcnt lgkmcnt(0)
s_mov_b32 s8, s64
s_mov_b32 s9, s65
s_mov_b32 s10, 4194304
s_mov_b32 s11, 0x20000
s_add_u32 s12, s66, s43
s_addc_u32 s13, s67, 0
s_mov_b32 s14, 6289536
s_mov_b32 s15, 0x20000
s_add_u32 s84, s82, 28311552
s_addc_u32 s85, s83, 0
s_branch Lov_3
.p2align 12
.fill 16, 4, 0xbf800000
Lst_3_0:
s_branch Lwr_163
s_nop 0
s_nop 0
Lov_3:
s_mov_b32 s86, 114688
s_mov_b32 s87, 0x20000
s_mov_b32 s56, s80
s_mov_b32 s57, s81
s_mov_b32 s58, 256
s_mov_b32 s59, 0x20000
v_mov_b32 v5, 0
v_lshlrev_b32 v14, 7, v1
s_or_b32 s43, s34, s35
s_cmp_lg_u32 s43, 0
s_cbranch_scc1 Lz_32
s_movk_i32 s43, 0x2000
buffer_store_dword v5, v14, s[84:87], 0 offen sc1
s_bfm_b64 exec, 44, 0
buffer_store_dword v5, v14, s[84:87], s43 offen sc1
s_mov_b64 exec, 1
v_mov_b32 v6, 1
s_waitcnt vmcnt(0)
buffer_store_dword v6, v5, s[56:59], 0 offen sc1
s_mov_b64 exec, -1
Lz_32:
s_lshl_b32 s43, s51, 11
buffer_load_dwordx4 v[96:99], v10, s[8:11], s43 offen offset:0
buffer_load_dwordx4 v[100:103], v10, s[8:11], s43 offen offset:1024
buffer_load_dwordx4 v[104:107], v10, s[8:11], s43 offen offset:2048
buffer_load_dwordx4 v[108:111], v10, s[8:11], s43 offen offset:3072
v_min_u32 v14, 23, v1
v_lshrrev_b32 v15, 3, v14
v_mul_u32_u24 v15, 43008, v15
v_and_b32 v14, 7, v14
v_lshl_add_u32 v15, v14, 4, v15
v_mov_b32 v32, 0x3f803f80
v_mov_b32 v33, 0x3f803f80
v_mov_b32 v34, 0x3f803f80
v_mov_b32 v35, 0x3f803f80
ds_write_b128 v15, v[32:35]
s_add_u32 s20, s82, 26214400
s_addc_u32 s21, s83, 0
s_mov_b32 s22, 16384
s_mov_b32 s23, 0x20000
s_add_u32 s43, s2, 128
s_lshl_b32 s43, s43, 7
v_lshlrev_b32 v14, 2, v1
s_mov_b64 exec, 15
buffer_store_dword v5, v14, s[84:87], s43 offen sc1
s_mov_b64 exec, -1
s_lshl_b32 s43, s34, 4
s_add_u32 s43, s43, s35
s_lshl_b32 s43, s43, 8
s_add_u32 s43, s43, 49152
v_lshlrev_b32 v14, 7, v1
s_mov_b64 exec, 3
buffer_store_dword v5, v14, s[84:87], s43 offen sc1
s_mov_b64 exec, -1
s_lshl_b32 s52, s34, 7
s_add_u32 s52, s52, 28319744
s_sub_u32 s53, s52, 128
s_cmp_eq_u32 s34, 0
s_cselect_b32 s53, s52, s53
s_waitcnt lgkmcnt(0)
s_barrier
s_waitcnt vmcnt(2)
s_mov_b32 s43, 0x3f803f80
v_mov_b32 v116, 0
v_mov_b32 v117, 0
v_mov_b32 v118, 0
v_mov_b32 v119, 0
v_mov_b32 v120, 0
v_mov_b32 v121, 0
v_mov_b32 v122, 0
v_mov_b32 v123, 0
v_dot2_f32_bf16 v116, v96, s43, v116
v_dot2_f32_bf16 v120, v96, v96, v120
v_dot2_f32_bf16 v118, v104, s43, v118
v_dot2_f32_bf16 v122, v104, v104, v122
v_dot2_f32_bf16 v117, v97, s43, v117
v_dot2_f32_bf16 v121, v97, v97, v121
v_dot2_f32_bf16 v119, v105, s43, v119
v_dot2_f32_bf16 v123, v105, v105, v123
v_dot2_f32_bf16 v116, v98, s43, v116
v_dot2_f32_bf16 v120, v98, v98, v120
v_dot2_f32_bf16 v118, v106, s43, v118
v_dot2_f32_bf16 v122, v106, v106, v122
v_dot2_f32_bf16 v117, v99, s43, v117
v_dot2_f32_bf16 v121, v99, v99, v121
v_dot2_f32_bf16 v119, v107, s43, v119
v_dot2_f32_bf16 v123, v107, v107, v123
v_dot2_f32_bf16 v116, v100, s43, v116
v_dot2_f32_bf16 v120, v100, v100, v120
v_dot2_f32_bf16 v118, v108, s43, v118
v_dot2_f32_bf16 v122, v108, v108, v122
v_dot2_f32_bf16 v117, v101, s43, v117
v_dot2_f32_bf16 v121, v101, v101, v121
v_dot2_f32_bf16 v119, v109, s43, v119
v_dot2_f32_bf16 v123, v109, v109, v123
v_dot2_f32_bf16 v116, v102, s43, v116
v_dot2_f32_bf16 v120, v102, v102, v120
v_dot2_f32_bf16 v118, v110, s43, v118
v_dot2_f32_bf16 v122, v110, v110, v122
v_dot2_f32_bf16 v117, v103, s43, v117
v_dot2_f32_bf16 v121, v103, v103, v121
v_dot2_f32_bf16 v119, v111, s43, v119
v_dot2_f32_bf16 v123, v111, v111, v123
s_nop 2
v_add_f32 v116, v116, v117
v_add_f32 v118, v118, v119
v_add_f32 v120, v120, v121
v_add_f32 v122, v122, v123
s_nop 1
v_permlane32_swap_b32 v116, v118
v_permlane32_swap_b32 v120, v122
v_add_f32 v116, v116, v118
v_add_f32 v120, v120, v122
s_nop 1
v_permlane16_swap_b32 v116, v120
v_add_f32 v116, v116, v120
s_nop 1
v_add_f32_dpp v116, v116, v116 row_ror:8 row_mask:0xf bank_mask:0xf
s_nop 1
v_add_f32_dpp v116, v116, v116 row_ror:4 row_mask:0xf bank_mask:0xf
s_nop 1
v_add_f32_dpp v116, v116, v116 row_ror:2 row_mask:0xf bank_mask:0xf
s_nop 1
v_add_f32_dpp v116, v116, v116 row_ror:1 row_mask:0xf bank_mask:0xf
v_mov_b32 v117, v116
s_nop 1
v_permlane16_swap_b32 v116, v117
v_mul_f32 v112, 0x3a800000, v116
v_mul_f32 v113, 0x3a800000, v117
v_fma_f32 v113, -v112, v112, v113
v_max_f32 v113, 0, v113
v_add_f32 v113, 0x3727c5ac, v113
v_rsq_f32 v113, v113
v_lshrrev_b32 v11, 5, v1
s_lshl_b32 s43, s47, 4
s_add_u32 s43, s43, 148608
v_lshl_add_u32 v11, v11, 3, s43
ds_write_b64 v11, v[112:113]
s_waitcnt lgkmcnt(0)
s_mov_b32 s28, s66
s_mov_b32 s29, s67
s_mov_b32 s30, 6291456
s_mov_b32 s31, 0x20000
s_mul_i32 s43, s33, 8832
s_add_u32 s43, s43, 1572864
v_lshlrev_b32 v30, 7, v1
buffer_load_dword v31, v30, s[28:31], s43 offen
s_add_u32 s43, s43, 8192
s_bfm_b64 exec, 5, 0
buffer_load_dword v31, v30, s[28:31], s43 offen
s_mov_b64 exec, -1
s_branch Lst_0_0
Lwr_160:
s_barrier
v_lshlrev_b32 v5, 4, v1
v_and_b32 v5, 63, v5
v_add_u32 v6, 148608, v5
ds_read_b128 v[112:115], v6
s_lshl_b32 s43, s63, 3
v_add_u32 v5, s43, v5
s_waitcnt lgkmcnt(0)
s_mov_b64 exec, 15
buffer_store_dwordx4 v[112:115], v5, s[20:23], 0 offen sc1
s_mov_b64 exec, -1
v_mov_b32 v4, 0
buffer_load_dword v6, v4, s[56:59], 0 offen sc1
s_mov_b32 s62, 0
s_mov_b32 s28, s66
s_mov_b32 s29, s67
s_mov_b32 s30, 6291456
s_mov_b32 s31, 0x20000
s_mul_i32 s43, s33, 12288
s_add_u32 s43, s43, 3538944
v_lshlrev_b32 v30, 7, v1
buffer_load_dword v31, v30, s[28:31], s43 offen
s_add_u32 s43, s43, 8192
s_bfm_b64 exec, 32, 0
buffer_load_dword v31, v30, s[28:31], s43 offen
s_mov_b64 exec, -1
s_branch Lst_1_0
Lwr_161:
s_barrier
s_lshl_b32 s43, s35, 7
s_add_u32 s28, s68, s43
s_addc_u32 s29, s69, 0
s_mov_b32 s30, 2095232
s_mov_b32 s31, 0x20000
v_and_b32 v29, 7, v1
v_lshrrev_b32 v30, 3, v1
v_lshl_add_u32 v29, v30, 6, v29
s_lshl_b32 s43, s48, 3
v_add_u32 v29, s43, v29
v_lshlrev_b32 v29, 11, v29
s_mov_b32 s43, 1048576
s_mov_b32 s28, s68
s_mov_b32 s29, s69
s_mov_b32 s30, 2097152
s_mov_b32 s31, 0x20000
s_mul_i32 s43, s33, 9472
v_lshlrev_b32 v30, 7, v1
buffer_load_dword v31, v30, s[28:31], s43 offen
s_add_u32 s43, s43, 8192
s_bfm_b64 exec, 10, 0
buffer_load_dword v31, v30, s[28:31], s43 offen
s_mov_b64 exec, -1
s_branch Lst_2_0
Lwr_162:
s_barrier
s_branch Lst_3_0
Lwr_163:
s_barrier
s_branch Lst_4_0
Lwr_164:
s_barrier
s_branch Lst_5_0
Lwr_165:
s_barrier
s_cmp_eq_u32 s62, 3
s_cbranch_scc1 Lste_36
s_cmp_eq_u32 s62, 2
s_cbranch_scc1 Lst2_34
s_cmp_ge_u32 s62, 4
s_cbranch_scc1 Lst4_35
s_cmp_eq_u32 s62, 1
s_cbranch_scc1 Lst1_33
s_waitcnt vmcnt(4)
v_readfirstlane_b32 s54, v6
s_cmp_eq_u32 s54, 0
s_cbranch_scc0 Lrep_37
buffer_load_dword v6, v4, s[56:59], 0 offen sc1
s_branch Lste_36
Lrep_37:
s_add_u32 s7, s34, 64
s_lshl_b32 s7, s7, 7
v_mov_b32 v5, s7
v_mov_b32 v6, 1
s_mov_b64 exec, 1
buffer_atomic_add v6, v5, s[84:87], 0 offen sc1
s_mov_b64 exec, -1
s_mov_b32 s62, 1
s_mov_b32 s54, 0
s_mov_b32 s55, 0
s_branch Lste_36
Lst1_33:
s_and_b32 s43, s54, s55
s_cmp_eq_u32 s43, 16
s_cbranch_scc1 Lg_38
s_load_dword s54, s[82:83], s52 glc
s_load_dword s55, s[82:83], s53 glc
s_branch Lste_36
Lg_38:
v_add_u32 v5, 0, v1
v_min_u32 v5, 143, v5
v_lshlrev_b32 v20, 3, v5
v_add_u32 v5, s50, v5
v_max_i32 v5, 0, v5
v_lshlrev_b32 v5, 3, v5
buffer_load_dwordx2 v[32:33], v5, s[20:23], 0 offen sc1
v_add_u32 v5, 64, v1
v_min_u32 v5, 143, v5
v_lshlrev_b32 v21, 3, v5
v_add_u32 v5, s50, v5
v_max_i32 v5, 0, v5
v_lshlrev_b32 v5, 3, v5
buffer_load_dwordx2 v[34:35], v5, s[20:23], 0 offen sc1
v_add_u32 v5, 128, v1
v_min_u32 v5, 143, v5
v_lshlrev_b32 v22, 3, v5
v_add_u32 v5, s50, v5
v_max_i32 v5, 0, v5
v_lshlrev_b32 v5, 3, v5
buffer_load_dwordx2 v[36:37], v5, s[20:23], 0 offen sc1
s_mov_b32 s62, 4
s_branch Lste_36
Lst4_35:
s_mov_b32 s62, 2
s_branch Lste_36
Lst2_34:
s_waitcnt vmcnt(0)
v_add_u32 v20, 147456, v20
ds_write_b64 v20, v[32:33]
v_add_u32 v21, 147456, v21
ds_write_b64 v21, v[34:35]
v_add_u32 v22, 147456, v22
ds_write_b64 v22, v[36:37]
s_waitcnt lgkmcnt(0)
s_mov_b32 s62, 3
Lste_36:
s_branch Lst_6_0
Lwr_166:
s_barrier
s_cmp_eq_u32 s62, 3
s_cbranch_scc1 Lste_42
s_cmp_eq_u32 s62, 2
s_cbranch_scc1 Lst2_40
s_cmp_ge_u32 s62, 4
s_cbranch_scc1 Lst4_41
s_cmp_eq_u32 s62, 1
s_cbranch_scc1 Lst1_39
s_waitcnt vmcnt(0)
v_readfirstlane_b32 s54, v6
s_cmp_eq_u32 s54, 0
s_cbranch_scc0 Lrep_43
buffer_load_dword v6, v4, s[56:59], 0 offen sc1
s_branch Lste_42
Lrep_43:
s_add_u32 s7, s34, 64
s_lshl_b32 s7, s7, 7
v_mov_b32 v5, s7
v_mov_b32 v6, 1
s_mov_b64 exec, 1
buffer_atomic_add v6, v5, s[84:87], 0 offen sc1
s_mov_b64 exec, -1
s_mov_b32 s62, 1
s_mov_b32 s54, 0
s_mov_b32 s55, 0
s_branch Lste_42
Lst1_39:
s_and_b32 s43, s54, s55
s_cmp_eq_u32 s43, 16
s_cbranch_scc1 Lg_44
s_load_dword s54, s[82:83], s52 glc
s_load_dword s55, s[82:83], s53 glc
s_branch Lste_42
Lg_44:
v_add_u32 v5, 0, v1
v_min_u32 v5, 143, v5
v_lshlrev_b32 v20, 3, v5
v_add_u32 v5, s50, v5
v_max_i32 v5, 0, v5
v_lshlrev_b32 v5, 3, v5
buffer_load_dwordx2 v[32:33], v5, s[20:23], 0 offen sc1
v_add_u32 v5, 64, v1
v_min_u32 v5, 143, v5
v_lshlrev_b32 v21, 3, v5
v_add_u32 v5, s50, v5
v_max_i32 v5, 0, v5
v_lshlrev_b32 v5, 3, v5
buffer_load_dwordx2 v[34:35], v5, s[20:23], 0 offen sc1
v_add_u32 v5, 128, v1
v_min_u32 v5, 143, v5
v_lshlrev_b32 v22, 3, v5
v_add_u32 v5, s50, v5
v_max_i32 v5, 0, v5
v_lshlrev_b32 v5, 3, v5
buffer_load_dwordx2 v[36:37], v5, s[20:23], 0 offen sc1
s_mov_b32 s62, 4
s_branch Lste_42
Lst4_41:
s_mov_b32 s62, 2
s_branch Lste_42
Lst2_40:
s_waitcnt vmcnt(0)
v_add_u32 v20, 147456, v20
ds_write_b64 v20, v[32:33]
v_add_u32 v21, 147456, v21
ds_write_b64 v21, v[34:35]
v_add_u32 v22, 147456, v22
ds_write_b64 v22, v[36:37]
s_waitcnt lgkmcnt(0)
s_mov_b32 s62, 3
Lste_42:
s_branch Lst_7_0
Lwr_167:
s_barrier
s_cmp_eq_u32 s62, 3
s_cbranch_scc1 Lste_48
s_cmp_eq_u32 s62, 2
s_cbranch_scc1 Lst2_46
s_cmp_ge_u32 s62, 4
s_cbranch_scc1 Lst4_47
s_cmp_eq_u32 s62, 1
s_cbranch_scc1 Lst1_45
s_waitcnt vmcnt(0)
v_readfirstlane_b32 s54, v6
s_cmp_eq_u32 s54, 0
s_cbranch_scc0 Lrep_49
buffer_load_dword v6, v4, s[56:59], 0 offen sc1
s_branch Lste_48
Lrep_49:
s_add_u32 s7, s34, 64
s_lshl_b32 s7, s7, 7
v_mov_b32 v5, s7
v_mov_b32 v6, 1
s_mov_b64 exec, 1
buffer_atomic_add v6, v5, s[84:87], 0 offen sc1
s_mov_b64 exec, -1
s_mov_b32 s62, 1
s_mov_b32 s54, 0
s_mov_b32 s55, 0
s_branch Lste_48
Lst1_45:
s_and_b32 s43, s54, s55
s_cmp_eq_u32 s43, 16
s_cbranch_scc1 Lg_50
s_load_dword s54, s[82:83], s52 glc
s_load_dword s55, s[82:83], s53 glc
s_branch Lste_48
Lg_50:
v_add_u32 v5, 0, v1
v_min_u32 v5, 143, v5
v_lshlrev_b32 v20, 3, v5
v_add_u32 v5, s50, v5
v_max_i32 v5, 0, v5
v_lshlrev_b32 v5, 3, v5
buffer_load_dwordx2 v[32:33], v5, s[20:23], 0 offen sc1
v_add_u32 v5, 64, v1
v_min_u32 v5, 143, v5
v_lshlrev_b32 v21, 3, v5
v_add_u32 v5, s50, v5
v_max_i32 v5, 0, v5
v_lshlrev_b32 v5, 3, v5
buffer_load_dwordx2 v[34:35], v5, s[20:23], 0 offen sc1
v_add_u32 v5, 128, v1
v_min_u32 v5, 143, v5
v_lshlrev_b32 v22, 3, v5
v_add_u32 v5, s50, v5
v_max_i32 v5, 0, v5
v_lshlrev_b32 v5, 3, v5
buffer_load_dwordx2 v[36:37], v5, s[20:23], 0 offen sc1
s_mov_b32 s62, 4
s_branch Lste_48
Lst4_47:
s_mov_b32 s62, 2
s_branch Lste_48
Lst2_46:
s_waitcnt vmcnt(0)
v_add_u32 v20, 147456, v20
ds_write_b64 v20, v[32:33]
v_add_u32 v21, 147456, v21
ds_write_b64 v21, v[34:35]
v_add_u32 v22, 147456, v22
ds_write_b64 v22, v[36:37]
s_waitcnt lgkmcnt(0)
s_mov_b32 s62, 3
Lste_48:
s_branch Lst_8_0
Lwr_168:
s_barrier
s_cmp_eq_u32 s62, 3
s_cbranch_scc1 Lste_54
s_cmp_eq_u32 s62, 2
s_cbranch_scc1 Lst2_52
s_cmp_ge_u32 s62, 4
s_cbranch_scc1 Lst4_53
s_cmp_eq_u32 s62, 1
s_cbranch_scc1 Lst1_51
s_waitcnt vmcnt(0)
v_readfirstlane_b32 s54, v6
s_cmp_eq_u32 s54, 0
s_cbranch_scc0 Lrep_55
buffer_load_dword v6, v4, s[56:59], 0 offen sc1
s_branch Lste_54
Lrep_55:
s_add_u32 s7, s34, 64
s_lshl_b32 s7, s7, 7
v_mov_b32 v5, s7
v_mov_b32 v6, 1
s_mov_b64 exec, 1
buffer_atomic_add v6, v5, s[84:87], 0 offen sc1
s_mov_b64 exec, -1
s_mov_b32 s62, 1
s_mov_b32 s54, 0
s_mov_b32 s55, 0
s_branch Lste_54
Lst1_51:
s_and_b32 s43, s54, s55
s_cmp_eq_u32 s43, 16
s_cbranch_scc1 Lg_56
s_load_dword s54, s[82:83], s52 glc
s_load_dword s55, s[82:83], s53 glc
s_branch Lste_54
Lg_56:
v_add_u32 v5, 0, v1
v_min_u32 v5, 143, v5
v_lshlrev_b32 v20, 3, v5
v_add_u32 v5, s50, v5
v_max_i32 v5, 0, v5
v_lshlrev_b32 v5, 3, v5
buffer_load_dwordx2 v[32:33], v5, s[20:23], 0 offen sc1
v_add_u32 v5, 64, v1
v_min_u32 v5, 143, v5
v_lshlrev_b32 v21, 3, v5
v_add_u32 v5, s50, v5
v_max_i32 v5, 0, v5
v_lshlrev_b32 v5, 3, v5
buffer_load_dwordx2 v[34:35], v5, s[20:23], 0 offen sc1
v_add_u32 v5, 128, v1
v_min_u32 v5, 143, v5
v_lshlrev_b32 v22, 3, v5
v_add_u32 v5, s50, v5
v_max_i32 v5, 0, v5
v_lshlrev_b32 v5, 3, v5
buffer_load_dwordx2 v[36:37], v5, s[20:23], 0 offen sc1
s_mov_b32 s62, 4
s_branch Lste_54
Lst4_53:
s_mov_b32 s62, 2
s_branch Lste_54
Lst2_52:
s_waitcnt vmcnt(0)
v_add_u32 v20, 147456, v20
ds_write_b64 v20, v[32:33]
v_add_u32 v21, 147456, v21
ds_write_b64 v21, v[34:35]
v_add_u32 v22, 147456, v22
ds_write_b64 v22, v[36:37]
s_waitcnt lgkmcnt(0)
s_mov_b32 s62, 3
Lste_54:
s_branch Lst_9_0
Lwr_169:
s_barrier
s_getpc_b64 s[100:101]
s_and_b32 s100, s100, 0xfffff000
s_sub_u32 s100, s100, 1064960
s_subb_u32 s101, s101, 0
s_lshr_b32 s6, s2, 3
s_mul_i32 s6, s6, 1
s_and_b32 s7, s36, 0
s_add_u32 s6, s6, s7
s_mulk_i32 s6, 640
s_add_u32 s6, s6, 1063168
s_load_dword s3, s[100:101], s6 offset:0
s_load_dword s3, s[100:101], s6 offset:64
s_load_dword s3, s[100:101], s6 offset:128
s_load_dword s3, s[100:101], s6 offset:192
s_load_dword s3, s[100:101], s6 offset:256
s_load_dword s3, s[100:101], s6 offset:320
s_load_dword s3, s[100:101], s6 offset:384
s_load_dword s3, s[100:101], s6 offset:448
s_load_dword s3, s[100:101], s6 offset:512
s_load_dword s3, s[100:101], s6 offset:576
s_nop 0
s_nop 0
s_nop 0
s_nop 0
s_nop 0
s_nop 0
s_nop 0
s_nop 0
s_nop 0
s_nop 0
s_cmp_eq_u32 s62, 3
s_cbranch_scc1 Lste_60
s_cmp_eq_u32 s62, 2
s_cbranch_scc1 Lst2_58
s_cmp_ge_u32 s62, 4
s_cbranch_scc1 Lst4_59
s_cmp_eq_u32 s62, 1
s_cbranch_scc1 Lst1_57
s_waitcnt vmcnt(0)
v_readfirstlane_b32 s54, v6
s_cmp_eq_u32 s54, 0
s_cbranch_scc0 Lrep_61
buffer_load_dword v6, v4, s[56:59], 0 offen sc1
s_branch Lste_60
Lrep_61:
s_add_u32 s7, s34, 64
s_lshl_b32 s7, s7, 7
v_mov_b32 v5, s7
v_mov_b32 v6, 1
s_mov_b64 exec, 1
buffer_atomic_add v6, v5, s[84:87], 0 offen sc1
s_mov_b64 exec, -1
s_mov_b32 s62, 1
s_mov_b32 s54, 0
s_mov_b32 s55, 0
s_branch Lste_60
Lst1_57:
s_and_b32 s43, s54, s55
s_cmp_eq_u32 s43, 16
s_cbranch_scc1 Lg_62
s_load_dword s54, s[82:83], s52 glc
s_load_dword s55, s[82:83], s53 glc
s_branch Lste_60
Lg_62:
v_add_u32 v5, 0, v1
v_min_u32 v5, 143, v5
v_lshlrev_b32 v20, 3, v5
v_add_u32 v5, s50, v5
v_max_i32 v5, 0, v5
v_lshlrev_b32 v5, 3, v5
buffer_load_dwordx2 v[32:33], v5, s[20:23], 0 offen sc1
v_add_u32 v5, 64, v1
v_min_u32 v5, 143, v5
v_lshlrev_b32 v21, 3, v5
v_add_u32 v5, s50, v5
v_max_i32 v5, 0, v5
v_lshlrev_b32 v5, 3, v5
buffer_load_dwordx2 v[34:35], v5, s[20:23], 0 offen sc1
v_add_u32 v5, 128, v1
v_min_u32 v5, 143, v5
v_lshlrev_b32 v22, 3, v5
v_add_u32 v5, s50, v5
v_max_i32 v5, 0, v5
v_lshlrev_b32 v5, 3, v5
buffer_load_dwordx2 v[36:37], v5, s[20:23], 0 offen sc1
s_mov_b32 s62, 4
s_branch Lste_60
Lst4_59:
s_mov_b32 s62, 2
s_branch Lste_60
Lst2_58:
s_waitcnt vmcnt(0)
v_add_u32 v20, 147456, v20
ds_write_b64 v20, v[32:33]
v_add_u32 v21, 147456, v21
ds_write_b64 v21, v[34:35]
v_add_u32 v22, 147456, v22
ds_write_b64 v22, v[36:37]
s_waitcnt lgkmcnt(0)
s_mov_b32 s62, 3
Lste_60:
s_branch Lst_10_0
Lwr_170:
s_barrier
s_cmp_eq_u32 s62, 3
s_cbranch_scc1 Lste_66
s_cmp_eq_u32 s62, 2
s_cbranch_scc1 Lst2_64
s_cmp_ge_u32 s62, 4
s_cbranch_scc1 Lst4_65
s_cmp_eq_u32 s62, 1
s_cbranch_scc1 Lst1_63
s_waitcnt vmcnt(0)
v_readfirstlane_b32 s54, v6
s_cmp_eq_u32 s54, 0
s_cbranch_scc0 Lrep_67
buffer_load_dword v6, v4, s[56:59], 0 offen sc1
s_branch Lste_66
Lrep_67:
s_add_u32 s7, s34, 64
s_lshl_b32 s7, s7, 7
v_mov_b32 v5, s7
v_mov_b32 v6, 1
s_mov_b64 exec, 1
buffer_atomic_add v6, v5, s[84:87], 0 offen sc1
s_mov_b64 exec, -1
s_mov_b32 s62, 1
s_mov_b32 s54, 0
s_mov_b32 s55, 0
s_branch Lste_66
Lst1_63:
s_and_b32 s43, s54, s55
s_cmp_eq_u32 s43, 16
s_cbranch_scc1 Lg_68
s_load_dword s54, s[82:83], s52 glc
s_load_dword s55, s[82:83], s53 glc
s_branch Lste_66
Lg_68:
v_add_u32 v5, 0, v1
v_min_u32 v5, 143, v5
v_lshlrev_b32 v20, 3, v5
v_add_u32 v5, s50, v5
v_max_i32 v5, 0, v5
v_lshlrev_b32 v5, 3, v5
buffer_load_dwordx2 v[32:33], v5, s[20:23], 0 offen sc1
v_add_u32 v5, 64, v1
v_min_u32 v5, 143, v5
v_lshlrev_b32 v21, 3, v5
v_add_u32 v5, s50, v5
v_max_i32 v5, 0, v5
v_lshlrev_b32 v5, 3, v5
buffer_load_dwordx2 v[34:35], v5, s[20:23], 0 offen sc1
v_add_u32 v5, 128, v1
v_min_u32 v5, 143, v5
v_lshlrev_b32 v22, 3, v5
v_add_u32 v5, s50, v5
v_max_i32 v5, 0, v5
v_lshlrev_b32 v5, 3, v5
buffer_load_dwordx2 v[36:37], v5, s[20:23], 0 offen sc1
s_mov_b32 s62, 4
s_branch Lste_66
Lst4_65:
s_mov_b32 s62, 2
s_branch Lste_66
Lst2_64:
s_waitcnt vmcnt(0)
v_add_u32 v20, 147456, v20
ds_write_b64 v20, v[32:33]
v_add_u32 v21, 147456, v21
ds_write_b64 v21, v[34:35]
v_add_u32 v22, 147456, v22
ds_write_b64 v22, v[36:37]
s_waitcnt lgkmcnt(0)
s_mov_b32 s62, 3
Lste_66:
s_branch Lst_11_0
Lwr_171:
s_barrier
s_cmp_eq_u32 s62, 3
s_cbranch_scc1 Lste_72
s_cmp_eq_u32 s62, 2
s_cbranch_scc1 Lst2_70
s_cmp_ge_u32 s62, 4
s_cbranch_scc1 Lst4_71
s_cmp_eq_u32 s62, 1
s_cbranch_scc1 Lst1_69
s_waitcnt vmcnt(0)
v_readfirstlane_b32 s54, v6
s_cmp_eq_u32 s54, 0
s_cbranch_scc0 Lrep_73
buffer_load_dword v6, v4, s[56:59], 0 offen sc1
s_branch Lste_72
Lrep_73:
s_add_u32 s7, s34, 64
s_lshl_b32 s7, s7, 7
v_mov_b32 v5, s7
v_mov_b32 v6, 1
s_mov_b64 exec, 1
buffer_atomic_add v6, v5, s[84:87], 0 offen sc1
s_mov_b64 exec, -1
s_mov_b32 s62, 1
s_mov_b32 s54, 0
s_mov_b32 s55, 0
s_branch Lste_72
Lst1_69:
s_and_b32 s43, s54, s55
s_cmp_eq_u32 s43, 16
s_cbranch_scc1 Lg_74
s_load_dword s54, s[82:83], s52 glc
s_load_dword s55, s[82:83], s53 glc
s_branch Lste_72
Lg_74:
v_add_u32 v5, 0, v1
v_min_u32 v5, 143, v5
v_lshlrev_b32 v20, 3, v5
v_add_u32 v5, s50, v5
v_max_i32 v5, 0, v5
v_lshlrev_b32 v5, 3, v5
buffer_load_dwordx2 v[32:33], v5, s[20:23], 0 offen sc1
v_add_u32 v5, 64, v1
v_min_u32 v5, 143, v5
v_lshlrev_b32 v21, 3, v5
v_add_u32 v5, s50, v5
v_max_i32 v5, 0, v5
v_lshlrev_b32 v5, 3, v5
buffer_load_dwordx2 v[34:35], v5, s[20:23], 0 offen sc1
v_add_u32 v5, 128, v1
v_min_u32 v5, 143, v5
v_lshlrev_b32 v22, 3, v5
v_add_u32 v5, s50, v5
v_max_i32 v5, 0, v5
v_lshlrev_b32 v5, 3, v5
buffer_load_dwordx2 v[36:37], v5, s[20:23], 0 offen sc1
s_mov_b32 s62, 4
s_branch Lste_72
Lst4_71:
s_mov_b32 s62, 2
s_branch Lste_72
Lst2_70:
s_waitcnt vmcnt(0)
v_add_u32 v20, 147456, v20
ds_write_b64 v20, v[32:33]
v_add_u32 v21, 147456, v21
ds_write_b64 v21, v[34:35]
v_add_u32 v22, 147456, v22
ds_write_b64 v22, v[36:37]
s_waitcnt lgkmcnt(0)
s_mov_b32 s62, 3
Lste_72:
s_branch Lst_12_0
Lwr_172:
s_barrier
s_cmp_eq_u32 s62, 3
s_cbranch_scc1 Lste_78
s_cmp_eq_u32 s62, 2
s_cbranch_scc1 Lst2_76
s_cmp_ge_u32 s62, 4
s_cbranch_scc1 Lst4_77
s_cmp_eq_u32 s62, 1
s_cbranch_scc1 Lst1_75
s_waitcnt vmcnt(0)
v_readfirstlane_b32 s54, v6
s_cmp_eq_u32 s54, 0
s_cbranch_scc0 Lrep_79
buffer_load_dword v6, v4, s[56:59], 0 offen sc1
s_branch Lste_78
Lrep_79:
s_add_u32 s7, s34, 64
s_lshl_b32 s7, s7, 7
v_mov_b32 v5, s7
v_mov_b32 v6, 1
s_mov_b64 exec, 1
buffer_atomic_add v6, v5, s[84:87], 0 offen sc1
s_mov_b64 exec, -1
s_mov_b32 s62, 1
s_mov_b32 s54, 0
s_mov_b32 s55, 0
s_branch Lste_78
Lst1_75:
s_and_b32 s43, s54, s55
s_cmp_eq_u32 s43, 16
s_cbranch_scc1 Lg_80
s_load_dword s54, s[82:83], s52 glc
s_load_dword s55, s[82:83], s53 glc
s_branch Lste_78
Lg_80:
v_add_u32 v5, 0, v1
v_min_u32 v5, 143, v5
v_lshlrev_b32 v20, 3, v5
v_add_u32 v5, s50, v5
v_max_i32 v5, 0, v5
v_lshlrev_b32 v5, 3, v5
buffer_load_dwordx2 v[32:33], v5, s[20:23], 0 offen sc1
v_add_u32 v5, 64, v1
v_min_u32 v5, 143, v5
v_lshlrev_b32 v21, 3, v5
v_add_u32 v5, s50, v5
v_max_i32 v5, 0, v5
v_lshlrev_b32 v5, 3, v5
buffer_load_dwordx2 v[34:35], v5, s[20:23], 0 offen sc1
v_add_u32 v5, 128, v1
v_min_u32 v5, 143, v5
v_lshlrev_b32 v22, 3, v5
v_add_u32 v5, s50, v5
v_max_i32 v5, 0, v5
v_lshlrev_b32 v5, 3, v5
buffer_load_dwordx2 v[36:37], v5, s[20:23], 0 offen sc1
s_mov_b32 s62, 4
s_branch Lov_4
.p2align 12
.fill 32, 4, 0xbf800000
Lst_4_0:
s_branch Lwr_164
s_nop 0
s_nop 0
Lov_4:
s_branch Lste_78
Lst4_77:
s_mov_b32 s62, 2
s_branch Lste_78
Lst2_76:
s_waitcnt vmcnt(0)
v_add_u32 v20, 147456, v20
ds_write_b64 v20, v[32:33]
v_add_u32 v21, 147456, v21
ds_write_b64 v21, v[34:35]
v_add_u32 v22, 147456, v22
ds_write_b64 v22, v[36:37]
s_waitcnt lgkmcnt(0)
s_mov_b32 s62, 3
Lste_78:
s_branch Lst_13_0
Lwr_173:
s_barrier
s_cmp_eq_u32 s62, 3
s_cbranch_scc1 Lste_84
s_cmp_eq_u32 s62, 2
s_cbranch_scc1 Lst2_82
s_cmp_ge_u32 s62, 4
s_cbranch_scc1 Lst4_83
s_cmp_eq_u32 s62, 1
s_cbranch_scc1 Lst1_81
s_waitcnt vmcnt(0)
v_readfirstlane_b32 s54, v6
s_cmp_eq_u32 s54, 0
s_cbranch_scc0 Lrep_85
buffer_load_dword v6, v4, s[56:59], 0 offen sc1
s_branch Lste_84
Lrep_85:
s_add_u32 s7, s34, 64
s_lshl_b32 s7, s7, 7
v_mov_b32 v5, s7
v_mov_b32 v6, 1
s_mov_b64 exec, 1
buffer_atomic_add v6, v5, s[84:87], 0 offen sc1
s_mov_b64 exec, -1
s_mov_b32 s62, 1
s_mov_b32 s54, 0
s_mov_b32 s55, 0
s_branch Lste_84
Lst1_81:
s_and_b32 s43, s54, s55
s_cmp_eq_u32 s43, 16
s_cbranch_scc1 Lg_86
s_load_dword s54, s[82:83], s52 glc
s_load_dword s55, s[82:83], s53 glc
s_branch Lste_84
Lg_86:
v_add_u32 v5, 0, v1
v_min_u32 v5, 143, v5
v_lshlrev_b32 v20, 3, v5
v_add_u32 v5, s50, v5
v_max_i32 v5, 0, v5
v_lshlrev_b32 v5, 3, v5
buffer_load_dwordx2 v[32:33], v5, s[20:23], 0 offen sc1
v_add_u32 v5, 64, v1
v_min_u32 v5, 143, v5
v_lshlrev_b32 v21, 3, v5
v_add_u32 v5, s50, v5
v_max_i32 v5, 0, v5
v_lshlrev_b32 v5, 3, v5
buffer_load_dwordx2 v[34:35], v5, s[20:23], 0 offen sc1
v_add_u32 v5, 128, v1
v_min_u32 v5, 143, v5
v_lshlrev_b32 v22, 3, v5
v_add_u32 v5, s50, v5
v_max_i32 v5, 0, v5
v_lshlrev_b32 v5, 3, v5
buffer_load_dwordx2 v[36:37], v5, s[20:23], 0 offen sc1
s_mov_b32 s62, 4
s_branch Lste_84
Lst4_83:
s_mov_b32 s62, 2
s_branch Lste_84
Lst2_82:
s_waitcnt vmcnt(0)
v_add_u32 v20, 147456, v20
ds_write_b64 v20, v[32:33]
v_add_u32 v21, 147456, v21
ds_write_b64 v21, v[34:35]
v_add_u32 v22, 147456, v22
ds_write_b64 v22, v[36:37]
s_waitcnt lgkmcnt(0)
s_mov_b32 s62, 3
Lste_84:
s_branch Lst_14_0
Lwr_174:
s_barrier
s_cmp_eq_u32 s62, 3
s_cbranch_scc1 Lste_89
s_cmp_ge_u32 s62, 5
s_cbranch_scc1 Lg_94
s_cmp_ge_u32 s62, 2
s_cbranch_scc1 Lst2_88
s_cmp_eq_u32 s62, 1
s_cbranch_scc1 Lst1_87
s_mov_b32 s41, 0x40000
Lz0_90:
s_waitcnt vmcnt(0)
v_readfirstlane_b32 s54, v6
s_cmp_eq_u32 s54, 0
s_cbranch_scc0 Lzok_91
buffer_load_dword v6, v4, s[56:59], 0 offen sc1
s_sub_u32 s41, s41, 1
s_cmp_lg_u32 s41, 0
s_cbranch_scc1 Lz0_90
s_waitcnt lgkmcnt(0)
Lzok_91:
s_add_u32 s7, s34, 64
s_lshl_b32 s7, s7, 7
v_mov_b32 v5, s7
v_mov_b32 v6, 1
s_mov_b64 exec, 1
buffer_atomic_add v6, v5, s[84:87], 0 offen sc1
s_mov_b64 exec, -1
Lst1_87:
s_load_dword s54, s[82:83], s52 glc
s_load_dword s55, s[82:83], s53 glc
s_mov_b32 s41, 0x40000
Lpoll_92:
s_waitcnt lgkmcnt(0)
s_and_b32 s54, s54, s55
s_cmp_eq_u32 s54, 16
s_cbranch_scc1 Lg_94
s_load_dword s54, s[82:83], s52 glc
s_load_dword s55, s[82:83], s53 glc
s_sub_u32 s41, s41, 1
s_cmp_lg_u32 s41, 0
s_cbranch_scc1 Lpoll_92
s_waitcnt lgkmcnt(0)
Lg_94:
v_add_u32 v5, 0, v1
v_min_u32 v5, 143, v5
v_lshlrev_b32 v20, 3, v5
v_add_u32 v5, s50, v5
v_max_i32 v5, 0, v5
v_lshlrev_b32 v5, 3, v5
buffer_load_dwordx2 v[32:33], v5, s[20:23], 0 offen sc1
v_add_u32 v5, 64, v1
v_min_u32 v5, 143, v5
v_lshlrev_b32 v21, 3, v5
v_add_u32 v5, s50, v5
v_max_i32 v5, 0, v5
v_lshlrev_b32 v5, 3, v5
buffer_load_dwordx2 v[34:35], v5, s[20:23], 0 offen sc1
v_add_u32 v5, 128, v1
v_min_u32 v5, 143, v5
v_lshlrev_b32 v22, 3, v5
v_add_u32 v5, s50, v5
v_max_i32 v5, 0, v5
v_lshlrev_b32 v5, 3, v5
buffer_load_dwordx2 v[36:37], v5, s[20:23], 0 offen sc1
Lst2_88:
s_waitcnt vmcnt(0)
v_add_u32 v20, 147456, v20
ds_write_b64 v20, v[32:33]
v_add_u32 v21, 147456, v21
ds_write_b64 v21, v[34:35]
v_add_u32 v22, 147456, v22
ds_write_b64 v22, v[36:37]
s_waitcnt lgkmcnt(0)
Lste_89:
s_bitcmp0_b32 s2, 0
s_cselect_b32 s88, s72, s74
s_cselect_b32 s89, s73, s75
s_cmp_lt_u32 s2, 192
s_cselect_b32 s90, 7340032, 0
s_mov_b32 s91, 0x20000
s_bfe_u32 s44, s2, 0x30001
s_lshl_b32 s44, s44, 2
s_and_b32 s43, s36, 3
s_add_u32 s44, s44, s43
s_lshl_b32 s44, s44, 5
v_lshrrev_b32 v18, 4, v1
v_add_u32 v18, s44, v18
v_mul_u32_u24 v18, 7168, v18
v_and_b32 v19, 15, v1
v_lshl_add_u32 v18, v19, 4, v18
s_lshr_b32 s43, s2, 4
s_lshl_b32 s43, s43, 8
s_add_u32 s43, s43, 4096
v_add_u32 v18, s43, v18
s_mov_b32 s43, 0
buffer_load_dwordx4 v[128:131], v18, s[88:91], s43 offen
s_mov_b32 s43, 28672
buffer_load_dwordx4 v[132:135], v18, s[88:91], s43 offen
s_mov_b32 s43, 57344
buffer_load_dwordx4 v[136:139], v18, s[88:91], s43 offen
s_mov_b32 s43, 86016
buffer_load_dwordx4 v[140:143], v18, s[88:91], s43 offen
s_mov_b32 s43, 114688
buffer_load_dwordx4 v[144:147], v18, s[88:91], s43 offen
s_mov_b32 s43, 143360
buffer_load_dwordx4 v[148:151], v18, s[88:91], s43 offen
s_mov_b32 s43, 172032
buffer_load_dwordx4 v[152:155], v18, s[88:91], s43 offen
s_mov_b32 s43, 200704
buffer_load_dwordx4 v[156:159], v18, s[88:91], s43 offen
s_barrier
s_lshl_b32 s43, s35, 7
s_add_u32 s28, s68, s43
s_addc_u32 s29, s69, 0
s_mov_b32 s30, 2095232
s_mov_b32 s31, 0x20000
v_lshrrev_b32 v15, 3, v1
v_and_b32 v16, 6, v15
v_and_b32 v7, 7, v1
v_xor_b32 v7, v7, v16
v_lshlrev_b32 v7, 4, v7
v_mul_u32_u24 v15, 2048, v15
v_add_u32 v7, v7, v15
s_and_b32 s40, s36, 3
s_lshl_b32 s39, s40, 13
s_add_u32 s40, s40, s35
s_add_u32 s42, s40, 0
s_and_b32 s42, s42, 15
s_lshl_b32 s42, s42, 17
s_add_u32 m0, s39, 65536
s_add_u32 s43, s42, 0
buffer_load_dwordx4 v7, s[28:31], s43 offen lds
s_add_u32 m0, s39, 66560
s_add_u32 s43, s42, 16384
buffer_load_dwordx4 v7, s[28:31], s43 offen lds
s_add_u32 m0, s39, 67584
s_add_u32 s43, s42, 32768
buffer_load_dwordx4 v7, s[28:31], s43 offen lds
s_add_u32 m0, s39, 68608
s_add_u32 s43, s42, 49152
buffer_load_dwordx4 v7, s[28:31], s43 offen lds
s_add_u32 m0, s39, 69632
s_add_u32 s43, s42, 65536
buffer_load_dwordx4 v7, s[28:31], s43 offen lds
s_add_u32 m0, s39, 70656
s_add_u32 s43, s42, 81920
buffer_load_dwordx4 v7, s[28:31], s43 offen lds
s_add_u32 m0, s39, 71680
s_add_u32 s43, s42, 98304
buffer_load_dwordx4 v7, s[28:31], s43 offen lds
s_add_u32 m0, s39, 72704
s_add_u32 s43, s42, 114688
buffer_load_dwordx4 v7, s[28:31], s43 offen lds
Lats_6:
s_and_b32 s43, s36, 1
s_bfe_u32 s44, s36, 0x10001
s_lshr_b32 s45, s36, 2
v_lshlrev_b32 v14, 2, v13
v_sub_u32 v14, v12, v14
v_mov_b32 v16, 0xff800000
s_or_b32 s46, s34, s45
s_cmp_lg_u32 s46, 0
s_cselect_b32 s46, 0, 0xff800000
v_subrev_u32 v15, 0, v14
v_cmp_ge_u32 vcc, 7, v15
v_add_u32 v15, 16, v15
s_nop 0
v_cndmask_b32 v248, v16, 0, vcc
v_cmp_ge_u32 vcc, 7, v15
s_nop 1
v_cndmask_b32 v244, v16, 0, vcc
v_or_b32 v240, s46, v244
v_subrev_u32 v15, 1, v14
v_cmp_ge_u32 vcc, 7, v15
v_add_u32 v15, 16, v15
s_nop 0
v_cndmask_b32 v249, v16, 0, vcc
v_cmp_ge_u32 vcc, 7, v15
s_nop 1
v_cndmask_b32 v245, v16, 0, vcc
v_or_b32 v241, s46, v245
v_subrev_u32 v15, 2, v14
v_cmp_ge_u32 vcc, 7, v15
v_add_u32 v15, 16, v15
s_nop 0
v_cndmask_b32 v250, v16, 0, vcc
v_cmp_ge_u32 vcc, 7, v15
s_nop 1
v_cndmask_b32 v246, v16, 0, vcc
v_or_b32 v242, s46, v246
v_subrev_u32 v15, 3, v14
v_cmp_ge_u32 vcc, 7, v15
v_add_u32 v15, 16, v15
s_nop 0
v_cndmask_b32 v251, v16, 0, vcc
v_cmp_ge_u32 vcc, 7, v15
s_nop 1
v_cndmask_b32 v247, v16, 0, vcc
v_or_b32 v243, s46, v247
s_lshl_b32 s46, s45, 6
s_add_u32 s46, s46, s44
s_add_u32 s46, s46, 16
v_lshl_add_u32 v14, v12, 1, s46
s_lshl_b32 s47, s43, 6
v_lshl_add_u32 v15, v13, 4, s47
v_mul_u32_u24 v20, 400, v14
v_add_u32 v20, v20, v15
v_subrev_u32 v16, 32, v14
v_max_i32 v16, 0, v16
v_mul_u32_u24 v21, 400, v16
v_add_u32 v21, v21, v15
v_lshrrev_b32 v16, 2, v12
v_lshl_add_u32 v16, v13, 2, v16
v_lshl_add_u32 v16, v16, 1, s46
v_and_b32 v17, 3, v1
v_lshl_add_u32 v17, v17, 3, s47
v_mul_u32_u24 v22, 400, v16
v_add_u32 v22, v22, v17
v_subrev_u32 v16, 32, v16
v_max_i32 v16, 0, v16
v_mul_u32_u24 v23, 400, v16
v_add_u32 v23, v23, v17
s_mul_i32 s60, s34, 262144
s_add_u32 s16, s82, s60
s_addc_u32 s17, s83, 0
s_mov_b32 s18, 262144
s_mov_b32 s19, 0x20000
s_lshl_b32 s60, s35, 14
s_lshl_b32 s43, s43, 13
s_add_u32 s60, s60, s43
s_lshl_b32 s43, s45, 12
s_add_u32 s60, s60, s43
s_lshl_b32 s43, s44, 10
s_add_u32 s60, s60, s43
v_lshlrev_b32 v24, 4, v1
s_mov_b32 s61, 0x3e8293ee
s_lshl_b32 s38, s35, 7
Latt_5:
s_barrier
ds_read_b128 v[32:35], v20 offset:0
ds_read_b128 v[36:39], v20 offset:128
ds_read_b128 v[40:43], v21 offset:128
ds_read_b128 v[80:83], v20 offset:12800
ds_read_b128 v[84:87], v20 offset:12928
ds_read_b128 v[88:91], v20 offset:128
ds_read_b64_tr_b16 v[44:45], v23 offset:256
ds_read_b64_tr_b16 v[46:47], v22 offset:256
ds_read_b64_tr_b16 v[48:49], v23 offset:288
ds_read_b64_tr_b16 v[50:51], v22 offset:288
ds_read_b64_tr_b16 v[92:93], v22 offset:256
ds_read_b64_tr_b16 v[94:95], v22 offset:13056
ds_read_b64_tr_b16 v[96:97], v22 offset:288
ds_read_b64_tr_b16 v[98:99], v22 offset:13088
s_waitcnt lgkmcnt(11)
v_mfma_f32_16x16x32_bf16 v[52:55], v[40:43], v[32:35], v[240:243]
v_mfma_f32_16x16x32_bf16 v[56:59], v[36:39], v[32:35], v[248:251]
s_waitcnt lgkmcnt(8)
v_mfma_f32_16x16x32_bf16 v[100:103], v[88:91], v[80:83], v[244:247]
v_mfma_f32_16x16x32_bf16 v[104:107], v[84:87], v[80:83], v[248:251]
s_nop 5
v_max3_f32 v60, v52, v53, v54
v_max3_f32 v108, v100, v101, v102
v_max3_f32 v61, v55, v56, v57
v_max3_f32 v109, v103, v104, v105
v_max3_f32 v60, v60, v58, v59
v_max3_f32 v108, v108, v106, v107
v_max_f32 v60, v60, v61
v_max_f32 v108, v108, v109
s_nop 1
v_permlane32_swap_b32 v60, v108
v_max_f32 v60, v60, v108
v_mov_b32 v61, v60
s_nop 1
v_permlane16_swap_b32 v60, v61
v_max_f32 v60, v60, v61
v_mul_f32 v60, s61, v60
s_nop 0
v_mov_b32 v108, v60
s_nop 1
v_permlane32_swap_b32 v60, v108
v_fma_f32 v52, v52, s61, -v60
v_fma_f32 v100, v100, s61, -v108
v_fma_f32 v53, v53, s61, -v60
v_fma_f32 v101, v101, s61, -v108
v_fma_f32 v54, v54, s61, -v60
v_fma_f32 v102, v102, s61, -v108
v_fma_f32 v55, v55, s61, -v60
v_fma_f32 v103, v103, s61, -v108
v_fma_f32 v56, v56, s61, -v60
v_fma_f32 v104, v104, s61, -v108
v_fma_f32 v57, v57, s61, -v60
v_fma_f32 v105, v105, s61, -v108
v_fma_f32 v58, v58, s61, -v60
v_fma_f32 v106, v106, s61, -v108
v_fma_f32 v59, v59, s61, -v60
v_fma_f32 v107, v107, s61, -v108
v_exp_f32 v52, v52
v_exp_f32 v100, v100
v_exp_f32 v53, v53
v_exp_f32 v101, v101
v_exp_f32 v54, v54
v_exp_f32 v102, v102
v_exp_f32 v55, v55
v_exp_f32 v103, v103
v_exp_f32 v56, v56
v_exp_f32 v104, v104
v_exp_f32 v57, v57
v_exp_f32 v105, v105
v_exp_f32 v58, v58
v_exp_f32 v106, v106
v_exp_f32 v59, v59
v_exp_f32 v107, v107
v_cvt_pk_bf16_f32 v64, v52, v53
v_cvt_pk_bf16_f32 v112, v100, v101
v_cvt_pk_bf16_f32 v65, v54, v55
v_cvt_pk_bf16_f32 v113, v102, v103
v_cvt_pk_bf16_f32 v66, v56, v57
v_cvt_pk_bf16_f32 v114, v104, v105
v_cvt_pk_bf16_f32 v67, v58, v59
v_cvt_pk_bf16_f32 v115, v106, v107
v_pk_add_f32 v[52:53], v[52:53], v[54:55]
v_pk_add_f32 v[100:101], v[100:101], v[102:103]
v_pk_add_f32 v[56:57], v[56:57], v[58:59]
v_pk_add_f32 v[104:105], v[104:105], v[106:107]
s_waitcnt lgkmcnt(0)
s_waitcnt lgkmcnt(0)
v_mfma_f32_16x16x32_bf16 v[68:71], v[44:47], v[64:67], 0
v_mfma_f32_16x16x32_bf16 v[116:119], v[92:95], v[112:115], 0
v_mfma_f32_16x16x32_bf16 v[72:75], v[48:51], v[64:67], 0
v_mfma_f32_16x16x32_bf16 v[120:123], v[96:99], v[112:115], 0
v_pk_add_f32 v[52:53], v[52:53], v[56:57]
v_pk_add_f32 v[100:101], v[100:101], v[104:105]
v_add_f32 v60, v52, v53
v_add_f32 v108, v100, v101
s_nop 1
v_permlane32_swap_b32 v60, v108
v_add_f32 v60, v60, v108
v_mov_b32 v61, v60
s_nop 1
v_permlane16_swap_b32 v60, v61
v_add_f32 v60, v60, v61
v_rcp_f32 v60, v60
s_nop 0
v_mov_b32 v108, v60
s_nop 1
v_permlane32_swap_b32 v60, v108
v_pk_mul_f32 v[68:69], v[60:61], v[68:69] op_sel_hi:[0,1]
v_pk_mul_f32 v[116:117], v[108:109], v[116:117] op_sel_hi:[0,1]
v_pk_mul_f32 v[70:71], v[60:61], v[70:71] op_sel_hi:[0,1]
v_pk_mul_f32 v[118:119], v[108:109], v[118:119] op_sel_hi:[0,1]
v_pk_mul_f32 v[72:73], v[60:61], v[72:73] op_sel_hi:[0,1]
v_pk_mul_f32 v[120:121], v[108:109], v[120:121] op_sel_hi:[0,1]
v_pk_mul_f32 v[74:75], v[60:61], v[74:75] op_sel_hi:[0,1]
v_pk_mul_f32 v[122:123], v[108:109], v[122:123] op_sel_hi:[0,1]
v_cvt_pk_bf16_f32 v64, v68, v69
v_cvt_pk_bf16_f32 v112, v116, v117
v_cvt_pk_bf16_f32 v65, v70, v71
v_cvt_pk_bf16_f32 v113, v118, v119
v_cvt_pk_bf16_f32 v66, v72, v73
v_cvt_pk_bf16_f32 v114, v120, v121
v_cvt_pk_bf16_f32 v67, v74, v75
v_cvt_pk_bf16_f32 v115, v122, v123
buffer_store_dwordx4 v[64:67], v24, s[16:19], s60 offen offset:0 sc1
buffer_store_dwordx4 v[112:115], v24, s[16:19], s60 offen offset:2048 sc1
s_add_u32 s56, s82, 28311552
s_addc_u32 s57, s83, 0
s_mov_b32 s58, 114688
s_mov_b32 s59, 0x20000
s_lshl_b32 s7, s34, 12
s_add_u32 s7, s7, 49152
v_lshl_add_u32 v26, v1, 8, s7
v_mov_b32 v27, 1
s_cmp_ge_u32 s36, 4
s_cbranch_scc1 Lh_96
s_waitcnt vmcnt(0)
s_branch Lo_95
Lh_96:
s_add_u32 s28, s68, s38
s_addc_u32 s29, s69, 0
s_mov_b32 s30, 2095232
s_mov_b32 s31, 0x20000
s_add_u32 s42, s40, 4
s_and_b32 s42, s42, 15
s_lshl_b32 s42, s42, 17
s_add_u32 m0, s39, 114688
s_add_u32 s43, s42, 0
buffer_load_dwordx4 v7, s[28:31], s43 offen lds
s_add_u32 m0, s39, 115712
s_add_u32 s43, s42, 16384
buffer_load_dwordx4 v7, s[28:31], s43 offen lds
s_add_u32 m0, s39, 116736
s_add_u32 s43, s42, 32768
buffer_load_dwordx4 v7, s[28:31], s43 offen lds
s_add_u32 m0, s39, 117760
s_add_u32 s43, s42, 49152
buffer_load_dwordx4 v7, s[28:31], s43 offen lds
s_add_u32 m0, s39, 118784
s_add_u32 s43, s42, 65536
buffer_load_dwordx4 v7, s[28:31], s43 offen lds
s_add_u32 m0, s39, 119808
s_add_u32 s43, s42, 81920
buffer_load_dwordx4 v7, s[28:31], s43 offen lds
s_add_u32 m0, s39, 120832
s_add_u32 s43, s42, 98304
buffer_load_dwordx4 v7, s[28:31], s43 offen lds
s_add_u32 m0, s39, 121856
s_add_u32 s43, s42, 114688
buffer_load_dwordx4 v7, s[28:31], s43 offen lds
s_waitcnt vmcnt(8)
Lo_95:
s_cmp_lg_u32 s36, 0
s_barrier
s_cbranch_scc1 Lsig_97
s_mov_b64 exec, 0xffff
buffer_atomic_add v27, v26, s[56:59], 0 offen sc1
s_mov_b64 exec, -1
Lsig_97:
s_cmp_ge_u32 s36, 4
s_cbranch_scc1 Lprod_99
v_and_b32 v12, 15, v1
v_lshrrev_b32 v13, 4, v1
v_lshlrev_b32 v10, 12, v12
v_and_b32 v14, 1, v13
v_lshl_add_u32 v10, v14, 5, v10
v_lshrrev_b32 v14, 1, v13
v_lshl_add_u32 v10, v14, 4, v10
s_lshl_b32 s43, s34, 18
s_lshl_b32 s44, s36, 16
s_add_u32 s43, s43, s44
s_lshl_b32 s44, s35, 7
s_add_u32 s43, s43, s44
buffer_load_dwordx4 v[128:131], v10, s[8:11], s43 offen offset:0
buffer_load_dwordx4 v[132:135], v10, s[8:11], s43 offen offset:64
buffer_load_dwordx4 v[136:139], v10, s[8:11], s43 offen offset:2048
buffer_load_dwordx4 v[140:143], v10, s[8:11], s43 offen offset:2112
v_and_b32 v12, 15, v1
v_lshrrev_b32 v13, 4, v1
s_mul_i32 s43, s34, 262144
s_add_u32 s20, s82, s43
s_addc_u32 s21, s83, 0
s_add_u32 s20, s20, 4194304
s_addc_u32 s21, s21, 0
s_mov_b32 s22, 262144
s_mov_b32 s23, 0x20000
s_mul_i32 s43, s34, 16384
s_add_u32 s24, s82, s43
s_addc_u32 s25, s83, 0
s_add_u32 s24, s24, 25165824
s_addc_u32 s25, s25, 0
s_mov_b32 s26, 16384
s_mov_b32 s27, 0x20000
v_lshlrev_b32 v11, 4, v1
s_lshl_b32 s43, s36, 11
v_add_u32 v2, s43, v11
v_add_u32 v3, 98304, v2
v_lshrrev_b32 v14, 2, v1
v_bfe_u32 v15, v14, 1, 2
v_mul_u32_u24 v14, 128, v14
v_lshl_add_u32 v14, v15, 5, v14
v_and_b32 v15, 3, v1
v_lshl_add_u32 v4, v15, 3, v14
v_xor_b32 v5, 32, v4
v_xor_b32 v6, 64, v4
v_xor_b32 v7, 96, v4
v_add_u32 v16, 0x10000, v4
v_add_u32 v20, 0x20000, v4
v_add_u32 v17, 0x10000, v5
v_add_u32 v21, 0x20000, v5
v_add_u32 v18, 0x10000, v6
v_add_u32 v22, 0x20000, v6
v_add_u32 v19, 0x10000, v7
v_add_u32 v23, 0x20000, v7
s_lshl_b32 s44, s35, 14
s_add_u32 s60, s44, s43
v_lshrrev_b32 v14, 1, v13
v_lshlrev_b32 v14, 11, v14
v_lshl_add_u32 v14, v12, 3, v14
v_and_b32 v15, 1, v13
v_lshl_add_u32 v14, v15, 2, v14
s_lshl_b32 s43, s36, 12
s_lshl_b32 s44, s35, 7
s_add_u32 s43, s43, s44
v_add_u32 v9, s43, v14
s_mov_b32 s61, 0x3f803f80
s_waitcnt vmcnt(0)
v_permlane16_swap_b32 v128, v130
v_permlane16_swap_b32 v129, v131
v_permlane16_swap_b32 v132, v134
v_permlane16_swap_b32 v133, v135
v_permlane16_swap_b32 v136, v138
v_permlane16_swap_b32 v137, v139
v_permlane16_swap_b32 v140, v142
v_permlane16_swap_b32 v141, v143
v_lshlrev_b32 v96, 16, v128
v_and_b32 v97, 0xffff0000, v128
v_lshlrev_b32 v98, 16, v129
v_and_b32 v99, 0xffff0000, v129
v_lshlrev_b32 v100, 16, v130
v_and_b32 v101, 0xffff0000, v130
v_lshlrev_b32 v102, 16, v131
v_and_b32 v103, 0xffff0000, v131
v_lshlrev_b32 v104, 16, v132
v_and_b32 v105, 0xffff0000, v132
v_lshlrev_b32 v106, 16, v133
v_and_b32 v107, 0xffff0000, v133
v_lshlrev_b32 v108, 16, v134
v_and_b32 v109, 0xffff0000, v134
v_lshlrev_b32 v110, 16, v135
v_and_b32 v111, 0xffff0000, v135
v_lshlrev_b32 v112, 16, v136
v_and_b32 v113, 0xffff0000, v136
v_lshlrev_b32 v114, 16, v137
v_and_b32 v115, 0xffff0000, v137
v_lshlrev_b32 v116, 16, v138
v_and_b32 v117, 0xffff0000, v138
v_lshlrev_b32 v118, 16, v139
v_and_b32 v119, 0xffff0000, v139
v_lshlrev_b32 v120, 16, v140
v_and_b32 v121, 0xffff0000, v140
v_lshlrev_b32 v122, 16, v141
v_and_b32 v123, 0xffff0000, v141
v_lshlrev_b32 v124, 16, v142
v_and_b32 v125, 0xffff0000, v142
v_lshlrev_b32 v126, 16, v143
v_and_b32 v127, 0xffff0000, v143
s_cmp_lg_u32 s36, 0
s_cbranch_scc1 Lwm_102
s_nop 0
s_branch Lwe_101
Lwm_102:
s_cmp_lg_u32 s36, 1
s_cbranch_scc1 Lwm_103
s_nop 0
s_branch Lwe_101
Lwm_103:
s_cmp_lg_u32 s36, 2
s_cbranch_scc1 Lwm_104
s_nop 0
s_branch Lwe_101
Lwm_104:
s_cmp_lg_u32 s36, 3
s_cbranch_scc1 Lwm_105
s_nop 0
s_branch Lwe_101
Lwm_105:
Lwe_101:
s_barrier
ds_read_b128 v[32:35], v2 offset:0
ds_read_b64_tr_b16 v[40:41], v16 offset:0
ds_read_b64_tr_b16 v[42:43], v16 offset:2048
ds_read_b64_tr_b16 v[44:45], v17 offset:0
ds_read_b64_tr_b16 v[46:47], v17 offset:2048
ds_read_b64_tr_b16 v[48:49], v18 offset:0
ds_read_b64_tr_b16 v[50:51], v18 offset:2048
ds_read_b64_tr_b16 v[52:53], v19 offset:0
ds_read_b64_tr_b16 v[54:55], v19 offset:2048
ds_read_b128 v[36:39], v2 offset:1024
ds_read_b128 v[56:59], v2 offset:8192
ds_read_b64_tr_b16 v[64:65], v16 offset:4096
ds_read_b64_tr_b16 v[66:67], v16 offset:6144
ds_read_b64_tr_b16 v[68:69], v17 offset:4096
ds_read_b64_tr_b16 v[70:71], v17 offset:6144
ds_read_b64_tr_b16 v[72:73], v18 offset:4096
ds_read_b64_tr_b16 v[74:75], v18 offset:6144
ds_read_b64_tr_b16 v[76:77], v19 offset:4096
ds_read_b64_tr_b16 v[78:79], v19 offset:6144
ds_read_b128 v[60:63], v2 offset:9216
s_waitcnt lgkmcnt(0)
s_barrier
v_mfma_f32_16x16x32_bf16 v[96:99], v[40:43], v[32:35], v[96:99]
ds_read_b128 v[144:147], v2 offset:49152
ds_read_b64_tr_b16 v[152:153], v16 offset:8192
v_mfma_f32_16x16x32_bf16 v[100:103], v[44:47], v[32:35], v[100:103]
ds_read_b64_tr_b16 v[154:155], v16 offset:10240
ds_read_b64_tr_b16 v[156:157], v17 offset:8192
v_mfma_f32_16x16x32_bf16 v[104:107], v[48:51], v[32:35], v[104:107]
ds_read_b64_tr_b16 v[158:159], v17 offset:10240
ds_read_b64_tr_b16 v[160:161], v18 offset:8192
v_mfma_f32_16x16x32_bf16 v[108:111], v[52:55], v[32:35], v[108:111]
ds_read_b64_tr_b16 v[162:163], v18 offset:10240
ds_read_b64_tr_b16 v[164:165], v19 offset:8192
v_mfma_f32_16x16x32_bf16 v[124:127], v[52:55], v[36:39], v[124:127]
ds_read_b64_tr_b16 v[166:167], v19 offset:10240
ds_read_b128 v[148:151], v2 offset:50176
v_mfma_f32_16x16x32_bf16 v[120:123], v[48:51], v[36:39], v[120:123]
ds_read_b128 v[168:171], v2 offset:57344
ds_read_b64_tr_b16 v[176:177], v16 offset:12288
v_mfma_f32_16x16x32_bf16 v[116:119], v[44:47], v[36:39], v[116:119]
ds_read_b64_tr_b16 v[178:179], v16 offset:14336
ds_read_b64_tr_b16 v[180:181], v17 offset:12288
v_mfma_f32_16x16x32_bf16 v[112:115], v[40:43], v[36:39], v[112:115]
ds_read_b64_tr_b16 v[182:183], v17 offset:14336
ds_read_b64_tr_b16 v[184:185], v18 offset:12288
v_mfma_f32_16x16x32_bf16 v[96:99], v[64:67], v[56:59], v[96:99]
ds_read_b64_tr_b16 v[186:187], v18 offset:14336
ds_read_b64_tr_b16 v[188:189], v19 offset:12288
v_mfma_f32_16x16x32_bf16 v[100:103], v[68:71], v[56:59], v[100:103]
ds_read_b64_tr_b16 v[190:191], v19 offset:14336
ds_read_b128 v[172:175], v2 offset:58368
v_mfma_f32_16x16x32_bf16 v[104:107], v[72:75], v[56:59], v[104:107]
s_bitcmp0_b32 s36, 1
s_branch Lov_5
.p2align 12
.fill 32, 4, 0xbf800000
Lst_5_0:
s_branch Lwr_165
s_nop 0
s_nop 0
Lov_5:
v_mfma_f32_16x16x32_bf16 v[108:111], v[76:79], v[56:59], v[108:111]
s_cselect_b32 s44, s72, s74
v_mfma_f32_16x16x32_bf16 v[124:127], v[76:79], v[60:63], v[124:127]
s_cselect_b32 s45, s73, s75
v_mfma_f32_16x16x32_bf16 v[120:123], v[72:75], v[60:63], v[120:123]
s_mul_i32 s43, s35, 192
v_mfma_f32_16x16x32_bf16 v[116:119], v[68:71], v[60:63], v[116:119]
s_add_u32 s16, s44, s43
v_mfma_f32_16x16x32_bf16 v[112:115], v[64:67], v[60:63], v[112:115]
s_addc_u32 s17, s45, 0
s_waitcnt lgkmcnt(0)
s_barrier
v_mfma_f32_16x16x32_bf16 v[96:99], v[152:155], v[144:147], v[96:99]
ds_read_b128 v[32:35], v3 offset:0
ds_read_b64_tr_b16 v[40:41], v16 offset:16384
v_mfma_f32_16x16x32_bf16 v[100:103], v[156:159], v[144:147], v[100:103]
ds_read_b64_tr_b16 v[42:43], v16 offset:18432
ds_read_b64_tr_b16 v[44:45], v17 offset:16384
v_mfma_f32_16x16x32_bf16 v[104:107], v[160:163], v[144:147], v[104:107]
ds_read_b64_tr_b16 v[46:47], v17 offset:18432
ds_read_b64_tr_b16 v[48:49], v18 offset:16384
v_mfma_f32_16x16x32_bf16 v[108:111], v[164:167], v[144:147], v[108:111]
ds_read_b64_tr_b16 v[50:51], v18 offset:18432
ds_read_b64_tr_b16 v[52:53], v19 offset:16384
v_mfma_f32_16x16x32_bf16 v[124:127], v[164:167], v[148:151], v[124:127]
ds_read_b64_tr_b16 v[54:55], v19 offset:18432
ds_read_b128 v[36:39], v3 offset:1024
v_mfma_f32_16x16x32_bf16 v[120:123], v[160:163], v[148:151], v[120:123]
ds_read_b128 v[56:59], v3 offset:8192
ds_read_b64_tr_b16 v[64:65], v16 offset:20480
v_mfma_f32_16x16x32_bf16 v[116:119], v[156:159], v[148:151], v[116:119]
ds_read_b64_tr_b16 v[66:67], v16 offset:22528
ds_read_b64_tr_b16 v[68:69], v17 offset:20480
v_mfma_f32_16x16x32_bf16 v[112:115], v[152:155], v[148:151], v[112:115]
ds_read_b64_tr_b16 v[70:71], v17 offset:22528
ds_read_b64_tr_b16 v[72:73], v18 offset:20480
v_mfma_f32_16x16x32_bf16 v[96:99], v[176:179], v[168:171], v[96:99]
ds_read_b64_tr_b16 v[74:75], v18 offset:22528
ds_read_b64_tr_b16 v[76:77], v19 offset:20480
v_mfma_f32_16x16x32_bf16 v[100:103], v[180:183], v[168:171], v[100:103]
ds_read_b64_tr_b16 v[78:79], v19 offset:22528
ds_read_b128 v[60:63], v3 offset:9216
v_mfma_f32_16x16x32_bf16 v[104:107], v[184:187], v[168:171], v[104:107]
s_add_u32 s16, s16, 4096
v_mfma_f32_16x16x32_bf16 v[108:111], v[188:191], v[168:171], v[108:111]
s_addc_u32 s17, s17, 0
v_mfma_f32_16x16x32_bf16 v[124:127], v[188:191], v[172:175], v[124:127]
s_mov_b32 s18, 7333056
v_mfma_f32_16x16x32_bf16 v[120:123], v[184:187], v[172:175], v[120:123]
s_mov_b32 s19, 0x20000
v_mfma_f32_16x16x32_bf16 v[116:119], v[180:183], v[172:175], v[116:119]
s_and_b32 s43, s36, 1
v_mfma_f32_16x16x32_bf16 v[112:115], v[176:179], v[172:175], v[112:115]
s_mul_i32 s43, s43, 229376
s_waitcnt lgkmcnt(0)
s_barrier
v_mfma_f32_16x16x32_bf16 v[96:99], v[40:43], v[32:35], v[96:99]
ds_read_b128 v[144:147], v3 offset:49152
ds_read_b64_tr_b16 v[152:153], v16 offset:24576
v_mfma_f32_16x16x32_bf16 v[100:103], v[44:47], v[32:35], v[100:103]
ds_read_b64_tr_b16 v[154:155], v16 offset:26624
ds_read_b64_tr_b16 v[156:157], v17 offset:24576
v_mfma_f32_16x16x32_bf16 v[104:107], v[48:51], v[32:35], v[104:107]
ds_read_b64_tr_b16 v[158:159], v17 offset:26624
ds_read_b64_tr_b16 v[160:161], v18 offset:24576
v_mfma_f32_16x16x32_bf16 v[108:111], v[52:55], v[32:35], v[108:111]
ds_read_b64_tr_b16 v[162:163], v18 offset:26624
ds_read_b64_tr_b16 v[164:165], v19 offset:24576
v_mfma_f32_16x16x32_bf16 v[124:127], v[52:55], v[36:39], v[124:127]
ds_read_b64_tr_b16 v[166:167], v19 offset:26624
ds_read_b128 v[148:151], v3 offset:50176
v_mfma_f32_16x16x32_bf16 v[120:123], v[48:51], v[36:39], v[120:123]
ds_read_b128 v[168:171], v3 offset:57344
ds_read_b64_tr_b16 v[176:177], v16 offset:28672
v_mfma_f32_16x16x32_bf16 v[116:119], v[44:47], v[36:39], v[116:119]
ds_read_b64_tr_b16 v[178:179], v16 offset:30720
ds_read_b64_tr_b16 v[180:181], v17 offset:28672
v_mfma_f32_16x16x32_bf16 v[112:115], v[40:43], v[36:39], v[112:115]
ds_read_b64_tr_b16 v[182:183], v17 offset:30720
ds_read_b64_tr_b16 v[184:185], v18 offset:28672
v_mfma_f32_16x16x32_bf16 v[96:99], v[64:67], v[56:59], v[96:99]
ds_read_b64_tr_b16 v[186:187], v18 offset:30720
ds_read_b64_tr_b16 v[188:189], v19 offset:28672
v_mfma_f32_16x16x32_bf16 v[100:103], v[68:71], v[56:59], v[100:103]
ds_read_b64_tr_b16 v[190:191], v19 offset:30720
ds_read_b128 v[172:175], v3 offset:58368
v_mfma_f32_16x16x32_bf16 v[104:107], v[72:75], v[56:59], v[104:107]
v_add_u32 v196, 0, v1
v_mfma_f32_16x16x32_bf16 v[108:111], v[76:79], v[56:59], v[108:111]
v_mul_u32_u24 v197, 5462, v196
v_mfma_f32_16x16x32_bf16 v[124:127], v[76:79], v[60:63], v[124:127]
v_lshrrev_b32 v197, 16, v197
v_mfma_f32_16x16x32_bf16 v[120:123], v[72:75], v[60:63], v[120:123]
v_mul_u32_u24 v198, 12, v197
v_mfma_f32_16x16x32_bf16 v[116:119], v[68:71], v[60:63], v[116:119]
v_sub_u32 v198, v196, v198
v_mfma_f32_16x16x32_bf16 v[112:115], v[64:67], v[60:63], v[112:115]
v_bfe_u32 v199, v197, 2, 1
s_waitcnt lgkmcnt(0)
s_barrier
v_mfma_f32_16x16x32_bf16 v[96:99], v[152:155], v[144:147], v[96:99]
ds_read_b128 v[32:35], v2 offset:0
ds_read_b64_tr_b16 v[40:41], v16 offset:49152
v_mfma_f32_16x16x32_bf16 v[100:103], v[156:159], v[144:147], v[100:103]
ds_read_b64_tr_b16 v[42:43], v16 offset:51200
ds_read_b64_tr_b16 v[44:45], v17 offset:49152
v_mfma_f32_16x16x32_bf16 v[104:107], v[160:163], v[144:147], v[104:107]
ds_read_b64_tr_b16 v[46:47], v17 offset:51200
ds_read_b64_tr_b16 v[48:49], v18 offset:49152
v_mfma_f32_16x16x32_bf16 v[108:111], v[164:167], v[144:147], v[108:111]
ds_read_b64_tr_b16 v[50:51], v18 offset:51200
ds_read_b64_tr_b16 v[52:53], v19 offset:49152
v_mfma_f32_16x16x32_bf16 v[124:127], v[164:167], v[148:151], v[124:127]
ds_read_b64_tr_b16 v[54:55], v19 offset:51200
ds_read_b128 v[36:39], v2 offset:1024
v_mfma_f32_16x16x32_bf16 v[120:123], v[160:163], v[148:151], v[120:123]
ds_read_b128 v[56:59], v2 offset:8192
ds_read_b64_tr_b16 v[64:65], v16 offset:53248
v_mfma_f32_16x16x32_bf16 v[116:119], v[156:159], v[148:151], v[116:119]
ds_read_b64_tr_b16 v[66:67], v16 offset:55296
ds_read_b64_tr_b16 v[68:69], v17 offset:53248
v_mfma_f32_16x16x32_bf16 v[112:115], v[152:155], v[148:151], v[112:115]
ds_read_b64_tr_b16 v[70:71], v17 offset:55296
ds_read_b64_tr_b16 v[72:73], v18 offset:53248
v_mfma_f32_16x16x32_bf16 v[96:99], v[176:179], v[168:171], v[96:99]
ds_read_b64_tr_b16 v[74:75], v18 offset:55296
ds_read_b64_tr_b16 v[76:77], v19 offset:53248
v_mfma_f32_16x16x32_bf16 v[100:103], v[180:183], v[168:171], v[100:103]
ds_read_b64_tr_b16 v[78:79], v19 offset:55296
ds_read_b128 v[60:63], v2 offset:9216
v_mfma_f32_16x16x32_bf16 v[104:107], v[184:187], v[168:171], v[104:107]
v_cmp_gt_u32 vcc, 8, v198
v_mfma_f32_16x16x32_bf16 v[108:111], v[188:191], v[168:171], v[108:111]
v_lshlrev_b32 v200, 1, v199
v_mfma_f32_16x16x32_bf16 v[124:127], v[188:191], v[172:175], v[124:127]
v_mul_u32_u24 v197, 7168, v197
v_mfma_f32_16x16x32_bf16 v[120:123], v[184:187], v[172:175], v[120:123]
v_cndmask_b32 v199, v199, v200, vcc
v_mfma_f32_16x16x32_bf16 v[116:119], v[180:183], v[172:175], v[116:119]
v_xor_b32 v198, v198, v199
v_mfma_f32_16x16x32_bf16 v[112:115], v[176:179], v[172:175], v[112:115]
v_lshl_add_u32 v192, v198, 4, v197
s_waitcnt lgkmcnt(0)
s_barrier
v_mfma_f32_16x16x32_bf16 v[96:99], v[40:43], v[32:35], v[96:99]
ds_read_b128 v[144:147], v2 offset:49152
ds_read_b64_tr_b16 v[152:153], v16 offset:57344
v_mfma_f32_16x16x32_bf16 v[100:103], v[44:47], v[32:35], v[100:103]
ds_read_b64_tr_b16 v[154:155], v16 offset:59392
ds_read_b64_tr_b16 v[156:157], v17 offset:57344
v_mfma_f32_16x16x32_bf16 v[104:107], v[48:51], v[32:35], v[104:107]
ds_read_b64_tr_b16 v[158:159], v17 offset:59392
ds_read_b64_tr_b16 v[160:161], v18 offset:57344
v_mfma_f32_16x16x32_bf16 v[108:111], v[52:55], v[32:35], v[108:111]
ds_read_b64_tr_b16 v[162:163], v18 offset:59392
ds_read_b64_tr_b16 v[164:165], v19 offset:57344
v_mfma_f32_16x16x32_bf16 v[124:127], v[52:55], v[36:39], v[124:127]
ds_read_b64_tr_b16 v[166:167], v19 offset:59392
ds_read_b128 v[148:151], v2 offset:50176
v_mfma_f32_16x16x32_bf16 v[120:123], v[48:51], v[36:39], v[120:123]
ds_read_b128 v[168:171], v2 offset:57344
ds_read_b64_tr_b16 v[176:177], v16 offset:61440
v_mfma_f32_16x16x32_bf16 v[116:119], v[44:47], v[36:39], v[116:119]
ds_read_b64_tr_b16 v[178:179], v16 offset:63488
ds_read_b64_tr_b16 v[180:181], v17 offset:61440
v_mfma_f32_16x16x32_bf16 v[112:115], v[40:43], v[36:39], v[112:115]
ds_read_b64_tr_b16 v[182:183], v17 offset:63488
ds_read_b64_tr_b16 v[184:185], v18 offset:61440
v_mfma_f32_16x16x32_bf16 v[96:99], v[64:67], v[56:59], v[96:99]
ds_read_b64_tr_b16 v[186:187], v18 offset:63488
ds_read_b64_tr_b16 v[188:189], v19 offset:61440
v_mfma_f32_16x16x32_bf16 v[100:103], v[68:71], v[56:59], v[100:103]
ds_read_b64_tr_b16 v[190:191], v19 offset:63488
ds_read_b128 v[172:175], v2 offset:58368
v_mfma_f32_16x16x32_bf16 v[104:107], v[72:75], v[56:59], v[104:107]
v_add_u32 v196, 64, v1
v_mfma_f32_16x16x32_bf16 v[108:111], v[76:79], v[56:59], v[108:111]
v_mul_u32_u24 v197, 5462, v196
v_mfma_f32_16x16x32_bf16 v[124:127], v[76:79], v[60:63], v[124:127]
v_lshrrev_b32 v197, 16, v197
v_mfma_f32_16x16x32_bf16 v[120:123], v[72:75], v[60:63], v[120:123]
v_mul_u32_u24 v198, 12, v197
v_mfma_f32_16x16x32_bf16 v[116:119], v[68:71], v[60:63], v[116:119]
v_sub_u32 v198, v196, v198
v_mfma_f32_16x16x32_bf16 v[112:115], v[64:67], v[60:63], v[112:115]
v_bfe_u32 v199, v197, 2, 1
s_waitcnt lgkmcnt(0)
s_barrier
v_mfma_f32_16x16x32_bf16 v[96:99], v[152:155], v[144:147], v[96:99]
ds_read_b128 v[32:35], v3 offset:0
ds_read_b64_tr_b16 v[40:41], v20 offset:0
v_mfma_f32_16x16x32_bf16 v[100:103], v[156:159], v[144:147], v[100:103]
ds_read_b64_tr_b16 v[42:43], v20 offset:2048
ds_read_b64_tr_b16 v[44:45], v21 offset:0
v_mfma_f32_16x16x32_bf16 v[104:107], v[160:163], v[144:147], v[104:107]
ds_read_b64_tr_b16 v[46:47], v21 offset:2048
ds_read_b64_tr_b16 v[48:49], v22 offset:0
v_mfma_f32_16x16x32_bf16 v[108:111], v[164:167], v[144:147], v[108:111]
ds_read_b64_tr_b16 v[50:51], v22 offset:2048
ds_read_b64_tr_b16 v[52:53], v23 offset:0
v_mfma_f32_16x16x32_bf16 v[124:127], v[164:167], v[148:151], v[124:127]
ds_read_b64_tr_b16 v[54:55], v23 offset:2048
ds_read_b128 v[36:39], v3 offset:1024
v_mfma_f32_16x16x32_bf16 v[120:123], v[160:163], v[148:151], v[120:123]
ds_read_b128 v[56:59], v3 offset:8192
ds_read_b64_tr_b16 v[64:65], v20 offset:4096
v_mfma_f32_16x16x32_bf16 v[116:119], v[156:159], v[148:151], v[116:119]
ds_read_b64_tr_b16 v[66:67], v20 offset:6144
ds_read_b64_tr_b16 v[68:69], v21 offset:4096
v_mfma_f32_16x16x32_bf16 v[112:115], v[152:155], v[148:151], v[112:115]
ds_read_b64_tr_b16 v[70:71], v21 offset:6144
ds_read_b64_tr_b16 v[72:73], v22 offset:4096
v_mfma_f32_16x16x32_bf16 v[96:99], v[176:179], v[168:171], v[96:99]
ds_read_b64_tr_b16 v[74:75], v22 offset:6144
ds_read_b64_tr_b16 v[76:77], v23 offset:4096
v_mfma_f32_16x16x32_bf16 v[100:103], v[180:183], v[168:171], v[100:103]
ds_read_b64_tr_b16 v[78:79], v23 offset:6144
ds_read_b128 v[60:63], v3 offset:9216
v_mfma_f32_16x16x32_bf16 v[104:107], v[184:187], v[168:171], v[104:107]
v_cmp_gt_u32 vcc, 8, v198
v_mfma_f32_16x16x32_bf16 v[108:111], v[188:191], v[168:171], v[108:111]
v_lshlrev_b32 v200, 1, v199
v_mfma_f32_16x16x32_bf16 v[124:127], v[188:191], v[172:175], v[124:127]
v_mul_u32_u24 v197, 7168, v197
v_mfma_f32_16x16x32_bf16 v[120:123], v[184:187], v[172:175], v[120:123]
v_cndmask_b32 v199, v199, v200, vcc
v_mfma_f32_16x16x32_bf16 v[116:119], v[180:183], v[172:175], v[116:119]
v_xor_b32 v198, v198, v199
v_mfma_f32_16x16x32_bf16 v[112:115], v[176:179], v[172:175], v[112:115]
v_lshl_add_u32 v193, v198, 4, v197
s_waitcnt lgkmcnt(0)
s_barrier
v_mfma_f32_16x16x32_bf16 v[96:99], v[40:43], v[32:35], v[96:99]
ds_read_b128 v[144:147], v3 offset:49152
ds_read_b64_tr_b16 v[152:153], v20 offset:8192
v_mfma_f32_16x16x32_bf16 v[100:103], v[44:47], v[32:35], v[100:103]
ds_read_b64_tr_b16 v[154:155], v20 offset:10240
ds_read_b64_tr_b16 v[156:157], v21 offset:8192
v_mfma_f32_16x16x32_bf16 v[104:107], v[48:51], v[32:35], v[104:107]
ds_read_b64_tr_b16 v[158:159], v21 offset:10240
ds_read_b64_tr_b16 v[160:161], v22 offset:8192
v_mfma_f32_16x16x32_bf16 v[108:111], v[52:55], v[32:35], v[108:111]
ds_read_b64_tr_b16 v[162:163], v22 offset:10240
ds_read_b64_tr_b16 v[164:165], v23 offset:8192
v_mfma_f32_16x16x32_bf16 v[124:127], v[52:55], v[36:39], v[124:127]
ds_read_b64_tr_b16 v[166:167], v23 offset:10240
ds_read_b128 v[148:151], v3 offset:50176
v_mfma_f32_16x16x32_bf16 v[120:123], v[48:51], v[36:39], v[120:123]
ds_read_b128 v[168:171], v3 offset:57344
ds_read_b64_tr_b16 v[176:177], v20 offset:12288
v_mfma_f32_16x16x32_bf16 v[116:119], v[44:47], v[36:39], v[116:119]
ds_read_b64_tr_b16 v[178:179], v20 offset:14336
ds_read_b64_tr_b16 v[180:181], v21 offset:12288
v_mfma_f32_16x16x32_bf16 v[112:115], v[40:43], v[36:39], v[112:115]
ds_read_b64_tr_b16 v[182:183], v21 offset:14336
ds_read_b64_tr_b16 v[184:185], v22 offset:12288
v_mfma_f32_16x16x32_bf16 v[96:99], v[64:67], v[56:59], v[96:99]
ds_read_b64_tr_b16 v[186:187], v22 offset:14336
ds_read_b64_tr_b16 v[188:189], v23 offset:12288
v_mfma_f32_16x16x32_bf16 v[100:103], v[68:71], v[56:59], v[100:103]
ds_read_b64_tr_b16 v[190:191], v23 offset:14336
ds_read_b128 v[172:175], v3 offset:58368
v_mfma_f32_16x16x32_bf16 v[104:107], v[72:75], v[56:59], v[104:107]
v_add_u32 v196, 128, v1
v_mfma_f32_16x16x32_bf16 v[108:111], v[76:79], v[56:59], v[108:111]
v_mul_u32_u24 v197, 5462, v196
v_mfma_f32_16x16x32_bf16 v[124:127], v[76:79], v[60:63], v[124:127]
v_lshrrev_b32 v197, 16, v197
v_mfma_f32_16x16x32_bf16 v[120:123], v[72:75], v[60:63], v[120:123]
v_mul_u32_u24 v198, 12, v197
v_mfma_f32_16x16x32_bf16 v[116:119], v[68:71], v[60:63], v[116:119]
v_sub_u32 v198, v196, v198
v_mfma_f32_16x16x32_bf16 v[112:115], v[64:67], v[60:63], v[112:115]
v_bfe_u32 v199, v197, 2, 1
s_waitcnt lgkmcnt(0)
s_barrier
v_mfma_f32_16x16x32_bf16 v[96:99], v[152:155], v[144:147], v[96:99]
ds_read_b128 v[32:35], v2 offset:0
ds_read_b64_tr_b16 v[40:41], v4 offset:16384
v_mfma_f32_16x16x32_bf16 v[100:103], v[156:159], v[144:147], v[100:103]
ds_read_b64_tr_b16 v[42:43], v4 offset:18432
ds_read_b64_tr_b16 v[44:45], v5 offset:16384
v_mfma_f32_16x16x32_bf16 v[104:107], v[160:163], v[144:147], v[104:107]
ds_read_b64_tr_b16 v[46:47], v5 offset:18432
ds_read_b64_tr_b16 v[48:49], v6 offset:16384
v_mfma_f32_16x16x32_bf16 v[108:111], v[164:167], v[144:147], v[108:111]
ds_read_b64_tr_b16 v[50:51], v6 offset:18432
ds_read_b64_tr_b16 v[52:53], v7 offset:16384
v_mfma_f32_16x16x32_bf16 v[124:127], v[164:167], v[148:151], v[124:127]
ds_read_b64_tr_b16 v[54:55], v7 offset:18432
ds_read_b128 v[36:39], v2 offset:1024
v_mfma_f32_16x16x32_bf16 v[120:123], v[160:163], v[148:151], v[120:123]
ds_read_b128 v[56:59], v2 offset:8192
ds_read_b64_tr_b16 v[64:65], v4 offset:20480
v_mfma_f32_16x16x32_bf16 v[116:119], v[156:159], v[148:151], v[116:119]
ds_read_b64_tr_b16 v[66:67], v4 offset:22528
ds_read_b64_tr_b16 v[68:69], v5 offset:20480
v_mfma_f32_16x16x32_bf16 v[112:115], v[152:155], v[148:151], v[112:115]
ds_read_b64_tr_b16 v[70:71], v5 offset:22528
ds_read_b64_tr_b16 v[72:73], v6 offset:20480
v_mfma_f32_16x16x32_bf16 v[96:99], v[176:179], v[168:171], v[96:99]
ds_read_b64_tr_b16 v[74:75], v6 offset:22528
ds_read_b64_tr_b16 v[76:77], v7 offset:20480
v_mfma_f32_16x16x32_bf16 v[100:103], v[180:183], v[168:171], v[100:103]
ds_read_b64_tr_b16 v[78:79], v7 offset:22528
ds_read_b128 v[60:63], v2 offset:9216
v_mfma_f32_16x16x32_bf16 v[104:107], v[184:187], v[168:171], v[104:107]
v_cmp_gt_u32 vcc, 8, v198
v_mfma_f32_16x16x32_bf16 v[108:111], v[188:191], v[168:171], v[108:111]
v_lshlrev_b32 v200, 1, v199
v_mfma_f32_16x16x32_bf16 v[124:127], v[188:191], v[172:175], v[124:127]
v_mul_u32_u24 v197, 7168, v197
v_mfma_f32_16x16x32_bf16 v[120:123], v[184:187], v[172:175], v[120:123]
v_cndmask_b32 v199, v199, v200, vcc
v_mfma_f32_16x16x32_bf16 v[116:119], v[180:183], v[172:175], v[116:119]
v_xor_b32 v198, v198, v199
v_mfma_f32_16x16x32_bf16 v[112:115], v[176:179], v[172:175], v[112:115]
v_lshl_add_u32 v194, v198, 4, v197
s_waitcnt lgkmcnt(0)
s_barrier
v_mfma_f32_16x16x32_bf16 v[96:99], v[40:43], v[32:35], v[96:99]
ds_read_b128 v[144:147], v2 offset:49152
ds_read_b64_tr_b16 v[152:153], v4 offset:24576
v_mfma_f32_16x16x32_bf16 v[100:103], v[44:47], v[32:35], v[100:103]
ds_read_b64_tr_b16 v[154:155], v4 offset:26624
ds_read_b64_tr_b16 v[156:157], v5 offset:24576
v_mfma_f32_16x16x32_bf16 v[104:107], v[48:51], v[32:35], v[104:107]
ds_read_b64_tr_b16 v[158:159], v5 offset:26624
ds_read_b64_tr_b16 v[160:161], v6 offset:24576
v_mfma_f32_16x16x32_bf16 v[108:111], v[52:55], v[32:35], v[108:111]
ds_read_b64_tr_b16 v[162:163], v6 offset:26624
ds_read_b64_tr_b16 v[164:165], v7 offset:24576
v_mfma_f32_16x16x32_bf16 v[124:127], v[52:55], v[36:39], v[124:127]
ds_read_b64_tr_b16 v[166:167], v7 offset:26624
ds_read_b128 v[148:151], v2 offset:50176
v_mfma_f32_16x16x32_bf16 v[120:123], v[48:51], v[36:39], v[120:123]
ds_read_b128 v[168:171], v2 offset:57344
ds_read_b64_tr_b16 v[176:177], v4 offset:28672
v_mfma_f32_16x16x32_bf16 v[116:119], v[44:47], v[36:39], v[116:119]
ds_read_b64_tr_b16 v[178:179], v4 offset:30720
ds_read_b64_tr_b16 v[180:181], v5 offset:28672
v_mfma_f32_16x16x32_bf16 v[112:115], v[40:43], v[36:39], v[112:115]
ds_read_b64_tr_b16 v[182:183], v5 offset:30720
ds_read_b64_tr_b16 v[184:185], v6 offset:28672
v_mfma_f32_16x16x32_bf16 v[96:99], v[64:67], v[56:59], v[96:99]
ds_read_b64_tr_b16 v[186:187], v6 offset:30720
ds_read_b64_tr_b16 v[188:189], v7 offset:28672
v_mfma_f32_16x16x32_bf16 v[100:103], v[68:71], v[56:59], v[100:103]
ds_read_b64_tr_b16 v[190:191], v7 offset:30720
ds_read_b128 v[172:175], v2 offset:58368
v_mfma_f32_16x16x32_bf16 v[104:107], v[72:75], v[56:59], v[104:107]
v_add_u32 v192, s43, v192
v_mfma_f32_16x16x32_bf16 v[108:111], v[76:79], v[56:59], v[108:111]
v_add_u32 v193, s43, v193
v_mfma_f32_16x16x32_bf16 v[124:127], v[76:79], v[60:63], v[124:127]
v_add_u32 v194, s43, v194
v_mfma_f32_16x16x32_bf16 v[120:123], v[72:75], v[60:63], v[120:123]
s_and_b32 s43, s36, 3
v_mfma_f32_16x16x32_bf16 v[116:119], v[68:71], v[60:63], v[116:119]
s_mul_i32 s50, s43, 6144
v_mfma_f32_16x16x32_bf16 v[112:115], v[64:67], v[60:63], v[112:115]
s_add_u32 s50, s50, 16384
s_waitcnt lgkmcnt(0)
s_barrier
v_mfma_f32_16x16x32_bf16 v[96:99], v[152:155], v[144:147], v[96:99]
ds_read_b128 v[32:35], v3 offset:0
ds_read_b64_tr_b16 v[40:41], v4 offset:32768
v_mfma_f32_16x16x32_bf16 v[100:103], v[156:159], v[144:147], v[100:103]
ds_read_b64_tr_b16 v[42:43], v4 offset:34816
ds_read_b64_tr_b16 v[44:45], v5 offset:32768
v_mfma_f32_16x16x32_bf16 v[104:107], v[160:163], v[144:147], v[104:107]
ds_read_b64_tr_b16 v[46:47], v5 offset:34816
ds_read_b64_tr_b16 v[48:49], v6 offset:32768
v_mfma_f32_16x16x32_bf16 v[108:111], v[164:167], v[144:147], v[108:111]
ds_read_b64_tr_b16 v[50:51], v6 offset:34816
ds_read_b64_tr_b16 v[52:53], v7 offset:32768
v_mfma_f32_16x16x32_bf16 v[124:127], v[164:167], v[148:151], v[124:127]
ds_read_b64_tr_b16 v[54:55], v7 offset:34816
ds_read_b128 v[36:39], v3 offset:1024
v_mfma_f32_16x16x32_bf16 v[120:123], v[160:163], v[148:151], v[120:123]
ds_read_b128 v[56:59], v3 offset:8192
ds_read_b64_tr_b16 v[64:65], v4 offset:36864
v_mfma_f32_16x16x32_bf16 v[116:119], v[156:159], v[148:151], v[116:119]
ds_read_b64_tr_b16 v[66:67], v4 offset:38912
ds_read_b64_tr_b16 v[68:69], v5 offset:36864
v_mfma_f32_16x16x32_bf16 v[112:115], v[152:155], v[148:151], v[112:115]
ds_read_b64_tr_b16 v[70:71], v5 offset:38912
ds_read_b64_tr_b16 v[72:73], v6 offset:36864
v_mfma_f32_16x16x32_bf16 v[96:99], v[176:179], v[168:171], v[96:99]
ds_read_b64_tr_b16 v[74:75], v6 offset:38912
ds_read_b64_tr_b16 v[76:77], v7 offset:36864
v_mfma_f32_16x16x32_bf16 v[100:103], v[180:183], v[168:171], v[100:103]
ds_read_b64_tr_b16 v[78:79], v7 offset:38912
ds_read_b128 v[60:63], v3 offset:9216
v_mfma_f32_16x16x32_bf16 v[104:107], v[184:187], v[168:171], v[104:107]
s_bitcmp0_b32 s2, 0
v_mfma_f32_16x16x32_bf16 v[108:111], v[188:191], v[168:171], v[108:111]
s_cselect_b32 s88, s72, s74
v_mfma_f32_16x16x32_bf16 v[124:127], v[188:191], v[172:175], v[124:127]
s_cselect_b32 s89, s73, s75
v_mfma_f32_16x16x32_bf16 v[120:123], v[184:187], v[172:175], v[120:123]
s_mov_b32 s90, 7340032
v_mfma_f32_16x16x32_bf16 v[116:119], v[180:183], v[172:175], v[116:119]
s_mov_b32 s91, 0x20000
v_mfma_f32_16x16x32_bf16 v[112:115], v[176:179], v[172:175], v[112:115]
s_bfe_u32 s44, s2, 0x30001
s_waitcnt lgkmcnt(0)
s_barrier
v_mfma_f32_16x16x32_bf16 v[96:99], v[40:43], v[32:35], v[96:99]
ds_read_b128 v[144:147], v3 offset:49152
ds_read_b64_tr_b16 v[152:153], v4 offset:40960
v_mfma_f32_16x16x32_bf16 v[100:103], v[44:47], v[32:35], v[100:103]
ds_read_b64_tr_b16 v[154:155], v4 offset:43008
ds_read_b64_tr_b16 v[156:157], v5 offset:40960
v_mfma_f32_16x16x32_bf16 v[104:107], v[48:51], v[32:35], v[104:107]
ds_read_b64_tr_b16 v[158:159], v5 offset:43008
ds_read_b64_tr_b16 v[160:161], v6 offset:40960
v_mfma_f32_16x16x32_bf16 v[108:111], v[52:55], v[32:35], v[108:111]
ds_read_b64_tr_b16 v[162:163], v6 offset:43008
ds_read_b64_tr_b16 v[164:165], v7 offset:40960
v_mfma_f32_16x16x32_bf16 v[124:127], v[52:55], v[36:39], v[124:127]
ds_read_b64_tr_b16 v[166:167], v7 offset:43008
ds_read_b128 v[148:151], v3 offset:50176
v_mfma_f32_16x16x32_bf16 v[120:123], v[48:51], v[36:39], v[120:123]
ds_read_b128 v[168:171], v3 offset:57344
ds_read_b64_tr_b16 v[176:177], v4 offset:45056
v_mfma_f32_16x16x32_bf16 v[116:119], v[44:47], v[36:39], v[116:119]
ds_read_b64_tr_b16 v[178:179], v4 offset:47104
ds_read_b64_tr_b16 v[180:181], v5 offset:45056
v_mfma_f32_16x16x32_bf16 v[112:115], v[40:43], v[36:39], v[112:115]
ds_read_b64_tr_b16 v[182:183], v5 offset:47104
ds_read_b64_tr_b16 v[184:185], v6 offset:45056
v_mfma_f32_16x16x32_bf16 v[96:99], v[64:67], v[56:59], v[96:99]
ds_read_b64_tr_b16 v[186:187], v6 offset:47104
ds_read_b64_tr_b16 v[188:189], v7 offset:45056
v_mfma_f32_16x16x32_bf16 v[100:103], v[68:71], v[56:59], v[100:103]
ds_read_b64_tr_b16 v[190:191], v7 offset:47104
ds_read_b128 v[172:175], v3 offset:58368
v_mfma_f32_16x16x32_bf16 v[104:107], v[72:75], v[56:59], v[104:107]
s_lshl_b32 s44, s44, 2
v_mfma_f32_16x16x32_bf16 v[108:111], v[76:79], v[56:59], v[108:111]
s_and_b32 s43, s36, 3
v_mfma_f32_16x16x32_bf16 v[124:127], v[76:79], v[60:63], v[124:127]
s_add_u32 s44, s44, s43
v_mfma_f32_16x16x32_bf16 v[120:123], v[72:75], v[60:63], v[120:123]
s_lshl_b32 s44, s44, 5
v_mfma_f32_16x16x32_bf16 v[116:119], v[68:71], v[60:63], v[116:119]
v_lshrrev_b32 v195, 4, v1
v_mfma_f32_16x16x32_bf16 v[112:115], v[64:67], v[60:63], v[112:115]
v_add_u32 v195, s44, v195
s_waitcnt lgkmcnt(0)
s_barrier
v_mfma_f32_16x16x32_bf16 v[96:99], v[152:155], v[144:147], v[96:99]
ds_read_b128 v[32:35], v2 offset:0
ds_read_b64_tr_b16 v[40:41], v16 offset:49152
v_mfma_f32_16x16x32_bf16 v[100:103], v[156:159], v[144:147], v[100:103]
ds_read_b64_tr_b16 v[42:43], v16 offset:51200
ds_read_b64_tr_b16 v[44:45], v17 offset:49152
v_mfma_f32_16x16x32_bf16 v[104:107], v[160:163], v[144:147], v[104:107]
ds_read_b64_tr_b16 v[46:47], v17 offset:51200
ds_read_b64_tr_b16 v[48:49], v18 offset:49152
v_mfma_f32_16x16x32_bf16 v[108:111], v[164:167], v[144:147], v[108:111]
ds_read_b64_tr_b16 v[50:51], v18 offset:51200
ds_read_b64_tr_b16 v[52:53], v19 offset:49152
v_mfma_f32_16x16x32_bf16 v[124:127], v[164:167], v[148:151], v[124:127]
ds_read_b64_tr_b16 v[54:55], v19 offset:51200
ds_read_b128 v[36:39], v2 offset:1024
v_mfma_f32_16x16x32_bf16 v[120:123], v[160:163], v[148:151], v[120:123]
ds_read_b128 v[56:59], v2 offset:8192
ds_read_b64_tr_b16 v[64:65], v16 offset:53248
v_mfma_f32_16x16x32_bf16 v[116:119], v[156:159], v[148:151], v[116:119]
ds_read_b64_tr_b16 v[66:67], v16 offset:55296
ds_read_b64_tr_b16 v[68:69], v17 offset:53248
v_mfma_f32_16x16x32_bf16 v[112:115], v[152:155], v[148:151], v[112:115]
ds_read_b64_tr_b16 v[70:71], v17 offset:55296
ds_read_b64_tr_b16 v[72:73], v18 offset:53248
v_mfma_f32_16x16x32_bf16 v[96:99], v[176:179], v[168:171], v[96:99]
ds_read_b64_tr_b16 v[74:75], v18 offset:55296
ds_read_b64_tr_b16 v[76:77], v19 offset:53248
v_mfma_f32_16x16x32_bf16 v[100:103], v[180:183], v[168:171], v[100:103]
ds_read_b64_tr_b16 v[78:79], v19 offset:55296
ds_read_b128 v[60:63], v2 offset:9216
v_mfma_f32_16x16x32_bf16 v[104:107], v[184:187], v[168:171], v[104:107]
v_mul_u32_u24 v195, 7168, v195
v_mfma_f32_16x16x32_bf16 v[108:111], v[188:191], v[168:171], v[108:111]
v_and_b32 v196, 15, v1
v_mfma_f32_16x16x32_bf16 v[124:127], v[188:191], v[172:175], v[124:127]
v_lshl_add_u32 v195, v196, 4, v195
v_mfma_f32_16x16x32_bf16 v[120:123], v[184:187], v[172:175], v[120:123]
s_lshr_b32 s43, s2, 4
v_mfma_f32_16x16x32_bf16 v[116:119], v[180:183], v[172:175], v[116:119]
s_lshl_b32 s43, s43, 8
v_mfma_f32_16x16x32_bf16 v[112:115], v[176:179], v[172:175], v[112:115]
v_add_u32 v195, s43, v195
s_waitcnt lgkmcnt(0)
s_barrier
v_mfma_f32_16x16x32_bf16 v[96:99], v[40:43], v[32:35], v[96:99]
ds_read_b128 v[144:147], v2 offset:49152
ds_read_b64_tr_b16 v[152:153], v16 offset:57344
v_mfma_f32_16x16x32_bf16 v[100:103], v[44:47], v[32:35], v[100:103]
ds_read_b64_tr_b16 v[154:155], v16 offset:59392
ds_read_b64_tr_b16 v[156:157], v17 offset:57344
v_mfma_f32_16x16x32_bf16 v[104:107], v[48:51], v[32:35], v[104:107]
ds_read_b64_tr_b16 v[158:159], v17 offset:59392
ds_read_b64_tr_b16 v[160:161], v18 offset:57344
v_mfma_f32_16x16x32_bf16 v[108:111], v[52:55], v[32:35], v[108:111]
ds_read_b64_tr_b16 v[162:163], v18 offset:59392
ds_read_b64_tr_b16 v[164:165], v19 offset:57344
v_mfma_f32_16x16x32_bf16 v[124:127], v[52:55], v[36:39], v[124:127]
ds_read_b64_tr_b16 v[166:167], v19 offset:59392
ds_read_b128 v[148:151], v2 offset:50176
v_mfma_f32_16x16x32_bf16 v[120:123], v[48:51], v[36:39], v[120:123]
ds_read_b128 v[168:171], v2 offset:57344
ds_read_b64_tr_b16 v[176:177], v16 offset:61440
v_mfma_f32_16x16x32_bf16 v[116:119], v[44:47], v[36:39], v[116:119]
ds_read_b64_tr_b16 v[178:179], v16 offset:63488
ds_read_b64_tr_b16 v[180:181], v17 offset:61440
v_mfma_f32_16x16x32_bf16 v[112:115], v[40:43], v[36:39], v[112:115]
ds_read_b64_tr_b16 v[182:183], v17 offset:63488
ds_read_b64_tr_b16 v[184:185], v18 offset:61440
v_mfma_f32_16x16x32_bf16 v[96:99], v[64:67], v[56:59], v[96:99]
ds_read_b64_tr_b16 v[186:187], v18 offset:63488
ds_read_b64_tr_b16 v[188:189], v19 offset:61440
v_mfma_f32_16x16x32_bf16 v[100:103], v[68:71], v[56:59], v[100:103]
ds_read_b64_tr_b16 v[190:191], v19 offset:63488
ds_read_b128 v[172:175], v2 offset:58368
v_mfma_f32_16x16x32_bf16 v[104:107], v[72:75], v[56:59], v[104:107]
v_mfma_f32_16x16x32_bf16 v[108:111], v[76:79], v[56:59], v[108:111]
v_mfma_f32_16x16x32_bf16 v[124:127], v[76:79], v[60:63], v[124:127]
s_branch Lov_6
.p2align 12
.fill 48, 4, 0xbf800000
Lst_6_0:
s_branch Lwr_166
s_nop 0
s_nop 0
Lov_6:
v_mfma_f32_16x16x32_bf16 v[120:123], v[72:75], v[60:63], v[120:123]
v_mfma_f32_16x16x32_bf16 v[116:119], v[68:71], v[60:63], v[116:119]
v_mfma_f32_16x16x32_bf16 v[112:115], v[64:67], v[60:63], v[112:115]
s_waitcnt lgkmcnt(0)
s_barrier
v_mfma_f32_16x16x32_bf16 v[96:99], v[152:155], v[144:147], v[96:99]
ds_read_b128 v[32:35], v3 offset:0
ds_read_b64_tr_b16 v[40:41], v20 offset:0
v_mfma_f32_16x16x32_bf16 v[100:103], v[156:159], v[144:147], v[100:103]
ds_read_b64_tr_b16 v[42:43], v20 offset:2048
ds_read_b64_tr_b16 v[44:45], v21 offset:0
v_mfma_f32_16x16x32_bf16 v[104:107], v[160:163], v[144:147], v[104:107]
ds_read_b64_tr_b16 v[46:47], v21 offset:2048
ds_read_b64_tr_b16 v[48:49], v22 offset:0
v_mfma_f32_16x16x32_bf16 v[108:111], v[164:167], v[144:147], v[108:111]
ds_read_b64_tr_b16 v[50:51], v22 offset:2048
ds_read_b64_tr_b16 v[52:53], v23 offset:0
v_mfma_f32_16x16x32_bf16 v[124:127], v[164:167], v[148:151], v[124:127]
ds_read_b64_tr_b16 v[54:55], v23 offset:2048
ds_read_b128 v[36:39], v3 offset:1024
v_mfma_f32_16x16x32_bf16 v[120:123], v[160:163], v[148:151], v[120:123]
ds_read_b128 v[56:59], v3 offset:8192
ds_read_b64_tr_b16 v[64:65], v20 offset:4096
v_mfma_f32_16x16x32_bf16 v[116:119], v[156:159], v[148:151], v[116:119]
ds_read_b64_tr_b16 v[66:67], v20 offset:6144
ds_read_b64_tr_b16 v[68:69], v21 offset:4096
v_mfma_f32_16x16x32_bf16 v[112:115], v[152:155], v[148:151], v[112:115]
ds_read_b64_tr_b16 v[70:71], v21 offset:6144
ds_read_b64_tr_b16 v[72:73], v22 offset:4096
v_mfma_f32_16x16x32_bf16 v[96:99], v[176:179], v[168:171], v[96:99]
ds_read_b64_tr_b16 v[74:75], v22 offset:6144
ds_read_b64_tr_b16 v[76:77], v23 offset:4096
v_mfma_f32_16x16x32_bf16 v[100:103], v[180:183], v[168:171], v[100:103]
ds_read_b64_tr_b16 v[78:79], v23 offset:6144
ds_read_b128 v[60:63], v3 offset:9216
v_mfma_f32_16x16x32_bf16 v[104:107], v[184:187], v[168:171], v[104:107]
v_mfma_f32_16x16x32_bf16 v[108:111], v[188:191], v[168:171], v[108:111]
v_mfma_f32_16x16x32_bf16 v[124:127], v[188:191], v[172:175], v[124:127]
v_mfma_f32_16x16x32_bf16 v[120:123], v[184:187], v[172:175], v[120:123]
v_mfma_f32_16x16x32_bf16 v[116:119], v[180:183], v[172:175], v[116:119]
v_mfma_f32_16x16x32_bf16 v[112:115], v[176:179], v[172:175], v[112:115]
s_waitcnt lgkmcnt(0)
v_mfma_f32_16x16x32_bf16 v[96:99], v[40:43], v[32:35], v[96:99]
ds_read_b128 v[144:147], v3 offset:49152
ds_read_b64_tr_b16 v[152:153], v20 offset:8192
v_mfma_f32_16x16x32_bf16 v[100:103], v[44:47], v[32:35], v[100:103]
ds_read_b64_tr_b16 v[154:155], v20 offset:10240
ds_read_b64_tr_b16 v[156:157], v21 offset:8192
v_mfma_f32_16x16x32_bf16 v[104:107], v[48:51], v[32:35], v[104:107]
ds_read_b64_tr_b16 v[158:159], v21 offset:10240
ds_read_b64_tr_b16 v[160:161], v22 offset:8192
v_mfma_f32_16x16x32_bf16 v[108:111], v[52:55], v[32:35], v[108:111]
ds_read_b64_tr_b16 v[162:163], v22 offset:10240
ds_read_b64_tr_b16 v[164:165], v23 offset:8192
v_mfma_f32_16x16x32_bf16 v[124:127], v[52:55], v[36:39], v[124:127]
ds_read_b64_tr_b16 v[166:167], v23 offset:10240
ds_read_b128 v[148:151], v3 offset:50176
v_mfma_f32_16x16x32_bf16 v[120:123], v[48:51], v[36:39], v[120:123]
ds_read_b128 v[168:171], v3 offset:57344
ds_read_b64_tr_b16 v[176:177], v20 offset:12288
v_mfma_f32_16x16x32_bf16 v[116:119], v[44:47], v[36:39], v[116:119]
ds_read_b64_tr_b16 v[178:179], v20 offset:14336
ds_read_b64_tr_b16 v[180:181], v21 offset:12288
v_mfma_f32_16x16x32_bf16 v[112:115], v[40:43], v[36:39], v[112:115]
ds_read_b64_tr_b16 v[182:183], v21 offset:14336
ds_read_b64_tr_b16 v[184:185], v22 offset:12288
v_mfma_f32_16x16x32_bf16 v[96:99], v[64:67], v[56:59], v[96:99]
ds_read_b64_tr_b16 v[186:187], v22 offset:14336
ds_read_b64_tr_b16 v[188:189], v23 offset:12288
v_mfma_f32_16x16x32_bf16 v[100:103], v[68:71], v[56:59], v[100:103]
ds_read_b64_tr_b16 v[190:191], v23 offset:14336
ds_read_b128 v[172:175], v3 offset:58368
v_mfma_f32_16x16x32_bf16 v[104:107], v[72:75], v[56:59], v[104:107]
v_mfma_f32_16x16x32_bf16 v[108:111], v[76:79], v[56:59], v[108:111]
v_mfma_f32_16x16x32_bf16 v[124:127], v[76:79], v[60:63], v[124:127]
v_mfma_f32_16x16x32_bf16 v[120:123], v[72:75], v[60:63], v[120:123]
v_mfma_f32_16x16x32_bf16 v[116:119], v[68:71], v[60:63], v[116:119]
v_mfma_f32_16x16x32_bf16 v[112:115], v[64:67], v[60:63], v[112:115]
s_waitcnt lgkmcnt(0)
v_mfma_f32_16x16x32_bf16 v[96:99], v[152:155], v[144:147], v[96:99]
v_mfma_f32_16x16x32_bf16 v[100:103], v[156:159], v[144:147], v[100:103]
v_mfma_f32_16x16x32_bf16 v[104:107], v[160:163], v[144:147], v[104:107]
v_mfma_f32_16x16x32_bf16 v[108:111], v[164:167], v[144:147], v[108:111]
v_mfma_f32_16x16x32_bf16 v[124:127], v[164:167], v[148:151], v[124:127]
v_mfma_f32_16x16x32_bf16 v[120:123], v[160:163], v[148:151], v[120:123]
v_mfma_f32_16x16x32_bf16 v[116:119], v[156:159], v[148:151], v[116:119]
v_mfma_f32_16x16x32_bf16 v[112:115], v[152:155], v[148:151], v[112:115]
v_mfma_f32_16x16x32_bf16 v[96:99], v[176:179], v[168:171], v[96:99]
v_mfma_f32_16x16x32_bf16 v[100:103], v[180:183], v[168:171], v[100:103]
v_mfma_f32_16x16x32_bf16 v[104:107], v[184:187], v[168:171], v[104:107]
v_mfma_f32_16x16x32_bf16 v[108:111], v[188:191], v[168:171], v[108:111]
v_mfma_f32_16x16x32_bf16 v[124:127], v[188:191], v[172:175], v[124:127]
v_mfma_f32_16x16x32_bf16 v[120:123], v[184:187], v[172:175], v[120:123]
v_mfma_f32_16x16x32_bf16 v[116:119], v[180:183], v[172:175], v[116:119]
v_mfma_f32_16x16x32_bf16 v[112:115], v[176:179], v[172:175], v[112:115]
s_nop 3
v_cvt_pk_bf16_f32 v32, v96, v97
v_cvt_pk_bf16_f32 v33, v98, v99
v_cvt_pk_bf16_f32 v34, v100, v101
v_cvt_pk_bf16_f32 v35, v102, v103
s_add_u32 s43, s60, 0
buffer_store_dwordx4 v[32:35], v11, s[20:23], s43 offen offset:0 sc1
v_cvt_pk_bf16_f32 v36, v104, v105
v_cvt_pk_bf16_f32 v37, v106, v107
v_cvt_pk_bf16_f32 v38, v108, v109
v_cvt_pk_bf16_f32 v39, v110, v111
s_add_u32 s43, s60, 8192
buffer_store_dwordx4 v[36:39], v11, s[20:23], s43 offen offset:0 sc1
v_cvt_pk_bf16_f32 v44, v120, v121
v_cvt_pk_bf16_f32 v45, v122, v123
v_cvt_pk_bf16_f32 v46, v124, v125
v_cvt_pk_bf16_f32 v47, v126, v127
s_add_u32 s43, s60, 8192
buffer_store_dwordx4 v[44:47], v11, s[20:23], s43 offen offset:1024 sc1
v_cvt_pk_bf16_f32 v40, v112, v113
v_cvt_pk_bf16_f32 v41, v114, v115
v_cvt_pk_bf16_f32 v42, v116, v117
v_cvt_pk_bf16_f32 v43, v118, v119
s_add_u32 s43, s60, 0
buffer_store_dwordx4 v[40:43], v11, s[20:23], s43 offen offset:1024 sc1
v_mov_b32 v64, 0
v_mov_b32 v65, 0
v_mov_b32 v66, 0
v_mov_b32 v67, 0
v_mov_b32 v68, 0
v_mov_b32 v69, 0
v_mov_b32 v70, 0
v_mov_b32 v71, 0
v_dot2_f32_bf16 v64, v32, s61, v64
v_dot2_f32_bf16 v66, v32, v32, v66
v_dot2_f32_bf16 v68, v40, s61, v68
v_dot2_f32_bf16 v70, v40, v40, v70
v_dot2_f32_bf16 v65, v33, s61, v65
v_dot2_f32_bf16 v67, v33, v33, v67
v_dot2_f32_bf16 v69, v41, s61, v69
v_dot2_f32_bf16 v71, v41, v41, v71
v_dot2_f32_bf16 v64, v34, s61, v64
v_dot2_f32_bf16 v66, v34, v34, v66
v_dot2_f32_bf16 v68, v42, s61, v68
v_dot2_f32_bf16 v70, v42, v42, v70
v_dot2_f32_bf16 v65, v35, s61, v65
v_dot2_f32_bf16 v67, v35, v35, v67
v_dot2_f32_bf16 v69, v43, s61, v69
v_dot2_f32_bf16 v71, v43, v43, v71
v_dot2_f32_bf16 v64, v36, s61, v64
v_dot2_f32_bf16 v66, v36, v36, v66
v_dot2_f32_bf16 v68, v44, s61, v68
v_dot2_f32_bf16 v70, v44, v44, v70
v_dot2_f32_bf16 v65, v37, s61, v65
v_dot2_f32_bf16 v67, v37, v37, v67
v_dot2_f32_bf16 v69, v45, s61, v69
v_dot2_f32_bf16 v71, v45, v45, v71
v_dot2_f32_bf16 v64, v38, s61, v64
v_dot2_f32_bf16 v66, v38, v38, v66
v_dot2_f32_bf16 v68, v46, s61, v68
v_dot2_f32_bf16 v70, v46, v46, v70
v_dot2_f32_bf16 v65, v39, s61, v65
v_dot2_f32_bf16 v67, v39, v39, v67
v_dot2_f32_bf16 v69, v47, s61, v69
v_dot2_f32_bf16 v71, v47, v47, v71
s_nop 2
v_add_f32 v64, v64, v65
v_add_f32 v66, v66, v67
v_add_f32 v68, v68, v69
v_add_f32 v70, v70, v71
s_nop 1
v_permlane32_swap_b32 v64, v68
v_permlane32_swap_b32 v66, v70
v_add_f32 v64, v64, v68
v_add_f32 v66, v66, v70
s_nop 1
v_permlane16_swap_b32 v64, v66
v_add_f32 v64, v64, v66
buffer_store_dword v64, v9, s[24:27], 0 offen sc1
s_lshl_b32 s7, s34, 12
s_add_u32 s7, s7, 49280
v_lshl_add_u32 v4, v1, 8, s7
v_mov_b32 v5, 1
s_waitcnt vmcnt(0)
s_cmp_lg_u32 s36, 0
s_barrier
s_cbranch_scc1 Lk2end_98
s_mov_b64 exec, 0xffff
buffer_atomic_add v5, v4, s[56:59], 0 offen sc1
s_mov_b64 exec, -1
s_branch Lk2end_98
Lprod_99:
s_mul_i32 s43, s34, 262144
s_add_u32 s8, s82, s43
s_addc_u32 s9, s83, 0
s_mov_b32 s10, 262144
s_mov_b32 s11, 0x20000
s_lshl_b32 s43, s35, 7
s_add_u32 s12, s68, s43
s_addc_u32 s13, s69, 0
s_mov_b32 s14, 2095232
s_mov_b32 s15, 0x20000
s_and_b32 s47, s36, 3
s_lshl_b32 s39, s47, 12
v_lshlrev_b32 v2, 4, v1
v_add_u32 v2, s39, v2
v_lshrrev_b32 v12, 3, v1
v_and_b32 v13, 6, v12
v_and_b32 v3, 7, v1
v_xor_b32 v3, v3, v13
v_lshlrev_b32 v3, 4, v3
v_mul_u32_u24 v12, 2048, v12
v_add_u32 v3, v3, v12
s_lshl_b32 s43, s47, 15
v_add_u32 v3, s43, v3
s_lshl_b32 s40, s47, 11
s_add_u32 s37, s35, 0
s_and_b32 s37, s37, 15
s_lshl_b32 s37, s37, 14
s_add_u32 m0, s39, 0
s_nop 0
buffer_load_dwordx4 v2, s[8:11], s37 offen offset:0 sc1 lds
buffer_load_dwordx4 v2, s[8:11], s37 offen offset:1024 sc1 lds
buffer_load_dwordx4 v2, s[8:11], s37 offen offset:2048 sc1 lds
buffer_load_dwordx4 v2, s[8:11], s37 offen offset:3072 sc1 lds
s_add_u32 s38, s35, 8
s_and_b32 s38, s38, 15
s_lshl_b32 s38, s38, 17
s_add_u32 m0, s40, 16384
s_nop 0
buffer_load_dwordx4 v3, s[12:15], s38 offen lds
s_add_u32 m0, s40, 17408
s_add_u32 s38, s38, 16384
buffer_load_dwordx4 v3, s[12:15], s38 offen lds
s_add_u32 s38, s35, 9
s_and_b32 s38, s38, 15
s_lshl_b32 s38, s38, 17
s_add_u32 m0, s40, 24576
s_nop 0
buffer_load_dwordx4 v3, s[12:15], s38 offen lds
s_add_u32 m0, s40, 25600
s_add_u32 s38, s38, 16384
buffer_load_dwordx4 v3, s[12:15], s38 offen lds
s_add_u32 s38, s35, 10
s_and_b32 s38, s38, 15
s_lshl_b32 s38, s38, 17
s_add_u32 m0, s40, 32768
s_nop 0
buffer_load_dwordx4 v3, s[12:15], s38 offen lds
s_add_u32 m0, s40, 33792
s_add_u32 s38, s38, 16384
buffer_load_dwordx4 v3, s[12:15], s38 offen lds
s_add_u32 s38, s35, 11
s_and_b32 s38, s38, 15
s_lshl_b32 s38, s38, 17
s_add_u32 m0, s40, 40960
s_nop 0
buffer_load_dwordx4 v3, s[12:15], s38 offen lds
s_add_u32 m0, s40, 41984
s_add_u32 s38, s38, 16384
buffer_load_dwordx4 v3, s[12:15], s38 offen lds
s_bitcmp0_b32 s36, 1
s_cselect_b32 s44, s72, s74
s_cselect_b32 s45, s73, s75
s_mul_i32 s43, s35, 192
s_add_u32 s16, s44, s43
s_addc_u32 s17, s45, 0
s_add_u32 s16, s16, 4096
s_addc_u32 s17, s17, 0
s_mov_b32 s18, 7333056
s_mov_b32 s19, 0x20000
s_and_b32 s43, s36, 1
s_mul_i32 s43, s43, 229376
v_add_u32 v196, 0, v1
v_mul_u32_u24 v197, 5462, v196
v_lshrrev_b32 v197, 16, v197
v_mul_u32_u24 v198, 12, v197
v_sub_u32 v198, v196, v198
v_bfe_u32 v199, v197, 2, 1
v_cmp_gt_u32 vcc, 8, v198
v_lshlrev_b32 v200, 1, v199
v_mul_u32_u24 v197, 7168, v197
v_cndmask_b32 v199, v199, v200, vcc
v_xor_b32 v198, v198, v199
v_lshl_add_u32 v192, v198, 4, v197
v_add_u32 v196, 64, v1
v_mul_u32_u24 v197, 5462, v196
v_lshrrev_b32 v197, 16, v197
v_mul_u32_u24 v198, 12, v197
v_sub_u32 v198, v196, v198
v_bfe_u32 v199, v197, 2, 1
v_cmp_gt_u32 vcc, 8, v198
v_lshlrev_b32 v200, 1, v199
v_mul_u32_u24 v197, 7168, v197
v_cndmask_b32 v199, v199, v200, vcc
v_xor_b32 v198, v198, v199
v_lshl_add_u32 v193, v198, 4, v197
v_add_u32 v196, 128, v1
v_mul_u32_u24 v197, 5462, v196
v_lshrrev_b32 v197, 16, v197
v_mul_u32_u24 v198, 12, v197
v_sub_u32 v198, v196, v198
v_bfe_u32 v199, v197, 2, 1
v_cmp_gt_u32 vcc, 8, v198
v_lshlrev_b32 v200, 1, v199
v_mul_u32_u24 v197, 7168, v197
v_cndmask_b32 v199, v199, v200, vcc
v_xor_b32 v198, v198, v199
v_lshl_add_u32 v194, v198, 4, v197
v_add_u32 v192, s43, v192
v_add_u32 v193, s43, v193
v_add_u32 v194, s43, v194
s_and_b32 s43, s36, 3
s_mul_i32 s50, s43, 6144
s_add_u32 s50, s50, 16384
s_cmp_eq_u32 s47, 3
s_cbranch_scc0 Lw_106
s_lshl_b32 s92, s34, 4
s_add_u32 s92, s92, s35
s_lshl_b32 s92, s92, 8
s_add_u32 s92, s92, 49152
s_add_u32 s92, s92, 28311552
s_mov_b32 s41, 0x40000
Lpoll_107:
s_load_dword s93, s[82:83], s92 glc
Lpchk_109:
s_waitcnt lgkmcnt(0)
s_cmp_eq_u32 s93, 16
s_cbranch_scc1 Lpok_108
s_sub_u32 s41, s41, 1
s_cmp_lg_u32 s41, 0
s_cbranch_scc1 Lpoll_107
Lpok_108:
Lw_106:
s_and_b32 s44, s36, 3
s_mul_i32 s44, s44, 11
s_bfe_u32 s43, s2, 0x30001
s_lshl_b32 s43, s43, 7
s_add_u32 s44, s44, s43
s_add_u32 s44, s44, 84
s_mul_i32 s44, s44, 7168
s_lshr_b32 s43, s2, 4
s_lshl_b32 s43, s43, 8
s_add_u32 s43, s43, s44
s_bitcmp0_b32 s2, 0
s_cselect_b32 s4, s72, s74
s_cselect_b32 s5, s73, s75
s_add_u32 s4, s4, s43
s_addc_u32 s5, s5, 0
s_cmp_eq_u32 s47, 3
s_cbranch_scc1 Lw_110
Lw_110:
s_waitcnt vmcnt(8)
s_barrier
s_add_u32 s37, s35, 1
s_and_b32 s37, s37, 15
s_lshl_b32 s37, s37, 14
s_add_u32 m0, s39, 49152
s_nop 0
buffer_load_dwordx4 v2, s[8:11], s37 offen offset:0 sc1 lds
buffer_load_dwordx4 v2, s[8:11], s37 offen offset:1024 sc1 lds
buffer_load_dwordx4 v2, s[8:11], s37 offen offset:2048 sc1 lds
buffer_load_dwordx4 v2, s[8:11], s37 offen offset:3072 sc1 lds
s_add_u32 s37, s35, 2
s_and_b32 s37, s37, 15
s_lshl_b32 s37, s37, 14
s_add_u32 m0, s39, 98304
s_nop 0
buffer_load_dwordx4 v2, s[8:11], s37 offen offset:0 sc1 lds
buffer_load_dwordx4 v2, s[8:11], s37 offen offset:1024 sc1 lds
buffer_load_dwordx4 v2, s[8:11], s37 offen offset:2048 sc1 lds
buffer_load_dwordx4 v2, s[8:11], s37 offen offset:3072 sc1 lds
s_add_u32 s37, s35, 3
s_and_b32 s37, s37, 15
s_lshl_b32 s37, s37, 14
s_add_u32 m0, s39, 147456
s_nop 0
buffer_load_dwordx4 v2, s[8:11], s37 offen offset:0 sc1 lds
buffer_load_dwordx4 v2, s[8:11], s37 offen offset:1024 sc1 lds
buffer_load_dwordx4 v2, s[8:11], s37 offen offset:2048 sc1 lds
buffer_load_dwordx4 v2, s[8:11], s37 offen offset:3072 sc1 lds
s_cmp_eq_u32 s47, 3
s_cbranch_scc0 Lw_111
Lw_111:
s_waitcnt vmcnt(8)
s_barrier
s_add_u32 s37, s35, 4
s_and_b32 s37, s37, 15
s_lshl_b32 s37, s37, 14
s_add_u32 m0, s39, 0
s_nop 0
buffer_load_dwordx4 v2, s[8:11], s37 offen offset:0 sc1 lds
buffer_load_dwordx4 v2, s[8:11], s37 offen offset:1024 sc1 lds
buffer_load_dwordx4 v2, s[8:11], s37 offen offset:2048 sc1 lds
buffer_load_dwordx4 v2, s[8:11], s37 offen offset:3072 sc1 lds
s_waitcnt vmcnt(8)
s_barrier
s_add_u32 s37, s35, 5
s_and_b32 s37, s37, 15
s_lshl_b32 s37, s37, 14
s_add_u32 m0, s39, 49152
s_nop 0
buffer_load_dwordx4 v2, s[8:11], s37 offen offset:0 sc1 lds
buffer_load_dwordx4 v2, s[8:11], s37 offen offset:1024 sc1 lds
buffer_load_dwordx4 v2, s[8:11], s37 offen offset:2048 sc1 lds
buffer_load_dwordx4 v2, s[8:11], s37 offen offset:3072 sc1 lds
s_waitcnt vmcnt(8)
s_barrier
s_add_u32 s37, s35, 6
s_and_b32 s37, s37, 15
s_lshl_b32 s37, s37, 14
s_add_u32 m0, s39, 98304
s_nop 0
buffer_load_dwordx4 v2, s[8:11], s37 offen offset:0 sc1 lds
buffer_load_dwordx4 v2, s[8:11], s37 offen offset:1024 sc1 lds
buffer_load_dwordx4 v2, s[8:11], s37 offen offset:2048 sc1 lds
buffer_load_dwordx4 v2, s[8:11], s37 offen offset:3072 sc1 lds
s_waitcnt vmcnt(8)
s_barrier
s_add_u32 s37, s35, 7
s_and_b32 s37, s37, 15
s_lshl_b32 s37, s37, 14
s_add_u32 m0, s39, 147456
s_nop 0
buffer_load_dwordx4 v2, s[8:11], s37 offen offset:0 sc1 lds
buffer_load_dwordx4 v2, s[8:11], s37 offen offset:1024 sc1 lds
buffer_load_dwordx4 v2, s[8:11], s37 offen offset:2048 sc1 lds
buffer_load_dwordx4 v2, s[8:11], s37 offen offset:3072 sc1 lds
s_waitcnt vmcnt(8)
s_barrier
s_add_u32 s37, s35, 8
s_and_b32 s37, s37, 15
s_lshl_b32 s37, s37, 14
s_add_u32 m0, s39, 0
s_nop 0
buffer_load_dwordx4 v2, s[8:11], s37 offen offset:0 sc1 lds
buffer_load_dwordx4 v2, s[8:11], s37 offen offset:1024 sc1 lds
buffer_load_dwordx4 v2, s[8:11], s37 offen offset:2048 sc1 lds
buffer_load_dwordx4 v2, s[8:11], s37 offen offset:3072 sc1 lds
s_add_u32 s38, s35, 12
s_and_b32 s38, s38, 15
s_lshl_b32 s38, s38, 17
s_add_u32 m0, s40, 114688
s_nop 0
buffer_load_dwordx4 v3, s[12:15], s38 offen lds
s_add_u32 m0, s40, 115712
s_add_u32 s38, s38, 16384
buffer_load_dwordx4 v3, s[12:15], s38 offen lds
s_waitcnt vmcnt(10)
s_barrier
s_add_u32 s37, s35, 9
s_and_b32 s37, s37, 15
s_lshl_b32 s37, s37, 14
s_add_u32 m0, s39, 49152
s_nop 0
buffer_load_dwordx4 v2, s[8:11], s37 offen offset:0 sc1 lds
buffer_load_dwordx4 v2, s[8:11], s37 offen offset:1024 sc1 lds
buffer_load_dwordx4 v2, s[8:11], s37 offen offset:2048 sc1 lds
buffer_load_dwordx4 v2, s[8:11], s37 offen offset:3072 sc1 lds
s_add_u32 s38, s35, 13
s_and_b32 s38, s38, 15
s_lshl_b32 s38, s38, 17
s_add_u32 m0, s40, 122880
s_nop 0
buffer_load_dwordx4 v3, s[12:15], s38 offen lds
s_add_u32 m0, s40, 123904
s_add_u32 s38, s38, 16384
buffer_load_dwordx4 v3, s[12:15], s38 offen lds
s_waitcnt vmcnt(12)
s_barrier
s_add_u32 s37, s35, 10
s_and_b32 s37, s37, 15
s_lshl_b32 s37, s37, 14
s_add_u32 m0, s39, 98304
s_nop 0
buffer_load_dwordx4 v2, s[8:11], s37 offen offset:0 sc1 lds
buffer_load_dwordx4 v2, s[8:11], s37 offen offset:1024 sc1 lds
buffer_load_dwordx4 v2, s[8:11], s37 offen offset:2048 sc1 lds
buffer_load_dwordx4 v2, s[8:11], s37 offen offset:3072 sc1 lds
s_add_u32 s38, s35, 14
s_and_b32 s38, s38, 15
s_lshl_b32 s38, s38, 17
s_add_u32 m0, s40, 131072
s_nop 0
buffer_load_dwordx4 v3, s[12:15], s38 offen lds
s_add_u32 m0, s40, 132096
s_add_u32 s38, s38, 16384
buffer_load_dwordx4 v3, s[12:15], s38 offen lds
s_waitcnt vmcnt(14)
s_barrier
s_add_u32 s37, s35, 11
s_and_b32 s37, s37, 15
s_lshl_b32 s37, s37, 14
s_add_u32 m0, s39, 147456
s_nop 0
buffer_load_dwordx4 v2, s[8:11], s37 offen offset:0 sc1 lds
buffer_load_dwordx4 v2, s[8:11], s37 offen offset:1024 sc1 lds
buffer_load_dwordx4 v2, s[8:11], s37 offen offset:2048 sc1 lds
buffer_load_dwordx4 v2, s[8:11], s37 offen offset:3072 sc1 lds
s_add_u32 s38, s35, 15
s_and_b32 s38, s38, 15
s_lshl_b32 s38, s38, 17
s_add_u32 m0, s40, 139264
s_nop 0
buffer_load_dwordx4 v3, s[12:15], s38 offen lds
s_add_u32 m0, s40, 140288
s_add_u32 s38, s38, 16384
buffer_load_dwordx4 v3, s[12:15], s38 offen lds
s_waitcnt vmcnt(14)
s_barrier
s_add_u32 s37, s35, 12
s_and_b32 s37, s37, 15
s_lshl_b32 s37, s37, 14
s_add_u32 m0, s39, 0
s_nop 0
buffer_load_dwordx4 v2, s[8:11], s37 offen offset:0 sc1 lds
buffer_load_dwordx4 v2, s[8:11], s37 offen offset:1024 sc1 lds
buffer_load_dwordx4 v2, s[8:11], s37 offen offset:2048 sc1 lds
buffer_load_dwordx4 v2, s[8:11], s37 offen offset:3072 sc1 lds
s_waitcnt vmcnt(12)
s_barrier
s_add_u32 s37, s35, 13
s_and_b32 s37, s37, 15
s_lshl_b32 s37, s37, 14
s_add_u32 m0, s39, 49152
s_nop 0
buffer_load_dwordx4 v2, s[8:11], s37 offen offset:0 sc1 lds
buffer_load_dwordx4 v2, s[8:11], s37 offen offset:1024 sc1 lds
buffer_load_dwordx4 v2, s[8:11], s37 offen offset:2048 sc1 lds
buffer_load_dwordx4 v2, s[8:11], s37 offen offset:3072 sc1 lds
s_waitcnt vmcnt(10)
s_barrier
s_add_u32 s37, s35, 14
s_and_b32 s37, s37, 15
s_lshl_b32 s37, s37, 14
s_add_u32 m0, s39, 98304
s_nop 0
buffer_load_dwordx4 v2, s[8:11], s37 offen offset:0 sc1 lds
buffer_load_dwordx4 v2, s[8:11], s37 offen offset:1024 sc1 lds
buffer_load_dwordx4 v2, s[8:11], s37 offen offset:2048 sc1 lds
buffer_load_dwordx4 v2, s[8:11], s37 offen offset:3072 sc1 lds
s_getpc_b64 s[100:101]
s_and_b32 s100, s100, 0xfffff000
s_sub_u32 s100, s100, 1077248
s_subb_u32 s101, s101, 0
s_lshr_b32 s6, s2, 3
s_mul_i32 s6, s6, 4
s_and_b32 s7, s36, 3
s_add_u32 s6, s6, s7
s_mulk_i32 s6, 384
s_add_u32 s6, s6, 1082048
s_load_dword s3, s[100:101], s6 offset:0
s_load_dword s3, s[100:101], s6 offset:64
s_load_dword s3, s[100:101], s6 offset:128
s_load_dword s3, s[100:101], s6 offset:192
s_load_dword s3, s[100:101], s6 offset:256
s_load_dword s3, s[100:101], s6 offset:320
s_nop 0
s_nop 0
s_waitcnt vmcnt(8)
s_barrier
s_add_u32 s37, s35, 15
s_and_b32 s37, s37, 15
s_lshl_b32 s37, s37, 14
s_add_u32 m0, s39, 147456
s_nop 0
buffer_load_dwordx4 v2, s[8:11], s37 offen offset:0 sc1 lds
buffer_load_dwordx4 v2, s[8:11], s37 offen offset:1024 sc1 lds
buffer_load_dwordx4 v2, s[8:11], s37 offen offset:2048 sc1 lds
buffer_load_dwordx4 v2, s[8:11], s37 offen offset:3072 sc1 lds
s_waitcnt vmcnt(8)
s_barrier
s_waitcnt vmcnt(0)
s_barrier
s_add_u32 s38, s35, 0
s_and_b32 s38, s38, 15
s_mul_i32 s38, s38, 458752
s_add_u32 m0, s50, 0
s_nop 0
buffer_load_dwordx4 v192, s[16:19], s38 offen lds
s_add_u32 m0, s50, 1024
s_nop 0
buffer_load_dwordx4 v193, s[16:19], s38 offen lds
s_add_u32 m0, s50, 2048
s_nop 0
buffer_load_dwordx4 v194, s[16:19], s38 offen lds
s_add_u32 m0, s50, 3072
s_add_u32 s38, s38, 114688
buffer_load_dwordx4 v192, s[16:19], s38 offen lds
s_add_u32 m0, s50, 4096
s_nop 0
buffer_load_dwordx4 v193, s[16:19], s38 offen lds
s_add_u32 m0, s50, 5120
s_nop 0
buffer_load_dwordx4 v194, s[16:19], s38 offen lds
s_add_u32 s38, s35, 1
s_and_b32 s38, s38, 15
s_mul_i32 s38, s38, 458752
s_add_u32 m0, s50, 49152
s_nop 0
buffer_load_dwordx4 v192, s[16:19], s38 offen lds
s_add_u32 m0, s50, 50176
s_nop 0
buffer_load_dwordx4 v193, s[16:19], s38 offen lds
s_add_u32 m0, s50, 51200
s_nop 0
buffer_load_dwordx4 v194, s[16:19], s38 offen lds
s_add_u32 m0, s50, 52224
s_add_u32 s38, s38, 114688
buffer_load_dwordx4 v192, s[16:19], s38 offen lds
s_add_u32 m0, s50, 53248
s_nop 0
buffer_load_dwordx4 v193, s[16:19], s38 offen lds
s_add_u32 m0, s50, 54272
s_nop 0
buffer_load_dwordx4 v194, s[16:19], s38 offen lds
v_lshlrev_b32 v240, 16, v128
v_and_b32 v241, 0xffff0000, v128
v_lshlrev_b32 v242, 16, v129
v_and_b32 v243, 0xffff0000, v129
v_lshlrev_b32 v244, 16, v130
v_and_b32 v245, 0xffff0000, v130
v_lshlrev_b32 v246, 16, v131
v_and_b32 v247, 0xffff0000, v131
v_lshlrev_b32 v24, 16, v132
v_and_b32 v25, 0xffff0000, v132
v_lshlrev_b32 v26, 16, v133
v_and_b32 v27, 0xffff0000, v133
v_lshlrev_b32 v28, 16, v134
v_and_b32 v29, 0xffff0000, v134
v_lshlrev_b32 v30, 16, v135
v_and_b32 v31, 0xffff0000, v135
v_add_f32 v240, v240, v24
v_add_f32 v241, v241, v25
v_add_f32 v242, v242, v26
v_add_f32 v243, v243, v27
v_add_f32 v244, v244, v28
v_add_f32 v245, v245, v29
v_add_f32 v246, v246, v30
v_add_f32 v247, v247, v31
v_lshlrev_b32 v24, 16, v136
s_branch Lov_7
.p2align 12
.fill 48, 4, 0xbf800000
Lst_7_0:
s_branch Lwr_167
s_nop 0
s_nop 0
Lov_7:
v_and_b32 v25, 0xffff0000, v136
v_lshlrev_b32 v26, 16, v137
v_and_b32 v27, 0xffff0000, v137
v_lshlrev_b32 v28, 16, v138
v_and_b32 v29, 0xffff0000, v138
v_lshlrev_b32 v30, 16, v139
v_and_b32 v31, 0xffff0000, v139
v_add_f32 v240, v240, v24
v_add_f32 v241, v241, v25
v_add_f32 v242, v242, v26
v_add_f32 v243, v243, v27
v_add_f32 v244, v244, v28
v_add_f32 v245, v245, v29
v_add_f32 v246, v246, v30
v_add_f32 v247, v247, v31
v_lshlrev_b32 v24, 16, v140
v_and_b32 v25, 0xffff0000, v140
v_lshlrev_b32 v26, 16, v141
v_and_b32 v27, 0xffff0000, v141
v_lshlrev_b32 v28, 16, v142
v_and_b32 v29, 0xffff0000, v142
v_lshlrev_b32 v30, 16, v143
v_and_b32 v31, 0xffff0000, v143
v_add_f32 v240, v240, v24
v_add_f32 v241, v241, v25
v_add_f32 v242, v242, v26
v_add_f32 v243, v243, v27
v_add_f32 v244, v244, v28
v_add_f32 v245, v245, v29
v_add_f32 v246, v246, v30
v_add_f32 v247, v247, v31
v_lshlrev_b32 v24, 16, v144
v_and_b32 v25, 0xffff0000, v144
v_lshlrev_b32 v26, 16, v145
v_and_b32 v27, 0xffff0000, v145
v_lshlrev_b32 v28, 16, v146
v_and_b32 v29, 0xffff0000, v146
v_lshlrev_b32 v30, 16, v147
v_and_b32 v31, 0xffff0000, v147
v_add_f32 v240, v240, v24
v_add_f32 v241, v241, v25
v_add_f32 v242, v242, v26
v_add_f32 v243, v243, v27
v_add_f32 v244, v244, v28
v_add_f32 v245, v245, v29
v_add_f32 v246, v246, v30
v_add_f32 v247, v247, v31
v_lshlrev_b32 v24, 16, v148
v_and_b32 v25, 0xffff0000, v148
v_lshlrev_b32 v26, 16, v149
v_and_b32 v27, 0xffff0000, v149
v_lshlrev_b32 v28, 16, v150
v_and_b32 v29, 0xffff0000, v150
v_lshlrev_b32 v30, 16, v151
v_and_b32 v31, 0xffff0000, v151
v_add_f32 v240, v240, v24
v_add_f32 v241, v241, v25
v_add_f32 v242, v242, v26
v_add_f32 v243, v243, v27
v_add_f32 v244, v244, v28
v_add_f32 v245, v245, v29
v_add_f32 v246, v246, v30
v_add_f32 v247, v247, v31
v_lshlrev_b32 v24, 16, v152
v_and_b32 v25, 0xffff0000, v152
v_lshlrev_b32 v26, 16, v153
v_and_b32 v27, 0xffff0000, v153
v_lshlrev_b32 v28, 16, v154
v_and_b32 v29, 0xffff0000, v154
v_lshlrev_b32 v30, 16, v155
v_and_b32 v31, 0xffff0000, v155
v_add_f32 v240, v240, v24
v_add_f32 v241, v241, v25
v_add_f32 v242, v242, v26
v_add_f32 v243, v243, v27
v_add_f32 v244, v244, v28
v_add_f32 v245, v245, v29
v_add_f32 v246, v246, v30
v_add_f32 v247, v247, v31
v_lshlrev_b32 v24, 16, v156
v_and_b32 v25, 0xffff0000, v156
v_lshlrev_b32 v26, 16, v157
v_and_b32 v27, 0xffff0000, v157
v_lshlrev_b32 v28, 16, v158
v_and_b32 v29, 0xffff0000, v158
v_lshlrev_b32 v30, 16, v159
v_and_b32 v31, 0xffff0000, v159
v_add_f32 v240, v240, v24
v_add_f32 v241, v241, v25
v_add_f32 v242, v242, v26
v_add_f32 v243, v243, v27
v_add_f32 v244, v244, v28
v_add_f32 v245, v245, v29
v_add_f32 v246, v246, v30
v_add_f32 v247, v247, v31
s_nop 0
v_permlane32_swap_b32 v240, v244
v_permlane32_swap_b32 v241, v245
v_permlane32_swap_b32 v242, v246
v_permlane32_swap_b32 v243, v247
v_add_f32 v240, v240, v244
v_add_f32 v241, v241, v245
v_add_f32 v242, v242, v246
v_add_f32 v243, v243, v247
s_nop 0
v_permlane16_swap_b32 v240, v242
v_permlane16_swap_b32 v241, v243
v_add_f32 v240, v240, v242
v_add_f32 v241, v241, v243
s_branch Lk3a
Lk2end_98:
Lk3:
s_branch Lgb_112
Lk3a:
s_mul_i32 s43, s34, 262144
s_add_u32 s8, s82, s43
s_addc_u32 s9, s83, 0
s_add_u32 s8, s8, 4194304
s_addc_u32 s9, s9, 0
s_mov_b32 s10, 262144
s_mov_b32 s11, 0x20000
s_mul_i32 s43, s34, 917504
s_add_u32 s24, s82, s43
s_addc_u32 s25, s83, 0
s_add_u32 s24, s24, 8388608
s_addc_u32 s25, s25, 0
s_mov_b32 s26, 917504
s_mov_b32 s27, 0x20000
s_add_u32 s84, s82, 27262976
s_addc_u32 s85, s83, 0
s_mov_b32 s86, 229376
s_mov_b32 s87, 0x20000
s_and_b32 s47, s36, 3
s_lshr_b32 s62, s47, 1
s_and_b32 s63, s47, 1
v_lshlrev_b32 v2, 4, v1
s_lshl_b32 s39, s47, 12
v_add_u32 v3, s39, v2
s_bitcmp0_b32 s36, 1
s_cselect_b32 s44, s72, s74
s_cselect_b32 s45, s73, s75
s_mul_i32 s43, s35, 256
s_add_u32 s12, s44, s43
s_addc_u32 s13, s45, 0
s_mov_b32 s14, 7333120
s_mov_b32 s15, 0x20000
s_and_b32 s43, s36, 1
s_mul_i32 s43, s43, 229376
v_lshrrev_b32 v28, 4, v1
v_lshlrev_b32 v29, 1, v28
v_and_b32 v4, 15, v1
v_xor_b32 v4, v4, v29
v_lshlrev_b32 v4, 4, v4
v_mul_u32_u24 v28, 7168, v28
v_add_u32 v4, v4, v28
v_add_u32 v4, s43, v4
v_xor_b32 v5, 128, v4
v_add_u32 v5, 28672, v5
s_and_b32 s43, s36, 3
s_mul_i32 s40, s43, 8192
s_add_u32 s40, s40, 16384
v_mov_b32 v6, v192
v_mov_b32 v7, v193
v_mov_b32 v8, v194
s_lshl_b32 s43, s62, 12
v_add_u32 v9, s43, v2
v_add_u32 v10, 98304, v9
v_lshrrev_b32 v27, 2, v1
v_bfe_u32 v28, v27, 2, 1
v_mul_u32_u24 v27, 192, v27
v_add_u32 v27, 16384, v27
v_and_b32 v29, 3, v1
v_lshl_add_u32 v12, v29, 3, v27
s_lshl_b32 s43, s63, 6
v_add_u32 v12, s43, v12
v_lshl_add_u32 v11, v28, 5, v12
v_xor_b32 v30, 1, v28
v_lshl_add_u32 v12, v30, 5, v12
v_xor_b32 v28, s63, v28
v_lshl_add_u32 v27, v28, 4, v27
v_lshrrev_b32 v28, 1, v29
v_lshl_add_u32 v27, v28, 5, v27
v_and_b32 v28, 1, v29
v_lshl_add_u32 v27, v28, 3, v27
v_add_u32 v13, 128, v27
v_add_u32 v14, 49152, v11
v_add_u32 v15, 49152, v12
v_add_u32 v16, 49152, v13
v_add_u32 v17, 98304, v11
v_add_u32 v18, 98304, v12
v_add_u32 v19, 98304, v13
s_cmp_lg_u32 s36, 4
s_cbranch_scc1 Lwm_114
s_branch Lst_8_1
Lwr_179:
s_branch Lwe_113
Lwm_114:
s_cmp_lg_u32 s36, 5
s_cbranch_scc1 Lwm_115
s_branch Lst_9_1
Lwr_180:
s_branch Lwe_113
Lwm_115:
s_cmp_lg_u32 s36, 6
s_cbranch_scc1 Lwm_116
s_branch Lst_10_1
Lwr_181:
s_branch Lwe_113
Lwm_116:
s_cmp_lg_u32 s36, 7
s_cbranch_scc1 Lwm_117
s_nop 0
s_branch Lwe_113
Lwm_117:
Lwe_113:
s_barrier
s_lshl_b32 s43, s47, 9
s_add_u32 s43, s43, 151552
v_and_b32 v28, 15, v1
v_lshl_add_u32 v28, v28, 5, s43
v_lshrrev_b32 v29, 4, v1
v_lshl_add_u32 v28, v29, 3, v28
ds_write_b64 v28, v[240:241]
s_waitcnt lgkmcnt(0)
s_cmp_lg_u32 s36, 4
s_cbranch_scc1 Lwm_119
s_branch Lst_11_1
Lwr_183:
s_branch Lwe_118
Lwm_119:
s_cmp_lg_u32 s36, 5
s_cbranch_scc1 Lwm_120
s_branch Lst_12_1
Lwr_184:
s_branch Lwe_118
Lwm_120:
s_cmp_lg_u32 s36, 6
s_cbranch_scc1 Lwm_121
s_branch Lst_13_1
Lwr_185:
s_branch Lwe_118
Lwm_121:
s_cmp_lg_u32 s36, 7
s_cbranch_scc1 Lwm_122
s_branch Lst_14_1
Lwr_186:
s_branch Lwe_118
Lwm_122:
Lwe_118:
s_waitcnt vmcnt(0) lgkmcnt(0)
s_barrier
ds_read_b128 v[32:35], v9 offset:0
ds_read_b64_tr_b16 v[48:49], v11 offset:0
ds_read_b64_tr_b16 v[50:51], v11 offset:3072
ds_read_b64_tr_b16 v[52:53], v12 offset:0
ds_read_b64_tr_b16 v[54:55], v12 offset:3072
ds_read_b64_tr_b16 v[56:57], v13 offset:0
ds_read_b64_tr_b16 v[58:59], v13 offset:3072
ds_read_b64_tr_b16 v[60:61], v11 offset:12288
ds_read_b64_tr_b16 v[62:63], v11 offset:15360
ds_read_b64_tr_b16 v[64:65], v12 offset:12288
ds_read_b64_tr_b16 v[66:67], v12 offset:15360
ds_read_b64_tr_b16 v[68:69], v13 offset:12288
ds_read_b64_tr_b16 v[70:71], v13 offset:15360
ds_read_b128 v[36:39], v9 offset:1024
ds_read_b128 v[40:43], v9 offset:2048
ds_read_b128 v[44:47], v9 offset:3072
s_waitcnt lgkmcnt(0)
v_mfma_f32_16x16x32_bf16 v[128:131], v[48:51], v[32:35], 0
ds_read_b128 v[72:75], v9 offset:8192
v_mfma_f32_16x16x32_bf16 v[152:155], v[48:51], v[36:39], 0
ds_read_b64_tr_b16 v[88:89], v11 offset:6144
v_mfma_f32_16x16x32_bf16 v[176:179], v[48:51], v[40:43], 0
ds_read_b64_tr_b16 v[90:91], v11 offset:9216
v_mfma_f32_16x16x32_bf16 v[200:203], v[48:51], v[44:47], 0
ds_read_b64_tr_b16 v[92:93], v12 offset:6144
v_mfma_f32_16x16x32_bf16 v[204:207], v[52:55], v[44:47], 0
ds_read_b64_tr_b16 v[94:95], v12 offset:9216
v_mfma_f32_16x16x32_bf16 v[180:183], v[52:55], v[40:43], 0
ds_read_b64_tr_b16 v[96:97], v13 offset:6144
v_mfma_f32_16x16x32_bf16 v[156:159], v[52:55], v[36:39], 0
ds_read_b64_tr_b16 v[98:99], v13 offset:9216
v_mfma_f32_16x16x32_bf16 v[132:135], v[52:55], v[32:35], 0
ds_read_b64_tr_b16 v[100:101], v11 offset:18432
v_mfma_f32_16x16x32_bf16 v[136:139], v[56:59], v[32:35], 0
ds_read_b64_tr_b16 v[102:103], v11 offset:21504
v_mfma_f32_16x16x32_bf16 v[160:163], v[56:59], v[36:39], 0
ds_read_b64_tr_b16 v[104:105], v12 offset:18432
v_mfma_f32_16x16x32_bf16 v[184:187], v[56:59], v[40:43], 0
ds_read_b64_tr_b16 v[106:107], v12 offset:21504
v_mfma_f32_16x16x32_bf16 v[208:211], v[56:59], v[44:47], 0
ds_read_b64_tr_b16 v[108:109], v13 offset:18432
v_mfma_f32_16x16x32_bf16 v[212:215], v[60:63], v[44:47], 0
ds_read_b64_tr_b16 v[110:111], v13 offset:21504
v_mfma_f32_16x16x32_bf16 v[188:191], v[60:63], v[40:43], 0
ds_read_b128 v[76:79], v9 offset:9216
v_mfma_f32_16x16x32_bf16 v[164:167], v[60:63], v[36:39], 0
ds_read_b128 v[80:83], v9 offset:10240
v_mfma_f32_16x16x32_bf16 v[140:143], v[60:63], v[32:35], 0
ds_read_b128 v[84:87], v9 offset:11264
v_mfma_f32_16x16x32_bf16 v[144:147], v[64:67], v[32:35], 0
v_mfma_f32_16x16x32_bf16 v[168:171], v[64:67], v[36:39], 0
v_mfma_f32_16x16x32_bf16 v[192:195], v[64:67], v[40:43], 0
v_mfma_f32_16x16x32_bf16 v[216:219], v[64:67], v[44:47], 0
v_mfma_f32_16x16x32_bf16 v[220:223], v[68:71], v[44:47], 0
v_mfma_f32_16x16x32_bf16 v[196:199], v[68:71], v[40:43], 0
v_mfma_f32_16x16x32_bf16 v[172:175], v[68:71], v[36:39], 0
v_mfma_f32_16x16x32_bf16 v[148:151], v[68:71], v[32:35], 0
s_waitcnt lgkmcnt(0)
s_barrier
v_mfma_f32_16x16x32_bf16 v[128:131], v[88:91], v[72:75], v[128:131]
ds_read_b128 v[32:35], v9 offset:49152
v_mfma_f32_16x16x32_bf16 v[152:155], v[88:91], v[76:79], v[152:155]
ds_read_b64_tr_b16 v[48:49], v14 offset:0
v_mfma_f32_16x16x32_bf16 v[176:179], v[88:91], v[80:83], v[176:179]
ds_read_b64_tr_b16 v[50:51], v14 offset:3072
v_mfma_f32_16x16x32_bf16 v[200:203], v[88:91], v[84:87], v[200:203]
ds_read_b64_tr_b16 v[52:53], v15 offset:0
v_mfma_f32_16x16x32_bf16 v[204:207], v[92:95], v[84:87], v[204:207]
ds_read_b64_tr_b16 v[54:55], v15 offset:3072
v_mfma_f32_16x16x32_bf16 v[180:183], v[92:95], v[80:83], v[180:183]
ds_read_b64_tr_b16 v[56:57], v16 offset:0
v_mfma_f32_16x16x32_bf16 v[156:159], v[92:95], v[76:79], v[156:159]
ds_read_b64_tr_b16 v[58:59], v16 offset:3072
v_mfma_f32_16x16x32_bf16 v[132:135], v[92:95], v[72:75], v[132:135]
ds_read_b64_tr_b16 v[60:61], v14 offset:12288
v_mfma_f32_16x16x32_bf16 v[136:139], v[96:99], v[72:75], v[136:139]
ds_read_b64_tr_b16 v[62:63], v14 offset:15360
v_mfma_f32_16x16x32_bf16 v[160:163], v[96:99], v[76:79], v[160:163]
ds_read_b64_tr_b16 v[64:65], v15 offset:12288
v_mfma_f32_16x16x32_bf16 v[184:187], v[96:99], v[80:83], v[184:187]
ds_read_b64_tr_b16 v[66:67], v15 offset:15360
v_mfma_f32_16x16x32_bf16 v[208:211], v[96:99], v[84:87], v[208:211]
ds_read_b64_tr_b16 v[68:69], v16 offset:12288
v_mfma_f32_16x16x32_bf16 v[212:215], v[100:103], v[84:87], v[212:215]
ds_read_b64_tr_b16 v[70:71], v16 offset:15360
v_mfma_f32_16x16x32_bf16 v[188:191], v[100:103], v[80:83], v[188:191]
ds_read_b128 v[36:39], v9 offset:50176
v_mfma_f32_16x16x32_bf16 v[164:167], v[100:103], v[76:79], v[164:167]
ds_read_b128 v[40:43], v9 offset:51200
v_mfma_f32_16x16x32_bf16 v[140:143], v[100:103], v[72:75], v[140:143]
ds_read_b128 v[44:47], v9 offset:52224
v_mfma_f32_16x16x32_bf16 v[144:147], v[104:107], v[72:75], v[144:147]
v_mfma_f32_16x16x32_bf16 v[168:171], v[104:107], v[76:79], v[168:171]
v_mfma_f32_16x16x32_bf16 v[192:195], v[104:107], v[80:83], v[192:195]
v_mfma_f32_16x16x32_bf16 v[216:219], v[104:107], v[84:87], v[216:219]
v_mfma_f32_16x16x32_bf16 v[220:223], v[108:111], v[84:87], v[220:223]
v_mfma_f32_16x16x32_bf16 v[196:199], v[108:111], v[80:83], v[196:199]
v_mfma_f32_16x16x32_bf16 v[172:175], v[108:111], v[76:79], v[172:175]
v_mfma_f32_16x16x32_bf16 v[148:151], v[108:111], v[72:75], v[148:151]
s_mov_b32 s41, 5
Lk3l_123:
s_waitcnt lgkmcnt(0)
v_mfma_f32_16x16x32_bf16 v[128:131], v[48:51], v[32:35], v[128:131]
ds_read_b128 v[72:75], v9 offset:57344
v_mfma_f32_16x16x32_bf16 v[152:155], v[48:51], v[36:39], v[152:155]
ds_read_b64_tr_b16 v[88:89], v14 offset:6144
v_mfma_f32_16x16x32_bf16 v[176:179], v[48:51], v[40:43], v[176:179]
ds_read_b64_tr_b16 v[90:91], v14 offset:9216
v_mfma_f32_16x16x32_bf16 v[200:203], v[48:51], v[44:47], v[200:203]
ds_read_b64_tr_b16 v[92:93], v15 offset:6144
v_mfma_f32_16x16x32_bf16 v[204:207], v[52:55], v[44:47], v[204:207]
ds_read_b64_tr_b16 v[94:95], v15 offset:9216
v_mfma_f32_16x16x32_bf16 v[180:183], v[52:55], v[40:43], v[180:183]
ds_read_b64_tr_b16 v[96:97], v16 offset:6144
v_mfma_f32_16x16x32_bf16 v[156:159], v[52:55], v[36:39], v[156:159]
ds_read_b64_tr_b16 v[98:99], v16 offset:9216
v_mfma_f32_16x16x32_bf16 v[132:135], v[52:55], v[32:35], v[132:135]
ds_read_b64_tr_b16 v[100:101], v14 offset:18432
v_mfma_f32_16x16x32_bf16 v[136:139], v[56:59], v[32:35], v[136:139]
ds_read_b64_tr_b16 v[102:103], v14 offset:21504
v_mfma_f32_16x16x32_bf16 v[160:163], v[56:59], v[36:39], v[160:163]
ds_read_b64_tr_b16 v[104:105], v15 offset:18432
v_mfma_f32_16x16x32_bf16 v[184:187], v[56:59], v[40:43], v[184:187]
ds_read_b64_tr_b16 v[106:107], v15 offset:21504
v_mfma_f32_16x16x32_bf16 v[208:211], v[56:59], v[44:47], v[208:211]
ds_read_b64_tr_b16 v[108:109], v16 offset:18432
v_mfma_f32_16x16x32_bf16 v[212:215], v[60:63], v[44:47], v[212:215]
ds_read_b64_tr_b16 v[110:111], v16 offset:21504
v_mfma_f32_16x16x32_bf16 v[188:191], v[60:63], v[40:43], v[188:191]
ds_read_b128 v[76:79], v9 offset:58368
v_mfma_f32_16x16x32_bf16 v[164:167], v[60:63], v[36:39], v[164:167]
ds_read_b128 v[80:83], v9 offset:59392
v_mfma_f32_16x16x32_bf16 v[140:143], v[60:63], v[32:35], v[140:143]
ds_read_b128 v[84:87], v9 offset:60416
v_mfma_f32_16x16x32_bf16 v[144:147], v[64:67], v[32:35], v[144:147]
v_mfma_f32_16x16x32_bf16 v[168:171], v[64:67], v[36:39], v[168:171]
v_mfma_f32_16x16x32_bf16 v[192:195], v[64:67], v[40:43], v[192:195]
v_mfma_f32_16x16x32_bf16 v[216:219], v[64:67], v[44:47], v[216:219]
v_mfma_f32_16x16x32_bf16 v[220:223], v[68:71], v[44:47], v[220:223]
v_mfma_f32_16x16x32_bf16 v[196:199], v[68:71], v[40:43], v[196:199]
v_mfma_f32_16x16x32_bf16 v[172:175], v[68:71], v[36:39], v[172:175]
v_mfma_f32_16x16x32_bf16 v[148:151], v[68:71], v[32:35], v[148:151]
s_waitcnt lgkmcnt(0)
s_barrier
v_mfma_f32_16x16x32_bf16 v[128:131], v[88:91], v[72:75], v[128:131]
ds_read_b128 v[32:35], v10 offset:0
v_mfma_f32_16x16x32_bf16 v[152:155], v[88:91], v[76:79], v[152:155]
ds_read_b64_tr_b16 v[48:49], v17 offset:0
v_mfma_f32_16x16x32_bf16 v[176:179], v[88:91], v[80:83], v[176:179]
ds_read_b64_tr_b16 v[50:51], v17 offset:3072
v_mfma_f32_16x16x32_bf16 v[200:203], v[88:91], v[84:87], v[200:203]
ds_read_b64_tr_b16 v[52:53], v18 offset:0
v_mfma_f32_16x16x32_bf16 v[204:207], v[92:95], v[84:87], v[204:207]
ds_read_b64_tr_b16 v[54:55], v18 offset:3072
v_mfma_f32_16x16x32_bf16 v[180:183], v[92:95], v[80:83], v[180:183]
ds_read_b64_tr_b16 v[56:57], v19 offset:0
v_mfma_f32_16x16x32_bf16 v[156:159], v[92:95], v[76:79], v[156:159]
ds_read_b64_tr_b16 v[58:59], v19 offset:3072
v_mfma_f32_16x16x32_bf16 v[132:135], v[92:95], v[72:75], v[132:135]
ds_read_b64_tr_b16 v[60:61], v17 offset:12288
v_mfma_f32_16x16x32_bf16 v[136:139], v[96:99], v[72:75], v[136:139]
ds_read_b64_tr_b16 v[62:63], v17 offset:15360
v_mfma_f32_16x16x32_bf16 v[160:163], v[96:99], v[76:79], v[160:163]
ds_read_b64_tr_b16 v[64:65], v18 offset:12288
v_mfma_f32_16x16x32_bf16 v[184:187], v[96:99], v[80:83], v[184:187]
ds_read_b64_tr_b16 v[66:67], v18 offset:15360
v_mfma_f32_16x16x32_bf16 v[208:211], v[96:99], v[84:87], v[208:211]
ds_read_b64_tr_b16 v[68:69], v19 offset:12288
v_mfma_f32_16x16x32_bf16 v[212:215], v[100:103], v[84:87], v[212:215]
ds_read_b64_tr_b16 v[70:71], v19 offset:15360
v_mfma_f32_16x16x32_bf16 v[188:191], v[100:103], v[80:83], v[188:191]
ds_read_b128 v[36:39], v10 offset:1024
v_mfma_f32_16x16x32_bf16 v[164:167], v[100:103], v[76:79], v[164:167]
ds_read_b128 v[40:43], v10 offset:2048
v_mfma_f32_16x16x32_bf16 v[140:143], v[100:103], v[72:75], v[140:143]
ds_read_b128 v[44:47], v10 offset:3072
v_mfma_f32_16x16x32_bf16 v[144:147], v[104:107], v[72:75], v[144:147]
v_mfma_f32_16x16x32_bf16 v[168:171], v[104:107], v[76:79], v[168:171]
v_mfma_f32_16x16x32_bf16 v[192:195], v[104:107], v[80:83], v[192:195]
v_mfma_f32_16x16x32_bf16 v[216:219], v[104:107], v[84:87], v[216:219]
v_mfma_f32_16x16x32_bf16 v[220:223], v[108:111], v[84:87], v[220:223]
v_mfma_f32_16x16x32_bf16 v[196:199], v[108:111], v[80:83], v[196:199]
v_mfma_f32_16x16x32_bf16 v[172:175], v[108:111], v[76:79], v[172:175]
v_mfma_f32_16x16x32_bf16 v[148:151], v[108:111], v[72:75], v[148:151]
s_waitcnt lgkmcnt(0)
v_mfma_f32_16x16x32_bf16 v[128:131], v[48:51], v[32:35], v[128:131]
ds_read_b128 v[72:75], v10 offset:8192
v_mfma_f32_16x16x32_bf16 v[152:155], v[48:51], v[36:39], v[152:155]
ds_read_b64_tr_b16 v[88:89], v17 offset:6144
v_mfma_f32_16x16x32_bf16 v[176:179], v[48:51], v[40:43], v[176:179]
ds_read_b64_tr_b16 v[90:91], v17 offset:9216
v_mfma_f32_16x16x32_bf16 v[200:203], v[48:51], v[44:47], v[200:203]
ds_read_b64_tr_b16 v[92:93], v18 offset:6144
v_mfma_f32_16x16x32_bf16 v[204:207], v[52:55], v[44:47], v[204:207]
ds_read_b64_tr_b16 v[94:95], v18 offset:9216
v_mfma_f32_16x16x32_bf16 v[180:183], v[52:55], v[40:43], v[180:183]
ds_read_b64_tr_b16 v[96:97], v19 offset:6144
v_mfma_f32_16x16x32_bf16 v[156:159], v[52:55], v[36:39], v[156:159]
ds_read_b64_tr_b16 v[98:99], v19 offset:9216
v_mfma_f32_16x16x32_bf16 v[132:135], v[52:55], v[32:35], v[132:135]
ds_read_b64_tr_b16 v[100:101], v17 offset:18432
v_mfma_f32_16x16x32_bf16 v[136:139], v[56:59], v[32:35], v[136:139]
ds_read_b64_tr_b16 v[102:103], v17 offset:21504
v_mfma_f32_16x16x32_bf16 v[160:163], v[56:59], v[36:39], v[160:163]
ds_read_b64_tr_b16 v[104:105], v18 offset:18432
v_mfma_f32_16x16x32_bf16 v[184:187], v[56:59], v[40:43], v[184:187]
ds_read_b64_tr_b16 v[106:107], v18 offset:21504
v_mfma_f32_16x16x32_bf16 v[208:211], v[56:59], v[44:47], v[208:211]
ds_read_b64_tr_b16 v[108:109], v19 offset:18432
v_mfma_f32_16x16x32_bf16 v[212:215], v[60:63], v[44:47], v[212:215]
ds_read_b64_tr_b16 v[110:111], v19 offset:21504
v_mfma_f32_16x16x32_bf16 v[188:191], v[60:63], v[40:43], v[188:191]
ds_read_b128 v[76:79], v10 offset:9216
v_mfma_f32_16x16x32_bf16 v[164:167], v[60:63], v[36:39], v[164:167]
ds_read_b128 v[80:83], v10 offset:10240
v_mfma_f32_16x16x32_bf16 v[140:143], v[60:63], v[32:35], v[140:143]
ds_read_b128 v[84:87], v10 offset:11264
v_mfma_f32_16x16x32_bf16 v[144:147], v[64:67], v[32:35], v[144:147]
v_mfma_f32_16x16x32_bf16 v[168:171], v[64:67], v[36:39], v[168:171]
v_mfma_f32_16x16x32_bf16 v[192:195], v[64:67], v[40:43], v[192:195]
v_mfma_f32_16x16x32_bf16 v[216:219], v[64:67], v[44:47], v[216:219]
v_mfma_f32_16x16x32_bf16 v[220:223], v[68:71], v[44:47], v[220:223]
v_mfma_f32_16x16x32_bf16 v[196:199], v[68:71], v[40:43], v[196:199]
v_mfma_f32_16x16x32_bf16 v[172:175], v[68:71], v[36:39], v[172:175]
v_mfma_f32_16x16x32_bf16 v[148:151], v[68:71], v[32:35], v[148:151]
s_waitcnt lgkmcnt(0)
s_barrier
v_mfma_f32_16x16x32_bf16 v[128:131], v[88:91], v[72:75], v[128:131]
ds_read_b128 v[32:35], v9 offset:0
v_mfma_f32_16x16x32_bf16 v[152:155], v[88:91], v[76:79], v[152:155]
ds_read_b64_tr_b16 v[48:49], v11 offset:0
v_mfma_f32_16x16x32_bf16 v[176:179], v[88:91], v[80:83], v[176:179]
ds_read_b64_tr_b16 v[50:51], v11 offset:3072
v_mfma_f32_16x16x32_bf16 v[200:203], v[88:91], v[84:87], v[200:203]
ds_read_b64_tr_b16 v[52:53], v12 offset:0
v_mfma_f32_16x16x32_bf16 v[204:207], v[92:95], v[84:87], v[204:207]
ds_read_b64_tr_b16 v[54:55], v12 offset:3072
v_mfma_f32_16x16x32_bf16 v[180:183], v[92:95], v[80:83], v[180:183]
ds_read_b64_tr_b16 v[56:57], v13 offset:0
v_mfma_f32_16x16x32_bf16 v[156:159], v[92:95], v[76:79], v[156:159]
ds_read_b64_tr_b16 v[58:59], v13 offset:3072
v_mfma_f32_16x16x32_bf16 v[132:135], v[92:95], v[72:75], v[132:135]
ds_read_b64_tr_b16 v[60:61], v11 offset:12288
v_mfma_f32_16x16x32_bf16 v[136:139], v[96:99], v[72:75], v[136:139]
ds_read_b64_tr_b16 v[62:63], v11 offset:15360
v_mfma_f32_16x16x32_bf16 v[160:163], v[96:99], v[76:79], v[160:163]
ds_read_b64_tr_b16 v[64:65], v12 offset:12288
v_mfma_f32_16x16x32_bf16 v[184:187], v[96:99], v[80:83], v[184:187]
ds_read_b64_tr_b16 v[66:67], v12 offset:15360
v_mfma_f32_16x16x32_bf16 v[208:211], v[96:99], v[84:87], v[208:211]
ds_read_b64_tr_b16 v[68:69], v13 offset:12288
v_mfma_f32_16x16x32_bf16 v[212:215], v[100:103], v[84:87], v[212:215]
ds_read_b64_tr_b16 v[70:71], v13 offset:15360
v_mfma_f32_16x16x32_bf16 v[188:191], v[100:103], v[80:83], v[188:191]
ds_read_b128 v[36:39], v9 offset:1024
v_mfma_f32_16x16x32_bf16 v[164:167], v[100:103], v[76:79], v[164:167]
ds_read_b128 v[40:43], v9 offset:2048
v_mfma_f32_16x16x32_bf16 v[140:143], v[100:103], v[72:75], v[140:143]
ds_read_b128 v[44:47], v9 offset:3072
v_mfma_f32_16x16x32_bf16 v[144:147], v[104:107], v[72:75], v[144:147]
v_mfma_f32_16x16x32_bf16 v[168:171], v[104:107], v[76:79], v[168:171]
v_mfma_f32_16x16x32_bf16 v[192:195], v[104:107], v[80:83], v[192:195]
v_mfma_f32_16x16x32_bf16 v[216:219], v[104:107], v[84:87], v[216:219]
v_mfma_f32_16x16x32_bf16 v[220:223], v[108:111], v[84:87], v[220:223]
v_mfma_f32_16x16x32_bf16 v[196:199], v[108:111], v[80:83], v[196:199]
v_mfma_f32_16x16x32_bf16 v[172:175], v[108:111], v[76:79], v[172:175]
v_mfma_f32_16x16x32_bf16 v[148:151], v[108:111], v[72:75], v[148:151]
s_waitcnt lgkmcnt(0)
v_mfma_f32_16x16x32_bf16 v[128:131], v[48:51], v[32:35], v[128:131]
ds_read_b128 v[72:75], v9 offset:8192
v_mfma_f32_16x16x32_bf16 v[152:155], v[48:51], v[36:39], v[152:155]
ds_read_b64_tr_b16 v[88:89], v11 offset:6144
v_mfma_f32_16x16x32_bf16 v[176:179], v[48:51], v[40:43], v[176:179]
ds_read_b64_tr_b16 v[90:91], v11 offset:9216
v_mfma_f32_16x16x32_bf16 v[200:203], v[48:51], v[44:47], v[200:203]
ds_read_b64_tr_b16 v[92:93], v12 offset:6144
v_mfma_f32_16x16x32_bf16 v[204:207], v[52:55], v[44:47], v[204:207]
ds_read_b64_tr_b16 v[94:95], v12 offset:9216
v_mfma_f32_16x16x32_bf16 v[180:183], v[52:55], v[40:43], v[180:183]
ds_read_b64_tr_b16 v[96:97], v13 offset:6144
v_mfma_f32_16x16x32_bf16 v[156:159], v[52:55], v[36:39], v[156:159]
ds_read_b64_tr_b16 v[98:99], v13 offset:9216
v_mfma_f32_16x16x32_bf16 v[132:135], v[52:55], v[32:35], v[132:135]
ds_read_b64_tr_b16 v[100:101], v11 offset:18432
v_mfma_f32_16x16x32_bf16 v[136:139], v[56:59], v[32:35], v[136:139]
ds_read_b64_tr_b16 v[102:103], v11 offset:21504
v_mfma_f32_16x16x32_bf16 v[160:163], v[56:59], v[36:39], v[160:163]
ds_read_b64_tr_b16 v[104:105], v12 offset:18432
v_mfma_f32_16x16x32_bf16 v[184:187], v[56:59], v[40:43], v[184:187]
ds_read_b64_tr_b16 v[106:107], v12 offset:21504
v_mfma_f32_16x16x32_bf16 v[208:211], v[56:59], v[44:47], v[208:211]
ds_read_b64_tr_b16 v[108:109], v13 offset:18432
v_mfma_f32_16x16x32_bf16 v[212:215], v[60:63], v[44:47], v[212:215]
ds_read_b64_tr_b16 v[110:111], v13 offset:21504
v_mfma_f32_16x16x32_bf16 v[188:191], v[60:63], v[40:43], v[188:191]
ds_read_b128 v[76:79], v9 offset:9216
v_mfma_f32_16x16x32_bf16 v[164:167], v[60:63], v[36:39], v[164:167]
ds_read_b128 v[80:83], v9 offset:10240
v_mfma_f32_16x16x32_bf16 v[140:143], v[60:63], v[32:35], v[140:143]
ds_read_b128 v[84:87], v9 offset:11264
v_mfma_f32_16x16x32_bf16 v[144:147], v[64:67], v[32:35], v[144:147]
v_mfma_f32_16x16x32_bf16 v[168:171], v[64:67], v[36:39], v[168:171]
v_mfma_f32_16x16x32_bf16 v[192:195], v[64:67], v[40:43], v[192:195]
v_mfma_f32_16x16x32_bf16 v[216:219], v[64:67], v[44:47], v[216:219]
v_mfma_f32_16x16x32_bf16 v[220:223], v[68:71], v[44:47], v[220:223]
v_mfma_f32_16x16x32_bf16 v[196:199], v[68:71], v[40:43], v[196:199]
v_mfma_f32_16x16x32_bf16 v[172:175], v[68:71], v[36:39], v[172:175]
v_mfma_f32_16x16x32_bf16 v[148:151], v[68:71], v[32:35], v[148:151]
s_waitcnt lgkmcnt(0)
s_barrier
v_mfma_f32_16x16x32_bf16 v[128:131], v[88:91], v[72:75], v[128:131]
ds_read_b128 v[32:35], v9 offset:49152
v_mfma_f32_16x16x32_bf16 v[152:155], v[88:91], v[76:79], v[152:155]
ds_read_b64_tr_b16 v[48:49], v14 offset:0
v_mfma_f32_16x16x32_bf16 v[176:179], v[88:91], v[80:83], v[176:179]
ds_read_b64_tr_b16 v[50:51], v14 offset:3072
v_mfma_f32_16x16x32_bf16 v[200:203], v[88:91], v[84:87], v[200:203]
ds_read_b64_tr_b16 v[52:53], v15 offset:0
v_mfma_f32_16x16x32_bf16 v[204:207], v[92:95], v[84:87], v[204:207]
ds_read_b64_tr_b16 v[54:55], v15 offset:3072
v_mfma_f32_16x16x32_bf16 v[180:183], v[92:95], v[80:83], v[180:183]
ds_read_b64_tr_b16 v[56:57], v16 offset:0
v_mfma_f32_16x16x32_bf16 v[156:159], v[92:95], v[76:79], v[156:159]
ds_read_b64_tr_b16 v[58:59], v16 offset:3072
v_mfma_f32_16x16x32_bf16 v[132:135], v[92:95], v[72:75], v[132:135]
ds_read_b64_tr_b16 v[60:61], v14 offset:12288
v_mfma_f32_16x16x32_bf16 v[136:139], v[96:99], v[72:75], v[136:139]
ds_read_b64_tr_b16 v[62:63], v14 offset:15360
v_mfma_f32_16x16x32_bf16 v[160:163], v[96:99], v[76:79], v[160:163]
ds_read_b64_tr_b16 v[64:65], v15 offset:12288
v_mfma_f32_16x16x32_bf16 v[184:187], v[96:99], v[80:83], v[184:187]
ds_read_b64_tr_b16 v[66:67], v15 offset:15360
v_mfma_f32_16x16x32_bf16 v[208:211], v[96:99], v[84:87], v[208:211]
ds_read_b64_tr_b16 v[68:69], v16 offset:12288
v_mfma_f32_16x16x32_bf16 v[212:215], v[100:103], v[84:87], v[212:215]
ds_read_b64_tr_b16 v[70:71], v16 offset:15360
v_mfma_f32_16x16x32_bf16 v[188:191], v[100:103], v[80:83], v[188:191]
ds_read_b128 v[36:39], v9 offset:50176
v_mfma_f32_16x16x32_bf16 v[164:167], v[100:103], v[76:79], v[164:167]
ds_read_b128 v[40:43], v9 offset:51200
v_mfma_f32_16x16x32_bf16 v[140:143], v[100:103], v[72:75], v[140:143]
ds_read_b128 v[44:47], v9 offset:52224
v_mfma_f32_16x16x32_bf16 v[144:147], v[104:107], v[72:75], v[144:147]
v_mfma_f32_16x16x32_bf16 v[168:171], v[104:107], v[76:79], v[168:171]
v_mfma_f32_16x16x32_bf16 v[192:195], v[104:107], v[80:83], v[192:195]
s_branch Lov_8
.p2align 12
.fill 64, 4, 0xbf800000
Lst_8_0:
s_branch Lwr_168
Lst_8_1:
s_branch Lwr_179
s_nop 0
Lov_8:
v_mfma_f32_16x16x32_bf16 v[216:219], v[104:107], v[84:87], v[216:219]
v_mfma_f32_16x16x32_bf16 v[220:223], v[108:111], v[84:87], v[220:223]
v_mfma_f32_16x16x32_bf16 v[196:199], v[108:111], v[80:83], v[196:199]
v_mfma_f32_16x16x32_bf16 v[172:175], v[108:111], v[76:79], v[172:175]
v_mfma_f32_16x16x32_bf16 v[148:151], v[108:111], v[72:75], v[148:151]
s_sub_u32 s41, s41, 1
s_cmp_lg_u32 s41, 0
s_cbranch_scc1 Lk3l_123
s_waitcnt lgkmcnt(0)
s_add_u32 s38, s35, 15
s_and_b32 s38, s38, 15
s_mul_i32 s38, s38, 458752
s_add_u32 m0, s40, 0
s_nop 0
buffer_load_dwordx4 v4, s[12:15], s38 offen lds
v_lshrrev_b32 v86, 4, v1
s_lshl_b32 s43, s63, 7
s_add_u32 s43, s43, 148992
v_lshl_add_u32 v87, v86, 4, s43
v_lshrrev_b32 v88, 1, v86
v_and_b32 v86, 1, v86
s_add_u32 m0, s40, 1024
s_nop 0
buffer_load_dwordx4 v5, s[12:15], s38 offen lds
s_lshl_b32 s43, s63, 5
s_add_u32 s43, s43, 149248
v_lshl_add_u32 v88, v88, 6, s43
v_lshl_add_u32 v88, v86, 4, v88
v_and_b32 v86, 15, v1
s_lshl_b32 s43, s62, 9
s_add_u32 m0, s40, 2048
s_add_u32 s38, s38, 57344
buffer_load_dwordx4 v4, s[12:15], s38 offen lds
s_add_u32 s43, s43, 147456
v_lshl_add_u32 v86, v86, 3, s43
ds_read_b128 v[32:35], v87 offset:0
ds_read_b128 v[36:39], v87 offset:64
ds_read_b128 v[40:43], v88 offset:0
ds_read_b128 v[44:47], v87 offset:896
s_add_u32 m0, s40, 3072
s_nop 0
buffer_load_dwordx4 v5, s[12:15], s38 offen lds
ds_read_b128 v[48:51], v87 offset:960
ds_read_b128 v[52:55], v88 offset:896
ds_read_b64 v[56:57], v86 offset:0
ds_read_b64 v[58:59], v86 offset:128
ds_read_b64 v[60:61], v86 offset:256
ds_read_b64 v[62:63], v86 offset:384
s_add_u32 m0, s40, 4096
s_add_u32 s38, s38, 57344
buffer_load_dwordx4 v4, s[12:15], s38 offen lds
s_mul_i32 s54, s35, 24576
s_lshl_b32 s43, s62, 12
s_add_u32 s54, s54, s43
s_add_u32 s54, s54, 524288
s_lshl_b32 s43, s63, 9
s_add_u32 s55, s54, s43
s_add_u32 m0, s40, 5120
s_nop 0
buffer_load_dwordx4 v5, s[12:15], s38 offen lds
s_add_u32 s55, s55, 16384
s_lshl_b32 s43, s63, 13
s_add_u32 s54, s54, s43
v_and_b32 v84, 32, v1
v_lshlrev_b32 v84, 4, v84
v_add_u32 v84, v84, v2
s_waitcnt lgkmcnt(0)
s_add_u32 m0, s40, 6144
s_add_u32 s38, s38, 57344
buffer_load_dwordx4 v4, s[12:15], s38 offen lds
s_add_u32 m0, s40, 7168
s_nop 0
buffer_load_dwordx4 v5, s[12:15], s38 offen lds
s_and_b32 s44, s36, 3
s_mul_i32 s43, s2, 28672
s_mul_i32 s44, s44, 7168
s_add_u32 s43, s43, s44
s_add_u32 s4, s76, s43
s_addc_u32 s5, s77, 0
s_barrier
s_cmp_eq_u32 s47, 3
s_cbranch_scc0 Lw_124
v_and_b32 v90, 31, v1
v_lshlrev_b32 v90, 4, v90
v_add_u32 v91, 153600, v90
ds_read_b128 v[108:111], v91 offset:0
ds_read_b128 v[112:115], v91 offset:512
ds_read_b128 v[116:119], v91 offset:1024
ds_read_b128 v[120:123], v91 offset:1536
s_and_b32 s44, s2, 15
s_mul_i32 s44, s44, 14336
s_lshr_b32 s43, s2, 4
s_lshl_b32 s43, s43, 9
s_add_u32 s44, s44, s43
s_waitcnt lgkmcnt(0)
v_add_f32 v108, v108, v112
v_add_f32 v116, v116, v120
v_add_f32 v109, v109, v113
v_add_f32 v117, v117, v121
v_add_f32 v110, v110, v114
v_add_f32 v118, v118, v122
v_add_f32 v111, v111, v115
v_add_f32 v119, v119, v123
v_add_f32 v108, v108, v116
v_add_f32 v109, v109, v117
v_add_f32 v110, v110, v118
v_add_f32 v111, v111, v119
s_mov_b64 exec, 0xffffffff
buffer_store_dwordx4 v[108:111], v90, s[84:87], s44 offen sc1
s_mov_b64 exec, -1
Lw_124:
s_waitcnt lgkmcnt(0)
s_add_u32 s37, s35, 0
s_and_b32 s37, s37, 15
s_mul_i32 s37, s37, 16384
s_add_u32 m0, s39, 49152
s_nop 0
buffer_load_dwordx4 v3, s[8:11], s37 offen sc1 lds
s_load_dword s3, s[4:5], 1792
s_load_dword s3, s[4:5], 1856
s_load_dword s3, s[4:5], 1920
s_load_dword s3, s[4:5], 1984
s_load_dword s3, s[4:5], 2048
s_load_dword s3, s[4:5], 2112
s_load_dword s3, s[4:5], 2176
buffer_load_dwordx4 v3, s[8:11], s37 offen offset:1024 sc1 lds
s_load_dword s3, s[4:5], 2240
s_load_dword s3, s[4:5], 2304
s_load_dword s3, s[4:5], 2368
s_load_dword s3, s[4:5], 2432
s_load_dword s3, s[4:5], 2496
s_load_dword s3, s[4:5], 2560
s_load_dword s3, s[4:5], 2624
buffer_load_dwordx4 v3, s[8:11], s37 offen offset:2048 sc1 lds
v_mul_f32 v66, v57, v57
v_mul_f32 v64, 0xc0135761, v57
v_mul_f32 v65, 0xbdd2d3e8, v57
v_mul_f32 v65, v65, v66
v_rcp_f32 v66, v66
v_mul_f32 v70, v59, v59
v_mul_f32 v68, 0xc0135761, v59
buffer_load_dwordx4 v3, s[8:11], s37 offen offset:3072 sc1 lds
v_mul_f32 v69, 0xbdd2d3e8, v59
v_mul_f32 v69, v69, v70
v_rcp_f32 v70, v70
v_fma_f32 v128, -v56, v32, v128
v_fma_f32 v129, -v56, v33, v129
v_fma_f32 v130, -v56, v34, v130
v_fma_f32 v131, -v56, v35, v131
v_fma_f32 v152, -v58, v32, v152
s_add_u32 s38, s35, 0
s_and_b32 s38, s38, 15
s_mul_i32 s38, s38, 458752
s_add_u32 m0, s40, 49152
s_nop 0
buffer_load_dwordx4 v4, s[12:15], s38 offen lds
v_fma_f32 v153, -v58, v33, v153
v_fma_f32 v154, -v58, v34, v154
v_fma_f32 v155, -v58, v35, v155
v_mul_f32 v72, v128, v128
v_mul_f32 v73, v129, v129
v_mul_f32 v74, v130, v130
v_mul_f32 v75, v131, v131
s_add_u32 m0, s40, 50176
s_nop 0
buffer_load_dwordx4 v5, s[12:15], s38 offen lds
v_mul_f32 v76, v152, v152
v_mul_f32 v77, v153, v153
v_mul_f32 v78, v154, v154
v_mul_f32 v79, v155, v155
v_fma_f32 v72, v72, v65, v64
v_fma_f32 v73, v73, v65, v64
v_fma_f32 v74, v74, v65, v64
s_add_u32 m0, s40, 51200
s_add_u32 s38, s38, 57344
buffer_load_dwordx4 v4, s[12:15], s38 offen lds
v_fma_f32 v75, v75, v65, v64
v_fma_f32 v76, v76, v69, v68
v_fma_f32 v77, v77, v69, v68
v_fma_f32 v78, v78, v69, v68
v_fma_f32 v79, v79, v69, v68
v_mul_f32 v72, v72, v128
v_mul_f32 v73, v73, v129
v_mul_f32 v74, v74, v130
s_add_u32 m0, s40, 52224
s_nop 0
buffer_load_dwordx4 v5, s[12:15], s38 offen lds
v_mul_f32 v75, v75, v131
v_mul_f32 v76, v76, v152
v_mul_f32 v77, v77, v153
v_mul_f32 v78, v78, v154
v_mul_f32 v79, v79, v155
v_exp_f32 v72, v72
v_exp_f32 v73, v73
s_add_u32 m0, s40, 53248
s_add_u32 s38, s38, 57344
buffer_load_dwordx4 v4, s[12:15], s38 offen lds
v_exp_f32 v74, v74
v_exp_f32 v75, v75
v_exp_f32 v76, v76
v_exp_f32 v77, v77
v_exp_f32 v78, v78
v_exp_f32 v79, v79
v_fma_f32 v140, -v56, v44, v140
s_add_u32 m0, s40, 54272
s_nop 0
buffer_load_dwordx4 v5, s[12:15], s38 offen lds
v_fma_f32 v141, -v56, v45, v141
v_fma_f32 v142, -v56, v46, v142
v_fma_f32 v143, -v56, v47, v143
v_fma_f32 v164, -v58, v44, v164
v_fma_f32 v165, -v58, v45, v165
v_fma_f32 v166, -v58, v46, v166
v_fma_f32 v167, -v58, v47, v167
v_fma_f32 v72, v72, v66, v66
s_add_u32 m0, s40, 55296
s_add_u32 s38, s38, 57344
buffer_load_dwordx4 v4, s[12:15], s38 offen lds
s_add_u32 m0, s40, 56320
s_nop 0
buffer_load_dwordx4 v5, s[12:15], s38 offen lds
s_waitcnt vmcnt(12)
s_barrier
s_add_u32 s37, s35, 1
s_and_b32 s37, s37, 15
s_mul_i32 s37, s37, 16384
s_add_u32 m0, s39, 98304
s_nop 0
buffer_load_dwordx4 v3, s[8:11], s37 offen sc1 lds
v_fma_f32 v73, v73, v66, v66
v_fma_f32 v74, v74, v66, v66
v_fma_f32 v75, v75, v66, v66
v_fma_f32 v76, v76, v70, v70
v_fma_f32 v77, v77, v70, v70
v_fma_f32 v78, v78, v70, v70
buffer_load_dwordx4 v3, s[8:11], s37 offen offset:1024 sc1 lds
v_fma_f32 v79, v79, v70, v70
v_rcp_f32 v72, v72
v_rcp_f32 v73, v73
v_rcp_f32 v74, v74
v_rcp_f32 v75, v75
v_rcp_f32 v76, v76
buffer_load_dwordx4 v3, s[8:11], s37 offen offset:2048 sc1 lds
v_rcp_f32 v77, v77
v_rcp_f32 v78, v78
v_rcp_f32 v79, v79
v_mul_f32 v140, v128, v140
v_mul_f32 v141, v129, v141
v_mul_f32 v142, v130, v142
buffer_load_dwordx4 v3, s[8:11], s37 offen offset:3072 sc1 lds
v_mul_f32 v143, v131, v143
v_mul_f32 v164, v152, v164
v_mul_f32 v165, v153, v165
v_mul_f32 v166, v154, v166
v_mul_f32 v167, v155, v167
v_mul_f32 v140, v140, v72
s_add_u32 s38, s35, 1
s_and_b32 s38, s38, 15
s_mul_i32 s38, s38, 458752
s_add_u32 m0, s40, 98304
s_nop 0
buffer_load_dwordx4 v4, s[12:15], s38 offen lds
v_mul_f32 v141, v141, v73
v_mul_f32 v142, v142, v74
v_mul_f32 v143, v143, v75
v_mul_f32 v164, v164, v76
v_mul_f32 v165, v165, v77
v_mul_f32 v166, v166, v78
s_add_u32 m0, s40, 99328
s_nop 0
buffer_load_dwordx4 v5, s[12:15], s38 offen lds
v_mul_f32 v167, v167, v79
v_cvt_pk_bf16_f32 v128, v140, v141
v_cvt_pk_bf16_f32 v129, v142, v143
v_cvt_pk_bf16_f32 v152, v164, v165
v_cvt_pk_bf16_f32 v153, v166, v167
v_fma_f32 v132, -v56, v36, v132
s_add_u32 m0, s40, 100352
s_add_u32 s38, s38, 57344
buffer_load_dwordx4 v4, s[12:15], s38 offen lds
v_fma_f32 v133, -v56, v37, v133
v_fma_f32 v134, -v56, v38, v134
v_fma_f32 v135, -v56, v39, v135
v_fma_f32 v156, -v58, v36, v156
v_fma_f32 v157, -v58, v37, v157
v_fma_f32 v158, -v58, v38, v158
s_add_u32 m0, s40, 101376
s_nop 0
buffer_load_dwordx4 v5, s[12:15], s38 offen lds
v_fma_f32 v159, -v58, v39, v159
v_mul_f32 v72, v132, v132
v_mul_f32 v73, v133, v133
v_mul_f32 v74, v134, v134
v_mul_f32 v75, v135, v135
v_mul_f32 v76, v156, v156
s_add_u32 m0, s40, 102400
s_add_u32 s38, s38, 57344
buffer_load_dwordx4 v4, s[12:15], s38 offen lds
v_mul_f32 v77, v157, v157
v_mul_f32 v78, v158, v158
v_mul_f32 v79, v159, v159
v_fma_f32 v72, v72, v65, v64
v_fma_f32 v73, v73, v65, v64
v_fma_f32 v74, v74, v65, v64
s_add_u32 m0, s40, 103424
s_nop 0
buffer_load_dwordx4 v5, s[12:15], s38 offen lds
v_fma_f32 v75, v75, v65, v64
v_fma_f32 v76, v76, v69, v68
v_fma_f32 v77, v77, v69, v68
v_fma_f32 v78, v78, v69, v68
v_fma_f32 v79, v79, v69, v68
v_mul_f32 v72, v72, v132
s_add_u32 m0, s40, 104448
s_add_u32 s38, s38, 57344
buffer_load_dwordx4 v4, s[12:15], s38 offen lds
s_add_u32 m0, s40, 105472
s_nop 0
buffer_load_dwordx4 v5, s[12:15], s38 offen lds
s_waitcnt vmcnt(12)
s_barrier
s_cmp_eq_u32 s47, 3
s_cbranch_scc0 Lw_125
s_lshr_b32 s43, s2, 4
s_add_u32 s43, s43, 80
s_lshl_b32 s43, s43, 7
v_mov_b32 v90, s43
v_mov_b32 v91, 1
s_mov_b64 exec, 1
buffer_atomic_add v91, v90, s[56:59], 0 offen sc1
s_mov_b64 exec, -1
Lw_125:
s_waitcnt lgkmcnt(0)
s_add_u32 s37, s35, 2
s_and_b32 s37, s37, 15
s_mul_i32 s37, s37, 16384
s_add_u32 m0, s39, 0
s_nop 0
buffer_load_dwordx4 v3, s[8:11], s37 offen sc1 lds
s_load_dword s3, s[4:5], 2688
s_load_dword s3, s[4:5], 2752
s_load_dword s3, s[4:5], 2816
s_load_dword s3, s[4:5], 2880
s_load_dword s3, s[4:5], 2944
s_load_dword s3, s[4:5], 3008
s_load_dword s3, s[4:5], 3072
buffer_load_dwordx4 v3, s[8:11], s37 offen offset:1024 sc1 lds
s_load_dword s3, s[4:5], 3136
s_load_dword s3, s[4:5], 3200
s_load_dword s3, s[4:5], 3264
s_load_dword s3, s[4:5], 3328
s_load_dword s3, s[4:5], 3392
s_load_dword s3, s[4:5], 3456
s_load_dword s3, s[4:5], 3520
buffer_load_dwordx4 v3, s[8:11], s37 offen offset:2048 sc1 lds
v_mul_f32 v73, v73, v133
v_mul_f32 v74, v74, v134
v_mul_f32 v75, v75, v135
v_mul_f32 v76, v76, v156
v_mul_f32 v77, v77, v157
v_mul_f32 v78, v78, v158
v_mul_f32 v79, v79, v159
v_exp_f32 v72, v72
buffer_load_dwordx4 v3, s[8:11], s37 offen offset:3072 sc1 lds
v_exp_f32 v73, v73
v_exp_f32 v74, v74
v_exp_f32 v75, v75
v_exp_f32 v76, v76
v_exp_f32 v77, v77
v_exp_f32 v78, v78
v_exp_f32 v79, v79
s_add_u32 s38, s35, 2
s_and_b32 s38, s38, 15
s_mul_i32 s38, s38, 458752
s_add_u32 m0, s40, 0
s_nop 0
buffer_load_dwordx4 v4, s[12:15], s38 offen lds
v_fma_f32 v144, -v56, v48, v144
v_fma_f32 v145, -v56, v49, v145
v_fma_f32 v146, -v56, v50, v146
v_fma_f32 v147, -v56, v51, v147
v_fma_f32 v168, -v58, v48, v168
v_fma_f32 v169, -v58, v49, v169
v_fma_f32 v170, -v58, v50, v170
v_fma_f32 v171, -v58, v51, v171
s_add_u32 m0, s40, 1024
s_nop 0
buffer_load_dwordx4 v5, s[12:15], s38 offen lds
v_fma_f32 v72, v72, v66, v66
v_fma_f32 v73, v73, v66, v66
v_fma_f32 v74, v74, v66, v66
v_fma_f32 v75, v75, v66, v66
v_fma_f32 v76, v76, v70, v70
v_fma_f32 v77, v77, v70, v70
v_fma_f32 v78, v78, v70, v70
s_add_u32 m0, s40, 2048
s_add_u32 s38, s38, 57344
buffer_load_dwordx4 v4, s[12:15], s38 offen lds
v_fma_f32 v79, v79, v70, v70
v_rcp_f32 v72, v72
v_rcp_f32 v73, v73
v_rcp_f32 v74, v74
v_rcp_f32 v75, v75
v_rcp_f32 v76, v76
v_rcp_f32 v77, v77
s_add_u32 m0, s40, 3072
s_nop 0
buffer_load_dwordx4 v5, s[12:15], s38 offen lds
v_rcp_f32 v78, v78
v_rcp_f32 v79, v79
v_mul_f32 v144, v132, v144
v_mul_f32 v145, v133, v145
v_mul_f32 v146, v134, v146
v_mul_f32 v147, v135, v147
v_mul_f32 v168, v156, v168
v_mul_f32 v169, v157, v169
s_add_u32 m0, s40, 4096
s_add_u32 s38, s38, 57344
buffer_load_dwordx4 v4, s[12:15], s38 offen lds
v_mul_f32 v170, v158, v170
v_mul_f32 v171, v159, v171
v_mul_f32 v144, v144, v72
v_mul_f32 v145, v145, v73
v_mul_f32 v146, v146, v74
v_mul_f32 v147, v147, v75
v_mul_f32 v168, v168, v76
s_add_u32 m0, s40, 5120
s_nop 0
buffer_load_dwordx4 v5, s[12:15], s38 offen lds
v_mul_f32 v169, v169, v77
v_mul_f32 v170, v170, v78
v_mul_f32 v171, v171, v79
v_cvt_pk_bf16_f32 v130, v144, v145
v_cvt_pk_bf16_f32 v131, v146, v147
v_cvt_pk_bf16_f32 v154, v168, v169
v_cvt_pk_bf16_f32 v155, v170, v171
buffer_store_dwordx4 v[128:131], v2, s[24:27], s54 offen offset:0 sc1
s_add_u32 m0, s40, 6144
s_add_u32 s38, s38, 57344
buffer_load_dwordx4 v4, s[12:15], s38 offen lds
s_add_u32 m0, s40, 7168
s_nop 0
buffer_load_dwordx4 v5, s[12:15], s38 offen lds
s_waitcnt vmcnt(13)
s_barrier
s_add_u32 s37, s35, 3
s_and_b32 s37, s37, 15
s_mul_i32 s37, s37, 16384
s_add_u32 m0, s39, 49152
s_nop 0
buffer_load_dwordx4 v3, s[8:11], s37 offen sc1 lds
buffer_store_dwordx4 v[152:155], v2, s[24:27], s54 offen offset:1024 sc1
v_fma_f32 v136, -v56, v40, v136
v_fma_f32 v137, -v56, v41, v137
v_fma_f32 v138, -v56, v42, v138
v_fma_f32 v139, -v56, v43, v139
v_fma_f32 v160, -v58, v40, v160
buffer_load_dwordx4 v3, s[8:11], s37 offen offset:1024 sc1 lds
v_fma_f32 v161, -v58, v41, v161
v_fma_f32 v162, -v58, v42, v162
v_fma_f32 v163, -v58, v43, v163
v_mul_f32 v72, v136, v136
v_mul_f32 v73, v137, v137
v_mul_f32 v74, v138, v138
buffer_load_dwordx4 v3, s[8:11], s37 offen offset:2048 sc1 lds
v_mul_f32 v75, v139, v139
v_mul_f32 v76, v160, v160
v_mul_f32 v77, v161, v161
v_mul_f32 v78, v162, v162
v_mul_f32 v79, v163, v163
v_fma_f32 v72, v72, v65, v64
buffer_load_dwordx4 v3, s[8:11], s37 offen offset:3072 sc1 lds
v_fma_f32 v73, v73, v65, v64
v_fma_f32 v74, v74, v65, v64
v_fma_f32 v75, v75, v65, v64
v_fma_f32 v76, v76, v69, v68
v_fma_f32 v77, v77, v69, v68
v_fma_f32 v78, v78, v69, v68
s_add_u32 s38, s35, 3
s_and_b32 s38, s38, 15
s_mul_i32 s38, s38, 458752
s_add_u32 m0, s40, 49152
s_nop 0
buffer_load_dwordx4 v4, s[12:15], s38 offen lds
v_fma_f32 v79, v79, v69, v68
v_mul_f32 v72, v72, v136
v_mul_f32 v73, v73, v137
v_mul_f32 v74, v74, v138
v_mul_f32 v75, v75, v139
v_mul_f32 v76, v76, v160
s_add_u32 m0, s40, 50176
s_nop 0
buffer_load_dwordx4 v5, s[12:15], s38 offen lds
v_mul_f32 v77, v77, v161
v_mul_f32 v78, v78, v162
v_mul_f32 v79, v79, v163
v_exp_f32 v72, v72
v_exp_f32 v73, v73
v_exp_f32 v74, v74
s_add_u32 m0, s40, 51200
s_add_u32 s38, s38, 57344
buffer_load_dwordx4 v4, s[12:15], s38 offen lds
v_exp_f32 v75, v75
v_exp_f32 v76, v76
v_exp_f32 v77, v77
v_exp_f32 v78, v78
v_exp_f32 v79, v79
v_fma_f32 v148, -v56, v52, v148
s_add_u32 m0, s40, 52224
s_nop 0
buffer_load_dwordx4 v5, s[12:15], s38 offen lds
v_fma_f32 v149, -v56, v53, v149
v_fma_f32 v150, -v56, v54, v150
v_fma_f32 v151, -v56, v55, v151
v_fma_f32 v172, -v58, v52, v172
v_fma_f32 v173, -v58, v53, v173
v_fma_f32 v174, -v58, v54, v174
s_add_u32 m0, s40, 53248
s_add_u32 s38, s38, 57344
buffer_load_dwordx4 v4, s[12:15], s38 offen lds
v_fma_f32 v175, -v58, v55, v175
v_fma_f32 v72, v72, v66, v66
v_fma_f32 v73, v73, v66, v66
v_fma_f32 v74, v74, v66, v66
v_fma_f32 v75, v75, v66, v66
v_fma_f32 v76, v76, v70, v70
s_add_u32 m0, s40, 54272
s_nop 0
buffer_load_dwordx4 v5, s[12:15], s38 offen lds
v_fma_f32 v77, v77, v70, v70
v_fma_f32 v78, v78, v70, v70
v_fma_f32 v79, v79, v70, v70
v_rcp_f32 v72, v72
v_rcp_f32 v73, v73
v_rcp_f32 v74, v74
s_add_u32 m0, s40, 55296
s_add_u32 s38, s38, 57344
buffer_load_dwordx4 v4, s[12:15], s38 offen lds
s_add_u32 m0, s40, 56320
s_nop 0
buffer_load_dwordx4 v5, s[12:15], s38 offen lds
s_waitcnt vmcnt(13)
s_barrier
s_waitcnt lgkmcnt(0)
s_add_u32 s37, s35, 4
s_and_b32 s37, s37, 15
s_mul_i32 s37, s37, 16384
s_add_u32 m0, s39, 98304
s_nop 0
buffer_load_dwordx4 v3, s[8:11], s37 offen sc1 lds
s_load_dword s3, s[4:5], 3584
s_load_dword s3, s[4:5], 3648
s_load_dword s3, s[4:5], 3712
s_load_dword s3, s[4:5], 3776
s_load_dword s3, s[4:5], 3840
s_load_dword s3, s[4:5], 3904
s_load_dword s3, s[4:5], 3968
buffer_load_dwordx4 v3, s[8:11], s37 offen offset:1024 sc1 lds
s_load_dword s3, s[4:5], 4032
s_load_dword s3, s[4:5], 4096
s_load_dword s3, s[4:5], 4160
s_load_dword s3, s[4:5], 4224
s_load_dword s3, s[4:5], 4288
s_load_dword s3, s[4:5], 4352
s_load_dword s3, s[4:5], 4416
buffer_load_dwordx4 v3, s[8:11], s37 offen offset:2048 sc1 lds
v_rcp_f32 v75, v75
v_rcp_f32 v76, v76
v_rcp_f32 v77, v77
v_rcp_f32 v78, v78
v_rcp_f32 v79, v79
v_mul_f32 v148, v136, v148
v_mul_f32 v149, v137, v149
buffer_load_dwordx4 v3, s[8:11], s37 offen offset:3072 sc1 lds
v_mul_f32 v150, v138, v150
v_mul_f32 v151, v139, v151
v_mul_f32 v172, v160, v172
v_mul_f32 v173, v161, v173
v_mul_f32 v174, v162, v174
v_mul_f32 v175, v163, v175
v_mul_f32 v148, v148, v72
v_mul_f32 v149, v149, v73
s_add_u32 s38, s35, 4
s_and_b32 s38, s38, 15
s_mul_i32 s38, s38, 458752
s_add_u32 m0, s40, 98304
s_nop 0
buffer_load_dwordx4 v4, s[12:15], s38 offen lds
v_mul_f32 v150, v150, v74
v_mul_f32 v151, v151, v75
v_mul_f32 v172, v172, v76
v_mul_f32 v173, v173, v77
v_mul_f32 v174, v174, v78
v_mul_f32 v175, v175, v79
v_cvt_pk_bf16_f32 v80, v148, v149
s_add_u32 m0, s40, 99328
s_nop 0
buffer_load_dwordx4 v5, s[12:15], s38 offen lds
v_cvt_pk_bf16_f32 v81, v150, v151
v_cvt_pk_bf16_f32 v82, v172, v173
v_cvt_pk_bf16_f32 v83, v174, v175
s_nop 1
v_permlane32_swap_b32 v80, v82
v_permlane32_swap_b32 v81, v83
buffer_store_dwordx4 v[80:83], v84, s[24:27], s55 offen offset:0 sc1
s_add_u32 m0, s40, 100352
s_add_u32 s38, s38, 57344
buffer_load_dwordx4 v4, s[12:15], s38 offen lds
s_nop 1
v_mul_f32 v66, v61, v61
v_mul_f32 v64, 0xc0135761, v61
v_mul_f32 v65, 0xbdd2d3e8, v61
v_mul_f32 v65, v65, v66
v_rcp_f32 v66, v66
v_mul_f32 v70, v63, v63
v_mul_f32 v68, 0xc0135761, v63
s_add_u32 m0, s40, 101376
s_nop 0
buffer_load_dwordx4 v5, s[12:15], s38 offen lds
v_mul_f32 v69, 0xbdd2d3e8, v63
v_mul_f32 v69, v69, v70
v_rcp_f32 v70, v70
s_branch Lov_9
.p2align 12
.fill 64, 4, 0xbf800000
Lst_9_0:
s_branch Lwr_169
Lst_9_1:
s_branch Lwr_180
s_nop 0
Lov_9:
v_fma_f32 v176, -v60, v32, v176
v_fma_f32 v177, -v60, v33, v177
v_fma_f32 v178, -v60, v34, v178
v_fma_f32 v179, -v60, v35, v179
s_add_u32 m0, s40, 102400
s_add_u32 s38, s38, 57344
buffer_load_dwordx4 v4, s[12:15], s38 offen lds
v_fma_f32 v200, -v62, v32, v200
v_fma_f32 v201, -v62, v33, v201
v_fma_f32 v202, -v62, v34, v202
v_fma_f32 v203, -v62, v35, v203
v_mul_f32 v72, v176, v176
v_mul_f32 v73, v177, v177
v_mul_f32 v74, v178, v178
s_add_u32 m0, s40, 103424
s_nop 0
buffer_load_dwordx4 v5, s[12:15], s38 offen lds
v_mul_f32 v75, v179, v179
v_mul_f32 v76, v200, v200
v_mul_f32 v77, v201, v201
v_mul_f32 v78, v202, v202
v_mul_f32 v79, v203, v203
v_fma_f32 v72, v72, v65, v64
v_fma_f32 v73, v73, v65, v64
v_fma_f32 v74, v74, v65, v64
s_add_u32 m0, s40, 104448
s_add_u32 s38, s38, 57344
buffer_load_dwordx4 v4, s[12:15], s38 offen lds
s_add_u32 m0, s40, 105472
s_nop 0
buffer_load_dwordx4 v5, s[12:15], s38 offen lds
s_waitcnt vmcnt(13)
s_barrier
s_add_u32 s37, s35, 5
s_and_b32 s37, s37, 15
s_mul_i32 s37, s37, 16384
s_add_u32 m0, s39, 0
s_nop 0
buffer_load_dwordx4 v3, s[8:11], s37 offen sc1 lds
v_fma_f32 v75, v75, v65, v64
v_fma_f32 v76, v76, v69, v68
v_fma_f32 v77, v77, v69, v68
v_fma_f32 v78, v78, v69, v68
v_fma_f32 v79, v79, v69, v68
v_mul_f32 v72, v72, v176
buffer_load_dwordx4 v3, s[8:11], s37 offen offset:1024 sc1 lds
v_mul_f32 v73, v73, v177
v_mul_f32 v74, v74, v178
v_mul_f32 v75, v75, v179
v_mul_f32 v76, v76, v200
v_mul_f32 v77, v77, v201
v_mul_f32 v78, v78, v202
buffer_load_dwordx4 v3, s[8:11], s37 offen offset:2048 sc1 lds
v_mul_f32 v79, v79, v203
v_exp_f32 v72, v72
v_exp_f32 v73, v73
v_exp_f32 v74, v74
v_exp_f32 v75, v75
v_exp_f32 v76, v76
buffer_load_dwordx4 v3, s[8:11], s37 offen offset:3072 sc1 lds
v_exp_f32 v77, v77
v_exp_f32 v78, v78
v_exp_f32 v79, v79
v_fma_f32 v188, -v60, v44, v188
v_fma_f32 v189, -v60, v45, v189
v_fma_f32 v190, -v60, v46, v190
s_add_u32 s38, s35, 5
s_and_b32 s38, s38, 15
s_mul_i32 s38, s38, 458752
s_add_u32 m0, s40, 0
s_nop 0
buffer_load_dwordx4 v4, s[12:15], s38 offen lds
v_fma_f32 v191, -v60, v47, v191
v_fma_f32 v212, -v62, v44, v212
v_fma_f32 v213, -v62, v45, v213
v_fma_f32 v214, -v62, v46, v214
v_fma_f32 v215, -v62, v47, v215
v_fma_f32 v72, v72, v66, v66
s_add_u32 m0, s40, 1024
s_nop 0
buffer_load_dwordx4 v5, s[12:15], s38 offen lds
v_fma_f32 v73, v73, v66, v66
v_fma_f32 v74, v74, v66, v66
v_fma_f32 v75, v75, v66, v66
v_fma_f32 v76, v76, v70, v70
v_fma_f32 v77, v77, v70, v70
v_fma_f32 v78, v78, v70, v70
s_add_u32 m0, s40, 2048
s_add_u32 s38, s38, 57344
buffer_load_dwordx4 v4, s[12:15], s38 offen lds
v_fma_f32 v79, v79, v70, v70
v_rcp_f32 v72, v72
v_rcp_f32 v73, v73
v_rcp_f32 v74, v74
v_rcp_f32 v75, v75
v_rcp_f32 v76, v76
s_add_u32 m0, s40, 3072
s_nop 0
buffer_load_dwordx4 v5, s[12:15], s38 offen lds
v_rcp_f32 v77, v77
v_rcp_f32 v78, v78
v_rcp_f32 v79, v79
v_mul_f32 v188, v176, v188
v_mul_f32 v189, v177, v189
v_mul_f32 v190, v178, v190
s_add_u32 m0, s40, 4096
s_add_u32 s38, s38, 57344
buffer_load_dwordx4 v4, s[12:15], s38 offen lds
v_mul_f32 v191, v179, v191
v_mul_f32 v212, v200, v212
v_mul_f32 v213, v201, v213
v_mul_f32 v214, v202, v214
v_mul_f32 v215, v203, v215
v_mul_f32 v188, v188, v72
s_add_u32 m0, s40, 5120
s_nop 0
buffer_load_dwordx4 v5, s[12:15], s38 offen lds
v_mul_f32 v189, v189, v73
v_mul_f32 v190, v190, v74
v_mul_f32 v191, v191, v75
v_mul_f32 v212, v212, v76
v_mul_f32 v213, v213, v77
v_mul_f32 v214, v214, v78
s_add_u32 m0, s40, 6144
s_add_u32 s38, s38, 57344
buffer_load_dwordx4 v4, s[12:15], s38 offen lds
s_add_u32 m0, s40, 7168
s_nop 0
buffer_load_dwordx4 v5, s[12:15], s38 offen lds
s_waitcnt vmcnt(12)
s_barrier
s_waitcnt lgkmcnt(0)
s_cmp_eq_u32 s47, 3
s_cbranch_scc0 Lw_126
s_lshl_b32 s60, s35, 7
s_add_u32 s60, s60, 28321792
s_mov_b32 s61, s60
s_load_dword s92, s[82:83], s60 glc
s_load_dword s93, s[82:83], s61 glc
Lw_126:
s_add_u32 s37, s35, 6
s_and_b32 s37, s37, 15
s_mul_i32 s37, s37, 16384
s_add_u32 m0, s39, 49152
s_nop 0
buffer_load_dwordx4 v3, s[8:11], s37 offen sc1 lds
s_load_dword s3, s[4:5], 4480
s_load_dword s3, s[4:5], 4544
s_load_dword s3, s[4:5], 4608
s_load_dword s3, s[4:5], 4672
s_load_dword s3, s[4:5], 4736
s_load_dword s3, s[4:5], 4800
s_load_dword s3, s[4:5], 4864
buffer_load_dwordx4 v3, s[8:11], s37 offen offset:1024 sc1 lds
s_load_dword s3, s[4:5], 4928
s_load_dword s3, s[4:5], 4992
s_load_dword s3, s[4:5], 5056
s_load_dword s3, s[4:5], 5120
s_load_dword s3, s[4:5], 5184
s_load_dword s3, s[4:5], 5248
s_load_dword s3, s[4:5], 5312
buffer_load_dwordx4 v3, s[8:11], s37 offen offset:2048 sc1 lds
v_mul_f32 v215, v215, v79
v_cvt_pk_bf16_f32 v176, v188, v189
v_cvt_pk_bf16_f32 v177, v190, v191
v_cvt_pk_bf16_f32 v200, v212, v213
v_cvt_pk_bf16_f32 v201, v214, v215
v_fma_f32 v180, -v60, v36, v180
v_fma_f32 v181, -v60, v37, v181
v_fma_f32 v182, -v60, v38, v182
buffer_load_dwordx4 v3, s[8:11], s37 offen offset:3072 sc1 lds
v_fma_f32 v183, -v60, v39, v183
v_fma_f32 v204, -v62, v36, v204
v_fma_f32 v205, -v62, v37, v205
v_fma_f32 v206, -v62, v38, v206
v_fma_f32 v207, -v62, v39, v207
v_mul_f32 v72, v180, v180
v_mul_f32 v73, v181, v181
s_add_u32 s38, s35, 6
s_and_b32 s38, s38, 15
s_mul_i32 s38, s38, 458752
s_add_u32 m0, s40, 49152
s_nop 0
buffer_load_dwordx4 v4, s[12:15], s38 offen lds
v_mul_f32 v74, v182, v182
v_mul_f32 v75, v183, v183
v_mul_f32 v76, v204, v204
v_mul_f32 v77, v205, v205
v_mul_f32 v78, v206, v206
v_mul_f32 v79, v207, v207
v_fma_f32 v72, v72, v65, v64
v_fma_f32 v73, v73, v65, v64
s_add_u32 m0, s40, 50176
s_nop 0
buffer_load_dwordx4 v5, s[12:15], s38 offen lds
v_fma_f32 v74, v74, v65, v64
v_fma_f32 v75, v75, v65, v64
v_fma_f32 v76, v76, v69, v68
v_fma_f32 v77, v77, v69, v68
v_fma_f32 v78, v78, v69, v68
v_fma_f32 v79, v79, v69, v68
v_mul_f32 v72, v72, v180
s_add_u32 m0, s40, 51200
s_add_u32 s38, s38, 57344
buffer_load_dwordx4 v4, s[12:15], s38 offen lds
v_mul_f32 v73, v73, v181
v_mul_f32 v74, v74, v182
v_mul_f32 v75, v75, v183
v_mul_f32 v76, v76, v204
v_mul_f32 v77, v77, v205
v_mul_f32 v78, v78, v206
v_mul_f32 v79, v79, v207
s_add_u32 m0, s40, 52224
s_nop 0
buffer_load_dwordx4 v5, s[12:15], s38 offen lds
v_exp_f32 v72, v72
v_exp_f32 v73, v73
v_exp_f32 v74, v74
v_exp_f32 v75, v75
v_exp_f32 v76, v76
v_exp_f32 v77, v77
v_exp_f32 v78, v78
v_exp_f32 v79, v79
s_add_u32 m0, s40, 53248
s_add_u32 s38, s38, 57344
buffer_load_dwordx4 v4, s[12:15], s38 offen lds
v_fma_f32 v192, -v60, v48, v192
v_fma_f32 v193, -v60, v49, v193
v_fma_f32 v194, -v60, v50, v194
v_fma_f32 v195, -v60, v51, v195
v_fma_f32 v216, -v62, v48, v216
v_fma_f32 v217, -v62, v49, v217
v_fma_f32 v218, -v62, v50, v218
s_add_u32 m0, s40, 54272
s_nop 0
buffer_load_dwordx4 v5, s[12:15], s38 offen lds
v_fma_f32 v219, -v62, v51, v219
v_fma_f32 v72, v72, v66, v66
v_fma_f32 v73, v73, v66, v66
v_fma_f32 v74, v74, v66, v66
v_fma_f32 v75, v75, v66, v66
v_fma_f32 v76, v76, v70, v70
v_fma_f32 v77, v77, v70, v70
v_fma_f32 v78, v78, v70, v70
s_add_u32 m0, s40, 55296
s_add_u32 s38, s38, 57344
buffer_load_dwordx4 v4, s[12:15], s38 offen lds
s_add_u32 m0, s40, 56320
s_nop 0
buffer_load_dwordx4 v5, s[12:15], s38 offen lds
s_waitcnt vmcnt(12)
s_barrier
s_add_u32 s37, s35, 7
s_and_b32 s37, s37, 15
s_mul_i32 s37, s37, 16384
s_add_u32 m0, s39, 98304
s_nop 0
buffer_load_dwordx4 v3, s[8:11], s37 offen sc1 lds
v_fma_f32 v79, v79, v70, v70
v_rcp_f32 v72, v72
v_rcp_f32 v73, v73
v_rcp_f32 v74, v74
v_rcp_f32 v75, v75
v_rcp_f32 v76, v76
buffer_load_dwordx4 v3, s[8:11], s37 offen offset:1024 sc1 lds
v_rcp_f32 v77, v77
v_rcp_f32 v78, v78
v_rcp_f32 v79, v79
v_mul_f32 v192, v180, v192
v_mul_f32 v193, v181, v193
v_mul_f32 v194, v182, v194
buffer_load_dwordx4 v3, s[8:11], s37 offen offset:2048 sc1 lds
v_mul_f32 v195, v183, v195
v_mul_f32 v216, v204, v216
v_mul_f32 v217, v205, v217
v_mul_f32 v218, v206, v218
v_mul_f32 v219, v207, v219
v_mul_f32 v192, v192, v72
buffer_load_dwordx4 v3, s[8:11], s37 offen offset:3072 sc1 lds
v_mul_f32 v193, v193, v73
v_mul_f32 v194, v194, v74
v_mul_f32 v195, v195, v75
v_mul_f32 v216, v216, v76
v_mul_f32 v217, v217, v77
v_mul_f32 v218, v218, v78
s_add_u32 s38, s35, 7
s_and_b32 s38, s38, 15
s_mul_i32 s38, s38, 458752
s_add_u32 m0, s40, 98304
s_nop 0
buffer_load_dwordx4 v4, s[12:15], s38 offen lds
v_mul_f32 v219, v219, v79
v_cvt_pk_bf16_f32 v178, v192, v193
v_cvt_pk_bf16_f32 v179, v194, v195
v_cvt_pk_bf16_f32 v202, v216, v217
v_cvt_pk_bf16_f32 v203, v218, v219
buffer_store_dwordx4 v[176:179], v2, s[24:27], s54 offen offset:2048 sc1
s_add_u32 m0, s40, 99328
s_nop 0
buffer_load_dwordx4 v5, s[12:15], s38 offen lds
buffer_store_dwordx4 v[200:203], v2, s[24:27], s54 offen offset:3072 sc1
v_fma_f32 v184, -v60, v40, v184
v_fma_f32 v185, -v60, v41, v185
v_fma_f32 v186, -v60, v42, v186
v_fma_f32 v187, -v60, v43, v187
v_fma_f32 v208, -v62, v40, v208
s_add_u32 m0, s40, 100352
s_add_u32 s38, s38, 57344
buffer_load_dwordx4 v4, s[12:15], s38 offen lds
v_fma_f32 v209, -v62, v41, v209
v_fma_f32 v210, -v62, v42, v210
v_fma_f32 v211, -v62, v43, v211
v_mul_f32 v72, v184, v184
v_mul_f32 v73, v185, v185
v_mul_f32 v74, v186, v186
s_add_u32 m0, s40, 101376
s_nop 0
buffer_load_dwordx4 v5, s[12:15], s38 offen lds
v_mul_f32 v75, v187, v187
v_mul_f32 v76, v208, v208
v_mul_f32 v77, v209, v209
v_mul_f32 v78, v210, v210
v_mul_f32 v79, v211, v211
v_fma_f32 v72, v72, v65, v64
s_add_u32 m0, s40, 102400
s_add_u32 s38, s38, 57344
buffer_load_dwordx4 v4, s[12:15], s38 offen lds
v_fma_f32 v73, v73, v65, v64
v_fma_f32 v74, v74, v65, v64
v_fma_f32 v75, v75, v65, v64
v_fma_f32 v76, v76, v69, v68
v_fma_f32 v77, v77, v69, v68
v_fma_f32 v78, v78, v69, v68
s_add_u32 m0, s40, 103424
s_nop 0
buffer_load_dwordx4 v5, s[12:15], s38 offen lds
v_fma_f32 v79, v79, v69, v68
v_mul_f32 v72, v72, v184
v_mul_f32 v73, v73, v185
v_mul_f32 v74, v74, v186
v_mul_f32 v75, v75, v187
v_mul_f32 v76, v76, v208
s_add_u32 m0, s40, 104448
s_add_u32 s38, s38, 57344
buffer_load_dwordx4 v4, s[12:15], s38 offen lds
s_add_u32 m0, s40, 105472
s_nop 0
buffer_load_dwordx4 v5, s[12:15], s38 offen lds
s_waitcnt vmcnt(14)
s_cmp_eq_u32 s47, 3
s_cbranch_scc0 Lw_127
s_mov_b32 s41, 0x40000
Lcp_128:
s_waitcnt lgkmcnt(0)
s_and_b32 s92, s92, s93
s_cmp_eq_u32 s92, 16
s_cbranch_scc1 Lco_129
s_load_dword s92, s[82:83], s60 glc
s_load_dword s93, s[82:83], s61 glc
s_sub_u32 s41, s41, 1
s_cmp_lg_u32 s41, 0
s_cbranch_scc1 Lcp_128
s_waitcnt lgkmcnt(0)
Lco_129:
Lw_127:
s_barrier
s_lshl_b32 s60, s35, 9
s_lshl_b32 s43, s47, 7
s_add_u32 s60, s60, s43
s_add_u32 s61, s60, 14336
s_add_u32 s52, s43, 148480
s_add_u32 s53, s52, 896
v_lshrrev_b32 v104, 3, v1
v_mul_u32_u24 v104, 28672, v104
v_and_b32 v105, 7, v1
v_lshl_add_u32 v104, v105, 4, v104
s_waitcnt lgkmcnt(0)
buffer_load_dwordx4 v[96:99], v104, s[84:87], s60 offen sc1
s_load_dword s3, s[4:5], 5376
s_load_dword s3, s[4:5], 5440
s_load_dword s3, s[4:5], 5504
s_load_dword s3, s[4:5], 5568
s_load_dword s3, s[4:5], 5632
s_load_dword s3, s[4:5], 5696
buffer_load_dwordx4 v[100:103], v104, s[84:87], s61 offen sc1
s_load_dword s3, s[4:5], 5760
s_load_dword s3, s[4:5], 5824
s_load_dword s3, s[4:5], 5888
s_load_dword s3, s[4:5], 5952
s_load_dword s3, s[4:5], 6016
s_load_dword s3, s[4:5], 6080
s_load_dword s3, s[4:5], 6144
s_add_u32 s37, s35, 8
s_and_b32 s37, s37, 15
s_mul_i32 s37, s37, 16384
s_add_u32 m0, s39, 0
s_nop 0
buffer_load_dwordx4 v3, s[8:11], s37 offen sc1 lds
s_load_dword s3, s[4:5], 6208
v_mul_f32 v77, v77, v209
v_mul_f32 v78, v78, v210
v_mul_f32 v79, v79, v211
v_exp_f32 v72, v72
v_exp_f32 v73, v73
v_exp_f32 v74, v74
buffer_load_dwordx4 v3, s[8:11], s37 offen offset:1024 sc1 lds
v_exp_f32 v75, v75
v_exp_f32 v76, v76
v_exp_f32 v77, v77
v_exp_f32 v78, v78
v_exp_f32 v79, v79
v_fma_f32 v196, -v60, v52, v196
v_fma_f32 v197, -v60, v53, v197
buffer_load_dwordx4 v3, s[8:11], s37 offen offset:2048 sc1 lds
v_fma_f32 v198, -v60, v54, v198
v_fma_f32 v199, -v60, v55, v199
v_fma_f32 v220, -v62, v52, v220
v_fma_f32 v221, -v62, v53, v221
v_fma_f32 v222, -v62, v54, v222
v_fma_f32 v223, -v62, v55, v223
buffer_load_dwordx4 v3, s[8:11], s37 offen offset:3072 sc1 lds
v_fma_f32 v72, v72, v66, v66
v_fma_f32 v73, v73, v66, v66
v_fma_f32 v74, v74, v66, v66
v_fma_f32 v75, v75, v66, v66
v_fma_f32 v76, v76, v70, v70
v_fma_f32 v77, v77, v70, v70
v_fma_f32 v78, v78, v70, v70
s_add_u32 s38, s35, 8
s_and_b32 s38, s38, 15
s_mul_i32 s38, s38, 458752
s_add_u32 m0, s40, 0
s_nop 0
buffer_load_dwordx4 v4, s[12:15], s38 offen lds
v_fma_f32 v79, v79, v70, v70
v_rcp_f32 v72, v72
v_rcp_f32 v73, v73
v_rcp_f32 v74, v74
v_rcp_f32 v75, v75
v_rcp_f32 v76, v76
v_rcp_f32 v77, v77
s_add_u32 m0, s40, 1024
s_nop 0
buffer_load_dwordx4 v5, s[12:15], s38 offen lds
v_rcp_f32 v78, v78
v_rcp_f32 v79, v79
v_mul_f32 v196, v184, v196
v_mul_f32 v197, v185, v197
v_mul_f32 v198, v186, v198
v_mul_f32 v199, v187, v199
v_mul_f32 v220, v208, v220
s_add_u32 m0, s40, 2048
s_add_u32 s38, s38, 57344
buffer_load_dwordx4 v4, s[12:15], s38 offen lds
v_mul_f32 v221, v209, v221
v_mul_f32 v222, v210, v222
v_mul_f32 v223, v211, v223
v_mul_f32 v196, v196, v72
v_mul_f32 v197, v197, v73
v_mul_f32 v198, v198, v74
s_add_u32 m0, s40, 3072
s_nop 0
buffer_load_dwordx4 v5, s[12:15], s38 offen lds
v_mul_f32 v199, v199, v75
v_mul_f32 v220, v220, v76
v_mul_f32 v221, v221, v77
v_mul_f32 v222, v222, v78
v_mul_f32 v223, v223, v79
v_cvt_pk_bf16_f32 v80, v196, v197
v_cvt_pk_bf16_f32 v81, v198, v199
s_add_u32 m0, s40, 4096
s_add_u32 s38, s38, 57344
buffer_load_dwordx4 v4, s[12:15], s38 offen lds
v_cvt_pk_bf16_f32 v82, v220, v221
v_cvt_pk_bf16_f32 v83, v222, v223
s_nop 1
v_permlane32_swap_b32 v80, v82
v_permlane32_swap_b32 v81, v83
buffer_store_dwordx4 v[80:83], v84, s[24:27], s55 offen offset:2048 sc1
s_nop 1
s_add_u32 m0, s40, 5120
s_nop 0
buffer_load_dwordx4 v5, s[12:15], s38 offen lds
v_cmp_gt_u32 vcc, 32, v1
v_mov_b32 v104, s52
v_mov_b32 v106, s53
v_cndmask_b32 v104, v106, v104, vcc
v_lshl_add_u32 v104, v105, 4, v104
v_bfe_u32 v105, v1, 4, 1
v_lshl_add_u32 v104, v105, 2, v104
s_add_u32 m0, s40, 6144
s_add_u32 s38, s38, 57344
buffer_load_dwordx4 v4, s[12:15], s38 offen lds
s_add_u32 m0, s40, 7168
s_nop 0
buffer_load_dwordx4 v5, s[12:15], s38 offen lds
s_waitcnt vmcnt(15)
s_barrier
s_add_u32 s37, s35, 9
s_and_b32 s37, s37, 15
s_mul_i32 s37, s37, 16384
s_add_u32 m0, s39, 49152
s_nop 0
buffer_load_dwordx4 v3, s[8:11], s37 offen sc1 lds
buffer_load_dwordx4 v3, s[8:11], s37 offen offset:1024 sc1 lds
buffer_load_dwordx4 v3, s[8:11], s37 offen offset:2048 sc1 lds
buffer_load_dwordx4 v3, s[8:11], s37 offen offset:3072 sc1 lds
s_add_u32 s38, s35, 9
s_and_b32 s38, s38, 15
s_mul_i32 s38, s38, 458752
s_add_u32 m0, s40, 49152
s_nop 0
buffer_load_dwordx4 v4, s[12:15], s38 offen lds
s_add_u32 m0, s40, 50176
s_nop 0
buffer_load_dwordx4 v5, s[12:15], s38 offen lds
s_add_u32 m0, s40, 51200
s_add_u32 s38, s38, 57344
buffer_load_dwordx4 v4, s[12:15], s38 offen lds
s_add_u32 m0, s40, 52224
s_nop 0
buffer_load_dwordx4 v5, s[12:15], s38 offen lds
s_add_u32 m0, s40, 53248
s_add_u32 s38, s38, 57344
buffer_load_dwordx4 v4, s[12:15], s38 offen lds
s_add_u32 m0, s40, 54272
s_nop 0
buffer_load_dwordx4 v5, s[12:15], s38 offen lds
s_add_u32 m0, s40, 55296
s_add_u32 s38, s38, 57344
buffer_load_dwordx4 v4, s[12:15], s38 offen lds
s_add_u32 m0, s40, 56320
s_nop 0
buffer_load_dwordx4 v5, s[12:15], s38 offen lds
s_waitcnt vmcnt(12)
s_barrier
s_cmp_eq_u32 s47, 0
s_cbranch_scc0 Lw_130
s_add_u32 s7, s34, 32
s_lshl_b32 s7, s7, 7
v_mov_b32 v90, s7
v_mov_b32 v91, 1
s_mov_b64 exec, 1
buffer_atomic_add v91, v90, s[56:59], 0 offen sc1
s_mov_b64 exec, -1
Lw_130:
v_permlane32_swap_b32 v96, v100
v_permlane32_swap_b32 v97, v101
v_permlane32_swap_b32 v98, v102
v_permlane32_swap_b32 v99, v103
v_add_f32 v96, v96, v100
v_add_f32 v97, v97, v101
v_add_f32 v98, v98, v102
v_add_f32 v99, v99, v103
s_nop 1
v_permlane16_swap_b32 v96, v97
v_permlane16_swap_b32 v98, v99
v_add_f32 v96, v96, v97
v_add_f32 v98, v98, v99
s_nop 1
v_add_f32_dpp v96, v96, v96 row_ror:8 row_mask:0xf bank_mask:0xf
v_add_f32_dpp v98, v98, v98 row_ror:8 row_mask:0xf bank_mask:0xf
ds_write_b32 v104, v96
ds_write_b32 v104, v98 offset:8
s_waitcnt lgkmcnt(0)
s_add_u32 s37, s35, 10
s_and_b32 s37, s37, 15
s_mul_i32 s37, s37, 16384
s_add_u32 m0, s39, 98304
s_nop 0
buffer_load_dwordx4 v3, s[8:11], s37 offen sc1 lds
s_load_dword s3, s[4:5], 6272
s_load_dword s3, s[4:5], 6336
s_load_dword s3, s[4:5], 6400
s_load_dword s3, s[4:5], 6464
s_load_dword s3, s[4:5], 6528
s_load_dword s3, s[4:5], 6592
buffer_load_dwordx4 v3, s[8:11], s37 offen offset:1024 sc1 lds
s_load_dword s3, s[4:5], 6656
s_load_dword s3, s[4:5], 6720
s_load_dword s3, s[4:5], 6784
s_load_dword s3, s[4:5], 6848
s_load_dword s3, s[4:5], 6912
s_load_dword s3, s[4:5], 6976
s_load_dword s3, s[4:5], 7040
buffer_load_dwordx4 v3, s[8:11], s37 offen offset:2048 sc1 lds
s_load_dword s3, s[4:5], 7104
s_bfe_u32 s61, s35, 0x10002
s_lshr_b32 s60, s35, 3
s_lshl_b32 s60, s60, 2
s_and_b32 s43, s35, 3
s_add_u32 s60, s60, s43
buffer_load_dwordx4 v3, s[8:11], s37 offen offset:3072 sc1 lds
s_lshl_b32 s43, s60, 8
s_add_u32 s28, s76, s43
s_addc_u32 s29, s77, 0
s_mov_b32 s30, 7338240
s_mov_b32 s31, 0x20000
s_mul_i32 s52, s61, 196608
s_mul_i32 s53, s61, 1572864
s_add_u32 s38, s35, 10
s_and_b32 s38, s38, 15
s_mul_i32 s38, s38, 458752
s_add_u32 m0, s40, 98304
s_nop 0
buffer_load_dwordx4 v4, s[12:15], s38 offen lds
s_mul_i32 s90, s61, 163840
s_mul_i32 s91, s61, 1310720
s_and_b32 s43, s35, 3
s_mul_i32 s32, s43, 3
s_mul_i32 s33, s43, 10
s_lshr_b32 s33, s33, 2
s_add_u32 m0, s40, 99328
s_nop 0
buffer_load_dwordx4 v5, s[12:15], s38 offen lds
s_lshl_b32 s51, s47, 11
s_lshl_b32 s44, s47, 15
v_lshrrev_b32 v122, 4, v1
v_lshlrev_b32 v123, 1, v122
v_and_b32 v23, 15, v1
v_xor_b32 v23, v23, v123
v_lshlrev_b32 v23, 4, v23
s_add_u32 m0, s40, 100352
s_add_u32 s38, s38, 57344
buffer_load_dwordx4 v4, s[12:15], s38 offen lds
v_mul_u32_u24 v122, 2048, v122
v_add_u32 v23, v23, v122
v_add_u32 v23, s44, v23
s_branch Lov_10
.p2align 12
.fill 80, 4, 0xbf800000
Lst_10_0:
s_branch Lwr_170
Lst_10_1:
s_branch Lwr_181
s_nop 0
Lov_10:
v_xor_b32 v24, 128, v23
v_add_u32 v24, 8192, v24
s_lshl_b32 s43, s60, 2
s_add_u32 m0, s40, 101376
s_nop 0
buffer_load_dwordx4 v5, s[12:15], s38 offen lds
s_lshl_b32 s44, s61, 1
s_add_u32 s43, s43, s44
s_add_u32 s43, s43, s63
s_lshl_b32 s43, s43, 13
s_lshl_b32 s44, s62, 12
s_add_u32 s50, s43, s44
v_add_u32 v17, s44, v2
s_add_u32 m0, s40, 102400
s_add_u32 s38, s38, 57344
buffer_load_dwordx4 v4, s[12:15], s38 offen lds
v_add_u32 v18, 0x10000, v17
v_add_u32 v19, 0x20000, v17
v_lshrrev_b32 v122, 2, v1
v_and_b32 v123, 7, v122
v_mul_u32_u24 v122, 256, v122
v_lshl_add_u32 v122, v123, 5, v122
s_add_u32 m0, s40, 103424
s_nop 0
buffer_load_dwordx4 v5, s[12:15], s38 offen lds
v_and_b32 v123, 3, v1
v_lshl_add_u32 v9, v123, 3, v122
s_lshl_b32 s43, s61, 7
s_lshl_b32 s44, s63, 6
s_add_u32 s43, s43, s44
v_xor_b32 v9, s43, v9
v_xor_b32 v10, 32, v9
s_add_u32 m0, s40, 104448
s_add_u32 s38, s38, 57344
buffer_load_dwordx4 v4, s[12:15], s38 offen lds
s_add_u32 m0, s40, 105472
s_nop 0
buffer_load_dwordx4 v5, s[12:15], s38 offen lds
s_waitcnt vmcnt(12)
s_barrier
buffer_load_dwordx4 v[160:163], v2, s[8:11], s50 offen offset:0 sc1
v_xor_b32 v11, 128, v9
v_xor_b32 v12, 128, v10
v_add_u32 v13, 65536, v9
buffer_load_dwordx4 v[164:167], v2, s[8:11], s50 offen offset:1024 sc1
v_add_u32 v14, 65536, v10
v_add_u32 v15, 65536, v11
v_add_u32 v16, 65536, v12
v_add_u32 v25, 131072, v9
buffer_load_dwordx4 v[168:171], v2, s[8:11], s50 offen offset:2048 sc1
v_add_u32 v26, 131072, v10
v_add_u32 v27, 131072, v11
v_add_u32 v28, 131072, v12
v_lshrrev_b32 v122, 2, v1
buffer_load_dwordx4 v[172:175], v2, s[8:11], s50 offen offset:3072 sc1
v_bfe_u32 v123, v122, 1, 2
v_mul_u32_u24 v122, 128, v122
v_lshl_add_u32 v122, v123, 5, v122
s_add_u32 s37, s35, 11
s_and_b32 s37, s37, 15
s_mul_i32 s37, s37, 16384
s_add_u32 m0, s39, 0
s_nop 0
buffer_load_dwordx4 v3, s[8:11], s37 offen sc1 lds
v_and_b32 v123, 3, v1
v_lshl_add_u32 v224, v123, 3, v122
v_xor_b32 v224, s44, v224
v_xor_b32 v225, 32, v224
buffer_load_dwordx4 v3, s[8:11], s37 offen offset:1024 sc1 lds
v_add_u32 v226, 65536, v224
v_add_u32 v227, 65536, v225
v_add_u32 v228, 131072, v224
v_add_u32 v229, 131072, v225
buffer_load_dwordx4 v3, s[8:11], s37 offen offset:2048 sc1 lds
s_add_u32 s84, s82, 33554432
s_addc_u32 s85, s83, 0
s_mov_b32 s86, 4194304
s_mov_b32 s87, 0x20000
buffer_load_dwordx4 v3, s[8:11], s37 offen offset:3072 sc1 lds
s_xor_b32 s43, s2, 2
s_lshl_b32 s44, s43, 2
s_add_u32 s44, s44, s47
s_add_u32 s38, s35, 11
s_and_b32 s38, s38, 15
s_mul_i32 s38, s38, 458752
s_add_u32 m0, s40, 0
s_nop 0
buffer_load_dwordx4 v4, s[12:15], s38 offen lds
s_lshl_b32 s45, s44, 12
s_lshl_b32 s46, s2, 2
s_add_u32 s46, s46, s47
s_lshl_b32 s46, s46, 12
s_add_u32 m0, s40, 1024
s_nop 0
buffer_load_dwordx4 v5, s[12:15], s38 offen lds
s_lshl_b32 s43, s34, 18
s_lshl_b32 s42, s60, 8
s_add_u32 s43, s43, s42
s_lshl_b32 s42, s61, 7
s_add_u32 m0, s40, 2048
s_add_u32 s38, s38, 57344
buffer_load_dwordx4 v4, s[12:15], s38 offen lds
s_add_u32 s43, s43, s42
s_lshl_b32 s42, s63, 6
s_add_u32 s43, s43, s42
s_add_u32 m0, s40, 3072
s_nop 0
buffer_load_dwordx4 v5, s[12:15], s38 offen lds
s_add_u32 s20, s78, s43
s_addc_u32 s21, s79, 0
s_mov_b32 s22, 260160
s_mov_b32 s23, 0x20000
s_add_u32 m0, s40, 4096
s_add_u32 s38, s38, 57344
buffer_load_dwordx4 v4, s[12:15], s38 offen lds
v_and_b32 v230, 15, v1
v_lshlrev_b32 v230, 12, v230
v_bfe_u32 v231, v1, 4, 1
v_lshl_add_u32 v230, v231, 5, v230
s_add_u32 m0, s40, 5120
s_nop 0
buffer_load_dwordx4 v5, s[12:15], s38 offen lds
v_bfe_u32 v231, v1, 5, 1
v_lshl_add_u32 v230, v231, 4, v230
s_lshl_b32 s54, s62, 17
s_add_u32 s55, s54, 65536
s_add_u32 m0, s40, 6144
s_add_u32 s38, s38, 57344
buffer_load_dwordx4 v4, s[12:15], s38 offen lds
s_add_u32 m0, s40, 7168
s_nop 0
buffer_load_dwordx4 v5, s[12:15], s38 offen lds
s_waitcnt vmcnt(16)
s_barrier
s_cmp_eq_u32 s47, 3
s_cbranch_scc0 Lw_131
s_lshl_b32 s92, s34, 7
s_add_u32 s92, s92, 28315648
s_load_dword s93, s[82:83], s92 glc
Lw_131:
s_add_u32 s37, s35, 12
s_and_b32 s37, s37, 15
s_mul_i32 s37, s37, 16384
s_add_u32 m0, s39, 49152
s_nop 0
buffer_load_dwordx4 v3, s[8:11], s37 offen sc1 lds
buffer_load_dwordx4 v3, s[8:11], s37 offen offset:1024 sc1 lds
buffer_load_dwordx4 v3, s[8:11], s37 offen offset:2048 sc1 lds
buffer_load_dwordx4 v3, s[8:11], s37 offen offset:3072 sc1 lds
s_add_u32 s38, s35, 12
s_and_b32 s38, s38, 15
s_mul_i32 s38, s38, 458752
s_add_u32 m0, s40, 49152
s_nop 0
buffer_load_dwordx4 v4, s[12:15], s38 offen lds
s_add_u32 m0, s40, 50176
s_nop 0
buffer_load_dwordx4 v5, s[12:15], s38 offen lds
s_add_u32 m0, s40, 51200
s_add_u32 s38, s38, 57344
buffer_load_dwordx4 v4, s[12:15], s38 offen lds
s_add_u32 m0, s40, 52224
s_nop 0
buffer_load_dwordx4 v5, s[12:15], s38 offen lds
s_add_u32 m0, s40, 53248
s_add_u32 s38, s38, 57344
buffer_load_dwordx4 v4, s[12:15], s38 offen lds
s_add_u32 m0, s40, 54272
s_nop 0
buffer_load_dwordx4 v5, s[12:15], s38 offen lds
s_add_u32 m0, s40, 55296
s_add_u32 s38, s38, 57344
buffer_load_dwordx4 v4, s[12:15], s38 offen lds
s_add_u32 m0, s40, 56320
s_nop 0
buffer_load_dwordx4 v5, s[12:15], s38 offen lds
s_waitcnt vmcnt(12)
s_cmp_eq_u32 s47, 3
s_cbranch_scc0 Lw_132
s_mov_b32 s41, 0x40000
s_branch Lpchk_135
Lpoll_133:
s_load_dword s93, s[82:83], s92 glc
Lpchk_135:
s_waitcnt lgkmcnt(0)
s_cmp_eq_u32 s93, 16
s_cbranch_scc1 Lpok_134
s_sub_u32 s41, s41, 1
s_cmp_lg_u32 s41, 0
s_cbranch_scc1 Lpoll_133
Lpok_134:
Lw_132:
s_barrier
s_add_u32 s37, s52, 524288
s_add_u32 m0, s39, 98304
s_nop 0
buffer_load_dwordx4 v3, s[24:27], s37 offen sc1 lds
v_lshlrev_b32 v128, 16, v160
v_and_b32 v129, 0xffff0000, v160
v_lshlrev_b32 v130, 16, v161
v_and_b32 v131, 0xffff0000, v161
v_lshlrev_b32 v132, 16, v162
buffer_load_dwordx4 v3, s[24:27], s37 offen offset:1024 sc1 lds
v_and_b32 v133, 0xffff0000, v162
v_lshlrev_b32 v134, 16, v163
v_and_b32 v135, 0xffff0000, v163
v_lshlrev_b32 v136, 16, v164
v_and_b32 v137, 0xffff0000, v164
buffer_load_dwordx4 v3, s[24:27], s37 offen offset:2048 sc1 lds
v_lshlrev_b32 v138, 16, v165
v_and_b32 v139, 0xffff0000, v165
v_lshlrev_b32 v140, 16, v166
v_and_b32 v141, 0xffff0000, v166
v_lshlrev_b32 v142, 16, v167
v_and_b32 v143, 0xffff0000, v167
buffer_load_dwordx4 v3, s[24:27], s37 offen offset:3072 sc1 lds
v_lshlrev_b32 v144, 16, v168
v_and_b32 v145, 0xffff0000, v168
v_lshlrev_b32 v146, 16, v169
v_and_b32 v147, 0xffff0000, v169
v_lshlrev_b32 v148, 16, v170
s_add_u32 s38, s53, 4194304
s_add_u32 m0, s39, 114688
s_nop 0
buffer_load_dwordx4 v23, s[28:31], s38 offen lds
v_and_b32 v149, 0xffff0000, v170
v_lshlrev_b32 v150, 16, v171
v_and_b32 v151, 0xffff0000, v171
v_lshlrev_b32 v152, 16, v172
v_and_b32 v153, 0xffff0000, v172
s_add_u32 m0, s39, 115712
s_nop 0
buffer_load_dwordx4 v24, s[28:31], s38 offen lds
v_lshlrev_b32 v154, 16, v173
v_and_b32 v155, 0xffff0000, v173
v_lshlrev_b32 v156, 16, v174
v_and_b32 v157, 0xffff0000, v174
v_lshlrev_b32 v158, 16, v175
v_and_b32 v159, 0xffff0000, v175
s_add_u32 m0, s39, 116736
s_add_u32 s38, s38, 16384
buffer_load_dwordx4 v23, s[28:31], s38 offen lds
s_add_u32 m0, s39, 117760
s_nop 0
buffer_load_dwordx4 v24, s[28:31], s38 offen lds
s_waitcnt vmcnt(8)
s_barrier
s_add_u32 s37, s52, 540672
s_add_u32 m0, s39, 131072
s_nop 0
buffer_load_dwordx4 v3, s[24:27], s37 offen sc1 lds
buffer_load_dwordx4 v3, s[24:27], s37 offen offset:1024 sc1 lds
buffer_load_dwordx4 v3, s[24:27], s37 offen offset:2048 sc1 lds
buffer_load_dwordx4 v3, s[24:27], s37 offen offset:3072 sc1 lds
s_add_u32 s38, s53, 4325376
s_add_u32 m0, s39, 0
s_nop 0
buffer_load_dwordx4 v23, s[28:31], s38 offen lds
s_add_u32 m0, s39, 1024
s_nop 0
buffer_load_dwordx4 v24, s[28:31], s38 offen lds
s_add_u32 m0, s39, 2048
s_add_u32 s38, s38, 16384
buffer_load_dwordx4 v23, s[28:31], s38 offen lds
s_add_u32 m0, s39, 3072
s_nop 0
buffer_load_dwordx4 v24, s[28:31], s38 offen lds
s_add_u32 s37, s52, 557056
s_add_u32 m0, s39, 16384
s_nop 0
buffer_load_dwordx4 v3, s[24:27], s37 offen sc1 lds
buffer_load_dwordx4 v3, s[24:27], s37 offen offset:1024 sc1 lds
buffer_load_dwordx4 v3, s[24:27], s37 offen offset:2048 sc1 lds
buffer_load_dwordx4 v3, s[24:27], s37 offen offset:3072 sc1 lds
s_add_u32 s38, s53, 4456448
s_add_u32 m0, s39, 32768
s_nop 0
buffer_load_dwordx4 v23, s[28:31], s38 offen lds
s_add_u32 m0, s39, 33792
s_nop 0
buffer_load_dwordx4 v24, s[28:31], s38 offen lds
s_add_u32 m0, s39, 34816
s_add_u32 s38, s38, 16384
buffer_load_dwordx4 v23, s[28:31], s38 offen lds
s_add_u32 m0, s39, 35840
s_nop 0
buffer_load_dwordx4 v24, s[28:31], s38 offen lds
s_waitcnt vmcnt(16)
s_barrier
ds_read_b128 v[32:35], v18 offset:32768
ds_read_b64_tr_b16 v[48:49], v13 offset:49152
ds_read_b64_tr_b16 v[50:51], v13 offset:53248
ds_read_b64_tr_b16 v[52:53], v14 offset:49152
ds_read_b64_tr_b16 v[54:55], v14 offset:53248
ds_read_b64_tr_b16 v[56:57], v15 offset:49152
ds_read_b64_tr_b16 v[58:59], v15 offset:53248
ds_read_b64_tr_b16 v[60:61], v16 offset:49152
ds_read_b64_tr_b16 v[62:63], v16 offset:53248
ds_read_b128 v[36:39], v18 offset:33792
ds_read_b128 v[40:43], v18 offset:34816
ds_read_b128 v[44:47], v18 offset:35840
ds_read_b128 v[64:67], v18 offset:40960
ds_read_b64_tr_b16 v[80:81], v13 offset:57344
ds_read_b64_tr_b16 v[82:83], v13 offset:61440
ds_read_b64_tr_b16 v[84:85], v14 offset:57344
ds_read_b64_tr_b16 v[86:87], v14 offset:61440
ds_read_b64_tr_b16 v[88:89], v15 offset:57344
ds_read_b64_tr_b16 v[90:91], v15 offset:61440
ds_read_b64_tr_b16 v[92:93], v16 offset:57344
ds_read_b64_tr_b16 v[94:95], v16 offset:61440
ds_read_b128 v[68:71], v18 offset:41984
ds_read_b128 v[72:75], v18 offset:43008
ds_read_b128 v[76:79], v18 offset:44032
s_add_u32 s37, s52, 573440
s_add_u32 m0, s39, 49152
s_nop 0
buffer_load_dwordx4 v3, s[24:27], s37 offen sc1 lds
buffer_load_dwordx4 v3, s[24:27], s37 offen offset:1024 sc1 lds
buffer_load_dwordx4 v3, s[24:27], s37 offen offset:2048 sc1 lds
buffer_load_dwordx4 v3, s[24:27], s37 offen offset:3072 sc1 lds
s_add_u32 s38, s53, 4587520
s_add_u32 m0, s39, 65536
s_nop 0
buffer_load_dwordx4 v23, s[28:31], s38 offen lds
s_add_u32 m0, s39, 66560
s_nop 0
buffer_load_dwordx4 v24, s[28:31], s38 offen lds
s_add_u32 m0, s39, 67584
s_add_u32 s38, s38, 16384
buffer_load_dwordx4 v23, s[28:31], s38 offen lds
s_add_u32 m0, s39, 68608
s_nop 0
buffer_load_dwordx4 v24, s[28:31], s38 offen lds
Lk4c:
s_waitcnt vmcnt(16)
s_waitcnt lgkmcnt(0)
s_barrier
v_mfma_f32_16x16x32_bf16 v[128:131], v[48:51], v[32:35], v[128:131]
ds_read_b128 v[96:99], v19 offset:0
v_mfma_f32_16x16x32_bf16 v[136:139], v[48:51], v[36:39], v[136:139]
ds_read_b64_tr_b16 v[112:113], v9 offset:0
v_mfma_f32_16x16x32_bf16 v[144:147], v[48:51], v[40:43], v[144:147]
ds_read_b64_tr_b16 v[114:115], v9 offset:4096
v_mfma_f32_16x16x32_bf16 v[152:155], v[48:51], v[44:47], v[152:155]
ds_read_b64_tr_b16 v[116:117], v10 offset:0
v_mfma_f32_16x16x32_bf16 v[156:159], v[52:55], v[44:47], v[156:159]
ds_read_b64_tr_b16 v[118:119], v10 offset:4096
v_mfma_f32_16x16x32_bf16 v[148:151], v[52:55], v[40:43], v[148:151]
ds_read_b64_tr_b16 v[120:121], v11 offset:0
v_mfma_f32_16x16x32_bf16 v[140:143], v[52:55], v[36:39], v[140:143]
ds_read_b64_tr_b16 v[122:123], v11 offset:4096
v_mfma_f32_16x16x32_bf16 v[132:135], v[52:55], v[32:35], v[132:135]
ds_read_b64_tr_b16 v[124:125], v12 offset:0
v_mfma_f32_16x16x32_bf16 v[160:163], v[56:59], v[32:35], 0
ds_read_b64_tr_b16 v[126:127], v12 offset:4096
v_mfma_f32_16x16x32_bf16 v[168:171], v[56:59], v[36:39], 0
ds_read_b128 v[100:103], v19 offset:1024
v_mfma_f32_16x16x32_bf16 v[176:179], v[56:59], v[40:43], 0
ds_read_b128 v[104:107], v19 offset:2048
v_mfma_f32_16x16x32_bf16 v[184:187], v[56:59], v[44:47], 0
ds_read_b128 v[108:111], v19 offset:3072
v_mfma_f32_16x16x32_bf16 v[188:191], v[60:63], v[44:47], 0
ds_read_b128 v[192:195], v19 offset:8192
v_mfma_f32_16x16x32_bf16 v[180:183], v[60:63], v[40:43], 0
ds_read_b64_tr_b16 v[208:209], v9 offset:8192
v_mfma_f32_16x16x32_bf16 v[172:175], v[60:63], v[36:39], 0
ds_read_b64_tr_b16 v[210:211], v9 offset:12288
v_mfma_f32_16x16x32_bf16 v[164:167], v[60:63], v[32:35], 0
ds_read_b64_tr_b16 v[212:213], v10 offset:8192
v_mfma_f32_16x16x32_bf16 v[128:131], v[80:83], v[64:67], v[128:131]
ds_read_b64_tr_b16 v[214:215], v10 offset:12288
v_mfma_f32_16x16x32_bf16 v[136:139], v[80:83], v[68:71], v[136:139]
ds_read_b64_tr_b16 v[216:217], v11 offset:8192
v_mfma_f32_16x16x32_bf16 v[144:147], v[80:83], v[72:75], v[144:147]
ds_read_b64_tr_b16 v[218:219], v11 offset:12288
v_mfma_f32_16x16x32_bf16 v[152:155], v[80:83], v[76:79], v[152:155]
ds_read_b64_tr_b16 v[220:221], v12 offset:8192
v_mfma_f32_16x16x32_bf16 v[156:159], v[84:87], v[76:79], v[156:159]
ds_read_b64_tr_b16 v[222:223], v12 offset:12288
v_mfma_f32_16x16x32_bf16 v[148:151], v[84:87], v[72:75], v[148:151]
ds_read_b128 v[196:199], v19 offset:9216
v_mfma_f32_16x16x32_bf16 v[140:143], v[84:87], v[68:71], v[140:143]
ds_read_b128 v[200:203], v19 offset:10240
v_mfma_f32_16x16x32_bf16 v[132:135], v[84:87], v[64:67], v[132:135]
ds_read_b128 v[204:207], v19 offset:11264
v_mfma_f32_16x16x32_bf16 v[160:163], v[88:91], v[64:67], v[160:163]
v_mfma_f32_16x16x32_bf16 v[168:171], v[88:91], v[68:71], v[168:171]
v_mfma_f32_16x16x32_bf16 v[176:179], v[88:91], v[72:75], v[176:179]
v_mfma_f32_16x16x32_bf16 v[184:187], v[88:91], v[76:79], v[184:187]
v_mfma_f32_16x16x32_bf16 v[188:191], v[92:95], v[76:79], v[188:191]
v_mfma_f32_16x16x32_bf16 v[180:183], v[92:95], v[72:75], v[180:183]
v_mfma_f32_16x16x32_bf16 v[172:175], v[92:95], v[68:71], v[172:175]
v_mfma_f32_16x16x32_bf16 v[164:167], v[92:95], v[64:67], v[164:167]
s_mov_b32 s41, 2
Lk4_136:
s_waitcnt vmcnt(8)
s_waitcnt lgkmcnt(0)
s_barrier
v_mfma_f32_16x16x32_bf16 v[128:131], v[112:115], v[96:99], v[128:131]
ds_read_b128 v[32:35], v17 offset:16384
v_mfma_f32_16x16x32_bf16 v[136:139], v[112:115], v[100:103], v[136:139]
ds_read_b64_tr_b16 v[48:49], v9 offset:32768
v_mfma_f32_16x16x32_bf16 v[144:147], v[112:115], v[104:107], v[144:147]
ds_read_b64_tr_b16 v[50:51], v9 offset:36864
v_mfma_f32_16x16x32_bf16 v[152:155], v[112:115], v[108:111], v[152:155]
ds_read_b64_tr_b16 v[52:53], v10 offset:32768
v_mfma_f32_16x16x32_bf16 v[156:159], v[116:119], v[108:111], v[156:159]
ds_read_b64_tr_b16 v[54:55], v10 offset:36864
v_mfma_f32_16x16x32_bf16 v[148:151], v[116:119], v[104:107], v[148:151]
ds_read_b64_tr_b16 v[56:57], v11 offset:32768
v_mfma_f32_16x16x32_bf16 v[140:143], v[116:119], v[100:103], v[140:143]
ds_read_b64_tr_b16 v[58:59], v11 offset:36864
v_mfma_f32_16x16x32_bf16 v[132:135], v[116:119], v[96:99], v[132:135]
ds_read_b64_tr_b16 v[60:61], v12 offset:32768
v_mfma_f32_16x16x32_bf16 v[160:163], v[120:123], v[96:99], v[160:163]
ds_read_b64_tr_b16 v[62:63], v12 offset:36864
v_mfma_f32_16x16x32_bf16 v[168:171], v[120:123], v[100:103], v[168:171]
ds_read_b128 v[36:39], v17 offset:17408
v_mfma_f32_16x16x32_bf16 v[176:179], v[120:123], v[104:107], v[176:179]
ds_read_b128 v[40:43], v17 offset:18432
v_mfma_f32_16x16x32_bf16 v[184:187], v[120:123], v[108:111], v[184:187]
ds_read_b128 v[44:47], v17 offset:19456
v_mfma_f32_16x16x32_bf16 v[188:191], v[124:127], v[108:111], v[188:191]
ds_read_b128 v[64:67], v17 offset:24576
v_mfma_f32_16x16x32_bf16 v[180:183], v[124:127], v[104:107], v[180:183]
ds_read_b64_tr_b16 v[80:81], v9 offset:40960
v_mfma_f32_16x16x32_bf16 v[172:175], v[124:127], v[100:103], v[172:175]
ds_read_b64_tr_b16 v[82:83], v9 offset:45056
v_mfma_f32_16x16x32_bf16 v[164:167], v[124:127], v[96:99], v[164:167]
ds_read_b64_tr_b16 v[84:85], v10 offset:40960
v_mfma_f32_16x16x32_bf16 v[128:131], v[208:211], v[192:195], v[128:131]
ds_read_b64_tr_b16 v[86:87], v10 offset:45056
v_mfma_f32_16x16x32_bf16 v[136:139], v[208:211], v[196:199], v[136:139]
ds_read_b64_tr_b16 v[88:89], v11 offset:40960
v_mfma_f32_16x16x32_bf16 v[144:147], v[208:211], v[200:203], v[144:147]
ds_read_b64_tr_b16 v[90:91], v11 offset:45056
v_mfma_f32_16x16x32_bf16 v[152:155], v[208:211], v[204:207], v[152:155]
ds_read_b64_tr_b16 v[92:93], v12 offset:40960
v_mfma_f32_16x16x32_bf16 v[156:159], v[212:215], v[204:207], v[156:159]
ds_read_b64_tr_b16 v[94:95], v12 offset:45056
v_mfma_f32_16x16x32_bf16 v[148:151], v[212:215], v[200:203], v[148:151]
ds_read_b128 v[68:71], v17 offset:25600
v_mfma_f32_16x16x32_bf16 v[140:143], v[212:215], v[196:199], v[140:143]
ds_read_b128 v[72:75], v17 offset:26624
v_mfma_f32_16x16x32_bf16 v[132:135], v[212:215], v[192:195], v[132:135]
ds_read_b128 v[76:79], v17 offset:27648
v_mfma_f32_16x16x32_bf16 v[160:163], v[216:219], v[192:195], v[160:163]
v_mfma_f32_16x16x32_bf16 v[168:171], v[216:219], v[196:199], v[168:171]
v_mfma_f32_16x16x32_bf16 v[176:179], v[216:219], v[200:203], v[176:179]
v_mfma_f32_16x16x32_bf16 v[184:187], v[216:219], v[204:207], v[184:187]
v_mfma_f32_16x16x32_bf16 v[188:191], v[220:223], v[204:207], v[188:191]
v_mfma_f32_16x16x32_bf16 v[180:183], v[220:223], v[200:203], v[180:183]
v_mfma_f32_16x16x32_bf16 v[172:175], v[220:223], v[196:199], v[172:175]
v_mfma_f32_16x16x32_bf16 v[164:167], v[220:223], v[192:195], v[164:167]
s_waitcnt vmcnt(0)
s_waitcnt lgkmcnt(0)
s_barrier
v_mfma_f32_16x16x32_bf16 v[128:131], v[48:51], v[32:35], v[128:131]
ds_read_b128 v[96:99], v17 offset:49152
v_mfma_f32_16x16x32_bf16 v[136:139], v[48:51], v[36:39], v[136:139]
ds_read_b64_tr_b16 v[112:113], v13 offset:0
v_mfma_f32_16x16x32_bf16 v[144:147], v[48:51], v[40:43], v[144:147]
ds_read_b64_tr_b16 v[114:115], v13 offset:4096
v_mfma_f32_16x16x32_bf16 v[152:155], v[48:51], v[44:47], v[152:155]
ds_read_b64_tr_b16 v[116:117], v14 offset:0
v_mfma_f32_16x16x32_bf16 v[156:159], v[52:55], v[44:47], v[156:159]
ds_read_b64_tr_b16 v[118:119], v14 offset:4096
v_mfma_f32_16x16x32_bf16 v[148:151], v[52:55], v[40:43], v[148:151]
ds_read_b64_tr_b16 v[120:121], v15 offset:0
v_mfma_f32_16x16x32_bf16 v[140:143], v[52:55], v[36:39], v[140:143]
ds_read_b64_tr_b16 v[122:123], v15 offset:4096
v_mfma_f32_16x16x32_bf16 v[132:135], v[52:55], v[32:35], v[132:135]
ds_read_b64_tr_b16 v[124:125], v16 offset:0
v_mfma_f32_16x16x32_bf16 v[160:163], v[56:59], v[32:35], v[160:163]
ds_read_b64_tr_b16 v[126:127], v16 offset:4096
v_mfma_f32_16x16x32_bf16 v[168:171], v[56:59], v[36:39], v[168:171]
ds_read_b128 v[100:103], v17 offset:50176
v_mfma_f32_16x16x32_bf16 v[176:179], v[56:59], v[40:43], v[176:179]
ds_read_b128 v[104:107], v17 offset:51200
v_mfma_f32_16x16x32_bf16 v[184:187], v[56:59], v[44:47], v[184:187]
ds_read_b128 v[108:111], v17 offset:52224
v_mfma_f32_16x16x32_bf16 v[188:191], v[60:63], v[44:47], v[188:191]
ds_read_b128 v[192:195], v17 offset:57344
v_mfma_f32_16x16x32_bf16 v[180:183], v[60:63], v[40:43], v[180:183]
ds_read_b64_tr_b16 v[208:209], v13 offset:8192
v_mfma_f32_16x16x32_bf16 v[172:175], v[60:63], v[36:39], v[172:175]
ds_read_b64_tr_b16 v[210:211], v13 offset:12288
v_mfma_f32_16x16x32_bf16 v[164:167], v[60:63], v[32:35], v[164:167]
ds_read_b64_tr_b16 v[212:213], v14 offset:8192
v_mfma_f32_16x16x32_bf16 v[128:131], v[80:83], v[64:67], v[128:131]
ds_read_b64_tr_b16 v[214:215], v14 offset:12288
v_mfma_f32_16x16x32_bf16 v[136:139], v[80:83], v[68:71], v[136:139]
ds_read_b64_tr_b16 v[216:217], v15 offset:8192
v_mfma_f32_16x16x32_bf16 v[144:147], v[80:83], v[72:75], v[144:147]
ds_read_b64_tr_b16 v[218:219], v15 offset:12288
v_mfma_f32_16x16x32_bf16 v[152:155], v[80:83], v[76:79], v[152:155]
ds_read_b64_tr_b16 v[220:221], v16 offset:8192
v_mfma_f32_16x16x32_bf16 v[156:159], v[84:87], v[76:79], v[156:159]
ds_read_b64_tr_b16 v[222:223], v16 offset:12288
v_mfma_f32_16x16x32_bf16 v[148:151], v[84:87], v[72:75], v[148:151]
ds_read_b128 v[196:199], v17 offset:58368
v_mfma_f32_16x16x32_bf16 v[140:143], v[84:87], v[68:71], v[140:143]
ds_read_b128 v[200:203], v17 offset:59392
v_mfma_f32_16x16x32_bf16 v[132:135], v[84:87], v[64:67], v[132:135]
ds_read_b128 v[204:207], v17 offset:60416
v_mfma_f32_16x16x32_bf16 v[160:163], v[88:91], v[64:67], v[160:163]
v_mfma_f32_16x16x32_bf16 v[168:171], v[88:91], v[68:71], v[168:171]
v_mfma_f32_16x16x32_bf16 v[176:179], v[88:91], v[72:75], v[176:179]
v_mfma_f32_16x16x32_bf16 v[184:187], v[88:91], v[76:79], v[184:187]
v_mfma_f32_16x16x32_bf16 v[188:191], v[92:95], v[76:79], v[188:191]
v_mfma_f32_16x16x32_bf16 v[180:183], v[92:95], v[72:75], v[180:183]
v_mfma_f32_16x16x32_bf16 v[172:175], v[92:95], v[68:71], v[172:175]
v_mfma_f32_16x16x32_bf16 v[164:167], v[92:95], v[64:67], v[164:167]
s_waitcnt lgkmcnt(0)
s_barrier
v_mfma_f32_16x16x32_bf16 v[128:131], v[112:115], v[96:99], v[128:131]
ds_read_b128 v[32:35], v18 offset:16384
v_mfma_f32_16x16x32_bf16 v[136:139], v[112:115], v[100:103], v[136:139]
ds_read_b64_tr_b16 v[48:49], v25 offset:16384
v_mfma_f32_16x16x32_bf16 v[144:147], v[112:115], v[104:107], v[144:147]
ds_read_b64_tr_b16 v[50:51], v25 offset:20480
v_mfma_f32_16x16x32_bf16 v[152:155], v[112:115], v[108:111], v[152:155]
ds_read_b64_tr_b16 v[52:53], v26 offset:16384
v_mfma_f32_16x16x32_bf16 v[156:159], v[116:119], v[108:111], v[156:159]
ds_read_b64_tr_b16 v[54:55], v26 offset:20480
v_mfma_f32_16x16x32_bf16 v[148:151], v[116:119], v[104:107], v[148:151]
ds_read_b64_tr_b16 v[56:57], v27 offset:16384
v_mfma_f32_16x16x32_bf16 v[140:143], v[116:119], v[100:103], v[140:143]
ds_read_b64_tr_b16 v[58:59], v27 offset:20480
v_mfma_f32_16x16x32_bf16 v[132:135], v[116:119], v[96:99], v[132:135]
ds_read_b64_tr_b16 v[60:61], v28 offset:16384
v_mfma_f32_16x16x32_bf16 v[160:163], v[120:123], v[96:99], v[160:163]
ds_read_b64_tr_b16 v[62:63], v28 offset:20480
v_mfma_f32_16x16x32_bf16 v[168:171], v[120:123], v[100:103], v[168:171]
ds_read_b128 v[36:39], v18 offset:17408
v_mfma_f32_16x16x32_bf16 v[176:179], v[120:123], v[104:107], v[176:179]
ds_read_b128 v[40:43], v18 offset:18432
v_mfma_f32_16x16x32_bf16 v[184:187], v[120:123], v[108:111], v[184:187]
ds_read_b128 v[44:47], v18 offset:19456
v_mfma_f32_16x16x32_bf16 v[188:191], v[124:127], v[108:111], v[188:191]
ds_read_b128 v[64:67], v18 offset:24576
v_mfma_f32_16x16x32_bf16 v[180:183], v[124:127], v[104:107], v[180:183]
ds_read_b64_tr_b16 v[80:81], v25 offset:24576
s_branch Lov_11
.p2align 12
.fill 80, 4, 0xbf800000
Lst_11_0:
s_branch Lwr_171
Lst_11_1:
s_branch Lst_15_0
s_nop 0
Lov_11:
v_mfma_f32_16x16x32_bf16 v[172:175], v[124:127], v[100:103], v[172:175]
ds_read_b64_tr_b16 v[82:83], v25 offset:28672
v_mfma_f32_16x16x32_bf16 v[164:167], v[124:127], v[96:99], v[164:167]
ds_read_b64_tr_b16 v[84:85], v26 offset:24576
v_mfma_f32_16x16x32_bf16 v[128:131], v[208:211], v[192:195], v[128:131]
ds_read_b64_tr_b16 v[86:87], v26 offset:28672
v_mfma_f32_16x16x32_bf16 v[136:139], v[208:211], v[196:199], v[136:139]
ds_read_b64_tr_b16 v[88:89], v27 offset:24576
v_mfma_f32_16x16x32_bf16 v[144:147], v[208:211], v[200:203], v[144:147]
ds_read_b64_tr_b16 v[90:91], v27 offset:28672
v_mfma_f32_16x16x32_bf16 v[152:155], v[208:211], v[204:207], v[152:155]
ds_read_b64_tr_b16 v[92:93], v28 offset:24576
v_mfma_f32_16x16x32_bf16 v[156:159], v[212:215], v[204:207], v[156:159]
ds_read_b64_tr_b16 v[94:95], v28 offset:28672
v_mfma_f32_16x16x32_bf16 v[148:151], v[212:215], v[200:203], v[148:151]
ds_read_b128 v[68:71], v18 offset:25600
v_mfma_f32_16x16x32_bf16 v[140:143], v[212:215], v[196:199], v[140:143]
ds_read_b128 v[72:75], v18 offset:26624
v_mfma_f32_16x16x32_bf16 v[132:135], v[212:215], v[192:195], v[132:135]
ds_read_b128 v[76:79], v18 offset:27648
v_mfma_f32_16x16x32_bf16 v[160:163], v[216:219], v[192:195], v[160:163]
v_mfma_f32_16x16x32_bf16 v[168:171], v[216:219], v[196:199], v[168:171]
v_mfma_f32_16x16x32_bf16 v[176:179], v[216:219], v[200:203], v[176:179]
v_mfma_f32_16x16x32_bf16 v[184:187], v[216:219], v[204:207], v[184:187]
v_mfma_f32_16x16x32_bf16 v[188:191], v[220:223], v[204:207], v[188:191]
v_mfma_f32_16x16x32_bf16 v[180:183], v[220:223], v[200:203], v[180:183]
v_mfma_f32_16x16x32_bf16 v[172:175], v[220:223], v[196:199], v[172:175]
v_mfma_f32_16x16x32_bf16 v[164:167], v[220:223], v[192:195], v[164:167]
s_waitcnt lgkmcnt(0)
s_barrier
v_mfma_f32_16x16x32_bf16 v[128:131], v[48:51], v[32:35], v[128:131]
ds_read_b128 v[96:99], v18 offset:32768
v_mfma_f32_16x16x32_bf16 v[136:139], v[48:51], v[36:39], v[136:139]
ds_read_b64_tr_b16 v[112:113], v13 offset:49152
v_mfma_f32_16x16x32_bf16 v[144:147], v[48:51], v[40:43], v[144:147]
ds_read_b64_tr_b16 v[114:115], v13 offset:53248
v_mfma_f32_16x16x32_bf16 v[152:155], v[48:51], v[44:47], v[152:155]
ds_read_b64_tr_b16 v[116:117], v14 offset:49152
v_mfma_f32_16x16x32_bf16 v[156:159], v[52:55], v[44:47], v[156:159]
ds_read_b64_tr_b16 v[118:119], v14 offset:53248
v_mfma_f32_16x16x32_bf16 v[148:151], v[52:55], v[40:43], v[148:151]
ds_read_b64_tr_b16 v[120:121], v15 offset:49152
v_mfma_f32_16x16x32_bf16 v[140:143], v[52:55], v[36:39], v[140:143]
ds_read_b64_tr_b16 v[122:123], v15 offset:53248
v_mfma_f32_16x16x32_bf16 v[132:135], v[52:55], v[32:35], v[132:135]
ds_read_b64_tr_b16 v[124:125], v16 offset:49152
v_mfma_f32_16x16x32_bf16 v[160:163], v[56:59], v[32:35], v[160:163]
ds_read_b64_tr_b16 v[126:127], v16 offset:53248
v_mfma_f32_16x16x32_bf16 v[168:171], v[56:59], v[36:39], v[168:171]
ds_read_b128 v[100:103], v18 offset:33792
v_mfma_f32_16x16x32_bf16 v[176:179], v[56:59], v[40:43], v[176:179]
ds_read_b128 v[104:107], v18 offset:34816
v_mfma_f32_16x16x32_bf16 v[184:187], v[56:59], v[44:47], v[184:187]
ds_read_b128 v[108:111], v18 offset:35840
v_mfma_f32_16x16x32_bf16 v[188:191], v[60:63], v[44:47], v[188:191]
ds_read_b128 v[192:195], v18 offset:40960
v_mfma_f32_16x16x32_bf16 v[180:183], v[60:63], v[40:43], v[180:183]
ds_read_b64_tr_b16 v[208:209], v13 offset:57344
v_mfma_f32_16x16x32_bf16 v[172:175], v[60:63], v[36:39], v[172:175]
ds_read_b64_tr_b16 v[210:211], v13 offset:61440
v_mfma_f32_16x16x32_bf16 v[164:167], v[60:63], v[32:35], v[164:167]
ds_read_b64_tr_b16 v[212:213], v14 offset:57344
v_mfma_f32_16x16x32_bf16 v[128:131], v[80:83], v[64:67], v[128:131]
ds_read_b64_tr_b16 v[214:215], v14 offset:61440
v_mfma_f32_16x16x32_bf16 v[136:139], v[80:83], v[68:71], v[136:139]
ds_read_b64_tr_b16 v[216:217], v15 offset:57344
v_mfma_f32_16x16x32_bf16 v[144:147], v[80:83], v[72:75], v[144:147]
ds_read_b64_tr_b16 v[218:219], v15 offset:61440
v_mfma_f32_16x16x32_bf16 v[152:155], v[80:83], v[76:79], v[152:155]
ds_read_b64_tr_b16 v[220:221], v16 offset:57344
v_mfma_f32_16x16x32_bf16 v[156:159], v[84:87], v[76:79], v[156:159]
ds_read_b64_tr_b16 v[222:223], v16 offset:61440
v_mfma_f32_16x16x32_bf16 v[148:151], v[84:87], v[72:75], v[148:151]
ds_read_b128 v[196:199], v18 offset:41984
v_mfma_f32_16x16x32_bf16 v[140:143], v[84:87], v[68:71], v[140:143]
ds_read_b128 v[200:203], v18 offset:43008
v_mfma_f32_16x16x32_bf16 v[132:135], v[84:87], v[64:67], v[132:135]
ds_read_b128 v[204:207], v18 offset:44032
v_mfma_f32_16x16x32_bf16 v[160:163], v[88:91], v[64:67], v[160:163]
v_mfma_f32_16x16x32_bf16 v[168:171], v[88:91], v[68:71], v[168:171]
v_mfma_f32_16x16x32_bf16 v[176:179], v[88:91], v[72:75], v[176:179]
v_mfma_f32_16x16x32_bf16 v[184:187], v[88:91], v[76:79], v[184:187]
v_mfma_f32_16x16x32_bf16 v[188:191], v[92:95], v[76:79], v[188:191]
v_mfma_f32_16x16x32_bf16 v[180:183], v[92:95], v[72:75], v[180:183]
v_mfma_f32_16x16x32_bf16 v[172:175], v[92:95], v[68:71], v[172:175]
v_mfma_f32_16x16x32_bf16 v[164:167], v[92:95], v[64:67], v[164:167]
s_waitcnt lgkmcnt(0)
s_barrier
v_mfma_f32_16x16x32_bf16 v[128:131], v[112:115], v[96:99], v[128:131]
ds_read_b128 v[32:35], v19 offset:0
v_mfma_f32_16x16x32_bf16 v[136:139], v[112:115], v[100:103], v[136:139]
ds_read_b64_tr_b16 v[48:49], v9 offset:0
v_mfma_f32_16x16x32_bf16 v[144:147], v[112:115], v[104:107], v[144:147]
ds_read_b64_tr_b16 v[50:51], v9 offset:4096
v_mfma_f32_16x16x32_bf16 v[152:155], v[112:115], v[108:111], v[152:155]
ds_read_b64_tr_b16 v[52:53], v10 offset:0
v_mfma_f32_16x16x32_bf16 v[156:159], v[116:119], v[108:111], v[156:159]
ds_read_b64_tr_b16 v[54:55], v10 offset:4096
v_mfma_f32_16x16x32_bf16 v[148:151], v[116:119], v[104:107], v[148:151]
ds_read_b64_tr_b16 v[56:57], v11 offset:0
v_mfma_f32_16x16x32_bf16 v[140:143], v[116:119], v[100:103], v[140:143]
ds_read_b64_tr_b16 v[58:59], v11 offset:4096
v_mfma_f32_16x16x32_bf16 v[132:135], v[116:119], v[96:99], v[132:135]
ds_read_b64_tr_b16 v[60:61], v12 offset:0
v_mfma_f32_16x16x32_bf16 v[160:163], v[120:123], v[96:99], v[160:163]
ds_read_b64_tr_b16 v[62:63], v12 offset:4096
v_mfma_f32_16x16x32_bf16 v[168:171], v[120:123], v[100:103], v[168:171]
ds_read_b128 v[36:39], v19 offset:1024
v_mfma_f32_16x16x32_bf16 v[176:179], v[120:123], v[104:107], v[176:179]
ds_read_b128 v[40:43], v19 offset:2048
v_mfma_f32_16x16x32_bf16 v[184:187], v[120:123], v[108:111], v[184:187]
ds_read_b128 v[44:47], v19 offset:3072
v_mfma_f32_16x16x32_bf16 v[188:191], v[124:127], v[108:111], v[188:191]
ds_read_b128 v[64:67], v19 offset:8192
v_mfma_f32_16x16x32_bf16 v[180:183], v[124:127], v[104:107], v[180:183]
ds_read_b64_tr_b16 v[80:81], v9 offset:8192
v_mfma_f32_16x16x32_bf16 v[172:175], v[124:127], v[100:103], v[172:175]
ds_read_b64_tr_b16 v[82:83], v9 offset:12288
v_mfma_f32_16x16x32_bf16 v[164:167], v[124:127], v[96:99], v[164:167]
ds_read_b64_tr_b16 v[84:85], v10 offset:8192
v_mfma_f32_16x16x32_bf16 v[128:131], v[208:211], v[192:195], v[128:131]
ds_read_b64_tr_b16 v[86:87], v10 offset:12288
v_mfma_f32_16x16x32_bf16 v[136:139], v[208:211], v[196:199], v[136:139]
ds_read_b64_tr_b16 v[88:89], v11 offset:8192
v_mfma_f32_16x16x32_bf16 v[144:147], v[208:211], v[200:203], v[144:147]
ds_read_b64_tr_b16 v[90:91], v11 offset:12288
v_mfma_f32_16x16x32_bf16 v[152:155], v[208:211], v[204:207], v[152:155]
ds_read_b64_tr_b16 v[92:93], v12 offset:8192
v_mfma_f32_16x16x32_bf16 v[156:159], v[212:215], v[204:207], v[156:159]
ds_read_b64_tr_b16 v[94:95], v12 offset:12288
v_mfma_f32_16x16x32_bf16 v[148:151], v[212:215], v[200:203], v[148:151]
ds_read_b128 v[68:71], v19 offset:9216
v_mfma_f32_16x16x32_bf16 v[140:143], v[212:215], v[196:199], v[140:143]
ds_read_b128 v[72:75], v19 offset:10240
v_mfma_f32_16x16x32_bf16 v[132:135], v[212:215], v[192:195], v[132:135]
ds_read_b128 v[76:79], v19 offset:11264
v_mfma_f32_16x16x32_bf16 v[160:163], v[216:219], v[192:195], v[160:163]
v_mfma_f32_16x16x32_bf16 v[168:171], v[216:219], v[196:199], v[168:171]
v_mfma_f32_16x16x32_bf16 v[176:179], v[216:219], v[200:203], v[176:179]
v_mfma_f32_16x16x32_bf16 v[184:187], v[216:219], v[204:207], v[184:187]
v_mfma_f32_16x16x32_bf16 v[188:191], v[220:223], v[204:207], v[188:191]
v_mfma_f32_16x16x32_bf16 v[180:183], v[220:223], v[200:203], v[180:183]
v_mfma_f32_16x16x32_bf16 v[172:175], v[220:223], v[196:199], v[172:175]
v_mfma_f32_16x16x32_bf16 v[164:167], v[220:223], v[192:195], v[164:167]
s_waitcnt lgkmcnt(0)
s_barrier
v_mfma_f32_16x16x32_bf16 v[128:131], v[48:51], v[32:35], v[128:131]
ds_read_b128 v[96:99], v17 offset:16384
v_mfma_f32_16x16x32_bf16 v[136:139], v[48:51], v[36:39], v[136:139]
ds_read_b64_tr_b16 v[112:113], v9 offset:32768
v_mfma_f32_16x16x32_bf16 v[144:147], v[48:51], v[40:43], v[144:147]
ds_read_b64_tr_b16 v[114:115], v9 offset:36864
v_mfma_f32_16x16x32_bf16 v[152:155], v[48:51], v[44:47], v[152:155]
ds_read_b64_tr_b16 v[116:117], v10 offset:32768
v_mfma_f32_16x16x32_bf16 v[156:159], v[52:55], v[44:47], v[156:159]
ds_read_b64_tr_b16 v[118:119], v10 offset:36864
v_mfma_f32_16x16x32_bf16 v[148:151], v[52:55], v[40:43], v[148:151]
ds_read_b64_tr_b16 v[120:121], v11 offset:32768
v_mfma_f32_16x16x32_bf16 v[140:143], v[52:55], v[36:39], v[140:143]
ds_read_b64_tr_b16 v[122:123], v11 offset:36864
v_mfma_f32_16x16x32_bf16 v[132:135], v[52:55], v[32:35], v[132:135]
ds_read_b64_tr_b16 v[124:125], v12 offset:32768
v_mfma_f32_16x16x32_bf16 v[160:163], v[56:59], v[32:35], v[160:163]
ds_read_b64_tr_b16 v[126:127], v12 offset:36864
v_mfma_f32_16x16x32_bf16 v[168:171], v[56:59], v[36:39], v[168:171]
ds_read_b128 v[100:103], v17 offset:17408
v_mfma_f32_16x16x32_bf16 v[176:179], v[56:59], v[40:43], v[176:179]
ds_read_b128 v[104:107], v17 offset:18432
v_mfma_f32_16x16x32_bf16 v[184:187], v[56:59], v[44:47], v[184:187]
ds_read_b128 v[108:111], v17 offset:19456
v_mfma_f32_16x16x32_bf16 v[188:191], v[60:63], v[44:47], v[188:191]
ds_read_b128 v[192:195], v17 offset:24576
v_mfma_f32_16x16x32_bf16 v[180:183], v[60:63], v[40:43], v[180:183]
ds_read_b64_tr_b16 v[208:209], v9 offset:40960
v_mfma_f32_16x16x32_bf16 v[172:175], v[60:63], v[36:39], v[172:175]
ds_read_b64_tr_b16 v[210:211], v9 offset:45056
v_mfma_f32_16x16x32_bf16 v[164:167], v[60:63], v[32:35], v[164:167]
ds_read_b64_tr_b16 v[212:213], v10 offset:40960
v_mfma_f32_16x16x32_bf16 v[128:131], v[80:83], v[64:67], v[128:131]
ds_read_b64_tr_b16 v[214:215], v10 offset:45056
v_mfma_f32_16x16x32_bf16 v[136:139], v[80:83], v[68:71], v[136:139]
ds_read_b64_tr_b16 v[216:217], v11 offset:40960
v_mfma_f32_16x16x32_bf16 v[144:147], v[80:83], v[72:75], v[144:147]
ds_read_b64_tr_b16 v[218:219], v11 offset:45056
v_mfma_f32_16x16x32_bf16 v[152:155], v[80:83], v[76:79], v[152:155]
ds_read_b64_tr_b16 v[220:221], v12 offset:40960
v_mfma_f32_16x16x32_bf16 v[156:159], v[84:87], v[76:79], v[156:159]
ds_read_b64_tr_b16 v[222:223], v12 offset:45056
v_mfma_f32_16x16x32_bf16 v[148:151], v[84:87], v[72:75], v[148:151]
ds_read_b128 v[196:199], v17 offset:25600
v_mfma_f32_16x16x32_bf16 v[140:143], v[84:87], v[68:71], v[140:143]
ds_read_b128 v[200:203], v17 offset:26624
v_mfma_f32_16x16x32_bf16 v[132:135], v[84:87], v[64:67], v[132:135]
ds_read_b128 v[204:207], v17 offset:27648
v_mfma_f32_16x16x32_bf16 v[160:163], v[88:91], v[64:67], v[160:163]
v_mfma_f32_16x16x32_bf16 v[168:171], v[88:91], v[68:71], v[168:171]
v_mfma_f32_16x16x32_bf16 v[176:179], v[88:91], v[72:75], v[176:179]
v_mfma_f32_16x16x32_bf16 v[184:187], v[88:91], v[76:79], v[184:187]
v_mfma_f32_16x16x32_bf16 v[188:191], v[92:95], v[76:79], v[188:191]
v_mfma_f32_16x16x32_bf16 v[180:183], v[92:95], v[72:75], v[180:183]
v_mfma_f32_16x16x32_bf16 v[172:175], v[92:95], v[68:71], v[172:175]
v_mfma_f32_16x16x32_bf16 v[164:167], v[92:95], v[64:67], v[164:167]
s_waitcnt lgkmcnt(0)
s_barrier
v_mfma_f32_16x16x32_bf16 v[128:131], v[112:115], v[96:99], v[128:131]
ds_read_b128 v[32:35], v17 offset:49152
v_mfma_f32_16x16x32_bf16 v[136:139], v[112:115], v[100:103], v[136:139]
ds_read_b64_tr_b16 v[48:49], v13 offset:0
v_mfma_f32_16x16x32_bf16 v[144:147], v[112:115], v[104:107], v[144:147]
ds_read_b64_tr_b16 v[50:51], v13 offset:4096
v_mfma_f32_16x16x32_bf16 v[152:155], v[112:115], v[108:111], v[152:155]
ds_read_b64_tr_b16 v[52:53], v14 offset:0
v_mfma_f32_16x16x32_bf16 v[156:159], v[116:119], v[108:111], v[156:159]
ds_read_b64_tr_b16 v[54:55], v14 offset:4096
v_mfma_f32_16x16x32_bf16 v[148:151], v[116:119], v[104:107], v[148:151]
ds_read_b64_tr_b16 v[56:57], v15 offset:0
v_mfma_f32_16x16x32_bf16 v[140:143], v[116:119], v[100:103], v[140:143]
ds_read_b64_tr_b16 v[58:59], v15 offset:4096
v_mfma_f32_16x16x32_bf16 v[132:135], v[116:119], v[96:99], v[132:135]
ds_read_b64_tr_b16 v[60:61], v16 offset:0
v_mfma_f32_16x16x32_bf16 v[160:163], v[120:123], v[96:99], v[160:163]
ds_read_b64_tr_b16 v[62:63], v16 offset:4096
v_mfma_f32_16x16x32_bf16 v[168:171], v[120:123], v[100:103], v[168:171]
ds_read_b128 v[36:39], v17 offset:50176
v_mfma_f32_16x16x32_bf16 v[176:179], v[120:123], v[104:107], v[176:179]
ds_read_b128 v[40:43], v17 offset:51200
v_mfma_f32_16x16x32_bf16 v[184:187], v[120:123], v[108:111], v[184:187]
ds_read_b128 v[44:47], v17 offset:52224
v_mfma_f32_16x16x32_bf16 v[188:191], v[124:127], v[108:111], v[188:191]
ds_read_b128 v[64:67], v17 offset:57344
v_mfma_f32_16x16x32_bf16 v[180:183], v[124:127], v[104:107], v[180:183]
ds_read_b64_tr_b16 v[80:81], v13 offset:8192
v_mfma_f32_16x16x32_bf16 v[172:175], v[124:127], v[100:103], v[172:175]
ds_read_b64_tr_b16 v[82:83], v13 offset:12288
v_mfma_f32_16x16x32_bf16 v[164:167], v[124:127], v[96:99], v[164:167]
ds_read_b64_tr_b16 v[84:85], v14 offset:8192
v_mfma_f32_16x16x32_bf16 v[128:131], v[208:211], v[192:195], v[128:131]
ds_read_b64_tr_b16 v[86:87], v14 offset:12288
v_mfma_f32_16x16x32_bf16 v[136:139], v[208:211], v[196:199], v[136:139]
ds_read_b64_tr_b16 v[88:89], v15 offset:8192
v_mfma_f32_16x16x32_bf16 v[144:147], v[208:211], v[200:203], v[144:147]
ds_read_b64_tr_b16 v[90:91], v15 offset:12288
v_mfma_f32_16x16x32_bf16 v[152:155], v[208:211], v[204:207], v[152:155]
ds_read_b64_tr_b16 v[92:93], v16 offset:8192
v_mfma_f32_16x16x32_bf16 v[156:159], v[212:215], v[204:207], v[156:159]
ds_read_b64_tr_b16 v[94:95], v16 offset:12288
v_mfma_f32_16x16x32_bf16 v[148:151], v[212:215], v[200:203], v[148:151]
ds_read_b128 v[68:71], v17 offset:58368
v_mfma_f32_16x16x32_bf16 v[140:143], v[212:215], v[196:199], v[140:143]
ds_read_b128 v[72:75], v17 offset:59392
v_mfma_f32_16x16x32_bf16 v[132:135], v[212:215], v[192:195], v[132:135]
ds_read_b128 v[76:79], v17 offset:60416
v_mfma_f32_16x16x32_bf16 v[160:163], v[216:219], v[192:195], v[160:163]
v_mfma_f32_16x16x32_bf16 v[168:171], v[216:219], v[196:199], v[168:171]
v_mfma_f32_16x16x32_bf16 v[176:179], v[216:219], v[200:203], v[176:179]
v_mfma_f32_16x16x32_bf16 v[184:187], v[216:219], v[204:207], v[184:187]
v_mfma_f32_16x16x32_bf16 v[188:191], v[220:223], v[204:207], v[188:191]
v_mfma_f32_16x16x32_bf16 v[180:183], v[220:223], v[200:203], v[180:183]
v_mfma_f32_16x16x32_bf16 v[172:175], v[220:223], v[196:199], v[172:175]
v_mfma_f32_16x16x32_bf16 v[164:167], v[220:223], v[192:195], v[164:167]
s_waitcnt lgkmcnt(0)
s_barrier
v_mfma_f32_16x16x32_bf16 v[128:131], v[48:51], v[32:35], v[128:131]
ds_read_b128 v[96:99], v18 offset:16384
v_mfma_f32_16x16x32_bf16 v[136:139], v[48:51], v[36:39], v[136:139]
ds_read_b64_tr_b16 v[112:113], v25 offset:16384
v_mfma_f32_16x16x32_bf16 v[144:147], v[48:51], v[40:43], v[144:147]
ds_read_b64_tr_b16 v[114:115], v25 offset:20480
v_mfma_f32_16x16x32_bf16 v[152:155], v[48:51], v[44:47], v[152:155]
ds_read_b64_tr_b16 v[116:117], v26 offset:16384
v_mfma_f32_16x16x32_bf16 v[156:159], v[52:55], v[44:47], v[156:159]
ds_read_b64_tr_b16 v[118:119], v26 offset:20480
v_mfma_f32_16x16x32_bf16 v[148:151], v[52:55], v[40:43], v[148:151]
ds_read_b64_tr_b16 v[120:121], v27 offset:16384
v_mfma_f32_16x16x32_bf16 v[140:143], v[52:55], v[36:39], v[140:143]
ds_read_b64_tr_b16 v[122:123], v27 offset:20480
v_mfma_f32_16x16x32_bf16 v[132:135], v[52:55], v[32:35], v[132:135]
ds_read_b64_tr_b16 v[124:125], v28 offset:16384
v_mfma_f32_16x16x32_bf16 v[160:163], v[56:59], v[32:35], v[160:163]
ds_read_b64_tr_b16 v[126:127], v28 offset:20480
v_mfma_f32_16x16x32_bf16 v[168:171], v[56:59], v[36:39], v[168:171]
ds_read_b128 v[100:103], v18 offset:17408
v_mfma_f32_16x16x32_bf16 v[176:179], v[56:59], v[40:43], v[176:179]
ds_read_b128 v[104:107], v18 offset:18432
v_mfma_f32_16x16x32_bf16 v[184:187], v[56:59], v[44:47], v[184:187]
ds_read_b128 v[108:111], v18 offset:19456
v_mfma_f32_16x16x32_bf16 v[188:191], v[60:63], v[44:47], v[188:191]
ds_read_b128 v[192:195], v18 offset:24576
v_mfma_f32_16x16x32_bf16 v[180:183], v[60:63], v[40:43], v[180:183]
ds_read_b64_tr_b16 v[208:209], v25 offset:24576
v_mfma_f32_16x16x32_bf16 v[172:175], v[60:63], v[36:39], v[172:175]
ds_read_b64_tr_b16 v[210:211], v25 offset:28672
v_mfma_f32_16x16x32_bf16 v[164:167], v[60:63], v[32:35], v[164:167]
ds_read_b64_tr_b16 v[212:213], v26 offset:24576
v_mfma_f32_16x16x32_bf16 v[128:131], v[80:83], v[64:67], v[128:131]
ds_read_b64_tr_b16 v[214:215], v26 offset:28672
v_mfma_f32_16x16x32_bf16 v[136:139], v[80:83], v[68:71], v[136:139]
ds_read_b64_tr_b16 v[216:217], v27 offset:24576
v_mfma_f32_16x16x32_bf16 v[144:147], v[80:83], v[72:75], v[144:147]
ds_read_b64_tr_b16 v[218:219], v27 offset:28672
v_mfma_f32_16x16x32_bf16 v[152:155], v[80:83], v[76:79], v[152:155]
ds_read_b64_tr_b16 v[220:221], v28 offset:24576
v_mfma_f32_16x16x32_bf16 v[156:159], v[84:87], v[76:79], v[156:159]
ds_read_b64_tr_b16 v[222:223], v28 offset:28672
v_mfma_f32_16x16x32_bf16 v[148:151], v[84:87], v[72:75], v[148:151]
ds_read_b128 v[196:199], v18 offset:25600
v_mfma_f32_16x16x32_bf16 v[140:143], v[84:87], v[68:71], v[140:143]
ds_read_b128 v[200:203], v18 offset:26624
v_mfma_f32_16x16x32_bf16 v[132:135], v[84:87], v[64:67], v[132:135]
ds_read_b128 v[204:207], v18 offset:27648
v_mfma_f32_16x16x32_bf16 v[160:163], v[88:91], v[64:67], v[160:163]
v_mfma_f32_16x16x32_bf16 v[168:171], v[88:91], v[68:71], v[168:171]
v_mfma_f32_16x16x32_bf16 v[176:179], v[88:91], v[72:75], v[176:179]
v_mfma_f32_16x16x32_bf16 v[184:187], v[88:91], v[76:79], v[184:187]
v_mfma_f32_16x16x32_bf16 v[188:191], v[92:95], v[76:79], v[188:191]
v_mfma_f32_16x16x32_bf16 v[180:183], v[92:95], v[72:75], v[180:183]
v_mfma_f32_16x16x32_bf16 v[172:175], v[92:95], v[68:71], v[172:175]
v_mfma_f32_16x16x32_bf16 v[164:167], v[92:95], v[64:67], v[164:167]
s_waitcnt lgkmcnt(0)
s_barrier
v_mfma_f32_16x16x32_bf16 v[128:131], v[112:115], v[96:99], v[128:131]
ds_read_b128 v[32:35], v18 offset:32768
v_mfma_f32_16x16x32_bf16 v[136:139], v[112:115], v[100:103], v[136:139]
ds_read_b64_tr_b16 v[48:49], v13 offset:49152
v_mfma_f32_16x16x32_bf16 v[144:147], v[112:115], v[104:107], v[144:147]
ds_read_b64_tr_b16 v[50:51], v13 offset:53248
v_mfma_f32_16x16x32_bf16 v[152:155], v[112:115], v[108:111], v[152:155]
ds_read_b64_tr_b16 v[52:53], v14 offset:49152
v_mfma_f32_16x16x32_bf16 v[156:159], v[116:119], v[108:111], v[156:159]
ds_read_b64_tr_b16 v[54:55], v14 offset:53248
v_mfma_f32_16x16x32_bf16 v[148:151], v[116:119], v[104:107], v[148:151]
ds_read_b64_tr_b16 v[56:57], v15 offset:49152
v_mfma_f32_16x16x32_bf16 v[140:143], v[116:119], v[100:103], v[140:143]
ds_read_b64_tr_b16 v[58:59], v15 offset:53248
v_mfma_f32_16x16x32_bf16 v[132:135], v[116:119], v[96:99], v[132:135]
ds_read_b64_tr_b16 v[60:61], v16 offset:49152
v_mfma_f32_16x16x32_bf16 v[160:163], v[120:123], v[96:99], v[160:163]
ds_read_b64_tr_b16 v[62:63], v16 offset:53248
v_mfma_f32_16x16x32_bf16 v[168:171], v[120:123], v[100:103], v[168:171]
ds_read_b128 v[36:39], v18 offset:33792
v_mfma_f32_16x16x32_bf16 v[176:179], v[120:123], v[104:107], v[176:179]
ds_read_b128 v[40:43], v18 offset:34816
v_mfma_f32_16x16x32_bf16 v[184:187], v[120:123], v[108:111], v[184:187]
ds_read_b128 v[44:47], v18 offset:35840
v_mfma_f32_16x16x32_bf16 v[188:191], v[124:127], v[108:111], v[188:191]
ds_read_b128 v[64:67], v18 offset:40960
v_mfma_f32_16x16x32_bf16 v[180:183], v[124:127], v[104:107], v[180:183]
ds_read_b64_tr_b16 v[80:81], v13 offset:57344
v_mfma_f32_16x16x32_bf16 v[172:175], v[124:127], v[100:103], v[172:175]
ds_read_b64_tr_b16 v[82:83], v13 offset:61440
v_mfma_f32_16x16x32_bf16 v[164:167], v[124:127], v[96:99], v[164:167]
ds_read_b64_tr_b16 v[84:85], v14 offset:57344
v_mfma_f32_16x16x32_bf16 v[128:131], v[208:211], v[192:195], v[128:131]
ds_read_b64_tr_b16 v[86:87], v14 offset:61440
v_mfma_f32_16x16x32_bf16 v[136:139], v[208:211], v[196:199], v[136:139]
ds_read_b64_tr_b16 v[88:89], v15 offset:57344
v_mfma_f32_16x16x32_bf16 v[144:147], v[208:211], v[200:203], v[144:147]
ds_read_b64_tr_b16 v[90:91], v15 offset:61440
v_mfma_f32_16x16x32_bf16 v[152:155], v[208:211], v[204:207], v[152:155]
ds_read_b64_tr_b16 v[92:93], v16 offset:57344
v_mfma_f32_16x16x32_bf16 v[156:159], v[212:215], v[204:207], v[156:159]
ds_read_b64_tr_b16 v[94:95], v16 offset:61440
v_mfma_f32_16x16x32_bf16 v[148:151], v[212:215], v[200:203], v[148:151]
ds_read_b128 v[68:71], v18 offset:41984
v_mfma_f32_16x16x32_bf16 v[140:143], v[212:215], v[196:199], v[140:143]
ds_read_b128 v[72:75], v18 offset:43008
v_mfma_f32_16x16x32_bf16 v[132:135], v[212:215], v[192:195], v[132:135]
ds_read_b128 v[76:79], v18 offset:44032
v_mfma_f32_16x16x32_bf16 v[160:163], v[216:219], v[192:195], v[160:163]
v_mfma_f32_16x16x32_bf16 v[168:171], v[216:219], v[196:199], v[168:171]
v_mfma_f32_16x16x32_bf16 v[176:179], v[216:219], v[200:203], v[176:179]
v_mfma_f32_16x16x32_bf16 v[184:187], v[216:219], v[204:207], v[184:187]
v_mfma_f32_16x16x32_bf16 v[188:191], v[220:223], v[204:207], v[188:191]
v_mfma_f32_16x16x32_bf16 v[180:183], v[220:223], v[200:203], v[180:183]
v_mfma_f32_16x16x32_bf16 v[172:175], v[220:223], v[196:199], v[172:175]
v_mfma_f32_16x16x32_bf16 v[164:167], v[220:223], v[192:195], v[164:167]
s_waitcnt lgkmcnt(0)
s_barrier
v_mfma_f32_16x16x32_bf16 v[128:131], v[48:51], v[32:35], v[128:131]
ds_read_b128 v[96:99], v19 offset:0
v_mfma_f32_16x16x32_bf16 v[136:139], v[48:51], v[36:39], v[136:139]
ds_read_b64_tr_b16 v[112:113], v9 offset:0
v_mfma_f32_16x16x32_bf16 v[144:147], v[48:51], v[40:43], v[144:147]
ds_read_b64_tr_b16 v[114:115], v9 offset:4096
v_mfma_f32_16x16x32_bf16 v[152:155], v[48:51], v[44:47], v[152:155]
ds_read_b64_tr_b16 v[116:117], v10 offset:0
v_mfma_f32_16x16x32_bf16 v[156:159], v[52:55], v[44:47], v[156:159]
ds_read_b64_tr_b16 v[118:119], v10 offset:4096
v_mfma_f32_16x16x32_bf16 v[148:151], v[52:55], v[40:43], v[148:151]
ds_read_b64_tr_b16 v[120:121], v11 offset:0
v_mfma_f32_16x16x32_bf16 v[140:143], v[52:55], v[36:39], v[140:143]
ds_read_b64_tr_b16 v[122:123], v11 offset:4096
v_mfma_f32_16x16x32_bf16 v[132:135], v[52:55], v[32:35], v[132:135]
ds_read_b64_tr_b16 v[124:125], v12 offset:0
v_mfma_f32_16x16x32_bf16 v[160:163], v[56:59], v[32:35], v[160:163]
ds_read_b64_tr_b16 v[126:127], v12 offset:4096
v_mfma_f32_16x16x32_bf16 v[168:171], v[56:59], v[36:39], v[168:171]
ds_read_b128 v[100:103], v19 offset:1024
v_mfma_f32_16x16x32_bf16 v[176:179], v[56:59], v[40:43], v[176:179]
ds_read_b128 v[104:107], v19 offset:2048
v_mfma_f32_16x16x32_bf16 v[184:187], v[56:59], v[44:47], v[184:187]
ds_read_b128 v[108:111], v19 offset:3072
v_mfma_f32_16x16x32_bf16 v[188:191], v[60:63], v[44:47], v[188:191]
ds_read_b128 v[192:195], v19 offset:8192
v_mfma_f32_16x16x32_bf16 v[180:183], v[60:63], v[40:43], v[180:183]
ds_read_b64_tr_b16 v[208:209], v9 offset:8192
v_mfma_f32_16x16x32_bf16 v[172:175], v[60:63], v[36:39], v[172:175]
ds_read_b64_tr_b16 v[210:211], v9 offset:12288
v_mfma_f32_16x16x32_bf16 v[164:167], v[60:63], v[32:35], v[164:167]
ds_read_b64_tr_b16 v[212:213], v10 offset:8192
v_mfma_f32_16x16x32_bf16 v[128:131], v[80:83], v[64:67], v[128:131]
ds_read_b64_tr_b16 v[214:215], v10 offset:12288
v_mfma_f32_16x16x32_bf16 v[136:139], v[80:83], v[68:71], v[136:139]
ds_read_b64_tr_b16 v[216:217], v11 offset:8192
v_mfma_f32_16x16x32_bf16 v[144:147], v[80:83], v[72:75], v[144:147]
ds_read_b64_tr_b16 v[218:219], v11 offset:12288
v_mfma_f32_16x16x32_bf16 v[152:155], v[80:83], v[76:79], v[152:155]
ds_read_b64_tr_b16 v[220:221], v12 offset:8192
v_mfma_f32_16x16x32_bf16 v[156:159], v[84:87], v[76:79], v[156:159]
ds_read_b64_tr_b16 v[222:223], v12 offset:12288
v_mfma_f32_16x16x32_bf16 v[148:151], v[84:87], v[72:75], v[148:151]
ds_read_b128 v[196:199], v19 offset:9216
v_mfma_f32_16x16x32_bf16 v[140:143], v[84:87], v[68:71], v[140:143]
ds_read_b128 v[200:203], v19 offset:10240
v_mfma_f32_16x16x32_bf16 v[132:135], v[84:87], v[64:67], v[132:135]
ds_read_b128 v[204:207], v19 offset:11264
v_mfma_f32_16x16x32_bf16 v[160:163], v[88:91], v[64:67], v[160:163]
v_mfma_f32_16x16x32_bf16 v[168:171], v[88:91], v[68:71], v[168:171]
v_mfma_f32_16x16x32_bf16 v[176:179], v[88:91], v[72:75], v[176:179]
v_mfma_f32_16x16x32_bf16 v[184:187], v[88:91], v[76:79], v[184:187]
v_mfma_f32_16x16x32_bf16 v[188:191], v[92:95], v[76:79], v[188:191]
v_mfma_f32_16x16x32_bf16 v[180:183], v[92:95], v[72:75], v[180:183]
v_mfma_f32_16x16x32_bf16 v[172:175], v[92:95], v[68:71], v[172:175]
v_mfma_f32_16x16x32_bf16 v[164:167], v[92:95], v[64:67], v[164:167]
s_sub_u32 s41, s41, 1
s_cmp_lg_u32 s41, 0
s_cbranch_scc1 Lk4_136
s_waitcnt lgkmcnt(0)
s_barrier
v_mfma_f32_16x16x32_bf16 v[128:131], v[112:115], v[96:99], v[128:131]
ds_read_b128 v[32:35], v17 offset:16384
v_mfma_f32_16x16x32_bf16 v[136:139], v[112:115], v[100:103], v[136:139]
ds_read_b64_tr_b16 v[48:49], v224 offset:32768
v_mfma_f32_16x16x32_bf16 v[144:147], v[112:115], v[104:107], v[144:147]
ds_read_b64_tr_b16 v[50:51], v224 offset:34816
v_mfma_f32_16x16x32_bf16 v[152:155], v[112:115], v[108:111], v[152:155]
ds_read_b64_tr_b16 v[52:53], v225 offset:32768
v_mfma_f32_16x16x32_bf16 v[156:159], v[116:119], v[108:111], v[156:159]
ds_read_b64_tr_b16 v[54:55], v225 offset:34816
v_mfma_f32_16x16x32_bf16 v[148:151], v[116:119], v[104:107], v[148:151]
ds_read_b128 v[36:39], v17 offset:17408
v_mfma_f32_16x16x32_bf16 v[140:143], v[116:119], v[100:103], v[140:143]
ds_read_b128 v[40:43], v17 offset:18432
v_mfma_f32_16x16x32_bf16 v[132:135], v[116:119], v[96:99], v[132:135]
ds_read_b128 v[44:47], v17 offset:19456
v_mfma_f32_16x16x32_bf16 v[160:163], v[120:123], v[96:99], v[160:163]
ds_read_b128 v[64:67], v17 offset:24576
v_mfma_f32_16x16x32_bf16 v[168:171], v[120:123], v[100:103], v[168:171]
ds_read_b64_tr_b16 v[80:81], v224 offset:36864
v_mfma_f32_16x16x32_bf16 v[176:179], v[120:123], v[104:107], v[176:179]
ds_read_b64_tr_b16 v[82:83], v224 offset:38912
v_mfma_f32_16x16x32_bf16 v[184:187], v[120:123], v[108:111], v[184:187]
ds_read_b64_tr_b16 v[84:85], v225 offset:36864
v_mfma_f32_16x16x32_bf16 v[188:191], v[124:127], v[108:111], v[188:191]
ds_read_b64_tr_b16 v[86:87], v225 offset:38912
v_mfma_f32_16x16x32_bf16 v[180:183], v[124:127], v[104:107], v[180:183]
ds_read_b128 v[68:71], v17 offset:25600
v_mfma_f32_16x16x32_bf16 v[172:175], v[124:127], v[100:103], v[172:175]
ds_read_b128 v[72:75], v17 offset:26624
v_mfma_f32_16x16x32_bf16 v[164:167], v[124:127], v[96:99], v[164:167]
ds_read_b128 v[76:79], v17 offset:27648
v_mfma_f32_16x16x32_bf16 v[128:131], v[208:211], v[192:195], v[128:131]
v_mfma_f32_16x16x32_bf16 v[136:139], v[208:211], v[196:199], v[136:139]
v_mfma_f32_16x16x32_bf16 v[144:147], v[208:211], v[200:203], v[144:147]
v_mfma_f32_16x16x32_bf16 v[152:155], v[208:211], v[204:207], v[152:155]
v_mfma_f32_16x16x32_bf16 v[156:159], v[212:215], v[204:207], v[156:159]
v_mfma_f32_16x16x32_bf16 v[148:151], v[212:215], v[200:203], v[148:151]
v_mfma_f32_16x16x32_bf16 v[140:143], v[212:215], v[196:199], v[140:143]
v_mfma_f32_16x16x32_bf16 v[132:135], v[212:215], v[192:195], v[132:135]
s_branch Lov_12
.p2align 12
.fill 96, 4, 0xbf800000
Lst_12_0:
s_branch Lwr_172
Lst_12_1:
s_branch Lst_16_0
s_nop 0
Lov_12:
v_mfma_f32_16x16x32_bf16 v[160:163], v[216:219], v[192:195], v[160:163]
v_mfma_f32_16x16x32_bf16 v[168:171], v[216:219], v[196:199], v[168:171]
v_mfma_f32_16x16x32_bf16 v[176:179], v[216:219], v[200:203], v[176:179]
v_mfma_f32_16x16x32_bf16 v[184:187], v[216:219], v[204:207], v[184:187]
v_mfma_f32_16x16x32_bf16 v[188:191], v[220:223], v[204:207], v[188:191]
v_mfma_f32_16x16x32_bf16 v[180:183], v[220:223], v[200:203], v[180:183]
v_mfma_f32_16x16x32_bf16 v[172:175], v[220:223], v[196:199], v[172:175]
v_mfma_f32_16x16x32_bf16 v[164:167], v[220:223], v[192:195], v[164:167]
s_waitcnt lgkmcnt(0)
s_barrier
v_mfma_f32_16x16x32_bf16 v[128:131], v[48:51], v[32:35], v[128:131]
ds_read_b128 v[96:99], v17 offset:49152
ds_read_b64_tr_b16 v[112:113], v226 offset:0
v_mfma_f32_16x16x32_bf16 v[136:139], v[48:51], v[36:39], v[136:139]
ds_read_b64_tr_b16 v[114:115], v226 offset:2048
ds_read_b64_tr_b16 v[116:117], v227 offset:0
v_mfma_f32_16x16x32_bf16 v[144:147], v[48:51], v[40:43], v[144:147]
ds_read_b64_tr_b16 v[118:119], v227 offset:2048
ds_read_b128 v[100:103], v17 offset:50176
v_mfma_f32_16x16x32_bf16 v[152:155], v[48:51], v[44:47], v[152:155]
ds_read_b128 v[104:107], v17 offset:51200
ds_read_b128 v[108:111], v17 offset:52224
v_mfma_f32_16x16x32_bf16 v[156:159], v[52:55], v[44:47], v[156:159]
ds_read_b128 v[192:195], v17 offset:57344
v_mfma_f32_16x16x32_bf16 v[148:151], v[52:55], v[40:43], v[148:151]
ds_read_b64_tr_b16 v[208:209], v226 offset:4096
v_mfma_f32_16x16x32_bf16 v[140:143], v[52:55], v[36:39], v[140:143]
ds_read_b64_tr_b16 v[210:211], v226 offset:6144
v_cvt_pk_bf16_f32 v160, v160, v161
v_cvt_pk_bf16_f32 v161, v162, v163
v_mfma_f32_16x16x32_bf16 v[132:135], v[52:55], v[32:35], v[132:135]
ds_read_b64_tr_b16 v[212:213], v227 offset:4096
v_cvt_pk_bf16_f32 v162, v164, v165
v_cvt_pk_bf16_f32 v163, v166, v167
v_mfma_f32_16x16x32_bf16 v[128:131], v[80:83], v[64:67], v[128:131]
ds_read_b64_tr_b16 v[214:215], v227 offset:6144
v_cvt_pk_bf16_f32 v164, v168, v169
v_cvt_pk_bf16_f32 v165, v170, v171
v_mfma_f32_16x16x32_bf16 v[136:139], v[80:83], v[68:71], v[136:139]
ds_read_b128 v[196:199], v17 offset:58368
v_cvt_pk_bf16_f32 v166, v172, v173
v_cvt_pk_bf16_f32 v167, v174, v175
v_mfma_f32_16x16x32_bf16 v[144:147], v[80:83], v[72:75], v[144:147]
ds_read_b128 v[200:203], v17 offset:59392
v_cvt_pk_bf16_f32 v168, v176, v177
v_cvt_pk_bf16_f32 v169, v178, v179
v_mfma_f32_16x16x32_bf16 v[152:155], v[80:83], v[76:79], v[152:155]
ds_read_b128 v[204:207], v17 offset:60416
v_cvt_pk_bf16_f32 v170, v180, v181
v_cvt_pk_bf16_f32 v171, v182, v183
v_mfma_f32_16x16x32_bf16 v[156:159], v[84:87], v[76:79], v[156:159]
v_cvt_pk_bf16_f32 v172, v184, v185
v_cvt_pk_bf16_f32 v173, v186, v187
v_mfma_f32_16x16x32_bf16 v[148:151], v[84:87], v[72:75], v[148:151]
v_cvt_pk_bf16_f32 v174, v188, v189
v_cvt_pk_bf16_f32 v175, v190, v191
v_mfma_f32_16x16x32_bf16 v[140:143], v[84:87], v[68:71], v[140:143]
v_mfma_f32_16x16x32_bf16 v[132:135], v[84:87], v[64:67], v[132:135]
buffer_store_dwordx4 v[160:163], v2, s[84:87], s45 offen offset:0 sc1
s_waitcnt lgkmcnt(0)
s_barrier
v_mfma_f32_16x16x32_bf16 v[128:131], v[112:115], v[96:99], v[128:131]
ds_read_b128 v[32:35], v18 offset:16384
ds_read_b64_tr_b16 v[48:49], v228 offset:16384
v_mfma_f32_16x16x32_bf16 v[136:139], v[112:115], v[100:103], v[136:139]
ds_read_b64_tr_b16 v[50:51], v228 offset:18432
ds_read_b64_tr_b16 v[52:53], v229 offset:16384
v_mfma_f32_16x16x32_bf16 v[144:147], v[112:115], v[104:107], v[144:147]
ds_read_b64_tr_b16 v[54:55], v229 offset:18432
ds_read_b128 v[36:39], v18 offset:17408
v_mfma_f32_16x16x32_bf16 v[152:155], v[112:115], v[108:111], v[152:155]
ds_read_b128 v[40:43], v18 offset:18432
ds_read_b128 v[44:47], v18 offset:19456
v_mfma_f32_16x16x32_bf16 v[156:159], v[116:119], v[108:111], v[156:159]
ds_read_b128 v[64:67], v18 offset:24576
v_mfma_f32_16x16x32_bf16 v[148:151], v[116:119], v[104:107], v[148:151]
ds_read_b64_tr_b16 v[80:81], v228 offset:20480
v_mfma_f32_16x16x32_bf16 v[140:143], v[116:119], v[100:103], v[140:143]
ds_read_b64_tr_b16 v[82:83], v228 offset:22528
v_mfma_f32_16x16x32_bf16 v[132:135], v[116:119], v[96:99], v[132:135]
ds_read_b64_tr_b16 v[84:85], v229 offset:20480
v_mfma_f32_16x16x32_bf16 v[128:131], v[208:211], v[192:195], v[128:131]
ds_read_b64_tr_b16 v[86:87], v229 offset:22528
buffer_store_dwordx4 v[164:167], v2, s[84:87], s45 offen offset:1024 sc1
v_mfma_f32_16x16x32_bf16 v[136:139], v[208:211], v[196:199], v[136:139]
ds_read_b128 v[68:71], v18 offset:25600
v_mfma_f32_16x16x32_bf16 v[144:147], v[208:211], v[200:203], v[144:147]
ds_read_b128 v[72:75], v18 offset:26624
v_mfma_f32_16x16x32_bf16 v[152:155], v[208:211], v[204:207], v[152:155]
ds_read_b128 v[76:79], v18 offset:27648
v_mfma_f32_16x16x32_bf16 v[156:159], v[212:215], v[204:207], v[156:159]
v_mfma_f32_16x16x32_bf16 v[148:151], v[212:215], v[200:203], v[148:151]
v_mfma_f32_16x16x32_bf16 v[140:143], v[212:215], v[196:199], v[140:143]
v_mfma_f32_16x16x32_bf16 v[132:135], v[212:215], v[192:195], v[132:135]
s_waitcnt lgkmcnt(0)
s_barrier
v_mfma_f32_16x16x32_bf16 v[128:131], v[48:51], v[32:35], v[128:131]
ds_read_b128 v[96:99], v18 offset:32768
ds_read_b64_tr_b16 v[112:113], v226 offset:49152
v_mfma_f32_16x16x32_bf16 v[136:139], v[48:51], v[36:39], v[136:139]
ds_read_b64_tr_b16 v[114:115], v226 offset:51200
ds_read_b64_tr_b16 v[116:117], v227 offset:49152
v_mfma_f32_16x16x32_bf16 v[144:147], v[48:51], v[40:43], v[144:147]
ds_read_b64_tr_b16 v[118:119], v227 offset:51200
ds_read_b128 v[100:103], v18 offset:33792
v_mfma_f32_16x16x32_bf16 v[152:155], v[48:51], v[44:47], v[152:155]
ds_read_b128 v[104:107], v18 offset:34816
ds_read_b128 v[108:111], v18 offset:35840
v_mfma_f32_16x16x32_bf16 v[156:159], v[52:55], v[44:47], v[156:159]
ds_read_b128 v[192:195], v18 offset:40960
v_mfma_f32_16x16x32_bf16 v[148:151], v[52:55], v[40:43], v[148:151]
ds_read_b64_tr_b16 v[208:209], v226 offset:53248
v_mfma_f32_16x16x32_bf16 v[140:143], v[52:55], v[36:39], v[140:143]
ds_read_b64_tr_b16 v[210:211], v226 offset:55296
v_mfma_f32_16x16x32_bf16 v[132:135], v[52:55], v[32:35], v[132:135]
ds_read_b64_tr_b16 v[212:213], v227 offset:53248
v_mfma_f32_16x16x32_bf16 v[128:131], v[80:83], v[64:67], v[128:131]
ds_read_b64_tr_b16 v[214:215], v227 offset:55296
buffer_store_dwordx4 v[168:171], v2, s[84:87], s45 offen offset:2048 sc1
v_mfma_f32_16x16x32_bf16 v[136:139], v[80:83], v[68:71], v[136:139]
ds_read_b128 v[196:199], v18 offset:41984
v_mfma_f32_16x16x32_bf16 v[144:147], v[80:83], v[72:75], v[144:147]
ds_read_b128 v[200:203], v18 offset:43008
v_mfma_f32_16x16x32_bf16 v[152:155], v[80:83], v[76:79], v[152:155]
ds_read_b128 v[204:207], v18 offset:44032
v_mfma_f32_16x16x32_bf16 v[156:159], v[84:87], v[76:79], v[156:159]
v_mfma_f32_16x16x32_bf16 v[148:151], v[84:87], v[72:75], v[148:151]
v_mfma_f32_16x16x32_bf16 v[140:143], v[84:87], v[68:71], v[140:143]
v_mfma_f32_16x16x32_bf16 v[132:135], v[84:87], v[64:67], v[132:135]
s_waitcnt lgkmcnt(0)
s_barrier
v_mfma_f32_16x16x32_bf16 v[128:131], v[112:115], v[96:99], v[128:131]
ds_read_b128 v[32:35], v19 offset:0
ds_read_b64_tr_b16 v[48:49], v224 offset:0
v_mfma_f32_16x16x32_bf16 v[136:139], v[112:115], v[100:103], v[136:139]
ds_read_b64_tr_b16 v[50:51], v224 offset:2048
ds_read_b64_tr_b16 v[52:53], v225 offset:0
v_mfma_f32_16x16x32_bf16 v[144:147], v[112:115], v[104:107], v[144:147]
ds_read_b64_tr_b16 v[54:55], v225 offset:2048
ds_read_b128 v[36:39], v19 offset:1024
v_mfma_f32_16x16x32_bf16 v[152:155], v[112:115], v[108:111], v[152:155]
ds_read_b128 v[40:43], v19 offset:2048
ds_read_b128 v[44:47], v19 offset:3072
v_mfma_f32_16x16x32_bf16 v[156:159], v[116:119], v[108:111], v[156:159]
ds_read_b128 v[64:67], v19 offset:8192
v_mfma_f32_16x16x32_bf16 v[148:151], v[116:119], v[104:107], v[148:151]
ds_read_b64_tr_b16 v[80:81], v224 offset:4096
v_mfma_f32_16x16x32_bf16 v[140:143], v[116:119], v[100:103], v[140:143]
ds_read_b64_tr_b16 v[82:83], v224 offset:6144
v_mfma_f32_16x16x32_bf16 v[132:135], v[116:119], v[96:99], v[132:135]
ds_read_b64_tr_b16 v[84:85], v225 offset:4096
v_mfma_f32_16x16x32_bf16 v[128:131], v[208:211], v[192:195], v[128:131]
ds_read_b64_tr_b16 v[86:87], v225 offset:6144
buffer_store_dwordx4 v[172:175], v2, s[84:87], s45 offen offset:3072 sc1
v_mfma_f32_16x16x32_bf16 v[136:139], v[208:211], v[196:199], v[136:139]
ds_read_b128 v[68:71], v19 offset:9216
v_mfma_f32_16x16x32_bf16 v[144:147], v[208:211], v[200:203], v[144:147]
ds_read_b128 v[72:75], v19 offset:10240
v_mfma_f32_16x16x32_bf16 v[152:155], v[208:211], v[204:207], v[152:155]
ds_read_b128 v[76:79], v19 offset:11264
v_mfma_f32_16x16x32_bf16 v[156:159], v[212:215], v[204:207], v[156:159]
v_mfma_f32_16x16x32_bf16 v[148:151], v[212:215], v[200:203], v[148:151]
v_mfma_f32_16x16x32_bf16 v[140:143], v[212:215], v[196:199], v[140:143]
v_mfma_f32_16x16x32_bf16 v[132:135], v[212:215], v[192:195], v[132:135]
s_waitcnt lgkmcnt(0)
s_barrier
v_mfma_f32_16x16x32_bf16 v[128:131], v[48:51], v[32:35], v[128:131]
ds_read_b128 v[96:99], v17 offset:16384
ds_read_b64_tr_b16 v[112:113], v224 offset:32768
v_mfma_f32_16x16x32_bf16 v[136:139], v[48:51], v[36:39], v[136:139]
ds_read_b64_tr_b16 v[114:115], v224 offset:34816
ds_read_b64_tr_b16 v[116:117], v225 offset:32768
v_mfma_f32_16x16x32_bf16 v[144:147], v[48:51], v[40:43], v[144:147]
ds_read_b64_tr_b16 v[118:119], v225 offset:34816
ds_read_b128 v[100:103], v17 offset:17408
v_mfma_f32_16x16x32_bf16 v[152:155], v[48:51], v[44:47], v[152:155]
ds_read_b128 v[104:107], v17 offset:18432
ds_read_b128 v[108:111], v17 offset:19456
v_mfma_f32_16x16x32_bf16 v[156:159], v[52:55], v[44:47], v[156:159]
ds_read_b128 v[192:195], v17 offset:24576
v_mfma_f32_16x16x32_bf16 v[148:151], v[52:55], v[40:43], v[148:151]
ds_read_b64_tr_b16 v[208:209], v224 offset:36864
v_mfma_f32_16x16x32_bf16 v[140:143], v[52:55], v[36:39], v[140:143]
ds_read_b64_tr_b16 v[210:211], v224 offset:38912
v_mfma_f32_16x16x32_bf16 v[132:135], v[52:55], v[32:35], v[132:135]
ds_read_b64_tr_b16 v[212:213], v225 offset:36864
v_mfma_f32_16x16x32_bf16 v[128:131], v[80:83], v[64:67], v[128:131]
ds_read_b64_tr_b16 v[214:215], v225 offset:38912
v_mfma_f32_16x16x32_bf16 v[136:139], v[80:83], v[68:71], v[136:139]
ds_read_b128 v[196:199], v17 offset:25600
v_mfma_f32_16x16x32_bf16 v[144:147], v[80:83], v[72:75], v[144:147]
ds_read_b128 v[200:203], v17 offset:26624
v_mfma_f32_16x16x32_bf16 v[152:155], v[80:83], v[76:79], v[152:155]
ds_read_b128 v[204:207], v17 offset:27648
v_mfma_f32_16x16x32_bf16 v[156:159], v[84:87], v[76:79], v[156:159]
v_mfma_f32_16x16x32_bf16 v[148:151], v[84:87], v[72:75], v[148:151]
v_mfma_f32_16x16x32_bf16 v[140:143], v[84:87], v[68:71], v[140:143]
v_mfma_f32_16x16x32_bf16 v[132:135], v[84:87], v[64:67], v[132:135]
s_waitcnt vmcnt(0)
s_waitcnt lgkmcnt(0)
s_barrier
v_mfma_f32_16x16x32_bf16 v[128:131], v[112:115], v[96:99], v[128:131]
ds_read_b128 v[32:35], v17 offset:49152
ds_read_b64_tr_b16 v[48:49], v226 offset:0
v_mfma_f32_16x16x32_bf16 v[136:139], v[112:115], v[100:103], v[136:139]
ds_read_b64_tr_b16 v[50:51], v226 offset:2048
ds_read_b64_tr_b16 v[52:53], v227 offset:0
v_mfma_f32_16x16x32_bf16 v[144:147], v[112:115], v[104:107], v[144:147]
ds_read_b64_tr_b16 v[54:55], v227 offset:2048
ds_read_b128 v[36:39], v17 offset:50176
v_mfma_f32_16x16x32_bf16 v[152:155], v[112:115], v[108:111], v[152:155]
ds_read_b128 v[40:43], v17 offset:51200
ds_read_b128 v[44:47], v17 offset:52224
v_mfma_f32_16x16x32_bf16 v[156:159], v[116:119], v[108:111], v[156:159]
ds_read_b128 v[64:67], v17 offset:57344
v_mfma_f32_16x16x32_bf16 v[148:151], v[116:119], v[104:107], v[148:151]
ds_read_b64_tr_b16 v[80:81], v226 offset:4096
v_mfma_f32_16x16x32_bf16 v[140:143], v[116:119], v[100:103], v[140:143]
ds_read_b64_tr_b16 v[82:83], v226 offset:6144
v_mfma_f32_16x16x32_bf16 v[132:135], v[116:119], v[96:99], v[132:135]
ds_read_b64_tr_b16 v[84:85], v227 offset:4096
v_mfma_f32_16x16x32_bf16 v[128:131], v[208:211], v[192:195], v[128:131]
ds_read_b64_tr_b16 v[86:87], v227 offset:6144
v_mfma_f32_16x16x32_bf16 v[136:139], v[208:211], v[196:199], v[136:139]
ds_read_b128 v[68:71], v17 offset:58368
v_mfma_f32_16x16x32_bf16 v[144:147], v[208:211], v[200:203], v[144:147]
ds_read_b128 v[72:75], v17 offset:59392
v_mfma_f32_16x16x32_bf16 v[152:155], v[208:211], v[204:207], v[152:155]
ds_read_b128 v[76:79], v17 offset:60416
v_mfma_f32_16x16x32_bf16 v[156:159], v[212:215], v[204:207], v[156:159]
v_mfma_f32_16x16x32_bf16 v[148:151], v[212:215], v[200:203], v[148:151]
v_mfma_f32_16x16x32_bf16 v[140:143], v[212:215], v[196:199], v[140:143]
v_mfma_f32_16x16x32_bf16 v[132:135], v[212:215], v[192:195], v[132:135]
s_waitcnt lgkmcnt(0)
s_barrier
v_mfma_f32_16x16x32_bf16 v[128:131], v[48:51], v[32:35], v[128:131]
ds_read_b128 v[96:99], v18 offset:16384
ds_read_b64_tr_b16 v[112:113], v228 offset:16384
v_mfma_f32_16x16x32_bf16 v[136:139], v[48:51], v[36:39], v[136:139]
ds_read_b64_tr_b16 v[114:115], v228 offset:18432
ds_read_b64_tr_b16 v[116:117], v229 offset:16384
v_mfma_f32_16x16x32_bf16 v[144:147], v[48:51], v[40:43], v[144:147]
ds_read_b64_tr_b16 v[118:119], v229 offset:18432
ds_read_b128 v[100:103], v18 offset:17408
v_mfma_f32_16x16x32_bf16 v[152:155], v[48:51], v[44:47], v[152:155]
ds_read_b128 v[104:107], v18 offset:18432
ds_read_b128 v[108:111], v18 offset:19456
v_mfma_f32_16x16x32_bf16 v[156:159], v[52:55], v[44:47], v[156:159]
ds_read_b128 v[192:195], v18 offset:24576
v_mfma_f32_16x16x32_bf16 v[148:151], v[52:55], v[40:43], v[148:151]
ds_read_b64_tr_b16 v[208:209], v228 offset:20480
v_mfma_f32_16x16x32_bf16 v[140:143], v[52:55], v[36:39], v[140:143]
ds_read_b64_tr_b16 v[210:211], v228 offset:22528
v_mfma_f32_16x16x32_bf16 v[132:135], v[52:55], v[32:35], v[132:135]
ds_read_b64_tr_b16 v[212:213], v229 offset:20480
v_mfma_f32_16x16x32_bf16 v[128:131], v[80:83], v[64:67], v[128:131]
ds_read_b64_tr_b16 v[214:215], v229 offset:22528
v_mfma_f32_16x16x32_bf16 v[136:139], v[80:83], v[68:71], v[136:139]
ds_read_b128 v[196:199], v18 offset:25600
v_mfma_f32_16x16x32_bf16 v[144:147], v[80:83], v[72:75], v[144:147]
ds_read_b128 v[200:203], v18 offset:26624
v_mfma_f32_16x16x32_bf16 v[152:155], v[80:83], v[76:79], v[152:155]
ds_read_b128 v[204:207], v18 offset:27648
v_mfma_f32_16x16x32_bf16 v[156:159], v[84:87], v[76:79], v[156:159]
v_mfma_f32_16x16x32_bf16 v[148:151], v[84:87], v[72:75], v[148:151]
v_mfma_f32_16x16x32_bf16 v[140:143], v[84:87], v[68:71], v[140:143]
v_mfma_f32_16x16x32_bf16 v[132:135], v[84:87], v[64:67], v[132:135]
s_waitcnt lgkmcnt(0)
s_barrier
v_mfma_f32_16x16x32_bf16 v[128:131], v[112:115], v[96:99], v[128:131]
ds_read_b128 v[32:35], v18 offset:32768
ds_read_b64_tr_b16 v[48:49], v226 offset:49152
v_mfma_f32_16x16x32_bf16 v[136:139], v[112:115], v[100:103], v[136:139]
ds_read_b64_tr_b16 v[50:51], v226 offset:51200
ds_read_b64_tr_b16 v[52:53], v227 offset:49152
v_mfma_f32_16x16x32_bf16 v[144:147], v[112:115], v[104:107], v[144:147]
ds_read_b64_tr_b16 v[54:55], v227 offset:51200
ds_read_b128 v[36:39], v18 offset:33792
v_mfma_f32_16x16x32_bf16 v[152:155], v[112:115], v[108:111], v[152:155]
ds_read_b128 v[40:43], v18 offset:34816
ds_read_b128 v[44:47], v18 offset:35840
v_mfma_f32_16x16x32_bf16 v[156:159], v[116:119], v[108:111], v[156:159]
ds_read_b128 v[64:67], v18 offset:40960
v_mfma_f32_16x16x32_bf16 v[148:151], v[116:119], v[104:107], v[148:151]
ds_read_b64_tr_b16 v[80:81], v226 offset:53248
v_mfma_f32_16x16x32_bf16 v[140:143], v[116:119], v[100:103], v[140:143]
ds_read_b64_tr_b16 v[82:83], v226 offset:55296
v_mfma_f32_16x16x32_bf16 v[132:135], v[116:119], v[96:99], v[132:135]
ds_read_b64_tr_b16 v[84:85], v227 offset:53248
v_mfma_f32_16x16x32_bf16 v[128:131], v[208:211], v[192:195], v[128:131]
ds_read_b64_tr_b16 v[86:87], v227 offset:55296
v_mfma_f32_16x16x32_bf16 v[136:139], v[208:211], v[196:199], v[136:139]
ds_read_b128 v[68:71], v18 offset:41984
v_mfma_f32_16x16x32_bf16 v[144:147], v[208:211], v[200:203], v[144:147]
ds_read_b128 v[72:75], v18 offset:43008
v_mfma_f32_16x16x32_bf16 v[152:155], v[208:211], v[204:207], v[152:155]
ds_read_b128 v[76:79], v18 offset:44032
v_mfma_f32_16x16x32_bf16 v[156:159], v[212:215], v[204:207], v[156:159]
v_mfma_f32_16x16x32_bf16 v[148:151], v[212:215], v[200:203], v[148:151]
v_mfma_f32_16x16x32_bf16 v[140:143], v[212:215], v[196:199], v[140:143]
v_mfma_f32_16x16x32_bf16 v[132:135], v[212:215], v[192:195], v[132:135]
s_waitcnt lgkmcnt(0)
s_barrier
buffer_load_dwordx4 v[232:235], v2, s[84:87], s46 offen offset:0 sc1
buffer_load_dwordx4 v[236:239], v2, s[84:87], s46 offen offset:1024 sc1
buffer_load_dwordx4 v[240:243], v2, s[84:87], s46 offen offset:2048 sc1
buffer_load_dwordx4 v[244:247], v2, s[84:87], s46 offen offset:3072 sc1
v_mfma_f32_16x16x32_bf16 v[128:131], v[48:51], v[32:35], v[128:131]
ds_read_b128 v[96:99], v19 offset:0
ds_read_b64_tr_b16 v[112:113], v224 offset:0
v_mfma_f32_16x16x32_bf16 v[136:139], v[48:51], v[36:39], v[136:139]
ds_read_b64_tr_b16 v[114:115], v224 offset:2048
ds_read_b64_tr_b16 v[116:117], v225 offset:0
v_mfma_f32_16x16x32_bf16 v[144:147], v[48:51], v[40:43], v[144:147]
ds_read_b64_tr_b16 v[118:119], v225 offset:2048
ds_read_b128 v[100:103], v19 offset:1024
v_mfma_f32_16x16x32_bf16 v[152:155], v[48:51], v[44:47], v[152:155]
ds_read_b128 v[104:107], v19 offset:2048
ds_read_b128 v[108:111], v19 offset:3072
v_mfma_f32_16x16x32_bf16 v[156:159], v[52:55], v[44:47], v[156:159]
ds_read_b128 v[192:195], v19 offset:8192
v_mfma_f32_16x16x32_bf16 v[148:151], v[52:55], v[40:43], v[148:151]
ds_read_b64_tr_b16 v[208:209], v224 offset:4096
v_mfma_f32_16x16x32_bf16 v[140:143], v[52:55], v[36:39], v[140:143]
ds_read_b64_tr_b16 v[210:211], v224 offset:6144
v_mfma_f32_16x16x32_bf16 v[132:135], v[52:55], v[32:35], v[132:135]
ds_read_b64_tr_b16 v[212:213], v225 offset:4096
v_mfma_f32_16x16x32_bf16 v[128:131], v[80:83], v[64:67], v[128:131]
ds_read_b64_tr_b16 v[214:215], v225 offset:6144
v_mfma_f32_16x16x32_bf16 v[136:139], v[80:83], v[68:71], v[136:139]
ds_read_b128 v[196:199], v19 offset:9216
v_mfma_f32_16x16x32_bf16 v[144:147], v[80:83], v[72:75], v[144:147]
ds_read_b128 v[200:203], v19 offset:10240
v_mfma_f32_16x16x32_bf16 v[152:155], v[80:83], v[76:79], v[152:155]
ds_read_b128 v[204:207], v19 offset:11264
v_mfma_f32_16x16x32_bf16 v[156:159], v[84:87], v[76:79], v[156:159]
v_mfma_f32_16x16x32_bf16 v[148:151], v[84:87], v[72:75], v[148:151]
v_mfma_f32_16x16x32_bf16 v[140:143], v[84:87], v[68:71], v[140:143]
v_mfma_f32_16x16x32_bf16 v[132:135], v[84:87], v[64:67], v[132:135]
s_waitcnt lgkmcnt(0)
s_barrier
v_mfma_f32_16x16x32_bf16 v[128:131], v[112:115], v[96:99], v[128:131]
ds_read_b128 v[32:35], v17 offset:16384
ds_read_b64_tr_b16 v[48:49], v224 offset:32768
v_mfma_f32_16x16x32_bf16 v[136:139], v[112:115], v[100:103], v[136:139]
ds_read_b64_tr_b16 v[50:51], v224 offset:34816
ds_read_b64_tr_b16 v[52:53], v225 offset:32768
v_mfma_f32_16x16x32_bf16 v[144:147], v[112:115], v[104:107], v[144:147]
ds_read_b64_tr_b16 v[54:55], v225 offset:34816
ds_read_b128 v[36:39], v17 offset:17408
v_mfma_f32_16x16x32_bf16 v[152:155], v[112:115], v[108:111], v[152:155]
ds_read_b128 v[40:43], v17 offset:18432
ds_read_b128 v[44:47], v17 offset:19456
v_mfma_f32_16x16x32_bf16 v[156:159], v[116:119], v[108:111], v[156:159]
ds_read_b128 v[64:67], v17 offset:24576
v_mfma_f32_16x16x32_bf16 v[148:151], v[116:119], v[104:107], v[148:151]
ds_read_b64_tr_b16 v[80:81], v224 offset:36864
v_mfma_f32_16x16x32_bf16 v[140:143], v[116:119], v[100:103], v[140:143]
ds_read_b64_tr_b16 v[82:83], v224 offset:38912
v_mfma_f32_16x16x32_bf16 v[132:135], v[116:119], v[96:99], v[132:135]
ds_read_b64_tr_b16 v[84:85], v225 offset:36864
v_mfma_f32_16x16x32_bf16 v[128:131], v[208:211], v[192:195], v[128:131]
ds_read_b64_tr_b16 v[86:87], v225 offset:38912
v_mfma_f32_16x16x32_bf16 v[136:139], v[208:211], v[196:199], v[136:139]
ds_read_b128 v[68:71], v17 offset:25600
v_mfma_f32_16x16x32_bf16 v[144:147], v[208:211], v[200:203], v[144:147]
ds_read_b128 v[72:75], v17 offset:26624
v_mfma_f32_16x16x32_bf16 v[152:155], v[208:211], v[204:207], v[152:155]
ds_read_b128 v[76:79], v17 offset:27648
v_mfma_f32_16x16x32_bf16 v[156:159], v[212:215], v[204:207], v[156:159]
v_mfma_f32_16x16x32_bf16 v[148:151], v[212:215], v[200:203], v[148:151]
v_mfma_f32_16x16x32_bf16 v[140:143], v[212:215], v[196:199], v[140:143]
v_mfma_f32_16x16x32_bf16 v[132:135], v[212:215], v[192:195], v[132:135]
s_waitcnt lgkmcnt(0)
s_barrier
v_mfma_f32_16x16x32_bf16 v[128:131], v[48:51], v[32:35], v[128:131]
ds_read_b128 v[96:99], v17 offset:49152
ds_read_b64_tr_b16 v[112:113], v226 offset:0
v_mfma_f32_16x16x32_bf16 v[136:139], v[48:51], v[36:39], v[136:139]
ds_read_b64_tr_b16 v[114:115], v226 offset:2048
ds_read_b64_tr_b16 v[116:117], v227 offset:0
v_mfma_f32_16x16x32_bf16 v[144:147], v[48:51], v[40:43], v[144:147]
ds_read_b64_tr_b16 v[118:119], v227 offset:2048
ds_read_b128 v[100:103], v17 offset:50176
v_mfma_f32_16x16x32_bf16 v[152:155], v[48:51], v[44:47], v[152:155]
ds_read_b128 v[104:107], v17 offset:51200
ds_read_b128 v[108:111], v17 offset:52224
v_mfma_f32_16x16x32_bf16 v[156:159], v[52:55], v[44:47], v[156:159]
ds_read_b128 v[192:195], v17 offset:57344
v_mfma_f32_16x16x32_bf16 v[148:151], v[52:55], v[40:43], v[148:151]
ds_read_b64_tr_b16 v[208:209], v226 offset:4096
v_mfma_f32_16x16x32_bf16 v[140:143], v[52:55], v[36:39], v[140:143]
ds_read_b64_tr_b16 v[210:211], v226 offset:6144
v_mfma_f32_16x16x32_bf16 v[132:135], v[52:55], v[32:35], v[132:135]
ds_read_b64_tr_b16 v[212:213], v227 offset:4096
v_mfma_f32_16x16x32_bf16 v[128:131], v[80:83], v[64:67], v[128:131]
ds_read_b64_tr_b16 v[214:215], v227 offset:6144
v_mfma_f32_16x16x32_bf16 v[136:139], v[80:83], v[68:71], v[136:139]
ds_read_b128 v[196:199], v17 offset:58368
v_mfma_f32_16x16x32_bf16 v[144:147], v[80:83], v[72:75], v[144:147]
ds_read_b128 v[200:203], v17 offset:59392
v_mfma_f32_16x16x32_bf16 v[152:155], v[80:83], v[76:79], v[152:155]
ds_read_b128 v[204:207], v17 offset:60416
v_mfma_f32_16x16x32_bf16 v[156:159], v[84:87], v[76:79], v[156:159]
v_mfma_f32_16x16x32_bf16 v[148:151], v[84:87], v[72:75], v[148:151]
v_mfma_f32_16x16x32_bf16 v[140:143], v[84:87], v[68:71], v[140:143]
v_mfma_f32_16x16x32_bf16 v[132:135], v[84:87], v[64:67], v[132:135]
s_waitcnt vmcnt(0)
s_waitcnt lgkmcnt(0)
s_barrier
v_mfma_f32_16x16x32_bf16 v[128:131], v[112:115], v[96:99], v[128:131]
v_lshlrev_b32 v160, 16, v232
v_and_b32 v161, 0xffff0000, v232
v_lshlrev_b32 v162, 16, v233
v_and_b32 v163, 0xffff0000, v233
v_mfma_f32_16x16x32_bf16 v[132:135], v[116:119], v[96:99], v[132:135]
v_lshlrev_b32 v164, 16, v234
v_and_b32 v165, 0xffff0000, v234
v_lshlrev_b32 v166, 16, v235
v_and_b32 v167, 0xffff0000, v235
v_mfma_f32_16x16x32_bf16 v[128:131], v[208:211], v[192:195], v[128:131]
v_lshlrev_b32 v168, 16, v236
v_and_b32 v169, 0xffff0000, v236
v_lshlrev_b32 v170, 16, v237
v_and_b32 v171, 0xffff0000, v237
v_mfma_f32_16x16x32_bf16 v[132:135], v[212:215], v[192:195], v[132:135]
v_lshlrev_b32 v172, 16, v238
v_and_b32 v173, 0xffff0000, v238
v_lshlrev_b32 v174, 16, v239
v_and_b32 v175, 0xffff0000, v239
v_mfma_f32_16x16x32_bf16 v[136:139], v[112:115], v[100:103], v[136:139]
v_lshlrev_b32 v176, 16, v240
v_and_b32 v177, 0xffff0000, v240
v_lshlrev_b32 v178, 16, v241
v_and_b32 v179, 0xffff0000, v241
v_mfma_f32_16x16x32_bf16 v[140:143], v[116:119], v[100:103], v[140:143]
v_lshlrev_b32 v180, 16, v242
v_and_b32 v181, 0xffff0000, v242
v_lshlrev_b32 v182, 16, v243
v_and_b32 v183, 0xffff0000, v243
v_mfma_f32_16x16x32_bf16 v[136:139], v[208:211], v[196:199], v[136:139]
v_lshlrev_b32 v184, 16, v244
v_and_b32 v185, 0xffff0000, v244
v_lshlrev_b32 v186, 16, v245
v_and_b32 v187, 0xffff0000, v245
v_mfma_f32_16x16x32_bf16 v[140:143], v[212:215], v[196:199], v[140:143]
v_lshlrev_b32 v188, 16, v246
v_and_b32 v189, 0xffff0000, v246
v_lshlrev_b32 v190, 16, v247
v_and_b32 v191, 0xffff0000, v247
v_mfma_f32_16x16x32_bf16 v[144:147], v[112:115], v[104:107], v[144:147]
v_add_f32 v128, v128, v160
v_add_f32 v129, v129, v161
v_add_f32 v130, v130, v162
v_mfma_f32_16x16x32_bf16 v[148:151], v[116:119], v[104:107], v[148:151]
v_add_f32 v131, v131, v163
v_add_f32 v132, v132, v164
v_add_f32 v133, v133, v165
v_mfma_f32_16x16x32_bf16 v[144:147], v[208:211], v[200:203], v[144:147]
v_add_f32 v134, v134, v166
v_add_f32 v135, v135, v167
v_cvt_pk_bf16_f32 v232, v128, v129
v_mfma_f32_16x16x32_bf16 v[148:151], v[212:215], v[200:203], v[148:151]
v_cvt_pk_bf16_f32 v233, v130, v131
v_cvt_pk_bf16_f32 v234, v132, v133
v_cvt_pk_bf16_f32 v235, v134, v135
v_mfma_f32_16x16x32_bf16 v[152:155], v[112:115], v[108:111], v[152:155]
v_add_f32 v136, v136, v168
v_add_f32 v137, v137, v169
v_add_f32 v138, v138, v170
v_mfma_f32_16x16x32_bf16 v[156:159], v[116:119], v[108:111], v[156:159]
v_add_f32 v139, v139, v171
v_add_f32 v140, v140, v172
v_add_f32 v141, v141, v173
v_add_f32 v142, v142, v174
v_mfma_f32_16x16x32_bf16 v[152:155], v[208:211], v[204:207], v[152:155]
v_add_f32 v143, v143, v175
v_cvt_pk_bf16_f32 v236, v136, v137
v_cvt_pk_bf16_f32 v237, v138, v139
v_cvt_pk_bf16_f32 v238, v140, v141
v_mfma_f32_16x16x32_bf16 v[156:159], v[212:215], v[204:207], v[156:159]
v_cvt_pk_bf16_f32 v239, v142, v143
v_permlane16_swap_b32 v232, v234
v_permlane16_swap_b32 v233, v235
buffer_store_dwordx4 v[232:235], v230, s[20:23], s54 offen offset:0 nt
v_permlane16_swap_b32 v236, v238
v_permlane16_swap_b32 v237, v239
buffer_store_dwordx4 v[236:239], v230, s[20:23], s54 offen offset:2048 nt
v_add_f32 v144, v144, v176
v_add_f32 v145, v145, v177
v_add_f32 v146, v146, v178
v_add_f32 v147, v147, v179
v_add_f32 v148, v148, v180
v_add_f32 v149, v149, v181
v_add_f32 v150, v150, v182
v_add_f32 v151, v151, v183
v_cvt_pk_bf16_f32 v240, v144, v145
s_branch Lov_13
.p2align 12
.fill 96, 4, 0xbf800000
Lst_13_0:
s_branch Lwr_173
Lst_13_1:
s_branch Lst_17_0
s_nop 0
Lov_13:
v_cvt_pk_bf16_f32 v241, v146, v147
v_cvt_pk_bf16_f32 v242, v148, v149
v_cvt_pk_bf16_f32 v243, v150, v151
s_nop 0
v_add_f32 v152, v152, v184
v_add_f32 v153, v153, v185
v_add_f32 v154, v154, v186
v_add_f32 v155, v155, v187
v_add_f32 v156, v156, v188
v_add_f32 v157, v157, v189
v_add_f32 v158, v158, v190
v_add_f32 v159, v159, v191
v_cvt_pk_bf16_f32 v244, v152, v153
v_cvt_pk_bf16_f32 v245, v154, v155
v_cvt_pk_bf16_f32 v246, v156, v157
v_cvt_pk_bf16_f32 v247, v158, v159
v_permlane16_swap_b32 v240, v242
v_permlane16_swap_b32 v241, v243
buffer_store_dwordx4 v[240:243], v230, s[20:23], s55 offen offset:0 nt
v_permlane16_swap_b32 v244, v246
v_permlane16_swap_b32 v245, v247
buffer_store_dwordx4 v[244:247], v230, s[20:23], s55 offen offset:2048 nt
s_branch Ldone_1
Lgb_112:
s_mul_i32 s43, s34, 262144
s_add_u32 s8, s82, s43
s_addc_u32 s9, s83, 0
s_add_u32 s8, s8, 4194304
s_addc_u32 s9, s9, 0
s_mov_b32 s10, 262144
s_mov_b32 s11, 0x20000
s_lshl_b32 s39, s36, 12
v_lshlrev_b32 v2, 4, v1
v_add_u32 v3, s39, v2
s_add_u32 s37, s35, 0
s_and_b32 s37, s37, 15
s_mul_i32 s37, s37, 16384
s_add_u32 m0, s39, 0
s_nop 0
buffer_load_dwordx4 v3, s[8:11], s37 offen sc1 lds
buffer_load_dwordx4 v3, s[8:11], s37 offen offset:1024 sc1 lds
buffer_load_dwordx4 v3, s[8:11], s37 offen offset:2048 sc1 lds
buffer_load_dwordx4 v3, s[8:11], s37 offen offset:3072 sc1 lds
s_mul_i32 s43, s34, 262144
s_add_u32 s8, s82, s43
s_addc_u32 s9, s83, 0
s_add_u32 s8, s8, 4194304
s_addc_u32 s9, s9, 0
s_mov_b32 s10, 262144
s_mov_b32 s11, 0x20000
s_mul_i32 s43, s34, 917504
s_add_u32 s24, s82, s43
s_addc_u32 s25, s83, 0
s_add_u32 s24, s24, 8388608
s_addc_u32 s25, s25, 0
s_mov_b32 s26, 917504
s_mov_b32 s27, 0x20000
s_add_u32 s84, s82, 27262976
s_addc_u32 s85, s83, 0
s_mov_b32 s86, 229376
s_mov_b32 s87, 0x20000
s_and_b32 s47, s36, 3
s_lshr_b32 s62, s47, 1
s_and_b32 s63, s47, 1
v_lshlrev_b32 v2, 4, v1
s_lshl_b32 s39, s47, 12
v_add_u32 v3, s39, v2
s_bitcmp0_b32 s36, 1
s_cselect_b32 s44, s72, s74
s_cselect_b32 s45, s73, s75
s_mul_i32 s43, s35, 256
s_add_u32 s12, s44, s43
s_addc_u32 s13, s45, 0
s_mov_b32 s14, 7333120
s_mov_b32 s15, 0x20000
s_and_b32 s43, s36, 1
s_mul_i32 s43, s43, 229376
v_lshrrev_b32 v28, 4, v1
v_lshlrev_b32 v29, 1, v28
v_and_b32 v4, 15, v1
v_xor_b32 v4, v4, v29
v_lshlrev_b32 v4, 4, v4
v_mul_u32_u24 v28, 7168, v28
v_add_u32 v4, v4, v28
v_add_u32 v4, s43, v4
v_xor_b32 v5, 128, v4
v_add_u32 v5, 28672, v5
s_and_b32 s43, s36, 3
s_mul_i32 s40, s43, 8192
s_add_u32 s40, s40, 16384
v_mov_b32 v6, v192
v_mov_b32 v7, v193
v_mov_b32 v8, v194
s_lshl_b32 s43, s62, 12
v_add_u32 v9, s43, v2
v_add_u32 v10, 98304, v9
v_mov_b32 v24, v195
s_mul_i32 s43, s34, 16384
s_add_u32 s20, s82, s43
s_addc_u32 s21, s83, 0
s_add_u32 s20, s20, 25165824
s_addc_u32 s21, s21, 0
s_mov_b32 s22, 16384
s_mov_b32 s23, 0x20000
s_add_u32 s38, s35, 2
s_and_b32 s38, s38, 15
s_mul_i32 s38, s38, 458752
s_add_u32 m0, s50, 98304
s_nop 0
buffer_load_dwordx4 v6, s[16:19], s38 offen lds
s_add_u32 m0, s50, 99328
s_nop 0
buffer_load_dwordx4 v7, s[16:19], s38 offen lds
s_add_u32 m0, s50, 100352
s_nop 0
buffer_load_dwordx4 v8, s[16:19], s38 offen lds
s_add_u32 m0, s50, 101376
s_add_u32 s38, s38, 114688
buffer_load_dwordx4 v6, s[16:19], s38 offen lds
s_add_u32 m0, s50, 102400
s_nop 0
buffer_load_dwordx4 v7, s[16:19], s38 offen lds
s_add_u32 m0, s50, 103424
s_nop 0
buffer_load_dwordx4 v8, s[16:19], s38 offen lds
s_cmp_eq_u32 s47, 1
s_cbranch_scc0 Lw_137
s_lshl_b32 s92, s34, 4
s_add_u32 s92, s92, s35
s_lshl_b32 s92, s92, 8
s_add_u32 s92, s92, 49280
s_add_u32 s92, s92, 28311552
s_mov_b32 s41, 0x40000
Lpoll_138:
s_load_dword s93, s[82:83], s92 glc
Lpchk_140:
s_waitcnt lgkmcnt(0)
s_cmp_eq_u32 s93, 16
s_cbranch_scc1 Lpok_139
s_sub_u32 s41, s41, 1
s_cmp_lg_u32 s41, 0
s_cbranch_scc1 Lpoll_138
Lpok_139:
Lw_137:
s_waitcnt vmcnt(0)
s_barrier
s_add_u32 s37, s35, 1
s_and_b32 s37, s37, 15
s_mul_i32 s37, s37, 16384
s_add_u32 m0, s39, 49152
s_nop 0
buffer_load_dwordx4 v3, s[8:11], s37 offen sc1 lds
buffer_load_dwordx4 v3, s[8:11], s37 offen offset:1024 sc1 lds
buffer_load_dwordx4 v3, s[8:11], s37 offen offset:2048 sc1 lds
buffer_load_dwordx4 v3, s[8:11], s37 offen offset:3072 sc1 lds
s_add_u32 s37, s35, 2
s_and_b32 s37, s37, 15
s_mul_i32 s37, s37, 16384
s_add_u32 m0, s39, 98304
s_nop 0
buffer_load_dwordx4 v3, s[8:11], s37 offen sc1 lds
buffer_load_dwordx4 v3, s[8:11], s37 offen offset:1024 sc1 lds
buffer_load_dwordx4 v3, s[8:11], s37 offen offset:2048 sc1 lds
buffer_load_dwordx4 v3, s[8:11], s37 offen offset:3072 sc1 lds
buffer_load_dwordx4 v[96:99], v3, s[20:23], 0 offen offset:0 sc1
buffer_load_dwordx4 v[100:103], v3, s[20:23], 0 offen offset:1024 sc1
buffer_load_dwordx4 v[104:107], v3, s[20:23], 0 offen offset:2048 sc1
buffer_load_dwordx4 v[108:111], v3, s[20:23], 0 offen offset:3072 sc1
s_and_b32 s44, s36, 3
s_mul_i32 s44, s44, 11
s_bfe_u32 s43, s2, 0x30001
s_lshl_b32 s43, s43, 7
s_add_u32 s44, s44, s43
s_add_u32 s44, s44, 84
s_mul_i32 s44, s44, 7168
s_lshr_b32 s43, s2, 4
s_lshl_b32 s43, s43, 8
s_add_u32 s43, s43, s44
s_bitcmp0_b32 s2, 0
s_cselect_b32 s4, s72, s74
s_cselect_b32 s5, s73, s75
s_add_u32 s4, s4, s43
s_addc_u32 s5, s5, 0
s_waitcnt vmcnt(8)
s_barrier
s_cmp_eq_u32 s47, 3
s_cbranch_scc0 Lw_141
v_and_b32 v90, 31, v1
v_lshlrev_b32 v90, 4, v90
v_add_u32 v91, 151552, v90
ds_read_b128 v[112:115], v91 offset:0
ds_read_b128 v[116:119], v91 offset:512
ds_read_b128 v[120:123], v91 offset:1024
ds_read_b128 v[124:127], v91 offset:1536
s_and_b32 s44, s2, 15
s_mul_i32 s44, s44, 14336
s_lshr_b32 s43, s2, 4
s_lshl_b32 s43, s43, 9
s_add_u32 s44, s44, s43
s_add_u32 s44, s44, 8192
s_cmp_lt_u32 s2, 192
s_cselect_b32 s44, s44, 0x7fffffff
s_waitcnt lgkmcnt(0)
v_add_f32 v112, v112, v116
v_add_f32 v120, v120, v124
v_add_f32 v113, v113, v117
v_add_f32 v121, v121, v125
v_add_f32 v114, v114, v118
v_add_f32 v122, v122, v126
v_add_f32 v115, v115, v119
v_add_f32 v123, v123, v127
v_add_f32 v112, v112, v120
v_add_f32 v113, v113, v121
v_add_f32 v114, v114, v122
v_add_f32 v115, v115, v123
s_mov_b64 exec, 0xffffffff
buffer_store_dwordx4 v[112:115], v90, s[84:87], s44 offen sc1
s_mov_b64 exec, -1
Lw_141:
s_add_u32 s37, s35, 3
s_and_b32 s37, s37, 15
s_mul_i32 s37, s37, 16384
s_add_u32 m0, s39, 0
s_nop 0
buffer_load_dwordx4 v3, s[8:11], s37 offen sc1 lds
s_load_dword s3, s[4:5], 0
buffer_load_dwordx4 v3, s[8:11], s37 offen offset:1024 sc1 lds
s_load_dword s3, s[4:5], 64
buffer_load_dwordx4 v3, s[8:11], s37 offen offset:2048 sc1 lds
s_load_dword s3, s[4:5], 128
buffer_load_dwordx4 v3, s[8:11], s37 offen offset:3072 sc1 lds
s_load_dword s3, s[4:5], 192
s_load_dword s3, s[4:5], 7168
s_add_u32 s38, s35, 3
s_and_b32 s38, s38, 15
s_mul_i32 s38, s38, 458752
s_add_u32 m0, s50, 0
s_nop 0
buffer_load_dwordx4 v6, s[16:19], s38 offen lds
s_load_dword s3, s[4:5], 7232
s_add_u32 m0, s50, 1024
s_nop 0
buffer_load_dwordx4 v7, s[16:19], s38 offen lds
s_load_dword s3, s[4:5], 7296
s_add_u32 m0, s50, 2048
s_nop 0
buffer_load_dwordx4 v8, s[16:19], s38 offen lds
s_load_dword s3, s[4:5], 7360
s_add_u32 m0, s50, 3072
s_add_u32 s38, s38, 114688
buffer_load_dwordx4 v6, s[16:19], s38 offen lds
s_load_dword s3, s[4:5], 14336
s_load_dword s3, s[4:5], 14400
s_add_u32 m0, s50, 4096
s_nop 0
buffer_load_dwordx4 v7, s[16:19], s38 offen lds
s_add_u32 m0, s50, 5120
s_nop 0
buffer_load_dwordx4 v8, s[16:19], s38 offen lds
s_waitcnt vmcnt(14)
s_barrier
s_add_u32 s37, s35, 4
s_and_b32 s37, s37, 15
s_mul_i32 s37, s37, 16384
s_add_u32 m0, s39, 49152
s_nop 0
buffer_load_dwordx4 v3, s[8:11], s37 offen sc1 lds
s_load_dword s3, s[4:5], 14464
buffer_load_dwordx4 v3, s[8:11], s37 offen offset:1024 sc1 lds
s_load_dword s3, s[4:5], 14528
buffer_load_dwordx4 v3, s[8:11], s37 offen offset:2048 sc1 lds
s_load_dword s3, s[4:5], 21504
buffer_load_dwordx4 v3, s[8:11], s37 offen offset:3072 sc1 lds
s_load_dword s3, s[4:5], 21568
s_load_dword s3, s[4:5], 21632
s_add_u32 s38, s35, 4
s_and_b32 s38, s38, 15
s_mul_i32 s38, s38, 458752
s_add_u32 m0, s50, 49152
s_nop 0
buffer_load_dwordx4 v6, s[16:19], s38 offen lds
s_load_dword s3, s[4:5], 21696
s_add_u32 m0, s50, 50176
s_nop 0
buffer_load_dwordx4 v7, s[16:19], s38 offen lds
s_load_dword s3, s[4:5], 28672
s_add_u32 m0, s50, 51200
s_nop 0
buffer_load_dwordx4 v8, s[16:19], s38 offen lds
s_load_dword s3, s[4:5], 28736
s_add_u32 m0, s50, 52224
s_add_u32 s38, s38, 114688
buffer_load_dwordx4 v6, s[16:19], s38 offen lds
s_load_dword s3, s[4:5], 28800
s_load_dword s3, s[4:5], 28864
s_add_u32 m0, s50, 53248
s_nop 0
buffer_load_dwordx4 v7, s[16:19], s38 offen lds
s_add_u32 m0, s50, 54272
s_nop 0
buffer_load_dwordx4 v8, s[16:19], s38 offen lds
s_waitcnt vmcnt(10)
s_barrier
s_cmp_eq_u32 s47, 3
s_cbranch_scc0 Lw_142
s_cmp_lt_u32 s2, 192
s_cbranch_scc0 Lw_142
s_lshr_b32 s43, s2, 4
s_add_u32 s43, s43, 96
s_lshl_b32 s43, s43, 7
v_mov_b32 v90, s43
v_mov_b32 v91, 1
s_mov_b64 exec, 1
buffer_atomic_add v91, v90, s[56:59], 0 offen sc1
s_mov_b64 exec, -1
Lw_142:
s_add_u32 s37, s35, 5
s_and_b32 s37, s37, 15
s_mul_i32 s37, s37, 16384
s_add_u32 m0, s39, 98304
s_nop 0
buffer_load_dwordx4 v3, s[8:11], s37 offen sc1 lds
v_add_f32 v96, v96, v100
v_add_f32 v97, v97, v101
v_add_f32 v98, v98, v102
buffer_load_dwordx4 v3, s[8:11], s37 offen offset:1024 sc1 lds
v_add_f32 v99, v99, v103
v_add_f32 v104, v104, v108
v_add_f32 v105, v105, v109
buffer_load_dwordx4 v3, s[8:11], s37 offen offset:2048 sc1 lds
v_add_f32 v106, v106, v110
v_add_f32 v107, v107, v111
s_nop 0
buffer_load_dwordx4 v3, s[8:11], s37 offen offset:3072 sc1 lds
v_permlane32_swap_b32 v96, v104
v_permlane32_swap_b32 v97, v105
v_permlane32_swap_b32 v98, v106
v_permlane32_swap_b32 v99, v107
s_add_u32 s38, s35, 5
s_and_b32 s38, s38, 15
s_mul_i32 s38, s38, 458752
s_add_u32 m0, s50, 98304
s_nop 0
buffer_load_dwordx4 v6, s[16:19], s38 offen lds
v_add_f32 v96, v96, v104
v_add_f32 v97, v97, v105
v_add_f32 v98, v98, v106
s_add_u32 m0, s50, 99328
s_nop 0
buffer_load_dwordx4 v7, s[16:19], s38 offen lds
v_add_f32 v99, v99, v107
v_mov_b32 v100, v96
v_mov_b32 v101, v97
s_add_u32 m0, s50, 100352
s_nop 0
buffer_load_dwordx4 v8, s[16:19], s38 offen lds
v_mov_b32 v102, v98
v_mov_b32 v103, v99
s_nop 0
s_add_u32 m0, s50, 101376
s_add_u32 s38, s38, 114688
buffer_load_dwordx4 v6, s[16:19], s38 offen lds
v_permlane16_swap_b32 v96, v100
v_permlane16_swap_b32 v97, v101
v_permlane16_swap_b32 v98, v102
v_permlane16_swap_b32 v99, v103
s_add_u32 m0, s50, 102400
s_nop 0
buffer_load_dwordx4 v7, s[16:19], s38 offen lds
s_add_u32 m0, s50, 103424
s_nop 0
buffer_load_dwordx4 v8, s[16:19], s38 offen lds
s_waitcnt vmcnt(10)
s_barrier
s_add_u32 s37, s35, 6
s_and_b32 s37, s37, 15
s_mul_i32 s37, s37, 16384
s_add_u32 m0, s39, 0
s_nop 0
buffer_load_dwordx4 v3, s[8:11], s37 offen sc1 lds
v_add_f32 v96, v96, v100
v_add_f32 v97, v97, v101
v_add_f32 v98, v98, v102
buffer_load_dwordx4 v3, s[8:11], s37 offen offset:1024 sc1 lds
v_add_f32 v99, v99, v103
s_nop 0
v_add_f32_dpp v96, v96, v96 row_ror:8 row_mask:0xf bank_mask:0xf
buffer_load_dwordx4 v3, s[8:11], s37 offen offset:2048 sc1 lds
v_add_f32_dpp v97, v97, v97 row_ror:8 row_mask:0xf bank_mask:0xf
v_add_f32_dpp v98, v98, v98 row_ror:8 row_mask:0xf bank_mask:0xf
v_add_f32_dpp v99, v99, v99 row_ror:8 row_mask:0xf bank_mask:0xf
v_mul_f32 v96, 0x3a800000, v96
buffer_load_dwordx4 v3, s[8:11], s37 offen offset:3072 sc1 lds
v_mul_f32 v97, 0x3a800000, v97
v_mul_f32 v98, 0x3a800000, v98
v_mul_f32 v99, 0x3a800000, v99
s_add_u32 s38, s35, 6
s_and_b32 s38, s38, 15
s_mul_i32 s38, s38, 458752
s_add_u32 m0, s50, 0
s_nop 0
buffer_load_dwordx4 v6, s[16:19], s38 offen lds
v_fma_f32 v97, -v96, v96, v97
v_fma_f32 v99, -v98, v98, v99
v_max_f32 v97, 0, v97
s_add_u32 m0, s50, 1024
s_nop 0
buffer_load_dwordx4 v7, s[16:19], s38 offen lds
v_max_f32 v99, 0, v99
v_add_f32 v97, 0x3727c5ac, v97
v_add_f32 v99, 0x3727c5ac, v99
v_rsq_f32 v97, v97
s_add_u32 m0, s50, 2048
s_nop 0
buffer_load_dwordx4 v8, s[16:19], s38 offen lds
v_rsq_f32 v99, v99
v_and_b32 v100, 7, v1
s_lshl_b32 s43, s47, 8
s_add_u32 m0, s50, 3072
s_add_u32 s38, s38, 114688
buffer_load_dwordx4 v6, s[16:19], s38 offen lds
s_add_u32 s43, s43, 147456
v_lshl_add_u32 v100, v100, 4, s43
v_lshrrev_b32 v101, 5, v1
v_lshl_add_u32 v100, v101, 7, v100
s_add_u32 m0, s50, 4096
s_nop 0
buffer_load_dwordx4 v7, s[16:19], s38 offen lds
s_add_u32 m0, s50, 5120
s_nop 0
buffer_load_dwordx4 v8, s[16:19], s38 offen lds
s_waitcnt vmcnt(10)
s_barrier
ds_write_b128 v100, v[96:99]
s_waitcnt lgkmcnt(0)
s_add_u32 s37, s35, 7
s_and_b32 s37, s37, 15
s_mul_i32 s37, s37, 16384
s_add_u32 m0, s39, 49152
s_nop 0
buffer_load_dwordx4 v3, s[8:11], s37 offen sc1 lds
s_load_dword s3, s[4:5], 35840
buffer_load_dwordx4 v3, s[8:11], s37 offen offset:1024 sc1 lds
s_load_dword s3, s[4:5], 35904
buffer_load_dwordx4 v3, s[8:11], s37 offen offset:2048 sc1 lds
s_load_dword s3, s[4:5], 35968
s_load_dword s3, s[4:5], 36032
buffer_load_dwordx4 v3, s[8:11], s37 offen offset:3072 sc1 lds
s_load_dword s3, s[4:5], 43008
s_add_u32 s38, s35, 7
s_and_b32 s38, s38, 15
s_mul_i32 s38, s38, 458752
s_add_u32 m0, s50, 49152
s_nop 0
buffer_load_dwordx4 v6, s[16:19], s38 offen lds
s_load_dword s3, s[4:5], 43072
s_add_u32 m0, s50, 50176
s_nop 0
buffer_load_dwordx4 v7, s[16:19], s38 offen lds
s_load_dword s3, s[4:5], 43136
s_load_dword s3, s[4:5], 43200
s_add_u32 m0, s50, 51200
s_nop 0
buffer_load_dwordx4 v8, s[16:19], s38 offen lds
s_load_dword s3, s[4:5], 50176
s_add_u32 m0, s50, 52224
s_add_u32 s38, s38, 114688
buffer_load_dwordx4 v6, s[16:19], s38 offen lds
s_load_dword s3, s[4:5], 50240
s_load_dword s3, s[4:5], 50304
s_add_u32 m0, s50, 53248
s_nop 0
buffer_load_dwordx4 v7, s[16:19], s38 offen lds
s_add_u32 m0, s50, 54272
s_nop 0
buffer_load_dwordx4 v8, s[16:19], s38 offen lds
s_waitcnt vmcnt(10)
s_barrier
s_add_u32 s37, s35, 8
s_and_b32 s37, s37, 15
s_mul_i32 s37, s37, 16384
s_add_u32 m0, s39, 98304
s_nop 0
buffer_load_dwordx4 v3, s[8:11], s37 offen sc1 lds
s_load_dword s3, s[4:5], 50368
s_load_dword s3, s[4:5], 57344
s_load_dword s3, s[4:5], 57408
buffer_load_dwordx4 v3, s[8:11], s37 offen offset:1024 sc1 lds
s_load_dword s3, s[4:5], 57472
s_load_dword s3, s[4:5], 57536
s_load_dword s3, s[4:5], 64512
s_load_dword s3, s[4:5], 64576
buffer_load_dwordx4 v3, s[8:11], s37 offen offset:2048 sc1 lds
s_load_dword s3, s[4:5], 64640
s_load_dword s3, s[4:5], 64704
s_load_dword s3, s[4:5], 71680
s_load_dword s3, s[4:5], 71744
buffer_load_dwordx4 v3, s[8:11], s37 offen offset:3072 sc1 lds
v_lshrrev_b32 v28, 2, v1
v_and_b32 v29, 7, v28
v_mul_u32_u24 v28, 256, v28
v_lshl_add_u32 v28, v29, 5, v28
s_add_u32 s38, s35, 8
s_and_b32 s38, s38, 15
s_mul_i32 s38, s38, 458752
s_add_u32 m0, s50, 98304
s_nop 0
buffer_load_dwordx4 v6, s[16:19], s38 offen lds
v_and_b32 v29, 3, v1
v_lshl_add_u32 v11, v29, 3, v28
s_lshl_b32 s43, s63, 7
v_xor_b32 v11, s43, v11
s_add_u32 m0, s50, 99328
s_nop 0
buffer_load_dwordx4 v7, s[16:19], s38 offen lds
v_add_u32 v11, 16384, v11
v_xor_b32 v12, 32, v11
v_xor_b32 v13, 64, v11
v_xor_b32 v14, 96, v11
s_add_u32 m0, s50, 100352
s_nop 0
buffer_load_dwordx4 v8, s[16:19], s38 offen lds
v_add_u32 v15, 49152, v11
v_add_u32 v16, 49152, v12
v_add_u32 v17, 49152, v13
v_add_u32 v18, 49152, v14
s_add_u32 m0, s50, 101376
s_add_u32 s38, s38, 114688
buffer_load_dwordx4 v6, s[16:19], s38 offen lds
v_add_u32 v19, 98304, v11
v_add_u32 v20, 98304, v12
v_add_u32 v21, 98304, v13
v_add_u32 v22, 98304, v14
s_add_u32 m0, s50, 102400
s_nop 0
buffer_load_dwordx4 v7, s[16:19], s38 offen lds
s_add_u32 m0, s50, 103424
s_nop 0
buffer_load_dwordx4 v8, s[16:19], s38 offen lds
s_waitcnt vmcnt(10)
s_barrier
s_cmp_eq_u32 s47, 3
s_cbranch_scc0 Lw_143
s_mul_i32 s60, s35, 96
s_add_u32 s61, s60, 95
s_and_b32 s60, s60, 0xff80
s_and_b32 s61, s61, 0xff80
s_add_u32 s60, s60, 28323840
s_add_u32 s61, s61, 28323840
s_load_dword s92, s[82:83], s60 glc
s_load_dword s93, s[82:83], s61 glc
Lw_143:
s_add_u32 s37, s35, 9
s_and_b32 s37, s37, 15
s_mul_i32 s37, s37, 16384
s_add_u32 m0, s39, 0
s_nop 0
buffer_load_dwordx4 v3, s[8:11], s37 offen sc1 lds
buffer_load_dwordx4 v3, s[8:11], s37 offen offset:1024 sc1 lds
buffer_load_dwordx4 v3, s[8:11], s37 offen offset:2048 sc1 lds
buffer_load_dwordx4 v3, s[8:11], s37 offen offset:3072 sc1 lds
s_add_u32 s38, s35, 9
s_and_b32 s38, s38, 15
s_mul_i32 s38, s38, 458752
s_add_u32 m0, s50, 0
s_nop 0
buffer_load_dwordx4 v6, s[16:19], s38 offen lds
s_add_u32 m0, s50, 1024
s_nop 0
buffer_load_dwordx4 v7, s[16:19], s38 offen lds
s_add_u32 m0, s50, 2048
s_nop 0
buffer_load_dwordx4 v8, s[16:19], s38 offen lds
s_add_u32 m0, s50, 3072
s_add_u32 s38, s38, 114688
buffer_load_dwordx4 v6, s[16:19], s38 offen lds
s_add_u32 m0, s50, 4096
s_nop 0
buffer_load_dwordx4 v7, s[16:19], s38 offen lds
s_add_u32 m0, s50, 5120
s_nop 0
buffer_load_dwordx4 v8, s[16:19], s38 offen lds
s_waitcnt vmcnt(10)
s_barrier
s_add_u32 s37, s35, 10
s_and_b32 s37, s37, 15
s_mul_i32 s37, s37, 16384
s_add_u32 m0, s39, 49152
s_nop 0
buffer_load_dwordx4 v3, s[8:11], s37 offen sc1 lds
buffer_load_dwordx4 v3, s[8:11], s37 offen offset:1024 sc1 lds
buffer_load_dwordx4 v3, s[8:11], s37 offen offset:2048 sc1 lds
buffer_load_dwordx4 v3, s[8:11], s37 offen offset:3072 sc1 lds
s_add_u32 s38, s35, 10
s_and_b32 s38, s38, 15
s_mul_i32 s38, s38, 458752
s_add_u32 m0, s50, 49152
s_nop 0
buffer_load_dwordx4 v6, s[16:19], s38 offen lds
s_add_u32 m0, s50, 50176
s_nop 0
buffer_load_dwordx4 v7, s[16:19], s38 offen lds
s_add_u32 m0, s50, 51200
s_nop 0
buffer_load_dwordx4 v8, s[16:19], s38 offen lds
s_add_u32 m0, s50, 52224
s_add_u32 s38, s38, 114688
buffer_load_dwordx4 v6, s[16:19], s38 offen lds
s_branch Lov_14
.p2align 12
.fill 112, 4, 0xbf800000
Lst_14_0:
s_branch Lwr_174
Lst_14_1:
s_branch Lst_18_0
s_nop 0
Lov_14:
s_add_u32 m0, s50, 53248
s_nop 0
buffer_load_dwordx4 v7, s[16:19], s38 offen lds
s_add_u32 m0, s50, 54272
s_nop 0
buffer_load_dwordx4 v8, s[16:19], s38 offen lds
s_mov_b32 s38, 0
buffer_load_dwordx4 v[40:43], v24, s[88:91], s38 offen
s_mov_b32 s38, 28672
buffer_load_dwordx4 v[44:47], v24, s[88:91], s38 offen
s_mov_b32 s38, 57344
buffer_load_dwordx4 v[48:51], v24, s[88:91], s38 offen
s_mov_b32 s38, 86016
buffer_load_dwordx4 v[52:55], v24, s[88:91], s38 offen
s_mov_b32 s38, 114688
buffer_load_dwordx4 v[56:59], v24, s[88:91], s38 offen
s_mov_b32 s38, 143360
buffer_load_dwordx4 v[60:63], v24, s[88:91], s38 offen
s_mov_b32 s38, 172032
buffer_load_dwordx4 v[64:67], v24, s[88:91], s38 offen
s_mov_b32 s38, 200704
buffer_load_dwordx4 v[68:71], v24, s[88:91], s38 offen
s_waitcnt vmcnt(18)
s_cmp_eq_u32 s47, 3
s_cbranch_scc0 Lw_144
s_mov_b32 s41, 0x40000
Lcp_145:
s_waitcnt lgkmcnt(0)
s_and_b32 s92, s92, s93
s_cmp_eq_u32 s92, 16
s_cbranch_scc1 Lco_146
s_load_dword s92, s[82:83], s60 glc
s_load_dword s93, s[82:83], s61 glc
s_sub_u32 s41, s41, 1
s_cmp_lg_u32 s41, 0
s_cbranch_scc1 Lcp_145
s_waitcnt lgkmcnt(0)
Lco_146:
Lw_144:
s_barrier
s_mov_b32 s45, s47
s_cmp_ge_u32 s45, 3
s_cselect_b32 s43, 1, 0
s_mul_i32 s44, s43, 3
s_sub_u32 s45, s45, s44
s_lshl_b32 s45, s45, 7
s_mul_i32 s52, s43, 896
s_add_u32 s52, s52, s45
s_add_u32 s52, s52, 148992
s_mul_i32 s43, s43, 14336
s_add_u32 s43, s43, s45
s_mul_i32 s44, s35, 384
s_add_u32 s43, s43, s44
s_add_u32 s60, s43, 8192
s_add_u32 s45, s47, 4
s_min_u32 s45, s45, 5
s_cmp_ge_u32 s45, 3
s_cselect_b32 s43, 1, 0
s_mul_i32 s44, s43, 3
s_sub_u32 s45, s45, s44
s_lshl_b32 s45, s45, 7
s_mul_i32 s53, s43, 896
s_add_u32 s53, s53, s45
s_add_u32 s53, s53, 148992
s_mul_i32 s43, s43, 14336
s_add_u32 s43, s43, s45
s_mul_i32 s44, s35, 384
s_add_u32 s43, s43, s44
s_add_u32 s61, s43, 8192
v_lshrrev_b32 v104, 3, v1
v_mul_u32_u24 v104, 28672, v104
v_and_b32 v105, 7, v1
v_lshl_add_u32 v104, v105, 4, v104
buffer_load_dwordx4 v[96:99], v104, s[84:87], s60 offen sc1
s_load_dword s3, s[4:5], 71808
s_load_dword s3, s[4:5], 71872
buffer_load_dwordx4 v[100:103], v104, s[84:87], s61 offen sc1
s_and_b32 s44, s36, 3
s_mul_i32 s43, s2, 28672
s_add_u32 s37, s35, 11
s_and_b32 s37, s37, 15
s_mul_i32 s37, s37, 16384
s_add_u32 m0, s39, 98304
s_nop 0
buffer_load_dwordx4 v3, s[8:11], s37 offen sc1 lds
s_mul_i32 s44, s44, 7168
s_add_u32 s43, s43, s44
buffer_load_dwordx4 v3, s[8:11], s37 offen offset:1024 sc1 lds
s_add_u32 s4, s76, s43
s_addc_u32 s5, s77, 0
s_load_dword s3, s[4:5], 0
buffer_load_dwordx4 v3, s[8:11], s37 offen offset:2048 sc1 lds
s_load_dword s3, s[4:5], 64
s_load_dword s3, s[4:5], 128
buffer_load_dwordx4 v3, s[8:11], s37 offen offset:3072 sc1 lds
s_load_dword s3, s[4:5], 192
s_load_dword s3, s[4:5], 256
s_add_u32 s38, s35, 11
s_and_b32 s38, s38, 15
s_mul_i32 s38, s38, 458752
s_add_u32 m0, s50, 98304
s_nop 0
buffer_load_dwordx4 v6, s[16:19], s38 offen lds
s_load_dword s3, s[4:5], 320
s_load_dword s3, s[4:5], 384
s_load_dword s3, s[4:5], 448
s_add_u32 m0, s50, 99328
s_nop 0
buffer_load_dwordx4 v7, s[16:19], s38 offen lds
v_cmp_gt_u32 vcc, 32, v1
v_mov_b32 v104, s52
s_add_u32 m0, s50, 100352
s_nop 0
buffer_load_dwordx4 v8, s[16:19], s38 offen lds
v_mov_b32 v106, s53
v_cndmask_b32 v104, v106, v104, vcc
s_add_u32 m0, s50, 101376
s_add_u32 s38, s38, 114688
buffer_load_dwordx4 v6, s[16:19], s38 offen lds
v_lshl_add_u32 v104, v105, 4, v104
v_bfe_u32 v105, v1, 4, 1
v_lshl_add_u32 v104, v105, 2, v104
s_add_u32 m0, s50, 102400
s_nop 0
buffer_load_dwordx4 v7, s[16:19], s38 offen lds
s_add_u32 m0, s50, 103424
s_nop 0
buffer_load_dwordx4 v8, s[16:19], s38 offen lds
s_waitcnt vmcnt(20)
s_barrier
s_add_u32 s37, s35, 12
s_and_b32 s37, s37, 15
s_mul_i32 s37, s37, 16384
s_add_u32 m0, s39, 0
s_nop 0
buffer_load_dwordx4 v3, s[8:11], s37 offen sc1 lds
buffer_load_dwordx4 v3, s[8:11], s37 offen offset:1024 sc1 lds
buffer_load_dwordx4 v3, s[8:11], s37 offen offset:2048 sc1 lds
buffer_load_dwordx4 v3, s[8:11], s37 offen offset:3072 sc1 lds
s_add_u32 s38, s35, 12
s_and_b32 s38, s38, 15
s_mul_i32 s38, s38, 458752
s_add_u32 m0, s50, 0
s_nop 0
buffer_load_dwordx4 v6, s[16:19], s38 offen lds
s_add_u32 m0, s50, 1024
s_nop 0
buffer_load_dwordx4 v7, s[16:19], s38 offen lds
s_add_u32 m0, s50, 2048
s_nop 0
buffer_load_dwordx4 v8, s[16:19], s38 offen lds
s_add_u32 m0, s50, 3072
s_add_u32 s38, s38, 114688
buffer_load_dwordx4 v6, s[16:19], s38 offen lds
s_add_u32 m0, s50, 4096
s_nop 0
buffer_load_dwordx4 v7, s[16:19], s38 offen lds
s_add_u32 m0, s50, 5120
s_nop 0
buffer_load_dwordx4 v8, s[16:19], s38 offen lds
s_waitcnt vmcnt(10)
s_barrier
v_permlane32_swap_b32 v96, v100
v_permlane32_swap_b32 v97, v101
v_permlane32_swap_b32 v98, v102
v_permlane32_swap_b32 v99, v103
v_add_f32 v96, v96, v100
v_add_f32 v97, v97, v101
v_add_f32 v98, v98, v102
v_add_f32 v99, v99, v103
s_nop 1
v_permlane16_swap_b32 v96, v97
v_permlane16_swap_b32 v98, v99
v_add_f32 v96, v96, v97
v_add_f32 v98, v98, v99
s_nop 1
v_add_f32_dpp v96, v96, v96 row_ror:8 row_mask:0xf bank_mask:0xf
v_add_f32_dpp v98, v98, v98 row_ror:8 row_mask:0xf bank_mask:0xf
ds_write_b32 v104, v96
ds_write_b32 v104, v98 offset:8
s_waitcnt lgkmcnt(0)
s_add_u32 s37, s35, 13
s_and_b32 s37, s37, 15
s_mul_i32 s37, s37, 16384
s_add_u32 m0, s39, 49152
s_nop 0
buffer_load_dwordx4 v3, s[8:11], s37 offen sc1 lds
s_load_dword s3, s[4:5], 512
s_load_dword s3, s[4:5], 576
s_load_dword s3, s[4:5], 640
s_load_dword s3, s[4:5], 704
s_load_dword s3, s[4:5], 768
buffer_load_dwordx4 v3, s[8:11], s37 offen offset:1024 sc1 lds
s_load_dword s3, s[4:5], 832
s_load_dword s3, s[4:5], 896
s_load_dword s3, s[4:5], 960
s_load_dword s3, s[4:5], 1024
s_load_dword s3, s[4:5], 1088
buffer_load_dwordx4 v3, s[8:11], s37 offen offset:2048 sc1 lds
v_lshlrev_b32 v72, 16, v40
v_and_b32 v73, 0xffff0000, v40
v_lshlrev_b32 v74, 16, v41
v_and_b32 v75, 0xffff0000, v41
v_lshlrev_b32 v76, 16, v42
v_and_b32 v77, 0xffff0000, v42
buffer_load_dwordx4 v3, s[8:11], s37 offen offset:3072 sc1 lds
v_lshlrev_b32 v78, 16, v43
v_and_b32 v79, 0xffff0000, v43
v_lshlrev_b32 v80, 16, v44
v_and_b32 v81, 0xffff0000, v44
v_lshlrev_b32 v82, 16, v45
s_add_u32 s38, s35, 13
s_and_b32 s38, s38, 15
s_mul_i32 s38, s38, 458752
s_add_u32 m0, s50, 49152
s_nop 0
buffer_load_dwordx4 v6, s[16:19], s38 offen lds
v_and_b32 v83, 0xffff0000, v45
v_lshlrev_b32 v84, 16, v46
v_and_b32 v85, 0xffff0000, v46
v_lshlrev_b32 v86, 16, v47
v_and_b32 v87, 0xffff0000, v47
s_add_u32 m0, s50, 50176
s_nop 0
buffer_load_dwordx4 v7, s[16:19], s38 offen lds
v_add_f32 v72, v72, v80
v_add_f32 v73, v73, v81
v_add_f32 v74, v74, v82
v_add_f32 v75, v75, v83
v_add_f32 v76, v76, v84
v_add_f32 v77, v77, v85
s_add_u32 m0, s50, 51200
s_nop 0
buffer_load_dwordx4 v8, s[16:19], s38 offen lds
v_add_f32 v78, v78, v86
v_add_f32 v79, v79, v87
v_lshlrev_b32 v80, 16, v48
v_and_b32 v81, 0xffff0000, v48
v_lshlrev_b32 v82, 16, v49
s_add_u32 m0, s50, 52224
s_add_u32 s38, s38, 114688
buffer_load_dwordx4 v6, s[16:19], s38 offen lds
v_and_b32 v83, 0xffff0000, v49
v_lshlrev_b32 v84, 16, v50
v_and_b32 v85, 0xffff0000, v50
v_lshlrev_b32 v86, 16, v51
v_and_b32 v87, 0xffff0000, v51
v_add_f32 v72, v72, v80
s_add_u32 m0, s50, 53248
s_nop 0
buffer_load_dwordx4 v7, s[16:19], s38 offen lds
s_add_u32 m0, s50, 54272
s_nop 0
buffer_load_dwordx4 v8, s[16:19], s38 offen lds
s_waitcnt vmcnt(10)
s_barrier
s_add_u32 s37, s35, 14
s_and_b32 s37, s37, 15
s_mul_i32 s37, s37, 16384
s_add_u32 m0, s39, 98304
s_nop 0
buffer_load_dwordx4 v3, s[8:11], s37 offen sc1 lds
s_load_dword s3, s[4:5], 1152
s_load_dword s3, s[4:5], 1216
s_load_dword s3, s[4:5], 1280
s_load_dword s3, s[4:5], 1344
s_load_dword s3, s[4:5], 1408
buffer_load_dwordx4 v3, s[8:11], s37 offen offset:1024 sc1 lds
s_load_dword s3, s[4:5], 1472
s_load_dword s3, s[4:5], 1536
s_load_dword s3, s[4:5], 1600
s_load_dword s3, s[4:5], 1664
s_load_dword s3, s[4:5], 1728
v_add_f32 v73, v73, v81
buffer_load_dwordx4 v3, s[8:11], s37 offen offset:2048 sc1 lds
v_add_f32 v74, v74, v82
v_add_f32 v75, v75, v83
v_add_f32 v76, v76, v84
v_add_f32 v77, v77, v85
v_add_f32 v78, v78, v86
buffer_load_dwordx4 v3, s[8:11], s37 offen offset:3072 sc1 lds
v_add_f32 v79, v79, v87
v_lshlrev_b32 v80, 16, v52
v_and_b32 v81, 0xffff0000, v52
v_lshlrev_b32 v82, 16, v53
v_and_b32 v83, 0xffff0000, v53
v_lshlrev_b32 v84, 16, v54
s_add_u32 s38, s35, 14
s_and_b32 s38, s38, 15
s_mul_i32 s38, s38, 458752
s_add_u32 m0, s50, 98304
s_nop 0
buffer_load_dwordx4 v6, s[16:19], s38 offen lds
v_and_b32 v85, 0xffff0000, v54
v_lshlrev_b32 v86, 16, v55
v_and_b32 v87, 0xffff0000, v55
v_add_f32 v72, v72, v80
v_add_f32 v73, v73, v81
s_add_u32 m0, s50, 99328
s_nop 0
buffer_load_dwordx4 v7, s[16:19], s38 offen lds
v_add_f32 v74, v74, v82
v_add_f32 v75, v75, v83
v_add_f32 v76, v76, v84
v_add_f32 v77, v77, v85
v_add_f32 v78, v78, v86
v_add_f32 v79, v79, v87
s_add_u32 m0, s50, 100352
s_nop 0
buffer_load_dwordx4 v8, s[16:19], s38 offen lds
v_lshlrev_b32 v80, 16, v56
v_and_b32 v81, 0xffff0000, v56
v_lshlrev_b32 v82, 16, v57
v_and_b32 v83, 0xffff0000, v57
v_lshlrev_b32 v84, 16, v58
s_add_u32 m0, s50, 101376
s_add_u32 s38, s38, 114688
buffer_load_dwordx4 v6, s[16:19], s38 offen lds
v_and_b32 v85, 0xffff0000, v58
v_lshlrev_b32 v86, 16, v59
v_and_b32 v87, 0xffff0000, v59
v_add_f32 v72, v72, v80
v_add_f32 v73, v73, v81
v_add_f32 v74, v74, v82
s_add_u32 m0, s50, 102400
s_nop 0
buffer_load_dwordx4 v7, s[16:19], s38 offen lds
s_add_u32 m0, s50, 103424
s_nop 0
buffer_load_dwordx4 v8, s[16:19], s38 offen lds
s_waitcnt vmcnt(10)
s_barrier
s_add_u32 s37, s35, 15
s_and_b32 s37, s37, 15
s_mul_i32 s37, s37, 16384
s_add_u32 m0, s39, 0
s_nop 0
buffer_load_dwordx4 v3, s[8:11], s37 offen sc1 lds
v_add_f32 v75, v75, v83
v_add_f32 v76, v76, v84
v_add_f32 v77, v77, v85
v_add_f32 v78, v78, v86
buffer_load_dwordx4 v3, s[8:11], s37 offen offset:1024 sc1 lds
v_add_f32 v79, v79, v87
v_lshlrev_b32 v80, 16, v60
v_and_b32 v81, 0xffff0000, v60
v_lshlrev_b32 v82, 16, v61
buffer_load_dwordx4 v3, s[8:11], s37 offen offset:2048 sc1 lds
v_and_b32 v83, 0xffff0000, v61
v_lshlrev_b32 v84, 16, v62
v_and_b32 v85, 0xffff0000, v62
v_lshlrev_b32 v86, 16, v63
buffer_load_dwordx4 v3, s[8:11], s37 offen offset:3072 sc1 lds
v_and_b32 v87, 0xffff0000, v63
v_add_f32 v72, v72, v80
v_add_f32 v73, v73, v81
v_add_f32 v74, v74, v82
s_add_u32 s38, s35, 15
s_and_b32 s38, s38, 15
s_mul_i32 s38, s38, 458752
s_add_u32 m0, s50, 0
s_nop 0
buffer_load_dwordx4 v6, s[16:19], s38 offen lds
v_add_f32 v75, v75, v83
v_add_f32 v76, v76, v84
v_add_f32 v77, v77, v85
v_add_f32 v78, v78, v86
s_add_u32 m0, s50, 1024
s_nop 0
buffer_load_dwordx4 v7, s[16:19], s38 offen lds
v_add_f32 v79, v79, v87
v_lshlrev_b32 v80, 16, v64
v_and_b32 v81, 0xffff0000, v64
v_lshlrev_b32 v82, 16, v65
s_add_u32 m0, s50, 2048
s_nop 0
buffer_load_dwordx4 v8, s[16:19], s38 offen lds
v_and_b32 v83, 0xffff0000, v65
v_lshlrev_b32 v84, 16, v66
v_and_b32 v85, 0xffff0000, v66
v_lshlrev_b32 v86, 16, v67
s_add_u32 m0, s50, 3072
s_add_u32 s38, s38, 114688
buffer_load_dwordx4 v6, s[16:19], s38 offen lds
v_and_b32 v87, 0xffff0000, v67
v_add_f32 v72, v72, v80
v_add_f32 v73, v73, v81
v_add_f32 v74, v74, v82
v_add_f32 v75, v75, v83
s_add_u32 m0, s50, 4096
s_nop 0
buffer_load_dwordx4 v7, s[16:19], s38 offen lds
s_add_u32 m0, s50, 5120
s_nop 0
buffer_load_dwordx4 v8, s[16:19], s38 offen lds
s_waitcnt vmcnt(10)
s_barrier
s_add_u32 s38, s35, 13
s_and_b32 s38, s38, 15
s_mul_i32 s38, s38, 458752
s_add_u32 m0, s40, 49152
s_nop 0
buffer_load_dwordx4 v4, s[12:15], s38 offen lds
v_add_f32 v76, v76, v84
v_add_f32 v77, v77, v85
v_add_f32 v78, v78, v86
v_add_f32 v79, v79, v87
v_lshlrev_b32 v80, 16, v68
s_add_u32 m0, s40, 50176
s_nop 0
buffer_load_dwordx4 v5, s[12:15], s38 offen lds
v_and_b32 v81, 0xffff0000, v68
v_lshlrev_b32 v82, 16, v69
v_and_b32 v83, 0xffff0000, v69
v_lshlrev_b32 v84, 16, v70
v_and_b32 v85, 0xffff0000, v70
v_lshlrev_b32 v86, 16, v71
s_add_u32 m0, s40, 51200
s_add_u32 s38, s38, 57344
buffer_load_dwordx4 v4, s[12:15], s38 offen lds
v_and_b32 v87, 0xffff0000, v71
v_add_f32 v72, v72, v80
v_add_f32 v73, v73, v81
v_add_f32 v74, v74, v82
v_add_f32 v75, v75, v83
v_add_f32 v76, v76, v84
s_add_u32 m0, s40, 52224
s_nop 0
buffer_load_dwordx4 v5, s[12:15], s38 offen lds
v_add_f32 v77, v77, v85
v_add_f32 v78, v78, v86
v_add_f32 v79, v79, v87
s_nop 0
v_permlane32_swap_b32 v72, v76
s_add_u32 m0, s40, 53248
s_add_u32 s38, s38, 57344
buffer_load_dwordx4 v4, s[12:15], s38 offen lds
v_permlane32_swap_b32 v73, v77
v_permlane32_swap_b32 v74, v78
v_permlane32_swap_b32 v75, v79
v_add_f32 v72, v72, v76
v_add_f32 v73, v73, v77
v_add_f32 v74, v74, v78
s_add_u32 m0, s40, 54272
s_nop 0
buffer_load_dwordx4 v5, s[12:15], s38 offen lds
v_add_f32 v75, v75, v79
s_nop 0
v_permlane16_swap_b32 v72, v74
v_permlane16_swap_b32 v73, v75
v_add_f32 v72, v72, v74
v_add_f32 v73, v73, v75
s_add_u32 m0, s40, 55296
s_add_u32 s38, s38, 57344
buffer_load_dwordx4 v4, s[12:15], s38 offen lds
s_add_u32 m0, s40, 56320
s_nop 0
buffer_load_dwordx4 v5, s[12:15], s38 offen lds
s_waitcnt vmcnt(8)
s_barrier
s_lshl_b32 s43, s47, 9
s_add_u32 s43, s43, 153600
v_and_b32 v80, 15, v1
v_lshl_add_u32 v80, v80, 5, s43
v_lshrrev_b32 v81, 4, v1
v_lshl_add_u32 v80, v81, 3, v80
ds_write_b64 v80, v[72:73]
s_waitcnt lgkmcnt(0)
s_add_u32 s38, s35, 14
s_and_b32 s38, s38, 15
s_mul_i32 s38, s38, 458752
s_add_u32 m0, s40, 98304
s_nop 0
buffer_load_dwordx4 v4, s[12:15], s38 offen lds
s_bfe_u32 s61, s35, 0x10002
s_lshr_b32 s60, s35, 3
s_lshl_b32 s60, s60, 2
s_and_b32 s43, s35, 3
s_add_u32 s60, s60, s43
s_add_u32 m0, s40, 99328
s_nop 0
buffer_load_dwordx4 v5, s[12:15], s38 offen lds
s_lshl_b32 s43, s60, 8
s_add_u32 s28, s76, s43
s_addc_u32 s29, s77, 0
s_mov_b32 s30, 7338240
s_mov_b32 s31, 0x20000
s_add_u32 m0, s40, 100352
s_add_u32 s38, s38, 57344
buffer_load_dwordx4 v4, s[12:15], s38 offen lds
s_mul_i32 s52, s61, 196608
s_mul_i32 s53, s61, 1572864
s_mul_i32 s90, s61, 163840
s_mul_i32 s91, s61, 1310720
s_and_b32 s43, s35, 3
s_add_u32 m0, s40, 101376
s_nop 0
buffer_load_dwordx4 v5, s[12:15], s38 offen lds
s_mul_i32 s32, s43, 3
s_mul_i32 s33, s43, 10
s_lshr_b32 s33, s33, 2
s_lshl_b32 s51, s47, 11
s_lshl_b32 s44, s47, 15
s_add_u32 m0, s40, 102400
s_add_u32 s38, s38, 57344
buffer_load_dwordx4 v4, s[12:15], s38 offen lds
v_lshrrev_b32 v122, 4, v1
v_lshlrev_b32 v123, 1, v122
v_and_b32 v23, 15, v1
v_xor_b32 v23, v23, v123
v_lshlrev_b32 v23, 4, v23
s_add_u32 m0, s40, 103424
s_nop 0
buffer_load_dwordx4 v5, s[12:15], s38 offen lds
v_mul_u32_u24 v122, 2048, v122
v_add_u32 v23, v23, v122
v_add_u32 v23, s44, v23
v_xor_b32 v24, 128, v23
v_add_u32 v24, 8192, v24
s_add_u32 m0, s40, 104448
s_add_u32 s38, s38, 57344
buffer_load_dwordx4 v4, s[12:15], s38 offen lds
s_add_u32 m0, s40, 105472
s_nop 0
buffer_load_dwordx4 v5, s[12:15], s38 offen lds
s_waitcnt vmcnt(8)
s_barrier
ds_read_b128 v[28:31], v9 offset:49152
ds_read_b64_tr_b16 v[44:45], v15 offset:0
ds_read_b64_tr_b16 v[46:47], v15 offset:4096
ds_read_b64_tr_b16 v[48:49], v16 offset:0
ds_read_b64_tr_b16 v[50:51], v16 offset:4096
ds_read_b64_tr_b16 v[52:53], v17 offset:0
ds_read_b64_tr_b16 v[54:55], v17 offset:4096
ds_read_b64_tr_b16 v[56:57], v18 offset:0
ds_read_b64_tr_b16 v[58:59], v18 offset:4096
ds_read_b64_tr_b16 v[60:61], v15 offset:16384
ds_read_b64_tr_b16 v[62:63], v15 offset:20480
ds_read_b64_tr_b16 v[64:65], v16 offset:16384
ds_read_b64_tr_b16 v[66:67], v16 offset:20480
ds_read_b64_tr_b16 v[68:69], v17 offset:16384
ds_read_b64_tr_b16 v[70:71], v17 offset:20480
ds_read_b64_tr_b16 v[72:73], v18 offset:16384
ds_read_b64_tr_b16 v[74:75], v18 offset:20480
ds_read_b128 v[32:35], v9 offset:50176
ds_read_b128 v[36:39], v9 offset:51200
ds_read_b128 v[40:43], v9 offset:52224
s_waitcnt lgkmcnt(0)
v_mfma_f32_16x16x32_bf16 v[124:127], v[44:47], v[28:31], 0
ds_read_b128 v[76:79], v9 offset:57344
v_mfma_f32_16x16x32_bf16 v[156:159], v[44:47], v[32:35], 0
ds_read_b64_tr_b16 v[92:93], v15 offset:8192
v_mfma_f32_16x16x32_bf16 v[188:191], v[44:47], v[36:39], 0
ds_read_b64_tr_b16 v[94:95], v15 offset:12288
v_mfma_f32_16x16x32_bf16 v[220:223], v[44:47], v[40:43], 0
ds_read_b64_tr_b16 v[96:97], v16 offset:8192
v_mfma_f32_16x16x32_bf16 v[224:227], v[48:51], v[40:43], 0
ds_read_b64_tr_b16 v[98:99], v16 offset:12288
v_mfma_f32_16x16x32_bf16 v[192:195], v[48:51], v[36:39], 0
ds_read_b64_tr_b16 v[100:101], v17 offset:8192
v_mfma_f32_16x16x32_bf16 v[160:163], v[48:51], v[32:35], 0
ds_read_b64_tr_b16 v[102:103], v17 offset:12288
v_mfma_f32_16x16x32_bf16 v[128:131], v[48:51], v[28:31], 0
ds_read_b64_tr_b16 v[104:105], v18 offset:8192
v_mfma_f32_16x16x32_bf16 v[132:135], v[52:55], v[28:31], 0
ds_read_b64_tr_b16 v[106:107], v18 offset:12288
v_mfma_f32_16x16x32_bf16 v[164:167], v[52:55], v[32:35], 0
ds_read_b64_tr_b16 v[108:109], v15 offset:24576
v_mfma_f32_16x16x32_bf16 v[196:199], v[52:55], v[36:39], 0
ds_read_b64_tr_b16 v[110:111], v15 offset:28672
v_mfma_f32_16x16x32_bf16 v[228:231], v[52:55], v[40:43], 0
ds_read_b64_tr_b16 v[112:113], v16 offset:24576
v_mfma_f32_16x16x32_bf16 v[232:235], v[56:59], v[40:43], 0
ds_read_b64_tr_b16 v[114:115], v16 offset:28672
v_mfma_f32_16x16x32_bf16 v[200:203], v[56:59], v[36:39], 0
ds_read_b64_tr_b16 v[116:117], v17 offset:24576
v_mfma_f32_16x16x32_bf16 v[168:171], v[56:59], v[32:35], 0
ds_read_b64_tr_b16 v[118:119], v17 offset:28672
v_mfma_f32_16x16x32_bf16 v[136:139], v[56:59], v[28:31], 0
ds_read_b64_tr_b16 v[120:121], v18 offset:24576
v_mfma_f32_16x16x32_bf16 v[140:143], v[60:63], v[28:31], 0
ds_read_b64_tr_b16 v[122:123], v18 offset:28672
v_mfma_f32_16x16x32_bf16 v[172:175], v[60:63], v[32:35], 0
ds_read_b128 v[80:83], v9 offset:58368
v_mfma_f32_16x16x32_bf16 v[204:207], v[60:63], v[36:39], 0
ds_read_b128 v[84:87], v9 offset:59392
v_mfma_f32_16x16x32_bf16 v[236:239], v[60:63], v[40:43], 0
ds_read_b128 v[88:91], v9 offset:60416
v_mfma_f32_16x16x32_bf16 v[240:243], v[64:67], v[40:43], 0
v_mfma_f32_16x16x32_bf16 v[208:211], v[64:67], v[36:39], 0
v_mfma_f32_16x16x32_bf16 v[176:179], v[64:67], v[32:35], 0
s_branch Lov_15
.p2align 12
.fill 112, 4, 0xbf800000
Lst_15_0:
s_branch Lwr_183
s_nop 0
s_nop 0
Lov_15:
v_mfma_f32_16x16x32_bf16 v[144:147], v[64:67], v[28:31], 0
v_mfma_f32_16x16x32_bf16 v[148:151], v[68:71], v[28:31], 0
v_mfma_f32_16x16x32_bf16 v[180:183], v[68:71], v[32:35], 0
v_mfma_f32_16x16x32_bf16 v[212:215], v[68:71], v[36:39], 0
v_mfma_f32_16x16x32_bf16 v[244:247], v[68:71], v[40:43], 0
v_mfma_f32_16x16x32_bf16 v[248:251], v[72:75], v[40:43], 0
v_mfma_f32_16x16x32_bf16 v[216:219], v[72:75], v[36:39], 0
v_mfma_f32_16x16x32_bf16 v[184:187], v[72:75], v[32:35], 0
v_mfma_f32_16x16x32_bf16 v[152:155], v[72:75], v[28:31], 0
s_waitcnt vmcnt(0)
s_waitcnt lgkmcnt(0)
s_barrier
v_mfma_f32_16x16x32_bf16 v[124:127], v[92:95], v[76:79], v[124:127]
ds_read_b128 v[28:31], v10 offset:0
v_mfma_f32_16x16x32_bf16 v[156:159], v[92:95], v[80:83], v[156:159]
ds_read_b64_tr_b16 v[44:45], v19 offset:0
v_mfma_f32_16x16x32_bf16 v[188:191], v[92:95], v[84:87], v[188:191]
ds_read_b64_tr_b16 v[46:47], v19 offset:4096
v_mfma_f32_16x16x32_bf16 v[220:223], v[92:95], v[88:91], v[220:223]
ds_read_b64_tr_b16 v[48:49], v20 offset:0
v_mfma_f32_16x16x32_bf16 v[224:227], v[96:99], v[88:91], v[224:227]
ds_read_b64_tr_b16 v[50:51], v20 offset:4096
v_mfma_f32_16x16x32_bf16 v[192:195], v[96:99], v[84:87], v[192:195]
ds_read_b64_tr_b16 v[52:53], v21 offset:0
v_mfma_f32_16x16x32_bf16 v[160:163], v[96:99], v[80:83], v[160:163]
ds_read_b64_tr_b16 v[54:55], v21 offset:4096
v_mfma_f32_16x16x32_bf16 v[128:131], v[96:99], v[76:79], v[128:131]
ds_read_b64_tr_b16 v[56:57], v22 offset:0
v_mfma_f32_16x16x32_bf16 v[132:135], v[100:103], v[76:79], v[132:135]
ds_read_b64_tr_b16 v[58:59], v22 offset:4096
v_mfma_f32_16x16x32_bf16 v[164:167], v[100:103], v[80:83], v[164:167]
ds_read_b64_tr_b16 v[60:61], v19 offset:16384
v_mfma_f32_16x16x32_bf16 v[196:199], v[100:103], v[84:87], v[196:199]
ds_read_b64_tr_b16 v[62:63], v19 offset:20480
v_mfma_f32_16x16x32_bf16 v[228:231], v[100:103], v[88:91], v[228:231]
ds_read_b64_tr_b16 v[64:65], v20 offset:16384
v_mfma_f32_16x16x32_bf16 v[232:235], v[104:107], v[88:91], v[232:235]
ds_read_b64_tr_b16 v[66:67], v20 offset:20480
v_mfma_f32_16x16x32_bf16 v[200:203], v[104:107], v[84:87], v[200:203]
ds_read_b64_tr_b16 v[68:69], v21 offset:16384
v_mfma_f32_16x16x32_bf16 v[168:171], v[104:107], v[80:83], v[168:171]
ds_read_b64_tr_b16 v[70:71], v21 offset:20480
v_mfma_f32_16x16x32_bf16 v[136:139], v[104:107], v[76:79], v[136:139]
ds_read_b64_tr_b16 v[72:73], v22 offset:16384
v_mfma_f32_16x16x32_bf16 v[140:143], v[108:111], v[76:79], v[140:143]
ds_read_b64_tr_b16 v[74:75], v22 offset:20480
v_mfma_f32_16x16x32_bf16 v[172:175], v[108:111], v[80:83], v[172:175]
ds_read_b128 v[32:35], v10 offset:1024
v_mfma_f32_16x16x32_bf16 v[204:207], v[108:111], v[84:87], v[204:207]
ds_read_b128 v[36:39], v10 offset:2048
v_mfma_f32_16x16x32_bf16 v[236:239], v[108:111], v[88:91], v[236:239]
ds_read_b128 v[40:43], v10 offset:3072
v_mfma_f32_16x16x32_bf16 v[240:243], v[112:115], v[88:91], v[240:243]
v_mfma_f32_16x16x32_bf16 v[208:211], v[112:115], v[84:87], v[208:211]
v_mfma_f32_16x16x32_bf16 v[176:179], v[112:115], v[80:83], v[176:179]
v_mfma_f32_16x16x32_bf16 v[144:147], v[112:115], v[76:79], v[144:147]
v_mfma_f32_16x16x32_bf16 v[148:151], v[116:119], v[76:79], v[148:151]
v_mfma_f32_16x16x32_bf16 v[180:183], v[116:119], v[80:83], v[180:183]
v_mfma_f32_16x16x32_bf16 v[212:215], v[116:119], v[84:87], v[212:215]
v_mfma_f32_16x16x32_bf16 v[244:247], v[116:119], v[88:91], v[244:247]
v_mfma_f32_16x16x32_bf16 v[248:251], v[120:123], v[88:91], v[248:251]
v_mfma_f32_16x16x32_bf16 v[216:219], v[120:123], v[84:87], v[216:219]
v_mfma_f32_16x16x32_bf16 v[184:187], v[120:123], v[80:83], v[184:187]
v_mfma_f32_16x16x32_bf16 v[152:155], v[120:123], v[76:79], v[152:155]
s_mov_b32 s41, 5
Lk3l_147:
s_waitcnt lgkmcnt(0)
v_mfma_f32_16x16x32_bf16 v[124:127], v[44:47], v[28:31], v[124:127]
ds_read_b128 v[76:79], v10 offset:8192
v_mfma_f32_16x16x32_bf16 v[156:159], v[44:47], v[32:35], v[156:159]
ds_read_b64_tr_b16 v[92:93], v19 offset:8192
v_mfma_f32_16x16x32_bf16 v[188:191], v[44:47], v[36:39], v[188:191]
ds_read_b64_tr_b16 v[94:95], v19 offset:12288
v_mfma_f32_16x16x32_bf16 v[220:223], v[44:47], v[40:43], v[220:223]
ds_read_b64_tr_b16 v[96:97], v20 offset:8192
v_mfma_f32_16x16x32_bf16 v[224:227], v[48:51], v[40:43], v[224:227]
ds_read_b64_tr_b16 v[98:99], v20 offset:12288
v_mfma_f32_16x16x32_bf16 v[192:195], v[48:51], v[36:39], v[192:195]
ds_read_b64_tr_b16 v[100:101], v21 offset:8192
v_mfma_f32_16x16x32_bf16 v[160:163], v[48:51], v[32:35], v[160:163]
ds_read_b64_tr_b16 v[102:103], v21 offset:12288
v_mfma_f32_16x16x32_bf16 v[128:131], v[48:51], v[28:31], v[128:131]
ds_read_b64_tr_b16 v[104:105], v22 offset:8192
v_mfma_f32_16x16x32_bf16 v[132:135], v[52:55], v[28:31], v[132:135]
ds_read_b64_tr_b16 v[106:107], v22 offset:12288
v_mfma_f32_16x16x32_bf16 v[164:167], v[52:55], v[32:35], v[164:167]
ds_read_b64_tr_b16 v[108:109], v19 offset:24576
v_mfma_f32_16x16x32_bf16 v[196:199], v[52:55], v[36:39], v[196:199]
ds_read_b64_tr_b16 v[110:111], v19 offset:28672
v_mfma_f32_16x16x32_bf16 v[228:231], v[52:55], v[40:43], v[228:231]
ds_read_b64_tr_b16 v[112:113], v20 offset:24576
v_mfma_f32_16x16x32_bf16 v[232:235], v[56:59], v[40:43], v[232:235]
ds_read_b64_tr_b16 v[114:115], v20 offset:28672
v_mfma_f32_16x16x32_bf16 v[200:203], v[56:59], v[36:39], v[200:203]
ds_read_b64_tr_b16 v[116:117], v21 offset:24576
v_mfma_f32_16x16x32_bf16 v[168:171], v[56:59], v[32:35], v[168:171]
ds_read_b64_tr_b16 v[118:119], v21 offset:28672
v_mfma_f32_16x16x32_bf16 v[136:139], v[56:59], v[28:31], v[136:139]
ds_read_b64_tr_b16 v[120:121], v22 offset:24576
v_mfma_f32_16x16x32_bf16 v[140:143], v[60:63], v[28:31], v[140:143]
ds_read_b64_tr_b16 v[122:123], v22 offset:28672
v_mfma_f32_16x16x32_bf16 v[172:175], v[60:63], v[32:35], v[172:175]
ds_read_b128 v[80:83], v10 offset:9216
v_mfma_f32_16x16x32_bf16 v[204:207], v[60:63], v[36:39], v[204:207]
ds_read_b128 v[84:87], v10 offset:10240
v_mfma_f32_16x16x32_bf16 v[236:239], v[60:63], v[40:43], v[236:239]
ds_read_b128 v[88:91], v10 offset:11264
v_mfma_f32_16x16x32_bf16 v[240:243], v[64:67], v[40:43], v[240:243]
v_mfma_f32_16x16x32_bf16 v[208:211], v[64:67], v[36:39], v[208:211]
v_mfma_f32_16x16x32_bf16 v[176:179], v[64:67], v[32:35], v[176:179]
v_mfma_f32_16x16x32_bf16 v[144:147], v[64:67], v[28:31], v[144:147]
v_mfma_f32_16x16x32_bf16 v[148:151], v[68:71], v[28:31], v[148:151]
v_mfma_f32_16x16x32_bf16 v[180:183], v[68:71], v[32:35], v[180:183]
v_mfma_f32_16x16x32_bf16 v[212:215], v[68:71], v[36:39], v[212:215]
v_mfma_f32_16x16x32_bf16 v[244:247], v[68:71], v[40:43], v[244:247]
v_mfma_f32_16x16x32_bf16 v[248:251], v[72:75], v[40:43], v[248:251]
v_mfma_f32_16x16x32_bf16 v[216:219], v[72:75], v[36:39], v[216:219]
v_mfma_f32_16x16x32_bf16 v[184:187], v[72:75], v[32:35], v[184:187]
v_mfma_f32_16x16x32_bf16 v[152:155], v[72:75], v[28:31], v[152:155]
s_waitcnt lgkmcnt(0)
s_barrier
v_mfma_f32_16x16x32_bf16 v[124:127], v[92:95], v[76:79], v[124:127]
ds_read_b128 v[28:31], v9 offset:0
v_mfma_f32_16x16x32_bf16 v[156:159], v[92:95], v[80:83], v[156:159]
ds_read_b64_tr_b16 v[44:45], v11 offset:0
v_mfma_f32_16x16x32_bf16 v[188:191], v[92:95], v[84:87], v[188:191]
ds_read_b64_tr_b16 v[46:47], v11 offset:4096
v_mfma_f32_16x16x32_bf16 v[220:223], v[92:95], v[88:91], v[220:223]
ds_read_b64_tr_b16 v[48:49], v12 offset:0
v_mfma_f32_16x16x32_bf16 v[224:227], v[96:99], v[88:91], v[224:227]
ds_read_b64_tr_b16 v[50:51], v12 offset:4096
v_mfma_f32_16x16x32_bf16 v[192:195], v[96:99], v[84:87], v[192:195]
ds_read_b64_tr_b16 v[52:53], v13 offset:0
v_mfma_f32_16x16x32_bf16 v[160:163], v[96:99], v[80:83], v[160:163]
ds_read_b64_tr_b16 v[54:55], v13 offset:4096
v_mfma_f32_16x16x32_bf16 v[128:131], v[96:99], v[76:79], v[128:131]
ds_read_b64_tr_b16 v[56:57], v14 offset:0
v_mfma_f32_16x16x32_bf16 v[132:135], v[100:103], v[76:79], v[132:135]
ds_read_b64_tr_b16 v[58:59], v14 offset:4096
v_mfma_f32_16x16x32_bf16 v[164:167], v[100:103], v[80:83], v[164:167]
ds_read_b64_tr_b16 v[60:61], v11 offset:16384
v_mfma_f32_16x16x32_bf16 v[196:199], v[100:103], v[84:87], v[196:199]
ds_read_b64_tr_b16 v[62:63], v11 offset:20480
v_mfma_f32_16x16x32_bf16 v[228:231], v[100:103], v[88:91], v[228:231]
ds_read_b64_tr_b16 v[64:65], v12 offset:16384
v_mfma_f32_16x16x32_bf16 v[232:235], v[104:107], v[88:91], v[232:235]
ds_read_b64_tr_b16 v[66:67], v12 offset:20480
v_mfma_f32_16x16x32_bf16 v[200:203], v[104:107], v[84:87], v[200:203]
ds_read_b64_tr_b16 v[68:69], v13 offset:16384
v_mfma_f32_16x16x32_bf16 v[168:171], v[104:107], v[80:83], v[168:171]
ds_read_b64_tr_b16 v[70:71], v13 offset:20480
v_mfma_f32_16x16x32_bf16 v[136:139], v[104:107], v[76:79], v[136:139]
ds_read_b64_tr_b16 v[72:73], v14 offset:16384
v_mfma_f32_16x16x32_bf16 v[140:143], v[108:111], v[76:79], v[140:143]
ds_read_b64_tr_b16 v[74:75], v14 offset:20480
v_mfma_f32_16x16x32_bf16 v[172:175], v[108:111], v[80:83], v[172:175]
ds_read_b128 v[32:35], v9 offset:1024
v_mfma_f32_16x16x32_bf16 v[204:207], v[108:111], v[84:87], v[204:207]
ds_read_b128 v[36:39], v9 offset:2048
v_mfma_f32_16x16x32_bf16 v[236:239], v[108:111], v[88:91], v[236:239]
ds_read_b128 v[40:43], v9 offset:3072
v_mfma_f32_16x16x32_bf16 v[240:243], v[112:115], v[88:91], v[240:243]
v_mfma_f32_16x16x32_bf16 v[208:211], v[112:115], v[84:87], v[208:211]
v_mfma_f32_16x16x32_bf16 v[176:179], v[112:115], v[80:83], v[176:179]
v_mfma_f32_16x16x32_bf16 v[144:147], v[112:115], v[76:79], v[144:147]
v_mfma_f32_16x16x32_bf16 v[148:151], v[116:119], v[76:79], v[148:151]
v_mfma_f32_16x16x32_bf16 v[180:183], v[116:119], v[80:83], v[180:183]
v_mfma_f32_16x16x32_bf16 v[212:215], v[116:119], v[84:87], v[212:215]
v_mfma_f32_16x16x32_bf16 v[244:247], v[116:119], v[88:91], v[244:247]
v_mfma_f32_16x16x32_bf16 v[248:251], v[120:123], v[88:91], v[248:251]
v_mfma_f32_16x16x32_bf16 v[216:219], v[120:123], v[84:87], v[216:219]
v_mfma_f32_16x16x32_bf16 v[184:187], v[120:123], v[80:83], v[184:187]
v_mfma_f32_16x16x32_bf16 v[152:155], v[120:123], v[76:79], v[152:155]
s_waitcnt lgkmcnt(0)
v_mfma_f32_16x16x32_bf16 v[124:127], v[44:47], v[28:31], v[124:127]
ds_read_b128 v[76:79], v9 offset:8192
v_mfma_f32_16x16x32_bf16 v[156:159], v[44:47], v[32:35], v[156:159]
ds_read_b64_tr_b16 v[92:93], v11 offset:8192
v_mfma_f32_16x16x32_bf16 v[188:191], v[44:47], v[36:39], v[188:191]
ds_read_b64_tr_b16 v[94:95], v11 offset:12288
v_mfma_f32_16x16x32_bf16 v[220:223], v[44:47], v[40:43], v[220:223]
ds_read_b64_tr_b16 v[96:97], v12 offset:8192
v_mfma_f32_16x16x32_bf16 v[224:227], v[48:51], v[40:43], v[224:227]
ds_read_b64_tr_b16 v[98:99], v12 offset:12288
v_mfma_f32_16x16x32_bf16 v[192:195], v[48:51], v[36:39], v[192:195]
ds_read_b64_tr_b16 v[100:101], v13 offset:8192
v_mfma_f32_16x16x32_bf16 v[160:163], v[48:51], v[32:35], v[160:163]
ds_read_b64_tr_b16 v[102:103], v13 offset:12288
v_mfma_f32_16x16x32_bf16 v[128:131], v[48:51], v[28:31], v[128:131]
ds_read_b64_tr_b16 v[104:105], v14 offset:8192
v_mfma_f32_16x16x32_bf16 v[132:135], v[52:55], v[28:31], v[132:135]
ds_read_b64_tr_b16 v[106:107], v14 offset:12288
v_mfma_f32_16x16x32_bf16 v[164:167], v[52:55], v[32:35], v[164:167]
ds_read_b64_tr_b16 v[108:109], v11 offset:24576
v_mfma_f32_16x16x32_bf16 v[196:199], v[52:55], v[36:39], v[196:199]
ds_read_b64_tr_b16 v[110:111], v11 offset:28672
v_mfma_f32_16x16x32_bf16 v[228:231], v[52:55], v[40:43], v[228:231]
ds_read_b64_tr_b16 v[112:113], v12 offset:24576
v_mfma_f32_16x16x32_bf16 v[232:235], v[56:59], v[40:43], v[232:235]
ds_read_b64_tr_b16 v[114:115], v12 offset:28672
v_mfma_f32_16x16x32_bf16 v[200:203], v[56:59], v[36:39], v[200:203]
ds_read_b64_tr_b16 v[116:117], v13 offset:24576
v_mfma_f32_16x16x32_bf16 v[168:171], v[56:59], v[32:35], v[168:171]
ds_read_b64_tr_b16 v[118:119], v13 offset:28672
v_mfma_f32_16x16x32_bf16 v[136:139], v[56:59], v[28:31], v[136:139]
ds_read_b64_tr_b16 v[120:121], v14 offset:24576
v_mfma_f32_16x16x32_bf16 v[140:143], v[60:63], v[28:31], v[140:143]
ds_read_b64_tr_b16 v[122:123], v14 offset:28672
v_mfma_f32_16x16x32_bf16 v[172:175], v[60:63], v[32:35], v[172:175]
ds_read_b128 v[80:83], v9 offset:9216
v_mfma_f32_16x16x32_bf16 v[204:207], v[60:63], v[36:39], v[204:207]
ds_read_b128 v[84:87], v9 offset:10240
v_mfma_f32_16x16x32_bf16 v[236:239], v[60:63], v[40:43], v[236:239]
ds_read_b128 v[88:91], v9 offset:11264
v_mfma_f32_16x16x32_bf16 v[240:243], v[64:67], v[40:43], v[240:243]
v_mfma_f32_16x16x32_bf16 v[208:211], v[64:67], v[36:39], v[208:211]
v_mfma_f32_16x16x32_bf16 v[176:179], v[64:67], v[32:35], v[176:179]
v_mfma_f32_16x16x32_bf16 v[144:147], v[64:67], v[28:31], v[144:147]
v_mfma_f32_16x16x32_bf16 v[148:151], v[68:71], v[28:31], v[148:151]
v_mfma_f32_16x16x32_bf16 v[180:183], v[68:71], v[32:35], v[180:183]
v_mfma_f32_16x16x32_bf16 v[212:215], v[68:71], v[36:39], v[212:215]
v_mfma_f32_16x16x32_bf16 v[244:247], v[68:71], v[40:43], v[244:247]
v_mfma_f32_16x16x32_bf16 v[248:251], v[72:75], v[40:43], v[248:251]
v_mfma_f32_16x16x32_bf16 v[216:219], v[72:75], v[36:39], v[216:219]
v_mfma_f32_16x16x32_bf16 v[184:187], v[72:75], v[32:35], v[184:187]
v_mfma_f32_16x16x32_bf16 v[152:155], v[72:75], v[28:31], v[152:155]
s_waitcnt lgkmcnt(0)
s_barrier
v_mfma_f32_16x16x32_bf16 v[124:127], v[92:95], v[76:79], v[124:127]
ds_read_b128 v[28:31], v9 offset:49152
v_mfma_f32_16x16x32_bf16 v[156:159], v[92:95], v[80:83], v[156:159]
ds_read_b64_tr_b16 v[44:45], v15 offset:0
v_mfma_f32_16x16x32_bf16 v[188:191], v[92:95], v[84:87], v[188:191]
ds_read_b64_tr_b16 v[46:47], v15 offset:4096
v_mfma_f32_16x16x32_bf16 v[220:223], v[92:95], v[88:91], v[220:223]
ds_read_b64_tr_b16 v[48:49], v16 offset:0
v_mfma_f32_16x16x32_bf16 v[224:227], v[96:99], v[88:91], v[224:227]
ds_read_b64_tr_b16 v[50:51], v16 offset:4096
v_mfma_f32_16x16x32_bf16 v[192:195], v[96:99], v[84:87], v[192:195]
ds_read_b64_tr_b16 v[52:53], v17 offset:0
v_mfma_f32_16x16x32_bf16 v[160:163], v[96:99], v[80:83], v[160:163]
ds_read_b64_tr_b16 v[54:55], v17 offset:4096
v_mfma_f32_16x16x32_bf16 v[128:131], v[96:99], v[76:79], v[128:131]
ds_read_b64_tr_b16 v[56:57], v18 offset:0
v_mfma_f32_16x16x32_bf16 v[132:135], v[100:103], v[76:79], v[132:135]
ds_read_b64_tr_b16 v[58:59], v18 offset:4096
v_mfma_f32_16x16x32_bf16 v[164:167], v[100:103], v[80:83], v[164:167]
ds_read_b64_tr_b16 v[60:61], v15 offset:16384
v_mfma_f32_16x16x32_bf16 v[196:199], v[100:103], v[84:87], v[196:199]
ds_read_b64_tr_b16 v[62:63], v15 offset:20480
v_mfma_f32_16x16x32_bf16 v[228:231], v[100:103], v[88:91], v[228:231]
ds_read_b64_tr_b16 v[64:65], v16 offset:16384
v_mfma_f32_16x16x32_bf16 v[232:235], v[104:107], v[88:91], v[232:235]
ds_read_b64_tr_b16 v[66:67], v16 offset:20480
v_mfma_f32_16x16x32_bf16 v[200:203], v[104:107], v[84:87], v[200:203]
ds_read_b64_tr_b16 v[68:69], v17 offset:16384
v_mfma_f32_16x16x32_bf16 v[168:171], v[104:107], v[80:83], v[168:171]
ds_read_b64_tr_b16 v[70:71], v17 offset:20480
v_mfma_f32_16x16x32_bf16 v[136:139], v[104:107], v[76:79], v[136:139]
ds_read_b64_tr_b16 v[72:73], v18 offset:16384
v_mfma_f32_16x16x32_bf16 v[140:143], v[108:111], v[76:79], v[140:143]
ds_read_b64_tr_b16 v[74:75], v18 offset:20480
v_mfma_f32_16x16x32_bf16 v[172:175], v[108:111], v[80:83], v[172:175]
ds_read_b128 v[32:35], v9 offset:50176
v_mfma_f32_16x16x32_bf16 v[204:207], v[108:111], v[84:87], v[204:207]
ds_read_b128 v[36:39], v9 offset:51200
v_mfma_f32_16x16x32_bf16 v[236:239], v[108:111], v[88:91], v[236:239]
ds_read_b128 v[40:43], v9 offset:52224
v_mfma_f32_16x16x32_bf16 v[240:243], v[112:115], v[88:91], v[240:243]
v_mfma_f32_16x16x32_bf16 v[208:211], v[112:115], v[84:87], v[208:211]
v_mfma_f32_16x16x32_bf16 v[176:179], v[112:115], v[80:83], v[176:179]
v_mfma_f32_16x16x32_bf16 v[144:147], v[112:115], v[76:79], v[144:147]
v_mfma_f32_16x16x32_bf16 v[148:151], v[116:119], v[76:79], v[148:151]
v_mfma_f32_16x16x32_bf16 v[180:183], v[116:119], v[80:83], v[180:183]
v_mfma_f32_16x16x32_bf16 v[212:215], v[116:119], v[84:87], v[212:215]
v_mfma_f32_16x16x32_bf16 v[244:247], v[116:119], v[88:91], v[244:247]
v_mfma_f32_16x16x32_bf16 v[248:251], v[120:123], v[88:91], v[248:251]
v_mfma_f32_16x16x32_bf16 v[216:219], v[120:123], v[84:87], v[216:219]
v_mfma_f32_16x16x32_bf16 v[184:187], v[120:123], v[80:83], v[184:187]
v_mfma_f32_16x16x32_bf16 v[152:155], v[120:123], v[76:79], v[152:155]
s_waitcnt lgkmcnt(0)
v_mfma_f32_16x16x32_bf16 v[124:127], v[44:47], v[28:31], v[124:127]
ds_read_b128 v[76:79], v9 offset:57344
v_mfma_f32_16x16x32_bf16 v[156:159], v[44:47], v[32:35], v[156:159]
ds_read_b64_tr_b16 v[92:93], v15 offset:8192
v_mfma_f32_16x16x32_bf16 v[188:191], v[44:47], v[36:39], v[188:191]
ds_read_b64_tr_b16 v[94:95], v15 offset:12288
v_mfma_f32_16x16x32_bf16 v[220:223], v[44:47], v[40:43], v[220:223]
ds_read_b64_tr_b16 v[96:97], v16 offset:8192
v_mfma_f32_16x16x32_bf16 v[224:227], v[48:51], v[40:43], v[224:227]
ds_read_b64_tr_b16 v[98:99], v16 offset:12288
v_mfma_f32_16x16x32_bf16 v[192:195], v[48:51], v[36:39], v[192:195]
ds_read_b64_tr_b16 v[100:101], v17 offset:8192
v_mfma_f32_16x16x32_bf16 v[160:163], v[48:51], v[32:35], v[160:163]
ds_read_b64_tr_b16 v[102:103], v17 offset:12288
v_mfma_f32_16x16x32_bf16 v[128:131], v[48:51], v[28:31], v[128:131]
ds_read_b64_tr_b16 v[104:105], v18 offset:8192
v_mfma_f32_16x16x32_bf16 v[132:135], v[52:55], v[28:31], v[132:135]
ds_read_b64_tr_b16 v[106:107], v18 offset:12288
v_mfma_f32_16x16x32_bf16 v[164:167], v[52:55], v[32:35], v[164:167]
ds_read_b64_tr_b16 v[108:109], v15 offset:24576
v_mfma_f32_16x16x32_bf16 v[196:199], v[52:55], v[36:39], v[196:199]
ds_read_b64_tr_b16 v[110:111], v15 offset:28672
v_mfma_f32_16x16x32_bf16 v[228:231], v[52:55], v[40:43], v[228:231]
ds_read_b64_tr_b16 v[112:113], v16 offset:24576
v_mfma_f32_16x16x32_bf16 v[232:235], v[56:59], v[40:43], v[232:235]
ds_read_b64_tr_b16 v[114:115], v16 offset:28672
v_mfma_f32_16x16x32_bf16 v[200:203], v[56:59], v[36:39], v[200:203]
ds_read_b64_tr_b16 v[116:117], v17 offset:24576
v_mfma_f32_16x16x32_bf16 v[168:171], v[56:59], v[32:35], v[168:171]
ds_read_b64_tr_b16 v[118:119], v17 offset:28672
v_mfma_f32_16x16x32_bf16 v[136:139], v[56:59], v[28:31], v[136:139]
ds_read_b64_tr_b16 v[120:121], v18 offset:24576
v_mfma_f32_16x16x32_bf16 v[140:143], v[60:63], v[28:31], v[140:143]
ds_read_b64_tr_b16 v[122:123], v18 offset:28672
v_mfma_f32_16x16x32_bf16 v[172:175], v[60:63], v[32:35], v[172:175]
ds_read_b128 v[80:83], v9 offset:58368
v_mfma_f32_16x16x32_bf16 v[204:207], v[60:63], v[36:39], v[204:207]
ds_read_b128 v[84:87], v9 offset:59392
v_mfma_f32_16x16x32_bf16 v[236:239], v[60:63], v[40:43], v[236:239]
ds_read_b128 v[88:91], v9 offset:60416
v_mfma_f32_16x16x32_bf16 v[240:243], v[64:67], v[40:43], v[240:243]
v_mfma_f32_16x16x32_bf16 v[208:211], v[64:67], v[36:39], v[208:211]
v_mfma_f32_16x16x32_bf16 v[176:179], v[64:67], v[32:35], v[176:179]
v_mfma_f32_16x16x32_bf16 v[144:147], v[64:67], v[28:31], v[144:147]
v_mfma_f32_16x16x32_bf16 v[148:151], v[68:71], v[28:31], v[148:151]
v_mfma_f32_16x16x32_bf16 v[180:183], v[68:71], v[32:35], v[180:183]
v_mfma_f32_16x16x32_bf16 v[212:215], v[68:71], v[36:39], v[212:215]
v_mfma_f32_16x16x32_bf16 v[244:247], v[68:71], v[40:43], v[244:247]
v_mfma_f32_16x16x32_bf16 v[248:251], v[72:75], v[40:43], v[248:251]
v_mfma_f32_16x16x32_bf16 v[216:219], v[72:75], v[36:39], v[216:219]
v_mfma_f32_16x16x32_bf16 v[184:187], v[72:75], v[32:35], v[184:187]
v_mfma_f32_16x16x32_bf16 v[152:155], v[72:75], v[28:31], v[152:155]
s_waitcnt lgkmcnt(0)
s_barrier
v_mfma_f32_16x16x32_bf16 v[124:127], v[92:95], v[76:79], v[124:127]
ds_read_b128 v[28:31], v10 offset:0
v_mfma_f32_16x16x32_bf16 v[156:159], v[92:95], v[80:83], v[156:159]
ds_read_b64_tr_b16 v[44:45], v19 offset:0
v_mfma_f32_16x16x32_bf16 v[188:191], v[92:95], v[84:87], v[188:191]
ds_read_b64_tr_b16 v[46:47], v19 offset:4096
v_mfma_f32_16x16x32_bf16 v[220:223], v[92:95], v[88:91], v[220:223]
ds_read_b64_tr_b16 v[48:49], v20 offset:0
v_mfma_f32_16x16x32_bf16 v[224:227], v[96:99], v[88:91], v[224:227]
ds_read_b64_tr_b16 v[50:51], v20 offset:4096
v_mfma_f32_16x16x32_bf16 v[192:195], v[96:99], v[84:87], v[192:195]
ds_read_b64_tr_b16 v[52:53], v21 offset:0
v_mfma_f32_16x16x32_bf16 v[160:163], v[96:99], v[80:83], v[160:163]
ds_read_b64_tr_b16 v[54:55], v21 offset:4096
v_mfma_f32_16x16x32_bf16 v[128:131], v[96:99], v[76:79], v[128:131]
ds_read_b64_tr_b16 v[56:57], v22 offset:0
v_mfma_f32_16x16x32_bf16 v[132:135], v[100:103], v[76:79], v[132:135]
ds_read_b64_tr_b16 v[58:59], v22 offset:4096
v_mfma_f32_16x16x32_bf16 v[164:167], v[100:103], v[80:83], v[164:167]
ds_read_b64_tr_b16 v[60:61], v19 offset:16384
v_mfma_f32_16x16x32_bf16 v[196:199], v[100:103], v[84:87], v[196:199]
ds_read_b64_tr_b16 v[62:63], v19 offset:20480
v_mfma_f32_16x16x32_bf16 v[228:231], v[100:103], v[88:91], v[228:231]
ds_read_b64_tr_b16 v[64:65], v20 offset:16384
v_mfma_f32_16x16x32_bf16 v[232:235], v[104:107], v[88:91], v[232:235]
ds_read_b64_tr_b16 v[66:67], v20 offset:20480
v_mfma_f32_16x16x32_bf16 v[200:203], v[104:107], v[84:87], v[200:203]
ds_read_b64_tr_b16 v[68:69], v21 offset:16384
v_mfma_f32_16x16x32_bf16 v[168:171], v[104:107], v[80:83], v[168:171]
ds_read_b64_tr_b16 v[70:71], v21 offset:20480
v_mfma_f32_16x16x32_bf16 v[136:139], v[104:107], v[76:79], v[136:139]
ds_read_b64_tr_b16 v[72:73], v22 offset:16384
v_mfma_f32_16x16x32_bf16 v[140:143], v[108:111], v[76:79], v[140:143]
ds_read_b64_tr_b16 v[74:75], v22 offset:20480
v_mfma_f32_16x16x32_bf16 v[172:175], v[108:111], v[80:83], v[172:175]
ds_read_b128 v[32:35], v10 offset:1024
v_mfma_f32_16x16x32_bf16 v[204:207], v[108:111], v[84:87], v[204:207]
ds_read_b128 v[36:39], v10 offset:2048
v_mfma_f32_16x16x32_bf16 v[236:239], v[108:111], v[88:91], v[236:239]
ds_read_b128 v[40:43], v10 offset:3072
v_mfma_f32_16x16x32_bf16 v[240:243], v[112:115], v[88:91], v[240:243]
v_mfma_f32_16x16x32_bf16 v[208:211], v[112:115], v[84:87], v[208:211]
v_mfma_f32_16x16x32_bf16 v[176:179], v[112:115], v[80:83], v[176:179]
v_mfma_f32_16x16x32_bf16 v[144:147], v[112:115], v[76:79], v[144:147]
v_mfma_f32_16x16x32_bf16 v[148:151], v[116:119], v[76:79], v[148:151]
v_mfma_f32_16x16x32_bf16 v[180:183], v[116:119], v[80:83], v[180:183]
v_mfma_f32_16x16x32_bf16 v[212:215], v[116:119], v[84:87], v[212:215]
v_mfma_f32_16x16x32_bf16 v[244:247], v[116:119], v[88:91], v[244:247]
v_mfma_f32_16x16x32_bf16 v[248:251], v[120:123], v[88:91], v[248:251]
v_mfma_f32_16x16x32_bf16 v[216:219], v[120:123], v[84:87], v[216:219]
v_mfma_f32_16x16x32_bf16 v[184:187], v[120:123], v[80:83], v[184:187]
v_mfma_f32_16x16x32_bf16 v[152:155], v[120:123], v[76:79], v[152:155]
s_sub_u32 s41, s41, 1
s_cmp_lg_u32 s41, 0
s_cbranch_scc1 Lk3l_147
s_waitcnt lgkmcnt(0)
s_barrier
v_lshrrev_b32 v84, 4, v1
s_lshl_b32 s43, s63, 8
s_add_u32 s43, s43, 148480
v_lshl_add_u32 v85, v84, 4, s43
v_and_b32 v84, 15, v1
s_lshl_b32 s43, s62, 9
s_add_u32 s43, s43, 147456
v_lshl_add_u32 v84, v84, 3, s43
ds_read_b128 v[28:31], v85 offset:0
ds_read_b128 v[32:35], v85 offset:64
ds_read_b128 v[36:39], v85 offset:128
ds_read_b128 v[40:43], v85 offset:192
ds_read_b128 v[44:47], v85 offset:896
ds_read_b128 v[48:51], v85 offset:960
ds_read_b128 v[52:55], v85 offset:1024
ds_read_b128 v[56:59], v85 offset:1088
ds_read_b64 v[60:61], v84 offset:0
ds_read_b64 v[62:63], v84 offset:128
ds_read_b64 v[64:65], v84 offset:256
ds_read_b64 v[66:67], v84 offset:384
s_lshl_b32 s54, s35, 15
s_lshl_b32 s43, s63, 14
s_add_u32 s54, s54, s43
s_lshl_b32 s43, s62, 12
s_add_u32 s54, s54, s43
s_add_u32 s55, s54, 8192
v_lshrrev_b32 v122, 3, v1
v_and_b32 v123, 6, v122
v_and_b32 v25, 7, v1
v_xor_b32 v25, v25, v123
v_lshlrev_b32 v25, 4, v25
v_mul_u32_u24 v122, 2048, v122
v_add_u32 v25, v25, v122
s_lshl_b32 s43, s61, 7
s_lshl_b32 s44, s47, 15
s_add_u32 s43, s43, s44
v_add_u32 v25, s43, v25
s_waitcnt lgkmcnt(0)
s_add_u32 s37, s52, 589824
s_add_u32 m0, s39, 81920
s_nop 0
buffer_load_dwordx4 v3, s[24:27], s37 offen sc1 lds
v_mul_f32 v70, v61, v61
v_mul_f32 v68, 0xc0135761, v61
v_mul_f32 v69, 0xbdd2d3e8, v61
v_mul_f32 v69, v69, v70
v_rcp_f32 v70, v70
v_mul_f32 v74, v63, v63
v_mul_f32 v72, 0xc0135761, v63
v_mul_f32 v73, 0xbdd2d3e8, v63
v_mul_f32 v73, v73, v74
v_rcp_f32 v74, v74
v_fma_f32 v124, -v60, v28, v124
v_fma_f32 v125, -v60, v29, v125
v_fma_f32 v126, -v60, v30, v126
v_fma_f32 v127, -v60, v31, v127
buffer_load_dwordx4 v3, s[24:27], s37 offen offset:1024 sc1 lds
v_fma_f32 v156, -v62, v28, v156
v_fma_f32 v157, -v62, v29, v157
v_fma_f32 v158, -v62, v30, v158
v_fma_f32 v159, -v62, v31, v159
v_mul_f32 v76, v124, v124
v_mul_f32 v77, v125, v125
v_mul_f32 v78, v126, v126
v_mul_f32 v79, v127, v127
v_mul_f32 v80, v156, v156
v_mul_f32 v81, v157, v157
v_mul_f32 v82, v158, v158
v_mul_f32 v83, v159, v159
v_fma_f32 v76, v76, v69, v68
v_fma_f32 v77, v77, v69, v68
buffer_load_dwordx4 v3, s[24:27], s37 offen offset:2048 sc1 lds
v_fma_f32 v78, v78, v69, v68
v_fma_f32 v79, v79, v69, v68
v_fma_f32 v80, v80, v73, v72
v_fma_f32 v81, v81, v73, v72
v_fma_f32 v82, v82, v73, v72
v_fma_f32 v83, v83, v73, v72
v_mul_f32 v76, v76, v124
v_mul_f32 v77, v77, v125
v_mul_f32 v78, v78, v126
v_mul_f32 v79, v79, v127
v_mul_f32 v80, v80, v156
v_mul_f32 v81, v81, v157
v_mul_f32 v82, v82, v158
v_mul_f32 v83, v83, v159
buffer_load_dwordx4 v3, s[24:27], s37 offen offset:3072 sc1 lds
v_exp_f32 v76, v76
v_exp_f32 v77, v77
v_exp_f32 v78, v78
v_exp_f32 v79, v79
v_exp_f32 v80, v80
v_exp_f32 v81, v81
v_exp_f32 v82, v82
v_exp_f32 v83, v83
v_fma_f32 v140, -v60, v44, v140
v_fma_f32 v141, -v60, v45, v141
s_branch Lov_16
.p2align 12
.fill 128, 4, 0xbf800000
Lst_16_0:
s_branch Lwr_184
s_nop 0
s_nop 0
Lov_16:
v_fma_f32 v142, -v60, v46, v142
v_fma_f32 v143, -v60, v47, v143
v_fma_f32 v172, -v62, v44, v172
v_fma_f32 v173, -v62, v45, v173
s_add_u32 s37, s52, 606208
s_add_u32 m0, s39, 98304
s_nop 0
buffer_load_dwordx4 v3, s[24:27], s37 offen sc1 lds
v_fma_f32 v174, -v62, v46, v174
v_fma_f32 v175, -v62, v47, v175
v_fma_f32 v76, v76, v70, v70
v_fma_f32 v77, v77, v70, v70
v_fma_f32 v78, v78, v70, v70
v_fma_f32 v79, v79, v70, v70
v_fma_f32 v80, v80, v74, v74
v_fma_f32 v81, v81, v74, v74
v_fma_f32 v82, v82, v74, v74
v_fma_f32 v83, v83, v74, v74
v_rcp_f32 v76, v76
v_rcp_f32 v77, v77
v_rcp_f32 v78, v78
v_rcp_f32 v79, v79
buffer_load_dwordx4 v3, s[24:27], s37 offen offset:1024 sc1 lds
v_rcp_f32 v80, v80
v_rcp_f32 v81, v81
v_rcp_f32 v82, v82
v_rcp_f32 v83, v83
v_mul_f32 v140, v124, v140
v_mul_f32 v141, v125, v141
v_mul_f32 v142, v126, v142
v_mul_f32 v143, v127, v143
v_mul_f32 v172, v156, v172
v_mul_f32 v173, v157, v173
v_mul_f32 v174, v158, v174
v_mul_f32 v175, v159, v175
v_mul_f32 v140, v140, v76
v_mul_f32 v141, v141, v77
buffer_load_dwordx4 v3, s[24:27], s37 offen offset:2048 sc1 lds
v_mul_f32 v142, v142, v78
v_mul_f32 v143, v143, v79
v_mul_f32 v172, v172, v80
v_mul_f32 v173, v173, v81
v_mul_f32 v174, v174, v82
v_mul_f32 v175, v175, v83
v_cvt_pk_bf16_f32 v124, v140, v141
v_cvt_pk_bf16_f32 v125, v142, v143
v_cvt_pk_bf16_f32 v156, v172, v173
v_cvt_pk_bf16_f32 v157, v174, v175
v_fma_f32 v128, -v60, v32, v128
v_fma_f32 v129, -v60, v33, v129
v_fma_f32 v130, -v60, v34, v130
v_fma_f32 v131, -v60, v35, v131
buffer_load_dwordx4 v3, s[24:27], s37 offen offset:3072 sc1 lds
v_fma_f32 v160, -v62, v32, v160
v_fma_f32 v161, -v62, v33, v161
v_fma_f32 v162, -v62, v34, v162
v_fma_f32 v163, -v62, v35, v163
v_mul_f32 v76, v128, v128
v_mul_f32 v77, v129, v129
v_mul_f32 v78, v130, v130
v_mul_f32 v79, v131, v131
v_mul_f32 v80, v160, v160
v_mul_f32 v81, v161, v161
v_mul_f32 v82, v162, v162
v_mul_f32 v83, v163, v163
v_fma_f32 v76, v76, v69, v68
v_fma_f32 v77, v77, v69, v68
s_add_u32 s38, s53, 4849664
s_add_u32 m0, s39, 114688
s_nop 0
buffer_load_dwordx4 v23, s[28:31], s38 offen lds
v_fma_f32 v78, v78, v69, v68
v_fma_f32 v79, v79, v69, v68
v_fma_f32 v80, v80, v73, v72
v_fma_f32 v81, v81, v73, v72
v_fma_f32 v82, v82, v73, v72
v_fma_f32 v83, v83, v73, v72
v_mul_f32 v76, v76, v128
v_mul_f32 v77, v77, v129
v_mul_f32 v78, v78, v130
v_mul_f32 v79, v79, v131
v_mul_f32 v80, v80, v160
v_mul_f32 v81, v81, v161
v_mul_f32 v82, v82, v162
v_mul_f32 v83, v83, v163
s_add_u32 m0, s39, 115712
s_nop 0
buffer_load_dwordx4 v24, s[28:31], s38 offen lds
v_exp_f32 v76, v76
v_exp_f32 v77, v77
v_exp_f32 v78, v78
v_exp_f32 v79, v79
v_exp_f32 v80, v80
v_exp_f32 v81, v81
v_exp_f32 v82, v82
v_exp_f32 v83, v83
v_fma_f32 v144, -v60, v48, v144
v_fma_f32 v145, -v60, v49, v145
v_fma_f32 v146, -v60, v50, v146
v_fma_f32 v147, -v60, v51, v147
v_fma_f32 v176, -v62, v48, v176
v_fma_f32 v177, -v62, v49, v177
s_add_u32 m0, s39, 116736
s_add_u32 s38, s38, 16384
buffer_load_dwordx4 v23, s[28:31], s38 offen lds
s_add_u32 m0, s39, 117760
s_nop 0
buffer_load_dwordx4 v24, s[28:31], s38 offen lds
s_barrier
s_add_u32 s38, s53, 4718592
s_add_u32 m0, s39, 147456
s_nop 0
buffer_load_dwordx4 v23, s[28:31], s38 offen lds
v_fma_f32 v178, -v62, v50, v178
v_fma_f32 v179, -v62, v51, v179
v_fma_f32 v76, v76, v70, v70
v_fma_f32 v77, v77, v70, v70
v_fma_f32 v78, v78, v70, v70
v_fma_f32 v79, v79, v70, v70
v_fma_f32 v80, v80, v74, v74
v_fma_f32 v81, v81, v74, v74
v_fma_f32 v82, v82, v74, v74
v_fma_f32 v83, v83, v74, v74
v_rcp_f32 v76, v76
v_rcp_f32 v77, v77
v_rcp_f32 v78, v78
v_rcp_f32 v79, v79
s_add_u32 m0, s39, 148480
s_nop 0
buffer_load_dwordx4 v24, s[28:31], s38 offen lds
v_rcp_f32 v80, v80
v_rcp_f32 v81, v81
v_rcp_f32 v82, v82
v_rcp_f32 v83, v83
v_mul_f32 v144, v128, v144
v_mul_f32 v145, v129, v145
v_mul_f32 v146, v130, v146
v_mul_f32 v147, v131, v147
v_mul_f32 v176, v160, v176
v_mul_f32 v177, v161, v177
v_mul_f32 v178, v162, v178
v_mul_f32 v179, v163, v179
v_mul_f32 v144, v144, v76
v_mul_f32 v145, v145, v77
s_add_u32 m0, s39, 149504
s_add_u32 s38, s38, 16384
buffer_load_dwordx4 v23, s[28:31], s38 offen lds
v_mul_f32 v146, v146, v78
v_mul_f32 v147, v147, v79
v_mul_f32 v176, v176, v80
v_mul_f32 v177, v177, v81
v_mul_f32 v178, v178, v82
v_mul_f32 v179, v179, v83
v_cvt_pk_bf16_f32 v126, v144, v145
v_cvt_pk_bf16_f32 v127, v146, v147
v_cvt_pk_bf16_f32 v158, v176, v177
v_cvt_pk_bf16_f32 v159, v178, v179
buffer_store_dwordx4 v[124:127], v2, s[24:27], s54 offen offset:0 sc1
buffer_store_dwordx4 v[156:159], v2, s[24:27], s54 offen offset:1024 sc1
v_fma_f32 v132, -v60, v36, v132
v_fma_f32 v133, -v60, v37, v133
s_add_u32 m0, s39, 150528
s_nop 0
buffer_load_dwordx4 v24, s[28:31], s38 offen lds
v_fma_f32 v134, -v60, v38, v134
v_fma_f32 v135, -v60, v39, v135
v_fma_f32 v164, -v62, v36, v164
v_fma_f32 v165, -v62, v37, v165
v_fma_f32 v166, -v62, v38, v166
v_fma_f32 v167, -v62, v39, v167
v_mul_f32 v76, v132, v132
v_mul_f32 v77, v133, v133
v_mul_f32 v78, v134, v134
v_mul_f32 v79, v135, v135
v_mul_f32 v80, v164, v164
v_mul_f32 v81, v165, v165
v_mul_f32 v82, v166, v166
v_mul_f32 v83, v167, v167
s_add_u32 s37, s52, 622592
s_add_u32 m0, s39, 131072
s_nop 0
buffer_load_dwordx4 v3, s[24:27], s37 offen sc1 lds
v_fma_f32 v76, v76, v69, v68
v_fma_f32 v77, v77, v69, v68
v_fma_f32 v78, v78, v69, v68
v_fma_f32 v79, v79, v69, v68
v_fma_f32 v80, v80, v73, v72
v_fma_f32 v81, v81, v73, v72
v_fma_f32 v82, v82, v73, v72
v_fma_f32 v83, v83, v73, v72
v_mul_f32 v76, v76, v132
v_mul_f32 v77, v77, v133
v_mul_f32 v78, v78, v134
v_mul_f32 v79, v79, v135
v_mul_f32 v80, v80, v164
v_mul_f32 v81, v81, v165
buffer_load_dwordx4 v3, s[24:27], s37 offen offset:1024 sc1 lds
v_mul_f32 v82, v82, v166
v_mul_f32 v83, v83, v167
v_exp_f32 v76, v76
v_exp_f32 v77, v77
v_exp_f32 v78, v78
v_exp_f32 v79, v79
v_exp_f32 v80, v80
v_exp_f32 v81, v81
v_exp_f32 v82, v82
v_exp_f32 v83, v83
v_fma_f32 v148, -v60, v52, v148
v_fma_f32 v149, -v60, v53, v149
v_fma_f32 v150, -v60, v54, v150
v_fma_f32 v151, -v60, v55, v151
buffer_load_dwordx4 v3, s[24:27], s37 offen offset:2048 sc1 lds
v_fma_f32 v180, -v62, v52, v180
v_fma_f32 v181, -v62, v53, v181
v_fma_f32 v182, -v62, v54, v182
v_fma_f32 v183, -v62, v55, v183
v_fma_f32 v76, v76, v70, v70
v_fma_f32 v77, v77, v70, v70
v_fma_f32 v78, v78, v70, v70
v_fma_f32 v79, v79, v70, v70
v_fma_f32 v80, v80, v74, v74
v_fma_f32 v81, v81, v74, v74
v_fma_f32 v82, v82, v74, v74
v_fma_f32 v83, v83, v74, v74
v_rcp_f32 v76, v76
v_rcp_f32 v77, v77
buffer_load_dwordx4 v3, s[24:27], s37 offen offset:3072 sc1 lds
v_rcp_f32 v78, v78
v_rcp_f32 v79, v79
v_rcp_f32 v80, v80
v_rcp_f32 v81, v81
v_rcp_f32 v82, v82
v_rcp_f32 v83, v83
v_mul_f32 v148, v132, v148
v_mul_f32 v149, v133, v149
v_mul_f32 v150, v134, v150
v_mul_f32 v151, v135, v151
v_mul_f32 v180, v164, v180
v_mul_f32 v181, v165, v181
v_mul_f32 v182, v166, v182
v_mul_f32 v183, v167, v183
s_add_u32 s38, s53, 4980736
s_add_u32 m0, s39, 0
s_nop 0
buffer_load_dwordx4 v23, s[28:31], s38 offen lds
v_mul_f32 v148, v148, v76
v_mul_f32 v149, v149, v77
v_mul_f32 v150, v150, v78
v_mul_f32 v151, v151, v79
v_mul_f32 v180, v180, v80
v_mul_f32 v181, v181, v81
v_mul_f32 v182, v182, v82
v_mul_f32 v183, v183, v83
v_cvt_pk_bf16_f32 v132, v148, v149
v_cvt_pk_bf16_f32 v133, v150, v151
v_cvt_pk_bf16_f32 v164, v180, v181
v_cvt_pk_bf16_f32 v165, v182, v183
v_fma_f32 v136, -v60, v40, v136
v_fma_f32 v137, -v60, v41, v137
s_add_u32 m0, s39, 1024
s_nop 0
buffer_load_dwordx4 v24, s[28:31], s38 offen lds
v_fma_f32 v138, -v60, v42, v138
v_fma_f32 v139, -v60, v43, v139
v_fma_f32 v168, -v62, v40, v168
v_fma_f32 v169, -v62, v41, v169
v_fma_f32 v170, -v62, v42, v170
v_fma_f32 v171, -v62, v43, v171
v_mul_f32 v76, v136, v136
v_mul_f32 v77, v137, v137
v_mul_f32 v78, v138, v138
v_mul_f32 v79, v139, v139
v_mul_f32 v80, v168, v168
v_mul_f32 v81, v169, v169
v_mul_f32 v82, v170, v170
v_mul_f32 v83, v171, v171
s_add_u32 m0, s39, 2048
s_add_u32 s38, s38, 16384
buffer_load_dwordx4 v23, s[28:31], s38 offen lds
s_add_u32 m0, s39, 3072
s_nop 0
buffer_load_dwordx4 v24, s[28:31], s38 offen lds
s_barrier
s_add_u32 s37, s52, 638976
s_add_u32 m0, s39, 16384
s_nop 0
buffer_load_dwordx4 v3, s[24:27], s37 offen sc1 lds
v_fma_f32 v76, v76, v69, v68
v_fma_f32 v77, v77, v69, v68
v_fma_f32 v78, v78, v69, v68
v_fma_f32 v79, v79, v69, v68
v_fma_f32 v80, v80, v73, v72
v_fma_f32 v81, v81, v73, v72
v_fma_f32 v82, v82, v73, v72
v_fma_f32 v83, v83, v73, v72
v_mul_f32 v76, v76, v136
v_mul_f32 v77, v77, v137
v_mul_f32 v78, v78, v138
v_mul_f32 v79, v79, v139
v_mul_f32 v80, v80, v168
v_mul_f32 v81, v81, v169
v_mul_f32 v82, v82, v170
v_mul_f32 v83, v83, v171
v_exp_f32 v76, v76
v_exp_f32 v77, v77
v_exp_f32 v78, v78
v_exp_f32 v79, v79
v_exp_f32 v80, v80
v_exp_f32 v81, v81
v_exp_f32 v82, v82
buffer_load_dwordx4 v3, s[24:27], s37 offen offset:1024 sc1 lds
v_exp_f32 v83, v83
v_fma_f32 v152, -v60, v56, v152
v_fma_f32 v153, -v60, v57, v153
v_fma_f32 v154, -v60, v58, v154
v_fma_f32 v155, -v60, v59, v155
v_fma_f32 v184, -v62, v56, v184
v_fma_f32 v185, -v62, v57, v185
v_fma_f32 v186, -v62, v58, v186
v_fma_f32 v187, -v62, v59, v187
v_fma_f32 v76, v76, v70, v70
v_fma_f32 v77, v77, v70, v70
v_fma_f32 v78, v78, v70, v70
v_fma_f32 v79, v79, v70, v70
v_fma_f32 v80, v80, v74, v74
v_fma_f32 v81, v81, v74, v74
v_fma_f32 v82, v82, v74, v74
v_fma_f32 v83, v83, v74, v74
v_rcp_f32 v76, v76
v_rcp_f32 v77, v77
v_rcp_f32 v78, v78
v_rcp_f32 v79, v79
v_rcp_f32 v80, v80
v_rcp_f32 v81, v81
buffer_load_dwordx4 v3, s[24:27], s37 offen offset:2048 sc1 lds
v_rcp_f32 v82, v82
v_rcp_f32 v83, v83
v_mul_f32 v152, v136, v152
v_mul_f32 v153, v137, v153
v_mul_f32 v154, v138, v154
v_mul_f32 v155, v139, v155
v_mul_f32 v184, v168, v184
v_mul_f32 v185, v169, v185
v_mul_f32 v186, v170, v186
v_mul_f32 v187, v171, v187
v_mul_f32 v152, v152, v76
v_mul_f32 v153, v153, v77
v_mul_f32 v154, v154, v78
v_mul_f32 v155, v155, v79
v_mul_f32 v184, v184, v80
v_mul_f32 v185, v185, v81
v_mul_f32 v186, v186, v82
v_mul_f32 v187, v187, v83
v_cvt_pk_bf16_f32 v134, v152, v153
v_cvt_pk_bf16_f32 v135, v154, v155
v_cvt_pk_bf16_f32 v166, v184, v185
v_cvt_pk_bf16_f32 v167, v186, v187
buffer_store_dwordx4 v[132:135], v2, s[24:27], s55 offen offset:0 sc1
buffer_store_dwordx4 v[164:167], v2, s[24:27], s55 offen offset:1024 sc1
buffer_load_dwordx4 v3, s[24:27], s37 offen offset:3072 sc1 lds
v_mul_f32 v70, v65, v65
v_mul_f32 v68, 0xc0135761, v65
v_mul_f32 v69, 0xbdd2d3e8, v65
v_mul_f32 v69, v69, v70
v_rcp_f32 v70, v70
v_mul_f32 v74, v67, v67
v_mul_f32 v72, 0xc0135761, v67
v_mul_f32 v73, 0xbdd2d3e8, v67
v_mul_f32 v73, v73, v74
v_rcp_f32 v74, v74
v_fma_f32 v188, -v64, v28, v188
v_fma_f32 v189, -v64, v29, v189
v_fma_f32 v190, -v64, v30, v190
v_fma_f32 v191, -v64, v31, v191
v_fma_f32 v220, -v66, v28, v220
v_fma_f32 v221, -v66, v29, v221
v_fma_f32 v222, -v66, v30, v222
v_fma_f32 v223, -v66, v31, v223
v_mul_f32 v76, v188, v188
v_mul_f32 v77, v189, v189
v_mul_f32 v78, v190, v190
v_mul_f32 v79, v191, v191
v_mul_f32 v80, v220, v220
s_add_u32 s38, s53, 5111808
s_add_u32 m0, s39, 32768
s_nop 0
buffer_load_dwordx4 v23, s[28:31], s38 offen lds
v_mul_f32 v81, v221, v221
v_mul_f32 v82, v222, v222
v_mul_f32 v83, v223, v223
v_fma_f32 v76, v76, v69, v68
v_fma_f32 v77, v77, v69, v68
v_fma_f32 v78, v78, v69, v68
v_fma_f32 v79, v79, v69, v68
v_fma_f32 v80, v80, v73, v72
v_fma_f32 v81, v81, v73, v72
v_fma_f32 v82, v82, v73, v72
v_fma_f32 v83, v83, v73, v72
v_mul_f32 v76, v76, v188
v_mul_f32 v77, v77, v189
v_mul_f32 v78, v78, v190
v_mul_f32 v79, v79, v191
v_mul_f32 v80, v80, v220
v_mul_f32 v81, v81, v221
v_mul_f32 v82, v82, v222
v_mul_f32 v83, v83, v223
v_exp_f32 v76, v76
v_exp_f32 v77, v77
v_exp_f32 v78, v78
v_exp_f32 v79, v79
s_add_u32 m0, s39, 33792
s_nop 0
buffer_load_dwordx4 v24, s[28:31], s38 offen lds
v_exp_f32 v80, v80
v_exp_f32 v81, v81
v_exp_f32 v82, v82
v_exp_f32 v83, v83
v_fma_f32 v204, -v64, v44, v204
v_fma_f32 v205, -v64, v45, v205
v_fma_f32 v206, -v64, v46, v206
v_fma_f32 v207, -v64, v47, v207
v_fma_f32 v236, -v66, v44, v236
v_fma_f32 v237, -v66, v45, v237
v_fma_f32 v238, -v66, v46, v238
v_fma_f32 v239, -v66, v47, v239
v_fma_f32 v76, v76, v70, v70
v_fma_f32 v77, v77, v70, v70
v_fma_f32 v78, v78, v70, v70
v_fma_f32 v79, v79, v70, v70
v_fma_f32 v80, v80, v74, v74
v_fma_f32 v81, v81, v74, v74
v_fma_f32 v82, v82, v74, v74
v_fma_f32 v83, v83, v74, v74
v_rcp_f32 v76, v76
v_rcp_f32 v77, v77
v_rcp_f32 v78, v78
v_rcp_f32 v79, v79
s_add_u32 m0, s39, 34816
s_add_u32 s38, s38, 16384
buffer_load_dwordx4 v23, s[28:31], s38 offen lds
s_add_u32 m0, s39, 35840
s_nop 0
buffer_load_dwordx4 v24, s[28:31], s38 offen lds
s_waitcnt vmcnt(18)
s_barrier
s_add_u32 s37, s52, 655360
s_add_u32 m0, s39, 49152
s_nop 0
buffer_load_dwordx4 v3, s[24:27], s37 offen sc1 lds
v_rcp_f32 v80, v80
v_rcp_f32 v81, v81
v_rcp_f32 v82, v82
v_rcp_f32 v83, v83
v_mul_f32 v204, v188, v204
v_mul_f32 v205, v189, v205
v_mul_f32 v206, v190, v206
v_mul_f32 v207, v191, v207
v_mul_f32 v236, v220, v236
v_mul_f32 v237, v221, v237
v_mul_f32 v238, v222, v238
v_mul_f32 v239, v223, v239
v_mul_f32 v204, v204, v76
v_mul_f32 v205, v205, v77
v_mul_f32 v206, v206, v78
v_mul_f32 v207, v207, v79
v_mul_f32 v236, v236, v80
v_mul_f32 v237, v237, v81
v_mul_f32 v238, v238, v82
v_mul_f32 v239, v239, v83
v_cvt_pk_bf16_f32 v188, v204, v205
v_cvt_pk_bf16_f32 v189, v206, v207
v_cvt_pk_bf16_f32 v220, v236, v237
buffer_load_dwordx4 v3, s[24:27], s37 offen offset:1024 sc1 lds
v_cvt_pk_bf16_f32 v221, v238, v239
v_fma_f32 v192, -v64, v32, v192
v_fma_f32 v193, -v64, v33, v193
v_fma_f32 v194, -v64, v34, v194
v_fma_f32 v195, -v64, v35, v195
v_fma_f32 v224, -v66, v32, v224
v_fma_f32 v225, -v66, v33, v225
v_fma_f32 v226, -v66, v34, v226
v_fma_f32 v227, -v66, v35, v227
v_mul_f32 v76, v192, v192
v_mul_f32 v77, v193, v193
v_mul_f32 v78, v194, v194
v_mul_f32 v79, v195, v195
v_mul_f32 v80, v224, v224
v_mul_f32 v81, v225, v225
v_mul_f32 v82, v226, v226
v_mul_f32 v83, v227, v227
v_fma_f32 v76, v76, v69, v68
v_fma_f32 v77, v77, v69, v68
v_fma_f32 v78, v78, v69, v68
v_fma_f32 v79, v79, v69, v68
v_fma_f32 v80, v80, v73, v72
v_fma_f32 v81, v81, v73, v72
buffer_load_dwordx4 v3, s[24:27], s37 offen offset:2048 sc1 lds
v_fma_f32 v82, v82, v73, v72
v_fma_f32 v83, v83, v73, v72
v_mul_f32 v76, v76, v192
v_mul_f32 v77, v77, v193
v_mul_f32 v78, v78, v194
v_mul_f32 v79, v79, v195
v_mul_f32 v80, v80, v224
v_mul_f32 v81, v81, v225
v_mul_f32 v82, v82, v226
v_mul_f32 v83, v83, v227
v_exp_f32 v76, v76
v_exp_f32 v77, v77
v_exp_f32 v78, v78
v_exp_f32 v79, v79
v_exp_f32 v80, v80
v_exp_f32 v81, v81
v_exp_f32 v82, v82
v_exp_f32 v83, v83
v_fma_f32 v208, -v64, v48, v208
v_fma_f32 v209, -v64, v49, v209
v_fma_f32 v210, -v64, v50, v210
v_fma_f32 v211, -v64, v51, v211
v_fma_f32 v240, -v66, v48, v240
v_fma_f32 v241, -v66, v49, v241
buffer_load_dwordx4 v3, s[24:27], s37 offen offset:3072 sc1 lds
v_fma_f32 v242, -v66, v50, v242
v_fma_f32 v243, -v66, v51, v243
v_fma_f32 v76, v76, v70, v70
v_fma_f32 v77, v77, v70, v70
v_fma_f32 v78, v78, v70, v70
v_fma_f32 v79, v79, v70, v70
v_fma_f32 v80, v80, v74, v74
v_fma_f32 v81, v81, v74, v74
v_fma_f32 v82, v82, v74, v74
v_fma_f32 v83, v83, v74, v74
v_rcp_f32 v76, v76
v_rcp_f32 v77, v77
v_rcp_f32 v78, v78
v_rcp_f32 v79, v79
v_rcp_f32 v80, v80
v_rcp_f32 v81, v81
v_rcp_f32 v82, v82
v_rcp_f32 v83, v83
v_mul_f32 v208, v192, v208
v_mul_f32 v209, v193, v209
v_mul_f32 v210, v194, v210
v_mul_f32 v211, v195, v211
v_mul_f32 v240, v224, v240
s_add_u32 s38, s53, 5242880
s_add_u32 m0, s39, 65536
s_nop 0
buffer_load_dwordx4 v23, s[28:31], s38 offen lds
v_mul_f32 v241, v225, v241
v_mul_f32 v242, v226, v242
v_mul_f32 v243, v227, v243
v_mul_f32 v208, v208, v76
v_mul_f32 v209, v209, v77
v_mul_f32 v210, v210, v78
v_mul_f32 v211, v211, v79
v_mul_f32 v240, v240, v80
v_mul_f32 v241, v241, v81
v_mul_f32 v242, v242, v82
v_mul_f32 v243, v243, v83
v_cvt_pk_bf16_f32 v190, v208, v209
v_cvt_pk_bf16_f32 v191, v210, v211
v_cvt_pk_bf16_f32 v222, v240, v241
v_cvt_pk_bf16_f32 v223, v242, v243
buffer_store_dwordx4 v[188:191], v2, s[24:27], s54 offen offset:2048 sc1
buffer_store_dwordx4 v[220:223], v2, s[24:27], s54 offen offset:3072 sc1
v_fma_f32 v196, -v64, v36, v196
v_fma_f32 v197, -v64, v37, v197
v_fma_f32 v198, -v64, v38, v198
v_fma_f32 v199, -v64, v39, v199
v_fma_f32 v228, -v66, v36, v228
v_fma_f32 v229, -v66, v37, v229
s_add_u32 m0, s39, 66560
s_nop 0
buffer_load_dwordx4 v24, s[28:31], s38 offen lds
v_fma_f32 v230, -v66, v38, v230
v_fma_f32 v231, -v66, v39, v231
v_mul_f32 v76, v196, v196
v_mul_f32 v77, v197, v197
v_mul_f32 v78, v198, v198
v_mul_f32 v79, v199, v199
v_mul_f32 v80, v228, v228
v_mul_f32 v81, v229, v229
v_mul_f32 v82, v230, v230
v_mul_f32 v83, v231, v231
v_fma_f32 v76, v76, v69, v68
v_fma_f32 v77, v77, v69, v68
v_fma_f32 v78, v78, v69, v68
v_fma_f32 v79, v79, v69, v68
v_fma_f32 v80, v80, v73, v72
v_fma_f32 v81, v81, v73, v72
v_fma_f32 v82, v82, v73, v72
v_fma_f32 v83, v83, v73, v72
v_mul_f32 v76, v76, v196
v_mul_f32 v77, v77, v197
v_mul_f32 v78, v78, v198
v_mul_f32 v79, v79, v199
v_mul_f32 v80, v80, v228
v_mul_f32 v81, v81, v229
s_branch Lov_17
.p2align 12
.fill 128, 4, 0xbf800000
Lst_17_0:
s_branch Lwr_185
s_nop 0
s_nop 0
Lov_17:
s_add_u32 m0, s39, 67584
s_add_u32 s38, s38, 16384
buffer_load_dwordx4 v23, s[28:31], s38 offen lds
s_add_u32 m0, s39, 68608
s_nop 0
buffer_load_dwordx4 v24, s[28:31], s38 offen lds
s_waitcnt vmcnt(34)
s_barrier
s_add_u32 s37, s52, 671744
s_add_u32 m0, s39, 81920
s_nop 0
buffer_load_dwordx4 v3, s[24:27], s37 offen sc1 lds
v_mul_f32 v82, v82, v230
v_mul_f32 v83, v83, v231
v_exp_f32 v76, v76
v_exp_f32 v77, v77
v_exp_f32 v78, v78
v_exp_f32 v79, v79
v_exp_f32 v80, v80
v_exp_f32 v81, v81
v_exp_f32 v82, v82
v_exp_f32 v83, v83
v_fma_f32 v212, -v64, v52, v212
v_fma_f32 v213, -v64, v53, v213
v_fma_f32 v214, -v64, v54, v214
v_fma_f32 v215, -v64, v55, v215
v_fma_f32 v244, -v66, v52, v244
v_fma_f32 v245, -v66, v53, v245
v_fma_f32 v246, -v66, v54, v246
v_fma_f32 v247, -v66, v55, v247
v_fma_f32 v76, v76, v70, v70
v_fma_f32 v77, v77, v70, v70
v_fma_f32 v78, v78, v70, v70
v_fma_f32 v79, v79, v70, v70
v_fma_f32 v80, v80, v74, v74
buffer_load_dwordx4 v3, s[24:27], s37 offen offset:1024 sc1 lds
v_fma_f32 v81, v81, v74, v74
v_fma_f32 v82, v82, v74, v74
v_fma_f32 v83, v83, v74, v74
v_rcp_f32 v76, v76
v_rcp_f32 v77, v77
v_rcp_f32 v78, v78
v_rcp_f32 v79, v79
v_rcp_f32 v80, v80
v_rcp_f32 v81, v81
v_rcp_f32 v82, v82
v_rcp_f32 v83, v83
v_mul_f32 v212, v196, v212
v_mul_f32 v213, v197, v213
v_mul_f32 v214, v198, v214
v_mul_f32 v215, v199, v215
v_mul_f32 v244, v228, v244
v_mul_f32 v245, v229, v245
v_mul_f32 v246, v230, v246
v_mul_f32 v247, v231, v247
v_mul_f32 v212, v212, v76
v_mul_f32 v213, v213, v77
v_mul_f32 v214, v214, v78
v_mul_f32 v215, v215, v79
buffer_load_dwordx4 v3, s[24:27], s37 offen offset:2048 sc1 lds
v_mul_f32 v244, v244, v80
v_mul_f32 v245, v245, v81
v_mul_f32 v246, v246, v82
v_mul_f32 v247, v247, v83
v_cvt_pk_bf16_f32 v196, v212, v213
v_cvt_pk_bf16_f32 v197, v214, v215
v_cvt_pk_bf16_f32 v228, v244, v245
v_cvt_pk_bf16_f32 v229, v246, v247
v_fma_f32 v200, -v64, v40, v200
v_fma_f32 v201, -v64, v41, v201
v_fma_f32 v202, -v64, v42, v202
v_fma_f32 v203, -v64, v43, v203
v_fma_f32 v232, -v66, v40, v232
v_fma_f32 v233, -v66, v41, v233
v_fma_f32 v234, -v66, v42, v234
v_fma_f32 v235, -v66, v43, v235
v_mul_f32 v76, v200, v200
v_mul_f32 v77, v201, v201
v_mul_f32 v78, v202, v202
v_mul_f32 v79, v203, v203
v_mul_f32 v80, v232, v232
v_mul_f32 v81, v233, v233
v_mul_f32 v82, v234, v234
v_mul_f32 v83, v235, v235
buffer_load_dwordx4 v3, s[24:27], s37 offen offset:3072 sc1 lds
v_fma_f32 v76, v76, v69, v68
v_fma_f32 v77, v77, v69, v68
v_fma_f32 v78, v78, v69, v68
v_fma_f32 v79, v79, v69, v68
v_fma_f32 v80, v80, v73, v72
v_fma_f32 v81, v81, v73, v72
v_fma_f32 v82, v82, v73, v72
v_fma_f32 v83, v83, v73, v72
v_mul_f32 v76, v76, v200
v_mul_f32 v77, v77, v201
v_mul_f32 v78, v78, v202
v_mul_f32 v79, v79, v203
v_mul_f32 v80, v80, v232
v_mul_f32 v81, v81, v233
v_mul_f32 v82, v82, v234
v_mul_f32 v83, v83, v235
v_exp_f32 v76, v76
v_exp_f32 v77, v77
v_exp_f32 v78, v78
v_exp_f32 v79, v79
v_exp_f32 v80, v80
v_exp_f32 v81, v81
v_exp_f32 v82, v82
s_add_u32 s38, s53, 5373952
s_add_u32 m0, s39, 147456
s_nop 0
buffer_load_dwordx4 v23, s[28:31], s38 offen lds
v_exp_f32 v83, v83
v_fma_f32 v216, -v64, v56, v216
v_fma_f32 v217, -v64, v57, v217
v_fma_f32 v218, -v64, v58, v218
v_fma_f32 v219, -v64, v59, v219
v_fma_f32 v248, -v66, v56, v248
v_fma_f32 v249, -v66, v57, v249
v_fma_f32 v250, -v66, v58, v250
v_fma_f32 v251, -v66, v59, v251
v_fma_f32 v76, v76, v70, v70
v_fma_f32 v77, v77, v70, v70
v_fma_f32 v78, v78, v70, v70
v_fma_f32 v79, v79, v70, v70
v_fma_f32 v80, v80, v74, v74
v_fma_f32 v81, v81, v74, v74
v_fma_f32 v82, v82, v74, v74
v_fma_f32 v83, v83, v74, v74
v_rcp_f32 v76, v76
v_rcp_f32 v77, v77
v_rcp_f32 v78, v78
v_rcp_f32 v79, v79
v_rcp_f32 v80, v80
v_rcp_f32 v81, v81
s_add_u32 m0, s39, 148480
s_nop 0
buffer_load_dwordx4 v24, s[28:31], s38 offen lds
v_rcp_f32 v82, v82
v_rcp_f32 v83, v83
v_mul_f32 v216, v200, v216
v_mul_f32 v217, v201, v217
v_mul_f32 v218, v202, v218
v_mul_f32 v219, v203, v219
v_mul_f32 v248, v232, v248
v_mul_f32 v249, v233, v249
v_mul_f32 v250, v234, v250
v_mul_f32 v251, v235, v251
v_mul_f32 v216, v216, v76
v_mul_f32 v217, v217, v77
v_mul_f32 v218, v218, v78
v_mul_f32 v219, v219, v79
v_mul_f32 v248, v248, v80
v_mul_f32 v249, v249, v81
v_mul_f32 v250, v250, v82
v_mul_f32 v251, v251, v83
v_cvt_pk_bf16_f32 v198, v216, v217
v_cvt_pk_bf16_f32 v199, v218, v219
v_cvt_pk_bf16_f32 v230, v248, v249
v_cvt_pk_bf16_f32 v231, v250, v251
buffer_store_dwordx4 v[196:199], v2, s[24:27], s55 offen offset:2048 sc1
buffer_store_dwordx4 v[228:231], v2, s[24:27], s55 offen offset:3072 sc1
s_add_u32 m0, s39, 149504
s_add_u32 s38, s38, 16384
buffer_load_dwordx4 v23, s[28:31], s38 offen lds
s_add_u32 m0, s39, 150528
s_nop 0
buffer_load_dwordx4 v24, s[28:31], s38 offen lds
s_waitcnt vmcnt(30)
s_barrier
s_add_u32 s37, s52, 688128
s_add_u32 m0, s39, 98304
s_nop 0
buffer_load_dwordx4 v3, s[24:27], s37 offen sc1 lds
buffer_load_dwordx4 v3, s[24:27], s37 offen offset:1024 sc1 lds
buffer_load_dwordx4 v3, s[24:27], s37 offen offset:2048 sc1 lds
buffer_load_dwordx4 v3, s[24:27], s37 offen offset:3072 sc1 lds
s_add_u32 s38, s53, 5505024
s_add_u32 m0, s39, 114688
s_nop 0
buffer_load_dwordx4 v23, s[28:31], s38 offen lds
s_add_u32 m0, s39, 115712
s_nop 0
buffer_load_dwordx4 v24, s[28:31], s38 offen lds
s_add_u32 m0, s39, 116736
s_add_u32 s38, s38, 16384
buffer_load_dwordx4 v23, s[28:31], s38 offen lds
s_add_u32 m0, s39, 117760
s_nop 0
buffer_load_dwordx4 v24, s[28:31], s38 offen lds
s_waitcnt vmcnt(10)
s_barrier
s_cmp_eq_u32 s47, 0
s_cbranch_scc0 Lw_148
s_add_u32 s7, s34, 48
s_lshl_b32 s7, s7, 7
v_mov_b32 v26, s7
v_mov_b32 v27, 1
s_mov_b64 exec, 1
buffer_atomic_add v27, v26, s[56:59], 0 offen sc1
s_mov_b64 exec, -1
Lw_148:
s_add_u32 s37, s52, 704512
s_add_u32 m0, s39, 131072
s_nop 0
buffer_load_dwordx4 v3, s[24:27], s37 offen sc1 lds
buffer_load_dwordx4 v3, s[24:27], s37 offen offset:1024 sc1 lds
buffer_load_dwordx4 v3, s[24:27], s37 offen offset:2048 sc1 lds
buffer_load_dwordx4 v3, s[24:27], s37 offen offset:3072 sc1 lds
s_add_u32 s38, s53, 5636096
s_add_u32 m0, s39, 0
s_nop 0
buffer_load_dwordx4 v23, s[28:31], s38 offen lds
s_add_u32 m0, s39, 1024
s_nop 0
buffer_load_dwordx4 v24, s[28:31], s38 offen lds
s_add_u32 m0, s39, 2048
s_add_u32 s38, s38, 16384
buffer_load_dwordx4 v23, s[28:31], s38 offen lds
s_add_u32 m0, s39, 3072
s_nop 0
buffer_load_dwordx4 v24, s[28:31], s38 offen lds
s_waitcnt vmcnt(26)
s_barrier
s_add_u32 s38, s91, 0
s_add_u32 m0, s39, 32768
s_nop 0
buffer_load_dwordx4 v23, s[28:31], s38 offen lds
s_add_u32 m0, s39, 33792
s_nop 0
buffer_load_dwordx4 v24, s[28:31], s38 offen lds
s_add_u32 m0, s39, 34816
s_add_u32 s38, s38, 16384
buffer_load_dwordx4 v23, s[28:31], s38 offen lds
s_add_u32 m0, s39, 35840
s_nop 0
buffer_load_dwordx4 v24, s[28:31], s38 offen lds
s_waitcnt vmcnt(20)
s_barrier
s_add_u32 s38, s91, 131072
s_add_u32 m0, s39, 65536
s_nop 0
buffer_load_dwordx4 v23, s[28:31], s38 offen lds
s_add_u32 m0, s39, 66560
s_nop 0
buffer_load_dwordx4 v24, s[28:31], s38 offen lds
s_add_u32 m0, s39, 67584
s_add_u32 s38, s38, 16384
buffer_load_dwordx4 v23, s[28:31], s38 offen lds
s_add_u32 m0, s39, 68608
s_nop 0
buffer_load_dwordx4 v24, s[28:31], s38 offen lds
s_waitcnt vmcnt(16)
s_barrier
s_cmp_eq_u32 s47, 3
s_cbranch_scc0 Lw_149
s_lshl_b32 s92, s34, 7
s_add_u32 s92, s92, 28317696
s_load_dword s93, s[82:83], s92 glc
Lw_149:
s_add_u32 s38, s91, 262144
s_add_u32 m0, s39, 147456
s_nop 0
buffer_load_dwordx4 v23, s[28:31], s38 offen lds
s_add_u32 m0, s39, 148480
s_nop 0
buffer_load_dwordx4 v24, s[28:31], s38 offen lds
s_add_u32 m0, s39, 149504
s_add_u32 s38, s38, 16384
buffer_load_dwordx4 v23, s[28:31], s38 offen lds
s_add_u32 m0, s39, 150528
s_nop 0
buffer_load_dwordx4 v24, s[28:31], s38 offen lds
s_waitcnt vmcnt(12)
s_cmp_eq_u32 s47, 3
s_cbranch_scc0 Lw_150
s_mov_b32 s41, 0x40000
s_branch Lpchk_153
Lpoll_151:
s_load_dword s93, s[82:83], s92 glc
Lpchk_153:
s_waitcnt lgkmcnt(0)
s_cmp_eq_u32 s93, 16
s_cbranch_scc1 Lpok_152
s_sub_u32 s41, s41, 1
s_cmp_lg_u32 s41, 0
s_cbranch_scc1 Lpoll_151
Lpok_152:
Lw_150:
s_barrier
s_add_u32 s37, s90, 0
s_add_u32 m0, s39, 16384
s_nop 0
buffer_load_dwordx4 v3, s[24:27], s37 offen sc1 lds
buffer_load_dwordx4 v3, s[24:27], s37 offen offset:1024 sc1 lds
buffer_load_dwordx4 v3, s[24:27], s37 offen offset:2048 sc1 lds
buffer_load_dwordx4 v3, s[24:27], s37 offen offset:3072 sc1 lds
s_add_u32 s37, s90, 16384
s_add_u32 m0, s39, 49152
s_nop 0
buffer_load_dwordx4 v3, s[24:27], s37 offen sc1 lds
buffer_load_dwordx4 v3, s[24:27], s37 offen offset:1024 sc1 lds
buffer_load_dwordx4 v3, s[24:27], s37 offen offset:2048 sc1 lds
buffer_load_dwordx4 v3, s[24:27], s37 offen offset:3072 sc1 lds
s_add_u32 s37, s90, 32768
s_add_u32 m0, s39, 81920
s_nop 0
buffer_load_dwordx4 v3, s[24:27], s37 offen sc1 lds
buffer_load_dwordx4 v3, s[24:27], s37 offen offset:1024 sc1 lds
buffer_load_dwordx4 v3, s[24:27], s37 offen offset:2048 sc1 lds
buffer_load_dwordx4 v3, s[24:27], s37 offen offset:3072 sc1 lds
s_add_u32 s37, s90, 49152
s_add_u32 m0, s39, 98304
s_nop 0
buffer_load_dwordx4 v3, s[24:27], s37 offen sc1 lds
buffer_load_dwordx4 v3, s[24:27], s37 offen offset:1024 sc1 lds
buffer_load_dwordx4 v3, s[24:27], s37 offen offset:2048 sc1 lds
buffer_load_dwordx4 v3, s[24:27], s37 offen offset:3072 sc1 lds
s_add_u32 s38, s91, 393216
s_add_u32 m0, s39, 114688
s_nop 0
buffer_load_dwordx4 v23, s[28:31], s38 offen lds
s_add_u32 m0, s39, 115712
s_nop 0
buffer_load_dwordx4 v24, s[28:31], s38 offen lds
s_add_u32 m0, s39, 116736
s_add_u32 s38, s38, 16384
buffer_load_dwordx4 v23, s[28:31], s38 offen lds
s_add_u32 m0, s39, 117760
s_nop 0
buffer_load_dwordx4 v24, s[28:31], s38 offen lds
s_waitcnt vmcnt(16)
s_barrier
s_add_u32 s37, s90, 65536
s_add_u32 m0, s39, 131072
s_nop 0
buffer_load_dwordx4 v3, s[24:27], s37 offen sc1 lds
buffer_load_dwordx4 v3, s[24:27], s37 offen offset:1024 sc1 lds
buffer_load_dwordx4 v3, s[24:27], s37 offen offset:2048 sc1 lds
buffer_load_dwordx4 v3, s[24:27], s37 offen offset:3072 sc1 lds
s_add_u32 s38, s91, 524288
s_add_u32 m0, s39, 0
s_nop 0
buffer_load_dwordx4 v23, s[28:31], s38 offen lds
s_add_u32 m0, s39, 1024
s_nop 0
buffer_load_dwordx4 v24, s[28:31], s38 offen lds
s_add_u32 m0, s39, 2048
s_add_u32 s38, s38, 16384
buffer_load_dwordx4 v23, s[28:31], s38 offen lds
s_add_u32 m0, s39, 3072
s_nop 0
buffer_load_dwordx4 v24, s[28:31], s38 offen lds
s_waitcnt vmcnt(20)
s_barrier
s_add_u32 s37, s90, 81920
s_add_u32 m0, s39, 16384
s_nop 0
buffer_load_dwordx4 v3, s[24:27], s37 offen sc1 lds
buffer_load_dwordx4 v3, s[24:27], s37 offen offset:1024 sc1 lds
buffer_load_dwordx4 v3, s[24:27], s37 offen offset:2048 sc1 lds
buffer_load_dwordx4 v3, s[24:27], s37 offen offset:3072 sc1 lds
s_add_u32 s38, s91, 655360
s_add_u32 m0, s39, 32768
s_nop 0
buffer_load_dwordx4 v23, s[28:31], s38 offen lds
s_add_u32 m0, s39, 33792
s_nop 0
buffer_load_dwordx4 v24, s[28:31], s38 offen lds
s_add_u32 m0, s39, 34816
s_add_u32 s38, s38, 16384
buffer_load_dwordx4 v23, s[28:31], s38 offen lds
s_add_u32 m0, s39, 35840
s_nop 0
buffer_load_dwordx4 v24, s[28:31], s38 offen lds
s_waitcnt vmcnt(24)
s_barrier
s_add_u32 s37, s90, 98304
s_add_u32 m0, s39, 49152
s_nop 0
buffer_load_dwordx4 v3, s[24:27], s37 offen sc1 lds
buffer_load_dwordx4 v3, s[24:27], s37 offen offset:1024 sc1 lds
buffer_load_dwordx4 v3, s[24:27], s37 offen offset:2048 sc1 lds
buffer_load_dwordx4 v3, s[24:27], s37 offen offset:3072 sc1 lds
s_add_u32 s38, s91, 786432
s_add_u32 m0, s39, 65536
s_nop 0
buffer_load_dwordx4 v23, s[28:31], s38 offen lds
s_add_u32 m0, s39, 66560
s_nop 0
buffer_load_dwordx4 v24, s[28:31], s38 offen lds
s_add_u32 m0, s39, 67584
s_add_u32 s38, s38, 16384
buffer_load_dwordx4 v23, s[28:31], s38 offen lds
s_add_u32 m0, s39, 68608
s_nop 0
buffer_load_dwordx4 v24, s[28:31], s38 offen lds
s_waitcnt vmcnt(24)
s_barrier
s_add_u32 s37, s90, 114688
s_add_u32 m0, s39, 81920
s_nop 0
buffer_load_dwordx4 v3, s[24:27], s37 offen sc1 lds
buffer_load_dwordx4 v3, s[24:27], s37 offen offset:1024 sc1 lds
buffer_load_dwordx4 v3, s[24:27], s37 offen offset:2048 sc1 lds
buffer_load_dwordx4 v3, s[24:27], s37 offen offset:3072 sc1 lds
s_add_u32 s38, s91, 917504
s_add_u32 m0, s39, 147456
s_nop 0
buffer_load_dwordx4 v23, s[28:31], s38 offen lds
s_add_u32 m0, s39, 148480
s_nop 0
buffer_load_dwordx4 v24, s[28:31], s38 offen lds
s_add_u32 m0, s39, 149504
s_add_u32 s38, s38, 16384
buffer_load_dwordx4 v23, s[28:31], s38 offen lds
s_add_u32 m0, s39, 150528
s_nop 0
buffer_load_dwordx4 v24, s[28:31], s38 offen lds
s_waitcnt vmcnt(24)
s_barrier
s_add_u32 s37, s90, 131072
s_add_u32 m0, s39, 98304
s_nop 0
buffer_load_dwordx4 v3, s[24:27], s37 offen sc1 lds
buffer_load_dwordx4 v3, s[24:27], s37 offen offset:1024 sc1 lds
buffer_load_dwordx4 v3, s[24:27], s37 offen offset:2048 sc1 lds
buffer_load_dwordx4 v3, s[24:27], s37 offen offset:3072 sc1 lds
s_add_u32 s38, s91, 1048576
s_add_u32 m0, s39, 114688
s_nop 0
buffer_load_dwordx4 v23, s[28:31], s38 offen lds
s_add_u32 m0, s39, 115712
s_nop 0
buffer_load_dwordx4 v24, s[28:31], s38 offen lds
s_add_u32 m0, s39, 116736
s_add_u32 s38, s38, 16384
buffer_load_dwordx4 v23, s[28:31], s38 offen lds
s_add_u32 m0, s39, 117760
s_nop 0
buffer_load_dwordx4 v24, s[28:31], s38 offen lds
s_waitcnt vmcnt(24)
s_barrier
s_add_u32 s37, s90, 147456
s_add_u32 m0, s39, 131072
s_nop 0
buffer_load_dwordx4 v3, s[24:27], s37 offen sc1 lds
buffer_load_dwordx4 v3, s[24:27], s37 offen offset:1024 sc1 lds
buffer_load_dwordx4 v3, s[24:27], s37 offen offset:2048 sc1 lds
buffer_load_dwordx4 v3, s[24:27], s37 offen offset:3072 sc1 lds
s_add_u32 s38, s91, 1179648
s_add_u32 m0, s39, 0
s_nop 0
buffer_load_dwordx4 v23, s[28:31], s38 offen lds
s_add_u32 m0, s39, 1024
s_nop 0
buffer_load_dwordx4 v24, s[28:31], s38 offen lds
s_add_u32 m0, s39, 2048
s_add_u32 s38, s38, 16384
buffer_load_dwordx4 v23, s[28:31], s38 offen lds
s_add_u32 m0, s39, 3072
s_nop 0
buffer_load_dwordx4 v24, s[28:31], s38 offen lds
s_waitcnt vmcnt(24)
s_barrier
s_mov_b32 s37, 327680
s_add_u32 m0, s39, 16384
s_nop 0
buffer_load_dwordx4 v3, s[24:27], s37 offen sc1 lds
buffer_load_dwordx4 v3, s[24:27], s37 offen offset:1024 sc1 lds
buffer_load_dwordx4 v3, s[24:27], s37 offen offset:2048 sc1 lds
buffer_load_dwordx4 v3, s[24:27], s37 offen offset:3072 sc1 lds
s_mov_b32 s38, 2621440
s_add_u32 m0, s51, 32768
s_nop 0
buffer_load_dwordx4 v25, s[28:31], s38 offen lds
s_add_u32 m0, s51, 33792
s_add_u32 s38, s38, 16384
buffer_load_dwordx4 v25, s[28:31], s38 offen lds
s_waitcnt vmcnt(22)
s_barrier
s_mov_b32 s37, 344064
s_add_u32 m0, s39, 49152
s_nop 0
buffer_load_dwordx4 v3, s[24:27], s37 offen sc1 lds
buffer_load_dwordx4 v3, s[24:27], s37 offen offset:1024 sc1 lds
buffer_load_dwordx4 v3, s[24:27], s37 offen offset:2048 sc1 lds
buffer_load_dwordx4 v3, s[24:27], s37 offen offset:3072 sc1 lds
s_mov_b32 s38, 2752512
s_add_u32 m0, s51, 65536
s_nop 0
buffer_load_dwordx4 v25, s[28:31], s38 offen lds
s_add_u32 m0, s51, 66560
s_add_u32 s38, s38, 16384
buffer_load_dwordx4 v25, s[28:31], s38 offen lds
s_waitcnt vmcnt(20)
s_barrier
s_mov_b32 s37, 360448
s_add_u32 m0, s39, 81920
s_nop 0
buffer_load_dwordx4 v3, s[24:27], s37 offen sc1 lds
buffer_load_dwordx4 v3, s[24:27], s37 offen offset:1024 sc1 lds
buffer_load_dwordx4 v3, s[24:27], s37 offen offset:2048 sc1 lds
buffer_load_dwordx4 v3, s[24:27], s37 offen offset:3072 sc1 lds
s_mov_b32 s38, 2883584
s_add_u32 m0, s51, 147456
s_nop 0
buffer_load_dwordx4 v25, s[28:31], s38 offen lds
s_add_u32 m0, s51, 148480
s_add_u32 s38, s38, 16384
buffer_load_dwordx4 v25, s[28:31], s38 offen lds
s_waitcnt vmcnt(18)
s_barrier
s_mov_b32 s37, 376832
s_add_u32 m0, s39, 98304
s_nop 0
buffer_load_dwordx4 v3, s[24:27], s37 offen sc1 lds
buffer_load_dwordx4 v3, s[24:27], s37 offen offset:1024 sc1 lds
buffer_load_dwordx4 v3, s[24:27], s37 offen offset:2048 sc1 lds
buffer_load_dwordx4 v3, s[24:27], s37 offen offset:3072 sc1 lds
s_mov_b32 s38, 3014656
s_add_u32 m0, s51, 114688
s_nop 0
buffer_load_dwordx4 v25, s[28:31], s38 offen lds
s_add_u32 m0, s51, 115712
s_add_u32 s38, s38, 16384
buffer_load_dwordx4 v25, s[28:31], s38 offen lds
s_waitcnt vmcnt(18)
s_barrier
s_mov_b32 s37, 393216
s_add_u32 m0, s39, 131072
s_nop 0
buffer_load_dwordx4 v3, s[24:27], s37 offen sc1 lds
buffer_load_dwordx4 v3, s[24:27], s37 offen offset:1024 sc1 lds
buffer_load_dwordx4 v3, s[24:27], s37 offen offset:2048 sc1 lds
buffer_load_dwordx4 v3, s[24:27], s37 offen offset:3072 sc1 lds
s_mov_b32 s38, 3145728
s_add_u32 m0, s51, 0
s_nop 0
buffer_load_dwordx4 v25, s[28:31], s38 offen lds
s_add_u32 m0, s51, 1024
s_add_u32 s38, s38, 16384
buffer_load_dwordx4 v25, s[28:31], s38 offen lds
s_waitcnt vmcnt(18)
s_barrier
s_mov_b32 s37, 409600
s_add_u32 m0, s39, 16384
s_nop 0
buffer_load_dwordx4 v3, s[24:27], s37 offen sc1 lds
buffer_load_dwordx4 v3, s[24:27], s37 offen offset:1024 sc1 lds
buffer_load_dwordx4 v3, s[24:27], s37 offen offset:2048 sc1 lds
buffer_load_dwordx4 v3, s[24:27], s37 offen offset:3072 sc1 lds
s_mov_b32 s38, 3276800
s_add_u32 m0, s51, 32768
s_nop 0
buffer_load_dwordx4 v25, s[28:31], s38 offen lds
s_add_u32 m0, s51, 33792
s_branch Lov_18
.p2align 12
.fill 144, 4, 0xbf800000
Lst_18_0:
s_branch Lwr_186
s_nop 0
s_nop 0
Lov_18:
s_add_u32 s38, s38, 16384
buffer_load_dwordx4 v25, s[28:31], s38 offen lds
s_waitcnt vmcnt(18)
s_barrier
s_mov_b32 s37, 425984
s_add_u32 m0, s39, 49152
s_nop 0
buffer_load_dwordx4 v3, s[24:27], s37 offen sc1 lds
buffer_load_dwordx4 v3, s[24:27], s37 offen offset:1024 sc1 lds
buffer_load_dwordx4 v3, s[24:27], s37 offen offset:2048 sc1 lds
buffer_load_dwordx4 v3, s[24:27], s37 offen offset:3072 sc1 lds
s_mov_b32 s38, 3407872
s_add_u32 m0, s51, 65536
s_nop 0
buffer_load_dwordx4 v25, s[28:31], s38 offen lds
s_add_u32 m0, s51, 66560
s_add_u32 s38, s38, 16384
buffer_load_dwordx4 v25, s[28:31], s38 offen lds
s_waitcnt vmcnt(18)
s_barrier
s_mov_b32 s37, 442368
s_add_u32 m0, s39, 81920
s_nop 0
buffer_load_dwordx4 v3, s[24:27], s37 offen sc1 lds
buffer_load_dwordx4 v3, s[24:27], s37 offen offset:1024 sc1 lds
buffer_load_dwordx4 v3, s[24:27], s37 offen offset:2048 sc1 lds
buffer_load_dwordx4 v3, s[24:27], s37 offen offset:3072 sc1 lds
s_mov_b32 s38, 3538944
s_add_u32 m0, s51, 147456
s_nop 0
buffer_load_dwordx4 v25, s[28:31], s38 offen lds
s_add_u32 m0, s51, 148480
s_add_u32 s38, s38, 16384
buffer_load_dwordx4 v25, s[28:31], s38 offen lds
s_waitcnt vmcnt(18)
s_barrier
s_mov_b32 s37, 458752
s_add_u32 m0, s39, 98304
s_nop 0
buffer_load_dwordx4 v3, s[24:27], s37 offen sc1 lds
buffer_load_dwordx4 v3, s[24:27], s37 offen offset:1024 sc1 lds
buffer_load_dwordx4 v3, s[24:27], s37 offen offset:2048 sc1 lds
buffer_load_dwordx4 v3, s[24:27], s37 offen offset:3072 sc1 lds
s_mov_b32 s38, 3670016
s_add_u32 m0, s51, 114688
s_nop 0
buffer_load_dwordx4 v25, s[28:31], s38 offen lds
s_add_u32 m0, s51, 115712
s_add_u32 s38, s38, 16384
buffer_load_dwordx4 v25, s[28:31], s38 offen lds
s_waitcnt vmcnt(18)
s_barrier
s_mov_b32 s37, 475136
s_add_u32 m0, s39, 131072
s_nop 0
buffer_load_dwordx4 v3, s[24:27], s37 offen sc1 lds
buffer_load_dwordx4 v3, s[24:27], s37 offen offset:1024 sc1 lds
buffer_load_dwordx4 v3, s[24:27], s37 offen offset:2048 sc1 lds
buffer_load_dwordx4 v3, s[24:27], s37 offen offset:3072 sc1 lds
s_mov_b32 s38, 3801088
s_add_u32 m0, s51, 0
s_nop 0
buffer_load_dwordx4 v25, s[28:31], s38 offen lds
s_add_u32 m0, s51, 1024
s_add_u32 s38, s38, 16384
buffer_load_dwordx4 v25, s[28:31], s38 offen lds
s_waitcnt vmcnt(18)
s_barrier
s_cmp_eq_u32 s47, 0
s_cbranch_scc0 Lw_154
s_xor_b32 s43, s2, 2
s_add_u32 s43, s43, 128
s_lshl_b32 s43, s43, 7
v_mov_b32 v26, s43
v_mov_b32 v27, 1
s_mov_b64 exec, 1
buffer_store_dword v27, v26, s[56:59], 0 offen sc1
s_mov_b64 exec, -1
Lw_154:
s_mov_b32 s37, 491520
s_add_u32 m0, s39, 16384
s_nop 0
buffer_load_dwordx4 v3, s[24:27], s37 offen sc1 lds
buffer_load_dwordx4 v3, s[24:27], s37 offen offset:1024 sc1 lds
buffer_load_dwordx4 v3, s[24:27], s37 offen offset:2048 sc1 lds
buffer_load_dwordx4 v3, s[24:27], s37 offen offset:3072 sc1 lds
s_mov_b32 s38, 3932160
s_add_u32 m0, s51, 32768
s_nop 0
buffer_load_dwordx4 v25, s[28:31], s38 offen lds
s_add_u32 m0, s51, 33792
s_add_u32 s38, s38, 16384
buffer_load_dwordx4 v25, s[28:31], s38 offen lds
s_waitcnt vmcnt(18)
s_barrier
s_mov_b32 s37, 507904
s_add_u32 m0, s39, 49152
s_nop 0
buffer_load_dwordx4 v3, s[24:27], s37 offen sc1 lds
buffer_load_dwordx4 v3, s[24:27], s37 offen offset:1024 sc1 lds
buffer_load_dwordx4 v3, s[24:27], s37 offen offset:2048 sc1 lds
buffer_load_dwordx4 v3, s[24:27], s37 offen offset:3072 sc1 lds
s_mov_b32 s38, 4063232
s_add_u32 m0, s51, 65536
s_nop 0
buffer_load_dwordx4 v25, s[28:31], s38 offen lds
s_add_u32 m0, s51, 66560
s_add_u32 s38, s38, 16384
buffer_load_dwordx4 v25, s[28:31], s38 offen lds
s_waitcnt vmcnt(18)
s_barrier
s_cmp_eq_u32 s47, 3
s_cbranch_scc0 Lw_155
s_lshl_b32 s92, s2, 7
s_add_u32 s92, s92, 28327936
s_load_dword s93, s[82:83], s92 glc
Lw_155:
s_waitcnt vmcnt(12)
s_cmp_eq_u32 s47, 3
s_cbranch_scc0 Lw_156
s_mov_b32 s41, 0x40000
s_branch Lpchk_159
Lpoll_157:
s_load_dword s93, s[82:83], s92 glc
Lpchk_159:
s_waitcnt lgkmcnt(0)
s_cmp_eq_u32 s93, 1
s_cbranch_scc1 Lpok_158
s_sub_u32 s41, s41, 1
s_cmp_lg_u32 s41, 0
s_cbranch_scc1 Lpoll_157
Lpok_158:
Lw_156:
s_barrier
s_waitcnt vmcnt(6)
s_barrier
s_waitcnt vmcnt(0)
s_barrier
s_barrier
s_branch Ldone_1
Ldone_1:
Lfin:
Lexit_2:
s_endpgm
.fill 1024, 4, 0xbf800000
.section .rodata,"a"
.p2align 6
.amdhsa_kernel sequential_preLN__sliding_local_dilated__glu_gated_geglu__prompt_kernel
  .amdhsa_next_free_vgpr 256
  .amdhsa_next_free_sgpr 102
  .amdhsa_accum_offset 256
  .amdhsa_group_segment_fixed_size 0
  .amdhsa_kernarg_size 80
  .amdhsa_user_sgpr_count 2
  .amdhsa_user_sgpr_kernarg_segment_ptr 1
  .amdhsa_system_sgpr_workgroup_id_x 1
  .amdhsa_float_denorm_mode_32 3
  .amdhsa_float_denorm_mode_16_64 3
.end_amdhsa_kernel
```

```asm
; @launch grid=(256,1,1) block=(512,1,1) lds=163840
.amdgcn_target "amdgcn-amd-amdhsa--gfx950"
.text
.globl sequential_preLN__sliding_local_dilated__glu_gated_geglu__prompt_kernel
.p2align 8
.type sequential_preLN__sliding_local_dilated__glu_gated_geglu__prompt_kernel,@function
sequential_preLN__sliding_local_dilated__glu_gated_geglu__prompt_kernel:
s_cmp_ge_u32 s2, 256
s_cbranch_scc1 Lexit_2
s_load_dwordx16 s[64:79], s[0:1], 0
s_load_dwordx4 s[80:83], s[0:1], 64
s_and_b32 s3, s2, 7
s_lshr_b32 s42, s2, 3
s_and_b32 s34, s3, 1
s_lshl_b32 s34, s34, 3
s_and_b32 s48, s42, 7
s_add_u32 s34, s34, s48
s_lshr_b32 s35, s3, 1
s_lshr_b32 s49, s42, 3
s_lshl_b32 s35, s35, 2
s_add_u32 s35, s35, s49
v_lshrrev_b32 v12, 6, v0
v_and_b32 v1, 63, v0
v_readfirstlane_b32 s36, v12
Lbeg:
s_lshl_b32 s50, s34, 7
s_sub_u32 s50, s50, 16
v_and_b32 v12, 15, v1
v_lshrrev_b32 v13, 4, v1
s_cmp_lt_u32 s36, 4
s_cbranch_scc1 Lcons_7
Lprod_3:
s_sub_u32 s47, s36, 4
s_lshl_b32 s43, s34, 7
s_lshl_b32 s44, s35, 3
s_add_u32 s63, s43, s44
s_lshl_b32 s44, s47, 1
s_add_u32 s51, s63, s44
v_lshlrev_b32 v10, 4, v1
s_and_b32 s43, s2, 7
s_lshr_b32 s44, s43, 2
s_lshl_b32 s44, s44, 1
s_and_b32 s45, s43, 1
s_add_u32 s44, s44, s45
s_lshr_b32 s45, s2, 3
s_lshl_b32 s45, s45, 2
s_add_u32 s44, s44, s45
s_add_u32 s44, s44, 96
s_bitcmp1_b32 s43, 1
s_cselect_b32 s44, s44, 0x10000
s_cmp_lt_u32 s2, 192
s_cselect_b32 s33, s2, s44
v_lshrrev_b32 v14, 3, v1
v_and_b32 v15, 7, v1
v_lshl_add_u32 v19, v14, 6, v15
s_lshl_b32 s43, s48, 3
v_add_u32 v19, s43, v19
v_mul_u32_u24 v19, 6144, v19
s_cmp_eq_u32 s47, 3
s_cbranch_scc1 Lpf_4
v_and_b32 v16, 2, v14
v_xor_b32 v16, v15, v16
v_lshlrev_b32 v16, 4, v16
v_mul_u32_u24 v17, 6144, v14
s_lshl_b32 s43, s47, 11
v_add3_u32 v2, v17, v16, s43
v_xor_b32 v3, 64, v2
v_lshrrev_b32 v16, 1, v14
v_xor_b32 v16, v15, v16
v_lshlrev_b32 v16, 4, v16
s_lshl_b32 s43, s47, 3
s_add_u32 s43, s43, s50
v_add_u32 v17, s43, v14
s_and_b32 s44, s47, 1
s_lshl_b32 s44, s44, 6
v_add_u32 v18, 0, v17
v_max_i32 v18, 0, v18
v_lshl_add_u32 v18, v18, 11, v16
v_xor_b32 v18, s44, v18
v_mov_b32 v4, v18
v_add_u32 v18, 24, v17
v_max_i32 v18, 0, v18
v_lshl_add_u32 v18, v18, 11, v16
v_xor_b32 v18, s44, v18
v_xor_b32 v5, 64, v18
v_add_u32 v18, 48, v17
v_max_i32 v18, 0, v18
v_lshl_add_u32 v18, v18, 11, v16
v_xor_b32 v18, s44, v18
v_mov_b32 v6, v18
v_add_u32 v18, 72, v17
v_max_i32 v18, 0, v18
v_lshl_add_u32 v18, v18, 11, v16
v_xor_b32 v18, s44, v18
v_xor_b32 v7, 64, v18
v_add_u32 v18, 96, v17
v_max_i32 v18, 0, v18
v_lshl_add_u32 v18, v18, 11, v16
v_xor_b32 v18, s44, v18
v_mov_b32 v8, v18
v_add_u32 v18, 120, v17
v_max_i32 v18, 0, v18
v_lshl_add_u32 v18, v18, 11, v16
v_xor_b32 v18, s44, v18
v_xor_b32 v9, 64, v18
s_lshl_b32 s39, s47, 10
s_lshl_b32 s40, s47, 13
s_add_u32 s40, s40, 18432
s_mov_b32 s37, 0
s_mov_b32 s38, 0
s_bfm_b64 s[60:61], 56, 8
s_cmp_eq_u32 s47, 0
s_cselect_b64 s[60:61], s[60:61], -1
s_lshl_b32 s43, s35, 7
s_waitcnt lgkmcnt(0)
s_mov_b32 s8, s64
s_mov_b32 s9, s65
s_mov_b32 s10, 4194304
s_mov_b32 s11, 0x20000
s_add_u32 s12, s66, s43
s_addc_u32 s13, s67, 0
s_mov_b32 s14, 6289536
s_mov_b32 s15, 0x20000
s_mov_b32 s28, s66
s_mov_b32 s29, s67
s_mov_b32 s30, 6291456
s_mov_b32 s31, 0x20000
s_mul_i32 s43, s33, 7296
v_lshlrev_b32 v30, 7, v1
s_mul_i32 s44, s47, 2432
s_add_u32 s43, s43, s44
s_bfm_b64 exec, 19, 0
buffer_load_dword v31, v30, s[28:31], s43 offen
s_mov_b64 exec, -1
s_add_u32 m0, s39, 0
s_mov_b64 exec, s[60:61]
buffer_load_dwordx4 v4, s[8:11], s37 offen lds
s_mov_b64 exec, -1
s_add_u32 m0, s39, 3072
s_nop 0
buffer_load_dwordx4 v5, s[8:11], s37 offen lds
s_add_u32 m0, s39, 6144
s_nop 0
buffer_load_dwordx4 v6, s[8:11], s37 offen lds
s_add_u32 m0, s39, 9216
s_nop 0
buffer_load_dwordx4 v7, s[8:11], s37 offen lds
s_add_u32 m0, s39, 12288
s_nop 0
buffer_load_dwordx4 v8, s[8:11], s37 offen lds
s_add_u32 m0, s39, 15360
s_nop 0
buffer_load_dwordx4 v9, s[8:11], s37 offen lds
s_add_u32 m0, s40, 0
s_add_u32 s43, s38, 0
buffer_load_dwordx4 v2, s[12:15], s43 offen lds
s_add_u32 m0, s40, 1024
s_add_u32 s43, s38, 49152
buffer_load_dwordx4 v3, s[12:15], s43 offen lds
s_add_u32 m0, s40, 2048
s_add_u32 s43, s38, 98304
buffer_load_dwordx4 v2, s[12:15], s43 offen lds
s_add_u32 m0, s40, 3072
s_add_u32 s43, s38, 147456
buffer_load_dwordx4 v3, s[12:15], s43 offen lds
s_add_u32 m0, s40, 4096
s_add_u32 s43, s38, 196608
buffer_load_dwordx4 v2, s[12:15], s43 offen lds
s_add_u32 m0, s40, 5120
s_add_u32 s43, s38, 245760
buffer_load_dwordx4 v3, s[12:15], s43 offen lds
s_add_u32 m0, s40, 6144
s_add_u32 s43, s38, 294912
buffer_load_dwordx4 v2, s[12:15], s43 offen lds
s_add_u32 m0, s40, 7168
s_add_u32 s43, s38, 344064
buffer_load_dwordx4 v3, s[12:15], s43 offen lds
s_add_u32 s37, s37, 128
s_add_u32 s38, s38, 393216
s_lshl_b32 s43, s51, 11
buffer_load_dwordx4 v[96:99], v10, s[8:11], s43 offen offset:0
buffer_load_dwordx4 v[100:103], v10, s[8:11], s43 offen offset:1024
buffer_load_dwordx4 v[104:107], v10, s[8:11], s43 offen offset:2048
buffer_load_dwordx4 v[108:111], v10, s[8:11], s43 offen offset:3072
s_add_u32 m0, s39, 43008
s_mov_b64 exec, s[60:61]
buffer_load_dwordx4 v4, s[8:11], s37 offen lds
s_mov_b64 exec, -1
s_add_u32 m0, s39, 46080
s_nop 0
buffer_load_dwordx4 v5, s[8:11], s37 offen lds
s_add_u32 m0, s39, 49152
s_nop 0
buffer_load_dwordx4 v6, s[8:11], s37 offen lds
s_add_u32 m0, s39, 52224
s_nop 0
buffer_load_dwordx4 v7, s[8:11], s37 offen lds
s_add_u32 m0, s39, 55296
s_nop 0
buffer_load_dwordx4 v8, s[8:11], s37 offen lds
s_add_u32 m0, s39, 58368
s_nop 0
buffer_load_dwordx4 v9, s[8:11], s37 offen lds
s_add_u32 m0, s40, 43008
s_add_u32 s43, s38, 0
buffer_load_dwordx4 v2, s[12:15], s43 offen lds
s_add_u32 m0, s40, 44032
s_add_u32 s43, s38, 49152
buffer_load_dwordx4 v3, s[12:15], s43 offen lds
s_add_u32 m0, s40, 45056
s_add_u32 s43, s38, 98304
buffer_load_dwordx4 v2, s[12:15], s43 offen lds
s_add_u32 m0, s40, 46080
s_add_u32 s43, s38, 147456
buffer_load_dwordx4 v3, s[12:15], s43 offen lds
s_add_u32 m0, s40, 47104
s_add_u32 s43, s38, 196608
buffer_load_dwordx4 v2, s[12:15], s43 offen lds
s_add_u32 m0, s40, 48128
s_add_u32 s43, s38, 245760
buffer_load_dwordx4 v3, s[12:15], s43 offen lds
s_add_u32 m0, s40, 49152
s_add_u32 s43, s38, 294912
buffer_load_dwordx4 v2, s[12:15], s43 offen lds
s_add_u32 m0, s40, 50176
s_add_u32 s43, s38, 344064
buffer_load_dwordx4 v3, s[12:15], s43 offen lds
s_add_u32 s37, s37, 128
s_add_u32 s38, s38, 393216
s_waitcnt vmcnt(18)
s_barrier
s_add_u32 m0, s39, 86016
s_mov_b64 exec, s[60:61]
buffer_load_dwordx4 v4, s[8:11], s37 offen lds
s_mov_b64 exec, -1
s_add_u32 m0, s39, 89088
s_nop 0
buffer_load_dwordx4 v5, s[8:11], s37 offen lds
s_add_u32 m0, s39, 92160
s_nop 0
buffer_load_dwordx4 v6, s[8:11], s37 offen lds
s_add_u32 m0, s39, 95232
s_nop 0
buffer_load_dwordx4 v7, s[8:11], s37 offen lds
s_add_u32 m0, s39, 98304
s_nop 0
buffer_load_dwordx4 v8, s[8:11], s37 offen lds
s_add_u32 m0, s39, 101376
s_nop 0
buffer_load_dwordx4 v9, s[8:11], s37 offen lds
s_add_u32 m0, s40, 86016
s_add_u32 s43, s38, 0
buffer_load_dwordx4 v2, s[12:15], s43 offen lds
s_add_u32 m0, s40, 87040
s_add_u32 s43, s38, 49152
buffer_load_dwordx4 v3, s[12:15], s43 offen lds
s_add_u32 m0, s40, 88064
s_add_u32 s43, s38, 98304
buffer_load_dwordx4 v2, s[12:15], s43 offen lds
s_add_u32 m0, s40, 89088
s_add_u32 s43, s38, 147456
buffer_load_dwordx4 v3, s[12:15], s43 offen lds
s_add_u32 m0, s40, 90112
s_add_u32 s43, s38, 196608
buffer_load_dwordx4 v2, s[12:15], s43 offen lds
s_add_u32 m0, s40, 91136
s_add_u32 s43, s38, 245760
buffer_load_dwordx4 v3, s[12:15], s43 offen lds
s_add_u32 m0, s40, 92160
s_add_u32 s43, s38, 294912
buffer_load_dwordx4 v2, s[12:15], s43 offen lds
s_add_u32 m0, s40, 93184
s_add_u32 s43, s38, 344064
buffer_load_dwordx4 v3, s[12:15], s43 offen lds
s_add_u32 s37, s37, 128
s_add_u32 s38, s38, 393216
s_waitcnt vmcnt(28)
s_mov_b32 s43, 0x3f803f80
v_mov_b32 v116, 0
v_mov_b32 v117, 0
v_mov_b32 v118, 0
v_mov_b32 v119, 0
v_mov_b32 v120, 0
v_mov_b32 v121, 0
v_mov_b32 v122, 0
v_mov_b32 v123, 0
v_dot2_f32_bf16 v116, v96, s43, v116
v_dot2_f32_bf16 v120, v96, v96, v120
v_dot2_f32_bf16 v118, v104, s43, v118
v_dot2_f32_bf16 v122, v104, v104, v122
v_dot2_f32_bf16 v117, v97, s43, v117
v_dot2_f32_bf16 v121, v97, v97, v121
v_dot2_f32_bf16 v119, v105, s43, v119
v_dot2_f32_bf16 v123, v105, v105, v123
v_dot2_f32_bf16 v116, v98, s43, v116
v_dot2_f32_bf16 v120, v98, v98, v120
v_dot2_f32_bf16 v118, v106, s43, v118
v_dot2_f32_bf16 v122, v106, v106, v122
v_dot2_f32_bf16 v117, v99, s43, v117
v_dot2_f32_bf16 v121, v99, v99, v121
v_dot2_f32_bf16 v119, v107, s43, v119
v_dot2_f32_bf16 v123, v107, v107, v123
v_dot2_f32_bf16 v116, v100, s43, v116
v_dot2_f32_bf16 v120, v100, v100, v120
v_dot2_f32_bf16 v118, v108, s43, v118
v_dot2_f32_bf16 v122, v108, v108, v122
v_dot2_f32_bf16 v117, v101, s43, v117
v_dot2_f32_bf16 v121, v101, v101, v121
v_dot2_f32_bf16 v119, v109, s43, v119
v_dot2_f32_bf16 v123, v109, v109, v123
v_dot2_f32_bf16 v116, v102, s43, v116
v_dot2_f32_bf16 v120, v102, v102, v120
v_dot2_f32_bf16 v118, v110, s43, v118
v_dot2_f32_bf16 v122, v110, v110, v122
v_dot2_f32_bf16 v117, v103, s43, v117
v_dot2_f32_bf16 v121, v103, v103, v121
v_dot2_f32_bf16 v119, v111, s43, v119
v_dot2_f32_bf16 v123, v111, v111, v123
s_nop 2
v_add_f32 v116, v116, v117
v_add_f32 v118, v118, v119
v_add_f32 v120, v120, v121
v_add_f32 v122, v122, v123
s_nop 1
v_permlane32_swap_b32 v116, v118
v_permlane32_swap_b32 v120, v122
v_add_f32 v116, v116, v118
v_add_f32 v120, v120, v122
s_nop 1
v_permlane16_swap_b32 v116, v120
v_add_f32 v116, v116, v120
s_nop 1
v_add_f32_dpp v116, v116, v116 row_ror:8 row_mask:0xf bank_mask:0xf
s_nop 1
v_add_f32_dpp v116, v116, v116 row_ror:4 row_mask:0xf bank_mask:0xf
s_nop 1
v_add_f32_dpp v116, v116, v116 row_ror:2 row_mask:0xf bank_mask:0xf
s_nop 1
v_add_f32_dpp v116, v116, v116 row_ror:1 row_mask:0xf bank_mask:0xf
v_mov_b32 v117, v116
s_nop 1
v_permlane16_swap_b32 v116, v117
v_mul_f32 v112, 0x3a800000, v116
v_mul_f32 v113, 0x3a800000, v117
v_fma_f32 v113, -v112, v112, v113
v_max_f32 v113, 0, v113
v_add_f32 v113, 0x3727c5ac, v113
v_rsq_f32 v113, v113
v_lshrrev_b32 v11, 5, v1
s_lshl_b32 s43, s47, 4
s_add_u32 s43, s43, 148608
v_lshl_add_u32 v11, v11, 3, s43
ds_write_b64 v11, v[112:113]
s_waitcnt lgkmcnt(0)
s_and_b32 s44, s36, 3
s_mul_i32 s44, s44, 28
s_bfe_u32 s43, s2, 0x30001
s_lshl_b32 s43, s43, 7
s_add_u32 s44, s44, s43
s_mul_i32 s44, s44, 7168
s_lshr_b32 s43, s2, 4
s_lshl_b32 s43, s43, 8
s_add_u32 s43, s43, s44
s_bitcmp0_b32 s2, 0
s_cselect_b32 s4, s72, s74
s_cselect_b32 s5, s73, s75
s_add_u32 s4, s4, s43
s_addc_u32 s5, s5, 0
Lsp_8:
s_waitcnt vmcnt(14)
s_barrier
s_add_u32 m0, s39, 0
s_mov_b64 exec, s[60:61]
buffer_load_dwordx4 v4, s[8:11], s37 offen lds
s_mov_b64 exec, -1
s_add_u32 m0, s39, 3072
s_nop 0
buffer_load_dwordx4 v5, s[8:11], s37 offen lds
s_add_u32 m0, s39, 6144
s_nop 0
buffer_load_dwordx4 v6, s[8:11], s37 offen lds
s_add_u32 m0, s39, 9216
s_nop 0
buffer_load_dwordx4 v7, s[8:11], s37 offen lds
s_add_u32 m0, s39, 12288
s_nop 0
buffer_load_dwordx4 v8, s[8:11], s37 offen lds
s_add_u32 m0, s39, 15360
s_nop 0
buffer_load_dwordx4 v9, s[8:11], s37 offen lds
s_add_u32 m0, s40, 0
s_add_u32 s43, s38, 0
buffer_load_dwordx4 v2, s[12:15], s43 offen lds
s_add_u32 m0, s40, 1024
s_add_u32 s43, s38, 49152
buffer_load_dwordx4 v3, s[12:15], s43 offen lds
s_add_u32 m0, s40, 2048
s_add_u32 s43, s38, 98304
buffer_load_dwordx4 v2, s[12:15], s43 offen lds
s_add_u32 m0, s40, 3072
s_add_u32 s43, s38, 147456
buffer_load_dwordx4 v3, s[12:15], s43 offen lds
s_add_u32 m0, s40, 4096
s_add_u32 s43, s38, 196608
buffer_load_dwordx4 v2, s[12:15], s43 offen lds
s_add_u32 m0, s40, 5120
s_add_u32 s43, s38, 245760
buffer_load_dwordx4 v3, s[12:15], s43 offen lds
s_add_u32 m0, s40, 6144
s_add_u32 s43, s38, 294912
buffer_load_dwordx4 v2, s[12:15], s43 offen lds
s_add_u32 m0, s40, 7168
s_add_u32 s43, s38, 344064
buffer_load_dwordx4 v3, s[12:15], s43 offen lds
s_add_u32 s37, s37, 128
s_add_u32 s38, s38, 393216
Lsp_9:
s_waitcnt vmcnt(14)
s_barrier
s_add_u32 m0, s39, 43008
s_mov_b64 exec, s[60:61]
buffer_load_dwordx4 v4, s[8:11], s37 offen lds
s_mov_b64 exec, -1
s_add_u32 m0, s39, 46080
s_nop 0
buffer_load_dwordx4 v5, s[8:11], s37 offen lds
s_add_u32 m0, s39, 49152
s_nop 0
buffer_load_dwordx4 v6, s[8:11], s37 offen lds
s_add_u32 m0, s39, 52224
s_nop 0
buffer_load_dwordx4 v7, s[8:11], s37 offen lds
s_add_u32 m0, s39, 55296
s_nop 0
buffer_load_dwordx4 v8, s[8:11], s37 offen lds
s_add_u32 m0, s39, 58368
s_nop 0
buffer_load_dwordx4 v9, s[8:11], s37 offen lds
s_add_u32 m0, s40, 43008
s_add_u32 s43, s38, 0
buffer_load_dwordx4 v2, s[12:15], s43 offen lds
s_add_u32 m0, s40, 44032
s_add_u32 s43, s38, 49152
buffer_load_dwordx4 v3, s[12:15], s43 offen lds
s_add_u32 m0, s40, 45056
s_add_u32 s43, s38, 98304
buffer_load_dwordx4 v2, s[12:15], s43 offen lds
s_add_u32 m0, s40, 46080
s_add_u32 s43, s38, 147456
buffer_load_dwordx4 v3, s[12:15], s43 offen lds
s_add_u32 m0, s40, 47104
s_add_u32 s43, s38, 196608
buffer_load_dwordx4 v2, s[12:15], s43 offen lds
s_add_u32 m0, s40, 48128
s_add_u32 s43, s38, 245760
buffer_load_dwordx4 v3, s[12:15], s43 offen lds
s_add_u32 m0, s40, 49152
s_add_u32 s43, s38, 294912
buffer_load_dwordx4 v2, s[12:15], s43 offen lds
s_add_u32 m0, s40, 50176
s_add_u32 s43, s38, 344064
buffer_load_dwordx4 v3, s[12:15], s43 offen lds
s_add_u32 s37, s37, 128
s_add_u32 s38, s38, 393216
s_load_dword s3, s[4:5], 0
s_load_dword s3, s[4:5], 64
s_load_dword s3, s[4:5], 128
Lsp_10:
s_waitcnt vmcnt(14)
s_barrier
s_add_u32 m0, s39, 86016
s_mov_b64 exec, s[60:61]
buffer_load_dwordx4 v4, s[8:11], s37 offen lds
s_mov_b64 exec, -1
s_add_u32 m0, s39, 89088
s_nop 0
buffer_load_dwordx4 v5, s[8:11], s37 offen lds
s_add_u32 m0, s39, 92160
s_nop 0
buffer_load_dwordx4 v6, s[8:11], s37 offen lds
s_add_u32 m0, s39, 95232
s_nop 0
buffer_load_dwordx4 v7, s[8:11], s37 offen lds
s_add_u32 m0, s39, 98304
s_nop 0
buffer_load_dwordx4 v8, s[8:11], s37 offen lds
s_add_u32 m0, s39, 101376
s_nop 0
buffer_load_dwordx4 v9, s[8:11], s37 offen lds
s_add_u32 m0, s40, 86016
s_add_u32 s43, s38, 0
buffer_load_dwordx4 v2, s[12:15], s43 offen lds
s_add_u32 m0, s40, 87040
s_add_u32 s43, s38, 49152
buffer_load_dwordx4 v3, s[12:15], s43 offen lds
s_add_u32 m0, s40, 88064
s_add_u32 s43, s38, 98304
buffer_load_dwordx4 v2, s[12:15], s43 offen lds
s_add_u32 m0, s40, 89088
s_add_u32 s43, s38, 147456
buffer_load_dwordx4 v3, s[12:15], s43 offen lds
s_add_u32 m0, s40, 90112
s_add_u32 s43, s38, 196608
buffer_load_dwordx4 v2, s[12:15], s43 offen lds
s_add_u32 m0, s40, 91136
s_add_u32 s43, s38, 245760
buffer_load_dwordx4 v3, s[12:15], s43 offen lds
s_add_u32 m0, s40, 92160
s_add_u32 s43, s38, 294912
buffer_load_dwordx4 v2, s[12:15], s43 offen lds
s_add_u32 m0, s40, 93184
s_add_u32 s43, s38, 344064
buffer_load_dwordx4 v3, s[12:15], s43 offen lds
s_add_u32 s37, s37, 128
s_add_u32 s38, s38, 393216
s_load_dword s3, s[4:5], 192
s_load_dword s3, s[4:5], 7168
s_load_dword s3, s[4:5], 7232
s_load_dword s3, s[4:5], 7296
s_load_dword s3, s[4:5], 7360
Lsp_11:
s_waitcnt vmcnt(14)
s_barrier
s_add_u32 m0, s39, 0
s_mov_b64 exec, s[60:61]
buffer_load_dwordx4 v4, s[8:11], s37 offen lds
s_mov_b64 exec, -1
s_add_u32 m0, s39, 3072
s_nop 0
buffer_load_dwordx4 v5, s[8:11], s37 offen lds
s_add_u32 m0, s39, 6144
s_nop 0
buffer_load_dwordx4 v6, s[8:11], s37 offen lds
s_branch Lov_0
.p2align 12
Lst_0_0:
s_branch Lwr_160
s_nop 0
s_nop 0
Lov_0:
s_add_u32 m0, s39, 9216
s_nop 0
buffer_load_dwordx4 v7, s[8:11], s37 offen lds
s_add_u32 m0, s39, 12288
s_nop 0
buffer_load_dwordx4 v8, s[8:11], s37 offen lds
s_add_u32 m0, s39, 15360
s_nop 0
buffer_load_dwordx4 v9, s[8:11], s37 offen lds
s_add_u32 m0, s40, 0
s_add_u32 s43, s38, 0
buffer_load_dwordx4 v2, s[12:15], s43 offen lds
s_add_u32 m0, s40, 1024
s_add_u32 s43, s38, 49152
buffer_load_dwordx4 v3, s[12:15], s43 offen lds
s_add_u32 m0, s40, 2048
s_add_u32 s43, s38, 98304
buffer_load_dwordx4 v2, s[12:15], s43 offen lds
s_add_u32 m0, s40, 3072
s_add_u32 s43, s38, 147456
buffer_load_dwordx4 v3, s[12:15], s43 offen lds
s_add_u32 m0, s40, 4096
s_add_u32 s43, s38, 196608
buffer_load_dwordx4 v2, s[12:15], s43 offen lds
s_add_u32 m0, s40, 5120
s_add_u32 s43, s38, 245760
buffer_load_dwordx4 v3, s[12:15], s43 offen lds
s_add_u32 m0, s40, 6144
s_add_u32 s43, s38, 294912
buffer_load_dwordx4 v2, s[12:15], s43 offen lds
s_add_u32 m0, s40, 7168
s_add_u32 s43, s38, 344064
buffer_load_dwordx4 v3, s[12:15], s43 offen lds
s_add_u32 s37, s37, 128
s_add_u32 s38, s38, 393216
s_load_dword s3, s[4:5], 14336
s_load_dword s3, s[4:5], 14400
s_load_dword s3, s[4:5], 14464
s_load_dword s3, s[4:5], 14528
s_load_dword s3, s[4:5], 21504
s_load_dword s3, s[4:5], 21568
Lsp_12:
s_waitcnt vmcnt(14)
s_barrier
s_add_u32 m0, s39, 43008
s_mov_b64 exec, s[60:61]
buffer_load_dwordx4 v4, s[8:11], s37 offen lds
s_mov_b64 exec, -1
s_add_u32 m0, s39, 46080
s_nop 0
buffer_load_dwordx4 v5, s[8:11], s37 offen lds
s_add_u32 m0, s39, 49152
s_nop 0
buffer_load_dwordx4 v6, s[8:11], s37 offen lds
s_add_u32 m0, s39, 52224
s_nop 0
buffer_load_dwordx4 v7, s[8:11], s37 offen lds
s_add_u32 m0, s39, 55296
s_nop 0
buffer_load_dwordx4 v8, s[8:11], s37 offen lds
s_add_u32 m0, s39, 58368
s_nop 0
buffer_load_dwordx4 v9, s[8:11], s37 offen lds
s_add_u32 m0, s40, 43008
s_add_u32 s43, s38, 0
buffer_load_dwordx4 v2, s[12:15], s43 offen lds
s_add_u32 m0, s40, 44032
s_add_u32 s43, s38, 49152
buffer_load_dwordx4 v3, s[12:15], s43 offen lds
s_add_u32 m0, s40, 45056
s_add_u32 s43, s38, 98304
buffer_load_dwordx4 v2, s[12:15], s43 offen lds
s_add_u32 m0, s40, 46080
s_add_u32 s43, s38, 147456
buffer_load_dwordx4 v3, s[12:15], s43 offen lds
s_add_u32 m0, s40, 47104
s_add_u32 s43, s38, 196608
buffer_load_dwordx4 v2, s[12:15], s43 offen lds
s_add_u32 m0, s40, 48128
s_add_u32 s43, s38, 245760
buffer_load_dwordx4 v3, s[12:15], s43 offen lds
s_add_u32 m0, s40, 49152
s_add_u32 s43, s38, 294912
buffer_load_dwordx4 v2, s[12:15], s43 offen lds
s_add_u32 m0, s40, 50176
s_add_u32 s43, s38, 344064
buffer_load_dwordx4 v3, s[12:15], s43 offen lds
s_add_u32 s37, s37, 128
s_add_u32 s38, s38, 393216
s_load_dword s3, s[4:5], 21632
s_load_dword s3, s[4:5], 21696
s_load_dword s3, s[4:5], 28672
s_load_dword s3, s[4:5], 28736
s_load_dword s3, s[4:5], 28800
s_load_dword s3, s[4:5], 28864
s_load_dword s3, s[4:5], 35840
Lsp_13:
s_waitcnt vmcnt(14)
s_barrier
s_add_u32 m0, s39, 86016
s_mov_b64 exec, s[60:61]
buffer_load_dwordx4 v4, s[8:11], s37 offen lds
s_mov_b64 exec, -1
s_add_u32 m0, s39, 89088
s_nop 0
buffer_load_dwordx4 v5, s[8:11], s37 offen lds
s_add_u32 m0, s39, 92160
s_nop 0
buffer_load_dwordx4 v6, s[8:11], s37 offen lds
s_add_u32 m0, s39, 95232
s_nop 0
buffer_load_dwordx4 v7, s[8:11], s37 offen lds
s_add_u32 m0, s39, 98304
s_nop 0
buffer_load_dwordx4 v8, s[8:11], s37 offen lds
s_add_u32 m0, s39, 101376
s_nop 0
buffer_load_dwordx4 v9, s[8:11], s37 offen lds
s_add_u32 m0, s40, 86016
s_add_u32 s43, s38, 0
buffer_load_dwordx4 v2, s[12:15], s43 offen lds
s_add_u32 m0, s40, 87040
s_add_u32 s43, s38, 49152
buffer_load_dwordx4 v3, s[12:15], s43 offen lds
s_add_u32 m0, s40, 88064
s_add_u32 s43, s38, 98304
buffer_load_dwordx4 v2, s[12:15], s43 offen lds
s_add_u32 m0, s40, 89088
s_add_u32 s43, s38, 147456
buffer_load_dwordx4 v3, s[12:15], s43 offen lds
s_add_u32 m0, s40, 90112
s_add_u32 s43, s38, 196608
buffer_load_dwordx4 v2, s[12:15], s43 offen lds
s_add_u32 m0, s40, 91136
s_add_u32 s43, s38, 245760
buffer_load_dwordx4 v3, s[12:15], s43 offen lds
s_add_u32 m0, s40, 92160
s_add_u32 s43, s38, 294912
buffer_load_dwordx4 v2, s[12:15], s43 offen lds
s_add_u32 m0, s40, 93184
s_add_u32 s43, s38, 344064
buffer_load_dwordx4 v3, s[12:15], s43 offen lds
s_add_u32 s37, s37, 128
s_add_u32 s38, s38, 393216
s_load_dword s3, s[4:5], 35904
s_load_dword s3, s[4:5], 35968
s_load_dword s3, s[4:5], 36032
s_load_dword s3, s[4:5], 43008
s_load_dword s3, s[4:5], 43072
s_load_dword s3, s[4:5], 43136
s_load_dword s3, s[4:5], 43200
s_load_dword s3, s[4:5], 50176
Lsp_14:
s_waitcnt vmcnt(14)
s_barrier
s_add_u32 m0, s39, 0
s_mov_b64 exec, s[60:61]
buffer_load_dwordx4 v4, s[8:11], s37 offen lds
s_mov_b64 exec, -1
s_add_u32 m0, s39, 3072
s_nop 0
buffer_load_dwordx4 v5, s[8:11], s37 offen lds
s_add_u32 m0, s39, 6144
s_nop 0
buffer_load_dwordx4 v6, s[8:11], s37 offen lds
s_add_u32 m0, s39, 9216
s_nop 0
buffer_load_dwordx4 v7, s[8:11], s37 offen lds
s_add_u32 m0, s39, 12288
s_nop 0
buffer_load_dwordx4 v8, s[8:11], s37 offen lds
s_add_u32 m0, s39, 15360
s_nop 0
buffer_load_dwordx4 v9, s[8:11], s37 offen lds
s_add_u32 m0, s40, 0
s_add_u32 s43, s38, 0
buffer_load_dwordx4 v2, s[12:15], s43 offen lds
s_add_u32 m0, s40, 1024
s_add_u32 s43, s38, 49152
buffer_load_dwordx4 v3, s[12:15], s43 offen lds
s_add_u32 m0, s40, 2048
s_add_u32 s43, s38, 98304
buffer_load_dwordx4 v2, s[12:15], s43 offen lds
s_add_u32 m0, s40, 3072
s_add_u32 s43, s38, 147456
buffer_load_dwordx4 v3, s[12:15], s43 offen lds
s_add_u32 m0, s40, 4096
s_add_u32 s43, s38, 196608
buffer_load_dwordx4 v2, s[12:15], s43 offen lds
s_add_u32 m0, s40, 5120
s_add_u32 s43, s38, 245760
buffer_load_dwordx4 v3, s[12:15], s43 offen lds
s_add_u32 m0, s40, 6144
s_add_u32 s43, s38, 294912
buffer_load_dwordx4 v2, s[12:15], s43 offen lds
s_add_u32 m0, s40, 7168
s_add_u32 s43, s38, 344064
buffer_load_dwordx4 v3, s[12:15], s43 offen lds
s_add_u32 s37, s37, 128
s_add_u32 s38, s38, 393216
s_load_dword s3, s[4:5], 50240
s_load_dword s3, s[4:5], 50304
s_load_dword s3, s[4:5], 50368
s_load_dword s3, s[4:5], 57344
s_load_dword s3, s[4:5], 57408
s_load_dword s3, s[4:5], 57472
s_load_dword s3, s[4:5], 57536
s_load_dword s3, s[4:5], 64512
s_load_dword s3, s[4:5], 64576
Lsp_15:
s_waitcnt vmcnt(14)
s_barrier
s_add_u32 m0, s39, 43008
s_mov_b64 exec, s[60:61]
buffer_load_dwordx4 v4, s[8:11], s37 offen lds
s_mov_b64 exec, -1
s_add_u32 m0, s39, 46080
s_nop 0
buffer_load_dwordx4 v5, s[8:11], s37 offen lds
s_add_u32 m0, s39, 49152
s_nop 0
buffer_load_dwordx4 v6, s[8:11], s37 offen lds
s_add_u32 m0, s39, 52224
s_nop 0
buffer_load_dwordx4 v7, s[8:11], s37 offen lds
s_add_u32 m0, s39, 55296
s_nop 0
buffer_load_dwordx4 v8, s[8:11], s37 offen lds
s_add_u32 m0, s39, 58368
s_nop 0
buffer_load_dwordx4 v9, s[8:11], s37 offen lds
s_add_u32 m0, s40, 43008
s_add_u32 s43, s38, 0
buffer_load_dwordx4 v2, s[12:15], s43 offen lds
s_add_u32 m0, s40, 44032
s_add_u32 s43, s38, 49152
buffer_load_dwordx4 v3, s[12:15], s43 offen lds
s_add_u32 m0, s40, 45056
s_add_u32 s43, s38, 98304
buffer_load_dwordx4 v2, s[12:15], s43 offen lds
s_add_u32 m0, s40, 46080
s_add_u32 s43, s38, 147456
buffer_load_dwordx4 v3, s[12:15], s43 offen lds
s_add_u32 m0, s40, 47104
s_add_u32 s43, s38, 196608
buffer_load_dwordx4 v2, s[12:15], s43 offen lds
s_add_u32 m0, s40, 48128
s_add_u32 s43, s38, 245760
buffer_load_dwordx4 v3, s[12:15], s43 offen lds
s_add_u32 m0, s40, 49152
s_add_u32 s43, s38, 294912
buffer_load_dwordx4 v2, s[12:15], s43 offen lds
s_add_u32 m0, s40, 50176
s_add_u32 s43, s38, 344064
buffer_load_dwordx4 v3, s[12:15], s43 offen lds
s_add_u32 s37, s37, 128
s_add_u32 s38, s38, 393216
s_load_dword s3, s[4:5], 64640
s_load_dword s3, s[4:5], 64704
s_load_dword s3, s[4:5], 71680
s_load_dword s3, s[4:5], 71744
s_load_dword s3, s[4:5], 71808
s_load_dword s3, s[4:5], 71872
s_load_dword s3, s[4:5], 78848
s_load_dword s3, s[4:5], 78912
s_load_dword s3, s[4:5], 78976
s_load_dword s3, s[4:5], 79040
Lsp_16:
s_waitcnt vmcnt(14)
s_barrier
s_add_u32 m0, s39, 86016
s_mov_b64 exec, s[60:61]
buffer_load_dwordx4 v4, s[8:11], s37 offen lds
s_mov_b64 exec, -1
s_add_u32 m0, s39, 89088
s_nop 0
buffer_load_dwordx4 v5, s[8:11], s37 offen lds
s_add_u32 m0, s39, 92160
s_nop 0
buffer_load_dwordx4 v6, s[8:11], s37 offen lds
s_add_u32 m0, s39, 95232
s_nop 0
buffer_load_dwordx4 v7, s[8:11], s37 offen lds
s_add_u32 m0, s39, 98304
s_nop 0
buffer_load_dwordx4 v8, s[8:11], s37 offen lds
s_add_u32 m0, s39, 101376
s_nop 0
buffer_load_dwordx4 v9, s[8:11], s37 offen lds
s_add_u32 m0, s40, 86016
s_add_u32 s43, s38, 0
buffer_load_dwordx4 v2, s[12:15], s43 offen lds
s_add_u32 m0, s40, 87040
s_add_u32 s43, s38, 49152
buffer_load_dwordx4 v3, s[12:15], s43 offen lds
s_add_u32 m0, s40, 88064
s_add_u32 s43, s38, 98304
buffer_load_dwordx4 v2, s[12:15], s43 offen lds
s_add_u32 m0, s40, 89088
s_add_u32 s43, s38, 147456
buffer_load_dwordx4 v3, s[12:15], s43 offen lds
s_add_u32 m0, s40, 90112
s_add_u32 s43, s38, 196608
buffer_load_dwordx4 v2, s[12:15], s43 offen lds
s_add_u32 m0, s40, 91136
s_add_u32 s43, s38, 245760
buffer_load_dwordx4 v3, s[12:15], s43 offen lds
s_add_u32 m0, s40, 92160
s_add_u32 s43, s38, 294912
buffer_load_dwordx4 v2, s[12:15], s43 offen lds
s_add_u32 m0, s40, 93184
s_add_u32 s43, s38, 344064
buffer_load_dwordx4 v3, s[12:15], s43 offen lds
s_add_u32 s37, s37, 128
s_add_u32 s38, s38, 393216
s_load_dword s3, s[4:5], 86016
s_load_dword s3, s[4:5], 86080
s_load_dword s3, s[4:5], 86144
s_load_dword s3, s[4:5], 86208
s_load_dword s3, s[4:5], 93184
s_load_dword s3, s[4:5], 93248
s_load_dword s3, s[4:5], 93312
s_load_dword s3, s[4:5], 93376
s_load_dword s3, s[4:5], 100352
s_load_dword s3, s[4:5], 100416
Lsp_17:
s_waitcnt vmcnt(14)
s_barrier
s_add_u32 m0, s39, 0
s_mov_b64 exec, s[60:61]
buffer_load_dwordx4 v4, s[8:11], s37 offen lds
s_mov_b64 exec, -1
s_add_u32 m0, s39, 3072
s_nop 0
buffer_load_dwordx4 v5, s[8:11], s37 offen lds
s_add_u32 m0, s39, 6144
s_nop 0
buffer_load_dwordx4 v6, s[8:11], s37 offen lds
s_add_u32 m0, s39, 9216
s_nop 0
buffer_load_dwordx4 v7, s[8:11], s37 offen lds
s_add_u32 m0, s39, 12288
s_nop 0
buffer_load_dwordx4 v8, s[8:11], s37 offen lds
s_add_u32 m0, s39, 15360
s_nop 0
buffer_load_dwordx4 v9, s[8:11], s37 offen lds
s_add_u32 m0, s40, 0
s_add_u32 s43, s38, 0
buffer_load_dwordx4 v2, s[12:15], s43 offen lds
s_add_u32 m0, s40, 1024
s_add_u32 s43, s38, 49152
buffer_load_dwordx4 v3, s[12:15], s43 offen lds
s_add_u32 m0, s40, 2048
s_add_u32 s43, s38, 98304
buffer_load_dwordx4 v2, s[12:15], s43 offen lds
s_add_u32 m0, s40, 3072
s_add_u32 s43, s38, 147456
buffer_load_dwordx4 v3, s[12:15], s43 offen lds
s_add_u32 m0, s40, 4096
s_add_u32 s43, s38, 196608
buffer_load_dwordx4 v2, s[12:15], s43 offen lds
s_add_u32 m0, s40, 5120
s_add_u32 s43, s38, 245760
buffer_load_dwordx4 v3, s[12:15], s43 offen lds
s_add_u32 m0, s40, 6144
s_add_u32 s43, s38, 294912
buffer_load_dwordx4 v2, s[12:15], s43 offen lds
s_add_u32 m0, s40, 7168
s_add_u32 s43, s38, 344064
buffer_load_dwordx4 v3, s[12:15], s43 offen lds
s_add_u32 s37, s37, 128
s_add_u32 s38, s38, 393216
s_load_dword s3, s[4:5], 100480
s_load_dword s3, s[4:5], 100544
s_load_dword s3, s[4:5], 107520
s_load_dword s3, s[4:5], 107584
s_load_dword s3, s[4:5], 107648
s_load_dword s3, s[4:5], 107712
s_load_dword s3, s[4:5], 114688
s_load_dword s3, s[4:5], 114752
s_load_dword s3, s[4:5], 114816
s_load_dword s3, s[4:5], 114880
s_load_dword s3, s[4:5], 121856
Lsp_18:
s_waitcnt vmcnt(14)
s_barrier
s_add_u32 m0, s39, 43008
s_mov_b64 exec, s[60:61]
buffer_load_dwordx4 v4, s[8:11], s37 offen lds
s_mov_b64 exec, -1
s_add_u32 m0, s39, 46080
s_nop 0
buffer_load_dwordx4 v5, s[8:11], s37 offen lds
s_add_u32 m0, s39, 49152
s_nop 0
buffer_load_dwordx4 v6, s[8:11], s37 offen lds
s_add_u32 m0, s39, 52224
s_nop 0
buffer_load_dwordx4 v7, s[8:11], s37 offen lds
s_add_u32 m0, s39, 55296
s_nop 0
buffer_load_dwordx4 v8, s[8:11], s37 offen lds
s_add_u32 m0, s39, 58368
s_nop 0
buffer_load_dwordx4 v9, s[8:11], s37 offen lds
s_add_u32 m0, s40, 43008
s_add_u32 s43, s38, 0
buffer_load_dwordx4 v2, s[12:15], s43 offen lds
s_add_u32 m0, s40, 44032
s_add_u32 s43, s38, 49152
buffer_load_dwordx4 v3, s[12:15], s43 offen lds
s_add_u32 m0, s40, 45056
s_add_u32 s43, s38, 98304
buffer_load_dwordx4 v2, s[12:15], s43 offen lds
s_add_u32 m0, s40, 46080
s_add_u32 s43, s38, 147456
buffer_load_dwordx4 v3, s[12:15], s43 offen lds
s_add_u32 m0, s40, 47104
s_add_u32 s43, s38, 196608
buffer_load_dwordx4 v2, s[12:15], s43 offen lds
s_add_u32 m0, s40, 48128
s_add_u32 s43, s38, 245760
buffer_load_dwordx4 v3, s[12:15], s43 offen lds
s_add_u32 m0, s40, 49152
s_add_u32 s43, s38, 294912
buffer_load_dwordx4 v2, s[12:15], s43 offen lds
s_add_u32 m0, s40, 50176
s_add_u32 s43, s38, 344064
buffer_load_dwordx4 v3, s[12:15], s43 offen lds
s_add_u32 s37, s37, 128
s_add_u32 s38, s38, 393216
s_load_dword s3, s[4:5], 121920
s_load_dword s3, s[4:5], 121984
s_load_dword s3, s[4:5], 122048
s_load_dword s3, s[4:5], 129024
s_load_dword s3, s[4:5], 129088
s_load_dword s3, s[4:5], 129152
s_load_dword s3, s[4:5], 129216
s_load_dword s3, s[4:5], 136192
s_load_dword s3, s[4:5], 136256
s_load_dword s3, s[4:5], 136320
s_load_dword s3, s[4:5], 136384
Lsp_19:
s_waitcnt vmcnt(14)
s_barrier
s_add_u32 m0, s39, 86016
s_mov_b64 exec, s[60:61]
buffer_load_dwordx4 v4, s[8:11], s37 offen lds
s_mov_b64 exec, -1
s_add_u32 m0, s39, 89088
s_nop 0
buffer_load_dwordx4 v5, s[8:11], s37 offen lds
s_add_u32 m0, s39, 92160
s_nop 0
buffer_load_dwordx4 v6, s[8:11], s37 offen lds
s_add_u32 m0, s39, 95232
s_nop 0
buffer_load_dwordx4 v7, s[8:11], s37 offen lds
s_add_u32 m0, s39, 98304
s_nop 0
buffer_load_dwordx4 v8, s[8:11], s37 offen lds
s_add_u32 m0, s39, 101376
s_nop 0
buffer_load_dwordx4 v9, s[8:11], s37 offen lds
s_add_u32 m0, s40, 86016
s_add_u32 s43, s38, 0
buffer_load_dwordx4 v2, s[12:15], s43 offen lds
s_add_u32 m0, s40, 87040
s_add_u32 s43, s38, 49152
buffer_load_dwordx4 v3, s[12:15], s43 offen lds
s_add_u32 m0, s40, 88064
s_add_u32 s43, s38, 98304
buffer_load_dwordx4 v2, s[12:15], s43 offen lds
s_add_u32 m0, s40, 89088
s_add_u32 s43, s38, 147456
buffer_load_dwordx4 v3, s[12:15], s43 offen lds
s_add_u32 m0, s40, 90112
s_add_u32 s43, s38, 196608
buffer_load_dwordx4 v2, s[12:15], s43 offen lds
s_add_u32 m0, s40, 91136
s_add_u32 s43, s38, 245760
buffer_load_dwordx4 v3, s[12:15], s43 offen lds
s_add_u32 m0, s40, 92160
s_add_u32 s43, s38, 294912
buffer_load_dwordx4 v2, s[12:15], s43 offen lds
s_add_u32 m0, s40, 93184
s_add_u32 s43, s38, 344064
buffer_load_dwordx4 v3, s[12:15], s43 offen lds
s_add_u32 s37, s37, 128
s_add_u32 s38, s38, 393216
s_load_dword s3, s[4:5], 143360
s_load_dword s3, s[4:5], 143424
s_load_dword s3, s[4:5], 143488
s_load_dword s3, s[4:5], 143552
s_load_dword s3, s[4:5], 150528
s_load_dword s3, s[4:5], 150592
s_load_dword s3, s[4:5], 150656
s_load_dword s3, s[4:5], 150720
s_load_dword s3, s[4:5], 157696
s_load_dword s3, s[4:5], 157760
s_load_dword s3, s[4:5], 157824
Lsp_20:
s_waitcnt vmcnt(14)
s_barrier
s_add_u32 m0, s39, 0
s_mov_b64 exec, s[60:61]
buffer_load_dwordx4 v4, s[8:11], s37 offen lds
s_mov_b64 exec, -1
s_add_u32 m0, s39, 3072
s_nop 0
buffer_load_dwordx4 v5, s[8:11], s37 offen lds
s_add_u32 m0, s39, 6144
s_nop 0
buffer_load_dwordx4 v6, s[8:11], s37 offen lds
s_add_u32 m0, s39, 9216
s_nop 0
buffer_load_dwordx4 v7, s[8:11], s37 offen lds
s_add_u32 m0, s39, 12288
s_nop 0
buffer_load_dwordx4 v8, s[8:11], s37 offen lds
s_add_u32 m0, s39, 15360
s_nop 0
buffer_load_dwordx4 v9, s[8:11], s37 offen lds
s_add_u32 m0, s40, 0
s_add_u32 s43, s38, 0
buffer_load_dwordx4 v2, s[12:15], s43 offen lds
s_add_u32 m0, s40, 1024
s_add_u32 s43, s38, 49152
buffer_load_dwordx4 v3, s[12:15], s43 offen lds
s_add_u32 m0, s40, 2048
s_add_u32 s43, s38, 98304
buffer_load_dwordx4 v2, s[12:15], s43 offen lds
s_add_u32 m0, s40, 3072
s_add_u32 s43, s38, 147456
buffer_load_dwordx4 v3, s[12:15], s43 offen lds
s_add_u32 m0, s40, 4096
s_add_u32 s43, s38, 196608
buffer_load_dwordx4 v2, s[12:15], s43 offen lds
s_add_u32 m0, s40, 5120
s_add_u32 s43, s38, 245760
buffer_load_dwordx4 v3, s[12:15], s43 offen lds
s_add_u32 m0, s40, 6144
s_add_u32 s43, s38, 294912
buffer_load_dwordx4 v2, s[12:15], s43 offen lds
s_add_u32 m0, s40, 7168
s_add_u32 s43, s38, 344064
buffer_load_dwordx4 v3, s[12:15], s43 offen lds
s_add_u32 s37, s37, 128
s_add_u32 s38, s38, 393216
s_load_dword s3, s[4:5], 157888
s_load_dword s3, s[4:5], 164864
s_load_dword s3, s[4:5], 164928
s_load_dword s3, s[4:5], 164992
s_load_dword s3, s[4:5], 165056
s_load_dword s3, s[4:5], 172032
s_load_dword s3, s[4:5], 172096
s_load_dword s3, s[4:5], 172160
s_load_dword s3, s[4:5], 172224
s_load_dword s3, s[4:5], 179200
s_load_dword s3, s[4:5], 179264
Lsp_21:
s_waitcnt vmcnt(14)
s_barrier
s_load_dword s3, s[4:5], 179328
s_load_dword s3, s[4:5], 179392
s_load_dword s3, s[4:5], 186368
s_load_dword s3, s[4:5], 186432
s_load_dword s3, s[4:5], 186496
s_load_dword s3, s[4:5], 186560
s_load_dword s3, s[4:5], 193536
s_branch Lov_1
.p2align 12
Lst_1_0:
s_branch Lwr_161
s_nop 0
s_nop 0
Lov_1:
s_load_dword s3, s[4:5], 193600
s_load_dword s3, s[4:5], 193664
s_load_dword s3, s[4:5], 193728
Lsp_22:
s_waitcnt vmcnt(0)
s_barrier
s_lshl_b32 s43, s35, 7
s_add_u32 s28, s68, s43
s_addc_u32 s29, s69, 0
s_mov_b32 s30, 2095232
s_mov_b32 s31, 0x20000
v_lshrrev_b32 v15, 3, v1
v_and_b32 v16, 6, v15
v_and_b32 v7, 7, v1
v_xor_b32 v7, v7, v16
v_lshlrev_b32 v7, 4, v7
v_mul_u32_u24 v15, 2048, v15
v_add_u32 v7, v7, v15
s_and_b32 s40, s36, 3
s_lshl_b32 s39, s40, 13
s_add_u32 s40, s40, s35
s_add_u32 s42, s40, 0
s_and_b32 s42, s42, 15
s_lshl_b32 s42, s42, 17
s_add_u32 m0, s39, 65536
s_add_u32 s43, s42, 0
buffer_load_dwordx4 v7, s[28:31], s43 offen lds
s_add_u32 m0, s39, 66560
s_add_u32 s43, s42, 16384
buffer_load_dwordx4 v7, s[28:31], s43 offen lds
s_add_u32 m0, s39, 67584
s_add_u32 s43, s42, 32768
buffer_load_dwordx4 v7, s[28:31], s43 offen lds
s_add_u32 m0, s39, 68608
s_add_u32 s43, s42, 49152
buffer_load_dwordx4 v7, s[28:31], s43 offen lds
s_add_u32 m0, s39, 69632
s_add_u32 s43, s42, 65536
buffer_load_dwordx4 v7, s[28:31], s43 offen lds
s_add_u32 m0, s39, 70656
s_add_u32 s43, s42, 81920
buffer_load_dwordx4 v7, s[28:31], s43 offen lds
s_add_u32 m0, s39, 71680
s_add_u32 s43, s42, 98304
buffer_load_dwordx4 v7, s[28:31], s43 offen lds
s_add_u32 m0, s39, 72704
s_add_u32 s43, s42, 114688
buffer_load_dwordx4 v7, s[28:31], s43 offen lds
s_bitcmp0_b32 s2, 0
s_cselect_b32 s88, s72, s74
s_cselect_b32 s89, s73, s75
s_cmp_lt_u32 s2, 192
s_cselect_b32 s90, 7340032, 0
s_mov_b32 s91, 0x20000
s_bfe_u32 s44, s2, 0x30001
s_lshl_b32 s44, s44, 2
s_and_b32 s43, s36, 3
s_add_u32 s44, s44, s43
s_lshl_b32 s44, s44, 5
v_lshrrev_b32 v18, 4, v1
v_add_u32 v18, s44, v18
v_mul_u32_u24 v18, 7168, v18
v_and_b32 v19, 15, v1
v_lshl_add_u32 v18, v19, 4, v18
s_lshr_b32 s43, s2, 4
s_lshl_b32 s43, s43, 8
s_add_u32 s43, s43, 4096
v_add_u32 v18, s43, v18
s_mov_b32 s43, 0
buffer_load_dwordx4 v[128:131], v18, s[88:91], s43 offen
s_mov_b32 s43, 28672
buffer_load_dwordx4 v[132:135], v18, s[88:91], s43 offen
s_mov_b32 s43, 57344
buffer_load_dwordx4 v[136:139], v18, s[88:91], s43 offen
s_mov_b32 s43, 86016
buffer_load_dwordx4 v[140:143], v18, s[88:91], s43 offen
s_mov_b32 s43, 114688
buffer_load_dwordx4 v[144:147], v18, s[88:91], s43 offen
s_mov_b32 s43, 143360
buffer_load_dwordx4 v[148:151], v18, s[88:91], s43 offen
s_mov_b32 s43, 172032
buffer_load_dwordx4 v[152:155], v18, s[88:91], s43 offen
s_mov_b32 s43, 200704
buffer_load_dwordx4 v[156:159], v18, s[88:91], s43 offen
s_barrier
s_branch Lats_6
Lcons_7:
s_lshl_b32 s43, s35, 7
s_waitcnt lgkmcnt(0)
s_mov_b32 s8, s64
s_mov_b32 s9, s65
s_mov_b32 s10, 4194304
s_mov_b32 s11, 0x20000
s_add_u32 s12, s66, s43
s_addc_u32 s13, s67, 0
s_mov_b32 s14, 6289536
s_mov_b32 s15, 0x20000
s_lshr_b32 s43, s2, 3
s_lshl_b32 s43, s43, 2
s_add_u32 s43, s43, s36
s_sub_u32 s44, s43, 0
s_and_b32 s44, s44, 127
s_cmp_lt_u32 s44, 24
s_cbranch_scc0 Lt_23
s_lshl_b32 s44, s44, 20
s_min_u32 s44, s44, 24117184
s_load_dword s3, s[82:83], s44 glc
Lt_23:
s_sub_u32 s44, s43, 24
s_and_b32 s44, s44, 127
s_cmp_lt_u32 s44, 8
s_cbranch_scc0 Lt_24
s_lshl_b32 s44, s44, 20
s_min_u32 s44, s44, 7339968
s_load_dword s3, s[72:73], s44
Lt_24:
s_sub_u32 s44, s43, 32
s_and_b32 s44, s44, 127
s_cmp_lt_u32 s44, 8
s_cbranch_scc0 Lt_25
s_lshl_b32 s44, s44, 20
s_min_u32 s44, s44, 7339968
s_load_dword s3, s[74:75], s44
Lt_25:
s_sub_u32 s44, s43, 40
s_and_b32 s44, s44, 127
s_cmp_lt_u32 s44, 3
s_cbranch_scc0 Lt_26
s_lshl_b32 s44, s44, 20
s_min_u32 s44, s44, 2097088
s_load_dword s3, s[68:69], s44
Lt_26:
s_sub_u32 s44, s43, 43
s_and_b32 s44, s44, 127
s_cmp_lt_u32 s44, 5
s_cbranch_scc0 Lt_27
s_lshl_b32 s44, s44, 20
s_min_u32 s44, s44, 4194240
s_add_u32 s44, s44, 25165824
s_load_dword s3, s[82:83], s44 glc
Lt_27:
s_sub_u32 s44, s43, 48
s_and_b32 s44, s44, 127
s_cmp_lt_u32 s44, 8
s_cbranch_scc0 Lt_28
s_lshl_b32 s44, s44, 20
s_min_u32 s44, s44, 7339968
s_load_dword s3, s[76:77], s44
Lt_28:
s_sub_u32 s44, s43, 56
s_and_b32 s44, s44, 127
s_cmp_lt_u32 s44, 5
s_cbranch_scc0 Lt_29
s_lshl_b32 s44, s44, 20
s_min_u32 s44, s44, 4194240
s_add_u32 s44, s44, 33554432
s_load_dword s3, s[82:83], s44 glc
Lt_29:
s_sub_u32 s44, s43, 61
s_and_b32 s44, s44, 127
s_cmp_lt_u32 s44, 5
s_cbranch_scc0 Lt_30
s_lshl_b32 s44, s44, 20
s_min_u32 s44, s44, 4194240
s_load_dword s3, s[78:79], s44 glc
Lt_30:
v_lshrrev_b32 v16, 1, v12
v_xor_b32 v15, v13, v16
v_lshlrev_b32 v15, 4, v15
v_lshl_add_u32 v2, v12, 7, v15
v_xor_b32 v3, 64, v2
v_add_u32 v4, 86016, v2
v_add_u32 v5, 86016, v3
v_lshrrev_b32 v15, 2, v12
v_and_b32 v16, 3, v1
v_lshl_add_u32 v19, v13, 3, v15
v_lshlrev_b32 v19, 7, v19
v_and_b32 v15, 2, v15
v_and_b32 v17, 1, v13
v_lshl_add_u32 v15, v17, 2, v15
v_lshrrev_b32 v17, 1, v16
s_lshl_b32 s43, s36, 1
v_add_u32 v17, s43, v17
v_xor_b32 v15, v15, v17
v_lshl_add_u32 v19, v15, 4, v19
v_and_b32 v16, 1, v16
v_lshl_add_u32 v19, v16, 3, v19
v_add_u32 v6, 18432, v19
v_add_u32 v7, 61440, v19
v_add_u32 v8, 104448, v19
s_and_b32 s43, s36, 1
s_bfe_u32 s44, s36, 0x10001
s_lshr_b32 s45, s36, 2
v_lshlrev_b32 v14, 2, v13
v_sub_u32 v14, v12, v14
v_mov_b32 v16, 0xff800000
s_or_b32 s46, s34, s45
s_cmp_lg_u32 s46, 0
s_cselect_b32 s46, 0, 0xff800000
v_subrev_u32 v15, 0, v14
v_cmp_ge_u32 vcc, 7, v15
v_add_u32 v15, 16, v15
s_nop 0
v_cndmask_b32 v248, v16, 0, vcc
v_cmp_ge_u32 vcc, 7, v15
s_nop 1
v_cndmask_b32 v244, v16, 0, vcc
v_or_b32 v240, s46, v244
v_subrev_u32 v15, 1, v14
v_cmp_ge_u32 vcc, 7, v15
v_add_u32 v15, 16, v15
s_nop 0
v_cndmask_b32 v249, v16, 0, vcc
v_cmp_ge_u32 vcc, 7, v15
s_nop 1
v_cndmask_b32 v245, v16, 0, vcc
v_or_b32 v241, s46, v245
v_subrev_u32 v15, 2, v14
v_cmp_ge_u32 vcc, 7, v15
v_add_u32 v15, 16, v15
s_nop 0
v_cndmask_b32 v250, v16, 0, vcc
v_cmp_ge_u32 vcc, 7, v15
s_nop 1
v_cndmask_b32 v246, v16, 0, vcc
v_or_b32 v242, s46, v246
v_subrev_u32 v15, 3, v14
v_cmp_ge_u32 vcc, 7, v15
v_add_u32 v15, 16, v15
s_nop 0
v_cndmask_b32 v251, v16, 0, vcc
v_cmp_ge_u32 vcc, 7, v15
s_nop 1
v_cndmask_b32 v247, v16, 0, vcc
v_or_b32 v243, s46, v247
s_lshl_b32 s46, s45, 6
s_add_u32 s46, s46, s44
s_add_u32 s46, s46, 16
v_lshl_add_u32 v14, v12, 1, s46
s_lshl_b32 s47, s43, 6
v_lshl_add_u32 v15, v13, 4, s47
v_mul_u32_u24 v20, 400, v14
v_add_u32 v20, v20, v15
v_subrev_u32 v16, 32, v14
v_max_i32 v16, 0, v16
v_mul_u32_u24 v21, 400, v16
v_add_u32 v21, v21, v15
v_lshrrev_b32 v16, 2, v12
v_lshl_add_u32 v16, v13, 2, v16
v_lshl_add_u32 v16, v16, 1, s46
v_and_b32 v17, 3, v1
v_lshl_add_u32 v17, v17, 3, s47
v_mul_u32_u24 v22, 400, v16
v_add_u32 v22, v22, v17
v_subrev_u32 v16, 32, v16
v_max_i32 v16, 0, v16
v_mul_u32_u24 v23, 400, v16
v_add_u32 v23, v23, v17
s_mul_i32 s60, s34, 262144
s_add_u32 s16, s82, s60
s_addc_u32 s17, s83, 0
s_mov_b32 s18, 262144
s_mov_b32 s19, 0x20000
s_lshl_b32 s60, s35, 14
s_lshl_b32 s43, s43, 13
s_add_u32 s60, s60, s43
s_lshl_b32 s43, s45, 12
s_add_u32 s60, s60, s43
s_lshl_b32 s43, s44, 10
s_add_u32 s60, s60, s43
v_lshlrev_b32 v24, 4, v1
s_mov_b32 s61, 0x3e8293ee
s_lshl_b32 s38, s35, 7
s_add_u32 s56, s82, 28311552
s_addc_u32 s57, s83, 0
s_mov_b32 s58, 114688
s_mov_b32 s59, 0x20000
s_barrier
ds_read_b128 v[32:35], v2 offset:0
ds_read_b64_tr_b16 v[72:73], v6 offset:8192
ds_read_b64_tr_b16 v[74:75], v6 offset:8704
ds_read_b64_tr_b16 v[76:77], v6 offset:16384
ds_read_b64_tr_b16 v[78:79], v6 offset:16896
ds_read_b64_tr_b16 v[68:69], v6 offset:0
ds_read_b64_tr_b16 v[70:71], v6 offset:512
ds_read_b128 v[36:39], v2 offset:2048
ds_read_b128 v[40:43], v2 offset:4096
ds_read_b128 v[44:47], v2 offset:6144
ds_read_b128 v[48:51], v2 offset:8192
ds_read_b128 v[52:55], v2 offset:10240
ds_read_b128 v[56:59], v2 offset:12288
ds_read_b128 v[60:63], v2 offset:14336
ds_read_b128 v[64:67], v2 offset:16384
s_waitcnt lgkmcnt(0)
v_mfma_f32_16x16x32_bf16 v[128:131], v[68:71], v[32:35], 0
ds_read_b128 v[80:83], v3 offset:0
v_mfma_f32_16x16x32_bf16 v[132:135], v[68:71], v[36:39], 0
ds_read_b64_tr_b16 v[120:121], v6 offset:12288
v_mfma_f32_16x16x32_bf16 v[136:139], v[68:71], v[40:43], 0
ds_read_b64_tr_b16 v[122:123], v6 offset:12800
v_mfma_f32_16x16x32_bf16 v[140:143], v[68:71], v[44:47], 0
ds_read_b64_tr_b16 v[124:125], v6 offset:20480
v_mfma_f32_16x16x32_bf16 v[144:147], v[68:71], v[48:51], 0
ds_read_b64_tr_b16 v[126:127], v6 offset:20992
v_mfma_f32_16x16x32_bf16 v[148:151], v[68:71], v[52:55], 0
ds_read_b64_tr_b16 v[116:117], v6 offset:4096
v_mfma_f32_16x16x32_bf16 v[152:155], v[68:71], v[56:59], 0
ds_read_b64_tr_b16 v[118:119], v6 offset:4608
v_mfma_f32_16x16x32_bf16 v[156:159], v[68:71], v[60:63], 0
ds_read_b128 v[84:87], v3 offset:2048
v_mfma_f32_16x16x32_bf16 v[160:163], v[68:71], v[64:67], 0
ds_read_b128 v[88:91], v3 offset:4096
v_mfma_f32_16x16x32_bf16 v[196:199], v[72:75], v[64:67], 0
ds_read_b128 v[92:95], v3 offset:6144
v_mfma_f32_16x16x32_bf16 v[192:195], v[72:75], v[60:63], 0
ds_read_b128 v[96:99], v3 offset:8192
v_mfma_f32_16x16x32_bf16 v[188:191], v[72:75], v[56:59], 0
ds_read_b128 v[100:103], v3 offset:10240
v_mfma_f32_16x16x32_bf16 v[184:187], v[72:75], v[52:55], 0
ds_read_b128 v[104:107], v3 offset:12288
v_mfma_f32_16x16x32_bf16 v[180:183], v[72:75], v[48:51], 0
ds_read_b128 v[108:111], v3 offset:14336
v_mfma_f32_16x16x32_bf16 v[176:179], v[72:75], v[44:47], 0
ds_read_b128 v[112:115], v3 offset:16384
v_mfma_f32_16x16x32_bf16 v[172:175], v[72:75], v[40:43], 0
v_mfma_f32_16x16x32_bf16 v[168:171], v[72:75], v[36:39], 0
v_mfma_f32_16x16x32_bf16 v[164:167], v[72:75], v[32:35], 0
v_mfma_f32_16x16x32_bf16 v[200:203], v[76:79], v[32:35], 0
v_mfma_f32_16x16x32_bf16 v[204:207], v[76:79], v[36:39], 0
v_mfma_f32_16x16x32_bf16 v[208:211], v[76:79], v[40:43], 0
v_mfma_f32_16x16x32_bf16 v[212:215], v[76:79], v[44:47], 0
v_mfma_f32_16x16x32_bf16 v[216:219], v[76:79], v[48:51], 0
v_mfma_f32_16x16x32_bf16 v[220:223], v[76:79], v[52:55], 0
v_mfma_f32_16x16x32_bf16 v[224:227], v[76:79], v[56:59], 0
v_mfma_f32_16x16x32_bf16 v[228:231], v[76:79], v[60:63], 0
v_mfma_f32_16x16x32_bf16 v[232:235], v[76:79], v[64:67], 0
s_waitcnt lgkmcnt(0)
s_barrier
v_mfma_f32_16x16x32_bf16 v[128:131], v[116:119], v[80:83], v[128:131]
ds_read_b128 v[32:35], v2 offset:43008
v_mfma_f32_16x16x32_bf16 v[132:135], v[116:119], v[84:87], v[132:135]
ds_read_b64_tr_b16 v[72:73], v7 offset:8192
v_mfma_f32_16x16x32_bf16 v[136:139], v[116:119], v[88:91], v[136:139]
ds_read_b64_tr_b16 v[74:75], v7 offset:8704
v_mfma_f32_16x16x32_bf16 v[140:143], v[116:119], v[92:95], v[140:143]
ds_read_b64_tr_b16 v[76:77], v7 offset:16384
v_mfma_f32_16x16x32_bf16 v[144:147], v[116:119], v[96:99], v[144:147]
ds_read_b64_tr_b16 v[78:79], v7 offset:16896
v_mfma_f32_16x16x32_bf16 v[148:151], v[116:119], v[100:103], v[148:151]
ds_read_b64_tr_b16 v[68:69], v7 offset:0
v_mfma_f32_16x16x32_bf16 v[152:155], v[116:119], v[104:107], v[152:155]
ds_read_b64_tr_b16 v[70:71], v7 offset:512
v_mfma_f32_16x16x32_bf16 v[156:159], v[116:119], v[108:111], v[156:159]
ds_read_b128 v[36:39], v2 offset:45056
v_mfma_f32_16x16x32_bf16 v[160:163], v[116:119], v[112:115], v[160:163]
ds_read_b128 v[40:43], v2 offset:47104
v_mfma_f32_16x16x32_bf16 v[196:199], v[120:123], v[112:115], v[196:199]
ds_read_b128 v[44:47], v2 offset:49152
v_mfma_f32_16x16x32_bf16 v[192:195], v[120:123], v[108:111], v[192:195]
ds_read_b128 v[48:51], v2 offset:51200
v_mfma_f32_16x16x32_bf16 v[188:191], v[120:123], v[104:107], v[188:191]
ds_read_b128 v[52:55], v2 offset:53248
v_mfma_f32_16x16x32_bf16 v[184:187], v[120:123], v[100:103], v[184:187]
ds_read_b128 v[56:59], v2 offset:55296
v_mfma_f32_16x16x32_bf16 v[180:183], v[120:123], v[96:99], v[180:183]
ds_read_b128 v[60:63], v2 offset:57344
v_mfma_f32_16x16x32_bf16 v[176:179], v[120:123], v[92:95], v[176:179]
ds_read_b128 v[64:67], v2 offset:59392
v_mfma_f32_16x16x32_bf16 v[172:175], v[120:123], v[88:91], v[172:175]
v_mfma_f32_16x16x32_bf16 v[168:171], v[120:123], v[84:87], v[168:171]
v_mfma_f32_16x16x32_bf16 v[164:167], v[120:123], v[80:83], v[164:167]
v_mfma_f32_16x16x32_bf16 v[200:203], v[124:127], v[80:83], v[200:203]
v_mfma_f32_16x16x32_bf16 v[204:207], v[124:127], v[84:87], v[204:207]
v_mfma_f32_16x16x32_bf16 v[208:211], v[124:127], v[88:91], v[208:211]
v_mfma_f32_16x16x32_bf16 v[212:215], v[124:127], v[92:95], v[212:215]
v_mfma_f32_16x16x32_bf16 v[216:219], v[124:127], v[96:99], v[216:219]
v_mfma_f32_16x16x32_bf16 v[220:223], v[124:127], v[100:103], v[220:223]
v_mfma_f32_16x16x32_bf16 v[224:227], v[124:127], v[104:107], v[224:227]
v_mfma_f32_16x16x32_bf16 v[228:231], v[124:127], v[108:111], v[228:231]
v_mfma_f32_16x16x32_bf16 v[232:235], v[124:127], v[112:115], v[232:235]
s_waitcnt lgkmcnt(0)
v_mfma_f32_16x16x32_bf16 v[128:131], v[68:71], v[32:35], v[128:131]
ds_read_b128 v[80:83], v3 offset:43008
v_mfma_f32_16x16x32_bf16 v[132:135], v[68:71], v[36:39], v[132:135]
ds_read_b64_tr_b16 v[120:121], v7 offset:12288
v_mfma_f32_16x16x32_bf16 v[136:139], v[68:71], v[40:43], v[136:139]
ds_read_b64_tr_b16 v[122:123], v7 offset:12800
v_mfma_f32_16x16x32_bf16 v[140:143], v[68:71], v[44:47], v[140:143]
ds_read_b64_tr_b16 v[124:125], v7 offset:20480
v_mfma_f32_16x16x32_bf16 v[144:147], v[68:71], v[48:51], v[144:147]
ds_read_b64_tr_b16 v[126:127], v7 offset:20992
v_mfma_f32_16x16x32_bf16 v[148:151], v[68:71], v[52:55], v[148:151]
ds_read_b64_tr_b16 v[116:117], v7 offset:4096
v_mfma_f32_16x16x32_bf16 v[152:155], v[68:71], v[56:59], v[152:155]
ds_read_b64_tr_b16 v[118:119], v7 offset:4608
v_mfma_f32_16x16x32_bf16 v[156:159], v[68:71], v[60:63], v[156:159]
ds_read_b128 v[84:87], v3 offset:45056
v_mfma_f32_16x16x32_bf16 v[160:163], v[68:71], v[64:67], v[160:163]
ds_read_b128 v[88:91], v3 offset:47104
v_mfma_f32_16x16x32_bf16 v[196:199], v[72:75], v[64:67], v[196:199]
ds_read_b128 v[92:95], v3 offset:49152
v_mfma_f32_16x16x32_bf16 v[192:195], v[72:75], v[60:63], v[192:195]
ds_read_b128 v[96:99], v3 offset:51200
v_mfma_f32_16x16x32_bf16 v[188:191], v[72:75], v[56:59], v[188:191]
ds_read_b128 v[100:103], v3 offset:53248
v_mfma_f32_16x16x32_bf16 v[184:187], v[72:75], v[52:55], v[184:187]
ds_read_b128 v[104:107], v3 offset:55296
v_mfma_f32_16x16x32_bf16 v[180:183], v[72:75], v[48:51], v[180:183]
ds_read_b128 v[108:111], v3 offset:57344
v_mfma_f32_16x16x32_bf16 v[176:179], v[72:75], v[44:47], v[176:179]
ds_read_b128 v[112:115], v3 offset:59392
v_mfma_f32_16x16x32_bf16 v[172:175], v[72:75], v[40:43], v[172:175]
v_mfma_f32_16x16x32_bf16 v[168:171], v[72:75], v[36:39], v[168:171]
v_mfma_f32_16x16x32_bf16 v[164:167], v[72:75], v[32:35], v[164:167]
v_mfma_f32_16x16x32_bf16 v[200:203], v[76:79], v[32:35], v[200:203]
v_mfma_f32_16x16x32_bf16 v[204:207], v[76:79], v[36:39], v[204:207]
v_mfma_f32_16x16x32_bf16 v[208:211], v[76:79], v[40:43], v[208:211]
v_mfma_f32_16x16x32_bf16 v[212:215], v[76:79], v[44:47], v[212:215]
v_mfma_f32_16x16x32_bf16 v[216:219], v[76:79], v[48:51], v[216:219]
v_mfma_f32_16x16x32_bf16 v[220:223], v[76:79], v[52:55], v[220:223]
v_mfma_f32_16x16x32_bf16 v[224:227], v[76:79], v[56:59], v[224:227]
v_mfma_f32_16x16x32_bf16 v[228:231], v[76:79], v[60:63], v[228:231]
v_mfma_f32_16x16x32_bf16 v[232:235], v[76:79], v[64:67], v[232:235]
s_waitcnt lgkmcnt(0)
s_barrier
v_mfma_f32_16x16x32_bf16 v[128:131], v[116:119], v[80:83], v[128:131]
ds_read_b128 v[32:35], v4 offset:0
v_mfma_f32_16x16x32_bf16 v[132:135], v[116:119], v[84:87], v[132:135]
ds_read_b64_tr_b16 v[72:73], v8 offset:8192
v_mfma_f32_16x16x32_bf16 v[136:139], v[116:119], v[88:91], v[136:139]
ds_read_b64_tr_b16 v[74:75], v8 offset:8704
v_mfma_f32_16x16x32_bf16 v[140:143], v[116:119], v[92:95], v[140:143]
ds_read_b64_tr_b16 v[76:77], v8 offset:16384
v_mfma_f32_16x16x32_bf16 v[144:147], v[116:119], v[96:99], v[144:147]
ds_read_b64_tr_b16 v[78:79], v8 offset:16896
v_mfma_f32_16x16x32_bf16 v[148:151], v[116:119], v[100:103], v[148:151]
ds_read_b64_tr_b16 v[68:69], v8 offset:0
v_mfma_f32_16x16x32_bf16 v[152:155], v[116:119], v[104:107], v[152:155]
ds_read_b64_tr_b16 v[70:71], v8 offset:512
v_mfma_f32_16x16x32_bf16 v[156:159], v[116:119], v[108:111], v[156:159]
ds_read_b128 v[36:39], v4 offset:2048
v_mfma_f32_16x16x32_bf16 v[160:163], v[116:119], v[112:115], v[160:163]
ds_read_b128 v[40:43], v4 offset:4096
v_mfma_f32_16x16x32_bf16 v[196:199], v[120:123], v[112:115], v[196:199]
ds_read_b128 v[44:47], v4 offset:6144
v_mfma_f32_16x16x32_bf16 v[192:195], v[120:123], v[108:111], v[192:195]
ds_read_b128 v[48:51], v4 offset:8192
v_mfma_f32_16x16x32_bf16 v[188:191], v[120:123], v[104:107], v[188:191]
ds_read_b128 v[52:55], v4 offset:10240
v_mfma_f32_16x16x32_bf16 v[184:187], v[120:123], v[100:103], v[184:187]
ds_read_b128 v[56:59], v4 offset:12288
v_mfma_f32_16x16x32_bf16 v[180:183], v[120:123], v[96:99], v[180:183]
ds_read_b128 v[60:63], v4 offset:14336
v_mfma_f32_16x16x32_bf16 v[176:179], v[120:123], v[92:95], v[176:179]
ds_read_b128 v[64:67], v4 offset:16384
v_mfma_f32_16x16x32_bf16 v[172:175], v[120:123], v[88:91], v[172:175]
v_mfma_f32_16x16x32_bf16 v[168:171], v[120:123], v[84:87], v[168:171]
v_mfma_f32_16x16x32_bf16 v[164:167], v[120:123], v[80:83], v[164:167]
v_mfma_f32_16x16x32_bf16 v[200:203], v[124:127], v[80:83], v[200:203]
v_mfma_f32_16x16x32_bf16 v[204:207], v[124:127], v[84:87], v[204:207]
v_mfma_f32_16x16x32_bf16 v[208:211], v[124:127], v[88:91], v[208:211]
v_mfma_f32_16x16x32_bf16 v[212:215], v[124:127], v[92:95], v[212:215]
v_mfma_f32_16x16x32_bf16 v[216:219], v[124:127], v[96:99], v[216:219]
v_mfma_f32_16x16x32_bf16 v[220:223], v[124:127], v[100:103], v[220:223]
v_mfma_f32_16x16x32_bf16 v[224:227], v[124:127], v[104:107], v[224:227]
v_mfma_f32_16x16x32_bf16 v[228:231], v[124:127], v[108:111], v[228:231]
v_mfma_f32_16x16x32_bf16 v[232:235], v[124:127], v[112:115], v[232:235]
s_waitcnt lgkmcnt(0)
v_mfma_f32_16x16x32_bf16 v[128:131], v[68:71], v[32:35], v[128:131]
ds_read_b128 v[80:83], v5 offset:0
v_mfma_f32_16x16x32_bf16 v[132:135], v[68:71], v[36:39], v[132:135]
ds_read_b64_tr_b16 v[120:121], v8 offset:12288
v_mfma_f32_16x16x32_bf16 v[136:139], v[68:71], v[40:43], v[136:139]
ds_read_b64_tr_b16 v[122:123], v8 offset:12800
v_mfma_f32_16x16x32_bf16 v[140:143], v[68:71], v[44:47], v[140:143]
ds_read_b64_tr_b16 v[124:125], v8 offset:20480
v_mfma_f32_16x16x32_bf16 v[144:147], v[68:71], v[48:51], v[144:147]
ds_read_b64_tr_b16 v[126:127], v8 offset:20992
v_mfma_f32_16x16x32_bf16 v[148:151], v[68:71], v[52:55], v[148:151]
ds_read_b64_tr_b16 v[116:117], v8 offset:4096
v_mfma_f32_16x16x32_bf16 v[152:155], v[68:71], v[56:59], v[152:155]
ds_read_b64_tr_b16 v[118:119], v8 offset:4608
v_mfma_f32_16x16x32_bf16 v[156:159], v[68:71], v[60:63], v[156:159]
ds_read_b128 v[84:87], v5 offset:2048
v_mfma_f32_16x16x32_bf16 v[160:163], v[68:71], v[64:67], v[160:163]
ds_read_b128 v[88:91], v5 offset:4096
v_mfma_f32_16x16x32_bf16 v[196:199], v[72:75], v[64:67], v[196:199]
ds_read_b128 v[92:95], v5 offset:6144
v_mfma_f32_16x16x32_bf16 v[192:195], v[72:75], v[60:63], v[192:195]
ds_read_b128 v[96:99], v5 offset:8192
v_mfma_f32_16x16x32_bf16 v[188:191], v[72:75], v[56:59], v[188:191]
ds_read_b128 v[100:103], v5 offset:10240
v_mfma_f32_16x16x32_bf16 v[184:187], v[72:75], v[52:55], v[184:187]
ds_read_b128 v[104:107], v5 offset:12288
v_mfma_f32_16x16x32_bf16 v[180:183], v[72:75], v[48:51], v[180:183]
ds_read_b128 v[108:111], v5 offset:14336
v_mfma_f32_16x16x32_bf16 v[176:179], v[72:75], v[44:47], v[176:179]
ds_read_b128 v[112:115], v5 offset:16384
v_mfma_f32_16x16x32_bf16 v[172:175], v[72:75], v[40:43], v[172:175]
v_mfma_f32_16x16x32_bf16 v[168:171], v[72:75], v[36:39], v[168:171]
v_mfma_f32_16x16x32_bf16 v[164:167], v[72:75], v[32:35], v[164:167]
v_mfma_f32_16x16x32_bf16 v[200:203], v[76:79], v[32:35], v[200:203]
v_mfma_f32_16x16x32_bf16 v[204:207], v[76:79], v[36:39], v[204:207]
v_mfma_f32_16x16x32_bf16 v[208:211], v[76:79], v[40:43], v[208:211]
v_mfma_f32_16x16x32_bf16 v[212:215], v[76:79], v[44:47], v[212:215]
v_mfma_f32_16x16x32_bf16 v[216:219], v[76:79], v[48:51], v[216:219]
v_mfma_f32_16x16x32_bf16 v[220:223], v[76:79], v[52:55], v[220:223]
v_mfma_f32_16x16x32_bf16 v[224:227], v[76:79], v[56:59], v[224:227]
v_mfma_f32_16x16x32_bf16 v[228:231], v[76:79], v[60:63], v[228:231]
v_mfma_f32_16x16x32_bf16 v[232:235], v[76:79], v[64:67], v[232:235]
s_waitcnt lgkmcnt(0)
s_barrier
v_mfma_f32_16x16x32_bf16 v[128:131], v[116:119], v[80:83], v[128:131]
ds_read_b128 v[32:35], v2 offset:0
v_mfma_f32_16x16x32_bf16 v[132:135], v[116:119], v[84:87], v[132:135]
ds_read_b64_tr_b16 v[72:73], v6 offset:8192
v_mfma_f32_16x16x32_bf16 v[136:139], v[116:119], v[88:91], v[136:139]
ds_read_b64_tr_b16 v[74:75], v6 offset:8704
v_mfma_f32_16x16x32_bf16 v[140:143], v[116:119], v[92:95], v[140:143]
ds_read_b64_tr_b16 v[76:77], v6 offset:16384
v_mfma_f32_16x16x32_bf16 v[144:147], v[116:119], v[96:99], v[144:147]
ds_read_b64_tr_b16 v[78:79], v6 offset:16896
v_mfma_f32_16x16x32_bf16 v[148:151], v[116:119], v[100:103], v[148:151]
ds_read_b64_tr_b16 v[68:69], v6 offset:0
v_mfma_f32_16x16x32_bf16 v[152:155], v[116:119], v[104:107], v[152:155]
ds_read_b64_tr_b16 v[70:71], v6 offset:512
v_mfma_f32_16x16x32_bf16 v[156:159], v[116:119], v[108:111], v[156:159]
ds_read_b128 v[36:39], v2 offset:2048
v_mfma_f32_16x16x32_bf16 v[160:163], v[116:119], v[112:115], v[160:163]
ds_read_b128 v[40:43], v2 offset:4096
v_mfma_f32_16x16x32_bf16 v[196:199], v[120:123], v[112:115], v[196:199]
ds_read_b128 v[44:47], v2 offset:6144
v_mfma_f32_16x16x32_bf16 v[192:195], v[120:123], v[108:111], v[192:195]
ds_read_b128 v[48:51], v2 offset:8192
v_mfma_f32_16x16x32_bf16 v[188:191], v[120:123], v[104:107], v[188:191]
ds_read_b128 v[52:55], v2 offset:10240
v_mfma_f32_16x16x32_bf16 v[184:187], v[120:123], v[100:103], v[184:187]
ds_read_b128 v[56:59], v2 offset:12288
v_mfma_f32_16x16x32_bf16 v[180:183], v[120:123], v[96:99], v[180:183]
ds_read_b128 v[60:63], v2 offset:14336
v_mfma_f32_16x16x32_bf16 v[176:179], v[120:123], v[92:95], v[176:179]
ds_read_b128 v[64:67], v2 offset:16384
v_mfma_f32_16x16x32_bf16 v[172:175], v[120:123], v[88:91], v[172:175]
v_mfma_f32_16x16x32_bf16 v[168:171], v[120:123], v[84:87], v[168:171]
v_mfma_f32_16x16x32_bf16 v[164:167], v[120:123], v[80:83], v[164:167]
v_mfma_f32_16x16x32_bf16 v[200:203], v[124:127], v[80:83], v[200:203]
v_mfma_f32_16x16x32_bf16 v[204:207], v[124:127], v[84:87], v[204:207]
v_mfma_f32_16x16x32_bf16 v[208:211], v[124:127], v[88:91], v[208:211]
v_mfma_f32_16x16x32_bf16 v[212:215], v[124:127], v[92:95], v[212:215]
v_mfma_f32_16x16x32_bf16 v[216:219], v[124:127], v[96:99], v[216:219]
v_mfma_f32_16x16x32_bf16 v[220:223], v[124:127], v[100:103], v[220:223]
v_mfma_f32_16x16x32_bf16 v[224:227], v[124:127], v[104:107], v[224:227]
v_mfma_f32_16x16x32_bf16 v[228:231], v[124:127], v[108:111], v[228:231]
v_mfma_f32_16x16x32_bf16 v[232:235], v[124:127], v[112:115], v[232:235]
s_mov_b32 s41, 4
Lcl_31:
s_waitcnt lgkmcnt(0)
v_mfma_f32_16x16x32_bf16 v[128:131], v[68:71], v[32:35], v[128:131]
ds_read_b128 v[80:83], v3 offset:0
v_mfma_f32_16x16x32_bf16 v[132:135], v[68:71], v[36:39], v[132:135]
ds_read_b64_tr_b16 v[120:121], v6 offset:12288
v_mfma_f32_16x16x32_bf16 v[136:139], v[68:71], v[40:43], v[136:139]
ds_read_b64_tr_b16 v[122:123], v6 offset:12800
v_mfma_f32_16x16x32_bf16 v[140:143], v[68:71], v[44:47], v[140:143]
ds_read_b64_tr_b16 v[124:125], v6 offset:20480
v_mfma_f32_16x16x32_bf16 v[144:147], v[68:71], v[48:51], v[144:147]
ds_read_b64_tr_b16 v[126:127], v6 offset:20992
v_mfma_f32_16x16x32_bf16 v[148:151], v[68:71], v[52:55], v[148:151]
ds_read_b64_tr_b16 v[116:117], v6 offset:4096
v_mfma_f32_16x16x32_bf16 v[152:155], v[68:71], v[56:59], v[152:155]
ds_read_b64_tr_b16 v[118:119], v6 offset:4608
v_mfma_f32_16x16x32_bf16 v[156:159], v[68:71], v[60:63], v[156:159]
ds_read_b128 v[84:87], v3 offset:2048
v_mfma_f32_16x16x32_bf16 v[160:163], v[68:71], v[64:67], v[160:163]
ds_read_b128 v[88:91], v3 offset:4096
v_mfma_f32_16x16x32_bf16 v[196:199], v[72:75], v[64:67], v[196:199]
ds_read_b128 v[92:95], v3 offset:6144
v_mfma_f32_16x16x32_bf16 v[192:195], v[72:75], v[60:63], v[192:195]
ds_read_b128 v[96:99], v3 offset:8192
v_mfma_f32_16x16x32_bf16 v[188:191], v[72:75], v[56:59], v[188:191]
ds_read_b128 v[100:103], v3 offset:10240
v_mfma_f32_16x16x32_bf16 v[184:187], v[72:75], v[52:55], v[184:187]
ds_read_b128 v[104:107], v3 offset:12288
v_mfma_f32_16x16x32_bf16 v[180:183], v[72:75], v[48:51], v[180:183]
ds_read_b128 v[108:111], v3 offset:14336
v_mfma_f32_16x16x32_bf16 v[176:179], v[72:75], v[44:47], v[176:179]
ds_read_b128 v[112:115], v3 offset:16384
v_mfma_f32_16x16x32_bf16 v[172:175], v[72:75], v[40:43], v[172:175]
v_mfma_f32_16x16x32_bf16 v[168:171], v[72:75], v[36:39], v[168:171]
v_mfma_f32_16x16x32_bf16 v[164:167], v[72:75], v[32:35], v[164:167]
v_mfma_f32_16x16x32_bf16 v[200:203], v[76:79], v[32:35], v[200:203]
v_mfma_f32_16x16x32_bf16 v[204:207], v[76:79], v[36:39], v[204:207]
v_mfma_f32_16x16x32_bf16 v[208:211], v[76:79], v[40:43], v[208:211]
v_mfma_f32_16x16x32_bf16 v[212:215], v[76:79], v[44:47], v[212:215]
v_mfma_f32_16x16x32_bf16 v[216:219], v[76:79], v[48:51], v[216:219]
v_mfma_f32_16x16x32_bf16 v[220:223], v[76:79], v[52:55], v[220:223]
v_mfma_f32_16x16x32_bf16 v[224:227], v[76:79], v[56:59], v[224:227]
v_mfma_f32_16x16x32_bf16 v[228:231], v[76:79], v[60:63], v[228:231]
v_mfma_f32_16x16x32_bf16 v[232:235], v[76:79], v[64:67], v[232:235]
s_waitcnt lgkmcnt(0)
s_barrier
v_mfma_f32_16x16x32_bf16 v[128:131], v[116:119], v[80:83], v[128:131]
s_branch Lov_2
.p2align 12
.fill 16, 4, 0xbf800000
Lst_2_0:
s_branch Lwr_162
s_nop 0
s_nop 0
Lov_2:
ds_read_b128 v[32:35], v2 offset:43008
v_mfma_f32_16x16x32_bf16 v[132:135], v[116:119], v[84:87], v[132:135]
ds_read_b64_tr_b16 v[72:73], v7 offset:8192
v_mfma_f32_16x16x32_bf16 v[136:139], v[116:119], v[88:91], v[136:139]
ds_read_b64_tr_b16 v[74:75], v7 offset:8704
v_mfma_f32_16x16x32_bf16 v[140:143], v[116:119], v[92:95], v[140:143]
ds_read_b64_tr_b16 v[76:77], v7 offset:16384
v_mfma_f32_16x16x32_bf16 v[144:147], v[116:119], v[96:99], v[144:147]
ds_read_b64_tr_b16 v[78:79], v7 offset:16896
v_mfma_f32_16x16x32_bf16 v[148:151], v[116:119], v[100:103], v[148:151]
ds_read_b64_tr_b16 v[68:69], v7 offset:0
v_mfma_f32_16x16x32_bf16 v[152:155], v[116:119], v[104:107], v[152:155]
ds_read_b64_tr_b16 v[70:71], v7 offset:512
v_mfma_f32_16x16x32_bf16 v[156:159], v[116:119], v[108:111], v[156:159]
ds_read_b128 v[36:39], v2 offset:45056
v_mfma_f32_16x16x32_bf16 v[160:163], v[116:119], v[112:115], v[160:163]
ds_read_b128 v[40:43], v2 offset:47104
v_mfma_f32_16x16x32_bf16 v[196:199], v[120:123], v[112:115], v[196:199]
ds_read_b128 v[44:47], v2 offset:49152
v_mfma_f32_16x16x32_bf16 v[192:195], v[120:123], v[108:111], v[192:195]
ds_read_b128 v[48:51], v2 offset:51200
v_mfma_f32_16x16x32_bf16 v[188:191], v[120:123], v[104:107], v[188:191]
ds_read_b128 v[52:55], v2 offset:53248
v_mfma_f32_16x16x32_bf16 v[184:187], v[120:123], v[100:103], v[184:187]
ds_read_b128 v[56:59], v2 offset:55296
v_mfma_f32_16x16x32_bf16 v[180:183], v[120:123], v[96:99], v[180:183]
ds_read_b128 v[60:63], v2 offset:57344
v_mfma_f32_16x16x32_bf16 v[176:179], v[120:123], v[92:95], v[176:179]
ds_read_b128 v[64:67], v2 offset:59392
v_mfma_f32_16x16x32_bf16 v[172:175], v[120:123], v[88:91], v[172:175]
v_mfma_f32_16x16x32_bf16 v[168:171], v[120:123], v[84:87], v[168:171]
v_mfma_f32_16x16x32_bf16 v[164:167], v[120:123], v[80:83], v[164:167]
v_mfma_f32_16x16x32_bf16 v[200:203], v[124:127], v[80:83], v[200:203]
v_mfma_f32_16x16x32_bf16 v[204:207], v[124:127], v[84:87], v[204:207]
v_mfma_f32_16x16x32_bf16 v[208:211], v[124:127], v[88:91], v[208:211]
v_mfma_f32_16x16x32_bf16 v[212:215], v[124:127], v[92:95], v[212:215]
v_mfma_f32_16x16x32_bf16 v[216:219], v[124:127], v[96:99], v[216:219]
v_mfma_f32_16x16x32_bf16 v[220:223], v[124:127], v[100:103], v[220:223]
v_mfma_f32_16x16x32_bf16 v[224:227], v[124:127], v[104:107], v[224:227]
v_mfma_f32_16x16x32_bf16 v[228:231], v[124:127], v[108:111], v[228:231]
v_mfma_f32_16x16x32_bf16 v[232:235], v[124:127], v[112:115], v[232:235]
s_waitcnt lgkmcnt(0)
v_mfma_f32_16x16x32_bf16 v[128:131], v[68:71], v[32:35], v[128:131]
ds_read_b128 v[80:83], v3 offset:43008
v_mfma_f32_16x16x32_bf16 v[132:135], v[68:71], v[36:39], v[132:135]
ds_read_b64_tr_b16 v[120:121], v7 offset:12288
v_mfma_f32_16x16x32_bf16 v[136:139], v[68:71], v[40:43], v[136:139]
ds_read_b64_tr_b16 v[122:123], v7 offset:12800
v_mfma_f32_16x16x32_bf16 v[140:143], v[68:71], v[44:47], v[140:143]
ds_read_b64_tr_b16 v[124:125], v7 offset:20480
v_mfma_f32_16x16x32_bf16 v[144:147], v[68:71], v[48:51], v[144:147]
ds_read_b64_tr_b16 v[126:127], v7 offset:20992
v_mfma_f32_16x16x32_bf16 v[148:151], v[68:71], v[52:55], v[148:151]
ds_read_b64_tr_b16 v[116:117], v7 offset:4096
v_mfma_f32_16x16x32_bf16 v[152:155], v[68:71], v[56:59], v[152:155]
ds_read_b64_tr_b16 v[118:119], v7 offset:4608
v_mfma_f32_16x16x32_bf16 v[156:159], v[68:71], v[60:63], v[156:159]
ds_read_b128 v[84:87], v3 offset:45056
v_mfma_f32_16x16x32_bf16 v[160:163], v[68:71], v[64:67], v[160:163]
ds_read_b128 v[88:91], v3 offset:47104
v_mfma_f32_16x16x32_bf16 v[196:199], v[72:75], v[64:67], v[196:199]
ds_read_b128 v[92:95], v3 offset:49152
v_mfma_f32_16x16x32_bf16 v[192:195], v[72:75], v[60:63], v[192:195]
ds_read_b128 v[96:99], v3 offset:51200
v_mfma_f32_16x16x32_bf16 v[188:191], v[72:75], v[56:59], v[188:191]
ds_read_b128 v[100:103], v3 offset:53248
v_mfma_f32_16x16x32_bf16 v[184:187], v[72:75], v[52:55], v[184:187]
ds_read_b128 v[104:107], v3 offset:55296
v_mfma_f32_16x16x32_bf16 v[180:183], v[72:75], v[48:51], v[180:183]
ds_read_b128 v[108:111], v3 offset:57344
v_mfma_f32_16x16x32_bf16 v[176:179], v[72:75], v[44:47], v[176:179]
ds_read_b128 v[112:115], v3 offset:59392
v_mfma_f32_16x16x32_bf16 v[172:175], v[72:75], v[40:43], v[172:175]
v_mfma_f32_16x16x32_bf16 v[168:171], v[72:75], v[36:39], v[168:171]
v_mfma_f32_16x16x32_bf16 v[164:167], v[72:75], v[32:35], v[164:167]
v_mfma_f32_16x16x32_bf16 v[200:203], v[76:79], v[32:35], v[200:203]
v_mfma_f32_16x16x32_bf16 v[204:207], v[76:79], v[36:39], v[204:207]
v_mfma_f32_16x16x32_bf16 v[208:211], v[76:79], v[40:43], v[208:211]
v_mfma_f32_16x16x32_bf16 v[212:215], v[76:79], v[44:47], v[212:215]
v_mfma_f32_16x16x32_bf16 v[216:219], v[76:79], v[48:51], v[216:219]
v_mfma_f32_16x16x32_bf16 v[220:223], v[76:79], v[52:55], v[220:223]
v_mfma_f32_16x16x32_bf16 v[224:227], v[76:79], v[56:59], v[224:227]
v_mfma_f32_16x16x32_bf16 v[228:231], v[76:79], v[60:63], v[228:231]
v_mfma_f32_16x16x32_bf16 v[232:235], v[76:79], v[64:67], v[232:235]
s_waitcnt lgkmcnt(0)
s_barrier
v_mfma_f32_16x16x32_bf16 v[128:131], v[116:119], v[80:83], v[128:131]
ds_read_b128 v[32:35], v4 offset:0
v_mfma_f32_16x16x32_bf16 v[132:135], v[116:119], v[84:87], v[132:135]
ds_read_b64_tr_b16 v[72:73], v8 offset:8192
v_mfma_f32_16x16x32_bf16 v[136:139], v[116:119], v[88:91], v[136:139]
ds_read_b64_tr_b16 v[74:75], v8 offset:8704
v_mfma_f32_16x16x32_bf16 v[140:143], v[116:119], v[92:95], v[140:143]
ds_read_b64_tr_b16 v[76:77], v8 offset:16384
v_mfma_f32_16x16x32_bf16 v[144:147], v[116:119], v[96:99], v[144:147]
ds_read_b64_tr_b16 v[78:79], v8 offset:16896
v_mfma_f32_16x16x32_bf16 v[148:151], v[116:119], v[100:103], v[148:151]
ds_read_b64_tr_b16 v[68:69], v8 offset:0
v_mfma_f32_16x16x32_bf16 v[152:155], v[116:119], v[104:107], v[152:155]
ds_read_b64_tr_b16 v[70:71], v8 offset:512
v_mfma_f32_16x16x32_bf16 v[156:159], v[116:119], v[108:111], v[156:159]
ds_read_b128 v[36:39], v4 offset:2048
v_mfma_f32_16x16x32_bf16 v[160:163], v[116:119], v[112:115], v[160:163]
ds_read_b128 v[40:43], v4 offset:4096
v_mfma_f32_16x16x32_bf16 v[196:199], v[120:123], v[112:115], v[196:199]
ds_read_b128 v[44:47], v4 offset:6144
v_mfma_f32_16x16x32_bf16 v[192:195], v[120:123], v[108:111], v[192:195]
ds_read_b128 v[48:51], v4 offset:8192
v_mfma_f32_16x16x32_bf16 v[188:191], v[120:123], v[104:107], v[188:191]
ds_read_b128 v[52:55], v4 offset:10240
v_mfma_f32_16x16x32_bf16 v[184:187], v[120:123], v[100:103], v[184:187]
ds_read_b128 v[56:59], v4 offset:12288
v_mfma_f32_16x16x32_bf16 v[180:183], v[120:123], v[96:99], v[180:183]
ds_read_b128 v[60:63], v4 offset:14336
v_mfma_f32_16x16x32_bf16 v[176:179], v[120:123], v[92:95], v[176:179]
ds_read_b128 v[64:67], v4 offset:16384
v_mfma_f32_16x16x32_bf16 v[172:175], v[120:123], v[88:91], v[172:175]
v_mfma_f32_16x16x32_bf16 v[168:171], v[120:123], v[84:87], v[168:171]
v_mfma_f32_16x16x32_bf16 v[164:167], v[120:123], v[80:83], v[164:167]
v_mfma_f32_16x16x32_bf16 v[200:203], v[124:127], v[80:83], v[200:203]
v_mfma_f32_16x16x32_bf16 v[204:207], v[124:127], v[84:87], v[204:207]
v_mfma_f32_16x16x32_bf16 v[208:211], v[124:127], v[88:91], v[208:211]
v_mfma_f32_16x16x32_bf16 v[212:215], v[124:127], v[92:95], v[212:215]
v_mfma_f32_16x16x32_bf16 v[216:219], v[124:127], v[96:99], v[216:219]
v_mfma_f32_16x16x32_bf16 v[220:223], v[124:127], v[100:103], v[220:223]
v_mfma_f32_16x16x32_bf16 v[224:227], v[124:127], v[104:107], v[224:227]
v_mfma_f32_16x16x32_bf16 v[228:231], v[124:127], v[108:111], v[228:231]
v_mfma_f32_16x16x32_bf16 v[232:235], v[124:127], v[112:115], v[232:235]
s_waitcnt lgkmcnt(0)
v_mfma_f32_16x16x32_bf16 v[128:131], v[68:71], v[32:35], v[128:131]
ds_read_b128 v[80:83], v5 offset:0
v_mfma_f32_16x16x32_bf16 v[132:135], v[68:71], v[36:39], v[132:135]
ds_read_b64_tr_b16 v[120:121], v8 offset:12288
v_mfma_f32_16x16x32_bf16 v[136:139], v[68:71], v[40:43], v[136:139]
ds_read_b64_tr_b16 v[122:123], v8 offset:12800
v_mfma_f32_16x16x32_bf16 v[140:143], v[68:71], v[44:47], v[140:143]
ds_read_b64_tr_b16 v[124:125], v8 offset:20480
v_mfma_f32_16x16x32_bf16 v[144:147], v[68:71], v[48:51], v[144:147]
ds_read_b64_tr_b16 v[126:127], v8 offset:20992
v_mfma_f32_16x16x32_bf16 v[148:151], v[68:71], v[52:55], v[148:151]
ds_read_b64_tr_b16 v[116:117], v8 offset:4096
v_mfma_f32_16x16x32_bf16 v[152:155], v[68:71], v[56:59], v[152:155]
ds_read_b64_tr_b16 v[118:119], v8 offset:4608
v_mfma_f32_16x16x32_bf16 v[156:159], v[68:71], v[60:63], v[156:159]
ds_read_b128 v[84:87], v5 offset:2048
v_mfma_f32_16x16x32_bf16 v[160:163], v[68:71], v[64:67], v[160:163]
ds_read_b128 v[88:91], v5 offset:4096
v_mfma_f32_16x16x32_bf16 v[196:199], v[72:75], v[64:67], v[196:199]
ds_read_b128 v[92:95], v5 offset:6144
v_mfma_f32_16x16x32_bf16 v[192:195], v[72:75], v[60:63], v[192:195]
ds_read_b128 v[96:99], v5 offset:8192
v_mfma_f32_16x16x32_bf16 v[188:191], v[72:75], v[56:59], v[188:191]
ds_read_b128 v[100:103], v5 offset:10240
v_mfma_f32_16x16x32_bf16 v[184:187], v[72:75], v[52:55], v[184:187]
ds_read_b128 v[104:107], v5 offset:12288
v_mfma_f32_16x16x32_bf16 v[180:183], v[72:75], v[48:51], v[180:183]
ds_read_b128 v[108:111], v5 offset:14336
v_mfma_f32_16x16x32_bf16 v[176:179], v[72:75], v[44:47], v[176:179]
ds_read_b128 v[112:115], v5 offset:16384
v_mfma_f32_16x16x32_bf16 v[172:175], v[72:75], v[40:43], v[172:175]
v_mfma_f32_16x16x32_bf16 v[168:171], v[72:75], v[36:39], v[168:171]
v_mfma_f32_16x16x32_bf16 v[164:167], v[72:75], v[32:35], v[164:167]
v_mfma_f32_16x16x32_bf16 v[200:203], v[76:79], v[32:35], v[200:203]
v_mfma_f32_16x16x32_bf16 v[204:207], v[76:79], v[36:39], v[204:207]
v_mfma_f32_16x16x32_bf16 v[208:211], v[76:79], v[40:43], v[208:211]
v_mfma_f32_16x16x32_bf16 v[212:215], v[76:79], v[44:47], v[212:215]
v_mfma_f32_16x16x32_bf16 v[216:219], v[76:79], v[48:51], v[216:219]
v_mfma_f32_16x16x32_bf16 v[220:223], v[76:79], v[52:55], v[220:223]
v_mfma_f32_16x16x32_bf16 v[224:227], v[76:79], v[56:59], v[224:227]
v_mfma_f32_16x16x32_bf16 v[228:231], v[76:79], v[60:63], v[228:231]
v_mfma_f32_16x16x32_bf16 v[232:235], v[76:79], v[64:67], v[232:235]
s_waitcnt lgkmcnt(0)
s_barrier
v_mfma_f32_16x16x32_bf16 v[128:131], v[116:119], v[80:83], v[128:131]
ds_read_b128 v[32:35], v2 offset:0
v_mfma_f32_16x16x32_bf16 v[132:135], v[116:119], v[84:87], v[132:135]
ds_read_b64_tr_b16 v[72:73], v6 offset:8192
v_mfma_f32_16x16x32_bf16 v[136:139], v[116:119], v[88:91], v[136:139]
ds_read_b64_tr_b16 v[74:75], v6 offset:8704
v_mfma_f32_16x16x32_bf16 v[140:143], v[116:119], v[92:95], v[140:143]
ds_read_b64_tr_b16 v[76:77], v6 offset:16384
v_mfma_f32_16x16x32_bf16 v[144:147], v[116:119], v[96:99], v[144:147]
ds_read_b64_tr_b16 v[78:79], v6 offset:16896
v_mfma_f32_16x16x32_bf16 v[148:151], v[116:119], v[100:103], v[148:151]
ds_read_b64_tr_b16 v[68:69], v6 offset:0
v_mfma_f32_16x16x32_bf16 v[152:155], v[116:119], v[104:107], v[152:155]
ds_read_b64_tr_b16 v[70:71], v6 offset:512
v_mfma_f32_16x16x32_bf16 v[156:159], v[116:119], v[108:111], v[156:159]
ds_read_b128 v[36:39], v2 offset:2048
v_mfma_f32_16x16x32_bf16 v[160:163], v[116:119], v[112:115], v[160:163]
ds_read_b128 v[40:43], v2 offset:4096
v_mfma_f32_16x16x32_bf16 v[196:199], v[120:123], v[112:115], v[196:199]
ds_read_b128 v[44:47], v2 offset:6144
v_mfma_f32_16x16x32_bf16 v[192:195], v[120:123], v[108:111], v[192:195]
ds_read_b128 v[48:51], v2 offset:8192
v_mfma_f32_16x16x32_bf16 v[188:191], v[120:123], v[104:107], v[188:191]
ds_read_b128 v[52:55], v2 offset:10240
v_mfma_f32_16x16x32_bf16 v[184:187], v[120:123], v[100:103], v[184:187]
ds_read_b128 v[56:59], v2 offset:12288
v_mfma_f32_16x16x32_bf16 v[180:183], v[120:123], v[96:99], v[180:183]
ds_read_b128 v[60:63], v2 offset:14336
v_mfma_f32_16x16x32_bf16 v[176:179], v[120:123], v[92:95], v[176:179]
ds_read_b128 v[64:67], v2 offset:16384
v_mfma_f32_16x16x32_bf16 v[172:175], v[120:123], v[88:91], v[172:175]
v_mfma_f32_16x16x32_bf16 v[168:171], v[120:123], v[84:87], v[168:171]
v_mfma_f32_16x16x32_bf16 v[164:167], v[120:123], v[80:83], v[164:167]
v_mfma_f32_16x16x32_bf16 v[200:203], v[124:127], v[80:83], v[200:203]
v_mfma_f32_16x16x32_bf16 v[204:207], v[124:127], v[84:87], v[204:207]
v_mfma_f32_16x16x32_bf16 v[208:211], v[124:127], v[88:91], v[208:211]
v_mfma_f32_16x16x32_bf16 v[212:215], v[124:127], v[92:95], v[212:215]
v_mfma_f32_16x16x32_bf16 v[216:219], v[124:127], v[96:99], v[216:219]
v_mfma_f32_16x16x32_bf16 v[220:223], v[124:127], v[100:103], v[220:223]
v_mfma_f32_16x16x32_bf16 v[224:227], v[124:127], v[104:107], v[224:227]
v_mfma_f32_16x16x32_bf16 v[228:231], v[124:127], v[108:111], v[228:231]
v_mfma_f32_16x16x32_bf16 v[232:235], v[124:127], v[112:115], v[232:235]
s_sub_u32 s41, s41, 1
s_cmp_lg_u32 s41, 0
s_cbranch_scc1 Lcl_31
s_waitcnt lgkmcnt(0)
v_mfma_f32_16x16x32_bf16 v[128:131], v[68:71], v[32:35], v[128:131]
ds_read_b128 v[80:83], v3 offset:0
v_mfma_f32_16x16x32_bf16 v[132:135], v[68:71], v[36:39], v[132:135]
ds_read_b64_tr_b16 v[120:121], v6 offset:12288
v_mfma_f32_16x16x32_bf16 v[136:139], v[68:71], v[40:43], v[136:139]
ds_read_b64_tr_b16 v[122:123], v6 offset:12800
v_mfma_f32_16x16x32_bf16 v[140:143], v[68:71], v[44:47], v[140:143]
ds_read_b64_tr_b16 v[124:125], v6 offset:20480
v_mfma_f32_16x16x32_bf16 v[144:147], v[68:71], v[48:51], v[144:147]
ds_read_b64_tr_b16 v[126:127], v6 offset:20992
v_mfma_f32_16x16x32_bf16 v[148:151], v[68:71], v[52:55], v[148:151]
ds_read_b64_tr_b16 v[116:117], v6 offset:4096
v_mfma_f32_16x16x32_bf16 v[152:155], v[68:71], v[56:59], v[152:155]
ds_read_b64_tr_b16 v[118:119], v6 offset:4608
v_mfma_f32_16x16x32_bf16 v[156:159], v[68:71], v[60:63], v[156:159]
ds_read_b128 v[84:87], v3 offset:2048
v_mfma_f32_16x16x32_bf16 v[160:163], v[68:71], v[64:67], v[160:163]
ds_read_b128 v[88:91], v3 offset:4096
v_mfma_f32_16x16x32_bf16 v[196:199], v[72:75], v[64:67], v[196:199]
ds_read_b128 v[92:95], v3 offset:6144
v_mfma_f32_16x16x32_bf16 v[192:195], v[72:75], v[60:63], v[192:195]
ds_read_b128 v[96:99], v3 offset:8192
v_mfma_f32_16x16x32_bf16 v[188:191], v[72:75], v[56:59], v[188:191]
ds_read_b128 v[100:103], v3 offset:10240
v_mfma_f32_16x16x32_bf16 v[184:187], v[72:75], v[52:55], v[184:187]
ds_read_b128 v[104:107], v3 offset:12288
v_mfma_f32_16x16x32_bf16 v[180:183], v[72:75], v[48:51], v[180:183]
ds_read_b128 v[108:111], v3 offset:14336
v_mfma_f32_16x16x32_bf16 v[176:179], v[72:75], v[44:47], v[176:179]
ds_read_b128 v[112:115], v3 offset:16384
v_mfma_f32_16x16x32_bf16 v[172:175], v[72:75], v[40:43], v[172:175]
v_mfma_f32_16x16x32_bf16 v[168:171], v[72:75], v[36:39], v[168:171]
v_mfma_f32_16x16x32_bf16 v[164:167], v[72:75], v[32:35], v[164:167]
v_mfma_f32_16x16x32_bf16 v[200:203], v[76:79], v[32:35], v[200:203]
v_mfma_f32_16x16x32_bf16 v[204:207], v[76:79], v[36:39], v[204:207]
v_mfma_f32_16x16x32_bf16 v[208:211], v[76:79], v[40:43], v[208:211]
v_mfma_f32_16x16x32_bf16 v[212:215], v[76:79], v[44:47], v[212:215]
v_mfma_f32_16x16x32_bf16 v[216:219], v[76:79], v[48:51], v[216:219]
v_mfma_f32_16x16x32_bf16 v[220:223], v[76:79], v[52:55], v[220:223]
v_mfma_f32_16x16x32_bf16 v[224:227], v[76:79], v[56:59], v[224:227]
v_mfma_f32_16x16x32_bf16 v[228:231], v[76:79], v[60:63], v[228:231]
v_mfma_f32_16x16x32_bf16 v[232:235], v[76:79], v[64:67], v[232:235]
s_waitcnt lgkmcnt(0)
v_mfma_f32_16x16x32_bf16 v[128:131], v[116:119], v[80:83], v[128:131]
v_mfma_f32_16x16x32_bf16 v[132:135], v[116:119], v[84:87], v[132:135]
v_mfma_f32_16x16x32_bf16 v[136:139], v[116:119], v[88:91], v[136:139]
v_mfma_f32_16x16x32_bf16 v[140:143], v[116:119], v[92:95], v[140:143]
v_mfma_f32_16x16x32_bf16 v[144:147], v[116:119], v[96:99], v[144:147]
v_mfma_f32_16x16x32_bf16 v[148:151], v[116:119], v[100:103], v[148:151]
v_mfma_f32_16x16x32_bf16 v[152:155], v[116:119], v[104:107], v[152:155]
v_mfma_f32_16x16x32_bf16 v[156:159], v[116:119], v[108:111], v[156:159]
v_mfma_f32_16x16x32_bf16 v[160:163], v[116:119], v[112:115], v[160:163]
v_mfma_f32_16x16x32_bf16 v[196:199], v[120:123], v[112:115], v[196:199]
v_mfma_f32_16x16x32_bf16 v[192:195], v[120:123], v[108:111], v[192:195]
v_mfma_f32_16x16x32_bf16 v[188:191], v[120:123], v[104:107], v[188:191]
v_mfma_f32_16x16x32_bf16 v[184:187], v[120:123], v[100:103], v[184:187]
v_mfma_f32_16x16x32_bf16 v[180:183], v[120:123], v[96:99], v[180:183]
v_mfma_f32_16x16x32_bf16 v[176:179], v[120:123], v[92:95], v[176:179]
v_mfma_f32_16x16x32_bf16 v[172:175], v[120:123], v[88:91], v[172:175]
v_mfma_f32_16x16x32_bf16 v[168:171], v[120:123], v[84:87], v[168:171]
v_mfma_f32_16x16x32_bf16 v[164:167], v[120:123], v[80:83], v[164:167]
v_mfma_f32_16x16x32_bf16 v[200:203], v[124:127], v[80:83], v[200:203]
v_mfma_f32_16x16x32_bf16 v[204:207], v[124:127], v[84:87], v[204:207]
v_mfma_f32_16x16x32_bf16 v[208:211], v[124:127], v[88:91], v[208:211]
v_mfma_f32_16x16x32_bf16 v[212:215], v[124:127], v[92:95], v[212:215]
v_mfma_f32_16x16x32_bf16 v[216:219], v[124:127], v[96:99], v[216:219]
v_mfma_f32_16x16x32_bf16 v[220:223], v[124:127], v[100:103], v[220:223]
v_mfma_f32_16x16x32_bf16 v[224:227], v[124:127], v[104:107], v[224:227]
v_mfma_f32_16x16x32_bf16 v[228:231], v[124:127], v[108:111], v[228:231]
v_mfma_f32_16x16x32_bf16 v[232:235], v[124:127], v[112:115], v[232:235]
Lepi:
v_lshlrev_b32 v14, 3, v12
v_add_u32 v14, 147456, v14
v_mul_u32_u24 v15, 400, v12
v_lshl_add_u32 v15, v13, 3, v15
s_lshl_b32 s43, s36, 5
v_add_u32 v15, s43, v15
s_barrier
ds_read_b64 v[32:33], v14 offset:0
ds_read_b64 v[34:35], v14 offset:128
ds_read_b64 v[36:37], v14 offset:256
ds_read_b64 v[38:39], v14 offset:384
ds_read_b64 v[40:41], v14 offset:512
ds_read_b64 v[42:43], v14 offset:640
ds_read_b64 v[44:45], v14 offset:768
ds_read_b64 v[46:47], v14 offset:896
ds_read_b64 v[48:49], v14 offset:1024
v_mov_b32_dpp v52, v128 row_newbcast:0 row_mask:0xf bank_mask:0xf
v_mov_b32_dpp v53, v129 row_newbcast:0 row_mask:0xf bank_mask:0xf
v_mov_b32_dpp v54, v130 row_newbcast:0 row_mask:0xf bank_mask:0xf
v_mov_b32_dpp v55, v131 row_newbcast:0 row_mask:0xf bank_mask:0xf
v_mov_b32_dpp v56, v164 row_newbcast:0 row_mask:0xf bank_mask:0xf
v_mov_b32_dpp v57, v165 row_newbcast:0 row_mask:0xf bank_mask:0xf
v_mov_b32_dpp v58, v166 row_newbcast:0 row_mask:0xf bank_mask:0xf
v_mov_b32_dpp v59, v167 row_newbcast:0 row_mask:0xf bank_mask:0xf
v_mov_b32_dpp v60, v200 row_newbcast:0 row_mask:0xf bank_mask:0xf
v_mov_b32_dpp v61, v201 row_newbcast:0 row_mask:0xf bank_mask:0xf
v_mov_b32_dpp v62, v202 row_newbcast:0 row_mask:0xf bank_mask:0xf
v_mov_b32_dpp v63, v203 row_newbcast:0 row_mask:0xf bank_mask:0xf
s_waitcnt lgkmcnt(0)
v_pk_fma_f32 v[164:165], v[32:33], v[56:57], v[164:165] op_sel_hi:[0,1,1] neg_lo:[1,0,0] neg_hi:[1,0,0]
v_pk_fma_f32 v[166:167], v[32:33], v[58:59], v[166:167] op_sel_hi:[0,1,1] neg_lo:[1,0,0] neg_hi:[1,0,0]
v_pk_fma_f32 v[200:201], v[32:33], v[60:61], v[200:201] op_sel_hi:[0,1,1] neg_lo:[1,0,0] neg_hi:[1,0,0]
v_pk_fma_f32 v[202:203], v[32:33], v[62:63], v[202:203] op_sel_hi:[0,1,1] neg_lo:[1,0,0] neg_hi:[1,0,0]
v_pk_mul_f32 v[164:165], v[32:33], v[164:165] op_sel:[1,0] op_sel_hi:[1,1]
v_pk_mul_f32 v[166:167], v[32:33], v[166:167] op_sel:[1,0] op_sel_hi:[1,1]
v_pk_fma_f32 v[132:133], v[34:35], v[52:53], v[132:133] op_sel_hi:[0,1,1] neg_lo:[1,0,0] neg_hi:[1,0,0]
v_pk_fma_f32 v[134:135], v[34:35], v[54:55], v[134:135] op_sel_hi:[0,1,1] neg_lo:[1,0,0] neg_hi:[1,0,0]
v_pk_mul_f32 v[200:201], v[32:33], v[200:201] op_sel:[1,0] op_sel_hi:[1,1]
v_pk_mul_f32 v[202:203], v[32:33], v[202:203] op_sel:[1,0] op_sel_hi:[1,1]
v_cvt_pk_bf16_f32 v164, v164, v165
v_cvt_pk_bf16_f32 v165, v166, v167
ds_write_b64 v15, v[164:165] offset:128
v_pk_fma_f32 v[168:169], v[34:35], v[56:57], v[168:169] op_sel_hi:[0,1,1] neg_lo:[1,0,0] neg_hi:[1,0,0]
v_pk_fma_f32 v[170:171], v[34:35], v[58:59], v[170:171] op_sel_hi:[0,1,1] neg_lo:[1,0,0] neg_hi:[1,0,0]
v_pk_mul_f32 v[132:133], v[34:35], v[132:133] op_sel:[1,0] op_sel_hi:[1,1]
v_pk_mul_f32 v[134:135], v[34:35], v[134:135] op_sel:[1,0] op_sel_hi:[1,1]
v_cvt_pk_bf16_f32 v200, v200, v201
v_cvt_pk_bf16_f32 v201, v202, v203
ds_write_b64 v15, v[200:201] offset:256
v_pk_fma_f32 v[204:205], v[34:35], v[60:61], v[204:205] op_sel_hi:[0,1,1] neg_lo:[1,0,0] neg_hi:[1,0,0]
v_pk_fma_f32 v[206:207], v[34:35], v[62:63], v[206:207] op_sel_hi:[0,1,1] neg_lo:[1,0,0] neg_hi:[1,0,0]
v_pk_mul_f32 v[168:169], v[34:35], v[168:169] op_sel:[1,0] op_sel_hi:[1,1]
v_pk_mul_f32 v[170:171], v[34:35], v[170:171] op_sel:[1,0] op_sel_hi:[1,1]
v_cvt_pk_bf16_f32 v132, v132, v133
v_cvt_pk_bf16_f32 v133, v134, v135
ds_write_b64 v15, v[132:133] offset:6400
v_pk_fma_f32 v[136:137], v[36:37], v[52:53], v[136:137] op_sel_hi:[0,1,1] neg_lo:[1,0,0] neg_hi:[1,0,0]
v_pk_fma_f32 v[138:139], v[36:37], v[54:55], v[138:139] op_sel_hi:[0,1,1] neg_lo:[1,0,0] neg_hi:[1,0,0]
v_pk_mul_f32 v[204:205], v[34:35], v[204:205] op_sel:[1,0] op_sel_hi:[1,1]
v_pk_mul_f32 v[206:207], v[34:35], v[206:207] op_sel:[1,0] op_sel_hi:[1,1]
v_cvt_pk_bf16_f32 v168, v168, v169
v_cvt_pk_bf16_f32 v169, v170, v171
ds_write_b64 v15, v[168:169] offset:6528
v_pk_fma_f32 v[172:173], v[36:37], v[56:57], v[172:173] op_sel_hi:[0,1,1] neg_lo:[1,0,0] neg_hi:[1,0,0]
v_pk_fma_f32 v[174:175], v[36:37], v[58:59], v[174:175] op_sel_hi:[0,1,1] neg_lo:[1,0,0] neg_hi:[1,0,0]
v_pk_mul_f32 v[136:137], v[36:37], v[136:137] op_sel:[1,0] op_sel_hi:[1,1]
v_pk_mul_f32 v[138:139], v[36:37], v[138:139] op_sel:[1,0] op_sel_hi:[1,1]
v_cvt_pk_bf16_f32 v204, v204, v205
v_cvt_pk_bf16_f32 v205, v206, v207
ds_write_b64 v15, v[204:205] offset:6656
v_pk_fma_f32 v[208:209], v[36:37], v[60:61], v[208:209] op_sel_hi:[0,1,1] neg_lo:[1,0,0] neg_hi:[1,0,0]
v_pk_fma_f32 v[210:211], v[36:37], v[62:63], v[210:211] op_sel_hi:[0,1,1] neg_lo:[1,0,0] neg_hi:[1,0,0]
v_pk_mul_f32 v[172:173], v[36:37], v[172:173] op_sel:[1,0] op_sel_hi:[1,1]
v_pk_mul_f32 v[174:175], v[36:37], v[174:175] op_sel:[1,0] op_sel_hi:[1,1]
v_cvt_pk_bf16_f32 v136, v136, v137
v_cvt_pk_bf16_f32 v137, v138, v139
ds_write_b64 v15, v[136:137] offset:12800
v_pk_fma_f32 v[140:141], v[38:39], v[52:53], v[140:141] op_sel_hi:[0,1,1] neg_lo:[1,0,0] neg_hi:[1,0,0]
v_pk_fma_f32 v[142:143], v[38:39], v[54:55], v[142:143] op_sel_hi:[0,1,1] neg_lo:[1,0,0] neg_hi:[1,0,0]
v_pk_mul_f32 v[208:209], v[36:37], v[208:209] op_sel:[1,0] op_sel_hi:[1,1]
v_pk_mul_f32 v[210:211], v[36:37], v[210:211] op_sel:[1,0] op_sel_hi:[1,1]
v_cvt_pk_bf16_f32 v172, v172, v173
v_cvt_pk_bf16_f32 v173, v174, v175
ds_write_b64 v15, v[172:173] offset:12928
v_pk_fma_f32 v[176:177], v[38:39], v[56:57], v[176:177] op_sel_hi:[0,1,1] neg_lo:[1,0,0] neg_hi:[1,0,0]
v_pk_fma_f32 v[178:179], v[38:39], v[58:59], v[178:179] op_sel_hi:[0,1,1] neg_lo:[1,0,0] neg_hi:[1,0,0]
v_pk_mul_f32 v[140:141], v[38:39], v[140:141] op_sel:[1,0] op_sel_hi:[1,1]
v_pk_mul_f32 v[142:143], v[38:39], v[142:143] op_sel:[1,0] op_sel_hi:[1,1]
v_cvt_pk_bf16_f32 v208, v208, v209
v_cvt_pk_bf16_f32 v209, v210, v211
ds_write_b64 v15, v[208:209] offset:13056
v_pk_fma_f32 v[212:213], v[38:39], v[60:61], v[212:213] op_sel_hi:[0,1,1] neg_lo:[1,0,0] neg_hi:[1,0,0]
v_pk_fma_f32 v[214:215], v[38:39], v[62:63], v[214:215] op_sel_hi:[0,1,1] neg_lo:[1,0,0] neg_hi:[1,0,0]
v_pk_mul_f32 v[176:177], v[38:39], v[176:177] op_sel:[1,0] op_sel_hi:[1,1]
v_pk_mul_f32 v[178:179], v[38:39], v[178:179] op_sel:[1,0] op_sel_hi:[1,1]
v_cvt_pk_bf16_f32 v140, v140, v141
v_cvt_pk_bf16_f32 v141, v142, v143
ds_write_b64 v15, v[140:141] offset:19200
v_pk_fma_f32 v[144:145], v[40:41], v[52:53], v[144:145] op_sel_hi:[0,1,1] neg_lo:[1,0,0] neg_hi:[1,0,0]
v_pk_fma_f32 v[146:147], v[40:41], v[54:55], v[146:147] op_sel_hi:[0,1,1] neg_lo:[1,0,0] neg_hi:[1,0,0]
v_pk_mul_f32 v[212:213], v[38:39], v[212:213] op_sel:[1,0] op_sel_hi:[1,1]
v_pk_mul_f32 v[214:215], v[38:39], v[214:215] op_sel:[1,0] op_sel_hi:[1,1]
v_cvt_pk_bf16_f32 v176, v176, v177
v_cvt_pk_bf16_f32 v177, v178, v179
ds_write_b64 v15, v[176:177] offset:19328
v_pk_fma_f32 v[180:181], v[40:41], v[56:57], v[180:181] op_sel_hi:[0,1,1] neg_lo:[1,0,0] neg_hi:[1,0,0]
v_pk_fma_f32 v[182:183], v[40:41], v[58:59], v[182:183] op_sel_hi:[0,1,1] neg_lo:[1,0,0] neg_hi:[1,0,0]
v_pk_mul_f32 v[144:145], v[40:41], v[144:145] op_sel:[1,0] op_sel_hi:[1,1]
v_pk_mul_f32 v[146:147], v[40:41], v[146:147] op_sel:[1,0] op_sel_hi:[1,1]
v_cvt_pk_bf16_f32 v212, v212, v213
v_cvt_pk_bf16_f32 v213, v214, v215
ds_write_b64 v15, v[212:213] offset:19456
v_pk_fma_f32 v[216:217], v[40:41], v[60:61], v[216:217] op_sel_hi:[0,1,1] neg_lo:[1,0,0] neg_hi:[1,0,0]
v_pk_fma_f32 v[218:219], v[40:41], v[62:63], v[218:219] op_sel_hi:[0,1,1] neg_lo:[1,0,0] neg_hi:[1,0,0]
v_pk_mul_f32 v[180:181], v[40:41], v[180:181] op_sel:[1,0] op_sel_hi:[1,1]
v_pk_mul_f32 v[182:183], v[40:41], v[182:183] op_sel:[1,0] op_sel_hi:[1,1]
v_cvt_pk_bf16_f32 v144, v144, v145
v_cvt_pk_bf16_f32 v145, v146, v147
ds_write_b64 v15, v[144:145] offset:25600
v_pk_fma_f32 v[148:149], v[42:43], v[52:53], v[148:149] op_sel_hi:[0,1,1] neg_lo:[1,0,0] neg_hi:[1,0,0]
v_pk_fma_f32 v[150:151], v[42:43], v[54:55], v[150:151] op_sel_hi:[0,1,1] neg_lo:[1,0,0] neg_hi:[1,0,0]
v_pk_mul_f32 v[216:217], v[40:41], v[216:217] op_sel:[1,0] op_sel_hi:[1,1]
v_pk_mul_f32 v[218:219], v[40:41], v[218:219] op_sel:[1,0] op_sel_hi:[1,1]
v_cvt_pk_bf16_f32 v180, v180, v181
v_cvt_pk_bf16_f32 v181, v182, v183
ds_write_b64 v15, v[180:181] offset:25728
v_pk_fma_f32 v[184:185], v[42:43], v[56:57], v[184:185] op_sel_hi:[0,1,1] neg_lo:[1,0,0] neg_hi:[1,0,0]
v_pk_fma_f32 v[186:187], v[42:43], v[58:59], v[186:187] op_sel_hi:[0,1,1] neg_lo:[1,0,0] neg_hi:[1,0,0]
v_pk_mul_f32 v[148:149], v[42:43], v[148:149] op_sel:[1,0] op_sel_hi:[1,1]
v_pk_mul_f32 v[150:151], v[42:43], v[150:151] op_sel:[1,0] op_sel_hi:[1,1]
v_cvt_pk_bf16_f32 v216, v216, v217
v_cvt_pk_bf16_f32 v217, v218, v219
ds_write_b64 v15, v[216:217] offset:25856
v_pk_fma_f32 v[220:221], v[42:43], v[60:61], v[220:221] op_sel_hi:[0,1,1] neg_lo:[1,0,0] neg_hi:[1,0,0]
v_pk_fma_f32 v[222:223], v[42:43], v[62:63], v[222:223] op_sel_hi:[0,1,1] neg_lo:[1,0,0] neg_hi:[1,0,0]
v_pk_mul_f32 v[184:185], v[42:43], v[184:185] op_sel:[1,0] op_sel_hi:[1,1]
v_pk_mul_f32 v[186:187], v[42:43], v[186:187] op_sel:[1,0] op_sel_hi:[1,1]
v_cvt_pk_bf16_f32 v148, v148, v149
v_cvt_pk_bf16_f32 v149, v150, v151
ds_write_b64 v15, v[148:149] offset:32000
v_pk_fma_f32 v[152:153], v[44:45], v[52:53], v[152:153] op_sel_hi:[0,1,1] neg_lo:[1,0,0] neg_hi:[1,0,0]
v_pk_fma_f32 v[154:155], v[44:45], v[54:55], v[154:155] op_sel_hi:[0,1,1] neg_lo:[1,0,0] neg_hi:[1,0,0]
v_pk_mul_f32 v[220:221], v[42:43], v[220:221] op_sel:[1,0] op_sel_hi:[1,1]
v_pk_mul_f32 v[222:223], v[42:43], v[222:223] op_sel:[1,0] op_sel_hi:[1,1]
v_cvt_pk_bf16_f32 v184, v184, v185
v_cvt_pk_bf16_f32 v185, v186, v187
ds_write_b64 v15, v[184:185] offset:32128
v_pk_fma_f32 v[188:189], v[44:45], v[56:57], v[188:189] op_sel_hi:[0,1,1] neg_lo:[1,0,0] neg_hi:[1,0,0]
v_pk_fma_f32 v[190:191], v[44:45], v[58:59], v[190:191] op_sel_hi:[0,1,1] neg_lo:[1,0,0] neg_hi:[1,0,0]
v_pk_mul_f32 v[152:153], v[44:45], v[152:153] op_sel:[1,0] op_sel_hi:[1,1]
v_pk_mul_f32 v[154:155], v[44:45], v[154:155] op_sel:[1,0] op_sel_hi:[1,1]
v_cvt_pk_bf16_f32 v220, v220, v221
v_cvt_pk_bf16_f32 v221, v222, v223
ds_write_b64 v15, v[220:221] offset:32256
v_pk_fma_f32 v[224:225], v[44:45], v[60:61], v[224:225] op_sel_hi:[0,1,1] neg_lo:[1,0,0] neg_hi:[1,0,0]
v_pk_fma_f32 v[226:227], v[44:45], v[62:63], v[226:227] op_sel_hi:[0,1,1] neg_lo:[1,0,0] neg_hi:[1,0,0]
v_pk_mul_f32 v[188:189], v[44:45], v[188:189] op_sel:[1,0] op_sel_hi:[1,1]
v_pk_mul_f32 v[190:191], v[44:45], v[190:191] op_sel:[1,0] op_sel_hi:[1,1]
v_cvt_pk_bf16_f32 v152, v152, v153
v_cvt_pk_bf16_f32 v153, v154, v155
ds_write_b64 v15, v[152:153] offset:38400
v_pk_fma_f32 v[156:157], v[46:47], v[52:53], v[156:157] op_sel_hi:[0,1,1] neg_lo:[1,0,0] neg_hi:[1,0,0]
v_pk_fma_f32 v[158:159], v[46:47], v[54:55], v[158:159] op_sel_hi:[0,1,1] neg_lo:[1,0,0] neg_hi:[1,0,0]
v_pk_mul_f32 v[224:225], v[44:45], v[224:225] op_sel:[1,0] op_sel_hi:[1,1]
v_pk_mul_f32 v[226:227], v[44:45], v[226:227] op_sel:[1,0] op_sel_hi:[1,1]
v_cvt_pk_bf16_f32 v188, v188, v189
v_cvt_pk_bf16_f32 v189, v190, v191
ds_write_b64 v15, v[188:189] offset:38528
v_pk_fma_f32 v[192:193], v[46:47], v[56:57], v[192:193] op_sel_hi:[0,1,1] neg_lo:[1,0,0] neg_hi:[1,0,0]
v_pk_fma_f32 v[194:195], v[46:47], v[58:59], v[194:195] op_sel_hi:[0,1,1] neg_lo:[1,0,0] neg_hi:[1,0,0]
v_pk_mul_f32 v[156:157], v[46:47], v[156:157] op_sel:[1,0] op_sel_hi:[1,1]
v_pk_mul_f32 v[158:159], v[46:47], v[158:159] op_sel:[1,0] op_sel_hi:[1,1]
v_cvt_pk_bf16_f32 v224, v224, v225
v_cvt_pk_bf16_f32 v225, v226, v227
ds_write_b64 v15, v[224:225] offset:38656
v_pk_fma_f32 v[228:229], v[46:47], v[60:61], v[228:229] op_sel_hi:[0,1,1] neg_lo:[1,0,0] neg_hi:[1,0,0]
v_pk_fma_f32 v[230:231], v[46:47], v[62:63], v[230:231] op_sel_hi:[0,1,1] neg_lo:[1,0,0] neg_hi:[1,0,0]
v_pk_mul_f32 v[192:193], v[46:47], v[192:193] op_sel:[1,0] op_sel_hi:[1,1]
v_pk_mul_f32 v[194:195], v[46:47], v[194:195] op_sel:[1,0] op_sel_hi:[1,1]
v_cvt_pk_bf16_f32 v156, v156, v157
v_cvt_pk_bf16_f32 v157, v158, v159
ds_write_b64 v15, v[156:157] offset:44800
v_pk_fma_f32 v[160:161], v[48:49], v[52:53], v[160:161] op_sel_hi:[0,1,1] neg_lo:[1,0,0] neg_hi:[1,0,0]
v_pk_fma_f32 v[162:163], v[48:49], v[54:55], v[162:163] op_sel_hi:[0,1,1] neg_lo:[1,0,0] neg_hi:[1,0,0]
v_pk_mul_f32 v[228:229], v[46:47], v[228:229] op_sel:[1,0] op_sel_hi:[1,1]
v_pk_mul_f32 v[230:231], v[46:47], v[230:231] op_sel:[1,0] op_sel_hi:[1,1]
v_cvt_pk_bf16_f32 v192, v192, v193
v_cvt_pk_bf16_f32 v193, v194, v195
ds_write_b64 v15, v[192:193] offset:44928
v_pk_fma_f32 v[196:197], v[48:49], v[56:57], v[196:197] op_sel_hi:[0,1,1] neg_lo:[1,0,0] neg_hi:[1,0,0]
v_pk_fma_f32 v[198:199], v[48:49], v[58:59], v[198:199] op_sel_hi:[0,1,1] neg_lo:[1,0,0] neg_hi:[1,0,0]
v_pk_mul_f32 v[160:161], v[48:49], v[160:161] op_sel:[1,0] op_sel_hi:[1,1]
v_pk_mul_f32 v[162:163], v[48:49], v[162:163] op_sel:[1,0] op_sel_hi:[1,1]
v_cvt_pk_bf16_f32 v228, v228, v229
v_cvt_pk_bf16_f32 v229, v230, v231
ds_write_b64 v15, v[228:229] offset:45056
v_pk_fma_f32 v[232:233], v[48:49], v[60:61], v[232:233] op_sel_hi:[0,1,1] neg_lo:[1,0,0] neg_hi:[1,0,0]
v_pk_fma_f32 v[234:235], v[48:49], v[62:63], v[234:235] op_sel_hi:[0,1,1] neg_lo:[1,0,0] neg_hi:[1,0,0]
v_pk_mul_f32 v[196:197], v[48:49], v[196:197] op_sel:[1,0] op_sel_hi:[1,1]
v_pk_mul_f32 v[198:199], v[48:49], v[198:199] op_sel:[1,0] op_sel_hi:[1,1]
v_cvt_pk_bf16_f32 v160, v160, v161
v_cvt_pk_bf16_f32 v161, v162, v163
ds_write_b64 v15, v[160:161] offset:51200
v_pk_mul_f32 v[232:233], v[48:49], v[232:233] op_sel:[1,0] op_sel_hi:[1,1]
v_pk_mul_f32 v[234:235], v[48:49], v[234:235] op_sel:[1,0] op_sel_hi:[1,1]
v_cvt_pk_bf16_f32 v196, v196, v197
v_cvt_pk_bf16_f32 v197, v198, v199
ds_write_b64 v15, v[196:197] offset:51328
v_cvt_pk_bf16_f32 v232, v232, v233
v_cvt_pk_bf16_f32 v233, v234, v235
ds_write_b64 v15, v[232:233] offset:51456
s_waitcnt lgkmcnt(0)
s_branch Latt_5
Lpf_4:
s_lshl_b32 s43, s35, 7
s_waitcnt lgkmcnt(0)
s_mov_b32 s8, s64
s_mov_b32 s9, s65
s_mov_b32 s10, 4194304
s_mov_b32 s11, 0x20000
s_add_u32 s12, s66, s43
s_addc_u32 s13, s67, 0
s_mov_b32 s14, 6289536
s_mov_b32 s15, 0x20000
s_add_u32 s84, s82, 28311552
s_addc_u32 s85, s83, 0
s_branch Lov_3
.p2align 12
.fill 16, 4, 0xbf800000
Lst_3_0:
s_branch Lwr_163
s_nop 0
s_nop 0
Lov_3:
s_mov_b32 s86, 114688
s_mov_b32 s87, 0x20000
s_mov_b32 s56, s80
s_mov_b32 s57, s81
s_mov_b32 s58, 256
s_mov_b32 s59, 0x20000
v_mov_b32 v5, 0
v_lshlrev_b32 v14, 7, v1
s_or_b32 s43, s34, s35
s_cmp_lg_u32 s43, 0
s_cbranch_scc1 Lz_32
s_movk_i32 s43, 0x2000
buffer_store_dword v5, v14, s[84:87], 0 offen sc1
s_bfm_b64 exec, 60, 0
buffer_store_dword v5, v14, s[84:87], s43 offen sc1
s_mov_b64 exec, 1
v_mov_b32 v6, 1
s_waitcnt vmcnt(0)
buffer_store_dword v6, v5, s[56:59], 0 offen sc1
s_mov_b64 exec, -1
Lz_32:
s_lshl_b32 s43, s51, 11
buffer_load_dwordx4 v[96:99], v10, s[8:11], s43 offen offset:0
buffer_load_dwordx4 v[100:103], v10, s[8:11], s43 offen offset:1024
buffer_load_dwordx4 v[104:107], v10, s[8:11], s43 offen offset:2048
buffer_load_dwordx4 v[108:111], v10, s[8:11], s43 offen offset:3072
v_min_u32 v14, 23, v1
v_lshrrev_b32 v15, 3, v14
v_mul_u32_u24 v15, 43008, v15
v_and_b32 v14, 7, v14
v_lshl_add_u32 v15, v14, 4, v15
v_mov_b32 v32, 0x3f803f80
v_mov_b32 v33, 0x3f803f80
v_mov_b32 v34, 0x3f803f80
v_mov_b32 v35, 0x3f803f80
ds_write_b128 v15, v[32:35]
s_add_u32 s20, s82, 26214400
s_addc_u32 s21, s83, 0
s_mov_b32 s22, 16384
s_mov_b32 s23, 0x20000
s_add_u32 s43, s2, 128
s_lshl_b32 s43, s43, 7
v_lshlrev_b32 v14, 2, v1
s_mov_b64 exec, 15
buffer_store_dword v5, v14, s[84:87], s43 offen sc1
s_mov_b64 exec, -1
s_lshl_b32 s43, s34, 4
s_add_u32 s43, s43, s35
s_lshl_b32 s43, s43, 8
s_add_u32 s43, s43, 49152
v_lshlrev_b32 v14, 7, v1
s_mov_b64 exec, 3
buffer_store_dword v5, v14, s[84:87], s43 offen sc1
s_mov_b64 exec, -1
s_lshl_b32 s52, s34, 7
s_add_u32 s52, s52, 28319744
s_sub_u32 s53, s52, 128
s_cmp_eq_u32 s34, 0
s_cselect_b32 s53, s52, s53
s_waitcnt lgkmcnt(0)
s_barrier
s_waitcnt vmcnt(2)
s_mov_b32 s43, 0x3f803f80
v_mov_b32 v116, 0
v_mov_b32 v117, 0
v_mov_b32 v118, 0
v_mov_b32 v119, 0
v_mov_b32 v120, 0
v_mov_b32 v121, 0
v_mov_b32 v122, 0
v_mov_b32 v123, 0
v_dot2_f32_bf16 v116, v96, s43, v116
v_dot2_f32_bf16 v120, v96, v96, v120
v_dot2_f32_bf16 v118, v104, s43, v118
v_dot2_f32_bf16 v122, v104, v104, v122
v_dot2_f32_bf16 v117, v97, s43, v117
v_dot2_f32_bf16 v121, v97, v97, v121
v_dot2_f32_bf16 v119, v105, s43, v119
v_dot2_f32_bf16 v123, v105, v105, v123
v_dot2_f32_bf16 v116, v98, s43, v116
v_dot2_f32_bf16 v120, v98, v98, v120
v_dot2_f32_bf16 v118, v106, s43, v118
v_dot2_f32_bf16 v122, v106, v106, v122
v_dot2_f32_bf16 v117, v99, s43, v117
v_dot2_f32_bf16 v121, v99, v99, v121
v_dot2_f32_bf16 v119, v107, s43, v119
v_dot2_f32_bf16 v123, v107, v107, v123
v_dot2_f32_bf16 v116, v100, s43, v116
v_dot2_f32_bf16 v120, v100, v100, v120
v_dot2_f32_bf16 v118, v108, s43, v118
v_dot2_f32_bf16 v122, v108, v108, v122
v_dot2_f32_bf16 v117, v101, s43, v117
v_dot2_f32_bf16 v121, v101, v101, v121
v_dot2_f32_bf16 v119, v109, s43, v119
v_dot2_f32_bf16 v123, v109, v109, v123
v_dot2_f32_bf16 v116, v102, s43, v116
v_dot2_f32_bf16 v120, v102, v102, v120
v_dot2_f32_bf16 v118, v110, s43, v118
v_dot2_f32_bf16 v122, v110, v110, v122
v_dot2_f32_bf16 v117, v103, s43, v117
v_dot2_f32_bf16 v121, v103, v103, v121
v_dot2_f32_bf16 v119, v111, s43, v119
v_dot2_f32_bf16 v123, v111, v111, v123
s_nop 2
v_add_f32 v116, v116, v117
v_add_f32 v118, v118, v119
v_add_f32 v120, v120, v121
v_add_f32 v122, v122, v123
s_nop 1
v_permlane32_swap_b32 v116, v118
v_permlane32_swap_b32 v120, v122
v_add_f32 v116, v116, v118
v_add_f32 v120, v120, v122
s_nop 1
v_permlane16_swap_b32 v116, v120
v_add_f32 v116, v116, v120
s_nop 1
v_add_f32_dpp v116, v116, v116 row_ror:8 row_mask:0xf bank_mask:0xf
s_nop 1
v_add_f32_dpp v116, v116, v116 row_ror:4 row_mask:0xf bank_mask:0xf
s_nop 1
v_add_f32_dpp v116, v116, v116 row_ror:2 row_mask:0xf bank_mask:0xf
s_nop 1
v_add_f32_dpp v116, v116, v116 row_ror:1 row_mask:0xf bank_mask:0xf
v_mov_b32 v117, v116
s_nop 1
v_permlane16_swap_b32 v116, v117
v_mul_f32 v112, 0x3a800000, v116
v_mul_f32 v113, 0x3a800000, v117
v_fma_f32 v113, -v112, v112, v113
v_max_f32 v113, 0, v113
v_add_f32 v113, 0x3727c5ac, v113
v_rsq_f32 v113, v113
v_lshrrev_b32 v11, 5, v1
s_lshl_b32 s43, s47, 4
s_add_u32 s43, s43, 148608
v_lshl_add_u32 v11, v11, 3, s43
ds_write_b64 v11, v[112:113]
s_waitcnt lgkmcnt(0)
s_mov_b32 s28, s66
s_mov_b32 s29, s67
s_mov_b32 s30, 6291456
s_mov_b32 s31, 0x20000
s_mul_i32 s43, s33, 8832
s_add_u32 s43, s43, 1572864
v_lshlrev_b32 v30, 7, v1
buffer_load_dword v31, v30, s[28:31], s43 offen
s_add_u32 s43, s43, 8192
s_bfm_b64 exec, 5, 0
buffer_load_dword v31, v30, s[28:31], s43 offen
s_mov_b64 exec, -1
s_branch Lst_0_0
Lwr_160:
s_barrier
v_lshlrev_b32 v5, 4, v1
v_and_b32 v5, 63, v5
v_add_u32 v6, 148608, v5
ds_read_b128 v[112:115], v6
s_lshl_b32 s43, s63, 3
v_add_u32 v5, s43, v5
s_waitcnt lgkmcnt(0)
s_mov_b64 exec, 15
buffer_store_dwordx4 v[112:115], v5, s[20:23], 0 offen sc1
s_mov_b64 exec, -1
v_mov_b32 v4, 0
buffer_load_dword v6, v4, s[56:59], 0 offen sc1
s_mov_b32 s62, 0
s_mov_b32 s28, s66
s_mov_b32 s29, s67
s_mov_b32 s30, 6291456
s_mov_b32 s31, 0x20000
s_mul_i32 s43, s33, 12288
s_add_u32 s43, s43, 3538944
v_lshlrev_b32 v30, 7, v1
buffer_load_dword v31, v30, s[28:31], s43 offen
s_add_u32 s43, s43, 8192
s_bfm_b64 exec, 32, 0
buffer_load_dword v31, v30, s[28:31], s43 offen
s_mov_b64 exec, -1
s_branch Lst_1_0
Lwr_161:
s_barrier
s_lshl_b32 s43, s35, 7
s_add_u32 s28, s68, s43
s_addc_u32 s29, s69, 0
s_mov_b32 s30, 2095232
s_mov_b32 s31, 0x20000
v_and_b32 v29, 7, v1
v_lshrrev_b32 v30, 3, v1
v_lshl_add_u32 v29, v30, 6, v29
s_lshl_b32 s43, s48, 3
v_add_u32 v29, s43, v29
v_lshlrev_b32 v29, 11, v29
s_mov_b32 s43, 1048576
s_mov_b32 s28, s68
s_mov_b32 s29, s69
s_mov_b32 s30, 2097152
s_mov_b32 s31, 0x20000
s_mul_i32 s43, s33, 9472
v_lshlrev_b32 v30, 7, v1
buffer_load_dword v31, v30, s[28:31], s43 offen
s_add_u32 s43, s43, 8192
s_bfm_b64 exec, 10, 0
buffer_load_dword v31, v30, s[28:31], s43 offen
s_mov_b64 exec, -1
s_branch Lst_2_0
Lwr_162:
s_barrier
s_branch Lst_3_0
Lwr_163:
s_barrier
s_branch Lst_4_0
Lwr_164:
s_barrier
s_branch Lst_5_0
Lwr_165:
s_barrier
s_cmp_eq_u32 s62, 3
s_cbranch_scc1 Lste_36
s_cmp_eq_u32 s62, 2
s_cbranch_scc1 Lst2_34
s_cmp_ge_u32 s62, 4
s_cbranch_scc1 Lst4_35
s_cmp_eq_u32 s62, 1
s_cbranch_scc1 Lst1_33
s_waitcnt vmcnt(4)
v_readfirstlane_b32 s54, v6
s_cmp_eq_u32 s54, 0
s_cbranch_scc0 Lrep_37
buffer_load_dword v6, v4, s[56:59], 0 offen sc1
s_branch Lste_36
Lrep_37:
s_add_u32 s7, s34, 64
s_lshl_b32 s7, s7, 7
v_mov_b32 v5, s7
v_mov_b32 v6, 1
s_mov_b64 exec, 1
buffer_atomic_add v6, v5, s[84:87], 0 offen sc1
s_mov_b64 exec, -1
s_mov_b32 s62, 1
s_mov_b32 s54, 0
s_mov_b32 s55, 0
s_branch Lste_36
Lst1_33:
s_and_b32 s43, s54, s55
s_cmp_eq_u32 s43, 16
s_cbranch_scc1 Lg_38
s_load_dword s54, s[82:83], s52 glc
s_load_dword s55, s[82:83], s53 glc
s_branch Lste_36
Lg_38:
v_add_u32 v5, 0, v1
v_min_u32 v5, 143, v5
v_lshlrev_b32 v20, 3, v5
v_add_u32 v5, s50, v5
v_max_i32 v5, 0, v5
v_lshlrev_b32 v5, 3, v5
buffer_load_dwordx2 v[32:33], v5, s[20:23], 0 offen sc1
v_add_u32 v5, 64, v1
v_min_u32 v5, 143, v5
v_lshlrev_b32 v21, 3, v5
v_add_u32 v5, s50, v5
v_max_i32 v5, 0, v5
v_lshlrev_b32 v5, 3, v5
buffer_load_dwordx2 v[34:35], v5, s[20:23], 0 offen sc1
v_add_u32 v5, 128, v1
v_min_u32 v5, 143, v5
v_lshlrev_b32 v22, 3, v5
v_add_u32 v5, s50, v5
v_max_i32 v5, 0, v5
v_lshlrev_b32 v5, 3, v5
buffer_load_dwordx2 v[36:37], v5, s[20:23], 0 offen sc1
s_mov_b32 s62, 4
s_branch Lste_36
Lst4_35:
s_mov_b32 s62, 2
s_branch Lste_36
Lst2_34:
s_waitcnt vmcnt(0)
v_add_u32 v20, 147456, v20
ds_write_b64 v20, v[32:33]
v_add_u32 v21, 147456, v21
ds_write_b64 v21, v[34:35]
v_add_u32 v22, 147456, v22
ds_write_b64 v22, v[36:37]
s_waitcnt lgkmcnt(0)
s_mov_b32 s62, 3
Lste_36:
s_branch Lst_6_0
Lwr_166:
s_barrier
s_cmp_eq_u32 s62, 3
s_cbranch_scc1 Lste_42
s_cmp_eq_u32 s62, 2
s_cbranch_scc1 Lst2_40
s_cmp_ge_u32 s62, 4
s_cbranch_scc1 Lst4_41
s_cmp_eq_u32 s62, 1
s_cbranch_scc1 Lst1_39
s_waitcnt vmcnt(0)
v_readfirstlane_b32 s54, v6
s_cmp_eq_u32 s54, 0
s_cbranch_scc0 Lrep_43
buffer_load_dword v6, v4, s[56:59], 0 offen sc1
s_branch Lste_42
Lrep_43:
s_add_u32 s7, s34, 64
s_lshl_b32 s7, s7, 7
v_mov_b32 v5, s7
v_mov_b32 v6, 1
s_mov_b64 exec, 1
buffer_atomic_add v6, v5, s[84:87], 0 offen sc1
s_mov_b64 exec, -1
s_mov_b32 s62, 1
s_mov_b32 s54, 0
s_mov_b32 s55, 0
s_branch Lste_42
Lst1_39:
s_and_b32 s43, s54, s55
s_cmp_eq_u32 s43, 16
s_cbranch_scc1 Lg_44
s_load_dword s54, s[82:83], s52 glc
s_load_dword s55, s[82:83], s53 glc
s_branch Lste_42
Lg_44:
v_add_u32 v5, 0, v1
v_min_u32 v5, 143, v5
v_lshlrev_b32 v20, 3, v5
v_add_u32 v5, s50, v5
v_max_i32 v5, 0, v5
v_lshlrev_b32 v5, 3, v5
buffer_load_dwordx2 v[32:33], v5, s[20:23], 0 offen sc1
v_add_u32 v5, 64, v1
v_min_u32 v5, 143, v5
v_lshlrev_b32 v21, 3, v5
v_add_u32 v5, s50, v5
v_max_i32 v5, 0, v5
v_lshlrev_b32 v5, 3, v5
buffer_load_dwordx2 v[34:35], v5, s[20:23], 0 offen sc1
v_add_u32 v5, 128, v1
v_min_u32 v5, 143, v5
v_lshlrev_b32 v22, 3, v5
v_add_u32 v5, s50, v5
v_max_i32 v5, 0, v5
v_lshlrev_b32 v5, 3, v5
buffer_load_dwordx2 v[36:37], v5, s[20:23], 0 offen sc1
s_mov_b32 s62, 4
s_branch Lste_42
Lst4_41:
s_mov_b32 s62, 2
s_branch Lste_42
Lst2_40:
s_waitcnt vmcnt(0)
v_add_u32 v20, 147456, v20
ds_write_b64 v20, v[32:33]
v_add_u32 v21, 147456, v21
ds_write_b64 v21, v[34:35]
v_add_u32 v22, 147456, v22
ds_write_b64 v22, v[36:37]
s_waitcnt lgkmcnt(0)
s_mov_b32 s62, 3
Lste_42:
s_branch Lst_7_0
Lwr_167:
s_barrier
s_cmp_eq_u32 s62, 3
s_cbranch_scc1 Lste_48
s_cmp_eq_u32 s62, 2
s_cbranch_scc1 Lst2_46
s_cmp_ge_u32 s62, 4
s_cbranch_scc1 Lst4_47
s_cmp_eq_u32 s62, 1
s_cbranch_scc1 Lst1_45
s_waitcnt vmcnt(0)
v_readfirstlane_b32 s54, v6
s_cmp_eq_u32 s54, 0
s_cbranch_scc0 Lrep_49
buffer_load_dword v6, v4, s[56:59], 0 offen sc1
s_branch Lste_48
Lrep_49:
s_add_u32 s7, s34, 64
s_lshl_b32 s7, s7, 7
v_mov_b32 v5, s7
v_mov_b32 v6, 1
s_mov_b64 exec, 1
buffer_atomic_add v6, v5, s[84:87], 0 offen sc1
s_mov_b64 exec, -1
s_mov_b32 s62, 1
s_mov_b32 s54, 0
s_mov_b32 s55, 0
s_branch Lste_48
Lst1_45:
s_and_b32 s43, s54, s55
s_cmp_eq_u32 s43, 16
s_cbranch_scc1 Lg_50
s_load_dword s54, s[82:83], s52 glc
s_load_dword s55, s[82:83], s53 glc
s_branch Lste_48
Lg_50:
v_add_u32 v5, 0, v1
v_min_u32 v5, 143, v5
v_lshlrev_b32 v20, 3, v5
v_add_u32 v5, s50, v5
v_max_i32 v5, 0, v5
v_lshlrev_b32 v5, 3, v5
buffer_load_dwordx2 v[32:33], v5, s[20:23], 0 offen sc1
v_add_u32 v5, 64, v1
v_min_u32 v5, 143, v5
v_lshlrev_b32 v21, 3, v5
v_add_u32 v5, s50, v5
v_max_i32 v5, 0, v5
v_lshlrev_b32 v5, 3, v5
buffer_load_dwordx2 v[34:35], v5, s[20:23], 0 offen sc1
v_add_u32 v5, 128, v1
v_min_u32 v5, 143, v5
v_lshlrev_b32 v22, 3, v5
v_add_u32 v5, s50, v5
v_max_i32 v5, 0, v5
v_lshlrev_b32 v5, 3, v5
buffer_load_dwordx2 v[36:37], v5, s[20:23], 0 offen sc1
s_mov_b32 s62, 4
s_branch Lste_48
Lst4_47:
s_mov_b32 s62, 2
s_branch Lste_48
Lst2_46:
s_waitcnt vmcnt(0)
v_add_u32 v20, 147456, v20
ds_write_b64 v20, v[32:33]
v_add_u32 v21, 147456, v21
ds_write_b64 v21, v[34:35]
v_add_u32 v22, 147456, v22
ds_write_b64 v22, v[36:37]
s_waitcnt lgkmcnt(0)
s_mov_b32 s62, 3
Lste_48:
s_branch Lst_8_0
Lwr_168:
s_barrier
s_cmp_eq_u32 s62, 3
s_cbranch_scc1 Lste_54
s_cmp_eq_u32 s62, 2
s_cbranch_scc1 Lst2_52
s_cmp_ge_u32 s62, 4
s_cbranch_scc1 Lst4_53
s_cmp_eq_u32 s62, 1
s_cbranch_scc1 Lst1_51
s_waitcnt vmcnt(0)
v_readfirstlane_b32 s54, v6
s_cmp_eq_u32 s54, 0
s_cbranch_scc0 Lrep_55
buffer_load_dword v6, v4, s[56:59], 0 offen sc1
s_branch Lste_54
Lrep_55:
s_add_u32 s7, s34, 64
s_lshl_b32 s7, s7, 7
v_mov_b32 v5, s7
v_mov_b32 v6, 1
s_mov_b64 exec, 1
buffer_atomic_add v6, v5, s[84:87], 0 offen sc1
s_mov_b64 exec, -1
s_mov_b32 s62, 1
s_mov_b32 s54, 0
s_mov_b32 s55, 0
s_branch Lste_54
Lst1_51:
s_and_b32 s43, s54, s55
s_cmp_eq_u32 s43, 16
s_cbranch_scc1 Lg_56
s_load_dword s54, s[82:83], s52 glc
s_load_dword s55, s[82:83], s53 glc
s_branch Lste_54
Lg_56:
v_add_u32 v5, 0, v1
v_min_u32 v5, 143, v5
v_lshlrev_b32 v20, 3, v5
v_add_u32 v5, s50, v5
v_max_i32 v5, 0, v5
v_lshlrev_b32 v5, 3, v5
buffer_load_dwordx2 v[32:33], v5, s[20:23], 0 offen sc1
v_add_u32 v5, 64, v1
v_min_u32 v5, 143, v5
v_lshlrev_b32 v21, 3, v5
v_add_u32 v5, s50, v5
v_max_i32 v5, 0, v5
v_lshlrev_b32 v5, 3, v5
buffer_load_dwordx2 v[34:35], v5, s[20:23], 0 offen sc1
v_add_u32 v5, 128, v1
v_min_u32 v5, 143, v5
v_lshlrev_b32 v22, 3, v5
v_add_u32 v5, s50, v5
v_max_i32 v5, 0, v5
v_lshlrev_b32 v5, 3, v5
buffer_load_dwordx2 v[36:37], v5, s[20:23], 0 offen sc1
s_mov_b32 s62, 4
s_branch Lste_54
Lst4_53:
s_mov_b32 s62, 2
s_branch Lste_54
Lst2_52:
s_waitcnt vmcnt(0)
v_add_u32 v20, 147456, v20
ds_write_b64 v20, v[32:33]
v_add_u32 v21, 147456, v21
ds_write_b64 v21, v[34:35]
v_add_u32 v22, 147456, v22
ds_write_b64 v22, v[36:37]
s_waitcnt lgkmcnt(0)
s_mov_b32 s62, 3
Lste_54:
s_branch Lst_9_0
Lwr_169:
s_barrier
s_getpc_b64 s[100:101]
s_and_b32 s100, s100, 0xfffff000
s_sub_u32 s100, s100, 1064960
s_subb_u32 s101, s101, 0
s_lshr_b32 s6, s2, 3
s_mul_i32 s6, s6, 1
s_and_b32 s7, s36, 0
s_add_u32 s6, s6, s7
s_mulk_i32 s6, 640
s_add_u32 s6, s6, 1063168
s_load_dword s3, s[100:101], s6 offset:0
s_load_dword s3, s[100:101], s6 offset:64
s_load_dword s3, s[100:101], s6 offset:128
s_load_dword s3, s[100:101], s6 offset:192
s_load_dword s3, s[100:101], s6 offset:256
s_load_dword s3, s[100:101], s6 offset:320
s_load_dword s3, s[100:101], s6 offset:384
s_load_dword s3, s[100:101], s6 offset:448
s_load_dword s3, s[100:101], s6 offset:512
s_load_dword s3, s[100:101], s6 offset:576
s_nop 0
s_nop 0
s_nop 0
s_nop 0
s_nop 0
s_nop 0
s_nop 0
s_nop 0
s_nop 0
s_nop 0
s_cmp_eq_u32 s62, 3
s_cbranch_scc1 Lste_60
s_cmp_eq_u32 s62, 2
s_cbranch_scc1 Lst2_58
s_cmp_ge_u32 s62, 4
s_cbranch_scc1 Lst4_59
s_cmp_eq_u32 s62, 1
s_cbranch_scc1 Lst1_57
s_waitcnt vmcnt(0)
v_readfirstlane_b32 s54, v6
s_cmp_eq_u32 s54, 0
s_cbranch_scc0 Lrep_61
buffer_load_dword v6, v4, s[56:59], 0 offen sc1
s_branch Lste_60
Lrep_61:
s_add_u32 s7, s34, 64
s_lshl_b32 s7, s7, 7
v_mov_b32 v5, s7
v_mov_b32 v6, 1
s_mov_b64 exec, 1
buffer_atomic_add v6, v5, s[84:87], 0 offen sc1
s_mov_b64 exec, -1
s_mov_b32 s62, 1
s_mov_b32 s54, 0
s_mov_b32 s55, 0
s_branch Lste_60
Lst1_57:
s_and_b32 s43, s54, s55
s_cmp_eq_u32 s43, 16
s_cbranch_scc1 Lg_62
s_load_dword s54, s[82:83], s52 glc
s_load_dword s55, s[82:83], s53 glc
s_branch Lste_60
Lg_62:
v_add_u32 v5, 0, v1
v_min_u32 v5, 143, v5
v_lshlrev_b32 v20, 3, v5
v_add_u32 v5, s50, v5
v_max_i32 v5, 0, v5
v_lshlrev_b32 v5, 3, v5
buffer_load_dwordx2 v[32:33], v5, s[20:23], 0 offen sc1
v_add_u32 v5, 64, v1
v_min_u32 v5, 143, v5
v_lshlrev_b32 v21, 3, v5
v_add_u32 v5, s50, v5
v_max_i32 v5, 0, v5
v_lshlrev_b32 v5, 3, v5
buffer_load_dwordx2 v[34:35], v5, s[20:23], 0 offen sc1
v_add_u32 v5, 128, v1
v_min_u32 v5, 143, v5
v_lshlrev_b32 v22, 3, v5
v_add_u32 v5, s50, v5
v_max_i32 v5, 0, v5
v_lshlrev_b32 v5, 3, v5
buffer_load_dwordx2 v[36:37], v5, s[20:23], 0 offen sc1
s_mov_b32 s62, 4
s_branch Lste_60
Lst4_59:
s_mov_b32 s62, 2
s_branch Lste_60
Lst2_58:
s_waitcnt vmcnt(0)
v_add_u32 v20, 147456, v20
ds_write_b64 v20, v[32:33]
v_add_u32 v21, 147456, v21
ds_write_b64 v21, v[34:35]
v_add_u32 v22, 147456, v22
ds_write_b64 v22, v[36:37]
s_waitcnt lgkmcnt(0)
s_mov_b32 s62, 3
Lste_60:
s_branch Lst_10_0
Lwr_170:
s_barrier
s_cmp_eq_u32 s62, 3
s_cbranch_scc1 Lste_66
s_cmp_eq_u32 s62, 2
s_cbranch_scc1 Lst2_64
s_cmp_ge_u32 s62, 4
s_cbranch_scc1 Lst4_65
s_cmp_eq_u32 s62, 1
s_cbranch_scc1 Lst1_63
s_waitcnt vmcnt(0)
v_readfirstlane_b32 s54, v6
s_cmp_eq_u32 s54, 0
s_cbranch_scc0 Lrep_67
buffer_load_dword v6, v4, s[56:59], 0 offen sc1
s_branch Lste_66
Lrep_67:
s_add_u32 s7, s34, 64
s_lshl_b32 s7, s7, 7
v_mov_b32 v5, s7
v_mov_b32 v6, 1
s_mov_b64 exec, 1
buffer_atomic_add v6, v5, s[84:87], 0 offen sc1
s_mov_b64 exec, -1
s_mov_b32 s62, 1
s_mov_b32 s54, 0
s_mov_b32 s55, 0
s_branch Lste_66
Lst1_63:
s_and_b32 s43, s54, s55
s_cmp_eq_u32 s43, 16
s_cbranch_scc1 Lg_68
s_load_dword s54, s[82:83], s52 glc
s_load_dword s55, s[82:83], s53 glc
s_branch Lste_66
Lg_68:
v_add_u32 v5, 0, v1
v_min_u32 v5, 143, v5
v_lshlrev_b32 v20, 3, v5
v_add_u32 v5, s50, v5
v_max_i32 v5, 0, v5
v_lshlrev_b32 v5, 3, v5
buffer_load_dwordx2 v[32:33], v5, s[20:23], 0 offen sc1
v_add_u32 v5, 64, v1
v_min_u32 v5, 143, v5
v_lshlrev_b32 v21, 3, v5
v_add_u32 v5, s50, v5
v_max_i32 v5, 0, v5
v_lshlrev_b32 v5, 3, v5
buffer_load_dwordx2 v[34:35], v5, s[20:23], 0 offen sc1
v_add_u32 v5, 128, v1
v_min_u32 v5, 143, v5
v_lshlrev_b32 v22, 3, v5
v_add_u32 v5, s50, v5
v_max_i32 v5, 0, v5
v_lshlrev_b32 v5, 3, v5
buffer_load_dwordx2 v[36:37], v5, s[20:23], 0 offen sc1
s_mov_b32 s62, 4
s_branch Lste_66
Lst4_65:
s_mov_b32 s62, 2
s_branch Lste_66
Lst2_64:
s_waitcnt vmcnt(0)
v_add_u32 v20, 147456, v20
ds_write_b64 v20, v[32:33]
v_add_u32 v21, 147456, v21
ds_write_b64 v21, v[34:35]
v_add_u32 v22, 147456, v22
ds_write_b64 v22, v[36:37]
s_waitcnt lgkmcnt(0)
s_mov_b32 s62, 3
Lste_66:
s_branch Lst_11_0
Lwr_171:
s_barrier
s_cmp_eq_u32 s62, 3
s_cbranch_scc1 Lste_72
s_cmp_eq_u32 s62, 2
s_cbranch_scc1 Lst2_70
s_cmp_ge_u32 s62, 4
s_cbranch_scc1 Lst4_71
s_cmp_eq_u32 s62, 1
s_cbranch_scc1 Lst1_69
s_waitcnt vmcnt(0)
v_readfirstlane_b32 s54, v6
s_cmp_eq_u32 s54, 0
s_cbranch_scc0 Lrep_73
buffer_load_dword v6, v4, s[56:59], 0 offen sc1
s_branch Lste_72
Lrep_73:
s_add_u32 s7, s34, 64
s_lshl_b32 s7, s7, 7
v_mov_b32 v5, s7
v_mov_b32 v6, 1
s_mov_b64 exec, 1
buffer_atomic_add v6, v5, s[84:87], 0 offen sc1
s_mov_b64 exec, -1
s_mov_b32 s62, 1
s_mov_b32 s54, 0
s_mov_b32 s55, 0
s_branch Lste_72
Lst1_69:
s_and_b32 s43, s54, s55
s_cmp_eq_u32 s43, 16
s_cbranch_scc1 Lg_74
s_load_dword s54, s[82:83], s52 glc
s_load_dword s55, s[82:83], s53 glc
s_branch Lste_72
Lg_74:
v_add_u32 v5, 0, v1
v_min_u32 v5, 143, v5
v_lshlrev_b32 v20, 3, v5
v_add_u32 v5, s50, v5
v_max_i32 v5, 0, v5
v_lshlrev_b32 v5, 3, v5
buffer_load_dwordx2 v[32:33], v5, s[20:23], 0 offen sc1
v_add_u32 v5, 64, v1
v_min_u32 v5, 143, v5
v_lshlrev_b32 v21, 3, v5
v_add_u32 v5, s50, v5
v_max_i32 v5, 0, v5
v_lshlrev_b32 v5, 3, v5
buffer_load_dwordx2 v[34:35], v5, s[20:23], 0 offen sc1
v_add_u32 v5, 128, v1
v_min_u32 v5, 143, v5
v_lshlrev_b32 v22, 3, v5
v_add_u32 v5, s50, v5
v_max_i32 v5, 0, v5
v_lshlrev_b32 v5, 3, v5
buffer_load_dwordx2 v[36:37], v5, s[20:23], 0 offen sc1
s_mov_b32 s62, 4
s_branch Lste_72
Lst4_71:
s_mov_b32 s62, 2
s_branch Lste_72
Lst2_70:
s_waitcnt vmcnt(0)
v_add_u32 v20, 147456, v20
ds_write_b64 v20, v[32:33]
v_add_u32 v21, 147456, v21
ds_write_b64 v21, v[34:35]
v_add_u32 v22, 147456, v22
ds_write_b64 v22, v[36:37]
s_waitcnt lgkmcnt(0)
s_mov_b32 s62, 3
Lste_72:
s_branch Lst_12_0
Lwr_172:
s_barrier
s_cmp_eq_u32 s62, 3
s_cbranch_scc1 Lste_78
s_cmp_eq_u32 s62, 2
s_cbranch_scc1 Lst2_76
s_cmp_ge_u32 s62, 4
s_cbranch_scc1 Lst4_77
s_cmp_eq_u32 s62, 1
s_cbranch_scc1 Lst1_75
s_waitcnt vmcnt(0)
v_readfirstlane_b32 s54, v6
s_cmp_eq_u32 s54, 0
s_cbranch_scc0 Lrep_79
buffer_load_dword v6, v4, s[56:59], 0 offen sc1
s_branch Lste_78
Lrep_79:
s_add_u32 s7, s34, 64
s_lshl_b32 s7, s7, 7
v_mov_b32 v5, s7
v_mov_b32 v6, 1
s_mov_b64 exec, 1
buffer_atomic_add v6, v5, s[84:87], 0 offen sc1
s_mov_b64 exec, -1
s_mov_b32 s62, 1
s_mov_b32 s54, 0
s_mov_b32 s55, 0
s_branch Lste_78
Lst1_75:
s_and_b32 s43, s54, s55
s_cmp_eq_u32 s43, 16
s_cbranch_scc1 Lg_80
s_load_dword s54, s[82:83], s52 glc
s_load_dword s55, s[82:83], s53 glc
s_branch Lste_78
Lg_80:
v_add_u32 v5, 0, v1
v_min_u32 v5, 143, v5
v_lshlrev_b32 v20, 3, v5
v_add_u32 v5, s50, v5
v_max_i32 v5, 0, v5
v_lshlrev_b32 v5, 3, v5
buffer_load_dwordx2 v[32:33], v5, s[20:23], 0 offen sc1
v_add_u32 v5, 64, v1
v_min_u32 v5, 143, v5
v_lshlrev_b32 v21, 3, v5
v_add_u32 v5, s50, v5
v_max_i32 v5, 0, v5
v_lshlrev_b32 v5, 3, v5
buffer_load_dwordx2 v[34:35], v5, s[20:23], 0 offen sc1
v_add_u32 v5, 128, v1
v_min_u32 v5, 143, v5
v_lshlrev_b32 v22, 3, v5
v_add_u32 v5, s50, v5
v_max_i32 v5, 0, v5
v_lshlrev_b32 v5, 3, v5
buffer_load_dwordx2 v[36:37], v5, s[20:23], 0 offen sc1
s_mov_b32 s62, 4
s_branch Lov_4
.p2align 12
.fill 32, 4, 0xbf800000
Lst_4_0:
s_branch Lwr_164
s_nop 0
s_nop 0
Lov_4:
s_branch Lste_78
Lst4_77:
s_mov_b32 s62, 2
s_branch Lste_78
Lst2_76:
s_waitcnt vmcnt(0)
v_add_u32 v20, 147456, v20
ds_write_b64 v20, v[32:33]
v_add_u32 v21, 147456, v21
ds_write_b64 v21, v[34:35]
v_add_u32 v22, 147456, v22
ds_write_b64 v22, v[36:37]
s_waitcnt lgkmcnt(0)
s_mov_b32 s62, 3
Lste_78:
s_branch Lst_13_0
Lwr_173:
s_barrier
s_cmp_eq_u32 s62, 3
s_cbranch_scc1 Lste_84
s_cmp_eq_u32 s62, 2
s_cbranch_scc1 Lst2_82
s_cmp_ge_u32 s62, 4
s_cbranch_scc1 Lst4_83
s_cmp_eq_u32 s62, 1
s_cbranch_scc1 Lst1_81
s_waitcnt vmcnt(0)
v_readfirstlane_b32 s54, v6
s_cmp_eq_u32 s54, 0
s_cbranch_scc0 Lrep_85
buffer_load_dword v6, v4, s[56:59], 0 offen sc1
s_branch Lste_84
Lrep_85:
s_add_u32 s7, s34, 64
s_lshl_b32 s7, s7, 7
v_mov_b32 v5, s7
v_mov_b32 v6, 1
s_mov_b64 exec, 1
buffer_atomic_add v6, v5, s[84:87], 0 offen sc1
s_mov_b64 exec, -1
s_mov_b32 s62, 1
s_mov_b32 s54, 0
s_mov_b32 s55, 0
s_branch Lste_84
Lst1_81:
s_and_b32 s43, s54, s55
s_cmp_eq_u32 s43, 16
s_cbranch_scc1 Lg_86
s_load_dword s54, s[82:83], s52 glc
s_load_dword s55, s[82:83], s53 glc
s_branch Lste_84
Lg_86:
v_add_u32 v5, 0, v1
v_min_u32 v5, 143, v5
v_lshlrev_b32 v20, 3, v5
v_add_u32 v5, s50, v5
v_max_i32 v5, 0, v5
v_lshlrev_b32 v5, 3, v5
buffer_load_dwordx2 v[32:33], v5, s[20:23], 0 offen sc1
v_add_u32 v5, 64, v1
v_min_u32 v5, 143, v5
v_lshlrev_b32 v21, 3, v5
v_add_u32 v5, s50, v5
v_max_i32 v5, 0, v5
v_lshlrev_b32 v5, 3, v5
buffer_load_dwordx2 v[34:35], v5, s[20:23], 0 offen sc1
v_add_u32 v5, 128, v1
v_min_u32 v5, 143, v5
v_lshlrev_b32 v22, 3, v5
v_add_u32 v5, s50, v5
v_max_i32 v5, 0, v5
v_lshlrev_b32 v5, 3, v5
buffer_load_dwordx2 v[36:37], v5, s[20:23], 0 offen sc1
s_mov_b32 s62, 4
s_branch Lste_84
Lst4_83:
s_mov_b32 s62, 2
s_branch Lste_84
Lst2_82:
s_waitcnt vmcnt(0)
v_add_u32 v20, 147456, v20
ds_write_b64 v20, v[32:33]
v_add_u32 v21, 147456, v21
ds_write_b64 v21, v[34:35]
v_add_u32 v22, 147456, v22
ds_write_b64 v22, v[36:37]
s_waitcnt lgkmcnt(0)
s_mov_b32 s62, 3
Lste_84:
s_branch Lst_14_0
Lwr_174:
s_barrier
s_cmp_eq_u32 s62, 3
s_cbranch_scc1 Lste_89
s_cmp_ge_u32 s62, 5
s_cbranch_scc1 Lg_94
s_cmp_ge_u32 s62, 2
s_cbranch_scc1 Lst2_88
s_cmp_eq_u32 s62, 1
s_cbranch_scc1 Lst1_87
s_mov_b32 s41, 0x40000
Lz0_90:
s_waitcnt vmcnt(0)
v_readfirstlane_b32 s54, v6
s_cmp_eq_u32 s54, 0
s_cbranch_scc0 Lzok_91
buffer_load_dword v6, v4, s[56:59], 0 offen sc1
s_sub_u32 s41, s41, 1
s_cmp_lg_u32 s41, 0
s_cbranch_scc1 Lz0_90
s_waitcnt lgkmcnt(0)
Lzok_91:
s_add_u32 s7, s34, 64
s_lshl_b32 s7, s7, 7
v_mov_b32 v5, s7
v_mov_b32 v6, 1
s_mov_b64 exec, 1
buffer_atomic_add v6, v5, s[84:87], 0 offen sc1
s_mov_b64 exec, -1
Lst1_87:
s_load_dword s54, s[82:83], s52 glc
s_load_dword s55, s[82:83], s53 glc
s_mov_b32 s41, 0x40000
Lpoll_92:
s_waitcnt lgkmcnt(0)
s_and_b32 s54, s54, s55
s_cmp_eq_u32 s54, 16
s_cbranch_scc1 Lg_94
s_load_dword s54, s[82:83], s52 glc
s_load_dword s55, s[82:83], s53 glc
s_sub_u32 s41, s41, 1
s_cmp_lg_u32 s41, 0
s_cbranch_scc1 Lpoll_92
s_waitcnt lgkmcnt(0)
Lg_94:
v_add_u32 v5, 0, v1
v_min_u32 v5, 143, v5
v_lshlrev_b32 v20, 3, v5
v_add_u32 v5, s50, v5
v_max_i32 v5, 0, v5
v_lshlrev_b32 v5, 3, v5
buffer_load_dwordx2 v[32:33], v5, s[20:23], 0 offen sc1
v_add_u32 v5, 64, v1
v_min_u32 v5, 143, v5
v_lshlrev_b32 v21, 3, v5
v_add_u32 v5, s50, v5
v_max_i32 v5, 0, v5
v_lshlrev_b32 v5, 3, v5
buffer_load_dwordx2 v[34:35], v5, s[20:23], 0 offen sc1
v_add_u32 v5, 128, v1
v_min_u32 v5, 143, v5
v_lshlrev_b32 v22, 3, v5
v_add_u32 v5, s50, v5
v_max_i32 v5, 0, v5
v_lshlrev_b32 v5, 3, v5
buffer_load_dwordx2 v[36:37], v5, s[20:23], 0 offen sc1
Lst2_88:
s_waitcnt vmcnt(0)
v_add_u32 v20, 147456, v20
ds_write_b64 v20, v[32:33]
v_add_u32 v21, 147456, v21
ds_write_b64 v21, v[34:35]
v_add_u32 v22, 147456, v22
ds_write_b64 v22, v[36:37]
s_waitcnt lgkmcnt(0)
Lste_89:
s_lshl_b32 s43, s35, 7
s_add_u32 s28, s68, s43
s_addc_u32 s29, s69, 0
s_mov_b32 s30, 2095232
s_mov_b32 s31, 0x20000
v_lshrrev_b32 v15, 3, v1
v_and_b32 v16, 6, v15
v_and_b32 v7, 7, v1
v_xor_b32 v7, v7, v16
v_lshlrev_b32 v7, 4, v7
v_mul_u32_u24 v15, 2048, v15
v_add_u32 v7, v7, v15
s_and_b32 s40, s36, 3
s_lshl_b32 s39, s40, 13
s_add_u32 s40, s40, s35
s_add_u32 s42, s40, 0
s_and_b32 s42, s42, 15
s_lshl_b32 s42, s42, 17
s_add_u32 m0, s39, 65536
s_add_u32 s43, s42, 0
buffer_load_dwordx4 v7, s[28:31], s43 offen lds
s_add_u32 m0, s39, 66560
s_add_u32 s43, s42, 16384
buffer_load_dwordx4 v7, s[28:31], s43 offen lds
s_add_u32 m0, s39, 67584
s_add_u32 s43, s42, 32768
buffer_load_dwordx4 v7, s[28:31], s43 offen lds
s_add_u32 m0, s39, 68608
s_add_u32 s43, s42, 49152
buffer_load_dwordx4 v7, s[28:31], s43 offen lds
s_add_u32 m0, s39, 69632
s_add_u32 s43, s42, 65536
buffer_load_dwordx4 v7, s[28:31], s43 offen lds
s_add_u32 m0, s39, 70656
s_add_u32 s43, s42, 81920
buffer_load_dwordx4 v7, s[28:31], s43 offen lds
s_add_u32 m0, s39, 71680
s_add_u32 s43, s42, 98304
buffer_load_dwordx4 v7, s[28:31], s43 offen lds
s_add_u32 m0, s39, 72704
s_add_u32 s43, s42, 114688
buffer_load_dwordx4 v7, s[28:31], s43 offen lds
s_bitcmp0_b32 s2, 0
s_cselect_b32 s88, s72, s74
s_cselect_b32 s89, s73, s75
s_cmp_lt_u32 s2, 192
s_cselect_b32 s90, 7340032, 0
s_mov_b32 s91, 0x20000
s_bfe_u32 s44, s2, 0x30001
s_lshl_b32 s44, s44, 2
s_and_b32 s43, s36, 3
s_add_u32 s44, s44, s43
s_lshl_b32 s44, s44, 5
v_lshrrev_b32 v18, 4, v1
v_add_u32 v18, s44, v18
v_mul_u32_u24 v18, 7168, v18
v_and_b32 v19, 15, v1
v_lshl_add_u32 v18, v19, 4, v18
s_lshr_b32 s43, s2, 4
s_lshl_b32 s43, s43, 8
s_add_u32 s43, s43, 4096
v_add_u32 v18, s43, v18
s_mov_b32 s43, 0
buffer_load_dwordx4 v[128:131], v18, s[88:91], s43 offen
s_mov_b32 s43, 28672
buffer_load_dwordx4 v[132:135], v18, s[88:91], s43 offen
s_mov_b32 s43, 57344
buffer_load_dwordx4 v[136:139], v18, s[88:91], s43 offen
s_mov_b32 s43, 86016
buffer_load_dwordx4 v[140:143], v18, s[88:91], s43 offen
s_mov_b32 s43, 114688
buffer_load_dwordx4 v[144:147], v18, s[88:91], s43 offen
s_mov_b32 s43, 143360
buffer_load_dwordx4 v[148:151], v18, s[88:91], s43 offen
s_mov_b32 s43, 172032
buffer_load_dwordx4 v[152:155], v18, s[88:91], s43 offen
s_mov_b32 s43, 200704
buffer_load_dwordx4 v[156:159], v18, s[88:91], s43 offen
s_barrier
Lats_6:
s_and_b32 s43, s36, 1
s_bfe_u32 s44, s36, 0x10001
s_lshr_b32 s45, s36, 2
v_lshlrev_b32 v14, 2, v13
v_sub_u32 v14, v12, v14
v_mov_b32 v16, 0xff800000
s_or_b32 s46, s34, s45
s_cmp_lg_u32 s46, 0
s_cselect_b32 s46, 0, 0xff800000
v_subrev_u32 v15, 0, v14
v_cmp_ge_u32 vcc, 7, v15
v_add_u32 v15, 16, v15
s_nop 0
v_cndmask_b32 v248, v16, 0, vcc
v_cmp_ge_u32 vcc, 7, v15
s_nop 1
v_cndmask_b32 v244, v16, 0, vcc
v_or_b32 v240, s46, v244
v_subrev_u32 v15, 1, v14
v_cmp_ge_u32 vcc, 7, v15
v_add_u32 v15, 16, v15
s_nop 0
v_cndmask_b32 v249, v16, 0, vcc
v_cmp_ge_u32 vcc, 7, v15
s_nop 1
v_cndmask_b32 v245, v16, 0, vcc
v_or_b32 v241, s46, v245
v_subrev_u32 v15, 2, v14
v_cmp_ge_u32 vcc, 7, v15
v_add_u32 v15, 16, v15
s_nop 0
v_cndmask_b32 v250, v16, 0, vcc
v_cmp_ge_u32 vcc, 7, v15
s_nop 1
v_cndmask_b32 v246, v16, 0, vcc
v_or_b32 v242, s46, v246
v_subrev_u32 v15, 3, v14
v_cmp_ge_u32 vcc, 7, v15
v_add_u32 v15, 16, v15
s_nop 0
v_cndmask_b32 v251, v16, 0, vcc
v_cmp_ge_u32 vcc, 7, v15
s_nop 1
v_cndmask_b32 v247, v16, 0, vcc
v_or_b32 v243, s46, v247
s_lshl_b32 s46, s45, 6
s_add_u32 s46, s46, s44
s_add_u32 s46, s46, 16
v_lshl_add_u32 v14, v12, 1, s46
s_lshl_b32 s47, s43, 6
v_lshl_add_u32 v15, v13, 4, s47
v_mul_u32_u24 v20, 400, v14
v_add_u32 v20, v20, v15
v_subrev_u32 v16, 32, v14
v_max_i32 v16, 0, v16
v_mul_u32_u24 v21, 400, v16
v_add_u32 v21, v21, v15
v_lshrrev_b32 v16, 2, v12
v_lshl_add_u32 v16, v13, 2, v16
v_lshl_add_u32 v16, v16, 1, s46
v_and_b32 v17, 3, v1
v_lshl_add_u32 v17, v17, 3, s47
v_mul_u32_u24 v22, 400, v16
v_add_u32 v22, v22, v17
v_subrev_u32 v16, 32, v16
v_max_i32 v16, 0, v16
v_mul_u32_u24 v23, 400, v16
v_add_u32 v23, v23, v17
s_mul_i32 s60, s34, 262144
s_add_u32 s16, s82, s60
s_addc_u32 s17, s83, 0
s_mov_b32 s18, 262144
s_mov_b32 s19, 0x20000
s_lshl_b32 s60, s35, 14
s_lshl_b32 s43, s43, 13
s_add_u32 s60, s60, s43
s_lshl_b32 s43, s45, 12
s_add_u32 s60, s60, s43
s_lshl_b32 s43, s44, 10
s_add_u32 s60, s60, s43
v_lshlrev_b32 v24, 4, v1
s_mov_b32 s61, 0x3e8293ee
s_lshl_b32 s38, s35, 7
Latt_5:
s_barrier
ds_read_b128 v[32:35], v20 offset:0
ds_read_b128 v[36:39], v20 offset:128
ds_read_b128 v[40:43], v21 offset:128
ds_read_b128 v[80:83], v20 offset:12800
ds_read_b128 v[84:87], v20 offset:12928
ds_read_b128 v[88:91], v20 offset:128
ds_read_b64_tr_b16 v[44:45], v23 offset:256
ds_read_b64_tr_b16 v[46:47], v22 offset:256
ds_read_b64_tr_b16 v[48:49], v23 offset:288
ds_read_b64_tr_b16 v[50:51], v22 offset:288
ds_read_b64_tr_b16 v[92:93], v22 offset:256
ds_read_b64_tr_b16 v[94:95], v22 offset:13056
ds_read_b64_tr_b16 v[96:97], v22 offset:288
ds_read_b64_tr_b16 v[98:99], v22 offset:13088
s_waitcnt lgkmcnt(11)
v_mfma_f32_16x16x32_bf16 v[52:55], v[40:43], v[32:35], v[240:243]
v_mfma_f32_16x16x32_bf16 v[56:59], v[36:39], v[32:35], v[248:251]
s_waitcnt lgkmcnt(8)
v_mfma_f32_16x16x32_bf16 v[100:103], v[88:91], v[80:83], v[244:247]
v_mfma_f32_16x16x32_bf16 v[104:107], v[84:87], v[80:83], v[248:251]
s_nop 5
v_max3_f32 v60, v52, v53, v54
v_max3_f32 v108, v100, v101, v102
v_max3_f32 v61, v55, v56, v57
v_max3_f32 v109, v103, v104, v105
v_max3_f32 v60, v60, v58, v59
v_max3_f32 v108, v108, v106, v107
v_max_f32 v60, v60, v61
v_max_f32 v108, v108, v109
s_nop 1
v_permlane32_swap_b32 v60, v108
v_max_f32 v60, v60, v108
v_mov_b32 v61, v60
s_nop 1
v_permlane16_swap_b32 v60, v61
v_max_f32 v60, v60, v61
v_mul_f32 v60, s61, v60
s_nop 0
v_mov_b32 v108, v60
s_nop 1
v_permlane32_swap_b32 v60, v108
v_fma_f32 v52, v52, s61, -v60
v_fma_f32 v100, v100, s61, -v108
v_fma_f32 v53, v53, s61, -v60
v_fma_f32 v101, v101, s61, -v108
v_fma_f32 v54, v54, s61, -v60
v_fma_f32 v102, v102, s61, -v108
v_fma_f32 v55, v55, s61, -v60
v_fma_f32 v103, v103, s61, -v108
v_fma_f32 v56, v56, s61, -v60
v_fma_f32 v104, v104, s61, -v108
v_fma_f32 v57, v57, s61, -v60
v_fma_f32 v105, v105, s61, -v108
v_fma_f32 v58, v58, s61, -v60
v_fma_f32 v106, v106, s61, -v108
v_fma_f32 v59, v59, s61, -v60
v_fma_f32 v107, v107, s61, -v108
v_exp_f32 v52, v52
v_exp_f32 v100, v100
v_exp_f32 v53, v53
v_exp_f32 v101, v101
v_exp_f32 v54, v54
v_exp_f32 v102, v102
v_exp_f32 v55, v55
v_exp_f32 v103, v103
v_exp_f32 v56, v56
v_exp_f32 v104, v104
v_exp_f32 v57, v57
v_exp_f32 v105, v105
v_exp_f32 v58, v58
v_exp_f32 v106, v106
v_exp_f32 v59, v59
v_exp_f32 v107, v107
v_cvt_pk_bf16_f32 v64, v52, v53
v_cvt_pk_bf16_f32 v112, v100, v101
v_cvt_pk_bf16_f32 v65, v54, v55
v_cvt_pk_bf16_f32 v113, v102, v103
v_cvt_pk_bf16_f32 v66, v56, v57
v_cvt_pk_bf16_f32 v114, v104, v105
v_cvt_pk_bf16_f32 v67, v58, v59
v_cvt_pk_bf16_f32 v115, v106, v107
v_pk_add_f32 v[52:53], v[52:53], v[54:55]
v_pk_add_f32 v[100:101], v[100:101], v[102:103]
v_pk_add_f32 v[56:57], v[56:57], v[58:59]
v_pk_add_f32 v[104:105], v[104:105], v[106:107]
s_waitcnt lgkmcnt(0)
s_waitcnt lgkmcnt(0)
v_mfma_f32_16x16x32_bf16 v[68:71], v[44:47], v[64:67], 0
v_mfma_f32_16x16x32_bf16 v[116:119], v[92:95], v[112:115], 0
v_mfma_f32_16x16x32_bf16 v[72:75], v[48:51], v[64:67], 0
v_mfma_f32_16x16x32_bf16 v[120:123], v[96:99], v[112:115], 0
v_pk_add_f32 v[52:53], v[52:53], v[56:57]
v_pk_add_f32 v[100:101], v[100:101], v[104:105]
v_add_f32 v60, v52, v53
v_add_f32 v108, v100, v101
s_nop 1
v_permlane32_swap_b32 v60, v108
v_add_f32 v60, v60, v108
v_mov_b32 v61, v60
s_nop 1
v_permlane16_swap_b32 v60, v61
v_add_f32 v60, v60, v61
v_rcp_f32 v60, v60
s_nop 0
v_mov_b32 v108, v60
s_nop 1
v_permlane32_swap_b32 v60, v108
v_pk_mul_f32 v[68:69], v[60:61], v[68:69] op_sel_hi:[0,1]
v_pk_mul_f32 v[116:117], v[108:109], v[116:117] op_sel_hi:[0,1]
v_pk_mul_f32 v[70:71], v[60:61], v[70:71] op_sel_hi:[0,1]
v_pk_mul_f32 v[118:119], v[108:109], v[118:119] op_sel_hi:[0,1]
v_pk_mul_f32 v[72:73], v[60:61], v[72:73] op_sel_hi:[0,1]
v_pk_mul_f32 v[120:121], v[108:109], v[120:121] op_sel_hi:[0,1]
v_pk_mul_f32 v[74:75], v[60:61], v[74:75] op_sel_hi:[0,1]
v_pk_mul_f32 v[122:123], v[108:109], v[122:123] op_sel_hi:[0,1]
v_cvt_pk_bf16_f32 v64, v68, v69
v_cvt_pk_bf16_f32 v112, v116, v117
v_cvt_pk_bf16_f32 v65, v70, v71
v_cvt_pk_bf16_f32 v113, v118, v119
v_cvt_pk_bf16_f32 v66, v72, v73
v_cvt_pk_bf16_f32 v114, v120, v121
v_cvt_pk_bf16_f32 v67, v74, v75
v_cvt_pk_bf16_f32 v115, v122, v123
buffer_store_dwordx4 v[64:67], v24, s[16:19], s60 offen offset:0 sc1
buffer_store_dwordx4 v[112:115], v24, s[16:19], s60 offen offset:2048 sc1
s_add_u32 s56, s82, 28311552
s_addc_u32 s57, s83, 0
s_mov_b32 s58, 114688
s_mov_b32 s59, 0x20000
s_lshl_b32 s7, s34, 12
s_add_u32 s7, s7, 49152
v_lshl_add_u32 v26, v1, 8, s7
v_mov_b32 v27, 1
s_cmp_ge_u32 s36, 4
s_cbranch_scc1 Lh_96
s_waitcnt vmcnt(0)
s_branch Lo_95
Lh_96:
s_add_u32 s28, s68, s38
s_addc_u32 s29, s69, 0
s_mov_b32 s30, 2095232
s_mov_b32 s31, 0x20000
s_add_u32 s42, s40, 4
s_and_b32 s42, s42, 15
s_lshl_b32 s42, s42, 17
s_add_u32 m0, s39, 114688
s_add_u32 s43, s42, 0
buffer_load_dwordx4 v7, s[28:31], s43 offen lds
s_add_u32 m0, s39, 115712
s_add_u32 s43, s42, 16384
buffer_load_dwordx4 v7, s[28:31], s43 offen lds
s_add_u32 m0, s39, 116736
s_add_u32 s43, s42, 32768
buffer_load_dwordx4 v7, s[28:31], s43 offen lds
s_add_u32 m0, s39, 117760
s_add_u32 s43, s42, 49152
buffer_load_dwordx4 v7, s[28:31], s43 offen lds
s_add_u32 m0, s39, 118784
s_add_u32 s43, s42, 65536
buffer_load_dwordx4 v7, s[28:31], s43 offen lds
s_add_u32 m0, s39, 119808
s_add_u32 s43, s42, 81920
buffer_load_dwordx4 v7, s[28:31], s43 offen lds
s_add_u32 m0, s39, 120832
s_add_u32 s43, s42, 98304
buffer_load_dwordx4 v7, s[28:31], s43 offen lds
s_add_u32 m0, s39, 121856
s_add_u32 s43, s42, 114688
buffer_load_dwordx4 v7, s[28:31], s43 offen lds
s_waitcnt vmcnt(8)
Lo_95:
s_cmp_lg_u32 s36, 0
s_barrier
s_cbranch_scc1 Lsig_97
s_mov_b64 exec, 0xffff
buffer_atomic_add v27, v26, s[56:59], 0 offen sc1
s_mov_b64 exec, -1
Lsig_97:
s_cmp_ge_u32 s36, 4
s_cbranch_scc1 Lprod_99
v_and_b32 v12, 15, v1
v_lshrrev_b32 v13, 4, v1
v_lshlrev_b32 v10, 12, v12
v_and_b32 v14, 1, v13
v_lshl_add_u32 v10, v14, 5, v10
v_lshrrev_b32 v14, 1, v13
v_lshl_add_u32 v10, v14, 4, v10
s_lshl_b32 s43, s34, 18
s_lshl_b32 s44, s36, 16
s_add_u32 s43, s43, s44
s_lshl_b32 s44, s35, 7
s_add_u32 s43, s43, s44
buffer_load_dwordx4 v[128:131], v10, s[8:11], s43 offen offset:0
buffer_load_dwordx4 v[132:135], v10, s[8:11], s43 offen offset:64
buffer_load_dwordx4 v[136:139], v10, s[8:11], s43 offen offset:2048
buffer_load_dwordx4 v[140:143], v10, s[8:11], s43 offen offset:2112
v_and_b32 v12, 15, v1
v_lshrrev_b32 v13, 4, v1
s_mul_i32 s43, s34, 262144
s_add_u32 s20, s82, s43
s_addc_u32 s21, s83, 0
s_add_u32 s20, s20, 4194304
s_addc_u32 s21, s21, 0
s_mov_b32 s22, 262144
s_mov_b32 s23, 0x20000
s_mul_i32 s43, s34, 16384
s_add_u32 s24, s82, s43
s_addc_u32 s25, s83, 0
s_add_u32 s24, s24, 25165824
s_addc_u32 s25, s25, 0
s_mov_b32 s26, 16384
s_mov_b32 s27, 0x20000
v_lshlrev_b32 v11, 4, v1
s_lshl_b32 s43, s36, 11
v_add_u32 v2, s43, v11
v_add_u32 v3, 98304, v2
v_lshrrev_b32 v14, 2, v1
v_bfe_u32 v15, v14, 1, 2
v_mul_u32_u24 v14, 128, v14
v_lshl_add_u32 v14, v15, 5, v14
v_and_b32 v15, 3, v1
v_lshl_add_u32 v4, v15, 3, v14
v_xor_b32 v5, 32, v4
v_xor_b32 v6, 64, v4
v_xor_b32 v7, 96, v4
v_add_u32 v16, 0x10000, v4
v_add_u32 v20, 0x20000, v4
v_add_u32 v17, 0x10000, v5
v_add_u32 v21, 0x20000, v5
v_add_u32 v18, 0x10000, v6
v_add_u32 v22, 0x20000, v6
v_add_u32 v19, 0x10000, v7
v_add_u32 v23, 0x20000, v7
s_lshl_b32 s44, s35, 14
s_add_u32 s60, s44, s43
v_lshrrev_b32 v14, 1, v13
v_lshlrev_b32 v14, 11, v14
v_lshl_add_u32 v14, v12, 3, v14
v_and_b32 v15, 1, v13
v_lshl_add_u32 v14, v15, 2, v14
s_lshl_b32 s43, s36, 12
s_lshl_b32 s44, s35, 7
s_add_u32 s43, s43, s44
v_add_u32 v9, s43, v14
s_mov_b32 s61, 0x3f803f80
s_waitcnt vmcnt(0)
v_permlane16_swap_b32 v128, v130
v_permlane16_swap_b32 v129, v131
v_permlane16_swap_b32 v132, v134
v_permlane16_swap_b32 v133, v135
v_permlane16_swap_b32 v136, v138
v_permlane16_swap_b32 v137, v139
v_permlane16_swap_b32 v140, v142
v_permlane16_swap_b32 v141, v143
v_lshlrev_b32 v96, 16, v128
v_and_b32 v97, 0xffff0000, v128
v_lshlrev_b32 v98, 16, v129
v_and_b32 v99, 0xffff0000, v129
v_lshlrev_b32 v100, 16, v130
v_and_b32 v101, 0xffff0000, v130
v_lshlrev_b32 v102, 16, v131
v_and_b32 v103, 0xffff0000, v131
v_lshlrev_b32 v104, 16, v132
v_and_b32 v105, 0xffff0000, v132
v_lshlrev_b32 v106, 16, v133
v_and_b32 v107, 0xffff0000, v133
v_lshlrev_b32 v108, 16, v134
v_and_b32 v109, 0xffff0000, v134
v_lshlrev_b32 v110, 16, v135
v_and_b32 v111, 0xffff0000, v135
v_lshlrev_b32 v112, 16, v136
v_and_b32 v113, 0xffff0000, v136
v_lshlrev_b32 v114, 16, v137
v_and_b32 v115, 0xffff0000, v137
v_lshlrev_b32 v116, 16, v138
v_and_b32 v117, 0xffff0000, v138
v_lshlrev_b32 v118, 16, v139
v_and_b32 v119, 0xffff0000, v139
v_lshlrev_b32 v120, 16, v140
v_and_b32 v121, 0xffff0000, v140
v_lshlrev_b32 v122, 16, v141
v_and_b32 v123, 0xffff0000, v141
v_lshlrev_b32 v124, 16, v142
v_and_b32 v125, 0xffff0000, v142
v_lshlrev_b32 v126, 16, v143
v_and_b32 v127, 0xffff0000, v143
s_cmp_lg_u32 s36, 0
s_cbranch_scc1 Lwm_102
s_nop 0
s_branch Lwe_101
Lwm_102:
s_cmp_lg_u32 s36, 1
s_cbranch_scc1 Lwm_103
s_nop 0
s_branch Lwe_101
Lwm_103:
s_cmp_lg_u32 s36, 2
s_cbranch_scc1 Lwm_104
s_nop 0
s_branch Lwe_101
Lwm_104:
s_cmp_lg_u32 s36, 3
s_cbranch_scc1 Lwm_105
s_nop 0
s_branch Lwe_101
Lwm_105:
Lwe_101:
s_barrier
ds_read_b128 v[32:35], v2 offset:0
ds_read_b64_tr_b16 v[40:41], v16 offset:0
ds_read_b64_tr_b16 v[42:43], v16 offset:2048
ds_read_b64_tr_b16 v[44:45], v17 offset:0
ds_read_b64_tr_b16 v[46:47], v17 offset:2048
ds_read_b64_tr_b16 v[48:49], v18 offset:0
ds_read_b64_tr_b16 v[50:51], v18 offset:2048
ds_read_b64_tr_b16 v[52:53], v19 offset:0
ds_read_b64_tr_b16 v[54:55], v19 offset:2048
ds_read_b128 v[36:39], v2 offset:1024
ds_read_b128 v[56:59], v2 offset:8192
ds_read_b64_tr_b16 v[64:65], v16 offset:4096
ds_read_b64_tr_b16 v[66:67], v16 offset:6144
ds_read_b64_tr_b16 v[68:69], v17 offset:4096
ds_read_b64_tr_b16 v[70:71], v17 offset:6144
ds_read_b64_tr_b16 v[72:73], v18 offset:4096
ds_read_b64_tr_b16 v[74:75], v18 offset:6144
ds_read_b64_tr_b16 v[76:77], v19 offset:4096
ds_read_b64_tr_b16 v[78:79], v19 offset:6144
ds_read_b128 v[60:63], v2 offset:9216
s_waitcnt lgkmcnt(0)
s_barrier
v_mfma_f32_16x16x32_bf16 v[96:99], v[40:43], v[32:35], v[96:99]
ds_read_b128 v[144:147], v2 offset:49152
ds_read_b64_tr_b16 v[152:153], v16 offset:8192
v_mfma_f32_16x16x32_bf16 v[100:103], v[44:47], v[32:35], v[100:103]
ds_read_b64_tr_b16 v[154:155], v16 offset:10240
ds_read_b64_tr_b16 v[156:157], v17 offset:8192
v_mfma_f32_16x16x32_bf16 v[104:107], v[48:51], v[32:35], v[104:107]
ds_read_b64_tr_b16 v[158:159], v17 offset:10240
ds_read_b64_tr_b16 v[160:161], v18 offset:8192
v_mfma_f32_16x16x32_bf16 v[108:111], v[52:55], v[32:35], v[108:111]
ds_read_b64_tr_b16 v[162:163], v18 offset:10240
ds_read_b64_tr_b16 v[164:165], v19 offset:8192
v_mfma_f32_16x16x32_bf16 v[124:127], v[52:55], v[36:39], v[124:127]
ds_read_b64_tr_b16 v[166:167], v19 offset:10240
ds_read_b128 v[148:151], v2 offset:50176
v_mfma_f32_16x16x32_bf16 v[120:123], v[48:51], v[36:39], v[120:123]
ds_read_b128 v[168:171], v2 offset:57344
ds_read_b64_tr_b16 v[176:177], v16 offset:12288
v_mfma_f32_16x16x32_bf16 v[116:119], v[44:47], v[36:39], v[116:119]
ds_read_b64_tr_b16 v[178:179], v16 offset:14336
ds_read_b64_tr_b16 v[180:181], v17 offset:12288
v_mfma_f32_16x16x32_bf16 v[112:115], v[40:43], v[36:39], v[112:115]
ds_read_b64_tr_b16 v[182:183], v17 offset:14336
ds_read_b64_tr_b16 v[184:185], v18 offset:12288
v_mfma_f32_16x16x32_bf16 v[96:99], v[64:67], v[56:59], v[96:99]
ds_read_b64_tr_b16 v[186:187], v18 offset:14336
ds_read_b64_tr_b16 v[188:189], v19 offset:12288
v_mfma_f32_16x16x32_bf16 v[100:103], v[68:71], v[56:59], v[100:103]
ds_read_b64_tr_b16 v[190:191], v19 offset:14336
ds_read_b128 v[172:175], v2 offset:58368
v_mfma_f32_16x16x32_bf16 v[104:107], v[72:75], v[56:59], v[104:107]
s_bitcmp0_b32 s36, 1
s_branch Lov_5
.p2align 12
.fill 32, 4, 0xbf800000
Lst_5_0:
s_branch Lwr_165
s_nop 0
s_nop 0
Lov_5:
v_mfma_f32_16x16x32_bf16 v[108:111], v[76:79], v[56:59], v[108:111]
s_cselect_b32 s44, s72, s74
v_mfma_f32_16x16x32_bf16 v[124:127], v[76:79], v[60:63], v[124:127]
s_cselect_b32 s45, s73, s75
v_mfma_f32_16x16x32_bf16 v[120:123], v[72:75], v[60:63], v[120:123]
s_mul_i32 s43, s35, 192
v_mfma_f32_16x16x32_bf16 v[116:119], v[68:71], v[60:63], v[116:119]
s_add_u32 s16, s44, s43
v_mfma_f32_16x16x32_bf16 v[112:115], v[64:67], v[60:63], v[112:115]
s_addc_u32 s17, s45, 0
s_waitcnt lgkmcnt(0)
s_barrier
v_mfma_f32_16x16x32_bf16 v[96:99], v[152:155], v[144:147], v[96:99]
ds_read_b128 v[32:35], v3 offset:0
ds_read_b64_tr_b16 v[40:41], v16 offset:16384
v_mfma_f32_16x16x32_bf16 v[100:103], v[156:159], v[144:147], v[100:103]
ds_read_b64_tr_b16 v[42:43], v16 offset:18432
ds_read_b64_tr_b16 v[44:45], v17 offset:16384
v_mfma_f32_16x16x32_bf16 v[104:107], v[160:163], v[144:147], v[104:107]
ds_read_b64_tr_b16 v[46:47], v17 offset:18432
ds_read_b64_tr_b16 v[48:49], v18 offset:16384
v_mfma_f32_16x16x32_bf16 v[108:111], v[164:167], v[144:147], v[108:111]
ds_read_b64_tr_b16 v[50:51], v18 offset:18432
ds_read_b64_tr_b16 v[52:53], v19 offset:16384
v_mfma_f32_16x16x32_bf16 v[124:127], v[164:167], v[148:151], v[124:127]
ds_read_b64_tr_b16 v[54:55], v19 offset:18432
ds_read_b128 v[36:39], v3 offset:1024
v_mfma_f32_16x16x32_bf16 v[120:123], v[160:163], v[148:151], v[120:123]
ds_read_b128 v[56:59], v3 offset:8192
ds_read_b64_tr_b16 v[64:65], v16 offset:20480
v_mfma_f32_16x16x32_bf16 v[116:119], v[156:159], v[148:151], v[116:119]
ds_read_b64_tr_b16 v[66:67], v16 offset:22528
ds_read_b64_tr_b16 v[68:69], v17 offset:20480
v_mfma_f32_16x16x32_bf16 v[112:115], v[152:155], v[148:151], v[112:115]
ds_read_b64_tr_b16 v[70:71], v17 offset:22528
ds_read_b64_tr_b16 v[72:73], v18 offset:20480
v_mfma_f32_16x16x32_bf16 v[96:99], v[176:179], v[168:171], v[96:99]
ds_read_b64_tr_b16 v[74:75], v18 offset:22528
ds_read_b64_tr_b16 v[76:77], v19 offset:20480
v_mfma_f32_16x16x32_bf16 v[100:103], v[180:183], v[168:171], v[100:103]
ds_read_b64_tr_b16 v[78:79], v19 offset:22528
ds_read_b128 v[60:63], v3 offset:9216
v_mfma_f32_16x16x32_bf16 v[104:107], v[184:187], v[168:171], v[104:107]
s_add_u32 s16, s16, 4096
v_mfma_f32_16x16x32_bf16 v[108:111], v[188:191], v[168:171], v[108:111]
s_addc_u32 s17, s17, 0
v_mfma_f32_16x16x32_bf16 v[124:127], v[188:191], v[172:175], v[124:127]
s_mov_b32 s18, 7333056
v_mfma_f32_16x16x32_bf16 v[120:123], v[184:187], v[172:175], v[120:123]
s_mov_b32 s19, 0x20000
v_mfma_f32_16x16x32_bf16 v[116:119], v[180:183], v[172:175], v[116:119]
s_and_b32 s43, s36, 1
v_mfma_f32_16x16x32_bf16 v[112:115], v[176:179], v[172:175], v[112:115]
s_mul_i32 s43, s43, 229376
s_waitcnt lgkmcnt(0)
s_barrier
v_mfma_f32_16x16x32_bf16 v[96:99], v[40:43], v[32:35], v[96:99]
ds_read_b128 v[144:147], v3 offset:49152
ds_read_b64_tr_b16 v[152:153], v16 offset:24576
v_mfma_f32_16x16x32_bf16 v[100:103], v[44:47], v[32:35], v[100:103]
ds_read_b64_tr_b16 v[154:155], v16 offset:26624
ds_read_b64_tr_b16 v[156:157], v17 offset:24576
v_mfma_f32_16x16x32_bf16 v[104:107], v[48:51], v[32:35], v[104:107]
ds_read_b64_tr_b16 v[158:159], v17 offset:26624
ds_read_b64_tr_b16 v[160:161], v18 offset:24576
v_mfma_f32_16x16x32_bf16 v[108:111], v[52:55], v[32:35], v[108:111]
ds_read_b64_tr_b16 v[162:163], v18 offset:26624
ds_read_b64_tr_b16 v[164:165], v19 offset:24576
v_mfma_f32_16x16x32_bf16 v[124:127], v[52:55], v[36:39], v[124:127]
ds_read_b64_tr_b16 v[166:167], v19 offset:26624
ds_read_b128 v[148:151], v3 offset:50176
v_mfma_f32_16x16x32_bf16 v[120:123], v[48:51], v[36:39], v[120:123]
ds_read_b128 v[168:171], v3 offset:57344
ds_read_b64_tr_b16 v[176:177], v16 offset:28672
v_mfma_f32_16x16x32_bf16 v[116:119], v[44:47], v[36:39], v[116:119]
ds_read_b64_tr_b16 v[178:179], v16 offset:30720
ds_read_b64_tr_b16 v[180:181], v17 offset:28672
v_mfma_f32_16x16x32_bf16 v[112:115], v[40:43], v[36:39], v[112:115]
ds_read_b64_tr_b16 v[182:183], v17 offset:30720
ds_read_b64_tr_b16 v[184:185], v18 offset:28672
v_mfma_f32_16x16x32_bf16 v[96:99], v[64:67], v[56:59], v[96:99]
ds_read_b64_tr_b16 v[186:187], v18 offset:30720
ds_read_b64_tr_b16 v[188:189], v19 offset:28672
v_mfma_f32_16x16x32_bf16 v[100:103], v[68:71], v[56:59], v[100:103]
ds_read_b64_tr_b16 v[190:191], v19 offset:30720
ds_read_b128 v[172:175], v3 offset:58368
v_mfma_f32_16x16x32_bf16 v[104:107], v[72:75], v[56:59], v[104:107]
v_add_u32 v196, 0, v1
v_mfma_f32_16x16x32_bf16 v[108:111], v[76:79], v[56:59], v[108:111]
v_mul_u32_u24 v197, 5462, v196
v_mfma_f32_16x16x32_bf16 v[124:127], v[76:79], v[60:63], v[124:127]
v_lshrrev_b32 v197, 16, v197
v_mfma_f32_16x16x32_bf16 v[120:123], v[72:75], v[60:63], v[120:123]
v_mul_u32_u24 v198, 12, v197
v_mfma_f32_16x16x32_bf16 v[116:119], v[68:71], v[60:63], v[116:119]
v_sub_u32 v198, v196, v198
v_mfma_f32_16x16x32_bf16 v[112:115], v[64:67], v[60:63], v[112:115]
v_bfe_u32 v199, v197, 2, 1
s_waitcnt lgkmcnt(0)
s_barrier
v_mfma_f32_16x16x32_bf16 v[96:99], v[152:155], v[144:147], v[96:99]
ds_read_b128 v[32:35], v2 offset:0
ds_read_b64_tr_b16 v[40:41], v16 offset:49152
v_mfma_f32_16x16x32_bf16 v[100:103], v[156:159], v[144:147], v[100:103]
ds_read_b64_tr_b16 v[42:43], v16 offset:51200
ds_read_b64_tr_b16 v[44:45], v17 offset:49152
v_mfma_f32_16x16x32_bf16 v[104:107], v[160:163], v[144:147], v[104:107]
ds_read_b64_tr_b16 v[46:47], v17 offset:51200
ds_read_b64_tr_b16 v[48:49], v18 offset:49152
v_mfma_f32_16x16x32_bf16 v[108:111], v[164:167], v[144:147], v[108:111]
ds_read_b64_tr_b16 v[50:51], v18 offset:51200
ds_read_b64_tr_b16 v[52:53], v19 offset:49152
v_mfma_f32_16x16x32_bf16 v[124:127], v[164:167], v[148:151], v[124:127]
ds_read_b64_tr_b16 v[54:55], v19 offset:51200
ds_read_b128 v[36:39], v2 offset:1024
v_mfma_f32_16x16x32_bf16 v[120:123], v[160:163], v[148:151], v[120:123]
ds_read_b128 v[56:59], v2 offset:8192
ds_read_b64_tr_b16 v[64:65], v16 offset:53248
v_mfma_f32_16x16x32_bf16 v[116:119], v[156:159], v[148:151], v[116:119]
ds_read_b64_tr_b16 v[66:67], v16 offset:55296
ds_read_b64_tr_b16 v[68:69], v17 offset:53248
v_mfma_f32_16x16x32_bf16 v[112:115], v[152:155], v[148:151], v[112:115]
ds_read_b64_tr_b16 v[70:71], v17 offset:55296
ds_read_b64_tr_b16 v[72:73], v18 offset:53248
v_mfma_f32_16x16x32_bf16 v[96:99], v[176:179], v[168:171], v[96:99]
ds_read_b64_tr_b16 v[74:75], v18 offset:55296
ds_read_b64_tr_b16 v[76:77], v19 offset:53248
v_mfma_f32_16x16x32_bf16 v[100:103], v[180:183], v[168:171], v[100:103]
ds_read_b64_tr_b16 v[78:79], v19 offset:55296
ds_read_b128 v[60:63], v2 offset:9216
v_mfma_f32_16x16x32_bf16 v[104:107], v[184:187], v[168:171], v[104:107]
v_cmp_gt_u32 vcc, 8, v198
v_mfma_f32_16x16x32_bf16 v[108:111], v[188:191], v[168:171], v[108:111]
v_lshlrev_b32 v200, 1, v199
v_mfma_f32_16x16x32_bf16 v[124:127], v[188:191], v[172:175], v[124:127]
v_mul_u32_u24 v197, 7168, v197
v_mfma_f32_16x16x32_bf16 v[120:123], v[184:187], v[172:175], v[120:123]
v_cndmask_b32 v199, v199, v200, vcc
v_mfma_f32_16x16x32_bf16 v[116:119], v[180:183], v[172:175], v[116:119]
v_xor_b32 v198, v198, v199
v_mfma_f32_16x16x32_bf16 v[112:115], v[176:179], v[172:175], v[112:115]
v_lshl_add_u32 v192, v198, 4, v197
s_waitcnt lgkmcnt(0)
s_barrier
v_mfma_f32_16x16x32_bf16 v[96:99], v[40:43], v[32:35], v[96:99]
ds_read_b128 v[144:147], v2 offset:49152
ds_read_b64_tr_b16 v[152:153], v16 offset:57344
v_mfma_f32_16x16x32_bf16 v[100:103], v[44:47], v[32:35], v[100:103]
ds_read_b64_tr_b16 v[154:155], v16 offset:59392
ds_read_b64_tr_b16 v[156:157], v17 offset:57344
v_mfma_f32_16x16x32_bf16 v[104:107], v[48:51], v[32:35], v[104:107]
ds_read_b64_tr_b16 v[158:159], v17 offset:59392
ds_read_b64_tr_b16 v[160:161], v18 offset:57344
v_mfma_f32_16x16x32_bf16 v[108:111], v[52:55], v[32:35], v[108:111]
ds_read_b64_tr_b16 v[162:163], v18 offset:59392
ds_read_b64_tr_b16 v[164:165], v19 offset:57344
v_mfma_f32_16x16x32_bf16 v[124:127], v[52:55], v[36:39], v[124:127]
ds_read_b64_tr_b16 v[166:167], v19 offset:59392
ds_read_b128 v[148:151], v2 offset:50176
v_mfma_f32_16x16x32_bf16 v[120:123], v[48:51], v[36:39], v[120:123]
ds_read_b128 v[168:171], v2 offset:57344
ds_read_b64_tr_b16 v[176:177], v16 offset:61440
v_mfma_f32_16x16x32_bf16 v[116:119], v[44:47], v[36:39], v[116:119]
ds_read_b64_tr_b16 v[178:179], v16 offset:63488
ds_read_b64_tr_b16 v[180:181], v17 offset:61440
v_mfma_f32_16x16x32_bf16 v[112:115], v[40:43], v[36:39], v[112:115]
ds_read_b64_tr_b16 v[182:183], v17 offset:63488
ds_read_b64_tr_b16 v[184:185], v18 offset:61440
v_mfma_f32_16x16x32_bf16 v[96:99], v[64:67], v[56:59], v[96:99]
ds_read_b64_tr_b16 v[186:187], v18 offset:63488
ds_read_b64_tr_b16 v[188:189], v19 offset:61440
v_mfma_f32_16x16x32_bf16 v[100:103], v[68:71], v[56:59], v[100:103]
ds_read_b64_tr_b16 v[190:191], v19 offset:63488
ds_read_b128 v[172:175], v2 offset:58368
v_mfma_f32_16x16x32_bf16 v[104:107], v[72:75], v[56:59], v[104:107]
v_add_u32 v196, 64, v1
v_mfma_f32_16x16x32_bf16 v[108:111], v[76:79], v[56:59], v[108:111]
v_mul_u32_u24 v197, 5462, v196
v_mfma_f32_16x16x32_bf16 v[124:127], v[76:79], v[60:63], v[124:127]
v_lshrrev_b32 v197, 16, v197
v_mfma_f32_16x16x32_bf16 v[120:123], v[72:75], v[60:63], v[120:123]
v_mul_u32_u24 v198, 12, v197
v_mfma_f32_16x16x32_bf16 v[116:119], v[68:71], v[60:63], v[116:119]
v_sub_u32 v198, v196, v198
v_mfma_f32_16x16x32_bf16 v[112:115], v[64:67], v[60:63], v[112:115]
v_bfe_u32 v199, v197, 2, 1
s_waitcnt lgkmcnt(0)
s_barrier
v_mfma_f32_16x16x32_bf16 v[96:99], v[152:155], v[144:147], v[96:99]
ds_read_b128 v[32:35], v3 offset:0
ds_read_b64_tr_b16 v[40:41], v20 offset:0
v_mfma_f32_16x16x32_bf16 v[100:103], v[156:159], v[144:147], v[100:103]
ds_read_b64_tr_b16 v[42:43], v20 offset:2048
ds_read_b64_tr_b16 v[44:45], v21 offset:0
v_mfma_f32_16x16x32_bf16 v[104:107], v[160:163], v[144:147], v[104:107]
ds_read_b64_tr_b16 v[46:47], v21 offset:2048
ds_read_b64_tr_b16 v[48:49], v22 offset:0
v_mfma_f32_16x16x32_bf16 v[108:111], v[164:167], v[144:147], v[108:111]
ds_read_b64_tr_b16 v[50:51], v22 offset:2048
ds_read_b64_tr_b16 v[52:53], v23 offset:0
v_mfma_f32_16x16x32_bf16 v[124:127], v[164:167], v[148:151], v[124:127]
ds_read_b64_tr_b16 v[54:55], v23 offset:2048
ds_read_b128 v[36:39], v3 offset:1024
v_mfma_f32_16x16x32_bf16 v[120:123], v[160:163], v[148:151], v[120:123]
ds_read_b128 v[56:59], v3 offset:8192
ds_read_b64_tr_b16 v[64:65], v20 offset:4096
v_mfma_f32_16x16x32_bf16 v[116:119], v[156:159], v[148:151], v[116:119]
ds_read_b64_tr_b16 v[66:67], v20 offset:6144
ds_read_b64_tr_b16 v[68:69], v21 offset:4096
v_mfma_f32_16x16x32_bf16 v[112:115], v[152:155], v[148:151], v[112:115]
ds_read_b64_tr_b16 v[70:71], v21 offset:6144
ds_read_b64_tr_b16 v[72:73], v22 offset:4096
v_mfma_f32_16x16x32_bf16 v[96:99], v[176:179], v[168:171], v[96:99]
ds_read_b64_tr_b16 v[74:75], v22 offset:6144
ds_read_b64_tr_b16 v[76:77], v23 offset:4096
v_mfma_f32_16x16x32_bf16 v[100:103], v[180:183], v[168:171], v[100:103]
ds_read_b64_tr_b16 v[78:79], v23 offset:6144
ds_read_b128 v[60:63], v3 offset:9216
v_mfma_f32_16x16x32_bf16 v[104:107], v[184:187], v[168:171], v[104:107]
v_cmp_gt_u32 vcc, 8, v198
v_mfma_f32_16x16x32_bf16 v[108:111], v[188:191], v[168:171], v[108:111]
v_lshlrev_b32 v200, 1, v199
v_mfma_f32_16x16x32_bf16 v[124:127], v[188:191], v[172:175], v[124:127]
v_mul_u32_u24 v197, 7168, v197
v_mfma_f32_16x16x32_bf16 v[120:123], v[184:187], v[172:175], v[120:123]
v_cndmask_b32 v199, v199, v200, vcc
v_mfma_f32_16x16x32_bf16 v[116:119], v[180:183], v[172:175], v[116:119]
v_xor_b32 v198, v198, v199
v_mfma_f32_16x16x32_bf16 v[112:115], v[176:179], v[172:175], v[112:115]
v_lshl_add_u32 v193, v198, 4, v197
s_waitcnt lgkmcnt(0)
s_barrier
v_mfma_f32_16x16x32_bf16 v[96:99], v[40:43], v[32:35], v[96:99]
ds_read_b128 v[144:147], v3 offset:49152
ds_read_b64_tr_b16 v[152:153], v20 offset:8192
v_mfma_f32_16x16x32_bf16 v[100:103], v[44:47], v[32:35], v[100:103]
ds_read_b64_tr_b16 v[154:155], v20 offset:10240
ds_read_b64_tr_b16 v[156:157], v21 offset:8192
v_mfma_f32_16x16x32_bf16 v[104:107], v[48:51], v[32:35], v[104:107]
ds_read_b64_tr_b16 v[158:159], v21 offset:10240
ds_read_b64_tr_b16 v[160:161], v22 offset:8192
v_mfma_f32_16x16x32_bf16 v[108:111], v[52:55], v[32:35], v[108:111]
ds_read_b64_tr_b16 v[162:163], v22 offset:10240
ds_read_b64_tr_b16 v[164:165], v23 offset:8192
v_mfma_f32_16x16x32_bf16 v[124:127], v[52:55], v[36:39], v[124:127]
ds_read_b64_tr_b16 v[166:167], v23 offset:10240
ds_read_b128 v[148:151], v3 offset:50176
v_mfma_f32_16x16x32_bf16 v[120:123], v[48:51], v[36:39], v[120:123]
ds_read_b128 v[168:171], v3 offset:57344
ds_read_b64_tr_b16 v[176:177], v20 offset:12288
v_mfma_f32_16x16x32_bf16 v[116:119], v[44:47], v[36:39], v[116:119]
ds_read_b64_tr_b16 v[178:179], v20 offset:14336
ds_read_b64_tr_b16 v[180:181], v21 offset:12288
v_mfma_f32_16x16x32_bf16 v[112:115], v[40:43], v[36:39], v[112:115]
ds_read_b64_tr_b16 v[182:183], v21 offset:14336
ds_read_b64_tr_b16 v[184:185], v22 offset:12288
v_mfma_f32_16x16x32_bf16 v[96:99], v[64:67], v[56:59], v[96:99]
ds_read_b64_tr_b16 v[186:187], v22 offset:14336
ds_read_b64_tr_b16 v[188:189], v23 offset:12288
v_mfma_f32_16x16x32_bf16 v[100:103], v[68:71], v[56:59], v[100:103]
ds_read_b64_tr_b16 v[190:191], v23 offset:14336
ds_read_b128 v[172:175], v3 offset:58368
v_mfma_f32_16x16x32_bf16 v[104:107], v[72:75], v[56:59], v[104:107]
v_add_u32 v196, 128, v1
v_mfma_f32_16x16x32_bf16 v[108:111], v[76:79], v[56:59], v[108:111]
v_mul_u32_u24 v197, 5462, v196
v_mfma_f32_16x16x32_bf16 v[124:127], v[76:79], v[60:63], v[124:127]
v_lshrrev_b32 v197, 16, v197
v_mfma_f32_16x16x32_bf16 v[120:123], v[72:75], v[60:63], v[120:123]
v_mul_u32_u24 v198, 12, v197
v_mfma_f32_16x16x32_bf16 v[116:119], v[68:71], v[60:63], v[116:119]
v_sub_u32 v198, v196, v198
v_mfma_f32_16x16x32_bf16 v[112:115], v[64:67], v[60:63], v[112:115]
v_bfe_u32 v199, v197, 2, 1
s_waitcnt lgkmcnt(0)
s_barrier
v_mfma_f32_16x16x32_bf16 v[96:99], v[152:155], v[144:147], v[96:99]
ds_read_b128 v[32:35], v2 offset:0
ds_read_b64_tr_b16 v[40:41], v4 offset:16384
v_mfma_f32_16x16x32_bf16 v[100:103], v[156:159], v[144:147], v[100:103]
ds_read_b64_tr_b16 v[42:43], v4 offset:18432
ds_read_b64_tr_b16 v[44:45], v5 offset:16384
v_mfma_f32_16x16x32_bf16 v[104:107], v[160:163], v[144:147], v[104:107]
ds_read_b64_tr_b16 v[46:47], v5 offset:18432
ds_read_b64_tr_b16 v[48:49], v6 offset:16384
v_mfma_f32_16x16x32_bf16 v[108:111], v[164:167], v[144:147], v[108:111]
ds_read_b64_tr_b16 v[50:51], v6 offset:18432
ds_read_b64_tr_b16 v[52:53], v7 offset:16384
v_mfma_f32_16x16x32_bf16 v[124:127], v[164:167], v[148:151], v[124:127]
ds_read_b64_tr_b16 v[54:55], v7 offset:18432
ds_read_b128 v[36:39], v2 offset:1024
v_mfma_f32_16x16x32_bf16 v[120:123], v[160:163], v[148:151], v[120:123]
ds_read_b128 v[56:59], v2 offset:8192
ds_read_b64_tr_b16 v[64:65], v4 offset:20480
v_mfma_f32_16x16x32_bf16 v[116:119], v[156:159], v[148:151], v[116:119]
ds_read_b64_tr_b16 v[66:67], v4 offset:22528
ds_read_b64_tr_b16 v[68:69], v5 offset:20480
v_mfma_f32_16x16x32_bf16 v[112:115], v[152:155], v[148:151], v[112:115]
ds_read_b64_tr_b16 v[70:71], v5 offset:22528
ds_read_b64_tr_b16 v[72:73], v6 offset:20480
v_mfma_f32_16x16x32_bf16 v[96:99], v[176:179], v[168:171], v[96:99]
ds_read_b64_tr_b16 v[74:75], v6 offset:22528
ds_read_b64_tr_b16 v[76:77], v7 offset:20480
v_mfma_f32_16x16x32_bf16 v[100:103], v[180:183], v[168:171], v[100:103]
ds_read_b64_tr_b16 v[78:79], v7 offset:22528
ds_read_b128 v[60:63], v2 offset:9216
v_mfma_f32_16x16x32_bf16 v[104:107], v[184:187], v[168:171], v[104:107]
v_cmp_gt_u32 vcc, 8, v198
v_mfma_f32_16x16x32_bf16 v[108:111], v[188:191], v[168:171], v[108:111]
v_lshlrev_b32 v200, 1, v199
v_mfma_f32_16x16x32_bf16 v[124:127], v[188:191], v[172:175], v[124:127]
v_mul_u32_u24 v197, 7168, v197
v_mfma_f32_16x16x32_bf16 v[120:123], v[184:187], v[172:175], v[120:123]
v_cndmask_b32 v199, v199, v200, vcc
v_mfma_f32_16x16x32_bf16 v[116:119], v[180:183], v[172:175], v[116:119]
v_xor_b32 v198, v198, v199
v_mfma_f32_16x16x32_bf16 v[112:115], v[176:179], v[172:175], v[112:115]
v_lshl_add_u32 v194, v198, 4, v197
s_waitcnt lgkmcnt(0)
s_barrier
v_mfma_f32_16x16x32_bf16 v[96:99], v[40:43], v[32:35], v[96:99]
ds_read_b128 v[144:147], v2 offset:49152
ds_read_b64_tr_b16 v[152:153], v4 offset:24576
v_mfma_f32_16x16x32_bf16 v[100:103], v[44:47], v[32:35], v[100:103]
ds_read_b64_tr_b16 v[154:155], v4 offset:26624
ds_read_b64_tr_b16 v[156:157], v5 offset:24576
v_mfma_f32_16x16x32_bf16 v[104:107], v[48:51], v[32:35], v[104:107]
ds_read_b64_tr_b16 v[158:159], v5 offset:26624
ds_read_b64_tr_b16 v[160:161], v6 offset:24576
v_mfma_f32_16x16x32_bf16 v[108:111], v[52:55], v[32:35], v[108:111]
ds_read_b64_tr_b16 v[162:163], v6 offset:26624
ds_read_b64_tr_b16 v[164:165], v7 offset:24576
v_mfma_f32_16x16x32_bf16 v[124:127], v[52:55], v[36:39], v[124:127]
ds_read_b64_tr_b16 v[166:167], v7 offset:26624
ds_read_b128 v[148:151], v2 offset:50176
v_mfma_f32_16x16x32_bf16 v[120:123], v[48:51], v[36:39], v[120:123]
ds_read_b128 v[168:171], v2 offset:57344
ds_read_b64_tr_b16 v[176:177], v4 offset:28672
v_mfma_f32_16x16x32_bf16 v[116:119], v[44:47], v[36:39], v[116:119]
ds_read_b64_tr_b16 v[178:179], v4 offset:30720
ds_read_b64_tr_b16 v[180:181], v5 offset:28672
v_mfma_f32_16x16x32_bf16 v[112:115], v[40:43], v[36:39], v[112:115]
ds_read_b64_tr_b16 v[182:183], v5 offset:30720
ds_read_b64_tr_b16 v[184:185], v6 offset:28672
v_mfma_f32_16x16x32_bf16 v[96:99], v[64:67], v[56:59], v[96:99]
ds_read_b64_tr_b16 v[186:187], v6 offset:30720
ds_read_b64_tr_b16 v[188:189], v7 offset:28672
v_mfma_f32_16x16x32_bf16 v[100:103], v[68:71], v[56:59], v[100:103]
ds_read_b64_tr_b16 v[190:191], v7 offset:30720
ds_read_b128 v[172:175], v2 offset:58368
v_mfma_f32_16x16x32_bf16 v[104:107], v[72:75], v[56:59], v[104:107]
v_add_u32 v192, s43, v192
v_mfma_f32_16x16x32_bf16 v[108:111], v[76:79], v[56:59], v[108:111]
v_add_u32 v193, s43, v193
v_mfma_f32_16x16x32_bf16 v[124:127], v[76:79], v[60:63], v[124:127]
v_add_u32 v194, s43, v194
v_mfma_f32_16x16x32_bf16 v[120:123], v[72:75], v[60:63], v[120:123]
s_and_b32 s43, s36, 3
v_mfma_f32_16x16x32_bf16 v[116:119], v[68:71], v[60:63], v[116:119]
s_mul_i32 s50, s43, 6144
v_mfma_f32_16x16x32_bf16 v[112:115], v[64:67], v[60:63], v[112:115]
s_add_u32 s50, s50, 16384
s_waitcnt lgkmcnt(0)
s_barrier
v_mfma_f32_16x16x32_bf16 v[96:99], v[152:155], v[144:147], v[96:99]
ds_read_b128 v[32:35], v3 offset:0
ds_read_b64_tr_b16 v[40:41], v4 offset:32768
v_mfma_f32_16x16x32_bf16 v[100:103], v[156:159], v[144:147], v[100:103]
ds_read_b64_tr_b16 v[42:43], v4 offset:34816
ds_read_b64_tr_b16 v[44:45], v5 offset:32768
v_mfma_f32_16x16x32_bf16 v[104:107], v[160:163], v[144:147], v[104:107]
ds_read_b64_tr_b16 v[46:47], v5 offset:34816
ds_read_b64_tr_b16 v[48:49], v6 offset:32768
v_mfma_f32_16x16x32_bf16 v[108:111], v[164:167], v[144:147], v[108:111]
ds_read_b64_tr_b16 v[50:51], v6 offset:34816
ds_read_b64_tr_b16 v[52:53], v7 offset:32768
v_mfma_f32_16x16x32_bf16 v[124:127], v[164:167], v[148:151], v[124:127]
ds_read_b64_tr_b16 v[54:55], v7 offset:34816
ds_read_b128 v[36:39], v3 offset:1024
v_mfma_f32_16x16x32_bf16 v[120:123], v[160:163], v[148:151], v[120:123]
ds_read_b128 v[56:59], v3 offset:8192
ds_read_b64_tr_b16 v[64:65], v4 offset:36864
v_mfma_f32_16x16x32_bf16 v[116:119], v[156:159], v[148:151], v[116:119]
ds_read_b64_tr_b16 v[66:67], v4 offset:38912
ds_read_b64_tr_b16 v[68:69], v5 offset:36864
v_mfma_f32_16x16x32_bf16 v[112:115], v[152:155], v[148:151], v[112:115]
ds_read_b64_tr_b16 v[70:71], v5 offset:38912
ds_read_b64_tr_b16 v[72:73], v6 offset:36864
v_mfma_f32_16x16x32_bf16 v[96:99], v[176:179], v[168:171], v[96:99]
ds_read_b64_tr_b16 v[74:75], v6 offset:38912
ds_read_b64_tr_b16 v[76:77], v7 offset:36864
v_mfma_f32_16x16x32_bf16 v[100:103], v[180:183], v[168:171], v[100:103]
ds_read_b64_tr_b16 v[78:79], v7 offset:38912
ds_read_b128 v[60:63], v3 offset:9216
v_mfma_f32_16x16x32_bf16 v[104:107], v[184:187], v[168:171], v[104:107]
s_bitcmp0_b32 s2, 0
v_mfma_f32_16x16x32_bf16 v[108:111], v[188:191], v[168:171], v[108:111]
s_cselect_b32 s88, s72, s74
v_mfma_f32_16x16x32_bf16 v[124:127], v[188:191], v[172:175], v[124:127]
s_cselect_b32 s89, s73, s75
v_mfma_f32_16x16x32_bf16 v[120:123], v[184:187], v[172:175], v[120:123]
s_mov_b32 s90, 7340032
v_mfma_f32_16x16x32_bf16 v[116:119], v[180:183], v[172:175], v[116:119]
s_mov_b32 s91, 0x20000
v_mfma_f32_16x16x32_bf16 v[112:115], v[176:179], v[172:175], v[112:115]
s_bfe_u32 s44, s2, 0x30001
s_waitcnt lgkmcnt(0)
s_barrier
v_mfma_f32_16x16x32_bf16 v[96:99], v[40:43], v[32:35], v[96:99]
ds_read_b128 v[144:147], v3 offset:49152
ds_read_b64_tr_b16 v[152:153], v4 offset:40960
v_mfma_f32_16x16x32_bf16 v[100:103], v[44:47], v[32:35], v[100:103]
ds_read_b64_tr_b16 v[154:155], v4 offset:43008
ds_read_b64_tr_b16 v[156:157], v5 offset:40960
v_mfma_f32_16x16x32_bf16 v[104:107], v[48:51], v[32:35], v[104:107]
ds_read_b64_tr_b16 v[158:159], v5 offset:43008
ds_read_b64_tr_b16 v[160:161], v6 offset:40960
v_mfma_f32_16x16x32_bf16 v[108:111], v[52:55], v[32:35], v[108:111]
ds_read_b64_tr_b16 v[162:163], v6 offset:43008
ds_read_b64_tr_b16 v[164:165], v7 offset:40960
v_mfma_f32_16x16x32_bf16 v[124:127], v[52:55], v[36:39], v[124:127]
ds_read_b64_tr_b16 v[166:167], v7 offset:43008
ds_read_b128 v[148:151], v3 offset:50176
v_mfma_f32_16x16x32_bf16 v[120:123], v[48:51], v[36:39], v[120:123]
ds_read_b128 v[168:171], v3 offset:57344
ds_read_b64_tr_b16 v[176:177], v4 offset:45056
v_mfma_f32_16x16x32_bf16 v[116:119], v[44:47], v[36:39], v[116:119]
ds_read_b64_tr_b16 v[178:179], v4 offset:47104
ds_read_b64_tr_b16 v[180:181], v5 offset:45056
v_mfma_f32_16x16x32_bf16 v[112:115], v[40:43], v[36:39], v[112:115]
ds_read_b64_tr_b16 v[182:183], v5 offset:47104
ds_read_b64_tr_b16 v[184:185], v6 offset:45056
v_mfma_f32_16x16x32_bf16 v[96:99], v[64:67], v[56:59], v[96:99]
ds_read_b64_tr_b16 v[186:187], v6 offset:47104
ds_read_b64_tr_b16 v[188:189], v7 offset:45056
v_mfma_f32_16x16x32_bf16 v[100:103], v[68:71], v[56:59], v[100:103]
ds_read_b64_tr_b16 v[190:191], v7 offset:47104
ds_read_b128 v[172:175], v3 offset:58368
v_mfma_f32_16x16x32_bf16 v[104:107], v[72:75], v[56:59], v[104:107]
s_lshl_b32 s44, s44, 2
v_mfma_f32_16x16x32_bf16 v[108:111], v[76:79], v[56:59], v[108:111]
s_and_b32 s43, s36, 3
v_mfma_f32_16x16x32_bf16 v[124:127], v[76:79], v[60:63], v[124:127]
s_add_u32 s44, s44, s43
v_mfma_f32_16x16x32_bf16 v[120:123], v[72:75], v[60:63], v[120:123]
s_lshl_b32 s44, s44, 5
v_mfma_f32_16x16x32_bf16 v[116:119], v[68:71], v[60:63], v[116:119]
v_lshrrev_b32 v195, 4, v1
v_mfma_f32_16x16x32_bf16 v[112:115], v[64:67], v[60:63], v[112:115]
v_add_u32 v195, s44, v195
s_waitcnt lgkmcnt(0)
s_barrier
v_mfma_f32_16x16x32_bf16 v[96:99], v[152:155], v[144:147], v[96:99]
ds_read_b128 v[32:35], v2 offset:0
ds_read_b64_tr_b16 v[40:41], v16 offset:49152
v_mfma_f32_16x16x32_bf16 v[100:103], v[156:159], v[144:147], v[100:103]
ds_read_b64_tr_b16 v[42:43], v16 offset:51200
ds_read_b64_tr_b16 v[44:45], v17 offset:49152
v_mfma_f32_16x16x32_bf16 v[104:107], v[160:163], v[144:147], v[104:107]
ds_read_b64_tr_b16 v[46:47], v17 offset:51200
ds_read_b64_tr_b16 v[48:49], v18 offset:49152
v_mfma_f32_16x16x32_bf16 v[108:111], v[164:167], v[144:147], v[108:111]
ds_read_b64_tr_b16 v[50:51], v18 offset:51200
ds_read_b64_tr_b16 v[52:53], v19 offset:49152
v_mfma_f32_16x16x32_bf16 v[124:127], v[164:167], v[148:151], v[124:127]
ds_read_b64_tr_b16 v[54:55], v19 offset:51200
ds_read_b128 v[36:39], v2 offset:1024
v_mfma_f32_16x16x32_bf16 v[120:123], v[160:163], v[148:151], v[120:123]
ds_read_b128 v[56:59], v2 offset:8192
ds_read_b64_tr_b16 v[64:65], v16 offset:53248
v_mfma_f32_16x16x32_bf16 v[116:119], v[156:159], v[148:151], v[116:119]
ds_read_b64_tr_b16 v[66:67], v16 offset:55296
ds_read_b64_tr_b16 v[68:69], v17 offset:53248
v_mfma_f32_16x16x32_bf16 v[112:115], v[152:155], v[148:151], v[112:115]
ds_read_b64_tr_b16 v[70:71], v17 offset:55296
ds_read_b64_tr_b16 v[72:73], v18 offset:53248
v_mfma_f32_16x16x32_bf16 v[96:99], v[176:179], v[168:171], v[96:99]
ds_read_b64_tr_b16 v[74:75], v18 offset:55296
ds_read_b64_tr_b16 v[76:77], v19 offset:53248
v_mfma_f32_16x16x32_bf16 v[100:103], v[180:183], v[168:171], v[100:103]
ds_read_b64_tr_b16 v[78:79], v19 offset:55296
ds_read_b128 v[60:63], v2 offset:9216
v_mfma_f32_16x16x32_bf16 v[104:107], v[184:187], v[168:171], v[104:107]
v_mul_u32_u24 v195, 7168, v195
v_mfma_f32_16x16x32_bf16 v[108:111], v[188:191], v[168:171], v[108:111]
v_and_b32 v196, 15, v1
v_mfma_f32_16x16x32_bf16 v[124:127], v[188:191], v[172:175], v[124:127]
v_lshl_add_u32 v195, v196, 4, v195
v_mfma_f32_16x16x32_bf16 v[120:123], v[184:187], v[172:175], v[120:123]
s_lshr_b32 s43, s2, 4
v_mfma_f32_16x16x32_bf16 v[116:119], v[180:183], v[172:175], v[116:119]
s_lshl_b32 s43, s43, 8
v_mfma_f32_16x16x32_bf16 v[112:115], v[176:179], v[172:175], v[112:115]
v_add_u32 v195, s43, v195
s_waitcnt lgkmcnt(0)
s_barrier
v_mfma_f32_16x16x32_bf16 v[96:99], v[40:43], v[32:35], v[96:99]
ds_read_b128 v[144:147], v2 offset:49152
ds_read_b64_tr_b16 v[152:153], v16 offset:57344
v_mfma_f32_16x16x32_bf16 v[100:103], v[44:47], v[32:35], v[100:103]
ds_read_b64_tr_b16 v[154:155], v16 offset:59392
ds_read_b64_tr_b16 v[156:157], v17 offset:57344
v_mfma_f32_16x16x32_bf16 v[104:107], v[48:51], v[32:35], v[104:107]
ds_read_b64_tr_b16 v[158:159], v17 offset:59392
ds_read_b64_tr_b16 v[160:161], v18 offset:57344
v_mfma_f32_16x16x32_bf16 v[108:111], v[52:55], v[32:35], v[108:111]
ds_read_b64_tr_b16 v[162:163], v18 offset:59392
ds_read_b64_tr_b16 v[164:165], v19 offset:57344
v_mfma_f32_16x16x32_bf16 v[124:127], v[52:55], v[36:39], v[124:127]
ds_read_b64_tr_b16 v[166:167], v19 offset:59392
ds_read_b128 v[148:151], v2 offset:50176
v_mfma_f32_16x16x32_bf16 v[120:123], v[48:51], v[36:39], v[120:123]
ds_read_b128 v[168:171], v2 offset:57344
ds_read_b64_tr_b16 v[176:177], v16 offset:61440
v_mfma_f32_16x16x32_bf16 v[116:119], v[44:47], v[36:39], v[116:119]
ds_read_b64_tr_b16 v[178:179], v16 offset:63488
ds_read_b64_tr_b16 v[180:181], v17 offset:61440
v_mfma_f32_16x16x32_bf16 v[112:115], v[40:43], v[36:39], v[112:115]
ds_read_b64_tr_b16 v[182:183], v17 offset:63488
ds_read_b64_tr_b16 v[184:185], v18 offset:61440
v_mfma_f32_16x16x32_bf16 v[96:99], v[64:67], v[56:59], v[96:99]
ds_read_b64_tr_b16 v[186:187], v18 offset:63488
ds_read_b64_tr_b16 v[188:189], v19 offset:61440
v_mfma_f32_16x16x32_bf16 v[100:103], v[68:71], v[56:59], v[100:103]
ds_read_b64_tr_b16 v[190:191], v19 offset:63488
ds_read_b128 v[172:175], v2 offset:58368
v_mfma_f32_16x16x32_bf16 v[104:107], v[72:75], v[56:59], v[104:107]
v_mfma_f32_16x16x32_bf16 v[108:111], v[76:79], v[56:59], v[108:111]
v_mfma_f32_16x16x32_bf16 v[124:127], v[76:79], v[60:63], v[124:127]
s_branch Lov_6
.p2align 12
.fill 48, 4, 0xbf800000
Lst_6_0:
s_branch Lwr_166
s_nop 0
s_nop 0
Lov_6:
v_mfma_f32_16x16x32_bf16 v[120:123], v[72:75], v[60:63], v[120:123]
v_mfma_f32_16x16x32_bf16 v[116:119], v[68:71], v[60:63], v[116:119]
v_mfma_f32_16x16x32_bf16 v[112:115], v[64:67], v[60:63], v[112:115]
s_waitcnt lgkmcnt(0)
s_barrier
v_mfma_f32_16x16x32_bf16 v[96:99], v[152:155], v[144:147], v[96:99]
ds_read_b128 v[32:35], v3 offset:0
ds_read_b64_tr_b16 v[40:41], v20 offset:0
v_mfma_f32_16x16x32_bf16 v[100:103], v[156:159], v[144:147], v[100:103]
ds_read_b64_tr_b16 v[42:43], v20 offset:2048
ds_read_b64_tr_b16 v[44:45], v21 offset:0
v_mfma_f32_16x16x32_bf16 v[104:107], v[160:163], v[144:147], v[104:107]
ds_read_b64_tr_b16 v[46:47], v21 offset:2048
ds_read_b64_tr_b16 v[48:49], v22 offset:0
v_mfma_f32_16x16x32_bf16 v[108:111], v[164:167], v[144:147], v[108:111]
ds_read_b64_tr_b16 v[50:51], v22 offset:2048
ds_read_b64_tr_b16 v[52:53], v23 offset:0
v_mfma_f32_16x16x32_bf16 v[124:127], v[164:167], v[148:151], v[124:127]
ds_read_b64_tr_b16 v[54:55], v23 offset:2048
ds_read_b128 v[36:39], v3 offset:1024
v_mfma_f32_16x16x32_bf16 v[120:123], v[160:163], v[148:151], v[120:123]
ds_read_b128 v[56:59], v3 offset:8192
ds_read_b64_tr_b16 v[64:65], v20 offset:4096
v_mfma_f32_16x16x32_bf16 v[116:119], v[156:159], v[148:151], v[116:119]
ds_read_b64_tr_b16 v[66:67], v20 offset:6144
ds_read_b64_tr_b16 v[68:69], v21 offset:4096
v_mfma_f32_16x16x32_bf16 v[112:115], v[152:155], v[148:151], v[112:115]
ds_read_b64_tr_b16 v[70:71], v21 offset:6144
ds_read_b64_tr_b16 v[72:73], v22 offset:4096
v_mfma_f32_16x16x32_bf16 v[96:99], v[176:179], v[168:171], v[96:99]
ds_read_b64_tr_b16 v[74:75], v22 offset:6144
ds_read_b64_tr_b16 v[76:77], v23 offset:4096
v_mfma_f32_16x16x32_bf16 v[100:103], v[180:183], v[168:171], v[100:103]
ds_read_b64_tr_b16 v[78:79], v23 offset:6144
ds_read_b128 v[60:63], v3 offset:9216
v_mfma_f32_16x16x32_bf16 v[104:107], v[184:187], v[168:171], v[104:107]
v_mfma_f32_16x16x32_bf16 v[108:111], v[188:191], v[168:171], v[108:111]
v_mfma_f32_16x16x32_bf16 v[124:127], v[188:191], v[172:175], v[124:127]
v_mfma_f32_16x16x32_bf16 v[120:123], v[184:187], v[172:175], v[120:123]
v_mfma_f32_16x16x32_bf16 v[116:119], v[180:183], v[172:175], v[116:119]
v_mfma_f32_16x16x32_bf16 v[112:115], v[176:179], v[172:175], v[112:115]
s_waitcnt lgkmcnt(0)
v_mfma_f32_16x16x32_bf16 v[96:99], v[40:43], v[32:35], v[96:99]
ds_read_b128 v[144:147], v3 offset:49152
ds_read_b64_tr_b16 v[152:153], v20 offset:8192
v_mfma_f32_16x16x32_bf16 v[100:103], v[44:47], v[32:35], v[100:103]
ds_read_b64_tr_b16 v[154:155], v20 offset:10240
ds_read_b64_tr_b16 v[156:157], v21 offset:8192
v_mfma_f32_16x16x32_bf16 v[104:107], v[48:51], v[32:35], v[104:107]
ds_read_b64_tr_b16 v[158:159], v21 offset:10240
ds_read_b64_tr_b16 v[160:161], v22 offset:8192
v_mfma_f32_16x16x32_bf16 v[108:111], v[52:55], v[32:35], v[108:111]
ds_read_b64_tr_b16 v[162:163], v22 offset:10240
ds_read_b64_tr_b16 v[164:165], v23 offset:8192
v_mfma_f32_16x16x32_bf16 v[124:127], v[52:55], v[36:39], v[124:127]
ds_read_b64_tr_b16 v[166:167], v23 offset:10240
ds_read_b128 v[148:151], v3 offset:50176
v_mfma_f32_16x16x32_bf16 v[120:123], v[48:51], v[36:39], v[120:123]
ds_read_b128 v[168:171], v3 offset:57344
ds_read_b64_tr_b16 v[176:177], v20 offset:12288
v_mfma_f32_16x16x32_bf16 v[116:119], v[44:47], v[36:39], v[116:119]
ds_read_b64_tr_b16 v[178:179], v20 offset:14336
ds_read_b64_tr_b16 v[180:181], v21 offset:12288
v_mfma_f32_16x16x32_bf16 v[112:115], v[40:43], v[36:39], v[112:115]
ds_read_b64_tr_b16 v[182:183], v21 offset:14336
ds_read_b64_tr_b16 v[184:185], v22 offset:12288
v_mfma_f32_16x16x32_bf16 v[96:99], v[64:67], v[56:59], v[96:99]
ds_read_b64_tr_b16 v[186:187], v22 offset:14336
ds_read_b64_tr_b16 v[188:189], v23 offset:12288
v_mfma_f32_16x16x32_bf16 v[100:103], v[68:71], v[56:59], v[100:103]
ds_read_b64_tr_b16 v[190:191], v23 offset:14336
ds_read_b128 v[172:175], v3 offset:58368
v_mfma_f32_16x16x32_bf16 v[104:107], v[72:75], v[56:59], v[104:107]
v_mfma_f32_16x16x32_bf16 v[108:111], v[76:79], v[56:59], v[108:111]
v_mfma_f32_16x16x32_bf16 v[124:127], v[76:79], v[60:63], v[124:127]
v_mfma_f32_16x16x32_bf16 v[120:123], v[72:75], v[60:63], v[120:123]
v_mfma_f32_16x16x32_bf16 v[116:119], v[68:71], v[60:63], v[116:119]
v_mfma_f32_16x16x32_bf16 v[112:115], v[64:67], v[60:63], v[112:115]
s_waitcnt lgkmcnt(0)
v_mfma_f32_16x16x32_bf16 v[96:99], v[152:155], v[144:147], v[96:99]
v_mfma_f32_16x16x32_bf16 v[100:103], v[156:159], v[144:147], v[100:103]
v_mfma_f32_16x16x32_bf16 v[104:107], v[160:163], v[144:147], v[104:107]
v_mfma_f32_16x16x32_bf16 v[108:111], v[164:167], v[144:147], v[108:111]
v_mfma_f32_16x16x32_bf16 v[124:127], v[164:167], v[148:151], v[124:127]
v_mfma_f32_16x16x32_bf16 v[120:123], v[160:163], v[148:151], v[120:123]
v_mfma_f32_16x16x32_bf16 v[116:119], v[156:159], v[148:151], v[116:119]
v_mfma_f32_16x16x32_bf16 v[112:115], v[152:155], v[148:151], v[112:115]
v_mfma_f32_16x16x32_bf16 v[96:99], v[176:179], v[168:171], v[96:99]
v_mfma_f32_16x16x32_bf16 v[100:103], v[180:183], v[168:171], v[100:103]
v_mfma_f32_16x16x32_bf16 v[104:107], v[184:187], v[168:171], v[104:107]
v_mfma_f32_16x16x32_bf16 v[108:111], v[188:191], v[168:171], v[108:111]
v_mfma_f32_16x16x32_bf16 v[124:127], v[188:191], v[172:175], v[124:127]
v_mfma_f32_16x16x32_bf16 v[120:123], v[184:187], v[172:175], v[120:123]
v_mfma_f32_16x16x32_bf16 v[116:119], v[180:183], v[172:175], v[116:119]
v_mfma_f32_16x16x32_bf16 v[112:115], v[176:179], v[172:175], v[112:115]
s_nop 3
v_cvt_pk_bf16_f32 v32, v96, v97
v_cvt_pk_bf16_f32 v33, v98, v99
v_cvt_pk_bf16_f32 v34, v100, v101
v_cvt_pk_bf16_f32 v35, v102, v103
s_add_u32 s43, s60, 0
buffer_store_dwordx4 v[32:35], v11, s[20:23], s43 offen offset:0 sc1
v_cvt_pk_bf16_f32 v36, v104, v105
v_cvt_pk_bf16_f32 v37, v106, v107
v_cvt_pk_bf16_f32 v38, v108, v109
v_cvt_pk_bf16_f32 v39, v110, v111
s_add_u32 s43, s60, 8192
buffer_store_dwordx4 v[36:39], v11, s[20:23], s43 offen offset:0 sc1
v_cvt_pk_bf16_f32 v44, v120, v121
v_cvt_pk_bf16_f32 v45, v122, v123
v_cvt_pk_bf16_f32 v46, v124, v125
v_cvt_pk_bf16_f32 v47, v126, v127
s_add_u32 s43, s60, 8192
buffer_store_dwordx4 v[44:47], v11, s[20:23], s43 offen offset:1024 sc1
v_cvt_pk_bf16_f32 v40, v112, v113
v_cvt_pk_bf16_f32 v41, v114, v115
v_cvt_pk_bf16_f32 v42, v116, v117
v_cvt_pk_bf16_f32 v43, v118, v119
s_add_u32 s43, s60, 0
buffer_store_dwordx4 v[40:43], v11, s[20:23], s43 offen offset:1024 sc1
v_mov_b32 v64, 0
v_mov_b32 v65, 0
v_mov_b32 v66, 0
v_mov_b32 v67, 0
v_mov_b32 v68, 0
v_mov_b32 v69, 0
v_mov_b32 v70, 0
v_mov_b32 v71, 0
v_dot2_f32_bf16 v64, v32, s61, v64
v_dot2_f32_bf16 v66, v32, v32, v66
v_dot2_f32_bf16 v68, v40, s61, v68
v_dot2_f32_bf16 v70, v40, v40, v70
v_dot2_f32_bf16 v65, v33, s61, v65
v_dot2_f32_bf16 v67, v33, v33, v67
v_dot2_f32_bf16 v69, v41, s61, v69
v_dot2_f32_bf16 v71, v41, v41, v71
v_dot2_f32_bf16 v64, v34, s61, v64
v_dot2_f32_bf16 v66, v34, v34, v66
v_dot2_f32_bf16 v68, v42, s61, v68
v_dot2_f32_bf16 v70, v42, v42, v70
v_dot2_f32_bf16 v65, v35, s61, v65
v_dot2_f32_bf16 v67, v35, v35, v67
v_dot2_f32_bf16 v69, v43, s61, v69
v_dot2_f32_bf16 v71, v43, v43, v71
v_dot2_f32_bf16 v64, v36, s61, v64
v_dot2_f32_bf16 v66, v36, v36, v66
v_dot2_f32_bf16 v68, v44, s61, v68
v_dot2_f32_bf16 v70, v44, v44, v70
v_dot2_f32_bf16 v65, v37, s61, v65
v_dot2_f32_bf16 v67, v37, v37, v67
v_dot2_f32_bf16 v69, v45, s61, v69
v_dot2_f32_bf16 v71, v45, v45, v71
v_dot2_f32_bf16 v64, v38, s61, v64
v_dot2_f32_bf16 v66, v38, v38, v66
v_dot2_f32_bf16 v68, v46, s61, v68
v_dot2_f32_bf16 v70, v46, v46, v70
v_dot2_f32_bf16 v65, v39, s61, v65
v_dot2_f32_bf16 v67, v39, v39, v67
v_dot2_f32_bf16 v69, v47, s61, v69
v_dot2_f32_bf16 v71, v47, v47, v71
s_nop 2
v_add_f32 v64, v64, v65
v_add_f32 v66, v66, v67
v_add_f32 v68, v68, v69
v_add_f32 v70, v70, v71
s_nop 1
v_permlane32_swap_b32 v64, v68
v_permlane32_swap_b32 v66, v70
v_add_f32 v64, v64, v68
v_add_f32 v66, v66, v70
s_nop 1
v_permlane16_swap_b32 v64, v66
v_add_f32 v64, v64, v66
buffer_store_dword v64, v9, s[24:27], 0 offen sc1
s_lshl_b32 s7, s34, 12
s_add_u32 s7, s7, 49280
v_lshl_add_u32 v4, v1, 8, s7
v_mov_b32 v5, 1
s_waitcnt vmcnt(0)
s_cmp_lg_u32 s36, 0
s_barrier
s_cbranch_scc1 Lk2end_98
s_mov_b64 exec, 0xffff
buffer_atomic_add v5, v4, s[56:59], 0 offen sc1
s_mov_b64 exec, -1
s_branch Lk2end_98
Lprod_99:
s_mul_i32 s43, s34, 262144
s_add_u32 s8, s82, s43
s_addc_u32 s9, s83, 0
s_mov_b32 s10, 262144
s_mov_b32 s11, 0x20000
s_lshl_b32 s43, s35, 7
s_add_u32 s12, s68, s43
s_addc_u32 s13, s69, 0
s_mov_b32 s14, 2095232
s_mov_b32 s15, 0x20000
s_and_b32 s47, s36, 3
s_lshl_b32 s39, s47, 12
v_lshlrev_b32 v2, 4, v1
v_add_u32 v2, s39, v2
v_lshrrev_b32 v12, 3, v1
v_and_b32 v13, 6, v12
v_and_b32 v3, 7, v1
v_xor_b32 v3, v3, v13
v_lshlrev_b32 v3, 4, v3
v_mul_u32_u24 v12, 2048, v12
v_add_u32 v3, v3, v12
s_lshl_b32 s43, s47, 15
v_add_u32 v3, s43, v3
s_lshl_b32 s40, s47, 11
s_add_u32 s37, s35, 0
s_and_b32 s37, s37, 15
s_lshl_b32 s37, s37, 14
s_add_u32 m0, s39, 0
s_nop 0
buffer_load_dwordx4 v2, s[8:11], s37 offen offset:0 sc1 lds
buffer_load_dwordx4 v2, s[8:11], s37 offen offset:1024 sc1 lds
buffer_load_dwordx4 v2, s[8:11], s37 offen offset:2048 sc1 lds
buffer_load_dwordx4 v2, s[8:11], s37 offen offset:3072 sc1 lds
s_add_u32 s38, s35, 8
s_and_b32 s38, s38, 15
s_lshl_b32 s38, s38, 17
s_add_u32 m0, s40, 16384
s_nop 0
buffer_load_dwordx4 v3, s[12:15], s38 offen lds
s_add_u32 m0, s40, 17408
s_add_u32 s38, s38, 16384
buffer_load_dwordx4 v3, s[12:15], s38 offen lds
s_add_u32 s38, s35, 9
s_and_b32 s38, s38, 15
s_lshl_b32 s38, s38, 17
s_add_u32 m0, s40, 24576
s_nop 0
buffer_load_dwordx4 v3, s[12:15], s38 offen lds
s_add_u32 m0, s40, 25600
s_add_u32 s38, s38, 16384
buffer_load_dwordx4 v3, s[12:15], s38 offen lds
s_add_u32 s38, s35, 10
s_and_b32 s38, s38, 15
s_lshl_b32 s38, s38, 17
s_add_u32 m0, s40, 32768
s_nop 0
buffer_load_dwordx4 v3, s[12:15], s38 offen lds
s_add_u32 m0, s40, 33792
s_add_u32 s38, s38, 16384
buffer_load_dwordx4 v3, s[12:15], s38 offen lds
s_add_u32 s38, s35, 11
s_and_b32 s38, s38, 15
s_lshl_b32 s38, s38, 17
s_add_u32 m0, s40, 40960
s_nop 0
buffer_load_dwordx4 v3, s[12:15], s38 offen lds
s_add_u32 m0, s40, 41984
s_add_u32 s38, s38, 16384
buffer_load_dwordx4 v3, s[12:15], s38 offen lds
s_bitcmp0_b32 s36, 1
s_cselect_b32 s44, s72, s74
s_cselect_b32 s45, s73, s75
s_mul_i32 s43, s35, 192
s_add_u32 s16, s44, s43
s_addc_u32 s17, s45, 0
s_add_u32 s16, s16, 4096
s_addc_u32 s17, s17, 0
s_mov_b32 s18, 7333056
s_mov_b32 s19, 0x20000
s_and_b32 s43, s36, 1
s_mul_i32 s43, s43, 229376
v_add_u32 v196, 0, v1
v_mul_u32_u24 v197, 5462, v196
v_lshrrev_b32 v197, 16, v197
v_mul_u32_u24 v198, 12, v197
v_sub_u32 v198, v196, v198
v_bfe_u32 v199, v197, 2, 1
v_cmp_gt_u32 vcc, 8, v198
v_lshlrev_b32 v200, 1, v199
v_mul_u32_u24 v197, 7168, v197
v_cndmask_b32 v199, v199, v200, vcc
v_xor_b32 v198, v198, v199
v_lshl_add_u32 v192, v198, 4, v197
v_add_u32 v196, 64, v1
v_mul_u32_u24 v197, 5462, v196
v_lshrrev_b32 v197, 16, v197
v_mul_u32_u24 v198, 12, v197
v_sub_u32 v198, v196, v198
v_bfe_u32 v199, v197, 2, 1
v_cmp_gt_u32 vcc, 8, v198
v_lshlrev_b32 v200, 1, v199
v_mul_u32_u24 v197, 7168, v197
v_cndmask_b32 v199, v199, v200, vcc
v_xor_b32 v198, v198, v199
v_lshl_add_u32 v193, v198, 4, v197
v_add_u32 v196, 128, v1
v_mul_u32_u24 v197, 5462, v196
v_lshrrev_b32 v197, 16, v197
v_mul_u32_u24 v198, 12, v197
v_sub_u32 v198, v196, v198
v_bfe_u32 v199, v197, 2, 1
v_cmp_gt_u32 vcc, 8, v198
v_lshlrev_b32 v200, 1, v199
v_mul_u32_u24 v197, 7168, v197
v_cndmask_b32 v199, v199, v200, vcc
v_xor_b32 v198, v198, v199
v_lshl_add_u32 v194, v198, 4, v197
v_add_u32 v192, s43, v192
v_add_u32 v193, s43, v193
v_add_u32 v194, s43, v194
s_and_b32 s43, s36, 3
s_mul_i32 s50, s43, 6144
s_add_u32 s50, s50, 16384
s_cmp_eq_u32 s47, 3
s_cbranch_scc0 Lw_106
s_lshl_b32 s92, s34, 4
s_add_u32 s92, s92, s35
s_lshl_b32 s92, s92, 8
s_add_u32 s92, s92, 49152
s_add_u32 s92, s92, 28311552
s_mov_b32 s41, 0x40000
Lpoll_107:
s_load_dword s93, s[82:83], s92 glc
Lpchk_109:
s_waitcnt lgkmcnt(0)
s_cmp_eq_u32 s93, 16
s_cbranch_scc1 Lpok_108
s_sub_u32 s41, s41, 1
s_cmp_lg_u32 s41, 0
s_cbranch_scc1 Lpoll_107
Lpok_108:
Lw_106:
s_and_b32 s44, s36, 3
s_mul_i32 s44, s44, 11
s_bfe_u32 s43, s2, 0x30001
s_lshl_b32 s43, s43, 7
s_add_u32 s44, s44, s43
s_add_u32 s44, s44, 84
s_mul_i32 s44, s44, 7168
s_lshr_b32 s43, s2, 4
s_lshl_b32 s43, s43, 8
s_add_u32 s43, s43, s44
s_bitcmp0_b32 s2, 0
s_cselect_b32 s4, s72, s74
s_cselect_b32 s5, s73, s75
s_add_u32 s4, s4, s43
s_addc_u32 s5, s5, 0
s_cmp_eq_u32 s47, 3
s_cbranch_scc1 Lw_110
Lw_110:
s_waitcnt vmcnt(8)
s_barrier
s_add_u32 s37, s35, 1
s_and_b32 s37, s37, 15
s_lshl_b32 s37, s37, 14
s_add_u32 m0, s39, 49152
s_nop 0
buffer_load_dwordx4 v2, s[8:11], s37 offen offset:0 sc1 lds
buffer_load_dwordx4 v2, s[8:11], s37 offen offset:1024 sc1 lds
buffer_load_dwordx4 v2, s[8:11], s37 offen offset:2048 sc1 lds
buffer_load_dwordx4 v2, s[8:11], s37 offen offset:3072 sc1 lds
s_add_u32 s37, s35, 2
s_and_b32 s37, s37, 15
s_lshl_b32 s37, s37, 14
s_add_u32 m0, s39, 98304
s_nop 0
buffer_load_dwordx4 v2, s[8:11], s37 offen offset:0 sc1 lds
buffer_load_dwordx4 v2, s[8:11], s37 offen offset:1024 sc1 lds
buffer_load_dwordx4 v2, s[8:11], s37 offen offset:2048 sc1 lds
buffer_load_dwordx4 v2, s[8:11], s37 offen offset:3072 sc1 lds
s_add_u32 s37, s35, 3
s_and_b32 s37, s37, 15
s_lshl_b32 s37, s37, 14
s_add_u32 m0, s39, 147456
s_nop 0
buffer_load_dwordx4 v2, s[8:11], s37 offen offset:0 sc1 lds
buffer_load_dwordx4 v2, s[8:11], s37 offen offset:1024 sc1 lds
buffer_load_dwordx4 v2, s[8:11], s37 offen offset:2048 sc1 lds
buffer_load_dwordx4 v2, s[8:11], s37 offen offset:3072 sc1 lds
s_cmp_eq_u32 s47, 3
s_cbranch_scc0 Lw_111
Lw_111:
s_waitcnt vmcnt(8)
s_barrier
s_add_u32 s37, s35, 4
s_and_b32 s37, s37, 15
s_lshl_b32 s37, s37, 14
s_add_u32 m0, s39, 0
s_nop 0
buffer_load_dwordx4 v2, s[8:11], s37 offen offset:0 sc1 lds
buffer_load_dwordx4 v2, s[8:11], s37 offen offset:1024 sc1 lds
buffer_load_dwordx4 v2, s[8:11], s37 offen offset:2048 sc1 lds
buffer_load_dwordx4 v2, s[8:11], s37 offen offset:3072 sc1 lds
s_waitcnt vmcnt(8)
s_barrier
s_add_u32 s37, s35, 5
s_and_b32 s37, s37, 15
s_lshl_b32 s37, s37, 14
s_add_u32 m0, s39, 49152
s_nop 0
buffer_load_dwordx4 v2, s[8:11], s37 offen offset:0 sc1 lds
buffer_load_dwordx4 v2, s[8:11], s37 offen offset:1024 sc1 lds
buffer_load_dwordx4 v2, s[8:11], s37 offen offset:2048 sc1 lds
buffer_load_dwordx4 v2, s[8:11], s37 offen offset:3072 sc1 lds
s_waitcnt vmcnt(8)
s_barrier
s_add_u32 s37, s35, 6
s_and_b32 s37, s37, 15
s_lshl_b32 s37, s37, 14
s_add_u32 m0, s39, 98304
s_nop 0
buffer_load_dwordx4 v2, s[8:11], s37 offen offset:0 sc1 lds
buffer_load_dwordx4 v2, s[8:11], s37 offen offset:1024 sc1 lds
buffer_load_dwordx4 v2, s[8:11], s37 offen offset:2048 sc1 lds
buffer_load_dwordx4 v2, s[8:11], s37 offen offset:3072 sc1 lds
s_waitcnt vmcnt(8)
s_barrier
s_add_u32 s37, s35, 7
s_and_b32 s37, s37, 15
s_lshl_b32 s37, s37, 14
s_add_u32 m0, s39, 147456
s_nop 0
buffer_load_dwordx4 v2, s[8:11], s37 offen offset:0 sc1 lds
buffer_load_dwordx4 v2, s[8:11], s37 offen offset:1024 sc1 lds
buffer_load_dwordx4 v2, s[8:11], s37 offen offset:2048 sc1 lds
buffer_load_dwordx4 v2, s[8:11], s37 offen offset:3072 sc1 lds
s_waitcnt vmcnt(8)
s_barrier
s_add_u32 s37, s35, 8
s_and_b32 s37, s37, 15
s_lshl_b32 s37, s37, 14
s_add_u32 m0, s39, 0
s_nop 0
buffer_load_dwordx4 v2, s[8:11], s37 offen offset:0 sc1 lds
buffer_load_dwordx4 v2, s[8:11], s37 offen offset:1024 sc1 lds
buffer_load_dwordx4 v2, s[8:11], s37 offen offset:2048 sc1 lds
buffer_load_dwordx4 v2, s[8:11], s37 offen offset:3072 sc1 lds
s_add_u32 s38, s35, 12
s_and_b32 s38, s38, 15
s_lshl_b32 s38, s38, 17
s_add_u32 m0, s40, 114688
s_nop 0
buffer_load_dwordx4 v3, s[12:15], s38 offen lds
s_add_u32 m0, s40, 115712
s_add_u32 s38, s38, 16384
buffer_load_dwordx4 v3, s[12:15], s38 offen lds
s_waitcnt vmcnt(10)
s_barrier
s_add_u32 s37, s35, 9
s_and_b32 s37, s37, 15
s_lshl_b32 s37, s37, 14
s_add_u32 m0, s39, 49152
s_nop 0
buffer_load_dwordx4 v2, s[8:11], s37 offen offset:0 sc1 lds
buffer_load_dwordx4 v2, s[8:11], s37 offen offset:1024 sc1 lds
buffer_load_dwordx4 v2, s[8:11], s37 offen offset:2048 sc1 lds
buffer_load_dwordx4 v2, s[8:11], s37 offen offset:3072 sc1 lds
s_add_u32 s38, s35, 13
s_and_b32 s38, s38, 15
s_lshl_b32 s38, s38, 17
s_add_u32 m0, s40, 122880
s_nop 0
buffer_load_dwordx4 v3, s[12:15], s38 offen lds
s_add_u32 m0, s40, 123904
s_add_u32 s38, s38, 16384
buffer_load_dwordx4 v3, s[12:15], s38 offen lds
s_waitcnt vmcnt(12)
s_barrier
s_add_u32 s37, s35, 10
s_and_b32 s37, s37, 15
s_lshl_b32 s37, s37, 14
s_add_u32 m0, s39, 98304
s_nop 0
buffer_load_dwordx4 v2, s[8:11], s37 offen offset:0 sc1 lds
buffer_load_dwordx4 v2, s[8:11], s37 offen offset:1024 sc1 lds
buffer_load_dwordx4 v2, s[8:11], s37 offen offset:2048 sc1 lds
buffer_load_dwordx4 v2, s[8:11], s37 offen offset:3072 sc1 lds
s_add_u32 s38, s35, 14
s_and_b32 s38, s38, 15
s_lshl_b32 s38, s38, 17
s_add_u32 m0, s40, 131072
s_nop 0
buffer_load_dwordx4 v3, s[12:15], s38 offen lds
s_add_u32 m0, s40, 132096
s_add_u32 s38, s38, 16384
buffer_load_dwordx4 v3, s[12:15], s38 offen lds
s_waitcnt vmcnt(14)
s_barrier
s_add_u32 s37, s35, 11
s_and_b32 s37, s37, 15
s_lshl_b32 s37, s37, 14
s_add_u32 m0, s39, 147456
s_nop 0
buffer_load_dwordx4 v2, s[8:11], s37 offen offset:0 sc1 lds
buffer_load_dwordx4 v2, s[8:11], s37 offen offset:1024 sc1 lds
buffer_load_dwordx4 v2, s[8:11], s37 offen offset:2048 sc1 lds
buffer_load_dwordx4 v2, s[8:11], s37 offen offset:3072 sc1 lds
s_add_u32 s38, s35, 15
s_and_b32 s38, s38, 15
s_lshl_b32 s38, s38, 17
s_add_u32 m0, s40, 139264
s_nop 0
buffer_load_dwordx4 v3, s[12:15], s38 offen lds
s_add_u32 m0, s40, 140288
s_add_u32 s38, s38, 16384
buffer_load_dwordx4 v3, s[12:15], s38 offen lds
s_waitcnt vmcnt(14)
s_barrier
s_add_u32 s37, s35, 12
s_and_b32 s37, s37, 15
s_lshl_b32 s37, s37, 14
s_add_u32 m0, s39, 0
s_nop 0
buffer_load_dwordx4 v2, s[8:11], s37 offen offset:0 sc1 lds
buffer_load_dwordx4 v2, s[8:11], s37 offen offset:1024 sc1 lds
buffer_load_dwordx4 v2, s[8:11], s37 offen offset:2048 sc1 lds
buffer_load_dwordx4 v2, s[8:11], s37 offen offset:3072 sc1 lds
s_waitcnt vmcnt(12)
s_barrier
s_add_u32 s37, s35, 13
s_and_b32 s37, s37, 15
s_lshl_b32 s37, s37, 14
s_add_u32 m0, s39, 49152
s_nop 0
buffer_load_dwordx4 v2, s[8:11], s37 offen offset:0 sc1 lds
buffer_load_dwordx4 v2, s[8:11], s37 offen offset:1024 sc1 lds
buffer_load_dwordx4 v2, s[8:11], s37 offen offset:2048 sc1 lds
buffer_load_dwordx4 v2, s[8:11], s37 offen offset:3072 sc1 lds
s_waitcnt vmcnt(10)
s_barrier
s_add_u32 s37, s35, 14
s_and_b32 s37, s37, 15
s_lshl_b32 s37, s37, 14
s_add_u32 m0, s39, 98304
s_nop 0
buffer_load_dwordx4 v2, s[8:11], s37 offen offset:0 sc1 lds
buffer_load_dwordx4 v2, s[8:11], s37 offen offset:1024 sc1 lds
buffer_load_dwordx4 v2, s[8:11], s37 offen offset:2048 sc1 lds
buffer_load_dwordx4 v2, s[8:11], s37 offen offset:3072 sc1 lds
s_getpc_b64 s[100:101]
s_and_b32 s100, s100, 0xfffff000
s_sub_u32 s100, s100, 1077248
s_subb_u32 s101, s101, 0
s_lshr_b32 s6, s2, 3
s_mul_i32 s6, s6, 4
s_and_b32 s7, s36, 3
s_add_u32 s6, s6, s7
s_mulk_i32 s6, 384
s_add_u32 s6, s6, 1082048
s_load_dword s3, s[100:101], s6 offset:0
s_load_dword s3, s[100:101], s6 offset:64
s_load_dword s3, s[100:101], s6 offset:128
s_load_dword s3, s[100:101], s6 offset:192
s_load_dword s3, s[100:101], s6 offset:256
s_load_dword s3, s[100:101], s6 offset:320
s_nop 0
s_nop 0
s_waitcnt vmcnt(8)
s_barrier
s_add_u32 s37, s35, 15
s_and_b32 s37, s37, 15
s_lshl_b32 s37, s37, 14
s_add_u32 m0, s39, 147456
s_nop 0
buffer_load_dwordx4 v2, s[8:11], s37 offen offset:0 sc1 lds
buffer_load_dwordx4 v2, s[8:11], s37 offen offset:1024 sc1 lds
buffer_load_dwordx4 v2, s[8:11], s37 offen offset:2048 sc1 lds
buffer_load_dwordx4 v2, s[8:11], s37 offen offset:3072 sc1 lds
s_waitcnt vmcnt(8)
s_barrier
s_waitcnt vmcnt(0)
s_barrier
s_add_u32 s38, s35, 0
s_and_b32 s38, s38, 15
s_mul_i32 s38, s38, 458752
s_add_u32 m0, s50, 0
s_nop 0
buffer_load_dwordx4 v192, s[16:19], s38 offen lds
s_add_u32 m0, s50, 1024
s_nop 0
buffer_load_dwordx4 v193, s[16:19], s38 offen lds
s_add_u32 m0, s50, 2048
s_nop 0
buffer_load_dwordx4 v194, s[16:19], s38 offen lds
s_add_u32 m0, s50, 3072
s_add_u32 s38, s38, 114688
buffer_load_dwordx4 v192, s[16:19], s38 offen lds
s_add_u32 m0, s50, 4096
s_nop 0
buffer_load_dwordx4 v193, s[16:19], s38 offen lds
s_add_u32 m0, s50, 5120
s_nop 0
buffer_load_dwordx4 v194, s[16:19], s38 offen lds
s_add_u32 s38, s35, 1
s_and_b32 s38, s38, 15
s_mul_i32 s38, s38, 458752
s_add_u32 m0, s50, 49152
s_nop 0
buffer_load_dwordx4 v192, s[16:19], s38 offen lds
s_add_u32 m0, s50, 50176
s_nop 0
buffer_load_dwordx4 v193, s[16:19], s38 offen lds
s_add_u32 m0, s50, 51200
s_nop 0
buffer_load_dwordx4 v194, s[16:19], s38 offen lds
s_add_u32 m0, s50, 52224
s_add_u32 s38, s38, 114688
buffer_load_dwordx4 v192, s[16:19], s38 offen lds
s_add_u32 m0, s50, 53248
s_nop 0
buffer_load_dwordx4 v193, s[16:19], s38 offen lds
s_add_u32 m0, s50, 54272
s_nop 0
buffer_load_dwordx4 v194, s[16:19], s38 offen lds
v_lshlrev_b32 v240, 16, v128
v_and_b32 v241, 0xffff0000, v128
v_lshlrev_b32 v242, 16, v129
v_and_b32 v243, 0xffff0000, v129
v_lshlrev_b32 v244, 16, v130
v_and_b32 v245, 0xffff0000, v130
v_lshlrev_b32 v246, 16, v131
v_and_b32 v247, 0xffff0000, v131
v_lshlrev_b32 v24, 16, v132
v_and_b32 v25, 0xffff0000, v132
v_lshlrev_b32 v26, 16, v133
v_and_b32 v27, 0xffff0000, v133
v_lshlrev_b32 v28, 16, v134
v_and_b32 v29, 0xffff0000, v134
v_lshlrev_b32 v30, 16, v135
v_and_b32 v31, 0xffff0000, v135
v_add_f32 v240, v240, v24
v_add_f32 v241, v241, v25
v_add_f32 v242, v242, v26
v_add_f32 v243, v243, v27
v_add_f32 v244, v244, v28
v_add_f32 v245, v245, v29
v_add_f32 v246, v246, v30
v_add_f32 v247, v247, v31
v_lshlrev_b32 v24, 16, v136
s_branch Lov_7
.p2align 12
.fill 48, 4, 0xbf800000
Lst_7_0:
s_branch Lwr_167
s_nop 0
s_nop 0
Lov_7:
v_and_b32 v25, 0xffff0000, v136
v_lshlrev_b32 v26, 16, v137
v_and_b32 v27, 0xffff0000, v137
v_lshlrev_b32 v28, 16, v138
v_and_b32 v29, 0xffff0000, v138
v_lshlrev_b32 v30, 16, v139
v_and_b32 v31, 0xffff0000, v139
v_add_f32 v240, v240, v24
v_add_f32 v241, v241, v25
v_add_f32 v242, v242, v26
v_add_f32 v243, v243, v27
v_add_f32 v244, v244, v28
v_add_f32 v245, v245, v29
v_add_f32 v246, v246, v30
v_add_f32 v247, v247, v31
v_lshlrev_b32 v24, 16, v140
v_and_b32 v25, 0xffff0000, v140
v_lshlrev_b32 v26, 16, v141
v_and_b32 v27, 0xffff0000, v141
v_lshlrev_b32 v28, 16, v142
v_and_b32 v29, 0xffff0000, v142
v_lshlrev_b32 v30, 16, v143
v_and_b32 v31, 0xffff0000, v143
v_add_f32 v240, v240, v24
v_add_f32 v241, v241, v25
v_add_f32 v242, v242, v26
v_add_f32 v243, v243, v27
v_add_f32 v244, v244, v28
v_add_f32 v245, v245, v29
v_add_f32 v246, v246, v30
v_add_f32 v247, v247, v31
v_lshlrev_b32 v24, 16, v144
v_and_b32 v25, 0xffff0000, v144
v_lshlrev_b32 v26, 16, v145
v_and_b32 v27, 0xffff0000, v145
v_lshlrev_b32 v28, 16, v146
v_and_b32 v29, 0xffff0000, v146
v_lshlrev_b32 v30, 16, v147
v_and_b32 v31, 0xffff0000, v147
v_add_f32 v240, v240, v24
v_add_f32 v241, v241, v25
v_add_f32 v242, v242, v26
v_add_f32 v243, v243, v27
v_add_f32 v244, v244, v28
v_add_f32 v245, v245, v29
v_add_f32 v246, v246, v30
v_add_f32 v247, v247, v31
v_lshlrev_b32 v24, 16, v148
v_and_b32 v25, 0xffff0000, v148
v_lshlrev_b32 v26, 16, v149
v_and_b32 v27, 0xffff0000, v149
v_lshlrev_b32 v28, 16, v150
v_and_b32 v29, 0xffff0000, v150
v_lshlrev_b32 v30, 16, v151
v_and_b32 v31, 0xffff0000, v151
v_add_f32 v240, v240, v24
v_add_f32 v241, v241, v25
v_add_f32 v242, v242, v26
v_add_f32 v243, v243, v27
v_add_f32 v244, v244, v28
v_add_f32 v245, v245, v29
v_add_f32 v246, v246, v30
v_add_f32 v247, v247, v31
v_lshlrev_b32 v24, 16, v152
v_and_b32 v25, 0xffff0000, v152
v_lshlrev_b32 v26, 16, v153
v_and_b32 v27, 0xffff0000, v153
v_lshlrev_b32 v28, 16, v154
v_and_b32 v29, 0xffff0000, v154
v_lshlrev_b32 v30, 16, v155
v_and_b32 v31, 0xffff0000, v155
v_add_f32 v240, v240, v24
v_add_f32 v241, v241, v25
v_add_f32 v242, v242, v26
v_add_f32 v243, v243, v27
v_add_f32 v244, v244, v28
v_add_f32 v245, v245, v29
v_add_f32 v246, v246, v30
v_add_f32 v247, v247, v31
v_lshlrev_b32 v24, 16, v156
v_and_b32 v25, 0xffff0000, v156
v_lshlrev_b32 v26, 16, v157
v_and_b32 v27, 0xffff0000, v157
v_lshlrev_b32 v28, 16, v158
v_and_b32 v29, 0xffff0000, v158
v_lshlrev_b32 v30, 16, v159
v_and_b32 v31, 0xffff0000, v159
v_add_f32 v240, v240, v24
v_add_f32 v241, v241, v25
v_add_f32 v242, v242, v26
v_add_f32 v243, v243, v27
v_add_f32 v244, v244, v28
v_add_f32 v245, v245, v29
v_add_f32 v246, v246, v30
v_add_f32 v247, v247, v31
s_nop 0
v_permlane32_swap_b32 v240, v244
v_permlane32_swap_b32 v241, v245
v_permlane32_swap_b32 v242, v246
v_permlane32_swap_b32 v243, v247
v_add_f32 v240, v240, v244
v_add_f32 v241, v241, v245
v_add_f32 v242, v242, v246
v_add_f32 v243, v243, v247
s_nop 0
v_permlane16_swap_b32 v240, v242
v_permlane16_swap_b32 v241, v243
v_add_f32 v240, v240, v242
v_add_f32 v241, v241, v243
s_branch Lk3a
Lk2end_98:
Lk3:
s_branch Lgb_112
Lk3a:
s_mul_i32 s43, s34, 262144
s_add_u32 s8, s82, s43
s_addc_u32 s9, s83, 0
s_add_u32 s8, s8, 4194304
s_addc_u32 s9, s9, 0
s_mov_b32 s10, 262144
s_mov_b32 s11, 0x20000
s_mul_i32 s43, s34, 917504
s_add_u32 s24, s82, s43
s_addc_u32 s25, s83, 0
s_add_u32 s24, s24, 8388608
s_addc_u32 s25, s25, 0
s_mov_b32 s26, 917504
s_mov_b32 s27, 0x20000
s_add_u32 s84, s82, 27262976
s_addc_u32 s85, s83, 0
s_mov_b32 s86, 229376
s_mov_b32 s87, 0x20000
s_and_b32 s47, s36, 3
s_lshr_b32 s62, s47, 1
s_and_b32 s63, s47, 1
v_lshlrev_b32 v2, 4, v1
s_lshl_b32 s39, s47, 12
v_add_u32 v3, s39, v2
s_bitcmp0_b32 s36, 1
s_cselect_b32 s44, s72, s74
s_cselect_b32 s45, s73, s75
s_mul_i32 s43, s35, 256
s_add_u32 s12, s44, s43
s_addc_u32 s13, s45, 0
s_mov_b32 s14, 7333120
s_mov_b32 s15, 0x20000
s_and_b32 s43, s36, 1
s_mul_i32 s43, s43, 229376
v_lshrrev_b32 v28, 4, v1
v_lshlrev_b32 v29, 1, v28
v_and_b32 v4, 15, v1
v_xor_b32 v4, v4, v29
v_lshlrev_b32 v4, 4, v4
v_mul_u32_u24 v28, 7168, v28
v_add_u32 v4, v4, v28
v_add_u32 v4, s43, v4
v_xor_b32 v5, 128, v4
v_add_u32 v5, 28672, v5
s_and_b32 s43, s36, 3
s_mul_i32 s40, s43, 8192
s_add_u32 s40, s40, 16384
v_mov_b32 v6, v192
v_mov_b32 v7, v193
v_mov_b32 v8, v194
s_lshl_b32 s43, s62, 12
v_add_u32 v9, s43, v2
v_add_u32 v10, 98304, v9
v_lshrrev_b32 v27, 2, v1
v_bfe_u32 v28, v27, 2, 1
v_mul_u32_u24 v27, 192, v27
v_add_u32 v27, 16384, v27
v_and_b32 v29, 3, v1
v_lshl_add_u32 v12, v29, 3, v27
s_lshl_b32 s43, s63, 6
v_add_u32 v12, s43, v12
v_lshl_add_u32 v11, v28, 5, v12
v_xor_b32 v30, 1, v28
v_lshl_add_u32 v12, v30, 5, v12
v_xor_b32 v28, s63, v28
v_lshl_add_u32 v27, v28, 4, v27
v_lshrrev_b32 v28, 1, v29
v_lshl_add_u32 v27, v28, 5, v27
v_and_b32 v28, 1, v29
v_lshl_add_u32 v27, v28, 3, v27
v_add_u32 v13, 128, v27
v_add_u32 v14, 49152, v11
v_add_u32 v15, 49152, v12
v_add_u32 v16, 49152, v13
v_add_u32 v17, 98304, v11
v_add_u32 v18, 98304, v12
v_add_u32 v19, 98304, v13
s_cmp_lg_u32 s36, 4
s_cbranch_scc1 Lwm_114
s_branch Lst_8_1
Lwr_179:
s_branch Lwe_113
Lwm_114:
s_cmp_lg_u32 s36, 5
s_cbranch_scc1 Lwm_115
s_branch Lst_9_1
Lwr_180:
s_branch Lwe_113
Lwm_115:
s_cmp_lg_u32 s36, 6
s_cbranch_scc1 Lwm_116
s_branch Lst_10_1
Lwr_181:
s_branch Lwe_113
Lwm_116:
s_cmp_lg_u32 s36, 7
s_cbranch_scc1 Lwm_117
s_nop 0
s_branch Lwe_113
Lwm_117:
Lwe_113:
s_barrier
s_lshl_b32 s43, s47, 9
s_add_u32 s43, s43, 151552
v_and_b32 v28, 15, v1
v_lshl_add_u32 v28, v28, 5, s43
v_lshrrev_b32 v29, 4, v1
v_lshl_add_u32 v28, v29, 3, v28
ds_write_b64 v28, v[240:241]
s_waitcnt lgkmcnt(0)
s_cmp_lg_u32 s36, 4
s_cbranch_scc1 Lwm_119
s_branch Lst_11_1
Lwr_183:
s_branch Lwe_118
Lwm_119:
s_cmp_lg_u32 s36, 5
s_cbranch_scc1 Lwm_120
s_branch Lst_12_1
Lwr_184:
s_branch Lwe_118
Lwm_120:
s_cmp_lg_u32 s36, 6
s_cbranch_scc1 Lwm_121
s_branch Lst_13_1
Lwr_185:
s_branch Lwe_118
Lwm_121:
s_cmp_lg_u32 s36, 7
s_cbranch_scc1 Lwm_122
s_branch Lst_14_1
Lwr_186:
s_branch Lwe_118
Lwm_122:
Lwe_118:
s_waitcnt vmcnt(0) lgkmcnt(0)
s_barrier
ds_read_b128 v[32:35], v9 offset:0
ds_read_b64_tr_b16 v[48:49], v11 offset:0
ds_read_b64_tr_b16 v[50:51], v11 offset:3072
ds_read_b64_tr_b16 v[52:53], v12 offset:0
ds_read_b64_tr_b16 v[54:55], v12 offset:3072
ds_read_b64_tr_b16 v[56:57], v13 offset:0
ds_read_b64_tr_b16 v[58:59], v13 offset:3072
ds_read_b64_tr_b16 v[60:61], v11 offset:12288
ds_read_b64_tr_b16 v[62:63], v11 offset:15360
ds_read_b64_tr_b16 v[64:65], v12 offset:12288
ds_read_b64_tr_b16 v[66:67], v12 offset:15360
ds_read_b64_tr_b16 v[68:69], v13 offset:12288
ds_read_b64_tr_b16 v[70:71], v13 offset:15360
ds_read_b128 v[36:39], v9 offset:1024
ds_read_b128 v[40:43], v9 offset:2048
ds_read_b128 v[44:47], v9 offset:3072
s_waitcnt lgkmcnt(0)
v_mfma_f32_16x16x32_bf16 v[128:131], v[48:51], v[32:35], 0
ds_read_b128 v[72:75], v9 offset:8192
v_mfma_f32_16x16x32_bf16 v[152:155], v[48:51], v[36:39], 0
ds_read_b64_tr_b16 v[88:89], v11 offset:6144
v_mfma_f32_16x16x32_bf16 v[176:179], v[48:51], v[40:43], 0
ds_read_b64_tr_b16 v[90:91], v11 offset:9216
v_mfma_f32_16x16x32_bf16 v[200:203], v[48:51], v[44:47], 0
ds_read_b64_tr_b16 v[92:93], v12 offset:6144
v_mfma_f32_16x16x32_bf16 v[204:207], v[52:55], v[44:47], 0
ds_read_b64_tr_b16 v[94:95], v12 offset:9216
v_mfma_f32_16x16x32_bf16 v[180:183], v[52:55], v[40:43], 0
ds_read_b64_tr_b16 v[96:97], v13 offset:6144
v_mfma_f32_16x16x32_bf16 v[156:159], v[52:55], v[36:39], 0
ds_read_b64_tr_b16 v[98:99], v13 offset:9216
v_mfma_f32_16x16x32_bf16 v[132:135], v[52:55], v[32:35], 0
ds_read_b64_tr_b16 v[100:101], v11 offset:18432
v_mfma_f32_16x16x32_bf16 v[136:139], v[56:59], v[32:35], 0
ds_read_b64_tr_b16 v[102:103], v11 offset:21504
v_mfma_f32_16x16x32_bf16 v[160:163], v[56:59], v[36:39], 0
ds_read_b64_tr_b16 v[104:105], v12 offset:18432
v_mfma_f32_16x16x32_bf16 v[184:187], v[56:59], v[40:43], 0
ds_read_b64_tr_b16 v[106:107], v12 offset:21504
v_mfma_f32_16x16x32_bf16 v[208:211], v[56:59], v[44:47], 0
ds_read_b64_tr_b16 v[108:109], v13 offset:18432
v_mfma_f32_16x16x32_bf16 v[212:215], v[60:63], v[44:47], 0
ds_read_b64_tr_b16 v[110:111], v13 offset:21504
v_mfma_f32_16x16x32_bf16 v[188:191], v[60:63], v[40:43], 0
ds_read_b128 v[76:79], v9 offset:9216
v_mfma_f32_16x16x32_bf16 v[164:167], v[60:63], v[36:39], 0
ds_read_b128 v[80:83], v9 offset:10240
v_mfma_f32_16x16x32_bf16 v[140:143], v[60:63], v[32:35], 0
ds_read_b128 v[84:87], v9 offset:11264
v_mfma_f32_16x16x32_bf16 v[144:147], v[64:67], v[32:35], 0
v_mfma_f32_16x16x32_bf16 v[168:171], v[64:67], v[36:39], 0
v_mfma_f32_16x16x32_bf16 v[192:195], v[64:67], v[40:43], 0
v_mfma_f32_16x16x32_bf16 v[216:219], v[64:67], v[44:47], 0
v_mfma_f32_16x16x32_bf16 v[220:223], v[68:71], v[44:47], 0
v_mfma_f32_16x16x32_bf16 v[196:199], v[68:71], v[40:43], 0
v_mfma_f32_16x16x32_bf16 v[172:175], v[68:71], v[36:39], 0
v_mfma_f32_16x16x32_bf16 v[148:151], v[68:71], v[32:35], 0
s_waitcnt lgkmcnt(0)
s_barrier
v_mfma_f32_16x16x32_bf16 v[128:131], v[88:91], v[72:75], v[128:131]
ds_read_b128 v[32:35], v9 offset:49152
v_mfma_f32_16x16x32_bf16 v[152:155], v[88:91], v[76:79], v[152:155]
ds_read_b64_tr_b16 v[48:49], v14 offset:0
v_mfma_f32_16x16x32_bf16 v[176:179], v[88:91], v[80:83], v[176:179]
ds_read_b64_tr_b16 v[50:51], v14 offset:3072
v_mfma_f32_16x16x32_bf16 v[200:203], v[88:91], v[84:87], v[200:203]
ds_read_b64_tr_b16 v[52:53], v15 offset:0
v_mfma_f32_16x16x32_bf16 v[204:207], v[92:95], v[84:87], v[204:207]
ds_read_b64_tr_b16 v[54:55], v15 offset:3072
v_mfma_f32_16x16x32_bf16 v[180:183], v[92:95], v[80:83], v[180:183]
ds_read_b64_tr_b16 v[56:57], v16 offset:0
v_mfma_f32_16x16x32_bf16 v[156:159], v[92:95], v[76:79], v[156:159]
ds_read_b64_tr_b16 v[58:59], v16 offset:3072
v_mfma_f32_16x16x32_bf16 v[132:135], v[92:95], v[72:75], v[132:135]
ds_read_b64_tr_b16 v[60:61], v14 offset:12288
v_mfma_f32_16x16x32_bf16 v[136:139], v[96:99], v[72:75], v[136:139]
ds_read_b64_tr_b16 v[62:63], v14 offset:15360
v_mfma_f32_16x16x32_bf16 v[160:163], v[96:99], v[76:79], v[160:163]
ds_read_b64_tr_b16 v[64:65], v15 offset:12288
v_mfma_f32_16x16x32_bf16 v[184:187], v[96:99], v[80:83], v[184:187]
ds_read_b64_tr_b16 v[66:67], v15 offset:15360
v_mfma_f32_16x16x32_bf16 v[208:211], v[96:99], v[84:87], v[208:211]
ds_read_b64_tr_b16 v[68:69], v16 offset:12288
v_mfma_f32_16x16x32_bf16 v[212:215], v[100:103], v[84:87], v[212:215]
ds_read_b64_tr_b16 v[70:71], v16 offset:15360
v_mfma_f32_16x16x32_bf16 v[188:191], v[100:103], v[80:83], v[188:191]
ds_read_b128 v[36:39], v9 offset:50176
v_mfma_f32_16x16x32_bf16 v[164:167], v[100:103], v[76:79], v[164:167]
ds_read_b128 v[40:43], v9 offset:51200
v_mfma_f32_16x16x32_bf16 v[140:143], v[100:103], v[72:75], v[140:143]
ds_read_b128 v[44:47], v9 offset:52224
v_mfma_f32_16x16x32_bf16 v[144:147], v[104:107], v[72:75], v[144:147]
v_mfma_f32_16x16x32_bf16 v[168:171], v[104:107], v[76:79], v[168:171]
v_mfma_f32_16x16x32_bf16 v[192:195], v[104:107], v[80:83], v[192:195]
v_mfma_f32_16x16x32_bf16 v[216:219], v[104:107], v[84:87], v[216:219]
v_mfma_f32_16x16x32_bf16 v[220:223], v[108:111], v[84:87], v[220:223]
v_mfma_f32_16x16x32_bf16 v[196:199], v[108:111], v[80:83], v[196:199]
v_mfma_f32_16x16x32_bf16 v[172:175], v[108:111], v[76:79], v[172:175]
v_mfma_f32_16x16x32_bf16 v[148:151], v[108:111], v[72:75], v[148:151]
s_mov_b32 s41, 5
Lk3l_123:
s_waitcnt lgkmcnt(0)
v_mfma_f32_16x16x32_bf16 v[128:131], v[48:51], v[32:35], v[128:131]
ds_read_b128 v[72:75], v9 offset:57344
v_mfma_f32_16x16x32_bf16 v[152:155], v[48:51], v[36:39], v[152:155]
ds_read_b64_tr_b16 v[88:89], v14 offset:6144
v_mfma_f32_16x16x32_bf16 v[176:179], v[48:51], v[40:43], v[176:179]
ds_read_b64_tr_b16 v[90:91], v14 offset:9216
v_mfma_f32_16x16x32_bf16 v[200:203], v[48:51], v[44:47], v[200:203]
ds_read_b64_tr_b16 v[92:93], v15 offset:6144
v_mfma_f32_16x16x32_bf16 v[204:207], v[52:55], v[44:47], v[204:207]
ds_read_b64_tr_b16 v[94:95], v15 offset:9216
v_mfma_f32_16x16x32_bf16 v[180:183], v[52:55], v[40:43], v[180:183]
ds_read_b64_tr_b16 v[96:97], v16 offset:6144
v_mfma_f32_16x16x32_bf16 v[156:159], v[52:55], v[36:39], v[156:159]
ds_read_b64_tr_b16 v[98:99], v16 offset:9216
v_mfma_f32_16x16x32_bf16 v[132:135], v[52:55], v[32:35], v[132:135]
ds_read_b64_tr_b16 v[100:101], v14 offset:18432
v_mfma_f32_16x16x32_bf16 v[136:139], v[56:59], v[32:35], v[136:139]
ds_read_b64_tr_b16 v[102:103], v14 offset:21504
v_mfma_f32_16x16x32_bf16 v[160:163], v[56:59], v[36:39], v[160:163]
ds_read_b64_tr_b16 v[104:105], v15 offset:18432
v_mfma_f32_16x16x32_bf16 v[184:187], v[56:59], v[40:43], v[184:187]
ds_read_b64_tr_b16 v[106:107], v15 offset:21504
v_mfma_f32_16x16x32_bf16 v[208:211], v[56:59], v[44:47], v[208:211]
ds_read_b64_tr_b16 v[108:109], v16 offset:18432
v_mfma_f32_16x16x32_bf16 v[212:215], v[60:63], v[44:47], v[212:215]
ds_read_b64_tr_b16 v[110:111], v16 offset:21504
v_mfma_f32_16x16x32_bf16 v[188:191], v[60:63], v[40:43], v[188:191]
ds_read_b128 v[76:79], v9 offset:58368
v_mfma_f32_16x16x32_bf16 v[164:167], v[60:63], v[36:39], v[164:167]
ds_read_b128 v[80:83], v9 offset:59392
v_mfma_f32_16x16x32_bf16 v[140:143], v[60:63], v[32:35], v[140:143]
ds_read_b128 v[84:87], v9 offset:60416
v_mfma_f32_16x16x32_bf16 v[144:147], v[64:67], v[32:35], v[144:147]
v_mfma_f32_16x16x32_bf16 v[168:171], v[64:67], v[36:39], v[168:171]
v_mfma_f32_16x16x32_bf16 v[192:195], v[64:67], v[40:43], v[192:195]
v_mfma_f32_16x16x32_bf16 v[216:219], v[64:67], v[44:47], v[216:219]
v_mfma_f32_16x16x32_bf16 v[220:223], v[68:71], v[44:47], v[220:223]
v_mfma_f32_16x16x32_bf16 v[196:199], v[68:71], v[40:43], v[196:199]
v_mfma_f32_16x16x32_bf16 v[172:175], v[68:71], v[36:39], v[172:175]
v_mfma_f32_16x16x32_bf16 v[148:151], v[68:71], v[32:35], v[148:151]
s_waitcnt lgkmcnt(0)
s_barrier
v_mfma_f32_16x16x32_bf16 v[128:131], v[88:91], v[72:75], v[128:131]
ds_read_b128 v[32:35], v10 offset:0
v_mfma_f32_16x16x32_bf16 v[152:155], v[88:91], v[76:79], v[152:155]
ds_read_b64_tr_b16 v[48:49], v17 offset:0
v_mfma_f32_16x16x32_bf16 v[176:179], v[88:91], v[80:83], v[176:179]
ds_read_b64_tr_b16 v[50:51], v17 offset:3072
v_mfma_f32_16x16x32_bf16 v[200:203], v[88:91], v[84:87], v[200:203]
ds_read_b64_tr_b16 v[52:53], v18 offset:0
v_mfma_f32_16x16x32_bf16 v[204:207], v[92:95], v[84:87], v[204:207]
ds_read_b64_tr_b16 v[54:55], v18 offset:3072
v_mfma_f32_16x16x32_bf16 v[180:183], v[92:95], v[80:83], v[180:183]
ds_read_b64_tr_b16 v[56:57], v19 offset:0
v_mfma_f32_16x16x32_bf16 v[156:159], v[92:95], v[76:79], v[156:159]
ds_read_b64_tr_b16 v[58:59], v19 offset:3072
v_mfma_f32_16x16x32_bf16 v[132:135], v[92:95], v[72:75], v[132:135]
ds_read_b64_tr_b16 v[60:61], v17 offset:12288
v_mfma_f32_16x16x32_bf16 v[136:139], v[96:99], v[72:75], v[136:139]
ds_read_b64_tr_b16 v[62:63], v17 offset:15360
v_mfma_f32_16x16x32_bf16 v[160:163], v[96:99], v[76:79], v[160:163]
ds_read_b64_tr_b16 v[64:65], v18 offset:12288
v_mfma_f32_16x16x32_bf16 v[184:187], v[96:99], v[80:83], v[184:187]
ds_read_b64_tr_b16 v[66:67], v18 offset:15360
v_mfma_f32_16x16x32_bf16 v[208:211], v[96:99], v[84:87], v[208:211]
ds_read_b64_tr_b16 v[68:69], v19 offset:12288
v_mfma_f32_16x16x32_bf16 v[212:215], v[100:103], v[84:87], v[212:215]
ds_read_b64_tr_b16 v[70:71], v19 offset:15360
v_mfma_f32_16x16x32_bf16 v[188:191], v[100:103], v[80:83], v[188:191]
ds_read_b128 v[36:39], v10 offset:1024
v_mfma_f32_16x16x32_bf16 v[164:167], v[100:103], v[76:79], v[164:167]
ds_read_b128 v[40:43], v10 offset:2048
v_mfma_f32_16x16x32_bf16 v[140:143], v[100:103], v[72:75], v[140:143]
ds_read_b128 v[44:47], v10 offset:3072
v_mfma_f32_16x16x32_bf16 v[144:147], v[104:107], v[72:75], v[144:147]
v_mfma_f32_16x16x32_bf16 v[168:171], v[104:107], v[76:79], v[168:171]
v_mfma_f32_16x16x32_bf16 v[192:195], v[104:107], v[80:83], v[192:195]
v_mfma_f32_16x16x32_bf16 v[216:219], v[104:107], v[84:87], v[216:219]
v_mfma_f32_16x16x32_bf16 v[220:223], v[108:111], v[84:87], v[220:223]
v_mfma_f32_16x16x32_bf16 v[196:199], v[108:111], v[80:83], v[196:199]
v_mfma_f32_16x16x32_bf16 v[172:175], v[108:111], v[76:79], v[172:175]
v_mfma_f32_16x16x32_bf16 v[148:151], v[108:111], v[72:75], v[148:151]
s_waitcnt lgkmcnt(0)
v_mfma_f32_16x16x32_bf16 v[128:131], v[48:51], v[32:35], v[128:131]
ds_read_b128 v[72:75], v10 offset:8192
v_mfma_f32_16x16x32_bf16 v[152:155], v[48:51], v[36:39], v[152:155]
ds_read_b64_tr_b16 v[88:89], v17 offset:6144
v_mfma_f32_16x16x32_bf16 v[176:179], v[48:51], v[40:43], v[176:179]
ds_read_b64_tr_b16 v[90:91], v17 offset:9216
v_mfma_f32_16x16x32_bf16 v[200:203], v[48:51], v[44:47], v[200:203]
ds_read_b64_tr_b16 v[92:93], v18 offset:6144
v_mfma_f32_16x16x32_bf16 v[204:207], v[52:55], v[44:47], v[204:207]
ds_read_b64_tr_b16 v[94:95], v18 offset:9216
v_mfma_f32_16x16x32_bf16 v[180:183], v[52:55], v[40:43], v[180:183]
ds_read_b64_tr_b16 v[96:97], v19 offset:6144
v_mfma_f32_16x16x32_bf16 v[156:159], v[52:55], v[36:39], v[156:159]
ds_read_b64_tr_b16 v[98:99], v19 offset:9216
v_mfma_f32_16x16x32_bf16 v[132:135], v[52:55], v[32:35], v[132:135]
ds_read_b64_tr_b16 v[100:101], v17 offset:18432
v_mfma_f32_16x16x32_bf16 v[136:139], v[56:59], v[32:35], v[136:139]
ds_read_b64_tr_b16 v[102:103], v17 offset:21504
v_mfma_f32_16x16x32_bf16 v[160:163], v[56:59], v[36:39], v[160:163]
ds_read_b64_tr_b16 v[104:105], v18 offset:18432
v_mfma_f32_16x16x32_bf16 v[184:187], v[56:59], v[40:43], v[184:187]
ds_read_b64_tr_b16 v[106:107], v18 offset:21504
v_mfma_f32_16x16x32_bf16 v[208:211], v[56:59], v[44:47], v[208:211]
ds_read_b64_tr_b16 v[108:109], v19 offset:18432
v_mfma_f32_16x16x32_bf16 v[212:215], v[60:63], v[44:47], v[212:215]
ds_read_b64_tr_b16 v[110:111], v19 offset:21504
v_mfma_f32_16x16x32_bf16 v[188:191], v[60:63], v[40:43], v[188:191]
ds_read_b128 v[76:79], v10 offset:9216
v_mfma_f32_16x16x32_bf16 v[164:167], v[60:63], v[36:39], v[164:167]
ds_read_b128 v[80:83], v10 offset:10240
v_mfma_f32_16x16x32_bf16 v[140:143], v[60:63], v[32:35], v[140:143]
ds_read_b128 v[84:87], v10 offset:11264
v_mfma_f32_16x16x32_bf16 v[144:147], v[64:67], v[32:35], v[144:147]
v_mfma_f32_16x16x32_bf16 v[168:171], v[64:67], v[36:39], v[168:171]
v_mfma_f32_16x16x32_bf16 v[192:195], v[64:67], v[40:43], v[192:195]
v_mfma_f32_16x16x32_bf16 v[216:219], v[64:67], v[44:47], v[216:219]
v_mfma_f32_16x16x32_bf16 v[220:223], v[68:71], v[44:47], v[220:223]
v_mfma_f32_16x16x32_bf16 v[196:199], v[68:71], v[40:43], v[196:199]
v_mfma_f32_16x16x32_bf16 v[172:175], v[68:71], v[36:39], v[172:175]
v_mfma_f32_16x16x32_bf16 v[148:151], v[68:71], v[32:35], v[148:151]
s_waitcnt lgkmcnt(0)
s_barrier
v_mfma_f32_16x16x32_bf16 v[128:131], v[88:91], v[72:75], v[128:131]
ds_read_b128 v[32:35], v9 offset:0
v_mfma_f32_16x16x32_bf16 v[152:155], v[88:91], v[76:79], v[152:155]
ds_read_b64_tr_b16 v[48:49], v11 offset:0
v_mfma_f32_16x16x32_bf16 v[176:179], v[88:91], v[80:83], v[176:179]
ds_read_b64_tr_b16 v[50:51], v11 offset:3072
v_mfma_f32_16x16x32_bf16 v[200:203], v[88:91], v[84:87], v[200:203]
ds_read_b64_tr_b16 v[52:53], v12 offset:0
v_mfma_f32_16x16x32_bf16 v[204:207], v[92:95], v[84:87], v[204:207]
ds_read_b64_tr_b16 v[54:55], v12 offset:3072
v_mfma_f32_16x16x32_bf16 v[180:183], v[92:95], v[80:83], v[180:183]
ds_read_b64_tr_b16 v[56:57], v13 offset:0
v_mfma_f32_16x16x32_bf16 v[156:159], v[92:95], v[76:79], v[156:159]
ds_read_b64_tr_b16 v[58:59], v13 offset:3072
v_mfma_f32_16x16x32_bf16 v[132:135], v[92:95], v[72:75], v[132:135]
ds_read_b64_tr_b16 v[60:61], v11 offset:12288
v_mfma_f32_16x16x32_bf16 v[136:139], v[96:99], v[72:75], v[136:139]
ds_read_b64_tr_b16 v[62:63], v11 offset:15360
v_mfma_f32_16x16x32_bf16 v[160:163], v[96:99], v[76:79], v[160:163]
ds_read_b64_tr_b16 v[64:65], v12 offset:12288
v_mfma_f32_16x16x32_bf16 v[184:187], v[96:99], v[80:83], v[184:187]
ds_read_b64_tr_b16 v[66:67], v12 offset:15360
v_mfma_f32_16x16x32_bf16 v[208:211], v[96:99], v[84:87], v[208:211]
ds_read_b64_tr_b16 v[68:69], v13 offset:12288
v_mfma_f32_16x16x32_bf16 v[212:215], v[100:103], v[84:87], v[212:215]
ds_read_b64_tr_b16 v[70:71], v13 offset:15360
v_mfma_f32_16x16x32_bf16 v[188:191], v[100:103], v[80:83], v[188:191]
ds_read_b128 v[36:39], v9 offset:1024
v_mfma_f32_16x16x32_bf16 v[164:167], v[100:103], v[76:79], v[164:167]
ds_read_b128 v[40:43], v9 offset:2048
v_mfma_f32_16x16x32_bf16 v[140:143], v[100:103], v[72:75], v[140:143]
ds_read_b128 v[44:47], v9 offset:3072
v_mfma_f32_16x16x32_bf16 v[144:147], v[104:107], v[72:75], v[144:147]
v_mfma_f32_16x16x32_bf16 v[168:171], v[104:107], v[76:79], v[168:171]
v_mfma_f32_16x16x32_bf16 v[192:195], v[104:107], v[80:83], v[192:195]
v_mfma_f32_16x16x32_bf16 v[216:219], v[104:107], v[84:87], v[216:219]
v_mfma_f32_16x16x32_bf16 v[220:223], v[108:111], v[84:87], v[220:223]
v_mfma_f32_16x16x32_bf16 v[196:199], v[108:111], v[80:83], v[196:199]
v_mfma_f32_16x16x32_bf16 v[172:175], v[108:111], v[76:79], v[172:175]
v_mfma_f32_16x16x32_bf16 v[148:151], v[108:111], v[72:75], v[148:151]
s_waitcnt lgkmcnt(0)
v_mfma_f32_16x16x32_bf16 v[128:131], v[48:51], v[32:35], v[128:131]
ds_read_b128 v[72:75], v9 offset:8192
v_mfma_f32_16x16x32_bf16 v[152:155], v[48:51], v[36:39], v[152:155]
ds_read_b64_tr_b16 v[88:89], v11 offset:6144
v_mfma_f32_16x16x32_bf16 v[176:179], v[48:51], v[40:43], v[176:179]
ds_read_b64_tr_b16 v[90:91], v11 offset:9216
v_mfma_f32_16x16x32_bf16 v[200:203], v[48:51], v[44:47], v[200:203]
ds_read_b64_tr_b16 v[92:93], v12 offset:6144
v_mfma_f32_16x16x32_bf16 v[204:207], v[52:55], v[44:47], v[204:207]
ds_read_b64_tr_b16 v[94:95], v12 offset:9216
v_mfma_f32_16x16x32_bf16 v[180:183], v[52:55], v[40:43], v[180:183]
ds_read_b64_tr_b16 v[96:97], v13 offset:6144
v_mfma_f32_16x16x32_bf16 v[156:159], v[52:55], v[36:39], v[156:159]
ds_read_b64_tr_b16 v[98:99], v13 offset:9216
v_mfma_f32_16x16x32_bf16 v[132:135], v[52:55], v[32:35], v[132:135]
ds_read_b64_tr_b16 v[100:101], v11 offset:18432
v_mfma_f32_16x16x32_bf16 v[136:139], v[56:59], v[32:35], v[136:139]
ds_read_b64_tr_b16 v[102:103], v11 offset:21504
v_mfma_f32_16x16x32_bf16 v[160:163], v[56:59], v[36:39], v[160:163]
ds_read_b64_tr_b16 v[104:105], v12 offset:18432
v_mfma_f32_16x16x32_bf16 v[184:187], v[56:59], v[40:43], v[184:187]
ds_read_b64_tr_b16 v[106:107], v12 offset:21504
v_mfma_f32_16x16x32_bf16 v[208:211], v[56:59], v[44:47], v[208:211]
ds_read_b64_tr_b16 v[108:109], v13 offset:18432
v_mfma_f32_16x16x32_bf16 v[212:215], v[60:63], v[44:47], v[212:215]
ds_read_b64_tr_b16 v[110:111], v13 offset:21504
v_mfma_f32_16x16x32_bf16 v[188:191], v[60:63], v[40:43], v[188:191]
ds_read_b128 v[76:79], v9 offset:9216
v_mfma_f32_16x16x32_bf16 v[164:167], v[60:63], v[36:39], v[164:167]
ds_read_b128 v[80:83], v9 offset:10240
v_mfma_f32_16x16x32_bf16 v[140:143], v[60:63], v[32:35], v[140:143]
ds_read_b128 v[84:87], v9 offset:11264
v_mfma_f32_16x16x32_bf16 v[144:147], v[64:67], v[32:35], v[144:147]
v_mfma_f32_16x16x32_bf16 v[168:171], v[64:67], v[36:39], v[168:171]
v_mfma_f32_16x16x32_bf16 v[192:195], v[64:67], v[40:43], v[192:195]
v_mfma_f32_16x16x32_bf16 v[216:219], v[64:67], v[44:47], v[216:219]
v_mfma_f32_16x16x32_bf16 v[220:223], v[68:71], v[44:47], v[220:223]
v_mfma_f32_16x16x32_bf16 v[196:199], v[68:71], v[40:43], v[196:199]
v_mfma_f32_16x16x32_bf16 v[172:175], v[68:71], v[36:39], v[172:175]
v_mfma_f32_16x16x32_bf16 v[148:151], v[68:71], v[32:35], v[148:151]
s_waitcnt lgkmcnt(0)
s_barrier
v_mfma_f32_16x16x32_bf16 v[128:131], v[88:91], v[72:75], v[128:131]
ds_read_b128 v[32:35], v9 offset:49152
v_mfma_f32_16x16x32_bf16 v[152:155], v[88:91], v[76:79], v[152:155]
ds_read_b64_tr_b16 v[48:49], v14 offset:0
v_mfma_f32_16x16x32_bf16 v[176:179], v[88:91], v[80:83], v[176:179]
ds_read_b64_tr_b16 v[50:51], v14 offset:3072
v_mfma_f32_16x16x32_bf16 v[200:203], v[88:91], v[84:87], v[200:203]
ds_read_b64_tr_b16 v[52:53], v15 offset:0
v_mfma_f32_16x16x32_bf16 v[204:207], v[92:95], v[84:87], v[204:207]
ds_read_b64_tr_b16 v[54:55], v15 offset:3072
v_mfma_f32_16x16x32_bf16 v[180:183], v[92:95], v[80:83], v[180:183]
ds_read_b64_tr_b16 v[56:57], v16 offset:0
v_mfma_f32_16x16x32_bf16 v[156:159], v[92:95], v[76:79], v[156:159]
ds_read_b64_tr_b16 v[58:59], v16 offset:3072
v_mfma_f32_16x16x32_bf16 v[132:135], v[92:95], v[72:75], v[132:135]
ds_read_b64_tr_b16 v[60:61], v14 offset:12288
v_mfma_f32_16x16x32_bf16 v[136:139], v[96:99], v[72:75], v[136:139]
ds_read_b64_tr_b16 v[62:63], v14 offset:15360
v_mfma_f32_16x16x32_bf16 v[160:163], v[96:99], v[76:79], v[160:163]
ds_read_b64_tr_b16 v[64:65], v15 offset:12288
v_mfma_f32_16x16x32_bf16 v[184:187], v[96:99], v[80:83], v[184:187]
ds_read_b64_tr_b16 v[66:67], v15 offset:15360
v_mfma_f32_16x16x32_bf16 v[208:211], v[96:99], v[84:87], v[208:211]
ds_read_b64_tr_b16 v[68:69], v16 offset:12288
v_mfma_f32_16x16x32_bf16 v[212:215], v[100:103], v[84:87], v[212:215]
ds_read_b64_tr_b16 v[70:71], v16 offset:15360
v_mfma_f32_16x16x32_bf16 v[188:191], v[100:103], v[80:83], v[188:191]
ds_read_b128 v[36:39], v9 offset:50176
v_mfma_f32_16x16x32_bf16 v[164:167], v[100:103], v[76:79], v[164:167]
ds_read_b128 v[40:43], v9 offset:51200
v_mfma_f32_16x16x32_bf16 v[140:143], v[100:103], v[72:75], v[140:143]
ds_read_b128 v[44:47], v9 offset:52224
v_mfma_f32_16x16x32_bf16 v[144:147], v[104:107], v[72:75], v[144:147]
v_mfma_f32_16x16x32_bf16 v[168:171], v[104:107], v[76:79], v[168:171]
v_mfma_f32_16x16x32_bf16 v[192:195], v[104:107], v[80:83], v[192:195]
s_branch Lov_8
.p2align 12
.fill 64, 4, 0xbf800000
Lst_8_0:
s_branch Lwr_168
Lst_8_1:
s_branch Lwr_179
s_nop 0
Lov_8:
v_mfma_f32_16x16x32_bf16 v[216:219], v[104:107], v[84:87], v[216:219]
v_mfma_f32_16x16x32_bf16 v[220:223], v[108:111], v[84:87], v[220:223]
v_mfma_f32_16x16x32_bf16 v[196:199], v[108:111], v[80:83], v[196:199]
v_mfma_f32_16x16x32_bf16 v[172:175], v[108:111], v[76:79], v[172:175]
v_mfma_f32_16x16x32_bf16 v[148:151], v[108:111], v[72:75], v[148:151]
s_sub_u32 s41, s41, 1
s_cmp_lg_u32 s41, 0
s_cbranch_scc1 Lk3l_123
s_waitcnt lgkmcnt(0)
s_add_u32 s38, s35, 15
s_and_b32 s38, s38, 15
s_mul_i32 s38, s38, 458752
s_add_u32 m0, s40, 0
s_nop 0
buffer_load_dwordx4 v4, s[12:15], s38 offen lds
v_lshrrev_b32 v86, 4, v1
s_lshl_b32 s43, s63, 7
s_add_u32 s43, s43, 148992
v_lshl_add_u32 v87, v86, 4, s43
v_lshrrev_b32 v88, 1, v86
v_and_b32 v86, 1, v86
s_add_u32 m0, s40, 1024
s_nop 0
buffer_load_dwordx4 v5, s[12:15], s38 offen lds
s_lshl_b32 s43, s63, 5
s_add_u32 s43, s43, 149248
v_lshl_add_u32 v88, v88, 6, s43
v_lshl_add_u32 v88, v86, 4, v88
v_and_b32 v86, 15, v1
s_lshl_b32 s43, s62, 9
s_add_u32 m0, s40, 2048
s_add_u32 s38, s38, 57344
buffer_load_dwordx4 v4, s[12:15], s38 offen lds
s_add_u32 s43, s43, 147456
v_lshl_add_u32 v86, v86, 3, s43
ds_read_b128 v[32:35], v87 offset:0
ds_read_b128 v[36:39], v87 offset:64
ds_read_b128 v[40:43], v88 offset:0
ds_read_b128 v[44:47], v87 offset:896
s_add_u32 m0, s40, 3072
s_nop 0
buffer_load_dwordx4 v5, s[12:15], s38 offen lds
ds_read_b128 v[48:51], v87 offset:960
ds_read_b128 v[52:55], v88 offset:896
ds_read_b64 v[56:57], v86 offset:0
ds_read_b64 v[58:59], v86 offset:128
ds_read_b64 v[60:61], v86 offset:256
ds_read_b64 v[62:63], v86 offset:384
s_add_u32 m0, s40, 4096
s_add_u32 s38, s38, 57344
buffer_load_dwordx4 v4, s[12:15], s38 offen lds
s_mul_i32 s54, s35, 24576
s_lshl_b32 s43, s62, 12
s_add_u32 s54, s54, s43
s_add_u32 s54, s54, 524288
s_lshl_b32 s43, s63, 9
s_add_u32 s55, s54, s43
s_add_u32 m0, s40, 5120
s_nop 0
buffer_load_dwordx4 v5, s[12:15], s38 offen lds
s_add_u32 s55, s55, 16384
s_lshl_b32 s43, s63, 13
s_add_u32 s54, s54, s43
v_and_b32 v84, 32, v1
v_lshlrev_b32 v84, 4, v84
v_add_u32 v84, v84, v2
s_waitcnt lgkmcnt(0)
s_add_u32 m0, s40, 6144
s_add_u32 s38, s38, 57344
buffer_load_dwordx4 v4, s[12:15], s38 offen lds
s_add_u32 m0, s40, 7168
s_nop 0
buffer_load_dwordx4 v5, s[12:15], s38 offen lds
s_and_b32 s44, s36, 3
s_mul_i32 s43, s2, 28672
s_mul_i32 s44, s44, 7168
s_add_u32 s43, s43, s44
s_add_u32 s4, s76, s43
s_addc_u32 s5, s77, 0
s_barrier
s_cmp_eq_u32 s47, 3
s_cbranch_scc0 Lw_124
v_and_b32 v90, 31, v1
v_lshlrev_b32 v90, 4, v90
v_add_u32 v91, 153600, v90
ds_read_b128 v[108:111], v91 offset:0
ds_read_b128 v[112:115], v91 offset:512
ds_read_b128 v[116:119], v91 offset:1024
ds_read_b128 v[120:123], v91 offset:1536
s_and_b32 s44, s2, 15
s_mul_i32 s44, s44, 14336
s_lshr_b32 s43, s2, 4
s_lshl_b32 s43, s43, 9
s_add_u32 s44, s44, s43
s_waitcnt lgkmcnt(0)
v_add_f32 v108, v108, v112
v_add_f32 v116, v116, v120
v_add_f32 v109, v109, v113
v_add_f32 v117, v117, v121
v_add_f32 v110, v110, v114
v_add_f32 v118, v118, v122
v_add_f32 v111, v111, v115
v_add_f32 v119, v119, v123
v_add_f32 v108, v108, v116
v_add_f32 v109, v109, v117
v_add_f32 v110, v110, v118
v_add_f32 v111, v111, v119
s_mov_b64 exec, 0xffffffff
buffer_store_dwordx4 v[108:111], v90, s[84:87], s44 offen sc1
s_mov_b64 exec, -1
Lw_124:
s_waitcnt lgkmcnt(0)
s_add_u32 s37, s35, 0
s_and_b32 s37, s37, 15
s_mul_i32 s37, s37, 16384
s_add_u32 m0, s39, 49152
s_nop 0
buffer_load_dwordx4 v3, s[8:11], s37 offen sc1 lds
s_load_dword s3, s[4:5], 1792
s_load_dword s3, s[4:5], 1856
s_load_dword s3, s[4:5], 1920
s_load_dword s3, s[4:5], 1984
s_load_dword s3, s[4:5], 2048
s_load_dword s3, s[4:5], 2112
s_load_dword s3, s[4:5], 2176
buffer_load_dwordx4 v3, s[8:11], s37 offen offset:1024 sc1 lds
s_load_dword s3, s[4:5], 2240
s_load_dword s3, s[4:5], 2304
s_load_dword s3, s[4:5], 2368
s_load_dword s3, s[4:5], 2432
s_load_dword s3, s[4:5], 2496
s_load_dword s3, s[4:5], 2560
s_load_dword s3, s[4:5], 2624
buffer_load_dwordx4 v3, s[8:11], s37 offen offset:2048 sc1 lds
v_mul_f32 v66, v57, v57
v_mul_f32 v64, 0xc0135761, v57
v_mul_f32 v65, 0xbdd2d3e8, v57
v_mul_f32 v65, v65, v66
v_rcp_f32 v66, v66
v_mul_f32 v70, v59, v59
v_mul_f32 v68, 0xc0135761, v59
buffer_load_dwordx4 v3, s[8:11], s37 offen offset:3072 sc1 lds
v_mul_f32 v69, 0xbdd2d3e8, v59
v_mul_f32 v69, v69, v70
v_rcp_f32 v70, v70
v_fma_f32 v128, -v56, v32, v128
v_fma_f32 v129, -v56, v33, v129
v_fma_f32 v130, -v56, v34, v130
v_fma_f32 v131, -v56, v35, v131
v_fma_f32 v152, -v58, v32, v152
s_add_u32 s38, s35, 0
s_and_b32 s38, s38, 15
s_mul_i32 s38, s38, 458752
s_add_u32 m0, s40, 49152
s_nop 0
buffer_load_dwordx4 v4, s[12:15], s38 offen lds
v_fma_f32 v153, -v58, v33, v153
v_fma_f32 v154, -v58, v34, v154
v_fma_f32 v155, -v58, v35, v155
v_mul_f32 v72, v128, v128
v_mul_f32 v73, v129, v129
v_mul_f32 v74, v130, v130
v_mul_f32 v75, v131, v131
s_add_u32 m0, s40, 50176
s_nop 0
buffer_load_dwordx4 v5, s[12:15], s38 offen lds
v_mul_f32 v76, v152, v152
v_mul_f32 v77, v153, v153
v_mul_f32 v78, v154, v154
v_mul_f32 v79, v155, v155
v_fma_f32 v72, v72, v65, v64
v_fma_f32 v73, v73, v65, v64
v_fma_f32 v74, v74, v65, v64
s_add_u32 m0, s40, 51200
s_add_u32 s38, s38, 57344
buffer_load_dwordx4 v4, s[12:15], s38 offen lds
v_fma_f32 v75, v75, v65, v64
v_fma_f32 v76, v76, v69, v68
v_fma_f32 v77, v77, v69, v68
v_fma_f32 v78, v78, v69, v68
v_fma_f32 v79, v79, v69, v68
v_mul_f32 v72, v72, v128
v_mul_f32 v73, v73, v129
v_mul_f32 v74, v74, v130
s_add_u32 m0, s40, 52224
s_nop 0
buffer_load_dwordx4 v5, s[12:15], s38 offen lds
v_mul_f32 v75, v75, v131
v_mul_f32 v76, v76, v152
v_mul_f32 v77, v77, v153
v_mul_f32 v78, v78, v154
v_mul_f32 v79, v79, v155
v_exp_f32 v72, v72
v_exp_f32 v73, v73
s_add_u32 m0, s40, 53248
s_add_u32 s38, s38, 57344
buffer_load_dwordx4 v4, s[12:15], s38 offen lds
v_exp_f32 v74, v74
v_exp_f32 v75, v75
v_exp_f32 v76, v76
v_exp_f32 v77, v77
v_exp_f32 v78, v78
v_exp_f32 v79, v79
v_fma_f32 v140, -v56, v44, v140
s_add_u32 m0, s40, 54272
s_nop 0
buffer_load_dwordx4 v5, s[12:15], s38 offen lds
v_fma_f32 v141, -v56, v45, v141
v_fma_f32 v142, -v56, v46, v142
v_fma_f32 v143, -v56, v47, v143
v_fma_f32 v164, -v58, v44, v164
v_fma_f32 v165, -v58, v45, v165
v_fma_f32 v166, -v58, v46, v166
v_fma_f32 v167, -v58, v47, v167
v_fma_f32 v72, v72, v66, v66
s_add_u32 m0, s40, 55296
s_add_u32 s38, s38, 57344
buffer_load_dwordx4 v4, s[12:15], s38 offen lds
s_add_u32 m0, s40, 56320
s_nop 0
buffer_load_dwordx4 v5, s[12:15], s38 offen lds
s_waitcnt vmcnt(12)
s_barrier
s_add_u32 s37, s35, 1
s_and_b32 s37, s37, 15
s_mul_i32 s37, s37, 16384
s_add_u32 m0, s39, 98304
s_nop 0
buffer_load_dwordx4 v3, s[8:11], s37 offen sc1 lds
v_fma_f32 v73, v73, v66, v66
v_fma_f32 v74, v74, v66, v66
v_fma_f32 v75, v75, v66, v66
v_fma_f32 v76, v76, v70, v70
v_fma_f32 v77, v77, v70, v70
v_fma_f32 v78, v78, v70, v70
buffer_load_dwordx4 v3, s[8:11], s37 offen offset:1024 sc1 lds
v_fma_f32 v79, v79, v70, v70
v_rcp_f32 v72, v72
v_rcp_f32 v73, v73
v_rcp_f32 v74, v74
v_rcp_f32 v75, v75
v_rcp_f32 v76, v76
buffer_load_dwordx4 v3, s[8:11], s37 offen offset:2048 sc1 lds
v_rcp_f32 v77, v77
v_rcp_f32 v78, v78
v_rcp_f32 v79, v79
v_mul_f32 v140, v128, v140
v_mul_f32 v141, v129, v141
v_mul_f32 v142, v130, v142
buffer_load_dwordx4 v3, s[8:11], s37 offen offset:3072 sc1 lds
v_mul_f32 v143, v131, v143
v_mul_f32 v164, v152, v164
v_mul_f32 v165, v153, v165
v_mul_f32 v166, v154, v166
v_mul_f32 v167, v155, v167
v_mul_f32 v140, v140, v72
s_add_u32 s38, s35, 1
s_and_b32 s38, s38, 15
s_mul_i32 s38, s38, 458752
s_add_u32 m0, s40, 98304
s_nop 0
buffer_load_dwordx4 v4, s[12:15], s38 offen lds
v_mul_f32 v141, v141, v73
v_mul_f32 v142, v142, v74
v_mul_f32 v143, v143, v75
v_mul_f32 v164, v164, v76
v_mul_f32 v165, v165, v77
v_mul_f32 v166, v166, v78
s_add_u32 m0, s40, 99328
s_nop 0
buffer_load_dwordx4 v5, s[12:15], s38 offen lds
v_mul_f32 v167, v167, v79
v_cvt_pk_bf16_f32 v128, v140, v141
v_cvt_pk_bf16_f32 v129, v142, v143
v_cvt_pk_bf16_f32 v152, v164, v165
v_cvt_pk_bf16_f32 v153, v166, v167
v_fma_f32 v132, -v56, v36, v132
s_add_u32 m0, s40, 100352
s_add_u32 s38, s38, 57344
buffer_load_dwordx4 v4, s[12:15], s38 offen lds
v_fma_f32 v133, -v56, v37, v133
v_fma_f32 v134, -v56, v38, v134
v_fma_f32 v135, -v56, v39, v135
v_fma_f32 v156, -v58, v36, v156
v_fma_f32 v157, -v58, v37, v157
v_fma_f32 v158, -v58, v38, v158
s_add_u32 m0, s40, 101376
s_nop 0
buffer_load_dwordx4 v5, s[12:15], s38 offen lds
v_fma_f32 v159, -v58, v39, v159
v_mul_f32 v72, v132, v132
v_mul_f32 v73, v133, v133
v_mul_f32 v74, v134, v134
v_mul_f32 v75, v135, v135
v_mul_f32 v76, v156, v156
s_add_u32 m0, s40, 102400
s_add_u32 s38, s38, 57344
buffer_load_dwordx4 v4, s[12:15], s38 offen lds
v_mul_f32 v77, v157, v157
v_mul_f32 v78, v158, v158
v_mul_f32 v79, v159, v159
v_fma_f32 v72, v72, v65, v64
v_fma_f32 v73, v73, v65, v64
v_fma_f32 v74, v74, v65, v64
s_add_u32 m0, s40, 103424
s_nop 0
buffer_load_dwordx4 v5, s[12:15], s38 offen lds
v_fma_f32 v75, v75, v65, v64
v_fma_f32 v76, v76, v69, v68
v_fma_f32 v77, v77, v69, v68
v_fma_f32 v78, v78, v69, v68
v_fma_f32 v79, v79, v69, v68
v_mul_f32 v72, v72, v132
s_add_u32 m0, s40, 104448
s_add_u32 s38, s38, 57344
buffer_load_dwordx4 v4, s[12:15], s38 offen lds
s_add_u32 m0, s40, 105472
s_nop 0
buffer_load_dwordx4 v5, s[12:15], s38 offen lds
s_waitcnt vmcnt(12)
s_barrier
s_cmp_eq_u32 s47, 3
s_cbranch_scc0 Lw_125
s_lshr_b32 s43, s2, 4
s_add_u32 s43, s43, 80
s_lshl_b32 s43, s43, 7
v_mov_b32 v90, s43
v_mov_b32 v91, 1
s_mov_b64 exec, 1
buffer_atomic_add v91, v90, s[56:59], 0 offen sc1
s_mov_b64 exec, -1
Lw_125:
s_waitcnt lgkmcnt(0)
s_add_u32 s37, s35, 2
s_and_b32 s37, s37, 15
s_mul_i32 s37, s37, 16384
s_add_u32 m0, s39, 0
s_nop 0
buffer_load_dwordx4 v3, s[8:11], s37 offen sc1 lds
s_load_dword s3, s[4:5], 2688
s_load_dword s3, s[4:5], 2752
s_load_dword s3, s[4:5], 2816
s_load_dword s3, s[4:5], 2880
s_load_dword s3, s[4:5], 2944
s_load_dword s3, s[4:5], 3008
s_load_dword s3, s[4:5], 3072
buffer_load_dwordx4 v3, s[8:11], s37 offen offset:1024 sc1 lds
s_load_dword s3, s[4:5], 3136
s_load_dword s3, s[4:5], 3200
s_load_dword s3, s[4:5], 3264
s_load_dword s3, s[4:5], 3328
s_load_dword s3, s[4:5], 3392
s_load_dword s3, s[4:5], 3456
s_load_dword s3, s[4:5], 3520
buffer_load_dwordx4 v3, s[8:11], s37 offen offset:2048 sc1 lds
v_mul_f32 v73, v73, v133
v_mul_f32 v74, v74, v134
v_mul_f32 v75, v75, v135
v_mul_f32 v76, v76, v156
v_mul_f32 v77, v77, v157
v_mul_f32 v78, v78, v158
v_mul_f32 v79, v79, v159
v_exp_f32 v72, v72
buffer_load_dwordx4 v3, s[8:11], s37 offen offset:3072 sc1 lds
v_exp_f32 v73, v73
v_exp_f32 v74, v74
v_exp_f32 v75, v75
v_exp_f32 v76, v76
v_exp_f32 v77, v77
v_exp_f32 v78, v78
v_exp_f32 v79, v79
s_add_u32 s38, s35, 2
s_and_b32 s38, s38, 15
s_mul_i32 s38, s38, 458752
s_add_u32 m0, s40, 0
s_nop 0
buffer_load_dwordx4 v4, s[12:15], s38 offen lds
v_fma_f32 v144, -v56, v48, v144
v_fma_f32 v145, -v56, v49, v145
v_fma_f32 v146, -v56, v50, v146
v_fma_f32 v147, -v56, v51, v147
v_fma_f32 v168, -v58, v48, v168
v_fma_f32 v169, -v58, v49, v169
v_fma_f32 v170, -v58, v50, v170
v_fma_f32 v171, -v58, v51, v171
s_add_u32 m0, s40, 1024
s_nop 0
buffer_load_dwordx4 v5, s[12:15], s38 offen lds
v_fma_f32 v72, v72, v66, v66
v_fma_f32 v73, v73, v66, v66
v_fma_f32 v74, v74, v66, v66
v_fma_f32 v75, v75, v66, v66
v_fma_f32 v76, v76, v70, v70
v_fma_f32 v77, v77, v70, v70
v_fma_f32 v78, v78, v70, v70
s_add_u32 m0, s40, 2048
s_add_u32 s38, s38, 57344
buffer_load_dwordx4 v4, s[12:15], s38 offen lds
v_fma_f32 v79, v79, v70, v70
v_rcp_f32 v72, v72
v_rcp_f32 v73, v73
v_rcp_f32 v74, v74
v_rcp_f32 v75, v75
v_rcp_f32 v76, v76
v_rcp_f32 v77, v77
s_add_u32 m0, s40, 3072
s_nop 0
buffer_load_dwordx4 v5, s[12:15], s38 offen lds
v_rcp_f32 v78, v78
v_rcp_f32 v79, v79
v_mul_f32 v144, v132, v144
v_mul_f32 v145, v133, v145
v_mul_f32 v146, v134, v146
v_mul_f32 v147, v135, v147
v_mul_f32 v168, v156, v168
v_mul_f32 v169, v157, v169
s_add_u32 m0, s40, 4096
s_add_u32 s38, s38, 57344
buffer_load_dwordx4 v4, s[12:15], s38 offen lds
v_mul_f32 v170, v158, v170
v_mul_f32 v171, v159, v171
v_mul_f32 v144, v144, v72
v_mul_f32 v145, v145, v73
v_mul_f32 v146, v146, v74
v_mul_f32 v147, v147, v75
v_mul_f32 v168, v168, v76
s_add_u32 m0, s40, 5120
s_nop 0
buffer_load_dwordx4 v5, s[12:15], s38 offen lds
v_mul_f32 v169, v169, v77
v_mul_f32 v170, v170, v78
v_mul_f32 v171, v171, v79
v_cvt_pk_bf16_f32 v130, v144, v145
v_cvt_pk_bf16_f32 v131, v146, v147
v_cvt_pk_bf16_f32 v154, v168, v169
v_cvt_pk_bf16_f32 v155, v170, v171
buffer_store_dwordx4 v[128:131], v2, s[24:27], s54 offen offset:0 sc1
s_add_u32 m0, s40, 6144
s_add_u32 s38, s38, 57344
buffer_load_dwordx4 v4, s[12:15], s38 offen lds
s_add_u32 m0, s40, 7168
s_nop 0
buffer_load_dwordx4 v5, s[12:15], s38 offen lds
s_waitcnt vmcnt(13)
s_barrier
s_add_u32 s37, s35, 3
s_and_b32 s37, s37, 15
s_mul_i32 s37, s37, 16384
s_add_u32 m0, s39, 49152
s_nop 0
buffer_load_dwordx4 v3, s[8:11], s37 offen sc1 lds
buffer_store_dwordx4 v[152:155], v2, s[24:27], s54 offen offset:1024 sc1
v_fma_f32 v136, -v56, v40, v136
v_fma_f32 v137, -v56, v41, v137
v_fma_f32 v138, -v56, v42, v138
v_fma_f32 v139, -v56, v43, v139
v_fma_f32 v160, -v58, v40, v160
buffer_load_dwordx4 v3, s[8:11], s37 offen offset:1024 sc1 lds
v_fma_f32 v161, -v58, v41, v161
v_fma_f32 v162, -v58, v42, v162
v_fma_f32 v163, -v58, v43, v163
v_mul_f32 v72, v136, v136
v_mul_f32 v73, v137, v137
v_mul_f32 v74, v138, v138
buffer_load_dwordx4 v3, s[8:11], s37 offen offset:2048 sc1 lds
v_mul_f32 v75, v139, v139
v_mul_f32 v76, v160, v160
v_mul_f32 v77, v161, v161
v_mul_f32 v78, v162, v162
v_mul_f32 v79, v163, v163
v_fma_f32 v72, v72, v65, v64
buffer_load_dwordx4 v3, s[8:11], s37 offen offset:3072 sc1 lds
v_fma_f32 v73, v73, v65, v64
v_fma_f32 v74, v74, v65, v64
v_fma_f32 v75, v75, v65, v64
v_fma_f32 v76, v76, v69, v68
v_fma_f32 v77, v77, v69, v68
v_fma_f32 v78, v78, v69, v68
s_add_u32 s38, s35, 3
s_and_b32 s38, s38, 15
s_mul_i32 s38, s38, 458752
s_add_u32 m0, s40, 49152
s_nop 0
buffer_load_dwordx4 v4, s[12:15], s38 offen lds
v_fma_f32 v79, v79, v69, v68
v_mul_f32 v72, v72, v136
v_mul_f32 v73, v73, v137
v_mul_f32 v74, v74, v138
v_mul_f32 v75, v75, v139
v_mul_f32 v76, v76, v160
s_add_u32 m0, s40, 50176
s_nop 0
buffer_load_dwordx4 v5, s[12:15], s38 offen lds
v_mul_f32 v77, v77, v161
v_mul_f32 v78, v78, v162
v_mul_f32 v79, v79, v163
v_exp_f32 v72, v72
v_exp_f32 v73, v73
v_exp_f32 v74, v74
s_add_u32 m0, s40, 51200
s_add_u32 s38, s38, 57344
buffer_load_dwordx4 v4, s[12:15], s38 offen lds
v_exp_f32 v75, v75
v_exp_f32 v76, v76
v_exp_f32 v77, v77
v_exp_f32 v78, v78
v_exp_f32 v79, v79
v_fma_f32 v148, -v56, v52, v148
s_add_u32 m0, s40, 52224
s_nop 0
buffer_load_dwordx4 v5, s[12:15], s38 offen lds
v_fma_f32 v149, -v56, v53, v149
v_fma_f32 v150, -v56, v54, v150
v_fma_f32 v151, -v56, v55, v151
v_fma_f32 v172, -v58, v52, v172
v_fma_f32 v173, -v58, v53, v173
v_fma_f32 v174, -v58, v54, v174
s_add_u32 m0, s40, 53248
s_add_u32 s38, s38, 57344
buffer_load_dwordx4 v4, s[12:15], s38 offen lds
v_fma_f32 v175, -v58, v55, v175
v_fma_f32 v72, v72, v66, v66
v_fma_f32 v73, v73, v66, v66
v_fma_f32 v74, v74, v66, v66
v_fma_f32 v75, v75, v66, v66
v_fma_f32 v76, v76, v70, v70
s_add_u32 m0, s40, 54272
s_nop 0
buffer_load_dwordx4 v5, s[12:15], s38 offen lds
v_fma_f32 v77, v77, v70, v70
v_fma_f32 v78, v78, v70, v70
v_fma_f32 v79, v79, v70, v70
v_rcp_f32 v72, v72
v_rcp_f32 v73, v73
v_rcp_f32 v74, v74
s_add_u32 m0, s40, 55296
s_add_u32 s38, s38, 57344
buffer_load_dwordx4 v4, s[12:15], s38 offen lds
s_add_u32 m0, s40, 56320
s_nop 0
buffer_load_dwordx4 v5, s[12:15], s38 offen lds
s_waitcnt vmcnt(13)
s_barrier
s_waitcnt lgkmcnt(0)
s_add_u32 s37, s35, 4
s_and_b32 s37, s37, 15
s_mul_i32 s37, s37, 16384
s_add_u32 m0, s39, 98304
s_nop 0
buffer_load_dwordx4 v3, s[8:11], s37 offen sc1 lds
s_load_dword s3, s[4:5], 3584
s_load_dword s3, s[4:5], 3648
s_load_dword s3, s[4:5], 3712
s_load_dword s3, s[4:5], 3776
s_load_dword s3, s[4:5], 3840
s_load_dword s3, s[4:5], 3904
s_load_dword s3, s[4:5], 3968
buffer_load_dwordx4 v3, s[8:11], s37 offen offset:1024 sc1 lds
s_load_dword s3, s[4:5], 4032
s_load_dword s3, s[4:5], 4096
s_load_dword s3, s[4:5], 4160
s_load_dword s3, s[4:5], 4224
s_load_dword s3, s[4:5], 4288
s_load_dword s3, s[4:5], 4352
s_load_dword s3, s[4:5], 4416
buffer_load_dwordx4 v3, s[8:11], s37 offen offset:2048 sc1 lds
v_rcp_f32 v75, v75
v_rcp_f32 v76, v76
v_rcp_f32 v77, v77
v_rcp_f32 v78, v78
v_rcp_f32 v79, v79
v_mul_f32 v148, v136, v148
v_mul_f32 v149, v137, v149
buffer_load_dwordx4 v3, s[8:11], s37 offen offset:3072 sc1 lds
v_mul_f32 v150, v138, v150
v_mul_f32 v151, v139, v151
v_mul_f32 v172, v160, v172
v_mul_f32 v173, v161, v173
v_mul_f32 v174, v162, v174
v_mul_f32 v175, v163, v175
v_mul_f32 v148, v148, v72
v_mul_f32 v149, v149, v73
s_add_u32 s38, s35, 4
s_and_b32 s38, s38, 15
s_mul_i32 s38, s38, 458752
s_add_u32 m0, s40, 98304
s_nop 0
buffer_load_dwordx4 v4, s[12:15], s38 offen lds
v_mul_f32 v150, v150, v74
v_mul_f32 v151, v151, v75
v_mul_f32 v172, v172, v76
v_mul_f32 v173, v173, v77
v_mul_f32 v174, v174, v78
v_mul_f32 v175, v175, v79
v_cvt_pk_bf16_f32 v80, v148, v149
s_add_u32 m0, s40, 99328
s_nop 0
buffer_load_dwordx4 v5, s[12:15], s38 offen lds
v_cvt_pk_bf16_f32 v81, v150, v151
v_cvt_pk_bf16_f32 v82, v172, v173
v_cvt_pk_bf16_f32 v83, v174, v175
s_nop 1
v_permlane32_swap_b32 v80, v82
v_permlane32_swap_b32 v81, v83
buffer_store_dwordx4 v[80:83], v84, s[24:27], s55 offen offset:0 sc1
s_add_u32 m0, s40, 100352
s_add_u32 s38, s38, 57344
buffer_load_dwordx4 v4, s[12:15], s38 offen lds
s_nop 1
v_mul_f32 v66, v61, v61
v_mul_f32 v64, 0xc0135761, v61
v_mul_f32 v65, 0xbdd2d3e8, v61
v_mul_f32 v65, v65, v66
v_rcp_f32 v66, v66
v_mul_f32 v70, v63, v63
v_mul_f32 v68, 0xc0135761, v63
s_add_u32 m0, s40, 101376
s_nop 0
buffer_load_dwordx4 v5, s[12:15], s38 offen lds
v_mul_f32 v69, 0xbdd2d3e8, v63
v_mul_f32 v69, v69, v70
v_rcp_f32 v70, v70
s_branch Lov_9
.p2align 12
.fill 64, 4, 0xbf800000
Lst_9_0:
s_branch Lwr_169
Lst_9_1:
s_branch Lwr_180
s_nop 0
Lov_9:
v_fma_f32 v176, -v60, v32, v176
v_fma_f32 v177, -v60, v33, v177
v_fma_f32 v178, -v60, v34, v178
v_fma_f32 v179, -v60, v35, v179
s_add_u32 m0, s40, 102400
s_add_u32 s38, s38, 57344
buffer_load_dwordx4 v4, s[12:15], s38 offen lds
v_fma_f32 v200, -v62, v32, v200
v_fma_f32 v201, -v62, v33, v201
v_fma_f32 v202, -v62, v34, v202
v_fma_f32 v203, -v62, v35, v203
v_mul_f32 v72, v176, v176
v_mul_f32 v73, v177, v177
v_mul_f32 v74, v178, v178
s_add_u32 m0, s40, 103424
s_nop 0
buffer_load_dwordx4 v5, s[12:15], s38 offen lds
v_mul_f32 v75, v179, v179
v_mul_f32 v76, v200, v200
v_mul_f32 v77, v201, v201
v_mul_f32 v78, v202, v202
v_mul_f32 v79, v203, v203
v_fma_f32 v72, v72, v65, v64
v_fma_f32 v73, v73, v65, v64
v_fma_f32 v74, v74, v65, v64
s_add_u32 m0, s40, 104448
s_add_u32 s38, s38, 57344
buffer_load_dwordx4 v4, s[12:15], s38 offen lds
s_add_u32 m0, s40, 105472
s_nop 0
buffer_load_dwordx4 v5, s[12:15], s38 offen lds
s_waitcnt vmcnt(13)
s_barrier
s_add_u32 s37, s35, 5
s_and_b32 s37, s37, 15
s_mul_i32 s37, s37, 16384
s_add_u32 m0, s39, 0
s_nop 0
buffer_load_dwordx4 v3, s[8:11], s37 offen sc1 lds
v_fma_f32 v75, v75, v65, v64
v_fma_f32 v76, v76, v69, v68
v_fma_f32 v77, v77, v69, v68
v_fma_f32 v78, v78, v69, v68
v_fma_f32 v79, v79, v69, v68
v_mul_f32 v72, v72, v176
buffer_load_dwordx4 v3, s[8:11], s37 offen offset:1024 sc1 lds
v_mul_f32 v73, v73, v177
v_mul_f32 v74, v74, v178
v_mul_f32 v75, v75, v179
v_mul_f32 v76, v76, v200
v_mul_f32 v77, v77, v201
v_mul_f32 v78, v78, v202
buffer_load_dwordx4 v3, s[8:11], s37 offen offset:2048 sc1 lds
v_mul_f32 v79, v79, v203
v_exp_f32 v72, v72
v_exp_f32 v73, v73
v_exp_f32 v74, v74
v_exp_f32 v75, v75
v_exp_f32 v76, v76
buffer_load_dwordx4 v3, s[8:11], s37 offen offset:3072 sc1 lds
v_exp_f32 v77, v77
v_exp_f32 v78, v78
v_exp_f32 v79, v79
v_fma_f32 v188, -v60, v44, v188
v_fma_f32 v189, -v60, v45, v189
v_fma_f32 v190, -v60, v46, v190
s_add_u32 s38, s35, 5
s_and_b32 s38, s38, 15
s_mul_i32 s38, s38, 458752
s_add_u32 m0, s40, 0
s_nop 0
buffer_load_dwordx4 v4, s[12:15], s38 offen lds
v_fma_f32 v191, -v60, v47, v191
v_fma_f32 v212, -v62, v44, v212
v_fma_f32 v213, -v62, v45, v213
v_fma_f32 v214, -v62, v46, v214
v_fma_f32 v215, -v62, v47, v215
v_fma_f32 v72, v72, v66, v66
s_add_u32 m0, s40, 1024
s_nop 0
buffer_load_dwordx4 v5, s[12:15], s38 offen lds
v_fma_f32 v73, v73, v66, v66
v_fma_f32 v74, v74, v66, v66
v_fma_f32 v75, v75, v66, v66
v_fma_f32 v76, v76, v70, v70
v_fma_f32 v77, v77, v70, v70
v_fma_f32 v78, v78, v70, v70
s_add_u32 m0, s40, 2048
s_add_u32 s38, s38, 57344
buffer_load_dwordx4 v4, s[12:15], s38 offen lds
v_fma_f32 v79, v79, v70, v70
v_rcp_f32 v72, v72
v_rcp_f32 v73, v73
v_rcp_f32 v74, v74
v_rcp_f32 v75, v75
v_rcp_f32 v76, v76
s_add_u32 m0, s40, 3072
s_nop 0
buffer_load_dwordx4 v5, s[12:15], s38 offen lds
v_rcp_f32 v77, v77
v_rcp_f32 v78, v78
v_rcp_f32 v79, v79
v_mul_f32 v188, v176, v188
v_mul_f32 v189, v177, v189
v_mul_f32 v190, v178, v190
s_add_u32 m0, s40, 4096
s_add_u32 s38, s38, 57344
buffer_load_dwordx4 v4, s[12:15], s38 offen lds
v_mul_f32 v191, v179, v191
v_mul_f32 v212, v200, v212
v_mul_f32 v213, v201, v213
v_mul_f32 v214, v202, v214
v_mul_f32 v215, v203, v215
v_mul_f32 v188, v188, v72
s_add_u32 m0, s40, 5120
s_nop 0
buffer_load_dwordx4 v5, s[12:15], s38 offen lds
v_mul_f32 v189, v189, v73
v_mul_f32 v190, v190, v74
v_mul_f32 v191, v191, v75
v_mul_f32 v212, v212, v76
v_mul_f32 v213, v213, v77
v_mul_f32 v214, v214, v78
s_add_u32 m0, s40, 6144
s_add_u32 s38, s38, 57344
buffer_load_dwordx4 v4, s[12:15], s38 offen lds
s_add_u32 m0, s40, 7168
s_nop 0
buffer_load_dwordx4 v5, s[12:15], s38 offen lds
s_waitcnt vmcnt(12)
s_barrier
s_waitcnt lgkmcnt(0)
s_cmp_eq_u32 s47, 3
s_cbranch_scc0 Lw_126
s_lshl_b32 s60, s35, 7
s_add_u32 s60, s60, 28321792
s_mov_b32 s61, s60
s_load_dword s92, s[82:83], s60 glc
s_load_dword s93, s[82:83], s61 glc
Lw_126:
s_add_u32 s37, s35, 6
s_and_b32 s37, s37, 15
s_mul_i32 s37, s37, 16384
s_add_u32 m0, s39, 49152
s_nop 0
buffer_load_dwordx4 v3, s[8:11], s37 offen sc1 lds
s_load_dword s3, s[4:5], 4480
s_load_dword s3, s[4:5], 4544
s_load_dword s3, s[4:5], 4608
s_load_dword s3, s[4:5], 4672
s_load_dword s3, s[4:5], 4736
s_load_dword s3, s[4:5], 4800
s_load_dword s3, s[4:5], 4864
buffer_load_dwordx4 v3, s[8:11], s37 offen offset:1024 sc1 lds
s_load_dword s3, s[4:5], 4928
s_load_dword s3, s[4:5], 4992
s_load_dword s3, s[4:5], 5056
s_load_dword s3, s[4:5], 5120
s_load_dword s3, s[4:5], 5184
s_load_dword s3, s[4:5], 5248
s_load_dword s3, s[4:5], 5312
buffer_load_dwordx4 v3, s[8:11], s37 offen offset:2048 sc1 lds
v_mul_f32 v215, v215, v79
v_cvt_pk_bf16_f32 v176, v188, v189
v_cvt_pk_bf16_f32 v177, v190, v191
v_cvt_pk_bf16_f32 v200, v212, v213
v_cvt_pk_bf16_f32 v201, v214, v215
v_fma_f32 v180, -v60, v36, v180
v_fma_f32 v181, -v60, v37, v181
v_fma_f32 v182, -v60, v38, v182
buffer_load_dwordx4 v3, s[8:11], s37 offen offset:3072 sc1 lds
v_fma_f32 v183, -v60, v39, v183
v_fma_f32 v204, -v62, v36, v204
v_fma_f32 v205, -v62, v37, v205
v_fma_f32 v206, -v62, v38, v206
v_fma_f32 v207, -v62, v39, v207
v_mul_f32 v72, v180, v180
v_mul_f32 v73, v181, v181
s_add_u32 s38, s35, 6
s_and_b32 s38, s38, 15
s_mul_i32 s38, s38, 458752
s_add_u32 m0, s40, 49152
s_nop 0
buffer_load_dwordx4 v4, s[12:15], s38 offen lds
v_mul_f32 v74, v182, v182
v_mul_f32 v75, v183, v183
v_mul_f32 v76, v204, v204
v_mul_f32 v77, v205, v205
v_mul_f32 v78, v206, v206
v_mul_f32 v79, v207, v207
v_fma_f32 v72, v72, v65, v64
v_fma_f32 v73, v73, v65, v64
s_add_u32 m0, s40, 50176
s_nop 0
buffer_load_dwordx4 v5, s[12:15], s38 offen lds
v_fma_f32 v74, v74, v65, v64
v_fma_f32 v75, v75, v65, v64
v_fma_f32 v76, v76, v69, v68
v_fma_f32 v77, v77, v69, v68
v_fma_f32 v78, v78, v69, v68
v_fma_f32 v79, v79, v69, v68
v_mul_f32 v72, v72, v180
s_add_u32 m0, s40, 51200
s_add_u32 s38, s38, 57344
buffer_load_dwordx4 v4, s[12:15], s38 offen lds
v_mul_f32 v73, v73, v181
v_mul_f32 v74, v74, v182
v_mul_f32 v75, v75, v183
v_mul_f32 v76, v76, v204
v_mul_f32 v77, v77, v205
v_mul_f32 v78, v78, v206
v_mul_f32 v79, v79, v207
s_add_u32 m0, s40, 52224
s_nop 0
buffer_load_dwordx4 v5, s[12:15], s38 offen lds
v_exp_f32 v72, v72
v_exp_f32 v73, v73
v_exp_f32 v74, v74
v_exp_f32 v75, v75
v_exp_f32 v76, v76
v_exp_f32 v77, v77
v_exp_f32 v78, v78
v_exp_f32 v79, v79
s_add_u32 m0, s40, 53248
s_add_u32 s38, s38, 57344
buffer_load_dwordx4 v4, s[12:15], s38 offen lds
v_fma_f32 v192, -v60, v48, v192
v_fma_f32 v193, -v60, v49, v193
v_fma_f32 v194, -v60, v50, v194
v_fma_f32 v195, -v60, v51, v195
v_fma_f32 v216, -v62, v48, v216
v_fma_f32 v217, -v62, v49, v217
v_fma_f32 v218, -v62, v50, v218
s_add_u32 m0, s40, 54272
s_nop 0
buffer_load_dwordx4 v5, s[12:15], s38 offen lds
v_fma_f32 v219, -v62, v51, v219
v_fma_f32 v72, v72, v66, v66
v_fma_f32 v73, v73, v66, v66
v_fma_f32 v74, v74, v66, v66
v_fma_f32 v75, v75, v66, v66
v_fma_f32 v76, v76, v70, v70
v_fma_f32 v77, v77, v70, v70
v_fma_f32 v78, v78, v70, v70
s_add_u32 m0, s40, 55296
s_add_u32 s38, s38, 57344
buffer_load_dwordx4 v4, s[12:15], s38 offen lds
s_add_u32 m0, s40, 56320
s_nop 0
buffer_load_dwordx4 v5, s[12:15], s38 offen lds
s_waitcnt vmcnt(12)
s_barrier
s_add_u32 s37, s35, 7
s_and_b32 s37, s37, 15
s_mul_i32 s37, s37, 16384
s_add_u32 m0, s39, 98304
s_nop 0
buffer_load_dwordx4 v3, s[8:11], s37 offen sc1 lds
v_fma_f32 v79, v79, v70, v70
v_rcp_f32 v72, v72
v_rcp_f32 v73, v73
v_rcp_f32 v74, v74
v_rcp_f32 v75, v75
v_rcp_f32 v76, v76
buffer_load_dwordx4 v3, s[8:11], s37 offen offset:1024 sc1 lds
v_rcp_f32 v77, v77
v_rcp_f32 v78, v78
v_rcp_f32 v79, v79
v_mul_f32 v192, v180, v192
v_mul_f32 v193, v181, v193
v_mul_f32 v194, v182, v194
buffer_load_dwordx4 v3, s[8:11], s37 offen offset:2048 sc1 lds
v_mul_f32 v195, v183, v195
v_mul_f32 v216, v204, v216
v_mul_f32 v217, v205, v217
v_mul_f32 v218, v206, v218
v_mul_f32 v219, v207, v219
v_mul_f32 v192, v192, v72
buffer_load_dwordx4 v3, s[8:11], s37 offen offset:3072 sc1 lds
v_mul_f32 v193, v193, v73
v_mul_f32 v194, v194, v74
v_mul_f32 v195, v195, v75
v_mul_f32 v216, v216, v76
v_mul_f32 v217, v217, v77
v_mul_f32 v218, v218, v78
s_add_u32 s38, s35, 7
s_and_b32 s38, s38, 15
s_mul_i32 s38, s38, 458752
s_add_u32 m0, s40, 98304
s_nop 0
buffer_load_dwordx4 v4, s[12:15], s38 offen lds
v_mul_f32 v219, v219, v79
v_cvt_pk_bf16_f32 v178, v192, v193
v_cvt_pk_bf16_f32 v179, v194, v195
v_cvt_pk_bf16_f32 v202, v216, v217
v_cvt_pk_bf16_f32 v203, v218, v219
buffer_store_dwordx4 v[176:179], v2, s[24:27], s54 offen offset:2048 sc1
s_add_u32 m0, s40, 99328
s_nop 0
buffer_load_dwordx4 v5, s[12:15], s38 offen lds
buffer_store_dwordx4 v[200:203], v2, s[24:27], s54 offen offset:3072 sc1
v_fma_f32 v184, -v60, v40, v184
v_fma_f32 v185, -v60, v41, v185
v_fma_f32 v186, -v60, v42, v186
v_fma_f32 v187, -v60, v43, v187
v_fma_f32 v208, -v62, v40, v208
s_add_u32 m0, s40, 100352
s_add_u32 s38, s38, 57344
buffer_load_dwordx4 v4, s[12:15], s38 offen lds
v_fma_f32 v209, -v62, v41, v209
v_fma_f32 v210, -v62, v42, v210
v_fma_f32 v211, -v62, v43, v211
v_mul_f32 v72, v184, v184
v_mul_f32 v73, v185, v185
v_mul_f32 v74, v186, v186
s_add_u32 m0, s40, 101376
s_nop 0
buffer_load_dwordx4 v5, s[12:15], s38 offen lds
v_mul_f32 v75, v187, v187
v_mul_f32 v76, v208, v208
v_mul_f32 v77, v209, v209
v_mul_f32 v78, v210, v210
v_mul_f32 v79, v211, v211
v_fma_f32 v72, v72, v65, v64
s_add_u32 m0, s40, 102400
s_add_u32 s38, s38, 57344
buffer_load_dwordx4 v4, s[12:15], s38 offen lds
v_fma_f32 v73, v73, v65, v64
v_fma_f32 v74, v74, v65, v64
v_fma_f32 v75, v75, v65, v64
v_fma_f32 v76, v76, v69, v68
v_fma_f32 v77, v77, v69, v68
v_fma_f32 v78, v78, v69, v68
s_add_u32 m0, s40, 103424
s_nop 0
buffer_load_dwordx4 v5, s[12:15], s38 offen lds
v_fma_f32 v79, v79, v69, v68
v_mul_f32 v72, v72, v184
v_mul_f32 v73, v73, v185
v_mul_f32 v74, v74, v186
v_mul_f32 v75, v75, v187
v_mul_f32 v76, v76, v208
s_add_u32 m0, s40, 104448
s_add_u32 s38, s38, 57344
buffer_load_dwordx4 v4, s[12:15], s38 offen lds
s_add_u32 m0, s40, 105472
s_nop 0
buffer_load_dwordx4 v5, s[12:15], s38 offen lds
s_waitcnt vmcnt(14)
s_cmp_eq_u32 s47, 3
s_cbranch_scc0 Lw_127
s_mov_b32 s41, 0x40000
Lcp_128:
s_waitcnt lgkmcnt(0)
s_and_b32 s92, s92, s93
s_cmp_eq_u32 s92, 16
s_cbranch_scc1 Lco_129
s_load_dword s92, s[82:83], s60 glc
s_load_dword s93, s[82:83], s61 glc
s_sub_u32 s41, s41, 1
s_cmp_lg_u32 s41, 0
s_cbranch_scc1 Lcp_128
s_waitcnt lgkmcnt(0)
Lco_129:
Lw_127:
s_barrier
s_lshl_b32 s60, s35, 9
s_lshl_b32 s43, s47, 7
s_add_u32 s60, s60, s43
s_add_u32 s61, s60, 14336
s_add_u32 s52, s43, 148480
s_add_u32 s53, s52, 896
v_lshrrev_b32 v104, 3, v1
v_mul_u32_u24 v104, 28672, v104
v_and_b32 v105, 7, v1
v_lshl_add_u32 v104, v105, 4, v104
s_waitcnt lgkmcnt(0)
buffer_load_dwordx4 v[96:99], v104, s[84:87], s60 offen sc1
s_load_dword s3, s[4:5], 5376
s_load_dword s3, s[4:5], 5440
s_load_dword s3, s[4:5], 5504
s_load_dword s3, s[4:5], 5568
s_load_dword s3, s[4:5], 5632
s_load_dword s3, s[4:5], 5696
buffer_load_dwordx4 v[100:103], v104, s[84:87], s61 offen sc1
s_load_dword s3, s[4:5], 5760
s_load_dword s3, s[4:5], 5824
s_load_dword s3, s[4:5], 5888
s_load_dword s3, s[4:5], 5952
s_load_dword s3, s[4:5], 6016
s_load_dword s3, s[4:5], 6080
s_load_dword s3, s[4:5], 6144
s_add_u32 s37, s35, 8
s_and_b32 s37, s37, 15
s_mul_i32 s37, s37, 16384
s_add_u32 m0, s39, 0
s_nop 0
buffer_load_dwordx4 v3, s[8:11], s37 offen sc1 lds
s_load_dword s3, s[4:5], 6208
v_mul_f32 v77, v77, v209
v_mul_f32 v78, v78, v210
v_mul_f32 v79, v79, v211
v_exp_f32 v72, v72
v_exp_f32 v73, v73
v_exp_f32 v74, v74
buffer_load_dwordx4 v3, s[8:11], s37 offen offset:1024 sc1 lds
v_exp_f32 v75, v75
v_exp_f32 v76, v76
v_exp_f32 v77, v77
v_exp_f32 v78, v78
v_exp_f32 v79, v79
v_fma_f32 v196, -v60, v52, v196
v_fma_f32 v197, -v60, v53, v197
buffer_load_dwordx4 v3, s[8:11], s37 offen offset:2048 sc1 lds
v_fma_f32 v198, -v60, v54, v198
v_fma_f32 v199, -v60, v55, v199
v_fma_f32 v220, -v62, v52, v220
v_fma_f32 v221, -v62, v53, v221
v_fma_f32 v222, -v62, v54, v222
v_fma_f32 v223, -v62, v55, v223
buffer_load_dwordx4 v3, s[8:11], s37 offen offset:3072 sc1 lds
v_fma_f32 v72, v72, v66, v66
v_fma_f32 v73, v73, v66, v66
v_fma_f32 v74, v74, v66, v66
v_fma_f32 v75, v75, v66, v66
v_fma_f32 v76, v76, v70, v70
v_fma_f32 v77, v77, v70, v70
v_fma_f32 v78, v78, v70, v70
s_add_u32 s38, s35, 8
s_and_b32 s38, s38, 15
s_mul_i32 s38, s38, 458752
s_add_u32 m0, s40, 0
s_nop 0
buffer_load_dwordx4 v4, s[12:15], s38 offen lds
v_fma_f32 v79, v79, v70, v70
v_rcp_f32 v72, v72
v_rcp_f32 v73, v73
v_rcp_f32 v74, v74
v_rcp_f32 v75, v75
v_rcp_f32 v76, v76
v_rcp_f32 v77, v77
s_add_u32 m0, s40, 1024
s_nop 0
buffer_load_dwordx4 v5, s[12:15], s38 offen lds
v_rcp_f32 v78, v78
v_rcp_f32 v79, v79
v_mul_f32 v196, v184, v196
v_mul_f32 v197, v185, v197
v_mul_f32 v198, v186, v198
v_mul_f32 v199, v187, v199
v_mul_f32 v220, v208, v220
s_add_u32 m0, s40, 2048
s_add_u32 s38, s38, 57344
buffer_load_dwordx4 v4, s[12:15], s38 offen lds
v_mul_f32 v221, v209, v221
v_mul_f32 v222, v210, v222
v_mul_f32 v223, v211, v223
v_mul_f32 v196, v196, v72
v_mul_f32 v197, v197, v73
v_mul_f32 v198, v198, v74
s_add_u32 m0, s40, 3072
s_nop 0
buffer_load_dwordx4 v5, s[12:15], s38 offen lds
v_mul_f32 v199, v199, v75
v_mul_f32 v220, v220, v76
v_mul_f32 v221, v221, v77
v_mul_f32 v222, v222, v78
v_mul_f32 v223, v223, v79
v_cvt_pk_bf16_f32 v80, v196, v197
v_cvt_pk_bf16_f32 v81, v198, v199
s_add_u32 m0, s40, 4096
s_add_u32 s38, s38, 57344
buffer_load_dwordx4 v4, s[12:15], s38 offen lds
v_cvt_pk_bf16_f32 v82, v220, v221
v_cvt_pk_bf16_f32 v83, v222, v223
s_nop 1
v_permlane32_swap_b32 v80, v82
v_permlane32_swap_b32 v81, v83
buffer_store_dwordx4 v[80:83], v84, s[24:27], s55 offen offset:2048 sc1
s_nop 1
s_add_u32 m0, s40, 5120
s_nop 0
buffer_load_dwordx4 v5, s[12:15], s38 offen lds
v_cmp_gt_u32 vcc, 32, v1
v_mov_b32 v104, s52
v_mov_b32 v106, s53
v_cndmask_b32 v104, v106, v104, vcc
v_lshl_add_u32 v104, v105, 4, v104
v_bfe_u32 v105, v1, 4, 1
v_lshl_add_u32 v104, v105, 2, v104
s_add_u32 m0, s40, 6144
s_add_u32 s38, s38, 57344
buffer_load_dwordx4 v4, s[12:15], s38 offen lds
s_add_u32 m0, s40, 7168
s_nop 0
buffer_load_dwordx4 v5, s[12:15], s38 offen lds
s_waitcnt vmcnt(15)
s_barrier
s_add_u32 s37, s35, 9
s_and_b32 s37, s37, 15
s_mul_i32 s37, s37, 16384
s_add_u32 m0, s39, 49152
s_nop 0
buffer_load_dwordx4 v3, s[8:11], s37 offen sc1 lds
buffer_load_dwordx4 v3, s[8:11], s37 offen offset:1024 sc1 lds
buffer_load_dwordx4 v3, s[8:11], s37 offen offset:2048 sc1 lds
buffer_load_dwordx4 v3, s[8:11], s37 offen offset:3072 sc1 lds
s_add_u32 s38, s35, 9
s_and_b32 s38, s38, 15
s_mul_i32 s38, s38, 458752
s_add_u32 m0, s40, 49152
s_nop 0
buffer_load_dwordx4 v4, s[12:15], s38 offen lds
s_add_u32 m0, s40, 50176
s_nop 0
buffer_load_dwordx4 v5, s[12:15], s38 offen lds
s_add_u32 m0, s40, 51200
s_add_u32 s38, s38, 57344
buffer_load_dwordx4 v4, s[12:15], s38 offen lds
s_add_u32 m0, s40, 52224
s_nop 0
buffer_load_dwordx4 v5, s[12:15], s38 offen lds
s_add_u32 m0, s40, 53248
s_add_u32 s38, s38, 57344
buffer_load_dwordx4 v4, s[12:15], s38 offen lds
s_add_u32 m0, s40, 54272
s_nop 0
buffer_load_dwordx4 v5, s[12:15], s38 offen lds
s_add_u32 m0, s40, 55296
s_add_u32 s38, s38, 57344
buffer_load_dwordx4 v4, s[12:15], s38 offen lds
s_add_u32 m0, s40, 56320
s_nop 0
buffer_load_dwordx4 v5, s[12:15], s38 offen lds
s_waitcnt vmcnt(12)
s_barrier
s_cmp_eq_u32 s47, 0
s_cbranch_scc0 Lw_130
s_add_u32 s7, s34, 32
s_lshl_b32 s7, s7, 7
v_mov_b32 v90, s7
v_mov_b32 v91, 1
s_mov_b64 exec, 1
buffer_atomic_add v91, v90, s[56:59], 0 offen sc1
s_mov_b64 exec, -1
Lw_130:
v_permlane32_swap_b32 v96, v100
v_permlane32_swap_b32 v97, v101
v_permlane32_swap_b32 v98, v102
v_permlane32_swap_b32 v99, v103
v_add_f32 v96, v96, v100
v_add_f32 v97, v97, v101
v_add_f32 v98, v98, v102
v_add_f32 v99, v99, v103
s_nop 1
v_permlane16_swap_b32 v96, v97
v_permlane16_swap_b32 v98, v99
v_add_f32 v96, v96, v97
v_add_f32 v98, v98, v99
s_nop 1
v_add_f32_dpp v96, v96, v96 row_ror:8 row_mask:0xf bank_mask:0xf
v_add_f32_dpp v98, v98, v98 row_ror:8 row_mask:0xf bank_mask:0xf
ds_write_b32 v104, v96
ds_write_b32 v104, v98 offset:8
s_waitcnt lgkmcnt(0)
s_add_u32 s37, s35, 10
s_and_b32 s37, s37, 15
s_mul_i32 s37, s37, 16384
s_add_u32 m0, s39, 98304
s_nop 0
buffer_load_dwordx4 v3, s[8:11], s37 offen sc1 lds
s_load_dword s3, s[4:5], 6272
s_load_dword s3, s[4:5], 6336
s_load_dword s3, s[4:5], 6400
s_load_dword s3, s[4:5], 6464
s_load_dword s3, s[4:5], 6528
s_load_dword s3, s[4:5], 6592
buffer_load_dwordx4 v3, s[8:11], s37 offen offset:1024 sc1 lds
s_load_dword s3, s[4:5], 6656
s_load_dword s3, s[4:5], 6720
s_load_dword s3, s[4:5], 6784
s_load_dword s3, s[4:5], 6848
s_load_dword s3, s[4:5], 6912
s_load_dword s3, s[4:5], 6976
s_load_dword s3, s[4:5], 7040
buffer_load_dwordx4 v3, s[8:11], s37 offen offset:2048 sc1 lds
s_load_dword s3, s[4:5], 7104
s_bfe_u32 s61, s35, 0x10002
s_lshr_b32 s60, s35, 3
s_lshl_b32 s60, s60, 2
s_and_b32 s43, s35, 3
s_add_u32 s60, s60, s43
buffer_load_dwordx4 v3, s[8:11], s37 offen offset:3072 sc1 lds
s_lshl_b32 s43, s60, 8
s_add_u32 s28, s76, s43
s_addc_u32 s29, s77, 0
s_mov_b32 s30, 7338240
s_mov_b32 s31, 0x20000
s_mul_i32 s52, s61, 196608
s_mul_i32 s53, s61, 1572864
s_add_u32 s38, s35, 10
s_and_b32 s38, s38, 15
s_mul_i32 s38, s38, 458752
s_add_u32 m0, s40, 98304
s_nop 0
buffer_load_dwordx4 v4, s[12:15], s38 offen lds
s_mul_i32 s90, s61, 163840
s_mul_i32 s91, s61, 1310720
s_and_b32 s43, s35, 3
s_mul_i32 s32, s43, 3
s_mul_i32 s33, s43, 10
s_lshr_b32 s33, s33, 2
s_add_u32 m0, s40, 99328
s_nop 0
buffer_load_dwordx4 v5, s[12:15], s38 offen lds
s_lshl_b32 s51, s47, 11
s_lshl_b32 s44, s47, 15
v_lshrrev_b32 v122, 4, v1
v_lshlrev_b32 v123, 1, v122
v_and_b32 v23, 15, v1
v_xor_b32 v23, v23, v123
v_lshlrev_b32 v23, 4, v23
s_add_u32 m0, s40, 100352
s_add_u32 s38, s38, 57344
buffer_load_dwordx4 v4, s[12:15], s38 offen lds
v_mul_u32_u24 v122, 2048, v122
v_add_u32 v23, v23, v122
v_add_u32 v23, s44, v23
s_branch Lov_10
.p2align 12
.fill 80, 4, 0xbf800000
Lst_10_0:
s_branch Lwr_170
Lst_10_1:
s_branch Lwr_181
s_nop 0
Lov_10:
v_xor_b32 v24, 128, v23
v_add_u32 v24, 8192, v24
s_lshl_b32 s43, s60, 2
s_add_u32 m0, s40, 101376
s_nop 0
buffer_load_dwordx4 v5, s[12:15], s38 offen lds
s_lshl_b32 s44, s61, 1
s_add_u32 s43, s43, s44
s_add_u32 s43, s43, s63
s_lshl_b32 s43, s43, 13
s_lshl_b32 s44, s62, 12
s_add_u32 s50, s43, s44
v_add_u32 v17, s44, v2
s_add_u32 m0, s40, 102400
s_add_u32 s38, s38, 57344
buffer_load_dwordx4 v4, s[12:15], s38 offen lds
v_add_u32 v18, 0x10000, v17
v_add_u32 v19, 0x20000, v17
v_lshrrev_b32 v122, 2, v1
v_and_b32 v123, 7, v122
v_mul_u32_u24 v122, 256, v122
v_lshl_add_u32 v122, v123, 5, v122
s_add_u32 m0, s40, 103424
s_nop 0
buffer_load_dwordx4 v5, s[12:15], s38 offen lds
v_and_b32 v123, 3, v1
v_lshl_add_u32 v9, v123, 3, v122
s_lshl_b32 s43, s61, 7
s_lshl_b32 s44, s63, 6
s_add_u32 s43, s43, s44
v_xor_b32 v9, s43, v9
v_xor_b32 v10, 32, v9
s_add_u32 m0, s40, 104448
s_add_u32 s38, s38, 57344
buffer_load_dwordx4 v4, s[12:15], s38 offen lds
s_add_u32 m0, s40, 105472
s_nop 0
buffer_load_dwordx4 v5, s[12:15], s38 offen lds
s_waitcnt vmcnt(12)
s_barrier
buffer_load_dwordx4 v[160:163], v2, s[8:11], s50 offen offset:0 sc1
v_xor_b32 v11, 128, v9
v_xor_b32 v12, 128, v10
v_add_u32 v13, 65536, v9
buffer_load_dwordx4 v[164:167], v2, s[8:11], s50 offen offset:1024 sc1
v_add_u32 v14, 65536, v10
v_add_u32 v15, 65536, v11
v_add_u32 v16, 65536, v12
v_add_u32 v25, 131072, v9
buffer_load_dwordx4 v[168:171], v2, s[8:11], s50 offen offset:2048 sc1
v_add_u32 v26, 131072, v10
v_add_u32 v27, 131072, v11
v_add_u32 v28, 131072, v12
v_lshrrev_b32 v122, 2, v1
buffer_load_dwordx4 v[172:175], v2, s[8:11], s50 offen offset:3072 sc1
v_bfe_u32 v123, v122, 1, 2
v_mul_u32_u24 v122, 128, v122
v_lshl_add_u32 v122, v123, 5, v122
s_add_u32 s37, s35, 11
s_and_b32 s37, s37, 15
s_mul_i32 s37, s37, 16384
s_add_u32 m0, s39, 0
s_nop 0
buffer_load_dwordx4 v3, s[8:11], s37 offen sc1 lds
v_and_b32 v123, 3, v1
v_lshl_add_u32 v224, v123, 3, v122
v_xor_b32 v224, s44, v224
v_xor_b32 v225, 32, v224
buffer_load_dwordx4 v3, s[8:11], s37 offen offset:1024 sc1 lds
v_add_u32 v226, 65536, v224
v_add_u32 v227, 65536, v225
v_add_u32 v228, 131072, v224
v_add_u32 v229, 131072, v225
buffer_load_dwordx4 v3, s[8:11], s37 offen offset:2048 sc1 lds
s_add_u32 s84, s82, 33554432
s_addc_u32 s85, s83, 0
s_mov_b32 s86, 4194304
s_mov_b32 s87, 0x20000
buffer_load_dwordx4 v3, s[8:11], s37 offen offset:3072 sc1 lds
s_xor_b32 s43, s2, 2
s_lshl_b32 s44, s43, 2
s_add_u32 s44, s44, s47
s_add_u32 s38, s35, 11
s_and_b32 s38, s38, 15
s_mul_i32 s38, s38, 458752
s_add_u32 m0, s40, 0
s_nop 0
buffer_load_dwordx4 v4, s[12:15], s38 offen lds
s_lshl_b32 s45, s44, 12
s_lshl_b32 s46, s2, 2
s_add_u32 s46, s46, s47
s_lshl_b32 s46, s46, 12
s_add_u32 m0, s40, 1024
s_nop 0
buffer_load_dwordx4 v5, s[12:15], s38 offen lds
s_lshl_b32 s43, s34, 18
s_lshl_b32 s42, s60, 8
s_add_u32 s43, s43, s42
s_lshl_b32 s42, s61, 7
s_add_u32 m0, s40, 2048
s_add_u32 s38, s38, 57344
buffer_load_dwordx4 v4, s[12:15], s38 offen lds
s_add_u32 s43, s43, s42
s_lshl_b32 s42, s63, 6
s_add_u32 s43, s43, s42
s_add_u32 m0, s40, 3072
s_nop 0
buffer_load_dwordx4 v5, s[12:15], s38 offen lds
s_add_u32 s20, s78, s43
s_addc_u32 s21, s79, 0
s_mov_b32 s22, 260160
s_mov_b32 s23, 0x20000
s_add_u32 m0, s40, 4096
s_add_u32 s38, s38, 57344
buffer_load_dwordx4 v4, s[12:15], s38 offen lds
v_and_b32 v230, 15, v1
v_lshlrev_b32 v230, 12, v230
v_bfe_u32 v231, v1, 4, 1
v_lshl_add_u32 v230, v231, 5, v230
s_add_u32 m0, s40, 5120
s_nop 0
buffer_load_dwordx4 v5, s[12:15], s38 offen lds
v_bfe_u32 v231, v1, 5, 1
v_lshl_add_u32 v230, v231, 4, v230
s_lshl_b32 s54, s62, 17
s_add_u32 s55, s54, 65536
s_add_u32 m0, s40, 6144
s_add_u32 s38, s38, 57344
buffer_load_dwordx4 v4, s[12:15], s38 offen lds
s_add_u32 m0, s40, 7168
s_nop 0
buffer_load_dwordx4 v5, s[12:15], s38 offen lds
s_waitcnt vmcnt(16)
s_barrier
s_cmp_eq_u32 s47, 3
s_cbranch_scc0 Lw_131
s_lshl_b32 s92, s34, 7
s_add_u32 s92, s92, 28315648
s_load_dword s93, s[82:83], s92 glc
Lw_131:
s_add_u32 s37, s35, 12
s_and_b32 s37, s37, 15
s_mul_i32 s37, s37, 16384
s_add_u32 m0, s39, 49152
s_nop 0
buffer_load_dwordx4 v3, s[8:11], s37 offen sc1 lds
buffer_load_dwordx4 v3, s[8:11], s37 offen offset:1024 sc1 lds
buffer_load_dwordx4 v3, s[8:11], s37 offen offset:2048 sc1 lds
buffer_load_dwordx4 v3, s[8:11], s37 offen offset:3072 sc1 lds
s_add_u32 s38, s35, 12
s_and_b32 s38, s38, 15
s_mul_i32 s38, s38, 458752
s_add_u32 m0, s40, 49152
s_nop 0
buffer_load_dwordx4 v4, s[12:15], s38 offen lds
s_add_u32 m0, s40, 50176
s_nop 0
buffer_load_dwordx4 v5, s[12:15], s38 offen lds
s_add_u32 m0, s40, 51200
s_add_u32 s38, s38, 57344
buffer_load_dwordx4 v4, s[12:15], s38 offen lds
s_add_u32 m0, s40, 52224
s_nop 0
buffer_load_dwordx4 v5, s[12:15], s38 offen lds
s_add_u32 m0, s40, 53248
s_add_u32 s38, s38, 57344
buffer_load_dwordx4 v4, s[12:15], s38 offen lds
s_add_u32 m0, s40, 54272
s_nop 0
buffer_load_dwordx4 v5, s[12:15], s38 offen lds
s_add_u32 m0, s40, 55296
s_add_u32 s38, s38, 57344
buffer_load_dwordx4 v4, s[12:15], s38 offen lds
s_add_u32 m0, s40, 56320
s_nop 0
buffer_load_dwordx4 v5, s[12:15], s38 offen lds
s_waitcnt vmcnt(12)
s_cmp_eq_u32 s47, 3
s_cbranch_scc0 Lw_132
s_mov_b32 s41, 0x40000
s_branch Lpchk_135
Lpoll_133:
s_load_dword s93, s[82:83], s92 glc
Lpchk_135:
s_waitcnt lgkmcnt(0)
s_cmp_eq_u32 s93, 16
s_cbranch_scc1 Lpok_134
s_sub_u32 s41, s41, 1
s_cmp_lg_u32 s41, 0
s_cbranch_scc1 Lpoll_133
Lpok_134:
Lw_132:
s_barrier
s_add_u32 s37, s52, 524288
s_add_u32 m0, s39, 98304
s_nop 0
buffer_load_dwordx4 v3, s[24:27], s37 offen sc1 lds
v_lshlrev_b32 v128, 16, v160
v_and_b32 v129, 0xffff0000, v160
v_lshlrev_b32 v130, 16, v161
v_and_b32 v131, 0xffff0000, v161
v_lshlrev_b32 v132, 16, v162
buffer_load_dwordx4 v3, s[24:27], s37 offen offset:1024 sc1 lds
v_and_b32 v133, 0xffff0000, v162
v_lshlrev_b32 v134, 16, v163
v_and_b32 v135, 0xffff0000, v163
v_lshlrev_b32 v136, 16, v164
v_and_b32 v137, 0xffff0000, v164
buffer_load_dwordx4 v3, s[24:27], s37 offen offset:2048 sc1 lds
v_lshlrev_b32 v138, 16, v165
v_and_b32 v139, 0xffff0000, v165
v_lshlrev_b32 v140, 16, v166
v_and_b32 v141, 0xffff0000, v166
v_lshlrev_b32 v142, 16, v167
v_and_b32 v143, 0xffff0000, v167
buffer_load_dwordx4 v3, s[24:27], s37 offen offset:3072 sc1 lds
v_lshlrev_b32 v144, 16, v168
v_and_b32 v145, 0xffff0000, v168
v_lshlrev_b32 v146, 16, v169
v_and_b32 v147, 0xffff0000, v169
v_lshlrev_b32 v148, 16, v170
s_add_u32 s38, s53, 4194304
s_add_u32 m0, s39, 114688
s_nop 0
buffer_load_dwordx4 v23, s[28:31], s38 offen lds
v_and_b32 v149, 0xffff0000, v170
v_lshlrev_b32 v150, 16, v171
v_and_b32 v151, 0xffff0000, v171
v_lshlrev_b32 v152, 16, v172
v_and_b32 v153, 0xffff0000, v172
s_add_u32 m0, s39, 115712
s_nop 0
buffer_load_dwordx4 v24, s[28:31], s38 offen lds
v_lshlrev_b32 v154, 16, v173
v_and_b32 v155, 0xffff0000, v173
v_lshlrev_b32 v156, 16, v174
v_and_b32 v157, 0xffff0000, v174
v_lshlrev_b32 v158, 16, v175
v_and_b32 v159, 0xffff0000, v175
s_add_u32 m0, s39, 116736
s_add_u32 s38, s38, 16384
buffer_load_dwordx4 v23, s[28:31], s38 offen lds
s_add_u32 m0, s39, 117760
s_nop 0
buffer_load_dwordx4 v24, s[28:31], s38 offen lds
s_waitcnt vmcnt(8)
s_barrier
s_add_u32 s37, s52, 540672
s_add_u32 m0, s39, 131072
s_nop 0
buffer_load_dwordx4 v3, s[24:27], s37 offen sc1 lds
buffer_load_dwordx4 v3, s[24:27], s37 offen offset:1024 sc1 lds
buffer_load_dwordx4 v3, s[24:27], s37 offen offset:2048 sc1 lds
buffer_load_dwordx4 v3, s[24:27], s37 offen offset:3072 sc1 lds
s_add_u32 s38, s53, 4325376
s_add_u32 m0, s39, 0
s_nop 0
buffer_load_dwordx4 v23, s[28:31], s38 offen lds
s_add_u32 m0, s39, 1024
s_nop 0
buffer_load_dwordx4 v24, s[28:31], s38 offen lds
s_add_u32 m0, s39, 2048
s_add_u32 s38, s38, 16384
buffer_load_dwordx4 v23, s[28:31], s38 offen lds
s_add_u32 m0, s39, 3072
s_nop 0
buffer_load_dwordx4 v24, s[28:31], s38 offen lds
s_add_u32 s37, s52, 557056
s_add_u32 m0, s39, 16384
s_nop 0
buffer_load_dwordx4 v3, s[24:27], s37 offen sc1 lds
buffer_load_dwordx4 v3, s[24:27], s37 offen offset:1024 sc1 lds
buffer_load_dwordx4 v3, s[24:27], s37 offen offset:2048 sc1 lds
buffer_load_dwordx4 v3, s[24:27], s37 offen offset:3072 sc1 lds
s_add_u32 s38, s53, 4456448
s_add_u32 m0, s39, 32768
s_nop 0
buffer_load_dwordx4 v23, s[28:31], s38 offen lds
s_add_u32 m0, s39, 33792
s_nop 0
buffer_load_dwordx4 v24, s[28:31], s38 offen lds
s_add_u32 m0, s39, 34816
s_add_u32 s38, s38, 16384
buffer_load_dwordx4 v23, s[28:31], s38 offen lds
s_add_u32 m0, s39, 35840
s_nop 0
buffer_load_dwordx4 v24, s[28:31], s38 offen lds
s_waitcnt vmcnt(16)
s_barrier
ds_read_b128 v[32:35], v18 offset:32768
ds_read_b64_tr_b16 v[48:49], v13 offset:49152
ds_read_b64_tr_b16 v[50:51], v13 offset:53248
ds_read_b64_tr_b16 v[52:53], v14 offset:49152
ds_read_b64_tr_b16 v[54:55], v14 offset:53248
ds_read_b64_tr_b16 v[56:57], v15 offset:49152
ds_read_b64_tr_b16 v[58:59], v15 offset:53248
ds_read_b64_tr_b16 v[60:61], v16 offset:49152
ds_read_b64_tr_b16 v[62:63], v16 offset:53248
ds_read_b128 v[36:39], v18 offset:33792
ds_read_b128 v[40:43], v18 offset:34816
ds_read_b128 v[44:47], v18 offset:35840
ds_read_b128 v[64:67], v18 offset:40960
ds_read_b64_tr_b16 v[80:81], v13 offset:57344
ds_read_b64_tr_b16 v[82:83], v13 offset:61440
ds_read_b64_tr_b16 v[84:85], v14 offset:57344
ds_read_b64_tr_b16 v[86:87], v14 offset:61440
ds_read_b64_tr_b16 v[88:89], v15 offset:57344
ds_read_b64_tr_b16 v[90:91], v15 offset:61440
ds_read_b64_tr_b16 v[92:93], v16 offset:57344
ds_read_b64_tr_b16 v[94:95], v16 offset:61440
ds_read_b128 v[68:71], v18 offset:41984
ds_read_b128 v[72:75], v18 offset:43008
ds_read_b128 v[76:79], v18 offset:44032
s_add_u32 s37, s52, 573440
s_add_u32 m0, s39, 49152
s_nop 0
buffer_load_dwordx4 v3, s[24:27], s37 offen sc1 lds
buffer_load_dwordx4 v3, s[24:27], s37 offen offset:1024 sc1 lds
buffer_load_dwordx4 v3, s[24:27], s37 offen offset:2048 sc1 lds
buffer_load_dwordx4 v3, s[24:27], s37 offen offset:3072 sc1 lds
s_add_u32 s38, s53, 4587520
s_add_u32 m0, s39, 65536
s_nop 0
buffer_load_dwordx4 v23, s[28:31], s38 offen lds
s_add_u32 m0, s39, 66560
s_nop 0
buffer_load_dwordx4 v24, s[28:31], s38 offen lds
s_add_u32 m0, s39, 67584
s_add_u32 s38, s38, 16384
buffer_load_dwordx4 v23, s[28:31], s38 offen lds
s_add_u32 m0, s39, 68608
s_nop 0
buffer_load_dwordx4 v24, s[28:31], s38 offen lds
Lk4c:
s_waitcnt vmcnt(16)
s_waitcnt lgkmcnt(0)
s_barrier
v_mfma_f32_16x16x32_bf16 v[128:131], v[48:51], v[32:35], v[128:131]
ds_read_b128 v[96:99], v19 offset:0
v_mfma_f32_16x16x32_bf16 v[136:139], v[48:51], v[36:39], v[136:139]
ds_read_b64_tr_b16 v[112:113], v9 offset:0
v_mfma_f32_16x16x32_bf16 v[144:147], v[48:51], v[40:43], v[144:147]
ds_read_b64_tr_b16 v[114:115], v9 offset:4096
v_mfma_f32_16x16x32_bf16 v[152:155], v[48:51], v[44:47], v[152:155]
ds_read_b64_tr_b16 v[116:117], v10 offset:0
v_mfma_f32_16x16x32_bf16 v[156:159], v[52:55], v[44:47], v[156:159]
ds_read_b64_tr_b16 v[118:119], v10 offset:4096
v_mfma_f32_16x16x32_bf16 v[148:151], v[52:55], v[40:43], v[148:151]
ds_read_b64_tr_b16 v[120:121], v11 offset:0
v_mfma_f32_16x16x32_bf16 v[140:143], v[52:55], v[36:39], v[140:143]
ds_read_b64_tr_b16 v[122:123], v11 offset:4096
v_mfma_f32_16x16x32_bf16 v[132:135], v[52:55], v[32:35], v[132:135]
ds_read_b64_tr_b16 v[124:125], v12 offset:0
v_mfma_f32_16x16x32_bf16 v[160:163], v[56:59], v[32:35], 0
ds_read_b64_tr_b16 v[126:127], v12 offset:4096
v_mfma_f32_16x16x32_bf16 v[168:171], v[56:59], v[36:39], 0
ds_read_b128 v[100:103], v19 offset:1024
v_mfma_f32_16x16x32_bf16 v[176:179], v[56:59], v[40:43], 0
ds_read_b128 v[104:107], v19 offset:2048
v_mfma_f32_16x16x32_bf16 v[184:187], v[56:59], v[44:47], 0
ds_read_b128 v[108:111], v19 offset:3072
v_mfma_f32_16x16x32_bf16 v[188:191], v[60:63], v[44:47], 0
ds_read_b128 v[192:195], v19 offset:8192
v_mfma_f32_16x16x32_bf16 v[180:183], v[60:63], v[40:43], 0
ds_read_b64_tr_b16 v[208:209], v9 offset:8192
v_mfma_f32_16x16x32_bf16 v[172:175], v[60:63], v[36:39], 0
ds_read_b64_tr_b16 v[210:211], v9 offset:12288
v_mfma_f32_16x16x32_bf16 v[164:167], v[60:63], v[32:35], 0
ds_read_b64_tr_b16 v[212:213], v10 offset:8192
v_mfma_f32_16x16x32_bf16 v[128:131], v[80:83], v[64:67], v[128:131]
ds_read_b64_tr_b16 v[214:215], v10 offset:12288
v_mfma_f32_16x16x32_bf16 v[136:139], v[80:83], v[68:71], v[136:139]
ds_read_b64_tr_b16 v[216:217], v11 offset:8192
v_mfma_f32_16x16x32_bf16 v[144:147], v[80:83], v[72:75], v[144:147]
ds_read_b64_tr_b16 v[218:219], v11 offset:12288
v_mfma_f32_16x16x32_bf16 v[152:155], v[80:83], v[76:79], v[152:155]
ds_read_b64_tr_b16 v[220:221], v12 offset:8192
v_mfma_f32_16x16x32_bf16 v[156:159], v[84:87], v[76:79], v[156:159]
ds_read_b64_tr_b16 v[222:223], v12 offset:12288
v_mfma_f32_16x16x32_bf16 v[148:151], v[84:87], v[72:75], v[148:151]
ds_read_b128 v[196:199], v19 offset:9216
v_mfma_f32_16x16x32_bf16 v[140:143], v[84:87], v[68:71], v[140:143]
ds_read_b128 v[200:203], v19 offset:10240
v_mfma_f32_16x16x32_bf16 v[132:135], v[84:87], v[64:67], v[132:135]
ds_read_b128 v[204:207], v19 offset:11264
v_mfma_f32_16x16x32_bf16 v[160:163], v[88:91], v[64:67], v[160:163]
v_mfma_f32_16x16x32_bf16 v[168:171], v[88:91], v[68:71], v[168:171]
v_mfma_f32_16x16x32_bf16 v[176:179], v[88:91], v[72:75], v[176:179]
v_mfma_f32_16x16x32_bf16 v[184:187], v[88:91], v[76:79], v[184:187]
v_mfma_f32_16x16x32_bf16 v[188:191], v[92:95], v[76:79], v[188:191]
v_mfma_f32_16x16x32_bf16 v[180:183], v[92:95], v[72:75], v[180:183]
v_mfma_f32_16x16x32_bf16 v[172:175], v[92:95], v[68:71], v[172:175]
v_mfma_f32_16x16x32_bf16 v[164:167], v[92:95], v[64:67], v[164:167]
s_mov_b32 s41, 2
Lk4_136:
s_waitcnt vmcnt(8)
s_waitcnt lgkmcnt(0)
s_barrier
v_mfma_f32_16x16x32_bf16 v[128:131], v[112:115], v[96:99], v[128:131]
ds_read_b128 v[32:35], v17 offset:16384
v_mfma_f32_16x16x32_bf16 v[136:139], v[112:115], v[100:103], v[136:139]
ds_read_b64_tr_b16 v[48:49], v9 offset:32768
v_mfma_f32_16x16x32_bf16 v[144:147], v[112:115], v[104:107], v[144:147]
ds_read_b64_tr_b16 v[50:51], v9 offset:36864
v_mfma_f32_16x16x32_bf16 v[152:155], v[112:115], v[108:111], v[152:155]
ds_read_b64_tr_b16 v[52:53], v10 offset:32768
v_mfma_f32_16x16x32_bf16 v[156:159], v[116:119], v[108:111], v[156:159]
ds_read_b64_tr_b16 v[54:55], v10 offset:36864
v_mfma_f32_16x16x32_bf16 v[148:151], v[116:119], v[104:107], v[148:151]
ds_read_b64_tr_b16 v[56:57], v11 offset:32768
v_mfma_f32_16x16x32_bf16 v[140:143], v[116:119], v[100:103], v[140:143]
ds_read_b64_tr_b16 v[58:59], v11 offset:36864
v_mfma_f32_16x16x32_bf16 v[132:135], v[116:119], v[96:99], v[132:135]
ds_read_b64_tr_b16 v[60:61], v12 offset:32768
v_mfma_f32_16x16x32_bf16 v[160:163], v[120:123], v[96:99], v[160:163]
ds_read_b64_tr_b16 v[62:63], v12 offset:36864
v_mfma_f32_16x16x32_bf16 v[168:171], v[120:123], v[100:103], v[168:171]
ds_read_b128 v[36:39], v17 offset:17408
v_mfma_f32_16x16x32_bf16 v[176:179], v[120:123], v[104:107], v[176:179]
ds_read_b128 v[40:43], v17 offset:18432
v_mfma_f32_16x16x32_bf16 v[184:187], v[120:123], v[108:111], v[184:187]
ds_read_b128 v[44:47], v17 offset:19456
v_mfma_f32_16x16x32_bf16 v[188:191], v[124:127], v[108:111], v[188:191]
ds_read_b128 v[64:67], v17 offset:24576
v_mfma_f32_16x16x32_bf16 v[180:183], v[124:127], v[104:107], v[180:183]
ds_read_b64_tr_b16 v[80:81], v9 offset:40960
v_mfma_f32_16x16x32_bf16 v[172:175], v[124:127], v[100:103], v[172:175]
ds_read_b64_tr_b16 v[82:83], v9 offset:45056
v_mfma_f32_16x16x32_bf16 v[164:167], v[124:127], v[96:99], v[164:167]
ds_read_b64_tr_b16 v[84:85], v10 offset:40960
v_mfma_f32_16x16x32_bf16 v[128:131], v[208:211], v[192:195], v[128:131]
ds_read_b64_tr_b16 v[86:87], v10 offset:45056
v_mfma_f32_16x16x32_bf16 v[136:139], v[208:211], v[196:199], v[136:139]
ds_read_b64_tr_b16 v[88:89], v11 offset:40960
v_mfma_f32_16x16x32_bf16 v[144:147], v[208:211], v[200:203], v[144:147]
ds_read_b64_tr_b16 v[90:91], v11 offset:45056
v_mfma_f32_16x16x32_bf16 v[152:155], v[208:211], v[204:207], v[152:155]
ds_read_b64_tr_b16 v[92:93], v12 offset:40960
v_mfma_f32_16x16x32_bf16 v[156:159], v[212:215], v[204:207], v[156:159]
ds_read_b64_tr_b16 v[94:95], v12 offset:45056
v_mfma_f32_16x16x32_bf16 v[148:151], v[212:215], v[200:203], v[148:151]
ds_read_b128 v[68:71], v17 offset:25600
v_mfma_f32_16x16x32_bf16 v[140:143], v[212:215], v[196:199], v[140:143]
ds_read_b128 v[72:75], v17 offset:26624
v_mfma_f32_16x16x32_bf16 v[132:135], v[212:215], v[192:195], v[132:135]
ds_read_b128 v[76:79], v17 offset:27648
v_mfma_f32_16x16x32_bf16 v[160:163], v[216:219], v[192:195], v[160:163]
v_mfma_f32_16x16x32_bf16 v[168:171], v[216:219], v[196:199], v[168:171]
v_mfma_f32_16x16x32_bf16 v[176:179], v[216:219], v[200:203], v[176:179]
v_mfma_f32_16x16x32_bf16 v[184:187], v[216:219], v[204:207], v[184:187]
v_mfma_f32_16x16x32_bf16 v[188:191], v[220:223], v[204:207], v[188:191]
v_mfma_f32_16x16x32_bf16 v[180:183], v[220:223], v[200:203], v[180:183]
v_mfma_f32_16x16x32_bf16 v[172:175], v[220:223], v[196:199], v[172:175]
v_mfma_f32_16x16x32_bf16 v[164:167], v[220:223], v[192:195], v[164:167]
s_waitcnt vmcnt(0)
s_waitcnt lgkmcnt(0)
s_barrier
v_mfma_f32_16x16x32_bf16 v[128:131], v[48:51], v[32:35], v[128:131]
ds_read_b128 v[96:99], v17 offset:49152
v_mfma_f32_16x16x32_bf16 v[136:139], v[48:51], v[36:39], v[136:139]
ds_read_b64_tr_b16 v[112:113], v13 offset:0
v_mfma_f32_16x16x32_bf16 v[144:147], v[48:51], v[40:43], v[144:147]
ds_read_b64_tr_b16 v[114:115], v13 offset:4096
v_mfma_f32_16x16x32_bf16 v[152:155], v[48:51], v[44:47], v[152:155]
ds_read_b64_tr_b16 v[116:117], v14 offset:0
v_mfma_f32_16x16x32_bf16 v[156:159], v[52:55], v[44:47], v[156:159]
ds_read_b64_tr_b16 v[118:119], v14 offset:4096
v_mfma_f32_16x16x32_bf16 v[148:151], v[52:55], v[40:43], v[148:151]
ds_read_b64_tr_b16 v[120:121], v15 offset:0
v_mfma_f32_16x16x32_bf16 v[140:143], v[52:55], v[36:39], v[140:143]
ds_read_b64_tr_b16 v[122:123], v15 offset:4096
v_mfma_f32_16x16x32_bf16 v[132:135], v[52:55], v[32:35], v[132:135]
ds_read_b64_tr_b16 v[124:125], v16 offset:0
v_mfma_f32_16x16x32_bf16 v[160:163], v[56:59], v[32:35], v[160:163]
ds_read_b64_tr_b16 v[126:127], v16 offset:4096
v_mfma_f32_16x16x32_bf16 v[168:171], v[56:59], v[36:39], v[168:171]
ds_read_b128 v[100:103], v17 offset:50176
v_mfma_f32_16x16x32_bf16 v[176:179], v[56:59], v[40:43], v[176:179]
ds_read_b128 v[104:107], v17 offset:51200
v_mfma_f32_16x16x32_bf16 v[184:187], v[56:59], v[44:47], v[184:187]
ds_read_b128 v[108:111], v17 offset:52224
v_mfma_f32_16x16x32_bf16 v[188:191], v[60:63], v[44:47], v[188:191]
ds_read_b128 v[192:195], v17 offset:57344
v_mfma_f32_16x16x32_bf16 v[180:183], v[60:63], v[40:43], v[180:183]
ds_read_b64_tr_b16 v[208:209], v13 offset:8192
v_mfma_f32_16x16x32_bf16 v[172:175], v[60:63], v[36:39], v[172:175]
ds_read_b64_tr_b16 v[210:211], v13 offset:12288
v_mfma_f32_16x16x32_bf16 v[164:167], v[60:63], v[32:35], v[164:167]
ds_read_b64_tr_b16 v[212:213], v14 offset:8192
v_mfma_f32_16x16x32_bf16 v[128:131], v[80:83], v[64:67], v[128:131]
ds_read_b64_tr_b16 v[214:215], v14 offset:12288
v_mfma_f32_16x16x32_bf16 v[136:139], v[80:83], v[68:71], v[136:139]
ds_read_b64_tr_b16 v[216:217], v15 offset:8192
v_mfma_f32_16x16x32_bf16 v[144:147], v[80:83], v[72:75], v[144:147]
ds_read_b64_tr_b16 v[218:219], v15 offset:12288
v_mfma_f32_16x16x32_bf16 v[152:155], v[80:83], v[76:79], v[152:155]
ds_read_b64_tr_b16 v[220:221], v16 offset:8192
v_mfma_f32_16x16x32_bf16 v[156:159], v[84:87], v[76:79], v[156:159]
ds_read_b64_tr_b16 v[222:223], v16 offset:12288
v_mfma_f32_16x16x32_bf16 v[148:151], v[84:87], v[72:75], v[148:151]
ds_read_b128 v[196:199], v17 offset:58368
v_mfma_f32_16x16x32_bf16 v[140:143], v[84:87], v[68:71], v[140:143]
ds_read_b128 v[200:203], v17 offset:59392
v_mfma_f32_16x16x32_bf16 v[132:135], v[84:87], v[64:67], v[132:135]
ds_read_b128 v[204:207], v17 offset:60416
v_mfma_f32_16x16x32_bf16 v[160:163], v[88:91], v[64:67], v[160:163]
v_mfma_f32_16x16x32_bf16 v[168:171], v[88:91], v[68:71], v[168:171]
v_mfma_f32_16x16x32_bf16 v[176:179], v[88:91], v[72:75], v[176:179]
v_mfma_f32_16x16x32_bf16 v[184:187], v[88:91], v[76:79], v[184:187]
v_mfma_f32_16x16x32_bf16 v[188:191], v[92:95], v[76:79], v[188:191]
v_mfma_f32_16x16x32_bf16 v[180:183], v[92:95], v[72:75], v[180:183]
v_mfma_f32_16x16x32_bf16 v[172:175], v[92:95], v[68:71], v[172:175]
v_mfma_f32_16x16x32_bf16 v[164:167], v[92:95], v[64:67], v[164:167]
s_waitcnt lgkmcnt(0)
s_barrier
v_mfma_f32_16x16x32_bf16 v[128:131], v[112:115], v[96:99], v[128:131]
ds_read_b128 v[32:35], v18 offset:16384
v_mfma_f32_16x16x32_bf16 v[136:139], v[112:115], v[100:103], v[136:139]
ds_read_b64_tr_b16 v[48:49], v25 offset:16384
v_mfma_f32_16x16x32_bf16 v[144:147], v[112:115], v[104:107], v[144:147]
ds_read_b64_tr_b16 v[50:51], v25 offset:20480
v_mfma_f32_16x16x32_bf16 v[152:155], v[112:115], v[108:111], v[152:155]
ds_read_b64_tr_b16 v[52:53], v26 offset:16384
v_mfma_f32_16x16x32_bf16 v[156:159], v[116:119], v[108:111], v[156:159]
ds_read_b64_tr_b16 v[54:55], v26 offset:20480
v_mfma_f32_16x16x32_bf16 v[148:151], v[116:119], v[104:107], v[148:151]
ds_read_b64_tr_b16 v[56:57], v27 offset:16384
v_mfma_f32_16x16x32_bf16 v[140:143], v[116:119], v[100:103], v[140:143]
ds_read_b64_tr_b16 v[58:59], v27 offset:20480
v_mfma_f32_16x16x32_bf16 v[132:135], v[116:119], v[96:99], v[132:135]
ds_read_b64_tr_b16 v[60:61], v28 offset:16384
v_mfma_f32_16x16x32_bf16 v[160:163], v[120:123], v[96:99], v[160:163]
ds_read_b64_tr_b16 v[62:63], v28 offset:20480
v_mfma_f32_16x16x32_bf16 v[168:171], v[120:123], v[100:103], v[168:171]
ds_read_b128 v[36:39], v18 offset:17408
v_mfma_f32_16x16x32_bf16 v[176:179], v[120:123], v[104:107], v[176:179]
ds_read_b128 v[40:43], v18 offset:18432
v_mfma_f32_16x16x32_bf16 v[184:187], v[120:123], v[108:111], v[184:187]
ds_read_b128 v[44:47], v18 offset:19456
v_mfma_f32_16x16x32_bf16 v[188:191], v[124:127], v[108:111], v[188:191]
ds_read_b128 v[64:67], v18 offset:24576
v_mfma_f32_16x16x32_bf16 v[180:183], v[124:127], v[104:107], v[180:183]
ds_read_b64_tr_b16 v[80:81], v25 offset:24576
s_branch Lov_11
.p2align 12
.fill 80, 4, 0xbf800000
Lst_11_0:
s_branch Lwr_171
Lst_11_1:
s_branch Lst_15_0
s_nop 0
Lov_11:
v_mfma_f32_16x16x32_bf16 v[172:175], v[124:127], v[100:103], v[172:175]
ds_read_b64_tr_b16 v[82:83], v25 offset:28672
v_mfma_f32_16x16x32_bf16 v[164:167], v[124:127], v[96:99], v[164:167]
ds_read_b64_tr_b16 v[84:85], v26 offset:24576
v_mfma_f32_16x16x32_bf16 v[128:131], v[208:211], v[192:195], v[128:131]
ds_read_b64_tr_b16 v[86:87], v26 offset:28672
v_mfma_f32_16x16x32_bf16 v[136:139], v[208:211], v[196:199], v[136:139]
ds_read_b64_tr_b16 v[88:89], v27 offset:24576
v_mfma_f32_16x16x32_bf16 v[144:147], v[208:211], v[200:203], v[144:147]
ds_read_b64_tr_b16 v[90:91], v27 offset:28672
v_mfma_f32_16x16x32_bf16 v[152:155], v[208:211], v[204:207], v[152:155]
ds_read_b64_tr_b16 v[92:93], v28 offset:24576
v_mfma_f32_16x16x32_bf16 v[156:159], v[212:215], v[204:207], v[156:159]
ds_read_b64_tr_b16 v[94:95], v28 offset:28672
v_mfma_f32_16x16x32_bf16 v[148:151], v[212:215], v[200:203], v[148:151]
ds_read_b128 v[68:71], v18 offset:25600
v_mfma_f32_16x16x32_bf16 v[140:143], v[212:215], v[196:199], v[140:143]
ds_read_b128 v[72:75], v18 offset:26624
v_mfma_f32_16x16x32_bf16 v[132:135], v[212:215], v[192:195], v[132:135]
ds_read_b128 v[76:79], v18 offset:27648
v_mfma_f32_16x16x32_bf16 v[160:163], v[216:219], v[192:195], v[160:163]
v_mfma_f32_16x16x32_bf16 v[168:171], v[216:219], v[196:199], v[168:171]
v_mfma_f32_16x16x32_bf16 v[176:179], v[216:219], v[200:203], v[176:179]
v_mfma_f32_16x16x32_bf16 v[184:187], v[216:219], v[204:207], v[184:187]
v_mfma_f32_16x16x32_bf16 v[188:191], v[220:223], v[204:207], v[188:191]
v_mfma_f32_16x16x32_bf16 v[180:183], v[220:223], v[200:203], v[180:183]
v_mfma_f32_16x16x32_bf16 v[172:175], v[220:223], v[196:199], v[172:175]
v_mfma_f32_16x16x32_bf16 v[164:167], v[220:223], v[192:195], v[164:167]
s_waitcnt lgkmcnt(0)
s_barrier
v_mfma_f32_16x16x32_bf16 v[128:131], v[48:51], v[32:35], v[128:131]
ds_read_b128 v[96:99], v18 offset:32768
v_mfma_f32_16x16x32_bf16 v[136:139], v[48:51], v[36:39], v[136:139]
ds_read_b64_tr_b16 v[112:113], v13 offset:49152
v_mfma_f32_16x16x32_bf16 v[144:147], v[48:51], v[40:43], v[144:147]
ds_read_b64_tr_b16 v[114:115], v13 offset:53248
v_mfma_f32_16x16x32_bf16 v[152:155], v[48:51], v[44:47], v[152:155]
ds_read_b64_tr_b16 v[116:117], v14 offset:49152
v_mfma_f32_16x16x32_bf16 v[156:159], v[52:55], v[44:47], v[156:159]
ds_read_b64_tr_b16 v[118:119], v14 offset:53248
v_mfma_f32_16x16x32_bf16 v[148:151], v[52:55], v[40:43], v[148:151]
ds_read_b64_tr_b16 v[120:121], v15 offset:49152
v_mfma_f32_16x16x32_bf16 v[140:143], v[52:55], v[36:39], v[140:143]
ds_read_b64_tr_b16 v[122:123], v15 offset:53248
v_mfma_f32_16x16x32_bf16 v[132:135], v[52:55], v[32:35], v[132:135]
ds_read_b64_tr_b16 v[124:125], v16 offset:49152
v_mfma_f32_16x16x32_bf16 v[160:163], v[56:59], v[32:35], v[160:163]
ds_read_b64_tr_b16 v[126:127], v16 offset:53248
v_mfma_f32_16x16x32_bf16 v[168:171], v[56:59], v[36:39], v[168:171]
ds_read_b128 v[100:103], v18 offset:33792
v_mfma_f32_16x16x32_bf16 v[176:179], v[56:59], v[40:43], v[176:179]
ds_read_b128 v[104:107], v18 offset:34816
v_mfma_f32_16x16x32_bf16 v[184:187], v[56:59], v[44:47], v[184:187]
ds_read_b128 v[108:111], v18 offset:35840
v_mfma_f32_16x16x32_bf16 v[188:191], v[60:63], v[44:47], v[188:191]
ds_read_b128 v[192:195], v18 offset:40960
v_mfma_f32_16x16x32_bf16 v[180:183], v[60:63], v[40:43], v[180:183]
ds_read_b64_tr_b16 v[208:209], v13 offset:57344
v_mfma_f32_16x16x32_bf16 v[172:175], v[60:63], v[36:39], v[172:175]
ds_read_b64_tr_b16 v[210:211], v13 offset:61440
v_mfma_f32_16x16x32_bf16 v[164:167], v[60:63], v[32:35], v[164:167]
ds_read_b64_tr_b16 v[212:213], v14 offset:57344
v_mfma_f32_16x16x32_bf16 v[128:131], v[80:83], v[64:67], v[128:131]
ds_read_b64_tr_b16 v[214:215], v14 offset:61440
v_mfma_f32_16x16x32_bf16 v[136:139], v[80:83], v[68:71], v[136:139]
ds_read_b64_tr_b16 v[216:217], v15 offset:57344
v_mfma_f32_16x16x32_bf16 v[144:147], v[80:83], v[72:75], v[144:147]
ds_read_b64_tr_b16 v[218:219], v15 offset:61440
v_mfma_f32_16x16x32_bf16 v[152:155], v[80:83], v[76:79], v[152:155]
ds_read_b64_tr_b16 v[220:221], v16 offset:57344
v_mfma_f32_16x16x32_bf16 v[156:159], v[84:87], v[76:79], v[156:159]
ds_read_b64_tr_b16 v[222:223], v16 offset:61440
v_mfma_f32_16x16x32_bf16 v[148:151], v[84:87], v[72:75], v[148:151]
ds_read_b128 v[196:199], v18 offset:41984
v_mfma_f32_16x16x32_bf16 v[140:143], v[84:87], v[68:71], v[140:143]
ds_read_b128 v[200:203], v18 offset:43008
v_mfma_f32_16x16x32_bf16 v[132:135], v[84:87], v[64:67], v[132:135]
ds_read_b128 v[204:207], v18 offset:44032
v_mfma_f32_16x16x32_bf16 v[160:163], v[88:91], v[64:67], v[160:163]
v_mfma_f32_16x16x32_bf16 v[168:171], v[88:91], v[68:71], v[168:171]
v_mfma_f32_16x16x32_bf16 v[176:179], v[88:91], v[72:75], v[176:179]
v_mfma_f32_16x16x32_bf16 v[184:187], v[88:91], v[76:79], v[184:187]
v_mfma_f32_16x16x32_bf16 v[188:191], v[92:95], v[76:79], v[188:191]
v_mfma_f32_16x16x32_bf16 v[180:183], v[92:95], v[72:75], v[180:183]
v_mfma_f32_16x16x32_bf16 v[172:175], v[92:95], v[68:71], v[172:175]
v_mfma_f32_16x16x32_bf16 v[164:167], v[92:95], v[64:67], v[164:167]
s_waitcnt lgkmcnt(0)
s_barrier
v_mfma_f32_16x16x32_bf16 v[128:131], v[112:115], v[96:99], v[128:131]
ds_read_b128 v[32:35], v19 offset:0
v_mfma_f32_16x16x32_bf16 v[136:139], v[112:115], v[100:103], v[136:139]
ds_read_b64_tr_b16 v[48:49], v9 offset:0
v_mfma_f32_16x16x32_bf16 v[144:147], v[112:115], v[104:107], v[144:147]
ds_read_b64_tr_b16 v[50:51], v9 offset:4096
v_mfma_f32_16x16x32_bf16 v[152:155], v[112:115], v[108:111], v[152:155]
ds_read_b64_tr_b16 v[52:53], v10 offset:0
v_mfma_f32_16x16x32_bf16 v[156:159], v[116:119], v[108:111], v[156:159]
ds_read_b64_tr_b16 v[54:55], v10 offset:4096
v_mfma_f32_16x16x32_bf16 v[148:151], v[116:119], v[104:107], v[148:151]
ds_read_b64_tr_b16 v[56:57], v11 offset:0
v_mfma_f32_16x16x32_bf16 v[140:143], v[116:119], v[100:103], v[140:143]
ds_read_b64_tr_b16 v[58:59], v11 offset:4096
v_mfma_f32_16x16x32_bf16 v[132:135], v[116:119], v[96:99], v[132:135]
ds_read_b64_tr_b16 v[60:61], v12 offset:0
v_mfma_f32_16x16x32_bf16 v[160:163], v[120:123], v[96:99], v[160:163]
ds_read_b64_tr_b16 v[62:63], v12 offset:4096
v_mfma_f32_16x16x32_bf16 v[168:171], v[120:123], v[100:103], v[168:171]
ds_read_b128 v[36:39], v19 offset:1024
v_mfma_f32_16x16x32_bf16 v[176:179], v[120:123], v[104:107], v[176:179]
ds_read_b128 v[40:43], v19 offset:2048
v_mfma_f32_16x16x32_bf16 v[184:187], v[120:123], v[108:111], v[184:187]
ds_read_b128 v[44:47], v19 offset:3072
v_mfma_f32_16x16x32_bf16 v[188:191], v[124:127], v[108:111], v[188:191]
ds_read_b128 v[64:67], v19 offset:8192
v_mfma_f32_16x16x32_bf16 v[180:183], v[124:127], v[104:107], v[180:183]
ds_read_b64_tr_b16 v[80:81], v9 offset:8192
v_mfma_f32_16x16x32_bf16 v[172:175], v[124:127], v[100:103], v[172:175]
ds_read_b64_tr_b16 v[82:83], v9 offset:12288
v_mfma_f32_16x16x32_bf16 v[164:167], v[124:127], v[96:99], v[164:167]
ds_read_b64_tr_b16 v[84:85], v10 offset:8192
v_mfma_f32_16x16x32_bf16 v[128:131], v[208:211], v[192:195], v[128:131]
ds_read_b64_tr_b16 v[86:87], v10 offset:12288
v_mfma_f32_16x16x32_bf16 v[136:139], v[208:211], v[196:199], v[136:139]
ds_read_b64_tr_b16 v[88:89], v11 offset:8192
v_mfma_f32_16x16x32_bf16 v[144:147], v[208:211], v[200:203], v[144:147]
ds_read_b64_tr_b16 v[90:91], v11 offset:12288
v_mfma_f32_16x16x32_bf16 v[152:155], v[208:211], v[204:207], v[152:155]
ds_read_b64_tr_b16 v[92:93], v12 offset:8192
v_mfma_f32_16x16x32_bf16 v[156:159], v[212:215], v[204:207], v[156:159]
ds_read_b64_tr_b16 v[94:95], v12 offset:12288
v_mfma_f32_16x16x32_bf16 v[148:151], v[212:215], v[200:203], v[148:151]
ds_read_b128 v[68:71], v19 offset:9216
v_mfma_f32_16x16x32_bf16 v[140:143], v[212:215], v[196:199], v[140:143]
ds_read_b128 v[72:75], v19 offset:10240
v_mfma_f32_16x16x32_bf16 v[132:135], v[212:215], v[192:195], v[132:135]
ds_read_b128 v[76:79], v19 offset:11264
v_mfma_f32_16x16x32_bf16 v[160:163], v[216:219], v[192:195], v[160:163]
v_mfma_f32_16x16x32_bf16 v[168:171], v[216:219], v[196:199], v[168:171]
v_mfma_f32_16x16x32_bf16 v[176:179], v[216:219], v[200:203], v[176:179]
v_mfma_f32_16x16x32_bf16 v[184:187], v[216:219], v[204:207], v[184:187]
v_mfma_f32_16x16x32_bf16 v[188:191], v[220:223], v[204:207], v[188:191]
v_mfma_f32_16x16x32_bf16 v[180:183], v[220:223], v[200:203], v[180:183]
v_mfma_f32_16x16x32_bf16 v[172:175], v[220:223], v[196:199], v[172:175]
v_mfma_f32_16x16x32_bf16 v[164:167], v[220:223], v[192:195], v[164:167]
s_waitcnt lgkmcnt(0)
s_barrier
v_mfma_f32_16x16x32_bf16 v[128:131], v[48:51], v[32:35], v[128:131]
ds_read_b128 v[96:99], v17 offset:16384
v_mfma_f32_16x16x32_bf16 v[136:139], v[48:51], v[36:39], v[136:139]
ds_read_b64_tr_b16 v[112:113], v9 offset:32768
v_mfma_f32_16x16x32_bf16 v[144:147], v[48:51], v[40:43], v[144:147]
ds_read_b64_tr_b16 v[114:115], v9 offset:36864
v_mfma_f32_16x16x32_bf16 v[152:155], v[48:51], v[44:47], v[152:155]
ds_read_b64_tr_b16 v[116:117], v10 offset:32768
v_mfma_f32_16x16x32_bf16 v[156:159], v[52:55], v[44:47], v[156:159]
ds_read_b64_tr_b16 v[118:119], v10 offset:36864
v_mfma_f32_16x16x32_bf16 v[148:151], v[52:55], v[40:43], v[148:151]
ds_read_b64_tr_b16 v[120:121], v11 offset:32768
v_mfma_f32_16x16x32_bf16 v[140:143], v[52:55], v[36:39], v[140:143]
ds_read_b64_tr_b16 v[122:123], v11 offset:36864
v_mfma_f32_16x16x32_bf16 v[132:135], v[52:55], v[32:35], v[132:135]
ds_read_b64_tr_b16 v[124:125], v12 offset:32768
v_mfma_f32_16x16x32_bf16 v[160:163], v[56:59], v[32:35], v[160:163]
ds_read_b64_tr_b16 v[126:127], v12 offset:36864
v_mfma_f32_16x16x32_bf16 v[168:171], v[56:59], v[36:39], v[168:171]
ds_read_b128 v[100:103], v17 offset:17408
v_mfma_f32_16x16x32_bf16 v[176:179], v[56:59], v[40:43], v[176:179]
ds_read_b128 v[104:107], v17 offset:18432
v_mfma_f32_16x16x32_bf16 v[184:187], v[56:59], v[44:47], v[184:187]
ds_read_b128 v[108:111], v17 offset:19456
v_mfma_f32_16x16x32_bf16 v[188:191], v[60:63], v[44:47], v[188:191]
ds_read_b128 v[192:195], v17 offset:24576
v_mfma_f32_16x16x32_bf16 v[180:183], v[60:63], v[40:43], v[180:183]
ds_read_b64_tr_b16 v[208:209], v9 offset:40960
v_mfma_f32_16x16x32_bf16 v[172:175], v[60:63], v[36:39], v[172:175]
ds_read_b64_tr_b16 v[210:211], v9 offset:45056
v_mfma_f32_16x16x32_bf16 v[164:167], v[60:63], v[32:35], v[164:167]
ds_read_b64_tr_b16 v[212:213], v10 offset:40960
v_mfma_f32_16x16x32_bf16 v[128:131], v[80:83], v[64:67], v[128:131]
ds_read_b64_tr_b16 v[214:215], v10 offset:45056
v_mfma_f32_16x16x32_bf16 v[136:139], v[80:83], v[68:71], v[136:139]
ds_read_b64_tr_b16 v[216:217], v11 offset:40960
v_mfma_f32_16x16x32_bf16 v[144:147], v[80:83], v[72:75], v[144:147]
ds_read_b64_tr_b16 v[218:219], v11 offset:45056
v_mfma_f32_16x16x32_bf16 v[152:155], v[80:83], v[76:79], v[152:155]
ds_read_b64_tr_b16 v[220:221], v12 offset:40960
v_mfma_f32_16x16x32_bf16 v[156:159], v[84:87], v[76:79], v[156:159]
ds_read_b64_tr_b16 v[222:223], v12 offset:45056
v_mfma_f32_16x16x32_bf16 v[148:151], v[84:87], v[72:75], v[148:151]
ds_read_b128 v[196:199], v17 offset:25600
v_mfma_f32_16x16x32_bf16 v[140:143], v[84:87], v[68:71], v[140:143]
ds_read_b128 v[200:203], v17 offset:26624
v_mfma_f32_16x16x32_bf16 v[132:135], v[84:87], v[64:67], v[132:135]
ds_read_b128 v[204:207], v17 offset:27648
v_mfma_f32_16x16x32_bf16 v[160:163], v[88:91], v[64:67], v[160:163]
v_mfma_f32_16x16x32_bf16 v[168:171], v[88:91], v[68:71], v[168:171]
v_mfma_f32_16x16x32_bf16 v[176:179], v[88:91], v[72:75], v[176:179]
v_mfma_f32_16x16x32_bf16 v[184:187], v[88:91], v[76:79], v[184:187]
v_mfma_f32_16x16x32_bf16 v[188:191], v[92:95], v[76:79], v[188:191]
v_mfma_f32_16x16x32_bf16 v[180:183], v[92:95], v[72:75], v[180:183]
v_mfma_f32_16x16x32_bf16 v[172:175], v[92:95], v[68:71], v[172:175]
v_mfma_f32_16x16x32_bf16 v[164:167], v[92:95], v[64:67], v[164:167]
s_waitcnt lgkmcnt(0)
s_barrier
v_mfma_f32_16x16x32_bf16 v[128:131], v[112:115], v[96:99], v[128:131]
ds_read_b128 v[32:35], v17 offset:49152
v_mfma_f32_16x16x32_bf16 v[136:139], v[112:115], v[100:103], v[136:139]
ds_read_b64_tr_b16 v[48:49], v13 offset:0
v_mfma_f32_16x16x32_bf16 v[144:147], v[112:115], v[104:107], v[144:147]
ds_read_b64_tr_b16 v[50:51], v13 offset:4096
v_mfma_f32_16x16x32_bf16 v[152:155], v[112:115], v[108:111], v[152:155]
ds_read_b64_tr_b16 v[52:53], v14 offset:0
v_mfma_f32_16x16x32_bf16 v[156:159], v[116:119], v[108:111], v[156:159]
ds_read_b64_tr_b16 v[54:55], v14 offset:4096
v_mfma_f32_16x16x32_bf16 v[148:151], v[116:119], v[104:107], v[148:151]
ds_read_b64_tr_b16 v[56:57], v15 offset:0
v_mfma_f32_16x16x32_bf16 v[140:143], v[116:119], v[100:103], v[140:143]
ds_read_b64_tr_b16 v[58:59], v15 offset:4096
v_mfma_f32_16x16x32_bf16 v[132:135], v[116:119], v[96:99], v[132:135]
ds_read_b64_tr_b16 v[60:61], v16 offset:0
v_mfma_f32_16x16x32_bf16 v[160:163], v[120:123], v[96:99], v[160:163]
ds_read_b64_tr_b16 v[62:63], v16 offset:4096
v_mfma_f32_16x16x32_bf16 v[168:171], v[120:123], v[100:103], v[168:171]
ds_read_b128 v[36:39], v17 offset:50176
v_mfma_f32_16x16x32_bf16 v[176:179], v[120:123], v[104:107], v[176:179]
ds_read_b128 v[40:43], v17 offset:51200
v_mfma_f32_16x16x32_bf16 v[184:187], v[120:123], v[108:111], v[184:187]
ds_read_b128 v[44:47], v17 offset:52224
v_mfma_f32_16x16x32_bf16 v[188:191], v[124:127], v[108:111], v[188:191]
ds_read_b128 v[64:67], v17 offset:57344
v_mfma_f32_16x16x32_bf16 v[180:183], v[124:127], v[104:107], v[180:183]
ds_read_b64_tr_b16 v[80:81], v13 offset:8192
v_mfma_f32_16x16x32_bf16 v[172:175], v[124:127], v[100:103], v[172:175]
ds_read_b64_tr_b16 v[82:83], v13 offset:12288
v_mfma_f32_16x16x32_bf16 v[164:167], v[124:127], v[96:99], v[164:167]
ds_read_b64_tr_b16 v[84:85], v14 offset:8192
v_mfma_f32_16x16x32_bf16 v[128:131], v[208:211], v[192:195], v[128:131]
ds_read_b64_tr_b16 v[86:87], v14 offset:12288
v_mfma_f32_16x16x32_bf16 v[136:139], v[208:211], v[196:199], v[136:139]
ds_read_b64_tr_b16 v[88:89], v15 offset:8192
v_mfma_f32_16x16x32_bf16 v[144:147], v[208:211], v[200:203], v[144:147]
ds_read_b64_tr_b16 v[90:91], v15 offset:12288
v_mfma_f32_16x16x32_bf16 v[152:155], v[208:211], v[204:207], v[152:155]
ds_read_b64_tr_b16 v[92:93], v16 offset:8192
v_mfma_f32_16x16x32_bf16 v[156:159], v[212:215], v[204:207], v[156:159]
ds_read_b64_tr_b16 v[94:95], v16 offset:12288
v_mfma_f32_16x16x32_bf16 v[148:151], v[212:215], v[200:203], v[148:151]
ds_read_b128 v[68:71], v17 offset:58368
v_mfma_f32_16x16x32_bf16 v[140:143], v[212:215], v[196:199], v[140:143]
ds_read_b128 v[72:75], v17 offset:59392
v_mfma_f32_16x16x32_bf16 v[132:135], v[212:215], v[192:195], v[132:135]
ds_read_b128 v[76:79], v17 offset:60416
v_mfma_f32_16x16x32_bf16 v[160:163], v[216:219], v[192:195], v[160:163]
v_mfma_f32_16x16x32_bf16 v[168:171], v[216:219], v[196:199], v[168:171]
v_mfma_f32_16x16x32_bf16 v[176:179], v[216:219], v[200:203], v[176:179]
v_mfma_f32_16x16x32_bf16 v[184:187], v[216:219], v[204:207], v[184:187]
v_mfma_f32_16x16x32_bf16 v[188:191], v[220:223], v[204:207], v[188:191]
v_mfma_f32_16x16x32_bf16 v[180:183], v[220:223], v[200:203], v[180:183]
v_mfma_f32_16x16x32_bf16 v[172:175], v[220:223], v[196:199], v[172:175]
v_mfma_f32_16x16x32_bf16 v[164:167], v[220:223], v[192:195], v[164:167]
s_waitcnt lgkmcnt(0)
s_barrier
v_mfma_f32_16x16x32_bf16 v[128:131], v[48:51], v[32:35], v[128:131]
ds_read_b128 v[96:99], v18 offset:16384
v_mfma_f32_16x16x32_bf16 v[136:139], v[48:51], v[36:39], v[136:139]
ds_read_b64_tr_b16 v[112:113], v25 offset:16384
v_mfma_f32_16x16x32_bf16 v[144:147], v[48:51], v[40:43], v[144:147]
ds_read_b64_tr_b16 v[114:115], v25 offset:20480
v_mfma_f32_16x16x32_bf16 v[152:155], v[48:51], v[44:47], v[152:155]
ds_read_b64_tr_b16 v[116:117], v26 offset:16384
v_mfma_f32_16x16x32_bf16 v[156:159], v[52:55], v[44:47], v[156:159]
ds_read_b64_tr_b16 v[118:119], v26 offset:20480
v_mfma_f32_16x16x32_bf16 v[148:151], v[52:55], v[40:43], v[148:151]
ds_read_b64_tr_b16 v[120:121], v27 offset:16384
v_mfma_f32_16x16x32_bf16 v[140:143], v[52:55], v[36:39], v[140:143]
ds_read_b64_tr_b16 v[122:123], v27 offset:20480
v_mfma_f32_16x16x32_bf16 v[132:135], v[52:55], v[32:35], v[132:135]
ds_read_b64_tr_b16 v[124:125], v28 offset:16384
v_mfma_f32_16x16x32_bf16 v[160:163], v[56:59], v[32:35], v[160:163]
ds_read_b64_tr_b16 v[126:127], v28 offset:20480
v_mfma_f32_16x16x32_bf16 v[168:171], v[56:59], v[36:39], v[168:171]
ds_read_b128 v[100:103], v18 offset:17408
v_mfma_f32_16x16x32_bf16 v[176:179], v[56:59], v[40:43], v[176:179]
ds_read_b128 v[104:107], v18 offset:18432
v_mfma_f32_16x16x32_bf16 v[184:187], v[56:59], v[44:47], v[184:187]
ds_read_b128 v[108:111], v18 offset:19456
v_mfma_f32_16x16x32_bf16 v[188:191], v[60:63], v[44:47], v[188:191]
ds_read_b128 v[192:195], v18 offset:24576
v_mfma_f32_16x16x32_bf16 v[180:183], v[60:63], v[40:43], v[180:183]
ds_read_b64_tr_b16 v[208:209], v25 offset:24576
v_mfma_f32_16x16x32_bf16 v[172:175], v[60:63], v[36:39], v[172:175]
ds_read_b64_tr_b16 v[210:211], v25 offset:28672
v_mfma_f32_16x16x32_bf16 v[164:167], v[60:63], v[32:35], v[164:167]
ds_read_b64_tr_b16 v[212:213], v26 offset:24576
v_mfma_f32_16x16x32_bf16 v[128:131], v[80:83], v[64:67], v[128:131]
ds_read_b64_tr_b16 v[214:215], v26 offset:28672
v_mfma_f32_16x16x32_bf16 v[136:139], v[80:83], v[68:71], v[136:139]
ds_read_b64_tr_b16 v[216:217], v27 offset:24576
v_mfma_f32_16x16x32_bf16 v[144:147], v[80:83], v[72:75], v[144:147]
ds_read_b64_tr_b16 v[218:219], v27 offset:28672
v_mfma_f32_16x16x32_bf16 v[152:155], v[80:83], v[76:79], v[152:155]
ds_read_b64_tr_b16 v[220:221], v28 offset:24576
v_mfma_f32_16x16x32_bf16 v[156:159], v[84:87], v[76:79], v[156:159]
ds_read_b64_tr_b16 v[222:223], v28 offset:28672
v_mfma_f32_16x16x32_bf16 v[148:151], v[84:87], v[72:75], v[148:151]
ds_read_b128 v[196:199], v18 offset:25600
v_mfma_f32_16x16x32_bf16 v[140:143], v[84:87], v[68:71], v[140:143]
ds_read_b128 v[200:203], v18 offset:26624
v_mfma_f32_16x16x32_bf16 v[132:135], v[84:87], v[64:67], v[132:135]
ds_read_b128 v[204:207], v18 offset:27648
v_mfma_f32_16x16x32_bf16 v[160:163], v[88:91], v[64:67], v[160:163]
v_mfma_f32_16x16x32_bf16 v[168:171], v[88:91], v[68:71], v[168:171]
v_mfma_f32_16x16x32_bf16 v[176:179], v[88:91], v[72:75], v[176:179]
v_mfma_f32_16x16x32_bf16 v[184:187], v[88:91], v[76:79], v[184:187]
v_mfma_f32_16x16x32_bf16 v[188:191], v[92:95], v[76:79], v[188:191]
v_mfma_f32_16x16x32_bf16 v[180:183], v[92:95], v[72:75], v[180:183]
v_mfma_f32_16x16x32_bf16 v[172:175], v[92:95], v[68:71], v[172:175]
v_mfma_f32_16x16x32_bf16 v[164:167], v[92:95], v[64:67], v[164:167]
s_waitcnt lgkmcnt(0)
s_barrier
v_mfma_f32_16x16x32_bf16 v[128:131], v[112:115], v[96:99], v[128:131]
ds_read_b128 v[32:35], v18 offset:32768
v_mfma_f32_16x16x32_bf16 v[136:139], v[112:115], v[100:103], v[136:139]
ds_read_b64_tr_b16 v[48:49], v13 offset:49152
v_mfma_f32_16x16x32_bf16 v[144:147], v[112:115], v[104:107], v[144:147]
ds_read_b64_tr_b16 v[50:51], v13 offset:53248
v_mfma_f32_16x16x32_bf16 v[152:155], v[112:115], v[108:111], v[152:155]
ds_read_b64_tr_b16 v[52:53], v14 offset:49152
v_mfma_f32_16x16x32_bf16 v[156:159], v[116:119], v[108:111], v[156:159]
ds_read_b64_tr_b16 v[54:55], v14 offset:53248
v_mfma_f32_16x16x32_bf16 v[148:151], v[116:119], v[104:107], v[148:151]
ds_read_b64_tr_b16 v[56:57], v15 offset:49152
v_mfma_f32_16x16x32_bf16 v[140:143], v[116:119], v[100:103], v[140:143]
ds_read_b64_tr_b16 v[58:59], v15 offset:53248
v_mfma_f32_16x16x32_bf16 v[132:135], v[116:119], v[96:99], v[132:135]
ds_read_b64_tr_b16 v[60:61], v16 offset:49152
v_mfma_f32_16x16x32_bf16 v[160:163], v[120:123], v[96:99], v[160:163]
ds_read_b64_tr_b16 v[62:63], v16 offset:53248
v_mfma_f32_16x16x32_bf16 v[168:171], v[120:123], v[100:103], v[168:171]
ds_read_b128 v[36:39], v18 offset:33792
v_mfma_f32_16x16x32_bf16 v[176:179], v[120:123], v[104:107], v[176:179]
ds_read_b128 v[40:43], v18 offset:34816
v_mfma_f32_16x16x32_bf16 v[184:187], v[120:123], v[108:111], v[184:187]
ds_read_b128 v[44:47], v18 offset:35840
v_mfma_f32_16x16x32_bf16 v[188:191], v[124:127], v[108:111], v[188:191]
ds_read_b128 v[64:67], v18 offset:40960
v_mfma_f32_16x16x32_bf16 v[180:183], v[124:127], v[104:107], v[180:183]
ds_read_b64_tr_b16 v[80:81], v13 offset:57344
v_mfma_f32_16x16x32_bf16 v[172:175], v[124:127], v[100:103], v[172:175]
ds_read_b64_tr_b16 v[82:83], v13 offset:61440
v_mfma_f32_16x16x32_bf16 v[164:167], v[124:127], v[96:99], v[164:167]
ds_read_b64_tr_b16 v[84:85], v14 offset:57344
v_mfma_f32_16x16x32_bf16 v[128:131], v[208:211], v[192:195], v[128:131]
ds_read_b64_tr_b16 v[86:87], v14 offset:61440
v_mfma_f32_16x16x32_bf16 v[136:139], v[208:211], v[196:199], v[136:139]
ds_read_b64_tr_b16 v[88:89], v15 offset:57344
v_mfma_f32_16x16x32_bf16 v[144:147], v[208:211], v[200:203], v[144:147]
ds_read_b64_tr_b16 v[90:91], v15 offset:61440
v_mfma_f32_16x16x32_bf16 v[152:155], v[208:211], v[204:207], v[152:155]
ds_read_b64_tr_b16 v[92:93], v16 offset:57344
v_mfma_f32_16x16x32_bf16 v[156:159], v[212:215], v[204:207], v[156:159]
ds_read_b64_tr_b16 v[94:95], v16 offset:61440
v_mfma_f32_16x16x32_bf16 v[148:151], v[212:215], v[200:203], v[148:151]
ds_read_b128 v[68:71], v18 offset:41984
v_mfma_f32_16x16x32_bf16 v[140:143], v[212:215], v[196:199], v[140:143]
ds_read_b128 v[72:75], v18 offset:43008
v_mfma_f32_16x16x32_bf16 v[132:135], v[212:215], v[192:195], v[132:135]
ds_read_b128 v[76:79], v18 offset:44032
v_mfma_f32_16x16x32_bf16 v[160:163], v[216:219], v[192:195], v[160:163]
v_mfma_f32_16x16x32_bf16 v[168:171], v[216:219], v[196:199], v[168:171]
v_mfma_f32_16x16x32_bf16 v[176:179], v[216:219], v[200:203], v[176:179]
v_mfma_f32_16x16x32_bf16 v[184:187], v[216:219], v[204:207], v[184:187]
v_mfma_f32_16x16x32_bf16 v[188:191], v[220:223], v[204:207], v[188:191]
v_mfma_f32_16x16x32_bf16 v[180:183], v[220:223], v[200:203], v[180:183]
v_mfma_f32_16x16x32_bf16 v[172:175], v[220:223], v[196:199], v[172:175]
v_mfma_f32_16x16x32_bf16 v[164:167], v[220:223], v[192:195], v[164:167]
s_waitcnt lgkmcnt(0)
s_barrier
v_mfma_f32_16x16x32_bf16 v[128:131], v[48:51], v[32:35], v[128:131]
ds_read_b128 v[96:99], v19 offset:0
v_mfma_f32_16x16x32_bf16 v[136:139], v[48:51], v[36:39], v[136:139]
ds_read_b64_tr_b16 v[112:113], v9 offset:0
v_mfma_f32_16x16x32_bf16 v[144:147], v[48:51], v[40:43], v[144:147]
ds_read_b64_tr_b16 v[114:115], v9 offset:4096
v_mfma_f32_16x16x32_bf16 v[152:155], v[48:51], v[44:47], v[152:155]
ds_read_b64_tr_b16 v[116:117], v10 offset:0
v_mfma_f32_16x16x32_bf16 v[156:159], v[52:55], v[44:47], v[156:159]
ds_read_b64_tr_b16 v[118:119], v10 offset:4096
v_mfma_f32_16x16x32_bf16 v[148:151], v[52:55], v[40:43], v[148:151]
ds_read_b64_tr_b16 v[120:121], v11 offset:0
v_mfma_f32_16x16x32_bf16 v[140:143], v[52:55], v[36:39], v[140:143]
ds_read_b64_tr_b16 v[122:123], v11 offset:4096
v_mfma_f32_16x16x32_bf16 v[132:135], v[52:55], v[32:35], v[132:135]
ds_read_b64_tr_b16 v[124:125], v12 offset:0
v_mfma_f32_16x16x32_bf16 v[160:163], v[56:59], v[32:35], v[160:163]
ds_read_b64_tr_b16 v[126:127], v12 offset:4096
v_mfma_f32_16x16x32_bf16 v[168:171], v[56:59], v[36:39], v[168:171]
ds_read_b128 v[100:103], v19 offset:1024
v_mfma_f32_16x16x32_bf16 v[176:179], v[56:59], v[40:43], v[176:179]
ds_read_b128 v[104:107], v19 offset:2048
v_mfma_f32_16x16x32_bf16 v[184:187], v[56:59], v[44:47], v[184:187]
ds_read_b128 v[108:111], v19 offset:3072
v_mfma_f32_16x16x32_bf16 v[188:191], v[60:63], v[44:47], v[188:191]
ds_read_b128 v[192:195], v19 offset:8192
v_mfma_f32_16x16x32_bf16 v[180:183], v[60:63], v[40:43], v[180:183]
ds_read_b64_tr_b16 v[208:209], v9 offset:8192
v_mfma_f32_16x16x32_bf16 v[172:175], v[60:63], v[36:39], v[172:175]
ds_read_b64_tr_b16 v[210:211], v9 offset:12288
v_mfma_f32_16x16x32_bf16 v[164:167], v[60:63], v[32:35], v[164:167]
ds_read_b64_tr_b16 v[212:213], v10 offset:8192
v_mfma_f32_16x16x32_bf16 v[128:131], v[80:83], v[64:67], v[128:131]
ds_read_b64_tr_b16 v[214:215], v10 offset:12288
v_mfma_f32_16x16x32_bf16 v[136:139], v[80:83], v[68:71], v[136:139]
ds_read_b64_tr_b16 v[216:217], v11 offset:8192
v_mfma_f32_16x16x32_bf16 v[144:147], v[80:83], v[72:75], v[144:147]
ds_read_b64_tr_b16 v[218:219], v11 offset:12288
v_mfma_f32_16x16x32_bf16 v[152:155], v[80:83], v[76:79], v[152:155]
ds_read_b64_tr_b16 v[220:221], v12 offset:8192
v_mfma_f32_16x16x32_bf16 v[156:159], v[84:87], v[76:79], v[156:159]
ds_read_b64_tr_b16 v[222:223], v12 offset:12288
v_mfma_f32_16x16x32_bf16 v[148:151], v[84:87], v[72:75], v[148:151]
ds_read_b128 v[196:199], v19 offset:9216
v_mfma_f32_16x16x32_bf16 v[140:143], v[84:87], v[68:71], v[140:143]
ds_read_b128 v[200:203], v19 offset:10240
v_mfma_f32_16x16x32_bf16 v[132:135], v[84:87], v[64:67], v[132:135]
ds_read_b128 v[204:207], v19 offset:11264
v_mfma_f32_16x16x32_bf16 v[160:163], v[88:91], v[64:67], v[160:163]
v_mfma_f32_16x16x32_bf16 v[168:171], v[88:91], v[68:71], v[168:171]
v_mfma_f32_16x16x32_bf16 v[176:179], v[88:91], v[72:75], v[176:179]
v_mfma_f32_16x16x32_bf16 v[184:187], v[88:91], v[76:79], v[184:187]
v_mfma_f32_16x16x32_bf16 v[188:191], v[92:95], v[76:79], v[188:191]
v_mfma_f32_16x16x32_bf16 v[180:183], v[92:95], v[72:75], v[180:183]
v_mfma_f32_16x16x32_bf16 v[172:175], v[92:95], v[68:71], v[172:175]
v_mfma_f32_16x16x32_bf16 v[164:167], v[92:95], v[64:67], v[164:167]
s_sub_u32 s41, s41, 1
s_cmp_lg_u32 s41, 0
s_cbranch_scc1 Lk4_136
s_waitcnt lgkmcnt(0)
s_barrier
v_mfma_f32_16x16x32_bf16 v[128:131], v[112:115], v[96:99], v[128:131]
ds_read_b128 v[32:35], v17 offset:16384
v_mfma_f32_16x16x32_bf16 v[136:139], v[112:115], v[100:103], v[136:139]
ds_read_b64_tr_b16 v[48:49], v224 offset:32768
v_mfma_f32_16x16x32_bf16 v[144:147], v[112:115], v[104:107], v[144:147]
ds_read_b64_tr_b16 v[50:51], v224 offset:34816
v_mfma_f32_16x16x32_bf16 v[152:155], v[112:115], v[108:111], v[152:155]
ds_read_b64_tr_b16 v[52:53], v225 offset:32768
v_mfma_f32_16x16x32_bf16 v[156:159], v[116:119], v[108:111], v[156:159]
ds_read_b64_tr_b16 v[54:55], v225 offset:34816
v_mfma_f32_16x16x32_bf16 v[148:151], v[116:119], v[104:107], v[148:151]
ds_read_b128 v[36:39], v17 offset:17408
v_mfma_f32_16x16x32_bf16 v[140:143], v[116:119], v[100:103], v[140:143]
ds_read_b128 v[40:43], v17 offset:18432
v_mfma_f32_16x16x32_bf16 v[132:135], v[116:119], v[96:99], v[132:135]
ds_read_b128 v[44:47], v17 offset:19456
v_mfma_f32_16x16x32_bf16 v[160:163], v[120:123], v[96:99], v[160:163]
ds_read_b128 v[64:67], v17 offset:24576
v_mfma_f32_16x16x32_bf16 v[168:171], v[120:123], v[100:103], v[168:171]
ds_read_b64_tr_b16 v[80:81], v224 offset:36864
v_mfma_f32_16x16x32_bf16 v[176:179], v[120:123], v[104:107], v[176:179]
ds_read_b64_tr_b16 v[82:83], v224 offset:38912
v_mfma_f32_16x16x32_bf16 v[184:187], v[120:123], v[108:111], v[184:187]
ds_read_b64_tr_b16 v[84:85], v225 offset:36864
v_mfma_f32_16x16x32_bf16 v[188:191], v[124:127], v[108:111], v[188:191]
ds_read_b64_tr_b16 v[86:87], v225 offset:38912
v_mfma_f32_16x16x32_bf16 v[180:183], v[124:127], v[104:107], v[180:183]
ds_read_b128 v[68:71], v17 offset:25600
v_mfma_f32_16x16x32_bf16 v[172:175], v[124:127], v[100:103], v[172:175]
ds_read_b128 v[72:75], v17 offset:26624
v_mfma_f32_16x16x32_bf16 v[164:167], v[124:127], v[96:99], v[164:167]
ds_read_b128 v[76:79], v17 offset:27648
v_mfma_f32_16x16x32_bf16 v[128:131], v[208:211], v[192:195], v[128:131]
v_mfma_f32_16x16x32_bf16 v[136:139], v[208:211], v[196:199], v[136:139]
v_mfma_f32_16x16x32_bf16 v[144:147], v[208:211], v[200:203], v[144:147]
v_mfma_f32_16x16x32_bf16 v[152:155], v[208:211], v[204:207], v[152:155]
v_mfma_f32_16x16x32_bf16 v[156:159], v[212:215], v[204:207], v[156:159]
v_mfma_f32_16x16x32_bf16 v[148:151], v[212:215], v[200:203], v[148:151]
v_mfma_f32_16x16x32_bf16 v[140:143], v[212:215], v[196:199], v[140:143]
v_mfma_f32_16x16x32_bf16 v[132:135], v[212:215], v[192:195], v[132:135]
s_branch Lov_12
.p2align 12
.fill 96, 4, 0xbf800000
Lst_12_0:
s_branch Lwr_172
Lst_12_1:
s_branch Lst_16_0
s_nop 0
Lov_12:
v_mfma_f32_16x16x32_bf16 v[160:163], v[216:219], v[192:195], v[160:163]
v_mfma_f32_16x16x32_bf16 v[168:171], v[216:219], v[196:199], v[168:171]
v_mfma_f32_16x16x32_bf16 v[176:179], v[216:219], v[200:203], v[176:179]
v_mfma_f32_16x16x32_bf16 v[184:187], v[216:219], v[204:207], v[184:187]
v_mfma_f32_16x16x32_bf16 v[188:191], v[220:223], v[204:207], v[188:191]
v_mfma_f32_16x16x32_bf16 v[180:183], v[220:223], v[200:203], v[180:183]
v_mfma_f32_16x16x32_bf16 v[172:175], v[220:223], v[196:199], v[172:175]
v_mfma_f32_16x16x32_bf16 v[164:167], v[220:223], v[192:195], v[164:167]
s_waitcnt lgkmcnt(0)
s_barrier
v_mfma_f32_16x16x32_bf16 v[128:131], v[48:51], v[32:35], v[128:131]
ds_read_b128 v[96:99], v17 offset:49152
ds_read_b64_tr_b16 v[112:113], v226 offset:0
v_mfma_f32_16x16x32_bf16 v[136:139], v[48:51], v[36:39], v[136:139]
ds_read_b64_tr_b16 v[114:115], v226 offset:2048
ds_read_b64_tr_b16 v[116:117], v227 offset:0
v_mfma_f32_16x16x32_bf16 v[144:147], v[48:51], v[40:43], v[144:147]
ds_read_b64_tr_b16 v[118:119], v227 offset:2048
ds_read_b128 v[100:103], v17 offset:50176
v_mfma_f32_16x16x32_bf16 v[152:155], v[48:51], v[44:47], v[152:155]
ds_read_b128 v[104:107], v17 offset:51200
ds_read_b128 v[108:111], v17 offset:52224
v_mfma_f32_16x16x32_bf16 v[156:159], v[52:55], v[44:47], v[156:159]
ds_read_b128 v[192:195], v17 offset:57344
v_mfma_f32_16x16x32_bf16 v[148:151], v[52:55], v[40:43], v[148:151]
ds_read_b64_tr_b16 v[208:209], v226 offset:4096
v_mfma_f32_16x16x32_bf16 v[140:143], v[52:55], v[36:39], v[140:143]
ds_read_b64_tr_b16 v[210:211], v226 offset:6144
v_cvt_pk_bf16_f32 v160, v160, v161
v_cvt_pk_bf16_f32 v161, v162, v163
v_mfma_f32_16x16x32_bf16 v[132:135], v[52:55], v[32:35], v[132:135]
ds_read_b64_tr_b16 v[212:213], v227 offset:4096
v_cvt_pk_bf16_f32 v162, v164, v165
v_cvt_pk_bf16_f32 v163, v166, v167
v_mfma_f32_16x16x32_bf16 v[128:131], v[80:83], v[64:67], v[128:131]
ds_read_b64_tr_b16 v[214:215], v227 offset:6144
v_cvt_pk_bf16_f32 v164, v168, v169
v_cvt_pk_bf16_f32 v165, v170, v171
v_mfma_f32_16x16x32_bf16 v[136:139], v[80:83], v[68:71], v[136:139]
ds_read_b128 v[196:199], v17 offset:58368
v_cvt_pk_bf16_f32 v166, v172, v173
v_cvt_pk_bf16_f32 v167, v174, v175
v_mfma_f32_16x16x32_bf16 v[144:147], v[80:83], v[72:75], v[144:147]
ds_read_b128 v[200:203], v17 offset:59392
v_cvt_pk_bf16_f32 v168, v176, v177
v_cvt_pk_bf16_f32 v169, v178, v179
v_mfma_f32_16x16x32_bf16 v[152:155], v[80:83], v[76:79], v[152:155]
ds_read_b128 v[204:207], v17 offset:60416
v_cvt_pk_bf16_f32 v170, v180, v181
v_cvt_pk_bf16_f32 v171, v182, v183
v_mfma_f32_16x16x32_bf16 v[156:159], v[84:87], v[76:79], v[156:159]
v_cvt_pk_bf16_f32 v172, v184, v185
v_cvt_pk_bf16_f32 v173, v186, v187
v_mfma_f32_16x16x32_bf16 v[148:151], v[84:87], v[72:75], v[148:151]
v_cvt_pk_bf16_f32 v174, v188, v189
v_cvt_pk_bf16_f32 v175, v190, v191
v_mfma_f32_16x16x32_bf16 v[140:143], v[84:87], v[68:71], v[140:143]
v_mfma_f32_16x16x32_bf16 v[132:135], v[84:87], v[64:67], v[132:135]
buffer_store_dwordx4 v[160:163], v2, s[84:87], s45 offen offset:0 sc1
s_waitcnt lgkmcnt(0)
s_barrier
v_mfma_f32_16x16x32_bf16 v[128:131], v[112:115], v[96:99], v[128:131]
ds_read_b128 v[32:35], v18 offset:16384
ds_read_b64_tr_b16 v[48:49], v228 offset:16384
v_mfma_f32_16x16x32_bf16 v[136:139], v[112:115], v[100:103], v[136:139]
ds_read_b64_tr_b16 v[50:51], v228 offset:18432
ds_read_b64_tr_b16 v[52:53], v229 offset:16384
v_mfma_f32_16x16x32_bf16 v[144:147], v[112:115], v[104:107], v[144:147]
ds_read_b64_tr_b16 v[54:55], v229 offset:18432
ds_read_b128 v[36:39], v18 offset:17408
v_mfma_f32_16x16x32_bf16 v[152:155], v[112:115], v[108:111], v[152:155]
ds_read_b128 v[40:43], v18 offset:18432
ds_read_b128 v[44:47], v18 offset:19456
v_mfma_f32_16x16x32_bf16 v[156:159], v[116:119], v[108:111], v[156:159]
ds_read_b128 v[64:67], v18 offset:24576
v_mfma_f32_16x16x32_bf16 v[148:151], v[116:119], v[104:107], v[148:151]
ds_read_b64_tr_b16 v[80:81], v228 offset:20480
v_mfma_f32_16x16x32_bf16 v[140:143], v[116:119], v[100:103], v[140:143]
ds_read_b64_tr_b16 v[82:83], v228 offset:22528
v_mfma_f32_16x16x32_bf16 v[132:135], v[116:119], v[96:99], v[132:135]
ds_read_b64_tr_b16 v[84:85], v229 offset:20480
v_mfma_f32_16x16x32_bf16 v[128:131], v[208:211], v[192:195], v[128:131]
ds_read_b64_tr_b16 v[86:87], v229 offset:22528
buffer_store_dwordx4 v[164:167], v2, s[84:87], s45 offen offset:1024 sc1
v_mfma_f32_16x16x32_bf16 v[136:139], v[208:211], v[196:199], v[136:139]
ds_read_b128 v[68:71], v18 offset:25600
v_mfma_f32_16x16x32_bf16 v[144:147], v[208:211], v[200:203], v[144:147]
ds_read_b128 v[72:75], v18 offset:26624
v_mfma_f32_16x16x32_bf16 v[152:155], v[208:211], v[204:207], v[152:155]
ds_read_b128 v[76:79], v18 offset:27648
v_mfma_f32_16x16x32_bf16 v[156:159], v[212:215], v[204:207], v[156:159]
v_mfma_f32_16x16x32_bf16 v[148:151], v[212:215], v[200:203], v[148:151]
v_mfma_f32_16x16x32_bf16 v[140:143], v[212:215], v[196:199], v[140:143]
v_mfma_f32_16x16x32_bf16 v[132:135], v[212:215], v[192:195], v[132:135]
s_waitcnt lgkmcnt(0)
s_barrier
v_mfma_f32_16x16x32_bf16 v[128:131], v[48:51], v[32:35], v[128:131]
ds_read_b128 v[96:99], v18 offset:32768
ds_read_b64_tr_b16 v[112:113], v226 offset:49152
v_mfma_f32_16x16x32_bf16 v[136:139], v[48:51], v[36:39], v[136:139]
ds_read_b64_tr_b16 v[114:115], v226 offset:51200
ds_read_b64_tr_b16 v[116:117], v227 offset:49152
v_mfma_f32_16x16x32_bf16 v[144:147], v[48:51], v[40:43], v[144:147]
ds_read_b64_tr_b16 v[118:119], v227 offset:51200
ds_read_b128 v[100:103], v18 offset:33792
v_mfma_f32_16x16x32_bf16 v[152:155], v[48:51], v[44:47], v[152:155]
ds_read_b128 v[104:107], v18 offset:34816
ds_read_b128 v[108:111], v18 offset:35840
v_mfma_f32_16x16x32_bf16 v[156:159], v[52:55], v[44:47], v[156:159]
ds_read_b128 v[192:195], v18 offset:40960
v_mfma_f32_16x16x32_bf16 v[148:151], v[52:55], v[40:43], v[148:151]
ds_read_b64_tr_b16 v[208:209], v226 offset:53248
v_mfma_f32_16x16x32_bf16 v[140:143], v[52:55], v[36:39], v[140:143]
ds_read_b64_tr_b16 v[210:211], v226 offset:55296
v_mfma_f32_16x16x32_bf16 v[132:135], v[52:55], v[32:35], v[132:135]
ds_read_b64_tr_b16 v[212:213], v227 offset:53248
v_mfma_f32_16x16x32_bf16 v[128:131], v[80:83], v[64:67], v[128:131]
ds_read_b64_tr_b16 v[214:215], v227 offset:55296
buffer_store_dwordx4 v[168:171], v2, s[84:87], s45 offen offset:2048 sc1
v_mfma_f32_16x16x32_bf16 v[136:139], v[80:83], v[68:71], v[136:139]
ds_read_b128 v[196:199], v18 offset:41984
v_mfma_f32_16x16x32_bf16 v[144:147], v[80:83], v[72:75], v[144:147]
ds_read_b128 v[200:203], v18 offset:43008
v_mfma_f32_16x16x32_bf16 v[152:155], v[80:83], v[76:79], v[152:155]
ds_read_b128 v[204:207], v18 offset:44032
v_mfma_f32_16x16x32_bf16 v[156:159], v[84:87], v[76:79], v[156:159]
v_mfma_f32_16x16x32_bf16 v[148:151], v[84:87], v[72:75], v[148:151]
v_mfma_f32_16x16x32_bf16 v[140:143], v[84:87], v[68:71], v[140:143]
v_mfma_f32_16x16x32_bf16 v[132:135], v[84:87], v[64:67], v[132:135]
s_waitcnt lgkmcnt(0)
s_barrier
v_mfma_f32_16x16x32_bf16 v[128:131], v[112:115], v[96:99], v[128:131]
ds_read_b128 v[32:35], v19 offset:0
ds_read_b64_tr_b16 v[48:49], v224 offset:0
v_mfma_f32_16x16x32_bf16 v[136:139], v[112:115], v[100:103], v[136:139]
ds_read_b64_tr_b16 v[50:51], v224 offset:2048
ds_read_b64_tr_b16 v[52:53], v225 offset:0
v_mfma_f32_16x16x32_bf16 v[144:147], v[112:115], v[104:107], v[144:147]
ds_read_b64_tr_b16 v[54:55], v225 offset:2048
ds_read_b128 v[36:39], v19 offset:1024
v_mfma_f32_16x16x32_bf16 v[152:155], v[112:115], v[108:111], v[152:155]
ds_read_b128 v[40:43], v19 offset:2048
ds_read_b128 v[44:47], v19 offset:3072
v_mfma_f32_16x16x32_bf16 v[156:159], v[116:119], v[108:111], v[156:159]
ds_read_b128 v[64:67], v19 offset:8192
v_mfma_f32_16x16x32_bf16 v[148:151], v[116:119], v[104:107], v[148:151]
ds_read_b64_tr_b16 v[80:81], v224 offset:4096
v_mfma_f32_16x16x32_bf16 v[140:143], v[116:119], v[100:103], v[140:143]
ds_read_b64_tr_b16 v[82:83], v224 offset:6144
v_mfma_f32_16x16x32_bf16 v[132:135], v[116:119], v[96:99], v[132:135]
ds_read_b64_tr_b16 v[84:85], v225 offset:4096
v_mfma_f32_16x16x32_bf16 v[128:131], v[208:211], v[192:195], v[128:131]
ds_read_b64_tr_b16 v[86:87], v225 offset:6144
buffer_store_dwordx4 v[172:175], v2, s[84:87], s45 offen offset:3072 sc1
v_mfma_f32_16x16x32_bf16 v[136:139], v[208:211], v[196:199], v[136:139]
ds_read_b128 v[68:71], v19 offset:9216
v_mfma_f32_16x16x32_bf16 v[144:147], v[208:211], v[200:203], v[144:147]
ds_read_b128 v[72:75], v19 offset:10240
v_mfma_f32_16x16x32_bf16 v[152:155], v[208:211], v[204:207], v[152:155]
ds_read_b128 v[76:79], v19 offset:11264
v_mfma_f32_16x16x32_bf16 v[156:159], v[212:215], v[204:207], v[156:159]
v_mfma_f32_16x16x32_bf16 v[148:151], v[212:215], v[200:203], v[148:151]
v_mfma_f32_16x16x32_bf16 v[140:143], v[212:215], v[196:199], v[140:143]
v_mfma_f32_16x16x32_bf16 v[132:135], v[212:215], v[192:195], v[132:135]
s_waitcnt lgkmcnt(0)
s_barrier
v_mfma_f32_16x16x32_bf16 v[128:131], v[48:51], v[32:35], v[128:131]
ds_read_b128 v[96:99], v17 offset:16384
ds_read_b64_tr_b16 v[112:113], v224 offset:32768
v_mfma_f32_16x16x32_bf16 v[136:139], v[48:51], v[36:39], v[136:139]
ds_read_b64_tr_b16 v[114:115], v224 offset:34816
ds_read_b64_tr_b16 v[116:117], v225 offset:32768
v_mfma_f32_16x16x32_bf16 v[144:147], v[48:51], v[40:43], v[144:147]
ds_read_b64_tr_b16 v[118:119], v225 offset:34816
ds_read_b128 v[100:103], v17 offset:17408
v_mfma_f32_16x16x32_bf16 v[152:155], v[48:51], v[44:47], v[152:155]
ds_read_b128 v[104:107], v17 offset:18432
ds_read_b128 v[108:111], v17 offset:19456
v_mfma_f32_16x16x32_bf16 v[156:159], v[52:55], v[44:47], v[156:159]
ds_read_b128 v[192:195], v17 offset:24576
v_mfma_f32_16x16x32_bf16 v[148:151], v[52:55], v[40:43], v[148:151]
ds_read_b64_tr_b16 v[208:209], v224 offset:36864
v_mfma_f32_16x16x32_bf16 v[140:143], v[52:55], v[36:39], v[140:143]
ds_read_b64_tr_b16 v[210:211], v224 offset:38912
v_mfma_f32_16x16x32_bf16 v[132:135], v[52:55], v[32:35], v[132:135]
ds_read_b64_tr_b16 v[212:213], v225 offset:36864
v_mfma_f32_16x16x32_bf16 v[128:131], v[80:83], v[64:67], v[128:131]
ds_read_b64_tr_b16 v[214:215], v225 offset:38912
v_mfma_f32_16x16x32_bf16 v[136:139], v[80:83], v[68:71], v[136:139]
ds_read_b128 v[196:199], v17 offset:25600
v_mfma_f32_16x16x32_bf16 v[144:147], v[80:83], v[72:75], v[144:147]
ds_read_b128 v[200:203], v17 offset:26624
v_mfma_f32_16x16x32_bf16 v[152:155], v[80:83], v[76:79], v[152:155]
ds_read_b128 v[204:207], v17 offset:27648
v_mfma_f32_16x16x32_bf16 v[156:159], v[84:87], v[76:79], v[156:159]
v_mfma_f32_16x16x32_bf16 v[148:151], v[84:87], v[72:75], v[148:151]
v_mfma_f32_16x16x32_bf16 v[140:143], v[84:87], v[68:71], v[140:143]
v_mfma_f32_16x16x32_bf16 v[132:135], v[84:87], v[64:67], v[132:135]
s_waitcnt vmcnt(0)
s_waitcnt lgkmcnt(0)
s_barrier
v_mfma_f32_16x16x32_bf16 v[128:131], v[112:115], v[96:99], v[128:131]
ds_read_b128 v[32:35], v17 offset:49152
ds_read_b64_tr_b16 v[48:49], v226 offset:0
v_mfma_f32_16x16x32_bf16 v[136:139], v[112:115], v[100:103], v[136:139]
ds_read_b64_tr_b16 v[50:51], v226 offset:2048
ds_read_b64_tr_b16 v[52:53], v227 offset:0
v_mfma_f32_16x16x32_bf16 v[144:147], v[112:115], v[104:107], v[144:147]
ds_read_b64_tr_b16 v[54:55], v227 offset:2048
ds_read_b128 v[36:39], v17 offset:50176
v_mfma_f32_16x16x32_bf16 v[152:155], v[112:115], v[108:111], v[152:155]
ds_read_b128 v[40:43], v17 offset:51200
ds_read_b128 v[44:47], v17 offset:52224
v_mfma_f32_16x16x32_bf16 v[156:159], v[116:119], v[108:111], v[156:159]
ds_read_b128 v[64:67], v17 offset:57344
v_mfma_f32_16x16x32_bf16 v[148:151], v[116:119], v[104:107], v[148:151]
ds_read_b64_tr_b16 v[80:81], v226 offset:4096
v_mfma_f32_16x16x32_bf16 v[140:143], v[116:119], v[100:103], v[140:143]
ds_read_b64_tr_b16 v[82:83], v226 offset:6144
v_mfma_f32_16x16x32_bf16 v[132:135], v[116:119], v[96:99], v[132:135]
ds_read_b64_tr_b16 v[84:85], v227 offset:4096
v_mfma_f32_16x16x32_bf16 v[128:131], v[208:211], v[192:195], v[128:131]
ds_read_b64_tr_b16 v[86:87], v227 offset:6144
v_mfma_f32_16x16x32_bf16 v[136:139], v[208:211], v[196:199], v[136:139]
ds_read_b128 v[68:71], v17 offset:58368
v_mfma_f32_16x16x32_bf16 v[144:147], v[208:211], v[200:203], v[144:147]
ds_read_b128 v[72:75], v17 offset:59392
v_mfma_f32_16x16x32_bf16 v[152:155], v[208:211], v[204:207], v[152:155]
ds_read_b128 v[76:79], v17 offset:60416
v_mfma_f32_16x16x32_bf16 v[156:159], v[212:215], v[204:207], v[156:159]
v_mfma_f32_16x16x32_bf16 v[148:151], v[212:215], v[200:203], v[148:151]
v_mfma_f32_16x16x32_bf16 v[140:143], v[212:215], v[196:199], v[140:143]
v_mfma_f32_16x16x32_bf16 v[132:135], v[212:215], v[192:195], v[132:135]
s_waitcnt lgkmcnt(0)
s_barrier
v_mfma_f32_16x16x32_bf16 v[128:131], v[48:51], v[32:35], v[128:131]
ds_read_b128 v[96:99], v18 offset:16384
ds_read_b64_tr_b16 v[112:113], v228 offset:16384
v_mfma_f32_16x16x32_bf16 v[136:139], v[48:51], v[36:39], v[136:139]
ds_read_b64_tr_b16 v[114:115], v228 offset:18432
ds_read_b64_tr_b16 v[116:117], v229 offset:16384
v_mfma_f32_16x16x32_bf16 v[144:147], v[48:51], v[40:43], v[144:147]
ds_read_b64_tr_b16 v[118:119], v229 offset:18432
ds_read_b128 v[100:103], v18 offset:17408
v_mfma_f32_16x16x32_bf16 v[152:155], v[48:51], v[44:47], v[152:155]
ds_read_b128 v[104:107], v18 offset:18432
ds_read_b128 v[108:111], v18 offset:19456
v_mfma_f32_16x16x32_bf16 v[156:159], v[52:55], v[44:47], v[156:159]
ds_read_b128 v[192:195], v18 offset:24576
v_mfma_f32_16x16x32_bf16 v[148:151], v[52:55], v[40:43], v[148:151]
ds_read_b64_tr_b16 v[208:209], v228 offset:20480
v_mfma_f32_16x16x32_bf16 v[140:143], v[52:55], v[36:39], v[140:143]
ds_read_b64_tr_b16 v[210:211], v228 offset:22528
v_mfma_f32_16x16x32_bf16 v[132:135], v[52:55], v[32:35], v[132:135]
ds_read_b64_tr_b16 v[212:213], v229 offset:20480
v_mfma_f32_16x16x32_bf16 v[128:131], v[80:83], v[64:67], v[128:131]
ds_read_b64_tr_b16 v[214:215], v229 offset:22528
v_mfma_f32_16x16x32_bf16 v[136:139], v[80:83], v[68:71], v[136:139]
ds_read_b128 v[196:199], v18 offset:25600
v_mfma_f32_16x16x32_bf16 v[144:147], v[80:83], v[72:75], v[144:147]
ds_read_b128 v[200:203], v18 offset:26624
v_mfma_f32_16x16x32_bf16 v[152:155], v[80:83], v[76:79], v[152:155]
ds_read_b128 v[204:207], v18 offset:27648
v_mfma_f32_16x16x32_bf16 v[156:159], v[84:87], v[76:79], v[156:159]
v_mfma_f32_16x16x32_bf16 v[148:151], v[84:87], v[72:75], v[148:151]
v_mfma_f32_16x16x32_bf16 v[140:143], v[84:87], v[68:71], v[140:143]
v_mfma_f32_16x16x32_bf16 v[132:135], v[84:87], v[64:67], v[132:135]
s_waitcnt lgkmcnt(0)
s_barrier
v_mfma_f32_16x16x32_bf16 v[128:131], v[112:115], v[96:99], v[128:131]
ds_read_b128 v[32:35], v18 offset:32768
ds_read_b64_tr_b16 v[48:49], v226 offset:49152
v_mfma_f32_16x16x32_bf16 v[136:139], v[112:115], v[100:103], v[136:139]
ds_read_b64_tr_b16 v[50:51], v226 offset:51200
ds_read_b64_tr_b16 v[52:53], v227 offset:49152
v_mfma_f32_16x16x32_bf16 v[144:147], v[112:115], v[104:107], v[144:147]
ds_read_b64_tr_b16 v[54:55], v227 offset:51200
ds_read_b128 v[36:39], v18 offset:33792
v_mfma_f32_16x16x32_bf16 v[152:155], v[112:115], v[108:111], v[152:155]
ds_read_b128 v[40:43], v18 offset:34816
ds_read_b128 v[44:47], v18 offset:35840
v_mfma_f32_16x16x32_bf16 v[156:159], v[116:119], v[108:111], v[156:159]
ds_read_b128 v[64:67], v18 offset:40960
v_mfma_f32_16x16x32_bf16 v[148:151], v[116:119], v[104:107], v[148:151]
ds_read_b64_tr_b16 v[80:81], v226 offset:53248
v_mfma_f32_16x16x32_bf16 v[140:143], v[116:119], v[100:103], v[140:143]
ds_read_b64_tr_b16 v[82:83], v226 offset:55296
v_mfma_f32_16x16x32_bf16 v[132:135], v[116:119], v[96:99], v[132:135]
ds_read_b64_tr_b16 v[84:85], v227 offset:53248
v_mfma_f32_16x16x32_bf16 v[128:131], v[208:211], v[192:195], v[128:131]
ds_read_b64_tr_b16 v[86:87], v227 offset:55296
v_mfma_f32_16x16x32_bf16 v[136:139], v[208:211], v[196:199], v[136:139]
ds_read_b128 v[68:71], v18 offset:41984
v_mfma_f32_16x16x32_bf16 v[144:147], v[208:211], v[200:203], v[144:147]
ds_read_b128 v[72:75], v18 offset:43008
v_mfma_f32_16x16x32_bf16 v[152:155], v[208:211], v[204:207], v[152:155]
ds_read_b128 v[76:79], v18 offset:44032
v_mfma_f32_16x16x32_bf16 v[156:159], v[212:215], v[204:207], v[156:159]
v_mfma_f32_16x16x32_bf16 v[148:151], v[212:215], v[200:203], v[148:151]
v_mfma_f32_16x16x32_bf16 v[140:143], v[212:215], v[196:199], v[140:143]
v_mfma_f32_16x16x32_bf16 v[132:135], v[212:215], v[192:195], v[132:135]
s_waitcnt lgkmcnt(0)
s_barrier
buffer_load_dwordx4 v[232:235], v2, s[84:87], s46 offen offset:0 sc1
buffer_load_dwordx4 v[236:239], v2, s[84:87], s46 offen offset:1024 sc1
buffer_load_dwordx4 v[240:243], v2, s[84:87], s46 offen offset:2048 sc1
buffer_load_dwordx4 v[244:247], v2, s[84:87], s46 offen offset:3072 sc1
v_mfma_f32_16x16x32_bf16 v[128:131], v[48:51], v[32:35], v[128:131]
ds_read_b128 v[96:99], v19 offset:0
ds_read_b64_tr_b16 v[112:113], v224 offset:0
v_mfma_f32_16x16x32_bf16 v[136:139], v[48:51], v[36:39], v[136:139]
ds_read_b64_tr_b16 v[114:115], v224 offset:2048
ds_read_b64_tr_b16 v[116:117], v225 offset:0
v_mfma_f32_16x16x32_bf16 v[144:147], v[48:51], v[40:43], v[144:147]
ds_read_b64_tr_b16 v[118:119], v225 offset:2048
ds_read_b128 v[100:103], v19 offset:1024
v_mfma_f32_16x16x32_bf16 v[152:155], v[48:51], v[44:47], v[152:155]
ds_read_b128 v[104:107], v19 offset:2048
ds_read_b128 v[108:111], v19 offset:3072
v_mfma_f32_16x16x32_bf16 v[156:159], v[52:55], v[44:47], v[156:159]
ds_read_b128 v[192:195], v19 offset:8192
v_mfma_f32_16x16x32_bf16 v[148:151], v[52:55], v[40:43], v[148:151]
ds_read_b64_tr_b16 v[208:209], v224 offset:4096
v_mfma_f32_16x16x32_bf16 v[140:143], v[52:55], v[36:39], v[140:143]
ds_read_b64_tr_b16 v[210:211], v224 offset:6144
v_mfma_f32_16x16x32_bf16 v[132:135], v[52:55], v[32:35], v[132:135]
ds_read_b64_tr_b16 v[212:213], v225 offset:4096
v_mfma_f32_16x16x32_bf16 v[128:131], v[80:83], v[64:67], v[128:131]
ds_read_b64_tr_b16 v[214:215], v225 offset:6144
v_mfma_f32_16x16x32_bf16 v[136:139], v[80:83], v[68:71], v[136:139]
ds_read_b128 v[196:199], v19 offset:9216
v_mfma_f32_16x16x32_bf16 v[144:147], v[80:83], v[72:75], v[144:147]
ds_read_b128 v[200:203], v19 offset:10240
v_mfma_f32_16x16x32_bf16 v[152:155], v[80:83], v[76:79], v[152:155]
ds_read_b128 v[204:207], v19 offset:11264
v_mfma_f32_16x16x32_bf16 v[156:159], v[84:87], v[76:79], v[156:159]
v_mfma_f32_16x16x32_bf16 v[148:151], v[84:87], v[72:75], v[148:151]
v_mfma_f32_16x16x32_bf16 v[140:143], v[84:87], v[68:71], v[140:143]
v_mfma_f32_16x16x32_bf16 v[132:135], v[84:87], v[64:67], v[132:135]
s_waitcnt lgkmcnt(0)
s_barrier
v_mfma_f32_16x16x32_bf16 v[128:131], v[112:115], v[96:99], v[128:131]
ds_read_b128 v[32:35], v17 offset:16384
ds_read_b64_tr_b16 v[48:49], v224 offset:32768
v_mfma_f32_16x16x32_bf16 v[136:139], v[112:115], v[100:103], v[136:139]
ds_read_b64_tr_b16 v[50:51], v224 offset:34816
ds_read_b64_tr_b16 v[52:53], v225 offset:32768
v_mfma_f32_16x16x32_bf16 v[144:147], v[112:115], v[104:107], v[144:147]
ds_read_b64_tr_b16 v[54:55], v225 offset:34816
ds_read_b128 v[36:39], v17 offset:17408
v_mfma_f32_16x16x32_bf16 v[152:155], v[112:115], v[108:111], v[152:155]
ds_read_b128 v[40:43], v17 offset:18432
ds_read_b128 v[44:47], v17 offset:19456
v_mfma_f32_16x16x32_bf16 v[156:159], v[116:119], v[108:111], v[156:159]
ds_read_b128 v[64:67], v17 offset:24576
v_mfma_f32_16x16x32_bf16 v[148:151], v[116:119], v[104:107], v[148:151]
ds_read_b64_tr_b16 v[80:81], v224 offset:36864
v_mfma_f32_16x16x32_bf16 v[140:143], v[116:119], v[100:103], v[140:143]
ds_read_b64_tr_b16 v[82:83], v224 offset:38912
v_mfma_f32_16x16x32_bf16 v[132:135], v[116:119], v[96:99], v[132:135]
ds_read_b64_tr_b16 v[84:85], v225 offset:36864
v_mfma_f32_16x16x32_bf16 v[128:131], v[208:211], v[192:195], v[128:131]
ds_read_b64_tr_b16 v[86:87], v225 offset:38912
v_mfma_f32_16x16x32_bf16 v[136:139], v[208:211], v[196:199], v[136:139]
ds_read_b128 v[68:71], v17 offset:25600
v_mfma_f32_16x16x32_bf16 v[144:147], v[208:211], v[200:203], v[144:147]
ds_read_b128 v[72:75], v17 offset:26624
v_mfma_f32_16x16x32_bf16 v[152:155], v[208:211], v[204:207], v[152:155]
ds_read_b128 v[76:79], v17 offset:27648
v_mfma_f32_16x16x32_bf16 v[156:159], v[212:215], v[204:207], v[156:159]
v_mfma_f32_16x16x32_bf16 v[148:151], v[212:215], v[200:203], v[148:151]
v_mfma_f32_16x16x32_bf16 v[140:143], v[212:215], v[196:199], v[140:143]
v_mfma_f32_16x16x32_bf16 v[132:135], v[212:215], v[192:195], v[132:135]
s_waitcnt lgkmcnt(0)
s_barrier
v_mfma_f32_16x16x32_bf16 v[128:131], v[48:51], v[32:35], v[128:131]
ds_read_b128 v[96:99], v17 offset:49152
ds_read_b64_tr_b16 v[112:113], v226 offset:0
v_mfma_f32_16x16x32_bf16 v[136:139], v[48:51], v[36:39], v[136:139]
ds_read_b64_tr_b16 v[114:115], v226 offset:2048
ds_read_b64_tr_b16 v[116:117], v227 offset:0
v_mfma_f32_16x16x32_bf16 v[144:147], v[48:51], v[40:43], v[144:147]
ds_read_b64_tr_b16 v[118:119], v227 offset:2048
ds_read_b128 v[100:103], v17 offset:50176
v_mfma_f32_16x16x32_bf16 v[152:155], v[48:51], v[44:47], v[152:155]
ds_read_b128 v[104:107], v17 offset:51200
ds_read_b128 v[108:111], v17 offset:52224
v_mfma_f32_16x16x32_bf16 v[156:159], v[52:55], v[44:47], v[156:159]
ds_read_b128 v[192:195], v17 offset:57344
v_mfma_f32_16x16x32_bf16 v[148:151], v[52:55], v[40:43], v[148:151]
ds_read_b64_tr_b16 v[208:209], v226 offset:4096
v_mfma_f32_16x16x32_bf16 v[140:143], v[52:55], v[36:39], v[140:143]
ds_read_b64_tr_b16 v[210:211], v226 offset:6144
v_mfma_f32_16x16x32_bf16 v[132:135], v[52:55], v[32:35], v[132:135]
ds_read_b64_tr_b16 v[212:213], v227 offset:4096
v_mfma_f32_16x16x32_bf16 v[128:131], v[80:83], v[64:67], v[128:131]
ds_read_b64_tr_b16 v[214:215], v227 offset:6144
v_mfma_f32_16x16x32_bf16 v[136:139], v[80:83], v[68:71], v[136:139]
ds_read_b128 v[196:199], v17 offset:58368
v_mfma_f32_16x16x32_bf16 v[144:147], v[80:83], v[72:75], v[144:147]
ds_read_b128 v[200:203], v17 offset:59392
v_mfma_f32_16x16x32_bf16 v[152:155], v[80:83], v[76:79], v[152:155]
ds_read_b128 v[204:207], v17 offset:60416
v_mfma_f32_16x16x32_bf16 v[156:159], v[84:87], v[76:79], v[156:159]
v_mfma_f32_16x16x32_bf16 v[148:151], v[84:87], v[72:75], v[148:151]
v_mfma_f32_16x16x32_bf16 v[140:143], v[84:87], v[68:71], v[140:143]
v_mfma_f32_16x16x32_bf16 v[132:135], v[84:87], v[64:67], v[132:135]
s_waitcnt vmcnt(0)
s_waitcnt lgkmcnt(0)
s_barrier
v_mfma_f32_16x16x32_bf16 v[128:131], v[112:115], v[96:99], v[128:131]
v_lshlrev_b32 v160, 16, v232
v_and_b32 v161, 0xffff0000, v232
v_lshlrev_b32 v162, 16, v233
v_and_b32 v163, 0xffff0000, v233
v_mfma_f32_16x16x32_bf16 v[132:135], v[116:119], v[96:99], v[132:135]
v_lshlrev_b32 v164, 16, v234
v_and_b32 v165, 0xffff0000, v234
v_lshlrev_b32 v166, 16, v235
v_and_b32 v167, 0xffff0000, v235
v_mfma_f32_16x16x32_bf16 v[128:131], v[208:211], v[192:195], v[128:131]
v_lshlrev_b32 v168, 16, v236
v_and_b32 v169, 0xffff0000, v236
v_lshlrev_b32 v170, 16, v237
v_and_b32 v171, 0xffff0000, v237
v_mfma_f32_16x16x32_bf16 v[132:135], v[212:215], v[192:195], v[132:135]
v_lshlrev_b32 v172, 16, v238
v_and_b32 v173, 0xffff0000, v238
v_lshlrev_b32 v174, 16, v239
v_and_b32 v175, 0xffff0000, v239
v_mfma_f32_16x16x32_bf16 v[136:139], v[112:115], v[100:103], v[136:139]
v_lshlrev_b32 v176, 16, v240
v_and_b32 v177, 0xffff0000, v240
v_lshlrev_b32 v178, 16, v241
v_and_b32 v179, 0xffff0000, v241
v_mfma_f32_16x16x32_bf16 v[140:143], v[116:119], v[100:103], v[140:143]
v_lshlrev_b32 v180, 16, v242
v_and_b32 v181, 0xffff0000, v242
v_lshlrev_b32 v182, 16, v243
v_and_b32 v183, 0xffff0000, v243
v_mfma_f32_16x16x32_bf16 v[136:139], v[208:211], v[196:199], v[136:139]
v_lshlrev_b32 v184, 16, v244
v_and_b32 v185, 0xffff0000, v244
v_lshlrev_b32 v186, 16, v245
v_and_b32 v187, 0xffff0000, v245
v_mfma_f32_16x16x32_bf16 v[140:143], v[212:215], v[196:199], v[140:143]
v_lshlrev_b32 v188, 16, v246
v_and_b32 v189, 0xffff0000, v246
v_lshlrev_b32 v190, 16, v247
v_and_b32 v191, 0xffff0000, v247
v_mfma_f32_16x16x32_bf16 v[144:147], v[112:115], v[104:107], v[144:147]
v_add_f32 v128, v128, v160
v_add_f32 v129, v129, v161
v_add_f32 v130, v130, v162
v_mfma_f32_16x16x32_bf16 v[148:151], v[116:119], v[104:107], v[148:151]
v_add_f32 v131, v131, v163
v_add_f32 v132, v132, v164
v_add_f32 v133, v133, v165
v_mfma_f32_16x16x32_bf16 v[144:147], v[208:211], v[200:203], v[144:147]
v_add_f32 v134, v134, v166
v_add_f32 v135, v135, v167
v_cvt_pk_bf16_f32 v232, v128, v129
v_mfma_f32_16x16x32_bf16 v[148:151], v[212:215], v[200:203], v[148:151]
v_cvt_pk_bf16_f32 v233, v130, v131
v_cvt_pk_bf16_f32 v234, v132, v133
v_cvt_pk_bf16_f32 v235, v134, v135
v_mfma_f32_16x16x32_bf16 v[152:155], v[112:115], v[108:111], v[152:155]
v_add_f32 v136, v136, v168
v_add_f32 v137, v137, v169
v_add_f32 v138, v138, v170
v_mfma_f32_16x16x32_bf16 v[156:159], v[116:119], v[108:111], v[156:159]
v_add_f32 v139, v139, v171
v_add_f32 v140, v140, v172
v_add_f32 v141, v141, v173
v_add_f32 v142, v142, v174
v_mfma_f32_16x16x32_bf16 v[152:155], v[208:211], v[204:207], v[152:155]
v_add_f32 v143, v143, v175
v_cvt_pk_bf16_f32 v236, v136, v137
v_cvt_pk_bf16_f32 v237, v138, v139
v_cvt_pk_bf16_f32 v238, v140, v141
v_mfma_f32_16x16x32_bf16 v[156:159], v[212:215], v[204:207], v[156:159]
v_cvt_pk_bf16_f32 v239, v142, v143
v_permlane16_swap_b32 v232, v234
v_permlane16_swap_b32 v233, v235
buffer_store_dwordx4 v[232:235], v230, s[20:23], s54 offen offset:0 nt
v_permlane16_swap_b32 v236, v238
v_permlane16_swap_b32 v237, v239
buffer_store_dwordx4 v[236:239], v230, s[20:23], s54 offen offset:2048 nt
v_add_f32 v144, v144, v176
v_add_f32 v145, v145, v177
v_add_f32 v146, v146, v178
v_add_f32 v147, v147, v179
v_add_f32 v148, v148, v180
v_add_f32 v149, v149, v181
v_add_f32 v150, v150, v182
v_add_f32 v151, v151, v183
v_cvt_pk_bf16_f32 v240, v144, v145
s_branch Lov_13
.p2align 12
.fill 96, 4, 0xbf800000
Lst_13_0:
s_branch Lwr_173
Lst_13_1:
s_branch Lst_17_0
s_nop 0
Lov_13:
v_cvt_pk_bf16_f32 v241, v146, v147
v_cvt_pk_bf16_f32 v242, v148, v149
v_cvt_pk_bf16_f32 v243, v150, v151
s_nop 0
v_add_f32 v152, v152, v184
v_add_f32 v153, v153, v185
v_add_f32 v154, v154, v186
v_add_f32 v155, v155, v187
v_add_f32 v156, v156, v188
v_add_f32 v157, v157, v189
v_add_f32 v158, v158, v190
v_add_f32 v159, v159, v191
v_cvt_pk_bf16_f32 v244, v152, v153
v_cvt_pk_bf16_f32 v245, v154, v155
v_cvt_pk_bf16_f32 v246, v156, v157
v_cvt_pk_bf16_f32 v247, v158, v159
v_permlane16_swap_b32 v240, v242
v_permlane16_swap_b32 v241, v243
buffer_store_dwordx4 v[240:243], v230, s[20:23], s55 offen offset:0 nt
v_permlane16_swap_b32 v244, v246
v_permlane16_swap_b32 v245, v247
buffer_store_dwordx4 v[244:247], v230, s[20:23], s55 offen offset:2048 nt
s_branch Ldone_1
Lgb_112:
s_mul_i32 s43, s34, 262144
s_add_u32 s8, s82, s43
s_addc_u32 s9, s83, 0
s_add_u32 s8, s8, 4194304
s_addc_u32 s9, s9, 0
s_mov_b32 s10, 262144
s_mov_b32 s11, 0x20000
s_lshl_b32 s39, s36, 12
v_lshlrev_b32 v2, 4, v1
v_add_u32 v3, s39, v2
s_add_u32 s37, s35, 0
s_and_b32 s37, s37, 15
s_mul_i32 s37, s37, 16384
s_add_u32 m0, s39, 0
s_nop 0
buffer_load_dwordx4 v3, s[8:11], s37 offen sc1 lds
buffer_load_dwordx4 v3, s[8:11], s37 offen offset:1024 sc1 lds
buffer_load_dwordx4 v3, s[8:11], s37 offen offset:2048 sc1 lds
buffer_load_dwordx4 v3, s[8:11], s37 offen offset:3072 sc1 lds
s_mul_i32 s43, s34, 262144
s_add_u32 s8, s82, s43
s_addc_u32 s9, s83, 0
s_add_u32 s8, s8, 4194304
s_addc_u32 s9, s9, 0
s_mov_b32 s10, 262144
s_mov_b32 s11, 0x20000
s_mul_i32 s43, s34, 917504
s_add_u32 s24, s82, s43
s_addc_u32 s25, s83, 0
s_add_u32 s24, s24, 8388608
s_addc_u32 s25, s25, 0
s_mov_b32 s26, 917504
s_mov_b32 s27, 0x20000
s_add_u32 s84, s82, 27262976
s_addc_u32 s85, s83, 0
s_mov_b32 s86, 229376
s_mov_b32 s87, 0x20000
s_and_b32 s47, s36, 3
s_lshr_b32 s62, s47, 1
s_and_b32 s63, s47, 1
v_lshlrev_b32 v2, 4, v1
s_lshl_b32 s39, s47, 12
v_add_u32 v3, s39, v2
s_bitcmp0_b32 s36, 1
s_cselect_b32 s44, s72, s74
s_cselect_b32 s45, s73, s75
s_mul_i32 s43, s35, 256
s_add_u32 s12, s44, s43
s_addc_u32 s13, s45, 0
s_mov_b32 s14, 7333120
s_mov_b32 s15, 0x20000
s_and_b32 s43, s36, 1
s_mul_i32 s43, s43, 229376
v_lshrrev_b32 v28, 4, v1
v_lshlrev_b32 v29, 1, v28
v_and_b32 v4, 15, v1
v_xor_b32 v4, v4, v29
v_lshlrev_b32 v4, 4, v4
v_mul_u32_u24 v28, 7168, v28
v_add_u32 v4, v4, v28
v_add_u32 v4, s43, v4
v_xor_b32 v5, 128, v4
v_add_u32 v5, 28672, v5
s_and_b32 s43, s36, 3
s_mul_i32 s40, s43, 8192
s_add_u32 s40, s40, 16384
v_mov_b32 v6, v192
v_mov_b32 v7, v193
v_mov_b32 v8, v194
s_lshl_b32 s43, s62, 12
v_add_u32 v9, s43, v2
v_add_u32 v10, 98304, v9
v_mov_b32 v24, v195
s_mul_i32 s43, s34, 16384
s_add_u32 s20, s82, s43
s_addc_u32 s21, s83, 0
s_add_u32 s20, s20, 25165824
s_addc_u32 s21, s21, 0
s_mov_b32 s22, 16384
s_mov_b32 s23, 0x20000
s_add_u32 s38, s35, 2
s_and_b32 s38, s38, 15
s_mul_i32 s38, s38, 458752
s_add_u32 m0, s50, 98304
s_nop 0
buffer_load_dwordx4 v6, s[16:19], s38 offen lds
s_add_u32 m0, s50, 99328
s_nop 0
buffer_load_dwordx4 v7, s[16:19], s38 offen lds
s_add_u32 m0, s50, 100352
s_nop 0
buffer_load_dwordx4 v8, s[16:19], s38 offen lds
s_add_u32 m0, s50, 101376
s_add_u32 s38, s38, 114688
buffer_load_dwordx4 v6, s[16:19], s38 offen lds
s_add_u32 m0, s50, 102400
s_nop 0
buffer_load_dwordx4 v7, s[16:19], s38 offen lds
s_add_u32 m0, s50, 103424
s_nop 0
buffer_load_dwordx4 v8, s[16:19], s38 offen lds
s_cmp_eq_u32 s47, 1
s_cbranch_scc0 Lw_137
s_lshl_b32 s92, s34, 4
s_add_u32 s92, s92, s35
s_lshl_b32 s92, s92, 8
s_add_u32 s92, s92, 49280
s_add_u32 s92, s92, 28311552
s_mov_b32 s41, 0x40000
Lpoll_138:
s_load_dword s93, s[82:83], s92 glc
Lpchk_140:
s_waitcnt lgkmcnt(0)
s_cmp_eq_u32 s93, 16
s_cbranch_scc1 Lpok_139
s_sub_u32 s41, s41, 1
s_cmp_lg_u32 s41, 0
s_cbranch_scc1 Lpoll_138
Lpok_139:
Lw_137:
s_waitcnt vmcnt(0)
s_barrier
s_add_u32 s37, s35, 1
s_and_b32 s37, s37, 15
s_mul_i32 s37, s37, 16384
s_add_u32 m0, s39, 49152
s_nop 0
buffer_load_dwordx4 v3, s[8:11], s37 offen sc1 lds
buffer_load_dwordx4 v3, s[8:11], s37 offen offset:1024 sc1 lds
buffer_load_dwordx4 v3, s[8:11], s37 offen offset:2048 sc1 lds
buffer_load_dwordx4 v3, s[8:11], s37 offen offset:3072 sc1 lds
s_add_u32 s37, s35, 2
s_and_b32 s37, s37, 15
s_mul_i32 s37, s37, 16384
s_add_u32 m0, s39, 98304
s_nop 0
buffer_load_dwordx4 v3, s[8:11], s37 offen sc1 lds
buffer_load_dwordx4 v3, s[8:11], s37 offen offset:1024 sc1 lds
buffer_load_dwordx4 v3, s[8:11], s37 offen offset:2048 sc1 lds
buffer_load_dwordx4 v3, s[8:11], s37 offen offset:3072 sc1 lds
buffer_load_dwordx4 v[96:99], v3, s[20:23], 0 offen offset:0 sc1
buffer_load_dwordx4 v[100:103], v3, s[20:23], 0 offen offset:1024 sc1
buffer_load_dwordx4 v[104:107], v3, s[20:23], 0 offen offset:2048 sc1
buffer_load_dwordx4 v[108:111], v3, s[20:23], 0 offen offset:3072 sc1
s_and_b32 s44, s36, 3
s_mul_i32 s44, s44, 11
s_bfe_u32 s43, s2, 0x30001
s_lshl_b32 s43, s43, 7
s_add_u32 s44, s44, s43
s_add_u32 s44, s44, 84
s_mul_i32 s44, s44, 7168
s_lshr_b32 s43, s2, 4
s_lshl_b32 s43, s43, 8
s_add_u32 s43, s43, s44
s_bitcmp0_b32 s2, 0
s_cselect_b32 s4, s72, s74
s_cselect_b32 s5, s73, s75
s_add_u32 s4, s4, s43
s_addc_u32 s5, s5, 0
s_waitcnt vmcnt(8)
s_barrier
s_cmp_eq_u32 s47, 3
s_cbranch_scc0 Lw_141
v_and_b32 v90, 31, v1
v_lshlrev_b32 v90, 4, v90
v_add_u32 v91, 151552, v90
ds_read_b128 v[112:115], v91 offset:0
ds_read_b128 v[116:119], v91 offset:512
ds_read_b128 v[120:123], v91 offset:1024
ds_read_b128 v[124:127], v91 offset:1536
s_and_b32 s44, s2, 15
s_mul_i32 s44, s44, 14336
s_lshr_b32 s43, s2, 4
s_lshl_b32 s43, s43, 9
s_add_u32 s44, s44, s43
s_add_u32 s44, s44, 8192
s_cmp_lt_u32 s2, 192
s_cselect_b32 s44, s44, 0x7fffffff
s_waitcnt lgkmcnt(0)
v_add_f32 v112, v112, v116
v_add_f32 v120, v120, v124
v_add_f32 v113, v113, v117
v_add_f32 v121, v121, v125
v_add_f32 v114, v114, v118
v_add_f32 v122, v122, v126
v_add_f32 v115, v115, v119
v_add_f32 v123, v123, v127
v_add_f32 v112, v112, v120
v_add_f32 v113, v113, v121
v_add_f32 v114, v114, v122
v_add_f32 v115, v115, v123
s_mov_b64 exec, 0xffffffff
buffer_store_dwordx4 v[112:115], v90, s[84:87], s44 offen sc1
s_mov_b64 exec, -1
Lw_141:
s_add_u32 s37, s35, 3
s_and_b32 s37, s37, 15
s_mul_i32 s37, s37, 16384
s_add_u32 m0, s39, 0
s_nop 0
buffer_load_dwordx4 v3, s[8:11], s37 offen sc1 lds
s_load_dword s3, s[4:5], 0
buffer_load_dwordx4 v3, s[8:11], s37 offen offset:1024 sc1 lds
s_load_dword s3, s[4:5], 64
buffer_load_dwordx4 v3, s[8:11], s37 offen offset:2048 sc1 lds
s_load_dword s3, s[4:5], 128
buffer_load_dwordx4 v3, s[8:11], s37 offen offset:3072 sc1 lds
s_load_dword s3, s[4:5], 192
s_load_dword s3, s[4:5], 7168
s_add_u32 s38, s35, 3
s_and_b32 s38, s38, 15
s_mul_i32 s38, s38, 458752
s_add_u32 m0, s50, 0
s_nop 0
buffer_load_dwordx4 v6, s[16:19], s38 offen lds
s_load_dword s3, s[4:5], 7232
s_add_u32 m0, s50, 1024
s_nop 0
buffer_load_dwordx4 v7, s[16:19], s38 offen lds
s_load_dword s3, s[4:5], 7296
s_add_u32 m0, s50, 2048
s_nop 0
buffer_load_dwordx4 v8, s[16:19], s38 offen lds
s_load_dword s3, s[4:5], 7360
s_add_u32 m0, s50, 3072
s_add_u32 s38, s38, 114688
buffer_load_dwordx4 v6, s[16:19], s38 offen lds
s_load_dword s3, s[4:5], 14336
s_load_dword s3, s[4:5], 14400
s_add_u32 m0, s50, 4096
s_nop 0
buffer_load_dwordx4 v7, s[16:19], s38 offen lds
s_add_u32 m0, s50, 5120
s_nop 0
buffer_load_dwordx4 v8, s[16:19], s38 offen lds
s_waitcnt vmcnt(14)
s_barrier
s_add_u32 s37, s35, 4
s_and_b32 s37, s37, 15
s_mul_i32 s37, s37, 16384
s_add_u32 m0, s39, 49152
s_nop 0
buffer_load_dwordx4 v3, s[8:11], s37 offen sc1 lds
s_load_dword s3, s[4:5], 14464
buffer_load_dwordx4 v3, s[8:11], s37 offen offset:1024 sc1 lds
s_load_dword s3, s[4:5], 14528
buffer_load_dwordx4 v3, s[8:11], s37 offen offset:2048 sc1 lds
s_load_dword s3, s[4:5], 21504
buffer_load_dwordx4 v3, s[8:11], s37 offen offset:3072 sc1 lds
s_load_dword s3, s[4:5], 21568
s_load_dword s3, s[4:5], 21632
s_add_u32 s38, s35, 4
s_and_b32 s38, s38, 15
s_mul_i32 s38, s38, 458752
s_add_u32 m0, s50, 49152
s_nop 0
buffer_load_dwordx4 v6, s[16:19], s38 offen lds
s_load_dword s3, s[4:5], 21696
s_add_u32 m0, s50, 50176
s_nop 0
buffer_load_dwordx4 v7, s[16:19], s38 offen lds
s_load_dword s3, s[4:5], 28672
s_add_u32 m0, s50, 51200
s_nop 0
buffer_load_dwordx4 v8, s[16:19], s38 offen lds
s_load_dword s3, s[4:5], 28736
s_add_u32 m0, s50, 52224
s_add_u32 s38, s38, 114688
buffer_load_dwordx4 v6, s[16:19], s38 offen lds
s_load_dword s3, s[4:5], 28800
s_load_dword s3, s[4:5], 28864
s_add_u32 m0, s50, 53248
s_nop 0
buffer_load_dwordx4 v7, s[16:19], s38 offen lds
s_add_u32 m0, s50, 54272
s_nop 0
buffer_load_dwordx4 v8, s[16:19], s38 offen lds
s_waitcnt vmcnt(10)
s_barrier
s_cmp_eq_u32 s47, 3
s_cbranch_scc0 Lw_142
s_cmp_lt_u32 s2, 192
s_cbranch_scc0 Lw_142
s_lshr_b32 s43, s2, 4
s_add_u32 s43, s43, 96
s_lshl_b32 s43, s43, 7
v_mov_b32 v90, s43
v_mov_b32 v91, 1
s_mov_b64 exec, 1
buffer_atomic_add v91, v90, s[56:59], 0 offen sc1
s_mov_b64 exec, -1
Lw_142:
s_add_u32 s37, s35, 5
s_and_b32 s37, s37, 15
s_mul_i32 s37, s37, 16384
s_add_u32 m0, s39, 98304
s_nop 0
buffer_load_dwordx4 v3, s[8:11], s37 offen sc1 lds
v_add_f32 v96, v96, v100
v_add_f32 v97, v97, v101
v_add_f32 v98, v98, v102
buffer_load_dwordx4 v3, s[8:11], s37 offen offset:1024 sc1 lds
v_add_f32 v99, v99, v103
v_add_f32 v104, v104, v108
v_add_f32 v105, v105, v109
buffer_load_dwordx4 v3, s[8:11], s37 offen offset:2048 sc1 lds
v_add_f32 v106, v106, v110
v_add_f32 v107, v107, v111
s_nop 0
buffer_load_dwordx4 v3, s[8:11], s37 offen offset:3072 sc1 lds
v_permlane32_swap_b32 v96, v104
v_permlane32_swap_b32 v97, v105
v_permlane32_swap_b32 v98, v106
v_permlane32_swap_b32 v99, v107
s_add_u32 s38, s35, 5
s_and_b32 s38, s38, 15
s_mul_i32 s38, s38, 458752
s_add_u32 m0, s50, 98304
s_nop 0
buffer_load_dwordx4 v6, s[16:19], s38 offen lds
v_add_f32 v96, v96, v104
v_add_f32 v97, v97, v105
v_add_f32 v98, v98, v106
s_add_u32 m0, s50, 99328
s_nop 0
buffer_load_dwordx4 v7, s[16:19], s38 offen lds
v_add_f32 v99, v99, v107
v_mov_b32 v100, v96
v_mov_b32 v101, v97
s_add_u32 m0, s50, 100352
s_nop 0
buffer_load_dwordx4 v8, s[16:19], s38 offen lds
v_mov_b32 v102, v98
v_mov_b32 v103, v99
s_nop 0
s_add_u32 m0, s50, 101376
s_add_u32 s38, s38, 114688
buffer_load_dwordx4 v6, s[16:19], s38 offen lds
v_permlane16_swap_b32 v96, v100
v_permlane16_swap_b32 v97, v101
v_permlane16_swap_b32 v98, v102
v_permlane16_swap_b32 v99, v103
s_add_u32 m0, s50, 102400
s_nop 0
buffer_load_dwordx4 v7, s[16:19], s38 offen lds
s_add_u32 m0, s50, 103424
s_nop 0
buffer_load_dwordx4 v8, s[16:19], s38 offen lds
s_waitcnt vmcnt(10)
s_barrier
s_add_u32 s37, s35, 6
s_and_b32 s37, s37, 15
s_mul_i32 s37, s37, 16384
s_add_u32 m0, s39, 0
s_nop 0
buffer_load_dwordx4 v3, s[8:11], s37 offen sc1 lds
v_add_f32 v96, v96, v100
v_add_f32 v97, v97, v101
v_add_f32 v98, v98, v102
buffer_load_dwordx4 v3, s[8:11], s37 offen offset:1024 sc1 lds
v_add_f32 v99, v99, v103
s_nop 0
v_add_f32_dpp v96, v96, v96 row_ror:8 row_mask:0xf bank_mask:0xf
buffer_load_dwordx4 v3, s[8:11], s37 offen offset:2048 sc1 lds
v_add_f32_dpp v97, v97, v97 row_ror:8 row_mask:0xf bank_mask:0xf
v_add_f32_dpp v98, v98, v98 row_ror:8 row_mask:0xf bank_mask:0xf
v_add_f32_dpp v99, v99, v99 row_ror:8 row_mask:0xf bank_mask:0xf
v_mul_f32 v96, 0x3a800000, v96
buffer_load_dwordx4 v3, s[8:11], s37 offen offset:3072 sc1 lds
v_mul_f32 v97, 0x3a800000, v97
v_mul_f32 v98, 0x3a800000, v98
v_mul_f32 v99, 0x3a800000, v99
s_add_u32 s38, s35, 6
s_and_b32 s38, s38, 15
s_mul_i32 s38, s38, 458752
s_add_u32 m0, s50, 0
s_nop 0
buffer_load_dwordx4 v6, s[16:19], s38 offen lds
v_fma_f32 v97, -v96, v96, v97
v_fma_f32 v99, -v98, v98, v99
v_max_f32 v97, 0, v97
s_add_u32 m0, s50, 1024
s_nop 0
buffer_load_dwordx4 v7, s[16:19], s38 offen lds
v_max_f32 v99, 0, v99
v_add_f32 v97, 0x3727c5ac, v97
v_add_f32 v99, 0x3727c5ac, v99
v_rsq_f32 v97, v97
s_add_u32 m0, s50, 2048
s_nop 0
buffer_load_dwordx4 v8, s[16:19], s38 offen lds
v_rsq_f32 v99, v99
v_and_b32 v100, 7, v1
s_lshl_b32 s43, s47, 8
s_add_u32 m0, s50, 3072
s_add_u32 s38, s38, 114688
buffer_load_dwordx4 v6, s[16:19], s38 offen lds
s_add_u32 s43, s43, 147456
v_lshl_add_u32 v100, v100, 4, s43
v_lshrrev_b32 v101, 5, v1
v_lshl_add_u32 v100, v101, 7, v100
s_add_u32 m0, s50, 4096
s_nop 0
buffer_load_dwordx4 v7, s[16:19], s38 offen lds
s_add_u32 m0, s50, 5120
s_nop 0
buffer_load_dwordx4 v8, s[16:19], s38 offen lds
s_waitcnt vmcnt(10)
s_barrier
ds_write_b128 v100, v[96:99]
s_waitcnt lgkmcnt(0)
s_add_u32 s37, s35, 7
s_and_b32 s37, s37, 15
s_mul_i32 s37, s37, 16384
s_add_u32 m0, s39, 49152
s_nop 0
buffer_load_dwordx4 v3, s[8:11], s37 offen sc1 lds
s_load_dword s3, s[4:5], 35840
buffer_load_dwordx4 v3, s[8:11], s37 offen offset:1024 sc1 lds
s_load_dword s3, s[4:5], 35904
buffer_load_dwordx4 v3, s[8:11], s37 offen offset:2048 sc1 lds
s_load_dword s3, s[4:5], 35968
s_load_dword s3, s[4:5], 36032
buffer_load_dwordx4 v3, s[8:11], s37 offen offset:3072 sc1 lds
s_load_dword s3, s[4:5], 43008
s_add_u32 s38, s35, 7
s_and_b32 s38, s38, 15
s_mul_i32 s38, s38, 458752
s_add_u32 m0, s50, 49152
s_nop 0
buffer_load_dwordx4 v6, s[16:19], s38 offen lds
s_load_dword s3, s[4:5], 43072
s_add_u32 m0, s50, 50176
s_nop 0
buffer_load_dwordx4 v7, s[16:19], s38 offen lds
s_load_dword s3, s[4:5], 43136
s_load_dword s3, s[4:5], 43200
s_add_u32 m0, s50, 51200
s_nop 0
buffer_load_dwordx4 v8, s[16:19], s38 offen lds
s_load_dword s3, s[4:5], 50176
s_add_u32 m0, s50, 52224
s_add_u32 s38, s38, 114688
buffer_load_dwordx4 v6, s[16:19], s38 offen lds
s_load_dword s3, s[4:5], 50240
s_load_dword s3, s[4:5], 50304
s_add_u32 m0, s50, 53248
s_nop 0
buffer_load_dwordx4 v7, s[16:19], s38 offen lds
s_add_u32 m0, s50, 54272
s_nop 0
buffer_load_dwordx4 v8, s[16:19], s38 offen lds
s_waitcnt vmcnt(10)
s_barrier
s_add_u32 s37, s35, 8
s_and_b32 s37, s37, 15
s_mul_i32 s37, s37, 16384
s_add_u32 m0, s39, 98304
s_nop 0
buffer_load_dwordx4 v3, s[8:11], s37 offen sc1 lds
s_load_dword s3, s[4:5], 50368
s_load_dword s3, s[4:5], 57344
s_load_dword s3, s[4:5], 57408
buffer_load_dwordx4 v3, s[8:11], s37 offen offset:1024 sc1 lds
s_load_dword s3, s[4:5], 57472
s_load_dword s3, s[4:5], 57536
s_load_dword s3, s[4:5], 64512
s_load_dword s3, s[4:5], 64576
buffer_load_dwordx4 v3, s[8:11], s37 offen offset:2048 sc1 lds
s_load_dword s3, s[4:5], 64640
s_load_dword s3, s[4:5], 64704
s_load_dword s3, s[4:5], 71680
s_load_dword s3, s[4:5], 71744
buffer_load_dwordx4 v3, s[8:11], s37 offen offset:3072 sc1 lds
v_lshrrev_b32 v28, 2, v1
v_and_b32 v29, 7, v28
v_mul_u32_u24 v28, 256, v28
v_lshl_add_u32 v28, v29, 5, v28
s_add_u32 s38, s35, 8
s_and_b32 s38, s38, 15
s_mul_i32 s38, s38, 458752
s_add_u32 m0, s50, 98304
s_nop 0
buffer_load_dwordx4 v6, s[16:19], s38 offen lds
v_and_b32 v29, 3, v1
v_lshl_add_u32 v11, v29, 3, v28
s_lshl_b32 s43, s63, 7
v_xor_b32 v11, s43, v11
s_add_u32 m0, s50, 99328
s_nop 0
buffer_load_dwordx4 v7, s[16:19], s38 offen lds
v_add_u32 v11, 16384, v11
v_xor_b32 v12, 32, v11
v_xor_b32 v13, 64, v11
v_xor_b32 v14, 96, v11
s_add_u32 m0, s50, 100352
s_nop 0
buffer_load_dwordx4 v8, s[16:19], s38 offen lds
v_add_u32 v15, 49152, v11
v_add_u32 v16, 49152, v12
v_add_u32 v17, 49152, v13
v_add_u32 v18, 49152, v14
s_add_u32 m0, s50, 101376
s_add_u32 s38, s38, 114688
buffer_load_dwordx4 v6, s[16:19], s38 offen lds
v_add_u32 v19, 98304, v11
v_add_u32 v20, 98304, v12
v_add_u32 v21, 98304, v13
v_add_u32 v22, 98304, v14
s_add_u32 m0, s50, 102400
s_nop 0
buffer_load_dwordx4 v7, s[16:19], s38 offen lds
s_add_u32 m0, s50, 103424
s_nop 0
buffer_load_dwordx4 v8, s[16:19], s38 offen lds
s_waitcnt vmcnt(10)
s_barrier
s_cmp_eq_u32 s47, 3
s_cbranch_scc0 Lw_143
s_mul_i32 s60, s35, 96
s_add_u32 s61, s60, 95
s_and_b32 s60, s60, 0xff80
s_and_b32 s61, s61, 0xff80
s_add_u32 s60, s60, 28323840
s_add_u32 s61, s61, 28323840
s_load_dword s92, s[82:83], s60 glc
s_load_dword s93, s[82:83], s61 glc
Lw_143:
s_add_u32 s37, s35, 9
s_and_b32 s37, s37, 15
s_mul_i32 s37, s37, 16384
s_add_u32 m0, s39, 0
s_nop 0
buffer_load_dwordx4 v3, s[8:11], s37 offen sc1 lds
buffer_load_dwordx4 v3, s[8:11], s37 offen offset:1024 sc1 lds
buffer_load_dwordx4 v3, s[8:11], s37 offen offset:2048 sc1 lds
buffer_load_dwordx4 v3, s[8:11], s37 offen offset:3072 sc1 lds
s_add_u32 s38, s35, 9
s_and_b32 s38, s38, 15
s_mul_i32 s38, s38, 458752
s_add_u32 m0, s50, 0
s_nop 0
buffer_load_dwordx4 v6, s[16:19], s38 offen lds
s_add_u32 m0, s50, 1024
s_nop 0
buffer_load_dwordx4 v7, s[16:19], s38 offen lds
s_add_u32 m0, s50, 2048
s_nop 0
buffer_load_dwordx4 v8, s[16:19], s38 offen lds
s_add_u32 m0, s50, 3072
s_add_u32 s38, s38, 114688
buffer_load_dwordx4 v6, s[16:19], s38 offen lds
s_add_u32 m0, s50, 4096
s_nop 0
buffer_load_dwordx4 v7, s[16:19], s38 offen lds
s_add_u32 m0, s50, 5120
s_nop 0
buffer_load_dwordx4 v8, s[16:19], s38 offen lds
s_waitcnt vmcnt(10)
s_barrier
s_add_u32 s37, s35, 10
s_and_b32 s37, s37, 15
s_mul_i32 s37, s37, 16384
s_add_u32 m0, s39, 49152
s_nop 0
buffer_load_dwordx4 v3, s[8:11], s37 offen sc1 lds
buffer_load_dwordx4 v3, s[8:11], s37 offen offset:1024 sc1 lds
buffer_load_dwordx4 v3, s[8:11], s37 offen offset:2048 sc1 lds
buffer_load_dwordx4 v3, s[8:11], s37 offen offset:3072 sc1 lds
s_add_u32 s38, s35, 10
s_and_b32 s38, s38, 15
s_mul_i32 s38, s38, 458752
s_add_u32 m0, s50, 49152
s_nop 0
buffer_load_dwordx4 v6, s[16:19], s38 offen lds
s_add_u32 m0, s50, 50176
s_nop 0
buffer_load_dwordx4 v7, s[16:19], s38 offen lds
s_add_u32 m0, s50, 51200
s_nop 0
buffer_load_dwordx4 v8, s[16:19], s38 offen lds
s_add_u32 m0, s50, 52224
s_add_u32 s38, s38, 114688
buffer_load_dwordx4 v6, s[16:19], s38 offen lds
s_branch Lov_14
.p2align 12
.fill 112, 4, 0xbf800000
Lst_14_0:
s_branch Lwr_174
Lst_14_1:
s_branch Lwr_186
s_nop 0
Lov_14:
s_add_u32 m0, s50, 53248
s_nop 0
buffer_load_dwordx4 v7, s[16:19], s38 offen lds
s_add_u32 m0, s50, 54272
s_nop 0
buffer_load_dwordx4 v8, s[16:19], s38 offen lds
s_mov_b32 s38, 0
buffer_load_dwordx4 v[40:43], v24, s[88:91], s38 offen
s_mov_b32 s38, 28672
buffer_load_dwordx4 v[44:47], v24, s[88:91], s38 offen
s_mov_b32 s38, 57344
buffer_load_dwordx4 v[48:51], v24, s[88:91], s38 offen
s_mov_b32 s38, 86016
buffer_load_dwordx4 v[52:55], v24, s[88:91], s38 offen
s_mov_b32 s38, 114688
buffer_load_dwordx4 v[56:59], v24, s[88:91], s38 offen
s_mov_b32 s38, 143360
buffer_load_dwordx4 v[60:63], v24, s[88:91], s38 offen
s_mov_b32 s38, 172032
buffer_load_dwordx4 v[64:67], v24, s[88:91], s38 offen
s_mov_b32 s38, 200704
buffer_load_dwordx4 v[68:71], v24, s[88:91], s38 offen
s_waitcnt vmcnt(18)
s_cmp_eq_u32 s47, 3
s_cbranch_scc0 Lw_144
s_mov_b32 s41, 0x40000
Lcp_145:
s_waitcnt lgkmcnt(0)
s_and_b32 s92, s92, s93
s_cmp_eq_u32 s92, 16
s_cbranch_scc1 Lco_146
s_load_dword s92, s[82:83], s60 glc
s_load_dword s93, s[82:83], s61 glc
s_sub_u32 s41, s41, 1
s_cmp_lg_u32 s41, 0
s_cbranch_scc1 Lcp_145
s_waitcnt lgkmcnt(0)
Lco_146:
Lw_144:
s_barrier
s_mov_b32 s45, s47
s_cmp_ge_u32 s45, 3
s_cselect_b32 s43, 1, 0
s_mul_i32 s44, s43, 3
s_sub_u32 s45, s45, s44
s_lshl_b32 s45, s45, 7
s_mul_i32 s52, s43, 896
s_add_u32 s52, s52, s45
s_add_u32 s52, s52, 148992
s_mul_i32 s43, s43, 14336
s_add_u32 s43, s43, s45
s_mul_i32 s44, s35, 384
s_add_u32 s43, s43, s44
s_add_u32 s60, s43, 8192
s_add_u32 s45, s47, 4
s_min_u32 s45, s45, 5
s_cmp_ge_u32 s45, 3
s_cselect_b32 s43, 1, 0
s_mul_i32 s44, s43, 3
s_sub_u32 s45, s45, s44
s_lshl_b32 s45, s45, 7
s_mul_i32 s53, s43, 896
s_add_u32 s53, s53, s45
s_add_u32 s53, s53, 148992
s_mul_i32 s43, s43, 14336
s_add_u32 s43, s43, s45
s_mul_i32 s44, s35, 384
s_add_u32 s43, s43, s44
s_add_u32 s61, s43, 8192
v_lshrrev_b32 v104, 3, v1
v_mul_u32_u24 v104, 28672, v104
v_and_b32 v105, 7, v1
v_lshl_add_u32 v104, v105, 4, v104
buffer_load_dwordx4 v[96:99], v104, s[84:87], s60 offen sc1
s_load_dword s3, s[4:5], 71808
s_load_dword s3, s[4:5], 71872
buffer_load_dwordx4 v[100:103], v104, s[84:87], s61 offen sc1
s_and_b32 s44, s36, 3
s_mul_i32 s43, s2, 28672
s_add_u32 s37, s35, 11
s_and_b32 s37, s37, 15
s_mul_i32 s37, s37, 16384
s_add_u32 m0, s39, 98304
s_nop 0
buffer_load_dwordx4 v3, s[8:11], s37 offen sc1 lds
s_mul_i32 s44, s44, 7168
s_add_u32 s43, s43, s44
buffer_load_dwordx4 v3, s[8:11], s37 offen offset:1024 sc1 lds
s_add_u32 s4, s76, s43
s_addc_u32 s5, s77, 0
s_load_dword s3, s[4:5], 0
buffer_load_dwordx4 v3, s[8:11], s37 offen offset:2048 sc1 lds
s_load_dword s3, s[4:5], 64
s_load_dword s3, s[4:5], 128
buffer_load_dwordx4 v3, s[8:11], s37 offen offset:3072 sc1 lds
s_load_dword s3, s[4:5], 192
s_load_dword s3, s[4:5], 256
s_add_u32 s38, s35, 11
s_and_b32 s38, s38, 15
s_mul_i32 s38, s38, 458752
s_add_u32 m0, s50, 98304
s_nop 0
buffer_load_dwordx4 v6, s[16:19], s38 offen lds
s_load_dword s3, s[4:5], 320
s_load_dword s3, s[4:5], 384
s_load_dword s3, s[4:5], 448
s_add_u32 m0, s50, 99328
s_nop 0
buffer_load_dwordx4 v7, s[16:19], s38 offen lds
v_cmp_gt_u32 vcc, 32, v1
v_mov_b32 v104, s52
s_add_u32 m0, s50, 100352
s_nop 0
buffer_load_dwordx4 v8, s[16:19], s38 offen lds
v_mov_b32 v106, s53
v_cndmask_b32 v104, v106, v104, vcc
s_add_u32 m0, s50, 101376
s_add_u32 s38, s38, 114688
buffer_load_dwordx4 v6, s[16:19], s38 offen lds
v_lshl_add_u32 v104, v105, 4, v104
v_bfe_u32 v105, v1, 4, 1
v_lshl_add_u32 v104, v105, 2, v104
s_add_u32 m0, s50, 102400
s_nop 0
buffer_load_dwordx4 v7, s[16:19], s38 offen lds
s_add_u32 m0, s50, 103424
s_nop 0
buffer_load_dwordx4 v8, s[16:19], s38 offen lds
s_waitcnt vmcnt(20)
s_barrier
s_add_u32 s37, s35, 12
s_and_b32 s37, s37, 15
s_mul_i32 s37, s37, 16384
s_add_u32 m0, s39, 0
s_nop 0
buffer_load_dwordx4 v3, s[8:11], s37 offen sc1 lds
buffer_load_dwordx4 v3, s[8:11], s37 offen offset:1024 sc1 lds
buffer_load_dwordx4 v3, s[8:11], s37 offen offset:2048 sc1 lds
buffer_load_dwordx4 v3, s[8:11], s37 offen offset:3072 sc1 lds
s_add_u32 s38, s35, 12
s_and_b32 s38, s38, 15
s_mul_i32 s38, s38, 458752
s_add_u32 m0, s50, 0
s_nop 0
buffer_load_dwordx4 v6, s[16:19], s38 offen lds
s_add_u32 m0, s50, 1024
s_nop 0
buffer_load_dwordx4 v7, s[16:19], s38 offen lds
s_add_u32 m0, s50, 2048
s_nop 0
buffer_load_dwordx4 v8, s[16:19], s38 offen lds
s_add_u32 m0, s50, 3072
s_add_u32 s38, s38, 114688
buffer_load_dwordx4 v6, s[16:19], s38 offen lds
s_add_u32 m0, s50, 4096
s_nop 0
buffer_load_dwordx4 v7, s[16:19], s38 offen lds
s_add_u32 m0, s50, 5120
s_nop 0
buffer_load_dwordx4 v8, s[16:19], s38 offen lds
s_waitcnt vmcnt(10)
s_barrier
v_permlane32_swap_b32 v96, v100
v_permlane32_swap_b32 v97, v101
v_permlane32_swap_b32 v98, v102
v_permlane32_swap_b32 v99, v103
v_add_f32 v96, v96, v100
v_add_f32 v97, v97, v101
v_add_f32 v98, v98, v102
v_add_f32 v99, v99, v103
s_nop 1
v_permlane16_swap_b32 v96, v97
v_permlane16_swap_b32 v98, v99
v_add_f32 v96, v96, v97
v_add_f32 v98, v98, v99
s_nop 1
v_add_f32_dpp v96, v96, v96 row_ror:8 row_mask:0xf bank_mask:0xf
v_add_f32_dpp v98, v98, v98 row_ror:8 row_mask:0xf bank_mask:0xf
ds_write_b32 v104, v96
ds_write_b32 v104, v98 offset:8
s_waitcnt lgkmcnt(0)
s_add_u32 s37, s35, 13
s_and_b32 s37, s37, 15
s_mul_i32 s37, s37, 16384
s_add_u32 m0, s39, 49152
s_nop 0
buffer_load_dwordx4 v3, s[8:11], s37 offen sc1 lds
s_load_dword s3, s[4:5], 512
s_load_dword s3, s[4:5], 576
s_load_dword s3, s[4:5], 640
s_load_dword s3, s[4:5], 704
s_load_dword s3, s[4:5], 768
buffer_load_dwordx4 v3, s[8:11], s37 offen offset:1024 sc1 lds
s_load_dword s3, s[4:5], 832
s_load_dword s3, s[4:5], 896
s_load_dword s3, s[4:5], 960
s_load_dword s3, s[4:5], 1024
s_load_dword s3, s[4:5], 1088
buffer_load_dwordx4 v3, s[8:11], s37 offen offset:2048 sc1 lds
v_lshlrev_b32 v72, 16, v40
v_and_b32 v73, 0xffff0000, v40
v_lshlrev_b32 v74, 16, v41
v_and_b32 v75, 0xffff0000, v41
v_lshlrev_b32 v76, 16, v42
v_and_b32 v77, 0xffff0000, v42
buffer_load_dwordx4 v3, s[8:11], s37 offen offset:3072 sc1 lds
v_lshlrev_b32 v78, 16, v43
v_and_b32 v79, 0xffff0000, v43
v_lshlrev_b32 v80, 16, v44
v_and_b32 v81, 0xffff0000, v44
v_lshlrev_b32 v82, 16, v45
s_add_u32 s38, s35, 13
s_and_b32 s38, s38, 15
s_mul_i32 s38, s38, 458752
s_add_u32 m0, s50, 49152
s_nop 0
buffer_load_dwordx4 v6, s[16:19], s38 offen lds
v_and_b32 v83, 0xffff0000, v45
v_lshlrev_b32 v84, 16, v46
v_and_b32 v85, 0xffff0000, v46
v_lshlrev_b32 v86, 16, v47
v_and_b32 v87, 0xffff0000, v47
s_add_u32 m0, s50, 50176
s_nop 0
buffer_load_dwordx4 v7, s[16:19], s38 offen lds
v_add_f32 v72, v72, v80
v_add_f32 v73, v73, v81
v_add_f32 v74, v74, v82
v_add_f32 v75, v75, v83
v_add_f32 v76, v76, v84
v_add_f32 v77, v77, v85
s_add_u32 m0, s50, 51200
s_nop 0
buffer_load_dwordx4 v8, s[16:19], s38 offen lds
v_add_f32 v78, v78, v86
v_add_f32 v79, v79, v87
v_lshlrev_b32 v80, 16, v48
v_and_b32 v81, 0xffff0000, v48
v_lshlrev_b32 v82, 16, v49
s_add_u32 m0, s50, 52224
s_add_u32 s38, s38, 114688
buffer_load_dwordx4 v6, s[16:19], s38 offen lds
v_and_b32 v83, 0xffff0000, v49
v_lshlrev_b32 v84, 16, v50
v_and_b32 v85, 0xffff0000, v50
v_lshlrev_b32 v86, 16, v51
v_and_b32 v87, 0xffff0000, v51
v_add_f32 v72, v72, v80
s_add_u32 m0, s50, 53248
s_nop 0
buffer_load_dwordx4 v7, s[16:19], s38 offen lds
s_add_u32 m0, s50, 54272
s_nop 0
buffer_load_dwordx4 v8, s[16:19], s38 offen lds
s_waitcnt vmcnt(10)
s_barrier
s_add_u32 s37, s35, 14
s_and_b32 s37, s37, 15
s_mul_i32 s37, s37, 16384
s_add_u32 m0, s39, 98304
s_nop 0
buffer_load_dwordx4 v3, s[8:11], s37 offen sc1 lds
s_load_dword s3, s[4:5], 1152
s_load_dword s3, s[4:5], 1216
s_load_dword s3, s[4:5], 1280
s_load_dword s3, s[4:5], 1344
s_load_dword s3, s[4:5], 1408
buffer_load_dwordx4 v3, s[8:11], s37 offen offset:1024 sc1 lds
s_load_dword s3, s[4:5], 1472
s_load_dword s3, s[4:5], 1536
s_load_dword s3, s[4:5], 1600
s_load_dword s3, s[4:5], 1664
s_load_dword s3, s[4:5], 1728
v_add_f32 v73, v73, v81
buffer_load_dwordx4 v3, s[8:11], s37 offen offset:2048 sc1 lds
v_add_f32 v74, v74, v82
v_add_f32 v75, v75, v83
v_add_f32 v76, v76, v84
v_add_f32 v77, v77, v85
v_add_f32 v78, v78, v86
buffer_load_dwordx4 v3, s[8:11], s37 offen offset:3072 sc1 lds
v_add_f32 v79, v79, v87
v_lshlrev_b32 v80, 16, v52
v_and_b32 v81, 0xffff0000, v52
v_lshlrev_b32 v82, 16, v53
v_and_b32 v83, 0xffff0000, v53
v_lshlrev_b32 v84, 16, v54
s_add_u32 s38, s35, 14
s_and_b32 s38, s38, 15
s_mul_i32 s38, s38, 458752
s_add_u32 m0, s50, 98304
s_nop 0
buffer_load_dwordx4 v6, s[16:19], s38 offen lds
v_and_b32 v85, 0xffff0000, v54
v_lshlrev_b32 v86, 16, v55
v_and_b32 v87, 0xffff0000, v55
v_add_f32 v72, v72, v80
v_add_f32 v73, v73, v81
s_add_u32 m0, s50, 99328
s_nop 0
buffer_load_dwordx4 v7, s[16:19], s38 offen lds
v_add_f32 v74, v74, v82
v_add_f32 v75, v75, v83
v_add_f32 v76, v76, v84
v_add_f32 v77, v77, v85
v_add_f32 v78, v78, v86
v_add_f32 v79, v79, v87
s_add_u32 m0, s50, 100352
s_nop 0
buffer_load_dwordx4 v8, s[16:19], s38 offen lds
v_lshlrev_b32 v80, 16, v56
v_and_b32 v81, 0xffff0000, v56
v_lshlrev_b32 v82, 16, v57
v_and_b32 v83, 0xffff0000, v57
v_lshlrev_b32 v84, 16, v58
s_add_u32 m0, s50, 101376
s_add_u32 s38, s38, 114688
buffer_load_dwordx4 v6, s[16:19], s38 offen lds
v_and_b32 v85, 0xffff0000, v58
v_lshlrev_b32 v86, 16, v59
v_and_b32 v87, 0xffff0000, v59
v_add_f32 v72, v72, v80
v_add_f32 v73, v73, v81
v_add_f32 v74, v74, v82
s_add_u32 m0, s50, 102400
s_nop 0
buffer_load_dwordx4 v7, s[16:19], s38 offen lds
s_add_u32 m0, s50, 103424
s_nop 0
buffer_load_dwordx4 v8, s[16:19], s38 offen lds
s_waitcnt vmcnt(10)
s_barrier
s_add_u32 s37, s35, 15
s_and_b32 s37, s37, 15
s_mul_i32 s37, s37, 16384
s_add_u32 m0, s39, 0
s_nop 0
buffer_load_dwordx4 v3, s[8:11], s37 offen sc1 lds
v_add_f32 v75, v75, v83
v_add_f32 v76, v76, v84
v_add_f32 v77, v77, v85
v_add_f32 v78, v78, v86
buffer_load_dwordx4 v3, s[8:11], s37 offen offset:1024 sc1 lds
v_add_f32 v79, v79, v87
v_lshlrev_b32 v80, 16, v60
v_and_b32 v81, 0xffff0000, v60
v_lshlrev_b32 v82, 16, v61
buffer_load_dwordx4 v3, s[8:11], s37 offen offset:2048 sc1 lds
v_and_b32 v83, 0xffff0000, v61
v_lshlrev_b32 v84, 16, v62
v_and_b32 v85, 0xffff0000, v62
v_lshlrev_b32 v86, 16, v63
buffer_load_dwordx4 v3, s[8:11], s37 offen offset:3072 sc1 lds
v_and_b32 v87, 0xffff0000, v63
v_add_f32 v72, v72, v80
v_add_f32 v73, v73, v81
v_add_f32 v74, v74, v82
s_add_u32 s38, s35, 15
s_and_b32 s38, s38, 15
s_mul_i32 s38, s38, 458752
s_add_u32 m0, s50, 0
s_nop 0
buffer_load_dwordx4 v6, s[16:19], s38 offen lds
v_add_f32 v75, v75, v83
v_add_f32 v76, v76, v84
v_add_f32 v77, v77, v85
v_add_f32 v78, v78, v86
s_add_u32 m0, s50, 1024
s_nop 0
buffer_load_dwordx4 v7, s[16:19], s38 offen lds
v_add_f32 v79, v79, v87
v_lshlrev_b32 v80, 16, v64
v_and_b32 v81, 0xffff0000, v64
v_lshlrev_b32 v82, 16, v65
s_add_u32 m0, s50, 2048
s_nop 0
buffer_load_dwordx4 v8, s[16:19], s38 offen lds
v_and_b32 v83, 0xffff0000, v65
v_lshlrev_b32 v84, 16, v66
v_and_b32 v85, 0xffff0000, v66
v_lshlrev_b32 v86, 16, v67
s_add_u32 m0, s50, 3072
s_add_u32 s38, s38, 114688
buffer_load_dwordx4 v6, s[16:19], s38 offen lds
v_and_b32 v87, 0xffff0000, v67
v_add_f32 v72, v72, v80
v_add_f32 v73, v73, v81
v_add_f32 v74, v74, v82
v_add_f32 v75, v75, v83
s_add_u32 m0, s50, 4096
s_nop 0
buffer_load_dwordx4 v7, s[16:19], s38 offen lds
s_add_u32 m0, s50, 5120
s_nop 0
buffer_load_dwordx4 v8, s[16:19], s38 offen lds
s_waitcnt vmcnt(10)
s_barrier
s_add_u32 s38, s35, 13
s_and_b32 s38, s38, 15
s_mul_i32 s38, s38, 458752
s_add_u32 m0, s40, 49152
s_nop 0
buffer_load_dwordx4 v4, s[12:15], s38 offen lds
v_add_f32 v76, v76, v84
v_add_f32 v77, v77, v85
v_add_f32 v78, v78, v86
v_add_f32 v79, v79, v87
v_lshlrev_b32 v80, 16, v68
s_add_u32 m0, s40, 50176
s_nop 0
buffer_load_dwordx4 v5, s[12:15], s38 offen lds
v_and_b32 v81, 0xffff0000, v68
v_lshlrev_b32 v82, 16, v69
v_and_b32 v83, 0xffff0000, v69
v_lshlrev_b32 v84, 16, v70
v_and_b32 v85, 0xffff0000, v70
v_lshlrev_b32 v86, 16, v71
s_add_u32 m0, s40, 51200
s_add_u32 s38, s38, 57344
buffer_load_dwordx4 v4, s[12:15], s38 offen lds
v_and_b32 v87, 0xffff0000, v71
v_add_f32 v72, v72, v80
v_add_f32 v73, v73, v81
v_add_f32 v74, v74, v82
v_add_f32 v75, v75, v83
v_add_f32 v76, v76, v84
s_add_u32 m0, s40, 52224
s_nop 0
buffer_load_dwordx4 v5, s[12:15], s38 offen lds
v_add_f32 v77, v77, v85
v_add_f32 v78, v78, v86
v_add_f32 v79, v79, v87
s_nop 0
v_permlane32_swap_b32 v72, v76
s_add_u32 m0, s40, 53248
s_add_u32 s38, s38, 57344
buffer_load_dwordx4 v4, s[12:15], s38 offen lds
v_permlane32_swap_b32 v73, v77
v_permlane32_swap_b32 v74, v78
v_permlane32_swap_b32 v75, v79
v_add_f32 v72, v72, v76
v_add_f32 v73, v73, v77
v_add_f32 v74, v74, v78
s_add_u32 m0, s40, 54272
s_nop 0
buffer_load_dwordx4 v5, s[12:15], s38 offen lds
v_add_f32 v75, v75, v79
s_nop 0
v_permlane16_swap_b32 v72, v74
v_permlane16_swap_b32 v73, v75
v_add_f32 v72, v72, v74
v_add_f32 v73, v73, v75
s_add_u32 m0, s40, 55296
s_add_u32 s38, s38, 57344
buffer_load_dwordx4 v4, s[12:15], s38 offen lds
s_add_u32 m0, s40, 56320
s_nop 0
buffer_load_dwordx4 v5, s[12:15], s38 offen lds
s_waitcnt vmcnt(8)
s_barrier
s_lshl_b32 s43, s47, 9
s_add_u32 s43, s43, 153600
v_and_b32 v80, 15, v1
v_lshl_add_u32 v80, v80, 5, s43
v_lshrrev_b32 v81, 4, v1
v_lshl_add_u32 v80, v81, 3, v80
ds_write_b64 v80, v[72:73]
s_waitcnt lgkmcnt(0)
s_add_u32 s38, s35, 14
s_and_b32 s38, s38, 15
s_mul_i32 s38, s38, 458752
s_add_u32 m0, s40, 98304
s_nop 0
buffer_load_dwordx4 v4, s[12:15], s38 offen lds
s_bfe_u32 s61, s35, 0x10002
s_lshr_b32 s60, s35, 3
s_lshl_b32 s60, s60, 2
s_and_b32 s43, s35, 3
s_add_u32 s60, s60, s43
s_add_u32 m0, s40, 99328
s_nop 0
buffer_load_dwordx4 v5, s[12:15], s38 offen lds
s_lshl_b32 s43, s60, 8
s_add_u32 s28, s76, s43
s_addc_u32 s29, s77, 0
s_mov_b32 s30, 7338240
s_mov_b32 s31, 0x20000
s_add_u32 m0, s40, 100352
s_add_u32 s38, s38, 57344
buffer_load_dwordx4 v4, s[12:15], s38 offen lds
s_mul_i32 s52, s61, 196608
s_mul_i32 s53, s61, 1572864
s_mul_i32 s90, s61, 163840
s_mul_i32 s91, s61, 1310720
s_and_b32 s43, s35, 3
s_add_u32 m0, s40, 101376
s_nop 0
buffer_load_dwordx4 v5, s[12:15], s38 offen lds
s_mul_i32 s32, s43, 3
s_mul_i32 s33, s43, 10
s_lshr_b32 s33, s33, 2
s_lshl_b32 s51, s47, 11
s_lshl_b32 s44, s47, 15
s_add_u32 m0, s40, 102400
s_add_u32 s38, s38, 57344
buffer_load_dwordx4 v4, s[12:15], s38 offen lds
v_lshrrev_b32 v122, 4, v1
v_lshlrev_b32 v123, 1, v122
v_and_b32 v23, 15, v1
v_xor_b32 v23, v23, v123
v_lshlrev_b32 v23, 4, v23
s_add_u32 m0, s40, 103424
s_nop 0
buffer_load_dwordx4 v5, s[12:15], s38 offen lds
v_mul_u32_u24 v122, 2048, v122
v_add_u32 v23, v23, v122
v_add_u32 v23, s44, v23
v_xor_b32 v24, 128, v23
v_add_u32 v24, 8192, v24
s_add_u32 m0, s40, 104448
s_add_u32 s38, s38, 57344
buffer_load_dwordx4 v4, s[12:15], s38 offen lds
s_add_u32 m0, s40, 105472
s_nop 0
buffer_load_dwordx4 v5, s[12:15], s38 offen lds
s_waitcnt vmcnt(8)
s_barrier
ds_read_b128 v[28:31], v9 offset:49152
ds_read_b64_tr_b16 v[44:45], v15 offset:0
ds_read_b64_tr_b16 v[46:47], v15 offset:4096
ds_read_b64_tr_b16 v[48:49], v16 offset:0
ds_read_b64_tr_b16 v[50:51], v16 offset:4096
ds_read_b64_tr_b16 v[52:53], v17 offset:0
ds_read_b64_tr_b16 v[54:55], v17 offset:4096
ds_read_b64_tr_b16 v[56:57], v18 offset:0
ds_read_b64_tr_b16 v[58:59], v18 offset:4096
ds_read_b64_tr_b16 v[60:61], v15 offset:16384
ds_read_b64_tr_b16 v[62:63], v15 offset:20480
ds_read_b64_tr_b16 v[64:65], v16 offset:16384
ds_read_b64_tr_b16 v[66:67], v16 offset:20480
ds_read_b64_tr_b16 v[68:69], v17 offset:16384
ds_read_b64_tr_b16 v[70:71], v17 offset:20480
ds_read_b64_tr_b16 v[72:73], v18 offset:16384
ds_read_b64_tr_b16 v[74:75], v18 offset:20480
ds_read_b128 v[32:35], v9 offset:50176
ds_read_b128 v[36:39], v9 offset:51200
ds_read_b128 v[40:43], v9 offset:52224
s_waitcnt lgkmcnt(0)
v_mfma_f32_16x16x32_bf16 v[124:127], v[44:47], v[28:31], 0
ds_read_b128 v[76:79], v9 offset:57344
v_mfma_f32_16x16x32_bf16 v[156:159], v[44:47], v[32:35], 0
ds_read_b64_tr_b16 v[92:93], v15 offset:8192
v_mfma_f32_16x16x32_bf16 v[188:191], v[44:47], v[36:39], 0
ds_read_b64_tr_b16 v[94:95], v15 offset:12288
v_mfma_f32_16x16x32_bf16 v[220:223], v[44:47], v[40:43], 0
ds_read_b64_tr_b16 v[96:97], v16 offset:8192
v_mfma_f32_16x16x32_bf16 v[224:227], v[48:51], v[40:43], 0
ds_read_b64_tr_b16 v[98:99], v16 offset:12288
v_mfma_f32_16x16x32_bf16 v[192:195], v[48:51], v[36:39], 0
ds_read_b64_tr_b16 v[100:101], v17 offset:8192
v_mfma_f32_16x16x32_bf16 v[160:163], v[48:51], v[32:35], 0
ds_read_b64_tr_b16 v[102:103], v17 offset:12288
v_mfma_f32_16x16x32_bf16 v[128:131], v[48:51], v[28:31], 0
ds_read_b64_tr_b16 v[104:105], v18 offset:8192
v_mfma_f32_16x16x32_bf16 v[132:135], v[52:55], v[28:31], 0
ds_read_b64_tr_b16 v[106:107], v18 offset:12288
v_mfma_f32_16x16x32_bf16 v[164:167], v[52:55], v[32:35], 0
ds_read_b64_tr_b16 v[108:109], v15 offset:24576
v_mfma_f32_16x16x32_bf16 v[196:199], v[52:55], v[36:39], 0
ds_read_b64_tr_b16 v[110:111], v15 offset:28672
v_mfma_f32_16x16x32_bf16 v[228:231], v[52:55], v[40:43], 0
ds_read_b64_tr_b16 v[112:113], v16 offset:24576
v_mfma_f32_16x16x32_bf16 v[232:235], v[56:59], v[40:43], 0
ds_read_b64_tr_b16 v[114:115], v16 offset:28672
v_mfma_f32_16x16x32_bf16 v[200:203], v[56:59], v[36:39], 0
ds_read_b64_tr_b16 v[116:117], v17 offset:24576
v_mfma_f32_16x16x32_bf16 v[168:171], v[56:59], v[32:35], 0
ds_read_b64_tr_b16 v[118:119], v17 offset:28672
v_mfma_f32_16x16x32_bf16 v[136:139], v[56:59], v[28:31], 0
ds_read_b64_tr_b16 v[120:121], v18 offset:24576
v_mfma_f32_16x16x32_bf16 v[140:143], v[60:63], v[28:31], 0
ds_read_b64_tr_b16 v[122:123], v18 offset:28672
v_mfma_f32_16x16x32_bf16 v[172:175], v[60:63], v[32:35], 0
ds_read_b128 v[80:83], v9 offset:58368
v_mfma_f32_16x16x32_bf16 v[204:207], v[60:63], v[36:39], 0
ds_read_b128 v[84:87], v9 offset:59392
v_mfma_f32_16x16x32_bf16 v[236:239], v[60:63], v[40:43], 0
ds_read_b128 v[88:91], v9 offset:60416
v_mfma_f32_16x16x32_bf16 v[240:243], v[64:67], v[40:43], 0
v_mfma_f32_16x16x32_bf16 v[208:211], v[64:67], v[36:39], 0
v_mfma_f32_16x16x32_bf16 v[176:179], v[64:67], v[32:35], 0
s_branch Lov_15
.p2align 12
.fill 112, 4, 0xbf800000
Lst_15_0:
s_branch Lwr_183
s_nop 0
s_nop 0
Lov_15:
v_mfma_f32_16x16x32_bf16 v[144:147], v[64:67], v[28:31], 0
v_mfma_f32_16x16x32_bf16 v[148:151], v[68:71], v[28:31], 0
v_mfma_f32_16x16x32_bf16 v[180:183], v[68:71], v[32:35], 0
v_mfma_f32_16x16x32_bf16 v[212:215], v[68:71], v[36:39], 0
v_mfma_f32_16x16x32_bf16 v[244:247], v[68:71], v[40:43], 0
v_mfma_f32_16x16x32_bf16 v[248:251], v[72:75], v[40:43], 0
v_mfma_f32_16x16x32_bf16 v[216:219], v[72:75], v[36:39], 0
v_mfma_f32_16x16x32_bf16 v[184:187], v[72:75], v[32:35], 0
v_mfma_f32_16x16x32_bf16 v[152:155], v[72:75], v[28:31], 0
s_waitcnt vmcnt(0)
s_waitcnt lgkmcnt(0)
s_barrier
v_mfma_f32_16x16x32_bf16 v[124:127], v[92:95], v[76:79], v[124:127]
ds_read_b128 v[28:31], v10 offset:0
v_mfma_f32_16x16x32_bf16 v[156:159], v[92:95], v[80:83], v[156:159]
ds_read_b64_tr_b16 v[44:45], v19 offset:0
v_mfma_f32_16x16x32_bf16 v[188:191], v[92:95], v[84:87], v[188:191]
ds_read_b64_tr_b16 v[46:47], v19 offset:4096
v_mfma_f32_16x16x32_bf16 v[220:223], v[92:95], v[88:91], v[220:223]
ds_read_b64_tr_b16 v[48:49], v20 offset:0
v_mfma_f32_16x16x32_bf16 v[224:227], v[96:99], v[88:91], v[224:227]
ds_read_b64_tr_b16 v[50:51], v20 offset:4096
v_mfma_f32_16x16x32_bf16 v[192:195], v[96:99], v[84:87], v[192:195]
ds_read_b64_tr_b16 v[52:53], v21 offset:0
v_mfma_f32_16x16x32_bf16 v[160:163], v[96:99], v[80:83], v[160:163]
ds_read_b64_tr_b16 v[54:55], v21 offset:4096
v_mfma_f32_16x16x32_bf16 v[128:131], v[96:99], v[76:79], v[128:131]
ds_read_b64_tr_b16 v[56:57], v22 offset:0
v_mfma_f32_16x16x32_bf16 v[132:135], v[100:103], v[76:79], v[132:135]
ds_read_b64_tr_b16 v[58:59], v22 offset:4096
v_mfma_f32_16x16x32_bf16 v[164:167], v[100:103], v[80:83], v[164:167]
ds_read_b64_tr_b16 v[60:61], v19 offset:16384
v_mfma_f32_16x16x32_bf16 v[196:199], v[100:103], v[84:87], v[196:199]
ds_read_b64_tr_b16 v[62:63], v19 offset:20480
v_mfma_f32_16x16x32_bf16 v[228:231], v[100:103], v[88:91], v[228:231]
ds_read_b64_tr_b16 v[64:65], v20 offset:16384
v_mfma_f32_16x16x32_bf16 v[232:235], v[104:107], v[88:91], v[232:235]
ds_read_b64_tr_b16 v[66:67], v20 offset:20480
v_mfma_f32_16x16x32_bf16 v[200:203], v[104:107], v[84:87], v[200:203]
ds_read_b64_tr_b16 v[68:69], v21 offset:16384
v_mfma_f32_16x16x32_bf16 v[168:171], v[104:107], v[80:83], v[168:171]
ds_read_b64_tr_b16 v[70:71], v21 offset:20480
v_mfma_f32_16x16x32_bf16 v[136:139], v[104:107], v[76:79], v[136:139]
ds_read_b64_tr_b16 v[72:73], v22 offset:16384
v_mfma_f32_16x16x32_bf16 v[140:143], v[108:111], v[76:79], v[140:143]
ds_read_b64_tr_b16 v[74:75], v22 offset:20480
v_mfma_f32_16x16x32_bf16 v[172:175], v[108:111], v[80:83], v[172:175]
ds_read_b128 v[32:35], v10 offset:1024
v_mfma_f32_16x16x32_bf16 v[204:207], v[108:111], v[84:87], v[204:207]
ds_read_b128 v[36:39], v10 offset:2048
v_mfma_f32_16x16x32_bf16 v[236:239], v[108:111], v[88:91], v[236:239]
ds_read_b128 v[40:43], v10 offset:3072
v_mfma_f32_16x16x32_bf16 v[240:243], v[112:115], v[88:91], v[240:243]
v_mfma_f32_16x16x32_bf16 v[208:211], v[112:115], v[84:87], v[208:211]
v_mfma_f32_16x16x32_bf16 v[176:179], v[112:115], v[80:83], v[176:179]
v_mfma_f32_16x16x32_bf16 v[144:147], v[112:115], v[76:79], v[144:147]
v_mfma_f32_16x16x32_bf16 v[148:151], v[116:119], v[76:79], v[148:151]
v_mfma_f32_16x16x32_bf16 v[180:183], v[116:119], v[80:83], v[180:183]
v_mfma_f32_16x16x32_bf16 v[212:215], v[116:119], v[84:87], v[212:215]
v_mfma_f32_16x16x32_bf16 v[244:247], v[116:119], v[88:91], v[244:247]
v_mfma_f32_16x16x32_bf16 v[248:251], v[120:123], v[88:91], v[248:251]
v_mfma_f32_16x16x32_bf16 v[216:219], v[120:123], v[84:87], v[216:219]
v_mfma_f32_16x16x32_bf16 v[184:187], v[120:123], v[80:83], v[184:187]
v_mfma_f32_16x16x32_bf16 v[152:155], v[120:123], v[76:79], v[152:155]
s_mov_b32 s41, 5
Lk3l_147:
s_waitcnt lgkmcnt(0)
v_mfma_f32_16x16x32_bf16 v[124:127], v[44:47], v[28:31], v[124:127]
ds_read_b128 v[76:79], v10 offset:8192
v_mfma_f32_16x16x32_bf16 v[156:159], v[44:47], v[32:35], v[156:159]
ds_read_b64_tr_b16 v[92:93], v19 offset:8192
v_mfma_f32_16x16x32_bf16 v[188:191], v[44:47], v[36:39], v[188:191]
ds_read_b64_tr_b16 v[94:95], v19 offset:12288
v_mfma_f32_16x16x32_bf16 v[220:223], v[44:47], v[40:43], v[220:223]
ds_read_b64_tr_b16 v[96:97], v20 offset:8192
v_mfma_f32_16x16x32_bf16 v[224:227], v[48:51], v[40:43], v[224:227]
ds_read_b64_tr_b16 v[98:99], v20 offset:12288
v_mfma_f32_16x16x32_bf16 v[192:195], v[48:51], v[36:39], v[192:195]
ds_read_b64_tr_b16 v[100:101], v21 offset:8192
v_mfma_f32_16x16x32_bf16 v[160:163], v[48:51], v[32:35], v[160:163]
ds_read_b64_tr_b16 v[102:103], v21 offset:12288
v_mfma_f32_16x16x32_bf16 v[128:131], v[48:51], v[28:31], v[128:131]
ds_read_b64_tr_b16 v[104:105], v22 offset:8192
v_mfma_f32_16x16x32_bf16 v[132:135], v[52:55], v[28:31], v[132:135]
ds_read_b64_tr_b16 v[106:107], v22 offset:12288
v_mfma_f32_16x16x32_bf16 v[164:167], v[52:55], v[32:35], v[164:167]
ds_read_b64_tr_b16 v[108:109], v19 offset:24576
v_mfma_f32_16x16x32_bf16 v[196:199], v[52:55], v[36:39], v[196:199]
ds_read_b64_tr_b16 v[110:111], v19 offset:28672
v_mfma_f32_16x16x32_bf16 v[228:231], v[52:55], v[40:43], v[228:231]
ds_read_b64_tr_b16 v[112:113], v20 offset:24576
v_mfma_f32_16x16x32_bf16 v[232:235], v[56:59], v[40:43], v[232:235]
ds_read_b64_tr_b16 v[114:115], v20 offset:28672
v_mfma_f32_16x16x32_bf16 v[200:203], v[56:59], v[36:39], v[200:203]
ds_read_b64_tr_b16 v[116:117], v21 offset:24576
v_mfma_f32_16x16x32_bf16 v[168:171], v[56:59], v[32:35], v[168:171]
ds_read_b64_tr_b16 v[118:119], v21 offset:28672
v_mfma_f32_16x16x32_bf16 v[136:139], v[56:59], v[28:31], v[136:139]
ds_read_b64_tr_b16 v[120:121], v22 offset:24576
v_mfma_f32_16x16x32_bf16 v[140:143], v[60:63], v[28:31], v[140:143]
ds_read_b64_tr_b16 v[122:123], v22 offset:28672
v_mfma_f32_16x16x32_bf16 v[172:175], v[60:63], v[32:35], v[172:175]
ds_read_b128 v[80:83], v10 offset:9216
v_mfma_f32_16x16x32_bf16 v[204:207], v[60:63], v[36:39], v[204:207]
ds_read_b128 v[84:87], v10 offset:10240
v_mfma_f32_16x16x32_bf16 v[236:239], v[60:63], v[40:43], v[236:239]
ds_read_b128 v[88:91], v10 offset:11264
v_mfma_f32_16x16x32_bf16 v[240:243], v[64:67], v[40:43], v[240:243]
v_mfma_f32_16x16x32_bf16 v[208:211], v[64:67], v[36:39], v[208:211]
v_mfma_f32_16x16x32_bf16 v[176:179], v[64:67], v[32:35], v[176:179]
v_mfma_f32_16x16x32_bf16 v[144:147], v[64:67], v[28:31], v[144:147]
v_mfma_f32_16x16x32_bf16 v[148:151], v[68:71], v[28:31], v[148:151]
v_mfma_f32_16x16x32_bf16 v[180:183], v[68:71], v[32:35], v[180:183]
v_mfma_f32_16x16x32_bf16 v[212:215], v[68:71], v[36:39], v[212:215]
v_mfma_f32_16x16x32_bf16 v[244:247], v[68:71], v[40:43], v[244:247]
v_mfma_f32_16x16x32_bf16 v[248:251], v[72:75], v[40:43], v[248:251]
v_mfma_f32_16x16x32_bf16 v[216:219], v[72:75], v[36:39], v[216:219]
v_mfma_f32_16x16x32_bf16 v[184:187], v[72:75], v[32:35], v[184:187]
v_mfma_f32_16x16x32_bf16 v[152:155], v[72:75], v[28:31], v[152:155]
s_waitcnt lgkmcnt(0)
s_barrier
v_mfma_f32_16x16x32_bf16 v[124:127], v[92:95], v[76:79], v[124:127]
ds_read_b128 v[28:31], v9 offset:0
v_mfma_f32_16x16x32_bf16 v[156:159], v[92:95], v[80:83], v[156:159]
ds_read_b64_tr_b16 v[44:45], v11 offset:0
v_mfma_f32_16x16x32_bf16 v[188:191], v[92:95], v[84:87], v[188:191]
ds_read_b64_tr_b16 v[46:47], v11 offset:4096
v_mfma_f32_16x16x32_bf16 v[220:223], v[92:95], v[88:91], v[220:223]
ds_read_b64_tr_b16 v[48:49], v12 offset:0
v_mfma_f32_16x16x32_bf16 v[224:227], v[96:99], v[88:91], v[224:227]
ds_read_b64_tr_b16 v[50:51], v12 offset:4096
v_mfma_f32_16x16x32_bf16 v[192:195], v[96:99], v[84:87], v[192:195]
ds_read_b64_tr_b16 v[52:53], v13 offset:0
v_mfma_f32_16x16x32_bf16 v[160:163], v[96:99], v[80:83], v[160:163]
ds_read_b64_tr_b16 v[54:55], v13 offset:4096
v_mfma_f32_16x16x32_bf16 v[128:131], v[96:99], v[76:79], v[128:131]
ds_read_b64_tr_b16 v[56:57], v14 offset:0
v_mfma_f32_16x16x32_bf16 v[132:135], v[100:103], v[76:79], v[132:135]
ds_read_b64_tr_b16 v[58:59], v14 offset:4096
v_mfma_f32_16x16x32_bf16 v[164:167], v[100:103], v[80:83], v[164:167]
ds_read_b64_tr_b16 v[60:61], v11 offset:16384
v_mfma_f32_16x16x32_bf16 v[196:199], v[100:103], v[84:87], v[196:199]
ds_read_b64_tr_b16 v[62:63], v11 offset:20480
v_mfma_f32_16x16x32_bf16 v[228:231], v[100:103], v[88:91], v[228:231]
ds_read_b64_tr_b16 v[64:65], v12 offset:16384
v_mfma_f32_16x16x32_bf16 v[232:235], v[104:107], v[88:91], v[232:235]
ds_read_b64_tr_b16 v[66:67], v12 offset:20480
v_mfma_f32_16x16x32_bf16 v[200:203], v[104:107], v[84:87], v[200:203]
ds_read_b64_tr_b16 v[68:69], v13 offset:16384
v_mfma_f32_16x16x32_bf16 v[168:171], v[104:107], v[80:83], v[168:171]
ds_read_b64_tr_b16 v[70:71], v13 offset:20480
v_mfma_f32_16x16x32_bf16 v[136:139], v[104:107], v[76:79], v[136:139]
ds_read_b64_tr_b16 v[72:73], v14 offset:16384
v_mfma_f32_16x16x32_bf16 v[140:143], v[108:111], v[76:79], v[140:143]
ds_read_b64_tr_b16 v[74:75], v14 offset:20480
v_mfma_f32_16x16x32_bf16 v[172:175], v[108:111], v[80:83], v[172:175]
ds_read_b128 v[32:35], v9 offset:1024
v_mfma_f32_16x16x32_bf16 v[204:207], v[108:111], v[84:87], v[204:207]
ds_read_b128 v[36:39], v9 offset:2048
v_mfma_f32_16x16x32_bf16 v[236:239], v[108:111], v[88:91], v[236:239]
ds_read_b128 v[40:43], v9 offset:3072
v_mfma_f32_16x16x32_bf16 v[240:243], v[112:115], v[88:91], v[240:243]
v_mfma_f32_16x16x32_bf16 v[208:211], v[112:115], v[84:87], v[208:211]
v_mfma_f32_16x16x32_bf16 v[176:179], v[112:115], v[80:83], v[176:179]
v_mfma_f32_16x16x32_bf16 v[144:147], v[112:115], v[76:79], v[144:147]
v_mfma_f32_16x16x32_bf16 v[148:151], v[116:119], v[76:79], v[148:151]
v_mfma_f32_16x16x32_bf16 v[180:183], v[116:119], v[80:83], v[180:183]
v_mfma_f32_16x16x32_bf16 v[212:215], v[116:119], v[84:87], v[212:215]
v_mfma_f32_16x16x32_bf16 v[244:247], v[116:119], v[88:91], v[244:247]
v_mfma_f32_16x16x32_bf16 v[248:251], v[120:123], v[88:91], v[248:251]
v_mfma_f32_16x16x32_bf16 v[216:219], v[120:123], v[84:87], v[216:219]
v_mfma_f32_16x16x32_bf16 v[184:187], v[120:123], v[80:83], v[184:187]
v_mfma_f32_16x16x32_bf16 v[152:155], v[120:123], v[76:79], v[152:155]
s_waitcnt lgkmcnt(0)
v_mfma_f32_16x16x32_bf16 v[124:127], v[44:47], v[28:31], v[124:127]
ds_read_b128 v[76:79], v9 offset:8192
v_mfma_f32_16x16x32_bf16 v[156:159], v[44:47], v[32:35], v[156:159]
ds_read_b64_tr_b16 v[92:93], v11 offset:8192
v_mfma_f32_16x16x32_bf16 v[188:191], v[44:47], v[36:39], v[188:191]
ds_read_b64_tr_b16 v[94:95], v11 offset:12288
v_mfma_f32_16x16x32_bf16 v[220:223], v[44:47], v[40:43], v[220:223]
ds_read_b64_tr_b16 v[96:97], v12 offset:8192
v_mfma_f32_16x16x32_bf16 v[224:227], v[48:51], v[40:43], v[224:227]
ds_read_b64_tr_b16 v[98:99], v12 offset:12288
v_mfma_f32_16x16x32_bf16 v[192:195], v[48:51], v[36:39], v[192:195]
ds_read_b64_tr_b16 v[100:101], v13 offset:8192
v_mfma_f32_16x16x32_bf16 v[160:163], v[48:51], v[32:35], v[160:163]
ds_read_b64_tr_b16 v[102:103], v13 offset:12288
v_mfma_f32_16x16x32_bf16 v[128:131], v[48:51], v[28:31], v[128:131]
ds_read_b64_tr_b16 v[104:105], v14 offset:8192
v_mfma_f32_16x16x32_bf16 v[132:135], v[52:55], v[28:31], v[132:135]
ds_read_b64_tr_b16 v[106:107], v14 offset:12288
v_mfma_f32_16x16x32_bf16 v[164:167], v[52:55], v[32:35], v[164:167]
ds_read_b64_tr_b16 v[108:109], v11 offset:24576
v_mfma_f32_16x16x32_bf16 v[196:199], v[52:55], v[36:39], v[196:199]
ds_read_b64_tr_b16 v[110:111], v11 offset:28672
v_mfma_f32_16x16x32_bf16 v[228:231], v[52:55], v[40:43], v[228:231]
ds_read_b64_tr_b16 v[112:113], v12 offset:24576
v_mfma_f32_16x16x32_bf16 v[232:235], v[56:59], v[40:43], v[232:235]
ds_read_b64_tr_b16 v[114:115], v12 offset:28672
v_mfma_f32_16x16x32_bf16 v[200:203], v[56:59], v[36:39], v[200:203]
ds_read_b64_tr_b16 v[116:117], v13 offset:24576
v_mfma_f32_16x16x32_bf16 v[168:171], v[56:59], v[32:35], v[168:171]
ds_read_b64_tr_b16 v[118:119], v13 offset:28672
v_mfma_f32_16x16x32_bf16 v[136:139], v[56:59], v[28:31], v[136:139]
ds_read_b64_tr_b16 v[120:121], v14 offset:24576
v_mfma_f32_16x16x32_bf16 v[140:143], v[60:63], v[28:31], v[140:143]
ds_read_b64_tr_b16 v[122:123], v14 offset:28672
v_mfma_f32_16x16x32_bf16 v[172:175], v[60:63], v[32:35], v[172:175]
ds_read_b128 v[80:83], v9 offset:9216
v_mfma_f32_16x16x32_bf16 v[204:207], v[60:63], v[36:39], v[204:207]
ds_read_b128 v[84:87], v9 offset:10240
v_mfma_f32_16x16x32_bf16 v[236:239], v[60:63], v[40:43], v[236:239]
ds_read_b128 v[88:91], v9 offset:11264
v_mfma_f32_16x16x32_bf16 v[240:243], v[64:67], v[40:43], v[240:243]
v_mfma_f32_16x16x32_bf16 v[208:211], v[64:67], v[36:39], v[208:211]
v_mfma_f32_16x16x32_bf16 v[176:179], v[64:67], v[32:35], v[176:179]
v_mfma_f32_16x16x32_bf16 v[144:147], v[64:67], v[28:31], v[144:147]
v_mfma_f32_16x16x32_bf16 v[148:151], v[68:71], v[28:31], v[148:151]
v_mfma_f32_16x16x32_bf16 v[180:183], v[68:71], v[32:35], v[180:183]
v_mfma_f32_16x16x32_bf16 v[212:215], v[68:71], v[36:39], v[212:215]
v_mfma_f32_16x16x32_bf16 v[244:247], v[68:71], v[40:43], v[244:247]
v_mfma_f32_16x16x32_bf16 v[248:251], v[72:75], v[40:43], v[248:251]
v_mfma_f32_16x16x32_bf16 v[216:219], v[72:75], v[36:39], v[216:219]
v_mfma_f32_16x16x32_bf16 v[184:187], v[72:75], v[32:35], v[184:187]
v_mfma_f32_16x16x32_bf16 v[152:155], v[72:75], v[28:31], v[152:155]
s_waitcnt lgkmcnt(0)
s_barrier
v_mfma_f32_16x16x32_bf16 v[124:127], v[92:95], v[76:79], v[124:127]
ds_read_b128 v[28:31], v9 offset:49152
v_mfma_f32_16x16x32_bf16 v[156:159], v[92:95], v[80:83], v[156:159]
ds_read_b64_tr_b16 v[44:45], v15 offset:0
v_mfma_f32_16x16x32_bf16 v[188:191], v[92:95], v[84:87], v[188:191]
ds_read_b64_tr_b16 v[46:47], v15 offset:4096
v_mfma_f32_16x16x32_bf16 v[220:223], v[92:95], v[88:91], v[220:223]
ds_read_b64_tr_b16 v[48:49], v16 offset:0
v_mfma_f32_16x16x32_bf16 v[224:227], v[96:99], v[88:91], v[224:227]
ds_read_b64_tr_b16 v[50:51], v16 offset:4096
v_mfma_f32_16x16x32_bf16 v[192:195], v[96:99], v[84:87], v[192:195]
ds_read_b64_tr_b16 v[52:53], v17 offset:0
v_mfma_f32_16x16x32_bf16 v[160:163], v[96:99], v[80:83], v[160:163]
ds_read_b64_tr_b16 v[54:55], v17 offset:4096
v_mfma_f32_16x16x32_bf16 v[128:131], v[96:99], v[76:79], v[128:131]
ds_read_b64_tr_b16 v[56:57], v18 offset:0
v_mfma_f32_16x16x32_bf16 v[132:135], v[100:103], v[76:79], v[132:135]
ds_read_b64_tr_b16 v[58:59], v18 offset:4096
v_mfma_f32_16x16x32_bf16 v[164:167], v[100:103], v[80:83], v[164:167]
ds_read_b64_tr_b16 v[60:61], v15 offset:16384
v_mfma_f32_16x16x32_bf16 v[196:199], v[100:103], v[84:87], v[196:199]
ds_read_b64_tr_b16 v[62:63], v15 offset:20480
v_mfma_f32_16x16x32_bf16 v[228:231], v[100:103], v[88:91], v[228:231]
ds_read_b64_tr_b16 v[64:65], v16 offset:16384
v_mfma_f32_16x16x32_bf16 v[232:235], v[104:107], v[88:91], v[232:235]
ds_read_b64_tr_b16 v[66:67], v16 offset:20480
v_mfma_f32_16x16x32_bf16 v[200:203], v[104:107], v[84:87], v[200:203]
ds_read_b64_tr_b16 v[68:69], v17 offset:16384
v_mfma_f32_16x16x32_bf16 v[168:171], v[104:107], v[80:83], v[168:171]
ds_read_b64_tr_b16 v[70:71], v17 offset:20480
v_mfma_f32_16x16x32_bf16 v[136:139], v[104:107], v[76:79], v[136:139]
ds_read_b64_tr_b16 v[72:73], v18 offset:16384
v_mfma_f32_16x16x32_bf16 v[140:143], v[108:111], v[76:79], v[140:143]
ds_read_b64_tr_b16 v[74:75], v18 offset:20480
v_mfma_f32_16x16x32_bf16 v[172:175], v[108:111], v[80:83], v[172:175]
ds_read_b128 v[32:35], v9 offset:50176
v_mfma_f32_16x16x32_bf16 v[204:207], v[108:111], v[84:87], v[204:207]
ds_read_b128 v[36:39], v9 offset:51200
v_mfma_f32_16x16x32_bf16 v[236:239], v[108:111], v[88:91], v[236:239]
ds_read_b128 v[40:43], v9 offset:52224
v_mfma_f32_16x16x32_bf16 v[240:243], v[112:115], v[88:91], v[240:243]
v_mfma_f32_16x16x32_bf16 v[208:211], v[112:115], v[84:87], v[208:211]
v_mfma_f32_16x16x32_bf16 v[176:179], v[112:115], v[80:83], v[176:179]
v_mfma_f32_16x16x32_bf16 v[144:147], v[112:115], v[76:79], v[144:147]
v_mfma_f32_16x16x32_bf16 v[148:151], v[116:119], v[76:79], v[148:151]
v_mfma_f32_16x16x32_bf16 v[180:183], v[116:119], v[80:83], v[180:183]
v_mfma_f32_16x16x32_bf16 v[212:215], v[116:119], v[84:87], v[212:215]
v_mfma_f32_16x16x32_bf16 v[244:247], v[116:119], v[88:91], v[244:247]
v_mfma_f32_16x16x32_bf16 v[248:251], v[120:123], v[88:91], v[248:251]
v_mfma_f32_16x16x32_bf16 v[216:219], v[120:123], v[84:87], v[216:219]
v_mfma_f32_16x16x32_bf16 v[184:187], v[120:123], v[80:83], v[184:187]
v_mfma_f32_16x16x32_bf16 v[152:155], v[120:123], v[76:79], v[152:155]
s_waitcnt lgkmcnt(0)
v_mfma_f32_16x16x32_bf16 v[124:127], v[44:47], v[28:31], v[124:127]
ds_read_b128 v[76:79], v9 offset:57344
v_mfma_f32_16x16x32_bf16 v[156:159], v[44:47], v[32:35], v[156:159]
ds_read_b64_tr_b16 v[92:93], v15 offset:8192
v_mfma_f32_16x16x32_bf16 v[188:191], v[44:47], v[36:39], v[188:191]
ds_read_b64_tr_b16 v[94:95], v15 offset:12288
v_mfma_f32_16x16x32_bf16 v[220:223], v[44:47], v[40:43], v[220:223]
ds_read_b64_tr_b16 v[96:97], v16 offset:8192
v_mfma_f32_16x16x32_bf16 v[224:227], v[48:51], v[40:43], v[224:227]
ds_read_b64_tr_b16 v[98:99], v16 offset:12288
v_mfma_f32_16x16x32_bf16 v[192:195], v[48:51], v[36:39], v[192:195]
ds_read_b64_tr_b16 v[100:101], v17 offset:8192
v_mfma_f32_16x16x32_bf16 v[160:163], v[48:51], v[32:35], v[160:163]
ds_read_b64_tr_b16 v[102:103], v17 offset:12288
v_mfma_f32_16x16x32_bf16 v[128:131], v[48:51], v[28:31], v[128:131]
ds_read_b64_tr_b16 v[104:105], v18 offset:8192
v_mfma_f32_16x16x32_bf16 v[132:135], v[52:55], v[28:31], v[132:135]
ds_read_b64_tr_b16 v[106:107], v18 offset:12288
v_mfma_f32_16x16x32_bf16 v[164:167], v[52:55], v[32:35], v[164:167]
ds_read_b64_tr_b16 v[108:109], v15 offset:24576
v_mfma_f32_16x16x32_bf16 v[196:199], v[52:55], v[36:39], v[196:199]
ds_read_b64_tr_b16 v[110:111], v15 offset:28672
v_mfma_f32_16x16x32_bf16 v[228:231], v[52:55], v[40:43], v[228:231]
ds_read_b64_tr_b16 v[112:113], v16 offset:24576
v_mfma_f32_16x16x32_bf16 v[232:235], v[56:59], v[40:43], v[232:235]
ds_read_b64_tr_b16 v[114:115], v16 offset:28672
v_mfma_f32_16x16x32_bf16 v[200:203], v[56:59], v[36:39], v[200:203]
ds_read_b64_tr_b16 v[116:117], v17 offset:24576
v_mfma_f32_16x16x32_bf16 v[168:171], v[56:59], v[32:35], v[168:171]
ds_read_b64_tr_b16 v[118:119], v17 offset:28672
v_mfma_f32_16x16x32_bf16 v[136:139], v[56:59], v[28:31], v[136:139]
ds_read_b64_tr_b16 v[120:121], v18 offset:24576
v_mfma_f32_16x16x32_bf16 v[140:143], v[60:63], v[28:31], v[140:143]
ds_read_b64_tr_b16 v[122:123], v18 offset:28672
v_mfma_f32_16x16x32_bf16 v[172:175], v[60:63], v[32:35], v[172:175]
ds_read_b128 v[80:83], v9 offset:58368
v_mfma_f32_16x16x32_bf16 v[204:207], v[60:63], v[36:39], v[204:207]
ds_read_b128 v[84:87], v9 offset:59392
v_mfma_f32_16x16x32_bf16 v[236:239], v[60:63], v[40:43], v[236:239]
ds_read_b128 v[88:91], v9 offset:60416
v_mfma_f32_16x16x32_bf16 v[240:243], v[64:67], v[40:43], v[240:243]
v_mfma_f32_16x16x32_bf16 v[208:211], v[64:67], v[36:39], v[208:211]
v_mfma_f32_16x16x32_bf16 v[176:179], v[64:67], v[32:35], v[176:179]
v_mfma_f32_16x16x32_bf16 v[144:147], v[64:67], v[28:31], v[144:147]
v_mfma_f32_16x16x32_bf16 v[148:151], v[68:71], v[28:31], v[148:151]
v_mfma_f32_16x16x32_bf16 v[180:183], v[68:71], v[32:35], v[180:183]
v_mfma_f32_16x16x32_bf16 v[212:215], v[68:71], v[36:39], v[212:215]
v_mfma_f32_16x16x32_bf16 v[244:247], v[68:71], v[40:43], v[244:247]
v_mfma_f32_16x16x32_bf16 v[248:251], v[72:75], v[40:43], v[248:251]
v_mfma_f32_16x16x32_bf16 v[216:219], v[72:75], v[36:39], v[216:219]
v_mfma_f32_16x16x32_bf16 v[184:187], v[72:75], v[32:35], v[184:187]
v_mfma_f32_16x16x32_bf16 v[152:155], v[72:75], v[28:31], v[152:155]
s_waitcnt lgkmcnt(0)
s_barrier
v_mfma_f32_16x16x32_bf16 v[124:127], v[92:95], v[76:79], v[124:127]
ds_read_b128 v[28:31], v10 offset:0
v_mfma_f32_16x16x32_bf16 v[156:159], v[92:95], v[80:83], v[156:159]
ds_read_b64_tr_b16 v[44:45], v19 offset:0
v_mfma_f32_16x16x32_bf16 v[188:191], v[92:95], v[84:87], v[188:191]
ds_read_b64_tr_b16 v[46:47], v19 offset:4096
v_mfma_f32_16x16x32_bf16 v[220:223], v[92:95], v[88:91], v[220:223]
ds_read_b64_tr_b16 v[48:49], v20 offset:0
v_mfma_f32_16x16x32_bf16 v[224:227], v[96:99], v[88:91], v[224:227]
ds_read_b64_tr_b16 v[50:51], v20 offset:4096
v_mfma_f32_16x16x32_bf16 v[192:195], v[96:99], v[84:87], v[192:195]
ds_read_b64_tr_b16 v[52:53], v21 offset:0
v_mfma_f32_16x16x32_bf16 v[160:163], v[96:99], v[80:83], v[160:163]
ds_read_b64_tr_b16 v[54:55], v21 offset:4096
v_mfma_f32_16x16x32_bf16 v[128:131], v[96:99], v[76:79], v[128:131]
ds_read_b64_tr_b16 v[56:57], v22 offset:0
v_mfma_f32_16x16x32_bf16 v[132:135], v[100:103], v[76:79], v[132:135]
ds_read_b64_tr_b16 v[58:59], v22 offset:4096
v_mfma_f32_16x16x32_bf16 v[164:167], v[100:103], v[80:83], v[164:167]
ds_read_b64_tr_b16 v[60:61], v19 offset:16384
v_mfma_f32_16x16x32_bf16 v[196:199], v[100:103], v[84:87], v[196:199]
ds_read_b64_tr_b16 v[62:63], v19 offset:20480
v_mfma_f32_16x16x32_bf16 v[228:231], v[100:103], v[88:91], v[228:231]
ds_read_b64_tr_b16 v[64:65], v20 offset:16384
v_mfma_f32_16x16x32_bf16 v[232:235], v[104:107], v[88:91], v[232:235]
ds_read_b64_tr_b16 v[66:67], v20 offset:20480
v_mfma_f32_16x16x32_bf16 v[200:203], v[104:107], v[84:87], v[200:203]
ds_read_b64_tr_b16 v[68:69], v21 offset:16384
v_mfma_f32_16x16x32_bf16 v[168:171], v[104:107], v[80:83], v[168:171]
ds_read_b64_tr_b16 v[70:71], v21 offset:20480
v_mfma_f32_16x16x32_bf16 v[136:139], v[104:107], v[76:79], v[136:139]
ds_read_b64_tr_b16 v[72:73], v22 offset:16384
v_mfma_f32_16x16x32_bf16 v[140:143], v[108:111], v[76:79], v[140:143]
ds_read_b64_tr_b16 v[74:75], v22 offset:20480
v_mfma_f32_16x16x32_bf16 v[172:175], v[108:111], v[80:83], v[172:175]
ds_read_b128 v[32:35], v10 offset:1024
v_mfma_f32_16x16x32_bf16 v[204:207], v[108:111], v[84:87], v[204:207]
ds_read_b128 v[36:39], v10 offset:2048
v_mfma_f32_16x16x32_bf16 v[236:239], v[108:111], v[88:91], v[236:239]
ds_read_b128 v[40:43], v10 offset:3072
v_mfma_f32_16x16x32_bf16 v[240:243], v[112:115], v[88:91], v[240:243]
v_mfma_f32_16x16x32_bf16 v[208:211], v[112:115], v[84:87], v[208:211]
v_mfma_f32_16x16x32_bf16 v[176:179], v[112:115], v[80:83], v[176:179]
v_mfma_f32_16x16x32_bf16 v[144:147], v[112:115], v[76:79], v[144:147]
v_mfma_f32_16x16x32_bf16 v[148:151], v[116:119], v[76:79], v[148:151]
v_mfma_f32_16x16x32_bf16 v[180:183], v[116:119], v[80:83], v[180:183]
v_mfma_f32_16x16x32_bf16 v[212:215], v[116:119], v[84:87], v[212:215]
v_mfma_f32_16x16x32_bf16 v[244:247], v[116:119], v[88:91], v[244:247]
v_mfma_f32_16x16x32_bf16 v[248:251], v[120:123], v[88:91], v[248:251]
v_mfma_f32_16x16x32_bf16 v[216:219], v[120:123], v[84:87], v[216:219]
v_mfma_f32_16x16x32_bf16 v[184:187], v[120:123], v[80:83], v[184:187]
v_mfma_f32_16x16x32_bf16 v[152:155], v[120:123], v[76:79], v[152:155]
s_sub_u32 s41, s41, 1
s_cmp_lg_u32 s41, 0
s_cbranch_scc1 Lk3l_147
s_waitcnt lgkmcnt(0)
v_lshrrev_b32 v84, 4, v1
s_lshl_b32 s43, s63, 8
s_add_u32 s43, s43, 148480
v_lshl_add_u32 v85, v84, 4, s43
v_and_b32 v84, 15, v1
s_lshl_b32 s43, s62, 9
s_add_u32 s43, s43, 147456
v_lshl_add_u32 v84, v84, 3, s43
ds_read_b128 v[28:31], v85 offset:0
ds_read_b128 v[32:35], v85 offset:64
ds_read_b128 v[36:39], v85 offset:128
ds_read_b128 v[40:43], v85 offset:192
ds_read_b128 v[44:47], v85 offset:896
ds_read_b128 v[48:51], v85 offset:960
ds_read_b128 v[52:55], v85 offset:1024
ds_read_b128 v[56:59], v85 offset:1088
ds_read_b64 v[60:61], v84 offset:0
ds_read_b64 v[62:63], v84 offset:128
ds_read_b64 v[64:65], v84 offset:256
ds_read_b64 v[66:67], v84 offset:384
s_lshl_b32 s54, s35, 15
s_lshl_b32 s43, s63, 14
s_add_u32 s54, s54, s43
s_lshl_b32 s43, s62, 12
s_add_u32 s54, s54, s43
s_add_u32 s55, s54, 8192
v_lshrrev_b32 v122, 3, v1
v_and_b32 v123, 6, v122
v_and_b32 v25, 7, v1
v_xor_b32 v25, v25, v123
v_lshlrev_b32 v25, 4, v25
v_mul_u32_u24 v122, 2048, v122
v_add_u32 v25, v25, v122
s_lshl_b32 s43, s61, 7
s_lshl_b32 s44, s47, 15
s_add_u32 s43, s43, s44
v_add_u32 v25, s43, v25
s_waitcnt lgkmcnt(0)
v_mul_f32 v70, v61, v61
v_mul_f32 v68, 0xc0135761, v61
v_mul_f32 v69, 0xbdd2d3e8, v61
v_mul_f32 v69, v69, v70
v_rcp_f32 v70, v70
v_mul_f32 v74, v63, v63
v_mul_f32 v72, 0xc0135761, v63
v_mul_f32 v73, 0xbdd2d3e8, v63
v_mul_f32 v73, v73, v74
v_rcp_f32 v74, v74
v_pk_fma_f32 v[124:125], v[60:61], v[28:29], v[124:125] op_sel_hi:[0,1,1] neg_lo:[1,0,0] neg_hi:[1,0,0]
v_pk_fma_f32 v[126:127], v[60:61], v[30:31], v[126:127] op_sel_hi:[0,1,1] neg_lo:[1,0,0] neg_hi:[1,0,0]
v_pk_fma_f32 v[156:157], v[62:63], v[28:29], v[156:157] op_sel_hi:[0,1,1] neg_lo:[1,0,0] neg_hi:[1,0,0]
v_pk_fma_f32 v[158:159], v[62:63], v[30:31], v[158:159] op_sel_hi:[0,1,1] neg_lo:[1,0,0] neg_hi:[1,0,0]
v_pk_mul_f32 v[76:77], v[124:125], v[124:125]
v_pk_mul_f32 v[78:79], v[126:127], v[126:127]
v_pk_mul_f32 v[80:81], v[156:157], v[156:157]
v_pk_mul_f32 v[82:83], v[158:159], v[158:159]
v_pk_fma_f32 v[76:77], v[76:77], v[68:69], v[68:69] op_sel:[0,1,0] op_sel_hi:[1,1,0]
v_pk_fma_f32 v[78:79], v[78:79], v[68:69], v[68:69] op_sel:[0,1,0] op_sel_hi:[1,1,0]
v_pk_fma_f32 v[80:81], v[80:81], v[72:73], v[72:73] op_sel:[0,1,0] op_sel_hi:[1,1,0]
v_pk_fma_f32 v[82:83], v[82:83], v[72:73], v[72:73] op_sel:[0,1,0] op_sel_hi:[1,1,0]
v_pk_mul_f32 v[76:77], v[76:77], v[124:125]
v_pk_mul_f32 v[78:79], v[78:79], v[126:127]
v_pk_mul_f32 v[80:81], v[80:81], v[156:157]
v_pk_mul_f32 v[82:83], v[82:83], v[158:159]
v_exp_f32 v76, v76
v_exp_f32 v77, v77
v_exp_f32 v78, v78
v_exp_f32 v79, v79
v_exp_f32 v80, v80
v_exp_f32 v81, v81
v_exp_f32 v82, v82
v_exp_f32 v83, v83
v_pk_fma_f32 v[140:141], v[60:61], v[44:45], v[140:141] op_sel_hi:[0,1,1] neg_lo:[1,0,0] neg_hi:[1,0,0]
v_pk_fma_f32 v[142:143], v[60:61], v[46:47], v[142:143] op_sel_hi:[0,1,1] neg_lo:[1,0,0] neg_hi:[1,0,0]
v_pk_fma_f32 v[172:173], v[62:63], v[44:45], v[172:173] op_sel_hi:[0,1,1] neg_lo:[1,0,0] neg_hi:[1,0,0]
v_pk_fma_f32 v[174:175], v[62:63], v[46:47], v[174:175] op_sel_hi:[0,1,1] neg_lo:[1,0,0] neg_hi:[1,0,0]
v_pk_fma_f32 v[76:77], v[76:77], v[70:71], v[70:71] op_sel_hi:[1,0,0]
v_pk_fma_f32 v[78:79], v[78:79], v[70:71], v[70:71] op_sel_hi:[1,0,0]
v_pk_fma_f32 v[80:81], v[80:81], v[74:75], v[74:75] op_sel_hi:[1,0,0]
v_pk_fma_f32 v[82:83], v[82:83], v[74:75], v[74:75] op_sel_hi:[1,0,0]
v_rcp_f32 v76, v76
v_rcp_f32 v77, v77
v_rcp_f32 v78, v78
v_rcp_f32 v79, v79
v_rcp_f32 v80, v80
v_rcp_f32 v81, v81
v_rcp_f32 v82, v82
v_rcp_f32 v83, v83
v_pk_mul_f32 v[140:141], v[124:125], v[140:141]
v_pk_mul_f32 v[142:143], v[126:127], v[142:143]
v_pk_mul_f32 v[172:173], v[156:157], v[172:173]
v_pk_mul_f32 v[174:175], v[158:159], v[174:175]
v_pk_mul_f32 v[140:141], v[140:141], v[76:77]
s_branch Lov_16
.p2align 12
.fill 128, 4, 0xbf800000
Lst_16_0:
s_branch Lwr_184
s_nop 0
s_nop 0
Lov_16:
v_pk_mul_f32 v[142:143], v[142:143], v[78:79]
v_pk_mul_f32 v[172:173], v[172:173], v[80:81]
v_pk_mul_f32 v[174:175], v[174:175], v[82:83]
v_cvt_pk_bf16_f32 v124, v140, v141
v_cvt_pk_bf16_f32 v125, v142, v143
v_cvt_pk_bf16_f32 v156, v172, v173
v_cvt_pk_bf16_f32 v157, v174, v175
v_pk_fma_f32 v[128:129], v[60:61], v[32:33], v[128:129] op_sel_hi:[0,1,1] neg_lo:[1,0,0] neg_hi:[1,0,0]
v_pk_fma_f32 v[130:131], v[60:61], v[34:35], v[130:131] op_sel_hi:[0,1,1] neg_lo:[1,0,0] neg_hi:[1,0,0]
v_pk_fma_f32 v[160:161], v[62:63], v[32:33], v[160:161] op_sel_hi:[0,1,1] neg_lo:[1,0,0] neg_hi:[1,0,0]
v_pk_fma_f32 v[162:163], v[62:63], v[34:35], v[162:163] op_sel_hi:[0,1,1] neg_lo:[1,0,0] neg_hi:[1,0,0]
v_pk_mul_f32 v[76:77], v[128:129], v[128:129]
v_pk_mul_f32 v[78:79], v[130:131], v[130:131]
v_pk_mul_f32 v[80:81], v[160:161], v[160:161]
v_pk_mul_f32 v[82:83], v[162:163], v[162:163]
v_pk_fma_f32 v[76:77], v[76:77], v[68:69], v[68:69] op_sel:[0,1,0] op_sel_hi:[1,1,0]
v_pk_fma_f32 v[78:79], v[78:79], v[68:69], v[68:69] op_sel:[0,1,0] op_sel_hi:[1,1,0]
v_pk_fma_f32 v[80:81], v[80:81], v[72:73], v[72:73] op_sel:[0,1,0] op_sel_hi:[1,1,0]
v_pk_fma_f32 v[82:83], v[82:83], v[72:73], v[72:73] op_sel:[0,1,0] op_sel_hi:[1,1,0]
v_pk_mul_f32 v[76:77], v[76:77], v[128:129]
v_pk_mul_f32 v[78:79], v[78:79], v[130:131]
v_pk_mul_f32 v[80:81], v[80:81], v[160:161]
v_pk_mul_f32 v[82:83], v[82:83], v[162:163]
v_exp_f32 v76, v76
v_exp_f32 v77, v77
v_exp_f32 v78, v78
v_exp_f32 v79, v79
v_exp_f32 v80, v80
v_exp_f32 v81, v81
v_exp_f32 v82, v82
v_exp_f32 v83, v83
v_pk_fma_f32 v[144:145], v[60:61], v[48:49], v[144:145] op_sel_hi:[0,1,1] neg_lo:[1,0,0] neg_hi:[1,0,0]
v_pk_fma_f32 v[146:147], v[60:61], v[50:51], v[146:147] op_sel_hi:[0,1,1] neg_lo:[1,0,0] neg_hi:[1,0,0]
v_pk_fma_f32 v[176:177], v[62:63], v[48:49], v[176:177] op_sel_hi:[0,1,1] neg_lo:[1,0,0] neg_hi:[1,0,0]
v_pk_fma_f32 v[178:179], v[62:63], v[50:51], v[178:179] op_sel_hi:[0,1,1] neg_lo:[1,0,0] neg_hi:[1,0,0]
v_pk_fma_f32 v[76:77], v[76:77], v[70:71], v[70:71] op_sel_hi:[1,0,0]
v_pk_fma_f32 v[78:79], v[78:79], v[70:71], v[70:71] op_sel_hi:[1,0,0]
v_pk_fma_f32 v[80:81], v[80:81], v[74:75], v[74:75] op_sel_hi:[1,0,0]
v_pk_fma_f32 v[82:83], v[82:83], v[74:75], v[74:75] op_sel_hi:[1,0,0]
v_rcp_f32 v76, v76
v_rcp_f32 v77, v77
v_rcp_f32 v78, v78
v_rcp_f32 v79, v79
v_rcp_f32 v80, v80
v_rcp_f32 v81, v81
v_rcp_f32 v82, v82
v_rcp_f32 v83, v83
v_pk_mul_f32 v[144:145], v[128:129], v[144:145]
v_pk_mul_f32 v[146:147], v[130:131], v[146:147]
v_pk_mul_f32 v[176:177], v[160:161], v[176:177]
v_pk_mul_f32 v[178:179], v[162:163], v[178:179]
v_pk_mul_f32 v[144:145], v[144:145], v[76:77]
v_pk_mul_f32 v[146:147], v[146:147], v[78:79]
v_pk_mul_f32 v[176:177], v[176:177], v[80:81]
v_pk_mul_f32 v[178:179], v[178:179], v[82:83]
v_cvt_pk_bf16_f32 v126, v144, v145
v_cvt_pk_bf16_f32 v127, v146, v147
v_cvt_pk_bf16_f32 v158, v176, v177
v_cvt_pk_bf16_f32 v159, v178, v179
buffer_store_dwordx4 v[124:127], v2, s[24:27], s54 offen offset:0 sc1
buffer_store_dwordx4 v[156:159], v2, s[24:27], s54 offen offset:1024 sc1
v_pk_fma_f32 v[132:133], v[60:61], v[36:37], v[132:133] op_sel_hi:[0,1,1] neg_lo:[1,0,0] neg_hi:[1,0,0]
v_pk_fma_f32 v[134:135], v[60:61], v[38:39], v[134:135] op_sel_hi:[0,1,1] neg_lo:[1,0,0] neg_hi:[1,0,0]
v_pk_fma_f32 v[164:165], v[62:63], v[36:37], v[164:165] op_sel_hi:[0,1,1] neg_lo:[1,0,0] neg_hi:[1,0,0]
v_pk_fma_f32 v[166:167], v[62:63], v[38:39], v[166:167] op_sel_hi:[0,1,1] neg_lo:[1,0,0] neg_hi:[1,0,0]
v_pk_mul_f32 v[76:77], v[132:133], v[132:133]
v_pk_mul_f32 v[78:79], v[134:135], v[134:135]
v_pk_mul_f32 v[80:81], v[164:165], v[164:165]
v_pk_mul_f32 v[82:83], v[166:167], v[166:167]
v_pk_fma_f32 v[76:77], v[76:77], v[68:69], v[68:69] op_sel:[0,1,0] op_sel_hi:[1,1,0]
v_pk_fma_f32 v[78:79], v[78:79], v[68:69], v[68:69] op_sel:[0,1,0] op_sel_hi:[1,1,0]
v_pk_fma_f32 v[80:81], v[80:81], v[72:73], v[72:73] op_sel:[0,1,0] op_sel_hi:[1,1,0]
v_pk_fma_f32 v[82:83], v[82:83], v[72:73], v[72:73] op_sel:[0,1,0] op_sel_hi:[1,1,0]
v_pk_mul_f32 v[76:77], v[76:77], v[132:133]
v_pk_mul_f32 v[78:79], v[78:79], v[134:135]
v_pk_mul_f32 v[80:81], v[80:81], v[164:165]
v_pk_mul_f32 v[82:83], v[82:83], v[166:167]
v_exp_f32 v76, v76
v_exp_f32 v77, v77
v_exp_f32 v78, v78
v_exp_f32 v79, v79
v_exp_f32 v80, v80
v_exp_f32 v81, v81
v_exp_f32 v82, v82
v_exp_f32 v83, v83
v_pk_fma_f32 v[148:149], v[60:61], v[52:53], v[148:149] op_sel_hi:[0,1,1] neg_lo:[1,0,0] neg_hi:[1,0,0]
v_pk_fma_f32 v[150:151], v[60:61], v[54:55], v[150:151] op_sel_hi:[0,1,1] neg_lo:[1,0,0] neg_hi:[1,0,0]
v_pk_fma_f32 v[180:181], v[62:63], v[52:53], v[180:181] op_sel_hi:[0,1,1] neg_lo:[1,0,0] neg_hi:[1,0,0]
v_pk_fma_f32 v[182:183], v[62:63], v[54:55], v[182:183] op_sel_hi:[0,1,1] neg_lo:[1,0,0] neg_hi:[1,0,0]
v_pk_fma_f32 v[76:77], v[76:77], v[70:71], v[70:71] op_sel_hi:[1,0,0]
v_pk_fma_f32 v[78:79], v[78:79], v[70:71], v[70:71] op_sel_hi:[1,0,0]
v_pk_fma_f32 v[80:81], v[80:81], v[74:75], v[74:75] op_sel_hi:[1,0,0]
v_pk_fma_f32 v[82:83], v[82:83], v[74:75], v[74:75] op_sel_hi:[1,0,0]
v_rcp_f32 v76, v76
v_rcp_f32 v77, v77
v_rcp_f32 v78, v78
v_rcp_f32 v79, v79
v_rcp_f32 v80, v80
v_rcp_f32 v81, v81
v_rcp_f32 v82, v82
v_rcp_f32 v83, v83
v_pk_mul_f32 v[148:149], v[132:133], v[148:149]
v_pk_mul_f32 v[150:151], v[134:135], v[150:151]
v_pk_mul_f32 v[180:181], v[164:165], v[180:181]
v_pk_mul_f32 v[182:183], v[166:167], v[182:183]
v_pk_mul_f32 v[148:149], v[148:149], v[76:77]
v_pk_mul_f32 v[150:151], v[150:151], v[78:79]
v_pk_mul_f32 v[180:181], v[180:181], v[80:81]
v_pk_mul_f32 v[182:183], v[182:183], v[82:83]
v_cvt_pk_bf16_f32 v132, v148, v149
v_cvt_pk_bf16_f32 v133, v150, v151
v_cvt_pk_bf16_f32 v164, v180, v181
v_cvt_pk_bf16_f32 v165, v182, v183
v_pk_fma_f32 v[136:137], v[60:61], v[40:41], v[136:137] op_sel_hi:[0,1,1] neg_lo:[1,0,0] neg_hi:[1,0,0]
v_pk_fma_f32 v[138:139], v[60:61], v[42:43], v[138:139] op_sel_hi:[0,1,1] neg_lo:[1,0,0] neg_hi:[1,0,0]
v_pk_fma_f32 v[168:169], v[62:63], v[40:41], v[168:169] op_sel_hi:[0,1,1] neg_lo:[1,0,0] neg_hi:[1,0,0]
v_pk_fma_f32 v[170:171], v[62:63], v[42:43], v[170:171] op_sel_hi:[0,1,1] neg_lo:[1,0,0] neg_hi:[1,0,0]
v_pk_mul_f32 v[76:77], v[136:137], v[136:137]
v_pk_mul_f32 v[78:79], v[138:139], v[138:139]
v_pk_mul_f32 v[80:81], v[168:169], v[168:169]
v_pk_mul_f32 v[82:83], v[170:171], v[170:171]
v_pk_fma_f32 v[76:77], v[76:77], v[68:69], v[68:69] op_sel:[0,1,0] op_sel_hi:[1,1,0]
v_pk_fma_f32 v[78:79], v[78:79], v[68:69], v[68:69] op_sel:[0,1,0] op_sel_hi:[1,1,0]
v_pk_fma_f32 v[80:81], v[80:81], v[72:73], v[72:73] op_sel:[0,1,0] op_sel_hi:[1,1,0]
v_pk_fma_f32 v[82:83], v[82:83], v[72:73], v[72:73] op_sel:[0,1,0] op_sel_hi:[1,1,0]
v_pk_mul_f32 v[76:77], v[76:77], v[136:137]
v_pk_mul_f32 v[78:79], v[78:79], v[138:139]
v_pk_mul_f32 v[80:81], v[80:81], v[168:169]
v_pk_mul_f32 v[82:83], v[82:83], v[170:171]
v_exp_f32 v76, v76
v_exp_f32 v77, v77
v_exp_f32 v78, v78
v_exp_f32 v79, v79
v_exp_f32 v80, v80
v_exp_f32 v81, v81
v_exp_f32 v82, v82
v_exp_f32 v83, v83
v_pk_fma_f32 v[152:153], v[60:61], v[56:57], v[152:153] op_sel_hi:[0,1,1] neg_lo:[1,0,0] neg_hi:[1,0,0]
v_pk_fma_f32 v[154:155], v[60:61], v[58:59], v[154:155] op_sel_hi:[0,1,1] neg_lo:[1,0,0] neg_hi:[1,0,0]
v_pk_fma_f32 v[184:185], v[62:63], v[56:57], v[184:185] op_sel_hi:[0,1,1] neg_lo:[1,0,0] neg_hi:[1,0,0]
v_pk_fma_f32 v[186:187], v[62:63], v[58:59], v[186:187] op_sel_hi:[0,1,1] neg_lo:[1,0,0] neg_hi:[1,0,0]
v_pk_fma_f32 v[76:77], v[76:77], v[70:71], v[70:71] op_sel_hi:[1,0,0]
v_pk_fma_f32 v[78:79], v[78:79], v[70:71], v[70:71] op_sel_hi:[1,0,0]
v_pk_fma_f32 v[80:81], v[80:81], v[74:75], v[74:75] op_sel_hi:[1,0,0]
v_pk_fma_f32 v[82:83], v[82:83], v[74:75], v[74:75] op_sel_hi:[1,0,0]
v_rcp_f32 v76, v76
v_rcp_f32 v77, v77
v_rcp_f32 v78, v78
v_rcp_f32 v79, v79
v_rcp_f32 v80, v80
v_rcp_f32 v81, v81
v_rcp_f32 v82, v82
v_rcp_f32 v83, v83
v_pk_mul_f32 v[152:153], v[136:137], v[152:153]
v_pk_mul_f32 v[154:155], v[138:139], v[154:155]
v_pk_mul_f32 v[184:185], v[168:169], v[184:185]
v_pk_mul_f32 v[186:187], v[170:171], v[186:187]
v_pk_mul_f32 v[152:153], v[152:153], v[76:77]
v_pk_mul_f32 v[154:155], v[154:155], v[78:79]
v_pk_mul_f32 v[184:185], v[184:185], v[80:81]
v_pk_mul_f32 v[186:187], v[186:187], v[82:83]
v_cvt_pk_bf16_f32 v134, v152, v153
v_cvt_pk_bf16_f32 v135, v154, v155
v_cvt_pk_bf16_f32 v166, v184, v185
v_cvt_pk_bf16_f32 v167, v186, v187
buffer_store_dwordx4 v[132:135], v2, s[24:27], s55 offen offset:0 sc1
buffer_store_dwordx4 v[164:167], v2, s[24:27], s55 offen offset:1024 sc1
v_mul_f32 v70, v65, v65
v_mul_f32 v68, 0xc0135761, v65
v_mul_f32 v69, 0xbdd2d3e8, v65
v_mul_f32 v69, v69, v70
v_rcp_f32 v70, v70
v_mul_f32 v74, v67, v67
v_mul_f32 v72, 0xc0135761, v67
v_mul_f32 v73, 0xbdd2d3e8, v67
v_mul_f32 v73, v73, v74
v_rcp_f32 v74, v74
v_pk_fma_f32 v[188:189], v[64:65], v[28:29], v[188:189] op_sel_hi:[0,1,1] neg_lo:[1,0,0] neg_hi:[1,0,0]
v_pk_fma_f32 v[190:191], v[64:65], v[30:31], v[190:191] op_sel_hi:[0,1,1] neg_lo:[1,0,0] neg_hi:[1,0,0]
v_pk_fma_f32 v[220:221], v[66:67], v[28:29], v[220:221] op_sel_hi:[0,1,1] neg_lo:[1,0,0] neg_hi:[1,0,0]
v_pk_fma_f32 v[222:223], v[66:67], v[30:31], v[222:223] op_sel_hi:[0,1,1] neg_lo:[1,0,0] neg_hi:[1,0,0]
v_pk_mul_f32 v[76:77], v[188:189], v[188:189]
v_pk_mul_f32 v[78:79], v[190:191], v[190:191]
v_pk_mul_f32 v[80:81], v[220:221], v[220:221]
v_pk_mul_f32 v[82:83], v[222:223], v[222:223]
v_pk_fma_f32 v[76:77], v[76:77], v[68:69], v[68:69] op_sel:[0,1,0] op_sel_hi:[1,1,0]
v_pk_fma_f32 v[78:79], v[78:79], v[68:69], v[68:69] op_sel:[0,1,0] op_sel_hi:[1,1,0]
v_pk_fma_f32 v[80:81], v[80:81], v[72:73], v[72:73] op_sel:[0,1,0] op_sel_hi:[1,1,0]
v_pk_fma_f32 v[82:83], v[82:83], v[72:73], v[72:73] op_sel:[0,1,0] op_sel_hi:[1,1,0]
v_pk_mul_f32 v[76:77], v[76:77], v[188:189]
v_pk_mul_f32 v[78:79], v[78:79], v[190:191]
v_pk_mul_f32 v[80:81], v[80:81], v[220:221]
v_pk_mul_f32 v[82:83], v[82:83], v[222:223]
v_exp_f32 v76, v76
v_exp_f32 v77, v77
v_exp_f32 v78, v78
v_exp_f32 v79, v79
v_exp_f32 v80, v80
v_exp_f32 v81, v81
v_exp_f32 v82, v82
v_exp_f32 v83, v83
v_pk_fma_f32 v[204:205], v[64:65], v[44:45], v[204:205] op_sel_hi:[0,1,1] neg_lo:[1,0,0] neg_hi:[1,0,0]
v_pk_fma_f32 v[206:207], v[64:65], v[46:47], v[206:207] op_sel_hi:[0,1,1] neg_lo:[1,0,0] neg_hi:[1,0,0]
v_pk_fma_f32 v[236:237], v[66:67], v[44:45], v[236:237] op_sel_hi:[0,1,1] neg_lo:[1,0,0] neg_hi:[1,0,0]
v_pk_fma_f32 v[238:239], v[66:67], v[46:47], v[238:239] op_sel_hi:[0,1,1] neg_lo:[1,0,0] neg_hi:[1,0,0]
v_pk_fma_f32 v[76:77], v[76:77], v[70:71], v[70:71] op_sel_hi:[1,0,0]
v_pk_fma_f32 v[78:79], v[78:79], v[70:71], v[70:71] op_sel_hi:[1,0,0]
v_pk_fma_f32 v[80:81], v[80:81], v[74:75], v[74:75] op_sel_hi:[1,0,0]
v_pk_fma_f32 v[82:83], v[82:83], v[74:75], v[74:75] op_sel_hi:[1,0,0]
v_rcp_f32 v76, v76
v_rcp_f32 v77, v77
v_rcp_f32 v78, v78
v_rcp_f32 v79, v79
v_rcp_f32 v80, v80
v_rcp_f32 v81, v81
v_rcp_f32 v82, v82
v_rcp_f32 v83, v83
v_pk_mul_f32 v[204:205], v[188:189], v[204:205]
v_pk_mul_f32 v[206:207], v[190:191], v[206:207]
v_pk_mul_f32 v[236:237], v[220:221], v[236:237]
v_pk_mul_f32 v[238:239], v[222:223], v[238:239]
v_pk_mul_f32 v[204:205], v[204:205], v[76:77]
v_pk_mul_f32 v[206:207], v[206:207], v[78:79]
v_pk_mul_f32 v[236:237], v[236:237], v[80:81]
v_pk_mul_f32 v[238:239], v[238:239], v[82:83]
v_cvt_pk_bf16_f32 v188, v204, v205
v_cvt_pk_bf16_f32 v189, v206, v207
v_cvt_pk_bf16_f32 v220, v236, v237
v_cvt_pk_bf16_f32 v221, v238, v239
v_pk_fma_f32 v[192:193], v[64:65], v[32:33], v[192:193] op_sel_hi:[0,1,1] neg_lo:[1,0,0] neg_hi:[1,0,0]
v_pk_fma_f32 v[194:195], v[64:65], v[34:35], v[194:195] op_sel_hi:[0,1,1] neg_lo:[1,0,0] neg_hi:[1,0,0]
v_pk_fma_f32 v[224:225], v[66:67], v[32:33], v[224:225] op_sel_hi:[0,1,1] neg_lo:[1,0,0] neg_hi:[1,0,0]
v_pk_fma_f32 v[226:227], v[66:67], v[34:35], v[226:227] op_sel_hi:[0,1,1] neg_lo:[1,0,0] neg_hi:[1,0,0]
v_pk_mul_f32 v[76:77], v[192:193], v[192:193]
v_pk_mul_f32 v[78:79], v[194:195], v[194:195]
v_pk_mul_f32 v[80:81], v[224:225], v[224:225]
v_pk_mul_f32 v[82:83], v[226:227], v[226:227]
v_pk_fma_f32 v[76:77], v[76:77], v[68:69], v[68:69] op_sel:[0,1,0] op_sel_hi:[1,1,0]
v_pk_fma_f32 v[78:79], v[78:79], v[68:69], v[68:69] op_sel:[0,1,0] op_sel_hi:[1,1,0]
v_pk_fma_f32 v[80:81], v[80:81], v[72:73], v[72:73] op_sel:[0,1,0] op_sel_hi:[1,1,0]
v_pk_fma_f32 v[82:83], v[82:83], v[72:73], v[72:73] op_sel:[0,1,0] op_sel_hi:[1,1,0]
v_pk_mul_f32 v[76:77], v[76:77], v[192:193]
v_pk_mul_f32 v[78:79], v[78:79], v[194:195]
v_pk_mul_f32 v[80:81], v[80:81], v[224:225]
v_pk_mul_f32 v[82:83], v[82:83], v[226:227]
v_exp_f32 v76, v76
v_exp_f32 v77, v77
v_exp_f32 v78, v78
v_exp_f32 v79, v79
v_exp_f32 v80, v80
v_exp_f32 v81, v81
v_exp_f32 v82, v82
v_exp_f32 v83, v83
v_pk_fma_f32 v[208:209], v[64:65], v[48:49], v[208:209] op_sel_hi:[0,1,1] neg_lo:[1,0,0] neg_hi:[1,0,0]
v_pk_fma_f32 v[210:211], v[64:65], v[50:51], v[210:211] op_sel_hi:[0,1,1] neg_lo:[1,0,0] neg_hi:[1,0,0]
v_pk_fma_f32 v[240:241], v[66:67], v[48:49], v[240:241] op_sel_hi:[0,1,1] neg_lo:[1,0,0] neg_hi:[1,0,0]
v_pk_fma_f32 v[242:243], v[66:67], v[50:51], v[242:243] op_sel_hi:[0,1,1] neg_lo:[1,0,0] neg_hi:[1,0,0]
v_pk_fma_f32 v[76:77], v[76:77], v[70:71], v[70:71] op_sel_hi:[1,0,0]
v_pk_fma_f32 v[78:79], v[78:79], v[70:71], v[70:71] op_sel_hi:[1,0,0]
v_pk_fma_f32 v[80:81], v[80:81], v[74:75], v[74:75] op_sel_hi:[1,0,0]
v_pk_fma_f32 v[82:83], v[82:83], v[74:75], v[74:75] op_sel_hi:[1,0,0]
v_rcp_f32 v76, v76
v_rcp_f32 v77, v77
v_rcp_f32 v78, v78
v_rcp_f32 v79, v79
v_rcp_f32 v80, v80
v_rcp_f32 v81, v81
v_rcp_f32 v82, v82
v_rcp_f32 v83, v83
v_pk_mul_f32 v[208:209], v[192:193], v[208:209]
v_pk_mul_f32 v[210:211], v[194:195], v[210:211]
v_pk_mul_f32 v[240:241], v[224:225], v[240:241]
v_pk_mul_f32 v[242:243], v[226:227], v[242:243]
v_pk_mul_f32 v[208:209], v[208:209], v[76:77]
v_pk_mul_f32 v[210:211], v[210:211], v[78:79]
v_pk_mul_f32 v[240:241], v[240:241], v[80:81]
v_pk_mul_f32 v[242:243], v[242:243], v[82:83]
v_cvt_pk_bf16_f32 v190, v208, v209
v_cvt_pk_bf16_f32 v191, v210, v211
v_cvt_pk_bf16_f32 v222, v240, v241
v_cvt_pk_bf16_f32 v223, v242, v243
buffer_store_dwordx4 v[188:191], v2, s[24:27], s54 offen offset:2048 sc1
buffer_store_dwordx4 v[220:223], v2, s[24:27], s54 offen offset:3072 sc1
v_pk_fma_f32 v[196:197], v[64:65], v[36:37], v[196:197] op_sel_hi:[0,1,1] neg_lo:[1,0,0] neg_hi:[1,0,0]
v_pk_fma_f32 v[198:199], v[64:65], v[38:39], v[198:199] op_sel_hi:[0,1,1] neg_lo:[1,0,0] neg_hi:[1,0,0]
v_pk_fma_f32 v[228:229], v[66:67], v[36:37], v[228:229] op_sel_hi:[0,1,1] neg_lo:[1,0,0] neg_hi:[1,0,0]
v_pk_fma_f32 v[230:231], v[66:67], v[38:39], v[230:231] op_sel_hi:[0,1,1] neg_lo:[1,0,0] neg_hi:[1,0,0]
v_pk_mul_f32 v[76:77], v[196:197], v[196:197]
v_pk_mul_f32 v[78:79], v[198:199], v[198:199]
v_pk_mul_f32 v[80:81], v[228:229], v[228:229]
v_pk_mul_f32 v[82:83], v[230:231], v[230:231]
v_pk_fma_f32 v[76:77], v[76:77], v[68:69], v[68:69] op_sel:[0,1,0] op_sel_hi:[1,1,0]
v_pk_fma_f32 v[78:79], v[78:79], v[68:69], v[68:69] op_sel:[0,1,0] op_sel_hi:[1,1,0]
v_pk_fma_f32 v[80:81], v[80:81], v[72:73], v[72:73] op_sel:[0,1,0] op_sel_hi:[1,1,0]
v_pk_fma_f32 v[82:83], v[82:83], v[72:73], v[72:73] op_sel:[0,1,0] op_sel_hi:[1,1,0]
v_pk_mul_f32 v[76:77], v[76:77], v[196:197]
v_pk_mul_f32 v[78:79], v[78:79], v[198:199]
v_pk_mul_f32 v[80:81], v[80:81], v[228:229]
v_pk_mul_f32 v[82:83], v[82:83], v[230:231]
v_exp_f32 v76, v76
v_exp_f32 v77, v77
v_exp_f32 v78, v78
v_exp_f32 v79, v79
v_exp_f32 v80, v80
v_exp_f32 v81, v81
v_exp_f32 v82, v82
v_exp_f32 v83, v83
v_pk_fma_f32 v[212:213], v[64:65], v[52:53], v[212:213] op_sel_hi:[0,1,1] neg_lo:[1,0,0] neg_hi:[1,0,0]
v_pk_fma_f32 v[214:215], v[64:65], v[54:55], v[214:215] op_sel_hi:[0,1,1] neg_lo:[1,0,0] neg_hi:[1,0,0]
v_pk_fma_f32 v[244:245], v[66:67], v[52:53], v[244:245] op_sel_hi:[0,1,1] neg_lo:[1,0,0] neg_hi:[1,0,0]
v_pk_fma_f32 v[246:247], v[66:67], v[54:55], v[246:247] op_sel_hi:[0,1,1] neg_lo:[1,0,0] neg_hi:[1,0,0]
v_pk_fma_f32 v[76:77], v[76:77], v[70:71], v[70:71] op_sel_hi:[1,0,0]
v_pk_fma_f32 v[78:79], v[78:79], v[70:71], v[70:71] op_sel_hi:[1,0,0]
v_pk_fma_f32 v[80:81], v[80:81], v[74:75], v[74:75] op_sel_hi:[1,0,0]
v_pk_fma_f32 v[82:83], v[82:83], v[74:75], v[74:75] op_sel_hi:[1,0,0]
v_rcp_f32 v76, v76
v_rcp_f32 v77, v77
v_rcp_f32 v78, v78
v_rcp_f32 v79, v79
v_rcp_f32 v80, v80
v_rcp_f32 v81, v81
v_rcp_f32 v82, v82
v_rcp_f32 v83, v83
v_pk_mul_f32 v[212:213], v[196:197], v[212:213]
v_pk_mul_f32 v[214:215], v[198:199], v[214:215]
v_pk_mul_f32 v[244:245], v[228:229], v[244:245]
v_pk_mul_f32 v[246:247], v[230:231], v[246:247]
v_pk_mul_f32 v[212:213], v[212:213], v[76:77]
v_pk_mul_f32 v[214:215], v[214:215], v[78:79]
v_pk_mul_f32 v[244:245], v[244:245], v[80:81]
v_pk_mul_f32 v[246:247], v[246:247], v[82:83]
v_cvt_pk_bf16_f32 v196, v212, v213
v_cvt_pk_bf16_f32 v197, v214, v215
v_cvt_pk_bf16_f32 v228, v244, v245
v_cvt_pk_bf16_f32 v229, v246, v247
v_pk_fma_f32 v[200:201], v[64:65], v[40:41], v[200:201] op_sel_hi:[0,1,1] neg_lo:[1,0,0] neg_hi:[1,0,0]
v_pk_fma_f32 v[202:203], v[64:65], v[42:43], v[202:203] op_sel_hi:[0,1,1] neg_lo:[1,0,0] neg_hi:[1,0,0]
v_pk_fma_f32 v[232:233], v[66:67], v[40:41], v[232:233] op_sel_hi:[0,1,1] neg_lo:[1,0,0] neg_hi:[1,0,0]
v_pk_fma_f32 v[234:235], v[66:67], v[42:43], v[234:235] op_sel_hi:[0,1,1] neg_lo:[1,0,0] neg_hi:[1,0,0]
v_pk_mul_f32 v[76:77], v[200:201], v[200:201]
v_pk_mul_f32 v[78:79], v[202:203], v[202:203]
v_pk_mul_f32 v[80:81], v[232:233], v[232:233]
v_pk_mul_f32 v[82:83], v[234:235], v[234:235]
v_pk_fma_f32 v[76:77], v[76:77], v[68:69], v[68:69] op_sel:[0,1,0] op_sel_hi:[1,1,0]
v_pk_fma_f32 v[78:79], v[78:79], v[68:69], v[68:69] op_sel:[0,1,0] op_sel_hi:[1,1,0]
v_pk_fma_f32 v[80:81], v[80:81], v[72:73], v[72:73] op_sel:[0,1,0] op_sel_hi:[1,1,0]
v_pk_fma_f32 v[82:83], v[82:83], v[72:73], v[72:73] op_sel:[0,1,0] op_sel_hi:[1,1,0]
v_pk_mul_f32 v[76:77], v[76:77], v[200:201]
v_pk_mul_f32 v[78:79], v[78:79], v[202:203]
v_pk_mul_f32 v[80:81], v[80:81], v[232:233]
v_pk_mul_f32 v[82:83], v[82:83], v[234:235]
v_exp_f32 v76, v76
v_exp_f32 v77, v77
v_exp_f32 v78, v78
v_exp_f32 v79, v79
v_exp_f32 v80, v80
v_exp_f32 v81, v81
v_exp_f32 v82, v82
v_exp_f32 v83, v83
v_pk_fma_f32 v[216:217], v[64:65], v[56:57], v[216:217] op_sel_hi:[0,1,1] neg_lo:[1,0,0] neg_hi:[1,0,0]
v_pk_fma_f32 v[218:219], v[64:65], v[58:59], v[218:219] op_sel_hi:[0,1,1] neg_lo:[1,0,0] neg_hi:[1,0,0]
v_pk_fma_f32 v[248:249], v[66:67], v[56:57], v[248:249] op_sel_hi:[0,1,1] neg_lo:[1,0,0] neg_hi:[1,0,0]
v_pk_fma_f32 v[250:251], v[66:67], v[58:59], v[250:251] op_sel_hi:[0,1,1] neg_lo:[1,0,0] neg_hi:[1,0,0]
v_pk_fma_f32 v[76:77], v[76:77], v[70:71], v[70:71] op_sel_hi:[1,0,0]
v_pk_fma_f32 v[78:79], v[78:79], v[70:71], v[70:71] op_sel_hi:[1,0,0]
v_pk_fma_f32 v[80:81], v[80:81], v[74:75], v[74:75] op_sel_hi:[1,0,0]
v_pk_fma_f32 v[82:83], v[82:83], v[74:75], v[74:75] op_sel_hi:[1,0,0]
v_rcp_f32 v76, v76
v_rcp_f32 v77, v77
v_rcp_f32 v78, v78
v_rcp_f32 v79, v79
v_rcp_f32 v80, v80
v_rcp_f32 v81, v81
v_rcp_f32 v82, v82
v_rcp_f32 v83, v83
v_pk_mul_f32 v[216:217], v[200:201], v[216:217]
v_pk_mul_f32 v[218:219], v[202:203], v[218:219]
v_pk_mul_f32 v[248:249], v[232:233], v[248:249]
v_pk_mul_f32 v[250:251], v[234:235], v[250:251]
v_pk_mul_f32 v[216:217], v[216:217], v[76:77]
v_pk_mul_f32 v[218:219], v[218:219], v[78:79]
v_pk_mul_f32 v[248:249], v[248:249], v[80:81]
v_pk_mul_f32 v[250:251], v[250:251], v[82:83]
v_cvt_pk_bf16_f32 v198, v216, v217
v_cvt_pk_bf16_f32 v199, v218, v219
v_cvt_pk_bf16_f32 v230, v248, v249
v_cvt_pk_bf16_f32 v231, v250, v251
buffer_store_dwordx4 v[196:199], v2, s[24:27], s55 offen offset:2048 sc1
buffer_store_dwordx4 v[228:231], v2, s[24:27], s55 offen offset:3072 sc1
s_barrier
s_add_u32 s37, s52, 589824
s_add_u32 m0, s39, 81920
s_nop 0
buffer_load_dwordx4 v3, s[24:27], s37 offen sc1 lds
buffer_load_dwordx4 v3, s[24:27], s37 offen offset:1024 sc1 lds
buffer_load_dwordx4 v3, s[24:27], s37 offen offset:2048 sc1 lds
buffer_load_dwordx4 v3, s[24:27], s37 offen offset:3072 sc1 lds
s_add_u32 s38, s53, 4718592
s_add_u32 m0, s39, 147456
s_nop 0
buffer_load_dwordx4 v23, s[28:31], s38 offen lds
s_add_u32 m0, s39, 148480
s_nop 0
buffer_load_dwordx4 v24, s[28:31], s38 offen lds
s_add_u32 m0, s39, 149504
s_add_u32 s38, s38, 16384
buffer_load_dwordx4 v23, s[28:31], s38 offen lds
s_add_u32 m0, s39, 150528
s_nop 0
buffer_load_dwordx4 v24, s[28:31], s38 offen lds
s_add_u32 s37, s52, 606208
s_add_u32 m0, s39, 98304
s_nop 0
buffer_load_dwordx4 v3, s[24:27], s37 offen sc1 lds
buffer_load_dwordx4 v3, s[24:27], s37 offen offset:1024 sc1 lds
buffer_load_dwordx4 v3, s[24:27], s37 offen offset:2048 sc1 lds
buffer_load_dwordx4 v3, s[24:27], s37 offen offset:3072 sc1 lds
s_add_u32 s38, s53, 4849664
s_add_u32 m0, s39, 114688
s_nop 0
buffer_load_dwordx4 v23, s[28:31], s38 offen lds
s_add_u32 m0, s39, 115712
s_nop 0
buffer_load_dwordx4 v24, s[28:31], s38 offen lds
s_add_u32 m0, s39, 116736
s_add_u32 s38, s38, 16384
buffer_load_dwordx4 v23, s[28:31], s38 offen lds
s_add_u32 m0, s39, 117760
s_nop 0
buffer_load_dwordx4 v24, s[28:31], s38 offen lds
s_barrier
s_add_u32 s37, s52, 622592
s_add_u32 m0, s39, 131072
s_nop 0
buffer_load_dwordx4 v3, s[24:27], s37 offen sc1 lds
buffer_load_dwordx4 v3, s[24:27], s37 offen offset:1024 sc1 lds
buffer_load_dwordx4 v3, s[24:27], s37 offen offset:2048 sc1 lds
buffer_load_dwordx4 v3, s[24:27], s37 offen offset:3072 sc1 lds
s_add_u32 s38, s53, 4980736
s_add_u32 m0, s39, 0
s_nop 0
buffer_load_dwordx4 v23, s[28:31], s38 offen lds
s_add_u32 m0, s39, 1024
s_nop 0
buffer_load_dwordx4 v24, s[28:31], s38 offen lds
s_add_u32 m0, s39, 2048
s_add_u32 s38, s38, 16384
buffer_load_dwordx4 v23, s[28:31], s38 offen lds
s_add_u32 m0, s39, 3072
s_nop 0
buffer_load_dwordx4 v24, s[28:31], s38 offen lds
s_waitcnt vmcnt(24)
s_barrier
s_cmp_eq_u32 s47, 0
s_cbranch_scc0 Lw_148
s_add_u32 s7, s34, 48
s_lshl_b32 s7, s7, 7
v_mov_b32 v26, s7
v_mov_b32 v27, 1
s_mov_b64 exec, 1
buffer_atomic_add v27, v26, s[56:59], 0 offen sc1
s_mov_b64 exec, -1
Lw_148:
s_add_u32 s37, s52, 638976
s_add_u32 m0, s39, 16384
s_nop 0
buffer_load_dwordx4 v3, s[24:27], s37 offen sc1 lds
buffer_load_dwordx4 v3, s[24:27], s37 offen offset:1024 sc1 lds
buffer_load_dwordx4 v3, s[24:27], s37 offen offset:2048 sc1 lds
buffer_load_dwordx4 v3, s[24:27], s37 offen offset:3072 sc1 lds
s_add_u32 s38, s53, 5111808
s_add_u32 m0, s39, 32768
s_nop 0
buffer_load_dwordx4 v23, s[28:31], s38 offen lds
s_add_u32 m0, s39, 33792
s_nop 0
buffer_load_dwordx4 v24, s[28:31], s38 offen lds
s_add_u32 m0, s39, 34816
s_add_u32 s38, s38, 16384
buffer_load_dwordx4 v23, s[28:31], s38 offen lds
s_add_u32 m0, s39, 35840
s_nop 0
buffer_load_dwordx4 v24, s[28:31], s38 offen lds
s_waitcnt vmcnt(24)
s_barrier
s_add_u32 s37, s52, 655360
s_add_u32 m0, s39, 49152
s_nop 0
buffer_load_dwordx4 v3, s[24:27], s37 offen sc1 lds
buffer_load_dwordx4 v3, s[24:27], s37 offen offset:1024 sc1 lds
buffer_load_dwordx4 v3, s[24:27], s37 offen offset:2048 sc1 lds
buffer_load_dwordx4 v3, s[24:27], s37 offen offset:3072 sc1 lds
s_add_u32 s38, s53, 5242880
s_add_u32 m0, s39, 65536
s_nop 0
buffer_load_dwordx4 v23, s[28:31], s38 offen lds
s_add_u32 m0, s39, 66560
s_nop 0
buffer_load_dwordx4 v24, s[28:31], s38 offen lds
s_add_u32 m0, s39, 67584
s_add_u32 s38, s38, 16384
buffer_load_dwordx4 v23, s[28:31], s38 offen lds
s_add_u32 m0, s39, 68608
s_nop 0
buffer_load_dwordx4 v24, s[28:31], s38 offen lds
s_waitcnt vmcnt(24)
s_barrier
s_add_u32 s37, s52, 671744
s_add_u32 m0, s39, 81920
s_nop 0
buffer_load_dwordx4 v3, s[24:27], s37 offen sc1 lds
buffer_load_dwordx4 v3, s[24:27], s37 offen offset:1024 sc1 lds
buffer_load_dwordx4 v3, s[24:27], s37 offen offset:2048 sc1 lds
buffer_load_dwordx4 v3, s[24:27], s37 offen offset:3072 sc1 lds
s_add_u32 s38, s53, 5373952
s_add_u32 m0, s39, 147456
s_nop 0
buffer_load_dwordx4 v23, s[28:31], s38 offen lds
s_add_u32 m0, s39, 148480
s_nop 0
buffer_load_dwordx4 v24, s[28:31], s38 offen lds
s_add_u32 m0, s39, 149504
s_add_u32 s38, s38, 16384
buffer_load_dwordx4 v23, s[28:31], s38 offen lds
s_add_u32 m0, s39, 150528
s_nop 0
s_branch Lov_17
.p2align 12
.fill 128, 4, 0xbf800000
Lst_17_0:
s_branch Lwr_185
s_nop 0
s_nop 0
Lov_17:
buffer_load_dwordx4 v24, s[28:31], s38 offen lds
s_waitcnt vmcnt(24)
s_barrier
s_add_u32 s37, s52, 688128
s_add_u32 m0, s39, 98304
s_nop 0
buffer_load_dwordx4 v3, s[24:27], s37 offen sc1 lds
buffer_load_dwordx4 v3, s[24:27], s37 offen offset:1024 sc1 lds
buffer_load_dwordx4 v3, s[24:27], s37 offen offset:2048 sc1 lds
buffer_load_dwordx4 v3, s[24:27], s37 offen offset:3072 sc1 lds
s_add_u32 s38, s53, 5505024
s_add_u32 m0, s39, 114688
s_nop 0
buffer_load_dwordx4 v23, s[28:31], s38 offen lds
s_add_u32 m0, s39, 115712
s_nop 0
buffer_load_dwordx4 v24, s[28:31], s38 offen lds
s_add_u32 m0, s39, 116736
s_add_u32 s38, s38, 16384
buffer_load_dwordx4 v23, s[28:31], s38 offen lds
s_add_u32 m0, s39, 117760
s_nop 0
buffer_load_dwordx4 v24, s[28:31], s38 offen lds
s_waitcnt vmcnt(24)
s_barrier
s_cmp_eq_u32 s47, 3
s_cbranch_scc0 Lw_149
s_lshl_b32 s92, s34, 7
s_add_u32 s92, s92, 28317696
s_load_dword s93, s[82:83], s92 glc
Lw_149:
s_add_u32 s37, s52, 704512
s_add_u32 m0, s39, 131072
s_nop 0
buffer_load_dwordx4 v3, s[24:27], s37 offen sc1 lds
buffer_load_dwordx4 v3, s[24:27], s37 offen offset:1024 sc1 lds
buffer_load_dwordx4 v3, s[24:27], s37 offen offset:2048 sc1 lds
buffer_load_dwordx4 v3, s[24:27], s37 offen offset:3072 sc1 lds
s_add_u32 s38, s53, 5636096
s_add_u32 m0, s39, 0
s_nop 0
buffer_load_dwordx4 v23, s[28:31], s38 offen lds
s_add_u32 m0, s39, 1024
s_nop 0
buffer_load_dwordx4 v24, s[28:31], s38 offen lds
s_add_u32 m0, s39, 2048
s_add_u32 s38, s38, 16384
buffer_load_dwordx4 v23, s[28:31], s38 offen lds
s_add_u32 m0, s39, 3072
s_nop 0
buffer_load_dwordx4 v24, s[28:31], s38 offen lds
s_waitcnt vmcnt(24)
s_cmp_eq_u32 s47, 3
s_cbranch_scc0 Lw_150
s_mov_b32 s41, 0x40000
s_branch Lpchk_153
Lpoll_151:
s_load_dword s93, s[82:83], s92 glc
Lpchk_153:
s_waitcnt lgkmcnt(0)
s_cmp_eq_u32 s93, 16
s_cbranch_scc1 Lpok_152
s_sub_u32 s41, s41, 1
s_cmp_lg_u32 s41, 0
s_cbranch_scc1 Lpoll_151
Lpok_152:
Lw_150:
s_barrier
s_add_u32 s37, s90, 0
s_add_u32 m0, s39, 16384
s_nop 0
buffer_load_dwordx4 v3, s[24:27], s37 offen sc1 lds
buffer_load_dwordx4 v3, s[24:27], s37 offen offset:1024 sc1 lds
buffer_load_dwordx4 v3, s[24:27], s37 offen offset:2048 sc1 lds
buffer_load_dwordx4 v3, s[24:27], s37 offen offset:3072 sc1 lds
s_add_u32 s38, s91, 0
s_add_u32 m0, s39, 32768
s_nop 0
buffer_load_dwordx4 v23, s[28:31], s38 offen lds
s_add_u32 m0, s39, 33792
s_nop 0
buffer_load_dwordx4 v24, s[28:31], s38 offen lds
s_add_u32 m0, s39, 34816
s_add_u32 s38, s38, 16384
buffer_load_dwordx4 v23, s[28:31], s38 offen lds
s_add_u32 m0, s39, 35840
s_nop 0
buffer_load_dwordx4 v24, s[28:31], s38 offen lds
s_waitcnt vmcnt(24)
s_barrier
s_add_u32 s37, s90, 16384
s_add_u32 m0, s39, 49152
s_nop 0
buffer_load_dwordx4 v3, s[24:27], s37 offen sc1 lds
buffer_load_dwordx4 v3, s[24:27], s37 offen offset:1024 sc1 lds
buffer_load_dwordx4 v3, s[24:27], s37 offen offset:2048 sc1 lds
buffer_load_dwordx4 v3, s[24:27], s37 offen offset:3072 sc1 lds
s_add_u32 s38, s91, 131072
s_add_u32 m0, s39, 65536
s_nop 0
buffer_load_dwordx4 v23, s[28:31], s38 offen lds
s_add_u32 m0, s39, 66560
s_nop 0
buffer_load_dwordx4 v24, s[28:31], s38 offen lds
s_add_u32 m0, s39, 67584
s_add_u32 s38, s38, 16384
buffer_load_dwordx4 v23, s[28:31], s38 offen lds
s_add_u32 m0, s39, 68608
s_nop 0
buffer_load_dwordx4 v24, s[28:31], s38 offen lds
s_waitcnt vmcnt(24)
s_barrier
s_add_u32 s37, s90, 32768
s_add_u32 m0, s39, 81920
s_nop 0
buffer_load_dwordx4 v3, s[24:27], s37 offen sc1 lds
buffer_load_dwordx4 v3, s[24:27], s37 offen offset:1024 sc1 lds
buffer_load_dwordx4 v3, s[24:27], s37 offen offset:2048 sc1 lds
buffer_load_dwordx4 v3, s[24:27], s37 offen offset:3072 sc1 lds
s_add_u32 s38, s91, 262144
s_add_u32 m0, s39, 147456
s_nop 0
buffer_load_dwordx4 v23, s[28:31], s38 offen lds
s_add_u32 m0, s39, 148480
s_nop 0
buffer_load_dwordx4 v24, s[28:31], s38 offen lds
s_add_u32 m0, s39, 149504
s_add_u32 s38, s38, 16384
buffer_load_dwordx4 v23, s[28:31], s38 offen lds
s_add_u32 m0, s39, 150528
s_nop 0
buffer_load_dwordx4 v24, s[28:31], s38 offen lds
s_waitcnt vmcnt(24)
s_barrier
s_add_u32 s37, s90, 49152
s_add_u32 m0, s39, 98304
s_nop 0
buffer_load_dwordx4 v3, s[24:27], s37 offen sc1 lds
buffer_load_dwordx4 v3, s[24:27], s37 offen offset:1024 sc1 lds
buffer_load_dwordx4 v3, s[24:27], s37 offen offset:2048 sc1 lds
buffer_load_dwordx4 v3, s[24:27], s37 offen offset:3072 sc1 lds
s_add_u32 s38, s91, 393216
s_add_u32 m0, s39, 114688
s_nop 0
buffer_load_dwordx4 v23, s[28:31], s38 offen lds
s_add_u32 m0, s39, 115712
s_nop 0
buffer_load_dwordx4 v24, s[28:31], s38 offen lds
s_add_u32 m0, s39, 116736
s_add_u32 s38, s38, 16384
buffer_load_dwordx4 v23, s[28:31], s38 offen lds
s_add_u32 m0, s39, 117760
s_nop 0
buffer_load_dwordx4 v24, s[28:31], s38 offen lds
s_waitcnt vmcnt(24)
s_barrier
s_add_u32 s37, s90, 65536
s_add_u32 m0, s39, 131072
s_nop 0
buffer_load_dwordx4 v3, s[24:27], s37 offen sc1 lds
buffer_load_dwordx4 v3, s[24:27], s37 offen offset:1024 sc1 lds
buffer_load_dwordx4 v3, s[24:27], s37 offen offset:2048 sc1 lds
buffer_load_dwordx4 v3, s[24:27], s37 offen offset:3072 sc1 lds
s_add_u32 s38, s91, 524288
s_add_u32 m0, s39, 0
s_nop 0
buffer_load_dwordx4 v23, s[28:31], s38 offen lds
s_add_u32 m0, s39, 1024
s_nop 0
buffer_load_dwordx4 v24, s[28:31], s38 offen lds
s_add_u32 m0, s39, 2048
s_add_u32 s38, s38, 16384
buffer_load_dwordx4 v23, s[28:31], s38 offen lds
s_add_u32 m0, s39, 3072
s_nop 0
buffer_load_dwordx4 v24, s[28:31], s38 offen lds
s_waitcnt vmcnt(24)
s_barrier
s_add_u32 s37, s90, 81920
s_add_u32 m0, s39, 16384
s_nop 0
buffer_load_dwordx4 v3, s[24:27], s37 offen sc1 lds
buffer_load_dwordx4 v3, s[24:27], s37 offen offset:1024 sc1 lds
buffer_load_dwordx4 v3, s[24:27], s37 offen offset:2048 sc1 lds
buffer_load_dwordx4 v3, s[24:27], s37 offen offset:3072 sc1 lds
s_add_u32 s38, s91, 655360
s_add_u32 m0, s39, 32768
s_nop 0
buffer_load_dwordx4 v23, s[28:31], s38 offen lds
s_add_u32 m0, s39, 33792
s_nop 0
buffer_load_dwordx4 v24, s[28:31], s38 offen lds
s_add_u32 m0, s39, 34816
s_add_u32 s38, s38, 16384
buffer_load_dwordx4 v23, s[28:31], s38 offen lds
s_add_u32 m0, s39, 35840
s_nop 0
buffer_load_dwordx4 v24, s[28:31], s38 offen lds
s_waitcnt vmcnt(24)
s_barrier
s_add_u32 s37, s90, 98304
s_add_u32 m0, s39, 49152
s_nop 0
buffer_load_dwordx4 v3, s[24:27], s37 offen sc1 lds
buffer_load_dwordx4 v3, s[24:27], s37 offen offset:1024 sc1 lds
buffer_load_dwordx4 v3, s[24:27], s37 offen offset:2048 sc1 lds
buffer_load_dwordx4 v3, s[24:27], s37 offen offset:3072 sc1 lds
s_add_u32 s38, s91, 786432
s_add_u32 m0, s39, 65536
s_nop 0
buffer_load_dwordx4 v23, s[28:31], s38 offen lds
s_add_u32 m0, s39, 66560
s_nop 0
buffer_load_dwordx4 v24, s[28:31], s38 offen lds
s_add_u32 m0, s39, 67584
s_add_u32 s38, s38, 16384
buffer_load_dwordx4 v23, s[28:31], s38 offen lds
s_add_u32 m0, s39, 68608
s_nop 0
buffer_load_dwordx4 v24, s[28:31], s38 offen lds
s_waitcnt vmcnt(24)
s_barrier
s_add_u32 s37, s90, 114688
s_add_u32 m0, s39, 81920
s_nop 0
buffer_load_dwordx4 v3, s[24:27], s37 offen sc1 lds
buffer_load_dwordx4 v3, s[24:27], s37 offen offset:1024 sc1 lds
buffer_load_dwordx4 v3, s[24:27], s37 offen offset:2048 sc1 lds
buffer_load_dwordx4 v3, s[24:27], s37 offen offset:3072 sc1 lds
s_add_u32 s38, s91, 917504
s_add_u32 m0, s39, 147456
s_nop 0
buffer_load_dwordx4 v23, s[28:31], s38 offen lds
s_add_u32 m0, s39, 148480
s_nop 0
buffer_load_dwordx4 v24, s[28:31], s38 offen lds
s_add_u32 m0, s39, 149504
s_add_u32 s38, s38, 16384
buffer_load_dwordx4 v23, s[28:31], s38 offen lds
s_add_u32 m0, s39, 150528
s_nop 0
buffer_load_dwordx4 v24, s[28:31], s38 offen lds
s_waitcnt vmcnt(24)
s_barrier
s_add_u32 s37, s90, 131072
s_add_u32 m0, s39, 98304
s_nop 0
buffer_load_dwordx4 v3, s[24:27], s37 offen sc1 lds
buffer_load_dwordx4 v3, s[24:27], s37 offen offset:1024 sc1 lds
buffer_load_dwordx4 v3, s[24:27], s37 offen offset:2048 sc1 lds
buffer_load_dwordx4 v3, s[24:27], s37 offen offset:3072 sc1 lds
s_add_u32 s38, s91, 1048576
s_add_u32 m0, s39, 114688
s_nop 0
buffer_load_dwordx4 v23, s[28:31], s38 offen lds
s_add_u32 m0, s39, 115712
s_nop 0
buffer_load_dwordx4 v24, s[28:31], s38 offen lds
s_add_u32 m0, s39, 116736
s_add_u32 s38, s38, 16384
buffer_load_dwordx4 v23, s[28:31], s38 offen lds
s_add_u32 m0, s39, 117760
s_nop 0
buffer_load_dwordx4 v24, s[28:31], s38 offen lds
s_waitcnt vmcnt(24)
s_barrier
s_add_u32 s37, s90, 147456
s_add_u32 m0, s39, 131072
s_nop 0
buffer_load_dwordx4 v3, s[24:27], s37 offen sc1 lds
buffer_load_dwordx4 v3, s[24:27], s37 offen offset:1024 sc1 lds
buffer_load_dwordx4 v3, s[24:27], s37 offen offset:2048 sc1 lds
buffer_load_dwordx4 v3, s[24:27], s37 offen offset:3072 sc1 lds
s_add_u32 s38, s91, 1179648
s_add_u32 m0, s39, 0
s_nop 0
buffer_load_dwordx4 v23, s[28:31], s38 offen lds
s_add_u32 m0, s39, 1024
s_nop 0
buffer_load_dwordx4 v24, s[28:31], s38 offen lds
s_add_u32 m0, s39, 2048
s_add_u32 s38, s38, 16384
buffer_load_dwordx4 v23, s[28:31], s38 offen lds
s_add_u32 m0, s39, 3072
s_nop 0
buffer_load_dwordx4 v24, s[28:31], s38 offen lds
s_waitcnt vmcnt(24)
s_barrier
s_mov_b32 s37, 327680
s_add_u32 m0, s39, 16384
s_nop 0
buffer_load_dwordx4 v3, s[24:27], s37 offen sc1 lds
buffer_load_dwordx4 v3, s[24:27], s37 offen offset:1024 sc1 lds
buffer_load_dwordx4 v3, s[24:27], s37 offen offset:2048 sc1 lds
buffer_load_dwordx4 v3, s[24:27], s37 offen offset:3072 sc1 lds
s_mov_b32 s38, 2621440
s_add_u32 m0, s51, 32768
s_nop 0
buffer_load_dwordx4 v25, s[28:31], s38 offen lds
s_add_u32 m0, s51, 33792
s_add_u32 s38, s38, 16384
buffer_load_dwordx4 v25, s[28:31], s38 offen lds
s_waitcnt vmcnt(22)
s_barrier
s_mov_b32 s37, 344064
s_add_u32 m0, s39, 49152
s_nop 0
buffer_load_dwordx4 v3, s[24:27], s37 offen sc1 lds
buffer_load_dwordx4 v3, s[24:27], s37 offen offset:1024 sc1 lds
buffer_load_dwordx4 v3, s[24:27], s37 offen offset:2048 sc1 lds
buffer_load_dwordx4 v3, s[24:27], s37 offen offset:3072 sc1 lds
s_mov_b32 s38, 2752512
s_add_u32 m0, s51, 65536
s_nop 0
buffer_load_dwordx4 v25, s[28:31], s38 offen lds
s_add_u32 m0, s51, 66560
s_add_u32 s38, s38, 16384
buffer_load_dwordx4 v25, s[28:31], s38 offen lds
s_waitcnt vmcnt(20)
s_barrier
s_mov_b32 s37, 360448
s_add_u32 m0, s39, 81920
s_nop 0
buffer_load_dwordx4 v3, s[24:27], s37 offen sc1 lds
buffer_load_dwordx4 v3, s[24:27], s37 offen offset:1024 sc1 lds
buffer_load_dwordx4 v3, s[24:27], s37 offen offset:2048 sc1 lds
buffer_load_dwordx4 v3, s[24:27], s37 offen offset:3072 sc1 lds
s_mov_b32 s38, 2883584
s_add_u32 m0, s51, 147456
s_nop 0
buffer_load_dwordx4 v25, s[28:31], s38 offen lds
s_add_u32 m0, s51, 148480
s_add_u32 s38, s38, 16384
buffer_load_dwordx4 v25, s[28:31], s38 offen lds
s_waitcnt vmcnt(18)
s_barrier
s_mov_b32 s37, 376832
s_add_u32 m0, s39, 98304
s_nop 0
buffer_load_dwordx4 v3, s[24:27], s37 offen sc1 lds
buffer_load_dwordx4 v3, s[24:27], s37 offen offset:1024 sc1 lds
buffer_load_dwordx4 v3, s[24:27], s37 offen offset:2048 sc1 lds
buffer_load_dwordx4 v3, s[24:27], s37 offen offset:3072 sc1 lds
s_mov_b32 s38, 3014656
s_add_u32 m0, s51, 114688
s_nop 0
buffer_load_dwordx4 v25, s[28:31], s38 offen lds
s_add_u32 m0, s51, 115712
s_add_u32 s38, s38, 16384
buffer_load_dwordx4 v25, s[28:31], s38 offen lds
s_waitcnt vmcnt(18)
s_barrier
s_mov_b32 s37, 393216
s_add_u32 m0, s39, 131072
s_nop 0
buffer_load_dwordx4 v3, s[24:27], s37 offen sc1 lds
buffer_load_dwordx4 v3, s[24:27], s37 offen offset:1024 sc1 lds
buffer_load_dwordx4 v3, s[24:27], s37 offen offset:2048 sc1 lds
buffer_load_dwordx4 v3, s[24:27], s37 offen offset:3072 sc1 lds
s_mov_b32 s38, 3145728
s_add_u32 m0, s51, 0
s_nop 0
buffer_load_dwordx4 v25, s[28:31], s38 offen lds
s_add_u32 m0, s51, 1024
s_add_u32 s38, s38, 16384
buffer_load_dwordx4 v25, s[28:31], s38 offen lds
s_waitcnt vmcnt(18)
s_barrier
s_mov_b32 s37, 409600
s_add_u32 m0, s39, 16384
s_nop 0
buffer_load_dwordx4 v3, s[24:27], s37 offen sc1 lds
buffer_load_dwordx4 v3, s[24:27], s37 offen offset:1024 sc1 lds
buffer_load_dwordx4 v3, s[24:27], s37 offen offset:2048 sc1 lds
buffer_load_dwordx4 v3, s[24:27], s37 offen offset:3072 sc1 lds
s_mov_b32 s38, 3276800
s_add_u32 m0, s51, 32768
s_nop 0
buffer_load_dwordx4 v25, s[28:31], s38 offen lds
s_add_u32 m0, s51, 33792
s_add_u32 s38, s38, 16384
buffer_load_dwordx4 v25, s[28:31], s38 offen lds
s_waitcnt vmcnt(18)
s_barrier
s_mov_b32 s37, 425984
s_add_u32 m0, s39, 49152
s_nop 0
buffer_load_dwordx4 v3, s[24:27], s37 offen sc1 lds
buffer_load_dwordx4 v3, s[24:27], s37 offen offset:1024 sc1 lds
buffer_load_dwordx4 v3, s[24:27], s37 offen offset:2048 sc1 lds
buffer_load_dwordx4 v3, s[24:27], s37 offen offset:3072 sc1 lds
s_mov_b32 s38, 3407872
s_add_u32 m0, s51, 65536
s_nop 0
buffer_load_dwordx4 v25, s[28:31], s38 offen lds
s_add_u32 m0, s51, 66560
s_add_u32 s38, s38, 16384
buffer_load_dwordx4 v25, s[28:31], s38 offen lds
s_waitcnt vmcnt(18)
s_barrier
s_mov_b32 s37, 442368
s_add_u32 m0, s39, 81920
s_nop 0
buffer_load_dwordx4 v3, s[24:27], s37 offen sc1 lds
buffer_load_dwordx4 v3, s[24:27], s37 offen offset:1024 sc1 lds
buffer_load_dwordx4 v3, s[24:27], s37 offen offset:2048 sc1 lds
buffer_load_dwordx4 v3, s[24:27], s37 offen offset:3072 sc1 lds
s_mov_b32 s38, 3538944
s_add_u32 m0, s51, 147456
s_nop 0
buffer_load_dwordx4 v25, s[28:31], s38 offen lds
s_add_u32 m0, s51, 148480
s_add_u32 s38, s38, 16384
buffer_load_dwordx4 v25, s[28:31], s38 offen lds
s_waitcnt vmcnt(18)
s_barrier
s_mov_b32 s37, 458752
s_add_u32 m0, s39, 98304
s_nop 0
buffer_load_dwordx4 v3, s[24:27], s37 offen sc1 lds
buffer_load_dwordx4 v3, s[24:27], s37 offen offset:1024 sc1 lds
buffer_load_dwordx4 v3, s[24:27], s37 offen offset:2048 sc1 lds
buffer_load_dwordx4 v3, s[24:27], s37 offen offset:3072 sc1 lds
s_mov_b32 s38, 3670016
s_add_u32 m0, s51, 114688
s_nop 0
buffer_load_dwordx4 v25, s[28:31], s38 offen lds
s_add_u32 m0, s51, 115712
s_add_u32 s38, s38, 16384
buffer_load_dwordx4 v25, s[28:31], s38 offen lds
s_waitcnt vmcnt(18)
s_barrier
s_mov_b32 s37, 475136
s_add_u32 m0, s39, 131072
s_nop 0
buffer_load_dwordx4 v3, s[24:27], s37 offen sc1 lds
buffer_load_dwordx4 v3, s[24:27], s37 offen offset:1024 sc1 lds
buffer_load_dwordx4 v3, s[24:27], s37 offen offset:2048 sc1 lds
buffer_load_dwordx4 v3, s[24:27], s37 offen offset:3072 sc1 lds
s_mov_b32 s38, 3801088
s_add_u32 m0, s51, 0
s_nop 0
buffer_load_dwordx4 v25, s[28:31], s38 offen lds
s_add_u32 m0, s51, 1024
s_add_u32 s38, s38, 16384
buffer_load_dwordx4 v25, s[28:31], s38 offen lds
s_waitcnt vmcnt(18)
s_barrier
s_cmp_eq_u32 s47, 0
s_cbranch_scc0 Lw_154
s_xor_b32 s43, s2, 2
s_add_u32 s43, s43, 128
s_lshl_b32 s43, s43, 7
v_mov_b32 v26, s43
v_mov_b32 v27, 1
s_mov_b64 exec, 1
buffer_store_dword v27, v26, s[56:59], 0 offen sc1
s_mov_b64 exec, -1
Lw_154:
s_mov_b32 s37, 491520
s_add_u32 m0, s39, 16384
s_nop 0
buffer_load_dwordx4 v3, s[24:27], s37 offen sc1 lds
buffer_load_dwordx4 v3, s[24:27], s37 offen offset:1024 sc1 lds
buffer_load_dwordx4 v3, s[24:27], s37 offen offset:2048 sc1 lds
buffer_load_dwordx4 v3, s[24:27], s37 offen offset:3072 sc1 lds
s_mov_b32 s38, 3932160
s_add_u32 m0, s51, 32768
s_nop 0
buffer_load_dwordx4 v25, s[28:31], s38 offen lds
s_add_u32 m0, s51, 33792
s_add_u32 s38, s38, 16384
buffer_load_dwordx4 v25, s[28:31], s38 offen lds
s_waitcnt vmcnt(18)
s_barrier
s_mov_b32 s37, 507904
s_add_u32 m0, s39, 49152
s_nop 0
buffer_load_dwordx4 v3, s[24:27], s37 offen sc1 lds
buffer_load_dwordx4 v3, s[24:27], s37 offen offset:1024 sc1 lds
buffer_load_dwordx4 v3, s[24:27], s37 offen offset:2048 sc1 lds
buffer_load_dwordx4 v3, s[24:27], s37 offen offset:3072 sc1 lds
s_mov_b32 s38, 4063232
s_add_u32 m0, s51, 65536
s_nop 0
buffer_load_dwordx4 v25, s[28:31], s38 offen lds
s_add_u32 m0, s51, 66560
s_add_u32 s38, s38, 16384
buffer_load_dwordx4 v25, s[28:31], s38 offen lds
s_waitcnt vmcnt(18)
s_barrier
s_cmp_eq_u32 s47, 3
s_cbranch_scc0 Lw_155
s_lshl_b32 s92, s2, 7
s_add_u32 s92, s92, 28327936
s_load_dword s93, s[82:83], s92 glc
Lw_155:
s_waitcnt vmcnt(12)
s_cmp_eq_u32 s47, 3
s_cbranch_scc0 Lw_156
s_mov_b32 s41, 0x40000
s_branch Lpchk_159
Lpoll_157:
s_load_dword s93, s[82:83], s92 glc
Lpchk_159:
s_waitcnt lgkmcnt(0)
s_cmp_eq_u32 s93, 1
s_cbranch_scc1 Lpok_158
s_sub_u32 s41, s41, 1
s_cmp_lg_u32 s41, 0
s_cbranch_scc1 Lpoll_157
Lpok_158:
Lw_156:
s_barrier
s_waitcnt vmcnt(6)
s_barrier
s_waitcnt vmcnt(0)
s_barrier
s_barrier
s_branch Ldone_1
Ldone_1:
Lfin:
Lexit_2:
s_endpgm
.fill 1024, 4, 0xbf800000
.section .rodata,"a"
.p2align 6
.amdhsa_kernel sequential_preLN__sliding_local_dilated__glu_gated_geglu__prompt_kernel
  .amdhsa_next_free_vgpr 256
  .amdhsa_next_free_sgpr 102
  .amdhsa_accum_offset 256
  .amdhsa_group_segment_fixed_size 0
  .amdhsa_kernarg_size 80
  .amdhsa_user_sgpr_count 2
  .amdhsa_user_sgpr_kernarg_segment_ptr 1
  .amdhsa_system_sgpr_workgroup_id_x 1
  .amdhsa_float_denorm_mode_32 3
  .amdhsa_float_denorm_mode_16_64 3
.end_amdhsa_kernel
```

```asm
; @launch grid=(256,1,1) block=(512,1,1) lds=163840
.amdgcn_target "amdgcn-amd-amdhsa--gfx950"
.text
.globl sequential_preLN__sliding_local_dilated__glu_gated_geglu__prompt_kernel
.p2align 8
.type sequential_preLN__sliding_local_dilated__glu_gated_geglu__prompt_kernel,@function
sequential_preLN__sliding_local_dilated__glu_gated_geglu__prompt_kernel:
s_cmp_ge_u32 s2, 256
s_cbranch_scc1 Lexit_2
s_load_dwordx16 s[64:79], s[0:1], 0
s_load_dwordx4 s[80:83], s[0:1], 64
s_and_b32 s3, s2, 7
s_lshr_b32 s42, s2, 3
s_and_b32 s34, s3, 1
s_lshl_b32 s34, s34, 3
s_and_b32 s48, s42, 7
s_add_u32 s34, s34, s48
s_lshr_b32 s35, s3, 1
s_lshr_b32 s49, s42, 3
s_lshl_b32 s35, s35, 2
s_add_u32 s35, s35, s49
v_lshrrev_b32 v12, 6, v0
v_and_b32 v1, 63, v0
v_readfirstlane_b32 s36, v12
Lbeg:
s_lshl_b32 s50, s34, 7
s_sub_u32 s50, s50, 16
v_and_b32 v12, 15, v1
v_lshrrev_b32 v13, 4, v1
s_cmp_lt_u32 s36, 4
s_cbranch_scc1 Lcons_7
Lprod_3:
s_sub_u32 s47, s36, 4
s_lshl_b32 s43, s34, 7
s_lshl_b32 s44, s35, 3
s_add_u32 s63, s43, s44
s_lshl_b32 s44, s47, 1
s_add_u32 s51, s63, s44
v_lshlrev_b32 v10, 4, v1
s_and_b32 s43, s2, 7
s_lshr_b32 s44, s43, 2
s_lshl_b32 s44, s44, 1
s_and_b32 s45, s43, 1
s_add_u32 s44, s44, s45
s_lshr_b32 s45, s2, 3
s_lshl_b32 s45, s45, 2
s_add_u32 s44, s44, s45
s_add_u32 s44, s44, 96
s_bitcmp1_b32 s43, 1
s_cselect_b32 s44, s44, 0x10000
s_cmp_lt_u32 s2, 192
s_cselect_b32 s33, s2, s44
v_lshrrev_b32 v14, 3, v1
v_and_b32 v15, 7, v1
v_lshl_add_u32 v19, v14, 6, v15
s_lshl_b32 s43, s48, 3
v_add_u32 v19, s43, v19
v_mul_u32_u24 v19, 6144, v19
s_cmp_eq_u32 s47, 3
s_cbranch_scc1 Lpf_4
v_and_b32 v16, 2, v14
v_xor_b32 v16, v15, v16
v_lshlrev_b32 v16, 4, v16
v_mul_u32_u24 v17, 6144, v14
s_lshl_b32 s43, s47, 11
v_add3_u32 v2, v17, v16, s43
v_xor_b32 v3, 64, v2
v_lshrrev_b32 v16, 1, v14
v_xor_b32 v16, v15, v16
v_lshlrev_b32 v16, 4, v16
s_lshl_b32 s43, s47, 3
s_add_u32 s43, s43, s50
v_add_u32 v17, s43, v14
s_and_b32 s44, s47, 1
s_lshl_b32 s44, s44, 6
v_add_u32 v18, 0, v17
v_max_i32 v18, 0, v18
v_lshl_add_u32 v18, v18, 11, v16
v_xor_b32 v18, s44, v18
v_mov_b32 v4, v18
v_add_u32 v18, 24, v17
v_max_i32 v18, 0, v18
v_lshl_add_u32 v18, v18, 11, v16
v_xor_b32 v18, s44, v18
v_xor_b32 v5, 64, v18
v_add_u32 v18, 48, v17
v_max_i32 v18, 0, v18
v_lshl_add_u32 v18, v18, 11, v16
v_xor_b32 v18, s44, v18
v_mov_b32 v6, v18
v_add_u32 v18, 72, v17
v_max_i32 v18, 0, v18
v_lshl_add_u32 v18, v18, 11, v16
v_xor_b32 v18, s44, v18
v_xor_b32 v7, 64, v18
v_add_u32 v18, 96, v17
v_max_i32 v18, 0, v18
v_lshl_add_u32 v18, v18, 11, v16
v_xor_b32 v18, s44, v18
v_mov_b32 v8, v18
v_add_u32 v18, 120, v17
v_max_i32 v18, 0, v18
v_lshl_add_u32 v18, v18, 11, v16
v_xor_b32 v18, s44, v18
v_xor_b32 v9, 64, v18
s_lshl_b32 s39, s47, 10
s_lshl_b32 s40, s47, 13
s_add_u32 s40, s40, 18432
s_mov_b32 s37, 0
s_mov_b32 s38, 0
s_bfm_b64 s[60:61], 56, 8
s_cmp_eq_u32 s47, 0
s_cselect_b64 s[60:61], s[60:61], -1
s_lshl_b32 s43, s35, 7
s_waitcnt lgkmcnt(0)
s_mov_b32 s8, s64
s_mov_b32 s9, s65
s_mov_b32 s10, 4194304
s_mov_b32 s11, 0x20000
s_add_u32 s12, s66, s43
s_addc_u32 s13, s67, 0
s_mov_b32 s14, 6289536
s_mov_b32 s15, 0x20000
s_mov_b32 s28, s66
s_mov_b32 s29, s67
s_mov_b32 s30, 6291456
s_mov_b32 s31, 0x20000
s_mul_i32 s43, s33, 7296
v_lshlrev_b32 v30, 7, v1
s_mul_i32 s44, s47, 2432
s_add_u32 s43, s43, s44
s_bfm_b64 exec, 19, 0
buffer_load_dword v31, v30, s[28:31], s43 offen
s_mov_b64 exec, -1
s_add_u32 m0, s39, 0
s_mov_b64 exec, s[60:61]
buffer_load_dwordx4 v4, s[8:11], s37 offen lds
s_mov_b64 exec, -1
s_add_u32 m0, s39, 3072
s_nop 0
buffer_load_dwordx4 v5, s[8:11], s37 offen lds
s_add_u32 m0, s39, 6144
s_nop 0
buffer_load_dwordx4 v6, s[8:11], s37 offen lds
s_add_u32 m0, s39, 9216
s_nop 0
buffer_load_dwordx4 v7, s[8:11], s37 offen lds
s_add_u32 m0, s39, 12288
s_nop 0
buffer_load_dwordx4 v8, s[8:11], s37 offen lds
s_add_u32 m0, s39, 15360
s_nop 0
buffer_load_dwordx4 v9, s[8:11], s37 offen lds
s_add_u32 m0, s40, 0
s_add_u32 s43, s38, 0
buffer_load_dwordx4 v2, s[12:15], s43 offen lds
s_add_u32 m0, s40, 1024
s_add_u32 s43, s38, 49152
buffer_load_dwordx4 v3, s[12:15], s43 offen lds
s_add_u32 m0, s40, 2048
s_add_u32 s43, s38, 98304
buffer_load_dwordx4 v2, s[12:15], s43 offen lds
s_add_u32 m0, s40, 3072
s_add_u32 s43, s38, 147456
buffer_load_dwordx4 v3, s[12:15], s43 offen lds
s_add_u32 m0, s40, 4096
s_add_u32 s43, s38, 196608
buffer_load_dwordx4 v2, s[12:15], s43 offen lds
s_add_u32 m0, s40, 5120
s_add_u32 s43, s38, 245760
buffer_load_dwordx4 v3, s[12:15], s43 offen lds
s_add_u32 m0, s40, 6144
s_add_u32 s43, s38, 294912
buffer_load_dwordx4 v2, s[12:15], s43 offen lds
s_add_u32 m0, s40, 7168
s_add_u32 s43, s38, 344064
buffer_load_dwordx4 v3, s[12:15], s43 offen lds
s_add_u32 s37, s37, 128
s_add_u32 s38, s38, 393216
s_lshl_b32 s43, s51, 11
buffer_load_dwordx4 v[96:99], v10, s[8:11], s43 offen offset:0
buffer_load_dwordx4 v[100:103], v10, s[8:11], s43 offen offset:1024
buffer_load_dwordx4 v[104:107], v10, s[8:11], s43 offen offset:2048
buffer_load_dwordx4 v[108:111], v10, s[8:11], s43 offen offset:3072
s_add_u32 m0, s39, 43008
s_mov_b64 exec, s[60:61]
buffer_load_dwordx4 v4, s[8:11], s37 offen lds
s_mov_b64 exec, -1
s_add_u32 m0, s39, 46080
s_nop 0
buffer_load_dwordx4 v5, s[8:11], s37 offen lds
s_add_u32 m0, s39, 49152
s_nop 0
buffer_load_dwordx4 v6, s[8:11], s37 offen lds
s_add_u32 m0, s39, 52224
s_nop 0
buffer_load_dwordx4 v7, s[8:11], s37 offen lds
s_add_u32 m0, s39, 55296
s_nop 0
buffer_load_dwordx4 v8, s[8:11], s37 offen lds
s_add_u32 m0, s39, 58368
s_nop 0
buffer_load_dwordx4 v9, s[8:11], s37 offen lds
s_add_u32 m0, s40, 43008
s_add_u32 s43, s38, 0
buffer_load_dwordx4 v2, s[12:15], s43 offen lds
s_add_u32 m0, s40, 44032
s_add_u32 s43, s38, 49152
buffer_load_dwordx4 v3, s[12:15], s43 offen lds
s_add_u32 m0, s40, 45056
s_add_u32 s43, s38, 98304
buffer_load_dwordx4 v2, s[12:15], s43 offen lds
s_add_u32 m0, s40, 46080
s_add_u32 s43, s38, 147456
buffer_load_dwordx4 v3, s[12:15], s43 offen lds
s_add_u32 m0, s40, 47104
s_add_u32 s43, s38, 196608
buffer_load_dwordx4 v2, s[12:15], s43 offen lds
s_add_u32 m0, s40, 48128
s_add_u32 s43, s38, 245760
buffer_load_dwordx4 v3, s[12:15], s43 offen lds
s_add_u32 m0, s40, 49152
s_add_u32 s43, s38, 294912
buffer_load_dwordx4 v2, s[12:15], s43 offen lds
s_add_u32 m0, s40, 50176
s_add_u32 s43, s38, 344064
buffer_load_dwordx4 v3, s[12:15], s43 offen lds
s_add_u32 s37, s37, 128
s_add_u32 s38, s38, 393216
s_waitcnt vmcnt(18)
s_barrier
s_add_u32 m0, s39, 86016
s_mov_b64 exec, s[60:61]
buffer_load_dwordx4 v4, s[8:11], s37 offen lds
s_mov_b64 exec, -1
s_add_u32 m0, s39, 89088
s_nop 0
buffer_load_dwordx4 v5, s[8:11], s37 offen lds
s_add_u32 m0, s39, 92160
s_nop 0
buffer_load_dwordx4 v6, s[8:11], s37 offen lds
s_add_u32 m0, s39, 95232
s_nop 0
buffer_load_dwordx4 v7, s[8:11], s37 offen lds
s_add_u32 m0, s39, 98304
s_nop 0
buffer_load_dwordx4 v8, s[8:11], s37 offen lds
s_add_u32 m0, s39, 101376
s_nop 0
buffer_load_dwordx4 v9, s[8:11], s37 offen lds
s_add_u32 m0, s40, 86016
s_add_u32 s43, s38, 0
buffer_load_dwordx4 v2, s[12:15], s43 offen lds
s_add_u32 m0, s40, 87040
s_add_u32 s43, s38, 49152
buffer_load_dwordx4 v3, s[12:15], s43 offen lds
s_add_u32 m0, s40, 88064
s_add_u32 s43, s38, 98304
buffer_load_dwordx4 v2, s[12:15], s43 offen lds
s_add_u32 m0, s40, 89088
s_add_u32 s43, s38, 147456
buffer_load_dwordx4 v3, s[12:15], s43 offen lds
s_add_u32 m0, s40, 90112
s_add_u32 s43, s38, 196608
buffer_load_dwordx4 v2, s[12:15], s43 offen lds
s_add_u32 m0, s40, 91136
s_add_u32 s43, s38, 245760
buffer_load_dwordx4 v3, s[12:15], s43 offen lds
s_add_u32 m0, s40, 92160
s_add_u32 s43, s38, 294912
buffer_load_dwordx4 v2, s[12:15], s43 offen lds
s_add_u32 m0, s40, 93184
s_add_u32 s43, s38, 344064
buffer_load_dwordx4 v3, s[12:15], s43 offen lds
s_add_u32 s37, s37, 128
s_add_u32 s38, s38, 393216
s_waitcnt vmcnt(28)
s_mov_b32 s43, 0x3f803f80
v_mov_b32 v116, 0
v_mov_b32 v117, 0
v_mov_b32 v118, 0
v_mov_b32 v119, 0
v_mov_b32 v120, 0
v_mov_b32 v121, 0
v_mov_b32 v122, 0
v_mov_b32 v123, 0
v_dot2_f32_bf16 v116, v96, s43, v116
v_dot2_f32_bf16 v120, v96, v96, v120
v_dot2_f32_bf16 v118, v104, s43, v118
v_dot2_f32_bf16 v122, v104, v104, v122
v_dot2_f32_bf16 v117, v97, s43, v117
v_dot2_f32_bf16 v121, v97, v97, v121
v_dot2_f32_bf16 v119, v105, s43, v119
v_dot2_f32_bf16 v123, v105, v105, v123
v_dot2_f32_bf16 v116, v98, s43, v116
v_dot2_f32_bf16 v120, v98, v98, v120
v_dot2_f32_bf16 v118, v106, s43, v118
v_dot2_f32_bf16 v122, v106, v106, v122
v_dot2_f32_bf16 v117, v99, s43, v117
v_dot2_f32_bf16 v121, v99, v99, v121
v_dot2_f32_bf16 v119, v107, s43, v119
v_dot2_f32_bf16 v123, v107, v107, v123
v_dot2_f32_bf16 v116, v100, s43, v116
v_dot2_f32_bf16 v120, v100, v100, v120
v_dot2_f32_bf16 v118, v108, s43, v118
v_dot2_f32_bf16 v122, v108, v108, v122
v_dot2_f32_bf16 v117, v101, s43, v117
v_dot2_f32_bf16 v121, v101, v101, v121
v_dot2_f32_bf16 v119, v109, s43, v119
v_dot2_f32_bf16 v123, v109, v109, v123
v_dot2_f32_bf16 v116, v102, s43, v116
v_dot2_f32_bf16 v120, v102, v102, v120
v_dot2_f32_bf16 v118, v110, s43, v118
v_dot2_f32_bf16 v122, v110, v110, v122
v_dot2_f32_bf16 v117, v103, s43, v117
v_dot2_f32_bf16 v121, v103, v103, v121
v_dot2_f32_bf16 v119, v111, s43, v119
v_dot2_f32_bf16 v123, v111, v111, v123
s_nop 2
v_add_f32 v116, v116, v117
v_add_f32 v118, v118, v119
v_add_f32 v120, v120, v121
v_add_f32 v122, v122, v123
s_nop 1
v_permlane32_swap_b32 v116, v118
v_permlane32_swap_b32 v120, v122
v_add_f32 v116, v116, v118
v_add_f32 v120, v120, v122
s_nop 1
v_permlane16_swap_b32 v116, v120
v_add_f32 v116, v116, v120
s_nop 1
v_add_f32_dpp v116, v116, v116 row_ror:8 row_mask:0xf bank_mask:0xf
s_nop 1
v_add_f32_dpp v116, v116, v116 row_ror:4 row_mask:0xf bank_mask:0xf
s_nop 1
v_add_f32_dpp v116, v116, v116 row_ror:2 row_mask:0xf bank_mask:0xf
s_nop 1
v_add_f32_dpp v116, v116, v116 row_ror:1 row_mask:0xf bank_mask:0xf
v_mov_b32 v117, v116
s_nop 1
v_permlane16_swap_b32 v116, v117
v_mul_f32 v112, 0x3a800000, v116
v_mul_f32 v113, 0x3a800000, v117
v_fma_f32 v113, -v112, v112, v113
v_max_f32 v113, 0, v113
v_add_f32 v113, 0x3727c5ac, v113
v_rsq_f32 v113, v113
v_lshrrev_b32 v11, 5, v1
s_lshl_b32 s43, s47, 4
s_add_u32 s43, s43, 148608
v_lshl_add_u32 v11, v11, 3, s43
ds_write_b64 v11, v[112:113]
s_waitcnt lgkmcnt(0)
s_and_b32 s44, s36, 3
s_mul_i32 s44, s44, 28
s_bfe_u32 s43, s2, 0x30001
s_lshl_b32 s43, s43, 7
s_add_u32 s44, s44, s43
s_mul_i32 s44, s44, 7168
s_lshr_b32 s43, s2, 4
s_lshl_b32 s43, s43, 8
s_add_u32 s43, s43, s44
s_bitcmp0_b32 s2, 0
s_cselect_b32 s4, s72, s74
s_cselect_b32 s5, s73, s75
s_add_u32 s4, s4, s43
s_addc_u32 s5, s5, 0
Lsp_8:
s_waitcnt vmcnt(14)
s_barrier
s_add_u32 m0, s39, 0
s_mov_b64 exec, s[60:61]
buffer_load_dwordx4 v4, s[8:11], s37 offen lds
s_mov_b64 exec, -1
s_add_u32 m0, s39, 3072
s_nop 0
buffer_load_dwordx4 v5, s[8:11], s37 offen lds
s_add_u32 m0, s39, 6144
s_nop 0
buffer_load_dwordx4 v6, s[8:11], s37 offen lds
s_add_u32 m0, s39, 9216
s_nop 0
buffer_load_dwordx4 v7, s[8:11], s37 offen lds
s_add_u32 m0, s39, 12288
s_nop 0
buffer_load_dwordx4 v8, s[8:11], s37 offen lds
s_add_u32 m0, s39, 15360
s_nop 0
buffer_load_dwordx4 v9, s[8:11], s37 offen lds
s_add_u32 m0, s40, 0
s_add_u32 s43, s38, 0
buffer_load_dwordx4 v2, s[12:15], s43 offen lds
s_add_u32 m0, s40, 1024
s_add_u32 s43, s38, 49152
buffer_load_dwordx4 v3, s[12:15], s43 offen lds
s_add_u32 m0, s40, 2048
s_add_u32 s43, s38, 98304
buffer_load_dwordx4 v2, s[12:15], s43 offen lds
s_add_u32 m0, s40, 3072
s_add_u32 s43, s38, 147456
buffer_load_dwordx4 v3, s[12:15], s43 offen lds
s_add_u32 m0, s40, 4096
s_add_u32 s43, s38, 196608
buffer_load_dwordx4 v2, s[12:15], s43 offen lds
s_add_u32 m0, s40, 5120
s_add_u32 s43, s38, 245760
buffer_load_dwordx4 v3, s[12:15], s43 offen lds
s_add_u32 m0, s40, 6144
s_add_u32 s43, s38, 294912
buffer_load_dwordx4 v2, s[12:15], s43 offen lds
s_add_u32 m0, s40, 7168
s_add_u32 s43, s38, 344064
buffer_load_dwordx4 v3, s[12:15], s43 offen lds
s_add_u32 s37, s37, 128
s_add_u32 s38, s38, 393216
Lsp_9:
s_waitcnt vmcnt(14)
s_barrier
s_add_u32 m0, s39, 43008
s_mov_b64 exec, s[60:61]
buffer_load_dwordx4 v4, s[8:11], s37 offen lds
s_mov_b64 exec, -1
s_add_u32 m0, s39, 46080
s_nop 0
buffer_load_dwordx4 v5, s[8:11], s37 offen lds
s_add_u32 m0, s39, 49152
s_nop 0
buffer_load_dwordx4 v6, s[8:11], s37 offen lds
s_add_u32 m0, s39, 52224
s_nop 0
buffer_load_dwordx4 v7, s[8:11], s37 offen lds
s_add_u32 m0, s39, 55296
s_nop 0
buffer_load_dwordx4 v8, s[8:11], s37 offen lds
s_add_u32 m0, s39, 58368
s_nop 0
buffer_load_dwordx4 v9, s[8:11], s37 offen lds
s_add_u32 m0, s40, 43008
s_add_u32 s43, s38, 0
buffer_load_dwordx4 v2, s[12:15], s43 offen lds
s_add_u32 m0, s40, 44032
s_add_u32 s43, s38, 49152
buffer_load_dwordx4 v3, s[12:15], s43 offen lds
s_add_u32 m0, s40, 45056
s_add_u32 s43, s38, 98304
buffer_load_dwordx4 v2, s[12:15], s43 offen lds
s_add_u32 m0, s40, 46080
s_add_u32 s43, s38, 147456
buffer_load_dwordx4 v3, s[12:15], s43 offen lds
s_add_u32 m0, s40, 47104
s_add_u32 s43, s38, 196608
buffer_load_dwordx4 v2, s[12:15], s43 offen lds
s_add_u32 m0, s40, 48128
s_add_u32 s43, s38, 245760
buffer_load_dwordx4 v3, s[12:15], s43 offen lds
s_add_u32 m0, s40, 49152
s_add_u32 s43, s38, 294912
buffer_load_dwordx4 v2, s[12:15], s43 offen lds
s_add_u32 m0, s40, 50176
s_add_u32 s43, s38, 344064
buffer_load_dwordx4 v3, s[12:15], s43 offen lds
s_add_u32 s37, s37, 128
s_add_u32 s38, s38, 393216
s_load_dword s3, s[4:5], 0
s_load_dword s3, s[4:5], 64
s_load_dword s3, s[4:5], 128
Lsp_10:
s_waitcnt vmcnt(14)
s_barrier
s_add_u32 m0, s39, 86016
s_mov_b64 exec, s[60:61]
buffer_load_dwordx4 v4, s[8:11], s37 offen lds
s_mov_b64 exec, -1
s_add_u32 m0, s39, 89088
s_nop 0
buffer_load_dwordx4 v5, s[8:11], s37 offen lds
s_add_u32 m0, s39, 92160
s_nop 0
buffer_load_dwordx4 v6, s[8:11], s37 offen lds
s_add_u32 m0, s39, 95232
s_nop 0
buffer_load_dwordx4 v7, s[8:11], s37 offen lds
s_add_u32 m0, s39, 98304
s_nop 0
buffer_load_dwordx4 v8, s[8:11], s37 offen lds
s_add_u32 m0, s39, 101376
s_nop 0
buffer_load_dwordx4 v9, s[8:11], s37 offen lds
s_add_u32 m0, s40, 86016
s_add_u32 s43, s38, 0
buffer_load_dwordx4 v2, s[12:15], s43 offen lds
s_add_u32 m0, s40, 87040
s_add_u32 s43, s38, 49152
buffer_load_dwordx4 v3, s[12:15], s43 offen lds
s_add_u32 m0, s40, 88064
s_add_u32 s43, s38, 98304
buffer_load_dwordx4 v2, s[12:15], s43 offen lds
s_add_u32 m0, s40, 89088
s_add_u32 s43, s38, 147456
buffer_load_dwordx4 v3, s[12:15], s43 offen lds
s_add_u32 m0, s40, 90112
s_add_u32 s43, s38, 196608
buffer_load_dwordx4 v2, s[12:15], s43 offen lds
s_add_u32 m0, s40, 91136
s_add_u32 s43, s38, 245760
buffer_load_dwordx4 v3, s[12:15], s43 offen lds
s_add_u32 m0, s40, 92160
s_add_u32 s43, s38, 294912
buffer_load_dwordx4 v2, s[12:15], s43 offen lds
s_add_u32 m0, s40, 93184
s_add_u32 s43, s38, 344064
buffer_load_dwordx4 v3, s[12:15], s43 offen lds
s_add_u32 s37, s37, 128
s_add_u32 s38, s38, 393216
s_load_dword s3, s[4:5], 192
s_load_dword s3, s[4:5], 7168
s_load_dword s3, s[4:5], 7232
s_load_dword s3, s[4:5], 7296
s_load_dword s3, s[4:5], 7360
Lsp_11:
s_waitcnt vmcnt(14)
s_barrier
s_add_u32 m0, s39, 0
s_mov_b64 exec, s[60:61]
buffer_load_dwordx4 v4, s[8:11], s37 offen lds
s_mov_b64 exec, -1
s_add_u32 m0, s39, 3072
s_nop 0
buffer_load_dwordx4 v5, s[8:11], s37 offen lds
s_add_u32 m0, s39, 6144
s_nop 0
buffer_load_dwordx4 v6, s[8:11], s37 offen lds
s_branch Lov_0
.p2align 12
Lst_0_0:
s_branch Lwr_160
s_nop 0
s_nop 0
Lov_0:
s_add_u32 m0, s39, 9216
s_nop 0
buffer_load_dwordx4 v7, s[8:11], s37 offen lds
s_add_u32 m0, s39, 12288
s_nop 0
buffer_load_dwordx4 v8, s[8:11], s37 offen lds
s_add_u32 m0, s39, 15360
s_nop 0
buffer_load_dwordx4 v9, s[8:11], s37 offen lds
s_add_u32 m0, s40, 0
s_add_u32 s43, s38, 0
buffer_load_dwordx4 v2, s[12:15], s43 offen lds
s_add_u32 m0, s40, 1024
s_add_u32 s43, s38, 49152
buffer_load_dwordx4 v3, s[12:15], s43 offen lds
s_add_u32 m0, s40, 2048
s_add_u32 s43, s38, 98304
buffer_load_dwordx4 v2, s[12:15], s43 offen lds
s_add_u32 m0, s40, 3072
s_add_u32 s43, s38, 147456
buffer_load_dwordx4 v3, s[12:15], s43 offen lds
s_add_u32 m0, s40, 4096
s_add_u32 s43, s38, 196608
buffer_load_dwordx4 v2, s[12:15], s43 offen lds
s_add_u32 m0, s40, 5120
s_add_u32 s43, s38, 245760
buffer_load_dwordx4 v3, s[12:15], s43 offen lds
s_add_u32 m0, s40, 6144
s_add_u32 s43, s38, 294912
buffer_load_dwordx4 v2, s[12:15], s43 offen lds
s_add_u32 m0, s40, 7168
s_add_u32 s43, s38, 344064
buffer_load_dwordx4 v3, s[12:15], s43 offen lds
s_add_u32 s37, s37, 128
s_add_u32 s38, s38, 393216
s_load_dword s3, s[4:5], 14336
s_load_dword s3, s[4:5], 14400
s_load_dword s3, s[4:5], 14464
s_load_dword s3, s[4:5], 14528
s_load_dword s3, s[4:5], 21504
s_load_dword s3, s[4:5], 21568
Lsp_12:
s_waitcnt vmcnt(14)
s_barrier
s_add_u32 m0, s39, 43008
s_mov_b64 exec, s[60:61]
buffer_load_dwordx4 v4, s[8:11], s37 offen lds
s_mov_b64 exec, -1
s_add_u32 m0, s39, 46080
s_nop 0
buffer_load_dwordx4 v5, s[8:11], s37 offen lds
s_add_u32 m0, s39, 49152
s_nop 0
buffer_load_dwordx4 v6, s[8:11], s37 offen lds
s_add_u32 m0, s39, 52224
s_nop 0
buffer_load_dwordx4 v7, s[8:11], s37 offen lds
s_add_u32 m0, s39, 55296
s_nop 0
buffer_load_dwordx4 v8, s[8:11], s37 offen lds
s_add_u32 m0, s39, 58368
s_nop 0
buffer_load_dwordx4 v9, s[8:11], s37 offen lds
s_add_u32 m0, s40, 43008
s_add_u32 s43, s38, 0
buffer_load_dwordx4 v2, s[12:15], s43 offen lds
s_add_u32 m0, s40, 44032
s_add_u32 s43, s38, 49152
buffer_load_dwordx4 v3, s[12:15], s43 offen lds
s_add_u32 m0, s40, 45056
s_add_u32 s43, s38, 98304
buffer_load_dwordx4 v2, s[12:15], s43 offen lds
s_add_u32 m0, s40, 46080
s_add_u32 s43, s38, 147456
buffer_load_dwordx4 v3, s[12:15], s43 offen lds
s_add_u32 m0, s40, 47104
s_add_u32 s43, s38, 196608
buffer_load_dwordx4 v2, s[12:15], s43 offen lds
s_add_u32 m0, s40, 48128
s_add_u32 s43, s38, 245760
buffer_load_dwordx4 v3, s[12:15], s43 offen lds
s_add_u32 m0, s40, 49152
s_add_u32 s43, s38, 294912
buffer_load_dwordx4 v2, s[12:15], s43 offen lds
s_add_u32 m0, s40, 50176
s_add_u32 s43, s38, 344064
buffer_load_dwordx4 v3, s[12:15], s43 offen lds
s_add_u32 s37, s37, 128
s_add_u32 s38, s38, 393216
s_load_dword s3, s[4:5], 21632
s_load_dword s3, s[4:5], 21696
s_load_dword s3, s[4:5], 28672
s_load_dword s3, s[4:5], 28736
s_load_dword s3, s[4:5], 28800
s_load_dword s3, s[4:5], 28864
s_load_dword s3, s[4:5], 35840
Lsp_13:
s_waitcnt vmcnt(14)
s_barrier
s_add_u32 m0, s39, 86016
s_mov_b64 exec, s[60:61]
buffer_load_dwordx4 v4, s[8:11], s37 offen lds
s_mov_b64 exec, -1
s_add_u32 m0, s39, 89088
s_nop 0
buffer_load_dwordx4 v5, s[8:11], s37 offen lds
s_add_u32 m0, s39, 92160
s_nop 0
buffer_load_dwordx4 v6, s[8:11], s37 offen lds
s_add_u32 m0, s39, 95232
s_nop 0
buffer_load_dwordx4 v7, s[8:11], s37 offen lds
s_add_u32 m0, s39, 98304
s_nop 0
buffer_load_dwordx4 v8, s[8:11], s37 offen lds
s_add_u32 m0, s39, 101376
s_nop 0
buffer_load_dwordx4 v9, s[8:11], s37 offen lds
s_add_u32 m0, s40, 86016
s_add_u32 s43, s38, 0
buffer_load_dwordx4 v2, s[12:15], s43 offen lds
s_add_u32 m0, s40, 87040
s_add_u32 s43, s38, 49152
buffer_load_dwordx4 v3, s[12:15], s43 offen lds
s_add_u32 m0, s40, 88064
s_add_u32 s43, s38, 98304
buffer_load_dwordx4 v2, s[12:15], s43 offen lds
s_add_u32 m0, s40, 89088
s_add_u32 s43, s38, 147456
buffer_load_dwordx4 v3, s[12:15], s43 offen lds
s_add_u32 m0, s40, 90112
s_add_u32 s43, s38, 196608
buffer_load_dwordx4 v2, s[12:15], s43 offen lds
s_add_u32 m0, s40, 91136
s_add_u32 s43, s38, 245760
buffer_load_dwordx4 v3, s[12:15], s43 offen lds
s_add_u32 m0, s40, 92160
s_add_u32 s43, s38, 294912
buffer_load_dwordx4 v2, s[12:15], s43 offen lds
s_add_u32 m0, s40, 93184
s_add_u32 s43, s38, 344064
buffer_load_dwordx4 v3, s[12:15], s43 offen lds
s_add_u32 s37, s37, 128
s_add_u32 s38, s38, 393216
s_load_dword s3, s[4:5], 35904
s_load_dword s3, s[4:5], 35968
s_load_dword s3, s[4:5], 36032
s_load_dword s3, s[4:5], 43008
s_load_dword s3, s[4:5], 43072
s_load_dword s3, s[4:5], 43136
s_load_dword s3, s[4:5], 43200
s_load_dword s3, s[4:5], 50176
Lsp_14:
s_waitcnt vmcnt(14)
s_barrier
s_add_u32 m0, s39, 0
s_mov_b64 exec, s[60:61]
buffer_load_dwordx4 v4, s[8:11], s37 offen lds
s_mov_b64 exec, -1
s_add_u32 m0, s39, 3072
s_nop 0
buffer_load_dwordx4 v5, s[8:11], s37 offen lds
s_add_u32 m0, s39, 6144
s_nop 0
buffer_load_dwordx4 v6, s[8:11], s37 offen lds
s_add_u32 m0, s39, 9216
s_nop 0
buffer_load_dwordx4 v7, s[8:11], s37 offen lds
s_add_u32 m0, s39, 12288
s_nop 0
buffer_load_dwordx4 v8, s[8:11], s37 offen lds
s_add_u32 m0, s39, 15360
s_nop 0
buffer_load_dwordx4 v9, s[8:11], s37 offen lds
s_add_u32 m0, s40, 0
s_add_u32 s43, s38, 0
buffer_load_dwordx4 v2, s[12:15], s43 offen lds
s_add_u32 m0, s40, 1024
s_add_u32 s43, s38, 49152
buffer_load_dwordx4 v3, s[12:15], s43 offen lds
s_add_u32 m0, s40, 2048
s_add_u32 s43, s38, 98304
buffer_load_dwordx4 v2, s[12:15], s43 offen lds
s_add_u32 m0, s40, 3072
s_add_u32 s43, s38, 147456
buffer_load_dwordx4 v3, s[12:15], s43 offen lds
s_add_u32 m0, s40, 4096
s_add_u32 s43, s38, 196608
buffer_load_dwordx4 v2, s[12:15], s43 offen lds
s_add_u32 m0, s40, 5120
s_add_u32 s43, s38, 245760
buffer_load_dwordx4 v3, s[12:15], s43 offen lds
s_add_u32 m0, s40, 6144
s_add_u32 s43, s38, 294912
buffer_load_dwordx4 v2, s[12:15], s43 offen lds
s_add_u32 m0, s40, 7168
s_add_u32 s43, s38, 344064
buffer_load_dwordx4 v3, s[12:15], s43 offen lds
s_add_u32 s37, s37, 128
s_add_u32 s38, s38, 393216
s_load_dword s3, s[4:5], 50240
s_load_dword s3, s[4:5], 50304
s_load_dword s3, s[4:5], 50368
s_load_dword s3, s[4:5], 57344
s_load_dword s3, s[4:5], 57408
s_load_dword s3, s[4:5], 57472
s_load_dword s3, s[4:5], 57536
s_load_dword s3, s[4:5], 64512
s_load_dword s3, s[4:5], 64576
Lsp_15:
s_waitcnt vmcnt(14)
s_barrier
s_add_u32 m0, s39, 43008
s_mov_b64 exec, s[60:61]
buffer_load_dwordx4 v4, s[8:11], s37 offen lds
s_mov_b64 exec, -1
s_add_u32 m0, s39, 46080
s_nop 0
buffer_load_dwordx4 v5, s[8:11], s37 offen lds
s_add_u32 m0, s39, 49152
s_nop 0
buffer_load_dwordx4 v6, s[8:11], s37 offen lds
s_add_u32 m0, s39, 52224
s_nop 0
buffer_load_dwordx4 v7, s[8:11], s37 offen lds
s_add_u32 m0, s39, 55296
s_nop 0
buffer_load_dwordx4 v8, s[8:11], s37 offen lds
s_add_u32 m0, s39, 58368
s_nop 0
buffer_load_dwordx4 v9, s[8:11], s37 offen lds
s_add_u32 m0, s40, 43008
s_add_u32 s43, s38, 0
buffer_load_dwordx4 v2, s[12:15], s43 offen lds
s_add_u32 m0, s40, 44032
s_add_u32 s43, s38, 49152
buffer_load_dwordx4 v3, s[12:15], s43 offen lds
s_add_u32 m0, s40, 45056
s_add_u32 s43, s38, 98304
buffer_load_dwordx4 v2, s[12:15], s43 offen lds
s_add_u32 m0, s40, 46080
s_add_u32 s43, s38, 147456
buffer_load_dwordx4 v3, s[12:15], s43 offen lds
s_add_u32 m0, s40, 47104
s_add_u32 s43, s38, 196608
buffer_load_dwordx4 v2, s[12:15], s43 offen lds
s_add_u32 m0, s40, 48128
s_add_u32 s43, s38, 245760
buffer_load_dwordx4 v3, s[12:15], s43 offen lds
s_add_u32 m0, s40, 49152
s_add_u32 s43, s38, 294912
buffer_load_dwordx4 v2, s[12:15], s43 offen lds
s_add_u32 m0, s40, 50176
s_add_u32 s43, s38, 344064
buffer_load_dwordx4 v3, s[12:15], s43 offen lds
s_add_u32 s37, s37, 128
s_add_u32 s38, s38, 393216
s_load_dword s3, s[4:5], 64640
s_load_dword s3, s[4:5], 64704
s_load_dword s3, s[4:5], 71680
s_load_dword s3, s[4:5], 71744
s_load_dword s3, s[4:5], 71808
s_load_dword s3, s[4:5], 71872
s_load_dword s3, s[4:5], 78848
s_load_dword s3, s[4:5], 78912
s_load_dword s3, s[4:5], 78976
s_load_dword s3, s[4:5], 79040
Lsp_16:
s_waitcnt vmcnt(14)
s_barrier
s_add_u32 m0, s39, 86016
s_mov_b64 exec, s[60:61]
buffer_load_dwordx4 v4, s[8:11], s37 offen lds
s_mov_b64 exec, -1
s_add_u32 m0, s39, 89088
s_nop 0
buffer_load_dwordx4 v5, s[8:11], s37 offen lds
s_add_u32 m0, s39, 92160
s_nop 0
buffer_load_dwordx4 v6, s[8:11], s37 offen lds
s_add_u32 m0, s39, 95232
s_nop 0
buffer_load_dwordx4 v7, s[8:11], s37 offen lds
s_add_u32 m0, s39, 98304
s_nop 0
buffer_load_dwordx4 v8, s[8:11], s37 offen lds
s_add_u32 m0, s39, 101376
s_nop 0
buffer_load_dwordx4 v9, s[8:11], s37 offen lds
s_add_u32 m0, s40, 86016
s_add_u32 s43, s38, 0
buffer_load_dwordx4 v2, s[12:15], s43 offen lds
s_add_u32 m0, s40, 87040
s_add_u32 s43, s38, 49152
buffer_load_dwordx4 v3, s[12:15], s43 offen lds
s_add_u32 m0, s40, 88064
s_add_u32 s43, s38, 98304
buffer_load_dwordx4 v2, s[12:15], s43 offen lds
s_add_u32 m0, s40, 89088
s_add_u32 s43, s38, 147456
buffer_load_dwordx4 v3, s[12:15], s43 offen lds
s_add_u32 m0, s40, 90112
s_add_u32 s43, s38, 196608
buffer_load_dwordx4 v2, s[12:15], s43 offen lds
s_add_u32 m0, s40, 91136
s_add_u32 s43, s38, 245760
buffer_load_dwordx4 v3, s[12:15], s43 offen lds
s_add_u32 m0, s40, 92160
s_add_u32 s43, s38, 294912
buffer_load_dwordx4 v2, s[12:15], s43 offen lds
s_add_u32 m0, s40, 93184
s_add_u32 s43, s38, 344064
buffer_load_dwordx4 v3, s[12:15], s43 offen lds
s_add_u32 s37, s37, 128
s_add_u32 s38, s38, 393216
s_load_dword s3, s[4:5], 86016
s_load_dword s3, s[4:5], 86080
s_load_dword s3, s[4:5], 86144
s_load_dword s3, s[4:5], 86208
s_load_dword s3, s[4:5], 93184
s_load_dword s3, s[4:5], 93248
s_load_dword s3, s[4:5], 93312
s_load_dword s3, s[4:5], 93376
s_load_dword s3, s[4:5], 100352
s_load_dword s3, s[4:5], 100416
Lsp_17:
s_waitcnt vmcnt(14)
s_barrier
s_add_u32 m0, s39, 0
s_mov_b64 exec, s[60:61]
buffer_load_dwordx4 v4, s[8:11], s37 offen lds
s_mov_b64 exec, -1
s_add_u32 m0, s39, 3072
s_nop 0
buffer_load_dwordx4 v5, s[8:11], s37 offen lds
s_add_u32 m0, s39, 6144
s_nop 0
buffer_load_dwordx4 v6, s[8:11], s37 offen lds
s_add_u32 m0, s39, 9216
s_nop 0
buffer_load_dwordx4 v7, s[8:11], s37 offen lds
s_add_u32 m0, s39, 12288
s_nop 0
buffer_load_dwordx4 v8, s[8:11], s37 offen lds
s_add_u32 m0, s39, 15360
s_nop 0
buffer_load_dwordx4 v9, s[8:11], s37 offen lds
s_add_u32 m0, s40, 0
s_add_u32 s43, s38, 0
buffer_load_dwordx4 v2, s[12:15], s43 offen lds
s_add_u32 m0, s40, 1024
s_add_u32 s43, s38, 49152
buffer_load_dwordx4 v3, s[12:15], s43 offen lds
s_add_u32 m0, s40, 2048
s_add_u32 s43, s38, 98304
buffer_load_dwordx4 v2, s[12:15], s43 offen lds
s_add_u32 m0, s40, 3072
s_add_u32 s43, s38, 147456
buffer_load_dwordx4 v3, s[12:15], s43 offen lds
s_add_u32 m0, s40, 4096
s_add_u32 s43, s38, 196608
buffer_load_dwordx4 v2, s[12:15], s43 offen lds
s_add_u32 m0, s40, 5120
s_add_u32 s43, s38, 245760
buffer_load_dwordx4 v3, s[12:15], s43 offen lds
s_add_u32 m0, s40, 6144
s_add_u32 s43, s38, 294912
buffer_load_dwordx4 v2, s[12:15], s43 offen lds
s_add_u32 m0, s40, 7168
s_add_u32 s43, s38, 344064
buffer_load_dwordx4 v3, s[12:15], s43 offen lds
s_add_u32 s37, s37, 128
s_add_u32 s38, s38, 393216
s_load_dword s3, s[4:5], 100480
s_load_dword s3, s[4:5], 100544
s_load_dword s3, s[4:5], 107520
s_load_dword s3, s[4:5], 107584
s_load_dword s3, s[4:5], 107648
s_load_dword s3, s[4:5], 107712
s_load_dword s3, s[4:5], 114688
s_load_dword s3, s[4:5], 114752
s_load_dword s3, s[4:5], 114816
s_load_dword s3, s[4:5], 114880
s_load_dword s3, s[4:5], 121856
Lsp_18:
s_waitcnt vmcnt(14)
s_barrier
s_add_u32 m0, s39, 43008
s_mov_b64 exec, s[60:61]
buffer_load_dwordx4 v4, s[8:11], s37 offen lds
s_mov_b64 exec, -1
s_add_u32 m0, s39, 46080
s_nop 0
buffer_load_dwordx4 v5, s[8:11], s37 offen lds
s_add_u32 m0, s39, 49152
s_nop 0
buffer_load_dwordx4 v6, s[8:11], s37 offen lds
s_add_u32 m0, s39, 52224
s_nop 0
buffer_load_dwordx4 v7, s[8:11], s37 offen lds
s_add_u32 m0, s39, 55296
s_nop 0
buffer_load_dwordx4 v8, s[8:11], s37 offen lds
s_add_u32 m0, s39, 58368
s_nop 0
buffer_load_dwordx4 v9, s[8:11], s37 offen lds
s_add_u32 m0, s40, 43008
s_add_u32 s43, s38, 0
buffer_load_dwordx4 v2, s[12:15], s43 offen lds
s_add_u32 m0, s40, 44032
s_add_u32 s43, s38, 49152
buffer_load_dwordx4 v3, s[12:15], s43 offen lds
s_add_u32 m0, s40, 45056
s_add_u32 s43, s38, 98304
buffer_load_dwordx4 v2, s[12:15], s43 offen lds
s_add_u32 m0, s40, 46080
s_add_u32 s43, s38, 147456
buffer_load_dwordx4 v3, s[12:15], s43 offen lds
s_add_u32 m0, s40, 47104
s_add_u32 s43, s38, 196608
buffer_load_dwordx4 v2, s[12:15], s43 offen lds
s_add_u32 m0, s40, 48128
s_add_u32 s43, s38, 245760
buffer_load_dwordx4 v3, s[12:15], s43 offen lds
s_add_u32 m0, s40, 49152
s_add_u32 s43, s38, 294912
buffer_load_dwordx4 v2, s[12:15], s43 offen lds
s_add_u32 m0, s40, 50176
s_add_u32 s43, s38, 344064
buffer_load_dwordx4 v3, s[12:15], s43 offen lds
s_add_u32 s37, s37, 128
s_add_u32 s38, s38, 393216
s_load_dword s3, s[4:5], 121920
s_load_dword s3, s[4:5], 121984
s_load_dword s3, s[4:5], 122048
s_load_dword s3, s[4:5], 129024
s_load_dword s3, s[4:5], 129088
s_load_dword s3, s[4:5], 129152
s_load_dword s3, s[4:5], 129216
s_load_dword s3, s[4:5], 136192
s_load_dword s3, s[4:5], 136256
s_load_dword s3, s[4:5], 136320
s_load_dword s3, s[4:5], 136384
Lsp_19:
s_waitcnt vmcnt(14)
s_barrier
s_add_u32 m0, s39, 86016
s_mov_b64 exec, s[60:61]
buffer_load_dwordx4 v4, s[8:11], s37 offen lds
s_mov_b64 exec, -1
s_add_u32 m0, s39, 89088
s_nop 0
buffer_load_dwordx4 v5, s[8:11], s37 offen lds
s_add_u32 m0, s39, 92160
s_nop 0
buffer_load_dwordx4 v6, s[8:11], s37 offen lds
s_add_u32 m0, s39, 95232
s_nop 0
buffer_load_dwordx4 v7, s[8:11], s37 offen lds
s_add_u32 m0, s39, 98304
s_nop 0
buffer_load_dwordx4 v8, s[8:11], s37 offen lds
s_add_u32 m0, s39, 101376
s_nop 0
buffer_load_dwordx4 v9, s[8:11], s37 offen lds
s_add_u32 m0, s40, 86016
s_add_u32 s43, s38, 0
buffer_load_dwordx4 v2, s[12:15], s43 offen lds
s_add_u32 m0, s40, 87040
s_add_u32 s43, s38, 49152
buffer_load_dwordx4 v3, s[12:15], s43 offen lds
s_add_u32 m0, s40, 88064
s_add_u32 s43, s38, 98304
buffer_load_dwordx4 v2, s[12:15], s43 offen lds
s_add_u32 m0, s40, 89088
s_add_u32 s43, s38, 147456
buffer_load_dwordx4 v3, s[12:15], s43 offen lds
s_add_u32 m0, s40, 90112
s_add_u32 s43, s38, 196608
buffer_load_dwordx4 v2, s[12:15], s43 offen lds
s_add_u32 m0, s40, 91136
s_add_u32 s43, s38, 245760
buffer_load_dwordx4 v3, s[12:15], s43 offen lds
s_add_u32 m0, s40, 92160
s_add_u32 s43, s38, 294912
buffer_load_dwordx4 v2, s[12:15], s43 offen lds
s_add_u32 m0, s40, 93184
s_add_u32 s43, s38, 344064
buffer_load_dwordx4 v3, s[12:15], s43 offen lds
s_add_u32 s37, s37, 128
s_add_u32 s38, s38, 393216
s_load_dword s3, s[4:5], 143360
s_load_dword s3, s[4:5], 143424
s_load_dword s3, s[4:5], 143488
s_load_dword s3, s[4:5], 143552
s_load_dword s3, s[4:5], 150528
s_load_dword s3, s[4:5], 150592
s_load_dword s3, s[4:5], 150656
s_load_dword s3, s[4:5], 150720
s_load_dword s3, s[4:5], 157696
s_load_dword s3, s[4:5], 157760
s_load_dword s3, s[4:5], 157824
Lsp_20:
s_waitcnt vmcnt(14)
s_barrier
s_add_u32 m0, s39, 0
s_mov_b64 exec, s[60:61]
buffer_load_dwordx4 v4, s[8:11], s37 offen lds
s_mov_b64 exec, -1
s_add_u32 m0, s39, 3072
s_nop 0
buffer_load_dwordx4 v5, s[8:11], s37 offen lds
s_add_u32 m0, s39, 6144
s_nop 0
buffer_load_dwordx4 v6, s[8:11], s37 offen lds
s_add_u32 m0, s39, 9216
s_nop 0
buffer_load_dwordx4 v7, s[8:11], s37 offen lds
s_add_u32 m0, s39, 12288
s_nop 0
buffer_load_dwordx4 v8, s[8:11], s37 offen lds
s_add_u32 m0, s39, 15360
s_nop 0
buffer_load_dwordx4 v9, s[8:11], s37 offen lds
s_add_u32 m0, s40, 0
s_add_u32 s43, s38, 0
buffer_load_dwordx4 v2, s[12:15], s43 offen lds
s_add_u32 m0, s40, 1024
s_add_u32 s43, s38, 49152
buffer_load_dwordx4 v3, s[12:15], s43 offen lds
s_add_u32 m0, s40, 2048
s_add_u32 s43, s38, 98304
buffer_load_dwordx4 v2, s[12:15], s43 offen lds
s_add_u32 m0, s40, 3072
s_add_u32 s43, s38, 147456
buffer_load_dwordx4 v3, s[12:15], s43 offen lds
s_add_u32 m0, s40, 4096
s_add_u32 s43, s38, 196608
buffer_load_dwordx4 v2, s[12:15], s43 offen lds
s_add_u32 m0, s40, 5120
s_add_u32 s43, s38, 245760
buffer_load_dwordx4 v3, s[12:15], s43 offen lds
s_add_u32 m0, s40, 6144
s_add_u32 s43, s38, 294912
buffer_load_dwordx4 v2, s[12:15], s43 offen lds
s_add_u32 m0, s40, 7168
s_add_u32 s43, s38, 344064
buffer_load_dwordx4 v3, s[12:15], s43 offen lds
s_add_u32 s37, s37, 128
s_add_u32 s38, s38, 393216
s_load_dword s3, s[4:5], 157888
s_load_dword s3, s[4:5], 164864
s_load_dword s3, s[4:5], 164928
s_load_dword s3, s[4:5], 164992
s_load_dword s3, s[4:5], 165056
s_load_dword s3, s[4:5], 172032
s_load_dword s3, s[4:5], 172096
s_load_dword s3, s[4:5], 172160
s_load_dword s3, s[4:5], 172224
s_load_dword s3, s[4:5], 179200
s_load_dword s3, s[4:5], 179264
Lsp_21:
s_waitcnt vmcnt(14)
s_barrier
s_load_dword s3, s[4:5], 179328
s_load_dword s3, s[4:5], 179392
s_load_dword s3, s[4:5], 186368
s_load_dword s3, s[4:5], 186432
s_load_dword s3, s[4:5], 186496
s_load_dword s3, s[4:5], 186560
s_load_dword s3, s[4:5], 193536
s_branch Lov_1
.p2align 12
Lst_1_0:
s_branch Lwr_161
s_nop 0
s_nop 0
Lov_1:
s_load_dword s3, s[4:5], 193600
s_load_dword s3, s[4:5], 193664
s_load_dword s3, s[4:5], 193728
Lsp_22:
s_waitcnt vmcnt(0)
s_barrier
s_lshl_b32 s43, s35, 7
s_add_u32 s28, s68, s43
s_addc_u32 s29, s69, 0
s_mov_b32 s30, 2095232
s_mov_b32 s31, 0x20000
v_lshrrev_b32 v15, 3, v1
v_and_b32 v16, 6, v15
v_and_b32 v7, 7, v1
v_xor_b32 v7, v7, v16
v_lshlrev_b32 v7, 4, v7
v_mul_u32_u24 v15, 2048, v15
v_add_u32 v7, v7, v15
s_and_b32 s40, s36, 3
s_lshl_b32 s39, s40, 13
s_add_u32 s40, s40, s35
s_add_u32 s42, s40, 0
s_and_b32 s42, s42, 15
s_lshl_b32 s42, s42, 17
s_add_u32 m0, s39, 65536
s_add_u32 s43, s42, 0
buffer_load_dwordx4 v7, s[28:31], s43 offen lds
s_add_u32 m0, s39, 66560
s_add_u32 s43, s42, 16384
buffer_load_dwordx4 v7, s[28:31], s43 offen lds
s_add_u32 m0, s39, 67584
s_add_u32 s43, s42, 32768
buffer_load_dwordx4 v7, s[28:31], s43 offen lds
s_add_u32 m0, s39, 68608
s_add_u32 s43, s42, 49152
buffer_load_dwordx4 v7, s[28:31], s43 offen lds
s_add_u32 m0, s39, 69632
s_add_u32 s43, s42, 65536
buffer_load_dwordx4 v7, s[28:31], s43 offen lds
s_add_u32 m0, s39, 70656
s_add_u32 s43, s42, 81920
buffer_load_dwordx4 v7, s[28:31], s43 offen lds
s_add_u32 m0, s39, 71680
s_add_u32 s43, s42, 98304
buffer_load_dwordx4 v7, s[28:31], s43 offen lds
s_add_u32 m0, s39, 72704
s_add_u32 s43, s42, 114688
buffer_load_dwordx4 v7, s[28:31], s43 offen lds
s_bitcmp0_b32 s2, 0
s_cselect_b32 s88, s72, s74
s_cselect_b32 s89, s73, s75
s_cmp_lt_u32 s2, 192
s_cselect_b32 s90, 7340032, 0
s_mov_b32 s91, 0x20000
s_bfe_u32 s44, s2, 0x30001
s_lshl_b32 s44, s44, 2
s_and_b32 s43, s36, 3
s_add_u32 s44, s44, s43
s_lshl_b32 s44, s44, 5
v_lshrrev_b32 v18, 4, v1
v_add_u32 v18, s44, v18
v_mul_u32_u24 v18, 7168, v18
v_and_b32 v19, 15, v1
v_lshl_add_u32 v18, v19, 4, v18
s_lshr_b32 s43, s2, 4
s_lshl_b32 s43, s43, 8
s_add_u32 s43, s43, 4096
v_add_u32 v18, s43, v18
s_mov_b32 s43, 0
buffer_load_dwordx4 v[128:131], v18, s[88:91], s43 offen
s_mov_b32 s43, 28672
buffer_load_dwordx4 v[132:135], v18, s[88:91], s43 offen
s_mov_b32 s43, 57344
buffer_load_dwordx4 v[136:139], v18, s[88:91], s43 offen
s_mov_b32 s43, 86016
buffer_load_dwordx4 v[140:143], v18, s[88:91], s43 offen
s_mov_b32 s43, 114688
buffer_load_dwordx4 v[144:147], v18, s[88:91], s43 offen
s_mov_b32 s43, 143360
buffer_load_dwordx4 v[148:151], v18, s[88:91], s43 offen
s_mov_b32 s43, 172032
buffer_load_dwordx4 v[152:155], v18, s[88:91], s43 offen
s_mov_b32 s43, 200704
buffer_load_dwordx4 v[156:159], v18, s[88:91], s43 offen
s_barrier
s_branch Lats_6
Lcons_7:
s_lshl_b32 s43, s35, 7
s_waitcnt lgkmcnt(0)
s_mov_b32 s8, s64
s_mov_b32 s9, s65
s_mov_b32 s10, 4194304
s_mov_b32 s11, 0x20000
s_add_u32 s12, s66, s43
s_addc_u32 s13, s67, 0
s_mov_b32 s14, 6289536
s_mov_b32 s15, 0x20000
s_lshr_b32 s43, s2, 3
s_lshl_b32 s43, s43, 2
s_add_u32 s43, s43, s36
s_sub_u32 s44, s43, 0
s_and_b32 s44, s44, 127
s_cmp_lt_u32 s44, 24
s_cbranch_scc0 Lt_23
s_lshl_b32 s44, s44, 20
s_min_u32 s44, s44, 24117184
s_load_dword s3, s[82:83], s44 glc
Lt_23:
s_sub_u32 s44, s43, 24
s_and_b32 s44, s44, 127
s_cmp_lt_u32 s44, 8
s_cbranch_scc0 Lt_24
s_lshl_b32 s44, s44, 20
s_min_u32 s44, s44, 7339968
s_load_dword s3, s[72:73], s44
Lt_24:
s_sub_u32 s44, s43, 32
s_and_b32 s44, s44, 127
s_cmp_lt_u32 s44, 8
s_cbranch_scc0 Lt_25
s_lshl_b32 s44, s44, 20
s_min_u32 s44, s44, 7339968
s_load_dword s3, s[74:75], s44
Lt_25:
s_sub_u32 s44, s43, 40
s_and_b32 s44, s44, 127
s_cmp_lt_u32 s44, 3
s_cbranch_scc0 Lt_26
s_lshl_b32 s44, s44, 20
s_min_u32 s44, s44, 2097088
s_load_dword s3, s[68:69], s44
Lt_26:
s_sub_u32 s44, s43, 43
s_and_b32 s44, s44, 127
s_cmp_lt_u32 s44, 5
s_cbranch_scc0 Lt_27
s_lshl_b32 s44, s44, 20
s_min_u32 s44, s44, 4194240
s_add_u32 s44, s44, 25165824
s_load_dword s3, s[82:83], s44 glc
Lt_27:
s_sub_u32 s44, s43, 48
s_and_b32 s44, s44, 127
s_cmp_lt_u32 s44, 8
s_cbranch_scc0 Lt_28
s_lshl_b32 s44, s44, 20
s_min_u32 s44, s44, 7339968
s_load_dword s3, s[76:77], s44
Lt_28:
s_sub_u32 s44, s43, 56
s_and_b32 s44, s44, 127
s_cmp_lt_u32 s44, 5
s_cbranch_scc0 Lt_29
s_lshl_b32 s44, s44, 20
s_min_u32 s44, s44, 4194240
s_add_u32 s44, s44, 33554432
s_load_dword s3, s[82:83], s44 glc
Lt_29:
s_sub_u32 s44, s43, 61
s_and_b32 s44, s44, 127
s_cmp_lt_u32 s44, 5
s_cbranch_scc0 Lt_30
s_lshl_b32 s44, s44, 20
s_min_u32 s44, s44, 4194240
s_load_dword s3, s[78:79], s44 glc
Lt_30:
v_lshrrev_b32 v16, 1, v12
v_xor_b32 v15, v13, v16
v_lshlrev_b32 v15, 4, v15
v_lshl_add_u32 v2, v12, 7, v15
v_xor_b32 v3, 64, v2
v_add_u32 v4, 86016, v2
v_add_u32 v5, 86016, v3
v_lshrrev_b32 v15, 2, v12
v_and_b32 v16, 3, v1
v_lshl_add_u32 v19, v13, 3, v15
v_lshlrev_b32 v19, 7, v19
v_and_b32 v15, 2, v15
v_and_b32 v17, 1, v13
v_lshl_add_u32 v15, v17, 2, v15
v_lshrrev_b32 v17, 1, v16
s_lshl_b32 s43, s36, 1
v_add_u32 v17, s43, v17
v_xor_b32 v15, v15, v17
v_lshl_add_u32 v19, v15, 4, v19
v_and_b32 v16, 1, v16
v_lshl_add_u32 v19, v16, 3, v19
v_add_u32 v6, 18432, v19
v_add_u32 v7, 61440, v19
v_add_u32 v8, 104448, v19
s_and_b32 s43, s36, 1
s_bfe_u32 s44, s36, 0x10001
s_lshr_b32 s45, s36, 2
v_lshlrev_b32 v14, 2, v13
v_sub_u32 v14, v12, v14
v_mov_b32 v16, 0xff800000
s_or_b32 s46, s34, s45
s_cmp_lg_u32 s46, 0
s_cselect_b32 s46, 0, 0xff800000
v_subrev_u32 v15, 0, v14
v_cmp_ge_u32 vcc, 7, v15
v_add_u32 v15, 16, v15
s_nop 0
v_cndmask_b32 v248, v16, 0, vcc
v_cmp_ge_u32 vcc, 7, v15
s_nop 1
v_cndmask_b32 v244, v16, 0, vcc
v_or_b32 v240, s46, v244
v_subrev_u32 v15, 1, v14
v_cmp_ge_u32 vcc, 7, v15
v_add_u32 v15, 16, v15
s_nop 0
v_cndmask_b32 v249, v16, 0, vcc
v_cmp_ge_u32 vcc, 7, v15
s_nop 1
v_cndmask_b32 v245, v16, 0, vcc
v_or_b32 v241, s46, v245
v_subrev_u32 v15, 2, v14
v_cmp_ge_u32 vcc, 7, v15
v_add_u32 v15, 16, v15
s_nop 0
v_cndmask_b32 v250, v16, 0, vcc
v_cmp_ge_u32 vcc, 7, v15
s_nop 1
v_cndmask_b32 v246, v16, 0, vcc
v_or_b32 v242, s46, v246
v_subrev_u32 v15, 3, v14
v_cmp_ge_u32 vcc, 7, v15
v_add_u32 v15, 16, v15
s_nop 0
v_cndmask_b32 v251, v16, 0, vcc
v_cmp_ge_u32 vcc, 7, v15
s_nop 1
v_cndmask_b32 v247, v16, 0, vcc
v_or_b32 v243, s46, v247
s_lshl_b32 s46, s45, 6
s_add_u32 s46, s46, s44
s_add_u32 s46, s46, 16
v_lshl_add_u32 v14, v12, 1, s46
s_lshl_b32 s47, s43, 6
v_lshl_add_u32 v15, v13, 4, s47
v_mul_u32_u24 v20, 400, v14
v_add_u32 v20, v20, v15
v_subrev_u32 v16, 32, v14
v_max_i32 v16, 0, v16
v_mul_u32_u24 v21, 400, v16
v_add_u32 v21, v21, v15
v_lshrrev_b32 v16, 2, v12
v_lshl_add_u32 v16, v13, 2, v16
v_lshl_add_u32 v16, v16, 1, s46
v_and_b32 v17, 3, v1
v_lshl_add_u32 v17, v17, 3, s47
v_mul_u32_u24 v22, 400, v16
v_add_u32 v22, v22, v17
v_subrev_u32 v16, 32, v16
v_max_i32 v16, 0, v16
v_mul_u32_u24 v23, 400, v16
v_add_u32 v23, v23, v17
s_mul_i32 s60, s34, 262144
s_add_u32 s16, s82, s60
s_addc_u32 s17, s83, 0
s_mov_b32 s18, 262144
s_mov_b32 s19, 0x20000
s_lshl_b32 s60, s35, 14
s_lshl_b32 s43, s43, 13
s_add_u32 s60, s60, s43
s_lshl_b32 s43, s45, 12
s_add_u32 s60, s60, s43
s_lshl_b32 s43, s44, 10
s_add_u32 s60, s60, s43
v_lshlrev_b32 v24, 4, v1
s_mov_b32 s61, 0x3e8293ee
s_lshl_b32 s38, s35, 7
s_add_u32 s56, s82, 28311552
s_addc_u32 s57, s83, 0
s_mov_b32 s58, 114688
s_mov_b32 s59, 0x20000
s_barrier
ds_read_b128 v[32:35], v2 offset:0
ds_read_b64_tr_b16 v[72:73], v6 offset:8192
ds_read_b64_tr_b16 v[74:75], v6 offset:8704
ds_read_b64_tr_b16 v[76:77], v6 offset:16384
ds_read_b64_tr_b16 v[78:79], v6 offset:16896
ds_read_b64_tr_b16 v[68:69], v6 offset:0
ds_read_b64_tr_b16 v[70:71], v6 offset:512
ds_read_b128 v[36:39], v2 offset:2048
ds_read_b128 v[40:43], v2 offset:4096
ds_read_b128 v[44:47], v2 offset:6144
ds_read_b128 v[48:51], v2 offset:8192
ds_read_b128 v[52:55], v2 offset:10240
ds_read_b128 v[56:59], v2 offset:12288
ds_read_b128 v[60:63], v2 offset:14336
ds_read_b128 v[64:67], v2 offset:16384
s_waitcnt lgkmcnt(0)
v_mfma_f32_16x16x32_bf16 v[128:131], v[68:71], v[32:35], 0
ds_read_b128 v[80:83], v3 offset:0
v_mfma_f32_16x16x32_bf16 v[132:135], v[68:71], v[36:39], 0
ds_read_b64_tr_b16 v[120:121], v6 offset:12288
v_mfma_f32_16x16x32_bf16 v[136:139], v[68:71], v[40:43], 0
ds_read_b64_tr_b16 v[122:123], v6 offset:12800
v_mfma_f32_16x16x32_bf16 v[140:143], v[68:71], v[44:47], 0
ds_read_b64_tr_b16 v[124:125], v6 offset:20480
v_mfma_f32_16x16x32_bf16 v[144:147], v[68:71], v[48:51], 0
ds_read_b64_tr_b16 v[126:127], v6 offset:20992
v_mfma_f32_16x16x32_bf16 v[148:151], v[68:71], v[52:55], 0
ds_read_b64_tr_b16 v[116:117], v6 offset:4096
v_mfma_f32_16x16x32_bf16 v[152:155], v[68:71], v[56:59], 0
ds_read_b64_tr_b16 v[118:119], v6 offset:4608
v_mfma_f32_16x16x32_bf16 v[156:159], v[68:71], v[60:63], 0
ds_read_b128 v[84:87], v3 offset:2048
v_mfma_f32_16x16x32_bf16 v[160:163], v[68:71], v[64:67], 0
ds_read_b128 v[88:91], v3 offset:4096
v_mfma_f32_16x16x32_bf16 v[196:199], v[72:75], v[64:67], 0
ds_read_b128 v[92:95], v3 offset:6144
v_mfma_f32_16x16x32_bf16 v[192:195], v[72:75], v[60:63], 0
ds_read_b128 v[96:99], v3 offset:8192
v_mfma_f32_16x16x32_bf16 v[188:191], v[72:75], v[56:59], 0
ds_read_b128 v[100:103], v3 offset:10240
v_mfma_f32_16x16x32_bf16 v[184:187], v[72:75], v[52:55], 0
ds_read_b128 v[104:107], v3 offset:12288
v_mfma_f32_16x16x32_bf16 v[180:183], v[72:75], v[48:51], 0
ds_read_b128 v[108:111], v3 offset:14336
v_mfma_f32_16x16x32_bf16 v[176:179], v[72:75], v[44:47], 0
ds_read_b128 v[112:115], v3 offset:16384
v_mfma_f32_16x16x32_bf16 v[172:175], v[72:75], v[40:43], 0
v_mfma_f32_16x16x32_bf16 v[168:171], v[72:75], v[36:39], 0
v_mfma_f32_16x16x32_bf16 v[164:167], v[72:75], v[32:35], 0
v_mfma_f32_16x16x32_bf16 v[200:203], v[76:79], v[32:35], 0
v_mfma_f32_16x16x32_bf16 v[204:207], v[76:79], v[36:39], 0
v_mfma_f32_16x16x32_bf16 v[208:211], v[76:79], v[40:43], 0
v_mfma_f32_16x16x32_bf16 v[212:215], v[76:79], v[44:47], 0
v_mfma_f32_16x16x32_bf16 v[216:219], v[76:79], v[48:51], 0
v_mfma_f32_16x16x32_bf16 v[220:223], v[76:79], v[52:55], 0
v_mfma_f32_16x16x32_bf16 v[224:227], v[76:79], v[56:59], 0
v_mfma_f32_16x16x32_bf16 v[228:231], v[76:79], v[60:63], 0
v_mfma_f32_16x16x32_bf16 v[232:235], v[76:79], v[64:67], 0
s_waitcnt lgkmcnt(0)
s_barrier
v_mfma_f32_16x16x32_bf16 v[128:131], v[116:119], v[80:83], v[128:131]
ds_read_b128 v[32:35], v2 offset:43008
v_mfma_f32_16x16x32_bf16 v[132:135], v[116:119], v[84:87], v[132:135]
ds_read_b64_tr_b16 v[72:73], v7 offset:8192
v_mfma_f32_16x16x32_bf16 v[136:139], v[116:119], v[88:91], v[136:139]
ds_read_b64_tr_b16 v[74:75], v7 offset:8704
v_mfma_f32_16x16x32_bf16 v[140:143], v[116:119], v[92:95], v[140:143]
ds_read_b64_tr_b16 v[76:77], v7 offset:16384
v_mfma_f32_16x16x32_bf16 v[144:147], v[116:119], v[96:99], v[144:147]
ds_read_b64_tr_b16 v[78:79], v7 offset:16896
v_mfma_f32_16x16x32_bf16 v[148:151], v[116:119], v[100:103], v[148:151]
ds_read_b64_tr_b16 v[68:69], v7 offset:0
v_mfma_f32_16x16x32_bf16 v[152:155], v[116:119], v[104:107], v[152:155]
ds_read_b64_tr_b16 v[70:71], v7 offset:512
v_mfma_f32_16x16x32_bf16 v[156:159], v[116:119], v[108:111], v[156:159]
ds_read_b128 v[36:39], v2 offset:45056
v_mfma_f32_16x16x32_bf16 v[160:163], v[116:119], v[112:115], v[160:163]
ds_read_b128 v[40:43], v2 offset:47104
v_mfma_f32_16x16x32_bf16 v[196:199], v[120:123], v[112:115], v[196:199]
ds_read_b128 v[44:47], v2 offset:49152
v_mfma_f32_16x16x32_bf16 v[192:195], v[120:123], v[108:111], v[192:195]
ds_read_b128 v[48:51], v2 offset:51200
v_mfma_f32_16x16x32_bf16 v[188:191], v[120:123], v[104:107], v[188:191]
ds_read_b128 v[52:55], v2 offset:53248
v_mfma_f32_16x16x32_bf16 v[184:187], v[120:123], v[100:103], v[184:187]
ds_read_b128 v[56:59], v2 offset:55296
v_mfma_f32_16x16x32_bf16 v[180:183], v[120:123], v[96:99], v[180:183]
ds_read_b128 v[60:63], v2 offset:57344
v_mfma_f32_16x16x32_bf16 v[176:179], v[120:123], v[92:95], v[176:179]
ds_read_b128 v[64:67], v2 offset:59392
v_mfma_f32_16x16x32_bf16 v[172:175], v[120:123], v[88:91], v[172:175]
v_mfma_f32_16x16x32_bf16 v[168:171], v[120:123], v[84:87], v[168:171]
v_mfma_f32_16x16x32_bf16 v[164:167], v[120:123], v[80:83], v[164:167]
v_mfma_f32_16x16x32_bf16 v[200:203], v[124:127], v[80:83], v[200:203]
v_mfma_f32_16x16x32_bf16 v[204:207], v[124:127], v[84:87], v[204:207]
v_mfma_f32_16x16x32_bf16 v[208:211], v[124:127], v[88:91], v[208:211]
v_mfma_f32_16x16x32_bf16 v[212:215], v[124:127], v[92:95], v[212:215]
v_mfma_f32_16x16x32_bf16 v[216:219], v[124:127], v[96:99], v[216:219]
v_mfma_f32_16x16x32_bf16 v[220:223], v[124:127], v[100:103], v[220:223]
v_mfma_f32_16x16x32_bf16 v[224:227], v[124:127], v[104:107], v[224:227]
v_mfma_f32_16x16x32_bf16 v[228:231], v[124:127], v[108:111], v[228:231]
v_mfma_f32_16x16x32_bf16 v[232:235], v[124:127], v[112:115], v[232:235]
s_waitcnt lgkmcnt(0)
v_mfma_f32_16x16x32_bf16 v[128:131], v[68:71], v[32:35], v[128:131]
ds_read_b128 v[80:83], v3 offset:43008
v_mfma_f32_16x16x32_bf16 v[132:135], v[68:71], v[36:39], v[132:135]
ds_read_b64_tr_b16 v[120:121], v7 offset:12288
v_mfma_f32_16x16x32_bf16 v[136:139], v[68:71], v[40:43], v[136:139]
ds_read_b64_tr_b16 v[122:123], v7 offset:12800
v_mfma_f32_16x16x32_bf16 v[140:143], v[68:71], v[44:47], v[140:143]
ds_read_b64_tr_b16 v[124:125], v7 offset:20480
v_mfma_f32_16x16x32_bf16 v[144:147], v[68:71], v[48:51], v[144:147]
ds_read_b64_tr_b16 v[126:127], v7 offset:20992
v_mfma_f32_16x16x32_bf16 v[148:151], v[68:71], v[52:55], v[148:151]
ds_read_b64_tr_b16 v[116:117], v7 offset:4096
v_mfma_f32_16x16x32_bf16 v[152:155], v[68:71], v[56:59], v[152:155]
ds_read_b64_tr_b16 v[118:119], v7 offset:4608
v_mfma_f32_16x16x32_bf16 v[156:159], v[68:71], v[60:63], v[156:159]
ds_read_b128 v[84:87], v3 offset:45056
v_mfma_f32_16x16x32_bf16 v[160:163], v[68:71], v[64:67], v[160:163]
ds_read_b128 v[88:91], v3 offset:47104
v_mfma_f32_16x16x32_bf16 v[196:199], v[72:75], v[64:67], v[196:199]
ds_read_b128 v[92:95], v3 offset:49152
v_mfma_f32_16x16x32_bf16 v[192:195], v[72:75], v[60:63], v[192:195]
ds_read_b128 v[96:99], v3 offset:51200
v_mfma_f32_16x16x32_bf16 v[188:191], v[72:75], v[56:59], v[188:191]
ds_read_b128 v[100:103], v3 offset:53248
v_mfma_f32_16x16x32_bf16 v[184:187], v[72:75], v[52:55], v[184:187]
ds_read_b128 v[104:107], v3 offset:55296
v_mfma_f32_16x16x32_bf16 v[180:183], v[72:75], v[48:51], v[180:183]
ds_read_b128 v[108:111], v3 offset:57344
v_mfma_f32_16x16x32_bf16 v[176:179], v[72:75], v[44:47], v[176:179]
ds_read_b128 v[112:115], v3 offset:59392
v_mfma_f32_16x16x32_bf16 v[172:175], v[72:75], v[40:43], v[172:175]
v_mfma_f32_16x16x32_bf16 v[168:171], v[72:75], v[36:39], v[168:171]
v_mfma_f32_16x16x32_bf16 v[164:167], v[72:75], v[32:35], v[164:167]
v_mfma_f32_16x16x32_bf16 v[200:203], v[76:79], v[32:35], v[200:203]
v_mfma_f32_16x16x32_bf16 v[204:207], v[76:79], v[36:39], v[204:207]
v_mfma_f32_16x16x32_bf16 v[208:211], v[76:79], v[40:43], v[208:211]
v_mfma_f32_16x16x32_bf16 v[212:215], v[76:79], v[44:47], v[212:215]
v_mfma_f32_16x16x32_bf16 v[216:219], v[76:79], v[48:51], v[216:219]
v_mfma_f32_16x16x32_bf16 v[220:223], v[76:79], v[52:55], v[220:223]
v_mfma_f32_16x16x32_bf16 v[224:227], v[76:79], v[56:59], v[224:227]
v_mfma_f32_16x16x32_bf16 v[228:231], v[76:79], v[60:63], v[228:231]
v_mfma_f32_16x16x32_bf16 v[232:235], v[76:79], v[64:67], v[232:235]
s_waitcnt lgkmcnt(0)
s_barrier
v_mfma_f32_16x16x32_bf16 v[128:131], v[116:119], v[80:83], v[128:131]
ds_read_b128 v[32:35], v4 offset:0
v_mfma_f32_16x16x32_bf16 v[132:135], v[116:119], v[84:87], v[132:135]
ds_read_b64_tr_b16 v[72:73], v8 offset:8192
v_mfma_f32_16x16x32_bf16 v[136:139], v[116:119], v[88:91], v[136:139]
ds_read_b64_tr_b16 v[74:75], v8 offset:8704
v_mfma_f32_16x16x32_bf16 v[140:143], v[116:119], v[92:95], v[140:143]
ds_read_b64_tr_b16 v[76:77], v8 offset:16384
v_mfma_f32_16x16x32_bf16 v[144:147], v[116:119], v[96:99], v[144:147]
ds_read_b64_tr_b16 v[78:79], v8 offset:16896
v_mfma_f32_16x16x32_bf16 v[148:151], v[116:119], v[100:103], v[148:151]
ds_read_b64_tr_b16 v[68:69], v8 offset:0
v_mfma_f32_16x16x32_bf16 v[152:155], v[116:119], v[104:107], v[152:155]
ds_read_b64_tr_b16 v[70:71], v8 offset:512
v_mfma_f32_16x16x32_bf16 v[156:159], v[116:119], v[108:111], v[156:159]
ds_read_b128 v[36:39], v4 offset:2048
v_mfma_f32_16x16x32_bf16 v[160:163], v[116:119], v[112:115], v[160:163]
ds_read_b128 v[40:43], v4 offset:4096
v_mfma_f32_16x16x32_bf16 v[196:199], v[120:123], v[112:115], v[196:199]
ds_read_b128 v[44:47], v4 offset:6144
v_mfma_f32_16x16x32_bf16 v[192:195], v[120:123], v[108:111], v[192:195]
ds_read_b128 v[48:51], v4 offset:8192
v_mfma_f32_16x16x32_bf16 v[188:191], v[120:123], v[104:107], v[188:191]
ds_read_b128 v[52:55], v4 offset:10240
v_mfma_f32_16x16x32_bf16 v[184:187], v[120:123], v[100:103], v[184:187]
ds_read_b128 v[56:59], v4 offset:12288
v_mfma_f32_16x16x32_bf16 v[180:183], v[120:123], v[96:99], v[180:183]
ds_read_b128 v[60:63], v4 offset:14336
v_mfma_f32_16x16x32_bf16 v[176:179], v[120:123], v[92:95], v[176:179]
ds_read_b128 v[64:67], v4 offset:16384
v_mfma_f32_16x16x32_bf16 v[172:175], v[120:123], v[88:91], v[172:175]
v_mfma_f32_16x16x32_bf16 v[168:171], v[120:123], v[84:87], v[168:171]
v_mfma_f32_16x16x32_bf16 v[164:167], v[120:123], v[80:83], v[164:167]
v_mfma_f32_16x16x32_bf16 v[200:203], v[124:127], v[80:83], v[200:203]
v_mfma_f32_16x16x32_bf16 v[204:207], v[124:127], v[84:87], v[204:207]
v_mfma_f32_16x16x32_bf16 v[208:211], v[124:127], v[88:91], v[208:211]
v_mfma_f32_16x16x32_bf16 v[212:215], v[124:127], v[92:95], v[212:215]
v_mfma_f32_16x16x32_bf16 v[216:219], v[124:127], v[96:99], v[216:219]
v_mfma_f32_16x16x32_bf16 v[220:223], v[124:127], v[100:103], v[220:223]
v_mfma_f32_16x16x32_bf16 v[224:227], v[124:127], v[104:107], v[224:227]
v_mfma_f32_16x16x32_bf16 v[228:231], v[124:127], v[108:111], v[228:231]
v_mfma_f32_16x16x32_bf16 v[232:235], v[124:127], v[112:115], v[232:235]
s_waitcnt lgkmcnt(0)
v_mfma_f32_16x16x32_bf16 v[128:131], v[68:71], v[32:35], v[128:131]
ds_read_b128 v[80:83], v5 offset:0
v_mfma_f32_16x16x32_bf16 v[132:135], v[68:71], v[36:39], v[132:135]
ds_read_b64_tr_b16 v[120:121], v8 offset:12288
v_mfma_f32_16x16x32_bf16 v[136:139], v[68:71], v[40:43], v[136:139]
ds_read_b64_tr_b16 v[122:123], v8 offset:12800
v_mfma_f32_16x16x32_bf16 v[140:143], v[68:71], v[44:47], v[140:143]
ds_read_b64_tr_b16 v[124:125], v8 offset:20480
v_mfma_f32_16x16x32_bf16 v[144:147], v[68:71], v[48:51], v[144:147]
ds_read_b64_tr_b16 v[126:127], v8 offset:20992
v_mfma_f32_16x16x32_bf16 v[148:151], v[68:71], v[52:55], v[148:151]
ds_read_b64_tr_b16 v[116:117], v8 offset:4096
v_mfma_f32_16x16x32_bf16 v[152:155], v[68:71], v[56:59], v[152:155]
ds_read_b64_tr_b16 v[118:119], v8 offset:4608
v_mfma_f32_16x16x32_bf16 v[156:159], v[68:71], v[60:63], v[156:159]
ds_read_b128 v[84:87], v5 offset:2048
v_mfma_f32_16x16x32_bf16 v[160:163], v[68:71], v[64:67], v[160:163]
ds_read_b128 v[88:91], v5 offset:4096
v_mfma_f32_16x16x32_bf16 v[196:199], v[72:75], v[64:67], v[196:199]
ds_read_b128 v[92:95], v5 offset:6144
v_mfma_f32_16x16x32_bf16 v[192:195], v[72:75], v[60:63], v[192:195]
ds_read_b128 v[96:99], v5 offset:8192
v_mfma_f32_16x16x32_bf16 v[188:191], v[72:75], v[56:59], v[188:191]
ds_read_b128 v[100:103], v5 offset:10240
v_mfma_f32_16x16x32_bf16 v[184:187], v[72:75], v[52:55], v[184:187]
ds_read_b128 v[104:107], v5 offset:12288
v_mfma_f32_16x16x32_bf16 v[180:183], v[72:75], v[48:51], v[180:183]
ds_read_b128 v[108:111], v5 offset:14336
v_mfma_f32_16x16x32_bf16 v[176:179], v[72:75], v[44:47], v[176:179]
ds_read_b128 v[112:115], v5 offset:16384
v_mfma_f32_16x16x32_bf16 v[172:175], v[72:75], v[40:43], v[172:175]
v_mfma_f32_16x16x32_bf16 v[168:171], v[72:75], v[36:39], v[168:171]
v_mfma_f32_16x16x32_bf16 v[164:167], v[72:75], v[32:35], v[164:167]
v_mfma_f32_16x16x32_bf16 v[200:203], v[76:79], v[32:35], v[200:203]
v_mfma_f32_16x16x32_bf16 v[204:207], v[76:79], v[36:39], v[204:207]
v_mfma_f32_16x16x32_bf16 v[208:211], v[76:79], v[40:43], v[208:211]
v_mfma_f32_16x16x32_bf16 v[212:215], v[76:79], v[44:47], v[212:215]
v_mfma_f32_16x16x32_bf16 v[216:219], v[76:79], v[48:51], v[216:219]
v_mfma_f32_16x16x32_bf16 v[220:223], v[76:79], v[52:55], v[220:223]
v_mfma_f32_16x16x32_bf16 v[224:227], v[76:79], v[56:59], v[224:227]
v_mfma_f32_16x16x32_bf16 v[228:231], v[76:79], v[60:63], v[228:231]
v_mfma_f32_16x16x32_bf16 v[232:235], v[76:79], v[64:67], v[232:235]
s_waitcnt lgkmcnt(0)
s_barrier
v_mfma_f32_16x16x32_bf16 v[128:131], v[116:119], v[80:83], v[128:131]
ds_read_b128 v[32:35], v2 offset:0
v_mfma_f32_16x16x32_bf16 v[132:135], v[116:119], v[84:87], v[132:135]
ds_read_b64_tr_b16 v[72:73], v6 offset:8192
v_mfma_f32_16x16x32_bf16 v[136:139], v[116:119], v[88:91], v[136:139]
ds_read_b64_tr_b16 v[74:75], v6 offset:8704
v_mfma_f32_16x16x32_bf16 v[140:143], v[116:119], v[92:95], v[140:143]
ds_read_b64_tr_b16 v[76:77], v6 offset:16384
v_mfma_f32_16x16x32_bf16 v[144:147], v[116:119], v[96:99], v[144:147]
ds_read_b64_tr_b16 v[78:79], v6 offset:16896
v_mfma_f32_16x16x32_bf16 v[148:151], v[116:119], v[100:103], v[148:151]
ds_read_b64_tr_b16 v[68:69], v6 offset:0
v_mfma_f32_16x16x32_bf16 v[152:155], v[116:119], v[104:107], v[152:155]
ds_read_b64_tr_b16 v[70:71], v6 offset:512
v_mfma_f32_16x16x32_bf16 v[156:159], v[116:119], v[108:111], v[156:159]
ds_read_b128 v[36:39], v2 offset:2048
v_mfma_f32_16x16x32_bf16 v[160:163], v[116:119], v[112:115], v[160:163]
ds_read_b128 v[40:43], v2 offset:4096
v_mfma_f32_16x16x32_bf16 v[196:199], v[120:123], v[112:115], v[196:199]
ds_read_b128 v[44:47], v2 offset:6144
v_mfma_f32_16x16x32_bf16 v[192:195], v[120:123], v[108:111], v[192:195]
ds_read_b128 v[48:51], v2 offset:8192
v_mfma_f32_16x16x32_bf16 v[188:191], v[120:123], v[104:107], v[188:191]
ds_read_b128 v[52:55], v2 offset:10240
v_mfma_f32_16x16x32_bf16 v[184:187], v[120:123], v[100:103], v[184:187]
ds_read_b128 v[56:59], v2 offset:12288
v_mfma_f32_16x16x32_bf16 v[180:183], v[120:123], v[96:99], v[180:183]
ds_read_b128 v[60:63], v2 offset:14336
v_mfma_f32_16x16x32_bf16 v[176:179], v[120:123], v[92:95], v[176:179]
ds_read_b128 v[64:67], v2 offset:16384
v_mfma_f32_16x16x32_bf16 v[172:175], v[120:123], v[88:91], v[172:175]
v_mfma_f32_16x16x32_bf16 v[168:171], v[120:123], v[84:87], v[168:171]
v_mfma_f32_16x16x32_bf16 v[164:167], v[120:123], v[80:83], v[164:167]
v_mfma_f32_16x16x32_bf16 v[200:203], v[124:127], v[80:83], v[200:203]
v_mfma_f32_16x16x32_bf16 v[204:207], v[124:127], v[84:87], v[204:207]
v_mfma_f32_16x16x32_bf16 v[208:211], v[124:127], v[88:91], v[208:211]
v_mfma_f32_16x16x32_bf16 v[212:215], v[124:127], v[92:95], v[212:215]
v_mfma_f32_16x16x32_bf16 v[216:219], v[124:127], v[96:99], v[216:219]
v_mfma_f32_16x16x32_bf16 v[220:223], v[124:127], v[100:103], v[220:223]
v_mfma_f32_16x16x32_bf16 v[224:227], v[124:127], v[104:107], v[224:227]
v_mfma_f32_16x16x32_bf16 v[228:231], v[124:127], v[108:111], v[228:231]
v_mfma_f32_16x16x32_bf16 v[232:235], v[124:127], v[112:115], v[232:235]
s_mov_b32 s41, 4
Lcl_31:
s_waitcnt lgkmcnt(0)
v_mfma_f32_16x16x32_bf16 v[128:131], v[68:71], v[32:35], v[128:131]
ds_read_b128 v[80:83], v3 offset:0
v_mfma_f32_16x16x32_bf16 v[132:135], v[68:71], v[36:39], v[132:135]
ds_read_b64_tr_b16 v[120:121], v6 offset:12288
v_mfma_f32_16x16x32_bf16 v[136:139], v[68:71], v[40:43], v[136:139]
ds_read_b64_tr_b16 v[122:123], v6 offset:12800
v_mfma_f32_16x16x32_bf16 v[140:143], v[68:71], v[44:47], v[140:143]
ds_read_b64_tr_b16 v[124:125], v6 offset:20480
v_mfma_f32_16x16x32_bf16 v[144:147], v[68:71], v[48:51], v[144:147]
ds_read_b64_tr_b16 v[126:127], v6 offset:20992
v_mfma_f32_16x16x32_bf16 v[148:151], v[68:71], v[52:55], v[148:151]
ds_read_b64_tr_b16 v[116:117], v6 offset:4096
v_mfma_f32_16x16x32_bf16 v[152:155], v[68:71], v[56:59], v[152:155]
ds_read_b64_tr_b16 v[118:119], v6 offset:4608
v_mfma_f32_16x16x32_bf16 v[156:159], v[68:71], v[60:63], v[156:159]
ds_read_b128 v[84:87], v3 offset:2048
v_mfma_f32_16x16x32_bf16 v[160:163], v[68:71], v[64:67], v[160:163]
ds_read_b128 v[88:91], v3 offset:4096
v_mfma_f32_16x16x32_bf16 v[196:199], v[72:75], v[64:67], v[196:199]
ds_read_b128 v[92:95], v3 offset:6144
v_mfma_f32_16x16x32_bf16 v[192:195], v[72:75], v[60:63], v[192:195]
ds_read_b128 v[96:99], v3 offset:8192
v_mfma_f32_16x16x32_bf16 v[188:191], v[72:75], v[56:59], v[188:191]
ds_read_b128 v[100:103], v3 offset:10240
v_mfma_f32_16x16x32_bf16 v[184:187], v[72:75], v[52:55], v[184:187]
ds_read_b128 v[104:107], v3 offset:12288
v_mfma_f32_16x16x32_bf16 v[180:183], v[72:75], v[48:51], v[180:183]
ds_read_b128 v[108:111], v3 offset:14336
v_mfma_f32_16x16x32_bf16 v[176:179], v[72:75], v[44:47], v[176:179]
ds_read_b128 v[112:115], v3 offset:16384
v_mfma_f32_16x16x32_bf16 v[172:175], v[72:75], v[40:43], v[172:175]
v_mfma_f32_16x16x32_bf16 v[168:171], v[72:75], v[36:39], v[168:171]
v_mfma_f32_16x16x32_bf16 v[164:167], v[72:75], v[32:35], v[164:167]
v_mfma_f32_16x16x32_bf16 v[200:203], v[76:79], v[32:35], v[200:203]
v_mfma_f32_16x16x32_bf16 v[204:207], v[76:79], v[36:39], v[204:207]
v_mfma_f32_16x16x32_bf16 v[208:211], v[76:79], v[40:43], v[208:211]
v_mfma_f32_16x16x32_bf16 v[212:215], v[76:79], v[44:47], v[212:215]
v_mfma_f32_16x16x32_bf16 v[216:219], v[76:79], v[48:51], v[216:219]
v_mfma_f32_16x16x32_bf16 v[220:223], v[76:79], v[52:55], v[220:223]
v_mfma_f32_16x16x32_bf16 v[224:227], v[76:79], v[56:59], v[224:227]
v_mfma_f32_16x16x32_bf16 v[228:231], v[76:79], v[60:63], v[228:231]
v_mfma_f32_16x16x32_bf16 v[232:235], v[76:79], v[64:67], v[232:235]
s_waitcnt lgkmcnt(0)
s_barrier
v_mfma_f32_16x16x32_bf16 v[128:131], v[116:119], v[80:83], v[128:131]
s_branch Lov_2
.p2align 12
.fill 16, 4, 0xbf800000
Lst_2_0:
s_branch Lwr_162
s_nop 0
s_nop 0
Lov_2:
ds_read_b128 v[32:35], v2 offset:43008
v_mfma_f32_16x16x32_bf16 v[132:135], v[116:119], v[84:87], v[132:135]
ds_read_b64_tr_b16 v[72:73], v7 offset:8192
v_mfma_f32_16x16x32_bf16 v[136:139], v[116:119], v[88:91], v[136:139]
ds_read_b64_tr_b16 v[74:75], v7 offset:8704
v_mfma_f32_16x16x32_bf16 v[140:143], v[116:119], v[92:95], v[140:143]
ds_read_b64_tr_b16 v[76:77], v7 offset:16384
v_mfma_f32_16x16x32_bf16 v[144:147], v[116:119], v[96:99], v[144:147]
ds_read_b64_tr_b16 v[78:79], v7 offset:16896
v_mfma_f32_16x16x32_bf16 v[148:151], v[116:119], v[100:103], v[148:151]
ds_read_b64_tr_b16 v[68:69], v7 offset:0
v_mfma_f32_16x16x32_bf16 v[152:155], v[116:119], v[104:107], v[152:155]
ds_read_b64_tr_b16 v[70:71], v7 offset:512
v_mfma_f32_16x16x32_bf16 v[156:159], v[116:119], v[108:111], v[156:159]
ds_read_b128 v[36:39], v2 offset:45056
v_mfma_f32_16x16x32_bf16 v[160:163], v[116:119], v[112:115], v[160:163]
ds_read_b128 v[40:43], v2 offset:47104
v_mfma_f32_16x16x32_bf16 v[196:199], v[120:123], v[112:115], v[196:199]
ds_read_b128 v[44:47], v2 offset:49152
v_mfma_f32_16x16x32_bf16 v[192:195], v[120:123], v[108:111], v[192:195]
ds_read_b128 v[48:51], v2 offset:51200
v_mfma_f32_16x16x32_bf16 v[188:191], v[120:123], v[104:107], v[188:191]
ds_read_b128 v[52:55], v2 offset:53248
v_mfma_f32_16x16x32_bf16 v[184:187], v[120:123], v[100:103], v[184:187]
ds_read_b128 v[56:59], v2 offset:55296
v_mfma_f32_16x16x32_bf16 v[180:183], v[120:123], v[96:99], v[180:183]
ds_read_b128 v[60:63], v2 offset:57344
v_mfma_f32_16x16x32_bf16 v[176:179], v[120:123], v[92:95], v[176:179]
ds_read_b128 v[64:67], v2 offset:59392
v_mfma_f32_16x16x32_bf16 v[172:175], v[120:123], v[88:91], v[172:175]
v_mfma_f32_16x16x32_bf16 v[168:171], v[120:123], v[84:87], v[168:171]
v_mfma_f32_16x16x32_bf16 v[164:167], v[120:123], v[80:83], v[164:167]
v_mfma_f32_16x16x32_bf16 v[200:203], v[124:127], v[80:83], v[200:203]
v_mfma_f32_16x16x32_bf16 v[204:207], v[124:127], v[84:87], v[204:207]
v_mfma_f32_16x16x32_bf16 v[208:211], v[124:127], v[88:91], v[208:211]
v_mfma_f32_16x16x32_bf16 v[212:215], v[124:127], v[92:95], v[212:215]
v_mfma_f32_16x16x32_bf16 v[216:219], v[124:127], v[96:99], v[216:219]
v_mfma_f32_16x16x32_bf16 v[220:223], v[124:127], v[100:103], v[220:223]
v_mfma_f32_16x16x32_bf16 v[224:227], v[124:127], v[104:107], v[224:227]
v_mfma_f32_16x16x32_bf16 v[228:231], v[124:127], v[108:111], v[228:231]
v_mfma_f32_16x16x32_bf16 v[232:235], v[124:127], v[112:115], v[232:235]
s_waitcnt lgkmcnt(0)
v_mfma_f32_16x16x32_bf16 v[128:131], v[68:71], v[32:35], v[128:131]
ds_read_b128 v[80:83], v3 offset:43008
v_mfma_f32_16x16x32_bf16 v[132:135], v[68:71], v[36:39], v[132:135]
ds_read_b64_tr_b16 v[120:121], v7 offset:12288
v_mfma_f32_16x16x32_bf16 v[136:139], v[68:71], v[40:43], v[136:139]
ds_read_b64_tr_b16 v[122:123], v7 offset:12800
v_mfma_f32_16x16x32_bf16 v[140:143], v[68:71], v[44:47], v[140:143]
ds_read_b64_tr_b16 v[124:125], v7 offset:20480
v_mfma_f32_16x16x32_bf16 v[144:147], v[68:71], v[48:51], v[144:147]
ds_read_b64_tr_b16 v[126:127], v7 offset:20992
v_mfma_f32_16x16x32_bf16 v[148:151], v[68:71], v[52:55], v[148:151]
ds_read_b64_tr_b16 v[116:117], v7 offset:4096
v_mfma_f32_16x16x32_bf16 v[152:155], v[68:71], v[56:59], v[152:155]
ds_read_b64_tr_b16 v[118:119], v7 offset:4608
v_mfma_f32_16x16x32_bf16 v[156:159], v[68:71], v[60:63], v[156:159]
ds_read_b128 v[84:87], v3 offset:45056
v_mfma_f32_16x16x32_bf16 v[160:163], v[68:71], v[64:67], v[160:163]
ds_read_b128 v[88:91], v3 offset:47104
v_mfma_f32_16x16x32_bf16 v[196:199], v[72:75], v[64:67], v[196:199]
ds_read_b128 v[92:95], v3 offset:49152
v_mfma_f32_16x16x32_bf16 v[192:195], v[72:75], v[60:63], v[192:195]
ds_read_b128 v[96:99], v3 offset:51200
v_mfma_f32_16x16x32_bf16 v[188:191], v[72:75], v[56:59], v[188:191]
ds_read_b128 v[100:103], v3 offset:53248
v_mfma_f32_16x16x32_bf16 v[184:187], v[72:75], v[52:55], v[184:187]
ds_read_b128 v[104:107], v3 offset:55296
v_mfma_f32_16x16x32_bf16 v[180:183], v[72:75], v[48:51], v[180:183]
ds_read_b128 v[108:111], v3 offset:57344
v_mfma_f32_16x16x32_bf16 v[176:179], v[72:75], v[44:47], v[176:179]
ds_read_b128 v[112:115], v3 offset:59392
v_mfma_f32_16x16x32_bf16 v[172:175], v[72:75], v[40:43], v[172:175]
v_mfma_f32_16x16x32_bf16 v[168:171], v[72:75], v[36:39], v[168:171]
v_mfma_f32_16x16x32_bf16 v[164:167], v[72:75], v[32:35], v[164:167]
v_mfma_f32_16x16x32_bf16 v[200:203], v[76:79], v[32:35], v[200:203]
v_mfma_f32_16x16x32_bf16 v[204:207], v[76:79], v[36:39], v[204:207]
v_mfma_f32_16x16x32_bf16 v[208:211], v[76:79], v[40:43], v[208:211]
v_mfma_f32_16x16x32_bf16 v[212:215], v[76:79], v[44:47], v[212:215]
v_mfma_f32_16x16x32_bf16 v[216:219], v[76:79], v[48:51], v[216:219]
v_mfma_f32_16x16x32_bf16 v[220:223], v[76:79], v[52:55], v[220:223]
v_mfma_f32_16x16x32_bf16 v[224:227], v[76:79], v[56:59], v[224:227]
v_mfma_f32_16x16x32_bf16 v[228:231], v[76:79], v[60:63], v[228:231]
v_mfma_f32_16x16x32_bf16 v[232:235], v[76:79], v[64:67], v[232:235]
s_waitcnt lgkmcnt(0)
s_barrier
v_mfma_f32_16x16x32_bf16 v[128:131], v[116:119], v[80:83], v[128:131]
ds_read_b128 v[32:35], v4 offset:0
v_mfma_f32_16x16x32_bf16 v[132:135], v[116:119], v[84:87], v[132:135]
ds_read_b64_tr_b16 v[72:73], v8 offset:8192
v_mfma_f32_16x16x32_bf16 v[136:139], v[116:119], v[88:91], v[136:139]
ds_read_b64_tr_b16 v[74:75], v8 offset:8704
v_mfma_f32_16x16x32_bf16 v[140:143], v[116:119], v[92:95], v[140:143]
ds_read_b64_tr_b16 v[76:77], v8 offset:16384
v_mfma_f32_16x16x32_bf16 v[144:147], v[116:119], v[96:99], v[144:147]
ds_read_b64_tr_b16 v[78:79], v8 offset:16896
v_mfma_f32_16x16x32_bf16 v[148:151], v[116:119], v[100:103], v[148:151]
ds_read_b64_tr_b16 v[68:69], v8 offset:0
v_mfma_f32_16x16x32_bf16 v[152:155], v[116:119], v[104:107], v[152:155]
ds_read_b64_tr_b16 v[70:71], v8 offset:512
v_mfma_f32_16x16x32_bf16 v[156:159], v[116:119], v[108:111], v[156:159]
ds_read_b128 v[36:39], v4 offset:2048
v_mfma_f32_16x16x32_bf16 v[160:163], v[116:119], v[112:115], v[160:163]
ds_read_b128 v[40:43], v4 offset:4096
v_mfma_f32_16x16x32_bf16 v[196:199], v[120:123], v[112:115], v[196:199]
ds_read_b128 v[44:47], v4 offset:6144
v_mfma_f32_16x16x32_bf16 v[192:195], v[120:123], v[108:111], v[192:195]
ds_read_b128 v[48:51], v4 offset:8192
v_mfma_f32_16x16x32_bf16 v[188:191], v[120:123], v[104:107], v[188:191]
ds_read_b128 v[52:55], v4 offset:10240
v_mfma_f32_16x16x32_bf16 v[184:187], v[120:123], v[100:103], v[184:187]
ds_read_b128 v[56:59], v4 offset:12288
v_mfma_f32_16x16x32_bf16 v[180:183], v[120:123], v[96:99], v[180:183]
ds_read_b128 v[60:63], v4 offset:14336
v_mfma_f32_16x16x32_bf16 v[176:179], v[120:123], v[92:95], v[176:179]
ds_read_b128 v[64:67], v4 offset:16384
v_mfma_f32_16x16x32_bf16 v[172:175], v[120:123], v[88:91], v[172:175]
v_mfma_f32_16x16x32_bf16 v[168:171], v[120:123], v[84:87], v[168:171]
v_mfma_f32_16x16x32_bf16 v[164:167], v[120:123], v[80:83], v[164:167]
v_mfma_f32_16x16x32_bf16 v[200:203], v[124:127], v[80:83], v[200:203]
v_mfma_f32_16x16x32_bf16 v[204:207], v[124:127], v[84:87], v[204:207]
v_mfma_f32_16x16x32_bf16 v[208:211], v[124:127], v[88:91], v[208:211]
v_mfma_f32_16x16x32_bf16 v[212:215], v[124:127], v[92:95], v[212:215]
v_mfma_f32_16x16x32_bf16 v[216:219], v[124:127], v[96:99], v[216:219]
v_mfma_f32_16x16x32_bf16 v[220:223], v[124:127], v[100:103], v[220:223]
v_mfma_f32_16x16x32_bf16 v[224:227], v[124:127], v[104:107], v[224:227]
v_mfma_f32_16x16x32_bf16 v[228:231], v[124:127], v[108:111], v[228:231]
v_mfma_f32_16x16x32_bf16 v[232:235], v[124:127], v[112:115], v[232:235]
s_waitcnt lgkmcnt(0)
v_mfma_f32_16x16x32_bf16 v[128:131], v[68:71], v[32:35], v[128:131]
ds_read_b128 v[80:83], v5 offset:0
v_mfma_f32_16x16x32_bf16 v[132:135], v[68:71], v[36:39], v[132:135]
ds_read_b64_tr_b16 v[120:121], v8 offset:12288
v_mfma_f32_16x16x32_bf16 v[136:139], v[68:71], v[40:43], v[136:139]
ds_read_b64_tr_b16 v[122:123], v8 offset:12800
v_mfma_f32_16x16x32_bf16 v[140:143], v[68:71], v[44:47], v[140:143]
ds_read_b64_tr_b16 v[124:125], v8 offset:20480
v_mfma_f32_16x16x32_bf16 v[144:147], v[68:71], v[48:51], v[144:147]
ds_read_b64_tr_b16 v[126:127], v8 offset:20992
v_mfma_f32_16x16x32_bf16 v[148:151], v[68:71], v[52:55], v[148:151]
ds_read_b64_tr_b16 v[116:117], v8 offset:4096
v_mfma_f32_16x16x32_bf16 v[152:155], v[68:71], v[56:59], v[152:155]
ds_read_b64_tr_b16 v[118:119], v8 offset:4608
v_mfma_f32_16x16x32_bf16 v[156:159], v[68:71], v[60:63], v[156:159]
ds_read_b128 v[84:87], v5 offset:2048
v_mfma_f32_16x16x32_bf16 v[160:163], v[68:71], v[64:67], v[160:163]
ds_read_b128 v[88:91], v5 offset:4096
v_mfma_f32_16x16x32_bf16 v[196:199], v[72:75], v[64:67], v[196:199]
ds_read_b128 v[92:95], v5 offset:6144
v_mfma_f32_16x16x32_bf16 v[192:195], v[72:75], v[60:63], v[192:195]
ds_read_b128 v[96:99], v5 offset:8192
v_mfma_f32_16x16x32_bf16 v[188:191], v[72:75], v[56:59], v[188:191]
ds_read_b128 v[100:103], v5 offset:10240
v_mfma_f32_16x16x32_bf16 v[184:187], v[72:75], v[52:55], v[184:187]
ds_read_b128 v[104:107], v5 offset:12288
v_mfma_f32_16x16x32_bf16 v[180:183], v[72:75], v[48:51], v[180:183]
ds_read_b128 v[108:111], v5 offset:14336
v_mfma_f32_16x16x32_bf16 v[176:179], v[72:75], v[44:47], v[176:179]
ds_read_b128 v[112:115], v5 offset:16384
v_mfma_f32_16x16x32_bf16 v[172:175], v[72:75], v[40:43], v[172:175]
v_mfma_f32_16x16x32_bf16 v[168:171], v[72:75], v[36:39], v[168:171]
v_mfma_f32_16x16x32_bf16 v[164:167], v[72:75], v[32:35], v[164:167]
v_mfma_f32_16x16x32_bf16 v[200:203], v[76:79], v[32:35], v[200:203]
v_mfma_f32_16x16x32_bf16 v[204:207], v[76:79], v[36:39], v[204:207]
v_mfma_f32_16x16x32_bf16 v[208:211], v[76:79], v[40:43], v[208:211]
v_mfma_f32_16x16x32_bf16 v[212:215], v[76:79], v[44:47], v[212:215]
v_mfma_f32_16x16x32_bf16 v[216:219], v[76:79], v[48:51], v[216:219]
v_mfma_f32_16x16x32_bf16 v[220:223], v[76:79], v[52:55], v[220:223]
v_mfma_f32_16x16x32_bf16 v[224:227], v[76:79], v[56:59], v[224:227]
v_mfma_f32_16x16x32_bf16 v[228:231], v[76:79], v[60:63], v[228:231]
v_mfma_f32_16x16x32_bf16 v[232:235], v[76:79], v[64:67], v[232:235]
s_waitcnt lgkmcnt(0)
s_barrier
v_mfma_f32_16x16x32_bf16 v[128:131], v[116:119], v[80:83], v[128:131]
ds_read_b128 v[32:35], v2 offset:0
v_mfma_f32_16x16x32_bf16 v[132:135], v[116:119], v[84:87], v[132:135]
ds_read_b64_tr_b16 v[72:73], v6 offset:8192
v_mfma_f32_16x16x32_bf16 v[136:139], v[116:119], v[88:91], v[136:139]
ds_read_b64_tr_b16 v[74:75], v6 offset:8704
v_mfma_f32_16x16x32_bf16 v[140:143], v[116:119], v[92:95], v[140:143]
ds_read_b64_tr_b16 v[76:77], v6 offset:16384
v_mfma_f32_16x16x32_bf16 v[144:147], v[116:119], v[96:99], v[144:147]
ds_read_b64_tr_b16 v[78:79], v6 offset:16896
v_mfma_f32_16x16x32_bf16 v[148:151], v[116:119], v[100:103], v[148:151]
ds_read_b64_tr_b16 v[68:69], v6 offset:0
v_mfma_f32_16x16x32_bf16 v[152:155], v[116:119], v[104:107], v[152:155]
ds_read_b64_tr_b16 v[70:71], v6 offset:512
v_mfma_f32_16x16x32_bf16 v[156:159], v[116:119], v[108:111], v[156:159]
ds_read_b128 v[36:39], v2 offset:2048
v_mfma_f32_16x16x32_bf16 v[160:163], v[116:119], v[112:115], v[160:163]
ds_read_b128 v[40:43], v2 offset:4096
v_mfma_f32_16x16x32_bf16 v[196:199], v[120:123], v[112:115], v[196:199]
ds_read_b128 v[44:47], v2 offset:6144
v_mfma_f32_16x16x32_bf16 v[192:195], v[120:123], v[108:111], v[192:195]
ds_read_b128 v[48:51], v2 offset:8192
v_mfma_f32_16x16x32_bf16 v[188:191], v[120:123], v[104:107], v[188:191]
ds_read_b128 v[52:55], v2 offset:10240
v_mfma_f32_16x16x32_bf16 v[184:187], v[120:123], v[100:103], v[184:187]
ds_read_b128 v[56:59], v2 offset:12288
v_mfma_f32_16x16x32_bf16 v[180:183], v[120:123], v[96:99], v[180:183]
ds_read_b128 v[60:63], v2 offset:14336
v_mfma_f32_16x16x32_bf16 v[176:179], v[120:123], v[92:95], v[176:179]
ds_read_b128 v[64:67], v2 offset:16384
v_mfma_f32_16x16x32_bf16 v[172:175], v[120:123], v[88:91], v[172:175]
v_mfma_f32_16x16x32_bf16 v[168:171], v[120:123], v[84:87], v[168:171]
v_mfma_f32_16x16x32_bf16 v[164:167], v[120:123], v[80:83], v[164:167]
v_mfma_f32_16x16x32_bf16 v[200:203], v[124:127], v[80:83], v[200:203]
v_mfma_f32_16x16x32_bf16 v[204:207], v[124:127], v[84:87], v[204:207]
v_mfma_f32_16x16x32_bf16 v[208:211], v[124:127], v[88:91], v[208:211]
v_mfma_f32_16x16x32_bf16 v[212:215], v[124:127], v[92:95], v[212:215]
v_mfma_f32_16x16x32_bf16 v[216:219], v[124:127], v[96:99], v[216:219]
v_mfma_f32_16x16x32_bf16 v[220:223], v[124:127], v[100:103], v[220:223]
v_mfma_f32_16x16x32_bf16 v[224:227], v[124:127], v[104:107], v[224:227]
v_mfma_f32_16x16x32_bf16 v[228:231], v[124:127], v[108:111], v[228:231]
v_mfma_f32_16x16x32_bf16 v[232:235], v[124:127], v[112:115], v[232:235]
s_sub_u32 s41, s41, 1
s_cmp_lg_u32 s41, 0
s_cbranch_scc1 Lcl_31
s_waitcnt lgkmcnt(0)
v_mfma_f32_16x16x32_bf16 v[128:131], v[68:71], v[32:35], v[128:131]
ds_read_b128 v[80:83], v3 offset:0
v_mfma_f32_16x16x32_bf16 v[132:135], v[68:71], v[36:39], v[132:135]
ds_read_b64_tr_b16 v[120:121], v6 offset:12288
v_mfma_f32_16x16x32_bf16 v[136:139], v[68:71], v[40:43], v[136:139]
ds_read_b64_tr_b16 v[122:123], v6 offset:12800
v_mfma_f32_16x16x32_bf16 v[140:143], v[68:71], v[44:47], v[140:143]
ds_read_b64_tr_b16 v[124:125], v6 offset:20480
v_mfma_f32_16x16x32_bf16 v[144:147], v[68:71], v[48:51], v[144:147]
ds_read_b64_tr_b16 v[126:127], v6 offset:20992
v_mfma_f32_16x16x32_bf16 v[148:151], v[68:71], v[52:55], v[148:151]
ds_read_b64_tr_b16 v[116:117], v6 offset:4096
v_mfma_f32_16x16x32_bf16 v[152:155], v[68:71], v[56:59], v[152:155]
ds_read_b64_tr_b16 v[118:119], v6 offset:4608
v_mfma_f32_16x16x32_bf16 v[156:159], v[68:71], v[60:63], v[156:159]
ds_read_b128 v[84:87], v3 offset:2048
v_mfma_f32_16x16x32_bf16 v[160:163], v[68:71], v[64:67], v[160:163]
ds_read_b128 v[88:91], v3 offset:4096
v_mfma_f32_16x16x32_bf16 v[196:199], v[72:75], v[64:67], v[196:199]
ds_read_b128 v[92:95], v3 offset:6144
v_mfma_f32_16x16x32_bf16 v[192:195], v[72:75], v[60:63], v[192:195]
ds_read_b128 v[96:99], v3 offset:8192
v_mfma_f32_16x16x32_bf16 v[188:191], v[72:75], v[56:59], v[188:191]
ds_read_b128 v[100:103], v3 offset:10240
v_mfma_f32_16x16x32_bf16 v[184:187], v[72:75], v[52:55], v[184:187]
ds_read_b128 v[104:107], v3 offset:12288
v_mfma_f32_16x16x32_bf16 v[180:183], v[72:75], v[48:51], v[180:183]
ds_read_b128 v[108:111], v3 offset:14336
v_mfma_f32_16x16x32_bf16 v[176:179], v[72:75], v[44:47], v[176:179]
ds_read_b128 v[112:115], v3 offset:16384
v_mfma_f32_16x16x32_bf16 v[172:175], v[72:75], v[40:43], v[172:175]
v_mfma_f32_16x16x32_bf16 v[168:171], v[72:75], v[36:39], v[168:171]
v_mfma_f32_16x16x32_bf16 v[164:167], v[72:75], v[32:35], v[164:167]
v_mfma_f32_16x16x32_bf16 v[200:203], v[76:79], v[32:35], v[200:203]
v_mfma_f32_16x16x32_bf16 v[204:207], v[76:79], v[36:39], v[204:207]
v_mfma_f32_16x16x32_bf16 v[208:211], v[76:79], v[40:43], v[208:211]
v_mfma_f32_16x16x32_bf16 v[212:215], v[76:79], v[44:47], v[212:215]
v_mfma_f32_16x16x32_bf16 v[216:219], v[76:79], v[48:51], v[216:219]
v_mfma_f32_16x16x32_bf16 v[220:223], v[76:79], v[52:55], v[220:223]
v_mfma_f32_16x16x32_bf16 v[224:227], v[76:79], v[56:59], v[224:227]
v_mfma_f32_16x16x32_bf16 v[228:231], v[76:79], v[60:63], v[228:231]
v_mfma_f32_16x16x32_bf16 v[232:235], v[76:79], v[64:67], v[232:235]
s_waitcnt lgkmcnt(0)
v_mfma_f32_16x16x32_bf16 v[128:131], v[116:119], v[80:83], v[128:131]
v_mfma_f32_16x16x32_bf16 v[132:135], v[116:119], v[84:87], v[132:135]
v_mfma_f32_16x16x32_bf16 v[136:139], v[116:119], v[88:91], v[136:139]
v_mfma_f32_16x16x32_bf16 v[140:143], v[116:119], v[92:95], v[140:143]
v_mfma_f32_16x16x32_bf16 v[144:147], v[116:119], v[96:99], v[144:147]
v_mfma_f32_16x16x32_bf16 v[148:151], v[116:119], v[100:103], v[148:151]
v_mfma_f32_16x16x32_bf16 v[152:155], v[116:119], v[104:107], v[152:155]
v_mfma_f32_16x16x32_bf16 v[156:159], v[116:119], v[108:111], v[156:159]
v_mfma_f32_16x16x32_bf16 v[160:163], v[116:119], v[112:115], v[160:163]
v_mfma_f32_16x16x32_bf16 v[196:199], v[120:123], v[112:115], v[196:199]
v_mfma_f32_16x16x32_bf16 v[192:195], v[120:123], v[108:111], v[192:195]
v_mfma_f32_16x16x32_bf16 v[188:191], v[120:123], v[104:107], v[188:191]
v_mfma_f32_16x16x32_bf16 v[184:187], v[120:123], v[100:103], v[184:187]
v_mfma_f32_16x16x32_bf16 v[180:183], v[120:123], v[96:99], v[180:183]
v_mfma_f32_16x16x32_bf16 v[176:179], v[120:123], v[92:95], v[176:179]
v_mfma_f32_16x16x32_bf16 v[172:175], v[120:123], v[88:91], v[172:175]
v_mfma_f32_16x16x32_bf16 v[168:171], v[120:123], v[84:87], v[168:171]
v_mfma_f32_16x16x32_bf16 v[164:167], v[120:123], v[80:83], v[164:167]
v_mfma_f32_16x16x32_bf16 v[200:203], v[124:127], v[80:83], v[200:203]
v_mfma_f32_16x16x32_bf16 v[204:207], v[124:127], v[84:87], v[204:207]
v_mfma_f32_16x16x32_bf16 v[208:211], v[124:127], v[88:91], v[208:211]
v_mfma_f32_16x16x32_bf16 v[212:215], v[124:127], v[92:95], v[212:215]
v_mfma_f32_16x16x32_bf16 v[216:219], v[124:127], v[96:99], v[216:219]
v_mfma_f32_16x16x32_bf16 v[220:223], v[124:127], v[100:103], v[220:223]
v_mfma_f32_16x16x32_bf16 v[224:227], v[124:127], v[104:107], v[224:227]
v_mfma_f32_16x16x32_bf16 v[228:231], v[124:127], v[108:111], v[228:231]
v_mfma_f32_16x16x32_bf16 v[232:235], v[124:127], v[112:115], v[232:235]
Lepi:
v_lshlrev_b32 v14, 3, v12
v_add_u32 v14, 147456, v14
v_mul_u32_u24 v15, 400, v12
v_lshl_add_u32 v15, v13, 3, v15
s_lshl_b32 s43, s36, 5
v_add_u32 v15, s43, v15
s_barrier
ds_read_b64 v[32:33], v14 offset:0
ds_read_b64 v[34:35], v14 offset:128
ds_read_b64 v[36:37], v14 offset:256
ds_read_b64 v[38:39], v14 offset:384
ds_read_b64 v[40:41], v14 offset:512
ds_read_b64 v[42:43], v14 offset:640
ds_read_b64 v[44:45], v14 offset:768
ds_read_b64 v[46:47], v14 offset:896
ds_read_b64 v[48:49], v14 offset:1024
v_mov_b32_dpp v52, v128 row_newbcast:0 row_mask:0xf bank_mask:0xf
v_mov_b32_dpp v53, v129 row_newbcast:0 row_mask:0xf bank_mask:0xf
v_mov_b32_dpp v54, v130 row_newbcast:0 row_mask:0xf bank_mask:0xf
v_mov_b32_dpp v55, v131 row_newbcast:0 row_mask:0xf bank_mask:0xf
v_mov_b32_dpp v56, v164 row_newbcast:0 row_mask:0xf bank_mask:0xf
v_mov_b32_dpp v57, v165 row_newbcast:0 row_mask:0xf bank_mask:0xf
v_mov_b32_dpp v58, v166 row_newbcast:0 row_mask:0xf bank_mask:0xf
v_mov_b32_dpp v59, v167 row_newbcast:0 row_mask:0xf bank_mask:0xf
v_mov_b32_dpp v60, v200 row_newbcast:0 row_mask:0xf bank_mask:0xf
v_mov_b32_dpp v61, v201 row_newbcast:0 row_mask:0xf bank_mask:0xf
v_mov_b32_dpp v62, v202 row_newbcast:0 row_mask:0xf bank_mask:0xf
v_mov_b32_dpp v63, v203 row_newbcast:0 row_mask:0xf bank_mask:0xf
s_waitcnt lgkmcnt(0)
v_pk_fma_f32 v[164:165], v[32:33], v[56:57], v[164:165] op_sel_hi:[0,1,1] neg_lo:[1,0,0] neg_hi:[1,0,0]
v_pk_fma_f32 v[166:167], v[32:33], v[58:59], v[166:167] op_sel_hi:[0,1,1] neg_lo:[1,0,0] neg_hi:[1,0,0]
v_pk_fma_f32 v[200:201], v[32:33], v[60:61], v[200:201] op_sel_hi:[0,1,1] neg_lo:[1,0,0] neg_hi:[1,0,0]
v_pk_fma_f32 v[202:203], v[32:33], v[62:63], v[202:203] op_sel_hi:[0,1,1] neg_lo:[1,0,0] neg_hi:[1,0,0]
v_pk_mul_f32 v[164:165], v[32:33], v[164:165] op_sel:[1,0] op_sel_hi:[1,1]
v_pk_mul_f32 v[166:167], v[32:33], v[166:167] op_sel:[1,0] op_sel_hi:[1,1]
v_pk_fma_f32 v[132:133], v[34:35], v[52:53], v[132:133] op_sel_hi:[0,1,1] neg_lo:[1,0,0] neg_hi:[1,0,0]
v_pk_fma_f32 v[134:135], v[34:35], v[54:55], v[134:135] op_sel_hi:[0,1,1] neg_lo:[1,0,0] neg_hi:[1,0,0]
v_pk_mul_f32 v[200:201], v[32:33], v[200:201] op_sel:[1,0] op_sel_hi:[1,1]
v_pk_mul_f32 v[202:203], v[32:33], v[202:203] op_sel:[1,0] op_sel_hi:[1,1]
v_cvt_pk_bf16_f32 v164, v164, v165
v_cvt_pk_bf16_f32 v165, v166, v167
ds_write_b64 v15, v[164:165] offset:128
v_pk_fma_f32 v[168:169], v[34:35], v[56:57], v[168:169] op_sel_hi:[0,1,1] neg_lo:[1,0,0] neg_hi:[1,0,0]
v_pk_fma_f32 v[170:171], v[34:35], v[58:59], v[170:171] op_sel_hi:[0,1,1] neg_lo:[1,0,0] neg_hi:[1,0,0]
v_pk_mul_f32 v[132:133], v[34:35], v[132:133] op_sel:[1,0] op_sel_hi:[1,1]
v_pk_mul_f32 v[134:135], v[34:35], v[134:135] op_sel:[1,0] op_sel_hi:[1,1]
v_cvt_pk_bf16_f32 v200, v200, v201
v_cvt_pk_bf16_f32 v201, v202, v203
ds_write_b64 v15, v[200:201] offset:256
v_pk_fma_f32 v[204:205], v[34:35], v[60:61], v[204:205] op_sel_hi:[0,1,1] neg_lo:[1,0,0] neg_hi:[1,0,0]
v_pk_fma_f32 v[206:207], v[34:35], v[62:63], v[206:207] op_sel_hi:[0,1,1] neg_lo:[1,0,0] neg_hi:[1,0,0]
v_pk_mul_f32 v[168:169], v[34:35], v[168:169] op_sel:[1,0] op_sel_hi:[1,1]
v_pk_mul_f32 v[170:171], v[34:35], v[170:171] op_sel:[1,0] op_sel_hi:[1,1]
v_cvt_pk_bf16_f32 v132, v132, v133
v_cvt_pk_bf16_f32 v133, v134, v135
ds_write_b64 v15, v[132:133] offset:6400
v_pk_fma_f32 v[136:137], v[36:37], v[52:53], v[136:137] op_sel_hi:[0,1,1] neg_lo:[1,0,0] neg_hi:[1,0,0]
v_pk_fma_f32 v[138:139], v[36:37], v[54:55], v[138:139] op_sel_hi:[0,1,1] neg_lo:[1,0,0] neg_hi:[1,0,0]
v_pk_mul_f32 v[204:205], v[34:35], v[204:205] op_sel:[1,0] op_sel_hi:[1,1]
v_pk_mul_f32 v[206:207], v[34:35], v[206:207] op_sel:[1,0] op_sel_hi:[1,1]
v_cvt_pk_bf16_f32 v168, v168, v169
v_cvt_pk_bf16_f32 v169, v170, v171
ds_write_b64 v15, v[168:169] offset:6528
v_pk_fma_f32 v[172:173], v[36:37], v[56:57], v[172:173] op_sel_hi:[0,1,1] neg_lo:[1,0,0] neg_hi:[1,0,0]
v_pk_fma_f32 v[174:175], v[36:37], v[58:59], v[174:175] op_sel_hi:[0,1,1] neg_lo:[1,0,0] neg_hi:[1,0,0]
v_pk_mul_f32 v[136:137], v[36:37], v[136:137] op_sel:[1,0] op_sel_hi:[1,1]
v_pk_mul_f32 v[138:139], v[36:37], v[138:139] op_sel:[1,0] op_sel_hi:[1,1]
v_cvt_pk_bf16_f32 v204, v204, v205
v_cvt_pk_bf16_f32 v205, v206, v207
ds_write_b64 v15, v[204:205] offset:6656
v_pk_fma_f32 v[208:209], v[36:37], v[60:61], v[208:209] op_sel_hi:[0,1,1] neg_lo:[1,0,0] neg_hi:[1,0,0]
v_pk_fma_f32 v[210:211], v[36:37], v[62:63], v[210:211] op_sel_hi:[0,1,1] neg_lo:[1,0,0] neg_hi:[1,0,0]
v_pk_mul_f32 v[172:173], v[36:37], v[172:173] op_sel:[1,0] op_sel_hi:[1,1]
v_pk_mul_f32 v[174:175], v[36:37], v[174:175] op_sel:[1,0] op_sel_hi:[1,1]
v_cvt_pk_bf16_f32 v136, v136, v137
v_cvt_pk_bf16_f32 v137, v138, v139
ds_write_b64 v15, v[136:137] offset:12800
v_pk_fma_f32 v[140:141], v[38:39], v[52:53], v[140:141] op_sel_hi:[0,1,1] neg_lo:[1,0,0] neg_hi:[1,0,0]
v_pk_fma_f32 v[142:143], v[38:39], v[54:55], v[142:143] op_sel_hi:[0,1,1] neg_lo:[1,0,0] neg_hi:[1,0,0]
v_pk_mul_f32 v[208:209], v[36:37], v[208:209] op_sel:[1,0] op_sel_hi:[1,1]
v_pk_mul_f32 v[210:211], v[36:37], v[210:211] op_sel:[1,0] op_sel_hi:[1,1]
v_cvt_pk_bf16_f32 v172, v172, v173
v_cvt_pk_bf16_f32 v173, v174, v175
ds_write_b64 v15, v[172:173] offset:12928
v_pk_fma_f32 v[176:177], v[38:39], v[56:57], v[176:177] op_sel_hi:[0,1,1] neg_lo:[1,0,0] neg_hi:[1,0,0]
v_pk_fma_f32 v[178:179], v[38:39], v[58:59], v[178:179] op_sel_hi:[0,1,1] neg_lo:[1,0,0] neg_hi:[1,0,0]
v_pk_mul_f32 v[140:141], v[38:39], v[140:141] op_sel:[1,0] op_sel_hi:[1,1]
v_pk_mul_f32 v[142:143], v[38:39], v[142:143] op_sel:[1,0] op_sel_hi:[1,1]
v_cvt_pk_bf16_f32 v208, v208, v209
v_cvt_pk_bf16_f32 v209, v210, v211
ds_write_b64 v15, v[208:209] offset:13056
v_pk_fma_f32 v[212:213], v[38:39], v[60:61], v[212:213] op_sel_hi:[0,1,1] neg_lo:[1,0,0] neg_hi:[1,0,0]
v_pk_fma_f32 v[214:215], v[38:39], v[62:63], v[214:215] op_sel_hi:[0,1,1] neg_lo:[1,0,0] neg_hi:[1,0,0]
v_pk_mul_f32 v[176:177], v[38:39], v[176:177] op_sel:[1,0] op_sel_hi:[1,1]
v_pk_mul_f32 v[178:179], v[38:39], v[178:179] op_sel:[1,0] op_sel_hi:[1,1]
v_cvt_pk_bf16_f32 v140, v140, v141
v_cvt_pk_bf16_f32 v141, v142, v143
ds_write_b64 v15, v[140:141] offset:19200
v_pk_fma_f32 v[144:145], v[40:41], v[52:53], v[144:145] op_sel_hi:[0,1,1] neg_lo:[1,0,0] neg_hi:[1,0,0]
v_pk_fma_f32 v[146:147], v[40:41], v[54:55], v[146:147] op_sel_hi:[0,1,1] neg_lo:[1,0,0] neg_hi:[1,0,0]
v_pk_mul_f32 v[212:213], v[38:39], v[212:213] op_sel:[1,0] op_sel_hi:[1,1]
v_pk_mul_f32 v[214:215], v[38:39], v[214:215] op_sel:[1,0] op_sel_hi:[1,1]
v_cvt_pk_bf16_f32 v176, v176, v177
v_cvt_pk_bf16_f32 v177, v178, v179
ds_write_b64 v15, v[176:177] offset:19328
v_pk_fma_f32 v[180:181], v[40:41], v[56:57], v[180:181] op_sel_hi:[0,1,1] neg_lo:[1,0,0] neg_hi:[1,0,0]
v_pk_fma_f32 v[182:183], v[40:41], v[58:59], v[182:183] op_sel_hi:[0,1,1] neg_lo:[1,0,0] neg_hi:[1,0,0]
v_pk_mul_f32 v[144:145], v[40:41], v[144:145] op_sel:[1,0] op_sel_hi:[1,1]
v_pk_mul_f32 v[146:147], v[40:41], v[146:147] op_sel:[1,0] op_sel_hi:[1,1]
v_cvt_pk_bf16_f32 v212, v212, v213
v_cvt_pk_bf16_f32 v213, v214, v215
ds_write_b64 v15, v[212:213] offset:19456
v_pk_fma_f32 v[216:217], v[40:41], v[60:61], v[216:217] op_sel_hi:[0,1,1] neg_lo:[1,0,0] neg_hi:[1,0,0]
v_pk_fma_f32 v[218:219], v[40:41], v[62:63], v[218:219] op_sel_hi:[0,1,1] neg_lo:[1,0,0] neg_hi:[1,0,0]
v_pk_mul_f32 v[180:181], v[40:41], v[180:181] op_sel:[1,0] op_sel_hi:[1,1]
v_pk_mul_f32 v[182:183], v[40:41], v[182:183] op_sel:[1,0] op_sel_hi:[1,1]
v_cvt_pk_bf16_f32 v144, v144, v145
v_cvt_pk_bf16_f32 v145, v146, v147
ds_write_b64 v15, v[144:145] offset:25600
v_pk_fma_f32 v[148:149], v[42:43], v[52:53], v[148:149] op_sel_hi:[0,1,1] neg_lo:[1,0,0] neg_hi:[1,0,0]
v_pk_fma_f32 v[150:151], v[42:43], v[54:55], v[150:151] op_sel_hi:[0,1,1] neg_lo:[1,0,0] neg_hi:[1,0,0]
v_pk_mul_f32 v[216:217], v[40:41], v[216:217] op_sel:[1,0] op_sel_hi:[1,1]
v_pk_mul_f32 v[218:219], v[40:41], v[218:219] op_sel:[1,0] op_sel_hi:[1,1]
v_cvt_pk_bf16_f32 v180, v180, v181
v_cvt_pk_bf16_f32 v181, v182, v183
ds_write_b64 v15, v[180:181] offset:25728
v_pk_fma_f32 v[184:185], v[42:43], v[56:57], v[184:185] op_sel_hi:[0,1,1] neg_lo:[1,0,0] neg_hi:[1,0,0]
v_pk_fma_f32 v[186:187], v[42:43], v[58:59], v[186:187] op_sel_hi:[0,1,1] neg_lo:[1,0,0] neg_hi:[1,0,0]
v_pk_mul_f32 v[148:149], v[42:43], v[148:149] op_sel:[1,0] op_sel_hi:[1,1]
v_pk_mul_f32 v[150:151], v[42:43], v[150:151] op_sel:[1,0] op_sel_hi:[1,1]
v_cvt_pk_bf16_f32 v216, v216, v217
v_cvt_pk_bf16_f32 v217, v218, v219
ds_write_b64 v15, v[216:217] offset:25856
v_pk_fma_f32 v[220:221], v[42:43], v[60:61], v[220:221] op_sel_hi:[0,1,1] neg_lo:[1,0,0] neg_hi:[1,0,0]
v_pk_fma_f32 v[222:223], v[42:43], v[62:63], v[222:223] op_sel_hi:[0,1,1] neg_lo:[1,0,0] neg_hi:[1,0,0]
v_pk_mul_f32 v[184:185], v[42:43], v[184:185] op_sel:[1,0] op_sel_hi:[1,1]
v_pk_mul_f32 v[186:187], v[42:43], v[186:187] op_sel:[1,0] op_sel_hi:[1,1]
v_cvt_pk_bf16_f32 v148, v148, v149
v_cvt_pk_bf16_f32 v149, v150, v151
ds_write_b64 v15, v[148:149] offset:32000
v_pk_fma_f32 v[152:153], v[44:45], v[52:53], v[152:153] op_sel_hi:[0,1,1] neg_lo:[1,0,0] neg_hi:[1,0,0]
v_pk_fma_f32 v[154:155], v[44:45], v[54:55], v[154:155] op_sel_hi:[0,1,1] neg_lo:[1,0,0] neg_hi:[1,0,0]
v_pk_mul_f32 v[220:221], v[42:43], v[220:221] op_sel:[1,0] op_sel_hi:[1,1]
v_pk_mul_f32 v[222:223], v[42:43], v[222:223] op_sel:[1,0] op_sel_hi:[1,1]
v_cvt_pk_bf16_f32 v184, v184, v185
v_cvt_pk_bf16_f32 v185, v186, v187
ds_write_b64 v15, v[184:185] offset:32128
v_pk_fma_f32 v[188:189], v[44:45], v[56:57], v[188:189] op_sel_hi:[0,1,1] neg_lo:[1,0,0] neg_hi:[1,0,0]
v_pk_fma_f32 v[190:191], v[44:45], v[58:59], v[190:191] op_sel_hi:[0,1,1] neg_lo:[1,0,0] neg_hi:[1,0,0]
v_pk_mul_f32 v[152:153], v[44:45], v[152:153] op_sel:[1,0] op_sel_hi:[1,1]
v_pk_mul_f32 v[154:155], v[44:45], v[154:155] op_sel:[1,0] op_sel_hi:[1,1]
v_cvt_pk_bf16_f32 v220, v220, v221
v_cvt_pk_bf16_f32 v221, v222, v223
ds_write_b64 v15, v[220:221] offset:32256
v_pk_fma_f32 v[224:225], v[44:45], v[60:61], v[224:225] op_sel_hi:[0,1,1] neg_lo:[1,0,0] neg_hi:[1,0,0]
v_pk_fma_f32 v[226:227], v[44:45], v[62:63], v[226:227] op_sel_hi:[0,1,1] neg_lo:[1,0,0] neg_hi:[1,0,0]
v_pk_mul_f32 v[188:189], v[44:45], v[188:189] op_sel:[1,0] op_sel_hi:[1,1]
v_pk_mul_f32 v[190:191], v[44:45], v[190:191] op_sel:[1,0] op_sel_hi:[1,1]
v_cvt_pk_bf16_f32 v152, v152, v153
v_cvt_pk_bf16_f32 v153, v154, v155
ds_write_b64 v15, v[152:153] offset:38400
v_pk_fma_f32 v[156:157], v[46:47], v[52:53], v[156:157] op_sel_hi:[0,1,1] neg_lo:[1,0,0] neg_hi:[1,0,0]
v_pk_fma_f32 v[158:159], v[46:47], v[54:55], v[158:159] op_sel_hi:[0,1,1] neg_lo:[1,0,0] neg_hi:[1,0,0]
v_pk_mul_f32 v[224:225], v[44:45], v[224:225] op_sel:[1,0] op_sel_hi:[1,1]
v_pk_mul_f32 v[226:227], v[44:45], v[226:227] op_sel:[1,0] op_sel_hi:[1,1]
v_cvt_pk_bf16_f32 v188, v188, v189
v_cvt_pk_bf16_f32 v189, v190, v191
ds_write_b64 v15, v[188:189] offset:38528
v_pk_fma_f32 v[192:193], v[46:47], v[56:57], v[192:193] op_sel_hi:[0,1,1] neg_lo:[1,0,0] neg_hi:[1,0,0]
v_pk_fma_f32 v[194:195], v[46:47], v[58:59], v[194:195] op_sel_hi:[0,1,1] neg_lo:[1,0,0] neg_hi:[1,0,0]
v_pk_mul_f32 v[156:157], v[46:47], v[156:157] op_sel:[1,0] op_sel_hi:[1,1]
v_pk_mul_f32 v[158:159], v[46:47], v[158:159] op_sel:[1,0] op_sel_hi:[1,1]
v_cvt_pk_bf16_f32 v224, v224, v225
v_cvt_pk_bf16_f32 v225, v226, v227
ds_write_b64 v15, v[224:225] offset:38656
v_pk_fma_f32 v[228:229], v[46:47], v[60:61], v[228:229] op_sel_hi:[0,1,1] neg_lo:[1,0,0] neg_hi:[1,0,0]
v_pk_fma_f32 v[230:231], v[46:47], v[62:63], v[230:231] op_sel_hi:[0,1,1] neg_lo:[1,0,0] neg_hi:[1,0,0]
v_pk_mul_f32 v[192:193], v[46:47], v[192:193] op_sel:[1,0] op_sel_hi:[1,1]
v_pk_mul_f32 v[194:195], v[46:47], v[194:195] op_sel:[1,0] op_sel_hi:[1,1]
v_cvt_pk_bf16_f32 v156, v156, v157
v_cvt_pk_bf16_f32 v157, v158, v159
ds_write_b64 v15, v[156:157] offset:44800
v_pk_fma_f32 v[160:161], v[48:49], v[52:53], v[160:161] op_sel_hi:[0,1,1] neg_lo:[1,0,0] neg_hi:[1,0,0]
v_pk_fma_f32 v[162:163], v[48:49], v[54:55], v[162:163] op_sel_hi:[0,1,1] neg_lo:[1,0,0] neg_hi:[1,0,0]
v_pk_mul_f32 v[228:229], v[46:47], v[228:229] op_sel:[1,0] op_sel_hi:[1,1]
v_pk_mul_f32 v[230:231], v[46:47], v[230:231] op_sel:[1,0] op_sel_hi:[1,1]
v_cvt_pk_bf16_f32 v192, v192, v193
v_cvt_pk_bf16_f32 v193, v194, v195
ds_write_b64 v15, v[192:193] offset:44928
v_pk_fma_f32 v[196:197], v[48:49], v[56:57], v[196:197] op_sel_hi:[0,1,1] neg_lo:[1,0,0] neg_hi:[1,0,0]
v_pk_fma_f32 v[198:199], v[48:49], v[58:59], v[198:199] op_sel_hi:[0,1,1] neg_lo:[1,0,0] neg_hi:[1,0,0]
v_pk_mul_f32 v[160:161], v[48:49], v[160:161] op_sel:[1,0] op_sel_hi:[1,1]
v_pk_mul_f32 v[162:163], v[48:49], v[162:163] op_sel:[1,0] op_sel_hi:[1,1]
v_cvt_pk_bf16_f32 v228, v228, v229
v_cvt_pk_bf16_f32 v229, v230, v231
ds_write_b64 v15, v[228:229] offset:45056
v_pk_fma_f32 v[232:233], v[48:49], v[60:61], v[232:233] op_sel_hi:[0,1,1] neg_lo:[1,0,0] neg_hi:[1,0,0]
v_pk_fma_f32 v[234:235], v[48:49], v[62:63], v[234:235] op_sel_hi:[0,1,1] neg_lo:[1,0,0] neg_hi:[1,0,0]
v_pk_mul_f32 v[196:197], v[48:49], v[196:197] op_sel:[1,0] op_sel_hi:[1,1]
v_pk_mul_f32 v[198:199], v[48:49], v[198:199] op_sel:[1,0] op_sel_hi:[1,1]
v_cvt_pk_bf16_f32 v160, v160, v161
v_cvt_pk_bf16_f32 v161, v162, v163
ds_write_b64 v15, v[160:161] offset:51200
v_pk_mul_f32 v[232:233], v[48:49], v[232:233] op_sel:[1,0] op_sel_hi:[1,1]
v_pk_mul_f32 v[234:235], v[48:49], v[234:235] op_sel:[1,0] op_sel_hi:[1,1]
v_cvt_pk_bf16_f32 v196, v196, v197
v_cvt_pk_bf16_f32 v197, v198, v199
ds_write_b64 v15, v[196:197] offset:51328
v_cvt_pk_bf16_f32 v232, v232, v233
v_cvt_pk_bf16_f32 v233, v234, v235
ds_write_b64 v15, v[232:233] offset:51456
s_waitcnt lgkmcnt(0)
s_branch Latt_5
Lpf_4:
s_lshl_b32 s43, s35, 7
s_waitcnt lgkmcnt(0)
s_mov_b32 s8, s64
s_mov_b32 s9, s65
s_mov_b32 s10, 4194304
s_mov_b32 s11, 0x20000
s_add_u32 s12, s66, s43
s_addc_u32 s13, s67, 0
s_mov_b32 s14, 6289536
s_mov_b32 s15, 0x20000
s_add_u32 s84, s82, 28311552
s_addc_u32 s85, s83, 0
s_branch Lov_3
.p2align 12
.fill 16, 4, 0xbf800000
Lst_3_0:
s_branch Lwr_163
s_nop 0
s_nop 0
Lov_3:
s_mov_b32 s86, 114688
s_mov_b32 s87, 0x20000
s_mov_b32 s56, s80
s_mov_b32 s57, s81
s_mov_b32 s58, 256
s_mov_b32 s59, 0x20000
v_mov_b32 v5, 0
v_lshlrev_b32 v14, 7, v1
s_or_b32 s43, s34, s35
s_cmp_lg_u32 s43, 0
s_cbranch_scc1 Lz_32
s_movk_i32 s43, 0x2000
buffer_store_dword v5, v14, s[84:87], 0 offen sc1
s_bfm_b64 exec, 60, 0
buffer_store_dword v5, v14, s[84:87], s43 offen sc1
s_mov_b64 exec, 1
v_mov_b32 v6, 1
s_waitcnt vmcnt(0)
buffer_store_dword v6, v5, s[56:59], 0 offen sc1
s_mov_b64 exec, -1
Lz_32:
s_lshl_b32 s43, s51, 11
buffer_load_dwordx4 v[96:99], v10, s[8:11], s43 offen offset:0
buffer_load_dwordx4 v[100:103], v10, s[8:11], s43 offen offset:1024
buffer_load_dwordx4 v[104:107], v10, s[8:11], s43 offen offset:2048
buffer_load_dwordx4 v[108:111], v10, s[8:11], s43 offen offset:3072
v_min_u32 v14, 23, v1
v_lshrrev_b32 v15, 3, v14
v_mul_u32_u24 v15, 43008, v15
v_and_b32 v14, 7, v14
v_lshl_add_u32 v15, v14, 4, v15
v_mov_b32 v32, 0x3f803f80
v_mov_b32 v33, 0x3f803f80
v_mov_b32 v34, 0x3f803f80
v_mov_b32 v35, 0x3f803f80
ds_write_b128 v15, v[32:35]
s_add_u32 s20, s82, 26214400
s_addc_u32 s21, s83, 0
s_mov_b32 s22, 16384
s_mov_b32 s23, 0x20000
s_add_u32 s43, s2, 128
s_lshl_b32 s43, s43, 7
v_lshlrev_b32 v14, 2, v1
s_mov_b64 exec, 15
buffer_store_dword v5, v14, s[84:87], s43 offen sc1
s_mov_b64 exec, -1
s_lshl_b32 s43, s34, 4
s_add_u32 s43, s43, s35
s_lshl_b32 s43, s43, 8
s_add_u32 s43, s43, 49152
v_lshlrev_b32 v14, 7, v1
s_mov_b64 exec, 3
buffer_store_dword v5, v14, s[84:87], s43 offen sc1
s_mov_b64 exec, -1
s_lshl_b32 s52, s34, 7
s_add_u32 s52, s52, 28319744
s_sub_u32 s53, s52, 128
s_cmp_eq_u32 s34, 0
s_cselect_b32 s53, s52, s53
s_waitcnt lgkmcnt(0)
s_barrier
s_waitcnt vmcnt(2)
s_mov_b32 s43, 0x3f803f80
v_mov_b32 v116, 0
v_mov_b32 v117, 0
v_mov_b32 v118, 0
v_mov_b32 v119, 0
v_mov_b32 v120, 0
v_mov_b32 v121, 0
v_mov_b32 v122, 0
v_mov_b32 v123, 0
v_dot2_f32_bf16 v116, v96, s43, v116
v_dot2_f32_bf16 v120, v96, v96, v120
v_dot2_f32_bf16 v118, v104, s43, v118
v_dot2_f32_bf16 v122, v104, v104, v122
v_dot2_f32_bf16 v117, v97, s43, v117
v_dot2_f32_bf16 v121, v97, v97, v121
v_dot2_f32_bf16 v119, v105, s43, v119
v_dot2_f32_bf16 v123, v105, v105, v123
v_dot2_f32_bf16 v116, v98, s43, v116
v_dot2_f32_bf16 v120, v98, v98, v120
v_dot2_f32_bf16 v118, v106, s43, v118
v_dot2_f32_bf16 v122, v106, v106, v122
v_dot2_f32_bf16 v117, v99, s43, v117
v_dot2_f32_bf16 v121, v99, v99, v121
v_dot2_f32_bf16 v119, v107, s43, v119
v_dot2_f32_bf16 v123, v107, v107, v123
v_dot2_f32_bf16 v116, v100, s43, v116
v_dot2_f32_bf16 v120, v100, v100, v120
v_dot2_f32_bf16 v118, v108, s43, v118
v_dot2_f32_bf16 v122, v108, v108, v122
v_dot2_f32_bf16 v117, v101, s43, v117
v_dot2_f32_bf16 v121, v101, v101, v121
v_dot2_f32_bf16 v119, v109, s43, v119
v_dot2_f32_bf16 v123, v109, v109, v123
v_dot2_f32_bf16 v116, v102, s43, v116
v_dot2_f32_bf16 v120, v102, v102, v120
v_dot2_f32_bf16 v118, v110, s43, v118
v_dot2_f32_bf16 v122, v110, v110, v122
v_dot2_f32_bf16 v117, v103, s43, v117
v_dot2_f32_bf16 v121, v103, v103, v121
v_dot2_f32_bf16 v119, v111, s43, v119
v_dot2_f32_bf16 v123, v111, v111, v123
s_nop 2
v_add_f32 v116, v116, v117
v_add_f32 v118, v118, v119
v_add_f32 v120, v120, v121
v_add_f32 v122, v122, v123
s_nop 1
v_permlane32_swap_b32 v116, v118
v_permlane32_swap_b32 v120, v122
v_add_f32 v116, v116, v118
v_add_f32 v120, v120, v122
s_nop 1
v_permlane16_swap_b32 v116, v120
v_add_f32 v116, v116, v120
s_nop 1
v_add_f32_dpp v116, v116, v116 row_ror:8 row_mask:0xf bank_mask:0xf
s_nop 1
v_add_f32_dpp v116, v116, v116 row_ror:4 row_mask:0xf bank_mask:0xf
s_nop 1
v_add_f32_dpp v116, v116, v116 row_ror:2 row_mask:0xf bank_mask:0xf
s_nop 1
v_add_f32_dpp v116, v116, v116 row_ror:1 row_mask:0xf bank_mask:0xf
v_mov_b32 v117, v116
s_nop 1
v_permlane16_swap_b32 v116, v117
v_mul_f32 v112, 0x3a800000, v116
v_mul_f32 v113, 0x3a800000, v117
v_fma_f32 v113, -v112, v112, v113
v_max_f32 v113, 0, v113
v_add_f32 v113, 0x3727c5ac, v113
v_rsq_f32 v113, v113
v_lshrrev_b32 v11, 5, v1
s_lshl_b32 s43, s47, 4
s_add_u32 s43, s43, 148608
v_lshl_add_u32 v11, v11, 3, s43
ds_write_b64 v11, v[112:113]
s_waitcnt lgkmcnt(0)
s_mov_b32 s28, s66
s_mov_b32 s29, s67
s_mov_b32 s30, 6291456
s_mov_b32 s31, 0x20000
s_mul_i32 s43, s33, 8832
s_add_u32 s43, s43, 1572864
v_lshlrev_b32 v30, 7, v1
buffer_load_dword v31, v30, s[28:31], s43 offen
s_add_u32 s43, s43, 8192
s_bfm_b64 exec, 5, 0
buffer_load_dword v31, v30, s[28:31], s43 offen
s_mov_b64 exec, -1
s_branch Lst_0_0
Lwr_160:
s_barrier
v_lshlrev_b32 v5, 4, v1
v_and_b32 v5, 63, v5
v_add_u32 v6, 148608, v5
ds_read_b128 v[112:115], v6
s_lshl_b32 s43, s63, 3
v_add_u32 v5, s43, v5
s_waitcnt lgkmcnt(0)
s_mov_b64 exec, 15
buffer_store_dwordx4 v[112:115], v5, s[20:23], 0 offen sc1
s_mov_b64 exec, -1
v_mov_b32 v4, 0
buffer_load_dword v6, v4, s[56:59], 0 offen sc1
s_mov_b32 s62, 0
s_mov_b32 s28, s66
s_mov_b32 s29, s67
s_mov_b32 s30, 6291456
s_mov_b32 s31, 0x20000
s_mul_i32 s43, s33, 12288
s_add_u32 s43, s43, 3538944
v_lshlrev_b32 v30, 7, v1
buffer_load_dword v31, v30, s[28:31], s43 offen
s_add_u32 s43, s43, 8192
s_bfm_b64 exec, 32, 0
buffer_load_dword v31, v30, s[28:31], s43 offen
s_mov_b64 exec, -1
s_branch Lst_1_0
Lwr_161:
s_barrier
s_lshl_b32 s43, s35, 7
s_add_u32 s28, s68, s43
s_addc_u32 s29, s69, 0
s_mov_b32 s30, 2095232
s_mov_b32 s31, 0x20000
v_and_b32 v29, 7, v1
v_lshrrev_b32 v30, 3, v1
v_lshl_add_u32 v29, v30, 6, v29
s_lshl_b32 s43, s48, 3
v_add_u32 v29, s43, v29
v_lshlrev_b32 v29, 11, v29
s_mov_b32 s43, 1048576
s_mov_b32 s28, s68
s_mov_b32 s29, s69
s_mov_b32 s30, 2097152
s_mov_b32 s31, 0x20000
s_mul_i32 s43, s33, 9472
v_lshlrev_b32 v30, 7, v1
buffer_load_dword v31, v30, s[28:31], s43 offen
s_add_u32 s43, s43, 8192
s_bfm_b64 exec, 10, 0
buffer_load_dword v31, v30, s[28:31], s43 offen
s_mov_b64 exec, -1
s_branch Lst_2_0
Lwr_162:
s_barrier
s_branch Lst_3_0
Lwr_163:
s_barrier
s_branch Lst_4_0
Lwr_164:
s_barrier
s_branch Lst_5_0
Lwr_165:
s_barrier
s_cmp_eq_u32 s62, 3
s_cbranch_scc1 Lste_36
s_cmp_eq_u32 s62, 2
s_cbranch_scc1 Lst2_34
s_cmp_ge_u32 s62, 4
s_cbranch_scc1 Lst4_35
s_cmp_eq_u32 s62, 1
s_cbranch_scc1 Lst1_33
s_waitcnt vmcnt(4)
v_readfirstlane_b32 s54, v6
s_cmp_eq_u32 s54, 0
s_cbranch_scc0 Lrep_37
buffer_load_dword v6, v4, s[56:59], 0 offen sc1
s_branch Lste_36
Lrep_37:
s_add_u32 s7, s34, 64
s_lshl_b32 s7, s7, 7
v_mov_b32 v5, s7
v_mov_b32 v6, 1
s_mov_b64 exec, 1
buffer_atomic_add v6, v5, s[84:87], 0 offen sc1
s_mov_b64 exec, -1
s_mov_b32 s62, 1
s_mov_b32 s54, 0
s_mov_b32 s55, 0
s_branch Lste_36
Lst1_33:
s_and_b32 s43, s54, s55
s_cmp_eq_u32 s43, 16
s_cbranch_scc1 Lg_38
s_load_dword s54, s[82:83], s52 glc
s_load_dword s55, s[82:83], s53 glc
s_branch Lste_36
Lg_38:
v_add_u32 v5, 0, v1
v_min_u32 v5, 143, v5
v_lshlrev_b32 v20, 3, v5
v_add_u32 v5, s50, v5
v_max_i32 v5, 0, v5
v_lshlrev_b32 v5, 3, v5
buffer_load_dwordx2 v[32:33], v5, s[20:23], 0 offen sc1
v_add_u32 v5, 64, v1
v_min_u32 v5, 143, v5
v_lshlrev_b32 v21, 3, v5
v_add_u32 v5, s50, v5
v_max_i32 v5, 0, v5
v_lshlrev_b32 v5, 3, v5
buffer_load_dwordx2 v[34:35], v5, s[20:23], 0 offen sc1
v_add_u32 v5, 128, v1
v_min_u32 v5, 143, v5
v_lshlrev_b32 v22, 3, v5
v_add_u32 v5, s50, v5
v_max_i32 v5, 0, v5
v_lshlrev_b32 v5, 3, v5
buffer_load_dwordx2 v[36:37], v5, s[20:23], 0 offen sc1
s_mov_b32 s62, 4
s_branch Lste_36
Lst4_35:
s_mov_b32 s62, 2
s_branch Lste_36
Lst2_34:
s_waitcnt vmcnt(0)
v_add_u32 v20, 147456, v20
ds_write_b64 v20, v[32:33]
v_add_u32 v21, 147456, v21
ds_write_b64 v21, v[34:35]
v_add_u32 v22, 147456, v22
ds_write_b64 v22, v[36:37]
s_waitcnt lgkmcnt(0)
s_mov_b32 s62, 3
Lste_36:
s_branch Lst_6_0
Lwr_166:
s_barrier
s_cmp_eq_u32 s62, 3
s_cbranch_scc1 Lste_42
s_cmp_eq_u32 s62, 2
s_cbranch_scc1 Lst2_40
s_cmp_ge_u32 s62, 4
s_cbranch_scc1 Lst4_41
s_cmp_eq_u32 s62, 1
s_cbranch_scc1 Lst1_39
s_waitcnt vmcnt(0)
v_readfirstlane_b32 s54, v6
s_cmp_eq_u32 s54, 0
s_cbranch_scc0 Lrep_43
buffer_load_dword v6, v4, s[56:59], 0 offen sc1
s_branch Lste_42
Lrep_43:
s_add_u32 s7, s34, 64
s_lshl_b32 s7, s7, 7
v_mov_b32 v5, s7
v_mov_b32 v6, 1
s_mov_b64 exec, 1
buffer_atomic_add v6, v5, s[84:87], 0 offen sc1
s_mov_b64 exec, -1
s_mov_b32 s62, 1
s_mov_b32 s54, 0
s_mov_b32 s55, 0
s_branch Lste_42
Lst1_39:
s_and_b32 s43, s54, s55
s_cmp_eq_u32 s43, 16
s_cbranch_scc1 Lg_44
s_load_dword s54, s[82:83], s52 glc
s_load_dword s55, s[82:83], s53 glc
s_branch Lste_42
Lg_44:
v_add_u32 v5, 0, v1
v_min_u32 v5, 143, v5
v_lshlrev_b32 v20, 3, v5
v_add_u32 v5, s50, v5
v_max_i32 v5, 0, v5
v_lshlrev_b32 v5, 3, v5
buffer_load_dwordx2 v[32:33], v5, s[20:23], 0 offen sc1
v_add_u32 v5, 64, v1
v_min_u32 v5, 143, v5
v_lshlrev_b32 v21, 3, v5
v_add_u32 v5, s50, v5
v_max_i32 v5, 0, v5
v_lshlrev_b32 v5, 3, v5
buffer_load_dwordx2 v[34:35], v5, s[20:23], 0 offen sc1
v_add_u32 v5, 128, v1
v_min_u32 v5, 143, v5
v_lshlrev_b32 v22, 3, v5
v_add_u32 v5, s50, v5
v_max_i32 v5, 0, v5
v_lshlrev_b32 v5, 3, v5
buffer_load_dwordx2 v[36:37], v5, s[20:23], 0 offen sc1
s_mov_b32 s62, 4
s_branch Lste_42
Lst4_41:
s_mov_b32 s62, 2
s_branch Lste_42
Lst2_40:
s_waitcnt vmcnt(0)
v_add_u32 v20, 147456, v20
ds_write_b64 v20, v[32:33]
v_add_u32 v21, 147456, v21
ds_write_b64 v21, v[34:35]
v_add_u32 v22, 147456, v22
ds_write_b64 v22, v[36:37]
s_waitcnt lgkmcnt(0)
s_mov_b32 s62, 3
Lste_42:
s_branch Lst_7_0
Lwr_167:
s_barrier
s_cmp_eq_u32 s62, 3
s_cbranch_scc1 Lste_48
s_cmp_eq_u32 s62, 2
s_cbranch_scc1 Lst2_46
s_cmp_ge_u32 s62, 4
s_cbranch_scc1 Lst4_47
s_cmp_eq_u32 s62, 1
s_cbranch_scc1 Lst1_45
s_waitcnt vmcnt(0)
v_readfirstlane_b32 s54, v6
s_cmp_eq_u32 s54, 0
s_cbranch_scc0 Lrep_49
buffer_load_dword v6, v4, s[56:59], 0 offen sc1
s_branch Lste_48
Lrep_49:
s_add_u32 s7, s34, 64
s_lshl_b32 s7, s7, 7
v_mov_b32 v5, s7
v_mov_b32 v6, 1
s_mov_b64 exec, 1
buffer_atomic_add v6, v5, s[84:87], 0 offen sc1
s_mov_b64 exec, -1
s_mov_b32 s62, 1
s_mov_b32 s54, 0
s_mov_b32 s55, 0
s_branch Lste_48
Lst1_45:
s_and_b32 s43, s54, s55
s_cmp_eq_u32 s43, 16
s_cbranch_scc1 Lg_50
s_load_dword s54, s[82:83], s52 glc
s_load_dword s55, s[82:83], s53 glc
s_branch Lste_48
Lg_50:
v_add_u32 v5, 0, v1
v_min_u32 v5, 143, v5
v_lshlrev_b32 v20, 3, v5
v_add_u32 v5, s50, v5
v_max_i32 v5, 0, v5
v_lshlrev_b32 v5, 3, v5
buffer_load_dwordx2 v[32:33], v5, s[20:23], 0 offen sc1
v_add_u32 v5, 64, v1
v_min_u32 v5, 143, v5
v_lshlrev_b32 v21, 3, v5
v_add_u32 v5, s50, v5
v_max_i32 v5, 0, v5
v_lshlrev_b32 v5, 3, v5
buffer_load_dwordx2 v[34:35], v5, s[20:23], 0 offen sc1
v_add_u32 v5, 128, v1
v_min_u32 v5, 143, v5
v_lshlrev_b32 v22, 3, v5
v_add_u32 v5, s50, v5
v_max_i32 v5, 0, v5
v_lshlrev_b32 v5, 3, v5
buffer_load_dwordx2 v[36:37], v5, s[20:23], 0 offen sc1
s_mov_b32 s62, 4
s_branch Lste_48
Lst4_47:
s_mov_b32 s62, 2
s_branch Lste_48
Lst2_46:
s_waitcnt vmcnt(0)
v_add_u32 v20, 147456, v20
ds_write_b64 v20, v[32:33]
v_add_u32 v21, 147456, v21
ds_write_b64 v21, v[34:35]
v_add_u32 v22, 147456, v22
ds_write_b64 v22, v[36:37]
s_waitcnt lgkmcnt(0)
s_mov_b32 s62, 3
Lste_48:
s_branch Lst_8_0
Lwr_168:
s_barrier
s_cmp_eq_u32 s62, 3
s_cbranch_scc1 Lste_54
s_cmp_eq_u32 s62, 2
s_cbranch_scc1 Lst2_52
s_cmp_ge_u32 s62, 4
s_cbranch_scc1 Lst4_53
s_cmp_eq_u32 s62, 1
s_cbranch_scc1 Lst1_51
s_waitcnt vmcnt(0)
v_readfirstlane_b32 s54, v6
s_cmp_eq_u32 s54, 0
s_cbranch_scc0 Lrep_55
buffer_load_dword v6, v4, s[56:59], 0 offen sc1
s_branch Lste_54
Lrep_55:
s_add_u32 s7, s34, 64
s_lshl_b32 s7, s7, 7
v_mov_b32 v5, s7
v_mov_b32 v6, 1
s_mov_b64 exec, 1
buffer_atomic_add v6, v5, s[84:87], 0 offen sc1
s_mov_b64 exec, -1
s_mov_b32 s62, 1
s_mov_b32 s54, 0
s_mov_b32 s55, 0
s_branch Lste_54
Lst1_51:
s_and_b32 s43, s54, s55
s_cmp_eq_u32 s43, 16
s_cbranch_scc1 Lg_56
s_load_dword s54, s[82:83], s52 glc
s_load_dword s55, s[82:83], s53 glc
s_branch Lste_54
Lg_56:
v_add_u32 v5, 0, v1
v_min_u32 v5, 143, v5
v_lshlrev_b32 v20, 3, v5
v_add_u32 v5, s50, v5
v_max_i32 v5, 0, v5
v_lshlrev_b32 v5, 3, v5
buffer_load_dwordx2 v[32:33], v5, s[20:23], 0 offen sc1
v_add_u32 v5, 64, v1
v_min_u32 v5, 143, v5
v_lshlrev_b32 v21, 3, v5
v_add_u32 v5, s50, v5
v_max_i32 v5, 0, v5
v_lshlrev_b32 v5, 3, v5
buffer_load_dwordx2 v[34:35], v5, s[20:23], 0 offen sc1
v_add_u32 v5, 128, v1
v_min_u32 v5, 143, v5
v_lshlrev_b32 v22, 3, v5
v_add_u32 v5, s50, v5
v_max_i32 v5, 0, v5
v_lshlrev_b32 v5, 3, v5
buffer_load_dwordx2 v[36:37], v5, s[20:23], 0 offen sc1
s_mov_b32 s62, 4
s_branch Lste_54
Lst4_53:
s_mov_b32 s62, 2
s_branch Lste_54
Lst2_52:
s_waitcnt vmcnt(0)
v_add_u32 v20, 147456, v20
ds_write_b64 v20, v[32:33]
v_add_u32 v21, 147456, v21
ds_write_b64 v21, v[34:35]
v_add_u32 v22, 147456, v22
ds_write_b64 v22, v[36:37]
s_waitcnt lgkmcnt(0)
s_mov_b32 s62, 3
Lste_54:
s_branch Lst_9_0
Lwr_169:
s_barrier
s_getpc_b64 s[100:101]
s_and_b32 s100, s100, 0xfffff000
s_sub_u32 s100, s100, 1064960
s_subb_u32 s101, s101, 0
s_lshr_b32 s6, s2, 3
s_mul_i32 s6, s6, 1
s_and_b32 s7, s36, 0
s_add_u32 s6, s6, s7
s_mulk_i32 s6, 640
s_add_u32 s6, s6, 1063168
s_load_dword s3, s[100:101], s6 offset:0
s_load_dword s3, s[100:101], s6 offset:64
s_load_dword s3, s[100:101], s6 offset:128
s_load_dword s3, s[100:101], s6 offset:192
s_load_dword s3, s[100:101], s6 offset:256
s_load_dword s3, s[100:101], s6 offset:320
s_load_dword s3, s[100:101], s6 offset:384
s_load_dword s3, s[100:101], s6 offset:448
s_load_dword s3, s[100:101], s6 offset:512
s_load_dword s3, s[100:101], s6 offset:576
s_nop 0
s_nop 0
s_nop 0
s_nop 0
s_nop 0
s_nop 0
s_nop 0
s_nop 0
s_nop 0
s_nop 0
s_cmp_eq_u32 s62, 3
s_cbranch_scc1 Lste_60
s_cmp_eq_u32 s62, 2
s_cbranch_scc1 Lst2_58
s_cmp_ge_u32 s62, 4
s_cbranch_scc1 Lst4_59
s_cmp_eq_u32 s62, 1
s_cbranch_scc1 Lst1_57
s_waitcnt vmcnt(0)
v_readfirstlane_b32 s54, v6
s_cmp_eq_u32 s54, 0
s_cbranch_scc0 Lrep_61
buffer_load_dword v6, v4, s[56:59], 0 offen sc1
s_branch Lste_60
Lrep_61:
s_add_u32 s7, s34, 64
s_lshl_b32 s7, s7, 7
v_mov_b32 v5, s7
v_mov_b32 v6, 1
s_mov_b64 exec, 1
buffer_atomic_add v6, v5, s[84:87], 0 offen sc1
s_mov_b64 exec, -1
s_mov_b32 s62, 1
s_mov_b32 s54, 0
s_mov_b32 s55, 0
s_branch Lste_60
Lst1_57:
s_and_b32 s43, s54, s55
s_cmp_eq_u32 s43, 16
s_cbranch_scc1 Lg_62
s_load_dword s54, s[82:83], s52 glc
s_load_dword s55, s[82:83], s53 glc
s_branch Lste_60
Lg_62:
v_add_u32 v5, 0, v1
v_min_u32 v5, 143, v5
v_lshlrev_b32 v20, 3, v5
v_add_u32 v5, s50, v5
v_max_i32 v5, 0, v5
v_lshlrev_b32 v5, 3, v5
buffer_load_dwordx2 v[32:33], v5, s[20:23], 0 offen sc1
v_add_u32 v5, 64, v1
v_min_u32 v5, 143, v5
v_lshlrev_b32 v21, 3, v5
v_add_u32 v5, s50, v5
v_max_i32 v5, 0, v5
v_lshlrev_b32 v5, 3, v5
buffer_load_dwordx2 v[34:35], v5, s[20:23], 0 offen sc1
v_add_u32 v5, 128, v1
v_min_u32 v5, 143, v5
v_lshlrev_b32 v22, 3, v5
v_add_u32 v5, s50, v5
v_max_i32 v5, 0, v5
v_lshlrev_b32 v5, 3, v5
buffer_load_dwordx2 v[36:37], v5, s[20:23], 0 offen sc1
s_mov_b32 s62, 4
s_branch Lste_60
Lst4_59:
s_mov_b32 s62, 2
s_branch Lste_60
Lst2_58:
s_waitcnt vmcnt(0)
v_add_u32 v20, 147456, v20
ds_write_b64 v20, v[32:33]
v_add_u32 v21, 147456, v21
ds_write_b64 v21, v[34:35]
v_add_u32 v22, 147456, v22
ds_write_b64 v22, v[36:37]
s_waitcnt lgkmcnt(0)
s_mov_b32 s62, 3
Lste_60:
s_branch Lst_10_0
Lwr_170:
s_barrier
s_cmp_eq_u32 s62, 3
s_cbranch_scc1 Lste_66
s_cmp_eq_u32 s62, 2
s_cbranch_scc1 Lst2_64
s_cmp_ge_u32 s62, 4
s_cbranch_scc1 Lst4_65
s_cmp_eq_u32 s62, 1
s_cbranch_scc1 Lst1_63
s_waitcnt vmcnt(0)
v_readfirstlane_b32 s54, v6
s_cmp_eq_u32 s54, 0
s_cbranch_scc0 Lrep_67
buffer_load_dword v6, v4, s[56:59], 0 offen sc1
s_branch Lste_66
Lrep_67:
s_add_u32 s7, s34, 64
s_lshl_b32 s7, s7, 7
v_mov_b32 v5, s7
v_mov_b32 v6, 1
s_mov_b64 exec, 1
buffer_atomic_add v6, v5, s[84:87], 0 offen sc1
s_mov_b64 exec, -1
s_mov_b32 s62, 1
s_mov_b32 s54, 0
s_mov_b32 s55, 0
s_branch Lste_66
Lst1_63:
s_and_b32 s43, s54, s55
s_cmp_eq_u32 s43, 16
s_cbranch_scc1 Lg_68
s_load_dword s54, s[82:83], s52 glc
s_load_dword s55, s[82:83], s53 glc
s_branch Lste_66
Lg_68:
v_add_u32 v5, 0, v1
v_min_u32 v5, 143, v5
v_lshlrev_b32 v20, 3, v5
v_add_u32 v5, s50, v5
v_max_i32 v5, 0, v5
v_lshlrev_b32 v5, 3, v5
buffer_load_dwordx2 v[32:33], v5, s[20:23], 0 offen sc1
v_add_u32 v5, 64, v1
v_min_u32 v5, 143, v5
v_lshlrev_b32 v21, 3, v5
v_add_u32 v5, s50, v5
v_max_i32 v5, 0, v5
v_lshlrev_b32 v5, 3, v5
buffer_load_dwordx2 v[34:35], v5, s[20:23], 0 offen sc1
v_add_u32 v5, 128, v1
v_min_u32 v5, 143, v5
v_lshlrev_b32 v22, 3, v5
v_add_u32 v5, s50, v5
v_max_i32 v5, 0, v5
v_lshlrev_b32 v5, 3, v5
buffer_load_dwordx2 v[36:37], v5, s[20:23], 0 offen sc1
s_mov_b32 s62, 4
s_branch Lste_66
Lst4_65:
s_mov_b32 s62, 2
s_branch Lste_66
Lst2_64:
s_waitcnt vmcnt(0)
v_add_u32 v20, 147456, v20
ds_write_b64 v20, v[32:33]
v_add_u32 v21, 147456, v21
ds_write_b64 v21, v[34:35]
v_add_u32 v22, 147456, v22
ds_write_b64 v22, v[36:37]
s_waitcnt lgkmcnt(0)
s_mov_b32 s62, 3
Lste_66:
s_branch Lst_11_0
Lwr_171:
s_barrier
s_cmp_eq_u32 s62, 3
s_cbranch_scc1 Lste_72
s_cmp_eq_u32 s62, 2
s_cbranch_scc1 Lst2_70
s_cmp_ge_u32 s62, 4
s_cbranch_scc1 Lst4_71
s_cmp_eq_u32 s62, 1
s_cbranch_scc1 Lst1_69
s_waitcnt vmcnt(0)
v_readfirstlane_b32 s54, v6
s_cmp_eq_u32 s54, 0
s_cbranch_scc0 Lrep_73
buffer_load_dword v6, v4, s[56:59], 0 offen sc1
s_branch Lste_72
Lrep_73:
s_add_u32 s7, s34, 64
s_lshl_b32 s7, s7, 7
v_mov_b32 v5, s7
v_mov_b32 v6, 1
s_mov_b64 exec, 1
buffer_atomic_add v6, v5, s[84:87], 0 offen sc1
s_mov_b64 exec, -1
s_mov_b32 s62, 1
s_mov_b32 s54, 0
s_mov_b32 s55, 0
s_branch Lste_72
Lst1_69:
s_and_b32 s43, s54, s55
s_cmp_eq_u32 s43, 16
s_cbranch_scc1 Lg_74
s_load_dword s54, s[82:83], s52 glc
s_load_dword s55, s[82:83], s53 glc
s_branch Lste_72
Lg_74:
v_add_u32 v5, 0, v1
v_min_u32 v5, 143, v5
v_lshlrev_b32 v20, 3, v5
v_add_u32 v5, s50, v5
v_max_i32 v5, 0, v5
v_lshlrev_b32 v5, 3, v5
buffer_load_dwordx2 v[32:33], v5, s[20:23], 0 offen sc1
v_add_u32 v5, 64, v1
v_min_u32 v5, 143, v5
v_lshlrev_b32 v21, 3, v5
v_add_u32 v5, s50, v5
v_max_i32 v5, 0, v5
v_lshlrev_b32 v5, 3, v5
buffer_load_dwordx2 v[34:35], v5, s[20:23], 0 offen sc1
v_add_u32 v5, 128, v1
v_min_u32 v5, 143, v5
v_lshlrev_b32 v22, 3, v5
v_add_u32 v5, s50, v5
v_max_i32 v5, 0, v5
v_lshlrev_b32 v5, 3, v5
buffer_load_dwordx2 v[36:37], v5, s[20:23], 0 offen sc1
s_mov_b32 s62, 4
s_branch Lste_72
Lst4_71:
s_mov_b32 s62, 2
s_branch Lste_72
Lst2_70:
s_waitcnt vmcnt(0)
v_add_u32 v20, 147456, v20
ds_write_b64 v20, v[32:33]
v_add_u32 v21, 147456, v21
ds_write_b64 v21, v[34:35]
v_add_u32 v22, 147456, v22
ds_write_b64 v22, v[36:37]
s_waitcnt lgkmcnt(0)
s_mov_b32 s62, 3
Lste_72:
s_branch Lst_12_0
Lwr_172:
s_barrier
s_cmp_eq_u32 s62, 3
s_cbranch_scc1 Lste_78
s_cmp_eq_u32 s62, 2
s_cbranch_scc1 Lst2_76
s_cmp_ge_u32 s62, 4
s_cbranch_scc1 Lst4_77
s_cmp_eq_u32 s62, 1
s_cbranch_scc1 Lst1_75
s_waitcnt vmcnt(0)
v_readfirstlane_b32 s54, v6
s_cmp_eq_u32 s54, 0
s_cbranch_scc0 Lrep_79
buffer_load_dword v6, v4, s[56:59], 0 offen sc1
s_branch Lste_78
Lrep_79:
s_add_u32 s7, s34, 64
s_lshl_b32 s7, s7, 7
v_mov_b32 v5, s7
v_mov_b32 v6, 1
s_mov_b64 exec, 1
buffer_atomic_add v6, v5, s[84:87], 0 offen sc1
s_mov_b64 exec, -1
s_mov_b32 s62, 1
s_mov_b32 s54, 0
s_mov_b32 s55, 0
s_branch Lste_78
Lst1_75:
s_and_b32 s43, s54, s55
s_cmp_eq_u32 s43, 16
s_cbranch_scc1 Lg_80
s_load_dword s54, s[82:83], s52 glc
s_load_dword s55, s[82:83], s53 glc
s_branch Lste_78
Lg_80:
v_add_u32 v5, 0, v1
v_min_u32 v5, 143, v5
v_lshlrev_b32 v20, 3, v5
v_add_u32 v5, s50, v5
v_max_i32 v5, 0, v5
v_lshlrev_b32 v5, 3, v5
buffer_load_dwordx2 v[32:33], v5, s[20:23], 0 offen sc1
v_add_u32 v5, 64, v1
v_min_u32 v5, 143, v5
v_lshlrev_b32 v21, 3, v5
v_add_u32 v5, s50, v5
v_max_i32 v5, 0, v5
v_lshlrev_b32 v5, 3, v5
buffer_load_dwordx2 v[34:35], v5, s[20:23], 0 offen sc1
v_add_u32 v5, 128, v1
v_min_u32 v5, 143, v5
v_lshlrev_b32 v22, 3, v5
v_add_u32 v5, s50, v5
v_max_i32 v5, 0, v5
v_lshlrev_b32 v5, 3, v5
buffer_load_dwordx2 v[36:37], v5, s[20:23], 0 offen sc1
s_mov_b32 s62, 4
s_branch Lov_4
.p2align 12
.fill 32, 4, 0xbf800000
Lst_4_0:
s_branch Lwr_164
s_nop 0
s_nop 0
Lov_4:
s_branch Lste_78
Lst4_77:
s_mov_b32 s62, 2
s_branch Lste_78
Lst2_76:
s_waitcnt vmcnt(0)
v_add_u32 v20, 147456, v20
ds_write_b64 v20, v[32:33]
v_add_u32 v21, 147456, v21
ds_write_b64 v21, v[34:35]
v_add_u32 v22, 147456, v22
ds_write_b64 v22, v[36:37]
s_waitcnt lgkmcnt(0)
s_mov_b32 s62, 3
Lste_78:
s_branch Lst_13_0
Lwr_173:
s_barrier
s_cmp_eq_u32 s62, 3
s_cbranch_scc1 Lste_84
s_cmp_eq_u32 s62, 2
s_cbranch_scc1 Lst2_82
s_cmp_ge_u32 s62, 4
s_cbranch_scc1 Lst4_83
s_cmp_eq_u32 s62, 1
s_cbranch_scc1 Lst1_81
s_waitcnt vmcnt(0)
v_readfirstlane_b32 s54, v6
s_cmp_eq_u32 s54, 0
s_cbranch_scc0 Lrep_85
buffer_load_dword v6, v4, s[56:59], 0 offen sc1
s_branch Lste_84
Lrep_85:
s_add_u32 s7, s34, 64
s_lshl_b32 s7, s7, 7
v_mov_b32 v5, s7
v_mov_b32 v6, 1
s_mov_b64 exec, 1
buffer_atomic_add v6, v5, s[84:87], 0 offen sc1
s_mov_b64 exec, -1
s_mov_b32 s62, 1
s_mov_b32 s54, 0
s_mov_b32 s55, 0
s_branch Lste_84
Lst1_81:
s_and_b32 s43, s54, s55
s_cmp_eq_u32 s43, 16
s_cbranch_scc1 Lg_86
s_load_dword s54, s[82:83], s52 glc
s_load_dword s55, s[82:83], s53 glc
s_branch Lste_84
Lg_86:
v_add_u32 v5, 0, v1
v_min_u32 v5, 143, v5
v_lshlrev_b32 v20, 3, v5
v_add_u32 v5, s50, v5
v_max_i32 v5, 0, v5
v_lshlrev_b32 v5, 3, v5
buffer_load_dwordx2 v[32:33], v5, s[20:23], 0 offen sc1
v_add_u32 v5, 64, v1
v_min_u32 v5, 143, v5
v_lshlrev_b32 v21, 3, v5
v_add_u32 v5, s50, v5
v_max_i32 v5, 0, v5
v_lshlrev_b32 v5, 3, v5
buffer_load_dwordx2 v[34:35], v5, s[20:23], 0 offen sc1
v_add_u32 v5, 128, v1
v_min_u32 v5, 143, v5
v_lshlrev_b32 v22, 3, v5
v_add_u32 v5, s50, v5
v_max_i32 v5, 0, v5
v_lshlrev_b32 v5, 3, v5
buffer_load_dwordx2 v[36:37], v5, s[20:23], 0 offen sc1
s_mov_b32 s62, 4
s_branch Lste_84
Lst4_83:
s_mov_b32 s62, 2
s_branch Lste_84
Lst2_82:
s_waitcnt vmcnt(0)
v_add_u32 v20, 147456, v20
ds_write_b64 v20, v[32:33]
v_add_u32 v21, 147456, v21
ds_write_b64 v21, v[34:35]
v_add_u32 v22, 147456, v22
ds_write_b64 v22, v[36:37]
s_waitcnt lgkmcnt(0)
s_mov_b32 s62, 3
Lste_84:
s_branch Lst_14_0
Lwr_174:
s_barrier
s_cmp_eq_u32 s62, 3
s_cbranch_scc1 Lste_89
s_cmp_ge_u32 s62, 5
s_cbranch_scc1 Lg_94
s_cmp_ge_u32 s62, 2
s_cbranch_scc1 Lst2_88
s_cmp_eq_u32 s62, 1
s_cbranch_scc1 Lst1_87
s_mov_b32 s41, 0x40000
Lz0_90:
s_waitcnt vmcnt(0)
v_readfirstlane_b32 s54, v6
s_cmp_eq_u32 s54, 0
s_cbranch_scc0 Lzok_91
buffer_load_dword v6, v4, s[56:59], 0 offen sc1
s_sub_u32 s41, s41, 1
s_cmp_lg_u32 s41, 0
s_cbranch_scc1 Lz0_90
s_waitcnt lgkmcnt(0)
Lzok_91:
s_add_u32 s7, s34, 64
s_lshl_b32 s7, s7, 7
v_mov_b32 v5, s7
v_mov_b32 v6, 1
s_mov_b64 exec, 1
buffer_atomic_add v6, v5, s[84:87], 0 offen sc1
s_mov_b64 exec, -1
Lst1_87:
s_load_dword s54, s[82:83], s52 glc
s_load_dword s55, s[82:83], s53 glc
s_mov_b32 s41, 0x40000
Lpoll_92:
s_waitcnt lgkmcnt(0)
s_and_b32 s54, s54, s55
s_cmp_eq_u32 s54, 16
s_cbranch_scc1 Lg_94
s_load_dword s54, s[82:83], s52 glc
s_load_dword s55, s[82:83], s53 glc
s_sub_u32 s41, s41, 1
s_cmp_lg_u32 s41, 0
s_cbranch_scc1 Lpoll_92
s_waitcnt lgkmcnt(0)
Lg_94:
v_add_u32 v5, 0, v1
v_min_u32 v5, 143, v5
v_lshlrev_b32 v20, 3, v5
v_add_u32 v5, s50, v5
v_max_i32 v5, 0, v5
v_lshlrev_b32 v5, 3, v5
buffer_load_dwordx2 v[32:33], v5, s[20:23], 0 offen sc1
v_add_u32 v5, 64, v1
v_min_u32 v5, 143, v5
v_lshlrev_b32 v21, 3, v5
v_add_u32 v5, s50, v5
v_max_i32 v5, 0, v5
v_lshlrev_b32 v5, 3, v5
buffer_load_dwordx2 v[34:35], v5, s[20:23], 0 offen sc1
v_add_u32 v5, 128, v1
v_min_u32 v5, 143, v5
v_lshlrev_b32 v22, 3, v5
v_add_u32 v5, s50, v5
v_max_i32 v5, 0, v5
v_lshlrev_b32 v5, 3, v5
buffer_load_dwordx2 v[36:37], v5, s[20:23], 0 offen sc1
Lst2_88:
s_waitcnt vmcnt(0)
v_add_u32 v20, 147456, v20
ds_write_b64 v20, v[32:33]
v_add_u32 v21, 147456, v21
ds_write_b64 v21, v[34:35]
v_add_u32 v22, 147456, v22
ds_write_b64 v22, v[36:37]
s_waitcnt lgkmcnt(0)
Lste_89:
s_lshl_b32 s43, s35, 7
s_add_u32 s28, s68, s43
s_addc_u32 s29, s69, 0
s_mov_b32 s30, 2095232
s_mov_b32 s31, 0x20000
v_lshrrev_b32 v15, 3, v1
v_and_b32 v16, 6, v15
v_and_b32 v7, 7, v1
v_xor_b32 v7, v7, v16
v_lshlrev_b32 v7, 4, v7
v_mul_u32_u24 v15, 2048, v15
v_add_u32 v7, v7, v15
s_and_b32 s40, s36, 3
s_lshl_b32 s39, s40, 13
s_add_u32 s40, s40, s35
s_add_u32 s42, s40, 0
s_and_b32 s42, s42, 15
s_lshl_b32 s42, s42, 17
s_add_u32 m0, s39, 65536
s_add_u32 s43, s42, 0
buffer_load_dwordx4 v7, s[28:31], s43 offen lds
s_add_u32 m0, s39, 66560
s_add_u32 s43, s42, 16384
buffer_load_dwordx4 v7, s[28:31], s43 offen lds
s_add_u32 m0, s39, 67584
s_add_u32 s43, s42, 32768
buffer_load_dwordx4 v7, s[28:31], s43 offen lds
s_add_u32 m0, s39, 68608
s_add_u32 s43, s42, 49152
buffer_load_dwordx4 v7, s[28:31], s43 offen lds
s_add_u32 m0, s39, 69632
s_add_u32 s43, s42, 65536
buffer_load_dwordx4 v7, s[28:31], s43 offen lds
s_add_u32 m0, s39, 70656
s_add_u32 s43, s42, 81920
buffer_load_dwordx4 v7, s[28:31], s43 offen lds
s_add_u32 m0, s39, 71680
s_add_u32 s43, s42, 98304
buffer_load_dwordx4 v7, s[28:31], s43 offen lds
s_add_u32 m0, s39, 72704
s_add_u32 s43, s42, 114688
buffer_load_dwordx4 v7, s[28:31], s43 offen lds
s_bitcmp0_b32 s2, 0
s_cselect_b32 s88, s72, s74
s_cselect_b32 s89, s73, s75
s_cmp_lt_u32 s2, 192
s_cselect_b32 s90, 7340032, 0
s_mov_b32 s91, 0x20000
s_bfe_u32 s44, s2, 0x30001
s_lshl_b32 s44, s44, 2
s_and_b32 s43, s36, 3
s_add_u32 s44, s44, s43
s_lshl_b32 s44, s44, 5
v_lshrrev_b32 v18, 4, v1
v_add_u32 v18, s44, v18
v_mul_u32_u24 v18, 7168, v18
v_and_b32 v19, 15, v1
v_lshl_add_u32 v18, v19, 4, v18
s_lshr_b32 s43, s2, 4
s_lshl_b32 s43, s43, 8
s_add_u32 s43, s43, 4096
v_add_u32 v18, s43, v18
s_mov_b32 s43, 0
buffer_load_dwordx4 v[128:131], v18, s[88:91], s43 offen
s_mov_b32 s43, 28672
buffer_load_dwordx4 v[132:135], v18, s[88:91], s43 offen
s_mov_b32 s43, 57344
buffer_load_dwordx4 v[136:139], v18, s[88:91], s43 offen
s_mov_b32 s43, 86016
buffer_load_dwordx4 v[140:143], v18, s[88:91], s43 offen
s_mov_b32 s43, 114688
buffer_load_dwordx4 v[144:147], v18, s[88:91], s43 offen
s_mov_b32 s43, 143360
buffer_load_dwordx4 v[148:151], v18, s[88:91], s43 offen
s_mov_b32 s43, 172032
buffer_load_dwordx4 v[152:155], v18, s[88:91], s43 offen
s_mov_b32 s43, 200704
buffer_load_dwordx4 v[156:159], v18, s[88:91], s43 offen
s_barrier
Lats_6:
s_and_b32 s43, s36, 1
s_bfe_u32 s44, s36, 0x10001
s_lshr_b32 s45, s36, 2
v_lshlrev_b32 v14, 2, v13
v_sub_u32 v14, v12, v14
v_mov_b32 v16, 0xff800000
s_or_b32 s46, s34, s45
s_cmp_lg_u32 s46, 0
s_cselect_b32 s46, 0, 0xff800000
v_subrev_u32 v15, 0, v14
v_cmp_ge_u32 vcc, 7, v15
v_add_u32 v15, 16, v15
s_nop 0
v_cndmask_b32 v248, v16, 0, vcc
v_cmp_ge_u32 vcc, 7, v15
s_nop 1
v_cndmask_b32 v244, v16, 0, vcc
v_or_b32 v240, s46, v244
v_subrev_u32 v15, 1, v14
v_cmp_ge_u32 vcc, 7, v15
v_add_u32 v15, 16, v15
s_nop 0
v_cndmask_b32 v249, v16, 0, vcc
v_cmp_ge_u32 vcc, 7, v15
s_nop 1
v_cndmask_b32 v245, v16, 0, vcc
v_or_b32 v241, s46, v245
v_subrev_u32 v15, 2, v14
v_cmp_ge_u32 vcc, 7, v15
v_add_u32 v15, 16, v15
s_nop 0
v_cndmask_b32 v250, v16, 0, vcc
v_cmp_ge_u32 vcc, 7, v15
s_nop 1
v_cndmask_b32 v246, v16, 0, vcc
v_or_b32 v242, s46, v246
v_subrev_u32 v15, 3, v14
v_cmp_ge_u32 vcc, 7, v15
v_add_u32 v15, 16, v15
s_nop 0
v_cndmask_b32 v251, v16, 0, vcc
v_cmp_ge_u32 vcc, 7, v15
s_nop 1
v_cndmask_b32 v247, v16, 0, vcc
v_or_b32 v243, s46, v247
s_lshl_b32 s46, s45, 6
s_add_u32 s46, s46, s44
s_add_u32 s46, s46, 16
v_lshl_add_u32 v14, v12, 1, s46
s_lshl_b32 s47, s43, 6
v_lshl_add_u32 v15, v13, 4, s47
v_mul_u32_u24 v20, 400, v14
v_add_u32 v20, v20, v15
v_subrev_u32 v16, 32, v14
v_max_i32 v16, 0, v16
v_mul_u32_u24 v21, 400, v16
v_add_u32 v21, v21, v15
v_lshrrev_b32 v16, 2, v12
v_lshl_add_u32 v16, v13, 2, v16
v_lshl_add_u32 v16, v16, 1, s46
v_and_b32 v17, 3, v1
v_lshl_add_u32 v17, v17, 3, s47
v_mul_u32_u24 v22, 400, v16
v_add_u32 v22, v22, v17
v_subrev_u32 v16, 32, v16
v_max_i32 v16, 0, v16
v_mul_u32_u24 v23, 400, v16
v_add_u32 v23, v23, v17
s_mul_i32 s60, s34, 262144
s_add_u32 s16, s82, s60
s_addc_u32 s17, s83, 0
s_mov_b32 s18, 262144
s_mov_b32 s19, 0x20000
s_lshl_b32 s60, s35, 14
s_lshl_b32 s43, s43, 13
s_add_u32 s60, s60, s43
s_lshl_b32 s43, s45, 12
s_add_u32 s60, s60, s43
s_lshl_b32 s43, s44, 10
s_add_u32 s60, s60, s43
v_lshlrev_b32 v24, 4, v1
s_mov_b32 s61, 0x3e8293ee
s_lshl_b32 s38, s35, 7
Latt_5:
s_barrier
ds_read_b128 v[32:35], v20 offset:0
ds_read_b128 v[36:39], v20 offset:128
ds_read_b128 v[40:43], v21 offset:128
ds_read_b128 v[80:83], v20 offset:12800
ds_read_b128 v[84:87], v20 offset:12928
ds_read_b128 v[88:91], v20 offset:128
ds_read_b64_tr_b16 v[44:45], v23 offset:256
ds_read_b64_tr_b16 v[46:47], v22 offset:256
ds_read_b64_tr_b16 v[48:49], v23 offset:288
ds_read_b64_tr_b16 v[50:51], v22 offset:288
ds_read_b64_tr_b16 v[92:93], v22 offset:256
ds_read_b64_tr_b16 v[94:95], v22 offset:13056
ds_read_b64_tr_b16 v[96:97], v22 offset:288
ds_read_b64_tr_b16 v[98:99], v22 offset:13088
s_waitcnt lgkmcnt(11)
v_mfma_f32_16x16x32_bf16 v[52:55], v[40:43], v[32:35], v[240:243]
v_mfma_f32_16x16x32_bf16 v[56:59], v[36:39], v[32:35], v[248:251]
s_waitcnt lgkmcnt(8)
v_mfma_f32_16x16x32_bf16 v[100:103], v[88:91], v[80:83], v[244:247]
v_mfma_f32_16x16x32_bf16 v[104:107], v[84:87], v[80:83], v[248:251]
s_nop 5
v_max3_f32 v60, v52, v53, v54
v_max3_f32 v108, v100, v101, v102
v_max3_f32 v61, v55, v56, v57
v_max3_f32 v109, v103, v104, v105
v_max3_f32 v60, v60, v58, v59
v_max3_f32 v108, v108, v106, v107
v_max_f32 v60, v60, v61
v_max_f32 v108, v108, v109
s_nop 1
v_permlane32_swap_b32 v60, v108
v_max_f32 v60, v60, v108
v_mov_b32 v61, v60
s_nop 1
v_permlane16_swap_b32 v60, v61
v_max_f32 v60, v60, v61
v_mul_f32 v60, s61, v60
s_nop 0
v_mov_b32 v108, v60
s_nop 1
v_permlane32_swap_b32 v60, v108
v_fma_f32 v52, v52, s61, -v60
v_fma_f32 v100, v100, s61, -v108
v_fma_f32 v53, v53, s61, -v60
v_fma_f32 v101, v101, s61, -v108
v_fma_f32 v54, v54, s61, -v60
v_fma_f32 v102, v102, s61, -v108
v_fma_f32 v55, v55, s61, -v60
v_fma_f32 v103, v103, s61, -v108
v_fma_f32 v56, v56, s61, -v60
v_fma_f32 v104, v104, s61, -v108
v_fma_f32 v57, v57, s61, -v60
v_fma_f32 v105, v105, s61, -v108
v_fma_f32 v58, v58, s61, -v60
v_fma_f32 v106, v106, s61, -v108
v_fma_f32 v59, v59, s61, -v60
v_fma_f32 v107, v107, s61, -v108
v_exp_f32 v52, v52
v_exp_f32 v100, v100
v_exp_f32 v53, v53
v_exp_f32 v101, v101
v_exp_f32 v54, v54
v_exp_f32 v102, v102
v_exp_f32 v55, v55
v_exp_f32 v103, v103
v_exp_f32 v56, v56
v_exp_f32 v104, v104
v_exp_f32 v57, v57
v_exp_f32 v105, v105
v_exp_f32 v58, v58
v_exp_f32 v106, v106
v_exp_f32 v59, v59
v_exp_f32 v107, v107
v_cvt_pk_bf16_f32 v64, v52, v53
v_cvt_pk_bf16_f32 v112, v100, v101
v_cvt_pk_bf16_f32 v65, v54, v55
v_cvt_pk_bf16_f32 v113, v102, v103
v_cvt_pk_bf16_f32 v66, v56, v57
v_cvt_pk_bf16_f32 v114, v104, v105
v_cvt_pk_bf16_f32 v67, v58, v59
v_cvt_pk_bf16_f32 v115, v106, v107
v_pk_add_f32 v[52:53], v[52:53], v[54:55]
v_pk_add_f32 v[100:101], v[100:101], v[102:103]
v_pk_add_f32 v[56:57], v[56:57], v[58:59]
v_pk_add_f32 v[104:105], v[104:105], v[106:107]
s_waitcnt lgkmcnt(0)
s_waitcnt lgkmcnt(0)
v_mfma_f32_16x16x32_bf16 v[68:71], v[44:47], v[64:67], 0
v_mfma_f32_16x16x32_bf16 v[116:119], v[92:95], v[112:115], 0
v_mfma_f32_16x16x32_bf16 v[72:75], v[48:51], v[64:67], 0
v_mfma_f32_16x16x32_bf16 v[120:123], v[96:99], v[112:115], 0
v_pk_add_f32 v[52:53], v[52:53], v[56:57]
v_pk_add_f32 v[100:101], v[100:101], v[104:105]
v_add_f32 v60, v52, v53
v_add_f32 v108, v100, v101
s_nop 1
v_permlane32_swap_b32 v60, v108
v_add_f32 v60, v60, v108
v_mov_b32 v61, v60
s_nop 1
v_permlane16_swap_b32 v60, v61
v_add_f32 v60, v60, v61
v_rcp_f32 v60, v60
s_nop 0
v_mov_b32 v108, v60
s_nop 1
v_permlane32_swap_b32 v60, v108
v_pk_mul_f32 v[68:69], v[60:61], v[68:69] op_sel_hi:[0,1]
v_pk_mul_f32 v[116:117], v[108:109], v[116:117] op_sel_hi:[0,1]
v_pk_mul_f32 v[70:71], v[60:61], v[70:71] op_sel_hi:[0,1]
v_pk_mul_f32 v[118:119], v[108:109], v[118:119] op_sel_hi:[0,1]
v_pk_mul_f32 v[72:73], v[60:61], v[72:73] op_sel_hi:[0,1]
v_pk_mul_f32 v[120:121], v[108:109], v[120:121] op_sel_hi:[0,1]
v_pk_mul_f32 v[74:75], v[60:61], v[74:75] op_sel_hi:[0,1]
v_pk_mul_f32 v[122:123], v[108:109], v[122:123] op_sel_hi:[0,1]
v_cvt_pk_bf16_f32 v64, v68, v69
v_cvt_pk_bf16_f32 v112, v116, v117
v_cvt_pk_bf16_f32 v65, v70, v71
v_cvt_pk_bf16_f32 v113, v118, v119
v_cvt_pk_bf16_f32 v66, v72, v73
v_cvt_pk_bf16_f32 v114, v120, v121
v_cvt_pk_bf16_f32 v67, v74, v75
v_cvt_pk_bf16_f32 v115, v122, v123
buffer_store_dwordx4 v[64:67], v24, s[16:19], s60 offen offset:0 sc1
buffer_store_dwordx4 v[112:115], v24, s[16:19], s60 offen offset:2048 sc1
s_add_u32 s56, s82, 28311552
s_addc_u32 s57, s83, 0
s_mov_b32 s58, 114688
s_mov_b32 s59, 0x20000
s_lshl_b32 s7, s34, 12
s_add_u32 s7, s7, 49152
v_lshl_add_u32 v26, v1, 8, s7
v_mov_b32 v27, 1
s_cmp_ge_u32 s36, 4
s_cbranch_scc1 Lh_96
s_waitcnt vmcnt(0)
s_branch Lo_95
Lh_96:
s_add_u32 s28, s68, s38
s_addc_u32 s29, s69, 0
s_mov_b32 s30, 2095232
s_mov_b32 s31, 0x20000
s_add_u32 s42, s40, 4
s_and_b32 s42, s42, 15
s_lshl_b32 s42, s42, 17
s_add_u32 m0, s39, 114688
s_add_u32 s43, s42, 0
buffer_load_dwordx4 v7, s[28:31], s43 offen lds
s_add_u32 m0, s39, 115712
s_add_u32 s43, s42, 16384
buffer_load_dwordx4 v7, s[28:31], s43 offen lds
s_add_u32 m0, s39, 116736
s_add_u32 s43, s42, 32768
buffer_load_dwordx4 v7, s[28:31], s43 offen lds
s_add_u32 m0, s39, 117760
s_add_u32 s43, s42, 49152
buffer_load_dwordx4 v7, s[28:31], s43 offen lds
s_add_u32 m0, s39, 118784
s_add_u32 s43, s42, 65536
buffer_load_dwordx4 v7, s[28:31], s43 offen lds
s_add_u32 m0, s39, 119808
s_add_u32 s43, s42, 81920
buffer_load_dwordx4 v7, s[28:31], s43 offen lds
s_add_u32 m0, s39, 120832
s_add_u32 s43, s42, 98304
buffer_load_dwordx4 v7, s[28:31], s43 offen lds
s_add_u32 m0, s39, 121856
s_add_u32 s43, s42, 114688
buffer_load_dwordx4 v7, s[28:31], s43 offen lds
s_waitcnt vmcnt(8)
Lo_95:
s_cmp_lg_u32 s36, 0
s_barrier
s_cbranch_scc1 Lsig_97
s_mov_b64 exec, 0xffff
buffer_atomic_add v27, v26, s[56:59], 0 offen sc1
s_mov_b64 exec, -1
Lsig_97:
s_cmp_ge_u32 s36, 4
s_cbranch_scc1 Lprod_99
v_and_b32 v12, 15, v1
v_lshrrev_b32 v13, 4, v1
v_lshlrev_b32 v10, 12, v12
v_and_b32 v14, 1, v13
v_lshl_add_u32 v10, v14, 5, v10
v_lshrrev_b32 v14, 1, v13
v_lshl_add_u32 v10, v14, 4, v10
s_lshl_b32 s43, s34, 18
s_lshl_b32 s44, s36, 16
s_add_u32 s43, s43, s44
s_lshl_b32 s44, s35, 7
s_add_u32 s43, s43, s44
buffer_load_dwordx4 v[128:131], v10, s[8:11], s43 offen offset:0
buffer_load_dwordx4 v[132:135], v10, s[8:11], s43 offen offset:64
buffer_load_dwordx4 v[136:139], v10, s[8:11], s43 offen offset:2048
buffer_load_dwordx4 v[140:143], v10, s[8:11], s43 offen offset:2112
v_and_b32 v12, 15, v1
v_lshrrev_b32 v13, 4, v1
s_mul_i32 s43, s34, 262144
s_add_u32 s20, s82, s43
s_addc_u32 s21, s83, 0
s_add_u32 s20, s20, 4194304
s_addc_u32 s21, s21, 0
s_mov_b32 s22, 262144
s_mov_b32 s23, 0x20000
s_mul_i32 s43, s34, 16384
s_add_u32 s24, s82, s43
s_addc_u32 s25, s83, 0
s_add_u32 s24, s24, 25165824
s_addc_u32 s25, s25, 0
s_mov_b32 s26, 16384
s_mov_b32 s27, 0x20000
v_lshlrev_b32 v11, 4, v1
s_lshl_b32 s43, s36, 11
v_add_u32 v2, s43, v11
v_add_u32 v3, 98304, v2
v_lshrrev_b32 v14, 2, v1
v_bfe_u32 v15, v14, 1, 2
v_mul_u32_u24 v14, 128, v14
v_lshl_add_u32 v14, v15, 5, v14
v_and_b32 v15, 3, v1
v_lshl_add_u32 v4, v15, 3, v14
v_xor_b32 v5, 32, v4
v_xor_b32 v6, 64, v4
v_xor_b32 v7, 96, v4
v_add_u32 v16, 0x10000, v4
v_add_u32 v20, 0x20000, v4
v_add_u32 v17, 0x10000, v5
v_add_u32 v21, 0x20000, v5
v_add_u32 v18, 0x10000, v6
v_add_u32 v22, 0x20000, v6
v_add_u32 v19, 0x10000, v7
v_add_u32 v23, 0x20000, v7
s_lshl_b32 s44, s35, 14
s_add_u32 s60, s44, s43
v_lshrrev_b32 v14, 1, v13
v_lshlrev_b32 v14, 11, v14
v_lshl_add_u32 v14, v12, 3, v14
v_and_b32 v15, 1, v13
v_lshl_add_u32 v14, v15, 2, v14
s_lshl_b32 s43, s36, 12
s_lshl_b32 s44, s35, 7
s_add_u32 s43, s43, s44
v_add_u32 v9, s43, v14
s_mov_b32 s61, 0x3f803f80
s_waitcnt vmcnt(0)
v_permlane16_swap_b32 v128, v130
v_permlane16_swap_b32 v129, v131
v_permlane16_swap_b32 v132, v134
v_permlane16_swap_b32 v133, v135
v_permlane16_swap_b32 v136, v138
v_permlane16_swap_b32 v137, v139
v_permlane16_swap_b32 v140, v142
v_permlane16_swap_b32 v141, v143
v_lshlrev_b32 v96, 16, v128
v_and_b32 v97, 0xffff0000, v128
v_lshlrev_b32 v98, 16, v129
v_and_b32 v99, 0xffff0000, v129
v_lshlrev_b32 v100, 16, v130
v_and_b32 v101, 0xffff0000, v130
v_lshlrev_b32 v102, 16, v131
v_and_b32 v103, 0xffff0000, v131
v_lshlrev_b32 v104, 16, v132
v_and_b32 v105, 0xffff0000, v132
v_lshlrev_b32 v106, 16, v133
v_and_b32 v107, 0xffff0000, v133
v_lshlrev_b32 v108, 16, v134
v_and_b32 v109, 0xffff0000, v134
v_lshlrev_b32 v110, 16, v135
v_and_b32 v111, 0xffff0000, v135
v_lshlrev_b32 v112, 16, v136
v_and_b32 v113, 0xffff0000, v136
v_lshlrev_b32 v114, 16, v137
v_and_b32 v115, 0xffff0000, v137
v_lshlrev_b32 v116, 16, v138
v_and_b32 v117, 0xffff0000, v138
v_lshlrev_b32 v118, 16, v139
v_and_b32 v119, 0xffff0000, v139
v_lshlrev_b32 v120, 16, v140
v_and_b32 v121, 0xffff0000, v140
v_lshlrev_b32 v122, 16, v141
v_and_b32 v123, 0xffff0000, v141
v_lshlrev_b32 v124, 16, v142
v_and_b32 v125, 0xffff0000, v142
v_lshlrev_b32 v126, 16, v143
v_and_b32 v127, 0xffff0000, v143
s_cmp_lg_u32 s36, 0
s_cbranch_scc1 Lwm_102
s_nop 0
s_branch Lwe_101
Lwm_102:
s_cmp_lg_u32 s36, 1
s_cbranch_scc1 Lwm_103
s_nop 0
s_branch Lwe_101
Lwm_103:
s_cmp_lg_u32 s36, 2
s_cbranch_scc1 Lwm_104
s_nop 0
s_branch Lwe_101
Lwm_104:
s_cmp_lg_u32 s36, 3
s_cbranch_scc1 Lwm_105
s_nop 0
s_branch Lwe_101
Lwm_105:
Lwe_101:
s_barrier
ds_read_b128 v[32:35], v2 offset:0
ds_read_b64_tr_b16 v[40:41], v16 offset:0
ds_read_b64_tr_b16 v[42:43], v16 offset:2048
ds_read_b64_tr_b16 v[44:45], v17 offset:0
ds_read_b64_tr_b16 v[46:47], v17 offset:2048
ds_read_b64_tr_b16 v[48:49], v18 offset:0
ds_read_b64_tr_b16 v[50:51], v18 offset:2048
ds_read_b64_tr_b16 v[52:53], v19 offset:0
ds_read_b64_tr_b16 v[54:55], v19 offset:2048
ds_read_b128 v[36:39], v2 offset:1024
ds_read_b128 v[56:59], v2 offset:8192
ds_read_b64_tr_b16 v[64:65], v16 offset:4096
ds_read_b64_tr_b16 v[66:67], v16 offset:6144
ds_read_b64_tr_b16 v[68:69], v17 offset:4096
ds_read_b64_tr_b16 v[70:71], v17 offset:6144
ds_read_b64_tr_b16 v[72:73], v18 offset:4096
ds_read_b64_tr_b16 v[74:75], v18 offset:6144
ds_read_b64_tr_b16 v[76:77], v19 offset:4096
ds_read_b64_tr_b16 v[78:79], v19 offset:6144
ds_read_b128 v[60:63], v2 offset:9216
s_waitcnt lgkmcnt(0)
s_barrier
v_mfma_f32_16x16x32_bf16 v[96:99], v[40:43], v[32:35], v[96:99]
ds_read_b128 v[144:147], v2 offset:49152
ds_read_b64_tr_b16 v[152:153], v16 offset:8192
v_mfma_f32_16x16x32_bf16 v[100:103], v[44:47], v[32:35], v[100:103]
ds_read_b64_tr_b16 v[154:155], v16 offset:10240
ds_read_b64_tr_b16 v[156:157], v17 offset:8192
v_mfma_f32_16x16x32_bf16 v[104:107], v[48:51], v[32:35], v[104:107]
ds_read_b64_tr_b16 v[158:159], v17 offset:10240
ds_read_b64_tr_b16 v[160:161], v18 offset:8192
v_mfma_f32_16x16x32_bf16 v[108:111], v[52:55], v[32:35], v[108:111]
ds_read_b64_tr_b16 v[162:163], v18 offset:10240
ds_read_b64_tr_b16 v[164:165], v19 offset:8192
v_mfma_f32_16x16x32_bf16 v[124:127], v[52:55], v[36:39], v[124:127]
ds_read_b64_tr_b16 v[166:167], v19 offset:10240
ds_read_b128 v[148:151], v2 offset:50176
v_mfma_f32_16x16x32_bf16 v[120:123], v[48:51], v[36:39], v[120:123]
ds_read_b128 v[168:171], v2 offset:57344
ds_read_b64_tr_b16 v[176:177], v16 offset:12288
v_mfma_f32_16x16x32_bf16 v[116:119], v[44:47], v[36:39], v[116:119]
ds_read_b64_tr_b16 v[178:179], v16 offset:14336
ds_read_b64_tr_b16 v[180:181], v17 offset:12288
v_mfma_f32_16x16x32_bf16 v[112:115], v[40:43], v[36:39], v[112:115]
ds_read_b64_tr_b16 v[182:183], v17 offset:14336
ds_read_b64_tr_b16 v[184:185], v18 offset:12288
v_mfma_f32_16x16x32_bf16 v[96:99], v[64:67], v[56:59], v[96:99]
ds_read_b64_tr_b16 v[186:187], v18 offset:14336
ds_read_b64_tr_b16 v[188:189], v19 offset:12288
v_mfma_f32_16x16x32_bf16 v[100:103], v[68:71], v[56:59], v[100:103]
ds_read_b64_tr_b16 v[190:191], v19 offset:14336
ds_read_b128 v[172:175], v2 offset:58368
v_mfma_f32_16x16x32_bf16 v[104:107], v[72:75], v[56:59], v[104:107]
s_bitcmp0_b32 s36, 1
s_branch Lov_5
.p2align 12
.fill 32, 4, 0xbf800000
Lst_5_0:
s_branch Lwr_165
s_nop 0
s_nop 0
Lov_5:
v_mfma_f32_16x16x32_bf16 v[108:111], v[76:79], v[56:59], v[108:111]
s_cselect_b32 s44, s72, s74
v_mfma_f32_16x16x32_bf16 v[124:127], v[76:79], v[60:63], v[124:127]
s_cselect_b32 s45, s73, s75
v_mfma_f32_16x16x32_bf16 v[120:123], v[72:75], v[60:63], v[120:123]
s_mul_i32 s43, s35, 192
v_mfma_f32_16x16x32_bf16 v[116:119], v[68:71], v[60:63], v[116:119]
s_add_u32 s16, s44, s43
v_mfma_f32_16x16x32_bf16 v[112:115], v[64:67], v[60:63], v[112:115]
s_addc_u32 s17, s45, 0
s_waitcnt lgkmcnt(0)
s_barrier
v_mfma_f32_16x16x32_bf16 v[96:99], v[152:155], v[144:147], v[96:99]
ds_read_b128 v[32:35], v3 offset:0
ds_read_b64_tr_b16 v[40:41], v16 offset:16384
v_mfma_f32_16x16x32_bf16 v[100:103], v[156:159], v[144:147], v[100:103]
ds_read_b64_tr_b16 v[42:43], v16 offset:18432
ds_read_b64_tr_b16 v[44:45], v17 offset:16384
v_mfma_f32_16x16x32_bf16 v[104:107], v[160:163], v[144:147], v[104:107]
ds_read_b64_tr_b16 v[46:47], v17 offset:18432
ds_read_b64_tr_b16 v[48:49], v18 offset:16384
v_mfma_f32_16x16x32_bf16 v[108:111], v[164:167], v[144:147], v[108:111]
ds_read_b64_tr_b16 v[50:51], v18 offset:18432
ds_read_b64_tr_b16 v[52:53], v19 offset:16384
v_mfma_f32_16x16x32_bf16 v[124:127], v[164:167], v[148:151], v[124:127]
ds_read_b64_tr_b16 v[54:55], v19 offset:18432
ds_read_b128 v[36:39], v3 offset:1024
v_mfma_f32_16x16x32_bf16 v[120:123], v[160:163], v[148:151], v[120:123]
ds_read_b128 v[56:59], v3 offset:8192
ds_read_b64_tr_b16 v[64:65], v16 offset:20480
v_mfma_f32_16x16x32_bf16 v[116:119], v[156:159], v[148:151], v[116:119]
ds_read_b64_tr_b16 v[66:67], v16 offset:22528
ds_read_b64_tr_b16 v[68:69], v17 offset:20480
v_mfma_f32_16x16x32_bf16 v[112:115], v[152:155], v[148:151], v[112:115]
ds_read_b64_tr_b16 v[70:71], v17 offset:22528
ds_read_b64_tr_b16 v[72:73], v18 offset:20480
v_mfma_f32_16x16x32_bf16 v[96:99], v[176:179], v[168:171], v[96:99]
ds_read_b64_tr_b16 v[74:75], v18 offset:22528
ds_read_b64_tr_b16 v[76:77], v19 offset:20480
v_mfma_f32_16x16x32_bf16 v[100:103], v[180:183], v[168:171], v[100:103]
ds_read_b64_tr_b16 v[78:79], v19 offset:22528
ds_read_b128 v[60:63], v3 offset:9216
v_mfma_f32_16x16x32_bf16 v[104:107], v[184:187], v[168:171], v[104:107]
s_add_u32 s16, s16, 4096
v_mfma_f32_16x16x32_bf16 v[108:111], v[188:191], v[168:171], v[108:111]
s_addc_u32 s17, s17, 0
v_mfma_f32_16x16x32_bf16 v[124:127], v[188:191], v[172:175], v[124:127]
s_mov_b32 s18, 7333056
v_mfma_f32_16x16x32_bf16 v[120:123], v[184:187], v[172:175], v[120:123]
s_mov_b32 s19, 0x20000
v_mfma_f32_16x16x32_bf16 v[116:119], v[180:183], v[172:175], v[116:119]
s_and_b32 s43, s36, 1
v_mfma_f32_16x16x32_bf16 v[112:115], v[176:179], v[172:175], v[112:115]
s_mul_i32 s43, s43, 229376
s_waitcnt lgkmcnt(0)
s_barrier
v_mfma_f32_16x16x32_bf16 v[96:99], v[40:43], v[32:35], v[96:99]
ds_read_b128 v[144:147], v3 offset:49152
ds_read_b64_tr_b16 v[152:153], v16 offset:24576
v_mfma_f32_16x16x32_bf16 v[100:103], v[44:47], v[32:35], v[100:103]
ds_read_b64_tr_b16 v[154:155], v16 offset:26624
ds_read_b64_tr_b16 v[156:157], v17 offset:24576
v_mfma_f32_16x16x32_bf16 v[104:107], v[48:51], v[32:35], v[104:107]
ds_read_b64_tr_b16 v[158:159], v17 offset:26624
ds_read_b64_tr_b16 v[160:161], v18 offset:24576
v_mfma_f32_16x16x32_bf16 v[108:111], v[52:55], v[32:35], v[108:111]
ds_read_b64_tr_b16 v[162:163], v18 offset:26624
ds_read_b64_tr_b16 v[164:165], v19 offset:24576
v_mfma_f32_16x16x32_bf16 v[124:127], v[52:55], v[36:39], v[124:127]
ds_read_b64_tr_b16 v[166:167], v19 offset:26624
ds_read_b128 v[148:151], v3 offset:50176
v_mfma_f32_16x16x32_bf16 v[120:123], v[48:51], v[36:39], v[120:123]
ds_read_b128 v[168:171], v3 offset:57344
ds_read_b64_tr_b16 v[176:177], v16 offset:28672
v_mfma_f32_16x16x32_bf16 v[116:119], v[44:47], v[36:39], v[116:119]
ds_read_b64_tr_b16 v[178:179], v16 offset:30720
ds_read_b64_tr_b16 v[180:181], v17 offset:28672
v_mfma_f32_16x16x32_bf16 v[112:115], v[40:43], v[36:39], v[112:115]
ds_read_b64_tr_b16 v[182:183], v17 offset:30720
ds_read_b64_tr_b16 v[184:185], v18 offset:28672
v_mfma_f32_16x16x32_bf16 v[96:99], v[64:67], v[56:59], v[96:99]
ds_read_b64_tr_b16 v[186:187], v18 offset:30720
ds_read_b64_tr_b16 v[188:189], v19 offset:28672
v_mfma_f32_16x16x32_bf16 v[100:103], v[68:71], v[56:59], v[100:103]
ds_read_b64_tr_b16 v[190:191], v19 offset:30720
ds_read_b128 v[172:175], v3 offset:58368
v_mfma_f32_16x16x32_bf16 v[104:107], v[72:75], v[56:59], v[104:107]
v_add_u32 v196, 0, v1
v_mfma_f32_16x16x32_bf16 v[108:111], v[76:79], v[56:59], v[108:111]
v_mul_u32_u24 v197, 5462, v196
v_mfma_f32_16x16x32_bf16 v[124:127], v[76:79], v[60:63], v[124:127]
v_lshrrev_b32 v197, 16, v197
v_mfma_f32_16x16x32_bf16 v[120:123], v[72:75], v[60:63], v[120:123]
v_mul_u32_u24 v198, 12, v197
v_mfma_f32_16x16x32_bf16 v[116:119], v[68:71], v[60:63], v[116:119]
v_sub_u32 v198, v196, v198
v_mfma_f32_16x16x32_bf16 v[112:115], v[64:67], v[60:63], v[112:115]
v_bfe_u32 v199, v197, 2, 1
s_waitcnt lgkmcnt(0)
s_barrier
v_mfma_f32_16x16x32_bf16 v[96:99], v[152:155], v[144:147], v[96:99]
ds_read_b128 v[32:35], v2 offset:0
ds_read_b64_tr_b16 v[40:41], v16 offset:49152
v_mfma_f32_16x16x32_bf16 v[100:103], v[156:159], v[144:147], v[100:103]
ds_read_b64_tr_b16 v[42:43], v16 offset:51200
ds_read_b64_tr_b16 v[44:45], v17 offset:49152
v_mfma_f32_16x16x32_bf16 v[104:107], v[160:163], v[144:147], v[104:107]
ds_read_b64_tr_b16 v[46:47], v17 offset:51200
ds_read_b64_tr_b16 v[48:49], v18 offset:49152
v_mfma_f32_16x16x32_bf16 v[108:111], v[164:167], v[144:147], v[108:111]
ds_read_b64_tr_b16 v[50:51], v18 offset:51200
ds_read_b64_tr_b16 v[52:53], v19 offset:49152
v_mfma_f32_16x16x32_bf16 v[124:127], v[164:167], v[148:151], v[124:127]
ds_read_b64_tr_b16 v[54:55], v19 offset:51200
ds_read_b128 v[36:39], v2 offset:1024
v_mfma_f32_16x16x32_bf16 v[120:123], v[160:163], v[148:151], v[120:123]
ds_read_b128 v[56:59], v2 offset:8192
ds_read_b64_tr_b16 v[64:65], v16 offset:53248
v_mfma_f32_16x16x32_bf16 v[116:119], v[156:159], v[148:151], v[116:119]
ds_read_b64_tr_b16 v[66:67], v16 offset:55296
ds_read_b64_tr_b16 v[68:69], v17 offset:53248
v_mfma_f32_16x16x32_bf16 v[112:115], v[152:155], v[148:151], v[112:115]
ds_read_b64_tr_b16 v[70:71], v17 offset:55296
ds_read_b64_tr_b16 v[72:73], v18 offset:53248
v_mfma_f32_16x16x32_bf16 v[96:99], v[176:179], v[168:171], v[96:99]
ds_read_b64_tr_b16 v[74:75], v18 offset:55296
ds_read_b64_tr_b16 v[76:77], v19 offset:53248
v_mfma_f32_16x16x32_bf16 v[100:103], v[180:183], v[168:171], v[100:103]
ds_read_b64_tr_b16 v[78:79], v19 offset:55296
ds_read_b128 v[60:63], v2 offset:9216
v_mfma_f32_16x16x32_bf16 v[104:107], v[184:187], v[168:171], v[104:107]
v_cmp_gt_u32 vcc, 8, v198
v_mfma_f32_16x16x32_bf16 v[108:111], v[188:191], v[168:171], v[108:111]
v_lshlrev_b32 v200, 1, v199
v_mfma_f32_16x16x32_bf16 v[124:127], v[188:191], v[172:175], v[124:127]
v_mul_u32_u24 v197, 7168, v197
v_mfma_f32_16x16x32_bf16 v[120:123], v[184:187], v[172:175], v[120:123]
v_cndmask_b32 v199, v199, v200, vcc
v_mfma_f32_16x16x32_bf16 v[116:119], v[180:183], v[172:175], v[116:119]
v_xor_b32 v198, v198, v199
v_mfma_f32_16x16x32_bf16 v[112:115], v[176:179], v[172:175], v[112:115]
v_lshl_add_u32 v192, v198, 4, v197
s_waitcnt lgkmcnt(0)
s_barrier
v_mfma_f32_16x16x32_bf16 v[96:99], v[40:43], v[32:35], v[96:99]
ds_read_b128 v[144:147], v2 offset:49152
ds_read_b64_tr_b16 v[152:153], v16 offset:57344
v_mfma_f32_16x16x32_bf16 v[100:103], v[44:47], v[32:35], v[100:103]
ds_read_b64_tr_b16 v[154:155], v16 offset:59392
ds_read_b64_tr_b16 v[156:157], v17 offset:57344
v_mfma_f32_16x16x32_bf16 v[104:107], v[48:51], v[32:35], v[104:107]
ds_read_b64_tr_b16 v[158:159], v17 offset:59392
ds_read_b64_tr_b16 v[160:161], v18 offset:57344
v_mfma_f32_16x16x32_bf16 v[108:111], v[52:55], v[32:35], v[108:111]
ds_read_b64_tr_b16 v[162:163], v18 offset:59392
ds_read_b64_tr_b16 v[164:165], v19 offset:57344
v_mfma_f32_16x16x32_bf16 v[124:127], v[52:55], v[36:39], v[124:127]
ds_read_b64_tr_b16 v[166:167], v19 offset:59392
ds_read_b128 v[148:151], v2 offset:50176
v_mfma_f32_16x16x32_bf16 v[120:123], v[48:51], v[36:39], v[120:123]
ds_read_b128 v[168:171], v2 offset:57344
ds_read_b64_tr_b16 v[176:177], v16 offset:61440
v_mfma_f32_16x16x32_bf16 v[116:119], v[44:47], v[36:39], v[116:119]
ds_read_b64_tr_b16 v[178:179], v16 offset:63488
ds_read_b64_tr_b16 v[180:181], v17 offset:61440
v_mfma_f32_16x16x32_bf16 v[112:115], v[40:43], v[36:39], v[112:115]
ds_read_b64_tr_b16 v[182:183], v17 offset:63488
ds_read_b64_tr_b16 v[184:185], v18 offset:61440
v_mfma_f32_16x16x32_bf16 v[96:99], v[64:67], v[56:59], v[96:99]
ds_read_b64_tr_b16 v[186:187], v18 offset:63488
ds_read_b64_tr_b16 v[188:189], v19 offset:61440
v_mfma_f32_16x16x32_bf16 v[100:103], v[68:71], v[56:59], v[100:103]
ds_read_b64_tr_b16 v[190:191], v19 offset:63488
ds_read_b128 v[172:175], v2 offset:58368
v_mfma_f32_16x16x32_bf16 v[104:107], v[72:75], v[56:59], v[104:107]
v_add_u32 v196, 64, v1
v_mfma_f32_16x16x32_bf16 v[108:111], v[76:79], v[56:59], v[108:111]
v_mul_u32_u24 v197, 5462, v196
v_mfma_f32_16x16x32_bf16 v[124:127], v[76:79], v[60:63], v[124:127]
v_lshrrev_b32 v197, 16, v197
v_mfma_f32_16x16x32_bf16 v[120:123], v[72:75], v[60:63], v[120:123]
v_mul_u32_u24 v198, 12, v197
v_mfma_f32_16x16x32_bf16 v[116:119], v[68:71], v[60:63], v[116:119]
v_sub_u32 v198, v196, v198
v_mfma_f32_16x16x32_bf16 v[112:115], v[64:67], v[60:63], v[112:115]
v_bfe_u32 v199, v197, 2, 1
s_waitcnt lgkmcnt(0)
s_barrier
v_mfma_f32_16x16x32_bf16 v[96:99], v[152:155], v[144:147], v[96:99]
ds_read_b128 v[32:35], v3 offset:0
ds_read_b64_tr_b16 v[40:41], v20 offset:0
v_mfma_f32_16x16x32_bf16 v[100:103], v[156:159], v[144:147], v[100:103]
ds_read_b64_tr_b16 v[42:43], v20 offset:2048
ds_read_b64_tr_b16 v[44:45], v21 offset:0
v_mfma_f32_16x16x32_bf16 v[104:107], v[160:163], v[144:147], v[104:107]
ds_read_b64_tr_b16 v[46:47], v21 offset:2048
ds_read_b64_tr_b16 v[48:49], v22 offset:0
v_mfma_f32_16x16x32_bf16 v[108:111], v[164:167], v[144:147], v[108:111]
ds_read_b64_tr_b16 v[50:51], v22 offset:2048
ds_read_b64_tr_b16 v[52:53], v23 offset:0
v_mfma_f32_16x16x32_bf16 v[124:127], v[164:167], v[148:151], v[124:127]
ds_read_b64_tr_b16 v[54:55], v23 offset:2048
ds_read_b128 v[36:39], v3 offset:1024
v_mfma_f32_16x16x32_bf16 v[120:123], v[160:163], v[148:151], v[120:123]
ds_read_b128 v[56:59], v3 offset:8192
ds_read_b64_tr_b16 v[64:65], v20 offset:4096
v_mfma_f32_16x16x32_bf16 v[116:119], v[156:159], v[148:151], v[116:119]
ds_read_b64_tr_b16 v[66:67], v20 offset:6144
ds_read_b64_tr_b16 v[68:69], v21 offset:4096
v_mfma_f32_16x16x32_bf16 v[112:115], v[152:155], v[148:151], v[112:115]
ds_read_b64_tr_b16 v[70:71], v21 offset:6144
ds_read_b64_tr_b16 v[72:73], v22 offset:4096
v_mfma_f32_16x16x32_bf16 v[96:99], v[176:179], v[168:171], v[96:99]
ds_read_b64_tr_b16 v[74:75], v22 offset:6144
ds_read_b64_tr_b16 v[76:77], v23 offset:4096
v_mfma_f32_16x16x32_bf16 v[100:103], v[180:183], v[168:171], v[100:103]
ds_read_b64_tr_b16 v[78:79], v23 offset:6144
ds_read_b128 v[60:63], v3 offset:9216
v_mfma_f32_16x16x32_bf16 v[104:107], v[184:187], v[168:171], v[104:107]
v_cmp_gt_u32 vcc, 8, v198
v_mfma_f32_16x16x32_bf16 v[108:111], v[188:191], v[168:171], v[108:111]
v_lshlrev_b32 v200, 1, v199
v_mfma_f32_16x16x32_bf16 v[124:127], v[188:191], v[172:175], v[124:127]
v_mul_u32_u24 v197, 7168, v197
v_mfma_f32_16x16x32_bf16 v[120:123], v[184:187], v[172:175], v[120:123]
v_cndmask_b32 v199, v199, v200, vcc
v_mfma_f32_16x16x32_bf16 v[116:119], v[180:183], v[172:175], v[116:119]
v_xor_b32 v198, v198, v199
v_mfma_f32_16x16x32_bf16 v[112:115], v[176:179], v[172:175], v[112:115]
v_lshl_add_u32 v193, v198, 4, v197
s_waitcnt lgkmcnt(0)
s_barrier
v_mfma_f32_16x16x32_bf16 v[96:99], v[40:43], v[32:35], v[96:99]
ds_read_b128 v[144:147], v3 offset:49152
ds_read_b64_tr_b16 v[152:153], v20 offset:8192
v_mfma_f32_16x16x32_bf16 v[100:103], v[44:47], v[32:35], v[100:103]
ds_read_b64_tr_b16 v[154:155], v20 offset:10240
ds_read_b64_tr_b16 v[156:157], v21 offset:8192
v_mfma_f32_16x16x32_bf16 v[104:107], v[48:51], v[32:35], v[104:107]
ds_read_b64_tr_b16 v[158:159], v21 offset:10240
ds_read_b64_tr_b16 v[160:161], v22 offset:8192
v_mfma_f32_16x16x32_bf16 v[108:111], v[52:55], v[32:35], v[108:111]
ds_read_b64_tr_b16 v[162:163], v22 offset:10240
ds_read_b64_tr_b16 v[164:165], v23 offset:8192
v_mfma_f32_16x16x32_bf16 v[124:127], v[52:55], v[36:39], v[124:127]
ds_read_b64_tr_b16 v[166:167], v23 offset:10240
ds_read_b128 v[148:151], v3 offset:50176
v_mfma_f32_16x16x32_bf16 v[120:123], v[48:51], v[36:39], v[120:123]
ds_read_b128 v[168:171], v3 offset:57344
ds_read_b64_tr_b16 v[176:177], v20 offset:12288
v_mfma_f32_16x16x32_bf16 v[116:119], v[44:47], v[36:39], v[116:119]
ds_read_b64_tr_b16 v[178:179], v20 offset:14336
ds_read_b64_tr_b16 v[180:181], v21 offset:12288
v_mfma_f32_16x16x32_bf16 v[112:115], v[40:43], v[36:39], v[112:115]
ds_read_b64_tr_b16 v[182:183], v21 offset:14336
ds_read_b64_tr_b16 v[184:185], v22 offset:12288
v_mfma_f32_16x16x32_bf16 v[96:99], v[64:67], v[56:59], v[96:99]
ds_read_b64_tr_b16 v[186:187], v22 offset:14336
ds_read_b64_tr_b16 v[188:189], v23 offset:12288
v_mfma_f32_16x16x32_bf16 v[100:103], v[68:71], v[56:59], v[100:103]
ds_read_b64_tr_b16 v[190:191], v23 offset:14336
ds_read_b128 v[172:175], v3 offset:58368
v_mfma_f32_16x16x32_bf16 v[104:107], v[72:75], v[56:59], v[104:107]
v_add_u32 v196, 128, v1
v_mfma_f32_16x16x32_bf16 v[108:111], v[76:79], v[56:59], v[108:111]
v_mul_u32_u24 v197, 5462, v196
v_mfma_f32_16x16x32_bf16 v[124:127], v[76:79], v[60:63], v[124:127]
v_lshrrev_b32 v197, 16, v197
v_mfma_f32_16x16x32_bf16 v[120:123], v[72:75], v[60:63], v[120:123]
v_mul_u32_u24 v198, 12, v197
v_mfma_f32_16x16x32_bf16 v[116:119], v[68:71], v[60:63], v[116:119]
v_sub_u32 v198, v196, v198
v_mfma_f32_16x16x32_bf16 v[112:115], v[64:67], v[60:63], v[112:115]
v_bfe_u32 v199, v197, 2, 1
s_waitcnt lgkmcnt(0)
s_barrier
v_mfma_f32_16x16x32_bf16 v[96:99], v[152:155], v[144:147], v[96:99]
ds_read_b128 v[32:35], v2 offset:0
ds_read_b64_tr_b16 v[40:41], v4 offset:16384
v_mfma_f32_16x16x32_bf16 v[100:103], v[156:159], v[144:147], v[100:103]
ds_read_b64_tr_b16 v[42:43], v4 offset:18432
ds_read_b64_tr_b16 v[44:45], v5 offset:16384
v_mfma_f32_16x16x32_bf16 v[104:107], v[160:163], v[144:147], v[104:107]
ds_read_b64_tr_b16 v[46:47], v5 offset:18432
ds_read_b64_tr_b16 v[48:49], v6 offset:16384
v_mfma_f32_16x16x32_bf16 v[108:111], v[164:167], v[144:147], v[108:111]
ds_read_b64_tr_b16 v[50:51], v6 offset:18432
ds_read_b64_tr_b16 v[52:53], v7 offset:16384
v_mfma_f32_16x16x32_bf16 v[124:127], v[164:167], v[148:151], v[124:127]
ds_read_b64_tr_b16 v[54:55], v7 offset:18432
ds_read_b128 v[36:39], v2 offset:1024
v_mfma_f32_16x16x32_bf16 v[120:123], v[160:163], v[148:151], v[120:123]
ds_read_b128 v[56:59], v2 offset:8192
ds_read_b64_tr_b16 v[64:65], v4 offset:20480
v_mfma_f32_16x16x32_bf16 v[116:119], v[156:159], v[148:151], v[116:119]
ds_read_b64_tr_b16 v[66:67], v4 offset:22528
ds_read_b64_tr_b16 v[68:69], v5 offset:20480
v_mfma_f32_16x16x32_bf16 v[112:115], v[152:155], v[148:151], v[112:115]
ds_read_b64_tr_b16 v[70:71], v5 offset:22528
ds_read_b64_tr_b16 v[72:73], v6 offset:20480
v_mfma_f32_16x16x32_bf16 v[96:99], v[176:179], v[168:171], v[96:99]
ds_read_b64_tr_b16 v[74:75], v6 offset:22528
ds_read_b64_tr_b16 v[76:77], v7 offset:20480
v_mfma_f32_16x16x32_bf16 v[100:103], v[180:183], v[168:171], v[100:103]
ds_read_b64_tr_b16 v[78:79], v7 offset:22528
ds_read_b128 v[60:63], v2 offset:9216
v_mfma_f32_16x16x32_bf16 v[104:107], v[184:187], v[168:171], v[104:107]
v_cmp_gt_u32 vcc, 8, v198
v_mfma_f32_16x16x32_bf16 v[108:111], v[188:191], v[168:171], v[108:111]
v_lshlrev_b32 v200, 1, v199
v_mfma_f32_16x16x32_bf16 v[124:127], v[188:191], v[172:175], v[124:127]
v_mul_u32_u24 v197, 7168, v197
v_mfma_f32_16x16x32_bf16 v[120:123], v[184:187], v[172:175], v[120:123]
v_cndmask_b32 v199, v199, v200, vcc
v_mfma_f32_16x16x32_bf16 v[116:119], v[180:183], v[172:175], v[116:119]
v_xor_b32 v198, v198, v199
v_mfma_f32_16x16x32_bf16 v[112:115], v[176:179], v[172:175], v[112:115]
v_lshl_add_u32 v194, v198, 4, v197
s_waitcnt lgkmcnt(0)
s_barrier
v_mfma_f32_16x16x32_bf16 v[96:99], v[40:43], v[32:35], v[96:99]
ds_read_b128 v[144:147], v2 offset:49152
ds_read_b64_tr_b16 v[152:153], v4 offset:24576
v_mfma_f32_16x16x32_bf16 v[100:103], v[44:47], v[32:35], v[100:103]
ds_read_b64_tr_b16 v[154:155], v4 offset:26624
ds_read_b64_tr_b16 v[156:157], v5 offset:24576
v_mfma_f32_16x16x32_bf16 v[104:107], v[48:51], v[32:35], v[104:107]
ds_read_b64_tr_b16 v[158:159], v5 offset:26624
ds_read_b64_tr_b16 v[160:161], v6 offset:24576
v_mfma_f32_16x16x32_bf16 v[108:111], v[52:55], v[32:35], v[108:111]
ds_read_b64_tr_b16 v[162:163], v6 offset:26624
ds_read_b64_tr_b16 v[164:165], v7 offset:24576
v_mfma_f32_16x16x32_bf16 v[124:127], v[52:55], v[36:39], v[124:127]
ds_read_b64_tr_b16 v[166:167], v7 offset:26624
ds_read_b128 v[148:151], v2 offset:50176
v_mfma_f32_16x16x32_bf16 v[120:123], v[48:51], v[36:39], v[120:123]
ds_read_b128 v[168:171], v2 offset:57344
ds_read_b64_tr_b16 v[176:177], v4 offset:28672
v_mfma_f32_16x16x32_bf16 v[116:119], v[44:47], v[36:39], v[116:119]
ds_read_b64_tr_b16 v[178:179], v4 offset:30720
ds_read_b64_tr_b16 v[180:181], v5 offset:28672
v_mfma_f32_16x16x32_bf16 v[112:115], v[40:43], v[36:39], v[112:115]
ds_read_b64_tr_b16 v[182:183], v5 offset:30720
ds_read_b64_tr_b16 v[184:185], v6 offset:28672
v_mfma_f32_16x16x32_bf16 v[96:99], v[64:67], v[56:59], v[96:99]
ds_read_b64_tr_b16 v[186:187], v6 offset:30720
ds_read_b64_tr_b16 v[188:189], v7 offset:28672
v_mfma_f32_16x16x32_bf16 v[100:103], v[68:71], v[56:59], v[100:103]
ds_read_b64_tr_b16 v[190:191], v7 offset:30720
ds_read_b128 v[172:175], v2 offset:58368
v_mfma_f32_16x16x32_bf16 v[104:107], v[72:75], v[56:59], v[104:107]
v_add_u32 v192, s43, v192
v_mfma_f32_16x16x32_bf16 v[108:111], v[76:79], v[56:59], v[108:111]
v_add_u32 v193, s43, v193
v_mfma_f32_16x16x32_bf16 v[124:127], v[76:79], v[60:63], v[124:127]
v_add_u32 v194, s43, v194
v_mfma_f32_16x16x32_bf16 v[120:123], v[72:75], v[60:63], v[120:123]
s_and_b32 s43, s36, 3
v_mfma_f32_16x16x32_bf16 v[116:119], v[68:71], v[60:63], v[116:119]
s_mul_i32 s50, s43, 6144
v_mfma_f32_16x16x32_bf16 v[112:115], v[64:67], v[60:63], v[112:115]
s_add_u32 s50, s50, 16384
s_waitcnt lgkmcnt(0)
s_barrier
v_mfma_f32_16x16x32_bf16 v[96:99], v[152:155], v[144:147], v[96:99]
ds_read_b128 v[32:35], v3 offset:0
ds_read_b64_tr_b16 v[40:41], v4 offset:32768
v_mfma_f32_16x16x32_bf16 v[100:103], v[156:159], v[144:147], v[100:103]
ds_read_b64_tr_b16 v[42:43], v4 offset:34816
ds_read_b64_tr_b16 v[44:45], v5 offset:32768
v_mfma_f32_16x16x32_bf16 v[104:107], v[160:163], v[144:147], v[104:107]
ds_read_b64_tr_b16 v[46:47], v5 offset:34816
ds_read_b64_tr_b16 v[48:49], v6 offset:32768
v_mfma_f32_16x16x32_bf16 v[108:111], v[164:167], v[144:147], v[108:111]
ds_read_b64_tr_b16 v[50:51], v6 offset:34816
ds_read_b64_tr_b16 v[52:53], v7 offset:32768
v_mfma_f32_16x16x32_bf16 v[124:127], v[164:167], v[148:151], v[124:127]
ds_read_b64_tr_b16 v[54:55], v7 offset:34816
ds_read_b128 v[36:39], v3 offset:1024
v_mfma_f32_16x16x32_bf16 v[120:123], v[160:163], v[148:151], v[120:123]
ds_read_b128 v[56:59], v3 offset:8192
ds_read_b64_tr_b16 v[64:65], v4 offset:36864
v_mfma_f32_16x16x32_bf16 v[116:119], v[156:159], v[148:151], v[116:119]
ds_read_b64_tr_b16 v[66:67], v4 offset:38912
ds_read_b64_tr_b16 v[68:69], v5 offset:36864
v_mfma_f32_16x16x32_bf16 v[112:115], v[152:155], v[148:151], v[112:115]
ds_read_b64_tr_b16 v[70:71], v5 offset:38912
ds_read_b64_tr_b16 v[72:73], v6 offset:36864
v_mfma_f32_16x16x32_bf16 v[96:99], v[176:179], v[168:171], v[96:99]
ds_read_b64_tr_b16 v[74:75], v6 offset:38912
ds_read_b64_tr_b16 v[76:77], v7 offset:36864
v_mfma_f32_16x16x32_bf16 v[100:103], v[180:183], v[168:171], v[100:103]
ds_read_b64_tr_b16 v[78:79], v7 offset:38912
ds_read_b128 v[60:63], v3 offset:9216
v_mfma_f32_16x16x32_bf16 v[104:107], v[184:187], v[168:171], v[104:107]
s_bitcmp0_b32 s2, 0
v_mfma_f32_16x16x32_bf16 v[108:111], v[188:191], v[168:171], v[108:111]
s_cselect_b32 s88, s72, s74
v_mfma_f32_16x16x32_bf16 v[124:127], v[188:191], v[172:175], v[124:127]
s_cselect_b32 s89, s73, s75
v_mfma_f32_16x16x32_bf16 v[120:123], v[184:187], v[172:175], v[120:123]
s_mov_b32 s90, 7340032
v_mfma_f32_16x16x32_bf16 v[116:119], v[180:183], v[172:175], v[116:119]
s_mov_b32 s91, 0x20000
v_mfma_f32_16x16x32_bf16 v[112:115], v[176:179], v[172:175], v[112:115]
s_bfe_u32 s44, s2, 0x30001
s_waitcnt lgkmcnt(0)
s_barrier
v_mfma_f32_16x16x32_bf16 v[96:99], v[40:43], v[32:35], v[96:99]
ds_read_b128 v[144:147], v3 offset:49152
ds_read_b64_tr_b16 v[152:153], v4 offset:40960
v_mfma_f32_16x16x32_bf16 v[100:103], v[44:47], v[32:35], v[100:103]
ds_read_b64_tr_b16 v[154:155], v4 offset:43008
ds_read_b64_tr_b16 v[156:157], v5 offset:40960
v_mfma_f32_16x16x32_bf16 v[104:107], v[48:51], v[32:35], v[104:107]
ds_read_b64_tr_b16 v[158:159], v5 offset:43008
ds_read_b64_tr_b16 v[160:161], v6 offset:40960
v_mfma_f32_16x16x32_bf16 v[108:111], v[52:55], v[32:35], v[108:111]
ds_read_b64_tr_b16 v[162:163], v6 offset:43008
ds_read_b64_tr_b16 v[164:165], v7 offset:40960
v_mfma_f32_16x16x32_bf16 v[124:127], v[52:55], v[36:39], v[124:127]
ds_read_b64_tr_b16 v[166:167], v7 offset:43008
ds_read_b128 v[148:151], v3 offset:50176
v_mfma_f32_16x16x32_bf16 v[120:123], v[48:51], v[36:39], v[120:123]
ds_read_b128 v[168:171], v3 offset:57344
ds_read_b64_tr_b16 v[176:177], v4 offset:45056
v_mfma_f32_16x16x32_bf16 v[116:119], v[44:47], v[36:39], v[116:119]
ds_read_b64_tr_b16 v[178:179], v4 offset:47104
ds_read_b64_tr_b16 v[180:181], v5 offset:45056
v_mfma_f32_16x16x32_bf16 v[112:115], v[40:43], v[36:39], v[112:115]
ds_read_b64_tr_b16 v[182:183], v5 offset:47104
ds_read_b64_tr_b16 v[184:185], v6 offset:45056
v_mfma_f32_16x16x32_bf16 v[96:99], v[64:67], v[56:59], v[96:99]
ds_read_b64_tr_b16 v[186:187], v6 offset:47104
ds_read_b64_tr_b16 v[188:189], v7 offset:45056
v_mfma_f32_16x16x32_bf16 v[100:103], v[68:71], v[56:59], v[100:103]
ds_read_b64_tr_b16 v[190:191], v7 offset:47104
ds_read_b128 v[172:175], v3 offset:58368
v_mfma_f32_16x16x32_bf16 v[104:107], v[72:75], v[56:59], v[104:107]
s_lshl_b32 s44, s44, 2
v_mfma_f32_16x16x32_bf16 v[108:111], v[76:79], v[56:59], v[108:111]
s_and_b32 s43, s36, 3
v_mfma_f32_16x16x32_bf16 v[124:127], v[76:79], v[60:63], v[124:127]
s_add_u32 s44, s44, s43
v_mfma_f32_16x16x32_bf16 v[120:123], v[72:75], v[60:63], v[120:123]
s_lshl_b32 s44, s44, 5
v_mfma_f32_16x16x32_bf16 v[116:119], v[68:71], v[60:63], v[116:119]
v_lshrrev_b32 v195, 4, v1
v_mfma_f32_16x16x32_bf16 v[112:115], v[64:67], v[60:63], v[112:115]
v_add_u32 v195, s44, v195
s_waitcnt lgkmcnt(0)
s_barrier
v_mfma_f32_16x16x32_bf16 v[96:99], v[152:155], v[144:147], v[96:99]
ds_read_b128 v[32:35], v2 offset:0
ds_read_b64_tr_b16 v[40:41], v16 offset:49152
v_mfma_f32_16x16x32_bf16 v[100:103], v[156:159], v[144:147], v[100:103]
ds_read_b64_tr_b16 v[42:43], v16 offset:51200
ds_read_b64_tr_b16 v[44:45], v17 offset:49152
v_mfma_f32_16x16x32_bf16 v[104:107], v[160:163], v[144:147], v[104:107]
ds_read_b64_tr_b16 v[46:47], v17 offset:51200
ds_read_b64_tr_b16 v[48:49], v18 offset:49152
v_mfma_f32_16x16x32_bf16 v[108:111], v[164:167], v[144:147], v[108:111]
ds_read_b64_tr_b16 v[50:51], v18 offset:51200
ds_read_b64_tr_b16 v[52:53], v19 offset:49152
v_mfma_f32_16x16x32_bf16 v[124:127], v[164:167], v[148:151], v[124:127]
ds_read_b64_tr_b16 v[54:55], v19 offset:51200
ds_read_b128 v[36:39], v2 offset:1024
v_mfma_f32_16x16x32_bf16 v[120:123], v[160:163], v[148:151], v[120:123]
ds_read_b128 v[56:59], v2 offset:8192
ds_read_b64_tr_b16 v[64:65], v16 offset:53248
v_mfma_f32_16x16x32_bf16 v[116:119], v[156:159], v[148:151], v[116:119]
ds_read_b64_tr_b16 v[66:67], v16 offset:55296
ds_read_b64_tr_b16 v[68:69], v17 offset:53248
v_mfma_f32_16x16x32_bf16 v[112:115], v[152:155], v[148:151], v[112:115]
ds_read_b64_tr_b16 v[70:71], v17 offset:55296
ds_read_b64_tr_b16 v[72:73], v18 offset:53248
v_mfma_f32_16x16x32_bf16 v[96:99], v[176:179], v[168:171], v[96:99]
ds_read_b64_tr_b16 v[74:75], v18 offset:55296
ds_read_b64_tr_b16 v[76:77], v19 offset:53248
v_mfma_f32_16x16x32_bf16 v[100:103], v[180:183], v[168:171], v[100:103]
ds_read_b64_tr_b16 v[78:79], v19 offset:55296
ds_read_b128 v[60:63], v2 offset:9216
v_mfma_f32_16x16x32_bf16 v[104:107], v[184:187], v[168:171], v[104:107]
v_mul_u32_u24 v195, 7168, v195
v_mfma_f32_16x16x32_bf16 v[108:111], v[188:191], v[168:171], v[108:111]
v_and_b32 v196, 15, v1
v_mfma_f32_16x16x32_bf16 v[124:127], v[188:191], v[172:175], v[124:127]
v_lshl_add_u32 v195, v196, 4, v195
v_mfma_f32_16x16x32_bf16 v[120:123], v[184:187], v[172:175], v[120:123]
s_lshr_b32 s43, s2, 4
v_mfma_f32_16x16x32_bf16 v[116:119], v[180:183], v[172:175], v[116:119]
s_lshl_b32 s43, s43, 8
v_mfma_f32_16x16x32_bf16 v[112:115], v[176:179], v[172:175], v[112:115]
v_add_u32 v195, s43, v195
s_waitcnt lgkmcnt(0)
s_barrier
v_mfma_f32_16x16x32_bf16 v[96:99], v[40:43], v[32:35], v[96:99]
ds_read_b128 v[144:147], v2 offset:49152
ds_read_b64_tr_b16 v[152:153], v16 offset:57344
v_mfma_f32_16x16x32_bf16 v[100:103], v[44:47], v[32:35], v[100:103]
ds_read_b64_tr_b16 v[154:155], v16 offset:59392
ds_read_b64_tr_b16 v[156:157], v17 offset:57344
v_mfma_f32_16x16x32_bf16 v[104:107], v[48:51], v[32:35], v[104:107]
ds_read_b64_tr_b16 v[158:159], v17 offset:59392
ds_read_b64_tr_b16 v[160:161], v18 offset:57344
v_mfma_f32_16x16x32_bf16 v[108:111], v[52:55], v[32:35], v[108:111]
ds_read_b64_tr_b16 v[162:163], v18 offset:59392
ds_read_b64_tr_b16 v[164:165], v19 offset:57344
v_mfma_f32_16x16x32_bf16 v[124:127], v[52:55], v[36:39], v[124:127]
ds_read_b64_tr_b16 v[166:167], v19 offset:59392
ds_read_b128 v[148:151], v2 offset:50176
v_mfma_f32_16x16x32_bf16 v[120:123], v[48:51], v[36:39], v[120:123]
ds_read_b128 v[168:171], v2 offset:57344
ds_read_b64_tr_b16 v[176:177], v16 offset:61440
v_mfma_f32_16x16x32_bf16 v[116:119], v[44:47], v[36:39], v[116:119]
ds_read_b64_tr_b16 v[178:179], v16 offset:63488
ds_read_b64_tr_b16 v[180:181], v17 offset:61440
v_mfma_f32_16x16x32_bf16 v[112:115], v[40:43], v[36:39], v[112:115]
ds_read_b64_tr_b16 v[182:183], v17 offset:63488
ds_read_b64_tr_b16 v[184:185], v18 offset:61440
v_mfma_f32_16x16x32_bf16 v[96:99], v[64:67], v[56:59], v[96:99]
ds_read_b64_tr_b16 v[186:187], v18 offset:63488
ds_read_b64_tr_b16 v[188:189], v19 offset:61440
v_mfma_f32_16x16x32_bf16 v[100:103], v[68:71], v[56:59], v[100:103]
ds_read_b64_tr_b16 v[190:191], v19 offset:63488
ds_read_b128 v[172:175], v2 offset:58368
v_mfma_f32_16x16x32_bf16 v[104:107], v[72:75], v[56:59], v[104:107]
v_mfma_f32_16x16x32_bf16 v[108:111], v[76:79], v[56:59], v[108:111]
v_mfma_f32_16x16x32_bf16 v[124:127], v[76:79], v[60:63], v[124:127]
s_branch Lov_6
.p2align 12
.fill 48, 4, 0xbf800000
Lst_6_0:
s_branch Lwr_166
s_nop 0
s_nop 0
Lov_6:
v_mfma_f32_16x16x32_bf16 v[120:123], v[72:75], v[60:63], v[120:123]
v_mfma_f32_16x16x32_bf16 v[116:119], v[68:71], v[60:63], v[116:119]
v_mfma_f32_16x16x32_bf16 v[112:115], v[64:67], v[60:63], v[112:115]
s_waitcnt lgkmcnt(0)
s_barrier
v_mfma_f32_16x16x32_bf16 v[96:99], v[152:155], v[144:147], v[96:99]
ds_read_b128 v[32:35], v3 offset:0
ds_read_b64_tr_b16 v[40:41], v20 offset:0
v_mfma_f32_16x16x32_bf16 v[100:103], v[156:159], v[144:147], v[100:103]
ds_read_b64_tr_b16 v[42:43], v20 offset:2048
ds_read_b64_tr_b16 v[44:45], v21 offset:0
v_mfma_f32_16x16x32_bf16 v[104:107], v[160:163], v[144:147], v[104:107]
ds_read_b64_tr_b16 v[46:47], v21 offset:2048
ds_read_b64_tr_b16 v[48:49], v22 offset:0
v_mfma_f32_16x16x32_bf16 v[108:111], v[164:167], v[144:147], v[108:111]
ds_read_b64_tr_b16 v[50:51], v22 offset:2048
ds_read_b64_tr_b16 v[52:53], v23 offset:0
v_mfma_f32_16x16x32_bf16 v[124:127], v[164:167], v[148:151], v[124:127]
ds_read_b64_tr_b16 v[54:55], v23 offset:2048
ds_read_b128 v[36:39], v3 offset:1024
v_mfma_f32_16x16x32_bf16 v[120:123], v[160:163], v[148:151], v[120:123]
ds_read_b128 v[56:59], v3 offset:8192
ds_read_b64_tr_b16 v[64:65], v20 offset:4096
v_mfma_f32_16x16x32_bf16 v[116:119], v[156:159], v[148:151], v[116:119]
ds_read_b64_tr_b16 v[66:67], v20 offset:6144
ds_read_b64_tr_b16 v[68:69], v21 offset:4096
v_mfma_f32_16x16x32_bf16 v[112:115], v[152:155], v[148:151], v[112:115]
ds_read_b64_tr_b16 v[70:71], v21 offset:6144
ds_read_b64_tr_b16 v[72:73], v22 offset:4096
v_mfma_f32_16x16x32_bf16 v[96:99], v[176:179], v[168:171], v[96:99]
ds_read_b64_tr_b16 v[74:75], v22 offset:6144
ds_read_b64_tr_b16 v[76:77], v23 offset:4096
v_mfma_f32_16x16x32_bf16 v[100:103], v[180:183], v[168:171], v[100:103]
ds_read_b64_tr_b16 v[78:79], v23 offset:6144
ds_read_b128 v[60:63], v3 offset:9216
v_mfma_f32_16x16x32_bf16 v[104:107], v[184:187], v[168:171], v[104:107]
v_mfma_f32_16x16x32_bf16 v[108:111], v[188:191], v[168:171], v[108:111]
v_mfma_f32_16x16x32_bf16 v[124:127], v[188:191], v[172:175], v[124:127]
v_mfma_f32_16x16x32_bf16 v[120:123], v[184:187], v[172:175], v[120:123]
v_mfma_f32_16x16x32_bf16 v[116:119], v[180:183], v[172:175], v[116:119]
v_mfma_f32_16x16x32_bf16 v[112:115], v[176:179], v[172:175], v[112:115]
s_waitcnt lgkmcnt(0)
v_mfma_f32_16x16x32_bf16 v[96:99], v[40:43], v[32:35], v[96:99]
ds_read_b128 v[144:147], v3 offset:49152
ds_read_b64_tr_b16 v[152:153], v20 offset:8192
v_mfma_f32_16x16x32_bf16 v[100:103], v[44:47], v[32:35], v[100:103]
ds_read_b64_tr_b16 v[154:155], v20 offset:10240
ds_read_b64_tr_b16 v[156:157], v21 offset:8192
v_mfma_f32_16x16x32_bf16 v[104:107], v[48:51], v[32:35], v[104:107]
ds_read_b64_tr_b16 v[158:159], v21 offset:10240
ds_read_b64_tr_b16 v[160:161], v22 offset:8192
v_mfma_f32_16x16x32_bf16 v[108:111], v[52:55], v[32:35], v[108:111]
ds_read_b64_tr_b16 v[162:163], v22 offset:10240
ds_read_b64_tr_b16 v[164:165], v23 offset:8192
v_mfma_f32_16x16x32_bf16 v[124:127], v[52:55], v[36:39], v[124:127]
ds_read_b64_tr_b16 v[166:167], v23 offset:10240
ds_read_b128 v[148:151], v3 offset:50176
v_mfma_f32_16x16x32_bf16 v[120:123], v[48:51], v[36:39], v[120:123]
ds_read_b128 v[168:171], v3 offset:57344
ds_read_b64_tr_b16 v[176:177], v20 offset:12288
v_mfma_f32_16x16x32_bf16 v[116:119], v[44:47], v[36:39], v[116:119]
ds_read_b64_tr_b16 v[178:179], v20 offset:14336
ds_read_b64_tr_b16 v[180:181], v21 offset:12288
v_mfma_f32_16x16x32_bf16 v[112:115], v[40:43], v[36:39], v[112:115]
ds_read_b64_tr_b16 v[182:183], v21 offset:14336
ds_read_b64_tr_b16 v[184:185], v22 offset:12288
v_mfma_f32_16x16x32_bf16 v[96:99], v[64:67], v[56:59], v[96:99]
ds_read_b64_tr_b16 v[186:187], v22 offset:14336
ds_read_b64_tr_b16 v[188:189], v23 offset:12288
v_mfma_f32_16x16x32_bf16 v[100:103], v[68:71], v[56:59], v[100:103]
ds_read_b64_tr_b16 v[190:191], v23 offset:14336
ds_read_b128 v[172:175], v3 offset:58368
v_mfma_f32_16x16x32_bf16 v[104:107], v[72:75], v[56:59], v[104:107]
v_mfma_f32_16x16x32_bf16 v[108:111], v[76:79], v[56:59], v[108:111]
v_mfma_f32_16x16x32_bf16 v[124:127], v[76:79], v[60:63], v[124:127]
v_mfma_f32_16x16x32_bf16 v[120:123], v[72:75], v[60:63], v[120:123]
v_mfma_f32_16x16x32_bf16 v[116:119], v[68:71], v[60:63], v[116:119]
v_mfma_f32_16x16x32_bf16 v[112:115], v[64:67], v[60:63], v[112:115]
s_waitcnt lgkmcnt(0)
v_mfma_f32_16x16x32_bf16 v[96:99], v[152:155], v[144:147], v[96:99]
v_mfma_f32_16x16x32_bf16 v[100:103], v[156:159], v[144:147], v[100:103]
v_mfma_f32_16x16x32_bf16 v[104:107], v[160:163], v[144:147], v[104:107]
v_mfma_f32_16x16x32_bf16 v[108:111], v[164:167], v[144:147], v[108:111]
v_mfma_f32_16x16x32_bf16 v[124:127], v[164:167], v[148:151], v[124:127]
v_mfma_f32_16x16x32_bf16 v[120:123], v[160:163], v[148:151], v[120:123]
v_mfma_f32_16x16x32_bf16 v[116:119], v[156:159], v[148:151], v[116:119]
v_mfma_f32_16x16x32_bf16 v[112:115], v[152:155], v[148:151], v[112:115]
v_mfma_f32_16x16x32_bf16 v[96:99], v[176:179], v[168:171], v[96:99]
v_mfma_f32_16x16x32_bf16 v[100:103], v[180:183], v[168:171], v[100:103]
v_mfma_f32_16x16x32_bf16 v[104:107], v[184:187], v[168:171], v[104:107]
v_mfma_f32_16x16x32_bf16 v[108:111], v[188:191], v[168:171], v[108:111]
v_mfma_f32_16x16x32_bf16 v[124:127], v[188:191], v[172:175], v[124:127]
v_mfma_f32_16x16x32_bf16 v[120:123], v[184:187], v[172:175], v[120:123]
v_mfma_f32_16x16x32_bf16 v[116:119], v[180:183], v[172:175], v[116:119]
v_mfma_f32_16x16x32_bf16 v[112:115], v[176:179], v[172:175], v[112:115]
s_nop 3
v_cvt_pk_bf16_f32 v32, v96, v97
v_cvt_pk_bf16_f32 v33, v98, v99
v_cvt_pk_bf16_f32 v34, v100, v101
v_cvt_pk_bf16_f32 v35, v102, v103
s_add_u32 s43, s60, 0
buffer_store_dwordx4 v[32:35], v11, s[20:23], s43 offen offset:0 sc1
v_cvt_pk_bf16_f32 v36, v104, v105
v_cvt_pk_bf16_f32 v37, v106, v107
v_cvt_pk_bf16_f32 v38, v108, v109
v_cvt_pk_bf16_f32 v39, v110, v111
s_add_u32 s43, s60, 8192
buffer_store_dwordx4 v[36:39], v11, s[20:23], s43 offen offset:0 sc1
v_cvt_pk_bf16_f32 v44, v120, v121
v_cvt_pk_bf16_f32 v45, v122, v123
v_cvt_pk_bf16_f32 v46, v124, v125
v_cvt_pk_bf16_f32 v47, v126, v127
s_add_u32 s43, s60, 8192
buffer_store_dwordx4 v[44:47], v11, s[20:23], s43 offen offset:1024 sc1
v_cvt_pk_bf16_f32 v40, v112, v113
v_cvt_pk_bf16_f32 v41, v114, v115
v_cvt_pk_bf16_f32 v42, v116, v117
v_cvt_pk_bf16_f32 v43, v118, v119
s_add_u32 s43, s60, 0
buffer_store_dwordx4 v[40:43], v11, s[20:23], s43 offen offset:1024 sc1
v_mov_b32 v64, 0
v_mov_b32 v65, 0
v_mov_b32 v66, 0
v_mov_b32 v67, 0
v_mov_b32 v68, 0
v_mov_b32 v69, 0
v_mov_b32 v70, 0
v_mov_b32 v71, 0
v_dot2_f32_bf16 v64, v32, s61, v64
v_dot2_f32_bf16 v66, v32, v32, v66
v_dot2_f32_bf16 v68, v40, s61, v68
v_dot2_f32_bf16 v70, v40, v40, v70
v_dot2_f32_bf16 v65, v33, s61, v65
v_dot2_f32_bf16 v67, v33, v33, v67
v_dot2_f32_bf16 v69, v41, s61, v69
v_dot2_f32_bf16 v71, v41, v41, v71
v_dot2_f32_bf16 v64, v34, s61, v64
v_dot2_f32_bf16 v66, v34, v34, v66
v_dot2_f32_bf16 v68, v42, s61, v68
v_dot2_f32_bf16 v70, v42, v42, v70
v_dot2_f32_bf16 v65, v35, s61, v65
v_dot2_f32_bf16 v67, v35, v35, v67
v_dot2_f32_bf16 v69, v43, s61, v69
v_dot2_f32_bf16 v71, v43, v43, v71
v_dot2_f32_bf16 v64, v36, s61, v64
v_dot2_f32_bf16 v66, v36, v36, v66
v_dot2_f32_bf16 v68, v44, s61, v68
v_dot2_f32_bf16 v70, v44, v44, v70
v_dot2_f32_bf16 v65, v37, s61, v65
v_dot2_f32_bf16 v67, v37, v37, v67
v_dot2_f32_bf16 v69, v45, s61, v69
v_dot2_f32_bf16 v71, v45, v45, v71
v_dot2_f32_bf16 v64, v38, s61, v64
v_dot2_f32_bf16 v66, v38, v38, v66
v_dot2_f32_bf16 v68, v46, s61, v68
v_dot2_f32_bf16 v70, v46, v46, v70
v_dot2_f32_bf16 v65, v39, s61, v65
v_dot2_f32_bf16 v67, v39, v39, v67
v_dot2_f32_bf16 v69, v47, s61, v69
v_dot2_f32_bf16 v71, v47, v47, v71
s_nop 2
v_add_f32 v64, v64, v65
v_add_f32 v66, v66, v67
v_add_f32 v68, v68, v69
v_add_f32 v70, v70, v71
s_nop 1
v_permlane32_swap_b32 v64, v68
v_permlane32_swap_b32 v66, v70
v_add_f32 v64, v64, v68
v_add_f32 v66, v66, v70
s_nop 1
v_permlane16_swap_b32 v64, v66
v_add_f32 v64, v64, v66
buffer_store_dword v64, v9, s[24:27], 0 offen sc1
s_lshl_b32 s7, s34, 12
s_add_u32 s7, s7, 49280
v_lshl_add_u32 v4, v1, 8, s7
v_mov_b32 v5, 1
s_waitcnt vmcnt(0)
s_cmp_lg_u32 s36, 0
s_barrier
s_cbranch_scc1 Lk2end_98
s_mov_b64 exec, 0xffff
buffer_atomic_add v5, v4, s[56:59], 0 offen sc1
s_mov_b64 exec, -1
s_branch Lk2end_98
Lprod_99:
s_mul_i32 s43, s34, 262144
s_add_u32 s8, s82, s43
s_addc_u32 s9, s83, 0
s_mov_b32 s10, 262144
s_mov_b32 s11, 0x20000
s_lshl_b32 s43, s35, 7
s_add_u32 s12, s68, s43
s_addc_u32 s13, s69, 0
s_mov_b32 s14, 2095232
s_mov_b32 s15, 0x20000
s_and_b32 s47, s36, 3
s_lshl_b32 s39, s47, 12
v_lshlrev_b32 v2, 4, v1
v_add_u32 v2, s39, v2
v_lshrrev_b32 v12, 3, v1
v_and_b32 v13, 6, v12
v_and_b32 v3, 7, v1
v_xor_b32 v3, v3, v13
v_lshlrev_b32 v3, 4, v3
v_mul_u32_u24 v12, 2048, v12
v_add_u32 v3, v3, v12
s_lshl_b32 s43, s47, 15
v_add_u32 v3, s43, v3
s_lshl_b32 s40, s47, 11
s_add_u32 s37, s35, 0
s_and_b32 s37, s37, 15
s_lshl_b32 s37, s37, 14
s_add_u32 m0, s39, 0
s_nop 0
buffer_load_dwordx4 v2, s[8:11], s37 offen offset:0 sc1 lds
buffer_load_dwordx4 v2, s[8:11], s37 offen offset:1024 sc1 lds
buffer_load_dwordx4 v2, s[8:11], s37 offen offset:2048 sc1 lds
buffer_load_dwordx4 v2, s[8:11], s37 offen offset:3072 sc1 lds
s_add_u32 s38, s35, 8
s_and_b32 s38, s38, 15
s_lshl_b32 s38, s38, 17
s_add_u32 m0, s40, 16384
s_nop 0
buffer_load_dwordx4 v3, s[12:15], s38 offen lds
s_add_u32 m0, s40, 17408
s_add_u32 s38, s38, 16384
buffer_load_dwordx4 v3, s[12:15], s38 offen lds
s_add_u32 s38, s35, 9
s_and_b32 s38, s38, 15
s_lshl_b32 s38, s38, 17
s_add_u32 m0, s40, 24576
s_nop 0
buffer_load_dwordx4 v3, s[12:15], s38 offen lds
s_add_u32 m0, s40, 25600
s_add_u32 s38, s38, 16384
buffer_load_dwordx4 v3, s[12:15], s38 offen lds
s_add_u32 s38, s35, 10
s_and_b32 s38, s38, 15
s_lshl_b32 s38, s38, 17
s_add_u32 m0, s40, 32768
s_nop 0
buffer_load_dwordx4 v3, s[12:15], s38 offen lds
s_add_u32 m0, s40, 33792
s_add_u32 s38, s38, 16384
buffer_load_dwordx4 v3, s[12:15], s38 offen lds
s_add_u32 s38, s35, 11
s_and_b32 s38, s38, 15
s_lshl_b32 s38, s38, 17
s_add_u32 m0, s40, 40960
s_nop 0
buffer_load_dwordx4 v3, s[12:15], s38 offen lds
s_add_u32 m0, s40, 41984
s_add_u32 s38, s38, 16384
buffer_load_dwordx4 v3, s[12:15], s38 offen lds
s_bitcmp0_b32 s36, 1
s_cselect_b32 s44, s72, s74
s_cselect_b32 s45, s73, s75
s_mul_i32 s43, s35, 192
s_add_u32 s16, s44, s43
s_addc_u32 s17, s45, 0
s_add_u32 s16, s16, 4096
s_addc_u32 s17, s17, 0
s_mov_b32 s18, 7333056
s_mov_b32 s19, 0x20000
s_and_b32 s43, s36, 1
s_mul_i32 s43, s43, 229376
v_add_u32 v196, 0, v1
v_mul_u32_u24 v197, 5462, v196
v_lshrrev_b32 v197, 16, v197
v_mul_u32_u24 v198, 12, v197
v_sub_u32 v198, v196, v198
v_bfe_u32 v199, v197, 2, 1
v_cmp_gt_u32 vcc, 8, v198
v_lshlrev_b32 v200, 1, v199
v_mul_u32_u24 v197, 7168, v197
v_cndmask_b32 v199, v199, v200, vcc
v_xor_b32 v198, v198, v199
v_lshl_add_u32 v192, v198, 4, v197
v_add_u32 v196, 64, v1
v_mul_u32_u24 v197, 5462, v196
v_lshrrev_b32 v197, 16, v197
v_mul_u32_u24 v198, 12, v197
v_sub_u32 v198, v196, v198
v_bfe_u32 v199, v197, 2, 1
v_cmp_gt_u32 vcc, 8, v198
v_lshlrev_b32 v200, 1, v199
v_mul_u32_u24 v197, 7168, v197
v_cndmask_b32 v199, v199, v200, vcc
v_xor_b32 v198, v198, v199
v_lshl_add_u32 v193, v198, 4, v197
v_add_u32 v196, 128, v1
v_mul_u32_u24 v197, 5462, v196
v_lshrrev_b32 v197, 16, v197
v_mul_u32_u24 v198, 12, v197
v_sub_u32 v198, v196, v198
v_bfe_u32 v199, v197, 2, 1
v_cmp_gt_u32 vcc, 8, v198
v_lshlrev_b32 v200, 1, v199
v_mul_u32_u24 v197, 7168, v197
v_cndmask_b32 v199, v199, v200, vcc
v_xor_b32 v198, v198, v199
v_lshl_add_u32 v194, v198, 4, v197
v_add_u32 v192, s43, v192
v_add_u32 v193, s43, v193
v_add_u32 v194, s43, v194
s_and_b32 s43, s36, 3
s_mul_i32 s50, s43, 6144
s_add_u32 s50, s50, 16384
s_cmp_eq_u32 s47, 3
s_cbranch_scc0 Lw_106
s_lshl_b32 s92, s34, 4
s_add_u32 s92, s92, s35
s_lshl_b32 s92, s92, 8
s_add_u32 s92, s92, 49152
s_add_u32 s92, s92, 28311552
s_mov_b32 s41, 0x40000
Lpoll_107:
s_load_dword s93, s[82:83], s92 glc
Lpchk_109:
s_waitcnt lgkmcnt(0)
s_cmp_eq_u32 s93, 16
s_cbranch_scc1 Lpok_108
s_sub_u32 s41, s41, 1
s_cmp_lg_u32 s41, 0
s_cbranch_scc1 Lpoll_107
Lpok_108:
Lw_106:
s_and_b32 s44, s36, 3
s_mul_i32 s44, s44, 11
s_bfe_u32 s43, s2, 0x30001
s_lshl_b32 s43, s43, 7
s_add_u32 s44, s44, s43
s_add_u32 s44, s44, 84
s_mul_i32 s44, s44, 7168
s_lshr_b32 s43, s2, 4
s_lshl_b32 s43, s43, 8
s_add_u32 s43, s43, s44
s_bitcmp0_b32 s2, 0
s_cselect_b32 s4, s72, s74
s_cselect_b32 s5, s73, s75
s_add_u32 s4, s4, s43
s_addc_u32 s5, s5, 0
s_cmp_eq_u32 s47, 3
s_cbranch_scc1 Lw_110
Lw_110:
s_waitcnt vmcnt(8)
s_barrier
s_add_u32 s37, s35, 1
s_and_b32 s37, s37, 15
s_lshl_b32 s37, s37, 14
s_add_u32 m0, s39, 49152
s_nop 0
buffer_load_dwordx4 v2, s[8:11], s37 offen offset:0 sc1 lds
buffer_load_dwordx4 v2, s[8:11], s37 offen offset:1024 sc1 lds
buffer_load_dwordx4 v2, s[8:11], s37 offen offset:2048 sc1 lds
buffer_load_dwordx4 v2, s[8:11], s37 offen offset:3072 sc1 lds
s_add_u32 s37, s35, 2
s_and_b32 s37, s37, 15
s_lshl_b32 s37, s37, 14
s_add_u32 m0, s39, 98304
s_nop 0
buffer_load_dwordx4 v2, s[8:11], s37 offen offset:0 sc1 lds
buffer_load_dwordx4 v2, s[8:11], s37 offen offset:1024 sc1 lds
buffer_load_dwordx4 v2, s[8:11], s37 offen offset:2048 sc1 lds
buffer_load_dwordx4 v2, s[8:11], s37 offen offset:3072 sc1 lds
s_add_u32 s37, s35, 3
s_and_b32 s37, s37, 15
s_lshl_b32 s37, s37, 14
s_add_u32 m0, s39, 147456
s_nop 0
buffer_load_dwordx4 v2, s[8:11], s37 offen offset:0 sc1 lds
buffer_load_dwordx4 v2, s[8:11], s37 offen offset:1024 sc1 lds
buffer_load_dwordx4 v2, s[8:11], s37 offen offset:2048 sc1 lds
buffer_load_dwordx4 v2, s[8:11], s37 offen offset:3072 sc1 lds
s_cmp_eq_u32 s47, 3
s_cbranch_scc0 Lw_111
Lw_111:
s_waitcnt vmcnt(8)
s_barrier
s_add_u32 s37, s35, 4
s_and_b32 s37, s37, 15
s_lshl_b32 s37, s37, 14
s_add_u32 m0, s39, 0
s_nop 0
buffer_load_dwordx4 v2, s[8:11], s37 offen offset:0 sc1 lds
buffer_load_dwordx4 v2, s[8:11], s37 offen offset:1024 sc1 lds
buffer_load_dwordx4 v2, s[8:11], s37 offen offset:2048 sc1 lds
buffer_load_dwordx4 v2, s[8:11], s37 offen offset:3072 sc1 lds
s_waitcnt vmcnt(8)
s_barrier
s_add_u32 s37, s35, 5
s_and_b32 s37, s37, 15
s_lshl_b32 s37, s37, 14
s_add_u32 m0, s39, 49152
s_nop 0
buffer_load_dwordx4 v2, s[8:11], s37 offen offset:0 sc1 lds
buffer_load_dwordx4 v2, s[8:11], s37 offen offset:1024 sc1 lds
buffer_load_dwordx4 v2, s[8:11], s37 offen offset:2048 sc1 lds
buffer_load_dwordx4 v2, s[8:11], s37 offen offset:3072 sc1 lds
s_waitcnt vmcnt(8)
s_barrier
s_add_u32 s37, s35, 6
s_and_b32 s37, s37, 15
s_lshl_b32 s37, s37, 14
s_add_u32 m0, s39, 98304
s_nop 0
buffer_load_dwordx4 v2, s[8:11], s37 offen offset:0 sc1 lds
buffer_load_dwordx4 v2, s[8:11], s37 offen offset:1024 sc1 lds
buffer_load_dwordx4 v2, s[8:11], s37 offen offset:2048 sc1 lds
buffer_load_dwordx4 v2, s[8:11], s37 offen offset:3072 sc1 lds
s_waitcnt vmcnt(8)
s_barrier
s_add_u32 s37, s35, 7
s_and_b32 s37, s37, 15
s_lshl_b32 s37, s37, 14
s_add_u32 m0, s39, 147456
s_nop 0
buffer_load_dwordx4 v2, s[8:11], s37 offen offset:0 sc1 lds
buffer_load_dwordx4 v2, s[8:11], s37 offen offset:1024 sc1 lds
buffer_load_dwordx4 v2, s[8:11], s37 offen offset:2048 sc1 lds
buffer_load_dwordx4 v2, s[8:11], s37 offen offset:3072 sc1 lds
s_waitcnt vmcnt(8)
s_barrier
s_add_u32 s37, s35, 8
s_and_b32 s37, s37, 15
s_lshl_b32 s37, s37, 14
s_add_u32 m0, s39, 0
s_nop 0
buffer_load_dwordx4 v2, s[8:11], s37 offen offset:0 sc1 lds
buffer_load_dwordx4 v2, s[8:11], s37 offen offset:1024 sc1 lds
buffer_load_dwordx4 v2, s[8:11], s37 offen offset:2048 sc1 lds
buffer_load_dwordx4 v2, s[8:11], s37 offen offset:3072 sc1 lds
s_add_u32 s38, s35, 12
s_and_b32 s38, s38, 15
s_lshl_b32 s38, s38, 17
s_add_u32 m0, s40, 114688
s_nop 0
buffer_load_dwordx4 v3, s[12:15], s38 offen lds
s_add_u32 m0, s40, 115712
s_add_u32 s38, s38, 16384
buffer_load_dwordx4 v3, s[12:15], s38 offen lds
s_waitcnt vmcnt(10)
s_barrier
s_add_u32 s37, s35, 9
s_and_b32 s37, s37, 15
s_lshl_b32 s37, s37, 14
s_add_u32 m0, s39, 49152
s_nop 0
buffer_load_dwordx4 v2, s[8:11], s37 offen offset:0 sc1 lds
buffer_load_dwordx4 v2, s[8:11], s37 offen offset:1024 sc1 lds
buffer_load_dwordx4 v2, s[8:11], s37 offen offset:2048 sc1 lds
buffer_load_dwordx4 v2, s[8:11], s37 offen offset:3072 sc1 lds
s_add_u32 s38, s35, 13
s_and_b32 s38, s38, 15
s_lshl_b32 s38, s38, 17
s_add_u32 m0, s40, 122880
s_nop 0
buffer_load_dwordx4 v3, s[12:15], s38 offen lds
s_add_u32 m0, s40, 123904
s_add_u32 s38, s38, 16384
buffer_load_dwordx4 v3, s[12:15], s38 offen lds
s_waitcnt vmcnt(12)
s_barrier
s_add_u32 s37, s35, 10
s_and_b32 s37, s37, 15
s_lshl_b32 s37, s37, 14
s_add_u32 m0, s39, 98304
s_nop 0
buffer_load_dwordx4 v2, s[8:11], s37 offen offset:0 sc1 lds
buffer_load_dwordx4 v2, s[8:11], s37 offen offset:1024 sc1 lds
buffer_load_dwordx4 v2, s[8:11], s37 offen offset:2048 sc1 lds
buffer_load_dwordx4 v2, s[8:11], s37 offen offset:3072 sc1 lds
s_add_u32 s38, s35, 14
s_and_b32 s38, s38, 15
s_lshl_b32 s38, s38, 17
s_add_u32 m0, s40, 131072
s_nop 0
buffer_load_dwordx4 v3, s[12:15], s38 offen lds
s_add_u32 m0, s40, 132096
s_add_u32 s38, s38, 16384
buffer_load_dwordx4 v3, s[12:15], s38 offen lds
s_waitcnt vmcnt(14)
s_barrier
s_add_u32 s37, s35, 11
s_and_b32 s37, s37, 15
s_lshl_b32 s37, s37, 14
s_add_u32 m0, s39, 147456
s_nop 0
buffer_load_dwordx4 v2, s[8:11], s37 offen offset:0 sc1 lds
buffer_load_dwordx4 v2, s[8:11], s37 offen offset:1024 sc1 lds
buffer_load_dwordx4 v2, s[8:11], s37 offen offset:2048 sc1 lds
buffer_load_dwordx4 v2, s[8:11], s37 offen offset:3072 sc1 lds
s_add_u32 s38, s35, 15
s_and_b32 s38, s38, 15
s_lshl_b32 s38, s38, 17
s_add_u32 m0, s40, 139264
s_nop 0
buffer_load_dwordx4 v3, s[12:15], s38 offen lds
s_add_u32 m0, s40, 140288
s_add_u32 s38, s38, 16384
buffer_load_dwordx4 v3, s[12:15], s38 offen lds
s_waitcnt vmcnt(14)
s_barrier
s_add_u32 s37, s35, 12
s_and_b32 s37, s37, 15
s_lshl_b32 s37, s37, 14
s_add_u32 m0, s39, 0
s_nop 0
buffer_load_dwordx4 v2, s[8:11], s37 offen offset:0 sc1 lds
buffer_load_dwordx4 v2, s[8:11], s37 offen offset:1024 sc1 lds
buffer_load_dwordx4 v2, s[8:11], s37 offen offset:2048 sc1 lds
buffer_load_dwordx4 v2, s[8:11], s37 offen offset:3072 sc1 lds
s_waitcnt vmcnt(12)
s_barrier
s_add_u32 s37, s35, 13
s_and_b32 s37, s37, 15
s_lshl_b32 s37, s37, 14
s_add_u32 m0, s39, 49152
s_nop 0
buffer_load_dwordx4 v2, s[8:11], s37 offen offset:0 sc1 lds
buffer_load_dwordx4 v2, s[8:11], s37 offen offset:1024 sc1 lds
buffer_load_dwordx4 v2, s[8:11], s37 offen offset:2048 sc1 lds
buffer_load_dwordx4 v2, s[8:11], s37 offen offset:3072 sc1 lds
s_waitcnt vmcnt(10)
s_barrier
s_add_u32 s37, s35, 14
s_and_b32 s37, s37, 15
s_lshl_b32 s37, s37, 14
s_add_u32 m0, s39, 98304
s_nop 0
buffer_load_dwordx4 v2, s[8:11], s37 offen offset:0 sc1 lds
buffer_load_dwordx4 v2, s[8:11], s37 offen offset:1024 sc1 lds
buffer_load_dwordx4 v2, s[8:11], s37 offen offset:2048 sc1 lds
buffer_load_dwordx4 v2, s[8:11], s37 offen offset:3072 sc1 lds
s_getpc_b64 s[100:101]
s_and_b32 s100, s100, 0xfffff000
s_sub_u32 s100, s100, 1077248
s_subb_u32 s101, s101, 0
s_lshr_b32 s6, s2, 3
s_mul_i32 s6, s6, 4
s_and_b32 s7, s36, 3
s_add_u32 s6, s6, s7
s_mulk_i32 s6, 384
s_add_u32 s6, s6, 1082048
s_load_dword s3, s[100:101], s6 offset:0
s_load_dword s3, s[100:101], s6 offset:64
s_load_dword s3, s[100:101], s6 offset:128
s_load_dword s3, s[100:101], s6 offset:192
s_load_dword s3, s[100:101], s6 offset:256
s_load_dword s3, s[100:101], s6 offset:320
s_nop 0
s_nop 0
s_waitcnt vmcnt(8)
s_barrier
s_add_u32 s37, s35, 15
s_and_b32 s37, s37, 15
s_lshl_b32 s37, s37, 14
s_add_u32 m0, s39, 147456
s_nop 0
buffer_load_dwordx4 v2, s[8:11], s37 offen offset:0 sc1 lds
buffer_load_dwordx4 v2, s[8:11], s37 offen offset:1024 sc1 lds
buffer_load_dwordx4 v2, s[8:11], s37 offen offset:2048 sc1 lds
buffer_load_dwordx4 v2, s[8:11], s37 offen offset:3072 sc1 lds
s_waitcnt vmcnt(8)
s_barrier
s_waitcnt vmcnt(0)
s_barrier
s_add_u32 s38, s35, 0
s_and_b32 s38, s38, 15
s_mul_i32 s38, s38, 458752
s_add_u32 m0, s50, 0
s_nop 0
buffer_load_dwordx4 v192, s[16:19], s38 offen lds
s_add_u32 m0, s50, 1024
s_nop 0
buffer_load_dwordx4 v193, s[16:19], s38 offen lds
s_add_u32 m0, s50, 2048
s_nop 0
buffer_load_dwordx4 v194, s[16:19], s38 offen lds
s_add_u32 m0, s50, 3072
s_add_u32 s38, s38, 114688
buffer_load_dwordx4 v192, s[16:19], s38 offen lds
s_add_u32 m0, s50, 4096
s_nop 0
buffer_load_dwordx4 v193, s[16:19], s38 offen lds
s_add_u32 m0, s50, 5120
s_nop 0
buffer_load_dwordx4 v194, s[16:19], s38 offen lds
s_add_u32 s38, s35, 1
s_and_b32 s38, s38, 15
s_mul_i32 s38, s38, 458752
s_add_u32 m0, s50, 49152
s_nop 0
buffer_load_dwordx4 v192, s[16:19], s38 offen lds
s_add_u32 m0, s50, 50176
s_nop 0
buffer_load_dwordx4 v193, s[16:19], s38 offen lds
s_add_u32 m0, s50, 51200
s_nop 0
buffer_load_dwordx4 v194, s[16:19], s38 offen lds
s_add_u32 m0, s50, 52224
s_add_u32 s38, s38, 114688
buffer_load_dwordx4 v192, s[16:19], s38 offen lds
s_add_u32 m0, s50, 53248
s_nop 0
buffer_load_dwordx4 v193, s[16:19], s38 offen lds
s_add_u32 m0, s50, 54272
s_nop 0
buffer_load_dwordx4 v194, s[16:19], s38 offen lds
v_lshlrev_b32 v240, 16, v128
v_and_b32 v241, 0xffff0000, v128
v_lshlrev_b32 v242, 16, v129
v_and_b32 v243, 0xffff0000, v129
v_lshlrev_b32 v244, 16, v130
v_and_b32 v245, 0xffff0000, v130
v_lshlrev_b32 v246, 16, v131
v_and_b32 v247, 0xffff0000, v131
v_lshlrev_b32 v24, 16, v132
v_and_b32 v25, 0xffff0000, v132
v_lshlrev_b32 v26, 16, v133
v_and_b32 v27, 0xffff0000, v133
v_lshlrev_b32 v28, 16, v134
v_and_b32 v29, 0xffff0000, v134
v_lshlrev_b32 v30, 16, v135
v_and_b32 v31, 0xffff0000, v135
v_add_f32 v240, v240, v24
v_add_f32 v241, v241, v25
v_add_f32 v242, v242, v26
v_add_f32 v243, v243, v27
v_add_f32 v244, v244, v28
v_add_f32 v245, v245, v29
v_add_f32 v246, v246, v30
v_add_f32 v247, v247, v31
v_lshlrev_b32 v24, 16, v136
s_branch Lov_7
.p2align 12
.fill 48, 4, 0xbf800000
Lst_7_0:
s_branch Lwr_167
s_nop 0
s_nop 0
Lov_7:
v_and_b32 v25, 0xffff0000, v136
v_lshlrev_b32 v26, 16, v137
v_and_b32 v27, 0xffff0000, v137
v_lshlrev_b32 v28, 16, v138
v_and_b32 v29, 0xffff0000, v138
v_lshlrev_b32 v30, 16, v139
v_and_b32 v31, 0xffff0000, v139
v_add_f32 v240, v240, v24
v_add_f32 v241, v241, v25
v_add_f32 v242, v242, v26
v_add_f32 v243, v243, v27
v_add_f32 v244, v244, v28
v_add_f32 v245, v245, v29
v_add_f32 v246, v246, v30
v_add_f32 v247, v247, v31
v_lshlrev_b32 v24, 16, v140
v_and_b32 v25, 0xffff0000, v140
v_lshlrev_b32 v26, 16, v141
v_and_b32 v27, 0xffff0000, v141
v_lshlrev_b32 v28, 16, v142
v_and_b32 v29, 0xffff0000, v142
v_lshlrev_b32 v30, 16, v143
v_and_b32 v31, 0xffff0000, v143
v_add_f32 v240, v240, v24
v_add_f32 v241, v241, v25
v_add_f32 v242, v242, v26
v_add_f32 v243, v243, v27
v_add_f32 v244, v244, v28
v_add_f32 v245, v245, v29
v_add_f32 v246, v246, v30
v_add_f32 v247, v247, v31
v_lshlrev_b32 v24, 16, v144
v_and_b32 v25, 0xffff0000, v144
v_lshlrev_b32 v26, 16, v145
v_and_b32 v27, 0xffff0000, v145
v_lshlrev_b32 v28, 16, v146
v_and_b32 v29, 0xffff0000, v146
v_lshlrev_b32 v30, 16, v147
v_and_b32 v31, 0xffff0000, v147
v_add_f32 v240, v240, v24
v_add_f32 v241, v241, v25
v_add_f32 v242, v242, v26
v_add_f32 v243, v243, v27
v_add_f32 v244, v244, v28
v_add_f32 v245, v245, v29
v_add_f32 v246, v246, v30
v_add_f32 v247, v247, v31
v_lshlrev_b32 v24, 16, v148
v_and_b32 v25, 0xffff0000, v148
v_lshlrev_b32 v26, 16, v149
v_and_b32 v27, 0xffff0000, v149
v_lshlrev_b32 v28, 16, v150
v_and_b32 v29, 0xffff0000, v150
v_lshlrev_b32 v30, 16, v151
v_and_b32 v31, 0xffff0000, v151
v_add_f32 v240, v240, v24
v_add_f32 v241, v241, v25
v_add_f32 v242, v242, v26
v_add_f32 v243, v243, v27
v_add_f32 v244, v244, v28
v_add_f32 v245, v245, v29
v_add_f32 v246, v246, v30
v_add_f32 v247, v247, v31
v_lshlrev_b32 v24, 16, v152
v_and_b32 v25, 0xffff0000, v152
v_lshlrev_b32 v26, 16, v153
v_and_b32 v27, 0xffff0000, v153
v_lshlrev_b32 v28, 16, v154
v_and_b32 v29, 0xffff0000, v154
v_lshlrev_b32 v30, 16, v155
v_and_b32 v31, 0xffff0000, v155
v_add_f32 v240, v240, v24
v_add_f32 v241, v241, v25
v_add_f32 v242, v242, v26
v_add_f32 v243, v243, v27
v_add_f32 v244, v244, v28
v_add_f32 v245, v245, v29
v_add_f32 v246, v246, v30
v_add_f32 v247, v247, v31
v_lshlrev_b32 v24, 16, v156
v_and_b32 v25, 0xffff0000, v156
v_lshlrev_b32 v26, 16, v157
v_and_b32 v27, 0xffff0000, v157
v_lshlrev_b32 v28, 16, v158
v_and_b32 v29, 0xffff0000, v158
v_lshlrev_b32 v30, 16, v159
v_and_b32 v31, 0xffff0000, v159
v_add_f32 v240, v240, v24
v_add_f32 v241, v241, v25
v_add_f32 v242, v242, v26
v_add_f32 v243, v243, v27
v_add_f32 v244, v244, v28
v_add_f32 v245, v245, v29
v_add_f32 v246, v246, v30
v_add_f32 v247, v247, v31
s_nop 0
v_permlane32_swap_b32 v240, v244
v_permlane32_swap_b32 v241, v245
v_permlane32_swap_b32 v242, v246
v_permlane32_swap_b32 v243, v247
v_add_f32 v240, v240, v244
v_add_f32 v241, v241, v245
v_add_f32 v242, v242, v246
v_add_f32 v243, v243, v247
s_nop 0
v_permlane16_swap_b32 v240, v242
v_permlane16_swap_b32 v241, v243
v_add_f32 v240, v240, v242
v_add_f32 v241, v241, v243
s_branch Lk3a
Lk2end_98:
Lk3:
s_branch Lgb_112
Lk3a:
s_mul_i32 s43, s34, 262144
s_add_u32 s8, s82, s43
s_addc_u32 s9, s83, 0
s_add_u32 s8, s8, 4194304
s_addc_u32 s9, s9, 0
s_mov_b32 s10, 262144
s_mov_b32 s11, 0x20000
s_mul_i32 s43, s34, 917504
s_add_u32 s24, s82, s43
s_addc_u32 s25, s83, 0
s_add_u32 s24, s24, 8388608
s_addc_u32 s25, s25, 0
s_mov_b32 s26, 917504
s_mov_b32 s27, 0x20000
s_add_u32 s84, s82, 27262976
s_addc_u32 s85, s83, 0
s_mov_b32 s86, 229376
s_mov_b32 s87, 0x20000
s_and_b32 s47, s36, 3
s_lshr_b32 s62, s47, 1
s_and_b32 s63, s47, 1
v_lshlrev_b32 v2, 4, v1
s_lshl_b32 s39, s47, 12
v_add_u32 v3, s39, v2
s_bitcmp0_b32 s36, 1
s_cselect_b32 s44, s72, s74
s_cselect_b32 s45, s73, s75
s_mul_i32 s43, s35, 256
s_add_u32 s12, s44, s43
s_addc_u32 s13, s45, 0
s_mov_b32 s14, 7333120
s_mov_b32 s15, 0x20000
s_and_b32 s43, s36, 1
s_mul_i32 s43, s43, 229376
v_lshrrev_b32 v28, 4, v1
v_lshlrev_b32 v29, 1, v28
v_and_b32 v4, 15, v1
v_xor_b32 v4, v4, v29
v_lshlrev_b32 v4, 4, v4
v_mul_u32_u24 v28, 7168, v28
v_add_u32 v4, v4, v28
v_add_u32 v4, s43, v4
v_xor_b32 v5, 128, v4
v_add_u32 v5, 28672, v5
s_and_b32 s43, s36, 3
s_mul_i32 s40, s43, 8192
s_add_u32 s40, s40, 16384
v_mov_b32 v6, v192
v_mov_b32 v7, v193
v_mov_b32 v8, v194
s_lshl_b32 s43, s62, 12
v_add_u32 v9, s43, v2
v_add_u32 v10, 98304, v9
v_lshrrev_b32 v27, 2, v1
v_bfe_u32 v28, v27, 2, 1
v_mul_u32_u24 v27, 192, v27
v_add_u32 v27, 16384, v27
v_and_b32 v29, 3, v1
v_lshl_add_u32 v12, v29, 3, v27
s_lshl_b32 s43, s63, 6
v_add_u32 v12, s43, v12
v_lshl_add_u32 v11, v28, 5, v12
v_xor_b32 v30, 1, v28
v_lshl_add_u32 v12, v30, 5, v12
v_xor_b32 v28, s63, v28
v_lshl_add_u32 v27, v28, 4, v27
v_lshrrev_b32 v28, 1, v29
v_lshl_add_u32 v27, v28, 5, v27
v_and_b32 v28, 1, v29
v_lshl_add_u32 v27, v28, 3, v27
v_add_u32 v13, 128, v27
v_add_u32 v14, 49152, v11
v_add_u32 v15, 49152, v12
v_add_u32 v16, 49152, v13
v_add_u32 v17, 98304, v11
v_add_u32 v18, 98304, v12
v_add_u32 v19, 98304, v13
s_cmp_lg_u32 s36, 4
s_cbranch_scc1 Lwm_114
s_branch Lst_8_1
Lwr_179:
s_branch Lwe_113
Lwm_114:
s_cmp_lg_u32 s36, 5
s_cbranch_scc1 Lwm_115
s_branch Lst_9_1
Lwr_180:
s_branch Lwe_113
Lwm_115:
s_cmp_lg_u32 s36, 6
s_cbranch_scc1 Lwm_116
s_branch Lst_10_1
Lwr_181:
s_branch Lwe_113
Lwm_116:
s_cmp_lg_u32 s36, 7
s_cbranch_scc1 Lwm_117
s_nop 0
s_branch Lwe_113
Lwm_117:
Lwe_113:
s_barrier
s_lshl_b32 s43, s47, 9
s_add_u32 s43, s43, 151552
v_and_b32 v28, 15, v1
v_lshl_add_u32 v28, v28, 5, s43
v_lshrrev_b32 v29, 4, v1
v_lshl_add_u32 v28, v29, 3, v28
ds_write_b64 v28, v[240:241]
s_waitcnt lgkmcnt(0)
s_cmp_lg_u32 s36, 4
s_cbranch_scc1 Lwm_119
s_branch Lst_11_1
Lwr_183:
s_branch Lwe_118
Lwm_119:
s_cmp_lg_u32 s36, 5
s_cbranch_scc1 Lwm_120
s_branch Lst_12_1
Lwr_184:
s_branch Lwe_118
Lwm_120:
s_cmp_lg_u32 s36, 6
s_cbranch_scc1 Lwm_121
s_branch Lst_13_1
Lwr_185:
s_branch Lwe_118
Lwm_121:
s_cmp_lg_u32 s36, 7
s_cbranch_scc1 Lwm_122
s_branch Lst_14_1
Lwr_186:
s_branch Lwe_118
Lwm_122:
Lwe_118:
s_waitcnt vmcnt(0) lgkmcnt(0)
s_barrier
ds_read_b128 v[32:35], v9 offset:0
ds_read_b64_tr_b16 v[48:49], v11 offset:0
ds_read_b64_tr_b16 v[50:51], v11 offset:3072
ds_read_b64_tr_b16 v[52:53], v12 offset:0
ds_read_b64_tr_b16 v[54:55], v12 offset:3072
ds_read_b64_tr_b16 v[56:57], v13 offset:0
ds_read_b64_tr_b16 v[58:59], v13 offset:3072
ds_read_b64_tr_b16 v[60:61], v11 offset:12288
ds_read_b64_tr_b16 v[62:63], v11 offset:15360
ds_read_b64_tr_b16 v[64:65], v12 offset:12288
ds_read_b64_tr_b16 v[66:67], v12 offset:15360
ds_read_b64_tr_b16 v[68:69], v13 offset:12288
ds_read_b64_tr_b16 v[70:71], v13 offset:15360
ds_read_b128 v[36:39], v9 offset:1024
ds_read_b128 v[40:43], v9 offset:2048
ds_read_b128 v[44:47], v9 offset:3072
s_waitcnt lgkmcnt(0)
v_mfma_f32_16x16x32_bf16 v[128:131], v[48:51], v[32:35], 0
ds_read_b128 v[72:75], v9 offset:8192
v_mfma_f32_16x16x32_bf16 v[152:155], v[48:51], v[36:39], 0
ds_read_b64_tr_b16 v[88:89], v11 offset:6144
v_mfma_f32_16x16x32_bf16 v[176:179], v[48:51], v[40:43], 0
ds_read_b64_tr_b16 v[90:91], v11 offset:9216
v_mfma_f32_16x16x32_bf16 v[200:203], v[48:51], v[44:47], 0
ds_read_b64_tr_b16 v[92:93], v12 offset:6144
v_mfma_f32_16x16x32_bf16 v[204:207], v[52:55], v[44:47], 0
ds_read_b64_tr_b16 v[94:95], v12 offset:9216
v_mfma_f32_16x16x32_bf16 v[180:183], v[52:55], v[40:43], 0
ds_read_b64_tr_b16 v[96:97], v13 offset:6144
v_mfma_f32_16x16x32_bf16 v[156:159], v[52:55], v[36:39], 0
ds_read_b64_tr_b16 v[98:99], v13 offset:9216
v_mfma_f32_16x16x32_bf16 v[132:135], v[52:55], v[32:35], 0
ds_read_b64_tr_b16 v[100:101], v11 offset:18432
v_mfma_f32_16x16x32_bf16 v[136:139], v[56:59], v[32:35], 0
ds_read_b64_tr_b16 v[102:103], v11 offset:21504
v_mfma_f32_16x16x32_bf16 v[160:163], v[56:59], v[36:39], 0
ds_read_b64_tr_b16 v[104:105], v12 offset:18432
v_mfma_f32_16x16x32_bf16 v[184:187], v[56:59], v[40:43], 0
ds_read_b64_tr_b16 v[106:107], v12 offset:21504
v_mfma_f32_16x16x32_bf16 v[208:211], v[56:59], v[44:47], 0
ds_read_b64_tr_b16 v[108:109], v13 offset:18432
v_mfma_f32_16x16x32_bf16 v[212:215], v[60:63], v[44:47], 0
ds_read_b64_tr_b16 v[110:111], v13 offset:21504
v_mfma_f32_16x16x32_bf16 v[188:191], v[60:63], v[40:43], 0
ds_read_b128 v[76:79], v9 offset:9216
v_mfma_f32_16x16x32_bf16 v[164:167], v[60:63], v[36:39], 0
ds_read_b128 v[80:83], v9 offset:10240
v_mfma_f32_16x16x32_bf16 v[140:143], v[60:63], v[32:35], 0
ds_read_b128 v[84:87], v9 offset:11264
v_mfma_f32_16x16x32_bf16 v[144:147], v[64:67], v[32:35], 0
v_mfma_f32_16x16x32_bf16 v[168:171], v[64:67], v[36:39], 0
v_mfma_f32_16x16x32_bf16 v[192:195], v[64:67], v[40:43], 0
v_mfma_f32_16x16x32_bf16 v[216:219], v[64:67], v[44:47], 0
v_mfma_f32_16x16x32_bf16 v[220:223], v[68:71], v[44:47], 0
v_mfma_f32_16x16x32_bf16 v[196:199], v[68:71], v[40:43], 0
v_mfma_f32_16x16x32_bf16 v[172:175], v[68:71], v[36:39], 0
v_mfma_f32_16x16x32_bf16 v[148:151], v[68:71], v[32:35], 0
s_waitcnt lgkmcnt(0)
s_barrier
v_mfma_f32_16x16x32_bf16 v[128:131], v[88:91], v[72:75], v[128:131]
ds_read_b128 v[32:35], v9 offset:49152
v_mfma_f32_16x16x32_bf16 v[152:155], v[88:91], v[76:79], v[152:155]
ds_read_b64_tr_b16 v[48:49], v14 offset:0
v_mfma_f32_16x16x32_bf16 v[176:179], v[88:91], v[80:83], v[176:179]
ds_read_b64_tr_b16 v[50:51], v14 offset:3072
v_mfma_f32_16x16x32_bf16 v[200:203], v[88:91], v[84:87], v[200:203]
ds_read_b64_tr_b16 v[52:53], v15 offset:0
v_mfma_f32_16x16x32_bf16 v[204:207], v[92:95], v[84:87], v[204:207]
ds_read_b64_tr_b16 v[54:55], v15 offset:3072
v_mfma_f32_16x16x32_bf16 v[180:183], v[92:95], v[80:83], v[180:183]
ds_read_b64_tr_b16 v[56:57], v16 offset:0
v_mfma_f32_16x16x32_bf16 v[156:159], v[92:95], v[76:79], v[156:159]
ds_read_b64_tr_b16 v[58:59], v16 offset:3072
v_mfma_f32_16x16x32_bf16 v[132:135], v[92:95], v[72:75], v[132:135]
ds_read_b64_tr_b16 v[60:61], v14 offset:12288
v_mfma_f32_16x16x32_bf16 v[136:139], v[96:99], v[72:75], v[136:139]
ds_read_b64_tr_b16 v[62:63], v14 offset:15360
v_mfma_f32_16x16x32_bf16 v[160:163], v[96:99], v[76:79], v[160:163]
ds_read_b64_tr_b16 v[64:65], v15 offset:12288
v_mfma_f32_16x16x32_bf16 v[184:187], v[96:99], v[80:83], v[184:187]
ds_read_b64_tr_b16 v[66:67], v15 offset:15360
v_mfma_f32_16x16x32_bf16 v[208:211], v[96:99], v[84:87], v[208:211]
ds_read_b64_tr_b16 v[68:69], v16 offset:12288
v_mfma_f32_16x16x32_bf16 v[212:215], v[100:103], v[84:87], v[212:215]
ds_read_b64_tr_b16 v[70:71], v16 offset:15360
v_mfma_f32_16x16x32_bf16 v[188:191], v[100:103], v[80:83], v[188:191]
ds_read_b128 v[36:39], v9 offset:50176
v_mfma_f32_16x16x32_bf16 v[164:167], v[100:103], v[76:79], v[164:167]
ds_read_b128 v[40:43], v9 offset:51200
v_mfma_f32_16x16x32_bf16 v[140:143], v[100:103], v[72:75], v[140:143]
ds_read_b128 v[44:47], v9 offset:52224
v_mfma_f32_16x16x32_bf16 v[144:147], v[104:107], v[72:75], v[144:147]
v_mfma_f32_16x16x32_bf16 v[168:171], v[104:107], v[76:79], v[168:171]
v_mfma_f32_16x16x32_bf16 v[192:195], v[104:107], v[80:83], v[192:195]
v_mfma_f32_16x16x32_bf16 v[216:219], v[104:107], v[84:87], v[216:219]
v_mfma_f32_16x16x32_bf16 v[220:223], v[108:111], v[84:87], v[220:223]
v_mfma_f32_16x16x32_bf16 v[196:199], v[108:111], v[80:83], v[196:199]
v_mfma_f32_16x16x32_bf16 v[172:175], v[108:111], v[76:79], v[172:175]
v_mfma_f32_16x16x32_bf16 v[148:151], v[108:111], v[72:75], v[148:151]
s_mov_b32 s41, 5
Lk3l_123:
s_waitcnt lgkmcnt(0)
v_mfma_f32_16x16x32_bf16 v[128:131], v[48:51], v[32:35], v[128:131]
ds_read_b128 v[72:75], v9 offset:57344
v_mfma_f32_16x16x32_bf16 v[152:155], v[48:51], v[36:39], v[152:155]
ds_read_b64_tr_b16 v[88:89], v14 offset:6144
v_mfma_f32_16x16x32_bf16 v[176:179], v[48:51], v[40:43], v[176:179]
ds_read_b64_tr_b16 v[90:91], v14 offset:9216
v_mfma_f32_16x16x32_bf16 v[200:203], v[48:51], v[44:47], v[200:203]
ds_read_b64_tr_b16 v[92:93], v15 offset:6144
v_mfma_f32_16x16x32_bf16 v[204:207], v[52:55], v[44:47], v[204:207]
ds_read_b64_tr_b16 v[94:95], v15 offset:9216
v_mfma_f32_16x16x32_bf16 v[180:183], v[52:55], v[40:43], v[180:183]
ds_read_b64_tr_b16 v[96:97], v16 offset:6144
v_mfma_f32_16x16x32_bf16 v[156:159], v[52:55], v[36:39], v[156:159]
ds_read_b64_tr_b16 v[98:99], v16 offset:9216
v_mfma_f32_16x16x32_bf16 v[132:135], v[52:55], v[32:35], v[132:135]
ds_read_b64_tr_b16 v[100:101], v14 offset:18432
v_mfma_f32_16x16x32_bf16 v[136:139], v[56:59], v[32:35], v[136:139]
ds_read_b64_tr_b16 v[102:103], v14 offset:21504
v_mfma_f32_16x16x32_bf16 v[160:163], v[56:59], v[36:39], v[160:163]
ds_read_b64_tr_b16 v[104:105], v15 offset:18432
v_mfma_f32_16x16x32_bf16 v[184:187], v[56:59], v[40:43], v[184:187]
ds_read_b64_tr_b16 v[106:107], v15 offset:21504
v_mfma_f32_16x16x32_bf16 v[208:211], v[56:59], v[44:47], v[208:211]
ds_read_b64_tr_b16 v[108:109], v16 offset:18432
v_mfma_f32_16x16x32_bf16 v[212:215], v[60:63], v[44:47], v[212:215]
ds_read_b64_tr_b16 v[110:111], v16 offset:21504
v_mfma_f32_16x16x32_bf16 v[188:191], v[60:63], v[40:43], v[188:191]
ds_read_b128 v[76:79], v9 offset:58368
v_mfma_f32_16x16x32_bf16 v[164:167], v[60:63], v[36:39], v[164:167]
ds_read_b128 v[80:83], v9 offset:59392
v_mfma_f32_16x16x32_bf16 v[140:143], v[60:63], v[32:35], v[140:143]
ds_read_b128 v[84:87], v9 offset:60416
v_mfma_f32_16x16x32_bf16 v[144:147], v[64:67], v[32:35], v[144:147]
v_mfma_f32_16x16x32_bf16 v[168:171], v[64:67], v[36:39], v[168:171]
v_mfma_f32_16x16x32_bf16 v[192:195], v[64:67], v[40:43], v[192:195]
v_mfma_f32_16x16x32_bf16 v[216:219], v[64:67], v[44:47], v[216:219]
v_mfma_f32_16x16x32_bf16 v[220:223], v[68:71], v[44:47], v[220:223]
v_mfma_f32_16x16x32_bf16 v[196:199], v[68:71], v[40:43], v[196:199]
v_mfma_f32_16x16x32_bf16 v[172:175], v[68:71], v[36:39], v[172:175]
v_mfma_f32_16x16x32_bf16 v[148:151], v[68:71], v[32:35], v[148:151]
s_waitcnt lgkmcnt(0)
s_barrier
v_mfma_f32_16x16x32_bf16 v[128:131], v[88:91], v[72:75], v[128:131]
ds_read_b128 v[32:35], v10 offset:0
v_mfma_f32_16x16x32_bf16 v[152:155], v[88:91], v[76:79], v[152:155]
ds_read_b64_tr_b16 v[48:49], v17 offset:0
v_mfma_f32_16x16x32_bf16 v[176:179], v[88:91], v[80:83], v[176:179]
ds_read_b64_tr_b16 v[50:51], v17 offset:3072
v_mfma_f32_16x16x32_bf16 v[200:203], v[88:91], v[84:87], v[200:203]
ds_read_b64_tr_b16 v[52:53], v18 offset:0
v_mfma_f32_16x16x32_bf16 v[204:207], v[92:95], v[84:87], v[204:207]
ds_read_b64_tr_b16 v[54:55], v18 offset:3072
v_mfma_f32_16x16x32_bf16 v[180:183], v[92:95], v[80:83], v[180:183]
ds_read_b64_tr_b16 v[56:57], v19 offset:0
v_mfma_f32_16x16x32_bf16 v[156:159], v[92:95], v[76:79], v[156:159]
ds_read_b64_tr_b16 v[58:59], v19 offset:3072
v_mfma_f32_16x16x32_bf16 v[132:135], v[92:95], v[72:75], v[132:135]
ds_read_b64_tr_b16 v[60:61], v17 offset:12288
v_mfma_f32_16x16x32_bf16 v[136:139], v[96:99], v[72:75], v[136:139]
ds_read_b64_tr_b16 v[62:63], v17 offset:15360
v_mfma_f32_16x16x32_bf16 v[160:163], v[96:99], v[76:79], v[160:163]
ds_read_b64_tr_b16 v[64:65], v18 offset:12288
v_mfma_f32_16x16x32_bf16 v[184:187], v[96:99], v[80:83], v[184:187]
ds_read_b64_tr_b16 v[66:67], v18 offset:15360
v_mfma_f32_16x16x32_bf16 v[208:211], v[96:99], v[84:87], v[208:211]
ds_read_b64_tr_b16 v[68:69], v19 offset:12288
v_mfma_f32_16x16x32_bf16 v[212:215], v[100:103], v[84:87], v[212:215]
ds_read_b64_tr_b16 v[70:71], v19 offset:15360
v_mfma_f32_16x16x32_bf16 v[188:191], v[100:103], v[80:83], v[188:191]
ds_read_b128 v[36:39], v10 offset:1024
v_mfma_f32_16x16x32_bf16 v[164:167], v[100:103], v[76:79], v[164:167]
ds_read_b128 v[40:43], v10 offset:2048
v_mfma_f32_16x16x32_bf16 v[140:143], v[100:103], v[72:75], v[140:143]
ds_read_b128 v[44:47], v10 offset:3072
v_mfma_f32_16x16x32_bf16 v[144:147], v[104:107], v[72:75], v[144:147]
v_mfma_f32_16x16x32_bf16 v[168:171], v[104:107], v[76:79], v[168:171]
v_mfma_f32_16x16x32_bf16 v[192:195], v[104:107], v[80:83], v[192:195]
v_mfma_f32_16x16x32_bf16 v[216:219], v[104:107], v[84:87], v[216:219]
v_mfma_f32_16x16x32_bf16 v[220:223], v[108:111], v[84:87], v[220:223]
v_mfma_f32_16x16x32_bf16 v[196:199], v[108:111], v[80:83], v[196:199]
v_mfma_f32_16x16x32_bf16 v[172:175], v[108:111], v[76:79], v[172:175]
v_mfma_f32_16x16x32_bf16 v[148:151], v[108:111], v[72:75], v[148:151]
s_waitcnt lgkmcnt(0)
v_mfma_f32_16x16x32_bf16 v[128:131], v[48:51], v[32:35], v[128:131]
ds_read_b128 v[72:75], v10 offset:8192
v_mfma_f32_16x16x32_bf16 v[152:155], v[48:51], v[36:39], v[152:155]
ds_read_b64_tr_b16 v[88:89], v17 offset:6144
v_mfma_f32_16x16x32_bf16 v[176:179], v[48:51], v[40:43], v[176:179]
ds_read_b64_tr_b16 v[90:91], v17 offset:9216
v_mfma_f32_16x16x32_bf16 v[200:203], v[48:51], v[44:47], v[200:203]
ds_read_b64_tr_b16 v[92:93], v18 offset:6144
v_mfma_f32_16x16x32_bf16 v[204:207], v[52:55], v[44:47], v[204:207]
ds_read_b64_tr_b16 v[94:95], v18 offset:9216
v_mfma_f32_16x16x32_bf16 v[180:183], v[52:55], v[40:43], v[180:183]
ds_read_b64_tr_b16 v[96:97], v19 offset:6144
v_mfma_f32_16x16x32_bf16 v[156:159], v[52:55], v[36:39], v[156:159]
ds_read_b64_tr_b16 v[98:99], v19 offset:9216
v_mfma_f32_16x16x32_bf16 v[132:135], v[52:55], v[32:35], v[132:135]
ds_read_b64_tr_b16 v[100:101], v17 offset:18432
v_mfma_f32_16x16x32_bf16 v[136:139], v[56:59], v[32:35], v[136:139]
ds_read_b64_tr_b16 v[102:103], v17 offset:21504
v_mfma_f32_16x16x32_bf16 v[160:163], v[56:59], v[36:39], v[160:163]
ds_read_b64_tr_b16 v[104:105], v18 offset:18432
v_mfma_f32_16x16x32_bf16 v[184:187], v[56:59], v[40:43], v[184:187]
ds_read_b64_tr_b16 v[106:107], v18 offset:21504
v_mfma_f32_16x16x32_bf16 v[208:211], v[56:59], v[44:47], v[208:211]
ds_read_b64_tr_b16 v[108:109], v19 offset:18432
v_mfma_f32_16x16x32_bf16 v[212:215], v[60:63], v[44:47], v[212:215]
ds_read_b64_tr_b16 v[110:111], v19 offset:21504
v_mfma_f32_16x16x32_bf16 v[188:191], v[60:63], v[40:43], v[188:191]
ds_read_b128 v[76:79], v10 offset:9216
v_mfma_f32_16x16x32_bf16 v[164:167], v[60:63], v[36:39], v[164:167]
ds_read_b128 v[80:83], v10 offset:10240
v_mfma_f32_16x16x32_bf16 v[140:143], v[60:63], v[32:35], v[140:143]
ds_read_b128 v[84:87], v10 offset:11264
v_mfma_f32_16x16x32_bf16 v[144:147], v[64:67], v[32:35], v[144:147]
v_mfma_f32_16x16x32_bf16 v[168:171], v[64:67], v[36:39], v[168:171]
v_mfma_f32_16x16x32_bf16 v[192:195], v[64:67], v[40:43], v[192:195]
v_mfma_f32_16x16x32_bf16 v[216:219], v[64:67], v[44:47], v[216:219]
v_mfma_f32_16x16x32_bf16 v[220:223], v[68:71], v[44:47], v[220:223]
v_mfma_f32_16x16x32_bf16 v[196:199], v[68:71], v[40:43], v[196:199]
v_mfma_f32_16x16x32_bf16 v[172:175], v[68:71], v[36:39], v[172:175]
v_mfma_f32_16x16x32_bf16 v[148:151], v[68:71], v[32:35], v[148:151]
s_waitcnt lgkmcnt(0)
s_barrier
v_mfma_f32_16x16x32_bf16 v[128:131], v[88:91], v[72:75], v[128:131]
ds_read_b128 v[32:35], v9 offset:0
v_mfma_f32_16x16x32_bf16 v[152:155], v[88:91], v[76:79], v[152:155]
ds_read_b64_tr_b16 v[48:49], v11 offset:0
v_mfma_f32_16x16x32_bf16 v[176:179], v[88:91], v[80:83], v[176:179]
ds_read_b64_tr_b16 v[50:51], v11 offset:3072
v_mfma_f32_16x16x32_bf16 v[200:203], v[88:91], v[84:87], v[200:203]
ds_read_b64_tr_b16 v[52:53], v12 offset:0
v_mfma_f32_16x16x32_bf16 v[204:207], v[92:95], v[84:87], v[204:207]
ds_read_b64_tr_b16 v[54:55], v12 offset:3072
v_mfma_f32_16x16x32_bf16 v[180:183], v[92:95], v[80:83], v[180:183]
ds_read_b64_tr_b16 v[56:57], v13 offset:0
v_mfma_f32_16x16x32_bf16 v[156:159], v[92:95], v[76:79], v[156:159]
ds_read_b64_tr_b16 v[58:59], v13 offset:3072
v_mfma_f32_16x16x32_bf16 v[132:135], v[92:95], v[72:75], v[132:135]
ds_read_b64_tr_b16 v[60:61], v11 offset:12288
v_mfma_f32_16x16x32_bf16 v[136:139], v[96:99], v[72:75], v[136:139]
ds_read_b64_tr_b16 v[62:63], v11 offset:15360
v_mfma_f32_16x16x32_bf16 v[160:163], v[96:99], v[76:79], v[160:163]
ds_read_b64_tr_b16 v[64:65], v12 offset:12288
v_mfma_f32_16x16x32_bf16 v[184:187], v[96:99], v[80:83], v[184:187]
ds_read_b64_tr_b16 v[66:67], v12 offset:15360
v_mfma_f32_16x16x32_bf16 v[208:211], v[96:99], v[84:87], v[208:211]
ds_read_b64_tr_b16 v[68:69], v13 offset:12288
v_mfma_f32_16x16x32_bf16 v[212:215], v[100:103], v[84:87], v[212:215]
ds_read_b64_tr_b16 v[70:71], v13 offset:15360
v_mfma_f32_16x16x32_bf16 v[188:191], v[100:103], v[80:83], v[188:191]
ds_read_b128 v[36:39], v9 offset:1024
v_mfma_f32_16x16x32_bf16 v[164:167], v[100:103], v[76:79], v[164:167]
ds_read_b128 v[40:43], v9 offset:2048
v_mfma_f32_16x16x32_bf16 v[140:143], v[100:103], v[72:75], v[140:143]
ds_read_b128 v[44:47], v9 offset:3072
v_mfma_f32_16x16x32_bf16 v[144:147], v[104:107], v[72:75], v[144:147]
v_mfma_f32_16x16x32_bf16 v[168:171], v[104:107], v[76:79], v[168:171]
v_mfma_f32_16x16x32_bf16 v[192:195], v[104:107], v[80:83], v[192:195]
v_mfma_f32_16x16x32_bf16 v[216:219], v[104:107], v[84:87], v[216:219]
v_mfma_f32_16x16x32_bf16 v[220:223], v[108:111], v[84:87], v[220:223]
v_mfma_f32_16x16x32_bf16 v[196:199], v[108:111], v[80:83], v[196:199]
v_mfma_f32_16x16x32_bf16 v[172:175], v[108:111], v[76:79], v[172:175]
v_mfma_f32_16x16x32_bf16 v[148:151], v[108:111], v[72:75], v[148:151]
s_waitcnt lgkmcnt(0)
v_mfma_f32_16x16x32_bf16 v[128:131], v[48:51], v[32:35], v[128:131]
ds_read_b128 v[72:75], v9 offset:8192
v_mfma_f32_16x16x32_bf16 v[152:155], v[48:51], v[36:39], v[152:155]
ds_read_b64_tr_b16 v[88:89], v11 offset:6144
v_mfma_f32_16x16x32_bf16 v[176:179], v[48:51], v[40:43], v[176:179]
ds_read_b64_tr_b16 v[90:91], v11 offset:9216
v_mfma_f32_16x16x32_bf16 v[200:203], v[48:51], v[44:47], v[200:203]
ds_read_b64_tr_b16 v[92:93], v12 offset:6144
v_mfma_f32_16x16x32_bf16 v[204:207], v[52:55], v[44:47], v[204:207]
ds_read_b64_tr_b16 v[94:95], v12 offset:9216
v_mfma_f32_16x16x32_bf16 v[180:183], v[52:55], v[40:43], v[180:183]
ds_read_b64_tr_b16 v[96:97], v13 offset:6144
v_mfma_f32_16x16x32_bf16 v[156:159], v[52:55], v[36:39], v[156:159]
ds_read_b64_tr_b16 v[98:99], v13 offset:9216
v_mfma_f32_16x16x32_bf16 v[132:135], v[52:55], v[32:35], v[132:135]
ds_read_b64_tr_b16 v[100:101], v11 offset:18432
v_mfma_f32_16x16x32_bf16 v[136:139], v[56:59], v[32:35], v[136:139]
ds_read_b64_tr_b16 v[102:103], v11 offset:21504
v_mfma_f32_16x16x32_bf16 v[160:163], v[56:59], v[36:39], v[160:163]
ds_read_b64_tr_b16 v[104:105], v12 offset:18432
v_mfma_f32_16x16x32_bf16 v[184:187], v[56:59], v[40:43], v[184:187]
ds_read_b64_tr_b16 v[106:107], v12 offset:21504
v_mfma_f32_16x16x32_bf16 v[208:211], v[56:59], v[44:47], v[208:211]
ds_read_b64_tr_b16 v[108:109], v13 offset:18432
v_mfma_f32_16x16x32_bf16 v[212:215], v[60:63], v[44:47], v[212:215]
ds_read_b64_tr_b16 v[110:111], v13 offset:21504
v_mfma_f32_16x16x32_bf16 v[188:191], v[60:63], v[40:43], v[188:191]
ds_read_b128 v[76:79], v9 offset:9216
v_mfma_f32_16x16x32_bf16 v[164:167], v[60:63], v[36:39], v[164:167]
ds_read_b128 v[80:83], v9 offset:10240
v_mfma_f32_16x16x32_bf16 v[140:143], v[60:63], v[32:35], v[140:143]
ds_read_b128 v[84:87], v9 offset:11264
v_mfma_f32_16x16x32_bf16 v[144:147], v[64:67], v[32:35], v[144:147]
v_mfma_f32_16x16x32_bf16 v[168:171], v[64:67], v[36:39], v[168:171]
v_mfma_f32_16x16x32_bf16 v[192:195], v[64:67], v[40:43], v[192:195]
v_mfma_f32_16x16x32_bf16 v[216:219], v[64:67], v[44:47], v[216:219]
v_mfma_f32_16x16x32_bf16 v[220:223], v[68:71], v[44:47], v[220:223]
v_mfma_f32_16x16x32_bf16 v[196:199], v[68:71], v[40:43], v[196:199]
v_mfma_f32_16x16x32_bf16 v[172:175], v[68:71], v[36:39], v[172:175]
v_mfma_f32_16x16x32_bf16 v[148:151], v[68:71], v[32:35], v[148:151]
s_waitcnt lgkmcnt(0)
s_barrier
v_mfma_f32_16x16x32_bf16 v[128:131], v[88:91], v[72:75], v[128:131]
ds_read_b128 v[32:35], v9 offset:49152
v_mfma_f32_16x16x32_bf16 v[152:155], v[88:91], v[76:79], v[152:155]
ds_read_b64_tr_b16 v[48:49], v14 offset:0
v_mfma_f32_16x16x32_bf16 v[176:179], v[88:91], v[80:83], v[176:179]
ds_read_b64_tr_b16 v[50:51], v14 offset:3072
v_mfma_f32_16x16x32_bf16 v[200:203], v[88:91], v[84:87], v[200:203]
ds_read_b64_tr_b16 v[52:53], v15 offset:0
v_mfma_f32_16x16x32_bf16 v[204:207], v[92:95], v[84:87], v[204:207]
ds_read_b64_tr_b16 v[54:55], v15 offset:3072
v_mfma_f32_16x16x32_bf16 v[180:183], v[92:95], v[80:83], v[180:183]
ds_read_b64_tr_b16 v[56:57], v16 offset:0
v_mfma_f32_16x16x32_bf16 v[156:159], v[92:95], v[76:79], v[156:159]
ds_read_b64_tr_b16 v[58:59], v16 offset:3072
v_mfma_f32_16x16x32_bf16 v[132:135], v[92:95], v[72:75], v[132:135]
ds_read_b64_tr_b16 v[60:61], v14 offset:12288
v_mfma_f32_16x16x32_bf16 v[136:139], v[96:99], v[72:75], v[136:139]
ds_read_b64_tr_b16 v[62:63], v14 offset:15360
v_mfma_f32_16x16x32_bf16 v[160:163], v[96:99], v[76:79], v[160:163]
ds_read_b64_tr_b16 v[64:65], v15 offset:12288
v_mfma_f32_16x16x32_bf16 v[184:187], v[96:99], v[80:83], v[184:187]
ds_read_b64_tr_b16 v[66:67], v15 offset:15360
v_mfma_f32_16x16x32_bf16 v[208:211], v[96:99], v[84:87], v[208:211]
ds_read_b64_tr_b16 v[68:69], v16 offset:12288
v_mfma_f32_16x16x32_bf16 v[212:215], v[100:103], v[84:87], v[212:215]
ds_read_b64_tr_b16 v[70:71], v16 offset:15360
v_mfma_f32_16x16x32_bf16 v[188:191], v[100:103], v[80:83], v[188:191]
ds_read_b128 v[36:39], v9 offset:50176
v_mfma_f32_16x16x32_bf16 v[164:167], v[100:103], v[76:79], v[164:167]
ds_read_b128 v[40:43], v9 offset:51200
v_mfma_f32_16x16x32_bf16 v[140:143], v[100:103], v[72:75], v[140:143]
ds_read_b128 v[44:47], v9 offset:52224
v_mfma_f32_16x16x32_bf16 v[144:147], v[104:107], v[72:75], v[144:147]
v_mfma_f32_16x16x32_bf16 v[168:171], v[104:107], v[76:79], v[168:171]
v_mfma_f32_16x16x32_bf16 v[192:195], v[104:107], v[80:83], v[192:195]
s_branch Lov_8
.p2align 12
.fill 64, 4, 0xbf800000
Lst_8_0:
s_branch Lwr_168
Lst_8_1:
s_branch Lwr_179
s_nop 0
Lov_8:
v_mfma_f32_16x16x32_bf16 v[216:219], v[104:107], v[84:87], v[216:219]
v_mfma_f32_16x16x32_bf16 v[220:223], v[108:111], v[84:87], v[220:223]
v_mfma_f32_16x16x32_bf16 v[196:199], v[108:111], v[80:83], v[196:199]
v_mfma_f32_16x16x32_bf16 v[172:175], v[108:111], v[76:79], v[172:175]
v_mfma_f32_16x16x32_bf16 v[148:151], v[108:111], v[72:75], v[148:151]
s_sub_u32 s41, s41, 1
s_cmp_lg_u32 s41, 0
s_cbranch_scc1 Lk3l_123
s_waitcnt lgkmcnt(0)
s_add_u32 s38, s35, 15
s_and_b32 s38, s38, 15
s_mul_i32 s38, s38, 458752
s_add_u32 m0, s40, 0
s_nop 0
buffer_load_dwordx4 v4, s[12:15], s38 offen lds
v_lshrrev_b32 v86, 4, v1
s_lshl_b32 s43, s63, 7
s_add_u32 s43, s43, 148992
v_lshl_add_u32 v87, v86, 4, s43
v_lshrrev_b32 v88, 1, v86
v_and_b32 v86, 1, v86
s_add_u32 m0, s40, 1024
s_nop 0
buffer_load_dwordx4 v5, s[12:15], s38 offen lds
s_lshl_b32 s43, s63, 5
s_add_u32 s43, s43, 149248
v_lshl_add_u32 v88, v88, 6, s43
v_lshl_add_u32 v88, v86, 4, v88
v_and_b32 v86, 15, v1
s_lshl_b32 s43, s62, 9
s_add_u32 m0, s40, 2048
s_add_u32 s38, s38, 57344
buffer_load_dwordx4 v4, s[12:15], s38 offen lds
s_add_u32 s43, s43, 147456
v_lshl_add_u32 v86, v86, 3, s43
ds_read_b128 v[32:35], v87 offset:0
ds_read_b128 v[36:39], v87 offset:64
ds_read_b128 v[40:43], v88 offset:0
ds_read_b128 v[44:47], v87 offset:896
s_add_u32 m0, s40, 3072
s_nop 0
buffer_load_dwordx4 v5, s[12:15], s38 offen lds
ds_read_b128 v[48:51], v87 offset:960
ds_read_b128 v[52:55], v88 offset:896
ds_read_b64 v[56:57], v86 offset:0
ds_read_b64 v[58:59], v86 offset:128
ds_read_b64 v[60:61], v86 offset:256
ds_read_b64 v[62:63], v86 offset:384
s_add_u32 m0, s40, 4096
s_add_u32 s38, s38, 57344
buffer_load_dwordx4 v4, s[12:15], s38 offen lds
s_mul_i32 s54, s35, 24576
s_lshl_b32 s43, s62, 12
s_add_u32 s54, s54, s43
s_add_u32 s54, s54, 524288
s_lshl_b32 s43, s63, 9
s_add_u32 s55, s54, s43
s_add_u32 m0, s40, 5120
s_nop 0
buffer_load_dwordx4 v5, s[12:15], s38 offen lds
s_add_u32 s55, s55, 16384
s_lshl_b32 s43, s63, 13
s_add_u32 s54, s54, s43
v_and_b32 v84, 32, v1
v_lshlrev_b32 v84, 4, v84
v_add_u32 v84, v84, v2
s_waitcnt lgkmcnt(0)
s_add_u32 m0, s40, 6144
s_add_u32 s38, s38, 57344
buffer_load_dwordx4 v4, s[12:15], s38 offen lds
s_add_u32 m0, s40, 7168
s_nop 0
buffer_load_dwordx4 v5, s[12:15], s38 offen lds
s_and_b32 s44, s36, 3
s_mul_i32 s43, s2, 28672
s_mul_i32 s44, s44, 7168
s_add_u32 s43, s43, s44
s_add_u32 s4, s76, s43
s_addc_u32 s5, s77, 0
s_barrier
s_cmp_eq_u32 s47, 3
s_cbranch_scc0 Lw_124
v_and_b32 v90, 31, v1
v_lshlrev_b32 v90, 4, v90
v_add_u32 v91, 153600, v90
ds_read_b128 v[108:111], v91 offset:0
ds_read_b128 v[112:115], v91 offset:512
ds_read_b128 v[116:119], v91 offset:1024
ds_read_b128 v[120:123], v91 offset:1536
s_and_b32 s44, s2, 15
s_mul_i32 s44, s44, 14336
s_lshr_b32 s43, s2, 4
s_lshl_b32 s43, s43, 9
s_add_u32 s44, s44, s43
s_waitcnt lgkmcnt(0)
v_add_f32 v108, v108, v112
v_add_f32 v116, v116, v120
v_add_f32 v109, v109, v113
v_add_f32 v117, v117, v121
v_add_f32 v110, v110, v114
v_add_f32 v118, v118, v122
v_add_f32 v111, v111, v115
v_add_f32 v119, v119, v123
v_add_f32 v108, v108, v116
v_add_f32 v109, v109, v117
v_add_f32 v110, v110, v118
v_add_f32 v111, v111, v119
s_mov_b64 exec, 0xffffffff
buffer_store_dwordx4 v[108:111], v90, s[84:87], s44 offen sc1
s_mov_b64 exec, -1
Lw_124:
s_waitcnt lgkmcnt(0)
s_add_u32 s37, s35, 0
s_and_b32 s37, s37, 15
s_mul_i32 s37, s37, 16384
s_add_u32 m0, s39, 49152
s_nop 0
buffer_load_dwordx4 v3, s[8:11], s37 offen sc1 lds
s_load_dword s3, s[4:5], 1792
s_load_dword s3, s[4:5], 1856
s_load_dword s3, s[4:5], 1920
s_load_dword s3, s[4:5], 1984
s_load_dword s3, s[4:5], 2048
s_load_dword s3, s[4:5], 2112
s_load_dword s3, s[4:5], 2176
buffer_load_dwordx4 v3, s[8:11], s37 offen offset:1024 sc1 lds
s_load_dword s3, s[4:5], 2240
s_load_dword s3, s[4:5], 2304
s_load_dword s3, s[4:5], 2368
s_load_dword s3, s[4:5], 2432
s_load_dword s3, s[4:5], 2496
s_load_dword s3, s[4:5], 2560
s_load_dword s3, s[4:5], 2624
buffer_load_dwordx4 v3, s[8:11], s37 offen offset:2048 sc1 lds
v_mul_f32 v66, v57, v57
v_mul_f32 v64, 0xc0135761, v57
v_mul_f32 v65, 0xbdd2d3e8, v57
v_mul_f32 v65, v65, v66
v_rcp_f32 v66, v66
v_mul_f32 v70, v59, v59
v_mul_f32 v68, 0xc0135761, v59
buffer_load_dwordx4 v3, s[8:11], s37 offen offset:3072 sc1 lds
v_mul_f32 v69, 0xbdd2d3e8, v59
v_mul_f32 v69, v69, v70
v_rcp_f32 v70, v70
v_fma_f32 v128, -v56, v32, v128
v_fma_f32 v129, -v56, v33, v129
v_fma_f32 v130, -v56, v34, v130
v_fma_f32 v131, -v56, v35, v131
v_fma_f32 v152, -v58, v32, v152
s_add_u32 s38, s35, 0
s_and_b32 s38, s38, 15
s_mul_i32 s38, s38, 458752
s_add_u32 m0, s40, 49152
s_nop 0
buffer_load_dwordx4 v4, s[12:15], s38 offen lds
v_fma_f32 v153, -v58, v33, v153
v_fma_f32 v154, -v58, v34, v154
v_fma_f32 v155, -v58, v35, v155
v_mul_f32 v72, v128, v128
v_mul_f32 v73, v129, v129
v_mul_f32 v74, v130, v130
v_mul_f32 v75, v131, v131
s_add_u32 m0, s40, 50176
s_nop 0
buffer_load_dwordx4 v5, s[12:15], s38 offen lds
v_mul_f32 v76, v152, v152
v_mul_f32 v77, v153, v153
v_mul_f32 v78, v154, v154
v_mul_f32 v79, v155, v155
v_fma_f32 v72, v72, v65, v64
v_fma_f32 v73, v73, v65, v64
v_fma_f32 v74, v74, v65, v64
s_add_u32 m0, s40, 51200
s_add_u32 s38, s38, 57344
buffer_load_dwordx4 v4, s[12:15], s38 offen lds
v_fma_f32 v75, v75, v65, v64
v_fma_f32 v76, v76, v69, v68
v_fma_f32 v77, v77, v69, v68
v_fma_f32 v78, v78, v69, v68
v_fma_f32 v79, v79, v69, v68
v_mul_f32 v72, v72, v128
v_mul_f32 v73, v73, v129
v_mul_f32 v74, v74, v130
s_add_u32 m0, s40, 52224
s_nop 0
buffer_load_dwordx4 v5, s[12:15], s38 offen lds
v_mul_f32 v75, v75, v131
v_mul_f32 v76, v76, v152
v_mul_f32 v77, v77, v153
v_mul_f32 v78, v78, v154
v_mul_f32 v79, v79, v155
v_exp_f32 v72, v72
v_exp_f32 v73, v73
s_add_u32 m0, s40, 53248
s_add_u32 s38, s38, 57344
buffer_load_dwordx4 v4, s[12:15], s38 offen lds
v_exp_f32 v74, v74
v_exp_f32 v75, v75
v_exp_f32 v76, v76
v_exp_f32 v77, v77
v_exp_f32 v78, v78
v_exp_f32 v79, v79
v_fma_f32 v140, -v56, v44, v140
s_add_u32 m0, s40, 54272
s_nop 0
buffer_load_dwordx4 v5, s[12:15], s38 offen lds
v_fma_f32 v141, -v56, v45, v141
v_fma_f32 v142, -v56, v46, v142
v_fma_f32 v143, -v56, v47, v143
v_fma_f32 v164, -v58, v44, v164
v_fma_f32 v165, -v58, v45, v165
v_fma_f32 v166, -v58, v46, v166
v_fma_f32 v167, -v58, v47, v167
v_fma_f32 v72, v72, v66, v66
s_add_u32 m0, s40, 55296
s_add_u32 s38, s38, 57344
buffer_load_dwordx4 v4, s[12:15], s38 offen lds
s_add_u32 m0, s40, 56320
s_nop 0
buffer_load_dwordx4 v5, s[12:15], s38 offen lds
s_waitcnt vmcnt(12)
s_barrier
s_add_u32 s37, s35, 1
s_and_b32 s37, s37, 15
s_mul_i32 s37, s37, 16384
s_add_u32 m0, s39, 98304
s_nop 0
buffer_load_dwordx4 v3, s[8:11], s37 offen sc1 lds
v_fma_f32 v73, v73, v66, v66
v_fma_f32 v74, v74, v66, v66
v_fma_f32 v75, v75, v66, v66
v_fma_f32 v76, v76, v70, v70
v_fma_f32 v77, v77, v70, v70
v_fma_f32 v78, v78, v70, v70
buffer_load_dwordx4 v3, s[8:11], s37 offen offset:1024 sc1 lds
v_fma_f32 v79, v79, v70, v70
v_rcp_f32 v72, v72
v_rcp_f32 v73, v73
v_rcp_f32 v74, v74
v_rcp_f32 v75, v75
v_rcp_f32 v76, v76
buffer_load_dwordx4 v3, s[8:11], s37 offen offset:2048 sc1 lds
v_rcp_f32 v77, v77
v_rcp_f32 v78, v78
v_rcp_f32 v79, v79
v_mul_f32 v140, v128, v140
v_mul_f32 v141, v129, v141
v_mul_f32 v142, v130, v142
buffer_load_dwordx4 v3, s[8:11], s37 offen offset:3072 sc1 lds
v_mul_f32 v143, v131, v143
v_mul_f32 v164, v152, v164
v_mul_f32 v165, v153, v165
v_mul_f32 v166, v154, v166
v_mul_f32 v167, v155, v167
v_mul_f32 v140, v140, v72
s_add_u32 s38, s35, 1
s_and_b32 s38, s38, 15
s_mul_i32 s38, s38, 458752
s_add_u32 m0, s40, 98304
s_nop 0
buffer_load_dwordx4 v4, s[12:15], s38 offen lds
v_mul_f32 v141, v141, v73
v_mul_f32 v142, v142, v74
v_mul_f32 v143, v143, v75
v_mul_f32 v164, v164, v76
v_mul_f32 v165, v165, v77
v_mul_f32 v166, v166, v78
s_add_u32 m0, s40, 99328
s_nop 0
buffer_load_dwordx4 v5, s[12:15], s38 offen lds
v_mul_f32 v167, v167, v79
v_cvt_pk_bf16_f32 v128, v140, v141
v_cvt_pk_bf16_f32 v129, v142, v143
v_cvt_pk_bf16_f32 v152, v164, v165
v_cvt_pk_bf16_f32 v153, v166, v167
v_fma_f32 v132, -v56, v36, v132
s_add_u32 m0, s40, 100352
s_add_u32 s38, s38, 57344
buffer_load_dwordx4 v4, s[12:15], s38 offen lds
v_fma_f32 v133, -v56, v37, v133
v_fma_f32 v134, -v56, v38, v134
v_fma_f32 v135, -v56, v39, v135
v_fma_f32 v156, -v58, v36, v156
v_fma_f32 v157, -v58, v37, v157
v_fma_f32 v158, -v58, v38, v158
s_add_u32 m0, s40, 101376
s_nop 0
buffer_load_dwordx4 v5, s[12:15], s38 offen lds
v_fma_f32 v159, -v58, v39, v159
v_mul_f32 v72, v132, v132
v_mul_f32 v73, v133, v133
v_mul_f32 v74, v134, v134
v_mul_f32 v75, v135, v135
v_mul_f32 v76, v156, v156
s_add_u32 m0, s40, 102400
s_add_u32 s38, s38, 57344
buffer_load_dwordx4 v4, s[12:15], s38 offen lds
v_mul_f32 v77, v157, v157
v_mul_f32 v78, v158, v158
v_mul_f32 v79, v159, v159
v_fma_f32 v72, v72, v65, v64
v_fma_f32 v73, v73, v65, v64
v_fma_f32 v74, v74, v65, v64
s_add_u32 m0, s40, 103424
s_nop 0
buffer_load_dwordx4 v5, s[12:15], s38 offen lds
v_fma_f32 v75, v75, v65, v64
v_fma_f32 v76, v76, v69, v68
v_fma_f32 v77, v77, v69, v68
v_fma_f32 v78, v78, v69, v68
v_fma_f32 v79, v79, v69, v68
v_mul_f32 v72, v72, v132
s_add_u32 m0, s40, 104448
s_add_u32 s38, s38, 57344
buffer_load_dwordx4 v4, s[12:15], s38 offen lds
s_add_u32 m0, s40, 105472
s_nop 0
buffer_load_dwordx4 v5, s[12:15], s38 offen lds
s_waitcnt vmcnt(12)
s_barrier
s_cmp_eq_u32 s47, 3
s_cbranch_scc0 Lw_125
s_lshr_b32 s43, s2, 4
s_add_u32 s43, s43, 80
s_lshl_b32 s43, s43, 7
v_mov_b32 v90, s43
v_mov_b32 v91, 1
s_mov_b64 exec, 1
buffer_atomic_add v91, v90, s[56:59], 0 offen sc1
s_mov_b64 exec, -1
Lw_125:
s_waitcnt lgkmcnt(0)
s_add_u32 s37, s35, 2
s_and_b32 s37, s37, 15
s_mul_i32 s37, s37, 16384
s_add_u32 m0, s39, 0
s_nop 0
buffer_load_dwordx4 v3, s[8:11], s37 offen sc1 lds
s_load_dword s3, s[4:5], 2688
s_load_dword s3, s[4:5], 2752
s_load_dword s3, s[4:5], 2816
s_load_dword s3, s[4:5], 2880
s_load_dword s3, s[4:5], 2944
s_load_dword s3, s[4:5], 3008
s_load_dword s3, s[4:5], 3072
buffer_load_dwordx4 v3, s[8:11], s37 offen offset:1024 sc1 lds
s_load_dword s3, s[4:5], 3136
s_load_dword s3, s[4:5], 3200
s_load_dword s3, s[4:5], 3264
s_load_dword s3, s[4:5], 3328
s_load_dword s3, s[4:5], 3392
s_load_dword s3, s[4:5], 3456
s_load_dword s3, s[4:5], 3520
buffer_load_dwordx4 v3, s[8:11], s37 offen offset:2048 sc1 lds
v_mul_f32 v73, v73, v133
v_mul_f32 v74, v74, v134
v_mul_f32 v75, v75, v135
v_mul_f32 v76, v76, v156
v_mul_f32 v77, v77, v157
v_mul_f32 v78, v78, v158
v_mul_f32 v79, v79, v159
v_exp_f32 v72, v72
buffer_load_dwordx4 v3, s[8:11], s37 offen offset:3072 sc1 lds
v_exp_f32 v73, v73
v_exp_f32 v74, v74
v_exp_f32 v75, v75
v_exp_f32 v76, v76
v_exp_f32 v77, v77
v_exp_f32 v78, v78
v_exp_f32 v79, v79
s_add_u32 s38, s35, 2
s_and_b32 s38, s38, 15
s_mul_i32 s38, s38, 458752
s_add_u32 m0, s40, 0
s_nop 0
buffer_load_dwordx4 v4, s[12:15], s38 offen lds
v_fma_f32 v144, -v56, v48, v144
v_fma_f32 v145, -v56, v49, v145
v_fma_f32 v146, -v56, v50, v146
v_fma_f32 v147, -v56, v51, v147
v_fma_f32 v168, -v58, v48, v168
v_fma_f32 v169, -v58, v49, v169
v_fma_f32 v170, -v58, v50, v170
v_fma_f32 v171, -v58, v51, v171
s_add_u32 m0, s40, 1024
s_nop 0
buffer_load_dwordx4 v5, s[12:15], s38 offen lds
v_fma_f32 v72, v72, v66, v66
v_fma_f32 v73, v73, v66, v66
v_fma_f32 v74, v74, v66, v66
v_fma_f32 v75, v75, v66, v66
v_fma_f32 v76, v76, v70, v70
v_fma_f32 v77, v77, v70, v70
v_fma_f32 v78, v78, v70, v70
s_add_u32 m0, s40, 2048
s_add_u32 s38, s38, 57344
buffer_load_dwordx4 v4, s[12:15], s38 offen lds
v_fma_f32 v79, v79, v70, v70
v_rcp_f32 v72, v72
v_rcp_f32 v73, v73
v_rcp_f32 v74, v74
v_rcp_f32 v75, v75
v_rcp_f32 v76, v76
v_rcp_f32 v77, v77
s_add_u32 m0, s40, 3072
s_nop 0
buffer_load_dwordx4 v5, s[12:15], s38 offen lds
v_rcp_f32 v78, v78
v_rcp_f32 v79, v79
v_mul_f32 v144, v132, v144
v_mul_f32 v145, v133, v145
v_mul_f32 v146, v134, v146
v_mul_f32 v147, v135, v147
v_mul_f32 v168, v156, v168
v_mul_f32 v169, v157, v169
s_add_u32 m0, s40, 4096
s_add_u32 s38, s38, 57344
buffer_load_dwordx4 v4, s[12:15], s38 offen lds
v_mul_f32 v170, v158, v170
v_mul_f32 v171, v159, v171
v_mul_f32 v144, v144, v72
v_mul_f32 v145, v145, v73
v_mul_f32 v146, v146, v74
v_mul_f32 v147, v147, v75
v_mul_f32 v168, v168, v76
s_add_u32 m0, s40, 5120
s_nop 0
buffer_load_dwordx4 v5, s[12:15], s38 offen lds
v_mul_f32 v169, v169, v77
v_mul_f32 v170, v170, v78
v_mul_f32 v171, v171, v79
v_cvt_pk_bf16_f32 v130, v144, v145
v_cvt_pk_bf16_f32 v131, v146, v147
v_cvt_pk_bf16_f32 v154, v168, v169
v_cvt_pk_bf16_f32 v155, v170, v171
buffer_store_dwordx4 v[128:131], v2, s[24:27], s54 offen offset:0 sc1
s_add_u32 m0, s40, 6144
s_add_u32 s38, s38, 57344
buffer_load_dwordx4 v4, s[12:15], s38 offen lds
s_add_u32 m0, s40, 7168
s_nop 0
buffer_load_dwordx4 v5, s[12:15], s38 offen lds
s_waitcnt vmcnt(13)
s_barrier
s_add_u32 s37, s35, 3
s_and_b32 s37, s37, 15
s_mul_i32 s37, s37, 16384
s_add_u32 m0, s39, 49152
s_nop 0
buffer_load_dwordx4 v3, s[8:11], s37 offen sc1 lds
buffer_store_dwordx4 v[152:155], v2, s[24:27], s54 offen offset:1024 sc1
v_fma_f32 v136, -v56, v40, v136
v_fma_f32 v137, -v56, v41, v137
v_fma_f32 v138, -v56, v42, v138
v_fma_f32 v139, -v56, v43, v139
v_fma_f32 v160, -v58, v40, v160
buffer_load_dwordx4 v3, s[8:11], s37 offen offset:1024 sc1 lds
v_fma_f32 v161, -v58, v41, v161
v_fma_f32 v162, -v58, v42, v162
v_fma_f32 v163, -v58, v43, v163
v_mul_f32 v72, v136, v136
v_mul_f32 v73, v137, v137
v_mul_f32 v74, v138, v138
buffer_load_dwordx4 v3, s[8:11], s37 offen offset:2048 sc1 lds
v_mul_f32 v75, v139, v139
v_mul_f32 v76, v160, v160
v_mul_f32 v77, v161, v161
v_mul_f32 v78, v162, v162
v_mul_f32 v79, v163, v163
v_fma_f32 v72, v72, v65, v64
buffer_load_dwordx4 v3, s[8:11], s37 offen offset:3072 sc1 lds
v_fma_f32 v73, v73, v65, v64
v_fma_f32 v74, v74, v65, v64
v_fma_f32 v75, v75, v65, v64
v_fma_f32 v76, v76, v69, v68
v_fma_f32 v77, v77, v69, v68
v_fma_f32 v78, v78, v69, v68
s_add_u32 s38, s35, 3
s_and_b32 s38, s38, 15
s_mul_i32 s38, s38, 458752
s_add_u32 m0, s40, 49152
s_nop 0
buffer_load_dwordx4 v4, s[12:15], s38 offen lds
v_fma_f32 v79, v79, v69, v68
v_mul_f32 v72, v72, v136
v_mul_f32 v73, v73, v137
v_mul_f32 v74, v74, v138
v_mul_f32 v75, v75, v139
v_mul_f32 v76, v76, v160
s_add_u32 m0, s40, 50176
s_nop 0
buffer_load_dwordx4 v5, s[12:15], s38 offen lds
v_mul_f32 v77, v77, v161
v_mul_f32 v78, v78, v162
v_mul_f32 v79, v79, v163
v_exp_f32 v72, v72
v_exp_f32 v73, v73
v_exp_f32 v74, v74
s_add_u32 m0, s40, 51200
s_add_u32 s38, s38, 57344
buffer_load_dwordx4 v4, s[12:15], s38 offen lds
v_exp_f32 v75, v75
v_exp_f32 v76, v76
v_exp_f32 v77, v77
v_exp_f32 v78, v78
v_exp_f32 v79, v79
v_fma_f32 v148, -v56, v52, v148
s_add_u32 m0, s40, 52224
s_nop 0
buffer_load_dwordx4 v5, s[12:15], s38 offen lds
v_fma_f32 v149, -v56, v53, v149
v_fma_f32 v150, -v56, v54, v150
v_fma_f32 v151, -v56, v55, v151
v_fma_f32 v172, -v58, v52, v172
v_fma_f32 v173, -v58, v53, v173
v_fma_f32 v174, -v58, v54, v174
s_add_u32 m0, s40, 53248
s_add_u32 s38, s38, 57344
buffer_load_dwordx4 v4, s[12:15], s38 offen lds
v_fma_f32 v175, -v58, v55, v175
v_fma_f32 v72, v72, v66, v66
v_fma_f32 v73, v73, v66, v66
v_fma_f32 v74, v74, v66, v66
v_fma_f32 v75, v75, v66, v66
v_fma_f32 v76, v76, v70, v70
s_add_u32 m0, s40, 54272
s_nop 0
buffer_load_dwordx4 v5, s[12:15], s38 offen lds
v_fma_f32 v77, v77, v70, v70
v_fma_f32 v78, v78, v70, v70
v_fma_f32 v79, v79, v70, v70
v_rcp_f32 v72, v72
v_rcp_f32 v73, v73
v_rcp_f32 v74, v74
s_add_u32 m0, s40, 55296
s_add_u32 s38, s38, 57344
buffer_load_dwordx4 v4, s[12:15], s38 offen lds
s_add_u32 m0, s40, 56320
s_nop 0
buffer_load_dwordx4 v5, s[12:15], s38 offen lds
s_waitcnt vmcnt(13)
s_barrier
s_waitcnt lgkmcnt(0)
s_add_u32 s37, s35, 4
s_and_b32 s37, s37, 15
s_mul_i32 s37, s37, 16384
s_add_u32 m0, s39, 98304
s_nop 0
buffer_load_dwordx4 v3, s[8:11], s37 offen sc1 lds
s_load_dword s3, s[4:5], 3584
s_load_dword s3, s[4:5], 3648
s_load_dword s3, s[4:5], 3712
s_load_dword s3, s[4:5], 3776
s_load_dword s3, s[4:5], 3840
s_load_dword s3, s[4:5], 3904
s_load_dword s3, s[4:5], 3968
buffer_load_dwordx4 v3, s[8:11], s37 offen offset:1024 sc1 lds
s_load_dword s3, s[4:5], 4032
s_load_dword s3, s[4:5], 4096
s_load_dword s3, s[4:5], 4160
s_load_dword s3, s[4:5], 4224
s_load_dword s3, s[4:5], 4288
s_load_dword s3, s[4:5], 4352
s_load_dword s3, s[4:5], 4416
buffer_load_dwordx4 v3, s[8:11], s37 offen offset:2048 sc1 lds
v_rcp_f32 v75, v75
v_rcp_f32 v76, v76
v_rcp_f32 v77, v77
v_rcp_f32 v78, v78
v_rcp_f32 v79, v79
v_mul_f32 v148, v136, v148
v_mul_f32 v149, v137, v149
buffer_load_dwordx4 v3, s[8:11], s37 offen offset:3072 sc1 lds
v_mul_f32 v150, v138, v150
v_mul_f32 v151, v139, v151
v_mul_f32 v172, v160, v172
v_mul_f32 v173, v161, v173
v_mul_f32 v174, v162, v174
v_mul_f32 v175, v163, v175
v_mul_f32 v148, v148, v72
v_mul_f32 v149, v149, v73
s_add_u32 s38, s35, 4
s_and_b32 s38, s38, 15
s_mul_i32 s38, s38, 458752
s_add_u32 m0, s40, 98304
s_nop 0
buffer_load_dwordx4 v4, s[12:15], s38 offen lds
v_mul_f32 v150, v150, v74
v_mul_f32 v151, v151, v75
v_mul_f32 v172, v172, v76
v_mul_f32 v173, v173, v77
v_mul_f32 v174, v174, v78
v_mul_f32 v175, v175, v79
v_cvt_pk_bf16_f32 v80, v148, v149
s_add_u32 m0, s40, 99328
s_nop 0
buffer_load_dwordx4 v5, s[12:15], s38 offen lds
v_cvt_pk_bf16_f32 v81, v150, v151
v_cvt_pk_bf16_f32 v82, v172, v173
v_cvt_pk_bf16_f32 v83, v174, v175
s_nop 1
v_permlane32_swap_b32 v80, v82
v_permlane32_swap_b32 v81, v83
buffer_store_dwordx4 v[80:83], v84, s[24:27], s55 offen offset:0 sc1
s_add_u32 m0, s40, 100352
s_add_u32 s38, s38, 57344
buffer_load_dwordx4 v4, s[12:15], s38 offen lds
s_nop 1
v_mul_f32 v66, v61, v61
v_mul_f32 v64, 0xc0135761, v61
v_mul_f32 v65, 0xbdd2d3e8, v61
v_mul_f32 v65, v65, v66
v_rcp_f32 v66, v66
v_mul_f32 v70, v63, v63
v_mul_f32 v68, 0xc0135761, v63
s_add_u32 m0, s40, 101376
s_nop 0
buffer_load_dwordx4 v5, s[12:15], s38 offen lds
v_mul_f32 v69, 0xbdd2d3e8, v63
v_mul_f32 v69, v69, v70
v_rcp_f32 v70, v70
s_branch Lov_9
.p2align 12
.fill 64, 4, 0xbf800000
Lst_9_0:
s_branch Lwr_169
Lst_9_1:
s_branch Lwr_180
s_nop 0
Lov_9:
v_fma_f32 v176, -v60, v32, v176
v_fma_f32 v177, -v60, v33, v177
v_fma_f32 v178, -v60, v34, v178
v_fma_f32 v179, -v60, v35, v179
s_add_u32 m0, s40, 102400
s_add_u32 s38, s38, 57344
buffer_load_dwordx4 v4, s[12:15], s38 offen lds
v_fma_f32 v200, -v62, v32, v200
v_fma_f32 v201, -v62, v33, v201
v_fma_f32 v202, -v62, v34, v202
v_fma_f32 v203, -v62, v35, v203
v_mul_f32 v72, v176, v176
v_mul_f32 v73, v177, v177
v_mul_f32 v74, v178, v178
s_add_u32 m0, s40, 103424
s_nop 0
buffer_load_dwordx4 v5, s[12:15], s38 offen lds
v_mul_f32 v75, v179, v179
v_mul_f32 v76, v200, v200
v_mul_f32 v77, v201, v201
v_mul_f32 v78, v202, v202
v_mul_f32 v79, v203, v203
v_fma_f32 v72, v72, v65, v64
v_fma_f32 v73, v73, v65, v64
v_fma_f32 v74, v74, v65, v64
s_add_u32 m0, s40, 104448
s_add_u32 s38, s38, 57344
buffer_load_dwordx4 v4, s[12:15], s38 offen lds
s_add_u32 m0, s40, 105472
s_nop 0
buffer_load_dwordx4 v5, s[12:15], s38 offen lds
s_waitcnt vmcnt(13)
s_barrier
s_add_u32 s37, s35, 5
s_and_b32 s37, s37, 15
s_mul_i32 s37, s37, 16384
s_add_u32 m0, s39, 0
s_nop 0
buffer_load_dwordx4 v3, s[8:11], s37 offen sc1 lds
v_fma_f32 v75, v75, v65, v64
v_fma_f32 v76, v76, v69, v68
v_fma_f32 v77, v77, v69, v68
v_fma_f32 v78, v78, v69, v68
v_fma_f32 v79, v79, v69, v68
v_mul_f32 v72, v72, v176
buffer_load_dwordx4 v3, s[8:11], s37 offen offset:1024 sc1 lds
v_mul_f32 v73, v73, v177
v_mul_f32 v74, v74, v178
v_mul_f32 v75, v75, v179
v_mul_f32 v76, v76, v200
v_mul_f32 v77, v77, v201
v_mul_f32 v78, v78, v202
buffer_load_dwordx4 v3, s[8:11], s37 offen offset:2048 sc1 lds
v_mul_f32 v79, v79, v203
v_exp_f32 v72, v72
v_exp_f32 v73, v73
v_exp_f32 v74, v74
v_exp_f32 v75, v75
v_exp_f32 v76, v76
buffer_load_dwordx4 v3, s[8:11], s37 offen offset:3072 sc1 lds
v_exp_f32 v77, v77
v_exp_f32 v78, v78
v_exp_f32 v79, v79
v_fma_f32 v188, -v60, v44, v188
v_fma_f32 v189, -v60, v45, v189
v_fma_f32 v190, -v60, v46, v190
s_add_u32 s38, s35, 5
s_and_b32 s38, s38, 15
s_mul_i32 s38, s38, 458752
s_add_u32 m0, s40, 0
s_nop 0
buffer_load_dwordx4 v4, s[12:15], s38 offen lds
v_fma_f32 v191, -v60, v47, v191
v_fma_f32 v212, -v62, v44, v212
v_fma_f32 v213, -v62, v45, v213
v_fma_f32 v214, -v62, v46, v214
v_fma_f32 v215, -v62, v47, v215
v_fma_f32 v72, v72, v66, v66
s_add_u32 m0, s40, 1024
s_nop 0
buffer_load_dwordx4 v5, s[12:15], s38 offen lds
v_fma_f32 v73, v73, v66, v66
v_fma_f32 v74, v74, v66, v66
v_fma_f32 v75, v75, v66, v66
v_fma_f32 v76, v76, v70, v70
v_fma_f32 v77, v77, v70, v70
v_fma_f32 v78, v78, v70, v70
s_add_u32 m0, s40, 2048
s_add_u32 s38, s38, 57344
buffer_load_dwordx4 v4, s[12:15], s38 offen lds
v_fma_f32 v79, v79, v70, v70
v_rcp_f32 v72, v72
v_rcp_f32 v73, v73
v_rcp_f32 v74, v74
v_rcp_f32 v75, v75
v_rcp_f32 v76, v76
s_add_u32 m0, s40, 3072
s_nop 0
buffer_load_dwordx4 v5, s[12:15], s38 offen lds
v_rcp_f32 v77, v77
v_rcp_f32 v78, v78
v_rcp_f32 v79, v79
v_mul_f32 v188, v176, v188
v_mul_f32 v189, v177, v189
v_mul_f32 v190, v178, v190
s_add_u32 m0, s40, 4096
s_add_u32 s38, s38, 57344
buffer_load_dwordx4 v4, s[12:15], s38 offen lds
v_mul_f32 v191, v179, v191
v_mul_f32 v212, v200, v212
v_mul_f32 v213, v201, v213
v_mul_f32 v214, v202, v214
v_mul_f32 v215, v203, v215
v_mul_f32 v188, v188, v72
s_add_u32 m0, s40, 5120
s_nop 0
buffer_load_dwordx4 v5, s[12:15], s38 offen lds
v_mul_f32 v189, v189, v73
v_mul_f32 v190, v190, v74
v_mul_f32 v191, v191, v75
v_mul_f32 v212, v212, v76
v_mul_f32 v213, v213, v77
v_mul_f32 v214, v214, v78
s_add_u32 m0, s40, 6144
s_add_u32 s38, s38, 57344
buffer_load_dwordx4 v4, s[12:15], s38 offen lds
s_add_u32 m0, s40, 7168
s_nop 0
buffer_load_dwordx4 v5, s[12:15], s38 offen lds
s_waitcnt vmcnt(12)
s_barrier
s_waitcnt lgkmcnt(0)
s_cmp_eq_u32 s47, 3
s_cbranch_scc0 Lw_126
s_lshl_b32 s60, s35, 7
s_add_u32 s60, s60, 28321792
s_mov_b32 s61, s60
s_load_dword s92, s[82:83], s60 glc
s_load_dword s93, s[82:83], s61 glc
Lw_126:
s_add_u32 s37, s35, 6
s_and_b32 s37, s37, 15
s_mul_i32 s37, s37, 16384
s_add_u32 m0, s39, 49152
s_nop 0
buffer_load_dwordx4 v3, s[8:11], s37 offen sc1 lds
s_load_dword s3, s[4:5], 4480
s_load_dword s3, s[4:5], 4544
s_load_dword s3, s[4:5], 4608
s_load_dword s3, s[4:5], 4672
s_load_dword s3, s[4:5], 4736
s_load_dword s3, s[4:5], 4800
s_load_dword s3, s[4:5], 4864
buffer_load_dwordx4 v3, s[8:11], s37 offen offset:1024 sc1 lds
s_load_dword s3, s[4:5], 4928
s_load_dword s3, s[4:5], 4992
s_load_dword s3, s[4:5], 5056
s_load_dword s3, s[4:5], 5120
s_load_dword s3, s[4:5], 5184
s_load_dword s3, s[4:5], 5248
s_load_dword s3, s[4:5], 5312
buffer_load_dwordx4 v3, s[8:11], s37 offen offset:2048 sc1 lds
v_mul_f32 v215, v215, v79
v_cvt_pk_bf16_f32 v176, v188, v189
v_cvt_pk_bf16_f32 v177, v190, v191
v_cvt_pk_bf16_f32 v200, v212, v213
v_cvt_pk_bf16_f32 v201, v214, v215
v_fma_f32 v180, -v60, v36, v180
v_fma_f32 v181, -v60, v37, v181
v_fma_f32 v182, -v60, v38, v182
buffer_load_dwordx4 v3, s[8:11], s37 offen offset:3072 sc1 lds
v_fma_f32 v183, -v60, v39, v183
v_fma_f32 v204, -v62, v36, v204
v_fma_f32 v205, -v62, v37, v205
v_fma_f32 v206, -v62, v38, v206
v_fma_f32 v207, -v62, v39, v207
v_mul_f32 v72, v180, v180
v_mul_f32 v73, v181, v181
s_add_u32 s38, s35, 6
s_and_b32 s38, s38, 15
s_mul_i32 s38, s38, 458752
s_add_u32 m0, s40, 49152
s_nop 0
buffer_load_dwordx4 v4, s[12:15], s38 offen lds
v_mul_f32 v74, v182, v182
v_mul_f32 v75, v183, v183
v_mul_f32 v76, v204, v204
v_mul_f32 v77, v205, v205
v_mul_f32 v78, v206, v206
v_mul_f32 v79, v207, v207
v_fma_f32 v72, v72, v65, v64
v_fma_f32 v73, v73, v65, v64
s_add_u32 m0, s40, 50176
s_nop 0
buffer_load_dwordx4 v5, s[12:15], s38 offen lds
v_fma_f32 v74, v74, v65, v64
v_fma_f32 v75, v75, v65, v64
v_fma_f32 v76, v76, v69, v68
v_fma_f32 v77, v77, v69, v68
v_fma_f32 v78, v78, v69, v68
v_fma_f32 v79, v79, v69, v68
v_mul_f32 v72, v72, v180
s_add_u32 m0, s40, 51200
s_add_u32 s38, s38, 57344
buffer_load_dwordx4 v4, s[12:15], s38 offen lds
v_mul_f32 v73, v73, v181
v_mul_f32 v74, v74, v182
v_mul_f32 v75, v75, v183
v_mul_f32 v76, v76, v204
v_mul_f32 v77, v77, v205
v_mul_f32 v78, v78, v206
v_mul_f32 v79, v79, v207
s_add_u32 m0, s40, 52224
s_nop 0
buffer_load_dwordx4 v5, s[12:15], s38 offen lds
v_exp_f32 v72, v72
v_exp_f32 v73, v73
v_exp_f32 v74, v74
v_exp_f32 v75, v75
v_exp_f32 v76, v76
v_exp_f32 v77, v77
v_exp_f32 v78, v78
v_exp_f32 v79, v79
s_add_u32 m0, s40, 53248
s_add_u32 s38, s38, 57344
buffer_load_dwordx4 v4, s[12:15], s38 offen lds
v_fma_f32 v192, -v60, v48, v192
v_fma_f32 v193, -v60, v49, v193
v_fma_f32 v194, -v60, v50, v194
v_fma_f32 v195, -v60, v51, v195
v_fma_f32 v216, -v62, v48, v216
v_fma_f32 v217, -v62, v49, v217
v_fma_f32 v218, -v62, v50, v218
s_add_u32 m0, s40, 54272
s_nop 0
buffer_load_dwordx4 v5, s[12:15], s38 offen lds
v_fma_f32 v219, -v62, v51, v219
v_fma_f32 v72, v72, v66, v66
v_fma_f32 v73, v73, v66, v66
v_fma_f32 v74, v74, v66, v66
v_fma_f32 v75, v75, v66, v66
v_fma_f32 v76, v76, v70, v70
v_fma_f32 v77, v77, v70, v70
v_fma_f32 v78, v78, v70, v70
s_add_u32 m0, s40, 55296
s_add_u32 s38, s38, 57344
buffer_load_dwordx4 v4, s[12:15], s38 offen lds
s_add_u32 m0, s40, 56320
s_nop 0
buffer_load_dwordx4 v5, s[12:15], s38 offen lds
s_waitcnt vmcnt(12)
s_barrier
s_add_u32 s37, s35, 7
s_and_b32 s37, s37, 15
s_mul_i32 s37, s37, 16384
s_add_u32 m0, s39, 98304
s_nop 0
buffer_load_dwordx4 v3, s[8:11], s37 offen sc1 lds
v_fma_f32 v79, v79, v70, v70
v_rcp_f32 v72, v72
v_rcp_f32 v73, v73
v_rcp_f32 v74, v74
v_rcp_f32 v75, v75
v_rcp_f32 v76, v76
buffer_load_dwordx4 v3, s[8:11], s37 offen offset:1024 sc1 lds
v_rcp_f32 v77, v77
v_rcp_f32 v78, v78
v_rcp_f32 v79, v79
v_mul_f32 v192, v180, v192
v_mul_f32 v193, v181, v193
v_mul_f32 v194, v182, v194
buffer_load_dwordx4 v3, s[8:11], s37 offen offset:2048 sc1 lds
v_mul_f32 v195, v183, v195
v_mul_f32 v216, v204, v216
v_mul_f32 v217, v205, v217
v_mul_f32 v218, v206, v218
v_mul_f32 v219, v207, v219
v_mul_f32 v192, v192, v72
buffer_load_dwordx4 v3, s[8:11], s37 offen offset:3072 sc1 lds
v_mul_f32 v193, v193, v73
v_mul_f32 v194, v194, v74
v_mul_f32 v195, v195, v75
v_mul_f32 v216, v216, v76
v_mul_f32 v217, v217, v77
v_mul_f32 v218, v218, v78
s_add_u32 s38, s35, 7
s_and_b32 s38, s38, 15
s_mul_i32 s38, s38, 458752
s_add_u32 m0, s40, 98304
s_nop 0
buffer_load_dwordx4 v4, s[12:15], s38 offen lds
v_mul_f32 v219, v219, v79
v_cvt_pk_bf16_f32 v178, v192, v193
v_cvt_pk_bf16_f32 v179, v194, v195
v_cvt_pk_bf16_f32 v202, v216, v217
v_cvt_pk_bf16_f32 v203, v218, v219
buffer_store_dwordx4 v[176:179], v2, s[24:27], s54 offen offset:2048 sc1
s_add_u32 m0, s40, 99328
s_nop 0
buffer_load_dwordx4 v5, s[12:15], s38 offen lds
buffer_store_dwordx4 v[200:203], v2, s[24:27], s54 offen offset:3072 sc1
v_fma_f32 v184, -v60, v40, v184
v_fma_f32 v185, -v60, v41, v185
v_fma_f32 v186, -v60, v42, v186
v_fma_f32 v187, -v60, v43, v187
v_fma_f32 v208, -v62, v40, v208
s_add_u32 m0, s40, 100352
s_add_u32 s38, s38, 57344
buffer_load_dwordx4 v4, s[12:15], s38 offen lds
v_fma_f32 v209, -v62, v41, v209
v_fma_f32 v210, -v62, v42, v210
v_fma_f32 v211, -v62, v43, v211
v_mul_f32 v72, v184, v184
v_mul_f32 v73, v185, v185
v_mul_f32 v74, v186, v186
s_add_u32 m0, s40, 101376
s_nop 0
buffer_load_dwordx4 v5, s[12:15], s38 offen lds
v_mul_f32 v75, v187, v187
v_mul_f32 v76, v208, v208
v_mul_f32 v77, v209, v209
v_mul_f32 v78, v210, v210
v_mul_f32 v79, v211, v211
v_fma_f32 v72, v72, v65, v64
s_add_u32 m0, s40, 102400
s_add_u32 s38, s38, 57344
buffer_load_dwordx4 v4, s[12:15], s38 offen lds
v_fma_f32 v73, v73, v65, v64
v_fma_f32 v74, v74, v65, v64
v_fma_f32 v75, v75, v65, v64
v_fma_f32 v76, v76, v69, v68
v_fma_f32 v77, v77, v69, v68
v_fma_f32 v78, v78, v69, v68
s_add_u32 m0, s40, 103424
s_nop 0
buffer_load_dwordx4 v5, s[12:15], s38 offen lds
v_fma_f32 v79, v79, v69, v68
v_mul_f32 v72, v72, v184
v_mul_f32 v73, v73, v185
v_mul_f32 v74, v74, v186
v_mul_f32 v75, v75, v187
v_mul_f32 v76, v76, v208
s_add_u32 m0, s40, 104448
s_add_u32 s38, s38, 57344
buffer_load_dwordx4 v4, s[12:15], s38 offen lds
s_add_u32 m0, s40, 105472
s_nop 0
buffer_load_dwordx4 v5, s[12:15], s38 offen lds
s_waitcnt vmcnt(14)
s_cmp_eq_u32 s47, 3
s_cbranch_scc0 Lw_127
s_mov_b32 s41, 0x40000
Lcp_128:
s_waitcnt lgkmcnt(0)
s_and_b32 s92, s92, s93
s_cmp_eq_u32 s92, 16
s_cbranch_scc1 Lco_129
s_load_dword s92, s[82:83], s60 glc
s_load_dword s93, s[82:83], s61 glc
s_sub_u32 s41, s41, 1
s_cmp_lg_u32 s41, 0
s_cbranch_scc1 Lcp_128
s_waitcnt lgkmcnt(0)
Lco_129:
Lw_127:
s_barrier
s_lshl_b32 s60, s35, 9
s_lshl_b32 s43, s47, 7
s_add_u32 s60, s60, s43
s_add_u32 s61, s60, 14336
s_add_u32 s52, s43, 148480
s_add_u32 s53, s52, 896
v_lshrrev_b32 v104, 3, v1
v_mul_u32_u24 v104, 28672, v104
v_and_b32 v105, 7, v1
v_lshl_add_u32 v104, v105, 4, v104
s_waitcnt lgkmcnt(0)
buffer_load_dwordx4 v[96:99], v104, s[84:87], s60 offen sc1
s_load_dword s3, s[4:5], 5376
s_load_dword s3, s[4:5], 5440
s_load_dword s3, s[4:5], 5504
s_load_dword s3, s[4:5], 5568
s_load_dword s3, s[4:5], 5632
s_load_dword s3, s[4:5], 5696
buffer_load_dwordx4 v[100:103], v104, s[84:87], s61 offen sc1
s_load_dword s3, s[4:5], 5760
s_load_dword s3, s[4:5], 5824
s_load_dword s3, s[4:5], 5888
s_load_dword s3, s[4:5], 5952
s_load_dword s3, s[4:5], 6016
s_load_dword s3, s[4:5], 6080
s_load_dword s3, s[4:5], 6144
s_add_u32 s37, s35, 8
s_and_b32 s37, s37, 15
s_mul_i32 s37, s37, 16384
s_add_u32 m0, s39, 0
s_nop 0
buffer_load_dwordx4 v3, s[8:11], s37 offen sc1 lds
s_load_dword s3, s[4:5], 6208
v_mul_f32 v77, v77, v209
v_mul_f32 v78, v78, v210
v_mul_f32 v79, v79, v211
v_exp_f32 v72, v72
v_exp_f32 v73, v73
v_exp_f32 v74, v74
buffer_load_dwordx4 v3, s[8:11], s37 offen offset:1024 sc1 lds
v_exp_f32 v75, v75
v_exp_f32 v76, v76
v_exp_f32 v77, v77
v_exp_f32 v78, v78
v_exp_f32 v79, v79
v_fma_f32 v196, -v60, v52, v196
v_fma_f32 v197, -v60, v53, v197
buffer_load_dwordx4 v3, s[8:11], s37 offen offset:2048 sc1 lds
v_fma_f32 v198, -v60, v54, v198
v_fma_f32 v199, -v60, v55, v199
v_fma_f32 v220, -v62, v52, v220
v_fma_f32 v221, -v62, v53, v221
v_fma_f32 v222, -v62, v54, v222
v_fma_f32 v223, -v62, v55, v223
buffer_load_dwordx4 v3, s[8:11], s37 offen offset:3072 sc1 lds
v_fma_f32 v72, v72, v66, v66
v_fma_f32 v73, v73, v66, v66
v_fma_f32 v74, v74, v66, v66
v_fma_f32 v75, v75, v66, v66
v_fma_f32 v76, v76, v70, v70
v_fma_f32 v77, v77, v70, v70
v_fma_f32 v78, v78, v70, v70
s_add_u32 s38, s35, 8
s_and_b32 s38, s38, 15
s_mul_i32 s38, s38, 458752
s_add_u32 m0, s40, 0
s_nop 0
buffer_load_dwordx4 v4, s[12:15], s38 offen lds
v_fma_f32 v79, v79, v70, v70
v_rcp_f32 v72, v72
v_rcp_f32 v73, v73
v_rcp_f32 v74, v74
v_rcp_f32 v75, v75
v_rcp_f32 v76, v76
v_rcp_f32 v77, v77
s_add_u32 m0, s40, 1024
s_nop 0
buffer_load_dwordx4 v5, s[12:15], s38 offen lds
v_rcp_f32 v78, v78
v_rcp_f32 v79, v79
v_mul_f32 v196, v184, v196
v_mul_f32 v197, v185, v197
v_mul_f32 v198, v186, v198
v_mul_f32 v199, v187, v199
v_mul_f32 v220, v208, v220
s_add_u32 m0, s40, 2048
s_add_u32 s38, s38, 57344
buffer_load_dwordx4 v4, s[12:15], s38 offen lds
v_mul_f32 v221, v209, v221
v_mul_f32 v222, v210, v222
v_mul_f32 v223, v211, v223
v_mul_f32 v196, v196, v72
v_mul_f32 v197, v197, v73
v_mul_f32 v198, v198, v74
s_add_u32 m0, s40, 3072
s_nop 0
buffer_load_dwordx4 v5, s[12:15], s38 offen lds
v_mul_f32 v199, v199, v75
v_mul_f32 v220, v220, v76
v_mul_f32 v221, v221, v77
v_mul_f32 v222, v222, v78
v_mul_f32 v223, v223, v79
v_cvt_pk_bf16_f32 v80, v196, v197
v_cvt_pk_bf16_f32 v81, v198, v199
s_add_u32 m0, s40, 4096
s_add_u32 s38, s38, 57344
buffer_load_dwordx4 v4, s[12:15], s38 offen lds
v_cvt_pk_bf16_f32 v82, v220, v221
v_cvt_pk_bf16_f32 v83, v222, v223
s_nop 1
v_permlane32_swap_b32 v80, v82
v_permlane32_swap_b32 v81, v83
buffer_store_dwordx4 v[80:83], v84, s[24:27], s55 offen offset:2048 sc1
s_nop 1
s_add_u32 m0, s40, 5120
s_nop 0
buffer_load_dwordx4 v5, s[12:15], s38 offen lds
v_cmp_gt_u32 vcc, 32, v1
v_mov_b32 v104, s52
v_mov_b32 v106, s53
v_cndmask_b32 v104, v106, v104, vcc
v_lshl_add_u32 v104, v105, 4, v104
v_bfe_u32 v105, v1, 4, 1
v_lshl_add_u32 v104, v105, 2, v104
s_add_u32 m0, s40, 6144
s_add_u32 s38, s38, 57344
buffer_load_dwordx4 v4, s[12:15], s38 offen lds
s_add_u32 m0, s40, 7168
s_nop 0
buffer_load_dwordx4 v5, s[12:15], s38 offen lds
s_waitcnt vmcnt(15)
s_barrier
s_add_u32 s37, s35, 9
s_and_b32 s37, s37, 15
s_mul_i32 s37, s37, 16384
s_add_u32 m0, s39, 49152
s_nop 0
buffer_load_dwordx4 v3, s[8:11], s37 offen sc1 lds
buffer_load_dwordx4 v3, s[8:11], s37 offen offset:1024 sc1 lds
buffer_load_dwordx4 v3, s[8:11], s37 offen offset:2048 sc1 lds
buffer_load_dwordx4 v3, s[8:11], s37 offen offset:3072 sc1 lds
s_add_u32 s38, s35, 9
s_and_b32 s38, s38, 15
s_mul_i32 s38, s38, 458752
s_add_u32 m0, s40, 49152
s_nop 0
buffer_load_dwordx4 v4, s[12:15], s38 offen lds
s_add_u32 m0, s40, 50176
s_nop 0
buffer_load_dwordx4 v5, s[12:15], s38 offen lds
s_add_u32 m0, s40, 51200
s_add_u32 s38, s38, 57344
buffer_load_dwordx4 v4, s[12:15], s38 offen lds
s_add_u32 m0, s40, 52224
s_nop 0
buffer_load_dwordx4 v5, s[12:15], s38 offen lds
s_add_u32 m0, s40, 53248
s_add_u32 s38, s38, 57344
buffer_load_dwordx4 v4, s[12:15], s38 offen lds
s_add_u32 m0, s40, 54272
s_nop 0
buffer_load_dwordx4 v5, s[12:15], s38 offen lds
s_add_u32 m0, s40, 55296
s_add_u32 s38, s38, 57344
buffer_load_dwordx4 v4, s[12:15], s38 offen lds
s_add_u32 m0, s40, 56320
s_nop 0
buffer_load_dwordx4 v5, s[12:15], s38 offen lds
s_waitcnt vmcnt(12)
s_barrier
s_cmp_eq_u32 s47, 0
s_cbranch_scc0 Lw_130
s_add_u32 s7, s34, 32
s_lshl_b32 s7, s7, 7
v_mov_b32 v90, s7
v_mov_b32 v91, 1
s_mov_b64 exec, 1
buffer_atomic_add v91, v90, s[56:59], 0 offen sc1
s_mov_b64 exec, -1
Lw_130:
v_permlane32_swap_b32 v96, v100
v_permlane32_swap_b32 v97, v101
v_permlane32_swap_b32 v98, v102
v_permlane32_swap_b32 v99, v103
v_add_f32 v96, v96, v100
v_add_f32 v97, v97, v101
v_add_f32 v98, v98, v102
v_add_f32 v99, v99, v103
s_nop 1
v_permlane16_swap_b32 v96, v97
v_permlane16_swap_b32 v98, v99
v_add_f32 v96, v96, v97
v_add_f32 v98, v98, v99
s_nop 1
v_add_f32_dpp v96, v96, v96 row_ror:8 row_mask:0xf bank_mask:0xf
v_add_f32_dpp v98, v98, v98 row_ror:8 row_mask:0xf bank_mask:0xf
ds_write_b32 v104, v96
ds_write_b32 v104, v98 offset:8
s_waitcnt lgkmcnt(0)
s_add_u32 s37, s35, 10
s_and_b32 s37, s37, 15
s_mul_i32 s37, s37, 16384
s_add_u32 m0, s39, 98304
s_nop 0
buffer_load_dwordx4 v3, s[8:11], s37 offen sc1 lds
s_load_dword s3, s[4:5], 6272
s_load_dword s3, s[4:5], 6336
s_load_dword s3, s[4:5], 6400
s_load_dword s3, s[4:5], 6464
s_load_dword s3, s[4:5], 6528
s_load_dword s3, s[4:5], 6592
buffer_load_dwordx4 v3, s[8:11], s37 offen offset:1024 sc1 lds
s_load_dword s3, s[4:5], 6656
s_load_dword s3, s[4:5], 6720
s_load_dword s3, s[4:5], 6784
s_load_dword s3, s[4:5], 6848
s_load_dword s3, s[4:5], 6912
s_load_dword s3, s[4:5], 6976
s_load_dword s3, s[4:5], 7040
buffer_load_dwordx4 v3, s[8:11], s37 offen offset:2048 sc1 lds
s_load_dword s3, s[4:5], 7104
s_bfe_u32 s61, s35, 0x10002
s_lshr_b32 s60, s35, 3
s_lshl_b32 s60, s60, 2
s_and_b32 s43, s35, 3
s_add_u32 s60, s60, s43
buffer_load_dwordx4 v3, s[8:11], s37 offen offset:3072 sc1 lds
s_lshl_b32 s43, s60, 8
s_add_u32 s28, s76, s43
s_addc_u32 s29, s77, 0
s_mov_b32 s30, 7338240
s_mov_b32 s31, 0x20000
s_mul_i32 s52, s61, 196608
s_mul_i32 s53, s61, 1572864
s_add_u32 s38, s35, 10
s_and_b32 s38, s38, 15
s_mul_i32 s38, s38, 458752
s_add_u32 m0, s40, 98304
s_nop 0
buffer_load_dwordx4 v4, s[12:15], s38 offen lds
s_mul_i32 s90, s61, 163840
s_mul_i32 s91, s61, 1310720
s_and_b32 s43, s35, 3
s_mul_i32 s32, s43, 3
s_mul_i32 s33, s43, 10
s_lshr_b32 s33, s33, 2
s_add_u32 m0, s40, 99328
s_nop 0
buffer_load_dwordx4 v5, s[12:15], s38 offen lds
s_lshl_b32 s51, s47, 11
s_lshl_b32 s44, s47, 15
v_lshrrev_b32 v122, 4, v1
v_lshlrev_b32 v123, 1, v122
v_and_b32 v23, 15, v1
v_xor_b32 v23, v23, v123
v_lshlrev_b32 v23, 4, v23
s_add_u32 m0, s40, 100352
s_add_u32 s38, s38, 57344
buffer_load_dwordx4 v4, s[12:15], s38 offen lds
v_mul_u32_u24 v122, 2048, v122
v_add_u32 v23, v23, v122
v_add_u32 v23, s44, v23
s_branch Lov_10
.p2align 12
.fill 80, 4, 0xbf800000
Lst_10_0:
s_branch Lwr_170
Lst_10_1:
s_branch Lwr_181
s_nop 0
Lov_10:
v_xor_b32 v24, 128, v23
v_add_u32 v24, 8192, v24
s_lshl_b32 s43, s60, 2
s_add_u32 m0, s40, 101376
s_nop 0
buffer_load_dwordx4 v5, s[12:15], s38 offen lds
s_lshl_b32 s44, s61, 1
s_add_u32 s43, s43, s44
s_add_u32 s43, s43, s63
s_lshl_b32 s43, s43, 13
s_lshl_b32 s44, s62, 12
s_add_u32 s49, s43, s44
v_add_u32 v17, s44, v2
s_add_u32 m0, s40, 102400
s_add_u32 s38, s38, 57344
buffer_load_dwordx4 v4, s[12:15], s38 offen lds
v_add_u32 v18, 0x10000, v17
v_add_u32 v19, 0x20000, v17
v_lshrrev_b32 v122, 2, v1
v_and_b32 v123, 7, v122
v_mul_u32_u24 v122, 256, v122
v_lshl_add_u32 v122, v123, 5, v122
s_add_u32 m0, s40, 103424
s_nop 0
buffer_load_dwordx4 v5, s[12:15], s38 offen lds
v_and_b32 v123, 3, v1
v_lshl_add_u32 v9, v123, 3, v122
s_lshl_b32 s43, s61, 7
s_lshl_b32 s44, s63, 6
s_add_u32 s43, s43, s44
v_xor_b32 v9, s43, v9
v_xor_b32 v10, 32, v9
s_add_u32 m0, s40, 104448
s_add_u32 s38, s38, 57344
buffer_load_dwordx4 v4, s[12:15], s38 offen lds
s_add_u32 m0, s40, 105472
s_nop 0
buffer_load_dwordx4 v5, s[12:15], s38 offen lds
s_waitcnt vmcnt(12)
s_barrier
buffer_load_dwordx4 v[160:163], v2, s[8:11], s49 offen offset:0 sc1
v_xor_b32 v11, 128, v9
v_xor_b32 v12, 128, v10
v_add_u32 v13, 65536, v9
buffer_load_dwordx4 v[164:167], v2, s[8:11], s49 offen offset:1024 sc1
v_add_u32 v14, 65536, v10
v_add_u32 v15, 65536, v11
v_add_u32 v16, 65536, v12
v_add_u32 v25, 131072, v9
buffer_load_dwordx4 v[168:171], v2, s[8:11], s49 offen offset:2048 sc1
v_add_u32 v26, 131072, v10
v_add_u32 v27, 131072, v11
v_add_u32 v28, 131072, v12
v_lshrrev_b32 v122, 2, v1
buffer_load_dwordx4 v[172:175], v2, s[8:11], s49 offen offset:3072 sc1
v_bfe_u32 v123, v122, 1, 2
v_mul_u32_u24 v122, 128, v122
v_lshl_add_u32 v122, v123, 5, v122
s_add_u32 s37, s35, 11
s_and_b32 s37, s37, 15
s_mul_i32 s37, s37, 16384
s_add_u32 m0, s39, 0
s_nop 0
buffer_load_dwordx4 v3, s[8:11], s37 offen sc1 lds
v_and_b32 v123, 3, v1
v_lshl_add_u32 v224, v123, 3, v122
v_xor_b32 v224, s44, v224
v_xor_b32 v225, 32, v224
buffer_load_dwordx4 v3, s[8:11], s37 offen offset:1024 sc1 lds
v_add_u32 v226, 65536, v224
v_add_u32 v227, 65536, v225
v_add_u32 v228, 131072, v224
v_add_u32 v229, 131072, v225
buffer_load_dwordx4 v3, s[8:11], s37 offen offset:2048 sc1 lds
s_add_u32 s84, s82, 33554432
s_addc_u32 s85, s83, 0
s_mov_b32 s86, 4194304
s_mov_b32 s87, 0x20000
buffer_load_dwordx4 v3, s[8:11], s37 offen offset:3072 sc1 lds
s_xor_b32 s43, s2, 2
s_lshl_b32 s44, s43, 2
s_add_u32 s44, s44, s47
s_add_u32 s38, s35, 11
s_and_b32 s38, s38, 15
s_mul_i32 s38, s38, 458752
s_add_u32 m0, s40, 0
s_nop 0
buffer_load_dwordx4 v4, s[12:15], s38 offen lds
s_lshl_b32 s45, s44, 12
s_lshl_b32 s46, s2, 2
s_add_u32 s46, s46, s47
s_lshl_b32 s46, s46, 12
s_add_u32 m0, s40, 1024
s_nop 0
buffer_load_dwordx4 v5, s[12:15], s38 offen lds
s_lshl_b32 s43, s34, 18
s_lshl_b32 s42, s60, 8
s_add_u32 s43, s43, s42
s_lshl_b32 s42, s61, 7
s_add_u32 m0, s40, 2048
s_add_u32 s38, s38, 57344
buffer_load_dwordx4 v4, s[12:15], s38 offen lds
s_add_u32 s43, s43, s42
s_lshl_b32 s42, s63, 6
s_add_u32 s43, s43, s42
s_add_u32 m0, s40, 3072
s_nop 0
buffer_load_dwordx4 v5, s[12:15], s38 offen lds
s_add_u32 s20, s78, s43
s_addc_u32 s21, s79, 0
s_mov_b32 s22, 260160
s_mov_b32 s23, 0x20000
s_add_u32 m0, s40, 4096
s_add_u32 s38, s38, 57344
buffer_load_dwordx4 v4, s[12:15], s38 offen lds
v_and_b32 v230, 15, v1
v_lshlrev_b32 v230, 12, v230
v_bfe_u32 v231, v1, 4, 1
v_lshl_add_u32 v230, v231, 5, v230
s_add_u32 m0, s40, 5120
s_nop 0
buffer_load_dwordx4 v5, s[12:15], s38 offen lds
v_bfe_u32 v231, v1, 5, 1
v_lshl_add_u32 v230, v231, 4, v230
s_lshl_b32 s54, s62, 17
s_add_u32 s55, s54, 65536
s_add_u32 m0, s40, 6144
s_add_u32 s38, s38, 57344
buffer_load_dwordx4 v4, s[12:15], s38 offen lds
s_add_u32 m0, s40, 7168
s_nop 0
buffer_load_dwordx4 v5, s[12:15], s38 offen lds
s_waitcnt vmcnt(16)
s_barrier
s_cmp_eq_u32 s47, 3
s_cbranch_scc0 Lw_131
s_lshl_b32 s92, s34, 7
s_add_u32 s92, s92, 28315648
s_load_dword s93, s[82:83], s92 glc
Lw_131:
s_add_u32 s37, s35, 12
s_and_b32 s37, s37, 15
s_mul_i32 s37, s37, 16384
s_add_u32 m0, s39, 49152
s_nop 0
buffer_load_dwordx4 v3, s[8:11], s37 offen sc1 lds
buffer_load_dwordx4 v3, s[8:11], s37 offen offset:1024 sc1 lds
buffer_load_dwordx4 v3, s[8:11], s37 offen offset:2048 sc1 lds
buffer_load_dwordx4 v3, s[8:11], s37 offen offset:3072 sc1 lds
s_add_u32 s38, s35, 12
s_and_b32 s38, s38, 15
s_mul_i32 s38, s38, 458752
s_add_u32 m0, s40, 49152
s_nop 0
buffer_load_dwordx4 v4, s[12:15], s38 offen lds
s_add_u32 m0, s40, 50176
s_nop 0
buffer_load_dwordx4 v5, s[12:15], s38 offen lds
s_add_u32 m0, s40, 51200
s_add_u32 s38, s38, 57344
buffer_load_dwordx4 v4, s[12:15], s38 offen lds
s_add_u32 m0, s40, 52224
s_nop 0
buffer_load_dwordx4 v5, s[12:15], s38 offen lds
s_add_u32 m0, s40, 53248
s_add_u32 s38, s38, 57344
buffer_load_dwordx4 v4, s[12:15], s38 offen lds
s_add_u32 m0, s40, 54272
s_nop 0
buffer_load_dwordx4 v5, s[12:15], s38 offen lds
s_add_u32 m0, s40, 55296
s_add_u32 s38, s38, 57344
buffer_load_dwordx4 v4, s[12:15], s38 offen lds
s_add_u32 m0, s40, 56320
s_nop 0
buffer_load_dwordx4 v5, s[12:15], s38 offen lds
s_waitcnt vmcnt(12)
s_cmp_eq_u32 s47, 3
s_cbranch_scc0 Lw_132
s_mov_b32 s41, 0x40000
s_branch Lpchk_135
Lpoll_133:
s_load_dword s93, s[82:83], s92 glc
Lpchk_135:
s_waitcnt lgkmcnt(0)
s_cmp_eq_u32 s93, 16
s_cbranch_scc1 Lpok_134
s_sub_u32 s41, s41, 1
s_cmp_lg_u32 s41, 0
s_cbranch_scc1 Lpoll_133
Lpok_134:
Lw_132:
s_barrier
s_add_u32 s37, s52, 524288
s_add_u32 m0, s39, 98304
s_nop 0
buffer_load_dwordx4 v3, s[24:27], s37 offen sc1 lds
v_lshlrev_b32 v128, 16, v160
v_and_b32 v129, 0xffff0000, v160
v_lshlrev_b32 v130, 16, v161
v_and_b32 v131, 0xffff0000, v161
v_lshlrev_b32 v132, 16, v162
buffer_load_dwordx4 v3, s[24:27], s37 offen offset:1024 sc1 lds
v_and_b32 v133, 0xffff0000, v162
v_lshlrev_b32 v134, 16, v163
v_and_b32 v135, 0xffff0000, v163
v_lshlrev_b32 v136, 16, v164
v_and_b32 v137, 0xffff0000, v164
buffer_load_dwordx4 v3, s[24:27], s37 offen offset:2048 sc1 lds
v_lshlrev_b32 v138, 16, v165
v_and_b32 v139, 0xffff0000, v165
v_lshlrev_b32 v140, 16, v166
v_and_b32 v141, 0xffff0000, v166
v_lshlrev_b32 v142, 16, v167
v_and_b32 v143, 0xffff0000, v167
buffer_load_dwordx4 v3, s[24:27], s37 offen offset:3072 sc1 lds
v_lshlrev_b32 v144, 16, v168
v_and_b32 v145, 0xffff0000, v168
v_lshlrev_b32 v146, 16, v169
v_and_b32 v147, 0xffff0000, v169
v_lshlrev_b32 v148, 16, v170
s_add_u32 s38, s53, 4194304
s_add_u32 m0, s39, 114688
s_nop 0
buffer_load_dwordx4 v23, s[28:31], s38 offen lds
v_and_b32 v149, 0xffff0000, v170
v_lshlrev_b32 v150, 16, v171
v_and_b32 v151, 0xffff0000, v171
v_lshlrev_b32 v152, 16, v172
v_and_b32 v153, 0xffff0000, v172
s_add_u32 m0, s39, 115712
s_nop 0
buffer_load_dwordx4 v24, s[28:31], s38 offen lds
v_lshlrev_b32 v154, 16, v173
v_and_b32 v155, 0xffff0000, v173
v_lshlrev_b32 v156, 16, v174
v_and_b32 v157, 0xffff0000, v174
v_lshlrev_b32 v158, 16, v175
v_and_b32 v159, 0xffff0000, v175
s_add_u32 m0, s39, 116736
s_add_u32 s38, s38, 16384
buffer_load_dwordx4 v23, s[28:31], s38 offen lds
s_add_u32 m0, s39, 117760
s_nop 0
buffer_load_dwordx4 v24, s[28:31], s38 offen lds
s_waitcnt vmcnt(8)
s_barrier
s_add_u32 s37, s52, 540672
s_add_u32 m0, s39, 131072
s_nop 0
buffer_load_dwordx4 v3, s[24:27], s37 offen sc1 lds
buffer_load_dwordx4 v3, s[24:27], s37 offen offset:1024 sc1 lds
buffer_load_dwordx4 v3, s[24:27], s37 offen offset:2048 sc1 lds
buffer_load_dwordx4 v3, s[24:27], s37 offen offset:3072 sc1 lds
s_add_u32 s38, s53, 4325376
s_add_u32 m0, s39, 0
s_nop 0
buffer_load_dwordx4 v23, s[28:31], s38 offen lds
s_add_u32 m0, s39, 1024
s_nop 0
buffer_load_dwordx4 v24, s[28:31], s38 offen lds
s_add_u32 m0, s39, 2048
s_add_u32 s38, s38, 16384
buffer_load_dwordx4 v23, s[28:31], s38 offen lds
s_add_u32 m0, s39, 3072
s_nop 0
buffer_load_dwordx4 v24, s[28:31], s38 offen lds
s_add_u32 s37, s52, 557056
s_add_u32 m0, s39, 16384
s_nop 0
buffer_load_dwordx4 v3, s[24:27], s37 offen sc1 lds
buffer_load_dwordx4 v3, s[24:27], s37 offen offset:1024 sc1 lds
buffer_load_dwordx4 v3, s[24:27], s37 offen offset:2048 sc1 lds
buffer_load_dwordx4 v3, s[24:27], s37 offen offset:3072 sc1 lds
s_add_u32 s38, s53, 4456448
s_add_u32 m0, s39, 32768
s_nop 0
buffer_load_dwordx4 v23, s[28:31], s38 offen lds
s_add_u32 m0, s39, 33792
s_nop 0
buffer_load_dwordx4 v24, s[28:31], s38 offen lds
s_add_u32 m0, s39, 34816
s_add_u32 s38, s38, 16384
buffer_load_dwordx4 v23, s[28:31], s38 offen lds
s_add_u32 m0, s39, 35840
s_nop 0
buffer_load_dwordx4 v24, s[28:31], s38 offen lds
s_waitcnt vmcnt(16)
s_barrier
ds_read_b128 v[32:35], v18 offset:32768
ds_read_b64_tr_b16 v[48:49], v13 offset:49152
ds_read_b64_tr_b16 v[50:51], v13 offset:53248
ds_read_b64_tr_b16 v[52:53], v14 offset:49152
ds_read_b64_tr_b16 v[54:55], v14 offset:53248
ds_read_b64_tr_b16 v[56:57], v15 offset:49152
ds_read_b64_tr_b16 v[58:59], v15 offset:53248
ds_read_b64_tr_b16 v[60:61], v16 offset:49152
ds_read_b64_tr_b16 v[62:63], v16 offset:53248
ds_read_b128 v[36:39], v18 offset:33792
ds_read_b128 v[40:43], v18 offset:34816
ds_read_b128 v[44:47], v18 offset:35840
ds_read_b128 v[64:67], v18 offset:40960
ds_read_b64_tr_b16 v[80:81], v13 offset:57344
ds_read_b64_tr_b16 v[82:83], v13 offset:61440
ds_read_b64_tr_b16 v[84:85], v14 offset:57344
ds_read_b64_tr_b16 v[86:87], v14 offset:61440
ds_read_b64_tr_b16 v[88:89], v15 offset:57344
ds_read_b64_tr_b16 v[90:91], v15 offset:61440
ds_read_b64_tr_b16 v[92:93], v16 offset:57344
ds_read_b64_tr_b16 v[94:95], v16 offset:61440
ds_read_b128 v[68:71], v18 offset:41984
ds_read_b128 v[72:75], v18 offset:43008
ds_read_b128 v[76:79], v18 offset:44032
s_add_u32 s37, s52, 573440
s_add_u32 m0, s39, 49152
s_nop 0
buffer_load_dwordx4 v3, s[24:27], s37 offen sc1 lds
buffer_load_dwordx4 v3, s[24:27], s37 offen offset:1024 sc1 lds
buffer_load_dwordx4 v3, s[24:27], s37 offen offset:2048 sc1 lds
buffer_load_dwordx4 v3, s[24:27], s37 offen offset:3072 sc1 lds
s_add_u32 s38, s53, 4587520
s_add_u32 m0, s39, 65536
s_nop 0
buffer_load_dwordx4 v23, s[28:31], s38 offen lds
s_add_u32 m0, s39, 66560
s_nop 0
buffer_load_dwordx4 v24, s[28:31], s38 offen lds
s_add_u32 m0, s39, 67584
s_add_u32 s38, s38, 16384
buffer_load_dwordx4 v23, s[28:31], s38 offen lds
s_add_u32 m0, s39, 68608
s_nop 0
buffer_load_dwordx4 v24, s[28:31], s38 offen lds
Lk4c:
s_waitcnt vmcnt(16)
s_waitcnt lgkmcnt(0)
s_barrier
v_mfma_f32_16x16x32_bf16 v[128:131], v[48:51], v[32:35], v[128:131]
ds_read_b128 v[96:99], v19 offset:0
v_mfma_f32_16x16x32_bf16 v[136:139], v[48:51], v[36:39], v[136:139]
ds_read_b64_tr_b16 v[112:113], v9 offset:0
v_mfma_f32_16x16x32_bf16 v[144:147], v[48:51], v[40:43], v[144:147]
ds_read_b64_tr_b16 v[114:115], v9 offset:4096
v_mfma_f32_16x16x32_bf16 v[152:155], v[48:51], v[44:47], v[152:155]
ds_read_b64_tr_b16 v[116:117], v10 offset:0
v_mfma_f32_16x16x32_bf16 v[156:159], v[52:55], v[44:47], v[156:159]
ds_read_b64_tr_b16 v[118:119], v10 offset:4096
v_mfma_f32_16x16x32_bf16 v[148:151], v[52:55], v[40:43], v[148:151]
ds_read_b64_tr_b16 v[120:121], v11 offset:0
v_mfma_f32_16x16x32_bf16 v[140:143], v[52:55], v[36:39], v[140:143]
ds_read_b64_tr_b16 v[122:123], v11 offset:4096
v_mfma_f32_16x16x32_bf16 v[132:135], v[52:55], v[32:35], v[132:135]
ds_read_b64_tr_b16 v[124:125], v12 offset:0
v_mfma_f32_16x16x32_bf16 v[160:163], v[56:59], v[32:35], 0
ds_read_b64_tr_b16 v[126:127], v12 offset:4096
v_mfma_f32_16x16x32_bf16 v[168:171], v[56:59], v[36:39], 0
ds_read_b128 v[100:103], v19 offset:1024
v_mfma_f32_16x16x32_bf16 v[176:179], v[56:59], v[40:43], 0
ds_read_b128 v[104:107], v19 offset:2048
v_mfma_f32_16x16x32_bf16 v[184:187], v[56:59], v[44:47], 0
ds_read_b128 v[108:111], v19 offset:3072
v_mfma_f32_16x16x32_bf16 v[188:191], v[60:63], v[44:47], 0
ds_read_b128 v[192:195], v19 offset:8192
v_mfma_f32_16x16x32_bf16 v[180:183], v[60:63], v[40:43], 0
ds_read_b64_tr_b16 v[208:209], v9 offset:8192
v_mfma_f32_16x16x32_bf16 v[172:175], v[60:63], v[36:39], 0
ds_read_b64_tr_b16 v[210:211], v9 offset:12288
v_mfma_f32_16x16x32_bf16 v[164:167], v[60:63], v[32:35], 0
ds_read_b64_tr_b16 v[212:213], v10 offset:8192
v_mfma_f32_16x16x32_bf16 v[128:131], v[80:83], v[64:67], v[128:131]
ds_read_b64_tr_b16 v[214:215], v10 offset:12288
v_mfma_f32_16x16x32_bf16 v[136:139], v[80:83], v[68:71], v[136:139]
ds_read_b64_tr_b16 v[216:217], v11 offset:8192
v_mfma_f32_16x16x32_bf16 v[144:147], v[80:83], v[72:75], v[144:147]
ds_read_b64_tr_b16 v[218:219], v11 offset:12288
v_mfma_f32_16x16x32_bf16 v[152:155], v[80:83], v[76:79], v[152:155]
ds_read_b64_tr_b16 v[220:221], v12 offset:8192
v_mfma_f32_16x16x32_bf16 v[156:159], v[84:87], v[76:79], v[156:159]
ds_read_b64_tr_b16 v[222:223], v12 offset:12288
v_mfma_f32_16x16x32_bf16 v[148:151], v[84:87], v[72:75], v[148:151]
ds_read_b128 v[196:199], v19 offset:9216
v_mfma_f32_16x16x32_bf16 v[140:143], v[84:87], v[68:71], v[140:143]
ds_read_b128 v[200:203], v19 offset:10240
v_mfma_f32_16x16x32_bf16 v[132:135], v[84:87], v[64:67], v[132:135]
ds_read_b128 v[204:207], v19 offset:11264
v_mfma_f32_16x16x32_bf16 v[160:163], v[88:91], v[64:67], v[160:163]
v_mfma_f32_16x16x32_bf16 v[168:171], v[88:91], v[68:71], v[168:171]
v_mfma_f32_16x16x32_bf16 v[176:179], v[88:91], v[72:75], v[176:179]
v_mfma_f32_16x16x32_bf16 v[184:187], v[88:91], v[76:79], v[184:187]
v_mfma_f32_16x16x32_bf16 v[188:191], v[92:95], v[76:79], v[188:191]
v_mfma_f32_16x16x32_bf16 v[180:183], v[92:95], v[72:75], v[180:183]
v_mfma_f32_16x16x32_bf16 v[172:175], v[92:95], v[68:71], v[172:175]
v_mfma_f32_16x16x32_bf16 v[164:167], v[92:95], v[64:67], v[164:167]
s_mov_b32 s41, 2
Lk4_136:
s_waitcnt vmcnt(8)
s_waitcnt lgkmcnt(0)
s_barrier
v_mfma_f32_16x16x32_bf16 v[128:131], v[112:115], v[96:99], v[128:131]
ds_read_b128 v[32:35], v17 offset:16384
v_mfma_f32_16x16x32_bf16 v[136:139], v[112:115], v[100:103], v[136:139]
ds_read_b64_tr_b16 v[48:49], v9 offset:32768
v_mfma_f32_16x16x32_bf16 v[144:147], v[112:115], v[104:107], v[144:147]
ds_read_b64_tr_b16 v[50:51], v9 offset:36864
v_mfma_f32_16x16x32_bf16 v[152:155], v[112:115], v[108:111], v[152:155]
ds_read_b64_tr_b16 v[52:53], v10 offset:32768
v_mfma_f32_16x16x32_bf16 v[156:159], v[116:119], v[108:111], v[156:159]
ds_read_b64_tr_b16 v[54:55], v10 offset:36864
v_mfma_f32_16x16x32_bf16 v[148:151], v[116:119], v[104:107], v[148:151]
ds_read_b64_tr_b16 v[56:57], v11 offset:32768
v_mfma_f32_16x16x32_bf16 v[140:143], v[116:119], v[100:103], v[140:143]
ds_read_b64_tr_b16 v[58:59], v11 offset:36864
v_mfma_f32_16x16x32_bf16 v[132:135], v[116:119], v[96:99], v[132:135]
ds_read_b64_tr_b16 v[60:61], v12 offset:32768
v_mfma_f32_16x16x32_bf16 v[160:163], v[120:123], v[96:99], v[160:163]
ds_read_b64_tr_b16 v[62:63], v12 offset:36864
v_mfma_f32_16x16x32_bf16 v[168:171], v[120:123], v[100:103], v[168:171]
ds_read_b128 v[36:39], v17 offset:17408
v_mfma_f32_16x16x32_bf16 v[176:179], v[120:123], v[104:107], v[176:179]
ds_read_b128 v[40:43], v17 offset:18432
v_mfma_f32_16x16x32_bf16 v[184:187], v[120:123], v[108:111], v[184:187]
ds_read_b128 v[44:47], v17 offset:19456
v_mfma_f32_16x16x32_bf16 v[188:191], v[124:127], v[108:111], v[188:191]
ds_read_b128 v[64:67], v17 offset:24576
v_mfma_f32_16x16x32_bf16 v[180:183], v[124:127], v[104:107], v[180:183]
ds_read_b64_tr_b16 v[80:81], v9 offset:40960
v_mfma_f32_16x16x32_bf16 v[172:175], v[124:127], v[100:103], v[172:175]
ds_read_b64_tr_b16 v[82:83], v9 offset:45056
v_mfma_f32_16x16x32_bf16 v[164:167], v[124:127], v[96:99], v[164:167]
ds_read_b64_tr_b16 v[84:85], v10 offset:40960
v_mfma_f32_16x16x32_bf16 v[128:131], v[208:211], v[192:195], v[128:131]
ds_read_b64_tr_b16 v[86:87], v10 offset:45056
v_mfma_f32_16x16x32_bf16 v[136:139], v[208:211], v[196:199], v[136:139]
ds_read_b64_tr_b16 v[88:89], v11 offset:40960
v_mfma_f32_16x16x32_bf16 v[144:147], v[208:211], v[200:203], v[144:147]
ds_read_b64_tr_b16 v[90:91], v11 offset:45056
v_mfma_f32_16x16x32_bf16 v[152:155], v[208:211], v[204:207], v[152:155]
ds_read_b64_tr_b16 v[92:93], v12 offset:40960
v_mfma_f32_16x16x32_bf16 v[156:159], v[212:215], v[204:207], v[156:159]
ds_read_b64_tr_b16 v[94:95], v12 offset:45056
v_mfma_f32_16x16x32_bf16 v[148:151], v[212:215], v[200:203], v[148:151]
ds_read_b128 v[68:71], v17 offset:25600
v_mfma_f32_16x16x32_bf16 v[140:143], v[212:215], v[196:199], v[140:143]
ds_read_b128 v[72:75], v17 offset:26624
v_mfma_f32_16x16x32_bf16 v[132:135], v[212:215], v[192:195], v[132:135]
ds_read_b128 v[76:79], v17 offset:27648
v_mfma_f32_16x16x32_bf16 v[160:163], v[216:219], v[192:195], v[160:163]
v_mfma_f32_16x16x32_bf16 v[168:171], v[216:219], v[196:199], v[168:171]
v_mfma_f32_16x16x32_bf16 v[176:179], v[216:219], v[200:203], v[176:179]
v_mfma_f32_16x16x32_bf16 v[184:187], v[216:219], v[204:207], v[184:187]
v_mfma_f32_16x16x32_bf16 v[188:191], v[220:223], v[204:207], v[188:191]
v_mfma_f32_16x16x32_bf16 v[180:183], v[220:223], v[200:203], v[180:183]
v_mfma_f32_16x16x32_bf16 v[172:175], v[220:223], v[196:199], v[172:175]
v_mfma_f32_16x16x32_bf16 v[164:167], v[220:223], v[192:195], v[164:167]
s_waitcnt vmcnt(0)
s_waitcnt lgkmcnt(0)
s_barrier
v_mfma_f32_16x16x32_bf16 v[128:131], v[48:51], v[32:35], v[128:131]
ds_read_b128 v[96:99], v17 offset:49152
v_mfma_f32_16x16x32_bf16 v[136:139], v[48:51], v[36:39], v[136:139]
ds_read_b64_tr_b16 v[112:113], v13 offset:0
v_mfma_f32_16x16x32_bf16 v[144:147], v[48:51], v[40:43], v[144:147]
ds_read_b64_tr_b16 v[114:115], v13 offset:4096
v_mfma_f32_16x16x32_bf16 v[152:155], v[48:51], v[44:47], v[152:155]
ds_read_b64_tr_b16 v[116:117], v14 offset:0
v_mfma_f32_16x16x32_bf16 v[156:159], v[52:55], v[44:47], v[156:159]
ds_read_b64_tr_b16 v[118:119], v14 offset:4096
v_mfma_f32_16x16x32_bf16 v[148:151], v[52:55], v[40:43], v[148:151]
ds_read_b64_tr_b16 v[120:121], v15 offset:0
v_mfma_f32_16x16x32_bf16 v[140:143], v[52:55], v[36:39], v[140:143]
ds_read_b64_tr_b16 v[122:123], v15 offset:4096
v_mfma_f32_16x16x32_bf16 v[132:135], v[52:55], v[32:35], v[132:135]
ds_read_b64_tr_b16 v[124:125], v16 offset:0
v_mfma_f32_16x16x32_bf16 v[160:163], v[56:59], v[32:35], v[160:163]
ds_read_b64_tr_b16 v[126:127], v16 offset:4096
v_mfma_f32_16x16x32_bf16 v[168:171], v[56:59], v[36:39], v[168:171]
ds_read_b128 v[100:103], v17 offset:50176
v_mfma_f32_16x16x32_bf16 v[176:179], v[56:59], v[40:43], v[176:179]
ds_read_b128 v[104:107], v17 offset:51200
v_mfma_f32_16x16x32_bf16 v[184:187], v[56:59], v[44:47], v[184:187]
ds_read_b128 v[108:111], v17 offset:52224
v_mfma_f32_16x16x32_bf16 v[188:191], v[60:63], v[44:47], v[188:191]
ds_read_b128 v[192:195], v17 offset:57344
v_mfma_f32_16x16x32_bf16 v[180:183], v[60:63], v[40:43], v[180:183]
ds_read_b64_tr_b16 v[208:209], v13 offset:8192
v_mfma_f32_16x16x32_bf16 v[172:175], v[60:63], v[36:39], v[172:175]
ds_read_b64_tr_b16 v[210:211], v13 offset:12288
v_mfma_f32_16x16x32_bf16 v[164:167], v[60:63], v[32:35], v[164:167]
ds_read_b64_tr_b16 v[212:213], v14 offset:8192
v_mfma_f32_16x16x32_bf16 v[128:131], v[80:83], v[64:67], v[128:131]
ds_read_b64_tr_b16 v[214:215], v14 offset:12288
v_mfma_f32_16x16x32_bf16 v[136:139], v[80:83], v[68:71], v[136:139]
ds_read_b64_tr_b16 v[216:217], v15 offset:8192
v_mfma_f32_16x16x32_bf16 v[144:147], v[80:83], v[72:75], v[144:147]
ds_read_b64_tr_b16 v[218:219], v15 offset:12288
v_mfma_f32_16x16x32_bf16 v[152:155], v[80:83], v[76:79], v[152:155]
ds_read_b64_tr_b16 v[220:221], v16 offset:8192
v_mfma_f32_16x16x32_bf16 v[156:159], v[84:87], v[76:79], v[156:159]
ds_read_b64_tr_b16 v[222:223], v16 offset:12288
v_mfma_f32_16x16x32_bf16 v[148:151], v[84:87], v[72:75], v[148:151]
ds_read_b128 v[196:199], v17 offset:58368
v_mfma_f32_16x16x32_bf16 v[140:143], v[84:87], v[68:71], v[140:143]
ds_read_b128 v[200:203], v17 offset:59392
v_mfma_f32_16x16x32_bf16 v[132:135], v[84:87], v[64:67], v[132:135]
ds_read_b128 v[204:207], v17 offset:60416
v_mfma_f32_16x16x32_bf16 v[160:163], v[88:91], v[64:67], v[160:163]
v_mfma_f32_16x16x32_bf16 v[168:171], v[88:91], v[68:71], v[168:171]
v_mfma_f32_16x16x32_bf16 v[176:179], v[88:91], v[72:75], v[176:179]
v_mfma_f32_16x16x32_bf16 v[184:187], v[88:91], v[76:79], v[184:187]
v_mfma_f32_16x16x32_bf16 v[188:191], v[92:95], v[76:79], v[188:191]
v_mfma_f32_16x16x32_bf16 v[180:183], v[92:95], v[72:75], v[180:183]
v_mfma_f32_16x16x32_bf16 v[172:175], v[92:95], v[68:71], v[172:175]
v_mfma_f32_16x16x32_bf16 v[164:167], v[92:95], v[64:67], v[164:167]
s_waitcnt lgkmcnt(0)
s_barrier
v_mfma_f32_16x16x32_bf16 v[128:131], v[112:115], v[96:99], v[128:131]
ds_read_b128 v[32:35], v18 offset:16384
v_mfma_f32_16x16x32_bf16 v[136:139], v[112:115], v[100:103], v[136:139]
ds_read_b64_tr_b16 v[48:49], v25 offset:16384
v_mfma_f32_16x16x32_bf16 v[144:147], v[112:115], v[104:107], v[144:147]
ds_read_b64_tr_b16 v[50:51], v25 offset:20480
v_mfma_f32_16x16x32_bf16 v[152:155], v[112:115], v[108:111], v[152:155]
ds_read_b64_tr_b16 v[52:53], v26 offset:16384
v_mfma_f32_16x16x32_bf16 v[156:159], v[116:119], v[108:111], v[156:159]
ds_read_b64_tr_b16 v[54:55], v26 offset:20480
v_mfma_f32_16x16x32_bf16 v[148:151], v[116:119], v[104:107], v[148:151]
ds_read_b64_tr_b16 v[56:57], v27 offset:16384
v_mfma_f32_16x16x32_bf16 v[140:143], v[116:119], v[100:103], v[140:143]
ds_read_b64_tr_b16 v[58:59], v27 offset:20480
v_mfma_f32_16x16x32_bf16 v[132:135], v[116:119], v[96:99], v[132:135]
ds_read_b64_tr_b16 v[60:61], v28 offset:16384
v_mfma_f32_16x16x32_bf16 v[160:163], v[120:123], v[96:99], v[160:163]
ds_read_b64_tr_b16 v[62:63], v28 offset:20480
v_mfma_f32_16x16x32_bf16 v[168:171], v[120:123], v[100:103], v[168:171]
ds_read_b128 v[36:39], v18 offset:17408
v_mfma_f32_16x16x32_bf16 v[176:179], v[120:123], v[104:107], v[176:179]
ds_read_b128 v[40:43], v18 offset:18432
v_mfma_f32_16x16x32_bf16 v[184:187], v[120:123], v[108:111], v[184:187]
ds_read_b128 v[44:47], v18 offset:19456
v_mfma_f32_16x16x32_bf16 v[188:191], v[124:127], v[108:111], v[188:191]
ds_read_b128 v[64:67], v18 offset:24576
v_mfma_f32_16x16x32_bf16 v[180:183], v[124:127], v[104:107], v[180:183]
ds_read_b64_tr_b16 v[80:81], v25 offset:24576
s_branch Lov_11
.p2align 12
.fill 80, 4, 0xbf800000
Lst_11_0:
s_branch Lwr_171
Lst_11_1:
s_branch Lst_15_0
s_nop 0
Lov_11:
v_mfma_f32_16x16x32_bf16 v[172:175], v[124:127], v[100:103], v[172:175]
ds_read_b64_tr_b16 v[82:83], v25 offset:28672
v_mfma_f32_16x16x32_bf16 v[164:167], v[124:127], v[96:99], v[164:167]
ds_read_b64_tr_b16 v[84:85], v26 offset:24576
v_mfma_f32_16x16x32_bf16 v[128:131], v[208:211], v[192:195], v[128:131]
ds_read_b64_tr_b16 v[86:87], v26 offset:28672
v_mfma_f32_16x16x32_bf16 v[136:139], v[208:211], v[196:199], v[136:139]
ds_read_b64_tr_b16 v[88:89], v27 offset:24576
v_mfma_f32_16x16x32_bf16 v[144:147], v[208:211], v[200:203], v[144:147]
ds_read_b64_tr_b16 v[90:91], v27 offset:28672
v_mfma_f32_16x16x32_bf16 v[152:155], v[208:211], v[204:207], v[152:155]
ds_read_b64_tr_b16 v[92:93], v28 offset:24576
v_mfma_f32_16x16x32_bf16 v[156:159], v[212:215], v[204:207], v[156:159]
ds_read_b64_tr_b16 v[94:95], v28 offset:28672
v_mfma_f32_16x16x32_bf16 v[148:151], v[212:215], v[200:203], v[148:151]
ds_read_b128 v[68:71], v18 offset:25600
v_mfma_f32_16x16x32_bf16 v[140:143], v[212:215], v[196:199], v[140:143]
ds_read_b128 v[72:75], v18 offset:26624
v_mfma_f32_16x16x32_bf16 v[132:135], v[212:215], v[192:195], v[132:135]
ds_read_b128 v[76:79], v18 offset:27648
v_mfma_f32_16x16x32_bf16 v[160:163], v[216:219], v[192:195], v[160:163]
v_mfma_f32_16x16x32_bf16 v[168:171], v[216:219], v[196:199], v[168:171]
v_mfma_f32_16x16x32_bf16 v[176:179], v[216:219], v[200:203], v[176:179]
v_mfma_f32_16x16x32_bf16 v[184:187], v[216:219], v[204:207], v[184:187]
v_mfma_f32_16x16x32_bf16 v[188:191], v[220:223], v[204:207], v[188:191]
v_mfma_f32_16x16x32_bf16 v[180:183], v[220:223], v[200:203], v[180:183]
v_mfma_f32_16x16x32_bf16 v[172:175], v[220:223], v[196:199], v[172:175]
v_mfma_f32_16x16x32_bf16 v[164:167], v[220:223], v[192:195], v[164:167]
s_waitcnt lgkmcnt(0)
s_barrier
v_mfma_f32_16x16x32_bf16 v[128:131], v[48:51], v[32:35], v[128:131]
ds_read_b128 v[96:99], v18 offset:32768
v_mfma_f32_16x16x32_bf16 v[136:139], v[48:51], v[36:39], v[136:139]
ds_read_b64_tr_b16 v[112:113], v13 offset:49152
v_mfma_f32_16x16x32_bf16 v[144:147], v[48:51], v[40:43], v[144:147]
ds_read_b64_tr_b16 v[114:115], v13 offset:53248
v_mfma_f32_16x16x32_bf16 v[152:155], v[48:51], v[44:47], v[152:155]
ds_read_b64_tr_b16 v[116:117], v14 offset:49152
v_mfma_f32_16x16x32_bf16 v[156:159], v[52:55], v[44:47], v[156:159]
ds_read_b64_tr_b16 v[118:119], v14 offset:53248
v_mfma_f32_16x16x32_bf16 v[148:151], v[52:55], v[40:43], v[148:151]
ds_read_b64_tr_b16 v[120:121], v15 offset:49152
v_mfma_f32_16x16x32_bf16 v[140:143], v[52:55], v[36:39], v[140:143]
ds_read_b64_tr_b16 v[122:123], v15 offset:53248
v_mfma_f32_16x16x32_bf16 v[132:135], v[52:55], v[32:35], v[132:135]
ds_read_b64_tr_b16 v[124:125], v16 offset:49152
v_mfma_f32_16x16x32_bf16 v[160:163], v[56:59], v[32:35], v[160:163]
ds_read_b64_tr_b16 v[126:127], v16 offset:53248
v_mfma_f32_16x16x32_bf16 v[168:171], v[56:59], v[36:39], v[168:171]
ds_read_b128 v[100:103], v18 offset:33792
v_mfma_f32_16x16x32_bf16 v[176:179], v[56:59], v[40:43], v[176:179]
ds_read_b128 v[104:107], v18 offset:34816
v_mfma_f32_16x16x32_bf16 v[184:187], v[56:59], v[44:47], v[184:187]
ds_read_b128 v[108:111], v18 offset:35840
v_mfma_f32_16x16x32_bf16 v[188:191], v[60:63], v[44:47], v[188:191]
ds_read_b128 v[192:195], v18 offset:40960
v_mfma_f32_16x16x32_bf16 v[180:183], v[60:63], v[40:43], v[180:183]
ds_read_b64_tr_b16 v[208:209], v13 offset:57344
v_mfma_f32_16x16x32_bf16 v[172:175], v[60:63], v[36:39], v[172:175]
ds_read_b64_tr_b16 v[210:211], v13 offset:61440
v_mfma_f32_16x16x32_bf16 v[164:167], v[60:63], v[32:35], v[164:167]
ds_read_b64_tr_b16 v[212:213], v14 offset:57344
v_mfma_f32_16x16x32_bf16 v[128:131], v[80:83], v[64:67], v[128:131]
ds_read_b64_tr_b16 v[214:215], v14 offset:61440
v_mfma_f32_16x16x32_bf16 v[136:139], v[80:83], v[68:71], v[136:139]
ds_read_b64_tr_b16 v[216:217], v15 offset:57344
v_mfma_f32_16x16x32_bf16 v[144:147], v[80:83], v[72:75], v[144:147]
ds_read_b64_tr_b16 v[218:219], v15 offset:61440
v_mfma_f32_16x16x32_bf16 v[152:155], v[80:83], v[76:79], v[152:155]
ds_read_b64_tr_b16 v[220:221], v16 offset:57344
v_mfma_f32_16x16x32_bf16 v[156:159], v[84:87], v[76:79], v[156:159]
ds_read_b64_tr_b16 v[222:223], v16 offset:61440
v_mfma_f32_16x16x32_bf16 v[148:151], v[84:87], v[72:75], v[148:151]
ds_read_b128 v[196:199], v18 offset:41984
v_mfma_f32_16x16x32_bf16 v[140:143], v[84:87], v[68:71], v[140:143]
ds_read_b128 v[200:203], v18 offset:43008
v_mfma_f32_16x16x32_bf16 v[132:135], v[84:87], v[64:67], v[132:135]
ds_read_b128 v[204:207], v18 offset:44032
v_mfma_f32_16x16x32_bf16 v[160:163], v[88:91], v[64:67], v[160:163]
v_mfma_f32_16x16x32_bf16 v[168:171], v[88:91], v[68:71], v[168:171]
v_mfma_f32_16x16x32_bf16 v[176:179], v[88:91], v[72:75], v[176:179]
v_mfma_f32_16x16x32_bf16 v[184:187], v[88:91], v[76:79], v[184:187]
v_mfma_f32_16x16x32_bf16 v[188:191], v[92:95], v[76:79], v[188:191]
v_mfma_f32_16x16x32_bf16 v[180:183], v[92:95], v[72:75], v[180:183]
v_mfma_f32_16x16x32_bf16 v[172:175], v[92:95], v[68:71], v[172:175]
v_mfma_f32_16x16x32_bf16 v[164:167], v[92:95], v[64:67], v[164:167]
s_waitcnt lgkmcnt(0)
s_barrier
v_mfma_f32_16x16x32_bf16 v[128:131], v[112:115], v[96:99], v[128:131]
ds_read_b128 v[32:35], v19 offset:0
v_mfma_f32_16x16x32_bf16 v[136:139], v[112:115], v[100:103], v[136:139]
ds_read_b64_tr_b16 v[48:49], v9 offset:0
v_mfma_f32_16x16x32_bf16 v[144:147], v[112:115], v[104:107], v[144:147]
ds_read_b64_tr_b16 v[50:51], v9 offset:4096
v_mfma_f32_16x16x32_bf16 v[152:155], v[112:115], v[108:111], v[152:155]
ds_read_b64_tr_b16 v[52:53], v10 offset:0
v_mfma_f32_16x16x32_bf16 v[156:159], v[116:119], v[108:111], v[156:159]
ds_read_b64_tr_b16 v[54:55], v10 offset:4096
v_mfma_f32_16x16x32_bf16 v[148:151], v[116:119], v[104:107], v[148:151]
ds_read_b64_tr_b16 v[56:57], v11 offset:0
v_mfma_f32_16x16x32_bf16 v[140:143], v[116:119], v[100:103], v[140:143]
ds_read_b64_tr_b16 v[58:59], v11 offset:4096
v_mfma_f32_16x16x32_bf16 v[132:135], v[116:119], v[96:99], v[132:135]
ds_read_b64_tr_b16 v[60:61], v12 offset:0
v_mfma_f32_16x16x32_bf16 v[160:163], v[120:123], v[96:99], v[160:163]
ds_read_b64_tr_b16 v[62:63], v12 offset:4096
v_mfma_f32_16x16x32_bf16 v[168:171], v[120:123], v[100:103], v[168:171]
ds_read_b128 v[36:39], v19 offset:1024
v_mfma_f32_16x16x32_bf16 v[176:179], v[120:123], v[104:107], v[176:179]
ds_read_b128 v[40:43], v19 offset:2048
v_mfma_f32_16x16x32_bf16 v[184:187], v[120:123], v[108:111], v[184:187]
ds_read_b128 v[44:47], v19 offset:3072
v_mfma_f32_16x16x32_bf16 v[188:191], v[124:127], v[108:111], v[188:191]
ds_read_b128 v[64:67], v19 offset:8192
v_mfma_f32_16x16x32_bf16 v[180:183], v[124:127], v[104:107], v[180:183]
ds_read_b64_tr_b16 v[80:81], v9 offset:8192
v_mfma_f32_16x16x32_bf16 v[172:175], v[124:127], v[100:103], v[172:175]
ds_read_b64_tr_b16 v[82:83], v9 offset:12288
v_mfma_f32_16x16x32_bf16 v[164:167], v[124:127], v[96:99], v[164:167]
ds_read_b64_tr_b16 v[84:85], v10 offset:8192
v_mfma_f32_16x16x32_bf16 v[128:131], v[208:211], v[192:195], v[128:131]
ds_read_b64_tr_b16 v[86:87], v10 offset:12288
v_mfma_f32_16x16x32_bf16 v[136:139], v[208:211], v[196:199], v[136:139]
ds_read_b64_tr_b16 v[88:89], v11 offset:8192
v_mfma_f32_16x16x32_bf16 v[144:147], v[208:211], v[200:203], v[144:147]
ds_read_b64_tr_b16 v[90:91], v11 offset:12288
v_mfma_f32_16x16x32_bf16 v[152:155], v[208:211], v[204:207], v[152:155]
ds_read_b64_tr_b16 v[92:93], v12 offset:8192
v_mfma_f32_16x16x32_bf16 v[156:159], v[212:215], v[204:207], v[156:159]
ds_read_b64_tr_b16 v[94:95], v12 offset:12288
v_mfma_f32_16x16x32_bf16 v[148:151], v[212:215], v[200:203], v[148:151]
ds_read_b128 v[68:71], v19 offset:9216
v_mfma_f32_16x16x32_bf16 v[140:143], v[212:215], v[196:199], v[140:143]
ds_read_b128 v[72:75], v19 offset:10240
v_mfma_f32_16x16x32_bf16 v[132:135], v[212:215], v[192:195], v[132:135]
ds_read_b128 v[76:79], v19 offset:11264
v_mfma_f32_16x16x32_bf16 v[160:163], v[216:219], v[192:195], v[160:163]
v_mfma_f32_16x16x32_bf16 v[168:171], v[216:219], v[196:199], v[168:171]
v_mfma_f32_16x16x32_bf16 v[176:179], v[216:219], v[200:203], v[176:179]
v_mfma_f32_16x16x32_bf16 v[184:187], v[216:219], v[204:207], v[184:187]
v_mfma_f32_16x16x32_bf16 v[188:191], v[220:223], v[204:207], v[188:191]
v_mfma_f32_16x16x32_bf16 v[180:183], v[220:223], v[200:203], v[180:183]
v_mfma_f32_16x16x32_bf16 v[172:175], v[220:223], v[196:199], v[172:175]
v_mfma_f32_16x16x32_bf16 v[164:167], v[220:223], v[192:195], v[164:167]
s_waitcnt lgkmcnt(0)
s_barrier
v_mfma_f32_16x16x32_bf16 v[128:131], v[48:51], v[32:35], v[128:131]
ds_read_b128 v[96:99], v17 offset:16384
v_mfma_f32_16x16x32_bf16 v[136:139], v[48:51], v[36:39], v[136:139]
ds_read_b64_tr_b16 v[112:113], v9 offset:32768
v_mfma_f32_16x16x32_bf16 v[144:147], v[48:51], v[40:43], v[144:147]
ds_read_b64_tr_b16 v[114:115], v9 offset:36864
v_mfma_f32_16x16x32_bf16 v[152:155], v[48:51], v[44:47], v[152:155]
ds_read_b64_tr_b16 v[116:117], v10 offset:32768
v_mfma_f32_16x16x32_bf16 v[156:159], v[52:55], v[44:47], v[156:159]
ds_read_b64_tr_b16 v[118:119], v10 offset:36864
v_mfma_f32_16x16x32_bf16 v[148:151], v[52:55], v[40:43], v[148:151]
ds_read_b64_tr_b16 v[120:121], v11 offset:32768
v_mfma_f32_16x16x32_bf16 v[140:143], v[52:55], v[36:39], v[140:143]
ds_read_b64_tr_b16 v[122:123], v11 offset:36864
v_mfma_f32_16x16x32_bf16 v[132:135], v[52:55], v[32:35], v[132:135]
ds_read_b64_tr_b16 v[124:125], v12 offset:32768
v_mfma_f32_16x16x32_bf16 v[160:163], v[56:59], v[32:35], v[160:163]
ds_read_b64_tr_b16 v[126:127], v12 offset:36864
v_mfma_f32_16x16x32_bf16 v[168:171], v[56:59], v[36:39], v[168:171]
ds_read_b128 v[100:103], v17 offset:17408
v_mfma_f32_16x16x32_bf16 v[176:179], v[56:59], v[40:43], v[176:179]
ds_read_b128 v[104:107], v17 offset:18432
v_mfma_f32_16x16x32_bf16 v[184:187], v[56:59], v[44:47], v[184:187]
ds_read_b128 v[108:111], v17 offset:19456
v_mfma_f32_16x16x32_bf16 v[188:191], v[60:63], v[44:47], v[188:191]
ds_read_b128 v[192:195], v17 offset:24576
v_mfma_f32_16x16x32_bf16 v[180:183], v[60:63], v[40:43], v[180:183]
ds_read_b64_tr_b16 v[208:209], v9 offset:40960
v_mfma_f32_16x16x32_bf16 v[172:175], v[60:63], v[36:39], v[172:175]
ds_read_b64_tr_b16 v[210:211], v9 offset:45056
v_mfma_f32_16x16x32_bf16 v[164:167], v[60:63], v[32:35], v[164:167]
ds_read_b64_tr_b16 v[212:213], v10 offset:40960
v_mfma_f32_16x16x32_bf16 v[128:131], v[80:83], v[64:67], v[128:131]
ds_read_b64_tr_b16 v[214:215], v10 offset:45056
v_mfma_f32_16x16x32_bf16 v[136:139], v[80:83], v[68:71], v[136:139]
ds_read_b64_tr_b16 v[216:217], v11 offset:40960
v_mfma_f32_16x16x32_bf16 v[144:147], v[80:83], v[72:75], v[144:147]
ds_read_b64_tr_b16 v[218:219], v11 offset:45056
v_mfma_f32_16x16x32_bf16 v[152:155], v[80:83], v[76:79], v[152:155]
ds_read_b64_tr_b16 v[220:221], v12 offset:40960
v_mfma_f32_16x16x32_bf16 v[156:159], v[84:87], v[76:79], v[156:159]
ds_read_b64_tr_b16 v[222:223], v12 offset:45056
v_mfma_f32_16x16x32_bf16 v[148:151], v[84:87], v[72:75], v[148:151]
ds_read_b128 v[196:199], v17 offset:25600
v_mfma_f32_16x16x32_bf16 v[140:143], v[84:87], v[68:71], v[140:143]
ds_read_b128 v[200:203], v17 offset:26624
v_mfma_f32_16x16x32_bf16 v[132:135], v[84:87], v[64:67], v[132:135]
ds_read_b128 v[204:207], v17 offset:27648
v_mfma_f32_16x16x32_bf16 v[160:163], v[88:91], v[64:67], v[160:163]
v_mfma_f32_16x16x32_bf16 v[168:171], v[88:91], v[68:71], v[168:171]
v_mfma_f32_16x16x32_bf16 v[176:179], v[88:91], v[72:75], v[176:179]
v_mfma_f32_16x16x32_bf16 v[184:187], v[88:91], v[76:79], v[184:187]
v_mfma_f32_16x16x32_bf16 v[188:191], v[92:95], v[76:79], v[188:191]
v_mfma_f32_16x16x32_bf16 v[180:183], v[92:95], v[72:75], v[180:183]
v_mfma_f32_16x16x32_bf16 v[172:175], v[92:95], v[68:71], v[172:175]
v_mfma_f32_16x16x32_bf16 v[164:167], v[92:95], v[64:67], v[164:167]
s_waitcnt lgkmcnt(0)
s_barrier
v_mfma_f32_16x16x32_bf16 v[128:131], v[112:115], v[96:99], v[128:131]
ds_read_b128 v[32:35], v17 offset:49152
v_mfma_f32_16x16x32_bf16 v[136:139], v[112:115], v[100:103], v[136:139]
ds_read_b64_tr_b16 v[48:49], v13 offset:0
v_mfma_f32_16x16x32_bf16 v[144:147], v[112:115], v[104:107], v[144:147]
ds_read_b64_tr_b16 v[50:51], v13 offset:4096
v_mfma_f32_16x16x32_bf16 v[152:155], v[112:115], v[108:111], v[152:155]
ds_read_b64_tr_b16 v[52:53], v14 offset:0
v_mfma_f32_16x16x32_bf16 v[156:159], v[116:119], v[108:111], v[156:159]
ds_read_b64_tr_b16 v[54:55], v14 offset:4096
v_mfma_f32_16x16x32_bf16 v[148:151], v[116:119], v[104:107], v[148:151]
ds_read_b64_tr_b16 v[56:57], v15 offset:0
v_mfma_f32_16x16x32_bf16 v[140:143], v[116:119], v[100:103], v[140:143]
ds_read_b64_tr_b16 v[58:59], v15 offset:4096
v_mfma_f32_16x16x32_bf16 v[132:135], v[116:119], v[96:99], v[132:135]
ds_read_b64_tr_b16 v[60:61], v16 offset:0
v_mfma_f32_16x16x32_bf16 v[160:163], v[120:123], v[96:99], v[160:163]
ds_read_b64_tr_b16 v[62:63], v16 offset:4096
v_mfma_f32_16x16x32_bf16 v[168:171], v[120:123], v[100:103], v[168:171]
ds_read_b128 v[36:39], v17 offset:50176
v_mfma_f32_16x16x32_bf16 v[176:179], v[120:123], v[104:107], v[176:179]
ds_read_b128 v[40:43], v17 offset:51200
v_mfma_f32_16x16x32_bf16 v[184:187], v[120:123], v[108:111], v[184:187]
ds_read_b128 v[44:47], v17 offset:52224
v_mfma_f32_16x16x32_bf16 v[188:191], v[124:127], v[108:111], v[188:191]
ds_read_b128 v[64:67], v17 offset:57344
v_mfma_f32_16x16x32_bf16 v[180:183], v[124:127], v[104:107], v[180:183]
ds_read_b64_tr_b16 v[80:81], v13 offset:8192
v_mfma_f32_16x16x32_bf16 v[172:175], v[124:127], v[100:103], v[172:175]
ds_read_b64_tr_b16 v[82:83], v13 offset:12288
v_mfma_f32_16x16x32_bf16 v[164:167], v[124:127], v[96:99], v[164:167]
ds_read_b64_tr_b16 v[84:85], v14 offset:8192
v_mfma_f32_16x16x32_bf16 v[128:131], v[208:211], v[192:195], v[128:131]
ds_read_b64_tr_b16 v[86:87], v14 offset:12288
v_mfma_f32_16x16x32_bf16 v[136:139], v[208:211], v[196:199], v[136:139]
ds_read_b64_tr_b16 v[88:89], v15 offset:8192
v_mfma_f32_16x16x32_bf16 v[144:147], v[208:211], v[200:203], v[144:147]
ds_read_b64_tr_b16 v[90:91], v15 offset:12288
v_mfma_f32_16x16x32_bf16 v[152:155], v[208:211], v[204:207], v[152:155]
ds_read_b64_tr_b16 v[92:93], v16 offset:8192
v_mfma_f32_16x16x32_bf16 v[156:159], v[212:215], v[204:207], v[156:159]
ds_read_b64_tr_b16 v[94:95], v16 offset:12288
v_mfma_f32_16x16x32_bf16 v[148:151], v[212:215], v[200:203], v[148:151]
ds_read_b128 v[68:71], v17 offset:58368
v_mfma_f32_16x16x32_bf16 v[140:143], v[212:215], v[196:199], v[140:143]
ds_read_b128 v[72:75], v17 offset:59392
v_mfma_f32_16x16x32_bf16 v[132:135], v[212:215], v[192:195], v[132:135]
ds_read_b128 v[76:79], v17 offset:60416
v_mfma_f32_16x16x32_bf16 v[160:163], v[216:219], v[192:195], v[160:163]
v_mfma_f32_16x16x32_bf16 v[168:171], v[216:219], v[196:199], v[168:171]
v_mfma_f32_16x16x32_bf16 v[176:179], v[216:219], v[200:203], v[176:179]
v_mfma_f32_16x16x32_bf16 v[184:187], v[216:219], v[204:207], v[184:187]
v_mfma_f32_16x16x32_bf16 v[188:191], v[220:223], v[204:207], v[188:191]
v_mfma_f32_16x16x32_bf16 v[180:183], v[220:223], v[200:203], v[180:183]
v_mfma_f32_16x16x32_bf16 v[172:175], v[220:223], v[196:199], v[172:175]
v_mfma_f32_16x16x32_bf16 v[164:167], v[220:223], v[192:195], v[164:167]
s_waitcnt lgkmcnt(0)
s_barrier
v_mfma_f32_16x16x32_bf16 v[128:131], v[48:51], v[32:35], v[128:131]
ds_read_b128 v[96:99], v18 offset:16384
v_mfma_f32_16x16x32_bf16 v[136:139], v[48:51], v[36:39], v[136:139]
ds_read_b64_tr_b16 v[112:113], v25 offset:16384
v_mfma_f32_16x16x32_bf16 v[144:147], v[48:51], v[40:43], v[144:147]
ds_read_b64_tr_b16 v[114:115], v25 offset:20480
v_mfma_f32_16x16x32_bf16 v[152:155], v[48:51], v[44:47], v[152:155]
ds_read_b64_tr_b16 v[116:117], v26 offset:16384
v_mfma_f32_16x16x32_bf16 v[156:159], v[52:55], v[44:47], v[156:159]
ds_read_b64_tr_b16 v[118:119], v26 offset:20480
v_mfma_f32_16x16x32_bf16 v[148:151], v[52:55], v[40:43], v[148:151]
ds_read_b64_tr_b16 v[120:121], v27 offset:16384
v_mfma_f32_16x16x32_bf16 v[140:143], v[52:55], v[36:39], v[140:143]
ds_read_b64_tr_b16 v[122:123], v27 offset:20480
v_mfma_f32_16x16x32_bf16 v[132:135], v[52:55], v[32:35], v[132:135]
ds_read_b64_tr_b16 v[124:125], v28 offset:16384
v_mfma_f32_16x16x32_bf16 v[160:163], v[56:59], v[32:35], v[160:163]
ds_read_b64_tr_b16 v[126:127], v28 offset:20480
v_mfma_f32_16x16x32_bf16 v[168:171], v[56:59], v[36:39], v[168:171]
ds_read_b128 v[100:103], v18 offset:17408
v_mfma_f32_16x16x32_bf16 v[176:179], v[56:59], v[40:43], v[176:179]
ds_read_b128 v[104:107], v18 offset:18432
v_mfma_f32_16x16x32_bf16 v[184:187], v[56:59], v[44:47], v[184:187]
ds_read_b128 v[108:111], v18 offset:19456
v_mfma_f32_16x16x32_bf16 v[188:191], v[60:63], v[44:47], v[188:191]
ds_read_b128 v[192:195], v18 offset:24576
v_mfma_f32_16x16x32_bf16 v[180:183], v[60:63], v[40:43], v[180:183]
ds_read_b64_tr_b16 v[208:209], v25 offset:24576
v_mfma_f32_16x16x32_bf16 v[172:175], v[60:63], v[36:39], v[172:175]
ds_read_b64_tr_b16 v[210:211], v25 offset:28672
v_mfma_f32_16x16x32_bf16 v[164:167], v[60:63], v[32:35], v[164:167]
ds_read_b64_tr_b16 v[212:213], v26 offset:24576
v_mfma_f32_16x16x32_bf16 v[128:131], v[80:83], v[64:67], v[128:131]
ds_read_b64_tr_b16 v[214:215], v26 offset:28672
v_mfma_f32_16x16x32_bf16 v[136:139], v[80:83], v[68:71], v[136:139]
ds_read_b64_tr_b16 v[216:217], v27 offset:24576
v_mfma_f32_16x16x32_bf16 v[144:147], v[80:83], v[72:75], v[144:147]
ds_read_b64_tr_b16 v[218:219], v27 offset:28672
v_mfma_f32_16x16x32_bf16 v[152:155], v[80:83], v[76:79], v[152:155]
ds_read_b64_tr_b16 v[220:221], v28 offset:24576
v_mfma_f32_16x16x32_bf16 v[156:159], v[84:87], v[76:79], v[156:159]
ds_read_b64_tr_b16 v[222:223], v28 offset:28672
v_mfma_f32_16x16x32_bf16 v[148:151], v[84:87], v[72:75], v[148:151]
ds_read_b128 v[196:199], v18 offset:25600
v_mfma_f32_16x16x32_bf16 v[140:143], v[84:87], v[68:71], v[140:143]
ds_read_b128 v[200:203], v18 offset:26624
v_mfma_f32_16x16x32_bf16 v[132:135], v[84:87], v[64:67], v[132:135]
ds_read_b128 v[204:207], v18 offset:27648
v_mfma_f32_16x16x32_bf16 v[160:163], v[88:91], v[64:67], v[160:163]
v_mfma_f32_16x16x32_bf16 v[168:171], v[88:91], v[68:71], v[168:171]
v_mfma_f32_16x16x32_bf16 v[176:179], v[88:91], v[72:75], v[176:179]
v_mfma_f32_16x16x32_bf16 v[184:187], v[88:91], v[76:79], v[184:187]
v_mfma_f32_16x16x32_bf16 v[188:191], v[92:95], v[76:79], v[188:191]
v_mfma_f32_16x16x32_bf16 v[180:183], v[92:95], v[72:75], v[180:183]
v_mfma_f32_16x16x32_bf16 v[172:175], v[92:95], v[68:71], v[172:175]
v_mfma_f32_16x16x32_bf16 v[164:167], v[92:95], v[64:67], v[164:167]
s_waitcnt lgkmcnt(0)
s_barrier
v_mfma_f32_16x16x32_bf16 v[128:131], v[112:115], v[96:99], v[128:131]
ds_read_b128 v[32:35], v18 offset:32768
v_mfma_f32_16x16x32_bf16 v[136:139], v[112:115], v[100:103], v[136:139]
ds_read_b64_tr_b16 v[48:49], v13 offset:49152
v_mfma_f32_16x16x32_bf16 v[144:147], v[112:115], v[104:107], v[144:147]
ds_read_b64_tr_b16 v[50:51], v13 offset:53248
v_mfma_f32_16x16x32_bf16 v[152:155], v[112:115], v[108:111], v[152:155]
ds_read_b64_tr_b16 v[52:53], v14 offset:49152
v_mfma_f32_16x16x32_bf16 v[156:159], v[116:119], v[108:111], v[156:159]
ds_read_b64_tr_b16 v[54:55], v14 offset:53248
v_mfma_f32_16x16x32_bf16 v[148:151], v[116:119], v[104:107], v[148:151]
ds_read_b64_tr_b16 v[56:57], v15 offset:49152
v_mfma_f32_16x16x32_bf16 v[140:143], v[116:119], v[100:103], v[140:143]
ds_read_b64_tr_b16 v[58:59], v15 offset:53248
v_mfma_f32_16x16x32_bf16 v[132:135], v[116:119], v[96:99], v[132:135]
ds_read_b64_tr_b16 v[60:61], v16 offset:49152
v_mfma_f32_16x16x32_bf16 v[160:163], v[120:123], v[96:99], v[160:163]
ds_read_b64_tr_b16 v[62:63], v16 offset:53248
v_mfma_f32_16x16x32_bf16 v[168:171], v[120:123], v[100:103], v[168:171]
ds_read_b128 v[36:39], v18 offset:33792
v_mfma_f32_16x16x32_bf16 v[176:179], v[120:123], v[104:107], v[176:179]
ds_read_b128 v[40:43], v18 offset:34816
v_mfma_f32_16x16x32_bf16 v[184:187], v[120:123], v[108:111], v[184:187]
ds_read_b128 v[44:47], v18 offset:35840
v_mfma_f32_16x16x32_bf16 v[188:191], v[124:127], v[108:111], v[188:191]
ds_read_b128 v[64:67], v18 offset:40960
v_mfma_f32_16x16x32_bf16 v[180:183], v[124:127], v[104:107], v[180:183]
ds_read_b64_tr_b16 v[80:81], v13 offset:57344
v_mfma_f32_16x16x32_bf16 v[172:175], v[124:127], v[100:103], v[172:175]
ds_read_b64_tr_b16 v[82:83], v13 offset:61440
v_mfma_f32_16x16x32_bf16 v[164:167], v[124:127], v[96:99], v[164:167]
ds_read_b64_tr_b16 v[84:85], v14 offset:57344
v_mfma_f32_16x16x32_bf16 v[128:131], v[208:211], v[192:195], v[128:131]
ds_read_b64_tr_b16 v[86:87], v14 offset:61440
v_mfma_f32_16x16x32_bf16 v[136:139], v[208:211], v[196:199], v[136:139]
ds_read_b64_tr_b16 v[88:89], v15 offset:57344
v_mfma_f32_16x16x32_bf16 v[144:147], v[208:211], v[200:203], v[144:147]
ds_read_b64_tr_b16 v[90:91], v15 offset:61440
v_mfma_f32_16x16x32_bf16 v[152:155], v[208:211], v[204:207], v[152:155]
ds_read_b64_tr_b16 v[92:93], v16 offset:57344
v_mfma_f32_16x16x32_bf16 v[156:159], v[212:215], v[204:207], v[156:159]
ds_read_b64_tr_b16 v[94:95], v16 offset:61440
v_mfma_f32_16x16x32_bf16 v[148:151], v[212:215], v[200:203], v[148:151]
ds_read_b128 v[68:71], v18 offset:41984
v_mfma_f32_16x16x32_bf16 v[140:143], v[212:215], v[196:199], v[140:143]
ds_read_b128 v[72:75], v18 offset:43008
v_mfma_f32_16x16x32_bf16 v[132:135], v[212:215], v[192:195], v[132:135]
ds_read_b128 v[76:79], v18 offset:44032
v_mfma_f32_16x16x32_bf16 v[160:163], v[216:219], v[192:195], v[160:163]
v_mfma_f32_16x16x32_bf16 v[168:171], v[216:219], v[196:199], v[168:171]
v_mfma_f32_16x16x32_bf16 v[176:179], v[216:219], v[200:203], v[176:179]
v_mfma_f32_16x16x32_bf16 v[184:187], v[216:219], v[204:207], v[184:187]
v_mfma_f32_16x16x32_bf16 v[188:191], v[220:223], v[204:207], v[188:191]
v_mfma_f32_16x16x32_bf16 v[180:183], v[220:223], v[200:203], v[180:183]
v_mfma_f32_16x16x32_bf16 v[172:175], v[220:223], v[196:199], v[172:175]
v_mfma_f32_16x16x32_bf16 v[164:167], v[220:223], v[192:195], v[164:167]
s_waitcnt lgkmcnt(0)
s_barrier
v_mfma_f32_16x16x32_bf16 v[128:131], v[48:51], v[32:35], v[128:131]
ds_read_b128 v[96:99], v19 offset:0
v_mfma_f32_16x16x32_bf16 v[136:139], v[48:51], v[36:39], v[136:139]
ds_read_b64_tr_b16 v[112:113], v9 offset:0
v_mfma_f32_16x16x32_bf16 v[144:147], v[48:51], v[40:43], v[144:147]
ds_read_b64_tr_b16 v[114:115], v9 offset:4096
v_mfma_f32_16x16x32_bf16 v[152:155], v[48:51], v[44:47], v[152:155]
ds_read_b64_tr_b16 v[116:117], v10 offset:0
v_mfma_f32_16x16x32_bf16 v[156:159], v[52:55], v[44:47], v[156:159]
ds_read_b64_tr_b16 v[118:119], v10 offset:4096
v_mfma_f32_16x16x32_bf16 v[148:151], v[52:55], v[40:43], v[148:151]
ds_read_b64_tr_b16 v[120:121], v11 offset:0
v_mfma_f32_16x16x32_bf16 v[140:143], v[52:55], v[36:39], v[140:143]
ds_read_b64_tr_b16 v[122:123], v11 offset:4096
v_mfma_f32_16x16x32_bf16 v[132:135], v[52:55], v[32:35], v[132:135]
ds_read_b64_tr_b16 v[124:125], v12 offset:0
v_mfma_f32_16x16x32_bf16 v[160:163], v[56:59], v[32:35], v[160:163]
ds_read_b64_tr_b16 v[126:127], v12 offset:4096
v_mfma_f32_16x16x32_bf16 v[168:171], v[56:59], v[36:39], v[168:171]
ds_read_b128 v[100:103], v19 offset:1024
v_mfma_f32_16x16x32_bf16 v[176:179], v[56:59], v[40:43], v[176:179]
ds_read_b128 v[104:107], v19 offset:2048
v_mfma_f32_16x16x32_bf16 v[184:187], v[56:59], v[44:47], v[184:187]
ds_read_b128 v[108:111], v19 offset:3072
v_mfma_f32_16x16x32_bf16 v[188:191], v[60:63], v[44:47], v[188:191]
ds_read_b128 v[192:195], v19 offset:8192
v_mfma_f32_16x16x32_bf16 v[180:183], v[60:63], v[40:43], v[180:183]
ds_read_b64_tr_b16 v[208:209], v9 offset:8192
v_mfma_f32_16x16x32_bf16 v[172:175], v[60:63], v[36:39], v[172:175]
ds_read_b64_tr_b16 v[210:211], v9 offset:12288
v_mfma_f32_16x16x32_bf16 v[164:167], v[60:63], v[32:35], v[164:167]
ds_read_b64_tr_b16 v[212:213], v10 offset:8192
v_mfma_f32_16x16x32_bf16 v[128:131], v[80:83], v[64:67], v[128:131]
ds_read_b64_tr_b16 v[214:215], v10 offset:12288
v_mfma_f32_16x16x32_bf16 v[136:139], v[80:83], v[68:71], v[136:139]
ds_read_b64_tr_b16 v[216:217], v11 offset:8192
v_mfma_f32_16x16x32_bf16 v[144:147], v[80:83], v[72:75], v[144:147]
ds_read_b64_tr_b16 v[218:219], v11 offset:12288
v_mfma_f32_16x16x32_bf16 v[152:155], v[80:83], v[76:79], v[152:155]
ds_read_b64_tr_b16 v[220:221], v12 offset:8192
v_mfma_f32_16x16x32_bf16 v[156:159], v[84:87], v[76:79], v[156:159]
ds_read_b64_tr_b16 v[222:223], v12 offset:12288
v_mfma_f32_16x16x32_bf16 v[148:151], v[84:87], v[72:75], v[148:151]
ds_read_b128 v[196:199], v19 offset:9216
v_mfma_f32_16x16x32_bf16 v[140:143], v[84:87], v[68:71], v[140:143]
ds_read_b128 v[200:203], v19 offset:10240
v_mfma_f32_16x16x32_bf16 v[132:135], v[84:87], v[64:67], v[132:135]
ds_read_b128 v[204:207], v19 offset:11264
v_mfma_f32_16x16x32_bf16 v[160:163], v[88:91], v[64:67], v[160:163]
v_mfma_f32_16x16x32_bf16 v[168:171], v[88:91], v[68:71], v[168:171]
v_mfma_f32_16x16x32_bf16 v[176:179], v[88:91], v[72:75], v[176:179]
v_mfma_f32_16x16x32_bf16 v[184:187], v[88:91], v[76:79], v[184:187]
v_mfma_f32_16x16x32_bf16 v[188:191], v[92:95], v[76:79], v[188:191]
v_mfma_f32_16x16x32_bf16 v[180:183], v[92:95], v[72:75], v[180:183]
v_mfma_f32_16x16x32_bf16 v[172:175], v[92:95], v[68:71], v[172:175]
v_mfma_f32_16x16x32_bf16 v[164:167], v[92:95], v[64:67], v[164:167]
s_sub_u32 s41, s41, 1
s_cmp_lg_u32 s41, 0
s_cbranch_scc1 Lk4_136
s_waitcnt lgkmcnt(0)
s_barrier
v_mfma_f32_16x16x32_bf16 v[128:131], v[112:115], v[96:99], v[128:131]
ds_read_b128 v[32:35], v17 offset:16384
v_mfma_f32_16x16x32_bf16 v[136:139], v[112:115], v[100:103], v[136:139]
ds_read_b64_tr_b16 v[48:49], v224 offset:32768
v_mfma_f32_16x16x32_bf16 v[144:147], v[112:115], v[104:107], v[144:147]
ds_read_b64_tr_b16 v[50:51], v224 offset:34816
v_mfma_f32_16x16x32_bf16 v[152:155], v[112:115], v[108:111], v[152:155]
ds_read_b64_tr_b16 v[52:53], v225 offset:32768
v_mfma_f32_16x16x32_bf16 v[156:159], v[116:119], v[108:111], v[156:159]
ds_read_b64_tr_b16 v[54:55], v225 offset:34816
v_mfma_f32_16x16x32_bf16 v[148:151], v[116:119], v[104:107], v[148:151]
ds_read_b128 v[36:39], v17 offset:17408
v_mfma_f32_16x16x32_bf16 v[140:143], v[116:119], v[100:103], v[140:143]
ds_read_b128 v[40:43], v17 offset:18432
v_mfma_f32_16x16x32_bf16 v[132:135], v[116:119], v[96:99], v[132:135]
ds_read_b128 v[44:47], v17 offset:19456
v_mfma_f32_16x16x32_bf16 v[160:163], v[120:123], v[96:99], v[160:163]
ds_read_b128 v[64:67], v17 offset:24576
v_mfma_f32_16x16x32_bf16 v[168:171], v[120:123], v[100:103], v[168:171]
ds_read_b64_tr_b16 v[80:81], v224 offset:36864
v_mfma_f32_16x16x32_bf16 v[176:179], v[120:123], v[104:107], v[176:179]
ds_read_b64_tr_b16 v[82:83], v224 offset:38912
v_mfma_f32_16x16x32_bf16 v[184:187], v[120:123], v[108:111], v[184:187]
ds_read_b64_tr_b16 v[84:85], v225 offset:36864
v_mfma_f32_16x16x32_bf16 v[188:191], v[124:127], v[108:111], v[188:191]
ds_read_b64_tr_b16 v[86:87], v225 offset:38912
v_mfma_f32_16x16x32_bf16 v[180:183], v[124:127], v[104:107], v[180:183]
ds_read_b128 v[68:71], v17 offset:25600
v_mfma_f32_16x16x32_bf16 v[172:175], v[124:127], v[100:103], v[172:175]
ds_read_b128 v[72:75], v17 offset:26624
v_mfma_f32_16x16x32_bf16 v[164:167], v[124:127], v[96:99], v[164:167]
ds_read_b128 v[76:79], v17 offset:27648
v_mfma_f32_16x16x32_bf16 v[128:131], v[208:211], v[192:195], v[128:131]
v_mfma_f32_16x16x32_bf16 v[136:139], v[208:211], v[196:199], v[136:139]
v_mfma_f32_16x16x32_bf16 v[144:147], v[208:211], v[200:203], v[144:147]
v_mfma_f32_16x16x32_bf16 v[152:155], v[208:211], v[204:207], v[152:155]
v_mfma_f32_16x16x32_bf16 v[156:159], v[212:215], v[204:207], v[156:159]
v_mfma_f32_16x16x32_bf16 v[148:151], v[212:215], v[200:203], v[148:151]
v_mfma_f32_16x16x32_bf16 v[140:143], v[212:215], v[196:199], v[140:143]
v_mfma_f32_16x16x32_bf16 v[132:135], v[212:215], v[192:195], v[132:135]
s_branch Lov_12
.p2align 12
.fill 96, 4, 0xbf800000
Lst_12_0:
s_branch Lwr_172
Lst_12_1:
s_branch Lst_16_0
s_nop 0
Lov_12:
v_mfma_f32_16x16x32_bf16 v[160:163], v[216:219], v[192:195], v[160:163]
v_mfma_f32_16x16x32_bf16 v[168:171], v[216:219], v[196:199], v[168:171]
v_mfma_f32_16x16x32_bf16 v[176:179], v[216:219], v[200:203], v[176:179]
v_mfma_f32_16x16x32_bf16 v[184:187], v[216:219], v[204:207], v[184:187]
v_mfma_f32_16x16x32_bf16 v[188:191], v[220:223], v[204:207], v[188:191]
v_mfma_f32_16x16x32_bf16 v[180:183], v[220:223], v[200:203], v[180:183]
v_mfma_f32_16x16x32_bf16 v[172:175], v[220:223], v[196:199], v[172:175]
v_mfma_f32_16x16x32_bf16 v[164:167], v[220:223], v[192:195], v[164:167]
s_waitcnt lgkmcnt(0)
s_barrier
v_mfma_f32_16x16x32_bf16 v[128:131], v[48:51], v[32:35], v[128:131]
ds_read_b128 v[96:99], v17 offset:49152
ds_read_b64_tr_b16 v[112:113], v226 offset:0
v_mfma_f32_16x16x32_bf16 v[136:139], v[48:51], v[36:39], v[136:139]
ds_read_b64_tr_b16 v[114:115], v226 offset:2048
ds_read_b64_tr_b16 v[116:117], v227 offset:0
v_mfma_f32_16x16x32_bf16 v[144:147], v[48:51], v[40:43], v[144:147]
ds_read_b64_tr_b16 v[118:119], v227 offset:2048
ds_read_b128 v[100:103], v17 offset:50176
v_mfma_f32_16x16x32_bf16 v[152:155], v[48:51], v[44:47], v[152:155]
ds_read_b128 v[104:107], v17 offset:51200
ds_read_b128 v[108:111], v17 offset:52224
v_mfma_f32_16x16x32_bf16 v[156:159], v[52:55], v[44:47], v[156:159]
ds_read_b128 v[192:195], v17 offset:57344
v_mfma_f32_16x16x32_bf16 v[148:151], v[52:55], v[40:43], v[148:151]
ds_read_b64_tr_b16 v[208:209], v226 offset:4096
v_mfma_f32_16x16x32_bf16 v[140:143], v[52:55], v[36:39], v[140:143]
ds_read_b64_tr_b16 v[210:211], v226 offset:6144
v_cvt_pk_bf16_f32 v160, v160, v161
v_cvt_pk_bf16_f32 v161, v162, v163
v_mfma_f32_16x16x32_bf16 v[132:135], v[52:55], v[32:35], v[132:135]
ds_read_b64_tr_b16 v[212:213], v227 offset:4096
v_cvt_pk_bf16_f32 v162, v164, v165
v_cvt_pk_bf16_f32 v163, v166, v167
v_mfma_f32_16x16x32_bf16 v[128:131], v[80:83], v[64:67], v[128:131]
ds_read_b64_tr_b16 v[214:215], v227 offset:6144
v_cvt_pk_bf16_f32 v164, v168, v169
v_cvt_pk_bf16_f32 v165, v170, v171
v_mfma_f32_16x16x32_bf16 v[136:139], v[80:83], v[68:71], v[136:139]
ds_read_b128 v[196:199], v17 offset:58368
v_cvt_pk_bf16_f32 v166, v172, v173
v_cvt_pk_bf16_f32 v167, v174, v175
v_mfma_f32_16x16x32_bf16 v[144:147], v[80:83], v[72:75], v[144:147]
ds_read_b128 v[200:203], v17 offset:59392
v_cvt_pk_bf16_f32 v168, v176, v177
v_cvt_pk_bf16_f32 v169, v178, v179
v_mfma_f32_16x16x32_bf16 v[152:155], v[80:83], v[76:79], v[152:155]
ds_read_b128 v[204:207], v17 offset:60416
v_cvt_pk_bf16_f32 v170, v180, v181
v_cvt_pk_bf16_f32 v171, v182, v183
v_mfma_f32_16x16x32_bf16 v[156:159], v[84:87], v[76:79], v[156:159]
v_cvt_pk_bf16_f32 v172, v184, v185
v_cvt_pk_bf16_f32 v173, v186, v187
v_mfma_f32_16x16x32_bf16 v[148:151], v[84:87], v[72:75], v[148:151]
v_cvt_pk_bf16_f32 v174, v188, v189
v_cvt_pk_bf16_f32 v175, v190, v191
v_mfma_f32_16x16x32_bf16 v[140:143], v[84:87], v[68:71], v[140:143]
v_mfma_f32_16x16x32_bf16 v[132:135], v[84:87], v[64:67], v[132:135]
buffer_store_dwordx4 v[160:163], v2, s[84:87], s45 offen offset:0 sc1
s_waitcnt lgkmcnt(0)
s_barrier
v_mfma_f32_16x16x32_bf16 v[128:131], v[112:115], v[96:99], v[128:131]
ds_read_b128 v[32:35], v18 offset:16384
ds_read_b64_tr_b16 v[48:49], v228 offset:16384
v_mfma_f32_16x16x32_bf16 v[136:139], v[112:115], v[100:103], v[136:139]
ds_read_b64_tr_b16 v[50:51], v228 offset:18432
ds_read_b64_tr_b16 v[52:53], v229 offset:16384
v_mfma_f32_16x16x32_bf16 v[144:147], v[112:115], v[104:107], v[144:147]
ds_read_b64_tr_b16 v[54:55], v229 offset:18432
ds_read_b128 v[36:39], v18 offset:17408
v_mfma_f32_16x16x32_bf16 v[152:155], v[112:115], v[108:111], v[152:155]
ds_read_b128 v[40:43], v18 offset:18432
ds_read_b128 v[44:47], v18 offset:19456
v_mfma_f32_16x16x32_bf16 v[156:159], v[116:119], v[108:111], v[156:159]
ds_read_b128 v[64:67], v18 offset:24576
v_mfma_f32_16x16x32_bf16 v[148:151], v[116:119], v[104:107], v[148:151]
ds_read_b64_tr_b16 v[80:81], v228 offset:20480
v_mfma_f32_16x16x32_bf16 v[140:143], v[116:119], v[100:103], v[140:143]
ds_read_b64_tr_b16 v[82:83], v228 offset:22528
v_mfma_f32_16x16x32_bf16 v[132:135], v[116:119], v[96:99], v[132:135]
ds_read_b64_tr_b16 v[84:85], v229 offset:20480
v_mfma_f32_16x16x32_bf16 v[128:131], v[208:211], v[192:195], v[128:131]
ds_read_b64_tr_b16 v[86:87], v229 offset:22528
buffer_store_dwordx4 v[164:167], v2, s[84:87], s45 offen offset:1024 sc1
v_mfma_f32_16x16x32_bf16 v[136:139], v[208:211], v[196:199], v[136:139]
ds_read_b128 v[68:71], v18 offset:25600
v_mfma_f32_16x16x32_bf16 v[144:147], v[208:211], v[200:203], v[144:147]
ds_read_b128 v[72:75], v18 offset:26624
v_mfma_f32_16x16x32_bf16 v[152:155], v[208:211], v[204:207], v[152:155]
ds_read_b128 v[76:79], v18 offset:27648
v_mfma_f32_16x16x32_bf16 v[156:159], v[212:215], v[204:207], v[156:159]
v_mfma_f32_16x16x32_bf16 v[148:151], v[212:215], v[200:203], v[148:151]
v_mfma_f32_16x16x32_bf16 v[140:143], v[212:215], v[196:199], v[140:143]
v_mfma_f32_16x16x32_bf16 v[132:135], v[212:215], v[192:195], v[132:135]
s_waitcnt lgkmcnt(0)
s_barrier
v_mfma_f32_16x16x32_bf16 v[128:131], v[48:51], v[32:35], v[128:131]
ds_read_b128 v[96:99], v18 offset:32768
ds_read_b64_tr_b16 v[112:113], v226 offset:49152
v_mfma_f32_16x16x32_bf16 v[136:139], v[48:51], v[36:39], v[136:139]
ds_read_b64_tr_b16 v[114:115], v226 offset:51200
ds_read_b64_tr_b16 v[116:117], v227 offset:49152
v_mfma_f32_16x16x32_bf16 v[144:147], v[48:51], v[40:43], v[144:147]
ds_read_b64_tr_b16 v[118:119], v227 offset:51200
ds_read_b128 v[100:103], v18 offset:33792
v_mfma_f32_16x16x32_bf16 v[152:155], v[48:51], v[44:47], v[152:155]
ds_read_b128 v[104:107], v18 offset:34816
ds_read_b128 v[108:111], v18 offset:35840
v_mfma_f32_16x16x32_bf16 v[156:159], v[52:55], v[44:47], v[156:159]
ds_read_b128 v[192:195], v18 offset:40960
v_mfma_f32_16x16x32_bf16 v[148:151], v[52:55], v[40:43], v[148:151]
ds_read_b64_tr_b16 v[208:209], v226 offset:53248
v_mfma_f32_16x16x32_bf16 v[140:143], v[52:55], v[36:39], v[140:143]
ds_read_b64_tr_b16 v[210:211], v226 offset:55296
v_mfma_f32_16x16x32_bf16 v[132:135], v[52:55], v[32:35], v[132:135]
ds_read_b64_tr_b16 v[212:213], v227 offset:53248
v_mfma_f32_16x16x32_bf16 v[128:131], v[80:83], v[64:67], v[128:131]
ds_read_b64_tr_b16 v[214:215], v227 offset:55296
buffer_store_dwordx4 v[168:171], v2, s[84:87], s45 offen offset:2048 sc1
v_mfma_f32_16x16x32_bf16 v[136:139], v[80:83], v[68:71], v[136:139]
ds_read_b128 v[196:199], v18 offset:41984
v_mfma_f32_16x16x32_bf16 v[144:147], v[80:83], v[72:75], v[144:147]
ds_read_b128 v[200:203], v18 offset:43008
v_mfma_f32_16x16x32_bf16 v[152:155], v[80:83], v[76:79], v[152:155]
ds_read_b128 v[204:207], v18 offset:44032
v_mfma_f32_16x16x32_bf16 v[156:159], v[84:87], v[76:79], v[156:159]
v_mfma_f32_16x16x32_bf16 v[148:151], v[84:87], v[72:75], v[148:151]
v_mfma_f32_16x16x32_bf16 v[140:143], v[84:87], v[68:71], v[140:143]
v_mfma_f32_16x16x32_bf16 v[132:135], v[84:87], v[64:67], v[132:135]
s_waitcnt lgkmcnt(0)
s_barrier
v_mfma_f32_16x16x32_bf16 v[128:131], v[112:115], v[96:99], v[128:131]
ds_read_b128 v[32:35], v19 offset:0
ds_read_b64_tr_b16 v[48:49], v224 offset:0
v_mfma_f32_16x16x32_bf16 v[136:139], v[112:115], v[100:103], v[136:139]
ds_read_b64_tr_b16 v[50:51], v224 offset:2048
ds_read_b64_tr_b16 v[52:53], v225 offset:0
v_mfma_f32_16x16x32_bf16 v[144:147], v[112:115], v[104:107], v[144:147]
ds_read_b64_tr_b16 v[54:55], v225 offset:2048
ds_read_b128 v[36:39], v19 offset:1024
v_mfma_f32_16x16x32_bf16 v[152:155], v[112:115], v[108:111], v[152:155]
ds_read_b128 v[40:43], v19 offset:2048
ds_read_b128 v[44:47], v19 offset:3072
v_mfma_f32_16x16x32_bf16 v[156:159], v[116:119], v[108:111], v[156:159]
ds_read_b128 v[64:67], v19 offset:8192
v_mfma_f32_16x16x32_bf16 v[148:151], v[116:119], v[104:107], v[148:151]
ds_read_b64_tr_b16 v[80:81], v224 offset:4096
v_mfma_f32_16x16x32_bf16 v[140:143], v[116:119], v[100:103], v[140:143]
ds_read_b64_tr_b16 v[82:83], v224 offset:6144
v_mfma_f32_16x16x32_bf16 v[132:135], v[116:119], v[96:99], v[132:135]
ds_read_b64_tr_b16 v[84:85], v225 offset:4096
v_mfma_f32_16x16x32_bf16 v[128:131], v[208:211], v[192:195], v[128:131]
ds_read_b64_tr_b16 v[86:87], v225 offset:6144
buffer_store_dwordx4 v[172:175], v2, s[84:87], s45 offen offset:3072 sc1
v_mfma_f32_16x16x32_bf16 v[136:139], v[208:211], v[196:199], v[136:139]
ds_read_b128 v[68:71], v19 offset:9216
v_mfma_f32_16x16x32_bf16 v[144:147], v[208:211], v[200:203], v[144:147]
ds_read_b128 v[72:75], v19 offset:10240
v_mfma_f32_16x16x32_bf16 v[152:155], v[208:211], v[204:207], v[152:155]
ds_read_b128 v[76:79], v19 offset:11264
v_mfma_f32_16x16x32_bf16 v[156:159], v[212:215], v[204:207], v[156:159]
v_mfma_f32_16x16x32_bf16 v[148:151], v[212:215], v[200:203], v[148:151]
v_mfma_f32_16x16x32_bf16 v[140:143], v[212:215], v[196:199], v[140:143]
v_mfma_f32_16x16x32_bf16 v[132:135], v[212:215], v[192:195], v[132:135]
s_waitcnt lgkmcnt(0)
s_barrier
v_mfma_f32_16x16x32_bf16 v[128:131], v[48:51], v[32:35], v[128:131]
ds_read_b128 v[96:99], v17 offset:16384
ds_read_b64_tr_b16 v[112:113], v224 offset:32768
v_mfma_f32_16x16x32_bf16 v[136:139], v[48:51], v[36:39], v[136:139]
ds_read_b64_tr_b16 v[114:115], v224 offset:34816
ds_read_b64_tr_b16 v[116:117], v225 offset:32768
v_mfma_f32_16x16x32_bf16 v[144:147], v[48:51], v[40:43], v[144:147]
ds_read_b64_tr_b16 v[118:119], v225 offset:34816
ds_read_b128 v[100:103], v17 offset:17408
v_mfma_f32_16x16x32_bf16 v[152:155], v[48:51], v[44:47], v[152:155]
ds_read_b128 v[104:107], v17 offset:18432
ds_read_b128 v[108:111], v17 offset:19456
v_mfma_f32_16x16x32_bf16 v[156:159], v[52:55], v[44:47], v[156:159]
ds_read_b128 v[192:195], v17 offset:24576
v_mfma_f32_16x16x32_bf16 v[148:151], v[52:55], v[40:43], v[148:151]
ds_read_b64_tr_b16 v[208:209], v224 offset:36864
v_mfma_f32_16x16x32_bf16 v[140:143], v[52:55], v[36:39], v[140:143]
ds_read_b64_tr_b16 v[210:211], v224 offset:38912
v_mfma_f32_16x16x32_bf16 v[132:135], v[52:55], v[32:35], v[132:135]
ds_read_b64_tr_b16 v[212:213], v225 offset:36864
v_mfma_f32_16x16x32_bf16 v[128:131], v[80:83], v[64:67], v[128:131]
ds_read_b64_tr_b16 v[214:215], v225 offset:38912
v_mfma_f32_16x16x32_bf16 v[136:139], v[80:83], v[68:71], v[136:139]
ds_read_b128 v[196:199], v17 offset:25600
v_mfma_f32_16x16x32_bf16 v[144:147], v[80:83], v[72:75], v[144:147]
ds_read_b128 v[200:203], v17 offset:26624
v_mfma_f32_16x16x32_bf16 v[152:155], v[80:83], v[76:79], v[152:155]
ds_read_b128 v[204:207], v17 offset:27648
v_mfma_f32_16x16x32_bf16 v[156:159], v[84:87], v[76:79], v[156:159]
v_mfma_f32_16x16x32_bf16 v[148:151], v[84:87], v[72:75], v[148:151]
v_mfma_f32_16x16x32_bf16 v[140:143], v[84:87], v[68:71], v[140:143]
v_mfma_f32_16x16x32_bf16 v[132:135], v[84:87], v[64:67], v[132:135]
s_waitcnt vmcnt(0)
s_waitcnt lgkmcnt(0)
s_barrier
v_mfma_f32_16x16x32_bf16 v[128:131], v[112:115], v[96:99], v[128:131]
ds_read_b128 v[32:35], v17 offset:49152
ds_read_b64_tr_b16 v[48:49], v226 offset:0
v_mfma_f32_16x16x32_bf16 v[136:139], v[112:115], v[100:103], v[136:139]
ds_read_b64_tr_b16 v[50:51], v226 offset:2048
ds_read_b64_tr_b16 v[52:53], v227 offset:0
v_mfma_f32_16x16x32_bf16 v[144:147], v[112:115], v[104:107], v[144:147]
ds_read_b64_tr_b16 v[54:55], v227 offset:2048
ds_read_b128 v[36:39], v17 offset:50176
v_mfma_f32_16x16x32_bf16 v[152:155], v[112:115], v[108:111], v[152:155]
ds_read_b128 v[40:43], v17 offset:51200
ds_read_b128 v[44:47], v17 offset:52224
v_mfma_f32_16x16x32_bf16 v[156:159], v[116:119], v[108:111], v[156:159]
ds_read_b128 v[64:67], v17 offset:57344
v_mfma_f32_16x16x32_bf16 v[148:151], v[116:119], v[104:107], v[148:151]
ds_read_b64_tr_b16 v[80:81], v226 offset:4096
v_mfma_f32_16x16x32_bf16 v[140:143], v[116:119], v[100:103], v[140:143]
ds_read_b64_tr_b16 v[82:83], v226 offset:6144
v_mfma_f32_16x16x32_bf16 v[132:135], v[116:119], v[96:99], v[132:135]
ds_read_b64_tr_b16 v[84:85], v227 offset:4096
v_mfma_f32_16x16x32_bf16 v[128:131], v[208:211], v[192:195], v[128:131]
ds_read_b64_tr_b16 v[86:87], v227 offset:6144
v_mfma_f32_16x16x32_bf16 v[136:139], v[208:211], v[196:199], v[136:139]
ds_read_b128 v[68:71], v17 offset:58368
v_mfma_f32_16x16x32_bf16 v[144:147], v[208:211], v[200:203], v[144:147]
ds_read_b128 v[72:75], v17 offset:59392
v_mfma_f32_16x16x32_bf16 v[152:155], v[208:211], v[204:207], v[152:155]
ds_read_b128 v[76:79], v17 offset:60416
v_mfma_f32_16x16x32_bf16 v[156:159], v[212:215], v[204:207], v[156:159]
v_mfma_f32_16x16x32_bf16 v[148:151], v[212:215], v[200:203], v[148:151]
v_mfma_f32_16x16x32_bf16 v[140:143], v[212:215], v[196:199], v[140:143]
v_mfma_f32_16x16x32_bf16 v[132:135], v[212:215], v[192:195], v[132:135]
s_waitcnt lgkmcnt(0)
s_barrier
v_mfma_f32_16x16x32_bf16 v[128:131], v[48:51], v[32:35], v[128:131]
ds_read_b128 v[96:99], v18 offset:16384
ds_read_b64_tr_b16 v[112:113], v228 offset:16384
v_mfma_f32_16x16x32_bf16 v[136:139], v[48:51], v[36:39], v[136:139]
ds_read_b64_tr_b16 v[114:115], v228 offset:18432
ds_read_b64_tr_b16 v[116:117], v229 offset:16384
v_mfma_f32_16x16x32_bf16 v[144:147], v[48:51], v[40:43], v[144:147]
ds_read_b64_tr_b16 v[118:119], v229 offset:18432
ds_read_b128 v[100:103], v18 offset:17408
v_mfma_f32_16x16x32_bf16 v[152:155], v[48:51], v[44:47], v[152:155]
ds_read_b128 v[104:107], v18 offset:18432
ds_read_b128 v[108:111], v18 offset:19456
v_mfma_f32_16x16x32_bf16 v[156:159], v[52:55], v[44:47], v[156:159]
ds_read_b128 v[192:195], v18 offset:24576
v_mfma_f32_16x16x32_bf16 v[148:151], v[52:55], v[40:43], v[148:151]
ds_read_b64_tr_b16 v[208:209], v228 offset:20480
v_mfma_f32_16x16x32_bf16 v[140:143], v[52:55], v[36:39], v[140:143]
ds_read_b64_tr_b16 v[210:211], v228 offset:22528
v_mfma_f32_16x16x32_bf16 v[132:135], v[52:55], v[32:35], v[132:135]
ds_read_b64_tr_b16 v[212:213], v229 offset:20480
v_mfma_f32_16x16x32_bf16 v[128:131], v[80:83], v[64:67], v[128:131]
ds_read_b64_tr_b16 v[214:215], v229 offset:22528
v_mfma_f32_16x16x32_bf16 v[136:139], v[80:83], v[68:71], v[136:139]
ds_read_b128 v[196:199], v18 offset:25600
v_mfma_f32_16x16x32_bf16 v[144:147], v[80:83], v[72:75], v[144:147]
ds_read_b128 v[200:203], v18 offset:26624
v_mfma_f32_16x16x32_bf16 v[152:155], v[80:83], v[76:79], v[152:155]
ds_read_b128 v[204:207], v18 offset:27648
v_mfma_f32_16x16x32_bf16 v[156:159], v[84:87], v[76:79], v[156:159]
v_mfma_f32_16x16x32_bf16 v[148:151], v[84:87], v[72:75], v[148:151]
v_mfma_f32_16x16x32_bf16 v[140:143], v[84:87], v[68:71], v[140:143]
v_mfma_f32_16x16x32_bf16 v[132:135], v[84:87], v[64:67], v[132:135]
s_waitcnt lgkmcnt(0)
s_barrier
v_mfma_f32_16x16x32_bf16 v[128:131], v[112:115], v[96:99], v[128:131]
ds_read_b128 v[32:35], v18 offset:32768
ds_read_b64_tr_b16 v[48:49], v226 offset:49152
v_mfma_f32_16x16x32_bf16 v[136:139], v[112:115], v[100:103], v[136:139]
ds_read_b64_tr_b16 v[50:51], v226 offset:51200
ds_read_b64_tr_b16 v[52:53], v227 offset:49152
v_mfma_f32_16x16x32_bf16 v[144:147], v[112:115], v[104:107], v[144:147]
ds_read_b64_tr_b16 v[54:55], v227 offset:51200
ds_read_b128 v[36:39], v18 offset:33792
v_mfma_f32_16x16x32_bf16 v[152:155], v[112:115], v[108:111], v[152:155]
ds_read_b128 v[40:43], v18 offset:34816
ds_read_b128 v[44:47], v18 offset:35840
v_mfma_f32_16x16x32_bf16 v[156:159], v[116:119], v[108:111], v[156:159]
ds_read_b128 v[64:67], v18 offset:40960
v_mfma_f32_16x16x32_bf16 v[148:151], v[116:119], v[104:107], v[148:151]
ds_read_b64_tr_b16 v[80:81], v226 offset:53248
v_mfma_f32_16x16x32_bf16 v[140:143], v[116:119], v[100:103], v[140:143]
ds_read_b64_tr_b16 v[82:83], v226 offset:55296
v_mfma_f32_16x16x32_bf16 v[132:135], v[116:119], v[96:99], v[132:135]
ds_read_b64_tr_b16 v[84:85], v227 offset:53248
v_mfma_f32_16x16x32_bf16 v[128:131], v[208:211], v[192:195], v[128:131]
ds_read_b64_tr_b16 v[86:87], v227 offset:55296
v_mfma_f32_16x16x32_bf16 v[136:139], v[208:211], v[196:199], v[136:139]
ds_read_b128 v[68:71], v18 offset:41984
v_mfma_f32_16x16x32_bf16 v[144:147], v[208:211], v[200:203], v[144:147]
ds_read_b128 v[72:75], v18 offset:43008
v_mfma_f32_16x16x32_bf16 v[152:155], v[208:211], v[204:207], v[152:155]
ds_read_b128 v[76:79], v18 offset:44032
v_mfma_f32_16x16x32_bf16 v[156:159], v[212:215], v[204:207], v[156:159]
v_mfma_f32_16x16x32_bf16 v[148:151], v[212:215], v[200:203], v[148:151]
v_mfma_f32_16x16x32_bf16 v[140:143], v[212:215], v[196:199], v[140:143]
v_mfma_f32_16x16x32_bf16 v[132:135], v[212:215], v[192:195], v[132:135]
s_waitcnt lgkmcnt(0)
s_barrier
buffer_load_dwordx4 v[232:235], v2, s[84:87], s46 offen offset:0 sc1
buffer_load_dwordx4 v[236:239], v2, s[84:87], s46 offen offset:1024 sc1
buffer_load_dwordx4 v[240:243], v2, s[84:87], s46 offen offset:2048 sc1
buffer_load_dwordx4 v[244:247], v2, s[84:87], s46 offen offset:3072 sc1
v_mfma_f32_16x16x32_bf16 v[128:131], v[48:51], v[32:35], v[128:131]
ds_read_b128 v[96:99], v19 offset:0
ds_read_b64_tr_b16 v[112:113], v224 offset:0
v_mfma_f32_16x16x32_bf16 v[136:139], v[48:51], v[36:39], v[136:139]
ds_read_b64_tr_b16 v[114:115], v224 offset:2048
ds_read_b64_tr_b16 v[116:117], v225 offset:0
v_mfma_f32_16x16x32_bf16 v[144:147], v[48:51], v[40:43], v[144:147]
ds_read_b64_tr_b16 v[118:119], v225 offset:2048
ds_read_b128 v[100:103], v19 offset:1024
v_mfma_f32_16x16x32_bf16 v[152:155], v[48:51], v[44:47], v[152:155]
ds_read_b128 v[104:107], v19 offset:2048
ds_read_b128 v[108:111], v19 offset:3072
v_mfma_f32_16x16x32_bf16 v[156:159], v[52:55], v[44:47], v[156:159]
ds_read_b128 v[192:195], v19 offset:8192
v_mfma_f32_16x16x32_bf16 v[148:151], v[52:55], v[40:43], v[148:151]
ds_read_b64_tr_b16 v[208:209], v224 offset:4096
v_mfma_f32_16x16x32_bf16 v[140:143], v[52:55], v[36:39], v[140:143]
ds_read_b64_tr_b16 v[210:211], v224 offset:6144
v_mfma_f32_16x16x32_bf16 v[132:135], v[52:55], v[32:35], v[132:135]
ds_read_b64_tr_b16 v[212:213], v225 offset:4096
v_mfma_f32_16x16x32_bf16 v[128:131], v[80:83], v[64:67], v[128:131]
ds_read_b64_tr_b16 v[214:215], v225 offset:6144
v_mfma_f32_16x16x32_bf16 v[136:139], v[80:83], v[68:71], v[136:139]
ds_read_b128 v[196:199], v19 offset:9216
v_mfma_f32_16x16x32_bf16 v[144:147], v[80:83], v[72:75], v[144:147]
ds_read_b128 v[200:203], v19 offset:10240
v_mfma_f32_16x16x32_bf16 v[152:155], v[80:83], v[76:79], v[152:155]
ds_read_b128 v[204:207], v19 offset:11264
v_mfma_f32_16x16x32_bf16 v[156:159], v[84:87], v[76:79], v[156:159]
v_mfma_f32_16x16x32_bf16 v[148:151], v[84:87], v[72:75], v[148:151]
v_mfma_f32_16x16x32_bf16 v[140:143], v[84:87], v[68:71], v[140:143]
v_mfma_f32_16x16x32_bf16 v[132:135], v[84:87], v[64:67], v[132:135]
s_waitcnt lgkmcnt(0)
s_barrier
v_mfma_f32_16x16x32_bf16 v[128:131], v[112:115], v[96:99], v[128:131]
ds_read_b128 v[32:35], v17 offset:16384
ds_read_b64_tr_b16 v[48:49], v224 offset:32768
v_mfma_f32_16x16x32_bf16 v[136:139], v[112:115], v[100:103], v[136:139]
ds_read_b64_tr_b16 v[50:51], v224 offset:34816
ds_read_b64_tr_b16 v[52:53], v225 offset:32768
v_mfma_f32_16x16x32_bf16 v[144:147], v[112:115], v[104:107], v[144:147]
ds_read_b64_tr_b16 v[54:55], v225 offset:34816
ds_read_b128 v[36:39], v17 offset:17408
v_mfma_f32_16x16x32_bf16 v[152:155], v[112:115], v[108:111], v[152:155]
ds_read_b128 v[40:43], v17 offset:18432
ds_read_b128 v[44:47], v17 offset:19456
v_mfma_f32_16x16x32_bf16 v[156:159], v[116:119], v[108:111], v[156:159]
ds_read_b128 v[64:67], v17 offset:24576
v_mfma_f32_16x16x32_bf16 v[148:151], v[116:119], v[104:107], v[148:151]
ds_read_b64_tr_b16 v[80:81], v224 offset:36864
v_mfma_f32_16x16x32_bf16 v[140:143], v[116:119], v[100:103], v[140:143]
ds_read_b64_tr_b16 v[82:83], v224 offset:38912
v_mfma_f32_16x16x32_bf16 v[132:135], v[116:119], v[96:99], v[132:135]
ds_read_b64_tr_b16 v[84:85], v225 offset:36864
v_mfma_f32_16x16x32_bf16 v[128:131], v[208:211], v[192:195], v[128:131]
ds_read_b64_tr_b16 v[86:87], v225 offset:38912
v_mfma_f32_16x16x32_bf16 v[136:139], v[208:211], v[196:199], v[136:139]
ds_read_b128 v[68:71], v17 offset:25600
v_mfma_f32_16x16x32_bf16 v[144:147], v[208:211], v[200:203], v[144:147]
ds_read_b128 v[72:75], v17 offset:26624
v_mfma_f32_16x16x32_bf16 v[152:155], v[208:211], v[204:207], v[152:155]
ds_read_b128 v[76:79], v17 offset:27648
v_mfma_f32_16x16x32_bf16 v[156:159], v[212:215], v[204:207], v[156:159]
v_mfma_f32_16x16x32_bf16 v[148:151], v[212:215], v[200:203], v[148:151]
v_mfma_f32_16x16x32_bf16 v[140:143], v[212:215], v[196:199], v[140:143]
v_mfma_f32_16x16x32_bf16 v[132:135], v[212:215], v[192:195], v[132:135]
s_waitcnt lgkmcnt(0)
s_barrier
v_mfma_f32_16x16x32_bf16 v[128:131], v[48:51], v[32:35], v[128:131]
ds_read_b128 v[96:99], v17 offset:49152
ds_read_b64_tr_b16 v[112:113], v226 offset:0
v_mfma_f32_16x16x32_bf16 v[136:139], v[48:51], v[36:39], v[136:139]
ds_read_b64_tr_b16 v[114:115], v226 offset:2048
ds_read_b64_tr_b16 v[116:117], v227 offset:0
v_mfma_f32_16x16x32_bf16 v[144:147], v[48:51], v[40:43], v[144:147]
ds_read_b64_tr_b16 v[118:119], v227 offset:2048
ds_read_b128 v[100:103], v17 offset:50176
v_mfma_f32_16x16x32_bf16 v[152:155], v[48:51], v[44:47], v[152:155]
ds_read_b128 v[104:107], v17 offset:51200
ds_read_b128 v[108:111], v17 offset:52224
v_mfma_f32_16x16x32_bf16 v[156:159], v[52:55], v[44:47], v[156:159]
ds_read_b128 v[192:195], v17 offset:57344
v_mfma_f32_16x16x32_bf16 v[148:151], v[52:55], v[40:43], v[148:151]
ds_read_b64_tr_b16 v[208:209], v226 offset:4096
v_mfma_f32_16x16x32_bf16 v[140:143], v[52:55], v[36:39], v[140:143]
ds_read_b64_tr_b16 v[210:211], v226 offset:6144
v_mfma_f32_16x16x32_bf16 v[132:135], v[52:55], v[32:35], v[132:135]
ds_read_b64_tr_b16 v[212:213], v227 offset:4096
v_mfma_f32_16x16x32_bf16 v[128:131], v[80:83], v[64:67], v[128:131]
ds_read_b64_tr_b16 v[214:215], v227 offset:6144
v_mfma_f32_16x16x32_bf16 v[136:139], v[80:83], v[68:71], v[136:139]
ds_read_b128 v[196:199], v17 offset:58368
v_mfma_f32_16x16x32_bf16 v[144:147], v[80:83], v[72:75], v[144:147]
ds_read_b128 v[200:203], v17 offset:59392
v_mfma_f32_16x16x32_bf16 v[152:155], v[80:83], v[76:79], v[152:155]
ds_read_b128 v[204:207], v17 offset:60416
v_mfma_f32_16x16x32_bf16 v[156:159], v[84:87], v[76:79], v[156:159]
v_mfma_f32_16x16x32_bf16 v[148:151], v[84:87], v[72:75], v[148:151]
v_mfma_f32_16x16x32_bf16 v[140:143], v[84:87], v[68:71], v[140:143]
v_mfma_f32_16x16x32_bf16 v[132:135], v[84:87], v[64:67], v[132:135]
s_waitcnt vmcnt(0)
s_waitcnt lgkmcnt(0)
s_barrier
v_mfma_f32_16x16x32_bf16 v[128:131], v[112:115], v[96:99], v[128:131]
v_lshlrev_b32 v160, 16, v232
v_and_b32 v161, 0xffff0000, v232
v_lshlrev_b32 v162, 16, v233
v_and_b32 v163, 0xffff0000, v233
v_mfma_f32_16x16x32_bf16 v[132:135], v[116:119], v[96:99], v[132:135]
v_lshlrev_b32 v164, 16, v234
v_and_b32 v165, 0xffff0000, v234
v_lshlrev_b32 v166, 16, v235
v_and_b32 v167, 0xffff0000, v235
v_mfma_f32_16x16x32_bf16 v[128:131], v[208:211], v[192:195], v[128:131]
v_lshlrev_b32 v168, 16, v236
v_and_b32 v169, 0xffff0000, v236
v_lshlrev_b32 v170, 16, v237
v_and_b32 v171, 0xffff0000, v237
v_mfma_f32_16x16x32_bf16 v[132:135], v[212:215], v[192:195], v[132:135]
v_lshlrev_b32 v172, 16, v238
v_and_b32 v173, 0xffff0000, v238
v_lshlrev_b32 v174, 16, v239
v_and_b32 v175, 0xffff0000, v239
v_mfma_f32_16x16x32_bf16 v[136:139], v[112:115], v[100:103], v[136:139]
v_lshlrev_b32 v176, 16, v240
v_and_b32 v177, 0xffff0000, v240
v_lshlrev_b32 v178, 16, v241
v_and_b32 v179, 0xffff0000, v241
v_mfma_f32_16x16x32_bf16 v[140:143], v[116:119], v[100:103], v[140:143]
v_lshlrev_b32 v180, 16, v242
v_and_b32 v181, 0xffff0000, v242
v_lshlrev_b32 v182, 16, v243
v_and_b32 v183, 0xffff0000, v243
v_mfma_f32_16x16x32_bf16 v[136:139], v[208:211], v[196:199], v[136:139]
v_lshlrev_b32 v184, 16, v244
v_and_b32 v185, 0xffff0000, v244
v_lshlrev_b32 v186, 16, v245
v_and_b32 v187, 0xffff0000, v245
v_mfma_f32_16x16x32_bf16 v[140:143], v[212:215], v[196:199], v[140:143]
v_lshlrev_b32 v188, 16, v246
v_and_b32 v189, 0xffff0000, v246
v_lshlrev_b32 v190, 16, v247
v_and_b32 v191, 0xffff0000, v247
v_mfma_f32_16x16x32_bf16 v[144:147], v[112:115], v[104:107], v[144:147]
v_add_f32 v128, v128, v160
v_add_f32 v129, v129, v161
v_add_f32 v130, v130, v162
v_mfma_f32_16x16x32_bf16 v[148:151], v[116:119], v[104:107], v[148:151]
v_add_f32 v131, v131, v163
v_add_f32 v132, v132, v164
v_add_f32 v133, v133, v165
v_mfma_f32_16x16x32_bf16 v[144:147], v[208:211], v[200:203], v[144:147]
v_add_f32 v134, v134, v166
v_add_f32 v135, v135, v167
v_cvt_pk_bf16_f32 v232, v128, v129
v_mfma_f32_16x16x32_bf16 v[148:151], v[212:215], v[200:203], v[148:151]
v_cvt_pk_bf16_f32 v233, v130, v131
v_cvt_pk_bf16_f32 v234, v132, v133
v_cvt_pk_bf16_f32 v235, v134, v135
v_mfma_f32_16x16x32_bf16 v[152:155], v[112:115], v[108:111], v[152:155]
v_add_f32 v136, v136, v168
v_add_f32 v137, v137, v169
v_add_f32 v138, v138, v170
v_mfma_f32_16x16x32_bf16 v[156:159], v[116:119], v[108:111], v[156:159]
v_add_f32 v139, v139, v171
v_add_f32 v140, v140, v172
v_add_f32 v141, v141, v173
v_add_f32 v142, v142, v174
v_mfma_f32_16x16x32_bf16 v[152:155], v[208:211], v[204:207], v[152:155]
v_add_f32 v143, v143, v175
v_cvt_pk_bf16_f32 v236, v136, v137
v_cvt_pk_bf16_f32 v237, v138, v139
v_cvt_pk_bf16_f32 v238, v140, v141
v_mfma_f32_16x16x32_bf16 v[156:159], v[212:215], v[204:207], v[156:159]
v_cvt_pk_bf16_f32 v239, v142, v143
v_permlane16_swap_b32 v232, v234
v_permlane16_swap_b32 v233, v235
buffer_store_dwordx4 v[232:235], v230, s[20:23], s54 offen offset:0 nt
v_permlane16_swap_b32 v236, v238
v_permlane16_swap_b32 v237, v239
buffer_store_dwordx4 v[236:239], v230, s[20:23], s54 offen offset:2048 nt
v_add_f32 v144, v144, v176
v_add_f32 v145, v145, v177
v_add_f32 v146, v146, v178
v_add_f32 v147, v147, v179
v_add_f32 v148, v148, v180
v_add_f32 v149, v149, v181
v_add_f32 v150, v150, v182
v_add_f32 v151, v151, v183
v_cvt_pk_bf16_f32 v240, v144, v145
s_branch Lov_13
.p2align 12
.fill 96, 4, 0xbf800000
Lst_13_0:
s_branch Lwr_173
Lst_13_1:
s_branch Lst_17_0
s_nop 0
Lov_13:
v_cvt_pk_bf16_f32 v241, v146, v147
v_cvt_pk_bf16_f32 v242, v148, v149
v_cvt_pk_bf16_f32 v243, v150, v151
s_nop 0
v_add_f32 v152, v152, v184
v_add_f32 v153, v153, v185
v_add_f32 v154, v154, v186
v_add_f32 v155, v155, v187
v_add_f32 v156, v156, v188
v_add_f32 v157, v157, v189
v_add_f32 v158, v158, v190
v_add_f32 v159, v159, v191
v_cvt_pk_bf16_f32 v244, v152, v153
v_cvt_pk_bf16_f32 v245, v154, v155
v_cvt_pk_bf16_f32 v246, v156, v157
v_cvt_pk_bf16_f32 v247, v158, v159
v_permlane16_swap_b32 v240, v242
v_permlane16_swap_b32 v241, v243
buffer_store_dwordx4 v[240:243], v230, s[20:23], s55 offen offset:0 nt
v_permlane16_swap_b32 v244, v246
v_permlane16_swap_b32 v245, v247
buffer_store_dwordx4 v[244:247], v230, s[20:23], s55 offen offset:2048 nt
s_branch Ldone_1
Lgb_112:
s_mul_i32 s43, s34, 262144
s_add_u32 s8, s82, s43
s_addc_u32 s9, s83, 0
s_add_u32 s8, s8, 4194304
s_addc_u32 s9, s9, 0
s_mov_b32 s10, 262144
s_mov_b32 s11, 0x20000
s_lshl_b32 s39, s36, 12
v_lshlrev_b32 v2, 4, v1
v_add_u32 v3, s39, v2
s_add_u32 s37, s35, 0
s_and_b32 s37, s37, 15
s_mul_i32 s37, s37, 16384
s_add_u32 m0, s39, 0
s_nop 0
buffer_load_dwordx4 v3, s[8:11], s37 offen sc1 lds
buffer_load_dwordx4 v3, s[8:11], s37 offen offset:1024 sc1 lds
buffer_load_dwordx4 v3, s[8:11], s37 offen offset:2048 sc1 lds
buffer_load_dwordx4 v3, s[8:11], s37 offen offset:3072 sc1 lds
s_mul_i32 s43, s34, 262144
s_add_u32 s8, s82, s43
s_addc_u32 s9, s83, 0
s_add_u32 s8, s8, 4194304
s_addc_u32 s9, s9, 0
s_mov_b32 s10, 262144
s_mov_b32 s11, 0x20000
s_mul_i32 s43, s34, 917504
s_add_u32 s24, s82, s43
s_addc_u32 s25, s83, 0
s_add_u32 s24, s24, 8388608
s_addc_u32 s25, s25, 0
s_mov_b32 s26, 917504
s_mov_b32 s27, 0x20000
s_add_u32 s84, s82, 27262976
s_addc_u32 s85, s83, 0
s_mov_b32 s86, 229376
s_mov_b32 s87, 0x20000
s_and_b32 s47, s36, 3
s_lshr_b32 s62, s47, 1
s_and_b32 s63, s47, 1
v_lshlrev_b32 v2, 4, v1
s_lshl_b32 s39, s47, 12
v_add_u32 v3, s39, v2
s_bitcmp0_b32 s36, 1
s_cselect_b32 s44, s72, s74
s_cselect_b32 s45, s73, s75
s_mul_i32 s43, s35, 256
s_add_u32 s12, s44, s43
s_addc_u32 s13, s45, 0
s_mov_b32 s14, 7333120
s_mov_b32 s15, 0x20000
s_and_b32 s43, s36, 1
s_mul_i32 s43, s43, 229376
v_lshrrev_b32 v28, 4, v1
v_lshlrev_b32 v29, 1, v28
v_and_b32 v4, 15, v1
v_xor_b32 v4, v4, v29
v_lshlrev_b32 v4, 4, v4
v_mul_u32_u24 v28, 7168, v28
v_add_u32 v4, v4, v28
v_add_u32 v4, s43, v4
v_xor_b32 v5, 128, v4
v_add_u32 v5, 28672, v5
s_and_b32 s43, s36, 3
s_mul_i32 s40, s43, 8192
s_add_u32 s40, s40, 16384
v_mov_b32 v6, v192
v_mov_b32 v7, v193
v_mov_b32 v8, v194
s_lshl_b32 s43, s62, 12
v_add_u32 v9, s43, v2
v_add_u32 v10, 98304, v9
v_mov_b32 v24, v195
s_mul_i32 s43, s34, 16384
s_add_u32 s20, s82, s43
s_addc_u32 s21, s83, 0
s_add_u32 s20, s20, 25165824
s_addc_u32 s21, s21, 0
s_mov_b32 s22, 16384
s_mov_b32 s23, 0x20000
s_add_u32 s38, s35, 2
s_and_b32 s38, s38, 15
s_mul_i32 s38, s38, 458752
s_add_u32 m0, s50, 98304
s_nop 0
buffer_load_dwordx4 v6, s[16:19], s38 offen lds
s_add_u32 m0, s50, 99328
s_nop 0
buffer_load_dwordx4 v7, s[16:19], s38 offen lds
s_add_u32 m0, s50, 100352
s_nop 0
buffer_load_dwordx4 v8, s[16:19], s38 offen lds
s_add_u32 m0, s50, 101376
s_add_u32 s38, s38, 114688
buffer_load_dwordx4 v6, s[16:19], s38 offen lds
s_add_u32 m0, s50, 102400
s_nop 0
buffer_load_dwordx4 v7, s[16:19], s38 offen lds
s_add_u32 m0, s50, 103424
s_nop 0
buffer_load_dwordx4 v8, s[16:19], s38 offen lds
s_cmp_eq_u32 s47, 1
s_cbranch_scc0 Lw_137
s_lshl_b32 s92, s34, 4
s_add_u32 s92, s92, s35
s_lshl_b32 s92, s92, 8
s_add_u32 s92, s92, 49280
s_add_u32 s92, s92, 28311552
s_mov_b32 s41, 0x40000
Lpoll_138:
s_load_dword s93, s[82:83], s92 glc
Lpchk_140:
s_waitcnt lgkmcnt(0)
s_cmp_eq_u32 s93, 16
s_cbranch_scc1 Lpok_139
s_sub_u32 s41, s41, 1
s_cmp_lg_u32 s41, 0
s_cbranch_scc1 Lpoll_138
Lpok_139:
Lw_137:
s_waitcnt vmcnt(0)
s_barrier
s_add_u32 s37, s35, 1
s_and_b32 s37, s37, 15
s_mul_i32 s37, s37, 16384
s_add_u32 m0, s39, 49152
s_nop 0
buffer_load_dwordx4 v3, s[8:11], s37 offen sc1 lds
buffer_load_dwordx4 v3, s[8:11], s37 offen offset:1024 sc1 lds
buffer_load_dwordx4 v3, s[8:11], s37 offen offset:2048 sc1 lds
buffer_load_dwordx4 v3, s[8:11], s37 offen offset:3072 sc1 lds
s_add_u32 s37, s35, 2
s_and_b32 s37, s37, 15
s_mul_i32 s37, s37, 16384
s_add_u32 m0, s39, 98304
s_nop 0
buffer_load_dwordx4 v3, s[8:11], s37 offen sc1 lds
buffer_load_dwordx4 v3, s[8:11], s37 offen offset:1024 sc1 lds
buffer_load_dwordx4 v3, s[8:11], s37 offen offset:2048 sc1 lds
buffer_load_dwordx4 v3, s[8:11], s37 offen offset:3072 sc1 lds
buffer_load_dwordx4 v[96:99], v3, s[20:23], 0 offen offset:0 sc1
buffer_load_dwordx4 v[100:103], v3, s[20:23], 0 offen offset:1024 sc1
buffer_load_dwordx4 v[104:107], v3, s[20:23], 0 offen offset:2048 sc1
buffer_load_dwordx4 v[108:111], v3, s[20:23], 0 offen offset:3072 sc1
s_and_b32 s44, s36, 3
s_mul_i32 s44, s44, 11
s_bfe_u32 s43, s2, 0x30001
s_lshl_b32 s43, s43, 7
s_add_u32 s44, s44, s43
s_add_u32 s44, s44, 84
s_mul_i32 s44, s44, 7168
s_lshr_b32 s43, s2, 4
s_lshl_b32 s43, s43, 8
s_add_u32 s43, s43, s44
s_bitcmp0_b32 s2, 0
s_cselect_b32 s4, s72, s74
s_cselect_b32 s5, s73, s75
s_add_u32 s4, s4, s43
s_addc_u32 s5, s5, 0
s_waitcnt vmcnt(8)
s_barrier
s_cmp_eq_u32 s47, 3
s_cbranch_scc0 Lw_141
v_and_b32 v90, 31, v1
v_lshlrev_b32 v90, 4, v90
v_add_u32 v91, 151552, v90
ds_read_b128 v[112:115], v91 offset:0
ds_read_b128 v[116:119], v91 offset:512
ds_read_b128 v[120:123], v91 offset:1024
ds_read_b128 v[124:127], v91 offset:1536
s_and_b32 s44, s2, 15
s_mul_i32 s44, s44, 14336
s_lshr_b32 s43, s2, 4
s_lshl_b32 s43, s43, 9
s_add_u32 s44, s44, s43
s_add_u32 s44, s44, 8192
s_cmp_lt_u32 s2, 192
s_cselect_b32 s44, s44, 0x7fffffff
s_waitcnt lgkmcnt(0)
v_add_f32 v112, v112, v116
v_add_f32 v120, v120, v124
v_add_f32 v113, v113, v117
v_add_f32 v121, v121, v125
v_add_f32 v114, v114, v118
v_add_f32 v122, v122, v126
v_add_f32 v115, v115, v119
v_add_f32 v123, v123, v127
v_add_f32 v112, v112, v120
v_add_f32 v113, v113, v121
v_add_f32 v114, v114, v122
v_add_f32 v115, v115, v123
s_mov_b64 exec, 0xffffffff
buffer_store_dwordx4 v[112:115], v90, s[84:87], s44 offen sc1
s_mov_b64 exec, -1
Lw_141:
s_add_u32 s37, s35, 3
s_and_b32 s37, s37, 15
s_mul_i32 s37, s37, 16384
s_add_u32 m0, s39, 0
s_nop 0
buffer_load_dwordx4 v3, s[8:11], s37 offen sc1 lds
s_load_dword s3, s[4:5], 0
buffer_load_dwordx4 v3, s[8:11], s37 offen offset:1024 sc1 lds
s_load_dword s3, s[4:5], 64
buffer_load_dwordx4 v3, s[8:11], s37 offen offset:2048 sc1 lds
s_load_dword s3, s[4:5], 128
buffer_load_dwordx4 v3, s[8:11], s37 offen offset:3072 sc1 lds
s_load_dword s3, s[4:5], 192
s_load_dword s3, s[4:5], 7168
s_add_u32 s38, s35, 3
s_and_b32 s38, s38, 15
s_mul_i32 s38, s38, 458752
s_add_u32 m0, s50, 0
s_nop 0
buffer_load_dwordx4 v6, s[16:19], s38 offen lds
s_load_dword s3, s[4:5], 7232
s_add_u32 m0, s50, 1024
s_nop 0
buffer_load_dwordx4 v7, s[16:19], s38 offen lds
s_load_dword s3, s[4:5], 7296
s_add_u32 m0, s50, 2048
s_nop 0
buffer_load_dwordx4 v8, s[16:19], s38 offen lds
s_load_dword s3, s[4:5], 7360
s_add_u32 m0, s50, 3072
s_add_u32 s38, s38, 114688
buffer_load_dwordx4 v6, s[16:19], s38 offen lds
s_load_dword s3, s[4:5], 14336
s_load_dword s3, s[4:5], 14400
s_add_u32 m0, s50, 4096
s_nop 0
buffer_load_dwordx4 v7, s[16:19], s38 offen lds
s_add_u32 m0, s50, 5120
s_nop 0
buffer_load_dwordx4 v8, s[16:19], s38 offen lds
s_waitcnt vmcnt(14)
s_barrier
s_add_u32 s37, s35, 4
s_and_b32 s37, s37, 15
s_mul_i32 s37, s37, 16384
s_add_u32 m0, s39, 49152
s_nop 0
buffer_load_dwordx4 v3, s[8:11], s37 offen sc1 lds
s_load_dword s3, s[4:5], 14464
buffer_load_dwordx4 v3, s[8:11], s37 offen offset:1024 sc1 lds
s_load_dword s3, s[4:5], 14528
buffer_load_dwordx4 v3, s[8:11], s37 offen offset:2048 sc1 lds
s_load_dword s3, s[4:5], 21504
buffer_load_dwordx4 v3, s[8:11], s37 offen offset:3072 sc1 lds
s_load_dword s3, s[4:5], 21568
s_load_dword s3, s[4:5], 21632
s_add_u32 s38, s35, 4
s_and_b32 s38, s38, 15
s_mul_i32 s38, s38, 458752
s_add_u32 m0, s50, 49152
s_nop 0
buffer_load_dwordx4 v6, s[16:19], s38 offen lds
s_load_dword s3, s[4:5], 21696
s_add_u32 m0, s50, 50176
s_nop 0
buffer_load_dwordx4 v7, s[16:19], s38 offen lds
s_load_dword s3, s[4:5], 28672
s_add_u32 m0, s50, 51200
s_nop 0
buffer_load_dwordx4 v8, s[16:19], s38 offen lds
s_load_dword s3, s[4:5], 28736
s_add_u32 m0, s50, 52224
s_add_u32 s38, s38, 114688
buffer_load_dwordx4 v6, s[16:19], s38 offen lds
s_load_dword s3, s[4:5], 28800
s_load_dword s3, s[4:5], 28864
s_add_u32 m0, s50, 53248
s_nop 0
buffer_load_dwordx4 v7, s[16:19], s38 offen lds
s_add_u32 m0, s50, 54272
s_nop 0
buffer_load_dwordx4 v8, s[16:19], s38 offen lds
s_waitcnt vmcnt(10)
s_barrier
s_cmp_eq_u32 s47, 3
s_cbranch_scc0 Lw_142
s_cmp_lt_u32 s2, 192
s_cbranch_scc0 Lw_142
s_lshr_b32 s43, s2, 4
s_add_u32 s43, s43, 96
s_lshl_b32 s43, s43, 7
v_mov_b32 v90, s43
v_mov_b32 v91, 1
s_mov_b64 exec, 1
buffer_atomic_add v91, v90, s[56:59], 0 offen sc1
s_mov_b64 exec, -1
Lw_142:
s_add_u32 s37, s35, 5
s_and_b32 s37, s37, 15
s_mul_i32 s37, s37, 16384
s_add_u32 m0, s39, 98304
s_nop 0
buffer_load_dwordx4 v3, s[8:11], s37 offen sc1 lds
v_add_f32 v96, v96, v100
v_add_f32 v97, v97, v101
v_add_f32 v98, v98, v102
buffer_load_dwordx4 v3, s[8:11], s37 offen offset:1024 sc1 lds
v_add_f32 v99, v99, v103
v_add_f32 v104, v104, v108
v_add_f32 v105, v105, v109
buffer_load_dwordx4 v3, s[8:11], s37 offen offset:2048 sc1 lds
v_add_f32 v106, v106, v110
v_add_f32 v107, v107, v111
s_nop 0
buffer_load_dwordx4 v3, s[8:11], s37 offen offset:3072 sc1 lds
v_permlane32_swap_b32 v96, v104
v_permlane32_swap_b32 v97, v105
v_permlane32_swap_b32 v98, v106
v_permlane32_swap_b32 v99, v107
s_add_u32 s38, s35, 5
s_and_b32 s38, s38, 15
s_mul_i32 s38, s38, 458752
s_add_u32 m0, s50, 98304
s_nop 0
buffer_load_dwordx4 v6, s[16:19], s38 offen lds
v_add_f32 v96, v96, v104
v_add_f32 v97, v97, v105
v_add_f32 v98, v98, v106
s_add_u32 m0, s50, 99328
s_nop 0
buffer_load_dwordx4 v7, s[16:19], s38 offen lds
v_add_f32 v99, v99, v107
v_mov_b32 v100, v96
v_mov_b32 v101, v97
s_add_u32 m0, s50, 100352
s_nop 0
buffer_load_dwordx4 v8, s[16:19], s38 offen lds
v_mov_b32 v102, v98
v_mov_b32 v103, v99
s_nop 0
s_add_u32 m0, s50, 101376
s_add_u32 s38, s38, 114688
buffer_load_dwordx4 v6, s[16:19], s38 offen lds
v_permlane16_swap_b32 v96, v100
v_permlane16_swap_b32 v97, v101
v_permlane16_swap_b32 v98, v102
v_permlane16_swap_b32 v99, v103
s_add_u32 m0, s50, 102400
s_nop 0
buffer_load_dwordx4 v7, s[16:19], s38 offen lds
s_add_u32 m0, s50, 103424
s_nop 0
buffer_load_dwordx4 v8, s[16:19], s38 offen lds
s_waitcnt vmcnt(10)
s_barrier
s_add_u32 s37, s35, 6
s_and_b32 s37, s37, 15
s_mul_i32 s37, s37, 16384
s_add_u32 m0, s39, 0
s_nop 0
buffer_load_dwordx4 v3, s[8:11], s37 offen sc1 lds
v_add_f32 v96, v96, v100
v_add_f32 v97, v97, v101
v_add_f32 v98, v98, v102
buffer_load_dwordx4 v3, s[8:11], s37 offen offset:1024 sc1 lds
v_add_f32 v99, v99, v103
s_nop 0
v_add_f32_dpp v96, v96, v96 row_ror:8 row_mask:0xf bank_mask:0xf
buffer_load_dwordx4 v3, s[8:11], s37 offen offset:2048 sc1 lds
v_add_f32_dpp v97, v97, v97 row_ror:8 row_mask:0xf bank_mask:0xf
v_add_f32_dpp v98, v98, v98 row_ror:8 row_mask:0xf bank_mask:0xf
v_add_f32_dpp v99, v99, v99 row_ror:8 row_mask:0xf bank_mask:0xf
v_mul_f32 v96, 0x3a800000, v96
buffer_load_dwordx4 v3, s[8:11], s37 offen offset:3072 sc1 lds
v_mul_f32 v97, 0x3a800000, v97
v_mul_f32 v98, 0x3a800000, v98
v_mul_f32 v99, 0x3a800000, v99
s_add_u32 s38, s35, 6
s_and_b32 s38, s38, 15
s_mul_i32 s38, s38, 458752
s_add_u32 m0, s50, 0
s_nop 0
buffer_load_dwordx4 v6, s[16:19], s38 offen lds
v_fma_f32 v97, -v96, v96, v97
v_fma_f32 v99, -v98, v98, v99
v_max_f32 v97, 0, v97
s_add_u32 m0, s50, 1024
s_nop 0
buffer_load_dwordx4 v7, s[16:19], s38 offen lds
v_max_f32 v99, 0, v99
v_add_f32 v97, 0x3727c5ac, v97
v_add_f32 v99, 0x3727c5ac, v99
v_rsq_f32 v97, v97
s_add_u32 m0, s50, 2048
s_nop 0
buffer_load_dwordx4 v8, s[16:19], s38 offen lds
v_rsq_f32 v99, v99
v_and_b32 v100, 7, v1
s_lshl_b32 s43, s47, 8
s_add_u32 m0, s50, 3072
s_add_u32 s38, s38, 114688
buffer_load_dwordx4 v6, s[16:19], s38 offen lds
s_add_u32 s43, s43, 147456
v_lshl_add_u32 v100, v100, 4, s43
v_lshrrev_b32 v101, 5, v1
v_lshl_add_u32 v100, v101, 7, v100
s_add_u32 m0, s50, 4096
s_nop 0
buffer_load_dwordx4 v7, s[16:19], s38 offen lds
s_add_u32 m0, s50, 5120
s_nop 0
buffer_load_dwordx4 v8, s[16:19], s38 offen lds
s_waitcnt vmcnt(10)
s_barrier
ds_write_b128 v100, v[96:99]
s_waitcnt lgkmcnt(0)
s_add_u32 s37, s35, 7
s_and_b32 s37, s37, 15
s_mul_i32 s37, s37, 16384
s_add_u32 m0, s39, 49152
s_nop 0
buffer_load_dwordx4 v3, s[8:11], s37 offen sc1 lds
s_load_dword s3, s[4:5], 35840
buffer_load_dwordx4 v3, s[8:11], s37 offen offset:1024 sc1 lds
s_load_dword s3, s[4:5], 35904
buffer_load_dwordx4 v3, s[8:11], s37 offen offset:2048 sc1 lds
s_load_dword s3, s[4:5], 35968
s_load_dword s3, s[4:5], 36032
buffer_load_dwordx4 v3, s[8:11], s37 offen offset:3072 sc1 lds
s_load_dword s3, s[4:5], 43008
s_add_u32 s38, s35, 7
s_and_b32 s38, s38, 15
s_mul_i32 s38, s38, 458752
s_add_u32 m0, s50, 49152
s_nop 0
buffer_load_dwordx4 v6, s[16:19], s38 offen lds
s_load_dword s3, s[4:5], 43072
s_add_u32 m0, s50, 50176
s_nop 0
buffer_load_dwordx4 v7, s[16:19], s38 offen lds
s_load_dword s3, s[4:5], 43136
s_load_dword s3, s[4:5], 43200
s_add_u32 m0, s50, 51200
s_nop 0
buffer_load_dwordx4 v8, s[16:19], s38 offen lds
s_load_dword s3, s[4:5], 50176
s_add_u32 m0, s50, 52224
s_add_u32 s38, s38, 114688
buffer_load_dwordx4 v6, s[16:19], s38 offen lds
s_load_dword s3, s[4:5], 50240
s_load_dword s3, s[4:5], 50304
s_add_u32 m0, s50, 53248
s_nop 0
buffer_load_dwordx4 v7, s[16:19], s38 offen lds
s_add_u32 m0, s50, 54272
s_nop 0
buffer_load_dwordx4 v8, s[16:19], s38 offen lds
s_waitcnt vmcnt(10)
s_barrier
s_add_u32 s37, s35, 8
s_and_b32 s37, s37, 15
s_mul_i32 s37, s37, 16384
s_add_u32 m0, s39, 98304
s_nop 0
buffer_load_dwordx4 v3, s[8:11], s37 offen sc1 lds
s_load_dword s3, s[4:5], 50368
s_load_dword s3, s[4:5], 57344
s_load_dword s3, s[4:5], 57408
buffer_load_dwordx4 v3, s[8:11], s37 offen offset:1024 sc1 lds
s_load_dword s3, s[4:5], 57472
s_load_dword s3, s[4:5], 57536
s_load_dword s3, s[4:5], 64512
s_load_dword s3, s[4:5], 64576
buffer_load_dwordx4 v3, s[8:11], s37 offen offset:2048 sc1 lds
s_load_dword s3, s[4:5], 64640
s_load_dword s3, s[4:5], 64704
s_load_dword s3, s[4:5], 71680
s_load_dword s3, s[4:5], 71744
buffer_load_dwordx4 v3, s[8:11], s37 offen offset:3072 sc1 lds
v_lshrrev_b32 v28, 2, v1
v_and_b32 v29, 7, v28
v_mul_u32_u24 v28, 256, v28
v_lshl_add_u32 v28, v29, 5, v28
s_add_u32 s38, s35, 8
s_and_b32 s38, s38, 15
s_mul_i32 s38, s38, 458752
s_add_u32 m0, s50, 98304
s_nop 0
buffer_load_dwordx4 v6, s[16:19], s38 offen lds
v_and_b32 v29, 3, v1
v_lshl_add_u32 v11, v29, 3, v28
s_lshl_b32 s43, s63, 7
v_xor_b32 v11, s43, v11
s_add_u32 m0, s50, 99328
s_nop 0
buffer_load_dwordx4 v7, s[16:19], s38 offen lds
v_add_u32 v11, 16384, v11
v_xor_b32 v12, 32, v11
v_xor_b32 v13, 64, v11
v_xor_b32 v14, 96, v11
s_add_u32 m0, s50, 100352
s_nop 0
buffer_load_dwordx4 v8, s[16:19], s38 offen lds
v_add_u32 v15, 49152, v11
v_add_u32 v16, 49152, v12
v_add_u32 v17, 49152, v13
v_add_u32 v18, 49152, v14
s_add_u32 m0, s50, 101376
s_add_u32 s38, s38, 114688
buffer_load_dwordx4 v6, s[16:19], s38 offen lds
v_add_u32 v19, 98304, v11
v_add_u32 v20, 98304, v12
v_add_u32 v21, 98304, v13
v_add_u32 v22, 98304, v14
s_add_u32 m0, s50, 102400
s_nop 0
buffer_load_dwordx4 v7, s[16:19], s38 offen lds
s_add_u32 m0, s50, 103424
s_nop 0
buffer_load_dwordx4 v8, s[16:19], s38 offen lds
s_waitcnt vmcnt(10)
s_barrier
s_cmp_eq_u32 s47, 3
s_cbranch_scc0 Lw_143
s_mul_i32 s60, s35, 96
s_add_u32 s61, s60, 95
s_and_b32 s60, s60, 0xff80
s_and_b32 s61, s61, 0xff80
s_add_u32 s60, s60, 28323840
s_add_u32 s61, s61, 28323840
s_load_dword s92, s[82:83], s60 glc
s_load_dword s93, s[82:83], s61 glc
Lw_143:
s_add_u32 s37, s35, 9
s_and_b32 s37, s37, 15
s_mul_i32 s37, s37, 16384
s_add_u32 m0, s39, 0
s_nop 0
buffer_load_dwordx4 v3, s[8:11], s37 offen sc1 lds
buffer_load_dwordx4 v3, s[8:11], s37 offen offset:1024 sc1 lds
buffer_load_dwordx4 v3, s[8:11], s37 offen offset:2048 sc1 lds
buffer_load_dwordx4 v3, s[8:11], s37 offen offset:3072 sc1 lds
s_add_u32 s38, s35, 9
s_and_b32 s38, s38, 15
s_mul_i32 s38, s38, 458752
s_add_u32 m0, s50, 0
s_nop 0
buffer_load_dwordx4 v6, s[16:19], s38 offen lds
s_add_u32 m0, s50, 1024
s_nop 0
buffer_load_dwordx4 v7, s[16:19], s38 offen lds
s_add_u32 m0, s50, 2048
s_nop 0
buffer_load_dwordx4 v8, s[16:19], s38 offen lds
s_add_u32 m0, s50, 3072
s_add_u32 s38, s38, 114688
buffer_load_dwordx4 v6, s[16:19], s38 offen lds
s_add_u32 m0, s50, 4096
s_nop 0
buffer_load_dwordx4 v7, s[16:19], s38 offen lds
s_add_u32 m0, s50, 5120
s_nop 0
buffer_load_dwordx4 v8, s[16:19], s38 offen lds
s_waitcnt vmcnt(10)
s_barrier
s_add_u32 s37, s35, 10
s_and_b32 s37, s37, 15
s_mul_i32 s37, s37, 16384
s_add_u32 m0, s39, 49152
s_nop 0
buffer_load_dwordx4 v3, s[8:11], s37 offen sc1 lds
buffer_load_dwordx4 v3, s[8:11], s37 offen offset:1024 sc1 lds
buffer_load_dwordx4 v3, s[8:11], s37 offen offset:2048 sc1 lds
buffer_load_dwordx4 v3, s[8:11], s37 offen offset:3072 sc1 lds
s_add_u32 s38, s35, 10
s_and_b32 s38, s38, 15
s_mul_i32 s38, s38, 458752
s_add_u32 m0, s50, 49152
s_nop 0
buffer_load_dwordx4 v6, s[16:19], s38 offen lds
s_add_u32 m0, s50, 50176
s_nop 0
buffer_load_dwordx4 v7, s[16:19], s38 offen lds
s_add_u32 m0, s50, 51200
s_nop 0
buffer_load_dwordx4 v8, s[16:19], s38 offen lds
s_add_u32 m0, s50, 52224
s_add_u32 s38, s38, 114688
buffer_load_dwordx4 v6, s[16:19], s38 offen lds
s_branch Lov_14
.p2align 12
.fill 112, 4, 0xbf800000
Lst_14_0:
s_branch Lwr_174
Lst_14_1:
s_branch Lwr_186
s_nop 0
Lov_14:
s_add_u32 m0, s50, 53248
s_nop 0
buffer_load_dwordx4 v7, s[16:19], s38 offen lds
s_add_u32 m0, s50, 54272
s_nop 0
buffer_load_dwordx4 v8, s[16:19], s38 offen lds
s_mov_b32 s38, 0
buffer_load_dwordx4 v[40:43], v24, s[88:91], s38 offen
s_mov_b32 s38, 28672
buffer_load_dwordx4 v[44:47], v24, s[88:91], s38 offen
s_mov_b32 s38, 57344
buffer_load_dwordx4 v[48:51], v24, s[88:91], s38 offen
s_mov_b32 s38, 86016
buffer_load_dwordx4 v[52:55], v24, s[88:91], s38 offen
s_mov_b32 s38, 114688
buffer_load_dwordx4 v[56:59], v24, s[88:91], s38 offen
s_mov_b32 s38, 143360
buffer_load_dwordx4 v[60:63], v24, s[88:91], s38 offen
s_mov_b32 s38, 172032
buffer_load_dwordx4 v[64:67], v24, s[88:91], s38 offen
s_mov_b32 s38, 200704
buffer_load_dwordx4 v[68:71], v24, s[88:91], s38 offen
s_waitcnt vmcnt(18)
s_cmp_eq_u32 s47, 3
s_cbranch_scc0 Lw_144
s_mov_b32 s41, 0x40000
Lcp_145:
s_waitcnt lgkmcnt(0)
s_and_b32 s92, s92, s93
s_cmp_eq_u32 s92, 16
s_cbranch_scc1 Lco_146
s_load_dword s92, s[82:83], s60 glc
s_load_dword s93, s[82:83], s61 glc
s_sub_u32 s41, s41, 1
s_cmp_lg_u32 s41, 0
s_cbranch_scc1 Lcp_145
s_waitcnt lgkmcnt(0)
Lco_146:
Lw_144:
s_barrier
s_mov_b32 s45, s47
s_cmp_ge_u32 s45, 3
s_cselect_b32 s43, 1, 0
s_mul_i32 s44, s43, 3
s_sub_u32 s45, s45, s44
s_lshl_b32 s45, s45, 7
s_mul_i32 s52, s43, 896
s_add_u32 s52, s52, s45
s_add_u32 s52, s52, 148992
s_mul_i32 s43, s43, 14336
s_add_u32 s43, s43, s45
s_mul_i32 s44, s35, 384
s_add_u32 s43, s43, s44
s_add_u32 s60, s43, 8192
s_add_u32 s45, s47, 4
s_min_u32 s45, s45, 5
s_cmp_ge_u32 s45, 3
s_cselect_b32 s43, 1, 0
s_mul_i32 s44, s43, 3
s_sub_u32 s45, s45, s44
s_lshl_b32 s45, s45, 7
s_mul_i32 s53, s43, 896
s_add_u32 s53, s53, s45
s_add_u32 s53, s53, 148992
s_mul_i32 s43, s43, 14336
s_add_u32 s43, s43, s45
s_mul_i32 s44, s35, 384
s_add_u32 s43, s43, s44
s_add_u32 s61, s43, 8192
v_lshrrev_b32 v104, 3, v1
v_mul_u32_u24 v104, 28672, v104
v_and_b32 v105, 7, v1
v_lshl_add_u32 v104, v105, 4, v104
buffer_load_dwordx4 v[96:99], v104, s[84:87], s60 offen sc1
s_load_dword s3, s[4:5], 71808
s_load_dword s3, s[4:5], 71872
buffer_load_dwordx4 v[100:103], v104, s[84:87], s61 offen sc1
s_and_b32 s44, s36, 3
s_mul_i32 s43, s2, 28672
s_add_u32 s37, s35, 11
s_and_b32 s37, s37, 15
s_mul_i32 s37, s37, 16384
s_add_u32 m0, s39, 98304
s_nop 0
buffer_load_dwordx4 v3, s[8:11], s37 offen sc1 lds
s_mul_i32 s44, s44, 7168
s_add_u32 s43, s43, s44
buffer_load_dwordx4 v3, s[8:11], s37 offen offset:1024 sc1 lds
s_add_u32 s4, s76, s43
s_addc_u32 s5, s77, 0
s_load_dword s3, s[4:5], 0
buffer_load_dwordx4 v3, s[8:11], s37 offen offset:2048 sc1 lds
s_load_dword s3, s[4:5], 64
s_load_dword s3, s[4:5], 128
buffer_load_dwordx4 v3, s[8:11], s37 offen offset:3072 sc1 lds
s_load_dword s3, s[4:5], 192
s_load_dword s3, s[4:5], 256
s_add_u32 s38, s35, 11
s_and_b32 s38, s38, 15
s_mul_i32 s38, s38, 458752
s_add_u32 m0, s50, 98304
s_nop 0
buffer_load_dwordx4 v6, s[16:19], s38 offen lds
s_load_dword s3, s[4:5], 320
s_load_dword s3, s[4:5], 384
s_load_dword s3, s[4:5], 448
s_add_u32 m0, s50, 99328
s_nop 0
buffer_load_dwordx4 v7, s[16:19], s38 offen lds
v_cmp_gt_u32 vcc, 32, v1
v_mov_b32 v104, s52
s_add_u32 m0, s50, 100352
s_nop 0
buffer_load_dwordx4 v8, s[16:19], s38 offen lds
v_mov_b32 v106, s53
v_cndmask_b32 v104, v106, v104, vcc
s_add_u32 m0, s50, 101376
s_add_u32 s38, s38, 114688
buffer_load_dwordx4 v6, s[16:19], s38 offen lds
v_lshl_add_u32 v104, v105, 4, v104
v_bfe_u32 v105, v1, 4, 1
v_lshl_add_u32 v104, v105, 2, v104
s_add_u32 m0, s50, 102400
s_nop 0
buffer_load_dwordx4 v7, s[16:19], s38 offen lds
s_add_u32 m0, s50, 103424
s_nop 0
buffer_load_dwordx4 v8, s[16:19], s38 offen lds
s_waitcnt vmcnt(20)
s_barrier
s_add_u32 s37, s35, 12
s_and_b32 s37, s37, 15
s_mul_i32 s37, s37, 16384
s_add_u32 m0, s39, 0
s_nop 0
buffer_load_dwordx4 v3, s[8:11], s37 offen sc1 lds
buffer_load_dwordx4 v3, s[8:11], s37 offen offset:1024 sc1 lds
buffer_load_dwordx4 v3, s[8:11], s37 offen offset:2048 sc1 lds
buffer_load_dwordx4 v3, s[8:11], s37 offen offset:3072 sc1 lds
s_add_u32 s38, s35, 12
s_and_b32 s38, s38, 15
s_mul_i32 s38, s38, 458752
s_add_u32 m0, s50, 0
s_nop 0
buffer_load_dwordx4 v6, s[16:19], s38 offen lds
s_add_u32 m0, s50, 1024
s_nop 0
buffer_load_dwordx4 v7, s[16:19], s38 offen lds
s_add_u32 m0, s50, 2048
s_nop 0
buffer_load_dwordx4 v8, s[16:19], s38 offen lds
s_add_u32 m0, s50, 3072
s_add_u32 s38, s38, 114688
buffer_load_dwordx4 v6, s[16:19], s38 offen lds
s_add_u32 m0, s50, 4096
s_nop 0
buffer_load_dwordx4 v7, s[16:19], s38 offen lds
s_add_u32 m0, s50, 5120
s_nop 0
buffer_load_dwordx4 v8, s[16:19], s38 offen lds
s_waitcnt vmcnt(10)
s_barrier
v_permlane32_swap_b32 v96, v100
v_permlane32_swap_b32 v97, v101
v_permlane32_swap_b32 v98, v102
v_permlane32_swap_b32 v99, v103
v_add_f32 v96, v96, v100
v_add_f32 v97, v97, v101
v_add_f32 v98, v98, v102
v_add_f32 v99, v99, v103
s_nop 1
v_permlane16_swap_b32 v96, v97
v_permlane16_swap_b32 v98, v99
v_add_f32 v96, v96, v97
v_add_f32 v98, v98, v99
s_nop 1
v_add_f32_dpp v96, v96, v96 row_ror:8 row_mask:0xf bank_mask:0xf
v_add_f32_dpp v98, v98, v98 row_ror:8 row_mask:0xf bank_mask:0xf
ds_write_b32 v104, v96
ds_write_b32 v104, v98 offset:8
s_waitcnt lgkmcnt(0)
s_add_u32 s37, s35, 13
s_and_b32 s37, s37, 15
s_mul_i32 s37, s37, 16384
s_add_u32 m0, s39, 49152
s_nop 0
buffer_load_dwordx4 v3, s[8:11], s37 offen sc1 lds
s_load_dword s3, s[4:5], 512
s_load_dword s3, s[4:5], 576
s_load_dword s3, s[4:5], 640
s_load_dword s3, s[4:5], 704
s_load_dword s3, s[4:5], 768
buffer_load_dwordx4 v3, s[8:11], s37 offen offset:1024 sc1 lds
s_load_dword s3, s[4:5], 832
s_load_dword s3, s[4:5], 896
s_load_dword s3, s[4:5], 960
s_load_dword s3, s[4:5], 1024
s_load_dword s3, s[4:5], 1088
buffer_load_dwordx4 v3, s[8:11], s37 offen offset:2048 sc1 lds
v_lshlrev_b32 v72, 16, v40
v_and_b32 v73, 0xffff0000, v40
v_lshlrev_b32 v74, 16, v41
v_and_b32 v75, 0xffff0000, v41
v_lshlrev_b32 v76, 16, v42
v_and_b32 v77, 0xffff0000, v42
buffer_load_dwordx4 v3, s[8:11], s37 offen offset:3072 sc1 lds
v_lshlrev_b32 v78, 16, v43
v_and_b32 v79, 0xffff0000, v43
v_lshlrev_b32 v80, 16, v44
v_and_b32 v81, 0xffff0000, v44
v_lshlrev_b32 v82, 16, v45
s_add_u32 s38, s35, 13
s_and_b32 s38, s38, 15
s_mul_i32 s38, s38, 458752
s_add_u32 m0, s50, 49152
s_nop 0
buffer_load_dwordx4 v6, s[16:19], s38 offen lds
v_and_b32 v83, 0xffff0000, v45
v_lshlrev_b32 v84, 16, v46
v_and_b32 v85, 0xffff0000, v46
v_lshlrev_b32 v86, 16, v47
v_and_b32 v87, 0xffff0000, v47
s_add_u32 m0, s50, 50176
s_nop 0
buffer_load_dwordx4 v7, s[16:19], s38 offen lds
v_add_f32 v72, v72, v80
v_add_f32 v73, v73, v81
v_add_f32 v74, v74, v82
v_add_f32 v75, v75, v83
v_add_f32 v76, v76, v84
v_add_f32 v77, v77, v85
s_add_u32 m0, s50, 51200
s_nop 0
buffer_load_dwordx4 v8, s[16:19], s38 offen lds
v_add_f32 v78, v78, v86
v_add_f32 v79, v79, v87
v_lshlrev_b32 v80, 16, v48
v_and_b32 v81, 0xffff0000, v48
v_lshlrev_b32 v82, 16, v49
s_add_u32 m0, s50, 52224
s_add_u32 s38, s38, 114688
buffer_load_dwordx4 v6, s[16:19], s38 offen lds
v_and_b32 v83, 0xffff0000, v49
v_lshlrev_b32 v84, 16, v50
v_and_b32 v85, 0xffff0000, v50
v_lshlrev_b32 v86, 16, v51
v_and_b32 v87, 0xffff0000, v51
v_add_f32 v72, v72, v80
s_add_u32 m0, s50, 53248
s_nop 0
buffer_load_dwordx4 v7, s[16:19], s38 offen lds
s_add_u32 m0, s50, 54272
s_nop 0
buffer_load_dwordx4 v8, s[16:19], s38 offen lds
s_waitcnt vmcnt(10)
s_barrier
s_add_u32 s37, s35, 14
s_and_b32 s37, s37, 15
s_mul_i32 s37, s37, 16384
s_add_u32 m0, s39, 98304
s_nop 0
buffer_load_dwordx4 v3, s[8:11], s37 offen sc1 lds
s_load_dword s3, s[4:5], 1152
s_load_dword s3, s[4:5], 1216
s_load_dword s3, s[4:5], 1280
s_load_dword s3, s[4:5], 1344
s_load_dword s3, s[4:5], 1408
buffer_load_dwordx4 v3, s[8:11], s37 offen offset:1024 sc1 lds
s_load_dword s3, s[4:5], 1472
s_load_dword s3, s[4:5], 1536
s_load_dword s3, s[4:5], 1600
s_load_dword s3, s[4:5], 1664
s_load_dword s3, s[4:5], 1728
v_add_f32 v73, v73, v81
buffer_load_dwordx4 v3, s[8:11], s37 offen offset:2048 sc1 lds
v_add_f32 v74, v74, v82
v_add_f32 v75, v75, v83
v_add_f32 v76, v76, v84
v_add_f32 v77, v77, v85
v_add_f32 v78, v78, v86
buffer_load_dwordx4 v3, s[8:11], s37 offen offset:3072 sc1 lds
v_add_f32 v79, v79, v87
v_lshlrev_b32 v80, 16, v52
v_and_b32 v81, 0xffff0000, v52
v_lshlrev_b32 v82, 16, v53
v_and_b32 v83, 0xffff0000, v53
v_lshlrev_b32 v84, 16, v54
s_add_u32 s38, s35, 14
s_and_b32 s38, s38, 15
s_mul_i32 s38, s38, 458752
s_add_u32 m0, s50, 98304
s_nop 0
buffer_load_dwordx4 v6, s[16:19], s38 offen lds
v_and_b32 v85, 0xffff0000, v54
v_lshlrev_b32 v86, 16, v55
v_and_b32 v87, 0xffff0000, v55
v_add_f32 v72, v72, v80
v_add_f32 v73, v73, v81
s_add_u32 m0, s50, 99328
s_nop 0
buffer_load_dwordx4 v7, s[16:19], s38 offen lds
v_add_f32 v74, v74, v82
v_add_f32 v75, v75, v83
v_add_f32 v76, v76, v84
v_add_f32 v77, v77, v85
v_add_f32 v78, v78, v86
v_add_f32 v79, v79, v87
s_add_u32 m0, s50, 100352
s_nop 0
buffer_load_dwordx4 v8, s[16:19], s38 offen lds
v_lshlrev_b32 v80, 16, v56
v_and_b32 v81, 0xffff0000, v56
v_lshlrev_b32 v82, 16, v57
v_and_b32 v83, 0xffff0000, v57
v_lshlrev_b32 v84, 16, v58
s_add_u32 m0, s50, 101376
s_add_u32 s38, s38, 114688
buffer_load_dwordx4 v6, s[16:19], s38 offen lds
v_and_b32 v85, 0xffff0000, v58
v_lshlrev_b32 v86, 16, v59
v_and_b32 v87, 0xffff0000, v59
v_add_f32 v72, v72, v80
v_add_f32 v73, v73, v81
v_add_f32 v74, v74, v82
s_add_u32 m0, s50, 102400
s_nop 0
buffer_load_dwordx4 v7, s[16:19], s38 offen lds
s_add_u32 m0, s50, 103424
s_nop 0
buffer_load_dwordx4 v8, s[16:19], s38 offen lds
s_waitcnt vmcnt(10)
s_barrier
s_add_u32 s37, s35, 15
s_and_b32 s37, s37, 15
s_mul_i32 s37, s37, 16384
s_add_u32 m0, s39, 0
s_nop 0
buffer_load_dwordx4 v3, s[8:11], s37 offen sc1 lds
v_add_f32 v75, v75, v83
v_add_f32 v76, v76, v84
v_add_f32 v77, v77, v85
v_add_f32 v78, v78, v86
buffer_load_dwordx4 v3, s[8:11], s37 offen offset:1024 sc1 lds
v_add_f32 v79, v79, v87
v_lshlrev_b32 v80, 16, v60
v_and_b32 v81, 0xffff0000, v60
v_lshlrev_b32 v82, 16, v61
buffer_load_dwordx4 v3, s[8:11], s37 offen offset:2048 sc1 lds
v_and_b32 v83, 0xffff0000, v61
v_lshlrev_b32 v84, 16, v62
v_and_b32 v85, 0xffff0000, v62
v_lshlrev_b32 v86, 16, v63
buffer_load_dwordx4 v3, s[8:11], s37 offen offset:3072 sc1 lds
v_and_b32 v87, 0xffff0000, v63
v_add_f32 v72, v72, v80
v_add_f32 v73, v73, v81
v_add_f32 v74, v74, v82
s_add_u32 s38, s35, 15
s_and_b32 s38, s38, 15
s_mul_i32 s38, s38, 458752
s_add_u32 m0, s50, 0
s_nop 0
buffer_load_dwordx4 v6, s[16:19], s38 offen lds
v_add_f32 v75, v75, v83
v_add_f32 v76, v76, v84
v_add_f32 v77, v77, v85
v_add_f32 v78, v78, v86
s_add_u32 m0, s50, 1024
s_nop 0
buffer_load_dwordx4 v7, s[16:19], s38 offen lds
v_add_f32 v79, v79, v87
v_lshlrev_b32 v80, 16, v64
v_and_b32 v81, 0xffff0000, v64
v_lshlrev_b32 v82, 16, v65
s_add_u32 m0, s50, 2048
s_nop 0
buffer_load_dwordx4 v8, s[16:19], s38 offen lds
v_and_b32 v83, 0xffff0000, v65
v_lshlrev_b32 v84, 16, v66
v_and_b32 v85, 0xffff0000, v66
v_lshlrev_b32 v86, 16, v67
s_add_u32 m0, s50, 3072
s_add_u32 s38, s38, 114688
buffer_load_dwordx4 v6, s[16:19], s38 offen lds
v_and_b32 v87, 0xffff0000, v67
v_add_f32 v72, v72, v80
v_add_f32 v73, v73, v81
v_add_f32 v74, v74, v82
v_add_f32 v75, v75, v83
s_add_u32 m0, s50, 4096
s_nop 0
buffer_load_dwordx4 v7, s[16:19], s38 offen lds
s_add_u32 m0, s50, 5120
s_nop 0
buffer_load_dwordx4 v8, s[16:19], s38 offen lds
s_waitcnt vmcnt(10)
s_barrier
s_add_u32 s38, s35, 13
s_and_b32 s38, s38, 15
s_mul_i32 s38, s38, 458752
s_add_u32 m0, s40, 49152
s_nop 0
buffer_load_dwordx4 v4, s[12:15], s38 offen lds
v_add_f32 v76, v76, v84
v_add_f32 v77, v77, v85
v_add_f32 v78, v78, v86
v_add_f32 v79, v79, v87
v_lshlrev_b32 v80, 16, v68
s_add_u32 m0, s40, 50176
s_nop 0
buffer_load_dwordx4 v5, s[12:15], s38 offen lds
v_and_b32 v81, 0xffff0000, v68
v_lshlrev_b32 v82, 16, v69
v_and_b32 v83, 0xffff0000, v69
v_lshlrev_b32 v84, 16, v70
v_and_b32 v85, 0xffff0000, v70
v_lshlrev_b32 v86, 16, v71
s_add_u32 m0, s40, 51200
s_add_u32 s38, s38, 57344
buffer_load_dwordx4 v4, s[12:15], s38 offen lds
v_and_b32 v87, 0xffff0000, v71
v_add_f32 v72, v72, v80
v_add_f32 v73, v73, v81
v_add_f32 v74, v74, v82
v_add_f32 v75, v75, v83
v_add_f32 v76, v76, v84
s_add_u32 m0, s40, 52224
s_nop 0
buffer_load_dwordx4 v5, s[12:15], s38 offen lds
v_add_f32 v77, v77, v85
v_add_f32 v78, v78, v86
v_add_f32 v79, v79, v87
s_nop 0
v_permlane32_swap_b32 v72, v76
s_add_u32 m0, s40, 53248
s_add_u32 s38, s38, 57344
buffer_load_dwordx4 v4, s[12:15], s38 offen lds
v_permlane32_swap_b32 v73, v77
v_permlane32_swap_b32 v74, v78
v_permlane32_swap_b32 v75, v79
v_add_f32 v72, v72, v76
v_add_f32 v73, v73, v77
v_add_f32 v74, v74, v78
s_add_u32 m0, s40, 54272
s_nop 0
buffer_load_dwordx4 v5, s[12:15], s38 offen lds
v_add_f32 v75, v75, v79
s_nop 0
v_permlane16_swap_b32 v72, v74
v_permlane16_swap_b32 v73, v75
v_add_f32 v72, v72, v74
v_add_f32 v73, v73, v75
s_add_u32 m0, s40, 55296
s_add_u32 s38, s38, 57344
buffer_load_dwordx4 v4, s[12:15], s38 offen lds
s_add_u32 m0, s40, 56320
s_nop 0
buffer_load_dwordx4 v5, s[12:15], s38 offen lds
s_waitcnt vmcnt(8)
s_barrier
s_lshl_b32 s43, s47, 9
s_add_u32 s43, s43, 153600
v_and_b32 v80, 15, v1
v_lshl_add_u32 v80, v80, 5, s43
v_lshrrev_b32 v81, 4, v1
v_lshl_add_u32 v80, v81, 3, v80
ds_write_b64 v80, v[72:73]
s_waitcnt lgkmcnt(0)
s_add_u32 s38, s35, 14
s_and_b32 s38, s38, 15
s_mul_i32 s38, s38, 458752
s_add_u32 m0, s40, 98304
s_nop 0
buffer_load_dwordx4 v4, s[12:15], s38 offen lds
s_bfe_u32 s61, s35, 0x10002
s_lshr_b32 s60, s35, 3
s_lshl_b32 s60, s60, 2
s_and_b32 s43, s35, 3
s_add_u32 s60, s60, s43
s_add_u32 m0, s40, 99328
s_nop 0
buffer_load_dwordx4 v5, s[12:15], s38 offen lds
s_lshl_b32 s43, s60, 8
s_add_u32 s28, s76, s43
s_addc_u32 s29, s77, 0
s_mov_b32 s30, 7338240
s_mov_b32 s31, 0x20000
s_add_u32 m0, s40, 100352
s_add_u32 s38, s38, 57344
buffer_load_dwordx4 v4, s[12:15], s38 offen lds
s_mul_i32 s52, s61, 196608
s_mul_i32 s53, s61, 1572864
s_mul_i32 s90, s61, 163840
s_mul_i32 s91, s61, 1310720
s_and_b32 s43, s35, 3
s_add_u32 m0, s40, 101376
s_nop 0
buffer_load_dwordx4 v5, s[12:15], s38 offen lds
s_mul_i32 s32, s43, 3
s_mul_i32 s33, s43, 10
s_lshr_b32 s33, s33, 2
s_lshl_b32 s51, s47, 11
s_lshl_b32 s44, s47, 15
s_add_u32 m0, s40, 102400
s_add_u32 s38, s38, 57344
buffer_load_dwordx4 v4, s[12:15], s38 offen lds
v_lshrrev_b32 v122, 4, v1
v_lshlrev_b32 v123, 1, v122
v_and_b32 v23, 15, v1
v_xor_b32 v23, v23, v123
v_lshlrev_b32 v23, 4, v23
s_add_u32 m0, s40, 103424
s_nop 0
buffer_load_dwordx4 v5, s[12:15], s38 offen lds
v_mul_u32_u24 v122, 2048, v122
v_add_u32 v23, v23, v122
v_add_u32 v23, s44, v23
v_xor_b32 v24, 128, v23
v_add_u32 v24, 8192, v24
s_add_u32 m0, s40, 104448
s_add_u32 s38, s38, 57344
buffer_load_dwordx4 v4, s[12:15], s38 offen lds
s_add_u32 m0, s40, 105472
s_nop 0
buffer_load_dwordx4 v5, s[12:15], s38 offen lds
s_waitcnt vmcnt(8)
s_barrier
ds_read_b128 v[28:31], v9 offset:49152
ds_read_b64_tr_b16 v[44:45], v15 offset:0
ds_read_b64_tr_b16 v[46:47], v15 offset:4096
ds_read_b64_tr_b16 v[48:49], v16 offset:0
ds_read_b64_tr_b16 v[50:51], v16 offset:4096
ds_read_b64_tr_b16 v[52:53], v17 offset:0
ds_read_b64_tr_b16 v[54:55], v17 offset:4096
ds_read_b64_tr_b16 v[56:57], v18 offset:0
ds_read_b64_tr_b16 v[58:59], v18 offset:4096
ds_read_b64_tr_b16 v[60:61], v15 offset:16384
ds_read_b64_tr_b16 v[62:63], v15 offset:20480
ds_read_b64_tr_b16 v[64:65], v16 offset:16384
ds_read_b64_tr_b16 v[66:67], v16 offset:20480
ds_read_b64_tr_b16 v[68:69], v17 offset:16384
ds_read_b64_tr_b16 v[70:71], v17 offset:20480
ds_read_b64_tr_b16 v[72:73], v18 offset:16384
ds_read_b64_tr_b16 v[74:75], v18 offset:20480
ds_read_b128 v[32:35], v9 offset:50176
ds_read_b128 v[36:39], v9 offset:51200
ds_read_b128 v[40:43], v9 offset:52224
s_waitcnt lgkmcnt(0)
v_mfma_f32_16x16x32_bf16 v[124:127], v[44:47], v[28:31], 0
ds_read_b128 v[76:79], v9 offset:57344
v_mfma_f32_16x16x32_bf16 v[156:159], v[44:47], v[32:35], 0
ds_read_b64_tr_b16 v[92:93], v15 offset:8192
v_mfma_f32_16x16x32_bf16 v[188:191], v[44:47], v[36:39], 0
ds_read_b64_tr_b16 v[94:95], v15 offset:12288
v_mfma_f32_16x16x32_bf16 v[220:223], v[44:47], v[40:43], 0
ds_read_b64_tr_b16 v[96:97], v16 offset:8192
v_mfma_f32_16x16x32_bf16 v[224:227], v[48:51], v[40:43], 0
ds_read_b64_tr_b16 v[98:99], v16 offset:12288
v_mfma_f32_16x16x32_bf16 v[192:195], v[48:51], v[36:39], 0
ds_read_b64_tr_b16 v[100:101], v17 offset:8192
v_mfma_f32_16x16x32_bf16 v[160:163], v[48:51], v[32:35], 0
ds_read_b64_tr_b16 v[102:103], v17 offset:12288
v_mfma_f32_16x16x32_bf16 v[128:131], v[48:51], v[28:31], 0
ds_read_b64_tr_b16 v[104:105], v18 offset:8192
v_mfma_f32_16x16x32_bf16 v[132:135], v[52:55], v[28:31], 0
ds_read_b64_tr_b16 v[106:107], v18 offset:12288
v_mfma_f32_16x16x32_bf16 v[164:167], v[52:55], v[32:35], 0
ds_read_b64_tr_b16 v[108:109], v15 offset:24576
v_mfma_f32_16x16x32_bf16 v[196:199], v[52:55], v[36:39], 0
ds_read_b64_tr_b16 v[110:111], v15 offset:28672
v_mfma_f32_16x16x32_bf16 v[228:231], v[52:55], v[40:43], 0
ds_read_b64_tr_b16 v[112:113], v16 offset:24576
v_mfma_f32_16x16x32_bf16 v[232:235], v[56:59], v[40:43], 0
ds_read_b64_tr_b16 v[114:115], v16 offset:28672
v_mfma_f32_16x16x32_bf16 v[200:203], v[56:59], v[36:39], 0
ds_read_b64_tr_b16 v[116:117], v17 offset:24576
v_mfma_f32_16x16x32_bf16 v[168:171], v[56:59], v[32:35], 0
ds_read_b64_tr_b16 v[118:119], v17 offset:28672
v_mfma_f32_16x16x32_bf16 v[136:139], v[56:59], v[28:31], 0
ds_read_b64_tr_b16 v[120:121], v18 offset:24576
v_mfma_f32_16x16x32_bf16 v[140:143], v[60:63], v[28:31], 0
ds_read_b64_tr_b16 v[122:123], v18 offset:28672
v_mfma_f32_16x16x32_bf16 v[172:175], v[60:63], v[32:35], 0
ds_read_b128 v[80:83], v9 offset:58368
v_mfma_f32_16x16x32_bf16 v[204:207], v[60:63], v[36:39], 0
ds_read_b128 v[84:87], v9 offset:59392
v_mfma_f32_16x16x32_bf16 v[236:239], v[60:63], v[40:43], 0
ds_read_b128 v[88:91], v9 offset:60416
v_mfma_f32_16x16x32_bf16 v[240:243], v[64:67], v[40:43], 0
v_mfma_f32_16x16x32_bf16 v[208:211], v[64:67], v[36:39], 0
v_mfma_f32_16x16x32_bf16 v[176:179], v[64:67], v[32:35], 0
s_branch Lov_15
.p2align 12
.fill 112, 4, 0xbf800000
Lst_15_0:
s_branch Lwr_183
s_nop 0
s_nop 0
Lov_15:
v_mfma_f32_16x16x32_bf16 v[144:147], v[64:67], v[28:31], 0
v_mfma_f32_16x16x32_bf16 v[148:151], v[68:71], v[28:31], 0
v_mfma_f32_16x16x32_bf16 v[180:183], v[68:71], v[32:35], 0
v_mfma_f32_16x16x32_bf16 v[212:215], v[68:71], v[36:39], 0
v_mfma_f32_16x16x32_bf16 v[244:247], v[68:71], v[40:43], 0
v_mfma_f32_16x16x32_bf16 v[248:251], v[72:75], v[40:43], 0
v_mfma_f32_16x16x32_bf16 v[216:219], v[72:75], v[36:39], 0
v_mfma_f32_16x16x32_bf16 v[184:187], v[72:75], v[32:35], 0
v_mfma_f32_16x16x32_bf16 v[152:155], v[72:75], v[28:31], 0
s_waitcnt vmcnt(0)
s_waitcnt lgkmcnt(0)
s_barrier
v_mfma_f32_16x16x32_bf16 v[124:127], v[92:95], v[76:79], v[124:127]
ds_read_b128 v[28:31], v10 offset:0
v_mfma_f32_16x16x32_bf16 v[156:159], v[92:95], v[80:83], v[156:159]
ds_read_b64_tr_b16 v[44:45], v19 offset:0
v_mfma_f32_16x16x32_bf16 v[188:191], v[92:95], v[84:87], v[188:191]
ds_read_b64_tr_b16 v[46:47], v19 offset:4096
v_mfma_f32_16x16x32_bf16 v[220:223], v[92:95], v[88:91], v[220:223]
ds_read_b64_tr_b16 v[48:49], v20 offset:0
v_mfma_f32_16x16x32_bf16 v[224:227], v[96:99], v[88:91], v[224:227]
ds_read_b64_tr_b16 v[50:51], v20 offset:4096
v_mfma_f32_16x16x32_bf16 v[192:195], v[96:99], v[84:87], v[192:195]
ds_read_b64_tr_b16 v[52:53], v21 offset:0
v_mfma_f32_16x16x32_bf16 v[160:163], v[96:99], v[80:83], v[160:163]
ds_read_b64_tr_b16 v[54:55], v21 offset:4096
v_mfma_f32_16x16x32_bf16 v[128:131], v[96:99], v[76:79], v[128:131]
ds_read_b64_tr_b16 v[56:57], v22 offset:0
v_mfma_f32_16x16x32_bf16 v[132:135], v[100:103], v[76:79], v[132:135]
ds_read_b64_tr_b16 v[58:59], v22 offset:4096
v_mfma_f32_16x16x32_bf16 v[164:167], v[100:103], v[80:83], v[164:167]
ds_read_b64_tr_b16 v[60:61], v19 offset:16384
v_mfma_f32_16x16x32_bf16 v[196:199], v[100:103], v[84:87], v[196:199]
ds_read_b64_tr_b16 v[62:63], v19 offset:20480
v_mfma_f32_16x16x32_bf16 v[228:231], v[100:103], v[88:91], v[228:231]
ds_read_b64_tr_b16 v[64:65], v20 offset:16384
v_mfma_f32_16x16x32_bf16 v[232:235], v[104:107], v[88:91], v[232:235]
ds_read_b64_tr_b16 v[66:67], v20 offset:20480
v_mfma_f32_16x16x32_bf16 v[200:203], v[104:107], v[84:87], v[200:203]
ds_read_b64_tr_b16 v[68:69], v21 offset:16384
v_mfma_f32_16x16x32_bf16 v[168:171], v[104:107], v[80:83], v[168:171]
ds_read_b64_tr_b16 v[70:71], v21 offset:20480
v_mfma_f32_16x16x32_bf16 v[136:139], v[104:107], v[76:79], v[136:139]
ds_read_b64_tr_b16 v[72:73], v22 offset:16384
v_mfma_f32_16x16x32_bf16 v[140:143], v[108:111], v[76:79], v[140:143]
ds_read_b64_tr_b16 v[74:75], v22 offset:20480
v_mfma_f32_16x16x32_bf16 v[172:175], v[108:111], v[80:83], v[172:175]
ds_read_b128 v[32:35], v10 offset:1024
v_mfma_f32_16x16x32_bf16 v[204:207], v[108:111], v[84:87], v[204:207]
ds_read_b128 v[36:39], v10 offset:2048
v_mfma_f32_16x16x32_bf16 v[236:239], v[108:111], v[88:91], v[236:239]
ds_read_b128 v[40:43], v10 offset:3072
v_mfma_f32_16x16x32_bf16 v[240:243], v[112:115], v[88:91], v[240:243]
v_mfma_f32_16x16x32_bf16 v[208:211], v[112:115], v[84:87], v[208:211]
v_mfma_f32_16x16x32_bf16 v[176:179], v[112:115], v[80:83], v[176:179]
v_mfma_f32_16x16x32_bf16 v[144:147], v[112:115], v[76:79], v[144:147]
v_mfma_f32_16x16x32_bf16 v[148:151], v[116:119], v[76:79], v[148:151]
v_mfma_f32_16x16x32_bf16 v[180:183], v[116:119], v[80:83], v[180:183]
v_mfma_f32_16x16x32_bf16 v[212:215], v[116:119], v[84:87], v[212:215]
v_mfma_f32_16x16x32_bf16 v[244:247], v[116:119], v[88:91], v[244:247]
v_mfma_f32_16x16x32_bf16 v[248:251], v[120:123], v[88:91], v[248:251]
v_mfma_f32_16x16x32_bf16 v[216:219], v[120:123], v[84:87], v[216:219]
v_mfma_f32_16x16x32_bf16 v[184:187], v[120:123], v[80:83], v[184:187]
v_mfma_f32_16x16x32_bf16 v[152:155], v[120:123], v[76:79], v[152:155]
s_mov_b32 s41, 5
Lk3l_147:
s_waitcnt lgkmcnt(0)
v_mfma_f32_16x16x32_bf16 v[124:127], v[44:47], v[28:31], v[124:127]
ds_read_b128 v[76:79], v10 offset:8192
v_mfma_f32_16x16x32_bf16 v[156:159], v[44:47], v[32:35], v[156:159]
ds_read_b64_tr_b16 v[92:93], v19 offset:8192
v_mfma_f32_16x16x32_bf16 v[188:191], v[44:47], v[36:39], v[188:191]
ds_read_b64_tr_b16 v[94:95], v19 offset:12288
v_mfma_f32_16x16x32_bf16 v[220:223], v[44:47], v[40:43], v[220:223]
ds_read_b64_tr_b16 v[96:97], v20 offset:8192
v_mfma_f32_16x16x32_bf16 v[224:227], v[48:51], v[40:43], v[224:227]
ds_read_b64_tr_b16 v[98:99], v20 offset:12288
v_mfma_f32_16x16x32_bf16 v[192:195], v[48:51], v[36:39], v[192:195]
ds_read_b64_tr_b16 v[100:101], v21 offset:8192
v_mfma_f32_16x16x32_bf16 v[160:163], v[48:51], v[32:35], v[160:163]
ds_read_b64_tr_b16 v[102:103], v21 offset:12288
v_mfma_f32_16x16x32_bf16 v[128:131], v[48:51], v[28:31], v[128:131]
ds_read_b64_tr_b16 v[104:105], v22 offset:8192
v_mfma_f32_16x16x32_bf16 v[132:135], v[52:55], v[28:31], v[132:135]
ds_read_b64_tr_b16 v[106:107], v22 offset:12288
v_mfma_f32_16x16x32_bf16 v[164:167], v[52:55], v[32:35], v[164:167]
ds_read_b64_tr_b16 v[108:109], v19 offset:24576
v_mfma_f32_16x16x32_bf16 v[196:199], v[52:55], v[36:39], v[196:199]
ds_read_b64_tr_b16 v[110:111], v19 offset:28672
v_mfma_f32_16x16x32_bf16 v[228:231], v[52:55], v[40:43], v[228:231]
ds_read_b64_tr_b16 v[112:113], v20 offset:24576
v_mfma_f32_16x16x32_bf16 v[232:235], v[56:59], v[40:43], v[232:235]
ds_read_b64_tr_b16 v[114:115], v20 offset:28672
v_mfma_f32_16x16x32_bf16 v[200:203], v[56:59], v[36:39], v[200:203]
ds_read_b64_tr_b16 v[116:117], v21 offset:24576
v_mfma_f32_16x16x32_bf16 v[168:171], v[56:59], v[32:35], v[168:171]
ds_read_b64_tr_b16 v[118:119], v21 offset:28672
v_mfma_f32_16x16x32_bf16 v[136:139], v[56:59], v[28:31], v[136:139]
ds_read_b64_tr_b16 v[120:121], v22 offset:24576
v_mfma_f32_16x16x32_bf16 v[140:143], v[60:63], v[28:31], v[140:143]
ds_read_b64_tr_b16 v[122:123], v22 offset:28672
v_mfma_f32_16x16x32_bf16 v[172:175], v[60:63], v[32:35], v[172:175]
ds_read_b128 v[80:83], v10 offset:9216
v_mfma_f32_16x16x32_bf16 v[204:207], v[60:63], v[36:39], v[204:207]
ds_read_b128 v[84:87], v10 offset:10240
v_mfma_f32_16x16x32_bf16 v[236:239], v[60:63], v[40:43], v[236:239]
ds_read_b128 v[88:91], v10 offset:11264
v_mfma_f32_16x16x32_bf16 v[240:243], v[64:67], v[40:43], v[240:243]
v_mfma_f32_16x16x32_bf16 v[208:211], v[64:67], v[36:39], v[208:211]
v_mfma_f32_16x16x32_bf16 v[176:179], v[64:67], v[32:35], v[176:179]
v_mfma_f32_16x16x32_bf16 v[144:147], v[64:67], v[28:31], v[144:147]
v_mfma_f32_16x16x32_bf16 v[148:151], v[68:71], v[28:31], v[148:151]
v_mfma_f32_16x16x32_bf16 v[180:183], v[68:71], v[32:35], v[180:183]
v_mfma_f32_16x16x32_bf16 v[212:215], v[68:71], v[36:39], v[212:215]
v_mfma_f32_16x16x32_bf16 v[244:247], v[68:71], v[40:43], v[244:247]
v_mfma_f32_16x16x32_bf16 v[248:251], v[72:75], v[40:43], v[248:251]
v_mfma_f32_16x16x32_bf16 v[216:219], v[72:75], v[36:39], v[216:219]
v_mfma_f32_16x16x32_bf16 v[184:187], v[72:75], v[32:35], v[184:187]
v_mfma_f32_16x16x32_bf16 v[152:155], v[72:75], v[28:31], v[152:155]
s_waitcnt lgkmcnt(0)
s_barrier
v_mfma_f32_16x16x32_bf16 v[124:127], v[92:95], v[76:79], v[124:127]
ds_read_b128 v[28:31], v9 offset:0
v_mfma_f32_16x16x32_bf16 v[156:159], v[92:95], v[80:83], v[156:159]
ds_read_b64_tr_b16 v[44:45], v11 offset:0
v_mfma_f32_16x16x32_bf16 v[188:191], v[92:95], v[84:87], v[188:191]
ds_read_b64_tr_b16 v[46:47], v11 offset:4096
v_mfma_f32_16x16x32_bf16 v[220:223], v[92:95], v[88:91], v[220:223]
ds_read_b64_tr_b16 v[48:49], v12 offset:0
v_mfma_f32_16x16x32_bf16 v[224:227], v[96:99], v[88:91], v[224:227]
ds_read_b64_tr_b16 v[50:51], v12 offset:4096
v_mfma_f32_16x16x32_bf16 v[192:195], v[96:99], v[84:87], v[192:195]
ds_read_b64_tr_b16 v[52:53], v13 offset:0
v_mfma_f32_16x16x32_bf16 v[160:163], v[96:99], v[80:83], v[160:163]
ds_read_b64_tr_b16 v[54:55], v13 offset:4096
v_mfma_f32_16x16x32_bf16 v[128:131], v[96:99], v[76:79], v[128:131]
ds_read_b64_tr_b16 v[56:57], v14 offset:0
v_mfma_f32_16x16x32_bf16 v[132:135], v[100:103], v[76:79], v[132:135]
ds_read_b64_tr_b16 v[58:59], v14 offset:4096
v_mfma_f32_16x16x32_bf16 v[164:167], v[100:103], v[80:83], v[164:167]
ds_read_b64_tr_b16 v[60:61], v11 offset:16384
v_mfma_f32_16x16x32_bf16 v[196:199], v[100:103], v[84:87], v[196:199]
ds_read_b64_tr_b16 v[62:63], v11 offset:20480
v_mfma_f32_16x16x32_bf16 v[228:231], v[100:103], v[88:91], v[228:231]
ds_read_b64_tr_b16 v[64:65], v12 offset:16384
v_mfma_f32_16x16x32_bf16 v[232:235], v[104:107], v[88:91], v[232:235]
ds_read_b64_tr_b16 v[66:67], v12 offset:20480
v_mfma_f32_16x16x32_bf16 v[200:203], v[104:107], v[84:87], v[200:203]
ds_read_b64_tr_b16 v[68:69], v13 offset:16384
v_mfma_f32_16x16x32_bf16 v[168:171], v[104:107], v[80:83], v[168:171]
ds_read_b64_tr_b16 v[70:71], v13 offset:20480
v_mfma_f32_16x16x32_bf16 v[136:139], v[104:107], v[76:79], v[136:139]
ds_read_b64_tr_b16 v[72:73], v14 offset:16384
v_mfma_f32_16x16x32_bf16 v[140:143], v[108:111], v[76:79], v[140:143]
ds_read_b64_tr_b16 v[74:75], v14 offset:20480
v_mfma_f32_16x16x32_bf16 v[172:175], v[108:111], v[80:83], v[172:175]
ds_read_b128 v[32:35], v9 offset:1024
v_mfma_f32_16x16x32_bf16 v[204:207], v[108:111], v[84:87], v[204:207]
ds_read_b128 v[36:39], v9 offset:2048
v_mfma_f32_16x16x32_bf16 v[236:239], v[108:111], v[88:91], v[236:239]
ds_read_b128 v[40:43], v9 offset:3072
v_mfma_f32_16x16x32_bf16 v[240:243], v[112:115], v[88:91], v[240:243]
v_mfma_f32_16x16x32_bf16 v[208:211], v[112:115], v[84:87], v[208:211]
v_mfma_f32_16x16x32_bf16 v[176:179], v[112:115], v[80:83], v[176:179]
v_mfma_f32_16x16x32_bf16 v[144:147], v[112:115], v[76:79], v[144:147]
v_mfma_f32_16x16x32_bf16 v[148:151], v[116:119], v[76:79], v[148:151]
v_mfma_f32_16x16x32_bf16 v[180:183], v[116:119], v[80:83], v[180:183]
v_mfma_f32_16x16x32_bf16 v[212:215], v[116:119], v[84:87], v[212:215]
v_mfma_f32_16x16x32_bf16 v[244:247], v[116:119], v[88:91], v[244:247]
v_mfma_f32_16x16x32_bf16 v[248:251], v[120:123], v[88:91], v[248:251]
v_mfma_f32_16x16x32_bf16 v[216:219], v[120:123], v[84:87], v[216:219]
v_mfma_f32_16x16x32_bf16 v[184:187], v[120:123], v[80:83], v[184:187]
v_mfma_f32_16x16x32_bf16 v[152:155], v[120:123], v[76:79], v[152:155]
s_waitcnt lgkmcnt(0)
v_mfma_f32_16x16x32_bf16 v[124:127], v[44:47], v[28:31], v[124:127]
ds_read_b128 v[76:79], v9 offset:8192
v_mfma_f32_16x16x32_bf16 v[156:159], v[44:47], v[32:35], v[156:159]
ds_read_b64_tr_b16 v[92:93], v11 offset:8192
v_mfma_f32_16x16x32_bf16 v[188:191], v[44:47], v[36:39], v[188:191]
ds_read_b64_tr_b16 v[94:95], v11 offset:12288
v_mfma_f32_16x16x32_bf16 v[220:223], v[44:47], v[40:43], v[220:223]
ds_read_b64_tr_b16 v[96:97], v12 offset:8192
v_mfma_f32_16x16x32_bf16 v[224:227], v[48:51], v[40:43], v[224:227]
ds_read_b64_tr_b16 v[98:99], v12 offset:12288
v_mfma_f32_16x16x32_bf16 v[192:195], v[48:51], v[36:39], v[192:195]
ds_read_b64_tr_b16 v[100:101], v13 offset:8192
v_mfma_f32_16x16x32_bf16 v[160:163], v[48:51], v[32:35], v[160:163]
ds_read_b64_tr_b16 v[102:103], v13 offset:12288
v_mfma_f32_16x16x32_bf16 v[128:131], v[48:51], v[28:31], v[128:131]
ds_read_b64_tr_b16 v[104:105], v14 offset:8192
v_mfma_f32_16x16x32_bf16 v[132:135], v[52:55], v[28:31], v[132:135]
ds_read_b64_tr_b16 v[106:107], v14 offset:12288
v_mfma_f32_16x16x32_bf16 v[164:167], v[52:55], v[32:35], v[164:167]
ds_read_b64_tr_b16 v[108:109], v11 offset:24576
v_mfma_f32_16x16x32_bf16 v[196:199], v[52:55], v[36:39], v[196:199]
ds_read_b64_tr_b16 v[110:111], v11 offset:28672
v_mfma_f32_16x16x32_bf16 v[228:231], v[52:55], v[40:43], v[228:231]
ds_read_b64_tr_b16 v[112:113], v12 offset:24576
v_mfma_f32_16x16x32_bf16 v[232:235], v[56:59], v[40:43], v[232:235]
ds_read_b64_tr_b16 v[114:115], v12 offset:28672
v_mfma_f32_16x16x32_bf16 v[200:203], v[56:59], v[36:39], v[200:203]
ds_read_b64_tr_b16 v[116:117], v13 offset:24576
v_mfma_f32_16x16x32_bf16 v[168:171], v[56:59], v[32:35], v[168:171]
ds_read_b64_tr_b16 v[118:119], v13 offset:28672
v_mfma_f32_16x16x32_bf16 v[136:139], v[56:59], v[28:31], v[136:139]
ds_read_b64_tr_b16 v[120:121], v14 offset:24576
v_mfma_f32_16x16x32_bf16 v[140:143], v[60:63], v[28:31], v[140:143]
ds_read_b64_tr_b16 v[122:123], v14 offset:28672
v_mfma_f32_16x16x32_bf16 v[172:175], v[60:63], v[32:35], v[172:175]
ds_read_b128 v[80:83], v9 offset:9216
v_mfma_f32_16x16x32_bf16 v[204:207], v[60:63], v[36:39], v[204:207]
ds_read_b128 v[84:87], v9 offset:10240
v_mfma_f32_16x16x32_bf16 v[236:239], v[60:63], v[40:43], v[236:239]
ds_read_b128 v[88:91], v9 offset:11264
v_mfma_f32_16x16x32_bf16 v[240:243], v[64:67], v[40:43], v[240:243]
v_mfma_f32_16x16x32_bf16 v[208:211], v[64:67], v[36:39], v[208:211]
v_mfma_f32_16x16x32_bf16 v[176:179], v[64:67], v[32:35], v[176:179]
v_mfma_f32_16x16x32_bf16 v[144:147], v[64:67], v[28:31], v[144:147]
v_mfma_f32_16x16x32_bf16 v[148:151], v[68:71], v[28:31], v[148:151]
v_mfma_f32_16x16x32_bf16 v[180:183], v[68:71], v[32:35], v[180:183]
v_mfma_f32_16x16x32_bf16 v[212:215], v[68:71], v[36:39], v[212:215]
v_mfma_f32_16x16x32_bf16 v[244:247], v[68:71], v[40:43], v[244:247]
v_mfma_f32_16x16x32_bf16 v[248:251], v[72:75], v[40:43], v[248:251]
v_mfma_f32_16x16x32_bf16 v[216:219], v[72:75], v[36:39], v[216:219]
v_mfma_f32_16x16x32_bf16 v[184:187], v[72:75], v[32:35], v[184:187]
v_mfma_f32_16x16x32_bf16 v[152:155], v[72:75], v[28:31], v[152:155]
s_waitcnt lgkmcnt(0)
s_barrier
v_mfma_f32_16x16x32_bf16 v[124:127], v[92:95], v[76:79], v[124:127]
ds_read_b128 v[28:31], v9 offset:49152
v_mfma_f32_16x16x32_bf16 v[156:159], v[92:95], v[80:83], v[156:159]
ds_read_b64_tr_b16 v[44:45], v15 offset:0
v_mfma_f32_16x16x32_bf16 v[188:191], v[92:95], v[84:87], v[188:191]
ds_read_b64_tr_b16 v[46:47], v15 offset:4096
v_mfma_f32_16x16x32_bf16 v[220:223], v[92:95], v[88:91], v[220:223]
ds_read_b64_tr_b16 v[48:49], v16 offset:0
v_mfma_f32_16x16x32_bf16 v[224:227], v[96:99], v[88:91], v[224:227]
ds_read_b64_tr_b16 v[50:51], v16 offset:4096
v_mfma_f32_16x16x32_bf16 v[192:195], v[96:99], v[84:87], v[192:195]
ds_read_b64_tr_b16 v[52:53], v17 offset:0
v_mfma_f32_16x16x32_bf16 v[160:163], v[96:99], v[80:83], v[160:163]
ds_read_b64_tr_b16 v[54:55], v17 offset:4096
v_mfma_f32_16x16x32_bf16 v[128:131], v[96:99], v[76:79], v[128:131]
ds_read_b64_tr_b16 v[56:57], v18 offset:0
v_mfma_f32_16x16x32_bf16 v[132:135], v[100:103], v[76:79], v[132:135]
ds_read_b64_tr_b16 v[58:59], v18 offset:4096
v_mfma_f32_16x16x32_bf16 v[164:167], v[100:103], v[80:83], v[164:167]
ds_read_b64_tr_b16 v[60:61], v15 offset:16384
v_mfma_f32_16x16x32_bf16 v[196:199], v[100:103], v[84:87], v[196:199]
ds_read_b64_tr_b16 v[62:63], v15 offset:20480
v_mfma_f32_16x16x32_bf16 v[228:231], v[100:103], v[88:91], v[228:231]
ds_read_b64_tr_b16 v[64:65], v16 offset:16384
v_mfma_f32_16x16x32_bf16 v[232:235], v[104:107], v[88:91], v[232:235]
ds_read_b64_tr_b16 v[66:67], v16 offset:20480
v_mfma_f32_16x16x32_bf16 v[200:203], v[104:107], v[84:87], v[200:203]
ds_read_b64_tr_b16 v[68:69], v17 offset:16384
v_mfma_f32_16x16x32_bf16 v[168:171], v[104:107], v[80:83], v[168:171]
ds_read_b64_tr_b16 v[70:71], v17 offset:20480
v_mfma_f32_16x16x32_bf16 v[136:139], v[104:107], v[76:79], v[136:139]
ds_read_b64_tr_b16 v[72:73], v18 offset:16384
v_mfma_f32_16x16x32_bf16 v[140:143], v[108:111], v[76:79], v[140:143]
ds_read_b64_tr_b16 v[74:75], v18 offset:20480
v_mfma_f32_16x16x32_bf16 v[172:175], v[108:111], v[80:83], v[172:175]
ds_read_b128 v[32:35], v9 offset:50176
v_mfma_f32_16x16x32_bf16 v[204:207], v[108:111], v[84:87], v[204:207]
ds_read_b128 v[36:39], v9 offset:51200
v_mfma_f32_16x16x32_bf16 v[236:239], v[108:111], v[88:91], v[236:239]
ds_read_b128 v[40:43], v9 offset:52224
v_mfma_f32_16x16x32_bf16 v[240:243], v[112:115], v[88:91], v[240:243]
v_mfma_f32_16x16x32_bf16 v[208:211], v[112:115], v[84:87], v[208:211]
v_mfma_f32_16x16x32_bf16 v[176:179], v[112:115], v[80:83], v[176:179]
v_mfma_f32_16x16x32_bf16 v[144:147], v[112:115], v[76:79], v[144:147]
v_mfma_f32_16x16x32_bf16 v[148:151], v[116:119], v[76:79], v[148:151]
v_mfma_f32_16x16x32_bf16 v[180:183], v[116:119], v[80:83], v[180:183]
v_mfma_f32_16x16x32_bf16 v[212:215], v[116:119], v[84:87], v[212:215]
v_mfma_f32_16x16x32_bf16 v[244:247], v[116:119], v[88:91], v[244:247]
v_mfma_f32_16x16x32_bf16 v[248:251], v[120:123], v[88:91], v[248:251]
v_mfma_f32_16x16x32_bf16 v[216:219], v[120:123], v[84:87], v[216:219]
v_mfma_f32_16x16x32_bf16 v[184:187], v[120:123], v[80:83], v[184:187]
v_mfma_f32_16x16x32_bf16 v[152:155], v[120:123], v[76:79], v[152:155]
s_waitcnt lgkmcnt(0)
v_mfma_f32_16x16x32_bf16 v[124:127], v[44:47], v[28:31], v[124:127]
ds_read_b128 v[76:79], v9 offset:57344
v_mfma_f32_16x16x32_bf16 v[156:159], v[44:47], v[32:35], v[156:159]
ds_read_b64_tr_b16 v[92:93], v15 offset:8192
v_mfma_f32_16x16x32_bf16 v[188:191], v[44:47], v[36:39], v[188:191]
ds_read_b64_tr_b16 v[94:95], v15 offset:12288
v_mfma_f32_16x16x32_bf16 v[220:223], v[44:47], v[40:43], v[220:223]
ds_read_b64_tr_b16 v[96:97], v16 offset:8192
v_mfma_f32_16x16x32_bf16 v[224:227], v[48:51], v[40:43], v[224:227]
ds_read_b64_tr_b16 v[98:99], v16 offset:12288
v_mfma_f32_16x16x32_bf16 v[192:195], v[48:51], v[36:39], v[192:195]
ds_read_b64_tr_b16 v[100:101], v17 offset:8192
v_mfma_f32_16x16x32_bf16 v[160:163], v[48:51], v[32:35], v[160:163]
ds_read_b64_tr_b16 v[102:103], v17 offset:12288
v_mfma_f32_16x16x32_bf16 v[128:131], v[48:51], v[28:31], v[128:131]
ds_read_b64_tr_b16 v[104:105], v18 offset:8192
v_mfma_f32_16x16x32_bf16 v[132:135], v[52:55], v[28:31], v[132:135]
ds_read_b64_tr_b16 v[106:107], v18 offset:12288
v_mfma_f32_16x16x32_bf16 v[164:167], v[52:55], v[32:35], v[164:167]
ds_read_b64_tr_b16 v[108:109], v15 offset:24576
v_mfma_f32_16x16x32_bf16 v[196:199], v[52:55], v[36:39], v[196:199]
ds_read_b64_tr_b16 v[110:111], v15 offset:28672
v_mfma_f32_16x16x32_bf16 v[228:231], v[52:55], v[40:43], v[228:231]
ds_read_b64_tr_b16 v[112:113], v16 offset:24576
v_mfma_f32_16x16x32_bf16 v[232:235], v[56:59], v[40:43], v[232:235]
ds_read_b64_tr_b16 v[114:115], v16 offset:28672
v_mfma_f32_16x16x32_bf16 v[200:203], v[56:59], v[36:39], v[200:203]
ds_read_b64_tr_b16 v[116:117], v17 offset:24576
v_mfma_f32_16x16x32_bf16 v[168:171], v[56:59], v[32:35], v[168:171]
ds_read_b64_tr_b16 v[118:119], v17 offset:28672
v_mfma_f32_16x16x32_bf16 v[136:139], v[56:59], v[28:31], v[136:139]
ds_read_b64_tr_b16 v[120:121], v18 offset:24576
v_mfma_f32_16x16x32_bf16 v[140:143], v[60:63], v[28:31], v[140:143]
ds_read_b64_tr_b16 v[122:123], v18 offset:28672
v_mfma_f32_16x16x32_bf16 v[172:175], v[60:63], v[32:35], v[172:175]
ds_read_b128 v[80:83], v9 offset:58368
v_mfma_f32_16x16x32_bf16 v[204:207], v[60:63], v[36:39], v[204:207]
ds_read_b128 v[84:87], v9 offset:59392
v_mfma_f32_16x16x32_bf16 v[236:239], v[60:63], v[40:43], v[236:239]
ds_read_b128 v[88:91], v9 offset:60416
v_mfma_f32_16x16x32_bf16 v[240:243], v[64:67], v[40:43], v[240:243]
v_mfma_f32_16x16x32_bf16 v[208:211], v[64:67], v[36:39], v[208:211]
v_mfma_f32_16x16x32_bf16 v[176:179], v[64:67], v[32:35], v[176:179]
v_mfma_f32_16x16x32_bf16 v[144:147], v[64:67], v[28:31], v[144:147]
v_mfma_f32_16x16x32_bf16 v[148:151], v[68:71], v[28:31], v[148:151]
v_mfma_f32_16x16x32_bf16 v[180:183], v[68:71], v[32:35], v[180:183]
v_mfma_f32_16x16x32_bf16 v[212:215], v[68:71], v[36:39], v[212:215]
v_mfma_f32_16x16x32_bf16 v[244:247], v[68:71], v[40:43], v[244:247]
v_mfma_f32_16x16x32_bf16 v[248:251], v[72:75], v[40:43], v[248:251]
v_mfma_f32_16x16x32_bf16 v[216:219], v[72:75], v[36:39], v[216:219]
v_mfma_f32_16x16x32_bf16 v[184:187], v[72:75], v[32:35], v[184:187]
v_mfma_f32_16x16x32_bf16 v[152:155], v[72:75], v[28:31], v[152:155]
s_waitcnt lgkmcnt(0)
s_barrier
v_mfma_f32_16x16x32_bf16 v[124:127], v[92:95], v[76:79], v[124:127]
ds_read_b128 v[28:31], v10 offset:0
v_mfma_f32_16x16x32_bf16 v[156:159], v[92:95], v[80:83], v[156:159]
ds_read_b64_tr_b16 v[44:45], v19 offset:0
v_mfma_f32_16x16x32_bf16 v[188:191], v[92:95], v[84:87], v[188:191]
ds_read_b64_tr_b16 v[46:47], v19 offset:4096
v_mfma_f32_16x16x32_bf16 v[220:223], v[92:95], v[88:91], v[220:223]
ds_read_b64_tr_b16 v[48:49], v20 offset:0
v_mfma_f32_16x16x32_bf16 v[224:227], v[96:99], v[88:91], v[224:227]
ds_read_b64_tr_b16 v[50:51], v20 offset:4096
v_mfma_f32_16x16x32_bf16 v[192:195], v[96:99], v[84:87], v[192:195]
ds_read_b64_tr_b16 v[52:53], v21 offset:0
v_mfma_f32_16x16x32_bf16 v[160:163], v[96:99], v[80:83], v[160:163]
ds_read_b64_tr_b16 v[54:55], v21 offset:4096
v_mfma_f32_16x16x32_bf16 v[128:131], v[96:99], v[76:79], v[128:131]
ds_read_b64_tr_b16 v[56:57], v22 offset:0
v_mfma_f32_16x16x32_bf16 v[132:135], v[100:103], v[76:79], v[132:135]
ds_read_b64_tr_b16 v[58:59], v22 offset:4096
v_mfma_f32_16x16x32_bf16 v[164:167], v[100:103], v[80:83], v[164:167]
ds_read_b64_tr_b16 v[60:61], v19 offset:16384
v_mfma_f32_16x16x32_bf16 v[196:199], v[100:103], v[84:87], v[196:199]
ds_read_b64_tr_b16 v[62:63], v19 offset:20480
v_mfma_f32_16x16x32_bf16 v[228:231], v[100:103], v[88:91], v[228:231]
ds_read_b64_tr_b16 v[64:65], v20 offset:16384
v_mfma_f32_16x16x32_bf16 v[232:235], v[104:107], v[88:91], v[232:235]
ds_read_b64_tr_b16 v[66:67], v20 offset:20480
v_mfma_f32_16x16x32_bf16 v[200:203], v[104:107], v[84:87], v[200:203]
ds_read_b64_tr_b16 v[68:69], v21 offset:16384
v_mfma_f32_16x16x32_bf16 v[168:171], v[104:107], v[80:83], v[168:171]
ds_read_b64_tr_b16 v[70:71], v21 offset:20480
v_mfma_f32_16x16x32_bf16 v[136:139], v[104:107], v[76:79], v[136:139]
ds_read_b64_tr_b16 v[72:73], v22 offset:16384
v_mfma_f32_16x16x32_bf16 v[140:143], v[108:111], v[76:79], v[140:143]
ds_read_b64_tr_b16 v[74:75], v22 offset:20480
v_mfma_f32_16x16x32_bf16 v[172:175], v[108:111], v[80:83], v[172:175]
ds_read_b128 v[32:35], v10 offset:1024
v_mfma_f32_16x16x32_bf16 v[204:207], v[108:111], v[84:87], v[204:207]
ds_read_b128 v[36:39], v10 offset:2048
v_mfma_f32_16x16x32_bf16 v[236:239], v[108:111], v[88:91], v[236:239]
ds_read_b128 v[40:43], v10 offset:3072
v_mfma_f32_16x16x32_bf16 v[240:243], v[112:115], v[88:91], v[240:243]
v_mfma_f32_16x16x32_bf16 v[208:211], v[112:115], v[84:87], v[208:211]
v_mfma_f32_16x16x32_bf16 v[176:179], v[112:115], v[80:83], v[176:179]
v_mfma_f32_16x16x32_bf16 v[144:147], v[112:115], v[76:79], v[144:147]
v_mfma_f32_16x16x32_bf16 v[148:151], v[116:119], v[76:79], v[148:151]
v_mfma_f32_16x16x32_bf16 v[180:183], v[116:119], v[80:83], v[180:183]
v_mfma_f32_16x16x32_bf16 v[212:215], v[116:119], v[84:87], v[212:215]
v_mfma_f32_16x16x32_bf16 v[244:247], v[116:119], v[88:91], v[244:247]
v_mfma_f32_16x16x32_bf16 v[248:251], v[120:123], v[88:91], v[248:251]
v_mfma_f32_16x16x32_bf16 v[216:219], v[120:123], v[84:87], v[216:219]
v_mfma_f32_16x16x32_bf16 v[184:187], v[120:123], v[80:83], v[184:187]
v_mfma_f32_16x16x32_bf16 v[152:155], v[120:123], v[76:79], v[152:155]
s_sub_u32 s41, s41, 1
s_cmp_lg_u32 s41, 0
s_cbranch_scc1 Lk3l_147
s_waitcnt lgkmcnt(0)
v_lshrrev_b32 v84, 4, v1
s_lshl_b32 s43, s63, 8
s_add_u32 s43, s43, 148480
v_lshl_add_u32 v85, v84, 4, s43
v_and_b32 v84, 15, v1
s_lshl_b32 s43, s62, 9
s_add_u32 s43, s43, 147456
v_lshl_add_u32 v84, v84, 3, s43
ds_read_b128 v[28:31], v85 offset:0
ds_read_b128 v[32:35], v85 offset:64
ds_read_b128 v[36:39], v85 offset:128
ds_read_b128 v[40:43], v85 offset:192
ds_read_b128 v[44:47], v85 offset:896
ds_read_b128 v[48:51], v85 offset:960
ds_read_b128 v[52:55], v85 offset:1024
ds_read_b128 v[56:59], v85 offset:1088
ds_read_b64 v[60:61], v84 offset:0
ds_read_b64 v[62:63], v84 offset:128
ds_read_b64 v[64:65], v84 offset:256
ds_read_b64 v[66:67], v84 offset:384
s_lshl_b32 s54, s35, 15
s_lshl_b32 s43, s63, 14
s_add_u32 s54, s54, s43
s_lshl_b32 s43, s62, 12
s_add_u32 s54, s54, s43
s_add_u32 s55, s54, 8192
v_lshrrev_b32 v122, 3, v1
v_and_b32 v123, 6, v122
v_and_b32 v25, 7, v1
v_xor_b32 v25, v25, v123
v_lshlrev_b32 v25, 4, v25
v_mul_u32_u24 v122, 2048, v122
v_add_u32 v25, v25, v122
s_lshl_b32 s43, s61, 7
s_lshl_b32 s44, s47, 15
s_add_u32 s43, s43, s44
v_add_u32 v25, s43, v25
s_waitcnt lgkmcnt(0)
v_mul_f32 v70, v61, v61
v_mul_f32 v68, 0xc0135761, v61
v_mul_f32 v69, 0xbdd2d3e8, v61
v_mul_f32 v69, v69, v70
v_rcp_f32 v70, v70
v_mul_f32 v74, v63, v63
v_mul_f32 v72, 0xc0135761, v63
v_mul_f32 v73, 0xbdd2d3e8, v63
v_mul_f32 v73, v73, v74
v_rcp_f32 v74, v74
v_pk_fma_f32 v[124:125], v[60:61], v[28:29], v[124:125] op_sel_hi:[0,1,1] neg_lo:[1,0,0] neg_hi:[1,0,0]
v_pk_fma_f32 v[126:127], v[60:61], v[30:31], v[126:127] op_sel_hi:[0,1,1] neg_lo:[1,0,0] neg_hi:[1,0,0]
v_pk_fma_f32 v[156:157], v[62:63], v[28:29], v[156:157] op_sel_hi:[0,1,1] neg_lo:[1,0,0] neg_hi:[1,0,0]
v_pk_fma_f32 v[158:159], v[62:63], v[30:31], v[158:159] op_sel_hi:[0,1,1] neg_lo:[1,0,0] neg_hi:[1,0,0]
v_pk_mul_f32 v[76:77], v[124:125], v[124:125]
v_pk_mul_f32 v[78:79], v[126:127], v[126:127]
v_pk_mul_f32 v[80:81], v[156:157], v[156:157]
v_pk_mul_f32 v[82:83], v[158:159], v[158:159]
v_pk_fma_f32 v[76:77], v[76:77], v[68:69], v[68:69] op_sel:[0,1,0] op_sel_hi:[1,1,0]
v_pk_fma_f32 v[78:79], v[78:79], v[68:69], v[68:69] op_sel:[0,1,0] op_sel_hi:[1,1,0]
v_pk_fma_f32 v[80:81], v[80:81], v[72:73], v[72:73] op_sel:[0,1,0] op_sel_hi:[1,1,0]
v_pk_fma_f32 v[82:83], v[82:83], v[72:73], v[72:73] op_sel:[0,1,0] op_sel_hi:[1,1,0]
v_pk_mul_f32 v[76:77], v[76:77], v[124:125]
v_pk_mul_f32 v[78:79], v[78:79], v[126:127]
v_pk_mul_f32 v[80:81], v[80:81], v[156:157]
v_pk_mul_f32 v[82:83], v[82:83], v[158:159]
v_exp_f32 v76, v76
v_exp_f32 v77, v77
v_exp_f32 v78, v78
v_exp_f32 v79, v79
v_exp_f32 v80, v80
v_exp_f32 v81, v81
v_exp_f32 v82, v82
v_exp_f32 v83, v83
v_pk_fma_f32 v[140:141], v[60:61], v[44:45], v[140:141] op_sel_hi:[0,1,1] neg_lo:[1,0,0] neg_hi:[1,0,0]
v_pk_fma_f32 v[142:143], v[60:61], v[46:47], v[142:143] op_sel_hi:[0,1,1] neg_lo:[1,0,0] neg_hi:[1,0,0]
v_pk_fma_f32 v[172:173], v[62:63], v[44:45], v[172:173] op_sel_hi:[0,1,1] neg_lo:[1,0,0] neg_hi:[1,0,0]
v_pk_fma_f32 v[174:175], v[62:63], v[46:47], v[174:175] op_sel_hi:[0,1,1] neg_lo:[1,0,0] neg_hi:[1,0,0]
v_pk_fma_f32 v[76:77], v[76:77], v[70:71], v[70:71] op_sel_hi:[1,0,0]
v_pk_fma_f32 v[78:79], v[78:79], v[70:71], v[70:71] op_sel_hi:[1,0,0]
v_pk_fma_f32 v[80:81], v[80:81], v[74:75], v[74:75] op_sel_hi:[1,0,0]
v_pk_fma_f32 v[82:83], v[82:83], v[74:75], v[74:75] op_sel_hi:[1,0,0]
v_rcp_f32 v76, v76
v_rcp_f32 v77, v77
v_rcp_f32 v78, v78
v_rcp_f32 v79, v79
v_rcp_f32 v80, v80
v_rcp_f32 v81, v81
v_rcp_f32 v82, v82
v_rcp_f32 v83, v83
v_pk_mul_f32 v[140:141], v[124:125], v[140:141]
v_pk_mul_f32 v[142:143], v[126:127], v[142:143]
v_pk_mul_f32 v[172:173], v[156:157], v[172:173]
v_pk_mul_f32 v[174:175], v[158:159], v[174:175]
v_pk_mul_f32 v[140:141], v[140:141], v[76:77]
s_branch Lov_16
.p2align 12
.fill 128, 4, 0xbf800000
Lst_16_0:
s_branch Lwr_184
s_nop 0
s_nop 0
Lov_16:
v_pk_mul_f32 v[142:143], v[142:143], v[78:79]
v_pk_mul_f32 v[172:173], v[172:173], v[80:81]
v_pk_mul_f32 v[174:175], v[174:175], v[82:83]
v_cvt_pk_bf16_f32 v124, v140, v141
v_cvt_pk_bf16_f32 v125, v142, v143
v_cvt_pk_bf16_f32 v156, v172, v173
v_cvt_pk_bf16_f32 v157, v174, v175
v_pk_fma_f32 v[128:129], v[60:61], v[32:33], v[128:129] op_sel_hi:[0,1,1] neg_lo:[1,0,0] neg_hi:[1,0,0]
v_pk_fma_f32 v[130:131], v[60:61], v[34:35], v[130:131] op_sel_hi:[0,1,1] neg_lo:[1,0,0] neg_hi:[1,0,0]
v_pk_fma_f32 v[160:161], v[62:63], v[32:33], v[160:161] op_sel_hi:[0,1,1] neg_lo:[1,0,0] neg_hi:[1,0,0]
v_pk_fma_f32 v[162:163], v[62:63], v[34:35], v[162:163] op_sel_hi:[0,1,1] neg_lo:[1,0,0] neg_hi:[1,0,0]
v_pk_mul_f32 v[76:77], v[128:129], v[128:129]
v_pk_mul_f32 v[78:79], v[130:131], v[130:131]
v_pk_mul_f32 v[80:81], v[160:161], v[160:161]
v_pk_mul_f32 v[82:83], v[162:163], v[162:163]
v_pk_fma_f32 v[76:77], v[76:77], v[68:69], v[68:69] op_sel:[0,1,0] op_sel_hi:[1,1,0]
v_pk_fma_f32 v[78:79], v[78:79], v[68:69], v[68:69] op_sel:[0,1,0] op_sel_hi:[1,1,0]
v_pk_fma_f32 v[80:81], v[80:81], v[72:73], v[72:73] op_sel:[0,1,0] op_sel_hi:[1,1,0]
v_pk_fma_f32 v[82:83], v[82:83], v[72:73], v[72:73] op_sel:[0,1,0] op_sel_hi:[1,1,0]
v_pk_mul_f32 v[76:77], v[76:77], v[128:129]
v_pk_mul_f32 v[78:79], v[78:79], v[130:131]
v_pk_mul_f32 v[80:81], v[80:81], v[160:161]
v_pk_mul_f32 v[82:83], v[82:83], v[162:163]
v_exp_f32 v76, v76
v_exp_f32 v77, v77
v_exp_f32 v78, v78
v_exp_f32 v79, v79
v_exp_f32 v80, v80
v_exp_f32 v81, v81
v_exp_f32 v82, v82
v_exp_f32 v83, v83
v_pk_fma_f32 v[144:145], v[60:61], v[48:49], v[144:145] op_sel_hi:[0,1,1] neg_lo:[1,0,0] neg_hi:[1,0,0]
v_pk_fma_f32 v[146:147], v[60:61], v[50:51], v[146:147] op_sel_hi:[0,1,1] neg_lo:[1,0,0] neg_hi:[1,0,0]
v_pk_fma_f32 v[176:177], v[62:63], v[48:49], v[176:177] op_sel_hi:[0,1,1] neg_lo:[1,0,0] neg_hi:[1,0,0]
v_pk_fma_f32 v[178:179], v[62:63], v[50:51], v[178:179] op_sel_hi:[0,1,1] neg_lo:[1,0,0] neg_hi:[1,0,0]
v_pk_fma_f32 v[76:77], v[76:77], v[70:71], v[70:71] op_sel_hi:[1,0,0]
v_pk_fma_f32 v[78:79], v[78:79], v[70:71], v[70:71] op_sel_hi:[1,0,0]
v_pk_fma_f32 v[80:81], v[80:81], v[74:75], v[74:75] op_sel_hi:[1,0,0]
v_pk_fma_f32 v[82:83], v[82:83], v[74:75], v[74:75] op_sel_hi:[1,0,0]
v_rcp_f32 v76, v76
v_rcp_f32 v77, v77
v_rcp_f32 v78, v78
v_rcp_f32 v79, v79
v_rcp_f32 v80, v80
v_rcp_f32 v81, v81
v_rcp_f32 v82, v82
v_rcp_f32 v83, v83
v_pk_mul_f32 v[144:145], v[128:129], v[144:145]
v_pk_mul_f32 v[146:147], v[130:131], v[146:147]
v_pk_mul_f32 v[176:177], v[160:161], v[176:177]
v_pk_mul_f32 v[178:179], v[162:163], v[178:179]
v_pk_mul_f32 v[144:145], v[144:145], v[76:77]
v_pk_mul_f32 v[146:147], v[146:147], v[78:79]
v_pk_mul_f32 v[176:177], v[176:177], v[80:81]
v_pk_mul_f32 v[178:179], v[178:179], v[82:83]
v_cvt_pk_bf16_f32 v126, v144, v145
v_cvt_pk_bf16_f32 v127, v146, v147
v_cvt_pk_bf16_f32 v158, v176, v177
v_cvt_pk_bf16_f32 v159, v178, v179
buffer_store_dwordx4 v[124:127], v2, s[24:27], s54 offen offset:0 sc1
buffer_store_dwordx4 v[156:159], v2, s[24:27], s54 offen offset:1024 sc1
v_pk_fma_f32 v[132:133], v[60:61], v[36:37], v[132:133] op_sel_hi:[0,1,1] neg_lo:[1,0,0] neg_hi:[1,0,0]
v_pk_fma_f32 v[134:135], v[60:61], v[38:39], v[134:135] op_sel_hi:[0,1,1] neg_lo:[1,0,0] neg_hi:[1,0,0]
v_pk_fma_f32 v[164:165], v[62:63], v[36:37], v[164:165] op_sel_hi:[0,1,1] neg_lo:[1,0,0] neg_hi:[1,0,0]
v_pk_fma_f32 v[166:167], v[62:63], v[38:39], v[166:167] op_sel_hi:[0,1,1] neg_lo:[1,0,0] neg_hi:[1,0,0]
v_pk_mul_f32 v[76:77], v[132:133], v[132:133]
v_pk_mul_f32 v[78:79], v[134:135], v[134:135]
v_pk_mul_f32 v[80:81], v[164:165], v[164:165]
v_pk_mul_f32 v[82:83], v[166:167], v[166:167]
v_pk_fma_f32 v[76:77], v[76:77], v[68:69], v[68:69] op_sel:[0,1,0] op_sel_hi:[1,1,0]
v_pk_fma_f32 v[78:79], v[78:79], v[68:69], v[68:69] op_sel:[0,1,0] op_sel_hi:[1,1,0]
v_pk_fma_f32 v[80:81], v[80:81], v[72:73], v[72:73] op_sel:[0,1,0] op_sel_hi:[1,1,0]
v_pk_fma_f32 v[82:83], v[82:83], v[72:73], v[72:73] op_sel:[0,1,0] op_sel_hi:[1,1,0]
v_pk_mul_f32 v[76:77], v[76:77], v[132:133]
v_pk_mul_f32 v[78:79], v[78:79], v[134:135]
v_pk_mul_f32 v[80:81], v[80:81], v[164:165]
v_pk_mul_f32 v[82:83], v[82:83], v[166:167]
v_exp_f32 v76, v76
v_exp_f32 v77, v77
v_exp_f32 v78, v78
v_exp_f32 v79, v79
v_exp_f32 v80, v80
v_exp_f32 v81, v81
v_exp_f32 v82, v82
v_exp_f32 v83, v83
v_pk_fma_f32 v[148:149], v[60:61], v[52:53], v[148:149] op_sel_hi:[0,1,1] neg_lo:[1,0,0] neg_hi:[1,0,0]
v_pk_fma_f32 v[150:151], v[60:61], v[54:55], v[150:151] op_sel_hi:[0,1,1] neg_lo:[1,0,0] neg_hi:[1,0,0]
v_pk_fma_f32 v[180:181], v[62:63], v[52:53], v[180:181] op_sel_hi:[0,1,1] neg_lo:[1,0,0] neg_hi:[1,0,0]
v_pk_fma_f32 v[182:183], v[62:63], v[54:55], v[182:183] op_sel_hi:[0,1,1] neg_lo:[1,0,0] neg_hi:[1,0,0]
v_pk_fma_f32 v[76:77], v[76:77], v[70:71], v[70:71] op_sel_hi:[1,0,0]
v_pk_fma_f32 v[78:79], v[78:79], v[70:71], v[70:71] op_sel_hi:[1,0,0]
v_pk_fma_f32 v[80:81], v[80:81], v[74:75], v[74:75] op_sel_hi:[1,0,0]
v_pk_fma_f32 v[82:83], v[82:83], v[74:75], v[74:75] op_sel_hi:[1,0,0]
v_rcp_f32 v76, v76
v_rcp_f32 v77, v77
v_rcp_f32 v78, v78
v_rcp_f32 v79, v79
v_rcp_f32 v80, v80
v_rcp_f32 v81, v81
v_rcp_f32 v82, v82
v_rcp_f32 v83, v83
v_pk_mul_f32 v[148:149], v[132:133], v[148:149]
v_pk_mul_f32 v[150:151], v[134:135], v[150:151]
v_pk_mul_f32 v[180:181], v[164:165], v[180:181]
v_pk_mul_f32 v[182:183], v[166:167], v[182:183]
v_pk_mul_f32 v[148:149], v[148:149], v[76:77]
v_pk_mul_f32 v[150:151], v[150:151], v[78:79]
v_pk_mul_f32 v[180:181], v[180:181], v[80:81]
v_pk_mul_f32 v[182:183], v[182:183], v[82:83]
v_cvt_pk_bf16_f32 v132, v148, v149
v_cvt_pk_bf16_f32 v133, v150, v151
v_cvt_pk_bf16_f32 v164, v180, v181
v_cvt_pk_bf16_f32 v165, v182, v183
v_pk_fma_f32 v[136:137], v[60:61], v[40:41], v[136:137] op_sel_hi:[0,1,1] neg_lo:[1,0,0] neg_hi:[1,0,0]
v_pk_fma_f32 v[138:139], v[60:61], v[42:43], v[138:139] op_sel_hi:[0,1,1] neg_lo:[1,0,0] neg_hi:[1,0,0]
v_pk_fma_f32 v[168:169], v[62:63], v[40:41], v[168:169] op_sel_hi:[0,1,1] neg_lo:[1,0,0] neg_hi:[1,0,0]
v_pk_fma_f32 v[170:171], v[62:63], v[42:43], v[170:171] op_sel_hi:[0,1,1] neg_lo:[1,0,0] neg_hi:[1,0,0]
v_pk_mul_f32 v[76:77], v[136:137], v[136:137]
v_pk_mul_f32 v[78:79], v[138:139], v[138:139]
v_pk_mul_f32 v[80:81], v[168:169], v[168:169]
v_pk_mul_f32 v[82:83], v[170:171], v[170:171]
v_pk_fma_f32 v[76:77], v[76:77], v[68:69], v[68:69] op_sel:[0,1,0] op_sel_hi:[1,1,0]
v_pk_fma_f32 v[78:79], v[78:79], v[68:69], v[68:69] op_sel:[0,1,0] op_sel_hi:[1,1,0]
v_pk_fma_f32 v[80:81], v[80:81], v[72:73], v[72:73] op_sel:[0,1,0] op_sel_hi:[1,1,0]
v_pk_fma_f32 v[82:83], v[82:83], v[72:73], v[72:73] op_sel:[0,1,0] op_sel_hi:[1,1,0]
v_pk_mul_f32 v[76:77], v[76:77], v[136:137]
v_pk_mul_f32 v[78:79], v[78:79], v[138:139]
v_pk_mul_f32 v[80:81], v[80:81], v[168:169]
v_pk_mul_f32 v[82:83], v[82:83], v[170:171]
v_exp_f32 v76, v76
v_exp_f32 v77, v77
v_exp_f32 v78, v78
v_exp_f32 v79, v79
v_exp_f32 v80, v80
v_exp_f32 v81, v81
v_exp_f32 v82, v82
v_exp_f32 v83, v83
v_pk_fma_f32 v[152:153], v[60:61], v[56:57], v[152:153] op_sel_hi:[0,1,1] neg_lo:[1,0,0] neg_hi:[1,0,0]
v_pk_fma_f32 v[154:155], v[60:61], v[58:59], v[154:155] op_sel_hi:[0,1,1] neg_lo:[1,0,0] neg_hi:[1,0,0]
v_pk_fma_f32 v[184:185], v[62:63], v[56:57], v[184:185] op_sel_hi:[0,1,1] neg_lo:[1,0,0] neg_hi:[1,0,0]
v_pk_fma_f32 v[186:187], v[62:63], v[58:59], v[186:187] op_sel_hi:[0,1,1] neg_lo:[1,0,0] neg_hi:[1,0,0]
v_pk_fma_f32 v[76:77], v[76:77], v[70:71], v[70:71] op_sel_hi:[1,0,0]
v_pk_fma_f32 v[78:79], v[78:79], v[70:71], v[70:71] op_sel_hi:[1,0,0]
v_pk_fma_f32 v[80:81], v[80:81], v[74:75], v[74:75] op_sel_hi:[1,0,0]
v_pk_fma_f32 v[82:83], v[82:83], v[74:75], v[74:75] op_sel_hi:[1,0,0]
v_rcp_f32 v76, v76
v_rcp_f32 v77, v77
v_rcp_f32 v78, v78
v_rcp_f32 v79, v79
v_rcp_f32 v80, v80
v_rcp_f32 v81, v81
v_rcp_f32 v82, v82
v_rcp_f32 v83, v83
v_pk_mul_f32 v[152:153], v[136:137], v[152:153]
v_pk_mul_f32 v[154:155], v[138:139], v[154:155]
v_pk_mul_f32 v[184:185], v[168:169], v[184:185]
v_pk_mul_f32 v[186:187], v[170:171], v[186:187]
v_pk_mul_f32 v[152:153], v[152:153], v[76:77]
v_pk_mul_f32 v[154:155], v[154:155], v[78:79]
v_pk_mul_f32 v[184:185], v[184:185], v[80:81]
v_pk_mul_f32 v[186:187], v[186:187], v[82:83]
v_cvt_pk_bf16_f32 v134, v152, v153
v_cvt_pk_bf16_f32 v135, v154, v155
v_cvt_pk_bf16_f32 v166, v184, v185
v_cvt_pk_bf16_f32 v167, v186, v187
buffer_store_dwordx4 v[132:135], v2, s[24:27], s55 offen offset:0 sc1
buffer_store_dwordx4 v[164:167], v2, s[24:27], s55 offen offset:1024 sc1
v_mul_f32 v70, v65, v65
v_mul_f32 v68, 0xc0135761, v65
v_mul_f32 v69, 0xbdd2d3e8, v65
v_mul_f32 v69, v69, v70
v_rcp_f32 v70, v70
v_mul_f32 v74, v67, v67
v_mul_f32 v72, 0xc0135761, v67
v_mul_f32 v73, 0xbdd2d3e8, v67
v_mul_f32 v73, v73, v74
v_rcp_f32 v74, v74
v_pk_fma_f32 v[188:189], v[64:65], v[28:29], v[188:189] op_sel_hi:[0,1,1] neg_lo:[1,0,0] neg_hi:[1,0,0]
v_pk_fma_f32 v[190:191], v[64:65], v[30:31], v[190:191] op_sel_hi:[0,1,1] neg_lo:[1,0,0] neg_hi:[1,0,0]
v_pk_fma_f32 v[220:221], v[66:67], v[28:29], v[220:221] op_sel_hi:[0,1,1] neg_lo:[1,0,0] neg_hi:[1,0,0]
v_pk_fma_f32 v[222:223], v[66:67], v[30:31], v[222:223] op_sel_hi:[0,1,1] neg_lo:[1,0,0] neg_hi:[1,0,0]
v_pk_mul_f32 v[76:77], v[188:189], v[188:189]
v_pk_mul_f32 v[78:79], v[190:191], v[190:191]
v_pk_mul_f32 v[80:81], v[220:221], v[220:221]
v_pk_mul_f32 v[82:83], v[222:223], v[222:223]
v_pk_fma_f32 v[76:77], v[76:77], v[68:69], v[68:69] op_sel:[0,1,0] op_sel_hi:[1,1,0]
v_pk_fma_f32 v[78:79], v[78:79], v[68:69], v[68:69] op_sel:[0,1,0] op_sel_hi:[1,1,0]
v_pk_fma_f32 v[80:81], v[80:81], v[72:73], v[72:73] op_sel:[0,1,0] op_sel_hi:[1,1,0]
v_pk_fma_f32 v[82:83], v[82:83], v[72:73], v[72:73] op_sel:[0,1,0] op_sel_hi:[1,1,0]
v_pk_mul_f32 v[76:77], v[76:77], v[188:189]
v_pk_mul_f32 v[78:79], v[78:79], v[190:191]
v_pk_mul_f32 v[80:81], v[80:81], v[220:221]
v_pk_mul_f32 v[82:83], v[82:83], v[222:223]
v_exp_f32 v76, v76
v_exp_f32 v77, v77
v_exp_f32 v78, v78
v_exp_f32 v79, v79
v_exp_f32 v80, v80
v_exp_f32 v81, v81
v_exp_f32 v82, v82
v_exp_f32 v83, v83
v_pk_fma_f32 v[204:205], v[64:65], v[44:45], v[204:205] op_sel_hi:[0,1,1] neg_lo:[1,0,0] neg_hi:[1,0,0]
v_pk_fma_f32 v[206:207], v[64:65], v[46:47], v[206:207] op_sel_hi:[0,1,1] neg_lo:[1,0,0] neg_hi:[1,0,0]
v_pk_fma_f32 v[236:237], v[66:67], v[44:45], v[236:237] op_sel_hi:[0,1,1] neg_lo:[1,0,0] neg_hi:[1,0,0]
v_pk_fma_f32 v[238:239], v[66:67], v[46:47], v[238:239] op_sel_hi:[0,1,1] neg_lo:[1,0,0] neg_hi:[1,0,0]
v_pk_fma_f32 v[76:77], v[76:77], v[70:71], v[70:71] op_sel_hi:[1,0,0]
v_pk_fma_f32 v[78:79], v[78:79], v[70:71], v[70:71] op_sel_hi:[1,0,0]
v_pk_fma_f32 v[80:81], v[80:81], v[74:75], v[74:75] op_sel_hi:[1,0,0]
v_pk_fma_f32 v[82:83], v[82:83], v[74:75], v[74:75] op_sel_hi:[1,0,0]
v_rcp_f32 v76, v76
v_rcp_f32 v77, v77
v_rcp_f32 v78, v78
v_rcp_f32 v79, v79
v_rcp_f32 v80, v80
v_rcp_f32 v81, v81
v_rcp_f32 v82, v82
v_rcp_f32 v83, v83
v_pk_mul_f32 v[204:205], v[188:189], v[204:205]
v_pk_mul_f32 v[206:207], v[190:191], v[206:207]
v_pk_mul_f32 v[236:237], v[220:221], v[236:237]
v_pk_mul_f32 v[238:239], v[222:223], v[238:239]
v_pk_mul_f32 v[204:205], v[204:205], v[76:77]
v_pk_mul_f32 v[206:207], v[206:207], v[78:79]
v_pk_mul_f32 v[236:237], v[236:237], v[80:81]
v_pk_mul_f32 v[238:239], v[238:239], v[82:83]
v_cvt_pk_bf16_f32 v188, v204, v205
v_cvt_pk_bf16_f32 v189, v206, v207
v_cvt_pk_bf16_f32 v220, v236, v237
v_cvt_pk_bf16_f32 v221, v238, v239
v_pk_fma_f32 v[192:193], v[64:65], v[32:33], v[192:193] op_sel_hi:[0,1,1] neg_lo:[1,0,0] neg_hi:[1,0,0]
v_pk_fma_f32 v[194:195], v[64:65], v[34:35], v[194:195] op_sel_hi:[0,1,1] neg_lo:[1,0,0] neg_hi:[1,0,0]
v_pk_fma_f32 v[224:225], v[66:67], v[32:33], v[224:225] op_sel_hi:[0,1,1] neg_lo:[1,0,0] neg_hi:[1,0,0]
v_pk_fma_f32 v[226:227], v[66:67], v[34:35], v[226:227] op_sel_hi:[0,1,1] neg_lo:[1,0,0] neg_hi:[1,0,0]
v_pk_mul_f32 v[76:77], v[192:193], v[192:193]
v_pk_mul_f32 v[78:79], v[194:195], v[194:195]
v_pk_mul_f32 v[80:81], v[224:225], v[224:225]
v_pk_mul_f32 v[82:83], v[226:227], v[226:227]
v_pk_fma_f32 v[76:77], v[76:77], v[68:69], v[68:69] op_sel:[0,1,0] op_sel_hi:[1,1,0]
v_pk_fma_f32 v[78:79], v[78:79], v[68:69], v[68:69] op_sel:[0,1,0] op_sel_hi:[1,1,0]
v_pk_fma_f32 v[80:81], v[80:81], v[72:73], v[72:73] op_sel:[0,1,0] op_sel_hi:[1,1,0]
v_pk_fma_f32 v[82:83], v[82:83], v[72:73], v[72:73] op_sel:[0,1,0] op_sel_hi:[1,1,0]
v_pk_mul_f32 v[76:77], v[76:77], v[192:193]
v_pk_mul_f32 v[78:79], v[78:79], v[194:195]
v_pk_mul_f32 v[80:81], v[80:81], v[224:225]
v_pk_mul_f32 v[82:83], v[82:83], v[226:227]
v_exp_f32 v76, v76
v_exp_f32 v77, v77
v_exp_f32 v78, v78
v_exp_f32 v79, v79
v_exp_f32 v80, v80
v_exp_f32 v81, v81
v_exp_f32 v82, v82
v_exp_f32 v83, v83
v_pk_fma_f32 v[208:209], v[64:65], v[48:49], v[208:209] op_sel_hi:[0,1,1] neg_lo:[1,0,0] neg_hi:[1,0,0]
v_pk_fma_f32 v[210:211], v[64:65], v[50:51], v[210:211] op_sel_hi:[0,1,1] neg_lo:[1,0,0] neg_hi:[1,0,0]
v_pk_fma_f32 v[240:241], v[66:67], v[48:49], v[240:241] op_sel_hi:[0,1,1] neg_lo:[1,0,0] neg_hi:[1,0,0]
v_pk_fma_f32 v[242:243], v[66:67], v[50:51], v[242:243] op_sel_hi:[0,1,1] neg_lo:[1,0,0] neg_hi:[1,0,0]
v_pk_fma_f32 v[76:77], v[76:77], v[70:71], v[70:71] op_sel_hi:[1,0,0]
v_pk_fma_f32 v[78:79], v[78:79], v[70:71], v[70:71] op_sel_hi:[1,0,0]
v_pk_fma_f32 v[80:81], v[80:81], v[74:75], v[74:75] op_sel_hi:[1,0,0]
v_pk_fma_f32 v[82:83], v[82:83], v[74:75], v[74:75] op_sel_hi:[1,0,0]
v_rcp_f32 v76, v76
v_rcp_f32 v77, v77
v_rcp_f32 v78, v78
v_rcp_f32 v79, v79
v_rcp_f32 v80, v80
v_rcp_f32 v81, v81
v_rcp_f32 v82, v82
v_rcp_f32 v83, v83
v_pk_mul_f32 v[208:209], v[192:193], v[208:209]
v_pk_mul_f32 v[210:211], v[194:195], v[210:211]
v_pk_mul_f32 v[240:241], v[224:225], v[240:241]
v_pk_mul_f32 v[242:243], v[226:227], v[242:243]
v_pk_mul_f32 v[208:209], v[208:209], v[76:77]
v_pk_mul_f32 v[210:211], v[210:211], v[78:79]
v_pk_mul_f32 v[240:241], v[240:241], v[80:81]
v_pk_mul_f32 v[242:243], v[242:243], v[82:83]
v_cvt_pk_bf16_f32 v190, v208, v209
v_cvt_pk_bf16_f32 v191, v210, v211
v_cvt_pk_bf16_f32 v222, v240, v241
v_cvt_pk_bf16_f32 v223, v242, v243
buffer_store_dwordx4 v[188:191], v2, s[24:27], s54 offen offset:2048 sc1
buffer_store_dwordx4 v[220:223], v2, s[24:27], s54 offen offset:3072 sc1
v_pk_fma_f32 v[196:197], v[64:65], v[36:37], v[196:197] op_sel_hi:[0,1,1] neg_lo:[1,0,0] neg_hi:[1,0,0]
v_pk_fma_f32 v[198:199], v[64:65], v[38:39], v[198:199] op_sel_hi:[0,1,1] neg_lo:[1,0,0] neg_hi:[1,0,0]
v_pk_fma_f32 v[228:229], v[66:67], v[36:37], v[228:229] op_sel_hi:[0,1,1] neg_lo:[1,0,0] neg_hi:[1,0,0]
v_pk_fma_f32 v[230:231], v[66:67], v[38:39], v[230:231] op_sel_hi:[0,1,1] neg_lo:[1,0,0] neg_hi:[1,0,0]
v_pk_mul_f32 v[76:77], v[196:197], v[196:197]
v_pk_mul_f32 v[78:79], v[198:199], v[198:199]
v_pk_mul_f32 v[80:81], v[228:229], v[228:229]
v_pk_mul_f32 v[82:83], v[230:231], v[230:231]
v_pk_fma_f32 v[76:77], v[76:77], v[68:69], v[68:69] op_sel:[0,1,0] op_sel_hi:[1,1,0]
v_pk_fma_f32 v[78:79], v[78:79], v[68:69], v[68:69] op_sel:[0,1,0] op_sel_hi:[1,1,0]
v_pk_fma_f32 v[80:81], v[80:81], v[72:73], v[72:73] op_sel:[0,1,0] op_sel_hi:[1,1,0]
v_pk_fma_f32 v[82:83], v[82:83], v[72:73], v[72:73] op_sel:[0,1,0] op_sel_hi:[1,1,0]
v_pk_mul_f32 v[76:77], v[76:77], v[196:197]
v_pk_mul_f32 v[78:79], v[78:79], v[198:199]
v_pk_mul_f32 v[80:81], v[80:81], v[228:229]
v_pk_mul_f32 v[82:83], v[82:83], v[230:231]
v_exp_f32 v76, v76
v_exp_f32 v77, v77
v_exp_f32 v78, v78
v_exp_f32 v79, v79
v_exp_f32 v80, v80
v_exp_f32 v81, v81
v_exp_f32 v82, v82
v_exp_f32 v83, v83
v_pk_fma_f32 v[212:213], v[64:65], v[52:53], v[212:213] op_sel_hi:[0,1,1] neg_lo:[1,0,0] neg_hi:[1,0,0]
v_pk_fma_f32 v[214:215], v[64:65], v[54:55], v[214:215] op_sel_hi:[0,1,1] neg_lo:[1,0,0] neg_hi:[1,0,0]
v_pk_fma_f32 v[244:245], v[66:67], v[52:53], v[244:245] op_sel_hi:[0,1,1] neg_lo:[1,0,0] neg_hi:[1,0,0]
v_pk_fma_f32 v[246:247], v[66:67], v[54:55], v[246:247] op_sel_hi:[0,1,1] neg_lo:[1,0,0] neg_hi:[1,0,0]
v_pk_fma_f32 v[76:77], v[76:77], v[70:71], v[70:71] op_sel_hi:[1,0,0]
v_pk_fma_f32 v[78:79], v[78:79], v[70:71], v[70:71] op_sel_hi:[1,0,0]
v_pk_fma_f32 v[80:81], v[80:81], v[74:75], v[74:75] op_sel_hi:[1,0,0]
v_pk_fma_f32 v[82:83], v[82:83], v[74:75], v[74:75] op_sel_hi:[1,0,0]
v_rcp_f32 v76, v76
v_rcp_f32 v77, v77
v_rcp_f32 v78, v78
v_rcp_f32 v79, v79
v_rcp_f32 v80, v80
v_rcp_f32 v81, v81
v_rcp_f32 v82, v82
v_rcp_f32 v83, v83
v_pk_mul_f32 v[212:213], v[196:197], v[212:213]
v_pk_mul_f32 v[214:215], v[198:199], v[214:215]
v_pk_mul_f32 v[244:245], v[228:229], v[244:245]
v_pk_mul_f32 v[246:247], v[230:231], v[246:247]
v_pk_mul_f32 v[212:213], v[212:213], v[76:77]
v_pk_mul_f32 v[214:215], v[214:215], v[78:79]
v_pk_mul_f32 v[244:245], v[244:245], v[80:81]
v_pk_mul_f32 v[246:247], v[246:247], v[82:83]
v_cvt_pk_bf16_f32 v196, v212, v213
v_cvt_pk_bf16_f32 v197, v214, v215
v_cvt_pk_bf16_f32 v228, v244, v245
v_cvt_pk_bf16_f32 v229, v246, v247
v_pk_fma_f32 v[200:201], v[64:65], v[40:41], v[200:201] op_sel_hi:[0,1,1] neg_lo:[1,0,0] neg_hi:[1,0,0]
v_pk_fma_f32 v[202:203], v[64:65], v[42:43], v[202:203] op_sel_hi:[0,1,1] neg_lo:[1,0,0] neg_hi:[1,0,0]
v_pk_fma_f32 v[232:233], v[66:67], v[40:41], v[232:233] op_sel_hi:[0,1,1] neg_lo:[1,0,0] neg_hi:[1,0,0]
v_pk_fma_f32 v[234:235], v[66:67], v[42:43], v[234:235] op_sel_hi:[0,1,1] neg_lo:[1,0,0] neg_hi:[1,0,0]
v_pk_mul_f32 v[76:77], v[200:201], v[200:201]
v_pk_mul_f32 v[78:79], v[202:203], v[202:203]
v_pk_mul_f32 v[80:81], v[232:233], v[232:233]
v_pk_mul_f32 v[82:83], v[234:235], v[234:235]
v_pk_fma_f32 v[76:77], v[76:77], v[68:69], v[68:69] op_sel:[0,1,0] op_sel_hi:[1,1,0]
v_pk_fma_f32 v[78:79], v[78:79], v[68:69], v[68:69] op_sel:[0,1,0] op_sel_hi:[1,1,0]
v_pk_fma_f32 v[80:81], v[80:81], v[72:73], v[72:73] op_sel:[0,1,0] op_sel_hi:[1,1,0]
v_pk_fma_f32 v[82:83], v[82:83], v[72:73], v[72:73] op_sel:[0,1,0] op_sel_hi:[1,1,0]
v_pk_mul_f32 v[76:77], v[76:77], v[200:201]
v_pk_mul_f32 v[78:79], v[78:79], v[202:203]
v_pk_mul_f32 v[80:81], v[80:81], v[232:233]
v_pk_mul_f32 v[82:83], v[82:83], v[234:235]
v_exp_f32 v76, v76
v_exp_f32 v77, v77
v_exp_f32 v78, v78
v_exp_f32 v79, v79
v_exp_f32 v80, v80
v_exp_f32 v81, v81
v_exp_f32 v82, v82
v_exp_f32 v83, v83
v_pk_fma_f32 v[216:217], v[64:65], v[56:57], v[216:217] op_sel_hi:[0,1,1] neg_lo:[1,0,0] neg_hi:[1,0,0]
v_pk_fma_f32 v[218:219], v[64:65], v[58:59], v[218:219] op_sel_hi:[0,1,1] neg_lo:[1,0,0] neg_hi:[1,0,0]
v_pk_fma_f32 v[248:249], v[66:67], v[56:57], v[248:249] op_sel_hi:[0,1,1] neg_lo:[1,0,0] neg_hi:[1,0,0]
v_pk_fma_f32 v[250:251], v[66:67], v[58:59], v[250:251] op_sel_hi:[0,1,1] neg_lo:[1,0,0] neg_hi:[1,0,0]
v_pk_fma_f32 v[76:77], v[76:77], v[70:71], v[70:71] op_sel_hi:[1,0,0]
v_pk_fma_f32 v[78:79], v[78:79], v[70:71], v[70:71] op_sel_hi:[1,0,0]
v_pk_fma_f32 v[80:81], v[80:81], v[74:75], v[74:75] op_sel_hi:[1,0,0]
v_pk_fma_f32 v[82:83], v[82:83], v[74:75], v[74:75] op_sel_hi:[1,0,0]
v_rcp_f32 v76, v76
v_rcp_f32 v77, v77
v_rcp_f32 v78, v78
v_rcp_f32 v79, v79
v_rcp_f32 v80, v80
v_rcp_f32 v81, v81
v_rcp_f32 v82, v82
v_rcp_f32 v83, v83
v_pk_mul_f32 v[216:217], v[200:201], v[216:217]
v_pk_mul_f32 v[218:219], v[202:203], v[218:219]
v_pk_mul_f32 v[248:249], v[232:233], v[248:249]
v_pk_mul_f32 v[250:251], v[234:235], v[250:251]
v_pk_mul_f32 v[216:217], v[216:217], v[76:77]
v_pk_mul_f32 v[218:219], v[218:219], v[78:79]
v_pk_mul_f32 v[248:249], v[248:249], v[80:81]
v_pk_mul_f32 v[250:251], v[250:251], v[82:83]
v_cvt_pk_bf16_f32 v198, v216, v217
v_cvt_pk_bf16_f32 v199, v218, v219
v_cvt_pk_bf16_f32 v230, v248, v249
v_cvt_pk_bf16_f32 v231, v250, v251
buffer_store_dwordx4 v[196:199], v2, s[24:27], s55 offen offset:2048 sc1
buffer_store_dwordx4 v[228:231], v2, s[24:27], s55 offen offset:3072 sc1
s_barrier
s_add_u32 s37, s52, 589824
s_add_u32 m0, s39, 81920
s_nop 0
buffer_load_dwordx4 v3, s[24:27], s37 offen sc1 lds
buffer_load_dwordx4 v3, s[24:27], s37 offen offset:1024 sc1 lds
buffer_load_dwordx4 v3, s[24:27], s37 offen offset:2048 sc1 lds
buffer_load_dwordx4 v3, s[24:27], s37 offen offset:3072 sc1 lds
s_add_u32 s38, s53, 4718592
s_add_u32 m0, s39, 147456
s_nop 0
buffer_load_dwordx4 v23, s[28:31], s38 offen lds
s_add_u32 m0, s39, 148480
s_nop 0
buffer_load_dwordx4 v24, s[28:31], s38 offen lds
s_add_u32 m0, s39, 149504
s_add_u32 s38, s38, 16384
buffer_load_dwordx4 v23, s[28:31], s38 offen lds
s_add_u32 m0, s39, 150528
s_nop 0
buffer_load_dwordx4 v24, s[28:31], s38 offen lds
s_add_u32 s37, s52, 606208
s_add_u32 m0, s39, 98304
s_nop 0
buffer_load_dwordx4 v3, s[24:27], s37 offen sc1 lds
buffer_load_dwordx4 v3, s[24:27], s37 offen offset:1024 sc1 lds
buffer_load_dwordx4 v3, s[24:27], s37 offen offset:2048 sc1 lds
buffer_load_dwordx4 v3, s[24:27], s37 offen offset:3072 sc1 lds
s_add_u32 s38, s53, 4849664
s_add_u32 m0, s39, 114688
s_nop 0
buffer_load_dwordx4 v23, s[28:31], s38 offen lds
s_add_u32 m0, s39, 115712
s_nop 0
buffer_load_dwordx4 v24, s[28:31], s38 offen lds
s_add_u32 m0, s39, 116736
s_add_u32 s38, s38, 16384
buffer_load_dwordx4 v23, s[28:31], s38 offen lds
s_add_u32 m0, s39, 117760
s_nop 0
buffer_load_dwordx4 v24, s[28:31], s38 offen lds
s_barrier
s_add_u32 s37, s52, 622592
s_add_u32 m0, s39, 131072
s_nop 0
buffer_load_dwordx4 v3, s[24:27], s37 offen sc1 lds
buffer_load_dwordx4 v3, s[24:27], s37 offen offset:1024 sc1 lds
buffer_load_dwordx4 v3, s[24:27], s37 offen offset:2048 sc1 lds
buffer_load_dwordx4 v3, s[24:27], s37 offen offset:3072 sc1 lds
s_add_u32 s38, s53, 4980736
s_add_u32 m0, s39, 0
s_nop 0
buffer_load_dwordx4 v23, s[28:31], s38 offen lds
s_add_u32 m0, s39, 1024
s_nop 0
buffer_load_dwordx4 v24, s[28:31], s38 offen lds
s_add_u32 m0, s39, 2048
s_add_u32 s38, s38, 16384
buffer_load_dwordx4 v23, s[28:31], s38 offen lds
s_add_u32 m0, s39, 3072
s_nop 0
buffer_load_dwordx4 v24, s[28:31], s38 offen lds
s_waitcnt vmcnt(24)
s_barrier
s_cmp_eq_u32 s47, 0
s_cbranch_scc0 Lw_148
s_add_u32 s7, s34, 48
s_lshl_b32 s7, s7, 7
v_mov_b32 v26, s7
v_mov_b32 v27, 1
s_mov_b64 exec, 1
buffer_atomic_add v27, v26, s[56:59], 0 offen sc1
s_mov_b64 exec, -1
Lw_148:
s_add_u32 s37, s52, 638976
s_add_u32 m0, s39, 16384
s_nop 0
buffer_load_dwordx4 v3, s[24:27], s37 offen sc1 lds
buffer_load_dwordx4 v3, s[24:27], s37 offen offset:1024 sc1 lds
buffer_load_dwordx4 v3, s[24:27], s37 offen offset:2048 sc1 lds
buffer_load_dwordx4 v3, s[24:27], s37 offen offset:3072 sc1 lds
s_add_u32 s38, s53, 5111808
s_add_u32 m0, s39, 32768
s_nop 0
buffer_load_dwordx4 v23, s[28:31], s38 offen lds
s_add_u32 m0, s39, 33792
s_nop 0
buffer_load_dwordx4 v24, s[28:31], s38 offen lds
s_add_u32 m0, s39, 34816
s_add_u32 s38, s38, 16384
buffer_load_dwordx4 v23, s[28:31], s38 offen lds
s_add_u32 m0, s39, 35840
s_nop 0
buffer_load_dwordx4 v24, s[28:31], s38 offen lds
s_waitcnt vmcnt(24)
s_barrier
s_add_u32 s37, s52, 655360
s_add_u32 m0, s39, 49152
s_nop 0
buffer_load_dwordx4 v3, s[24:27], s37 offen sc1 lds
buffer_load_dwordx4 v3, s[24:27], s37 offen offset:1024 sc1 lds
buffer_load_dwordx4 v3, s[24:27], s37 offen offset:2048 sc1 lds
buffer_load_dwordx4 v3, s[24:27], s37 offen offset:3072 sc1 lds
s_add_u32 s38, s53, 5242880
s_add_u32 m0, s39, 65536
s_nop 0
buffer_load_dwordx4 v23, s[28:31], s38 offen lds
s_add_u32 m0, s39, 66560
s_nop 0
buffer_load_dwordx4 v24, s[28:31], s38 offen lds
s_add_u32 m0, s39, 67584
s_add_u32 s38, s38, 16384
buffer_load_dwordx4 v23, s[28:31], s38 offen lds
s_add_u32 m0, s39, 68608
s_nop 0
buffer_load_dwordx4 v24, s[28:31], s38 offen lds
s_waitcnt vmcnt(24)
s_barrier
s_add_u32 s37, s52, 671744
s_add_u32 m0, s39, 81920
s_nop 0
buffer_load_dwordx4 v3, s[24:27], s37 offen sc1 lds
buffer_load_dwordx4 v3, s[24:27], s37 offen offset:1024 sc1 lds
buffer_load_dwordx4 v3, s[24:27], s37 offen offset:2048 sc1 lds
buffer_load_dwordx4 v3, s[24:27], s37 offen offset:3072 sc1 lds
s_add_u32 s38, s53, 5373952
s_add_u32 m0, s39, 147456
s_nop 0
buffer_load_dwordx4 v23, s[28:31], s38 offen lds
s_add_u32 m0, s39, 148480
s_nop 0
buffer_load_dwordx4 v24, s[28:31], s38 offen lds
s_add_u32 m0, s39, 149504
s_add_u32 s38, s38, 16384
buffer_load_dwordx4 v23, s[28:31], s38 offen lds
s_add_u32 m0, s39, 150528
s_nop 0
s_branch Lov_17
.p2align 12
.fill 128, 4, 0xbf800000
Lst_17_0:
s_branch Lwr_185
s_nop 0
s_nop 0
Lov_17:
buffer_load_dwordx4 v24, s[28:31], s38 offen lds
s_waitcnt vmcnt(24)
s_barrier
s_add_u32 s37, s52, 688128
s_add_u32 m0, s39, 98304
s_nop 0
buffer_load_dwordx4 v3, s[24:27], s37 offen sc1 lds
buffer_load_dwordx4 v3, s[24:27], s37 offen offset:1024 sc1 lds
buffer_load_dwordx4 v3, s[24:27], s37 offen offset:2048 sc1 lds
buffer_load_dwordx4 v3, s[24:27], s37 offen offset:3072 sc1 lds
s_add_u32 s38, s53, 5505024
s_add_u32 m0, s39, 114688
s_nop 0
buffer_load_dwordx4 v23, s[28:31], s38 offen lds
s_add_u32 m0, s39, 115712
s_nop 0
buffer_load_dwordx4 v24, s[28:31], s38 offen lds
s_add_u32 m0, s39, 116736
s_add_u32 s38, s38, 16384
buffer_load_dwordx4 v23, s[28:31], s38 offen lds
s_add_u32 m0, s39, 117760
s_nop 0
buffer_load_dwordx4 v24, s[28:31], s38 offen lds
s_waitcnt vmcnt(24)
s_barrier
s_cmp_eq_u32 s47, 3
s_cbranch_scc0 Lw_149
s_lshl_b32 s92, s34, 7
s_add_u32 s92, s92, 28317696
s_load_dword s93, s[82:83], s92 glc
Lw_149:
s_add_u32 s37, s52, 704512
s_add_u32 m0, s39, 131072
s_nop 0
buffer_load_dwordx4 v3, s[24:27], s37 offen sc1 lds
buffer_load_dwordx4 v3, s[24:27], s37 offen offset:1024 sc1 lds
buffer_load_dwordx4 v3, s[24:27], s37 offen offset:2048 sc1 lds
buffer_load_dwordx4 v3, s[24:27], s37 offen offset:3072 sc1 lds
s_add_u32 s38, s53, 5636096
s_add_u32 m0, s39, 0
s_nop 0
buffer_load_dwordx4 v23, s[28:31], s38 offen lds
s_add_u32 m0, s39, 1024
s_nop 0
buffer_load_dwordx4 v24, s[28:31], s38 offen lds
s_add_u32 m0, s39, 2048
s_add_u32 s38, s38, 16384
buffer_load_dwordx4 v23, s[28:31], s38 offen lds
s_add_u32 m0, s39, 3072
s_nop 0
buffer_load_dwordx4 v24, s[28:31], s38 offen lds
s_waitcnt vmcnt(24)
s_cmp_eq_u32 s47, 3
s_cbranch_scc0 Lw_150
s_mov_b32 s41, 0x40000
s_branch Lpchk_153
Lpoll_151:
s_load_dword s93, s[82:83], s92 glc
Lpchk_153:
s_waitcnt lgkmcnt(0)
s_cmp_eq_u32 s93, 16
s_cbranch_scc1 Lpok_152
s_sub_u32 s41, s41, 1
s_cmp_lg_u32 s41, 0
s_cbranch_scc1 Lpoll_151
Lpok_152:
Lw_150:
s_barrier
s_add_u32 s37, s90, 0
s_add_u32 m0, s39, 16384
s_nop 0
buffer_load_dwordx4 v3, s[24:27], s37 offen sc1 lds
buffer_load_dwordx4 v3, s[24:27], s37 offen offset:1024 sc1 lds
buffer_load_dwordx4 v3, s[24:27], s37 offen offset:2048 sc1 lds
buffer_load_dwordx4 v3, s[24:27], s37 offen offset:3072 sc1 lds
s_add_u32 s38, s91, 0
s_add_u32 m0, s39, 32768
s_nop 0
buffer_load_dwordx4 v23, s[28:31], s38 offen lds
s_add_u32 m0, s39, 33792
s_nop 0
buffer_load_dwordx4 v24, s[28:31], s38 offen lds
s_add_u32 m0, s39, 34816
s_add_u32 s38, s38, 16384
buffer_load_dwordx4 v23, s[28:31], s38 offen lds
s_add_u32 m0, s39, 35840
s_nop 0
buffer_load_dwordx4 v24, s[28:31], s38 offen lds
s_waitcnt vmcnt(24)
s_barrier
s_add_u32 s37, s90, 16384
s_add_u32 m0, s39, 49152
s_nop 0
buffer_load_dwordx4 v3, s[24:27], s37 offen sc1 lds
buffer_load_dwordx4 v3, s[24:27], s37 offen offset:1024 sc1 lds
buffer_load_dwordx4 v3, s[24:27], s37 offen offset:2048 sc1 lds
buffer_load_dwordx4 v3, s[24:27], s37 offen offset:3072 sc1 lds
s_add_u32 s38, s91, 131072
s_add_u32 m0, s39, 65536
s_nop 0
buffer_load_dwordx4 v23, s[28:31], s38 offen lds
s_add_u32 m0, s39, 66560
s_nop 0
buffer_load_dwordx4 v24, s[28:31], s38 offen lds
s_add_u32 m0, s39, 67584
s_add_u32 s38, s38, 16384
buffer_load_dwordx4 v23, s[28:31], s38 offen lds
s_add_u32 m0, s39, 68608
s_nop 0
buffer_load_dwordx4 v24, s[28:31], s38 offen lds
s_waitcnt vmcnt(24)
s_barrier
s_add_u32 s37, s90, 32768
s_add_u32 m0, s39, 81920
s_nop 0
buffer_load_dwordx4 v3, s[24:27], s37 offen sc1 lds
buffer_load_dwordx4 v3, s[24:27], s37 offen offset:1024 sc1 lds
buffer_load_dwordx4 v3, s[24:27], s37 offen offset:2048 sc1 lds
buffer_load_dwordx4 v3, s[24:27], s37 offen offset:3072 sc1 lds
s_add_u32 s38, s91, 262144
s_add_u32 m0, s39, 147456
s_nop 0
buffer_load_dwordx4 v23, s[28:31], s38 offen lds
s_add_u32 m0, s39, 148480
s_nop 0
buffer_load_dwordx4 v24, s[28:31], s38 offen lds
s_add_u32 m0, s39, 149504
s_add_u32 s38, s38, 16384
buffer_load_dwordx4 v23, s[28:31], s38 offen lds
s_add_u32 m0, s39, 150528
s_nop 0
buffer_load_dwordx4 v24, s[28:31], s38 offen lds
s_waitcnt vmcnt(24)
s_barrier
s_add_u32 s37, s90, 49152
s_add_u32 m0, s39, 98304
s_nop 0
buffer_load_dwordx4 v3, s[24:27], s37 offen sc1 lds
buffer_load_dwordx4 v3, s[24:27], s37 offen offset:1024 sc1 lds
buffer_load_dwordx4 v3, s[24:27], s37 offen offset:2048 sc1 lds
buffer_load_dwordx4 v3, s[24:27], s37 offen offset:3072 sc1 lds
s_add_u32 s38, s91, 393216
s_add_u32 m0, s39, 114688
s_nop 0
buffer_load_dwordx4 v23, s[28:31], s38 offen lds
s_add_u32 m0, s39, 115712
s_nop 0
buffer_load_dwordx4 v24, s[28:31], s38 offen lds
s_add_u32 m0, s39, 116736
s_add_u32 s38, s38, 16384
buffer_load_dwordx4 v23, s[28:31], s38 offen lds
s_add_u32 m0, s39, 117760
s_nop 0
buffer_load_dwordx4 v24, s[28:31], s38 offen lds
s_waitcnt vmcnt(24)
s_barrier
s_add_u32 s37, s90, 65536
s_add_u32 m0, s39, 131072
s_nop 0
buffer_load_dwordx4 v3, s[24:27], s37 offen sc1 lds
buffer_load_dwordx4 v3, s[24:27], s37 offen offset:1024 sc1 lds
buffer_load_dwordx4 v3, s[24:27], s37 offen offset:2048 sc1 lds
buffer_load_dwordx4 v3, s[24:27], s37 offen offset:3072 sc1 lds
s_add_u32 s38, s91, 524288
s_add_u32 m0, s39, 0
s_nop 0
buffer_load_dwordx4 v23, s[28:31], s38 offen lds
s_add_u32 m0, s39, 1024
s_nop 0
buffer_load_dwordx4 v24, s[28:31], s38 offen lds
s_add_u32 m0, s39, 2048
s_add_u32 s38, s38, 16384
buffer_load_dwordx4 v23, s[28:31], s38 offen lds
s_add_u32 m0, s39, 3072
s_nop 0
buffer_load_dwordx4 v24, s[28:31], s38 offen lds
s_waitcnt vmcnt(24)
s_barrier
s_add_u32 s37, s90, 81920
s_add_u32 m0, s39, 16384
s_nop 0
buffer_load_dwordx4 v3, s[24:27], s37 offen sc1 lds
buffer_load_dwordx4 v3, s[24:27], s37 offen offset:1024 sc1 lds
buffer_load_dwordx4 v3, s[24:27], s37 offen offset:2048 sc1 lds
buffer_load_dwordx4 v3, s[24:27], s37 offen offset:3072 sc1 lds
s_add_u32 s38, s91, 655360
s_add_u32 m0, s39, 32768
s_nop 0
buffer_load_dwordx4 v23, s[28:31], s38 offen lds
s_add_u32 m0, s39, 33792
s_nop 0
buffer_load_dwordx4 v24, s[28:31], s38 offen lds
s_add_u32 m0, s39, 34816
s_add_u32 s38, s38, 16384
buffer_load_dwordx4 v23, s[28:31], s38 offen lds
s_add_u32 m0, s39, 35840
s_nop 0
buffer_load_dwordx4 v24, s[28:31], s38 offen lds
s_waitcnt vmcnt(24)
s_barrier
s_add_u32 s37, s90, 98304
s_add_u32 m0, s39, 49152
s_nop 0
buffer_load_dwordx4 v3, s[24:27], s37 offen sc1 lds
buffer_load_dwordx4 v3, s[24:27], s37 offen offset:1024 sc1 lds
buffer_load_dwordx4 v3, s[24:27], s37 offen offset:2048 sc1 lds
buffer_load_dwordx4 v3, s[24:27], s37 offen offset:3072 sc1 lds
s_add_u32 s38, s91, 786432
s_add_u32 m0, s39, 65536
s_nop 0
buffer_load_dwordx4 v23, s[28:31], s38 offen lds
s_add_u32 m0, s39, 66560
s_nop 0
buffer_load_dwordx4 v24, s[28:31], s38 offen lds
s_add_u32 m0, s39, 67584
s_add_u32 s38, s38, 16384
buffer_load_dwordx4 v23, s[28:31], s38 offen lds
s_add_u32 m0, s39, 68608
s_nop 0
buffer_load_dwordx4 v24, s[28:31], s38 offen lds
s_waitcnt vmcnt(24)
s_barrier
s_add_u32 s37, s90, 114688
s_add_u32 m0, s39, 81920
s_nop 0
buffer_load_dwordx4 v3, s[24:27], s37 offen sc1 lds
buffer_load_dwordx4 v3, s[24:27], s37 offen offset:1024 sc1 lds
buffer_load_dwordx4 v3, s[24:27], s37 offen offset:2048 sc1 lds
buffer_load_dwordx4 v3, s[24:27], s37 offen offset:3072 sc1 lds
s_add_u32 s38, s91, 917504
s_add_u32 m0, s39, 147456
s_nop 0
buffer_load_dwordx4 v23, s[28:31], s38 offen lds
s_add_u32 m0, s39, 148480
s_nop 0
buffer_load_dwordx4 v24, s[28:31], s38 offen lds
s_add_u32 m0, s39, 149504
s_add_u32 s38, s38, 16384
buffer_load_dwordx4 v23, s[28:31], s38 offen lds
s_add_u32 m0, s39, 150528
s_nop 0
buffer_load_dwordx4 v24, s[28:31], s38 offen lds
s_waitcnt vmcnt(24)
s_barrier
s_add_u32 s37, s90, 131072
s_add_u32 m0, s39, 98304
s_nop 0
buffer_load_dwordx4 v3, s[24:27], s37 offen sc1 lds
buffer_load_dwordx4 v3, s[24:27], s37 offen offset:1024 sc1 lds
buffer_load_dwordx4 v3, s[24:27], s37 offen offset:2048 sc1 lds
buffer_load_dwordx4 v3, s[24:27], s37 offen offset:3072 sc1 lds
s_add_u32 s38, s91, 1048576
s_add_u32 m0, s39, 114688
s_nop 0
buffer_load_dwordx4 v23, s[28:31], s38 offen lds
s_add_u32 m0, s39, 115712
s_nop 0
buffer_load_dwordx4 v24, s[28:31], s38 offen lds
s_add_u32 m0, s39, 116736
s_add_u32 s38, s38, 16384
buffer_load_dwordx4 v23, s[28:31], s38 offen lds
s_add_u32 m0, s39, 117760
s_nop 0
buffer_load_dwordx4 v24, s[28:31], s38 offen lds
s_waitcnt vmcnt(24)
s_barrier
s_add_u32 s37, s90, 147456
s_add_u32 m0, s39, 131072
s_nop 0
buffer_load_dwordx4 v3, s[24:27], s37 offen sc1 lds
buffer_load_dwordx4 v3, s[24:27], s37 offen offset:1024 sc1 lds
buffer_load_dwordx4 v3, s[24:27], s37 offen offset:2048 sc1 lds
buffer_load_dwordx4 v3, s[24:27], s37 offen offset:3072 sc1 lds
s_add_u32 s38, s91, 1179648
s_add_u32 m0, s39, 0
s_nop 0
buffer_load_dwordx4 v23, s[28:31], s38 offen lds
s_add_u32 m0, s39, 1024
s_nop 0
buffer_load_dwordx4 v24, s[28:31], s38 offen lds
s_add_u32 m0, s39, 2048
s_add_u32 s38, s38, 16384
buffer_load_dwordx4 v23, s[28:31], s38 offen lds
s_add_u32 m0, s39, 3072
s_nop 0
buffer_load_dwordx4 v24, s[28:31], s38 offen lds
s_waitcnt vmcnt(24)
s_barrier
s_mov_b32 s37, 327680
s_add_u32 m0, s39, 16384
s_nop 0
buffer_load_dwordx4 v3, s[24:27], s37 offen sc1 lds
buffer_load_dwordx4 v3, s[24:27], s37 offen offset:1024 sc1 lds
buffer_load_dwordx4 v3, s[24:27], s37 offen offset:2048 sc1 lds
buffer_load_dwordx4 v3, s[24:27], s37 offen offset:3072 sc1 lds
s_mov_b32 s38, 2621440
s_add_u32 m0, s51, 32768
s_nop 0
buffer_load_dwordx4 v25, s[28:31], s38 offen lds
s_add_u32 m0, s51, 33792
s_add_u32 s38, s38, 16384
buffer_load_dwordx4 v25, s[28:31], s38 offen lds
s_waitcnt vmcnt(22)
s_barrier
s_mov_b32 s37, 344064
s_add_u32 m0, s39, 49152
s_nop 0
buffer_load_dwordx4 v3, s[24:27], s37 offen sc1 lds
buffer_load_dwordx4 v3, s[24:27], s37 offen offset:1024 sc1 lds
buffer_load_dwordx4 v3, s[24:27], s37 offen offset:2048 sc1 lds
buffer_load_dwordx4 v3, s[24:27], s37 offen offset:3072 sc1 lds
s_mov_b32 s38, 2752512
s_add_u32 m0, s51, 65536
s_nop 0
buffer_load_dwordx4 v25, s[28:31], s38 offen lds
s_add_u32 m0, s51, 66560
s_add_u32 s38, s38, 16384
buffer_load_dwordx4 v25, s[28:31], s38 offen lds
s_waitcnt vmcnt(20)
s_barrier
s_mov_b32 s37, 360448
s_add_u32 m0, s39, 81920
s_nop 0
buffer_load_dwordx4 v3, s[24:27], s37 offen sc1 lds
buffer_load_dwordx4 v3, s[24:27], s37 offen offset:1024 sc1 lds
buffer_load_dwordx4 v3, s[24:27], s37 offen offset:2048 sc1 lds
buffer_load_dwordx4 v3, s[24:27], s37 offen offset:3072 sc1 lds
s_mov_b32 s38, 2883584
s_add_u32 m0, s51, 147456
s_nop 0
buffer_load_dwordx4 v25, s[28:31], s38 offen lds
s_add_u32 m0, s51, 148480
s_add_u32 s38, s38, 16384
buffer_load_dwordx4 v25, s[28:31], s38 offen lds
s_waitcnt vmcnt(18)
s_barrier
s_mov_b32 s37, 376832
s_add_u32 m0, s39, 98304
s_nop 0
buffer_load_dwordx4 v3, s[24:27], s37 offen sc1 lds
buffer_load_dwordx4 v3, s[24:27], s37 offen offset:1024 sc1 lds
buffer_load_dwordx4 v3, s[24:27], s37 offen offset:2048 sc1 lds
buffer_load_dwordx4 v3, s[24:27], s37 offen offset:3072 sc1 lds
s_mov_b32 s38, 3014656
s_add_u32 m0, s51, 114688
s_nop 0
buffer_load_dwordx4 v25, s[28:31], s38 offen lds
s_add_u32 m0, s51, 115712
s_add_u32 s38, s38, 16384
buffer_load_dwordx4 v25, s[28:31], s38 offen lds
s_waitcnt vmcnt(18)
s_barrier
s_mov_b32 s37, 393216
s_add_u32 m0, s39, 131072
s_nop 0
buffer_load_dwordx4 v3, s[24:27], s37 offen sc1 lds
buffer_load_dwordx4 v3, s[24:27], s37 offen offset:1024 sc1 lds
buffer_load_dwordx4 v3, s[24:27], s37 offen offset:2048 sc1 lds
buffer_load_dwordx4 v3, s[24:27], s37 offen offset:3072 sc1 lds
s_mov_b32 s38, 3145728
s_add_u32 m0, s51, 0
s_nop 0
buffer_load_dwordx4 v25, s[28:31], s38 offen lds
s_add_u32 m0, s51, 1024
s_add_u32 s38, s38, 16384
buffer_load_dwordx4 v25, s[28:31], s38 offen lds
s_waitcnt vmcnt(18)
s_barrier
s_mov_b32 s37, 409600
s_add_u32 m0, s39, 16384
s_nop 0
buffer_load_dwordx4 v3, s[24:27], s37 offen sc1 lds
buffer_load_dwordx4 v3, s[24:27], s37 offen offset:1024 sc1 lds
buffer_load_dwordx4 v3, s[24:27], s37 offen offset:2048 sc1 lds
buffer_load_dwordx4 v3, s[24:27], s37 offen offset:3072 sc1 lds
s_mov_b32 s38, 3276800
s_add_u32 m0, s51, 32768
s_nop 0
buffer_load_dwordx4 v25, s[28:31], s38 offen lds
s_add_u32 m0, s51, 33792
s_add_u32 s38, s38, 16384
buffer_load_dwordx4 v25, s[28:31], s38 offen lds
s_waitcnt vmcnt(18)
s_barrier
s_mov_b32 s37, 425984
s_add_u32 m0, s39, 49152
s_nop 0
buffer_load_dwordx4 v3, s[24:27], s37 offen sc1 lds
buffer_load_dwordx4 v3, s[24:27], s37 offen offset:1024 sc1 lds
buffer_load_dwordx4 v3, s[24:27], s37 offen offset:2048 sc1 lds
buffer_load_dwordx4 v3, s[24:27], s37 offen offset:3072 sc1 lds
s_mov_b32 s38, 3407872
s_add_u32 m0, s51, 65536
s_nop 0
buffer_load_dwordx4 v25, s[28:31], s38 offen lds
s_add_u32 m0, s51, 66560
s_add_u32 s38, s38, 16384
buffer_load_dwordx4 v25, s[28:31], s38 offen lds
s_waitcnt vmcnt(18)
s_barrier
s_mov_b32 s37, 442368
s_add_u32 m0, s39, 81920
s_nop 0
buffer_load_dwordx4 v3, s[24:27], s37 offen sc1 lds
buffer_load_dwordx4 v3, s[24:27], s37 offen offset:1024 sc1 lds
buffer_load_dwordx4 v3, s[24:27], s37 offen offset:2048 sc1 lds
buffer_load_dwordx4 v3, s[24:27], s37 offen offset:3072 sc1 lds
s_mov_b32 s38, 3538944
s_add_u32 m0, s51, 147456
s_nop 0
buffer_load_dwordx4 v25, s[28:31], s38 offen lds
s_add_u32 m0, s51, 148480
s_add_u32 s38, s38, 16384
buffer_load_dwordx4 v25, s[28:31], s38 offen lds
s_waitcnt vmcnt(18)
s_barrier
s_mov_b32 s37, 458752
s_add_u32 m0, s39, 98304
s_nop 0
buffer_load_dwordx4 v3, s[24:27], s37 offen sc1 lds
buffer_load_dwordx4 v3, s[24:27], s37 offen offset:1024 sc1 lds
buffer_load_dwordx4 v3, s[24:27], s37 offen offset:2048 sc1 lds
buffer_load_dwordx4 v3, s[24:27], s37 offen offset:3072 sc1 lds
s_mov_b32 s38, 3670016
s_add_u32 m0, s51, 114688
s_nop 0
buffer_load_dwordx4 v25, s[28:31], s38 offen lds
s_add_u32 m0, s51, 115712
s_add_u32 s38, s38, 16384
buffer_load_dwordx4 v25, s[28:31], s38 offen lds
s_waitcnt vmcnt(18)
s_barrier
s_mov_b32 s37, 475136
s_add_u32 m0, s39, 131072
s_nop 0
buffer_load_dwordx4 v3, s[24:27], s37 offen sc1 lds
buffer_load_dwordx4 v3, s[24:27], s37 offen offset:1024 sc1 lds
buffer_load_dwordx4 v3, s[24:27], s37 offen offset:2048 sc1 lds
buffer_load_dwordx4 v3, s[24:27], s37 offen offset:3072 sc1 lds
s_mov_b32 s38, 3801088
s_add_u32 m0, s51, 0
s_nop 0
buffer_load_dwordx4 v25, s[28:31], s38 offen lds
s_add_u32 m0, s51, 1024
s_add_u32 s38, s38, 16384
buffer_load_dwordx4 v25, s[28:31], s38 offen lds
s_waitcnt vmcnt(18)
s_barrier
s_cmp_eq_u32 s47, 0
s_cbranch_scc0 Lw_154
s_xor_b32 s43, s2, 2
s_add_u32 s43, s43, 128
s_lshl_b32 s43, s43, 7
v_mov_b32 v26, s43
v_mov_b32 v27, 1
s_mov_b64 exec, 1
buffer_store_dword v27, v26, s[56:59], 0 offen sc1
s_mov_b64 exec, -1
Lw_154:
s_mov_b32 s37, 491520
s_add_u32 m0, s39, 16384
s_nop 0
buffer_load_dwordx4 v3, s[24:27], s37 offen sc1 lds
buffer_load_dwordx4 v3, s[24:27], s37 offen offset:1024 sc1 lds
buffer_load_dwordx4 v3, s[24:27], s37 offen offset:2048 sc1 lds
buffer_load_dwordx4 v3, s[24:27], s37 offen offset:3072 sc1 lds
s_mov_b32 s38, 3932160
s_add_u32 m0, s51, 32768
s_nop 0
buffer_load_dwordx4 v25, s[28:31], s38 offen lds
s_add_u32 m0, s51, 33792
s_add_u32 s38, s38, 16384
buffer_load_dwordx4 v25, s[28:31], s38 offen lds
s_waitcnt vmcnt(18)
s_barrier
s_mov_b32 s37, 507904
s_add_u32 m0, s39, 49152
s_nop 0
buffer_load_dwordx4 v3, s[24:27], s37 offen sc1 lds
buffer_load_dwordx4 v3, s[24:27], s37 offen offset:1024 sc1 lds
buffer_load_dwordx4 v3, s[24:27], s37 offen offset:2048 sc1 lds
buffer_load_dwordx4 v3, s[24:27], s37 offen offset:3072 sc1 lds
s_mov_b32 s38, 4063232
s_add_u32 m0, s51, 65536
s_nop 0
buffer_load_dwordx4 v25, s[28:31], s38 offen lds
s_add_u32 m0, s51, 66560
s_add_u32 s38, s38, 16384
buffer_load_dwordx4 v25, s[28:31], s38 offen lds
s_waitcnt vmcnt(18)
s_barrier
s_cmp_eq_u32 s47, 3
s_cbranch_scc0 Lw_155
s_lshl_b32 s92, s2, 7
s_add_u32 s92, s92, 28327936
s_load_dword s93, s[82:83], s92 glc
Lw_155:
s_waitcnt vmcnt(12)
s_cmp_eq_u32 s47, 3
s_cbranch_scc0 Lw_156
s_mov_b32 s41, 0x40000
s_branch Lpchk_159
Lpoll_157:
s_load_dword s93, s[82:83], s92 glc
Lpchk_159:
s_waitcnt lgkmcnt(0)
s_cmp_eq_u32 s93, 1
s_cbranch_scc1 Lpok_158
s_sub_u32 s41, s41, 1
s_cmp_lg_u32 s41, 0
s_cbranch_scc1 Lpoll_157
Lpok_158:
Lw_156:
s_barrier
s_waitcnt vmcnt(6)
s_barrier
s_waitcnt vmcnt(0)
s_barrier
s_barrier
s_branch Ldone_1
Ldone_1:
Lfin:
Lexit_2:
s_endpgm
.fill 1024, 4, 0xbf800000
.section .rodata,"a"
.p2align 6
.amdhsa_kernel sequential_preLN__sliding_local_dilated__glu_gated_geglu__prompt_kernel
  .amdhsa_next_free_vgpr 256
  .amdhsa_next_free_sgpr 102
  .amdhsa_accum_offset 256
  .amdhsa_group_segment_fixed_size 0
  .amdhsa_kernarg_size 80
  .amdhsa_user_sgpr_count 2
  .amdhsa_user_sgpr_kernarg_segment_ptr 1
  .amdhsa_system_sgpr_workgroup_id_x 1
  .amdhsa_float_denorm_mode_32 3
  .amdhsa_float_denorm_mode_16_64 3
.end_amdhsa_kernel
```

```asm
; @launch grid=(256,1,1) block=(512,1,1) lds=163840
.amdgcn_target "amdgcn-amd-amdhsa--gfx950"
.text
.globl sequential_preLN__sliding_local_dilated__glu_gated_geglu__prompt_kernel
.p2align 8
.type sequential_preLN__sliding_local_dilated__glu_gated_geglu__prompt_kernel,@function
sequential_preLN__sliding_local_dilated__glu_gated_geglu__prompt_kernel:
s_cmp_ge_u32 s2, 256
s_cbranch_scc1 Lexit_2
s_load_dwordx16 s[64:79], s[0:1], 0
s_load_dwordx4 s[80:83], s[0:1], 64
s_and_b32 s3, s2, 7
s_lshr_b32 s42, s2, 3
s_and_b32 s34, s3, 1
s_lshl_b32 s34, s34, 3
s_and_b32 s48, s42, 7
s_add_u32 s34, s34, s48
s_lshr_b32 s35, s3, 1
s_lshr_b32 s49, s42, 3
s_lshl_b32 s35, s35, 2
s_add_u32 s35, s35, s49
v_lshrrev_b32 v12, 6, v0
v_and_b32 v1, 63, v0
v_readfirstlane_b32 s36, v12
Lbeg:
s_lshl_b32 s50, s34, 7
s_sub_u32 s50, s50, 16
v_and_b32 v12, 15, v1
v_lshrrev_b32 v13, 4, v1
s_cmp_lt_u32 s36, 4
s_cbranch_scc1 Lcons_7
Lprod_3:
s_sub_u32 s47, s36, 4
s_lshl_b32 s43, s34, 7
s_lshl_b32 s44, s35, 3
s_add_u32 s63, s43, s44
s_lshl_b32 s44, s47, 1
s_add_u32 s51, s63, s44
v_lshlrev_b32 v10, 4, v1
s_and_b32 s43, s2, 7
s_lshr_b32 s44, s43, 2
s_lshl_b32 s44, s44, 1
s_and_b32 s45, s43, 1
s_add_u32 s44, s44, s45
s_lshr_b32 s45, s2, 3
s_lshl_b32 s45, s45, 2
s_add_u32 s44, s44, s45
s_add_u32 s44, s44, 96
s_bitcmp1_b32 s43, 1
s_cselect_b32 s44, s44, 0x10000
s_cmp_lt_u32 s2, 192
s_cselect_b32 s33, s2, s44
v_lshrrev_b32 v14, 3, v1
v_and_b32 v15, 7, v1
v_lshl_add_u32 v19, v14, 6, v15
s_lshl_b32 s43, s48, 3
v_add_u32 v19, s43, v19
v_mul_u32_u24 v19, 6144, v19
s_cmp_eq_u32 s47, 3
s_cbranch_scc1 Lpf_4
v_and_b32 v16, 2, v14
v_xor_b32 v16, v15, v16
v_lshlrev_b32 v16, 4, v16
v_mul_u32_u24 v17, 6144, v14
s_lshl_b32 s43, s47, 11
v_add3_u32 v2, v17, v16, s43
v_xor_b32 v3, 64, v2
v_lshrrev_b32 v16, 1, v14
v_xor_b32 v16, v15, v16
v_lshlrev_b32 v16, 4, v16
s_lshl_b32 s43, s47, 3
s_add_u32 s43, s43, s50
v_add_u32 v17, s43, v14
s_and_b32 s44, s47, 1
s_lshl_b32 s44, s44, 6
v_add_u32 v18, 0, v17
v_max_i32 v18, 0, v18
v_lshl_add_u32 v18, v18, 11, v16
v_xor_b32 v18, s44, v18
v_mov_b32 v4, v18
v_add_u32 v18, 24, v17
v_max_i32 v18, 0, v18
v_lshl_add_u32 v18, v18, 11, v16
v_xor_b32 v18, s44, v18
v_xor_b32 v5, 64, v18
v_add_u32 v18, 48, v17
v_max_i32 v18, 0, v18
v_lshl_add_u32 v18, v18, 11, v16
v_xor_b32 v18, s44, v18
v_mov_b32 v6, v18
v_add_u32 v18, 72, v17
v_max_i32 v18, 0, v18
v_lshl_add_u32 v18, v18, 11, v16
v_xor_b32 v18, s44, v18
v_xor_b32 v7, 64, v18
v_add_u32 v18, 96, v17
v_max_i32 v18, 0, v18
v_lshl_add_u32 v18, v18, 11, v16
v_xor_b32 v18, s44, v18
v_mov_b32 v8, v18
v_add_u32 v18, 120, v17
v_max_i32 v18, 0, v18
v_lshl_add_u32 v18, v18, 11, v16
v_xor_b32 v18, s44, v18
v_xor_b32 v9, 64, v18
s_lshl_b32 s39, s47, 10
s_lshl_b32 s40, s47, 13
s_add_u32 s40, s40, 18432
s_mov_b32 s37, 0
s_mov_b32 s38, 0
s_bfm_b64 s[60:61], 56, 8
s_cmp_eq_u32 s47, 0
s_cselect_b64 s[60:61], s[60:61], -1
s_lshl_b32 s43, s35, 7
s_waitcnt lgkmcnt(0)
s_mov_b32 s8, s64
s_mov_b32 s9, s65
s_mov_b32 s10, 4194304
s_mov_b32 s11, 0x20000
s_add_u32 s12, s66, s43
s_addc_u32 s13, s67, 0
s_mov_b32 s14, 6289536
s_mov_b32 s15, 0x20000
s_mov_b32 s28, s66
s_mov_b32 s29, s67
s_mov_b32 s30, 6291456
s_mov_b32 s31, 0x20000
s_mul_i32 s43, s33, 7296
v_lshlrev_b32 v30, 7, v1
s_mul_i32 s44, s47, 2432
s_add_u32 s43, s43, s44
s_bfm_b64 exec, 19, 0
buffer_load_dword v31, v30, s[28:31], s43 offen
s_mov_b64 exec, -1
s_add_u32 m0, s39, 0
s_mov_b64 exec, s[60:61]
buffer_load_dwordx4 v4, s[8:11], s37 offen lds
s_mov_b64 exec, -1
s_add_u32 m0, s39, 3072
s_nop 0
buffer_load_dwordx4 v5, s[8:11], s37 offen lds
s_add_u32 m0, s39, 6144
s_nop 0
buffer_load_dwordx4 v6, s[8:11], s37 offen lds
s_add_u32 m0, s39, 9216
s_nop 0
buffer_load_dwordx4 v7, s[8:11], s37 offen lds
s_add_u32 m0, s39, 12288
s_nop 0
buffer_load_dwordx4 v8, s[8:11], s37 offen lds
s_add_u32 m0, s39, 15360
s_nop 0
buffer_load_dwordx4 v9, s[8:11], s37 offen lds
s_add_u32 m0, s40, 0
s_add_u32 s43, s38, 0
buffer_load_dwordx4 v2, s[12:15], s43 offen lds
s_add_u32 m0, s40, 1024
s_add_u32 s43, s38, 49152
buffer_load_dwordx4 v3, s[12:15], s43 offen lds
s_add_u32 m0, s40, 2048
s_add_u32 s43, s38, 98304
buffer_load_dwordx4 v2, s[12:15], s43 offen lds
s_add_u32 m0, s40, 3072
s_add_u32 s43, s38, 147456
buffer_load_dwordx4 v3, s[12:15], s43 offen lds
s_add_u32 m0, s40, 4096
s_add_u32 s43, s38, 196608
buffer_load_dwordx4 v2, s[12:15], s43 offen lds
s_add_u32 m0, s40, 5120
s_add_u32 s43, s38, 245760
buffer_load_dwordx4 v3, s[12:15], s43 offen lds
s_add_u32 m0, s40, 6144
s_add_u32 s43, s38, 294912
buffer_load_dwordx4 v2, s[12:15], s43 offen lds
s_add_u32 m0, s40, 7168
s_add_u32 s43, s38, 344064
buffer_load_dwordx4 v3, s[12:15], s43 offen lds
s_add_u32 s37, s37, 128
s_add_u32 s38, s38, 393216
s_lshl_b32 s43, s51, 11
buffer_load_dwordx4 v[96:99], v10, s[8:11], s43 offen offset:0
buffer_load_dwordx4 v[100:103], v10, s[8:11], s43 offen offset:1024
buffer_load_dwordx4 v[104:107], v10, s[8:11], s43 offen offset:2048
buffer_load_dwordx4 v[108:111], v10, s[8:11], s43 offen offset:3072
s_add_u32 m0, s39, 43008
s_mov_b64 exec, s[60:61]
buffer_load_dwordx4 v4, s[8:11], s37 offen lds
s_mov_b64 exec, -1
s_add_u32 m0, s39, 46080
s_nop 0
buffer_load_dwordx4 v5, s[8:11], s37 offen lds
s_add_u32 m0, s39, 49152
s_nop 0
buffer_load_dwordx4 v6, s[8:11], s37 offen lds
s_add_u32 m0, s39, 52224
s_nop 0
buffer_load_dwordx4 v7, s[8:11], s37 offen lds
s_add_u32 m0, s39, 55296
s_nop 0
buffer_load_dwordx4 v8, s[8:11], s37 offen lds
s_add_u32 m0, s39, 58368
s_nop 0
buffer_load_dwordx4 v9, s[8:11], s37 offen lds
s_add_u32 m0, s40, 43008
s_add_u32 s43, s38, 0
buffer_load_dwordx4 v2, s[12:15], s43 offen lds
s_add_u32 m0, s40, 44032
s_add_u32 s43, s38, 49152
buffer_load_dwordx4 v3, s[12:15], s43 offen lds
s_add_u32 m0, s40, 45056
s_add_u32 s43, s38, 98304
buffer_load_dwordx4 v2, s[12:15], s43 offen lds
s_add_u32 m0, s40, 46080
s_add_u32 s43, s38, 147456
buffer_load_dwordx4 v3, s[12:15], s43 offen lds
s_add_u32 m0, s40, 47104
s_add_u32 s43, s38, 196608
buffer_load_dwordx4 v2, s[12:15], s43 offen lds
s_add_u32 m0, s40, 48128
s_add_u32 s43, s38, 245760
buffer_load_dwordx4 v3, s[12:15], s43 offen lds
s_add_u32 m0, s40, 49152
s_add_u32 s43, s38, 294912
buffer_load_dwordx4 v2, s[12:15], s43 offen lds
s_add_u32 m0, s40, 50176
s_add_u32 s43, s38, 344064
buffer_load_dwordx4 v3, s[12:15], s43 offen lds
s_add_u32 s37, s37, 128
s_add_u32 s38, s38, 393216
s_waitcnt vmcnt(18)
s_barrier
s_add_u32 m0, s39, 86016
s_mov_b64 exec, s[60:61]
buffer_load_dwordx4 v4, s[8:11], s37 offen lds
s_mov_b64 exec, -1
s_add_u32 m0, s39, 89088
s_nop 0
buffer_load_dwordx4 v5, s[8:11], s37 offen lds
s_add_u32 m0, s39, 92160
s_nop 0
buffer_load_dwordx4 v6, s[8:11], s37 offen lds
s_add_u32 m0, s39, 95232
s_nop 0
buffer_load_dwordx4 v7, s[8:11], s37 offen lds
s_add_u32 m0, s39, 98304
s_nop 0
buffer_load_dwordx4 v8, s[8:11], s37 offen lds
s_add_u32 m0, s39, 101376
s_nop 0
buffer_load_dwordx4 v9, s[8:11], s37 offen lds
s_add_u32 m0, s40, 86016
s_add_u32 s43, s38, 0
buffer_load_dwordx4 v2, s[12:15], s43 offen lds
s_add_u32 m0, s40, 87040
s_add_u32 s43, s38, 49152
buffer_load_dwordx4 v3, s[12:15], s43 offen lds
s_add_u32 m0, s40, 88064
s_add_u32 s43, s38, 98304
buffer_load_dwordx4 v2, s[12:15], s43 offen lds
s_add_u32 m0, s40, 89088
s_add_u32 s43, s38, 147456
buffer_load_dwordx4 v3, s[12:15], s43 offen lds
s_add_u32 m0, s40, 90112
s_add_u32 s43, s38, 196608
buffer_load_dwordx4 v2, s[12:15], s43 offen lds
s_add_u32 m0, s40, 91136
s_add_u32 s43, s38, 245760
buffer_load_dwordx4 v3, s[12:15], s43 offen lds
s_add_u32 m0, s40, 92160
s_add_u32 s43, s38, 294912
buffer_load_dwordx4 v2, s[12:15], s43 offen lds
s_add_u32 m0, s40, 93184
s_add_u32 s43, s38, 344064
buffer_load_dwordx4 v3, s[12:15], s43 offen lds
s_add_u32 s37, s37, 128
s_add_u32 s38, s38, 393216
s_waitcnt vmcnt(28)
s_mov_b32 s43, 0x3f803f80
v_mov_b32 v116, 0
v_mov_b32 v117, 0
v_mov_b32 v118, 0
v_mov_b32 v119, 0
v_mov_b32 v120, 0
v_mov_b32 v121, 0
v_mov_b32 v122, 0
v_mov_b32 v123, 0
v_dot2_f32_bf16 v116, v96, s43, v116
v_dot2_f32_bf16 v120, v96, v96, v120
v_dot2_f32_bf16 v118, v104, s43, v118
v_dot2_f32_bf16 v122, v104, v104, v122
v_dot2_f32_bf16 v117, v97, s43, v117
v_dot2_f32_bf16 v121, v97, v97, v121
v_dot2_f32_bf16 v119, v105, s43, v119
v_dot2_f32_bf16 v123, v105, v105, v123
v_dot2_f32_bf16 v116, v98, s43, v116
v_dot2_f32_bf16 v120, v98, v98, v120
v_dot2_f32_bf16 v118, v106, s43, v118
v_dot2_f32_bf16 v122, v106, v106, v122
v_dot2_f32_bf16 v117, v99, s43, v117
v_dot2_f32_bf16 v121, v99, v99, v121
v_dot2_f32_bf16 v119, v107, s43, v119
v_dot2_f32_bf16 v123, v107, v107, v123
v_dot2_f32_bf16 v116, v100, s43, v116
v_dot2_f32_bf16 v120, v100, v100, v120
v_dot2_f32_bf16 v118, v108, s43, v118
v_dot2_f32_bf16 v122, v108, v108, v122
v_dot2_f32_bf16 v117, v101, s43, v117
v_dot2_f32_bf16 v121, v101, v101, v121
v_dot2_f32_bf16 v119, v109, s43, v119
v_dot2_f32_bf16 v123, v109, v109, v123
v_dot2_f32_bf16 v116, v102, s43, v116
v_dot2_f32_bf16 v120, v102, v102, v120
v_dot2_f32_bf16 v118, v110, s43, v118
v_dot2_f32_bf16 v122, v110, v110, v122
v_dot2_f32_bf16 v117, v103, s43, v117
v_dot2_f32_bf16 v121, v103, v103, v121
v_dot2_f32_bf16 v119, v111, s43, v119
v_dot2_f32_bf16 v123, v111, v111, v123
s_nop 2
v_add_f32 v116, v116, v117
v_add_f32 v118, v118, v119
v_add_f32 v120, v120, v121
v_add_f32 v122, v122, v123
s_nop 1
v_permlane32_swap_b32 v116, v118
v_permlane32_swap_b32 v120, v122
v_add_f32 v116, v116, v118
v_add_f32 v120, v120, v122
s_nop 1
v_permlane16_swap_b32 v116, v120
v_add_f32 v116, v116, v120
s_nop 1
v_add_f32_dpp v116, v116, v116 row_ror:8 row_mask:0xf bank_mask:0xf
s_nop 1
v_add_f32_dpp v116, v116, v116 row_ror:4 row_mask:0xf bank_mask:0xf
s_nop 1
v_add_f32_dpp v116, v116, v116 row_ror:2 row_mask:0xf bank_mask:0xf
s_nop 1
v_add_f32_dpp v116, v116, v116 row_ror:1 row_mask:0xf bank_mask:0xf
v_mov_b32 v117, v116
s_nop 1
v_permlane16_swap_b32 v116, v117
v_mul_f32 v112, 0x3a800000, v116
v_mul_f32 v113, 0x3a800000, v117
v_fma_f32 v113, -v112, v112, v113
v_max_f32 v113, 0, v113
v_add_f32 v113, 0x3727c5ac, v113
v_rsq_f32 v113, v113
v_lshrrev_b32 v11, 5, v1
s_lshl_b32 s43, s47, 4
s_add_u32 s43, s43, 148608
v_lshl_add_u32 v11, v11, 3, s43
ds_write_b64 v11, v[112:113]
s_waitcnt lgkmcnt(0)
s_and_b32 s44, s36, 3
s_mul_i32 s44, s44, 28
s_bfe_u32 s43, s2, 0x30001
s_lshl_b32 s43, s43, 7
s_add_u32 s44, s44, s43
s_mul_i32 s44, s44, 7168
s_lshr_b32 s43, s2, 4
s_lshl_b32 s43, s43, 8
s_add_u32 s43, s43, s44
s_bitcmp0_b32 s2, 0
s_cselect_b32 s4, s72, s74
s_cselect_b32 s5, s73, s75
s_add_u32 s4, s4, s43
s_addc_u32 s5, s5, 0
Lsp_8:
s_waitcnt vmcnt(14)
s_barrier
s_add_u32 m0, s39, 0
s_mov_b64 exec, s[60:61]
buffer_load_dwordx4 v4, s[8:11], s37 offen lds
s_mov_b64 exec, -1
s_add_u32 m0, s39, 3072
s_nop 0
buffer_load_dwordx4 v5, s[8:11], s37 offen lds
s_add_u32 m0, s39, 6144
s_nop 0
buffer_load_dwordx4 v6, s[8:11], s37 offen lds
s_add_u32 m0, s39, 9216
s_nop 0
buffer_load_dwordx4 v7, s[8:11], s37 offen lds
s_add_u32 m0, s39, 12288
s_nop 0
buffer_load_dwordx4 v8, s[8:11], s37 offen lds
s_add_u32 m0, s39, 15360
s_nop 0
buffer_load_dwordx4 v9, s[8:11], s37 offen lds
s_add_u32 m0, s40, 0
s_add_u32 s43, s38, 0
buffer_load_dwordx4 v2, s[12:15], s43 offen lds
s_add_u32 m0, s40, 1024
s_add_u32 s43, s38, 49152
buffer_load_dwordx4 v3, s[12:15], s43 offen lds
s_add_u32 m0, s40, 2048
s_add_u32 s43, s38, 98304
buffer_load_dwordx4 v2, s[12:15], s43 offen lds
s_add_u32 m0, s40, 3072
s_add_u32 s43, s38, 147456
buffer_load_dwordx4 v3, s[12:15], s43 offen lds
s_add_u32 m0, s40, 4096
s_add_u32 s43, s38, 196608
buffer_load_dwordx4 v2, s[12:15], s43 offen lds
s_add_u32 m0, s40, 5120
s_add_u32 s43, s38, 245760
buffer_load_dwordx4 v3, s[12:15], s43 offen lds
s_add_u32 m0, s40, 6144
s_add_u32 s43, s38, 294912
buffer_load_dwordx4 v2, s[12:15], s43 offen lds
s_add_u32 m0, s40, 7168
s_add_u32 s43, s38, 344064
buffer_load_dwordx4 v3, s[12:15], s43 offen lds
s_add_u32 s37, s37, 128
s_add_u32 s38, s38, 393216
Lsp_9:
s_waitcnt vmcnt(14)
s_barrier
s_add_u32 m0, s39, 43008
s_mov_b64 exec, s[60:61]
buffer_load_dwordx4 v4, s[8:11], s37 offen lds
s_mov_b64 exec, -1
s_add_u32 m0, s39, 46080
s_nop 0
buffer_load_dwordx4 v5, s[8:11], s37 offen lds
s_add_u32 m0, s39, 49152
s_nop 0
buffer_load_dwordx4 v6, s[8:11], s37 offen lds
s_add_u32 m0, s39, 52224
s_nop 0
buffer_load_dwordx4 v7, s[8:11], s37 offen lds
s_add_u32 m0, s39, 55296
s_nop 0
buffer_load_dwordx4 v8, s[8:11], s37 offen lds
s_add_u32 m0, s39, 58368
s_nop 0
buffer_load_dwordx4 v9, s[8:11], s37 offen lds
s_add_u32 m0, s40, 43008
s_add_u32 s43, s38, 0
buffer_load_dwordx4 v2, s[12:15], s43 offen lds
s_add_u32 m0, s40, 44032
s_add_u32 s43, s38, 49152
buffer_load_dwordx4 v3, s[12:15], s43 offen lds
s_add_u32 m0, s40, 45056
s_add_u32 s43, s38, 98304
buffer_load_dwordx4 v2, s[12:15], s43 offen lds
s_add_u32 m0, s40, 46080
s_add_u32 s43, s38, 147456
buffer_load_dwordx4 v3, s[12:15], s43 offen lds
s_add_u32 m0, s40, 47104
s_add_u32 s43, s38, 196608
buffer_load_dwordx4 v2, s[12:15], s43 offen lds
s_add_u32 m0, s40, 48128
s_add_u32 s43, s38, 245760
buffer_load_dwordx4 v3, s[12:15], s43 offen lds
s_add_u32 m0, s40, 49152
s_add_u32 s43, s38, 294912
buffer_load_dwordx4 v2, s[12:15], s43 offen lds
s_add_u32 m0, s40, 50176
s_add_u32 s43, s38, 344064
buffer_load_dwordx4 v3, s[12:15], s43 offen lds
s_add_u32 s37, s37, 128
s_add_u32 s38, s38, 393216
s_load_dword s3, s[4:5], 0
s_load_dword s3, s[4:5], 64
s_load_dword s3, s[4:5], 128
Lsp_10:
s_waitcnt vmcnt(14)
s_barrier
s_add_u32 m0, s39, 86016
s_mov_b64 exec, s[60:61]
buffer_load_dwordx4 v4, s[8:11], s37 offen lds
s_mov_b64 exec, -1
s_add_u32 m0, s39, 89088
s_nop 0
buffer_load_dwordx4 v5, s[8:11], s37 offen lds
s_add_u32 m0, s39, 92160
s_nop 0
buffer_load_dwordx4 v6, s[8:11], s37 offen lds
s_add_u32 m0, s39, 95232
s_nop 0
buffer_load_dwordx4 v7, s[8:11], s37 offen lds
s_add_u32 m0, s39, 98304
s_nop 0
buffer_load_dwordx4 v8, s[8:11], s37 offen lds
s_add_u32 m0, s39, 101376
s_nop 0
buffer_load_dwordx4 v9, s[8:11], s37 offen lds
s_add_u32 m0, s40, 86016
s_add_u32 s43, s38, 0
buffer_load_dwordx4 v2, s[12:15], s43 offen lds
s_add_u32 m0, s40, 87040
s_add_u32 s43, s38, 49152
buffer_load_dwordx4 v3, s[12:15], s43 offen lds
s_add_u32 m0, s40, 88064
s_add_u32 s43, s38, 98304
buffer_load_dwordx4 v2, s[12:15], s43 offen lds
s_add_u32 m0, s40, 89088
s_add_u32 s43, s38, 147456
buffer_load_dwordx4 v3, s[12:15], s43 offen lds
s_add_u32 m0, s40, 90112
s_add_u32 s43, s38, 196608
buffer_load_dwordx4 v2, s[12:15], s43 offen lds
s_add_u32 m0, s40, 91136
s_add_u32 s43, s38, 245760
buffer_load_dwordx4 v3, s[12:15], s43 offen lds
s_add_u32 m0, s40, 92160
s_add_u32 s43, s38, 294912
buffer_load_dwordx4 v2, s[12:15], s43 offen lds
s_add_u32 m0, s40, 93184
s_add_u32 s43, s38, 344064
buffer_load_dwordx4 v3, s[12:15], s43 offen lds
s_add_u32 s37, s37, 128
s_add_u32 s38, s38, 393216
s_load_dword s3, s[4:5], 192
s_load_dword s3, s[4:5], 7168
s_load_dword s3, s[4:5], 7232
s_load_dword s3, s[4:5], 7296
s_load_dword s3, s[4:5], 7360
Lsp_11:
s_waitcnt vmcnt(14)
s_barrier
s_add_u32 m0, s39, 0
s_mov_b64 exec, s[60:61]
buffer_load_dwordx4 v4, s[8:11], s37 offen lds
s_mov_b64 exec, -1
s_add_u32 m0, s39, 3072
s_nop 0
buffer_load_dwordx4 v5, s[8:11], s37 offen lds
s_add_u32 m0, s39, 6144
s_nop 0
buffer_load_dwordx4 v6, s[8:11], s37 offen lds
s_branch Lov_0
.p2align 12
Lst_0_0:
s_branch Lwr_155
s_nop 0
s_nop 0
Lov_0:
s_add_u32 m0, s39, 9216
s_nop 0
buffer_load_dwordx4 v7, s[8:11], s37 offen lds
s_add_u32 m0, s39, 12288
s_nop 0
buffer_load_dwordx4 v8, s[8:11], s37 offen lds
s_add_u32 m0, s39, 15360
s_nop 0
buffer_load_dwordx4 v9, s[8:11], s37 offen lds
s_add_u32 m0, s40, 0
s_add_u32 s43, s38, 0
buffer_load_dwordx4 v2, s[12:15], s43 offen lds
s_add_u32 m0, s40, 1024
s_add_u32 s43, s38, 49152
buffer_load_dwordx4 v3, s[12:15], s43 offen lds
s_add_u32 m0, s40, 2048
s_add_u32 s43, s38, 98304
buffer_load_dwordx4 v2, s[12:15], s43 offen lds
s_add_u32 m0, s40, 3072
s_add_u32 s43, s38, 147456
buffer_load_dwordx4 v3, s[12:15], s43 offen lds
s_add_u32 m0, s40, 4096
s_add_u32 s43, s38, 196608
buffer_load_dwordx4 v2, s[12:15], s43 offen lds
s_add_u32 m0, s40, 5120
s_add_u32 s43, s38, 245760
buffer_load_dwordx4 v3, s[12:15], s43 offen lds
s_add_u32 m0, s40, 6144
s_add_u32 s43, s38, 294912
buffer_load_dwordx4 v2, s[12:15], s43 offen lds
s_add_u32 m0, s40, 7168
s_add_u32 s43, s38, 344064
buffer_load_dwordx4 v3, s[12:15], s43 offen lds
s_add_u32 s37, s37, 128
s_add_u32 s38, s38, 393216
s_load_dword s3, s[4:5], 14336
s_load_dword s3, s[4:5], 14400
s_load_dword s3, s[4:5], 14464
s_load_dword s3, s[4:5], 14528
s_load_dword s3, s[4:5], 21504
s_load_dword s3, s[4:5], 21568
Lsp_12:
s_waitcnt vmcnt(14)
s_barrier
s_add_u32 m0, s39, 43008
s_mov_b64 exec, s[60:61]
buffer_load_dwordx4 v4, s[8:11], s37 offen lds
s_mov_b64 exec, -1
s_add_u32 m0, s39, 46080
s_nop 0
buffer_load_dwordx4 v5, s[8:11], s37 offen lds
s_add_u32 m0, s39, 49152
s_nop 0
buffer_load_dwordx4 v6, s[8:11], s37 offen lds
s_add_u32 m0, s39, 52224
s_nop 0
buffer_load_dwordx4 v7, s[8:11], s37 offen lds
s_add_u32 m0, s39, 55296
s_nop 0
buffer_load_dwordx4 v8, s[8:11], s37 offen lds
s_add_u32 m0, s39, 58368
s_nop 0
buffer_load_dwordx4 v9, s[8:11], s37 offen lds
s_add_u32 m0, s40, 43008
s_add_u32 s43, s38, 0
buffer_load_dwordx4 v2, s[12:15], s43 offen lds
s_add_u32 m0, s40, 44032
s_add_u32 s43, s38, 49152
buffer_load_dwordx4 v3, s[12:15], s43 offen lds
s_add_u32 m0, s40, 45056
s_add_u32 s43, s38, 98304
buffer_load_dwordx4 v2, s[12:15], s43 offen lds
s_add_u32 m0, s40, 46080
s_add_u32 s43, s38, 147456
buffer_load_dwordx4 v3, s[12:15], s43 offen lds
s_add_u32 m0, s40, 47104
s_add_u32 s43, s38, 196608
buffer_load_dwordx4 v2, s[12:15], s43 offen lds
s_add_u32 m0, s40, 48128
s_add_u32 s43, s38, 245760
buffer_load_dwordx4 v3, s[12:15], s43 offen lds
s_add_u32 m0, s40, 49152
s_add_u32 s43, s38, 294912
buffer_load_dwordx4 v2, s[12:15], s43 offen lds
s_add_u32 m0, s40, 50176
s_add_u32 s43, s38, 344064
buffer_load_dwordx4 v3, s[12:15], s43 offen lds
s_add_u32 s37, s37, 128
s_add_u32 s38, s38, 393216
s_load_dword s3, s[4:5], 21632
s_load_dword s3, s[4:5], 21696
s_load_dword s3, s[4:5], 28672
s_load_dword s3, s[4:5], 28736
s_load_dword s3, s[4:5], 28800
s_load_dword s3, s[4:5], 28864
s_load_dword s3, s[4:5], 35840
Lsp_13:
s_waitcnt vmcnt(14)
s_barrier
s_add_u32 m0, s39, 86016
s_mov_b64 exec, s[60:61]
buffer_load_dwordx4 v4, s[8:11], s37 offen lds
s_mov_b64 exec, -1
s_add_u32 m0, s39, 89088
s_nop 0
buffer_load_dwordx4 v5, s[8:11], s37 offen lds
s_add_u32 m0, s39, 92160
s_nop 0
buffer_load_dwordx4 v6, s[8:11], s37 offen lds
s_add_u32 m0, s39, 95232
s_nop 0
buffer_load_dwordx4 v7, s[8:11], s37 offen lds
s_add_u32 m0, s39, 98304
s_nop 0
buffer_load_dwordx4 v8, s[8:11], s37 offen lds
s_add_u32 m0, s39, 101376
s_nop 0
buffer_load_dwordx4 v9, s[8:11], s37 offen lds
s_add_u32 m0, s40, 86016
s_add_u32 s43, s38, 0
buffer_load_dwordx4 v2, s[12:15], s43 offen lds
s_add_u32 m0, s40, 87040
s_add_u32 s43, s38, 49152
buffer_load_dwordx4 v3, s[12:15], s43 offen lds
s_add_u32 m0, s40, 88064
s_add_u32 s43, s38, 98304
buffer_load_dwordx4 v2, s[12:15], s43 offen lds
s_add_u32 m0, s40, 89088
s_add_u32 s43, s38, 147456
buffer_load_dwordx4 v3, s[12:15], s43 offen lds
s_add_u32 m0, s40, 90112
s_add_u32 s43, s38, 196608
buffer_load_dwordx4 v2, s[12:15], s43 offen lds
s_add_u32 m0, s40, 91136
s_add_u32 s43, s38, 245760
buffer_load_dwordx4 v3, s[12:15], s43 offen lds
s_add_u32 m0, s40, 92160
s_add_u32 s43, s38, 294912
buffer_load_dwordx4 v2, s[12:15], s43 offen lds
s_add_u32 m0, s40, 93184
s_add_u32 s43, s38, 344064
buffer_load_dwordx4 v3, s[12:15], s43 offen lds
s_add_u32 s37, s37, 128
s_add_u32 s38, s38, 393216
s_load_dword s3, s[4:5], 35904
s_load_dword s3, s[4:5], 35968
s_load_dword s3, s[4:5], 36032
s_load_dword s3, s[4:5], 43008
s_load_dword s3, s[4:5], 43072
s_load_dword s3, s[4:5], 43136
s_load_dword s3, s[4:5], 43200
s_load_dword s3, s[4:5], 50176
Lsp_14:
s_waitcnt vmcnt(14)
s_barrier
s_add_u32 m0, s39, 0
s_mov_b64 exec, s[60:61]
buffer_load_dwordx4 v4, s[8:11], s37 offen lds
s_mov_b64 exec, -1
s_add_u32 m0, s39, 3072
s_nop 0
buffer_load_dwordx4 v5, s[8:11], s37 offen lds
s_add_u32 m0, s39, 6144
s_nop 0
buffer_load_dwordx4 v6, s[8:11], s37 offen lds
s_add_u32 m0, s39, 9216
s_nop 0
buffer_load_dwordx4 v7, s[8:11], s37 offen lds
s_add_u32 m0, s39, 12288
s_nop 0
buffer_load_dwordx4 v8, s[8:11], s37 offen lds
s_add_u32 m0, s39, 15360
s_nop 0
buffer_load_dwordx4 v9, s[8:11], s37 offen lds
s_add_u32 m0, s40, 0
s_add_u32 s43, s38, 0
buffer_load_dwordx4 v2, s[12:15], s43 offen lds
s_add_u32 m0, s40, 1024
s_add_u32 s43, s38, 49152
buffer_load_dwordx4 v3, s[12:15], s43 offen lds
s_add_u32 m0, s40, 2048
s_add_u32 s43, s38, 98304
buffer_load_dwordx4 v2, s[12:15], s43 offen lds
s_add_u32 m0, s40, 3072
s_add_u32 s43, s38, 147456
buffer_load_dwordx4 v3, s[12:15], s43 offen lds
s_add_u32 m0, s40, 4096
s_add_u32 s43, s38, 196608
buffer_load_dwordx4 v2, s[12:15], s43 offen lds
s_add_u32 m0, s40, 5120
s_add_u32 s43, s38, 245760
buffer_load_dwordx4 v3, s[12:15], s43 offen lds
s_add_u32 m0, s40, 6144
s_add_u32 s43, s38, 294912
buffer_load_dwordx4 v2, s[12:15], s43 offen lds
s_add_u32 m0, s40, 7168
s_add_u32 s43, s38, 344064
buffer_load_dwordx4 v3, s[12:15], s43 offen lds
s_add_u32 s37, s37, 128
s_add_u32 s38, s38, 393216
s_load_dword s3, s[4:5], 50240
s_load_dword s3, s[4:5], 50304
s_load_dword s3, s[4:5], 50368
s_load_dword s3, s[4:5], 57344
s_load_dword s3, s[4:5], 57408
s_load_dword s3, s[4:5], 57472
s_load_dword s3, s[4:5], 57536
s_load_dword s3, s[4:5], 64512
s_load_dword s3, s[4:5], 64576
Lsp_15:
s_waitcnt vmcnt(14)
s_barrier
s_add_u32 m0, s39, 43008
s_mov_b64 exec, s[60:61]
buffer_load_dwordx4 v4, s[8:11], s37 offen lds
s_mov_b64 exec, -1
s_add_u32 m0, s39, 46080
s_nop 0
buffer_load_dwordx4 v5, s[8:11], s37 offen lds
s_add_u32 m0, s39, 49152
s_nop 0
buffer_load_dwordx4 v6, s[8:11], s37 offen lds
s_add_u32 m0, s39, 52224
s_nop 0
buffer_load_dwordx4 v7, s[8:11], s37 offen lds
s_add_u32 m0, s39, 55296
s_nop 0
buffer_load_dwordx4 v8, s[8:11], s37 offen lds
s_add_u32 m0, s39, 58368
s_nop 0
buffer_load_dwordx4 v9, s[8:11], s37 offen lds
s_add_u32 m0, s40, 43008
s_add_u32 s43, s38, 0
buffer_load_dwordx4 v2, s[12:15], s43 offen lds
s_add_u32 m0, s40, 44032
s_add_u32 s43, s38, 49152
buffer_load_dwordx4 v3, s[12:15], s43 offen lds
s_add_u32 m0, s40, 45056
s_add_u32 s43, s38, 98304
buffer_load_dwordx4 v2, s[12:15], s43 offen lds
s_add_u32 m0, s40, 46080
s_add_u32 s43, s38, 147456
buffer_load_dwordx4 v3, s[12:15], s43 offen lds
s_add_u32 m0, s40, 47104
s_add_u32 s43, s38, 196608
buffer_load_dwordx4 v2, s[12:15], s43 offen lds
s_add_u32 m0, s40, 48128
s_add_u32 s43, s38, 245760
buffer_load_dwordx4 v3, s[12:15], s43 offen lds
s_add_u32 m0, s40, 49152
s_add_u32 s43, s38, 294912
buffer_load_dwordx4 v2, s[12:15], s43 offen lds
s_add_u32 m0, s40, 50176
s_add_u32 s43, s38, 344064
buffer_load_dwordx4 v3, s[12:15], s43 offen lds
s_add_u32 s37, s37, 128
s_add_u32 s38, s38, 393216
s_load_dword s3, s[4:5], 64640
s_load_dword s3, s[4:5], 64704
s_load_dword s3, s[4:5], 71680
s_load_dword s3, s[4:5], 71744
s_load_dword s3, s[4:5], 71808
s_load_dword s3, s[4:5], 71872
s_load_dword s3, s[4:5], 78848
s_load_dword s3, s[4:5], 78912
s_load_dword s3, s[4:5], 78976
s_load_dword s3, s[4:5], 79040
Lsp_16:
s_waitcnt vmcnt(14)
s_barrier
s_add_u32 m0, s39, 86016
s_mov_b64 exec, s[60:61]
buffer_load_dwordx4 v4, s[8:11], s37 offen lds
s_mov_b64 exec, -1
s_add_u32 m0, s39, 89088
s_nop 0
buffer_load_dwordx4 v5, s[8:11], s37 offen lds
s_add_u32 m0, s39, 92160
s_nop 0
buffer_load_dwordx4 v6, s[8:11], s37 offen lds
s_add_u32 m0, s39, 95232
s_nop 0
buffer_load_dwordx4 v7, s[8:11], s37 offen lds
s_add_u32 m0, s39, 98304
s_nop 0
buffer_load_dwordx4 v8, s[8:11], s37 offen lds
s_add_u32 m0, s39, 101376
s_nop 0
buffer_load_dwordx4 v9, s[8:11], s37 offen lds
s_add_u32 m0, s40, 86016
s_add_u32 s43, s38, 0
buffer_load_dwordx4 v2, s[12:15], s43 offen lds
s_add_u32 m0, s40, 87040
s_add_u32 s43, s38, 49152
buffer_load_dwordx4 v3, s[12:15], s43 offen lds
s_add_u32 m0, s40, 88064
s_add_u32 s43, s38, 98304
buffer_load_dwordx4 v2, s[12:15], s43 offen lds
s_add_u32 m0, s40, 89088
s_add_u32 s43, s38, 147456
buffer_load_dwordx4 v3, s[12:15], s43 offen lds
s_add_u32 m0, s40, 90112
s_add_u32 s43, s38, 196608
buffer_load_dwordx4 v2, s[12:15], s43 offen lds
s_add_u32 m0, s40, 91136
s_add_u32 s43, s38, 245760
buffer_load_dwordx4 v3, s[12:15], s43 offen lds
s_add_u32 m0, s40, 92160
s_add_u32 s43, s38, 294912
buffer_load_dwordx4 v2, s[12:15], s43 offen lds
s_add_u32 m0, s40, 93184
s_add_u32 s43, s38, 344064
buffer_load_dwordx4 v3, s[12:15], s43 offen lds
s_add_u32 s37, s37, 128
s_add_u32 s38, s38, 393216
s_load_dword s3, s[4:5], 86016
s_load_dword s3, s[4:5], 86080
s_load_dword s3, s[4:5], 86144
s_load_dword s3, s[4:5], 86208
s_load_dword s3, s[4:5], 93184
s_load_dword s3, s[4:5], 93248
s_load_dword s3, s[4:5], 93312
s_load_dword s3, s[4:5], 93376
s_load_dword s3, s[4:5], 100352
s_load_dword s3, s[4:5], 100416
Lsp_17:
s_waitcnt vmcnt(14)
s_barrier
s_add_u32 m0, s39, 0
s_mov_b64 exec, s[60:61]
buffer_load_dwordx4 v4, s[8:11], s37 offen lds
s_mov_b64 exec, -1
s_add_u32 m0, s39, 3072
s_nop 0
buffer_load_dwordx4 v5, s[8:11], s37 offen lds
s_add_u32 m0, s39, 6144
s_nop 0
buffer_load_dwordx4 v6, s[8:11], s37 offen lds
s_add_u32 m0, s39, 9216
s_nop 0
buffer_load_dwordx4 v7, s[8:11], s37 offen lds
s_add_u32 m0, s39, 12288
s_nop 0
buffer_load_dwordx4 v8, s[8:11], s37 offen lds
s_add_u32 m0, s39, 15360
s_nop 0
buffer_load_dwordx4 v9, s[8:11], s37 offen lds
s_add_u32 m0, s40, 0
s_add_u32 s43, s38, 0
buffer_load_dwordx4 v2, s[12:15], s43 offen lds
s_add_u32 m0, s40, 1024
s_add_u32 s43, s38, 49152
buffer_load_dwordx4 v3, s[12:15], s43 offen lds
s_add_u32 m0, s40, 2048
s_add_u32 s43, s38, 98304
buffer_load_dwordx4 v2, s[12:15], s43 offen lds
s_add_u32 m0, s40, 3072
s_add_u32 s43, s38, 147456
buffer_load_dwordx4 v3, s[12:15], s43 offen lds
s_add_u32 m0, s40, 4096
s_add_u32 s43, s38, 196608
buffer_load_dwordx4 v2, s[12:15], s43 offen lds
s_add_u32 m0, s40, 5120
s_add_u32 s43, s38, 245760
buffer_load_dwordx4 v3, s[12:15], s43 offen lds
s_add_u32 m0, s40, 6144
s_add_u32 s43, s38, 294912
buffer_load_dwordx4 v2, s[12:15], s43 offen lds
s_add_u32 m0, s40, 7168
s_add_u32 s43, s38, 344064
buffer_load_dwordx4 v3, s[12:15], s43 offen lds
s_add_u32 s37, s37, 128
s_add_u32 s38, s38, 393216
s_load_dword s3, s[4:5], 100480
s_load_dword s3, s[4:5], 100544
s_load_dword s3, s[4:5], 107520
s_load_dword s3, s[4:5], 107584
s_load_dword s3, s[4:5], 107648
s_load_dword s3, s[4:5], 107712
s_load_dword s3, s[4:5], 114688
s_load_dword s3, s[4:5], 114752
s_load_dword s3, s[4:5], 114816
s_load_dword s3, s[4:5], 114880
s_load_dword s3, s[4:5], 121856
Lsp_18:
s_waitcnt vmcnt(14)
s_barrier
s_add_u32 m0, s39, 43008
s_mov_b64 exec, s[60:61]
buffer_load_dwordx4 v4, s[8:11], s37 offen lds
s_mov_b64 exec, -1
s_add_u32 m0, s39, 46080
s_nop 0
buffer_load_dwordx4 v5, s[8:11], s37 offen lds
s_add_u32 m0, s39, 49152
s_nop 0
buffer_load_dwordx4 v6, s[8:11], s37 offen lds
s_add_u32 m0, s39, 52224
s_nop 0
buffer_load_dwordx4 v7, s[8:11], s37 offen lds
s_add_u32 m0, s39, 55296
s_nop 0
buffer_load_dwordx4 v8, s[8:11], s37 offen lds
s_add_u32 m0, s39, 58368
s_nop 0
buffer_load_dwordx4 v9, s[8:11], s37 offen lds
s_add_u32 m0, s40, 43008
s_add_u32 s43, s38, 0
buffer_load_dwordx4 v2, s[12:15], s43 offen lds
s_add_u32 m0, s40, 44032
s_add_u32 s43, s38, 49152
buffer_load_dwordx4 v3, s[12:15], s43 offen lds
s_add_u32 m0, s40, 45056
s_add_u32 s43, s38, 98304
buffer_load_dwordx4 v2, s[12:15], s43 offen lds
s_add_u32 m0, s40, 46080
s_add_u32 s43, s38, 147456
buffer_load_dwordx4 v3, s[12:15], s43 offen lds
s_add_u32 m0, s40, 47104
s_add_u32 s43, s38, 196608
buffer_load_dwordx4 v2, s[12:15], s43 offen lds
s_add_u32 m0, s40, 48128
s_add_u32 s43, s38, 245760
buffer_load_dwordx4 v3, s[12:15], s43 offen lds
s_add_u32 m0, s40, 49152
s_add_u32 s43, s38, 294912
buffer_load_dwordx4 v2, s[12:15], s43 offen lds
s_add_u32 m0, s40, 50176
s_add_u32 s43, s38, 344064
buffer_load_dwordx4 v3, s[12:15], s43 offen lds
s_add_u32 s37, s37, 128
s_add_u32 s38, s38, 393216
s_load_dword s3, s[4:5], 121920
s_load_dword s3, s[4:5], 121984
s_load_dword s3, s[4:5], 122048
s_load_dword s3, s[4:5], 129024
s_load_dword s3, s[4:5], 129088
s_load_dword s3, s[4:5], 129152
s_load_dword s3, s[4:5], 129216
s_load_dword s3, s[4:5], 136192
s_load_dword s3, s[4:5], 136256
s_load_dword s3, s[4:5], 136320
s_load_dword s3, s[4:5], 136384
Lsp_19:
s_waitcnt vmcnt(14)
s_barrier
s_add_u32 m0, s39, 86016
s_mov_b64 exec, s[60:61]
buffer_load_dwordx4 v4, s[8:11], s37 offen lds
s_mov_b64 exec, -1
s_add_u32 m0, s39, 89088
s_nop 0
buffer_load_dwordx4 v5, s[8:11], s37 offen lds
s_add_u32 m0, s39, 92160
s_nop 0
buffer_load_dwordx4 v6, s[8:11], s37 offen lds
s_add_u32 m0, s39, 95232
s_nop 0
buffer_load_dwordx4 v7, s[8:11], s37 offen lds
s_add_u32 m0, s39, 98304
s_nop 0
buffer_load_dwordx4 v8, s[8:11], s37 offen lds
s_add_u32 m0, s39, 101376
s_nop 0
buffer_load_dwordx4 v9, s[8:11], s37 offen lds
s_add_u32 m0, s40, 86016
s_add_u32 s43, s38, 0
buffer_load_dwordx4 v2, s[12:15], s43 offen lds
s_add_u32 m0, s40, 87040
s_add_u32 s43, s38, 49152
buffer_load_dwordx4 v3, s[12:15], s43 offen lds
s_add_u32 m0, s40, 88064
s_add_u32 s43, s38, 98304
buffer_load_dwordx4 v2, s[12:15], s43 offen lds
s_add_u32 m0, s40, 89088
s_add_u32 s43, s38, 147456
buffer_load_dwordx4 v3, s[12:15], s43 offen lds
s_add_u32 m0, s40, 90112
s_add_u32 s43, s38, 196608
buffer_load_dwordx4 v2, s[12:15], s43 offen lds
s_add_u32 m0, s40, 91136
s_add_u32 s43, s38, 245760
buffer_load_dwordx4 v3, s[12:15], s43 offen lds
s_add_u32 m0, s40, 92160
s_add_u32 s43, s38, 294912
buffer_load_dwordx4 v2, s[12:15], s43 offen lds
s_add_u32 m0, s40, 93184
s_add_u32 s43, s38, 344064
buffer_load_dwordx4 v3, s[12:15], s43 offen lds
s_add_u32 s37, s37, 128
s_add_u32 s38, s38, 393216
s_load_dword s3, s[4:5], 143360
s_load_dword s3, s[4:5], 143424
s_load_dword s3, s[4:5], 143488
s_load_dword s3, s[4:5], 143552
s_load_dword s3, s[4:5], 150528
s_load_dword s3, s[4:5], 150592
s_load_dword s3, s[4:5], 150656
s_load_dword s3, s[4:5], 150720
s_load_dword s3, s[4:5], 157696
s_load_dword s3, s[4:5], 157760
s_load_dword s3, s[4:5], 157824
Lsp_20:
s_waitcnt vmcnt(14)
s_barrier
s_add_u32 m0, s39, 0
s_mov_b64 exec, s[60:61]
buffer_load_dwordx4 v4, s[8:11], s37 offen lds
s_mov_b64 exec, -1
s_add_u32 m0, s39, 3072
s_nop 0
buffer_load_dwordx4 v5, s[8:11], s37 offen lds
s_add_u32 m0, s39, 6144
s_nop 0
buffer_load_dwordx4 v6, s[8:11], s37 offen lds
s_add_u32 m0, s39, 9216
s_nop 0
buffer_load_dwordx4 v7, s[8:11], s37 offen lds
s_add_u32 m0, s39, 12288
s_nop 0
buffer_load_dwordx4 v8, s[8:11], s37 offen lds
s_add_u32 m0, s39, 15360
s_nop 0
buffer_load_dwordx4 v9, s[8:11], s37 offen lds
s_add_u32 m0, s40, 0
s_add_u32 s43, s38, 0
buffer_load_dwordx4 v2, s[12:15], s43 offen lds
s_add_u32 m0, s40, 1024
s_add_u32 s43, s38, 49152
buffer_load_dwordx4 v3, s[12:15], s43 offen lds
s_add_u32 m0, s40, 2048
s_add_u32 s43, s38, 98304
buffer_load_dwordx4 v2, s[12:15], s43 offen lds
s_add_u32 m0, s40, 3072
s_add_u32 s43, s38, 147456
buffer_load_dwordx4 v3, s[12:15], s43 offen lds
s_add_u32 m0, s40, 4096
s_add_u32 s43, s38, 196608
buffer_load_dwordx4 v2, s[12:15], s43 offen lds
s_add_u32 m0, s40, 5120
s_add_u32 s43, s38, 245760
buffer_load_dwordx4 v3, s[12:15], s43 offen lds
s_add_u32 m0, s40, 6144
s_add_u32 s43, s38, 294912
buffer_load_dwordx4 v2, s[12:15], s43 offen lds
s_add_u32 m0, s40, 7168
s_add_u32 s43, s38, 344064
buffer_load_dwordx4 v3, s[12:15], s43 offen lds
s_add_u32 s37, s37, 128
s_add_u32 s38, s38, 393216
s_load_dword s3, s[4:5], 157888
s_load_dword s3, s[4:5], 164864
s_load_dword s3, s[4:5], 164928
s_load_dword s3, s[4:5], 164992
s_load_dword s3, s[4:5], 165056
s_load_dword s3, s[4:5], 172032
s_load_dword s3, s[4:5], 172096
s_load_dword s3, s[4:5], 172160
s_load_dword s3, s[4:5], 172224
s_load_dword s3, s[4:5], 179200
s_load_dword s3, s[4:5], 179264
Lsp_21:
s_waitcnt vmcnt(14)
s_barrier
s_load_dword s3, s[4:5], 179328
s_load_dword s3, s[4:5], 179392
s_load_dword s3, s[4:5], 186368
s_load_dword s3, s[4:5], 186432
s_load_dword s3, s[4:5], 186496
s_load_dword s3, s[4:5], 186560
s_load_dword s3, s[4:5], 193536
s_branch Lov_1
.p2align 12
Lst_1_0:
s_branch Lwr_156
s_nop 0
s_nop 0
Lov_1:
s_load_dword s3, s[4:5], 193600
s_load_dword s3, s[4:5], 193664
s_load_dword s3, s[4:5], 193728
Lsp_22:
s_waitcnt vmcnt(0)
s_barrier
s_lshl_b32 s43, s35, 7
s_add_u32 s28, s68, s43
s_addc_u32 s29, s69, 0
s_mov_b32 s30, 2095232
s_mov_b32 s31, 0x20000
v_lshrrev_b32 v15, 3, v1
v_and_b32 v16, 6, v15
v_and_b32 v7, 7, v1
v_xor_b32 v7, v7, v16
v_lshlrev_b32 v7, 4, v7
v_mul_u32_u24 v15, 2048, v15
v_add_u32 v7, v7, v15
s_and_b32 s40, s36, 3
s_lshl_b32 s39, s40, 13
s_add_u32 s40, s40, s35
s_add_u32 s42, s40, 0
s_and_b32 s42, s42, 15
s_lshl_b32 s42, s42, 17
s_add_u32 m0, s39, 65536
s_add_u32 s43, s42, 0
buffer_load_dwordx4 v7, s[28:31], s43 offen lds
s_add_u32 m0, s39, 66560
s_add_u32 s43, s42, 16384
buffer_load_dwordx4 v7, s[28:31], s43 offen lds
s_add_u32 m0, s39, 67584
s_add_u32 s43, s42, 32768
buffer_load_dwordx4 v7, s[28:31], s43 offen lds
s_add_u32 m0, s39, 68608
s_add_u32 s43, s42, 49152
buffer_load_dwordx4 v7, s[28:31], s43 offen lds
s_add_u32 m0, s39, 69632
s_add_u32 s43, s42, 65536
buffer_load_dwordx4 v7, s[28:31], s43 offen lds
s_add_u32 m0, s39, 70656
s_add_u32 s43, s42, 81920
buffer_load_dwordx4 v7, s[28:31], s43 offen lds
s_add_u32 m0, s39, 71680
s_add_u32 s43, s42, 98304
buffer_load_dwordx4 v7, s[28:31], s43 offen lds
s_add_u32 m0, s39, 72704
s_add_u32 s43, s42, 114688
buffer_load_dwordx4 v7, s[28:31], s43 offen lds
s_bitcmp0_b32 s2, 0
s_cselect_b32 s88, s72, s74
s_cselect_b32 s89, s73, s75
s_cmp_lt_u32 s2, 192
s_cselect_b32 s90, 7340032, 0
s_mov_b32 s91, 0x20000
s_bfe_u32 s44, s2, 0x30001
s_lshl_b32 s44, s44, 2
s_and_b32 s43, s36, 3
s_add_u32 s44, s44, s43
s_lshl_b32 s44, s44, 5
v_lshrrev_b32 v18, 4, v1
v_add_u32 v18, s44, v18
v_mul_u32_u24 v18, 7168, v18
v_and_b32 v19, 15, v1
v_lshl_add_u32 v18, v19, 4, v18
s_lshr_b32 s43, s2, 4
s_lshl_b32 s43, s43, 8
s_add_u32 s43, s43, 4096
v_add_u32 v18, s43, v18
s_mov_b32 s43, 0
buffer_load_dwordx4 v[128:131], v18, s[88:91], s43 offen
s_mov_b32 s43, 28672
buffer_load_dwordx4 v[132:135], v18, s[88:91], s43 offen
s_mov_b32 s43, 57344
buffer_load_dwordx4 v[136:139], v18, s[88:91], s43 offen
s_mov_b32 s43, 86016
buffer_load_dwordx4 v[140:143], v18, s[88:91], s43 offen
s_mov_b32 s43, 114688
buffer_load_dwordx4 v[144:147], v18, s[88:91], s43 offen
s_mov_b32 s43, 143360
buffer_load_dwordx4 v[148:151], v18, s[88:91], s43 offen
s_mov_b32 s43, 172032
buffer_load_dwordx4 v[152:155], v18, s[88:91], s43 offen
s_mov_b32 s43, 200704
buffer_load_dwordx4 v[156:159], v18, s[88:91], s43 offen
s_barrier
s_branch Lats_6
Lcons_7:
s_lshl_b32 s43, s35, 7
s_waitcnt lgkmcnt(0)
s_mov_b32 s8, s64
s_mov_b32 s9, s65
s_mov_b32 s10, 4194304
s_mov_b32 s11, 0x20000
s_add_u32 s12, s66, s43
s_addc_u32 s13, s67, 0
s_mov_b32 s14, 6289536
s_mov_b32 s15, 0x20000
s_lshr_b32 s43, s2, 3
s_lshl_b32 s43, s43, 2
s_add_u32 s43, s43, s36
s_sub_u32 s44, s43, 0
s_and_b32 s44, s44, 127
s_cmp_lt_u32 s44, 24
s_cbranch_scc0 Lt_23
s_lshl_b32 s44, s44, 20
s_min_u32 s44, s44, 24117184
s_load_dword s3, s[82:83], s44 glc
Lt_23:
s_sub_u32 s44, s43, 24
s_and_b32 s44, s44, 127
s_cmp_lt_u32 s44, 8
s_cbranch_scc0 Lt_24
s_lshl_b32 s44, s44, 20
s_min_u32 s44, s44, 7339968
s_load_dword s3, s[72:73], s44
Lt_24:
s_sub_u32 s44, s43, 32
s_and_b32 s44, s44, 127
s_cmp_lt_u32 s44, 8
s_cbranch_scc0 Lt_25
s_lshl_b32 s44, s44, 20
s_min_u32 s44, s44, 7339968
s_load_dword s3, s[74:75], s44
Lt_25:
s_sub_u32 s44, s43, 40
s_and_b32 s44, s44, 127
s_cmp_lt_u32 s44, 3
s_cbranch_scc0 Lt_26
s_lshl_b32 s44, s44, 20
s_min_u32 s44, s44, 2097088
s_load_dword s3, s[68:69], s44
Lt_26:
s_sub_u32 s44, s43, 43
s_and_b32 s44, s44, 127
s_cmp_lt_u32 s44, 5
s_cbranch_scc0 Lt_27
s_lshl_b32 s44, s44, 20
s_min_u32 s44, s44, 4194240
s_add_u32 s44, s44, 25165824
s_load_dword s3, s[82:83], s44 glc
Lt_27:
s_sub_u32 s44, s43, 48
s_and_b32 s44, s44, 127
s_cmp_lt_u32 s44, 8
s_cbranch_scc0 Lt_28
s_lshl_b32 s44, s44, 20
s_min_u32 s44, s44, 7339968
s_load_dword s3, s[76:77], s44
Lt_28:
s_sub_u32 s44, s43, 56
s_and_b32 s44, s44, 127
s_cmp_lt_u32 s44, 5
s_cbranch_scc0 Lt_29
s_lshl_b32 s44, s44, 20
s_min_u32 s44, s44, 4194240
s_add_u32 s44, s44, 33554432
s_load_dword s3, s[82:83], s44 glc
Lt_29:
s_sub_u32 s44, s43, 61
s_and_b32 s44, s44, 127
s_cmp_lt_u32 s44, 5
s_cbranch_scc0 Lt_30
s_lshl_b32 s44, s44, 20
s_min_u32 s44, s44, 4194240
s_load_dword s3, s[78:79], s44 glc
Lt_30:
v_lshrrev_b32 v16, 1, v12
v_xor_b32 v15, v13, v16
v_lshlrev_b32 v15, 4, v15
v_lshl_add_u32 v2, v12, 7, v15
v_xor_b32 v3, 64, v2
v_add_u32 v4, 86016, v2
v_add_u32 v5, 86016, v3
v_lshrrev_b32 v15, 2, v12
v_and_b32 v16, 3, v1
v_lshl_add_u32 v19, v13, 3, v15
v_lshlrev_b32 v19, 7, v19
v_and_b32 v15, 2, v15
v_and_b32 v17, 1, v13
v_lshl_add_u32 v15, v17, 2, v15
v_lshrrev_b32 v17, 1, v16
s_lshl_b32 s43, s36, 1
v_add_u32 v17, s43, v17
v_xor_b32 v15, v15, v17
v_lshl_add_u32 v19, v15, 4, v19
v_and_b32 v16, 1, v16
v_lshl_add_u32 v19, v16, 3, v19
v_add_u32 v6, 18432, v19
v_add_u32 v7, 61440, v19
v_add_u32 v8, 104448, v19
s_and_b32 s43, s36, 1
s_bfe_u32 s44, s36, 0x10001
s_lshr_b32 s45, s36, 2
v_lshlrev_b32 v14, 2, v13
v_sub_u32 v14, v12, v14
v_mov_b32 v16, 0xff800000
s_or_b32 s46, s34, s45
s_cmp_lg_u32 s46, 0
s_cselect_b32 s46, 0, 0xff800000
v_subrev_u32 v15, 0, v14
v_cmp_ge_u32 vcc, 7, v15
v_add_u32 v15, 16, v15
s_nop 0
v_cndmask_b32 v248, v16, 0, vcc
v_cmp_ge_u32 vcc, 7, v15
s_nop 1
v_cndmask_b32 v244, v16, 0, vcc
v_or_b32 v240, s46, v244
v_subrev_u32 v15, 1, v14
v_cmp_ge_u32 vcc, 7, v15
v_add_u32 v15, 16, v15
s_nop 0
v_cndmask_b32 v249, v16, 0, vcc
v_cmp_ge_u32 vcc, 7, v15
s_nop 1
v_cndmask_b32 v245, v16, 0, vcc
v_or_b32 v241, s46, v245
v_subrev_u32 v15, 2, v14
v_cmp_ge_u32 vcc, 7, v15
v_add_u32 v15, 16, v15
s_nop 0
v_cndmask_b32 v250, v16, 0, vcc
v_cmp_ge_u32 vcc, 7, v15
s_nop 1
v_cndmask_b32 v246, v16, 0, vcc
v_or_b32 v242, s46, v246
v_subrev_u32 v15, 3, v14
v_cmp_ge_u32 vcc, 7, v15
v_add_u32 v15, 16, v15
s_nop 0
v_cndmask_b32 v251, v16, 0, vcc
v_cmp_ge_u32 vcc, 7, v15
s_nop 1
v_cndmask_b32 v247, v16, 0, vcc
v_or_b32 v243, s46, v247
s_lshl_b32 s46, s45, 6
s_add_u32 s46, s46, s44
s_add_u32 s46, s46, 16
v_lshl_add_u32 v14, v12, 1, s46
s_lshl_b32 s47, s43, 6
v_lshl_add_u32 v15, v13, 4, s47
v_mul_u32_u24 v20, 400, v14
v_add_u32 v20, v20, v15
v_subrev_u32 v16, 32, v14
v_max_i32 v16, 0, v16
v_mul_u32_u24 v21, 400, v16
v_add_u32 v21, v21, v15
v_lshrrev_b32 v16, 2, v12
v_lshl_add_u32 v16, v13, 2, v16
v_lshl_add_u32 v16, v16, 1, s46
v_and_b32 v17, 3, v1
v_lshl_add_u32 v17, v17, 3, s47
v_mul_u32_u24 v22, 400, v16
v_add_u32 v22, v22, v17
v_subrev_u32 v16, 32, v16
v_max_i32 v16, 0, v16
v_mul_u32_u24 v23, 400, v16
v_add_u32 v23, v23, v17
s_mul_i32 s60, s34, 262144
s_add_u32 s16, s82, s60
s_addc_u32 s17, s83, 0
s_mov_b32 s18, 262144
s_mov_b32 s19, 0x20000
s_lshl_b32 s60, s35, 14
s_lshl_b32 s43, s43, 13
s_add_u32 s60, s60, s43
s_lshl_b32 s43, s45, 12
s_add_u32 s60, s60, s43
s_lshl_b32 s43, s44, 10
s_add_u32 s60, s60, s43
v_lshlrev_b32 v24, 4, v1
s_mov_b32 s61, 0x3e8293ee
s_lshl_b32 s38, s35, 7
s_add_u32 s56, s82, 28311552
s_addc_u32 s57, s83, 0
s_mov_b32 s58, 114688
s_mov_b32 s59, 0x20000
s_barrier
ds_read_b128 v[32:35], v2 offset:0
ds_read_b64_tr_b16 v[72:73], v6 offset:8192
ds_read_b64_tr_b16 v[74:75], v6 offset:8704
ds_read_b64_tr_b16 v[76:77], v6 offset:16384
ds_read_b64_tr_b16 v[78:79], v6 offset:16896
ds_read_b64_tr_b16 v[68:69], v6 offset:0
ds_read_b64_tr_b16 v[70:71], v6 offset:512
ds_read_b128 v[36:39], v2 offset:2048
ds_read_b128 v[40:43], v2 offset:4096
ds_read_b128 v[44:47], v2 offset:6144
ds_read_b128 v[48:51], v2 offset:8192
ds_read_b128 v[52:55], v2 offset:10240
ds_read_b128 v[56:59], v2 offset:12288
ds_read_b128 v[60:63], v2 offset:14336
ds_read_b128 v[64:67], v2 offset:16384
s_waitcnt lgkmcnt(0)
v_mfma_f32_16x16x32_bf16 v[128:131], v[68:71], v[32:35], 0
ds_read_b128 v[80:83], v3 offset:0
v_mfma_f32_16x16x32_bf16 v[132:135], v[68:71], v[36:39], 0
ds_read_b64_tr_b16 v[120:121], v6 offset:12288
v_mfma_f32_16x16x32_bf16 v[136:139], v[68:71], v[40:43], 0
ds_read_b64_tr_b16 v[122:123], v6 offset:12800
v_mfma_f32_16x16x32_bf16 v[140:143], v[68:71], v[44:47], 0
ds_read_b64_tr_b16 v[124:125], v6 offset:20480
v_mfma_f32_16x16x32_bf16 v[144:147], v[68:71], v[48:51], 0
ds_read_b64_tr_b16 v[126:127], v6 offset:20992
v_mfma_f32_16x16x32_bf16 v[148:151], v[68:71], v[52:55], 0
ds_read_b64_tr_b16 v[116:117], v6 offset:4096
v_mfma_f32_16x16x32_bf16 v[152:155], v[68:71], v[56:59], 0
ds_read_b64_tr_b16 v[118:119], v6 offset:4608
v_mfma_f32_16x16x32_bf16 v[156:159], v[68:71], v[60:63], 0
ds_read_b128 v[84:87], v3 offset:2048
v_mfma_f32_16x16x32_bf16 v[160:163], v[68:71], v[64:67], 0
ds_read_b128 v[88:91], v3 offset:4096
v_mfma_f32_16x16x32_bf16 v[196:199], v[72:75], v[64:67], 0
ds_read_b128 v[92:95], v3 offset:6144
v_mfma_f32_16x16x32_bf16 v[192:195], v[72:75], v[60:63], 0
ds_read_b128 v[96:99], v3 offset:8192
v_mfma_f32_16x16x32_bf16 v[188:191], v[72:75], v[56:59], 0
ds_read_b128 v[100:103], v3 offset:10240
v_mfma_f32_16x16x32_bf16 v[184:187], v[72:75], v[52:55], 0
ds_read_b128 v[104:107], v3 offset:12288
v_mfma_f32_16x16x32_bf16 v[180:183], v[72:75], v[48:51], 0
ds_read_b128 v[108:111], v3 offset:14336
v_mfma_f32_16x16x32_bf16 v[176:179], v[72:75], v[44:47], 0
ds_read_b128 v[112:115], v3 offset:16384
v_mfma_f32_16x16x32_bf16 v[172:175], v[72:75], v[40:43], 0
v_mfma_f32_16x16x32_bf16 v[168:171], v[72:75], v[36:39], 0
v_mfma_f32_16x16x32_bf16 v[164:167], v[72:75], v[32:35], 0
v_mfma_f32_16x16x32_bf16 v[200:203], v[76:79], v[32:35], 0
v_mfma_f32_16x16x32_bf16 v[204:207], v[76:79], v[36:39], 0
v_mfma_f32_16x16x32_bf16 v[208:211], v[76:79], v[40:43], 0
v_mfma_f32_16x16x32_bf16 v[212:215], v[76:79], v[44:47], 0
v_mfma_f32_16x16x32_bf16 v[216:219], v[76:79], v[48:51], 0
v_mfma_f32_16x16x32_bf16 v[220:223], v[76:79], v[52:55], 0
v_mfma_f32_16x16x32_bf16 v[224:227], v[76:79], v[56:59], 0
v_mfma_f32_16x16x32_bf16 v[228:231], v[76:79], v[60:63], 0
v_mfma_f32_16x16x32_bf16 v[232:235], v[76:79], v[64:67], 0
s_waitcnt lgkmcnt(0)
s_barrier
v_mfma_f32_16x16x32_bf16 v[128:131], v[116:119], v[80:83], v[128:131]
ds_read_b128 v[32:35], v2 offset:43008
v_mfma_f32_16x16x32_bf16 v[132:135], v[116:119], v[84:87], v[132:135]
ds_read_b64_tr_b16 v[72:73], v7 offset:8192
v_mfma_f32_16x16x32_bf16 v[136:139], v[116:119], v[88:91], v[136:139]
ds_read_b64_tr_b16 v[74:75], v7 offset:8704
v_mfma_f32_16x16x32_bf16 v[140:143], v[116:119], v[92:95], v[140:143]
ds_read_b64_tr_b16 v[76:77], v7 offset:16384
v_mfma_f32_16x16x32_bf16 v[144:147], v[116:119], v[96:99], v[144:147]
ds_read_b64_tr_b16 v[78:79], v7 offset:16896
v_mfma_f32_16x16x32_bf16 v[148:151], v[116:119], v[100:103], v[148:151]
ds_read_b64_tr_b16 v[68:69], v7 offset:0
v_mfma_f32_16x16x32_bf16 v[152:155], v[116:119], v[104:107], v[152:155]
ds_read_b64_tr_b16 v[70:71], v7 offset:512
v_mfma_f32_16x16x32_bf16 v[156:159], v[116:119], v[108:111], v[156:159]
ds_read_b128 v[36:39], v2 offset:45056
v_mfma_f32_16x16x32_bf16 v[160:163], v[116:119], v[112:115], v[160:163]
ds_read_b128 v[40:43], v2 offset:47104
v_mfma_f32_16x16x32_bf16 v[196:199], v[120:123], v[112:115], v[196:199]
ds_read_b128 v[44:47], v2 offset:49152
v_mfma_f32_16x16x32_bf16 v[192:195], v[120:123], v[108:111], v[192:195]
ds_read_b128 v[48:51], v2 offset:51200
v_mfma_f32_16x16x32_bf16 v[188:191], v[120:123], v[104:107], v[188:191]
ds_read_b128 v[52:55], v2 offset:53248
v_mfma_f32_16x16x32_bf16 v[184:187], v[120:123], v[100:103], v[184:187]
ds_read_b128 v[56:59], v2 offset:55296
v_mfma_f32_16x16x32_bf16 v[180:183], v[120:123], v[96:99], v[180:183]
ds_read_b128 v[60:63], v2 offset:57344
v_mfma_f32_16x16x32_bf16 v[176:179], v[120:123], v[92:95], v[176:179]
ds_read_b128 v[64:67], v2 offset:59392
v_mfma_f32_16x16x32_bf16 v[172:175], v[120:123], v[88:91], v[172:175]
v_mfma_f32_16x16x32_bf16 v[168:171], v[120:123], v[84:87], v[168:171]
v_mfma_f32_16x16x32_bf16 v[164:167], v[120:123], v[80:83], v[164:167]
v_mfma_f32_16x16x32_bf16 v[200:203], v[124:127], v[80:83], v[200:203]
v_mfma_f32_16x16x32_bf16 v[204:207], v[124:127], v[84:87], v[204:207]
v_mfma_f32_16x16x32_bf16 v[208:211], v[124:127], v[88:91], v[208:211]
v_mfma_f32_16x16x32_bf16 v[212:215], v[124:127], v[92:95], v[212:215]
v_mfma_f32_16x16x32_bf16 v[216:219], v[124:127], v[96:99], v[216:219]
v_mfma_f32_16x16x32_bf16 v[220:223], v[124:127], v[100:103], v[220:223]
v_mfma_f32_16x16x32_bf16 v[224:227], v[124:127], v[104:107], v[224:227]
v_mfma_f32_16x16x32_bf16 v[228:231], v[124:127], v[108:111], v[228:231]
v_mfma_f32_16x16x32_bf16 v[232:235], v[124:127], v[112:115], v[232:235]
s_waitcnt lgkmcnt(0)
v_mfma_f32_16x16x32_bf16 v[128:131], v[68:71], v[32:35], v[128:131]
ds_read_b128 v[80:83], v3 offset:43008
v_mfma_f32_16x16x32_bf16 v[132:135], v[68:71], v[36:39], v[132:135]
ds_read_b64_tr_b16 v[120:121], v7 offset:12288
v_mfma_f32_16x16x32_bf16 v[136:139], v[68:71], v[40:43], v[136:139]
ds_read_b64_tr_b16 v[122:123], v7 offset:12800
v_mfma_f32_16x16x32_bf16 v[140:143], v[68:71], v[44:47], v[140:143]
ds_read_b64_tr_b16 v[124:125], v7 offset:20480
v_mfma_f32_16x16x32_bf16 v[144:147], v[68:71], v[48:51], v[144:147]
ds_read_b64_tr_b16 v[126:127], v7 offset:20992
v_mfma_f32_16x16x32_bf16 v[148:151], v[68:71], v[52:55], v[148:151]
ds_read_b64_tr_b16 v[116:117], v7 offset:4096
v_mfma_f32_16x16x32_bf16 v[152:155], v[68:71], v[56:59], v[152:155]
ds_read_b64_tr_b16 v[118:119], v7 offset:4608
v_mfma_f32_16x16x32_bf16 v[156:159], v[68:71], v[60:63], v[156:159]
ds_read_b128 v[84:87], v3 offset:45056
v_mfma_f32_16x16x32_bf16 v[160:163], v[68:71], v[64:67], v[160:163]
ds_read_b128 v[88:91], v3 offset:47104
v_mfma_f32_16x16x32_bf16 v[196:199], v[72:75], v[64:67], v[196:199]
ds_read_b128 v[92:95], v3 offset:49152
v_mfma_f32_16x16x32_bf16 v[192:195], v[72:75], v[60:63], v[192:195]
ds_read_b128 v[96:99], v3 offset:51200
v_mfma_f32_16x16x32_bf16 v[188:191], v[72:75], v[56:59], v[188:191]
ds_read_b128 v[100:103], v3 offset:53248
v_mfma_f32_16x16x32_bf16 v[184:187], v[72:75], v[52:55], v[184:187]
ds_read_b128 v[104:107], v3 offset:55296
v_mfma_f32_16x16x32_bf16 v[180:183], v[72:75], v[48:51], v[180:183]
ds_read_b128 v[108:111], v3 offset:57344
v_mfma_f32_16x16x32_bf16 v[176:179], v[72:75], v[44:47], v[176:179]
ds_read_b128 v[112:115], v3 offset:59392
v_mfma_f32_16x16x32_bf16 v[172:175], v[72:75], v[40:43], v[172:175]
v_mfma_f32_16x16x32_bf16 v[168:171], v[72:75], v[36:39], v[168:171]
v_mfma_f32_16x16x32_bf16 v[164:167], v[72:75], v[32:35], v[164:167]
v_mfma_f32_16x16x32_bf16 v[200:203], v[76:79], v[32:35], v[200:203]
v_mfma_f32_16x16x32_bf16 v[204:207], v[76:79], v[36:39], v[204:207]
v_mfma_f32_16x16x32_bf16 v[208:211], v[76:79], v[40:43], v[208:211]
v_mfma_f32_16x16x32_bf16 v[212:215], v[76:79], v[44:47], v[212:215]
v_mfma_f32_16x16x32_bf16 v[216:219], v[76:79], v[48:51], v[216:219]
v_mfma_f32_16x16x32_bf16 v[220:223], v[76:79], v[52:55], v[220:223]
v_mfma_f32_16x16x32_bf16 v[224:227], v[76:79], v[56:59], v[224:227]
v_mfma_f32_16x16x32_bf16 v[228:231], v[76:79], v[60:63], v[228:231]
v_mfma_f32_16x16x32_bf16 v[232:235], v[76:79], v[64:67], v[232:235]
s_waitcnt lgkmcnt(0)
s_barrier
v_mfma_f32_16x16x32_bf16 v[128:131], v[116:119], v[80:83], v[128:131]
ds_read_b128 v[32:35], v4 offset:0
v_mfma_f32_16x16x32_bf16 v[132:135], v[116:119], v[84:87], v[132:135]
ds_read_b64_tr_b16 v[72:73], v8 offset:8192
v_mfma_f32_16x16x32_bf16 v[136:139], v[116:119], v[88:91], v[136:139]
ds_read_b64_tr_b16 v[74:75], v8 offset:8704
v_mfma_f32_16x16x32_bf16 v[140:143], v[116:119], v[92:95], v[140:143]
ds_read_b64_tr_b16 v[76:77], v8 offset:16384
v_mfma_f32_16x16x32_bf16 v[144:147], v[116:119], v[96:99], v[144:147]
ds_read_b64_tr_b16 v[78:79], v8 offset:16896
v_mfma_f32_16x16x32_bf16 v[148:151], v[116:119], v[100:103], v[148:151]
ds_read_b64_tr_b16 v[68:69], v8 offset:0
v_mfma_f32_16x16x32_bf16 v[152:155], v[116:119], v[104:107], v[152:155]
ds_read_b64_tr_b16 v[70:71], v8 offset:512
v_mfma_f32_16x16x32_bf16 v[156:159], v[116:119], v[108:111], v[156:159]
ds_read_b128 v[36:39], v4 offset:2048
v_mfma_f32_16x16x32_bf16 v[160:163], v[116:119], v[112:115], v[160:163]
ds_read_b128 v[40:43], v4 offset:4096
v_mfma_f32_16x16x32_bf16 v[196:199], v[120:123], v[112:115], v[196:199]
ds_read_b128 v[44:47], v4 offset:6144
v_mfma_f32_16x16x32_bf16 v[192:195], v[120:123], v[108:111], v[192:195]
ds_read_b128 v[48:51], v4 offset:8192
v_mfma_f32_16x16x32_bf16 v[188:191], v[120:123], v[104:107], v[188:191]
ds_read_b128 v[52:55], v4 offset:10240
v_mfma_f32_16x16x32_bf16 v[184:187], v[120:123], v[100:103], v[184:187]
ds_read_b128 v[56:59], v4 offset:12288
v_mfma_f32_16x16x32_bf16 v[180:183], v[120:123], v[96:99], v[180:183]
ds_read_b128 v[60:63], v4 offset:14336
v_mfma_f32_16x16x32_bf16 v[176:179], v[120:123], v[92:95], v[176:179]
ds_read_b128 v[64:67], v4 offset:16384
v_mfma_f32_16x16x32_bf16 v[172:175], v[120:123], v[88:91], v[172:175]
v_mfma_f32_16x16x32_bf16 v[168:171], v[120:123], v[84:87], v[168:171]
v_mfma_f32_16x16x32_bf16 v[164:167], v[120:123], v[80:83], v[164:167]
v_mfma_f32_16x16x32_bf16 v[200:203], v[124:127], v[80:83], v[200:203]
v_mfma_f32_16x16x32_bf16 v[204:207], v[124:127], v[84:87], v[204:207]
v_mfma_f32_16x16x32_bf16 v[208:211], v[124:127], v[88:91], v[208:211]
v_mfma_f32_16x16x32_bf16 v[212:215], v[124:127], v[92:95], v[212:215]
v_mfma_f32_16x16x32_bf16 v[216:219], v[124:127], v[96:99], v[216:219]
v_mfma_f32_16x16x32_bf16 v[220:223], v[124:127], v[100:103], v[220:223]
v_mfma_f32_16x16x32_bf16 v[224:227], v[124:127], v[104:107], v[224:227]
v_mfma_f32_16x16x32_bf16 v[228:231], v[124:127], v[108:111], v[228:231]
v_mfma_f32_16x16x32_bf16 v[232:235], v[124:127], v[112:115], v[232:235]
s_waitcnt lgkmcnt(0)
v_mfma_f32_16x16x32_bf16 v[128:131], v[68:71], v[32:35], v[128:131]
ds_read_b128 v[80:83], v5 offset:0
v_mfma_f32_16x16x32_bf16 v[132:135], v[68:71], v[36:39], v[132:135]
ds_read_b64_tr_b16 v[120:121], v8 offset:12288
v_mfma_f32_16x16x32_bf16 v[136:139], v[68:71], v[40:43], v[136:139]
ds_read_b64_tr_b16 v[122:123], v8 offset:12800
v_mfma_f32_16x16x32_bf16 v[140:143], v[68:71], v[44:47], v[140:143]
ds_read_b64_tr_b16 v[124:125], v8 offset:20480
v_mfma_f32_16x16x32_bf16 v[144:147], v[68:71], v[48:51], v[144:147]
ds_read_b64_tr_b16 v[126:127], v8 offset:20992
v_mfma_f32_16x16x32_bf16 v[148:151], v[68:71], v[52:55], v[148:151]
ds_read_b64_tr_b16 v[116:117], v8 offset:4096
v_mfma_f32_16x16x32_bf16 v[152:155], v[68:71], v[56:59], v[152:155]
ds_read_b64_tr_b16 v[118:119], v8 offset:4608
v_mfma_f32_16x16x32_bf16 v[156:159], v[68:71], v[60:63], v[156:159]
ds_read_b128 v[84:87], v5 offset:2048
v_mfma_f32_16x16x32_bf16 v[160:163], v[68:71], v[64:67], v[160:163]
ds_read_b128 v[88:91], v5 offset:4096
v_mfma_f32_16x16x32_bf16 v[196:199], v[72:75], v[64:67], v[196:199]
ds_read_b128 v[92:95], v5 offset:6144
v_mfma_f32_16x16x32_bf16 v[192:195], v[72:75], v[60:63], v[192:195]
ds_read_b128 v[96:99], v5 offset:8192
v_mfma_f32_16x16x32_bf16 v[188:191], v[72:75], v[56:59], v[188:191]
ds_read_b128 v[100:103], v5 offset:10240
v_mfma_f32_16x16x32_bf16 v[184:187], v[72:75], v[52:55], v[184:187]
ds_read_b128 v[104:107], v5 offset:12288
v_mfma_f32_16x16x32_bf16 v[180:183], v[72:75], v[48:51], v[180:183]
ds_read_b128 v[108:111], v5 offset:14336
v_mfma_f32_16x16x32_bf16 v[176:179], v[72:75], v[44:47], v[176:179]
ds_read_b128 v[112:115], v5 offset:16384
v_mfma_f32_16x16x32_bf16 v[172:175], v[72:75], v[40:43], v[172:175]
v_mfma_f32_16x16x32_bf16 v[168:171], v[72:75], v[36:39], v[168:171]
v_mfma_f32_16x16x32_bf16 v[164:167], v[72:75], v[32:35], v[164:167]
v_mfma_f32_16x16x32_bf16 v[200:203], v[76:79], v[32:35], v[200:203]
v_mfma_f32_16x16x32_bf16 v[204:207], v[76:79], v[36:39], v[204:207]
v_mfma_f32_16x16x32_bf16 v[208:211], v[76:79], v[40:43], v[208:211]
v_mfma_f32_16x16x32_bf16 v[212:215], v[76:79], v[44:47], v[212:215]
v_mfma_f32_16x16x32_bf16 v[216:219], v[76:79], v[48:51], v[216:219]
v_mfma_f32_16x16x32_bf16 v[220:223], v[76:79], v[52:55], v[220:223]
v_mfma_f32_16x16x32_bf16 v[224:227], v[76:79], v[56:59], v[224:227]
v_mfma_f32_16x16x32_bf16 v[228:231], v[76:79], v[60:63], v[228:231]
v_mfma_f32_16x16x32_bf16 v[232:235], v[76:79], v[64:67], v[232:235]
s_waitcnt lgkmcnt(0)
s_barrier
v_mfma_f32_16x16x32_bf16 v[128:131], v[116:119], v[80:83], v[128:131]
ds_read_b128 v[32:35], v2 offset:0
v_mfma_f32_16x16x32_bf16 v[132:135], v[116:119], v[84:87], v[132:135]
ds_read_b64_tr_b16 v[72:73], v6 offset:8192
v_mfma_f32_16x16x32_bf16 v[136:139], v[116:119], v[88:91], v[136:139]
ds_read_b64_tr_b16 v[74:75], v6 offset:8704
v_mfma_f32_16x16x32_bf16 v[140:143], v[116:119], v[92:95], v[140:143]
ds_read_b64_tr_b16 v[76:77], v6 offset:16384
v_mfma_f32_16x16x32_bf16 v[144:147], v[116:119], v[96:99], v[144:147]
ds_read_b64_tr_b16 v[78:79], v6 offset:16896
v_mfma_f32_16x16x32_bf16 v[148:151], v[116:119], v[100:103], v[148:151]
ds_read_b64_tr_b16 v[68:69], v6 offset:0
v_mfma_f32_16x16x32_bf16 v[152:155], v[116:119], v[104:107], v[152:155]
ds_read_b64_tr_b16 v[70:71], v6 offset:512
v_mfma_f32_16x16x32_bf16 v[156:159], v[116:119], v[108:111], v[156:159]
ds_read_b128 v[36:39], v2 offset:2048
v_mfma_f32_16x16x32_bf16 v[160:163], v[116:119], v[112:115], v[160:163]
ds_read_b128 v[40:43], v2 offset:4096
v_mfma_f32_16x16x32_bf16 v[196:199], v[120:123], v[112:115], v[196:199]
ds_read_b128 v[44:47], v2 offset:6144
v_mfma_f32_16x16x32_bf16 v[192:195], v[120:123], v[108:111], v[192:195]
ds_read_b128 v[48:51], v2 offset:8192
v_mfma_f32_16x16x32_bf16 v[188:191], v[120:123], v[104:107], v[188:191]
ds_read_b128 v[52:55], v2 offset:10240
v_mfma_f32_16x16x32_bf16 v[184:187], v[120:123], v[100:103], v[184:187]
ds_read_b128 v[56:59], v2 offset:12288
v_mfma_f32_16x16x32_bf16 v[180:183], v[120:123], v[96:99], v[180:183]
ds_read_b128 v[60:63], v2 offset:14336
v_mfma_f32_16x16x32_bf16 v[176:179], v[120:123], v[92:95], v[176:179]
ds_read_b128 v[64:67], v2 offset:16384
v_mfma_f32_16x16x32_bf16 v[172:175], v[120:123], v[88:91], v[172:175]
v_mfma_f32_16x16x32_bf16 v[168:171], v[120:123], v[84:87], v[168:171]
v_mfma_f32_16x16x32_bf16 v[164:167], v[120:123], v[80:83], v[164:167]
v_mfma_f32_16x16x32_bf16 v[200:203], v[124:127], v[80:83], v[200:203]
v_mfma_f32_16x16x32_bf16 v[204:207], v[124:127], v[84:87], v[204:207]
v_mfma_f32_16x16x32_bf16 v[208:211], v[124:127], v[88:91], v[208:211]
v_mfma_f32_16x16x32_bf16 v[212:215], v[124:127], v[92:95], v[212:215]
v_mfma_f32_16x16x32_bf16 v[216:219], v[124:127], v[96:99], v[216:219]
v_mfma_f32_16x16x32_bf16 v[220:223], v[124:127], v[100:103], v[220:223]
v_mfma_f32_16x16x32_bf16 v[224:227], v[124:127], v[104:107], v[224:227]
v_mfma_f32_16x16x32_bf16 v[228:231], v[124:127], v[108:111], v[228:231]
v_mfma_f32_16x16x32_bf16 v[232:235], v[124:127], v[112:115], v[232:235]
s_mov_b32 s41, 4
Lcl_31:
s_waitcnt lgkmcnt(0)
v_mfma_f32_16x16x32_bf16 v[128:131], v[68:71], v[32:35], v[128:131]
ds_read_b128 v[80:83], v3 offset:0
v_mfma_f32_16x16x32_bf16 v[132:135], v[68:71], v[36:39], v[132:135]
ds_read_b64_tr_b16 v[120:121], v6 offset:12288
v_mfma_f32_16x16x32_bf16 v[136:139], v[68:71], v[40:43], v[136:139]
ds_read_b64_tr_b16 v[122:123], v6 offset:12800
v_mfma_f32_16x16x32_bf16 v[140:143], v[68:71], v[44:47], v[140:143]
ds_read_b64_tr_b16 v[124:125], v6 offset:20480
v_mfma_f32_16x16x32_bf16 v[144:147], v[68:71], v[48:51], v[144:147]
ds_read_b64_tr_b16 v[126:127], v6 offset:20992
v_mfma_f32_16x16x32_bf16 v[148:151], v[68:71], v[52:55], v[148:151]
ds_read_b64_tr_b16 v[116:117], v6 offset:4096
v_mfma_f32_16x16x32_bf16 v[152:155], v[68:71], v[56:59], v[152:155]
ds_read_b64_tr_b16 v[118:119], v6 offset:4608
v_mfma_f32_16x16x32_bf16 v[156:159], v[68:71], v[60:63], v[156:159]
ds_read_b128 v[84:87], v3 offset:2048
v_mfma_f32_16x16x32_bf16 v[160:163], v[68:71], v[64:67], v[160:163]
ds_read_b128 v[88:91], v3 offset:4096
v_mfma_f32_16x16x32_bf16 v[196:199], v[72:75], v[64:67], v[196:199]
ds_read_b128 v[92:95], v3 offset:6144
v_mfma_f32_16x16x32_bf16 v[192:195], v[72:75], v[60:63], v[192:195]
ds_read_b128 v[96:99], v3 offset:8192
v_mfma_f32_16x16x32_bf16 v[188:191], v[72:75], v[56:59], v[188:191]
ds_read_b128 v[100:103], v3 offset:10240
v_mfma_f32_16x16x32_bf16 v[184:187], v[72:75], v[52:55], v[184:187]
ds_read_b128 v[104:107], v3 offset:12288
v_mfma_f32_16x16x32_bf16 v[180:183], v[72:75], v[48:51], v[180:183]
ds_read_b128 v[108:111], v3 offset:14336
v_mfma_f32_16x16x32_bf16 v[176:179], v[72:75], v[44:47], v[176:179]
ds_read_b128 v[112:115], v3 offset:16384
v_mfma_f32_16x16x32_bf16 v[172:175], v[72:75], v[40:43], v[172:175]
v_mfma_f32_16x16x32_bf16 v[168:171], v[72:75], v[36:39], v[168:171]
v_mfma_f32_16x16x32_bf16 v[164:167], v[72:75], v[32:35], v[164:167]
v_mfma_f32_16x16x32_bf16 v[200:203], v[76:79], v[32:35], v[200:203]
v_mfma_f32_16x16x32_bf16 v[204:207], v[76:79], v[36:39], v[204:207]
v_mfma_f32_16x16x32_bf16 v[208:211], v[76:79], v[40:43], v[208:211]
v_mfma_f32_16x16x32_bf16 v[212:215], v[76:79], v[44:47], v[212:215]
v_mfma_f32_16x16x32_bf16 v[216:219], v[76:79], v[48:51], v[216:219]
v_mfma_f32_16x16x32_bf16 v[220:223], v[76:79], v[52:55], v[220:223]
v_mfma_f32_16x16x32_bf16 v[224:227], v[76:79], v[56:59], v[224:227]
v_mfma_f32_16x16x32_bf16 v[228:231], v[76:79], v[60:63], v[228:231]
v_mfma_f32_16x16x32_bf16 v[232:235], v[76:79], v[64:67], v[232:235]
s_waitcnt lgkmcnt(0)
s_barrier
v_mfma_f32_16x16x32_bf16 v[128:131], v[116:119], v[80:83], v[128:131]
s_branch Lov_2
.p2align 12
.fill 16, 4, 0xbf800000
Lst_2_0:
s_branch Lwr_157
s_nop 0
s_nop 0
Lov_2:
ds_read_b128 v[32:35], v2 offset:43008
v_mfma_f32_16x16x32_bf16 v[132:135], v[116:119], v[84:87], v[132:135]
ds_read_b64_tr_b16 v[72:73], v7 offset:8192
v_mfma_f32_16x16x32_bf16 v[136:139], v[116:119], v[88:91], v[136:139]
ds_read_b64_tr_b16 v[74:75], v7 offset:8704
v_mfma_f32_16x16x32_bf16 v[140:143], v[116:119], v[92:95], v[140:143]
ds_read_b64_tr_b16 v[76:77], v7 offset:16384
v_mfma_f32_16x16x32_bf16 v[144:147], v[116:119], v[96:99], v[144:147]
ds_read_b64_tr_b16 v[78:79], v7 offset:16896
v_mfma_f32_16x16x32_bf16 v[148:151], v[116:119], v[100:103], v[148:151]
ds_read_b64_tr_b16 v[68:69], v7 offset:0
v_mfma_f32_16x16x32_bf16 v[152:155], v[116:119], v[104:107], v[152:155]
ds_read_b64_tr_b16 v[70:71], v7 offset:512
v_mfma_f32_16x16x32_bf16 v[156:159], v[116:119], v[108:111], v[156:159]
ds_read_b128 v[36:39], v2 offset:45056
v_mfma_f32_16x16x32_bf16 v[160:163], v[116:119], v[112:115], v[160:163]
ds_read_b128 v[40:43], v2 offset:47104
v_mfma_f32_16x16x32_bf16 v[196:199], v[120:123], v[112:115], v[196:199]
ds_read_b128 v[44:47], v2 offset:49152
v_mfma_f32_16x16x32_bf16 v[192:195], v[120:123], v[108:111], v[192:195]
ds_read_b128 v[48:51], v2 offset:51200
v_mfma_f32_16x16x32_bf16 v[188:191], v[120:123], v[104:107], v[188:191]
ds_read_b128 v[52:55], v2 offset:53248
v_mfma_f32_16x16x32_bf16 v[184:187], v[120:123], v[100:103], v[184:187]
ds_read_b128 v[56:59], v2 offset:55296
v_mfma_f32_16x16x32_bf16 v[180:183], v[120:123], v[96:99], v[180:183]
ds_read_b128 v[60:63], v2 offset:57344
v_mfma_f32_16x16x32_bf16 v[176:179], v[120:123], v[92:95], v[176:179]
ds_read_b128 v[64:67], v2 offset:59392
v_mfma_f32_16x16x32_bf16 v[172:175], v[120:123], v[88:91], v[172:175]
v_mfma_f32_16x16x32_bf16 v[168:171], v[120:123], v[84:87], v[168:171]
v_mfma_f32_16x16x32_bf16 v[164:167], v[120:123], v[80:83], v[164:167]
v_mfma_f32_16x16x32_bf16 v[200:203], v[124:127], v[80:83], v[200:203]
v_mfma_f32_16x16x32_bf16 v[204:207], v[124:127], v[84:87], v[204:207]
v_mfma_f32_16x16x32_bf16 v[208:211], v[124:127], v[88:91], v[208:211]
v_mfma_f32_16x16x32_bf16 v[212:215], v[124:127], v[92:95], v[212:215]
v_mfma_f32_16x16x32_bf16 v[216:219], v[124:127], v[96:99], v[216:219]
v_mfma_f32_16x16x32_bf16 v[220:223], v[124:127], v[100:103], v[220:223]
v_mfma_f32_16x16x32_bf16 v[224:227], v[124:127], v[104:107], v[224:227]
v_mfma_f32_16x16x32_bf16 v[228:231], v[124:127], v[108:111], v[228:231]
v_mfma_f32_16x16x32_bf16 v[232:235], v[124:127], v[112:115], v[232:235]
s_waitcnt lgkmcnt(0)
v_mfma_f32_16x16x32_bf16 v[128:131], v[68:71], v[32:35], v[128:131]
ds_read_b128 v[80:83], v3 offset:43008
v_mfma_f32_16x16x32_bf16 v[132:135], v[68:71], v[36:39], v[132:135]
ds_read_b64_tr_b16 v[120:121], v7 offset:12288
v_mfma_f32_16x16x32_bf16 v[136:139], v[68:71], v[40:43], v[136:139]
ds_read_b64_tr_b16 v[122:123], v7 offset:12800
v_mfma_f32_16x16x32_bf16 v[140:143], v[68:71], v[44:47], v[140:143]
ds_read_b64_tr_b16 v[124:125], v7 offset:20480
v_mfma_f32_16x16x32_bf16 v[144:147], v[68:71], v[48:51], v[144:147]
ds_read_b64_tr_b16 v[126:127], v7 offset:20992
v_mfma_f32_16x16x32_bf16 v[148:151], v[68:71], v[52:55], v[148:151]
ds_read_b64_tr_b16 v[116:117], v7 offset:4096
v_mfma_f32_16x16x32_bf16 v[152:155], v[68:71], v[56:59], v[152:155]
ds_read_b64_tr_b16 v[118:119], v7 offset:4608
v_mfma_f32_16x16x32_bf16 v[156:159], v[68:71], v[60:63], v[156:159]
ds_read_b128 v[84:87], v3 offset:45056
v_mfma_f32_16x16x32_bf16 v[160:163], v[68:71], v[64:67], v[160:163]
ds_read_b128 v[88:91], v3 offset:47104
v_mfma_f32_16x16x32_bf16 v[196:199], v[72:75], v[64:67], v[196:199]
ds_read_b128 v[92:95], v3 offset:49152
v_mfma_f32_16x16x32_bf16 v[192:195], v[72:75], v[60:63], v[192:195]
ds_read_b128 v[96:99], v3 offset:51200
v_mfma_f32_16x16x32_bf16 v[188:191], v[72:75], v[56:59], v[188:191]
ds_read_b128 v[100:103], v3 offset:53248
v_mfma_f32_16x16x32_bf16 v[184:187], v[72:75], v[52:55], v[184:187]
ds_read_b128 v[104:107], v3 offset:55296
v_mfma_f32_16x16x32_bf16 v[180:183], v[72:75], v[48:51], v[180:183]
ds_read_b128 v[108:111], v3 offset:57344
v_mfma_f32_16x16x32_bf16 v[176:179], v[72:75], v[44:47], v[176:179]
ds_read_b128 v[112:115], v3 offset:59392
v_mfma_f32_16x16x32_bf16 v[172:175], v[72:75], v[40:43], v[172:175]
v_mfma_f32_16x16x32_bf16 v[168:171], v[72:75], v[36:39], v[168:171]
v_mfma_f32_16x16x32_bf16 v[164:167], v[72:75], v[32:35], v[164:167]
v_mfma_f32_16x16x32_bf16 v[200:203], v[76:79], v[32:35], v[200:203]
v_mfma_f32_16x16x32_bf16 v[204:207], v[76:79], v[36:39], v[204:207]
v_mfma_f32_16x16x32_bf16 v[208:211], v[76:79], v[40:43], v[208:211]
v_mfma_f32_16x16x32_bf16 v[212:215], v[76:79], v[44:47], v[212:215]
v_mfma_f32_16x16x32_bf16 v[216:219], v[76:79], v[48:51], v[216:219]
v_mfma_f32_16x16x32_bf16 v[220:223], v[76:79], v[52:55], v[220:223]
v_mfma_f32_16x16x32_bf16 v[224:227], v[76:79], v[56:59], v[224:227]
v_mfma_f32_16x16x32_bf16 v[228:231], v[76:79], v[60:63], v[228:231]
v_mfma_f32_16x16x32_bf16 v[232:235], v[76:79], v[64:67], v[232:235]
s_waitcnt lgkmcnt(0)
s_barrier
v_mfma_f32_16x16x32_bf16 v[128:131], v[116:119], v[80:83], v[128:131]
ds_read_b128 v[32:35], v4 offset:0
v_mfma_f32_16x16x32_bf16 v[132:135], v[116:119], v[84:87], v[132:135]
ds_read_b64_tr_b16 v[72:73], v8 offset:8192
v_mfma_f32_16x16x32_bf16 v[136:139], v[116:119], v[88:91], v[136:139]
ds_read_b64_tr_b16 v[74:75], v8 offset:8704
v_mfma_f32_16x16x32_bf16 v[140:143], v[116:119], v[92:95], v[140:143]
ds_read_b64_tr_b16 v[76:77], v8 offset:16384
v_mfma_f32_16x16x32_bf16 v[144:147], v[116:119], v[96:99], v[144:147]
ds_read_b64_tr_b16 v[78:79], v8 offset:16896
v_mfma_f32_16x16x32_bf16 v[148:151], v[116:119], v[100:103], v[148:151]
ds_read_b64_tr_b16 v[68:69], v8 offset:0
v_mfma_f32_16x16x32_bf16 v[152:155], v[116:119], v[104:107], v[152:155]
ds_read_b64_tr_b16 v[70:71], v8 offset:512
v_mfma_f32_16x16x32_bf16 v[156:159], v[116:119], v[108:111], v[156:159]
ds_read_b128 v[36:39], v4 offset:2048
v_mfma_f32_16x16x32_bf16 v[160:163], v[116:119], v[112:115], v[160:163]
ds_read_b128 v[40:43], v4 offset:4096
v_mfma_f32_16x16x32_bf16 v[196:199], v[120:123], v[112:115], v[196:199]
ds_read_b128 v[44:47], v4 offset:6144
v_mfma_f32_16x16x32_bf16 v[192:195], v[120:123], v[108:111], v[192:195]
ds_read_b128 v[48:51], v4 offset:8192
v_mfma_f32_16x16x32_bf16 v[188:191], v[120:123], v[104:107], v[188:191]
ds_read_b128 v[52:55], v4 offset:10240
v_mfma_f32_16x16x32_bf16 v[184:187], v[120:123], v[100:103], v[184:187]
ds_read_b128 v[56:59], v4 offset:12288
v_mfma_f32_16x16x32_bf16 v[180:183], v[120:123], v[96:99], v[180:183]
ds_read_b128 v[60:63], v4 offset:14336
v_mfma_f32_16x16x32_bf16 v[176:179], v[120:123], v[92:95], v[176:179]
ds_read_b128 v[64:67], v4 offset:16384
v_mfma_f32_16x16x32_bf16 v[172:175], v[120:123], v[88:91], v[172:175]
v_mfma_f32_16x16x32_bf16 v[168:171], v[120:123], v[84:87], v[168:171]
v_mfma_f32_16x16x32_bf16 v[164:167], v[120:123], v[80:83], v[164:167]
v_mfma_f32_16x16x32_bf16 v[200:203], v[124:127], v[80:83], v[200:203]
v_mfma_f32_16x16x32_bf16 v[204:207], v[124:127], v[84:87], v[204:207]
v_mfma_f32_16x16x32_bf16 v[208:211], v[124:127], v[88:91], v[208:211]
v_mfma_f32_16x16x32_bf16 v[212:215], v[124:127], v[92:95], v[212:215]
v_mfma_f32_16x16x32_bf16 v[216:219], v[124:127], v[96:99], v[216:219]
v_mfma_f32_16x16x32_bf16 v[220:223], v[124:127], v[100:103], v[220:223]
v_mfma_f32_16x16x32_bf16 v[224:227], v[124:127], v[104:107], v[224:227]
v_mfma_f32_16x16x32_bf16 v[228:231], v[124:127], v[108:111], v[228:231]
v_mfma_f32_16x16x32_bf16 v[232:235], v[124:127], v[112:115], v[232:235]
s_waitcnt lgkmcnt(0)
v_mfma_f32_16x16x32_bf16 v[128:131], v[68:71], v[32:35], v[128:131]
ds_read_b128 v[80:83], v5 offset:0
v_mfma_f32_16x16x32_bf16 v[132:135], v[68:71], v[36:39], v[132:135]
ds_read_b64_tr_b16 v[120:121], v8 offset:12288
v_mfma_f32_16x16x32_bf16 v[136:139], v[68:71], v[40:43], v[136:139]
ds_read_b64_tr_b16 v[122:123], v8 offset:12800
v_mfma_f32_16x16x32_bf16 v[140:143], v[68:71], v[44:47], v[140:143]
ds_read_b64_tr_b16 v[124:125], v8 offset:20480
v_mfma_f32_16x16x32_bf16 v[144:147], v[68:71], v[48:51], v[144:147]
ds_read_b64_tr_b16 v[126:127], v8 offset:20992
v_mfma_f32_16x16x32_bf16 v[148:151], v[68:71], v[52:55], v[148:151]
ds_read_b64_tr_b16 v[116:117], v8 offset:4096
v_mfma_f32_16x16x32_bf16 v[152:155], v[68:71], v[56:59], v[152:155]
ds_read_b64_tr_b16 v[118:119], v8 offset:4608
v_mfma_f32_16x16x32_bf16 v[156:159], v[68:71], v[60:63], v[156:159]
ds_read_b128 v[84:87], v5 offset:2048
v_mfma_f32_16x16x32_bf16 v[160:163], v[68:71], v[64:67], v[160:163]
ds_read_b128 v[88:91], v5 offset:4096
v_mfma_f32_16x16x32_bf16 v[196:199], v[72:75], v[64:67], v[196:199]
ds_read_b128 v[92:95], v5 offset:6144
v_mfma_f32_16x16x32_bf16 v[192:195], v[72:75], v[60:63], v[192:195]
ds_read_b128 v[96:99], v5 offset:8192
v_mfma_f32_16x16x32_bf16 v[188:191], v[72:75], v[56:59], v[188:191]
ds_read_b128 v[100:103], v5 offset:10240
v_mfma_f32_16x16x32_bf16 v[184:187], v[72:75], v[52:55], v[184:187]
ds_read_b128 v[104:107], v5 offset:12288
v_mfma_f32_16x16x32_bf16 v[180:183], v[72:75], v[48:51], v[180:183]
ds_read_b128 v[108:111], v5 offset:14336
v_mfma_f32_16x16x32_bf16 v[176:179], v[72:75], v[44:47], v[176:179]
ds_read_b128 v[112:115], v5 offset:16384
v_mfma_f32_16x16x32_bf16 v[172:175], v[72:75], v[40:43], v[172:175]
v_mfma_f32_16x16x32_bf16 v[168:171], v[72:75], v[36:39], v[168:171]
v_mfma_f32_16x16x32_bf16 v[164:167], v[72:75], v[32:35], v[164:167]
v_mfma_f32_16x16x32_bf16 v[200:203], v[76:79], v[32:35], v[200:203]
v_mfma_f32_16x16x32_bf16 v[204:207], v[76:79], v[36:39], v[204:207]
v_mfma_f32_16x16x32_bf16 v[208:211], v[76:79], v[40:43], v[208:211]
v_mfma_f32_16x16x32_bf16 v[212:215], v[76:79], v[44:47], v[212:215]
v_mfma_f32_16x16x32_bf16 v[216:219], v[76:79], v[48:51], v[216:219]
v_mfma_f32_16x16x32_bf16 v[220:223], v[76:79], v[52:55], v[220:223]
v_mfma_f32_16x16x32_bf16 v[224:227], v[76:79], v[56:59], v[224:227]
v_mfma_f32_16x16x32_bf16 v[228:231], v[76:79], v[60:63], v[228:231]
v_mfma_f32_16x16x32_bf16 v[232:235], v[76:79], v[64:67], v[232:235]
s_waitcnt lgkmcnt(0)
s_barrier
v_mfma_f32_16x16x32_bf16 v[128:131], v[116:119], v[80:83], v[128:131]
ds_read_b128 v[32:35], v2 offset:0
v_mfma_f32_16x16x32_bf16 v[132:135], v[116:119], v[84:87], v[132:135]
ds_read_b64_tr_b16 v[72:73], v6 offset:8192
v_mfma_f32_16x16x32_bf16 v[136:139], v[116:119], v[88:91], v[136:139]
ds_read_b64_tr_b16 v[74:75], v6 offset:8704
v_mfma_f32_16x16x32_bf16 v[140:143], v[116:119], v[92:95], v[140:143]
ds_read_b64_tr_b16 v[76:77], v6 offset:16384
v_mfma_f32_16x16x32_bf16 v[144:147], v[116:119], v[96:99], v[144:147]
ds_read_b64_tr_b16 v[78:79], v6 offset:16896
v_mfma_f32_16x16x32_bf16 v[148:151], v[116:119], v[100:103], v[148:151]
ds_read_b64_tr_b16 v[68:69], v6 offset:0
v_mfma_f32_16x16x32_bf16 v[152:155], v[116:119], v[104:107], v[152:155]
ds_read_b64_tr_b16 v[70:71], v6 offset:512
v_mfma_f32_16x16x32_bf16 v[156:159], v[116:119], v[108:111], v[156:159]
ds_read_b128 v[36:39], v2 offset:2048
v_mfma_f32_16x16x32_bf16 v[160:163], v[116:119], v[112:115], v[160:163]
ds_read_b128 v[40:43], v2 offset:4096
v_mfma_f32_16x16x32_bf16 v[196:199], v[120:123], v[112:115], v[196:199]
ds_read_b128 v[44:47], v2 offset:6144
v_mfma_f32_16x16x32_bf16 v[192:195], v[120:123], v[108:111], v[192:195]
ds_read_b128 v[48:51], v2 offset:8192
v_mfma_f32_16x16x32_bf16 v[188:191], v[120:123], v[104:107], v[188:191]
ds_read_b128 v[52:55], v2 offset:10240
v_mfma_f32_16x16x32_bf16 v[184:187], v[120:123], v[100:103], v[184:187]
ds_read_b128 v[56:59], v2 offset:12288
v_mfma_f32_16x16x32_bf16 v[180:183], v[120:123], v[96:99], v[180:183]
ds_read_b128 v[60:63], v2 offset:14336
v_mfma_f32_16x16x32_bf16 v[176:179], v[120:123], v[92:95], v[176:179]
ds_read_b128 v[64:67], v2 offset:16384
v_mfma_f32_16x16x32_bf16 v[172:175], v[120:123], v[88:91], v[172:175]
v_mfma_f32_16x16x32_bf16 v[168:171], v[120:123], v[84:87], v[168:171]
v_mfma_f32_16x16x32_bf16 v[164:167], v[120:123], v[80:83], v[164:167]
v_mfma_f32_16x16x32_bf16 v[200:203], v[124:127], v[80:83], v[200:203]
v_mfma_f32_16x16x32_bf16 v[204:207], v[124:127], v[84:87], v[204:207]
v_mfma_f32_16x16x32_bf16 v[208:211], v[124:127], v[88:91], v[208:211]
v_mfma_f32_16x16x32_bf16 v[212:215], v[124:127], v[92:95], v[212:215]
v_mfma_f32_16x16x32_bf16 v[216:219], v[124:127], v[96:99], v[216:219]
v_mfma_f32_16x16x32_bf16 v[220:223], v[124:127], v[100:103], v[220:223]
v_mfma_f32_16x16x32_bf16 v[224:227], v[124:127], v[104:107], v[224:227]
v_mfma_f32_16x16x32_bf16 v[228:231], v[124:127], v[108:111], v[228:231]
v_mfma_f32_16x16x32_bf16 v[232:235], v[124:127], v[112:115], v[232:235]
s_sub_u32 s41, s41, 1
s_cmp_lg_u32 s41, 0
s_cbranch_scc1 Lcl_31
s_waitcnt lgkmcnt(0)
v_mfma_f32_16x16x32_bf16 v[128:131], v[68:71], v[32:35], v[128:131]
ds_read_b128 v[80:83], v3 offset:0
v_mfma_f32_16x16x32_bf16 v[132:135], v[68:71], v[36:39], v[132:135]
ds_read_b64_tr_b16 v[120:121], v6 offset:12288
v_mfma_f32_16x16x32_bf16 v[136:139], v[68:71], v[40:43], v[136:139]
ds_read_b64_tr_b16 v[122:123], v6 offset:12800
v_mfma_f32_16x16x32_bf16 v[140:143], v[68:71], v[44:47], v[140:143]
ds_read_b64_tr_b16 v[124:125], v6 offset:20480
v_mfma_f32_16x16x32_bf16 v[144:147], v[68:71], v[48:51], v[144:147]
ds_read_b64_tr_b16 v[126:127], v6 offset:20992
v_mfma_f32_16x16x32_bf16 v[148:151], v[68:71], v[52:55], v[148:151]
ds_read_b64_tr_b16 v[116:117], v6 offset:4096
v_mfma_f32_16x16x32_bf16 v[152:155], v[68:71], v[56:59], v[152:155]
ds_read_b64_tr_b16 v[118:119], v6 offset:4608
v_mfma_f32_16x16x32_bf16 v[156:159], v[68:71], v[60:63], v[156:159]
ds_read_b128 v[84:87], v3 offset:2048
v_mfma_f32_16x16x32_bf16 v[160:163], v[68:71], v[64:67], v[160:163]
ds_read_b128 v[88:91], v3 offset:4096
v_mfma_f32_16x16x32_bf16 v[196:199], v[72:75], v[64:67], v[196:199]
ds_read_b128 v[92:95], v3 offset:6144
v_mfma_f32_16x16x32_bf16 v[192:195], v[72:75], v[60:63], v[192:195]
ds_read_b128 v[96:99], v3 offset:8192
v_mfma_f32_16x16x32_bf16 v[188:191], v[72:75], v[56:59], v[188:191]
ds_read_b128 v[100:103], v3 offset:10240
v_mfma_f32_16x16x32_bf16 v[184:187], v[72:75], v[52:55], v[184:187]
ds_read_b128 v[104:107], v3 offset:12288
v_mfma_f32_16x16x32_bf16 v[180:183], v[72:75], v[48:51], v[180:183]
ds_read_b128 v[108:111], v3 offset:14336
v_mfma_f32_16x16x32_bf16 v[176:179], v[72:75], v[44:47], v[176:179]
ds_read_b128 v[112:115], v3 offset:16384
v_mfma_f32_16x16x32_bf16 v[172:175], v[72:75], v[40:43], v[172:175]
v_mfma_f32_16x16x32_bf16 v[168:171], v[72:75], v[36:39], v[168:171]
v_mfma_f32_16x16x32_bf16 v[164:167], v[72:75], v[32:35], v[164:167]
v_mfma_f32_16x16x32_bf16 v[200:203], v[76:79], v[32:35], v[200:203]
v_mfma_f32_16x16x32_bf16 v[204:207], v[76:79], v[36:39], v[204:207]
v_mfma_f32_16x16x32_bf16 v[208:211], v[76:79], v[40:43], v[208:211]
v_mfma_f32_16x16x32_bf16 v[212:215], v[76:79], v[44:47], v[212:215]
v_mfma_f32_16x16x32_bf16 v[216:219], v[76:79], v[48:51], v[216:219]
v_mfma_f32_16x16x32_bf16 v[220:223], v[76:79], v[52:55], v[220:223]
v_mfma_f32_16x16x32_bf16 v[224:227], v[76:79], v[56:59], v[224:227]
v_mfma_f32_16x16x32_bf16 v[228:231], v[76:79], v[60:63], v[228:231]
v_mfma_f32_16x16x32_bf16 v[232:235], v[76:79], v[64:67], v[232:235]
s_waitcnt lgkmcnt(0)
v_mfma_f32_16x16x32_bf16 v[128:131], v[116:119], v[80:83], v[128:131]
v_mfma_f32_16x16x32_bf16 v[132:135], v[116:119], v[84:87], v[132:135]
v_mfma_f32_16x16x32_bf16 v[136:139], v[116:119], v[88:91], v[136:139]
v_mfma_f32_16x16x32_bf16 v[140:143], v[116:119], v[92:95], v[140:143]
v_mfma_f32_16x16x32_bf16 v[144:147], v[116:119], v[96:99], v[144:147]
v_mfma_f32_16x16x32_bf16 v[148:151], v[116:119], v[100:103], v[148:151]
v_mfma_f32_16x16x32_bf16 v[152:155], v[116:119], v[104:107], v[152:155]
v_mfma_f32_16x16x32_bf16 v[156:159], v[116:119], v[108:111], v[156:159]
v_mfma_f32_16x16x32_bf16 v[160:163], v[116:119], v[112:115], v[160:163]
v_mfma_f32_16x16x32_bf16 v[196:199], v[120:123], v[112:115], v[196:199]
v_mfma_f32_16x16x32_bf16 v[192:195], v[120:123], v[108:111], v[192:195]
v_mfma_f32_16x16x32_bf16 v[188:191], v[120:123], v[104:107], v[188:191]
v_mfma_f32_16x16x32_bf16 v[184:187], v[120:123], v[100:103], v[184:187]
v_mfma_f32_16x16x32_bf16 v[180:183], v[120:123], v[96:99], v[180:183]
v_mfma_f32_16x16x32_bf16 v[176:179], v[120:123], v[92:95], v[176:179]
v_mfma_f32_16x16x32_bf16 v[172:175], v[120:123], v[88:91], v[172:175]
v_mfma_f32_16x16x32_bf16 v[168:171], v[120:123], v[84:87], v[168:171]
v_mfma_f32_16x16x32_bf16 v[164:167], v[120:123], v[80:83], v[164:167]
v_mfma_f32_16x16x32_bf16 v[200:203], v[124:127], v[80:83], v[200:203]
v_mfma_f32_16x16x32_bf16 v[204:207], v[124:127], v[84:87], v[204:207]
v_mfma_f32_16x16x32_bf16 v[208:211], v[124:127], v[88:91], v[208:211]
v_mfma_f32_16x16x32_bf16 v[212:215], v[124:127], v[92:95], v[212:215]
v_mfma_f32_16x16x32_bf16 v[216:219], v[124:127], v[96:99], v[216:219]
v_mfma_f32_16x16x32_bf16 v[220:223], v[124:127], v[100:103], v[220:223]
v_mfma_f32_16x16x32_bf16 v[224:227], v[124:127], v[104:107], v[224:227]
v_mfma_f32_16x16x32_bf16 v[228:231], v[124:127], v[108:111], v[228:231]
v_mfma_f32_16x16x32_bf16 v[232:235], v[124:127], v[112:115], v[232:235]
Lepi:
v_lshlrev_b32 v14, 3, v12
v_add_u32 v14, 147456, v14
v_mul_u32_u24 v15, 400, v12
v_lshl_add_u32 v15, v13, 3, v15
s_lshl_b32 s43, s36, 5
v_add_u32 v15, s43, v15
s_barrier
ds_read_b64 v[32:33], v14 offset:0
ds_read_b64 v[34:35], v14 offset:128
ds_read_b64 v[36:37], v14 offset:256
ds_read_b64 v[38:39], v14 offset:384
ds_read_b64 v[40:41], v14 offset:512
ds_read_b64 v[42:43], v14 offset:640
ds_read_b64 v[44:45], v14 offset:768
ds_read_b64 v[46:47], v14 offset:896
ds_read_b64 v[48:49], v14 offset:1024
v_mov_b32_dpp v52, v128 row_newbcast:0 row_mask:0xf bank_mask:0xf
v_mov_b32_dpp v53, v129 row_newbcast:0 row_mask:0xf bank_mask:0xf
v_mov_b32_dpp v54, v130 row_newbcast:0 row_mask:0xf bank_mask:0xf
v_mov_b32_dpp v55, v131 row_newbcast:0 row_mask:0xf bank_mask:0xf
v_mov_b32_dpp v56, v164 row_newbcast:0 row_mask:0xf bank_mask:0xf
v_mov_b32_dpp v57, v165 row_newbcast:0 row_mask:0xf bank_mask:0xf
v_mov_b32_dpp v58, v166 row_newbcast:0 row_mask:0xf bank_mask:0xf
v_mov_b32_dpp v59, v167 row_newbcast:0 row_mask:0xf bank_mask:0xf
v_mov_b32_dpp v60, v200 row_newbcast:0 row_mask:0xf bank_mask:0xf
v_mov_b32_dpp v61, v201 row_newbcast:0 row_mask:0xf bank_mask:0xf
v_mov_b32_dpp v62, v202 row_newbcast:0 row_mask:0xf bank_mask:0xf
v_mov_b32_dpp v63, v203 row_newbcast:0 row_mask:0xf bank_mask:0xf
s_waitcnt lgkmcnt(0)
v_pk_fma_f32 v[164:165], v[32:33], v[56:57], v[164:165] op_sel_hi:[0,1,1] neg_lo:[1,0,0] neg_hi:[1,0,0]
v_pk_fma_f32 v[166:167], v[32:33], v[58:59], v[166:167] op_sel_hi:[0,1,1] neg_lo:[1,0,0] neg_hi:[1,0,0]
v_pk_fma_f32 v[200:201], v[32:33], v[60:61], v[200:201] op_sel_hi:[0,1,1] neg_lo:[1,0,0] neg_hi:[1,0,0]
v_pk_fma_f32 v[202:203], v[32:33], v[62:63], v[202:203] op_sel_hi:[0,1,1] neg_lo:[1,0,0] neg_hi:[1,0,0]
v_pk_mul_f32 v[164:165], v[32:33], v[164:165] op_sel:[1,0] op_sel_hi:[1,1]
v_pk_mul_f32 v[166:167], v[32:33], v[166:167] op_sel:[1,0] op_sel_hi:[1,1]
v_pk_fma_f32 v[132:133], v[34:35], v[52:53], v[132:133] op_sel_hi:[0,1,1] neg_lo:[1,0,0] neg_hi:[1,0,0]
v_pk_fma_f32 v[134:135], v[34:35], v[54:55], v[134:135] op_sel_hi:[0,1,1] neg_lo:[1,0,0] neg_hi:[1,0,0]
v_pk_mul_f32 v[200:201], v[32:33], v[200:201] op_sel:[1,0] op_sel_hi:[1,1]
v_pk_mul_f32 v[202:203], v[32:33], v[202:203] op_sel:[1,0] op_sel_hi:[1,1]
v_cvt_pk_bf16_f32 v164, v164, v165
v_cvt_pk_bf16_f32 v165, v166, v167
ds_write_b64 v15, v[164:165] offset:128
v_pk_fma_f32 v[168:169], v[34:35], v[56:57], v[168:169] op_sel_hi:[0,1,1] neg_lo:[1,0,0] neg_hi:[1,0,0]
v_pk_fma_f32 v[170:171], v[34:35], v[58:59], v[170:171] op_sel_hi:[0,1,1] neg_lo:[1,0,0] neg_hi:[1,0,0]
v_pk_mul_f32 v[132:133], v[34:35], v[132:133] op_sel:[1,0] op_sel_hi:[1,1]
v_pk_mul_f32 v[134:135], v[34:35], v[134:135] op_sel:[1,0] op_sel_hi:[1,1]
v_cvt_pk_bf16_f32 v200, v200, v201
v_cvt_pk_bf16_f32 v201, v202, v203
ds_write_b64 v15, v[200:201] offset:256
v_pk_fma_f32 v[204:205], v[34:35], v[60:61], v[204:205] op_sel_hi:[0,1,1] neg_lo:[1,0,0] neg_hi:[1,0,0]
v_pk_fma_f32 v[206:207], v[34:35], v[62:63], v[206:207] op_sel_hi:[0,1,1] neg_lo:[1,0,0] neg_hi:[1,0,0]
v_pk_mul_f32 v[168:169], v[34:35], v[168:169] op_sel:[1,0] op_sel_hi:[1,1]
v_pk_mul_f32 v[170:171], v[34:35], v[170:171] op_sel:[1,0] op_sel_hi:[1,1]
v_cvt_pk_bf16_f32 v132, v132, v133
v_cvt_pk_bf16_f32 v133, v134, v135
ds_write_b64 v15, v[132:133] offset:6400
v_pk_fma_f32 v[136:137], v[36:37], v[52:53], v[136:137] op_sel_hi:[0,1,1] neg_lo:[1,0,0] neg_hi:[1,0,0]
v_pk_fma_f32 v[138:139], v[36:37], v[54:55], v[138:139] op_sel_hi:[0,1,1] neg_lo:[1,0,0] neg_hi:[1,0,0]
v_pk_mul_f32 v[204:205], v[34:35], v[204:205] op_sel:[1,0] op_sel_hi:[1,1]
v_pk_mul_f32 v[206:207], v[34:35], v[206:207] op_sel:[1,0] op_sel_hi:[1,1]
v_cvt_pk_bf16_f32 v168, v168, v169
v_cvt_pk_bf16_f32 v169, v170, v171
ds_write_b64 v15, v[168:169] offset:6528
v_pk_fma_f32 v[172:173], v[36:37], v[56:57], v[172:173] op_sel_hi:[0,1,1] neg_lo:[1,0,0] neg_hi:[1,0,0]
v_pk_fma_f32 v[174:175], v[36:37], v[58:59], v[174:175] op_sel_hi:[0,1,1] neg_lo:[1,0,0] neg_hi:[1,0,0]
v_pk_mul_f32 v[136:137], v[36:37], v[136:137] op_sel:[1,0] op_sel_hi:[1,1]
v_pk_mul_f32 v[138:139], v[36:37], v[138:139] op_sel:[1,0] op_sel_hi:[1,1]
v_cvt_pk_bf16_f32 v204, v204, v205
v_cvt_pk_bf16_f32 v205, v206, v207
ds_write_b64 v15, v[204:205] offset:6656
v_pk_fma_f32 v[208:209], v[36:37], v[60:61], v[208:209] op_sel_hi:[0,1,1] neg_lo:[1,0,0] neg_hi:[1,0,0]
v_pk_fma_f32 v[210:211], v[36:37], v[62:63], v[210:211] op_sel_hi:[0,1,1] neg_lo:[1,0,0] neg_hi:[1,0,0]
v_pk_mul_f32 v[172:173], v[36:37], v[172:173] op_sel:[1,0] op_sel_hi:[1,1]
v_pk_mul_f32 v[174:175], v[36:37], v[174:175] op_sel:[1,0] op_sel_hi:[1,1]
v_cvt_pk_bf16_f32 v136, v136, v137
v_cvt_pk_bf16_f32 v137, v138, v139
ds_write_b64 v15, v[136:137] offset:12800
v_pk_fma_f32 v[140:141], v[38:39], v[52:53], v[140:141] op_sel_hi:[0,1,1] neg_lo:[1,0,0] neg_hi:[1,0,0]
v_pk_fma_f32 v[142:143], v[38:39], v[54:55], v[142:143] op_sel_hi:[0,1,1] neg_lo:[1,0,0] neg_hi:[1,0,0]
v_pk_mul_f32 v[208:209], v[36:37], v[208:209] op_sel:[1,0] op_sel_hi:[1,1]
v_pk_mul_f32 v[210:211], v[36:37], v[210:211] op_sel:[1,0] op_sel_hi:[1,1]
v_cvt_pk_bf16_f32 v172, v172, v173
v_cvt_pk_bf16_f32 v173, v174, v175
ds_write_b64 v15, v[172:173] offset:12928
v_pk_fma_f32 v[176:177], v[38:39], v[56:57], v[176:177] op_sel_hi:[0,1,1] neg_lo:[1,0,0] neg_hi:[1,0,0]
v_pk_fma_f32 v[178:179], v[38:39], v[58:59], v[178:179] op_sel_hi:[0,1,1] neg_lo:[1,0,0] neg_hi:[1,0,0]
v_pk_mul_f32 v[140:141], v[38:39], v[140:141] op_sel:[1,0] op_sel_hi:[1,1]
v_pk_mul_f32 v[142:143], v[38:39], v[142:143] op_sel:[1,0] op_sel_hi:[1,1]
v_cvt_pk_bf16_f32 v208, v208, v209
v_cvt_pk_bf16_f32 v209, v210, v211
ds_write_b64 v15, v[208:209] offset:13056
v_pk_fma_f32 v[212:213], v[38:39], v[60:61], v[212:213] op_sel_hi:[0,1,1] neg_lo:[1,0,0] neg_hi:[1,0,0]
v_pk_fma_f32 v[214:215], v[38:39], v[62:63], v[214:215] op_sel_hi:[0,1,1] neg_lo:[1,0,0] neg_hi:[1,0,0]
v_pk_mul_f32 v[176:177], v[38:39], v[176:177] op_sel:[1,0] op_sel_hi:[1,1]
v_pk_mul_f32 v[178:179], v[38:39], v[178:179] op_sel:[1,0] op_sel_hi:[1,1]
v_cvt_pk_bf16_f32 v140, v140, v141
v_cvt_pk_bf16_f32 v141, v142, v143
ds_write_b64 v15, v[140:141] offset:19200
v_pk_fma_f32 v[144:145], v[40:41], v[52:53], v[144:145] op_sel_hi:[0,1,1] neg_lo:[1,0,0] neg_hi:[1,0,0]
v_pk_fma_f32 v[146:147], v[40:41], v[54:55], v[146:147] op_sel_hi:[0,1,1] neg_lo:[1,0,0] neg_hi:[1,0,0]
v_pk_mul_f32 v[212:213], v[38:39], v[212:213] op_sel:[1,0] op_sel_hi:[1,1]
v_pk_mul_f32 v[214:215], v[38:39], v[214:215] op_sel:[1,0] op_sel_hi:[1,1]
v_cvt_pk_bf16_f32 v176, v176, v177
v_cvt_pk_bf16_f32 v177, v178, v179
ds_write_b64 v15, v[176:177] offset:19328
v_pk_fma_f32 v[180:181], v[40:41], v[56:57], v[180:181] op_sel_hi:[0,1,1] neg_lo:[1,0,0] neg_hi:[1,0,0]
v_pk_fma_f32 v[182:183], v[40:41], v[58:59], v[182:183] op_sel_hi:[0,1,1] neg_lo:[1,0,0] neg_hi:[1,0,0]
v_pk_mul_f32 v[144:145], v[40:41], v[144:145] op_sel:[1,0] op_sel_hi:[1,1]
v_pk_mul_f32 v[146:147], v[40:41], v[146:147] op_sel:[1,0] op_sel_hi:[1,1]
v_cvt_pk_bf16_f32 v212, v212, v213
v_cvt_pk_bf16_f32 v213, v214, v215
ds_write_b64 v15, v[212:213] offset:19456
v_pk_fma_f32 v[216:217], v[40:41], v[60:61], v[216:217] op_sel_hi:[0,1,1] neg_lo:[1,0,0] neg_hi:[1,0,0]
v_pk_fma_f32 v[218:219], v[40:41], v[62:63], v[218:219] op_sel_hi:[0,1,1] neg_lo:[1,0,0] neg_hi:[1,0,0]
v_pk_mul_f32 v[180:181], v[40:41], v[180:181] op_sel:[1,0] op_sel_hi:[1,1]
v_pk_mul_f32 v[182:183], v[40:41], v[182:183] op_sel:[1,0] op_sel_hi:[1,1]
v_cvt_pk_bf16_f32 v144, v144, v145
v_cvt_pk_bf16_f32 v145, v146, v147
ds_write_b64 v15, v[144:145] offset:25600
v_pk_fma_f32 v[148:149], v[42:43], v[52:53], v[148:149] op_sel_hi:[0,1,1] neg_lo:[1,0,0] neg_hi:[1,0,0]
v_pk_fma_f32 v[150:151], v[42:43], v[54:55], v[150:151] op_sel_hi:[0,1,1] neg_lo:[1,0,0] neg_hi:[1,0,0]
v_pk_mul_f32 v[216:217], v[40:41], v[216:217] op_sel:[1,0] op_sel_hi:[1,1]
v_pk_mul_f32 v[218:219], v[40:41], v[218:219] op_sel:[1,0] op_sel_hi:[1,1]
v_cvt_pk_bf16_f32 v180, v180, v181
v_cvt_pk_bf16_f32 v181, v182, v183
ds_write_b64 v15, v[180:181] offset:25728
v_pk_fma_f32 v[184:185], v[42:43], v[56:57], v[184:185] op_sel_hi:[0,1,1] neg_lo:[1,0,0] neg_hi:[1,0,0]
v_pk_fma_f32 v[186:187], v[42:43], v[58:59], v[186:187] op_sel_hi:[0,1,1] neg_lo:[1,0,0] neg_hi:[1,0,0]
v_pk_mul_f32 v[148:149], v[42:43], v[148:149] op_sel:[1,0] op_sel_hi:[1,1]
v_pk_mul_f32 v[150:151], v[42:43], v[150:151] op_sel:[1,0] op_sel_hi:[1,1]
v_cvt_pk_bf16_f32 v216, v216, v217
v_cvt_pk_bf16_f32 v217, v218, v219
ds_write_b64 v15, v[216:217] offset:25856
v_pk_fma_f32 v[220:221], v[42:43], v[60:61], v[220:221] op_sel_hi:[0,1,1] neg_lo:[1,0,0] neg_hi:[1,0,0]
v_pk_fma_f32 v[222:223], v[42:43], v[62:63], v[222:223] op_sel_hi:[0,1,1] neg_lo:[1,0,0] neg_hi:[1,0,0]
v_pk_mul_f32 v[184:185], v[42:43], v[184:185] op_sel:[1,0] op_sel_hi:[1,1]
v_pk_mul_f32 v[186:187], v[42:43], v[186:187] op_sel:[1,0] op_sel_hi:[1,1]
v_cvt_pk_bf16_f32 v148, v148, v149
v_cvt_pk_bf16_f32 v149, v150, v151
ds_write_b64 v15, v[148:149] offset:32000
v_pk_fma_f32 v[152:153], v[44:45], v[52:53], v[152:153] op_sel_hi:[0,1,1] neg_lo:[1,0,0] neg_hi:[1,0,0]
v_pk_fma_f32 v[154:155], v[44:45], v[54:55], v[154:155] op_sel_hi:[0,1,1] neg_lo:[1,0,0] neg_hi:[1,0,0]
v_pk_mul_f32 v[220:221], v[42:43], v[220:221] op_sel:[1,0] op_sel_hi:[1,1]
v_pk_mul_f32 v[222:223], v[42:43], v[222:223] op_sel:[1,0] op_sel_hi:[1,1]
v_cvt_pk_bf16_f32 v184, v184, v185
v_cvt_pk_bf16_f32 v185, v186, v187
ds_write_b64 v15, v[184:185] offset:32128
v_pk_fma_f32 v[188:189], v[44:45], v[56:57], v[188:189] op_sel_hi:[0,1,1] neg_lo:[1,0,0] neg_hi:[1,0,0]
v_pk_fma_f32 v[190:191], v[44:45], v[58:59], v[190:191] op_sel_hi:[0,1,1] neg_lo:[1,0,0] neg_hi:[1,0,0]
v_pk_mul_f32 v[152:153], v[44:45], v[152:153] op_sel:[1,0] op_sel_hi:[1,1]
v_pk_mul_f32 v[154:155], v[44:45], v[154:155] op_sel:[1,0] op_sel_hi:[1,1]
v_cvt_pk_bf16_f32 v220, v220, v221
v_cvt_pk_bf16_f32 v221, v222, v223
ds_write_b64 v15, v[220:221] offset:32256
v_pk_fma_f32 v[224:225], v[44:45], v[60:61], v[224:225] op_sel_hi:[0,1,1] neg_lo:[1,0,0] neg_hi:[1,0,0]
v_pk_fma_f32 v[226:227], v[44:45], v[62:63], v[226:227] op_sel_hi:[0,1,1] neg_lo:[1,0,0] neg_hi:[1,0,0]
v_pk_mul_f32 v[188:189], v[44:45], v[188:189] op_sel:[1,0] op_sel_hi:[1,1]
v_pk_mul_f32 v[190:191], v[44:45], v[190:191] op_sel:[1,0] op_sel_hi:[1,1]
v_cvt_pk_bf16_f32 v152, v152, v153
v_cvt_pk_bf16_f32 v153, v154, v155
ds_write_b64 v15, v[152:153] offset:38400
v_pk_fma_f32 v[156:157], v[46:47], v[52:53], v[156:157] op_sel_hi:[0,1,1] neg_lo:[1,0,0] neg_hi:[1,0,0]
v_pk_fma_f32 v[158:159], v[46:47], v[54:55], v[158:159] op_sel_hi:[0,1,1] neg_lo:[1,0,0] neg_hi:[1,0,0]
v_pk_mul_f32 v[224:225], v[44:45], v[224:225] op_sel:[1,0] op_sel_hi:[1,1]
v_pk_mul_f32 v[226:227], v[44:45], v[226:227] op_sel:[1,0] op_sel_hi:[1,1]
v_cvt_pk_bf16_f32 v188, v188, v189
v_cvt_pk_bf16_f32 v189, v190, v191
ds_write_b64 v15, v[188:189] offset:38528
v_pk_fma_f32 v[192:193], v[46:47], v[56:57], v[192:193] op_sel_hi:[0,1,1] neg_lo:[1,0,0] neg_hi:[1,0,0]
v_pk_fma_f32 v[194:195], v[46:47], v[58:59], v[194:195] op_sel_hi:[0,1,1] neg_lo:[1,0,0] neg_hi:[1,0,0]
v_pk_mul_f32 v[156:157], v[46:47], v[156:157] op_sel:[1,0] op_sel_hi:[1,1]
v_pk_mul_f32 v[158:159], v[46:47], v[158:159] op_sel:[1,0] op_sel_hi:[1,1]
v_cvt_pk_bf16_f32 v224, v224, v225
v_cvt_pk_bf16_f32 v225, v226, v227
ds_write_b64 v15, v[224:225] offset:38656
v_pk_fma_f32 v[228:229], v[46:47], v[60:61], v[228:229] op_sel_hi:[0,1,1] neg_lo:[1,0,0] neg_hi:[1,0,0]
v_pk_fma_f32 v[230:231], v[46:47], v[62:63], v[230:231] op_sel_hi:[0,1,1] neg_lo:[1,0,0] neg_hi:[1,0,0]
v_pk_mul_f32 v[192:193], v[46:47], v[192:193] op_sel:[1,0] op_sel_hi:[1,1]
v_pk_mul_f32 v[194:195], v[46:47], v[194:195] op_sel:[1,0] op_sel_hi:[1,1]
v_cvt_pk_bf16_f32 v156, v156, v157
v_cvt_pk_bf16_f32 v157, v158, v159
ds_write_b64 v15, v[156:157] offset:44800
v_pk_fma_f32 v[160:161], v[48:49], v[52:53], v[160:161] op_sel_hi:[0,1,1] neg_lo:[1,0,0] neg_hi:[1,0,0]
v_pk_fma_f32 v[162:163], v[48:49], v[54:55], v[162:163] op_sel_hi:[0,1,1] neg_lo:[1,0,0] neg_hi:[1,0,0]
v_pk_mul_f32 v[228:229], v[46:47], v[228:229] op_sel:[1,0] op_sel_hi:[1,1]
v_pk_mul_f32 v[230:231], v[46:47], v[230:231] op_sel:[1,0] op_sel_hi:[1,1]
v_cvt_pk_bf16_f32 v192, v192, v193
v_cvt_pk_bf16_f32 v193, v194, v195
ds_write_b64 v15, v[192:193] offset:44928
v_pk_fma_f32 v[196:197], v[48:49], v[56:57], v[196:197] op_sel_hi:[0,1,1] neg_lo:[1,0,0] neg_hi:[1,0,0]
v_pk_fma_f32 v[198:199], v[48:49], v[58:59], v[198:199] op_sel_hi:[0,1,1] neg_lo:[1,0,0] neg_hi:[1,0,0]
v_pk_mul_f32 v[160:161], v[48:49], v[160:161] op_sel:[1,0] op_sel_hi:[1,1]
v_pk_mul_f32 v[162:163], v[48:49], v[162:163] op_sel:[1,0] op_sel_hi:[1,1]
v_cvt_pk_bf16_f32 v228, v228, v229
v_cvt_pk_bf16_f32 v229, v230, v231
ds_write_b64 v15, v[228:229] offset:45056
v_pk_fma_f32 v[232:233], v[48:49], v[60:61], v[232:233] op_sel_hi:[0,1,1] neg_lo:[1,0,0] neg_hi:[1,0,0]
v_pk_fma_f32 v[234:235], v[48:49], v[62:63], v[234:235] op_sel_hi:[0,1,1] neg_lo:[1,0,0] neg_hi:[1,0,0]
v_pk_mul_f32 v[196:197], v[48:49], v[196:197] op_sel:[1,0] op_sel_hi:[1,1]
v_pk_mul_f32 v[198:199], v[48:49], v[198:199] op_sel:[1,0] op_sel_hi:[1,1]
v_cvt_pk_bf16_f32 v160, v160, v161
v_cvt_pk_bf16_f32 v161, v162, v163
ds_write_b64 v15, v[160:161] offset:51200
v_pk_mul_f32 v[232:233], v[48:49], v[232:233] op_sel:[1,0] op_sel_hi:[1,1]
v_pk_mul_f32 v[234:235], v[48:49], v[234:235] op_sel:[1,0] op_sel_hi:[1,1]
v_cvt_pk_bf16_f32 v196, v196, v197
v_cvt_pk_bf16_f32 v197, v198, v199
ds_write_b64 v15, v[196:197] offset:51328
v_cvt_pk_bf16_f32 v232, v232, v233
v_cvt_pk_bf16_f32 v233, v234, v235
ds_write_b64 v15, v[232:233] offset:51456
s_waitcnt lgkmcnt(0)
s_branch Latt_5
Lpf_4:
s_lshl_b32 s43, s35, 7
s_waitcnt lgkmcnt(0)
s_mov_b32 s8, s64
s_mov_b32 s9, s65
s_mov_b32 s10, 4194304
s_mov_b32 s11, 0x20000
s_add_u32 s12, s66, s43
s_addc_u32 s13, s67, 0
s_mov_b32 s14, 6289536
s_mov_b32 s15, 0x20000
s_add_u32 s84, s82, 28311552
s_addc_u32 s85, s83, 0
s_branch Lov_3
.p2align 12
.fill 16, 4, 0xbf800000
Lst_3_0:
s_branch Lwr_158
s_nop 0
s_nop 0
Lov_3:
s_mov_b32 s86, 114688
s_mov_b32 s87, 0x20000
s_mov_b32 s56, s80
s_mov_b32 s57, s81
s_mov_b32 s58, 256
s_mov_b32 s59, 0x20000
v_mov_b32 v5, 0
v_lshlrev_b32 v14, 7, v1
s_or_b32 s43, s34, s35
s_cmp_lg_u32 s43, 0
s_cbranch_scc1 Lz_32
s_movk_i32 s43, 0x2000
buffer_store_dword v5, v14, s[84:87], 0 offen sc1
s_bfm_b64 exec, 60, 0
buffer_store_dword v5, v14, s[84:87], s43 offen sc1
s_mov_b64 exec, 1
v_mov_b32 v6, 1
s_waitcnt vmcnt(0)
buffer_store_dword v6, v5, s[56:59], 0 offen sc1
s_mov_b64 exec, -1
Lz_32:
s_lshl_b32 s43, s51, 11
buffer_load_dwordx4 v[96:99], v10, s[8:11], s43 offen offset:0
buffer_load_dwordx4 v[100:103], v10, s[8:11], s43 offen offset:1024
buffer_load_dwordx4 v[104:107], v10, s[8:11], s43 offen offset:2048
buffer_load_dwordx4 v[108:111], v10, s[8:11], s43 offen offset:3072
v_min_u32 v14, 23, v1
v_lshrrev_b32 v15, 3, v14
v_mul_u32_u24 v15, 43008, v15
v_and_b32 v14, 7, v14
v_lshl_add_u32 v15, v14, 4, v15
v_mov_b32 v32, 0x3f803f80
v_mov_b32 v33, 0x3f803f80
v_mov_b32 v34, 0x3f803f80
v_mov_b32 v35, 0x3f803f80
ds_write_b128 v15, v[32:35]
s_add_u32 s20, s82, 26214400
s_addc_u32 s21, s83, 0
s_mov_b32 s22, 16384
s_mov_b32 s23, 0x20000
s_add_u32 s43, s2, 128
s_lshl_b32 s43, s43, 7
v_lshlrev_b32 v14, 2, v1
s_mov_b64 exec, 15
buffer_store_dword v5, v14, s[84:87], s43 offen sc1
s_mov_b64 exec, -1
s_lshl_b32 s43, s34, 4
s_add_u32 s43, s43, s35
s_lshl_b32 s43, s43, 8
s_add_u32 s43, s43, 49152
v_lshlrev_b32 v14, 7, v1
s_mov_b64 exec, 3
buffer_store_dword v5, v14, s[84:87], s43 offen sc1
s_mov_b64 exec, -1
s_lshl_b32 s52, s34, 7
s_add_u32 s52, s52, 28319744
s_sub_u32 s53, s52, 128
s_cmp_eq_u32 s34, 0
s_cselect_b32 s53, s52, s53
s_waitcnt lgkmcnt(0)
s_barrier
s_waitcnt vmcnt(2)
s_mov_b32 s43, 0x3f803f80
v_mov_b32 v116, 0
v_mov_b32 v117, 0
v_mov_b32 v118, 0
v_mov_b32 v119, 0
v_mov_b32 v120, 0
v_mov_b32 v121, 0
v_mov_b32 v122, 0
v_mov_b32 v123, 0
v_dot2_f32_bf16 v116, v96, s43, v116
v_dot2_f32_bf16 v120, v96, v96, v120
v_dot2_f32_bf16 v118, v104, s43, v118
v_dot2_f32_bf16 v122, v104, v104, v122
v_dot2_f32_bf16 v117, v97, s43, v117
v_dot2_f32_bf16 v121, v97, v97, v121
v_dot2_f32_bf16 v119, v105, s43, v119
v_dot2_f32_bf16 v123, v105, v105, v123
v_dot2_f32_bf16 v116, v98, s43, v116
v_dot2_f32_bf16 v120, v98, v98, v120
v_dot2_f32_bf16 v118, v106, s43, v118
v_dot2_f32_bf16 v122, v106, v106, v122
v_dot2_f32_bf16 v117, v99, s43, v117
v_dot2_f32_bf16 v121, v99, v99, v121
v_dot2_f32_bf16 v119, v107, s43, v119
v_dot2_f32_bf16 v123, v107, v107, v123
v_dot2_f32_bf16 v116, v100, s43, v116
v_dot2_f32_bf16 v120, v100, v100, v120
v_dot2_f32_bf16 v118, v108, s43, v118
v_dot2_f32_bf16 v122, v108, v108, v122
v_dot2_f32_bf16 v117, v101, s43, v117
v_dot2_f32_bf16 v121, v101, v101, v121
v_dot2_f32_bf16 v119, v109, s43, v119
v_dot2_f32_bf16 v123, v109, v109, v123
v_dot2_f32_bf16 v116, v102, s43, v116
v_dot2_f32_bf16 v120, v102, v102, v120
v_dot2_f32_bf16 v118, v110, s43, v118
v_dot2_f32_bf16 v122, v110, v110, v122
v_dot2_f32_bf16 v117, v103, s43, v117
v_dot2_f32_bf16 v121, v103, v103, v121
v_dot2_f32_bf16 v119, v111, s43, v119
v_dot2_f32_bf16 v123, v111, v111, v123
s_nop 2
v_add_f32 v116, v116, v117
v_add_f32 v118, v118, v119
v_add_f32 v120, v120, v121
v_add_f32 v122, v122, v123
s_nop 1
v_permlane32_swap_b32 v116, v118
v_permlane32_swap_b32 v120, v122
v_add_f32 v116, v116, v118
v_add_f32 v120, v120, v122
s_nop 1
v_permlane16_swap_b32 v116, v120
v_add_f32 v116, v116, v120
s_nop 1
v_add_f32_dpp v116, v116, v116 row_ror:8 row_mask:0xf bank_mask:0xf
s_nop 1
v_add_f32_dpp v116, v116, v116 row_ror:4 row_mask:0xf bank_mask:0xf
s_nop 1
v_add_f32_dpp v116, v116, v116 row_ror:2 row_mask:0xf bank_mask:0xf
s_nop 1
v_add_f32_dpp v116, v116, v116 row_ror:1 row_mask:0xf bank_mask:0xf
v_mov_b32 v117, v116
s_nop 1
v_permlane16_swap_b32 v116, v117
v_mul_f32 v112, 0x3a800000, v116
v_mul_f32 v113, 0x3a800000, v117
v_fma_f32 v113, -v112, v112, v113
v_max_f32 v113, 0, v113
v_add_f32 v113, 0x3727c5ac, v113
v_rsq_f32 v113, v113
v_lshrrev_b32 v11, 5, v1
s_lshl_b32 s43, s47, 4
s_add_u32 s43, s43, 148608
v_lshl_add_u32 v11, v11, 3, s43
ds_write_b64 v11, v[112:113]
s_waitcnt lgkmcnt(0)
s_mov_b32 s28, s66
s_mov_b32 s29, s67
s_mov_b32 s30, 6291456
s_mov_b32 s31, 0x20000
s_mul_i32 s43, s33, 8832
s_add_u32 s43, s43, 1572864
v_lshlrev_b32 v30, 7, v1
buffer_load_dword v31, v30, s[28:31], s43 offen
s_add_u32 s43, s43, 8192
s_bfm_b64 exec, 5, 0
buffer_load_dword v31, v30, s[28:31], s43 offen
s_mov_b64 exec, -1
s_branch Lst_0_0
Lwr_155:
s_barrier
v_lshlrev_b32 v5, 4, v1
v_and_b32 v5, 63, v5
v_add_u32 v6, 148608, v5
ds_read_b128 v[112:115], v6
s_lshl_b32 s43, s63, 3
v_add_u32 v5, s43, v5
s_waitcnt lgkmcnt(0)
s_mov_b64 exec, 15
buffer_store_dwordx4 v[112:115], v5, s[20:23], 0 offen sc1
s_mov_b64 exec, -1
v_mov_b32 v4, 0
buffer_load_dword v6, v4, s[56:59], 0 offen sc1
s_mov_b32 s62, 0
s_mov_b32 s28, s66
s_mov_b32 s29, s67
s_mov_b32 s30, 6291456
s_mov_b32 s31, 0x20000
s_mul_i32 s43, s33, 12288
s_add_u32 s43, s43, 3538944
v_lshlrev_b32 v30, 7, v1
buffer_load_dword v31, v30, s[28:31], s43 offen
s_add_u32 s43, s43, 8192
s_bfm_b64 exec, 32, 0
buffer_load_dword v31, v30, s[28:31], s43 offen
s_mov_b64 exec, -1
s_branch Lst_1_0
Lwr_156:
s_barrier
s_lshl_b32 s43, s35, 7
s_add_u32 s28, s68, s43
s_addc_u32 s29, s69, 0
s_mov_b32 s30, 2095232
s_mov_b32 s31, 0x20000
v_and_b32 v29, 7, v1
v_lshrrev_b32 v30, 3, v1
v_lshl_add_u32 v29, v30, 6, v29
s_lshl_b32 s43, s48, 3
v_add_u32 v29, s43, v29
v_lshlrev_b32 v29, 11, v29
s_mov_b32 s43, 1048576
s_mov_b32 s28, s68
s_mov_b32 s29, s69
s_mov_b32 s30, 2097152
s_mov_b32 s31, 0x20000
s_mul_i32 s43, s33, 9472
v_lshlrev_b32 v30, 7, v1
buffer_load_dword v31, v30, s[28:31], s43 offen
s_add_u32 s43, s43, 8192
s_bfm_b64 exec, 10, 0
buffer_load_dword v31, v30, s[28:31], s43 offen
s_mov_b64 exec, -1
s_branch Lst_2_0
Lwr_157:
s_barrier
s_branch Lst_3_0
Lwr_158:
s_barrier
s_branch Lst_4_0
Lwr_159:
s_barrier
s_branch Lst_5_0
Lwr_160:
s_barrier
s_cmp_eq_u32 s62, 3
s_cbranch_scc1 Lste_36
s_cmp_eq_u32 s62, 2
s_cbranch_scc1 Lst2_34
s_cmp_ge_u32 s62, 4
s_cbranch_scc1 Lst4_35
s_cmp_eq_u32 s62, 1
s_cbranch_scc1 Lst1_33
s_waitcnt vmcnt(4)
v_readfirstlane_b32 s54, v6
s_cmp_eq_u32 s54, 0
s_cbranch_scc0 Lrep_37
buffer_load_dword v6, v4, s[56:59], 0 offen sc1
s_branch Lste_36
Lrep_37:
s_add_u32 s7, s34, 64
s_lshl_b32 s7, s7, 7
v_mov_b32 v5, s7
v_mov_b32 v6, 1
s_mov_b64 exec, 1
buffer_atomic_add v6, v5, s[84:87], 0 offen sc1
s_mov_b64 exec, -1
s_mov_b32 s62, 1
s_mov_b32 s54, 0
s_mov_b32 s55, 0
s_branch Lste_36
Lst1_33:
s_and_b32 s43, s54, s55
s_cmp_eq_u32 s43, 16
s_cbranch_scc1 Lg_38
s_load_dword s54, s[82:83], s52 glc
s_load_dword s55, s[82:83], s53 glc
s_branch Lste_36
Lg_38:
v_add_u32 v5, 0, v1
v_min_u32 v5, 143, v5
v_lshlrev_b32 v20, 3, v5
v_add_u32 v5, s50, v5
v_max_i32 v5, 0, v5
v_lshlrev_b32 v5, 3, v5
buffer_load_dwordx2 v[32:33], v5, s[20:23], 0 offen sc1
v_add_u32 v5, 64, v1
v_min_u32 v5, 143, v5
v_lshlrev_b32 v21, 3, v5
v_add_u32 v5, s50, v5
v_max_i32 v5, 0, v5
v_lshlrev_b32 v5, 3, v5
buffer_load_dwordx2 v[34:35], v5, s[20:23], 0 offen sc1
v_add_u32 v5, 128, v1
v_min_u32 v5, 143, v5
v_lshlrev_b32 v22, 3, v5
v_add_u32 v5, s50, v5
v_max_i32 v5, 0, v5
v_lshlrev_b32 v5, 3, v5
buffer_load_dwordx2 v[36:37], v5, s[20:23], 0 offen sc1
s_mov_b32 s62, 4
s_branch Lste_36
Lst4_35:
s_mov_b32 s62, 2
s_branch Lste_36
Lst2_34:
s_waitcnt vmcnt(0)
v_add_u32 v20, 147456, v20
ds_write_b64 v20, v[32:33]
v_add_u32 v21, 147456, v21
ds_write_b64 v21, v[34:35]
v_add_u32 v22, 147456, v22
ds_write_b64 v22, v[36:37]
s_waitcnt lgkmcnt(0)
s_mov_b32 s62, 3
Lste_36:
s_branch Lst_6_0
Lwr_161:
s_barrier
s_cmp_eq_u32 s62, 3
s_cbranch_scc1 Lste_42
s_cmp_eq_u32 s62, 2
s_cbranch_scc1 Lst2_40
s_cmp_ge_u32 s62, 4
s_cbranch_scc1 Lst4_41
s_cmp_eq_u32 s62, 1
s_cbranch_scc1 Lst1_39
s_waitcnt vmcnt(0)
v_readfirstlane_b32 s54, v6
s_cmp_eq_u32 s54, 0
s_cbranch_scc0 Lrep_43
buffer_load_dword v6, v4, s[56:59], 0 offen sc1
s_branch Lste_42
Lrep_43:
s_add_u32 s7, s34, 64
s_lshl_b32 s7, s7, 7
v_mov_b32 v5, s7
v_mov_b32 v6, 1
s_mov_b64 exec, 1
buffer_atomic_add v6, v5, s[84:87], 0 offen sc1
s_mov_b64 exec, -1
s_mov_b32 s62, 1
s_mov_b32 s54, 0
s_mov_b32 s55, 0
s_branch Lste_42
Lst1_39:
s_and_b32 s43, s54, s55
s_cmp_eq_u32 s43, 16
s_cbranch_scc1 Lg_44
s_load_dword s54, s[82:83], s52 glc
s_load_dword s55, s[82:83], s53 glc
s_branch Lste_42
Lg_44:
v_add_u32 v5, 0, v1
v_min_u32 v5, 143, v5
v_lshlrev_b32 v20, 3, v5
v_add_u32 v5, s50, v5
v_max_i32 v5, 0, v5
v_lshlrev_b32 v5, 3, v5
buffer_load_dwordx2 v[32:33], v5, s[20:23], 0 offen sc1
v_add_u32 v5, 64, v1
v_min_u32 v5, 143, v5
v_lshlrev_b32 v21, 3, v5
v_add_u32 v5, s50, v5
v_max_i32 v5, 0, v5
v_lshlrev_b32 v5, 3, v5
buffer_load_dwordx2 v[34:35], v5, s[20:23], 0 offen sc1
v_add_u32 v5, 128, v1
v_min_u32 v5, 143, v5
v_lshlrev_b32 v22, 3, v5
v_add_u32 v5, s50, v5
v_max_i32 v5, 0, v5
v_lshlrev_b32 v5, 3, v5
buffer_load_dwordx2 v[36:37], v5, s[20:23], 0 offen sc1
s_mov_b32 s62, 4
s_branch Lste_42
Lst4_41:
s_mov_b32 s62, 2
s_branch Lste_42
Lst2_40:
s_waitcnt vmcnt(0)
v_add_u32 v20, 147456, v20
ds_write_b64 v20, v[32:33]
v_add_u32 v21, 147456, v21
ds_write_b64 v21, v[34:35]
v_add_u32 v22, 147456, v22
ds_write_b64 v22, v[36:37]
s_waitcnt lgkmcnt(0)
s_mov_b32 s62, 3
Lste_42:
s_branch Lst_7_0
Lwr_162:
s_barrier
s_cmp_eq_u32 s62, 3
s_cbranch_scc1 Lste_48
s_cmp_eq_u32 s62, 2
s_cbranch_scc1 Lst2_46
s_cmp_ge_u32 s62, 4
s_cbranch_scc1 Lst4_47
s_cmp_eq_u32 s62, 1
s_cbranch_scc1 Lst1_45
s_waitcnt vmcnt(0)
v_readfirstlane_b32 s54, v6
s_cmp_eq_u32 s54, 0
s_cbranch_scc0 Lrep_49
buffer_load_dword v6, v4, s[56:59], 0 offen sc1
s_branch Lste_48
Lrep_49:
s_add_u32 s7, s34, 64
s_lshl_b32 s7, s7, 7
v_mov_b32 v5, s7
v_mov_b32 v6, 1
s_mov_b64 exec, 1
buffer_atomic_add v6, v5, s[84:87], 0 offen sc1
s_mov_b64 exec, -1
s_mov_b32 s62, 1
s_mov_b32 s54, 0
s_mov_b32 s55, 0
s_branch Lste_48
Lst1_45:
s_and_b32 s43, s54, s55
s_cmp_eq_u32 s43, 16
s_cbranch_scc1 Lg_50
s_load_dword s54, s[82:83], s52 glc
s_load_dword s55, s[82:83], s53 glc
s_branch Lste_48
Lg_50:
v_add_u32 v5, 0, v1
v_min_u32 v5, 143, v5
v_lshlrev_b32 v20, 3, v5
v_add_u32 v5, s50, v5
v_max_i32 v5, 0, v5
v_lshlrev_b32 v5, 3, v5
buffer_load_dwordx2 v[32:33], v5, s[20:23], 0 offen sc1
v_add_u32 v5, 64, v1
v_min_u32 v5, 143, v5
v_lshlrev_b32 v21, 3, v5
v_add_u32 v5, s50, v5
v_max_i32 v5, 0, v5
v_lshlrev_b32 v5, 3, v5
buffer_load_dwordx2 v[34:35], v5, s[20:23], 0 offen sc1
v_add_u32 v5, 128, v1
v_min_u32 v5, 143, v5
v_lshlrev_b32 v22, 3, v5
v_add_u32 v5, s50, v5
v_max_i32 v5, 0, v5
v_lshlrev_b32 v5, 3, v5
buffer_load_dwordx2 v[36:37], v5, s[20:23], 0 offen sc1
s_mov_b32 s62, 4
s_branch Lste_48
Lst4_47:
s_mov_b32 s62, 2
s_branch Lste_48
Lst2_46:
s_waitcnt vmcnt(0)
v_add_u32 v20, 147456, v20
ds_write_b64 v20, v[32:33]
v_add_u32 v21, 147456, v21
ds_write_b64 v21, v[34:35]
v_add_u32 v22, 147456, v22
ds_write_b64 v22, v[36:37]
s_waitcnt lgkmcnt(0)
s_mov_b32 s62, 3
Lste_48:
s_branch Lst_8_0
Lwr_163:
s_barrier
s_cmp_eq_u32 s62, 3
s_cbranch_scc1 Lste_54
s_cmp_eq_u32 s62, 2
s_cbranch_scc1 Lst2_52
s_cmp_ge_u32 s62, 4
s_cbranch_scc1 Lst4_53
s_cmp_eq_u32 s62, 1
s_cbranch_scc1 Lst1_51
s_waitcnt vmcnt(0)
v_readfirstlane_b32 s54, v6
s_cmp_eq_u32 s54, 0
s_cbranch_scc0 Lrep_55
buffer_load_dword v6, v4, s[56:59], 0 offen sc1
s_branch Lste_54
Lrep_55:
s_add_u32 s7, s34, 64
s_lshl_b32 s7, s7, 7
v_mov_b32 v5, s7
v_mov_b32 v6, 1
s_mov_b64 exec, 1
buffer_atomic_add v6, v5, s[84:87], 0 offen sc1
s_mov_b64 exec, -1
s_mov_b32 s62, 1
s_mov_b32 s54, 0
s_mov_b32 s55, 0
s_branch Lste_54
Lst1_51:
s_and_b32 s43, s54, s55
s_cmp_eq_u32 s43, 16
s_cbranch_scc1 Lg_56
s_load_dword s54, s[82:83], s52 glc
s_load_dword s55, s[82:83], s53 glc
s_branch Lste_54
Lg_56:
v_add_u32 v5, 0, v1
v_min_u32 v5, 143, v5
v_lshlrev_b32 v20, 3, v5
v_add_u32 v5, s50, v5
v_max_i32 v5, 0, v5
v_lshlrev_b32 v5, 3, v5
buffer_load_dwordx2 v[32:33], v5, s[20:23], 0 offen sc1
v_add_u32 v5, 64, v1
v_min_u32 v5, 143, v5
v_lshlrev_b32 v21, 3, v5
v_add_u32 v5, s50, v5
v_max_i32 v5, 0, v5
v_lshlrev_b32 v5, 3, v5
buffer_load_dwordx2 v[34:35], v5, s[20:23], 0 offen sc1
v_add_u32 v5, 128, v1
v_min_u32 v5, 143, v5
v_lshlrev_b32 v22, 3, v5
v_add_u32 v5, s50, v5
v_max_i32 v5, 0, v5
v_lshlrev_b32 v5, 3, v5
buffer_load_dwordx2 v[36:37], v5, s[20:23], 0 offen sc1
s_mov_b32 s62, 4
s_branch Lste_54
Lst4_53:
s_mov_b32 s62, 2
s_branch Lste_54
Lst2_52:
s_waitcnt vmcnt(0)
v_add_u32 v20, 147456, v20
ds_write_b64 v20, v[32:33]
v_add_u32 v21, 147456, v21
ds_write_b64 v21, v[34:35]
v_add_u32 v22, 147456, v22
ds_write_b64 v22, v[36:37]
s_waitcnt lgkmcnt(0)
s_mov_b32 s62, 3
Lste_54:
s_branch Lst_9_0
Lwr_164:
s_barrier
s_getpc_b64 s[100:101]
s_and_b32 s100, s100, 0xfffff000
s_sub_u32 s100, s100, 1064960
s_subb_u32 s101, s101, 0
s_lshr_b32 s6, s2, 3
s_mul_i32 s6, s6, 1
s_and_b32 s7, s36, 0
s_add_u32 s6, s6, s7
s_mulk_i32 s6, 640
s_add_u32 s6, s6, 1063168
s_load_dword s3, s[100:101], s6 offset:0
s_load_dword s3, s[100:101], s6 offset:64
s_load_dword s3, s[100:101], s6 offset:128
s_load_dword s3, s[100:101], s6 offset:192
s_load_dword s3, s[100:101], s6 offset:256
s_load_dword s3, s[100:101], s6 offset:320
s_load_dword s3, s[100:101], s6 offset:384
s_load_dword s3, s[100:101], s6 offset:448
s_load_dword s3, s[100:101], s6 offset:512
s_load_dword s3, s[100:101], s6 offset:576
s_cmp_eq_u32 s62, 3
s_cbranch_scc1 Lste_60
s_cmp_eq_u32 s62, 2
s_cbranch_scc1 Lst2_58
s_cmp_ge_u32 s62, 4
s_cbranch_scc1 Lst4_59
s_cmp_eq_u32 s62, 1
s_cbranch_scc1 Lst1_57
s_waitcnt vmcnt(0)
v_readfirstlane_b32 s54, v6
s_cmp_eq_u32 s54, 0
s_cbranch_scc0 Lrep_61
buffer_load_dword v6, v4, s[56:59], 0 offen sc1
s_branch Lste_60
Lrep_61:
s_add_u32 s7, s34, 64
s_lshl_b32 s7, s7, 7
v_mov_b32 v5, s7
v_mov_b32 v6, 1
s_mov_b64 exec, 1
buffer_atomic_add v6, v5, s[84:87], 0 offen sc1
s_mov_b64 exec, -1
s_mov_b32 s62, 1
s_mov_b32 s54, 0
s_mov_b32 s55, 0
s_branch Lste_60
Lst1_57:
s_and_b32 s43, s54, s55
s_cmp_eq_u32 s43, 16
s_cbranch_scc1 Lg_62
s_load_dword s54, s[82:83], s52 glc
s_load_dword s55, s[82:83], s53 glc
s_branch Lste_60
Lg_62:
v_add_u32 v5, 0, v1
v_min_u32 v5, 143, v5
v_lshlrev_b32 v20, 3, v5
v_add_u32 v5, s50, v5
v_max_i32 v5, 0, v5
v_lshlrev_b32 v5, 3, v5
buffer_load_dwordx2 v[32:33], v5, s[20:23], 0 offen sc1
v_add_u32 v5, 64, v1
v_min_u32 v5, 143, v5
v_lshlrev_b32 v21, 3, v5
v_add_u32 v5, s50, v5
v_max_i32 v5, 0, v5
v_lshlrev_b32 v5, 3, v5
buffer_load_dwordx2 v[34:35], v5, s[20:23], 0 offen sc1
v_add_u32 v5, 128, v1
v_min_u32 v5, 143, v5
v_lshlrev_b32 v22, 3, v5
v_add_u32 v5, s50, v5
v_max_i32 v5, 0, v5
v_lshlrev_b32 v5, 3, v5
buffer_load_dwordx2 v[36:37], v5, s[20:23], 0 offen sc1
s_mov_b32 s62, 4
s_branch Lste_60
Lst4_59:
s_mov_b32 s62, 2
s_branch Lste_60
Lst2_58:
s_waitcnt vmcnt(0)
v_add_u32 v20, 147456, v20
ds_write_b64 v20, v[32:33]
v_add_u32 v21, 147456, v21
ds_write_b64 v21, v[34:35]
v_add_u32 v22, 147456, v22
ds_write_b64 v22, v[36:37]
s_waitcnt lgkmcnt(0)
s_mov_b32 s62, 3
Lste_60:
s_branch Lst_10_0
Lwr_165:
s_barrier
s_cmp_eq_u32 s62, 3
s_cbranch_scc1 Lste_66
s_cmp_eq_u32 s62, 2
s_cbranch_scc1 Lst2_64
s_cmp_ge_u32 s62, 4
s_cbranch_scc1 Lst4_65
s_cmp_eq_u32 s62, 1
s_cbranch_scc1 Lst1_63
s_waitcnt vmcnt(0)
v_readfirstlane_b32 s54, v6
s_cmp_eq_u32 s54, 0
s_cbranch_scc0 Lrep_67
buffer_load_dword v6, v4, s[56:59], 0 offen sc1
s_branch Lste_66
Lrep_67:
s_add_u32 s7, s34, 64
s_lshl_b32 s7, s7, 7
v_mov_b32 v5, s7
v_mov_b32 v6, 1
s_mov_b64 exec, 1
buffer_atomic_add v6, v5, s[84:87], 0 offen sc1
s_mov_b64 exec, -1
s_mov_b32 s62, 1
s_mov_b32 s54, 0
s_mov_b32 s55, 0
s_branch Lste_66
Lst1_63:
s_and_b32 s43, s54, s55
s_cmp_eq_u32 s43, 16
s_cbranch_scc1 Lg_68
s_load_dword s54, s[82:83], s52 glc
s_load_dword s55, s[82:83], s53 glc
s_branch Lste_66
Lg_68:
v_add_u32 v5, 0, v1
v_min_u32 v5, 143, v5
v_lshlrev_b32 v20, 3, v5
v_add_u32 v5, s50, v5
v_max_i32 v5, 0, v5
v_lshlrev_b32 v5, 3, v5
buffer_load_dwordx2 v[32:33], v5, s[20:23], 0 offen sc1
v_add_u32 v5, 64, v1
v_min_u32 v5, 143, v5
v_lshlrev_b32 v21, 3, v5
v_add_u32 v5, s50, v5
v_max_i32 v5, 0, v5
v_lshlrev_b32 v5, 3, v5
buffer_load_dwordx2 v[34:35], v5, s[20:23], 0 offen sc1
v_add_u32 v5, 128, v1
v_min_u32 v5, 143, v5
v_lshlrev_b32 v22, 3, v5
v_add_u32 v5, s50, v5
v_max_i32 v5, 0, v5
v_lshlrev_b32 v5, 3, v5
buffer_load_dwordx2 v[36:37], v5, s[20:23], 0 offen sc1
s_mov_b32 s62, 4
s_branch Lste_66
Lst4_65:
s_mov_b32 s62, 2
s_branch Lste_66
Lst2_64:
s_waitcnt vmcnt(0)
v_add_u32 v20, 147456, v20
ds_write_b64 v20, v[32:33]
v_add_u32 v21, 147456, v21
ds_write_b64 v21, v[34:35]
v_add_u32 v22, 147456, v22
ds_write_b64 v22, v[36:37]
s_waitcnt lgkmcnt(0)
s_mov_b32 s62, 3
Lste_66:
s_branch Lst_11_0
Lwr_166:
s_barrier
s_cmp_eq_u32 s62, 3
s_cbranch_scc1 Lste_72
s_cmp_eq_u32 s62, 2
s_cbranch_scc1 Lst2_70
s_cmp_ge_u32 s62, 4
s_cbranch_scc1 Lst4_71
s_cmp_eq_u32 s62, 1
s_cbranch_scc1 Lst1_69
s_waitcnt vmcnt(0)
v_readfirstlane_b32 s54, v6
s_cmp_eq_u32 s54, 0
s_cbranch_scc0 Lrep_73
buffer_load_dword v6, v4, s[56:59], 0 offen sc1
s_branch Lste_72
Lrep_73:
s_add_u32 s7, s34, 64
s_lshl_b32 s7, s7, 7
v_mov_b32 v5, s7
v_mov_b32 v6, 1
s_mov_b64 exec, 1
buffer_atomic_add v6, v5, s[84:87], 0 offen sc1
s_mov_b64 exec, -1
s_mov_b32 s62, 1
s_mov_b32 s54, 0
s_mov_b32 s55, 0
s_branch Lste_72
Lst1_69:
s_and_b32 s43, s54, s55
s_cmp_eq_u32 s43, 16
s_cbranch_scc1 Lg_74
s_load_dword s54, s[82:83], s52 glc
s_load_dword s55, s[82:83], s53 glc
s_branch Lste_72
Lg_74:
v_add_u32 v5, 0, v1
v_min_u32 v5, 143, v5
v_lshlrev_b32 v20, 3, v5
v_add_u32 v5, s50, v5
v_max_i32 v5, 0, v5
v_lshlrev_b32 v5, 3, v5
buffer_load_dwordx2 v[32:33], v5, s[20:23], 0 offen sc1
v_add_u32 v5, 64, v1
v_min_u32 v5, 143, v5
v_lshlrev_b32 v21, 3, v5
v_add_u32 v5, s50, v5
v_max_i32 v5, 0, v5
v_lshlrev_b32 v5, 3, v5
buffer_load_dwordx2 v[34:35], v5, s[20:23], 0 offen sc1
v_add_u32 v5, 128, v1
v_min_u32 v5, 143, v5
v_lshlrev_b32 v22, 3, v5
v_add_u32 v5, s50, v5
v_max_i32 v5, 0, v5
v_lshlrev_b32 v5, 3, v5
buffer_load_dwordx2 v[36:37], v5, s[20:23], 0 offen sc1
s_mov_b32 s62, 4
s_branch Lste_72
Lst4_71:
s_mov_b32 s62, 2
s_branch Lste_72
Lst2_70:
s_waitcnt vmcnt(0)
v_add_u32 v20, 147456, v20
ds_write_b64 v20, v[32:33]
v_add_u32 v21, 147456, v21
ds_write_b64 v21, v[34:35]
v_add_u32 v22, 147456, v22
ds_write_b64 v22, v[36:37]
s_waitcnt lgkmcnt(0)
s_mov_b32 s62, 3
Lste_72:
s_branch Lst_12_0
Lwr_167:
s_barrier
s_cmp_eq_u32 s62, 3
s_cbranch_scc1 Lste_78
s_cmp_eq_u32 s62, 2
s_cbranch_scc1 Lst2_76
s_cmp_ge_u32 s62, 4
s_cbranch_scc1 Lst4_77
s_cmp_eq_u32 s62, 1
s_cbranch_scc1 Lst1_75
s_waitcnt vmcnt(0)
v_readfirstlane_b32 s54, v6
s_cmp_eq_u32 s54, 0
s_cbranch_scc0 Lrep_79
buffer_load_dword v6, v4, s[56:59], 0 offen sc1
s_branch Lste_78
Lrep_79:
s_add_u32 s7, s34, 64
s_lshl_b32 s7, s7, 7
v_mov_b32 v5, s7
v_mov_b32 v6, 1
s_mov_b64 exec, 1
buffer_atomic_add v6, v5, s[84:87], 0 offen sc1
s_mov_b64 exec, -1
s_mov_b32 s62, 1
s_mov_b32 s54, 0
s_mov_b32 s55, 0
s_branch Lste_78
Lst1_75:
s_and_b32 s43, s54, s55
s_cmp_eq_u32 s43, 16
s_cbranch_scc1 Lg_80
s_load_dword s54, s[82:83], s52 glc
s_load_dword s55, s[82:83], s53 glc
s_branch Lste_78
Lg_80:
v_add_u32 v5, 0, v1
v_min_u32 v5, 143, v5
v_lshlrev_b32 v20, 3, v5
v_add_u32 v5, s50, v5
v_max_i32 v5, 0, v5
v_lshlrev_b32 v5, 3, v5
buffer_load_dwordx2 v[32:33], v5, s[20:23], 0 offen sc1
v_add_u32 v5, 64, v1
v_min_u32 v5, 143, v5
v_lshlrev_b32 v21, 3, v5
v_add_u32 v5, s50, v5
v_max_i32 v5, 0, v5
v_lshlrev_b32 v5, 3, v5
buffer_load_dwordx2 v[34:35], v5, s[20:23], 0 offen sc1
v_add_u32 v5, 128, v1
v_min_u32 v5, 143, v5
v_lshlrev_b32 v22, 3, v5
v_add_u32 v5, s50, v5
v_max_i32 v5, 0, v5
v_lshlrev_b32 v5, 3, v5
buffer_load_dwordx2 v[36:37], v5, s[20:23], 0 offen sc1
s_mov_b32 s62, 4
s_branch Lste_78
Lst4_77:
s_mov_b32 s62, 2
s_branch Lste_78
Lst2_76:
s_waitcnt vmcnt(0)
v_add_u32 v20, 147456, v20
ds_write_b64 v20, v[32:33]
v_add_u32 v21, 147456, v21
s_branch Lov_4
.p2align 12
.fill 32, 4, 0xbf800000
Lst_4_0:
s_branch Lwr_159
s_nop 0
s_nop 0
Lov_4:
ds_write_b64 v21, v[34:35]
v_add_u32 v22, 147456, v22
ds_write_b64 v22, v[36:37]
s_waitcnt lgkmcnt(0)
s_mov_b32 s62, 3
Lste_78:
s_branch Lst_13_0
Lwr_168:
s_barrier
s_cmp_eq_u32 s62, 3
s_cbranch_scc1 Lste_84
s_cmp_eq_u32 s62, 2
s_cbranch_scc1 Lst2_82
s_cmp_ge_u32 s62, 4
s_cbranch_scc1 Lst4_83
s_cmp_eq_u32 s62, 1
s_cbranch_scc1 Lst1_81
s_waitcnt vmcnt(0)
v_readfirstlane_b32 s54, v6
s_cmp_eq_u32 s54, 0
s_cbranch_scc0 Lrep_85
buffer_load_dword v6, v4, s[56:59], 0 offen sc1
s_branch Lste_84
Lrep_85:
s_add_u32 s7, s34, 64
s_lshl_b32 s7, s7, 7
v_mov_b32 v5, s7
v_mov_b32 v6, 1
s_mov_b64 exec, 1
buffer_atomic_add v6, v5, s[84:87], 0 offen sc1
s_mov_b64 exec, -1
s_mov_b32 s62, 1
s_mov_b32 s54, 0
s_mov_b32 s55, 0
s_branch Lste_84
Lst1_81:
s_and_b32 s43, s54, s55
s_cmp_eq_u32 s43, 16
s_cbranch_scc1 Lg_86
s_load_dword s54, s[82:83], s52 glc
s_load_dword s55, s[82:83], s53 glc
s_branch Lste_84
Lg_86:
v_add_u32 v5, 0, v1
v_min_u32 v5, 143, v5
v_lshlrev_b32 v20, 3, v5
v_add_u32 v5, s50, v5
v_max_i32 v5, 0, v5
v_lshlrev_b32 v5, 3, v5
buffer_load_dwordx2 v[32:33], v5, s[20:23], 0 offen sc1
v_add_u32 v5, 64, v1
v_min_u32 v5, 143, v5
v_lshlrev_b32 v21, 3, v5
v_add_u32 v5, s50, v5
v_max_i32 v5, 0, v5
v_lshlrev_b32 v5, 3, v5
buffer_load_dwordx2 v[34:35], v5, s[20:23], 0 offen sc1
v_add_u32 v5, 128, v1
v_min_u32 v5, 143, v5
v_lshlrev_b32 v22, 3, v5
v_add_u32 v5, s50, v5
v_max_i32 v5, 0, v5
v_lshlrev_b32 v5, 3, v5
buffer_load_dwordx2 v[36:37], v5, s[20:23], 0 offen sc1
s_mov_b32 s62, 4
s_branch Lste_84
Lst4_83:
s_mov_b32 s62, 2
s_branch Lste_84
Lst2_82:
s_waitcnt vmcnt(0)
v_add_u32 v20, 147456, v20
ds_write_b64 v20, v[32:33]
v_add_u32 v21, 147456, v21
ds_write_b64 v21, v[34:35]
v_add_u32 v22, 147456, v22
ds_write_b64 v22, v[36:37]
s_waitcnt lgkmcnt(0)
s_mov_b32 s62, 3
Lste_84:
s_branch Lst_14_0
Lwr_169:
s_barrier
s_cmp_eq_u32 s62, 3
s_cbranch_scc1 Lste_89
s_cmp_ge_u32 s62, 5
s_cbranch_scc1 Lg_94
s_cmp_ge_u32 s62, 2
s_cbranch_scc1 Lst2_88
s_cmp_eq_u32 s62, 1
s_cbranch_scc1 Lst1_87
s_mov_b32 s41, 0x40000
Lz0_90:
s_waitcnt vmcnt(0)
v_readfirstlane_b32 s54, v6
s_cmp_eq_u32 s54, 0
s_cbranch_scc0 Lzok_91
buffer_load_dword v6, v4, s[56:59], 0 offen sc1
s_sub_u32 s41, s41, 1
s_cmp_lg_u32 s41, 0
s_cbranch_scc1 Lz0_90
s_waitcnt lgkmcnt(0)
Lzok_91:
s_add_u32 s7, s34, 64
s_lshl_b32 s7, s7, 7
v_mov_b32 v5, s7
v_mov_b32 v6, 1
s_mov_b64 exec, 1
buffer_atomic_add v6, v5, s[84:87], 0 offen sc1
s_mov_b64 exec, -1
Lst1_87:
s_load_dword s54, s[82:83], s52 glc
s_load_dword s55, s[82:83], s53 glc
s_mov_b32 s41, 0x40000
Lpoll_92:
s_waitcnt lgkmcnt(0)
s_and_b32 s54, s54, s55
s_cmp_eq_u32 s54, 16
s_cbranch_scc1 Lg_94
s_load_dword s54, s[82:83], s52 glc
s_load_dword s55, s[82:83], s53 glc
s_sub_u32 s41, s41, 1
s_cmp_lg_u32 s41, 0
s_cbranch_scc1 Lpoll_92
s_waitcnt lgkmcnt(0)
Lg_94:
v_add_u32 v5, 0, v1
v_min_u32 v5, 143, v5
v_lshlrev_b32 v20, 3, v5
v_add_u32 v5, s50, v5
v_max_i32 v5, 0, v5
v_lshlrev_b32 v5, 3, v5
buffer_load_dwordx2 v[32:33], v5, s[20:23], 0 offen sc1
v_add_u32 v5, 64, v1
v_min_u32 v5, 143, v5
v_lshlrev_b32 v21, 3, v5
v_add_u32 v5, s50, v5
v_max_i32 v5, 0, v5
v_lshlrev_b32 v5, 3, v5
buffer_load_dwordx2 v[34:35], v5, s[20:23], 0 offen sc1
v_add_u32 v5, 128, v1
v_min_u32 v5, 143, v5
v_lshlrev_b32 v22, 3, v5
v_add_u32 v5, s50, v5
v_max_i32 v5, 0, v5
v_lshlrev_b32 v5, 3, v5
buffer_load_dwordx2 v[36:37], v5, s[20:23], 0 offen sc1
Lst2_88:
s_waitcnt vmcnt(0)
v_add_u32 v20, 147456, v20
ds_write_b64 v20, v[32:33]
v_add_u32 v21, 147456, v21
ds_write_b64 v21, v[34:35]
v_add_u32 v22, 147456, v22
ds_write_b64 v22, v[36:37]
s_waitcnt lgkmcnt(0)
Lste_89:
s_lshl_b32 s43, s35, 7
s_add_u32 s28, s68, s43
s_addc_u32 s29, s69, 0
s_mov_b32 s30, 2095232
s_mov_b32 s31, 0x20000
v_lshrrev_b32 v15, 3, v1
v_and_b32 v16, 6, v15
v_and_b32 v7, 7, v1
v_xor_b32 v7, v7, v16
v_lshlrev_b32 v7, 4, v7
v_mul_u32_u24 v15, 2048, v15
v_add_u32 v7, v7, v15
s_and_b32 s40, s36, 3
s_lshl_b32 s39, s40, 13
s_add_u32 s40, s40, s35
s_add_u32 s42, s40, 0
s_and_b32 s42, s42, 15
s_lshl_b32 s42, s42, 17
s_add_u32 m0, s39, 65536
s_add_u32 s43, s42, 0
buffer_load_dwordx4 v7, s[28:31], s43 offen lds
s_add_u32 m0, s39, 66560
s_add_u32 s43, s42, 16384
buffer_load_dwordx4 v7, s[28:31], s43 offen lds
s_add_u32 m0, s39, 67584
s_add_u32 s43, s42, 32768
buffer_load_dwordx4 v7, s[28:31], s43 offen lds
s_add_u32 m0, s39, 68608
s_add_u32 s43, s42, 49152
buffer_load_dwordx4 v7, s[28:31], s43 offen lds
s_add_u32 m0, s39, 69632
s_add_u32 s43, s42, 65536
buffer_load_dwordx4 v7, s[28:31], s43 offen lds
s_add_u32 m0, s39, 70656
s_add_u32 s43, s42, 81920
buffer_load_dwordx4 v7, s[28:31], s43 offen lds
s_add_u32 m0, s39, 71680
s_add_u32 s43, s42, 98304
buffer_load_dwordx4 v7, s[28:31], s43 offen lds
s_add_u32 m0, s39, 72704
s_add_u32 s43, s42, 114688
buffer_load_dwordx4 v7, s[28:31], s43 offen lds
s_bitcmp0_b32 s2, 0
s_cselect_b32 s88, s72, s74
s_cselect_b32 s89, s73, s75
s_cmp_lt_u32 s2, 192
s_cselect_b32 s90, 7340032, 0
s_mov_b32 s91, 0x20000
s_bfe_u32 s44, s2, 0x30001
s_lshl_b32 s44, s44, 2
s_and_b32 s43, s36, 3
s_add_u32 s44, s44, s43
s_lshl_b32 s44, s44, 5
v_lshrrev_b32 v18, 4, v1
v_add_u32 v18, s44, v18
v_mul_u32_u24 v18, 7168, v18
v_and_b32 v19, 15, v1
v_lshl_add_u32 v18, v19, 4, v18
s_lshr_b32 s43, s2, 4
s_lshl_b32 s43, s43, 8
s_add_u32 s43, s43, 4096
v_add_u32 v18, s43, v18
s_mov_b32 s43, 0
buffer_load_dwordx4 v[128:131], v18, s[88:91], s43 offen
s_mov_b32 s43, 28672
buffer_load_dwordx4 v[132:135], v18, s[88:91], s43 offen
s_mov_b32 s43, 57344
buffer_load_dwordx4 v[136:139], v18, s[88:91], s43 offen
s_mov_b32 s43, 86016
buffer_load_dwordx4 v[140:143], v18, s[88:91], s43 offen
s_mov_b32 s43, 114688
buffer_load_dwordx4 v[144:147], v18, s[88:91], s43 offen
s_mov_b32 s43, 143360
buffer_load_dwordx4 v[148:151], v18, s[88:91], s43 offen
s_mov_b32 s43, 172032
buffer_load_dwordx4 v[152:155], v18, s[88:91], s43 offen
s_mov_b32 s43, 200704
buffer_load_dwordx4 v[156:159], v18, s[88:91], s43 offen
s_barrier
Lats_6:
s_and_b32 s43, s36, 1
s_bfe_u32 s44, s36, 0x10001
s_lshr_b32 s45, s36, 2
v_lshlrev_b32 v14, 2, v13
v_sub_u32 v14, v12, v14
v_mov_b32 v16, 0xff800000
s_or_b32 s46, s34, s45
s_cmp_lg_u32 s46, 0
s_cselect_b32 s46, 0, 0xff800000
v_subrev_u32 v15, 0, v14
v_cmp_ge_u32 vcc, 7, v15
v_add_u32 v15, 16, v15
s_nop 0
v_cndmask_b32 v248, v16, 0, vcc
v_cmp_ge_u32 vcc, 7, v15
s_nop 1
v_cndmask_b32 v244, v16, 0, vcc
v_or_b32 v240, s46, v244
v_subrev_u32 v15, 1, v14
v_cmp_ge_u32 vcc, 7, v15
v_add_u32 v15, 16, v15
s_nop 0
v_cndmask_b32 v249, v16, 0, vcc
v_cmp_ge_u32 vcc, 7, v15
s_nop 1
v_cndmask_b32 v245, v16, 0, vcc
v_or_b32 v241, s46, v245
v_subrev_u32 v15, 2, v14
v_cmp_ge_u32 vcc, 7, v15
v_add_u32 v15, 16, v15
s_nop 0
v_cndmask_b32 v250, v16, 0, vcc
v_cmp_ge_u32 vcc, 7, v15
s_nop 1
v_cndmask_b32 v246, v16, 0, vcc
v_or_b32 v242, s46, v246
v_subrev_u32 v15, 3, v14
v_cmp_ge_u32 vcc, 7, v15
v_add_u32 v15, 16, v15
s_nop 0
v_cndmask_b32 v251, v16, 0, vcc
v_cmp_ge_u32 vcc, 7, v15
s_nop 1
v_cndmask_b32 v247, v16, 0, vcc
v_or_b32 v243, s46, v247
s_lshl_b32 s46, s45, 6
s_add_u32 s46, s46, s44
s_add_u32 s46, s46, 16
v_lshl_add_u32 v14, v12, 1, s46
s_lshl_b32 s47, s43, 6
v_lshl_add_u32 v15, v13, 4, s47
v_mul_u32_u24 v20, 400, v14
v_add_u32 v20, v20, v15
v_subrev_u32 v16, 32, v14
v_max_i32 v16, 0, v16
v_mul_u32_u24 v21, 400, v16
v_add_u32 v21, v21, v15
v_lshrrev_b32 v16, 2, v12
v_lshl_add_u32 v16, v13, 2, v16
v_lshl_add_u32 v16, v16, 1, s46
v_and_b32 v17, 3, v1
v_lshl_add_u32 v17, v17, 3, s47
v_mul_u32_u24 v22, 400, v16
v_add_u32 v22, v22, v17
v_subrev_u32 v16, 32, v16
v_max_i32 v16, 0, v16
v_mul_u32_u24 v23, 400, v16
v_add_u32 v23, v23, v17
s_mul_i32 s60, s34, 262144
s_add_u32 s16, s82, s60
s_addc_u32 s17, s83, 0
s_mov_b32 s18, 262144
s_mov_b32 s19, 0x20000
s_lshl_b32 s60, s35, 14
s_lshl_b32 s43, s43, 13
s_add_u32 s60, s60, s43
s_lshl_b32 s43, s45, 12
s_add_u32 s60, s60, s43
s_lshl_b32 s43, s44, 10
s_add_u32 s60, s60, s43
v_lshlrev_b32 v24, 4, v1
s_mov_b32 s61, 0x3e8293ee
s_lshl_b32 s38, s35, 7
Latt_5:
s_barrier
ds_read_b128 v[32:35], v20 offset:0
ds_read_b128 v[36:39], v20 offset:128
ds_read_b128 v[40:43], v21 offset:128
ds_read_b128 v[80:83], v20 offset:12800
ds_read_b128 v[84:87], v20 offset:12928
ds_read_b128 v[88:91], v20 offset:128
ds_read_b64_tr_b16 v[44:45], v23 offset:256
ds_read_b64_tr_b16 v[46:47], v22 offset:256
ds_read_b64_tr_b16 v[48:49], v23 offset:288
ds_read_b64_tr_b16 v[50:51], v22 offset:288
ds_read_b64_tr_b16 v[92:93], v22 offset:256
ds_read_b64_tr_b16 v[94:95], v22 offset:13056
ds_read_b64_tr_b16 v[96:97], v22 offset:288
ds_read_b64_tr_b16 v[98:99], v22 offset:13088
s_waitcnt lgkmcnt(11)
v_mfma_f32_16x16x32_bf16 v[52:55], v[40:43], v[32:35], v[240:243]
v_mfma_f32_16x16x32_bf16 v[56:59], v[36:39], v[32:35], v[248:251]
s_waitcnt lgkmcnt(8)
v_mfma_f32_16x16x32_bf16 v[100:103], v[88:91], v[80:83], v[244:247]
v_mfma_f32_16x16x32_bf16 v[104:107], v[84:87], v[80:83], v[248:251]
s_nop 5
v_max3_f32 v60, v52, v53, v54
v_max3_f32 v108, v100, v101, v102
v_max3_f32 v61, v55, v56, v57
v_max3_f32 v109, v103, v104, v105
v_max3_f32 v60, v60, v58, v59
v_max3_f32 v108, v108, v106, v107
v_max_f32 v60, v60, v61
v_max_f32 v108, v108, v109
s_nop 1
v_permlane32_swap_b32 v60, v108
v_max_f32 v60, v60, v108
v_mov_b32 v61, v60
s_nop 1
v_permlane16_swap_b32 v60, v61
v_max_f32 v60, v60, v61
v_mul_f32 v60, s61, v60
s_nop 0
v_mov_b32 v108, v60
s_nop 1
v_permlane32_swap_b32 v60, v108
v_fma_f32 v52, v52, s61, -v60
v_fma_f32 v100, v100, s61, -v108
v_fma_f32 v53, v53, s61, -v60
v_fma_f32 v101, v101, s61, -v108
v_fma_f32 v54, v54, s61, -v60
v_fma_f32 v102, v102, s61, -v108
v_fma_f32 v55, v55, s61, -v60
v_fma_f32 v103, v103, s61, -v108
v_fma_f32 v56, v56, s61, -v60
v_fma_f32 v104, v104, s61, -v108
v_fma_f32 v57, v57, s61, -v60
v_fma_f32 v105, v105, s61, -v108
v_fma_f32 v58, v58, s61, -v60
v_fma_f32 v106, v106, s61, -v108
v_fma_f32 v59, v59, s61, -v60
v_fma_f32 v107, v107, s61, -v108
v_exp_f32 v52, v52
v_exp_f32 v100, v100
v_exp_f32 v53, v53
v_exp_f32 v101, v101
v_exp_f32 v54, v54
v_exp_f32 v102, v102
v_exp_f32 v55, v55
v_exp_f32 v103, v103
v_exp_f32 v56, v56
v_exp_f32 v104, v104
v_exp_f32 v57, v57
v_exp_f32 v105, v105
v_exp_f32 v58, v58
v_exp_f32 v106, v106
v_exp_f32 v59, v59
v_exp_f32 v107, v107
v_cvt_pk_bf16_f32 v64, v52, v53
v_cvt_pk_bf16_f32 v112, v100, v101
v_cvt_pk_bf16_f32 v65, v54, v55
v_cvt_pk_bf16_f32 v113, v102, v103
v_cvt_pk_bf16_f32 v66, v56, v57
v_cvt_pk_bf16_f32 v114, v104, v105
v_cvt_pk_bf16_f32 v67, v58, v59
v_cvt_pk_bf16_f32 v115, v106, v107
v_pk_add_f32 v[52:53], v[52:53], v[54:55]
v_pk_add_f32 v[100:101], v[100:101], v[102:103]
v_pk_add_f32 v[56:57], v[56:57], v[58:59]
v_pk_add_f32 v[104:105], v[104:105], v[106:107]
s_waitcnt lgkmcnt(0)
s_waitcnt lgkmcnt(0)
v_mfma_f32_16x16x32_bf16 v[68:71], v[44:47], v[64:67], 0
v_mfma_f32_16x16x32_bf16 v[116:119], v[92:95], v[112:115], 0
v_mfma_f32_16x16x32_bf16 v[72:75], v[48:51], v[64:67], 0
v_mfma_f32_16x16x32_bf16 v[120:123], v[96:99], v[112:115], 0
v_pk_add_f32 v[52:53], v[52:53], v[56:57]
v_pk_add_f32 v[100:101], v[100:101], v[104:105]
v_add_f32 v60, v52, v53
v_add_f32 v108, v100, v101
s_nop 1
v_permlane32_swap_b32 v60, v108
v_add_f32 v60, v60, v108
v_mov_b32 v61, v60
s_nop 1
v_permlane16_swap_b32 v60, v61
v_add_f32 v60, v60, v61
v_rcp_f32 v60, v60
s_nop 0
v_mov_b32 v108, v60
s_nop 1
v_permlane32_swap_b32 v60, v108
v_pk_mul_f32 v[68:69], v[60:61], v[68:69] op_sel_hi:[0,1]
v_pk_mul_f32 v[116:117], v[108:109], v[116:117] op_sel_hi:[0,1]
v_pk_mul_f32 v[70:71], v[60:61], v[70:71] op_sel_hi:[0,1]
v_pk_mul_f32 v[118:119], v[108:109], v[118:119] op_sel_hi:[0,1]
v_pk_mul_f32 v[72:73], v[60:61], v[72:73] op_sel_hi:[0,1]
v_pk_mul_f32 v[120:121], v[108:109], v[120:121] op_sel_hi:[0,1]
v_pk_mul_f32 v[74:75], v[60:61], v[74:75] op_sel_hi:[0,1]
v_pk_mul_f32 v[122:123], v[108:109], v[122:123] op_sel_hi:[0,1]
v_cvt_pk_bf16_f32 v64, v68, v69
v_cvt_pk_bf16_f32 v112, v116, v117
v_cvt_pk_bf16_f32 v65, v70, v71
v_cvt_pk_bf16_f32 v113, v118, v119
v_cvt_pk_bf16_f32 v66, v72, v73
v_cvt_pk_bf16_f32 v114, v120, v121
v_cvt_pk_bf16_f32 v67, v74, v75
v_cvt_pk_bf16_f32 v115, v122, v123
buffer_store_dwordx4 v[64:67], v24, s[16:19], s60 offen offset:0 sc1
buffer_store_dwordx4 v[112:115], v24, s[16:19], s60 offen offset:2048 sc1
s_add_u32 s56, s82, 28311552
s_addc_u32 s57, s83, 0
s_mov_b32 s58, 114688
s_mov_b32 s59, 0x20000
s_lshl_b32 s7, s34, 12
s_add_u32 s7, s7, 49152
v_lshl_add_u32 v26, v1, 8, s7
v_mov_b32 v27, 1
s_cmp_ge_u32 s36, 4
s_cbranch_scc1 Lh_96
s_waitcnt vmcnt(0)
s_branch Lo_95
Lh_96:
s_add_u32 s28, s68, s38
s_addc_u32 s29, s69, 0
s_mov_b32 s30, 2095232
s_mov_b32 s31, 0x20000
s_add_u32 s42, s40, 4
s_and_b32 s42, s42, 15
s_lshl_b32 s42, s42, 17
s_add_u32 m0, s39, 114688
s_add_u32 s43, s42, 0
buffer_load_dwordx4 v7, s[28:31], s43 offen lds
s_add_u32 m0, s39, 115712
s_add_u32 s43, s42, 16384
buffer_load_dwordx4 v7, s[28:31], s43 offen lds
s_add_u32 m0, s39, 116736
s_add_u32 s43, s42, 32768
buffer_load_dwordx4 v7, s[28:31], s43 offen lds
s_add_u32 m0, s39, 117760
s_add_u32 s43, s42, 49152
buffer_load_dwordx4 v7, s[28:31], s43 offen lds
s_add_u32 m0, s39, 118784
s_add_u32 s43, s42, 65536
buffer_load_dwordx4 v7, s[28:31], s43 offen lds
s_add_u32 m0, s39, 119808
s_add_u32 s43, s42, 81920
buffer_load_dwordx4 v7, s[28:31], s43 offen lds
s_add_u32 m0, s39, 120832
s_add_u32 s43, s42, 98304
buffer_load_dwordx4 v7, s[28:31], s43 offen lds
s_add_u32 m0, s39, 121856
s_add_u32 s43, s42, 114688
buffer_load_dwordx4 v7, s[28:31], s43 offen lds
s_waitcnt vmcnt(8)
Lo_95:
s_cmp_lg_u32 s36, 0
s_barrier
s_cbranch_scc1 Lsig_97
s_mov_b64 exec, 0xffff
buffer_atomic_add v27, v26, s[56:59], 0 offen sc1
s_mov_b64 exec, -1
Lsig_97:
s_cmp_ge_u32 s36, 4
s_cbranch_scc1 Lprod_99
v_and_b32 v12, 15, v1
v_lshrrev_b32 v13, 4, v1
v_lshlrev_b32 v10, 12, v12
v_and_b32 v14, 1, v13
v_lshl_add_u32 v10, v14, 5, v10
v_lshrrev_b32 v14, 1, v13
v_lshl_add_u32 v10, v14, 4, v10
s_lshl_b32 s43, s34, 18
s_lshl_b32 s44, s36, 16
s_add_u32 s43, s43, s44
s_lshl_b32 s44, s35, 7
s_add_u32 s43, s43, s44
buffer_load_dwordx4 v[128:131], v10, s[8:11], s43 offen offset:0
buffer_load_dwordx4 v[132:135], v10, s[8:11], s43 offen offset:64
buffer_load_dwordx4 v[136:139], v10, s[8:11], s43 offen offset:2048
buffer_load_dwordx4 v[140:143], v10, s[8:11], s43 offen offset:2112
v_and_b32 v12, 15, v1
v_lshrrev_b32 v13, 4, v1
s_mul_i32 s43, s34, 262144
s_add_u32 s20, s82, s43
s_addc_u32 s21, s83, 0
s_add_u32 s20, s20, 4194304
s_addc_u32 s21, s21, 0
s_mov_b32 s22, 262144
s_mov_b32 s23, 0x20000
s_mul_i32 s43, s34, 16384
s_add_u32 s24, s82, s43
s_addc_u32 s25, s83, 0
s_add_u32 s24, s24, 25165824
s_addc_u32 s25, s25, 0
s_mov_b32 s26, 16384
s_mov_b32 s27, 0x20000
v_lshlrev_b32 v11, 4, v1
s_lshl_b32 s43, s36, 11
v_add_u32 v2, s43, v11
v_add_u32 v3, 98304, v2
v_lshrrev_b32 v14, 2, v1
v_bfe_u32 v15, v14, 1, 2
v_mul_u32_u24 v14, 128, v14
v_lshl_add_u32 v14, v15, 5, v14
v_and_b32 v15, 3, v1
v_lshl_add_u32 v4, v15, 3, v14
v_xor_b32 v5, 32, v4
v_xor_b32 v6, 64, v4
v_xor_b32 v7, 96, v4
v_add_u32 v16, 0x10000, v4
v_add_u32 v20, 0x20000, v4
v_add_u32 v17, 0x10000, v5
v_add_u32 v21, 0x20000, v5
v_add_u32 v18, 0x10000, v6
v_add_u32 v22, 0x20000, v6
v_add_u32 v19, 0x10000, v7
v_add_u32 v23, 0x20000, v7
s_lshl_b32 s44, s35, 14
s_add_u32 s60, s44, s43
v_lshrrev_b32 v14, 1, v13
v_lshlrev_b32 v14, 11, v14
v_lshl_add_u32 v14, v12, 3, v14
v_and_b32 v15, 1, v13
v_lshl_add_u32 v14, v15, 2, v14
s_lshl_b32 s43, s36, 12
s_lshl_b32 s44, s35, 7
s_add_u32 s43, s43, s44
v_add_u32 v9, s43, v14
s_mov_b32 s61, 0x3f803f80
s_waitcnt vmcnt(0)
v_permlane16_swap_b32 v128, v130
v_permlane16_swap_b32 v129, v131
v_permlane16_swap_b32 v132, v134
v_permlane16_swap_b32 v133, v135
v_permlane16_swap_b32 v136, v138
v_permlane16_swap_b32 v137, v139
v_permlane16_swap_b32 v140, v142
v_permlane16_swap_b32 v141, v143
v_lshlrev_b32 v96, 16, v128
v_and_b32 v97, 0xffff0000, v128
v_lshlrev_b32 v98, 16, v129
v_and_b32 v99, 0xffff0000, v129
v_lshlrev_b32 v100, 16, v130
v_and_b32 v101, 0xffff0000, v130
v_lshlrev_b32 v102, 16, v131
v_and_b32 v103, 0xffff0000, v131
v_lshlrev_b32 v104, 16, v132
v_and_b32 v105, 0xffff0000, v132
v_lshlrev_b32 v106, 16, v133
v_and_b32 v107, 0xffff0000, v133
v_lshlrev_b32 v108, 16, v134
v_and_b32 v109, 0xffff0000, v134
v_lshlrev_b32 v110, 16, v135
v_and_b32 v111, 0xffff0000, v135
v_lshlrev_b32 v112, 16, v136
v_and_b32 v113, 0xffff0000, v136
v_lshlrev_b32 v114, 16, v137
v_and_b32 v115, 0xffff0000, v137
v_lshlrev_b32 v116, 16, v138
v_and_b32 v117, 0xffff0000, v138
v_lshlrev_b32 v118, 16, v139
v_and_b32 v119, 0xffff0000, v139
v_lshlrev_b32 v120, 16, v140
v_and_b32 v121, 0xffff0000, v140
v_lshlrev_b32 v122, 16, v141
v_and_b32 v123, 0xffff0000, v141
v_lshlrev_b32 v124, 16, v142
v_and_b32 v125, 0xffff0000, v142
v_lshlrev_b32 v126, 16, v143
v_and_b32 v127, 0xffff0000, v143
s_barrier
ds_read_b128 v[32:35], v2 offset:0
ds_read_b64_tr_b16 v[40:41], v16 offset:0
ds_read_b64_tr_b16 v[42:43], v16 offset:2048
ds_read_b64_tr_b16 v[44:45], v17 offset:0
ds_read_b64_tr_b16 v[46:47], v17 offset:2048
ds_read_b64_tr_b16 v[48:49], v18 offset:0
ds_read_b64_tr_b16 v[50:51], v18 offset:2048
ds_read_b64_tr_b16 v[52:53], v19 offset:0
ds_read_b64_tr_b16 v[54:55], v19 offset:2048
ds_read_b128 v[36:39], v2 offset:1024
ds_read_b128 v[56:59], v2 offset:8192
ds_read_b64_tr_b16 v[64:65], v16 offset:4096
ds_read_b64_tr_b16 v[66:67], v16 offset:6144
ds_read_b64_tr_b16 v[68:69], v17 offset:4096
ds_read_b64_tr_b16 v[70:71], v17 offset:6144
ds_read_b64_tr_b16 v[72:73], v18 offset:4096
ds_read_b64_tr_b16 v[74:75], v18 offset:6144
ds_read_b64_tr_b16 v[76:77], v19 offset:4096
ds_read_b64_tr_b16 v[78:79], v19 offset:6144
ds_read_b128 v[60:63], v2 offset:9216
s_waitcnt lgkmcnt(0)
s_barrier
v_mfma_f32_16x16x32_bf16 v[96:99], v[40:43], v[32:35], v[96:99]
ds_read_b128 v[144:147], v2 offset:49152
ds_read_b64_tr_b16 v[152:153], v16 offset:8192
v_mfma_f32_16x16x32_bf16 v[100:103], v[44:47], v[32:35], v[100:103]
ds_read_b64_tr_b16 v[154:155], v16 offset:10240
ds_read_b64_tr_b16 v[156:157], v17 offset:8192
v_mfma_f32_16x16x32_bf16 v[104:107], v[48:51], v[32:35], v[104:107]
ds_read_b64_tr_b16 v[158:159], v17 offset:10240
ds_read_b64_tr_b16 v[160:161], v18 offset:8192
v_mfma_f32_16x16x32_bf16 v[108:111], v[52:55], v[32:35], v[108:111]
ds_read_b64_tr_b16 v[162:163], v18 offset:10240
ds_read_b64_tr_b16 v[164:165], v19 offset:8192
v_mfma_f32_16x16x32_bf16 v[124:127], v[52:55], v[36:39], v[124:127]
ds_read_b64_tr_b16 v[166:167], v19 offset:10240
ds_read_b128 v[148:151], v2 offset:50176
v_mfma_f32_16x16x32_bf16 v[120:123], v[48:51], v[36:39], v[120:123]
ds_read_b128 v[168:171], v2 offset:57344
ds_read_b64_tr_b16 v[176:177], v16 offset:12288
v_mfma_f32_16x16x32_bf16 v[116:119], v[44:47], v[36:39], v[116:119]
ds_read_b64_tr_b16 v[178:179], v16 offset:14336
ds_read_b64_tr_b16 v[180:181], v17 offset:12288
v_mfma_f32_16x16x32_bf16 v[112:115], v[40:43], v[36:39], v[112:115]
ds_read_b64_tr_b16 v[182:183], v17 offset:14336
ds_read_b64_tr_b16 v[184:185], v18 offset:12288
v_mfma_f32_16x16x32_bf16 v[96:99], v[64:67], v[56:59], v[96:99]
ds_read_b64_tr_b16 v[186:187], v18 offset:14336
ds_read_b64_tr_b16 v[188:189], v19 offset:12288
v_mfma_f32_16x16x32_bf16 v[100:103], v[68:71], v[56:59], v[100:103]
ds_read_b64_tr_b16 v[190:191], v19 offset:14336
ds_read_b128 v[172:175], v2 offset:58368
v_mfma_f32_16x16x32_bf16 v[104:107], v[72:75], v[56:59], v[104:107]
s_bitcmp0_b32 s36, 1
v_mfma_f32_16x16x32_bf16 v[108:111], v[76:79], v[56:59], v[108:111]
s_cselect_b32 s44, s72, s74
v_mfma_f32_16x16x32_bf16 v[124:127], v[76:79], v[60:63], v[124:127]
s_cselect_b32 s45, s73, s75
v_mfma_f32_16x16x32_bf16 v[120:123], v[72:75], v[60:63], v[120:123]
s_mul_i32 s43, s35, 192
v_mfma_f32_16x16x32_bf16 v[116:119], v[68:71], v[60:63], v[116:119]
s_add_u32 s16, s44, s43
v_mfma_f32_16x16x32_bf16 v[112:115], v[64:67], v[60:63], v[112:115]
s_addc_u32 s17, s45, 0
s_waitcnt lgkmcnt(0)
s_barrier
v_mfma_f32_16x16x32_bf16 v[96:99], v[152:155], v[144:147], v[96:99]
ds_read_b128 v[32:35], v3 offset:0
ds_read_b64_tr_b16 v[40:41], v16 offset:16384
v_mfma_f32_16x16x32_bf16 v[100:103], v[156:159], v[144:147], v[100:103]
s_branch Lov_5
.p2align 12
.fill 32, 4, 0xbf800000
Lst_5_0:
s_branch Lwr_160
s_nop 0
s_nop 0
Lov_5:
ds_read_b64_tr_b16 v[42:43], v16 offset:18432
ds_read_b64_tr_b16 v[44:45], v17 offset:16384
v_mfma_f32_16x16x32_bf16 v[104:107], v[160:163], v[144:147], v[104:107]
ds_read_b64_tr_b16 v[46:47], v17 offset:18432
ds_read_b64_tr_b16 v[48:49], v18 offset:16384
v_mfma_f32_16x16x32_bf16 v[108:111], v[164:167], v[144:147], v[108:111]
ds_read_b64_tr_b16 v[50:51], v18 offset:18432
ds_read_b64_tr_b16 v[52:53], v19 offset:16384
v_mfma_f32_16x16x32_bf16 v[124:127], v[164:167], v[148:151], v[124:127]
ds_read_b64_tr_b16 v[54:55], v19 offset:18432
ds_read_b128 v[36:39], v3 offset:1024
v_mfma_f32_16x16x32_bf16 v[120:123], v[160:163], v[148:151], v[120:123]
ds_read_b128 v[56:59], v3 offset:8192
ds_read_b64_tr_b16 v[64:65], v16 offset:20480
v_mfma_f32_16x16x32_bf16 v[116:119], v[156:159], v[148:151], v[116:119]
ds_read_b64_tr_b16 v[66:67], v16 offset:22528
ds_read_b64_tr_b16 v[68:69], v17 offset:20480
v_mfma_f32_16x16x32_bf16 v[112:115], v[152:155], v[148:151], v[112:115]
ds_read_b64_tr_b16 v[70:71], v17 offset:22528
ds_read_b64_tr_b16 v[72:73], v18 offset:20480
v_mfma_f32_16x16x32_bf16 v[96:99], v[176:179], v[168:171], v[96:99]
ds_read_b64_tr_b16 v[74:75], v18 offset:22528
ds_read_b64_tr_b16 v[76:77], v19 offset:20480
v_mfma_f32_16x16x32_bf16 v[100:103], v[180:183], v[168:171], v[100:103]
ds_read_b64_tr_b16 v[78:79], v19 offset:22528
ds_read_b128 v[60:63], v3 offset:9216
v_mfma_f32_16x16x32_bf16 v[104:107], v[184:187], v[168:171], v[104:107]
s_add_u32 s16, s16, 4096
v_mfma_f32_16x16x32_bf16 v[108:111], v[188:191], v[168:171], v[108:111]
s_addc_u32 s17, s17, 0
v_mfma_f32_16x16x32_bf16 v[124:127], v[188:191], v[172:175], v[124:127]
s_mov_b32 s18, 7333056
v_mfma_f32_16x16x32_bf16 v[120:123], v[184:187], v[172:175], v[120:123]
s_mov_b32 s19, 0x20000
v_mfma_f32_16x16x32_bf16 v[116:119], v[180:183], v[172:175], v[116:119]
s_and_b32 s43, s36, 1
v_mfma_f32_16x16x32_bf16 v[112:115], v[176:179], v[172:175], v[112:115]
s_mul_i32 s43, s43, 229376
s_waitcnt lgkmcnt(0)
s_barrier
v_mfma_f32_16x16x32_bf16 v[96:99], v[40:43], v[32:35], v[96:99]
ds_read_b128 v[144:147], v3 offset:49152
ds_read_b64_tr_b16 v[152:153], v16 offset:24576
v_mfma_f32_16x16x32_bf16 v[100:103], v[44:47], v[32:35], v[100:103]
ds_read_b64_tr_b16 v[154:155], v16 offset:26624
ds_read_b64_tr_b16 v[156:157], v17 offset:24576
v_mfma_f32_16x16x32_bf16 v[104:107], v[48:51], v[32:35], v[104:107]
ds_read_b64_tr_b16 v[158:159], v17 offset:26624
ds_read_b64_tr_b16 v[160:161], v18 offset:24576
v_mfma_f32_16x16x32_bf16 v[108:111], v[52:55], v[32:35], v[108:111]
ds_read_b64_tr_b16 v[162:163], v18 offset:26624
ds_read_b64_tr_b16 v[164:165], v19 offset:24576
v_mfma_f32_16x16x32_bf16 v[124:127], v[52:55], v[36:39], v[124:127]
ds_read_b64_tr_b16 v[166:167], v19 offset:26624
ds_read_b128 v[148:151], v3 offset:50176
v_mfma_f32_16x16x32_bf16 v[120:123], v[48:51], v[36:39], v[120:123]
ds_read_b128 v[168:171], v3 offset:57344
ds_read_b64_tr_b16 v[176:177], v16 offset:28672
v_mfma_f32_16x16x32_bf16 v[116:119], v[44:47], v[36:39], v[116:119]
ds_read_b64_tr_b16 v[178:179], v16 offset:30720
ds_read_b64_tr_b16 v[180:181], v17 offset:28672
v_mfma_f32_16x16x32_bf16 v[112:115], v[40:43], v[36:39], v[112:115]
ds_read_b64_tr_b16 v[182:183], v17 offset:30720
ds_read_b64_tr_b16 v[184:185], v18 offset:28672
v_mfma_f32_16x16x32_bf16 v[96:99], v[64:67], v[56:59], v[96:99]
ds_read_b64_tr_b16 v[186:187], v18 offset:30720
ds_read_b64_tr_b16 v[188:189], v19 offset:28672
v_mfma_f32_16x16x32_bf16 v[100:103], v[68:71], v[56:59], v[100:103]
ds_read_b64_tr_b16 v[190:191], v19 offset:30720
ds_read_b128 v[172:175], v3 offset:58368
v_mfma_f32_16x16x32_bf16 v[104:107], v[72:75], v[56:59], v[104:107]
v_add_u32 v196, 0, v1
v_mfma_f32_16x16x32_bf16 v[108:111], v[76:79], v[56:59], v[108:111]
v_mul_u32_u24 v197, 5462, v196
v_mfma_f32_16x16x32_bf16 v[124:127], v[76:79], v[60:63], v[124:127]
v_lshrrev_b32 v197, 16, v197
v_mfma_f32_16x16x32_bf16 v[120:123], v[72:75], v[60:63], v[120:123]
v_mul_u32_u24 v198, 12, v197
v_mfma_f32_16x16x32_bf16 v[116:119], v[68:71], v[60:63], v[116:119]
v_sub_u32 v198, v196, v198
v_mfma_f32_16x16x32_bf16 v[112:115], v[64:67], v[60:63], v[112:115]
v_bfe_u32 v199, v197, 2, 1
s_waitcnt lgkmcnt(0)
s_barrier
v_mfma_f32_16x16x32_bf16 v[96:99], v[152:155], v[144:147], v[96:99]
ds_read_b128 v[32:35], v2 offset:0
ds_read_b64_tr_b16 v[40:41], v16 offset:49152
v_mfma_f32_16x16x32_bf16 v[100:103], v[156:159], v[144:147], v[100:103]
ds_read_b64_tr_b16 v[42:43], v16 offset:51200
ds_read_b64_tr_b16 v[44:45], v17 offset:49152
v_mfma_f32_16x16x32_bf16 v[104:107], v[160:163], v[144:147], v[104:107]
ds_read_b64_tr_b16 v[46:47], v17 offset:51200
ds_read_b64_tr_b16 v[48:49], v18 offset:49152
v_mfma_f32_16x16x32_bf16 v[108:111], v[164:167], v[144:147], v[108:111]
ds_read_b64_tr_b16 v[50:51], v18 offset:51200
ds_read_b64_tr_b16 v[52:53], v19 offset:49152
v_mfma_f32_16x16x32_bf16 v[124:127], v[164:167], v[148:151], v[124:127]
ds_read_b64_tr_b16 v[54:55], v19 offset:51200
ds_read_b128 v[36:39], v2 offset:1024
v_mfma_f32_16x16x32_bf16 v[120:123], v[160:163], v[148:151], v[120:123]
ds_read_b128 v[56:59], v2 offset:8192
ds_read_b64_tr_b16 v[64:65], v16 offset:53248
v_mfma_f32_16x16x32_bf16 v[116:119], v[156:159], v[148:151], v[116:119]
ds_read_b64_tr_b16 v[66:67], v16 offset:55296
ds_read_b64_tr_b16 v[68:69], v17 offset:53248
v_mfma_f32_16x16x32_bf16 v[112:115], v[152:155], v[148:151], v[112:115]
ds_read_b64_tr_b16 v[70:71], v17 offset:55296
ds_read_b64_tr_b16 v[72:73], v18 offset:53248
v_mfma_f32_16x16x32_bf16 v[96:99], v[176:179], v[168:171], v[96:99]
ds_read_b64_tr_b16 v[74:75], v18 offset:55296
ds_read_b64_tr_b16 v[76:77], v19 offset:53248
v_mfma_f32_16x16x32_bf16 v[100:103], v[180:183], v[168:171], v[100:103]
ds_read_b64_tr_b16 v[78:79], v19 offset:55296
ds_read_b128 v[60:63], v2 offset:9216
v_mfma_f32_16x16x32_bf16 v[104:107], v[184:187], v[168:171], v[104:107]
v_cmp_gt_u32 vcc, 8, v198
v_mfma_f32_16x16x32_bf16 v[108:111], v[188:191], v[168:171], v[108:111]
v_lshlrev_b32 v200, 1, v199
v_mfma_f32_16x16x32_bf16 v[124:127], v[188:191], v[172:175], v[124:127]
v_mul_u32_u24 v197, 7168, v197
v_mfma_f32_16x16x32_bf16 v[120:123], v[184:187], v[172:175], v[120:123]
v_cndmask_b32 v199, v199, v200, vcc
v_mfma_f32_16x16x32_bf16 v[116:119], v[180:183], v[172:175], v[116:119]
v_xor_b32 v198, v198, v199
v_mfma_f32_16x16x32_bf16 v[112:115], v[176:179], v[172:175], v[112:115]
v_lshl_add_u32 v192, v198, 4, v197
s_waitcnt lgkmcnt(0)
s_barrier
v_mfma_f32_16x16x32_bf16 v[96:99], v[40:43], v[32:35], v[96:99]
ds_read_b128 v[144:147], v2 offset:49152
ds_read_b64_tr_b16 v[152:153], v16 offset:57344
v_mfma_f32_16x16x32_bf16 v[100:103], v[44:47], v[32:35], v[100:103]
ds_read_b64_tr_b16 v[154:155], v16 offset:59392
ds_read_b64_tr_b16 v[156:157], v17 offset:57344
v_mfma_f32_16x16x32_bf16 v[104:107], v[48:51], v[32:35], v[104:107]
ds_read_b64_tr_b16 v[158:159], v17 offset:59392
ds_read_b64_tr_b16 v[160:161], v18 offset:57344
v_mfma_f32_16x16x32_bf16 v[108:111], v[52:55], v[32:35], v[108:111]
ds_read_b64_tr_b16 v[162:163], v18 offset:59392
ds_read_b64_tr_b16 v[164:165], v19 offset:57344
v_mfma_f32_16x16x32_bf16 v[124:127], v[52:55], v[36:39], v[124:127]
ds_read_b64_tr_b16 v[166:167], v19 offset:59392
ds_read_b128 v[148:151], v2 offset:50176
v_mfma_f32_16x16x32_bf16 v[120:123], v[48:51], v[36:39], v[120:123]
ds_read_b128 v[168:171], v2 offset:57344
ds_read_b64_tr_b16 v[176:177], v16 offset:61440
v_mfma_f32_16x16x32_bf16 v[116:119], v[44:47], v[36:39], v[116:119]
ds_read_b64_tr_b16 v[178:179], v16 offset:63488
ds_read_b64_tr_b16 v[180:181], v17 offset:61440
v_mfma_f32_16x16x32_bf16 v[112:115], v[40:43], v[36:39], v[112:115]
ds_read_b64_tr_b16 v[182:183], v17 offset:63488
ds_read_b64_tr_b16 v[184:185], v18 offset:61440
v_mfma_f32_16x16x32_bf16 v[96:99], v[64:67], v[56:59], v[96:99]
ds_read_b64_tr_b16 v[186:187], v18 offset:63488
ds_read_b64_tr_b16 v[188:189], v19 offset:61440
v_mfma_f32_16x16x32_bf16 v[100:103], v[68:71], v[56:59], v[100:103]
ds_read_b64_tr_b16 v[190:191], v19 offset:63488
ds_read_b128 v[172:175], v2 offset:58368
v_mfma_f32_16x16x32_bf16 v[104:107], v[72:75], v[56:59], v[104:107]
v_add_u32 v196, 64, v1
v_mfma_f32_16x16x32_bf16 v[108:111], v[76:79], v[56:59], v[108:111]
v_mul_u32_u24 v197, 5462, v196
v_mfma_f32_16x16x32_bf16 v[124:127], v[76:79], v[60:63], v[124:127]
v_lshrrev_b32 v197, 16, v197
v_mfma_f32_16x16x32_bf16 v[120:123], v[72:75], v[60:63], v[120:123]
v_mul_u32_u24 v198, 12, v197
v_mfma_f32_16x16x32_bf16 v[116:119], v[68:71], v[60:63], v[116:119]
v_sub_u32 v198, v196, v198
v_mfma_f32_16x16x32_bf16 v[112:115], v[64:67], v[60:63], v[112:115]
v_bfe_u32 v199, v197, 2, 1
s_waitcnt lgkmcnt(0)
s_barrier
v_mfma_f32_16x16x32_bf16 v[96:99], v[152:155], v[144:147], v[96:99]
ds_read_b128 v[32:35], v3 offset:0
ds_read_b64_tr_b16 v[40:41], v20 offset:0
v_mfma_f32_16x16x32_bf16 v[100:103], v[156:159], v[144:147], v[100:103]
ds_read_b64_tr_b16 v[42:43], v20 offset:2048
ds_read_b64_tr_b16 v[44:45], v21 offset:0
v_mfma_f32_16x16x32_bf16 v[104:107], v[160:163], v[144:147], v[104:107]
ds_read_b64_tr_b16 v[46:47], v21 offset:2048
ds_read_b64_tr_b16 v[48:49], v22 offset:0
v_mfma_f32_16x16x32_bf16 v[108:111], v[164:167], v[144:147], v[108:111]
ds_read_b64_tr_b16 v[50:51], v22 offset:2048
ds_read_b64_tr_b16 v[52:53], v23 offset:0
v_mfma_f32_16x16x32_bf16 v[124:127], v[164:167], v[148:151], v[124:127]
ds_read_b64_tr_b16 v[54:55], v23 offset:2048
ds_read_b128 v[36:39], v3 offset:1024
v_mfma_f32_16x16x32_bf16 v[120:123], v[160:163], v[148:151], v[120:123]
ds_read_b128 v[56:59], v3 offset:8192
ds_read_b64_tr_b16 v[64:65], v20 offset:4096
v_mfma_f32_16x16x32_bf16 v[116:119], v[156:159], v[148:151], v[116:119]
ds_read_b64_tr_b16 v[66:67], v20 offset:6144
ds_read_b64_tr_b16 v[68:69], v21 offset:4096
v_mfma_f32_16x16x32_bf16 v[112:115], v[152:155], v[148:151], v[112:115]
ds_read_b64_tr_b16 v[70:71], v21 offset:6144
ds_read_b64_tr_b16 v[72:73], v22 offset:4096
v_mfma_f32_16x16x32_bf16 v[96:99], v[176:179], v[168:171], v[96:99]
ds_read_b64_tr_b16 v[74:75], v22 offset:6144
ds_read_b64_tr_b16 v[76:77], v23 offset:4096
v_mfma_f32_16x16x32_bf16 v[100:103], v[180:183], v[168:171], v[100:103]
ds_read_b64_tr_b16 v[78:79], v23 offset:6144
ds_read_b128 v[60:63], v3 offset:9216
v_mfma_f32_16x16x32_bf16 v[104:107], v[184:187], v[168:171], v[104:107]
v_cmp_gt_u32 vcc, 8, v198
v_mfma_f32_16x16x32_bf16 v[108:111], v[188:191], v[168:171], v[108:111]
v_lshlrev_b32 v200, 1, v199
v_mfma_f32_16x16x32_bf16 v[124:127], v[188:191], v[172:175], v[124:127]
v_mul_u32_u24 v197, 7168, v197
v_mfma_f32_16x16x32_bf16 v[120:123], v[184:187], v[172:175], v[120:123]
v_cndmask_b32 v199, v199, v200, vcc
v_mfma_f32_16x16x32_bf16 v[116:119], v[180:183], v[172:175], v[116:119]
v_xor_b32 v198, v198, v199
v_mfma_f32_16x16x32_bf16 v[112:115], v[176:179], v[172:175], v[112:115]
v_lshl_add_u32 v193, v198, 4, v197
s_waitcnt lgkmcnt(0)
s_barrier
v_mfma_f32_16x16x32_bf16 v[96:99], v[40:43], v[32:35], v[96:99]
ds_read_b128 v[144:147], v3 offset:49152
ds_read_b64_tr_b16 v[152:153], v20 offset:8192
v_mfma_f32_16x16x32_bf16 v[100:103], v[44:47], v[32:35], v[100:103]
ds_read_b64_tr_b16 v[154:155], v20 offset:10240
ds_read_b64_tr_b16 v[156:157], v21 offset:8192
v_mfma_f32_16x16x32_bf16 v[104:107], v[48:51], v[32:35], v[104:107]
ds_read_b64_tr_b16 v[158:159], v21 offset:10240
ds_read_b64_tr_b16 v[160:161], v22 offset:8192
v_mfma_f32_16x16x32_bf16 v[108:111], v[52:55], v[32:35], v[108:111]
ds_read_b64_tr_b16 v[162:163], v22 offset:10240
ds_read_b64_tr_b16 v[164:165], v23 offset:8192
v_mfma_f32_16x16x32_bf16 v[124:127], v[52:55], v[36:39], v[124:127]
ds_read_b64_tr_b16 v[166:167], v23 offset:10240
ds_read_b128 v[148:151], v3 offset:50176
v_mfma_f32_16x16x32_bf16 v[120:123], v[48:51], v[36:39], v[120:123]
ds_read_b128 v[168:171], v3 offset:57344
ds_read_b64_tr_b16 v[176:177], v20 offset:12288
v_mfma_f32_16x16x32_bf16 v[116:119], v[44:47], v[36:39], v[116:119]
ds_read_b64_tr_b16 v[178:179], v20 offset:14336
ds_read_b64_tr_b16 v[180:181], v21 offset:12288
v_mfma_f32_16x16x32_bf16 v[112:115], v[40:43], v[36:39], v[112:115]
ds_read_b64_tr_b16 v[182:183], v21 offset:14336
ds_read_b64_tr_b16 v[184:185], v22 offset:12288
v_mfma_f32_16x16x32_bf16 v[96:99], v[64:67], v[56:59], v[96:99]
ds_read_b64_tr_b16 v[186:187], v22 offset:14336
ds_read_b64_tr_b16 v[188:189], v23 offset:12288
v_mfma_f32_16x16x32_bf16 v[100:103], v[68:71], v[56:59], v[100:103]
ds_read_b64_tr_b16 v[190:191], v23 offset:14336
ds_read_b128 v[172:175], v3 offset:58368
v_mfma_f32_16x16x32_bf16 v[104:107], v[72:75], v[56:59], v[104:107]
v_add_u32 v196, 128, v1
v_mfma_f32_16x16x32_bf16 v[108:111], v[76:79], v[56:59], v[108:111]
v_mul_u32_u24 v197, 5462, v196
v_mfma_f32_16x16x32_bf16 v[124:127], v[76:79], v[60:63], v[124:127]
v_lshrrev_b32 v197, 16, v197
v_mfma_f32_16x16x32_bf16 v[120:123], v[72:75], v[60:63], v[120:123]
v_mul_u32_u24 v198, 12, v197
v_mfma_f32_16x16x32_bf16 v[116:119], v[68:71], v[60:63], v[116:119]
v_sub_u32 v198, v196, v198
v_mfma_f32_16x16x32_bf16 v[112:115], v[64:67], v[60:63], v[112:115]
v_bfe_u32 v199, v197, 2, 1
s_waitcnt lgkmcnt(0)
s_barrier
v_mfma_f32_16x16x32_bf16 v[96:99], v[152:155], v[144:147], v[96:99]
ds_read_b128 v[32:35], v2 offset:0
ds_read_b64_tr_b16 v[40:41], v4 offset:16384
v_mfma_f32_16x16x32_bf16 v[100:103], v[156:159], v[144:147], v[100:103]
ds_read_b64_tr_b16 v[42:43], v4 offset:18432
ds_read_b64_tr_b16 v[44:45], v5 offset:16384
v_mfma_f32_16x16x32_bf16 v[104:107], v[160:163], v[144:147], v[104:107]
ds_read_b64_tr_b16 v[46:47], v5 offset:18432
ds_read_b64_tr_b16 v[48:49], v6 offset:16384
v_mfma_f32_16x16x32_bf16 v[108:111], v[164:167], v[144:147], v[108:111]
ds_read_b64_tr_b16 v[50:51], v6 offset:18432
ds_read_b64_tr_b16 v[52:53], v7 offset:16384
v_mfma_f32_16x16x32_bf16 v[124:127], v[164:167], v[148:151], v[124:127]
ds_read_b64_tr_b16 v[54:55], v7 offset:18432
ds_read_b128 v[36:39], v2 offset:1024
v_mfma_f32_16x16x32_bf16 v[120:123], v[160:163], v[148:151], v[120:123]
ds_read_b128 v[56:59], v2 offset:8192
ds_read_b64_tr_b16 v[64:65], v4 offset:20480
v_mfma_f32_16x16x32_bf16 v[116:119], v[156:159], v[148:151], v[116:119]
ds_read_b64_tr_b16 v[66:67], v4 offset:22528
ds_read_b64_tr_b16 v[68:69], v5 offset:20480
v_mfma_f32_16x16x32_bf16 v[112:115], v[152:155], v[148:151], v[112:115]
ds_read_b64_tr_b16 v[70:71], v5 offset:22528
ds_read_b64_tr_b16 v[72:73], v6 offset:20480
v_mfma_f32_16x16x32_bf16 v[96:99], v[176:179], v[168:171], v[96:99]
ds_read_b64_tr_b16 v[74:75], v6 offset:22528
ds_read_b64_tr_b16 v[76:77], v7 offset:20480
v_mfma_f32_16x16x32_bf16 v[100:103], v[180:183], v[168:171], v[100:103]
ds_read_b64_tr_b16 v[78:79], v7 offset:22528
ds_read_b128 v[60:63], v2 offset:9216
v_mfma_f32_16x16x32_bf16 v[104:107], v[184:187], v[168:171], v[104:107]
v_cmp_gt_u32 vcc, 8, v198
v_mfma_f32_16x16x32_bf16 v[108:111], v[188:191], v[168:171], v[108:111]
v_lshlrev_b32 v200, 1, v199
v_mfma_f32_16x16x32_bf16 v[124:127], v[188:191], v[172:175], v[124:127]
v_mul_u32_u24 v197, 7168, v197
v_mfma_f32_16x16x32_bf16 v[120:123], v[184:187], v[172:175], v[120:123]
v_cndmask_b32 v199, v199, v200, vcc
v_mfma_f32_16x16x32_bf16 v[116:119], v[180:183], v[172:175], v[116:119]
v_xor_b32 v198, v198, v199
v_mfma_f32_16x16x32_bf16 v[112:115], v[176:179], v[172:175], v[112:115]
v_lshl_add_u32 v194, v198, 4, v197
s_waitcnt lgkmcnt(0)
s_barrier
v_mfma_f32_16x16x32_bf16 v[96:99], v[40:43], v[32:35], v[96:99]
ds_read_b128 v[144:147], v2 offset:49152
ds_read_b64_tr_b16 v[152:153], v4 offset:24576
v_mfma_f32_16x16x32_bf16 v[100:103], v[44:47], v[32:35], v[100:103]
ds_read_b64_tr_b16 v[154:155], v4 offset:26624
ds_read_b64_tr_b16 v[156:157], v5 offset:24576
v_mfma_f32_16x16x32_bf16 v[104:107], v[48:51], v[32:35], v[104:107]
ds_read_b64_tr_b16 v[158:159], v5 offset:26624
ds_read_b64_tr_b16 v[160:161], v6 offset:24576
v_mfma_f32_16x16x32_bf16 v[108:111], v[52:55], v[32:35], v[108:111]
ds_read_b64_tr_b16 v[162:163], v6 offset:26624
ds_read_b64_tr_b16 v[164:165], v7 offset:24576
v_mfma_f32_16x16x32_bf16 v[124:127], v[52:55], v[36:39], v[124:127]
ds_read_b64_tr_b16 v[166:167], v7 offset:26624
ds_read_b128 v[148:151], v2 offset:50176
v_mfma_f32_16x16x32_bf16 v[120:123], v[48:51], v[36:39], v[120:123]
ds_read_b128 v[168:171], v2 offset:57344
ds_read_b64_tr_b16 v[176:177], v4 offset:28672
v_mfma_f32_16x16x32_bf16 v[116:119], v[44:47], v[36:39], v[116:119]
ds_read_b64_tr_b16 v[178:179], v4 offset:30720
ds_read_b64_tr_b16 v[180:181], v5 offset:28672
v_mfma_f32_16x16x32_bf16 v[112:115], v[40:43], v[36:39], v[112:115]
ds_read_b64_tr_b16 v[182:183], v5 offset:30720
ds_read_b64_tr_b16 v[184:185], v6 offset:28672
v_mfma_f32_16x16x32_bf16 v[96:99], v[64:67], v[56:59], v[96:99]
ds_read_b64_tr_b16 v[186:187], v6 offset:30720
ds_read_b64_tr_b16 v[188:189], v7 offset:28672
v_mfma_f32_16x16x32_bf16 v[100:103], v[68:71], v[56:59], v[100:103]
ds_read_b64_tr_b16 v[190:191], v7 offset:30720
ds_read_b128 v[172:175], v2 offset:58368
v_mfma_f32_16x16x32_bf16 v[104:107], v[72:75], v[56:59], v[104:107]
v_add_u32 v192, s43, v192
v_mfma_f32_16x16x32_bf16 v[108:111], v[76:79], v[56:59], v[108:111]
v_add_u32 v193, s43, v193
v_mfma_f32_16x16x32_bf16 v[124:127], v[76:79], v[60:63], v[124:127]
v_add_u32 v194, s43, v194
v_mfma_f32_16x16x32_bf16 v[120:123], v[72:75], v[60:63], v[120:123]
s_and_b32 s43, s36, 3
v_mfma_f32_16x16x32_bf16 v[116:119], v[68:71], v[60:63], v[116:119]
s_mul_i32 s50, s43, 6144
v_mfma_f32_16x16x32_bf16 v[112:115], v[64:67], v[60:63], v[112:115]
s_add_u32 s50, s50, 16384
s_waitcnt lgkmcnt(0)
s_barrier
v_mfma_f32_16x16x32_bf16 v[96:99], v[152:155], v[144:147], v[96:99]
ds_read_b128 v[32:35], v3 offset:0
ds_read_b64_tr_b16 v[40:41], v4 offset:32768
v_mfma_f32_16x16x32_bf16 v[100:103], v[156:159], v[144:147], v[100:103]
ds_read_b64_tr_b16 v[42:43], v4 offset:34816
ds_read_b64_tr_b16 v[44:45], v5 offset:32768
v_mfma_f32_16x16x32_bf16 v[104:107], v[160:163], v[144:147], v[104:107]
ds_read_b64_tr_b16 v[46:47], v5 offset:34816
ds_read_b64_tr_b16 v[48:49], v6 offset:32768
v_mfma_f32_16x16x32_bf16 v[108:111], v[164:167], v[144:147], v[108:111]
ds_read_b64_tr_b16 v[50:51], v6 offset:34816
ds_read_b64_tr_b16 v[52:53], v7 offset:32768
v_mfma_f32_16x16x32_bf16 v[124:127], v[164:167], v[148:151], v[124:127]
ds_read_b64_tr_b16 v[54:55], v7 offset:34816
ds_read_b128 v[36:39], v3 offset:1024
v_mfma_f32_16x16x32_bf16 v[120:123], v[160:163], v[148:151], v[120:123]
ds_read_b128 v[56:59], v3 offset:8192
ds_read_b64_tr_b16 v[64:65], v4 offset:36864
v_mfma_f32_16x16x32_bf16 v[116:119], v[156:159], v[148:151], v[116:119]
ds_read_b64_tr_b16 v[66:67], v4 offset:38912
ds_read_b64_tr_b16 v[68:69], v5 offset:36864
v_mfma_f32_16x16x32_bf16 v[112:115], v[152:155], v[148:151], v[112:115]
ds_read_b64_tr_b16 v[70:71], v5 offset:38912
ds_read_b64_tr_b16 v[72:73], v6 offset:36864
v_mfma_f32_16x16x32_bf16 v[96:99], v[176:179], v[168:171], v[96:99]
ds_read_b64_tr_b16 v[74:75], v6 offset:38912
ds_read_b64_tr_b16 v[76:77], v7 offset:36864
v_mfma_f32_16x16x32_bf16 v[100:103], v[180:183], v[168:171], v[100:103]
ds_read_b64_tr_b16 v[78:79], v7 offset:38912
ds_read_b128 v[60:63], v3 offset:9216
v_mfma_f32_16x16x32_bf16 v[104:107], v[184:187], v[168:171], v[104:107]
s_bitcmp0_b32 s2, 0
v_mfma_f32_16x16x32_bf16 v[108:111], v[188:191], v[168:171], v[108:111]
s_cselect_b32 s88, s72, s74
v_mfma_f32_16x16x32_bf16 v[124:127], v[188:191], v[172:175], v[124:127]
s_cselect_b32 s89, s73, s75
v_mfma_f32_16x16x32_bf16 v[120:123], v[184:187], v[172:175], v[120:123]
s_mov_b32 s90, 7340032
v_mfma_f32_16x16x32_bf16 v[116:119], v[180:183], v[172:175], v[116:119]
s_mov_b32 s91, 0x20000
v_mfma_f32_16x16x32_bf16 v[112:115], v[176:179], v[172:175], v[112:115]
s_bfe_u32 s44, s2, 0x30001
s_waitcnt lgkmcnt(0)
s_barrier
v_mfma_f32_16x16x32_bf16 v[96:99], v[40:43], v[32:35], v[96:99]
ds_read_b128 v[144:147], v3 offset:49152
ds_read_b64_tr_b16 v[152:153], v4 offset:40960
v_mfma_f32_16x16x32_bf16 v[100:103], v[44:47], v[32:35], v[100:103]
ds_read_b64_tr_b16 v[154:155], v4 offset:43008
ds_read_b64_tr_b16 v[156:157], v5 offset:40960
v_mfma_f32_16x16x32_bf16 v[104:107], v[48:51], v[32:35], v[104:107]
ds_read_b64_tr_b16 v[158:159], v5 offset:43008
ds_read_b64_tr_b16 v[160:161], v6 offset:40960
v_mfma_f32_16x16x32_bf16 v[108:111], v[52:55], v[32:35], v[108:111]
ds_read_b64_tr_b16 v[162:163], v6 offset:43008
ds_read_b64_tr_b16 v[164:165], v7 offset:40960
v_mfma_f32_16x16x32_bf16 v[124:127], v[52:55], v[36:39], v[124:127]
ds_read_b64_tr_b16 v[166:167], v7 offset:43008
ds_read_b128 v[148:151], v3 offset:50176
v_mfma_f32_16x16x32_bf16 v[120:123], v[48:51], v[36:39], v[120:123]
ds_read_b128 v[168:171], v3 offset:57344
ds_read_b64_tr_b16 v[176:177], v4 offset:45056
v_mfma_f32_16x16x32_bf16 v[116:119], v[44:47], v[36:39], v[116:119]
ds_read_b64_tr_b16 v[178:179], v4 offset:47104
ds_read_b64_tr_b16 v[180:181], v5 offset:45056
v_mfma_f32_16x16x32_bf16 v[112:115], v[40:43], v[36:39], v[112:115]
ds_read_b64_tr_b16 v[182:183], v5 offset:47104
ds_read_b64_tr_b16 v[184:185], v6 offset:45056
v_mfma_f32_16x16x32_bf16 v[96:99], v[64:67], v[56:59], v[96:99]
ds_read_b64_tr_b16 v[186:187], v6 offset:47104
ds_read_b64_tr_b16 v[188:189], v7 offset:45056
v_mfma_f32_16x16x32_bf16 v[100:103], v[68:71], v[56:59], v[100:103]
ds_read_b64_tr_b16 v[190:191], v7 offset:47104
ds_read_b128 v[172:175], v3 offset:58368
v_mfma_f32_16x16x32_bf16 v[104:107], v[72:75], v[56:59], v[104:107]
s_lshl_b32 s44, s44, 2
v_mfma_f32_16x16x32_bf16 v[108:111], v[76:79], v[56:59], v[108:111]
s_and_b32 s43, s36, 3
v_mfma_f32_16x16x32_bf16 v[124:127], v[76:79], v[60:63], v[124:127]
s_add_u32 s44, s44, s43
v_mfma_f32_16x16x32_bf16 v[120:123], v[72:75], v[60:63], v[120:123]
s_lshl_b32 s44, s44, 5
v_mfma_f32_16x16x32_bf16 v[116:119], v[68:71], v[60:63], v[116:119]
v_lshrrev_b32 v195, 4, v1
v_mfma_f32_16x16x32_bf16 v[112:115], v[64:67], v[60:63], v[112:115]
v_add_u32 v195, s44, v195
s_waitcnt lgkmcnt(0)
s_barrier
v_mfma_f32_16x16x32_bf16 v[96:99], v[152:155], v[144:147], v[96:99]
ds_read_b128 v[32:35], v2 offset:0
ds_read_b64_tr_b16 v[40:41], v16 offset:49152
v_mfma_f32_16x16x32_bf16 v[100:103], v[156:159], v[144:147], v[100:103]
ds_read_b64_tr_b16 v[42:43], v16 offset:51200
ds_read_b64_tr_b16 v[44:45], v17 offset:49152
v_mfma_f32_16x16x32_bf16 v[104:107], v[160:163], v[144:147], v[104:107]
ds_read_b64_tr_b16 v[46:47], v17 offset:51200
ds_read_b64_tr_b16 v[48:49], v18 offset:49152
v_mfma_f32_16x16x32_bf16 v[108:111], v[164:167], v[144:147], v[108:111]
ds_read_b64_tr_b16 v[50:51], v18 offset:51200
ds_read_b64_tr_b16 v[52:53], v19 offset:49152
v_mfma_f32_16x16x32_bf16 v[124:127], v[164:167], v[148:151], v[124:127]
ds_read_b64_tr_b16 v[54:55], v19 offset:51200
ds_read_b128 v[36:39], v2 offset:1024
v_mfma_f32_16x16x32_bf16 v[120:123], v[160:163], v[148:151], v[120:123]
ds_read_b128 v[56:59], v2 offset:8192
ds_read_b64_tr_b16 v[64:65], v16 offset:53248
v_mfma_f32_16x16x32_bf16 v[116:119], v[156:159], v[148:151], v[116:119]
ds_read_b64_tr_b16 v[66:67], v16 offset:55296
ds_read_b64_tr_b16 v[68:69], v17 offset:53248
v_mfma_f32_16x16x32_bf16 v[112:115], v[152:155], v[148:151], v[112:115]
ds_read_b64_tr_b16 v[70:71], v17 offset:55296
ds_read_b64_tr_b16 v[72:73], v18 offset:53248
v_mfma_f32_16x16x32_bf16 v[96:99], v[176:179], v[168:171], v[96:99]
ds_read_b64_tr_b16 v[74:75], v18 offset:55296
ds_read_b64_tr_b16 v[76:77], v19 offset:53248
v_mfma_f32_16x16x32_bf16 v[100:103], v[180:183], v[168:171], v[100:103]
ds_read_b64_tr_b16 v[78:79], v19 offset:55296
ds_read_b128 v[60:63], v2 offset:9216
v_mfma_f32_16x16x32_bf16 v[104:107], v[184:187], v[168:171], v[104:107]
v_mul_u32_u24 v195, 7168, v195
v_mfma_f32_16x16x32_bf16 v[108:111], v[188:191], v[168:171], v[108:111]
v_and_b32 v196, 15, v1
v_mfma_f32_16x16x32_bf16 v[124:127], v[188:191], v[172:175], v[124:127]
v_lshl_add_u32 v195, v196, 4, v195
v_mfma_f32_16x16x32_bf16 v[120:123], v[184:187], v[172:175], v[120:123]
s_lshr_b32 s43, s2, 4
v_mfma_f32_16x16x32_bf16 v[116:119], v[180:183], v[172:175], v[116:119]
s_lshl_b32 s43, s43, 8
v_mfma_f32_16x16x32_bf16 v[112:115], v[176:179], v[172:175], v[112:115]
v_add_u32 v195, s43, v195
s_waitcnt lgkmcnt(0)
s_barrier
v_mfma_f32_16x16x32_bf16 v[96:99], v[40:43], v[32:35], v[96:99]
ds_read_b128 v[144:147], v2 offset:49152
ds_read_b64_tr_b16 v[152:153], v16 offset:57344
v_mfma_f32_16x16x32_bf16 v[100:103], v[44:47], v[32:35], v[100:103]
ds_read_b64_tr_b16 v[154:155], v16 offset:59392
ds_read_b64_tr_b16 v[156:157], v17 offset:57344
v_mfma_f32_16x16x32_bf16 v[104:107], v[48:51], v[32:35], v[104:107]
ds_read_b64_tr_b16 v[158:159], v17 offset:59392
ds_read_b64_tr_b16 v[160:161], v18 offset:57344
v_mfma_f32_16x16x32_bf16 v[108:111], v[52:55], v[32:35], v[108:111]
ds_read_b64_tr_b16 v[162:163], v18 offset:59392
ds_read_b64_tr_b16 v[164:165], v19 offset:57344
v_mfma_f32_16x16x32_bf16 v[124:127], v[52:55], v[36:39], v[124:127]
ds_read_b64_tr_b16 v[166:167], v19 offset:59392
ds_read_b128 v[148:151], v2 offset:50176
v_mfma_f32_16x16x32_bf16 v[120:123], v[48:51], v[36:39], v[120:123]
ds_read_b128 v[168:171], v2 offset:57344
ds_read_b64_tr_b16 v[176:177], v16 offset:61440
v_mfma_f32_16x16x32_bf16 v[116:119], v[44:47], v[36:39], v[116:119]
ds_read_b64_tr_b16 v[178:179], v16 offset:63488
ds_read_b64_tr_b16 v[180:181], v17 offset:61440
v_mfma_f32_16x16x32_bf16 v[112:115], v[40:43], v[36:39], v[112:115]
ds_read_b64_tr_b16 v[182:183], v17 offset:63488
ds_read_b64_tr_b16 v[184:185], v18 offset:61440
v_mfma_f32_16x16x32_bf16 v[96:99], v[64:67], v[56:59], v[96:99]
ds_read_b64_tr_b16 v[186:187], v18 offset:63488
ds_read_b64_tr_b16 v[188:189], v19 offset:61440
v_mfma_f32_16x16x32_bf16 v[100:103], v[68:71], v[56:59], v[100:103]
ds_read_b64_tr_b16 v[190:191], v19 offset:63488
ds_read_b128 v[172:175], v2 offset:58368
v_mfma_f32_16x16x32_bf16 v[104:107], v[72:75], v[56:59], v[104:107]
v_mfma_f32_16x16x32_bf16 v[108:111], v[76:79], v[56:59], v[108:111]
v_mfma_f32_16x16x32_bf16 v[124:127], v[76:79], v[60:63], v[124:127]
v_mfma_f32_16x16x32_bf16 v[120:123], v[72:75], v[60:63], v[120:123]
v_mfma_f32_16x16x32_bf16 v[116:119], v[68:71], v[60:63], v[116:119]
v_mfma_f32_16x16x32_bf16 v[112:115], v[64:67], v[60:63], v[112:115]
s_waitcnt lgkmcnt(0)
s_barrier
v_mfma_f32_16x16x32_bf16 v[96:99], v[152:155], v[144:147], v[96:99]
ds_read_b128 v[32:35], v3 offset:0
ds_read_b64_tr_b16 v[40:41], v20 offset:0
v_mfma_f32_16x16x32_bf16 v[100:103], v[156:159], v[144:147], v[100:103]
ds_read_b64_tr_b16 v[42:43], v20 offset:2048
ds_read_b64_tr_b16 v[44:45], v21 offset:0
v_mfma_f32_16x16x32_bf16 v[104:107], v[160:163], v[144:147], v[104:107]
ds_read_b64_tr_b16 v[46:47], v21 offset:2048
ds_read_b64_tr_b16 v[48:49], v22 offset:0
s_branch Lov_6
.p2align 12
.fill 48, 4, 0xbf800000
Lst_6_0:
s_branch Lwr_161
s_nop 0
s_nop 0
Lov_6:
v_mfma_f32_16x16x32_bf16 v[108:111], v[164:167], v[144:147], v[108:111]
ds_read_b64_tr_b16 v[50:51], v22 offset:2048
ds_read_b64_tr_b16 v[52:53], v23 offset:0
v_mfma_f32_16x16x32_bf16 v[124:127], v[164:167], v[148:151], v[124:127]
ds_read_b64_tr_b16 v[54:55], v23 offset:2048
ds_read_b128 v[36:39], v3 offset:1024
v_mfma_f32_16x16x32_bf16 v[120:123], v[160:163], v[148:151], v[120:123]
ds_read_b128 v[56:59], v3 offset:8192
ds_read_b64_tr_b16 v[64:65], v20 offset:4096
v_mfma_f32_16x16x32_bf16 v[116:119], v[156:159], v[148:151], v[116:119]
ds_read_b64_tr_b16 v[66:67], v20 offset:6144
ds_read_b64_tr_b16 v[68:69], v21 offset:4096
v_mfma_f32_16x16x32_bf16 v[112:115], v[152:155], v[148:151], v[112:115]
ds_read_b64_tr_b16 v[70:71], v21 offset:6144
ds_read_b64_tr_b16 v[72:73], v22 offset:4096
v_mfma_f32_16x16x32_bf16 v[96:99], v[176:179], v[168:171], v[96:99]
ds_read_b64_tr_b16 v[74:75], v22 offset:6144
ds_read_b64_tr_b16 v[76:77], v23 offset:4096
v_mfma_f32_16x16x32_bf16 v[100:103], v[180:183], v[168:171], v[100:103]
ds_read_b64_tr_b16 v[78:79], v23 offset:6144
ds_read_b128 v[60:63], v3 offset:9216
v_mfma_f32_16x16x32_bf16 v[104:107], v[184:187], v[168:171], v[104:107]
v_mfma_f32_16x16x32_bf16 v[108:111], v[188:191], v[168:171], v[108:111]
v_mfma_f32_16x16x32_bf16 v[124:127], v[188:191], v[172:175], v[124:127]
v_mfma_f32_16x16x32_bf16 v[120:123], v[184:187], v[172:175], v[120:123]
v_mfma_f32_16x16x32_bf16 v[116:119], v[180:183], v[172:175], v[116:119]
v_mfma_f32_16x16x32_bf16 v[112:115], v[176:179], v[172:175], v[112:115]
s_waitcnt lgkmcnt(0)
v_mfma_f32_16x16x32_bf16 v[96:99], v[40:43], v[32:35], v[96:99]
ds_read_b128 v[144:147], v3 offset:49152
ds_read_b64_tr_b16 v[152:153], v20 offset:8192
v_mfma_f32_16x16x32_bf16 v[100:103], v[44:47], v[32:35], v[100:103]
ds_read_b64_tr_b16 v[154:155], v20 offset:10240
ds_read_b64_tr_b16 v[156:157], v21 offset:8192
v_mfma_f32_16x16x32_bf16 v[104:107], v[48:51], v[32:35], v[104:107]
ds_read_b64_tr_b16 v[158:159], v21 offset:10240
ds_read_b64_tr_b16 v[160:161], v22 offset:8192
v_mfma_f32_16x16x32_bf16 v[108:111], v[52:55], v[32:35], v[108:111]
ds_read_b64_tr_b16 v[162:163], v22 offset:10240
ds_read_b64_tr_b16 v[164:165], v23 offset:8192
v_mfma_f32_16x16x32_bf16 v[124:127], v[52:55], v[36:39], v[124:127]
ds_read_b64_tr_b16 v[166:167], v23 offset:10240
ds_read_b128 v[148:151], v3 offset:50176
v_mfma_f32_16x16x32_bf16 v[120:123], v[48:51], v[36:39], v[120:123]
ds_read_b128 v[168:171], v3 offset:57344
ds_read_b64_tr_b16 v[176:177], v20 offset:12288
v_mfma_f32_16x16x32_bf16 v[116:119], v[44:47], v[36:39], v[116:119]
ds_read_b64_tr_b16 v[178:179], v20 offset:14336
ds_read_b64_tr_b16 v[180:181], v21 offset:12288
v_mfma_f32_16x16x32_bf16 v[112:115], v[40:43], v[36:39], v[112:115]
ds_read_b64_tr_b16 v[182:183], v21 offset:14336
ds_read_b64_tr_b16 v[184:185], v22 offset:12288
v_mfma_f32_16x16x32_bf16 v[96:99], v[64:67], v[56:59], v[96:99]
ds_read_b64_tr_b16 v[186:187], v22 offset:14336
ds_read_b64_tr_b16 v[188:189], v23 offset:12288
v_mfma_f32_16x16x32_bf16 v[100:103], v[68:71], v[56:59], v[100:103]
ds_read_b64_tr_b16 v[190:191], v23 offset:14336
ds_read_b128 v[172:175], v3 offset:58368
v_mfma_f32_16x16x32_bf16 v[104:107], v[72:75], v[56:59], v[104:107]
v_mfma_f32_16x16x32_bf16 v[108:111], v[76:79], v[56:59], v[108:111]
v_mfma_f32_16x16x32_bf16 v[124:127], v[76:79], v[60:63], v[124:127]
v_mfma_f32_16x16x32_bf16 v[120:123], v[72:75], v[60:63], v[120:123]
v_mfma_f32_16x16x32_bf16 v[116:119], v[68:71], v[60:63], v[116:119]
v_mfma_f32_16x16x32_bf16 v[112:115], v[64:67], v[60:63], v[112:115]
s_waitcnt lgkmcnt(0)
v_mfma_f32_16x16x32_bf16 v[96:99], v[152:155], v[144:147], v[96:99]
v_mfma_f32_16x16x32_bf16 v[100:103], v[156:159], v[144:147], v[100:103]
v_mfma_f32_16x16x32_bf16 v[104:107], v[160:163], v[144:147], v[104:107]
v_mfma_f32_16x16x32_bf16 v[108:111], v[164:167], v[144:147], v[108:111]
v_mfma_f32_16x16x32_bf16 v[124:127], v[164:167], v[148:151], v[124:127]
v_mfma_f32_16x16x32_bf16 v[120:123], v[160:163], v[148:151], v[120:123]
v_mfma_f32_16x16x32_bf16 v[116:119], v[156:159], v[148:151], v[116:119]
v_mfma_f32_16x16x32_bf16 v[112:115], v[152:155], v[148:151], v[112:115]
v_mfma_f32_16x16x32_bf16 v[96:99], v[176:179], v[168:171], v[96:99]
v_mfma_f32_16x16x32_bf16 v[100:103], v[180:183], v[168:171], v[100:103]
v_mfma_f32_16x16x32_bf16 v[104:107], v[184:187], v[168:171], v[104:107]
v_mfma_f32_16x16x32_bf16 v[108:111], v[188:191], v[168:171], v[108:111]
v_mfma_f32_16x16x32_bf16 v[124:127], v[188:191], v[172:175], v[124:127]
v_mfma_f32_16x16x32_bf16 v[120:123], v[184:187], v[172:175], v[120:123]
v_mfma_f32_16x16x32_bf16 v[116:119], v[180:183], v[172:175], v[116:119]
v_mfma_f32_16x16x32_bf16 v[112:115], v[176:179], v[172:175], v[112:115]
s_nop 3
v_cvt_pk_bf16_f32 v32, v96, v97
v_cvt_pk_bf16_f32 v33, v98, v99
v_cvt_pk_bf16_f32 v34, v100, v101
v_cvt_pk_bf16_f32 v35, v102, v103
s_add_u32 s43, s60, 0
buffer_store_dwordx4 v[32:35], v11, s[20:23], s43 offen offset:0 sc1
v_cvt_pk_bf16_f32 v36, v104, v105
v_cvt_pk_bf16_f32 v37, v106, v107
v_cvt_pk_bf16_f32 v38, v108, v109
v_cvt_pk_bf16_f32 v39, v110, v111
s_add_u32 s43, s60, 8192
buffer_store_dwordx4 v[36:39], v11, s[20:23], s43 offen offset:0 sc1
v_cvt_pk_bf16_f32 v44, v120, v121
v_cvt_pk_bf16_f32 v45, v122, v123
v_cvt_pk_bf16_f32 v46, v124, v125
v_cvt_pk_bf16_f32 v47, v126, v127
s_add_u32 s43, s60, 8192
buffer_store_dwordx4 v[44:47], v11, s[20:23], s43 offen offset:1024 sc1
v_cvt_pk_bf16_f32 v40, v112, v113
v_cvt_pk_bf16_f32 v41, v114, v115
v_cvt_pk_bf16_f32 v42, v116, v117
v_cvt_pk_bf16_f32 v43, v118, v119
s_add_u32 s43, s60, 0
buffer_store_dwordx4 v[40:43], v11, s[20:23], s43 offen offset:1024 sc1
v_mov_b32 v64, 0
v_mov_b32 v65, 0
v_mov_b32 v66, 0
v_mov_b32 v67, 0
v_mov_b32 v68, 0
v_mov_b32 v69, 0
v_mov_b32 v70, 0
v_mov_b32 v71, 0
v_dot2_f32_bf16 v64, v32, s61, v64
v_dot2_f32_bf16 v66, v32, v32, v66
v_dot2_f32_bf16 v68, v40, s61, v68
v_dot2_f32_bf16 v70, v40, v40, v70
v_dot2_f32_bf16 v65, v33, s61, v65
v_dot2_f32_bf16 v67, v33, v33, v67
v_dot2_f32_bf16 v69, v41, s61, v69
v_dot2_f32_bf16 v71, v41, v41, v71
v_dot2_f32_bf16 v64, v34, s61, v64
v_dot2_f32_bf16 v66, v34, v34, v66
v_dot2_f32_bf16 v68, v42, s61, v68
v_dot2_f32_bf16 v70, v42, v42, v70
v_dot2_f32_bf16 v65, v35, s61, v65
v_dot2_f32_bf16 v67, v35, v35, v67
v_dot2_f32_bf16 v69, v43, s61, v69
v_dot2_f32_bf16 v71, v43, v43, v71
v_dot2_f32_bf16 v64, v36, s61, v64
v_dot2_f32_bf16 v66, v36, v36, v66
v_dot2_f32_bf16 v68, v44, s61, v68
v_dot2_f32_bf16 v70, v44, v44, v70
v_dot2_f32_bf16 v65, v37, s61, v65
v_dot2_f32_bf16 v67, v37, v37, v67
v_dot2_f32_bf16 v69, v45, s61, v69
v_dot2_f32_bf16 v71, v45, v45, v71
v_dot2_f32_bf16 v64, v38, s61, v64
v_dot2_f32_bf16 v66, v38, v38, v66
v_dot2_f32_bf16 v68, v46, s61, v68
v_dot2_f32_bf16 v70, v46, v46, v70
v_dot2_f32_bf16 v65, v39, s61, v65
v_dot2_f32_bf16 v67, v39, v39, v67
v_dot2_f32_bf16 v69, v47, s61, v69
v_dot2_f32_bf16 v71, v47, v47, v71
s_nop 2
v_add_f32 v64, v64, v65
v_add_f32 v66, v66, v67
v_add_f32 v68, v68, v69
v_add_f32 v70, v70, v71
s_nop 1
v_permlane32_swap_b32 v64, v68
v_permlane32_swap_b32 v66, v70
v_add_f32 v64, v64, v68
v_add_f32 v66, v66, v70
s_nop 1
v_permlane16_swap_b32 v64, v66
v_add_f32 v64, v64, v66
buffer_store_dword v64, v9, s[24:27], 0 offen sc1
s_lshl_b32 s7, s34, 12
s_add_u32 s7, s7, 49280
v_lshl_add_u32 v4, v1, 8, s7
v_mov_b32 v5, 1
s_waitcnt vmcnt(0)
s_cmp_lg_u32 s36, 0
s_barrier
s_cbranch_scc1 Lk2end_98
s_mov_b64 exec, 0xffff
buffer_atomic_add v5, v4, s[56:59], 0 offen sc1
s_mov_b64 exec, -1
s_branch Lk2end_98
Lprod_99:
s_mul_i32 s43, s34, 262144
s_add_u32 s8, s82, s43
s_addc_u32 s9, s83, 0
s_mov_b32 s10, 262144
s_mov_b32 s11, 0x20000
s_lshl_b32 s43, s35, 7
s_add_u32 s12, s68, s43
s_addc_u32 s13, s69, 0
s_mov_b32 s14, 2095232
s_mov_b32 s15, 0x20000
s_and_b32 s47, s36, 3
s_lshl_b32 s39, s47, 12
v_lshlrev_b32 v2, 4, v1
v_add_u32 v2, s39, v2
v_lshrrev_b32 v12, 3, v1
v_and_b32 v13, 6, v12
v_and_b32 v3, 7, v1
v_xor_b32 v3, v3, v13
v_lshlrev_b32 v3, 4, v3
v_mul_u32_u24 v12, 2048, v12
v_add_u32 v3, v3, v12
s_lshl_b32 s43, s47, 15
v_add_u32 v3, s43, v3
s_lshl_b32 s40, s47, 11
s_add_u32 s37, s35, 0
s_and_b32 s37, s37, 15
s_lshl_b32 s37, s37, 14
s_add_u32 m0, s39, 0
s_nop 0
buffer_load_dwordx4 v2, s[8:11], s37 offen offset:0 sc1 lds
buffer_load_dwordx4 v2, s[8:11], s37 offen offset:1024 sc1 lds
buffer_load_dwordx4 v2, s[8:11], s37 offen offset:2048 sc1 lds
buffer_load_dwordx4 v2, s[8:11], s37 offen offset:3072 sc1 lds
s_add_u32 s38, s35, 8
s_and_b32 s38, s38, 15
s_lshl_b32 s38, s38, 17
s_add_u32 m0, s40, 16384
s_nop 0
buffer_load_dwordx4 v3, s[12:15], s38 offen lds
s_add_u32 m0, s40, 17408
s_add_u32 s38, s38, 16384
buffer_load_dwordx4 v3, s[12:15], s38 offen lds
s_add_u32 s38, s35, 9
s_and_b32 s38, s38, 15
s_lshl_b32 s38, s38, 17
s_add_u32 m0, s40, 24576
s_nop 0
buffer_load_dwordx4 v3, s[12:15], s38 offen lds
s_add_u32 m0, s40, 25600
s_add_u32 s38, s38, 16384
buffer_load_dwordx4 v3, s[12:15], s38 offen lds
s_add_u32 s38, s35, 10
s_and_b32 s38, s38, 15
s_lshl_b32 s38, s38, 17
s_add_u32 m0, s40, 32768
s_nop 0
buffer_load_dwordx4 v3, s[12:15], s38 offen lds
s_add_u32 m0, s40, 33792
s_add_u32 s38, s38, 16384
buffer_load_dwordx4 v3, s[12:15], s38 offen lds
s_add_u32 s38, s35, 11
s_and_b32 s38, s38, 15
s_lshl_b32 s38, s38, 17
s_add_u32 m0, s40, 40960
s_nop 0
buffer_load_dwordx4 v3, s[12:15], s38 offen lds
s_add_u32 m0, s40, 41984
s_add_u32 s38, s38, 16384
buffer_load_dwordx4 v3, s[12:15], s38 offen lds
s_bitcmp0_b32 s36, 1
s_cselect_b32 s44, s72, s74
s_cselect_b32 s45, s73, s75
s_mul_i32 s43, s35, 192
s_add_u32 s16, s44, s43
s_addc_u32 s17, s45, 0
s_add_u32 s16, s16, 4096
s_addc_u32 s17, s17, 0
s_mov_b32 s18, 7333056
s_mov_b32 s19, 0x20000
s_and_b32 s43, s36, 1
s_mul_i32 s43, s43, 229376
v_add_u32 v196, 0, v1
v_mul_u32_u24 v197, 5462, v196
v_lshrrev_b32 v197, 16, v197
v_mul_u32_u24 v198, 12, v197
v_sub_u32 v198, v196, v198
v_bfe_u32 v199, v197, 2, 1
v_cmp_gt_u32 vcc, 8, v198
v_lshlrev_b32 v200, 1, v199
v_mul_u32_u24 v197, 7168, v197
v_cndmask_b32 v199, v199, v200, vcc
v_xor_b32 v198, v198, v199
v_lshl_add_u32 v192, v198, 4, v197
v_add_u32 v196, 64, v1
v_mul_u32_u24 v197, 5462, v196
v_lshrrev_b32 v197, 16, v197
v_mul_u32_u24 v198, 12, v197
v_sub_u32 v198, v196, v198
v_bfe_u32 v199, v197, 2, 1
v_cmp_gt_u32 vcc, 8, v198
v_lshlrev_b32 v200, 1, v199
v_mul_u32_u24 v197, 7168, v197
v_cndmask_b32 v199, v199, v200, vcc
v_xor_b32 v198, v198, v199
v_lshl_add_u32 v193, v198, 4, v197
v_add_u32 v196, 128, v1
v_mul_u32_u24 v197, 5462, v196
v_lshrrev_b32 v197, 16, v197
v_mul_u32_u24 v198, 12, v197
v_sub_u32 v198, v196, v198
v_bfe_u32 v199, v197, 2, 1
v_cmp_gt_u32 vcc, 8, v198
v_lshlrev_b32 v200, 1, v199
v_mul_u32_u24 v197, 7168, v197
v_cndmask_b32 v199, v199, v200, vcc
v_xor_b32 v198, v198, v199
v_lshl_add_u32 v194, v198, 4, v197
v_add_u32 v192, s43, v192
v_add_u32 v193, s43, v193
v_add_u32 v194, s43, v194
s_and_b32 s43, s36, 3
s_mul_i32 s50, s43, 6144
s_add_u32 s50, s50, 16384
s_cmp_eq_u32 s47, 3
s_cbranch_scc0 Lw_101
s_lshl_b32 s92, s34, 4
s_add_u32 s92, s92, s35
s_lshl_b32 s92, s92, 8
s_add_u32 s92, s92, 49152
s_add_u32 s92, s92, 28311552
s_mov_b32 s41, 0x40000
Lpoll_102:
s_load_dword s93, s[82:83], s92 glc
Lpchk_104:
s_waitcnt lgkmcnt(0)
s_cmp_eq_u32 s93, 16
s_cbranch_scc1 Lpok_103
s_sub_u32 s41, s41, 1
s_cmp_lg_u32 s41, 0
s_cbranch_scc1 Lpoll_102
Lpok_103:
Lw_101:
s_and_b32 s44, s36, 3
s_mul_i32 s44, s44, 11
s_bfe_u32 s43, s2, 0x30001
s_lshl_b32 s43, s43, 7
s_add_u32 s44, s44, s43
s_add_u32 s44, s44, 84
s_mul_i32 s44, s44, 7168
s_lshr_b32 s43, s2, 4
s_lshl_b32 s43, s43, 8
s_add_u32 s43, s43, s44
s_bitcmp0_b32 s2, 0
s_cselect_b32 s4, s72, s74
s_cselect_b32 s5, s73, s75
s_add_u32 s4, s4, s43
s_addc_u32 s5, s5, 0
s_cmp_eq_u32 s47, 3
s_cbranch_scc1 Lw_105
Lw_105:
s_waitcnt vmcnt(8)
s_barrier
s_add_u32 s37, s35, 1
s_and_b32 s37, s37, 15
s_lshl_b32 s37, s37, 14
s_add_u32 m0, s39, 49152
s_nop 0
buffer_load_dwordx4 v2, s[8:11], s37 offen offset:0 sc1 lds
buffer_load_dwordx4 v2, s[8:11], s37 offen offset:1024 sc1 lds
buffer_load_dwordx4 v2, s[8:11], s37 offen offset:2048 sc1 lds
buffer_load_dwordx4 v2, s[8:11], s37 offen offset:3072 sc1 lds
s_add_u32 s37, s35, 2
s_and_b32 s37, s37, 15
s_lshl_b32 s37, s37, 14
s_add_u32 m0, s39, 98304
s_nop 0
buffer_load_dwordx4 v2, s[8:11], s37 offen offset:0 sc1 lds
buffer_load_dwordx4 v2, s[8:11], s37 offen offset:1024 sc1 lds
buffer_load_dwordx4 v2, s[8:11], s37 offen offset:2048 sc1 lds
buffer_load_dwordx4 v2, s[8:11], s37 offen offset:3072 sc1 lds
s_add_u32 s37, s35, 3
s_and_b32 s37, s37, 15
s_lshl_b32 s37, s37, 14
s_add_u32 m0, s39, 147456
s_nop 0
buffer_load_dwordx4 v2, s[8:11], s37 offen offset:0 sc1 lds
buffer_load_dwordx4 v2, s[8:11], s37 offen offset:1024 sc1 lds
buffer_load_dwordx4 v2, s[8:11], s37 offen offset:2048 sc1 lds
buffer_load_dwordx4 v2, s[8:11], s37 offen offset:3072 sc1 lds
s_cmp_eq_u32 s47, 3
s_cbranch_scc0 Lw_106
Lw_106:
s_waitcnt vmcnt(8)
s_barrier
s_add_u32 s37, s35, 4
s_and_b32 s37, s37, 15
s_lshl_b32 s37, s37, 14
s_add_u32 m0, s39, 0
s_nop 0
buffer_load_dwordx4 v2, s[8:11], s37 offen offset:0 sc1 lds
buffer_load_dwordx4 v2, s[8:11], s37 offen offset:1024 sc1 lds
buffer_load_dwordx4 v2, s[8:11], s37 offen offset:2048 sc1 lds
buffer_load_dwordx4 v2, s[8:11], s37 offen offset:3072 sc1 lds
s_waitcnt vmcnt(8)
s_barrier
s_add_u32 s37, s35, 5
s_and_b32 s37, s37, 15
s_lshl_b32 s37, s37, 14
s_add_u32 m0, s39, 49152
s_nop 0
buffer_load_dwordx4 v2, s[8:11], s37 offen offset:0 sc1 lds
buffer_load_dwordx4 v2, s[8:11], s37 offen offset:1024 sc1 lds
buffer_load_dwordx4 v2, s[8:11], s37 offen offset:2048 sc1 lds
buffer_load_dwordx4 v2, s[8:11], s37 offen offset:3072 sc1 lds
s_waitcnt vmcnt(8)
s_barrier
s_add_u32 s37, s35, 6
s_and_b32 s37, s37, 15
s_lshl_b32 s37, s37, 14
s_add_u32 m0, s39, 98304
s_nop 0
buffer_load_dwordx4 v2, s[8:11], s37 offen offset:0 sc1 lds
buffer_load_dwordx4 v2, s[8:11], s37 offen offset:1024 sc1 lds
buffer_load_dwordx4 v2, s[8:11], s37 offen offset:2048 sc1 lds
buffer_load_dwordx4 v2, s[8:11], s37 offen offset:3072 sc1 lds
s_waitcnt vmcnt(8)
s_barrier
s_add_u32 s37, s35, 7
s_and_b32 s37, s37, 15
s_lshl_b32 s37, s37, 14
s_add_u32 m0, s39, 147456
s_nop 0
buffer_load_dwordx4 v2, s[8:11], s37 offen offset:0 sc1 lds
buffer_load_dwordx4 v2, s[8:11], s37 offen offset:1024 sc1 lds
buffer_load_dwordx4 v2, s[8:11], s37 offen offset:2048 sc1 lds
buffer_load_dwordx4 v2, s[8:11], s37 offen offset:3072 sc1 lds
s_waitcnt vmcnt(8)
s_barrier
s_add_u32 s37, s35, 8
s_and_b32 s37, s37, 15
s_lshl_b32 s37, s37, 14
s_add_u32 m0, s39, 0
s_nop 0
buffer_load_dwordx4 v2, s[8:11], s37 offen offset:0 sc1 lds
buffer_load_dwordx4 v2, s[8:11], s37 offen offset:1024 sc1 lds
buffer_load_dwordx4 v2, s[8:11], s37 offen offset:2048 sc1 lds
buffer_load_dwordx4 v2, s[8:11], s37 offen offset:3072 sc1 lds
s_add_u32 s38, s35, 12
s_and_b32 s38, s38, 15
s_lshl_b32 s38, s38, 17
s_add_u32 m0, s40, 114688
s_nop 0
buffer_load_dwordx4 v3, s[12:15], s38 offen lds
s_add_u32 m0, s40, 115712
s_add_u32 s38, s38, 16384
buffer_load_dwordx4 v3, s[12:15], s38 offen lds
s_waitcnt vmcnt(10)
s_barrier
s_add_u32 s37, s35, 9
s_and_b32 s37, s37, 15
s_lshl_b32 s37, s37, 14
s_add_u32 m0, s39, 49152
s_nop 0
buffer_load_dwordx4 v2, s[8:11], s37 offen offset:0 sc1 lds
buffer_load_dwordx4 v2, s[8:11], s37 offen offset:1024 sc1 lds
buffer_load_dwordx4 v2, s[8:11], s37 offen offset:2048 sc1 lds
buffer_load_dwordx4 v2, s[8:11], s37 offen offset:3072 sc1 lds
s_add_u32 s38, s35, 13
s_and_b32 s38, s38, 15
s_lshl_b32 s38, s38, 17
s_add_u32 m0, s40, 122880
s_nop 0
buffer_load_dwordx4 v3, s[12:15], s38 offen lds
s_add_u32 m0, s40, 123904
s_add_u32 s38, s38, 16384
buffer_load_dwordx4 v3, s[12:15], s38 offen lds
s_waitcnt vmcnt(12)
s_barrier
s_add_u32 s37, s35, 10
s_and_b32 s37, s37, 15
s_lshl_b32 s37, s37, 14
s_add_u32 m0, s39, 98304
s_nop 0
buffer_load_dwordx4 v2, s[8:11], s37 offen offset:0 sc1 lds
buffer_load_dwordx4 v2, s[8:11], s37 offen offset:1024 sc1 lds
buffer_load_dwordx4 v2, s[8:11], s37 offen offset:2048 sc1 lds
buffer_load_dwordx4 v2, s[8:11], s37 offen offset:3072 sc1 lds
s_add_u32 s38, s35, 14
s_and_b32 s38, s38, 15
s_lshl_b32 s38, s38, 17
s_add_u32 m0, s40, 131072
s_nop 0
buffer_load_dwordx4 v3, s[12:15], s38 offen lds
s_add_u32 m0, s40, 132096
s_add_u32 s38, s38, 16384
buffer_load_dwordx4 v3, s[12:15], s38 offen lds
s_waitcnt vmcnt(14)
s_barrier
s_add_u32 s37, s35, 11
s_and_b32 s37, s37, 15
s_lshl_b32 s37, s37, 14
s_add_u32 m0, s39, 147456
s_nop 0
buffer_load_dwordx4 v2, s[8:11], s37 offen offset:0 sc1 lds
buffer_load_dwordx4 v2, s[8:11], s37 offen offset:1024 sc1 lds
buffer_load_dwordx4 v2, s[8:11], s37 offen offset:2048 sc1 lds
buffer_load_dwordx4 v2, s[8:11], s37 offen offset:3072 sc1 lds
s_add_u32 s38, s35, 15
s_and_b32 s38, s38, 15
s_lshl_b32 s38, s38, 17
s_add_u32 m0, s40, 139264
s_nop 0
buffer_load_dwordx4 v3, s[12:15], s38 offen lds
s_add_u32 m0, s40, 140288
s_add_u32 s38, s38, 16384
buffer_load_dwordx4 v3, s[12:15], s38 offen lds
s_waitcnt vmcnt(14)
s_barrier
s_add_u32 s37, s35, 12
s_and_b32 s37, s37, 15
s_lshl_b32 s37, s37, 14
s_add_u32 m0, s39, 0
s_nop 0
buffer_load_dwordx4 v2, s[8:11], s37 offen offset:0 sc1 lds
buffer_load_dwordx4 v2, s[8:11], s37 offen offset:1024 sc1 lds
buffer_load_dwordx4 v2, s[8:11], s37 offen offset:2048 sc1 lds
buffer_load_dwordx4 v2, s[8:11], s37 offen offset:3072 sc1 lds
s_waitcnt vmcnt(12)
s_barrier
s_add_u32 s37, s35, 13
s_and_b32 s37, s37, 15
s_lshl_b32 s37, s37, 14
s_add_u32 m0, s39, 49152
s_nop 0
buffer_load_dwordx4 v2, s[8:11], s37 offen offset:0 sc1 lds
buffer_load_dwordx4 v2, s[8:11], s37 offen offset:1024 sc1 lds
buffer_load_dwordx4 v2, s[8:11], s37 offen offset:2048 sc1 lds
buffer_load_dwordx4 v2, s[8:11], s37 offen offset:3072 sc1 lds
s_waitcnt vmcnt(10)
s_barrier
s_add_u32 s37, s35, 14
s_and_b32 s37, s37, 15
s_lshl_b32 s37, s37, 14
s_add_u32 m0, s39, 98304
s_nop 0
buffer_load_dwordx4 v2, s[8:11], s37 offen offset:0 sc1 lds
buffer_load_dwordx4 v2, s[8:11], s37 offen offset:1024 sc1 lds
buffer_load_dwordx4 v2, s[8:11], s37 offen offset:2048 sc1 lds
buffer_load_dwordx4 v2, s[8:11], s37 offen offset:3072 sc1 lds
s_getpc_b64 s[100:101]
s_and_b32 s100, s100, 0xfffff000
s_sub_u32 s100, s100, 1077248
s_subb_u32 s101, s101, 0
s_lshr_b32 s6, s2, 3
s_mul_i32 s6, s6, 4
s_and_b32 s7, s36, 3
s_add_u32 s6, s6, s7
s_mulk_i32 s6, 384
s_add_u32 s6, s6, 1081920
s_load_dword s3, s[100:101], s6 offset:0
s_load_dword s3, s[100:101], s6 offset:64
s_load_dword s3, s[100:101], s6 offset:128
s_load_dword s3, s[100:101], s6 offset:192
s_load_dword s3, s[100:101], s6 offset:256
s_load_dword s3, s[100:101], s6 offset:320
s_waitcnt vmcnt(8)
s_barrier
s_add_u32 s37, s35, 15
s_and_b32 s37, s37, 15
s_lshl_b32 s37, s37, 14
s_add_u32 m0, s39, 147456
s_nop 0
buffer_load_dwordx4 v2, s[8:11], s37 offen offset:0 sc1 lds
buffer_load_dwordx4 v2, s[8:11], s37 offen offset:1024 sc1 lds
buffer_load_dwordx4 v2, s[8:11], s37 offen offset:2048 sc1 lds
buffer_load_dwordx4 v2, s[8:11], s37 offen offset:3072 sc1 lds
s_waitcnt vmcnt(8)
s_barrier
s_waitcnt vmcnt(0)
s_barrier
s_add_u32 s38, s35, 0
s_and_b32 s38, s38, 15
s_mul_i32 s38, s38, 458752
s_add_u32 m0, s50, 0
s_nop 0
buffer_load_dwordx4 v192, s[16:19], s38 offen lds
s_add_u32 m0, s50, 1024
s_nop 0
buffer_load_dwordx4 v193, s[16:19], s38 offen lds
s_add_u32 m0, s50, 2048
s_nop 0
buffer_load_dwordx4 v194, s[16:19], s38 offen lds
s_add_u32 m0, s50, 3072
s_add_u32 s38, s38, 114688
buffer_load_dwordx4 v192, s[16:19], s38 offen lds
s_add_u32 m0, s50, 4096
s_nop 0
buffer_load_dwordx4 v193, s[16:19], s38 offen lds
s_add_u32 m0, s50, 5120
s_nop 0
buffer_load_dwordx4 v194, s[16:19], s38 offen lds
s_add_u32 s38, s35, 1
s_and_b32 s38, s38, 15
s_mul_i32 s38, s38, 458752
s_add_u32 m0, s50, 49152
s_nop 0
buffer_load_dwordx4 v192, s[16:19], s38 offen lds
s_add_u32 m0, s50, 50176
s_nop 0
buffer_load_dwordx4 v193, s[16:19], s38 offen lds
s_add_u32 m0, s50, 51200
s_nop 0
buffer_load_dwordx4 v194, s[16:19], s38 offen lds
s_add_u32 m0, s50, 52224
s_add_u32 s38, s38, 114688
buffer_load_dwordx4 v192, s[16:19], s38 offen lds
s_add_u32 m0, s50, 53248
s_nop 0
buffer_load_dwordx4 v193, s[16:19], s38 offen lds
s_add_u32 m0, s50, 54272
s_nop 0
buffer_load_dwordx4 v194, s[16:19], s38 offen lds
v_lshlrev_b32 v240, 16, v128
v_and_b32 v241, 0xffff0000, v128
v_lshlrev_b32 v242, 16, v129
v_and_b32 v243, 0xffff0000, v129
v_lshlrev_b32 v244, 16, v130
v_and_b32 v245, 0xffff0000, v130
v_lshlrev_b32 v246, 16, v131
v_and_b32 v247, 0xffff0000, v131
v_lshlrev_b32 v24, 16, v132
v_and_b32 v25, 0xffff0000, v132
v_lshlrev_b32 v26, 16, v133
v_and_b32 v27, 0xffff0000, v133
v_lshlrev_b32 v28, 16, v134
v_and_b32 v29, 0xffff0000, v134
v_lshlrev_b32 v30, 16, v135
v_and_b32 v31, 0xffff0000, v135
v_add_f32 v240, v240, v24
v_add_f32 v241, v241, v25
v_add_f32 v242, v242, v26
v_add_f32 v243, v243, v27
v_add_f32 v244, v244, v28
v_add_f32 v245, v245, v29
v_add_f32 v246, v246, v30
v_add_f32 v247, v247, v31
v_lshlrev_b32 v24, 16, v136
v_and_b32 v25, 0xffff0000, v136
v_lshlrev_b32 v26, 16, v137
v_and_b32 v27, 0xffff0000, v137
v_lshlrev_b32 v28, 16, v138
v_and_b32 v29, 0xffff0000, v138
v_lshlrev_b32 v30, 16, v139
v_and_b32 v31, 0xffff0000, v139
v_add_f32 v240, v240, v24
v_add_f32 v241, v241, v25
v_add_f32 v242, v242, v26
v_add_f32 v243, v243, v27
v_add_f32 v244, v244, v28
v_add_f32 v245, v245, v29
v_add_f32 v246, v246, v30
v_add_f32 v247, v247, v31
v_lshlrev_b32 v24, 16, v140
v_and_b32 v25, 0xffff0000, v140
v_lshlrev_b32 v26, 16, v141
v_and_b32 v27, 0xffff0000, v141
v_lshlrev_b32 v28, 16, v142
v_and_b32 v29, 0xffff0000, v142
s_branch Lov_7
.p2align 12
.fill 48, 4, 0xbf800000
Lst_7_0:
s_branch Lwr_162
s_nop 0
s_nop 0
Lov_7:
v_lshlrev_b32 v30, 16, v143
v_and_b32 v31, 0xffff0000, v143
v_add_f32 v240, v240, v24
v_add_f32 v241, v241, v25
v_add_f32 v242, v242, v26
v_add_f32 v243, v243, v27
v_add_f32 v244, v244, v28
v_add_f32 v245, v245, v29
v_add_f32 v246, v246, v30
v_add_f32 v247, v247, v31
v_lshlrev_b32 v24, 16, v144
v_and_b32 v25, 0xffff0000, v144
v_lshlrev_b32 v26, 16, v145
v_and_b32 v27, 0xffff0000, v145
v_lshlrev_b32 v28, 16, v146
v_and_b32 v29, 0xffff0000, v146
v_lshlrev_b32 v30, 16, v147
v_and_b32 v31, 0xffff0000, v147
v_add_f32 v240, v240, v24
v_add_f32 v241, v241, v25
v_add_f32 v242, v242, v26
v_add_f32 v243, v243, v27
v_add_f32 v244, v244, v28
v_add_f32 v245, v245, v29
v_add_f32 v246, v246, v30
v_add_f32 v247, v247, v31
v_lshlrev_b32 v24, 16, v148
v_and_b32 v25, 0xffff0000, v148
v_lshlrev_b32 v26, 16, v149
v_and_b32 v27, 0xffff0000, v149
v_lshlrev_b32 v28, 16, v150
v_and_b32 v29, 0xffff0000, v150
v_lshlrev_b32 v30, 16, v151
v_and_b32 v31, 0xffff0000, v151
v_add_f32 v240, v240, v24
v_add_f32 v241, v241, v25
v_add_f32 v242, v242, v26
v_add_f32 v243, v243, v27
v_add_f32 v244, v244, v28
v_add_f32 v245, v245, v29
v_add_f32 v246, v246, v30
v_add_f32 v247, v247, v31
v_lshlrev_b32 v24, 16, v152
v_and_b32 v25, 0xffff0000, v152
v_lshlrev_b32 v26, 16, v153
v_and_b32 v27, 0xffff0000, v153
v_lshlrev_b32 v28, 16, v154
v_and_b32 v29, 0xffff0000, v154
v_lshlrev_b32 v30, 16, v155
v_and_b32 v31, 0xffff0000, v155
v_add_f32 v240, v240, v24
v_add_f32 v241, v241, v25
v_add_f32 v242, v242, v26
v_add_f32 v243, v243, v27
v_add_f32 v244, v244, v28
v_add_f32 v245, v245, v29
v_add_f32 v246, v246, v30
v_add_f32 v247, v247, v31
v_lshlrev_b32 v24, 16, v156
v_and_b32 v25, 0xffff0000, v156
v_lshlrev_b32 v26, 16, v157
v_and_b32 v27, 0xffff0000, v157
v_lshlrev_b32 v28, 16, v158
v_and_b32 v29, 0xffff0000, v158
v_lshlrev_b32 v30, 16, v159
v_and_b32 v31, 0xffff0000, v159
v_add_f32 v240, v240, v24
v_add_f32 v241, v241, v25
v_add_f32 v242, v242, v26
v_add_f32 v243, v243, v27
v_add_f32 v244, v244, v28
v_add_f32 v245, v245, v29
v_add_f32 v246, v246, v30
v_add_f32 v247, v247, v31
s_nop 0
v_permlane32_swap_b32 v240, v244
v_permlane32_swap_b32 v241, v245
v_permlane32_swap_b32 v242, v246
v_permlane32_swap_b32 v243, v247
v_add_f32 v240, v240, v244
v_add_f32 v241, v241, v245
v_add_f32 v242, v242, v246
v_add_f32 v243, v243, v247
s_nop 0
v_permlane16_swap_b32 v240, v242
v_permlane16_swap_b32 v241, v243
v_add_f32 v240, v240, v242
v_add_f32 v241, v241, v243
s_branch Lk3a
Lk2end_98:
Lk3:
s_branch Lgb_107
Lk3a:
s_mul_i32 s43, s34, 262144
s_add_u32 s8, s82, s43
s_addc_u32 s9, s83, 0
s_add_u32 s8, s8, 4194304
s_addc_u32 s9, s9, 0
s_mov_b32 s10, 262144
s_mov_b32 s11, 0x20000
s_mul_i32 s43, s34, 917504
s_add_u32 s24, s82, s43
s_addc_u32 s25, s83, 0
s_add_u32 s24, s24, 8388608
s_addc_u32 s25, s25, 0
s_mov_b32 s26, 917504
s_mov_b32 s27, 0x20000
s_add_u32 s84, s82, 27262976
s_addc_u32 s85, s83, 0
s_mov_b32 s86, 229376
s_mov_b32 s87, 0x20000
s_and_b32 s47, s36, 3
s_lshr_b32 s62, s47, 1
s_and_b32 s63, s47, 1
v_lshlrev_b32 v2, 4, v1
s_lshl_b32 s39, s47, 12
v_add_u32 v3, s39, v2
s_bitcmp0_b32 s36, 1
s_cselect_b32 s44, s72, s74
s_cselect_b32 s45, s73, s75
s_mul_i32 s43, s35, 256
s_add_u32 s12, s44, s43
s_addc_u32 s13, s45, 0
s_mov_b32 s14, 7333120
s_mov_b32 s15, 0x20000
s_and_b32 s43, s36, 1
s_mul_i32 s43, s43, 229376
v_lshrrev_b32 v28, 4, v1
v_lshlrev_b32 v29, 1, v28
v_and_b32 v4, 15, v1
v_xor_b32 v4, v4, v29
v_lshlrev_b32 v4, 4, v4
v_mul_u32_u24 v28, 7168, v28
v_add_u32 v4, v4, v28
v_add_u32 v4, s43, v4
v_xor_b32 v5, 128, v4
v_add_u32 v5, 28672, v5
s_and_b32 s43, s36, 3
s_mul_i32 s40, s43, 8192
s_add_u32 s40, s40, 16384
v_mov_b32 v6, v192
v_mov_b32 v7, v193
v_mov_b32 v8, v194
s_lshl_b32 s43, s62, 12
v_add_u32 v9, s43, v2
v_add_u32 v10, 98304, v9
v_lshrrev_b32 v27, 2, v1
v_bfe_u32 v28, v27, 2, 1
v_mul_u32_u24 v27, 192, v27
v_add_u32 v27, 16384, v27
v_and_b32 v29, 3, v1
v_lshl_add_u32 v12, v29, 3, v27
s_lshl_b32 s43, s63, 6
v_add_u32 v12, s43, v12
v_lshl_add_u32 v11, v28, 5, v12
v_xor_b32 v30, 1, v28
v_lshl_add_u32 v12, v30, 5, v12
v_xor_b32 v28, s63, v28
v_lshl_add_u32 v27, v28, 4, v27
v_lshrrev_b32 v28, 1, v29
v_lshl_add_u32 v27, v28, 5, v27
v_and_b32 v28, 1, v29
v_lshl_add_u32 v27, v28, 3, v27
v_add_u32 v13, 128, v27
v_add_u32 v14, 49152, v11
v_add_u32 v15, 49152, v12
v_add_u32 v16, 49152, v13
v_add_u32 v17, 98304, v11
v_add_u32 v18, 98304, v12
v_add_u32 v19, 98304, v13
s_cmp_lg_u32 s36, 4
s_cbranch_scc1 Lwm_109
s_branch Lst_8_1
Lwr_170:
s_branch Lwe_108
Lwm_109:
s_cmp_lg_u32 s36, 5
s_cbranch_scc1 Lwm_110
s_branch Lst_9_1
Lwr_171:
s_branch Lwe_108
Lwm_110:
s_cmp_lg_u32 s36, 6
s_cbranch_scc1 Lwm_111
s_branch Lst_10_1
Lwr_172:
s_branch Lwe_108
Lwm_111:
s_cmp_lg_u32 s36, 7
s_cbranch_scc1 Lwm_112
s_nop 0
s_branch Lwe_108
Lwm_112:
Lwe_108:
s_barrier
s_lshl_b32 s43, s47, 9
s_add_u32 s43, s43, 151552
v_and_b32 v28, 15, v1
v_lshl_add_u32 v28, v28, 5, s43
v_lshrrev_b32 v29, 4, v1
v_lshl_add_u32 v28, v29, 3, v28
ds_write_b64 v28, v[240:241]
s_waitcnt lgkmcnt(0)
s_cmp_lg_u32 s36, 4
s_cbranch_scc1 Lwm_114
s_branch Lst_11_1
Lwr_174:
s_branch Lwe_113
Lwm_114:
s_cmp_lg_u32 s36, 5
s_cbranch_scc1 Lwm_115
s_branch Lst_12_1
Lwr_175:
s_branch Lwe_113
Lwm_115:
s_cmp_lg_u32 s36, 6
s_cbranch_scc1 Lwm_116
s_branch Lst_13_1
Lwr_176:
s_branch Lwe_113
Lwm_116:
s_cmp_lg_u32 s36, 7
s_cbranch_scc1 Lwm_117
s_branch Lst_14_1
Lwr_177:
s_branch Lwe_113
Lwm_117:
Lwe_113:
s_waitcnt vmcnt(0) lgkmcnt(0)
s_barrier
ds_read_b128 v[32:35], v9 offset:0
ds_read_b64_tr_b16 v[48:49], v11 offset:0
ds_read_b64_tr_b16 v[50:51], v11 offset:3072
ds_read_b64_tr_b16 v[52:53], v12 offset:0
ds_read_b64_tr_b16 v[54:55], v12 offset:3072
ds_read_b64_tr_b16 v[56:57], v13 offset:0
ds_read_b64_tr_b16 v[58:59], v13 offset:3072
ds_read_b64_tr_b16 v[60:61], v11 offset:12288
ds_read_b64_tr_b16 v[62:63], v11 offset:15360
ds_read_b64_tr_b16 v[64:65], v12 offset:12288
ds_read_b64_tr_b16 v[66:67], v12 offset:15360
ds_read_b64_tr_b16 v[68:69], v13 offset:12288
ds_read_b64_tr_b16 v[70:71], v13 offset:15360
ds_read_b128 v[36:39], v9 offset:1024
ds_read_b128 v[40:43], v9 offset:2048
ds_read_b128 v[44:47], v9 offset:3072
s_waitcnt lgkmcnt(0)
v_mfma_f32_16x16x32_bf16 v[128:131], v[48:51], v[32:35], 0
ds_read_b128 v[72:75], v9 offset:8192
v_mfma_f32_16x16x32_bf16 v[152:155], v[48:51], v[36:39], 0
ds_read_b64_tr_b16 v[88:89], v11 offset:6144
v_mfma_f32_16x16x32_bf16 v[176:179], v[48:51], v[40:43], 0
ds_read_b64_tr_b16 v[90:91], v11 offset:9216
v_mfma_f32_16x16x32_bf16 v[200:203], v[48:51], v[44:47], 0
ds_read_b64_tr_b16 v[92:93], v12 offset:6144
v_mfma_f32_16x16x32_bf16 v[204:207], v[52:55], v[44:47], 0
ds_read_b64_tr_b16 v[94:95], v12 offset:9216
v_mfma_f32_16x16x32_bf16 v[180:183], v[52:55], v[40:43], 0
ds_read_b64_tr_b16 v[96:97], v13 offset:6144
v_mfma_f32_16x16x32_bf16 v[156:159], v[52:55], v[36:39], 0
ds_read_b64_tr_b16 v[98:99], v13 offset:9216
v_mfma_f32_16x16x32_bf16 v[132:135], v[52:55], v[32:35], 0
ds_read_b64_tr_b16 v[100:101], v11 offset:18432
v_mfma_f32_16x16x32_bf16 v[136:139], v[56:59], v[32:35], 0
ds_read_b64_tr_b16 v[102:103], v11 offset:21504
v_mfma_f32_16x16x32_bf16 v[160:163], v[56:59], v[36:39], 0
ds_read_b64_tr_b16 v[104:105], v12 offset:18432
v_mfma_f32_16x16x32_bf16 v[184:187], v[56:59], v[40:43], 0
ds_read_b64_tr_b16 v[106:107], v12 offset:21504
v_mfma_f32_16x16x32_bf16 v[208:211], v[56:59], v[44:47], 0
ds_read_b64_tr_b16 v[108:109], v13 offset:18432
v_mfma_f32_16x16x32_bf16 v[212:215], v[60:63], v[44:47], 0
ds_read_b64_tr_b16 v[110:111], v13 offset:21504
v_mfma_f32_16x16x32_bf16 v[188:191], v[60:63], v[40:43], 0
ds_read_b128 v[76:79], v9 offset:9216
v_mfma_f32_16x16x32_bf16 v[164:167], v[60:63], v[36:39], 0
ds_read_b128 v[80:83], v9 offset:10240
v_mfma_f32_16x16x32_bf16 v[140:143], v[60:63], v[32:35], 0
ds_read_b128 v[84:87], v9 offset:11264
v_mfma_f32_16x16x32_bf16 v[144:147], v[64:67], v[32:35], 0
v_mfma_f32_16x16x32_bf16 v[168:171], v[64:67], v[36:39], 0
v_mfma_f32_16x16x32_bf16 v[192:195], v[64:67], v[40:43], 0
v_mfma_f32_16x16x32_bf16 v[216:219], v[64:67], v[44:47], 0
v_mfma_f32_16x16x32_bf16 v[220:223], v[68:71], v[44:47], 0
v_mfma_f32_16x16x32_bf16 v[196:199], v[68:71], v[40:43], 0
v_mfma_f32_16x16x32_bf16 v[172:175], v[68:71], v[36:39], 0
v_mfma_f32_16x16x32_bf16 v[148:151], v[68:71], v[32:35], 0
s_waitcnt lgkmcnt(0)
s_barrier
v_mfma_f32_16x16x32_bf16 v[128:131], v[88:91], v[72:75], v[128:131]
ds_read_b128 v[32:35], v9 offset:49152
v_mfma_f32_16x16x32_bf16 v[152:155], v[88:91], v[76:79], v[152:155]
ds_read_b64_tr_b16 v[48:49], v14 offset:0
v_mfma_f32_16x16x32_bf16 v[176:179], v[88:91], v[80:83], v[176:179]
ds_read_b64_tr_b16 v[50:51], v14 offset:3072
v_mfma_f32_16x16x32_bf16 v[200:203], v[88:91], v[84:87], v[200:203]
ds_read_b64_tr_b16 v[52:53], v15 offset:0
v_mfma_f32_16x16x32_bf16 v[204:207], v[92:95], v[84:87], v[204:207]
ds_read_b64_tr_b16 v[54:55], v15 offset:3072
v_mfma_f32_16x16x32_bf16 v[180:183], v[92:95], v[80:83], v[180:183]
ds_read_b64_tr_b16 v[56:57], v16 offset:0
v_mfma_f32_16x16x32_bf16 v[156:159], v[92:95], v[76:79], v[156:159]
ds_read_b64_tr_b16 v[58:59], v16 offset:3072
v_mfma_f32_16x16x32_bf16 v[132:135], v[92:95], v[72:75], v[132:135]
ds_read_b64_tr_b16 v[60:61], v14 offset:12288
v_mfma_f32_16x16x32_bf16 v[136:139], v[96:99], v[72:75], v[136:139]
ds_read_b64_tr_b16 v[62:63], v14 offset:15360
v_mfma_f32_16x16x32_bf16 v[160:163], v[96:99], v[76:79], v[160:163]
ds_read_b64_tr_b16 v[64:65], v15 offset:12288
v_mfma_f32_16x16x32_bf16 v[184:187], v[96:99], v[80:83], v[184:187]
ds_read_b64_tr_b16 v[66:67], v15 offset:15360
v_mfma_f32_16x16x32_bf16 v[208:211], v[96:99], v[84:87], v[208:211]
ds_read_b64_tr_b16 v[68:69], v16 offset:12288
v_mfma_f32_16x16x32_bf16 v[212:215], v[100:103], v[84:87], v[212:215]
ds_read_b64_tr_b16 v[70:71], v16 offset:15360
v_mfma_f32_16x16x32_bf16 v[188:191], v[100:103], v[80:83], v[188:191]
ds_read_b128 v[36:39], v9 offset:50176
v_mfma_f32_16x16x32_bf16 v[164:167], v[100:103], v[76:79], v[164:167]
ds_read_b128 v[40:43], v9 offset:51200
v_mfma_f32_16x16x32_bf16 v[140:143], v[100:103], v[72:75], v[140:143]
ds_read_b128 v[44:47], v9 offset:52224
v_mfma_f32_16x16x32_bf16 v[144:147], v[104:107], v[72:75], v[144:147]
v_mfma_f32_16x16x32_bf16 v[168:171], v[104:107], v[76:79], v[168:171]
v_mfma_f32_16x16x32_bf16 v[192:195], v[104:107], v[80:83], v[192:195]
v_mfma_f32_16x16x32_bf16 v[216:219], v[104:107], v[84:87], v[216:219]
v_mfma_f32_16x16x32_bf16 v[220:223], v[108:111], v[84:87], v[220:223]
v_mfma_f32_16x16x32_bf16 v[196:199], v[108:111], v[80:83], v[196:199]
v_mfma_f32_16x16x32_bf16 v[172:175], v[108:111], v[76:79], v[172:175]
v_mfma_f32_16x16x32_bf16 v[148:151], v[108:111], v[72:75], v[148:151]
s_mov_b32 s41, 5
Lk3l_118:
s_waitcnt lgkmcnt(0)
v_mfma_f32_16x16x32_bf16 v[128:131], v[48:51], v[32:35], v[128:131]
ds_read_b128 v[72:75], v9 offset:57344
v_mfma_f32_16x16x32_bf16 v[152:155], v[48:51], v[36:39], v[152:155]
ds_read_b64_tr_b16 v[88:89], v14 offset:6144
v_mfma_f32_16x16x32_bf16 v[176:179], v[48:51], v[40:43], v[176:179]
ds_read_b64_tr_b16 v[90:91], v14 offset:9216
v_mfma_f32_16x16x32_bf16 v[200:203], v[48:51], v[44:47], v[200:203]
ds_read_b64_tr_b16 v[92:93], v15 offset:6144
v_mfma_f32_16x16x32_bf16 v[204:207], v[52:55], v[44:47], v[204:207]
ds_read_b64_tr_b16 v[94:95], v15 offset:9216
v_mfma_f32_16x16x32_bf16 v[180:183], v[52:55], v[40:43], v[180:183]
ds_read_b64_tr_b16 v[96:97], v16 offset:6144
v_mfma_f32_16x16x32_bf16 v[156:159], v[52:55], v[36:39], v[156:159]
ds_read_b64_tr_b16 v[98:99], v16 offset:9216
v_mfma_f32_16x16x32_bf16 v[132:135], v[52:55], v[32:35], v[132:135]
ds_read_b64_tr_b16 v[100:101], v14 offset:18432
v_mfma_f32_16x16x32_bf16 v[136:139], v[56:59], v[32:35], v[136:139]
ds_read_b64_tr_b16 v[102:103], v14 offset:21504
v_mfma_f32_16x16x32_bf16 v[160:163], v[56:59], v[36:39], v[160:163]
ds_read_b64_tr_b16 v[104:105], v15 offset:18432
v_mfma_f32_16x16x32_bf16 v[184:187], v[56:59], v[40:43], v[184:187]
ds_read_b64_tr_b16 v[106:107], v15 offset:21504
v_mfma_f32_16x16x32_bf16 v[208:211], v[56:59], v[44:47], v[208:211]
ds_read_b64_tr_b16 v[108:109], v16 offset:18432
v_mfma_f32_16x16x32_bf16 v[212:215], v[60:63], v[44:47], v[212:215]
ds_read_b64_tr_b16 v[110:111], v16 offset:21504
v_mfma_f32_16x16x32_bf16 v[188:191], v[60:63], v[40:43], v[188:191]
ds_read_b128 v[76:79], v9 offset:58368
v_mfma_f32_16x16x32_bf16 v[164:167], v[60:63], v[36:39], v[164:167]
ds_read_b128 v[80:83], v9 offset:59392
v_mfma_f32_16x16x32_bf16 v[140:143], v[60:63], v[32:35], v[140:143]
ds_read_b128 v[84:87], v9 offset:60416
v_mfma_f32_16x16x32_bf16 v[144:147], v[64:67], v[32:35], v[144:147]
v_mfma_f32_16x16x32_bf16 v[168:171], v[64:67], v[36:39], v[168:171]
v_mfma_f32_16x16x32_bf16 v[192:195], v[64:67], v[40:43], v[192:195]
v_mfma_f32_16x16x32_bf16 v[216:219], v[64:67], v[44:47], v[216:219]
v_mfma_f32_16x16x32_bf16 v[220:223], v[68:71], v[44:47], v[220:223]
v_mfma_f32_16x16x32_bf16 v[196:199], v[68:71], v[40:43], v[196:199]
v_mfma_f32_16x16x32_bf16 v[172:175], v[68:71], v[36:39], v[172:175]
v_mfma_f32_16x16x32_bf16 v[148:151], v[68:71], v[32:35], v[148:151]
s_waitcnt lgkmcnt(0)
s_barrier
v_mfma_f32_16x16x32_bf16 v[128:131], v[88:91], v[72:75], v[128:131]
ds_read_b128 v[32:35], v10 offset:0
v_mfma_f32_16x16x32_bf16 v[152:155], v[88:91], v[76:79], v[152:155]
ds_read_b64_tr_b16 v[48:49], v17 offset:0
v_mfma_f32_16x16x32_bf16 v[176:179], v[88:91], v[80:83], v[176:179]
ds_read_b64_tr_b16 v[50:51], v17 offset:3072
v_mfma_f32_16x16x32_bf16 v[200:203], v[88:91], v[84:87], v[200:203]
ds_read_b64_tr_b16 v[52:53], v18 offset:0
v_mfma_f32_16x16x32_bf16 v[204:207], v[92:95], v[84:87], v[204:207]
ds_read_b64_tr_b16 v[54:55], v18 offset:3072
v_mfma_f32_16x16x32_bf16 v[180:183], v[92:95], v[80:83], v[180:183]
ds_read_b64_tr_b16 v[56:57], v19 offset:0
v_mfma_f32_16x16x32_bf16 v[156:159], v[92:95], v[76:79], v[156:159]
ds_read_b64_tr_b16 v[58:59], v19 offset:3072
v_mfma_f32_16x16x32_bf16 v[132:135], v[92:95], v[72:75], v[132:135]
ds_read_b64_tr_b16 v[60:61], v17 offset:12288
v_mfma_f32_16x16x32_bf16 v[136:139], v[96:99], v[72:75], v[136:139]
ds_read_b64_tr_b16 v[62:63], v17 offset:15360
v_mfma_f32_16x16x32_bf16 v[160:163], v[96:99], v[76:79], v[160:163]
ds_read_b64_tr_b16 v[64:65], v18 offset:12288
v_mfma_f32_16x16x32_bf16 v[184:187], v[96:99], v[80:83], v[184:187]
ds_read_b64_tr_b16 v[66:67], v18 offset:15360
v_mfma_f32_16x16x32_bf16 v[208:211], v[96:99], v[84:87], v[208:211]
ds_read_b64_tr_b16 v[68:69], v19 offset:12288
v_mfma_f32_16x16x32_bf16 v[212:215], v[100:103], v[84:87], v[212:215]
ds_read_b64_tr_b16 v[70:71], v19 offset:15360
v_mfma_f32_16x16x32_bf16 v[188:191], v[100:103], v[80:83], v[188:191]
ds_read_b128 v[36:39], v10 offset:1024
v_mfma_f32_16x16x32_bf16 v[164:167], v[100:103], v[76:79], v[164:167]
ds_read_b128 v[40:43], v10 offset:2048
v_mfma_f32_16x16x32_bf16 v[140:143], v[100:103], v[72:75], v[140:143]
ds_read_b128 v[44:47], v10 offset:3072
v_mfma_f32_16x16x32_bf16 v[144:147], v[104:107], v[72:75], v[144:147]
v_mfma_f32_16x16x32_bf16 v[168:171], v[104:107], v[76:79], v[168:171]
v_mfma_f32_16x16x32_bf16 v[192:195], v[104:107], v[80:83], v[192:195]
v_mfma_f32_16x16x32_bf16 v[216:219], v[104:107], v[84:87], v[216:219]
v_mfma_f32_16x16x32_bf16 v[220:223], v[108:111], v[84:87], v[220:223]
v_mfma_f32_16x16x32_bf16 v[196:199], v[108:111], v[80:83], v[196:199]
v_mfma_f32_16x16x32_bf16 v[172:175], v[108:111], v[76:79], v[172:175]
v_mfma_f32_16x16x32_bf16 v[148:151], v[108:111], v[72:75], v[148:151]
s_waitcnt lgkmcnt(0)
v_mfma_f32_16x16x32_bf16 v[128:131], v[48:51], v[32:35], v[128:131]
ds_read_b128 v[72:75], v10 offset:8192
v_mfma_f32_16x16x32_bf16 v[152:155], v[48:51], v[36:39], v[152:155]
ds_read_b64_tr_b16 v[88:89], v17 offset:6144
v_mfma_f32_16x16x32_bf16 v[176:179], v[48:51], v[40:43], v[176:179]
ds_read_b64_tr_b16 v[90:91], v17 offset:9216
v_mfma_f32_16x16x32_bf16 v[200:203], v[48:51], v[44:47], v[200:203]
ds_read_b64_tr_b16 v[92:93], v18 offset:6144
v_mfma_f32_16x16x32_bf16 v[204:207], v[52:55], v[44:47], v[204:207]
ds_read_b64_tr_b16 v[94:95], v18 offset:9216
v_mfma_f32_16x16x32_bf16 v[180:183], v[52:55], v[40:43], v[180:183]
ds_read_b64_tr_b16 v[96:97], v19 offset:6144
v_mfma_f32_16x16x32_bf16 v[156:159], v[52:55], v[36:39], v[156:159]
ds_read_b64_tr_b16 v[98:99], v19 offset:9216
v_mfma_f32_16x16x32_bf16 v[132:135], v[52:55], v[32:35], v[132:135]
ds_read_b64_tr_b16 v[100:101], v17 offset:18432
v_mfma_f32_16x16x32_bf16 v[136:139], v[56:59], v[32:35], v[136:139]
ds_read_b64_tr_b16 v[102:103], v17 offset:21504
v_mfma_f32_16x16x32_bf16 v[160:163], v[56:59], v[36:39], v[160:163]
ds_read_b64_tr_b16 v[104:105], v18 offset:18432
v_mfma_f32_16x16x32_bf16 v[184:187], v[56:59], v[40:43], v[184:187]
ds_read_b64_tr_b16 v[106:107], v18 offset:21504
v_mfma_f32_16x16x32_bf16 v[208:211], v[56:59], v[44:47], v[208:211]
ds_read_b64_tr_b16 v[108:109], v19 offset:18432
v_mfma_f32_16x16x32_bf16 v[212:215], v[60:63], v[44:47], v[212:215]
ds_read_b64_tr_b16 v[110:111], v19 offset:21504
v_mfma_f32_16x16x32_bf16 v[188:191], v[60:63], v[40:43], v[188:191]
ds_read_b128 v[76:79], v10 offset:9216
v_mfma_f32_16x16x32_bf16 v[164:167], v[60:63], v[36:39], v[164:167]
ds_read_b128 v[80:83], v10 offset:10240
v_mfma_f32_16x16x32_bf16 v[140:143], v[60:63], v[32:35], v[140:143]
ds_read_b128 v[84:87], v10 offset:11264
v_mfma_f32_16x16x32_bf16 v[144:147], v[64:67], v[32:35], v[144:147]
v_mfma_f32_16x16x32_bf16 v[168:171], v[64:67], v[36:39], v[168:171]
v_mfma_f32_16x16x32_bf16 v[192:195], v[64:67], v[40:43], v[192:195]
v_mfma_f32_16x16x32_bf16 v[216:219], v[64:67], v[44:47], v[216:219]
v_mfma_f32_16x16x32_bf16 v[220:223], v[68:71], v[44:47], v[220:223]
v_mfma_f32_16x16x32_bf16 v[196:199], v[68:71], v[40:43], v[196:199]
v_mfma_f32_16x16x32_bf16 v[172:175], v[68:71], v[36:39], v[172:175]
v_mfma_f32_16x16x32_bf16 v[148:151], v[68:71], v[32:35], v[148:151]
s_waitcnt lgkmcnt(0)
s_barrier
v_mfma_f32_16x16x32_bf16 v[128:131], v[88:91], v[72:75], v[128:131]
ds_read_b128 v[32:35], v9 offset:0
v_mfma_f32_16x16x32_bf16 v[152:155], v[88:91], v[76:79], v[152:155]
ds_read_b64_tr_b16 v[48:49], v11 offset:0
v_mfma_f32_16x16x32_bf16 v[176:179], v[88:91], v[80:83], v[176:179]
ds_read_b64_tr_b16 v[50:51], v11 offset:3072
v_mfma_f32_16x16x32_bf16 v[200:203], v[88:91], v[84:87], v[200:203]
ds_read_b64_tr_b16 v[52:53], v12 offset:0
v_mfma_f32_16x16x32_bf16 v[204:207], v[92:95], v[84:87], v[204:207]
ds_read_b64_tr_b16 v[54:55], v12 offset:3072
v_mfma_f32_16x16x32_bf16 v[180:183], v[92:95], v[80:83], v[180:183]
ds_read_b64_tr_b16 v[56:57], v13 offset:0
v_mfma_f32_16x16x32_bf16 v[156:159], v[92:95], v[76:79], v[156:159]
ds_read_b64_tr_b16 v[58:59], v13 offset:3072
v_mfma_f32_16x16x32_bf16 v[132:135], v[92:95], v[72:75], v[132:135]
ds_read_b64_tr_b16 v[60:61], v11 offset:12288
v_mfma_f32_16x16x32_bf16 v[136:139], v[96:99], v[72:75], v[136:139]
ds_read_b64_tr_b16 v[62:63], v11 offset:15360
v_mfma_f32_16x16x32_bf16 v[160:163], v[96:99], v[76:79], v[160:163]
ds_read_b64_tr_b16 v[64:65], v12 offset:12288
v_mfma_f32_16x16x32_bf16 v[184:187], v[96:99], v[80:83], v[184:187]
ds_read_b64_tr_b16 v[66:67], v12 offset:15360
v_mfma_f32_16x16x32_bf16 v[208:211], v[96:99], v[84:87], v[208:211]
ds_read_b64_tr_b16 v[68:69], v13 offset:12288
v_mfma_f32_16x16x32_bf16 v[212:215], v[100:103], v[84:87], v[212:215]
ds_read_b64_tr_b16 v[70:71], v13 offset:15360
v_mfma_f32_16x16x32_bf16 v[188:191], v[100:103], v[80:83], v[188:191]
ds_read_b128 v[36:39], v9 offset:1024
v_mfma_f32_16x16x32_bf16 v[164:167], v[100:103], v[76:79], v[164:167]
ds_read_b128 v[40:43], v9 offset:2048
v_mfma_f32_16x16x32_bf16 v[140:143], v[100:103], v[72:75], v[140:143]
ds_read_b128 v[44:47], v9 offset:3072
v_mfma_f32_16x16x32_bf16 v[144:147], v[104:107], v[72:75], v[144:147]
v_mfma_f32_16x16x32_bf16 v[168:171], v[104:107], v[76:79], v[168:171]
v_mfma_f32_16x16x32_bf16 v[192:195], v[104:107], v[80:83], v[192:195]
v_mfma_f32_16x16x32_bf16 v[216:219], v[104:107], v[84:87], v[216:219]
v_mfma_f32_16x16x32_bf16 v[220:223], v[108:111], v[84:87], v[220:223]
v_mfma_f32_16x16x32_bf16 v[196:199], v[108:111], v[80:83], v[196:199]
v_mfma_f32_16x16x32_bf16 v[172:175], v[108:111], v[76:79], v[172:175]
v_mfma_f32_16x16x32_bf16 v[148:151], v[108:111], v[72:75], v[148:151]
s_waitcnt lgkmcnt(0)
v_mfma_f32_16x16x32_bf16 v[128:131], v[48:51], v[32:35], v[128:131]
ds_read_b128 v[72:75], v9 offset:8192
v_mfma_f32_16x16x32_bf16 v[152:155], v[48:51], v[36:39], v[152:155]
ds_read_b64_tr_b16 v[88:89], v11 offset:6144
v_mfma_f32_16x16x32_bf16 v[176:179], v[48:51], v[40:43], v[176:179]
ds_read_b64_tr_b16 v[90:91], v11 offset:9216
v_mfma_f32_16x16x32_bf16 v[200:203], v[48:51], v[44:47], v[200:203]
ds_read_b64_tr_b16 v[92:93], v12 offset:6144
v_mfma_f32_16x16x32_bf16 v[204:207], v[52:55], v[44:47], v[204:207]
ds_read_b64_tr_b16 v[94:95], v12 offset:9216
v_mfma_f32_16x16x32_bf16 v[180:183], v[52:55], v[40:43], v[180:183]
ds_read_b64_tr_b16 v[96:97], v13 offset:6144
v_mfma_f32_16x16x32_bf16 v[156:159], v[52:55], v[36:39], v[156:159]
ds_read_b64_tr_b16 v[98:99], v13 offset:9216
v_mfma_f32_16x16x32_bf16 v[132:135], v[52:55], v[32:35], v[132:135]
ds_read_b64_tr_b16 v[100:101], v11 offset:18432
v_mfma_f32_16x16x32_bf16 v[136:139], v[56:59], v[32:35], v[136:139]
ds_read_b64_tr_b16 v[102:103], v11 offset:21504
v_mfma_f32_16x16x32_bf16 v[160:163], v[56:59], v[36:39], v[160:163]
ds_read_b64_tr_b16 v[104:105], v12 offset:18432
v_mfma_f32_16x16x32_bf16 v[184:187], v[56:59], v[40:43], v[184:187]
ds_read_b64_tr_b16 v[106:107], v12 offset:21504
v_mfma_f32_16x16x32_bf16 v[208:211], v[56:59], v[44:47], v[208:211]
ds_read_b64_tr_b16 v[108:109], v13 offset:18432
v_mfma_f32_16x16x32_bf16 v[212:215], v[60:63], v[44:47], v[212:215]
ds_read_b64_tr_b16 v[110:111], v13 offset:21504
v_mfma_f32_16x16x32_bf16 v[188:191], v[60:63], v[40:43], v[188:191]
ds_read_b128 v[76:79], v9 offset:9216
v_mfma_f32_16x16x32_bf16 v[164:167], v[60:63], v[36:39], v[164:167]
ds_read_b128 v[80:83], v9 offset:10240
v_mfma_f32_16x16x32_bf16 v[140:143], v[60:63], v[32:35], v[140:143]
ds_read_b128 v[84:87], v9 offset:11264
v_mfma_f32_16x16x32_bf16 v[144:147], v[64:67], v[32:35], v[144:147]
v_mfma_f32_16x16x32_bf16 v[168:171], v[64:67], v[36:39], v[168:171]
v_mfma_f32_16x16x32_bf16 v[192:195], v[64:67], v[40:43], v[192:195]
v_mfma_f32_16x16x32_bf16 v[216:219], v[64:67], v[44:47], v[216:219]
v_mfma_f32_16x16x32_bf16 v[220:223], v[68:71], v[44:47], v[220:223]
v_mfma_f32_16x16x32_bf16 v[196:199], v[68:71], v[40:43], v[196:199]
v_mfma_f32_16x16x32_bf16 v[172:175], v[68:71], v[36:39], v[172:175]
v_mfma_f32_16x16x32_bf16 v[148:151], v[68:71], v[32:35], v[148:151]
s_waitcnt lgkmcnt(0)
s_barrier
v_mfma_f32_16x16x32_bf16 v[128:131], v[88:91], v[72:75], v[128:131]
ds_read_b128 v[32:35], v9 offset:49152
v_mfma_f32_16x16x32_bf16 v[152:155], v[88:91], v[76:79], v[152:155]
ds_read_b64_tr_b16 v[48:49], v14 offset:0
v_mfma_f32_16x16x32_bf16 v[176:179], v[88:91], v[80:83], v[176:179]
ds_read_b64_tr_b16 v[50:51], v14 offset:3072
v_mfma_f32_16x16x32_bf16 v[200:203], v[88:91], v[84:87], v[200:203]
ds_read_b64_tr_b16 v[52:53], v15 offset:0
v_mfma_f32_16x16x32_bf16 v[204:207], v[92:95], v[84:87], v[204:207]
ds_read_b64_tr_b16 v[54:55], v15 offset:3072
v_mfma_f32_16x16x32_bf16 v[180:183], v[92:95], v[80:83], v[180:183]
ds_read_b64_tr_b16 v[56:57], v16 offset:0
v_mfma_f32_16x16x32_bf16 v[156:159], v[92:95], v[76:79], v[156:159]
ds_read_b64_tr_b16 v[58:59], v16 offset:3072
v_mfma_f32_16x16x32_bf16 v[132:135], v[92:95], v[72:75], v[132:135]
ds_read_b64_tr_b16 v[60:61], v14 offset:12288
v_mfma_f32_16x16x32_bf16 v[136:139], v[96:99], v[72:75], v[136:139]
ds_read_b64_tr_b16 v[62:63], v14 offset:15360
v_mfma_f32_16x16x32_bf16 v[160:163], v[96:99], v[76:79], v[160:163]
ds_read_b64_tr_b16 v[64:65], v15 offset:12288
v_mfma_f32_16x16x32_bf16 v[184:187], v[96:99], v[80:83], v[184:187]
ds_read_b64_tr_b16 v[66:67], v15 offset:15360
v_mfma_f32_16x16x32_bf16 v[208:211], v[96:99], v[84:87], v[208:211]
ds_read_b64_tr_b16 v[68:69], v16 offset:12288
v_mfma_f32_16x16x32_bf16 v[212:215], v[100:103], v[84:87], v[212:215]
ds_read_b64_tr_b16 v[70:71], v16 offset:15360
v_mfma_f32_16x16x32_bf16 v[188:191], v[100:103], v[80:83], v[188:191]
ds_read_b128 v[36:39], v9 offset:50176
v_mfma_f32_16x16x32_bf16 v[164:167], v[100:103], v[76:79], v[164:167]
ds_read_b128 v[40:43], v9 offset:51200
v_mfma_f32_16x16x32_bf16 v[140:143], v[100:103], v[72:75], v[140:143]
ds_read_b128 v[44:47], v9 offset:52224
v_mfma_f32_16x16x32_bf16 v[144:147], v[104:107], v[72:75], v[144:147]
v_mfma_f32_16x16x32_bf16 v[168:171], v[104:107], v[76:79], v[168:171]
v_mfma_f32_16x16x32_bf16 v[192:195], v[104:107], v[80:83], v[192:195]
v_mfma_f32_16x16x32_bf16 v[216:219], v[104:107], v[84:87], v[216:219]
v_mfma_f32_16x16x32_bf16 v[220:223], v[108:111], v[84:87], v[220:223]
v_mfma_f32_16x16x32_bf16 v[196:199], v[108:111], v[80:83], v[196:199]
v_mfma_f32_16x16x32_bf16 v[172:175], v[108:111], v[76:79], v[172:175]
v_mfma_f32_16x16x32_bf16 v[148:151], v[108:111], v[72:75], v[148:151]
s_sub_u32 s41, s41, 1
s_cmp_lg_u32 s41, 0
s_cbranch_scc1 Lk3l_118
s_waitcnt lgkmcnt(0)
s_add_u32 s38, s35, 15
s_and_b32 s38, s38, 15
s_mul_i32 s38, s38, 458752
s_add_u32 m0, s40, 0
s_nop 0
buffer_load_dwordx4 v4, s[12:15], s38 offen lds
v_lshrrev_b32 v86, 4, v1
s_lshl_b32 s43, s63, 7
s_add_u32 s43, s43, 148992
v_lshl_add_u32 v87, v86, 4, s43
v_lshrrev_b32 v88, 1, v86
s_branch Lov_8
.p2align 12
.fill 64, 4, 0xbf800000
Lst_8_0:
s_branch Lwr_163
Lst_8_1:
s_branch Lwr_170
s_nop 0
Lov_8:
v_and_b32 v86, 1, v86
s_add_u32 m0, s40, 1024
s_nop 0
buffer_load_dwordx4 v5, s[12:15], s38 offen lds
s_lshl_b32 s43, s63, 5
s_add_u32 s43, s43, 149248
v_lshl_add_u32 v88, v88, 6, s43
v_lshl_add_u32 v88, v86, 4, v88
v_and_b32 v86, 15, v1
s_lshl_b32 s43, s62, 9
s_add_u32 m0, s40, 2048
s_add_u32 s38, s38, 57344
buffer_load_dwordx4 v4, s[12:15], s38 offen lds
s_add_u32 s43, s43, 147456
v_lshl_add_u32 v86, v86, 3, s43
ds_read_b128 v[32:35], v87 offset:0
ds_read_b128 v[36:39], v87 offset:64
ds_read_b128 v[40:43], v88 offset:0
ds_read_b128 v[44:47], v87 offset:896
s_add_u32 m0, s40, 3072
s_nop 0
buffer_load_dwordx4 v5, s[12:15], s38 offen lds
ds_read_b128 v[48:51], v87 offset:960
ds_read_b128 v[52:55], v88 offset:896
ds_read_b64 v[56:57], v86 offset:0
ds_read_b64 v[58:59], v86 offset:128
ds_read_b64 v[60:61], v86 offset:256
ds_read_b64 v[62:63], v86 offset:384
s_add_u32 m0, s40, 4096
s_add_u32 s38, s38, 57344
buffer_load_dwordx4 v4, s[12:15], s38 offen lds
s_mul_i32 s54, s35, 24576
s_lshl_b32 s43, s62, 12
s_add_u32 s54, s54, s43
s_add_u32 s54, s54, 524288
s_lshl_b32 s43, s63, 9
s_add_u32 s55, s54, s43
s_add_u32 m0, s40, 5120
s_nop 0
buffer_load_dwordx4 v5, s[12:15], s38 offen lds
s_add_u32 s55, s55, 16384
s_lshl_b32 s43, s63, 13
s_add_u32 s54, s54, s43
v_and_b32 v84, 32, v1
v_lshlrev_b32 v84, 4, v84
v_add_u32 v84, v84, v2
s_waitcnt lgkmcnt(0)
s_add_u32 m0, s40, 6144
s_add_u32 s38, s38, 57344
buffer_load_dwordx4 v4, s[12:15], s38 offen lds
s_add_u32 m0, s40, 7168
s_nop 0
buffer_load_dwordx4 v5, s[12:15], s38 offen lds
s_and_b32 s44, s36, 3
s_mul_i32 s43, s2, 28672
s_mul_i32 s44, s44, 7168
s_add_u32 s43, s43, s44
s_add_u32 s4, s76, s43
s_addc_u32 s5, s77, 0
s_barrier
s_cmp_eq_u32 s47, 3
s_cbranch_scc0 Lw_119
v_and_b32 v90, 31, v1
v_lshlrev_b32 v90, 4, v90
v_add_u32 v91, 153600, v90
ds_read_b128 v[108:111], v91 offset:0
ds_read_b128 v[112:115], v91 offset:512
ds_read_b128 v[116:119], v91 offset:1024
ds_read_b128 v[120:123], v91 offset:1536
s_and_b32 s44, s2, 15
s_mul_i32 s44, s44, 14336
s_lshr_b32 s43, s2, 4
s_lshl_b32 s43, s43, 9
s_add_u32 s44, s44, s43
s_waitcnt lgkmcnt(0)
v_add_f32 v108, v108, v112
v_add_f32 v116, v116, v120
v_add_f32 v109, v109, v113
v_add_f32 v117, v117, v121
v_add_f32 v110, v110, v114
v_add_f32 v118, v118, v122
v_add_f32 v111, v111, v115
v_add_f32 v119, v119, v123
v_add_f32 v108, v108, v116
v_add_f32 v109, v109, v117
v_add_f32 v110, v110, v118
v_add_f32 v111, v111, v119
s_mov_b64 exec, 0xffffffff
buffer_store_dwordx4 v[108:111], v90, s[84:87], s44 offen sc1
s_mov_b64 exec, -1
Lw_119:
s_waitcnt lgkmcnt(0)
s_add_u32 s37, s35, 0
s_and_b32 s37, s37, 15
s_mul_i32 s37, s37, 16384
s_add_u32 m0, s39, 49152
s_nop 0
buffer_load_dwordx4 v3, s[8:11], s37 offen sc1 lds
s_load_dword s3, s[4:5], 1792
s_load_dword s3, s[4:5], 1856
s_load_dword s3, s[4:5], 1920
s_load_dword s3, s[4:5], 1984
s_load_dword s3, s[4:5], 2048
s_load_dword s3, s[4:5], 2112
s_load_dword s3, s[4:5], 2176
buffer_load_dwordx4 v3, s[8:11], s37 offen offset:1024 sc1 lds
s_load_dword s3, s[4:5], 2240
s_load_dword s3, s[4:5], 2304
s_load_dword s3, s[4:5], 2368
s_load_dword s3, s[4:5], 2432
s_load_dword s3, s[4:5], 2496
s_load_dword s3, s[4:5], 2560
s_load_dword s3, s[4:5], 2624
buffer_load_dwordx4 v3, s[8:11], s37 offen offset:2048 sc1 lds
v_mul_f32 v66, v57, v57
v_mul_f32 v64, 0xc0135761, v57
v_mul_f32 v65, 0xbdd2d3e8, v57
v_mul_f32 v65, v65, v66
v_rcp_f32 v66, v66
v_mul_f32 v70, v59, v59
v_mul_f32 v68, 0xc0135761, v59
buffer_load_dwordx4 v3, s[8:11], s37 offen offset:3072 sc1 lds
v_mul_f32 v69, 0xbdd2d3e8, v59
v_mul_f32 v69, v69, v70
v_rcp_f32 v70, v70
v_fma_f32 v128, -v56, v32, v128
v_fma_f32 v129, -v56, v33, v129
v_fma_f32 v130, -v56, v34, v130
v_fma_f32 v131, -v56, v35, v131
v_fma_f32 v152, -v58, v32, v152
s_add_u32 s38, s35, 0
s_and_b32 s38, s38, 15
s_mul_i32 s38, s38, 458752
s_add_u32 m0, s40, 49152
s_nop 0
buffer_load_dwordx4 v4, s[12:15], s38 offen lds
v_fma_f32 v153, -v58, v33, v153
v_fma_f32 v154, -v58, v34, v154
v_fma_f32 v155, -v58, v35, v155
v_mul_f32 v72, v128, v128
v_mul_f32 v73, v129, v129
v_mul_f32 v74, v130, v130
v_mul_f32 v75, v131, v131
s_add_u32 m0, s40, 50176
s_nop 0
buffer_load_dwordx4 v5, s[12:15], s38 offen lds
v_mul_f32 v76, v152, v152
v_mul_f32 v77, v153, v153
v_mul_f32 v78, v154, v154
v_mul_f32 v79, v155, v155
v_fma_f32 v72, v72, v65, v64
v_fma_f32 v73, v73, v65, v64
v_fma_f32 v74, v74, v65, v64
s_add_u32 m0, s40, 51200
s_add_u32 s38, s38, 57344
buffer_load_dwordx4 v4, s[12:15], s38 offen lds
v_fma_f32 v75, v75, v65, v64
v_fma_f32 v76, v76, v69, v68
v_fma_f32 v77, v77, v69, v68
v_fma_f32 v78, v78, v69, v68
v_fma_f32 v79, v79, v69, v68
v_mul_f32 v72, v72, v128
v_mul_f32 v73, v73, v129
v_mul_f32 v74, v74, v130
s_add_u32 m0, s40, 52224
s_nop 0
buffer_load_dwordx4 v5, s[12:15], s38 offen lds
v_mul_f32 v75, v75, v131
v_mul_f32 v76, v76, v152
v_mul_f32 v77, v77, v153
v_mul_f32 v78, v78, v154
v_mul_f32 v79, v79, v155
v_exp_f32 v72, v72
v_exp_f32 v73, v73
s_add_u32 m0, s40, 53248
s_add_u32 s38, s38, 57344
buffer_load_dwordx4 v4, s[12:15], s38 offen lds
v_exp_f32 v74, v74
v_exp_f32 v75, v75
v_exp_f32 v76, v76
v_exp_f32 v77, v77
v_exp_f32 v78, v78
v_exp_f32 v79, v79
v_fma_f32 v140, -v56, v44, v140
s_add_u32 m0, s40, 54272
s_nop 0
buffer_load_dwordx4 v5, s[12:15], s38 offen lds
v_fma_f32 v141, -v56, v45, v141
v_fma_f32 v142, -v56, v46, v142
v_fma_f32 v143, -v56, v47, v143
v_fma_f32 v164, -v58, v44, v164
v_fma_f32 v165, -v58, v45, v165
v_fma_f32 v166, -v58, v46, v166
v_fma_f32 v167, -v58, v47, v167
v_fma_f32 v72, v72, v66, v66
s_add_u32 m0, s40, 55296
s_add_u32 s38, s38, 57344
buffer_load_dwordx4 v4, s[12:15], s38 offen lds
s_add_u32 m0, s40, 56320
s_nop 0
buffer_load_dwordx4 v5, s[12:15], s38 offen lds
s_waitcnt vmcnt(12)
s_barrier
s_add_u32 s37, s35, 1
s_and_b32 s37, s37, 15
s_mul_i32 s37, s37, 16384
s_add_u32 m0, s39, 98304
s_nop 0
buffer_load_dwordx4 v3, s[8:11], s37 offen sc1 lds
v_fma_f32 v73, v73, v66, v66
v_fma_f32 v74, v74, v66, v66
v_fma_f32 v75, v75, v66, v66
v_fma_f32 v76, v76, v70, v70
v_fma_f32 v77, v77, v70, v70
v_fma_f32 v78, v78, v70, v70
buffer_load_dwordx4 v3, s[8:11], s37 offen offset:1024 sc1 lds
v_fma_f32 v79, v79, v70, v70
v_rcp_f32 v72, v72
v_rcp_f32 v73, v73
v_rcp_f32 v74, v74
v_rcp_f32 v75, v75
v_rcp_f32 v76, v76
buffer_load_dwordx4 v3, s[8:11], s37 offen offset:2048 sc1 lds
v_rcp_f32 v77, v77
v_rcp_f32 v78, v78
v_rcp_f32 v79, v79
v_mul_f32 v140, v128, v140
v_mul_f32 v141, v129, v141
v_mul_f32 v142, v130, v142
buffer_load_dwordx4 v3, s[8:11], s37 offen offset:3072 sc1 lds
v_mul_f32 v143, v131, v143
v_mul_f32 v164, v152, v164
v_mul_f32 v165, v153, v165
v_mul_f32 v166, v154, v166
v_mul_f32 v167, v155, v167
v_mul_f32 v140, v140, v72
s_add_u32 s38, s35, 1
s_and_b32 s38, s38, 15
s_mul_i32 s38, s38, 458752
s_add_u32 m0, s40, 98304
s_nop 0
buffer_load_dwordx4 v4, s[12:15], s38 offen lds
v_mul_f32 v141, v141, v73
v_mul_f32 v142, v142, v74
v_mul_f32 v143, v143, v75
v_mul_f32 v164, v164, v76
v_mul_f32 v165, v165, v77
v_mul_f32 v166, v166, v78
s_add_u32 m0, s40, 99328
s_nop 0
buffer_load_dwordx4 v5, s[12:15], s38 offen lds
v_mul_f32 v167, v167, v79
v_cvt_pk_bf16_f32 v128, v140, v141
v_cvt_pk_bf16_f32 v129, v142, v143
v_cvt_pk_bf16_f32 v152, v164, v165
v_cvt_pk_bf16_f32 v153, v166, v167
v_fma_f32 v132, -v56, v36, v132
s_add_u32 m0, s40, 100352
s_add_u32 s38, s38, 57344
buffer_load_dwordx4 v4, s[12:15], s38 offen lds
v_fma_f32 v133, -v56, v37, v133
v_fma_f32 v134, -v56, v38, v134
v_fma_f32 v135, -v56, v39, v135
v_fma_f32 v156, -v58, v36, v156
v_fma_f32 v157, -v58, v37, v157
v_fma_f32 v158, -v58, v38, v158
s_add_u32 m0, s40, 101376
s_nop 0
buffer_load_dwordx4 v5, s[12:15], s38 offen lds
v_fma_f32 v159, -v58, v39, v159
v_mul_f32 v72, v132, v132
v_mul_f32 v73, v133, v133
v_mul_f32 v74, v134, v134
v_mul_f32 v75, v135, v135
v_mul_f32 v76, v156, v156
s_add_u32 m0, s40, 102400
s_add_u32 s38, s38, 57344
buffer_load_dwordx4 v4, s[12:15], s38 offen lds
v_mul_f32 v77, v157, v157
v_mul_f32 v78, v158, v158
v_mul_f32 v79, v159, v159
v_fma_f32 v72, v72, v65, v64
v_fma_f32 v73, v73, v65, v64
v_fma_f32 v74, v74, v65, v64
s_add_u32 m0, s40, 103424
s_nop 0
buffer_load_dwordx4 v5, s[12:15], s38 offen lds
v_fma_f32 v75, v75, v65, v64
v_fma_f32 v76, v76, v69, v68
v_fma_f32 v77, v77, v69, v68
v_fma_f32 v78, v78, v69, v68
v_fma_f32 v79, v79, v69, v68
v_mul_f32 v72, v72, v132
s_add_u32 m0, s40, 104448
s_add_u32 s38, s38, 57344
buffer_load_dwordx4 v4, s[12:15], s38 offen lds
s_add_u32 m0, s40, 105472
s_nop 0
buffer_load_dwordx4 v5, s[12:15], s38 offen lds
s_waitcnt vmcnt(12)
s_barrier
s_cmp_eq_u32 s47, 3
s_cbranch_scc0 Lw_120
s_lshr_b32 s43, s2, 4
s_add_u32 s43, s43, 80
s_lshl_b32 s43, s43, 7
v_mov_b32 v90, s43
v_mov_b32 v91, 1
s_mov_b64 exec, 1
buffer_atomic_add v91, v90, s[56:59], 0 offen sc1
s_mov_b64 exec, -1
Lw_120:
s_waitcnt lgkmcnt(0)
s_add_u32 s37, s35, 2
s_and_b32 s37, s37, 15
s_mul_i32 s37, s37, 16384
s_add_u32 m0, s39, 0
s_nop 0
buffer_load_dwordx4 v3, s[8:11], s37 offen sc1 lds
s_load_dword s3, s[4:5], 2688
s_load_dword s3, s[4:5], 2752
s_load_dword s3, s[4:5], 2816
s_load_dword s3, s[4:5], 2880
s_load_dword s3, s[4:5], 2944
s_load_dword s3, s[4:5], 3008
s_load_dword s3, s[4:5], 3072
buffer_load_dwordx4 v3, s[8:11], s37 offen offset:1024 sc1 lds
s_load_dword s3, s[4:5], 3136
s_load_dword s3, s[4:5], 3200
s_load_dword s3, s[4:5], 3264
s_load_dword s3, s[4:5], 3328
s_load_dword s3, s[4:5], 3392
s_load_dword s3, s[4:5], 3456
s_load_dword s3, s[4:5], 3520
buffer_load_dwordx4 v3, s[8:11], s37 offen offset:2048 sc1 lds
v_mul_f32 v73, v73, v133
v_mul_f32 v74, v74, v134
v_mul_f32 v75, v75, v135
v_mul_f32 v76, v76, v156
v_mul_f32 v77, v77, v157
v_mul_f32 v78, v78, v158
v_mul_f32 v79, v79, v159
v_exp_f32 v72, v72
buffer_load_dwordx4 v3, s[8:11], s37 offen offset:3072 sc1 lds
v_exp_f32 v73, v73
v_exp_f32 v74, v74
v_exp_f32 v75, v75
v_exp_f32 v76, v76
v_exp_f32 v77, v77
v_exp_f32 v78, v78
v_exp_f32 v79, v79
s_add_u32 s38, s35, 2
s_and_b32 s38, s38, 15
s_mul_i32 s38, s38, 458752
s_add_u32 m0, s40, 0
s_nop 0
buffer_load_dwordx4 v4, s[12:15], s38 offen lds
v_fma_f32 v144, -v56, v48, v144
v_fma_f32 v145, -v56, v49, v145
v_fma_f32 v146, -v56, v50, v146
v_fma_f32 v147, -v56, v51, v147
v_fma_f32 v168, -v58, v48, v168
v_fma_f32 v169, -v58, v49, v169
v_fma_f32 v170, -v58, v50, v170
v_fma_f32 v171, -v58, v51, v171
s_add_u32 m0, s40, 1024
s_nop 0
buffer_load_dwordx4 v5, s[12:15], s38 offen lds
v_fma_f32 v72, v72, v66, v66
v_fma_f32 v73, v73, v66, v66
v_fma_f32 v74, v74, v66, v66
v_fma_f32 v75, v75, v66, v66
v_fma_f32 v76, v76, v70, v70
v_fma_f32 v77, v77, v70, v70
v_fma_f32 v78, v78, v70, v70
s_add_u32 m0, s40, 2048
s_add_u32 s38, s38, 57344
buffer_load_dwordx4 v4, s[12:15], s38 offen lds
v_fma_f32 v79, v79, v70, v70
v_rcp_f32 v72, v72
v_rcp_f32 v73, v73
v_rcp_f32 v74, v74
v_rcp_f32 v75, v75
v_rcp_f32 v76, v76
v_rcp_f32 v77, v77
s_add_u32 m0, s40, 3072
s_nop 0
buffer_load_dwordx4 v5, s[12:15], s38 offen lds
v_rcp_f32 v78, v78
v_rcp_f32 v79, v79
v_mul_f32 v144, v132, v144
v_mul_f32 v145, v133, v145
v_mul_f32 v146, v134, v146
v_mul_f32 v147, v135, v147
v_mul_f32 v168, v156, v168
v_mul_f32 v169, v157, v169
s_add_u32 m0, s40, 4096
s_add_u32 s38, s38, 57344
buffer_load_dwordx4 v4, s[12:15], s38 offen lds
v_mul_f32 v170, v158, v170
v_mul_f32 v171, v159, v171
v_mul_f32 v144, v144, v72
v_mul_f32 v145, v145, v73
v_mul_f32 v146, v146, v74
v_mul_f32 v147, v147, v75
v_mul_f32 v168, v168, v76
s_add_u32 m0, s40, 5120
s_nop 0
buffer_load_dwordx4 v5, s[12:15], s38 offen lds
v_mul_f32 v169, v169, v77
v_mul_f32 v170, v170, v78
v_mul_f32 v171, v171, v79
v_cvt_pk_bf16_f32 v130, v144, v145
v_cvt_pk_bf16_f32 v131, v146, v147
v_cvt_pk_bf16_f32 v154, v168, v169
v_cvt_pk_bf16_f32 v155, v170, v171
buffer_store_dwordx4 v[128:131], v2, s[24:27], s54 offen offset:0 sc1
s_add_u32 m0, s40, 6144
s_add_u32 s38, s38, 57344
buffer_load_dwordx4 v4, s[12:15], s38 offen lds
s_add_u32 m0, s40, 7168
s_nop 0
buffer_load_dwordx4 v5, s[12:15], s38 offen lds
s_waitcnt vmcnt(13)
s_barrier
s_add_u32 s37, s35, 3
s_and_b32 s37, s37, 15
s_mul_i32 s37, s37, 16384
s_add_u32 m0, s39, 49152
s_nop 0
buffer_load_dwordx4 v3, s[8:11], s37 offen sc1 lds
buffer_store_dwordx4 v[152:155], v2, s[24:27], s54 offen offset:1024 sc1
v_fma_f32 v136, -v56, v40, v136
v_fma_f32 v137, -v56, v41, v137
v_fma_f32 v138, -v56, v42, v138
v_fma_f32 v139, -v56, v43, v139
v_fma_f32 v160, -v58, v40, v160
buffer_load_dwordx4 v3, s[8:11], s37 offen offset:1024 sc1 lds
v_fma_f32 v161, -v58, v41, v161
v_fma_f32 v162, -v58, v42, v162
v_fma_f32 v163, -v58, v43, v163
v_mul_f32 v72, v136, v136
v_mul_f32 v73, v137, v137
v_mul_f32 v74, v138, v138
buffer_load_dwordx4 v3, s[8:11], s37 offen offset:2048 sc1 lds
v_mul_f32 v75, v139, v139
v_mul_f32 v76, v160, v160
v_mul_f32 v77, v161, v161
v_mul_f32 v78, v162, v162
v_mul_f32 v79, v163, v163
v_fma_f32 v72, v72, v65, v64
buffer_load_dwordx4 v3, s[8:11], s37 offen offset:3072 sc1 lds
v_fma_f32 v73, v73, v65, v64
v_fma_f32 v74, v74, v65, v64
v_fma_f32 v75, v75, v65, v64
v_fma_f32 v76, v76, v69, v68
v_fma_f32 v77, v77, v69, v68
v_fma_f32 v78, v78, v69, v68
s_add_u32 s38, s35, 3
s_and_b32 s38, s38, 15
s_mul_i32 s38, s38, 458752
s_add_u32 m0, s40, 49152
s_nop 0
buffer_load_dwordx4 v4, s[12:15], s38 offen lds
v_fma_f32 v79, v79, v69, v68
v_mul_f32 v72, v72, v136
v_mul_f32 v73, v73, v137
v_mul_f32 v74, v74, v138
v_mul_f32 v75, v75, v139
v_mul_f32 v76, v76, v160
s_add_u32 m0, s40, 50176
s_nop 0
buffer_load_dwordx4 v5, s[12:15], s38 offen lds
v_mul_f32 v77, v77, v161
v_mul_f32 v78, v78, v162
v_mul_f32 v79, v79, v163
v_exp_f32 v72, v72
v_exp_f32 v73, v73
v_exp_f32 v74, v74
s_add_u32 m0, s40, 51200
s_add_u32 s38, s38, 57344
buffer_load_dwordx4 v4, s[12:15], s38 offen lds
v_exp_f32 v75, v75
v_exp_f32 v76, v76
v_exp_f32 v77, v77
v_exp_f32 v78, v78
v_exp_f32 v79, v79
v_fma_f32 v148, -v56, v52, v148
s_add_u32 m0, s40, 52224
s_nop 0
buffer_load_dwordx4 v5, s[12:15], s38 offen lds
v_fma_f32 v149, -v56, v53, v149
v_fma_f32 v150, -v56, v54, v150
v_fma_f32 v151, -v56, v55, v151
v_fma_f32 v172, -v58, v52, v172
v_fma_f32 v173, -v58, v53, v173
v_fma_f32 v174, -v58, v54, v174
s_add_u32 m0, s40, 53248
s_add_u32 s38, s38, 57344
buffer_load_dwordx4 v4, s[12:15], s38 offen lds
v_fma_f32 v175, -v58, v55, v175
v_fma_f32 v72, v72, v66, v66
v_fma_f32 v73, v73, v66, v66
v_fma_f32 v74, v74, v66, v66
v_fma_f32 v75, v75, v66, v66
v_fma_f32 v76, v76, v70, v70
s_add_u32 m0, s40, 54272
s_nop 0
buffer_load_dwordx4 v5, s[12:15], s38 offen lds
v_fma_f32 v77, v77, v70, v70
v_fma_f32 v78, v78, v70, v70
v_fma_f32 v79, v79, v70, v70
v_rcp_f32 v72, v72
v_rcp_f32 v73, v73
v_rcp_f32 v74, v74
s_add_u32 m0, s40, 55296
s_add_u32 s38, s38, 57344
buffer_load_dwordx4 v4, s[12:15], s38 offen lds
s_add_u32 m0, s40, 56320
s_nop 0
buffer_load_dwordx4 v5, s[12:15], s38 offen lds
s_waitcnt vmcnt(13)
s_barrier
s_waitcnt lgkmcnt(0)
s_add_u32 s37, s35, 4
s_and_b32 s37, s37, 15
s_mul_i32 s37, s37, 16384
s_add_u32 m0, s39, 98304
s_nop 0
buffer_load_dwordx4 v3, s[8:11], s37 offen sc1 lds
s_load_dword s3, s[4:5], 3584
s_load_dword s3, s[4:5], 3648
s_load_dword s3, s[4:5], 3712
s_load_dword s3, s[4:5], 3776
s_load_dword s3, s[4:5], 3840
s_load_dword s3, s[4:5], 3904
s_load_dword s3, s[4:5], 3968
buffer_load_dwordx4 v3, s[8:11], s37 offen offset:1024 sc1 lds
s_load_dword s3, s[4:5], 4032
s_load_dword s3, s[4:5], 4096
s_load_dword s3, s[4:5], 4160
s_load_dword s3, s[4:5], 4224
s_load_dword s3, s[4:5], 4288
s_load_dword s3, s[4:5], 4352
s_load_dword s3, s[4:5], 4416
buffer_load_dwordx4 v3, s[8:11], s37 offen offset:2048 sc1 lds
v_rcp_f32 v75, v75
v_rcp_f32 v76, v76
v_rcp_f32 v77, v77
v_rcp_f32 v78, v78
v_rcp_f32 v79, v79
v_mul_f32 v148, v136, v148
v_mul_f32 v149, v137, v149
buffer_load_dwordx4 v3, s[8:11], s37 offen offset:3072 sc1 lds
v_mul_f32 v150, v138, v150
v_mul_f32 v151, v139, v151
v_mul_f32 v172, v160, v172
v_mul_f32 v173, v161, v173
v_mul_f32 v174, v162, v174
v_mul_f32 v175, v163, v175
v_mul_f32 v148, v148, v72
v_mul_f32 v149, v149, v73
s_add_u32 s38, s35, 4
s_and_b32 s38, s38, 15
s_mul_i32 s38, s38, 458752
s_add_u32 m0, s40, 98304
s_nop 0
buffer_load_dwordx4 v4, s[12:15], s38 offen lds
v_mul_f32 v150, v150, v74
v_mul_f32 v151, v151, v75
v_mul_f32 v172, v172, v76
v_mul_f32 v173, v173, v77
v_mul_f32 v174, v174, v78
v_mul_f32 v175, v175, v79
v_cvt_pk_bf16_f32 v80, v148, v149
s_add_u32 m0, s40, 99328
s_nop 0
buffer_load_dwordx4 v5, s[12:15], s38 offen lds
v_cvt_pk_bf16_f32 v81, v150, v151
v_cvt_pk_bf16_f32 v82, v172, v173
v_cvt_pk_bf16_f32 v83, v174, v175
s_nop 1
v_permlane32_swap_b32 v80, v82
v_permlane32_swap_b32 v81, v83
buffer_store_dwordx4 v[80:83], v84, s[24:27], s55 offen offset:0 sc1
s_add_u32 m0, s40, 100352
s_add_u32 s38, s38, 57344
buffer_load_dwordx4 v4, s[12:15], s38 offen lds
s_nop 1
v_mul_f32 v66, v61, v61
v_mul_f32 v64, 0xc0135761, v61
v_mul_f32 v65, 0xbdd2d3e8, v61
v_mul_f32 v65, v65, v66
v_rcp_f32 v66, v66
v_mul_f32 v70, v63, v63
v_mul_f32 v68, 0xc0135761, v63
s_add_u32 m0, s40, 101376
s_nop 0
buffer_load_dwordx4 v5, s[12:15], s38 offen lds
v_mul_f32 v69, 0xbdd2d3e8, v63
v_mul_f32 v69, v69, v70
v_rcp_f32 v70, v70
v_fma_f32 v176, -v60, v32, v176
v_fma_f32 v177, -v60, v33, v177
v_fma_f32 v178, -v60, v34, v178
v_fma_f32 v179, -v60, v35, v179
s_add_u32 m0, s40, 102400
s_add_u32 s38, s38, 57344
buffer_load_dwordx4 v4, s[12:15], s38 offen lds
v_fma_f32 v200, -v62, v32, v200
v_fma_f32 v201, -v62, v33, v201
v_fma_f32 v202, -v62, v34, v202
v_fma_f32 v203, -v62, v35, v203
v_mul_f32 v72, v176, v176
v_mul_f32 v73, v177, v177
v_mul_f32 v74, v178, v178
s_add_u32 m0, s40, 103424
s_nop 0
buffer_load_dwordx4 v5, s[12:15], s38 offen lds
s_branch Lov_9
.p2align 12
.fill 64, 4, 0xbf800000
Lst_9_0:
s_branch Lwr_164
Lst_9_1:
s_branch Lwr_171
s_nop 0
Lov_9:
v_mul_f32 v75, v179, v179
v_mul_f32 v76, v200, v200
v_mul_f32 v77, v201, v201
v_mul_f32 v78, v202, v202
v_mul_f32 v79, v203, v203
v_fma_f32 v72, v72, v65, v64
v_fma_f32 v73, v73, v65, v64
v_fma_f32 v74, v74, v65, v64
s_add_u32 m0, s40, 104448
s_add_u32 s38, s38, 57344
buffer_load_dwordx4 v4, s[12:15], s38 offen lds
s_add_u32 m0, s40, 105472
s_nop 0
buffer_load_dwordx4 v5, s[12:15], s38 offen lds
s_waitcnt vmcnt(13)
s_barrier
s_add_u32 s37, s35, 5
s_and_b32 s37, s37, 15
s_mul_i32 s37, s37, 16384
s_add_u32 m0, s39, 0
s_nop 0
buffer_load_dwordx4 v3, s[8:11], s37 offen sc1 lds
v_fma_f32 v75, v75, v65, v64
v_fma_f32 v76, v76, v69, v68
v_fma_f32 v77, v77, v69, v68
v_fma_f32 v78, v78, v69, v68
v_fma_f32 v79, v79, v69, v68
v_mul_f32 v72, v72, v176
buffer_load_dwordx4 v3, s[8:11], s37 offen offset:1024 sc1 lds
v_mul_f32 v73, v73, v177
v_mul_f32 v74, v74, v178
v_mul_f32 v75, v75, v179
v_mul_f32 v76, v76, v200
v_mul_f32 v77, v77, v201
v_mul_f32 v78, v78, v202
buffer_load_dwordx4 v3, s[8:11], s37 offen offset:2048 sc1 lds
v_mul_f32 v79, v79, v203
v_exp_f32 v72, v72
v_exp_f32 v73, v73
v_exp_f32 v74, v74
v_exp_f32 v75, v75
v_exp_f32 v76, v76
buffer_load_dwordx4 v3, s[8:11], s37 offen offset:3072 sc1 lds
v_exp_f32 v77, v77
v_exp_f32 v78, v78
v_exp_f32 v79, v79
v_fma_f32 v188, -v60, v44, v188
v_fma_f32 v189, -v60, v45, v189
v_fma_f32 v190, -v60, v46, v190
s_add_u32 s38, s35, 5
s_and_b32 s38, s38, 15
s_mul_i32 s38, s38, 458752
s_add_u32 m0, s40, 0
s_nop 0
buffer_load_dwordx4 v4, s[12:15], s38 offen lds
v_fma_f32 v191, -v60, v47, v191
v_fma_f32 v212, -v62, v44, v212
v_fma_f32 v213, -v62, v45, v213
v_fma_f32 v214, -v62, v46, v214
v_fma_f32 v215, -v62, v47, v215
v_fma_f32 v72, v72, v66, v66
s_add_u32 m0, s40, 1024
s_nop 0
buffer_load_dwordx4 v5, s[12:15], s38 offen lds
v_fma_f32 v73, v73, v66, v66
v_fma_f32 v74, v74, v66, v66
v_fma_f32 v75, v75, v66, v66
v_fma_f32 v76, v76, v70, v70
v_fma_f32 v77, v77, v70, v70
v_fma_f32 v78, v78, v70, v70
s_add_u32 m0, s40, 2048
s_add_u32 s38, s38, 57344
buffer_load_dwordx4 v4, s[12:15], s38 offen lds
v_fma_f32 v79, v79, v70, v70
v_rcp_f32 v72, v72
v_rcp_f32 v73, v73
v_rcp_f32 v74, v74
v_rcp_f32 v75, v75
v_rcp_f32 v76, v76
s_add_u32 m0, s40, 3072
s_nop 0
buffer_load_dwordx4 v5, s[12:15], s38 offen lds
v_rcp_f32 v77, v77
v_rcp_f32 v78, v78
v_rcp_f32 v79, v79
v_mul_f32 v188, v176, v188
v_mul_f32 v189, v177, v189
v_mul_f32 v190, v178, v190
s_add_u32 m0, s40, 4096
s_add_u32 s38, s38, 57344
buffer_load_dwordx4 v4, s[12:15], s38 offen lds
v_mul_f32 v191, v179, v191
v_mul_f32 v212, v200, v212
v_mul_f32 v213, v201, v213
v_mul_f32 v214, v202, v214
v_mul_f32 v215, v203, v215
v_mul_f32 v188, v188, v72
s_add_u32 m0, s40, 5120
s_nop 0
buffer_load_dwordx4 v5, s[12:15], s38 offen lds
v_mul_f32 v189, v189, v73
v_mul_f32 v190, v190, v74
v_mul_f32 v191, v191, v75
v_mul_f32 v212, v212, v76
v_mul_f32 v213, v213, v77
v_mul_f32 v214, v214, v78
s_add_u32 m0, s40, 6144
s_add_u32 s38, s38, 57344
buffer_load_dwordx4 v4, s[12:15], s38 offen lds
s_add_u32 m0, s40, 7168
s_nop 0
buffer_load_dwordx4 v5, s[12:15], s38 offen lds
s_waitcnt vmcnt(12)
s_barrier
s_waitcnt lgkmcnt(0)
s_cmp_eq_u32 s47, 3
s_cbranch_scc0 Lw_121
s_lshl_b32 s60, s35, 7
s_add_u32 s60, s60, 28321792
s_mov_b32 s61, s60
s_load_dword s92, s[82:83], s60 glc
s_load_dword s93, s[82:83], s61 glc
Lw_121:
s_add_u32 s37, s35, 6
s_and_b32 s37, s37, 15
s_mul_i32 s37, s37, 16384
s_add_u32 m0, s39, 49152
s_nop 0
buffer_load_dwordx4 v3, s[8:11], s37 offen sc1 lds
s_load_dword s3, s[4:5], 4480
s_load_dword s3, s[4:5], 4544
s_load_dword s3, s[4:5], 4608
s_load_dword s3, s[4:5], 4672
s_load_dword s3, s[4:5], 4736
s_load_dword s3, s[4:5], 4800
s_load_dword s3, s[4:5], 4864
buffer_load_dwordx4 v3, s[8:11], s37 offen offset:1024 sc1 lds
s_load_dword s3, s[4:5], 4928
s_load_dword s3, s[4:5], 4992
s_load_dword s3, s[4:5], 5056
s_load_dword s3, s[4:5], 5120
s_load_dword s3, s[4:5], 5184
s_load_dword s3, s[4:5], 5248
s_load_dword s3, s[4:5], 5312
buffer_load_dwordx4 v3, s[8:11], s37 offen offset:2048 sc1 lds
v_mul_f32 v215, v215, v79
v_cvt_pk_bf16_f32 v176, v188, v189
v_cvt_pk_bf16_f32 v177, v190, v191
v_cvt_pk_bf16_f32 v200, v212, v213
v_cvt_pk_bf16_f32 v201, v214, v215
v_fma_f32 v180, -v60, v36, v180
v_fma_f32 v181, -v60, v37, v181
v_fma_f32 v182, -v60, v38, v182
buffer_load_dwordx4 v3, s[8:11], s37 offen offset:3072 sc1 lds
v_fma_f32 v183, -v60, v39, v183
v_fma_f32 v204, -v62, v36, v204
v_fma_f32 v205, -v62, v37, v205
v_fma_f32 v206, -v62, v38, v206
v_fma_f32 v207, -v62, v39, v207
v_mul_f32 v72, v180, v180
v_mul_f32 v73, v181, v181
s_add_u32 s38, s35, 6
s_and_b32 s38, s38, 15
s_mul_i32 s38, s38, 458752
s_add_u32 m0, s40, 49152
s_nop 0
buffer_load_dwordx4 v4, s[12:15], s38 offen lds
v_mul_f32 v74, v182, v182
v_mul_f32 v75, v183, v183
v_mul_f32 v76, v204, v204
v_mul_f32 v77, v205, v205
v_mul_f32 v78, v206, v206
v_mul_f32 v79, v207, v207
v_fma_f32 v72, v72, v65, v64
v_fma_f32 v73, v73, v65, v64
s_add_u32 m0, s40, 50176
s_nop 0
buffer_load_dwordx4 v5, s[12:15], s38 offen lds
v_fma_f32 v74, v74, v65, v64
v_fma_f32 v75, v75, v65, v64
v_fma_f32 v76, v76, v69, v68
v_fma_f32 v77, v77, v69, v68
v_fma_f32 v78, v78, v69, v68
v_fma_f32 v79, v79, v69, v68
v_mul_f32 v72, v72, v180
s_add_u32 m0, s40, 51200
s_add_u32 s38, s38, 57344
buffer_load_dwordx4 v4, s[12:15], s38 offen lds
v_mul_f32 v73, v73, v181
v_mul_f32 v74, v74, v182
v_mul_f32 v75, v75, v183
v_mul_f32 v76, v76, v204
v_mul_f32 v77, v77, v205
v_mul_f32 v78, v78, v206
v_mul_f32 v79, v79, v207
s_add_u32 m0, s40, 52224
s_nop 0
buffer_load_dwordx4 v5, s[12:15], s38 offen lds
v_exp_f32 v72, v72
v_exp_f32 v73, v73
v_exp_f32 v74, v74
v_exp_f32 v75, v75
v_exp_f32 v76, v76
v_exp_f32 v77, v77
v_exp_f32 v78, v78
v_exp_f32 v79, v79
s_add_u32 m0, s40, 53248
s_add_u32 s38, s38, 57344
buffer_load_dwordx4 v4, s[12:15], s38 offen lds
v_fma_f32 v192, -v60, v48, v192
v_fma_f32 v193, -v60, v49, v193
v_fma_f32 v194, -v60, v50, v194
v_fma_f32 v195, -v60, v51, v195
v_fma_f32 v216, -v62, v48, v216
v_fma_f32 v217, -v62, v49, v217
v_fma_f32 v218, -v62, v50, v218
s_add_u32 m0, s40, 54272
s_nop 0
buffer_load_dwordx4 v5, s[12:15], s38 offen lds
v_fma_f32 v219, -v62, v51, v219
v_fma_f32 v72, v72, v66, v66
v_fma_f32 v73, v73, v66, v66
v_fma_f32 v74, v74, v66, v66
v_fma_f32 v75, v75, v66, v66
v_fma_f32 v76, v76, v70, v70
v_fma_f32 v77, v77, v70, v70
v_fma_f32 v78, v78, v70, v70
s_add_u32 m0, s40, 55296
s_add_u32 s38, s38, 57344
buffer_load_dwordx4 v4, s[12:15], s38 offen lds
s_add_u32 m0, s40, 56320
s_nop 0
buffer_load_dwordx4 v5, s[12:15], s38 offen lds
s_waitcnt vmcnt(12)
s_barrier
s_add_u32 s37, s35, 7
s_and_b32 s37, s37, 15
s_mul_i32 s37, s37, 16384
s_add_u32 m0, s39, 98304
s_nop 0
buffer_load_dwordx4 v3, s[8:11], s37 offen sc1 lds
v_fma_f32 v79, v79, v70, v70
v_rcp_f32 v72, v72
v_rcp_f32 v73, v73
v_rcp_f32 v74, v74
v_rcp_f32 v75, v75
v_rcp_f32 v76, v76
buffer_load_dwordx4 v3, s[8:11], s37 offen offset:1024 sc1 lds
v_rcp_f32 v77, v77
v_rcp_f32 v78, v78
v_rcp_f32 v79, v79
v_mul_f32 v192, v180, v192
v_mul_f32 v193, v181, v193
v_mul_f32 v194, v182, v194
buffer_load_dwordx4 v3, s[8:11], s37 offen offset:2048 sc1 lds
v_mul_f32 v195, v183, v195
v_mul_f32 v216, v204, v216
v_mul_f32 v217, v205, v217
v_mul_f32 v218, v206, v218
v_mul_f32 v219, v207, v219
v_mul_f32 v192, v192, v72
buffer_load_dwordx4 v3, s[8:11], s37 offen offset:3072 sc1 lds
v_mul_f32 v193, v193, v73
v_mul_f32 v194, v194, v74
v_mul_f32 v195, v195, v75
v_mul_f32 v216, v216, v76
v_mul_f32 v217, v217, v77
v_mul_f32 v218, v218, v78
s_add_u32 s38, s35, 7
s_and_b32 s38, s38, 15
s_mul_i32 s38, s38, 458752
s_add_u32 m0, s40, 98304
s_nop 0
buffer_load_dwordx4 v4, s[12:15], s38 offen lds
v_mul_f32 v219, v219, v79
v_cvt_pk_bf16_f32 v178, v192, v193
v_cvt_pk_bf16_f32 v179, v194, v195
v_cvt_pk_bf16_f32 v202, v216, v217
v_cvt_pk_bf16_f32 v203, v218, v219
buffer_store_dwordx4 v[176:179], v2, s[24:27], s54 offen offset:2048 sc1
s_add_u32 m0, s40, 99328
s_nop 0
buffer_load_dwordx4 v5, s[12:15], s38 offen lds
buffer_store_dwordx4 v[200:203], v2, s[24:27], s54 offen offset:3072 sc1
v_fma_f32 v184, -v60, v40, v184
v_fma_f32 v185, -v60, v41, v185
v_fma_f32 v186, -v60, v42, v186
v_fma_f32 v187, -v60, v43, v187
v_fma_f32 v208, -v62, v40, v208
s_add_u32 m0, s40, 100352
s_add_u32 s38, s38, 57344
buffer_load_dwordx4 v4, s[12:15], s38 offen lds
v_fma_f32 v209, -v62, v41, v209
v_fma_f32 v210, -v62, v42, v210
v_fma_f32 v211, -v62, v43, v211
v_mul_f32 v72, v184, v184
v_mul_f32 v73, v185, v185
v_mul_f32 v74, v186, v186
s_add_u32 m0, s40, 101376
s_nop 0
buffer_load_dwordx4 v5, s[12:15], s38 offen lds
v_mul_f32 v75, v187, v187
v_mul_f32 v76, v208, v208
v_mul_f32 v77, v209, v209
v_mul_f32 v78, v210, v210
v_mul_f32 v79, v211, v211
v_fma_f32 v72, v72, v65, v64
s_add_u32 m0, s40, 102400
s_add_u32 s38, s38, 57344
buffer_load_dwordx4 v4, s[12:15], s38 offen lds
v_fma_f32 v73, v73, v65, v64
v_fma_f32 v74, v74, v65, v64
v_fma_f32 v75, v75, v65, v64
v_fma_f32 v76, v76, v69, v68
v_fma_f32 v77, v77, v69, v68
v_fma_f32 v78, v78, v69, v68
s_add_u32 m0, s40, 103424
s_nop 0
buffer_load_dwordx4 v5, s[12:15], s38 offen lds
v_fma_f32 v79, v79, v69, v68
v_mul_f32 v72, v72, v184
v_mul_f32 v73, v73, v185
v_mul_f32 v74, v74, v186
v_mul_f32 v75, v75, v187
v_mul_f32 v76, v76, v208
s_add_u32 m0, s40, 104448
s_add_u32 s38, s38, 57344
buffer_load_dwordx4 v4, s[12:15], s38 offen lds
s_add_u32 m0, s40, 105472
s_nop 0
buffer_load_dwordx4 v5, s[12:15], s38 offen lds
s_waitcnt vmcnt(14)
s_cmp_eq_u32 s47, 3
s_cbranch_scc0 Lw_122
s_mov_b32 s41, 0x40000
Lcp_123:
s_waitcnt lgkmcnt(0)
s_and_b32 s92, s92, s93
s_cmp_eq_u32 s92, 16
s_cbranch_scc1 Lco_124
s_load_dword s92, s[82:83], s60 glc
s_load_dword s93, s[82:83], s61 glc
s_sub_u32 s41, s41, 1
s_cmp_lg_u32 s41, 0
s_cbranch_scc1 Lcp_123
s_waitcnt lgkmcnt(0)
Lco_124:
Lw_122:
s_barrier
s_lshl_b32 s60, s35, 9
s_lshl_b32 s43, s47, 7
s_add_u32 s60, s60, s43
s_add_u32 s61, s60, 14336
s_add_u32 s52, s43, 148480
s_add_u32 s53, s52, 896
v_lshrrev_b32 v104, 3, v1
v_mul_u32_u24 v104, 28672, v104
v_and_b32 v105, 7, v1
v_lshl_add_u32 v104, v105, 4, v104
s_waitcnt lgkmcnt(0)
buffer_load_dwordx4 v[96:99], v104, s[84:87], s60 offen sc1
s_load_dword s3, s[4:5], 5376
s_load_dword s3, s[4:5], 5440
s_load_dword s3, s[4:5], 5504
s_load_dword s3, s[4:5], 5568
s_load_dword s3, s[4:5], 5632
s_load_dword s3, s[4:5], 5696
buffer_load_dwordx4 v[100:103], v104, s[84:87], s61 offen sc1
s_load_dword s3, s[4:5], 5760
s_load_dword s3, s[4:5], 5824
s_load_dword s3, s[4:5], 5888
s_load_dword s3, s[4:5], 5952
s_load_dword s3, s[4:5], 6016
s_load_dword s3, s[4:5], 6080
s_load_dword s3, s[4:5], 6144
s_add_u32 s37, s35, 8
s_and_b32 s37, s37, 15
s_mul_i32 s37, s37, 16384
s_add_u32 m0, s39, 0
s_nop 0
buffer_load_dwordx4 v3, s[8:11], s37 offen sc1 lds
s_load_dword s3, s[4:5], 6208
v_mul_f32 v77, v77, v209
v_mul_f32 v78, v78, v210
v_mul_f32 v79, v79, v211
v_exp_f32 v72, v72
v_exp_f32 v73, v73
v_exp_f32 v74, v74
buffer_load_dwordx4 v3, s[8:11], s37 offen offset:1024 sc1 lds
v_exp_f32 v75, v75
v_exp_f32 v76, v76
v_exp_f32 v77, v77
v_exp_f32 v78, v78
v_exp_f32 v79, v79
v_fma_f32 v196, -v60, v52, v196
v_fma_f32 v197, -v60, v53, v197
buffer_load_dwordx4 v3, s[8:11], s37 offen offset:2048 sc1 lds
v_fma_f32 v198, -v60, v54, v198
v_fma_f32 v199, -v60, v55, v199
v_fma_f32 v220, -v62, v52, v220
v_fma_f32 v221, -v62, v53, v221
v_fma_f32 v222, -v62, v54, v222
v_fma_f32 v223, -v62, v55, v223
buffer_load_dwordx4 v3, s[8:11], s37 offen offset:3072 sc1 lds
v_fma_f32 v72, v72, v66, v66
v_fma_f32 v73, v73, v66, v66
v_fma_f32 v74, v74, v66, v66
v_fma_f32 v75, v75, v66, v66
v_fma_f32 v76, v76, v70, v70
v_fma_f32 v77, v77, v70, v70
v_fma_f32 v78, v78, v70, v70
s_add_u32 s38, s35, 8
s_and_b32 s38, s38, 15
s_mul_i32 s38, s38, 458752
s_add_u32 m0, s40, 0
s_nop 0
buffer_load_dwordx4 v4, s[12:15], s38 offen lds
v_fma_f32 v79, v79, v70, v70
v_rcp_f32 v72, v72
v_rcp_f32 v73, v73
v_rcp_f32 v74, v74
v_rcp_f32 v75, v75
v_rcp_f32 v76, v76
v_rcp_f32 v77, v77
s_add_u32 m0, s40, 1024
s_nop 0
buffer_load_dwordx4 v5, s[12:15], s38 offen lds
v_rcp_f32 v78, v78
v_rcp_f32 v79, v79
v_mul_f32 v196, v184, v196
v_mul_f32 v197, v185, v197
v_mul_f32 v198, v186, v198
v_mul_f32 v199, v187, v199
v_mul_f32 v220, v208, v220
s_add_u32 m0, s40, 2048
s_add_u32 s38, s38, 57344
buffer_load_dwordx4 v4, s[12:15], s38 offen lds
v_mul_f32 v221, v209, v221
v_mul_f32 v222, v210, v222
v_mul_f32 v223, v211, v223
v_mul_f32 v196, v196, v72
v_mul_f32 v197, v197, v73
v_mul_f32 v198, v198, v74
s_add_u32 m0, s40, 3072
s_nop 0
buffer_load_dwordx4 v5, s[12:15], s38 offen lds
v_mul_f32 v199, v199, v75
v_mul_f32 v220, v220, v76
v_mul_f32 v221, v221, v77
v_mul_f32 v222, v222, v78
v_mul_f32 v223, v223, v79
v_cvt_pk_bf16_f32 v80, v196, v197
v_cvt_pk_bf16_f32 v81, v198, v199
s_add_u32 m0, s40, 4096
s_add_u32 s38, s38, 57344
buffer_load_dwordx4 v4, s[12:15], s38 offen lds
v_cvt_pk_bf16_f32 v82, v220, v221
v_cvt_pk_bf16_f32 v83, v222, v223
s_nop 1
v_permlane32_swap_b32 v80, v82
v_permlane32_swap_b32 v81, v83
buffer_store_dwordx4 v[80:83], v84, s[24:27], s55 offen offset:2048 sc1
s_nop 1
s_add_u32 m0, s40, 5120
s_nop 0
buffer_load_dwordx4 v5, s[12:15], s38 offen lds
v_cmp_gt_u32 vcc, 32, v1
v_mov_b32 v104, s52
v_mov_b32 v106, s53
v_cndmask_b32 v104, v106, v104, vcc
v_lshl_add_u32 v104, v105, 4, v104
v_bfe_u32 v105, v1, 4, 1
v_lshl_add_u32 v104, v105, 2, v104
s_add_u32 m0, s40, 6144
s_add_u32 s38, s38, 57344
buffer_load_dwordx4 v4, s[12:15], s38 offen lds
s_add_u32 m0, s40, 7168
s_nop 0
buffer_load_dwordx4 v5, s[12:15], s38 offen lds
s_waitcnt vmcnt(15)
s_barrier
s_add_u32 s37, s35, 9
s_and_b32 s37, s37, 15
s_mul_i32 s37, s37, 16384
s_add_u32 m0, s39, 49152
s_nop 0
buffer_load_dwordx4 v3, s[8:11], s37 offen sc1 lds
buffer_load_dwordx4 v3, s[8:11], s37 offen offset:1024 sc1 lds
buffer_load_dwordx4 v3, s[8:11], s37 offen offset:2048 sc1 lds
buffer_load_dwordx4 v3, s[8:11], s37 offen offset:3072 sc1 lds
s_add_u32 s38, s35, 9
s_and_b32 s38, s38, 15
s_mul_i32 s38, s38, 458752
s_add_u32 m0, s40, 49152
s_nop 0
buffer_load_dwordx4 v4, s[12:15], s38 offen lds
s_add_u32 m0, s40, 50176
s_nop 0
buffer_load_dwordx4 v5, s[12:15], s38 offen lds
s_add_u32 m0, s40, 51200
s_add_u32 s38, s38, 57344
buffer_load_dwordx4 v4, s[12:15], s38 offen lds
s_add_u32 m0, s40, 52224
s_nop 0
buffer_load_dwordx4 v5, s[12:15], s38 offen lds
s_add_u32 m0, s40, 53248
s_add_u32 s38, s38, 57344
buffer_load_dwordx4 v4, s[12:15], s38 offen lds
s_add_u32 m0, s40, 54272
s_nop 0
buffer_load_dwordx4 v5, s[12:15], s38 offen lds
s_add_u32 m0, s40, 55296
s_add_u32 s38, s38, 57344
buffer_load_dwordx4 v4, s[12:15], s38 offen lds
s_add_u32 m0, s40, 56320
s_nop 0
buffer_load_dwordx4 v5, s[12:15], s38 offen lds
s_waitcnt vmcnt(12)
s_barrier
s_cmp_eq_u32 s47, 0
s_cbranch_scc0 Lw_125
s_add_u32 s7, s34, 32
s_lshl_b32 s7, s7, 7
v_mov_b32 v90, s7
v_mov_b32 v91, 1
s_mov_b64 exec, 1
buffer_atomic_add v91, v90, s[56:59], 0 offen sc1
s_mov_b64 exec, -1
Lw_125:
v_permlane32_swap_b32 v96, v100
v_permlane32_swap_b32 v97, v101
v_permlane32_swap_b32 v98, v102
v_permlane32_swap_b32 v99, v103
v_add_f32 v96, v96, v100
v_add_f32 v97, v97, v101
v_add_f32 v98, v98, v102
v_add_f32 v99, v99, v103
s_nop 1
v_permlane16_swap_b32 v96, v97
v_permlane16_swap_b32 v98, v99
v_add_f32 v96, v96, v97
v_add_f32 v98, v98, v99
s_nop 1
v_add_f32_dpp v96, v96, v96 row_ror:8 row_mask:0xf bank_mask:0xf
v_add_f32_dpp v98, v98, v98 row_ror:8 row_mask:0xf bank_mask:0xf
ds_write_b32 v104, v96
ds_write_b32 v104, v98 offset:8
s_waitcnt lgkmcnt(0)
s_add_u32 s37, s35, 10
s_and_b32 s37, s37, 15
s_mul_i32 s37, s37, 16384
s_add_u32 m0, s39, 98304
s_nop 0
buffer_load_dwordx4 v3, s[8:11], s37 offen sc1 lds
s_load_dword s3, s[4:5], 6272
s_load_dword s3, s[4:5], 6336
s_load_dword s3, s[4:5], 6400
s_load_dword s3, s[4:5], 6464
s_load_dword s3, s[4:5], 6528
s_load_dword s3, s[4:5], 6592
buffer_load_dwordx4 v3, s[8:11], s37 offen offset:1024 sc1 lds
s_load_dword s3, s[4:5], 6656
s_load_dword s3, s[4:5], 6720
s_load_dword s3, s[4:5], 6784
s_load_dword s3, s[4:5], 6848
s_load_dword s3, s[4:5], 6912
s_load_dword s3, s[4:5], 6976
s_load_dword s3, s[4:5], 7040
buffer_load_dwordx4 v3, s[8:11], s37 offen offset:2048 sc1 lds
s_load_dword s3, s[4:5], 7104
s_bfe_u32 s61, s35, 0x10002
s_lshr_b32 s60, s35, 3
s_lshl_b32 s60, s60, 2
s_and_b32 s43, s35, 3
s_add_u32 s60, s60, s43
buffer_load_dwordx4 v3, s[8:11], s37 offen offset:3072 sc1 lds
s_lshl_b32 s43, s60, 8
s_add_u32 s28, s76, s43
s_addc_u32 s29, s77, 0
s_mov_b32 s30, 7338240
s_mov_b32 s31, 0x20000
s_mul_i32 s52, s61, 196608
s_mul_i32 s53, s61, 1572864
s_add_u32 s38, s35, 10
s_and_b32 s38, s38, 15
s_mul_i32 s38, s38, 458752
s_add_u32 m0, s40, 98304
s_nop 0
buffer_load_dwordx4 v4, s[12:15], s38 offen lds
s_mul_i32 s90, s61, 163840
s_mul_i32 s91, s61, 1310720
s_and_b32 s43, s35, 3
s_mul_i32 s32, s43, 3
s_mul_i32 s33, s43, 10
s_lshr_b32 s33, s33, 2
s_add_u32 m0, s40, 99328
s_nop 0
buffer_load_dwordx4 v5, s[12:15], s38 offen lds
s_lshl_b32 s51, s47, 11
s_lshl_b32 s44, s47, 15
v_lshrrev_b32 v122, 4, v1
v_lshlrev_b32 v123, 1, v122
v_and_b32 v23, 15, v1
v_xor_b32 v23, v23, v123
v_lshlrev_b32 v23, 4, v23
s_add_u32 m0, s40, 100352
s_add_u32 s38, s38, 57344
buffer_load_dwordx4 v4, s[12:15], s38 offen lds
v_mul_u32_u24 v122, 2048, v122
v_add_u32 v23, v23, v122
v_add_u32 v23, s44, v23
v_xor_b32 v24, 128, v23
v_add_u32 v24, 8192, v24
s_lshl_b32 s43, s60, 2
s_add_u32 m0, s40, 101376
s_nop 0
buffer_load_dwordx4 v5, s[12:15], s38 offen lds
s_lshl_b32 s44, s61, 1
s_add_u32 s43, s43, s44
s_add_u32 s43, s43, s63
s_lshl_b32 s43, s43, 13
s_lshl_b32 s44, s62, 12
s_add_u32 s49, s43, s44
v_add_u32 v17, s44, v2
s_add_u32 m0, s40, 102400
s_add_u32 s38, s38, 57344
buffer_load_dwordx4 v4, s[12:15], s38 offen lds
v_add_u32 v18, 0x10000, v17
v_add_u32 v19, 0x20000, v17
v_lshrrev_b32 v122, 2, v1
v_and_b32 v123, 7, v122
v_mul_u32_u24 v122, 256, v122
s_branch Lov_10
.p2align 12
.fill 80, 4, 0xbf800000
Lst_10_0:
s_branch Lwr_165
Lst_10_1:
s_branch Lwr_172
s_nop 0
Lov_10:
v_lshl_add_u32 v122, v123, 5, v122
s_add_u32 m0, s40, 103424
s_nop 0
buffer_load_dwordx4 v5, s[12:15], s38 offen lds
v_and_b32 v123, 3, v1
v_lshl_add_u32 v9, v123, 3, v122
s_lshl_b32 s43, s61, 7
s_lshl_b32 s44, s63, 6
s_add_u32 s43, s43, s44
v_xor_b32 v9, s43, v9
v_xor_b32 v10, 32, v9
s_add_u32 m0, s40, 104448
s_add_u32 s38, s38, 57344
buffer_load_dwordx4 v4, s[12:15], s38 offen lds
s_add_u32 m0, s40, 105472
s_nop 0
buffer_load_dwordx4 v5, s[12:15], s38 offen lds
s_waitcnt vmcnt(12)
s_barrier
buffer_load_dwordx4 v[160:163], v2, s[8:11], s49 offen offset:0 sc1
v_xor_b32 v11, 128, v9
v_xor_b32 v12, 128, v10
v_add_u32 v13, 65536, v9
buffer_load_dwordx4 v[164:167], v2, s[8:11], s49 offen offset:1024 sc1
v_add_u32 v14, 65536, v10
v_add_u32 v15, 65536, v11
v_add_u32 v16, 65536, v12
v_add_u32 v25, 131072, v9
buffer_load_dwordx4 v[168:171], v2, s[8:11], s49 offen offset:2048 sc1
v_add_u32 v26, 131072, v10
v_add_u32 v27, 131072, v11
v_add_u32 v28, 131072, v12
v_lshrrev_b32 v122, 2, v1
buffer_load_dwordx4 v[172:175], v2, s[8:11], s49 offen offset:3072 sc1
v_bfe_u32 v123, v122, 1, 2
v_mul_u32_u24 v122, 128, v122
v_lshl_add_u32 v122, v123, 5, v122
s_add_u32 s37, s35, 11
s_and_b32 s37, s37, 15
s_mul_i32 s37, s37, 16384
s_add_u32 m0, s39, 0
s_nop 0
buffer_load_dwordx4 v3, s[8:11], s37 offen sc1 lds
v_and_b32 v123, 3, v1
v_lshl_add_u32 v224, v123, 3, v122
v_xor_b32 v224, s44, v224
v_xor_b32 v225, 32, v224
buffer_load_dwordx4 v3, s[8:11], s37 offen offset:1024 sc1 lds
v_add_u32 v226, 65536, v224
v_add_u32 v227, 65536, v225
v_add_u32 v228, 131072, v224
v_add_u32 v229, 131072, v225
buffer_load_dwordx4 v3, s[8:11], s37 offen offset:2048 sc1 lds
s_add_u32 s84, s82, 33554432
s_addc_u32 s85, s83, 0
s_mov_b32 s86, 4194304
s_mov_b32 s87, 0x20000
buffer_load_dwordx4 v3, s[8:11], s37 offen offset:3072 sc1 lds
s_xor_b32 s43, s2, 2
s_lshl_b32 s44, s43, 2
s_add_u32 s44, s44, s47
s_add_u32 s38, s35, 11
s_and_b32 s38, s38, 15
s_mul_i32 s38, s38, 458752
s_add_u32 m0, s40, 0
s_nop 0
buffer_load_dwordx4 v4, s[12:15], s38 offen lds
s_lshl_b32 s45, s44, 12
s_lshl_b32 s46, s2, 2
s_add_u32 s46, s46, s47
s_lshl_b32 s46, s46, 12
s_add_u32 m0, s40, 1024
s_nop 0
buffer_load_dwordx4 v5, s[12:15], s38 offen lds
s_lshl_b32 s43, s34, 18
s_lshl_b32 s42, s60, 8
s_add_u32 s43, s43, s42
s_lshl_b32 s42, s61, 7
s_add_u32 m0, s40, 2048
s_add_u32 s38, s38, 57344
buffer_load_dwordx4 v4, s[12:15], s38 offen lds
s_add_u32 s43, s43, s42
s_lshl_b32 s42, s63, 6
s_add_u32 s43, s43, s42
s_add_u32 m0, s40, 3072
s_nop 0
buffer_load_dwordx4 v5, s[12:15], s38 offen lds
s_add_u32 s20, s78, s43
s_addc_u32 s21, s79, 0
s_mov_b32 s22, 260160
s_mov_b32 s23, 0x20000
s_add_u32 m0, s40, 4096
s_add_u32 s38, s38, 57344
buffer_load_dwordx4 v4, s[12:15], s38 offen lds
v_and_b32 v230, 15, v1
v_lshlrev_b32 v230, 12, v230
v_bfe_u32 v231, v1, 4, 1
v_lshl_add_u32 v230, v231, 5, v230
s_add_u32 m0, s40, 5120
s_nop 0
buffer_load_dwordx4 v5, s[12:15], s38 offen lds
v_bfe_u32 v231, v1, 5, 1
v_lshl_add_u32 v230, v231, 4, v230
s_lshl_b32 s54, s62, 17
s_add_u32 s55, s54, 65536
s_add_u32 m0, s40, 6144
s_add_u32 s38, s38, 57344
buffer_load_dwordx4 v4, s[12:15], s38 offen lds
s_add_u32 m0, s40, 7168
s_nop 0
buffer_load_dwordx4 v5, s[12:15], s38 offen lds
s_waitcnt vmcnt(16)
s_barrier
s_cmp_eq_u32 s47, 3
s_cbranch_scc0 Lw_126
s_lshl_b32 s92, s34, 7
s_add_u32 s92, s92, 28315648
s_load_dword s93, s[82:83], s92 glc
Lw_126:
s_add_u32 s37, s35, 12
s_and_b32 s37, s37, 15
s_mul_i32 s37, s37, 16384
s_add_u32 m0, s39, 49152
s_nop 0
buffer_load_dwordx4 v3, s[8:11], s37 offen sc1 lds
buffer_load_dwordx4 v3, s[8:11], s37 offen offset:1024 sc1 lds
buffer_load_dwordx4 v3, s[8:11], s37 offen offset:2048 sc1 lds
buffer_load_dwordx4 v3, s[8:11], s37 offen offset:3072 sc1 lds
s_add_u32 s38, s35, 12
s_and_b32 s38, s38, 15
s_mul_i32 s38, s38, 458752
s_add_u32 m0, s40, 49152
s_nop 0
buffer_load_dwordx4 v4, s[12:15], s38 offen lds
s_add_u32 m0, s40, 50176
s_nop 0
buffer_load_dwordx4 v5, s[12:15], s38 offen lds
s_add_u32 m0, s40, 51200
s_add_u32 s38, s38, 57344
buffer_load_dwordx4 v4, s[12:15], s38 offen lds
s_add_u32 m0, s40, 52224
s_nop 0
buffer_load_dwordx4 v5, s[12:15], s38 offen lds
s_add_u32 m0, s40, 53248
s_add_u32 s38, s38, 57344
buffer_load_dwordx4 v4, s[12:15], s38 offen lds
s_add_u32 m0, s40, 54272
s_nop 0
buffer_load_dwordx4 v5, s[12:15], s38 offen lds
s_add_u32 m0, s40, 55296
s_add_u32 s38, s38, 57344
buffer_load_dwordx4 v4, s[12:15], s38 offen lds
s_add_u32 m0, s40, 56320
s_nop 0
buffer_load_dwordx4 v5, s[12:15], s38 offen lds
s_waitcnt vmcnt(12)
s_cmp_eq_u32 s47, 3
s_cbranch_scc0 Lw_127
s_mov_b32 s41, 0x40000
s_branch Lpchk_130
Lpoll_128:
s_load_dword s93, s[82:83], s92 glc
Lpchk_130:
s_waitcnt lgkmcnt(0)
s_cmp_eq_u32 s93, 16
s_cbranch_scc1 Lpok_129
s_sub_u32 s41, s41, 1
s_cmp_lg_u32 s41, 0
s_cbranch_scc1 Lpoll_128
Lpok_129:
Lw_127:
s_barrier
s_add_u32 s37, s52, 524288
s_add_u32 m0, s39, 98304
s_nop 0
buffer_load_dwordx4 v3, s[24:27], s37 offen sc1 lds
v_lshlrev_b32 v128, 16, v160
v_and_b32 v129, 0xffff0000, v160
v_lshlrev_b32 v130, 16, v161
v_and_b32 v131, 0xffff0000, v161
v_lshlrev_b32 v132, 16, v162
buffer_load_dwordx4 v3, s[24:27], s37 offen offset:1024 sc1 lds
v_and_b32 v133, 0xffff0000, v162
v_lshlrev_b32 v134, 16, v163
v_and_b32 v135, 0xffff0000, v163
v_lshlrev_b32 v136, 16, v164
v_and_b32 v137, 0xffff0000, v164
buffer_load_dwordx4 v3, s[24:27], s37 offen offset:2048 sc1 lds
v_lshlrev_b32 v138, 16, v165
v_and_b32 v139, 0xffff0000, v165
v_lshlrev_b32 v140, 16, v166
v_and_b32 v141, 0xffff0000, v166
v_lshlrev_b32 v142, 16, v167
v_and_b32 v143, 0xffff0000, v167
buffer_load_dwordx4 v3, s[24:27], s37 offen offset:3072 sc1 lds
v_lshlrev_b32 v144, 16, v168
v_and_b32 v145, 0xffff0000, v168
v_lshlrev_b32 v146, 16, v169
v_and_b32 v147, 0xffff0000, v169
v_lshlrev_b32 v148, 16, v170
s_add_u32 s38, s53, 4194304
s_add_u32 m0, s39, 114688
s_nop 0
buffer_load_dwordx4 v23, s[28:31], s38 offen lds
v_and_b32 v149, 0xffff0000, v170
v_lshlrev_b32 v150, 16, v171
v_and_b32 v151, 0xffff0000, v171
v_lshlrev_b32 v152, 16, v172
v_and_b32 v153, 0xffff0000, v172
s_add_u32 m0, s39, 115712
s_nop 0
buffer_load_dwordx4 v24, s[28:31], s38 offen lds
v_lshlrev_b32 v154, 16, v173
v_and_b32 v155, 0xffff0000, v173
v_lshlrev_b32 v156, 16, v174
v_and_b32 v157, 0xffff0000, v174
v_lshlrev_b32 v158, 16, v175
v_and_b32 v159, 0xffff0000, v175
s_add_u32 m0, s39, 116736
s_add_u32 s38, s38, 16384
buffer_load_dwordx4 v23, s[28:31], s38 offen lds
s_add_u32 m0, s39, 117760
s_nop 0
buffer_load_dwordx4 v24, s[28:31], s38 offen lds
s_waitcnt vmcnt(8)
s_barrier
s_add_u32 s37, s52, 540672
s_add_u32 m0, s39, 131072
s_nop 0
buffer_load_dwordx4 v3, s[24:27], s37 offen sc1 lds
buffer_load_dwordx4 v3, s[24:27], s37 offen offset:1024 sc1 lds
buffer_load_dwordx4 v3, s[24:27], s37 offen offset:2048 sc1 lds
buffer_load_dwordx4 v3, s[24:27], s37 offen offset:3072 sc1 lds
s_add_u32 s38, s53, 4325376
s_add_u32 m0, s39, 0
s_nop 0
buffer_load_dwordx4 v23, s[28:31], s38 offen lds
s_add_u32 m0, s39, 1024
s_nop 0
buffer_load_dwordx4 v24, s[28:31], s38 offen lds
s_add_u32 m0, s39, 2048
s_add_u32 s38, s38, 16384
buffer_load_dwordx4 v23, s[28:31], s38 offen lds
s_add_u32 m0, s39, 3072
s_nop 0
buffer_load_dwordx4 v24, s[28:31], s38 offen lds
s_add_u32 s37, s52, 557056
s_add_u32 m0, s39, 16384
s_nop 0
buffer_load_dwordx4 v3, s[24:27], s37 offen sc1 lds
buffer_load_dwordx4 v3, s[24:27], s37 offen offset:1024 sc1 lds
buffer_load_dwordx4 v3, s[24:27], s37 offen offset:2048 sc1 lds
buffer_load_dwordx4 v3, s[24:27], s37 offen offset:3072 sc1 lds
s_add_u32 s38, s53, 4456448
s_add_u32 m0, s39, 32768
s_nop 0
buffer_load_dwordx4 v23, s[28:31], s38 offen lds
s_add_u32 m0, s39, 33792
s_nop 0
buffer_load_dwordx4 v24, s[28:31], s38 offen lds
s_add_u32 m0, s39, 34816
s_add_u32 s38, s38, 16384
buffer_load_dwordx4 v23, s[28:31], s38 offen lds
s_add_u32 m0, s39, 35840
s_nop 0
buffer_load_dwordx4 v24, s[28:31], s38 offen lds
s_waitcnt vmcnt(16)
s_barrier
ds_read_b128 v[32:35], v18 offset:32768
ds_read_b64_tr_b16 v[48:49], v13 offset:49152
ds_read_b64_tr_b16 v[50:51], v13 offset:53248
ds_read_b64_tr_b16 v[52:53], v14 offset:49152
ds_read_b64_tr_b16 v[54:55], v14 offset:53248
ds_read_b64_tr_b16 v[56:57], v15 offset:49152
ds_read_b64_tr_b16 v[58:59], v15 offset:53248
ds_read_b64_tr_b16 v[60:61], v16 offset:49152
ds_read_b64_tr_b16 v[62:63], v16 offset:53248
ds_read_b128 v[36:39], v18 offset:33792
ds_read_b128 v[40:43], v18 offset:34816
ds_read_b128 v[44:47], v18 offset:35840
ds_read_b128 v[64:67], v18 offset:40960
ds_read_b64_tr_b16 v[80:81], v13 offset:57344
ds_read_b64_tr_b16 v[82:83], v13 offset:61440
ds_read_b64_tr_b16 v[84:85], v14 offset:57344
ds_read_b64_tr_b16 v[86:87], v14 offset:61440
ds_read_b64_tr_b16 v[88:89], v15 offset:57344
ds_read_b64_tr_b16 v[90:91], v15 offset:61440
ds_read_b64_tr_b16 v[92:93], v16 offset:57344
ds_read_b64_tr_b16 v[94:95], v16 offset:61440
ds_read_b128 v[68:71], v18 offset:41984
ds_read_b128 v[72:75], v18 offset:43008
ds_read_b128 v[76:79], v18 offset:44032
s_add_u32 s37, s52, 573440
s_add_u32 m0, s39, 49152
s_nop 0
buffer_load_dwordx4 v3, s[24:27], s37 offen sc1 lds
buffer_load_dwordx4 v3, s[24:27], s37 offen offset:1024 sc1 lds
buffer_load_dwordx4 v3, s[24:27], s37 offen offset:2048 sc1 lds
buffer_load_dwordx4 v3, s[24:27], s37 offen offset:3072 sc1 lds
s_add_u32 s38, s53, 4587520
s_add_u32 m0, s39, 65536
s_nop 0
buffer_load_dwordx4 v23, s[28:31], s38 offen lds
s_add_u32 m0, s39, 66560
s_nop 0
buffer_load_dwordx4 v24, s[28:31], s38 offen lds
s_add_u32 m0, s39, 67584
s_add_u32 s38, s38, 16384
buffer_load_dwordx4 v23, s[28:31], s38 offen lds
s_add_u32 m0, s39, 68608
s_nop 0
buffer_load_dwordx4 v24, s[28:31], s38 offen lds
Lk4c:
s_waitcnt vmcnt(16)
s_waitcnt lgkmcnt(0)
s_barrier
v_mfma_f32_16x16x32_bf16 v[128:131], v[48:51], v[32:35], v[128:131]
ds_read_b128 v[96:99], v19 offset:0
v_mfma_f32_16x16x32_bf16 v[136:139], v[48:51], v[36:39], v[136:139]
ds_read_b64_tr_b16 v[112:113], v9 offset:0
v_mfma_f32_16x16x32_bf16 v[144:147], v[48:51], v[40:43], v[144:147]
ds_read_b64_tr_b16 v[114:115], v9 offset:4096
v_mfma_f32_16x16x32_bf16 v[152:155], v[48:51], v[44:47], v[152:155]
ds_read_b64_tr_b16 v[116:117], v10 offset:0
v_mfma_f32_16x16x32_bf16 v[156:159], v[52:55], v[44:47], v[156:159]
ds_read_b64_tr_b16 v[118:119], v10 offset:4096
v_mfma_f32_16x16x32_bf16 v[148:151], v[52:55], v[40:43], v[148:151]
ds_read_b64_tr_b16 v[120:121], v11 offset:0
v_mfma_f32_16x16x32_bf16 v[140:143], v[52:55], v[36:39], v[140:143]
ds_read_b64_tr_b16 v[122:123], v11 offset:4096
v_mfma_f32_16x16x32_bf16 v[132:135], v[52:55], v[32:35], v[132:135]
ds_read_b64_tr_b16 v[124:125], v12 offset:0
v_mfma_f32_16x16x32_bf16 v[160:163], v[56:59], v[32:35], 0
ds_read_b64_tr_b16 v[126:127], v12 offset:4096
v_mfma_f32_16x16x32_bf16 v[168:171], v[56:59], v[36:39], 0
ds_read_b128 v[100:103], v19 offset:1024
v_mfma_f32_16x16x32_bf16 v[176:179], v[56:59], v[40:43], 0
ds_read_b128 v[104:107], v19 offset:2048
v_mfma_f32_16x16x32_bf16 v[184:187], v[56:59], v[44:47], 0
ds_read_b128 v[108:111], v19 offset:3072
v_mfma_f32_16x16x32_bf16 v[188:191], v[60:63], v[44:47], 0
ds_read_b128 v[192:195], v19 offset:8192
v_mfma_f32_16x16x32_bf16 v[180:183], v[60:63], v[40:43], 0
ds_read_b64_tr_b16 v[208:209], v9 offset:8192
v_mfma_f32_16x16x32_bf16 v[172:175], v[60:63], v[36:39], 0
ds_read_b64_tr_b16 v[210:211], v9 offset:12288
v_mfma_f32_16x16x32_bf16 v[164:167], v[60:63], v[32:35], 0
ds_read_b64_tr_b16 v[212:213], v10 offset:8192
v_mfma_f32_16x16x32_bf16 v[128:131], v[80:83], v[64:67], v[128:131]
ds_read_b64_tr_b16 v[214:215], v10 offset:12288
v_mfma_f32_16x16x32_bf16 v[136:139], v[80:83], v[68:71], v[136:139]
ds_read_b64_tr_b16 v[216:217], v11 offset:8192
v_mfma_f32_16x16x32_bf16 v[144:147], v[80:83], v[72:75], v[144:147]
ds_read_b64_tr_b16 v[218:219], v11 offset:12288
v_mfma_f32_16x16x32_bf16 v[152:155], v[80:83], v[76:79], v[152:155]
ds_read_b64_tr_b16 v[220:221], v12 offset:8192
v_mfma_f32_16x16x32_bf16 v[156:159], v[84:87], v[76:79], v[156:159]
ds_read_b64_tr_b16 v[222:223], v12 offset:12288
v_mfma_f32_16x16x32_bf16 v[148:151], v[84:87], v[72:75], v[148:151]
ds_read_b128 v[196:199], v19 offset:9216
v_mfma_f32_16x16x32_bf16 v[140:143], v[84:87], v[68:71], v[140:143]
ds_read_b128 v[200:203], v19 offset:10240
v_mfma_f32_16x16x32_bf16 v[132:135], v[84:87], v[64:67], v[132:135]
ds_read_b128 v[204:207], v19 offset:11264
v_mfma_f32_16x16x32_bf16 v[160:163], v[88:91], v[64:67], v[160:163]
v_mfma_f32_16x16x32_bf16 v[168:171], v[88:91], v[68:71], v[168:171]
v_mfma_f32_16x16x32_bf16 v[176:179], v[88:91], v[72:75], v[176:179]
v_mfma_f32_16x16x32_bf16 v[184:187], v[88:91], v[76:79], v[184:187]
v_mfma_f32_16x16x32_bf16 v[188:191], v[92:95], v[76:79], v[188:191]
v_mfma_f32_16x16x32_bf16 v[180:183], v[92:95], v[72:75], v[180:183]
v_mfma_f32_16x16x32_bf16 v[172:175], v[92:95], v[68:71], v[172:175]
v_mfma_f32_16x16x32_bf16 v[164:167], v[92:95], v[64:67], v[164:167]
s_mov_b32 s41, 2
Lk4_131:
s_waitcnt vmcnt(8)
s_waitcnt lgkmcnt(0)
s_barrier
v_mfma_f32_16x16x32_bf16 v[128:131], v[112:115], v[96:99], v[128:131]
ds_read_b128 v[32:35], v17 offset:16384
v_mfma_f32_16x16x32_bf16 v[136:139], v[112:115], v[100:103], v[136:139]
ds_read_b64_tr_b16 v[48:49], v9 offset:32768
v_mfma_f32_16x16x32_bf16 v[144:147], v[112:115], v[104:107], v[144:147]
ds_read_b64_tr_b16 v[50:51], v9 offset:36864
v_mfma_f32_16x16x32_bf16 v[152:155], v[112:115], v[108:111], v[152:155]
ds_read_b64_tr_b16 v[52:53], v10 offset:32768
v_mfma_f32_16x16x32_bf16 v[156:159], v[116:119], v[108:111], v[156:159]
ds_read_b64_tr_b16 v[54:55], v10 offset:36864
v_mfma_f32_16x16x32_bf16 v[148:151], v[116:119], v[104:107], v[148:151]
ds_read_b64_tr_b16 v[56:57], v11 offset:32768
v_mfma_f32_16x16x32_bf16 v[140:143], v[116:119], v[100:103], v[140:143]
ds_read_b64_tr_b16 v[58:59], v11 offset:36864
v_mfma_f32_16x16x32_bf16 v[132:135], v[116:119], v[96:99], v[132:135]
ds_read_b64_tr_b16 v[60:61], v12 offset:32768
v_mfma_f32_16x16x32_bf16 v[160:163], v[120:123], v[96:99], v[160:163]
ds_read_b64_tr_b16 v[62:63], v12 offset:36864
v_mfma_f32_16x16x32_bf16 v[168:171], v[120:123], v[100:103], v[168:171]
ds_read_b128 v[36:39], v17 offset:17408
v_mfma_f32_16x16x32_bf16 v[176:179], v[120:123], v[104:107], v[176:179]
ds_read_b128 v[40:43], v17 offset:18432
v_mfma_f32_16x16x32_bf16 v[184:187], v[120:123], v[108:111], v[184:187]
ds_read_b128 v[44:47], v17 offset:19456
v_mfma_f32_16x16x32_bf16 v[188:191], v[124:127], v[108:111], v[188:191]
ds_read_b128 v[64:67], v17 offset:24576
v_mfma_f32_16x16x32_bf16 v[180:183], v[124:127], v[104:107], v[180:183]
ds_read_b64_tr_b16 v[80:81], v9 offset:40960
v_mfma_f32_16x16x32_bf16 v[172:175], v[124:127], v[100:103], v[172:175]
ds_read_b64_tr_b16 v[82:83], v9 offset:45056
v_mfma_f32_16x16x32_bf16 v[164:167], v[124:127], v[96:99], v[164:167]
ds_read_b64_tr_b16 v[84:85], v10 offset:40960
v_mfma_f32_16x16x32_bf16 v[128:131], v[208:211], v[192:195], v[128:131]
ds_read_b64_tr_b16 v[86:87], v10 offset:45056
v_mfma_f32_16x16x32_bf16 v[136:139], v[208:211], v[196:199], v[136:139]
ds_read_b64_tr_b16 v[88:89], v11 offset:40960
v_mfma_f32_16x16x32_bf16 v[144:147], v[208:211], v[200:203], v[144:147]
ds_read_b64_tr_b16 v[90:91], v11 offset:45056
v_mfma_f32_16x16x32_bf16 v[152:155], v[208:211], v[204:207], v[152:155]
ds_read_b64_tr_b16 v[92:93], v12 offset:40960
v_mfma_f32_16x16x32_bf16 v[156:159], v[212:215], v[204:207], v[156:159]
ds_read_b64_tr_b16 v[94:95], v12 offset:45056
v_mfma_f32_16x16x32_bf16 v[148:151], v[212:215], v[200:203], v[148:151]
ds_read_b128 v[68:71], v17 offset:25600
v_mfma_f32_16x16x32_bf16 v[140:143], v[212:215], v[196:199], v[140:143]
ds_read_b128 v[72:75], v17 offset:26624
v_mfma_f32_16x16x32_bf16 v[132:135], v[212:215], v[192:195], v[132:135]
ds_read_b128 v[76:79], v17 offset:27648
v_mfma_f32_16x16x32_bf16 v[160:163], v[216:219], v[192:195], v[160:163]
v_mfma_f32_16x16x32_bf16 v[168:171], v[216:219], v[196:199], v[168:171]
v_mfma_f32_16x16x32_bf16 v[176:179], v[216:219], v[200:203], v[176:179]
v_mfma_f32_16x16x32_bf16 v[184:187], v[216:219], v[204:207], v[184:187]
v_mfma_f32_16x16x32_bf16 v[188:191], v[220:223], v[204:207], v[188:191]
v_mfma_f32_16x16x32_bf16 v[180:183], v[220:223], v[200:203], v[180:183]
v_mfma_f32_16x16x32_bf16 v[172:175], v[220:223], v[196:199], v[172:175]
v_mfma_f32_16x16x32_bf16 v[164:167], v[220:223], v[192:195], v[164:167]
s_waitcnt vmcnt(0)
s_waitcnt lgkmcnt(0)
s_barrier
v_mfma_f32_16x16x32_bf16 v[128:131], v[48:51], v[32:35], v[128:131]
ds_read_b128 v[96:99], v17 offset:49152
v_mfma_f32_16x16x32_bf16 v[136:139], v[48:51], v[36:39], v[136:139]
ds_read_b64_tr_b16 v[112:113], v13 offset:0
v_mfma_f32_16x16x32_bf16 v[144:147], v[48:51], v[40:43], v[144:147]
ds_read_b64_tr_b16 v[114:115], v13 offset:4096
v_mfma_f32_16x16x32_bf16 v[152:155], v[48:51], v[44:47], v[152:155]
ds_read_b64_tr_b16 v[116:117], v14 offset:0
v_mfma_f32_16x16x32_bf16 v[156:159], v[52:55], v[44:47], v[156:159]
ds_read_b64_tr_b16 v[118:119], v14 offset:4096
v_mfma_f32_16x16x32_bf16 v[148:151], v[52:55], v[40:43], v[148:151]
ds_read_b64_tr_b16 v[120:121], v15 offset:0
v_mfma_f32_16x16x32_bf16 v[140:143], v[52:55], v[36:39], v[140:143]
ds_read_b64_tr_b16 v[122:123], v15 offset:4096
v_mfma_f32_16x16x32_bf16 v[132:135], v[52:55], v[32:35], v[132:135]
ds_read_b64_tr_b16 v[124:125], v16 offset:0
v_mfma_f32_16x16x32_bf16 v[160:163], v[56:59], v[32:35], v[160:163]
ds_read_b64_tr_b16 v[126:127], v16 offset:4096
v_mfma_f32_16x16x32_bf16 v[168:171], v[56:59], v[36:39], v[168:171]
ds_read_b128 v[100:103], v17 offset:50176
v_mfma_f32_16x16x32_bf16 v[176:179], v[56:59], v[40:43], v[176:179]
ds_read_b128 v[104:107], v17 offset:51200
v_mfma_f32_16x16x32_bf16 v[184:187], v[56:59], v[44:47], v[184:187]
ds_read_b128 v[108:111], v17 offset:52224
v_mfma_f32_16x16x32_bf16 v[188:191], v[60:63], v[44:47], v[188:191]
ds_read_b128 v[192:195], v17 offset:57344
v_mfma_f32_16x16x32_bf16 v[180:183], v[60:63], v[40:43], v[180:183]
ds_read_b64_tr_b16 v[208:209], v13 offset:8192
v_mfma_f32_16x16x32_bf16 v[172:175], v[60:63], v[36:39], v[172:175]
ds_read_b64_tr_b16 v[210:211], v13 offset:12288
v_mfma_f32_16x16x32_bf16 v[164:167], v[60:63], v[32:35], v[164:167]
ds_read_b64_tr_b16 v[212:213], v14 offset:8192
v_mfma_f32_16x16x32_bf16 v[128:131], v[80:83], v[64:67], v[128:131]
ds_read_b64_tr_b16 v[214:215], v14 offset:12288
v_mfma_f32_16x16x32_bf16 v[136:139], v[80:83], v[68:71], v[136:139]
ds_read_b64_tr_b16 v[216:217], v15 offset:8192
v_mfma_f32_16x16x32_bf16 v[144:147], v[80:83], v[72:75], v[144:147]
ds_read_b64_tr_b16 v[218:219], v15 offset:12288
v_mfma_f32_16x16x32_bf16 v[152:155], v[80:83], v[76:79], v[152:155]
ds_read_b64_tr_b16 v[220:221], v16 offset:8192
v_mfma_f32_16x16x32_bf16 v[156:159], v[84:87], v[76:79], v[156:159]
ds_read_b64_tr_b16 v[222:223], v16 offset:12288
v_mfma_f32_16x16x32_bf16 v[148:151], v[84:87], v[72:75], v[148:151]
ds_read_b128 v[196:199], v17 offset:58368
v_mfma_f32_16x16x32_bf16 v[140:143], v[84:87], v[68:71], v[140:143]
ds_read_b128 v[200:203], v17 offset:59392
v_mfma_f32_16x16x32_bf16 v[132:135], v[84:87], v[64:67], v[132:135]
ds_read_b128 v[204:207], v17 offset:60416
v_mfma_f32_16x16x32_bf16 v[160:163], v[88:91], v[64:67], v[160:163]
v_mfma_f32_16x16x32_bf16 v[168:171], v[88:91], v[68:71], v[168:171]
v_mfma_f32_16x16x32_bf16 v[176:179], v[88:91], v[72:75], v[176:179]
v_mfma_f32_16x16x32_bf16 v[184:187], v[88:91], v[76:79], v[184:187]
v_mfma_f32_16x16x32_bf16 v[188:191], v[92:95], v[76:79], v[188:191]
v_mfma_f32_16x16x32_bf16 v[180:183], v[92:95], v[72:75], v[180:183]
v_mfma_f32_16x16x32_bf16 v[172:175], v[92:95], v[68:71], v[172:175]
v_mfma_f32_16x16x32_bf16 v[164:167], v[92:95], v[64:67], v[164:167]
s_waitcnt lgkmcnt(0)
s_barrier
v_mfma_f32_16x16x32_bf16 v[128:131], v[112:115], v[96:99], v[128:131]
ds_read_b128 v[32:35], v18 offset:16384
v_mfma_f32_16x16x32_bf16 v[136:139], v[112:115], v[100:103], v[136:139]
ds_read_b64_tr_b16 v[48:49], v25 offset:16384
v_mfma_f32_16x16x32_bf16 v[144:147], v[112:115], v[104:107], v[144:147]
ds_read_b64_tr_b16 v[50:51], v25 offset:20480
v_mfma_f32_16x16x32_bf16 v[152:155], v[112:115], v[108:111], v[152:155]
ds_read_b64_tr_b16 v[52:53], v26 offset:16384
v_mfma_f32_16x16x32_bf16 v[156:159], v[116:119], v[108:111], v[156:159]
ds_read_b64_tr_b16 v[54:55], v26 offset:20480
v_mfma_f32_16x16x32_bf16 v[148:151], v[116:119], v[104:107], v[148:151]
ds_read_b64_tr_b16 v[56:57], v27 offset:16384
v_mfma_f32_16x16x32_bf16 v[140:143], v[116:119], v[100:103], v[140:143]
ds_read_b64_tr_b16 v[58:59], v27 offset:20480
v_mfma_f32_16x16x32_bf16 v[132:135], v[116:119], v[96:99], v[132:135]
ds_read_b64_tr_b16 v[60:61], v28 offset:16384
v_mfma_f32_16x16x32_bf16 v[160:163], v[120:123], v[96:99], v[160:163]
ds_read_b64_tr_b16 v[62:63], v28 offset:20480
v_mfma_f32_16x16x32_bf16 v[168:171], v[120:123], v[100:103], v[168:171]
ds_read_b128 v[36:39], v18 offset:17408
v_mfma_f32_16x16x32_bf16 v[176:179], v[120:123], v[104:107], v[176:179]
ds_read_b128 v[40:43], v18 offset:18432
v_mfma_f32_16x16x32_bf16 v[184:187], v[120:123], v[108:111], v[184:187]
ds_read_b128 v[44:47], v18 offset:19456
v_mfma_f32_16x16x32_bf16 v[188:191], v[124:127], v[108:111], v[188:191]
ds_read_b128 v[64:67], v18 offset:24576
v_mfma_f32_16x16x32_bf16 v[180:183], v[124:127], v[104:107], v[180:183]
ds_read_b64_tr_b16 v[80:81], v25 offset:24576
v_mfma_f32_16x16x32_bf16 v[172:175], v[124:127], v[100:103], v[172:175]
ds_read_b64_tr_b16 v[82:83], v25 offset:28672
v_mfma_f32_16x16x32_bf16 v[164:167], v[124:127], v[96:99], v[164:167]
ds_read_b64_tr_b16 v[84:85], v26 offset:24576
v_mfma_f32_16x16x32_bf16 v[128:131], v[208:211], v[192:195], v[128:131]
ds_read_b64_tr_b16 v[86:87], v26 offset:28672
v_mfma_f32_16x16x32_bf16 v[136:139], v[208:211], v[196:199], v[136:139]
ds_read_b64_tr_b16 v[88:89], v27 offset:24576
v_mfma_f32_16x16x32_bf16 v[144:147], v[208:211], v[200:203], v[144:147]
ds_read_b64_tr_b16 v[90:91], v27 offset:28672
v_mfma_f32_16x16x32_bf16 v[152:155], v[208:211], v[204:207], v[152:155]
ds_read_b64_tr_b16 v[92:93], v28 offset:24576
v_mfma_f32_16x16x32_bf16 v[156:159], v[212:215], v[204:207], v[156:159]
ds_read_b64_tr_b16 v[94:95], v28 offset:28672
v_mfma_f32_16x16x32_bf16 v[148:151], v[212:215], v[200:203], v[148:151]
s_branch Lov_11
.p2align 12
.fill 80, 4, 0xbf800000
Lst_11_0:
s_branch Lwr_166
Lst_11_1:
s_branch Lst_15_0
s_nop 0
Lov_11:
ds_read_b128 v[68:71], v18 offset:25600
v_mfma_f32_16x16x32_bf16 v[140:143], v[212:215], v[196:199], v[140:143]
ds_read_b128 v[72:75], v18 offset:26624
v_mfma_f32_16x16x32_bf16 v[132:135], v[212:215], v[192:195], v[132:135]
ds_read_b128 v[76:79], v18 offset:27648
v_mfma_f32_16x16x32_bf16 v[160:163], v[216:219], v[192:195], v[160:163]
v_mfma_f32_16x16x32_bf16 v[168:171], v[216:219], v[196:199], v[168:171]
v_mfma_f32_16x16x32_bf16 v[176:179], v[216:219], v[200:203], v[176:179]
v_mfma_f32_16x16x32_bf16 v[184:187], v[216:219], v[204:207], v[184:187]
v_mfma_f32_16x16x32_bf16 v[188:191], v[220:223], v[204:207], v[188:191]
v_mfma_f32_16x16x32_bf16 v[180:183], v[220:223], v[200:203], v[180:183]
v_mfma_f32_16x16x32_bf16 v[172:175], v[220:223], v[196:199], v[172:175]
v_mfma_f32_16x16x32_bf16 v[164:167], v[220:223], v[192:195], v[164:167]
s_waitcnt lgkmcnt(0)
s_barrier
v_mfma_f32_16x16x32_bf16 v[128:131], v[48:51], v[32:35], v[128:131]
ds_read_b128 v[96:99], v18 offset:32768
v_mfma_f32_16x16x32_bf16 v[136:139], v[48:51], v[36:39], v[136:139]
ds_read_b64_tr_b16 v[112:113], v13 offset:49152
v_mfma_f32_16x16x32_bf16 v[144:147], v[48:51], v[40:43], v[144:147]
ds_read_b64_tr_b16 v[114:115], v13 offset:53248
v_mfma_f32_16x16x32_bf16 v[152:155], v[48:51], v[44:47], v[152:155]
ds_read_b64_tr_b16 v[116:117], v14 offset:49152
v_mfma_f32_16x16x32_bf16 v[156:159], v[52:55], v[44:47], v[156:159]
ds_read_b64_tr_b16 v[118:119], v14 offset:53248
v_mfma_f32_16x16x32_bf16 v[148:151], v[52:55], v[40:43], v[148:151]
ds_read_b64_tr_b16 v[120:121], v15 offset:49152
v_mfma_f32_16x16x32_bf16 v[140:143], v[52:55], v[36:39], v[140:143]
ds_read_b64_tr_b16 v[122:123], v15 offset:53248
v_mfma_f32_16x16x32_bf16 v[132:135], v[52:55], v[32:35], v[132:135]
ds_read_b64_tr_b16 v[124:125], v16 offset:49152
v_mfma_f32_16x16x32_bf16 v[160:163], v[56:59], v[32:35], v[160:163]
ds_read_b64_tr_b16 v[126:127], v16 offset:53248
v_mfma_f32_16x16x32_bf16 v[168:171], v[56:59], v[36:39], v[168:171]
ds_read_b128 v[100:103], v18 offset:33792
v_mfma_f32_16x16x32_bf16 v[176:179], v[56:59], v[40:43], v[176:179]
ds_read_b128 v[104:107], v18 offset:34816
v_mfma_f32_16x16x32_bf16 v[184:187], v[56:59], v[44:47], v[184:187]
ds_read_b128 v[108:111], v18 offset:35840
v_mfma_f32_16x16x32_bf16 v[188:191], v[60:63], v[44:47], v[188:191]
ds_read_b128 v[192:195], v18 offset:40960
v_mfma_f32_16x16x32_bf16 v[180:183], v[60:63], v[40:43], v[180:183]
ds_read_b64_tr_b16 v[208:209], v13 offset:57344
v_mfma_f32_16x16x32_bf16 v[172:175], v[60:63], v[36:39], v[172:175]
ds_read_b64_tr_b16 v[210:211], v13 offset:61440
v_mfma_f32_16x16x32_bf16 v[164:167], v[60:63], v[32:35], v[164:167]
ds_read_b64_tr_b16 v[212:213], v14 offset:57344
v_mfma_f32_16x16x32_bf16 v[128:131], v[80:83], v[64:67], v[128:131]
ds_read_b64_tr_b16 v[214:215], v14 offset:61440
v_mfma_f32_16x16x32_bf16 v[136:139], v[80:83], v[68:71], v[136:139]
ds_read_b64_tr_b16 v[216:217], v15 offset:57344
v_mfma_f32_16x16x32_bf16 v[144:147], v[80:83], v[72:75], v[144:147]
ds_read_b64_tr_b16 v[218:219], v15 offset:61440
v_mfma_f32_16x16x32_bf16 v[152:155], v[80:83], v[76:79], v[152:155]
ds_read_b64_tr_b16 v[220:221], v16 offset:57344
v_mfma_f32_16x16x32_bf16 v[156:159], v[84:87], v[76:79], v[156:159]
ds_read_b64_tr_b16 v[222:223], v16 offset:61440
v_mfma_f32_16x16x32_bf16 v[148:151], v[84:87], v[72:75], v[148:151]
ds_read_b128 v[196:199], v18 offset:41984
v_mfma_f32_16x16x32_bf16 v[140:143], v[84:87], v[68:71], v[140:143]
ds_read_b128 v[200:203], v18 offset:43008
v_mfma_f32_16x16x32_bf16 v[132:135], v[84:87], v[64:67], v[132:135]
ds_read_b128 v[204:207], v18 offset:44032
v_mfma_f32_16x16x32_bf16 v[160:163], v[88:91], v[64:67], v[160:163]
v_mfma_f32_16x16x32_bf16 v[168:171], v[88:91], v[68:71], v[168:171]
v_mfma_f32_16x16x32_bf16 v[176:179], v[88:91], v[72:75], v[176:179]
v_mfma_f32_16x16x32_bf16 v[184:187], v[88:91], v[76:79], v[184:187]
v_mfma_f32_16x16x32_bf16 v[188:191], v[92:95], v[76:79], v[188:191]
v_mfma_f32_16x16x32_bf16 v[180:183], v[92:95], v[72:75], v[180:183]
v_mfma_f32_16x16x32_bf16 v[172:175], v[92:95], v[68:71], v[172:175]
v_mfma_f32_16x16x32_bf16 v[164:167], v[92:95], v[64:67], v[164:167]
s_waitcnt lgkmcnt(0)
s_barrier
v_mfma_f32_16x16x32_bf16 v[128:131], v[112:115], v[96:99], v[128:131]
ds_read_b128 v[32:35], v19 offset:0
v_mfma_f32_16x16x32_bf16 v[136:139], v[112:115], v[100:103], v[136:139]
ds_read_b64_tr_b16 v[48:49], v9 offset:0
v_mfma_f32_16x16x32_bf16 v[144:147], v[112:115], v[104:107], v[144:147]
ds_read_b64_tr_b16 v[50:51], v9 offset:4096
v_mfma_f32_16x16x32_bf16 v[152:155], v[112:115], v[108:111], v[152:155]
ds_read_b64_tr_b16 v[52:53], v10 offset:0
v_mfma_f32_16x16x32_bf16 v[156:159], v[116:119], v[108:111], v[156:159]
ds_read_b64_tr_b16 v[54:55], v10 offset:4096
v_mfma_f32_16x16x32_bf16 v[148:151], v[116:119], v[104:107], v[148:151]
ds_read_b64_tr_b16 v[56:57], v11 offset:0
v_mfma_f32_16x16x32_bf16 v[140:143], v[116:119], v[100:103], v[140:143]
ds_read_b64_tr_b16 v[58:59], v11 offset:4096
v_mfma_f32_16x16x32_bf16 v[132:135], v[116:119], v[96:99], v[132:135]
ds_read_b64_tr_b16 v[60:61], v12 offset:0
v_mfma_f32_16x16x32_bf16 v[160:163], v[120:123], v[96:99], v[160:163]
ds_read_b64_tr_b16 v[62:63], v12 offset:4096
v_mfma_f32_16x16x32_bf16 v[168:171], v[120:123], v[100:103], v[168:171]
ds_read_b128 v[36:39], v19 offset:1024
v_mfma_f32_16x16x32_bf16 v[176:179], v[120:123], v[104:107], v[176:179]
ds_read_b128 v[40:43], v19 offset:2048
v_mfma_f32_16x16x32_bf16 v[184:187], v[120:123], v[108:111], v[184:187]
ds_read_b128 v[44:47], v19 offset:3072
v_mfma_f32_16x16x32_bf16 v[188:191], v[124:127], v[108:111], v[188:191]
ds_read_b128 v[64:67], v19 offset:8192
v_mfma_f32_16x16x32_bf16 v[180:183], v[124:127], v[104:107], v[180:183]
ds_read_b64_tr_b16 v[80:81], v9 offset:8192
v_mfma_f32_16x16x32_bf16 v[172:175], v[124:127], v[100:103], v[172:175]
ds_read_b64_tr_b16 v[82:83], v9 offset:12288
v_mfma_f32_16x16x32_bf16 v[164:167], v[124:127], v[96:99], v[164:167]
ds_read_b64_tr_b16 v[84:85], v10 offset:8192
v_mfma_f32_16x16x32_bf16 v[128:131], v[208:211], v[192:195], v[128:131]
ds_read_b64_tr_b16 v[86:87], v10 offset:12288
v_mfma_f32_16x16x32_bf16 v[136:139], v[208:211], v[196:199], v[136:139]
ds_read_b64_tr_b16 v[88:89], v11 offset:8192
v_mfma_f32_16x16x32_bf16 v[144:147], v[208:211], v[200:203], v[144:147]
ds_read_b64_tr_b16 v[90:91], v11 offset:12288
v_mfma_f32_16x16x32_bf16 v[152:155], v[208:211], v[204:207], v[152:155]
ds_read_b64_tr_b16 v[92:93], v12 offset:8192
v_mfma_f32_16x16x32_bf16 v[156:159], v[212:215], v[204:207], v[156:159]
ds_read_b64_tr_b16 v[94:95], v12 offset:12288
v_mfma_f32_16x16x32_bf16 v[148:151], v[212:215], v[200:203], v[148:151]
ds_read_b128 v[68:71], v19 offset:9216
v_mfma_f32_16x16x32_bf16 v[140:143], v[212:215], v[196:199], v[140:143]
ds_read_b128 v[72:75], v19 offset:10240
v_mfma_f32_16x16x32_bf16 v[132:135], v[212:215], v[192:195], v[132:135]
ds_read_b128 v[76:79], v19 offset:11264
v_mfma_f32_16x16x32_bf16 v[160:163], v[216:219], v[192:195], v[160:163]
v_mfma_f32_16x16x32_bf16 v[168:171], v[216:219], v[196:199], v[168:171]
v_mfma_f32_16x16x32_bf16 v[176:179], v[216:219], v[200:203], v[176:179]
v_mfma_f32_16x16x32_bf16 v[184:187], v[216:219], v[204:207], v[184:187]
v_mfma_f32_16x16x32_bf16 v[188:191], v[220:223], v[204:207], v[188:191]
v_mfma_f32_16x16x32_bf16 v[180:183], v[220:223], v[200:203], v[180:183]
v_mfma_f32_16x16x32_bf16 v[172:175], v[220:223], v[196:199], v[172:175]
v_mfma_f32_16x16x32_bf16 v[164:167], v[220:223], v[192:195], v[164:167]
s_waitcnt lgkmcnt(0)
s_barrier
v_mfma_f32_16x16x32_bf16 v[128:131], v[48:51], v[32:35], v[128:131]
ds_read_b128 v[96:99], v17 offset:16384
v_mfma_f32_16x16x32_bf16 v[136:139], v[48:51], v[36:39], v[136:139]
ds_read_b64_tr_b16 v[112:113], v9 offset:32768
v_mfma_f32_16x16x32_bf16 v[144:147], v[48:51], v[40:43], v[144:147]
ds_read_b64_tr_b16 v[114:115], v9 offset:36864
v_mfma_f32_16x16x32_bf16 v[152:155], v[48:51], v[44:47], v[152:155]
ds_read_b64_tr_b16 v[116:117], v10 offset:32768
v_mfma_f32_16x16x32_bf16 v[156:159], v[52:55], v[44:47], v[156:159]
ds_read_b64_tr_b16 v[118:119], v10 offset:36864
v_mfma_f32_16x16x32_bf16 v[148:151], v[52:55], v[40:43], v[148:151]
ds_read_b64_tr_b16 v[120:121], v11 offset:32768
v_mfma_f32_16x16x32_bf16 v[140:143], v[52:55], v[36:39], v[140:143]
ds_read_b64_tr_b16 v[122:123], v11 offset:36864
v_mfma_f32_16x16x32_bf16 v[132:135], v[52:55], v[32:35], v[132:135]
ds_read_b64_tr_b16 v[124:125], v12 offset:32768
v_mfma_f32_16x16x32_bf16 v[160:163], v[56:59], v[32:35], v[160:163]
ds_read_b64_tr_b16 v[126:127], v12 offset:36864
v_mfma_f32_16x16x32_bf16 v[168:171], v[56:59], v[36:39], v[168:171]
ds_read_b128 v[100:103], v17 offset:17408
v_mfma_f32_16x16x32_bf16 v[176:179], v[56:59], v[40:43], v[176:179]
ds_read_b128 v[104:107], v17 offset:18432
v_mfma_f32_16x16x32_bf16 v[184:187], v[56:59], v[44:47], v[184:187]
ds_read_b128 v[108:111], v17 offset:19456
v_mfma_f32_16x16x32_bf16 v[188:191], v[60:63], v[44:47], v[188:191]
ds_read_b128 v[192:195], v17 offset:24576
v_mfma_f32_16x16x32_bf16 v[180:183], v[60:63], v[40:43], v[180:183]
ds_read_b64_tr_b16 v[208:209], v9 offset:40960
v_mfma_f32_16x16x32_bf16 v[172:175], v[60:63], v[36:39], v[172:175]
ds_read_b64_tr_b16 v[210:211], v9 offset:45056
v_mfma_f32_16x16x32_bf16 v[164:167], v[60:63], v[32:35], v[164:167]
ds_read_b64_tr_b16 v[212:213], v10 offset:40960
v_mfma_f32_16x16x32_bf16 v[128:131], v[80:83], v[64:67], v[128:131]
ds_read_b64_tr_b16 v[214:215], v10 offset:45056
v_mfma_f32_16x16x32_bf16 v[136:139], v[80:83], v[68:71], v[136:139]
ds_read_b64_tr_b16 v[216:217], v11 offset:40960
v_mfma_f32_16x16x32_bf16 v[144:147], v[80:83], v[72:75], v[144:147]
ds_read_b64_tr_b16 v[218:219], v11 offset:45056
v_mfma_f32_16x16x32_bf16 v[152:155], v[80:83], v[76:79], v[152:155]
ds_read_b64_tr_b16 v[220:221], v12 offset:40960
v_mfma_f32_16x16x32_bf16 v[156:159], v[84:87], v[76:79], v[156:159]
ds_read_b64_tr_b16 v[222:223], v12 offset:45056
v_mfma_f32_16x16x32_bf16 v[148:151], v[84:87], v[72:75], v[148:151]
ds_read_b128 v[196:199], v17 offset:25600
v_mfma_f32_16x16x32_bf16 v[140:143], v[84:87], v[68:71], v[140:143]
ds_read_b128 v[200:203], v17 offset:26624
v_mfma_f32_16x16x32_bf16 v[132:135], v[84:87], v[64:67], v[132:135]
ds_read_b128 v[204:207], v17 offset:27648
v_mfma_f32_16x16x32_bf16 v[160:163], v[88:91], v[64:67], v[160:163]
v_mfma_f32_16x16x32_bf16 v[168:171], v[88:91], v[68:71], v[168:171]
v_mfma_f32_16x16x32_bf16 v[176:179], v[88:91], v[72:75], v[176:179]
v_mfma_f32_16x16x32_bf16 v[184:187], v[88:91], v[76:79], v[184:187]
v_mfma_f32_16x16x32_bf16 v[188:191], v[92:95], v[76:79], v[188:191]
v_mfma_f32_16x16x32_bf16 v[180:183], v[92:95], v[72:75], v[180:183]
v_mfma_f32_16x16x32_bf16 v[172:175], v[92:95], v[68:71], v[172:175]
v_mfma_f32_16x16x32_bf16 v[164:167], v[92:95], v[64:67], v[164:167]
s_waitcnt lgkmcnt(0)
s_barrier
v_mfma_f32_16x16x32_bf16 v[128:131], v[112:115], v[96:99], v[128:131]
ds_read_b128 v[32:35], v17 offset:49152
v_mfma_f32_16x16x32_bf16 v[136:139], v[112:115], v[100:103], v[136:139]
ds_read_b64_tr_b16 v[48:49], v13 offset:0
v_mfma_f32_16x16x32_bf16 v[144:147], v[112:115], v[104:107], v[144:147]
ds_read_b64_tr_b16 v[50:51], v13 offset:4096
v_mfma_f32_16x16x32_bf16 v[152:155], v[112:115], v[108:111], v[152:155]
ds_read_b64_tr_b16 v[52:53], v14 offset:0
v_mfma_f32_16x16x32_bf16 v[156:159], v[116:119], v[108:111], v[156:159]
ds_read_b64_tr_b16 v[54:55], v14 offset:4096
v_mfma_f32_16x16x32_bf16 v[148:151], v[116:119], v[104:107], v[148:151]
ds_read_b64_tr_b16 v[56:57], v15 offset:0
v_mfma_f32_16x16x32_bf16 v[140:143], v[116:119], v[100:103], v[140:143]
ds_read_b64_tr_b16 v[58:59], v15 offset:4096
v_mfma_f32_16x16x32_bf16 v[132:135], v[116:119], v[96:99], v[132:135]
ds_read_b64_tr_b16 v[60:61], v16 offset:0
v_mfma_f32_16x16x32_bf16 v[160:163], v[120:123], v[96:99], v[160:163]
ds_read_b64_tr_b16 v[62:63], v16 offset:4096
v_mfma_f32_16x16x32_bf16 v[168:171], v[120:123], v[100:103], v[168:171]
ds_read_b128 v[36:39], v17 offset:50176
v_mfma_f32_16x16x32_bf16 v[176:179], v[120:123], v[104:107], v[176:179]
ds_read_b128 v[40:43], v17 offset:51200
v_mfma_f32_16x16x32_bf16 v[184:187], v[120:123], v[108:111], v[184:187]
ds_read_b128 v[44:47], v17 offset:52224
v_mfma_f32_16x16x32_bf16 v[188:191], v[124:127], v[108:111], v[188:191]
ds_read_b128 v[64:67], v17 offset:57344
v_mfma_f32_16x16x32_bf16 v[180:183], v[124:127], v[104:107], v[180:183]
ds_read_b64_tr_b16 v[80:81], v13 offset:8192
v_mfma_f32_16x16x32_bf16 v[172:175], v[124:127], v[100:103], v[172:175]
ds_read_b64_tr_b16 v[82:83], v13 offset:12288
v_mfma_f32_16x16x32_bf16 v[164:167], v[124:127], v[96:99], v[164:167]
ds_read_b64_tr_b16 v[84:85], v14 offset:8192
v_mfma_f32_16x16x32_bf16 v[128:131], v[208:211], v[192:195], v[128:131]
ds_read_b64_tr_b16 v[86:87], v14 offset:12288
v_mfma_f32_16x16x32_bf16 v[136:139], v[208:211], v[196:199], v[136:139]
ds_read_b64_tr_b16 v[88:89], v15 offset:8192
v_mfma_f32_16x16x32_bf16 v[144:147], v[208:211], v[200:203], v[144:147]
ds_read_b64_tr_b16 v[90:91], v15 offset:12288
v_mfma_f32_16x16x32_bf16 v[152:155], v[208:211], v[204:207], v[152:155]
ds_read_b64_tr_b16 v[92:93], v16 offset:8192
v_mfma_f32_16x16x32_bf16 v[156:159], v[212:215], v[204:207], v[156:159]
ds_read_b64_tr_b16 v[94:95], v16 offset:12288
v_mfma_f32_16x16x32_bf16 v[148:151], v[212:215], v[200:203], v[148:151]
ds_read_b128 v[68:71], v17 offset:58368
v_mfma_f32_16x16x32_bf16 v[140:143], v[212:215], v[196:199], v[140:143]
ds_read_b128 v[72:75], v17 offset:59392
v_mfma_f32_16x16x32_bf16 v[132:135], v[212:215], v[192:195], v[132:135]
ds_read_b128 v[76:79], v17 offset:60416
v_mfma_f32_16x16x32_bf16 v[160:163], v[216:219], v[192:195], v[160:163]
v_mfma_f32_16x16x32_bf16 v[168:171], v[216:219], v[196:199], v[168:171]
v_mfma_f32_16x16x32_bf16 v[176:179], v[216:219], v[200:203], v[176:179]
v_mfma_f32_16x16x32_bf16 v[184:187], v[216:219], v[204:207], v[184:187]
v_mfma_f32_16x16x32_bf16 v[188:191], v[220:223], v[204:207], v[188:191]
v_mfma_f32_16x16x32_bf16 v[180:183], v[220:223], v[200:203], v[180:183]
v_mfma_f32_16x16x32_bf16 v[172:175], v[220:223], v[196:199], v[172:175]
v_mfma_f32_16x16x32_bf16 v[164:167], v[220:223], v[192:195], v[164:167]
s_waitcnt lgkmcnt(0)
s_barrier
v_mfma_f32_16x16x32_bf16 v[128:131], v[48:51], v[32:35], v[128:131]
ds_read_b128 v[96:99], v18 offset:16384
v_mfma_f32_16x16x32_bf16 v[136:139], v[48:51], v[36:39], v[136:139]
ds_read_b64_tr_b16 v[112:113], v25 offset:16384
v_mfma_f32_16x16x32_bf16 v[144:147], v[48:51], v[40:43], v[144:147]
ds_read_b64_tr_b16 v[114:115], v25 offset:20480
v_mfma_f32_16x16x32_bf16 v[152:155], v[48:51], v[44:47], v[152:155]
ds_read_b64_tr_b16 v[116:117], v26 offset:16384
v_mfma_f32_16x16x32_bf16 v[156:159], v[52:55], v[44:47], v[156:159]
ds_read_b64_tr_b16 v[118:119], v26 offset:20480
v_mfma_f32_16x16x32_bf16 v[148:151], v[52:55], v[40:43], v[148:151]
ds_read_b64_tr_b16 v[120:121], v27 offset:16384
v_mfma_f32_16x16x32_bf16 v[140:143], v[52:55], v[36:39], v[140:143]
ds_read_b64_tr_b16 v[122:123], v27 offset:20480
v_mfma_f32_16x16x32_bf16 v[132:135], v[52:55], v[32:35], v[132:135]
ds_read_b64_tr_b16 v[124:125], v28 offset:16384
v_mfma_f32_16x16x32_bf16 v[160:163], v[56:59], v[32:35], v[160:163]
ds_read_b64_tr_b16 v[126:127], v28 offset:20480
v_mfma_f32_16x16x32_bf16 v[168:171], v[56:59], v[36:39], v[168:171]
ds_read_b128 v[100:103], v18 offset:17408
v_mfma_f32_16x16x32_bf16 v[176:179], v[56:59], v[40:43], v[176:179]
ds_read_b128 v[104:107], v18 offset:18432
v_mfma_f32_16x16x32_bf16 v[184:187], v[56:59], v[44:47], v[184:187]
ds_read_b128 v[108:111], v18 offset:19456
v_mfma_f32_16x16x32_bf16 v[188:191], v[60:63], v[44:47], v[188:191]
ds_read_b128 v[192:195], v18 offset:24576
v_mfma_f32_16x16x32_bf16 v[180:183], v[60:63], v[40:43], v[180:183]
ds_read_b64_tr_b16 v[208:209], v25 offset:24576
v_mfma_f32_16x16x32_bf16 v[172:175], v[60:63], v[36:39], v[172:175]
ds_read_b64_tr_b16 v[210:211], v25 offset:28672
v_mfma_f32_16x16x32_bf16 v[164:167], v[60:63], v[32:35], v[164:167]
ds_read_b64_tr_b16 v[212:213], v26 offset:24576
v_mfma_f32_16x16x32_bf16 v[128:131], v[80:83], v[64:67], v[128:131]
ds_read_b64_tr_b16 v[214:215], v26 offset:28672
v_mfma_f32_16x16x32_bf16 v[136:139], v[80:83], v[68:71], v[136:139]
ds_read_b64_tr_b16 v[216:217], v27 offset:24576
v_mfma_f32_16x16x32_bf16 v[144:147], v[80:83], v[72:75], v[144:147]
ds_read_b64_tr_b16 v[218:219], v27 offset:28672
v_mfma_f32_16x16x32_bf16 v[152:155], v[80:83], v[76:79], v[152:155]
ds_read_b64_tr_b16 v[220:221], v28 offset:24576
v_mfma_f32_16x16x32_bf16 v[156:159], v[84:87], v[76:79], v[156:159]
ds_read_b64_tr_b16 v[222:223], v28 offset:28672
v_mfma_f32_16x16x32_bf16 v[148:151], v[84:87], v[72:75], v[148:151]
ds_read_b128 v[196:199], v18 offset:25600
v_mfma_f32_16x16x32_bf16 v[140:143], v[84:87], v[68:71], v[140:143]
ds_read_b128 v[200:203], v18 offset:26624
v_mfma_f32_16x16x32_bf16 v[132:135], v[84:87], v[64:67], v[132:135]
ds_read_b128 v[204:207], v18 offset:27648
v_mfma_f32_16x16x32_bf16 v[160:163], v[88:91], v[64:67], v[160:163]
v_mfma_f32_16x16x32_bf16 v[168:171], v[88:91], v[68:71], v[168:171]
v_mfma_f32_16x16x32_bf16 v[176:179], v[88:91], v[72:75], v[176:179]
v_mfma_f32_16x16x32_bf16 v[184:187], v[88:91], v[76:79], v[184:187]
v_mfma_f32_16x16x32_bf16 v[188:191], v[92:95], v[76:79], v[188:191]
v_mfma_f32_16x16x32_bf16 v[180:183], v[92:95], v[72:75], v[180:183]
v_mfma_f32_16x16x32_bf16 v[172:175], v[92:95], v[68:71], v[172:175]
v_mfma_f32_16x16x32_bf16 v[164:167], v[92:95], v[64:67], v[164:167]
s_waitcnt lgkmcnt(0)
s_barrier
v_mfma_f32_16x16x32_bf16 v[128:131], v[112:115], v[96:99], v[128:131]
ds_read_b128 v[32:35], v18 offset:32768
v_mfma_f32_16x16x32_bf16 v[136:139], v[112:115], v[100:103], v[136:139]
ds_read_b64_tr_b16 v[48:49], v13 offset:49152
v_mfma_f32_16x16x32_bf16 v[144:147], v[112:115], v[104:107], v[144:147]
ds_read_b64_tr_b16 v[50:51], v13 offset:53248
v_mfma_f32_16x16x32_bf16 v[152:155], v[112:115], v[108:111], v[152:155]
ds_read_b64_tr_b16 v[52:53], v14 offset:49152
v_mfma_f32_16x16x32_bf16 v[156:159], v[116:119], v[108:111], v[156:159]
ds_read_b64_tr_b16 v[54:55], v14 offset:53248
v_mfma_f32_16x16x32_bf16 v[148:151], v[116:119], v[104:107], v[148:151]
ds_read_b64_tr_b16 v[56:57], v15 offset:49152
v_mfma_f32_16x16x32_bf16 v[140:143], v[116:119], v[100:103], v[140:143]
ds_read_b64_tr_b16 v[58:59], v15 offset:53248
v_mfma_f32_16x16x32_bf16 v[132:135], v[116:119], v[96:99], v[132:135]
ds_read_b64_tr_b16 v[60:61], v16 offset:49152
v_mfma_f32_16x16x32_bf16 v[160:163], v[120:123], v[96:99], v[160:163]
ds_read_b64_tr_b16 v[62:63], v16 offset:53248
v_mfma_f32_16x16x32_bf16 v[168:171], v[120:123], v[100:103], v[168:171]
ds_read_b128 v[36:39], v18 offset:33792
v_mfma_f32_16x16x32_bf16 v[176:179], v[120:123], v[104:107], v[176:179]
ds_read_b128 v[40:43], v18 offset:34816
v_mfma_f32_16x16x32_bf16 v[184:187], v[120:123], v[108:111], v[184:187]
ds_read_b128 v[44:47], v18 offset:35840
v_mfma_f32_16x16x32_bf16 v[188:191], v[124:127], v[108:111], v[188:191]
ds_read_b128 v[64:67], v18 offset:40960
v_mfma_f32_16x16x32_bf16 v[180:183], v[124:127], v[104:107], v[180:183]
ds_read_b64_tr_b16 v[80:81], v13 offset:57344
v_mfma_f32_16x16x32_bf16 v[172:175], v[124:127], v[100:103], v[172:175]
ds_read_b64_tr_b16 v[82:83], v13 offset:61440
v_mfma_f32_16x16x32_bf16 v[164:167], v[124:127], v[96:99], v[164:167]
ds_read_b64_tr_b16 v[84:85], v14 offset:57344
v_mfma_f32_16x16x32_bf16 v[128:131], v[208:211], v[192:195], v[128:131]
ds_read_b64_tr_b16 v[86:87], v14 offset:61440
v_mfma_f32_16x16x32_bf16 v[136:139], v[208:211], v[196:199], v[136:139]
ds_read_b64_tr_b16 v[88:89], v15 offset:57344
v_mfma_f32_16x16x32_bf16 v[144:147], v[208:211], v[200:203], v[144:147]
ds_read_b64_tr_b16 v[90:91], v15 offset:61440
v_mfma_f32_16x16x32_bf16 v[152:155], v[208:211], v[204:207], v[152:155]
ds_read_b64_tr_b16 v[92:93], v16 offset:57344
v_mfma_f32_16x16x32_bf16 v[156:159], v[212:215], v[204:207], v[156:159]
ds_read_b64_tr_b16 v[94:95], v16 offset:61440
v_mfma_f32_16x16x32_bf16 v[148:151], v[212:215], v[200:203], v[148:151]
ds_read_b128 v[68:71], v18 offset:41984
v_mfma_f32_16x16x32_bf16 v[140:143], v[212:215], v[196:199], v[140:143]
ds_read_b128 v[72:75], v18 offset:43008
v_mfma_f32_16x16x32_bf16 v[132:135], v[212:215], v[192:195], v[132:135]
ds_read_b128 v[76:79], v18 offset:44032
v_mfma_f32_16x16x32_bf16 v[160:163], v[216:219], v[192:195], v[160:163]
v_mfma_f32_16x16x32_bf16 v[168:171], v[216:219], v[196:199], v[168:171]
v_mfma_f32_16x16x32_bf16 v[176:179], v[216:219], v[200:203], v[176:179]
v_mfma_f32_16x16x32_bf16 v[184:187], v[216:219], v[204:207], v[184:187]
v_mfma_f32_16x16x32_bf16 v[188:191], v[220:223], v[204:207], v[188:191]
v_mfma_f32_16x16x32_bf16 v[180:183], v[220:223], v[200:203], v[180:183]
v_mfma_f32_16x16x32_bf16 v[172:175], v[220:223], v[196:199], v[172:175]
v_mfma_f32_16x16x32_bf16 v[164:167], v[220:223], v[192:195], v[164:167]
s_waitcnt lgkmcnt(0)
s_barrier
v_mfma_f32_16x16x32_bf16 v[128:131], v[48:51], v[32:35], v[128:131]
ds_read_b128 v[96:99], v19 offset:0
v_mfma_f32_16x16x32_bf16 v[136:139], v[48:51], v[36:39], v[136:139]
ds_read_b64_tr_b16 v[112:113], v9 offset:0
v_mfma_f32_16x16x32_bf16 v[144:147], v[48:51], v[40:43], v[144:147]
ds_read_b64_tr_b16 v[114:115], v9 offset:4096
v_mfma_f32_16x16x32_bf16 v[152:155], v[48:51], v[44:47], v[152:155]
ds_read_b64_tr_b16 v[116:117], v10 offset:0
v_mfma_f32_16x16x32_bf16 v[156:159], v[52:55], v[44:47], v[156:159]
ds_read_b64_tr_b16 v[118:119], v10 offset:4096
v_mfma_f32_16x16x32_bf16 v[148:151], v[52:55], v[40:43], v[148:151]
ds_read_b64_tr_b16 v[120:121], v11 offset:0
v_mfma_f32_16x16x32_bf16 v[140:143], v[52:55], v[36:39], v[140:143]
ds_read_b64_tr_b16 v[122:123], v11 offset:4096
v_mfma_f32_16x16x32_bf16 v[132:135], v[52:55], v[32:35], v[132:135]
ds_read_b64_tr_b16 v[124:125], v12 offset:0
v_mfma_f32_16x16x32_bf16 v[160:163], v[56:59], v[32:35], v[160:163]
ds_read_b64_tr_b16 v[126:127], v12 offset:4096
v_mfma_f32_16x16x32_bf16 v[168:171], v[56:59], v[36:39], v[168:171]
ds_read_b128 v[100:103], v19 offset:1024
v_mfma_f32_16x16x32_bf16 v[176:179], v[56:59], v[40:43], v[176:179]
ds_read_b128 v[104:107], v19 offset:2048
v_mfma_f32_16x16x32_bf16 v[184:187], v[56:59], v[44:47], v[184:187]
ds_read_b128 v[108:111], v19 offset:3072
v_mfma_f32_16x16x32_bf16 v[188:191], v[60:63], v[44:47], v[188:191]
ds_read_b128 v[192:195], v19 offset:8192
v_mfma_f32_16x16x32_bf16 v[180:183], v[60:63], v[40:43], v[180:183]
ds_read_b64_tr_b16 v[208:209], v9 offset:8192
v_mfma_f32_16x16x32_bf16 v[172:175], v[60:63], v[36:39], v[172:175]
ds_read_b64_tr_b16 v[210:211], v9 offset:12288
v_mfma_f32_16x16x32_bf16 v[164:167], v[60:63], v[32:35], v[164:167]
ds_read_b64_tr_b16 v[212:213], v10 offset:8192
v_mfma_f32_16x16x32_bf16 v[128:131], v[80:83], v[64:67], v[128:131]
ds_read_b64_tr_b16 v[214:215], v10 offset:12288
v_mfma_f32_16x16x32_bf16 v[136:139], v[80:83], v[68:71], v[136:139]
ds_read_b64_tr_b16 v[216:217], v11 offset:8192
v_mfma_f32_16x16x32_bf16 v[144:147], v[80:83], v[72:75], v[144:147]
ds_read_b64_tr_b16 v[218:219], v11 offset:12288
v_mfma_f32_16x16x32_bf16 v[152:155], v[80:83], v[76:79], v[152:155]
ds_read_b64_tr_b16 v[220:221], v12 offset:8192
v_mfma_f32_16x16x32_bf16 v[156:159], v[84:87], v[76:79], v[156:159]
ds_read_b64_tr_b16 v[222:223], v12 offset:12288
v_mfma_f32_16x16x32_bf16 v[148:151], v[84:87], v[72:75], v[148:151]
ds_read_b128 v[196:199], v19 offset:9216
v_mfma_f32_16x16x32_bf16 v[140:143], v[84:87], v[68:71], v[140:143]
ds_read_b128 v[200:203], v19 offset:10240
v_mfma_f32_16x16x32_bf16 v[132:135], v[84:87], v[64:67], v[132:135]
ds_read_b128 v[204:207], v19 offset:11264
v_mfma_f32_16x16x32_bf16 v[160:163], v[88:91], v[64:67], v[160:163]
v_mfma_f32_16x16x32_bf16 v[168:171], v[88:91], v[68:71], v[168:171]
v_mfma_f32_16x16x32_bf16 v[176:179], v[88:91], v[72:75], v[176:179]
v_mfma_f32_16x16x32_bf16 v[184:187], v[88:91], v[76:79], v[184:187]
v_mfma_f32_16x16x32_bf16 v[188:191], v[92:95], v[76:79], v[188:191]
v_mfma_f32_16x16x32_bf16 v[180:183], v[92:95], v[72:75], v[180:183]
v_mfma_f32_16x16x32_bf16 v[172:175], v[92:95], v[68:71], v[172:175]
v_mfma_f32_16x16x32_bf16 v[164:167], v[92:95], v[64:67], v[164:167]
s_sub_u32 s41, s41, 1
s_cmp_lg_u32 s41, 0
s_cbranch_scc1 Lk4_131
s_waitcnt lgkmcnt(0)
s_barrier
v_mfma_f32_16x16x32_bf16 v[128:131], v[112:115], v[96:99], v[128:131]
ds_read_b128 v[32:35], v17 offset:16384
v_mfma_f32_16x16x32_bf16 v[136:139], v[112:115], v[100:103], v[136:139]
ds_read_b64_tr_b16 v[48:49], v224 offset:32768
v_mfma_f32_16x16x32_bf16 v[144:147], v[112:115], v[104:107], v[144:147]
ds_read_b64_tr_b16 v[50:51], v224 offset:34816
v_mfma_f32_16x16x32_bf16 v[152:155], v[112:115], v[108:111], v[152:155]
ds_read_b64_tr_b16 v[52:53], v225 offset:32768
v_mfma_f32_16x16x32_bf16 v[156:159], v[116:119], v[108:111], v[156:159]
ds_read_b64_tr_b16 v[54:55], v225 offset:34816
v_mfma_f32_16x16x32_bf16 v[148:151], v[116:119], v[104:107], v[148:151]
ds_read_b128 v[36:39], v17 offset:17408
v_mfma_f32_16x16x32_bf16 v[140:143], v[116:119], v[100:103], v[140:143]
ds_read_b128 v[40:43], v17 offset:18432
v_mfma_f32_16x16x32_bf16 v[132:135], v[116:119], v[96:99], v[132:135]
ds_read_b128 v[44:47], v17 offset:19456
v_mfma_f32_16x16x32_bf16 v[160:163], v[120:123], v[96:99], v[160:163]
ds_read_b128 v[64:67], v17 offset:24576
v_mfma_f32_16x16x32_bf16 v[168:171], v[120:123], v[100:103], v[168:171]
ds_read_b64_tr_b16 v[80:81], v224 offset:36864
v_mfma_f32_16x16x32_bf16 v[176:179], v[120:123], v[104:107], v[176:179]
ds_read_b64_tr_b16 v[82:83], v224 offset:38912
v_mfma_f32_16x16x32_bf16 v[184:187], v[120:123], v[108:111], v[184:187]
ds_read_b64_tr_b16 v[84:85], v225 offset:36864
v_mfma_f32_16x16x32_bf16 v[188:191], v[124:127], v[108:111], v[188:191]
ds_read_b64_tr_b16 v[86:87], v225 offset:38912
v_mfma_f32_16x16x32_bf16 v[180:183], v[124:127], v[104:107], v[180:183]
ds_read_b128 v[68:71], v17 offset:25600
v_mfma_f32_16x16x32_bf16 v[172:175], v[124:127], v[100:103], v[172:175]
ds_read_b128 v[72:75], v17 offset:26624
v_mfma_f32_16x16x32_bf16 v[164:167], v[124:127], v[96:99], v[164:167]
ds_read_b128 v[76:79], v17 offset:27648
v_mfma_f32_16x16x32_bf16 v[128:131], v[208:211], v[192:195], v[128:131]
v_mfma_f32_16x16x32_bf16 v[136:139], v[208:211], v[196:199], v[136:139]
v_mfma_f32_16x16x32_bf16 v[144:147], v[208:211], v[200:203], v[144:147]
v_mfma_f32_16x16x32_bf16 v[152:155], v[208:211], v[204:207], v[152:155]
v_mfma_f32_16x16x32_bf16 v[156:159], v[212:215], v[204:207], v[156:159]
v_mfma_f32_16x16x32_bf16 v[148:151], v[212:215], v[200:203], v[148:151]
v_mfma_f32_16x16x32_bf16 v[140:143], v[212:215], v[196:199], v[140:143]
v_mfma_f32_16x16x32_bf16 v[132:135], v[212:215], v[192:195], v[132:135]
v_mfma_f32_16x16x32_bf16 v[160:163], v[216:219], v[192:195], v[160:163]
v_mfma_f32_16x16x32_bf16 v[168:171], v[216:219], v[196:199], v[168:171]
v_mfma_f32_16x16x32_bf16 v[176:179], v[216:219], v[200:203], v[176:179]
v_mfma_f32_16x16x32_bf16 v[184:187], v[216:219], v[204:207], v[184:187]
v_mfma_f32_16x16x32_bf16 v[188:191], v[220:223], v[204:207], v[188:191]
v_mfma_f32_16x16x32_bf16 v[180:183], v[220:223], v[200:203], v[180:183]
v_mfma_f32_16x16x32_bf16 v[172:175], v[220:223], v[196:199], v[172:175]
v_mfma_f32_16x16x32_bf16 v[164:167], v[220:223], v[192:195], v[164:167]
s_waitcnt lgkmcnt(0)
s_barrier
v_mfma_f32_16x16x32_bf16 v[128:131], v[48:51], v[32:35], v[128:131]
ds_read_b128 v[96:99], v17 offset:49152
ds_read_b64_tr_b16 v[112:113], v226 offset:0
v_mfma_f32_16x16x32_bf16 v[136:139], v[48:51], v[36:39], v[136:139]
ds_read_b64_tr_b16 v[114:115], v226 offset:2048
ds_read_b64_tr_b16 v[116:117], v227 offset:0
s_branch Lov_12
.p2align 12
.fill 96, 4, 0xbf800000
Lst_12_0:
s_branch Lwr_167
Lst_12_1:
s_branch Lst_16_0
s_nop 0
Lov_12:
v_mfma_f32_16x16x32_bf16 v[144:147], v[48:51], v[40:43], v[144:147]
ds_read_b64_tr_b16 v[118:119], v227 offset:2048
ds_read_b128 v[100:103], v17 offset:50176
v_mfma_f32_16x16x32_bf16 v[152:155], v[48:51], v[44:47], v[152:155]
ds_read_b128 v[104:107], v17 offset:51200
ds_read_b128 v[108:111], v17 offset:52224
v_mfma_f32_16x16x32_bf16 v[156:159], v[52:55], v[44:47], v[156:159]
ds_read_b128 v[192:195], v17 offset:57344
v_mfma_f32_16x16x32_bf16 v[148:151], v[52:55], v[40:43], v[148:151]
ds_read_b64_tr_b16 v[208:209], v226 offset:4096
v_mfma_f32_16x16x32_bf16 v[140:143], v[52:55], v[36:39], v[140:143]
ds_read_b64_tr_b16 v[210:211], v226 offset:6144
v_cvt_pk_bf16_f32 v160, v160, v161
v_cvt_pk_bf16_f32 v161, v162, v163
v_mfma_f32_16x16x32_bf16 v[132:135], v[52:55], v[32:35], v[132:135]
ds_read_b64_tr_b16 v[212:213], v227 offset:4096
v_cvt_pk_bf16_f32 v162, v164, v165
v_cvt_pk_bf16_f32 v163, v166, v167
v_mfma_f32_16x16x32_bf16 v[128:131], v[80:83], v[64:67], v[128:131]
ds_read_b64_tr_b16 v[214:215], v227 offset:6144
v_cvt_pk_bf16_f32 v164, v168, v169
v_cvt_pk_bf16_f32 v165, v170, v171
v_mfma_f32_16x16x32_bf16 v[136:139], v[80:83], v[68:71], v[136:139]
ds_read_b128 v[196:199], v17 offset:58368
v_cvt_pk_bf16_f32 v166, v172, v173
v_cvt_pk_bf16_f32 v167, v174, v175
v_mfma_f32_16x16x32_bf16 v[144:147], v[80:83], v[72:75], v[144:147]
ds_read_b128 v[200:203], v17 offset:59392
v_cvt_pk_bf16_f32 v168, v176, v177
v_cvt_pk_bf16_f32 v169, v178, v179
v_mfma_f32_16x16x32_bf16 v[152:155], v[80:83], v[76:79], v[152:155]
ds_read_b128 v[204:207], v17 offset:60416
v_cvt_pk_bf16_f32 v170, v180, v181
v_cvt_pk_bf16_f32 v171, v182, v183
v_mfma_f32_16x16x32_bf16 v[156:159], v[84:87], v[76:79], v[156:159]
v_cvt_pk_bf16_f32 v172, v184, v185
v_cvt_pk_bf16_f32 v173, v186, v187
v_mfma_f32_16x16x32_bf16 v[148:151], v[84:87], v[72:75], v[148:151]
v_cvt_pk_bf16_f32 v174, v188, v189
v_cvt_pk_bf16_f32 v175, v190, v191
v_mfma_f32_16x16x32_bf16 v[140:143], v[84:87], v[68:71], v[140:143]
v_mfma_f32_16x16x32_bf16 v[132:135], v[84:87], v[64:67], v[132:135]
buffer_store_dwordx4 v[160:163], v2, s[84:87], s45 offen offset:0 sc1
s_waitcnt lgkmcnt(0)
s_barrier
v_mfma_f32_16x16x32_bf16 v[128:131], v[112:115], v[96:99], v[128:131]
ds_read_b128 v[32:35], v18 offset:16384
ds_read_b64_tr_b16 v[48:49], v228 offset:16384
v_mfma_f32_16x16x32_bf16 v[136:139], v[112:115], v[100:103], v[136:139]
ds_read_b64_tr_b16 v[50:51], v228 offset:18432
ds_read_b64_tr_b16 v[52:53], v229 offset:16384
v_mfma_f32_16x16x32_bf16 v[144:147], v[112:115], v[104:107], v[144:147]
ds_read_b64_tr_b16 v[54:55], v229 offset:18432
ds_read_b128 v[36:39], v18 offset:17408
v_mfma_f32_16x16x32_bf16 v[152:155], v[112:115], v[108:111], v[152:155]
ds_read_b128 v[40:43], v18 offset:18432
ds_read_b128 v[44:47], v18 offset:19456
v_mfma_f32_16x16x32_bf16 v[156:159], v[116:119], v[108:111], v[156:159]
ds_read_b128 v[64:67], v18 offset:24576
v_mfma_f32_16x16x32_bf16 v[148:151], v[116:119], v[104:107], v[148:151]
ds_read_b64_tr_b16 v[80:81], v228 offset:20480
v_mfma_f32_16x16x32_bf16 v[140:143], v[116:119], v[100:103], v[140:143]
ds_read_b64_tr_b16 v[82:83], v228 offset:22528
v_mfma_f32_16x16x32_bf16 v[132:135], v[116:119], v[96:99], v[132:135]
ds_read_b64_tr_b16 v[84:85], v229 offset:20480
v_mfma_f32_16x16x32_bf16 v[128:131], v[208:211], v[192:195], v[128:131]
ds_read_b64_tr_b16 v[86:87], v229 offset:22528
buffer_store_dwordx4 v[164:167], v2, s[84:87], s45 offen offset:1024 sc1
v_mfma_f32_16x16x32_bf16 v[136:139], v[208:211], v[196:199], v[136:139]
ds_read_b128 v[68:71], v18 offset:25600
v_mfma_f32_16x16x32_bf16 v[144:147], v[208:211], v[200:203], v[144:147]
ds_read_b128 v[72:75], v18 offset:26624
v_mfma_f32_16x16x32_bf16 v[152:155], v[208:211], v[204:207], v[152:155]
ds_read_b128 v[76:79], v18 offset:27648
v_mfma_f32_16x16x32_bf16 v[156:159], v[212:215], v[204:207], v[156:159]
v_mfma_f32_16x16x32_bf16 v[148:151], v[212:215], v[200:203], v[148:151]
v_mfma_f32_16x16x32_bf16 v[140:143], v[212:215], v[196:199], v[140:143]
v_mfma_f32_16x16x32_bf16 v[132:135], v[212:215], v[192:195], v[132:135]
s_waitcnt lgkmcnt(0)
s_barrier
v_mfma_f32_16x16x32_bf16 v[128:131], v[48:51], v[32:35], v[128:131]
ds_read_b128 v[96:99], v18 offset:32768
ds_read_b64_tr_b16 v[112:113], v226 offset:49152
v_mfma_f32_16x16x32_bf16 v[136:139], v[48:51], v[36:39], v[136:139]
ds_read_b64_tr_b16 v[114:115], v226 offset:51200
ds_read_b64_tr_b16 v[116:117], v227 offset:49152
v_mfma_f32_16x16x32_bf16 v[144:147], v[48:51], v[40:43], v[144:147]
ds_read_b64_tr_b16 v[118:119], v227 offset:51200
ds_read_b128 v[100:103], v18 offset:33792
v_mfma_f32_16x16x32_bf16 v[152:155], v[48:51], v[44:47], v[152:155]
ds_read_b128 v[104:107], v18 offset:34816
ds_read_b128 v[108:111], v18 offset:35840
v_mfma_f32_16x16x32_bf16 v[156:159], v[52:55], v[44:47], v[156:159]
ds_read_b128 v[192:195], v18 offset:40960
v_mfma_f32_16x16x32_bf16 v[148:151], v[52:55], v[40:43], v[148:151]
ds_read_b64_tr_b16 v[208:209], v226 offset:53248
v_mfma_f32_16x16x32_bf16 v[140:143], v[52:55], v[36:39], v[140:143]
ds_read_b64_tr_b16 v[210:211], v226 offset:55296
v_mfma_f32_16x16x32_bf16 v[132:135], v[52:55], v[32:35], v[132:135]
ds_read_b64_tr_b16 v[212:213], v227 offset:53248
v_mfma_f32_16x16x32_bf16 v[128:131], v[80:83], v[64:67], v[128:131]
ds_read_b64_tr_b16 v[214:215], v227 offset:55296
buffer_store_dwordx4 v[168:171], v2, s[84:87], s45 offen offset:2048 sc1
v_mfma_f32_16x16x32_bf16 v[136:139], v[80:83], v[68:71], v[136:139]
ds_read_b128 v[196:199], v18 offset:41984
v_mfma_f32_16x16x32_bf16 v[144:147], v[80:83], v[72:75], v[144:147]
ds_read_b128 v[200:203], v18 offset:43008
v_mfma_f32_16x16x32_bf16 v[152:155], v[80:83], v[76:79], v[152:155]
ds_read_b128 v[204:207], v18 offset:44032
v_mfma_f32_16x16x32_bf16 v[156:159], v[84:87], v[76:79], v[156:159]
v_mfma_f32_16x16x32_bf16 v[148:151], v[84:87], v[72:75], v[148:151]
v_mfma_f32_16x16x32_bf16 v[140:143], v[84:87], v[68:71], v[140:143]
v_mfma_f32_16x16x32_bf16 v[132:135], v[84:87], v[64:67], v[132:135]
s_waitcnt lgkmcnt(0)
s_barrier
v_mfma_f32_16x16x32_bf16 v[128:131], v[112:115], v[96:99], v[128:131]
ds_read_b128 v[32:35], v19 offset:0
ds_read_b64_tr_b16 v[48:49], v224 offset:0
v_mfma_f32_16x16x32_bf16 v[136:139], v[112:115], v[100:103], v[136:139]
ds_read_b64_tr_b16 v[50:51], v224 offset:2048
ds_read_b64_tr_b16 v[52:53], v225 offset:0
v_mfma_f32_16x16x32_bf16 v[144:147], v[112:115], v[104:107], v[144:147]
ds_read_b64_tr_b16 v[54:55], v225 offset:2048
ds_read_b128 v[36:39], v19 offset:1024
v_mfma_f32_16x16x32_bf16 v[152:155], v[112:115], v[108:111], v[152:155]
ds_read_b128 v[40:43], v19 offset:2048
ds_read_b128 v[44:47], v19 offset:3072
v_mfma_f32_16x16x32_bf16 v[156:159], v[116:119], v[108:111], v[156:159]
ds_read_b128 v[64:67], v19 offset:8192
v_mfma_f32_16x16x32_bf16 v[148:151], v[116:119], v[104:107], v[148:151]
ds_read_b64_tr_b16 v[80:81], v224 offset:4096
v_mfma_f32_16x16x32_bf16 v[140:143], v[116:119], v[100:103], v[140:143]
ds_read_b64_tr_b16 v[82:83], v224 offset:6144
v_mfma_f32_16x16x32_bf16 v[132:135], v[116:119], v[96:99], v[132:135]
ds_read_b64_tr_b16 v[84:85], v225 offset:4096
v_mfma_f32_16x16x32_bf16 v[128:131], v[208:211], v[192:195], v[128:131]
ds_read_b64_tr_b16 v[86:87], v225 offset:6144
buffer_store_dwordx4 v[172:175], v2, s[84:87], s45 offen offset:3072 sc1
v_mfma_f32_16x16x32_bf16 v[136:139], v[208:211], v[196:199], v[136:139]
ds_read_b128 v[68:71], v19 offset:9216
v_mfma_f32_16x16x32_bf16 v[144:147], v[208:211], v[200:203], v[144:147]
ds_read_b128 v[72:75], v19 offset:10240
v_mfma_f32_16x16x32_bf16 v[152:155], v[208:211], v[204:207], v[152:155]
ds_read_b128 v[76:79], v19 offset:11264
v_mfma_f32_16x16x32_bf16 v[156:159], v[212:215], v[204:207], v[156:159]
v_mfma_f32_16x16x32_bf16 v[148:151], v[212:215], v[200:203], v[148:151]
v_mfma_f32_16x16x32_bf16 v[140:143], v[212:215], v[196:199], v[140:143]
v_mfma_f32_16x16x32_bf16 v[132:135], v[212:215], v[192:195], v[132:135]
s_waitcnt lgkmcnt(0)
s_barrier
v_mfma_f32_16x16x32_bf16 v[128:131], v[48:51], v[32:35], v[128:131]
ds_read_b128 v[96:99], v17 offset:16384
ds_read_b64_tr_b16 v[112:113], v224 offset:32768
v_mfma_f32_16x16x32_bf16 v[136:139], v[48:51], v[36:39], v[136:139]
ds_read_b64_tr_b16 v[114:115], v224 offset:34816
ds_read_b64_tr_b16 v[116:117], v225 offset:32768
v_mfma_f32_16x16x32_bf16 v[144:147], v[48:51], v[40:43], v[144:147]
ds_read_b64_tr_b16 v[118:119], v225 offset:34816
ds_read_b128 v[100:103], v17 offset:17408
v_mfma_f32_16x16x32_bf16 v[152:155], v[48:51], v[44:47], v[152:155]
ds_read_b128 v[104:107], v17 offset:18432
ds_read_b128 v[108:111], v17 offset:19456
v_mfma_f32_16x16x32_bf16 v[156:159], v[52:55], v[44:47], v[156:159]
ds_read_b128 v[192:195], v17 offset:24576
v_mfma_f32_16x16x32_bf16 v[148:151], v[52:55], v[40:43], v[148:151]
ds_read_b64_tr_b16 v[208:209], v224 offset:36864
v_mfma_f32_16x16x32_bf16 v[140:143], v[52:55], v[36:39], v[140:143]
ds_read_b64_tr_b16 v[210:211], v224 offset:38912
v_mfma_f32_16x16x32_bf16 v[132:135], v[52:55], v[32:35], v[132:135]
ds_read_b64_tr_b16 v[212:213], v225 offset:36864
v_mfma_f32_16x16x32_bf16 v[128:131], v[80:83], v[64:67], v[128:131]
ds_read_b64_tr_b16 v[214:215], v225 offset:38912
v_mfma_f32_16x16x32_bf16 v[136:139], v[80:83], v[68:71], v[136:139]
ds_read_b128 v[196:199], v17 offset:25600
v_mfma_f32_16x16x32_bf16 v[144:147], v[80:83], v[72:75], v[144:147]
ds_read_b128 v[200:203], v17 offset:26624
v_mfma_f32_16x16x32_bf16 v[152:155], v[80:83], v[76:79], v[152:155]
ds_read_b128 v[204:207], v17 offset:27648
v_mfma_f32_16x16x32_bf16 v[156:159], v[84:87], v[76:79], v[156:159]
v_mfma_f32_16x16x32_bf16 v[148:151], v[84:87], v[72:75], v[148:151]
v_mfma_f32_16x16x32_bf16 v[140:143], v[84:87], v[68:71], v[140:143]
v_mfma_f32_16x16x32_bf16 v[132:135], v[84:87], v[64:67], v[132:135]
s_waitcnt vmcnt(0)
s_waitcnt lgkmcnt(0)
s_barrier
v_mfma_f32_16x16x32_bf16 v[128:131], v[112:115], v[96:99], v[128:131]
ds_read_b128 v[32:35], v17 offset:49152
ds_read_b64_tr_b16 v[48:49], v226 offset:0
v_mfma_f32_16x16x32_bf16 v[136:139], v[112:115], v[100:103], v[136:139]
ds_read_b64_tr_b16 v[50:51], v226 offset:2048
ds_read_b64_tr_b16 v[52:53], v227 offset:0
v_mfma_f32_16x16x32_bf16 v[144:147], v[112:115], v[104:107], v[144:147]
ds_read_b64_tr_b16 v[54:55], v227 offset:2048
ds_read_b128 v[36:39], v17 offset:50176
v_mfma_f32_16x16x32_bf16 v[152:155], v[112:115], v[108:111], v[152:155]
ds_read_b128 v[40:43], v17 offset:51200
ds_read_b128 v[44:47], v17 offset:52224
v_mfma_f32_16x16x32_bf16 v[156:159], v[116:119], v[108:111], v[156:159]
ds_read_b128 v[64:67], v17 offset:57344
v_mfma_f32_16x16x32_bf16 v[148:151], v[116:119], v[104:107], v[148:151]
ds_read_b64_tr_b16 v[80:81], v226 offset:4096
v_mfma_f32_16x16x32_bf16 v[140:143], v[116:119], v[100:103], v[140:143]
ds_read_b64_tr_b16 v[82:83], v226 offset:6144
v_mfma_f32_16x16x32_bf16 v[132:135], v[116:119], v[96:99], v[132:135]
ds_read_b64_tr_b16 v[84:85], v227 offset:4096
v_mfma_f32_16x16x32_bf16 v[128:131], v[208:211], v[192:195], v[128:131]
ds_read_b64_tr_b16 v[86:87], v227 offset:6144
v_mfma_f32_16x16x32_bf16 v[136:139], v[208:211], v[196:199], v[136:139]
ds_read_b128 v[68:71], v17 offset:58368
v_mfma_f32_16x16x32_bf16 v[144:147], v[208:211], v[200:203], v[144:147]
ds_read_b128 v[72:75], v17 offset:59392
v_mfma_f32_16x16x32_bf16 v[152:155], v[208:211], v[204:207], v[152:155]
ds_read_b128 v[76:79], v17 offset:60416
v_mfma_f32_16x16x32_bf16 v[156:159], v[212:215], v[204:207], v[156:159]
v_mfma_f32_16x16x32_bf16 v[148:151], v[212:215], v[200:203], v[148:151]
v_mfma_f32_16x16x32_bf16 v[140:143], v[212:215], v[196:199], v[140:143]
v_mfma_f32_16x16x32_bf16 v[132:135], v[212:215], v[192:195], v[132:135]
s_waitcnt lgkmcnt(0)
s_barrier
v_mfma_f32_16x16x32_bf16 v[128:131], v[48:51], v[32:35], v[128:131]
ds_read_b128 v[96:99], v18 offset:16384
ds_read_b64_tr_b16 v[112:113], v228 offset:16384
v_mfma_f32_16x16x32_bf16 v[136:139], v[48:51], v[36:39], v[136:139]
ds_read_b64_tr_b16 v[114:115], v228 offset:18432
ds_read_b64_tr_b16 v[116:117], v229 offset:16384
v_mfma_f32_16x16x32_bf16 v[144:147], v[48:51], v[40:43], v[144:147]
ds_read_b64_tr_b16 v[118:119], v229 offset:18432
ds_read_b128 v[100:103], v18 offset:17408
v_mfma_f32_16x16x32_bf16 v[152:155], v[48:51], v[44:47], v[152:155]
ds_read_b128 v[104:107], v18 offset:18432
ds_read_b128 v[108:111], v18 offset:19456
v_mfma_f32_16x16x32_bf16 v[156:159], v[52:55], v[44:47], v[156:159]
ds_read_b128 v[192:195], v18 offset:24576
v_mfma_f32_16x16x32_bf16 v[148:151], v[52:55], v[40:43], v[148:151]
ds_read_b64_tr_b16 v[208:209], v228 offset:20480
v_mfma_f32_16x16x32_bf16 v[140:143], v[52:55], v[36:39], v[140:143]
ds_read_b64_tr_b16 v[210:211], v228 offset:22528
v_mfma_f32_16x16x32_bf16 v[132:135], v[52:55], v[32:35], v[132:135]
ds_read_b64_tr_b16 v[212:213], v229 offset:20480
v_mfma_f32_16x16x32_bf16 v[128:131], v[80:83], v[64:67], v[128:131]
ds_read_b64_tr_b16 v[214:215], v229 offset:22528
v_mfma_f32_16x16x32_bf16 v[136:139], v[80:83], v[68:71], v[136:139]
ds_read_b128 v[196:199], v18 offset:25600
v_mfma_f32_16x16x32_bf16 v[144:147], v[80:83], v[72:75], v[144:147]
ds_read_b128 v[200:203], v18 offset:26624
v_mfma_f32_16x16x32_bf16 v[152:155], v[80:83], v[76:79], v[152:155]
ds_read_b128 v[204:207], v18 offset:27648
v_mfma_f32_16x16x32_bf16 v[156:159], v[84:87], v[76:79], v[156:159]
v_mfma_f32_16x16x32_bf16 v[148:151], v[84:87], v[72:75], v[148:151]
v_mfma_f32_16x16x32_bf16 v[140:143], v[84:87], v[68:71], v[140:143]
v_mfma_f32_16x16x32_bf16 v[132:135], v[84:87], v[64:67], v[132:135]
s_waitcnt lgkmcnt(0)
s_barrier
v_mfma_f32_16x16x32_bf16 v[128:131], v[112:115], v[96:99], v[128:131]
ds_read_b128 v[32:35], v18 offset:32768
ds_read_b64_tr_b16 v[48:49], v226 offset:49152
v_mfma_f32_16x16x32_bf16 v[136:139], v[112:115], v[100:103], v[136:139]
ds_read_b64_tr_b16 v[50:51], v226 offset:51200
ds_read_b64_tr_b16 v[52:53], v227 offset:49152
v_mfma_f32_16x16x32_bf16 v[144:147], v[112:115], v[104:107], v[144:147]
ds_read_b64_tr_b16 v[54:55], v227 offset:51200
ds_read_b128 v[36:39], v18 offset:33792
v_mfma_f32_16x16x32_bf16 v[152:155], v[112:115], v[108:111], v[152:155]
ds_read_b128 v[40:43], v18 offset:34816
ds_read_b128 v[44:47], v18 offset:35840
v_mfma_f32_16x16x32_bf16 v[156:159], v[116:119], v[108:111], v[156:159]
ds_read_b128 v[64:67], v18 offset:40960
v_mfma_f32_16x16x32_bf16 v[148:151], v[116:119], v[104:107], v[148:151]
ds_read_b64_tr_b16 v[80:81], v226 offset:53248
v_mfma_f32_16x16x32_bf16 v[140:143], v[116:119], v[100:103], v[140:143]
ds_read_b64_tr_b16 v[82:83], v226 offset:55296
v_mfma_f32_16x16x32_bf16 v[132:135], v[116:119], v[96:99], v[132:135]
ds_read_b64_tr_b16 v[84:85], v227 offset:53248
v_mfma_f32_16x16x32_bf16 v[128:131], v[208:211], v[192:195], v[128:131]
ds_read_b64_tr_b16 v[86:87], v227 offset:55296
v_mfma_f32_16x16x32_bf16 v[136:139], v[208:211], v[196:199], v[136:139]
ds_read_b128 v[68:71], v18 offset:41984
v_mfma_f32_16x16x32_bf16 v[144:147], v[208:211], v[200:203], v[144:147]
ds_read_b128 v[72:75], v18 offset:43008
v_mfma_f32_16x16x32_bf16 v[152:155], v[208:211], v[204:207], v[152:155]
ds_read_b128 v[76:79], v18 offset:44032
v_mfma_f32_16x16x32_bf16 v[156:159], v[212:215], v[204:207], v[156:159]
v_mfma_f32_16x16x32_bf16 v[148:151], v[212:215], v[200:203], v[148:151]
v_mfma_f32_16x16x32_bf16 v[140:143], v[212:215], v[196:199], v[140:143]
v_mfma_f32_16x16x32_bf16 v[132:135], v[212:215], v[192:195], v[132:135]
s_waitcnt lgkmcnt(0)
s_barrier
buffer_load_dwordx4 v[232:235], v2, s[84:87], s46 offen offset:0 sc1
buffer_load_dwordx4 v[236:239], v2, s[84:87], s46 offen offset:1024 sc1
buffer_load_dwordx4 v[240:243], v2, s[84:87], s46 offen offset:2048 sc1
buffer_load_dwordx4 v[244:247], v2, s[84:87], s46 offen offset:3072 sc1
v_mfma_f32_16x16x32_bf16 v[128:131], v[48:51], v[32:35], v[128:131]
ds_read_b128 v[96:99], v19 offset:0
ds_read_b64_tr_b16 v[112:113], v224 offset:0
v_mfma_f32_16x16x32_bf16 v[136:139], v[48:51], v[36:39], v[136:139]
ds_read_b64_tr_b16 v[114:115], v224 offset:2048
ds_read_b64_tr_b16 v[116:117], v225 offset:0
v_mfma_f32_16x16x32_bf16 v[144:147], v[48:51], v[40:43], v[144:147]
ds_read_b64_tr_b16 v[118:119], v225 offset:2048
ds_read_b128 v[100:103], v19 offset:1024
v_mfma_f32_16x16x32_bf16 v[152:155], v[48:51], v[44:47], v[152:155]
ds_read_b128 v[104:107], v19 offset:2048
ds_read_b128 v[108:111], v19 offset:3072
v_mfma_f32_16x16x32_bf16 v[156:159], v[52:55], v[44:47], v[156:159]
ds_read_b128 v[192:195], v19 offset:8192
v_mfma_f32_16x16x32_bf16 v[148:151], v[52:55], v[40:43], v[148:151]
ds_read_b64_tr_b16 v[208:209], v224 offset:4096
v_mfma_f32_16x16x32_bf16 v[140:143], v[52:55], v[36:39], v[140:143]
ds_read_b64_tr_b16 v[210:211], v224 offset:6144
v_mfma_f32_16x16x32_bf16 v[132:135], v[52:55], v[32:35], v[132:135]
ds_read_b64_tr_b16 v[212:213], v225 offset:4096
v_mfma_f32_16x16x32_bf16 v[128:131], v[80:83], v[64:67], v[128:131]
ds_read_b64_tr_b16 v[214:215], v225 offset:6144
v_mfma_f32_16x16x32_bf16 v[136:139], v[80:83], v[68:71], v[136:139]
ds_read_b128 v[196:199], v19 offset:9216
v_mfma_f32_16x16x32_bf16 v[144:147], v[80:83], v[72:75], v[144:147]
ds_read_b128 v[200:203], v19 offset:10240
v_mfma_f32_16x16x32_bf16 v[152:155], v[80:83], v[76:79], v[152:155]
ds_read_b128 v[204:207], v19 offset:11264
v_mfma_f32_16x16x32_bf16 v[156:159], v[84:87], v[76:79], v[156:159]
v_mfma_f32_16x16x32_bf16 v[148:151], v[84:87], v[72:75], v[148:151]
v_mfma_f32_16x16x32_bf16 v[140:143], v[84:87], v[68:71], v[140:143]
v_mfma_f32_16x16x32_bf16 v[132:135], v[84:87], v[64:67], v[132:135]
s_waitcnt lgkmcnt(0)
s_barrier
v_mfma_f32_16x16x32_bf16 v[128:131], v[112:115], v[96:99], v[128:131]
ds_read_b128 v[32:35], v17 offset:16384
ds_read_b64_tr_b16 v[48:49], v224 offset:32768
v_mfma_f32_16x16x32_bf16 v[136:139], v[112:115], v[100:103], v[136:139]
ds_read_b64_tr_b16 v[50:51], v224 offset:34816
ds_read_b64_tr_b16 v[52:53], v225 offset:32768
v_mfma_f32_16x16x32_bf16 v[144:147], v[112:115], v[104:107], v[144:147]
ds_read_b64_tr_b16 v[54:55], v225 offset:34816
ds_read_b128 v[36:39], v17 offset:17408
v_mfma_f32_16x16x32_bf16 v[152:155], v[112:115], v[108:111], v[152:155]
ds_read_b128 v[40:43], v17 offset:18432
ds_read_b128 v[44:47], v17 offset:19456
v_mfma_f32_16x16x32_bf16 v[156:159], v[116:119], v[108:111], v[156:159]
ds_read_b128 v[64:67], v17 offset:24576
v_mfma_f32_16x16x32_bf16 v[148:151], v[116:119], v[104:107], v[148:151]
ds_read_b64_tr_b16 v[80:81], v224 offset:36864
v_mfma_f32_16x16x32_bf16 v[140:143], v[116:119], v[100:103], v[140:143]
ds_read_b64_tr_b16 v[82:83], v224 offset:38912
v_mfma_f32_16x16x32_bf16 v[132:135], v[116:119], v[96:99], v[132:135]
ds_read_b64_tr_b16 v[84:85], v225 offset:36864
v_mfma_f32_16x16x32_bf16 v[128:131], v[208:211], v[192:195], v[128:131]
ds_read_b64_tr_b16 v[86:87], v225 offset:38912
v_mfma_f32_16x16x32_bf16 v[136:139], v[208:211], v[196:199], v[136:139]
ds_read_b128 v[68:71], v17 offset:25600
v_mfma_f32_16x16x32_bf16 v[144:147], v[208:211], v[200:203], v[144:147]
ds_read_b128 v[72:75], v17 offset:26624
v_mfma_f32_16x16x32_bf16 v[152:155], v[208:211], v[204:207], v[152:155]
ds_read_b128 v[76:79], v17 offset:27648
v_mfma_f32_16x16x32_bf16 v[156:159], v[212:215], v[204:207], v[156:159]
v_mfma_f32_16x16x32_bf16 v[148:151], v[212:215], v[200:203], v[148:151]
v_mfma_f32_16x16x32_bf16 v[140:143], v[212:215], v[196:199], v[140:143]
v_mfma_f32_16x16x32_bf16 v[132:135], v[212:215], v[192:195], v[132:135]
s_waitcnt lgkmcnt(0)
s_barrier
v_mfma_f32_16x16x32_bf16 v[128:131], v[48:51], v[32:35], v[128:131]
ds_read_b128 v[96:99], v17 offset:49152
ds_read_b64_tr_b16 v[112:113], v226 offset:0
v_mfma_f32_16x16x32_bf16 v[136:139], v[48:51], v[36:39], v[136:139]
ds_read_b64_tr_b16 v[114:115], v226 offset:2048
ds_read_b64_tr_b16 v[116:117], v227 offset:0
v_mfma_f32_16x16x32_bf16 v[144:147], v[48:51], v[40:43], v[144:147]
ds_read_b64_tr_b16 v[118:119], v227 offset:2048
ds_read_b128 v[100:103], v17 offset:50176
v_mfma_f32_16x16x32_bf16 v[152:155], v[48:51], v[44:47], v[152:155]
ds_read_b128 v[104:107], v17 offset:51200
ds_read_b128 v[108:111], v17 offset:52224
v_mfma_f32_16x16x32_bf16 v[156:159], v[52:55], v[44:47], v[156:159]
ds_read_b128 v[192:195], v17 offset:57344
v_mfma_f32_16x16x32_bf16 v[148:151], v[52:55], v[40:43], v[148:151]
ds_read_b64_tr_b16 v[208:209], v226 offset:4096
v_mfma_f32_16x16x32_bf16 v[140:143], v[52:55], v[36:39], v[140:143]
ds_read_b64_tr_b16 v[210:211], v226 offset:6144
v_mfma_f32_16x16x32_bf16 v[132:135], v[52:55], v[32:35], v[132:135]
ds_read_b64_tr_b16 v[212:213], v227 offset:4096
v_mfma_f32_16x16x32_bf16 v[128:131], v[80:83], v[64:67], v[128:131]
ds_read_b64_tr_b16 v[214:215], v227 offset:6144
v_mfma_f32_16x16x32_bf16 v[136:139], v[80:83], v[68:71], v[136:139]
ds_read_b128 v[196:199], v17 offset:58368
v_mfma_f32_16x16x32_bf16 v[144:147], v[80:83], v[72:75], v[144:147]
ds_read_b128 v[200:203], v17 offset:59392
v_mfma_f32_16x16x32_bf16 v[152:155], v[80:83], v[76:79], v[152:155]
ds_read_b128 v[204:207], v17 offset:60416
v_mfma_f32_16x16x32_bf16 v[156:159], v[84:87], v[76:79], v[156:159]
v_mfma_f32_16x16x32_bf16 v[148:151], v[84:87], v[72:75], v[148:151]
v_mfma_f32_16x16x32_bf16 v[140:143], v[84:87], v[68:71], v[140:143]
v_mfma_f32_16x16x32_bf16 v[132:135], v[84:87], v[64:67], v[132:135]
s_waitcnt vmcnt(0)
s_waitcnt lgkmcnt(0)
s_barrier
v_mfma_f32_16x16x32_bf16 v[128:131], v[112:115], v[96:99], v[128:131]
v_lshlrev_b32 v160, 16, v232
v_and_b32 v161, 0xffff0000, v232
v_lshlrev_b32 v162, 16, v233
v_and_b32 v163, 0xffff0000, v233
v_mfma_f32_16x16x32_bf16 v[132:135], v[116:119], v[96:99], v[132:135]
v_lshlrev_b32 v164, 16, v234
v_and_b32 v165, 0xffff0000, v234
v_lshlrev_b32 v166, 16, v235
v_and_b32 v167, 0xffff0000, v235
v_mfma_f32_16x16x32_bf16 v[128:131], v[208:211], v[192:195], v[128:131]
v_lshlrev_b32 v168, 16, v236
v_and_b32 v169, 0xffff0000, v236
v_lshlrev_b32 v170, 16, v237
v_and_b32 v171, 0xffff0000, v237
v_mfma_f32_16x16x32_bf16 v[132:135], v[212:215], v[192:195], v[132:135]
v_lshlrev_b32 v172, 16, v238
v_and_b32 v173, 0xffff0000, v238
v_lshlrev_b32 v174, 16, v239
v_and_b32 v175, 0xffff0000, v239
v_mfma_f32_16x16x32_bf16 v[136:139], v[112:115], v[100:103], v[136:139]
v_lshlrev_b32 v176, 16, v240
v_and_b32 v177, 0xffff0000, v240
v_lshlrev_b32 v178, 16, v241
v_and_b32 v179, 0xffff0000, v241
v_mfma_f32_16x16x32_bf16 v[140:143], v[116:119], v[100:103], v[140:143]
v_lshlrev_b32 v180, 16, v242
v_and_b32 v181, 0xffff0000, v242
v_lshlrev_b32 v182, 16, v243
v_and_b32 v183, 0xffff0000, v243
v_mfma_f32_16x16x32_bf16 v[136:139], v[208:211], v[196:199], v[136:139]
v_lshlrev_b32 v184, 16, v244
v_and_b32 v185, 0xffff0000, v244
v_lshlrev_b32 v186, 16, v245
v_and_b32 v187, 0xffff0000, v245
v_mfma_f32_16x16x32_bf16 v[140:143], v[212:215], v[196:199], v[140:143]
v_lshlrev_b32 v188, 16, v246
v_and_b32 v189, 0xffff0000, v246
v_lshlrev_b32 v190, 16, v247
v_and_b32 v191, 0xffff0000, v247
v_mfma_f32_16x16x32_bf16 v[144:147], v[112:115], v[104:107], v[144:147]
v_add_f32 v128, v128, v160
v_add_f32 v129, v129, v161
v_add_f32 v130, v130, v162
v_mfma_f32_16x16x32_bf16 v[148:151], v[116:119], v[104:107], v[148:151]
v_add_f32 v131, v131, v163
v_add_f32 v132, v132, v164
v_add_f32 v133, v133, v165
v_mfma_f32_16x16x32_bf16 v[144:147], v[208:211], v[200:203], v[144:147]
v_add_f32 v134, v134, v166
v_add_f32 v135, v135, v167
v_cvt_pk_bf16_f32 v232, v128, v129
v_mfma_f32_16x16x32_bf16 v[148:151], v[212:215], v[200:203], v[148:151]
v_cvt_pk_bf16_f32 v233, v130, v131
v_cvt_pk_bf16_f32 v234, v132, v133
v_cvt_pk_bf16_f32 v235, v134, v135
v_mfma_f32_16x16x32_bf16 v[152:155], v[112:115], v[108:111], v[152:155]
v_add_f32 v136, v136, v168
v_add_f32 v137, v137, v169
v_add_f32 v138, v138, v170
v_mfma_f32_16x16x32_bf16 v[156:159], v[116:119], v[108:111], v[156:159]
v_add_f32 v139, v139, v171
v_add_f32 v140, v140, v172
v_add_f32 v141, v141, v173
v_add_f32 v142, v142, v174
v_mfma_f32_16x16x32_bf16 v[152:155], v[208:211], v[204:207], v[152:155]
v_add_f32 v143, v143, v175
v_cvt_pk_bf16_f32 v236, v136, v137
v_cvt_pk_bf16_f32 v237, v138, v139
v_cvt_pk_bf16_f32 v238, v140, v141
v_mfma_f32_16x16x32_bf16 v[156:159], v[212:215], v[204:207], v[156:159]
v_cvt_pk_bf16_f32 v239, v142, v143
v_permlane16_swap_b32 v232, v234
v_permlane16_swap_b32 v233, v235
buffer_store_dwordx4 v[232:235], v230, s[20:23], s54 offen offset:0 nt
v_permlane16_swap_b32 v236, v238
v_permlane16_swap_b32 v237, v239
buffer_store_dwordx4 v[236:239], v230, s[20:23], s54 offen offset:2048 nt
v_add_f32 v144, v144, v176
v_add_f32 v145, v145, v177
v_add_f32 v146, v146, v178
v_add_f32 v147, v147, v179
v_add_f32 v148, v148, v180
v_add_f32 v149, v149, v181
v_add_f32 v150, v150, v182
v_add_f32 v151, v151, v183
v_cvt_pk_bf16_f32 v240, v144, v145
v_cvt_pk_bf16_f32 v241, v146, v147
v_cvt_pk_bf16_f32 v242, v148, v149
v_cvt_pk_bf16_f32 v243, v150, v151
s_nop 0
v_add_f32 v152, v152, v184
v_add_f32 v153, v153, v185
v_add_f32 v154, v154, v186
v_add_f32 v155, v155, v187
v_add_f32 v156, v156, v188
v_add_f32 v157, v157, v189
v_add_f32 v158, v158, v190
v_add_f32 v159, v159, v191
v_cvt_pk_bf16_f32 v244, v152, v153
v_cvt_pk_bf16_f32 v245, v154, v155
v_cvt_pk_bf16_f32 v246, v156, v157
v_cvt_pk_bf16_f32 v247, v158, v159
v_permlane16_swap_b32 v240, v242
v_permlane16_swap_b32 v241, v243
buffer_store_dwordx4 v[240:243], v230, s[20:23], s55 offen offset:0 nt
v_permlane16_swap_b32 v244, v246
v_permlane16_swap_b32 v245, v247
s_branch Lov_13
.p2align 12
.fill 96, 4, 0xbf800000
Lst_13_0:
s_branch Lwr_168
Lst_13_1:
s_branch Lst_17_0
s_nop 0
Lov_13:
buffer_store_dwordx4 v[244:247], v230, s[20:23], s55 offen offset:2048 nt
s_branch Ldone_1
Lgb_107:
s_mul_i32 s43, s34, 262144
s_add_u32 s8, s82, s43
s_addc_u32 s9, s83, 0
s_add_u32 s8, s8, 4194304
s_addc_u32 s9, s9, 0
s_mov_b32 s10, 262144
s_mov_b32 s11, 0x20000
s_lshl_b32 s39, s36, 12
v_lshlrev_b32 v2, 4, v1
v_add_u32 v3, s39, v2
s_add_u32 s37, s35, 0
s_and_b32 s37, s37, 15
s_mul_i32 s37, s37, 16384
s_add_u32 m0, s39, 0
s_nop 0
buffer_load_dwordx4 v3, s[8:11], s37 offen sc1 lds
buffer_load_dwordx4 v3, s[8:11], s37 offen offset:1024 sc1 lds
buffer_load_dwordx4 v3, s[8:11], s37 offen offset:2048 sc1 lds
buffer_load_dwordx4 v3, s[8:11], s37 offen offset:3072 sc1 lds
s_mul_i32 s43, s34, 262144
s_add_u32 s8, s82, s43
s_addc_u32 s9, s83, 0
s_add_u32 s8, s8, 4194304
s_addc_u32 s9, s9, 0
s_mov_b32 s10, 262144
s_mov_b32 s11, 0x20000
s_mul_i32 s43, s34, 917504
s_add_u32 s24, s82, s43
s_addc_u32 s25, s83, 0
s_add_u32 s24, s24, 8388608
s_addc_u32 s25, s25, 0
s_mov_b32 s26, 917504
s_mov_b32 s27, 0x20000
s_add_u32 s84, s82, 27262976
s_addc_u32 s85, s83, 0
s_mov_b32 s86, 229376
s_mov_b32 s87, 0x20000
s_and_b32 s47, s36, 3
s_lshr_b32 s62, s47, 1
s_and_b32 s63, s47, 1
v_lshlrev_b32 v2, 4, v1
s_lshl_b32 s39, s47, 12
v_add_u32 v3, s39, v2
s_bitcmp0_b32 s36, 1
s_cselect_b32 s44, s72, s74
s_cselect_b32 s45, s73, s75
s_mul_i32 s43, s35, 256
s_add_u32 s12, s44, s43
s_addc_u32 s13, s45, 0
s_mov_b32 s14, 7333120
s_mov_b32 s15, 0x20000
s_and_b32 s43, s36, 1
s_mul_i32 s43, s43, 229376
v_lshrrev_b32 v28, 4, v1
v_lshlrev_b32 v29, 1, v28
v_and_b32 v4, 15, v1
v_xor_b32 v4, v4, v29
v_lshlrev_b32 v4, 4, v4
v_mul_u32_u24 v28, 7168, v28
v_add_u32 v4, v4, v28
v_add_u32 v4, s43, v4
v_xor_b32 v5, 128, v4
v_add_u32 v5, 28672, v5
s_and_b32 s43, s36, 3
s_mul_i32 s40, s43, 8192
s_add_u32 s40, s40, 16384
v_mov_b32 v6, v192
v_mov_b32 v7, v193
v_mov_b32 v8, v194
s_lshl_b32 s43, s62, 12
v_add_u32 v9, s43, v2
v_add_u32 v10, 98304, v9
v_mov_b32 v24, v195
s_mul_i32 s43, s34, 16384
s_add_u32 s20, s82, s43
s_addc_u32 s21, s83, 0
s_add_u32 s20, s20, 25165824
s_addc_u32 s21, s21, 0
s_mov_b32 s22, 16384
s_mov_b32 s23, 0x20000
s_add_u32 s38, s35, 2
s_and_b32 s38, s38, 15
s_mul_i32 s38, s38, 458752
s_add_u32 m0, s50, 98304
s_nop 0
buffer_load_dwordx4 v6, s[16:19], s38 offen lds
s_add_u32 m0, s50, 99328
s_nop 0
buffer_load_dwordx4 v7, s[16:19], s38 offen lds
s_add_u32 m0, s50, 100352
s_nop 0
buffer_load_dwordx4 v8, s[16:19], s38 offen lds
s_add_u32 m0, s50, 101376
s_add_u32 s38, s38, 114688
buffer_load_dwordx4 v6, s[16:19], s38 offen lds
s_add_u32 m0, s50, 102400
s_nop 0
buffer_load_dwordx4 v7, s[16:19], s38 offen lds
s_add_u32 m0, s50, 103424
s_nop 0
buffer_load_dwordx4 v8, s[16:19], s38 offen lds
s_cmp_eq_u32 s47, 1
s_cbranch_scc0 Lw_132
s_lshl_b32 s92, s34, 4
s_add_u32 s92, s92, s35
s_lshl_b32 s92, s92, 8
s_add_u32 s92, s92, 49280
s_add_u32 s92, s92, 28311552
s_mov_b32 s41, 0x40000
Lpoll_133:
s_load_dword s93, s[82:83], s92 glc
Lpchk_135:
s_waitcnt lgkmcnt(0)
s_cmp_eq_u32 s93, 16
s_cbranch_scc1 Lpok_134
s_sub_u32 s41, s41, 1
s_cmp_lg_u32 s41, 0
s_cbranch_scc1 Lpoll_133
Lpok_134:
Lw_132:
s_waitcnt vmcnt(0)
s_barrier
s_add_u32 s37, s35, 1
s_and_b32 s37, s37, 15
s_mul_i32 s37, s37, 16384
s_add_u32 m0, s39, 49152
s_nop 0
buffer_load_dwordx4 v3, s[8:11], s37 offen sc1 lds
buffer_load_dwordx4 v3, s[8:11], s37 offen offset:1024 sc1 lds
buffer_load_dwordx4 v3, s[8:11], s37 offen offset:2048 sc1 lds
buffer_load_dwordx4 v3, s[8:11], s37 offen offset:3072 sc1 lds
s_add_u32 s37, s35, 2
s_and_b32 s37, s37, 15
s_mul_i32 s37, s37, 16384
s_add_u32 m0, s39, 98304
s_nop 0
buffer_load_dwordx4 v3, s[8:11], s37 offen sc1 lds
buffer_load_dwordx4 v3, s[8:11], s37 offen offset:1024 sc1 lds
buffer_load_dwordx4 v3, s[8:11], s37 offen offset:2048 sc1 lds
buffer_load_dwordx4 v3, s[8:11], s37 offen offset:3072 sc1 lds
buffer_load_dwordx4 v[96:99], v3, s[20:23], 0 offen offset:0 sc1
buffer_load_dwordx4 v[100:103], v3, s[20:23], 0 offen offset:1024 sc1
buffer_load_dwordx4 v[104:107], v3, s[20:23], 0 offen offset:2048 sc1
buffer_load_dwordx4 v[108:111], v3, s[20:23], 0 offen offset:3072 sc1
s_and_b32 s44, s36, 3
s_mul_i32 s44, s44, 11
s_bfe_u32 s43, s2, 0x30001
s_lshl_b32 s43, s43, 7
s_add_u32 s44, s44, s43
s_add_u32 s44, s44, 84
s_mul_i32 s44, s44, 7168
s_lshr_b32 s43, s2, 4
s_lshl_b32 s43, s43, 8
s_add_u32 s43, s43, s44
s_bitcmp0_b32 s2, 0
s_cselect_b32 s4, s72, s74
s_cselect_b32 s5, s73, s75
s_add_u32 s4, s4, s43
s_addc_u32 s5, s5, 0
s_waitcnt vmcnt(8)
s_barrier
s_cmp_eq_u32 s47, 3
s_cbranch_scc0 Lw_136
v_and_b32 v90, 31, v1
v_lshlrev_b32 v90, 4, v90
v_add_u32 v91, 151552, v90
ds_read_b128 v[112:115], v91 offset:0
ds_read_b128 v[116:119], v91 offset:512
ds_read_b128 v[120:123], v91 offset:1024
ds_read_b128 v[124:127], v91 offset:1536
s_and_b32 s44, s2, 15
s_mul_i32 s44, s44, 14336
s_lshr_b32 s43, s2, 4
s_lshl_b32 s43, s43, 9
s_add_u32 s44, s44, s43
s_add_u32 s44, s44, 8192
s_cmp_lt_u32 s2, 192
s_cselect_b32 s44, s44, 0x7fffffff
s_waitcnt lgkmcnt(0)
v_add_f32 v112, v112, v116
v_add_f32 v120, v120, v124
v_add_f32 v113, v113, v117
v_add_f32 v121, v121, v125
v_add_f32 v114, v114, v118
v_add_f32 v122, v122, v126
v_add_f32 v115, v115, v119
v_add_f32 v123, v123, v127
v_add_f32 v112, v112, v120
v_add_f32 v113, v113, v121
v_add_f32 v114, v114, v122
v_add_f32 v115, v115, v123
s_mov_b64 exec, 0xffffffff
buffer_store_dwordx4 v[112:115], v90, s[84:87], s44 offen sc1
s_mov_b64 exec, -1
Lw_136:
s_add_u32 s37, s35, 3
s_and_b32 s37, s37, 15
s_mul_i32 s37, s37, 16384
s_add_u32 m0, s39, 0
s_nop 0
buffer_load_dwordx4 v3, s[8:11], s37 offen sc1 lds
s_load_dword s3, s[4:5], 0
buffer_load_dwordx4 v3, s[8:11], s37 offen offset:1024 sc1 lds
s_load_dword s3, s[4:5], 64
buffer_load_dwordx4 v3, s[8:11], s37 offen offset:2048 sc1 lds
s_load_dword s3, s[4:5], 128
buffer_load_dwordx4 v3, s[8:11], s37 offen offset:3072 sc1 lds
s_load_dword s3, s[4:5], 192
s_load_dword s3, s[4:5], 7168
s_add_u32 s38, s35, 3
s_and_b32 s38, s38, 15
s_mul_i32 s38, s38, 458752
s_add_u32 m0, s50, 0
s_nop 0
buffer_load_dwordx4 v6, s[16:19], s38 offen lds
s_load_dword s3, s[4:5], 7232
s_add_u32 m0, s50, 1024
s_nop 0
buffer_load_dwordx4 v7, s[16:19], s38 offen lds
s_load_dword s3, s[4:5], 7296
s_add_u32 m0, s50, 2048
s_nop 0
buffer_load_dwordx4 v8, s[16:19], s38 offen lds
s_load_dword s3, s[4:5], 7360
s_add_u32 m0, s50, 3072
s_add_u32 s38, s38, 114688
buffer_load_dwordx4 v6, s[16:19], s38 offen lds
s_load_dword s3, s[4:5], 14336
s_load_dword s3, s[4:5], 14400
s_add_u32 m0, s50, 4096
s_nop 0
buffer_load_dwordx4 v7, s[16:19], s38 offen lds
s_add_u32 m0, s50, 5120
s_nop 0
buffer_load_dwordx4 v8, s[16:19], s38 offen lds
s_waitcnt vmcnt(14)
s_barrier
s_add_u32 s37, s35, 4
s_and_b32 s37, s37, 15
s_mul_i32 s37, s37, 16384
s_add_u32 m0, s39, 49152
s_nop 0
buffer_load_dwordx4 v3, s[8:11], s37 offen sc1 lds
s_load_dword s3, s[4:5], 14464
buffer_load_dwordx4 v3, s[8:11], s37 offen offset:1024 sc1 lds
s_load_dword s3, s[4:5], 14528
buffer_load_dwordx4 v3, s[8:11], s37 offen offset:2048 sc1 lds
s_load_dword s3, s[4:5], 21504
buffer_load_dwordx4 v3, s[8:11], s37 offen offset:3072 sc1 lds
s_load_dword s3, s[4:5], 21568
s_load_dword s3, s[4:5], 21632
s_add_u32 s38, s35, 4
s_and_b32 s38, s38, 15
s_mul_i32 s38, s38, 458752
s_add_u32 m0, s50, 49152
s_nop 0
buffer_load_dwordx4 v6, s[16:19], s38 offen lds
s_load_dword s3, s[4:5], 21696
s_add_u32 m0, s50, 50176
s_nop 0
buffer_load_dwordx4 v7, s[16:19], s38 offen lds
s_load_dword s3, s[4:5], 28672
s_add_u32 m0, s50, 51200
s_nop 0
buffer_load_dwordx4 v8, s[16:19], s38 offen lds
s_load_dword s3, s[4:5], 28736
s_add_u32 m0, s50, 52224
s_add_u32 s38, s38, 114688
buffer_load_dwordx4 v6, s[16:19], s38 offen lds
s_load_dword s3, s[4:5], 28800
s_load_dword s3, s[4:5], 28864
s_add_u32 m0, s50, 53248
s_nop 0
buffer_load_dwordx4 v7, s[16:19], s38 offen lds
s_add_u32 m0, s50, 54272
s_nop 0
buffer_load_dwordx4 v8, s[16:19], s38 offen lds
s_waitcnt vmcnt(10)
s_barrier
s_cmp_eq_u32 s47, 3
s_cbranch_scc0 Lw_137
s_cmp_lt_u32 s2, 192
s_cbranch_scc0 Lw_137
s_lshr_b32 s43, s2, 4
s_add_u32 s43, s43, 96
s_lshl_b32 s43, s43, 7
v_mov_b32 v90, s43
v_mov_b32 v91, 1
s_mov_b64 exec, 1
buffer_atomic_add v91, v90, s[56:59], 0 offen sc1
s_mov_b64 exec, -1
Lw_137:
s_add_u32 s37, s35, 5
s_and_b32 s37, s37, 15
s_mul_i32 s37, s37, 16384
s_add_u32 m0, s39, 98304
s_nop 0
buffer_load_dwordx4 v3, s[8:11], s37 offen sc1 lds
v_add_f32 v96, v96, v100
v_add_f32 v97, v97, v101
v_add_f32 v98, v98, v102
buffer_load_dwordx4 v3, s[8:11], s37 offen offset:1024 sc1 lds
v_add_f32 v99, v99, v103
v_add_f32 v104, v104, v108
v_add_f32 v105, v105, v109
buffer_load_dwordx4 v3, s[8:11], s37 offen offset:2048 sc1 lds
v_add_f32 v106, v106, v110
v_add_f32 v107, v107, v111
s_nop 0
buffer_load_dwordx4 v3, s[8:11], s37 offen offset:3072 sc1 lds
v_permlane32_swap_b32 v96, v104
v_permlane32_swap_b32 v97, v105
v_permlane32_swap_b32 v98, v106
v_permlane32_swap_b32 v99, v107
s_add_u32 s38, s35, 5
s_and_b32 s38, s38, 15
s_mul_i32 s38, s38, 458752
s_add_u32 m0, s50, 98304
s_nop 0
buffer_load_dwordx4 v6, s[16:19], s38 offen lds
v_add_f32 v96, v96, v104
v_add_f32 v97, v97, v105
v_add_f32 v98, v98, v106
s_add_u32 m0, s50, 99328
s_nop 0
buffer_load_dwordx4 v7, s[16:19], s38 offen lds
v_add_f32 v99, v99, v107
v_mov_b32 v100, v96
v_mov_b32 v101, v97
s_add_u32 m0, s50, 100352
s_nop 0
buffer_load_dwordx4 v8, s[16:19], s38 offen lds
v_mov_b32 v102, v98
v_mov_b32 v103, v99
s_nop 0
s_add_u32 m0, s50, 101376
s_add_u32 s38, s38, 114688
buffer_load_dwordx4 v6, s[16:19], s38 offen lds
v_permlane16_swap_b32 v96, v100
v_permlane16_swap_b32 v97, v101
v_permlane16_swap_b32 v98, v102
v_permlane16_swap_b32 v99, v103
s_add_u32 m0, s50, 102400
s_nop 0
buffer_load_dwordx4 v7, s[16:19], s38 offen lds
s_add_u32 m0, s50, 103424
s_nop 0
buffer_load_dwordx4 v8, s[16:19], s38 offen lds
s_waitcnt vmcnt(10)
s_barrier
s_add_u32 s37, s35, 6
s_and_b32 s37, s37, 15
s_mul_i32 s37, s37, 16384
s_add_u32 m0, s39, 0
s_nop 0
buffer_load_dwordx4 v3, s[8:11], s37 offen sc1 lds
v_add_f32 v96, v96, v100
v_add_f32 v97, v97, v101
v_add_f32 v98, v98, v102
buffer_load_dwordx4 v3, s[8:11], s37 offen offset:1024 sc1 lds
v_add_f32 v99, v99, v103
s_nop 0
v_add_f32_dpp v96, v96, v96 row_ror:8 row_mask:0xf bank_mask:0xf
buffer_load_dwordx4 v3, s[8:11], s37 offen offset:2048 sc1 lds
v_add_f32_dpp v97, v97, v97 row_ror:8 row_mask:0xf bank_mask:0xf
v_add_f32_dpp v98, v98, v98 row_ror:8 row_mask:0xf bank_mask:0xf
v_add_f32_dpp v99, v99, v99 row_ror:8 row_mask:0xf bank_mask:0xf
v_mul_f32 v96, 0x3a800000, v96
buffer_load_dwordx4 v3, s[8:11], s37 offen offset:3072 sc1 lds
v_mul_f32 v97, 0x3a800000, v97
v_mul_f32 v98, 0x3a800000, v98
v_mul_f32 v99, 0x3a800000, v99
s_add_u32 s38, s35, 6
s_and_b32 s38, s38, 15
s_mul_i32 s38, s38, 458752
s_add_u32 m0, s50, 0
s_nop 0
buffer_load_dwordx4 v6, s[16:19], s38 offen lds
v_fma_f32 v97, -v96, v96, v97
v_fma_f32 v99, -v98, v98, v99
v_max_f32 v97, 0, v97
s_add_u32 m0, s50, 1024
s_nop 0
buffer_load_dwordx4 v7, s[16:19], s38 offen lds
v_max_f32 v99, 0, v99
v_add_f32 v97, 0x3727c5ac, v97
v_add_f32 v99, 0x3727c5ac, v99
v_rsq_f32 v97, v97
s_add_u32 m0, s50, 2048
s_nop 0
buffer_load_dwordx4 v8, s[16:19], s38 offen lds
v_rsq_f32 v99, v99
v_and_b32 v100, 7, v1
s_lshl_b32 s43, s47, 8
s_add_u32 m0, s50, 3072
s_add_u32 s38, s38, 114688
buffer_load_dwordx4 v6, s[16:19], s38 offen lds
s_add_u32 s43, s43, 147456
v_lshl_add_u32 v100, v100, 4, s43
v_lshrrev_b32 v101, 5, v1
v_lshl_add_u32 v100, v101, 7, v100
s_add_u32 m0, s50, 4096
s_nop 0
buffer_load_dwordx4 v7, s[16:19], s38 offen lds
s_add_u32 m0, s50, 5120
s_nop 0
buffer_load_dwordx4 v8, s[16:19], s38 offen lds
s_waitcnt vmcnt(10)
s_barrier
ds_write_b128 v100, v[96:99]
s_waitcnt lgkmcnt(0)
s_add_u32 s37, s35, 7
s_and_b32 s37, s37, 15
s_mul_i32 s37, s37, 16384
s_add_u32 m0, s39, 49152
s_nop 0
buffer_load_dwordx4 v3, s[8:11], s37 offen sc1 lds
s_load_dword s3, s[4:5], 35840
buffer_load_dwordx4 v3, s[8:11], s37 offen offset:1024 sc1 lds
s_load_dword s3, s[4:5], 35904
buffer_load_dwordx4 v3, s[8:11], s37 offen offset:2048 sc1 lds
s_load_dword s3, s[4:5], 35968
s_load_dword s3, s[4:5], 36032
buffer_load_dwordx4 v3, s[8:11], s37 offen offset:3072 sc1 lds
s_load_dword s3, s[4:5], 43008
s_add_u32 s38, s35, 7
s_and_b32 s38, s38, 15
s_mul_i32 s38, s38, 458752
s_add_u32 m0, s50, 49152
s_nop 0
buffer_load_dwordx4 v6, s[16:19], s38 offen lds
s_load_dword s3, s[4:5], 43072
s_add_u32 m0, s50, 50176
s_nop 0
buffer_load_dwordx4 v7, s[16:19], s38 offen lds
s_load_dword s3, s[4:5], 43136
s_load_dword s3, s[4:5], 43200
s_add_u32 m0, s50, 51200
s_nop 0
buffer_load_dwordx4 v8, s[16:19], s38 offen lds
s_load_dword s3, s[4:5], 50176
s_add_u32 m0, s50, 52224
s_add_u32 s38, s38, 114688
buffer_load_dwordx4 v6, s[16:19], s38 offen lds
s_load_dword s3, s[4:5], 50240
s_load_dword s3, s[4:5], 50304
s_add_u32 m0, s50, 53248
s_nop 0
buffer_load_dwordx4 v7, s[16:19], s38 offen lds
s_add_u32 m0, s50, 54272
s_nop 0
buffer_load_dwordx4 v8, s[16:19], s38 offen lds
s_waitcnt vmcnt(10)
s_barrier
s_add_u32 s37, s35, 8
s_and_b32 s37, s37, 15
s_mul_i32 s37, s37, 16384
s_add_u32 m0, s39, 98304
s_nop 0
buffer_load_dwordx4 v3, s[8:11], s37 offen sc1 lds
s_load_dword s3, s[4:5], 50368
s_load_dword s3, s[4:5], 57344
s_load_dword s3, s[4:5], 57408
buffer_load_dwordx4 v3, s[8:11], s37 offen offset:1024 sc1 lds
s_load_dword s3, s[4:5], 57472
s_load_dword s3, s[4:5], 57536
s_load_dword s3, s[4:5], 64512
s_load_dword s3, s[4:5], 64576
buffer_load_dwordx4 v3, s[8:11], s37 offen offset:2048 sc1 lds
s_load_dword s3, s[4:5], 64640
s_load_dword s3, s[4:5], 64704
s_load_dword s3, s[4:5], 71680
s_load_dword s3, s[4:5], 71744
buffer_load_dwordx4 v3, s[8:11], s37 offen offset:3072 sc1 lds
v_lshrrev_b32 v28, 2, v1
v_and_b32 v29, 7, v28
v_mul_u32_u24 v28, 256, v28
v_lshl_add_u32 v28, v29, 5, v28
s_add_u32 s38, s35, 8
s_and_b32 s38, s38, 15
s_mul_i32 s38, s38, 458752
s_add_u32 m0, s50, 98304
s_nop 0
buffer_load_dwordx4 v6, s[16:19], s38 offen lds
v_and_b32 v29, 3, v1
v_lshl_add_u32 v11, v29, 3, v28
s_lshl_b32 s43, s63, 7
v_xor_b32 v11, s43, v11
s_add_u32 m0, s50, 99328
s_nop 0
buffer_load_dwordx4 v7, s[16:19], s38 offen lds
v_add_u32 v11, 16384, v11
v_xor_b32 v12, 32, v11
v_xor_b32 v13, 64, v11
v_xor_b32 v14, 96, v11
s_add_u32 m0, s50, 100352
s_nop 0
buffer_load_dwordx4 v8, s[16:19], s38 offen lds
v_add_u32 v15, 49152, v11
v_add_u32 v16, 49152, v12
v_add_u32 v17, 49152, v13
v_add_u32 v18, 49152, v14
s_add_u32 m0, s50, 101376
s_add_u32 s38, s38, 114688
buffer_load_dwordx4 v6, s[16:19], s38 offen lds
v_add_u32 v19, 98304, v11
v_add_u32 v20, 98304, v12
v_add_u32 v21, 98304, v13
v_add_u32 v22, 98304, v14
s_add_u32 m0, s50, 102400
s_nop 0
buffer_load_dwordx4 v7, s[16:19], s38 offen lds
s_add_u32 m0, s50, 103424
s_nop 0
buffer_load_dwordx4 v8, s[16:19], s38 offen lds
s_waitcnt vmcnt(10)
s_barrier
s_cmp_eq_u32 s47, 3
s_cbranch_scc0 Lw_138
s_mul_i32 s60, s35, 96
s_add_u32 s61, s60, 95
s_and_b32 s60, s60, 0xff80
s_and_b32 s61, s61, 0xff80
s_add_u32 s60, s60, 28323840
s_add_u32 s61, s61, 28323840
s_load_dword s92, s[82:83], s60 glc
s_load_dword s93, s[82:83], s61 glc
Lw_138:
s_add_u32 s37, s35, 9
s_and_b32 s37, s37, 15
s_mul_i32 s37, s37, 16384
s_add_u32 m0, s39, 0
s_nop 0
buffer_load_dwordx4 v3, s[8:11], s37 offen sc1 lds
buffer_load_dwordx4 v3, s[8:11], s37 offen offset:1024 sc1 lds
buffer_load_dwordx4 v3, s[8:11], s37 offen offset:2048 sc1 lds
buffer_load_dwordx4 v3, s[8:11], s37 offen offset:3072 sc1 lds
s_add_u32 s38, s35, 9
s_and_b32 s38, s38, 15
s_mul_i32 s38, s38, 458752
s_add_u32 m0, s50, 0
s_nop 0
buffer_load_dwordx4 v6, s[16:19], s38 offen lds
s_add_u32 m0, s50, 1024
s_nop 0
buffer_load_dwordx4 v7, s[16:19], s38 offen lds
s_add_u32 m0, s50, 2048
s_nop 0
buffer_load_dwordx4 v8, s[16:19], s38 offen lds
s_add_u32 m0, s50, 3072
s_add_u32 s38, s38, 114688
buffer_load_dwordx4 v6, s[16:19], s38 offen lds
s_add_u32 m0, s50, 4096
s_nop 0
buffer_load_dwordx4 v7, s[16:19], s38 offen lds
s_add_u32 m0, s50, 5120
s_nop 0
buffer_load_dwordx4 v8, s[16:19], s38 offen lds
s_waitcnt vmcnt(10)
s_barrier
s_add_u32 s37, s35, 10
s_and_b32 s37, s37, 15
s_mul_i32 s37, s37, 16384
s_add_u32 m0, s39, 49152
s_nop 0
buffer_load_dwordx4 v3, s[8:11], s37 offen sc1 lds
buffer_load_dwordx4 v3, s[8:11], s37 offen offset:1024 sc1 lds
buffer_load_dwordx4 v3, s[8:11], s37 offen offset:2048 sc1 lds
buffer_load_dwordx4 v3, s[8:11], s37 offen offset:3072 sc1 lds
s_add_u32 s38, s35, 10
s_and_b32 s38, s38, 15
s_mul_i32 s38, s38, 458752
s_add_u32 m0, s50, 49152
s_nop 0
buffer_load_dwordx4 v6, s[16:19], s38 offen lds
s_add_u32 m0, s50, 50176
s_nop 0
buffer_load_dwordx4 v7, s[16:19], s38 offen lds
s_add_u32 m0, s50, 51200
s_nop 0
buffer_load_dwordx4 v8, s[16:19], s38 offen lds
s_add_u32 m0, s50, 52224
s_add_u32 s38, s38, 114688
buffer_load_dwordx4 v6, s[16:19], s38 offen lds
s_add_u32 m0, s50, 53248
s_nop 0
buffer_load_dwordx4 v7, s[16:19], s38 offen lds
s_add_u32 m0, s50, 54272
s_nop 0
buffer_load_dwordx4 v8, s[16:19], s38 offen lds
s_mov_b32 s38, 0
buffer_load_dwordx4 v[40:43], v24, s[88:91], s38 offen
s_mov_b32 s38, 28672
buffer_load_dwordx4 v[44:47], v24, s[88:91], s38 offen
s_mov_b32 s38, 57344
buffer_load_dwordx4 v[48:51], v24, s[88:91], s38 offen
s_mov_b32 s38, 86016
buffer_load_dwordx4 v[52:55], v24, s[88:91], s38 offen
s_mov_b32 s38, 114688
buffer_load_dwordx4 v[56:59], v24, s[88:91], s38 offen
s_branch Lov_14
.p2align 12
.fill 112, 4, 0xbf800000
Lst_14_0:
s_branch Lwr_169
Lst_14_1:
s_branch Lwr_177
s_nop 0
Lov_14:
s_mov_b32 s38, 143360
buffer_load_dwordx4 v[60:63], v24, s[88:91], s38 offen
s_mov_b32 s38, 172032
buffer_load_dwordx4 v[64:67], v24, s[88:91], s38 offen
s_mov_b32 s38, 200704
buffer_load_dwordx4 v[68:71], v24, s[88:91], s38 offen
s_waitcnt vmcnt(18)
s_cmp_eq_u32 s47, 3
s_cbranch_scc0 Lw_139
s_mov_b32 s41, 0x40000
Lcp_140:
s_waitcnt lgkmcnt(0)
s_and_b32 s92, s92, s93
s_cmp_eq_u32 s92, 16
s_cbranch_scc1 Lco_141
s_load_dword s92, s[82:83], s60 glc
s_load_dword s93, s[82:83], s61 glc
s_sub_u32 s41, s41, 1
s_cmp_lg_u32 s41, 0
s_cbranch_scc1 Lcp_140
s_waitcnt lgkmcnt(0)
Lco_141:
Lw_139:
s_barrier
s_mov_b32 s45, s47
s_cmp_ge_u32 s45, 3
s_cselect_b32 s43, 1, 0
s_mul_i32 s44, s43, 3
s_sub_u32 s45, s45, s44
s_lshl_b32 s45, s45, 7
s_mul_i32 s52, s43, 896
s_add_u32 s52, s52, s45
s_add_u32 s52, s52, 148992
s_mul_i32 s43, s43, 14336
s_add_u32 s43, s43, s45
s_mul_i32 s44, s35, 384
s_add_u32 s43, s43, s44
s_add_u32 s60, s43, 8192
s_add_u32 s45, s47, 4
s_min_u32 s45, s45, 5
s_cmp_ge_u32 s45, 3
s_cselect_b32 s43, 1, 0
s_mul_i32 s44, s43, 3
s_sub_u32 s45, s45, s44
s_lshl_b32 s45, s45, 7
s_mul_i32 s53, s43, 896
s_add_u32 s53, s53, s45
s_add_u32 s53, s53, 148992
s_mul_i32 s43, s43, 14336
s_add_u32 s43, s43, s45
s_mul_i32 s44, s35, 384
s_add_u32 s43, s43, s44
s_add_u32 s61, s43, 8192
v_lshrrev_b32 v104, 3, v1
v_mul_u32_u24 v104, 28672, v104
v_and_b32 v105, 7, v1
v_lshl_add_u32 v104, v105, 4, v104
buffer_load_dwordx4 v[96:99], v104, s[84:87], s60 offen sc1
s_load_dword s3, s[4:5], 71808
s_load_dword s3, s[4:5], 71872
buffer_load_dwordx4 v[100:103], v104, s[84:87], s61 offen sc1
s_and_b32 s44, s36, 3
s_mul_i32 s43, s2, 28672
s_add_u32 s37, s35, 11
s_and_b32 s37, s37, 15
s_mul_i32 s37, s37, 16384
s_add_u32 m0, s39, 98304
s_nop 0
buffer_load_dwordx4 v3, s[8:11], s37 offen sc1 lds
s_mul_i32 s44, s44, 7168
s_add_u32 s43, s43, s44
buffer_load_dwordx4 v3, s[8:11], s37 offen offset:1024 sc1 lds
s_add_u32 s4, s76, s43
s_addc_u32 s5, s77, 0
s_load_dword s3, s[4:5], 0
buffer_load_dwordx4 v3, s[8:11], s37 offen offset:2048 sc1 lds
s_load_dword s3, s[4:5], 64
s_load_dword s3, s[4:5], 128
buffer_load_dwordx4 v3, s[8:11], s37 offen offset:3072 sc1 lds
s_load_dword s3, s[4:5], 192
s_load_dword s3, s[4:5], 256
s_add_u32 s38, s35, 11
s_and_b32 s38, s38, 15
s_mul_i32 s38, s38, 458752
s_add_u32 m0, s50, 98304
s_nop 0
buffer_load_dwordx4 v6, s[16:19], s38 offen lds
s_load_dword s3, s[4:5], 320
s_load_dword s3, s[4:5], 384
s_load_dword s3, s[4:5], 448
s_add_u32 m0, s50, 99328
s_nop 0
buffer_load_dwordx4 v7, s[16:19], s38 offen lds
v_cmp_gt_u32 vcc, 32, v1
v_mov_b32 v104, s52
s_add_u32 m0, s50, 100352
s_nop 0
buffer_load_dwordx4 v8, s[16:19], s38 offen lds
v_mov_b32 v106, s53
v_cndmask_b32 v104, v106, v104, vcc
s_add_u32 m0, s50, 101376
s_add_u32 s38, s38, 114688
buffer_load_dwordx4 v6, s[16:19], s38 offen lds
v_lshl_add_u32 v104, v105, 4, v104
v_bfe_u32 v105, v1, 4, 1
v_lshl_add_u32 v104, v105, 2, v104
s_add_u32 m0, s50, 102400
s_nop 0
buffer_load_dwordx4 v7, s[16:19], s38 offen lds
s_add_u32 m0, s50, 103424
s_nop 0
buffer_load_dwordx4 v8, s[16:19], s38 offen lds
s_waitcnt vmcnt(20)
s_barrier
s_add_u32 s37, s35, 12
s_and_b32 s37, s37, 15
s_mul_i32 s37, s37, 16384
s_add_u32 m0, s39, 0
s_nop 0
buffer_load_dwordx4 v3, s[8:11], s37 offen sc1 lds
buffer_load_dwordx4 v3, s[8:11], s37 offen offset:1024 sc1 lds
buffer_load_dwordx4 v3, s[8:11], s37 offen offset:2048 sc1 lds
buffer_load_dwordx4 v3, s[8:11], s37 offen offset:3072 sc1 lds
s_add_u32 s38, s35, 12
s_and_b32 s38, s38, 15
s_mul_i32 s38, s38, 458752
s_add_u32 m0, s50, 0
s_nop 0
buffer_load_dwordx4 v6, s[16:19], s38 offen lds
s_add_u32 m0, s50, 1024
s_nop 0
buffer_load_dwordx4 v7, s[16:19], s38 offen lds
s_add_u32 m0, s50, 2048
s_nop 0
buffer_load_dwordx4 v8, s[16:19], s38 offen lds
s_add_u32 m0, s50, 3072
s_add_u32 s38, s38, 114688
buffer_load_dwordx4 v6, s[16:19], s38 offen lds
s_add_u32 m0, s50, 4096
s_nop 0
buffer_load_dwordx4 v7, s[16:19], s38 offen lds
s_add_u32 m0, s50, 5120
s_nop 0
buffer_load_dwordx4 v8, s[16:19], s38 offen lds
s_waitcnt vmcnt(10)
s_barrier
v_permlane32_swap_b32 v96, v100
v_permlane32_swap_b32 v97, v101
v_permlane32_swap_b32 v98, v102
v_permlane32_swap_b32 v99, v103
v_add_f32 v96, v96, v100
v_add_f32 v97, v97, v101
v_add_f32 v98, v98, v102
v_add_f32 v99, v99, v103
s_nop 1
v_permlane16_swap_b32 v96, v97
v_permlane16_swap_b32 v98, v99
v_add_f32 v96, v96, v97
v_add_f32 v98, v98, v99
s_nop 1
v_add_f32_dpp v96, v96, v96 row_ror:8 row_mask:0xf bank_mask:0xf
v_add_f32_dpp v98, v98, v98 row_ror:8 row_mask:0xf bank_mask:0xf
ds_write_b32 v104, v96
ds_write_b32 v104, v98 offset:8
s_waitcnt lgkmcnt(0)
s_add_u32 s37, s35, 13
s_and_b32 s37, s37, 15
s_mul_i32 s37, s37, 16384
s_add_u32 m0, s39, 49152
s_nop 0
buffer_load_dwordx4 v3, s[8:11], s37 offen sc1 lds
s_load_dword s3, s[4:5], 512
s_load_dword s3, s[4:5], 576
s_load_dword s3, s[4:5], 640
s_load_dword s3, s[4:5], 704
s_load_dword s3, s[4:5], 768
buffer_load_dwordx4 v3, s[8:11], s37 offen offset:1024 sc1 lds
s_load_dword s3, s[4:5], 832
s_load_dword s3, s[4:5], 896
s_load_dword s3, s[4:5], 960
s_load_dword s3, s[4:5], 1024
s_load_dword s3, s[4:5], 1088
buffer_load_dwordx4 v3, s[8:11], s37 offen offset:2048 sc1 lds
v_lshlrev_b32 v72, 16, v40
v_and_b32 v73, 0xffff0000, v40
v_lshlrev_b32 v74, 16, v41
v_and_b32 v75, 0xffff0000, v41
v_lshlrev_b32 v76, 16, v42
v_and_b32 v77, 0xffff0000, v42
buffer_load_dwordx4 v3, s[8:11], s37 offen offset:3072 sc1 lds
v_lshlrev_b32 v78, 16, v43
v_and_b32 v79, 0xffff0000, v43
v_lshlrev_b32 v80, 16, v44
v_and_b32 v81, 0xffff0000, v44
v_lshlrev_b32 v82, 16, v45
s_add_u32 s38, s35, 13
s_and_b32 s38, s38, 15
s_mul_i32 s38, s38, 458752
s_add_u32 m0, s50, 49152
s_nop 0
buffer_load_dwordx4 v6, s[16:19], s38 offen lds
v_and_b32 v83, 0xffff0000, v45
v_lshlrev_b32 v84, 16, v46
v_and_b32 v85, 0xffff0000, v46
v_lshlrev_b32 v86, 16, v47
v_and_b32 v87, 0xffff0000, v47
s_add_u32 m0, s50, 50176
s_nop 0
buffer_load_dwordx4 v7, s[16:19], s38 offen lds
v_add_f32 v72, v72, v80
v_add_f32 v73, v73, v81
v_add_f32 v74, v74, v82
v_add_f32 v75, v75, v83
v_add_f32 v76, v76, v84
v_add_f32 v77, v77, v85
s_add_u32 m0, s50, 51200
s_nop 0
buffer_load_dwordx4 v8, s[16:19], s38 offen lds
v_add_f32 v78, v78, v86
v_add_f32 v79, v79, v87
v_lshlrev_b32 v80, 16, v48
v_and_b32 v81, 0xffff0000, v48
v_lshlrev_b32 v82, 16, v49
s_add_u32 m0, s50, 52224
s_add_u32 s38, s38, 114688
buffer_load_dwordx4 v6, s[16:19], s38 offen lds
v_and_b32 v83, 0xffff0000, v49
v_lshlrev_b32 v84, 16, v50
v_and_b32 v85, 0xffff0000, v50
v_lshlrev_b32 v86, 16, v51
v_and_b32 v87, 0xffff0000, v51
v_add_f32 v72, v72, v80
s_add_u32 m0, s50, 53248
s_nop 0
buffer_load_dwordx4 v7, s[16:19], s38 offen lds
s_add_u32 m0, s50, 54272
s_nop 0
buffer_load_dwordx4 v8, s[16:19], s38 offen lds
s_waitcnt vmcnt(10)
s_barrier
s_add_u32 s37, s35, 14
s_and_b32 s37, s37, 15
s_mul_i32 s37, s37, 16384
s_add_u32 m0, s39, 98304
s_nop 0
buffer_load_dwordx4 v3, s[8:11], s37 offen sc1 lds
s_load_dword s3, s[4:5], 1152
s_load_dword s3, s[4:5], 1216
s_load_dword s3, s[4:5], 1280
s_load_dword s3, s[4:5], 1344
s_load_dword s3, s[4:5], 1408
buffer_load_dwordx4 v3, s[8:11], s37 offen offset:1024 sc1 lds
s_load_dword s3, s[4:5], 1472
s_load_dword s3, s[4:5], 1536
s_load_dword s3, s[4:5], 1600
s_load_dword s3, s[4:5], 1664
s_load_dword s3, s[4:5], 1728
v_add_f32 v73, v73, v81
buffer_load_dwordx4 v3, s[8:11], s37 offen offset:2048 sc1 lds
v_add_f32 v74, v74, v82
v_add_f32 v75, v75, v83
v_add_f32 v76, v76, v84
v_add_f32 v77, v77, v85
v_add_f32 v78, v78, v86
buffer_load_dwordx4 v3, s[8:11], s37 offen offset:3072 sc1 lds
v_add_f32 v79, v79, v87
v_lshlrev_b32 v80, 16, v52
v_and_b32 v81, 0xffff0000, v52
v_lshlrev_b32 v82, 16, v53
v_and_b32 v83, 0xffff0000, v53
v_lshlrev_b32 v84, 16, v54
s_add_u32 s38, s35, 14
s_and_b32 s38, s38, 15
s_mul_i32 s38, s38, 458752
s_add_u32 m0, s50, 98304
s_nop 0
buffer_load_dwordx4 v6, s[16:19], s38 offen lds
v_and_b32 v85, 0xffff0000, v54
v_lshlrev_b32 v86, 16, v55
v_and_b32 v87, 0xffff0000, v55
v_add_f32 v72, v72, v80
v_add_f32 v73, v73, v81
s_add_u32 m0, s50, 99328
s_nop 0
buffer_load_dwordx4 v7, s[16:19], s38 offen lds
v_add_f32 v74, v74, v82
v_add_f32 v75, v75, v83
v_add_f32 v76, v76, v84
v_add_f32 v77, v77, v85
v_add_f32 v78, v78, v86
v_add_f32 v79, v79, v87
s_add_u32 m0, s50, 100352
s_nop 0
buffer_load_dwordx4 v8, s[16:19], s38 offen lds
v_lshlrev_b32 v80, 16, v56
v_and_b32 v81, 0xffff0000, v56
v_lshlrev_b32 v82, 16, v57
v_and_b32 v83, 0xffff0000, v57
v_lshlrev_b32 v84, 16, v58
s_add_u32 m0, s50, 101376
s_add_u32 s38, s38, 114688
buffer_load_dwordx4 v6, s[16:19], s38 offen lds
v_and_b32 v85, 0xffff0000, v58
v_lshlrev_b32 v86, 16, v59
v_and_b32 v87, 0xffff0000, v59
v_add_f32 v72, v72, v80
v_add_f32 v73, v73, v81
v_add_f32 v74, v74, v82
s_add_u32 m0, s50, 102400
s_nop 0
buffer_load_dwordx4 v7, s[16:19], s38 offen lds
s_add_u32 m0, s50, 103424
s_nop 0
buffer_load_dwordx4 v8, s[16:19], s38 offen lds
s_waitcnt vmcnt(10)
s_barrier
s_add_u32 s37, s35, 15
s_and_b32 s37, s37, 15
s_mul_i32 s37, s37, 16384
s_add_u32 m0, s39, 0
s_nop 0
buffer_load_dwordx4 v3, s[8:11], s37 offen sc1 lds
v_add_f32 v75, v75, v83
v_add_f32 v76, v76, v84
v_add_f32 v77, v77, v85
v_add_f32 v78, v78, v86
buffer_load_dwordx4 v3, s[8:11], s37 offen offset:1024 sc1 lds
v_add_f32 v79, v79, v87
v_lshlrev_b32 v80, 16, v60
v_and_b32 v81, 0xffff0000, v60
v_lshlrev_b32 v82, 16, v61
buffer_load_dwordx4 v3, s[8:11], s37 offen offset:2048 sc1 lds
v_and_b32 v83, 0xffff0000, v61
v_lshlrev_b32 v84, 16, v62
v_and_b32 v85, 0xffff0000, v62
v_lshlrev_b32 v86, 16, v63
buffer_load_dwordx4 v3, s[8:11], s37 offen offset:3072 sc1 lds
v_and_b32 v87, 0xffff0000, v63
v_add_f32 v72, v72, v80
v_add_f32 v73, v73, v81
v_add_f32 v74, v74, v82
s_add_u32 s38, s35, 15
s_and_b32 s38, s38, 15
s_mul_i32 s38, s38, 458752
s_add_u32 m0, s50, 0
s_nop 0
buffer_load_dwordx4 v6, s[16:19], s38 offen lds
v_add_f32 v75, v75, v83
v_add_f32 v76, v76, v84
v_add_f32 v77, v77, v85
v_add_f32 v78, v78, v86
s_add_u32 m0, s50, 1024
s_nop 0
buffer_load_dwordx4 v7, s[16:19], s38 offen lds
v_add_f32 v79, v79, v87
v_lshlrev_b32 v80, 16, v64
v_and_b32 v81, 0xffff0000, v64
v_lshlrev_b32 v82, 16, v65
s_add_u32 m0, s50, 2048
s_nop 0
buffer_load_dwordx4 v8, s[16:19], s38 offen lds
v_and_b32 v83, 0xffff0000, v65
v_lshlrev_b32 v84, 16, v66
v_and_b32 v85, 0xffff0000, v66
v_lshlrev_b32 v86, 16, v67
s_add_u32 m0, s50, 3072
s_add_u32 s38, s38, 114688
buffer_load_dwordx4 v6, s[16:19], s38 offen lds
v_and_b32 v87, 0xffff0000, v67
v_add_f32 v72, v72, v80
v_add_f32 v73, v73, v81
v_add_f32 v74, v74, v82
v_add_f32 v75, v75, v83
s_add_u32 m0, s50, 4096
s_nop 0
buffer_load_dwordx4 v7, s[16:19], s38 offen lds
s_add_u32 m0, s50, 5120
s_nop 0
buffer_load_dwordx4 v8, s[16:19], s38 offen lds
s_waitcnt vmcnt(10)
s_barrier
s_add_u32 s38, s35, 13
s_and_b32 s38, s38, 15
s_mul_i32 s38, s38, 458752
s_add_u32 m0, s40, 49152
s_nop 0
buffer_load_dwordx4 v4, s[12:15], s38 offen lds
v_add_f32 v76, v76, v84
v_add_f32 v77, v77, v85
v_add_f32 v78, v78, v86
v_add_f32 v79, v79, v87
v_lshlrev_b32 v80, 16, v68
s_add_u32 m0, s40, 50176
s_nop 0
buffer_load_dwordx4 v5, s[12:15], s38 offen lds
v_and_b32 v81, 0xffff0000, v68
v_lshlrev_b32 v82, 16, v69
v_and_b32 v83, 0xffff0000, v69
v_lshlrev_b32 v84, 16, v70
v_and_b32 v85, 0xffff0000, v70
v_lshlrev_b32 v86, 16, v71
s_add_u32 m0, s40, 51200
s_add_u32 s38, s38, 57344
buffer_load_dwordx4 v4, s[12:15], s38 offen lds
v_and_b32 v87, 0xffff0000, v71
v_add_f32 v72, v72, v80
v_add_f32 v73, v73, v81
v_add_f32 v74, v74, v82
v_add_f32 v75, v75, v83
v_add_f32 v76, v76, v84
s_add_u32 m0, s40, 52224
s_nop 0
buffer_load_dwordx4 v5, s[12:15], s38 offen lds
v_add_f32 v77, v77, v85
v_add_f32 v78, v78, v86
v_add_f32 v79, v79, v87
s_nop 0
v_permlane32_swap_b32 v72, v76
s_add_u32 m0, s40, 53248
s_add_u32 s38, s38, 57344
buffer_load_dwordx4 v4, s[12:15], s38 offen lds
v_permlane32_swap_b32 v73, v77
v_permlane32_swap_b32 v74, v78
v_permlane32_swap_b32 v75, v79
v_add_f32 v72, v72, v76
v_add_f32 v73, v73, v77
v_add_f32 v74, v74, v78
s_add_u32 m0, s40, 54272
s_nop 0
buffer_load_dwordx4 v5, s[12:15], s38 offen lds
v_add_f32 v75, v75, v79
s_nop 0
v_permlane16_swap_b32 v72, v74
v_permlane16_swap_b32 v73, v75
v_add_f32 v72, v72, v74
v_add_f32 v73, v73, v75
s_add_u32 m0, s40, 55296
s_add_u32 s38, s38, 57344
buffer_load_dwordx4 v4, s[12:15], s38 offen lds
s_add_u32 m0, s40, 56320
s_nop 0
buffer_load_dwordx4 v5, s[12:15], s38 offen lds
s_waitcnt vmcnt(8)
s_barrier
s_lshl_b32 s43, s47, 9
s_add_u32 s43, s43, 153600
v_and_b32 v80, 15, v1
v_lshl_add_u32 v80, v80, 5, s43
v_lshrrev_b32 v81, 4, v1
v_lshl_add_u32 v80, v81, 3, v80
ds_write_b64 v80, v[72:73]
s_waitcnt lgkmcnt(0)
s_add_u32 s38, s35, 14
s_and_b32 s38, s38, 15
s_mul_i32 s38, s38, 458752
s_add_u32 m0, s40, 98304
s_nop 0
buffer_load_dwordx4 v4, s[12:15], s38 offen lds
s_bfe_u32 s61, s35, 0x10002
s_lshr_b32 s60, s35, 3
s_lshl_b32 s60, s60, 2
s_and_b32 s43, s35, 3
s_add_u32 s60, s60, s43
s_add_u32 m0, s40, 99328
s_nop 0
buffer_load_dwordx4 v5, s[12:15], s38 offen lds
s_lshl_b32 s43, s60, 8
s_add_u32 s28, s76, s43
s_addc_u32 s29, s77, 0
s_mov_b32 s30, 7338240
s_mov_b32 s31, 0x20000
s_add_u32 m0, s40, 100352
s_add_u32 s38, s38, 57344
buffer_load_dwordx4 v4, s[12:15], s38 offen lds
s_mul_i32 s52, s61, 196608
s_mul_i32 s53, s61, 1572864
s_mul_i32 s90, s61, 163840
s_mul_i32 s91, s61, 1310720
s_and_b32 s43, s35, 3
s_add_u32 m0, s40, 101376
s_nop 0
buffer_load_dwordx4 v5, s[12:15], s38 offen lds
s_mul_i32 s32, s43, 3
s_mul_i32 s33, s43, 10
s_lshr_b32 s33, s33, 2
s_lshl_b32 s51, s47, 11
s_lshl_b32 s44, s47, 15
s_add_u32 m0, s40, 102400
s_add_u32 s38, s38, 57344
buffer_load_dwordx4 v4, s[12:15], s38 offen lds
v_lshrrev_b32 v122, 4, v1
v_lshlrev_b32 v123, 1, v122
v_and_b32 v23, 15, v1
v_xor_b32 v23, v23, v123
v_lshlrev_b32 v23, 4, v23
s_add_u32 m0, s40, 103424
s_nop 0
buffer_load_dwordx4 v5, s[12:15], s38 offen lds
v_mul_u32_u24 v122, 2048, v122
v_add_u32 v23, v23, v122
v_add_u32 v23, s44, v23
v_xor_b32 v24, 128, v23
v_add_u32 v24, 8192, v24
s_add_u32 m0, s40, 104448
s_add_u32 s38, s38, 57344
buffer_load_dwordx4 v4, s[12:15], s38 offen lds
s_add_u32 m0, s40, 105472
s_nop 0
buffer_load_dwordx4 v5, s[12:15], s38 offen lds
s_waitcnt vmcnt(8)
s_barrier
ds_read_b128 v[28:31], v9 offset:49152
ds_read_b64_tr_b16 v[44:45], v15 offset:0
ds_read_b64_tr_b16 v[46:47], v15 offset:4096
ds_read_b64_tr_b16 v[48:49], v16 offset:0
ds_read_b64_tr_b16 v[50:51], v16 offset:4096
ds_read_b64_tr_b16 v[52:53], v17 offset:0
ds_read_b64_tr_b16 v[54:55], v17 offset:4096
ds_read_b64_tr_b16 v[56:57], v18 offset:0
ds_read_b64_tr_b16 v[58:59], v18 offset:4096
ds_read_b64_tr_b16 v[60:61], v15 offset:16384
ds_read_b64_tr_b16 v[62:63], v15 offset:20480
ds_read_b64_tr_b16 v[64:65], v16 offset:16384
ds_read_b64_tr_b16 v[66:67], v16 offset:20480
ds_read_b64_tr_b16 v[68:69], v17 offset:16384
ds_read_b64_tr_b16 v[70:71], v17 offset:20480
ds_read_b64_tr_b16 v[72:73], v18 offset:16384
ds_read_b64_tr_b16 v[74:75], v18 offset:20480
ds_read_b128 v[32:35], v9 offset:50176
ds_read_b128 v[36:39], v9 offset:51200
ds_read_b128 v[40:43], v9 offset:52224
s_waitcnt lgkmcnt(0)
v_mfma_f32_16x16x32_bf16 v[124:127], v[44:47], v[28:31], 0
ds_read_b128 v[76:79], v9 offset:57344
v_mfma_f32_16x16x32_bf16 v[156:159], v[44:47], v[32:35], 0
ds_read_b64_tr_b16 v[92:93], v15 offset:8192
v_mfma_f32_16x16x32_bf16 v[188:191], v[44:47], v[36:39], 0
ds_read_b64_tr_b16 v[94:95], v15 offset:12288
v_mfma_f32_16x16x32_bf16 v[220:223], v[44:47], v[40:43], 0
ds_read_b64_tr_b16 v[96:97], v16 offset:8192
v_mfma_f32_16x16x32_bf16 v[224:227], v[48:51], v[40:43], 0
ds_read_b64_tr_b16 v[98:99], v16 offset:12288
v_mfma_f32_16x16x32_bf16 v[192:195], v[48:51], v[36:39], 0
ds_read_b64_tr_b16 v[100:101], v17 offset:8192
v_mfma_f32_16x16x32_bf16 v[160:163], v[48:51], v[32:35], 0
ds_read_b64_tr_b16 v[102:103], v17 offset:12288
v_mfma_f32_16x16x32_bf16 v[128:131], v[48:51], v[28:31], 0
ds_read_b64_tr_b16 v[104:105], v18 offset:8192
v_mfma_f32_16x16x32_bf16 v[132:135], v[52:55], v[28:31], 0
ds_read_b64_tr_b16 v[106:107], v18 offset:12288
v_mfma_f32_16x16x32_bf16 v[164:167], v[52:55], v[32:35], 0
ds_read_b64_tr_b16 v[108:109], v15 offset:24576
v_mfma_f32_16x16x32_bf16 v[196:199], v[52:55], v[36:39], 0
ds_read_b64_tr_b16 v[110:111], v15 offset:28672
v_mfma_f32_16x16x32_bf16 v[228:231], v[52:55], v[40:43], 0
ds_read_b64_tr_b16 v[112:113], v16 offset:24576
v_mfma_f32_16x16x32_bf16 v[232:235], v[56:59], v[40:43], 0
ds_read_b64_tr_b16 v[114:115], v16 offset:28672
v_mfma_f32_16x16x32_bf16 v[200:203], v[56:59], v[36:39], 0
ds_read_b64_tr_b16 v[116:117], v17 offset:24576
v_mfma_f32_16x16x32_bf16 v[168:171], v[56:59], v[32:35], 0
ds_read_b64_tr_b16 v[118:119], v17 offset:28672
v_mfma_f32_16x16x32_bf16 v[136:139], v[56:59], v[28:31], 0
ds_read_b64_tr_b16 v[120:121], v18 offset:24576
v_mfma_f32_16x16x32_bf16 v[140:143], v[60:63], v[28:31], 0
ds_read_b64_tr_b16 v[122:123], v18 offset:28672
v_mfma_f32_16x16x32_bf16 v[172:175], v[60:63], v[32:35], 0
ds_read_b128 v[80:83], v9 offset:58368
v_mfma_f32_16x16x32_bf16 v[204:207], v[60:63], v[36:39], 0
ds_read_b128 v[84:87], v9 offset:59392
v_mfma_f32_16x16x32_bf16 v[236:239], v[60:63], v[40:43], 0
ds_read_b128 v[88:91], v9 offset:60416
v_mfma_f32_16x16x32_bf16 v[240:243], v[64:67], v[40:43], 0
v_mfma_f32_16x16x32_bf16 v[208:211], v[64:67], v[36:39], 0
v_mfma_f32_16x16x32_bf16 v[176:179], v[64:67], v[32:35], 0
v_mfma_f32_16x16x32_bf16 v[144:147], v[64:67], v[28:31], 0
v_mfma_f32_16x16x32_bf16 v[148:151], v[68:71], v[28:31], 0
v_mfma_f32_16x16x32_bf16 v[180:183], v[68:71], v[32:35], 0
v_mfma_f32_16x16x32_bf16 v[212:215], v[68:71], v[36:39], 0
v_mfma_f32_16x16x32_bf16 v[244:247], v[68:71], v[40:43], 0
v_mfma_f32_16x16x32_bf16 v[248:251], v[72:75], v[40:43], 0
v_mfma_f32_16x16x32_bf16 v[216:219], v[72:75], v[36:39], 0
v_mfma_f32_16x16x32_bf16 v[184:187], v[72:75], v[32:35], 0
v_mfma_f32_16x16x32_bf16 v[152:155], v[72:75], v[28:31], 0
s_waitcnt vmcnt(0)
s_waitcnt lgkmcnt(0)
s_barrier
v_mfma_f32_16x16x32_bf16 v[124:127], v[92:95], v[76:79], v[124:127]
ds_read_b128 v[28:31], v10 offset:0
v_mfma_f32_16x16x32_bf16 v[156:159], v[92:95], v[80:83], v[156:159]
ds_read_b64_tr_b16 v[44:45], v19 offset:0
s_branch Lov_15
.p2align 12
.fill 112, 4, 0xbf800000
Lst_15_0:
s_branch Lwr_174
s_nop 0
s_nop 0
Lov_15:
v_mfma_f32_16x16x32_bf16 v[188:191], v[92:95], v[84:87], v[188:191]
ds_read_b64_tr_b16 v[46:47], v19 offset:4096
v_mfma_f32_16x16x32_bf16 v[220:223], v[92:95], v[88:91], v[220:223]
ds_read_b64_tr_b16 v[48:49], v20 offset:0
v_mfma_f32_16x16x32_bf16 v[224:227], v[96:99], v[88:91], v[224:227]
ds_read_b64_tr_b16 v[50:51], v20 offset:4096
v_mfma_f32_16x16x32_bf16 v[192:195], v[96:99], v[84:87], v[192:195]
ds_read_b64_tr_b16 v[52:53], v21 offset:0
v_mfma_f32_16x16x32_bf16 v[160:163], v[96:99], v[80:83], v[160:163]
ds_read_b64_tr_b16 v[54:55], v21 offset:4096
v_mfma_f32_16x16x32_bf16 v[128:131], v[96:99], v[76:79], v[128:131]
ds_read_b64_tr_b16 v[56:57], v22 offset:0
v_mfma_f32_16x16x32_bf16 v[132:135], v[100:103], v[76:79], v[132:135]
ds_read_b64_tr_b16 v[58:59], v22 offset:4096
v_mfma_f32_16x16x32_bf16 v[164:167], v[100:103], v[80:83], v[164:167]
ds_read_b64_tr_b16 v[60:61], v19 offset:16384
v_mfma_f32_16x16x32_bf16 v[196:199], v[100:103], v[84:87], v[196:199]
ds_read_b64_tr_b16 v[62:63], v19 offset:20480
v_mfma_f32_16x16x32_bf16 v[228:231], v[100:103], v[88:91], v[228:231]
ds_read_b64_tr_b16 v[64:65], v20 offset:16384
v_mfma_f32_16x16x32_bf16 v[232:235], v[104:107], v[88:91], v[232:235]
ds_read_b64_tr_b16 v[66:67], v20 offset:20480
v_mfma_f32_16x16x32_bf16 v[200:203], v[104:107], v[84:87], v[200:203]
ds_read_b64_tr_b16 v[68:69], v21 offset:16384
v_mfma_f32_16x16x32_bf16 v[168:171], v[104:107], v[80:83], v[168:171]
ds_read_b64_tr_b16 v[70:71], v21 offset:20480
v_mfma_f32_16x16x32_bf16 v[136:139], v[104:107], v[76:79], v[136:139]
ds_read_b64_tr_b16 v[72:73], v22 offset:16384
v_mfma_f32_16x16x32_bf16 v[140:143], v[108:111], v[76:79], v[140:143]
ds_read_b64_tr_b16 v[74:75], v22 offset:20480
v_mfma_f32_16x16x32_bf16 v[172:175], v[108:111], v[80:83], v[172:175]
ds_read_b128 v[32:35], v10 offset:1024
v_mfma_f32_16x16x32_bf16 v[204:207], v[108:111], v[84:87], v[204:207]
ds_read_b128 v[36:39], v10 offset:2048
v_mfma_f32_16x16x32_bf16 v[236:239], v[108:111], v[88:91], v[236:239]
ds_read_b128 v[40:43], v10 offset:3072
v_mfma_f32_16x16x32_bf16 v[240:243], v[112:115], v[88:91], v[240:243]
v_mfma_f32_16x16x32_bf16 v[208:211], v[112:115], v[84:87], v[208:211]
v_mfma_f32_16x16x32_bf16 v[176:179], v[112:115], v[80:83], v[176:179]
v_mfma_f32_16x16x32_bf16 v[144:147], v[112:115], v[76:79], v[144:147]
v_mfma_f32_16x16x32_bf16 v[148:151], v[116:119], v[76:79], v[148:151]
v_mfma_f32_16x16x32_bf16 v[180:183], v[116:119], v[80:83], v[180:183]
v_mfma_f32_16x16x32_bf16 v[212:215], v[116:119], v[84:87], v[212:215]
v_mfma_f32_16x16x32_bf16 v[244:247], v[116:119], v[88:91], v[244:247]
v_mfma_f32_16x16x32_bf16 v[248:251], v[120:123], v[88:91], v[248:251]
v_mfma_f32_16x16x32_bf16 v[216:219], v[120:123], v[84:87], v[216:219]
v_mfma_f32_16x16x32_bf16 v[184:187], v[120:123], v[80:83], v[184:187]
v_mfma_f32_16x16x32_bf16 v[152:155], v[120:123], v[76:79], v[152:155]
s_mov_b32 s41, 5
Lk3l_142:
s_waitcnt lgkmcnt(0)
v_mfma_f32_16x16x32_bf16 v[124:127], v[44:47], v[28:31], v[124:127]
ds_read_b128 v[76:79], v10 offset:8192
v_mfma_f32_16x16x32_bf16 v[156:159], v[44:47], v[32:35], v[156:159]
ds_read_b64_tr_b16 v[92:93], v19 offset:8192
v_mfma_f32_16x16x32_bf16 v[188:191], v[44:47], v[36:39], v[188:191]
ds_read_b64_tr_b16 v[94:95], v19 offset:12288
v_mfma_f32_16x16x32_bf16 v[220:223], v[44:47], v[40:43], v[220:223]
ds_read_b64_tr_b16 v[96:97], v20 offset:8192
v_mfma_f32_16x16x32_bf16 v[224:227], v[48:51], v[40:43], v[224:227]
ds_read_b64_tr_b16 v[98:99], v20 offset:12288
v_mfma_f32_16x16x32_bf16 v[192:195], v[48:51], v[36:39], v[192:195]
ds_read_b64_tr_b16 v[100:101], v21 offset:8192
v_mfma_f32_16x16x32_bf16 v[160:163], v[48:51], v[32:35], v[160:163]
ds_read_b64_tr_b16 v[102:103], v21 offset:12288
v_mfma_f32_16x16x32_bf16 v[128:131], v[48:51], v[28:31], v[128:131]
ds_read_b64_tr_b16 v[104:105], v22 offset:8192
v_mfma_f32_16x16x32_bf16 v[132:135], v[52:55], v[28:31], v[132:135]
ds_read_b64_tr_b16 v[106:107], v22 offset:12288
v_mfma_f32_16x16x32_bf16 v[164:167], v[52:55], v[32:35], v[164:167]
ds_read_b64_tr_b16 v[108:109], v19 offset:24576
v_mfma_f32_16x16x32_bf16 v[196:199], v[52:55], v[36:39], v[196:199]
ds_read_b64_tr_b16 v[110:111], v19 offset:28672
v_mfma_f32_16x16x32_bf16 v[228:231], v[52:55], v[40:43], v[228:231]
ds_read_b64_tr_b16 v[112:113], v20 offset:24576
v_mfma_f32_16x16x32_bf16 v[232:235], v[56:59], v[40:43], v[232:235]
ds_read_b64_tr_b16 v[114:115], v20 offset:28672
v_mfma_f32_16x16x32_bf16 v[200:203], v[56:59], v[36:39], v[200:203]
ds_read_b64_tr_b16 v[116:117], v21 offset:24576
v_mfma_f32_16x16x32_bf16 v[168:171], v[56:59], v[32:35], v[168:171]
ds_read_b64_tr_b16 v[118:119], v21 offset:28672
v_mfma_f32_16x16x32_bf16 v[136:139], v[56:59], v[28:31], v[136:139]
ds_read_b64_tr_b16 v[120:121], v22 offset:24576
v_mfma_f32_16x16x32_bf16 v[140:143], v[60:63], v[28:31], v[140:143]
ds_read_b64_tr_b16 v[122:123], v22 offset:28672
v_mfma_f32_16x16x32_bf16 v[172:175], v[60:63], v[32:35], v[172:175]
ds_read_b128 v[80:83], v10 offset:9216
v_mfma_f32_16x16x32_bf16 v[204:207], v[60:63], v[36:39], v[204:207]
ds_read_b128 v[84:87], v10 offset:10240
v_mfma_f32_16x16x32_bf16 v[236:239], v[60:63], v[40:43], v[236:239]
ds_read_b128 v[88:91], v10 offset:11264
v_mfma_f32_16x16x32_bf16 v[240:243], v[64:67], v[40:43], v[240:243]
v_mfma_f32_16x16x32_bf16 v[208:211], v[64:67], v[36:39], v[208:211]
v_mfma_f32_16x16x32_bf16 v[176:179], v[64:67], v[32:35], v[176:179]
v_mfma_f32_16x16x32_bf16 v[144:147], v[64:67], v[28:31], v[144:147]
v_mfma_f32_16x16x32_bf16 v[148:151], v[68:71], v[28:31], v[148:151]
v_mfma_f32_16x16x32_bf16 v[180:183], v[68:71], v[32:35], v[180:183]
v_mfma_f32_16x16x32_bf16 v[212:215], v[68:71], v[36:39], v[212:215]
v_mfma_f32_16x16x32_bf16 v[244:247], v[68:71], v[40:43], v[244:247]
v_mfma_f32_16x16x32_bf16 v[248:251], v[72:75], v[40:43], v[248:251]
v_mfma_f32_16x16x32_bf16 v[216:219], v[72:75], v[36:39], v[216:219]
v_mfma_f32_16x16x32_bf16 v[184:187], v[72:75], v[32:35], v[184:187]
v_mfma_f32_16x16x32_bf16 v[152:155], v[72:75], v[28:31], v[152:155]
s_waitcnt lgkmcnt(0)
s_barrier
v_mfma_f32_16x16x32_bf16 v[124:127], v[92:95], v[76:79], v[124:127]
ds_read_b128 v[28:31], v9 offset:0
v_mfma_f32_16x16x32_bf16 v[156:159], v[92:95], v[80:83], v[156:159]
ds_read_b64_tr_b16 v[44:45], v11 offset:0
v_mfma_f32_16x16x32_bf16 v[188:191], v[92:95], v[84:87], v[188:191]
ds_read_b64_tr_b16 v[46:47], v11 offset:4096
v_mfma_f32_16x16x32_bf16 v[220:223], v[92:95], v[88:91], v[220:223]
ds_read_b64_tr_b16 v[48:49], v12 offset:0
v_mfma_f32_16x16x32_bf16 v[224:227], v[96:99], v[88:91], v[224:227]
ds_read_b64_tr_b16 v[50:51], v12 offset:4096
v_mfma_f32_16x16x32_bf16 v[192:195], v[96:99], v[84:87], v[192:195]
ds_read_b64_tr_b16 v[52:53], v13 offset:0
v_mfma_f32_16x16x32_bf16 v[160:163], v[96:99], v[80:83], v[160:163]
ds_read_b64_tr_b16 v[54:55], v13 offset:4096
v_mfma_f32_16x16x32_bf16 v[128:131], v[96:99], v[76:79], v[128:131]
ds_read_b64_tr_b16 v[56:57], v14 offset:0
v_mfma_f32_16x16x32_bf16 v[132:135], v[100:103], v[76:79], v[132:135]
ds_read_b64_tr_b16 v[58:59], v14 offset:4096
v_mfma_f32_16x16x32_bf16 v[164:167], v[100:103], v[80:83], v[164:167]
ds_read_b64_tr_b16 v[60:61], v11 offset:16384
v_mfma_f32_16x16x32_bf16 v[196:199], v[100:103], v[84:87], v[196:199]
ds_read_b64_tr_b16 v[62:63], v11 offset:20480
v_mfma_f32_16x16x32_bf16 v[228:231], v[100:103], v[88:91], v[228:231]
ds_read_b64_tr_b16 v[64:65], v12 offset:16384
v_mfma_f32_16x16x32_bf16 v[232:235], v[104:107], v[88:91], v[232:235]
ds_read_b64_tr_b16 v[66:67], v12 offset:20480
v_mfma_f32_16x16x32_bf16 v[200:203], v[104:107], v[84:87], v[200:203]
ds_read_b64_tr_b16 v[68:69], v13 offset:16384
v_mfma_f32_16x16x32_bf16 v[168:171], v[104:107], v[80:83], v[168:171]
ds_read_b64_tr_b16 v[70:71], v13 offset:20480
v_mfma_f32_16x16x32_bf16 v[136:139], v[104:107], v[76:79], v[136:139]
ds_read_b64_tr_b16 v[72:73], v14 offset:16384
v_mfma_f32_16x16x32_bf16 v[140:143], v[108:111], v[76:79], v[140:143]
ds_read_b64_tr_b16 v[74:75], v14 offset:20480
v_mfma_f32_16x16x32_bf16 v[172:175], v[108:111], v[80:83], v[172:175]
ds_read_b128 v[32:35], v9 offset:1024
v_mfma_f32_16x16x32_bf16 v[204:207], v[108:111], v[84:87], v[204:207]
ds_read_b128 v[36:39], v9 offset:2048
v_mfma_f32_16x16x32_bf16 v[236:239], v[108:111], v[88:91], v[236:239]
ds_read_b128 v[40:43], v9 offset:3072
v_mfma_f32_16x16x32_bf16 v[240:243], v[112:115], v[88:91], v[240:243]
v_mfma_f32_16x16x32_bf16 v[208:211], v[112:115], v[84:87], v[208:211]
v_mfma_f32_16x16x32_bf16 v[176:179], v[112:115], v[80:83], v[176:179]
v_mfma_f32_16x16x32_bf16 v[144:147], v[112:115], v[76:79], v[144:147]
v_mfma_f32_16x16x32_bf16 v[148:151], v[116:119], v[76:79], v[148:151]
v_mfma_f32_16x16x32_bf16 v[180:183], v[116:119], v[80:83], v[180:183]
v_mfma_f32_16x16x32_bf16 v[212:215], v[116:119], v[84:87], v[212:215]
v_mfma_f32_16x16x32_bf16 v[244:247], v[116:119], v[88:91], v[244:247]
v_mfma_f32_16x16x32_bf16 v[248:251], v[120:123], v[88:91], v[248:251]
v_mfma_f32_16x16x32_bf16 v[216:219], v[120:123], v[84:87], v[216:219]
v_mfma_f32_16x16x32_bf16 v[184:187], v[120:123], v[80:83], v[184:187]
v_mfma_f32_16x16x32_bf16 v[152:155], v[120:123], v[76:79], v[152:155]
s_waitcnt lgkmcnt(0)
v_mfma_f32_16x16x32_bf16 v[124:127], v[44:47], v[28:31], v[124:127]
ds_read_b128 v[76:79], v9 offset:8192
v_mfma_f32_16x16x32_bf16 v[156:159], v[44:47], v[32:35], v[156:159]
ds_read_b64_tr_b16 v[92:93], v11 offset:8192
v_mfma_f32_16x16x32_bf16 v[188:191], v[44:47], v[36:39], v[188:191]
ds_read_b64_tr_b16 v[94:95], v11 offset:12288
v_mfma_f32_16x16x32_bf16 v[220:223], v[44:47], v[40:43], v[220:223]
ds_read_b64_tr_b16 v[96:97], v12 offset:8192
v_mfma_f32_16x16x32_bf16 v[224:227], v[48:51], v[40:43], v[224:227]
ds_read_b64_tr_b16 v[98:99], v12 offset:12288
v_mfma_f32_16x16x32_bf16 v[192:195], v[48:51], v[36:39], v[192:195]
ds_read_b64_tr_b16 v[100:101], v13 offset:8192
v_mfma_f32_16x16x32_bf16 v[160:163], v[48:51], v[32:35], v[160:163]
ds_read_b64_tr_b16 v[102:103], v13 offset:12288
v_mfma_f32_16x16x32_bf16 v[128:131], v[48:51], v[28:31], v[128:131]
ds_read_b64_tr_b16 v[104:105], v14 offset:8192
v_mfma_f32_16x16x32_bf16 v[132:135], v[52:55], v[28:31], v[132:135]
ds_read_b64_tr_b16 v[106:107], v14 offset:12288
v_mfma_f32_16x16x32_bf16 v[164:167], v[52:55], v[32:35], v[164:167]
ds_read_b64_tr_b16 v[108:109], v11 offset:24576
v_mfma_f32_16x16x32_bf16 v[196:199], v[52:55], v[36:39], v[196:199]
ds_read_b64_tr_b16 v[110:111], v11 offset:28672
v_mfma_f32_16x16x32_bf16 v[228:231], v[52:55], v[40:43], v[228:231]
ds_read_b64_tr_b16 v[112:113], v12 offset:24576
v_mfma_f32_16x16x32_bf16 v[232:235], v[56:59], v[40:43], v[232:235]
ds_read_b64_tr_b16 v[114:115], v12 offset:28672
v_mfma_f32_16x16x32_bf16 v[200:203], v[56:59], v[36:39], v[200:203]
ds_read_b64_tr_b16 v[116:117], v13 offset:24576
v_mfma_f32_16x16x32_bf16 v[168:171], v[56:59], v[32:35], v[168:171]
ds_read_b64_tr_b16 v[118:119], v13 offset:28672
v_mfma_f32_16x16x32_bf16 v[136:139], v[56:59], v[28:31], v[136:139]
ds_read_b64_tr_b16 v[120:121], v14 offset:24576
v_mfma_f32_16x16x32_bf16 v[140:143], v[60:63], v[28:31], v[140:143]
ds_read_b64_tr_b16 v[122:123], v14 offset:28672
v_mfma_f32_16x16x32_bf16 v[172:175], v[60:63], v[32:35], v[172:175]
ds_read_b128 v[80:83], v9 offset:9216
v_mfma_f32_16x16x32_bf16 v[204:207], v[60:63], v[36:39], v[204:207]
ds_read_b128 v[84:87], v9 offset:10240
v_mfma_f32_16x16x32_bf16 v[236:239], v[60:63], v[40:43], v[236:239]
ds_read_b128 v[88:91], v9 offset:11264
v_mfma_f32_16x16x32_bf16 v[240:243], v[64:67], v[40:43], v[240:243]
v_mfma_f32_16x16x32_bf16 v[208:211], v[64:67], v[36:39], v[208:211]
v_mfma_f32_16x16x32_bf16 v[176:179], v[64:67], v[32:35], v[176:179]
v_mfma_f32_16x16x32_bf16 v[144:147], v[64:67], v[28:31], v[144:147]
v_mfma_f32_16x16x32_bf16 v[148:151], v[68:71], v[28:31], v[148:151]
v_mfma_f32_16x16x32_bf16 v[180:183], v[68:71], v[32:35], v[180:183]
v_mfma_f32_16x16x32_bf16 v[212:215], v[68:71], v[36:39], v[212:215]
v_mfma_f32_16x16x32_bf16 v[244:247], v[68:71], v[40:43], v[244:247]
v_mfma_f32_16x16x32_bf16 v[248:251], v[72:75], v[40:43], v[248:251]
v_mfma_f32_16x16x32_bf16 v[216:219], v[72:75], v[36:39], v[216:219]
v_mfma_f32_16x16x32_bf16 v[184:187], v[72:75], v[32:35], v[184:187]
v_mfma_f32_16x16x32_bf16 v[152:155], v[72:75], v[28:31], v[152:155]
s_waitcnt lgkmcnt(0)
s_barrier
v_mfma_f32_16x16x32_bf16 v[124:127], v[92:95], v[76:79], v[124:127]
ds_read_b128 v[28:31], v9 offset:49152
v_mfma_f32_16x16x32_bf16 v[156:159], v[92:95], v[80:83], v[156:159]
ds_read_b64_tr_b16 v[44:45], v15 offset:0
v_mfma_f32_16x16x32_bf16 v[188:191], v[92:95], v[84:87], v[188:191]
ds_read_b64_tr_b16 v[46:47], v15 offset:4096
v_mfma_f32_16x16x32_bf16 v[220:223], v[92:95], v[88:91], v[220:223]
ds_read_b64_tr_b16 v[48:49], v16 offset:0
v_mfma_f32_16x16x32_bf16 v[224:227], v[96:99], v[88:91], v[224:227]
ds_read_b64_tr_b16 v[50:51], v16 offset:4096
v_mfma_f32_16x16x32_bf16 v[192:195], v[96:99], v[84:87], v[192:195]
ds_read_b64_tr_b16 v[52:53], v17 offset:0
v_mfma_f32_16x16x32_bf16 v[160:163], v[96:99], v[80:83], v[160:163]
ds_read_b64_tr_b16 v[54:55], v17 offset:4096
v_mfma_f32_16x16x32_bf16 v[128:131], v[96:99], v[76:79], v[128:131]
ds_read_b64_tr_b16 v[56:57], v18 offset:0
v_mfma_f32_16x16x32_bf16 v[132:135], v[100:103], v[76:79], v[132:135]
ds_read_b64_tr_b16 v[58:59], v18 offset:4096
v_mfma_f32_16x16x32_bf16 v[164:167], v[100:103], v[80:83], v[164:167]
ds_read_b64_tr_b16 v[60:61], v15 offset:16384
v_mfma_f32_16x16x32_bf16 v[196:199], v[100:103], v[84:87], v[196:199]
ds_read_b64_tr_b16 v[62:63], v15 offset:20480
v_mfma_f32_16x16x32_bf16 v[228:231], v[100:103], v[88:91], v[228:231]
ds_read_b64_tr_b16 v[64:65], v16 offset:16384
v_mfma_f32_16x16x32_bf16 v[232:235], v[104:107], v[88:91], v[232:235]
ds_read_b64_tr_b16 v[66:67], v16 offset:20480
v_mfma_f32_16x16x32_bf16 v[200:203], v[104:107], v[84:87], v[200:203]
ds_read_b64_tr_b16 v[68:69], v17 offset:16384
v_mfma_f32_16x16x32_bf16 v[168:171], v[104:107], v[80:83], v[168:171]
ds_read_b64_tr_b16 v[70:71], v17 offset:20480
v_mfma_f32_16x16x32_bf16 v[136:139], v[104:107], v[76:79], v[136:139]
ds_read_b64_tr_b16 v[72:73], v18 offset:16384
v_mfma_f32_16x16x32_bf16 v[140:143], v[108:111], v[76:79], v[140:143]
ds_read_b64_tr_b16 v[74:75], v18 offset:20480
v_mfma_f32_16x16x32_bf16 v[172:175], v[108:111], v[80:83], v[172:175]
ds_read_b128 v[32:35], v9 offset:50176
v_mfma_f32_16x16x32_bf16 v[204:207], v[108:111], v[84:87], v[204:207]
ds_read_b128 v[36:39], v9 offset:51200
v_mfma_f32_16x16x32_bf16 v[236:239], v[108:111], v[88:91], v[236:239]
ds_read_b128 v[40:43], v9 offset:52224
v_mfma_f32_16x16x32_bf16 v[240:243], v[112:115], v[88:91], v[240:243]
v_mfma_f32_16x16x32_bf16 v[208:211], v[112:115], v[84:87], v[208:211]
v_mfma_f32_16x16x32_bf16 v[176:179], v[112:115], v[80:83], v[176:179]
v_mfma_f32_16x16x32_bf16 v[144:147], v[112:115], v[76:79], v[144:147]
v_mfma_f32_16x16x32_bf16 v[148:151], v[116:119], v[76:79], v[148:151]
v_mfma_f32_16x16x32_bf16 v[180:183], v[116:119], v[80:83], v[180:183]
v_mfma_f32_16x16x32_bf16 v[212:215], v[116:119], v[84:87], v[212:215]
v_mfma_f32_16x16x32_bf16 v[244:247], v[116:119], v[88:91], v[244:247]
v_mfma_f32_16x16x32_bf16 v[248:251], v[120:123], v[88:91], v[248:251]
v_mfma_f32_16x16x32_bf16 v[216:219], v[120:123], v[84:87], v[216:219]
v_mfma_f32_16x16x32_bf16 v[184:187], v[120:123], v[80:83], v[184:187]
v_mfma_f32_16x16x32_bf16 v[152:155], v[120:123], v[76:79], v[152:155]
s_waitcnt lgkmcnt(0)
v_mfma_f32_16x16x32_bf16 v[124:127], v[44:47], v[28:31], v[124:127]
ds_read_b128 v[76:79], v9 offset:57344
v_mfma_f32_16x16x32_bf16 v[156:159], v[44:47], v[32:35], v[156:159]
ds_read_b64_tr_b16 v[92:93], v15 offset:8192
v_mfma_f32_16x16x32_bf16 v[188:191], v[44:47], v[36:39], v[188:191]
ds_read_b64_tr_b16 v[94:95], v15 offset:12288
v_mfma_f32_16x16x32_bf16 v[220:223], v[44:47], v[40:43], v[220:223]
ds_read_b64_tr_b16 v[96:97], v16 offset:8192
v_mfma_f32_16x16x32_bf16 v[224:227], v[48:51], v[40:43], v[224:227]
ds_read_b64_tr_b16 v[98:99], v16 offset:12288
v_mfma_f32_16x16x32_bf16 v[192:195], v[48:51], v[36:39], v[192:195]
ds_read_b64_tr_b16 v[100:101], v17 offset:8192
v_mfma_f32_16x16x32_bf16 v[160:163], v[48:51], v[32:35], v[160:163]
ds_read_b64_tr_b16 v[102:103], v17 offset:12288
v_mfma_f32_16x16x32_bf16 v[128:131], v[48:51], v[28:31], v[128:131]
ds_read_b64_tr_b16 v[104:105], v18 offset:8192
v_mfma_f32_16x16x32_bf16 v[132:135], v[52:55], v[28:31], v[132:135]
ds_read_b64_tr_b16 v[106:107], v18 offset:12288
v_mfma_f32_16x16x32_bf16 v[164:167], v[52:55], v[32:35], v[164:167]
ds_read_b64_tr_b16 v[108:109], v15 offset:24576
v_mfma_f32_16x16x32_bf16 v[196:199], v[52:55], v[36:39], v[196:199]
ds_read_b64_tr_b16 v[110:111], v15 offset:28672
v_mfma_f32_16x16x32_bf16 v[228:231], v[52:55], v[40:43], v[228:231]
ds_read_b64_tr_b16 v[112:113], v16 offset:24576
v_mfma_f32_16x16x32_bf16 v[232:235], v[56:59], v[40:43], v[232:235]
ds_read_b64_tr_b16 v[114:115], v16 offset:28672
v_mfma_f32_16x16x32_bf16 v[200:203], v[56:59], v[36:39], v[200:203]
ds_read_b64_tr_b16 v[116:117], v17 offset:24576
v_mfma_f32_16x16x32_bf16 v[168:171], v[56:59], v[32:35], v[168:171]
ds_read_b64_tr_b16 v[118:119], v17 offset:28672
v_mfma_f32_16x16x32_bf16 v[136:139], v[56:59], v[28:31], v[136:139]
ds_read_b64_tr_b16 v[120:121], v18 offset:24576
v_mfma_f32_16x16x32_bf16 v[140:143], v[60:63], v[28:31], v[140:143]
ds_read_b64_tr_b16 v[122:123], v18 offset:28672
v_mfma_f32_16x16x32_bf16 v[172:175], v[60:63], v[32:35], v[172:175]
ds_read_b128 v[80:83], v9 offset:58368
v_mfma_f32_16x16x32_bf16 v[204:207], v[60:63], v[36:39], v[204:207]
ds_read_b128 v[84:87], v9 offset:59392
v_mfma_f32_16x16x32_bf16 v[236:239], v[60:63], v[40:43], v[236:239]
ds_read_b128 v[88:91], v9 offset:60416
v_mfma_f32_16x16x32_bf16 v[240:243], v[64:67], v[40:43], v[240:243]
v_mfma_f32_16x16x32_bf16 v[208:211], v[64:67], v[36:39], v[208:211]
v_mfma_f32_16x16x32_bf16 v[176:179], v[64:67], v[32:35], v[176:179]
v_mfma_f32_16x16x32_bf16 v[144:147], v[64:67], v[28:31], v[144:147]
v_mfma_f32_16x16x32_bf16 v[148:151], v[68:71], v[28:31], v[148:151]
v_mfma_f32_16x16x32_bf16 v[180:183], v[68:71], v[32:35], v[180:183]
v_mfma_f32_16x16x32_bf16 v[212:215], v[68:71], v[36:39], v[212:215]
v_mfma_f32_16x16x32_bf16 v[244:247], v[68:71], v[40:43], v[244:247]
v_mfma_f32_16x16x32_bf16 v[248:251], v[72:75], v[40:43], v[248:251]
v_mfma_f32_16x16x32_bf16 v[216:219], v[72:75], v[36:39], v[216:219]
v_mfma_f32_16x16x32_bf16 v[184:187], v[72:75], v[32:35], v[184:187]
v_mfma_f32_16x16x32_bf16 v[152:155], v[72:75], v[28:31], v[152:155]
s_waitcnt lgkmcnt(0)
s_barrier
v_mfma_f32_16x16x32_bf16 v[124:127], v[92:95], v[76:79], v[124:127]
ds_read_b128 v[28:31], v10 offset:0
v_mfma_f32_16x16x32_bf16 v[156:159], v[92:95], v[80:83], v[156:159]
ds_read_b64_tr_b16 v[44:45], v19 offset:0
v_mfma_f32_16x16x32_bf16 v[188:191], v[92:95], v[84:87], v[188:191]
ds_read_b64_tr_b16 v[46:47], v19 offset:4096
v_mfma_f32_16x16x32_bf16 v[220:223], v[92:95], v[88:91], v[220:223]
ds_read_b64_tr_b16 v[48:49], v20 offset:0
v_mfma_f32_16x16x32_bf16 v[224:227], v[96:99], v[88:91], v[224:227]
ds_read_b64_tr_b16 v[50:51], v20 offset:4096
v_mfma_f32_16x16x32_bf16 v[192:195], v[96:99], v[84:87], v[192:195]
ds_read_b64_tr_b16 v[52:53], v21 offset:0
v_mfma_f32_16x16x32_bf16 v[160:163], v[96:99], v[80:83], v[160:163]
ds_read_b64_tr_b16 v[54:55], v21 offset:4096
v_mfma_f32_16x16x32_bf16 v[128:131], v[96:99], v[76:79], v[128:131]
ds_read_b64_tr_b16 v[56:57], v22 offset:0
v_mfma_f32_16x16x32_bf16 v[132:135], v[100:103], v[76:79], v[132:135]
ds_read_b64_tr_b16 v[58:59], v22 offset:4096
v_mfma_f32_16x16x32_bf16 v[164:167], v[100:103], v[80:83], v[164:167]
ds_read_b64_tr_b16 v[60:61], v19 offset:16384
v_mfma_f32_16x16x32_bf16 v[196:199], v[100:103], v[84:87], v[196:199]
ds_read_b64_tr_b16 v[62:63], v19 offset:20480
v_mfma_f32_16x16x32_bf16 v[228:231], v[100:103], v[88:91], v[228:231]
ds_read_b64_tr_b16 v[64:65], v20 offset:16384
v_mfma_f32_16x16x32_bf16 v[232:235], v[104:107], v[88:91], v[232:235]
ds_read_b64_tr_b16 v[66:67], v20 offset:20480
v_mfma_f32_16x16x32_bf16 v[200:203], v[104:107], v[84:87], v[200:203]
ds_read_b64_tr_b16 v[68:69], v21 offset:16384
v_mfma_f32_16x16x32_bf16 v[168:171], v[104:107], v[80:83], v[168:171]
ds_read_b64_tr_b16 v[70:71], v21 offset:20480
v_mfma_f32_16x16x32_bf16 v[136:139], v[104:107], v[76:79], v[136:139]
ds_read_b64_tr_b16 v[72:73], v22 offset:16384
v_mfma_f32_16x16x32_bf16 v[140:143], v[108:111], v[76:79], v[140:143]
ds_read_b64_tr_b16 v[74:75], v22 offset:20480
v_mfma_f32_16x16x32_bf16 v[172:175], v[108:111], v[80:83], v[172:175]
ds_read_b128 v[32:35], v10 offset:1024
v_mfma_f32_16x16x32_bf16 v[204:207], v[108:111], v[84:87], v[204:207]
ds_read_b128 v[36:39], v10 offset:2048
v_mfma_f32_16x16x32_bf16 v[236:239], v[108:111], v[88:91], v[236:239]
ds_read_b128 v[40:43], v10 offset:3072
v_mfma_f32_16x16x32_bf16 v[240:243], v[112:115], v[88:91], v[240:243]
v_mfma_f32_16x16x32_bf16 v[208:211], v[112:115], v[84:87], v[208:211]
v_mfma_f32_16x16x32_bf16 v[176:179], v[112:115], v[80:83], v[176:179]
v_mfma_f32_16x16x32_bf16 v[144:147], v[112:115], v[76:79], v[144:147]
v_mfma_f32_16x16x32_bf16 v[148:151], v[116:119], v[76:79], v[148:151]
v_mfma_f32_16x16x32_bf16 v[180:183], v[116:119], v[80:83], v[180:183]
v_mfma_f32_16x16x32_bf16 v[212:215], v[116:119], v[84:87], v[212:215]
v_mfma_f32_16x16x32_bf16 v[244:247], v[116:119], v[88:91], v[244:247]
v_mfma_f32_16x16x32_bf16 v[248:251], v[120:123], v[88:91], v[248:251]
v_mfma_f32_16x16x32_bf16 v[216:219], v[120:123], v[84:87], v[216:219]
v_mfma_f32_16x16x32_bf16 v[184:187], v[120:123], v[80:83], v[184:187]
v_mfma_f32_16x16x32_bf16 v[152:155], v[120:123], v[76:79], v[152:155]
s_sub_u32 s41, s41, 1
s_cmp_lg_u32 s41, 0
s_cbranch_scc1 Lk3l_142
s_waitcnt lgkmcnt(0)
v_lshrrev_b32 v84, 4, v1
s_lshl_b32 s43, s63, 8
s_add_u32 s43, s43, 148480
v_lshl_add_u32 v85, v84, 4, s43
v_and_b32 v84, 15, v1
s_lshl_b32 s43, s62, 9
s_add_u32 s43, s43, 147456
v_lshl_add_u32 v84, v84, 3, s43
ds_read_b128 v[28:31], v85 offset:0
ds_read_b128 v[32:35], v85 offset:64
ds_read_b128 v[36:39], v85 offset:128
ds_read_b128 v[40:43], v85 offset:192
ds_read_b128 v[44:47], v85 offset:896
ds_read_b128 v[48:51], v85 offset:960
ds_read_b128 v[52:55], v85 offset:1024
ds_read_b128 v[56:59], v85 offset:1088
ds_read_b64 v[60:61], v84 offset:0
ds_read_b64 v[62:63], v84 offset:128
ds_read_b64 v[64:65], v84 offset:256
ds_read_b64 v[66:67], v84 offset:384
s_lshl_b32 s54, s35, 15
s_lshl_b32 s43, s63, 14
s_add_u32 s54, s54, s43
s_lshl_b32 s43, s62, 12
s_add_u32 s54, s54, s43
s_add_u32 s55, s54, 8192
v_lshrrev_b32 v122, 3, v1
v_and_b32 v123, 6, v122
v_and_b32 v25, 7, v1
v_xor_b32 v25, v25, v123
v_lshlrev_b32 v25, 4, v25
v_mul_u32_u24 v122, 2048, v122
v_add_u32 v25, v25, v122
s_lshl_b32 s43, s61, 7
s_lshl_b32 s44, s47, 15
s_add_u32 s43, s43, s44
v_add_u32 v25, s43, v25
s_waitcnt lgkmcnt(0)
v_mul_f32 v70, v61, v61
v_mul_f32 v68, 0xc0135761, v61
v_mul_f32 v69, 0xbdd2d3e8, v61
v_mul_f32 v69, v69, v70
v_rcp_f32 v70, v70
v_mul_f32 v74, v63, v63
v_mul_f32 v72, 0xc0135761, v63
v_mul_f32 v73, 0xbdd2d3e8, v63
v_mul_f32 v73, v73, v74
v_rcp_f32 v74, v74
v_pk_fma_f32 v[124:125], v[60:61], v[28:29], v[124:125] op_sel_hi:[0,1,1] neg_lo:[1,0,0] neg_hi:[1,0,0]
v_pk_fma_f32 v[126:127], v[60:61], v[30:31], v[126:127] op_sel_hi:[0,1,1] neg_lo:[1,0,0] neg_hi:[1,0,0]
v_pk_fma_f32 v[156:157], v[62:63], v[28:29], v[156:157] op_sel_hi:[0,1,1] neg_lo:[1,0,0] neg_hi:[1,0,0]
v_pk_fma_f32 v[158:159], v[62:63], v[30:31], v[158:159] op_sel_hi:[0,1,1] neg_lo:[1,0,0] neg_hi:[1,0,0]
v_pk_mul_f32 v[76:77], v[124:125], v[124:125]
v_pk_mul_f32 v[78:79], v[126:127], v[126:127]
v_pk_mul_f32 v[80:81], v[156:157], v[156:157]
v_pk_mul_f32 v[82:83], v[158:159], v[158:159]
v_pk_fma_f32 v[76:77], v[76:77], v[68:69], v[68:69] op_sel:[0,1,0] op_sel_hi:[1,1,0]
v_pk_fma_f32 v[78:79], v[78:79], v[68:69], v[68:69] op_sel:[0,1,0] op_sel_hi:[1,1,0]
v_pk_fma_f32 v[80:81], v[80:81], v[72:73], v[72:73] op_sel:[0,1,0] op_sel_hi:[1,1,0]
v_pk_fma_f32 v[82:83], v[82:83], v[72:73], v[72:73] op_sel:[0,1,0] op_sel_hi:[1,1,0]
v_pk_mul_f32 v[76:77], v[76:77], v[124:125]
v_pk_mul_f32 v[78:79], v[78:79], v[126:127]
v_pk_mul_f32 v[80:81], v[80:81], v[156:157]
v_pk_mul_f32 v[82:83], v[82:83], v[158:159]
v_exp_f32 v76, v76
v_exp_f32 v77, v77
v_exp_f32 v78, v78
v_exp_f32 v79, v79
v_exp_f32 v80, v80
v_exp_f32 v81, v81
v_exp_f32 v82, v82
v_exp_f32 v83, v83
v_pk_fma_f32 v[140:141], v[60:61], v[44:45], v[140:141] op_sel_hi:[0,1,1] neg_lo:[1,0,0] neg_hi:[1,0,0]
v_pk_fma_f32 v[142:143], v[60:61], v[46:47], v[142:143] op_sel_hi:[0,1,1] neg_lo:[1,0,0] neg_hi:[1,0,0]
v_pk_fma_f32 v[172:173], v[62:63], v[44:45], v[172:173] op_sel_hi:[0,1,1] neg_lo:[1,0,0] neg_hi:[1,0,0]
v_pk_fma_f32 v[174:175], v[62:63], v[46:47], v[174:175] op_sel_hi:[0,1,1] neg_lo:[1,0,0] neg_hi:[1,0,0]
v_pk_fma_f32 v[76:77], v[76:77], v[70:71], v[70:71] op_sel_hi:[1,0,0]
v_pk_fma_f32 v[78:79], v[78:79], v[70:71], v[70:71] op_sel_hi:[1,0,0]
v_pk_fma_f32 v[80:81], v[80:81], v[74:75], v[74:75] op_sel_hi:[1,0,0]
v_pk_fma_f32 v[82:83], v[82:83], v[74:75], v[74:75] op_sel_hi:[1,0,0]
v_rcp_f32 v76, v76
v_rcp_f32 v77, v77
v_rcp_f32 v78, v78
v_rcp_f32 v79, v79
v_rcp_f32 v80, v80
v_rcp_f32 v81, v81
v_rcp_f32 v82, v82
v_rcp_f32 v83, v83
v_pk_mul_f32 v[140:141], v[124:125], v[140:141]
v_pk_mul_f32 v[142:143], v[126:127], v[142:143]
v_pk_mul_f32 v[172:173], v[156:157], v[172:173]
v_pk_mul_f32 v[174:175], v[158:159], v[174:175]
v_pk_mul_f32 v[140:141], v[140:141], v[76:77]
v_pk_mul_f32 v[142:143], v[142:143], v[78:79]
v_pk_mul_f32 v[172:173], v[172:173], v[80:81]
v_pk_mul_f32 v[174:175], v[174:175], v[82:83]
v_cvt_pk_bf16_f32 v124, v140, v141
v_cvt_pk_bf16_f32 v125, v142, v143
v_cvt_pk_bf16_f32 v156, v172, v173
v_cvt_pk_bf16_f32 v157, v174, v175
v_pk_fma_f32 v[128:129], v[60:61], v[32:33], v[128:129] op_sel_hi:[0,1,1] neg_lo:[1,0,0] neg_hi:[1,0,0]
v_pk_fma_f32 v[130:131], v[60:61], v[34:35], v[130:131] op_sel_hi:[0,1,1] neg_lo:[1,0,0] neg_hi:[1,0,0]
v_pk_fma_f32 v[160:161], v[62:63], v[32:33], v[160:161] op_sel_hi:[0,1,1] neg_lo:[1,0,0] neg_hi:[1,0,0]
v_pk_fma_f32 v[162:163], v[62:63], v[34:35], v[162:163] op_sel_hi:[0,1,1] neg_lo:[1,0,0] neg_hi:[1,0,0]
v_pk_mul_f32 v[76:77], v[128:129], v[128:129]
v_pk_mul_f32 v[78:79], v[130:131], v[130:131]
v_pk_mul_f32 v[80:81], v[160:161], v[160:161]
v_pk_mul_f32 v[82:83], v[162:163], v[162:163]
s_branch Lov_16
.p2align 12
.fill 128, 4, 0xbf800000
Lst_16_0:
s_branch Lwr_175
s_nop 0
s_nop 0
Lov_16:
v_pk_fma_f32 v[76:77], v[76:77], v[68:69], v[68:69] op_sel:[0,1,0] op_sel_hi:[1,1,0]
v_pk_fma_f32 v[78:79], v[78:79], v[68:69], v[68:69] op_sel:[0,1,0] op_sel_hi:[1,1,0]
v_pk_fma_f32 v[80:81], v[80:81], v[72:73], v[72:73] op_sel:[0,1,0] op_sel_hi:[1,1,0]
v_pk_fma_f32 v[82:83], v[82:83], v[72:73], v[72:73] op_sel:[0,1,0] op_sel_hi:[1,1,0]
v_pk_mul_f32 v[76:77], v[76:77], v[128:129]
v_pk_mul_f32 v[78:79], v[78:79], v[130:131]
v_pk_mul_f32 v[80:81], v[80:81], v[160:161]
v_pk_mul_f32 v[82:83], v[82:83], v[162:163]
v_exp_f32 v76, v76
v_exp_f32 v77, v77
v_exp_f32 v78, v78
v_exp_f32 v79, v79
v_exp_f32 v80, v80
v_exp_f32 v81, v81
v_exp_f32 v82, v82
v_exp_f32 v83, v83
v_pk_fma_f32 v[144:145], v[60:61], v[48:49], v[144:145] op_sel_hi:[0,1,1] neg_lo:[1,0,0] neg_hi:[1,0,0]
v_pk_fma_f32 v[146:147], v[60:61], v[50:51], v[146:147] op_sel_hi:[0,1,1] neg_lo:[1,0,0] neg_hi:[1,0,0]
v_pk_fma_f32 v[176:177], v[62:63], v[48:49], v[176:177] op_sel_hi:[0,1,1] neg_lo:[1,0,0] neg_hi:[1,0,0]
v_pk_fma_f32 v[178:179], v[62:63], v[50:51], v[178:179] op_sel_hi:[0,1,1] neg_lo:[1,0,0] neg_hi:[1,0,0]
v_pk_fma_f32 v[76:77], v[76:77], v[70:71], v[70:71] op_sel_hi:[1,0,0]
v_pk_fma_f32 v[78:79], v[78:79], v[70:71], v[70:71] op_sel_hi:[1,0,0]
v_pk_fma_f32 v[80:81], v[80:81], v[74:75], v[74:75] op_sel_hi:[1,0,0]
v_pk_fma_f32 v[82:83], v[82:83], v[74:75], v[74:75] op_sel_hi:[1,0,0]
v_rcp_f32 v76, v76
v_rcp_f32 v77, v77
v_rcp_f32 v78, v78
v_rcp_f32 v79, v79
v_rcp_f32 v80, v80
v_rcp_f32 v81, v81
v_rcp_f32 v82, v82
v_rcp_f32 v83, v83
v_pk_mul_f32 v[144:145], v[128:129], v[144:145]
v_pk_mul_f32 v[146:147], v[130:131], v[146:147]
v_pk_mul_f32 v[176:177], v[160:161], v[176:177]
v_pk_mul_f32 v[178:179], v[162:163], v[178:179]
v_pk_mul_f32 v[144:145], v[144:145], v[76:77]
v_pk_mul_f32 v[146:147], v[146:147], v[78:79]
v_pk_mul_f32 v[176:177], v[176:177], v[80:81]
v_pk_mul_f32 v[178:179], v[178:179], v[82:83]
v_cvt_pk_bf16_f32 v126, v144, v145
v_cvt_pk_bf16_f32 v127, v146, v147
v_cvt_pk_bf16_f32 v158, v176, v177
v_cvt_pk_bf16_f32 v159, v178, v179
buffer_store_dwordx4 v[124:127], v2, s[24:27], s54 offen offset:0 sc1
buffer_store_dwordx4 v[156:159], v2, s[24:27], s54 offen offset:1024 sc1
v_pk_fma_f32 v[132:133], v[60:61], v[36:37], v[132:133] op_sel_hi:[0,1,1] neg_lo:[1,0,0] neg_hi:[1,0,0]
v_pk_fma_f32 v[134:135], v[60:61], v[38:39], v[134:135] op_sel_hi:[0,1,1] neg_lo:[1,0,0] neg_hi:[1,0,0]
v_pk_fma_f32 v[164:165], v[62:63], v[36:37], v[164:165] op_sel_hi:[0,1,1] neg_lo:[1,0,0] neg_hi:[1,0,0]
v_pk_fma_f32 v[166:167], v[62:63], v[38:39], v[166:167] op_sel_hi:[0,1,1] neg_lo:[1,0,0] neg_hi:[1,0,0]
v_pk_mul_f32 v[76:77], v[132:133], v[132:133]
v_pk_mul_f32 v[78:79], v[134:135], v[134:135]
v_pk_mul_f32 v[80:81], v[164:165], v[164:165]
v_pk_mul_f32 v[82:83], v[166:167], v[166:167]
v_pk_fma_f32 v[76:77], v[76:77], v[68:69], v[68:69] op_sel:[0,1,0] op_sel_hi:[1,1,0]
v_pk_fma_f32 v[78:79], v[78:79], v[68:69], v[68:69] op_sel:[0,1,0] op_sel_hi:[1,1,0]
v_pk_fma_f32 v[80:81], v[80:81], v[72:73], v[72:73] op_sel:[0,1,0] op_sel_hi:[1,1,0]
v_pk_fma_f32 v[82:83], v[82:83], v[72:73], v[72:73] op_sel:[0,1,0] op_sel_hi:[1,1,0]
v_pk_mul_f32 v[76:77], v[76:77], v[132:133]
v_pk_mul_f32 v[78:79], v[78:79], v[134:135]
v_pk_mul_f32 v[80:81], v[80:81], v[164:165]
v_pk_mul_f32 v[82:83], v[82:83], v[166:167]
v_exp_f32 v76, v76
v_exp_f32 v77, v77
v_exp_f32 v78, v78
v_exp_f32 v79, v79
v_exp_f32 v80, v80
v_exp_f32 v81, v81
v_exp_f32 v82, v82
v_exp_f32 v83, v83
v_pk_fma_f32 v[148:149], v[60:61], v[52:53], v[148:149] op_sel_hi:[0,1,1] neg_lo:[1,0,0] neg_hi:[1,0,0]
v_pk_fma_f32 v[150:151], v[60:61], v[54:55], v[150:151] op_sel_hi:[0,1,1] neg_lo:[1,0,0] neg_hi:[1,0,0]
v_pk_fma_f32 v[180:181], v[62:63], v[52:53], v[180:181] op_sel_hi:[0,1,1] neg_lo:[1,0,0] neg_hi:[1,0,0]
v_pk_fma_f32 v[182:183], v[62:63], v[54:55], v[182:183] op_sel_hi:[0,1,1] neg_lo:[1,0,0] neg_hi:[1,0,0]
v_pk_fma_f32 v[76:77], v[76:77], v[70:71], v[70:71] op_sel_hi:[1,0,0]
v_pk_fma_f32 v[78:79], v[78:79], v[70:71], v[70:71] op_sel_hi:[1,0,0]
v_pk_fma_f32 v[80:81], v[80:81], v[74:75], v[74:75] op_sel_hi:[1,0,0]
v_pk_fma_f32 v[82:83], v[82:83], v[74:75], v[74:75] op_sel_hi:[1,0,0]
v_rcp_f32 v76, v76
v_rcp_f32 v77, v77
v_rcp_f32 v78, v78
v_rcp_f32 v79, v79
v_rcp_f32 v80, v80
v_rcp_f32 v81, v81
v_rcp_f32 v82, v82
v_rcp_f32 v83, v83
v_pk_mul_f32 v[148:149], v[132:133], v[148:149]
v_pk_mul_f32 v[150:151], v[134:135], v[150:151]
v_pk_mul_f32 v[180:181], v[164:165], v[180:181]
v_pk_mul_f32 v[182:183], v[166:167], v[182:183]
v_pk_mul_f32 v[148:149], v[148:149], v[76:77]
v_pk_mul_f32 v[150:151], v[150:151], v[78:79]
v_pk_mul_f32 v[180:181], v[180:181], v[80:81]
v_pk_mul_f32 v[182:183], v[182:183], v[82:83]
v_cvt_pk_bf16_f32 v132, v148, v149
v_cvt_pk_bf16_f32 v133, v150, v151
v_cvt_pk_bf16_f32 v164, v180, v181
v_cvt_pk_bf16_f32 v165, v182, v183
v_pk_fma_f32 v[136:137], v[60:61], v[40:41], v[136:137] op_sel_hi:[0,1,1] neg_lo:[1,0,0] neg_hi:[1,0,0]
v_pk_fma_f32 v[138:139], v[60:61], v[42:43], v[138:139] op_sel_hi:[0,1,1] neg_lo:[1,0,0] neg_hi:[1,0,0]
v_pk_fma_f32 v[168:169], v[62:63], v[40:41], v[168:169] op_sel_hi:[0,1,1] neg_lo:[1,0,0] neg_hi:[1,0,0]
v_pk_fma_f32 v[170:171], v[62:63], v[42:43], v[170:171] op_sel_hi:[0,1,1] neg_lo:[1,0,0] neg_hi:[1,0,0]
v_pk_mul_f32 v[76:77], v[136:137], v[136:137]
v_pk_mul_f32 v[78:79], v[138:139], v[138:139]
v_pk_mul_f32 v[80:81], v[168:169], v[168:169]
v_pk_mul_f32 v[82:83], v[170:171], v[170:171]
v_pk_fma_f32 v[76:77], v[76:77], v[68:69], v[68:69] op_sel:[0,1,0] op_sel_hi:[1,1,0]
v_pk_fma_f32 v[78:79], v[78:79], v[68:69], v[68:69] op_sel:[0,1,0] op_sel_hi:[1,1,0]
v_pk_fma_f32 v[80:81], v[80:81], v[72:73], v[72:73] op_sel:[0,1,0] op_sel_hi:[1,1,0]
v_pk_fma_f32 v[82:83], v[82:83], v[72:73], v[72:73] op_sel:[0,1,0] op_sel_hi:[1,1,0]
v_pk_mul_f32 v[76:77], v[76:77], v[136:137]
v_pk_mul_f32 v[78:79], v[78:79], v[138:139]
v_pk_mul_f32 v[80:81], v[80:81], v[168:169]
v_pk_mul_f32 v[82:83], v[82:83], v[170:171]
v_exp_f32 v76, v76
v_exp_f32 v77, v77
v_exp_f32 v78, v78
v_exp_f32 v79, v79
v_exp_f32 v80, v80
v_exp_f32 v81, v81
v_exp_f32 v82, v82
v_exp_f32 v83, v83
v_pk_fma_f32 v[152:153], v[60:61], v[56:57], v[152:153] op_sel_hi:[0,1,1] neg_lo:[1,0,0] neg_hi:[1,0,0]
v_pk_fma_f32 v[154:155], v[60:61], v[58:59], v[154:155] op_sel_hi:[0,1,1] neg_lo:[1,0,0] neg_hi:[1,0,0]
v_pk_fma_f32 v[184:185], v[62:63], v[56:57], v[184:185] op_sel_hi:[0,1,1] neg_lo:[1,0,0] neg_hi:[1,0,0]
v_pk_fma_f32 v[186:187], v[62:63], v[58:59], v[186:187] op_sel_hi:[0,1,1] neg_lo:[1,0,0] neg_hi:[1,0,0]
v_pk_fma_f32 v[76:77], v[76:77], v[70:71], v[70:71] op_sel_hi:[1,0,0]
v_pk_fma_f32 v[78:79], v[78:79], v[70:71], v[70:71] op_sel_hi:[1,0,0]
v_pk_fma_f32 v[80:81], v[80:81], v[74:75], v[74:75] op_sel_hi:[1,0,0]
v_pk_fma_f32 v[82:83], v[82:83], v[74:75], v[74:75] op_sel_hi:[1,0,0]
v_rcp_f32 v76, v76
v_rcp_f32 v77, v77
v_rcp_f32 v78, v78
v_rcp_f32 v79, v79
v_rcp_f32 v80, v80
v_rcp_f32 v81, v81
v_rcp_f32 v82, v82
v_rcp_f32 v83, v83
v_pk_mul_f32 v[152:153], v[136:137], v[152:153]
v_pk_mul_f32 v[154:155], v[138:139], v[154:155]
v_pk_mul_f32 v[184:185], v[168:169], v[184:185]
v_pk_mul_f32 v[186:187], v[170:171], v[186:187]
v_pk_mul_f32 v[152:153], v[152:153], v[76:77]
v_pk_mul_f32 v[154:155], v[154:155], v[78:79]
v_pk_mul_f32 v[184:185], v[184:185], v[80:81]
v_pk_mul_f32 v[186:187], v[186:187], v[82:83]
v_cvt_pk_bf16_f32 v134, v152, v153
v_cvt_pk_bf16_f32 v135, v154, v155
v_cvt_pk_bf16_f32 v166, v184, v185
v_cvt_pk_bf16_f32 v167, v186, v187
buffer_store_dwordx4 v[132:135], v2, s[24:27], s55 offen offset:0 sc1
buffer_store_dwordx4 v[164:167], v2, s[24:27], s55 offen offset:1024 sc1
v_mul_f32 v70, v65, v65
v_mul_f32 v68, 0xc0135761, v65
v_mul_f32 v69, 0xbdd2d3e8, v65
v_mul_f32 v69, v69, v70
v_rcp_f32 v70, v70
v_mul_f32 v74, v67, v67
v_mul_f32 v72, 0xc0135761, v67
v_mul_f32 v73, 0xbdd2d3e8, v67
v_mul_f32 v73, v73, v74
v_rcp_f32 v74, v74
v_pk_fma_f32 v[188:189], v[64:65], v[28:29], v[188:189] op_sel_hi:[0,1,1] neg_lo:[1,0,0] neg_hi:[1,0,0]
v_pk_fma_f32 v[190:191], v[64:65], v[30:31], v[190:191] op_sel_hi:[0,1,1] neg_lo:[1,0,0] neg_hi:[1,0,0]
v_pk_fma_f32 v[220:221], v[66:67], v[28:29], v[220:221] op_sel_hi:[0,1,1] neg_lo:[1,0,0] neg_hi:[1,0,0]
v_pk_fma_f32 v[222:223], v[66:67], v[30:31], v[222:223] op_sel_hi:[0,1,1] neg_lo:[1,0,0] neg_hi:[1,0,0]
v_pk_mul_f32 v[76:77], v[188:189], v[188:189]
v_pk_mul_f32 v[78:79], v[190:191], v[190:191]
v_pk_mul_f32 v[80:81], v[220:221], v[220:221]
v_pk_mul_f32 v[82:83], v[222:223], v[222:223]
v_pk_fma_f32 v[76:77], v[76:77], v[68:69], v[68:69] op_sel:[0,1,0] op_sel_hi:[1,1,0]
v_pk_fma_f32 v[78:79], v[78:79], v[68:69], v[68:69] op_sel:[0,1,0] op_sel_hi:[1,1,0]
v_pk_fma_f32 v[80:81], v[80:81], v[72:73], v[72:73] op_sel:[0,1,0] op_sel_hi:[1,1,0]
v_pk_fma_f32 v[82:83], v[82:83], v[72:73], v[72:73] op_sel:[0,1,0] op_sel_hi:[1,1,0]
v_pk_mul_f32 v[76:77], v[76:77], v[188:189]
v_pk_mul_f32 v[78:79], v[78:79], v[190:191]
v_pk_mul_f32 v[80:81], v[80:81], v[220:221]
v_pk_mul_f32 v[82:83], v[82:83], v[222:223]
v_exp_f32 v76, v76
v_exp_f32 v77, v77
v_exp_f32 v78, v78
v_exp_f32 v79, v79
v_exp_f32 v80, v80
v_exp_f32 v81, v81
v_exp_f32 v82, v82
v_exp_f32 v83, v83
v_pk_fma_f32 v[204:205], v[64:65], v[44:45], v[204:205] op_sel_hi:[0,1,1] neg_lo:[1,0,0] neg_hi:[1,0,0]
v_pk_fma_f32 v[206:207], v[64:65], v[46:47], v[206:207] op_sel_hi:[0,1,1] neg_lo:[1,0,0] neg_hi:[1,0,0]
v_pk_fma_f32 v[236:237], v[66:67], v[44:45], v[236:237] op_sel_hi:[0,1,1] neg_lo:[1,0,0] neg_hi:[1,0,0]
v_pk_fma_f32 v[238:239], v[66:67], v[46:47], v[238:239] op_sel_hi:[0,1,1] neg_lo:[1,0,0] neg_hi:[1,0,0]
v_pk_fma_f32 v[76:77], v[76:77], v[70:71], v[70:71] op_sel_hi:[1,0,0]
v_pk_fma_f32 v[78:79], v[78:79], v[70:71], v[70:71] op_sel_hi:[1,0,0]
v_pk_fma_f32 v[80:81], v[80:81], v[74:75], v[74:75] op_sel_hi:[1,0,0]
v_pk_fma_f32 v[82:83], v[82:83], v[74:75], v[74:75] op_sel_hi:[1,0,0]
v_rcp_f32 v76, v76
v_rcp_f32 v77, v77
v_rcp_f32 v78, v78
v_rcp_f32 v79, v79
v_rcp_f32 v80, v80
v_rcp_f32 v81, v81
v_rcp_f32 v82, v82
v_rcp_f32 v83, v83
v_pk_mul_f32 v[204:205], v[188:189], v[204:205]
v_pk_mul_f32 v[206:207], v[190:191], v[206:207]
v_pk_mul_f32 v[236:237], v[220:221], v[236:237]
v_pk_mul_f32 v[238:239], v[222:223], v[238:239]
v_pk_mul_f32 v[204:205], v[204:205], v[76:77]
v_pk_mul_f32 v[206:207], v[206:207], v[78:79]
v_pk_mul_f32 v[236:237], v[236:237], v[80:81]
v_pk_mul_f32 v[238:239], v[238:239], v[82:83]
v_cvt_pk_bf16_f32 v188, v204, v205
v_cvt_pk_bf16_f32 v189, v206, v207
v_cvt_pk_bf16_f32 v220, v236, v237
v_cvt_pk_bf16_f32 v221, v238, v239
v_pk_fma_f32 v[192:193], v[64:65], v[32:33], v[192:193] op_sel_hi:[0,1,1] neg_lo:[1,0,0] neg_hi:[1,0,0]
v_pk_fma_f32 v[194:195], v[64:65], v[34:35], v[194:195] op_sel_hi:[0,1,1] neg_lo:[1,0,0] neg_hi:[1,0,0]
v_pk_fma_f32 v[224:225], v[66:67], v[32:33], v[224:225] op_sel_hi:[0,1,1] neg_lo:[1,0,0] neg_hi:[1,0,0]
v_pk_fma_f32 v[226:227], v[66:67], v[34:35], v[226:227] op_sel_hi:[0,1,1] neg_lo:[1,0,0] neg_hi:[1,0,0]
v_pk_mul_f32 v[76:77], v[192:193], v[192:193]
v_pk_mul_f32 v[78:79], v[194:195], v[194:195]
v_pk_mul_f32 v[80:81], v[224:225], v[224:225]
v_pk_mul_f32 v[82:83], v[226:227], v[226:227]
v_pk_fma_f32 v[76:77], v[76:77], v[68:69], v[68:69] op_sel:[0,1,0] op_sel_hi:[1,1,0]
v_pk_fma_f32 v[78:79], v[78:79], v[68:69], v[68:69] op_sel:[0,1,0] op_sel_hi:[1,1,0]
v_pk_fma_f32 v[80:81], v[80:81], v[72:73], v[72:73] op_sel:[0,1,0] op_sel_hi:[1,1,0]
v_pk_fma_f32 v[82:83], v[82:83], v[72:73], v[72:73] op_sel:[0,1,0] op_sel_hi:[1,1,0]
v_pk_mul_f32 v[76:77], v[76:77], v[192:193]
v_pk_mul_f32 v[78:79], v[78:79], v[194:195]
v_pk_mul_f32 v[80:81], v[80:81], v[224:225]
v_pk_mul_f32 v[82:83], v[82:83], v[226:227]
v_exp_f32 v76, v76
v_exp_f32 v77, v77
v_exp_f32 v78, v78
v_exp_f32 v79, v79
v_exp_f32 v80, v80
v_exp_f32 v81, v81
v_exp_f32 v82, v82
v_exp_f32 v83, v83
v_pk_fma_f32 v[208:209], v[64:65], v[48:49], v[208:209] op_sel_hi:[0,1,1] neg_lo:[1,0,0] neg_hi:[1,0,0]
v_pk_fma_f32 v[210:211], v[64:65], v[50:51], v[210:211] op_sel_hi:[0,1,1] neg_lo:[1,0,0] neg_hi:[1,0,0]
v_pk_fma_f32 v[240:241], v[66:67], v[48:49], v[240:241] op_sel_hi:[0,1,1] neg_lo:[1,0,0] neg_hi:[1,0,0]
v_pk_fma_f32 v[242:243], v[66:67], v[50:51], v[242:243] op_sel_hi:[0,1,1] neg_lo:[1,0,0] neg_hi:[1,0,0]
v_pk_fma_f32 v[76:77], v[76:77], v[70:71], v[70:71] op_sel_hi:[1,0,0]
v_pk_fma_f32 v[78:79], v[78:79], v[70:71], v[70:71] op_sel_hi:[1,0,0]
v_pk_fma_f32 v[80:81], v[80:81], v[74:75], v[74:75] op_sel_hi:[1,0,0]
v_pk_fma_f32 v[82:83], v[82:83], v[74:75], v[74:75] op_sel_hi:[1,0,0]
v_rcp_f32 v76, v76
v_rcp_f32 v77, v77
v_rcp_f32 v78, v78
v_rcp_f32 v79, v79
v_rcp_f32 v80, v80
v_rcp_f32 v81, v81
v_rcp_f32 v82, v82
v_rcp_f32 v83, v83
v_pk_mul_f32 v[208:209], v[192:193], v[208:209]
v_pk_mul_f32 v[210:211], v[194:195], v[210:211]
v_pk_mul_f32 v[240:241], v[224:225], v[240:241]
v_pk_mul_f32 v[242:243], v[226:227], v[242:243]
v_pk_mul_f32 v[208:209], v[208:209], v[76:77]
v_pk_mul_f32 v[210:211], v[210:211], v[78:79]
v_pk_mul_f32 v[240:241], v[240:241], v[80:81]
v_pk_mul_f32 v[242:243], v[242:243], v[82:83]
v_cvt_pk_bf16_f32 v190, v208, v209
v_cvt_pk_bf16_f32 v191, v210, v211
v_cvt_pk_bf16_f32 v222, v240, v241
v_cvt_pk_bf16_f32 v223, v242, v243
buffer_store_dwordx4 v[188:191], v2, s[24:27], s54 offen offset:2048 sc1
buffer_store_dwordx4 v[220:223], v2, s[24:27], s54 offen offset:3072 sc1
v_pk_fma_f32 v[196:197], v[64:65], v[36:37], v[196:197] op_sel_hi:[0,1,1] neg_lo:[1,0,0] neg_hi:[1,0,0]
v_pk_fma_f32 v[198:199], v[64:65], v[38:39], v[198:199] op_sel_hi:[0,1,1] neg_lo:[1,0,0] neg_hi:[1,0,0]
v_pk_fma_f32 v[228:229], v[66:67], v[36:37], v[228:229] op_sel_hi:[0,1,1] neg_lo:[1,0,0] neg_hi:[1,0,0]
v_pk_fma_f32 v[230:231], v[66:67], v[38:39], v[230:231] op_sel_hi:[0,1,1] neg_lo:[1,0,0] neg_hi:[1,0,0]
v_pk_mul_f32 v[76:77], v[196:197], v[196:197]
v_pk_mul_f32 v[78:79], v[198:199], v[198:199]
v_pk_mul_f32 v[80:81], v[228:229], v[228:229]
v_pk_mul_f32 v[82:83], v[230:231], v[230:231]
v_pk_fma_f32 v[76:77], v[76:77], v[68:69], v[68:69] op_sel:[0,1,0] op_sel_hi:[1,1,0]
v_pk_fma_f32 v[78:79], v[78:79], v[68:69], v[68:69] op_sel:[0,1,0] op_sel_hi:[1,1,0]
v_pk_fma_f32 v[80:81], v[80:81], v[72:73], v[72:73] op_sel:[0,1,0] op_sel_hi:[1,1,0]
v_pk_fma_f32 v[82:83], v[82:83], v[72:73], v[72:73] op_sel:[0,1,0] op_sel_hi:[1,1,0]
v_pk_mul_f32 v[76:77], v[76:77], v[196:197]
v_pk_mul_f32 v[78:79], v[78:79], v[198:199]
v_pk_mul_f32 v[80:81], v[80:81], v[228:229]
v_pk_mul_f32 v[82:83], v[82:83], v[230:231]
v_exp_f32 v76, v76
v_exp_f32 v77, v77
v_exp_f32 v78, v78
v_exp_f32 v79, v79
v_exp_f32 v80, v80
v_exp_f32 v81, v81
v_exp_f32 v82, v82
v_exp_f32 v83, v83
v_pk_fma_f32 v[212:213], v[64:65], v[52:53], v[212:213] op_sel_hi:[0,1,1] neg_lo:[1,0,0] neg_hi:[1,0,0]
v_pk_fma_f32 v[214:215], v[64:65], v[54:55], v[214:215] op_sel_hi:[0,1,1] neg_lo:[1,0,0] neg_hi:[1,0,0]
v_pk_fma_f32 v[244:245], v[66:67], v[52:53], v[244:245] op_sel_hi:[0,1,1] neg_lo:[1,0,0] neg_hi:[1,0,0]
v_pk_fma_f32 v[246:247], v[66:67], v[54:55], v[246:247] op_sel_hi:[0,1,1] neg_lo:[1,0,0] neg_hi:[1,0,0]
v_pk_fma_f32 v[76:77], v[76:77], v[70:71], v[70:71] op_sel_hi:[1,0,0]
v_pk_fma_f32 v[78:79], v[78:79], v[70:71], v[70:71] op_sel_hi:[1,0,0]
v_pk_fma_f32 v[80:81], v[80:81], v[74:75], v[74:75] op_sel_hi:[1,0,0]
v_pk_fma_f32 v[82:83], v[82:83], v[74:75], v[74:75] op_sel_hi:[1,0,0]
v_rcp_f32 v76, v76
v_rcp_f32 v77, v77
v_rcp_f32 v78, v78
v_rcp_f32 v79, v79
v_rcp_f32 v80, v80
v_rcp_f32 v81, v81
v_rcp_f32 v82, v82
v_rcp_f32 v83, v83
v_pk_mul_f32 v[212:213], v[196:197], v[212:213]
v_pk_mul_f32 v[214:215], v[198:199], v[214:215]
v_pk_mul_f32 v[244:245], v[228:229], v[244:245]
v_pk_mul_f32 v[246:247], v[230:231], v[246:247]
v_pk_mul_f32 v[212:213], v[212:213], v[76:77]
v_pk_mul_f32 v[214:215], v[214:215], v[78:79]
v_pk_mul_f32 v[244:245], v[244:245], v[80:81]
v_pk_mul_f32 v[246:247], v[246:247], v[82:83]
v_cvt_pk_bf16_f32 v196, v212, v213
v_cvt_pk_bf16_f32 v197, v214, v215
v_cvt_pk_bf16_f32 v228, v244, v245
v_cvt_pk_bf16_f32 v229, v246, v247
v_pk_fma_f32 v[200:201], v[64:65], v[40:41], v[200:201] op_sel_hi:[0,1,1] neg_lo:[1,0,0] neg_hi:[1,0,0]
v_pk_fma_f32 v[202:203], v[64:65], v[42:43], v[202:203] op_sel_hi:[0,1,1] neg_lo:[1,0,0] neg_hi:[1,0,0]
v_pk_fma_f32 v[232:233], v[66:67], v[40:41], v[232:233] op_sel_hi:[0,1,1] neg_lo:[1,0,0] neg_hi:[1,0,0]
v_pk_fma_f32 v[234:235], v[66:67], v[42:43], v[234:235] op_sel_hi:[0,1,1] neg_lo:[1,0,0] neg_hi:[1,0,0]
v_pk_mul_f32 v[76:77], v[200:201], v[200:201]
v_pk_mul_f32 v[78:79], v[202:203], v[202:203]
v_pk_mul_f32 v[80:81], v[232:233], v[232:233]
v_pk_mul_f32 v[82:83], v[234:235], v[234:235]
v_pk_fma_f32 v[76:77], v[76:77], v[68:69], v[68:69] op_sel:[0,1,0] op_sel_hi:[1,1,0]
v_pk_fma_f32 v[78:79], v[78:79], v[68:69], v[68:69] op_sel:[0,1,0] op_sel_hi:[1,1,0]
v_pk_fma_f32 v[80:81], v[80:81], v[72:73], v[72:73] op_sel:[0,1,0] op_sel_hi:[1,1,0]
v_pk_fma_f32 v[82:83], v[82:83], v[72:73], v[72:73] op_sel:[0,1,0] op_sel_hi:[1,1,0]
v_pk_mul_f32 v[76:77], v[76:77], v[200:201]
v_pk_mul_f32 v[78:79], v[78:79], v[202:203]
v_pk_mul_f32 v[80:81], v[80:81], v[232:233]
v_pk_mul_f32 v[82:83], v[82:83], v[234:235]
v_exp_f32 v76, v76
v_exp_f32 v77, v77
v_exp_f32 v78, v78
v_exp_f32 v79, v79
v_exp_f32 v80, v80
v_exp_f32 v81, v81
v_exp_f32 v82, v82
v_exp_f32 v83, v83
v_pk_fma_f32 v[216:217], v[64:65], v[56:57], v[216:217] op_sel_hi:[0,1,1] neg_lo:[1,0,0] neg_hi:[1,0,0]
v_pk_fma_f32 v[218:219], v[64:65], v[58:59], v[218:219] op_sel_hi:[0,1,1] neg_lo:[1,0,0] neg_hi:[1,0,0]
v_pk_fma_f32 v[248:249], v[66:67], v[56:57], v[248:249] op_sel_hi:[0,1,1] neg_lo:[1,0,0] neg_hi:[1,0,0]
v_pk_fma_f32 v[250:251], v[66:67], v[58:59], v[250:251] op_sel_hi:[0,1,1] neg_lo:[1,0,0] neg_hi:[1,0,0]
v_pk_fma_f32 v[76:77], v[76:77], v[70:71], v[70:71] op_sel_hi:[1,0,0]
v_pk_fma_f32 v[78:79], v[78:79], v[70:71], v[70:71] op_sel_hi:[1,0,0]
v_pk_fma_f32 v[80:81], v[80:81], v[74:75], v[74:75] op_sel_hi:[1,0,0]
v_pk_fma_f32 v[82:83], v[82:83], v[74:75], v[74:75] op_sel_hi:[1,0,0]
v_rcp_f32 v76, v76
v_rcp_f32 v77, v77
v_rcp_f32 v78, v78
v_rcp_f32 v79, v79
v_rcp_f32 v80, v80
v_rcp_f32 v81, v81
v_rcp_f32 v82, v82
v_rcp_f32 v83, v83
v_pk_mul_f32 v[216:217], v[200:201], v[216:217]
v_pk_mul_f32 v[218:219], v[202:203], v[218:219]
v_pk_mul_f32 v[248:249], v[232:233], v[248:249]
v_pk_mul_f32 v[250:251], v[234:235], v[250:251]
v_pk_mul_f32 v[216:217], v[216:217], v[76:77]
v_pk_mul_f32 v[218:219], v[218:219], v[78:79]
v_pk_mul_f32 v[248:249], v[248:249], v[80:81]
v_pk_mul_f32 v[250:251], v[250:251], v[82:83]
v_cvt_pk_bf16_f32 v198, v216, v217
v_cvt_pk_bf16_f32 v199, v218, v219
v_cvt_pk_bf16_f32 v230, v248, v249
v_cvt_pk_bf16_f32 v231, v250, v251
buffer_store_dwordx4 v[196:199], v2, s[24:27], s55 offen offset:2048 sc1
buffer_store_dwordx4 v[228:231], v2, s[24:27], s55 offen offset:3072 sc1
s_barrier
s_add_u32 s37, s52, 589824
s_add_u32 m0, s39, 81920
s_nop 0
buffer_load_dwordx4 v3, s[24:27], s37 offen sc1 lds
buffer_load_dwordx4 v3, s[24:27], s37 offen offset:1024 sc1 lds
buffer_load_dwordx4 v3, s[24:27], s37 offen offset:2048 sc1 lds
buffer_load_dwordx4 v3, s[24:27], s37 offen offset:3072 sc1 lds
s_add_u32 s38, s53, 4718592
s_add_u32 m0, s39, 147456
s_nop 0
buffer_load_dwordx4 v23, s[28:31], s38 offen lds
s_add_u32 m0, s39, 148480
s_nop 0
buffer_load_dwordx4 v24, s[28:31], s38 offen lds
s_add_u32 m0, s39, 149504
s_add_u32 s38, s38, 16384
buffer_load_dwordx4 v23, s[28:31], s38 offen lds
s_add_u32 m0, s39, 150528
s_nop 0
buffer_load_dwordx4 v24, s[28:31], s38 offen lds
s_add_u32 s37, s52, 606208
s_add_u32 m0, s39, 98304
s_nop 0
buffer_load_dwordx4 v3, s[24:27], s37 offen sc1 lds
buffer_load_dwordx4 v3, s[24:27], s37 offen offset:1024 sc1 lds
buffer_load_dwordx4 v3, s[24:27], s37 offen offset:2048 sc1 lds
buffer_load_dwordx4 v3, s[24:27], s37 offen offset:3072 sc1 lds
s_add_u32 s38, s53, 4849664
s_add_u32 m0, s39, 114688
s_nop 0
buffer_load_dwordx4 v23, s[28:31], s38 offen lds
s_add_u32 m0, s39, 115712
s_nop 0
buffer_load_dwordx4 v24, s[28:31], s38 offen lds
s_add_u32 m0, s39, 116736
s_add_u32 s38, s38, 16384
buffer_load_dwordx4 v23, s[28:31], s38 offen lds
s_add_u32 m0, s39, 117760
s_nop 0
buffer_load_dwordx4 v24, s[28:31], s38 offen lds
s_barrier
s_add_u32 s37, s52, 622592
s_add_u32 m0, s39, 131072
s_nop 0
buffer_load_dwordx4 v3, s[24:27], s37 offen sc1 lds
buffer_load_dwordx4 v3, s[24:27], s37 offen offset:1024 sc1 lds
buffer_load_dwordx4 v3, s[24:27], s37 offen offset:2048 sc1 lds
buffer_load_dwordx4 v3, s[24:27], s37 offen offset:3072 sc1 lds
s_add_u32 s38, s53, 4980736
s_add_u32 m0, s39, 0
s_nop 0
buffer_load_dwordx4 v23, s[28:31], s38 offen lds
s_add_u32 m0, s39, 1024
s_nop 0
buffer_load_dwordx4 v24, s[28:31], s38 offen lds
s_add_u32 m0, s39, 2048
s_add_u32 s38, s38, 16384
buffer_load_dwordx4 v23, s[28:31], s38 offen lds
s_add_u32 m0, s39, 3072
s_nop 0
buffer_load_dwordx4 v24, s[28:31], s38 offen lds
s_waitcnt vmcnt(24)
s_barrier
s_cmp_eq_u32 s47, 0
s_cbranch_scc0 Lw_143
s_add_u32 s7, s34, 48
s_lshl_b32 s7, s7, 7
v_mov_b32 v26, s7
v_mov_b32 v27, 1
s_mov_b64 exec, 1
buffer_atomic_add v27, v26, s[56:59], 0 offen sc1
s_mov_b64 exec, -1
Lw_143:
s_add_u32 s37, s52, 638976
s_add_u32 m0, s39, 16384
s_nop 0
buffer_load_dwordx4 v3, s[24:27], s37 offen sc1 lds
buffer_load_dwordx4 v3, s[24:27], s37 offen offset:1024 sc1 lds
buffer_load_dwordx4 v3, s[24:27], s37 offen offset:2048 sc1 lds
buffer_load_dwordx4 v3, s[24:27], s37 offen offset:3072 sc1 lds
s_add_u32 s38, s53, 5111808
s_add_u32 m0, s39, 32768
s_nop 0
buffer_load_dwordx4 v23, s[28:31], s38 offen lds
s_add_u32 m0, s39, 33792
s_nop 0
buffer_load_dwordx4 v24, s[28:31], s38 offen lds
s_add_u32 m0, s39, 34816
s_add_u32 s38, s38, 16384
buffer_load_dwordx4 v23, s[28:31], s38 offen lds
s_add_u32 m0, s39, 35840
s_nop 0
buffer_load_dwordx4 v24, s[28:31], s38 offen lds
s_waitcnt vmcnt(24)
s_barrier
s_add_u32 s37, s52, 655360
s_add_u32 m0, s39, 49152
s_nop 0
buffer_load_dwordx4 v3, s[24:27], s37 offen sc1 lds
buffer_load_dwordx4 v3, s[24:27], s37 offen offset:1024 sc1 lds
buffer_load_dwordx4 v3, s[24:27], s37 offen offset:2048 sc1 lds
buffer_load_dwordx4 v3, s[24:27], s37 offen offset:3072 sc1 lds
s_add_u32 s38, s53, 5242880
s_add_u32 m0, s39, 65536
s_nop 0
buffer_load_dwordx4 v23, s[28:31], s38 offen lds
s_add_u32 m0, s39, 66560
s_nop 0
buffer_load_dwordx4 v24, s[28:31], s38 offen lds
s_add_u32 m0, s39, 67584
s_add_u32 s38, s38, 16384
buffer_load_dwordx4 v23, s[28:31], s38 offen lds
s_add_u32 m0, s39, 68608
s_nop 0
buffer_load_dwordx4 v24, s[28:31], s38 offen lds
s_waitcnt vmcnt(24)
s_barrier
s_add_u32 s37, s52, 671744
s_add_u32 m0, s39, 81920
s_nop 0
buffer_load_dwordx4 v3, s[24:27], s37 offen sc1 lds
buffer_load_dwordx4 v3, s[24:27], s37 offen offset:1024 sc1 lds
buffer_load_dwordx4 v3, s[24:27], s37 offen offset:2048 sc1 lds
buffer_load_dwordx4 v3, s[24:27], s37 offen offset:3072 sc1 lds
s_add_u32 s38, s53, 5373952
s_add_u32 m0, s39, 147456
s_nop 0
buffer_load_dwordx4 v23, s[28:31], s38 offen lds
s_add_u32 m0, s39, 148480
s_nop 0
buffer_load_dwordx4 v24, s[28:31], s38 offen lds
s_add_u32 m0, s39, 149504
s_add_u32 s38, s38, 16384
buffer_load_dwordx4 v23, s[28:31], s38 offen lds
s_add_u32 m0, s39, 150528
s_nop 0
buffer_load_dwordx4 v24, s[28:31], s38 offen lds
s_waitcnt vmcnt(24)
s_barrier
s_add_u32 s37, s52, 688128
s_add_u32 m0, s39, 98304
s_nop 0
buffer_load_dwordx4 v3, s[24:27], s37 offen sc1 lds
buffer_load_dwordx4 v3, s[24:27], s37 offen offset:1024 sc1 lds
buffer_load_dwordx4 v3, s[24:27], s37 offen offset:2048 sc1 lds
buffer_load_dwordx4 v3, s[24:27], s37 offen offset:3072 sc1 lds
s_add_u32 s38, s53, 5505024
s_add_u32 m0, s39, 114688
s_nop 0
buffer_load_dwordx4 v23, s[28:31], s38 offen lds
s_add_u32 m0, s39, 115712
s_nop 0
buffer_load_dwordx4 v24, s[28:31], s38 offen lds
s_add_u32 m0, s39, 116736
s_branch Lov_17
.p2align 12
.fill 128, 4, 0xbf800000
Lst_17_0:
s_branch Lwr_176
s_nop 0
s_nop 0
Lov_17:
s_add_u32 s38, s38, 16384
buffer_load_dwordx4 v23, s[28:31], s38 offen lds
s_add_u32 m0, s39, 117760
s_nop 0
buffer_load_dwordx4 v24, s[28:31], s38 offen lds
s_waitcnt vmcnt(24)
s_barrier
s_cmp_eq_u32 s47, 3
s_cbranch_scc0 Lw_144
s_lshl_b32 s92, s34, 7
s_add_u32 s92, s92, 28317696
s_load_dword s93, s[82:83], s92 glc
Lw_144:
s_add_u32 s37, s52, 704512
s_add_u32 m0, s39, 131072
s_nop 0
buffer_load_dwordx4 v3, s[24:27], s37 offen sc1 lds
buffer_load_dwordx4 v3, s[24:27], s37 offen offset:1024 sc1 lds
buffer_load_dwordx4 v3, s[24:27], s37 offen offset:2048 sc1 lds
buffer_load_dwordx4 v3, s[24:27], s37 offen offset:3072 sc1 lds
s_add_u32 s38, s53, 5636096
s_add_u32 m0, s39, 0
s_nop 0
buffer_load_dwordx4 v23, s[28:31], s38 offen lds
s_add_u32 m0, s39, 1024
s_nop 0
buffer_load_dwordx4 v24, s[28:31], s38 offen lds
s_add_u32 m0, s39, 2048
s_add_u32 s38, s38, 16384
buffer_load_dwordx4 v23, s[28:31], s38 offen lds
s_add_u32 m0, s39, 3072
s_nop 0
buffer_load_dwordx4 v24, s[28:31], s38 offen lds
s_waitcnt vmcnt(24)
s_cmp_eq_u32 s47, 3
s_cbranch_scc0 Lw_145
s_mov_b32 s41, 0x40000
s_branch Lpchk_148
Lpoll_146:
s_load_dword s93, s[82:83], s92 glc
Lpchk_148:
s_waitcnt lgkmcnt(0)
s_cmp_eq_u32 s93, 16
s_cbranch_scc1 Lpok_147
s_sub_u32 s41, s41, 1
s_cmp_lg_u32 s41, 0
s_cbranch_scc1 Lpoll_146
Lpok_147:
Lw_145:
s_barrier
s_add_u32 s37, s90, 0
s_add_u32 m0, s39, 16384
s_nop 0
buffer_load_dwordx4 v3, s[24:27], s37 offen sc1 lds
buffer_load_dwordx4 v3, s[24:27], s37 offen offset:1024 sc1 lds
buffer_load_dwordx4 v3, s[24:27], s37 offen offset:2048 sc1 lds
buffer_load_dwordx4 v3, s[24:27], s37 offen offset:3072 sc1 lds
s_add_u32 s38, s91, 0
s_add_u32 m0, s39, 32768
s_nop 0
buffer_load_dwordx4 v23, s[28:31], s38 offen lds
s_add_u32 m0, s39, 33792
s_nop 0
buffer_load_dwordx4 v24, s[28:31], s38 offen lds
s_add_u32 m0, s39, 34816
s_add_u32 s38, s38, 16384
buffer_load_dwordx4 v23, s[28:31], s38 offen lds
s_add_u32 m0, s39, 35840
s_nop 0
buffer_load_dwordx4 v24, s[28:31], s38 offen lds
s_waitcnt vmcnt(24)
s_barrier
s_add_u32 s37, s90, 16384
s_add_u32 m0, s39, 49152
s_nop 0
buffer_load_dwordx4 v3, s[24:27], s37 offen sc1 lds
buffer_load_dwordx4 v3, s[24:27], s37 offen offset:1024 sc1 lds
buffer_load_dwordx4 v3, s[24:27], s37 offen offset:2048 sc1 lds
buffer_load_dwordx4 v3, s[24:27], s37 offen offset:3072 sc1 lds
s_add_u32 s38, s91, 131072
s_add_u32 m0, s39, 65536
s_nop 0
buffer_load_dwordx4 v23, s[28:31], s38 offen lds
s_add_u32 m0, s39, 66560
s_nop 0
buffer_load_dwordx4 v24, s[28:31], s38 offen lds
s_add_u32 m0, s39, 67584
s_add_u32 s38, s38, 16384
buffer_load_dwordx4 v23, s[28:31], s38 offen lds
s_add_u32 m0, s39, 68608
s_nop 0
buffer_load_dwordx4 v24, s[28:31], s38 offen lds
s_waitcnt vmcnt(24)
s_barrier
s_add_u32 s37, s90, 32768
s_add_u32 m0, s39, 81920
s_nop 0
buffer_load_dwordx4 v3, s[24:27], s37 offen sc1 lds
buffer_load_dwordx4 v3, s[24:27], s37 offen offset:1024 sc1 lds
buffer_load_dwordx4 v3, s[24:27], s37 offen offset:2048 sc1 lds
buffer_load_dwordx4 v3, s[24:27], s37 offen offset:3072 sc1 lds
s_add_u32 s38, s91, 262144
s_add_u32 m0, s39, 147456
s_nop 0
buffer_load_dwordx4 v23, s[28:31], s38 offen lds
s_add_u32 m0, s39, 148480
s_nop 0
buffer_load_dwordx4 v24, s[28:31], s38 offen lds
s_add_u32 m0, s39, 149504
s_add_u32 s38, s38, 16384
buffer_load_dwordx4 v23, s[28:31], s38 offen lds
s_add_u32 m0, s39, 150528
s_nop 0
buffer_load_dwordx4 v24, s[28:31], s38 offen lds
s_waitcnt vmcnt(24)
s_barrier
s_add_u32 s37, s90, 49152
s_add_u32 m0, s39, 98304
s_nop 0
buffer_load_dwordx4 v3, s[24:27], s37 offen sc1 lds
buffer_load_dwordx4 v3, s[24:27], s37 offen offset:1024 sc1 lds
buffer_load_dwordx4 v3, s[24:27], s37 offen offset:2048 sc1 lds
buffer_load_dwordx4 v3, s[24:27], s37 offen offset:3072 sc1 lds
s_add_u32 s38, s91, 393216
s_add_u32 m0, s39, 114688
s_nop 0
buffer_load_dwordx4 v23, s[28:31], s38 offen lds
s_add_u32 m0, s39, 115712
s_nop 0
buffer_load_dwordx4 v24, s[28:31], s38 offen lds
s_add_u32 m0, s39, 116736
s_add_u32 s38, s38, 16384
buffer_load_dwordx4 v23, s[28:31], s38 offen lds
s_add_u32 m0, s39, 117760
s_nop 0
buffer_load_dwordx4 v24, s[28:31], s38 offen lds
s_waitcnt vmcnt(24)
s_barrier
s_add_u32 s37, s90, 65536
s_add_u32 m0, s39, 131072
s_nop 0
buffer_load_dwordx4 v3, s[24:27], s37 offen sc1 lds
buffer_load_dwordx4 v3, s[24:27], s37 offen offset:1024 sc1 lds
buffer_load_dwordx4 v3, s[24:27], s37 offen offset:2048 sc1 lds
buffer_load_dwordx4 v3, s[24:27], s37 offen offset:3072 sc1 lds
s_add_u32 s38, s91, 524288
s_add_u32 m0, s39, 0
s_nop 0
buffer_load_dwordx4 v23, s[28:31], s38 offen lds
s_add_u32 m0, s39, 1024
s_nop 0
buffer_load_dwordx4 v24, s[28:31], s38 offen lds
s_add_u32 m0, s39, 2048
s_add_u32 s38, s38, 16384
buffer_load_dwordx4 v23, s[28:31], s38 offen lds
s_add_u32 m0, s39, 3072
s_nop 0
buffer_load_dwordx4 v24, s[28:31], s38 offen lds
s_waitcnt vmcnt(24)
s_barrier
s_add_u32 s37, s90, 81920
s_add_u32 m0, s39, 16384
s_nop 0
buffer_load_dwordx4 v3, s[24:27], s37 offen sc1 lds
buffer_load_dwordx4 v3, s[24:27], s37 offen offset:1024 sc1 lds
buffer_load_dwordx4 v3, s[24:27], s37 offen offset:2048 sc1 lds
buffer_load_dwordx4 v3, s[24:27], s37 offen offset:3072 sc1 lds
s_add_u32 s38, s91, 655360
s_add_u32 m0, s39, 32768
s_nop 0
buffer_load_dwordx4 v23, s[28:31], s38 offen lds
s_add_u32 m0, s39, 33792
s_nop 0
buffer_load_dwordx4 v24, s[28:31], s38 offen lds
s_add_u32 m0, s39, 34816
s_add_u32 s38, s38, 16384
buffer_load_dwordx4 v23, s[28:31], s38 offen lds
s_add_u32 m0, s39, 35840
s_nop 0
buffer_load_dwordx4 v24, s[28:31], s38 offen lds
s_waitcnt vmcnt(24)
s_barrier
s_add_u32 s37, s90, 98304
s_add_u32 m0, s39, 49152
s_nop 0
buffer_load_dwordx4 v3, s[24:27], s37 offen sc1 lds
buffer_load_dwordx4 v3, s[24:27], s37 offen offset:1024 sc1 lds
buffer_load_dwordx4 v3, s[24:27], s37 offen offset:2048 sc1 lds
buffer_load_dwordx4 v3, s[24:27], s37 offen offset:3072 sc1 lds
s_add_u32 s38, s91, 786432
s_add_u32 m0, s39, 65536
s_nop 0
buffer_load_dwordx4 v23, s[28:31], s38 offen lds
s_add_u32 m0, s39, 66560
s_nop 0
buffer_load_dwordx4 v24, s[28:31], s38 offen lds
s_add_u32 m0, s39, 67584
s_add_u32 s38, s38, 16384
buffer_load_dwordx4 v23, s[28:31], s38 offen lds
s_add_u32 m0, s39, 68608
s_nop 0
buffer_load_dwordx4 v24, s[28:31], s38 offen lds
s_waitcnt vmcnt(24)
s_barrier
s_add_u32 s37, s90, 114688
s_add_u32 m0, s39, 81920
s_nop 0
buffer_load_dwordx4 v3, s[24:27], s37 offen sc1 lds
buffer_load_dwordx4 v3, s[24:27], s37 offen offset:1024 sc1 lds
buffer_load_dwordx4 v3, s[24:27], s37 offen offset:2048 sc1 lds
buffer_load_dwordx4 v3, s[24:27], s37 offen offset:3072 sc1 lds
s_add_u32 s38, s91, 917504
s_add_u32 m0, s39, 147456
s_nop 0
buffer_load_dwordx4 v23, s[28:31], s38 offen lds
s_add_u32 m0, s39, 148480
s_nop 0
buffer_load_dwordx4 v24, s[28:31], s38 offen lds
s_add_u32 m0, s39, 149504
s_add_u32 s38, s38, 16384
buffer_load_dwordx4 v23, s[28:31], s38 offen lds
s_add_u32 m0, s39, 150528
s_nop 0
buffer_load_dwordx4 v24, s[28:31], s38 offen lds
s_waitcnt vmcnt(24)
s_barrier
s_add_u32 s37, s90, 131072
s_add_u32 m0, s39, 98304
s_nop 0
buffer_load_dwordx4 v3, s[24:27], s37 offen sc1 lds
buffer_load_dwordx4 v3, s[24:27], s37 offen offset:1024 sc1 lds
buffer_load_dwordx4 v3, s[24:27], s37 offen offset:2048 sc1 lds
buffer_load_dwordx4 v3, s[24:27], s37 offen offset:3072 sc1 lds
s_add_u32 s38, s91, 1048576
s_add_u32 m0, s39, 114688
s_nop 0
buffer_load_dwordx4 v23, s[28:31], s38 offen lds
s_add_u32 m0, s39, 115712
s_nop 0
buffer_load_dwordx4 v24, s[28:31], s38 offen lds
s_add_u32 m0, s39, 116736
s_add_u32 s38, s38, 16384
buffer_load_dwordx4 v23, s[28:31], s38 offen lds
s_add_u32 m0, s39, 117760
s_nop 0
buffer_load_dwordx4 v24, s[28:31], s38 offen lds
s_waitcnt vmcnt(24)
s_barrier
s_add_u32 s37, s90, 147456
s_add_u32 m0, s39, 131072
s_nop 0
buffer_load_dwordx4 v3, s[24:27], s37 offen sc1 lds
buffer_load_dwordx4 v3, s[24:27], s37 offen offset:1024 sc1 lds
buffer_load_dwordx4 v3, s[24:27], s37 offen offset:2048 sc1 lds
buffer_load_dwordx4 v3, s[24:27], s37 offen offset:3072 sc1 lds
s_add_u32 s38, s91, 1179648
s_add_u32 m0, s39, 0
s_nop 0
buffer_load_dwordx4 v23, s[28:31], s38 offen lds
s_add_u32 m0, s39, 1024
s_nop 0
buffer_load_dwordx4 v24, s[28:31], s38 offen lds
s_add_u32 m0, s39, 2048
s_add_u32 s38, s38, 16384
buffer_load_dwordx4 v23, s[28:31], s38 offen lds
s_add_u32 m0, s39, 3072
s_nop 0
buffer_load_dwordx4 v24, s[28:31], s38 offen lds
s_waitcnt vmcnt(24)
s_barrier
s_mov_b32 s37, 327680
s_add_u32 m0, s39, 16384
s_nop 0
buffer_load_dwordx4 v3, s[24:27], s37 offen sc1 lds
buffer_load_dwordx4 v3, s[24:27], s37 offen offset:1024 sc1 lds
buffer_load_dwordx4 v3, s[24:27], s37 offen offset:2048 sc1 lds
buffer_load_dwordx4 v3, s[24:27], s37 offen offset:3072 sc1 lds
s_mov_b32 s38, 2621440
s_add_u32 m0, s51, 32768
s_nop 0
buffer_load_dwordx4 v25, s[28:31], s38 offen lds
s_add_u32 m0, s51, 33792
s_add_u32 s38, s38, 16384
buffer_load_dwordx4 v25, s[28:31], s38 offen lds
s_waitcnt vmcnt(22)
s_barrier
s_mov_b32 s37, 344064
s_add_u32 m0, s39, 49152
s_nop 0
buffer_load_dwordx4 v3, s[24:27], s37 offen sc1 lds
buffer_load_dwordx4 v3, s[24:27], s37 offen offset:1024 sc1 lds
buffer_load_dwordx4 v3, s[24:27], s37 offen offset:2048 sc1 lds
buffer_load_dwordx4 v3, s[24:27], s37 offen offset:3072 sc1 lds
s_mov_b32 s38, 2752512
s_add_u32 m0, s51, 65536
s_nop 0
buffer_load_dwordx4 v25, s[28:31], s38 offen lds
s_add_u32 m0, s51, 66560
s_add_u32 s38, s38, 16384
buffer_load_dwordx4 v25, s[28:31], s38 offen lds
s_waitcnt vmcnt(20)
s_barrier
s_mov_b32 s37, 360448
s_add_u32 m0, s39, 81920
s_nop 0
buffer_load_dwordx4 v3, s[24:27], s37 offen sc1 lds
buffer_load_dwordx4 v3, s[24:27], s37 offen offset:1024 sc1 lds
buffer_load_dwordx4 v3, s[24:27], s37 offen offset:2048 sc1 lds
buffer_load_dwordx4 v3, s[24:27], s37 offen offset:3072 sc1 lds
s_mov_b32 s38, 2883584
s_add_u32 m0, s51, 147456
s_nop 0
buffer_load_dwordx4 v25, s[28:31], s38 offen lds
s_add_u32 m0, s51, 148480
s_add_u32 s38, s38, 16384
buffer_load_dwordx4 v25, s[28:31], s38 offen lds
s_waitcnt vmcnt(18)
s_barrier
s_mov_b32 s37, 376832
s_add_u32 m0, s39, 98304
s_nop 0
buffer_load_dwordx4 v3, s[24:27], s37 offen sc1 lds
buffer_load_dwordx4 v3, s[24:27], s37 offen offset:1024 sc1 lds
buffer_load_dwordx4 v3, s[24:27], s37 offen offset:2048 sc1 lds
buffer_load_dwordx4 v3, s[24:27], s37 offen offset:3072 sc1 lds
s_mov_b32 s38, 3014656
s_add_u32 m0, s51, 114688
s_nop 0
buffer_load_dwordx4 v25, s[28:31], s38 offen lds
s_add_u32 m0, s51, 115712
s_add_u32 s38, s38, 16384
buffer_load_dwordx4 v25, s[28:31], s38 offen lds
s_waitcnt vmcnt(18)
s_barrier
s_mov_b32 s37, 393216
s_add_u32 m0, s39, 131072
s_nop 0
buffer_load_dwordx4 v3, s[24:27], s37 offen sc1 lds
buffer_load_dwordx4 v3, s[24:27], s37 offen offset:1024 sc1 lds
buffer_load_dwordx4 v3, s[24:27], s37 offen offset:2048 sc1 lds
buffer_load_dwordx4 v3, s[24:27], s37 offen offset:3072 sc1 lds
s_mov_b32 s38, 3145728
s_add_u32 m0, s51, 0
s_nop 0
buffer_load_dwordx4 v25, s[28:31], s38 offen lds
s_add_u32 m0, s51, 1024
s_add_u32 s38, s38, 16384
buffer_load_dwordx4 v25, s[28:31], s38 offen lds
s_waitcnt vmcnt(18)
s_barrier
s_mov_b32 s37, 409600
s_add_u32 m0, s39, 16384
s_nop 0
buffer_load_dwordx4 v3, s[24:27], s37 offen sc1 lds
buffer_load_dwordx4 v3, s[24:27], s37 offen offset:1024 sc1 lds
buffer_load_dwordx4 v3, s[24:27], s37 offen offset:2048 sc1 lds
buffer_load_dwordx4 v3, s[24:27], s37 offen offset:3072 sc1 lds
s_mov_b32 s38, 3276800
s_add_u32 m0, s51, 32768
s_nop 0
buffer_load_dwordx4 v25, s[28:31], s38 offen lds
s_add_u32 m0, s51, 33792
s_add_u32 s38, s38, 16384
buffer_load_dwordx4 v25, s[28:31], s38 offen lds
s_waitcnt vmcnt(18)
s_barrier
s_mov_b32 s37, 425984
s_add_u32 m0, s39, 49152
s_nop 0
buffer_load_dwordx4 v3, s[24:27], s37 offen sc1 lds
buffer_load_dwordx4 v3, s[24:27], s37 offen offset:1024 sc1 lds
buffer_load_dwordx4 v3, s[24:27], s37 offen offset:2048 sc1 lds
buffer_load_dwordx4 v3, s[24:27], s37 offen offset:3072 sc1 lds
s_mov_b32 s38, 3407872
s_add_u32 m0, s51, 65536
s_nop 0
buffer_load_dwordx4 v25, s[28:31], s38 offen lds
s_add_u32 m0, s51, 66560
s_add_u32 s38, s38, 16384
buffer_load_dwordx4 v25, s[28:31], s38 offen lds
s_waitcnt vmcnt(18)
s_barrier
s_mov_b32 s37, 442368
s_add_u32 m0, s39, 81920
s_nop 0
buffer_load_dwordx4 v3, s[24:27], s37 offen sc1 lds
buffer_load_dwordx4 v3, s[24:27], s37 offen offset:1024 sc1 lds
buffer_load_dwordx4 v3, s[24:27], s37 offen offset:2048 sc1 lds
buffer_load_dwordx4 v3, s[24:27], s37 offen offset:3072 sc1 lds
s_mov_b32 s38, 3538944
s_add_u32 m0, s51, 147456
s_nop 0
buffer_load_dwordx4 v25, s[28:31], s38 offen lds
s_add_u32 m0, s51, 148480
s_add_u32 s38, s38, 16384
buffer_load_dwordx4 v25, s[28:31], s38 offen lds
s_waitcnt vmcnt(18)
s_barrier
s_mov_b32 s37, 458752
s_add_u32 m0, s39, 98304
s_nop 0
buffer_load_dwordx4 v3, s[24:27], s37 offen sc1 lds
buffer_load_dwordx4 v3, s[24:27], s37 offen offset:1024 sc1 lds
buffer_load_dwordx4 v3, s[24:27], s37 offen offset:2048 sc1 lds
buffer_load_dwordx4 v3, s[24:27], s37 offen offset:3072 sc1 lds
s_mov_b32 s38, 3670016
s_add_u32 m0, s51, 114688
s_nop 0
buffer_load_dwordx4 v25, s[28:31], s38 offen lds
s_add_u32 m0, s51, 115712
s_add_u32 s38, s38, 16384
buffer_load_dwordx4 v25, s[28:31], s38 offen lds
s_waitcnt vmcnt(18)
s_barrier
s_mov_b32 s37, 475136
s_add_u32 m0, s39, 131072
s_nop 0
buffer_load_dwordx4 v3, s[24:27], s37 offen sc1 lds
buffer_load_dwordx4 v3, s[24:27], s37 offen offset:1024 sc1 lds
buffer_load_dwordx4 v3, s[24:27], s37 offen offset:2048 sc1 lds
buffer_load_dwordx4 v3, s[24:27], s37 offen offset:3072 sc1 lds
s_mov_b32 s38, 3801088
s_add_u32 m0, s51, 0
s_nop 0
buffer_load_dwordx4 v25, s[28:31], s38 offen lds
s_add_u32 m0, s51, 1024
s_add_u32 s38, s38, 16384
buffer_load_dwordx4 v25, s[28:31], s38 offen lds
s_waitcnt vmcnt(18)
s_barrier
s_cmp_eq_u32 s47, 0
s_cbranch_scc0 Lw_149
s_xor_b32 s43, s2, 2
s_add_u32 s43, s43, 128
s_lshl_b32 s43, s43, 7
v_mov_b32 v26, s43
v_mov_b32 v27, 1
s_mov_b64 exec, 1
buffer_store_dword v27, v26, s[56:59], 0 offen sc1
s_mov_b64 exec, -1
Lw_149:
s_mov_b32 s37, 491520
s_add_u32 m0, s39, 16384
s_nop 0
buffer_load_dwordx4 v3, s[24:27], s37 offen sc1 lds
buffer_load_dwordx4 v3, s[24:27], s37 offen offset:1024 sc1 lds
buffer_load_dwordx4 v3, s[24:27], s37 offen offset:2048 sc1 lds
buffer_load_dwordx4 v3, s[24:27], s37 offen offset:3072 sc1 lds
s_mov_b32 s38, 3932160
s_add_u32 m0, s51, 32768
s_nop 0
buffer_load_dwordx4 v25, s[28:31], s38 offen lds
s_add_u32 m0, s51, 33792
s_add_u32 s38, s38, 16384
buffer_load_dwordx4 v25, s[28:31], s38 offen lds
s_waitcnt vmcnt(18)
s_barrier
s_mov_b32 s37, 507904
s_add_u32 m0, s39, 49152
s_nop 0
buffer_load_dwordx4 v3, s[24:27], s37 offen sc1 lds
buffer_load_dwordx4 v3, s[24:27], s37 offen offset:1024 sc1 lds
buffer_load_dwordx4 v3, s[24:27], s37 offen offset:2048 sc1 lds
buffer_load_dwordx4 v3, s[24:27], s37 offen offset:3072 sc1 lds
s_mov_b32 s38, 4063232
s_add_u32 m0, s51, 65536
s_nop 0
buffer_load_dwordx4 v25, s[28:31], s38 offen lds
s_add_u32 m0, s51, 66560
s_add_u32 s38, s38, 16384
buffer_load_dwordx4 v25, s[28:31], s38 offen lds
s_waitcnt vmcnt(18)
s_barrier
s_cmp_eq_u32 s47, 3
s_cbranch_scc0 Lw_150
s_lshl_b32 s92, s2, 7
s_add_u32 s92, s92, 28327936
s_load_dword s93, s[82:83], s92 glc
Lw_150:
s_waitcnt vmcnt(12)
s_cmp_eq_u32 s47, 3
s_cbranch_scc0 Lw_151
s_mov_b32 s41, 0x40000
s_branch Lpchk_154
Lpoll_152:
s_load_dword s93, s[82:83], s92 glc
Lpchk_154:
s_waitcnt lgkmcnt(0)
s_cmp_eq_u32 s93, 1
s_cbranch_scc1 Lpok_153
s_sub_u32 s41, s41, 1
s_cmp_lg_u32 s41, 0
s_cbranch_scc1 Lpoll_152
Lpok_153:
Lw_151:
s_barrier
s_waitcnt vmcnt(6)
s_barrier
s_waitcnt vmcnt(0)
s_barrier
s_barrier
s_branch Ldone_1
Ldone_1:
Lfin:
Lexit_2:
s_endpgm
.fill 2304, 4, 0xbf800000
.section .rodata,"a"
.p2align 6
.amdhsa_kernel sequential_preLN__sliding_local_dilated__glu_gated_geglu__prompt_kernel
  .amdhsa_next_free_vgpr 256
  .amdhsa_next_free_sgpr 102
  .amdhsa_accum_offset 256
  .amdhsa_group_segment_fixed_size 0
  .amdhsa_kernarg_size 80
  .amdhsa_user_sgpr_count 2
  .amdhsa_user_sgpr_kernarg_segment_ptr 1
  .amdhsa_system_sgpr_workgroup_id_x 1
  .amdhsa_float_denorm_mode_32 3
  .amdhsa_float_denorm_mode_16_64 3
.end_amdhsa_kernel
```

```asm
; @launch grid=(256,1,1) block=(512,1,1) lds=163840
.amdgcn_target "amdgcn-amd-amdhsa--gfx950"
.text
.globl sequential_preLN__sliding_local_dilated__glu_gated_geglu__prompt_kernel
.p2align 8
.type sequential_preLN__sliding_local_dilated__glu_gated_geglu__prompt_kernel,@function
sequential_preLN__sliding_local_dilated__glu_gated_geglu__prompt_kernel:
s_cmp_ge_u32 s2, 256
s_cbranch_scc1 Lexit_2
s_load_dwordx16 s[64:79], s[0:1], 0
s_load_dwordx4 s[80:83], s[0:1], 64
s_and_b32 s3, s2, 7
s_lshr_b32 s42, s2, 3
s_and_b32 s34, s3, 1
s_lshl_b32 s34, s34, 3
s_and_b32 s48, s42, 7
s_add_u32 s34, s34, s48
s_lshr_b32 s35, s3, 1
s_lshr_b32 s49, s42, 3
s_lshl_b32 s35, s35, 2
s_add_u32 s35, s35, s49
v_lshrrev_b32 v12, 6, v0
v_and_b32 v1, 63, v0
v_readfirstlane_b32 s36, v12
Lbeg:
s_lshl_b32 s50, s34, 7
s_sub_u32 s50, s50, 16
v_and_b32 v12, 15, v1
v_lshrrev_b32 v13, 4, v1
s_cmp_lt_u32 s36, 4
s_cbranch_scc1 Lcons_7
Lprod_3:
s_sub_u32 s47, s36, 4
s_lshl_b32 s43, s34, 7
s_lshl_b32 s44, s35, 3
s_add_u32 s63, s43, s44
s_lshl_b32 s44, s47, 1
s_add_u32 s51, s63, s44
v_lshlrev_b32 v10, 4, v1
s_and_b32 s43, s2, 7
s_lshr_b32 s44, s43, 2
s_lshl_b32 s44, s44, 1
s_and_b32 s45, s43, 1
s_add_u32 s44, s44, s45
s_lshr_b32 s45, s2, 3
s_lshl_b32 s45, s45, 2
s_add_u32 s44, s44, s45
s_add_u32 s44, s44, 96
s_bitcmp1_b32 s43, 1
s_cselect_b32 s44, s44, 0x10000
s_cmp_lt_u32 s2, 192
s_cselect_b32 s33, s2, s44
v_lshrrev_b32 v14, 3, v1
v_and_b32 v15, 7, v1
v_lshl_add_u32 v19, v14, 6, v15
s_lshl_b32 s43, s48, 3
v_add_u32 v19, s43, v19
v_mul_u32_u24 v19, 6144, v19
s_cmp_eq_u32 s47, 3
s_cbranch_scc1 Lpf_4
v_and_b32 v16, 2, v14
v_xor_b32 v16, v15, v16
v_lshlrev_b32 v16, 4, v16
v_mul_u32_u24 v17, 6144, v14
s_lshl_b32 s43, s47, 11
v_add3_u32 v2, v17, v16, s43
v_xor_b32 v3, 64, v2
v_lshrrev_b32 v16, 1, v14
v_xor_b32 v16, v15, v16
v_lshlrev_b32 v16, 4, v16
s_lshl_b32 s43, s47, 3
s_add_u32 s43, s43, s50
v_add_u32 v17, s43, v14
s_and_b32 s44, s47, 1
s_lshl_b32 s44, s44, 6
v_add_u32 v18, 0, v17
v_max_i32 v18, 0, v18
v_lshl_add_u32 v18, v18, 11, v16
v_xor_b32 v18, s44, v18
v_mov_b32 v4, v18
v_add_u32 v18, 24, v17
v_max_i32 v18, 0, v18
v_lshl_add_u32 v18, v18, 11, v16
v_xor_b32 v18, s44, v18
v_xor_b32 v5, 64, v18
v_add_u32 v18, 48, v17
v_max_i32 v18, 0, v18
v_lshl_add_u32 v18, v18, 11, v16
v_xor_b32 v18, s44, v18
v_mov_b32 v6, v18
v_add_u32 v18, 72, v17
v_max_i32 v18, 0, v18
v_lshl_add_u32 v18, v18, 11, v16
v_xor_b32 v18, s44, v18
v_xor_b32 v7, 64, v18
v_add_u32 v18, 96, v17
v_max_i32 v18, 0, v18
v_lshl_add_u32 v18, v18, 11, v16
v_xor_b32 v18, s44, v18
v_mov_b32 v8, v18
v_add_u32 v18, 120, v17
v_max_i32 v18, 0, v18
v_lshl_add_u32 v18, v18, 11, v16
v_xor_b32 v18, s44, v18
v_xor_b32 v9, 64, v18
s_lshl_b32 s39, s47, 10
s_lshl_b32 s40, s47, 13
s_add_u32 s40, s40, 18432
s_mov_b32 s37, 0
s_mov_b32 s38, 0
s_bfm_b64 s[60:61], 56, 8
s_cmp_eq_u32 s47, 0
s_cselect_b64 s[60:61], s[60:61], -1
s_lshl_b32 s43, s35, 7
s_waitcnt lgkmcnt(0)
s_mov_b32 s8, s64
s_mov_b32 s9, s65
s_mov_b32 s10, 4194304
s_mov_b32 s11, 0x20000
s_add_u32 s12, s66, s43
s_addc_u32 s13, s67, 0
s_mov_b32 s14, 6289536
s_mov_b32 s15, 0x20000
s_mov_b32 s28, s66
s_mov_b32 s29, s67
s_mov_b32 s30, 6291456
s_mov_b32 s31, 0x20000
s_mul_i32 s43, s33, 7296
v_lshlrev_b32 v30, 7, v1
s_mul_i32 s44, s47, 2432
s_add_u32 s43, s43, s44
s_bfm_b64 exec, 19, 0
buffer_load_dword v31, v30, s[28:31], s43 offen
s_mov_b64 exec, -1
s_add_u32 m0, s39, 0
s_mov_b64 exec, s[60:61]
buffer_load_dwordx4 v4, s[8:11], s37 offen lds
s_mov_b64 exec, -1
s_add_u32 m0, s39, 3072
s_nop 0
buffer_load_dwordx4 v5, s[8:11], s37 offen lds
s_add_u32 m0, s39, 6144
s_nop 0
buffer_load_dwordx4 v6, s[8:11], s37 offen lds
s_add_u32 m0, s39, 9216
s_nop 0
buffer_load_dwordx4 v7, s[8:11], s37 offen lds
s_add_u32 m0, s39, 12288
s_nop 0
buffer_load_dwordx4 v8, s[8:11], s37 offen lds
s_add_u32 m0, s39, 15360
s_nop 0
buffer_load_dwordx4 v9, s[8:11], s37 offen lds
s_add_u32 m0, s40, 0
s_add_u32 s43, s38, 0
buffer_load_dwordx4 v2, s[12:15], s43 offen lds
s_add_u32 m0, s40, 1024
s_add_u32 s43, s38, 49152
buffer_load_dwordx4 v3, s[12:15], s43 offen lds
s_add_u32 m0, s40, 2048
s_add_u32 s43, s38, 98304
buffer_load_dwordx4 v2, s[12:15], s43 offen lds
s_add_u32 m0, s40, 3072
s_add_u32 s43, s38, 147456
buffer_load_dwordx4 v3, s[12:15], s43 offen lds
s_add_u32 m0, s40, 4096
s_add_u32 s43, s38, 196608
buffer_load_dwordx4 v2, s[12:15], s43 offen lds
s_add_u32 m0, s40, 5120
s_add_u32 s43, s38, 245760
buffer_load_dwordx4 v3, s[12:15], s43 offen lds
s_add_u32 m0, s40, 6144
s_add_u32 s43, s38, 294912
buffer_load_dwordx4 v2, s[12:15], s43 offen lds
s_add_u32 m0, s40, 7168
s_add_u32 s43, s38, 344064
buffer_load_dwordx4 v3, s[12:15], s43 offen lds
s_add_u32 s37, s37, 128
s_add_u32 s38, s38, 393216
s_lshl_b32 s43, s51, 11
buffer_load_dwordx4 v[96:99], v10, s[8:11], s43 offen offset:0
buffer_load_dwordx4 v[100:103], v10, s[8:11], s43 offen offset:1024
buffer_load_dwordx4 v[104:107], v10, s[8:11], s43 offen offset:2048
buffer_load_dwordx4 v[108:111], v10, s[8:11], s43 offen offset:3072
s_add_u32 m0, s39, 43008
s_mov_b64 exec, s[60:61]
buffer_load_dwordx4 v4, s[8:11], s37 offen lds
s_mov_b64 exec, -1
s_add_u32 m0, s39, 46080
s_nop 0
buffer_load_dwordx4 v5, s[8:11], s37 offen lds
s_add_u32 m0, s39, 49152
s_nop 0
buffer_load_dwordx4 v6, s[8:11], s37 offen lds
s_add_u32 m0, s39, 52224
s_nop 0
buffer_load_dwordx4 v7, s[8:11], s37 offen lds
s_add_u32 m0, s39, 55296
s_nop 0
buffer_load_dwordx4 v8, s[8:11], s37 offen lds
s_add_u32 m0, s39, 58368
s_nop 0
buffer_load_dwordx4 v9, s[8:11], s37 offen lds
s_add_u32 m0, s40, 43008
s_add_u32 s43, s38, 0
buffer_load_dwordx4 v2, s[12:15], s43 offen lds
s_add_u32 m0, s40, 44032
s_add_u32 s43, s38, 49152
buffer_load_dwordx4 v3, s[12:15], s43 offen lds
s_add_u32 m0, s40, 45056
s_add_u32 s43, s38, 98304
buffer_load_dwordx4 v2, s[12:15], s43 offen lds
s_add_u32 m0, s40, 46080
s_add_u32 s43, s38, 147456
buffer_load_dwordx4 v3, s[12:15], s43 offen lds
s_add_u32 m0, s40, 47104
s_add_u32 s43, s38, 196608
buffer_load_dwordx4 v2, s[12:15], s43 offen lds
s_add_u32 m0, s40, 48128
s_add_u32 s43, s38, 245760
buffer_load_dwordx4 v3, s[12:15], s43 offen lds
s_add_u32 m0, s40, 49152
s_add_u32 s43, s38, 294912
buffer_load_dwordx4 v2, s[12:15], s43 offen lds
s_add_u32 m0, s40, 50176
s_add_u32 s43, s38, 344064
buffer_load_dwordx4 v3, s[12:15], s43 offen lds
s_add_u32 s37, s37, 128
s_add_u32 s38, s38, 393216
s_waitcnt vmcnt(18)
s_barrier
s_add_u32 m0, s39, 86016
s_mov_b64 exec, s[60:61]
buffer_load_dwordx4 v4, s[8:11], s37 offen lds
s_mov_b64 exec, -1
s_add_u32 m0, s39, 89088
s_nop 0
buffer_load_dwordx4 v5, s[8:11], s37 offen lds
s_add_u32 m0, s39, 92160
s_nop 0
buffer_load_dwordx4 v6, s[8:11], s37 offen lds
s_add_u32 m0, s39, 95232
s_nop 0
buffer_load_dwordx4 v7, s[8:11], s37 offen lds
s_add_u32 m0, s39, 98304
s_nop 0
buffer_load_dwordx4 v8, s[8:11], s37 offen lds
s_add_u32 m0, s39, 101376
s_nop 0
buffer_load_dwordx4 v9, s[8:11], s37 offen lds
s_add_u32 m0, s40, 86016
s_add_u32 s43, s38, 0
buffer_load_dwordx4 v2, s[12:15], s43 offen lds
s_add_u32 m0, s40, 87040
s_add_u32 s43, s38, 49152
buffer_load_dwordx4 v3, s[12:15], s43 offen lds
s_add_u32 m0, s40, 88064
s_add_u32 s43, s38, 98304
buffer_load_dwordx4 v2, s[12:15], s43 offen lds
s_add_u32 m0, s40, 89088
s_add_u32 s43, s38, 147456
buffer_load_dwordx4 v3, s[12:15], s43 offen lds
s_add_u32 m0, s40, 90112
s_add_u32 s43, s38, 196608
buffer_load_dwordx4 v2, s[12:15], s43 offen lds
s_add_u32 m0, s40, 91136
s_add_u32 s43, s38, 245760
buffer_load_dwordx4 v3, s[12:15], s43 offen lds
s_add_u32 m0, s40, 92160
s_add_u32 s43, s38, 294912
buffer_load_dwordx4 v2, s[12:15], s43 offen lds
s_add_u32 m0, s40, 93184
s_add_u32 s43, s38, 344064
buffer_load_dwordx4 v3, s[12:15], s43 offen lds
s_add_u32 s37, s37, 128
s_add_u32 s38, s38, 393216
s_waitcnt vmcnt(28)
s_mov_b32 s43, 0x3f803f80
v_mov_b32 v116, 0
v_mov_b32 v117, 0
v_mov_b32 v118, 0
v_mov_b32 v119, 0
v_mov_b32 v120, 0
v_mov_b32 v121, 0
v_mov_b32 v122, 0
v_mov_b32 v123, 0
v_dot2_f32_bf16 v116, v96, s43, v116
v_dot2_f32_bf16 v120, v96, v96, v120
v_dot2_f32_bf16 v118, v104, s43, v118
v_dot2_f32_bf16 v122, v104, v104, v122
v_dot2_f32_bf16 v117, v97, s43, v117
v_dot2_f32_bf16 v121, v97, v97, v121
v_dot2_f32_bf16 v119, v105, s43, v119
v_dot2_f32_bf16 v123, v105, v105, v123
v_dot2_f32_bf16 v116, v98, s43, v116
v_dot2_f32_bf16 v120, v98, v98, v120
v_dot2_f32_bf16 v118, v106, s43, v118
v_dot2_f32_bf16 v122, v106, v106, v122
v_dot2_f32_bf16 v117, v99, s43, v117
v_dot2_f32_bf16 v121, v99, v99, v121
v_dot2_f32_bf16 v119, v107, s43, v119
v_dot2_f32_bf16 v123, v107, v107, v123
v_dot2_f32_bf16 v116, v100, s43, v116
v_dot2_f32_bf16 v120, v100, v100, v120
v_dot2_f32_bf16 v118, v108, s43, v118
v_dot2_f32_bf16 v122, v108, v108, v122
v_dot2_f32_bf16 v117, v101, s43, v117
v_dot2_f32_bf16 v121, v101, v101, v121
v_dot2_f32_bf16 v119, v109, s43, v119
v_dot2_f32_bf16 v123, v109, v109, v123
v_dot2_f32_bf16 v116, v102, s43, v116
v_dot2_f32_bf16 v120, v102, v102, v120
v_dot2_f32_bf16 v118, v110, s43, v118
v_dot2_f32_bf16 v122, v110, v110, v122
v_dot2_f32_bf16 v117, v103, s43, v117
v_dot2_f32_bf16 v121, v103, v103, v121
v_dot2_f32_bf16 v119, v111, s43, v119
v_dot2_f32_bf16 v123, v111, v111, v123
s_nop 2
v_add_f32 v116, v116, v117
v_add_f32 v118, v118, v119
v_add_f32 v120, v120, v121
v_add_f32 v122, v122, v123
s_nop 1
v_permlane32_swap_b32 v116, v118
v_permlane32_swap_b32 v120, v122
v_add_f32 v116, v116, v118
v_add_f32 v120, v120, v122
s_nop 1
v_permlane16_swap_b32 v116, v120
v_add_f32 v116, v116, v120
s_nop 1
v_add_f32_dpp v116, v116, v116 row_ror:8 row_mask:0xf bank_mask:0xf
s_nop 1
v_add_f32_dpp v116, v116, v116 row_ror:4 row_mask:0xf bank_mask:0xf
s_nop 1
v_add_f32_dpp v116, v116, v116 row_ror:2 row_mask:0xf bank_mask:0xf
s_nop 1
v_add_f32_dpp v116, v116, v116 row_ror:1 row_mask:0xf bank_mask:0xf
v_mov_b32 v117, v116
s_nop 1
v_permlane16_swap_b32 v116, v117
v_mul_f32 v112, 0x3a800000, v116
v_mul_f32 v113, 0x3a800000, v117
v_fma_f32 v113, -v112, v112, v113
v_max_f32 v113, 0, v113
v_add_f32 v113, 0x3727c5ac, v113
v_rsq_f32 v113, v113
v_lshrrev_b32 v11, 5, v1
s_lshl_b32 s43, s47, 4
s_add_u32 s43, s43, 148608
v_lshl_add_u32 v11, v11, 3, s43
ds_write_b64 v11, v[112:113]
s_waitcnt lgkmcnt(0)
s_and_b32 s44, s36, 3
s_mul_i32 s44, s44, 28
s_bfe_u32 s43, s2, 0x30001
s_lshl_b32 s43, s43, 7
s_add_u32 s44, s44, s43
s_mul_i32 s44, s44, 7168
s_lshr_b32 s43, s2, 4
s_lshl_b32 s43, s43, 8
s_add_u32 s43, s43, s44
s_bitcmp0_b32 s2, 0
s_cselect_b32 s4, s72, s74
s_cselect_b32 s5, s73, s75
s_add_u32 s4, s4, s43
s_addc_u32 s5, s5, 0
Lsp_8:
s_waitcnt vmcnt(14)
s_barrier
s_add_u32 m0, s39, 0
s_mov_b64 exec, s[60:61]
buffer_load_dwordx4 v4, s[8:11], s37 offen lds
s_mov_b64 exec, -1
s_add_u32 m0, s39, 3072
s_nop 0
buffer_load_dwordx4 v5, s[8:11], s37 offen lds
s_add_u32 m0, s39, 6144
s_nop 0
buffer_load_dwordx4 v6, s[8:11], s37 offen lds
s_add_u32 m0, s39, 9216
s_nop 0
buffer_load_dwordx4 v7, s[8:11], s37 offen lds
s_add_u32 m0, s39, 12288
s_nop 0
buffer_load_dwordx4 v8, s[8:11], s37 offen lds
s_add_u32 m0, s39, 15360
s_nop 0
buffer_load_dwordx4 v9, s[8:11], s37 offen lds
s_add_u32 m0, s40, 0
s_add_u32 s43, s38, 0
buffer_load_dwordx4 v2, s[12:15], s43 offen lds
s_add_u32 m0, s40, 1024
s_add_u32 s43, s38, 49152
buffer_load_dwordx4 v3, s[12:15], s43 offen lds
s_add_u32 m0, s40, 2048
s_add_u32 s43, s38, 98304
buffer_load_dwordx4 v2, s[12:15], s43 offen lds
s_add_u32 m0, s40, 3072
s_add_u32 s43, s38, 147456
buffer_load_dwordx4 v3, s[12:15], s43 offen lds
s_add_u32 m0, s40, 4096
s_add_u32 s43, s38, 196608
buffer_load_dwordx4 v2, s[12:15], s43 offen lds
s_add_u32 m0, s40, 5120
s_add_u32 s43, s38, 245760
buffer_load_dwordx4 v3, s[12:15], s43 offen lds
s_add_u32 m0, s40, 6144
s_add_u32 s43, s38, 294912
buffer_load_dwordx4 v2, s[12:15], s43 offen lds
s_add_u32 m0, s40, 7168
s_add_u32 s43, s38, 344064
buffer_load_dwordx4 v3, s[12:15], s43 offen lds
s_add_u32 s37, s37, 128
s_add_u32 s38, s38, 393216
Lsp_9:
s_waitcnt vmcnt(14)
s_barrier
s_add_u32 m0, s39, 43008
s_mov_b64 exec, s[60:61]
buffer_load_dwordx4 v4, s[8:11], s37 offen lds
s_mov_b64 exec, -1
s_add_u32 m0, s39, 46080
s_nop 0
buffer_load_dwordx4 v5, s[8:11], s37 offen lds
s_add_u32 m0, s39, 49152
s_nop 0
buffer_load_dwordx4 v6, s[8:11], s37 offen lds
s_add_u32 m0, s39, 52224
s_nop 0
buffer_load_dwordx4 v7, s[8:11], s37 offen lds
s_add_u32 m0, s39, 55296
s_nop 0
buffer_load_dwordx4 v8, s[8:11], s37 offen lds
s_add_u32 m0, s39, 58368
s_nop 0
buffer_load_dwordx4 v9, s[8:11], s37 offen lds
s_add_u32 m0, s40, 43008
s_add_u32 s43, s38, 0
buffer_load_dwordx4 v2, s[12:15], s43 offen lds
s_add_u32 m0, s40, 44032
s_add_u32 s43, s38, 49152
buffer_load_dwordx4 v3, s[12:15], s43 offen lds
s_add_u32 m0, s40, 45056
s_add_u32 s43, s38, 98304
buffer_load_dwordx4 v2, s[12:15], s43 offen lds
s_add_u32 m0, s40, 46080
s_add_u32 s43, s38, 147456
buffer_load_dwordx4 v3, s[12:15], s43 offen lds
s_add_u32 m0, s40, 47104
s_add_u32 s43, s38, 196608
buffer_load_dwordx4 v2, s[12:15], s43 offen lds
s_add_u32 m0, s40, 48128
s_add_u32 s43, s38, 245760
buffer_load_dwordx4 v3, s[12:15], s43 offen lds
s_add_u32 m0, s40, 49152
s_add_u32 s43, s38, 294912
buffer_load_dwordx4 v2, s[12:15], s43 offen lds
s_add_u32 m0, s40, 50176
s_add_u32 s43, s38, 344064
buffer_load_dwordx4 v3, s[12:15], s43 offen lds
s_add_u32 s37, s37, 128
s_add_u32 s38, s38, 393216
s_load_dword s3, s[4:5], 0
s_load_dword s3, s[4:5], 64
s_load_dword s3, s[4:5], 128
Lsp_10:
s_waitcnt vmcnt(14)
s_barrier
s_add_u32 m0, s39, 86016
s_mov_b64 exec, s[60:61]
buffer_load_dwordx4 v4, s[8:11], s37 offen lds
s_mov_b64 exec, -1
s_add_u32 m0, s39, 89088
s_nop 0
buffer_load_dwordx4 v5, s[8:11], s37 offen lds
s_add_u32 m0, s39, 92160
s_nop 0
buffer_load_dwordx4 v6, s[8:11], s37 offen lds
s_add_u32 m0, s39, 95232
s_nop 0
buffer_load_dwordx4 v7, s[8:11], s37 offen lds
s_add_u32 m0, s39, 98304
s_nop 0
buffer_load_dwordx4 v8, s[8:11], s37 offen lds
s_add_u32 m0, s39, 101376
s_nop 0
buffer_load_dwordx4 v9, s[8:11], s37 offen lds
s_add_u32 m0, s40, 86016
s_add_u32 s43, s38, 0
buffer_load_dwordx4 v2, s[12:15], s43 offen lds
s_add_u32 m0, s40, 87040
s_add_u32 s43, s38, 49152
buffer_load_dwordx4 v3, s[12:15], s43 offen lds
s_add_u32 m0, s40, 88064
s_add_u32 s43, s38, 98304
buffer_load_dwordx4 v2, s[12:15], s43 offen lds
s_add_u32 m0, s40, 89088
s_add_u32 s43, s38, 147456
buffer_load_dwordx4 v3, s[12:15], s43 offen lds
s_add_u32 m0, s40, 90112
s_add_u32 s43, s38, 196608
buffer_load_dwordx4 v2, s[12:15], s43 offen lds
s_add_u32 m0, s40, 91136
s_add_u32 s43, s38, 245760
buffer_load_dwordx4 v3, s[12:15], s43 offen lds
s_add_u32 m0, s40, 92160
s_add_u32 s43, s38, 294912
buffer_load_dwordx4 v2, s[12:15], s43 offen lds
s_add_u32 m0, s40, 93184
s_add_u32 s43, s38, 344064
buffer_load_dwordx4 v3, s[12:15], s43 offen lds
s_add_u32 s37, s37, 128
s_add_u32 s38, s38, 393216
s_load_dword s3, s[4:5], 192
s_load_dword s3, s[4:5], 7168
s_load_dword s3, s[4:5], 7232
s_load_dword s3, s[4:5], 7296
s_load_dword s3, s[4:5], 7360
Lsp_11:
s_waitcnt vmcnt(14)
s_barrier
s_add_u32 m0, s39, 0
s_mov_b64 exec, s[60:61]
buffer_load_dwordx4 v4, s[8:11], s37 offen lds
s_mov_b64 exec, -1
s_add_u32 m0, s39, 3072
s_nop 0
buffer_load_dwordx4 v5, s[8:11], s37 offen lds
s_add_u32 m0, s39, 6144
s_nop 0
buffer_load_dwordx4 v6, s[8:11], s37 offen lds
s_branch Lov_0
.p2align 12
Lst_0_0:
s_branch Lwr_155
s_nop 0
s_nop 0
Lov_0:
s_add_u32 m0, s39, 9216
s_nop 0
buffer_load_dwordx4 v7, s[8:11], s37 offen lds
s_add_u32 m0, s39, 12288
s_nop 0
buffer_load_dwordx4 v8, s[8:11], s37 offen lds
s_add_u32 m0, s39, 15360
s_nop 0
buffer_load_dwordx4 v9, s[8:11], s37 offen lds
s_add_u32 m0, s40, 0
s_add_u32 s43, s38, 0
buffer_load_dwordx4 v2, s[12:15], s43 offen lds
s_add_u32 m0, s40, 1024
s_add_u32 s43, s38, 49152
buffer_load_dwordx4 v3, s[12:15], s43 offen lds
s_add_u32 m0, s40, 2048
s_add_u32 s43, s38, 98304
buffer_load_dwordx4 v2, s[12:15], s43 offen lds
s_add_u32 m0, s40, 3072
s_add_u32 s43, s38, 147456
buffer_load_dwordx4 v3, s[12:15], s43 offen lds
s_add_u32 m0, s40, 4096
s_add_u32 s43, s38, 196608
buffer_load_dwordx4 v2, s[12:15], s43 offen lds
s_add_u32 m0, s40, 5120
s_add_u32 s43, s38, 245760
buffer_load_dwordx4 v3, s[12:15], s43 offen lds
s_add_u32 m0, s40, 6144
s_add_u32 s43, s38, 294912
buffer_load_dwordx4 v2, s[12:15], s43 offen lds
s_add_u32 m0, s40, 7168
s_add_u32 s43, s38, 344064
buffer_load_dwordx4 v3, s[12:15], s43 offen lds
s_add_u32 s37, s37, 128
s_add_u32 s38, s38, 393216
s_load_dword s3, s[4:5], 14336
s_load_dword s3, s[4:5], 14400
s_load_dword s3, s[4:5], 14464
s_load_dword s3, s[4:5], 14528
s_load_dword s3, s[4:5], 21504
s_load_dword s3, s[4:5], 21568
Lsp_12:
s_waitcnt vmcnt(14)
s_barrier
s_add_u32 m0, s39, 43008
s_mov_b64 exec, s[60:61]
buffer_load_dwordx4 v4, s[8:11], s37 offen lds
s_mov_b64 exec, -1
s_add_u32 m0, s39, 46080
s_nop 0
buffer_load_dwordx4 v5, s[8:11], s37 offen lds
s_add_u32 m0, s39, 49152
s_nop 0
buffer_load_dwordx4 v6, s[8:11], s37 offen lds
s_add_u32 m0, s39, 52224
s_nop 0
buffer_load_dwordx4 v7, s[8:11], s37 offen lds
s_add_u32 m0, s39, 55296
s_nop 0
buffer_load_dwordx4 v8, s[8:11], s37 offen lds
s_add_u32 m0, s39, 58368
s_nop 0
buffer_load_dwordx4 v9, s[8:11], s37 offen lds
s_add_u32 m0, s40, 43008
s_add_u32 s43, s38, 0
buffer_load_dwordx4 v2, s[12:15], s43 offen lds
s_add_u32 m0, s40, 44032
s_add_u32 s43, s38, 49152
buffer_load_dwordx4 v3, s[12:15], s43 offen lds
s_add_u32 m0, s40, 45056
s_add_u32 s43, s38, 98304
buffer_load_dwordx4 v2, s[12:15], s43 offen lds
s_add_u32 m0, s40, 46080
s_add_u32 s43, s38, 147456
buffer_load_dwordx4 v3, s[12:15], s43 offen lds
s_add_u32 m0, s40, 47104
s_add_u32 s43, s38, 196608
buffer_load_dwordx4 v2, s[12:15], s43 offen lds
s_add_u32 m0, s40, 48128
s_add_u32 s43, s38, 245760
buffer_load_dwordx4 v3, s[12:15], s43 offen lds
s_add_u32 m0, s40, 49152
s_add_u32 s43, s38, 294912
buffer_load_dwordx4 v2, s[12:15], s43 offen lds
s_add_u32 m0, s40, 50176
s_add_u32 s43, s38, 344064
buffer_load_dwordx4 v3, s[12:15], s43 offen lds
s_add_u32 s37, s37, 128
s_add_u32 s38, s38, 393216
s_load_dword s3, s[4:5], 21632
s_load_dword s3, s[4:5], 21696
s_load_dword s3, s[4:5], 28672
s_load_dword s3, s[4:5], 28736
s_load_dword s3, s[4:5], 28800
s_load_dword s3, s[4:5], 28864
s_load_dword s3, s[4:5], 35840
Lsp_13:
s_waitcnt vmcnt(14)
s_barrier
s_add_u32 m0, s39, 86016
s_mov_b64 exec, s[60:61]
buffer_load_dwordx4 v4, s[8:11], s37 offen lds
s_mov_b64 exec, -1
s_add_u32 m0, s39, 89088
s_nop 0
buffer_load_dwordx4 v5, s[8:11], s37 offen lds
s_add_u32 m0, s39, 92160
s_nop 0
buffer_load_dwordx4 v6, s[8:11], s37 offen lds
s_add_u32 m0, s39, 95232
s_nop 0
buffer_load_dwordx4 v7, s[8:11], s37 offen lds
s_add_u32 m0, s39, 98304
s_nop 0
buffer_load_dwordx4 v8, s[8:11], s37 offen lds
s_add_u32 m0, s39, 101376
s_nop 0
buffer_load_dwordx4 v9, s[8:11], s37 offen lds
s_add_u32 m0, s40, 86016
s_add_u32 s43, s38, 0
buffer_load_dwordx4 v2, s[12:15], s43 offen lds
s_add_u32 m0, s40, 87040
s_add_u32 s43, s38, 49152
buffer_load_dwordx4 v3, s[12:15], s43 offen lds
s_add_u32 m0, s40, 88064
s_add_u32 s43, s38, 98304
buffer_load_dwordx4 v2, s[12:15], s43 offen lds
s_add_u32 m0, s40, 89088
s_add_u32 s43, s38, 147456
buffer_load_dwordx4 v3, s[12:15], s43 offen lds
s_add_u32 m0, s40, 90112
s_add_u32 s43, s38, 196608
buffer_load_dwordx4 v2, s[12:15], s43 offen lds
s_add_u32 m0, s40, 91136
s_add_u32 s43, s38, 245760
buffer_load_dwordx4 v3, s[12:15], s43 offen lds
s_add_u32 m0, s40, 92160
s_add_u32 s43, s38, 294912
buffer_load_dwordx4 v2, s[12:15], s43 offen lds
s_add_u32 m0, s40, 93184
s_add_u32 s43, s38, 344064
buffer_load_dwordx4 v3, s[12:15], s43 offen lds
s_add_u32 s37, s37, 128
s_add_u32 s38, s38, 393216
s_load_dword s3, s[4:5], 35904
s_load_dword s3, s[4:5], 35968
s_load_dword s3, s[4:5], 36032
s_load_dword s3, s[4:5], 43008
s_load_dword s3, s[4:5], 43072
s_load_dword s3, s[4:5], 43136
s_load_dword s3, s[4:5], 43200
s_load_dword s3, s[4:5], 50176
Lsp_14:
s_waitcnt vmcnt(14)
s_barrier
s_add_u32 m0, s39, 0
s_mov_b64 exec, s[60:61]
buffer_load_dwordx4 v4, s[8:11], s37 offen lds
s_mov_b64 exec, -1
s_add_u32 m0, s39, 3072
s_nop 0
buffer_load_dwordx4 v5, s[8:11], s37 offen lds
s_add_u32 m0, s39, 6144
s_nop 0
buffer_load_dwordx4 v6, s[8:11], s37 offen lds
s_add_u32 m0, s39, 9216
s_nop 0
buffer_load_dwordx4 v7, s[8:11], s37 offen lds
s_add_u32 m0, s39, 12288
s_nop 0
buffer_load_dwordx4 v8, s[8:11], s37 offen lds
s_add_u32 m0, s39, 15360
s_nop 0
buffer_load_dwordx4 v9, s[8:11], s37 offen lds
s_add_u32 m0, s40, 0
s_add_u32 s43, s38, 0
buffer_load_dwordx4 v2, s[12:15], s43 offen lds
s_add_u32 m0, s40, 1024
s_add_u32 s43, s38, 49152
buffer_load_dwordx4 v3, s[12:15], s43 offen lds
s_add_u32 m0, s40, 2048
s_add_u32 s43, s38, 98304
buffer_load_dwordx4 v2, s[12:15], s43 offen lds
s_add_u32 m0, s40, 3072
s_add_u32 s43, s38, 147456
buffer_load_dwordx4 v3, s[12:15], s43 offen lds
s_add_u32 m0, s40, 4096
s_add_u32 s43, s38, 196608
buffer_load_dwordx4 v2, s[12:15], s43 offen lds
s_add_u32 m0, s40, 5120
s_add_u32 s43, s38, 245760
buffer_load_dwordx4 v3, s[12:15], s43 offen lds
s_add_u32 m0, s40, 6144
s_add_u32 s43, s38, 294912
buffer_load_dwordx4 v2, s[12:15], s43 offen lds
s_add_u32 m0, s40, 7168
s_add_u32 s43, s38, 344064
buffer_load_dwordx4 v3, s[12:15], s43 offen lds
s_add_u32 s37, s37, 128
s_add_u32 s38, s38, 393216
s_load_dword s3, s[4:5], 50240
s_load_dword s3, s[4:5], 50304
s_load_dword s3, s[4:5], 50368
s_load_dword s3, s[4:5], 57344
s_load_dword s3, s[4:5], 57408
s_load_dword s3, s[4:5], 57472
s_load_dword s3, s[4:5], 57536
s_load_dword s3, s[4:5], 64512
s_load_dword s3, s[4:5], 64576
Lsp_15:
s_waitcnt vmcnt(14)
s_barrier
s_add_u32 m0, s39, 43008
s_mov_b64 exec, s[60:61]
buffer_load_dwordx4 v4, s[8:11], s37 offen lds
s_mov_b64 exec, -1
s_add_u32 m0, s39, 46080
s_nop 0
buffer_load_dwordx4 v5, s[8:11], s37 offen lds
s_add_u32 m0, s39, 49152
s_nop 0
buffer_load_dwordx4 v6, s[8:11], s37 offen lds
s_add_u32 m0, s39, 52224
s_nop 0
buffer_load_dwordx4 v7, s[8:11], s37 offen lds
s_add_u32 m0, s39, 55296
s_nop 0
buffer_load_dwordx4 v8, s[8:11], s37 offen lds
s_add_u32 m0, s39, 58368
s_nop 0
buffer_load_dwordx4 v9, s[8:11], s37 offen lds
s_add_u32 m0, s40, 43008
s_add_u32 s43, s38, 0
buffer_load_dwordx4 v2, s[12:15], s43 offen lds
s_add_u32 m0, s40, 44032
s_add_u32 s43, s38, 49152
buffer_load_dwordx4 v3, s[12:15], s43 offen lds
s_add_u32 m0, s40, 45056
s_add_u32 s43, s38, 98304
buffer_load_dwordx4 v2, s[12:15], s43 offen lds
s_add_u32 m0, s40, 46080
s_add_u32 s43, s38, 147456
buffer_load_dwordx4 v3, s[12:15], s43 offen lds
s_add_u32 m0, s40, 47104
s_add_u32 s43, s38, 196608
buffer_load_dwordx4 v2, s[12:15], s43 offen lds
s_add_u32 m0, s40, 48128
s_add_u32 s43, s38, 245760
buffer_load_dwordx4 v3, s[12:15], s43 offen lds
s_add_u32 m0, s40, 49152
s_add_u32 s43, s38, 294912
buffer_load_dwordx4 v2, s[12:15], s43 offen lds
s_add_u32 m0, s40, 50176
s_add_u32 s43, s38, 344064
buffer_load_dwordx4 v3, s[12:15], s43 offen lds
s_add_u32 s37, s37, 128
s_add_u32 s38, s38, 393216
s_load_dword s3, s[4:5], 64640
s_load_dword s3, s[4:5], 64704
s_load_dword s3, s[4:5], 71680
s_load_dword s3, s[4:5], 71744
s_load_dword s3, s[4:5], 71808
s_load_dword s3, s[4:5], 71872
s_load_dword s3, s[4:5], 78848
s_load_dword s3, s[4:5], 78912
s_load_dword s3, s[4:5], 78976
s_load_dword s3, s[4:5], 79040
Lsp_16:
s_waitcnt vmcnt(14)
s_barrier
s_add_u32 m0, s39, 86016
s_mov_b64 exec, s[60:61]
buffer_load_dwordx4 v4, s[8:11], s37 offen lds
s_mov_b64 exec, -1
s_add_u32 m0, s39, 89088
s_nop 0
buffer_load_dwordx4 v5, s[8:11], s37 offen lds
s_add_u32 m0, s39, 92160
s_nop 0
buffer_load_dwordx4 v6, s[8:11], s37 offen lds
s_add_u32 m0, s39, 95232
s_nop 0
buffer_load_dwordx4 v7, s[8:11], s37 offen lds
s_add_u32 m0, s39, 98304
s_nop 0
buffer_load_dwordx4 v8, s[8:11], s37 offen lds
s_add_u32 m0, s39, 101376
s_nop 0
buffer_load_dwordx4 v9, s[8:11], s37 offen lds
s_add_u32 m0, s40, 86016
s_add_u32 s43, s38, 0
buffer_load_dwordx4 v2, s[12:15], s43 offen lds
s_add_u32 m0, s40, 87040
s_add_u32 s43, s38, 49152
buffer_load_dwordx4 v3, s[12:15], s43 offen lds
s_add_u32 m0, s40, 88064
s_add_u32 s43, s38, 98304
buffer_load_dwordx4 v2, s[12:15], s43 offen lds
s_add_u32 m0, s40, 89088
s_add_u32 s43, s38, 147456
buffer_load_dwordx4 v3, s[12:15], s43 offen lds
s_add_u32 m0, s40, 90112
s_add_u32 s43, s38, 196608
buffer_load_dwordx4 v2, s[12:15], s43 offen lds
s_add_u32 m0, s40, 91136
s_add_u32 s43, s38, 245760
buffer_load_dwordx4 v3, s[12:15], s43 offen lds
s_add_u32 m0, s40, 92160
s_add_u32 s43, s38, 294912
buffer_load_dwordx4 v2, s[12:15], s43 offen lds
s_add_u32 m0, s40, 93184
s_add_u32 s43, s38, 344064
buffer_load_dwordx4 v3, s[12:15], s43 offen lds
s_add_u32 s37, s37, 128
s_add_u32 s38, s38, 393216
s_load_dword s3, s[4:5], 86016
s_load_dword s3, s[4:5], 86080
s_load_dword s3, s[4:5], 86144
s_load_dword s3, s[4:5], 86208
s_load_dword s3, s[4:5], 93184
s_load_dword s3, s[4:5], 93248
s_load_dword s3, s[4:5], 93312
s_load_dword s3, s[4:5], 93376
s_load_dword s3, s[4:5], 100352
s_load_dword s3, s[4:5], 100416
Lsp_17:
s_waitcnt vmcnt(14)
s_barrier
s_add_u32 m0, s39, 0
s_mov_b64 exec, s[60:61]
buffer_load_dwordx4 v4, s[8:11], s37 offen lds
s_mov_b64 exec, -1
s_add_u32 m0, s39, 3072
s_nop 0
buffer_load_dwordx4 v5, s[8:11], s37 offen lds
s_add_u32 m0, s39, 6144
s_nop 0
buffer_load_dwordx4 v6, s[8:11], s37 offen lds
s_add_u32 m0, s39, 9216
s_nop 0
buffer_load_dwordx4 v7, s[8:11], s37 offen lds
s_add_u32 m0, s39, 12288
s_nop 0
buffer_load_dwordx4 v8, s[8:11], s37 offen lds
s_add_u32 m0, s39, 15360
s_nop 0
buffer_load_dwordx4 v9, s[8:11], s37 offen lds
s_add_u32 m0, s40, 0
s_add_u32 s43, s38, 0
buffer_load_dwordx4 v2, s[12:15], s43 offen lds
s_add_u32 m0, s40, 1024
s_add_u32 s43, s38, 49152
buffer_load_dwordx4 v3, s[12:15], s43 offen lds
s_add_u32 m0, s40, 2048
s_add_u32 s43, s38, 98304
buffer_load_dwordx4 v2, s[12:15], s43 offen lds
s_add_u32 m0, s40, 3072
s_add_u32 s43, s38, 147456
buffer_load_dwordx4 v3, s[12:15], s43 offen lds
s_add_u32 m0, s40, 4096
s_add_u32 s43, s38, 196608
buffer_load_dwordx4 v2, s[12:15], s43 offen lds
s_add_u32 m0, s40, 5120
s_add_u32 s43, s38, 245760
buffer_load_dwordx4 v3, s[12:15], s43 offen lds
s_add_u32 m0, s40, 6144
s_add_u32 s43, s38, 294912
buffer_load_dwordx4 v2, s[12:15], s43 offen lds
s_add_u32 m0, s40, 7168
s_add_u32 s43, s38, 344064
buffer_load_dwordx4 v3, s[12:15], s43 offen lds
s_add_u32 s37, s37, 128
s_add_u32 s38, s38, 393216
s_load_dword s3, s[4:5], 100480
s_load_dword s3, s[4:5], 100544
s_load_dword s3, s[4:5], 107520
s_load_dword s3, s[4:5], 107584
s_load_dword s3, s[4:5], 107648
s_load_dword s3, s[4:5], 107712
s_load_dword s3, s[4:5], 114688
s_load_dword s3, s[4:5], 114752
s_load_dword s3, s[4:5], 114816
s_load_dword s3, s[4:5], 114880
s_load_dword s3, s[4:5], 121856
Lsp_18:
s_waitcnt vmcnt(14)
s_barrier
s_add_u32 m0, s39, 43008
s_mov_b64 exec, s[60:61]
buffer_load_dwordx4 v4, s[8:11], s37 offen lds
s_mov_b64 exec, -1
s_add_u32 m0, s39, 46080
s_nop 0
buffer_load_dwordx4 v5, s[8:11], s37 offen lds
s_add_u32 m0, s39, 49152
s_nop 0
buffer_load_dwordx4 v6, s[8:11], s37 offen lds
s_add_u32 m0, s39, 52224
s_nop 0
buffer_load_dwordx4 v7, s[8:11], s37 offen lds
s_add_u32 m0, s39, 55296
s_nop 0
buffer_load_dwordx4 v8, s[8:11], s37 offen lds
s_add_u32 m0, s39, 58368
s_nop 0
buffer_load_dwordx4 v9, s[8:11], s37 offen lds
s_add_u32 m0, s40, 43008
s_add_u32 s43, s38, 0
buffer_load_dwordx4 v2, s[12:15], s43 offen lds
s_add_u32 m0, s40, 44032
s_add_u32 s43, s38, 49152
buffer_load_dwordx4 v3, s[12:15], s43 offen lds
s_add_u32 m0, s40, 45056
s_add_u32 s43, s38, 98304
buffer_load_dwordx4 v2, s[12:15], s43 offen lds
s_add_u32 m0, s40, 46080
s_add_u32 s43, s38, 147456
buffer_load_dwordx4 v3, s[12:15], s43 offen lds
s_add_u32 m0, s40, 47104
s_add_u32 s43, s38, 196608
buffer_load_dwordx4 v2, s[12:15], s43 offen lds
s_add_u32 m0, s40, 48128
s_add_u32 s43, s38, 245760
buffer_load_dwordx4 v3, s[12:15], s43 offen lds
s_add_u32 m0, s40, 49152
s_add_u32 s43, s38, 294912
buffer_load_dwordx4 v2, s[12:15], s43 offen lds
s_add_u32 m0, s40, 50176
s_add_u32 s43, s38, 344064
buffer_load_dwordx4 v3, s[12:15], s43 offen lds
s_add_u32 s37, s37, 128
s_add_u32 s38, s38, 393216
s_load_dword s3, s[4:5], 121920
s_load_dword s3, s[4:5], 121984
s_load_dword s3, s[4:5], 122048
s_load_dword s3, s[4:5], 129024
s_load_dword s3, s[4:5], 129088
s_load_dword s3, s[4:5], 129152
s_load_dword s3, s[4:5], 129216
s_load_dword s3, s[4:5], 136192
s_load_dword s3, s[4:5], 136256
s_load_dword s3, s[4:5], 136320
s_load_dword s3, s[4:5], 136384
Lsp_19:
s_waitcnt vmcnt(14)
s_barrier
s_add_u32 m0, s39, 86016
s_mov_b64 exec, s[60:61]
buffer_load_dwordx4 v4, s[8:11], s37 offen lds
s_mov_b64 exec, -1
s_add_u32 m0, s39, 89088
s_nop 0
buffer_load_dwordx4 v5, s[8:11], s37 offen lds
s_add_u32 m0, s39, 92160
s_nop 0
buffer_load_dwordx4 v6, s[8:11], s37 offen lds
s_add_u32 m0, s39, 95232
s_nop 0
buffer_load_dwordx4 v7, s[8:11], s37 offen lds
s_add_u32 m0, s39, 98304
s_nop 0
buffer_load_dwordx4 v8, s[8:11], s37 offen lds
s_add_u32 m0, s39, 101376
s_nop 0
buffer_load_dwordx4 v9, s[8:11], s37 offen lds
s_add_u32 m0, s40, 86016
s_add_u32 s43, s38, 0
buffer_load_dwordx4 v2, s[12:15], s43 offen lds
s_add_u32 m0, s40, 87040
s_add_u32 s43, s38, 49152
buffer_load_dwordx4 v3, s[12:15], s43 offen lds
s_add_u32 m0, s40, 88064
s_add_u32 s43, s38, 98304
buffer_load_dwordx4 v2, s[12:15], s43 offen lds
s_add_u32 m0, s40, 89088
s_add_u32 s43, s38, 147456
buffer_load_dwordx4 v3, s[12:15], s43 offen lds
s_add_u32 m0, s40, 90112
s_add_u32 s43, s38, 196608
buffer_load_dwordx4 v2, s[12:15], s43 offen lds
s_add_u32 m0, s40, 91136
s_add_u32 s43, s38, 245760
buffer_load_dwordx4 v3, s[12:15], s43 offen lds
s_add_u32 m0, s40, 92160
s_add_u32 s43, s38, 294912
buffer_load_dwordx4 v2, s[12:15], s43 offen lds
s_add_u32 m0, s40, 93184
s_add_u32 s43, s38, 344064
buffer_load_dwordx4 v3, s[12:15], s43 offen lds
s_add_u32 s37, s37, 128
s_add_u32 s38, s38, 393216
s_load_dword s3, s[4:5], 143360
s_load_dword s3, s[4:5], 143424
s_load_dword s3, s[4:5], 143488
s_load_dword s3, s[4:5], 143552
s_load_dword s3, s[4:5], 150528
s_load_dword s3, s[4:5], 150592
s_load_dword s3, s[4:5], 150656
s_load_dword s3, s[4:5], 150720
s_load_dword s3, s[4:5], 157696
s_load_dword s3, s[4:5], 157760
s_load_dword s3, s[4:5], 157824
Lsp_20:
s_waitcnt vmcnt(14)
s_barrier
s_add_u32 m0, s39, 0
s_mov_b64 exec, s[60:61]
buffer_load_dwordx4 v4, s[8:11], s37 offen lds
s_mov_b64 exec, -1
s_add_u32 m0, s39, 3072
s_nop 0
buffer_load_dwordx4 v5, s[8:11], s37 offen lds
s_add_u32 m0, s39, 6144
s_nop 0
buffer_load_dwordx4 v6, s[8:11], s37 offen lds
s_add_u32 m0, s39, 9216
s_nop 0
buffer_load_dwordx4 v7, s[8:11], s37 offen lds
s_add_u32 m0, s39, 12288
s_nop 0
buffer_load_dwordx4 v8, s[8:11], s37 offen lds
s_add_u32 m0, s39, 15360
s_nop 0
buffer_load_dwordx4 v9, s[8:11], s37 offen lds
s_add_u32 m0, s40, 0
s_add_u32 s43, s38, 0
buffer_load_dwordx4 v2, s[12:15], s43 offen lds
s_add_u32 m0, s40, 1024
s_add_u32 s43, s38, 49152
buffer_load_dwordx4 v3, s[12:15], s43 offen lds
s_add_u32 m0, s40, 2048
s_add_u32 s43, s38, 98304
buffer_load_dwordx4 v2, s[12:15], s43 offen lds
s_add_u32 m0, s40, 3072
s_add_u32 s43, s38, 147456
buffer_load_dwordx4 v3, s[12:15], s43 offen lds
s_add_u32 m0, s40, 4096
s_add_u32 s43, s38, 196608
buffer_load_dwordx4 v2, s[12:15], s43 offen lds
s_add_u32 m0, s40, 5120
s_add_u32 s43, s38, 245760
buffer_load_dwordx4 v3, s[12:15], s43 offen lds
s_add_u32 m0, s40, 6144
s_add_u32 s43, s38, 294912
buffer_load_dwordx4 v2, s[12:15], s43 offen lds
s_add_u32 m0, s40, 7168
s_add_u32 s43, s38, 344064
buffer_load_dwordx4 v3, s[12:15], s43 offen lds
s_add_u32 s37, s37, 128
s_add_u32 s38, s38, 393216
s_load_dword s3, s[4:5], 157888
s_load_dword s3, s[4:5], 164864
s_load_dword s3, s[4:5], 164928
s_load_dword s3, s[4:5], 164992
s_load_dword s3, s[4:5], 165056
s_load_dword s3, s[4:5], 172032
s_load_dword s3, s[4:5], 172096
s_load_dword s3, s[4:5], 172160
s_load_dword s3, s[4:5], 172224
s_load_dword s3, s[4:5], 179200
s_load_dword s3, s[4:5], 179264
Lsp_21:
s_waitcnt vmcnt(14)
s_barrier
s_load_dword s3, s[4:5], 179328
s_load_dword s3, s[4:5], 179392
s_load_dword s3, s[4:5], 186368
s_load_dword s3, s[4:5], 186432
s_load_dword s3, s[4:5], 186496
s_load_dword s3, s[4:5], 186560
s_load_dword s3, s[4:5], 193536
s_branch Lov_1
.p2align 12
Lst_1_0:
s_branch Lwr_156
s_nop 0
s_nop 0
Lov_1:
s_load_dword s3, s[4:5], 193600
s_load_dword s3, s[4:5], 193664
s_load_dword s3, s[4:5], 193728
Lsp_22:
s_waitcnt vmcnt(0)
s_barrier
s_lshl_b32 s43, s35, 7
s_add_u32 s28, s68, s43
s_addc_u32 s29, s69, 0
s_mov_b32 s30, 2095232
s_mov_b32 s31, 0x20000
v_lshrrev_b32 v15, 3, v1
v_and_b32 v16, 6, v15
v_and_b32 v7, 7, v1
v_xor_b32 v7, v7, v16
v_lshlrev_b32 v7, 4, v7
v_mul_u32_u24 v15, 2048, v15
v_add_u32 v7, v7, v15
s_and_b32 s40, s36, 3
s_lshl_b32 s39, s40, 13
s_add_u32 s40, s40, s35
s_add_u32 s42, s40, 0
s_and_b32 s42, s42, 15
s_lshl_b32 s42, s42, 17
s_add_u32 m0, s39, 65536
s_add_u32 s43, s42, 0
buffer_load_dwordx4 v7, s[28:31], s43 offen lds
s_add_u32 m0, s39, 66560
s_add_u32 s43, s42, 16384
buffer_load_dwordx4 v7, s[28:31], s43 offen lds
s_add_u32 m0, s39, 67584
s_add_u32 s43, s42, 32768
buffer_load_dwordx4 v7, s[28:31], s43 offen lds
s_add_u32 m0, s39, 68608
s_add_u32 s43, s42, 49152
buffer_load_dwordx4 v7, s[28:31], s43 offen lds
s_add_u32 m0, s39, 69632
s_add_u32 s43, s42, 65536
buffer_load_dwordx4 v7, s[28:31], s43 offen lds
s_add_u32 m0, s39, 70656
s_add_u32 s43, s42, 81920
buffer_load_dwordx4 v7, s[28:31], s43 offen lds
s_add_u32 m0, s39, 71680
s_add_u32 s43, s42, 98304
buffer_load_dwordx4 v7, s[28:31], s43 offen lds
s_add_u32 m0, s39, 72704
s_add_u32 s43, s42, 114688
buffer_load_dwordx4 v7, s[28:31], s43 offen lds
s_bitcmp0_b32 s2, 0
s_cselect_b32 s88, s72, s74
s_cselect_b32 s89, s73, s75
s_cmp_lt_u32 s2, 192
s_cselect_b32 s90, 7340032, 0
s_mov_b32 s91, 0x20000
s_bfe_u32 s44, s2, 0x30001
s_lshl_b32 s44, s44, 2
s_and_b32 s43, s36, 3
s_add_u32 s44, s44, s43
s_lshl_b32 s44, s44, 5
v_lshrrev_b32 v18, 4, v1
v_add_u32 v18, s44, v18
v_mul_u32_u24 v18, 7168, v18
v_and_b32 v19, 15, v1
v_lshl_add_u32 v18, v19, 4, v18
s_lshr_b32 s43, s2, 4
s_lshl_b32 s43, s43, 8
s_add_u32 s43, s43, 4096
v_add_u32 v18, s43, v18
s_mov_b32 s43, 0
buffer_load_dwordx4 v[128:131], v18, s[88:91], s43 offen
s_mov_b32 s43, 28672
buffer_load_dwordx4 v[132:135], v18, s[88:91], s43 offen
s_mov_b32 s43, 57344
buffer_load_dwordx4 v[136:139], v18, s[88:91], s43 offen
s_mov_b32 s43, 86016
buffer_load_dwordx4 v[140:143], v18, s[88:91], s43 offen
s_mov_b32 s43, 114688
buffer_load_dwordx4 v[144:147], v18, s[88:91], s43 offen
s_mov_b32 s43, 143360
buffer_load_dwordx4 v[148:151], v18, s[88:91], s43 offen
s_mov_b32 s43, 172032
buffer_load_dwordx4 v[152:155], v18, s[88:91], s43 offen
s_mov_b32 s43, 200704
buffer_load_dwordx4 v[156:159], v18, s[88:91], s43 offen
s_barrier
s_branch Lats_6
Lcons_7:
s_getpc_b64 s[100:101]
s_and_b32 s100, s100, 0xfffff000
s_sub_u32 s100, s100, 1056768
s_subb_u32 s101, s101, 0
s_lshr_b32 s6, s2, 3
s_mul_i32 s6, s6, 4
s_and_b32 s7, s36, 3
s_add_u32 s6, s6, s7
s_mulk_i32 s6, 192
s_add_u32 s6, s6, 1049408
s_load_dword s3, s[100:101], s6 offset:0
s_load_dword s3, s[100:101], s6 offset:64
s_load_dword s3, s[100:101], s6 offset:128
s_lshl_b32 s43, s35, 7
s_waitcnt lgkmcnt(0)
s_mov_b32 s8, s64
s_mov_b32 s9, s65
s_mov_b32 s10, 4194304
s_mov_b32 s11, 0x20000
s_add_u32 s12, s66, s43
s_addc_u32 s13, s67, 0
s_mov_b32 s14, 6289536
s_mov_b32 s15, 0x20000
s_lshr_b32 s43, s2, 3
s_lshl_b32 s43, s43, 2
s_add_u32 s43, s43, s36
s_sub_u32 s44, s43, 0
s_and_b32 s44, s44, 127
s_cmp_lt_u32 s44, 24
s_cbranch_scc0 Lt_23
s_lshl_b32 s44, s44, 20
s_min_u32 s44, s44, 24117184
s_load_dword s3, s[82:83], s44 glc
Lt_23:
s_sub_u32 s44, s43, 24
s_and_b32 s44, s44, 127
s_cmp_lt_u32 s44, 8
s_cbranch_scc0 Lt_24
s_lshl_b32 s44, s44, 20
s_min_u32 s44, s44, 7339968
s_load_dword s3, s[72:73], s44
Lt_24:
s_sub_u32 s44, s43, 32
s_and_b32 s44, s44, 127
s_cmp_lt_u32 s44, 8
s_cbranch_scc0 Lt_25
s_lshl_b32 s44, s44, 20
s_min_u32 s44, s44, 7339968
s_load_dword s3, s[74:75], s44
Lt_25:
s_sub_u32 s44, s43, 40
s_and_b32 s44, s44, 127
s_cmp_lt_u32 s44, 3
s_cbranch_scc0 Lt_26
s_lshl_b32 s44, s44, 20
s_min_u32 s44, s44, 2097088
s_load_dword s3, s[68:69], s44
Lt_26:
s_sub_u32 s44, s43, 43
s_and_b32 s44, s44, 127
s_cmp_lt_u32 s44, 5
s_cbranch_scc0 Lt_27
s_lshl_b32 s44, s44, 20
s_min_u32 s44, s44, 4194240
s_add_u32 s44, s44, 25165824
s_load_dword s3, s[82:83], s44 glc
Lt_27:
s_sub_u32 s44, s43, 48
s_and_b32 s44, s44, 127
s_cmp_lt_u32 s44, 8
s_cbranch_scc0 Lt_28
s_lshl_b32 s44, s44, 20
s_min_u32 s44, s44, 7339968
s_load_dword s3, s[76:77], s44
Lt_28:
s_sub_u32 s44, s43, 56
s_and_b32 s44, s44, 127
s_cmp_lt_u32 s44, 5
s_cbranch_scc0 Lt_29
s_lshl_b32 s44, s44, 20
s_min_u32 s44, s44, 4194240
s_add_u32 s44, s44, 33554432
s_load_dword s3, s[82:83], s44 glc
Lt_29:
s_sub_u32 s44, s43, 61
s_and_b32 s44, s44, 127
s_cmp_lt_u32 s44, 5
s_cbranch_scc0 Lt_30
s_lshl_b32 s44, s44, 20
s_min_u32 s44, s44, 4194240
s_load_dword s3, s[78:79], s44 glc
Lt_30:
v_lshrrev_b32 v16, 1, v12
v_xor_b32 v15, v13, v16
v_lshlrev_b32 v15, 4, v15
v_lshl_add_u32 v2, v12, 7, v15
v_xor_b32 v3, 64, v2
v_add_u32 v4, 86016, v2
v_add_u32 v5, 86016, v3
v_lshrrev_b32 v15, 2, v12
v_and_b32 v16, 3, v1
v_lshl_add_u32 v19, v13, 3, v15
v_lshlrev_b32 v19, 7, v19
v_and_b32 v15, 2, v15
v_and_b32 v17, 1, v13
v_lshl_add_u32 v15, v17, 2, v15
v_lshrrev_b32 v17, 1, v16
s_lshl_b32 s43, s36, 1
v_add_u32 v17, s43, v17
v_xor_b32 v15, v15, v17
v_lshl_add_u32 v19, v15, 4, v19
v_and_b32 v16, 1, v16
v_lshl_add_u32 v19, v16, 3, v19
v_add_u32 v6, 18432, v19
v_add_u32 v7, 61440, v19
v_add_u32 v8, 104448, v19
s_and_b32 s43, s36, 1
s_bfe_u32 s44, s36, 0x10001
s_lshr_b32 s45, s36, 2
v_lshlrev_b32 v14, 2, v13
v_sub_u32 v14, v12, v14
v_mov_b32 v16, 0xff800000
s_or_b32 s46, s34, s45
s_cmp_lg_u32 s46, 0
s_cselect_b32 s46, 0, 0xff800000
v_subrev_u32 v15, 0, v14
v_cmp_ge_u32 vcc, 7, v15
v_add_u32 v15, 16, v15
s_nop 0
v_cndmask_b32 v248, v16, 0, vcc
v_cmp_ge_u32 vcc, 7, v15
s_nop 1
v_cndmask_b32 v244, v16, 0, vcc
v_or_b32 v240, s46, v244
v_subrev_u32 v15, 1, v14
v_cmp_ge_u32 vcc, 7, v15
v_add_u32 v15, 16, v15
s_nop 0
v_cndmask_b32 v249, v16, 0, vcc
v_cmp_ge_u32 vcc, 7, v15
s_nop 1
v_cndmask_b32 v245, v16, 0, vcc
v_or_b32 v241, s46, v245
v_subrev_u32 v15, 2, v14
v_cmp_ge_u32 vcc, 7, v15
v_add_u32 v15, 16, v15
s_nop 0
v_cndmask_b32 v250, v16, 0, vcc
v_cmp_ge_u32 vcc, 7, v15
s_nop 1
v_cndmask_b32 v246, v16, 0, vcc
v_or_b32 v242, s46, v246
v_subrev_u32 v15, 3, v14
v_cmp_ge_u32 vcc, 7, v15
v_add_u32 v15, 16, v15
s_nop 0
v_cndmask_b32 v251, v16, 0, vcc
v_cmp_ge_u32 vcc, 7, v15
s_nop 1
v_cndmask_b32 v247, v16, 0, vcc
v_or_b32 v243, s46, v247
s_lshl_b32 s46, s45, 6
s_add_u32 s46, s46, s44
s_add_u32 s46, s46, 16
v_lshl_add_u32 v14, v12, 1, s46
s_lshl_b32 s47, s43, 6
v_lshl_add_u32 v15, v13, 4, s47
v_mul_u32_u24 v20, 400, v14
v_add_u32 v20, v20, v15
v_subrev_u32 v16, 32, v14
v_max_i32 v16, 0, v16
v_mul_u32_u24 v21, 400, v16
v_add_u32 v21, v21, v15
v_lshrrev_b32 v16, 2, v12
v_lshl_add_u32 v16, v13, 2, v16
v_lshl_add_u32 v16, v16, 1, s46
v_and_b32 v17, 3, v1
v_lshl_add_u32 v17, v17, 3, s47
v_mul_u32_u24 v22, 400, v16
v_add_u32 v22, v22, v17
v_subrev_u32 v16, 32, v16
v_max_i32 v16, 0, v16
v_mul_u32_u24 v23, 400, v16
v_add_u32 v23, v23, v17
s_mul_i32 s60, s34, 262144
s_add_u32 s16, s82, s60
s_addc_u32 s17, s83, 0
s_mov_b32 s18, 262144
s_mov_b32 s19, 0x20000
s_lshl_b32 s60, s35, 14
s_lshl_b32 s43, s43, 13
s_add_u32 s60, s60, s43
s_lshl_b32 s43, s45, 12
s_add_u32 s60, s60, s43
s_lshl_b32 s43, s44, 10
s_add_u32 s60, s60, s43
v_lshlrev_b32 v24, 4, v1
s_mov_b32 s61, 0x3e8293ee
s_lshl_b32 s38, s35, 7
s_add_u32 s56, s82, 28311552
s_addc_u32 s57, s83, 0
s_mov_b32 s58, 114688
s_mov_b32 s59, 0x20000
s_barrier
ds_read_b128 v[32:35], v2 offset:0
ds_read_b64_tr_b16 v[72:73], v6 offset:8192
ds_read_b64_tr_b16 v[74:75], v6 offset:8704
ds_read_b64_tr_b16 v[76:77], v6 offset:16384
ds_read_b64_tr_b16 v[78:79], v6 offset:16896
ds_read_b64_tr_b16 v[68:69], v6 offset:0
ds_read_b64_tr_b16 v[70:71], v6 offset:512
ds_read_b128 v[36:39], v2 offset:2048
ds_read_b128 v[40:43], v2 offset:4096
ds_read_b128 v[44:47], v2 offset:6144
ds_read_b128 v[48:51], v2 offset:8192
ds_read_b128 v[52:55], v2 offset:10240
ds_read_b128 v[56:59], v2 offset:12288
ds_read_b128 v[60:63], v2 offset:14336
ds_read_b128 v[64:67], v2 offset:16384
s_waitcnt lgkmcnt(0)
v_mfma_f32_16x16x32_bf16 v[128:131], v[68:71], v[32:35], 0
ds_read_b128 v[80:83], v3 offset:0
v_mfma_f32_16x16x32_bf16 v[132:135], v[68:71], v[36:39], 0
ds_read_b64_tr_b16 v[120:121], v6 offset:12288
v_mfma_f32_16x16x32_bf16 v[136:139], v[68:71], v[40:43], 0
ds_read_b64_tr_b16 v[122:123], v6 offset:12800
v_mfma_f32_16x16x32_bf16 v[140:143], v[68:71], v[44:47], 0
ds_read_b64_tr_b16 v[124:125], v6 offset:20480
v_mfma_f32_16x16x32_bf16 v[144:147], v[68:71], v[48:51], 0
ds_read_b64_tr_b16 v[126:127], v6 offset:20992
v_mfma_f32_16x16x32_bf16 v[148:151], v[68:71], v[52:55], 0
ds_read_b64_tr_b16 v[116:117], v6 offset:4096
v_mfma_f32_16x16x32_bf16 v[152:155], v[68:71], v[56:59], 0
ds_read_b64_tr_b16 v[118:119], v6 offset:4608
v_mfma_f32_16x16x32_bf16 v[156:159], v[68:71], v[60:63], 0
ds_read_b128 v[84:87], v3 offset:2048
v_mfma_f32_16x16x32_bf16 v[160:163], v[68:71], v[64:67], 0
ds_read_b128 v[88:91], v3 offset:4096
v_mfma_f32_16x16x32_bf16 v[196:199], v[72:75], v[64:67], 0
ds_read_b128 v[92:95], v3 offset:6144
v_mfma_f32_16x16x32_bf16 v[192:195], v[72:75], v[60:63], 0
ds_read_b128 v[96:99], v3 offset:8192
v_mfma_f32_16x16x32_bf16 v[188:191], v[72:75], v[56:59], 0
ds_read_b128 v[100:103], v3 offset:10240
v_mfma_f32_16x16x32_bf16 v[184:187], v[72:75], v[52:55], 0
ds_read_b128 v[104:107], v3 offset:12288
v_mfma_f32_16x16x32_bf16 v[180:183], v[72:75], v[48:51], 0
ds_read_b128 v[108:111], v3 offset:14336
v_mfma_f32_16x16x32_bf16 v[176:179], v[72:75], v[44:47], 0
ds_read_b128 v[112:115], v3 offset:16384
v_mfma_f32_16x16x32_bf16 v[172:175], v[72:75], v[40:43], 0
v_mfma_f32_16x16x32_bf16 v[168:171], v[72:75], v[36:39], 0
v_mfma_f32_16x16x32_bf16 v[164:167], v[72:75], v[32:35], 0
v_mfma_f32_16x16x32_bf16 v[200:203], v[76:79], v[32:35], 0
v_mfma_f32_16x16x32_bf16 v[204:207], v[76:79], v[36:39], 0
v_mfma_f32_16x16x32_bf16 v[208:211], v[76:79], v[40:43], 0
v_mfma_f32_16x16x32_bf16 v[212:215], v[76:79], v[44:47], 0
v_mfma_f32_16x16x32_bf16 v[216:219], v[76:79], v[48:51], 0
v_mfma_f32_16x16x32_bf16 v[220:223], v[76:79], v[52:55], 0
v_mfma_f32_16x16x32_bf16 v[224:227], v[76:79], v[56:59], 0
v_mfma_f32_16x16x32_bf16 v[228:231], v[76:79], v[60:63], 0
v_mfma_f32_16x16x32_bf16 v[232:235], v[76:79], v[64:67], 0
s_waitcnt lgkmcnt(0)
s_barrier
v_mfma_f32_16x16x32_bf16 v[128:131], v[116:119], v[80:83], v[128:131]
ds_read_b128 v[32:35], v2 offset:43008
v_mfma_f32_16x16x32_bf16 v[132:135], v[116:119], v[84:87], v[132:135]
ds_read_b64_tr_b16 v[72:73], v7 offset:8192
v_mfma_f32_16x16x32_bf16 v[136:139], v[116:119], v[88:91], v[136:139]
ds_read_b64_tr_b16 v[74:75], v7 offset:8704
v_mfma_f32_16x16x32_bf16 v[140:143], v[116:119], v[92:95], v[140:143]
ds_read_b64_tr_b16 v[76:77], v7 offset:16384
v_mfma_f32_16x16x32_bf16 v[144:147], v[116:119], v[96:99], v[144:147]
ds_read_b64_tr_b16 v[78:79], v7 offset:16896
v_mfma_f32_16x16x32_bf16 v[148:151], v[116:119], v[100:103], v[148:151]
ds_read_b64_tr_b16 v[68:69], v7 offset:0
v_mfma_f32_16x16x32_bf16 v[152:155], v[116:119], v[104:107], v[152:155]
ds_read_b64_tr_b16 v[70:71], v7 offset:512
v_mfma_f32_16x16x32_bf16 v[156:159], v[116:119], v[108:111], v[156:159]
ds_read_b128 v[36:39], v2 offset:45056
v_mfma_f32_16x16x32_bf16 v[160:163], v[116:119], v[112:115], v[160:163]
ds_read_b128 v[40:43], v2 offset:47104
v_mfma_f32_16x16x32_bf16 v[196:199], v[120:123], v[112:115], v[196:199]
ds_read_b128 v[44:47], v2 offset:49152
v_mfma_f32_16x16x32_bf16 v[192:195], v[120:123], v[108:111], v[192:195]
ds_read_b128 v[48:51], v2 offset:51200
v_mfma_f32_16x16x32_bf16 v[188:191], v[120:123], v[104:107], v[188:191]
ds_read_b128 v[52:55], v2 offset:53248
v_mfma_f32_16x16x32_bf16 v[184:187], v[120:123], v[100:103], v[184:187]
ds_read_b128 v[56:59], v2 offset:55296
v_mfma_f32_16x16x32_bf16 v[180:183], v[120:123], v[96:99], v[180:183]
ds_read_b128 v[60:63], v2 offset:57344
v_mfma_f32_16x16x32_bf16 v[176:179], v[120:123], v[92:95], v[176:179]
ds_read_b128 v[64:67], v2 offset:59392
v_mfma_f32_16x16x32_bf16 v[172:175], v[120:123], v[88:91], v[172:175]
v_mfma_f32_16x16x32_bf16 v[168:171], v[120:123], v[84:87], v[168:171]
v_mfma_f32_16x16x32_bf16 v[164:167], v[120:123], v[80:83], v[164:167]
v_mfma_f32_16x16x32_bf16 v[200:203], v[124:127], v[80:83], v[200:203]
v_mfma_f32_16x16x32_bf16 v[204:207], v[124:127], v[84:87], v[204:207]
v_mfma_f32_16x16x32_bf16 v[208:211], v[124:127], v[88:91], v[208:211]
v_mfma_f32_16x16x32_bf16 v[212:215], v[124:127], v[92:95], v[212:215]
v_mfma_f32_16x16x32_bf16 v[216:219], v[124:127], v[96:99], v[216:219]
v_mfma_f32_16x16x32_bf16 v[220:223], v[124:127], v[100:103], v[220:223]
v_mfma_f32_16x16x32_bf16 v[224:227], v[124:127], v[104:107], v[224:227]
v_mfma_f32_16x16x32_bf16 v[228:231], v[124:127], v[108:111], v[228:231]
v_mfma_f32_16x16x32_bf16 v[232:235], v[124:127], v[112:115], v[232:235]
s_waitcnt lgkmcnt(0)
v_mfma_f32_16x16x32_bf16 v[128:131], v[68:71], v[32:35], v[128:131]
ds_read_b128 v[80:83], v3 offset:43008
v_mfma_f32_16x16x32_bf16 v[132:135], v[68:71], v[36:39], v[132:135]
ds_read_b64_tr_b16 v[120:121], v7 offset:12288
v_mfma_f32_16x16x32_bf16 v[136:139], v[68:71], v[40:43], v[136:139]
ds_read_b64_tr_b16 v[122:123], v7 offset:12800
v_mfma_f32_16x16x32_bf16 v[140:143], v[68:71], v[44:47], v[140:143]
ds_read_b64_tr_b16 v[124:125], v7 offset:20480
v_mfma_f32_16x16x32_bf16 v[144:147], v[68:71], v[48:51], v[144:147]
ds_read_b64_tr_b16 v[126:127], v7 offset:20992
v_mfma_f32_16x16x32_bf16 v[148:151], v[68:71], v[52:55], v[148:151]
ds_read_b64_tr_b16 v[116:117], v7 offset:4096
v_mfma_f32_16x16x32_bf16 v[152:155], v[68:71], v[56:59], v[152:155]
ds_read_b64_tr_b16 v[118:119], v7 offset:4608
v_mfma_f32_16x16x32_bf16 v[156:159], v[68:71], v[60:63], v[156:159]
ds_read_b128 v[84:87], v3 offset:45056
v_mfma_f32_16x16x32_bf16 v[160:163], v[68:71], v[64:67], v[160:163]
ds_read_b128 v[88:91], v3 offset:47104
v_mfma_f32_16x16x32_bf16 v[196:199], v[72:75], v[64:67], v[196:199]
ds_read_b128 v[92:95], v3 offset:49152
v_mfma_f32_16x16x32_bf16 v[192:195], v[72:75], v[60:63], v[192:195]
ds_read_b128 v[96:99], v3 offset:51200
v_mfma_f32_16x16x32_bf16 v[188:191], v[72:75], v[56:59], v[188:191]
ds_read_b128 v[100:103], v3 offset:53248
v_mfma_f32_16x16x32_bf16 v[184:187], v[72:75], v[52:55], v[184:187]
ds_read_b128 v[104:107], v3 offset:55296
v_mfma_f32_16x16x32_bf16 v[180:183], v[72:75], v[48:51], v[180:183]
ds_read_b128 v[108:111], v3 offset:57344
v_mfma_f32_16x16x32_bf16 v[176:179], v[72:75], v[44:47], v[176:179]
ds_read_b128 v[112:115], v3 offset:59392
v_mfma_f32_16x16x32_bf16 v[172:175], v[72:75], v[40:43], v[172:175]
v_mfma_f32_16x16x32_bf16 v[168:171], v[72:75], v[36:39], v[168:171]
v_mfma_f32_16x16x32_bf16 v[164:167], v[72:75], v[32:35], v[164:167]
v_mfma_f32_16x16x32_bf16 v[200:203], v[76:79], v[32:35], v[200:203]
v_mfma_f32_16x16x32_bf16 v[204:207], v[76:79], v[36:39], v[204:207]
v_mfma_f32_16x16x32_bf16 v[208:211], v[76:79], v[40:43], v[208:211]
v_mfma_f32_16x16x32_bf16 v[212:215], v[76:79], v[44:47], v[212:215]
v_mfma_f32_16x16x32_bf16 v[216:219], v[76:79], v[48:51], v[216:219]
v_mfma_f32_16x16x32_bf16 v[220:223], v[76:79], v[52:55], v[220:223]
v_mfma_f32_16x16x32_bf16 v[224:227], v[76:79], v[56:59], v[224:227]
v_mfma_f32_16x16x32_bf16 v[228:231], v[76:79], v[60:63], v[228:231]
v_mfma_f32_16x16x32_bf16 v[232:235], v[76:79], v[64:67], v[232:235]
s_waitcnt lgkmcnt(0)
s_barrier
v_mfma_f32_16x16x32_bf16 v[128:131], v[116:119], v[80:83], v[128:131]
ds_read_b128 v[32:35], v4 offset:0
v_mfma_f32_16x16x32_bf16 v[132:135], v[116:119], v[84:87], v[132:135]
ds_read_b64_tr_b16 v[72:73], v8 offset:8192
v_mfma_f32_16x16x32_bf16 v[136:139], v[116:119], v[88:91], v[136:139]
ds_read_b64_tr_b16 v[74:75], v8 offset:8704
v_mfma_f32_16x16x32_bf16 v[140:143], v[116:119], v[92:95], v[140:143]
ds_read_b64_tr_b16 v[76:77], v8 offset:16384
v_mfma_f32_16x16x32_bf16 v[144:147], v[116:119], v[96:99], v[144:147]
ds_read_b64_tr_b16 v[78:79], v8 offset:16896
v_mfma_f32_16x16x32_bf16 v[148:151], v[116:119], v[100:103], v[148:151]
ds_read_b64_tr_b16 v[68:69], v8 offset:0
v_mfma_f32_16x16x32_bf16 v[152:155], v[116:119], v[104:107], v[152:155]
ds_read_b64_tr_b16 v[70:71], v8 offset:512
v_mfma_f32_16x16x32_bf16 v[156:159], v[116:119], v[108:111], v[156:159]
ds_read_b128 v[36:39], v4 offset:2048
v_mfma_f32_16x16x32_bf16 v[160:163], v[116:119], v[112:115], v[160:163]
ds_read_b128 v[40:43], v4 offset:4096
v_mfma_f32_16x16x32_bf16 v[196:199], v[120:123], v[112:115], v[196:199]
ds_read_b128 v[44:47], v4 offset:6144
v_mfma_f32_16x16x32_bf16 v[192:195], v[120:123], v[108:111], v[192:195]
ds_read_b128 v[48:51], v4 offset:8192
v_mfma_f32_16x16x32_bf16 v[188:191], v[120:123], v[104:107], v[188:191]
ds_read_b128 v[52:55], v4 offset:10240
v_mfma_f32_16x16x32_bf16 v[184:187], v[120:123], v[100:103], v[184:187]
ds_read_b128 v[56:59], v4 offset:12288
v_mfma_f32_16x16x32_bf16 v[180:183], v[120:123], v[96:99], v[180:183]
ds_read_b128 v[60:63], v4 offset:14336
v_mfma_f32_16x16x32_bf16 v[176:179], v[120:123], v[92:95], v[176:179]
ds_read_b128 v[64:67], v4 offset:16384
v_mfma_f32_16x16x32_bf16 v[172:175], v[120:123], v[88:91], v[172:175]
v_mfma_f32_16x16x32_bf16 v[168:171], v[120:123], v[84:87], v[168:171]
v_mfma_f32_16x16x32_bf16 v[164:167], v[120:123], v[80:83], v[164:167]
v_mfma_f32_16x16x32_bf16 v[200:203], v[124:127], v[80:83], v[200:203]
v_mfma_f32_16x16x32_bf16 v[204:207], v[124:127], v[84:87], v[204:207]
v_mfma_f32_16x16x32_bf16 v[208:211], v[124:127], v[88:91], v[208:211]
v_mfma_f32_16x16x32_bf16 v[212:215], v[124:127], v[92:95], v[212:215]
v_mfma_f32_16x16x32_bf16 v[216:219], v[124:127], v[96:99], v[216:219]
v_mfma_f32_16x16x32_bf16 v[220:223], v[124:127], v[100:103], v[220:223]
v_mfma_f32_16x16x32_bf16 v[224:227], v[124:127], v[104:107], v[224:227]
v_mfma_f32_16x16x32_bf16 v[228:231], v[124:127], v[108:111], v[228:231]
v_mfma_f32_16x16x32_bf16 v[232:235], v[124:127], v[112:115], v[232:235]
s_waitcnt lgkmcnt(0)
v_mfma_f32_16x16x32_bf16 v[128:131], v[68:71], v[32:35], v[128:131]
ds_read_b128 v[80:83], v5 offset:0
v_mfma_f32_16x16x32_bf16 v[132:135], v[68:71], v[36:39], v[132:135]
ds_read_b64_tr_b16 v[120:121], v8 offset:12288
v_mfma_f32_16x16x32_bf16 v[136:139], v[68:71], v[40:43], v[136:139]
ds_read_b64_tr_b16 v[122:123], v8 offset:12800
v_mfma_f32_16x16x32_bf16 v[140:143], v[68:71], v[44:47], v[140:143]
ds_read_b64_tr_b16 v[124:125], v8 offset:20480
v_mfma_f32_16x16x32_bf16 v[144:147], v[68:71], v[48:51], v[144:147]
ds_read_b64_tr_b16 v[126:127], v8 offset:20992
v_mfma_f32_16x16x32_bf16 v[148:151], v[68:71], v[52:55], v[148:151]
ds_read_b64_tr_b16 v[116:117], v8 offset:4096
v_mfma_f32_16x16x32_bf16 v[152:155], v[68:71], v[56:59], v[152:155]
ds_read_b64_tr_b16 v[118:119], v8 offset:4608
v_mfma_f32_16x16x32_bf16 v[156:159], v[68:71], v[60:63], v[156:159]
ds_read_b128 v[84:87], v5 offset:2048
v_mfma_f32_16x16x32_bf16 v[160:163], v[68:71], v[64:67], v[160:163]
ds_read_b128 v[88:91], v5 offset:4096
v_mfma_f32_16x16x32_bf16 v[196:199], v[72:75], v[64:67], v[196:199]
ds_read_b128 v[92:95], v5 offset:6144
v_mfma_f32_16x16x32_bf16 v[192:195], v[72:75], v[60:63], v[192:195]
ds_read_b128 v[96:99], v5 offset:8192
v_mfma_f32_16x16x32_bf16 v[188:191], v[72:75], v[56:59], v[188:191]
ds_read_b128 v[100:103], v5 offset:10240
v_mfma_f32_16x16x32_bf16 v[184:187], v[72:75], v[52:55], v[184:187]
ds_read_b128 v[104:107], v5 offset:12288
v_mfma_f32_16x16x32_bf16 v[180:183], v[72:75], v[48:51], v[180:183]
ds_read_b128 v[108:111], v5 offset:14336
v_mfma_f32_16x16x32_bf16 v[176:179], v[72:75], v[44:47], v[176:179]
ds_read_b128 v[112:115], v5 offset:16384
v_mfma_f32_16x16x32_bf16 v[172:175], v[72:75], v[40:43], v[172:175]
v_mfma_f32_16x16x32_bf16 v[168:171], v[72:75], v[36:39], v[168:171]
v_mfma_f32_16x16x32_bf16 v[164:167], v[72:75], v[32:35], v[164:167]
v_mfma_f32_16x16x32_bf16 v[200:203], v[76:79], v[32:35], v[200:203]
v_mfma_f32_16x16x32_bf16 v[204:207], v[76:79], v[36:39], v[204:207]
v_mfma_f32_16x16x32_bf16 v[208:211], v[76:79], v[40:43], v[208:211]
v_mfma_f32_16x16x32_bf16 v[212:215], v[76:79], v[44:47], v[212:215]
v_mfma_f32_16x16x32_bf16 v[216:219], v[76:79], v[48:51], v[216:219]
v_mfma_f32_16x16x32_bf16 v[220:223], v[76:79], v[52:55], v[220:223]
v_mfma_f32_16x16x32_bf16 v[224:227], v[76:79], v[56:59], v[224:227]
v_mfma_f32_16x16x32_bf16 v[228:231], v[76:79], v[60:63], v[228:231]
v_mfma_f32_16x16x32_bf16 v[232:235], v[76:79], v[64:67], v[232:235]
s_waitcnt lgkmcnt(0)
s_barrier
v_mfma_f32_16x16x32_bf16 v[128:131], v[116:119], v[80:83], v[128:131]
ds_read_b128 v[32:35], v2 offset:0
v_mfma_f32_16x16x32_bf16 v[132:135], v[116:119], v[84:87], v[132:135]
ds_read_b64_tr_b16 v[72:73], v6 offset:8192
v_mfma_f32_16x16x32_bf16 v[136:139], v[116:119], v[88:91], v[136:139]
ds_read_b64_tr_b16 v[74:75], v6 offset:8704
v_mfma_f32_16x16x32_bf16 v[140:143], v[116:119], v[92:95], v[140:143]
ds_read_b64_tr_b16 v[76:77], v6 offset:16384
v_mfma_f32_16x16x32_bf16 v[144:147], v[116:119], v[96:99], v[144:147]
ds_read_b64_tr_b16 v[78:79], v6 offset:16896
v_mfma_f32_16x16x32_bf16 v[148:151], v[116:119], v[100:103], v[148:151]
ds_read_b64_tr_b16 v[68:69], v6 offset:0
v_mfma_f32_16x16x32_bf16 v[152:155], v[116:119], v[104:107], v[152:155]
ds_read_b64_tr_b16 v[70:71], v6 offset:512
v_mfma_f32_16x16x32_bf16 v[156:159], v[116:119], v[108:111], v[156:159]
ds_read_b128 v[36:39], v2 offset:2048
v_mfma_f32_16x16x32_bf16 v[160:163], v[116:119], v[112:115], v[160:163]
ds_read_b128 v[40:43], v2 offset:4096
v_mfma_f32_16x16x32_bf16 v[196:199], v[120:123], v[112:115], v[196:199]
ds_read_b128 v[44:47], v2 offset:6144
v_mfma_f32_16x16x32_bf16 v[192:195], v[120:123], v[108:111], v[192:195]
ds_read_b128 v[48:51], v2 offset:8192
v_mfma_f32_16x16x32_bf16 v[188:191], v[120:123], v[104:107], v[188:191]
ds_read_b128 v[52:55], v2 offset:10240
v_mfma_f32_16x16x32_bf16 v[184:187], v[120:123], v[100:103], v[184:187]
ds_read_b128 v[56:59], v2 offset:12288
v_mfma_f32_16x16x32_bf16 v[180:183], v[120:123], v[96:99], v[180:183]
ds_read_b128 v[60:63], v2 offset:14336
v_mfma_f32_16x16x32_bf16 v[176:179], v[120:123], v[92:95], v[176:179]
ds_read_b128 v[64:67], v2 offset:16384
v_mfma_f32_16x16x32_bf16 v[172:175], v[120:123], v[88:91], v[172:175]
v_mfma_f32_16x16x32_bf16 v[168:171], v[120:123], v[84:87], v[168:171]
v_mfma_f32_16x16x32_bf16 v[164:167], v[120:123], v[80:83], v[164:167]
v_mfma_f32_16x16x32_bf16 v[200:203], v[124:127], v[80:83], v[200:203]
v_mfma_f32_16x16x32_bf16 v[204:207], v[124:127], v[84:87], v[204:207]
v_mfma_f32_16x16x32_bf16 v[208:211], v[124:127], v[88:91], v[208:211]
v_mfma_f32_16x16x32_bf16 v[212:215], v[124:127], v[92:95], v[212:215]
v_mfma_f32_16x16x32_bf16 v[216:219], v[124:127], v[96:99], v[216:219]
v_mfma_f32_16x16x32_bf16 v[220:223], v[124:127], v[100:103], v[220:223]
v_mfma_f32_16x16x32_bf16 v[224:227], v[124:127], v[104:107], v[224:227]
v_mfma_f32_16x16x32_bf16 v[228:231], v[124:127], v[108:111], v[228:231]
v_mfma_f32_16x16x32_bf16 v[232:235], v[124:127], v[112:115], v[232:235]
s_mov_b32 s41, 4
Lcl_31:
s_waitcnt lgkmcnt(0)
v_mfma_f32_16x16x32_bf16 v[128:131], v[68:71], v[32:35], v[128:131]
ds_read_b128 v[80:83], v3 offset:0
v_mfma_f32_16x16x32_bf16 v[132:135], v[68:71], v[36:39], v[132:135]
ds_read_b64_tr_b16 v[120:121], v6 offset:12288
v_mfma_f32_16x16x32_bf16 v[136:139], v[68:71], v[40:43], v[136:139]
ds_read_b64_tr_b16 v[122:123], v6 offset:12800
v_mfma_f32_16x16x32_bf16 v[140:143], v[68:71], v[44:47], v[140:143]
ds_read_b64_tr_b16 v[124:125], v6 offset:20480
v_mfma_f32_16x16x32_bf16 v[144:147], v[68:71], v[48:51], v[144:147]
ds_read_b64_tr_b16 v[126:127], v6 offset:20992
v_mfma_f32_16x16x32_bf16 v[148:151], v[68:71], v[52:55], v[148:151]
ds_read_b64_tr_b16 v[116:117], v6 offset:4096
v_mfma_f32_16x16x32_bf16 v[152:155], v[68:71], v[56:59], v[152:155]
ds_read_b64_tr_b16 v[118:119], v6 offset:4608
v_mfma_f32_16x16x32_bf16 v[156:159], v[68:71], v[60:63], v[156:159]
ds_read_b128 v[84:87], v3 offset:2048
v_mfma_f32_16x16x32_bf16 v[160:163], v[68:71], v[64:67], v[160:163]
ds_read_b128 v[88:91], v3 offset:4096
v_mfma_f32_16x16x32_bf16 v[196:199], v[72:75], v[64:67], v[196:199]
ds_read_b128 v[92:95], v3 offset:6144
v_mfma_f32_16x16x32_bf16 v[192:195], v[72:75], v[60:63], v[192:195]
ds_read_b128 v[96:99], v3 offset:8192
v_mfma_f32_16x16x32_bf16 v[188:191], v[72:75], v[56:59], v[188:191]
ds_read_b128 v[100:103], v3 offset:10240
v_mfma_f32_16x16x32_bf16 v[184:187], v[72:75], v[52:55], v[184:187]
ds_read_b128 v[104:107], v3 offset:12288
v_mfma_f32_16x16x32_bf16 v[180:183], v[72:75], v[48:51], v[180:183]
ds_read_b128 v[108:111], v3 offset:14336
v_mfma_f32_16x16x32_bf16 v[176:179], v[72:75], v[44:47], v[176:179]
ds_read_b128 v[112:115], v3 offset:16384
v_mfma_f32_16x16x32_bf16 v[172:175], v[72:75], v[40:43], v[172:175]
v_mfma_f32_16x16x32_bf16 v[168:171], v[72:75], v[36:39], v[168:171]
v_mfma_f32_16x16x32_bf16 v[164:167], v[72:75], v[32:35], v[164:167]
v_mfma_f32_16x16x32_bf16 v[200:203], v[76:79], v[32:35], v[200:203]
v_mfma_f32_16x16x32_bf16 v[204:207], v[76:79], v[36:39], v[204:207]
s_branch Lov_2
.p2align 12
.fill 16, 4, 0xbf800000
Lst_2_0:
s_branch Lwr_157
s_nop 0
s_nop 0
Lov_2:
v_mfma_f32_16x16x32_bf16 v[208:211], v[76:79], v[40:43], v[208:211]
v_mfma_f32_16x16x32_bf16 v[212:215], v[76:79], v[44:47], v[212:215]
v_mfma_f32_16x16x32_bf16 v[216:219], v[76:79], v[48:51], v[216:219]
v_mfma_f32_16x16x32_bf16 v[220:223], v[76:79], v[52:55], v[220:223]
v_mfma_f32_16x16x32_bf16 v[224:227], v[76:79], v[56:59], v[224:227]
v_mfma_f32_16x16x32_bf16 v[228:231], v[76:79], v[60:63], v[228:231]
v_mfma_f32_16x16x32_bf16 v[232:235], v[76:79], v[64:67], v[232:235]
s_waitcnt lgkmcnt(0)
s_barrier
v_mfma_f32_16x16x32_bf16 v[128:131], v[116:119], v[80:83], v[128:131]
ds_read_b128 v[32:35], v2 offset:43008
v_mfma_f32_16x16x32_bf16 v[132:135], v[116:119], v[84:87], v[132:135]
ds_read_b64_tr_b16 v[72:73], v7 offset:8192
v_mfma_f32_16x16x32_bf16 v[136:139], v[116:119], v[88:91], v[136:139]
ds_read_b64_tr_b16 v[74:75], v7 offset:8704
v_mfma_f32_16x16x32_bf16 v[140:143], v[116:119], v[92:95], v[140:143]
ds_read_b64_tr_b16 v[76:77], v7 offset:16384
v_mfma_f32_16x16x32_bf16 v[144:147], v[116:119], v[96:99], v[144:147]
ds_read_b64_tr_b16 v[78:79], v7 offset:16896
v_mfma_f32_16x16x32_bf16 v[148:151], v[116:119], v[100:103], v[148:151]
ds_read_b64_tr_b16 v[68:69], v7 offset:0
v_mfma_f32_16x16x32_bf16 v[152:155], v[116:119], v[104:107], v[152:155]
ds_read_b64_tr_b16 v[70:71], v7 offset:512
v_mfma_f32_16x16x32_bf16 v[156:159], v[116:119], v[108:111], v[156:159]
ds_read_b128 v[36:39], v2 offset:45056
v_mfma_f32_16x16x32_bf16 v[160:163], v[116:119], v[112:115], v[160:163]
ds_read_b128 v[40:43], v2 offset:47104
v_mfma_f32_16x16x32_bf16 v[196:199], v[120:123], v[112:115], v[196:199]
ds_read_b128 v[44:47], v2 offset:49152
v_mfma_f32_16x16x32_bf16 v[192:195], v[120:123], v[108:111], v[192:195]
ds_read_b128 v[48:51], v2 offset:51200
v_mfma_f32_16x16x32_bf16 v[188:191], v[120:123], v[104:107], v[188:191]
ds_read_b128 v[52:55], v2 offset:53248
v_mfma_f32_16x16x32_bf16 v[184:187], v[120:123], v[100:103], v[184:187]
ds_read_b128 v[56:59], v2 offset:55296
v_mfma_f32_16x16x32_bf16 v[180:183], v[120:123], v[96:99], v[180:183]
ds_read_b128 v[60:63], v2 offset:57344
v_mfma_f32_16x16x32_bf16 v[176:179], v[120:123], v[92:95], v[176:179]
ds_read_b128 v[64:67], v2 offset:59392
v_mfma_f32_16x16x32_bf16 v[172:175], v[120:123], v[88:91], v[172:175]
v_mfma_f32_16x16x32_bf16 v[168:171], v[120:123], v[84:87], v[168:171]
v_mfma_f32_16x16x32_bf16 v[164:167], v[120:123], v[80:83], v[164:167]
v_mfma_f32_16x16x32_bf16 v[200:203], v[124:127], v[80:83], v[200:203]
v_mfma_f32_16x16x32_bf16 v[204:207], v[124:127], v[84:87], v[204:207]
v_mfma_f32_16x16x32_bf16 v[208:211], v[124:127], v[88:91], v[208:211]
v_mfma_f32_16x16x32_bf16 v[212:215], v[124:127], v[92:95], v[212:215]
v_mfma_f32_16x16x32_bf16 v[216:219], v[124:127], v[96:99], v[216:219]
v_mfma_f32_16x16x32_bf16 v[220:223], v[124:127], v[100:103], v[220:223]
v_mfma_f32_16x16x32_bf16 v[224:227], v[124:127], v[104:107], v[224:227]
v_mfma_f32_16x16x32_bf16 v[228:231], v[124:127], v[108:111], v[228:231]
v_mfma_f32_16x16x32_bf16 v[232:235], v[124:127], v[112:115], v[232:235]
s_waitcnt lgkmcnt(0)
v_mfma_f32_16x16x32_bf16 v[128:131], v[68:71], v[32:35], v[128:131]
ds_read_b128 v[80:83], v3 offset:43008
v_mfma_f32_16x16x32_bf16 v[132:135], v[68:71], v[36:39], v[132:135]
ds_read_b64_tr_b16 v[120:121], v7 offset:12288
v_mfma_f32_16x16x32_bf16 v[136:139], v[68:71], v[40:43], v[136:139]
ds_read_b64_tr_b16 v[122:123], v7 offset:12800
v_mfma_f32_16x16x32_bf16 v[140:143], v[68:71], v[44:47], v[140:143]
ds_read_b64_tr_b16 v[124:125], v7 offset:20480
v_mfma_f32_16x16x32_bf16 v[144:147], v[68:71], v[48:51], v[144:147]
ds_read_b64_tr_b16 v[126:127], v7 offset:20992
v_mfma_f32_16x16x32_bf16 v[148:151], v[68:71], v[52:55], v[148:151]
ds_read_b64_tr_b16 v[116:117], v7 offset:4096
v_mfma_f32_16x16x32_bf16 v[152:155], v[68:71], v[56:59], v[152:155]
ds_read_b64_tr_b16 v[118:119], v7 offset:4608
v_mfma_f32_16x16x32_bf16 v[156:159], v[68:71], v[60:63], v[156:159]
ds_read_b128 v[84:87], v3 offset:45056
v_mfma_f32_16x16x32_bf16 v[160:163], v[68:71], v[64:67], v[160:163]
ds_read_b128 v[88:91], v3 offset:47104
v_mfma_f32_16x16x32_bf16 v[196:199], v[72:75], v[64:67], v[196:199]
ds_read_b128 v[92:95], v3 offset:49152
v_mfma_f32_16x16x32_bf16 v[192:195], v[72:75], v[60:63], v[192:195]
ds_read_b128 v[96:99], v3 offset:51200
v_mfma_f32_16x16x32_bf16 v[188:191], v[72:75], v[56:59], v[188:191]
ds_read_b128 v[100:103], v3 offset:53248
v_mfma_f32_16x16x32_bf16 v[184:187], v[72:75], v[52:55], v[184:187]
ds_read_b128 v[104:107], v3 offset:55296
v_mfma_f32_16x16x32_bf16 v[180:183], v[72:75], v[48:51], v[180:183]
ds_read_b128 v[108:111], v3 offset:57344
v_mfma_f32_16x16x32_bf16 v[176:179], v[72:75], v[44:47], v[176:179]
ds_read_b128 v[112:115], v3 offset:59392
v_mfma_f32_16x16x32_bf16 v[172:175], v[72:75], v[40:43], v[172:175]
v_mfma_f32_16x16x32_bf16 v[168:171], v[72:75], v[36:39], v[168:171]
v_mfma_f32_16x16x32_bf16 v[164:167], v[72:75], v[32:35], v[164:167]
v_mfma_f32_16x16x32_bf16 v[200:203], v[76:79], v[32:35], v[200:203]
v_mfma_f32_16x16x32_bf16 v[204:207], v[76:79], v[36:39], v[204:207]
v_mfma_f32_16x16x32_bf16 v[208:211], v[76:79], v[40:43], v[208:211]
v_mfma_f32_16x16x32_bf16 v[212:215], v[76:79], v[44:47], v[212:215]
v_mfma_f32_16x16x32_bf16 v[216:219], v[76:79], v[48:51], v[216:219]
v_mfma_f32_16x16x32_bf16 v[220:223], v[76:79], v[52:55], v[220:223]
v_mfma_f32_16x16x32_bf16 v[224:227], v[76:79], v[56:59], v[224:227]
v_mfma_f32_16x16x32_bf16 v[228:231], v[76:79], v[60:63], v[228:231]
v_mfma_f32_16x16x32_bf16 v[232:235], v[76:79], v[64:67], v[232:235]
s_waitcnt lgkmcnt(0)
s_barrier
v_mfma_f32_16x16x32_bf16 v[128:131], v[116:119], v[80:83], v[128:131]
ds_read_b128 v[32:35], v4 offset:0
v_mfma_f32_16x16x32_bf16 v[132:135], v[116:119], v[84:87], v[132:135]
ds_read_b64_tr_b16 v[72:73], v8 offset:8192
v_mfma_f32_16x16x32_bf16 v[136:139], v[116:119], v[88:91], v[136:139]
ds_read_b64_tr_b16 v[74:75], v8 offset:8704
v_mfma_f32_16x16x32_bf16 v[140:143], v[116:119], v[92:95], v[140:143]
ds_read_b64_tr_b16 v[76:77], v8 offset:16384
v_mfma_f32_16x16x32_bf16 v[144:147], v[116:119], v[96:99], v[144:147]
ds_read_b64_tr_b16 v[78:79], v8 offset:16896
v_mfma_f32_16x16x32_bf16 v[148:151], v[116:119], v[100:103], v[148:151]
ds_read_b64_tr_b16 v[68:69], v8 offset:0
v_mfma_f32_16x16x32_bf16 v[152:155], v[116:119], v[104:107], v[152:155]
ds_read_b64_tr_b16 v[70:71], v8 offset:512
v_mfma_f32_16x16x32_bf16 v[156:159], v[116:119], v[108:111], v[156:159]
ds_read_b128 v[36:39], v4 offset:2048
v_mfma_f32_16x16x32_bf16 v[160:163], v[116:119], v[112:115], v[160:163]
ds_read_b128 v[40:43], v4 offset:4096
v_mfma_f32_16x16x32_bf16 v[196:199], v[120:123], v[112:115], v[196:199]
ds_read_b128 v[44:47], v4 offset:6144
v_mfma_f32_16x16x32_bf16 v[192:195], v[120:123], v[108:111], v[192:195]
ds_read_b128 v[48:51], v4 offset:8192
v_mfma_f32_16x16x32_bf16 v[188:191], v[120:123], v[104:107], v[188:191]
ds_read_b128 v[52:55], v4 offset:10240
v_mfma_f32_16x16x32_bf16 v[184:187], v[120:123], v[100:103], v[184:187]
ds_read_b128 v[56:59], v4 offset:12288
v_mfma_f32_16x16x32_bf16 v[180:183], v[120:123], v[96:99], v[180:183]
ds_read_b128 v[60:63], v4 offset:14336
v_mfma_f32_16x16x32_bf16 v[176:179], v[120:123], v[92:95], v[176:179]
ds_read_b128 v[64:67], v4 offset:16384
v_mfma_f32_16x16x32_bf16 v[172:175], v[120:123], v[88:91], v[172:175]
v_mfma_f32_16x16x32_bf16 v[168:171], v[120:123], v[84:87], v[168:171]
v_mfma_f32_16x16x32_bf16 v[164:167], v[120:123], v[80:83], v[164:167]
v_mfma_f32_16x16x32_bf16 v[200:203], v[124:127], v[80:83], v[200:203]
v_mfma_f32_16x16x32_bf16 v[204:207], v[124:127], v[84:87], v[204:207]
v_mfma_f32_16x16x32_bf16 v[208:211], v[124:127], v[88:91], v[208:211]
v_mfma_f32_16x16x32_bf16 v[212:215], v[124:127], v[92:95], v[212:215]
v_mfma_f32_16x16x32_bf16 v[216:219], v[124:127], v[96:99], v[216:219]
v_mfma_f32_16x16x32_bf16 v[220:223], v[124:127], v[100:103], v[220:223]
v_mfma_f32_16x16x32_bf16 v[224:227], v[124:127], v[104:107], v[224:227]
v_mfma_f32_16x16x32_bf16 v[228:231], v[124:127], v[108:111], v[228:231]
v_mfma_f32_16x16x32_bf16 v[232:235], v[124:127], v[112:115], v[232:235]
s_waitcnt lgkmcnt(0)
v_mfma_f32_16x16x32_bf16 v[128:131], v[68:71], v[32:35], v[128:131]
ds_read_b128 v[80:83], v5 offset:0
v_mfma_f32_16x16x32_bf16 v[132:135], v[68:71], v[36:39], v[132:135]
ds_read_b64_tr_b16 v[120:121], v8 offset:12288
v_mfma_f32_16x16x32_bf16 v[136:139], v[68:71], v[40:43], v[136:139]
ds_read_b64_tr_b16 v[122:123], v8 offset:12800
v_mfma_f32_16x16x32_bf16 v[140:143], v[68:71], v[44:47], v[140:143]
ds_read_b64_tr_b16 v[124:125], v8 offset:20480
v_mfma_f32_16x16x32_bf16 v[144:147], v[68:71], v[48:51], v[144:147]
ds_read_b64_tr_b16 v[126:127], v8 offset:20992
v_mfma_f32_16x16x32_bf16 v[148:151], v[68:71], v[52:55], v[148:151]
ds_read_b64_tr_b16 v[116:117], v8 offset:4096
v_mfma_f32_16x16x32_bf16 v[152:155], v[68:71], v[56:59], v[152:155]
ds_read_b64_tr_b16 v[118:119], v8 offset:4608
v_mfma_f32_16x16x32_bf16 v[156:159], v[68:71], v[60:63], v[156:159]
ds_read_b128 v[84:87], v5 offset:2048
v_mfma_f32_16x16x32_bf16 v[160:163], v[68:71], v[64:67], v[160:163]
ds_read_b128 v[88:91], v5 offset:4096
v_mfma_f32_16x16x32_bf16 v[196:199], v[72:75], v[64:67], v[196:199]
ds_read_b128 v[92:95], v5 offset:6144
v_mfma_f32_16x16x32_bf16 v[192:195], v[72:75], v[60:63], v[192:195]
ds_read_b128 v[96:99], v5 offset:8192
v_mfma_f32_16x16x32_bf16 v[188:191], v[72:75], v[56:59], v[188:191]
ds_read_b128 v[100:103], v5 offset:10240
v_mfma_f32_16x16x32_bf16 v[184:187], v[72:75], v[52:55], v[184:187]
ds_read_b128 v[104:107], v5 offset:12288
v_mfma_f32_16x16x32_bf16 v[180:183], v[72:75], v[48:51], v[180:183]
ds_read_b128 v[108:111], v5 offset:14336
v_mfma_f32_16x16x32_bf16 v[176:179], v[72:75], v[44:47], v[176:179]
ds_read_b128 v[112:115], v5 offset:16384
v_mfma_f32_16x16x32_bf16 v[172:175], v[72:75], v[40:43], v[172:175]
v_mfma_f32_16x16x32_bf16 v[168:171], v[72:75], v[36:39], v[168:171]
v_mfma_f32_16x16x32_bf16 v[164:167], v[72:75], v[32:35], v[164:167]
v_mfma_f32_16x16x32_bf16 v[200:203], v[76:79], v[32:35], v[200:203]
v_mfma_f32_16x16x32_bf16 v[204:207], v[76:79], v[36:39], v[204:207]
v_mfma_f32_16x16x32_bf16 v[208:211], v[76:79], v[40:43], v[208:211]
v_mfma_f32_16x16x32_bf16 v[212:215], v[76:79], v[44:47], v[212:215]
v_mfma_f32_16x16x32_bf16 v[216:219], v[76:79], v[48:51], v[216:219]
v_mfma_f32_16x16x32_bf16 v[220:223], v[76:79], v[52:55], v[220:223]
v_mfma_f32_16x16x32_bf16 v[224:227], v[76:79], v[56:59], v[224:227]
v_mfma_f32_16x16x32_bf16 v[228:231], v[76:79], v[60:63], v[228:231]
v_mfma_f32_16x16x32_bf16 v[232:235], v[76:79], v[64:67], v[232:235]
s_waitcnt lgkmcnt(0)
s_barrier
v_mfma_f32_16x16x32_bf16 v[128:131], v[116:119], v[80:83], v[128:131]
ds_read_b128 v[32:35], v2 offset:0
v_mfma_f32_16x16x32_bf16 v[132:135], v[116:119], v[84:87], v[132:135]
ds_read_b64_tr_b16 v[72:73], v6 offset:8192
v_mfma_f32_16x16x32_bf16 v[136:139], v[116:119], v[88:91], v[136:139]
ds_read_b64_tr_b16 v[74:75], v6 offset:8704
v_mfma_f32_16x16x32_bf16 v[140:143], v[116:119], v[92:95], v[140:143]
ds_read_b64_tr_b16 v[76:77], v6 offset:16384
v_mfma_f32_16x16x32_bf16 v[144:147], v[116:119], v[96:99], v[144:147]
ds_read_b64_tr_b16 v[78:79], v6 offset:16896
v_mfma_f32_16x16x32_bf16 v[148:151], v[116:119], v[100:103], v[148:151]
ds_read_b64_tr_b16 v[68:69], v6 offset:0
v_mfma_f32_16x16x32_bf16 v[152:155], v[116:119], v[104:107], v[152:155]
ds_read_b64_tr_b16 v[70:71], v6 offset:512
v_mfma_f32_16x16x32_bf16 v[156:159], v[116:119], v[108:111], v[156:159]
ds_read_b128 v[36:39], v2 offset:2048
v_mfma_f32_16x16x32_bf16 v[160:163], v[116:119], v[112:115], v[160:163]
ds_read_b128 v[40:43], v2 offset:4096
v_mfma_f32_16x16x32_bf16 v[196:199], v[120:123], v[112:115], v[196:199]
ds_read_b128 v[44:47], v2 offset:6144
v_mfma_f32_16x16x32_bf16 v[192:195], v[120:123], v[108:111], v[192:195]
ds_read_b128 v[48:51], v2 offset:8192
v_mfma_f32_16x16x32_bf16 v[188:191], v[120:123], v[104:107], v[188:191]
ds_read_b128 v[52:55], v2 offset:10240
v_mfma_f32_16x16x32_bf16 v[184:187], v[120:123], v[100:103], v[184:187]
ds_read_b128 v[56:59], v2 offset:12288
v_mfma_f32_16x16x32_bf16 v[180:183], v[120:123], v[96:99], v[180:183]
ds_read_b128 v[60:63], v2 offset:14336
v_mfma_f32_16x16x32_bf16 v[176:179], v[120:123], v[92:95], v[176:179]
ds_read_b128 v[64:67], v2 offset:16384
v_mfma_f32_16x16x32_bf16 v[172:175], v[120:123], v[88:91], v[172:175]
v_mfma_f32_16x16x32_bf16 v[168:171], v[120:123], v[84:87], v[168:171]
v_mfma_f32_16x16x32_bf16 v[164:167], v[120:123], v[80:83], v[164:167]
v_mfma_f32_16x16x32_bf16 v[200:203], v[124:127], v[80:83], v[200:203]
v_mfma_f32_16x16x32_bf16 v[204:207], v[124:127], v[84:87], v[204:207]
v_mfma_f32_16x16x32_bf16 v[208:211], v[124:127], v[88:91], v[208:211]
v_mfma_f32_16x16x32_bf16 v[212:215], v[124:127], v[92:95], v[212:215]
v_mfma_f32_16x16x32_bf16 v[216:219], v[124:127], v[96:99], v[216:219]
v_mfma_f32_16x16x32_bf16 v[220:223], v[124:127], v[100:103], v[220:223]
v_mfma_f32_16x16x32_bf16 v[224:227], v[124:127], v[104:107], v[224:227]
v_mfma_f32_16x16x32_bf16 v[228:231], v[124:127], v[108:111], v[228:231]
v_mfma_f32_16x16x32_bf16 v[232:235], v[124:127], v[112:115], v[232:235]
s_sub_u32 s41, s41, 1
s_cmp_lg_u32 s41, 0
s_cbranch_scc1 Lcl_31
s_waitcnt lgkmcnt(0)
v_mfma_f32_16x16x32_bf16 v[128:131], v[68:71], v[32:35], v[128:131]
ds_read_b128 v[80:83], v3 offset:0
v_mfma_f32_16x16x32_bf16 v[132:135], v[68:71], v[36:39], v[132:135]
ds_read_b64_tr_b16 v[120:121], v6 offset:12288
v_mfma_f32_16x16x32_bf16 v[136:139], v[68:71], v[40:43], v[136:139]
ds_read_b64_tr_b16 v[122:123], v6 offset:12800
v_mfma_f32_16x16x32_bf16 v[140:143], v[68:71], v[44:47], v[140:143]
ds_read_b64_tr_b16 v[124:125], v6 offset:20480
v_mfma_f32_16x16x32_bf16 v[144:147], v[68:71], v[48:51], v[144:147]
ds_read_b64_tr_b16 v[126:127], v6 offset:20992
v_mfma_f32_16x16x32_bf16 v[148:151], v[68:71], v[52:55], v[148:151]
ds_read_b64_tr_b16 v[116:117], v6 offset:4096
v_mfma_f32_16x16x32_bf16 v[152:155], v[68:71], v[56:59], v[152:155]
ds_read_b64_tr_b16 v[118:119], v6 offset:4608
v_mfma_f32_16x16x32_bf16 v[156:159], v[68:71], v[60:63], v[156:159]
ds_read_b128 v[84:87], v3 offset:2048
v_mfma_f32_16x16x32_bf16 v[160:163], v[68:71], v[64:67], v[160:163]
ds_read_b128 v[88:91], v3 offset:4096
v_mfma_f32_16x16x32_bf16 v[196:199], v[72:75], v[64:67], v[196:199]
ds_read_b128 v[92:95], v3 offset:6144
v_mfma_f32_16x16x32_bf16 v[192:195], v[72:75], v[60:63], v[192:195]
ds_read_b128 v[96:99], v3 offset:8192
v_mfma_f32_16x16x32_bf16 v[188:191], v[72:75], v[56:59], v[188:191]
ds_read_b128 v[100:103], v3 offset:10240
v_mfma_f32_16x16x32_bf16 v[184:187], v[72:75], v[52:55], v[184:187]
ds_read_b128 v[104:107], v3 offset:12288
v_mfma_f32_16x16x32_bf16 v[180:183], v[72:75], v[48:51], v[180:183]
ds_read_b128 v[108:111], v3 offset:14336
v_mfma_f32_16x16x32_bf16 v[176:179], v[72:75], v[44:47], v[176:179]
ds_read_b128 v[112:115], v3 offset:16384
v_mfma_f32_16x16x32_bf16 v[172:175], v[72:75], v[40:43], v[172:175]
v_mfma_f32_16x16x32_bf16 v[168:171], v[72:75], v[36:39], v[168:171]
v_mfma_f32_16x16x32_bf16 v[164:167], v[72:75], v[32:35], v[164:167]
v_mfma_f32_16x16x32_bf16 v[200:203], v[76:79], v[32:35], v[200:203]
v_mfma_f32_16x16x32_bf16 v[204:207], v[76:79], v[36:39], v[204:207]
v_mfma_f32_16x16x32_bf16 v[208:211], v[76:79], v[40:43], v[208:211]
v_mfma_f32_16x16x32_bf16 v[212:215], v[76:79], v[44:47], v[212:215]
v_mfma_f32_16x16x32_bf16 v[216:219], v[76:79], v[48:51], v[216:219]
v_mfma_f32_16x16x32_bf16 v[220:223], v[76:79], v[52:55], v[220:223]
v_mfma_f32_16x16x32_bf16 v[224:227], v[76:79], v[56:59], v[224:227]
v_mfma_f32_16x16x32_bf16 v[228:231], v[76:79], v[60:63], v[228:231]
v_mfma_f32_16x16x32_bf16 v[232:235], v[76:79], v[64:67], v[232:235]
s_waitcnt lgkmcnt(0)
v_mfma_f32_16x16x32_bf16 v[128:131], v[116:119], v[80:83], v[128:131]
v_mfma_f32_16x16x32_bf16 v[132:135], v[116:119], v[84:87], v[132:135]
v_mfma_f32_16x16x32_bf16 v[136:139], v[116:119], v[88:91], v[136:139]
v_mfma_f32_16x16x32_bf16 v[140:143], v[116:119], v[92:95], v[140:143]
v_mfma_f32_16x16x32_bf16 v[144:147], v[116:119], v[96:99], v[144:147]
v_mfma_f32_16x16x32_bf16 v[148:151], v[116:119], v[100:103], v[148:151]
v_mfma_f32_16x16x32_bf16 v[152:155], v[116:119], v[104:107], v[152:155]
v_mfma_f32_16x16x32_bf16 v[156:159], v[116:119], v[108:111], v[156:159]
v_mfma_f32_16x16x32_bf16 v[160:163], v[116:119], v[112:115], v[160:163]
v_mfma_f32_16x16x32_bf16 v[196:199], v[120:123], v[112:115], v[196:199]
v_mfma_f32_16x16x32_bf16 v[192:195], v[120:123], v[108:111], v[192:195]
v_mfma_f32_16x16x32_bf16 v[188:191], v[120:123], v[104:107], v[188:191]
v_mfma_f32_16x16x32_bf16 v[184:187], v[120:123], v[100:103], v[184:187]
v_mfma_f32_16x16x32_bf16 v[180:183], v[120:123], v[96:99], v[180:183]
v_mfma_f32_16x16x32_bf16 v[176:179], v[120:123], v[92:95], v[176:179]
v_mfma_f32_16x16x32_bf16 v[172:175], v[120:123], v[88:91], v[172:175]
v_mfma_f32_16x16x32_bf16 v[168:171], v[120:123], v[84:87], v[168:171]
v_mfma_f32_16x16x32_bf16 v[164:167], v[120:123], v[80:83], v[164:167]
v_mfma_f32_16x16x32_bf16 v[200:203], v[124:127], v[80:83], v[200:203]
v_mfma_f32_16x16x32_bf16 v[204:207], v[124:127], v[84:87], v[204:207]
v_mfma_f32_16x16x32_bf16 v[208:211], v[124:127], v[88:91], v[208:211]
v_mfma_f32_16x16x32_bf16 v[212:215], v[124:127], v[92:95], v[212:215]
v_mfma_f32_16x16x32_bf16 v[216:219], v[124:127], v[96:99], v[216:219]
v_mfma_f32_16x16x32_bf16 v[220:223], v[124:127], v[100:103], v[220:223]
v_mfma_f32_16x16x32_bf16 v[224:227], v[124:127], v[104:107], v[224:227]
v_mfma_f32_16x16x32_bf16 v[228:231], v[124:127], v[108:111], v[228:231]
v_mfma_f32_16x16x32_bf16 v[232:235], v[124:127], v[112:115], v[232:235]
Lepi:
v_lshlrev_b32 v14, 3, v12
v_add_u32 v14, 147456, v14
v_mul_u32_u24 v15, 400, v12
v_lshl_add_u32 v15, v13, 3, v15
s_lshl_b32 s43, s36, 5
v_add_u32 v15, s43, v15
s_barrier
ds_read_b64 v[32:33], v14 offset:0
ds_read_b64 v[34:35], v14 offset:128
ds_read_b64 v[36:37], v14 offset:256
ds_read_b64 v[38:39], v14 offset:384
ds_read_b64 v[40:41], v14 offset:512
ds_read_b64 v[42:43], v14 offset:640
ds_read_b64 v[44:45], v14 offset:768
ds_read_b64 v[46:47], v14 offset:896
ds_read_b64 v[48:49], v14 offset:1024
v_mov_b32_dpp v52, v128 row_newbcast:0 row_mask:0xf bank_mask:0xf
v_mov_b32_dpp v53, v129 row_newbcast:0 row_mask:0xf bank_mask:0xf
v_mov_b32_dpp v54, v130 row_newbcast:0 row_mask:0xf bank_mask:0xf
v_mov_b32_dpp v55, v131 row_newbcast:0 row_mask:0xf bank_mask:0xf
v_mov_b32_dpp v56, v164 row_newbcast:0 row_mask:0xf bank_mask:0xf
v_mov_b32_dpp v57, v165 row_newbcast:0 row_mask:0xf bank_mask:0xf
v_mov_b32_dpp v58, v166 row_newbcast:0 row_mask:0xf bank_mask:0xf
v_mov_b32_dpp v59, v167 row_newbcast:0 row_mask:0xf bank_mask:0xf
v_mov_b32_dpp v60, v200 row_newbcast:0 row_mask:0xf bank_mask:0xf
v_mov_b32_dpp v61, v201 row_newbcast:0 row_mask:0xf bank_mask:0xf
v_mov_b32_dpp v62, v202 row_newbcast:0 row_mask:0xf bank_mask:0xf
v_mov_b32_dpp v63, v203 row_newbcast:0 row_mask:0xf bank_mask:0xf
s_waitcnt lgkmcnt(0)
v_pk_fma_f32 v[164:165], v[32:33], v[56:57], v[164:165] op_sel_hi:[0,1,1] neg_lo:[1,0,0] neg_hi:[1,0,0]
v_pk_fma_f32 v[166:167], v[32:33], v[58:59], v[166:167] op_sel_hi:[0,1,1] neg_lo:[1,0,0] neg_hi:[1,0,0]
v_pk_fma_f32 v[200:201], v[32:33], v[60:61], v[200:201] op_sel_hi:[0,1,1] neg_lo:[1,0,0] neg_hi:[1,0,0]
v_pk_fma_f32 v[202:203], v[32:33], v[62:63], v[202:203] op_sel_hi:[0,1,1] neg_lo:[1,0,0] neg_hi:[1,0,0]
v_pk_mul_f32 v[164:165], v[32:33], v[164:165] op_sel:[1,0] op_sel_hi:[1,1]
v_pk_mul_f32 v[166:167], v[32:33], v[166:167] op_sel:[1,0] op_sel_hi:[1,1]
v_pk_fma_f32 v[132:133], v[34:35], v[52:53], v[132:133] op_sel_hi:[0,1,1] neg_lo:[1,0,0] neg_hi:[1,0,0]
v_pk_fma_f32 v[134:135], v[34:35], v[54:55], v[134:135] op_sel_hi:[0,1,1] neg_lo:[1,0,0] neg_hi:[1,0,0]
v_pk_mul_f32 v[200:201], v[32:33], v[200:201] op_sel:[1,0] op_sel_hi:[1,1]
v_pk_mul_f32 v[202:203], v[32:33], v[202:203] op_sel:[1,0] op_sel_hi:[1,1]
v_cvt_pk_bf16_f32 v164, v164, v165
v_cvt_pk_bf16_f32 v165, v166, v167
ds_write_b64 v15, v[164:165] offset:128
v_pk_fma_f32 v[168:169], v[34:35], v[56:57], v[168:169] op_sel_hi:[0,1,1] neg_lo:[1,0,0] neg_hi:[1,0,0]
v_pk_fma_f32 v[170:171], v[34:35], v[58:59], v[170:171] op_sel_hi:[0,1,1] neg_lo:[1,0,0] neg_hi:[1,0,0]
v_pk_mul_f32 v[132:133], v[34:35], v[132:133] op_sel:[1,0] op_sel_hi:[1,1]
v_pk_mul_f32 v[134:135], v[34:35], v[134:135] op_sel:[1,0] op_sel_hi:[1,1]
v_cvt_pk_bf16_f32 v200, v200, v201
v_cvt_pk_bf16_f32 v201, v202, v203
ds_write_b64 v15, v[200:201] offset:256
v_pk_fma_f32 v[204:205], v[34:35], v[60:61], v[204:205] op_sel_hi:[0,1,1] neg_lo:[1,0,0] neg_hi:[1,0,0]
v_pk_fma_f32 v[206:207], v[34:35], v[62:63], v[206:207] op_sel_hi:[0,1,1] neg_lo:[1,0,0] neg_hi:[1,0,0]
v_pk_mul_f32 v[168:169], v[34:35], v[168:169] op_sel:[1,0] op_sel_hi:[1,1]
v_pk_mul_f32 v[170:171], v[34:35], v[170:171] op_sel:[1,0] op_sel_hi:[1,1]
v_cvt_pk_bf16_f32 v132, v132, v133
v_cvt_pk_bf16_f32 v133, v134, v135
ds_write_b64 v15, v[132:133] offset:6400
v_pk_fma_f32 v[136:137], v[36:37], v[52:53], v[136:137] op_sel_hi:[0,1,1] neg_lo:[1,0,0] neg_hi:[1,0,0]
v_pk_fma_f32 v[138:139], v[36:37], v[54:55], v[138:139] op_sel_hi:[0,1,1] neg_lo:[1,0,0] neg_hi:[1,0,0]
v_pk_mul_f32 v[204:205], v[34:35], v[204:205] op_sel:[1,0] op_sel_hi:[1,1]
v_pk_mul_f32 v[206:207], v[34:35], v[206:207] op_sel:[1,0] op_sel_hi:[1,1]
v_cvt_pk_bf16_f32 v168, v168, v169
v_cvt_pk_bf16_f32 v169, v170, v171
ds_write_b64 v15, v[168:169] offset:6528
v_pk_fma_f32 v[172:173], v[36:37], v[56:57], v[172:173] op_sel_hi:[0,1,1] neg_lo:[1,0,0] neg_hi:[1,0,0]
v_pk_fma_f32 v[174:175], v[36:37], v[58:59], v[174:175] op_sel_hi:[0,1,1] neg_lo:[1,0,0] neg_hi:[1,0,0]
v_pk_mul_f32 v[136:137], v[36:37], v[136:137] op_sel:[1,0] op_sel_hi:[1,1]
v_pk_mul_f32 v[138:139], v[36:37], v[138:139] op_sel:[1,0] op_sel_hi:[1,1]
v_cvt_pk_bf16_f32 v204, v204, v205
v_cvt_pk_bf16_f32 v205, v206, v207
ds_write_b64 v15, v[204:205] offset:6656
v_pk_fma_f32 v[208:209], v[36:37], v[60:61], v[208:209] op_sel_hi:[0,1,1] neg_lo:[1,0,0] neg_hi:[1,0,0]
v_pk_fma_f32 v[210:211], v[36:37], v[62:63], v[210:211] op_sel_hi:[0,1,1] neg_lo:[1,0,0] neg_hi:[1,0,0]
v_pk_mul_f32 v[172:173], v[36:37], v[172:173] op_sel:[1,0] op_sel_hi:[1,1]
v_pk_mul_f32 v[174:175], v[36:37], v[174:175] op_sel:[1,0] op_sel_hi:[1,1]
v_cvt_pk_bf16_f32 v136, v136, v137
v_cvt_pk_bf16_f32 v137, v138, v139
ds_write_b64 v15, v[136:137] offset:12800
v_pk_fma_f32 v[140:141], v[38:39], v[52:53], v[140:141] op_sel_hi:[0,1,1] neg_lo:[1,0,0] neg_hi:[1,0,0]
v_pk_fma_f32 v[142:143], v[38:39], v[54:55], v[142:143] op_sel_hi:[0,1,1] neg_lo:[1,0,0] neg_hi:[1,0,0]
v_pk_mul_f32 v[208:209], v[36:37], v[208:209] op_sel:[1,0] op_sel_hi:[1,1]
v_pk_mul_f32 v[210:211], v[36:37], v[210:211] op_sel:[1,0] op_sel_hi:[1,1]
v_cvt_pk_bf16_f32 v172, v172, v173
v_cvt_pk_bf16_f32 v173, v174, v175
ds_write_b64 v15, v[172:173] offset:12928
v_pk_fma_f32 v[176:177], v[38:39], v[56:57], v[176:177] op_sel_hi:[0,1,1] neg_lo:[1,0,0] neg_hi:[1,0,0]
v_pk_fma_f32 v[178:179], v[38:39], v[58:59], v[178:179] op_sel_hi:[0,1,1] neg_lo:[1,0,0] neg_hi:[1,0,0]
v_pk_mul_f32 v[140:141], v[38:39], v[140:141] op_sel:[1,0] op_sel_hi:[1,1]
v_pk_mul_f32 v[142:143], v[38:39], v[142:143] op_sel:[1,0] op_sel_hi:[1,1]
v_cvt_pk_bf16_f32 v208, v208, v209
v_cvt_pk_bf16_f32 v209, v210, v211
ds_write_b64 v15, v[208:209] offset:13056
v_pk_fma_f32 v[212:213], v[38:39], v[60:61], v[212:213] op_sel_hi:[0,1,1] neg_lo:[1,0,0] neg_hi:[1,0,0]
v_pk_fma_f32 v[214:215], v[38:39], v[62:63], v[214:215] op_sel_hi:[0,1,1] neg_lo:[1,0,0] neg_hi:[1,0,0]
v_pk_mul_f32 v[176:177], v[38:39], v[176:177] op_sel:[1,0] op_sel_hi:[1,1]
v_pk_mul_f32 v[178:179], v[38:39], v[178:179] op_sel:[1,0] op_sel_hi:[1,1]
v_cvt_pk_bf16_f32 v140, v140, v141
v_cvt_pk_bf16_f32 v141, v142, v143
ds_write_b64 v15, v[140:141] offset:19200
v_pk_fma_f32 v[144:145], v[40:41], v[52:53], v[144:145] op_sel_hi:[0,1,1] neg_lo:[1,0,0] neg_hi:[1,0,0]
v_pk_fma_f32 v[146:147], v[40:41], v[54:55], v[146:147] op_sel_hi:[0,1,1] neg_lo:[1,0,0] neg_hi:[1,0,0]
v_pk_mul_f32 v[212:213], v[38:39], v[212:213] op_sel:[1,0] op_sel_hi:[1,1]
v_pk_mul_f32 v[214:215], v[38:39], v[214:215] op_sel:[1,0] op_sel_hi:[1,1]
v_cvt_pk_bf16_f32 v176, v176, v177
v_cvt_pk_bf16_f32 v177, v178, v179
ds_write_b64 v15, v[176:177] offset:19328
v_pk_fma_f32 v[180:181], v[40:41], v[56:57], v[180:181] op_sel_hi:[0,1,1] neg_lo:[1,0,0] neg_hi:[1,0,0]
v_pk_fma_f32 v[182:183], v[40:41], v[58:59], v[182:183] op_sel_hi:[0,1,1] neg_lo:[1,0,0] neg_hi:[1,0,0]
v_pk_mul_f32 v[144:145], v[40:41], v[144:145] op_sel:[1,0] op_sel_hi:[1,1]
v_pk_mul_f32 v[146:147], v[40:41], v[146:147] op_sel:[1,0] op_sel_hi:[1,1]
v_cvt_pk_bf16_f32 v212, v212, v213
v_cvt_pk_bf16_f32 v213, v214, v215
ds_write_b64 v15, v[212:213] offset:19456
v_pk_fma_f32 v[216:217], v[40:41], v[60:61], v[216:217] op_sel_hi:[0,1,1] neg_lo:[1,0,0] neg_hi:[1,0,0]
v_pk_fma_f32 v[218:219], v[40:41], v[62:63], v[218:219] op_sel_hi:[0,1,1] neg_lo:[1,0,0] neg_hi:[1,0,0]
v_pk_mul_f32 v[180:181], v[40:41], v[180:181] op_sel:[1,0] op_sel_hi:[1,1]
v_pk_mul_f32 v[182:183], v[40:41], v[182:183] op_sel:[1,0] op_sel_hi:[1,1]
v_cvt_pk_bf16_f32 v144, v144, v145
v_cvt_pk_bf16_f32 v145, v146, v147
ds_write_b64 v15, v[144:145] offset:25600
v_pk_fma_f32 v[148:149], v[42:43], v[52:53], v[148:149] op_sel_hi:[0,1,1] neg_lo:[1,0,0] neg_hi:[1,0,0]
v_pk_fma_f32 v[150:151], v[42:43], v[54:55], v[150:151] op_sel_hi:[0,1,1] neg_lo:[1,0,0] neg_hi:[1,0,0]
v_pk_mul_f32 v[216:217], v[40:41], v[216:217] op_sel:[1,0] op_sel_hi:[1,1]
v_pk_mul_f32 v[218:219], v[40:41], v[218:219] op_sel:[1,0] op_sel_hi:[1,1]
v_cvt_pk_bf16_f32 v180, v180, v181
v_cvt_pk_bf16_f32 v181, v182, v183
ds_write_b64 v15, v[180:181] offset:25728
v_pk_fma_f32 v[184:185], v[42:43], v[56:57], v[184:185] op_sel_hi:[0,1,1] neg_lo:[1,0,0] neg_hi:[1,0,0]
v_pk_fma_f32 v[186:187], v[42:43], v[58:59], v[186:187] op_sel_hi:[0,1,1] neg_lo:[1,0,0] neg_hi:[1,0,0]
v_pk_mul_f32 v[148:149], v[42:43], v[148:149] op_sel:[1,0] op_sel_hi:[1,1]
v_pk_mul_f32 v[150:151], v[42:43], v[150:151] op_sel:[1,0] op_sel_hi:[1,1]
v_cvt_pk_bf16_f32 v216, v216, v217
v_cvt_pk_bf16_f32 v217, v218, v219
ds_write_b64 v15, v[216:217] offset:25856
v_pk_fma_f32 v[220:221], v[42:43], v[60:61], v[220:221] op_sel_hi:[0,1,1] neg_lo:[1,0,0] neg_hi:[1,0,0]
v_pk_fma_f32 v[222:223], v[42:43], v[62:63], v[222:223] op_sel_hi:[0,1,1] neg_lo:[1,0,0] neg_hi:[1,0,0]
v_pk_mul_f32 v[184:185], v[42:43], v[184:185] op_sel:[1,0] op_sel_hi:[1,1]
v_pk_mul_f32 v[186:187], v[42:43], v[186:187] op_sel:[1,0] op_sel_hi:[1,1]
v_cvt_pk_bf16_f32 v148, v148, v149
v_cvt_pk_bf16_f32 v149, v150, v151
ds_write_b64 v15, v[148:149] offset:32000
v_pk_fma_f32 v[152:153], v[44:45], v[52:53], v[152:153] op_sel_hi:[0,1,1] neg_lo:[1,0,0] neg_hi:[1,0,0]
v_pk_fma_f32 v[154:155], v[44:45], v[54:55], v[154:155] op_sel_hi:[0,1,1] neg_lo:[1,0,0] neg_hi:[1,0,0]
v_pk_mul_f32 v[220:221], v[42:43], v[220:221] op_sel:[1,0] op_sel_hi:[1,1]
v_pk_mul_f32 v[222:223], v[42:43], v[222:223] op_sel:[1,0] op_sel_hi:[1,1]
v_cvt_pk_bf16_f32 v184, v184, v185
v_cvt_pk_bf16_f32 v185, v186, v187
ds_write_b64 v15, v[184:185] offset:32128
v_pk_fma_f32 v[188:189], v[44:45], v[56:57], v[188:189] op_sel_hi:[0,1,1] neg_lo:[1,0,0] neg_hi:[1,0,0]
v_pk_fma_f32 v[190:191], v[44:45], v[58:59], v[190:191] op_sel_hi:[0,1,1] neg_lo:[1,0,0] neg_hi:[1,0,0]
v_pk_mul_f32 v[152:153], v[44:45], v[152:153] op_sel:[1,0] op_sel_hi:[1,1]
v_pk_mul_f32 v[154:155], v[44:45], v[154:155] op_sel:[1,0] op_sel_hi:[1,1]
v_cvt_pk_bf16_f32 v220, v220, v221
v_cvt_pk_bf16_f32 v221, v222, v223
ds_write_b64 v15, v[220:221] offset:32256
v_pk_fma_f32 v[224:225], v[44:45], v[60:61], v[224:225] op_sel_hi:[0,1,1] neg_lo:[1,0,0] neg_hi:[1,0,0]
v_pk_fma_f32 v[226:227], v[44:45], v[62:63], v[226:227] op_sel_hi:[0,1,1] neg_lo:[1,0,0] neg_hi:[1,0,0]
v_pk_mul_f32 v[188:189], v[44:45], v[188:189] op_sel:[1,0] op_sel_hi:[1,1]
v_pk_mul_f32 v[190:191], v[44:45], v[190:191] op_sel:[1,0] op_sel_hi:[1,1]
v_cvt_pk_bf16_f32 v152, v152, v153
v_cvt_pk_bf16_f32 v153, v154, v155
ds_write_b64 v15, v[152:153] offset:38400
v_pk_fma_f32 v[156:157], v[46:47], v[52:53], v[156:157] op_sel_hi:[0,1,1] neg_lo:[1,0,0] neg_hi:[1,0,0]
v_pk_fma_f32 v[158:159], v[46:47], v[54:55], v[158:159] op_sel_hi:[0,1,1] neg_lo:[1,0,0] neg_hi:[1,0,0]
v_pk_mul_f32 v[224:225], v[44:45], v[224:225] op_sel:[1,0] op_sel_hi:[1,1]
v_pk_mul_f32 v[226:227], v[44:45], v[226:227] op_sel:[1,0] op_sel_hi:[1,1]
v_cvt_pk_bf16_f32 v188, v188, v189
v_cvt_pk_bf16_f32 v189, v190, v191
ds_write_b64 v15, v[188:189] offset:38528
v_pk_fma_f32 v[192:193], v[46:47], v[56:57], v[192:193] op_sel_hi:[0,1,1] neg_lo:[1,0,0] neg_hi:[1,0,0]
v_pk_fma_f32 v[194:195], v[46:47], v[58:59], v[194:195] op_sel_hi:[0,1,1] neg_lo:[1,0,0] neg_hi:[1,0,0]
v_pk_mul_f32 v[156:157], v[46:47], v[156:157] op_sel:[1,0] op_sel_hi:[1,1]
v_pk_mul_f32 v[158:159], v[46:47], v[158:159] op_sel:[1,0] op_sel_hi:[1,1]
v_cvt_pk_bf16_f32 v224, v224, v225
v_cvt_pk_bf16_f32 v225, v226, v227
ds_write_b64 v15, v[224:225] offset:38656
v_pk_fma_f32 v[228:229], v[46:47], v[60:61], v[228:229] op_sel_hi:[0,1,1] neg_lo:[1,0,0] neg_hi:[1,0,0]
v_pk_fma_f32 v[230:231], v[46:47], v[62:63], v[230:231] op_sel_hi:[0,1,1] neg_lo:[1,0,0] neg_hi:[1,0,0]
v_pk_mul_f32 v[192:193], v[46:47], v[192:193] op_sel:[1,0] op_sel_hi:[1,1]
v_pk_mul_f32 v[194:195], v[46:47], v[194:195] op_sel:[1,0] op_sel_hi:[1,1]
v_cvt_pk_bf16_f32 v156, v156, v157
v_cvt_pk_bf16_f32 v157, v158, v159
ds_write_b64 v15, v[156:157] offset:44800
v_pk_fma_f32 v[160:161], v[48:49], v[52:53], v[160:161] op_sel_hi:[0,1,1] neg_lo:[1,0,0] neg_hi:[1,0,0]
v_pk_fma_f32 v[162:163], v[48:49], v[54:55], v[162:163] op_sel_hi:[0,1,1] neg_lo:[1,0,0] neg_hi:[1,0,0]
v_pk_mul_f32 v[228:229], v[46:47], v[228:229] op_sel:[1,0] op_sel_hi:[1,1]
v_pk_mul_f32 v[230:231], v[46:47], v[230:231] op_sel:[1,0] op_sel_hi:[1,1]
v_cvt_pk_bf16_f32 v192, v192, v193
v_cvt_pk_bf16_f32 v193, v194, v195
ds_write_b64 v15, v[192:193] offset:44928
v_pk_fma_f32 v[196:197], v[48:49], v[56:57], v[196:197] op_sel_hi:[0,1,1] neg_lo:[1,0,0] neg_hi:[1,0,0]
v_pk_fma_f32 v[198:199], v[48:49], v[58:59], v[198:199] op_sel_hi:[0,1,1] neg_lo:[1,0,0] neg_hi:[1,0,0]
v_pk_mul_f32 v[160:161], v[48:49], v[160:161] op_sel:[1,0] op_sel_hi:[1,1]
v_pk_mul_f32 v[162:163], v[48:49], v[162:163] op_sel:[1,0] op_sel_hi:[1,1]
v_cvt_pk_bf16_f32 v228, v228, v229
v_cvt_pk_bf16_f32 v229, v230, v231
ds_write_b64 v15, v[228:229] offset:45056
v_pk_fma_f32 v[232:233], v[48:49], v[60:61], v[232:233] op_sel_hi:[0,1,1] neg_lo:[1,0,0] neg_hi:[1,0,0]
v_pk_fma_f32 v[234:235], v[48:49], v[62:63], v[234:235] op_sel_hi:[0,1,1] neg_lo:[1,0,0] neg_hi:[1,0,0]
v_pk_mul_f32 v[196:197], v[48:49], v[196:197] op_sel:[1,0] op_sel_hi:[1,1]
v_pk_mul_f32 v[198:199], v[48:49], v[198:199] op_sel:[1,0] op_sel_hi:[1,1]
v_cvt_pk_bf16_f32 v160, v160, v161
v_cvt_pk_bf16_f32 v161, v162, v163
ds_write_b64 v15, v[160:161] offset:51200
v_pk_mul_f32 v[232:233], v[48:49], v[232:233] op_sel:[1,0] op_sel_hi:[1,1]
v_pk_mul_f32 v[234:235], v[48:49], v[234:235] op_sel:[1,0] op_sel_hi:[1,1]
v_cvt_pk_bf16_f32 v196, v196, v197
v_cvt_pk_bf16_f32 v197, v198, v199
ds_write_b64 v15, v[196:197] offset:51328
v_cvt_pk_bf16_f32 v232, v232, v233
v_cvt_pk_bf16_f32 v233, v234, v235
ds_write_b64 v15, v[232:233] offset:51456
s_waitcnt lgkmcnt(0)
s_branch Latt_5
Lpf_4:
s_branch Lov_3
.p2align 12
.fill 16, 4, 0xbf800000
Lst_3_0:
s_branch Lwr_158
s_nop 0
s_nop 0
Lov_3:
s_lshl_b32 s43, s35, 7
s_waitcnt lgkmcnt(0)
s_mov_b32 s8, s64
s_mov_b32 s9, s65
s_mov_b32 s10, 4194304
s_mov_b32 s11, 0x20000
s_add_u32 s12, s66, s43
s_addc_u32 s13, s67, 0
s_mov_b32 s14, 6289536
s_mov_b32 s15, 0x20000
s_add_u32 s84, s82, 28311552
s_addc_u32 s85, s83, 0
s_mov_b32 s86, 114688
s_mov_b32 s87, 0x20000
s_mov_b32 s56, s80
s_mov_b32 s57, s81
s_mov_b32 s58, 256
s_mov_b32 s59, 0x20000
v_mov_b32 v5, 0
v_lshlrev_b32 v14, 7, v1
s_or_b32 s43, s34, s35
s_cmp_lg_u32 s43, 0
s_cbranch_scc1 Lz_32
s_movk_i32 s43, 0x2000
buffer_store_dword v5, v14, s[84:87], 0 offen sc1
s_bfm_b64 exec, 60, 0
buffer_store_dword v5, v14, s[84:87], s43 offen sc1
s_mov_b64 exec, 1
v_mov_b32 v6, 1
s_waitcnt vmcnt(0)
buffer_store_dword v6, v5, s[56:59], 0 offen sc1
s_mov_b64 exec, -1
Lz_32:
s_lshl_b32 s43, s51, 11
buffer_load_dwordx4 v[96:99], v10, s[8:11], s43 offen offset:0
buffer_load_dwordx4 v[100:103], v10, s[8:11], s43 offen offset:1024
buffer_load_dwordx4 v[104:107], v10, s[8:11], s43 offen offset:2048
buffer_load_dwordx4 v[108:111], v10, s[8:11], s43 offen offset:3072
v_min_u32 v14, 23, v1
v_lshrrev_b32 v15, 3, v14
v_mul_u32_u24 v15, 43008, v15
v_and_b32 v14, 7, v14
v_lshl_add_u32 v15, v14, 4, v15
v_mov_b32 v32, 0x3f803f80
v_mov_b32 v33, 0x3f803f80
v_mov_b32 v34, 0x3f803f80
v_mov_b32 v35, 0x3f803f80
ds_write_b128 v15, v[32:35]
s_add_u32 s20, s82, 26214400
s_addc_u32 s21, s83, 0
s_mov_b32 s22, 16384
s_mov_b32 s23, 0x20000
s_add_u32 s43, s2, 128
s_lshl_b32 s43, s43, 7
v_lshlrev_b32 v14, 2, v1
s_mov_b64 exec, 15
buffer_store_dword v5, v14, s[84:87], s43 offen sc1
s_mov_b64 exec, -1
s_lshl_b32 s43, s34, 4
s_add_u32 s43, s43, s35
s_lshl_b32 s43, s43, 8
s_add_u32 s43, s43, 49152
v_lshlrev_b32 v14, 7, v1
s_mov_b64 exec, 3
buffer_store_dword v5, v14, s[84:87], s43 offen sc1
s_mov_b64 exec, -1
s_lshl_b32 s52, s34, 7
s_add_u32 s52, s52, 28319744
s_sub_u32 s53, s52, 128
s_cmp_eq_u32 s34, 0
s_cselect_b32 s53, s52, s53
s_waitcnt lgkmcnt(0)
s_barrier
s_waitcnt vmcnt(2)
s_mov_b32 s43, 0x3f803f80
v_mov_b32 v116, 0
v_mov_b32 v117, 0
v_mov_b32 v118, 0
v_mov_b32 v119, 0
v_mov_b32 v120, 0
v_mov_b32 v121, 0
v_mov_b32 v122, 0
v_mov_b32 v123, 0
v_dot2_f32_bf16 v116, v96, s43, v116
v_dot2_f32_bf16 v120, v96, v96, v120
v_dot2_f32_bf16 v118, v104, s43, v118
v_dot2_f32_bf16 v122, v104, v104, v122
v_dot2_f32_bf16 v117, v97, s43, v117
v_dot2_f32_bf16 v121, v97, v97, v121
v_dot2_f32_bf16 v119, v105, s43, v119
v_dot2_f32_bf16 v123, v105, v105, v123
v_dot2_f32_bf16 v116, v98, s43, v116
v_dot2_f32_bf16 v120, v98, v98, v120
v_dot2_f32_bf16 v118, v106, s43, v118
v_dot2_f32_bf16 v122, v106, v106, v122
v_dot2_f32_bf16 v117, v99, s43, v117
v_dot2_f32_bf16 v121, v99, v99, v121
v_dot2_f32_bf16 v119, v107, s43, v119
v_dot2_f32_bf16 v123, v107, v107, v123
v_dot2_f32_bf16 v116, v100, s43, v116
v_dot2_f32_bf16 v120, v100, v100, v120
v_dot2_f32_bf16 v118, v108, s43, v118
v_dot2_f32_bf16 v122, v108, v108, v122
v_dot2_f32_bf16 v117, v101, s43, v117
v_dot2_f32_bf16 v121, v101, v101, v121
v_dot2_f32_bf16 v119, v109, s43, v119
v_dot2_f32_bf16 v123, v109, v109, v123
v_dot2_f32_bf16 v116, v102, s43, v116
v_dot2_f32_bf16 v120, v102, v102, v120
v_dot2_f32_bf16 v118, v110, s43, v118
v_dot2_f32_bf16 v122, v110, v110, v122
v_dot2_f32_bf16 v117, v103, s43, v117
v_dot2_f32_bf16 v121, v103, v103, v121
v_dot2_f32_bf16 v119, v111, s43, v119
v_dot2_f32_bf16 v123, v111, v111, v123
s_nop 2
v_add_f32 v116, v116, v117
v_add_f32 v118, v118, v119
v_add_f32 v120, v120, v121
v_add_f32 v122, v122, v123
s_nop 1
v_permlane32_swap_b32 v116, v118
v_permlane32_swap_b32 v120, v122
v_add_f32 v116, v116, v118
v_add_f32 v120, v120, v122
s_nop 1
v_permlane16_swap_b32 v116, v120
v_add_f32 v116, v116, v120
s_nop 1
v_add_f32_dpp v116, v116, v116 row_ror:8 row_mask:0xf bank_mask:0xf
s_nop 1
v_add_f32_dpp v116, v116, v116 row_ror:4 row_mask:0xf bank_mask:0xf
s_nop 1
v_add_f32_dpp v116, v116, v116 row_ror:2 row_mask:0xf bank_mask:0xf
s_nop 1
v_add_f32_dpp v116, v116, v116 row_ror:1 row_mask:0xf bank_mask:0xf
v_mov_b32 v117, v116
s_nop 1
v_permlane16_swap_b32 v116, v117
v_mul_f32 v112, 0x3a800000, v116
v_mul_f32 v113, 0x3a800000, v117
v_fma_f32 v113, -v112, v112, v113
v_max_f32 v113, 0, v113
v_add_f32 v113, 0x3727c5ac, v113
v_rsq_f32 v113, v113
v_lshrrev_b32 v11, 5, v1
s_lshl_b32 s43, s47, 4
s_add_u32 s43, s43, 148608
v_lshl_add_u32 v11, v11, 3, s43
ds_write_b64 v11, v[112:113]
s_waitcnt lgkmcnt(0)
s_mov_b32 s28, s66
s_mov_b32 s29, s67
s_mov_b32 s30, 6291456
s_mov_b32 s31, 0x20000
s_mul_i32 s43, s33, 8832
s_add_u32 s43, s43, 1572864
v_lshlrev_b32 v30, 7, v1
buffer_load_dword v31, v30, s[28:31], s43 offen
s_add_u32 s43, s43, 8192
s_bfm_b64 exec, 5, 0
buffer_load_dword v31, v30, s[28:31], s43 offen
s_mov_b64 exec, -1
s_branch Lst_0_0
Lwr_155:
s_barrier
v_lshlrev_b32 v5, 4, v1
v_and_b32 v5, 63, v5
v_add_u32 v6, 148608, v5
ds_read_b128 v[112:115], v6
s_lshl_b32 s43, s63, 3
v_add_u32 v5, s43, v5
s_waitcnt lgkmcnt(0)
s_mov_b64 exec, 15
buffer_store_dwordx4 v[112:115], v5, s[20:23], 0 offen sc1
s_mov_b64 exec, -1
v_mov_b32 v4, 0
buffer_load_dword v6, v4, s[56:59], 0 offen sc1
s_mov_b32 s62, 0
s_mov_b32 s28, s66
s_mov_b32 s29, s67
s_mov_b32 s30, 6291456
s_mov_b32 s31, 0x20000
s_mul_i32 s43, s33, 12288
s_add_u32 s43, s43, 3538944
v_lshlrev_b32 v30, 7, v1
buffer_load_dword v31, v30, s[28:31], s43 offen
s_add_u32 s43, s43, 8192
s_bfm_b64 exec, 32, 0
buffer_load_dword v31, v30, s[28:31], s43 offen
s_mov_b64 exec, -1
s_branch Lst_1_0
Lwr_156:
s_barrier
s_lshl_b32 s43, s35, 7
s_add_u32 s28, s68, s43
s_addc_u32 s29, s69, 0
s_mov_b32 s30, 2095232
s_mov_b32 s31, 0x20000
v_and_b32 v29, 7, v1
v_lshrrev_b32 v30, 3, v1
v_lshl_add_u32 v29, v30, 6, v29
s_lshl_b32 s43, s48, 3
v_add_u32 v29, s43, v29
v_lshlrev_b32 v29, 11, v29
s_mov_b32 s43, 1048576
s_mov_b32 s28, s68
s_mov_b32 s29, s69
s_mov_b32 s30, 2097152
s_mov_b32 s31, 0x20000
s_mul_i32 s43, s33, 9472
v_lshlrev_b32 v30, 7, v1
buffer_load_dword v31, v30, s[28:31], s43 offen
s_add_u32 s43, s43, 8192
s_bfm_b64 exec, 10, 0
buffer_load_dword v31, v30, s[28:31], s43 offen
s_mov_b64 exec, -1
s_branch Lst_2_0
Lwr_157:
s_barrier
s_branch Lst_3_0
Lwr_158:
s_barrier
s_branch Lst_4_0
Lwr_159:
s_barrier
s_branch Lst_5_0
Lwr_160:
s_barrier
s_cmp_eq_u32 s62, 3
s_cbranch_scc1 Lste_36
s_cmp_eq_u32 s62, 2
s_cbranch_scc1 Lst2_34
s_cmp_ge_u32 s62, 4
s_cbranch_scc1 Lst4_35
s_cmp_eq_u32 s62, 1
s_cbranch_scc1 Lst1_33
s_waitcnt vmcnt(4)
v_readfirstlane_b32 s54, v6
s_cmp_eq_u32 s54, 0
s_cbranch_scc0 Lrep_37
buffer_load_dword v6, v4, s[56:59], 0 offen sc1
s_branch Lste_36
Lrep_37:
s_add_u32 s7, s34, 64
s_lshl_b32 s7, s7, 7
v_mov_b32 v5, s7
v_mov_b32 v6, 1
s_mov_b64 exec, 1
buffer_atomic_add v6, v5, s[84:87], 0 offen sc1
s_mov_b64 exec, -1
s_mov_b32 s62, 1
s_mov_b32 s54, 0
s_mov_b32 s55, 0
s_branch Lste_36
Lst1_33:
s_and_b32 s43, s54, s55
s_cmp_eq_u32 s43, 16
s_cbranch_scc1 Lg_38
s_load_dword s54, s[82:83], s52 glc
s_load_dword s55, s[82:83], s53 glc
s_branch Lste_36
Lg_38:
v_add_u32 v5, 0, v1
v_min_u32 v5, 143, v5
v_lshlrev_b32 v20, 3, v5
v_add_u32 v5, s50, v5
v_max_i32 v5, 0, v5
v_lshlrev_b32 v5, 3, v5
buffer_load_dwordx2 v[32:33], v5, s[20:23], 0 offen sc1
v_add_u32 v5, 64, v1
v_min_u32 v5, 143, v5
v_lshlrev_b32 v21, 3, v5
v_add_u32 v5, s50, v5
v_max_i32 v5, 0, v5
v_lshlrev_b32 v5, 3, v5
buffer_load_dwordx2 v[34:35], v5, s[20:23], 0 offen sc1
v_add_u32 v5, 128, v1
v_min_u32 v5, 143, v5
v_lshlrev_b32 v22, 3, v5
v_add_u32 v5, s50, v5
v_max_i32 v5, 0, v5
v_lshlrev_b32 v5, 3, v5
buffer_load_dwordx2 v[36:37], v5, s[20:23], 0 offen sc1
s_mov_b32 s62, 4
s_branch Lste_36
Lst4_35:
s_mov_b32 s62, 2
s_branch Lste_36
Lst2_34:
s_waitcnt vmcnt(0)
v_add_u32 v20, 147456, v20
ds_write_b64 v20, v[32:33]
v_add_u32 v21, 147456, v21
ds_write_b64 v21, v[34:35]
v_add_u32 v22, 147456, v22
ds_write_b64 v22, v[36:37]
s_waitcnt lgkmcnt(0)
s_mov_b32 s62, 3
Lste_36:
s_branch Lst_6_0
Lwr_161:
s_barrier
s_cmp_eq_u32 s62, 3
s_cbranch_scc1 Lste_42
s_cmp_eq_u32 s62, 2
s_cbranch_scc1 Lst2_40
s_cmp_ge_u32 s62, 4
s_cbranch_scc1 Lst4_41
s_cmp_eq_u32 s62, 1
s_cbranch_scc1 Lst1_39
s_waitcnt vmcnt(0)
v_readfirstlane_b32 s54, v6
s_cmp_eq_u32 s54, 0
s_cbranch_scc0 Lrep_43
buffer_load_dword v6, v4, s[56:59], 0 offen sc1
s_branch Lste_42
Lrep_43:
s_add_u32 s7, s34, 64
s_lshl_b32 s7, s7, 7
v_mov_b32 v5, s7
v_mov_b32 v6, 1
s_mov_b64 exec, 1
buffer_atomic_add v6, v5, s[84:87], 0 offen sc1
s_mov_b64 exec, -1
s_mov_b32 s62, 1
s_mov_b32 s54, 0
s_mov_b32 s55, 0
s_branch Lste_42
Lst1_39:
s_and_b32 s43, s54, s55
s_cmp_eq_u32 s43, 16
s_cbranch_scc1 Lg_44
s_load_dword s54, s[82:83], s52 glc
s_load_dword s55, s[82:83], s53 glc
s_branch Lste_42
Lg_44:
v_add_u32 v5, 0, v1
v_min_u32 v5, 143, v5
v_lshlrev_b32 v20, 3, v5
v_add_u32 v5, s50, v5
v_max_i32 v5, 0, v5
v_lshlrev_b32 v5, 3, v5
buffer_load_dwordx2 v[32:33], v5, s[20:23], 0 offen sc1
v_add_u32 v5, 64, v1
v_min_u32 v5, 143, v5
v_lshlrev_b32 v21, 3, v5
v_add_u32 v5, s50, v5
v_max_i32 v5, 0, v5
v_lshlrev_b32 v5, 3, v5
buffer_load_dwordx2 v[34:35], v5, s[20:23], 0 offen sc1
v_add_u32 v5, 128, v1
v_min_u32 v5, 143, v5
v_lshlrev_b32 v22, 3, v5
v_add_u32 v5, s50, v5
v_max_i32 v5, 0, v5
v_lshlrev_b32 v5, 3, v5
buffer_load_dwordx2 v[36:37], v5, s[20:23], 0 offen sc1
s_mov_b32 s62, 4
s_branch Lste_42
Lst4_41:
s_mov_b32 s62, 2
s_branch Lste_42
Lst2_40:
s_waitcnt vmcnt(0)
v_add_u32 v20, 147456, v20
ds_write_b64 v20, v[32:33]
v_add_u32 v21, 147456, v21
ds_write_b64 v21, v[34:35]
v_add_u32 v22, 147456, v22
ds_write_b64 v22, v[36:37]
s_waitcnt lgkmcnt(0)
s_mov_b32 s62, 3
Lste_42:
s_branch Lst_7_0
Lwr_162:
s_barrier
s_cmp_eq_u32 s62, 3
s_cbranch_scc1 Lste_48
s_cmp_eq_u32 s62, 2
s_cbranch_scc1 Lst2_46
s_cmp_ge_u32 s62, 4
s_cbranch_scc1 Lst4_47
s_cmp_eq_u32 s62, 1
s_cbranch_scc1 Lst1_45
s_waitcnt vmcnt(0)
v_readfirstlane_b32 s54, v6
s_cmp_eq_u32 s54, 0
s_cbranch_scc0 Lrep_49
buffer_load_dword v6, v4, s[56:59], 0 offen sc1
s_branch Lste_48
Lrep_49:
s_add_u32 s7, s34, 64
s_lshl_b32 s7, s7, 7
v_mov_b32 v5, s7
v_mov_b32 v6, 1
s_mov_b64 exec, 1
buffer_atomic_add v6, v5, s[84:87], 0 offen sc1
s_mov_b64 exec, -1
s_mov_b32 s62, 1
s_mov_b32 s54, 0
s_mov_b32 s55, 0
s_branch Lste_48
Lst1_45:
s_and_b32 s43, s54, s55
s_cmp_eq_u32 s43, 16
s_cbranch_scc1 Lg_50
s_load_dword s54, s[82:83], s52 glc
s_load_dword s55, s[82:83], s53 glc
s_branch Lste_48
Lg_50:
v_add_u32 v5, 0, v1
v_min_u32 v5, 143, v5
v_lshlrev_b32 v20, 3, v5
v_add_u32 v5, s50, v5
v_max_i32 v5, 0, v5
v_lshlrev_b32 v5, 3, v5
buffer_load_dwordx2 v[32:33], v5, s[20:23], 0 offen sc1
v_add_u32 v5, 64, v1
v_min_u32 v5, 143, v5
v_lshlrev_b32 v21, 3, v5
v_add_u32 v5, s50, v5
v_max_i32 v5, 0, v5
v_lshlrev_b32 v5, 3, v5
buffer_load_dwordx2 v[34:35], v5, s[20:23], 0 offen sc1
v_add_u32 v5, 128, v1
v_min_u32 v5, 143, v5
v_lshlrev_b32 v22, 3, v5
v_add_u32 v5, s50, v5
v_max_i32 v5, 0, v5
v_lshlrev_b32 v5, 3, v5
buffer_load_dwordx2 v[36:37], v5, s[20:23], 0 offen sc1
s_mov_b32 s62, 4
s_branch Lste_48
Lst4_47:
s_mov_b32 s62, 2
s_branch Lste_48
Lst2_46:
s_waitcnt vmcnt(0)
v_add_u32 v20, 147456, v20
ds_write_b64 v20, v[32:33]
v_add_u32 v21, 147456, v21
ds_write_b64 v21, v[34:35]
v_add_u32 v22, 147456, v22
ds_write_b64 v22, v[36:37]
s_waitcnt lgkmcnt(0)
s_mov_b32 s62, 3
Lste_48:
s_branch Lst_8_0
Lwr_163:
s_barrier
s_cmp_eq_u32 s62, 3
s_cbranch_scc1 Lste_54
s_cmp_eq_u32 s62, 2
s_cbranch_scc1 Lst2_52
s_cmp_ge_u32 s62, 4
s_cbranch_scc1 Lst4_53
s_cmp_eq_u32 s62, 1
s_cbranch_scc1 Lst1_51
s_waitcnt vmcnt(0)
v_readfirstlane_b32 s54, v6
s_cmp_eq_u32 s54, 0
s_cbranch_scc0 Lrep_55
buffer_load_dword v6, v4, s[56:59], 0 offen sc1
s_branch Lste_54
Lrep_55:
s_add_u32 s7, s34, 64
s_lshl_b32 s7, s7, 7
v_mov_b32 v5, s7
v_mov_b32 v6, 1
s_mov_b64 exec, 1
buffer_atomic_add v6, v5, s[84:87], 0 offen sc1
s_mov_b64 exec, -1
s_mov_b32 s62, 1
s_mov_b32 s54, 0
s_mov_b32 s55, 0
s_branch Lste_54
Lst1_51:
s_and_b32 s43, s54, s55
s_cmp_eq_u32 s43, 16
s_cbranch_scc1 Lg_56
s_load_dword s54, s[82:83], s52 glc
s_load_dword s55, s[82:83], s53 glc
s_branch Lste_54
Lg_56:
v_add_u32 v5, 0, v1
v_min_u32 v5, 143, v5
v_lshlrev_b32 v20, 3, v5
v_add_u32 v5, s50, v5
v_max_i32 v5, 0, v5
v_lshlrev_b32 v5, 3, v5
buffer_load_dwordx2 v[32:33], v5, s[20:23], 0 offen sc1
v_add_u32 v5, 64, v1
v_min_u32 v5, 143, v5
v_lshlrev_b32 v21, 3, v5
v_add_u32 v5, s50, v5
v_max_i32 v5, 0, v5
v_lshlrev_b32 v5, 3, v5
buffer_load_dwordx2 v[34:35], v5, s[20:23], 0 offen sc1
v_add_u32 v5, 128, v1
v_min_u32 v5, 143, v5
v_lshlrev_b32 v22, 3, v5
v_add_u32 v5, s50, v5
v_max_i32 v5, 0, v5
v_lshlrev_b32 v5, 3, v5
buffer_load_dwordx2 v[36:37], v5, s[20:23], 0 offen sc1
s_mov_b32 s62, 4
s_branch Lste_54
Lst4_53:
s_mov_b32 s62, 2
s_branch Lste_54
Lst2_52:
s_waitcnt vmcnt(0)
v_add_u32 v20, 147456, v20
ds_write_b64 v20, v[32:33]
v_add_u32 v21, 147456, v21
ds_write_b64 v21, v[34:35]
v_add_u32 v22, 147456, v22
ds_write_b64 v22, v[36:37]
s_waitcnt lgkmcnt(0)
s_mov_b32 s62, 3
Lste_54:
s_branch Lst_9_0
Lwr_164:
s_barrier
s_getpc_b64 s[100:101]
s_and_b32 s100, s100, 0xfffff000
s_sub_u32 s100, s100, 1064960
s_subb_u32 s101, s101, 0
s_lshr_b32 s6, s2, 3
s_mul_i32 s6, s6, 1
s_and_b32 s7, s36, 0
s_add_u32 s6, s6, s7
s_mulk_i32 s6, 640
s_add_u32 s6, s6, 1063232
s_load_dword s3, s[100:101], s6 offset:0
s_load_dword s3, s[100:101], s6 offset:64
s_load_dword s3, s[100:101], s6 offset:128
s_load_dword s3, s[100:101], s6 offset:192
s_load_dword s3, s[100:101], s6 offset:256
s_load_dword s3, s[100:101], s6 offset:320
s_load_dword s3, s[100:101], s6 offset:384
s_load_dword s3, s[100:101], s6 offset:448
s_load_dword s3, s[100:101], s6 offset:512
s_load_dword s3, s[100:101], s6 offset:576
s_cmp_eq_u32 s62, 3
s_cbranch_scc1 Lste_60
s_cmp_eq_u32 s62, 2
s_cbranch_scc1 Lst2_58
s_cmp_ge_u32 s62, 4
s_cbranch_scc1 Lst4_59
s_cmp_eq_u32 s62, 1
s_cbranch_scc1 Lst1_57
s_waitcnt vmcnt(0)
v_readfirstlane_b32 s54, v6
s_cmp_eq_u32 s54, 0
s_cbranch_scc0 Lrep_61
buffer_load_dword v6, v4, s[56:59], 0 offen sc1
s_branch Lste_60
Lrep_61:
s_add_u32 s7, s34, 64
s_lshl_b32 s7, s7, 7
v_mov_b32 v5, s7
v_mov_b32 v6, 1
s_mov_b64 exec, 1
buffer_atomic_add v6, v5, s[84:87], 0 offen sc1
s_mov_b64 exec, -1
s_mov_b32 s62, 1
s_mov_b32 s54, 0
s_mov_b32 s55, 0
s_branch Lste_60
Lst1_57:
s_and_b32 s43, s54, s55
s_cmp_eq_u32 s43, 16
s_cbranch_scc1 Lg_62
s_load_dword s54, s[82:83], s52 glc
s_load_dword s55, s[82:83], s53 glc
s_branch Lste_60
Lg_62:
v_add_u32 v5, 0, v1
v_min_u32 v5, 143, v5
v_lshlrev_b32 v20, 3, v5
v_add_u32 v5, s50, v5
v_max_i32 v5, 0, v5
v_lshlrev_b32 v5, 3, v5
buffer_load_dwordx2 v[32:33], v5, s[20:23], 0 offen sc1
v_add_u32 v5, 64, v1
v_min_u32 v5, 143, v5
v_lshlrev_b32 v21, 3, v5
v_add_u32 v5, s50, v5
v_max_i32 v5, 0, v5
v_lshlrev_b32 v5, 3, v5
buffer_load_dwordx2 v[34:35], v5, s[20:23], 0 offen sc1
v_add_u32 v5, 128, v1
v_min_u32 v5, 143, v5
v_lshlrev_b32 v22, 3, v5
v_add_u32 v5, s50, v5
v_max_i32 v5, 0, v5
v_lshlrev_b32 v5, 3, v5
buffer_load_dwordx2 v[36:37], v5, s[20:23], 0 offen sc1
s_mov_b32 s62, 4
s_branch Lste_60
Lst4_59:
s_mov_b32 s62, 2
s_branch Lste_60
Lst2_58:
s_waitcnt vmcnt(0)
v_add_u32 v20, 147456, v20
ds_write_b64 v20, v[32:33]
v_add_u32 v21, 147456, v21
ds_write_b64 v21, v[34:35]
v_add_u32 v22, 147456, v22
ds_write_b64 v22, v[36:37]
s_waitcnt lgkmcnt(0)
s_mov_b32 s62, 3
Lste_60:
s_branch Lst_10_0
Lwr_165:
s_barrier
s_cmp_eq_u32 s62, 3
s_cbranch_scc1 Lste_66
s_cmp_eq_u32 s62, 2
s_cbranch_scc1 Lst2_64
s_cmp_ge_u32 s62, 4
s_cbranch_scc1 Lst4_65
s_cmp_eq_u32 s62, 1
s_cbranch_scc1 Lst1_63
s_waitcnt vmcnt(0)
v_readfirstlane_b32 s54, v6
s_cmp_eq_u32 s54, 0
s_cbranch_scc0 Lrep_67
buffer_load_dword v6, v4, s[56:59], 0 offen sc1
s_branch Lste_66
Lrep_67:
s_add_u32 s7, s34, 64
s_lshl_b32 s7, s7, 7
v_mov_b32 v5, s7
v_mov_b32 v6, 1
s_mov_b64 exec, 1
buffer_atomic_add v6, v5, s[84:87], 0 offen sc1
s_mov_b64 exec, -1
s_mov_b32 s62, 1
s_mov_b32 s54, 0
s_mov_b32 s55, 0
s_branch Lste_66
Lst1_63:
s_and_b32 s43, s54, s55
s_cmp_eq_u32 s43, 16
s_cbranch_scc1 Lg_68
s_load_dword s54, s[82:83], s52 glc
s_load_dword s55, s[82:83], s53 glc
s_branch Lste_66
Lg_68:
v_add_u32 v5, 0, v1
v_min_u32 v5, 143, v5
v_lshlrev_b32 v20, 3, v5
v_add_u32 v5, s50, v5
v_max_i32 v5, 0, v5
v_lshlrev_b32 v5, 3, v5
buffer_load_dwordx2 v[32:33], v5, s[20:23], 0 offen sc1
v_add_u32 v5, 64, v1
v_min_u32 v5, 143, v5
v_lshlrev_b32 v21, 3, v5
v_add_u32 v5, s50, v5
v_max_i32 v5, 0, v5
v_lshlrev_b32 v5, 3, v5
buffer_load_dwordx2 v[34:35], v5, s[20:23], 0 offen sc1
v_add_u32 v5, 128, v1
v_min_u32 v5, 143, v5
v_lshlrev_b32 v22, 3, v5
v_add_u32 v5, s50, v5
v_max_i32 v5, 0, v5
v_lshlrev_b32 v5, 3, v5
buffer_load_dwordx2 v[36:37], v5, s[20:23], 0 offen sc1
s_mov_b32 s62, 4
s_branch Lste_66
Lst4_65:
s_mov_b32 s62, 2
s_branch Lste_66
Lst2_64:
s_waitcnt vmcnt(0)
v_add_u32 v20, 147456, v20
ds_write_b64 v20, v[32:33]
v_add_u32 v21, 147456, v21
ds_write_b64 v21, v[34:35]
v_add_u32 v22, 147456, v22
ds_write_b64 v22, v[36:37]
s_waitcnt lgkmcnt(0)
s_mov_b32 s62, 3
Lste_66:
s_branch Lst_11_0
Lwr_166:
s_barrier
s_cmp_eq_u32 s62, 3
s_cbranch_scc1 Lste_72
s_cmp_eq_u32 s62, 2
s_cbranch_scc1 Lst2_70
s_cmp_ge_u32 s62, 4
s_cbranch_scc1 Lst4_71
s_cmp_eq_u32 s62, 1
s_cbranch_scc1 Lst1_69
s_waitcnt vmcnt(0)
v_readfirstlane_b32 s54, v6
s_cmp_eq_u32 s54, 0
s_cbranch_scc0 Lrep_73
buffer_load_dword v6, v4, s[56:59], 0 offen sc1
s_branch Lste_72
Lrep_73:
s_add_u32 s7, s34, 64
s_lshl_b32 s7, s7, 7
v_mov_b32 v5, s7
v_mov_b32 v6, 1
s_mov_b64 exec, 1
buffer_atomic_add v6, v5, s[84:87], 0 offen sc1
s_mov_b64 exec, -1
s_mov_b32 s62, 1
s_mov_b32 s54, 0
s_mov_b32 s55, 0
s_branch Lste_72
Lst1_69:
s_and_b32 s43, s54, s55
s_cmp_eq_u32 s43, 16
s_cbranch_scc1 Lg_74
s_load_dword s54, s[82:83], s52 glc
s_load_dword s55, s[82:83], s53 glc
s_branch Lste_72
Lg_74:
v_add_u32 v5, 0, v1
v_min_u32 v5, 143, v5
v_lshlrev_b32 v20, 3, v5
v_add_u32 v5, s50, v5
v_max_i32 v5, 0, v5
v_lshlrev_b32 v5, 3, v5
buffer_load_dwordx2 v[32:33], v5, s[20:23], 0 offen sc1
v_add_u32 v5, 64, v1
v_min_u32 v5, 143, v5
v_lshlrev_b32 v21, 3, v5
v_add_u32 v5, s50, v5
v_max_i32 v5, 0, v5
v_lshlrev_b32 v5, 3, v5
buffer_load_dwordx2 v[34:35], v5, s[20:23], 0 offen sc1
v_add_u32 v5, 128, v1
v_min_u32 v5, 143, v5
v_lshlrev_b32 v22, 3, v5
v_add_u32 v5, s50, v5
v_max_i32 v5, 0, v5
v_lshlrev_b32 v5, 3, v5
buffer_load_dwordx2 v[36:37], v5, s[20:23], 0 offen sc1
s_mov_b32 s62, 4
s_branch Lste_72
Lst4_71:
s_mov_b32 s62, 2
s_branch Lste_72
Lst2_70:
s_waitcnt vmcnt(0)
v_add_u32 v20, 147456, v20
ds_write_b64 v20, v[32:33]
v_add_u32 v21, 147456, v21
ds_write_b64 v21, v[34:35]
v_add_u32 v22, 147456, v22
ds_write_b64 v22, v[36:37]
s_waitcnt lgkmcnt(0)
s_mov_b32 s62, 3
Lste_72:
s_branch Lst_12_0
Lwr_167:
s_barrier
s_cmp_eq_u32 s62, 3
s_cbranch_scc1 Lste_78
s_cmp_eq_u32 s62, 2
s_cbranch_scc1 Lst2_76
s_cmp_ge_u32 s62, 4
s_cbranch_scc1 Lst4_77
s_cmp_eq_u32 s62, 1
s_cbranch_scc1 Lst1_75
s_waitcnt vmcnt(0)
v_readfirstlane_b32 s54, v6
s_cmp_eq_u32 s54, 0
s_cbranch_scc0 Lrep_79
buffer_load_dword v6, v4, s[56:59], 0 offen sc1
s_branch Lste_78
Lrep_79:
s_add_u32 s7, s34, 64
s_lshl_b32 s7, s7, 7
v_mov_b32 v5, s7
v_mov_b32 v6, 1
s_mov_b64 exec, 1
buffer_atomic_add v6, v5, s[84:87], 0 offen sc1
s_mov_b64 exec, -1
s_mov_b32 s62, 1
s_mov_b32 s54, 0
s_mov_b32 s55, 0
s_branch Lste_78
Lst1_75:
s_and_b32 s43, s54, s55
s_cmp_eq_u32 s43, 16
s_cbranch_scc1 Lg_80
s_load_dword s54, s[82:83], s52 glc
s_load_dword s55, s[82:83], s53 glc
s_branch Lste_78
Lg_80:
v_add_u32 v5, 0, v1
v_min_u32 v5, 143, v5
v_lshlrev_b32 v20, 3, v5
v_add_u32 v5, s50, v5
v_max_i32 v5, 0, v5
v_lshlrev_b32 v5, 3, v5
buffer_load_dwordx2 v[32:33], v5, s[20:23], 0 offen sc1
v_add_u32 v5, 64, v1
v_min_u32 v5, 143, v5
v_lshlrev_b32 v21, 3, v5
v_add_u32 v5, s50, v5
v_max_i32 v5, 0, v5
v_lshlrev_b32 v5, 3, v5
buffer_load_dwordx2 v[34:35], v5, s[20:23], 0 offen sc1
v_add_u32 v5, 128, v1
v_min_u32 v5, 143, v5
s_branch Lov_4
.p2align 12
.fill 32, 4, 0xbf800000
Lst_4_0:
s_branch Lwr_159
s_nop 0
s_nop 0
Lov_4:
v_lshlrev_b32 v22, 3, v5
v_add_u32 v5, s50, v5
v_max_i32 v5, 0, v5
v_lshlrev_b32 v5, 3, v5
buffer_load_dwordx2 v[36:37], v5, s[20:23], 0 offen sc1
s_mov_b32 s62, 4
s_branch Lste_78
Lst4_77:
s_mov_b32 s62, 2
s_branch Lste_78
Lst2_76:
s_waitcnt vmcnt(0)
v_add_u32 v20, 147456, v20
ds_write_b64 v20, v[32:33]
v_add_u32 v21, 147456, v21
ds_write_b64 v21, v[34:35]
v_add_u32 v22, 147456, v22
ds_write_b64 v22, v[36:37]
s_waitcnt lgkmcnt(0)
s_mov_b32 s62, 3
Lste_78:
s_branch Lst_13_0
Lwr_168:
s_barrier
s_cmp_eq_u32 s62, 3
s_cbranch_scc1 Lste_84
s_cmp_eq_u32 s62, 2
s_cbranch_scc1 Lst2_82
s_cmp_ge_u32 s62, 4
s_cbranch_scc1 Lst4_83
s_cmp_eq_u32 s62, 1
s_cbranch_scc1 Lst1_81
s_waitcnt vmcnt(0)
v_readfirstlane_b32 s54, v6
s_cmp_eq_u32 s54, 0
s_cbranch_scc0 Lrep_85
buffer_load_dword v6, v4, s[56:59], 0 offen sc1
s_branch Lste_84
Lrep_85:
s_add_u32 s7, s34, 64
s_lshl_b32 s7, s7, 7
v_mov_b32 v5, s7
v_mov_b32 v6, 1
s_mov_b64 exec, 1
buffer_atomic_add v6, v5, s[84:87], 0 offen sc1
s_mov_b64 exec, -1
s_mov_b32 s62, 1
s_mov_b32 s54, 0
s_mov_b32 s55, 0
s_branch Lste_84
Lst1_81:
s_and_b32 s43, s54, s55
s_cmp_eq_u32 s43, 16
s_cbranch_scc1 Lg_86
s_load_dword s54, s[82:83], s52 glc
s_load_dword s55, s[82:83], s53 glc
s_branch Lste_84
Lg_86:
v_add_u32 v5, 0, v1
v_min_u32 v5, 143, v5
v_lshlrev_b32 v20, 3, v5
v_add_u32 v5, s50, v5
v_max_i32 v5, 0, v5
v_lshlrev_b32 v5, 3, v5
buffer_load_dwordx2 v[32:33], v5, s[20:23], 0 offen sc1
v_add_u32 v5, 64, v1
v_min_u32 v5, 143, v5
v_lshlrev_b32 v21, 3, v5
v_add_u32 v5, s50, v5
v_max_i32 v5, 0, v5
v_lshlrev_b32 v5, 3, v5
buffer_load_dwordx2 v[34:35], v5, s[20:23], 0 offen sc1
v_add_u32 v5, 128, v1
v_min_u32 v5, 143, v5
v_lshlrev_b32 v22, 3, v5
v_add_u32 v5, s50, v5
v_max_i32 v5, 0, v5
v_lshlrev_b32 v5, 3, v5
buffer_load_dwordx2 v[36:37], v5, s[20:23], 0 offen sc1
s_mov_b32 s62, 4
s_branch Lste_84
Lst4_83:
s_mov_b32 s62, 2
s_branch Lste_84
Lst2_82:
s_waitcnt vmcnt(0)
v_add_u32 v20, 147456, v20
ds_write_b64 v20, v[32:33]
v_add_u32 v21, 147456, v21
ds_write_b64 v21, v[34:35]
v_add_u32 v22, 147456, v22
ds_write_b64 v22, v[36:37]
s_waitcnt lgkmcnt(0)
s_mov_b32 s62, 3
Lste_84:
s_branch Lst_14_0
Lwr_169:
s_barrier
s_cmp_eq_u32 s62, 3
s_cbranch_scc1 Lste_89
s_cmp_ge_u32 s62, 5
s_cbranch_scc1 Lg_94
s_cmp_ge_u32 s62, 2
s_cbranch_scc1 Lst2_88
s_cmp_eq_u32 s62, 1
s_cbranch_scc1 Lst1_87
s_mov_b32 s41, 0x40000
Lz0_90:
s_waitcnt vmcnt(0)
v_readfirstlane_b32 s54, v6
s_cmp_eq_u32 s54, 0
s_cbranch_scc0 Lzok_91
buffer_load_dword v6, v4, s[56:59], 0 offen sc1
s_sub_u32 s41, s41, 1
s_cmp_lg_u32 s41, 0
s_cbranch_scc1 Lz0_90
s_waitcnt lgkmcnt(0)
Lzok_91:
s_add_u32 s7, s34, 64
s_lshl_b32 s7, s7, 7
v_mov_b32 v5, s7
v_mov_b32 v6, 1
s_mov_b64 exec, 1
buffer_atomic_add v6, v5, s[84:87], 0 offen sc1
s_mov_b64 exec, -1
Lst1_87:
s_load_dword s54, s[82:83], s52 glc
s_load_dword s55, s[82:83], s53 glc
s_mov_b32 s41, 0x40000
Lpoll_92:
s_waitcnt lgkmcnt(0)
s_and_b32 s54, s54, s55
s_cmp_eq_u32 s54, 16
s_cbranch_scc1 Lg_94
s_load_dword s54, s[82:83], s52 glc
s_load_dword s55, s[82:83], s53 glc
s_sub_u32 s41, s41, 1
s_cmp_lg_u32 s41, 0
s_cbranch_scc1 Lpoll_92
s_waitcnt lgkmcnt(0)
Lg_94:
v_add_u32 v5, 0, v1
v_min_u32 v5, 143, v5
v_lshlrev_b32 v20, 3, v5
v_add_u32 v5, s50, v5
v_max_i32 v5, 0, v5
v_lshlrev_b32 v5, 3, v5
buffer_load_dwordx2 v[32:33], v5, s[20:23], 0 offen sc1
v_add_u32 v5, 64, v1
v_min_u32 v5, 143, v5
v_lshlrev_b32 v21, 3, v5
v_add_u32 v5, s50, v5
v_max_i32 v5, 0, v5
v_lshlrev_b32 v5, 3, v5
buffer_load_dwordx2 v[34:35], v5, s[20:23], 0 offen sc1
v_add_u32 v5, 128, v1
v_min_u32 v5, 143, v5
v_lshlrev_b32 v22, 3, v5
v_add_u32 v5, s50, v5
v_max_i32 v5, 0, v5
v_lshlrev_b32 v5, 3, v5
buffer_load_dwordx2 v[36:37], v5, s[20:23], 0 offen sc1
Lst2_88:
s_waitcnt vmcnt(0)
v_add_u32 v20, 147456, v20
ds_write_b64 v20, v[32:33]
v_add_u32 v21, 147456, v21
ds_write_b64 v21, v[34:35]
v_add_u32 v22, 147456, v22
ds_write_b64 v22, v[36:37]
s_waitcnt lgkmcnt(0)
Lste_89:
s_lshl_b32 s43, s35, 7
s_add_u32 s28, s68, s43
s_addc_u32 s29, s69, 0
s_mov_b32 s30, 2095232
s_mov_b32 s31, 0x20000
v_lshrrev_b32 v15, 3, v1
v_and_b32 v16, 6, v15
v_and_b32 v7, 7, v1
v_xor_b32 v7, v7, v16
v_lshlrev_b32 v7, 4, v7
v_mul_u32_u24 v15, 2048, v15
v_add_u32 v7, v7, v15
s_and_b32 s40, s36, 3
s_lshl_b32 s39, s40, 13
s_add_u32 s40, s40, s35
s_add_u32 s42, s40, 0
s_and_b32 s42, s42, 15
s_lshl_b32 s42, s42, 17
s_add_u32 m0, s39, 65536
s_add_u32 s43, s42, 0
buffer_load_dwordx4 v7, s[28:31], s43 offen lds
s_add_u32 m0, s39, 66560
s_add_u32 s43, s42, 16384
buffer_load_dwordx4 v7, s[28:31], s43 offen lds
s_add_u32 m0, s39, 67584
s_add_u32 s43, s42, 32768
buffer_load_dwordx4 v7, s[28:31], s43 offen lds
s_add_u32 m0, s39, 68608
s_add_u32 s43, s42, 49152
buffer_load_dwordx4 v7, s[28:31], s43 offen lds
s_add_u32 m0, s39, 69632
s_add_u32 s43, s42, 65536
buffer_load_dwordx4 v7, s[28:31], s43 offen lds
s_add_u32 m0, s39, 70656
s_add_u32 s43, s42, 81920
buffer_load_dwordx4 v7, s[28:31], s43 offen lds
s_add_u32 m0, s39, 71680
s_add_u32 s43, s42, 98304
buffer_load_dwordx4 v7, s[28:31], s43 offen lds
s_add_u32 m0, s39, 72704
s_add_u32 s43, s42, 114688
buffer_load_dwordx4 v7, s[28:31], s43 offen lds
s_bitcmp0_b32 s2, 0
s_cselect_b32 s88, s72, s74
s_cselect_b32 s89, s73, s75
s_cmp_lt_u32 s2, 192
s_cselect_b32 s90, 7340032, 0
s_mov_b32 s91, 0x20000
s_bfe_u32 s44, s2, 0x30001
s_lshl_b32 s44, s44, 2
s_and_b32 s43, s36, 3
s_add_u32 s44, s44, s43
s_lshl_b32 s44, s44, 5
v_lshrrev_b32 v18, 4, v1
v_add_u32 v18, s44, v18
v_mul_u32_u24 v18, 7168, v18
v_and_b32 v19, 15, v1
v_lshl_add_u32 v18, v19, 4, v18
s_lshr_b32 s43, s2, 4
s_lshl_b32 s43, s43, 8
s_add_u32 s43, s43, 4096
v_add_u32 v18, s43, v18
s_mov_b32 s43, 0
buffer_load_dwordx4 v[128:131], v18, s[88:91], s43 offen
s_mov_b32 s43, 28672
buffer_load_dwordx4 v[132:135], v18, s[88:91], s43 offen
s_mov_b32 s43, 57344
buffer_load_dwordx4 v[136:139], v18, s[88:91], s43 offen
s_mov_b32 s43, 86016
buffer_load_dwordx4 v[140:143], v18, s[88:91], s43 offen
s_mov_b32 s43, 114688
buffer_load_dwordx4 v[144:147], v18, s[88:91], s43 offen
s_mov_b32 s43, 143360
buffer_load_dwordx4 v[148:151], v18, s[88:91], s43 offen
s_mov_b32 s43, 172032
buffer_load_dwordx4 v[152:155], v18, s[88:91], s43 offen
s_mov_b32 s43, 200704
buffer_load_dwordx4 v[156:159], v18, s[88:91], s43 offen
s_barrier
Latts:
Lats_6:
s_and_b32 s43, s36, 1
s_bfe_u32 s44, s36, 0x10001
s_lshr_b32 s45, s36, 2
v_lshlrev_b32 v14, 2, v13
v_sub_u32 v14, v12, v14
v_mov_b32 v16, 0xff800000
s_or_b32 s46, s34, s45
s_cmp_lg_u32 s46, 0
s_cselect_b32 s46, 0, 0xff800000
v_subrev_u32 v15, 0, v14
v_cmp_ge_u32 vcc, 7, v15
v_add_u32 v15, 16, v15
s_nop 0
v_cndmask_b32 v248, v16, 0, vcc
v_cmp_ge_u32 vcc, 7, v15
s_nop 1
v_cndmask_b32 v244, v16, 0, vcc
v_or_b32 v240, s46, v244
v_subrev_u32 v15, 1, v14
v_cmp_ge_u32 vcc, 7, v15
v_add_u32 v15, 16, v15
s_nop 0
v_cndmask_b32 v249, v16, 0, vcc
v_cmp_ge_u32 vcc, 7, v15
s_nop 1
v_cndmask_b32 v245, v16, 0, vcc
v_or_b32 v241, s46, v245
v_subrev_u32 v15, 2, v14
v_cmp_ge_u32 vcc, 7, v15
v_add_u32 v15, 16, v15
s_nop 0
v_cndmask_b32 v250, v16, 0, vcc
v_cmp_ge_u32 vcc, 7, v15
s_nop 1
v_cndmask_b32 v246, v16, 0, vcc
v_or_b32 v242, s46, v246
v_subrev_u32 v15, 3, v14
v_cmp_ge_u32 vcc, 7, v15
v_add_u32 v15, 16, v15
s_nop 0
v_cndmask_b32 v251, v16, 0, vcc
v_cmp_ge_u32 vcc, 7, v15
s_nop 1
v_cndmask_b32 v247, v16, 0, vcc
v_or_b32 v243, s46, v247
s_lshl_b32 s46, s45, 6
s_add_u32 s46, s46, s44
s_add_u32 s46, s46, 16
v_lshl_add_u32 v14, v12, 1, s46
s_lshl_b32 s47, s43, 6
v_lshl_add_u32 v15, v13, 4, s47
v_mul_u32_u24 v20, 400, v14
v_add_u32 v20, v20, v15
v_subrev_u32 v16, 32, v14
v_max_i32 v16, 0, v16
v_mul_u32_u24 v21, 400, v16
v_add_u32 v21, v21, v15
v_lshrrev_b32 v16, 2, v12
v_lshl_add_u32 v16, v13, 2, v16
v_lshl_add_u32 v16, v16, 1, s46
v_and_b32 v17, 3, v1
v_lshl_add_u32 v17, v17, 3, s47
v_mul_u32_u24 v22, 400, v16
v_add_u32 v22, v22, v17
v_subrev_u32 v16, 32, v16
v_max_i32 v16, 0, v16
v_mul_u32_u24 v23, 400, v16
v_add_u32 v23, v23, v17
s_mul_i32 s60, s34, 262144
s_add_u32 s16, s82, s60
s_addc_u32 s17, s83, 0
s_mov_b32 s18, 262144
s_mov_b32 s19, 0x20000
s_lshl_b32 s60, s35, 14
s_lshl_b32 s43, s43, 13
s_add_u32 s60, s60, s43
s_lshl_b32 s43, s45, 12
s_add_u32 s60, s60, s43
s_lshl_b32 s43, s44, 10
s_add_u32 s60, s60, s43
v_lshlrev_b32 v24, 4, v1
s_mov_b32 s61, 0x3e8293ee
s_lshl_b32 s38, s35, 7
Latt_5:
s_barrier
ds_read_b128 v[32:35], v20 offset:0
ds_read_b128 v[36:39], v20 offset:128
ds_read_b128 v[40:43], v21 offset:128
ds_read_b128 v[80:83], v20 offset:12800
ds_read_b128 v[84:87], v20 offset:12928
ds_read_b128 v[88:91], v20 offset:128
ds_read_b64_tr_b16 v[44:45], v23 offset:256
ds_read_b64_tr_b16 v[46:47], v22 offset:256
ds_read_b64_tr_b16 v[48:49], v23 offset:288
ds_read_b64_tr_b16 v[50:51], v22 offset:288
ds_read_b64_tr_b16 v[92:93], v22 offset:256
ds_read_b64_tr_b16 v[94:95], v22 offset:13056
ds_read_b64_tr_b16 v[96:97], v22 offset:288
ds_read_b64_tr_b16 v[98:99], v22 offset:13088
s_waitcnt lgkmcnt(11)
v_mfma_f32_16x16x32_bf16 v[52:55], v[40:43], v[32:35], v[240:243]
v_mfma_f32_16x16x32_bf16 v[56:59], v[36:39], v[32:35], v[248:251]
s_waitcnt lgkmcnt(8)
v_mfma_f32_16x16x32_bf16 v[100:103], v[88:91], v[80:83], v[244:247]
v_mfma_f32_16x16x32_bf16 v[104:107], v[84:87], v[80:83], v[248:251]
s_nop 5
v_max3_f32 v60, v52, v53, v54
v_max3_f32 v108, v100, v101, v102
v_max3_f32 v61, v55, v56, v57
v_max3_f32 v109, v103, v104, v105
v_max3_f32 v60, v60, v58, v59
v_max3_f32 v108, v108, v106, v107
v_max_f32 v60, v60, v61
v_max_f32 v108, v108, v109
s_nop 1
v_permlane32_swap_b32 v60, v108
v_max_f32 v60, v60, v108
v_mov_b32 v61, v60
s_nop 1
v_permlane16_swap_b32 v60, v61
v_max_f32 v60, v60, v61
v_mul_f32 v60, s61, v60
s_nop 0
v_mov_b32 v108, v60
s_nop 1
v_permlane32_swap_b32 v60, v108
v_fma_f32 v52, v52, s61, -v60
v_fma_f32 v100, v100, s61, -v108
v_fma_f32 v53, v53, s61, -v60
v_fma_f32 v101, v101, s61, -v108
v_fma_f32 v54, v54, s61, -v60
v_fma_f32 v102, v102, s61, -v108
v_fma_f32 v55, v55, s61, -v60
v_fma_f32 v103, v103, s61, -v108
v_fma_f32 v56, v56, s61, -v60
v_fma_f32 v104, v104, s61, -v108
v_fma_f32 v57, v57, s61, -v60
v_fma_f32 v105, v105, s61, -v108
v_fma_f32 v58, v58, s61, -v60
v_fma_f32 v106, v106, s61, -v108
v_fma_f32 v59, v59, s61, -v60
v_fma_f32 v107, v107, s61, -v108
v_exp_f32 v52, v52
v_exp_f32 v100, v100
v_exp_f32 v53, v53
v_exp_f32 v101, v101
v_exp_f32 v54, v54
v_exp_f32 v102, v102
v_exp_f32 v55, v55
v_exp_f32 v103, v103
v_exp_f32 v56, v56
v_exp_f32 v104, v104
v_exp_f32 v57, v57
v_exp_f32 v105, v105
v_exp_f32 v58, v58
v_exp_f32 v106, v106
v_exp_f32 v59, v59
v_exp_f32 v107, v107
v_cvt_pk_bf16_f32 v64, v52, v53
v_cvt_pk_bf16_f32 v112, v100, v101
v_cvt_pk_bf16_f32 v65, v54, v55
v_cvt_pk_bf16_f32 v113, v102, v103
v_cvt_pk_bf16_f32 v66, v56, v57
v_cvt_pk_bf16_f32 v114, v104, v105
v_cvt_pk_bf16_f32 v67, v58, v59
v_cvt_pk_bf16_f32 v115, v106, v107
v_pk_add_f32 v[52:53], v[52:53], v[54:55]
v_pk_add_f32 v[100:101], v[100:101], v[102:103]
v_pk_add_f32 v[56:57], v[56:57], v[58:59]
v_pk_add_f32 v[104:105], v[104:105], v[106:107]
s_waitcnt lgkmcnt(0)
s_waitcnt lgkmcnt(0)
v_mfma_f32_16x16x32_bf16 v[68:71], v[44:47], v[64:67], 0
v_mfma_f32_16x16x32_bf16 v[116:119], v[92:95], v[112:115], 0
v_mfma_f32_16x16x32_bf16 v[72:75], v[48:51], v[64:67], 0
v_mfma_f32_16x16x32_bf16 v[120:123], v[96:99], v[112:115], 0
v_pk_add_f32 v[52:53], v[52:53], v[56:57]
v_pk_add_f32 v[100:101], v[100:101], v[104:105]
v_add_f32 v60, v52, v53
v_add_f32 v108, v100, v101
s_nop 1
v_permlane32_swap_b32 v60, v108
v_add_f32 v60, v60, v108
v_mov_b32 v61, v60
s_nop 1
v_permlane16_swap_b32 v60, v61
v_add_f32 v60, v60, v61
v_rcp_f32 v60, v60
s_nop 0
v_mov_b32 v108, v60
s_nop 1
v_permlane32_swap_b32 v60, v108
v_pk_mul_f32 v[68:69], v[60:61], v[68:69] op_sel_hi:[0,1]
v_pk_mul_f32 v[116:117], v[108:109], v[116:117] op_sel_hi:[0,1]
v_pk_mul_f32 v[70:71], v[60:61], v[70:71] op_sel_hi:[0,1]
v_pk_mul_f32 v[118:119], v[108:109], v[118:119] op_sel_hi:[0,1]
v_pk_mul_f32 v[72:73], v[60:61], v[72:73] op_sel_hi:[0,1]
v_pk_mul_f32 v[120:121], v[108:109], v[120:121] op_sel_hi:[0,1]
v_pk_mul_f32 v[74:75], v[60:61], v[74:75] op_sel_hi:[0,1]
v_pk_mul_f32 v[122:123], v[108:109], v[122:123] op_sel_hi:[0,1]
v_cvt_pk_bf16_f32 v64, v68, v69
v_cvt_pk_bf16_f32 v112, v116, v117
v_cvt_pk_bf16_f32 v65, v70, v71
v_cvt_pk_bf16_f32 v113, v118, v119
v_cvt_pk_bf16_f32 v66, v72, v73
v_cvt_pk_bf16_f32 v114, v120, v121
v_cvt_pk_bf16_f32 v67, v74, v75
v_cvt_pk_bf16_f32 v115, v122, v123
buffer_store_dwordx4 v[64:67], v24, s[16:19], s60 offen offset:0 sc1
buffer_store_dwordx4 v[112:115], v24, s[16:19], s60 offen offset:2048 sc1
s_add_u32 s56, s82, 28311552
s_addc_u32 s57, s83, 0
s_mov_b32 s58, 114688
s_mov_b32 s59, 0x20000
s_lshl_b32 s7, s34, 12
s_add_u32 s7, s7, 49152
v_lshl_add_u32 v26, v1, 8, s7
v_mov_b32 v27, 1
s_cmp_ge_u32 s36, 4
s_cbranch_scc1 Lh_96
s_waitcnt vmcnt(0)
s_branch Lo_95
Lh_96:
s_add_u32 s28, s68, s38
s_addc_u32 s29, s69, 0
s_mov_b32 s30, 2095232
s_mov_b32 s31, 0x20000
s_add_u32 s42, s40, 4
s_and_b32 s42, s42, 15
s_lshl_b32 s42, s42, 17
s_add_u32 m0, s39, 114688
s_add_u32 s43, s42, 0
buffer_load_dwordx4 v7, s[28:31], s43 offen lds
s_add_u32 m0, s39, 115712
s_add_u32 s43, s42, 16384
buffer_load_dwordx4 v7, s[28:31], s43 offen lds
s_add_u32 m0, s39, 116736
s_add_u32 s43, s42, 32768
buffer_load_dwordx4 v7, s[28:31], s43 offen lds
s_add_u32 m0, s39, 117760
s_add_u32 s43, s42, 49152
buffer_load_dwordx4 v7, s[28:31], s43 offen lds
s_add_u32 m0, s39, 118784
s_add_u32 s43, s42, 65536
buffer_load_dwordx4 v7, s[28:31], s43 offen lds
s_add_u32 m0, s39, 119808
s_add_u32 s43, s42, 81920
buffer_load_dwordx4 v7, s[28:31], s43 offen lds
s_add_u32 m0, s39, 120832
s_add_u32 s43, s42, 98304
buffer_load_dwordx4 v7, s[28:31], s43 offen lds
s_add_u32 m0, s39, 121856
s_add_u32 s43, s42, 114688
buffer_load_dwordx4 v7, s[28:31], s43 offen lds
s_waitcnt vmcnt(8)
Lo_95:
s_cmp_lg_u32 s36, 0
s_barrier
s_cbranch_scc1 Lsig_97
s_mov_b64 exec, 0xffff
buffer_atomic_add v27, v26, s[56:59], 0 offen sc1
s_mov_b64 exec, -1
Lsig_97:
s_cmp_ge_u32 s36, 4
s_cbranch_scc1 Lprod_99
v_and_b32 v12, 15, v1
v_lshrrev_b32 v13, 4, v1
v_lshlrev_b32 v10, 12, v12
v_and_b32 v14, 1, v13
v_lshl_add_u32 v10, v14, 5, v10
v_lshrrev_b32 v14, 1, v13
v_lshl_add_u32 v10, v14, 4, v10
s_lshl_b32 s43, s34, 18
s_lshl_b32 s44, s36, 16
s_add_u32 s43, s43, s44
s_lshl_b32 s44, s35, 7
s_add_u32 s43, s43, s44
buffer_load_dwordx4 v[128:131], v10, s[8:11], s43 offen offset:0
buffer_load_dwordx4 v[132:135], v10, s[8:11], s43 offen offset:64
buffer_load_dwordx4 v[136:139], v10, s[8:11], s43 offen offset:2048
buffer_load_dwordx4 v[140:143], v10, s[8:11], s43 offen offset:2112
v_and_b32 v12, 15, v1
v_lshrrev_b32 v13, 4, v1
s_mul_i32 s43, s34, 262144
s_add_u32 s20, s82, s43
s_addc_u32 s21, s83, 0
s_add_u32 s20, s20, 4194304
s_addc_u32 s21, s21, 0
s_mov_b32 s22, 262144
s_mov_b32 s23, 0x20000
s_mul_i32 s43, s34, 16384
s_add_u32 s24, s82, s43
s_addc_u32 s25, s83, 0
s_add_u32 s24, s24, 25165824
s_addc_u32 s25, s25, 0
s_mov_b32 s26, 16384
s_mov_b32 s27, 0x20000
v_lshlrev_b32 v11, 4, v1
s_lshl_b32 s43, s36, 11
v_add_u32 v2, s43, v11
v_add_u32 v3, 98304, v2
v_lshrrev_b32 v14, 2, v1
v_bfe_u32 v15, v14, 1, 2
v_mul_u32_u24 v14, 128, v14
v_lshl_add_u32 v14, v15, 5, v14
v_and_b32 v15, 3, v1
v_lshl_add_u32 v4, v15, 3, v14
v_xor_b32 v5, 32, v4
v_xor_b32 v6, 64, v4
v_xor_b32 v7, 96, v4
v_add_u32 v16, 0x10000, v4
v_add_u32 v20, 0x20000, v4
v_add_u32 v17, 0x10000, v5
v_add_u32 v21, 0x20000, v5
v_add_u32 v18, 0x10000, v6
v_add_u32 v22, 0x20000, v6
v_add_u32 v19, 0x10000, v7
v_add_u32 v23, 0x20000, v7
s_lshl_b32 s44, s35, 14
s_add_u32 s60, s44, s43
v_lshrrev_b32 v14, 1, v13
v_lshlrev_b32 v14, 11, v14
v_lshl_add_u32 v14, v12, 3, v14
v_and_b32 v15, 1, v13
v_lshl_add_u32 v14, v15, 2, v14
s_lshl_b32 s43, s36, 12
s_lshl_b32 s44, s35, 7
s_add_u32 s43, s43, s44
v_add_u32 v9, s43, v14
s_mov_b32 s61, 0x3f803f80
s_waitcnt vmcnt(0)
v_permlane16_swap_b32 v128, v130
v_permlane16_swap_b32 v129, v131
v_permlane16_swap_b32 v132, v134
v_permlane16_swap_b32 v133, v135
v_permlane16_swap_b32 v136, v138
v_permlane16_swap_b32 v137, v139
v_permlane16_swap_b32 v140, v142
v_permlane16_swap_b32 v141, v143
v_lshlrev_b32 v96, 16, v128
v_and_b32 v97, 0xffff0000, v128
v_lshlrev_b32 v98, 16, v129
v_and_b32 v99, 0xffff0000, v129
v_lshlrev_b32 v100, 16, v130
v_and_b32 v101, 0xffff0000, v130
v_lshlrev_b32 v102, 16, v131
v_and_b32 v103, 0xffff0000, v131
v_lshlrev_b32 v104, 16, v132
v_and_b32 v105, 0xffff0000, v132
v_lshlrev_b32 v106, 16, v133
v_and_b32 v107, 0xffff0000, v133
v_lshlrev_b32 v108, 16, v134
v_and_b32 v109, 0xffff0000, v134
v_lshlrev_b32 v110, 16, v135
v_and_b32 v111, 0xffff0000, v135
v_lshlrev_b32 v112, 16, v136
v_and_b32 v113, 0xffff0000, v136
v_lshlrev_b32 v114, 16, v137
v_and_b32 v115, 0xffff0000, v137
v_lshlrev_b32 v116, 16, v138
v_and_b32 v117, 0xffff0000, v138
v_lshlrev_b32 v118, 16, v139
v_and_b32 v119, 0xffff0000, v139
v_lshlrev_b32 v120, 16, v140
v_and_b32 v121, 0xffff0000, v140
v_lshlrev_b32 v122, 16, v141
v_and_b32 v123, 0xffff0000, v141
v_lshlrev_b32 v124, 16, v142
v_and_b32 v125, 0xffff0000, v142
v_lshlrev_b32 v126, 16, v143
v_and_b32 v127, 0xffff0000, v143
s_barrier
ds_read_b128 v[32:35], v2 offset:0
ds_read_b64_tr_b16 v[40:41], v16 offset:0
ds_read_b64_tr_b16 v[42:43], v16 offset:2048
ds_read_b64_tr_b16 v[44:45], v17 offset:0
ds_read_b64_tr_b16 v[46:47], v17 offset:2048
ds_read_b64_tr_b16 v[48:49], v18 offset:0
ds_read_b64_tr_b16 v[50:51], v18 offset:2048
ds_read_b64_tr_b16 v[52:53], v19 offset:0
ds_read_b64_tr_b16 v[54:55], v19 offset:2048
ds_read_b128 v[36:39], v2 offset:1024
ds_read_b128 v[56:59], v2 offset:8192
ds_read_b64_tr_b16 v[64:65], v16 offset:4096
ds_read_b64_tr_b16 v[66:67], v16 offset:6144
ds_read_b64_tr_b16 v[68:69], v17 offset:4096
ds_read_b64_tr_b16 v[70:71], v17 offset:6144
ds_read_b64_tr_b16 v[72:73], v18 offset:4096
ds_read_b64_tr_b16 v[74:75], v18 offset:6144
ds_read_b64_tr_b16 v[76:77], v19 offset:4096
ds_read_b64_tr_b16 v[78:79], v19 offset:6144
ds_read_b128 v[60:63], v2 offset:9216
s_waitcnt lgkmcnt(0)
s_barrier
v_mfma_f32_16x16x32_bf16 v[96:99], v[40:43], v[32:35], v[96:99]
ds_read_b128 v[144:147], v2 offset:49152
ds_read_b64_tr_b16 v[152:153], v16 offset:8192
v_mfma_f32_16x16x32_bf16 v[100:103], v[44:47], v[32:35], v[100:103]
ds_read_b64_tr_b16 v[154:155], v16 offset:10240
ds_read_b64_tr_b16 v[156:157], v17 offset:8192
v_mfma_f32_16x16x32_bf16 v[104:107], v[48:51], v[32:35], v[104:107]
ds_read_b64_tr_b16 v[158:159], v17 offset:10240
ds_read_b64_tr_b16 v[160:161], v18 offset:8192
v_mfma_f32_16x16x32_bf16 v[108:111], v[52:55], v[32:35], v[108:111]
ds_read_b64_tr_b16 v[162:163], v18 offset:10240
ds_read_b64_tr_b16 v[164:165], v19 offset:8192
v_mfma_f32_16x16x32_bf16 v[124:127], v[52:55], v[36:39], v[124:127]
ds_read_b64_tr_b16 v[166:167], v19 offset:10240
ds_read_b128 v[148:151], v2 offset:50176
v_mfma_f32_16x16x32_bf16 v[120:123], v[48:51], v[36:39], v[120:123]
ds_read_b128 v[168:171], v2 offset:57344
ds_read_b64_tr_b16 v[176:177], v16 offset:12288
v_mfma_f32_16x16x32_bf16 v[116:119], v[44:47], v[36:39], v[116:119]
ds_read_b64_tr_b16 v[178:179], v16 offset:14336
ds_read_b64_tr_b16 v[180:181], v17 offset:12288
v_mfma_f32_16x16x32_bf16 v[112:115], v[40:43], v[36:39], v[112:115]
ds_read_b64_tr_b16 v[182:183], v17 offset:14336
ds_read_b64_tr_b16 v[184:185], v18 offset:12288
v_mfma_f32_16x16x32_bf16 v[96:99], v[64:67], v[56:59], v[96:99]
ds_read_b64_tr_b16 v[186:187], v18 offset:14336
ds_read_b64_tr_b16 v[188:189], v19 offset:12288
v_mfma_f32_16x16x32_bf16 v[100:103], v[68:71], v[56:59], v[100:103]
ds_read_b64_tr_b16 v[190:191], v19 offset:14336
ds_read_b128 v[172:175], v2 offset:58368
v_mfma_f32_16x16x32_bf16 v[104:107], v[72:75], v[56:59], v[104:107]
s_bitcmp0_b32 s36, 1
v_mfma_f32_16x16x32_bf16 v[108:111], v[76:79], v[56:59], v[108:111]
s_cselect_b32 s44, s72, s74
v_mfma_f32_16x16x32_bf16 v[124:127], v[76:79], v[60:63], v[124:127]
s_cselect_b32 s45, s73, s75
v_mfma_f32_16x16x32_bf16 v[120:123], v[72:75], v[60:63], v[120:123]
s_mul_i32 s43, s35, 192
s_branch Lov_5
.p2align 12
.fill 32, 4, 0xbf800000
Lst_5_0:
s_branch Lwr_160
s_nop 0
s_nop 0
Lov_5:
v_mfma_f32_16x16x32_bf16 v[116:119], v[68:71], v[60:63], v[116:119]
s_add_u32 s16, s44, s43
v_mfma_f32_16x16x32_bf16 v[112:115], v[64:67], v[60:63], v[112:115]
s_addc_u32 s17, s45, 0
s_waitcnt lgkmcnt(0)
s_barrier
v_mfma_f32_16x16x32_bf16 v[96:99], v[152:155], v[144:147], v[96:99]
ds_read_b128 v[32:35], v3 offset:0
ds_read_b64_tr_b16 v[40:41], v16 offset:16384
v_mfma_f32_16x16x32_bf16 v[100:103], v[156:159], v[144:147], v[100:103]
ds_read_b64_tr_b16 v[42:43], v16 offset:18432
ds_read_b64_tr_b16 v[44:45], v17 offset:16384
v_mfma_f32_16x16x32_bf16 v[104:107], v[160:163], v[144:147], v[104:107]
ds_read_b64_tr_b16 v[46:47], v17 offset:18432
ds_read_b64_tr_b16 v[48:49], v18 offset:16384
v_mfma_f32_16x16x32_bf16 v[108:111], v[164:167], v[144:147], v[108:111]
ds_read_b64_tr_b16 v[50:51], v18 offset:18432
ds_read_b64_tr_b16 v[52:53], v19 offset:16384
v_mfma_f32_16x16x32_bf16 v[124:127], v[164:167], v[148:151], v[124:127]
ds_read_b64_tr_b16 v[54:55], v19 offset:18432
ds_read_b128 v[36:39], v3 offset:1024
v_mfma_f32_16x16x32_bf16 v[120:123], v[160:163], v[148:151], v[120:123]
ds_read_b128 v[56:59], v3 offset:8192
ds_read_b64_tr_b16 v[64:65], v16 offset:20480
v_mfma_f32_16x16x32_bf16 v[116:119], v[156:159], v[148:151], v[116:119]
ds_read_b64_tr_b16 v[66:67], v16 offset:22528
ds_read_b64_tr_b16 v[68:69], v17 offset:20480
v_mfma_f32_16x16x32_bf16 v[112:115], v[152:155], v[148:151], v[112:115]
ds_read_b64_tr_b16 v[70:71], v17 offset:22528
ds_read_b64_tr_b16 v[72:73], v18 offset:20480
v_mfma_f32_16x16x32_bf16 v[96:99], v[176:179], v[168:171], v[96:99]
ds_read_b64_tr_b16 v[74:75], v18 offset:22528
ds_read_b64_tr_b16 v[76:77], v19 offset:20480
v_mfma_f32_16x16x32_bf16 v[100:103], v[180:183], v[168:171], v[100:103]
ds_read_b64_tr_b16 v[78:79], v19 offset:22528
ds_read_b128 v[60:63], v3 offset:9216
v_mfma_f32_16x16x32_bf16 v[104:107], v[184:187], v[168:171], v[104:107]
s_add_u32 s16, s16, 4096
v_mfma_f32_16x16x32_bf16 v[108:111], v[188:191], v[168:171], v[108:111]
s_addc_u32 s17, s17, 0
v_mfma_f32_16x16x32_bf16 v[124:127], v[188:191], v[172:175], v[124:127]
s_mov_b32 s18, 7333056
v_mfma_f32_16x16x32_bf16 v[120:123], v[184:187], v[172:175], v[120:123]
s_mov_b32 s19, 0x20000
v_mfma_f32_16x16x32_bf16 v[116:119], v[180:183], v[172:175], v[116:119]
s_and_b32 s43, s36, 1
v_mfma_f32_16x16x32_bf16 v[112:115], v[176:179], v[172:175], v[112:115]
s_mul_i32 s43, s43, 229376
s_waitcnt lgkmcnt(0)
s_barrier
v_mfma_f32_16x16x32_bf16 v[96:99], v[40:43], v[32:35], v[96:99]
ds_read_b128 v[144:147], v3 offset:49152
ds_read_b64_tr_b16 v[152:153], v16 offset:24576
v_mfma_f32_16x16x32_bf16 v[100:103], v[44:47], v[32:35], v[100:103]
ds_read_b64_tr_b16 v[154:155], v16 offset:26624
ds_read_b64_tr_b16 v[156:157], v17 offset:24576
v_mfma_f32_16x16x32_bf16 v[104:107], v[48:51], v[32:35], v[104:107]
ds_read_b64_tr_b16 v[158:159], v17 offset:26624
ds_read_b64_tr_b16 v[160:161], v18 offset:24576
v_mfma_f32_16x16x32_bf16 v[108:111], v[52:55], v[32:35], v[108:111]
ds_read_b64_tr_b16 v[162:163], v18 offset:26624
ds_read_b64_tr_b16 v[164:165], v19 offset:24576
v_mfma_f32_16x16x32_bf16 v[124:127], v[52:55], v[36:39], v[124:127]
ds_read_b64_tr_b16 v[166:167], v19 offset:26624
ds_read_b128 v[148:151], v3 offset:50176
v_mfma_f32_16x16x32_bf16 v[120:123], v[48:51], v[36:39], v[120:123]
ds_read_b128 v[168:171], v3 offset:57344
ds_read_b64_tr_b16 v[176:177], v16 offset:28672
v_mfma_f32_16x16x32_bf16 v[116:119], v[44:47], v[36:39], v[116:119]
ds_read_b64_tr_b16 v[178:179], v16 offset:30720
ds_read_b64_tr_b16 v[180:181], v17 offset:28672
v_mfma_f32_16x16x32_bf16 v[112:115], v[40:43], v[36:39], v[112:115]
ds_read_b64_tr_b16 v[182:183], v17 offset:30720
ds_read_b64_tr_b16 v[184:185], v18 offset:28672
v_mfma_f32_16x16x32_bf16 v[96:99], v[64:67], v[56:59], v[96:99]
ds_read_b64_tr_b16 v[186:187], v18 offset:30720
ds_read_b64_tr_b16 v[188:189], v19 offset:28672
v_mfma_f32_16x16x32_bf16 v[100:103], v[68:71], v[56:59], v[100:103]
ds_read_b64_tr_b16 v[190:191], v19 offset:30720
ds_read_b128 v[172:175], v3 offset:58368
v_mfma_f32_16x16x32_bf16 v[104:107], v[72:75], v[56:59], v[104:107]
v_add_u32 v196, 0, v1
v_mfma_f32_16x16x32_bf16 v[108:111], v[76:79], v[56:59], v[108:111]
v_mul_u32_u24 v197, 5462, v196
v_mfma_f32_16x16x32_bf16 v[124:127], v[76:79], v[60:63], v[124:127]
v_lshrrev_b32 v197, 16, v197
v_mfma_f32_16x16x32_bf16 v[120:123], v[72:75], v[60:63], v[120:123]
v_mul_u32_u24 v198, 12, v197
v_mfma_f32_16x16x32_bf16 v[116:119], v[68:71], v[60:63], v[116:119]
v_sub_u32 v198, v196, v198
v_mfma_f32_16x16x32_bf16 v[112:115], v[64:67], v[60:63], v[112:115]
v_bfe_u32 v199, v197, 2, 1
s_waitcnt lgkmcnt(0)
s_barrier
v_mfma_f32_16x16x32_bf16 v[96:99], v[152:155], v[144:147], v[96:99]
ds_read_b128 v[32:35], v2 offset:0
ds_read_b64_tr_b16 v[40:41], v16 offset:49152
v_mfma_f32_16x16x32_bf16 v[100:103], v[156:159], v[144:147], v[100:103]
ds_read_b64_tr_b16 v[42:43], v16 offset:51200
ds_read_b64_tr_b16 v[44:45], v17 offset:49152
v_mfma_f32_16x16x32_bf16 v[104:107], v[160:163], v[144:147], v[104:107]
ds_read_b64_tr_b16 v[46:47], v17 offset:51200
ds_read_b64_tr_b16 v[48:49], v18 offset:49152
v_mfma_f32_16x16x32_bf16 v[108:111], v[164:167], v[144:147], v[108:111]
ds_read_b64_tr_b16 v[50:51], v18 offset:51200
ds_read_b64_tr_b16 v[52:53], v19 offset:49152
v_mfma_f32_16x16x32_bf16 v[124:127], v[164:167], v[148:151], v[124:127]
ds_read_b64_tr_b16 v[54:55], v19 offset:51200
ds_read_b128 v[36:39], v2 offset:1024
v_mfma_f32_16x16x32_bf16 v[120:123], v[160:163], v[148:151], v[120:123]
ds_read_b128 v[56:59], v2 offset:8192
ds_read_b64_tr_b16 v[64:65], v16 offset:53248
v_mfma_f32_16x16x32_bf16 v[116:119], v[156:159], v[148:151], v[116:119]
ds_read_b64_tr_b16 v[66:67], v16 offset:55296
ds_read_b64_tr_b16 v[68:69], v17 offset:53248
v_mfma_f32_16x16x32_bf16 v[112:115], v[152:155], v[148:151], v[112:115]
ds_read_b64_tr_b16 v[70:71], v17 offset:55296
ds_read_b64_tr_b16 v[72:73], v18 offset:53248
v_mfma_f32_16x16x32_bf16 v[96:99], v[176:179], v[168:171], v[96:99]
ds_read_b64_tr_b16 v[74:75], v18 offset:55296
ds_read_b64_tr_b16 v[76:77], v19 offset:53248
v_mfma_f32_16x16x32_bf16 v[100:103], v[180:183], v[168:171], v[100:103]
ds_read_b64_tr_b16 v[78:79], v19 offset:55296
ds_read_b128 v[60:63], v2 offset:9216
v_mfma_f32_16x16x32_bf16 v[104:107], v[184:187], v[168:171], v[104:107]
v_cmp_gt_u32 vcc, 8, v198
v_mfma_f32_16x16x32_bf16 v[108:111], v[188:191], v[168:171], v[108:111]
v_lshlrev_b32 v200, 1, v199
v_mfma_f32_16x16x32_bf16 v[124:127], v[188:191], v[172:175], v[124:127]
v_mul_u32_u24 v197, 7168, v197
v_mfma_f32_16x16x32_bf16 v[120:123], v[184:187], v[172:175], v[120:123]
v_cndmask_b32 v199, v199, v200, vcc
v_mfma_f32_16x16x32_bf16 v[116:119], v[180:183], v[172:175], v[116:119]
v_xor_b32 v198, v198, v199
v_mfma_f32_16x16x32_bf16 v[112:115], v[176:179], v[172:175], v[112:115]
v_lshl_add_u32 v192, v198, 4, v197
s_waitcnt lgkmcnt(0)
s_barrier
v_mfma_f32_16x16x32_bf16 v[96:99], v[40:43], v[32:35], v[96:99]
ds_read_b128 v[144:147], v2 offset:49152
ds_read_b64_tr_b16 v[152:153], v16 offset:57344
v_mfma_f32_16x16x32_bf16 v[100:103], v[44:47], v[32:35], v[100:103]
ds_read_b64_tr_b16 v[154:155], v16 offset:59392
ds_read_b64_tr_b16 v[156:157], v17 offset:57344
v_mfma_f32_16x16x32_bf16 v[104:107], v[48:51], v[32:35], v[104:107]
ds_read_b64_tr_b16 v[158:159], v17 offset:59392
ds_read_b64_tr_b16 v[160:161], v18 offset:57344
v_mfma_f32_16x16x32_bf16 v[108:111], v[52:55], v[32:35], v[108:111]
ds_read_b64_tr_b16 v[162:163], v18 offset:59392
ds_read_b64_tr_b16 v[164:165], v19 offset:57344
v_mfma_f32_16x16x32_bf16 v[124:127], v[52:55], v[36:39], v[124:127]
ds_read_b64_tr_b16 v[166:167], v19 offset:59392
ds_read_b128 v[148:151], v2 offset:50176
v_mfma_f32_16x16x32_bf16 v[120:123], v[48:51], v[36:39], v[120:123]
ds_read_b128 v[168:171], v2 offset:57344
ds_read_b64_tr_b16 v[176:177], v16 offset:61440
v_mfma_f32_16x16x32_bf16 v[116:119], v[44:47], v[36:39], v[116:119]
ds_read_b64_tr_b16 v[178:179], v16 offset:63488
ds_read_b64_tr_b16 v[180:181], v17 offset:61440
v_mfma_f32_16x16x32_bf16 v[112:115], v[40:43], v[36:39], v[112:115]
ds_read_b64_tr_b16 v[182:183], v17 offset:63488
ds_read_b64_tr_b16 v[184:185], v18 offset:61440
v_mfma_f32_16x16x32_bf16 v[96:99], v[64:67], v[56:59], v[96:99]
ds_read_b64_tr_b16 v[186:187], v18 offset:63488
ds_read_b64_tr_b16 v[188:189], v19 offset:61440
v_mfma_f32_16x16x32_bf16 v[100:103], v[68:71], v[56:59], v[100:103]
ds_read_b64_tr_b16 v[190:191], v19 offset:63488
ds_read_b128 v[172:175], v2 offset:58368
v_mfma_f32_16x16x32_bf16 v[104:107], v[72:75], v[56:59], v[104:107]
v_add_u32 v196, 64, v1
v_mfma_f32_16x16x32_bf16 v[108:111], v[76:79], v[56:59], v[108:111]
v_mul_u32_u24 v197, 5462, v196
v_mfma_f32_16x16x32_bf16 v[124:127], v[76:79], v[60:63], v[124:127]
v_lshrrev_b32 v197, 16, v197
v_mfma_f32_16x16x32_bf16 v[120:123], v[72:75], v[60:63], v[120:123]
v_mul_u32_u24 v198, 12, v197
v_mfma_f32_16x16x32_bf16 v[116:119], v[68:71], v[60:63], v[116:119]
v_sub_u32 v198, v196, v198
v_mfma_f32_16x16x32_bf16 v[112:115], v[64:67], v[60:63], v[112:115]
v_bfe_u32 v199, v197, 2, 1
s_waitcnt lgkmcnt(0)
s_barrier
v_mfma_f32_16x16x32_bf16 v[96:99], v[152:155], v[144:147], v[96:99]
ds_read_b128 v[32:35], v3 offset:0
ds_read_b64_tr_b16 v[40:41], v20 offset:0
v_mfma_f32_16x16x32_bf16 v[100:103], v[156:159], v[144:147], v[100:103]
ds_read_b64_tr_b16 v[42:43], v20 offset:2048
ds_read_b64_tr_b16 v[44:45], v21 offset:0
v_mfma_f32_16x16x32_bf16 v[104:107], v[160:163], v[144:147], v[104:107]
ds_read_b64_tr_b16 v[46:47], v21 offset:2048
ds_read_b64_tr_b16 v[48:49], v22 offset:0
v_mfma_f32_16x16x32_bf16 v[108:111], v[164:167], v[144:147], v[108:111]
ds_read_b64_tr_b16 v[50:51], v22 offset:2048
ds_read_b64_tr_b16 v[52:53], v23 offset:0
v_mfma_f32_16x16x32_bf16 v[124:127], v[164:167], v[148:151], v[124:127]
ds_read_b64_tr_b16 v[54:55], v23 offset:2048
ds_read_b128 v[36:39], v3 offset:1024
v_mfma_f32_16x16x32_bf16 v[120:123], v[160:163], v[148:151], v[120:123]
ds_read_b128 v[56:59], v3 offset:8192
ds_read_b64_tr_b16 v[64:65], v20 offset:4096
v_mfma_f32_16x16x32_bf16 v[116:119], v[156:159], v[148:151], v[116:119]
ds_read_b64_tr_b16 v[66:67], v20 offset:6144
ds_read_b64_tr_b16 v[68:69], v21 offset:4096
v_mfma_f32_16x16x32_bf16 v[112:115], v[152:155], v[148:151], v[112:115]
ds_read_b64_tr_b16 v[70:71], v21 offset:6144
ds_read_b64_tr_b16 v[72:73], v22 offset:4096
v_mfma_f32_16x16x32_bf16 v[96:99], v[176:179], v[168:171], v[96:99]
ds_read_b64_tr_b16 v[74:75], v22 offset:6144
ds_read_b64_tr_b16 v[76:77], v23 offset:4096
v_mfma_f32_16x16x32_bf16 v[100:103], v[180:183], v[168:171], v[100:103]
ds_read_b64_tr_b16 v[78:79], v23 offset:6144
ds_read_b128 v[60:63], v3 offset:9216
v_mfma_f32_16x16x32_bf16 v[104:107], v[184:187], v[168:171], v[104:107]
v_cmp_gt_u32 vcc, 8, v198
v_mfma_f32_16x16x32_bf16 v[108:111], v[188:191], v[168:171], v[108:111]
v_lshlrev_b32 v200, 1, v199
v_mfma_f32_16x16x32_bf16 v[124:127], v[188:191], v[172:175], v[124:127]
v_mul_u32_u24 v197, 7168, v197
v_mfma_f32_16x16x32_bf16 v[120:123], v[184:187], v[172:175], v[120:123]
v_cndmask_b32 v199, v199, v200, vcc
v_mfma_f32_16x16x32_bf16 v[116:119], v[180:183], v[172:175], v[116:119]
v_xor_b32 v198, v198, v199
v_mfma_f32_16x16x32_bf16 v[112:115], v[176:179], v[172:175], v[112:115]
v_lshl_add_u32 v193, v198, 4, v197
s_waitcnt lgkmcnt(0)
s_barrier
v_mfma_f32_16x16x32_bf16 v[96:99], v[40:43], v[32:35], v[96:99]
ds_read_b128 v[144:147], v3 offset:49152
ds_read_b64_tr_b16 v[152:153], v20 offset:8192
v_mfma_f32_16x16x32_bf16 v[100:103], v[44:47], v[32:35], v[100:103]
ds_read_b64_tr_b16 v[154:155], v20 offset:10240
ds_read_b64_tr_b16 v[156:157], v21 offset:8192
v_mfma_f32_16x16x32_bf16 v[104:107], v[48:51], v[32:35], v[104:107]
ds_read_b64_tr_b16 v[158:159], v21 offset:10240
ds_read_b64_tr_b16 v[160:161], v22 offset:8192
v_mfma_f32_16x16x32_bf16 v[108:111], v[52:55], v[32:35], v[108:111]
ds_read_b64_tr_b16 v[162:163], v22 offset:10240
ds_read_b64_tr_b16 v[164:165], v23 offset:8192
v_mfma_f32_16x16x32_bf16 v[124:127], v[52:55], v[36:39], v[124:127]
ds_read_b64_tr_b16 v[166:167], v23 offset:10240
ds_read_b128 v[148:151], v3 offset:50176
v_mfma_f32_16x16x32_bf16 v[120:123], v[48:51], v[36:39], v[120:123]
ds_read_b128 v[168:171], v3 offset:57344
ds_read_b64_tr_b16 v[176:177], v20 offset:12288
v_mfma_f32_16x16x32_bf16 v[116:119], v[44:47], v[36:39], v[116:119]
ds_read_b64_tr_b16 v[178:179], v20 offset:14336
ds_read_b64_tr_b16 v[180:181], v21 offset:12288
v_mfma_f32_16x16x32_bf16 v[112:115], v[40:43], v[36:39], v[112:115]
ds_read_b64_tr_b16 v[182:183], v21 offset:14336
ds_read_b64_tr_b16 v[184:185], v22 offset:12288
v_mfma_f32_16x16x32_bf16 v[96:99], v[64:67], v[56:59], v[96:99]
ds_read_b64_tr_b16 v[186:187], v22 offset:14336
ds_read_b64_tr_b16 v[188:189], v23 offset:12288
v_mfma_f32_16x16x32_bf16 v[100:103], v[68:71], v[56:59], v[100:103]
ds_read_b64_tr_b16 v[190:191], v23 offset:14336
ds_read_b128 v[172:175], v3 offset:58368
v_mfma_f32_16x16x32_bf16 v[104:107], v[72:75], v[56:59], v[104:107]
v_add_u32 v196, 128, v1
v_mfma_f32_16x16x32_bf16 v[108:111], v[76:79], v[56:59], v[108:111]
v_mul_u32_u24 v197, 5462, v196
v_mfma_f32_16x16x32_bf16 v[124:127], v[76:79], v[60:63], v[124:127]
v_lshrrev_b32 v197, 16, v197
v_mfma_f32_16x16x32_bf16 v[120:123], v[72:75], v[60:63], v[120:123]
v_mul_u32_u24 v198, 12, v197
v_mfma_f32_16x16x32_bf16 v[116:119], v[68:71], v[60:63], v[116:119]
v_sub_u32 v198, v196, v198
v_mfma_f32_16x16x32_bf16 v[112:115], v[64:67], v[60:63], v[112:115]
v_bfe_u32 v199, v197, 2, 1
s_waitcnt lgkmcnt(0)
s_barrier
v_mfma_f32_16x16x32_bf16 v[96:99], v[152:155], v[144:147], v[96:99]
ds_read_b128 v[32:35], v2 offset:0
ds_read_b64_tr_b16 v[40:41], v4 offset:16384
v_mfma_f32_16x16x32_bf16 v[100:103], v[156:159], v[144:147], v[100:103]
ds_read_b64_tr_b16 v[42:43], v4 offset:18432
ds_read_b64_tr_b16 v[44:45], v5 offset:16384
v_mfma_f32_16x16x32_bf16 v[104:107], v[160:163], v[144:147], v[104:107]
ds_read_b64_tr_b16 v[46:47], v5 offset:18432
ds_read_b64_tr_b16 v[48:49], v6 offset:16384
v_mfma_f32_16x16x32_bf16 v[108:111], v[164:167], v[144:147], v[108:111]
ds_read_b64_tr_b16 v[50:51], v6 offset:18432
ds_read_b64_tr_b16 v[52:53], v7 offset:16384
v_mfma_f32_16x16x32_bf16 v[124:127], v[164:167], v[148:151], v[124:127]
ds_read_b64_tr_b16 v[54:55], v7 offset:18432
ds_read_b128 v[36:39], v2 offset:1024
v_mfma_f32_16x16x32_bf16 v[120:123], v[160:163], v[148:151], v[120:123]
ds_read_b128 v[56:59], v2 offset:8192
ds_read_b64_tr_b16 v[64:65], v4 offset:20480
v_mfma_f32_16x16x32_bf16 v[116:119], v[156:159], v[148:151], v[116:119]
ds_read_b64_tr_b16 v[66:67], v4 offset:22528
ds_read_b64_tr_b16 v[68:69], v5 offset:20480
v_mfma_f32_16x16x32_bf16 v[112:115], v[152:155], v[148:151], v[112:115]
ds_read_b64_tr_b16 v[70:71], v5 offset:22528
ds_read_b64_tr_b16 v[72:73], v6 offset:20480
v_mfma_f32_16x16x32_bf16 v[96:99], v[176:179], v[168:171], v[96:99]
ds_read_b64_tr_b16 v[74:75], v6 offset:22528
ds_read_b64_tr_b16 v[76:77], v7 offset:20480
v_mfma_f32_16x16x32_bf16 v[100:103], v[180:183], v[168:171], v[100:103]
ds_read_b64_tr_b16 v[78:79], v7 offset:22528
ds_read_b128 v[60:63], v2 offset:9216
v_mfma_f32_16x16x32_bf16 v[104:107], v[184:187], v[168:171], v[104:107]
v_cmp_gt_u32 vcc, 8, v198
v_mfma_f32_16x16x32_bf16 v[108:111], v[188:191], v[168:171], v[108:111]
v_lshlrev_b32 v200, 1, v199
v_mfma_f32_16x16x32_bf16 v[124:127], v[188:191], v[172:175], v[124:127]
v_mul_u32_u24 v197, 7168, v197
v_mfma_f32_16x16x32_bf16 v[120:123], v[184:187], v[172:175], v[120:123]
v_cndmask_b32 v199, v199, v200, vcc
v_mfma_f32_16x16x32_bf16 v[116:119], v[180:183], v[172:175], v[116:119]
v_xor_b32 v198, v198, v199
v_mfma_f32_16x16x32_bf16 v[112:115], v[176:179], v[172:175], v[112:115]
v_lshl_add_u32 v194, v198, 4, v197
s_waitcnt lgkmcnt(0)
s_barrier
v_mfma_f32_16x16x32_bf16 v[96:99], v[40:43], v[32:35], v[96:99]
ds_read_b128 v[144:147], v2 offset:49152
ds_read_b64_tr_b16 v[152:153], v4 offset:24576
v_mfma_f32_16x16x32_bf16 v[100:103], v[44:47], v[32:35], v[100:103]
ds_read_b64_tr_b16 v[154:155], v4 offset:26624
ds_read_b64_tr_b16 v[156:157], v5 offset:24576
v_mfma_f32_16x16x32_bf16 v[104:107], v[48:51], v[32:35], v[104:107]
ds_read_b64_tr_b16 v[158:159], v5 offset:26624
ds_read_b64_tr_b16 v[160:161], v6 offset:24576
v_mfma_f32_16x16x32_bf16 v[108:111], v[52:55], v[32:35], v[108:111]
ds_read_b64_tr_b16 v[162:163], v6 offset:26624
ds_read_b64_tr_b16 v[164:165], v7 offset:24576
v_mfma_f32_16x16x32_bf16 v[124:127], v[52:55], v[36:39], v[124:127]
ds_read_b64_tr_b16 v[166:167], v7 offset:26624
ds_read_b128 v[148:151], v2 offset:50176
v_mfma_f32_16x16x32_bf16 v[120:123], v[48:51], v[36:39], v[120:123]
ds_read_b128 v[168:171], v2 offset:57344
ds_read_b64_tr_b16 v[176:177], v4 offset:28672
v_mfma_f32_16x16x32_bf16 v[116:119], v[44:47], v[36:39], v[116:119]
ds_read_b64_tr_b16 v[178:179], v4 offset:30720
ds_read_b64_tr_b16 v[180:181], v5 offset:28672
v_mfma_f32_16x16x32_bf16 v[112:115], v[40:43], v[36:39], v[112:115]
ds_read_b64_tr_b16 v[182:183], v5 offset:30720
ds_read_b64_tr_b16 v[184:185], v6 offset:28672
v_mfma_f32_16x16x32_bf16 v[96:99], v[64:67], v[56:59], v[96:99]
ds_read_b64_tr_b16 v[186:187], v6 offset:30720
ds_read_b64_tr_b16 v[188:189], v7 offset:28672
v_mfma_f32_16x16x32_bf16 v[100:103], v[68:71], v[56:59], v[100:103]
ds_read_b64_tr_b16 v[190:191], v7 offset:30720
ds_read_b128 v[172:175], v2 offset:58368
v_mfma_f32_16x16x32_bf16 v[104:107], v[72:75], v[56:59], v[104:107]
v_add_u32 v192, s43, v192
v_mfma_f32_16x16x32_bf16 v[108:111], v[76:79], v[56:59], v[108:111]
v_add_u32 v193, s43, v193
v_mfma_f32_16x16x32_bf16 v[124:127], v[76:79], v[60:63], v[124:127]
v_add_u32 v194, s43, v194
v_mfma_f32_16x16x32_bf16 v[120:123], v[72:75], v[60:63], v[120:123]
s_and_b32 s43, s36, 3
v_mfma_f32_16x16x32_bf16 v[116:119], v[68:71], v[60:63], v[116:119]
s_mul_i32 s50, s43, 6144
v_mfma_f32_16x16x32_bf16 v[112:115], v[64:67], v[60:63], v[112:115]
s_add_u32 s50, s50, 16384
s_waitcnt lgkmcnt(0)
s_barrier
v_mfma_f32_16x16x32_bf16 v[96:99], v[152:155], v[144:147], v[96:99]
ds_read_b128 v[32:35], v3 offset:0
ds_read_b64_tr_b16 v[40:41], v4 offset:32768
v_mfma_f32_16x16x32_bf16 v[100:103], v[156:159], v[144:147], v[100:103]
ds_read_b64_tr_b16 v[42:43], v4 offset:34816
ds_read_b64_tr_b16 v[44:45], v5 offset:32768
v_mfma_f32_16x16x32_bf16 v[104:107], v[160:163], v[144:147], v[104:107]
ds_read_b64_tr_b16 v[46:47], v5 offset:34816
ds_read_b64_tr_b16 v[48:49], v6 offset:32768
v_mfma_f32_16x16x32_bf16 v[108:111], v[164:167], v[144:147], v[108:111]
ds_read_b64_tr_b16 v[50:51], v6 offset:34816
ds_read_b64_tr_b16 v[52:53], v7 offset:32768
v_mfma_f32_16x16x32_bf16 v[124:127], v[164:167], v[148:151], v[124:127]
ds_read_b64_tr_b16 v[54:55], v7 offset:34816
ds_read_b128 v[36:39], v3 offset:1024
v_mfma_f32_16x16x32_bf16 v[120:123], v[160:163], v[148:151], v[120:123]
ds_read_b128 v[56:59], v3 offset:8192
ds_read_b64_tr_b16 v[64:65], v4 offset:36864
v_mfma_f32_16x16x32_bf16 v[116:119], v[156:159], v[148:151], v[116:119]
ds_read_b64_tr_b16 v[66:67], v4 offset:38912
ds_read_b64_tr_b16 v[68:69], v5 offset:36864
v_mfma_f32_16x16x32_bf16 v[112:115], v[152:155], v[148:151], v[112:115]
ds_read_b64_tr_b16 v[70:71], v5 offset:38912
ds_read_b64_tr_b16 v[72:73], v6 offset:36864
v_mfma_f32_16x16x32_bf16 v[96:99], v[176:179], v[168:171], v[96:99]
ds_read_b64_tr_b16 v[74:75], v6 offset:38912
ds_read_b64_tr_b16 v[76:77], v7 offset:36864
v_mfma_f32_16x16x32_bf16 v[100:103], v[180:183], v[168:171], v[100:103]
ds_read_b64_tr_b16 v[78:79], v7 offset:38912
ds_read_b128 v[60:63], v3 offset:9216
v_mfma_f32_16x16x32_bf16 v[104:107], v[184:187], v[168:171], v[104:107]
s_bitcmp0_b32 s2, 0
v_mfma_f32_16x16x32_bf16 v[108:111], v[188:191], v[168:171], v[108:111]
s_cselect_b32 s88, s72, s74
v_mfma_f32_16x16x32_bf16 v[124:127], v[188:191], v[172:175], v[124:127]
s_cselect_b32 s89, s73, s75
v_mfma_f32_16x16x32_bf16 v[120:123], v[184:187], v[172:175], v[120:123]
s_mov_b32 s90, 7340032
v_mfma_f32_16x16x32_bf16 v[116:119], v[180:183], v[172:175], v[116:119]
s_mov_b32 s91, 0x20000
v_mfma_f32_16x16x32_bf16 v[112:115], v[176:179], v[172:175], v[112:115]
s_bfe_u32 s44, s2, 0x30001
s_waitcnt lgkmcnt(0)
s_barrier
v_mfma_f32_16x16x32_bf16 v[96:99], v[40:43], v[32:35], v[96:99]
ds_read_b128 v[144:147], v3 offset:49152
ds_read_b64_tr_b16 v[152:153], v4 offset:40960
v_mfma_f32_16x16x32_bf16 v[100:103], v[44:47], v[32:35], v[100:103]
ds_read_b64_tr_b16 v[154:155], v4 offset:43008
ds_read_b64_tr_b16 v[156:157], v5 offset:40960
v_mfma_f32_16x16x32_bf16 v[104:107], v[48:51], v[32:35], v[104:107]
ds_read_b64_tr_b16 v[158:159], v5 offset:43008
ds_read_b64_tr_b16 v[160:161], v6 offset:40960
v_mfma_f32_16x16x32_bf16 v[108:111], v[52:55], v[32:35], v[108:111]
ds_read_b64_tr_b16 v[162:163], v6 offset:43008
ds_read_b64_tr_b16 v[164:165], v7 offset:40960
v_mfma_f32_16x16x32_bf16 v[124:127], v[52:55], v[36:39], v[124:127]
ds_read_b64_tr_b16 v[166:167], v7 offset:43008
ds_read_b128 v[148:151], v3 offset:50176
v_mfma_f32_16x16x32_bf16 v[120:123], v[48:51], v[36:39], v[120:123]
ds_read_b128 v[168:171], v3 offset:57344
ds_read_b64_tr_b16 v[176:177], v4 offset:45056
v_mfma_f32_16x16x32_bf16 v[116:119], v[44:47], v[36:39], v[116:119]
ds_read_b64_tr_b16 v[178:179], v4 offset:47104
ds_read_b64_tr_b16 v[180:181], v5 offset:45056
v_mfma_f32_16x16x32_bf16 v[112:115], v[40:43], v[36:39], v[112:115]
ds_read_b64_tr_b16 v[182:183], v5 offset:47104
ds_read_b64_tr_b16 v[184:185], v6 offset:45056
v_mfma_f32_16x16x32_bf16 v[96:99], v[64:67], v[56:59], v[96:99]
ds_read_b64_tr_b16 v[186:187], v6 offset:47104
ds_read_b64_tr_b16 v[188:189], v7 offset:45056
v_mfma_f32_16x16x32_bf16 v[100:103], v[68:71], v[56:59], v[100:103]
ds_read_b64_tr_b16 v[190:191], v7 offset:47104
ds_read_b128 v[172:175], v3 offset:58368
v_mfma_f32_16x16x32_bf16 v[104:107], v[72:75], v[56:59], v[104:107]
s_lshl_b32 s44, s44, 2
v_mfma_f32_16x16x32_bf16 v[108:111], v[76:79], v[56:59], v[108:111]
s_and_b32 s43, s36, 3
v_mfma_f32_16x16x32_bf16 v[124:127], v[76:79], v[60:63], v[124:127]
s_add_u32 s44, s44, s43
v_mfma_f32_16x16x32_bf16 v[120:123], v[72:75], v[60:63], v[120:123]
s_lshl_b32 s44, s44, 5
v_mfma_f32_16x16x32_bf16 v[116:119], v[68:71], v[60:63], v[116:119]
v_lshrrev_b32 v195, 4, v1
v_mfma_f32_16x16x32_bf16 v[112:115], v[64:67], v[60:63], v[112:115]
v_add_u32 v195, s44, v195
s_waitcnt lgkmcnt(0)
s_barrier
v_mfma_f32_16x16x32_bf16 v[96:99], v[152:155], v[144:147], v[96:99]
ds_read_b128 v[32:35], v2 offset:0
ds_read_b64_tr_b16 v[40:41], v16 offset:49152
v_mfma_f32_16x16x32_bf16 v[100:103], v[156:159], v[144:147], v[100:103]
ds_read_b64_tr_b16 v[42:43], v16 offset:51200
ds_read_b64_tr_b16 v[44:45], v17 offset:49152
v_mfma_f32_16x16x32_bf16 v[104:107], v[160:163], v[144:147], v[104:107]
ds_read_b64_tr_b16 v[46:47], v17 offset:51200
ds_read_b64_tr_b16 v[48:49], v18 offset:49152
v_mfma_f32_16x16x32_bf16 v[108:111], v[164:167], v[144:147], v[108:111]
ds_read_b64_tr_b16 v[50:51], v18 offset:51200
ds_read_b64_tr_b16 v[52:53], v19 offset:49152
v_mfma_f32_16x16x32_bf16 v[124:127], v[164:167], v[148:151], v[124:127]
ds_read_b64_tr_b16 v[54:55], v19 offset:51200
ds_read_b128 v[36:39], v2 offset:1024
v_mfma_f32_16x16x32_bf16 v[120:123], v[160:163], v[148:151], v[120:123]
ds_read_b128 v[56:59], v2 offset:8192
ds_read_b64_tr_b16 v[64:65], v16 offset:53248
v_mfma_f32_16x16x32_bf16 v[116:119], v[156:159], v[148:151], v[116:119]
ds_read_b64_tr_b16 v[66:67], v16 offset:55296
ds_read_b64_tr_b16 v[68:69], v17 offset:53248
v_mfma_f32_16x16x32_bf16 v[112:115], v[152:155], v[148:151], v[112:115]
ds_read_b64_tr_b16 v[70:71], v17 offset:55296
ds_read_b64_tr_b16 v[72:73], v18 offset:53248
v_mfma_f32_16x16x32_bf16 v[96:99], v[176:179], v[168:171], v[96:99]
ds_read_b64_tr_b16 v[74:75], v18 offset:55296
ds_read_b64_tr_b16 v[76:77], v19 offset:53248
v_mfma_f32_16x16x32_bf16 v[100:103], v[180:183], v[168:171], v[100:103]
ds_read_b64_tr_b16 v[78:79], v19 offset:55296
ds_read_b128 v[60:63], v2 offset:9216
v_mfma_f32_16x16x32_bf16 v[104:107], v[184:187], v[168:171], v[104:107]
v_mul_u32_u24 v195, 7168, v195
v_mfma_f32_16x16x32_bf16 v[108:111], v[188:191], v[168:171], v[108:111]
v_and_b32 v196, 15, v1
v_mfma_f32_16x16x32_bf16 v[124:127], v[188:191], v[172:175], v[124:127]
v_lshl_add_u32 v195, v196, 4, v195
v_mfma_f32_16x16x32_bf16 v[120:123], v[184:187], v[172:175], v[120:123]
s_lshr_b32 s43, s2, 4
v_mfma_f32_16x16x32_bf16 v[116:119], v[180:183], v[172:175], v[116:119]
s_lshl_b32 s43, s43, 8
v_mfma_f32_16x16x32_bf16 v[112:115], v[176:179], v[172:175], v[112:115]
v_add_u32 v195, s43, v195
s_waitcnt lgkmcnt(0)
s_barrier
v_mfma_f32_16x16x32_bf16 v[96:99], v[40:43], v[32:35], v[96:99]
ds_read_b128 v[144:147], v2 offset:49152
ds_read_b64_tr_b16 v[152:153], v16 offset:57344
v_mfma_f32_16x16x32_bf16 v[100:103], v[44:47], v[32:35], v[100:103]
ds_read_b64_tr_b16 v[154:155], v16 offset:59392
ds_read_b64_tr_b16 v[156:157], v17 offset:57344
v_mfma_f32_16x16x32_bf16 v[104:107], v[48:51], v[32:35], v[104:107]
ds_read_b64_tr_b16 v[158:159], v17 offset:59392
ds_read_b64_tr_b16 v[160:161], v18 offset:57344
v_mfma_f32_16x16x32_bf16 v[108:111], v[52:55], v[32:35], v[108:111]
ds_read_b64_tr_b16 v[162:163], v18 offset:59392
ds_read_b64_tr_b16 v[164:165], v19 offset:57344
v_mfma_f32_16x16x32_bf16 v[124:127], v[52:55], v[36:39], v[124:127]
ds_read_b64_tr_b16 v[166:167], v19 offset:59392
ds_read_b128 v[148:151], v2 offset:50176
v_mfma_f32_16x16x32_bf16 v[120:123], v[48:51], v[36:39], v[120:123]
ds_read_b128 v[168:171], v2 offset:57344
ds_read_b64_tr_b16 v[176:177], v16 offset:61440
v_mfma_f32_16x16x32_bf16 v[116:119], v[44:47], v[36:39], v[116:119]
ds_read_b64_tr_b16 v[178:179], v16 offset:63488
ds_read_b64_tr_b16 v[180:181], v17 offset:61440
v_mfma_f32_16x16x32_bf16 v[112:115], v[40:43], v[36:39], v[112:115]
ds_read_b64_tr_b16 v[182:183], v17 offset:63488
ds_read_b64_tr_b16 v[184:185], v18 offset:61440
v_mfma_f32_16x16x32_bf16 v[96:99], v[64:67], v[56:59], v[96:99]
ds_read_b64_tr_b16 v[186:187], v18 offset:63488
ds_read_b64_tr_b16 v[188:189], v19 offset:61440
v_mfma_f32_16x16x32_bf16 v[100:103], v[68:71], v[56:59], v[100:103]
ds_read_b64_tr_b16 v[190:191], v19 offset:63488
ds_read_b128 v[172:175], v2 offset:58368
v_mfma_f32_16x16x32_bf16 v[104:107], v[72:75], v[56:59], v[104:107]
v_mfma_f32_16x16x32_bf16 v[108:111], v[76:79], v[56:59], v[108:111]
v_mfma_f32_16x16x32_bf16 v[124:127], v[76:79], v[60:63], v[124:127]
v_mfma_f32_16x16x32_bf16 v[120:123], v[72:75], v[60:63], v[120:123]
v_mfma_f32_16x16x32_bf16 v[116:119], v[68:71], v[60:63], v[116:119]
v_mfma_f32_16x16x32_bf16 v[112:115], v[64:67], v[60:63], v[112:115]
s_waitcnt lgkmcnt(0)
s_barrier
v_mfma_f32_16x16x32_bf16 v[96:99], v[152:155], v[144:147], v[96:99]
s_branch Lov_6
.p2align 12
.fill 48, 4, 0xbf800000
Lst_6_0:
s_branch Lwr_161
s_nop 0
s_nop 0
Lov_6:
ds_read_b128 v[32:35], v3 offset:0
ds_read_b64_tr_b16 v[40:41], v20 offset:0
v_mfma_f32_16x16x32_bf16 v[100:103], v[156:159], v[144:147], v[100:103]
ds_read_b64_tr_b16 v[42:43], v20 offset:2048
ds_read_b64_tr_b16 v[44:45], v21 offset:0
v_mfma_f32_16x16x32_bf16 v[104:107], v[160:163], v[144:147], v[104:107]
ds_read_b64_tr_b16 v[46:47], v21 offset:2048
ds_read_b64_tr_b16 v[48:49], v22 offset:0
v_mfma_f32_16x16x32_bf16 v[108:111], v[164:167], v[144:147], v[108:111]
ds_read_b64_tr_b16 v[50:51], v22 offset:2048
ds_read_b64_tr_b16 v[52:53], v23 offset:0
v_mfma_f32_16x16x32_bf16 v[124:127], v[164:167], v[148:151], v[124:127]
ds_read_b64_tr_b16 v[54:55], v23 offset:2048
ds_read_b128 v[36:39], v3 offset:1024
v_mfma_f32_16x16x32_bf16 v[120:123], v[160:163], v[148:151], v[120:123]
ds_read_b128 v[56:59], v3 offset:8192
ds_read_b64_tr_b16 v[64:65], v20 offset:4096
v_mfma_f32_16x16x32_bf16 v[116:119], v[156:159], v[148:151], v[116:119]
ds_read_b64_tr_b16 v[66:67], v20 offset:6144
ds_read_b64_tr_b16 v[68:69], v21 offset:4096
v_mfma_f32_16x16x32_bf16 v[112:115], v[152:155], v[148:151], v[112:115]
ds_read_b64_tr_b16 v[70:71], v21 offset:6144
ds_read_b64_tr_b16 v[72:73], v22 offset:4096
v_mfma_f32_16x16x32_bf16 v[96:99], v[176:179], v[168:171], v[96:99]
ds_read_b64_tr_b16 v[74:75], v22 offset:6144
ds_read_b64_tr_b16 v[76:77], v23 offset:4096
v_mfma_f32_16x16x32_bf16 v[100:103], v[180:183], v[168:171], v[100:103]
ds_read_b64_tr_b16 v[78:79], v23 offset:6144
ds_read_b128 v[60:63], v3 offset:9216
v_mfma_f32_16x16x32_bf16 v[104:107], v[184:187], v[168:171], v[104:107]
v_mfma_f32_16x16x32_bf16 v[108:111], v[188:191], v[168:171], v[108:111]
v_mfma_f32_16x16x32_bf16 v[124:127], v[188:191], v[172:175], v[124:127]
v_mfma_f32_16x16x32_bf16 v[120:123], v[184:187], v[172:175], v[120:123]
v_mfma_f32_16x16x32_bf16 v[116:119], v[180:183], v[172:175], v[116:119]
v_mfma_f32_16x16x32_bf16 v[112:115], v[176:179], v[172:175], v[112:115]
s_waitcnt lgkmcnt(0)
v_mfma_f32_16x16x32_bf16 v[96:99], v[40:43], v[32:35], v[96:99]
ds_read_b128 v[144:147], v3 offset:49152
ds_read_b64_tr_b16 v[152:153], v20 offset:8192
v_mfma_f32_16x16x32_bf16 v[100:103], v[44:47], v[32:35], v[100:103]
ds_read_b64_tr_b16 v[154:155], v20 offset:10240
ds_read_b64_tr_b16 v[156:157], v21 offset:8192
v_mfma_f32_16x16x32_bf16 v[104:107], v[48:51], v[32:35], v[104:107]
ds_read_b64_tr_b16 v[158:159], v21 offset:10240
ds_read_b64_tr_b16 v[160:161], v22 offset:8192
v_mfma_f32_16x16x32_bf16 v[108:111], v[52:55], v[32:35], v[108:111]
ds_read_b64_tr_b16 v[162:163], v22 offset:10240
ds_read_b64_tr_b16 v[164:165], v23 offset:8192
v_mfma_f32_16x16x32_bf16 v[124:127], v[52:55], v[36:39], v[124:127]
ds_read_b64_tr_b16 v[166:167], v23 offset:10240
ds_read_b128 v[148:151], v3 offset:50176
v_mfma_f32_16x16x32_bf16 v[120:123], v[48:51], v[36:39], v[120:123]
ds_read_b128 v[168:171], v3 offset:57344
ds_read_b64_tr_b16 v[176:177], v20 offset:12288
v_mfma_f32_16x16x32_bf16 v[116:119], v[44:47], v[36:39], v[116:119]
ds_read_b64_tr_b16 v[178:179], v20 offset:14336
ds_read_b64_tr_b16 v[180:181], v21 offset:12288
v_mfma_f32_16x16x32_bf16 v[112:115], v[40:43], v[36:39], v[112:115]
ds_read_b64_tr_b16 v[182:183], v21 offset:14336
ds_read_b64_tr_b16 v[184:185], v22 offset:12288
v_mfma_f32_16x16x32_bf16 v[96:99], v[64:67], v[56:59], v[96:99]
ds_read_b64_tr_b16 v[186:187], v22 offset:14336
ds_read_b64_tr_b16 v[188:189], v23 offset:12288
v_mfma_f32_16x16x32_bf16 v[100:103], v[68:71], v[56:59], v[100:103]
ds_read_b64_tr_b16 v[190:191], v23 offset:14336
ds_read_b128 v[172:175], v3 offset:58368
v_mfma_f32_16x16x32_bf16 v[104:107], v[72:75], v[56:59], v[104:107]
v_mfma_f32_16x16x32_bf16 v[108:111], v[76:79], v[56:59], v[108:111]
v_mfma_f32_16x16x32_bf16 v[124:127], v[76:79], v[60:63], v[124:127]
v_mfma_f32_16x16x32_bf16 v[120:123], v[72:75], v[60:63], v[120:123]
v_mfma_f32_16x16x32_bf16 v[116:119], v[68:71], v[60:63], v[116:119]
v_mfma_f32_16x16x32_bf16 v[112:115], v[64:67], v[60:63], v[112:115]
s_waitcnt lgkmcnt(0)
v_mfma_f32_16x16x32_bf16 v[96:99], v[152:155], v[144:147], v[96:99]
v_mfma_f32_16x16x32_bf16 v[100:103], v[156:159], v[144:147], v[100:103]
v_mfma_f32_16x16x32_bf16 v[104:107], v[160:163], v[144:147], v[104:107]
v_mfma_f32_16x16x32_bf16 v[108:111], v[164:167], v[144:147], v[108:111]
v_mfma_f32_16x16x32_bf16 v[124:127], v[164:167], v[148:151], v[124:127]
v_mfma_f32_16x16x32_bf16 v[120:123], v[160:163], v[148:151], v[120:123]
v_mfma_f32_16x16x32_bf16 v[116:119], v[156:159], v[148:151], v[116:119]
v_mfma_f32_16x16x32_bf16 v[112:115], v[152:155], v[148:151], v[112:115]
v_mfma_f32_16x16x32_bf16 v[96:99], v[176:179], v[168:171], v[96:99]
v_mfma_f32_16x16x32_bf16 v[100:103], v[180:183], v[168:171], v[100:103]
v_mfma_f32_16x16x32_bf16 v[104:107], v[184:187], v[168:171], v[104:107]
v_mfma_f32_16x16x32_bf16 v[108:111], v[188:191], v[168:171], v[108:111]
v_mfma_f32_16x16x32_bf16 v[124:127], v[188:191], v[172:175], v[124:127]
v_mfma_f32_16x16x32_bf16 v[120:123], v[184:187], v[172:175], v[120:123]
v_mfma_f32_16x16x32_bf16 v[116:119], v[180:183], v[172:175], v[116:119]
v_mfma_f32_16x16x32_bf16 v[112:115], v[176:179], v[172:175], v[112:115]
s_nop 3
v_cvt_pk_bf16_f32 v32, v96, v97
v_cvt_pk_bf16_f32 v33, v98, v99
v_cvt_pk_bf16_f32 v34, v100, v101
v_cvt_pk_bf16_f32 v35, v102, v103
s_add_u32 s43, s60, 0
buffer_store_dwordx4 v[32:35], v11, s[20:23], s43 offen offset:0 sc1
v_cvt_pk_bf16_f32 v36, v104, v105
v_cvt_pk_bf16_f32 v37, v106, v107
v_cvt_pk_bf16_f32 v38, v108, v109
v_cvt_pk_bf16_f32 v39, v110, v111
s_add_u32 s43, s60, 8192
buffer_store_dwordx4 v[36:39], v11, s[20:23], s43 offen offset:0 sc1
v_cvt_pk_bf16_f32 v44, v120, v121
v_cvt_pk_bf16_f32 v45, v122, v123
v_cvt_pk_bf16_f32 v46, v124, v125
v_cvt_pk_bf16_f32 v47, v126, v127
s_add_u32 s43, s60, 8192
buffer_store_dwordx4 v[44:47], v11, s[20:23], s43 offen offset:1024 sc1
v_cvt_pk_bf16_f32 v40, v112, v113
v_cvt_pk_bf16_f32 v41, v114, v115
v_cvt_pk_bf16_f32 v42, v116, v117
v_cvt_pk_bf16_f32 v43, v118, v119
s_add_u32 s43, s60, 0
buffer_store_dwordx4 v[40:43], v11, s[20:23], s43 offen offset:1024 sc1
v_mov_b32 v64, 0
v_mov_b32 v65, 0
v_mov_b32 v66, 0
v_mov_b32 v67, 0
v_mov_b32 v68, 0
v_mov_b32 v69, 0
v_mov_b32 v70, 0
v_mov_b32 v71, 0
v_dot2_f32_bf16 v64, v32, s61, v64
v_dot2_f32_bf16 v66, v32, v32, v66
v_dot2_f32_bf16 v68, v40, s61, v68
v_dot2_f32_bf16 v70, v40, v40, v70
v_dot2_f32_bf16 v65, v33, s61, v65
v_dot2_f32_bf16 v67, v33, v33, v67
v_dot2_f32_bf16 v69, v41, s61, v69
v_dot2_f32_bf16 v71, v41, v41, v71
v_dot2_f32_bf16 v64, v34, s61, v64
v_dot2_f32_bf16 v66, v34, v34, v66
v_dot2_f32_bf16 v68, v42, s61, v68
v_dot2_f32_bf16 v70, v42, v42, v70
v_dot2_f32_bf16 v65, v35, s61, v65
v_dot2_f32_bf16 v67, v35, v35, v67
v_dot2_f32_bf16 v69, v43, s61, v69
v_dot2_f32_bf16 v71, v43, v43, v71
v_dot2_f32_bf16 v64, v36, s61, v64
v_dot2_f32_bf16 v66, v36, v36, v66
v_dot2_f32_bf16 v68, v44, s61, v68
v_dot2_f32_bf16 v70, v44, v44, v70
v_dot2_f32_bf16 v65, v37, s61, v65
v_dot2_f32_bf16 v67, v37, v37, v67
v_dot2_f32_bf16 v69, v45, s61, v69
v_dot2_f32_bf16 v71, v45, v45, v71
v_dot2_f32_bf16 v64, v38, s61, v64
v_dot2_f32_bf16 v66, v38, v38, v66
v_dot2_f32_bf16 v68, v46, s61, v68
v_dot2_f32_bf16 v70, v46, v46, v70
v_dot2_f32_bf16 v65, v39, s61, v65
v_dot2_f32_bf16 v67, v39, v39, v67
v_dot2_f32_bf16 v69, v47, s61, v69
v_dot2_f32_bf16 v71, v47, v47, v71
s_nop 2
v_add_f32 v64, v64, v65
v_add_f32 v66, v66, v67
v_add_f32 v68, v68, v69
v_add_f32 v70, v70, v71
s_nop 1
v_permlane32_swap_b32 v64, v68
v_permlane32_swap_b32 v66, v70
v_add_f32 v64, v64, v68
v_add_f32 v66, v66, v70
s_nop 1
v_permlane16_swap_b32 v64, v66
v_add_f32 v64, v64, v66
buffer_store_dword v64, v9, s[24:27], 0 offen sc1
s_lshl_b32 s7, s34, 12
s_add_u32 s7, s7, 49280
v_lshl_add_u32 v4, v1, 8, s7
v_mov_b32 v5, 1
s_waitcnt vmcnt(0)
s_cmp_lg_u32 s36, 0
s_barrier
s_cbranch_scc1 Lk2end_98
s_mov_b64 exec, 0xffff
buffer_atomic_add v5, v4, s[56:59], 0 offen sc1
s_mov_b64 exec, -1
s_branch Lk2end_98
Lprod_99:
s_mul_i32 s43, s34, 262144
s_add_u32 s8, s82, s43
s_addc_u32 s9, s83, 0
s_mov_b32 s10, 262144
s_mov_b32 s11, 0x20000
s_lshl_b32 s43, s35, 7
s_add_u32 s12, s68, s43
s_addc_u32 s13, s69, 0
s_mov_b32 s14, 2095232
s_mov_b32 s15, 0x20000
s_and_b32 s47, s36, 3
s_lshl_b32 s39, s47, 12
v_lshlrev_b32 v2, 4, v1
v_add_u32 v2, s39, v2
v_lshrrev_b32 v12, 3, v1
v_and_b32 v13, 6, v12
v_and_b32 v3, 7, v1
v_xor_b32 v3, v3, v13
v_lshlrev_b32 v3, 4, v3
v_mul_u32_u24 v12, 2048, v12
v_add_u32 v3, v3, v12
s_lshl_b32 s43, s47, 15
v_add_u32 v3, s43, v3
s_lshl_b32 s40, s47, 11
s_add_u32 s37, s35, 0
s_and_b32 s37, s37, 15
s_lshl_b32 s37, s37, 14
s_add_u32 m0, s39, 0
s_nop 0
buffer_load_dwordx4 v2, s[8:11], s37 offen offset:0 sc1 lds
buffer_load_dwordx4 v2, s[8:11], s37 offen offset:1024 sc1 lds
buffer_load_dwordx4 v2, s[8:11], s37 offen offset:2048 sc1 lds
buffer_load_dwordx4 v2, s[8:11], s37 offen offset:3072 sc1 lds
s_add_u32 s38, s35, 8
s_and_b32 s38, s38, 15
s_lshl_b32 s38, s38, 17
s_add_u32 m0, s40, 16384
s_nop 0
buffer_load_dwordx4 v3, s[12:15], s38 offen lds
s_add_u32 m0, s40, 17408
s_add_u32 s38, s38, 16384
buffer_load_dwordx4 v3, s[12:15], s38 offen lds
s_add_u32 s38, s35, 9
s_and_b32 s38, s38, 15
s_lshl_b32 s38, s38, 17
s_add_u32 m0, s40, 24576
s_nop 0
buffer_load_dwordx4 v3, s[12:15], s38 offen lds
s_add_u32 m0, s40, 25600
s_add_u32 s38, s38, 16384
buffer_load_dwordx4 v3, s[12:15], s38 offen lds
s_add_u32 s38, s35, 10
s_and_b32 s38, s38, 15
s_lshl_b32 s38, s38, 17
s_add_u32 m0, s40, 32768
s_nop 0
buffer_load_dwordx4 v3, s[12:15], s38 offen lds
s_add_u32 m0, s40, 33792
s_add_u32 s38, s38, 16384
buffer_load_dwordx4 v3, s[12:15], s38 offen lds
s_add_u32 s38, s35, 11
s_and_b32 s38, s38, 15
s_lshl_b32 s38, s38, 17
s_add_u32 m0, s40, 40960
s_nop 0
buffer_load_dwordx4 v3, s[12:15], s38 offen lds
s_add_u32 m0, s40, 41984
s_add_u32 s38, s38, 16384
buffer_load_dwordx4 v3, s[12:15], s38 offen lds
s_bitcmp0_b32 s36, 1
s_cselect_b32 s44, s72, s74
s_cselect_b32 s45, s73, s75
s_mul_i32 s43, s35, 192
s_add_u32 s16, s44, s43
s_addc_u32 s17, s45, 0
s_add_u32 s16, s16, 4096
s_addc_u32 s17, s17, 0
s_mov_b32 s18, 7333056
s_mov_b32 s19, 0x20000
s_and_b32 s43, s36, 1
s_mul_i32 s43, s43, 229376
v_add_u32 v196, 0, v1
v_mul_u32_u24 v197, 5462, v196
v_lshrrev_b32 v197, 16, v197
v_mul_u32_u24 v198, 12, v197
v_sub_u32 v198, v196, v198
v_bfe_u32 v199, v197, 2, 1
v_cmp_gt_u32 vcc, 8, v198
v_lshlrev_b32 v200, 1, v199
v_mul_u32_u24 v197, 7168, v197
v_cndmask_b32 v199, v199, v200, vcc
v_xor_b32 v198, v198, v199
v_lshl_add_u32 v192, v198, 4, v197
v_add_u32 v196, 64, v1
v_mul_u32_u24 v197, 5462, v196
v_lshrrev_b32 v197, 16, v197
v_mul_u32_u24 v198, 12, v197
v_sub_u32 v198, v196, v198
v_bfe_u32 v199, v197, 2, 1
v_cmp_gt_u32 vcc, 8, v198
v_lshlrev_b32 v200, 1, v199
v_mul_u32_u24 v197, 7168, v197
v_cndmask_b32 v199, v199, v200, vcc
v_xor_b32 v198, v198, v199
v_lshl_add_u32 v193, v198, 4, v197
v_add_u32 v196, 128, v1
v_mul_u32_u24 v197, 5462, v196
v_lshrrev_b32 v197, 16, v197
v_mul_u32_u24 v198, 12, v197
v_sub_u32 v198, v196, v198
v_bfe_u32 v199, v197, 2, 1
v_cmp_gt_u32 vcc, 8, v198
v_lshlrev_b32 v200, 1, v199
v_mul_u32_u24 v197, 7168, v197
v_cndmask_b32 v199, v199, v200, vcc
v_xor_b32 v198, v198, v199
v_lshl_add_u32 v194, v198, 4, v197
v_add_u32 v192, s43, v192
v_add_u32 v193, s43, v193
v_add_u32 v194, s43, v194
s_and_b32 s43, s36, 3
s_mul_i32 s50, s43, 6144
s_add_u32 s50, s50, 16384
s_cmp_eq_u32 s47, 3
s_cbranch_scc0 Lw_101
s_lshl_b32 s92, s34, 4
s_add_u32 s92, s92, s35
s_lshl_b32 s92, s92, 8
s_add_u32 s92, s92, 49152
s_add_u32 s92, s92, 28311552
s_mov_b32 s41, 0x40000
Lpoll_102:
s_load_dword s93, s[82:83], s92 glc
Lpchk_104:
s_waitcnt lgkmcnt(0)
s_cmp_eq_u32 s93, 16
s_cbranch_scc1 Lpok_103
s_sub_u32 s41, s41, 1
s_cmp_lg_u32 s41, 0
s_cbranch_scc1 Lpoll_102
Lpok_103:
Lw_101:
s_and_b32 s44, s36, 3
s_mul_i32 s44, s44, 11
s_bfe_u32 s43, s2, 0x30001
s_lshl_b32 s43, s43, 7
s_add_u32 s44, s44, s43
s_add_u32 s44, s44, 84
s_mul_i32 s44, s44, 7168
s_lshr_b32 s43, s2, 4
s_lshl_b32 s43, s43, 8
s_add_u32 s43, s43, s44
s_bitcmp0_b32 s2, 0
s_cselect_b32 s4, s72, s74
s_cselect_b32 s5, s73, s75
s_add_u32 s4, s4, s43
s_addc_u32 s5, s5, 0
s_cmp_eq_u32 s47, 3
s_cbranch_scc1 Lw_105
Lw_105:
s_waitcnt vmcnt(8)
s_barrier
s_add_u32 s37, s35, 1
s_and_b32 s37, s37, 15
s_lshl_b32 s37, s37, 14
s_add_u32 m0, s39, 49152
s_nop 0
buffer_load_dwordx4 v2, s[8:11], s37 offen offset:0 sc1 lds
buffer_load_dwordx4 v2, s[8:11], s37 offen offset:1024 sc1 lds
buffer_load_dwordx4 v2, s[8:11], s37 offen offset:2048 sc1 lds
buffer_load_dwordx4 v2, s[8:11], s37 offen offset:3072 sc1 lds
s_add_u32 s37, s35, 2
s_and_b32 s37, s37, 15
s_lshl_b32 s37, s37, 14
s_add_u32 m0, s39, 98304
s_nop 0
buffer_load_dwordx4 v2, s[8:11], s37 offen offset:0 sc1 lds
buffer_load_dwordx4 v2, s[8:11], s37 offen offset:1024 sc1 lds
buffer_load_dwordx4 v2, s[8:11], s37 offen offset:2048 sc1 lds
buffer_load_dwordx4 v2, s[8:11], s37 offen offset:3072 sc1 lds
s_add_u32 s37, s35, 3
s_and_b32 s37, s37, 15
s_lshl_b32 s37, s37, 14
s_add_u32 m0, s39, 147456
s_nop 0
buffer_load_dwordx4 v2, s[8:11], s37 offen offset:0 sc1 lds
buffer_load_dwordx4 v2, s[8:11], s37 offen offset:1024 sc1 lds
buffer_load_dwordx4 v2, s[8:11], s37 offen offset:2048 sc1 lds
buffer_load_dwordx4 v2, s[8:11], s37 offen offset:3072 sc1 lds
s_cmp_eq_u32 s47, 3
s_cbranch_scc0 Lw_106
Lw_106:
s_waitcnt vmcnt(8)
s_barrier
s_add_u32 s37, s35, 4
s_and_b32 s37, s37, 15
s_lshl_b32 s37, s37, 14
s_add_u32 m0, s39, 0
s_nop 0
buffer_load_dwordx4 v2, s[8:11], s37 offen offset:0 sc1 lds
buffer_load_dwordx4 v2, s[8:11], s37 offen offset:1024 sc1 lds
buffer_load_dwordx4 v2, s[8:11], s37 offen offset:2048 sc1 lds
buffer_load_dwordx4 v2, s[8:11], s37 offen offset:3072 sc1 lds
s_waitcnt vmcnt(8)
s_barrier
s_add_u32 s37, s35, 5
s_and_b32 s37, s37, 15
s_lshl_b32 s37, s37, 14
s_add_u32 m0, s39, 49152
s_nop 0
buffer_load_dwordx4 v2, s[8:11], s37 offen offset:0 sc1 lds
buffer_load_dwordx4 v2, s[8:11], s37 offen offset:1024 sc1 lds
buffer_load_dwordx4 v2, s[8:11], s37 offen offset:2048 sc1 lds
buffer_load_dwordx4 v2, s[8:11], s37 offen offset:3072 sc1 lds
s_waitcnt vmcnt(8)
s_barrier
s_add_u32 s37, s35, 6
s_and_b32 s37, s37, 15
s_lshl_b32 s37, s37, 14
s_add_u32 m0, s39, 98304
s_nop 0
buffer_load_dwordx4 v2, s[8:11], s37 offen offset:0 sc1 lds
buffer_load_dwordx4 v2, s[8:11], s37 offen offset:1024 sc1 lds
buffer_load_dwordx4 v2, s[8:11], s37 offen offset:2048 sc1 lds
buffer_load_dwordx4 v2, s[8:11], s37 offen offset:3072 sc1 lds
s_waitcnt vmcnt(8)
s_barrier
s_add_u32 s37, s35, 7
s_and_b32 s37, s37, 15
s_lshl_b32 s37, s37, 14
s_add_u32 m0, s39, 147456
s_nop 0
buffer_load_dwordx4 v2, s[8:11], s37 offen offset:0 sc1 lds
buffer_load_dwordx4 v2, s[8:11], s37 offen offset:1024 sc1 lds
buffer_load_dwordx4 v2, s[8:11], s37 offen offset:2048 sc1 lds
buffer_load_dwordx4 v2, s[8:11], s37 offen offset:3072 sc1 lds
s_waitcnt vmcnt(8)
s_barrier
s_add_u32 s37, s35, 8
s_and_b32 s37, s37, 15
s_lshl_b32 s37, s37, 14
s_add_u32 m0, s39, 0
s_nop 0
buffer_load_dwordx4 v2, s[8:11], s37 offen offset:0 sc1 lds
buffer_load_dwordx4 v2, s[8:11], s37 offen offset:1024 sc1 lds
buffer_load_dwordx4 v2, s[8:11], s37 offen offset:2048 sc1 lds
buffer_load_dwordx4 v2, s[8:11], s37 offen offset:3072 sc1 lds
s_add_u32 s38, s35, 12
s_and_b32 s38, s38, 15
s_lshl_b32 s38, s38, 17
s_add_u32 m0, s40, 114688
s_nop 0
buffer_load_dwordx4 v3, s[12:15], s38 offen lds
s_add_u32 m0, s40, 115712
s_add_u32 s38, s38, 16384
buffer_load_dwordx4 v3, s[12:15], s38 offen lds
s_waitcnt vmcnt(10)
s_barrier
s_add_u32 s37, s35, 9
s_and_b32 s37, s37, 15
s_lshl_b32 s37, s37, 14
s_add_u32 m0, s39, 49152
s_nop 0
buffer_load_dwordx4 v2, s[8:11], s37 offen offset:0 sc1 lds
buffer_load_dwordx4 v2, s[8:11], s37 offen offset:1024 sc1 lds
buffer_load_dwordx4 v2, s[8:11], s37 offen offset:2048 sc1 lds
buffer_load_dwordx4 v2, s[8:11], s37 offen offset:3072 sc1 lds
s_add_u32 s38, s35, 13
s_and_b32 s38, s38, 15
s_lshl_b32 s38, s38, 17
s_add_u32 m0, s40, 122880
s_nop 0
buffer_load_dwordx4 v3, s[12:15], s38 offen lds
s_add_u32 m0, s40, 123904
s_add_u32 s38, s38, 16384
buffer_load_dwordx4 v3, s[12:15], s38 offen lds
s_waitcnt vmcnt(12)
s_barrier
s_add_u32 s37, s35, 10
s_and_b32 s37, s37, 15
s_lshl_b32 s37, s37, 14
s_add_u32 m0, s39, 98304
s_nop 0
buffer_load_dwordx4 v2, s[8:11], s37 offen offset:0 sc1 lds
buffer_load_dwordx4 v2, s[8:11], s37 offen offset:1024 sc1 lds
buffer_load_dwordx4 v2, s[8:11], s37 offen offset:2048 sc1 lds
buffer_load_dwordx4 v2, s[8:11], s37 offen offset:3072 sc1 lds
s_add_u32 s38, s35, 14
s_and_b32 s38, s38, 15
s_lshl_b32 s38, s38, 17
s_add_u32 m0, s40, 131072
s_nop 0
buffer_load_dwordx4 v3, s[12:15], s38 offen lds
s_add_u32 m0, s40, 132096
s_add_u32 s38, s38, 16384
buffer_load_dwordx4 v3, s[12:15], s38 offen lds
s_waitcnt vmcnt(14)
s_barrier
s_add_u32 s37, s35, 11
s_and_b32 s37, s37, 15
s_lshl_b32 s37, s37, 14
s_add_u32 m0, s39, 147456
s_nop 0
buffer_load_dwordx4 v2, s[8:11], s37 offen offset:0 sc1 lds
buffer_load_dwordx4 v2, s[8:11], s37 offen offset:1024 sc1 lds
buffer_load_dwordx4 v2, s[8:11], s37 offen offset:2048 sc1 lds
buffer_load_dwordx4 v2, s[8:11], s37 offen offset:3072 sc1 lds
s_add_u32 s38, s35, 15
s_and_b32 s38, s38, 15
s_lshl_b32 s38, s38, 17
s_add_u32 m0, s40, 139264
s_nop 0
buffer_load_dwordx4 v3, s[12:15], s38 offen lds
s_add_u32 m0, s40, 140288
s_add_u32 s38, s38, 16384
buffer_load_dwordx4 v3, s[12:15], s38 offen lds
s_waitcnt vmcnt(14)
s_barrier
s_add_u32 s37, s35, 12
s_and_b32 s37, s37, 15
s_lshl_b32 s37, s37, 14
s_add_u32 m0, s39, 0
s_nop 0
buffer_load_dwordx4 v2, s[8:11], s37 offen offset:0 sc1 lds
buffer_load_dwordx4 v2, s[8:11], s37 offen offset:1024 sc1 lds
buffer_load_dwordx4 v2, s[8:11], s37 offen offset:2048 sc1 lds
buffer_load_dwordx4 v2, s[8:11], s37 offen offset:3072 sc1 lds
s_waitcnt vmcnt(12)
s_barrier
s_add_u32 s37, s35, 13
s_and_b32 s37, s37, 15
s_lshl_b32 s37, s37, 14
s_add_u32 m0, s39, 49152
s_nop 0
buffer_load_dwordx4 v2, s[8:11], s37 offen offset:0 sc1 lds
buffer_load_dwordx4 v2, s[8:11], s37 offen offset:1024 sc1 lds
buffer_load_dwordx4 v2, s[8:11], s37 offen offset:2048 sc1 lds
buffer_load_dwordx4 v2, s[8:11], s37 offen offset:3072 sc1 lds
s_waitcnt vmcnt(10)
s_barrier
s_add_u32 s37, s35, 14
s_and_b32 s37, s37, 15
s_lshl_b32 s37, s37, 14
s_add_u32 m0, s39, 98304
s_nop 0
buffer_load_dwordx4 v2, s[8:11], s37 offen offset:0 sc1 lds
buffer_load_dwordx4 v2, s[8:11], s37 offen offset:1024 sc1 lds
buffer_load_dwordx4 v2, s[8:11], s37 offen offset:2048 sc1 lds
buffer_load_dwordx4 v2, s[8:11], s37 offen offset:3072 sc1 lds
s_getpc_b64 s[100:101]
s_and_b32 s100, s100, 0xfffff000
s_sub_u32 s100, s100, 1077248
s_subb_u32 s101, s101, 0
s_lshr_b32 s6, s2, 3
s_mul_i32 s6, s6, 4
s_and_b32 s7, s36, 3
s_add_u32 s6, s6, s7
s_mulk_i32 s6, 384
s_add_u32 s6, s6, 1081984
s_load_dword s3, s[100:101], s6 offset:0
s_load_dword s3, s[100:101], s6 offset:64
s_load_dword s3, s[100:101], s6 offset:128
s_load_dword s3, s[100:101], s6 offset:192
s_load_dword s3, s[100:101], s6 offset:256
s_load_dword s3, s[100:101], s6 offset:320
s_waitcnt vmcnt(8)
s_barrier
s_add_u32 s37, s35, 15
s_and_b32 s37, s37, 15
s_lshl_b32 s37, s37, 14
s_add_u32 m0, s39, 147456
s_nop 0
buffer_load_dwordx4 v2, s[8:11], s37 offen offset:0 sc1 lds
buffer_load_dwordx4 v2, s[8:11], s37 offen offset:1024 sc1 lds
buffer_load_dwordx4 v2, s[8:11], s37 offen offset:2048 sc1 lds
buffer_load_dwordx4 v2, s[8:11], s37 offen offset:3072 sc1 lds
s_waitcnt vmcnt(8)
s_barrier
s_waitcnt vmcnt(0)
s_barrier
s_add_u32 s38, s35, 0
s_and_b32 s38, s38, 15
s_mul_i32 s38, s38, 458752
s_add_u32 m0, s50, 0
s_nop 0
buffer_load_dwordx4 v192, s[16:19], s38 offen lds
s_add_u32 m0, s50, 1024
s_nop 0
buffer_load_dwordx4 v193, s[16:19], s38 offen lds
s_add_u32 m0, s50, 2048
s_nop 0
buffer_load_dwordx4 v194, s[16:19], s38 offen lds
s_add_u32 m0, s50, 3072
s_add_u32 s38, s38, 114688
buffer_load_dwordx4 v192, s[16:19], s38 offen lds
s_add_u32 m0, s50, 4096
s_nop 0
buffer_load_dwordx4 v193, s[16:19], s38 offen lds
s_add_u32 m0, s50, 5120
s_nop 0
buffer_load_dwordx4 v194, s[16:19], s38 offen lds
s_add_u32 s38, s35, 1
s_and_b32 s38, s38, 15
s_mul_i32 s38, s38, 458752
s_add_u32 m0, s50, 49152
s_nop 0
buffer_load_dwordx4 v192, s[16:19], s38 offen lds
s_add_u32 m0, s50, 50176
s_nop 0
buffer_load_dwordx4 v193, s[16:19], s38 offen lds
s_add_u32 m0, s50, 51200
s_nop 0
buffer_load_dwordx4 v194, s[16:19], s38 offen lds
s_add_u32 m0, s50, 52224
s_add_u32 s38, s38, 114688
buffer_load_dwordx4 v192, s[16:19], s38 offen lds
s_add_u32 m0, s50, 53248
s_nop 0
buffer_load_dwordx4 v193, s[16:19], s38 offen lds
s_add_u32 m0, s50, 54272
s_nop 0
buffer_load_dwordx4 v194, s[16:19], s38 offen lds
v_lshlrev_b32 v240, 16, v128
v_and_b32 v241, 0xffff0000, v128
v_lshlrev_b32 v242, 16, v129
v_and_b32 v243, 0xffff0000, v129
v_lshlrev_b32 v244, 16, v130
v_and_b32 v245, 0xffff0000, v130
v_lshlrev_b32 v246, 16, v131
v_and_b32 v247, 0xffff0000, v131
v_lshlrev_b32 v24, 16, v132
v_and_b32 v25, 0xffff0000, v132
v_lshlrev_b32 v26, 16, v133
v_and_b32 v27, 0xffff0000, v133
v_lshlrev_b32 v28, 16, v134
v_and_b32 v29, 0xffff0000, v134
v_lshlrev_b32 v30, 16, v135
v_and_b32 v31, 0xffff0000, v135
v_add_f32 v240, v240, v24
v_add_f32 v241, v241, v25
v_add_f32 v242, v242, v26
v_add_f32 v243, v243, v27
v_add_f32 v244, v244, v28
v_add_f32 v245, v245, v29
v_add_f32 v246, v246, v30
v_add_f32 v247, v247, v31
v_lshlrev_b32 v24, 16, v136
v_and_b32 v25, 0xffff0000, v136
v_lshlrev_b32 v26, 16, v137
v_and_b32 v27, 0xffff0000, v137
v_lshlrev_b32 v28, 16, v138
v_and_b32 v29, 0xffff0000, v138
v_lshlrev_b32 v30, 16, v139
v_and_b32 v31, 0xffff0000, v139
v_add_f32 v240, v240, v24
s_branch Lov_7
.p2align 12
.fill 48, 4, 0xbf800000
Lst_7_0:
s_branch Lwr_162
s_nop 0
s_nop 0
Lov_7:
v_add_f32 v241, v241, v25
v_add_f32 v242, v242, v26
v_add_f32 v243, v243, v27
v_add_f32 v244, v244, v28
v_add_f32 v245, v245, v29
v_add_f32 v246, v246, v30
v_add_f32 v247, v247, v31
v_lshlrev_b32 v24, 16, v140
v_and_b32 v25, 0xffff0000, v140
v_lshlrev_b32 v26, 16, v141
v_and_b32 v27, 0xffff0000, v141
v_lshlrev_b32 v28, 16, v142
v_and_b32 v29, 0xffff0000, v142
v_lshlrev_b32 v30, 16, v143
v_and_b32 v31, 0xffff0000, v143
v_add_f32 v240, v240, v24
v_add_f32 v241, v241, v25
v_add_f32 v242, v242, v26
v_add_f32 v243, v243, v27
v_add_f32 v244, v244, v28
v_add_f32 v245, v245, v29
v_add_f32 v246, v246, v30
v_add_f32 v247, v247, v31
v_lshlrev_b32 v24, 16, v144
v_and_b32 v25, 0xffff0000, v144
v_lshlrev_b32 v26, 16, v145
v_and_b32 v27, 0xffff0000, v145
v_lshlrev_b32 v28, 16, v146
v_and_b32 v29, 0xffff0000, v146
v_lshlrev_b32 v30, 16, v147
v_and_b32 v31, 0xffff0000, v147
v_add_f32 v240, v240, v24
v_add_f32 v241, v241, v25
v_add_f32 v242, v242, v26
v_add_f32 v243, v243, v27
v_add_f32 v244, v244, v28
v_add_f32 v245, v245, v29
v_add_f32 v246, v246, v30
v_add_f32 v247, v247, v31
v_lshlrev_b32 v24, 16, v148
v_and_b32 v25, 0xffff0000, v148
v_lshlrev_b32 v26, 16, v149
v_and_b32 v27, 0xffff0000, v149
v_lshlrev_b32 v28, 16, v150
v_and_b32 v29, 0xffff0000, v150
v_lshlrev_b32 v30, 16, v151
v_and_b32 v31, 0xffff0000, v151
v_add_f32 v240, v240, v24
v_add_f32 v241, v241, v25
v_add_f32 v242, v242, v26
v_add_f32 v243, v243, v27
v_add_f32 v244, v244, v28
v_add_f32 v245, v245, v29
v_add_f32 v246, v246, v30
v_add_f32 v247, v247, v31
v_lshlrev_b32 v24, 16, v152
v_and_b32 v25, 0xffff0000, v152
v_lshlrev_b32 v26, 16, v153
v_and_b32 v27, 0xffff0000, v153
v_lshlrev_b32 v28, 16, v154
v_and_b32 v29, 0xffff0000, v154
v_lshlrev_b32 v30, 16, v155
v_and_b32 v31, 0xffff0000, v155
v_add_f32 v240, v240, v24
v_add_f32 v241, v241, v25
v_add_f32 v242, v242, v26
v_add_f32 v243, v243, v27
v_add_f32 v244, v244, v28
v_add_f32 v245, v245, v29
v_add_f32 v246, v246, v30
v_add_f32 v247, v247, v31
v_lshlrev_b32 v24, 16, v156
v_and_b32 v25, 0xffff0000, v156
v_lshlrev_b32 v26, 16, v157
v_and_b32 v27, 0xffff0000, v157
v_lshlrev_b32 v28, 16, v158
v_and_b32 v29, 0xffff0000, v158
v_lshlrev_b32 v30, 16, v159
v_and_b32 v31, 0xffff0000, v159
v_add_f32 v240, v240, v24
v_add_f32 v241, v241, v25
v_add_f32 v242, v242, v26
v_add_f32 v243, v243, v27
v_add_f32 v244, v244, v28
v_add_f32 v245, v245, v29
v_add_f32 v246, v246, v30
v_add_f32 v247, v247, v31
s_nop 0
v_permlane32_swap_b32 v240, v244
v_permlane32_swap_b32 v241, v245
v_permlane32_swap_b32 v242, v246
v_permlane32_swap_b32 v243, v247
v_add_f32 v240, v240, v244
v_add_f32 v241, v241, v245
v_add_f32 v242, v242, v246
v_add_f32 v243, v243, v247
s_nop 0
v_permlane16_swap_b32 v240, v242
v_permlane16_swap_b32 v241, v243
v_add_f32 v240, v240, v242
v_add_f32 v241, v241, v243
s_branch Lk3a
Lk2end_98:
Lk3:
s_branch Lgb_107
Lk3a:
s_mul_i32 s43, s34, 262144
s_add_u32 s8, s82, s43
s_addc_u32 s9, s83, 0
s_add_u32 s8, s8, 4194304
s_addc_u32 s9, s9, 0
s_mov_b32 s10, 262144
s_mov_b32 s11, 0x20000
s_mul_i32 s43, s34, 917504
s_add_u32 s24, s82, s43
s_addc_u32 s25, s83, 0
s_add_u32 s24, s24, 8388608
s_addc_u32 s25, s25, 0
s_mov_b32 s26, 917504
s_mov_b32 s27, 0x20000
s_add_u32 s84, s82, 27262976
s_addc_u32 s85, s83, 0
s_mov_b32 s86, 229376
s_mov_b32 s87, 0x20000
s_and_b32 s47, s36, 3
s_lshr_b32 s62, s47, 1
s_and_b32 s63, s47, 1
v_lshlrev_b32 v2, 4, v1
s_lshl_b32 s39, s47, 12
v_add_u32 v3, s39, v2
s_bitcmp0_b32 s36, 1
s_cselect_b32 s44, s72, s74
s_cselect_b32 s45, s73, s75
s_mul_i32 s43, s35, 256
s_add_u32 s12, s44, s43
s_addc_u32 s13, s45, 0
s_mov_b32 s14, 7333120
s_mov_b32 s15, 0x20000
s_and_b32 s43, s36, 1
s_mul_i32 s43, s43, 229376
v_lshrrev_b32 v28, 4, v1
v_lshlrev_b32 v29, 1, v28
v_and_b32 v4, 15, v1
v_xor_b32 v4, v4, v29
v_lshlrev_b32 v4, 4, v4
v_mul_u32_u24 v28, 7168, v28
v_add_u32 v4, v4, v28
v_add_u32 v4, s43, v4
v_xor_b32 v5, 128, v4
v_add_u32 v5, 28672, v5
s_and_b32 s43, s36, 3
s_mul_i32 s40, s43, 8192
s_add_u32 s40, s40, 16384
v_mov_b32 v6, v192
v_mov_b32 v7, v193
v_mov_b32 v8, v194
s_lshl_b32 s43, s62, 12
v_add_u32 v9, s43, v2
v_add_u32 v10, 98304, v9
v_lshrrev_b32 v27, 2, v1
v_bfe_u32 v28, v27, 2, 1
v_mul_u32_u24 v27, 192, v27
v_add_u32 v27, 16384, v27
v_and_b32 v29, 3, v1
v_lshl_add_u32 v12, v29, 3, v27
s_lshl_b32 s43, s63, 6
v_add_u32 v12, s43, v12
v_lshl_add_u32 v11, v28, 5, v12
v_xor_b32 v30, 1, v28
v_lshl_add_u32 v12, v30, 5, v12
v_xor_b32 v28, s63, v28
v_lshl_add_u32 v27, v28, 4, v27
v_lshrrev_b32 v28, 1, v29
v_lshl_add_u32 v27, v28, 5, v27
v_and_b32 v28, 1, v29
v_lshl_add_u32 v27, v28, 3, v27
v_add_u32 v13, 128, v27
v_add_u32 v14, 49152, v11
v_add_u32 v15, 49152, v12
v_add_u32 v16, 49152, v13
v_add_u32 v17, 98304, v11
v_add_u32 v18, 98304, v12
v_add_u32 v19, 98304, v13
s_cmp_lg_u32 s36, 4
s_cbranch_scc1 Lwm_109
s_branch Lst_8_1
Lwr_170:
s_branch Lwe_108
Lwm_109:
s_cmp_lg_u32 s36, 5
s_cbranch_scc1 Lwm_110
s_branch Lst_9_1
Lwr_171:
s_branch Lwe_108
Lwm_110:
s_cmp_lg_u32 s36, 6
s_cbranch_scc1 Lwm_111
s_branch Lst_10_1
Lwr_172:
s_branch Lwe_108
Lwm_111:
s_cmp_lg_u32 s36, 7
s_cbranch_scc1 Lwm_112
s_nop 0
s_branch Lwe_108
Lwm_112:
Lwe_108:
s_barrier
s_lshl_b32 s43, s47, 9
s_add_u32 s43, s43, 151552
v_and_b32 v28, 15, v1
v_lshl_add_u32 v28, v28, 5, s43
v_lshrrev_b32 v29, 4, v1
v_lshl_add_u32 v28, v29, 3, v28
ds_write_b64 v28, v[240:241]
s_waitcnt lgkmcnt(0)
s_cmp_lg_u32 s36, 4
s_cbranch_scc1 Lwm_114
s_branch Lst_11_1
Lwr_174:
s_branch Lwe_113
Lwm_114:
s_cmp_lg_u32 s36, 5
s_cbranch_scc1 Lwm_115
s_branch Lst_12_1
Lwr_175:
s_branch Lwe_113
Lwm_115:
s_cmp_lg_u32 s36, 6
s_cbranch_scc1 Lwm_116
s_branch Lst_13_1
Lwr_176:
s_branch Lwe_113
Lwm_116:
s_cmp_lg_u32 s36, 7
s_cbranch_scc1 Lwm_117
s_branch Lst_14_1
Lwr_177:
s_branch Lwe_113
Lwm_117:
Lwe_113:
s_waitcnt vmcnt(0) lgkmcnt(0)
s_barrier
ds_read_b128 v[32:35], v9 offset:0
ds_read_b64_tr_b16 v[48:49], v11 offset:0
ds_read_b64_tr_b16 v[50:51], v11 offset:3072
ds_read_b64_tr_b16 v[52:53], v12 offset:0
ds_read_b64_tr_b16 v[54:55], v12 offset:3072
ds_read_b64_tr_b16 v[56:57], v13 offset:0
ds_read_b64_tr_b16 v[58:59], v13 offset:3072
ds_read_b64_tr_b16 v[60:61], v11 offset:12288
ds_read_b64_tr_b16 v[62:63], v11 offset:15360
ds_read_b64_tr_b16 v[64:65], v12 offset:12288
ds_read_b64_tr_b16 v[66:67], v12 offset:15360
ds_read_b64_tr_b16 v[68:69], v13 offset:12288
ds_read_b64_tr_b16 v[70:71], v13 offset:15360
ds_read_b128 v[36:39], v9 offset:1024
ds_read_b128 v[40:43], v9 offset:2048
ds_read_b128 v[44:47], v9 offset:3072
s_waitcnt lgkmcnt(0)
v_mfma_f32_16x16x32_bf16 v[128:131], v[48:51], v[32:35], 0
ds_read_b128 v[72:75], v9 offset:8192
v_mfma_f32_16x16x32_bf16 v[152:155], v[48:51], v[36:39], 0
ds_read_b64_tr_b16 v[88:89], v11 offset:6144
v_mfma_f32_16x16x32_bf16 v[176:179], v[48:51], v[40:43], 0
ds_read_b64_tr_b16 v[90:91], v11 offset:9216
v_mfma_f32_16x16x32_bf16 v[200:203], v[48:51], v[44:47], 0
ds_read_b64_tr_b16 v[92:93], v12 offset:6144
v_mfma_f32_16x16x32_bf16 v[204:207], v[52:55], v[44:47], 0
ds_read_b64_tr_b16 v[94:95], v12 offset:9216
v_mfma_f32_16x16x32_bf16 v[180:183], v[52:55], v[40:43], 0
ds_read_b64_tr_b16 v[96:97], v13 offset:6144
v_mfma_f32_16x16x32_bf16 v[156:159], v[52:55], v[36:39], 0
ds_read_b64_tr_b16 v[98:99], v13 offset:9216
v_mfma_f32_16x16x32_bf16 v[132:135], v[52:55], v[32:35], 0
ds_read_b64_tr_b16 v[100:101], v11 offset:18432
v_mfma_f32_16x16x32_bf16 v[136:139], v[56:59], v[32:35], 0
ds_read_b64_tr_b16 v[102:103], v11 offset:21504
v_mfma_f32_16x16x32_bf16 v[160:163], v[56:59], v[36:39], 0
ds_read_b64_tr_b16 v[104:105], v12 offset:18432
v_mfma_f32_16x16x32_bf16 v[184:187], v[56:59], v[40:43], 0
ds_read_b64_tr_b16 v[106:107], v12 offset:21504
v_mfma_f32_16x16x32_bf16 v[208:211], v[56:59], v[44:47], 0
ds_read_b64_tr_b16 v[108:109], v13 offset:18432
v_mfma_f32_16x16x32_bf16 v[212:215], v[60:63], v[44:47], 0
ds_read_b64_tr_b16 v[110:111], v13 offset:21504
v_mfma_f32_16x16x32_bf16 v[188:191], v[60:63], v[40:43], 0
ds_read_b128 v[76:79], v9 offset:9216
v_mfma_f32_16x16x32_bf16 v[164:167], v[60:63], v[36:39], 0
ds_read_b128 v[80:83], v9 offset:10240
v_mfma_f32_16x16x32_bf16 v[140:143], v[60:63], v[32:35], 0
ds_read_b128 v[84:87], v9 offset:11264
v_mfma_f32_16x16x32_bf16 v[144:147], v[64:67], v[32:35], 0
v_mfma_f32_16x16x32_bf16 v[168:171], v[64:67], v[36:39], 0
v_mfma_f32_16x16x32_bf16 v[192:195], v[64:67], v[40:43], 0
v_mfma_f32_16x16x32_bf16 v[216:219], v[64:67], v[44:47], 0
v_mfma_f32_16x16x32_bf16 v[220:223], v[68:71], v[44:47], 0
v_mfma_f32_16x16x32_bf16 v[196:199], v[68:71], v[40:43], 0
v_mfma_f32_16x16x32_bf16 v[172:175], v[68:71], v[36:39], 0
v_mfma_f32_16x16x32_bf16 v[148:151], v[68:71], v[32:35], 0
s_waitcnt lgkmcnt(0)
s_barrier
v_mfma_f32_16x16x32_bf16 v[128:131], v[88:91], v[72:75], v[128:131]
ds_read_b128 v[32:35], v9 offset:49152
v_mfma_f32_16x16x32_bf16 v[152:155], v[88:91], v[76:79], v[152:155]
ds_read_b64_tr_b16 v[48:49], v14 offset:0
v_mfma_f32_16x16x32_bf16 v[176:179], v[88:91], v[80:83], v[176:179]
ds_read_b64_tr_b16 v[50:51], v14 offset:3072
v_mfma_f32_16x16x32_bf16 v[200:203], v[88:91], v[84:87], v[200:203]
ds_read_b64_tr_b16 v[52:53], v15 offset:0
v_mfma_f32_16x16x32_bf16 v[204:207], v[92:95], v[84:87], v[204:207]
ds_read_b64_tr_b16 v[54:55], v15 offset:3072
v_mfma_f32_16x16x32_bf16 v[180:183], v[92:95], v[80:83], v[180:183]
ds_read_b64_tr_b16 v[56:57], v16 offset:0
v_mfma_f32_16x16x32_bf16 v[156:159], v[92:95], v[76:79], v[156:159]
ds_read_b64_tr_b16 v[58:59], v16 offset:3072
v_mfma_f32_16x16x32_bf16 v[132:135], v[92:95], v[72:75], v[132:135]
ds_read_b64_tr_b16 v[60:61], v14 offset:12288
v_mfma_f32_16x16x32_bf16 v[136:139], v[96:99], v[72:75], v[136:139]
ds_read_b64_tr_b16 v[62:63], v14 offset:15360
v_mfma_f32_16x16x32_bf16 v[160:163], v[96:99], v[76:79], v[160:163]
ds_read_b64_tr_b16 v[64:65], v15 offset:12288
v_mfma_f32_16x16x32_bf16 v[184:187], v[96:99], v[80:83], v[184:187]
ds_read_b64_tr_b16 v[66:67], v15 offset:15360
v_mfma_f32_16x16x32_bf16 v[208:211], v[96:99], v[84:87], v[208:211]
ds_read_b64_tr_b16 v[68:69], v16 offset:12288
v_mfma_f32_16x16x32_bf16 v[212:215], v[100:103], v[84:87], v[212:215]
ds_read_b64_tr_b16 v[70:71], v16 offset:15360
v_mfma_f32_16x16x32_bf16 v[188:191], v[100:103], v[80:83], v[188:191]
ds_read_b128 v[36:39], v9 offset:50176
v_mfma_f32_16x16x32_bf16 v[164:167], v[100:103], v[76:79], v[164:167]
ds_read_b128 v[40:43], v9 offset:51200
v_mfma_f32_16x16x32_bf16 v[140:143], v[100:103], v[72:75], v[140:143]
ds_read_b128 v[44:47], v9 offset:52224
v_mfma_f32_16x16x32_bf16 v[144:147], v[104:107], v[72:75], v[144:147]
v_mfma_f32_16x16x32_bf16 v[168:171], v[104:107], v[76:79], v[168:171]
v_mfma_f32_16x16x32_bf16 v[192:195], v[104:107], v[80:83], v[192:195]
v_mfma_f32_16x16x32_bf16 v[216:219], v[104:107], v[84:87], v[216:219]
v_mfma_f32_16x16x32_bf16 v[220:223], v[108:111], v[84:87], v[220:223]
v_mfma_f32_16x16x32_bf16 v[196:199], v[108:111], v[80:83], v[196:199]
v_mfma_f32_16x16x32_bf16 v[172:175], v[108:111], v[76:79], v[172:175]
v_mfma_f32_16x16x32_bf16 v[148:151], v[108:111], v[72:75], v[148:151]
s_mov_b32 s41, 5
Lk3l_118:
s_waitcnt lgkmcnt(0)
v_mfma_f32_16x16x32_bf16 v[128:131], v[48:51], v[32:35], v[128:131]
ds_read_b128 v[72:75], v9 offset:57344
v_mfma_f32_16x16x32_bf16 v[152:155], v[48:51], v[36:39], v[152:155]
ds_read_b64_tr_b16 v[88:89], v14 offset:6144
v_mfma_f32_16x16x32_bf16 v[176:179], v[48:51], v[40:43], v[176:179]
ds_read_b64_tr_b16 v[90:91], v14 offset:9216
v_mfma_f32_16x16x32_bf16 v[200:203], v[48:51], v[44:47], v[200:203]
ds_read_b64_tr_b16 v[92:93], v15 offset:6144
v_mfma_f32_16x16x32_bf16 v[204:207], v[52:55], v[44:47], v[204:207]
ds_read_b64_tr_b16 v[94:95], v15 offset:9216
v_mfma_f32_16x16x32_bf16 v[180:183], v[52:55], v[40:43], v[180:183]
ds_read_b64_tr_b16 v[96:97], v16 offset:6144
v_mfma_f32_16x16x32_bf16 v[156:159], v[52:55], v[36:39], v[156:159]
ds_read_b64_tr_b16 v[98:99], v16 offset:9216
v_mfma_f32_16x16x32_bf16 v[132:135], v[52:55], v[32:35], v[132:135]
ds_read_b64_tr_b16 v[100:101], v14 offset:18432
v_mfma_f32_16x16x32_bf16 v[136:139], v[56:59], v[32:35], v[136:139]
ds_read_b64_tr_b16 v[102:103], v14 offset:21504
v_mfma_f32_16x16x32_bf16 v[160:163], v[56:59], v[36:39], v[160:163]
ds_read_b64_tr_b16 v[104:105], v15 offset:18432
v_mfma_f32_16x16x32_bf16 v[184:187], v[56:59], v[40:43], v[184:187]
ds_read_b64_tr_b16 v[106:107], v15 offset:21504
v_mfma_f32_16x16x32_bf16 v[208:211], v[56:59], v[44:47], v[208:211]
ds_read_b64_tr_b16 v[108:109], v16 offset:18432
v_mfma_f32_16x16x32_bf16 v[212:215], v[60:63], v[44:47], v[212:215]
ds_read_b64_tr_b16 v[110:111], v16 offset:21504
v_mfma_f32_16x16x32_bf16 v[188:191], v[60:63], v[40:43], v[188:191]
ds_read_b128 v[76:79], v9 offset:58368
v_mfma_f32_16x16x32_bf16 v[164:167], v[60:63], v[36:39], v[164:167]
ds_read_b128 v[80:83], v9 offset:59392
v_mfma_f32_16x16x32_bf16 v[140:143], v[60:63], v[32:35], v[140:143]
ds_read_b128 v[84:87], v9 offset:60416
v_mfma_f32_16x16x32_bf16 v[144:147], v[64:67], v[32:35], v[144:147]
v_mfma_f32_16x16x32_bf16 v[168:171], v[64:67], v[36:39], v[168:171]
v_mfma_f32_16x16x32_bf16 v[192:195], v[64:67], v[40:43], v[192:195]
v_mfma_f32_16x16x32_bf16 v[216:219], v[64:67], v[44:47], v[216:219]
v_mfma_f32_16x16x32_bf16 v[220:223], v[68:71], v[44:47], v[220:223]
v_mfma_f32_16x16x32_bf16 v[196:199], v[68:71], v[40:43], v[196:199]
v_mfma_f32_16x16x32_bf16 v[172:175], v[68:71], v[36:39], v[172:175]
v_mfma_f32_16x16x32_bf16 v[148:151], v[68:71], v[32:35], v[148:151]
s_waitcnt lgkmcnt(0)
s_barrier
v_mfma_f32_16x16x32_bf16 v[128:131], v[88:91], v[72:75], v[128:131]
ds_read_b128 v[32:35], v10 offset:0
v_mfma_f32_16x16x32_bf16 v[152:155], v[88:91], v[76:79], v[152:155]
ds_read_b64_tr_b16 v[48:49], v17 offset:0
v_mfma_f32_16x16x32_bf16 v[176:179], v[88:91], v[80:83], v[176:179]
ds_read_b64_tr_b16 v[50:51], v17 offset:3072
v_mfma_f32_16x16x32_bf16 v[200:203], v[88:91], v[84:87], v[200:203]
ds_read_b64_tr_b16 v[52:53], v18 offset:0
v_mfma_f32_16x16x32_bf16 v[204:207], v[92:95], v[84:87], v[204:207]
ds_read_b64_tr_b16 v[54:55], v18 offset:3072
v_mfma_f32_16x16x32_bf16 v[180:183], v[92:95], v[80:83], v[180:183]
ds_read_b64_tr_b16 v[56:57], v19 offset:0
v_mfma_f32_16x16x32_bf16 v[156:159], v[92:95], v[76:79], v[156:159]
ds_read_b64_tr_b16 v[58:59], v19 offset:3072
v_mfma_f32_16x16x32_bf16 v[132:135], v[92:95], v[72:75], v[132:135]
ds_read_b64_tr_b16 v[60:61], v17 offset:12288
v_mfma_f32_16x16x32_bf16 v[136:139], v[96:99], v[72:75], v[136:139]
ds_read_b64_tr_b16 v[62:63], v17 offset:15360
v_mfma_f32_16x16x32_bf16 v[160:163], v[96:99], v[76:79], v[160:163]
ds_read_b64_tr_b16 v[64:65], v18 offset:12288
v_mfma_f32_16x16x32_bf16 v[184:187], v[96:99], v[80:83], v[184:187]
ds_read_b64_tr_b16 v[66:67], v18 offset:15360
v_mfma_f32_16x16x32_bf16 v[208:211], v[96:99], v[84:87], v[208:211]
ds_read_b64_tr_b16 v[68:69], v19 offset:12288
v_mfma_f32_16x16x32_bf16 v[212:215], v[100:103], v[84:87], v[212:215]
ds_read_b64_tr_b16 v[70:71], v19 offset:15360
v_mfma_f32_16x16x32_bf16 v[188:191], v[100:103], v[80:83], v[188:191]
ds_read_b128 v[36:39], v10 offset:1024
v_mfma_f32_16x16x32_bf16 v[164:167], v[100:103], v[76:79], v[164:167]
ds_read_b128 v[40:43], v10 offset:2048
v_mfma_f32_16x16x32_bf16 v[140:143], v[100:103], v[72:75], v[140:143]
ds_read_b128 v[44:47], v10 offset:3072
v_mfma_f32_16x16x32_bf16 v[144:147], v[104:107], v[72:75], v[144:147]
v_mfma_f32_16x16x32_bf16 v[168:171], v[104:107], v[76:79], v[168:171]
v_mfma_f32_16x16x32_bf16 v[192:195], v[104:107], v[80:83], v[192:195]
v_mfma_f32_16x16x32_bf16 v[216:219], v[104:107], v[84:87], v[216:219]
v_mfma_f32_16x16x32_bf16 v[220:223], v[108:111], v[84:87], v[220:223]
v_mfma_f32_16x16x32_bf16 v[196:199], v[108:111], v[80:83], v[196:199]
v_mfma_f32_16x16x32_bf16 v[172:175], v[108:111], v[76:79], v[172:175]
v_mfma_f32_16x16x32_bf16 v[148:151], v[108:111], v[72:75], v[148:151]
s_waitcnt lgkmcnt(0)
v_mfma_f32_16x16x32_bf16 v[128:131], v[48:51], v[32:35], v[128:131]
ds_read_b128 v[72:75], v10 offset:8192
v_mfma_f32_16x16x32_bf16 v[152:155], v[48:51], v[36:39], v[152:155]
ds_read_b64_tr_b16 v[88:89], v17 offset:6144
v_mfma_f32_16x16x32_bf16 v[176:179], v[48:51], v[40:43], v[176:179]
ds_read_b64_tr_b16 v[90:91], v17 offset:9216
v_mfma_f32_16x16x32_bf16 v[200:203], v[48:51], v[44:47], v[200:203]
ds_read_b64_tr_b16 v[92:93], v18 offset:6144
v_mfma_f32_16x16x32_bf16 v[204:207], v[52:55], v[44:47], v[204:207]
ds_read_b64_tr_b16 v[94:95], v18 offset:9216
v_mfma_f32_16x16x32_bf16 v[180:183], v[52:55], v[40:43], v[180:183]
ds_read_b64_tr_b16 v[96:97], v19 offset:6144
v_mfma_f32_16x16x32_bf16 v[156:159], v[52:55], v[36:39], v[156:159]
ds_read_b64_tr_b16 v[98:99], v19 offset:9216
v_mfma_f32_16x16x32_bf16 v[132:135], v[52:55], v[32:35], v[132:135]
ds_read_b64_tr_b16 v[100:101], v17 offset:18432
v_mfma_f32_16x16x32_bf16 v[136:139], v[56:59], v[32:35], v[136:139]
ds_read_b64_tr_b16 v[102:103], v17 offset:21504
v_mfma_f32_16x16x32_bf16 v[160:163], v[56:59], v[36:39], v[160:163]
ds_read_b64_tr_b16 v[104:105], v18 offset:18432
v_mfma_f32_16x16x32_bf16 v[184:187], v[56:59], v[40:43], v[184:187]
ds_read_b64_tr_b16 v[106:107], v18 offset:21504
v_mfma_f32_16x16x32_bf16 v[208:211], v[56:59], v[44:47], v[208:211]
ds_read_b64_tr_b16 v[108:109], v19 offset:18432
v_mfma_f32_16x16x32_bf16 v[212:215], v[60:63], v[44:47], v[212:215]
ds_read_b64_tr_b16 v[110:111], v19 offset:21504
v_mfma_f32_16x16x32_bf16 v[188:191], v[60:63], v[40:43], v[188:191]
ds_read_b128 v[76:79], v10 offset:9216
v_mfma_f32_16x16x32_bf16 v[164:167], v[60:63], v[36:39], v[164:167]
ds_read_b128 v[80:83], v10 offset:10240
v_mfma_f32_16x16x32_bf16 v[140:143], v[60:63], v[32:35], v[140:143]
ds_read_b128 v[84:87], v10 offset:11264
v_mfma_f32_16x16x32_bf16 v[144:147], v[64:67], v[32:35], v[144:147]
v_mfma_f32_16x16x32_bf16 v[168:171], v[64:67], v[36:39], v[168:171]
v_mfma_f32_16x16x32_bf16 v[192:195], v[64:67], v[40:43], v[192:195]
v_mfma_f32_16x16x32_bf16 v[216:219], v[64:67], v[44:47], v[216:219]
v_mfma_f32_16x16x32_bf16 v[220:223], v[68:71], v[44:47], v[220:223]
v_mfma_f32_16x16x32_bf16 v[196:199], v[68:71], v[40:43], v[196:199]
v_mfma_f32_16x16x32_bf16 v[172:175], v[68:71], v[36:39], v[172:175]
v_mfma_f32_16x16x32_bf16 v[148:151], v[68:71], v[32:35], v[148:151]
s_waitcnt lgkmcnt(0)
s_barrier
v_mfma_f32_16x16x32_bf16 v[128:131], v[88:91], v[72:75], v[128:131]
ds_read_b128 v[32:35], v9 offset:0
v_mfma_f32_16x16x32_bf16 v[152:155], v[88:91], v[76:79], v[152:155]
ds_read_b64_tr_b16 v[48:49], v11 offset:0
v_mfma_f32_16x16x32_bf16 v[176:179], v[88:91], v[80:83], v[176:179]
ds_read_b64_tr_b16 v[50:51], v11 offset:3072
v_mfma_f32_16x16x32_bf16 v[200:203], v[88:91], v[84:87], v[200:203]
ds_read_b64_tr_b16 v[52:53], v12 offset:0
v_mfma_f32_16x16x32_bf16 v[204:207], v[92:95], v[84:87], v[204:207]
ds_read_b64_tr_b16 v[54:55], v12 offset:3072
v_mfma_f32_16x16x32_bf16 v[180:183], v[92:95], v[80:83], v[180:183]
ds_read_b64_tr_b16 v[56:57], v13 offset:0
v_mfma_f32_16x16x32_bf16 v[156:159], v[92:95], v[76:79], v[156:159]
ds_read_b64_tr_b16 v[58:59], v13 offset:3072
v_mfma_f32_16x16x32_bf16 v[132:135], v[92:95], v[72:75], v[132:135]
ds_read_b64_tr_b16 v[60:61], v11 offset:12288
v_mfma_f32_16x16x32_bf16 v[136:139], v[96:99], v[72:75], v[136:139]
ds_read_b64_tr_b16 v[62:63], v11 offset:15360
v_mfma_f32_16x16x32_bf16 v[160:163], v[96:99], v[76:79], v[160:163]
ds_read_b64_tr_b16 v[64:65], v12 offset:12288
v_mfma_f32_16x16x32_bf16 v[184:187], v[96:99], v[80:83], v[184:187]
ds_read_b64_tr_b16 v[66:67], v12 offset:15360
v_mfma_f32_16x16x32_bf16 v[208:211], v[96:99], v[84:87], v[208:211]
ds_read_b64_tr_b16 v[68:69], v13 offset:12288
v_mfma_f32_16x16x32_bf16 v[212:215], v[100:103], v[84:87], v[212:215]
ds_read_b64_tr_b16 v[70:71], v13 offset:15360
v_mfma_f32_16x16x32_bf16 v[188:191], v[100:103], v[80:83], v[188:191]
ds_read_b128 v[36:39], v9 offset:1024
v_mfma_f32_16x16x32_bf16 v[164:167], v[100:103], v[76:79], v[164:167]
ds_read_b128 v[40:43], v9 offset:2048
v_mfma_f32_16x16x32_bf16 v[140:143], v[100:103], v[72:75], v[140:143]
ds_read_b128 v[44:47], v9 offset:3072
v_mfma_f32_16x16x32_bf16 v[144:147], v[104:107], v[72:75], v[144:147]
v_mfma_f32_16x16x32_bf16 v[168:171], v[104:107], v[76:79], v[168:171]
v_mfma_f32_16x16x32_bf16 v[192:195], v[104:107], v[80:83], v[192:195]
v_mfma_f32_16x16x32_bf16 v[216:219], v[104:107], v[84:87], v[216:219]
v_mfma_f32_16x16x32_bf16 v[220:223], v[108:111], v[84:87], v[220:223]
v_mfma_f32_16x16x32_bf16 v[196:199], v[108:111], v[80:83], v[196:199]
v_mfma_f32_16x16x32_bf16 v[172:175], v[108:111], v[76:79], v[172:175]
v_mfma_f32_16x16x32_bf16 v[148:151], v[108:111], v[72:75], v[148:151]
s_waitcnt lgkmcnt(0)
v_mfma_f32_16x16x32_bf16 v[128:131], v[48:51], v[32:35], v[128:131]
ds_read_b128 v[72:75], v9 offset:8192
v_mfma_f32_16x16x32_bf16 v[152:155], v[48:51], v[36:39], v[152:155]
ds_read_b64_tr_b16 v[88:89], v11 offset:6144
v_mfma_f32_16x16x32_bf16 v[176:179], v[48:51], v[40:43], v[176:179]
ds_read_b64_tr_b16 v[90:91], v11 offset:9216
v_mfma_f32_16x16x32_bf16 v[200:203], v[48:51], v[44:47], v[200:203]
ds_read_b64_tr_b16 v[92:93], v12 offset:6144
v_mfma_f32_16x16x32_bf16 v[204:207], v[52:55], v[44:47], v[204:207]
ds_read_b64_tr_b16 v[94:95], v12 offset:9216
v_mfma_f32_16x16x32_bf16 v[180:183], v[52:55], v[40:43], v[180:183]
ds_read_b64_tr_b16 v[96:97], v13 offset:6144
v_mfma_f32_16x16x32_bf16 v[156:159], v[52:55], v[36:39], v[156:159]
ds_read_b64_tr_b16 v[98:99], v13 offset:9216
v_mfma_f32_16x16x32_bf16 v[132:135], v[52:55], v[32:35], v[132:135]
ds_read_b64_tr_b16 v[100:101], v11 offset:18432
v_mfma_f32_16x16x32_bf16 v[136:139], v[56:59], v[32:35], v[136:139]
ds_read_b64_tr_b16 v[102:103], v11 offset:21504
v_mfma_f32_16x16x32_bf16 v[160:163], v[56:59], v[36:39], v[160:163]
ds_read_b64_tr_b16 v[104:105], v12 offset:18432
v_mfma_f32_16x16x32_bf16 v[184:187], v[56:59], v[40:43], v[184:187]
ds_read_b64_tr_b16 v[106:107], v12 offset:21504
v_mfma_f32_16x16x32_bf16 v[208:211], v[56:59], v[44:47], v[208:211]
ds_read_b64_tr_b16 v[108:109], v13 offset:18432
v_mfma_f32_16x16x32_bf16 v[212:215], v[60:63], v[44:47], v[212:215]
ds_read_b64_tr_b16 v[110:111], v13 offset:21504
v_mfma_f32_16x16x32_bf16 v[188:191], v[60:63], v[40:43], v[188:191]
ds_read_b128 v[76:79], v9 offset:9216
v_mfma_f32_16x16x32_bf16 v[164:167], v[60:63], v[36:39], v[164:167]
ds_read_b128 v[80:83], v9 offset:10240
v_mfma_f32_16x16x32_bf16 v[140:143], v[60:63], v[32:35], v[140:143]
ds_read_b128 v[84:87], v9 offset:11264
v_mfma_f32_16x16x32_bf16 v[144:147], v[64:67], v[32:35], v[144:147]
v_mfma_f32_16x16x32_bf16 v[168:171], v[64:67], v[36:39], v[168:171]
v_mfma_f32_16x16x32_bf16 v[192:195], v[64:67], v[40:43], v[192:195]
v_mfma_f32_16x16x32_bf16 v[216:219], v[64:67], v[44:47], v[216:219]
v_mfma_f32_16x16x32_bf16 v[220:223], v[68:71], v[44:47], v[220:223]
v_mfma_f32_16x16x32_bf16 v[196:199], v[68:71], v[40:43], v[196:199]
v_mfma_f32_16x16x32_bf16 v[172:175], v[68:71], v[36:39], v[172:175]
v_mfma_f32_16x16x32_bf16 v[148:151], v[68:71], v[32:35], v[148:151]
s_waitcnt lgkmcnt(0)
s_barrier
v_mfma_f32_16x16x32_bf16 v[128:131], v[88:91], v[72:75], v[128:131]
ds_read_b128 v[32:35], v9 offset:49152
v_mfma_f32_16x16x32_bf16 v[152:155], v[88:91], v[76:79], v[152:155]
ds_read_b64_tr_b16 v[48:49], v14 offset:0
v_mfma_f32_16x16x32_bf16 v[176:179], v[88:91], v[80:83], v[176:179]
ds_read_b64_tr_b16 v[50:51], v14 offset:3072
v_mfma_f32_16x16x32_bf16 v[200:203], v[88:91], v[84:87], v[200:203]
ds_read_b64_tr_b16 v[52:53], v15 offset:0
v_mfma_f32_16x16x32_bf16 v[204:207], v[92:95], v[84:87], v[204:207]
ds_read_b64_tr_b16 v[54:55], v15 offset:3072
v_mfma_f32_16x16x32_bf16 v[180:183], v[92:95], v[80:83], v[180:183]
ds_read_b64_tr_b16 v[56:57], v16 offset:0
v_mfma_f32_16x16x32_bf16 v[156:159], v[92:95], v[76:79], v[156:159]
ds_read_b64_tr_b16 v[58:59], v16 offset:3072
v_mfma_f32_16x16x32_bf16 v[132:135], v[92:95], v[72:75], v[132:135]
ds_read_b64_tr_b16 v[60:61], v14 offset:12288
v_mfma_f32_16x16x32_bf16 v[136:139], v[96:99], v[72:75], v[136:139]
ds_read_b64_tr_b16 v[62:63], v14 offset:15360
v_mfma_f32_16x16x32_bf16 v[160:163], v[96:99], v[76:79], v[160:163]
ds_read_b64_tr_b16 v[64:65], v15 offset:12288
v_mfma_f32_16x16x32_bf16 v[184:187], v[96:99], v[80:83], v[184:187]
ds_read_b64_tr_b16 v[66:67], v15 offset:15360
v_mfma_f32_16x16x32_bf16 v[208:211], v[96:99], v[84:87], v[208:211]
ds_read_b64_tr_b16 v[68:69], v16 offset:12288
v_mfma_f32_16x16x32_bf16 v[212:215], v[100:103], v[84:87], v[212:215]
ds_read_b64_tr_b16 v[70:71], v16 offset:15360
v_mfma_f32_16x16x32_bf16 v[188:191], v[100:103], v[80:83], v[188:191]
ds_read_b128 v[36:39], v9 offset:50176
v_mfma_f32_16x16x32_bf16 v[164:167], v[100:103], v[76:79], v[164:167]
ds_read_b128 v[40:43], v9 offset:51200
v_mfma_f32_16x16x32_bf16 v[140:143], v[100:103], v[72:75], v[140:143]
ds_read_b128 v[44:47], v9 offset:52224
v_mfma_f32_16x16x32_bf16 v[144:147], v[104:107], v[72:75], v[144:147]
v_mfma_f32_16x16x32_bf16 v[168:171], v[104:107], v[76:79], v[168:171]
v_mfma_f32_16x16x32_bf16 v[192:195], v[104:107], v[80:83], v[192:195]
v_mfma_f32_16x16x32_bf16 v[216:219], v[104:107], v[84:87], v[216:219]
v_mfma_f32_16x16x32_bf16 v[220:223], v[108:111], v[84:87], v[220:223]
v_mfma_f32_16x16x32_bf16 v[196:199], v[108:111], v[80:83], v[196:199]
v_mfma_f32_16x16x32_bf16 v[172:175], v[108:111], v[76:79], v[172:175]
v_mfma_f32_16x16x32_bf16 v[148:151], v[108:111], v[72:75], v[148:151]
s_sub_u32 s41, s41, 1
s_cmp_lg_u32 s41, 0
s_cbranch_scc1 Lk3l_118
s_branch Lov_8
.p2align 12
.fill 64, 4, 0xbf800000
Lst_8_0:
s_branch Lwr_163
Lst_8_1:
s_branch Lwr_170
s_nop 0
Lov_8:
s_waitcnt lgkmcnt(0)
s_add_u32 s38, s35, 15
s_and_b32 s38, s38, 15
s_mul_i32 s38, s38, 458752
s_add_u32 m0, s40, 0
s_nop 0
buffer_load_dwordx4 v4, s[12:15], s38 offen lds
v_lshrrev_b32 v86, 4, v1
s_lshl_b32 s43, s63, 7
s_add_u32 s43, s43, 148992
v_lshl_add_u32 v87, v86, 4, s43
v_lshrrev_b32 v88, 1, v86
v_and_b32 v86, 1, v86
s_add_u32 m0, s40, 1024
s_nop 0
buffer_load_dwordx4 v5, s[12:15], s38 offen lds
s_lshl_b32 s43, s63, 5
s_add_u32 s43, s43, 149248
v_lshl_add_u32 v88, v88, 6, s43
v_lshl_add_u32 v88, v86, 4, v88
v_and_b32 v86, 15, v1
s_lshl_b32 s43, s62, 9
s_add_u32 m0, s40, 2048
s_add_u32 s38, s38, 57344
buffer_load_dwordx4 v4, s[12:15], s38 offen lds
s_add_u32 s43, s43, 147456
v_lshl_add_u32 v86, v86, 3, s43
ds_read_b128 v[32:35], v87 offset:0
ds_read_b128 v[36:39], v87 offset:64
ds_read_b128 v[40:43], v88 offset:0
ds_read_b128 v[44:47], v87 offset:896
s_add_u32 m0, s40, 3072
s_nop 0
buffer_load_dwordx4 v5, s[12:15], s38 offen lds
ds_read_b128 v[48:51], v87 offset:960
ds_read_b128 v[52:55], v88 offset:896
ds_read_b64 v[56:57], v86 offset:0
ds_read_b64 v[58:59], v86 offset:128
ds_read_b64 v[60:61], v86 offset:256
ds_read_b64 v[62:63], v86 offset:384
s_add_u32 m0, s40, 4096
s_add_u32 s38, s38, 57344
buffer_load_dwordx4 v4, s[12:15], s38 offen lds
s_mul_i32 s54, s35, 24576
s_lshl_b32 s43, s62, 12
s_add_u32 s54, s54, s43
s_add_u32 s54, s54, 524288
s_lshl_b32 s43, s63, 9
s_add_u32 s55, s54, s43
s_add_u32 m0, s40, 5120
s_nop 0
buffer_load_dwordx4 v5, s[12:15], s38 offen lds
s_add_u32 s55, s55, 16384
s_lshl_b32 s43, s63, 13
s_add_u32 s54, s54, s43
v_and_b32 v84, 32, v1
v_lshlrev_b32 v84, 4, v84
v_add_u32 v84, v84, v2
s_waitcnt lgkmcnt(0)
s_add_u32 m0, s40, 6144
s_add_u32 s38, s38, 57344
buffer_load_dwordx4 v4, s[12:15], s38 offen lds
s_add_u32 m0, s40, 7168
s_nop 0
buffer_load_dwordx4 v5, s[12:15], s38 offen lds
s_and_b32 s44, s36, 3
s_mul_i32 s43, s2, 28672
s_mul_i32 s44, s44, 7168
s_add_u32 s43, s43, s44
s_add_u32 s4, s76, s43
s_addc_u32 s5, s77, 0
s_barrier
s_cmp_eq_u32 s47, 3
s_cbranch_scc0 Lw_119
v_and_b32 v90, 31, v1
v_lshlrev_b32 v90, 4, v90
v_add_u32 v91, 153600, v90
ds_read_b128 v[108:111], v91 offset:0
ds_read_b128 v[112:115], v91 offset:512
ds_read_b128 v[116:119], v91 offset:1024
ds_read_b128 v[120:123], v91 offset:1536
s_and_b32 s44, s2, 15
s_mul_i32 s44, s44, 14336
s_lshr_b32 s43, s2, 4
s_lshl_b32 s43, s43, 9
s_add_u32 s44, s44, s43
s_waitcnt lgkmcnt(0)
v_add_f32 v108, v108, v112
v_add_f32 v116, v116, v120
v_add_f32 v109, v109, v113
v_add_f32 v117, v117, v121
v_add_f32 v110, v110, v114
v_add_f32 v118, v118, v122
v_add_f32 v111, v111, v115
v_add_f32 v119, v119, v123
v_add_f32 v108, v108, v116
v_add_f32 v109, v109, v117
v_add_f32 v110, v110, v118
v_add_f32 v111, v111, v119
s_mov_b64 exec, 0xffffffff
buffer_store_dwordx4 v[108:111], v90, s[84:87], s44 offen sc1
s_mov_b64 exec, -1
Lw_119:
s_waitcnt lgkmcnt(0)
s_add_u32 s37, s35, 0
s_and_b32 s37, s37, 15
s_mul_i32 s37, s37, 16384
s_add_u32 m0, s39, 49152
s_nop 0
buffer_load_dwordx4 v3, s[8:11], s37 offen sc1 lds
s_load_dword s3, s[4:5], 1792
s_load_dword s3, s[4:5], 1856
s_load_dword s3, s[4:5], 1920
s_load_dword s3, s[4:5], 1984
s_load_dword s3, s[4:5], 2048
s_load_dword s3, s[4:5], 2112
s_load_dword s3, s[4:5], 2176
buffer_load_dwordx4 v3, s[8:11], s37 offen offset:1024 sc1 lds
s_load_dword s3, s[4:5], 2240
s_load_dword s3, s[4:5], 2304
s_load_dword s3, s[4:5], 2368
s_load_dword s3, s[4:5], 2432
s_load_dword s3, s[4:5], 2496
s_load_dword s3, s[4:5], 2560
s_load_dword s3, s[4:5], 2624
buffer_load_dwordx4 v3, s[8:11], s37 offen offset:2048 sc1 lds
v_mul_f32 v66, v57, v57
v_mul_f32 v64, 0xc0135761, v57
v_mul_f32 v65, 0xbdd2d3e8, v57
v_mul_f32 v65, v65, v66
v_rcp_f32 v66, v66
v_mul_f32 v70, v59, v59
v_mul_f32 v68, 0xc0135761, v59
buffer_load_dwordx4 v3, s[8:11], s37 offen offset:3072 sc1 lds
v_mul_f32 v69, 0xbdd2d3e8, v59
v_mul_f32 v69, v69, v70
v_rcp_f32 v70, v70
v_fma_f32 v128, -v56, v32, v128
v_fma_f32 v129, -v56, v33, v129
v_fma_f32 v130, -v56, v34, v130
v_fma_f32 v131, -v56, v35, v131
v_fma_f32 v152, -v58, v32, v152
s_add_u32 s38, s35, 0
s_and_b32 s38, s38, 15
s_mul_i32 s38, s38, 458752
s_add_u32 m0, s40, 49152
s_nop 0
buffer_load_dwordx4 v4, s[12:15], s38 offen lds
v_fma_f32 v153, -v58, v33, v153
v_fma_f32 v154, -v58, v34, v154
v_fma_f32 v155, -v58, v35, v155
v_mul_f32 v72, v128, v128
v_mul_f32 v73, v129, v129
v_mul_f32 v74, v130, v130
v_mul_f32 v75, v131, v131
s_add_u32 m0, s40, 50176
s_nop 0
buffer_load_dwordx4 v5, s[12:15], s38 offen lds
v_mul_f32 v76, v152, v152
v_mul_f32 v77, v153, v153
v_mul_f32 v78, v154, v154
v_mul_f32 v79, v155, v155
v_fma_f32 v72, v72, v65, v64
v_fma_f32 v73, v73, v65, v64
v_fma_f32 v74, v74, v65, v64
s_add_u32 m0, s40, 51200
s_add_u32 s38, s38, 57344
buffer_load_dwordx4 v4, s[12:15], s38 offen lds
v_fma_f32 v75, v75, v65, v64
v_fma_f32 v76, v76, v69, v68
v_fma_f32 v77, v77, v69, v68
v_fma_f32 v78, v78, v69, v68
v_fma_f32 v79, v79, v69, v68
v_mul_f32 v72, v72, v128
v_mul_f32 v73, v73, v129
v_mul_f32 v74, v74, v130
s_add_u32 m0, s40, 52224
s_nop 0
buffer_load_dwordx4 v5, s[12:15], s38 offen lds
v_mul_f32 v75, v75, v131
v_mul_f32 v76, v76, v152
v_mul_f32 v77, v77, v153
v_mul_f32 v78, v78, v154
v_mul_f32 v79, v79, v155
v_exp_f32 v72, v72
v_exp_f32 v73, v73
s_add_u32 m0, s40, 53248
s_add_u32 s38, s38, 57344
buffer_load_dwordx4 v4, s[12:15], s38 offen lds
v_exp_f32 v74, v74
v_exp_f32 v75, v75
v_exp_f32 v76, v76
v_exp_f32 v77, v77
v_exp_f32 v78, v78
v_exp_f32 v79, v79
v_fma_f32 v140, -v56, v44, v140
s_add_u32 m0, s40, 54272
s_nop 0
buffer_load_dwordx4 v5, s[12:15], s38 offen lds
v_fma_f32 v141, -v56, v45, v141
v_fma_f32 v142, -v56, v46, v142
v_fma_f32 v143, -v56, v47, v143
v_fma_f32 v164, -v58, v44, v164
v_fma_f32 v165, -v58, v45, v165
v_fma_f32 v166, -v58, v46, v166
v_fma_f32 v167, -v58, v47, v167
v_fma_f32 v72, v72, v66, v66
s_add_u32 m0, s40, 55296
s_add_u32 s38, s38, 57344
buffer_load_dwordx4 v4, s[12:15], s38 offen lds
s_add_u32 m0, s40, 56320
s_nop 0
buffer_load_dwordx4 v5, s[12:15], s38 offen lds
s_waitcnt vmcnt(12)
s_barrier
s_add_u32 s37, s35, 1
s_and_b32 s37, s37, 15
s_mul_i32 s37, s37, 16384
s_add_u32 m0, s39, 98304
s_nop 0
buffer_load_dwordx4 v3, s[8:11], s37 offen sc1 lds
v_fma_f32 v73, v73, v66, v66
v_fma_f32 v74, v74, v66, v66
v_fma_f32 v75, v75, v66, v66
v_fma_f32 v76, v76, v70, v70
v_fma_f32 v77, v77, v70, v70
v_fma_f32 v78, v78, v70, v70
buffer_load_dwordx4 v3, s[8:11], s37 offen offset:1024 sc1 lds
v_fma_f32 v79, v79, v70, v70
v_rcp_f32 v72, v72
v_rcp_f32 v73, v73
v_rcp_f32 v74, v74
v_rcp_f32 v75, v75
v_rcp_f32 v76, v76
buffer_load_dwordx4 v3, s[8:11], s37 offen offset:2048 sc1 lds
v_rcp_f32 v77, v77
v_rcp_f32 v78, v78
v_rcp_f32 v79, v79
v_mul_f32 v140, v128, v140
v_mul_f32 v141, v129, v141
v_mul_f32 v142, v130, v142
buffer_load_dwordx4 v3, s[8:11], s37 offen offset:3072 sc1 lds
v_mul_f32 v143, v131, v143
v_mul_f32 v164, v152, v164
v_mul_f32 v165, v153, v165
v_mul_f32 v166, v154, v166
v_mul_f32 v167, v155, v167
v_mul_f32 v140, v140, v72
s_add_u32 s38, s35, 1
s_and_b32 s38, s38, 15
s_mul_i32 s38, s38, 458752
s_add_u32 m0, s40, 98304
s_nop 0
buffer_load_dwordx4 v4, s[12:15], s38 offen lds
v_mul_f32 v141, v141, v73
v_mul_f32 v142, v142, v74
v_mul_f32 v143, v143, v75
v_mul_f32 v164, v164, v76
v_mul_f32 v165, v165, v77
v_mul_f32 v166, v166, v78
s_add_u32 m0, s40, 99328
s_nop 0
buffer_load_dwordx4 v5, s[12:15], s38 offen lds
v_mul_f32 v167, v167, v79
v_cvt_pk_bf16_f32 v128, v140, v141
v_cvt_pk_bf16_f32 v129, v142, v143
v_cvt_pk_bf16_f32 v152, v164, v165
v_cvt_pk_bf16_f32 v153, v166, v167
v_fma_f32 v132, -v56, v36, v132
s_add_u32 m0, s40, 100352
s_add_u32 s38, s38, 57344
buffer_load_dwordx4 v4, s[12:15], s38 offen lds
v_fma_f32 v133, -v56, v37, v133
v_fma_f32 v134, -v56, v38, v134
v_fma_f32 v135, -v56, v39, v135
v_fma_f32 v156, -v58, v36, v156
v_fma_f32 v157, -v58, v37, v157
v_fma_f32 v158, -v58, v38, v158
s_add_u32 m0, s40, 101376
s_nop 0
buffer_load_dwordx4 v5, s[12:15], s38 offen lds
v_fma_f32 v159, -v58, v39, v159
v_mul_f32 v72, v132, v132
v_mul_f32 v73, v133, v133
v_mul_f32 v74, v134, v134
v_mul_f32 v75, v135, v135
v_mul_f32 v76, v156, v156
s_add_u32 m0, s40, 102400
s_add_u32 s38, s38, 57344
buffer_load_dwordx4 v4, s[12:15], s38 offen lds
v_mul_f32 v77, v157, v157
v_mul_f32 v78, v158, v158
v_mul_f32 v79, v159, v159
v_fma_f32 v72, v72, v65, v64
v_fma_f32 v73, v73, v65, v64
v_fma_f32 v74, v74, v65, v64
s_add_u32 m0, s40, 103424
s_nop 0
buffer_load_dwordx4 v5, s[12:15], s38 offen lds
v_fma_f32 v75, v75, v65, v64
v_fma_f32 v76, v76, v69, v68
v_fma_f32 v77, v77, v69, v68
v_fma_f32 v78, v78, v69, v68
v_fma_f32 v79, v79, v69, v68
v_mul_f32 v72, v72, v132
s_add_u32 m0, s40, 104448
s_add_u32 s38, s38, 57344
buffer_load_dwordx4 v4, s[12:15], s38 offen lds
s_add_u32 m0, s40, 105472
s_nop 0
buffer_load_dwordx4 v5, s[12:15], s38 offen lds
s_waitcnt vmcnt(12)
s_barrier
s_cmp_eq_u32 s47, 3
s_cbranch_scc0 Lw_120
s_lshr_b32 s43, s2, 4
s_add_u32 s43, s43, 80
s_lshl_b32 s43, s43, 7
v_mov_b32 v90, s43
v_mov_b32 v91, 1
s_mov_b64 exec, 1
buffer_atomic_add v91, v90, s[56:59], 0 offen sc1
s_mov_b64 exec, -1
Lw_120:
s_waitcnt lgkmcnt(0)
s_add_u32 s37, s35, 2
s_and_b32 s37, s37, 15
s_mul_i32 s37, s37, 16384
s_add_u32 m0, s39, 0
s_nop 0
buffer_load_dwordx4 v3, s[8:11], s37 offen sc1 lds
s_load_dword s3, s[4:5], 2688
s_load_dword s3, s[4:5], 2752
s_load_dword s3, s[4:5], 2816
s_load_dword s3, s[4:5], 2880
s_load_dword s3, s[4:5], 2944
s_load_dword s3, s[4:5], 3008
s_load_dword s3, s[4:5], 3072
buffer_load_dwordx4 v3, s[8:11], s37 offen offset:1024 sc1 lds
s_load_dword s3, s[4:5], 3136
s_load_dword s3, s[4:5], 3200
s_load_dword s3, s[4:5], 3264
s_load_dword s3, s[4:5], 3328
s_load_dword s3, s[4:5], 3392
s_load_dword s3, s[4:5], 3456
s_load_dword s3, s[4:5], 3520
buffer_load_dwordx4 v3, s[8:11], s37 offen offset:2048 sc1 lds
v_mul_f32 v73, v73, v133
v_mul_f32 v74, v74, v134
v_mul_f32 v75, v75, v135
v_mul_f32 v76, v76, v156
v_mul_f32 v77, v77, v157
v_mul_f32 v78, v78, v158
v_mul_f32 v79, v79, v159
v_exp_f32 v72, v72
buffer_load_dwordx4 v3, s[8:11], s37 offen offset:3072 sc1 lds
v_exp_f32 v73, v73
v_exp_f32 v74, v74
v_exp_f32 v75, v75
v_exp_f32 v76, v76
v_exp_f32 v77, v77
v_exp_f32 v78, v78
v_exp_f32 v79, v79
s_add_u32 s38, s35, 2
s_and_b32 s38, s38, 15
s_mul_i32 s38, s38, 458752
s_add_u32 m0, s40, 0
s_nop 0
buffer_load_dwordx4 v4, s[12:15], s38 offen lds
v_fma_f32 v144, -v56, v48, v144
v_fma_f32 v145, -v56, v49, v145
v_fma_f32 v146, -v56, v50, v146
v_fma_f32 v147, -v56, v51, v147
v_fma_f32 v168, -v58, v48, v168
v_fma_f32 v169, -v58, v49, v169
v_fma_f32 v170, -v58, v50, v170
v_fma_f32 v171, -v58, v51, v171
s_add_u32 m0, s40, 1024
s_nop 0
buffer_load_dwordx4 v5, s[12:15], s38 offen lds
v_fma_f32 v72, v72, v66, v66
v_fma_f32 v73, v73, v66, v66
v_fma_f32 v74, v74, v66, v66
v_fma_f32 v75, v75, v66, v66
v_fma_f32 v76, v76, v70, v70
v_fma_f32 v77, v77, v70, v70
v_fma_f32 v78, v78, v70, v70
s_add_u32 m0, s40, 2048
s_add_u32 s38, s38, 57344
buffer_load_dwordx4 v4, s[12:15], s38 offen lds
v_fma_f32 v79, v79, v70, v70
v_rcp_f32 v72, v72
v_rcp_f32 v73, v73
v_rcp_f32 v74, v74
v_rcp_f32 v75, v75
v_rcp_f32 v76, v76
v_rcp_f32 v77, v77
s_add_u32 m0, s40, 3072
s_nop 0
buffer_load_dwordx4 v5, s[12:15], s38 offen lds
v_rcp_f32 v78, v78
v_rcp_f32 v79, v79
v_mul_f32 v144, v132, v144
v_mul_f32 v145, v133, v145
v_mul_f32 v146, v134, v146
v_mul_f32 v147, v135, v147
v_mul_f32 v168, v156, v168
v_mul_f32 v169, v157, v169
s_add_u32 m0, s40, 4096
s_add_u32 s38, s38, 57344
buffer_load_dwordx4 v4, s[12:15], s38 offen lds
v_mul_f32 v170, v158, v170
v_mul_f32 v171, v159, v171
v_mul_f32 v144, v144, v72
v_mul_f32 v145, v145, v73
v_mul_f32 v146, v146, v74
v_mul_f32 v147, v147, v75
v_mul_f32 v168, v168, v76
s_add_u32 m0, s40, 5120
s_nop 0
buffer_load_dwordx4 v5, s[12:15], s38 offen lds
v_mul_f32 v169, v169, v77
v_mul_f32 v170, v170, v78
v_mul_f32 v171, v171, v79
v_cvt_pk_bf16_f32 v130, v144, v145
v_cvt_pk_bf16_f32 v131, v146, v147
v_cvt_pk_bf16_f32 v154, v168, v169
v_cvt_pk_bf16_f32 v155, v170, v171
buffer_store_dwordx4 v[128:131], v2, s[24:27], s54 offen offset:0 sc1
s_add_u32 m0, s40, 6144
s_add_u32 s38, s38, 57344
buffer_load_dwordx4 v4, s[12:15], s38 offen lds
s_add_u32 m0, s40, 7168
s_nop 0
buffer_load_dwordx4 v5, s[12:15], s38 offen lds
s_waitcnt vmcnt(13)
s_barrier
s_add_u32 s37, s35, 3
s_and_b32 s37, s37, 15
s_mul_i32 s37, s37, 16384
s_add_u32 m0, s39, 49152
s_nop 0
buffer_load_dwordx4 v3, s[8:11], s37 offen sc1 lds
buffer_store_dwordx4 v[152:155], v2, s[24:27], s54 offen offset:1024 sc1
v_fma_f32 v136, -v56, v40, v136
v_fma_f32 v137, -v56, v41, v137
v_fma_f32 v138, -v56, v42, v138
v_fma_f32 v139, -v56, v43, v139
v_fma_f32 v160, -v58, v40, v160
buffer_load_dwordx4 v3, s[8:11], s37 offen offset:1024 sc1 lds
v_fma_f32 v161, -v58, v41, v161
v_fma_f32 v162, -v58, v42, v162
v_fma_f32 v163, -v58, v43, v163
v_mul_f32 v72, v136, v136
v_mul_f32 v73, v137, v137
v_mul_f32 v74, v138, v138
buffer_load_dwordx4 v3, s[8:11], s37 offen offset:2048 sc1 lds
v_mul_f32 v75, v139, v139
v_mul_f32 v76, v160, v160
v_mul_f32 v77, v161, v161
v_mul_f32 v78, v162, v162
v_mul_f32 v79, v163, v163
v_fma_f32 v72, v72, v65, v64
buffer_load_dwordx4 v3, s[8:11], s37 offen offset:3072 sc1 lds
v_fma_f32 v73, v73, v65, v64
v_fma_f32 v74, v74, v65, v64
v_fma_f32 v75, v75, v65, v64
v_fma_f32 v76, v76, v69, v68
v_fma_f32 v77, v77, v69, v68
v_fma_f32 v78, v78, v69, v68
s_add_u32 s38, s35, 3
s_and_b32 s38, s38, 15
s_mul_i32 s38, s38, 458752
s_add_u32 m0, s40, 49152
s_nop 0
buffer_load_dwordx4 v4, s[12:15], s38 offen lds
v_fma_f32 v79, v79, v69, v68
v_mul_f32 v72, v72, v136
v_mul_f32 v73, v73, v137
v_mul_f32 v74, v74, v138
v_mul_f32 v75, v75, v139
v_mul_f32 v76, v76, v160
s_add_u32 m0, s40, 50176
s_nop 0
buffer_load_dwordx4 v5, s[12:15], s38 offen lds
v_mul_f32 v77, v77, v161
v_mul_f32 v78, v78, v162
v_mul_f32 v79, v79, v163
v_exp_f32 v72, v72
v_exp_f32 v73, v73
v_exp_f32 v74, v74
s_add_u32 m0, s40, 51200
s_add_u32 s38, s38, 57344
buffer_load_dwordx4 v4, s[12:15], s38 offen lds
v_exp_f32 v75, v75
v_exp_f32 v76, v76
v_exp_f32 v77, v77
v_exp_f32 v78, v78
v_exp_f32 v79, v79
v_fma_f32 v148, -v56, v52, v148
s_add_u32 m0, s40, 52224
s_nop 0
buffer_load_dwordx4 v5, s[12:15], s38 offen lds
v_fma_f32 v149, -v56, v53, v149
v_fma_f32 v150, -v56, v54, v150
v_fma_f32 v151, -v56, v55, v151
v_fma_f32 v172, -v58, v52, v172
v_fma_f32 v173, -v58, v53, v173
v_fma_f32 v174, -v58, v54, v174
s_add_u32 m0, s40, 53248
s_add_u32 s38, s38, 57344
buffer_load_dwordx4 v4, s[12:15], s38 offen lds
v_fma_f32 v175, -v58, v55, v175
v_fma_f32 v72, v72, v66, v66
v_fma_f32 v73, v73, v66, v66
v_fma_f32 v74, v74, v66, v66
v_fma_f32 v75, v75, v66, v66
v_fma_f32 v76, v76, v70, v70
s_add_u32 m0, s40, 54272
s_nop 0
buffer_load_dwordx4 v5, s[12:15], s38 offen lds
v_fma_f32 v77, v77, v70, v70
v_fma_f32 v78, v78, v70, v70
v_fma_f32 v79, v79, v70, v70
v_rcp_f32 v72, v72
v_rcp_f32 v73, v73
v_rcp_f32 v74, v74
s_add_u32 m0, s40, 55296
s_add_u32 s38, s38, 57344
buffer_load_dwordx4 v4, s[12:15], s38 offen lds
s_add_u32 m0, s40, 56320
s_nop 0
buffer_load_dwordx4 v5, s[12:15], s38 offen lds
s_waitcnt vmcnt(13)
s_barrier
s_waitcnt lgkmcnt(0)
s_add_u32 s37, s35, 4
s_and_b32 s37, s37, 15
s_mul_i32 s37, s37, 16384
s_add_u32 m0, s39, 98304
s_nop 0
buffer_load_dwordx4 v3, s[8:11], s37 offen sc1 lds
s_load_dword s3, s[4:5], 3584
s_load_dword s3, s[4:5], 3648
s_load_dword s3, s[4:5], 3712
s_load_dword s3, s[4:5], 3776
s_load_dword s3, s[4:5], 3840
s_load_dword s3, s[4:5], 3904
s_load_dword s3, s[4:5], 3968
buffer_load_dwordx4 v3, s[8:11], s37 offen offset:1024 sc1 lds
s_load_dword s3, s[4:5], 4032
s_load_dword s3, s[4:5], 4096
s_load_dword s3, s[4:5], 4160
s_load_dword s3, s[4:5], 4224
s_load_dword s3, s[4:5], 4288
s_load_dword s3, s[4:5], 4352
s_load_dword s3, s[4:5], 4416
buffer_load_dwordx4 v3, s[8:11], s37 offen offset:2048 sc1 lds
v_rcp_f32 v75, v75
v_rcp_f32 v76, v76
v_rcp_f32 v77, v77
v_rcp_f32 v78, v78
v_rcp_f32 v79, v79
v_mul_f32 v148, v136, v148
v_mul_f32 v149, v137, v149
buffer_load_dwordx4 v3, s[8:11], s37 offen offset:3072 sc1 lds
v_mul_f32 v150, v138, v150
v_mul_f32 v151, v139, v151
v_mul_f32 v172, v160, v172
v_mul_f32 v173, v161, v173
v_mul_f32 v174, v162, v174
v_mul_f32 v175, v163, v175
v_mul_f32 v148, v148, v72
v_mul_f32 v149, v149, v73
s_add_u32 s38, s35, 4
s_and_b32 s38, s38, 15
s_mul_i32 s38, s38, 458752
s_add_u32 m0, s40, 98304
s_nop 0
buffer_load_dwordx4 v4, s[12:15], s38 offen lds
v_mul_f32 v150, v150, v74
v_mul_f32 v151, v151, v75
v_mul_f32 v172, v172, v76
v_mul_f32 v173, v173, v77
v_mul_f32 v174, v174, v78
v_mul_f32 v175, v175, v79
v_cvt_pk_bf16_f32 v80, v148, v149
s_add_u32 m0, s40, 99328
s_nop 0
buffer_load_dwordx4 v5, s[12:15], s38 offen lds
v_cvt_pk_bf16_f32 v81, v150, v151
v_cvt_pk_bf16_f32 v82, v172, v173
v_cvt_pk_bf16_f32 v83, v174, v175
s_nop 1
v_permlane32_swap_b32 v80, v82
v_permlane32_swap_b32 v81, v83
buffer_store_dwordx4 v[80:83], v84, s[24:27], s55 offen offset:0 sc1
s_add_u32 m0, s40, 100352
s_add_u32 s38, s38, 57344
buffer_load_dwordx4 v4, s[12:15], s38 offen lds
s_nop 1
v_mul_f32 v66, v61, v61
v_mul_f32 v64, 0xc0135761, v61
v_mul_f32 v65, 0xbdd2d3e8, v61
v_mul_f32 v65, v65, v66
v_rcp_f32 v66, v66
v_mul_f32 v70, v63, v63
v_mul_f32 v68, 0xc0135761, v63
s_add_u32 m0, s40, 101376
s_nop 0
buffer_load_dwordx4 v5, s[12:15], s38 offen lds
v_mul_f32 v69, 0xbdd2d3e8, v63
v_mul_f32 v69, v69, v70
v_rcp_f32 v70, v70
v_fma_f32 v176, -v60, v32, v176
v_fma_f32 v177, -v60, v33, v177
v_fma_f32 v178, -v60, v34, v178
v_fma_f32 v179, -v60, v35, v179
s_add_u32 m0, s40, 102400
s_add_u32 s38, s38, 57344
buffer_load_dwordx4 v4, s[12:15], s38 offen lds
s_branch Lov_9
.p2align 12
.fill 64, 4, 0xbf800000
Lst_9_0:
s_branch Lwr_164
Lst_9_1:
s_branch Lwr_171
s_nop 0
Lov_9:
v_fma_f32 v200, -v62, v32, v200
v_fma_f32 v201, -v62, v33, v201
v_fma_f32 v202, -v62, v34, v202
v_fma_f32 v203, -v62, v35, v203
v_mul_f32 v72, v176, v176
v_mul_f32 v73, v177, v177
v_mul_f32 v74, v178, v178
s_add_u32 m0, s40, 103424
s_nop 0
buffer_load_dwordx4 v5, s[12:15], s38 offen lds
v_mul_f32 v75, v179, v179
v_mul_f32 v76, v200, v200
v_mul_f32 v77, v201, v201
v_mul_f32 v78, v202, v202
v_mul_f32 v79, v203, v203
v_fma_f32 v72, v72, v65, v64
v_fma_f32 v73, v73, v65, v64
v_fma_f32 v74, v74, v65, v64
s_add_u32 m0, s40, 104448
s_add_u32 s38, s38, 57344
buffer_load_dwordx4 v4, s[12:15], s38 offen lds
s_add_u32 m0, s40, 105472
s_nop 0
buffer_load_dwordx4 v5, s[12:15], s38 offen lds
s_waitcnt vmcnt(13)
s_barrier
s_add_u32 s37, s35, 5
s_and_b32 s37, s37, 15
s_mul_i32 s37, s37, 16384
s_add_u32 m0, s39, 0
s_nop 0
buffer_load_dwordx4 v3, s[8:11], s37 offen sc1 lds
v_fma_f32 v75, v75, v65, v64
v_fma_f32 v76, v76, v69, v68
v_fma_f32 v77, v77, v69, v68
v_fma_f32 v78, v78, v69, v68
v_fma_f32 v79, v79, v69, v68
v_mul_f32 v72, v72, v176
buffer_load_dwordx4 v3, s[8:11], s37 offen offset:1024 sc1 lds
v_mul_f32 v73, v73, v177
v_mul_f32 v74, v74, v178
v_mul_f32 v75, v75, v179
v_mul_f32 v76, v76, v200
v_mul_f32 v77, v77, v201
v_mul_f32 v78, v78, v202
buffer_load_dwordx4 v3, s[8:11], s37 offen offset:2048 sc1 lds
v_mul_f32 v79, v79, v203
v_exp_f32 v72, v72
v_exp_f32 v73, v73
v_exp_f32 v74, v74
v_exp_f32 v75, v75
v_exp_f32 v76, v76
buffer_load_dwordx4 v3, s[8:11], s37 offen offset:3072 sc1 lds
v_exp_f32 v77, v77
v_exp_f32 v78, v78
v_exp_f32 v79, v79
v_fma_f32 v188, -v60, v44, v188
v_fma_f32 v189, -v60, v45, v189
v_fma_f32 v190, -v60, v46, v190
s_add_u32 s38, s35, 5
s_and_b32 s38, s38, 15
s_mul_i32 s38, s38, 458752
s_add_u32 m0, s40, 0
s_nop 0
buffer_load_dwordx4 v4, s[12:15], s38 offen lds
v_fma_f32 v191, -v60, v47, v191
v_fma_f32 v212, -v62, v44, v212
v_fma_f32 v213, -v62, v45, v213
v_fma_f32 v214, -v62, v46, v214
v_fma_f32 v215, -v62, v47, v215
v_fma_f32 v72, v72, v66, v66
s_add_u32 m0, s40, 1024
s_nop 0
buffer_load_dwordx4 v5, s[12:15], s38 offen lds
v_fma_f32 v73, v73, v66, v66
v_fma_f32 v74, v74, v66, v66
v_fma_f32 v75, v75, v66, v66
v_fma_f32 v76, v76, v70, v70
v_fma_f32 v77, v77, v70, v70
v_fma_f32 v78, v78, v70, v70
s_add_u32 m0, s40, 2048
s_add_u32 s38, s38, 57344
buffer_load_dwordx4 v4, s[12:15], s38 offen lds
v_fma_f32 v79, v79, v70, v70
v_rcp_f32 v72, v72
v_rcp_f32 v73, v73
v_rcp_f32 v74, v74
v_rcp_f32 v75, v75
v_rcp_f32 v76, v76
s_add_u32 m0, s40, 3072
s_nop 0
buffer_load_dwordx4 v5, s[12:15], s38 offen lds
v_rcp_f32 v77, v77
v_rcp_f32 v78, v78
v_rcp_f32 v79, v79
v_mul_f32 v188, v176, v188
v_mul_f32 v189, v177, v189
v_mul_f32 v190, v178, v190
s_add_u32 m0, s40, 4096
s_add_u32 s38, s38, 57344
buffer_load_dwordx4 v4, s[12:15], s38 offen lds
v_mul_f32 v191, v179, v191
v_mul_f32 v212, v200, v212
v_mul_f32 v213, v201, v213
v_mul_f32 v214, v202, v214
v_mul_f32 v215, v203, v215
v_mul_f32 v188, v188, v72
s_add_u32 m0, s40, 5120
s_nop 0
buffer_load_dwordx4 v5, s[12:15], s38 offen lds
v_mul_f32 v189, v189, v73
v_mul_f32 v190, v190, v74
v_mul_f32 v191, v191, v75
v_mul_f32 v212, v212, v76
v_mul_f32 v213, v213, v77
v_mul_f32 v214, v214, v78
s_add_u32 m0, s40, 6144
s_add_u32 s38, s38, 57344
buffer_load_dwordx4 v4, s[12:15], s38 offen lds
s_add_u32 m0, s40, 7168
s_nop 0
buffer_load_dwordx4 v5, s[12:15], s38 offen lds
s_waitcnt vmcnt(12)
s_barrier
s_waitcnt lgkmcnt(0)
s_cmp_eq_u32 s47, 3
s_cbranch_scc0 Lw_121
s_lshl_b32 s60, s35, 7
s_add_u32 s60, s60, 28321792
s_mov_b32 s61, s60
s_load_dword s92, s[82:83], s60 glc
s_load_dword s93, s[82:83], s61 glc
Lw_121:
s_add_u32 s37, s35, 6
s_and_b32 s37, s37, 15
s_mul_i32 s37, s37, 16384
s_add_u32 m0, s39, 49152
s_nop 0
buffer_load_dwordx4 v3, s[8:11], s37 offen sc1 lds
s_load_dword s3, s[4:5], 4480
s_load_dword s3, s[4:5], 4544
s_load_dword s3, s[4:5], 4608
s_load_dword s3, s[4:5], 4672
s_load_dword s3, s[4:5], 4736
s_load_dword s3, s[4:5], 4800
s_load_dword s3, s[4:5], 4864
buffer_load_dwordx4 v3, s[8:11], s37 offen offset:1024 sc1 lds
s_load_dword s3, s[4:5], 4928
s_load_dword s3, s[4:5], 4992
s_load_dword s3, s[4:5], 5056
s_load_dword s3, s[4:5], 5120
s_load_dword s3, s[4:5], 5184
s_load_dword s3, s[4:5], 5248
s_load_dword s3, s[4:5], 5312
buffer_load_dwordx4 v3, s[8:11], s37 offen offset:2048 sc1 lds
v_mul_f32 v215, v215, v79
v_cvt_pk_bf16_f32 v176, v188, v189
v_cvt_pk_bf16_f32 v177, v190, v191
v_cvt_pk_bf16_f32 v200, v212, v213
v_cvt_pk_bf16_f32 v201, v214, v215
v_fma_f32 v180, -v60, v36, v180
v_fma_f32 v181, -v60, v37, v181
v_fma_f32 v182, -v60, v38, v182
buffer_load_dwordx4 v3, s[8:11], s37 offen offset:3072 sc1 lds
v_fma_f32 v183, -v60, v39, v183
v_fma_f32 v204, -v62, v36, v204
v_fma_f32 v205, -v62, v37, v205
v_fma_f32 v206, -v62, v38, v206
v_fma_f32 v207, -v62, v39, v207
v_mul_f32 v72, v180, v180
v_mul_f32 v73, v181, v181
s_add_u32 s38, s35, 6
s_and_b32 s38, s38, 15
s_mul_i32 s38, s38, 458752
s_add_u32 m0, s40, 49152
s_nop 0
buffer_load_dwordx4 v4, s[12:15], s38 offen lds
v_mul_f32 v74, v182, v182
v_mul_f32 v75, v183, v183
v_mul_f32 v76, v204, v204
v_mul_f32 v77, v205, v205
v_mul_f32 v78, v206, v206
v_mul_f32 v79, v207, v207
v_fma_f32 v72, v72, v65, v64
v_fma_f32 v73, v73, v65, v64
s_add_u32 m0, s40, 50176
s_nop 0
buffer_load_dwordx4 v5, s[12:15], s38 offen lds
v_fma_f32 v74, v74, v65, v64
v_fma_f32 v75, v75, v65, v64
v_fma_f32 v76, v76, v69, v68
v_fma_f32 v77, v77, v69, v68
v_fma_f32 v78, v78, v69, v68
v_fma_f32 v79, v79, v69, v68
v_mul_f32 v72, v72, v180
s_add_u32 m0, s40, 51200
s_add_u32 s38, s38, 57344
buffer_load_dwordx4 v4, s[12:15], s38 offen lds
v_mul_f32 v73, v73, v181
v_mul_f32 v74, v74, v182
v_mul_f32 v75, v75, v183
v_mul_f32 v76, v76, v204
v_mul_f32 v77, v77, v205
v_mul_f32 v78, v78, v206
v_mul_f32 v79, v79, v207
s_add_u32 m0, s40, 52224
s_nop 0
buffer_load_dwordx4 v5, s[12:15], s38 offen lds
v_exp_f32 v72, v72
v_exp_f32 v73, v73
v_exp_f32 v74, v74
v_exp_f32 v75, v75
v_exp_f32 v76, v76
v_exp_f32 v77, v77
v_exp_f32 v78, v78
v_exp_f32 v79, v79
s_add_u32 m0, s40, 53248
s_add_u32 s38, s38, 57344
buffer_load_dwordx4 v4, s[12:15], s38 offen lds
v_fma_f32 v192, -v60, v48, v192
v_fma_f32 v193, -v60, v49, v193
v_fma_f32 v194, -v60, v50, v194
v_fma_f32 v195, -v60, v51, v195
v_fma_f32 v216, -v62, v48, v216
v_fma_f32 v217, -v62, v49, v217
v_fma_f32 v218, -v62, v50, v218
s_add_u32 m0, s40, 54272
s_nop 0
buffer_load_dwordx4 v5, s[12:15], s38 offen lds
v_fma_f32 v219, -v62, v51, v219
v_fma_f32 v72, v72, v66, v66
v_fma_f32 v73, v73, v66, v66
v_fma_f32 v74, v74, v66, v66
v_fma_f32 v75, v75, v66, v66
v_fma_f32 v76, v76, v70, v70
v_fma_f32 v77, v77, v70, v70
v_fma_f32 v78, v78, v70, v70
s_add_u32 m0, s40, 55296
s_add_u32 s38, s38, 57344
buffer_load_dwordx4 v4, s[12:15], s38 offen lds
s_add_u32 m0, s40, 56320
s_nop 0
buffer_load_dwordx4 v5, s[12:15], s38 offen lds
s_waitcnt vmcnt(12)
s_barrier
s_add_u32 s37, s35, 7
s_and_b32 s37, s37, 15
s_mul_i32 s37, s37, 16384
s_add_u32 m0, s39, 98304
s_nop 0
buffer_load_dwordx4 v3, s[8:11], s37 offen sc1 lds
v_fma_f32 v79, v79, v70, v70
v_rcp_f32 v72, v72
v_rcp_f32 v73, v73
v_rcp_f32 v74, v74
v_rcp_f32 v75, v75
v_rcp_f32 v76, v76
buffer_load_dwordx4 v3, s[8:11], s37 offen offset:1024 sc1 lds
v_rcp_f32 v77, v77
v_rcp_f32 v78, v78
v_rcp_f32 v79, v79
v_mul_f32 v192, v180, v192
v_mul_f32 v193, v181, v193
v_mul_f32 v194, v182, v194
buffer_load_dwordx4 v3, s[8:11], s37 offen offset:2048 sc1 lds
v_mul_f32 v195, v183, v195
v_mul_f32 v216, v204, v216
v_mul_f32 v217, v205, v217
v_mul_f32 v218, v206, v218
v_mul_f32 v219, v207, v219
v_mul_f32 v192, v192, v72
buffer_load_dwordx4 v3, s[8:11], s37 offen offset:3072 sc1 lds
v_mul_f32 v193, v193, v73
v_mul_f32 v194, v194, v74
v_mul_f32 v195, v195, v75
v_mul_f32 v216, v216, v76
v_mul_f32 v217, v217, v77
v_mul_f32 v218, v218, v78
s_add_u32 s38, s35, 7
s_and_b32 s38, s38, 15
s_mul_i32 s38, s38, 458752
s_add_u32 m0, s40, 98304
s_nop 0
buffer_load_dwordx4 v4, s[12:15], s38 offen lds
v_mul_f32 v219, v219, v79
v_cvt_pk_bf16_f32 v178, v192, v193
v_cvt_pk_bf16_f32 v179, v194, v195
v_cvt_pk_bf16_f32 v202, v216, v217
v_cvt_pk_bf16_f32 v203, v218, v219
buffer_store_dwordx4 v[176:179], v2, s[24:27], s54 offen offset:2048 sc1
s_add_u32 m0, s40, 99328
s_nop 0
buffer_load_dwordx4 v5, s[12:15], s38 offen lds
buffer_store_dwordx4 v[200:203], v2, s[24:27], s54 offen offset:3072 sc1
v_fma_f32 v184, -v60, v40, v184
v_fma_f32 v185, -v60, v41, v185
v_fma_f32 v186, -v60, v42, v186
v_fma_f32 v187, -v60, v43, v187
v_fma_f32 v208, -v62, v40, v208
s_add_u32 m0, s40, 100352
s_add_u32 s38, s38, 57344
buffer_load_dwordx4 v4, s[12:15], s38 offen lds
v_fma_f32 v209, -v62, v41, v209
v_fma_f32 v210, -v62, v42, v210
v_fma_f32 v211, -v62, v43, v211
v_mul_f32 v72, v184, v184
v_mul_f32 v73, v185, v185
v_mul_f32 v74, v186, v186
s_add_u32 m0, s40, 101376
s_nop 0
buffer_load_dwordx4 v5, s[12:15], s38 offen lds
v_mul_f32 v75, v187, v187
v_mul_f32 v76, v208, v208
v_mul_f32 v77, v209, v209
v_mul_f32 v78, v210, v210
v_mul_f32 v79, v211, v211
v_fma_f32 v72, v72, v65, v64
s_add_u32 m0, s40, 102400
s_add_u32 s38, s38, 57344
buffer_load_dwordx4 v4, s[12:15], s38 offen lds
v_fma_f32 v73, v73, v65, v64
v_fma_f32 v74, v74, v65, v64
v_fma_f32 v75, v75, v65, v64
v_fma_f32 v76, v76, v69, v68
v_fma_f32 v77, v77, v69, v68
v_fma_f32 v78, v78, v69, v68
s_add_u32 m0, s40, 103424
s_nop 0
buffer_load_dwordx4 v5, s[12:15], s38 offen lds
v_fma_f32 v79, v79, v69, v68
v_mul_f32 v72, v72, v184
v_mul_f32 v73, v73, v185
v_mul_f32 v74, v74, v186
v_mul_f32 v75, v75, v187
v_mul_f32 v76, v76, v208
s_add_u32 m0, s40, 104448
s_add_u32 s38, s38, 57344
buffer_load_dwordx4 v4, s[12:15], s38 offen lds
s_add_u32 m0, s40, 105472
s_nop 0
buffer_load_dwordx4 v5, s[12:15], s38 offen lds
s_waitcnt vmcnt(14)
s_cmp_eq_u32 s47, 3
s_cbranch_scc0 Lw_122
s_mov_b32 s41, 0x40000
Lcp_123:
s_waitcnt lgkmcnt(0)
s_and_b32 s92, s92, s93
s_cmp_eq_u32 s92, 16
s_cbranch_scc1 Lco_124
s_load_dword s92, s[82:83], s60 glc
s_load_dword s93, s[82:83], s61 glc
s_sub_u32 s41, s41, 1
s_cmp_lg_u32 s41, 0
s_cbranch_scc1 Lcp_123
s_waitcnt lgkmcnt(0)
Lco_124:
Lw_122:
s_barrier
s_lshl_b32 s60, s35, 9
s_lshl_b32 s43, s47, 7
s_add_u32 s60, s60, s43
s_add_u32 s61, s60, 14336
s_add_u32 s52, s43, 148480
s_add_u32 s53, s52, 896
v_lshrrev_b32 v104, 3, v1
v_mul_u32_u24 v104, 28672, v104
v_and_b32 v105, 7, v1
v_lshl_add_u32 v104, v105, 4, v104
s_waitcnt lgkmcnt(0)
buffer_load_dwordx4 v[96:99], v104, s[84:87], s60 offen sc1
s_load_dword s3, s[4:5], 5376
s_load_dword s3, s[4:5], 5440
s_load_dword s3, s[4:5], 5504
s_load_dword s3, s[4:5], 5568
s_load_dword s3, s[4:5], 5632
s_load_dword s3, s[4:5], 5696
buffer_load_dwordx4 v[100:103], v104, s[84:87], s61 offen sc1
s_load_dword s3, s[4:5], 5760
s_load_dword s3, s[4:5], 5824
s_load_dword s3, s[4:5], 5888
s_load_dword s3, s[4:5], 5952
s_load_dword s3, s[4:5], 6016
s_load_dword s3, s[4:5], 6080
s_load_dword s3, s[4:5], 6144
s_add_u32 s37, s35, 8
s_and_b32 s37, s37, 15
s_mul_i32 s37, s37, 16384
s_add_u32 m0, s39, 0
s_nop 0
buffer_load_dwordx4 v3, s[8:11], s37 offen sc1 lds
s_load_dword s3, s[4:5], 6208
v_mul_f32 v77, v77, v209
v_mul_f32 v78, v78, v210
v_mul_f32 v79, v79, v211
v_exp_f32 v72, v72
v_exp_f32 v73, v73
v_exp_f32 v74, v74
buffer_load_dwordx4 v3, s[8:11], s37 offen offset:1024 sc1 lds
v_exp_f32 v75, v75
v_exp_f32 v76, v76
v_exp_f32 v77, v77
v_exp_f32 v78, v78
v_exp_f32 v79, v79
v_fma_f32 v196, -v60, v52, v196
v_fma_f32 v197, -v60, v53, v197
buffer_load_dwordx4 v3, s[8:11], s37 offen offset:2048 sc1 lds
v_fma_f32 v198, -v60, v54, v198
v_fma_f32 v199, -v60, v55, v199
v_fma_f32 v220, -v62, v52, v220
v_fma_f32 v221, -v62, v53, v221
v_fma_f32 v222, -v62, v54, v222
v_fma_f32 v223, -v62, v55, v223
buffer_load_dwordx4 v3, s[8:11], s37 offen offset:3072 sc1 lds
v_fma_f32 v72, v72, v66, v66
v_fma_f32 v73, v73, v66, v66
v_fma_f32 v74, v74, v66, v66
v_fma_f32 v75, v75, v66, v66
v_fma_f32 v76, v76, v70, v70
v_fma_f32 v77, v77, v70, v70
v_fma_f32 v78, v78, v70, v70
s_add_u32 s38, s35, 8
s_and_b32 s38, s38, 15
s_mul_i32 s38, s38, 458752
s_add_u32 m0, s40, 0
s_nop 0
buffer_load_dwordx4 v4, s[12:15], s38 offen lds
v_fma_f32 v79, v79, v70, v70
v_rcp_f32 v72, v72
v_rcp_f32 v73, v73
v_rcp_f32 v74, v74
v_rcp_f32 v75, v75
v_rcp_f32 v76, v76
v_rcp_f32 v77, v77
s_add_u32 m0, s40, 1024
s_nop 0
buffer_load_dwordx4 v5, s[12:15], s38 offen lds
v_rcp_f32 v78, v78
v_rcp_f32 v79, v79
v_mul_f32 v196, v184, v196
v_mul_f32 v197, v185, v197
v_mul_f32 v198, v186, v198
v_mul_f32 v199, v187, v199
v_mul_f32 v220, v208, v220
s_add_u32 m0, s40, 2048
s_add_u32 s38, s38, 57344
buffer_load_dwordx4 v4, s[12:15], s38 offen lds
v_mul_f32 v221, v209, v221
v_mul_f32 v222, v210, v222
v_mul_f32 v223, v211, v223
v_mul_f32 v196, v196, v72
v_mul_f32 v197, v197, v73
v_mul_f32 v198, v198, v74
s_add_u32 m0, s40, 3072
s_nop 0
buffer_load_dwordx4 v5, s[12:15], s38 offen lds
v_mul_f32 v199, v199, v75
v_mul_f32 v220, v220, v76
v_mul_f32 v221, v221, v77
v_mul_f32 v222, v222, v78
v_mul_f32 v223, v223, v79
v_cvt_pk_bf16_f32 v80, v196, v197
v_cvt_pk_bf16_f32 v81, v198, v199
s_add_u32 m0, s40, 4096
s_add_u32 s38, s38, 57344
buffer_load_dwordx4 v4, s[12:15], s38 offen lds
v_cvt_pk_bf16_f32 v82, v220, v221
v_cvt_pk_bf16_f32 v83, v222, v223
s_nop 1
v_permlane32_swap_b32 v80, v82
v_permlane32_swap_b32 v81, v83
buffer_store_dwordx4 v[80:83], v84, s[24:27], s55 offen offset:2048 sc1
s_nop 1
s_add_u32 m0, s40, 5120
s_nop 0
buffer_load_dwordx4 v5, s[12:15], s38 offen lds
v_cmp_gt_u32 vcc, 32, v1
v_mov_b32 v104, s52
v_mov_b32 v106, s53
v_cndmask_b32 v104, v106, v104, vcc
v_lshl_add_u32 v104, v105, 4, v104
v_bfe_u32 v105, v1, 4, 1
v_lshl_add_u32 v104, v105, 2, v104
s_add_u32 m0, s40, 6144
s_add_u32 s38, s38, 57344
buffer_load_dwordx4 v4, s[12:15], s38 offen lds
s_add_u32 m0, s40, 7168
s_nop 0
buffer_load_dwordx4 v5, s[12:15], s38 offen lds
s_waitcnt vmcnt(15)
s_barrier
s_add_u32 s37, s35, 9
s_and_b32 s37, s37, 15
s_mul_i32 s37, s37, 16384
s_add_u32 m0, s39, 49152
s_nop 0
buffer_load_dwordx4 v3, s[8:11], s37 offen sc1 lds
buffer_load_dwordx4 v3, s[8:11], s37 offen offset:1024 sc1 lds
buffer_load_dwordx4 v3, s[8:11], s37 offen offset:2048 sc1 lds
buffer_load_dwordx4 v3, s[8:11], s37 offen offset:3072 sc1 lds
s_add_u32 s38, s35, 9
s_and_b32 s38, s38, 15
s_mul_i32 s38, s38, 458752
s_add_u32 m0, s40, 49152
s_nop 0
buffer_load_dwordx4 v4, s[12:15], s38 offen lds
s_add_u32 m0, s40, 50176
s_nop 0
buffer_load_dwordx4 v5, s[12:15], s38 offen lds
s_add_u32 m0, s40, 51200
s_add_u32 s38, s38, 57344
buffer_load_dwordx4 v4, s[12:15], s38 offen lds
s_add_u32 m0, s40, 52224
s_nop 0
buffer_load_dwordx4 v5, s[12:15], s38 offen lds
s_add_u32 m0, s40, 53248
s_add_u32 s38, s38, 57344
buffer_load_dwordx4 v4, s[12:15], s38 offen lds
s_add_u32 m0, s40, 54272
s_nop 0
buffer_load_dwordx4 v5, s[12:15], s38 offen lds
s_add_u32 m0, s40, 55296
s_add_u32 s38, s38, 57344
buffer_load_dwordx4 v4, s[12:15], s38 offen lds
s_add_u32 m0, s40, 56320
s_nop 0
buffer_load_dwordx4 v5, s[12:15], s38 offen lds
s_waitcnt vmcnt(12)
s_barrier
s_cmp_eq_u32 s47, 0
s_cbranch_scc0 Lw_125
s_add_u32 s7, s34, 32
s_lshl_b32 s7, s7, 7
v_mov_b32 v90, s7
v_mov_b32 v91, 1
s_mov_b64 exec, 1
buffer_atomic_add v91, v90, s[56:59], 0 offen sc1
s_mov_b64 exec, -1
Lw_125:
v_permlane32_swap_b32 v96, v100
v_permlane32_swap_b32 v97, v101
v_permlane32_swap_b32 v98, v102
v_permlane32_swap_b32 v99, v103
v_add_f32 v96, v96, v100
v_add_f32 v97, v97, v101
v_add_f32 v98, v98, v102
v_add_f32 v99, v99, v103
s_nop 1
v_permlane16_swap_b32 v96, v97
v_permlane16_swap_b32 v98, v99
v_add_f32 v96, v96, v97
v_add_f32 v98, v98, v99
s_nop 1
v_add_f32_dpp v96, v96, v96 row_ror:8 row_mask:0xf bank_mask:0xf
v_add_f32_dpp v98, v98, v98 row_ror:8 row_mask:0xf bank_mask:0xf
ds_write_b32 v104, v96
ds_write_b32 v104, v98 offset:8
s_waitcnt lgkmcnt(0)
s_add_u32 s37, s35, 10
s_and_b32 s37, s37, 15
s_mul_i32 s37, s37, 16384
s_add_u32 m0, s39, 98304
s_nop 0
buffer_load_dwordx4 v3, s[8:11], s37 offen sc1 lds
s_load_dword s3, s[4:5], 6272
s_load_dword s3, s[4:5], 6336
s_load_dword s3, s[4:5], 6400
s_load_dword s3, s[4:5], 6464
s_load_dword s3, s[4:5], 6528
s_load_dword s3, s[4:5], 6592
buffer_load_dwordx4 v3, s[8:11], s37 offen offset:1024 sc1 lds
s_load_dword s3, s[4:5], 6656
s_load_dword s3, s[4:5], 6720
s_load_dword s3, s[4:5], 6784
s_load_dword s3, s[4:5], 6848
s_load_dword s3, s[4:5], 6912
s_load_dword s3, s[4:5], 6976
s_load_dword s3, s[4:5], 7040
buffer_load_dwordx4 v3, s[8:11], s37 offen offset:2048 sc1 lds
s_load_dword s3, s[4:5], 7104
s_bfe_u32 s61, s35, 0x10002
s_lshr_b32 s60, s35, 3
s_lshl_b32 s60, s60, 2
s_and_b32 s43, s35, 3
s_add_u32 s60, s60, s43
buffer_load_dwordx4 v3, s[8:11], s37 offen offset:3072 sc1 lds
s_lshl_b32 s43, s60, 8
s_add_u32 s28, s76, s43
s_addc_u32 s29, s77, 0
s_mov_b32 s30, 7338240
s_mov_b32 s31, 0x20000
s_mul_i32 s52, s61, 196608
s_mul_i32 s53, s61, 1572864
s_add_u32 s38, s35, 10
s_and_b32 s38, s38, 15
s_mul_i32 s38, s38, 458752
s_add_u32 m0, s40, 98304
s_nop 0
buffer_load_dwordx4 v4, s[12:15], s38 offen lds
s_mul_i32 s90, s61, 163840
s_mul_i32 s91, s61, 1310720
s_and_b32 s43, s35, 3
s_mul_i32 s32, s43, 3
s_mul_i32 s33, s43, 10
s_lshr_b32 s33, s33, 2
s_add_u32 m0, s40, 99328
s_nop 0
buffer_load_dwordx4 v5, s[12:15], s38 offen lds
s_lshl_b32 s51, s47, 11
s_lshl_b32 s44, s47, 15
v_lshrrev_b32 v122, 4, v1
v_lshlrev_b32 v123, 1, v122
v_and_b32 v23, 15, v1
v_xor_b32 v23, v23, v123
v_lshlrev_b32 v23, 4, v23
s_add_u32 m0, s40, 100352
s_add_u32 s38, s38, 57344
buffer_load_dwordx4 v4, s[12:15], s38 offen lds
v_mul_u32_u24 v122, 2048, v122
v_add_u32 v23, v23, v122
v_add_u32 v23, s44, v23
v_xor_b32 v24, 128, v23
v_add_u32 v24, 8192, v24
s_lshl_b32 s43, s60, 2
s_add_u32 m0, s40, 101376
s_nop 0
buffer_load_dwordx4 v5, s[12:15], s38 offen lds
s_lshl_b32 s44, s61, 1
s_add_u32 s43, s43, s44
s_add_u32 s43, s43, s63
s_lshl_b32 s43, s43, 13
s_lshl_b32 s44, s62, 12
s_branch Lov_10
.p2align 12
.fill 80, 4, 0xbf800000
Lst_10_0:
s_branch Lwr_165
Lst_10_1:
s_branch Lwr_172
s_nop 0
Lov_10:
s_add_u32 s49, s43, s44
v_add_u32 v17, s44, v2
s_add_u32 m0, s40, 102400
s_add_u32 s38, s38, 57344
buffer_load_dwordx4 v4, s[12:15], s38 offen lds
v_add_u32 v18, 0x10000, v17
v_add_u32 v19, 0x20000, v17
v_lshrrev_b32 v122, 2, v1
v_and_b32 v123, 7, v122
v_mul_u32_u24 v122, 256, v122
v_lshl_add_u32 v122, v123, 5, v122
s_add_u32 m0, s40, 103424
s_nop 0
buffer_load_dwordx4 v5, s[12:15], s38 offen lds
v_and_b32 v123, 3, v1
v_lshl_add_u32 v9, v123, 3, v122
s_lshl_b32 s43, s61, 7
s_lshl_b32 s44, s63, 6
s_add_u32 s43, s43, s44
v_xor_b32 v9, s43, v9
v_xor_b32 v10, 32, v9
s_add_u32 m0, s40, 104448
s_add_u32 s38, s38, 57344
buffer_load_dwordx4 v4, s[12:15], s38 offen lds
s_add_u32 m0, s40, 105472
s_nop 0
buffer_load_dwordx4 v5, s[12:15], s38 offen lds
s_waitcnt vmcnt(12)
s_barrier
buffer_load_dwordx4 v[160:163], v2, s[8:11], s49 offen offset:0 sc1
v_xor_b32 v11, 128, v9
v_xor_b32 v12, 128, v10
v_add_u32 v13, 65536, v9
buffer_load_dwordx4 v[164:167], v2, s[8:11], s49 offen offset:1024 sc1
v_add_u32 v14, 65536, v10
v_add_u32 v15, 65536, v11
v_add_u32 v16, 65536, v12
v_add_u32 v25, 131072, v9
buffer_load_dwordx4 v[168:171], v2, s[8:11], s49 offen offset:2048 sc1
v_add_u32 v26, 131072, v10
v_add_u32 v27, 131072, v11
v_add_u32 v28, 131072, v12
v_lshrrev_b32 v122, 2, v1
buffer_load_dwordx4 v[172:175], v2, s[8:11], s49 offen offset:3072 sc1
v_bfe_u32 v123, v122, 1, 2
v_mul_u32_u24 v122, 128, v122
v_lshl_add_u32 v122, v123, 5, v122
s_add_u32 s37, s35, 11
s_and_b32 s37, s37, 15
s_mul_i32 s37, s37, 16384
s_add_u32 m0, s39, 0
s_nop 0
buffer_load_dwordx4 v3, s[8:11], s37 offen sc1 lds
v_and_b32 v123, 3, v1
v_lshl_add_u32 v224, v123, 3, v122
v_xor_b32 v224, s44, v224
v_xor_b32 v225, 32, v224
buffer_load_dwordx4 v3, s[8:11], s37 offen offset:1024 sc1 lds
v_add_u32 v226, 65536, v224
v_add_u32 v227, 65536, v225
v_add_u32 v228, 131072, v224
v_add_u32 v229, 131072, v225
buffer_load_dwordx4 v3, s[8:11], s37 offen offset:2048 sc1 lds
s_add_u32 s84, s82, 33554432
s_addc_u32 s85, s83, 0
s_mov_b32 s86, 4194304
s_mov_b32 s87, 0x20000
buffer_load_dwordx4 v3, s[8:11], s37 offen offset:3072 sc1 lds
s_xor_b32 s43, s2, 2
s_lshl_b32 s44, s43, 2
s_add_u32 s44, s44, s47
s_add_u32 s38, s35, 11
s_and_b32 s38, s38, 15
s_mul_i32 s38, s38, 458752
s_add_u32 m0, s40, 0
s_nop 0
buffer_load_dwordx4 v4, s[12:15], s38 offen lds
s_lshl_b32 s45, s44, 12
s_lshl_b32 s46, s2, 2
s_add_u32 s46, s46, s47
s_lshl_b32 s46, s46, 12
s_add_u32 m0, s40, 1024
s_nop 0
buffer_load_dwordx4 v5, s[12:15], s38 offen lds
s_lshl_b32 s43, s34, 18
s_lshl_b32 s42, s60, 8
s_add_u32 s43, s43, s42
s_lshl_b32 s42, s61, 7
s_add_u32 m0, s40, 2048
s_add_u32 s38, s38, 57344
buffer_load_dwordx4 v4, s[12:15], s38 offen lds
s_add_u32 s43, s43, s42
s_lshl_b32 s42, s63, 6
s_add_u32 s43, s43, s42
s_add_u32 m0, s40, 3072
s_nop 0
buffer_load_dwordx4 v5, s[12:15], s38 offen lds
s_add_u32 s20, s78, s43
s_addc_u32 s21, s79, 0
s_mov_b32 s22, 260160
s_mov_b32 s23, 0x20000
s_add_u32 m0, s40, 4096
s_add_u32 s38, s38, 57344
buffer_load_dwordx4 v4, s[12:15], s38 offen lds
v_and_b32 v230, 15, v1
v_lshlrev_b32 v230, 12, v230
v_bfe_u32 v231, v1, 4, 1
v_lshl_add_u32 v230, v231, 5, v230
s_add_u32 m0, s40, 5120
s_nop 0
buffer_load_dwordx4 v5, s[12:15], s38 offen lds
v_bfe_u32 v231, v1, 5, 1
v_lshl_add_u32 v230, v231, 4, v230
s_lshl_b32 s54, s62, 17
s_add_u32 s55, s54, 65536
s_add_u32 m0, s40, 6144
s_add_u32 s38, s38, 57344
buffer_load_dwordx4 v4, s[12:15], s38 offen lds
s_add_u32 m0, s40, 7168
s_nop 0
buffer_load_dwordx4 v5, s[12:15], s38 offen lds
s_waitcnt vmcnt(16)
s_barrier
s_cmp_eq_u32 s47, 3
s_cbranch_scc0 Lw_126
s_lshl_b32 s92, s34, 7
s_add_u32 s92, s92, 28315648
s_load_dword s93, s[82:83], s92 glc
Lw_126:
s_add_u32 s37, s35, 12
s_and_b32 s37, s37, 15
s_mul_i32 s37, s37, 16384
s_add_u32 m0, s39, 49152
s_nop 0
buffer_load_dwordx4 v3, s[8:11], s37 offen sc1 lds
buffer_load_dwordx4 v3, s[8:11], s37 offen offset:1024 sc1 lds
buffer_load_dwordx4 v3, s[8:11], s37 offen offset:2048 sc1 lds
buffer_load_dwordx4 v3, s[8:11], s37 offen offset:3072 sc1 lds
s_add_u32 s38, s35, 12
s_and_b32 s38, s38, 15
s_mul_i32 s38, s38, 458752
s_add_u32 m0, s40, 49152
s_nop 0
buffer_load_dwordx4 v4, s[12:15], s38 offen lds
s_add_u32 m0, s40, 50176
s_nop 0
buffer_load_dwordx4 v5, s[12:15], s38 offen lds
s_add_u32 m0, s40, 51200
s_add_u32 s38, s38, 57344
buffer_load_dwordx4 v4, s[12:15], s38 offen lds
s_add_u32 m0, s40, 52224
s_nop 0
buffer_load_dwordx4 v5, s[12:15], s38 offen lds
s_add_u32 m0, s40, 53248
s_add_u32 s38, s38, 57344
buffer_load_dwordx4 v4, s[12:15], s38 offen lds
s_add_u32 m0, s40, 54272
s_nop 0
buffer_load_dwordx4 v5, s[12:15], s38 offen lds
s_add_u32 m0, s40, 55296
s_add_u32 s38, s38, 57344
buffer_load_dwordx4 v4, s[12:15], s38 offen lds
s_add_u32 m0, s40, 56320
s_nop 0
buffer_load_dwordx4 v5, s[12:15], s38 offen lds
s_waitcnt vmcnt(12)
s_cmp_eq_u32 s47, 3
s_cbranch_scc0 Lw_127
s_mov_b32 s41, 0x40000
s_branch Lpchk_130
Lpoll_128:
s_load_dword s93, s[82:83], s92 glc
Lpchk_130:
s_waitcnt lgkmcnt(0)
s_cmp_eq_u32 s93, 16
s_cbranch_scc1 Lpok_129
s_sub_u32 s41, s41, 1
s_cmp_lg_u32 s41, 0
s_cbranch_scc1 Lpoll_128
Lpok_129:
Lw_127:
s_barrier
s_add_u32 s37, s52, 524288
s_add_u32 m0, s39, 98304
s_nop 0
buffer_load_dwordx4 v3, s[24:27], s37 offen sc1 lds
v_lshlrev_b32 v128, 16, v160
v_and_b32 v129, 0xffff0000, v160
v_lshlrev_b32 v130, 16, v161
v_and_b32 v131, 0xffff0000, v161
v_lshlrev_b32 v132, 16, v162
buffer_load_dwordx4 v3, s[24:27], s37 offen offset:1024 sc1 lds
v_and_b32 v133, 0xffff0000, v162
v_lshlrev_b32 v134, 16, v163
v_and_b32 v135, 0xffff0000, v163
v_lshlrev_b32 v136, 16, v164
v_and_b32 v137, 0xffff0000, v164
buffer_load_dwordx4 v3, s[24:27], s37 offen offset:2048 sc1 lds
v_lshlrev_b32 v138, 16, v165
v_and_b32 v139, 0xffff0000, v165
v_lshlrev_b32 v140, 16, v166
v_and_b32 v141, 0xffff0000, v166
v_lshlrev_b32 v142, 16, v167
v_and_b32 v143, 0xffff0000, v167
buffer_load_dwordx4 v3, s[24:27], s37 offen offset:3072 sc1 lds
v_lshlrev_b32 v144, 16, v168
v_and_b32 v145, 0xffff0000, v168
v_lshlrev_b32 v146, 16, v169
v_and_b32 v147, 0xffff0000, v169
v_lshlrev_b32 v148, 16, v170
s_add_u32 s38, s53, 4194304
s_add_u32 m0, s39, 114688
s_nop 0
buffer_load_dwordx4 v23, s[28:31], s38 offen lds
v_and_b32 v149, 0xffff0000, v170
v_lshlrev_b32 v150, 16, v171
v_and_b32 v151, 0xffff0000, v171
v_lshlrev_b32 v152, 16, v172
v_and_b32 v153, 0xffff0000, v172
s_add_u32 m0, s39, 115712
s_nop 0
buffer_load_dwordx4 v24, s[28:31], s38 offen lds
v_lshlrev_b32 v154, 16, v173
v_and_b32 v155, 0xffff0000, v173
v_lshlrev_b32 v156, 16, v174
v_and_b32 v157, 0xffff0000, v174
v_lshlrev_b32 v158, 16, v175
v_and_b32 v159, 0xffff0000, v175
s_add_u32 m0, s39, 116736
s_add_u32 s38, s38, 16384
buffer_load_dwordx4 v23, s[28:31], s38 offen lds
s_add_u32 m0, s39, 117760
s_nop 0
buffer_load_dwordx4 v24, s[28:31], s38 offen lds
s_waitcnt vmcnt(8)
s_barrier
s_add_u32 s37, s52, 540672
s_add_u32 m0, s39, 131072
s_nop 0
buffer_load_dwordx4 v3, s[24:27], s37 offen sc1 lds
buffer_load_dwordx4 v3, s[24:27], s37 offen offset:1024 sc1 lds
buffer_load_dwordx4 v3, s[24:27], s37 offen offset:2048 sc1 lds
buffer_load_dwordx4 v3, s[24:27], s37 offen offset:3072 sc1 lds
s_add_u32 s38, s53, 4325376
s_add_u32 m0, s39, 0
s_nop 0
buffer_load_dwordx4 v23, s[28:31], s38 offen lds
s_add_u32 m0, s39, 1024
s_nop 0
buffer_load_dwordx4 v24, s[28:31], s38 offen lds
s_add_u32 m0, s39, 2048
s_add_u32 s38, s38, 16384
buffer_load_dwordx4 v23, s[28:31], s38 offen lds
s_add_u32 m0, s39, 3072
s_nop 0
buffer_load_dwordx4 v24, s[28:31], s38 offen lds
s_add_u32 s37, s52, 557056
s_add_u32 m0, s39, 16384
s_nop 0
buffer_load_dwordx4 v3, s[24:27], s37 offen sc1 lds
buffer_load_dwordx4 v3, s[24:27], s37 offen offset:1024 sc1 lds
buffer_load_dwordx4 v3, s[24:27], s37 offen offset:2048 sc1 lds
buffer_load_dwordx4 v3, s[24:27], s37 offen offset:3072 sc1 lds
s_add_u32 s38, s53, 4456448
s_add_u32 m0, s39, 32768
s_nop 0
buffer_load_dwordx4 v23, s[28:31], s38 offen lds
s_add_u32 m0, s39, 33792
s_nop 0
buffer_load_dwordx4 v24, s[28:31], s38 offen lds
s_add_u32 m0, s39, 34816
s_add_u32 s38, s38, 16384
buffer_load_dwordx4 v23, s[28:31], s38 offen lds
s_add_u32 m0, s39, 35840
s_nop 0
buffer_load_dwordx4 v24, s[28:31], s38 offen lds
s_waitcnt vmcnt(16)
s_barrier
ds_read_b128 v[32:35], v18 offset:32768
ds_read_b64_tr_b16 v[48:49], v13 offset:49152
ds_read_b64_tr_b16 v[50:51], v13 offset:53248
ds_read_b64_tr_b16 v[52:53], v14 offset:49152
ds_read_b64_tr_b16 v[54:55], v14 offset:53248
ds_read_b64_tr_b16 v[56:57], v15 offset:49152
ds_read_b64_tr_b16 v[58:59], v15 offset:53248
ds_read_b64_tr_b16 v[60:61], v16 offset:49152
ds_read_b64_tr_b16 v[62:63], v16 offset:53248
ds_read_b128 v[36:39], v18 offset:33792
ds_read_b128 v[40:43], v18 offset:34816
ds_read_b128 v[44:47], v18 offset:35840
ds_read_b128 v[64:67], v18 offset:40960
ds_read_b64_tr_b16 v[80:81], v13 offset:57344
ds_read_b64_tr_b16 v[82:83], v13 offset:61440
ds_read_b64_tr_b16 v[84:85], v14 offset:57344
ds_read_b64_tr_b16 v[86:87], v14 offset:61440
ds_read_b64_tr_b16 v[88:89], v15 offset:57344
ds_read_b64_tr_b16 v[90:91], v15 offset:61440
ds_read_b64_tr_b16 v[92:93], v16 offset:57344
ds_read_b64_tr_b16 v[94:95], v16 offset:61440
ds_read_b128 v[68:71], v18 offset:41984
ds_read_b128 v[72:75], v18 offset:43008
ds_read_b128 v[76:79], v18 offset:44032
s_add_u32 s37, s52, 573440
s_add_u32 m0, s39, 49152
s_nop 0
buffer_load_dwordx4 v3, s[24:27], s37 offen sc1 lds
buffer_load_dwordx4 v3, s[24:27], s37 offen offset:1024 sc1 lds
buffer_load_dwordx4 v3, s[24:27], s37 offen offset:2048 sc1 lds
buffer_load_dwordx4 v3, s[24:27], s37 offen offset:3072 sc1 lds
s_add_u32 s38, s53, 4587520
s_add_u32 m0, s39, 65536
s_nop 0
buffer_load_dwordx4 v23, s[28:31], s38 offen lds
s_add_u32 m0, s39, 66560
s_nop 0
buffer_load_dwordx4 v24, s[28:31], s38 offen lds
s_add_u32 m0, s39, 67584
s_add_u32 s38, s38, 16384
buffer_load_dwordx4 v23, s[28:31], s38 offen lds
s_add_u32 m0, s39, 68608
s_nop 0
buffer_load_dwordx4 v24, s[28:31], s38 offen lds
Lk4c:
s_waitcnt vmcnt(16)
s_waitcnt lgkmcnt(0)
s_barrier
v_mfma_f32_16x16x32_bf16 v[128:131], v[48:51], v[32:35], v[128:131]
ds_read_b128 v[96:99], v19 offset:0
v_mfma_f32_16x16x32_bf16 v[136:139], v[48:51], v[36:39], v[136:139]
ds_read_b64_tr_b16 v[112:113], v9 offset:0
v_mfma_f32_16x16x32_bf16 v[144:147], v[48:51], v[40:43], v[144:147]
ds_read_b64_tr_b16 v[114:115], v9 offset:4096
v_mfma_f32_16x16x32_bf16 v[152:155], v[48:51], v[44:47], v[152:155]
ds_read_b64_tr_b16 v[116:117], v10 offset:0
v_mfma_f32_16x16x32_bf16 v[156:159], v[52:55], v[44:47], v[156:159]
ds_read_b64_tr_b16 v[118:119], v10 offset:4096
v_mfma_f32_16x16x32_bf16 v[148:151], v[52:55], v[40:43], v[148:151]
ds_read_b64_tr_b16 v[120:121], v11 offset:0
v_mfma_f32_16x16x32_bf16 v[140:143], v[52:55], v[36:39], v[140:143]
ds_read_b64_tr_b16 v[122:123], v11 offset:4096
v_mfma_f32_16x16x32_bf16 v[132:135], v[52:55], v[32:35], v[132:135]
ds_read_b64_tr_b16 v[124:125], v12 offset:0
v_mfma_f32_16x16x32_bf16 v[160:163], v[56:59], v[32:35], 0
ds_read_b64_tr_b16 v[126:127], v12 offset:4096
v_mfma_f32_16x16x32_bf16 v[168:171], v[56:59], v[36:39], 0
ds_read_b128 v[100:103], v19 offset:1024
v_mfma_f32_16x16x32_bf16 v[176:179], v[56:59], v[40:43], 0
ds_read_b128 v[104:107], v19 offset:2048
v_mfma_f32_16x16x32_bf16 v[184:187], v[56:59], v[44:47], 0
ds_read_b128 v[108:111], v19 offset:3072
v_mfma_f32_16x16x32_bf16 v[188:191], v[60:63], v[44:47], 0
ds_read_b128 v[192:195], v19 offset:8192
v_mfma_f32_16x16x32_bf16 v[180:183], v[60:63], v[40:43], 0
ds_read_b64_tr_b16 v[208:209], v9 offset:8192
v_mfma_f32_16x16x32_bf16 v[172:175], v[60:63], v[36:39], 0
ds_read_b64_tr_b16 v[210:211], v9 offset:12288
v_mfma_f32_16x16x32_bf16 v[164:167], v[60:63], v[32:35], 0
ds_read_b64_tr_b16 v[212:213], v10 offset:8192
v_mfma_f32_16x16x32_bf16 v[128:131], v[80:83], v[64:67], v[128:131]
ds_read_b64_tr_b16 v[214:215], v10 offset:12288
v_mfma_f32_16x16x32_bf16 v[136:139], v[80:83], v[68:71], v[136:139]
ds_read_b64_tr_b16 v[216:217], v11 offset:8192
v_mfma_f32_16x16x32_bf16 v[144:147], v[80:83], v[72:75], v[144:147]
ds_read_b64_tr_b16 v[218:219], v11 offset:12288
v_mfma_f32_16x16x32_bf16 v[152:155], v[80:83], v[76:79], v[152:155]
ds_read_b64_tr_b16 v[220:221], v12 offset:8192
v_mfma_f32_16x16x32_bf16 v[156:159], v[84:87], v[76:79], v[156:159]
ds_read_b64_tr_b16 v[222:223], v12 offset:12288
v_mfma_f32_16x16x32_bf16 v[148:151], v[84:87], v[72:75], v[148:151]
ds_read_b128 v[196:199], v19 offset:9216
v_mfma_f32_16x16x32_bf16 v[140:143], v[84:87], v[68:71], v[140:143]
ds_read_b128 v[200:203], v19 offset:10240
v_mfma_f32_16x16x32_bf16 v[132:135], v[84:87], v[64:67], v[132:135]
ds_read_b128 v[204:207], v19 offset:11264
v_mfma_f32_16x16x32_bf16 v[160:163], v[88:91], v[64:67], v[160:163]
v_mfma_f32_16x16x32_bf16 v[168:171], v[88:91], v[68:71], v[168:171]
v_mfma_f32_16x16x32_bf16 v[176:179], v[88:91], v[72:75], v[176:179]
v_mfma_f32_16x16x32_bf16 v[184:187], v[88:91], v[76:79], v[184:187]
v_mfma_f32_16x16x32_bf16 v[188:191], v[92:95], v[76:79], v[188:191]
v_mfma_f32_16x16x32_bf16 v[180:183], v[92:95], v[72:75], v[180:183]
v_mfma_f32_16x16x32_bf16 v[172:175], v[92:95], v[68:71], v[172:175]
v_mfma_f32_16x16x32_bf16 v[164:167], v[92:95], v[64:67], v[164:167]
s_mov_b32 s41, 2
Lk4_131:
s_waitcnt vmcnt(8)
s_waitcnt lgkmcnt(0)
s_barrier
v_mfma_f32_16x16x32_bf16 v[128:131], v[112:115], v[96:99], v[128:131]
ds_read_b128 v[32:35], v17 offset:16384
v_mfma_f32_16x16x32_bf16 v[136:139], v[112:115], v[100:103], v[136:139]
ds_read_b64_tr_b16 v[48:49], v9 offset:32768
v_mfma_f32_16x16x32_bf16 v[144:147], v[112:115], v[104:107], v[144:147]
ds_read_b64_tr_b16 v[50:51], v9 offset:36864
v_mfma_f32_16x16x32_bf16 v[152:155], v[112:115], v[108:111], v[152:155]
ds_read_b64_tr_b16 v[52:53], v10 offset:32768
v_mfma_f32_16x16x32_bf16 v[156:159], v[116:119], v[108:111], v[156:159]
ds_read_b64_tr_b16 v[54:55], v10 offset:36864
v_mfma_f32_16x16x32_bf16 v[148:151], v[116:119], v[104:107], v[148:151]
ds_read_b64_tr_b16 v[56:57], v11 offset:32768
v_mfma_f32_16x16x32_bf16 v[140:143], v[116:119], v[100:103], v[140:143]
ds_read_b64_tr_b16 v[58:59], v11 offset:36864
v_mfma_f32_16x16x32_bf16 v[132:135], v[116:119], v[96:99], v[132:135]
ds_read_b64_tr_b16 v[60:61], v12 offset:32768
v_mfma_f32_16x16x32_bf16 v[160:163], v[120:123], v[96:99], v[160:163]
ds_read_b64_tr_b16 v[62:63], v12 offset:36864
v_mfma_f32_16x16x32_bf16 v[168:171], v[120:123], v[100:103], v[168:171]
ds_read_b128 v[36:39], v17 offset:17408
v_mfma_f32_16x16x32_bf16 v[176:179], v[120:123], v[104:107], v[176:179]
ds_read_b128 v[40:43], v17 offset:18432
v_mfma_f32_16x16x32_bf16 v[184:187], v[120:123], v[108:111], v[184:187]
ds_read_b128 v[44:47], v17 offset:19456
v_mfma_f32_16x16x32_bf16 v[188:191], v[124:127], v[108:111], v[188:191]
ds_read_b128 v[64:67], v17 offset:24576
v_mfma_f32_16x16x32_bf16 v[180:183], v[124:127], v[104:107], v[180:183]
ds_read_b64_tr_b16 v[80:81], v9 offset:40960
v_mfma_f32_16x16x32_bf16 v[172:175], v[124:127], v[100:103], v[172:175]
ds_read_b64_tr_b16 v[82:83], v9 offset:45056
v_mfma_f32_16x16x32_bf16 v[164:167], v[124:127], v[96:99], v[164:167]
ds_read_b64_tr_b16 v[84:85], v10 offset:40960
v_mfma_f32_16x16x32_bf16 v[128:131], v[208:211], v[192:195], v[128:131]
ds_read_b64_tr_b16 v[86:87], v10 offset:45056
v_mfma_f32_16x16x32_bf16 v[136:139], v[208:211], v[196:199], v[136:139]
ds_read_b64_tr_b16 v[88:89], v11 offset:40960
v_mfma_f32_16x16x32_bf16 v[144:147], v[208:211], v[200:203], v[144:147]
ds_read_b64_tr_b16 v[90:91], v11 offset:45056
v_mfma_f32_16x16x32_bf16 v[152:155], v[208:211], v[204:207], v[152:155]
ds_read_b64_tr_b16 v[92:93], v12 offset:40960
v_mfma_f32_16x16x32_bf16 v[156:159], v[212:215], v[204:207], v[156:159]
ds_read_b64_tr_b16 v[94:95], v12 offset:45056
v_mfma_f32_16x16x32_bf16 v[148:151], v[212:215], v[200:203], v[148:151]
ds_read_b128 v[68:71], v17 offset:25600
v_mfma_f32_16x16x32_bf16 v[140:143], v[212:215], v[196:199], v[140:143]
ds_read_b128 v[72:75], v17 offset:26624
v_mfma_f32_16x16x32_bf16 v[132:135], v[212:215], v[192:195], v[132:135]
ds_read_b128 v[76:79], v17 offset:27648
v_mfma_f32_16x16x32_bf16 v[160:163], v[216:219], v[192:195], v[160:163]
v_mfma_f32_16x16x32_bf16 v[168:171], v[216:219], v[196:199], v[168:171]
v_mfma_f32_16x16x32_bf16 v[176:179], v[216:219], v[200:203], v[176:179]
v_mfma_f32_16x16x32_bf16 v[184:187], v[216:219], v[204:207], v[184:187]
v_mfma_f32_16x16x32_bf16 v[188:191], v[220:223], v[204:207], v[188:191]
v_mfma_f32_16x16x32_bf16 v[180:183], v[220:223], v[200:203], v[180:183]
v_mfma_f32_16x16x32_bf16 v[172:175], v[220:223], v[196:199], v[172:175]
v_mfma_f32_16x16x32_bf16 v[164:167], v[220:223], v[192:195], v[164:167]
s_waitcnt vmcnt(0)
s_waitcnt lgkmcnt(0)
s_barrier
v_mfma_f32_16x16x32_bf16 v[128:131], v[48:51], v[32:35], v[128:131]
ds_read_b128 v[96:99], v17 offset:49152
v_mfma_f32_16x16x32_bf16 v[136:139], v[48:51], v[36:39], v[136:139]
ds_read_b64_tr_b16 v[112:113], v13 offset:0
v_mfma_f32_16x16x32_bf16 v[144:147], v[48:51], v[40:43], v[144:147]
ds_read_b64_tr_b16 v[114:115], v13 offset:4096
v_mfma_f32_16x16x32_bf16 v[152:155], v[48:51], v[44:47], v[152:155]
ds_read_b64_tr_b16 v[116:117], v14 offset:0
v_mfma_f32_16x16x32_bf16 v[156:159], v[52:55], v[44:47], v[156:159]
ds_read_b64_tr_b16 v[118:119], v14 offset:4096
v_mfma_f32_16x16x32_bf16 v[148:151], v[52:55], v[40:43], v[148:151]
ds_read_b64_tr_b16 v[120:121], v15 offset:0
v_mfma_f32_16x16x32_bf16 v[140:143], v[52:55], v[36:39], v[140:143]
ds_read_b64_tr_b16 v[122:123], v15 offset:4096
v_mfma_f32_16x16x32_bf16 v[132:135], v[52:55], v[32:35], v[132:135]
ds_read_b64_tr_b16 v[124:125], v16 offset:0
v_mfma_f32_16x16x32_bf16 v[160:163], v[56:59], v[32:35], v[160:163]
ds_read_b64_tr_b16 v[126:127], v16 offset:4096
v_mfma_f32_16x16x32_bf16 v[168:171], v[56:59], v[36:39], v[168:171]
ds_read_b128 v[100:103], v17 offset:50176
v_mfma_f32_16x16x32_bf16 v[176:179], v[56:59], v[40:43], v[176:179]
ds_read_b128 v[104:107], v17 offset:51200
v_mfma_f32_16x16x32_bf16 v[184:187], v[56:59], v[44:47], v[184:187]
ds_read_b128 v[108:111], v17 offset:52224
v_mfma_f32_16x16x32_bf16 v[188:191], v[60:63], v[44:47], v[188:191]
ds_read_b128 v[192:195], v17 offset:57344
v_mfma_f32_16x16x32_bf16 v[180:183], v[60:63], v[40:43], v[180:183]
ds_read_b64_tr_b16 v[208:209], v13 offset:8192
v_mfma_f32_16x16x32_bf16 v[172:175], v[60:63], v[36:39], v[172:175]
ds_read_b64_tr_b16 v[210:211], v13 offset:12288
v_mfma_f32_16x16x32_bf16 v[164:167], v[60:63], v[32:35], v[164:167]
ds_read_b64_tr_b16 v[212:213], v14 offset:8192
v_mfma_f32_16x16x32_bf16 v[128:131], v[80:83], v[64:67], v[128:131]
ds_read_b64_tr_b16 v[214:215], v14 offset:12288
v_mfma_f32_16x16x32_bf16 v[136:139], v[80:83], v[68:71], v[136:139]
ds_read_b64_tr_b16 v[216:217], v15 offset:8192
v_mfma_f32_16x16x32_bf16 v[144:147], v[80:83], v[72:75], v[144:147]
ds_read_b64_tr_b16 v[218:219], v15 offset:12288
v_mfma_f32_16x16x32_bf16 v[152:155], v[80:83], v[76:79], v[152:155]
ds_read_b64_tr_b16 v[220:221], v16 offset:8192
v_mfma_f32_16x16x32_bf16 v[156:159], v[84:87], v[76:79], v[156:159]
ds_read_b64_tr_b16 v[222:223], v16 offset:12288
v_mfma_f32_16x16x32_bf16 v[148:151], v[84:87], v[72:75], v[148:151]
ds_read_b128 v[196:199], v17 offset:58368
v_mfma_f32_16x16x32_bf16 v[140:143], v[84:87], v[68:71], v[140:143]
ds_read_b128 v[200:203], v17 offset:59392
v_mfma_f32_16x16x32_bf16 v[132:135], v[84:87], v[64:67], v[132:135]
ds_read_b128 v[204:207], v17 offset:60416
v_mfma_f32_16x16x32_bf16 v[160:163], v[88:91], v[64:67], v[160:163]
v_mfma_f32_16x16x32_bf16 v[168:171], v[88:91], v[68:71], v[168:171]
v_mfma_f32_16x16x32_bf16 v[176:179], v[88:91], v[72:75], v[176:179]
v_mfma_f32_16x16x32_bf16 v[184:187], v[88:91], v[76:79], v[184:187]
v_mfma_f32_16x16x32_bf16 v[188:191], v[92:95], v[76:79], v[188:191]
v_mfma_f32_16x16x32_bf16 v[180:183], v[92:95], v[72:75], v[180:183]
v_mfma_f32_16x16x32_bf16 v[172:175], v[92:95], v[68:71], v[172:175]
v_mfma_f32_16x16x32_bf16 v[164:167], v[92:95], v[64:67], v[164:167]
s_waitcnt lgkmcnt(0)
s_barrier
v_mfma_f32_16x16x32_bf16 v[128:131], v[112:115], v[96:99], v[128:131]
ds_read_b128 v[32:35], v18 offset:16384
v_mfma_f32_16x16x32_bf16 v[136:139], v[112:115], v[100:103], v[136:139]
ds_read_b64_tr_b16 v[48:49], v25 offset:16384
v_mfma_f32_16x16x32_bf16 v[144:147], v[112:115], v[104:107], v[144:147]
ds_read_b64_tr_b16 v[50:51], v25 offset:20480
v_mfma_f32_16x16x32_bf16 v[152:155], v[112:115], v[108:111], v[152:155]
ds_read_b64_tr_b16 v[52:53], v26 offset:16384
v_mfma_f32_16x16x32_bf16 v[156:159], v[116:119], v[108:111], v[156:159]
ds_read_b64_tr_b16 v[54:55], v26 offset:20480
v_mfma_f32_16x16x32_bf16 v[148:151], v[116:119], v[104:107], v[148:151]
ds_read_b64_tr_b16 v[56:57], v27 offset:16384
v_mfma_f32_16x16x32_bf16 v[140:143], v[116:119], v[100:103], v[140:143]
ds_read_b64_tr_b16 v[58:59], v27 offset:20480
v_mfma_f32_16x16x32_bf16 v[132:135], v[116:119], v[96:99], v[132:135]
ds_read_b64_tr_b16 v[60:61], v28 offset:16384
v_mfma_f32_16x16x32_bf16 v[160:163], v[120:123], v[96:99], v[160:163]
ds_read_b64_tr_b16 v[62:63], v28 offset:20480
v_mfma_f32_16x16x32_bf16 v[168:171], v[120:123], v[100:103], v[168:171]
ds_read_b128 v[36:39], v18 offset:17408
v_mfma_f32_16x16x32_bf16 v[176:179], v[120:123], v[104:107], v[176:179]
ds_read_b128 v[40:43], v18 offset:18432
v_mfma_f32_16x16x32_bf16 v[184:187], v[120:123], v[108:111], v[184:187]
ds_read_b128 v[44:47], v18 offset:19456
v_mfma_f32_16x16x32_bf16 v[188:191], v[124:127], v[108:111], v[188:191]
ds_read_b128 v[64:67], v18 offset:24576
v_mfma_f32_16x16x32_bf16 v[180:183], v[124:127], v[104:107], v[180:183]
ds_read_b64_tr_b16 v[80:81], v25 offset:24576
v_mfma_f32_16x16x32_bf16 v[172:175], v[124:127], v[100:103], v[172:175]
ds_read_b64_tr_b16 v[82:83], v25 offset:28672
v_mfma_f32_16x16x32_bf16 v[164:167], v[124:127], v[96:99], v[164:167]
ds_read_b64_tr_b16 v[84:85], v26 offset:24576
v_mfma_f32_16x16x32_bf16 v[128:131], v[208:211], v[192:195], v[128:131]
ds_read_b64_tr_b16 v[86:87], v26 offset:28672
v_mfma_f32_16x16x32_bf16 v[136:139], v[208:211], v[196:199], v[136:139]
s_branch Lov_11
.p2align 12
.fill 80, 4, 0xbf800000
Lst_11_0:
s_branch Lwr_166
Lst_11_1:
s_branch Lst_15_0
s_nop 0
Lov_11:
ds_read_b64_tr_b16 v[88:89], v27 offset:24576
v_mfma_f32_16x16x32_bf16 v[144:147], v[208:211], v[200:203], v[144:147]
ds_read_b64_tr_b16 v[90:91], v27 offset:28672
v_mfma_f32_16x16x32_bf16 v[152:155], v[208:211], v[204:207], v[152:155]
ds_read_b64_tr_b16 v[92:93], v28 offset:24576
v_mfma_f32_16x16x32_bf16 v[156:159], v[212:215], v[204:207], v[156:159]
ds_read_b64_tr_b16 v[94:95], v28 offset:28672
v_mfma_f32_16x16x32_bf16 v[148:151], v[212:215], v[200:203], v[148:151]
ds_read_b128 v[68:71], v18 offset:25600
v_mfma_f32_16x16x32_bf16 v[140:143], v[212:215], v[196:199], v[140:143]
ds_read_b128 v[72:75], v18 offset:26624
v_mfma_f32_16x16x32_bf16 v[132:135], v[212:215], v[192:195], v[132:135]
ds_read_b128 v[76:79], v18 offset:27648
v_mfma_f32_16x16x32_bf16 v[160:163], v[216:219], v[192:195], v[160:163]
v_mfma_f32_16x16x32_bf16 v[168:171], v[216:219], v[196:199], v[168:171]
v_mfma_f32_16x16x32_bf16 v[176:179], v[216:219], v[200:203], v[176:179]
v_mfma_f32_16x16x32_bf16 v[184:187], v[216:219], v[204:207], v[184:187]
v_mfma_f32_16x16x32_bf16 v[188:191], v[220:223], v[204:207], v[188:191]
v_mfma_f32_16x16x32_bf16 v[180:183], v[220:223], v[200:203], v[180:183]
v_mfma_f32_16x16x32_bf16 v[172:175], v[220:223], v[196:199], v[172:175]
v_mfma_f32_16x16x32_bf16 v[164:167], v[220:223], v[192:195], v[164:167]
s_waitcnt lgkmcnt(0)
s_barrier
v_mfma_f32_16x16x32_bf16 v[128:131], v[48:51], v[32:35], v[128:131]
ds_read_b128 v[96:99], v18 offset:32768
v_mfma_f32_16x16x32_bf16 v[136:139], v[48:51], v[36:39], v[136:139]
ds_read_b64_tr_b16 v[112:113], v13 offset:49152
v_mfma_f32_16x16x32_bf16 v[144:147], v[48:51], v[40:43], v[144:147]
ds_read_b64_tr_b16 v[114:115], v13 offset:53248
v_mfma_f32_16x16x32_bf16 v[152:155], v[48:51], v[44:47], v[152:155]
ds_read_b64_tr_b16 v[116:117], v14 offset:49152
v_mfma_f32_16x16x32_bf16 v[156:159], v[52:55], v[44:47], v[156:159]
ds_read_b64_tr_b16 v[118:119], v14 offset:53248
v_mfma_f32_16x16x32_bf16 v[148:151], v[52:55], v[40:43], v[148:151]
ds_read_b64_tr_b16 v[120:121], v15 offset:49152
v_mfma_f32_16x16x32_bf16 v[140:143], v[52:55], v[36:39], v[140:143]
ds_read_b64_tr_b16 v[122:123], v15 offset:53248
v_mfma_f32_16x16x32_bf16 v[132:135], v[52:55], v[32:35], v[132:135]
ds_read_b64_tr_b16 v[124:125], v16 offset:49152
v_mfma_f32_16x16x32_bf16 v[160:163], v[56:59], v[32:35], v[160:163]
ds_read_b64_tr_b16 v[126:127], v16 offset:53248
v_mfma_f32_16x16x32_bf16 v[168:171], v[56:59], v[36:39], v[168:171]
ds_read_b128 v[100:103], v18 offset:33792
v_mfma_f32_16x16x32_bf16 v[176:179], v[56:59], v[40:43], v[176:179]
ds_read_b128 v[104:107], v18 offset:34816
v_mfma_f32_16x16x32_bf16 v[184:187], v[56:59], v[44:47], v[184:187]
ds_read_b128 v[108:111], v18 offset:35840
v_mfma_f32_16x16x32_bf16 v[188:191], v[60:63], v[44:47], v[188:191]
ds_read_b128 v[192:195], v18 offset:40960
v_mfma_f32_16x16x32_bf16 v[180:183], v[60:63], v[40:43], v[180:183]
ds_read_b64_tr_b16 v[208:209], v13 offset:57344
v_mfma_f32_16x16x32_bf16 v[172:175], v[60:63], v[36:39], v[172:175]
ds_read_b64_tr_b16 v[210:211], v13 offset:61440
v_mfma_f32_16x16x32_bf16 v[164:167], v[60:63], v[32:35], v[164:167]
ds_read_b64_tr_b16 v[212:213], v14 offset:57344
v_mfma_f32_16x16x32_bf16 v[128:131], v[80:83], v[64:67], v[128:131]
ds_read_b64_tr_b16 v[214:215], v14 offset:61440
v_mfma_f32_16x16x32_bf16 v[136:139], v[80:83], v[68:71], v[136:139]
ds_read_b64_tr_b16 v[216:217], v15 offset:57344
v_mfma_f32_16x16x32_bf16 v[144:147], v[80:83], v[72:75], v[144:147]
ds_read_b64_tr_b16 v[218:219], v15 offset:61440
v_mfma_f32_16x16x32_bf16 v[152:155], v[80:83], v[76:79], v[152:155]
ds_read_b64_tr_b16 v[220:221], v16 offset:57344
v_mfma_f32_16x16x32_bf16 v[156:159], v[84:87], v[76:79], v[156:159]
ds_read_b64_tr_b16 v[222:223], v16 offset:61440
v_mfma_f32_16x16x32_bf16 v[148:151], v[84:87], v[72:75], v[148:151]
ds_read_b128 v[196:199], v18 offset:41984
v_mfma_f32_16x16x32_bf16 v[140:143], v[84:87], v[68:71], v[140:143]
ds_read_b128 v[200:203], v18 offset:43008
v_mfma_f32_16x16x32_bf16 v[132:135], v[84:87], v[64:67], v[132:135]
ds_read_b128 v[204:207], v18 offset:44032
v_mfma_f32_16x16x32_bf16 v[160:163], v[88:91], v[64:67], v[160:163]
v_mfma_f32_16x16x32_bf16 v[168:171], v[88:91], v[68:71], v[168:171]
v_mfma_f32_16x16x32_bf16 v[176:179], v[88:91], v[72:75], v[176:179]
v_mfma_f32_16x16x32_bf16 v[184:187], v[88:91], v[76:79], v[184:187]
v_mfma_f32_16x16x32_bf16 v[188:191], v[92:95], v[76:79], v[188:191]
v_mfma_f32_16x16x32_bf16 v[180:183], v[92:95], v[72:75], v[180:183]
v_mfma_f32_16x16x32_bf16 v[172:175], v[92:95], v[68:71], v[172:175]
v_mfma_f32_16x16x32_bf16 v[164:167], v[92:95], v[64:67], v[164:167]
s_waitcnt lgkmcnt(0)
s_barrier
v_mfma_f32_16x16x32_bf16 v[128:131], v[112:115], v[96:99], v[128:131]
ds_read_b128 v[32:35], v19 offset:0
v_mfma_f32_16x16x32_bf16 v[136:139], v[112:115], v[100:103], v[136:139]
ds_read_b64_tr_b16 v[48:49], v9 offset:0
v_mfma_f32_16x16x32_bf16 v[144:147], v[112:115], v[104:107], v[144:147]
ds_read_b64_tr_b16 v[50:51], v9 offset:4096
v_mfma_f32_16x16x32_bf16 v[152:155], v[112:115], v[108:111], v[152:155]
ds_read_b64_tr_b16 v[52:53], v10 offset:0
v_mfma_f32_16x16x32_bf16 v[156:159], v[116:119], v[108:111], v[156:159]
ds_read_b64_tr_b16 v[54:55], v10 offset:4096
v_mfma_f32_16x16x32_bf16 v[148:151], v[116:119], v[104:107], v[148:151]
ds_read_b64_tr_b16 v[56:57], v11 offset:0
v_mfma_f32_16x16x32_bf16 v[140:143], v[116:119], v[100:103], v[140:143]
ds_read_b64_tr_b16 v[58:59], v11 offset:4096
v_mfma_f32_16x16x32_bf16 v[132:135], v[116:119], v[96:99], v[132:135]
ds_read_b64_tr_b16 v[60:61], v12 offset:0
v_mfma_f32_16x16x32_bf16 v[160:163], v[120:123], v[96:99], v[160:163]
ds_read_b64_tr_b16 v[62:63], v12 offset:4096
v_mfma_f32_16x16x32_bf16 v[168:171], v[120:123], v[100:103], v[168:171]
ds_read_b128 v[36:39], v19 offset:1024
v_mfma_f32_16x16x32_bf16 v[176:179], v[120:123], v[104:107], v[176:179]
ds_read_b128 v[40:43], v19 offset:2048
v_mfma_f32_16x16x32_bf16 v[184:187], v[120:123], v[108:111], v[184:187]
ds_read_b128 v[44:47], v19 offset:3072
v_mfma_f32_16x16x32_bf16 v[188:191], v[124:127], v[108:111], v[188:191]
ds_read_b128 v[64:67], v19 offset:8192
v_mfma_f32_16x16x32_bf16 v[180:183], v[124:127], v[104:107], v[180:183]
ds_read_b64_tr_b16 v[80:81], v9 offset:8192
v_mfma_f32_16x16x32_bf16 v[172:175], v[124:127], v[100:103], v[172:175]
ds_read_b64_tr_b16 v[82:83], v9 offset:12288
v_mfma_f32_16x16x32_bf16 v[164:167], v[124:127], v[96:99], v[164:167]
ds_read_b64_tr_b16 v[84:85], v10 offset:8192
v_mfma_f32_16x16x32_bf16 v[128:131], v[208:211], v[192:195], v[128:131]
ds_read_b64_tr_b16 v[86:87], v10 offset:12288
v_mfma_f32_16x16x32_bf16 v[136:139], v[208:211], v[196:199], v[136:139]
ds_read_b64_tr_b16 v[88:89], v11 offset:8192
v_mfma_f32_16x16x32_bf16 v[144:147], v[208:211], v[200:203], v[144:147]
ds_read_b64_tr_b16 v[90:91], v11 offset:12288
v_mfma_f32_16x16x32_bf16 v[152:155], v[208:211], v[204:207], v[152:155]
ds_read_b64_tr_b16 v[92:93], v12 offset:8192
v_mfma_f32_16x16x32_bf16 v[156:159], v[212:215], v[204:207], v[156:159]
ds_read_b64_tr_b16 v[94:95], v12 offset:12288
v_mfma_f32_16x16x32_bf16 v[148:151], v[212:215], v[200:203], v[148:151]
ds_read_b128 v[68:71], v19 offset:9216
v_mfma_f32_16x16x32_bf16 v[140:143], v[212:215], v[196:199], v[140:143]
ds_read_b128 v[72:75], v19 offset:10240
v_mfma_f32_16x16x32_bf16 v[132:135], v[212:215], v[192:195], v[132:135]
ds_read_b128 v[76:79], v19 offset:11264
v_mfma_f32_16x16x32_bf16 v[160:163], v[216:219], v[192:195], v[160:163]
v_mfma_f32_16x16x32_bf16 v[168:171], v[216:219], v[196:199], v[168:171]
v_mfma_f32_16x16x32_bf16 v[176:179], v[216:219], v[200:203], v[176:179]
v_mfma_f32_16x16x32_bf16 v[184:187], v[216:219], v[204:207], v[184:187]
v_mfma_f32_16x16x32_bf16 v[188:191], v[220:223], v[204:207], v[188:191]
v_mfma_f32_16x16x32_bf16 v[180:183], v[220:223], v[200:203], v[180:183]
v_mfma_f32_16x16x32_bf16 v[172:175], v[220:223], v[196:199], v[172:175]
v_mfma_f32_16x16x32_bf16 v[164:167], v[220:223], v[192:195], v[164:167]
s_waitcnt lgkmcnt(0)
s_barrier
v_mfma_f32_16x16x32_bf16 v[128:131], v[48:51], v[32:35], v[128:131]
ds_read_b128 v[96:99], v17 offset:16384
v_mfma_f32_16x16x32_bf16 v[136:139], v[48:51], v[36:39], v[136:139]
ds_read_b64_tr_b16 v[112:113], v9 offset:32768
v_mfma_f32_16x16x32_bf16 v[144:147], v[48:51], v[40:43], v[144:147]
ds_read_b64_tr_b16 v[114:115], v9 offset:36864
v_mfma_f32_16x16x32_bf16 v[152:155], v[48:51], v[44:47], v[152:155]
ds_read_b64_tr_b16 v[116:117], v10 offset:32768
v_mfma_f32_16x16x32_bf16 v[156:159], v[52:55], v[44:47], v[156:159]
ds_read_b64_tr_b16 v[118:119], v10 offset:36864
v_mfma_f32_16x16x32_bf16 v[148:151], v[52:55], v[40:43], v[148:151]
ds_read_b64_tr_b16 v[120:121], v11 offset:32768
v_mfma_f32_16x16x32_bf16 v[140:143], v[52:55], v[36:39], v[140:143]
ds_read_b64_tr_b16 v[122:123], v11 offset:36864
v_mfma_f32_16x16x32_bf16 v[132:135], v[52:55], v[32:35], v[132:135]
ds_read_b64_tr_b16 v[124:125], v12 offset:32768
v_mfma_f32_16x16x32_bf16 v[160:163], v[56:59], v[32:35], v[160:163]
ds_read_b64_tr_b16 v[126:127], v12 offset:36864
v_mfma_f32_16x16x32_bf16 v[168:171], v[56:59], v[36:39], v[168:171]
ds_read_b128 v[100:103], v17 offset:17408
v_mfma_f32_16x16x32_bf16 v[176:179], v[56:59], v[40:43], v[176:179]
ds_read_b128 v[104:107], v17 offset:18432
v_mfma_f32_16x16x32_bf16 v[184:187], v[56:59], v[44:47], v[184:187]
ds_read_b128 v[108:111], v17 offset:19456
v_mfma_f32_16x16x32_bf16 v[188:191], v[60:63], v[44:47], v[188:191]
ds_read_b128 v[192:195], v17 offset:24576
v_mfma_f32_16x16x32_bf16 v[180:183], v[60:63], v[40:43], v[180:183]
ds_read_b64_tr_b16 v[208:209], v9 offset:40960
v_mfma_f32_16x16x32_bf16 v[172:175], v[60:63], v[36:39], v[172:175]
ds_read_b64_tr_b16 v[210:211], v9 offset:45056
v_mfma_f32_16x16x32_bf16 v[164:167], v[60:63], v[32:35], v[164:167]
ds_read_b64_tr_b16 v[212:213], v10 offset:40960
v_mfma_f32_16x16x32_bf16 v[128:131], v[80:83], v[64:67], v[128:131]
ds_read_b64_tr_b16 v[214:215], v10 offset:45056
v_mfma_f32_16x16x32_bf16 v[136:139], v[80:83], v[68:71], v[136:139]
ds_read_b64_tr_b16 v[216:217], v11 offset:40960
v_mfma_f32_16x16x32_bf16 v[144:147], v[80:83], v[72:75], v[144:147]
ds_read_b64_tr_b16 v[218:219], v11 offset:45056
v_mfma_f32_16x16x32_bf16 v[152:155], v[80:83], v[76:79], v[152:155]
ds_read_b64_tr_b16 v[220:221], v12 offset:40960
v_mfma_f32_16x16x32_bf16 v[156:159], v[84:87], v[76:79], v[156:159]
ds_read_b64_tr_b16 v[222:223], v12 offset:45056
v_mfma_f32_16x16x32_bf16 v[148:151], v[84:87], v[72:75], v[148:151]
ds_read_b128 v[196:199], v17 offset:25600
v_mfma_f32_16x16x32_bf16 v[140:143], v[84:87], v[68:71], v[140:143]
ds_read_b128 v[200:203], v17 offset:26624
v_mfma_f32_16x16x32_bf16 v[132:135], v[84:87], v[64:67], v[132:135]
ds_read_b128 v[204:207], v17 offset:27648
v_mfma_f32_16x16x32_bf16 v[160:163], v[88:91], v[64:67], v[160:163]
v_mfma_f32_16x16x32_bf16 v[168:171], v[88:91], v[68:71], v[168:171]
v_mfma_f32_16x16x32_bf16 v[176:179], v[88:91], v[72:75], v[176:179]
v_mfma_f32_16x16x32_bf16 v[184:187], v[88:91], v[76:79], v[184:187]
v_mfma_f32_16x16x32_bf16 v[188:191], v[92:95], v[76:79], v[188:191]
v_mfma_f32_16x16x32_bf16 v[180:183], v[92:95], v[72:75], v[180:183]
v_mfma_f32_16x16x32_bf16 v[172:175], v[92:95], v[68:71], v[172:175]
v_mfma_f32_16x16x32_bf16 v[164:167], v[92:95], v[64:67], v[164:167]
s_waitcnt lgkmcnt(0)
s_barrier
v_mfma_f32_16x16x32_bf16 v[128:131], v[112:115], v[96:99], v[128:131]
ds_read_b128 v[32:35], v17 offset:49152
v_mfma_f32_16x16x32_bf16 v[136:139], v[112:115], v[100:103], v[136:139]
ds_read_b64_tr_b16 v[48:49], v13 offset:0
v_mfma_f32_16x16x32_bf16 v[144:147], v[112:115], v[104:107], v[144:147]
ds_read_b64_tr_b16 v[50:51], v13 offset:4096
v_mfma_f32_16x16x32_bf16 v[152:155], v[112:115], v[108:111], v[152:155]
ds_read_b64_tr_b16 v[52:53], v14 offset:0
v_mfma_f32_16x16x32_bf16 v[156:159], v[116:119], v[108:111], v[156:159]
ds_read_b64_tr_b16 v[54:55], v14 offset:4096
v_mfma_f32_16x16x32_bf16 v[148:151], v[116:119], v[104:107], v[148:151]
ds_read_b64_tr_b16 v[56:57], v15 offset:0
v_mfma_f32_16x16x32_bf16 v[140:143], v[116:119], v[100:103], v[140:143]
ds_read_b64_tr_b16 v[58:59], v15 offset:4096
v_mfma_f32_16x16x32_bf16 v[132:135], v[116:119], v[96:99], v[132:135]
ds_read_b64_tr_b16 v[60:61], v16 offset:0
v_mfma_f32_16x16x32_bf16 v[160:163], v[120:123], v[96:99], v[160:163]
ds_read_b64_tr_b16 v[62:63], v16 offset:4096
v_mfma_f32_16x16x32_bf16 v[168:171], v[120:123], v[100:103], v[168:171]
ds_read_b128 v[36:39], v17 offset:50176
v_mfma_f32_16x16x32_bf16 v[176:179], v[120:123], v[104:107], v[176:179]
ds_read_b128 v[40:43], v17 offset:51200
v_mfma_f32_16x16x32_bf16 v[184:187], v[120:123], v[108:111], v[184:187]
ds_read_b128 v[44:47], v17 offset:52224
v_mfma_f32_16x16x32_bf16 v[188:191], v[124:127], v[108:111], v[188:191]
ds_read_b128 v[64:67], v17 offset:57344
v_mfma_f32_16x16x32_bf16 v[180:183], v[124:127], v[104:107], v[180:183]
ds_read_b64_tr_b16 v[80:81], v13 offset:8192
v_mfma_f32_16x16x32_bf16 v[172:175], v[124:127], v[100:103], v[172:175]
ds_read_b64_tr_b16 v[82:83], v13 offset:12288
v_mfma_f32_16x16x32_bf16 v[164:167], v[124:127], v[96:99], v[164:167]
ds_read_b64_tr_b16 v[84:85], v14 offset:8192
v_mfma_f32_16x16x32_bf16 v[128:131], v[208:211], v[192:195], v[128:131]
ds_read_b64_tr_b16 v[86:87], v14 offset:12288
v_mfma_f32_16x16x32_bf16 v[136:139], v[208:211], v[196:199], v[136:139]
ds_read_b64_tr_b16 v[88:89], v15 offset:8192
v_mfma_f32_16x16x32_bf16 v[144:147], v[208:211], v[200:203], v[144:147]
ds_read_b64_tr_b16 v[90:91], v15 offset:12288
v_mfma_f32_16x16x32_bf16 v[152:155], v[208:211], v[204:207], v[152:155]
ds_read_b64_tr_b16 v[92:93], v16 offset:8192
v_mfma_f32_16x16x32_bf16 v[156:159], v[212:215], v[204:207], v[156:159]
ds_read_b64_tr_b16 v[94:95], v16 offset:12288
v_mfma_f32_16x16x32_bf16 v[148:151], v[212:215], v[200:203], v[148:151]
ds_read_b128 v[68:71], v17 offset:58368
v_mfma_f32_16x16x32_bf16 v[140:143], v[212:215], v[196:199], v[140:143]
ds_read_b128 v[72:75], v17 offset:59392
v_mfma_f32_16x16x32_bf16 v[132:135], v[212:215], v[192:195], v[132:135]
ds_read_b128 v[76:79], v17 offset:60416
v_mfma_f32_16x16x32_bf16 v[160:163], v[216:219], v[192:195], v[160:163]
v_mfma_f32_16x16x32_bf16 v[168:171], v[216:219], v[196:199], v[168:171]
v_mfma_f32_16x16x32_bf16 v[176:179], v[216:219], v[200:203], v[176:179]
v_mfma_f32_16x16x32_bf16 v[184:187], v[216:219], v[204:207], v[184:187]
v_mfma_f32_16x16x32_bf16 v[188:191], v[220:223], v[204:207], v[188:191]
v_mfma_f32_16x16x32_bf16 v[180:183], v[220:223], v[200:203], v[180:183]
v_mfma_f32_16x16x32_bf16 v[172:175], v[220:223], v[196:199], v[172:175]
v_mfma_f32_16x16x32_bf16 v[164:167], v[220:223], v[192:195], v[164:167]
s_waitcnt lgkmcnt(0)
s_barrier
v_mfma_f32_16x16x32_bf16 v[128:131], v[48:51], v[32:35], v[128:131]
ds_read_b128 v[96:99], v18 offset:16384
v_mfma_f32_16x16x32_bf16 v[136:139], v[48:51], v[36:39], v[136:139]
ds_read_b64_tr_b16 v[112:113], v25 offset:16384
v_mfma_f32_16x16x32_bf16 v[144:147], v[48:51], v[40:43], v[144:147]
ds_read_b64_tr_b16 v[114:115], v25 offset:20480
v_mfma_f32_16x16x32_bf16 v[152:155], v[48:51], v[44:47], v[152:155]
ds_read_b64_tr_b16 v[116:117], v26 offset:16384
v_mfma_f32_16x16x32_bf16 v[156:159], v[52:55], v[44:47], v[156:159]
ds_read_b64_tr_b16 v[118:119], v26 offset:20480
v_mfma_f32_16x16x32_bf16 v[148:151], v[52:55], v[40:43], v[148:151]
ds_read_b64_tr_b16 v[120:121], v27 offset:16384
v_mfma_f32_16x16x32_bf16 v[140:143], v[52:55], v[36:39], v[140:143]
ds_read_b64_tr_b16 v[122:123], v27 offset:20480
v_mfma_f32_16x16x32_bf16 v[132:135], v[52:55], v[32:35], v[132:135]
ds_read_b64_tr_b16 v[124:125], v28 offset:16384
v_mfma_f32_16x16x32_bf16 v[160:163], v[56:59], v[32:35], v[160:163]
ds_read_b64_tr_b16 v[126:127], v28 offset:20480
v_mfma_f32_16x16x32_bf16 v[168:171], v[56:59], v[36:39], v[168:171]
ds_read_b128 v[100:103], v18 offset:17408
v_mfma_f32_16x16x32_bf16 v[176:179], v[56:59], v[40:43], v[176:179]
ds_read_b128 v[104:107], v18 offset:18432
v_mfma_f32_16x16x32_bf16 v[184:187], v[56:59], v[44:47], v[184:187]
ds_read_b128 v[108:111], v18 offset:19456
v_mfma_f32_16x16x32_bf16 v[188:191], v[60:63], v[44:47], v[188:191]
ds_read_b128 v[192:195], v18 offset:24576
v_mfma_f32_16x16x32_bf16 v[180:183], v[60:63], v[40:43], v[180:183]
ds_read_b64_tr_b16 v[208:209], v25 offset:24576
v_mfma_f32_16x16x32_bf16 v[172:175], v[60:63], v[36:39], v[172:175]
ds_read_b64_tr_b16 v[210:211], v25 offset:28672
v_mfma_f32_16x16x32_bf16 v[164:167], v[60:63], v[32:35], v[164:167]
ds_read_b64_tr_b16 v[212:213], v26 offset:24576
v_mfma_f32_16x16x32_bf16 v[128:131], v[80:83], v[64:67], v[128:131]
ds_read_b64_tr_b16 v[214:215], v26 offset:28672
v_mfma_f32_16x16x32_bf16 v[136:139], v[80:83], v[68:71], v[136:139]
ds_read_b64_tr_b16 v[216:217], v27 offset:24576
v_mfma_f32_16x16x32_bf16 v[144:147], v[80:83], v[72:75], v[144:147]
ds_read_b64_tr_b16 v[218:219], v27 offset:28672
v_mfma_f32_16x16x32_bf16 v[152:155], v[80:83], v[76:79], v[152:155]
ds_read_b64_tr_b16 v[220:221], v28 offset:24576
v_mfma_f32_16x16x32_bf16 v[156:159], v[84:87], v[76:79], v[156:159]
ds_read_b64_tr_b16 v[222:223], v28 offset:28672
v_mfma_f32_16x16x32_bf16 v[148:151], v[84:87], v[72:75], v[148:151]
ds_read_b128 v[196:199], v18 offset:25600
v_mfma_f32_16x16x32_bf16 v[140:143], v[84:87], v[68:71], v[140:143]
ds_read_b128 v[200:203], v18 offset:26624
v_mfma_f32_16x16x32_bf16 v[132:135], v[84:87], v[64:67], v[132:135]
ds_read_b128 v[204:207], v18 offset:27648
v_mfma_f32_16x16x32_bf16 v[160:163], v[88:91], v[64:67], v[160:163]
v_mfma_f32_16x16x32_bf16 v[168:171], v[88:91], v[68:71], v[168:171]
v_mfma_f32_16x16x32_bf16 v[176:179], v[88:91], v[72:75], v[176:179]
v_mfma_f32_16x16x32_bf16 v[184:187], v[88:91], v[76:79], v[184:187]
v_mfma_f32_16x16x32_bf16 v[188:191], v[92:95], v[76:79], v[188:191]
v_mfma_f32_16x16x32_bf16 v[180:183], v[92:95], v[72:75], v[180:183]
v_mfma_f32_16x16x32_bf16 v[172:175], v[92:95], v[68:71], v[172:175]
v_mfma_f32_16x16x32_bf16 v[164:167], v[92:95], v[64:67], v[164:167]
s_waitcnt lgkmcnt(0)
s_barrier
v_mfma_f32_16x16x32_bf16 v[128:131], v[112:115], v[96:99], v[128:131]
ds_read_b128 v[32:35], v18 offset:32768
v_mfma_f32_16x16x32_bf16 v[136:139], v[112:115], v[100:103], v[136:139]
ds_read_b64_tr_b16 v[48:49], v13 offset:49152
v_mfma_f32_16x16x32_bf16 v[144:147], v[112:115], v[104:107], v[144:147]
ds_read_b64_tr_b16 v[50:51], v13 offset:53248
v_mfma_f32_16x16x32_bf16 v[152:155], v[112:115], v[108:111], v[152:155]
ds_read_b64_tr_b16 v[52:53], v14 offset:49152
v_mfma_f32_16x16x32_bf16 v[156:159], v[116:119], v[108:111], v[156:159]
ds_read_b64_tr_b16 v[54:55], v14 offset:53248
v_mfma_f32_16x16x32_bf16 v[148:151], v[116:119], v[104:107], v[148:151]
ds_read_b64_tr_b16 v[56:57], v15 offset:49152
v_mfma_f32_16x16x32_bf16 v[140:143], v[116:119], v[100:103], v[140:143]
ds_read_b64_tr_b16 v[58:59], v15 offset:53248
v_mfma_f32_16x16x32_bf16 v[132:135], v[116:119], v[96:99], v[132:135]
ds_read_b64_tr_b16 v[60:61], v16 offset:49152
v_mfma_f32_16x16x32_bf16 v[160:163], v[120:123], v[96:99], v[160:163]
ds_read_b64_tr_b16 v[62:63], v16 offset:53248
v_mfma_f32_16x16x32_bf16 v[168:171], v[120:123], v[100:103], v[168:171]
ds_read_b128 v[36:39], v18 offset:33792
v_mfma_f32_16x16x32_bf16 v[176:179], v[120:123], v[104:107], v[176:179]
ds_read_b128 v[40:43], v18 offset:34816
v_mfma_f32_16x16x32_bf16 v[184:187], v[120:123], v[108:111], v[184:187]
ds_read_b128 v[44:47], v18 offset:35840
v_mfma_f32_16x16x32_bf16 v[188:191], v[124:127], v[108:111], v[188:191]
ds_read_b128 v[64:67], v18 offset:40960
v_mfma_f32_16x16x32_bf16 v[180:183], v[124:127], v[104:107], v[180:183]
ds_read_b64_tr_b16 v[80:81], v13 offset:57344
v_mfma_f32_16x16x32_bf16 v[172:175], v[124:127], v[100:103], v[172:175]
ds_read_b64_tr_b16 v[82:83], v13 offset:61440
v_mfma_f32_16x16x32_bf16 v[164:167], v[124:127], v[96:99], v[164:167]
ds_read_b64_tr_b16 v[84:85], v14 offset:57344
v_mfma_f32_16x16x32_bf16 v[128:131], v[208:211], v[192:195], v[128:131]
ds_read_b64_tr_b16 v[86:87], v14 offset:61440
v_mfma_f32_16x16x32_bf16 v[136:139], v[208:211], v[196:199], v[136:139]
ds_read_b64_tr_b16 v[88:89], v15 offset:57344
v_mfma_f32_16x16x32_bf16 v[144:147], v[208:211], v[200:203], v[144:147]
ds_read_b64_tr_b16 v[90:91], v15 offset:61440
v_mfma_f32_16x16x32_bf16 v[152:155], v[208:211], v[204:207], v[152:155]
ds_read_b64_tr_b16 v[92:93], v16 offset:57344
v_mfma_f32_16x16x32_bf16 v[156:159], v[212:215], v[204:207], v[156:159]
ds_read_b64_tr_b16 v[94:95], v16 offset:61440
v_mfma_f32_16x16x32_bf16 v[148:151], v[212:215], v[200:203], v[148:151]
ds_read_b128 v[68:71], v18 offset:41984
v_mfma_f32_16x16x32_bf16 v[140:143], v[212:215], v[196:199], v[140:143]
ds_read_b128 v[72:75], v18 offset:43008
v_mfma_f32_16x16x32_bf16 v[132:135], v[212:215], v[192:195], v[132:135]
ds_read_b128 v[76:79], v18 offset:44032
v_mfma_f32_16x16x32_bf16 v[160:163], v[216:219], v[192:195], v[160:163]
v_mfma_f32_16x16x32_bf16 v[168:171], v[216:219], v[196:199], v[168:171]
v_mfma_f32_16x16x32_bf16 v[176:179], v[216:219], v[200:203], v[176:179]
v_mfma_f32_16x16x32_bf16 v[184:187], v[216:219], v[204:207], v[184:187]
v_mfma_f32_16x16x32_bf16 v[188:191], v[220:223], v[204:207], v[188:191]
v_mfma_f32_16x16x32_bf16 v[180:183], v[220:223], v[200:203], v[180:183]
v_mfma_f32_16x16x32_bf16 v[172:175], v[220:223], v[196:199], v[172:175]
v_mfma_f32_16x16x32_bf16 v[164:167], v[220:223], v[192:195], v[164:167]
s_waitcnt lgkmcnt(0)
s_barrier
v_mfma_f32_16x16x32_bf16 v[128:131], v[48:51], v[32:35], v[128:131]
ds_read_b128 v[96:99], v19 offset:0
v_mfma_f32_16x16x32_bf16 v[136:139], v[48:51], v[36:39], v[136:139]
ds_read_b64_tr_b16 v[112:113], v9 offset:0
v_mfma_f32_16x16x32_bf16 v[144:147], v[48:51], v[40:43], v[144:147]
ds_read_b64_tr_b16 v[114:115], v9 offset:4096
v_mfma_f32_16x16x32_bf16 v[152:155], v[48:51], v[44:47], v[152:155]
ds_read_b64_tr_b16 v[116:117], v10 offset:0
v_mfma_f32_16x16x32_bf16 v[156:159], v[52:55], v[44:47], v[156:159]
ds_read_b64_tr_b16 v[118:119], v10 offset:4096
v_mfma_f32_16x16x32_bf16 v[148:151], v[52:55], v[40:43], v[148:151]
ds_read_b64_tr_b16 v[120:121], v11 offset:0
v_mfma_f32_16x16x32_bf16 v[140:143], v[52:55], v[36:39], v[140:143]
ds_read_b64_tr_b16 v[122:123], v11 offset:4096
v_mfma_f32_16x16x32_bf16 v[132:135], v[52:55], v[32:35], v[132:135]
ds_read_b64_tr_b16 v[124:125], v12 offset:0
v_mfma_f32_16x16x32_bf16 v[160:163], v[56:59], v[32:35], v[160:163]
ds_read_b64_tr_b16 v[126:127], v12 offset:4096
v_mfma_f32_16x16x32_bf16 v[168:171], v[56:59], v[36:39], v[168:171]
ds_read_b128 v[100:103], v19 offset:1024
v_mfma_f32_16x16x32_bf16 v[176:179], v[56:59], v[40:43], v[176:179]
ds_read_b128 v[104:107], v19 offset:2048
v_mfma_f32_16x16x32_bf16 v[184:187], v[56:59], v[44:47], v[184:187]
ds_read_b128 v[108:111], v19 offset:3072
v_mfma_f32_16x16x32_bf16 v[188:191], v[60:63], v[44:47], v[188:191]
ds_read_b128 v[192:195], v19 offset:8192
v_mfma_f32_16x16x32_bf16 v[180:183], v[60:63], v[40:43], v[180:183]
ds_read_b64_tr_b16 v[208:209], v9 offset:8192
v_mfma_f32_16x16x32_bf16 v[172:175], v[60:63], v[36:39], v[172:175]
ds_read_b64_tr_b16 v[210:211], v9 offset:12288
v_mfma_f32_16x16x32_bf16 v[164:167], v[60:63], v[32:35], v[164:167]
ds_read_b64_tr_b16 v[212:213], v10 offset:8192
v_mfma_f32_16x16x32_bf16 v[128:131], v[80:83], v[64:67], v[128:131]
ds_read_b64_tr_b16 v[214:215], v10 offset:12288
v_mfma_f32_16x16x32_bf16 v[136:139], v[80:83], v[68:71], v[136:139]
ds_read_b64_tr_b16 v[216:217], v11 offset:8192
v_mfma_f32_16x16x32_bf16 v[144:147], v[80:83], v[72:75], v[144:147]
ds_read_b64_tr_b16 v[218:219], v11 offset:12288
v_mfma_f32_16x16x32_bf16 v[152:155], v[80:83], v[76:79], v[152:155]
ds_read_b64_tr_b16 v[220:221], v12 offset:8192
v_mfma_f32_16x16x32_bf16 v[156:159], v[84:87], v[76:79], v[156:159]
ds_read_b64_tr_b16 v[222:223], v12 offset:12288
v_mfma_f32_16x16x32_bf16 v[148:151], v[84:87], v[72:75], v[148:151]
ds_read_b128 v[196:199], v19 offset:9216
v_mfma_f32_16x16x32_bf16 v[140:143], v[84:87], v[68:71], v[140:143]
ds_read_b128 v[200:203], v19 offset:10240
v_mfma_f32_16x16x32_bf16 v[132:135], v[84:87], v[64:67], v[132:135]
ds_read_b128 v[204:207], v19 offset:11264
v_mfma_f32_16x16x32_bf16 v[160:163], v[88:91], v[64:67], v[160:163]
v_mfma_f32_16x16x32_bf16 v[168:171], v[88:91], v[68:71], v[168:171]
v_mfma_f32_16x16x32_bf16 v[176:179], v[88:91], v[72:75], v[176:179]
v_mfma_f32_16x16x32_bf16 v[184:187], v[88:91], v[76:79], v[184:187]
v_mfma_f32_16x16x32_bf16 v[188:191], v[92:95], v[76:79], v[188:191]
v_mfma_f32_16x16x32_bf16 v[180:183], v[92:95], v[72:75], v[180:183]
v_mfma_f32_16x16x32_bf16 v[172:175], v[92:95], v[68:71], v[172:175]
v_mfma_f32_16x16x32_bf16 v[164:167], v[92:95], v[64:67], v[164:167]
s_sub_u32 s41, s41, 1
s_cmp_lg_u32 s41, 0
s_cbranch_scc1 Lk4_131
s_waitcnt lgkmcnt(0)
s_barrier
v_mfma_f32_16x16x32_bf16 v[128:131], v[112:115], v[96:99], v[128:131]
ds_read_b128 v[32:35], v17 offset:16384
v_mfma_f32_16x16x32_bf16 v[136:139], v[112:115], v[100:103], v[136:139]
ds_read_b64_tr_b16 v[48:49], v224 offset:32768
v_mfma_f32_16x16x32_bf16 v[144:147], v[112:115], v[104:107], v[144:147]
ds_read_b64_tr_b16 v[50:51], v224 offset:34816
v_mfma_f32_16x16x32_bf16 v[152:155], v[112:115], v[108:111], v[152:155]
ds_read_b64_tr_b16 v[52:53], v225 offset:32768
v_mfma_f32_16x16x32_bf16 v[156:159], v[116:119], v[108:111], v[156:159]
ds_read_b64_tr_b16 v[54:55], v225 offset:34816
v_mfma_f32_16x16x32_bf16 v[148:151], v[116:119], v[104:107], v[148:151]
ds_read_b128 v[36:39], v17 offset:17408
v_mfma_f32_16x16x32_bf16 v[140:143], v[116:119], v[100:103], v[140:143]
ds_read_b128 v[40:43], v17 offset:18432
v_mfma_f32_16x16x32_bf16 v[132:135], v[116:119], v[96:99], v[132:135]
ds_read_b128 v[44:47], v17 offset:19456
v_mfma_f32_16x16x32_bf16 v[160:163], v[120:123], v[96:99], v[160:163]
ds_read_b128 v[64:67], v17 offset:24576
v_mfma_f32_16x16x32_bf16 v[168:171], v[120:123], v[100:103], v[168:171]
ds_read_b64_tr_b16 v[80:81], v224 offset:36864
v_mfma_f32_16x16x32_bf16 v[176:179], v[120:123], v[104:107], v[176:179]
ds_read_b64_tr_b16 v[82:83], v224 offset:38912
v_mfma_f32_16x16x32_bf16 v[184:187], v[120:123], v[108:111], v[184:187]
ds_read_b64_tr_b16 v[84:85], v225 offset:36864
v_mfma_f32_16x16x32_bf16 v[188:191], v[124:127], v[108:111], v[188:191]
ds_read_b64_tr_b16 v[86:87], v225 offset:38912
v_mfma_f32_16x16x32_bf16 v[180:183], v[124:127], v[104:107], v[180:183]
ds_read_b128 v[68:71], v17 offset:25600
v_mfma_f32_16x16x32_bf16 v[172:175], v[124:127], v[100:103], v[172:175]
ds_read_b128 v[72:75], v17 offset:26624
v_mfma_f32_16x16x32_bf16 v[164:167], v[124:127], v[96:99], v[164:167]
ds_read_b128 v[76:79], v17 offset:27648
v_mfma_f32_16x16x32_bf16 v[128:131], v[208:211], v[192:195], v[128:131]
v_mfma_f32_16x16x32_bf16 v[136:139], v[208:211], v[196:199], v[136:139]
v_mfma_f32_16x16x32_bf16 v[144:147], v[208:211], v[200:203], v[144:147]
v_mfma_f32_16x16x32_bf16 v[152:155], v[208:211], v[204:207], v[152:155]
v_mfma_f32_16x16x32_bf16 v[156:159], v[212:215], v[204:207], v[156:159]
v_mfma_f32_16x16x32_bf16 v[148:151], v[212:215], v[200:203], v[148:151]
v_mfma_f32_16x16x32_bf16 v[140:143], v[212:215], v[196:199], v[140:143]
v_mfma_f32_16x16x32_bf16 v[132:135], v[212:215], v[192:195], v[132:135]
v_mfma_f32_16x16x32_bf16 v[160:163], v[216:219], v[192:195], v[160:163]
v_mfma_f32_16x16x32_bf16 v[168:171], v[216:219], v[196:199], v[168:171]
v_mfma_f32_16x16x32_bf16 v[176:179], v[216:219], v[200:203], v[176:179]
v_mfma_f32_16x16x32_bf16 v[184:187], v[216:219], v[204:207], v[184:187]
v_mfma_f32_16x16x32_bf16 v[188:191], v[220:223], v[204:207], v[188:191]
v_mfma_f32_16x16x32_bf16 v[180:183], v[220:223], v[200:203], v[180:183]
v_mfma_f32_16x16x32_bf16 v[172:175], v[220:223], v[196:199], v[172:175]
s_branch Lov_12
.p2align 12
.fill 96, 4, 0xbf800000
Lst_12_0:
s_branch Lwr_167
Lst_12_1:
s_branch Lst_16_0
s_nop 0
Lov_12:
v_mfma_f32_16x16x32_bf16 v[164:167], v[220:223], v[192:195], v[164:167]
s_waitcnt lgkmcnt(0)
s_barrier
v_mfma_f32_16x16x32_bf16 v[128:131], v[48:51], v[32:35], v[128:131]
ds_read_b128 v[96:99], v17 offset:49152
ds_read_b64_tr_b16 v[112:113], v226 offset:0
v_mfma_f32_16x16x32_bf16 v[136:139], v[48:51], v[36:39], v[136:139]
ds_read_b64_tr_b16 v[114:115], v226 offset:2048
ds_read_b64_tr_b16 v[116:117], v227 offset:0
v_mfma_f32_16x16x32_bf16 v[144:147], v[48:51], v[40:43], v[144:147]
ds_read_b64_tr_b16 v[118:119], v227 offset:2048
ds_read_b128 v[100:103], v17 offset:50176
v_mfma_f32_16x16x32_bf16 v[152:155], v[48:51], v[44:47], v[152:155]
ds_read_b128 v[104:107], v17 offset:51200
ds_read_b128 v[108:111], v17 offset:52224
v_mfma_f32_16x16x32_bf16 v[156:159], v[52:55], v[44:47], v[156:159]
ds_read_b128 v[192:195], v17 offset:57344
v_mfma_f32_16x16x32_bf16 v[148:151], v[52:55], v[40:43], v[148:151]
ds_read_b64_tr_b16 v[208:209], v226 offset:4096
v_mfma_f32_16x16x32_bf16 v[140:143], v[52:55], v[36:39], v[140:143]
ds_read_b64_tr_b16 v[210:211], v226 offset:6144
v_cvt_pk_bf16_f32 v160, v160, v161
v_cvt_pk_bf16_f32 v161, v162, v163
v_mfma_f32_16x16x32_bf16 v[132:135], v[52:55], v[32:35], v[132:135]
ds_read_b64_tr_b16 v[212:213], v227 offset:4096
v_cvt_pk_bf16_f32 v162, v164, v165
v_cvt_pk_bf16_f32 v163, v166, v167
v_mfma_f32_16x16x32_bf16 v[128:131], v[80:83], v[64:67], v[128:131]
ds_read_b64_tr_b16 v[214:215], v227 offset:6144
v_cvt_pk_bf16_f32 v164, v168, v169
v_cvt_pk_bf16_f32 v165, v170, v171
v_mfma_f32_16x16x32_bf16 v[136:139], v[80:83], v[68:71], v[136:139]
ds_read_b128 v[196:199], v17 offset:58368
v_cvt_pk_bf16_f32 v166, v172, v173
v_cvt_pk_bf16_f32 v167, v174, v175
v_mfma_f32_16x16x32_bf16 v[144:147], v[80:83], v[72:75], v[144:147]
ds_read_b128 v[200:203], v17 offset:59392
v_cvt_pk_bf16_f32 v168, v176, v177
v_cvt_pk_bf16_f32 v169, v178, v179
v_mfma_f32_16x16x32_bf16 v[152:155], v[80:83], v[76:79], v[152:155]
ds_read_b128 v[204:207], v17 offset:60416
v_cvt_pk_bf16_f32 v170, v180, v181
v_cvt_pk_bf16_f32 v171, v182, v183
v_mfma_f32_16x16x32_bf16 v[156:159], v[84:87], v[76:79], v[156:159]
v_cvt_pk_bf16_f32 v172, v184, v185
v_cvt_pk_bf16_f32 v173, v186, v187
v_mfma_f32_16x16x32_bf16 v[148:151], v[84:87], v[72:75], v[148:151]
v_cvt_pk_bf16_f32 v174, v188, v189
v_cvt_pk_bf16_f32 v175, v190, v191
v_mfma_f32_16x16x32_bf16 v[140:143], v[84:87], v[68:71], v[140:143]
v_mfma_f32_16x16x32_bf16 v[132:135], v[84:87], v[64:67], v[132:135]
buffer_store_dwordx4 v[160:163], v2, s[84:87], s45 offen offset:0 sc1
s_waitcnt lgkmcnt(0)
s_barrier
v_mfma_f32_16x16x32_bf16 v[128:131], v[112:115], v[96:99], v[128:131]
ds_read_b128 v[32:35], v18 offset:16384
ds_read_b64_tr_b16 v[48:49], v228 offset:16384
v_mfma_f32_16x16x32_bf16 v[136:139], v[112:115], v[100:103], v[136:139]
ds_read_b64_tr_b16 v[50:51], v228 offset:18432
ds_read_b64_tr_b16 v[52:53], v229 offset:16384
v_mfma_f32_16x16x32_bf16 v[144:147], v[112:115], v[104:107], v[144:147]
ds_read_b64_tr_b16 v[54:55], v229 offset:18432
ds_read_b128 v[36:39], v18 offset:17408
v_mfma_f32_16x16x32_bf16 v[152:155], v[112:115], v[108:111], v[152:155]
ds_read_b128 v[40:43], v18 offset:18432
ds_read_b128 v[44:47], v18 offset:19456
v_mfma_f32_16x16x32_bf16 v[156:159], v[116:119], v[108:111], v[156:159]
ds_read_b128 v[64:67], v18 offset:24576
v_mfma_f32_16x16x32_bf16 v[148:151], v[116:119], v[104:107], v[148:151]
ds_read_b64_tr_b16 v[80:81], v228 offset:20480
v_mfma_f32_16x16x32_bf16 v[140:143], v[116:119], v[100:103], v[140:143]
ds_read_b64_tr_b16 v[82:83], v228 offset:22528
v_mfma_f32_16x16x32_bf16 v[132:135], v[116:119], v[96:99], v[132:135]
ds_read_b64_tr_b16 v[84:85], v229 offset:20480
v_mfma_f32_16x16x32_bf16 v[128:131], v[208:211], v[192:195], v[128:131]
ds_read_b64_tr_b16 v[86:87], v229 offset:22528
buffer_store_dwordx4 v[164:167], v2, s[84:87], s45 offen offset:1024 sc1
v_mfma_f32_16x16x32_bf16 v[136:139], v[208:211], v[196:199], v[136:139]
ds_read_b128 v[68:71], v18 offset:25600
v_mfma_f32_16x16x32_bf16 v[144:147], v[208:211], v[200:203], v[144:147]
ds_read_b128 v[72:75], v18 offset:26624
v_mfma_f32_16x16x32_bf16 v[152:155], v[208:211], v[204:207], v[152:155]
ds_read_b128 v[76:79], v18 offset:27648
v_mfma_f32_16x16x32_bf16 v[156:159], v[212:215], v[204:207], v[156:159]
v_mfma_f32_16x16x32_bf16 v[148:151], v[212:215], v[200:203], v[148:151]
v_mfma_f32_16x16x32_bf16 v[140:143], v[212:215], v[196:199], v[140:143]
v_mfma_f32_16x16x32_bf16 v[132:135], v[212:215], v[192:195], v[132:135]
s_waitcnt lgkmcnt(0)
s_barrier
v_mfma_f32_16x16x32_bf16 v[128:131], v[48:51], v[32:35], v[128:131]
ds_read_b128 v[96:99], v18 offset:32768
ds_read_b64_tr_b16 v[112:113], v226 offset:49152
v_mfma_f32_16x16x32_bf16 v[136:139], v[48:51], v[36:39], v[136:139]
ds_read_b64_tr_b16 v[114:115], v226 offset:51200
ds_read_b64_tr_b16 v[116:117], v227 offset:49152
v_mfma_f32_16x16x32_bf16 v[144:147], v[48:51], v[40:43], v[144:147]
ds_read_b64_tr_b16 v[118:119], v227 offset:51200
ds_read_b128 v[100:103], v18 offset:33792
v_mfma_f32_16x16x32_bf16 v[152:155], v[48:51], v[44:47], v[152:155]
ds_read_b128 v[104:107], v18 offset:34816
ds_read_b128 v[108:111], v18 offset:35840
v_mfma_f32_16x16x32_bf16 v[156:159], v[52:55], v[44:47], v[156:159]
ds_read_b128 v[192:195], v18 offset:40960
v_mfma_f32_16x16x32_bf16 v[148:151], v[52:55], v[40:43], v[148:151]
ds_read_b64_tr_b16 v[208:209], v226 offset:53248
v_mfma_f32_16x16x32_bf16 v[140:143], v[52:55], v[36:39], v[140:143]
ds_read_b64_tr_b16 v[210:211], v226 offset:55296
v_mfma_f32_16x16x32_bf16 v[132:135], v[52:55], v[32:35], v[132:135]
ds_read_b64_tr_b16 v[212:213], v227 offset:53248
v_mfma_f32_16x16x32_bf16 v[128:131], v[80:83], v[64:67], v[128:131]
ds_read_b64_tr_b16 v[214:215], v227 offset:55296
buffer_store_dwordx4 v[168:171], v2, s[84:87], s45 offen offset:2048 sc1
v_mfma_f32_16x16x32_bf16 v[136:139], v[80:83], v[68:71], v[136:139]
ds_read_b128 v[196:199], v18 offset:41984
v_mfma_f32_16x16x32_bf16 v[144:147], v[80:83], v[72:75], v[144:147]
ds_read_b128 v[200:203], v18 offset:43008
v_mfma_f32_16x16x32_bf16 v[152:155], v[80:83], v[76:79], v[152:155]
ds_read_b128 v[204:207], v18 offset:44032
v_mfma_f32_16x16x32_bf16 v[156:159], v[84:87], v[76:79], v[156:159]
v_mfma_f32_16x16x32_bf16 v[148:151], v[84:87], v[72:75], v[148:151]
v_mfma_f32_16x16x32_bf16 v[140:143], v[84:87], v[68:71], v[140:143]
v_mfma_f32_16x16x32_bf16 v[132:135], v[84:87], v[64:67], v[132:135]
s_waitcnt lgkmcnt(0)
s_barrier
v_mfma_f32_16x16x32_bf16 v[128:131], v[112:115], v[96:99], v[128:131]
ds_read_b128 v[32:35], v19 offset:0
ds_read_b64_tr_b16 v[48:49], v224 offset:0
v_mfma_f32_16x16x32_bf16 v[136:139], v[112:115], v[100:103], v[136:139]
ds_read_b64_tr_b16 v[50:51], v224 offset:2048
ds_read_b64_tr_b16 v[52:53], v225 offset:0
v_mfma_f32_16x16x32_bf16 v[144:147], v[112:115], v[104:107], v[144:147]
ds_read_b64_tr_b16 v[54:55], v225 offset:2048
ds_read_b128 v[36:39], v19 offset:1024
v_mfma_f32_16x16x32_bf16 v[152:155], v[112:115], v[108:111], v[152:155]
ds_read_b128 v[40:43], v19 offset:2048
ds_read_b128 v[44:47], v19 offset:3072
v_mfma_f32_16x16x32_bf16 v[156:159], v[116:119], v[108:111], v[156:159]
ds_read_b128 v[64:67], v19 offset:8192
v_mfma_f32_16x16x32_bf16 v[148:151], v[116:119], v[104:107], v[148:151]
ds_read_b64_tr_b16 v[80:81], v224 offset:4096
v_mfma_f32_16x16x32_bf16 v[140:143], v[116:119], v[100:103], v[140:143]
ds_read_b64_tr_b16 v[82:83], v224 offset:6144
v_mfma_f32_16x16x32_bf16 v[132:135], v[116:119], v[96:99], v[132:135]
ds_read_b64_tr_b16 v[84:85], v225 offset:4096
v_mfma_f32_16x16x32_bf16 v[128:131], v[208:211], v[192:195], v[128:131]
ds_read_b64_tr_b16 v[86:87], v225 offset:6144
buffer_store_dwordx4 v[172:175], v2, s[84:87], s45 offen offset:3072 sc1
v_mfma_f32_16x16x32_bf16 v[136:139], v[208:211], v[196:199], v[136:139]
ds_read_b128 v[68:71], v19 offset:9216
v_mfma_f32_16x16x32_bf16 v[144:147], v[208:211], v[200:203], v[144:147]
ds_read_b128 v[72:75], v19 offset:10240
v_mfma_f32_16x16x32_bf16 v[152:155], v[208:211], v[204:207], v[152:155]
ds_read_b128 v[76:79], v19 offset:11264
v_mfma_f32_16x16x32_bf16 v[156:159], v[212:215], v[204:207], v[156:159]
v_mfma_f32_16x16x32_bf16 v[148:151], v[212:215], v[200:203], v[148:151]
v_mfma_f32_16x16x32_bf16 v[140:143], v[212:215], v[196:199], v[140:143]
v_mfma_f32_16x16x32_bf16 v[132:135], v[212:215], v[192:195], v[132:135]
s_waitcnt lgkmcnt(0)
s_barrier
v_mfma_f32_16x16x32_bf16 v[128:131], v[48:51], v[32:35], v[128:131]
ds_read_b128 v[96:99], v17 offset:16384
ds_read_b64_tr_b16 v[112:113], v224 offset:32768
v_mfma_f32_16x16x32_bf16 v[136:139], v[48:51], v[36:39], v[136:139]
ds_read_b64_tr_b16 v[114:115], v224 offset:34816
ds_read_b64_tr_b16 v[116:117], v225 offset:32768
v_mfma_f32_16x16x32_bf16 v[144:147], v[48:51], v[40:43], v[144:147]
ds_read_b64_tr_b16 v[118:119], v225 offset:34816
ds_read_b128 v[100:103], v17 offset:17408
v_mfma_f32_16x16x32_bf16 v[152:155], v[48:51], v[44:47], v[152:155]
ds_read_b128 v[104:107], v17 offset:18432
ds_read_b128 v[108:111], v17 offset:19456
v_mfma_f32_16x16x32_bf16 v[156:159], v[52:55], v[44:47], v[156:159]
ds_read_b128 v[192:195], v17 offset:24576
v_mfma_f32_16x16x32_bf16 v[148:151], v[52:55], v[40:43], v[148:151]
ds_read_b64_tr_b16 v[208:209], v224 offset:36864
v_mfma_f32_16x16x32_bf16 v[140:143], v[52:55], v[36:39], v[140:143]
ds_read_b64_tr_b16 v[210:211], v224 offset:38912
v_mfma_f32_16x16x32_bf16 v[132:135], v[52:55], v[32:35], v[132:135]
ds_read_b64_tr_b16 v[212:213], v225 offset:36864
v_mfma_f32_16x16x32_bf16 v[128:131], v[80:83], v[64:67], v[128:131]
ds_read_b64_tr_b16 v[214:215], v225 offset:38912
v_mfma_f32_16x16x32_bf16 v[136:139], v[80:83], v[68:71], v[136:139]
ds_read_b128 v[196:199], v17 offset:25600
v_mfma_f32_16x16x32_bf16 v[144:147], v[80:83], v[72:75], v[144:147]
ds_read_b128 v[200:203], v17 offset:26624
v_mfma_f32_16x16x32_bf16 v[152:155], v[80:83], v[76:79], v[152:155]
ds_read_b128 v[204:207], v17 offset:27648
v_mfma_f32_16x16x32_bf16 v[156:159], v[84:87], v[76:79], v[156:159]
v_mfma_f32_16x16x32_bf16 v[148:151], v[84:87], v[72:75], v[148:151]
v_mfma_f32_16x16x32_bf16 v[140:143], v[84:87], v[68:71], v[140:143]
v_mfma_f32_16x16x32_bf16 v[132:135], v[84:87], v[64:67], v[132:135]
s_waitcnt vmcnt(0)
s_waitcnt lgkmcnt(0)
s_barrier
v_mfma_f32_16x16x32_bf16 v[128:131], v[112:115], v[96:99], v[128:131]
ds_read_b128 v[32:35], v17 offset:49152
ds_read_b64_tr_b16 v[48:49], v226 offset:0
v_mfma_f32_16x16x32_bf16 v[136:139], v[112:115], v[100:103], v[136:139]
ds_read_b64_tr_b16 v[50:51], v226 offset:2048
ds_read_b64_tr_b16 v[52:53], v227 offset:0
v_mfma_f32_16x16x32_bf16 v[144:147], v[112:115], v[104:107], v[144:147]
ds_read_b64_tr_b16 v[54:55], v227 offset:2048
ds_read_b128 v[36:39], v17 offset:50176
v_mfma_f32_16x16x32_bf16 v[152:155], v[112:115], v[108:111], v[152:155]
ds_read_b128 v[40:43], v17 offset:51200
ds_read_b128 v[44:47], v17 offset:52224
v_mfma_f32_16x16x32_bf16 v[156:159], v[116:119], v[108:111], v[156:159]
ds_read_b128 v[64:67], v17 offset:57344
v_mfma_f32_16x16x32_bf16 v[148:151], v[116:119], v[104:107], v[148:151]
ds_read_b64_tr_b16 v[80:81], v226 offset:4096
v_mfma_f32_16x16x32_bf16 v[140:143], v[116:119], v[100:103], v[140:143]
ds_read_b64_tr_b16 v[82:83], v226 offset:6144
v_mfma_f32_16x16x32_bf16 v[132:135], v[116:119], v[96:99], v[132:135]
ds_read_b64_tr_b16 v[84:85], v227 offset:4096
v_mfma_f32_16x16x32_bf16 v[128:131], v[208:211], v[192:195], v[128:131]
ds_read_b64_tr_b16 v[86:87], v227 offset:6144
v_mfma_f32_16x16x32_bf16 v[136:139], v[208:211], v[196:199], v[136:139]
ds_read_b128 v[68:71], v17 offset:58368
v_mfma_f32_16x16x32_bf16 v[144:147], v[208:211], v[200:203], v[144:147]
ds_read_b128 v[72:75], v17 offset:59392
v_mfma_f32_16x16x32_bf16 v[152:155], v[208:211], v[204:207], v[152:155]
ds_read_b128 v[76:79], v17 offset:60416
v_mfma_f32_16x16x32_bf16 v[156:159], v[212:215], v[204:207], v[156:159]
v_mfma_f32_16x16x32_bf16 v[148:151], v[212:215], v[200:203], v[148:151]
v_mfma_f32_16x16x32_bf16 v[140:143], v[212:215], v[196:199], v[140:143]
v_mfma_f32_16x16x32_bf16 v[132:135], v[212:215], v[192:195], v[132:135]
s_waitcnt lgkmcnt(0)
s_barrier
v_mfma_f32_16x16x32_bf16 v[128:131], v[48:51], v[32:35], v[128:131]
ds_read_b128 v[96:99], v18 offset:16384
ds_read_b64_tr_b16 v[112:113], v228 offset:16384
v_mfma_f32_16x16x32_bf16 v[136:139], v[48:51], v[36:39], v[136:139]
ds_read_b64_tr_b16 v[114:115], v228 offset:18432
ds_read_b64_tr_b16 v[116:117], v229 offset:16384
v_mfma_f32_16x16x32_bf16 v[144:147], v[48:51], v[40:43], v[144:147]
ds_read_b64_tr_b16 v[118:119], v229 offset:18432
ds_read_b128 v[100:103], v18 offset:17408
v_mfma_f32_16x16x32_bf16 v[152:155], v[48:51], v[44:47], v[152:155]
ds_read_b128 v[104:107], v18 offset:18432
ds_read_b128 v[108:111], v18 offset:19456
v_mfma_f32_16x16x32_bf16 v[156:159], v[52:55], v[44:47], v[156:159]
ds_read_b128 v[192:195], v18 offset:24576
v_mfma_f32_16x16x32_bf16 v[148:151], v[52:55], v[40:43], v[148:151]
ds_read_b64_tr_b16 v[208:209], v228 offset:20480
v_mfma_f32_16x16x32_bf16 v[140:143], v[52:55], v[36:39], v[140:143]
ds_read_b64_tr_b16 v[210:211], v228 offset:22528
v_mfma_f32_16x16x32_bf16 v[132:135], v[52:55], v[32:35], v[132:135]
ds_read_b64_tr_b16 v[212:213], v229 offset:20480
v_mfma_f32_16x16x32_bf16 v[128:131], v[80:83], v[64:67], v[128:131]
ds_read_b64_tr_b16 v[214:215], v229 offset:22528
v_mfma_f32_16x16x32_bf16 v[136:139], v[80:83], v[68:71], v[136:139]
ds_read_b128 v[196:199], v18 offset:25600
v_mfma_f32_16x16x32_bf16 v[144:147], v[80:83], v[72:75], v[144:147]
ds_read_b128 v[200:203], v18 offset:26624
v_mfma_f32_16x16x32_bf16 v[152:155], v[80:83], v[76:79], v[152:155]
ds_read_b128 v[204:207], v18 offset:27648
v_mfma_f32_16x16x32_bf16 v[156:159], v[84:87], v[76:79], v[156:159]
v_mfma_f32_16x16x32_bf16 v[148:151], v[84:87], v[72:75], v[148:151]
v_mfma_f32_16x16x32_bf16 v[140:143], v[84:87], v[68:71], v[140:143]
v_mfma_f32_16x16x32_bf16 v[132:135], v[84:87], v[64:67], v[132:135]
s_waitcnt lgkmcnt(0)
s_barrier
v_mfma_f32_16x16x32_bf16 v[128:131], v[112:115], v[96:99], v[128:131]
ds_read_b128 v[32:35], v18 offset:32768
ds_read_b64_tr_b16 v[48:49], v226 offset:49152
v_mfma_f32_16x16x32_bf16 v[136:139], v[112:115], v[100:103], v[136:139]
ds_read_b64_tr_b16 v[50:51], v226 offset:51200
ds_read_b64_tr_b16 v[52:53], v227 offset:49152
v_mfma_f32_16x16x32_bf16 v[144:147], v[112:115], v[104:107], v[144:147]
ds_read_b64_tr_b16 v[54:55], v227 offset:51200
ds_read_b128 v[36:39], v18 offset:33792
v_mfma_f32_16x16x32_bf16 v[152:155], v[112:115], v[108:111], v[152:155]
ds_read_b128 v[40:43], v18 offset:34816
ds_read_b128 v[44:47], v18 offset:35840
v_mfma_f32_16x16x32_bf16 v[156:159], v[116:119], v[108:111], v[156:159]
ds_read_b128 v[64:67], v18 offset:40960
v_mfma_f32_16x16x32_bf16 v[148:151], v[116:119], v[104:107], v[148:151]
ds_read_b64_tr_b16 v[80:81], v226 offset:53248
v_mfma_f32_16x16x32_bf16 v[140:143], v[116:119], v[100:103], v[140:143]
ds_read_b64_tr_b16 v[82:83], v226 offset:55296
v_mfma_f32_16x16x32_bf16 v[132:135], v[116:119], v[96:99], v[132:135]
ds_read_b64_tr_b16 v[84:85], v227 offset:53248
v_mfma_f32_16x16x32_bf16 v[128:131], v[208:211], v[192:195], v[128:131]
ds_read_b64_tr_b16 v[86:87], v227 offset:55296
v_mfma_f32_16x16x32_bf16 v[136:139], v[208:211], v[196:199], v[136:139]
ds_read_b128 v[68:71], v18 offset:41984
v_mfma_f32_16x16x32_bf16 v[144:147], v[208:211], v[200:203], v[144:147]
ds_read_b128 v[72:75], v18 offset:43008
v_mfma_f32_16x16x32_bf16 v[152:155], v[208:211], v[204:207], v[152:155]
ds_read_b128 v[76:79], v18 offset:44032
v_mfma_f32_16x16x32_bf16 v[156:159], v[212:215], v[204:207], v[156:159]
v_mfma_f32_16x16x32_bf16 v[148:151], v[212:215], v[200:203], v[148:151]
v_mfma_f32_16x16x32_bf16 v[140:143], v[212:215], v[196:199], v[140:143]
v_mfma_f32_16x16x32_bf16 v[132:135], v[212:215], v[192:195], v[132:135]
s_waitcnt lgkmcnt(0)
s_barrier
buffer_load_dwordx4 v[232:235], v2, s[84:87], s46 offen offset:0 sc1
buffer_load_dwordx4 v[236:239], v2, s[84:87], s46 offen offset:1024 sc1
buffer_load_dwordx4 v[240:243], v2, s[84:87], s46 offen offset:2048 sc1
buffer_load_dwordx4 v[244:247], v2, s[84:87], s46 offen offset:3072 sc1
v_mfma_f32_16x16x32_bf16 v[128:131], v[48:51], v[32:35], v[128:131]
ds_read_b128 v[96:99], v19 offset:0
ds_read_b64_tr_b16 v[112:113], v224 offset:0
v_mfma_f32_16x16x32_bf16 v[136:139], v[48:51], v[36:39], v[136:139]
ds_read_b64_tr_b16 v[114:115], v224 offset:2048
ds_read_b64_tr_b16 v[116:117], v225 offset:0
v_mfma_f32_16x16x32_bf16 v[144:147], v[48:51], v[40:43], v[144:147]
ds_read_b64_tr_b16 v[118:119], v225 offset:2048
ds_read_b128 v[100:103], v19 offset:1024
v_mfma_f32_16x16x32_bf16 v[152:155], v[48:51], v[44:47], v[152:155]
ds_read_b128 v[104:107], v19 offset:2048
ds_read_b128 v[108:111], v19 offset:3072
v_mfma_f32_16x16x32_bf16 v[156:159], v[52:55], v[44:47], v[156:159]
ds_read_b128 v[192:195], v19 offset:8192
v_mfma_f32_16x16x32_bf16 v[148:151], v[52:55], v[40:43], v[148:151]
ds_read_b64_tr_b16 v[208:209], v224 offset:4096
v_mfma_f32_16x16x32_bf16 v[140:143], v[52:55], v[36:39], v[140:143]
ds_read_b64_tr_b16 v[210:211], v224 offset:6144
v_mfma_f32_16x16x32_bf16 v[132:135], v[52:55], v[32:35], v[132:135]
ds_read_b64_tr_b16 v[212:213], v225 offset:4096
v_mfma_f32_16x16x32_bf16 v[128:131], v[80:83], v[64:67], v[128:131]
ds_read_b64_tr_b16 v[214:215], v225 offset:6144
v_mfma_f32_16x16x32_bf16 v[136:139], v[80:83], v[68:71], v[136:139]
ds_read_b128 v[196:199], v19 offset:9216
v_mfma_f32_16x16x32_bf16 v[144:147], v[80:83], v[72:75], v[144:147]
ds_read_b128 v[200:203], v19 offset:10240
v_mfma_f32_16x16x32_bf16 v[152:155], v[80:83], v[76:79], v[152:155]
ds_read_b128 v[204:207], v19 offset:11264
v_mfma_f32_16x16x32_bf16 v[156:159], v[84:87], v[76:79], v[156:159]
v_mfma_f32_16x16x32_bf16 v[148:151], v[84:87], v[72:75], v[148:151]
v_mfma_f32_16x16x32_bf16 v[140:143], v[84:87], v[68:71], v[140:143]
v_mfma_f32_16x16x32_bf16 v[132:135], v[84:87], v[64:67], v[132:135]
s_waitcnt lgkmcnt(0)
s_barrier
v_mfma_f32_16x16x32_bf16 v[128:131], v[112:115], v[96:99], v[128:131]
ds_read_b128 v[32:35], v17 offset:16384
ds_read_b64_tr_b16 v[48:49], v224 offset:32768
v_mfma_f32_16x16x32_bf16 v[136:139], v[112:115], v[100:103], v[136:139]
ds_read_b64_tr_b16 v[50:51], v224 offset:34816
ds_read_b64_tr_b16 v[52:53], v225 offset:32768
v_mfma_f32_16x16x32_bf16 v[144:147], v[112:115], v[104:107], v[144:147]
ds_read_b64_tr_b16 v[54:55], v225 offset:34816
ds_read_b128 v[36:39], v17 offset:17408
v_mfma_f32_16x16x32_bf16 v[152:155], v[112:115], v[108:111], v[152:155]
ds_read_b128 v[40:43], v17 offset:18432
ds_read_b128 v[44:47], v17 offset:19456
v_mfma_f32_16x16x32_bf16 v[156:159], v[116:119], v[108:111], v[156:159]
ds_read_b128 v[64:67], v17 offset:24576
v_mfma_f32_16x16x32_bf16 v[148:151], v[116:119], v[104:107], v[148:151]
ds_read_b64_tr_b16 v[80:81], v224 offset:36864
v_mfma_f32_16x16x32_bf16 v[140:143], v[116:119], v[100:103], v[140:143]
ds_read_b64_tr_b16 v[82:83], v224 offset:38912
v_mfma_f32_16x16x32_bf16 v[132:135], v[116:119], v[96:99], v[132:135]
ds_read_b64_tr_b16 v[84:85], v225 offset:36864
v_mfma_f32_16x16x32_bf16 v[128:131], v[208:211], v[192:195], v[128:131]
ds_read_b64_tr_b16 v[86:87], v225 offset:38912
v_mfma_f32_16x16x32_bf16 v[136:139], v[208:211], v[196:199], v[136:139]
ds_read_b128 v[68:71], v17 offset:25600
v_mfma_f32_16x16x32_bf16 v[144:147], v[208:211], v[200:203], v[144:147]
ds_read_b128 v[72:75], v17 offset:26624
v_mfma_f32_16x16x32_bf16 v[152:155], v[208:211], v[204:207], v[152:155]
ds_read_b128 v[76:79], v17 offset:27648
v_mfma_f32_16x16x32_bf16 v[156:159], v[212:215], v[204:207], v[156:159]
v_mfma_f32_16x16x32_bf16 v[148:151], v[212:215], v[200:203], v[148:151]
v_mfma_f32_16x16x32_bf16 v[140:143], v[212:215], v[196:199], v[140:143]
v_mfma_f32_16x16x32_bf16 v[132:135], v[212:215], v[192:195], v[132:135]
s_waitcnt lgkmcnt(0)
s_barrier
v_mfma_f32_16x16x32_bf16 v[128:131], v[48:51], v[32:35], v[128:131]
ds_read_b128 v[96:99], v17 offset:49152
ds_read_b64_tr_b16 v[112:113], v226 offset:0
v_mfma_f32_16x16x32_bf16 v[136:139], v[48:51], v[36:39], v[136:139]
ds_read_b64_tr_b16 v[114:115], v226 offset:2048
ds_read_b64_tr_b16 v[116:117], v227 offset:0
v_mfma_f32_16x16x32_bf16 v[144:147], v[48:51], v[40:43], v[144:147]
ds_read_b64_tr_b16 v[118:119], v227 offset:2048
ds_read_b128 v[100:103], v17 offset:50176
v_mfma_f32_16x16x32_bf16 v[152:155], v[48:51], v[44:47], v[152:155]
ds_read_b128 v[104:107], v17 offset:51200
ds_read_b128 v[108:111], v17 offset:52224
v_mfma_f32_16x16x32_bf16 v[156:159], v[52:55], v[44:47], v[156:159]
ds_read_b128 v[192:195], v17 offset:57344
v_mfma_f32_16x16x32_bf16 v[148:151], v[52:55], v[40:43], v[148:151]
ds_read_b64_tr_b16 v[208:209], v226 offset:4096
v_mfma_f32_16x16x32_bf16 v[140:143], v[52:55], v[36:39], v[140:143]
ds_read_b64_tr_b16 v[210:211], v226 offset:6144
v_mfma_f32_16x16x32_bf16 v[132:135], v[52:55], v[32:35], v[132:135]
ds_read_b64_tr_b16 v[212:213], v227 offset:4096
v_mfma_f32_16x16x32_bf16 v[128:131], v[80:83], v[64:67], v[128:131]
ds_read_b64_tr_b16 v[214:215], v227 offset:6144
v_mfma_f32_16x16x32_bf16 v[136:139], v[80:83], v[68:71], v[136:139]
ds_read_b128 v[196:199], v17 offset:58368
v_mfma_f32_16x16x32_bf16 v[144:147], v[80:83], v[72:75], v[144:147]
ds_read_b128 v[200:203], v17 offset:59392
v_mfma_f32_16x16x32_bf16 v[152:155], v[80:83], v[76:79], v[152:155]
ds_read_b128 v[204:207], v17 offset:60416
v_mfma_f32_16x16x32_bf16 v[156:159], v[84:87], v[76:79], v[156:159]
v_mfma_f32_16x16x32_bf16 v[148:151], v[84:87], v[72:75], v[148:151]
v_mfma_f32_16x16x32_bf16 v[140:143], v[84:87], v[68:71], v[140:143]
v_mfma_f32_16x16x32_bf16 v[132:135], v[84:87], v[64:67], v[132:135]
s_waitcnt vmcnt(0)
s_waitcnt lgkmcnt(0)
s_barrier
v_mfma_f32_16x16x32_bf16 v[128:131], v[112:115], v[96:99], v[128:131]
v_lshlrev_b32 v160, 16, v232
v_and_b32 v161, 0xffff0000, v232
v_lshlrev_b32 v162, 16, v233
v_and_b32 v163, 0xffff0000, v233
v_mfma_f32_16x16x32_bf16 v[132:135], v[116:119], v[96:99], v[132:135]
v_lshlrev_b32 v164, 16, v234
v_and_b32 v165, 0xffff0000, v234
v_lshlrev_b32 v166, 16, v235
v_and_b32 v167, 0xffff0000, v235
v_mfma_f32_16x16x32_bf16 v[128:131], v[208:211], v[192:195], v[128:131]
v_lshlrev_b32 v168, 16, v236
v_and_b32 v169, 0xffff0000, v236
v_lshlrev_b32 v170, 16, v237
v_and_b32 v171, 0xffff0000, v237
v_mfma_f32_16x16x32_bf16 v[132:135], v[212:215], v[192:195], v[132:135]
v_lshlrev_b32 v172, 16, v238
v_and_b32 v173, 0xffff0000, v238
v_lshlrev_b32 v174, 16, v239
v_and_b32 v175, 0xffff0000, v239
v_mfma_f32_16x16x32_bf16 v[136:139], v[112:115], v[100:103], v[136:139]
v_lshlrev_b32 v176, 16, v240
v_and_b32 v177, 0xffff0000, v240
v_lshlrev_b32 v178, 16, v241
v_and_b32 v179, 0xffff0000, v241
v_mfma_f32_16x16x32_bf16 v[140:143], v[116:119], v[100:103], v[140:143]
v_lshlrev_b32 v180, 16, v242
v_and_b32 v181, 0xffff0000, v242
v_lshlrev_b32 v182, 16, v243
v_and_b32 v183, 0xffff0000, v243
v_mfma_f32_16x16x32_bf16 v[136:139], v[208:211], v[196:199], v[136:139]
v_lshlrev_b32 v184, 16, v244
v_and_b32 v185, 0xffff0000, v244
v_lshlrev_b32 v186, 16, v245
v_and_b32 v187, 0xffff0000, v245
v_mfma_f32_16x16x32_bf16 v[140:143], v[212:215], v[196:199], v[140:143]
v_lshlrev_b32 v188, 16, v246
v_and_b32 v189, 0xffff0000, v246
v_lshlrev_b32 v190, 16, v247
v_and_b32 v191, 0xffff0000, v247
v_mfma_f32_16x16x32_bf16 v[144:147], v[112:115], v[104:107], v[144:147]
v_add_f32 v128, v128, v160
v_add_f32 v129, v129, v161
v_add_f32 v130, v130, v162
v_mfma_f32_16x16x32_bf16 v[148:151], v[116:119], v[104:107], v[148:151]
v_add_f32 v131, v131, v163
v_add_f32 v132, v132, v164
v_add_f32 v133, v133, v165
v_mfma_f32_16x16x32_bf16 v[144:147], v[208:211], v[200:203], v[144:147]
v_add_f32 v134, v134, v166
v_add_f32 v135, v135, v167
v_cvt_pk_bf16_f32 v232, v128, v129
v_mfma_f32_16x16x32_bf16 v[148:151], v[212:215], v[200:203], v[148:151]
v_cvt_pk_bf16_f32 v233, v130, v131
v_cvt_pk_bf16_f32 v234, v132, v133
v_cvt_pk_bf16_f32 v235, v134, v135
v_mfma_f32_16x16x32_bf16 v[152:155], v[112:115], v[108:111], v[152:155]
v_add_f32 v136, v136, v168
v_add_f32 v137, v137, v169
v_add_f32 v138, v138, v170
v_mfma_f32_16x16x32_bf16 v[156:159], v[116:119], v[108:111], v[156:159]
v_add_f32 v139, v139, v171
v_add_f32 v140, v140, v172
v_add_f32 v141, v141, v173
v_add_f32 v142, v142, v174
v_mfma_f32_16x16x32_bf16 v[152:155], v[208:211], v[204:207], v[152:155]
v_add_f32 v143, v143, v175
v_cvt_pk_bf16_f32 v236, v136, v137
v_cvt_pk_bf16_f32 v237, v138, v139
v_cvt_pk_bf16_f32 v238, v140, v141
v_mfma_f32_16x16x32_bf16 v[156:159], v[212:215], v[204:207], v[156:159]
v_cvt_pk_bf16_f32 v239, v142, v143
v_permlane16_swap_b32 v232, v234
v_permlane16_swap_b32 v233, v235
buffer_store_dwordx4 v[232:235], v230, s[20:23], s54 offen offset:0 nt
v_permlane16_swap_b32 v236, v238
v_permlane16_swap_b32 v237, v239
buffer_store_dwordx4 v[236:239], v230, s[20:23], s54 offen offset:2048 nt
v_add_f32 v144, v144, v176
v_add_f32 v145, v145, v177
v_add_f32 v146, v146, v178
v_add_f32 v147, v147, v179
v_add_f32 v148, v148, v180
v_add_f32 v149, v149, v181
v_add_f32 v150, v150, v182
v_add_f32 v151, v151, v183
v_cvt_pk_bf16_f32 v240, v144, v145
v_cvt_pk_bf16_f32 v241, v146, v147
v_cvt_pk_bf16_f32 v242, v148, v149
v_cvt_pk_bf16_f32 v243, v150, v151
s_nop 0
v_add_f32 v152, v152, v184
v_add_f32 v153, v153, v185
v_add_f32 v154, v154, v186
v_add_f32 v155, v155, v187
v_add_f32 v156, v156, v188
v_add_f32 v157, v157, v189
v_add_f32 v158, v158, v190
s_branch Lov_13
.p2align 12
.fill 96, 4, 0xbf800000
Lst_13_0:
s_branch Lwr_168
Lst_13_1:
s_branch Lst_17_0
s_nop 0
Lov_13:
v_add_f32 v159, v159, v191
v_cvt_pk_bf16_f32 v244, v152, v153
v_cvt_pk_bf16_f32 v245, v154, v155
v_cvt_pk_bf16_f32 v246, v156, v157
v_cvt_pk_bf16_f32 v247, v158, v159
v_permlane16_swap_b32 v240, v242
v_permlane16_swap_b32 v241, v243
buffer_store_dwordx4 v[240:243], v230, s[20:23], s55 offen offset:0 nt
v_permlane16_swap_b32 v244, v246
v_permlane16_swap_b32 v245, v247
buffer_store_dwordx4 v[244:247], v230, s[20:23], s55 offen offset:2048 nt
s_branch Ldone_1
Lgb_107:
s_mul_i32 s43, s34, 262144
s_add_u32 s8, s82, s43
s_addc_u32 s9, s83, 0
s_add_u32 s8, s8, 4194304
s_addc_u32 s9, s9, 0
s_mov_b32 s10, 262144
s_mov_b32 s11, 0x20000
s_lshl_b32 s39, s36, 12
v_lshlrev_b32 v2, 4, v1
v_add_u32 v3, s39, v2
s_add_u32 s37, s35, 0
s_and_b32 s37, s37, 15
s_mul_i32 s37, s37, 16384
s_add_u32 m0, s39, 0
s_nop 0
buffer_load_dwordx4 v3, s[8:11], s37 offen sc1 lds
buffer_load_dwordx4 v3, s[8:11], s37 offen offset:1024 sc1 lds
buffer_load_dwordx4 v3, s[8:11], s37 offen offset:2048 sc1 lds
buffer_load_dwordx4 v3, s[8:11], s37 offen offset:3072 sc1 lds
s_mul_i32 s43, s34, 262144
s_add_u32 s8, s82, s43
s_addc_u32 s9, s83, 0
s_add_u32 s8, s8, 4194304
s_addc_u32 s9, s9, 0
s_mov_b32 s10, 262144
s_mov_b32 s11, 0x20000
s_mul_i32 s43, s34, 917504
s_add_u32 s24, s82, s43
s_addc_u32 s25, s83, 0
s_add_u32 s24, s24, 8388608
s_addc_u32 s25, s25, 0
s_mov_b32 s26, 917504
s_mov_b32 s27, 0x20000
s_add_u32 s84, s82, 27262976
s_addc_u32 s85, s83, 0
s_mov_b32 s86, 229376
s_mov_b32 s87, 0x20000
s_and_b32 s47, s36, 3
s_lshr_b32 s62, s47, 1
s_and_b32 s63, s47, 1
v_lshlrev_b32 v2, 4, v1
s_lshl_b32 s39, s47, 12
v_add_u32 v3, s39, v2
s_bitcmp0_b32 s36, 1
s_cselect_b32 s44, s72, s74
s_cselect_b32 s45, s73, s75
s_mul_i32 s43, s35, 256
s_add_u32 s12, s44, s43
s_addc_u32 s13, s45, 0
s_mov_b32 s14, 7333120
s_mov_b32 s15, 0x20000
s_and_b32 s43, s36, 1
s_mul_i32 s43, s43, 229376
v_lshrrev_b32 v28, 4, v1
v_lshlrev_b32 v29, 1, v28
v_and_b32 v4, 15, v1
v_xor_b32 v4, v4, v29
v_lshlrev_b32 v4, 4, v4
v_mul_u32_u24 v28, 7168, v28
v_add_u32 v4, v4, v28
v_add_u32 v4, s43, v4
v_xor_b32 v5, 128, v4
v_add_u32 v5, 28672, v5
s_and_b32 s43, s36, 3
s_mul_i32 s40, s43, 8192
s_add_u32 s40, s40, 16384
v_mov_b32 v6, v192
v_mov_b32 v7, v193
v_mov_b32 v8, v194
s_lshl_b32 s43, s62, 12
v_add_u32 v9, s43, v2
v_add_u32 v10, 98304, v9
v_mov_b32 v24, v195
s_mul_i32 s43, s34, 16384
s_add_u32 s20, s82, s43
s_addc_u32 s21, s83, 0
s_add_u32 s20, s20, 25165824
s_addc_u32 s21, s21, 0
s_mov_b32 s22, 16384
s_mov_b32 s23, 0x20000
s_add_u32 s38, s35, 2
s_and_b32 s38, s38, 15
s_mul_i32 s38, s38, 458752
s_add_u32 m0, s50, 98304
s_nop 0
buffer_load_dwordx4 v6, s[16:19], s38 offen lds
s_add_u32 m0, s50, 99328
s_nop 0
buffer_load_dwordx4 v7, s[16:19], s38 offen lds
s_add_u32 m0, s50, 100352
s_nop 0
buffer_load_dwordx4 v8, s[16:19], s38 offen lds
s_add_u32 m0, s50, 101376
s_add_u32 s38, s38, 114688
buffer_load_dwordx4 v6, s[16:19], s38 offen lds
s_add_u32 m0, s50, 102400
s_nop 0
buffer_load_dwordx4 v7, s[16:19], s38 offen lds
s_add_u32 m0, s50, 103424
s_nop 0
buffer_load_dwordx4 v8, s[16:19], s38 offen lds
s_cmp_eq_u32 s47, 1
s_cbranch_scc0 Lw_132
s_lshl_b32 s92, s34, 4
s_add_u32 s92, s92, s35
s_lshl_b32 s92, s92, 8
s_add_u32 s92, s92, 49280
s_add_u32 s92, s92, 28311552
s_mov_b32 s41, 0x40000
Lpoll_133:
s_load_dword s93, s[82:83], s92 glc
Lpchk_135:
s_waitcnt lgkmcnt(0)
s_cmp_eq_u32 s93, 16
s_cbranch_scc1 Lpok_134
s_sub_u32 s41, s41, 1
s_cmp_lg_u32 s41, 0
s_cbranch_scc1 Lpoll_133
Lpok_134:
Lw_132:
s_waitcnt vmcnt(0)
s_barrier
s_add_u32 s37, s35, 1
s_and_b32 s37, s37, 15
s_mul_i32 s37, s37, 16384
s_add_u32 m0, s39, 49152
s_nop 0
buffer_load_dwordx4 v3, s[8:11], s37 offen sc1 lds
buffer_load_dwordx4 v3, s[8:11], s37 offen offset:1024 sc1 lds
buffer_load_dwordx4 v3, s[8:11], s37 offen offset:2048 sc1 lds
buffer_load_dwordx4 v3, s[8:11], s37 offen offset:3072 sc1 lds
s_add_u32 s37, s35, 2
s_and_b32 s37, s37, 15
s_mul_i32 s37, s37, 16384
s_add_u32 m0, s39, 98304
s_nop 0
buffer_load_dwordx4 v3, s[8:11], s37 offen sc1 lds
buffer_load_dwordx4 v3, s[8:11], s37 offen offset:1024 sc1 lds
buffer_load_dwordx4 v3, s[8:11], s37 offen offset:2048 sc1 lds
buffer_load_dwordx4 v3, s[8:11], s37 offen offset:3072 sc1 lds
buffer_load_dwordx4 v[96:99], v3, s[20:23], 0 offen offset:0 sc1
buffer_load_dwordx4 v[100:103], v3, s[20:23], 0 offen offset:1024 sc1
buffer_load_dwordx4 v[104:107], v3, s[20:23], 0 offen offset:2048 sc1
buffer_load_dwordx4 v[108:111], v3, s[20:23], 0 offen offset:3072 sc1
s_and_b32 s44, s36, 3
s_mul_i32 s44, s44, 11
s_bfe_u32 s43, s2, 0x30001
s_lshl_b32 s43, s43, 7
s_add_u32 s44, s44, s43
s_add_u32 s44, s44, 84
s_mul_i32 s44, s44, 7168
s_lshr_b32 s43, s2, 4
s_lshl_b32 s43, s43, 8
s_add_u32 s43, s43, s44
s_bitcmp0_b32 s2, 0
s_cselect_b32 s4, s72, s74
s_cselect_b32 s5, s73, s75
s_add_u32 s4, s4, s43
s_addc_u32 s5, s5, 0
s_waitcnt vmcnt(8)
s_barrier
s_cmp_eq_u32 s47, 3
s_cbranch_scc0 Lw_136
v_and_b32 v90, 31, v1
v_lshlrev_b32 v90, 4, v90
v_add_u32 v91, 151552, v90
ds_read_b128 v[112:115], v91 offset:0
ds_read_b128 v[116:119], v91 offset:512
ds_read_b128 v[120:123], v91 offset:1024
ds_read_b128 v[124:127], v91 offset:1536
s_and_b32 s44, s2, 15
s_mul_i32 s44, s44, 14336
s_lshr_b32 s43, s2, 4
s_lshl_b32 s43, s43, 9
s_add_u32 s44, s44, s43
s_add_u32 s44, s44, 8192
s_cmp_lt_u32 s2, 192
s_cselect_b32 s44, s44, 0x7fffffff
s_waitcnt lgkmcnt(0)
v_add_f32 v112, v112, v116
v_add_f32 v120, v120, v124
v_add_f32 v113, v113, v117
v_add_f32 v121, v121, v125
v_add_f32 v114, v114, v118
v_add_f32 v122, v122, v126
v_add_f32 v115, v115, v119
v_add_f32 v123, v123, v127
v_add_f32 v112, v112, v120
v_add_f32 v113, v113, v121
v_add_f32 v114, v114, v122
v_add_f32 v115, v115, v123
s_mov_b64 exec, 0xffffffff
buffer_store_dwordx4 v[112:115], v90, s[84:87], s44 offen sc1
s_mov_b64 exec, -1
Lw_136:
s_add_u32 s37, s35, 3
s_and_b32 s37, s37, 15
s_mul_i32 s37, s37, 16384
s_add_u32 m0, s39, 0
s_nop 0
buffer_load_dwordx4 v3, s[8:11], s37 offen sc1 lds
s_load_dword s3, s[4:5], 0
buffer_load_dwordx4 v3, s[8:11], s37 offen offset:1024 sc1 lds
s_load_dword s3, s[4:5], 64
buffer_load_dwordx4 v3, s[8:11], s37 offen offset:2048 sc1 lds
s_load_dword s3, s[4:5], 128
buffer_load_dwordx4 v3, s[8:11], s37 offen offset:3072 sc1 lds
s_load_dword s3, s[4:5], 192
s_load_dword s3, s[4:5], 7168
s_add_u32 s38, s35, 3
s_and_b32 s38, s38, 15
s_mul_i32 s38, s38, 458752
s_add_u32 m0, s50, 0
s_nop 0
buffer_load_dwordx4 v6, s[16:19], s38 offen lds
s_load_dword s3, s[4:5], 7232
s_add_u32 m0, s50, 1024
s_nop 0
buffer_load_dwordx4 v7, s[16:19], s38 offen lds
s_load_dword s3, s[4:5], 7296
s_add_u32 m0, s50, 2048
s_nop 0
buffer_load_dwordx4 v8, s[16:19], s38 offen lds
s_load_dword s3, s[4:5], 7360
s_add_u32 m0, s50, 3072
s_add_u32 s38, s38, 114688
buffer_load_dwordx4 v6, s[16:19], s38 offen lds
s_load_dword s3, s[4:5], 14336
s_load_dword s3, s[4:5], 14400
s_add_u32 m0, s50, 4096
s_nop 0
buffer_load_dwordx4 v7, s[16:19], s38 offen lds
s_add_u32 m0, s50, 5120
s_nop 0
buffer_load_dwordx4 v8, s[16:19], s38 offen lds
s_waitcnt vmcnt(14)
s_barrier
s_add_u32 s37, s35, 4
s_and_b32 s37, s37, 15
s_mul_i32 s37, s37, 16384
s_add_u32 m0, s39, 49152
s_nop 0
buffer_load_dwordx4 v3, s[8:11], s37 offen sc1 lds
s_load_dword s3, s[4:5], 14464
buffer_load_dwordx4 v3, s[8:11], s37 offen offset:1024 sc1 lds
s_load_dword s3, s[4:5], 14528
buffer_load_dwordx4 v3, s[8:11], s37 offen offset:2048 sc1 lds
s_load_dword s3, s[4:5], 21504
buffer_load_dwordx4 v3, s[8:11], s37 offen offset:3072 sc1 lds
s_load_dword s3, s[4:5], 21568
s_load_dword s3, s[4:5], 21632
s_add_u32 s38, s35, 4
s_and_b32 s38, s38, 15
s_mul_i32 s38, s38, 458752
s_add_u32 m0, s50, 49152
s_nop 0
buffer_load_dwordx4 v6, s[16:19], s38 offen lds
s_load_dword s3, s[4:5], 21696
s_add_u32 m0, s50, 50176
s_nop 0
buffer_load_dwordx4 v7, s[16:19], s38 offen lds
s_load_dword s3, s[4:5], 28672
s_add_u32 m0, s50, 51200
s_nop 0
buffer_load_dwordx4 v8, s[16:19], s38 offen lds
s_load_dword s3, s[4:5], 28736
s_add_u32 m0, s50, 52224
s_add_u32 s38, s38, 114688
buffer_load_dwordx4 v6, s[16:19], s38 offen lds
s_load_dword s3, s[4:5], 28800
s_load_dword s3, s[4:5], 28864
s_add_u32 m0, s50, 53248
s_nop 0
buffer_load_dwordx4 v7, s[16:19], s38 offen lds
s_add_u32 m0, s50, 54272
s_nop 0
buffer_load_dwordx4 v8, s[16:19], s38 offen lds
s_waitcnt vmcnt(10)
s_barrier
s_cmp_eq_u32 s47, 3
s_cbranch_scc0 Lw_137
s_cmp_lt_u32 s2, 192
s_cbranch_scc0 Lw_137
s_lshr_b32 s43, s2, 4
s_add_u32 s43, s43, 96
s_lshl_b32 s43, s43, 7
v_mov_b32 v90, s43
v_mov_b32 v91, 1
s_mov_b64 exec, 1
buffer_atomic_add v91, v90, s[56:59], 0 offen sc1
s_mov_b64 exec, -1
Lw_137:
s_add_u32 s37, s35, 5
s_and_b32 s37, s37, 15
s_mul_i32 s37, s37, 16384
s_add_u32 m0, s39, 98304
s_nop 0
buffer_load_dwordx4 v3, s[8:11], s37 offen sc1 lds
v_add_f32 v96, v96, v100
v_add_f32 v97, v97, v101
v_add_f32 v98, v98, v102
buffer_load_dwordx4 v3, s[8:11], s37 offen offset:1024 sc1 lds
v_add_f32 v99, v99, v103
v_add_f32 v104, v104, v108
v_add_f32 v105, v105, v109
buffer_load_dwordx4 v3, s[8:11], s37 offen offset:2048 sc1 lds
v_add_f32 v106, v106, v110
v_add_f32 v107, v107, v111
s_nop 0
buffer_load_dwordx4 v3, s[8:11], s37 offen offset:3072 sc1 lds
v_permlane32_swap_b32 v96, v104
v_permlane32_swap_b32 v97, v105
v_permlane32_swap_b32 v98, v106
v_permlane32_swap_b32 v99, v107
s_add_u32 s38, s35, 5
s_and_b32 s38, s38, 15
s_mul_i32 s38, s38, 458752
s_add_u32 m0, s50, 98304
s_nop 0
buffer_load_dwordx4 v6, s[16:19], s38 offen lds
v_add_f32 v96, v96, v104
v_add_f32 v97, v97, v105
v_add_f32 v98, v98, v106
s_add_u32 m0, s50, 99328
s_nop 0
buffer_load_dwordx4 v7, s[16:19], s38 offen lds
v_add_f32 v99, v99, v107
v_mov_b32 v100, v96
v_mov_b32 v101, v97
s_add_u32 m0, s50, 100352
s_nop 0
buffer_load_dwordx4 v8, s[16:19], s38 offen lds
v_mov_b32 v102, v98
v_mov_b32 v103, v99
s_nop 0
s_add_u32 m0, s50, 101376
s_add_u32 s38, s38, 114688
buffer_load_dwordx4 v6, s[16:19], s38 offen lds
v_permlane16_swap_b32 v96, v100
v_permlane16_swap_b32 v97, v101
v_permlane16_swap_b32 v98, v102
v_permlane16_swap_b32 v99, v103
s_add_u32 m0, s50, 102400
s_nop 0
buffer_load_dwordx4 v7, s[16:19], s38 offen lds
s_add_u32 m0, s50, 103424
s_nop 0
buffer_load_dwordx4 v8, s[16:19], s38 offen lds
s_waitcnt vmcnt(10)
s_barrier
s_add_u32 s37, s35, 6
s_and_b32 s37, s37, 15
s_mul_i32 s37, s37, 16384
s_add_u32 m0, s39, 0
s_nop 0
buffer_load_dwordx4 v3, s[8:11], s37 offen sc1 lds
v_add_f32 v96, v96, v100
v_add_f32 v97, v97, v101
v_add_f32 v98, v98, v102
buffer_load_dwordx4 v3, s[8:11], s37 offen offset:1024 sc1 lds
v_add_f32 v99, v99, v103
s_nop 0
v_add_f32_dpp v96, v96, v96 row_ror:8 row_mask:0xf bank_mask:0xf
buffer_load_dwordx4 v3, s[8:11], s37 offen offset:2048 sc1 lds
v_add_f32_dpp v97, v97, v97 row_ror:8 row_mask:0xf bank_mask:0xf
v_add_f32_dpp v98, v98, v98 row_ror:8 row_mask:0xf bank_mask:0xf
v_add_f32_dpp v99, v99, v99 row_ror:8 row_mask:0xf bank_mask:0xf
v_mul_f32 v96, 0x3a800000, v96
buffer_load_dwordx4 v3, s[8:11], s37 offen offset:3072 sc1 lds
v_mul_f32 v97, 0x3a800000, v97
v_mul_f32 v98, 0x3a800000, v98
v_mul_f32 v99, 0x3a800000, v99
s_add_u32 s38, s35, 6
s_and_b32 s38, s38, 15
s_mul_i32 s38, s38, 458752
s_add_u32 m0, s50, 0
s_nop 0
buffer_load_dwordx4 v6, s[16:19], s38 offen lds
v_fma_f32 v97, -v96, v96, v97
v_fma_f32 v99, -v98, v98, v99
v_max_f32 v97, 0, v97
s_add_u32 m0, s50, 1024
s_nop 0
buffer_load_dwordx4 v7, s[16:19], s38 offen lds
v_max_f32 v99, 0, v99
v_add_f32 v97, 0x3727c5ac, v97
v_add_f32 v99, 0x3727c5ac, v99
v_rsq_f32 v97, v97
s_add_u32 m0, s50, 2048
s_nop 0
buffer_load_dwordx4 v8, s[16:19], s38 offen lds
v_rsq_f32 v99, v99
v_and_b32 v100, 7, v1
s_lshl_b32 s43, s47, 8
s_add_u32 m0, s50, 3072
s_add_u32 s38, s38, 114688
buffer_load_dwordx4 v6, s[16:19], s38 offen lds
s_add_u32 s43, s43, 147456
v_lshl_add_u32 v100, v100, 4, s43
v_lshrrev_b32 v101, 5, v1
v_lshl_add_u32 v100, v101, 7, v100
s_add_u32 m0, s50, 4096
s_nop 0
buffer_load_dwordx4 v7, s[16:19], s38 offen lds
s_add_u32 m0, s50, 5120
s_nop 0
buffer_load_dwordx4 v8, s[16:19], s38 offen lds
s_waitcnt vmcnt(10)
s_barrier
ds_write_b128 v100, v[96:99]
s_waitcnt lgkmcnt(0)
s_add_u32 s37, s35, 7
s_and_b32 s37, s37, 15
s_mul_i32 s37, s37, 16384
s_add_u32 m0, s39, 49152
s_nop 0
buffer_load_dwordx4 v3, s[8:11], s37 offen sc1 lds
s_load_dword s3, s[4:5], 35840
buffer_load_dwordx4 v3, s[8:11], s37 offen offset:1024 sc1 lds
s_load_dword s3, s[4:5], 35904
buffer_load_dwordx4 v3, s[8:11], s37 offen offset:2048 sc1 lds
s_load_dword s3, s[4:5], 35968
s_load_dword s3, s[4:5], 36032
buffer_load_dwordx4 v3, s[8:11], s37 offen offset:3072 sc1 lds
s_load_dword s3, s[4:5], 43008
s_add_u32 s38, s35, 7
s_and_b32 s38, s38, 15
s_mul_i32 s38, s38, 458752
s_add_u32 m0, s50, 49152
s_nop 0
buffer_load_dwordx4 v6, s[16:19], s38 offen lds
s_load_dword s3, s[4:5], 43072
s_add_u32 m0, s50, 50176
s_nop 0
buffer_load_dwordx4 v7, s[16:19], s38 offen lds
s_load_dword s3, s[4:5], 43136
s_load_dword s3, s[4:5], 43200
s_add_u32 m0, s50, 51200
s_nop 0
buffer_load_dwordx4 v8, s[16:19], s38 offen lds
s_load_dword s3, s[4:5], 50176
s_add_u32 m0, s50, 52224
s_add_u32 s38, s38, 114688
buffer_load_dwordx4 v6, s[16:19], s38 offen lds
s_load_dword s3, s[4:5], 50240
s_load_dword s3, s[4:5], 50304
s_add_u32 m0, s50, 53248
s_nop 0
buffer_load_dwordx4 v7, s[16:19], s38 offen lds
s_add_u32 m0, s50, 54272
s_nop 0
buffer_load_dwordx4 v8, s[16:19], s38 offen lds
s_waitcnt vmcnt(10)
s_barrier
s_add_u32 s37, s35, 8
s_and_b32 s37, s37, 15
s_mul_i32 s37, s37, 16384
s_add_u32 m0, s39, 98304
s_nop 0
buffer_load_dwordx4 v3, s[8:11], s37 offen sc1 lds
s_load_dword s3, s[4:5], 50368
s_load_dword s3, s[4:5], 57344
s_load_dword s3, s[4:5], 57408
buffer_load_dwordx4 v3, s[8:11], s37 offen offset:1024 sc1 lds
s_load_dword s3, s[4:5], 57472
s_load_dword s3, s[4:5], 57536
s_load_dword s3, s[4:5], 64512
s_load_dword s3, s[4:5], 64576
buffer_load_dwordx4 v3, s[8:11], s37 offen offset:2048 sc1 lds
s_load_dword s3, s[4:5], 64640
s_load_dword s3, s[4:5], 64704
s_load_dword s3, s[4:5], 71680
s_load_dword s3, s[4:5], 71744
buffer_load_dwordx4 v3, s[8:11], s37 offen offset:3072 sc1 lds
v_lshrrev_b32 v28, 2, v1
v_and_b32 v29, 7, v28
v_mul_u32_u24 v28, 256, v28
v_lshl_add_u32 v28, v29, 5, v28
s_add_u32 s38, s35, 8
s_and_b32 s38, s38, 15
s_mul_i32 s38, s38, 458752
s_add_u32 m0, s50, 98304
s_nop 0
buffer_load_dwordx4 v6, s[16:19], s38 offen lds
v_and_b32 v29, 3, v1
v_lshl_add_u32 v11, v29, 3, v28
s_lshl_b32 s43, s63, 7
v_xor_b32 v11, s43, v11
s_add_u32 m0, s50, 99328
s_nop 0
buffer_load_dwordx4 v7, s[16:19], s38 offen lds
v_add_u32 v11, 16384, v11
v_xor_b32 v12, 32, v11
v_xor_b32 v13, 64, v11
v_xor_b32 v14, 96, v11
s_add_u32 m0, s50, 100352
s_nop 0
buffer_load_dwordx4 v8, s[16:19], s38 offen lds
v_add_u32 v15, 49152, v11
v_add_u32 v16, 49152, v12
v_add_u32 v17, 49152, v13
v_add_u32 v18, 49152, v14
s_add_u32 m0, s50, 101376
s_add_u32 s38, s38, 114688
buffer_load_dwordx4 v6, s[16:19], s38 offen lds
v_add_u32 v19, 98304, v11
v_add_u32 v20, 98304, v12
v_add_u32 v21, 98304, v13
v_add_u32 v22, 98304, v14
s_add_u32 m0, s50, 102400
s_nop 0
buffer_load_dwordx4 v7, s[16:19], s38 offen lds
s_add_u32 m0, s50, 103424
s_nop 0
buffer_load_dwordx4 v8, s[16:19], s38 offen lds
s_waitcnt vmcnt(10)
s_barrier
s_cmp_eq_u32 s47, 3
s_cbranch_scc0 Lw_138
s_mul_i32 s60, s35, 96
s_add_u32 s61, s60, 95
s_and_b32 s60, s60, 0xff80
s_and_b32 s61, s61, 0xff80
s_add_u32 s60, s60, 28323840
s_add_u32 s61, s61, 28323840
s_load_dword s92, s[82:83], s60 glc
s_load_dword s93, s[82:83], s61 glc
Lw_138:
s_add_u32 s37, s35, 9
s_and_b32 s37, s37, 15
s_mul_i32 s37, s37, 16384
s_add_u32 m0, s39, 0
s_nop 0
buffer_load_dwordx4 v3, s[8:11], s37 offen sc1 lds
buffer_load_dwordx4 v3, s[8:11], s37 offen offset:1024 sc1 lds
buffer_load_dwordx4 v3, s[8:11], s37 offen offset:2048 sc1 lds
buffer_load_dwordx4 v3, s[8:11], s37 offen offset:3072 sc1 lds
s_add_u32 s38, s35, 9
s_and_b32 s38, s38, 15
s_mul_i32 s38, s38, 458752
s_add_u32 m0, s50, 0
s_nop 0
buffer_load_dwordx4 v6, s[16:19], s38 offen lds
s_add_u32 m0, s50, 1024
s_nop 0
buffer_load_dwordx4 v7, s[16:19], s38 offen lds
s_add_u32 m0, s50, 2048
s_nop 0
buffer_load_dwordx4 v8, s[16:19], s38 offen lds
s_add_u32 m0, s50, 3072
s_add_u32 s38, s38, 114688
buffer_load_dwordx4 v6, s[16:19], s38 offen lds
s_add_u32 m0, s50, 4096
s_nop 0
buffer_load_dwordx4 v7, s[16:19], s38 offen lds
s_add_u32 m0, s50, 5120
s_nop 0
buffer_load_dwordx4 v8, s[16:19], s38 offen lds
s_waitcnt vmcnt(10)
s_barrier
s_add_u32 s37, s35, 10
s_and_b32 s37, s37, 15
s_mul_i32 s37, s37, 16384
s_add_u32 m0, s39, 49152
s_nop 0
buffer_load_dwordx4 v3, s[8:11], s37 offen sc1 lds
buffer_load_dwordx4 v3, s[8:11], s37 offen offset:1024 sc1 lds
buffer_load_dwordx4 v3, s[8:11], s37 offen offset:2048 sc1 lds
buffer_load_dwordx4 v3, s[8:11], s37 offen offset:3072 sc1 lds
s_add_u32 s38, s35, 10
s_and_b32 s38, s38, 15
s_mul_i32 s38, s38, 458752
s_add_u32 m0, s50, 49152
s_nop 0
buffer_load_dwordx4 v6, s[16:19], s38 offen lds
s_add_u32 m0, s50, 50176
s_nop 0
buffer_load_dwordx4 v7, s[16:19], s38 offen lds
s_add_u32 m0, s50, 51200
s_nop 0
buffer_load_dwordx4 v8, s[16:19], s38 offen lds
s_add_u32 m0, s50, 52224
s_add_u32 s38, s38, 114688
buffer_load_dwordx4 v6, s[16:19], s38 offen lds
s_add_u32 m0, s50, 53248
s_nop 0
buffer_load_dwordx4 v7, s[16:19], s38 offen lds
s_add_u32 m0, s50, 54272
s_nop 0
buffer_load_dwordx4 v8, s[16:19], s38 offen lds
s_mov_b32 s38, 0
buffer_load_dwordx4 v[40:43], v24, s[88:91], s38 offen
s_mov_b32 s38, 28672
s_branch Lov_14
.p2align 12
.fill 112, 4, 0xbf800000
Lst_14_0:
s_branch Lwr_169
Lst_14_1:
s_branch Lwr_177
s_nop 0
Lov_14:
buffer_load_dwordx4 v[44:47], v24, s[88:91], s38 offen
s_mov_b32 s38, 57344
buffer_load_dwordx4 v[48:51], v24, s[88:91], s38 offen
s_mov_b32 s38, 86016
buffer_load_dwordx4 v[52:55], v24, s[88:91], s38 offen
s_mov_b32 s38, 114688
buffer_load_dwordx4 v[56:59], v24, s[88:91], s38 offen
s_mov_b32 s38, 143360
buffer_load_dwordx4 v[60:63], v24, s[88:91], s38 offen
s_mov_b32 s38, 172032
buffer_load_dwordx4 v[64:67], v24, s[88:91], s38 offen
s_mov_b32 s38, 200704
buffer_load_dwordx4 v[68:71], v24, s[88:91], s38 offen
s_waitcnt vmcnt(18)
s_cmp_eq_u32 s47, 3
s_cbranch_scc0 Lw_139
s_mov_b32 s41, 0x40000
Lcp_140:
s_waitcnt lgkmcnt(0)
s_and_b32 s92, s92, s93
s_cmp_eq_u32 s92, 16
s_cbranch_scc1 Lco_141
s_load_dword s92, s[82:83], s60 glc
s_load_dword s93, s[82:83], s61 glc
s_sub_u32 s41, s41, 1
s_cmp_lg_u32 s41, 0
s_cbranch_scc1 Lcp_140
s_waitcnt lgkmcnt(0)
Lco_141:
Lw_139:
s_barrier
s_mov_b32 s45, s47
s_cmp_ge_u32 s45, 3
s_cselect_b32 s43, 1, 0
s_mul_i32 s44, s43, 3
s_sub_u32 s45, s45, s44
s_lshl_b32 s45, s45, 7
s_mul_i32 s52, s43, 896
s_add_u32 s52, s52, s45
s_add_u32 s52, s52, 148992
s_mul_i32 s43, s43, 14336
s_add_u32 s43, s43, s45
s_mul_i32 s44, s35, 384
s_add_u32 s43, s43, s44
s_add_u32 s60, s43, 8192
s_add_u32 s45, s47, 4
s_min_u32 s45, s45, 5
s_cmp_ge_u32 s45, 3
s_cselect_b32 s43, 1, 0
s_mul_i32 s44, s43, 3
s_sub_u32 s45, s45, s44
s_lshl_b32 s45, s45, 7
s_mul_i32 s53, s43, 896
s_add_u32 s53, s53, s45
s_add_u32 s53, s53, 148992
s_mul_i32 s43, s43, 14336
s_add_u32 s43, s43, s45
s_mul_i32 s44, s35, 384
s_add_u32 s43, s43, s44
s_add_u32 s61, s43, 8192
v_lshrrev_b32 v104, 3, v1
v_mul_u32_u24 v104, 28672, v104
v_and_b32 v105, 7, v1
v_lshl_add_u32 v104, v105, 4, v104
buffer_load_dwordx4 v[96:99], v104, s[84:87], s60 offen sc1
s_load_dword s3, s[4:5], 71808
s_load_dword s3, s[4:5], 71872
buffer_load_dwordx4 v[100:103], v104, s[84:87], s61 offen sc1
s_and_b32 s44, s36, 3
s_mul_i32 s43, s2, 28672
s_add_u32 s37, s35, 11
s_and_b32 s37, s37, 15
s_mul_i32 s37, s37, 16384
s_add_u32 m0, s39, 98304
s_nop 0
buffer_load_dwordx4 v3, s[8:11], s37 offen sc1 lds
s_mul_i32 s44, s44, 7168
s_add_u32 s43, s43, s44
buffer_load_dwordx4 v3, s[8:11], s37 offen offset:1024 sc1 lds
s_add_u32 s4, s76, s43
s_addc_u32 s5, s77, 0
s_load_dword s3, s[4:5], 0
buffer_load_dwordx4 v3, s[8:11], s37 offen offset:2048 sc1 lds
s_load_dword s3, s[4:5], 64
s_load_dword s3, s[4:5], 128
buffer_load_dwordx4 v3, s[8:11], s37 offen offset:3072 sc1 lds
s_load_dword s3, s[4:5], 192
s_load_dword s3, s[4:5], 256
s_add_u32 s38, s35, 11
s_and_b32 s38, s38, 15
s_mul_i32 s38, s38, 458752
s_add_u32 m0, s50, 98304
s_nop 0
buffer_load_dwordx4 v6, s[16:19], s38 offen lds
s_load_dword s3, s[4:5], 320
s_load_dword s3, s[4:5], 384
s_load_dword s3, s[4:5], 448
s_add_u32 m0, s50, 99328
s_nop 0
buffer_load_dwordx4 v7, s[16:19], s38 offen lds
v_cmp_gt_u32 vcc, 32, v1
v_mov_b32 v104, s52
s_add_u32 m0, s50, 100352
s_nop 0
buffer_load_dwordx4 v8, s[16:19], s38 offen lds
v_mov_b32 v106, s53
v_cndmask_b32 v104, v106, v104, vcc
s_add_u32 m0, s50, 101376
s_add_u32 s38, s38, 114688
buffer_load_dwordx4 v6, s[16:19], s38 offen lds
v_lshl_add_u32 v104, v105, 4, v104
v_bfe_u32 v105, v1, 4, 1
v_lshl_add_u32 v104, v105, 2, v104
s_add_u32 m0, s50, 102400
s_nop 0
buffer_load_dwordx4 v7, s[16:19], s38 offen lds
s_add_u32 m0, s50, 103424
s_nop 0
buffer_load_dwordx4 v8, s[16:19], s38 offen lds
s_waitcnt vmcnt(20)
s_barrier
s_add_u32 s37, s35, 12
s_and_b32 s37, s37, 15
s_mul_i32 s37, s37, 16384
s_add_u32 m0, s39, 0
s_nop 0
buffer_load_dwordx4 v3, s[8:11], s37 offen sc1 lds
buffer_load_dwordx4 v3, s[8:11], s37 offen offset:1024 sc1 lds
buffer_load_dwordx4 v3, s[8:11], s37 offen offset:2048 sc1 lds
buffer_load_dwordx4 v3, s[8:11], s37 offen offset:3072 sc1 lds
s_add_u32 s38, s35, 12
s_and_b32 s38, s38, 15
s_mul_i32 s38, s38, 458752
s_add_u32 m0, s50, 0
s_nop 0
buffer_load_dwordx4 v6, s[16:19], s38 offen lds
s_add_u32 m0, s50, 1024
s_nop 0
buffer_load_dwordx4 v7, s[16:19], s38 offen lds
s_add_u32 m0, s50, 2048
s_nop 0
buffer_load_dwordx4 v8, s[16:19], s38 offen lds
s_add_u32 m0, s50, 3072
s_add_u32 s38, s38, 114688
buffer_load_dwordx4 v6, s[16:19], s38 offen lds
s_add_u32 m0, s50, 4096
s_nop 0
buffer_load_dwordx4 v7, s[16:19], s38 offen lds
s_add_u32 m0, s50, 5120
s_nop 0
buffer_load_dwordx4 v8, s[16:19], s38 offen lds
s_waitcnt vmcnt(10)
s_barrier
v_permlane32_swap_b32 v96, v100
v_permlane32_swap_b32 v97, v101
v_permlane32_swap_b32 v98, v102
v_permlane32_swap_b32 v99, v103
v_add_f32 v96, v96, v100
v_add_f32 v97, v97, v101
v_add_f32 v98, v98, v102
v_add_f32 v99, v99, v103
s_nop 1
v_permlane16_swap_b32 v96, v97
v_permlane16_swap_b32 v98, v99
v_add_f32 v96, v96, v97
v_add_f32 v98, v98, v99
s_nop 1
v_add_f32_dpp v96, v96, v96 row_ror:8 row_mask:0xf bank_mask:0xf
v_add_f32_dpp v98, v98, v98 row_ror:8 row_mask:0xf bank_mask:0xf
ds_write_b32 v104, v96
ds_write_b32 v104, v98 offset:8
s_waitcnt lgkmcnt(0)
s_add_u32 s37, s35, 13
s_and_b32 s37, s37, 15
s_mul_i32 s37, s37, 16384
s_add_u32 m0, s39, 49152
s_nop 0
buffer_load_dwordx4 v3, s[8:11], s37 offen sc1 lds
s_load_dword s3, s[4:5], 512
s_load_dword s3, s[4:5], 576
s_load_dword s3, s[4:5], 640
s_load_dword s3, s[4:5], 704
s_load_dword s3, s[4:5], 768
buffer_load_dwordx4 v3, s[8:11], s37 offen offset:1024 sc1 lds
s_load_dword s3, s[4:5], 832
s_load_dword s3, s[4:5], 896
s_load_dword s3, s[4:5], 960
s_load_dword s3, s[4:5], 1024
s_load_dword s3, s[4:5], 1088
buffer_load_dwordx4 v3, s[8:11], s37 offen offset:2048 sc1 lds
v_lshlrev_b32 v72, 16, v40
v_and_b32 v73, 0xffff0000, v40
v_lshlrev_b32 v74, 16, v41
v_and_b32 v75, 0xffff0000, v41
v_lshlrev_b32 v76, 16, v42
v_and_b32 v77, 0xffff0000, v42
buffer_load_dwordx4 v3, s[8:11], s37 offen offset:3072 sc1 lds
v_lshlrev_b32 v78, 16, v43
v_and_b32 v79, 0xffff0000, v43
v_lshlrev_b32 v80, 16, v44
v_and_b32 v81, 0xffff0000, v44
v_lshlrev_b32 v82, 16, v45
s_add_u32 s38, s35, 13
s_and_b32 s38, s38, 15
s_mul_i32 s38, s38, 458752
s_add_u32 m0, s50, 49152
s_nop 0
buffer_load_dwordx4 v6, s[16:19], s38 offen lds
v_and_b32 v83, 0xffff0000, v45
v_lshlrev_b32 v84, 16, v46
v_and_b32 v85, 0xffff0000, v46
v_lshlrev_b32 v86, 16, v47
v_and_b32 v87, 0xffff0000, v47
s_add_u32 m0, s50, 50176
s_nop 0
buffer_load_dwordx4 v7, s[16:19], s38 offen lds
v_add_f32 v72, v72, v80
v_add_f32 v73, v73, v81
v_add_f32 v74, v74, v82
v_add_f32 v75, v75, v83
v_add_f32 v76, v76, v84
v_add_f32 v77, v77, v85
s_add_u32 m0, s50, 51200
s_nop 0
buffer_load_dwordx4 v8, s[16:19], s38 offen lds
v_add_f32 v78, v78, v86
v_add_f32 v79, v79, v87
v_lshlrev_b32 v80, 16, v48
v_and_b32 v81, 0xffff0000, v48
v_lshlrev_b32 v82, 16, v49
s_add_u32 m0, s50, 52224
s_add_u32 s38, s38, 114688
buffer_load_dwordx4 v6, s[16:19], s38 offen lds
v_and_b32 v83, 0xffff0000, v49
v_lshlrev_b32 v84, 16, v50
v_and_b32 v85, 0xffff0000, v50
v_lshlrev_b32 v86, 16, v51
v_and_b32 v87, 0xffff0000, v51
v_add_f32 v72, v72, v80
s_add_u32 m0, s50, 53248
s_nop 0
buffer_load_dwordx4 v7, s[16:19], s38 offen lds
s_add_u32 m0, s50, 54272
s_nop 0
buffer_load_dwordx4 v8, s[16:19], s38 offen lds
s_waitcnt vmcnt(10)
s_barrier
s_add_u32 s37, s35, 14
s_and_b32 s37, s37, 15
s_mul_i32 s37, s37, 16384
s_add_u32 m0, s39, 98304
s_nop 0
buffer_load_dwordx4 v3, s[8:11], s37 offen sc1 lds
s_load_dword s3, s[4:5], 1152
s_load_dword s3, s[4:5], 1216
s_load_dword s3, s[4:5], 1280
s_load_dword s3, s[4:5], 1344
s_load_dword s3, s[4:5], 1408
buffer_load_dwordx4 v3, s[8:11], s37 offen offset:1024 sc1 lds
s_load_dword s3, s[4:5], 1472
s_load_dword s3, s[4:5], 1536
s_load_dword s3, s[4:5], 1600
s_load_dword s3, s[4:5], 1664
s_load_dword s3, s[4:5], 1728
v_add_f32 v73, v73, v81
buffer_load_dwordx4 v3, s[8:11], s37 offen offset:2048 sc1 lds
v_add_f32 v74, v74, v82
v_add_f32 v75, v75, v83
v_add_f32 v76, v76, v84
v_add_f32 v77, v77, v85
v_add_f32 v78, v78, v86
buffer_load_dwordx4 v3, s[8:11], s37 offen offset:3072 sc1 lds
v_add_f32 v79, v79, v87
v_lshlrev_b32 v80, 16, v52
v_and_b32 v81, 0xffff0000, v52
v_lshlrev_b32 v82, 16, v53
v_and_b32 v83, 0xffff0000, v53
v_lshlrev_b32 v84, 16, v54
s_add_u32 s38, s35, 14
s_and_b32 s38, s38, 15
s_mul_i32 s38, s38, 458752
s_add_u32 m0, s50, 98304
s_nop 0
buffer_load_dwordx4 v6, s[16:19], s38 offen lds
v_and_b32 v85, 0xffff0000, v54
v_lshlrev_b32 v86, 16, v55
v_and_b32 v87, 0xffff0000, v55
v_add_f32 v72, v72, v80
v_add_f32 v73, v73, v81
s_add_u32 m0, s50, 99328
s_nop 0
buffer_load_dwordx4 v7, s[16:19], s38 offen lds
v_add_f32 v74, v74, v82
v_add_f32 v75, v75, v83
v_add_f32 v76, v76, v84
v_add_f32 v77, v77, v85
v_add_f32 v78, v78, v86
v_add_f32 v79, v79, v87
s_add_u32 m0, s50, 100352
s_nop 0
buffer_load_dwordx4 v8, s[16:19], s38 offen lds
v_lshlrev_b32 v80, 16, v56
v_and_b32 v81, 0xffff0000, v56
v_lshlrev_b32 v82, 16, v57
v_and_b32 v83, 0xffff0000, v57
v_lshlrev_b32 v84, 16, v58
s_add_u32 m0, s50, 101376
s_add_u32 s38, s38, 114688
buffer_load_dwordx4 v6, s[16:19], s38 offen lds
v_and_b32 v85, 0xffff0000, v58
v_lshlrev_b32 v86, 16, v59
v_and_b32 v87, 0xffff0000, v59
v_add_f32 v72, v72, v80
v_add_f32 v73, v73, v81
v_add_f32 v74, v74, v82
s_add_u32 m0, s50, 102400
s_nop 0
buffer_load_dwordx4 v7, s[16:19], s38 offen lds
s_add_u32 m0, s50, 103424
s_nop 0
buffer_load_dwordx4 v8, s[16:19], s38 offen lds
s_waitcnt vmcnt(10)
s_barrier
s_add_u32 s37, s35, 15
s_and_b32 s37, s37, 15
s_mul_i32 s37, s37, 16384
s_add_u32 m0, s39, 0
s_nop 0
buffer_load_dwordx4 v3, s[8:11], s37 offen sc1 lds
v_add_f32 v75, v75, v83
v_add_f32 v76, v76, v84
v_add_f32 v77, v77, v85
v_add_f32 v78, v78, v86
buffer_load_dwordx4 v3, s[8:11], s37 offen offset:1024 sc1 lds
v_add_f32 v79, v79, v87
v_lshlrev_b32 v80, 16, v60
v_and_b32 v81, 0xffff0000, v60
v_lshlrev_b32 v82, 16, v61
buffer_load_dwordx4 v3, s[8:11], s37 offen offset:2048 sc1 lds
v_and_b32 v83, 0xffff0000, v61
v_lshlrev_b32 v84, 16, v62
v_and_b32 v85, 0xffff0000, v62
v_lshlrev_b32 v86, 16, v63
buffer_load_dwordx4 v3, s[8:11], s37 offen offset:3072 sc1 lds
v_and_b32 v87, 0xffff0000, v63
v_add_f32 v72, v72, v80
v_add_f32 v73, v73, v81
v_add_f32 v74, v74, v82
s_add_u32 s38, s35, 15
s_and_b32 s38, s38, 15
s_mul_i32 s38, s38, 458752
s_add_u32 m0, s50, 0
s_nop 0
buffer_load_dwordx4 v6, s[16:19], s38 offen lds
v_add_f32 v75, v75, v83
v_add_f32 v76, v76, v84
v_add_f32 v77, v77, v85
v_add_f32 v78, v78, v86
s_add_u32 m0, s50, 1024
s_nop 0
buffer_load_dwordx4 v7, s[16:19], s38 offen lds
v_add_f32 v79, v79, v87
v_lshlrev_b32 v80, 16, v64
v_and_b32 v81, 0xffff0000, v64
v_lshlrev_b32 v82, 16, v65
s_add_u32 m0, s50, 2048
s_nop 0
buffer_load_dwordx4 v8, s[16:19], s38 offen lds
v_and_b32 v83, 0xffff0000, v65
v_lshlrev_b32 v84, 16, v66
v_and_b32 v85, 0xffff0000, v66
v_lshlrev_b32 v86, 16, v67
s_add_u32 m0, s50, 3072
s_add_u32 s38, s38, 114688
buffer_load_dwordx4 v6, s[16:19], s38 offen lds
v_and_b32 v87, 0xffff0000, v67
v_add_f32 v72, v72, v80
v_add_f32 v73, v73, v81
v_add_f32 v74, v74, v82
v_add_f32 v75, v75, v83
s_add_u32 m0, s50, 4096
s_nop 0
buffer_load_dwordx4 v7, s[16:19], s38 offen lds
s_add_u32 m0, s50, 5120
s_nop 0
buffer_load_dwordx4 v8, s[16:19], s38 offen lds
s_waitcnt vmcnt(10)
s_barrier
s_add_u32 s38, s35, 13
s_and_b32 s38, s38, 15
s_mul_i32 s38, s38, 458752
s_add_u32 m0, s40, 49152
s_nop 0
buffer_load_dwordx4 v4, s[12:15], s38 offen lds
v_add_f32 v76, v76, v84
v_add_f32 v77, v77, v85
v_add_f32 v78, v78, v86
v_add_f32 v79, v79, v87
v_lshlrev_b32 v80, 16, v68
s_add_u32 m0, s40, 50176
s_nop 0
buffer_load_dwordx4 v5, s[12:15], s38 offen lds
v_and_b32 v81, 0xffff0000, v68
v_lshlrev_b32 v82, 16, v69
v_and_b32 v83, 0xffff0000, v69
v_lshlrev_b32 v84, 16, v70
v_and_b32 v85, 0xffff0000, v70
v_lshlrev_b32 v86, 16, v71
s_add_u32 m0, s40, 51200
s_add_u32 s38, s38, 57344
buffer_load_dwordx4 v4, s[12:15], s38 offen lds
v_and_b32 v87, 0xffff0000, v71
v_add_f32 v72, v72, v80
v_add_f32 v73, v73, v81
v_add_f32 v74, v74, v82
v_add_f32 v75, v75, v83
v_add_f32 v76, v76, v84
s_add_u32 m0, s40, 52224
s_nop 0
buffer_load_dwordx4 v5, s[12:15], s38 offen lds
v_add_f32 v77, v77, v85
v_add_f32 v78, v78, v86
v_add_f32 v79, v79, v87
s_nop 0
v_permlane32_swap_b32 v72, v76
s_add_u32 m0, s40, 53248
s_add_u32 s38, s38, 57344
buffer_load_dwordx4 v4, s[12:15], s38 offen lds
v_permlane32_swap_b32 v73, v77
v_permlane32_swap_b32 v74, v78
v_permlane32_swap_b32 v75, v79
v_add_f32 v72, v72, v76
v_add_f32 v73, v73, v77
v_add_f32 v74, v74, v78
s_add_u32 m0, s40, 54272
s_nop 0
buffer_load_dwordx4 v5, s[12:15], s38 offen lds
v_add_f32 v75, v75, v79
s_nop 0
v_permlane16_swap_b32 v72, v74
v_permlane16_swap_b32 v73, v75
v_add_f32 v72, v72, v74
v_add_f32 v73, v73, v75
s_add_u32 m0, s40, 55296
s_add_u32 s38, s38, 57344
buffer_load_dwordx4 v4, s[12:15], s38 offen lds
s_add_u32 m0, s40, 56320
s_nop 0
buffer_load_dwordx4 v5, s[12:15], s38 offen lds
s_waitcnt vmcnt(8)
s_barrier
s_lshl_b32 s43, s47, 9
s_add_u32 s43, s43, 153600
v_and_b32 v80, 15, v1
v_lshl_add_u32 v80, v80, 5, s43
v_lshrrev_b32 v81, 4, v1
v_lshl_add_u32 v80, v81, 3, v80
ds_write_b64 v80, v[72:73]
s_waitcnt lgkmcnt(0)
s_add_u32 s38, s35, 14
s_and_b32 s38, s38, 15
s_mul_i32 s38, s38, 458752
s_add_u32 m0, s40, 98304
s_nop 0
buffer_load_dwordx4 v4, s[12:15], s38 offen lds
s_bfe_u32 s61, s35, 0x10002
s_lshr_b32 s60, s35, 3
s_lshl_b32 s60, s60, 2
s_and_b32 s43, s35, 3
s_add_u32 s60, s60, s43
s_add_u32 m0, s40, 99328
s_nop 0
buffer_load_dwordx4 v5, s[12:15], s38 offen lds
s_lshl_b32 s43, s60, 8
s_add_u32 s28, s76, s43
s_addc_u32 s29, s77, 0
s_mov_b32 s30, 7338240
s_mov_b32 s31, 0x20000
s_add_u32 m0, s40, 100352
s_add_u32 s38, s38, 57344
buffer_load_dwordx4 v4, s[12:15], s38 offen lds
s_mul_i32 s52, s61, 196608
s_mul_i32 s53, s61, 1572864
s_mul_i32 s90, s61, 163840
s_mul_i32 s91, s61, 1310720
s_and_b32 s43, s35, 3
s_add_u32 m0, s40, 101376
s_nop 0
buffer_load_dwordx4 v5, s[12:15], s38 offen lds
s_mul_i32 s32, s43, 3
s_mul_i32 s33, s43, 10
s_lshr_b32 s33, s33, 2
s_lshl_b32 s51, s47, 11
s_lshl_b32 s44, s47, 15
s_add_u32 m0, s40, 102400
s_add_u32 s38, s38, 57344
buffer_load_dwordx4 v4, s[12:15], s38 offen lds
v_lshrrev_b32 v122, 4, v1
v_lshlrev_b32 v123, 1, v122
v_and_b32 v23, 15, v1
v_xor_b32 v23, v23, v123
v_lshlrev_b32 v23, 4, v23
s_add_u32 m0, s40, 103424
s_nop 0
buffer_load_dwordx4 v5, s[12:15], s38 offen lds
v_mul_u32_u24 v122, 2048, v122
v_add_u32 v23, v23, v122
v_add_u32 v23, s44, v23
v_xor_b32 v24, 128, v23
v_add_u32 v24, 8192, v24
s_add_u32 m0, s40, 104448
s_add_u32 s38, s38, 57344
buffer_load_dwordx4 v4, s[12:15], s38 offen lds
s_add_u32 m0, s40, 105472
s_nop 0
buffer_load_dwordx4 v5, s[12:15], s38 offen lds
s_waitcnt vmcnt(8)
s_barrier
ds_read_b128 v[28:31], v9 offset:49152
ds_read_b64_tr_b16 v[44:45], v15 offset:0
ds_read_b64_tr_b16 v[46:47], v15 offset:4096
ds_read_b64_tr_b16 v[48:49], v16 offset:0
ds_read_b64_tr_b16 v[50:51], v16 offset:4096
ds_read_b64_tr_b16 v[52:53], v17 offset:0
ds_read_b64_tr_b16 v[54:55], v17 offset:4096
ds_read_b64_tr_b16 v[56:57], v18 offset:0
ds_read_b64_tr_b16 v[58:59], v18 offset:4096
ds_read_b64_tr_b16 v[60:61], v15 offset:16384
ds_read_b64_tr_b16 v[62:63], v15 offset:20480
ds_read_b64_tr_b16 v[64:65], v16 offset:16384
ds_read_b64_tr_b16 v[66:67], v16 offset:20480
ds_read_b64_tr_b16 v[68:69], v17 offset:16384
ds_read_b64_tr_b16 v[70:71], v17 offset:20480
ds_read_b64_tr_b16 v[72:73], v18 offset:16384
ds_read_b64_tr_b16 v[74:75], v18 offset:20480
ds_read_b128 v[32:35], v9 offset:50176
ds_read_b128 v[36:39], v9 offset:51200
ds_read_b128 v[40:43], v9 offset:52224
s_waitcnt lgkmcnt(0)
v_mfma_f32_16x16x32_bf16 v[124:127], v[44:47], v[28:31], 0
ds_read_b128 v[76:79], v9 offset:57344
v_mfma_f32_16x16x32_bf16 v[156:159], v[44:47], v[32:35], 0
ds_read_b64_tr_b16 v[92:93], v15 offset:8192
v_mfma_f32_16x16x32_bf16 v[188:191], v[44:47], v[36:39], 0
ds_read_b64_tr_b16 v[94:95], v15 offset:12288
v_mfma_f32_16x16x32_bf16 v[220:223], v[44:47], v[40:43], 0
ds_read_b64_tr_b16 v[96:97], v16 offset:8192
v_mfma_f32_16x16x32_bf16 v[224:227], v[48:51], v[40:43], 0
ds_read_b64_tr_b16 v[98:99], v16 offset:12288
v_mfma_f32_16x16x32_bf16 v[192:195], v[48:51], v[36:39], 0
ds_read_b64_tr_b16 v[100:101], v17 offset:8192
v_mfma_f32_16x16x32_bf16 v[160:163], v[48:51], v[32:35], 0
ds_read_b64_tr_b16 v[102:103], v17 offset:12288
v_mfma_f32_16x16x32_bf16 v[128:131], v[48:51], v[28:31], 0
ds_read_b64_tr_b16 v[104:105], v18 offset:8192
v_mfma_f32_16x16x32_bf16 v[132:135], v[52:55], v[28:31], 0
ds_read_b64_tr_b16 v[106:107], v18 offset:12288
v_mfma_f32_16x16x32_bf16 v[164:167], v[52:55], v[32:35], 0
ds_read_b64_tr_b16 v[108:109], v15 offset:24576
v_mfma_f32_16x16x32_bf16 v[196:199], v[52:55], v[36:39], 0
ds_read_b64_tr_b16 v[110:111], v15 offset:28672
v_mfma_f32_16x16x32_bf16 v[228:231], v[52:55], v[40:43], 0
ds_read_b64_tr_b16 v[112:113], v16 offset:24576
v_mfma_f32_16x16x32_bf16 v[232:235], v[56:59], v[40:43], 0
ds_read_b64_tr_b16 v[114:115], v16 offset:28672
v_mfma_f32_16x16x32_bf16 v[200:203], v[56:59], v[36:39], 0
ds_read_b64_tr_b16 v[116:117], v17 offset:24576
v_mfma_f32_16x16x32_bf16 v[168:171], v[56:59], v[32:35], 0
ds_read_b64_tr_b16 v[118:119], v17 offset:28672
v_mfma_f32_16x16x32_bf16 v[136:139], v[56:59], v[28:31], 0
ds_read_b64_tr_b16 v[120:121], v18 offset:24576
v_mfma_f32_16x16x32_bf16 v[140:143], v[60:63], v[28:31], 0
ds_read_b64_tr_b16 v[122:123], v18 offset:28672
v_mfma_f32_16x16x32_bf16 v[172:175], v[60:63], v[32:35], 0
ds_read_b128 v[80:83], v9 offset:58368
v_mfma_f32_16x16x32_bf16 v[204:207], v[60:63], v[36:39], 0
ds_read_b128 v[84:87], v9 offset:59392
v_mfma_f32_16x16x32_bf16 v[236:239], v[60:63], v[40:43], 0
ds_read_b128 v[88:91], v9 offset:60416
v_mfma_f32_16x16x32_bf16 v[240:243], v[64:67], v[40:43], 0
v_mfma_f32_16x16x32_bf16 v[208:211], v[64:67], v[36:39], 0
v_mfma_f32_16x16x32_bf16 v[176:179], v[64:67], v[32:35], 0
v_mfma_f32_16x16x32_bf16 v[144:147], v[64:67], v[28:31], 0
v_mfma_f32_16x16x32_bf16 v[148:151], v[68:71], v[28:31], 0
v_mfma_f32_16x16x32_bf16 v[180:183], v[68:71], v[32:35], 0
v_mfma_f32_16x16x32_bf16 v[212:215], v[68:71], v[36:39], 0
v_mfma_f32_16x16x32_bf16 v[244:247], v[68:71], v[40:43], 0
v_mfma_f32_16x16x32_bf16 v[248:251], v[72:75], v[40:43], 0
v_mfma_f32_16x16x32_bf16 v[216:219], v[72:75], v[36:39], 0
s_branch Lov_15
.p2align 12
.fill 112, 4, 0xbf800000
Lst_15_0:
s_branch Lwr_174
s_nop 0
s_nop 0
Lov_15:
v_mfma_f32_16x16x32_bf16 v[184:187], v[72:75], v[32:35], 0
v_mfma_f32_16x16x32_bf16 v[152:155], v[72:75], v[28:31], 0
s_waitcnt vmcnt(0)
s_waitcnt lgkmcnt(0)
s_barrier
v_mfma_f32_16x16x32_bf16 v[124:127], v[92:95], v[76:79], v[124:127]
ds_read_b128 v[28:31], v10 offset:0
v_mfma_f32_16x16x32_bf16 v[156:159], v[92:95], v[80:83], v[156:159]
ds_read_b64_tr_b16 v[44:45], v19 offset:0
v_mfma_f32_16x16x32_bf16 v[188:191], v[92:95], v[84:87], v[188:191]
ds_read_b64_tr_b16 v[46:47], v19 offset:4096
v_mfma_f32_16x16x32_bf16 v[220:223], v[92:95], v[88:91], v[220:223]
ds_read_b64_tr_b16 v[48:49], v20 offset:0
v_mfma_f32_16x16x32_bf16 v[224:227], v[96:99], v[88:91], v[224:227]
ds_read_b64_tr_b16 v[50:51], v20 offset:4096
v_mfma_f32_16x16x32_bf16 v[192:195], v[96:99], v[84:87], v[192:195]
ds_read_b64_tr_b16 v[52:53], v21 offset:0
v_mfma_f32_16x16x32_bf16 v[160:163], v[96:99], v[80:83], v[160:163]
ds_read_b64_tr_b16 v[54:55], v21 offset:4096
v_mfma_f32_16x16x32_bf16 v[128:131], v[96:99], v[76:79], v[128:131]
ds_read_b64_tr_b16 v[56:57], v22 offset:0
v_mfma_f32_16x16x32_bf16 v[132:135], v[100:103], v[76:79], v[132:135]
ds_read_b64_tr_b16 v[58:59], v22 offset:4096
v_mfma_f32_16x16x32_bf16 v[164:167], v[100:103], v[80:83], v[164:167]
ds_read_b64_tr_b16 v[60:61], v19 offset:16384
v_mfma_f32_16x16x32_bf16 v[196:199], v[100:103], v[84:87], v[196:199]
ds_read_b64_tr_b16 v[62:63], v19 offset:20480
v_mfma_f32_16x16x32_bf16 v[228:231], v[100:103], v[88:91], v[228:231]
ds_read_b64_tr_b16 v[64:65], v20 offset:16384
v_mfma_f32_16x16x32_bf16 v[232:235], v[104:107], v[88:91], v[232:235]
ds_read_b64_tr_b16 v[66:67], v20 offset:20480
v_mfma_f32_16x16x32_bf16 v[200:203], v[104:107], v[84:87], v[200:203]
ds_read_b64_tr_b16 v[68:69], v21 offset:16384
v_mfma_f32_16x16x32_bf16 v[168:171], v[104:107], v[80:83], v[168:171]
ds_read_b64_tr_b16 v[70:71], v21 offset:20480
v_mfma_f32_16x16x32_bf16 v[136:139], v[104:107], v[76:79], v[136:139]
ds_read_b64_tr_b16 v[72:73], v22 offset:16384
v_mfma_f32_16x16x32_bf16 v[140:143], v[108:111], v[76:79], v[140:143]
ds_read_b64_tr_b16 v[74:75], v22 offset:20480
v_mfma_f32_16x16x32_bf16 v[172:175], v[108:111], v[80:83], v[172:175]
ds_read_b128 v[32:35], v10 offset:1024
v_mfma_f32_16x16x32_bf16 v[204:207], v[108:111], v[84:87], v[204:207]
ds_read_b128 v[36:39], v10 offset:2048
v_mfma_f32_16x16x32_bf16 v[236:239], v[108:111], v[88:91], v[236:239]
ds_read_b128 v[40:43], v10 offset:3072
v_mfma_f32_16x16x32_bf16 v[240:243], v[112:115], v[88:91], v[240:243]
v_mfma_f32_16x16x32_bf16 v[208:211], v[112:115], v[84:87], v[208:211]
v_mfma_f32_16x16x32_bf16 v[176:179], v[112:115], v[80:83], v[176:179]
v_mfma_f32_16x16x32_bf16 v[144:147], v[112:115], v[76:79], v[144:147]
v_mfma_f32_16x16x32_bf16 v[148:151], v[116:119], v[76:79], v[148:151]
v_mfma_f32_16x16x32_bf16 v[180:183], v[116:119], v[80:83], v[180:183]
v_mfma_f32_16x16x32_bf16 v[212:215], v[116:119], v[84:87], v[212:215]
v_mfma_f32_16x16x32_bf16 v[244:247], v[116:119], v[88:91], v[244:247]
v_mfma_f32_16x16x32_bf16 v[248:251], v[120:123], v[88:91], v[248:251]
v_mfma_f32_16x16x32_bf16 v[216:219], v[120:123], v[84:87], v[216:219]
v_mfma_f32_16x16x32_bf16 v[184:187], v[120:123], v[80:83], v[184:187]
v_mfma_f32_16x16x32_bf16 v[152:155], v[120:123], v[76:79], v[152:155]
s_mov_b32 s41, 5
Lk3l_142:
s_waitcnt lgkmcnt(0)
v_mfma_f32_16x16x32_bf16 v[124:127], v[44:47], v[28:31], v[124:127]
ds_read_b128 v[76:79], v10 offset:8192
v_mfma_f32_16x16x32_bf16 v[156:159], v[44:47], v[32:35], v[156:159]
ds_read_b64_tr_b16 v[92:93], v19 offset:8192
v_mfma_f32_16x16x32_bf16 v[188:191], v[44:47], v[36:39], v[188:191]
ds_read_b64_tr_b16 v[94:95], v19 offset:12288
v_mfma_f32_16x16x32_bf16 v[220:223], v[44:47], v[40:43], v[220:223]
ds_read_b64_tr_b16 v[96:97], v20 offset:8192
v_mfma_f32_16x16x32_bf16 v[224:227], v[48:51], v[40:43], v[224:227]
ds_read_b64_tr_b16 v[98:99], v20 offset:12288
v_mfma_f32_16x16x32_bf16 v[192:195], v[48:51], v[36:39], v[192:195]
ds_read_b64_tr_b16 v[100:101], v21 offset:8192
v_mfma_f32_16x16x32_bf16 v[160:163], v[48:51], v[32:35], v[160:163]
ds_read_b64_tr_b16 v[102:103], v21 offset:12288
v_mfma_f32_16x16x32_bf16 v[128:131], v[48:51], v[28:31], v[128:131]
ds_read_b64_tr_b16 v[104:105], v22 offset:8192
v_mfma_f32_16x16x32_bf16 v[132:135], v[52:55], v[28:31], v[132:135]
ds_read_b64_tr_b16 v[106:107], v22 offset:12288
v_mfma_f32_16x16x32_bf16 v[164:167], v[52:55], v[32:35], v[164:167]
ds_read_b64_tr_b16 v[108:109], v19 offset:24576
v_mfma_f32_16x16x32_bf16 v[196:199], v[52:55], v[36:39], v[196:199]
ds_read_b64_tr_b16 v[110:111], v19 offset:28672
v_mfma_f32_16x16x32_bf16 v[228:231], v[52:55], v[40:43], v[228:231]
ds_read_b64_tr_b16 v[112:113], v20 offset:24576
v_mfma_f32_16x16x32_bf16 v[232:235], v[56:59], v[40:43], v[232:235]
ds_read_b64_tr_b16 v[114:115], v20 offset:28672
v_mfma_f32_16x16x32_bf16 v[200:203], v[56:59], v[36:39], v[200:203]
ds_read_b64_tr_b16 v[116:117], v21 offset:24576
v_mfma_f32_16x16x32_bf16 v[168:171], v[56:59], v[32:35], v[168:171]
ds_read_b64_tr_b16 v[118:119], v21 offset:28672
v_mfma_f32_16x16x32_bf16 v[136:139], v[56:59], v[28:31], v[136:139]
ds_read_b64_tr_b16 v[120:121], v22 offset:24576
v_mfma_f32_16x16x32_bf16 v[140:143], v[60:63], v[28:31], v[140:143]
ds_read_b64_tr_b16 v[122:123], v22 offset:28672
v_mfma_f32_16x16x32_bf16 v[172:175], v[60:63], v[32:35], v[172:175]
ds_read_b128 v[80:83], v10 offset:9216
v_mfma_f32_16x16x32_bf16 v[204:207], v[60:63], v[36:39], v[204:207]
ds_read_b128 v[84:87], v10 offset:10240
v_mfma_f32_16x16x32_bf16 v[236:239], v[60:63], v[40:43], v[236:239]
ds_read_b128 v[88:91], v10 offset:11264
v_mfma_f32_16x16x32_bf16 v[240:243], v[64:67], v[40:43], v[240:243]
v_mfma_f32_16x16x32_bf16 v[208:211], v[64:67], v[36:39], v[208:211]
v_mfma_f32_16x16x32_bf16 v[176:179], v[64:67], v[32:35], v[176:179]
v_mfma_f32_16x16x32_bf16 v[144:147], v[64:67], v[28:31], v[144:147]
v_mfma_f32_16x16x32_bf16 v[148:151], v[68:71], v[28:31], v[148:151]
v_mfma_f32_16x16x32_bf16 v[180:183], v[68:71], v[32:35], v[180:183]
v_mfma_f32_16x16x32_bf16 v[212:215], v[68:71], v[36:39], v[212:215]
v_mfma_f32_16x16x32_bf16 v[244:247], v[68:71], v[40:43], v[244:247]
v_mfma_f32_16x16x32_bf16 v[248:251], v[72:75], v[40:43], v[248:251]
v_mfma_f32_16x16x32_bf16 v[216:219], v[72:75], v[36:39], v[216:219]
v_mfma_f32_16x16x32_bf16 v[184:187], v[72:75], v[32:35], v[184:187]
v_mfma_f32_16x16x32_bf16 v[152:155], v[72:75], v[28:31], v[152:155]
s_waitcnt lgkmcnt(0)
s_barrier
v_mfma_f32_16x16x32_bf16 v[124:127], v[92:95], v[76:79], v[124:127]
ds_read_b128 v[28:31], v9 offset:0
v_mfma_f32_16x16x32_bf16 v[156:159], v[92:95], v[80:83], v[156:159]
ds_read_b64_tr_b16 v[44:45], v11 offset:0
v_mfma_f32_16x16x32_bf16 v[188:191], v[92:95], v[84:87], v[188:191]
ds_read_b64_tr_b16 v[46:47], v11 offset:4096
v_mfma_f32_16x16x32_bf16 v[220:223], v[92:95], v[88:91], v[220:223]
ds_read_b64_tr_b16 v[48:49], v12 offset:0
v_mfma_f32_16x16x32_bf16 v[224:227], v[96:99], v[88:91], v[224:227]
ds_read_b64_tr_b16 v[50:51], v12 offset:4096
v_mfma_f32_16x16x32_bf16 v[192:195], v[96:99], v[84:87], v[192:195]
ds_read_b64_tr_b16 v[52:53], v13 offset:0
v_mfma_f32_16x16x32_bf16 v[160:163], v[96:99], v[80:83], v[160:163]
ds_read_b64_tr_b16 v[54:55], v13 offset:4096
v_mfma_f32_16x16x32_bf16 v[128:131], v[96:99], v[76:79], v[128:131]
ds_read_b64_tr_b16 v[56:57], v14 offset:0
v_mfma_f32_16x16x32_bf16 v[132:135], v[100:103], v[76:79], v[132:135]
ds_read_b64_tr_b16 v[58:59], v14 offset:4096
v_mfma_f32_16x16x32_bf16 v[164:167], v[100:103], v[80:83], v[164:167]
ds_read_b64_tr_b16 v[60:61], v11 offset:16384
v_mfma_f32_16x16x32_bf16 v[196:199], v[100:103], v[84:87], v[196:199]
ds_read_b64_tr_b16 v[62:63], v11 offset:20480
v_mfma_f32_16x16x32_bf16 v[228:231], v[100:103], v[88:91], v[228:231]
ds_read_b64_tr_b16 v[64:65], v12 offset:16384
v_mfma_f32_16x16x32_bf16 v[232:235], v[104:107], v[88:91], v[232:235]
ds_read_b64_tr_b16 v[66:67], v12 offset:20480
v_mfma_f32_16x16x32_bf16 v[200:203], v[104:107], v[84:87], v[200:203]
ds_read_b64_tr_b16 v[68:69], v13 offset:16384
v_mfma_f32_16x16x32_bf16 v[168:171], v[104:107], v[80:83], v[168:171]
ds_read_b64_tr_b16 v[70:71], v13 offset:20480
v_mfma_f32_16x16x32_bf16 v[136:139], v[104:107], v[76:79], v[136:139]
ds_read_b64_tr_b16 v[72:73], v14 offset:16384
v_mfma_f32_16x16x32_bf16 v[140:143], v[108:111], v[76:79], v[140:143]
ds_read_b64_tr_b16 v[74:75], v14 offset:20480
v_mfma_f32_16x16x32_bf16 v[172:175], v[108:111], v[80:83], v[172:175]
ds_read_b128 v[32:35], v9 offset:1024
v_mfma_f32_16x16x32_bf16 v[204:207], v[108:111], v[84:87], v[204:207]
ds_read_b128 v[36:39], v9 offset:2048
v_mfma_f32_16x16x32_bf16 v[236:239], v[108:111], v[88:91], v[236:239]
ds_read_b128 v[40:43], v9 offset:3072
v_mfma_f32_16x16x32_bf16 v[240:243], v[112:115], v[88:91], v[240:243]
v_mfma_f32_16x16x32_bf16 v[208:211], v[112:115], v[84:87], v[208:211]
v_mfma_f32_16x16x32_bf16 v[176:179], v[112:115], v[80:83], v[176:179]
v_mfma_f32_16x16x32_bf16 v[144:147], v[112:115], v[76:79], v[144:147]
v_mfma_f32_16x16x32_bf16 v[148:151], v[116:119], v[76:79], v[148:151]
v_mfma_f32_16x16x32_bf16 v[180:183], v[116:119], v[80:83], v[180:183]
v_mfma_f32_16x16x32_bf16 v[212:215], v[116:119], v[84:87], v[212:215]
v_mfma_f32_16x16x32_bf16 v[244:247], v[116:119], v[88:91], v[244:247]
v_mfma_f32_16x16x32_bf16 v[248:251], v[120:123], v[88:91], v[248:251]
v_mfma_f32_16x16x32_bf16 v[216:219], v[120:123], v[84:87], v[216:219]
v_mfma_f32_16x16x32_bf16 v[184:187], v[120:123], v[80:83], v[184:187]
v_mfma_f32_16x16x32_bf16 v[152:155], v[120:123], v[76:79], v[152:155]
s_waitcnt lgkmcnt(0)
v_mfma_f32_16x16x32_bf16 v[124:127], v[44:47], v[28:31], v[124:127]
ds_read_b128 v[76:79], v9 offset:8192
v_mfma_f32_16x16x32_bf16 v[156:159], v[44:47], v[32:35], v[156:159]
ds_read_b64_tr_b16 v[92:93], v11 offset:8192
v_mfma_f32_16x16x32_bf16 v[188:191], v[44:47], v[36:39], v[188:191]
ds_read_b64_tr_b16 v[94:95], v11 offset:12288
v_mfma_f32_16x16x32_bf16 v[220:223], v[44:47], v[40:43], v[220:223]
ds_read_b64_tr_b16 v[96:97], v12 offset:8192
v_mfma_f32_16x16x32_bf16 v[224:227], v[48:51], v[40:43], v[224:227]
ds_read_b64_tr_b16 v[98:99], v12 offset:12288
v_mfma_f32_16x16x32_bf16 v[192:195], v[48:51], v[36:39], v[192:195]
ds_read_b64_tr_b16 v[100:101], v13 offset:8192
v_mfma_f32_16x16x32_bf16 v[160:163], v[48:51], v[32:35], v[160:163]
ds_read_b64_tr_b16 v[102:103], v13 offset:12288
v_mfma_f32_16x16x32_bf16 v[128:131], v[48:51], v[28:31], v[128:131]
ds_read_b64_tr_b16 v[104:105], v14 offset:8192
v_mfma_f32_16x16x32_bf16 v[132:135], v[52:55], v[28:31], v[132:135]
ds_read_b64_tr_b16 v[106:107], v14 offset:12288
v_mfma_f32_16x16x32_bf16 v[164:167], v[52:55], v[32:35], v[164:167]
ds_read_b64_tr_b16 v[108:109], v11 offset:24576
v_mfma_f32_16x16x32_bf16 v[196:199], v[52:55], v[36:39], v[196:199]
ds_read_b64_tr_b16 v[110:111], v11 offset:28672
v_mfma_f32_16x16x32_bf16 v[228:231], v[52:55], v[40:43], v[228:231]
ds_read_b64_tr_b16 v[112:113], v12 offset:24576
v_mfma_f32_16x16x32_bf16 v[232:235], v[56:59], v[40:43], v[232:235]
ds_read_b64_tr_b16 v[114:115], v12 offset:28672
v_mfma_f32_16x16x32_bf16 v[200:203], v[56:59], v[36:39], v[200:203]
ds_read_b64_tr_b16 v[116:117], v13 offset:24576
v_mfma_f32_16x16x32_bf16 v[168:171], v[56:59], v[32:35], v[168:171]
ds_read_b64_tr_b16 v[118:119], v13 offset:28672
v_mfma_f32_16x16x32_bf16 v[136:139], v[56:59], v[28:31], v[136:139]
ds_read_b64_tr_b16 v[120:121], v14 offset:24576
v_mfma_f32_16x16x32_bf16 v[140:143], v[60:63], v[28:31], v[140:143]
ds_read_b64_tr_b16 v[122:123], v14 offset:28672
v_mfma_f32_16x16x32_bf16 v[172:175], v[60:63], v[32:35], v[172:175]
ds_read_b128 v[80:83], v9 offset:9216
v_mfma_f32_16x16x32_bf16 v[204:207], v[60:63], v[36:39], v[204:207]
ds_read_b128 v[84:87], v9 offset:10240
v_mfma_f32_16x16x32_bf16 v[236:239], v[60:63], v[40:43], v[236:239]
ds_read_b128 v[88:91], v9 offset:11264
v_mfma_f32_16x16x32_bf16 v[240:243], v[64:67], v[40:43], v[240:243]
v_mfma_f32_16x16x32_bf16 v[208:211], v[64:67], v[36:39], v[208:211]
v_mfma_f32_16x16x32_bf16 v[176:179], v[64:67], v[32:35], v[176:179]
v_mfma_f32_16x16x32_bf16 v[144:147], v[64:67], v[28:31], v[144:147]
v_mfma_f32_16x16x32_bf16 v[148:151], v[68:71], v[28:31], v[148:151]
v_mfma_f32_16x16x32_bf16 v[180:183], v[68:71], v[32:35], v[180:183]
v_mfma_f32_16x16x32_bf16 v[212:215], v[68:71], v[36:39], v[212:215]
v_mfma_f32_16x16x32_bf16 v[244:247], v[68:71], v[40:43], v[244:247]
v_mfma_f32_16x16x32_bf16 v[248:251], v[72:75], v[40:43], v[248:251]
v_mfma_f32_16x16x32_bf16 v[216:219], v[72:75], v[36:39], v[216:219]
v_mfma_f32_16x16x32_bf16 v[184:187], v[72:75], v[32:35], v[184:187]
v_mfma_f32_16x16x32_bf16 v[152:155], v[72:75], v[28:31], v[152:155]
s_waitcnt lgkmcnt(0)
s_barrier
v_mfma_f32_16x16x32_bf16 v[124:127], v[92:95], v[76:79], v[124:127]
ds_read_b128 v[28:31], v9 offset:49152
v_mfma_f32_16x16x32_bf16 v[156:159], v[92:95], v[80:83], v[156:159]
ds_read_b64_tr_b16 v[44:45], v15 offset:0
v_mfma_f32_16x16x32_bf16 v[188:191], v[92:95], v[84:87], v[188:191]
ds_read_b64_tr_b16 v[46:47], v15 offset:4096
v_mfma_f32_16x16x32_bf16 v[220:223], v[92:95], v[88:91], v[220:223]
ds_read_b64_tr_b16 v[48:49], v16 offset:0
v_mfma_f32_16x16x32_bf16 v[224:227], v[96:99], v[88:91], v[224:227]
ds_read_b64_tr_b16 v[50:51], v16 offset:4096
v_mfma_f32_16x16x32_bf16 v[192:195], v[96:99], v[84:87], v[192:195]
ds_read_b64_tr_b16 v[52:53], v17 offset:0
v_mfma_f32_16x16x32_bf16 v[160:163], v[96:99], v[80:83], v[160:163]
ds_read_b64_tr_b16 v[54:55], v17 offset:4096
v_mfma_f32_16x16x32_bf16 v[128:131], v[96:99], v[76:79], v[128:131]
ds_read_b64_tr_b16 v[56:57], v18 offset:0
v_mfma_f32_16x16x32_bf16 v[132:135], v[100:103], v[76:79], v[132:135]
ds_read_b64_tr_b16 v[58:59], v18 offset:4096
v_mfma_f32_16x16x32_bf16 v[164:167], v[100:103], v[80:83], v[164:167]
ds_read_b64_tr_b16 v[60:61], v15 offset:16384
v_mfma_f32_16x16x32_bf16 v[196:199], v[100:103], v[84:87], v[196:199]
ds_read_b64_tr_b16 v[62:63], v15 offset:20480
v_mfma_f32_16x16x32_bf16 v[228:231], v[100:103], v[88:91], v[228:231]
ds_read_b64_tr_b16 v[64:65], v16 offset:16384
v_mfma_f32_16x16x32_bf16 v[232:235], v[104:107], v[88:91], v[232:235]
ds_read_b64_tr_b16 v[66:67], v16 offset:20480
v_mfma_f32_16x16x32_bf16 v[200:203], v[104:107], v[84:87], v[200:203]
ds_read_b64_tr_b16 v[68:69], v17 offset:16384
v_mfma_f32_16x16x32_bf16 v[168:171], v[104:107], v[80:83], v[168:171]
ds_read_b64_tr_b16 v[70:71], v17 offset:20480
v_mfma_f32_16x16x32_bf16 v[136:139], v[104:107], v[76:79], v[136:139]
ds_read_b64_tr_b16 v[72:73], v18 offset:16384
v_mfma_f32_16x16x32_bf16 v[140:143], v[108:111], v[76:79], v[140:143]
ds_read_b64_tr_b16 v[74:75], v18 offset:20480
v_mfma_f32_16x16x32_bf16 v[172:175], v[108:111], v[80:83], v[172:175]
ds_read_b128 v[32:35], v9 offset:50176
v_mfma_f32_16x16x32_bf16 v[204:207], v[108:111], v[84:87], v[204:207]
ds_read_b128 v[36:39], v9 offset:51200
v_mfma_f32_16x16x32_bf16 v[236:239], v[108:111], v[88:91], v[236:239]
ds_read_b128 v[40:43], v9 offset:52224
v_mfma_f32_16x16x32_bf16 v[240:243], v[112:115], v[88:91], v[240:243]
v_mfma_f32_16x16x32_bf16 v[208:211], v[112:115], v[84:87], v[208:211]
v_mfma_f32_16x16x32_bf16 v[176:179], v[112:115], v[80:83], v[176:179]
v_mfma_f32_16x16x32_bf16 v[144:147], v[112:115], v[76:79], v[144:147]
v_mfma_f32_16x16x32_bf16 v[148:151], v[116:119], v[76:79], v[148:151]
v_mfma_f32_16x16x32_bf16 v[180:183], v[116:119], v[80:83], v[180:183]
v_mfma_f32_16x16x32_bf16 v[212:215], v[116:119], v[84:87], v[212:215]
v_mfma_f32_16x16x32_bf16 v[244:247], v[116:119], v[88:91], v[244:247]
v_mfma_f32_16x16x32_bf16 v[248:251], v[120:123], v[88:91], v[248:251]
v_mfma_f32_16x16x32_bf16 v[216:219], v[120:123], v[84:87], v[216:219]
v_mfma_f32_16x16x32_bf16 v[184:187], v[120:123], v[80:83], v[184:187]
v_mfma_f32_16x16x32_bf16 v[152:155], v[120:123], v[76:79], v[152:155]
s_waitcnt lgkmcnt(0)
v_mfma_f32_16x16x32_bf16 v[124:127], v[44:47], v[28:31], v[124:127]
ds_read_b128 v[76:79], v9 offset:57344
v_mfma_f32_16x16x32_bf16 v[156:159], v[44:47], v[32:35], v[156:159]
ds_read_b64_tr_b16 v[92:93], v15 offset:8192
v_mfma_f32_16x16x32_bf16 v[188:191], v[44:47], v[36:39], v[188:191]
ds_read_b64_tr_b16 v[94:95], v15 offset:12288
v_mfma_f32_16x16x32_bf16 v[220:223], v[44:47], v[40:43], v[220:223]
ds_read_b64_tr_b16 v[96:97], v16 offset:8192
v_mfma_f32_16x16x32_bf16 v[224:227], v[48:51], v[40:43], v[224:227]
ds_read_b64_tr_b16 v[98:99], v16 offset:12288
v_mfma_f32_16x16x32_bf16 v[192:195], v[48:51], v[36:39], v[192:195]
ds_read_b64_tr_b16 v[100:101], v17 offset:8192
v_mfma_f32_16x16x32_bf16 v[160:163], v[48:51], v[32:35], v[160:163]
ds_read_b64_tr_b16 v[102:103], v17 offset:12288
v_mfma_f32_16x16x32_bf16 v[128:131], v[48:51], v[28:31], v[128:131]
ds_read_b64_tr_b16 v[104:105], v18 offset:8192
v_mfma_f32_16x16x32_bf16 v[132:135], v[52:55], v[28:31], v[132:135]
ds_read_b64_tr_b16 v[106:107], v18 offset:12288
v_mfma_f32_16x16x32_bf16 v[164:167], v[52:55], v[32:35], v[164:167]
ds_read_b64_tr_b16 v[108:109], v15 offset:24576
v_mfma_f32_16x16x32_bf16 v[196:199], v[52:55], v[36:39], v[196:199]
ds_read_b64_tr_b16 v[110:111], v15 offset:28672
v_mfma_f32_16x16x32_bf16 v[228:231], v[52:55], v[40:43], v[228:231]
ds_read_b64_tr_b16 v[112:113], v16 offset:24576
v_mfma_f32_16x16x32_bf16 v[232:235], v[56:59], v[40:43], v[232:235]
ds_read_b64_tr_b16 v[114:115], v16 offset:28672
v_mfma_f32_16x16x32_bf16 v[200:203], v[56:59], v[36:39], v[200:203]
ds_read_b64_tr_b16 v[116:117], v17 offset:24576
v_mfma_f32_16x16x32_bf16 v[168:171], v[56:59], v[32:35], v[168:171]
ds_read_b64_tr_b16 v[118:119], v17 offset:28672
v_mfma_f32_16x16x32_bf16 v[136:139], v[56:59], v[28:31], v[136:139]
ds_read_b64_tr_b16 v[120:121], v18 offset:24576
v_mfma_f32_16x16x32_bf16 v[140:143], v[60:63], v[28:31], v[140:143]
ds_read_b64_tr_b16 v[122:123], v18 offset:28672
v_mfma_f32_16x16x32_bf16 v[172:175], v[60:63], v[32:35], v[172:175]
ds_read_b128 v[80:83], v9 offset:58368
v_mfma_f32_16x16x32_bf16 v[204:207], v[60:63], v[36:39], v[204:207]
ds_read_b128 v[84:87], v9 offset:59392
v_mfma_f32_16x16x32_bf16 v[236:239], v[60:63], v[40:43], v[236:239]
ds_read_b128 v[88:91], v9 offset:60416
v_mfma_f32_16x16x32_bf16 v[240:243], v[64:67], v[40:43], v[240:243]
v_mfma_f32_16x16x32_bf16 v[208:211], v[64:67], v[36:39], v[208:211]
v_mfma_f32_16x16x32_bf16 v[176:179], v[64:67], v[32:35], v[176:179]
v_mfma_f32_16x16x32_bf16 v[144:147], v[64:67], v[28:31], v[144:147]
v_mfma_f32_16x16x32_bf16 v[148:151], v[68:71], v[28:31], v[148:151]
v_mfma_f32_16x16x32_bf16 v[180:183], v[68:71], v[32:35], v[180:183]
v_mfma_f32_16x16x32_bf16 v[212:215], v[68:71], v[36:39], v[212:215]
v_mfma_f32_16x16x32_bf16 v[244:247], v[68:71], v[40:43], v[244:247]
v_mfma_f32_16x16x32_bf16 v[248:251], v[72:75], v[40:43], v[248:251]
v_mfma_f32_16x16x32_bf16 v[216:219], v[72:75], v[36:39], v[216:219]
v_mfma_f32_16x16x32_bf16 v[184:187], v[72:75], v[32:35], v[184:187]
v_mfma_f32_16x16x32_bf16 v[152:155], v[72:75], v[28:31], v[152:155]
s_waitcnt lgkmcnt(0)
s_barrier
v_mfma_f32_16x16x32_bf16 v[124:127], v[92:95], v[76:79], v[124:127]
ds_read_b128 v[28:31], v10 offset:0
v_mfma_f32_16x16x32_bf16 v[156:159], v[92:95], v[80:83], v[156:159]
ds_read_b64_tr_b16 v[44:45], v19 offset:0
v_mfma_f32_16x16x32_bf16 v[188:191], v[92:95], v[84:87], v[188:191]
ds_read_b64_tr_b16 v[46:47], v19 offset:4096
v_mfma_f32_16x16x32_bf16 v[220:223], v[92:95], v[88:91], v[220:223]
ds_read_b64_tr_b16 v[48:49], v20 offset:0
v_mfma_f32_16x16x32_bf16 v[224:227], v[96:99], v[88:91], v[224:227]
ds_read_b64_tr_b16 v[50:51], v20 offset:4096
v_mfma_f32_16x16x32_bf16 v[192:195], v[96:99], v[84:87], v[192:195]
ds_read_b64_tr_b16 v[52:53], v21 offset:0
v_mfma_f32_16x16x32_bf16 v[160:163], v[96:99], v[80:83], v[160:163]
ds_read_b64_tr_b16 v[54:55], v21 offset:4096
v_mfma_f32_16x16x32_bf16 v[128:131], v[96:99], v[76:79], v[128:131]
ds_read_b64_tr_b16 v[56:57], v22 offset:0
v_mfma_f32_16x16x32_bf16 v[132:135], v[100:103], v[76:79], v[132:135]
ds_read_b64_tr_b16 v[58:59], v22 offset:4096
v_mfma_f32_16x16x32_bf16 v[164:167], v[100:103], v[80:83], v[164:167]
ds_read_b64_tr_b16 v[60:61], v19 offset:16384
v_mfma_f32_16x16x32_bf16 v[196:199], v[100:103], v[84:87], v[196:199]
ds_read_b64_tr_b16 v[62:63], v19 offset:20480
v_mfma_f32_16x16x32_bf16 v[228:231], v[100:103], v[88:91], v[228:231]
ds_read_b64_tr_b16 v[64:65], v20 offset:16384
v_mfma_f32_16x16x32_bf16 v[232:235], v[104:107], v[88:91], v[232:235]
ds_read_b64_tr_b16 v[66:67], v20 offset:20480
v_mfma_f32_16x16x32_bf16 v[200:203], v[104:107], v[84:87], v[200:203]
ds_read_b64_tr_b16 v[68:69], v21 offset:16384
v_mfma_f32_16x16x32_bf16 v[168:171], v[104:107], v[80:83], v[168:171]
ds_read_b64_tr_b16 v[70:71], v21 offset:20480
v_mfma_f32_16x16x32_bf16 v[136:139], v[104:107], v[76:79], v[136:139]
ds_read_b64_tr_b16 v[72:73], v22 offset:16384
v_mfma_f32_16x16x32_bf16 v[140:143], v[108:111], v[76:79], v[140:143]
ds_read_b64_tr_b16 v[74:75], v22 offset:20480
v_mfma_f32_16x16x32_bf16 v[172:175], v[108:111], v[80:83], v[172:175]
ds_read_b128 v[32:35], v10 offset:1024
v_mfma_f32_16x16x32_bf16 v[204:207], v[108:111], v[84:87], v[204:207]
ds_read_b128 v[36:39], v10 offset:2048
v_mfma_f32_16x16x32_bf16 v[236:239], v[108:111], v[88:91], v[236:239]
ds_read_b128 v[40:43], v10 offset:3072
v_mfma_f32_16x16x32_bf16 v[240:243], v[112:115], v[88:91], v[240:243]
v_mfma_f32_16x16x32_bf16 v[208:211], v[112:115], v[84:87], v[208:211]
v_mfma_f32_16x16x32_bf16 v[176:179], v[112:115], v[80:83], v[176:179]
v_mfma_f32_16x16x32_bf16 v[144:147], v[112:115], v[76:79], v[144:147]
v_mfma_f32_16x16x32_bf16 v[148:151], v[116:119], v[76:79], v[148:151]
v_mfma_f32_16x16x32_bf16 v[180:183], v[116:119], v[80:83], v[180:183]
v_mfma_f32_16x16x32_bf16 v[212:215], v[116:119], v[84:87], v[212:215]
v_mfma_f32_16x16x32_bf16 v[244:247], v[116:119], v[88:91], v[244:247]
v_mfma_f32_16x16x32_bf16 v[248:251], v[120:123], v[88:91], v[248:251]
v_mfma_f32_16x16x32_bf16 v[216:219], v[120:123], v[84:87], v[216:219]
v_mfma_f32_16x16x32_bf16 v[184:187], v[120:123], v[80:83], v[184:187]
v_mfma_f32_16x16x32_bf16 v[152:155], v[120:123], v[76:79], v[152:155]
s_sub_u32 s41, s41, 1
s_cmp_lg_u32 s41, 0
s_cbranch_scc1 Lk3l_142
s_waitcnt lgkmcnt(0)
v_lshrrev_b32 v84, 4, v1
s_lshl_b32 s43, s63, 8
s_add_u32 s43, s43, 148480
v_lshl_add_u32 v85, v84, 4, s43
v_and_b32 v84, 15, v1
s_lshl_b32 s43, s62, 9
s_add_u32 s43, s43, 147456
v_lshl_add_u32 v84, v84, 3, s43
ds_read_b128 v[28:31], v85 offset:0
ds_read_b128 v[32:35], v85 offset:64
ds_read_b128 v[36:39], v85 offset:128
ds_read_b128 v[40:43], v85 offset:192
ds_read_b128 v[44:47], v85 offset:896
ds_read_b128 v[48:51], v85 offset:960
ds_read_b128 v[52:55], v85 offset:1024
ds_read_b128 v[56:59], v85 offset:1088
ds_read_b64 v[60:61], v84 offset:0
ds_read_b64 v[62:63], v84 offset:128
ds_read_b64 v[64:65], v84 offset:256
ds_read_b64 v[66:67], v84 offset:384
s_lshl_b32 s54, s35, 15
s_lshl_b32 s43, s63, 14
s_add_u32 s54, s54, s43
s_lshl_b32 s43, s62, 12
s_add_u32 s54, s54, s43
s_add_u32 s55, s54, 8192
v_lshrrev_b32 v122, 3, v1
v_and_b32 v123, 6, v122
v_and_b32 v25, 7, v1
v_xor_b32 v25, v25, v123
v_lshlrev_b32 v25, 4, v25
v_mul_u32_u24 v122, 2048, v122
v_add_u32 v25, v25, v122
s_lshl_b32 s43, s61, 7
s_lshl_b32 s44, s47, 15
s_add_u32 s43, s43, s44
v_add_u32 v25, s43, v25
s_waitcnt lgkmcnt(0)
v_mul_f32 v70, v61, v61
v_mul_f32 v68, 0xc0135761, v61
v_mul_f32 v69, 0xbdd2d3e8, v61
v_mul_f32 v69, v69, v70
v_rcp_f32 v70, v70
v_mul_f32 v74, v63, v63
v_mul_f32 v72, 0xc0135761, v63
v_mul_f32 v73, 0xbdd2d3e8, v63
v_mul_f32 v73, v73, v74
v_rcp_f32 v74, v74
v_pk_fma_f32 v[124:125], v[60:61], v[28:29], v[124:125] op_sel_hi:[0,1,1] neg_lo:[1,0,0] neg_hi:[1,0,0]
v_pk_fma_f32 v[126:127], v[60:61], v[30:31], v[126:127] op_sel_hi:[0,1,1] neg_lo:[1,0,0] neg_hi:[1,0,0]
v_pk_fma_f32 v[156:157], v[62:63], v[28:29], v[156:157] op_sel_hi:[0,1,1] neg_lo:[1,0,0] neg_hi:[1,0,0]
v_pk_fma_f32 v[158:159], v[62:63], v[30:31], v[158:159] op_sel_hi:[0,1,1] neg_lo:[1,0,0] neg_hi:[1,0,0]
v_pk_mul_f32 v[76:77], v[124:125], v[124:125]
v_pk_mul_f32 v[78:79], v[126:127], v[126:127]
v_pk_mul_f32 v[80:81], v[156:157], v[156:157]
v_pk_mul_f32 v[82:83], v[158:159], v[158:159]
v_pk_fma_f32 v[76:77], v[76:77], v[68:69], v[68:69] op_sel:[0,1,0] op_sel_hi:[1,1,0]
v_pk_fma_f32 v[78:79], v[78:79], v[68:69], v[68:69] op_sel:[0,1,0] op_sel_hi:[1,1,0]
v_pk_fma_f32 v[80:81], v[80:81], v[72:73], v[72:73] op_sel:[0,1,0] op_sel_hi:[1,1,0]
v_pk_fma_f32 v[82:83], v[82:83], v[72:73], v[72:73] op_sel:[0,1,0] op_sel_hi:[1,1,0]
v_pk_mul_f32 v[76:77], v[76:77], v[124:125]
v_pk_mul_f32 v[78:79], v[78:79], v[126:127]
v_pk_mul_f32 v[80:81], v[80:81], v[156:157]
v_pk_mul_f32 v[82:83], v[82:83], v[158:159]
v_exp_f32 v76, v76
v_exp_f32 v77, v77
v_exp_f32 v78, v78
v_exp_f32 v79, v79
v_exp_f32 v80, v80
v_exp_f32 v81, v81
v_exp_f32 v82, v82
v_exp_f32 v83, v83
v_pk_fma_f32 v[140:141], v[60:61], v[44:45], v[140:141] op_sel_hi:[0,1,1] neg_lo:[1,0,0] neg_hi:[1,0,0]
v_pk_fma_f32 v[142:143], v[60:61], v[46:47], v[142:143] op_sel_hi:[0,1,1] neg_lo:[1,0,0] neg_hi:[1,0,0]
v_pk_fma_f32 v[172:173], v[62:63], v[44:45], v[172:173] op_sel_hi:[0,1,1] neg_lo:[1,0,0] neg_hi:[1,0,0]
v_pk_fma_f32 v[174:175], v[62:63], v[46:47], v[174:175] op_sel_hi:[0,1,1] neg_lo:[1,0,0] neg_hi:[1,0,0]
v_pk_fma_f32 v[76:77], v[76:77], v[70:71], v[70:71] op_sel_hi:[1,0,0]
v_pk_fma_f32 v[78:79], v[78:79], v[70:71], v[70:71] op_sel_hi:[1,0,0]
v_pk_fma_f32 v[80:81], v[80:81], v[74:75], v[74:75] op_sel_hi:[1,0,0]
v_pk_fma_f32 v[82:83], v[82:83], v[74:75], v[74:75] op_sel_hi:[1,0,0]
v_rcp_f32 v76, v76
v_rcp_f32 v77, v77
v_rcp_f32 v78, v78
v_rcp_f32 v79, v79
v_rcp_f32 v80, v80
v_rcp_f32 v81, v81
v_rcp_f32 v82, v82
v_rcp_f32 v83, v83
v_pk_mul_f32 v[140:141], v[124:125], v[140:141]
v_pk_mul_f32 v[142:143], v[126:127], v[142:143]
v_pk_mul_f32 v[172:173], v[156:157], v[172:173]
v_pk_mul_f32 v[174:175], v[158:159], v[174:175]
v_pk_mul_f32 v[140:141], v[140:141], v[76:77]
v_pk_mul_f32 v[142:143], v[142:143], v[78:79]
v_pk_mul_f32 v[172:173], v[172:173], v[80:81]
v_pk_mul_f32 v[174:175], v[174:175], v[82:83]
v_cvt_pk_bf16_f32 v124, v140, v141
v_cvt_pk_bf16_f32 v125, v142, v143
v_cvt_pk_bf16_f32 v156, v172, v173
v_cvt_pk_bf16_f32 v157, v174, v175
s_branch Lov_16
.p2align 12
.fill 128, 4, 0xbf800000
Lst_16_0:
s_branch Lwr_175
s_nop 0
s_nop 0
Lov_16:
v_pk_fma_f32 v[128:129], v[60:61], v[32:33], v[128:129] op_sel_hi:[0,1,1] neg_lo:[1,0,0] neg_hi:[1,0,0]
v_pk_fma_f32 v[130:131], v[60:61], v[34:35], v[130:131] op_sel_hi:[0,1,1] neg_lo:[1,0,0] neg_hi:[1,0,0]
v_pk_fma_f32 v[160:161], v[62:63], v[32:33], v[160:161] op_sel_hi:[0,1,1] neg_lo:[1,0,0] neg_hi:[1,0,0]
v_pk_fma_f32 v[162:163], v[62:63], v[34:35], v[162:163] op_sel_hi:[0,1,1] neg_lo:[1,0,0] neg_hi:[1,0,0]
v_pk_mul_f32 v[76:77], v[128:129], v[128:129]
v_pk_mul_f32 v[78:79], v[130:131], v[130:131]
v_pk_mul_f32 v[80:81], v[160:161], v[160:161]
v_pk_mul_f32 v[82:83], v[162:163], v[162:163]
v_pk_fma_f32 v[76:77], v[76:77], v[68:69], v[68:69] op_sel:[0,1,0] op_sel_hi:[1,1,0]
v_pk_fma_f32 v[78:79], v[78:79], v[68:69], v[68:69] op_sel:[0,1,0] op_sel_hi:[1,1,0]
v_pk_fma_f32 v[80:81], v[80:81], v[72:73], v[72:73] op_sel:[0,1,0] op_sel_hi:[1,1,0]
v_pk_fma_f32 v[82:83], v[82:83], v[72:73], v[72:73] op_sel:[0,1,0] op_sel_hi:[1,1,0]
v_pk_mul_f32 v[76:77], v[76:77], v[128:129]
v_pk_mul_f32 v[78:79], v[78:79], v[130:131]
v_pk_mul_f32 v[80:81], v[80:81], v[160:161]
v_pk_mul_f32 v[82:83], v[82:83], v[162:163]
v_exp_f32 v76, v76
v_exp_f32 v77, v77
v_exp_f32 v78, v78
v_exp_f32 v79, v79
v_exp_f32 v80, v80
v_exp_f32 v81, v81
v_exp_f32 v82, v82
v_exp_f32 v83, v83
v_pk_fma_f32 v[144:145], v[60:61], v[48:49], v[144:145] op_sel_hi:[0,1,1] neg_lo:[1,0,0] neg_hi:[1,0,0]
v_pk_fma_f32 v[146:147], v[60:61], v[50:51], v[146:147] op_sel_hi:[0,1,1] neg_lo:[1,0,0] neg_hi:[1,0,0]
v_pk_fma_f32 v[176:177], v[62:63], v[48:49], v[176:177] op_sel_hi:[0,1,1] neg_lo:[1,0,0] neg_hi:[1,0,0]
v_pk_fma_f32 v[178:179], v[62:63], v[50:51], v[178:179] op_sel_hi:[0,1,1] neg_lo:[1,0,0] neg_hi:[1,0,0]
v_pk_fma_f32 v[76:77], v[76:77], v[70:71], v[70:71] op_sel_hi:[1,0,0]
v_pk_fma_f32 v[78:79], v[78:79], v[70:71], v[70:71] op_sel_hi:[1,0,0]
v_pk_fma_f32 v[80:81], v[80:81], v[74:75], v[74:75] op_sel_hi:[1,0,0]
v_pk_fma_f32 v[82:83], v[82:83], v[74:75], v[74:75] op_sel_hi:[1,0,0]
v_rcp_f32 v76, v76
v_rcp_f32 v77, v77
v_rcp_f32 v78, v78
v_rcp_f32 v79, v79
v_rcp_f32 v80, v80
v_rcp_f32 v81, v81
v_rcp_f32 v82, v82
v_rcp_f32 v83, v83
v_pk_mul_f32 v[144:145], v[128:129], v[144:145]
v_pk_mul_f32 v[146:147], v[130:131], v[146:147]
v_pk_mul_f32 v[176:177], v[160:161], v[176:177]
v_pk_mul_f32 v[178:179], v[162:163], v[178:179]
v_pk_mul_f32 v[144:145], v[144:145], v[76:77]
v_pk_mul_f32 v[146:147], v[146:147], v[78:79]
v_pk_mul_f32 v[176:177], v[176:177], v[80:81]
v_pk_mul_f32 v[178:179], v[178:179], v[82:83]
v_cvt_pk_bf16_f32 v126, v144, v145
v_cvt_pk_bf16_f32 v127, v146, v147
v_cvt_pk_bf16_f32 v158, v176, v177
v_cvt_pk_bf16_f32 v159, v178, v179
buffer_store_dwordx4 v[124:127], v2, s[24:27], s54 offen offset:0 sc1
buffer_store_dwordx4 v[156:159], v2, s[24:27], s54 offen offset:1024 sc1
v_pk_fma_f32 v[132:133], v[60:61], v[36:37], v[132:133] op_sel_hi:[0,1,1] neg_lo:[1,0,0] neg_hi:[1,0,0]
v_pk_fma_f32 v[134:135], v[60:61], v[38:39], v[134:135] op_sel_hi:[0,1,1] neg_lo:[1,0,0] neg_hi:[1,0,0]
v_pk_fma_f32 v[164:165], v[62:63], v[36:37], v[164:165] op_sel_hi:[0,1,1] neg_lo:[1,0,0] neg_hi:[1,0,0]
v_pk_fma_f32 v[166:167], v[62:63], v[38:39], v[166:167] op_sel_hi:[0,1,1] neg_lo:[1,0,0] neg_hi:[1,0,0]
v_pk_mul_f32 v[76:77], v[132:133], v[132:133]
v_pk_mul_f32 v[78:79], v[134:135], v[134:135]
v_pk_mul_f32 v[80:81], v[164:165], v[164:165]
v_pk_mul_f32 v[82:83], v[166:167], v[166:167]
v_pk_fma_f32 v[76:77], v[76:77], v[68:69], v[68:69] op_sel:[0,1,0] op_sel_hi:[1,1,0]
v_pk_fma_f32 v[78:79], v[78:79], v[68:69], v[68:69] op_sel:[0,1,0] op_sel_hi:[1,1,0]
v_pk_fma_f32 v[80:81], v[80:81], v[72:73], v[72:73] op_sel:[0,1,0] op_sel_hi:[1,1,0]
v_pk_fma_f32 v[82:83], v[82:83], v[72:73], v[72:73] op_sel:[0,1,0] op_sel_hi:[1,1,0]
v_pk_mul_f32 v[76:77], v[76:77], v[132:133]
v_pk_mul_f32 v[78:79], v[78:79], v[134:135]
v_pk_mul_f32 v[80:81], v[80:81], v[164:165]
v_pk_mul_f32 v[82:83], v[82:83], v[166:167]
v_exp_f32 v76, v76
v_exp_f32 v77, v77
v_exp_f32 v78, v78
v_exp_f32 v79, v79
v_exp_f32 v80, v80
v_exp_f32 v81, v81
v_exp_f32 v82, v82
v_exp_f32 v83, v83
v_pk_fma_f32 v[148:149], v[60:61], v[52:53], v[148:149] op_sel_hi:[0,1,1] neg_lo:[1,0,0] neg_hi:[1,0,0]
v_pk_fma_f32 v[150:151], v[60:61], v[54:55], v[150:151] op_sel_hi:[0,1,1] neg_lo:[1,0,0] neg_hi:[1,0,0]
v_pk_fma_f32 v[180:181], v[62:63], v[52:53], v[180:181] op_sel_hi:[0,1,1] neg_lo:[1,0,0] neg_hi:[1,0,0]
v_pk_fma_f32 v[182:183], v[62:63], v[54:55], v[182:183] op_sel_hi:[0,1,1] neg_lo:[1,0,0] neg_hi:[1,0,0]
v_pk_fma_f32 v[76:77], v[76:77], v[70:71], v[70:71] op_sel_hi:[1,0,0]
v_pk_fma_f32 v[78:79], v[78:79], v[70:71], v[70:71] op_sel_hi:[1,0,0]
v_pk_fma_f32 v[80:81], v[80:81], v[74:75], v[74:75] op_sel_hi:[1,0,0]
v_pk_fma_f32 v[82:83], v[82:83], v[74:75], v[74:75] op_sel_hi:[1,0,0]
v_rcp_f32 v76, v76
v_rcp_f32 v77, v77
v_rcp_f32 v78, v78
v_rcp_f32 v79, v79
v_rcp_f32 v80, v80
v_rcp_f32 v81, v81
v_rcp_f32 v82, v82
v_rcp_f32 v83, v83
v_pk_mul_f32 v[148:149], v[132:133], v[148:149]
v_pk_mul_f32 v[150:151], v[134:135], v[150:151]
v_pk_mul_f32 v[180:181], v[164:165], v[180:181]
v_pk_mul_f32 v[182:183], v[166:167], v[182:183]
v_pk_mul_f32 v[148:149], v[148:149], v[76:77]
v_pk_mul_f32 v[150:151], v[150:151], v[78:79]
v_pk_mul_f32 v[180:181], v[180:181], v[80:81]
v_pk_mul_f32 v[182:183], v[182:183], v[82:83]
v_cvt_pk_bf16_f32 v132, v148, v149
v_cvt_pk_bf16_f32 v133, v150, v151
v_cvt_pk_bf16_f32 v164, v180, v181
v_cvt_pk_bf16_f32 v165, v182, v183
v_pk_fma_f32 v[136:137], v[60:61], v[40:41], v[136:137] op_sel_hi:[0,1,1] neg_lo:[1,0,0] neg_hi:[1,0,0]
v_pk_fma_f32 v[138:139], v[60:61], v[42:43], v[138:139] op_sel_hi:[0,1,1] neg_lo:[1,0,0] neg_hi:[1,0,0]
v_pk_fma_f32 v[168:169], v[62:63], v[40:41], v[168:169] op_sel_hi:[0,1,1] neg_lo:[1,0,0] neg_hi:[1,0,0]
v_pk_fma_f32 v[170:171], v[62:63], v[42:43], v[170:171] op_sel_hi:[0,1,1] neg_lo:[1,0,0] neg_hi:[1,0,0]
v_pk_mul_f32 v[76:77], v[136:137], v[136:137]
v_pk_mul_f32 v[78:79], v[138:139], v[138:139]
v_pk_mul_f32 v[80:81], v[168:169], v[168:169]
v_pk_mul_f32 v[82:83], v[170:171], v[170:171]
v_pk_fma_f32 v[76:77], v[76:77], v[68:69], v[68:69] op_sel:[0,1,0] op_sel_hi:[1,1,0]
v_pk_fma_f32 v[78:79], v[78:79], v[68:69], v[68:69] op_sel:[0,1,0] op_sel_hi:[1,1,0]
v_pk_fma_f32 v[80:81], v[80:81], v[72:73], v[72:73] op_sel:[0,1,0] op_sel_hi:[1,1,0]
v_pk_fma_f32 v[82:83], v[82:83], v[72:73], v[72:73] op_sel:[0,1,0] op_sel_hi:[1,1,0]
v_pk_mul_f32 v[76:77], v[76:77], v[136:137]
v_pk_mul_f32 v[78:79], v[78:79], v[138:139]
v_pk_mul_f32 v[80:81], v[80:81], v[168:169]
v_pk_mul_f32 v[82:83], v[82:83], v[170:171]
v_exp_f32 v76, v76
v_exp_f32 v77, v77
v_exp_f32 v78, v78
v_exp_f32 v79, v79
v_exp_f32 v80, v80
v_exp_f32 v81, v81
v_exp_f32 v82, v82
v_exp_f32 v83, v83
v_pk_fma_f32 v[152:153], v[60:61], v[56:57], v[152:153] op_sel_hi:[0,1,1] neg_lo:[1,0,0] neg_hi:[1,0,0]
v_pk_fma_f32 v[154:155], v[60:61], v[58:59], v[154:155] op_sel_hi:[0,1,1] neg_lo:[1,0,0] neg_hi:[1,0,0]
v_pk_fma_f32 v[184:185], v[62:63], v[56:57], v[184:185] op_sel_hi:[0,1,1] neg_lo:[1,0,0] neg_hi:[1,0,0]
v_pk_fma_f32 v[186:187], v[62:63], v[58:59], v[186:187] op_sel_hi:[0,1,1] neg_lo:[1,0,0] neg_hi:[1,0,0]
v_pk_fma_f32 v[76:77], v[76:77], v[70:71], v[70:71] op_sel_hi:[1,0,0]
v_pk_fma_f32 v[78:79], v[78:79], v[70:71], v[70:71] op_sel_hi:[1,0,0]
v_pk_fma_f32 v[80:81], v[80:81], v[74:75], v[74:75] op_sel_hi:[1,0,0]
v_pk_fma_f32 v[82:83], v[82:83], v[74:75], v[74:75] op_sel_hi:[1,0,0]
v_rcp_f32 v76, v76
v_rcp_f32 v77, v77
v_rcp_f32 v78, v78
v_rcp_f32 v79, v79
v_rcp_f32 v80, v80
v_rcp_f32 v81, v81
v_rcp_f32 v82, v82
v_rcp_f32 v83, v83
v_pk_mul_f32 v[152:153], v[136:137], v[152:153]
v_pk_mul_f32 v[154:155], v[138:139], v[154:155]
v_pk_mul_f32 v[184:185], v[168:169], v[184:185]
v_pk_mul_f32 v[186:187], v[170:171], v[186:187]
v_pk_mul_f32 v[152:153], v[152:153], v[76:77]
v_pk_mul_f32 v[154:155], v[154:155], v[78:79]
v_pk_mul_f32 v[184:185], v[184:185], v[80:81]
v_pk_mul_f32 v[186:187], v[186:187], v[82:83]
v_cvt_pk_bf16_f32 v134, v152, v153
v_cvt_pk_bf16_f32 v135, v154, v155
v_cvt_pk_bf16_f32 v166, v184, v185
v_cvt_pk_bf16_f32 v167, v186, v187
buffer_store_dwordx4 v[132:135], v2, s[24:27], s55 offen offset:0 sc1
buffer_store_dwordx4 v[164:167], v2, s[24:27], s55 offen offset:1024 sc1
v_mul_f32 v70, v65, v65
v_mul_f32 v68, 0xc0135761, v65
v_mul_f32 v69, 0xbdd2d3e8, v65
v_mul_f32 v69, v69, v70
v_rcp_f32 v70, v70
v_mul_f32 v74, v67, v67
v_mul_f32 v72, 0xc0135761, v67
v_mul_f32 v73, 0xbdd2d3e8, v67
v_mul_f32 v73, v73, v74
v_rcp_f32 v74, v74
v_pk_fma_f32 v[188:189], v[64:65], v[28:29], v[188:189] op_sel_hi:[0,1,1] neg_lo:[1,0,0] neg_hi:[1,0,0]
v_pk_fma_f32 v[190:191], v[64:65], v[30:31], v[190:191] op_sel_hi:[0,1,1] neg_lo:[1,0,0] neg_hi:[1,0,0]
v_pk_fma_f32 v[220:221], v[66:67], v[28:29], v[220:221] op_sel_hi:[0,1,1] neg_lo:[1,0,0] neg_hi:[1,0,0]
v_pk_fma_f32 v[222:223], v[66:67], v[30:31], v[222:223] op_sel_hi:[0,1,1] neg_lo:[1,0,0] neg_hi:[1,0,0]
v_pk_mul_f32 v[76:77], v[188:189], v[188:189]
v_pk_mul_f32 v[78:79], v[190:191], v[190:191]
v_pk_mul_f32 v[80:81], v[220:221], v[220:221]
v_pk_mul_f32 v[82:83], v[222:223], v[222:223]
v_pk_fma_f32 v[76:77], v[76:77], v[68:69], v[68:69] op_sel:[0,1,0] op_sel_hi:[1,1,0]
v_pk_fma_f32 v[78:79], v[78:79], v[68:69], v[68:69] op_sel:[0,1,0] op_sel_hi:[1,1,0]
v_pk_fma_f32 v[80:81], v[80:81], v[72:73], v[72:73] op_sel:[0,1,0] op_sel_hi:[1,1,0]
v_pk_fma_f32 v[82:83], v[82:83], v[72:73], v[72:73] op_sel:[0,1,0] op_sel_hi:[1,1,0]
v_pk_mul_f32 v[76:77], v[76:77], v[188:189]
v_pk_mul_f32 v[78:79], v[78:79], v[190:191]
v_pk_mul_f32 v[80:81], v[80:81], v[220:221]
v_pk_mul_f32 v[82:83], v[82:83], v[222:223]
v_exp_f32 v76, v76
v_exp_f32 v77, v77
v_exp_f32 v78, v78
v_exp_f32 v79, v79
v_exp_f32 v80, v80
v_exp_f32 v81, v81
v_exp_f32 v82, v82
v_exp_f32 v83, v83
v_pk_fma_f32 v[204:205], v[64:65], v[44:45], v[204:205] op_sel_hi:[0,1,1] neg_lo:[1,0,0] neg_hi:[1,0,0]
v_pk_fma_f32 v[206:207], v[64:65], v[46:47], v[206:207] op_sel_hi:[0,1,1] neg_lo:[1,0,0] neg_hi:[1,0,0]
v_pk_fma_f32 v[236:237], v[66:67], v[44:45], v[236:237] op_sel_hi:[0,1,1] neg_lo:[1,0,0] neg_hi:[1,0,0]
v_pk_fma_f32 v[238:239], v[66:67], v[46:47], v[238:239] op_sel_hi:[0,1,1] neg_lo:[1,0,0] neg_hi:[1,0,0]
v_pk_fma_f32 v[76:77], v[76:77], v[70:71], v[70:71] op_sel_hi:[1,0,0]
v_pk_fma_f32 v[78:79], v[78:79], v[70:71], v[70:71] op_sel_hi:[1,0,0]
v_pk_fma_f32 v[80:81], v[80:81], v[74:75], v[74:75] op_sel_hi:[1,0,0]
v_pk_fma_f32 v[82:83], v[82:83], v[74:75], v[74:75] op_sel_hi:[1,0,0]
v_rcp_f32 v76, v76
v_rcp_f32 v77, v77
v_rcp_f32 v78, v78
v_rcp_f32 v79, v79
v_rcp_f32 v80, v80
v_rcp_f32 v81, v81
v_rcp_f32 v82, v82
v_rcp_f32 v83, v83
v_pk_mul_f32 v[204:205], v[188:189], v[204:205]
v_pk_mul_f32 v[206:207], v[190:191], v[206:207]
v_pk_mul_f32 v[236:237], v[220:221], v[236:237]
v_pk_mul_f32 v[238:239], v[222:223], v[238:239]
v_pk_mul_f32 v[204:205], v[204:205], v[76:77]
v_pk_mul_f32 v[206:207], v[206:207], v[78:79]
v_pk_mul_f32 v[236:237], v[236:237], v[80:81]
v_pk_mul_f32 v[238:239], v[238:239], v[82:83]
v_cvt_pk_bf16_f32 v188, v204, v205
v_cvt_pk_bf16_f32 v189, v206, v207
v_cvt_pk_bf16_f32 v220, v236, v237
v_cvt_pk_bf16_f32 v221, v238, v239
v_pk_fma_f32 v[192:193], v[64:65], v[32:33], v[192:193] op_sel_hi:[0,1,1] neg_lo:[1,0,0] neg_hi:[1,0,0]
v_pk_fma_f32 v[194:195], v[64:65], v[34:35], v[194:195] op_sel_hi:[0,1,1] neg_lo:[1,0,0] neg_hi:[1,0,0]
v_pk_fma_f32 v[224:225], v[66:67], v[32:33], v[224:225] op_sel_hi:[0,1,1] neg_lo:[1,0,0] neg_hi:[1,0,0]
v_pk_fma_f32 v[226:227], v[66:67], v[34:35], v[226:227] op_sel_hi:[0,1,1] neg_lo:[1,0,0] neg_hi:[1,0,0]
v_pk_mul_f32 v[76:77], v[192:193], v[192:193]
v_pk_mul_f32 v[78:79], v[194:195], v[194:195]
v_pk_mul_f32 v[80:81], v[224:225], v[224:225]
v_pk_mul_f32 v[82:83], v[226:227], v[226:227]
v_pk_fma_f32 v[76:77], v[76:77], v[68:69], v[68:69] op_sel:[0,1,0] op_sel_hi:[1,1,0]
v_pk_fma_f32 v[78:79], v[78:79], v[68:69], v[68:69] op_sel:[0,1,0] op_sel_hi:[1,1,0]
v_pk_fma_f32 v[80:81], v[80:81], v[72:73], v[72:73] op_sel:[0,1,0] op_sel_hi:[1,1,0]
v_pk_fma_f32 v[82:83], v[82:83], v[72:73], v[72:73] op_sel:[0,1,0] op_sel_hi:[1,1,0]
v_pk_mul_f32 v[76:77], v[76:77], v[192:193]
v_pk_mul_f32 v[78:79], v[78:79], v[194:195]
v_pk_mul_f32 v[80:81], v[80:81], v[224:225]
v_pk_mul_f32 v[82:83], v[82:83], v[226:227]
v_exp_f32 v76, v76
v_exp_f32 v77, v77
v_exp_f32 v78, v78
v_exp_f32 v79, v79
v_exp_f32 v80, v80
v_exp_f32 v81, v81
v_exp_f32 v82, v82
v_exp_f32 v83, v83
v_pk_fma_f32 v[208:209], v[64:65], v[48:49], v[208:209] op_sel_hi:[0,1,1] neg_lo:[1,0,0] neg_hi:[1,0,0]
v_pk_fma_f32 v[210:211], v[64:65], v[50:51], v[210:211] op_sel_hi:[0,1,1] neg_lo:[1,0,0] neg_hi:[1,0,0]
v_pk_fma_f32 v[240:241], v[66:67], v[48:49], v[240:241] op_sel_hi:[0,1,1] neg_lo:[1,0,0] neg_hi:[1,0,0]
v_pk_fma_f32 v[242:243], v[66:67], v[50:51], v[242:243] op_sel_hi:[0,1,1] neg_lo:[1,0,0] neg_hi:[1,0,0]
v_pk_fma_f32 v[76:77], v[76:77], v[70:71], v[70:71] op_sel_hi:[1,0,0]
v_pk_fma_f32 v[78:79], v[78:79], v[70:71], v[70:71] op_sel_hi:[1,0,0]
v_pk_fma_f32 v[80:81], v[80:81], v[74:75], v[74:75] op_sel_hi:[1,0,0]
v_pk_fma_f32 v[82:83], v[82:83], v[74:75], v[74:75] op_sel_hi:[1,0,0]
v_rcp_f32 v76, v76
v_rcp_f32 v77, v77
v_rcp_f32 v78, v78
v_rcp_f32 v79, v79
v_rcp_f32 v80, v80
v_rcp_f32 v81, v81
v_rcp_f32 v82, v82
v_rcp_f32 v83, v83
v_pk_mul_f32 v[208:209], v[192:193], v[208:209]
v_pk_mul_f32 v[210:211], v[194:195], v[210:211]
v_pk_mul_f32 v[240:241], v[224:225], v[240:241]
v_pk_mul_f32 v[242:243], v[226:227], v[242:243]
v_pk_mul_f32 v[208:209], v[208:209], v[76:77]
v_pk_mul_f32 v[210:211], v[210:211], v[78:79]
v_pk_mul_f32 v[240:241], v[240:241], v[80:81]
v_pk_mul_f32 v[242:243], v[242:243], v[82:83]
v_cvt_pk_bf16_f32 v190, v208, v209
v_cvt_pk_bf16_f32 v191, v210, v211
v_cvt_pk_bf16_f32 v222, v240, v241
v_cvt_pk_bf16_f32 v223, v242, v243
buffer_store_dwordx4 v[188:191], v2, s[24:27], s54 offen offset:2048 sc1
buffer_store_dwordx4 v[220:223], v2, s[24:27], s54 offen offset:3072 sc1
v_pk_fma_f32 v[196:197], v[64:65], v[36:37], v[196:197] op_sel_hi:[0,1,1] neg_lo:[1,0,0] neg_hi:[1,0,0]
v_pk_fma_f32 v[198:199], v[64:65], v[38:39], v[198:199] op_sel_hi:[0,1,1] neg_lo:[1,0,0] neg_hi:[1,0,0]
v_pk_fma_f32 v[228:229], v[66:67], v[36:37], v[228:229] op_sel_hi:[0,1,1] neg_lo:[1,0,0] neg_hi:[1,0,0]
v_pk_fma_f32 v[230:231], v[66:67], v[38:39], v[230:231] op_sel_hi:[0,1,1] neg_lo:[1,0,0] neg_hi:[1,0,0]
v_pk_mul_f32 v[76:77], v[196:197], v[196:197]
v_pk_mul_f32 v[78:79], v[198:199], v[198:199]
v_pk_mul_f32 v[80:81], v[228:229], v[228:229]
v_pk_mul_f32 v[82:83], v[230:231], v[230:231]
v_pk_fma_f32 v[76:77], v[76:77], v[68:69], v[68:69] op_sel:[0,1,0] op_sel_hi:[1,1,0]
v_pk_fma_f32 v[78:79], v[78:79], v[68:69], v[68:69] op_sel:[0,1,0] op_sel_hi:[1,1,0]
v_pk_fma_f32 v[80:81], v[80:81], v[72:73], v[72:73] op_sel:[0,1,0] op_sel_hi:[1,1,0]
v_pk_fma_f32 v[82:83], v[82:83], v[72:73], v[72:73] op_sel:[0,1,0] op_sel_hi:[1,1,0]
v_pk_mul_f32 v[76:77], v[76:77], v[196:197]
v_pk_mul_f32 v[78:79], v[78:79], v[198:199]
v_pk_mul_f32 v[80:81], v[80:81], v[228:229]
v_pk_mul_f32 v[82:83], v[82:83], v[230:231]
v_exp_f32 v76, v76
v_exp_f32 v77, v77
v_exp_f32 v78, v78
v_exp_f32 v79, v79
v_exp_f32 v80, v80
v_exp_f32 v81, v81
v_exp_f32 v82, v82
v_exp_f32 v83, v83
v_pk_fma_f32 v[212:213], v[64:65], v[52:53], v[212:213] op_sel_hi:[0,1,1] neg_lo:[1,0,0] neg_hi:[1,0,0]
v_pk_fma_f32 v[214:215], v[64:65], v[54:55], v[214:215] op_sel_hi:[0,1,1] neg_lo:[1,0,0] neg_hi:[1,0,0]
v_pk_fma_f32 v[244:245], v[66:67], v[52:53], v[244:245] op_sel_hi:[0,1,1] neg_lo:[1,0,0] neg_hi:[1,0,0]
v_pk_fma_f32 v[246:247], v[66:67], v[54:55], v[246:247] op_sel_hi:[0,1,1] neg_lo:[1,0,0] neg_hi:[1,0,0]
v_pk_fma_f32 v[76:77], v[76:77], v[70:71], v[70:71] op_sel_hi:[1,0,0]
v_pk_fma_f32 v[78:79], v[78:79], v[70:71], v[70:71] op_sel_hi:[1,0,0]
v_pk_fma_f32 v[80:81], v[80:81], v[74:75], v[74:75] op_sel_hi:[1,0,0]
v_pk_fma_f32 v[82:83], v[82:83], v[74:75], v[74:75] op_sel_hi:[1,0,0]
v_rcp_f32 v76, v76
v_rcp_f32 v77, v77
v_rcp_f32 v78, v78
v_rcp_f32 v79, v79
v_rcp_f32 v80, v80
v_rcp_f32 v81, v81
v_rcp_f32 v82, v82
v_rcp_f32 v83, v83
v_pk_mul_f32 v[212:213], v[196:197], v[212:213]
v_pk_mul_f32 v[214:215], v[198:199], v[214:215]
v_pk_mul_f32 v[244:245], v[228:229], v[244:245]
v_pk_mul_f32 v[246:247], v[230:231], v[246:247]
v_pk_mul_f32 v[212:213], v[212:213], v[76:77]
v_pk_mul_f32 v[214:215], v[214:215], v[78:79]
v_pk_mul_f32 v[244:245], v[244:245], v[80:81]
v_pk_mul_f32 v[246:247], v[246:247], v[82:83]
v_cvt_pk_bf16_f32 v196, v212, v213
v_cvt_pk_bf16_f32 v197, v214, v215
v_cvt_pk_bf16_f32 v228, v244, v245
v_cvt_pk_bf16_f32 v229, v246, v247
v_pk_fma_f32 v[200:201], v[64:65], v[40:41], v[200:201] op_sel_hi:[0,1,1] neg_lo:[1,0,0] neg_hi:[1,0,0]
v_pk_fma_f32 v[202:203], v[64:65], v[42:43], v[202:203] op_sel_hi:[0,1,1] neg_lo:[1,0,0] neg_hi:[1,0,0]
v_pk_fma_f32 v[232:233], v[66:67], v[40:41], v[232:233] op_sel_hi:[0,1,1] neg_lo:[1,0,0] neg_hi:[1,0,0]
v_pk_fma_f32 v[234:235], v[66:67], v[42:43], v[234:235] op_sel_hi:[0,1,1] neg_lo:[1,0,0] neg_hi:[1,0,0]
v_pk_mul_f32 v[76:77], v[200:201], v[200:201]
v_pk_mul_f32 v[78:79], v[202:203], v[202:203]
v_pk_mul_f32 v[80:81], v[232:233], v[232:233]
v_pk_mul_f32 v[82:83], v[234:235], v[234:235]
v_pk_fma_f32 v[76:77], v[76:77], v[68:69], v[68:69] op_sel:[0,1,0] op_sel_hi:[1,1,0]
v_pk_fma_f32 v[78:79], v[78:79], v[68:69], v[68:69] op_sel:[0,1,0] op_sel_hi:[1,1,0]
v_pk_fma_f32 v[80:81], v[80:81], v[72:73], v[72:73] op_sel:[0,1,0] op_sel_hi:[1,1,0]
v_pk_fma_f32 v[82:83], v[82:83], v[72:73], v[72:73] op_sel:[0,1,0] op_sel_hi:[1,1,0]
v_pk_mul_f32 v[76:77], v[76:77], v[200:201]
v_pk_mul_f32 v[78:79], v[78:79], v[202:203]
v_pk_mul_f32 v[80:81], v[80:81], v[232:233]
v_pk_mul_f32 v[82:83], v[82:83], v[234:235]
v_exp_f32 v76, v76
v_exp_f32 v77, v77
v_exp_f32 v78, v78
v_exp_f32 v79, v79
v_exp_f32 v80, v80
v_exp_f32 v81, v81
v_exp_f32 v82, v82
v_exp_f32 v83, v83
v_pk_fma_f32 v[216:217], v[64:65], v[56:57], v[216:217] op_sel_hi:[0,1,1] neg_lo:[1,0,0] neg_hi:[1,0,0]
v_pk_fma_f32 v[218:219], v[64:65], v[58:59], v[218:219] op_sel_hi:[0,1,1] neg_lo:[1,0,0] neg_hi:[1,0,0]
v_pk_fma_f32 v[248:249], v[66:67], v[56:57], v[248:249] op_sel_hi:[0,1,1] neg_lo:[1,0,0] neg_hi:[1,0,0]
v_pk_fma_f32 v[250:251], v[66:67], v[58:59], v[250:251] op_sel_hi:[0,1,1] neg_lo:[1,0,0] neg_hi:[1,0,0]
v_pk_fma_f32 v[76:77], v[76:77], v[70:71], v[70:71] op_sel_hi:[1,0,0]
v_pk_fma_f32 v[78:79], v[78:79], v[70:71], v[70:71] op_sel_hi:[1,0,0]
v_pk_fma_f32 v[80:81], v[80:81], v[74:75], v[74:75] op_sel_hi:[1,0,0]
v_pk_fma_f32 v[82:83], v[82:83], v[74:75], v[74:75] op_sel_hi:[1,0,0]
v_rcp_f32 v76, v76
v_rcp_f32 v77, v77
v_rcp_f32 v78, v78
v_rcp_f32 v79, v79
v_rcp_f32 v80, v80
v_rcp_f32 v81, v81
v_rcp_f32 v82, v82
v_rcp_f32 v83, v83
v_pk_mul_f32 v[216:217], v[200:201], v[216:217]
v_pk_mul_f32 v[218:219], v[202:203], v[218:219]
v_pk_mul_f32 v[248:249], v[232:233], v[248:249]
v_pk_mul_f32 v[250:251], v[234:235], v[250:251]
v_pk_mul_f32 v[216:217], v[216:217], v[76:77]
v_pk_mul_f32 v[218:219], v[218:219], v[78:79]
v_pk_mul_f32 v[248:249], v[248:249], v[80:81]
v_pk_mul_f32 v[250:251], v[250:251], v[82:83]
v_cvt_pk_bf16_f32 v198, v216, v217
v_cvt_pk_bf16_f32 v199, v218, v219
v_cvt_pk_bf16_f32 v230, v248, v249
v_cvt_pk_bf16_f32 v231, v250, v251
buffer_store_dwordx4 v[196:199], v2, s[24:27], s55 offen offset:2048 sc1
buffer_store_dwordx4 v[228:231], v2, s[24:27], s55 offen offset:3072 sc1
s_barrier
s_add_u32 s37, s52, 589824
s_add_u32 m0, s39, 81920
s_nop 0
buffer_load_dwordx4 v3, s[24:27], s37 offen sc1 lds
buffer_load_dwordx4 v3, s[24:27], s37 offen offset:1024 sc1 lds
buffer_load_dwordx4 v3, s[24:27], s37 offen offset:2048 sc1 lds
buffer_load_dwordx4 v3, s[24:27], s37 offen offset:3072 sc1 lds
s_add_u32 s38, s53, 4718592
s_add_u32 m0, s39, 147456
s_nop 0
buffer_load_dwordx4 v23, s[28:31], s38 offen lds
s_add_u32 m0, s39, 148480
s_nop 0
buffer_load_dwordx4 v24, s[28:31], s38 offen lds
s_add_u32 m0, s39, 149504
s_add_u32 s38, s38, 16384
buffer_load_dwordx4 v23, s[28:31], s38 offen lds
s_add_u32 m0, s39, 150528
s_nop 0
buffer_load_dwordx4 v24, s[28:31], s38 offen lds
s_add_u32 s37, s52, 606208
s_add_u32 m0, s39, 98304
s_nop 0
buffer_load_dwordx4 v3, s[24:27], s37 offen sc1 lds
buffer_load_dwordx4 v3, s[24:27], s37 offen offset:1024 sc1 lds
buffer_load_dwordx4 v3, s[24:27], s37 offen offset:2048 sc1 lds
buffer_load_dwordx4 v3, s[24:27], s37 offen offset:3072 sc1 lds
s_add_u32 s38, s53, 4849664
s_add_u32 m0, s39, 114688
s_nop 0
buffer_load_dwordx4 v23, s[28:31], s38 offen lds
s_add_u32 m0, s39, 115712
s_nop 0
buffer_load_dwordx4 v24, s[28:31], s38 offen lds
s_add_u32 m0, s39, 116736
s_add_u32 s38, s38, 16384
buffer_load_dwordx4 v23, s[28:31], s38 offen lds
s_add_u32 m0, s39, 117760
s_nop 0
buffer_load_dwordx4 v24, s[28:31], s38 offen lds
s_barrier
s_add_u32 s37, s52, 622592
s_add_u32 m0, s39, 131072
s_nop 0
buffer_load_dwordx4 v3, s[24:27], s37 offen sc1 lds
buffer_load_dwordx4 v3, s[24:27], s37 offen offset:1024 sc1 lds
buffer_load_dwordx4 v3, s[24:27], s37 offen offset:2048 sc1 lds
buffer_load_dwordx4 v3, s[24:27], s37 offen offset:3072 sc1 lds
s_add_u32 s38, s53, 4980736
s_add_u32 m0, s39, 0
s_nop 0
buffer_load_dwordx4 v23, s[28:31], s38 offen lds
s_add_u32 m0, s39, 1024
s_nop 0
buffer_load_dwordx4 v24, s[28:31], s38 offen lds
s_add_u32 m0, s39, 2048
s_add_u32 s38, s38, 16384
buffer_load_dwordx4 v23, s[28:31], s38 offen lds
s_add_u32 m0, s39, 3072
s_nop 0
buffer_load_dwordx4 v24, s[28:31], s38 offen lds
s_waitcnt vmcnt(24)
s_barrier
s_cmp_eq_u32 s47, 0
s_cbranch_scc0 Lw_143
s_add_u32 s7, s34, 48
s_lshl_b32 s7, s7, 7
v_mov_b32 v26, s7
v_mov_b32 v27, 1
s_mov_b64 exec, 1
buffer_atomic_add v27, v26, s[56:59], 0 offen sc1
s_mov_b64 exec, -1
Lw_143:
s_add_u32 s37, s52, 638976
s_add_u32 m0, s39, 16384
s_nop 0
buffer_load_dwordx4 v3, s[24:27], s37 offen sc1 lds
buffer_load_dwordx4 v3, s[24:27], s37 offen offset:1024 sc1 lds
buffer_load_dwordx4 v3, s[24:27], s37 offen offset:2048 sc1 lds
buffer_load_dwordx4 v3, s[24:27], s37 offen offset:3072 sc1 lds
s_add_u32 s38, s53, 5111808
s_add_u32 m0, s39, 32768
s_nop 0
buffer_load_dwordx4 v23, s[28:31], s38 offen lds
s_add_u32 m0, s39, 33792
s_nop 0
buffer_load_dwordx4 v24, s[28:31], s38 offen lds
s_add_u32 m0, s39, 34816
s_add_u32 s38, s38, 16384
buffer_load_dwordx4 v23, s[28:31], s38 offen lds
s_add_u32 m0, s39, 35840
s_nop 0
buffer_load_dwordx4 v24, s[28:31], s38 offen lds
s_waitcnt vmcnt(24)
s_barrier
s_add_u32 s37, s52, 655360
s_add_u32 m0, s39, 49152
s_nop 0
buffer_load_dwordx4 v3, s[24:27], s37 offen sc1 lds
buffer_load_dwordx4 v3, s[24:27], s37 offen offset:1024 sc1 lds
buffer_load_dwordx4 v3, s[24:27], s37 offen offset:2048 sc1 lds
buffer_load_dwordx4 v3, s[24:27], s37 offen offset:3072 sc1 lds
s_add_u32 s38, s53, 5242880
s_add_u32 m0, s39, 65536
s_nop 0
buffer_load_dwordx4 v23, s[28:31], s38 offen lds
s_add_u32 m0, s39, 66560
s_nop 0
buffer_load_dwordx4 v24, s[28:31], s38 offen lds
s_add_u32 m0, s39, 67584
s_add_u32 s38, s38, 16384
buffer_load_dwordx4 v23, s[28:31], s38 offen lds
s_add_u32 m0, s39, 68608
s_nop 0
buffer_load_dwordx4 v24, s[28:31], s38 offen lds
s_waitcnt vmcnt(24)
s_barrier
s_add_u32 s37, s52, 671744
s_add_u32 m0, s39, 81920
s_nop 0
buffer_load_dwordx4 v3, s[24:27], s37 offen sc1 lds
buffer_load_dwordx4 v3, s[24:27], s37 offen offset:1024 sc1 lds
buffer_load_dwordx4 v3, s[24:27], s37 offen offset:2048 sc1 lds
buffer_load_dwordx4 v3, s[24:27], s37 offen offset:3072 sc1 lds
s_add_u32 s38, s53, 5373952
s_add_u32 m0, s39, 147456
s_nop 0
buffer_load_dwordx4 v23, s[28:31], s38 offen lds
s_add_u32 m0, s39, 148480
s_nop 0
buffer_load_dwordx4 v24, s[28:31], s38 offen lds
s_add_u32 m0, s39, 149504
s_add_u32 s38, s38, 16384
buffer_load_dwordx4 v23, s[28:31], s38 offen lds
s_add_u32 m0, s39, 150528
s_nop 0
buffer_load_dwordx4 v24, s[28:31], s38 offen lds
s_waitcnt vmcnt(24)
s_barrier
s_add_u32 s37, s52, 688128
s_add_u32 m0, s39, 98304
s_nop 0
buffer_load_dwordx4 v3, s[24:27], s37 offen sc1 lds
buffer_load_dwordx4 v3, s[24:27], s37 offen offset:1024 sc1 lds
buffer_load_dwordx4 v3, s[24:27], s37 offen offset:2048 sc1 lds
s_branch Lov_17
.p2align 12
.fill 128, 4, 0xbf800000
Lst_17_0:
s_branch Lwr_176
s_nop 0
s_nop 0
Lov_17:
buffer_load_dwordx4 v3, s[24:27], s37 offen offset:3072 sc1 lds
s_add_u32 s38, s53, 5505024
s_add_u32 m0, s39, 114688
s_nop 0
buffer_load_dwordx4 v23, s[28:31], s38 offen lds
s_add_u32 m0, s39, 115712
s_nop 0
buffer_load_dwordx4 v24, s[28:31], s38 offen lds
s_add_u32 m0, s39, 116736
s_add_u32 s38, s38, 16384
buffer_load_dwordx4 v23, s[28:31], s38 offen lds
s_add_u32 m0, s39, 117760
s_nop 0
buffer_load_dwordx4 v24, s[28:31], s38 offen lds
s_waitcnt vmcnt(24)
s_barrier
s_cmp_eq_u32 s47, 3
s_cbranch_scc0 Lw_144
s_lshl_b32 s92, s34, 7
s_add_u32 s92, s92, 28317696
s_load_dword s93, s[82:83], s92 glc
Lw_144:
s_add_u32 s37, s52, 704512
s_add_u32 m0, s39, 131072
s_nop 0
buffer_load_dwordx4 v3, s[24:27], s37 offen sc1 lds
buffer_load_dwordx4 v3, s[24:27], s37 offen offset:1024 sc1 lds
buffer_load_dwordx4 v3, s[24:27], s37 offen offset:2048 sc1 lds
buffer_load_dwordx4 v3, s[24:27], s37 offen offset:3072 sc1 lds
s_add_u32 s38, s53, 5636096
s_add_u32 m0, s39, 0
s_nop 0
buffer_load_dwordx4 v23, s[28:31], s38 offen lds
s_add_u32 m0, s39, 1024
s_nop 0
buffer_load_dwordx4 v24, s[28:31], s38 offen lds
s_add_u32 m0, s39, 2048
s_add_u32 s38, s38, 16384
buffer_load_dwordx4 v23, s[28:31], s38 offen lds
s_add_u32 m0, s39, 3072
s_nop 0
buffer_load_dwordx4 v24, s[28:31], s38 offen lds
s_waitcnt vmcnt(24)
s_cmp_eq_u32 s47, 3
s_cbranch_scc0 Lw_145
s_mov_b32 s41, 0x40000
s_branch Lpchk_148
Lpoll_146:
s_load_dword s93, s[82:83], s92 glc
Lpchk_148:
s_waitcnt lgkmcnt(0)
s_cmp_eq_u32 s93, 16
s_cbranch_scc1 Lpok_147
s_sub_u32 s41, s41, 1
s_cmp_lg_u32 s41, 0
s_cbranch_scc1 Lpoll_146
Lpok_147:
Lw_145:
s_barrier
s_add_u32 s37, s90, 0
s_add_u32 m0, s39, 16384
s_nop 0
buffer_load_dwordx4 v3, s[24:27], s37 offen sc1 lds
buffer_load_dwordx4 v3, s[24:27], s37 offen offset:1024 sc1 lds
buffer_load_dwordx4 v3, s[24:27], s37 offen offset:2048 sc1 lds
buffer_load_dwordx4 v3, s[24:27], s37 offen offset:3072 sc1 lds
s_add_u32 s38, s91, 0
s_add_u32 m0, s39, 32768
s_nop 0
buffer_load_dwordx4 v23, s[28:31], s38 offen lds
s_add_u32 m0, s39, 33792
s_nop 0
buffer_load_dwordx4 v24, s[28:31], s38 offen lds
s_add_u32 m0, s39, 34816
s_add_u32 s38, s38, 16384
buffer_load_dwordx4 v23, s[28:31], s38 offen lds
s_add_u32 m0, s39, 35840
s_nop 0
buffer_load_dwordx4 v24, s[28:31], s38 offen lds
s_waitcnt vmcnt(24)
s_barrier
s_add_u32 s37, s90, 16384
s_add_u32 m0, s39, 49152
s_nop 0
buffer_load_dwordx4 v3, s[24:27], s37 offen sc1 lds
buffer_load_dwordx4 v3, s[24:27], s37 offen offset:1024 sc1 lds
buffer_load_dwordx4 v3, s[24:27], s37 offen offset:2048 sc1 lds
buffer_load_dwordx4 v3, s[24:27], s37 offen offset:3072 sc1 lds
s_add_u32 s38, s91, 131072
s_add_u32 m0, s39, 65536
s_nop 0
buffer_load_dwordx4 v23, s[28:31], s38 offen lds
s_add_u32 m0, s39, 66560
s_nop 0
buffer_load_dwordx4 v24, s[28:31], s38 offen lds
s_add_u32 m0, s39, 67584
s_add_u32 s38, s38, 16384
buffer_load_dwordx4 v23, s[28:31], s38 offen lds
s_add_u32 m0, s39, 68608
s_nop 0
buffer_load_dwordx4 v24, s[28:31], s38 offen lds
s_waitcnt vmcnt(24)
s_barrier
s_add_u32 s37, s90, 32768
s_add_u32 m0, s39, 81920
s_nop 0
buffer_load_dwordx4 v3, s[24:27], s37 offen sc1 lds
buffer_load_dwordx4 v3, s[24:27], s37 offen offset:1024 sc1 lds
buffer_load_dwordx4 v3, s[24:27], s37 offen offset:2048 sc1 lds
buffer_load_dwordx4 v3, s[24:27], s37 offen offset:3072 sc1 lds
s_add_u32 s38, s91, 262144
s_add_u32 m0, s39, 147456
s_nop 0
buffer_load_dwordx4 v23, s[28:31], s38 offen lds
s_add_u32 m0, s39, 148480
s_nop 0
buffer_load_dwordx4 v24, s[28:31], s38 offen lds
s_add_u32 m0, s39, 149504
s_add_u32 s38, s38, 16384
buffer_load_dwordx4 v23, s[28:31], s38 offen lds
s_add_u32 m0, s39, 150528
s_nop 0
buffer_load_dwordx4 v24, s[28:31], s38 offen lds
s_waitcnt vmcnt(24)
s_barrier
s_add_u32 s37, s90, 49152
s_add_u32 m0, s39, 98304
s_nop 0
buffer_load_dwordx4 v3, s[24:27], s37 offen sc1 lds
buffer_load_dwordx4 v3, s[24:27], s37 offen offset:1024 sc1 lds
buffer_load_dwordx4 v3, s[24:27], s37 offen offset:2048 sc1 lds
buffer_load_dwordx4 v3, s[24:27], s37 offen offset:3072 sc1 lds
s_add_u32 s38, s91, 393216
s_add_u32 m0, s39, 114688
s_nop 0
buffer_load_dwordx4 v23, s[28:31], s38 offen lds
s_add_u32 m0, s39, 115712
s_nop 0
buffer_load_dwordx4 v24, s[28:31], s38 offen lds
s_add_u32 m0, s39, 116736
s_add_u32 s38, s38, 16384
buffer_load_dwordx4 v23, s[28:31], s38 offen lds
s_add_u32 m0, s39, 117760
s_nop 0
buffer_load_dwordx4 v24, s[28:31], s38 offen lds
s_waitcnt vmcnt(24)
s_barrier
s_add_u32 s37, s90, 65536
s_add_u32 m0, s39, 131072
s_nop 0
buffer_load_dwordx4 v3, s[24:27], s37 offen sc1 lds
buffer_load_dwordx4 v3, s[24:27], s37 offen offset:1024 sc1 lds
buffer_load_dwordx4 v3, s[24:27], s37 offen offset:2048 sc1 lds
buffer_load_dwordx4 v3, s[24:27], s37 offen offset:3072 sc1 lds
s_add_u32 s38, s91, 524288
s_add_u32 m0, s39, 0
s_nop 0
buffer_load_dwordx4 v23, s[28:31], s38 offen lds
s_add_u32 m0, s39, 1024
s_nop 0
buffer_load_dwordx4 v24, s[28:31], s38 offen lds
s_add_u32 m0, s39, 2048
s_add_u32 s38, s38, 16384
buffer_load_dwordx4 v23, s[28:31], s38 offen lds
s_add_u32 m0, s39, 3072
s_nop 0
buffer_load_dwordx4 v24, s[28:31], s38 offen lds
s_waitcnt vmcnt(24)
s_barrier
s_add_u32 s37, s90, 81920
s_add_u32 m0, s39, 16384
s_nop 0
buffer_load_dwordx4 v3, s[24:27], s37 offen sc1 lds
buffer_load_dwordx4 v3, s[24:27], s37 offen offset:1024 sc1 lds
buffer_load_dwordx4 v3, s[24:27], s37 offen offset:2048 sc1 lds
buffer_load_dwordx4 v3, s[24:27], s37 offen offset:3072 sc1 lds
s_add_u32 s38, s91, 655360
s_add_u32 m0, s39, 32768
s_nop 0
buffer_load_dwordx4 v23, s[28:31], s38 offen lds
s_add_u32 m0, s39, 33792
s_nop 0
buffer_load_dwordx4 v24, s[28:31], s38 offen lds
s_add_u32 m0, s39, 34816
s_add_u32 s38, s38, 16384
buffer_load_dwordx4 v23, s[28:31], s38 offen lds
s_add_u32 m0, s39, 35840
s_nop 0
buffer_load_dwordx4 v24, s[28:31], s38 offen lds
s_waitcnt vmcnt(24)
s_barrier
s_add_u32 s37, s90, 98304
s_add_u32 m0, s39, 49152
s_nop 0
buffer_load_dwordx4 v3, s[24:27], s37 offen sc1 lds
buffer_load_dwordx4 v3, s[24:27], s37 offen offset:1024 sc1 lds
buffer_load_dwordx4 v3, s[24:27], s37 offen offset:2048 sc1 lds
buffer_load_dwordx4 v3, s[24:27], s37 offen offset:3072 sc1 lds
s_add_u32 s38, s91, 786432
s_add_u32 m0, s39, 65536
s_nop 0
buffer_load_dwordx4 v23, s[28:31], s38 offen lds
s_add_u32 m0, s39, 66560
s_nop 0
buffer_load_dwordx4 v24, s[28:31], s38 offen lds
s_add_u32 m0, s39, 67584
s_add_u32 s38, s38, 16384
buffer_load_dwordx4 v23, s[28:31], s38 offen lds
s_add_u32 m0, s39, 68608
s_nop 0
buffer_load_dwordx4 v24, s[28:31], s38 offen lds
s_waitcnt vmcnt(24)
s_barrier
s_add_u32 s37, s90, 114688
s_add_u32 m0, s39, 81920
s_nop 0
buffer_load_dwordx4 v3, s[24:27], s37 offen sc1 lds
buffer_load_dwordx4 v3, s[24:27], s37 offen offset:1024 sc1 lds
buffer_load_dwordx4 v3, s[24:27], s37 offen offset:2048 sc1 lds
buffer_load_dwordx4 v3, s[24:27], s37 offen offset:3072 sc1 lds
s_add_u32 s38, s91, 917504
s_add_u32 m0, s39, 147456
s_nop 0
buffer_load_dwordx4 v23, s[28:31], s38 offen lds
s_add_u32 m0, s39, 148480
s_nop 0
buffer_load_dwordx4 v24, s[28:31], s38 offen lds
s_add_u32 m0, s39, 149504
s_add_u32 s38, s38, 16384
buffer_load_dwordx4 v23, s[28:31], s38 offen lds
s_add_u32 m0, s39, 150528
s_nop 0
buffer_load_dwordx4 v24, s[28:31], s38 offen lds
s_waitcnt vmcnt(24)
s_barrier
s_add_u32 s37, s90, 131072
s_add_u32 m0, s39, 98304
s_nop 0
buffer_load_dwordx4 v3, s[24:27], s37 offen sc1 lds
buffer_load_dwordx4 v3, s[24:27], s37 offen offset:1024 sc1 lds
buffer_load_dwordx4 v3, s[24:27], s37 offen offset:2048 sc1 lds
buffer_load_dwordx4 v3, s[24:27], s37 offen offset:3072 sc1 lds
s_add_u32 s38, s91, 1048576
s_add_u32 m0, s39, 114688
s_nop 0
buffer_load_dwordx4 v23, s[28:31], s38 offen lds
s_add_u32 m0, s39, 115712
s_nop 0
buffer_load_dwordx4 v24, s[28:31], s38 offen lds
s_add_u32 m0, s39, 116736
s_add_u32 s38, s38, 16384
buffer_load_dwordx4 v23, s[28:31], s38 offen lds
s_add_u32 m0, s39, 117760
s_nop 0
buffer_load_dwordx4 v24, s[28:31], s38 offen lds
s_waitcnt vmcnt(24)
s_barrier
s_add_u32 s37, s90, 147456
s_add_u32 m0, s39, 131072
s_nop 0
buffer_load_dwordx4 v3, s[24:27], s37 offen sc1 lds
buffer_load_dwordx4 v3, s[24:27], s37 offen offset:1024 sc1 lds
buffer_load_dwordx4 v3, s[24:27], s37 offen offset:2048 sc1 lds
buffer_load_dwordx4 v3, s[24:27], s37 offen offset:3072 sc1 lds
s_add_u32 s38, s91, 1179648
s_add_u32 m0, s39, 0
s_nop 0
buffer_load_dwordx4 v23, s[28:31], s38 offen lds
s_add_u32 m0, s39, 1024
s_nop 0
buffer_load_dwordx4 v24, s[28:31], s38 offen lds
s_add_u32 m0, s39, 2048
s_add_u32 s38, s38, 16384
buffer_load_dwordx4 v23, s[28:31], s38 offen lds
s_add_u32 m0, s39, 3072
s_nop 0
buffer_load_dwordx4 v24, s[28:31], s38 offen lds
s_waitcnt vmcnt(24)
s_barrier
s_mov_b32 s37, 327680
s_add_u32 m0, s39, 16384
s_nop 0
buffer_load_dwordx4 v3, s[24:27], s37 offen sc1 lds
buffer_load_dwordx4 v3, s[24:27], s37 offen offset:1024 sc1 lds
buffer_load_dwordx4 v3, s[24:27], s37 offen offset:2048 sc1 lds
buffer_load_dwordx4 v3, s[24:27], s37 offen offset:3072 sc1 lds
s_mov_b32 s38, 2621440
s_add_u32 m0, s51, 32768
s_nop 0
buffer_load_dwordx4 v25, s[28:31], s38 offen lds
s_add_u32 m0, s51, 33792
s_add_u32 s38, s38, 16384
buffer_load_dwordx4 v25, s[28:31], s38 offen lds
s_waitcnt vmcnt(22)
s_barrier
s_mov_b32 s37, 344064
s_add_u32 m0, s39, 49152
s_nop 0
buffer_load_dwordx4 v3, s[24:27], s37 offen sc1 lds
buffer_load_dwordx4 v3, s[24:27], s37 offen offset:1024 sc1 lds
buffer_load_dwordx4 v3, s[24:27], s37 offen offset:2048 sc1 lds
buffer_load_dwordx4 v3, s[24:27], s37 offen offset:3072 sc1 lds
s_mov_b32 s38, 2752512
s_add_u32 m0, s51, 65536
s_nop 0
buffer_load_dwordx4 v25, s[28:31], s38 offen lds
s_add_u32 m0, s51, 66560
s_add_u32 s38, s38, 16384
buffer_load_dwordx4 v25, s[28:31], s38 offen lds
s_waitcnt vmcnt(20)
s_barrier
s_mov_b32 s37, 360448
s_add_u32 m0, s39, 81920
s_nop 0
buffer_load_dwordx4 v3, s[24:27], s37 offen sc1 lds
buffer_load_dwordx4 v3, s[24:27], s37 offen offset:1024 sc1 lds
buffer_load_dwordx4 v3, s[24:27], s37 offen offset:2048 sc1 lds
buffer_load_dwordx4 v3, s[24:27], s37 offen offset:3072 sc1 lds
s_mov_b32 s38, 2883584
s_add_u32 m0, s51, 147456
s_nop 0
buffer_load_dwordx4 v25, s[28:31], s38 offen lds
s_add_u32 m0, s51, 148480
s_add_u32 s38, s38, 16384
buffer_load_dwordx4 v25, s[28:31], s38 offen lds
s_waitcnt vmcnt(18)
s_barrier
s_mov_b32 s37, 376832
s_add_u32 m0, s39, 98304
s_nop 0
buffer_load_dwordx4 v3, s[24:27], s37 offen sc1 lds
buffer_load_dwordx4 v3, s[24:27], s37 offen offset:1024 sc1 lds
buffer_load_dwordx4 v3, s[24:27], s37 offen offset:2048 sc1 lds
buffer_load_dwordx4 v3, s[24:27], s37 offen offset:3072 sc1 lds
s_mov_b32 s38, 3014656
s_add_u32 m0, s51, 114688
s_nop 0
buffer_load_dwordx4 v25, s[28:31], s38 offen lds
s_add_u32 m0, s51, 115712
s_add_u32 s38, s38, 16384
buffer_load_dwordx4 v25, s[28:31], s38 offen lds
s_waitcnt vmcnt(18)
s_barrier
s_mov_b32 s37, 393216
s_add_u32 m0, s39, 131072
s_nop 0
buffer_load_dwordx4 v3, s[24:27], s37 offen sc1 lds
buffer_load_dwordx4 v3, s[24:27], s37 offen offset:1024 sc1 lds
buffer_load_dwordx4 v3, s[24:27], s37 offen offset:2048 sc1 lds
buffer_load_dwordx4 v3, s[24:27], s37 offen offset:3072 sc1 lds
s_mov_b32 s38, 3145728
s_add_u32 m0, s51, 0
s_nop 0
buffer_load_dwordx4 v25, s[28:31], s38 offen lds
s_add_u32 m0, s51, 1024
s_add_u32 s38, s38, 16384
buffer_load_dwordx4 v25, s[28:31], s38 offen lds
s_waitcnt vmcnt(18)
s_barrier
s_mov_b32 s37, 409600
s_add_u32 m0, s39, 16384
s_nop 0
buffer_load_dwordx4 v3, s[24:27], s37 offen sc1 lds
buffer_load_dwordx4 v3, s[24:27], s37 offen offset:1024 sc1 lds
buffer_load_dwordx4 v3, s[24:27], s37 offen offset:2048 sc1 lds
buffer_load_dwordx4 v3, s[24:27], s37 offen offset:3072 sc1 lds
s_mov_b32 s38, 3276800
s_add_u32 m0, s51, 32768
s_nop 0
buffer_load_dwordx4 v25, s[28:31], s38 offen lds
s_add_u32 m0, s51, 33792
s_add_u32 s38, s38, 16384
buffer_load_dwordx4 v25, s[28:31], s38 offen lds
s_waitcnt vmcnt(18)
s_barrier
s_mov_b32 s37, 425984
s_add_u32 m0, s39, 49152
s_nop 0
buffer_load_dwordx4 v3, s[24:27], s37 offen sc1 lds
buffer_load_dwordx4 v3, s[24:27], s37 offen offset:1024 sc1 lds
buffer_load_dwordx4 v3, s[24:27], s37 offen offset:2048 sc1 lds
buffer_load_dwordx4 v3, s[24:27], s37 offen offset:3072 sc1 lds
s_mov_b32 s38, 3407872
s_add_u32 m0, s51, 65536
s_nop 0
buffer_load_dwordx4 v25, s[28:31], s38 offen lds
s_add_u32 m0, s51, 66560
s_add_u32 s38, s38, 16384
buffer_load_dwordx4 v25, s[28:31], s38 offen lds
s_waitcnt vmcnt(18)
s_barrier
s_mov_b32 s37, 442368
s_add_u32 m0, s39, 81920
s_nop 0
buffer_load_dwordx4 v3, s[24:27], s37 offen sc1 lds
buffer_load_dwordx4 v3, s[24:27], s37 offen offset:1024 sc1 lds
buffer_load_dwordx4 v3, s[24:27], s37 offen offset:2048 sc1 lds
buffer_load_dwordx4 v3, s[24:27], s37 offen offset:3072 sc1 lds
s_mov_b32 s38, 3538944
s_add_u32 m0, s51, 147456
s_nop 0
buffer_load_dwordx4 v25, s[28:31], s38 offen lds
s_add_u32 m0, s51, 148480
s_add_u32 s38, s38, 16384
buffer_load_dwordx4 v25, s[28:31], s38 offen lds
s_waitcnt vmcnt(18)
s_barrier
s_mov_b32 s37, 458752
s_add_u32 m0, s39, 98304
s_nop 0
buffer_load_dwordx4 v3, s[24:27], s37 offen sc1 lds
buffer_load_dwordx4 v3, s[24:27], s37 offen offset:1024 sc1 lds
buffer_load_dwordx4 v3, s[24:27], s37 offen offset:2048 sc1 lds
buffer_load_dwordx4 v3, s[24:27], s37 offen offset:3072 sc1 lds
s_mov_b32 s38, 3670016
s_add_u32 m0, s51, 114688
s_nop 0
buffer_load_dwordx4 v25, s[28:31], s38 offen lds
s_add_u32 m0, s51, 115712
s_add_u32 s38, s38, 16384
buffer_load_dwordx4 v25, s[28:31], s38 offen lds
s_waitcnt vmcnt(18)
s_barrier
s_mov_b32 s37, 475136
s_add_u32 m0, s39, 131072
s_nop 0
buffer_load_dwordx4 v3, s[24:27], s37 offen sc1 lds
buffer_load_dwordx4 v3, s[24:27], s37 offen offset:1024 sc1 lds
buffer_load_dwordx4 v3, s[24:27], s37 offen offset:2048 sc1 lds
buffer_load_dwordx4 v3, s[24:27], s37 offen offset:3072 sc1 lds
s_mov_b32 s38, 3801088
s_add_u32 m0, s51, 0
s_nop 0
buffer_load_dwordx4 v25, s[28:31], s38 offen lds
s_add_u32 m0, s51, 1024
s_add_u32 s38, s38, 16384
buffer_load_dwordx4 v25, s[28:31], s38 offen lds
s_waitcnt vmcnt(18)
s_barrier
s_cmp_eq_u32 s47, 0
s_cbranch_scc0 Lw_149
s_xor_b32 s43, s2, 2
s_add_u32 s43, s43, 128
s_lshl_b32 s43, s43, 7
v_mov_b32 v26, s43
v_mov_b32 v27, 1
s_mov_b64 exec, 1
buffer_store_dword v27, v26, s[56:59], 0 offen sc1
s_mov_b64 exec, -1
Lw_149:
s_mov_b32 s37, 491520
s_add_u32 m0, s39, 16384
s_nop 0
buffer_load_dwordx4 v3, s[24:27], s37 offen sc1 lds
buffer_load_dwordx4 v3, s[24:27], s37 offen offset:1024 sc1 lds
buffer_load_dwordx4 v3, s[24:27], s37 offen offset:2048 sc1 lds
buffer_load_dwordx4 v3, s[24:27], s37 offen offset:3072 sc1 lds
s_mov_b32 s38, 3932160
s_add_u32 m0, s51, 32768
s_nop 0
buffer_load_dwordx4 v25, s[28:31], s38 offen lds
s_add_u32 m0, s51, 33792
s_add_u32 s38, s38, 16384
buffer_load_dwordx4 v25, s[28:31], s38 offen lds
s_waitcnt vmcnt(18)
s_barrier
s_mov_b32 s37, 507904
s_add_u32 m0, s39, 49152
s_nop 0
buffer_load_dwordx4 v3, s[24:27], s37 offen sc1 lds
buffer_load_dwordx4 v3, s[24:27], s37 offen offset:1024 sc1 lds
buffer_load_dwordx4 v3, s[24:27], s37 offen offset:2048 sc1 lds
buffer_load_dwordx4 v3, s[24:27], s37 offen offset:3072 sc1 lds
s_mov_b32 s38, 4063232
s_add_u32 m0, s51, 65536
s_nop 0
buffer_load_dwordx4 v25, s[28:31], s38 offen lds
s_add_u32 m0, s51, 66560
s_add_u32 s38, s38, 16384
buffer_load_dwordx4 v25, s[28:31], s38 offen lds
s_waitcnt vmcnt(18)
s_barrier
s_cmp_eq_u32 s47, 3
s_cbranch_scc0 Lw_150
s_lshl_b32 s92, s2, 7
s_add_u32 s92, s92, 28327936
s_load_dword s93, s[82:83], s92 glc
Lw_150:
s_waitcnt vmcnt(12)
s_cmp_eq_u32 s47, 3
s_cbranch_scc0 Lw_151
s_mov_b32 s41, 0x40000
s_branch Lpchk_154
Lpoll_152:
s_load_dword s93, s[82:83], s92 glc
Lpchk_154:
s_waitcnt lgkmcnt(0)
s_cmp_eq_u32 s93, 1
s_cbranch_scc1 Lpok_153
s_sub_u32 s41, s41, 1
s_cmp_lg_u32 s41, 0
s_cbranch_scc1 Lpoll_152
Lpok_153:
Lw_151:
s_barrier
s_waitcnt vmcnt(6)
s_barrier
s_waitcnt vmcnt(0)
s_barrier
s_barrier
s_branch Ldone_1
Ldone_1:
Lfin:
Lexit_2:
s_endpgm
.fill 2304, 4, 0xbf800000
.section .rodata,"a"
.p2align 6
.amdhsa_kernel sequential_preLN__sliding_local_dilated__glu_gated_geglu__prompt_kernel
  .amdhsa_next_free_vgpr 256
  .amdhsa_next_free_sgpr 102
  .amdhsa_accum_offset 256
  .amdhsa_group_segment_fixed_size 0
  .amdhsa_kernarg_size 80
  .amdhsa_user_sgpr_count 2
  .amdhsa_user_sgpr_kernarg_segment_ptr 1
  .amdhsa_system_sgpr_workgroup_id_x 1
  .amdhsa_float_denorm_mode_32 3
  .amdhsa_float_denorm_mode_16_64 3
.end_amdhsa_kernel
```

```asm
; @launch grid=(256,1,1) block=(512,1,1) lds=163840
.amdgcn_target "amdgcn-amd-amdhsa--gfx950"
.text
.globl sequential_preLN__sliding_local_dilated__glu_gated_geglu__prompt_kernel
.p2align 8
.type sequential_preLN__sliding_local_dilated__glu_gated_geglu__prompt_kernel,@function
sequential_preLN__sliding_local_dilated__glu_gated_geglu__prompt_kernel:
s_cmp_ge_u32 s2, 256
s_cbranch_scc1 Lexit_2
s_load_dwordx16 s[64:79], s[0:1], 0
s_load_dwordx4 s[80:83], s[0:1], 64
s_and_b32 s3, s2, 7
s_lshr_b32 s42, s2, 3
s_and_b32 s34, s3, 1
s_lshl_b32 s34, s34, 3
s_and_b32 s48, s42, 7
s_add_u32 s34, s34, s48
s_lshr_b32 s35, s3, 1
s_lshr_b32 s49, s42, 3
s_lshl_b32 s35, s35, 2
s_add_u32 s35, s35, s49
v_lshrrev_b32 v12, 6, v0
v_and_b32 v1, 63, v0
v_readfirstlane_b32 s36, v12
Lbeg:
s_lshl_b32 s50, s34, 7
s_sub_u32 s50, s50, 16
v_and_b32 v12, 15, v1
v_lshrrev_b32 v13, 4, v1
s_cmp_lt_u32 s36, 4
s_cbranch_scc1 Lcons_7
Lprod_3:
s_sub_u32 s47, s36, 4
s_lshl_b32 s43, s34, 7
s_lshl_b32 s44, s35, 3
s_add_u32 s63, s43, s44
s_lshl_b32 s44, s47, 1
s_add_u32 s51, s63, s44
v_lshlrev_b32 v10, 4, v1
s_and_b32 s43, s2, 7
s_lshr_b32 s44, s43, 2
s_lshl_b32 s44, s44, 1
s_and_b32 s45, s43, 1
s_add_u32 s44, s44, s45
s_lshr_b32 s45, s2, 3
s_lshl_b32 s45, s45, 2
s_add_u32 s44, s44, s45
s_add_u32 s44, s44, 96
s_bitcmp1_b32 s43, 1
s_cselect_b32 s44, s44, 0x10000
s_cmp_lt_u32 s2, 192
s_cselect_b32 s33, s2, s44
v_lshrrev_b32 v14, 3, v1
v_and_b32 v15, 7, v1
v_lshl_add_u32 v19, v14, 6, v15
s_lshl_b32 s43, s48, 3
v_add_u32 v19, s43, v19
v_mul_u32_u24 v19, 6144, v19
s_cmp_eq_u32 s47, 3
s_cbranch_scc1 Lpf_4
v_and_b32 v16, 2, v14
v_xor_b32 v16, v15, v16
v_lshlrev_b32 v16, 4, v16
v_mul_u32_u24 v17, 6144, v14
s_lshl_b32 s43, s47, 11
v_add3_u32 v2, v17, v16, s43
v_xor_b32 v3, 64, v2
v_lshrrev_b32 v16, 1, v14
v_xor_b32 v16, v15, v16
v_lshlrev_b32 v16, 4, v16
s_lshl_b32 s43, s47, 3
s_add_u32 s43, s43, s50
v_add_u32 v17, s43, v14
s_and_b32 s44, s47, 1
s_lshl_b32 s44, s44, 6
v_add_u32 v18, 0, v17
v_max_i32 v18, 0, v18
v_lshl_add_u32 v18, v18, 11, v16
v_xor_b32 v18, s44, v18
v_mov_b32 v4, v18
v_add_u32 v18, 24, v17
v_max_i32 v18, 0, v18
v_lshl_add_u32 v18, v18, 11, v16
v_xor_b32 v18, s44, v18
v_xor_b32 v5, 64, v18
v_add_u32 v18, 48, v17
v_max_i32 v18, 0, v18
v_lshl_add_u32 v18, v18, 11, v16
v_xor_b32 v18, s44, v18
v_mov_b32 v6, v18
v_add_u32 v18, 72, v17
v_max_i32 v18, 0, v18
v_lshl_add_u32 v18, v18, 11, v16
v_xor_b32 v18, s44, v18
v_xor_b32 v7, 64, v18
v_add_u32 v18, 96, v17
v_max_i32 v18, 0, v18
v_lshl_add_u32 v18, v18, 11, v16
v_xor_b32 v18, s44, v18
v_mov_b32 v8, v18
v_add_u32 v18, 120, v17
v_max_i32 v18, 0, v18
v_lshl_add_u32 v18, v18, 11, v16
v_xor_b32 v18, s44, v18
v_xor_b32 v9, 64, v18
s_lshl_b32 s39, s47, 10
s_lshl_b32 s40, s47, 13
s_add_u32 s40, s40, 18432
s_mov_b32 s37, 0
s_mov_b32 s38, 0
s_bfm_b64 s[60:61], 56, 8
s_cmp_eq_u32 s47, 0
s_cselect_b64 s[60:61], s[60:61], -1
s_lshl_b32 s43, s35, 7
s_waitcnt lgkmcnt(0)
s_mov_b32 s8, s64
s_mov_b32 s9, s65
s_mov_b32 s10, 4194304
s_mov_b32 s11, 0x20000
s_add_u32 s12, s66, s43
s_addc_u32 s13, s67, 0
s_mov_b32 s14, 6289536
s_mov_b32 s15, 0x20000
s_mov_b32 s28, s66
s_mov_b32 s29, s67
s_mov_b32 s30, 6291456
s_mov_b32 s31, 0x20000
s_mul_i32 s43, s33, 5376
v_lshlrev_b32 v30, 7, v1
s_mul_i32 s44, s47, 1792
s_add_u32 s43, s43, s44
s_bfm_b64 exec, 14, 0
buffer_load_dword v31, v30, s[28:31], s43 offen
s_mov_b64 exec, -1
s_add_u32 m0, s39, 0
s_mov_b64 exec, s[60:61]
buffer_load_dwordx4 v4, s[8:11], s37 offen lds
s_mov_b64 exec, -1
s_add_u32 m0, s39, 3072
s_nop 0
buffer_load_dwordx4 v5, s[8:11], s37 offen lds
s_add_u32 m0, s39, 6144
s_nop 0
buffer_load_dwordx4 v6, s[8:11], s37 offen lds
s_add_u32 m0, s39, 9216
s_nop 0
buffer_load_dwordx4 v7, s[8:11], s37 offen lds
s_add_u32 m0, s39, 12288
s_nop 0
buffer_load_dwordx4 v8, s[8:11], s37 offen lds
s_add_u32 m0, s39, 15360
s_nop 0
buffer_load_dwordx4 v9, s[8:11], s37 offen lds
s_add_u32 m0, s40, 0
s_add_u32 s43, s38, 0
buffer_load_dwordx4 v2, s[12:15], s43 offen lds
s_add_u32 m0, s40, 1024
s_add_u32 s43, s38, 49152
buffer_load_dwordx4 v3, s[12:15], s43 offen lds
s_add_u32 m0, s40, 2048
s_add_u32 s43, s38, 98304
buffer_load_dwordx4 v2, s[12:15], s43 offen lds
s_add_u32 m0, s40, 3072
s_add_u32 s43, s38, 147456
buffer_load_dwordx4 v3, s[12:15], s43 offen lds
s_add_u32 m0, s40, 4096
s_add_u32 s43, s38, 196608
buffer_load_dwordx4 v2, s[12:15], s43 offen lds
s_add_u32 m0, s40, 5120
s_add_u32 s43, s38, 245760
buffer_load_dwordx4 v3, s[12:15], s43 offen lds
s_add_u32 m0, s40, 6144
s_add_u32 s43, s38, 294912
buffer_load_dwordx4 v2, s[12:15], s43 offen lds
s_add_u32 m0, s40, 7168
s_add_u32 s43, s38, 344064
buffer_load_dwordx4 v3, s[12:15], s43 offen lds
s_add_u32 s37, s37, 128
s_add_u32 s38, s38, 393216
s_lshl_b32 s43, s51, 11
buffer_load_dwordx4 v[96:99], v10, s[8:11], s43 offen offset:0
buffer_load_dwordx4 v[100:103], v10, s[8:11], s43 offen offset:1024
buffer_load_dwordx4 v[104:107], v10, s[8:11], s43 offen offset:2048
buffer_load_dwordx4 v[108:111], v10, s[8:11], s43 offen offset:3072
s_mul_i32 s43, s2, 1536
s_and_b32 s44, s36, 3
s_mul_i32 s45, s44, 512
s_add_u32 s43, s43, s45
s_add_u32 s4, s66, s43
s_addc_u32 s5, s67, 0
s_lshl_b32 s43, s2, 13
s_mul_i32 s44, s44, 2752
s_add_u32 s43, s43, s44
s_min_u32 s43, s43, 2094400
s_add_u32 s26, s68, s43
s_addc_u32 s27, s69, 0
s_add_u32 m0, s39, 43008
s_mov_b64 exec, s[60:61]
buffer_load_dwordx4 v4, s[8:11], s37 offen lds
s_mov_b64 exec, -1
s_add_u32 m0, s39, 46080
s_nop 0
buffer_load_dwordx4 v5, s[8:11], s37 offen lds
s_add_u32 m0, s39, 49152
s_nop 0
buffer_load_dwordx4 v6, s[8:11], s37 offen lds
s_add_u32 m0, s39, 52224
s_nop 0
buffer_load_dwordx4 v7, s[8:11], s37 offen lds
s_add_u32 m0, s39, 55296
s_nop 0
buffer_load_dwordx4 v8, s[8:11], s37 offen lds
s_add_u32 m0, s39, 58368
s_nop 0
buffer_load_dwordx4 v9, s[8:11], s37 offen lds
s_add_u32 m0, s40, 43008
s_add_u32 s43, s38, 0
buffer_load_dwordx4 v2, s[12:15], s43 offen lds
s_add_u32 m0, s40, 44032
s_add_u32 s43, s38, 49152
buffer_load_dwordx4 v3, s[12:15], s43 offen lds
s_add_u32 m0, s40, 45056
s_add_u32 s43, s38, 98304
buffer_load_dwordx4 v2, s[12:15], s43 offen lds
s_add_u32 m0, s40, 46080
s_add_u32 s43, s38, 147456
buffer_load_dwordx4 v3, s[12:15], s43 offen lds
s_add_u32 m0, s40, 47104
s_add_u32 s43, s38, 196608
buffer_load_dwordx4 v2, s[12:15], s43 offen lds
s_add_u32 m0, s40, 48128
s_add_u32 s43, s38, 245760
buffer_load_dwordx4 v3, s[12:15], s43 offen lds
s_add_u32 m0, s40, 49152
s_add_u32 s43, s38, 294912
buffer_load_dwordx4 v2, s[12:15], s43 offen lds
s_add_u32 m0, s40, 50176
s_add_u32 s43, s38, 344064
buffer_load_dwordx4 v3, s[12:15], s43 offen lds
s_add_u32 s37, s37, 128
s_add_u32 s38, s38, 393216
s_waitcnt vmcnt(18)
s_barrier
s_add_u32 m0, s39, 86016
s_mov_b64 exec, s[60:61]
buffer_load_dwordx4 v4, s[8:11], s37 offen lds
s_mov_b64 exec, -1
s_add_u32 m0, s39, 89088
s_nop 0
buffer_load_dwordx4 v5, s[8:11], s37 offen lds
s_add_u32 m0, s39, 92160
s_nop 0
buffer_load_dwordx4 v6, s[8:11], s37 offen lds
s_add_u32 m0, s39, 95232
s_nop 0
buffer_load_dwordx4 v7, s[8:11], s37 offen lds
s_add_u32 m0, s39, 98304
s_nop 0
buffer_load_dwordx4 v8, s[8:11], s37 offen lds
s_add_u32 m0, s39, 101376
s_nop 0
buffer_load_dwordx4 v9, s[8:11], s37 offen lds
s_add_u32 m0, s40, 86016
s_add_u32 s43, s38, 0
buffer_load_dwordx4 v2, s[12:15], s43 offen lds
s_add_u32 m0, s40, 87040
s_add_u32 s43, s38, 49152
buffer_load_dwordx4 v3, s[12:15], s43 offen lds
s_add_u32 m0, s40, 88064
s_add_u32 s43, s38, 98304
buffer_load_dwordx4 v2, s[12:15], s43 offen lds
s_add_u32 m0, s40, 89088
s_add_u32 s43, s38, 147456
buffer_load_dwordx4 v3, s[12:15], s43 offen lds
s_add_u32 m0, s40, 90112
s_add_u32 s43, s38, 196608
buffer_load_dwordx4 v2, s[12:15], s43 offen lds
s_add_u32 m0, s40, 91136
s_add_u32 s43, s38, 245760
buffer_load_dwordx4 v3, s[12:15], s43 offen lds
s_add_u32 m0, s40, 92160
s_add_u32 s43, s38, 294912
buffer_load_dwordx4 v2, s[12:15], s43 offen lds
s_add_u32 m0, s40, 93184
s_add_u32 s43, s38, 344064
buffer_load_dwordx4 v3, s[12:15], s43 offen lds
s_add_u32 s37, s37, 128
s_add_u32 s38, s38, 393216
s_waitcnt vmcnt(28)
s_mov_b32 s43, 0x3f803f80
v_mov_b32 v116, 0
v_mov_b32 v117, 0
v_mov_b32 v118, 0
v_mov_b32 v119, 0
v_mov_b32 v120, 0
v_mov_b32 v121, 0
v_mov_b32 v122, 0
v_mov_b32 v123, 0
v_dot2_f32_bf16 v116, v96, s43, v116
v_dot2_f32_bf16 v120, v96, v96, v120
v_dot2_f32_bf16 v118, v104, s43, v118
v_dot2_f32_bf16 v122, v104, v104, v122
v_dot2_f32_bf16 v117, v97, s43, v117
v_dot2_f32_bf16 v121, v97, v97, v121
v_dot2_f32_bf16 v119, v105, s43, v119
v_dot2_f32_bf16 v123, v105, v105, v123
v_dot2_f32_bf16 v116, v98, s43, v116
v_dot2_f32_bf16 v120, v98, v98, v120
v_dot2_f32_bf16 v118, v106, s43, v118
v_dot2_f32_bf16 v122, v106, v106, v122
v_dot2_f32_bf16 v117, v99, s43, v117
v_dot2_f32_bf16 v121, v99, v99, v121
v_dot2_f32_bf16 v119, v107, s43, v119
v_dot2_f32_bf16 v123, v107, v107, v123
v_dot2_f32_bf16 v116, v100, s43, v116
v_dot2_f32_bf16 v120, v100, v100, v120
v_dot2_f32_bf16 v118, v108, s43, v118
v_dot2_f32_bf16 v122, v108, v108, v122
v_dot2_f32_bf16 v117, v101, s43, v117
v_dot2_f32_bf16 v121, v101, v101, v121
v_dot2_f32_bf16 v119, v109, s43, v119
v_dot2_f32_bf16 v123, v109, v109, v123
v_dot2_f32_bf16 v116, v102, s43, v116
v_dot2_f32_bf16 v120, v102, v102, v120
v_dot2_f32_bf16 v118, v110, s43, v118
v_dot2_f32_bf16 v122, v110, v110, v122
v_dot2_f32_bf16 v117, v103, s43, v117
v_dot2_f32_bf16 v121, v103, v103, v121
v_dot2_f32_bf16 v119, v111, s43, v119
v_dot2_f32_bf16 v123, v111, v111, v123
s_nop 2
v_add_f32 v116, v116, v117
v_add_f32 v118, v118, v119
v_add_f32 v120, v120, v121
v_add_f32 v122, v122, v123
s_nop 1
v_permlane32_swap_b32 v116, v118
v_permlane32_swap_b32 v120, v122
v_add_f32 v116, v116, v118
v_add_f32 v120, v120, v122
s_nop 1
v_permlane16_swap_b32 v116, v120
v_add_f32 v116, v116, v120
s_nop 1
v_add_f32_dpp v116, v116, v116 row_ror:8 row_mask:0xf bank_mask:0xf
s_nop 1
v_add_f32_dpp v116, v116, v116 row_ror:4 row_mask:0xf bank_mask:0xf
s_nop 1
v_add_f32_dpp v116, v116, v116 row_ror:2 row_mask:0xf bank_mask:0xf
s_nop 1
v_add_f32_dpp v116, v116, v116 row_ror:1 row_mask:0xf bank_mask:0xf
v_mov_b32 v117, v116
s_nop 1
v_permlane16_swap_b32 v116, v117
v_mul_f32 v112, 0x3a800000, v116
v_mul_f32 v113, 0x3a800000, v117
v_fma_f32 v113, -v112, v112, v113
v_max_f32 v113, 0, v113
v_add_f32 v113, 0x3727c5ac, v113
v_rsq_f32 v113, v113
v_lshrrev_b32 v11, 5, v1
s_lshl_b32 s43, s47, 4
s_add_u32 s43, s43, 148608
v_lshl_add_u32 v11, v11, 3, s43
ds_write_b64 v11, v[112:113]
s_waitcnt lgkmcnt(0)
s_waitcnt vmcnt(14)
s_barrier
s_add_u32 m0, s39, 0
s_mov_b64 exec, s[60:61]
buffer_load_dwordx4 v4, s[8:11], s37 offen lds
s_mov_b64 exec, -1
s_add_u32 m0, s39, 3072
s_nop 0
buffer_load_dwordx4 v5, s[8:11], s37 offen lds
s_add_u32 m0, s39, 6144
s_nop 0
buffer_load_dwordx4 v6, s[8:11], s37 offen lds
s_add_u32 m0, s39, 9216
s_nop 0
buffer_load_dwordx4 v7, s[8:11], s37 offen lds
s_add_u32 m0, s39, 12288
s_nop 0
buffer_load_dwordx4 v8, s[8:11], s37 offen lds
s_add_u32 m0, s39, 15360
s_nop 0
buffer_load_dwordx4 v9, s[8:11], s37 offen lds
s_add_u32 m0, s40, 0
s_add_u32 s43, s38, 0
buffer_load_dwordx4 v2, s[12:15], s43 offen lds
s_add_u32 m0, s40, 1024
s_add_u32 s43, s38, 49152
buffer_load_dwordx4 v3, s[12:15], s43 offen lds
s_add_u32 m0, s40, 2048
s_add_u32 s43, s38, 98304
buffer_load_dwordx4 v2, s[12:15], s43 offen lds
s_add_u32 m0, s40, 3072
s_add_u32 s43, s38, 147456
buffer_load_dwordx4 v3, s[12:15], s43 offen lds
s_add_u32 m0, s40, 4096
s_add_u32 s43, s38, 196608
buffer_load_dwordx4 v2, s[12:15], s43 offen lds
s_add_u32 m0, s40, 5120
s_add_u32 s43, s38, 245760
buffer_load_dwordx4 v3, s[12:15], s43 offen lds
s_add_u32 m0, s40, 6144
s_add_u32 s43, s38, 294912
buffer_load_dwordx4 v2, s[12:15], s43 offen lds
s_add_u32 m0, s40, 7168
s_add_u32 s43, s38, 344064
buffer_load_dwordx4 v3, s[12:15], s43 offen lds
s_add_u32 s37, s37, 128
s_add_u32 s38, s38, 393216
s_mov_b32 s6, 3932160
s_load_dword s3, s[4:5], s6 offset:0
s_load_dword s3, s[4:5], s6 offset:64
s_load_dword s3, s[4:5], s6 offset:128
s_load_dword s3, s[4:5], s6 offset:192
s_load_dword s3, s[4:5], s6 offset:256
s_load_dword s3, s[4:5], s6 offset:320
s_load_dword s3, s[4:5], s6 offset:384
s_load_dword s3, s[4:5], s6 offset:448
s_waitcnt vmcnt(14)
s_barrier
s_add_u32 m0, s39, 43008
s_mov_b64 exec, s[60:61]
buffer_load_dwordx4 v4, s[8:11], s37 offen lds
s_mov_b64 exec, -1
s_add_u32 m0, s39, 46080
s_nop 0
buffer_load_dwordx4 v5, s[8:11], s37 offen lds
s_add_u32 m0, s39, 49152
s_nop 0
buffer_load_dwordx4 v6, s[8:11], s37 offen lds
s_add_u32 m0, s39, 52224
s_nop 0
buffer_load_dwordx4 v7, s[8:11], s37 offen lds
s_add_u32 m0, s39, 55296
s_nop 0
buffer_load_dwordx4 v8, s[8:11], s37 offen lds
s_add_u32 m0, s39, 58368
s_nop 0
buffer_load_dwordx4 v9, s[8:11], s37 offen lds
s_add_u32 m0, s40, 43008
s_add_u32 s43, s38, 0
buffer_load_dwordx4 v2, s[12:15], s43 offen lds
s_add_u32 m0, s40, 44032
s_add_u32 s43, s38, 49152
buffer_load_dwordx4 v3, s[12:15], s43 offen lds
s_add_u32 m0, s40, 45056
s_add_u32 s43, s38, 98304
buffer_load_dwordx4 v2, s[12:15], s43 offen lds
s_add_u32 m0, s40, 46080
s_add_u32 s43, s38, 147456
buffer_load_dwordx4 v3, s[12:15], s43 offen lds
s_add_u32 m0, s40, 47104
s_add_u32 s43, s38, 196608
buffer_load_dwordx4 v2, s[12:15], s43 offen lds
s_add_u32 m0, s40, 48128
s_add_u32 s43, s38, 245760
buffer_load_dwordx4 v3, s[12:15], s43 offen lds
s_add_u32 m0, s40, 49152
s_add_u32 s43, s38, 294912
buffer_load_dwordx4 v2, s[12:15], s43 offen lds
s_add_u32 m0, s40, 50176
s_add_u32 s43, s38, 344064
buffer_load_dwordx4 v3, s[12:15], s43 offen lds
s_add_u32 s37, s37, 128
s_add_u32 s38, s38, 393216
s_mov_b32 s6, 4325376
s_load_dword s3, s[4:5], s6 offset:0
s_load_dword s3, s[4:5], s6 offset:64
s_load_dword s3, s[4:5], s6 offset:128
s_load_dword s3, s[4:5], s6 offset:192
s_load_dword s3, s[4:5], s6 offset:256
s_load_dword s3, s[4:5], s6 offset:320
s_load_dword s3, s[4:5], s6 offset:384
s_load_dword s3, s[4:5], s6 offset:448
s_waitcnt vmcnt(14)
s_barrier
s_add_u32 m0, s39, 86016
s_mov_b64 exec, s[60:61]
buffer_load_dwordx4 v4, s[8:11], s37 offen lds
s_mov_b64 exec, -1
s_add_u32 m0, s39, 89088
s_nop 0
buffer_load_dwordx4 v5, s[8:11], s37 offen lds
s_add_u32 m0, s39, 92160
s_nop 0
buffer_load_dwordx4 v6, s[8:11], s37 offen lds
s_add_u32 m0, s39, 95232
s_nop 0
buffer_load_dwordx4 v7, s[8:11], s37 offen lds
s_add_u32 m0, s39, 98304
s_nop 0
buffer_load_dwordx4 v8, s[8:11], s37 offen lds
s_add_u32 m0, s39, 101376
s_nop 0
buffer_load_dwordx4 v9, s[8:11], s37 offen lds
s_add_u32 m0, s40, 86016
s_add_u32 s43, s38, 0
buffer_load_dwordx4 v2, s[12:15], s43 offen lds
s_add_u32 m0, s40, 87040
s_add_u32 s43, s38, 49152
buffer_load_dwordx4 v3, s[12:15], s43 offen lds
s_add_u32 m0, s40, 88064
s_add_u32 s43, s38, 98304
buffer_load_dwordx4 v2, s[12:15], s43 offen lds
s_add_u32 m0, s40, 89088
s_add_u32 s43, s38, 147456
buffer_load_dwordx4 v3, s[12:15], s43 offen lds
s_add_u32 m0, s40, 90112
s_add_u32 s43, s38, 196608
buffer_load_dwordx4 v2, s[12:15], s43 offen lds
s_add_u32 m0, s40, 91136
s_add_u32 s43, s38, 245760
buffer_load_dwordx4 v3, s[12:15], s43 offen lds
s_add_u32 m0, s40, 92160
s_add_u32 s43, s38, 294912
buffer_load_dwordx4 v2, s[12:15], s43 offen lds
s_add_u32 m0, s40, 93184
s_add_u32 s43, s38, 344064
buffer_load_dwordx4 v3, s[12:15], s43 offen lds
s_add_u32 s37, s37, 128
s_branch Lov_0
.p2align 12
Lst_0_0:
s_branch Lwr_140
s_nop 0
s_nop 0
Lov_0:
s_add_u32 s38, s38, 393216
s_mov_b32 s6, 4718592
s_load_dword s3, s[4:5], s6 offset:0
s_load_dword s3, s[4:5], s6 offset:64
s_load_dword s3, s[4:5], s6 offset:128
s_load_dword s3, s[4:5], s6 offset:192
s_load_dword s3, s[4:5], s6 offset:256
s_load_dword s3, s[4:5], s6 offset:320
s_load_dword s3, s[4:5], s6 offset:384
s_load_dword s3, s[4:5], s6 offset:448
s_waitcnt vmcnt(14)
s_barrier
s_add_u32 m0, s39, 0
s_mov_b64 exec, s[60:61]
buffer_load_dwordx4 v4, s[8:11], s37 offen lds
s_mov_b64 exec, -1
s_add_u32 m0, s39, 3072
s_nop 0
buffer_load_dwordx4 v5, s[8:11], s37 offen lds
s_add_u32 m0, s39, 6144
s_nop 0
buffer_load_dwordx4 v6, s[8:11], s37 offen lds
s_add_u32 m0, s39, 9216
s_nop 0
buffer_load_dwordx4 v7, s[8:11], s37 offen lds
s_add_u32 m0, s39, 12288
s_nop 0
buffer_load_dwordx4 v8, s[8:11], s37 offen lds
s_add_u32 m0, s39, 15360
s_nop 0
buffer_load_dwordx4 v9, s[8:11], s37 offen lds
s_add_u32 m0, s40, 0
s_add_u32 s43, s38, 0
buffer_load_dwordx4 v2, s[12:15], s43 offen lds
s_add_u32 m0, s40, 1024
s_add_u32 s43, s38, 49152
buffer_load_dwordx4 v3, s[12:15], s43 offen lds
s_add_u32 m0, s40, 2048
s_add_u32 s43, s38, 98304
buffer_load_dwordx4 v2, s[12:15], s43 offen lds
s_add_u32 m0, s40, 3072
s_add_u32 s43, s38, 147456
buffer_load_dwordx4 v3, s[12:15], s43 offen lds
s_add_u32 m0, s40, 4096
s_add_u32 s43, s38, 196608
buffer_load_dwordx4 v2, s[12:15], s43 offen lds
s_add_u32 m0, s40, 5120
s_add_u32 s43, s38, 245760
buffer_load_dwordx4 v3, s[12:15], s43 offen lds
s_add_u32 m0, s40, 6144
s_add_u32 s43, s38, 294912
buffer_load_dwordx4 v2, s[12:15], s43 offen lds
s_add_u32 m0, s40, 7168
s_add_u32 s43, s38, 344064
buffer_load_dwordx4 v3, s[12:15], s43 offen lds
s_add_u32 s37, s37, 128
s_add_u32 s38, s38, 393216
s_mov_b32 s6, 5111808
s_load_dword s3, s[4:5], s6 offset:0
s_load_dword s3, s[4:5], s6 offset:64
s_load_dword s3, s[4:5], s6 offset:128
s_load_dword s3, s[4:5], s6 offset:192
s_load_dword s3, s[4:5], s6 offset:256
s_load_dword s3, s[4:5], s6 offset:320
s_load_dword s3, s[4:5], s6 offset:384
s_load_dword s3, s[4:5], s6 offset:448
s_waitcnt vmcnt(14)
s_barrier
s_add_u32 m0, s39, 43008
s_mov_b64 exec, s[60:61]
buffer_load_dwordx4 v4, s[8:11], s37 offen lds
s_mov_b64 exec, -1
s_add_u32 m0, s39, 46080
s_nop 0
buffer_load_dwordx4 v5, s[8:11], s37 offen lds
s_add_u32 m0, s39, 49152
s_nop 0
buffer_load_dwordx4 v6, s[8:11], s37 offen lds
s_add_u32 m0, s39, 52224
s_nop 0
buffer_load_dwordx4 v7, s[8:11], s37 offen lds
s_add_u32 m0, s39, 55296
s_nop 0
buffer_load_dwordx4 v8, s[8:11], s37 offen lds
s_add_u32 m0, s39, 58368
s_nop 0
buffer_load_dwordx4 v9, s[8:11], s37 offen lds
s_add_u32 m0, s40, 43008
s_add_u32 s43, s38, 0
buffer_load_dwordx4 v2, s[12:15], s43 offen lds
s_add_u32 m0, s40, 44032
s_add_u32 s43, s38, 49152
buffer_load_dwordx4 v3, s[12:15], s43 offen lds
s_add_u32 m0, s40, 45056
s_add_u32 s43, s38, 98304
buffer_load_dwordx4 v2, s[12:15], s43 offen lds
s_add_u32 m0, s40, 46080
s_add_u32 s43, s38, 147456
buffer_load_dwordx4 v3, s[12:15], s43 offen lds
s_add_u32 m0, s40, 47104
s_add_u32 s43, s38, 196608
buffer_load_dwordx4 v2, s[12:15], s43 offen lds
s_add_u32 m0, s40, 48128
s_add_u32 s43, s38, 245760
buffer_load_dwordx4 v3, s[12:15], s43 offen lds
s_add_u32 m0, s40, 49152
s_add_u32 s43, s38, 294912
buffer_load_dwordx4 v2, s[12:15], s43 offen lds
s_add_u32 m0, s40, 50176
s_add_u32 s43, s38, 344064
buffer_load_dwordx4 v3, s[12:15], s43 offen lds
s_add_u32 s37, s37, 128
s_add_u32 s38, s38, 393216
s_mov_b32 s6, 5505024
s_load_dword s3, s[4:5], s6 offset:0
s_load_dword s3, s[4:5], s6 offset:64
s_load_dword s3, s[4:5], s6 offset:128
s_load_dword s3, s[4:5], s6 offset:192
s_load_dword s3, s[4:5], s6 offset:256
s_load_dword s3, s[4:5], s6 offset:320
s_load_dword s3, s[4:5], s6 offset:384
s_load_dword s3, s[4:5], s6 offset:448
s_waitcnt vmcnt(14)
s_barrier
s_add_u32 m0, s39, 86016
s_mov_b64 exec, s[60:61]
buffer_load_dwordx4 v4, s[8:11], s37 offen lds
s_mov_b64 exec, -1
s_add_u32 m0, s39, 89088
s_nop 0
buffer_load_dwordx4 v5, s[8:11], s37 offen lds
s_add_u32 m0, s39, 92160
s_nop 0
buffer_load_dwordx4 v6, s[8:11], s37 offen lds
s_add_u32 m0, s39, 95232
s_nop 0
buffer_load_dwordx4 v7, s[8:11], s37 offen lds
s_add_u32 m0, s39, 98304
s_nop 0
buffer_load_dwordx4 v8, s[8:11], s37 offen lds
s_add_u32 m0, s39, 101376
s_nop 0
buffer_load_dwordx4 v9, s[8:11], s37 offen lds
s_add_u32 m0, s40, 86016
s_add_u32 s43, s38, 0
buffer_load_dwordx4 v2, s[12:15], s43 offen lds
s_add_u32 m0, s40, 87040
s_add_u32 s43, s38, 49152
buffer_load_dwordx4 v3, s[12:15], s43 offen lds
s_add_u32 m0, s40, 88064
s_add_u32 s43, s38, 98304
buffer_load_dwordx4 v2, s[12:15], s43 offen lds
s_add_u32 m0, s40, 89088
s_add_u32 s43, s38, 147456
buffer_load_dwordx4 v3, s[12:15], s43 offen lds
s_add_u32 m0, s40, 90112
s_add_u32 s43, s38, 196608
buffer_load_dwordx4 v2, s[12:15], s43 offen lds
s_add_u32 m0, s40, 91136
s_add_u32 s43, s38, 245760
buffer_load_dwordx4 v3, s[12:15], s43 offen lds
s_add_u32 m0, s40, 92160
s_add_u32 s43, s38, 294912
buffer_load_dwordx4 v2, s[12:15], s43 offen lds
s_add_u32 m0, s40, 93184
s_add_u32 s43, s38, 344064
buffer_load_dwordx4 v3, s[12:15], s43 offen lds
s_add_u32 s37, s37, 128
s_add_u32 s38, s38, 393216
s_mov_b32 s6, 5898240
s_load_dword s3, s[4:5], s6 offset:0
s_load_dword s3, s[4:5], s6 offset:64
s_load_dword s3, s[4:5], s6 offset:128
s_load_dword s3, s[4:5], s6 offset:192
s_load_dword s3, s[4:5], s6 offset:256
s_load_dword s3, s[4:5], s6 offset:320
s_load_dword s3, s[4:5], s6 offset:384
s_load_dword s3, s[4:5], s6 offset:448
s_waitcnt vmcnt(14)
s_barrier
s_add_u32 m0, s39, 0
s_mov_b64 exec, s[60:61]
buffer_load_dwordx4 v4, s[8:11], s37 offen lds
s_mov_b64 exec, -1
s_add_u32 m0, s39, 3072
s_nop 0
buffer_load_dwordx4 v5, s[8:11], s37 offen lds
s_add_u32 m0, s39, 6144
s_nop 0
buffer_load_dwordx4 v6, s[8:11], s37 offen lds
s_add_u32 m0, s39, 9216
s_nop 0
buffer_load_dwordx4 v7, s[8:11], s37 offen lds
s_add_u32 m0, s39, 12288
s_nop 0
buffer_load_dwordx4 v8, s[8:11], s37 offen lds
s_add_u32 m0, s39, 15360
s_nop 0
buffer_load_dwordx4 v9, s[8:11], s37 offen lds
s_add_u32 m0, s40, 0
s_add_u32 s43, s38, 0
buffer_load_dwordx4 v2, s[12:15], s43 offen lds
s_add_u32 m0, s40, 1024
s_add_u32 s43, s38, 49152
buffer_load_dwordx4 v3, s[12:15], s43 offen lds
s_add_u32 m0, s40, 2048
s_add_u32 s43, s38, 98304
buffer_load_dwordx4 v2, s[12:15], s43 offen lds
s_add_u32 m0, s40, 3072
s_add_u32 s43, s38, 147456
buffer_load_dwordx4 v3, s[12:15], s43 offen lds
s_add_u32 m0, s40, 4096
s_add_u32 s43, s38, 196608
buffer_load_dwordx4 v2, s[12:15], s43 offen lds
s_add_u32 m0, s40, 5120
s_add_u32 s43, s38, 245760
buffer_load_dwordx4 v3, s[12:15], s43 offen lds
s_add_u32 m0, s40, 6144
s_add_u32 s43, s38, 294912
buffer_load_dwordx4 v2, s[12:15], s43 offen lds
s_add_u32 m0, s40, 7168
s_add_u32 s43, s38, 344064
buffer_load_dwordx4 v3, s[12:15], s43 offen lds
s_add_u32 s37, s37, 128
s_add_u32 s38, s38, 393216
s_load_dword s3, s[26:27], 0
s_load_dword s3, s[26:27], 64
s_load_dword s3, s[26:27], 128
s_load_dword s3, s[26:27], 192
s_load_dword s3, s[26:27], 256
s_load_dword s3, s[26:27], 320
s_load_dword s3, s[26:27], 384
s_load_dword s3, s[26:27], 448
s_load_dword s3, s[26:27], 512
s_waitcnt vmcnt(14)
s_barrier
s_add_u32 m0, s39, 43008
s_mov_b64 exec, s[60:61]
buffer_load_dwordx4 v4, s[8:11], s37 offen lds
s_mov_b64 exec, -1
s_add_u32 m0, s39, 46080
s_nop 0
buffer_load_dwordx4 v5, s[8:11], s37 offen lds
s_add_u32 m0, s39, 49152
s_nop 0
buffer_load_dwordx4 v6, s[8:11], s37 offen lds
s_add_u32 m0, s39, 52224
s_nop 0
buffer_load_dwordx4 v7, s[8:11], s37 offen lds
s_add_u32 m0, s39, 55296
s_nop 0
buffer_load_dwordx4 v8, s[8:11], s37 offen lds
s_add_u32 m0, s39, 58368
s_nop 0
buffer_load_dwordx4 v9, s[8:11], s37 offen lds
s_add_u32 m0, s40, 43008
s_add_u32 s43, s38, 0
buffer_load_dwordx4 v2, s[12:15], s43 offen lds
s_add_u32 m0, s40, 44032
s_add_u32 s43, s38, 49152
buffer_load_dwordx4 v3, s[12:15], s43 offen lds
s_add_u32 m0, s40, 45056
s_add_u32 s43, s38, 98304
buffer_load_dwordx4 v2, s[12:15], s43 offen lds
s_add_u32 m0, s40, 46080
s_add_u32 s43, s38, 147456
buffer_load_dwordx4 v3, s[12:15], s43 offen lds
s_add_u32 m0, s40, 47104
s_add_u32 s43, s38, 196608
buffer_load_dwordx4 v2, s[12:15], s43 offen lds
s_add_u32 m0, s40, 48128
s_add_u32 s43, s38, 245760
buffer_load_dwordx4 v3, s[12:15], s43 offen lds
s_add_u32 m0, s40, 49152
s_add_u32 s43, s38, 294912
buffer_load_dwordx4 v2, s[12:15], s43 offen lds
s_add_u32 m0, s40, 50176
s_add_u32 s43, s38, 344064
buffer_load_dwordx4 v3, s[12:15], s43 offen lds
s_add_u32 s37, s37, 128
s_add_u32 s38, s38, 393216
s_load_dword s3, s[26:27], 576
s_load_dword s3, s[26:27], 640
s_load_dword s3, s[26:27], 704
s_load_dword s3, s[26:27], 768
s_load_dword s3, s[26:27], 832
s_load_dword s3, s[26:27], 896
s_load_dword s3, s[26:27], 960
s_load_dword s3, s[26:27], 1024
s_load_dword s3, s[26:27], 1088
s_waitcnt vmcnt(14)
s_barrier
s_add_u32 m0, s39, 86016
s_mov_b64 exec, s[60:61]
buffer_load_dwordx4 v4, s[8:11], s37 offen lds
s_mov_b64 exec, -1
s_add_u32 m0, s39, 89088
s_nop 0
buffer_load_dwordx4 v5, s[8:11], s37 offen lds
s_add_u32 m0, s39, 92160
s_nop 0
buffer_load_dwordx4 v6, s[8:11], s37 offen lds
s_add_u32 m0, s39, 95232
s_nop 0
buffer_load_dwordx4 v7, s[8:11], s37 offen lds
s_add_u32 m0, s39, 98304
s_nop 0
buffer_load_dwordx4 v8, s[8:11], s37 offen lds
s_add_u32 m0, s39, 101376
s_nop 0
buffer_load_dwordx4 v9, s[8:11], s37 offen lds
s_add_u32 m0, s40, 86016
s_add_u32 s43, s38, 0
buffer_load_dwordx4 v2, s[12:15], s43 offen lds
s_add_u32 m0, s40, 87040
s_add_u32 s43, s38, 49152
buffer_load_dwordx4 v3, s[12:15], s43 offen lds
s_add_u32 m0, s40, 88064
s_add_u32 s43, s38, 98304
buffer_load_dwordx4 v2, s[12:15], s43 offen lds
s_add_u32 m0, s40, 89088
s_add_u32 s43, s38, 147456
buffer_load_dwordx4 v3, s[12:15], s43 offen lds
s_add_u32 m0, s40, 90112
s_add_u32 s43, s38, 196608
buffer_load_dwordx4 v2, s[12:15], s43 offen lds
s_add_u32 m0, s40, 91136
s_add_u32 s43, s38, 245760
buffer_load_dwordx4 v3, s[12:15], s43 offen lds
s_add_u32 m0, s40, 92160
s_add_u32 s43, s38, 294912
buffer_load_dwordx4 v2, s[12:15], s43 offen lds
s_add_u32 m0, s40, 93184
s_add_u32 s43, s38, 344064
buffer_load_dwordx4 v3, s[12:15], s43 offen lds
s_add_u32 s37, s37, 128
s_add_u32 s38, s38, 393216
s_load_dword s3, s[26:27], 1152
s_load_dword s3, s[26:27], 1216
s_load_dword s3, s[26:27], 1280
s_load_dword s3, s[26:27], 1344
s_load_dword s3, s[26:27], 1408
s_load_dword s3, s[26:27], 1472
s_load_dword s3, s[26:27], 1536
s_load_dword s3, s[26:27], 1600
s_load_dword s3, s[26:27], 1664
s_waitcnt vmcnt(14)
s_barrier
s_add_u32 m0, s39, 0
s_mov_b64 exec, s[60:61]
buffer_load_dwordx4 v4, s[8:11], s37 offen lds
s_mov_b64 exec, -1
s_add_u32 m0, s39, 3072
s_nop 0
buffer_load_dwordx4 v5, s[8:11], s37 offen lds
s_add_u32 m0, s39, 6144
s_nop 0
buffer_load_dwordx4 v6, s[8:11], s37 offen lds
s_add_u32 m0, s39, 9216
s_nop 0
buffer_load_dwordx4 v7, s[8:11], s37 offen lds
s_add_u32 m0, s39, 12288
s_nop 0
buffer_load_dwordx4 v8, s[8:11], s37 offen lds
s_add_u32 m0, s39, 15360
s_nop 0
buffer_load_dwordx4 v9, s[8:11], s37 offen lds
s_add_u32 m0, s40, 0
s_add_u32 s43, s38, 0
buffer_load_dwordx4 v2, s[12:15], s43 offen lds
s_add_u32 m0, s40, 1024
s_add_u32 s43, s38, 49152
buffer_load_dwordx4 v3, s[12:15], s43 offen lds
s_add_u32 m0, s40, 2048
s_add_u32 s43, s38, 98304
buffer_load_dwordx4 v2, s[12:15], s43 offen lds
s_add_u32 m0, s40, 3072
s_add_u32 s43, s38, 147456
buffer_load_dwordx4 v3, s[12:15], s43 offen lds
s_add_u32 m0, s40, 4096
s_add_u32 s43, s38, 196608
buffer_load_dwordx4 v2, s[12:15], s43 offen lds
s_add_u32 m0, s40, 5120
s_add_u32 s43, s38, 245760
buffer_load_dwordx4 v3, s[12:15], s43 offen lds
s_add_u32 m0, s40, 6144
s_add_u32 s43, s38, 294912
buffer_load_dwordx4 v2, s[12:15], s43 offen lds
s_add_u32 m0, s40, 7168
s_add_u32 s43, s38, 344064
buffer_load_dwordx4 v3, s[12:15], s43 offen lds
s_add_u32 s37, s37, 128
s_add_u32 s38, s38, 393216
s_load_dword s3, s[26:27], 1728
s_load_dword s3, s[26:27], 1792
s_load_dword s3, s[26:27], 1856
s_load_dword s3, s[26:27], 1920
s_load_dword s3, s[26:27], 1984
s_load_dword s3, s[26:27], 2048
s_load_dword s3, s[26:27], 2112
s_load_dword s3, s[26:27], 2176
s_load_dword s3, s[26:27], 2240
s_waitcnt vmcnt(14)
s_barrier
s_add_u32 m0, s39, 43008
s_mov_b64 exec, s[60:61]
buffer_load_dwordx4 v4, s[8:11], s37 offen lds
s_mov_b64 exec, -1
s_add_u32 m0, s39, 46080
s_nop 0
buffer_load_dwordx4 v5, s[8:11], s37 offen lds
s_add_u32 m0, s39, 49152
s_nop 0
buffer_load_dwordx4 v6, s[8:11], s37 offen lds
s_add_u32 m0, s39, 52224
s_nop 0
buffer_load_dwordx4 v7, s[8:11], s37 offen lds
s_add_u32 m0, s39, 55296
s_nop 0
buffer_load_dwordx4 v8, s[8:11], s37 offen lds
s_add_u32 m0, s39, 58368
s_nop 0
buffer_load_dwordx4 v9, s[8:11], s37 offen lds
s_add_u32 m0, s40, 43008
s_add_u32 s43, s38, 0
buffer_load_dwordx4 v2, s[12:15], s43 offen lds
s_add_u32 m0, s40, 44032
s_add_u32 s43, s38, 49152
buffer_load_dwordx4 v3, s[12:15], s43 offen lds
s_add_u32 m0, s40, 45056
s_add_u32 s43, s38, 98304
buffer_load_dwordx4 v2, s[12:15], s43 offen lds
s_add_u32 m0, s40, 46080
s_add_u32 s43, s38, 147456
buffer_load_dwordx4 v3, s[12:15], s43 offen lds
s_add_u32 m0, s40, 47104
s_add_u32 s43, s38, 196608
buffer_load_dwordx4 v2, s[12:15], s43 offen lds
s_add_u32 m0, s40, 48128
s_add_u32 s43, s38, 245760
buffer_load_dwordx4 v3, s[12:15], s43 offen lds
s_add_u32 m0, s40, 49152
s_add_u32 s43, s38, 294912
buffer_load_dwordx4 v2, s[12:15], s43 offen lds
s_add_u32 m0, s40, 50176
s_add_u32 s43, s38, 344064
buffer_load_dwordx4 v3, s[12:15], s43 offen lds
s_add_u32 s37, s37, 128
s_add_u32 s38, s38, 393216
s_load_dword s3, s[26:27], 2304
s_load_dword s3, s[26:27], 2368
s_load_dword s3, s[26:27], 2432
s_load_dword s3, s[26:27], 2496
s_load_dword s3, s[26:27], 2560
s_load_dword s3, s[26:27], 2624
s_load_dword s3, s[26:27], 2688
s_waitcnt vmcnt(14)
s_barrier
s_add_u32 m0, s39, 86016
s_mov_b64 exec, s[60:61]
buffer_load_dwordx4 v4, s[8:11], s37 offen lds
s_mov_b64 exec, -1
s_add_u32 m0, s39, 89088
s_nop 0
buffer_load_dwordx4 v5, s[8:11], s37 offen lds
s_add_u32 m0, s39, 92160
s_nop 0
buffer_load_dwordx4 v6, s[8:11], s37 offen lds
s_add_u32 m0, s39, 95232
s_nop 0
buffer_load_dwordx4 v7, s[8:11], s37 offen lds
s_add_u32 m0, s39, 98304
s_nop 0
buffer_load_dwordx4 v8, s[8:11], s37 offen lds
s_add_u32 m0, s39, 101376
s_nop 0
buffer_load_dwordx4 v9, s[8:11], s37 offen lds
s_add_u32 m0, s40, 86016
s_add_u32 s43, s38, 0
buffer_load_dwordx4 v2, s[12:15], s43 offen lds
s_add_u32 m0, s40, 87040
s_add_u32 s43, s38, 49152
buffer_load_dwordx4 v3, s[12:15], s43 offen lds
s_add_u32 m0, s40, 88064
s_add_u32 s43, s38, 98304
buffer_load_dwordx4 v2, s[12:15], s43 offen lds
s_add_u32 m0, s40, 89088
s_add_u32 s43, s38, 147456
buffer_load_dwordx4 v3, s[12:15], s43 offen lds
s_add_u32 m0, s40, 90112
s_add_u32 s43, s38, 196608
buffer_load_dwordx4 v2, s[12:15], s43 offen lds
s_add_u32 m0, s40, 91136
s_add_u32 s43, s38, 245760
buffer_load_dwordx4 v3, s[12:15], s43 offen lds
s_add_u32 m0, s40, 92160
s_add_u32 s43, s38, 294912
buffer_load_dwordx4 v2, s[12:15], s43 offen lds
s_add_u32 m0, s40, 93184
s_add_u32 s43, s38, 344064
buffer_load_dwordx4 v3, s[12:15], s43 offen lds
s_add_u32 s37, s37, 128
s_add_u32 s38, s38, 393216
s_and_b32 s44, s36, 3
s_mul_i32 s44, s44, 0
s_bfe_u32 s43, s2, 0x30001
s_lshl_b32 s43, s43, 7
s_add_u32 s44, s44, s43
s_mul_i32 s44, s44, 7168
s_lshr_b32 s43, s2, 4
s_lshl_b32 s43, s43, 8
s_add_u32 s43, s43, s44
s_bitcmp0_b32 s2, 0
s_cselect_b32 s4, s72, s74
s_cselect_b32 s5, s73, s75
s_add_u32 s4, s4, s43
s_addc_u32 s5, s5, 0
s_waitcnt vmcnt(14)
s_barrier
s_add_u32 m0, s39, 0
s_mov_b64 exec, s[60:61]
buffer_load_dwordx4 v4, s[8:11], s37 offen lds
s_mov_b64 exec, -1
s_add_u32 m0, s39, 3072
s_nop 0
buffer_load_dwordx4 v5, s[8:11], s37 offen lds
s_add_u32 m0, s39, 6144
s_nop 0
buffer_load_dwordx4 v6, s[8:11], s37 offen lds
s_add_u32 m0, s39, 9216
s_nop 0
buffer_load_dwordx4 v7, s[8:11], s37 offen lds
s_add_u32 m0, s39, 12288
s_nop 0
buffer_load_dwordx4 v8, s[8:11], s37 offen lds
s_add_u32 m0, s39, 15360
s_nop 0
buffer_load_dwordx4 v9, s[8:11], s37 offen lds
s_add_u32 m0, s40, 0
s_add_u32 s43, s38, 0
buffer_load_dwordx4 v2, s[12:15], s43 offen lds
s_add_u32 m0, s40, 1024
s_add_u32 s43, s38, 49152
buffer_load_dwordx4 v3, s[12:15], s43 offen lds
s_add_u32 m0, s40, 2048
s_add_u32 s43, s38, 98304
buffer_load_dwordx4 v2, s[12:15], s43 offen lds
s_add_u32 m0, s40, 3072
s_add_u32 s43, s38, 147456
buffer_load_dwordx4 v3, s[12:15], s43 offen lds
s_add_u32 m0, s40, 4096
s_add_u32 s43, s38, 196608
buffer_load_dwordx4 v2, s[12:15], s43 offen lds
s_add_u32 m0, s40, 5120
s_add_u32 s43, s38, 245760
buffer_load_dwordx4 v3, s[12:15], s43 offen lds
s_add_u32 m0, s40, 6144
s_add_u32 s43, s38, 294912
buffer_load_dwordx4 v2, s[12:15], s43 offen lds
s_add_u32 m0, s40, 7168
s_add_u32 s43, s38, 344064
buffer_load_dwordx4 v3, s[12:15], s43 offen lds
s_add_u32 s37, s37, 128
s_add_u32 s38, s38, 393216
s_waitcnt vmcnt(14)
s_barrier
s_waitcnt vmcnt(0)
s_barrier
s_lshl_b32 s43, s35, 7
s_add_u32 s28, s68, s43
s_addc_u32 s29, s69, 0
s_mov_b32 s30, 2095232
s_mov_b32 s31, 0x20000
v_lshrrev_b32 v15, 3, v1
s_branch Lov_1
.p2align 12
Lst_1_0:
s_branch Lwr_141
s_nop 0
s_nop 0
Lov_1:
v_and_b32 v16, 6, v15
v_and_b32 v7, 7, v1
v_xor_b32 v7, v7, v16
v_lshlrev_b32 v7, 4, v7
v_mul_u32_u24 v15, 2048, v15
v_add_u32 v7, v7, v15
s_and_b32 s40, s36, 3
s_lshl_b32 s39, s40, 13
s_add_u32 s40, s40, s35
s_add_u32 s42, s40, 0
s_and_b32 s42, s42, 15
s_lshl_b32 s42, s42, 17
s_add_u32 m0, s39, 65536
s_add_u32 s43, s42, 0
buffer_load_dwordx4 v7, s[28:31], s43 offen lds
s_add_u32 m0, s39, 66560
s_add_u32 s43, s42, 16384
buffer_load_dwordx4 v7, s[28:31], s43 offen lds
s_add_u32 m0, s39, 67584
s_add_u32 s43, s42, 32768
buffer_load_dwordx4 v7, s[28:31], s43 offen lds
s_add_u32 m0, s39, 68608
s_add_u32 s43, s42, 49152
buffer_load_dwordx4 v7, s[28:31], s43 offen lds
s_add_u32 m0, s39, 69632
s_add_u32 s43, s42, 65536
buffer_load_dwordx4 v7, s[28:31], s43 offen lds
s_add_u32 m0, s39, 70656
s_add_u32 s43, s42, 81920
buffer_load_dwordx4 v7, s[28:31], s43 offen lds
s_add_u32 m0, s39, 71680
s_add_u32 s43, s42, 98304
buffer_load_dwordx4 v7, s[28:31], s43 offen lds
s_add_u32 m0, s39, 72704
s_add_u32 s43, s42, 114688
buffer_load_dwordx4 v7, s[28:31], s43 offen lds
s_bitcmp0_b32 s2, 0
s_cselect_b32 s88, s72, s74
s_cselect_b32 s89, s73, s75
s_cmp_lt_u32 s2, 192
s_cselect_b32 s90, 7340032, 0
s_mov_b32 s91, 0x20000
s_bfe_u32 s44, s2, 0x30001
s_lshl_b32 s44, s44, 2
s_and_b32 s43, s36, 3
s_add_u32 s44, s44, s43
s_lshl_b32 s44, s44, 5
v_lshrrev_b32 v18, 4, v1
v_add_u32 v18, s44, v18
v_mul_u32_u24 v18, 7168, v18
v_and_b32 v19, 15, v1
v_lshl_add_u32 v18, v19, 4, v18
s_lshr_b32 s43, s2, 4
s_lshl_b32 s43, s43, 8
s_add_u32 s43, s43, 4096
v_add_u32 v18, s43, v18
s_mov_b32 s43, 0
buffer_load_dwordx4 v[128:131], v18, s[88:91], s43 offen
s_mov_b32 s43, 28672
buffer_load_dwordx4 v[132:135], v18, s[88:91], s43 offen
s_mov_b32 s43, 57344
buffer_load_dwordx4 v[136:139], v18, s[88:91], s43 offen
s_mov_b32 s43, 86016
buffer_load_dwordx4 v[140:143], v18, s[88:91], s43 offen
s_mov_b32 s43, 114688
buffer_load_dwordx4 v[144:147], v18, s[88:91], s43 offen
s_mov_b32 s43, 143360
buffer_load_dwordx4 v[148:151], v18, s[88:91], s43 offen
s_mov_b32 s43, 172032
buffer_load_dwordx4 v[152:155], v18, s[88:91], s43 offen
s_mov_b32 s43, 200704
buffer_load_dwordx4 v[156:159], v18, s[88:91], s43 offen
s_barrier
s_branch Lats_6
Lcons_7:
s_lshl_b32 s43, s35, 7
s_waitcnt lgkmcnt(0)
s_mov_b32 s8, s64
s_mov_b32 s9, s65
s_mov_b32 s10, 4194304
s_mov_b32 s11, 0x20000
s_add_u32 s12, s66, s43
s_addc_u32 s13, s67, 0
s_mov_b32 s14, 6289536
s_mov_b32 s15, 0x20000
s_getpc_b64 s[100:101]
s_and_b32 s100, s100, 0xfffff000
s_sub_u32 s100, s100, 1056768
s_subb_u32 s101, s101, 0
s_lshr_b32 s6, s2, 3
s_mul_i32 s6, s6, 4
s_and_b32 s7, s36, 3
s_add_u32 s6, s6, s7
s_mulk_i32 s6, 192
s_add_u32 s6, s6, 1049408
s_load_dword s3, s[100:101], s6 offset:0
s_load_dword s3, s[100:101], s6 offset:64
s_load_dword s3, s[100:101], s6 offset:128
s_lshr_b32 s43, s2, 3
s_lshl_b32 s43, s43, 2
s_add_u32 s43, s43, s36
s_sub_u32 s44, s43, 0
s_and_b32 s44, s44, 127
s_cmp_lt_u32 s44, 24
s_cbranch_scc0 Lt_8
s_lshl_b32 s44, s44, 20
s_min_u32 s44, s44, 24117184
s_load_dword s3, s[82:83], s44 glc
Lt_8:
s_sub_u32 s44, s43, 24
s_and_b32 s44, s44, 127
s_cmp_lt_u32 s44, 8
s_cbranch_scc0 Lt_9
s_lshl_b32 s44, s44, 20
s_min_u32 s44, s44, 7339968
s_load_dword s3, s[72:73], s44
Lt_9:
s_sub_u32 s44, s43, 32
s_and_b32 s44, s44, 127
s_cmp_lt_u32 s44, 8
s_cbranch_scc0 Lt_10
s_lshl_b32 s44, s44, 20
s_min_u32 s44, s44, 7339968
s_load_dword s3, s[74:75], s44
Lt_10:
s_sub_u32 s44, s43, 40
s_and_b32 s44, s44, 127
s_cmp_lt_u32 s44, 3
s_cbranch_scc0 Lt_11
s_lshl_b32 s44, s44, 20
s_min_u32 s44, s44, 2097088
s_load_dword s3, s[68:69], s44
Lt_11:
s_sub_u32 s44, s43, 43
s_and_b32 s44, s44, 127
s_cmp_lt_u32 s44, 5
s_cbranch_scc0 Lt_12
s_lshl_b32 s44, s44, 20
s_min_u32 s44, s44, 4194240
s_add_u32 s44, s44, 25165824
s_load_dword s3, s[82:83], s44 glc
Lt_12:
s_sub_u32 s44, s43, 48
s_and_b32 s44, s44, 127
s_cmp_lt_u32 s44, 8
s_cbranch_scc0 Lt_13
s_lshl_b32 s44, s44, 20
s_min_u32 s44, s44, 7339968
s_load_dword s3, s[76:77], s44
Lt_13:
s_sub_u32 s44, s43, 56
s_and_b32 s44, s44, 127
s_cmp_lt_u32 s44, 5
s_cbranch_scc0 Lt_14
s_lshl_b32 s44, s44, 20
s_min_u32 s44, s44, 4194240
s_add_u32 s44, s44, 33554432
s_load_dword s3, s[82:83], s44 glc
Lt_14:
s_sub_u32 s44, s43, 61
s_and_b32 s44, s44, 127
s_cmp_lt_u32 s44, 5
s_cbranch_scc0 Lt_15
s_lshl_b32 s44, s44, 20
s_min_u32 s44, s44, 4194240
s_load_dword s3, s[78:79], s44 glc
Lt_15:
v_lshrrev_b32 v16, 1, v12
v_xor_b32 v15, v13, v16
v_lshlrev_b32 v15, 4, v15
v_lshl_add_u32 v2, v12, 7, v15
v_xor_b32 v3, 64, v2
v_add_u32 v4, 86016, v2
v_add_u32 v5, 86016, v3
v_lshrrev_b32 v15, 2, v12
v_and_b32 v16, 3, v1
v_lshl_add_u32 v19, v13, 3, v15
v_lshlrev_b32 v19, 7, v19
v_and_b32 v15, 2, v15
v_and_b32 v17, 1, v13
v_lshl_add_u32 v15, v17, 2, v15
v_lshrrev_b32 v17, 1, v16
s_lshl_b32 s43, s36, 1
v_add_u32 v17, s43, v17
v_xor_b32 v15, v15, v17
v_lshl_add_u32 v19, v15, 4, v19
v_and_b32 v16, 1, v16
v_lshl_add_u32 v19, v16, 3, v19
v_add_u32 v6, 18432, v19
v_add_u32 v7, 61440, v19
v_add_u32 v8, 104448, v19
s_and_b32 s43, s36, 1
s_bfe_u32 s44, s36, 0x10001
s_lshr_b32 s45, s36, 2
v_lshlrev_b32 v14, 2, v13
v_sub_u32 v14, v12, v14
v_mov_b32 v16, 0xff800000
s_or_b32 s46, s34, s45
s_cmp_lg_u32 s46, 0
s_cselect_b32 s46, 0, 0xff800000
v_subrev_u32 v15, 0, v14
v_cmp_ge_u32 vcc, 7, v15
v_add_u32 v15, 16, v15
s_nop 0
v_cndmask_b32 v248, v16, 0, vcc
v_cmp_ge_u32 vcc, 7, v15
s_nop 1
v_cndmask_b32 v244, v16, 0, vcc
v_or_b32 v240, s46, v244
v_subrev_u32 v15, 1, v14
v_cmp_ge_u32 vcc, 7, v15
v_add_u32 v15, 16, v15
s_nop 0
v_cndmask_b32 v249, v16, 0, vcc
v_cmp_ge_u32 vcc, 7, v15
s_nop 1
v_cndmask_b32 v245, v16, 0, vcc
v_or_b32 v241, s46, v245
v_subrev_u32 v15, 2, v14
v_cmp_ge_u32 vcc, 7, v15
v_add_u32 v15, 16, v15
s_nop 0
v_cndmask_b32 v250, v16, 0, vcc
v_cmp_ge_u32 vcc, 7, v15
s_nop 1
v_cndmask_b32 v246, v16, 0, vcc
v_or_b32 v242, s46, v246
v_subrev_u32 v15, 3, v14
v_cmp_ge_u32 vcc, 7, v15
v_add_u32 v15, 16, v15
s_nop 0
v_cndmask_b32 v251, v16, 0, vcc
v_cmp_ge_u32 vcc, 7, v15
s_nop 1
v_cndmask_b32 v247, v16, 0, vcc
v_or_b32 v243, s46, v247
s_lshl_b32 s46, s45, 6
s_add_u32 s46, s46, s44
s_add_u32 s46, s46, 16
v_lshl_add_u32 v14, v12, 1, s46
s_lshl_b32 s47, s43, 6
v_lshl_add_u32 v15, v13, 4, s47
v_mul_u32_u24 v20, 400, v14
v_add_u32 v20, v20, v15
v_subrev_u32 v16, 32, v14
v_max_i32 v16, 0, v16
v_mul_u32_u24 v21, 400, v16
v_add_u32 v21, v21, v15
v_lshrrev_b32 v16, 2, v12
v_lshl_add_u32 v16, v13, 2, v16
v_lshl_add_u32 v16, v16, 1, s46
v_and_b32 v17, 3, v1
v_lshl_add_u32 v17, v17, 3, s47
v_mul_u32_u24 v22, 400, v16
v_add_u32 v22, v22, v17
v_subrev_u32 v16, 32, v16
v_max_i32 v16, 0, v16
v_mul_u32_u24 v23, 400, v16
v_add_u32 v23, v23, v17
s_mul_i32 s60, s34, 262144
s_add_u32 s16, s82, s60
s_addc_u32 s17, s83, 0
s_mov_b32 s18, 262144
s_mov_b32 s19, 0x20000
s_lshl_b32 s60, s35, 14
s_lshl_b32 s43, s43, 13
s_add_u32 s60, s60, s43
s_lshl_b32 s43, s45, 12
s_add_u32 s60, s60, s43
s_lshl_b32 s43, s44, 10
s_add_u32 s60, s60, s43
v_lshlrev_b32 v24, 4, v1
s_mov_b32 s61, 0x3e8293ee
s_lshl_b32 s38, s35, 7
s_add_u32 s56, s82, 28311552
s_addc_u32 s57, s83, 0
s_mov_b32 s58, 114688
s_mov_b32 s59, 0x20000
s_barrier
ds_read_b128 v[32:35], v2 offset:0
ds_read_b64_tr_b16 v[72:73], v6 offset:8192
ds_read_b64_tr_b16 v[74:75], v6 offset:8704
ds_read_b64_tr_b16 v[76:77], v6 offset:16384
ds_read_b64_tr_b16 v[78:79], v6 offset:16896
ds_read_b64_tr_b16 v[68:69], v6 offset:0
ds_read_b64_tr_b16 v[70:71], v6 offset:512
ds_read_b128 v[36:39], v2 offset:2048
ds_read_b128 v[40:43], v2 offset:4096
ds_read_b128 v[44:47], v2 offset:6144
ds_read_b128 v[48:51], v2 offset:8192
ds_read_b128 v[52:55], v2 offset:10240
ds_read_b128 v[56:59], v2 offset:12288
ds_read_b128 v[60:63], v2 offset:14336
ds_read_b128 v[64:67], v2 offset:16384
s_waitcnt lgkmcnt(0)
v_mfma_f32_16x16x32_bf16 v[128:131], v[68:71], v[32:35], 0
ds_read_b128 v[80:83], v3 offset:0
v_mfma_f32_16x16x32_bf16 v[132:135], v[68:71], v[36:39], 0
ds_read_b64_tr_b16 v[120:121], v6 offset:12288
v_mfma_f32_16x16x32_bf16 v[136:139], v[68:71], v[40:43], 0
ds_read_b64_tr_b16 v[122:123], v6 offset:12800
v_mfma_f32_16x16x32_bf16 v[140:143], v[68:71], v[44:47], 0
ds_read_b64_tr_b16 v[124:125], v6 offset:20480
v_mfma_f32_16x16x32_bf16 v[144:147], v[68:71], v[48:51], 0
ds_read_b64_tr_b16 v[126:127], v6 offset:20992
v_mfma_f32_16x16x32_bf16 v[148:151], v[68:71], v[52:55], 0
ds_read_b64_tr_b16 v[116:117], v6 offset:4096
v_mfma_f32_16x16x32_bf16 v[152:155], v[68:71], v[56:59], 0
ds_read_b64_tr_b16 v[118:119], v6 offset:4608
v_mfma_f32_16x16x32_bf16 v[156:159], v[68:71], v[60:63], 0
ds_read_b128 v[84:87], v3 offset:2048
v_mfma_f32_16x16x32_bf16 v[160:163], v[68:71], v[64:67], 0
ds_read_b128 v[88:91], v3 offset:4096
v_mfma_f32_16x16x32_bf16 v[196:199], v[72:75], v[64:67], 0
ds_read_b128 v[92:95], v3 offset:6144
v_mfma_f32_16x16x32_bf16 v[192:195], v[72:75], v[60:63], 0
ds_read_b128 v[96:99], v3 offset:8192
v_mfma_f32_16x16x32_bf16 v[188:191], v[72:75], v[56:59], 0
ds_read_b128 v[100:103], v3 offset:10240
v_mfma_f32_16x16x32_bf16 v[184:187], v[72:75], v[52:55], 0
ds_read_b128 v[104:107], v3 offset:12288
v_mfma_f32_16x16x32_bf16 v[180:183], v[72:75], v[48:51], 0
ds_read_b128 v[108:111], v3 offset:14336
v_mfma_f32_16x16x32_bf16 v[176:179], v[72:75], v[44:47], 0
ds_read_b128 v[112:115], v3 offset:16384
v_mfma_f32_16x16x32_bf16 v[172:175], v[72:75], v[40:43], 0
v_mfma_f32_16x16x32_bf16 v[168:171], v[72:75], v[36:39], 0
v_mfma_f32_16x16x32_bf16 v[164:167], v[72:75], v[32:35], 0
v_mfma_f32_16x16x32_bf16 v[200:203], v[76:79], v[32:35], 0
v_mfma_f32_16x16x32_bf16 v[204:207], v[76:79], v[36:39], 0
v_mfma_f32_16x16x32_bf16 v[208:211], v[76:79], v[40:43], 0
v_mfma_f32_16x16x32_bf16 v[212:215], v[76:79], v[44:47], 0
v_mfma_f32_16x16x32_bf16 v[216:219], v[76:79], v[48:51], 0
v_mfma_f32_16x16x32_bf16 v[220:223], v[76:79], v[52:55], 0
v_mfma_f32_16x16x32_bf16 v[224:227], v[76:79], v[56:59], 0
v_mfma_f32_16x16x32_bf16 v[228:231], v[76:79], v[60:63], 0
v_mfma_f32_16x16x32_bf16 v[232:235], v[76:79], v[64:67], 0
s_waitcnt lgkmcnt(0)
s_barrier
v_mfma_f32_16x16x32_bf16 v[128:131], v[116:119], v[80:83], v[128:131]
ds_read_b128 v[32:35], v2 offset:43008
v_mfma_f32_16x16x32_bf16 v[132:135], v[116:119], v[84:87], v[132:135]
ds_read_b64_tr_b16 v[72:73], v7 offset:8192
v_mfma_f32_16x16x32_bf16 v[136:139], v[116:119], v[88:91], v[136:139]
ds_read_b64_tr_b16 v[74:75], v7 offset:8704
v_mfma_f32_16x16x32_bf16 v[140:143], v[116:119], v[92:95], v[140:143]
ds_read_b64_tr_b16 v[76:77], v7 offset:16384
v_mfma_f32_16x16x32_bf16 v[144:147], v[116:119], v[96:99], v[144:147]
ds_read_b64_tr_b16 v[78:79], v7 offset:16896
v_mfma_f32_16x16x32_bf16 v[148:151], v[116:119], v[100:103], v[148:151]
ds_read_b64_tr_b16 v[68:69], v7 offset:0
v_mfma_f32_16x16x32_bf16 v[152:155], v[116:119], v[104:107], v[152:155]
ds_read_b64_tr_b16 v[70:71], v7 offset:512
v_mfma_f32_16x16x32_bf16 v[156:159], v[116:119], v[108:111], v[156:159]
ds_read_b128 v[36:39], v2 offset:45056
v_mfma_f32_16x16x32_bf16 v[160:163], v[116:119], v[112:115], v[160:163]
ds_read_b128 v[40:43], v2 offset:47104
v_mfma_f32_16x16x32_bf16 v[196:199], v[120:123], v[112:115], v[196:199]
ds_read_b128 v[44:47], v2 offset:49152
v_mfma_f32_16x16x32_bf16 v[192:195], v[120:123], v[108:111], v[192:195]
ds_read_b128 v[48:51], v2 offset:51200
v_mfma_f32_16x16x32_bf16 v[188:191], v[120:123], v[104:107], v[188:191]
ds_read_b128 v[52:55], v2 offset:53248
v_mfma_f32_16x16x32_bf16 v[184:187], v[120:123], v[100:103], v[184:187]
ds_read_b128 v[56:59], v2 offset:55296
v_mfma_f32_16x16x32_bf16 v[180:183], v[120:123], v[96:99], v[180:183]
ds_read_b128 v[60:63], v2 offset:57344
v_mfma_f32_16x16x32_bf16 v[176:179], v[120:123], v[92:95], v[176:179]
ds_read_b128 v[64:67], v2 offset:59392
v_mfma_f32_16x16x32_bf16 v[172:175], v[120:123], v[88:91], v[172:175]
v_mfma_f32_16x16x32_bf16 v[168:171], v[120:123], v[84:87], v[168:171]
v_mfma_f32_16x16x32_bf16 v[164:167], v[120:123], v[80:83], v[164:167]
v_mfma_f32_16x16x32_bf16 v[200:203], v[124:127], v[80:83], v[200:203]
v_mfma_f32_16x16x32_bf16 v[204:207], v[124:127], v[84:87], v[204:207]
v_mfma_f32_16x16x32_bf16 v[208:211], v[124:127], v[88:91], v[208:211]
v_mfma_f32_16x16x32_bf16 v[212:215], v[124:127], v[92:95], v[212:215]
v_mfma_f32_16x16x32_bf16 v[216:219], v[124:127], v[96:99], v[216:219]
v_mfma_f32_16x16x32_bf16 v[220:223], v[124:127], v[100:103], v[220:223]
v_mfma_f32_16x16x32_bf16 v[224:227], v[124:127], v[104:107], v[224:227]
v_mfma_f32_16x16x32_bf16 v[228:231], v[124:127], v[108:111], v[228:231]
v_mfma_f32_16x16x32_bf16 v[232:235], v[124:127], v[112:115], v[232:235]
s_waitcnt lgkmcnt(0)
v_mfma_f32_16x16x32_bf16 v[128:131], v[68:71], v[32:35], v[128:131]
ds_read_b128 v[80:83], v3 offset:43008
v_mfma_f32_16x16x32_bf16 v[132:135], v[68:71], v[36:39], v[132:135]
ds_read_b64_tr_b16 v[120:121], v7 offset:12288
v_mfma_f32_16x16x32_bf16 v[136:139], v[68:71], v[40:43], v[136:139]
ds_read_b64_tr_b16 v[122:123], v7 offset:12800
v_mfma_f32_16x16x32_bf16 v[140:143], v[68:71], v[44:47], v[140:143]
ds_read_b64_tr_b16 v[124:125], v7 offset:20480
v_mfma_f32_16x16x32_bf16 v[144:147], v[68:71], v[48:51], v[144:147]
ds_read_b64_tr_b16 v[126:127], v7 offset:20992
v_mfma_f32_16x16x32_bf16 v[148:151], v[68:71], v[52:55], v[148:151]
ds_read_b64_tr_b16 v[116:117], v7 offset:4096
v_mfma_f32_16x16x32_bf16 v[152:155], v[68:71], v[56:59], v[152:155]
ds_read_b64_tr_b16 v[118:119], v7 offset:4608
v_mfma_f32_16x16x32_bf16 v[156:159], v[68:71], v[60:63], v[156:159]
ds_read_b128 v[84:87], v3 offset:45056
v_mfma_f32_16x16x32_bf16 v[160:163], v[68:71], v[64:67], v[160:163]
ds_read_b128 v[88:91], v3 offset:47104
v_mfma_f32_16x16x32_bf16 v[196:199], v[72:75], v[64:67], v[196:199]
ds_read_b128 v[92:95], v3 offset:49152
v_mfma_f32_16x16x32_bf16 v[192:195], v[72:75], v[60:63], v[192:195]
ds_read_b128 v[96:99], v3 offset:51200
v_mfma_f32_16x16x32_bf16 v[188:191], v[72:75], v[56:59], v[188:191]
ds_read_b128 v[100:103], v3 offset:53248
v_mfma_f32_16x16x32_bf16 v[184:187], v[72:75], v[52:55], v[184:187]
ds_read_b128 v[104:107], v3 offset:55296
v_mfma_f32_16x16x32_bf16 v[180:183], v[72:75], v[48:51], v[180:183]
ds_read_b128 v[108:111], v3 offset:57344
v_mfma_f32_16x16x32_bf16 v[176:179], v[72:75], v[44:47], v[176:179]
ds_read_b128 v[112:115], v3 offset:59392
v_mfma_f32_16x16x32_bf16 v[172:175], v[72:75], v[40:43], v[172:175]
v_mfma_f32_16x16x32_bf16 v[168:171], v[72:75], v[36:39], v[168:171]
v_mfma_f32_16x16x32_bf16 v[164:167], v[72:75], v[32:35], v[164:167]
v_mfma_f32_16x16x32_bf16 v[200:203], v[76:79], v[32:35], v[200:203]
v_mfma_f32_16x16x32_bf16 v[204:207], v[76:79], v[36:39], v[204:207]
v_mfma_f32_16x16x32_bf16 v[208:211], v[76:79], v[40:43], v[208:211]
v_mfma_f32_16x16x32_bf16 v[212:215], v[76:79], v[44:47], v[212:215]
v_mfma_f32_16x16x32_bf16 v[216:219], v[76:79], v[48:51], v[216:219]
v_mfma_f32_16x16x32_bf16 v[220:223], v[76:79], v[52:55], v[220:223]
v_mfma_f32_16x16x32_bf16 v[224:227], v[76:79], v[56:59], v[224:227]
v_mfma_f32_16x16x32_bf16 v[228:231], v[76:79], v[60:63], v[228:231]
v_mfma_f32_16x16x32_bf16 v[232:235], v[76:79], v[64:67], v[232:235]
s_waitcnt lgkmcnt(0)
s_barrier
v_mfma_f32_16x16x32_bf16 v[128:131], v[116:119], v[80:83], v[128:131]
ds_read_b128 v[32:35], v4 offset:0
v_mfma_f32_16x16x32_bf16 v[132:135], v[116:119], v[84:87], v[132:135]
ds_read_b64_tr_b16 v[72:73], v8 offset:8192
v_mfma_f32_16x16x32_bf16 v[136:139], v[116:119], v[88:91], v[136:139]
ds_read_b64_tr_b16 v[74:75], v8 offset:8704
v_mfma_f32_16x16x32_bf16 v[140:143], v[116:119], v[92:95], v[140:143]
ds_read_b64_tr_b16 v[76:77], v8 offset:16384
v_mfma_f32_16x16x32_bf16 v[144:147], v[116:119], v[96:99], v[144:147]
ds_read_b64_tr_b16 v[78:79], v8 offset:16896
v_mfma_f32_16x16x32_bf16 v[148:151], v[116:119], v[100:103], v[148:151]
ds_read_b64_tr_b16 v[68:69], v8 offset:0
v_mfma_f32_16x16x32_bf16 v[152:155], v[116:119], v[104:107], v[152:155]
ds_read_b64_tr_b16 v[70:71], v8 offset:512
v_mfma_f32_16x16x32_bf16 v[156:159], v[116:119], v[108:111], v[156:159]
ds_read_b128 v[36:39], v4 offset:2048
v_mfma_f32_16x16x32_bf16 v[160:163], v[116:119], v[112:115], v[160:163]
ds_read_b128 v[40:43], v4 offset:4096
v_mfma_f32_16x16x32_bf16 v[196:199], v[120:123], v[112:115], v[196:199]
ds_read_b128 v[44:47], v4 offset:6144
v_mfma_f32_16x16x32_bf16 v[192:195], v[120:123], v[108:111], v[192:195]
ds_read_b128 v[48:51], v4 offset:8192
v_mfma_f32_16x16x32_bf16 v[188:191], v[120:123], v[104:107], v[188:191]
ds_read_b128 v[52:55], v4 offset:10240
v_mfma_f32_16x16x32_bf16 v[184:187], v[120:123], v[100:103], v[184:187]
ds_read_b128 v[56:59], v4 offset:12288
v_mfma_f32_16x16x32_bf16 v[180:183], v[120:123], v[96:99], v[180:183]
ds_read_b128 v[60:63], v4 offset:14336
v_mfma_f32_16x16x32_bf16 v[176:179], v[120:123], v[92:95], v[176:179]
ds_read_b128 v[64:67], v4 offset:16384
v_mfma_f32_16x16x32_bf16 v[172:175], v[120:123], v[88:91], v[172:175]
v_mfma_f32_16x16x32_bf16 v[168:171], v[120:123], v[84:87], v[168:171]
v_mfma_f32_16x16x32_bf16 v[164:167], v[120:123], v[80:83], v[164:167]
v_mfma_f32_16x16x32_bf16 v[200:203], v[124:127], v[80:83], v[200:203]
v_mfma_f32_16x16x32_bf16 v[204:207], v[124:127], v[84:87], v[204:207]
v_mfma_f32_16x16x32_bf16 v[208:211], v[124:127], v[88:91], v[208:211]
v_mfma_f32_16x16x32_bf16 v[212:215], v[124:127], v[92:95], v[212:215]
v_mfma_f32_16x16x32_bf16 v[216:219], v[124:127], v[96:99], v[216:219]
v_mfma_f32_16x16x32_bf16 v[220:223], v[124:127], v[100:103], v[220:223]
v_mfma_f32_16x16x32_bf16 v[224:227], v[124:127], v[104:107], v[224:227]
v_mfma_f32_16x16x32_bf16 v[228:231], v[124:127], v[108:111], v[228:231]
v_mfma_f32_16x16x32_bf16 v[232:235], v[124:127], v[112:115], v[232:235]
s_waitcnt lgkmcnt(0)
v_mfma_f32_16x16x32_bf16 v[128:131], v[68:71], v[32:35], v[128:131]
ds_read_b128 v[80:83], v5 offset:0
v_mfma_f32_16x16x32_bf16 v[132:135], v[68:71], v[36:39], v[132:135]
ds_read_b64_tr_b16 v[120:121], v8 offset:12288
v_mfma_f32_16x16x32_bf16 v[136:139], v[68:71], v[40:43], v[136:139]
ds_read_b64_tr_b16 v[122:123], v8 offset:12800
v_mfma_f32_16x16x32_bf16 v[140:143], v[68:71], v[44:47], v[140:143]
ds_read_b64_tr_b16 v[124:125], v8 offset:20480
v_mfma_f32_16x16x32_bf16 v[144:147], v[68:71], v[48:51], v[144:147]
ds_read_b64_tr_b16 v[126:127], v8 offset:20992
v_mfma_f32_16x16x32_bf16 v[148:151], v[68:71], v[52:55], v[148:151]
ds_read_b64_tr_b16 v[116:117], v8 offset:4096
v_mfma_f32_16x16x32_bf16 v[152:155], v[68:71], v[56:59], v[152:155]
ds_read_b64_tr_b16 v[118:119], v8 offset:4608
v_mfma_f32_16x16x32_bf16 v[156:159], v[68:71], v[60:63], v[156:159]
ds_read_b128 v[84:87], v5 offset:2048
v_mfma_f32_16x16x32_bf16 v[160:163], v[68:71], v[64:67], v[160:163]
ds_read_b128 v[88:91], v5 offset:4096
v_mfma_f32_16x16x32_bf16 v[196:199], v[72:75], v[64:67], v[196:199]
ds_read_b128 v[92:95], v5 offset:6144
v_mfma_f32_16x16x32_bf16 v[192:195], v[72:75], v[60:63], v[192:195]
ds_read_b128 v[96:99], v5 offset:8192
v_mfma_f32_16x16x32_bf16 v[188:191], v[72:75], v[56:59], v[188:191]
ds_read_b128 v[100:103], v5 offset:10240
v_mfma_f32_16x16x32_bf16 v[184:187], v[72:75], v[52:55], v[184:187]
ds_read_b128 v[104:107], v5 offset:12288
v_mfma_f32_16x16x32_bf16 v[180:183], v[72:75], v[48:51], v[180:183]
ds_read_b128 v[108:111], v5 offset:14336
v_mfma_f32_16x16x32_bf16 v[176:179], v[72:75], v[44:47], v[176:179]
ds_read_b128 v[112:115], v5 offset:16384
v_mfma_f32_16x16x32_bf16 v[172:175], v[72:75], v[40:43], v[172:175]
v_mfma_f32_16x16x32_bf16 v[168:171], v[72:75], v[36:39], v[168:171]
v_mfma_f32_16x16x32_bf16 v[164:167], v[72:75], v[32:35], v[164:167]
v_mfma_f32_16x16x32_bf16 v[200:203], v[76:79], v[32:35], v[200:203]
v_mfma_f32_16x16x32_bf16 v[204:207], v[76:79], v[36:39], v[204:207]
v_mfma_f32_16x16x32_bf16 v[208:211], v[76:79], v[40:43], v[208:211]
v_mfma_f32_16x16x32_bf16 v[212:215], v[76:79], v[44:47], v[212:215]
v_mfma_f32_16x16x32_bf16 v[216:219], v[76:79], v[48:51], v[216:219]
v_mfma_f32_16x16x32_bf16 v[220:223], v[76:79], v[52:55], v[220:223]
v_mfma_f32_16x16x32_bf16 v[224:227], v[76:79], v[56:59], v[224:227]
v_mfma_f32_16x16x32_bf16 v[228:231], v[76:79], v[60:63], v[228:231]
v_mfma_f32_16x16x32_bf16 v[232:235], v[76:79], v[64:67], v[232:235]
s_waitcnt lgkmcnt(0)
s_barrier
v_mfma_f32_16x16x32_bf16 v[128:131], v[116:119], v[80:83], v[128:131]
ds_read_b128 v[32:35], v2 offset:0
v_mfma_f32_16x16x32_bf16 v[132:135], v[116:119], v[84:87], v[132:135]
ds_read_b64_tr_b16 v[72:73], v6 offset:8192
v_mfma_f32_16x16x32_bf16 v[136:139], v[116:119], v[88:91], v[136:139]
ds_read_b64_tr_b16 v[74:75], v6 offset:8704
v_mfma_f32_16x16x32_bf16 v[140:143], v[116:119], v[92:95], v[140:143]
ds_read_b64_tr_b16 v[76:77], v6 offset:16384
v_mfma_f32_16x16x32_bf16 v[144:147], v[116:119], v[96:99], v[144:147]
ds_read_b64_tr_b16 v[78:79], v6 offset:16896
v_mfma_f32_16x16x32_bf16 v[148:151], v[116:119], v[100:103], v[148:151]
ds_read_b64_tr_b16 v[68:69], v6 offset:0
v_mfma_f32_16x16x32_bf16 v[152:155], v[116:119], v[104:107], v[152:155]
ds_read_b64_tr_b16 v[70:71], v6 offset:512
v_mfma_f32_16x16x32_bf16 v[156:159], v[116:119], v[108:111], v[156:159]
ds_read_b128 v[36:39], v2 offset:2048
v_mfma_f32_16x16x32_bf16 v[160:163], v[116:119], v[112:115], v[160:163]
ds_read_b128 v[40:43], v2 offset:4096
v_mfma_f32_16x16x32_bf16 v[196:199], v[120:123], v[112:115], v[196:199]
ds_read_b128 v[44:47], v2 offset:6144
v_mfma_f32_16x16x32_bf16 v[192:195], v[120:123], v[108:111], v[192:195]
ds_read_b128 v[48:51], v2 offset:8192
v_mfma_f32_16x16x32_bf16 v[188:191], v[120:123], v[104:107], v[188:191]
ds_read_b128 v[52:55], v2 offset:10240
v_mfma_f32_16x16x32_bf16 v[184:187], v[120:123], v[100:103], v[184:187]
ds_read_b128 v[56:59], v2 offset:12288
v_mfma_f32_16x16x32_bf16 v[180:183], v[120:123], v[96:99], v[180:183]
ds_read_b128 v[60:63], v2 offset:14336
v_mfma_f32_16x16x32_bf16 v[176:179], v[120:123], v[92:95], v[176:179]
ds_read_b128 v[64:67], v2 offset:16384
v_mfma_f32_16x16x32_bf16 v[172:175], v[120:123], v[88:91], v[172:175]
v_mfma_f32_16x16x32_bf16 v[168:171], v[120:123], v[84:87], v[168:171]
v_mfma_f32_16x16x32_bf16 v[164:167], v[120:123], v[80:83], v[164:167]
v_mfma_f32_16x16x32_bf16 v[200:203], v[124:127], v[80:83], v[200:203]
v_mfma_f32_16x16x32_bf16 v[204:207], v[124:127], v[84:87], v[204:207]
v_mfma_f32_16x16x32_bf16 v[208:211], v[124:127], v[88:91], v[208:211]
v_mfma_f32_16x16x32_bf16 v[212:215], v[124:127], v[92:95], v[212:215]
v_mfma_f32_16x16x32_bf16 v[216:219], v[124:127], v[96:99], v[216:219]
v_mfma_f32_16x16x32_bf16 v[220:223], v[124:127], v[100:103], v[220:223]
v_mfma_f32_16x16x32_bf16 v[224:227], v[124:127], v[104:107], v[224:227]
v_mfma_f32_16x16x32_bf16 v[228:231], v[124:127], v[108:111], v[228:231]
v_mfma_f32_16x16x32_bf16 v[232:235], v[124:127], v[112:115], v[232:235]
s_mov_b32 s41, 4
Lcl_16:
s_waitcnt lgkmcnt(0)
v_mfma_f32_16x16x32_bf16 v[128:131], v[68:71], v[32:35], v[128:131]
ds_read_b128 v[80:83], v3 offset:0
v_mfma_f32_16x16x32_bf16 v[132:135], v[68:71], v[36:39], v[132:135]
ds_read_b64_tr_b16 v[120:121], v6 offset:12288
v_mfma_f32_16x16x32_bf16 v[136:139], v[68:71], v[40:43], v[136:139]
ds_read_b64_tr_b16 v[122:123], v6 offset:12800
v_mfma_f32_16x16x32_bf16 v[140:143], v[68:71], v[44:47], v[140:143]
ds_read_b64_tr_b16 v[124:125], v6 offset:20480
v_mfma_f32_16x16x32_bf16 v[144:147], v[68:71], v[48:51], v[144:147]
ds_read_b64_tr_b16 v[126:127], v6 offset:20992
v_mfma_f32_16x16x32_bf16 v[148:151], v[68:71], v[52:55], v[148:151]
ds_read_b64_tr_b16 v[116:117], v6 offset:4096
v_mfma_f32_16x16x32_bf16 v[152:155], v[68:71], v[56:59], v[152:155]
ds_read_b64_tr_b16 v[118:119], v6 offset:4608
v_mfma_f32_16x16x32_bf16 v[156:159], v[68:71], v[60:63], v[156:159]
ds_read_b128 v[84:87], v3 offset:2048
v_mfma_f32_16x16x32_bf16 v[160:163], v[68:71], v[64:67], v[160:163]
ds_read_b128 v[88:91], v3 offset:4096
v_mfma_f32_16x16x32_bf16 v[196:199], v[72:75], v[64:67], v[196:199]
ds_read_b128 v[92:95], v3 offset:6144
v_mfma_f32_16x16x32_bf16 v[192:195], v[72:75], v[60:63], v[192:195]
ds_read_b128 v[96:99], v3 offset:8192
v_mfma_f32_16x16x32_bf16 v[188:191], v[72:75], v[56:59], v[188:191]
ds_read_b128 v[100:103], v3 offset:10240
v_mfma_f32_16x16x32_bf16 v[184:187], v[72:75], v[52:55], v[184:187]
ds_read_b128 v[104:107], v3 offset:12288
v_mfma_f32_16x16x32_bf16 v[180:183], v[72:75], v[48:51], v[180:183]
ds_read_b128 v[108:111], v3 offset:14336
v_mfma_f32_16x16x32_bf16 v[176:179], v[72:75], v[44:47], v[176:179]
ds_read_b128 v[112:115], v3 offset:16384
v_mfma_f32_16x16x32_bf16 v[172:175], v[72:75], v[40:43], v[172:175]
v_mfma_f32_16x16x32_bf16 v[168:171], v[72:75], v[36:39], v[168:171]
v_mfma_f32_16x16x32_bf16 v[164:167], v[72:75], v[32:35], v[164:167]
v_mfma_f32_16x16x32_bf16 v[200:203], v[76:79], v[32:35], v[200:203]
v_mfma_f32_16x16x32_bf16 v[204:207], v[76:79], v[36:39], v[204:207]
v_mfma_f32_16x16x32_bf16 v[208:211], v[76:79], v[40:43], v[208:211]
v_mfma_f32_16x16x32_bf16 v[212:215], v[76:79], v[44:47], v[212:215]
v_mfma_f32_16x16x32_bf16 v[216:219], v[76:79], v[48:51], v[216:219]
v_mfma_f32_16x16x32_bf16 v[220:223], v[76:79], v[52:55], v[220:223]
v_mfma_f32_16x16x32_bf16 v[224:227], v[76:79], v[56:59], v[224:227]
v_mfma_f32_16x16x32_bf16 v[228:231], v[76:79], v[60:63], v[228:231]
v_mfma_f32_16x16x32_bf16 v[232:235], v[76:79], v[64:67], v[232:235]
s_waitcnt lgkmcnt(0)
s_barrier
s_branch Lov_2
.p2align 12
.fill 16, 4, 0xbf800000
Lst_2_0:
s_branch Lwr_142
s_nop 0
s_nop 0
Lov_2:
v_mfma_f32_16x16x32_bf16 v[128:131], v[116:119], v[80:83], v[128:131]
ds_read_b128 v[32:35], v2 offset:43008
v_mfma_f32_16x16x32_bf16 v[132:135], v[116:119], v[84:87], v[132:135]
ds_read_b64_tr_b16 v[72:73], v7 offset:8192
v_mfma_f32_16x16x32_bf16 v[136:139], v[116:119], v[88:91], v[136:139]
ds_read_b64_tr_b16 v[74:75], v7 offset:8704
v_mfma_f32_16x16x32_bf16 v[140:143], v[116:119], v[92:95], v[140:143]
ds_read_b64_tr_b16 v[76:77], v7 offset:16384
v_mfma_f32_16x16x32_bf16 v[144:147], v[116:119], v[96:99], v[144:147]
ds_read_b64_tr_b16 v[78:79], v7 offset:16896
v_mfma_f32_16x16x32_bf16 v[148:151], v[116:119], v[100:103], v[148:151]
ds_read_b64_tr_b16 v[68:69], v7 offset:0
v_mfma_f32_16x16x32_bf16 v[152:155], v[116:119], v[104:107], v[152:155]
ds_read_b64_tr_b16 v[70:71], v7 offset:512
v_mfma_f32_16x16x32_bf16 v[156:159], v[116:119], v[108:111], v[156:159]
ds_read_b128 v[36:39], v2 offset:45056
v_mfma_f32_16x16x32_bf16 v[160:163], v[116:119], v[112:115], v[160:163]
ds_read_b128 v[40:43], v2 offset:47104
v_mfma_f32_16x16x32_bf16 v[196:199], v[120:123], v[112:115], v[196:199]
ds_read_b128 v[44:47], v2 offset:49152
v_mfma_f32_16x16x32_bf16 v[192:195], v[120:123], v[108:111], v[192:195]
ds_read_b128 v[48:51], v2 offset:51200
v_mfma_f32_16x16x32_bf16 v[188:191], v[120:123], v[104:107], v[188:191]
ds_read_b128 v[52:55], v2 offset:53248
v_mfma_f32_16x16x32_bf16 v[184:187], v[120:123], v[100:103], v[184:187]
ds_read_b128 v[56:59], v2 offset:55296
v_mfma_f32_16x16x32_bf16 v[180:183], v[120:123], v[96:99], v[180:183]
ds_read_b128 v[60:63], v2 offset:57344
v_mfma_f32_16x16x32_bf16 v[176:179], v[120:123], v[92:95], v[176:179]
ds_read_b128 v[64:67], v2 offset:59392
v_mfma_f32_16x16x32_bf16 v[172:175], v[120:123], v[88:91], v[172:175]
v_mfma_f32_16x16x32_bf16 v[168:171], v[120:123], v[84:87], v[168:171]
v_mfma_f32_16x16x32_bf16 v[164:167], v[120:123], v[80:83], v[164:167]
v_mfma_f32_16x16x32_bf16 v[200:203], v[124:127], v[80:83], v[200:203]
v_mfma_f32_16x16x32_bf16 v[204:207], v[124:127], v[84:87], v[204:207]
v_mfma_f32_16x16x32_bf16 v[208:211], v[124:127], v[88:91], v[208:211]
v_mfma_f32_16x16x32_bf16 v[212:215], v[124:127], v[92:95], v[212:215]
v_mfma_f32_16x16x32_bf16 v[216:219], v[124:127], v[96:99], v[216:219]
v_mfma_f32_16x16x32_bf16 v[220:223], v[124:127], v[100:103], v[220:223]
v_mfma_f32_16x16x32_bf16 v[224:227], v[124:127], v[104:107], v[224:227]
v_mfma_f32_16x16x32_bf16 v[228:231], v[124:127], v[108:111], v[228:231]
v_mfma_f32_16x16x32_bf16 v[232:235], v[124:127], v[112:115], v[232:235]
s_waitcnt lgkmcnt(0)
v_mfma_f32_16x16x32_bf16 v[128:131], v[68:71], v[32:35], v[128:131]
ds_read_b128 v[80:83], v3 offset:43008
v_mfma_f32_16x16x32_bf16 v[132:135], v[68:71], v[36:39], v[132:135]
ds_read_b64_tr_b16 v[120:121], v7 offset:12288
v_mfma_f32_16x16x32_bf16 v[136:139], v[68:71], v[40:43], v[136:139]
ds_read_b64_tr_b16 v[122:123], v7 offset:12800
v_mfma_f32_16x16x32_bf16 v[140:143], v[68:71], v[44:47], v[140:143]
ds_read_b64_tr_b16 v[124:125], v7 offset:20480
v_mfma_f32_16x16x32_bf16 v[144:147], v[68:71], v[48:51], v[144:147]
ds_read_b64_tr_b16 v[126:127], v7 offset:20992
v_mfma_f32_16x16x32_bf16 v[148:151], v[68:71], v[52:55], v[148:151]
ds_read_b64_tr_b16 v[116:117], v7 offset:4096
v_mfma_f32_16x16x32_bf16 v[152:155], v[68:71], v[56:59], v[152:155]
ds_read_b64_tr_b16 v[118:119], v7 offset:4608
v_mfma_f32_16x16x32_bf16 v[156:159], v[68:71], v[60:63], v[156:159]
ds_read_b128 v[84:87], v3 offset:45056
v_mfma_f32_16x16x32_bf16 v[160:163], v[68:71], v[64:67], v[160:163]
ds_read_b128 v[88:91], v3 offset:47104
v_mfma_f32_16x16x32_bf16 v[196:199], v[72:75], v[64:67], v[196:199]
ds_read_b128 v[92:95], v3 offset:49152
v_mfma_f32_16x16x32_bf16 v[192:195], v[72:75], v[60:63], v[192:195]
ds_read_b128 v[96:99], v3 offset:51200
v_mfma_f32_16x16x32_bf16 v[188:191], v[72:75], v[56:59], v[188:191]
ds_read_b128 v[100:103], v3 offset:53248
v_mfma_f32_16x16x32_bf16 v[184:187], v[72:75], v[52:55], v[184:187]
ds_read_b128 v[104:107], v3 offset:55296
v_mfma_f32_16x16x32_bf16 v[180:183], v[72:75], v[48:51], v[180:183]
ds_read_b128 v[108:111], v3 offset:57344
v_mfma_f32_16x16x32_bf16 v[176:179], v[72:75], v[44:47], v[176:179]
ds_read_b128 v[112:115], v3 offset:59392
v_mfma_f32_16x16x32_bf16 v[172:175], v[72:75], v[40:43], v[172:175]
v_mfma_f32_16x16x32_bf16 v[168:171], v[72:75], v[36:39], v[168:171]
v_mfma_f32_16x16x32_bf16 v[164:167], v[72:75], v[32:35], v[164:167]
v_mfma_f32_16x16x32_bf16 v[200:203], v[76:79], v[32:35], v[200:203]
v_mfma_f32_16x16x32_bf16 v[204:207], v[76:79], v[36:39], v[204:207]
v_mfma_f32_16x16x32_bf16 v[208:211], v[76:79], v[40:43], v[208:211]
v_mfma_f32_16x16x32_bf16 v[212:215], v[76:79], v[44:47], v[212:215]
v_mfma_f32_16x16x32_bf16 v[216:219], v[76:79], v[48:51], v[216:219]
v_mfma_f32_16x16x32_bf16 v[220:223], v[76:79], v[52:55], v[220:223]
v_mfma_f32_16x16x32_bf16 v[224:227], v[76:79], v[56:59], v[224:227]
v_mfma_f32_16x16x32_bf16 v[228:231], v[76:79], v[60:63], v[228:231]
v_mfma_f32_16x16x32_bf16 v[232:235], v[76:79], v[64:67], v[232:235]
s_waitcnt lgkmcnt(0)
s_barrier
v_mfma_f32_16x16x32_bf16 v[128:131], v[116:119], v[80:83], v[128:131]
ds_read_b128 v[32:35], v4 offset:0
v_mfma_f32_16x16x32_bf16 v[132:135], v[116:119], v[84:87], v[132:135]
ds_read_b64_tr_b16 v[72:73], v8 offset:8192
v_mfma_f32_16x16x32_bf16 v[136:139], v[116:119], v[88:91], v[136:139]
ds_read_b64_tr_b16 v[74:75], v8 offset:8704
v_mfma_f32_16x16x32_bf16 v[140:143], v[116:119], v[92:95], v[140:143]
ds_read_b64_tr_b16 v[76:77], v8 offset:16384
v_mfma_f32_16x16x32_bf16 v[144:147], v[116:119], v[96:99], v[144:147]
ds_read_b64_tr_b16 v[78:79], v8 offset:16896
v_mfma_f32_16x16x32_bf16 v[148:151], v[116:119], v[100:103], v[148:151]
ds_read_b64_tr_b16 v[68:69], v8 offset:0
v_mfma_f32_16x16x32_bf16 v[152:155], v[116:119], v[104:107], v[152:155]
ds_read_b64_tr_b16 v[70:71], v8 offset:512
v_mfma_f32_16x16x32_bf16 v[156:159], v[116:119], v[108:111], v[156:159]
ds_read_b128 v[36:39], v4 offset:2048
v_mfma_f32_16x16x32_bf16 v[160:163], v[116:119], v[112:115], v[160:163]
ds_read_b128 v[40:43], v4 offset:4096
v_mfma_f32_16x16x32_bf16 v[196:199], v[120:123], v[112:115], v[196:199]
ds_read_b128 v[44:47], v4 offset:6144
v_mfma_f32_16x16x32_bf16 v[192:195], v[120:123], v[108:111], v[192:195]
ds_read_b128 v[48:51], v4 offset:8192
v_mfma_f32_16x16x32_bf16 v[188:191], v[120:123], v[104:107], v[188:191]
ds_read_b128 v[52:55], v4 offset:10240
v_mfma_f32_16x16x32_bf16 v[184:187], v[120:123], v[100:103], v[184:187]
ds_read_b128 v[56:59], v4 offset:12288
v_mfma_f32_16x16x32_bf16 v[180:183], v[120:123], v[96:99], v[180:183]
ds_read_b128 v[60:63], v4 offset:14336
v_mfma_f32_16x16x32_bf16 v[176:179], v[120:123], v[92:95], v[176:179]
ds_read_b128 v[64:67], v4 offset:16384
v_mfma_f32_16x16x32_bf16 v[172:175], v[120:123], v[88:91], v[172:175]
v_mfma_f32_16x16x32_bf16 v[168:171], v[120:123], v[84:87], v[168:171]
v_mfma_f32_16x16x32_bf16 v[164:167], v[120:123], v[80:83], v[164:167]
v_mfma_f32_16x16x32_bf16 v[200:203], v[124:127], v[80:83], v[200:203]
v_mfma_f32_16x16x32_bf16 v[204:207], v[124:127], v[84:87], v[204:207]
v_mfma_f32_16x16x32_bf16 v[208:211], v[124:127], v[88:91], v[208:211]
v_mfma_f32_16x16x32_bf16 v[212:215], v[124:127], v[92:95], v[212:215]
v_mfma_f32_16x16x32_bf16 v[216:219], v[124:127], v[96:99], v[216:219]
v_mfma_f32_16x16x32_bf16 v[220:223], v[124:127], v[100:103], v[220:223]
v_mfma_f32_16x16x32_bf16 v[224:227], v[124:127], v[104:107], v[224:227]
v_mfma_f32_16x16x32_bf16 v[228:231], v[124:127], v[108:111], v[228:231]
v_mfma_f32_16x16x32_bf16 v[232:235], v[124:127], v[112:115], v[232:235]
s_waitcnt lgkmcnt(0)
v_mfma_f32_16x16x32_bf16 v[128:131], v[68:71], v[32:35], v[128:131]
ds_read_b128 v[80:83], v5 offset:0
v_mfma_f32_16x16x32_bf16 v[132:135], v[68:71], v[36:39], v[132:135]
ds_read_b64_tr_b16 v[120:121], v8 offset:12288
v_mfma_f32_16x16x32_bf16 v[136:139], v[68:71], v[40:43], v[136:139]
ds_read_b64_tr_b16 v[122:123], v8 offset:12800
v_mfma_f32_16x16x32_bf16 v[140:143], v[68:71], v[44:47], v[140:143]
ds_read_b64_tr_b16 v[124:125], v8 offset:20480
v_mfma_f32_16x16x32_bf16 v[144:147], v[68:71], v[48:51], v[144:147]
ds_read_b64_tr_b16 v[126:127], v8 offset:20992
v_mfma_f32_16x16x32_bf16 v[148:151], v[68:71], v[52:55], v[148:151]
ds_read_b64_tr_b16 v[116:117], v8 offset:4096
v_mfma_f32_16x16x32_bf16 v[152:155], v[68:71], v[56:59], v[152:155]
ds_read_b64_tr_b16 v[118:119], v8 offset:4608
v_mfma_f32_16x16x32_bf16 v[156:159], v[68:71], v[60:63], v[156:159]
ds_read_b128 v[84:87], v5 offset:2048
v_mfma_f32_16x16x32_bf16 v[160:163], v[68:71], v[64:67], v[160:163]
ds_read_b128 v[88:91], v5 offset:4096
v_mfma_f32_16x16x32_bf16 v[196:199], v[72:75], v[64:67], v[196:199]
ds_read_b128 v[92:95], v5 offset:6144
v_mfma_f32_16x16x32_bf16 v[192:195], v[72:75], v[60:63], v[192:195]
ds_read_b128 v[96:99], v5 offset:8192
v_mfma_f32_16x16x32_bf16 v[188:191], v[72:75], v[56:59], v[188:191]
ds_read_b128 v[100:103], v5 offset:10240
v_mfma_f32_16x16x32_bf16 v[184:187], v[72:75], v[52:55], v[184:187]
ds_read_b128 v[104:107], v5 offset:12288
v_mfma_f32_16x16x32_bf16 v[180:183], v[72:75], v[48:51], v[180:183]
ds_read_b128 v[108:111], v5 offset:14336
v_mfma_f32_16x16x32_bf16 v[176:179], v[72:75], v[44:47], v[176:179]
ds_read_b128 v[112:115], v5 offset:16384
v_mfma_f32_16x16x32_bf16 v[172:175], v[72:75], v[40:43], v[172:175]
v_mfma_f32_16x16x32_bf16 v[168:171], v[72:75], v[36:39], v[168:171]
v_mfma_f32_16x16x32_bf16 v[164:167], v[72:75], v[32:35], v[164:167]
v_mfma_f32_16x16x32_bf16 v[200:203], v[76:79], v[32:35], v[200:203]
v_mfma_f32_16x16x32_bf16 v[204:207], v[76:79], v[36:39], v[204:207]
v_mfma_f32_16x16x32_bf16 v[208:211], v[76:79], v[40:43], v[208:211]
v_mfma_f32_16x16x32_bf16 v[212:215], v[76:79], v[44:47], v[212:215]
v_mfma_f32_16x16x32_bf16 v[216:219], v[76:79], v[48:51], v[216:219]
v_mfma_f32_16x16x32_bf16 v[220:223], v[76:79], v[52:55], v[220:223]
v_mfma_f32_16x16x32_bf16 v[224:227], v[76:79], v[56:59], v[224:227]
v_mfma_f32_16x16x32_bf16 v[228:231], v[76:79], v[60:63], v[228:231]
v_mfma_f32_16x16x32_bf16 v[232:235], v[76:79], v[64:67], v[232:235]
s_waitcnt lgkmcnt(0)
s_barrier
v_mfma_f32_16x16x32_bf16 v[128:131], v[116:119], v[80:83], v[128:131]
ds_read_b128 v[32:35], v2 offset:0
v_mfma_f32_16x16x32_bf16 v[132:135], v[116:119], v[84:87], v[132:135]
ds_read_b64_tr_b16 v[72:73], v6 offset:8192
v_mfma_f32_16x16x32_bf16 v[136:139], v[116:119], v[88:91], v[136:139]
ds_read_b64_tr_b16 v[74:75], v6 offset:8704
v_mfma_f32_16x16x32_bf16 v[140:143], v[116:119], v[92:95], v[140:143]
ds_read_b64_tr_b16 v[76:77], v6 offset:16384
v_mfma_f32_16x16x32_bf16 v[144:147], v[116:119], v[96:99], v[144:147]
ds_read_b64_tr_b16 v[78:79], v6 offset:16896
v_mfma_f32_16x16x32_bf16 v[148:151], v[116:119], v[100:103], v[148:151]
ds_read_b64_tr_b16 v[68:69], v6 offset:0
v_mfma_f32_16x16x32_bf16 v[152:155], v[116:119], v[104:107], v[152:155]
ds_read_b64_tr_b16 v[70:71], v6 offset:512
v_mfma_f32_16x16x32_bf16 v[156:159], v[116:119], v[108:111], v[156:159]
ds_read_b128 v[36:39], v2 offset:2048
v_mfma_f32_16x16x32_bf16 v[160:163], v[116:119], v[112:115], v[160:163]
ds_read_b128 v[40:43], v2 offset:4096
v_mfma_f32_16x16x32_bf16 v[196:199], v[120:123], v[112:115], v[196:199]
ds_read_b128 v[44:47], v2 offset:6144
v_mfma_f32_16x16x32_bf16 v[192:195], v[120:123], v[108:111], v[192:195]
ds_read_b128 v[48:51], v2 offset:8192
v_mfma_f32_16x16x32_bf16 v[188:191], v[120:123], v[104:107], v[188:191]
ds_read_b128 v[52:55], v2 offset:10240
v_mfma_f32_16x16x32_bf16 v[184:187], v[120:123], v[100:103], v[184:187]
ds_read_b128 v[56:59], v2 offset:12288
v_mfma_f32_16x16x32_bf16 v[180:183], v[120:123], v[96:99], v[180:183]
ds_read_b128 v[60:63], v2 offset:14336
v_mfma_f32_16x16x32_bf16 v[176:179], v[120:123], v[92:95], v[176:179]
ds_read_b128 v[64:67], v2 offset:16384
v_mfma_f32_16x16x32_bf16 v[172:175], v[120:123], v[88:91], v[172:175]
v_mfma_f32_16x16x32_bf16 v[168:171], v[120:123], v[84:87], v[168:171]
v_mfma_f32_16x16x32_bf16 v[164:167], v[120:123], v[80:83], v[164:167]
v_mfma_f32_16x16x32_bf16 v[200:203], v[124:127], v[80:83], v[200:203]
v_mfma_f32_16x16x32_bf16 v[204:207], v[124:127], v[84:87], v[204:207]
v_mfma_f32_16x16x32_bf16 v[208:211], v[124:127], v[88:91], v[208:211]
v_mfma_f32_16x16x32_bf16 v[212:215], v[124:127], v[92:95], v[212:215]
v_mfma_f32_16x16x32_bf16 v[216:219], v[124:127], v[96:99], v[216:219]
v_mfma_f32_16x16x32_bf16 v[220:223], v[124:127], v[100:103], v[220:223]
v_mfma_f32_16x16x32_bf16 v[224:227], v[124:127], v[104:107], v[224:227]
v_mfma_f32_16x16x32_bf16 v[228:231], v[124:127], v[108:111], v[228:231]
v_mfma_f32_16x16x32_bf16 v[232:235], v[124:127], v[112:115], v[232:235]
s_sub_u32 s41, s41, 1
s_cmp_lg_u32 s41, 0
s_cbranch_scc1 Lcl_16
s_waitcnt lgkmcnt(0)
v_mfma_f32_16x16x32_bf16 v[128:131], v[68:71], v[32:35], v[128:131]
ds_read_b128 v[80:83], v3 offset:0
v_mfma_f32_16x16x32_bf16 v[132:135], v[68:71], v[36:39], v[132:135]
ds_read_b64_tr_b16 v[120:121], v6 offset:12288
v_mfma_f32_16x16x32_bf16 v[136:139], v[68:71], v[40:43], v[136:139]
ds_read_b64_tr_b16 v[122:123], v6 offset:12800
v_mfma_f32_16x16x32_bf16 v[140:143], v[68:71], v[44:47], v[140:143]
ds_read_b64_tr_b16 v[124:125], v6 offset:20480
v_mfma_f32_16x16x32_bf16 v[144:147], v[68:71], v[48:51], v[144:147]
ds_read_b64_tr_b16 v[126:127], v6 offset:20992
v_mfma_f32_16x16x32_bf16 v[148:151], v[68:71], v[52:55], v[148:151]
ds_read_b64_tr_b16 v[116:117], v6 offset:4096
v_mfma_f32_16x16x32_bf16 v[152:155], v[68:71], v[56:59], v[152:155]
ds_read_b64_tr_b16 v[118:119], v6 offset:4608
v_mfma_f32_16x16x32_bf16 v[156:159], v[68:71], v[60:63], v[156:159]
ds_read_b128 v[84:87], v3 offset:2048
v_mfma_f32_16x16x32_bf16 v[160:163], v[68:71], v[64:67], v[160:163]
ds_read_b128 v[88:91], v3 offset:4096
v_mfma_f32_16x16x32_bf16 v[196:199], v[72:75], v[64:67], v[196:199]
ds_read_b128 v[92:95], v3 offset:6144
v_mfma_f32_16x16x32_bf16 v[192:195], v[72:75], v[60:63], v[192:195]
ds_read_b128 v[96:99], v3 offset:8192
v_mfma_f32_16x16x32_bf16 v[188:191], v[72:75], v[56:59], v[188:191]
ds_read_b128 v[100:103], v3 offset:10240
v_mfma_f32_16x16x32_bf16 v[184:187], v[72:75], v[52:55], v[184:187]
ds_read_b128 v[104:107], v3 offset:12288
v_mfma_f32_16x16x32_bf16 v[180:183], v[72:75], v[48:51], v[180:183]
ds_read_b128 v[108:111], v3 offset:14336
v_mfma_f32_16x16x32_bf16 v[176:179], v[72:75], v[44:47], v[176:179]
ds_read_b128 v[112:115], v3 offset:16384
v_mfma_f32_16x16x32_bf16 v[172:175], v[72:75], v[40:43], v[172:175]
v_mfma_f32_16x16x32_bf16 v[168:171], v[72:75], v[36:39], v[168:171]
v_mfma_f32_16x16x32_bf16 v[164:167], v[72:75], v[32:35], v[164:167]
v_mfma_f32_16x16x32_bf16 v[200:203], v[76:79], v[32:35], v[200:203]
v_mfma_f32_16x16x32_bf16 v[204:207], v[76:79], v[36:39], v[204:207]
v_mfma_f32_16x16x32_bf16 v[208:211], v[76:79], v[40:43], v[208:211]
v_mfma_f32_16x16x32_bf16 v[212:215], v[76:79], v[44:47], v[212:215]
v_mfma_f32_16x16x32_bf16 v[216:219], v[76:79], v[48:51], v[216:219]
v_mfma_f32_16x16x32_bf16 v[220:223], v[76:79], v[52:55], v[220:223]
v_mfma_f32_16x16x32_bf16 v[224:227], v[76:79], v[56:59], v[224:227]
v_mfma_f32_16x16x32_bf16 v[228:231], v[76:79], v[60:63], v[228:231]
v_mfma_f32_16x16x32_bf16 v[232:235], v[76:79], v[64:67], v[232:235]
s_waitcnt lgkmcnt(0)
v_mfma_f32_16x16x32_bf16 v[128:131], v[116:119], v[80:83], v[128:131]
v_mfma_f32_16x16x32_bf16 v[132:135], v[116:119], v[84:87], v[132:135]
v_mfma_f32_16x16x32_bf16 v[136:139], v[116:119], v[88:91], v[136:139]
v_mfma_f32_16x16x32_bf16 v[140:143], v[116:119], v[92:95], v[140:143]
v_mfma_f32_16x16x32_bf16 v[144:147], v[116:119], v[96:99], v[144:147]
v_mfma_f32_16x16x32_bf16 v[148:151], v[116:119], v[100:103], v[148:151]
v_mfma_f32_16x16x32_bf16 v[152:155], v[116:119], v[104:107], v[152:155]
v_mfma_f32_16x16x32_bf16 v[156:159], v[116:119], v[108:111], v[156:159]
v_mfma_f32_16x16x32_bf16 v[160:163], v[116:119], v[112:115], v[160:163]
v_mfma_f32_16x16x32_bf16 v[196:199], v[120:123], v[112:115], v[196:199]
v_mfma_f32_16x16x32_bf16 v[192:195], v[120:123], v[108:111], v[192:195]
v_mfma_f32_16x16x32_bf16 v[188:191], v[120:123], v[104:107], v[188:191]
v_mfma_f32_16x16x32_bf16 v[184:187], v[120:123], v[100:103], v[184:187]
v_mfma_f32_16x16x32_bf16 v[180:183], v[120:123], v[96:99], v[180:183]
v_mfma_f32_16x16x32_bf16 v[176:179], v[120:123], v[92:95], v[176:179]
v_mfma_f32_16x16x32_bf16 v[172:175], v[120:123], v[88:91], v[172:175]
v_mfma_f32_16x16x32_bf16 v[168:171], v[120:123], v[84:87], v[168:171]
v_mfma_f32_16x16x32_bf16 v[164:167], v[120:123], v[80:83], v[164:167]
v_mfma_f32_16x16x32_bf16 v[200:203], v[124:127], v[80:83], v[200:203]
v_mfma_f32_16x16x32_bf16 v[204:207], v[124:127], v[84:87], v[204:207]
v_mfma_f32_16x16x32_bf16 v[208:211], v[124:127], v[88:91], v[208:211]
v_mfma_f32_16x16x32_bf16 v[212:215], v[124:127], v[92:95], v[212:215]
v_mfma_f32_16x16x32_bf16 v[216:219], v[124:127], v[96:99], v[216:219]
v_mfma_f32_16x16x32_bf16 v[220:223], v[124:127], v[100:103], v[220:223]
v_mfma_f32_16x16x32_bf16 v[224:227], v[124:127], v[104:107], v[224:227]
v_mfma_f32_16x16x32_bf16 v[228:231], v[124:127], v[108:111], v[228:231]
v_mfma_f32_16x16x32_bf16 v[232:235], v[124:127], v[112:115], v[232:235]
Lepi:
v_lshlrev_b32 v14, 3, v12
v_add_u32 v14, 147456, v14
v_mul_u32_u24 v15, 400, v12
v_lshl_add_u32 v15, v13, 3, v15
s_lshl_b32 s43, s36, 5
v_add_u32 v15, s43, v15
s_barrier
ds_read_b64 v[32:33], v14 offset:0
ds_read_b64 v[34:35], v14 offset:128
ds_read_b64 v[36:37], v14 offset:256
ds_read_b64 v[38:39], v14 offset:384
ds_read_b64 v[40:41], v14 offset:512
ds_read_b64 v[42:43], v14 offset:640
ds_read_b64 v[44:45], v14 offset:768
ds_read_b64 v[46:47], v14 offset:896
ds_read_b64 v[48:49], v14 offset:1024
v_mov_b32_dpp v52, v128 row_newbcast:0 row_mask:0xf bank_mask:0xf
v_mov_b32_dpp v53, v129 row_newbcast:0 row_mask:0xf bank_mask:0xf
v_mov_b32_dpp v54, v130 row_newbcast:0 row_mask:0xf bank_mask:0xf
v_mov_b32_dpp v55, v131 row_newbcast:0 row_mask:0xf bank_mask:0xf
v_mov_b32_dpp v56, v164 row_newbcast:0 row_mask:0xf bank_mask:0xf
v_mov_b32_dpp v57, v165 row_newbcast:0 row_mask:0xf bank_mask:0xf
v_mov_b32_dpp v58, v166 row_newbcast:0 row_mask:0xf bank_mask:0xf
v_mov_b32_dpp v59, v167 row_newbcast:0 row_mask:0xf bank_mask:0xf
v_mov_b32_dpp v60, v200 row_newbcast:0 row_mask:0xf bank_mask:0xf
v_mov_b32_dpp v61, v201 row_newbcast:0 row_mask:0xf bank_mask:0xf
v_mov_b32_dpp v62, v202 row_newbcast:0 row_mask:0xf bank_mask:0xf
v_mov_b32_dpp v63, v203 row_newbcast:0 row_mask:0xf bank_mask:0xf
s_waitcnt lgkmcnt(0)
v_pk_fma_f32 v[164:165], v[32:33], v[56:57], v[164:165] op_sel_hi:[0,1,1] neg_lo:[1,0,0] neg_hi:[1,0,0]
v_pk_fma_f32 v[166:167], v[32:33], v[58:59], v[166:167] op_sel_hi:[0,1,1] neg_lo:[1,0,0] neg_hi:[1,0,0]
v_pk_fma_f32 v[200:201], v[32:33], v[60:61], v[200:201] op_sel_hi:[0,1,1] neg_lo:[1,0,0] neg_hi:[1,0,0]
v_pk_fma_f32 v[202:203], v[32:33], v[62:63], v[202:203] op_sel_hi:[0,1,1] neg_lo:[1,0,0] neg_hi:[1,0,0]
v_pk_mul_f32 v[164:165], v[32:33], v[164:165] op_sel:[1,0] op_sel_hi:[1,1]
v_pk_mul_f32 v[166:167], v[32:33], v[166:167] op_sel:[1,0] op_sel_hi:[1,1]
v_pk_fma_f32 v[132:133], v[34:35], v[52:53], v[132:133] op_sel_hi:[0,1,1] neg_lo:[1,0,0] neg_hi:[1,0,0]
v_pk_fma_f32 v[134:135], v[34:35], v[54:55], v[134:135] op_sel_hi:[0,1,1] neg_lo:[1,0,0] neg_hi:[1,0,0]
v_pk_mul_f32 v[200:201], v[32:33], v[200:201] op_sel:[1,0] op_sel_hi:[1,1]
v_pk_mul_f32 v[202:203], v[32:33], v[202:203] op_sel:[1,0] op_sel_hi:[1,1]
v_cvt_pk_bf16_f32 v164, v164, v165
v_cvt_pk_bf16_f32 v165, v166, v167
ds_write_b64 v15, v[164:165] offset:128
v_pk_fma_f32 v[168:169], v[34:35], v[56:57], v[168:169] op_sel_hi:[0,1,1] neg_lo:[1,0,0] neg_hi:[1,0,0]
v_pk_fma_f32 v[170:171], v[34:35], v[58:59], v[170:171] op_sel_hi:[0,1,1] neg_lo:[1,0,0] neg_hi:[1,0,0]
v_pk_mul_f32 v[132:133], v[34:35], v[132:133] op_sel:[1,0] op_sel_hi:[1,1]
v_pk_mul_f32 v[134:135], v[34:35], v[134:135] op_sel:[1,0] op_sel_hi:[1,1]
v_cvt_pk_bf16_f32 v200, v200, v201
v_cvt_pk_bf16_f32 v201, v202, v203
ds_write_b64 v15, v[200:201] offset:256
v_pk_fma_f32 v[204:205], v[34:35], v[60:61], v[204:205] op_sel_hi:[0,1,1] neg_lo:[1,0,0] neg_hi:[1,0,0]
v_pk_fma_f32 v[206:207], v[34:35], v[62:63], v[206:207] op_sel_hi:[0,1,1] neg_lo:[1,0,0] neg_hi:[1,0,0]
v_pk_mul_f32 v[168:169], v[34:35], v[168:169] op_sel:[1,0] op_sel_hi:[1,1]
v_pk_mul_f32 v[170:171], v[34:35], v[170:171] op_sel:[1,0] op_sel_hi:[1,1]
v_cvt_pk_bf16_f32 v132, v132, v133
v_cvt_pk_bf16_f32 v133, v134, v135
ds_write_b64 v15, v[132:133] offset:6400
v_pk_fma_f32 v[136:137], v[36:37], v[52:53], v[136:137] op_sel_hi:[0,1,1] neg_lo:[1,0,0] neg_hi:[1,0,0]
v_pk_fma_f32 v[138:139], v[36:37], v[54:55], v[138:139] op_sel_hi:[0,1,1] neg_lo:[1,0,0] neg_hi:[1,0,0]
v_pk_mul_f32 v[204:205], v[34:35], v[204:205] op_sel:[1,0] op_sel_hi:[1,1]
v_pk_mul_f32 v[206:207], v[34:35], v[206:207] op_sel:[1,0] op_sel_hi:[1,1]
v_cvt_pk_bf16_f32 v168, v168, v169
v_cvt_pk_bf16_f32 v169, v170, v171
ds_write_b64 v15, v[168:169] offset:6528
v_pk_fma_f32 v[172:173], v[36:37], v[56:57], v[172:173] op_sel_hi:[0,1,1] neg_lo:[1,0,0] neg_hi:[1,0,0]
v_pk_fma_f32 v[174:175], v[36:37], v[58:59], v[174:175] op_sel_hi:[0,1,1] neg_lo:[1,0,0] neg_hi:[1,0,0]
v_pk_mul_f32 v[136:137], v[36:37], v[136:137] op_sel:[1,0] op_sel_hi:[1,1]
v_pk_mul_f32 v[138:139], v[36:37], v[138:139] op_sel:[1,0] op_sel_hi:[1,1]
v_cvt_pk_bf16_f32 v204, v204, v205
v_cvt_pk_bf16_f32 v205, v206, v207
ds_write_b64 v15, v[204:205] offset:6656
v_pk_fma_f32 v[208:209], v[36:37], v[60:61], v[208:209] op_sel_hi:[0,1,1] neg_lo:[1,0,0] neg_hi:[1,0,0]
v_pk_fma_f32 v[210:211], v[36:37], v[62:63], v[210:211] op_sel_hi:[0,1,1] neg_lo:[1,0,0] neg_hi:[1,0,0]
v_pk_mul_f32 v[172:173], v[36:37], v[172:173] op_sel:[1,0] op_sel_hi:[1,1]
v_pk_mul_f32 v[174:175], v[36:37], v[174:175] op_sel:[1,0] op_sel_hi:[1,1]
v_cvt_pk_bf16_f32 v136, v136, v137
v_cvt_pk_bf16_f32 v137, v138, v139
ds_write_b64 v15, v[136:137] offset:12800
v_pk_fma_f32 v[140:141], v[38:39], v[52:53], v[140:141] op_sel_hi:[0,1,1] neg_lo:[1,0,0] neg_hi:[1,0,0]
v_pk_fma_f32 v[142:143], v[38:39], v[54:55], v[142:143] op_sel_hi:[0,1,1] neg_lo:[1,0,0] neg_hi:[1,0,0]
v_pk_mul_f32 v[208:209], v[36:37], v[208:209] op_sel:[1,0] op_sel_hi:[1,1]
v_pk_mul_f32 v[210:211], v[36:37], v[210:211] op_sel:[1,0] op_sel_hi:[1,1]
v_cvt_pk_bf16_f32 v172, v172, v173
v_cvt_pk_bf16_f32 v173, v174, v175
ds_write_b64 v15, v[172:173] offset:12928
v_pk_fma_f32 v[176:177], v[38:39], v[56:57], v[176:177] op_sel_hi:[0,1,1] neg_lo:[1,0,0] neg_hi:[1,0,0]
v_pk_fma_f32 v[178:179], v[38:39], v[58:59], v[178:179] op_sel_hi:[0,1,1] neg_lo:[1,0,0] neg_hi:[1,0,0]
v_pk_mul_f32 v[140:141], v[38:39], v[140:141] op_sel:[1,0] op_sel_hi:[1,1]
v_pk_mul_f32 v[142:143], v[38:39], v[142:143] op_sel:[1,0] op_sel_hi:[1,1]
v_cvt_pk_bf16_f32 v208, v208, v209
v_cvt_pk_bf16_f32 v209, v210, v211
ds_write_b64 v15, v[208:209] offset:13056
v_pk_fma_f32 v[212:213], v[38:39], v[60:61], v[212:213] op_sel_hi:[0,1,1] neg_lo:[1,0,0] neg_hi:[1,0,0]
v_pk_fma_f32 v[214:215], v[38:39], v[62:63], v[214:215] op_sel_hi:[0,1,1] neg_lo:[1,0,0] neg_hi:[1,0,0]
v_pk_mul_f32 v[176:177], v[38:39], v[176:177] op_sel:[1,0] op_sel_hi:[1,1]
v_pk_mul_f32 v[178:179], v[38:39], v[178:179] op_sel:[1,0] op_sel_hi:[1,1]
v_cvt_pk_bf16_f32 v140, v140, v141
v_cvt_pk_bf16_f32 v141, v142, v143
ds_write_b64 v15, v[140:141] offset:19200
v_pk_fma_f32 v[144:145], v[40:41], v[52:53], v[144:145] op_sel_hi:[0,1,1] neg_lo:[1,0,0] neg_hi:[1,0,0]
v_pk_fma_f32 v[146:147], v[40:41], v[54:55], v[146:147] op_sel_hi:[0,1,1] neg_lo:[1,0,0] neg_hi:[1,0,0]
v_pk_mul_f32 v[212:213], v[38:39], v[212:213] op_sel:[1,0] op_sel_hi:[1,1]
v_pk_mul_f32 v[214:215], v[38:39], v[214:215] op_sel:[1,0] op_sel_hi:[1,1]
v_cvt_pk_bf16_f32 v176, v176, v177
v_cvt_pk_bf16_f32 v177, v178, v179
ds_write_b64 v15, v[176:177] offset:19328
v_pk_fma_f32 v[180:181], v[40:41], v[56:57], v[180:181] op_sel_hi:[0,1,1] neg_lo:[1,0,0] neg_hi:[1,0,0]
v_pk_fma_f32 v[182:183], v[40:41], v[58:59], v[182:183] op_sel_hi:[0,1,1] neg_lo:[1,0,0] neg_hi:[1,0,0]
v_pk_mul_f32 v[144:145], v[40:41], v[144:145] op_sel:[1,0] op_sel_hi:[1,1]
v_pk_mul_f32 v[146:147], v[40:41], v[146:147] op_sel:[1,0] op_sel_hi:[1,1]
v_cvt_pk_bf16_f32 v212, v212, v213
v_cvt_pk_bf16_f32 v213, v214, v215
ds_write_b64 v15, v[212:213] offset:19456
v_pk_fma_f32 v[216:217], v[40:41], v[60:61], v[216:217] op_sel_hi:[0,1,1] neg_lo:[1,0,0] neg_hi:[1,0,0]
v_pk_fma_f32 v[218:219], v[40:41], v[62:63], v[218:219] op_sel_hi:[0,1,1] neg_lo:[1,0,0] neg_hi:[1,0,0]
v_pk_mul_f32 v[180:181], v[40:41], v[180:181] op_sel:[1,0] op_sel_hi:[1,1]
v_pk_mul_f32 v[182:183], v[40:41], v[182:183] op_sel:[1,0] op_sel_hi:[1,1]
v_cvt_pk_bf16_f32 v144, v144, v145
v_cvt_pk_bf16_f32 v145, v146, v147
ds_write_b64 v15, v[144:145] offset:25600
v_pk_fma_f32 v[148:149], v[42:43], v[52:53], v[148:149] op_sel_hi:[0,1,1] neg_lo:[1,0,0] neg_hi:[1,0,0]
v_pk_fma_f32 v[150:151], v[42:43], v[54:55], v[150:151] op_sel_hi:[0,1,1] neg_lo:[1,0,0] neg_hi:[1,0,0]
v_pk_mul_f32 v[216:217], v[40:41], v[216:217] op_sel:[1,0] op_sel_hi:[1,1]
v_pk_mul_f32 v[218:219], v[40:41], v[218:219] op_sel:[1,0] op_sel_hi:[1,1]
v_cvt_pk_bf16_f32 v180, v180, v181
v_cvt_pk_bf16_f32 v181, v182, v183
ds_write_b64 v15, v[180:181] offset:25728
v_pk_fma_f32 v[184:185], v[42:43], v[56:57], v[184:185] op_sel_hi:[0,1,1] neg_lo:[1,0,0] neg_hi:[1,0,0]
v_pk_fma_f32 v[186:187], v[42:43], v[58:59], v[186:187] op_sel_hi:[0,1,1] neg_lo:[1,0,0] neg_hi:[1,0,0]
v_pk_mul_f32 v[148:149], v[42:43], v[148:149] op_sel:[1,0] op_sel_hi:[1,1]
v_pk_mul_f32 v[150:151], v[42:43], v[150:151] op_sel:[1,0] op_sel_hi:[1,1]
v_cvt_pk_bf16_f32 v216, v216, v217
v_cvt_pk_bf16_f32 v217, v218, v219
ds_write_b64 v15, v[216:217] offset:25856
v_pk_fma_f32 v[220:221], v[42:43], v[60:61], v[220:221] op_sel_hi:[0,1,1] neg_lo:[1,0,0] neg_hi:[1,0,0]
v_pk_fma_f32 v[222:223], v[42:43], v[62:63], v[222:223] op_sel_hi:[0,1,1] neg_lo:[1,0,0] neg_hi:[1,0,0]
v_pk_mul_f32 v[184:185], v[42:43], v[184:185] op_sel:[1,0] op_sel_hi:[1,1]
v_pk_mul_f32 v[186:187], v[42:43], v[186:187] op_sel:[1,0] op_sel_hi:[1,1]
v_cvt_pk_bf16_f32 v148, v148, v149
v_cvt_pk_bf16_f32 v149, v150, v151
ds_write_b64 v15, v[148:149] offset:32000
v_pk_fma_f32 v[152:153], v[44:45], v[52:53], v[152:153] op_sel_hi:[0,1,1] neg_lo:[1,0,0] neg_hi:[1,0,0]
v_pk_fma_f32 v[154:155], v[44:45], v[54:55], v[154:155] op_sel_hi:[0,1,1] neg_lo:[1,0,0] neg_hi:[1,0,0]
v_pk_mul_f32 v[220:221], v[42:43], v[220:221] op_sel:[1,0] op_sel_hi:[1,1]
v_pk_mul_f32 v[222:223], v[42:43], v[222:223] op_sel:[1,0] op_sel_hi:[1,1]
v_cvt_pk_bf16_f32 v184, v184, v185
v_cvt_pk_bf16_f32 v185, v186, v187
ds_write_b64 v15, v[184:185] offset:32128
v_pk_fma_f32 v[188:189], v[44:45], v[56:57], v[188:189] op_sel_hi:[0,1,1] neg_lo:[1,0,0] neg_hi:[1,0,0]
v_pk_fma_f32 v[190:191], v[44:45], v[58:59], v[190:191] op_sel_hi:[0,1,1] neg_lo:[1,0,0] neg_hi:[1,0,0]
v_pk_mul_f32 v[152:153], v[44:45], v[152:153] op_sel:[1,0] op_sel_hi:[1,1]
v_pk_mul_f32 v[154:155], v[44:45], v[154:155] op_sel:[1,0] op_sel_hi:[1,1]
v_cvt_pk_bf16_f32 v220, v220, v221
v_cvt_pk_bf16_f32 v221, v222, v223
ds_write_b64 v15, v[220:221] offset:32256
v_pk_fma_f32 v[224:225], v[44:45], v[60:61], v[224:225] op_sel_hi:[0,1,1] neg_lo:[1,0,0] neg_hi:[1,0,0]
v_pk_fma_f32 v[226:227], v[44:45], v[62:63], v[226:227] op_sel_hi:[0,1,1] neg_lo:[1,0,0] neg_hi:[1,0,0]
v_pk_mul_f32 v[188:189], v[44:45], v[188:189] op_sel:[1,0] op_sel_hi:[1,1]
v_pk_mul_f32 v[190:191], v[44:45], v[190:191] op_sel:[1,0] op_sel_hi:[1,1]
v_cvt_pk_bf16_f32 v152, v152, v153
v_cvt_pk_bf16_f32 v153, v154, v155
ds_write_b64 v15, v[152:153] offset:38400
v_pk_fma_f32 v[156:157], v[46:47], v[52:53], v[156:157] op_sel_hi:[0,1,1] neg_lo:[1,0,0] neg_hi:[1,0,0]
v_pk_fma_f32 v[158:159], v[46:47], v[54:55], v[158:159] op_sel_hi:[0,1,1] neg_lo:[1,0,0] neg_hi:[1,0,0]
v_pk_mul_f32 v[224:225], v[44:45], v[224:225] op_sel:[1,0] op_sel_hi:[1,1]
v_pk_mul_f32 v[226:227], v[44:45], v[226:227] op_sel:[1,0] op_sel_hi:[1,1]
v_cvt_pk_bf16_f32 v188, v188, v189
v_cvt_pk_bf16_f32 v189, v190, v191
ds_write_b64 v15, v[188:189] offset:38528
v_pk_fma_f32 v[192:193], v[46:47], v[56:57], v[192:193] op_sel_hi:[0,1,1] neg_lo:[1,0,0] neg_hi:[1,0,0]
v_pk_fma_f32 v[194:195], v[46:47], v[58:59], v[194:195] op_sel_hi:[0,1,1] neg_lo:[1,0,0] neg_hi:[1,0,0]
v_pk_mul_f32 v[156:157], v[46:47], v[156:157] op_sel:[1,0] op_sel_hi:[1,1]
v_pk_mul_f32 v[158:159], v[46:47], v[158:159] op_sel:[1,0] op_sel_hi:[1,1]
v_cvt_pk_bf16_f32 v224, v224, v225
v_cvt_pk_bf16_f32 v225, v226, v227
ds_write_b64 v15, v[224:225] offset:38656
v_pk_fma_f32 v[228:229], v[46:47], v[60:61], v[228:229] op_sel_hi:[0,1,1] neg_lo:[1,0,0] neg_hi:[1,0,0]
v_pk_fma_f32 v[230:231], v[46:47], v[62:63], v[230:231] op_sel_hi:[0,1,1] neg_lo:[1,0,0] neg_hi:[1,0,0]
v_pk_mul_f32 v[192:193], v[46:47], v[192:193] op_sel:[1,0] op_sel_hi:[1,1]
v_pk_mul_f32 v[194:195], v[46:47], v[194:195] op_sel:[1,0] op_sel_hi:[1,1]
v_cvt_pk_bf16_f32 v156, v156, v157
v_cvt_pk_bf16_f32 v157, v158, v159
ds_write_b64 v15, v[156:157] offset:44800
v_pk_fma_f32 v[160:161], v[48:49], v[52:53], v[160:161] op_sel_hi:[0,1,1] neg_lo:[1,0,0] neg_hi:[1,0,0]
v_pk_fma_f32 v[162:163], v[48:49], v[54:55], v[162:163] op_sel_hi:[0,1,1] neg_lo:[1,0,0] neg_hi:[1,0,0]
v_pk_mul_f32 v[228:229], v[46:47], v[228:229] op_sel:[1,0] op_sel_hi:[1,1]
v_pk_mul_f32 v[230:231], v[46:47], v[230:231] op_sel:[1,0] op_sel_hi:[1,1]
v_cvt_pk_bf16_f32 v192, v192, v193
v_cvt_pk_bf16_f32 v193, v194, v195
ds_write_b64 v15, v[192:193] offset:44928
v_pk_fma_f32 v[196:197], v[48:49], v[56:57], v[196:197] op_sel_hi:[0,1,1] neg_lo:[1,0,0] neg_hi:[1,0,0]
v_pk_fma_f32 v[198:199], v[48:49], v[58:59], v[198:199] op_sel_hi:[0,1,1] neg_lo:[1,0,0] neg_hi:[1,0,0]
v_pk_mul_f32 v[160:161], v[48:49], v[160:161] op_sel:[1,0] op_sel_hi:[1,1]
v_pk_mul_f32 v[162:163], v[48:49], v[162:163] op_sel:[1,0] op_sel_hi:[1,1]
v_cvt_pk_bf16_f32 v228, v228, v229
v_cvt_pk_bf16_f32 v229, v230, v231
ds_write_b64 v15, v[228:229] offset:45056
v_pk_fma_f32 v[232:233], v[48:49], v[60:61], v[232:233] op_sel_hi:[0,1,1] neg_lo:[1,0,0] neg_hi:[1,0,0]
v_pk_fma_f32 v[234:235], v[48:49], v[62:63], v[234:235] op_sel_hi:[0,1,1] neg_lo:[1,0,0] neg_hi:[1,0,0]
v_pk_mul_f32 v[196:197], v[48:49], v[196:197] op_sel:[1,0] op_sel_hi:[1,1]
v_pk_mul_f32 v[198:199], v[48:49], v[198:199] op_sel:[1,0] op_sel_hi:[1,1]
v_cvt_pk_bf16_f32 v160, v160, v161
v_cvt_pk_bf16_f32 v161, v162, v163
ds_write_b64 v15, v[160:161] offset:51200
v_pk_mul_f32 v[232:233], v[48:49], v[232:233] op_sel:[1,0] op_sel_hi:[1,1]
v_pk_mul_f32 v[234:235], v[48:49], v[234:235] op_sel:[1,0] op_sel_hi:[1,1]
v_cvt_pk_bf16_f32 v196, v196, v197
v_cvt_pk_bf16_f32 v197, v198, v199
ds_write_b64 v15, v[196:197] offset:51328
v_cvt_pk_bf16_f32 v232, v232, v233
v_cvt_pk_bf16_f32 v233, v234, v235
ds_write_b64 v15, v[232:233] offset:51456
s_waitcnt lgkmcnt(0)
s_branch Latt_5
Lpf_4:
s_lshl_b32 s43, s35, 7
s_waitcnt lgkmcnt(0)
s_mov_b32 s8, s64
s_mov_b32 s9, s65
s_mov_b32 s10, 4194304
s_mov_b32 s11, 0x20000
s_add_u32 s12, s66, s43
s_addc_u32 s13, s67, 0
s_mov_b32 s14, 6289536
s_mov_b32 s15, 0x20000
s_add_u32 s84, s82, 28311552
s_branch Lov_3
.p2align 12
.fill 16, 4, 0xbf800000
Lst_3_0:
s_branch Lwr_143
s_nop 0
s_nop 0
Lov_3:
s_addc_u32 s85, s83, 0
s_mov_b32 s86, 114688
s_mov_b32 s87, 0x20000
s_mov_b32 s56, s80
s_mov_b32 s57, s81
s_mov_b32 s58, 256
s_mov_b32 s59, 0x20000
v_mov_b32 v5, 0
v_lshlrev_b32 v14, 7, v1
s_or_b32 s43, s34, s35
s_cmp_lg_u32 s43, 0
s_cbranch_scc1 Lz_17
s_movk_i32 s43, 0x2000
buffer_store_dword v5, v14, s[84:87], 0 offen sc1
s_bfm_b64 exec, 60, 0
buffer_store_dword v5, v14, s[84:87], s43 offen sc1
s_mov_b64 exec, 1
v_mov_b32 v6, 1
s_waitcnt vmcnt(0)
buffer_store_dword v6, v5, s[56:59], 0 offen sc1
s_mov_b64 exec, -1
Lz_17:
s_lshl_b32 s43, s51, 11
buffer_load_dwordx4 v[96:99], v10, s[8:11], s43 offen offset:0
buffer_load_dwordx4 v[100:103], v10, s[8:11], s43 offen offset:1024
buffer_load_dwordx4 v[104:107], v10, s[8:11], s43 offen offset:2048
buffer_load_dwordx4 v[108:111], v10, s[8:11], s43 offen offset:3072
v_min_u32 v14, 23, v1
v_lshrrev_b32 v15, 3, v14
v_mul_u32_u24 v15, 43008, v15
v_and_b32 v14, 7, v14
v_lshl_add_u32 v15, v14, 4, v15
v_mov_b32 v32, 0x3f803f80
v_mov_b32 v33, 0x3f803f80
v_mov_b32 v34, 0x3f803f80
v_mov_b32 v35, 0x3f803f80
ds_write_b128 v15, v[32:35]
s_add_u32 s20, s82, 26214400
s_addc_u32 s21, s83, 0
s_mov_b32 s22, 16384
s_mov_b32 s23, 0x20000
s_add_u32 s43, s2, 128
s_lshl_b32 s43, s43, 7
v_lshlrev_b32 v14, 2, v1
s_mov_b64 exec, 15
buffer_store_dword v5, v14, s[84:87], s43 offen sc1
s_mov_b64 exec, -1
s_lshl_b32 s43, s34, 4
s_add_u32 s43, s43, s35
s_lshl_b32 s43, s43, 8
s_add_u32 s43, s43, 49152
v_lshlrev_b32 v14, 7, v1
s_mov_b64 exec, 3
buffer_store_dword v5, v14, s[84:87], s43 offen sc1
s_mov_b64 exec, -1
s_lshl_b32 s52, s34, 7
s_add_u32 s52, s52, 28319744
s_sub_u32 s53, s52, 128
s_cmp_eq_u32 s34, 0
s_cselect_b32 s53, s52, s53
s_waitcnt lgkmcnt(0)
s_barrier
s_waitcnt vmcnt(2)
s_mov_b32 s43, 0x3f803f80
v_mov_b32 v116, 0
v_mov_b32 v117, 0
v_mov_b32 v118, 0
v_mov_b32 v119, 0
v_mov_b32 v120, 0
v_mov_b32 v121, 0
v_mov_b32 v122, 0
v_mov_b32 v123, 0
v_dot2_f32_bf16 v116, v96, s43, v116
v_dot2_f32_bf16 v120, v96, v96, v120
v_dot2_f32_bf16 v118, v104, s43, v118
v_dot2_f32_bf16 v122, v104, v104, v122
v_dot2_f32_bf16 v117, v97, s43, v117
v_dot2_f32_bf16 v121, v97, v97, v121
v_dot2_f32_bf16 v119, v105, s43, v119
v_dot2_f32_bf16 v123, v105, v105, v123
v_dot2_f32_bf16 v116, v98, s43, v116
v_dot2_f32_bf16 v120, v98, v98, v120
v_dot2_f32_bf16 v118, v106, s43, v118
v_dot2_f32_bf16 v122, v106, v106, v122
v_dot2_f32_bf16 v117, v99, s43, v117
v_dot2_f32_bf16 v121, v99, v99, v121
v_dot2_f32_bf16 v119, v107, s43, v119
v_dot2_f32_bf16 v123, v107, v107, v123
v_dot2_f32_bf16 v116, v100, s43, v116
v_dot2_f32_bf16 v120, v100, v100, v120
v_dot2_f32_bf16 v118, v108, s43, v118
v_dot2_f32_bf16 v122, v108, v108, v122
v_dot2_f32_bf16 v117, v101, s43, v117
v_dot2_f32_bf16 v121, v101, v101, v121
v_dot2_f32_bf16 v119, v109, s43, v119
v_dot2_f32_bf16 v123, v109, v109, v123
v_dot2_f32_bf16 v116, v102, s43, v116
v_dot2_f32_bf16 v120, v102, v102, v120
v_dot2_f32_bf16 v118, v110, s43, v118
v_dot2_f32_bf16 v122, v110, v110, v122
v_dot2_f32_bf16 v117, v103, s43, v117
v_dot2_f32_bf16 v121, v103, v103, v121
v_dot2_f32_bf16 v119, v111, s43, v119
v_dot2_f32_bf16 v123, v111, v111, v123
s_nop 2
v_add_f32 v116, v116, v117
v_add_f32 v118, v118, v119
v_add_f32 v120, v120, v121
v_add_f32 v122, v122, v123
s_nop 1
v_permlane32_swap_b32 v116, v118
v_permlane32_swap_b32 v120, v122
v_add_f32 v116, v116, v118
v_add_f32 v120, v120, v122
s_nop 1
v_permlane16_swap_b32 v116, v120
v_add_f32 v116, v116, v120
s_nop 1
v_add_f32_dpp v116, v116, v116 row_ror:8 row_mask:0xf bank_mask:0xf
s_nop 1
v_add_f32_dpp v116, v116, v116 row_ror:4 row_mask:0xf bank_mask:0xf
s_nop 1
v_add_f32_dpp v116, v116, v116 row_ror:2 row_mask:0xf bank_mask:0xf
s_nop 1
v_add_f32_dpp v116, v116, v116 row_ror:1 row_mask:0xf bank_mask:0xf
v_mov_b32 v117, v116
s_nop 1
v_permlane16_swap_b32 v116, v117
v_mul_f32 v112, 0x3a800000, v116
v_mul_f32 v113, 0x3a800000, v117
v_fma_f32 v113, -v112, v112, v113
v_max_f32 v113, 0, v113
v_add_f32 v113, 0x3727c5ac, v113
v_rsq_f32 v113, v113
v_lshrrev_b32 v11, 5, v1
s_lshl_b32 s43, s47, 4
s_add_u32 s43, s43, 148608
v_lshl_add_u32 v11, v11, 3, s43
ds_write_b64 v11, v[112:113]
s_waitcnt lgkmcnt(0)
s_mov_b32 s28, s66
s_mov_b32 s29, s67
s_mov_b32 s30, 6291456
s_mov_b32 s31, 0x20000
s_mul_i32 s43, s33, 12288
s_add_u32 s43, s43, 1179648
v_lshlrev_b32 v30, 7, v1
buffer_load_dword v31, v30, s[28:31], s43 offen
s_add_u32 s43, s43, 8192
s_bfm_b64 exec, 32, 0
buffer_load_dword v31, v30, s[28:31], s43 offen
s_mov_b64 exec, -1
s_branch Lst_0_0
Lwr_140:
s_barrier
v_lshlrev_b32 v5, 4, v1
v_and_b32 v5, 63, v5
v_add_u32 v6, 148608, v5
ds_read_b128 v[112:115], v6
s_lshl_b32 s43, s63, 3
v_add_u32 v5, s43, v5
s_waitcnt lgkmcnt(0)
s_mov_b64 exec, 15
buffer_store_dwordx4 v[112:115], v5, s[20:23], 0 offen sc1
s_mov_b64 exec, -1
v_mov_b32 v4, 0
buffer_load_dword v6, v4, s[56:59], 0 offen sc1
s_mov_b32 s62, 0
s_branch Lst_1_0
Lwr_141:
s_barrier
s_branch Lst_2_0
Lwr_142:
s_barrier
s_branch Lst_3_0
Lwr_143:
s_barrier
s_branch Lst_4_0
Lwr_144:
s_barrier
s_branch Lst_5_0
Lwr_145:
s_barrier
s_cmp_eq_u32 s62, 3
s_cbranch_scc1 Lste_21
s_cmp_eq_u32 s62, 2
s_cbranch_scc1 Lst2_19
s_cmp_ge_u32 s62, 4
s_cbranch_scc1 Lst4_20
s_cmp_eq_u32 s62, 1
s_cbranch_scc1 Lst1_18
s_waitcnt vmcnt(0)
v_readfirstlane_b32 s54, v6
s_cmp_eq_u32 s54, 0
s_cbranch_scc0 Lrep_22
buffer_load_dword v6, v4, s[56:59], 0 offen sc1
s_branch Lste_21
Lrep_22:
s_add_u32 s7, s34, 64
s_lshl_b32 s7, s7, 7
v_mov_b32 v5, s7
v_mov_b32 v6, 1
s_mov_b64 exec, 1
buffer_atomic_add v6, v5, s[84:87], 0 offen sc1
s_mov_b64 exec, -1
s_mov_b32 s62, 1
s_mov_b32 s54, 0
s_mov_b32 s55, 0
s_branch Lste_21
Lst1_18:
s_and_b32 s43, s54, s55
s_cmp_eq_u32 s43, 16
s_cbranch_scc1 Lg_23
s_load_dword s54, s[82:83], s52 glc
s_load_dword s55, s[82:83], s53 glc
s_branch Lste_21
Lg_23:
v_add_u32 v5, 0, v1
v_min_u32 v5, 143, v5
v_lshlrev_b32 v20, 3, v5
v_add_u32 v5, s50, v5
v_max_i32 v5, 0, v5
v_lshlrev_b32 v5, 3, v5
buffer_load_dwordx2 v[32:33], v5, s[20:23], 0 offen sc1
v_add_u32 v5, 64, v1
v_min_u32 v5, 143, v5
v_lshlrev_b32 v21, 3, v5
v_add_u32 v5, s50, v5
v_max_i32 v5, 0, v5
v_lshlrev_b32 v5, 3, v5
buffer_load_dwordx2 v[34:35], v5, s[20:23], 0 offen sc1
v_add_u32 v5, 128, v1
v_min_u32 v5, 143, v5
v_lshlrev_b32 v22, 3, v5
v_add_u32 v5, s50, v5
v_max_i32 v5, 0, v5
v_lshlrev_b32 v5, 3, v5
buffer_load_dwordx2 v[36:37], v5, s[20:23], 0 offen sc1
s_mov_b32 s62, 4
s_branch Lste_21
Lst4_20:
s_mov_b32 s62, 2
s_branch Lste_21
Lst2_19:
s_waitcnt vmcnt(0)
v_add_u32 v20, 147456, v20
ds_write_b64 v20, v[32:33]
v_add_u32 v21, 147456, v21
ds_write_b64 v21, v[34:35]
v_add_u32 v22, 147456, v22
ds_write_b64 v22, v[36:37]
s_waitcnt lgkmcnt(0)
s_mov_b32 s62, 3
Lste_21:
s_branch Lst_6_0
Lwr_146:
s_barrier
s_cmp_eq_u32 s62, 3
s_cbranch_scc1 Lste_27
s_cmp_eq_u32 s62, 2
s_cbranch_scc1 Lst2_25
s_cmp_ge_u32 s62, 4
s_cbranch_scc1 Lst4_26
s_cmp_eq_u32 s62, 1
s_cbranch_scc1 Lst1_24
s_waitcnt vmcnt(0)
v_readfirstlane_b32 s54, v6
s_cmp_eq_u32 s54, 0
s_cbranch_scc0 Lrep_28
buffer_load_dword v6, v4, s[56:59], 0 offen sc1
s_branch Lste_27
Lrep_28:
s_add_u32 s7, s34, 64
s_lshl_b32 s7, s7, 7
v_mov_b32 v5, s7
v_mov_b32 v6, 1
s_mov_b64 exec, 1
buffer_atomic_add v6, v5, s[84:87], 0 offen sc1
s_mov_b64 exec, -1
s_mov_b32 s62, 1
s_mov_b32 s54, 0
s_mov_b32 s55, 0
s_branch Lste_27
Lst1_24:
s_and_b32 s43, s54, s55
s_cmp_eq_u32 s43, 16
s_cbranch_scc1 Lg_29
s_load_dword s54, s[82:83], s52 glc
s_load_dword s55, s[82:83], s53 glc
s_branch Lste_27
Lg_29:
v_add_u32 v5, 0, v1
v_min_u32 v5, 143, v5
v_lshlrev_b32 v20, 3, v5
v_add_u32 v5, s50, v5
v_max_i32 v5, 0, v5
v_lshlrev_b32 v5, 3, v5
buffer_load_dwordx2 v[32:33], v5, s[20:23], 0 offen sc1
v_add_u32 v5, 64, v1
v_min_u32 v5, 143, v5
v_lshlrev_b32 v21, 3, v5
v_add_u32 v5, s50, v5
v_max_i32 v5, 0, v5
v_lshlrev_b32 v5, 3, v5
buffer_load_dwordx2 v[34:35], v5, s[20:23], 0 offen sc1
v_add_u32 v5, 128, v1
v_min_u32 v5, 143, v5
v_lshlrev_b32 v22, 3, v5
v_add_u32 v5, s50, v5
v_max_i32 v5, 0, v5
v_lshlrev_b32 v5, 3, v5
buffer_load_dwordx2 v[36:37], v5, s[20:23], 0 offen sc1
s_mov_b32 s62, 4
s_branch Lste_27
Lst4_26:
s_mov_b32 s62, 2
s_branch Lste_27
Lst2_25:
s_waitcnt vmcnt(0)
v_add_u32 v20, 147456, v20
ds_write_b64 v20, v[32:33]
v_add_u32 v21, 147456, v21
ds_write_b64 v21, v[34:35]
v_add_u32 v22, 147456, v22
ds_write_b64 v22, v[36:37]
s_waitcnt lgkmcnt(0)
s_mov_b32 s62, 3
Lste_27:
s_branch Lst_7_0
Lwr_147:
s_barrier
s_cmp_eq_u32 s62, 3
s_cbranch_scc1 Lste_33
s_cmp_eq_u32 s62, 2
s_cbranch_scc1 Lst2_31
s_cmp_ge_u32 s62, 4
s_cbranch_scc1 Lst4_32
s_cmp_eq_u32 s62, 1
s_cbranch_scc1 Lst1_30
s_waitcnt vmcnt(0)
v_readfirstlane_b32 s54, v6
s_cmp_eq_u32 s54, 0
s_cbranch_scc0 Lrep_34
buffer_load_dword v6, v4, s[56:59], 0 offen sc1
s_branch Lste_33
Lrep_34:
s_add_u32 s7, s34, 64
s_lshl_b32 s7, s7, 7
v_mov_b32 v5, s7
v_mov_b32 v6, 1
s_mov_b64 exec, 1
buffer_atomic_add v6, v5, s[84:87], 0 offen sc1
s_mov_b64 exec, -1
s_mov_b32 s62, 1
s_mov_b32 s54, 0
s_mov_b32 s55, 0
s_branch Lste_33
Lst1_30:
s_and_b32 s43, s54, s55
s_cmp_eq_u32 s43, 16
s_cbranch_scc1 Lg_35
s_load_dword s54, s[82:83], s52 glc
s_load_dword s55, s[82:83], s53 glc
s_branch Lste_33
Lg_35:
v_add_u32 v5, 0, v1
v_min_u32 v5, 143, v5
v_lshlrev_b32 v20, 3, v5
v_add_u32 v5, s50, v5
v_max_i32 v5, 0, v5
v_lshlrev_b32 v5, 3, v5
buffer_load_dwordx2 v[32:33], v5, s[20:23], 0 offen sc1
v_add_u32 v5, 64, v1
v_min_u32 v5, 143, v5
v_lshlrev_b32 v21, 3, v5
v_add_u32 v5, s50, v5
v_max_i32 v5, 0, v5
v_lshlrev_b32 v5, 3, v5
buffer_load_dwordx2 v[34:35], v5, s[20:23], 0 offen sc1
v_add_u32 v5, 128, v1
v_min_u32 v5, 143, v5
v_lshlrev_b32 v22, 3, v5
v_add_u32 v5, s50, v5
v_max_i32 v5, 0, v5
v_lshlrev_b32 v5, 3, v5
buffer_load_dwordx2 v[36:37], v5, s[20:23], 0 offen sc1
s_mov_b32 s62, 4
s_branch Lste_33
Lst4_32:
s_mov_b32 s62, 2
s_branch Lste_33
Lst2_31:
s_waitcnt vmcnt(0)
v_add_u32 v20, 147456, v20
ds_write_b64 v20, v[32:33]
v_add_u32 v21, 147456, v21
ds_write_b64 v21, v[34:35]
v_add_u32 v22, 147456, v22
ds_write_b64 v22, v[36:37]
s_waitcnt lgkmcnt(0)
s_mov_b32 s62, 3
Lste_33:
s_branch Lst_8_0
Lwr_148:
s_barrier
s_cmp_eq_u32 s62, 3
s_cbranch_scc1 Lste_39
s_cmp_eq_u32 s62, 2
s_cbranch_scc1 Lst2_37
s_cmp_ge_u32 s62, 4
s_cbranch_scc1 Lst4_38
s_cmp_eq_u32 s62, 1
s_cbranch_scc1 Lst1_36
s_waitcnt vmcnt(0)
v_readfirstlane_b32 s54, v6
s_cmp_eq_u32 s54, 0
s_cbranch_scc0 Lrep_40
buffer_load_dword v6, v4, s[56:59], 0 offen sc1
s_branch Lste_39
Lrep_40:
s_add_u32 s7, s34, 64
s_lshl_b32 s7, s7, 7
v_mov_b32 v5, s7
v_mov_b32 v6, 1
s_mov_b64 exec, 1
buffer_atomic_add v6, v5, s[84:87], 0 offen sc1
s_mov_b64 exec, -1
s_mov_b32 s62, 1
s_mov_b32 s54, 0
s_mov_b32 s55, 0
s_branch Lste_39
Lst1_36:
s_and_b32 s43, s54, s55
s_cmp_eq_u32 s43, 16
s_cbranch_scc1 Lg_41
s_load_dword s54, s[82:83], s52 glc
s_load_dword s55, s[82:83], s53 glc
s_branch Lste_39
Lg_41:
v_add_u32 v5, 0, v1
v_min_u32 v5, 143, v5
v_lshlrev_b32 v20, 3, v5
v_add_u32 v5, s50, v5
v_max_i32 v5, 0, v5
v_lshlrev_b32 v5, 3, v5
buffer_load_dwordx2 v[32:33], v5, s[20:23], 0 offen sc1
v_add_u32 v5, 64, v1
v_min_u32 v5, 143, v5
v_lshlrev_b32 v21, 3, v5
v_add_u32 v5, s50, v5
v_max_i32 v5, 0, v5
v_lshlrev_b32 v5, 3, v5
buffer_load_dwordx2 v[34:35], v5, s[20:23], 0 offen sc1
v_add_u32 v5, 128, v1
v_min_u32 v5, 143, v5
v_lshlrev_b32 v22, 3, v5
v_add_u32 v5, s50, v5
v_max_i32 v5, 0, v5
v_lshlrev_b32 v5, 3, v5
buffer_load_dwordx2 v[36:37], v5, s[20:23], 0 offen sc1
s_mov_b32 s62, 4
s_branch Lste_39
Lst4_38:
s_mov_b32 s62, 2
s_branch Lste_39
Lst2_37:
s_waitcnt vmcnt(0)
v_add_u32 v20, 147456, v20
ds_write_b64 v20, v[32:33]
v_add_u32 v21, 147456, v21
ds_write_b64 v21, v[34:35]
v_add_u32 v22, 147456, v22
ds_write_b64 v22, v[36:37]
s_waitcnt lgkmcnt(0)
s_mov_b32 s62, 3
Lste_39:
s_branch Lst_9_0
Lwr_149:
s_barrier
s_getpc_b64 s[100:101]
s_and_b32 s100, s100, 0xfffff000
s_sub_u32 s100, s100, 1064960
s_subb_u32 s101, s101, 0
s_lshr_b32 s6, s2, 3
s_mul_i32 s6, s6, 1
s_and_b32 s7, s36, 0
s_add_u32 s6, s6, s7
s_mulk_i32 s6, 640
s_add_u32 s6, s6, 1063168
s_load_dword s3, s[100:101], s6 offset:0
s_load_dword s3, s[100:101], s6 offset:64
s_load_dword s3, s[100:101], s6 offset:128
s_load_dword s3, s[100:101], s6 offset:192
s_load_dword s3, s[100:101], s6 offset:256
s_load_dword s3, s[100:101], s6 offset:320
s_load_dword s3, s[100:101], s6 offset:384
s_load_dword s3, s[100:101], s6 offset:448
s_load_dword s3, s[100:101], s6 offset:512
s_load_dword s3, s[100:101], s6 offset:576
s_cmp_eq_u32 s62, 3
s_cbranch_scc1 Lste_45
s_cmp_eq_u32 s62, 2
s_cbranch_scc1 Lst2_43
s_cmp_ge_u32 s62, 4
s_cbranch_scc1 Lst4_44
s_cmp_eq_u32 s62, 1
s_cbranch_scc1 Lst1_42
s_waitcnt vmcnt(0)
v_readfirstlane_b32 s54, v6
s_cmp_eq_u32 s54, 0
s_cbranch_scc0 Lrep_46
buffer_load_dword v6, v4, s[56:59], 0 offen sc1
s_branch Lste_45
Lrep_46:
s_add_u32 s7, s34, 64
s_lshl_b32 s7, s7, 7
v_mov_b32 v5, s7
v_mov_b32 v6, 1
s_mov_b64 exec, 1
buffer_atomic_add v6, v5, s[84:87], 0 offen sc1
s_mov_b64 exec, -1
s_mov_b32 s62, 1
s_mov_b32 s54, 0
s_mov_b32 s55, 0
s_branch Lste_45
Lst1_42:
s_and_b32 s43, s54, s55
s_cmp_eq_u32 s43, 16
s_cbranch_scc1 Lg_47
s_load_dword s54, s[82:83], s52 glc
s_load_dword s55, s[82:83], s53 glc
s_branch Lste_45
Lg_47:
v_add_u32 v5, 0, v1
v_min_u32 v5, 143, v5
v_lshlrev_b32 v20, 3, v5
v_add_u32 v5, s50, v5
v_max_i32 v5, 0, v5
v_lshlrev_b32 v5, 3, v5
buffer_load_dwordx2 v[32:33], v5, s[20:23], 0 offen sc1
v_add_u32 v5, 64, v1
v_min_u32 v5, 143, v5
v_lshlrev_b32 v21, 3, v5
v_add_u32 v5, s50, v5
v_max_i32 v5, 0, v5
v_lshlrev_b32 v5, 3, v5
buffer_load_dwordx2 v[34:35], v5, s[20:23], 0 offen sc1
v_add_u32 v5, 128, v1
v_min_u32 v5, 143, v5
v_lshlrev_b32 v22, 3, v5
v_add_u32 v5, s50, v5
v_max_i32 v5, 0, v5
v_lshlrev_b32 v5, 3, v5
buffer_load_dwordx2 v[36:37], v5, s[20:23], 0 offen sc1
s_mov_b32 s62, 4
s_branch Lste_45
Lst4_44:
s_mov_b32 s62, 2
s_branch Lste_45
Lst2_43:
s_waitcnt vmcnt(0)
v_add_u32 v20, 147456, v20
ds_write_b64 v20, v[32:33]
v_add_u32 v21, 147456, v21
ds_write_b64 v21, v[34:35]
v_add_u32 v22, 147456, v22
ds_write_b64 v22, v[36:37]
s_waitcnt lgkmcnt(0)
s_mov_b32 s62, 3
Lste_45:
s_branch Lst_10_0
Lwr_150:
s_barrier
s_cmp_eq_u32 s62, 3
s_cbranch_scc1 Lste_51
s_cmp_eq_u32 s62, 2
s_cbranch_scc1 Lst2_49
s_cmp_ge_u32 s62, 4
s_cbranch_scc1 Lst4_50
s_cmp_eq_u32 s62, 1
s_cbranch_scc1 Lst1_48
s_waitcnt vmcnt(0)
v_readfirstlane_b32 s54, v6
s_cmp_eq_u32 s54, 0
s_cbranch_scc0 Lrep_52
buffer_load_dword v6, v4, s[56:59], 0 offen sc1
s_branch Lste_51
Lrep_52:
s_add_u32 s7, s34, 64
s_lshl_b32 s7, s7, 7
v_mov_b32 v5, s7
v_mov_b32 v6, 1
s_mov_b64 exec, 1
buffer_atomic_add v6, v5, s[84:87], 0 offen sc1
s_mov_b64 exec, -1
s_mov_b32 s62, 1
s_mov_b32 s54, 0
s_mov_b32 s55, 0
s_branch Lste_51
Lst1_48:
s_and_b32 s43, s54, s55
s_cmp_eq_u32 s43, 16
s_cbranch_scc1 Lg_53
s_load_dword s54, s[82:83], s52 glc
s_load_dword s55, s[82:83], s53 glc
s_branch Lste_51
Lg_53:
v_add_u32 v5, 0, v1
v_min_u32 v5, 143, v5
v_lshlrev_b32 v20, 3, v5
v_add_u32 v5, s50, v5
v_max_i32 v5, 0, v5
v_lshlrev_b32 v5, 3, v5
buffer_load_dwordx2 v[32:33], v5, s[20:23], 0 offen sc1
v_add_u32 v5, 64, v1
v_min_u32 v5, 143, v5
v_lshlrev_b32 v21, 3, v5
v_add_u32 v5, s50, v5
v_max_i32 v5, 0, v5
v_lshlrev_b32 v5, 3, v5
buffer_load_dwordx2 v[34:35], v5, s[20:23], 0 offen sc1
v_add_u32 v5, 128, v1
v_min_u32 v5, 143, v5
v_lshlrev_b32 v22, 3, v5
v_add_u32 v5, s50, v5
v_max_i32 v5, 0, v5
v_lshlrev_b32 v5, 3, v5
buffer_load_dwordx2 v[36:37], v5, s[20:23], 0 offen sc1
s_mov_b32 s62, 4
s_branch Lste_51
Lst4_50:
s_mov_b32 s62, 2
s_branch Lste_51
Lst2_49:
s_waitcnt vmcnt(0)
v_add_u32 v20, 147456, v20
ds_write_b64 v20, v[32:33]
v_add_u32 v21, 147456, v21
ds_write_b64 v21, v[34:35]
v_add_u32 v22, 147456, v22
ds_write_b64 v22, v[36:37]
s_waitcnt lgkmcnt(0)
s_mov_b32 s62, 3
Lste_51:
s_branch Lst_11_0
Lwr_151:
s_barrier
s_cmp_eq_u32 s62, 3
s_cbranch_scc1 Lste_57
s_cmp_eq_u32 s62, 2
s_cbranch_scc1 Lst2_55
s_cmp_ge_u32 s62, 4
s_cbranch_scc1 Lst4_56
s_cmp_eq_u32 s62, 1
s_cbranch_scc1 Lst1_54
s_waitcnt vmcnt(0)
v_readfirstlane_b32 s54, v6
s_cmp_eq_u32 s54, 0
s_cbranch_scc0 Lrep_58
buffer_load_dword v6, v4, s[56:59], 0 offen sc1
s_branch Lste_57
Lrep_58:
s_add_u32 s7, s34, 64
s_lshl_b32 s7, s7, 7
v_mov_b32 v5, s7
v_mov_b32 v6, 1
s_mov_b64 exec, 1
buffer_atomic_add v6, v5, s[84:87], 0 offen sc1
s_mov_b64 exec, -1
s_mov_b32 s62, 1
s_mov_b32 s54, 0
s_mov_b32 s55, 0
s_branch Lste_57
Lst1_54:
s_and_b32 s43, s54, s55
s_cmp_eq_u32 s43, 16
s_cbranch_scc1 Lg_59
s_load_dword s54, s[82:83], s52 glc
s_load_dword s55, s[82:83], s53 glc
s_branch Lste_57
Lg_59:
v_add_u32 v5, 0, v1
v_min_u32 v5, 143, v5
v_lshlrev_b32 v20, 3, v5
v_add_u32 v5, s50, v5
v_max_i32 v5, 0, v5
v_lshlrev_b32 v5, 3, v5
buffer_load_dwordx2 v[32:33], v5, s[20:23], 0 offen sc1
v_add_u32 v5, 64, v1
v_min_u32 v5, 143, v5
v_lshlrev_b32 v21, 3, v5
v_add_u32 v5, s50, v5
v_max_i32 v5, 0, v5
v_lshlrev_b32 v5, 3, v5
buffer_load_dwordx2 v[34:35], v5, s[20:23], 0 offen sc1
v_add_u32 v5, 128, v1
v_min_u32 v5, 143, v5
v_lshlrev_b32 v22, 3, v5
v_add_u32 v5, s50, v5
v_max_i32 v5, 0, v5
v_lshlrev_b32 v5, 3, v5
buffer_load_dwordx2 v[36:37], v5, s[20:23], 0 offen sc1
s_mov_b32 s62, 4
s_branch Lste_57
Lst4_56:
s_mov_b32 s62, 2
s_branch Lste_57
Lst2_55:
s_waitcnt vmcnt(0)
v_add_u32 v20, 147456, v20
ds_write_b64 v20, v[32:33]
v_add_u32 v21, 147456, v21
ds_write_b64 v21, v[34:35]
v_add_u32 v22, 147456, v22
ds_write_b64 v22, v[36:37]
s_waitcnt lgkmcnt(0)
s_mov_b32 s62, 3
Lste_57:
s_branch Lst_12_0
Lwr_152:
s_barrier
s_cmp_eq_u32 s62, 3
s_cbranch_scc1 Lste_63
s_cmp_eq_u32 s62, 2
s_cbranch_scc1 Lst2_61
s_cmp_ge_u32 s62, 4
s_cbranch_scc1 Lst4_62
s_cmp_eq_u32 s62, 1
s_cbranch_scc1 Lst1_60
s_waitcnt vmcnt(0)
v_readfirstlane_b32 s54, v6
s_cmp_eq_u32 s54, 0
s_cbranch_scc0 Lrep_64
buffer_load_dword v6, v4, s[56:59], 0 offen sc1
s_branch Lste_63
Lrep_64:
s_add_u32 s7, s34, 64
s_lshl_b32 s7, s7, 7
v_mov_b32 v5, s7
v_mov_b32 v6, 1
s_mov_b64 exec, 1
buffer_atomic_add v6, v5, s[84:87], 0 offen sc1
s_mov_b64 exec, -1
s_mov_b32 s62, 1
s_mov_b32 s54, 0
s_mov_b32 s55, 0
s_branch Lste_63
Lst1_60:
s_and_b32 s43, s54, s55
s_cmp_eq_u32 s43, 16
s_cbranch_scc1 Lg_65
s_load_dword s54, s[82:83], s52 glc
s_load_dword s55, s[82:83], s53 glc
s_branch Lste_63
Lg_65:
v_add_u32 v5, 0, v1
v_min_u32 v5, 143, v5
v_lshlrev_b32 v20, 3, v5
v_add_u32 v5, s50, v5
v_max_i32 v5, 0, v5
v_lshlrev_b32 v5, 3, v5
buffer_load_dwordx2 v[32:33], v5, s[20:23], 0 offen sc1
v_add_u32 v5, 64, v1
v_min_u32 v5, 143, v5
v_lshlrev_b32 v21, 3, v5
v_add_u32 v5, s50, v5
v_max_i32 v5, 0, v5
v_lshlrev_b32 v5, 3, v5
buffer_load_dwordx2 v[34:35], v5, s[20:23], 0 offen sc1
v_add_u32 v5, 128, v1
v_min_u32 v5, 143, v5
v_lshlrev_b32 v22, 3, v5
v_add_u32 v5, s50, v5
v_max_i32 v5, 0, v5
v_lshlrev_b32 v5, 3, v5
buffer_load_dwordx2 v[36:37], v5, s[20:23], 0 offen sc1
s_mov_b32 s62, 4
s_branch Lste_63
Lst4_62:
s_mov_b32 s62, 2
s_branch Lste_63
Lst2_61:
s_waitcnt vmcnt(0)
v_add_u32 v20, 147456, v20
ds_write_b64 v20, v[32:33]
v_add_u32 v21, 147456, v21
ds_write_b64 v21, v[34:35]
v_add_u32 v22, 147456, v22
ds_write_b64 v22, v[36:37]
s_waitcnt lgkmcnt(0)
s_mov_b32 s62, 3
Lste_63:
s_branch Lst_13_0
Lwr_153:
s_barrier
s_cmp_eq_u32 s62, 3
s_cbranch_scc1 Lste_69
s_cmp_eq_u32 s62, 2
s_cbranch_scc1 Lst2_67
s_cmp_ge_u32 s62, 4
s_cbranch_scc1 Lst4_68
s_cmp_eq_u32 s62, 1
s_cbranch_scc1 Lst1_66
s_waitcnt vmcnt(0)
v_readfirstlane_b32 s54, v6
s_cmp_eq_u32 s54, 0
s_cbranch_scc0 Lrep_70
buffer_load_dword v6, v4, s[56:59], 0 offen sc1
s_branch Lste_69
Lrep_70:
s_add_u32 s7, s34, 64
s_lshl_b32 s7, s7, 7
v_mov_b32 v5, s7
v_mov_b32 v6, 1
s_mov_b64 exec, 1
buffer_atomic_add v6, v5, s[84:87], 0 offen sc1
s_mov_b64 exec, -1
s_mov_b32 s62, 1
s_mov_b32 s54, 0
s_mov_b32 s55, 0
s_branch Lste_69
Lst1_66:
s_and_b32 s43, s54, s55
s_cmp_eq_u32 s43, 16
s_cbranch_scc1 Lg_71
s_load_dword s54, s[82:83], s52 glc
s_load_dword s55, s[82:83], s53 glc
s_branch Lste_69
Lg_71:
v_add_u32 v5, 0, v1
v_min_u32 v5, 143, v5
v_lshlrev_b32 v20, 3, v5
v_add_u32 v5, s50, v5
v_max_i32 v5, 0, v5
s_branch Lov_4
.p2align 12
.fill 32, 4, 0xbf800000
Lst_4_0:
s_branch Lwr_144
s_nop 0
s_nop 0
Lov_4:
v_lshlrev_b32 v5, 3, v5
buffer_load_dwordx2 v[32:33], v5, s[20:23], 0 offen sc1
v_add_u32 v5, 64, v1
v_min_u32 v5, 143, v5
v_lshlrev_b32 v21, 3, v5
v_add_u32 v5, s50, v5
v_max_i32 v5, 0, v5
v_lshlrev_b32 v5, 3, v5
buffer_load_dwordx2 v[34:35], v5, s[20:23], 0 offen sc1
v_add_u32 v5, 128, v1
v_min_u32 v5, 143, v5
v_lshlrev_b32 v22, 3, v5
v_add_u32 v5, s50, v5
v_max_i32 v5, 0, v5
v_lshlrev_b32 v5, 3, v5
buffer_load_dwordx2 v[36:37], v5, s[20:23], 0 offen sc1
s_mov_b32 s62, 4
s_branch Lste_69
Lst4_68:
s_mov_b32 s62, 2
s_branch Lste_69
Lst2_67:
s_waitcnt vmcnt(0)
v_add_u32 v20, 147456, v20
ds_write_b64 v20, v[32:33]
v_add_u32 v21, 147456, v21
ds_write_b64 v21, v[34:35]
v_add_u32 v22, 147456, v22
ds_write_b64 v22, v[36:37]
s_waitcnt lgkmcnt(0)
s_mov_b32 s62, 3
Lste_69:
s_branch Lst_14_0
Lwr_154:
s_barrier
s_cmp_eq_u32 s62, 3
s_cbranch_scc1 Lste_74
s_cmp_ge_u32 s62, 5
s_cbranch_scc1 Lg_79
s_cmp_ge_u32 s62, 2
s_cbranch_scc1 Lst2_73
s_cmp_eq_u32 s62, 1
s_cbranch_scc1 Lst1_72
s_mov_b32 s41, 0x40000
Lz0_75:
s_waitcnt vmcnt(0)
v_readfirstlane_b32 s54, v6
s_cmp_eq_u32 s54, 0
s_cbranch_scc0 Lzok_76
buffer_load_dword v6, v4, s[56:59], 0 offen sc1
s_sub_u32 s41, s41, 1
s_cmp_lg_u32 s41, 0
s_cbranch_scc1 Lz0_75
s_waitcnt lgkmcnt(0)
Lzok_76:
s_add_u32 s7, s34, 64
s_lshl_b32 s7, s7, 7
v_mov_b32 v5, s7
v_mov_b32 v6, 1
s_mov_b64 exec, 1
buffer_atomic_add v6, v5, s[84:87], 0 offen sc1
s_mov_b64 exec, -1
Lst1_72:
s_load_dword s54, s[82:83], s52 glc
s_load_dword s55, s[82:83], s53 glc
s_mov_b32 s41, 0x40000
Lpoll_77:
s_waitcnt lgkmcnt(0)
s_and_b32 s54, s54, s55
s_cmp_eq_u32 s54, 16
s_cbranch_scc1 Lg_79
s_load_dword s54, s[82:83], s52 glc
s_load_dword s55, s[82:83], s53 glc
s_sub_u32 s41, s41, 1
s_cmp_lg_u32 s41, 0
s_cbranch_scc1 Lpoll_77
s_waitcnt lgkmcnt(0)
Lg_79:
v_add_u32 v5, 0, v1
v_min_u32 v5, 143, v5
v_lshlrev_b32 v20, 3, v5
v_add_u32 v5, s50, v5
v_max_i32 v5, 0, v5
v_lshlrev_b32 v5, 3, v5
buffer_load_dwordx2 v[32:33], v5, s[20:23], 0 offen sc1
v_add_u32 v5, 64, v1
v_min_u32 v5, 143, v5
v_lshlrev_b32 v21, 3, v5
v_add_u32 v5, s50, v5
v_max_i32 v5, 0, v5
v_lshlrev_b32 v5, 3, v5
buffer_load_dwordx2 v[34:35], v5, s[20:23], 0 offen sc1
v_add_u32 v5, 128, v1
v_min_u32 v5, 143, v5
v_lshlrev_b32 v22, 3, v5
v_add_u32 v5, s50, v5
v_max_i32 v5, 0, v5
v_lshlrev_b32 v5, 3, v5
buffer_load_dwordx2 v[36:37], v5, s[20:23], 0 offen sc1
Lst2_73:
s_waitcnt vmcnt(0)
v_add_u32 v20, 147456, v20
ds_write_b64 v20, v[32:33]
v_add_u32 v21, 147456, v21
ds_write_b64 v21, v[34:35]
v_add_u32 v22, 147456, v22
ds_write_b64 v22, v[36:37]
s_waitcnt lgkmcnt(0)
Lste_74:
s_lshl_b32 s43, s35, 7
s_add_u32 s28, s68, s43
s_addc_u32 s29, s69, 0
s_mov_b32 s30, 2095232
s_mov_b32 s31, 0x20000
v_lshrrev_b32 v15, 3, v1
v_and_b32 v16, 6, v15
v_and_b32 v7, 7, v1
v_xor_b32 v7, v7, v16
v_lshlrev_b32 v7, 4, v7
v_mul_u32_u24 v15, 2048, v15
v_add_u32 v7, v7, v15
s_and_b32 s40, s36, 3
s_lshl_b32 s39, s40, 13
s_add_u32 s40, s40, s35
s_add_u32 s42, s40, 0
s_and_b32 s42, s42, 15
s_lshl_b32 s42, s42, 17
s_add_u32 m0, s39, 65536
s_add_u32 s43, s42, 0
buffer_load_dwordx4 v7, s[28:31], s43 offen lds
s_add_u32 m0, s39, 66560
s_add_u32 s43, s42, 16384
buffer_load_dwordx4 v7, s[28:31], s43 offen lds
s_add_u32 m0, s39, 67584
s_add_u32 s43, s42, 32768
buffer_load_dwordx4 v7, s[28:31], s43 offen lds
s_add_u32 m0, s39, 68608
s_add_u32 s43, s42, 49152
buffer_load_dwordx4 v7, s[28:31], s43 offen lds
s_add_u32 m0, s39, 69632
s_add_u32 s43, s42, 65536
buffer_load_dwordx4 v7, s[28:31], s43 offen lds
s_add_u32 m0, s39, 70656
s_add_u32 s43, s42, 81920
buffer_load_dwordx4 v7, s[28:31], s43 offen lds
s_add_u32 m0, s39, 71680
s_add_u32 s43, s42, 98304
buffer_load_dwordx4 v7, s[28:31], s43 offen lds
s_add_u32 m0, s39, 72704
s_add_u32 s43, s42, 114688
buffer_load_dwordx4 v7, s[28:31], s43 offen lds
s_bitcmp0_b32 s2, 0
s_cselect_b32 s88, s72, s74
s_cselect_b32 s89, s73, s75
s_cmp_lt_u32 s2, 192
s_cselect_b32 s90, 7340032, 0
s_mov_b32 s91, 0x20000
s_bfe_u32 s44, s2, 0x30001
s_lshl_b32 s44, s44, 2
s_and_b32 s43, s36, 3
s_add_u32 s44, s44, s43
s_lshl_b32 s44, s44, 5
v_lshrrev_b32 v18, 4, v1
v_add_u32 v18, s44, v18
v_mul_u32_u24 v18, 7168, v18
v_and_b32 v19, 15, v1
v_lshl_add_u32 v18, v19, 4, v18
s_lshr_b32 s43, s2, 4
s_lshl_b32 s43, s43, 8
s_add_u32 s43, s43, 4096
v_add_u32 v18, s43, v18
s_mov_b32 s43, 0
buffer_load_dwordx4 v[128:131], v18, s[88:91], s43 offen
s_mov_b32 s43, 28672
buffer_load_dwordx4 v[132:135], v18, s[88:91], s43 offen
s_mov_b32 s43, 57344
buffer_load_dwordx4 v[136:139], v18, s[88:91], s43 offen
s_mov_b32 s43, 86016
buffer_load_dwordx4 v[140:143], v18, s[88:91], s43 offen
s_mov_b32 s43, 114688
buffer_load_dwordx4 v[144:147], v18, s[88:91], s43 offen
s_mov_b32 s43, 143360
buffer_load_dwordx4 v[148:151], v18, s[88:91], s43 offen
s_mov_b32 s43, 172032
buffer_load_dwordx4 v[152:155], v18, s[88:91], s43 offen
s_mov_b32 s43, 200704
buffer_load_dwordx4 v[156:159], v18, s[88:91], s43 offen
s_barrier
Latts:
Lats_6:
s_and_b32 s43, s36, 1
s_bfe_u32 s44, s36, 0x10001
s_lshr_b32 s45, s36, 2
v_lshlrev_b32 v14, 2, v13
v_sub_u32 v14, v12, v14
v_mov_b32 v16, 0xff800000
s_or_b32 s46, s34, s45
s_cmp_lg_u32 s46, 0
s_cselect_b32 s46, 0, 0xff800000
v_subrev_u32 v15, 0, v14
v_cmp_ge_u32 vcc, 7, v15
v_add_u32 v15, 16, v15
s_nop 0
v_cndmask_b32 v248, v16, 0, vcc
v_cmp_ge_u32 vcc, 7, v15
s_nop 1
v_cndmask_b32 v244, v16, 0, vcc
v_or_b32 v240, s46, v244
v_subrev_u32 v15, 1, v14
v_cmp_ge_u32 vcc, 7, v15
v_add_u32 v15, 16, v15
s_nop 0
v_cndmask_b32 v249, v16, 0, vcc
v_cmp_ge_u32 vcc, 7, v15
s_nop 1
v_cndmask_b32 v245, v16, 0, vcc
v_or_b32 v241, s46, v245
v_subrev_u32 v15, 2, v14
v_cmp_ge_u32 vcc, 7, v15
v_add_u32 v15, 16, v15
s_nop 0
v_cndmask_b32 v250, v16, 0, vcc
v_cmp_ge_u32 vcc, 7, v15
s_nop 1
v_cndmask_b32 v246, v16, 0, vcc
v_or_b32 v242, s46, v246
v_subrev_u32 v15, 3, v14
v_cmp_ge_u32 vcc, 7, v15
v_add_u32 v15, 16, v15
s_nop 0
v_cndmask_b32 v251, v16, 0, vcc
v_cmp_ge_u32 vcc, 7, v15
s_nop 1
v_cndmask_b32 v247, v16, 0, vcc
v_or_b32 v243, s46, v247
s_lshl_b32 s46, s45, 6
s_add_u32 s46, s46, s44
s_add_u32 s46, s46, 16
v_lshl_add_u32 v14, v12, 1, s46
s_lshl_b32 s47, s43, 6
v_lshl_add_u32 v15, v13, 4, s47
v_mul_u32_u24 v20, 400, v14
v_add_u32 v20, v20, v15
v_subrev_u32 v16, 32, v14
v_max_i32 v16, 0, v16
v_mul_u32_u24 v21, 400, v16
v_add_u32 v21, v21, v15
v_lshrrev_b32 v16, 2, v12
v_lshl_add_u32 v16, v13, 2, v16
v_lshl_add_u32 v16, v16, 1, s46
v_and_b32 v17, 3, v1
v_lshl_add_u32 v17, v17, 3, s47
v_mul_u32_u24 v22, 400, v16
v_add_u32 v22, v22, v17
v_subrev_u32 v16, 32, v16
v_max_i32 v16, 0, v16
v_mul_u32_u24 v23, 400, v16
v_add_u32 v23, v23, v17
s_mul_i32 s60, s34, 262144
s_add_u32 s16, s82, s60
s_addc_u32 s17, s83, 0
s_mov_b32 s18, 262144
s_mov_b32 s19, 0x20000
s_lshl_b32 s60, s35, 14
s_lshl_b32 s43, s43, 13
s_add_u32 s60, s60, s43
s_lshl_b32 s43, s45, 12
s_add_u32 s60, s60, s43
s_lshl_b32 s43, s44, 10
s_add_u32 s60, s60, s43
v_lshlrev_b32 v24, 4, v1
s_mov_b32 s61, 0x3e8293ee
s_lshl_b32 s38, s35, 7
Latt_5:
s_barrier
ds_read_b128 v[32:35], v20 offset:0
ds_read_b128 v[36:39], v20 offset:128
ds_read_b128 v[40:43], v21 offset:128
ds_read_b128 v[80:83], v20 offset:12800
ds_read_b128 v[84:87], v20 offset:12928
ds_read_b128 v[88:91], v20 offset:128
ds_read_b64_tr_b16 v[44:45], v23 offset:256
ds_read_b64_tr_b16 v[46:47], v22 offset:256
ds_read_b64_tr_b16 v[48:49], v23 offset:288
ds_read_b64_tr_b16 v[50:51], v22 offset:288
ds_read_b64_tr_b16 v[92:93], v22 offset:256
ds_read_b64_tr_b16 v[94:95], v22 offset:13056
ds_read_b64_tr_b16 v[96:97], v22 offset:288
ds_read_b64_tr_b16 v[98:99], v22 offset:13088
s_waitcnt lgkmcnt(11)
v_mfma_f32_16x16x32_bf16 v[52:55], v[40:43], v[32:35], v[240:243]
v_mfma_f32_16x16x32_bf16 v[56:59], v[36:39], v[32:35], v[248:251]
s_waitcnt lgkmcnt(8)
v_mfma_f32_16x16x32_bf16 v[100:103], v[88:91], v[80:83], v[244:247]
v_mfma_f32_16x16x32_bf16 v[104:107], v[84:87], v[80:83], v[248:251]
s_nop 5
v_max3_f32 v60, v52, v53, v54
v_max3_f32 v108, v100, v101, v102
v_max3_f32 v61, v55, v56, v57
v_max3_f32 v109, v103, v104, v105
v_max3_f32 v60, v60, v58, v59
v_max3_f32 v108, v108, v106, v107
v_max_f32 v60, v60, v61
v_max_f32 v108, v108, v109
s_nop 1
v_permlane32_swap_b32 v60, v108
v_max_f32 v60, v60, v108
v_mov_b32 v61, v60
s_nop 1
v_permlane16_swap_b32 v60, v61
v_max_f32 v60, v60, v61
v_mul_f32 v60, s61, v60
s_nop 0
v_mov_b32 v108, v60
s_nop 1
v_permlane32_swap_b32 v60, v108
v_fma_f32 v52, v52, s61, -v60
v_fma_f32 v100, v100, s61, -v108
v_fma_f32 v53, v53, s61, -v60
v_fma_f32 v101, v101, s61, -v108
v_fma_f32 v54, v54, s61, -v60
v_fma_f32 v102, v102, s61, -v108
v_fma_f32 v55, v55, s61, -v60
v_fma_f32 v103, v103, s61, -v108
v_fma_f32 v56, v56, s61, -v60
v_fma_f32 v104, v104, s61, -v108
v_fma_f32 v57, v57, s61, -v60
v_fma_f32 v105, v105, s61, -v108
v_fma_f32 v58, v58, s61, -v60
v_fma_f32 v106, v106, s61, -v108
v_fma_f32 v59, v59, s61, -v60
v_fma_f32 v107, v107, s61, -v108
v_exp_f32 v52, v52
v_exp_f32 v100, v100
v_exp_f32 v53, v53
v_exp_f32 v101, v101
v_exp_f32 v54, v54
v_exp_f32 v102, v102
v_exp_f32 v55, v55
v_exp_f32 v103, v103
v_exp_f32 v56, v56
v_exp_f32 v104, v104
v_exp_f32 v57, v57
v_exp_f32 v105, v105
v_exp_f32 v58, v58
v_exp_f32 v106, v106
v_exp_f32 v59, v59
v_exp_f32 v107, v107
v_cvt_pk_bf16_f32 v64, v52, v53
v_cvt_pk_bf16_f32 v112, v100, v101
v_cvt_pk_bf16_f32 v65, v54, v55
v_cvt_pk_bf16_f32 v113, v102, v103
v_cvt_pk_bf16_f32 v66, v56, v57
v_cvt_pk_bf16_f32 v114, v104, v105
v_cvt_pk_bf16_f32 v67, v58, v59
v_cvt_pk_bf16_f32 v115, v106, v107
v_pk_add_f32 v[52:53], v[52:53], v[54:55]
v_pk_add_f32 v[100:101], v[100:101], v[102:103]
v_pk_add_f32 v[56:57], v[56:57], v[58:59]
v_pk_add_f32 v[104:105], v[104:105], v[106:107]
s_waitcnt lgkmcnt(0)
s_waitcnt lgkmcnt(0)
v_mfma_f32_16x16x32_bf16 v[68:71], v[44:47], v[64:67], 0
v_mfma_f32_16x16x32_bf16 v[116:119], v[92:95], v[112:115], 0
v_mfma_f32_16x16x32_bf16 v[72:75], v[48:51], v[64:67], 0
v_mfma_f32_16x16x32_bf16 v[120:123], v[96:99], v[112:115], 0
v_pk_add_f32 v[52:53], v[52:53], v[56:57]
v_pk_add_f32 v[100:101], v[100:101], v[104:105]
v_add_f32 v60, v52, v53
v_add_f32 v108, v100, v101
s_nop 1
v_permlane32_swap_b32 v60, v108
v_add_f32 v60, v60, v108
v_mov_b32 v61, v60
s_nop 1
v_permlane16_swap_b32 v60, v61
v_add_f32 v60, v60, v61
v_rcp_f32 v60, v60
s_nop 0
v_mov_b32 v108, v60
s_nop 1
v_permlane32_swap_b32 v60, v108
v_pk_mul_f32 v[68:69], v[60:61], v[68:69] op_sel_hi:[0,1]
v_pk_mul_f32 v[116:117], v[108:109], v[116:117] op_sel_hi:[0,1]
v_pk_mul_f32 v[70:71], v[60:61], v[70:71] op_sel_hi:[0,1]
v_pk_mul_f32 v[118:119], v[108:109], v[118:119] op_sel_hi:[0,1]
v_pk_mul_f32 v[72:73], v[60:61], v[72:73] op_sel_hi:[0,1]
v_pk_mul_f32 v[120:121], v[108:109], v[120:121] op_sel_hi:[0,1]
v_pk_mul_f32 v[74:75], v[60:61], v[74:75] op_sel_hi:[0,1]
v_pk_mul_f32 v[122:123], v[108:109], v[122:123] op_sel_hi:[0,1]
v_cvt_pk_bf16_f32 v64, v68, v69
v_cvt_pk_bf16_f32 v112, v116, v117
v_cvt_pk_bf16_f32 v65, v70, v71
v_cvt_pk_bf16_f32 v113, v118, v119
v_cvt_pk_bf16_f32 v66, v72, v73
v_cvt_pk_bf16_f32 v114, v120, v121
v_cvt_pk_bf16_f32 v67, v74, v75
v_cvt_pk_bf16_f32 v115, v122, v123
buffer_store_dwordx4 v[64:67], v24, s[16:19], s60 offen offset:0 sc1
buffer_store_dwordx4 v[112:115], v24, s[16:19], s60 offen offset:2048 sc1
s_add_u32 s56, s82, 28311552
s_addc_u32 s57, s83, 0
s_mov_b32 s58, 114688
s_mov_b32 s59, 0x20000
s_lshl_b32 s7, s34, 12
s_add_u32 s7, s7, 49152
v_lshl_add_u32 v26, v1, 8, s7
v_mov_b32 v27, 1
s_cmp_ge_u32 s36, 4
s_cbranch_scc1 Lh_81
s_waitcnt vmcnt(0)
s_branch Lo_80
Lh_81:
s_add_u32 s28, s68, s38
s_addc_u32 s29, s69, 0
s_mov_b32 s30, 2095232
s_mov_b32 s31, 0x20000
s_add_u32 s42, s40, 4
s_and_b32 s42, s42, 15
s_lshl_b32 s42, s42, 17
s_add_u32 m0, s39, 114688
s_add_u32 s43, s42, 0
buffer_load_dwordx4 v7, s[28:31], s43 offen lds
s_add_u32 m0, s39, 115712
s_add_u32 s43, s42, 16384
buffer_load_dwordx4 v7, s[28:31], s43 offen lds
s_add_u32 m0, s39, 116736
s_add_u32 s43, s42, 32768
buffer_load_dwordx4 v7, s[28:31], s43 offen lds
s_add_u32 m0, s39, 117760
s_add_u32 s43, s42, 49152
buffer_load_dwordx4 v7, s[28:31], s43 offen lds
s_add_u32 m0, s39, 118784
s_add_u32 s43, s42, 65536
buffer_load_dwordx4 v7, s[28:31], s43 offen lds
s_add_u32 m0, s39, 119808
s_add_u32 s43, s42, 81920
buffer_load_dwordx4 v7, s[28:31], s43 offen lds
s_add_u32 m0, s39, 120832
s_add_u32 s43, s42, 98304
buffer_load_dwordx4 v7, s[28:31], s43 offen lds
s_add_u32 m0, s39, 121856
s_add_u32 s43, s42, 114688
buffer_load_dwordx4 v7, s[28:31], s43 offen lds
s_waitcnt vmcnt(8)
Lo_80:
s_cmp_lg_u32 s36, 0
s_barrier
s_cbranch_scc1 Lsig_82
s_mov_b64 exec, 0xffff
buffer_atomic_add v27, v26, s[56:59], 0 offen sc1
s_mov_b64 exec, -1
Lsig_82:
s_cmp_ge_u32 s36, 4
s_cbranch_scc1 Lprod_84
v_and_b32 v12, 15, v1
v_lshrrev_b32 v13, 4, v1
v_lshlrev_b32 v10, 12, v12
v_and_b32 v14, 1, v13
v_lshl_add_u32 v10, v14, 5, v10
v_lshrrev_b32 v14, 1, v13
v_lshl_add_u32 v10, v14, 4, v10
s_lshl_b32 s43, s34, 18
s_lshl_b32 s44, s36, 16
s_add_u32 s43, s43, s44
s_lshl_b32 s44, s35, 7
s_add_u32 s43, s43, s44
buffer_load_dwordx4 v[128:131], v10, s[8:11], s43 offen offset:0
buffer_load_dwordx4 v[132:135], v10, s[8:11], s43 offen offset:64
buffer_load_dwordx4 v[136:139], v10, s[8:11], s43 offen offset:2048
buffer_load_dwordx4 v[140:143], v10, s[8:11], s43 offen offset:2112
v_and_b32 v12, 15, v1
v_lshrrev_b32 v13, 4, v1
s_mul_i32 s43, s34, 262144
s_add_u32 s20, s82, s43
s_addc_u32 s21, s83, 0
s_add_u32 s20, s20, 4194304
s_addc_u32 s21, s21, 0
s_mov_b32 s22, 262144
s_mov_b32 s23, 0x20000
s_mul_i32 s43, s34, 16384
s_add_u32 s24, s82, s43
s_addc_u32 s25, s83, 0
s_add_u32 s24, s24, 25165824
s_addc_u32 s25, s25, 0
s_mov_b32 s26, 16384
s_mov_b32 s27, 0x20000
v_lshlrev_b32 v11, 4, v1
s_lshl_b32 s43, s36, 11
v_add_u32 v2, s43, v11
v_add_u32 v3, 98304, v2
v_lshrrev_b32 v14, 2, v1
v_bfe_u32 v15, v14, 1, 2
v_mul_u32_u24 v14, 128, v14
v_lshl_add_u32 v14, v15, 5, v14
v_and_b32 v15, 3, v1
v_lshl_add_u32 v4, v15, 3, v14
v_xor_b32 v5, 32, v4
v_xor_b32 v6, 64, v4
v_xor_b32 v7, 96, v4
v_add_u32 v16, 0x10000, v4
v_add_u32 v20, 0x20000, v4
v_add_u32 v17, 0x10000, v5
v_add_u32 v21, 0x20000, v5
v_add_u32 v18, 0x10000, v6
v_add_u32 v22, 0x20000, v6
v_add_u32 v19, 0x10000, v7
v_add_u32 v23, 0x20000, v7
s_lshl_b32 s44, s35, 14
s_add_u32 s60, s44, s43
v_lshrrev_b32 v14, 1, v13
v_lshlrev_b32 v14, 11, v14
v_lshl_add_u32 v14, v12, 3, v14
v_and_b32 v15, 1, v13
v_lshl_add_u32 v14, v15, 2, v14
s_lshl_b32 s43, s36, 12
s_lshl_b32 s44, s35, 7
s_add_u32 s43, s43, s44
v_add_u32 v9, s43, v14
s_mov_b32 s61, 0x3f803f80
s_waitcnt vmcnt(0)
v_permlane16_swap_b32 v128, v130
v_permlane16_swap_b32 v129, v131
v_permlane16_swap_b32 v132, v134
v_permlane16_swap_b32 v133, v135
v_permlane16_swap_b32 v136, v138
v_permlane16_swap_b32 v137, v139
v_permlane16_swap_b32 v140, v142
v_permlane16_swap_b32 v141, v143
v_lshlrev_b32 v96, 16, v128
v_and_b32 v97, 0xffff0000, v128
v_lshlrev_b32 v98, 16, v129
v_and_b32 v99, 0xffff0000, v129
v_lshlrev_b32 v100, 16, v130
v_and_b32 v101, 0xffff0000, v130
v_lshlrev_b32 v102, 16, v131
v_and_b32 v103, 0xffff0000, v131
v_lshlrev_b32 v104, 16, v132
v_and_b32 v105, 0xffff0000, v132
v_lshlrev_b32 v106, 16, v133
v_and_b32 v107, 0xffff0000, v133
v_lshlrev_b32 v108, 16, v134
v_and_b32 v109, 0xffff0000, v134
v_lshlrev_b32 v110, 16, v135
v_and_b32 v111, 0xffff0000, v135
v_lshlrev_b32 v112, 16, v136
v_and_b32 v113, 0xffff0000, v136
v_lshlrev_b32 v114, 16, v137
v_and_b32 v115, 0xffff0000, v137
v_lshlrev_b32 v116, 16, v138
v_and_b32 v117, 0xffff0000, v138
v_lshlrev_b32 v118, 16, v139
v_and_b32 v119, 0xffff0000, v139
v_lshlrev_b32 v120, 16, v140
v_and_b32 v121, 0xffff0000, v140
v_lshlrev_b32 v122, 16, v141
v_and_b32 v123, 0xffff0000, v141
v_lshlrev_b32 v124, 16, v142
v_and_b32 v125, 0xffff0000, v142
v_lshlrev_b32 v126, 16, v143
v_and_b32 v127, 0xffff0000, v143
s_barrier
ds_read_b128 v[32:35], v2 offset:0
ds_read_b64_tr_b16 v[40:41], v16 offset:0
ds_read_b64_tr_b16 v[42:43], v16 offset:2048
ds_read_b64_tr_b16 v[44:45], v17 offset:0
ds_read_b64_tr_b16 v[46:47], v17 offset:2048
ds_read_b64_tr_b16 v[48:49], v18 offset:0
ds_read_b64_tr_b16 v[50:51], v18 offset:2048
ds_read_b64_tr_b16 v[52:53], v19 offset:0
ds_read_b64_tr_b16 v[54:55], v19 offset:2048
ds_read_b128 v[36:39], v2 offset:1024
ds_read_b128 v[56:59], v2 offset:8192
ds_read_b64_tr_b16 v[64:65], v16 offset:4096
ds_read_b64_tr_b16 v[66:67], v16 offset:6144
ds_read_b64_tr_b16 v[68:69], v17 offset:4096
ds_read_b64_tr_b16 v[70:71], v17 offset:6144
ds_read_b64_tr_b16 v[72:73], v18 offset:4096
ds_read_b64_tr_b16 v[74:75], v18 offset:6144
ds_read_b64_tr_b16 v[76:77], v19 offset:4096
ds_read_b64_tr_b16 v[78:79], v19 offset:6144
ds_read_b128 v[60:63], v2 offset:9216
s_waitcnt lgkmcnt(0)
s_barrier
v_mfma_f32_16x16x32_bf16 v[96:99], v[40:43], v[32:35], v[96:99]
ds_read_b128 v[144:147], v2 offset:49152
ds_read_b64_tr_b16 v[152:153], v16 offset:8192
v_mfma_f32_16x16x32_bf16 v[100:103], v[44:47], v[32:35], v[100:103]
ds_read_b64_tr_b16 v[154:155], v16 offset:10240
ds_read_b64_tr_b16 v[156:157], v17 offset:8192
v_mfma_f32_16x16x32_bf16 v[104:107], v[48:51], v[32:35], v[104:107]
ds_read_b64_tr_b16 v[158:159], v17 offset:10240
ds_read_b64_tr_b16 v[160:161], v18 offset:8192
v_mfma_f32_16x16x32_bf16 v[108:111], v[52:55], v[32:35], v[108:111]
ds_read_b64_tr_b16 v[162:163], v18 offset:10240
ds_read_b64_tr_b16 v[164:165], v19 offset:8192
v_mfma_f32_16x16x32_bf16 v[124:127], v[52:55], v[36:39], v[124:127]
ds_read_b64_tr_b16 v[166:167], v19 offset:10240
ds_read_b128 v[148:151], v2 offset:50176
v_mfma_f32_16x16x32_bf16 v[120:123], v[48:51], v[36:39], v[120:123]
ds_read_b128 v[168:171], v2 offset:57344
ds_read_b64_tr_b16 v[176:177], v16 offset:12288
v_mfma_f32_16x16x32_bf16 v[116:119], v[44:47], v[36:39], v[116:119]
ds_read_b64_tr_b16 v[178:179], v16 offset:14336
ds_read_b64_tr_b16 v[180:181], v17 offset:12288
v_mfma_f32_16x16x32_bf16 v[112:115], v[40:43], v[36:39], v[112:115]
ds_read_b64_tr_b16 v[182:183], v17 offset:14336
ds_read_b64_tr_b16 v[184:185], v18 offset:12288
v_mfma_f32_16x16x32_bf16 v[96:99], v[64:67], v[56:59], v[96:99]
ds_read_b64_tr_b16 v[186:187], v18 offset:14336
ds_read_b64_tr_b16 v[188:189], v19 offset:12288
v_mfma_f32_16x16x32_bf16 v[100:103], v[68:71], v[56:59], v[100:103]
ds_read_b64_tr_b16 v[190:191], v19 offset:14336
ds_read_b128 v[172:175], v2 offset:58368
v_mfma_f32_16x16x32_bf16 v[104:107], v[72:75], v[56:59], v[104:107]
s_bitcmp0_b32 s36, 1
v_mfma_f32_16x16x32_bf16 v[108:111], v[76:79], v[56:59], v[108:111]
s_cselect_b32 s44, s72, s74
v_mfma_f32_16x16x32_bf16 v[124:127], v[76:79], v[60:63], v[124:127]
s_cselect_b32 s45, s73, s75
v_mfma_f32_16x16x32_bf16 v[120:123], v[72:75], v[60:63], v[120:123]
s_mul_i32 s43, s35, 192
v_mfma_f32_16x16x32_bf16 v[116:119], v[68:71], v[60:63], v[116:119]
s_add_u32 s16, s44, s43
v_mfma_f32_16x16x32_bf16 v[112:115], v[64:67], v[60:63], v[112:115]
s_addc_u32 s17, s45, 0
s_waitcnt lgkmcnt(0)
s_barrier
v_mfma_f32_16x16x32_bf16 v[96:99], v[152:155], v[144:147], v[96:99]
ds_read_b128 v[32:35], v3 offset:0
ds_read_b64_tr_b16 v[40:41], v16 offset:16384
v_mfma_f32_16x16x32_bf16 v[100:103], v[156:159], v[144:147], v[100:103]
ds_read_b64_tr_b16 v[42:43], v16 offset:18432
ds_read_b64_tr_b16 v[44:45], v17 offset:16384
v_mfma_f32_16x16x32_bf16 v[104:107], v[160:163], v[144:147], v[104:107]
ds_read_b64_tr_b16 v[46:47], v17 offset:18432
ds_read_b64_tr_b16 v[48:49], v18 offset:16384
v_mfma_f32_16x16x32_bf16 v[108:111], v[164:167], v[144:147], v[108:111]
ds_read_b64_tr_b16 v[50:51], v18 offset:18432
ds_read_b64_tr_b16 v[52:53], v19 offset:16384
v_mfma_f32_16x16x32_bf16 v[124:127], v[164:167], v[148:151], v[124:127]
ds_read_b64_tr_b16 v[54:55], v19 offset:18432
ds_read_b128 v[36:39], v3 offset:1024
v_mfma_f32_16x16x32_bf16 v[120:123], v[160:163], v[148:151], v[120:123]
ds_read_b128 v[56:59], v3 offset:8192
ds_read_b64_tr_b16 v[64:65], v16 offset:20480
v_mfma_f32_16x16x32_bf16 v[116:119], v[156:159], v[148:151], v[116:119]
ds_read_b64_tr_b16 v[66:67], v16 offset:22528
ds_read_b64_tr_b16 v[68:69], v17 offset:20480
v_mfma_f32_16x16x32_bf16 v[112:115], v[152:155], v[148:151], v[112:115]
ds_read_b64_tr_b16 v[70:71], v17 offset:22528
ds_read_b64_tr_b16 v[72:73], v18 offset:20480
v_mfma_f32_16x16x32_bf16 v[96:99], v[176:179], v[168:171], v[96:99]
ds_read_b64_tr_b16 v[74:75], v18 offset:22528
ds_read_b64_tr_b16 v[76:77], v19 offset:20480
v_mfma_f32_16x16x32_bf16 v[100:103], v[180:183], v[168:171], v[100:103]
ds_read_b64_tr_b16 v[78:79], v19 offset:22528
ds_read_b128 v[60:63], v3 offset:9216
s_branch Lov_5
.p2align 12
.fill 32, 4, 0xbf800000
Lst_5_0:
s_branch Lwr_145
s_nop 0
s_nop 0
Lov_5:
v_mfma_f32_16x16x32_bf16 v[104:107], v[184:187], v[168:171], v[104:107]
s_add_u32 s16, s16, 4096
v_mfma_f32_16x16x32_bf16 v[108:111], v[188:191], v[168:171], v[108:111]
s_addc_u32 s17, s17, 0
v_mfma_f32_16x16x32_bf16 v[124:127], v[188:191], v[172:175], v[124:127]
s_mov_b32 s18, 7333056
v_mfma_f32_16x16x32_bf16 v[120:123], v[184:187], v[172:175], v[120:123]
s_mov_b32 s19, 0x20000
v_mfma_f32_16x16x32_bf16 v[116:119], v[180:183], v[172:175], v[116:119]
s_and_b32 s43, s36, 1
v_mfma_f32_16x16x32_bf16 v[112:115], v[176:179], v[172:175], v[112:115]
s_mul_i32 s43, s43, 229376
s_waitcnt lgkmcnt(0)
s_barrier
v_mfma_f32_16x16x32_bf16 v[96:99], v[40:43], v[32:35], v[96:99]
ds_read_b128 v[144:147], v3 offset:49152
ds_read_b64_tr_b16 v[152:153], v16 offset:24576
v_mfma_f32_16x16x32_bf16 v[100:103], v[44:47], v[32:35], v[100:103]
ds_read_b64_tr_b16 v[154:155], v16 offset:26624
ds_read_b64_tr_b16 v[156:157], v17 offset:24576
v_mfma_f32_16x16x32_bf16 v[104:107], v[48:51], v[32:35], v[104:107]
ds_read_b64_tr_b16 v[158:159], v17 offset:26624
ds_read_b64_tr_b16 v[160:161], v18 offset:24576
v_mfma_f32_16x16x32_bf16 v[108:111], v[52:55], v[32:35], v[108:111]
ds_read_b64_tr_b16 v[162:163], v18 offset:26624
ds_read_b64_tr_b16 v[164:165], v19 offset:24576
v_mfma_f32_16x16x32_bf16 v[124:127], v[52:55], v[36:39], v[124:127]
ds_read_b64_tr_b16 v[166:167], v19 offset:26624
ds_read_b128 v[148:151], v3 offset:50176
v_mfma_f32_16x16x32_bf16 v[120:123], v[48:51], v[36:39], v[120:123]
ds_read_b128 v[168:171], v3 offset:57344
ds_read_b64_tr_b16 v[176:177], v16 offset:28672
v_mfma_f32_16x16x32_bf16 v[116:119], v[44:47], v[36:39], v[116:119]
ds_read_b64_tr_b16 v[178:179], v16 offset:30720
ds_read_b64_tr_b16 v[180:181], v17 offset:28672
v_mfma_f32_16x16x32_bf16 v[112:115], v[40:43], v[36:39], v[112:115]
ds_read_b64_tr_b16 v[182:183], v17 offset:30720
ds_read_b64_tr_b16 v[184:185], v18 offset:28672
v_mfma_f32_16x16x32_bf16 v[96:99], v[64:67], v[56:59], v[96:99]
ds_read_b64_tr_b16 v[186:187], v18 offset:30720
ds_read_b64_tr_b16 v[188:189], v19 offset:28672
v_mfma_f32_16x16x32_bf16 v[100:103], v[68:71], v[56:59], v[100:103]
ds_read_b64_tr_b16 v[190:191], v19 offset:30720
ds_read_b128 v[172:175], v3 offset:58368
v_mfma_f32_16x16x32_bf16 v[104:107], v[72:75], v[56:59], v[104:107]
v_add_u32 v196, 0, v1
v_mfma_f32_16x16x32_bf16 v[108:111], v[76:79], v[56:59], v[108:111]
v_mul_u32_u24 v197, 5462, v196
v_mfma_f32_16x16x32_bf16 v[124:127], v[76:79], v[60:63], v[124:127]
v_lshrrev_b32 v197, 16, v197
v_mfma_f32_16x16x32_bf16 v[120:123], v[72:75], v[60:63], v[120:123]
v_mul_u32_u24 v198, 12, v197
v_mfma_f32_16x16x32_bf16 v[116:119], v[68:71], v[60:63], v[116:119]
v_sub_u32 v198, v196, v198
v_mfma_f32_16x16x32_bf16 v[112:115], v[64:67], v[60:63], v[112:115]
v_bfe_u32 v199, v197, 2, 1
s_waitcnt lgkmcnt(0)
s_barrier
v_mfma_f32_16x16x32_bf16 v[96:99], v[152:155], v[144:147], v[96:99]
ds_read_b128 v[32:35], v2 offset:0
ds_read_b64_tr_b16 v[40:41], v16 offset:49152
v_mfma_f32_16x16x32_bf16 v[100:103], v[156:159], v[144:147], v[100:103]
ds_read_b64_tr_b16 v[42:43], v16 offset:51200
ds_read_b64_tr_b16 v[44:45], v17 offset:49152
v_mfma_f32_16x16x32_bf16 v[104:107], v[160:163], v[144:147], v[104:107]
ds_read_b64_tr_b16 v[46:47], v17 offset:51200
ds_read_b64_tr_b16 v[48:49], v18 offset:49152
v_mfma_f32_16x16x32_bf16 v[108:111], v[164:167], v[144:147], v[108:111]
ds_read_b64_tr_b16 v[50:51], v18 offset:51200
ds_read_b64_tr_b16 v[52:53], v19 offset:49152
v_mfma_f32_16x16x32_bf16 v[124:127], v[164:167], v[148:151], v[124:127]
ds_read_b64_tr_b16 v[54:55], v19 offset:51200
ds_read_b128 v[36:39], v2 offset:1024
v_mfma_f32_16x16x32_bf16 v[120:123], v[160:163], v[148:151], v[120:123]
ds_read_b128 v[56:59], v2 offset:8192
ds_read_b64_tr_b16 v[64:65], v16 offset:53248
v_mfma_f32_16x16x32_bf16 v[116:119], v[156:159], v[148:151], v[116:119]
ds_read_b64_tr_b16 v[66:67], v16 offset:55296
ds_read_b64_tr_b16 v[68:69], v17 offset:53248
v_mfma_f32_16x16x32_bf16 v[112:115], v[152:155], v[148:151], v[112:115]
ds_read_b64_tr_b16 v[70:71], v17 offset:55296
ds_read_b64_tr_b16 v[72:73], v18 offset:53248
v_mfma_f32_16x16x32_bf16 v[96:99], v[176:179], v[168:171], v[96:99]
ds_read_b64_tr_b16 v[74:75], v18 offset:55296
ds_read_b64_tr_b16 v[76:77], v19 offset:53248
v_mfma_f32_16x16x32_bf16 v[100:103], v[180:183], v[168:171], v[100:103]
ds_read_b64_tr_b16 v[78:79], v19 offset:55296
ds_read_b128 v[60:63], v2 offset:9216
v_mfma_f32_16x16x32_bf16 v[104:107], v[184:187], v[168:171], v[104:107]
v_cmp_gt_u32 vcc, 8, v198
v_mfma_f32_16x16x32_bf16 v[108:111], v[188:191], v[168:171], v[108:111]
v_lshlrev_b32 v200, 1, v199
v_mfma_f32_16x16x32_bf16 v[124:127], v[188:191], v[172:175], v[124:127]
v_mul_u32_u24 v197, 7168, v197
v_mfma_f32_16x16x32_bf16 v[120:123], v[184:187], v[172:175], v[120:123]
v_cndmask_b32 v199, v199, v200, vcc
v_mfma_f32_16x16x32_bf16 v[116:119], v[180:183], v[172:175], v[116:119]
v_xor_b32 v198, v198, v199
v_mfma_f32_16x16x32_bf16 v[112:115], v[176:179], v[172:175], v[112:115]
v_lshl_add_u32 v192, v198, 4, v197
s_waitcnt lgkmcnt(0)
s_barrier
v_mfma_f32_16x16x32_bf16 v[96:99], v[40:43], v[32:35], v[96:99]
ds_read_b128 v[144:147], v2 offset:49152
ds_read_b64_tr_b16 v[152:153], v16 offset:57344
v_mfma_f32_16x16x32_bf16 v[100:103], v[44:47], v[32:35], v[100:103]
ds_read_b64_tr_b16 v[154:155], v16 offset:59392
ds_read_b64_tr_b16 v[156:157], v17 offset:57344
v_mfma_f32_16x16x32_bf16 v[104:107], v[48:51], v[32:35], v[104:107]
ds_read_b64_tr_b16 v[158:159], v17 offset:59392
ds_read_b64_tr_b16 v[160:161], v18 offset:57344
v_mfma_f32_16x16x32_bf16 v[108:111], v[52:55], v[32:35], v[108:111]
ds_read_b64_tr_b16 v[162:163], v18 offset:59392
ds_read_b64_tr_b16 v[164:165], v19 offset:57344
v_mfma_f32_16x16x32_bf16 v[124:127], v[52:55], v[36:39], v[124:127]
ds_read_b64_tr_b16 v[166:167], v19 offset:59392
ds_read_b128 v[148:151], v2 offset:50176
v_mfma_f32_16x16x32_bf16 v[120:123], v[48:51], v[36:39], v[120:123]
ds_read_b128 v[168:171], v2 offset:57344
ds_read_b64_tr_b16 v[176:177], v16 offset:61440
v_mfma_f32_16x16x32_bf16 v[116:119], v[44:47], v[36:39], v[116:119]
ds_read_b64_tr_b16 v[178:179], v16 offset:63488
ds_read_b64_tr_b16 v[180:181], v17 offset:61440
v_mfma_f32_16x16x32_bf16 v[112:115], v[40:43], v[36:39], v[112:115]
ds_read_b64_tr_b16 v[182:183], v17 offset:63488
ds_read_b64_tr_b16 v[184:185], v18 offset:61440
v_mfma_f32_16x16x32_bf16 v[96:99], v[64:67], v[56:59], v[96:99]
ds_read_b64_tr_b16 v[186:187], v18 offset:63488
ds_read_b64_tr_b16 v[188:189], v19 offset:61440
v_mfma_f32_16x16x32_bf16 v[100:103], v[68:71], v[56:59], v[100:103]
ds_read_b64_tr_b16 v[190:191], v19 offset:63488
ds_read_b128 v[172:175], v2 offset:58368
v_mfma_f32_16x16x32_bf16 v[104:107], v[72:75], v[56:59], v[104:107]
v_add_u32 v196, 64, v1
v_mfma_f32_16x16x32_bf16 v[108:111], v[76:79], v[56:59], v[108:111]
v_mul_u32_u24 v197, 5462, v196
v_mfma_f32_16x16x32_bf16 v[124:127], v[76:79], v[60:63], v[124:127]
v_lshrrev_b32 v197, 16, v197
v_mfma_f32_16x16x32_bf16 v[120:123], v[72:75], v[60:63], v[120:123]
v_mul_u32_u24 v198, 12, v197
v_mfma_f32_16x16x32_bf16 v[116:119], v[68:71], v[60:63], v[116:119]
v_sub_u32 v198, v196, v198
v_mfma_f32_16x16x32_bf16 v[112:115], v[64:67], v[60:63], v[112:115]
v_bfe_u32 v199, v197, 2, 1
s_waitcnt lgkmcnt(0)
s_barrier
v_mfma_f32_16x16x32_bf16 v[96:99], v[152:155], v[144:147], v[96:99]
ds_read_b128 v[32:35], v3 offset:0
ds_read_b64_tr_b16 v[40:41], v20 offset:0
v_mfma_f32_16x16x32_bf16 v[100:103], v[156:159], v[144:147], v[100:103]
ds_read_b64_tr_b16 v[42:43], v20 offset:2048
ds_read_b64_tr_b16 v[44:45], v21 offset:0
v_mfma_f32_16x16x32_bf16 v[104:107], v[160:163], v[144:147], v[104:107]
ds_read_b64_tr_b16 v[46:47], v21 offset:2048
ds_read_b64_tr_b16 v[48:49], v22 offset:0
v_mfma_f32_16x16x32_bf16 v[108:111], v[164:167], v[144:147], v[108:111]
ds_read_b64_tr_b16 v[50:51], v22 offset:2048
ds_read_b64_tr_b16 v[52:53], v23 offset:0
v_mfma_f32_16x16x32_bf16 v[124:127], v[164:167], v[148:151], v[124:127]
ds_read_b64_tr_b16 v[54:55], v23 offset:2048
ds_read_b128 v[36:39], v3 offset:1024
v_mfma_f32_16x16x32_bf16 v[120:123], v[160:163], v[148:151], v[120:123]
ds_read_b128 v[56:59], v3 offset:8192
ds_read_b64_tr_b16 v[64:65], v20 offset:4096
v_mfma_f32_16x16x32_bf16 v[116:119], v[156:159], v[148:151], v[116:119]
ds_read_b64_tr_b16 v[66:67], v20 offset:6144
ds_read_b64_tr_b16 v[68:69], v21 offset:4096
v_mfma_f32_16x16x32_bf16 v[112:115], v[152:155], v[148:151], v[112:115]
ds_read_b64_tr_b16 v[70:71], v21 offset:6144
ds_read_b64_tr_b16 v[72:73], v22 offset:4096
v_mfma_f32_16x16x32_bf16 v[96:99], v[176:179], v[168:171], v[96:99]
ds_read_b64_tr_b16 v[74:75], v22 offset:6144
ds_read_b64_tr_b16 v[76:77], v23 offset:4096
v_mfma_f32_16x16x32_bf16 v[100:103], v[180:183], v[168:171], v[100:103]
ds_read_b64_tr_b16 v[78:79], v23 offset:6144
ds_read_b128 v[60:63], v3 offset:9216
v_mfma_f32_16x16x32_bf16 v[104:107], v[184:187], v[168:171], v[104:107]
v_cmp_gt_u32 vcc, 8, v198
v_mfma_f32_16x16x32_bf16 v[108:111], v[188:191], v[168:171], v[108:111]
v_lshlrev_b32 v200, 1, v199
v_mfma_f32_16x16x32_bf16 v[124:127], v[188:191], v[172:175], v[124:127]
v_mul_u32_u24 v197, 7168, v197
v_mfma_f32_16x16x32_bf16 v[120:123], v[184:187], v[172:175], v[120:123]
v_cndmask_b32 v199, v199, v200, vcc
v_mfma_f32_16x16x32_bf16 v[116:119], v[180:183], v[172:175], v[116:119]
v_xor_b32 v198, v198, v199
v_mfma_f32_16x16x32_bf16 v[112:115], v[176:179], v[172:175], v[112:115]
v_lshl_add_u32 v193, v198, 4, v197
s_waitcnt lgkmcnt(0)
s_barrier
v_mfma_f32_16x16x32_bf16 v[96:99], v[40:43], v[32:35], v[96:99]
ds_read_b128 v[144:147], v3 offset:49152
ds_read_b64_tr_b16 v[152:153], v20 offset:8192
v_mfma_f32_16x16x32_bf16 v[100:103], v[44:47], v[32:35], v[100:103]
ds_read_b64_tr_b16 v[154:155], v20 offset:10240
ds_read_b64_tr_b16 v[156:157], v21 offset:8192
v_mfma_f32_16x16x32_bf16 v[104:107], v[48:51], v[32:35], v[104:107]
ds_read_b64_tr_b16 v[158:159], v21 offset:10240
ds_read_b64_tr_b16 v[160:161], v22 offset:8192
v_mfma_f32_16x16x32_bf16 v[108:111], v[52:55], v[32:35], v[108:111]
ds_read_b64_tr_b16 v[162:163], v22 offset:10240
ds_read_b64_tr_b16 v[164:165], v23 offset:8192
v_mfma_f32_16x16x32_bf16 v[124:127], v[52:55], v[36:39], v[124:127]
ds_read_b64_tr_b16 v[166:167], v23 offset:10240
ds_read_b128 v[148:151], v3 offset:50176
v_mfma_f32_16x16x32_bf16 v[120:123], v[48:51], v[36:39], v[120:123]
ds_read_b128 v[168:171], v3 offset:57344
ds_read_b64_tr_b16 v[176:177], v20 offset:12288
v_mfma_f32_16x16x32_bf16 v[116:119], v[44:47], v[36:39], v[116:119]
ds_read_b64_tr_b16 v[178:179], v20 offset:14336
ds_read_b64_tr_b16 v[180:181], v21 offset:12288
v_mfma_f32_16x16x32_bf16 v[112:115], v[40:43], v[36:39], v[112:115]
ds_read_b64_tr_b16 v[182:183], v21 offset:14336
ds_read_b64_tr_b16 v[184:185], v22 offset:12288
v_mfma_f32_16x16x32_bf16 v[96:99], v[64:67], v[56:59], v[96:99]
ds_read_b64_tr_b16 v[186:187], v22 offset:14336
ds_read_b64_tr_b16 v[188:189], v23 offset:12288
v_mfma_f32_16x16x32_bf16 v[100:103], v[68:71], v[56:59], v[100:103]
ds_read_b64_tr_b16 v[190:191], v23 offset:14336
ds_read_b128 v[172:175], v3 offset:58368
v_mfma_f32_16x16x32_bf16 v[104:107], v[72:75], v[56:59], v[104:107]
v_add_u32 v196, 128, v1
v_mfma_f32_16x16x32_bf16 v[108:111], v[76:79], v[56:59], v[108:111]
v_mul_u32_u24 v197, 5462, v196
v_mfma_f32_16x16x32_bf16 v[124:127], v[76:79], v[60:63], v[124:127]
v_lshrrev_b32 v197, 16, v197
v_mfma_f32_16x16x32_bf16 v[120:123], v[72:75], v[60:63], v[120:123]
v_mul_u32_u24 v198, 12, v197
v_mfma_f32_16x16x32_bf16 v[116:119], v[68:71], v[60:63], v[116:119]
v_sub_u32 v198, v196, v198
v_mfma_f32_16x16x32_bf16 v[112:115], v[64:67], v[60:63], v[112:115]
v_bfe_u32 v199, v197, 2, 1
s_waitcnt lgkmcnt(0)
s_barrier
v_mfma_f32_16x16x32_bf16 v[96:99], v[152:155], v[144:147], v[96:99]
ds_read_b128 v[32:35], v2 offset:0
ds_read_b64_tr_b16 v[40:41], v4 offset:16384
v_mfma_f32_16x16x32_bf16 v[100:103], v[156:159], v[144:147], v[100:103]
ds_read_b64_tr_b16 v[42:43], v4 offset:18432
ds_read_b64_tr_b16 v[44:45], v5 offset:16384
v_mfma_f32_16x16x32_bf16 v[104:107], v[160:163], v[144:147], v[104:107]
ds_read_b64_tr_b16 v[46:47], v5 offset:18432
ds_read_b64_tr_b16 v[48:49], v6 offset:16384
v_mfma_f32_16x16x32_bf16 v[108:111], v[164:167], v[144:147], v[108:111]
ds_read_b64_tr_b16 v[50:51], v6 offset:18432
ds_read_b64_tr_b16 v[52:53], v7 offset:16384
v_mfma_f32_16x16x32_bf16 v[124:127], v[164:167], v[148:151], v[124:127]
ds_read_b64_tr_b16 v[54:55], v7 offset:18432
ds_read_b128 v[36:39], v2 offset:1024
v_mfma_f32_16x16x32_bf16 v[120:123], v[160:163], v[148:151], v[120:123]
ds_read_b128 v[56:59], v2 offset:8192
ds_read_b64_tr_b16 v[64:65], v4 offset:20480
v_mfma_f32_16x16x32_bf16 v[116:119], v[156:159], v[148:151], v[116:119]
ds_read_b64_tr_b16 v[66:67], v4 offset:22528
ds_read_b64_tr_b16 v[68:69], v5 offset:20480
v_mfma_f32_16x16x32_bf16 v[112:115], v[152:155], v[148:151], v[112:115]
ds_read_b64_tr_b16 v[70:71], v5 offset:22528
ds_read_b64_tr_b16 v[72:73], v6 offset:20480
v_mfma_f32_16x16x32_bf16 v[96:99], v[176:179], v[168:171], v[96:99]
ds_read_b64_tr_b16 v[74:75], v6 offset:22528
ds_read_b64_tr_b16 v[76:77], v7 offset:20480
v_mfma_f32_16x16x32_bf16 v[100:103], v[180:183], v[168:171], v[100:103]
ds_read_b64_tr_b16 v[78:79], v7 offset:22528
ds_read_b128 v[60:63], v2 offset:9216
v_mfma_f32_16x16x32_bf16 v[104:107], v[184:187], v[168:171], v[104:107]
v_cmp_gt_u32 vcc, 8, v198
v_mfma_f32_16x16x32_bf16 v[108:111], v[188:191], v[168:171], v[108:111]
v_lshlrev_b32 v200, 1, v199
v_mfma_f32_16x16x32_bf16 v[124:127], v[188:191], v[172:175], v[124:127]
v_mul_u32_u24 v197, 7168, v197
v_mfma_f32_16x16x32_bf16 v[120:123], v[184:187], v[172:175], v[120:123]
v_cndmask_b32 v199, v199, v200, vcc
v_mfma_f32_16x16x32_bf16 v[116:119], v[180:183], v[172:175], v[116:119]
v_xor_b32 v198, v198, v199
v_mfma_f32_16x16x32_bf16 v[112:115], v[176:179], v[172:175], v[112:115]
v_lshl_add_u32 v194, v198, 4, v197
s_waitcnt lgkmcnt(0)
s_barrier
v_mfma_f32_16x16x32_bf16 v[96:99], v[40:43], v[32:35], v[96:99]
ds_read_b128 v[144:147], v2 offset:49152
ds_read_b64_tr_b16 v[152:153], v4 offset:24576
v_mfma_f32_16x16x32_bf16 v[100:103], v[44:47], v[32:35], v[100:103]
ds_read_b64_tr_b16 v[154:155], v4 offset:26624
ds_read_b64_tr_b16 v[156:157], v5 offset:24576
v_mfma_f32_16x16x32_bf16 v[104:107], v[48:51], v[32:35], v[104:107]
ds_read_b64_tr_b16 v[158:159], v5 offset:26624
ds_read_b64_tr_b16 v[160:161], v6 offset:24576
v_mfma_f32_16x16x32_bf16 v[108:111], v[52:55], v[32:35], v[108:111]
ds_read_b64_tr_b16 v[162:163], v6 offset:26624
ds_read_b64_tr_b16 v[164:165], v7 offset:24576
v_mfma_f32_16x16x32_bf16 v[124:127], v[52:55], v[36:39], v[124:127]
ds_read_b64_tr_b16 v[166:167], v7 offset:26624
ds_read_b128 v[148:151], v2 offset:50176
v_mfma_f32_16x16x32_bf16 v[120:123], v[48:51], v[36:39], v[120:123]
ds_read_b128 v[168:171], v2 offset:57344
ds_read_b64_tr_b16 v[176:177], v4 offset:28672
v_mfma_f32_16x16x32_bf16 v[116:119], v[44:47], v[36:39], v[116:119]
ds_read_b64_tr_b16 v[178:179], v4 offset:30720
ds_read_b64_tr_b16 v[180:181], v5 offset:28672
v_mfma_f32_16x16x32_bf16 v[112:115], v[40:43], v[36:39], v[112:115]
ds_read_b64_tr_b16 v[182:183], v5 offset:30720
ds_read_b64_tr_b16 v[184:185], v6 offset:28672
v_mfma_f32_16x16x32_bf16 v[96:99], v[64:67], v[56:59], v[96:99]
ds_read_b64_tr_b16 v[186:187], v6 offset:30720
ds_read_b64_tr_b16 v[188:189], v7 offset:28672
v_mfma_f32_16x16x32_bf16 v[100:103], v[68:71], v[56:59], v[100:103]
ds_read_b64_tr_b16 v[190:191], v7 offset:30720
ds_read_b128 v[172:175], v2 offset:58368
v_mfma_f32_16x16x32_bf16 v[104:107], v[72:75], v[56:59], v[104:107]
v_add_u32 v192, s43, v192
v_mfma_f32_16x16x32_bf16 v[108:111], v[76:79], v[56:59], v[108:111]
v_add_u32 v193, s43, v193
v_mfma_f32_16x16x32_bf16 v[124:127], v[76:79], v[60:63], v[124:127]
v_add_u32 v194, s43, v194
v_mfma_f32_16x16x32_bf16 v[120:123], v[72:75], v[60:63], v[120:123]
s_and_b32 s43, s36, 3
v_mfma_f32_16x16x32_bf16 v[116:119], v[68:71], v[60:63], v[116:119]
s_mul_i32 s50, s43, 6144
v_mfma_f32_16x16x32_bf16 v[112:115], v[64:67], v[60:63], v[112:115]
s_add_u32 s50, s50, 16384
s_waitcnt lgkmcnt(0)
s_barrier
v_mfma_f32_16x16x32_bf16 v[96:99], v[152:155], v[144:147], v[96:99]
ds_read_b128 v[32:35], v3 offset:0
ds_read_b64_tr_b16 v[40:41], v4 offset:32768
v_mfma_f32_16x16x32_bf16 v[100:103], v[156:159], v[144:147], v[100:103]
ds_read_b64_tr_b16 v[42:43], v4 offset:34816
ds_read_b64_tr_b16 v[44:45], v5 offset:32768
v_mfma_f32_16x16x32_bf16 v[104:107], v[160:163], v[144:147], v[104:107]
ds_read_b64_tr_b16 v[46:47], v5 offset:34816
ds_read_b64_tr_b16 v[48:49], v6 offset:32768
v_mfma_f32_16x16x32_bf16 v[108:111], v[164:167], v[144:147], v[108:111]
ds_read_b64_tr_b16 v[50:51], v6 offset:34816
ds_read_b64_tr_b16 v[52:53], v7 offset:32768
v_mfma_f32_16x16x32_bf16 v[124:127], v[164:167], v[148:151], v[124:127]
ds_read_b64_tr_b16 v[54:55], v7 offset:34816
ds_read_b128 v[36:39], v3 offset:1024
v_mfma_f32_16x16x32_bf16 v[120:123], v[160:163], v[148:151], v[120:123]
ds_read_b128 v[56:59], v3 offset:8192
ds_read_b64_tr_b16 v[64:65], v4 offset:36864
v_mfma_f32_16x16x32_bf16 v[116:119], v[156:159], v[148:151], v[116:119]
ds_read_b64_tr_b16 v[66:67], v4 offset:38912
ds_read_b64_tr_b16 v[68:69], v5 offset:36864
v_mfma_f32_16x16x32_bf16 v[112:115], v[152:155], v[148:151], v[112:115]
ds_read_b64_tr_b16 v[70:71], v5 offset:38912
ds_read_b64_tr_b16 v[72:73], v6 offset:36864
v_mfma_f32_16x16x32_bf16 v[96:99], v[176:179], v[168:171], v[96:99]
ds_read_b64_tr_b16 v[74:75], v6 offset:38912
ds_read_b64_tr_b16 v[76:77], v7 offset:36864
v_mfma_f32_16x16x32_bf16 v[100:103], v[180:183], v[168:171], v[100:103]
ds_read_b64_tr_b16 v[78:79], v7 offset:38912
ds_read_b128 v[60:63], v3 offset:9216
v_mfma_f32_16x16x32_bf16 v[104:107], v[184:187], v[168:171], v[104:107]
s_bitcmp0_b32 s2, 0
v_mfma_f32_16x16x32_bf16 v[108:111], v[188:191], v[168:171], v[108:111]
s_cselect_b32 s88, s72, s74
v_mfma_f32_16x16x32_bf16 v[124:127], v[188:191], v[172:175], v[124:127]
s_cselect_b32 s89, s73, s75
v_mfma_f32_16x16x32_bf16 v[120:123], v[184:187], v[172:175], v[120:123]
s_mov_b32 s90, 7340032
v_mfma_f32_16x16x32_bf16 v[116:119], v[180:183], v[172:175], v[116:119]
s_mov_b32 s91, 0x20000
v_mfma_f32_16x16x32_bf16 v[112:115], v[176:179], v[172:175], v[112:115]
s_bfe_u32 s44, s2, 0x30001
s_waitcnt lgkmcnt(0)
s_barrier
v_mfma_f32_16x16x32_bf16 v[96:99], v[40:43], v[32:35], v[96:99]
ds_read_b128 v[144:147], v3 offset:49152
ds_read_b64_tr_b16 v[152:153], v4 offset:40960
v_mfma_f32_16x16x32_bf16 v[100:103], v[44:47], v[32:35], v[100:103]
ds_read_b64_tr_b16 v[154:155], v4 offset:43008
ds_read_b64_tr_b16 v[156:157], v5 offset:40960
v_mfma_f32_16x16x32_bf16 v[104:107], v[48:51], v[32:35], v[104:107]
ds_read_b64_tr_b16 v[158:159], v5 offset:43008
ds_read_b64_tr_b16 v[160:161], v6 offset:40960
v_mfma_f32_16x16x32_bf16 v[108:111], v[52:55], v[32:35], v[108:111]
ds_read_b64_tr_b16 v[162:163], v6 offset:43008
ds_read_b64_tr_b16 v[164:165], v7 offset:40960
v_mfma_f32_16x16x32_bf16 v[124:127], v[52:55], v[36:39], v[124:127]
ds_read_b64_tr_b16 v[166:167], v7 offset:43008
ds_read_b128 v[148:151], v3 offset:50176
v_mfma_f32_16x16x32_bf16 v[120:123], v[48:51], v[36:39], v[120:123]
ds_read_b128 v[168:171], v3 offset:57344
ds_read_b64_tr_b16 v[176:177], v4 offset:45056
v_mfma_f32_16x16x32_bf16 v[116:119], v[44:47], v[36:39], v[116:119]
ds_read_b64_tr_b16 v[178:179], v4 offset:47104
ds_read_b64_tr_b16 v[180:181], v5 offset:45056
v_mfma_f32_16x16x32_bf16 v[112:115], v[40:43], v[36:39], v[112:115]
ds_read_b64_tr_b16 v[182:183], v5 offset:47104
ds_read_b64_tr_b16 v[184:185], v6 offset:45056
v_mfma_f32_16x16x32_bf16 v[96:99], v[64:67], v[56:59], v[96:99]
ds_read_b64_tr_b16 v[186:187], v6 offset:47104
ds_read_b64_tr_b16 v[188:189], v7 offset:45056
v_mfma_f32_16x16x32_bf16 v[100:103], v[68:71], v[56:59], v[100:103]
ds_read_b64_tr_b16 v[190:191], v7 offset:47104
ds_read_b128 v[172:175], v3 offset:58368
v_mfma_f32_16x16x32_bf16 v[104:107], v[72:75], v[56:59], v[104:107]
s_lshl_b32 s44, s44, 2
v_mfma_f32_16x16x32_bf16 v[108:111], v[76:79], v[56:59], v[108:111]
s_and_b32 s43, s36, 3
v_mfma_f32_16x16x32_bf16 v[124:127], v[76:79], v[60:63], v[124:127]
s_add_u32 s44, s44, s43
v_mfma_f32_16x16x32_bf16 v[120:123], v[72:75], v[60:63], v[120:123]
s_lshl_b32 s44, s44, 5
v_mfma_f32_16x16x32_bf16 v[116:119], v[68:71], v[60:63], v[116:119]
v_lshrrev_b32 v195, 4, v1
v_mfma_f32_16x16x32_bf16 v[112:115], v[64:67], v[60:63], v[112:115]
v_add_u32 v195, s44, v195
s_waitcnt lgkmcnt(0)
s_barrier
v_mfma_f32_16x16x32_bf16 v[96:99], v[152:155], v[144:147], v[96:99]
ds_read_b128 v[32:35], v2 offset:0
ds_read_b64_tr_b16 v[40:41], v16 offset:49152
v_mfma_f32_16x16x32_bf16 v[100:103], v[156:159], v[144:147], v[100:103]
ds_read_b64_tr_b16 v[42:43], v16 offset:51200
ds_read_b64_tr_b16 v[44:45], v17 offset:49152
v_mfma_f32_16x16x32_bf16 v[104:107], v[160:163], v[144:147], v[104:107]
ds_read_b64_tr_b16 v[46:47], v17 offset:51200
ds_read_b64_tr_b16 v[48:49], v18 offset:49152
v_mfma_f32_16x16x32_bf16 v[108:111], v[164:167], v[144:147], v[108:111]
ds_read_b64_tr_b16 v[50:51], v18 offset:51200
ds_read_b64_tr_b16 v[52:53], v19 offset:49152
v_mfma_f32_16x16x32_bf16 v[124:127], v[164:167], v[148:151], v[124:127]
ds_read_b64_tr_b16 v[54:55], v19 offset:51200
ds_read_b128 v[36:39], v2 offset:1024
v_mfma_f32_16x16x32_bf16 v[120:123], v[160:163], v[148:151], v[120:123]
ds_read_b128 v[56:59], v2 offset:8192
ds_read_b64_tr_b16 v[64:65], v16 offset:53248
v_mfma_f32_16x16x32_bf16 v[116:119], v[156:159], v[148:151], v[116:119]
ds_read_b64_tr_b16 v[66:67], v16 offset:55296
ds_read_b64_tr_b16 v[68:69], v17 offset:53248
v_mfma_f32_16x16x32_bf16 v[112:115], v[152:155], v[148:151], v[112:115]
ds_read_b64_tr_b16 v[70:71], v17 offset:55296
ds_read_b64_tr_b16 v[72:73], v18 offset:53248
v_mfma_f32_16x16x32_bf16 v[96:99], v[176:179], v[168:171], v[96:99]
ds_read_b64_tr_b16 v[74:75], v18 offset:55296
ds_read_b64_tr_b16 v[76:77], v19 offset:53248
v_mfma_f32_16x16x32_bf16 v[100:103], v[180:183], v[168:171], v[100:103]
ds_read_b64_tr_b16 v[78:79], v19 offset:55296
ds_read_b128 v[60:63], v2 offset:9216
v_mfma_f32_16x16x32_bf16 v[104:107], v[184:187], v[168:171], v[104:107]
v_mul_u32_u24 v195, 7168, v195
v_mfma_f32_16x16x32_bf16 v[108:111], v[188:191], v[168:171], v[108:111]
v_and_b32 v196, 15, v1
v_mfma_f32_16x16x32_bf16 v[124:127], v[188:191], v[172:175], v[124:127]
v_lshl_add_u32 v195, v196, 4, v195
v_mfma_f32_16x16x32_bf16 v[120:123], v[184:187], v[172:175], v[120:123]
s_lshr_b32 s43, s2, 4
v_mfma_f32_16x16x32_bf16 v[116:119], v[180:183], v[172:175], v[116:119]
s_lshl_b32 s43, s43, 8
v_mfma_f32_16x16x32_bf16 v[112:115], v[176:179], v[172:175], v[112:115]
v_add_u32 v195, s43, v195
s_waitcnt lgkmcnt(0)
s_barrier
v_mfma_f32_16x16x32_bf16 v[96:99], v[40:43], v[32:35], v[96:99]
ds_read_b128 v[144:147], v2 offset:49152
ds_read_b64_tr_b16 v[152:153], v16 offset:57344
v_mfma_f32_16x16x32_bf16 v[100:103], v[44:47], v[32:35], v[100:103]
ds_read_b64_tr_b16 v[154:155], v16 offset:59392
ds_read_b64_tr_b16 v[156:157], v17 offset:57344
v_mfma_f32_16x16x32_bf16 v[104:107], v[48:51], v[32:35], v[104:107]
ds_read_b64_tr_b16 v[158:159], v17 offset:59392
ds_read_b64_tr_b16 v[160:161], v18 offset:57344
v_mfma_f32_16x16x32_bf16 v[108:111], v[52:55], v[32:35], v[108:111]
ds_read_b64_tr_b16 v[162:163], v18 offset:59392
ds_read_b64_tr_b16 v[164:165], v19 offset:57344
v_mfma_f32_16x16x32_bf16 v[124:127], v[52:55], v[36:39], v[124:127]
ds_read_b64_tr_b16 v[166:167], v19 offset:59392
ds_read_b128 v[148:151], v2 offset:50176
v_mfma_f32_16x16x32_bf16 v[120:123], v[48:51], v[36:39], v[120:123]
ds_read_b128 v[168:171], v2 offset:57344
ds_read_b64_tr_b16 v[176:177], v16 offset:61440
v_mfma_f32_16x16x32_bf16 v[116:119], v[44:47], v[36:39], v[116:119]
ds_read_b64_tr_b16 v[178:179], v16 offset:63488
ds_read_b64_tr_b16 v[180:181], v17 offset:61440
v_mfma_f32_16x16x32_bf16 v[112:115], v[40:43], v[36:39], v[112:115]
ds_read_b64_tr_b16 v[182:183], v17 offset:63488
ds_read_b64_tr_b16 v[184:185], v18 offset:61440
v_mfma_f32_16x16x32_bf16 v[96:99], v[64:67], v[56:59], v[96:99]
ds_read_b64_tr_b16 v[186:187], v18 offset:63488
ds_read_b64_tr_b16 v[188:189], v19 offset:61440
v_mfma_f32_16x16x32_bf16 v[100:103], v[68:71], v[56:59], v[100:103]
ds_read_b64_tr_b16 v[190:191], v19 offset:63488
ds_read_b128 v[172:175], v2 offset:58368
v_mfma_f32_16x16x32_bf16 v[104:107], v[72:75], v[56:59], v[104:107]
v_mfma_f32_16x16x32_bf16 v[108:111], v[76:79], v[56:59], v[108:111]
v_mfma_f32_16x16x32_bf16 v[124:127], v[76:79], v[60:63], v[124:127]
v_mfma_f32_16x16x32_bf16 v[120:123], v[72:75], v[60:63], v[120:123]
v_mfma_f32_16x16x32_bf16 v[116:119], v[68:71], v[60:63], v[116:119]
v_mfma_f32_16x16x32_bf16 v[112:115], v[64:67], v[60:63], v[112:115]
s_waitcnt lgkmcnt(0)
s_barrier
v_mfma_f32_16x16x32_bf16 v[96:99], v[152:155], v[144:147], v[96:99]
ds_read_b128 v[32:35], v3 offset:0
ds_read_b64_tr_b16 v[40:41], v20 offset:0
v_mfma_f32_16x16x32_bf16 v[100:103], v[156:159], v[144:147], v[100:103]
ds_read_b64_tr_b16 v[42:43], v20 offset:2048
ds_read_b64_tr_b16 v[44:45], v21 offset:0
v_mfma_f32_16x16x32_bf16 v[104:107], v[160:163], v[144:147], v[104:107]
ds_read_b64_tr_b16 v[46:47], v21 offset:2048
ds_read_b64_tr_b16 v[48:49], v22 offset:0
v_mfma_f32_16x16x32_bf16 v[108:111], v[164:167], v[144:147], v[108:111]
ds_read_b64_tr_b16 v[50:51], v22 offset:2048
ds_read_b64_tr_b16 v[52:53], v23 offset:0
v_mfma_f32_16x16x32_bf16 v[124:127], v[164:167], v[148:151], v[124:127]
ds_read_b64_tr_b16 v[54:55], v23 offset:2048
ds_read_b128 v[36:39], v3 offset:1024
v_mfma_f32_16x16x32_bf16 v[120:123], v[160:163], v[148:151], v[120:123]
ds_read_b128 v[56:59], v3 offset:8192
ds_read_b64_tr_b16 v[64:65], v20 offset:4096
v_mfma_f32_16x16x32_bf16 v[116:119], v[156:159], v[148:151], v[116:119]
ds_read_b64_tr_b16 v[66:67], v20 offset:6144
ds_read_b64_tr_b16 v[68:69], v21 offset:4096
v_mfma_f32_16x16x32_bf16 v[112:115], v[152:155], v[148:151], v[112:115]
ds_read_b64_tr_b16 v[70:71], v21 offset:6144
ds_read_b64_tr_b16 v[72:73], v22 offset:4096
v_mfma_f32_16x16x32_bf16 v[96:99], v[176:179], v[168:171], v[96:99]
ds_read_b64_tr_b16 v[74:75], v22 offset:6144
ds_read_b64_tr_b16 v[76:77], v23 offset:4096
v_mfma_f32_16x16x32_bf16 v[100:103], v[180:183], v[168:171], v[100:103]
ds_read_b64_tr_b16 v[78:79], v23 offset:6144
ds_read_b128 v[60:63], v3 offset:9216
v_mfma_f32_16x16x32_bf16 v[104:107], v[184:187], v[168:171], v[104:107]
v_mfma_f32_16x16x32_bf16 v[108:111], v[188:191], v[168:171], v[108:111]
v_mfma_f32_16x16x32_bf16 v[124:127], v[188:191], v[172:175], v[124:127]
v_mfma_f32_16x16x32_bf16 v[120:123], v[184:187], v[172:175], v[120:123]
v_mfma_f32_16x16x32_bf16 v[116:119], v[180:183], v[172:175], v[116:119]
s_branch Lov_6
.p2align 12
.fill 48, 4, 0xbf800000
Lst_6_0:
s_branch Lwr_146
s_nop 0
s_nop 0
Lov_6:
v_mfma_f32_16x16x32_bf16 v[112:115], v[176:179], v[172:175], v[112:115]
s_waitcnt lgkmcnt(0)
v_mfma_f32_16x16x32_bf16 v[96:99], v[40:43], v[32:35], v[96:99]
ds_read_b128 v[144:147], v3 offset:49152
ds_read_b64_tr_b16 v[152:153], v20 offset:8192
v_mfma_f32_16x16x32_bf16 v[100:103], v[44:47], v[32:35], v[100:103]
ds_read_b64_tr_b16 v[154:155], v20 offset:10240
ds_read_b64_tr_b16 v[156:157], v21 offset:8192
v_mfma_f32_16x16x32_bf16 v[104:107], v[48:51], v[32:35], v[104:107]
ds_read_b64_tr_b16 v[158:159], v21 offset:10240
ds_read_b64_tr_b16 v[160:161], v22 offset:8192
v_mfma_f32_16x16x32_bf16 v[108:111], v[52:55], v[32:35], v[108:111]
ds_read_b64_tr_b16 v[162:163], v22 offset:10240
ds_read_b64_tr_b16 v[164:165], v23 offset:8192
v_mfma_f32_16x16x32_bf16 v[124:127], v[52:55], v[36:39], v[124:127]
ds_read_b64_tr_b16 v[166:167], v23 offset:10240
ds_read_b128 v[148:151], v3 offset:50176
v_mfma_f32_16x16x32_bf16 v[120:123], v[48:51], v[36:39], v[120:123]
ds_read_b128 v[168:171], v3 offset:57344
ds_read_b64_tr_b16 v[176:177], v20 offset:12288
v_mfma_f32_16x16x32_bf16 v[116:119], v[44:47], v[36:39], v[116:119]
ds_read_b64_tr_b16 v[178:179], v20 offset:14336
ds_read_b64_tr_b16 v[180:181], v21 offset:12288
v_mfma_f32_16x16x32_bf16 v[112:115], v[40:43], v[36:39], v[112:115]
ds_read_b64_tr_b16 v[182:183], v21 offset:14336
ds_read_b64_tr_b16 v[184:185], v22 offset:12288
v_mfma_f32_16x16x32_bf16 v[96:99], v[64:67], v[56:59], v[96:99]
ds_read_b64_tr_b16 v[186:187], v22 offset:14336
ds_read_b64_tr_b16 v[188:189], v23 offset:12288
v_mfma_f32_16x16x32_bf16 v[100:103], v[68:71], v[56:59], v[100:103]
ds_read_b64_tr_b16 v[190:191], v23 offset:14336
ds_read_b128 v[172:175], v3 offset:58368
v_mfma_f32_16x16x32_bf16 v[104:107], v[72:75], v[56:59], v[104:107]
v_mfma_f32_16x16x32_bf16 v[108:111], v[76:79], v[56:59], v[108:111]
v_mfma_f32_16x16x32_bf16 v[124:127], v[76:79], v[60:63], v[124:127]
v_mfma_f32_16x16x32_bf16 v[120:123], v[72:75], v[60:63], v[120:123]
v_mfma_f32_16x16x32_bf16 v[116:119], v[68:71], v[60:63], v[116:119]
v_mfma_f32_16x16x32_bf16 v[112:115], v[64:67], v[60:63], v[112:115]
s_waitcnt lgkmcnt(0)
v_mfma_f32_16x16x32_bf16 v[96:99], v[152:155], v[144:147], v[96:99]
v_mfma_f32_16x16x32_bf16 v[100:103], v[156:159], v[144:147], v[100:103]
v_mfma_f32_16x16x32_bf16 v[104:107], v[160:163], v[144:147], v[104:107]
v_mfma_f32_16x16x32_bf16 v[108:111], v[164:167], v[144:147], v[108:111]
v_mfma_f32_16x16x32_bf16 v[124:127], v[164:167], v[148:151], v[124:127]
v_mfma_f32_16x16x32_bf16 v[120:123], v[160:163], v[148:151], v[120:123]
v_mfma_f32_16x16x32_bf16 v[116:119], v[156:159], v[148:151], v[116:119]
v_mfma_f32_16x16x32_bf16 v[112:115], v[152:155], v[148:151], v[112:115]
v_mfma_f32_16x16x32_bf16 v[96:99], v[176:179], v[168:171], v[96:99]
v_mfma_f32_16x16x32_bf16 v[100:103], v[180:183], v[168:171], v[100:103]
v_mfma_f32_16x16x32_bf16 v[104:107], v[184:187], v[168:171], v[104:107]
v_mfma_f32_16x16x32_bf16 v[108:111], v[188:191], v[168:171], v[108:111]
v_mfma_f32_16x16x32_bf16 v[124:127], v[188:191], v[172:175], v[124:127]
v_mfma_f32_16x16x32_bf16 v[120:123], v[184:187], v[172:175], v[120:123]
v_mfma_f32_16x16x32_bf16 v[116:119], v[180:183], v[172:175], v[116:119]
v_mfma_f32_16x16x32_bf16 v[112:115], v[176:179], v[172:175], v[112:115]
s_nop 3
v_cvt_pk_bf16_f32 v32, v96, v97
v_cvt_pk_bf16_f32 v33, v98, v99
v_cvt_pk_bf16_f32 v34, v100, v101
v_cvt_pk_bf16_f32 v35, v102, v103
s_add_u32 s43, s60, 0
buffer_store_dwordx4 v[32:35], v11, s[20:23], s43 offen offset:0 sc1
v_cvt_pk_bf16_f32 v36, v104, v105
v_cvt_pk_bf16_f32 v37, v106, v107
v_cvt_pk_bf16_f32 v38, v108, v109
v_cvt_pk_bf16_f32 v39, v110, v111
s_add_u32 s43, s60, 8192
buffer_store_dwordx4 v[36:39], v11, s[20:23], s43 offen offset:0 sc1
v_cvt_pk_bf16_f32 v44, v120, v121
v_cvt_pk_bf16_f32 v45, v122, v123
v_cvt_pk_bf16_f32 v46, v124, v125
v_cvt_pk_bf16_f32 v47, v126, v127
s_add_u32 s43, s60, 8192
buffer_store_dwordx4 v[44:47], v11, s[20:23], s43 offen offset:1024 sc1
v_cvt_pk_bf16_f32 v40, v112, v113
v_cvt_pk_bf16_f32 v41, v114, v115
v_cvt_pk_bf16_f32 v42, v116, v117
v_cvt_pk_bf16_f32 v43, v118, v119
s_add_u32 s43, s60, 0
buffer_store_dwordx4 v[40:43], v11, s[20:23], s43 offen offset:1024 sc1
v_mov_b32 v64, 0
v_mov_b32 v65, 0
v_mov_b32 v66, 0
v_mov_b32 v67, 0
v_mov_b32 v68, 0
v_mov_b32 v69, 0
v_mov_b32 v70, 0
v_mov_b32 v71, 0
v_dot2_f32_bf16 v64, v32, s61, v64
v_dot2_f32_bf16 v66, v32, v32, v66
v_dot2_f32_bf16 v68, v40, s61, v68
v_dot2_f32_bf16 v70, v40, v40, v70
v_dot2_f32_bf16 v65, v33, s61, v65
v_dot2_f32_bf16 v67, v33, v33, v67
v_dot2_f32_bf16 v69, v41, s61, v69
v_dot2_f32_bf16 v71, v41, v41, v71
v_dot2_f32_bf16 v64, v34, s61, v64
v_dot2_f32_bf16 v66, v34, v34, v66
v_dot2_f32_bf16 v68, v42, s61, v68
v_dot2_f32_bf16 v70, v42, v42, v70
v_dot2_f32_bf16 v65, v35, s61, v65
v_dot2_f32_bf16 v67, v35, v35, v67
v_dot2_f32_bf16 v69, v43, s61, v69
v_dot2_f32_bf16 v71, v43, v43, v71
v_dot2_f32_bf16 v64, v36, s61, v64
v_dot2_f32_bf16 v66, v36, v36, v66
v_dot2_f32_bf16 v68, v44, s61, v68
v_dot2_f32_bf16 v70, v44, v44, v70
v_dot2_f32_bf16 v65, v37, s61, v65
v_dot2_f32_bf16 v67, v37, v37, v67
v_dot2_f32_bf16 v69, v45, s61, v69
v_dot2_f32_bf16 v71, v45, v45, v71
v_dot2_f32_bf16 v64, v38, s61, v64
v_dot2_f32_bf16 v66, v38, v38, v66
v_dot2_f32_bf16 v68, v46, s61, v68
v_dot2_f32_bf16 v70, v46, v46, v70
v_dot2_f32_bf16 v65, v39, s61, v65
v_dot2_f32_bf16 v67, v39, v39, v67
v_dot2_f32_bf16 v69, v47, s61, v69
v_dot2_f32_bf16 v71, v47, v47, v71
s_nop 2
v_add_f32 v64, v64, v65
v_add_f32 v66, v66, v67
v_add_f32 v68, v68, v69
v_add_f32 v70, v70, v71
s_nop 1
v_permlane32_swap_b32 v64, v68
v_permlane32_swap_b32 v66, v70
v_add_f32 v64, v64, v68
v_add_f32 v66, v66, v70
s_nop 1
v_permlane16_swap_b32 v64, v66
v_add_f32 v64, v64, v66
buffer_store_dword v64, v9, s[24:27], 0 offen sc1
s_lshl_b32 s7, s34, 12
s_add_u32 s7, s7, 49280
v_lshl_add_u32 v4, v1, 8, s7
v_mov_b32 v5, 1
s_waitcnt vmcnt(0)
s_cmp_lg_u32 s36, 0
s_barrier
s_cbranch_scc1 Lk2end_83
s_mov_b64 exec, 0xffff
buffer_atomic_add v5, v4, s[56:59], 0 offen sc1
s_mov_b64 exec, -1
s_branch Lk2end_83
Lprod_84:
s_mul_i32 s43, s34, 262144
s_add_u32 s8, s82, s43
s_addc_u32 s9, s83, 0
s_mov_b32 s10, 262144
s_mov_b32 s11, 0x20000
s_lshl_b32 s43, s35, 7
s_add_u32 s12, s68, s43
s_addc_u32 s13, s69, 0
s_mov_b32 s14, 2095232
s_mov_b32 s15, 0x20000
s_and_b32 s47, s36, 3
s_lshl_b32 s39, s47, 12
v_lshlrev_b32 v2, 4, v1
v_add_u32 v2, s39, v2
v_lshrrev_b32 v12, 3, v1
v_and_b32 v13, 6, v12
v_and_b32 v3, 7, v1
v_xor_b32 v3, v3, v13
v_lshlrev_b32 v3, 4, v3
v_mul_u32_u24 v12, 2048, v12
v_add_u32 v3, v3, v12
s_lshl_b32 s43, s47, 15
v_add_u32 v3, s43, v3
s_lshl_b32 s40, s47, 11
s_add_u32 s37, s35, 0
s_and_b32 s37, s37, 15
s_lshl_b32 s37, s37, 14
s_add_u32 m0, s39, 0
s_nop 0
buffer_load_dwordx4 v2, s[8:11], s37 offen offset:0 sc1 lds
buffer_load_dwordx4 v2, s[8:11], s37 offen offset:1024 sc1 lds
buffer_load_dwordx4 v2, s[8:11], s37 offen offset:2048 sc1 lds
buffer_load_dwordx4 v2, s[8:11], s37 offen offset:3072 sc1 lds
s_add_u32 s38, s35, 8
s_and_b32 s38, s38, 15
s_lshl_b32 s38, s38, 17
s_add_u32 m0, s40, 16384
s_nop 0
buffer_load_dwordx4 v3, s[12:15], s38 offen lds
s_add_u32 m0, s40, 17408
s_add_u32 s38, s38, 16384
buffer_load_dwordx4 v3, s[12:15], s38 offen lds
s_add_u32 s38, s35, 9
s_and_b32 s38, s38, 15
s_lshl_b32 s38, s38, 17
s_add_u32 m0, s40, 24576
s_nop 0
buffer_load_dwordx4 v3, s[12:15], s38 offen lds
s_add_u32 m0, s40, 25600
s_add_u32 s38, s38, 16384
buffer_load_dwordx4 v3, s[12:15], s38 offen lds
s_add_u32 s38, s35, 10
s_and_b32 s38, s38, 15
s_lshl_b32 s38, s38, 17
s_add_u32 m0, s40, 32768
s_nop 0
buffer_load_dwordx4 v3, s[12:15], s38 offen lds
s_add_u32 m0, s40, 33792
s_add_u32 s38, s38, 16384
buffer_load_dwordx4 v3, s[12:15], s38 offen lds
s_add_u32 s38, s35, 11
s_and_b32 s38, s38, 15
s_lshl_b32 s38, s38, 17
s_add_u32 m0, s40, 40960
s_nop 0
buffer_load_dwordx4 v3, s[12:15], s38 offen lds
s_add_u32 m0, s40, 41984
s_add_u32 s38, s38, 16384
buffer_load_dwordx4 v3, s[12:15], s38 offen lds
s_bitcmp0_b32 s36, 1
s_cselect_b32 s44, s72, s74
s_cselect_b32 s45, s73, s75
s_mul_i32 s43, s35, 192
s_add_u32 s16, s44, s43
s_addc_u32 s17, s45, 0
s_add_u32 s16, s16, 4096
s_addc_u32 s17, s17, 0
s_mov_b32 s18, 7333056
s_mov_b32 s19, 0x20000
s_and_b32 s43, s36, 1
s_mul_i32 s43, s43, 229376
v_add_u32 v196, 0, v1
v_mul_u32_u24 v197, 5462, v196
v_lshrrev_b32 v197, 16, v197
v_mul_u32_u24 v198, 12, v197
v_sub_u32 v198, v196, v198
v_bfe_u32 v199, v197, 2, 1
v_cmp_gt_u32 vcc, 8, v198
v_lshlrev_b32 v200, 1, v199
v_mul_u32_u24 v197, 7168, v197
v_cndmask_b32 v199, v199, v200, vcc
v_xor_b32 v198, v198, v199
v_lshl_add_u32 v192, v198, 4, v197
v_add_u32 v196, 64, v1
v_mul_u32_u24 v197, 5462, v196
v_lshrrev_b32 v197, 16, v197
v_mul_u32_u24 v198, 12, v197
v_sub_u32 v198, v196, v198
v_bfe_u32 v199, v197, 2, 1
v_cmp_gt_u32 vcc, 8, v198
v_lshlrev_b32 v200, 1, v199
v_mul_u32_u24 v197, 7168, v197
v_cndmask_b32 v199, v199, v200, vcc
v_xor_b32 v198, v198, v199
v_lshl_add_u32 v193, v198, 4, v197
v_add_u32 v196, 128, v1
v_mul_u32_u24 v197, 5462, v196
v_lshrrev_b32 v197, 16, v197
v_mul_u32_u24 v198, 12, v197
v_sub_u32 v198, v196, v198
v_bfe_u32 v199, v197, 2, 1
v_cmp_gt_u32 vcc, 8, v198
v_lshlrev_b32 v200, 1, v199
v_mul_u32_u24 v197, 7168, v197
v_cndmask_b32 v199, v199, v200, vcc
v_xor_b32 v198, v198, v199
v_lshl_add_u32 v194, v198, 4, v197
v_add_u32 v192, s43, v192
v_add_u32 v193, s43, v193
v_add_u32 v194, s43, v194
s_and_b32 s43, s36, 3
s_mul_i32 s50, s43, 6144
s_add_u32 s50, s50, 16384
s_cmp_eq_u32 s47, 3
s_cbranch_scc0 Lw_86
s_lshl_b32 s92, s34, 4
s_add_u32 s92, s92, s35
s_lshl_b32 s92, s92, 8
s_add_u32 s92, s92, 49152
s_add_u32 s92, s92, 28311552
s_mov_b32 s41, 0x40000
Lpoll_87:
s_load_dword s93, s[82:83], s92 glc
Lpchk_89:
s_waitcnt lgkmcnt(0)
s_cmp_eq_u32 s93, 16
s_cbranch_scc1 Lpok_88
s_sub_u32 s41, s41, 1
s_cmp_lg_u32 s41, 0
s_cbranch_scc1 Lpoll_87
Lpok_88:
Lw_86:
s_and_b32 s44, s36, 3
s_mul_i32 s44, s44, 32
s_bfe_u32 s43, s2, 0x30001
s_lshl_b32 s43, s43, 7
s_add_u32 s44, s44, s43
s_add_u32 s44, s44, 0
s_mul_i32 s44, s44, 7168
s_lshr_b32 s43, s2, 4
s_lshl_b32 s43, s43, 8
s_add_u32 s43, s43, s44
s_bitcmp0_b32 s2, 0
s_cselect_b32 s4, s72, s74
s_cselect_b32 s5, s73, s75
s_add_u32 s4, s4, s43
s_addc_u32 s5, s5, 0
s_cmp_eq_u32 s47, 3
s_cbranch_scc1 Lw_90
Lw_90:
s_waitcnt vmcnt(8)
s_barrier
s_add_u32 s37, s35, 1
s_and_b32 s37, s37, 15
s_lshl_b32 s37, s37, 14
s_add_u32 m0, s39, 49152
s_nop 0
buffer_load_dwordx4 v2, s[8:11], s37 offen offset:0 sc1 lds
buffer_load_dwordx4 v2, s[8:11], s37 offen offset:1024 sc1 lds
buffer_load_dwordx4 v2, s[8:11], s37 offen offset:2048 sc1 lds
buffer_load_dwordx4 v2, s[8:11], s37 offen offset:3072 sc1 lds
s_add_u32 s37, s35, 2
s_and_b32 s37, s37, 15
s_lshl_b32 s37, s37, 14
s_add_u32 m0, s39, 98304
s_nop 0
buffer_load_dwordx4 v2, s[8:11], s37 offen offset:0 sc1 lds
buffer_load_dwordx4 v2, s[8:11], s37 offen offset:1024 sc1 lds
buffer_load_dwordx4 v2, s[8:11], s37 offen offset:2048 sc1 lds
buffer_load_dwordx4 v2, s[8:11], s37 offen offset:3072 sc1 lds
s_add_u32 s37, s35, 3
s_and_b32 s37, s37, 15
s_lshl_b32 s37, s37, 14
s_add_u32 m0, s39, 147456
s_nop 0
buffer_load_dwordx4 v2, s[8:11], s37 offen offset:0 sc1 lds
buffer_load_dwordx4 v2, s[8:11], s37 offen offset:1024 sc1 lds
buffer_load_dwordx4 v2, s[8:11], s37 offen offset:2048 sc1 lds
buffer_load_dwordx4 v2, s[8:11], s37 offen offset:3072 sc1 lds
s_cmp_eq_u32 s47, 3
s_cbranch_scc0 Lw_91
Lw_91:
s_waitcnt vmcnt(8)
s_barrier
s_add_u32 s37, s35, 4
s_and_b32 s37, s37, 15
s_lshl_b32 s37, s37, 14
s_add_u32 m0, s39, 0
s_nop 0
buffer_load_dwordx4 v2, s[8:11], s37 offen offset:0 sc1 lds
buffer_load_dwordx4 v2, s[8:11], s37 offen offset:1024 sc1 lds
buffer_load_dwordx4 v2, s[8:11], s37 offen offset:2048 sc1 lds
buffer_load_dwordx4 v2, s[8:11], s37 offen offset:3072 sc1 lds
s_waitcnt vmcnt(8)
s_barrier
s_add_u32 s37, s35, 5
s_and_b32 s37, s37, 15
s_lshl_b32 s37, s37, 14
s_add_u32 m0, s39, 49152
s_nop 0
buffer_load_dwordx4 v2, s[8:11], s37 offen offset:0 sc1 lds
buffer_load_dwordx4 v2, s[8:11], s37 offen offset:1024 sc1 lds
buffer_load_dwordx4 v2, s[8:11], s37 offen offset:2048 sc1 lds
buffer_load_dwordx4 v2, s[8:11], s37 offen offset:3072 sc1 lds
s_waitcnt vmcnt(8)
s_barrier
s_add_u32 s37, s35, 6
s_and_b32 s37, s37, 15
s_lshl_b32 s37, s37, 14
s_add_u32 m0, s39, 98304
s_nop 0
buffer_load_dwordx4 v2, s[8:11], s37 offen offset:0 sc1 lds
buffer_load_dwordx4 v2, s[8:11], s37 offen offset:1024 sc1 lds
buffer_load_dwordx4 v2, s[8:11], s37 offen offset:2048 sc1 lds
buffer_load_dwordx4 v2, s[8:11], s37 offen offset:3072 sc1 lds
s_waitcnt vmcnt(8)
s_barrier
s_add_u32 s37, s35, 7
s_and_b32 s37, s37, 15
s_lshl_b32 s37, s37, 14
s_add_u32 m0, s39, 147456
s_nop 0
buffer_load_dwordx4 v2, s[8:11], s37 offen offset:0 sc1 lds
buffer_load_dwordx4 v2, s[8:11], s37 offen offset:1024 sc1 lds
buffer_load_dwordx4 v2, s[8:11], s37 offen offset:2048 sc1 lds
buffer_load_dwordx4 v2, s[8:11], s37 offen offset:3072 sc1 lds
s_waitcnt vmcnt(8)
s_barrier
s_add_u32 s37, s35, 8
s_and_b32 s37, s37, 15
s_lshl_b32 s37, s37, 14
s_add_u32 m0, s39, 0
s_nop 0
buffer_load_dwordx4 v2, s[8:11], s37 offen offset:0 sc1 lds
buffer_load_dwordx4 v2, s[8:11], s37 offen offset:1024 sc1 lds
buffer_load_dwordx4 v2, s[8:11], s37 offen offset:2048 sc1 lds
buffer_load_dwordx4 v2, s[8:11], s37 offen offset:3072 sc1 lds
s_add_u32 s38, s35, 12
s_and_b32 s38, s38, 15
s_lshl_b32 s38, s38, 17
s_add_u32 m0, s40, 114688
s_nop 0
buffer_load_dwordx4 v3, s[12:15], s38 offen lds
s_add_u32 m0, s40, 115712
s_add_u32 s38, s38, 16384
buffer_load_dwordx4 v3, s[12:15], s38 offen lds
s_waitcnt vmcnt(10)
s_barrier
s_add_u32 s37, s35, 9
s_and_b32 s37, s37, 15
s_lshl_b32 s37, s37, 14
s_add_u32 m0, s39, 49152
s_nop 0
buffer_load_dwordx4 v2, s[8:11], s37 offen offset:0 sc1 lds
buffer_load_dwordx4 v2, s[8:11], s37 offen offset:1024 sc1 lds
buffer_load_dwordx4 v2, s[8:11], s37 offen offset:2048 sc1 lds
buffer_load_dwordx4 v2, s[8:11], s37 offen offset:3072 sc1 lds
s_add_u32 s38, s35, 13
s_and_b32 s38, s38, 15
s_lshl_b32 s38, s38, 17
s_add_u32 m0, s40, 122880
s_nop 0
buffer_load_dwordx4 v3, s[12:15], s38 offen lds
s_add_u32 m0, s40, 123904
s_add_u32 s38, s38, 16384
buffer_load_dwordx4 v3, s[12:15], s38 offen lds
s_waitcnt vmcnt(12)
s_barrier
s_add_u32 s37, s35, 10
s_and_b32 s37, s37, 15
s_lshl_b32 s37, s37, 14
s_add_u32 m0, s39, 98304
s_nop 0
buffer_load_dwordx4 v2, s[8:11], s37 offen offset:0 sc1 lds
buffer_load_dwordx4 v2, s[8:11], s37 offen offset:1024 sc1 lds
buffer_load_dwordx4 v2, s[8:11], s37 offen offset:2048 sc1 lds
buffer_load_dwordx4 v2, s[8:11], s37 offen offset:3072 sc1 lds
s_add_u32 s38, s35, 14
s_and_b32 s38, s38, 15
s_lshl_b32 s38, s38, 17
s_add_u32 m0, s40, 131072
s_nop 0
buffer_load_dwordx4 v3, s[12:15], s38 offen lds
s_add_u32 m0, s40, 132096
s_add_u32 s38, s38, 16384
buffer_load_dwordx4 v3, s[12:15], s38 offen lds
s_waitcnt vmcnt(14)
s_barrier
s_add_u32 s37, s35, 11
s_and_b32 s37, s37, 15
s_lshl_b32 s37, s37, 14
s_add_u32 m0, s39, 147456
s_nop 0
buffer_load_dwordx4 v2, s[8:11], s37 offen offset:0 sc1 lds
buffer_load_dwordx4 v2, s[8:11], s37 offen offset:1024 sc1 lds
buffer_load_dwordx4 v2, s[8:11], s37 offen offset:2048 sc1 lds
buffer_load_dwordx4 v2, s[8:11], s37 offen offset:3072 sc1 lds
s_add_u32 s38, s35, 15
s_and_b32 s38, s38, 15
s_lshl_b32 s38, s38, 17
s_add_u32 m0, s40, 139264
s_nop 0
buffer_load_dwordx4 v3, s[12:15], s38 offen lds
s_add_u32 m0, s40, 140288
s_add_u32 s38, s38, 16384
buffer_load_dwordx4 v3, s[12:15], s38 offen lds
s_waitcnt vmcnt(14)
s_barrier
s_add_u32 s37, s35, 12
s_and_b32 s37, s37, 15
s_lshl_b32 s37, s37, 14
s_add_u32 m0, s39, 0
s_nop 0
buffer_load_dwordx4 v2, s[8:11], s37 offen offset:0 sc1 lds
buffer_load_dwordx4 v2, s[8:11], s37 offen offset:1024 sc1 lds
buffer_load_dwordx4 v2, s[8:11], s37 offen offset:2048 sc1 lds
buffer_load_dwordx4 v2, s[8:11], s37 offen offset:3072 sc1 lds
s_waitcnt vmcnt(12)
s_barrier
s_add_u32 s37, s35, 13
s_and_b32 s37, s37, 15
s_lshl_b32 s37, s37, 14
s_add_u32 m0, s39, 49152
s_nop 0
buffer_load_dwordx4 v2, s[8:11], s37 offen offset:0 sc1 lds
buffer_load_dwordx4 v2, s[8:11], s37 offen offset:1024 sc1 lds
buffer_load_dwordx4 v2, s[8:11], s37 offen offset:2048 sc1 lds
buffer_load_dwordx4 v2, s[8:11], s37 offen offset:3072 sc1 lds
s_waitcnt vmcnt(10)
s_barrier
s_add_u32 s37, s35, 14
s_and_b32 s37, s37, 15
s_lshl_b32 s37, s37, 14
s_add_u32 m0, s39, 98304
s_nop 0
buffer_load_dwordx4 v2, s[8:11], s37 offen offset:0 sc1 lds
buffer_load_dwordx4 v2, s[8:11], s37 offen offset:1024 sc1 lds
buffer_load_dwordx4 v2, s[8:11], s37 offen offset:2048 sc1 lds
buffer_load_dwordx4 v2, s[8:11], s37 offen offset:3072 sc1 lds
s_getpc_b64 s[100:101]
s_and_b32 s100, s100, 0xfffff000
s_sub_u32 s100, s100, 1077248
s_subb_u32 s101, s101, 0
s_lshr_b32 s6, s2, 3
s_mul_i32 s6, s6, 4
s_and_b32 s7, s36, 3
s_add_u32 s6, s6, s7
s_mulk_i32 s6, 384
s_add_u32 s6, s6, 1081728
s_load_dword s3, s[100:101], s6 offset:0
s_load_dword s3, s[100:101], s6 offset:64
s_load_dword s3, s[100:101], s6 offset:128
s_load_dword s3, s[100:101], s6 offset:192
s_load_dword s3, s[100:101], s6 offset:256
s_load_dword s3, s[100:101], s6 offset:320
s_waitcnt vmcnt(8)
s_barrier
s_add_u32 s37, s35, 15
s_and_b32 s37, s37, 15
s_lshl_b32 s37, s37, 14
s_add_u32 m0, s39, 147456
s_nop 0
buffer_load_dwordx4 v2, s[8:11], s37 offen offset:0 sc1 lds
buffer_load_dwordx4 v2, s[8:11], s37 offen offset:1024 sc1 lds
buffer_load_dwordx4 v2, s[8:11], s37 offen offset:2048 sc1 lds
buffer_load_dwordx4 v2, s[8:11], s37 offen offset:3072 sc1 lds
s_waitcnt vmcnt(8)
s_barrier
s_waitcnt vmcnt(0)
s_barrier
s_add_u32 s38, s35, 0
s_and_b32 s38, s38, 15
s_mul_i32 s38, s38, 458752
s_add_u32 m0, s50, 0
s_nop 0
buffer_load_dwordx4 v192, s[16:19], s38 offen lds
s_add_u32 m0, s50, 1024
s_nop 0
buffer_load_dwordx4 v193, s[16:19], s38 offen lds
s_add_u32 m0, s50, 2048
s_nop 0
buffer_load_dwordx4 v194, s[16:19], s38 offen lds
s_add_u32 m0, s50, 3072
s_add_u32 s38, s38, 114688
buffer_load_dwordx4 v192, s[16:19], s38 offen lds
s_add_u32 m0, s50, 4096
s_nop 0
buffer_load_dwordx4 v193, s[16:19], s38 offen lds
s_add_u32 m0, s50, 5120
s_nop 0
buffer_load_dwordx4 v194, s[16:19], s38 offen lds
s_add_u32 s38, s35, 1
s_and_b32 s38, s38, 15
s_mul_i32 s38, s38, 458752
s_add_u32 m0, s50, 49152
s_nop 0
buffer_load_dwordx4 v192, s[16:19], s38 offen lds
s_add_u32 m0, s50, 50176
s_nop 0
buffer_load_dwordx4 v193, s[16:19], s38 offen lds
s_add_u32 m0, s50, 51200
s_nop 0
buffer_load_dwordx4 v194, s[16:19], s38 offen lds
s_add_u32 m0, s50, 52224
s_add_u32 s38, s38, 114688
buffer_load_dwordx4 v192, s[16:19], s38 offen lds
s_add_u32 m0, s50, 53248
s_nop 0
buffer_load_dwordx4 v193, s[16:19], s38 offen lds
s_add_u32 m0, s50, 54272
s_nop 0
buffer_load_dwordx4 v194, s[16:19], s38 offen lds
v_lshlrev_b32 v240, 16, v128
v_and_b32 v241, 0xffff0000, v128
v_lshlrev_b32 v242, 16, v129
v_and_b32 v243, 0xffff0000, v129
v_lshlrev_b32 v244, 16, v130
v_and_b32 v245, 0xffff0000, v130
v_lshlrev_b32 v246, 16, v131
v_and_b32 v247, 0xffff0000, v131
v_lshlrev_b32 v24, 16, v132
v_and_b32 v25, 0xffff0000, v132
v_lshlrev_b32 v26, 16, v133
v_and_b32 v27, 0xffff0000, v133
v_lshlrev_b32 v28, 16, v134
v_and_b32 v29, 0xffff0000, v134
v_lshlrev_b32 v30, 16, v135
v_and_b32 v31, 0xffff0000, v135
v_add_f32 v240, v240, v24
v_add_f32 v241, v241, v25
v_add_f32 v242, v242, v26
v_add_f32 v243, v243, v27
v_add_f32 v244, v244, v28
v_add_f32 v245, v245, v29
v_add_f32 v246, v246, v30
v_add_f32 v247, v247, v31
v_lshlrev_b32 v24, 16, v136
v_and_b32 v25, 0xffff0000, v136
v_lshlrev_b32 v26, 16, v137
v_and_b32 v27, 0xffff0000, v137
v_lshlrev_b32 v28, 16, v138
v_and_b32 v29, 0xffff0000, v138
v_lshlrev_b32 v30, 16, v139
v_and_b32 v31, 0xffff0000, v139
v_add_f32 v240, v240, v24
v_add_f32 v241, v241, v25
v_add_f32 v242, v242, v26
v_add_f32 v243, v243, v27
v_add_f32 v244, v244, v28
v_add_f32 v245, v245, v29
v_add_f32 v246, v246, v30
v_add_f32 v247, v247, v31
v_lshlrev_b32 v24, 16, v140
v_and_b32 v25, 0xffff0000, v140
v_lshlrev_b32 v26, 16, v141
v_and_b32 v27, 0xffff0000, v141
v_lshlrev_b32 v28, 16, v142
v_and_b32 v29, 0xffff0000, v142
v_lshlrev_b32 v30, 16, v143
v_and_b32 v31, 0xffff0000, v143
v_add_f32 v240, v240, v24
v_add_f32 v241, v241, v25
v_add_f32 v242, v242, v26
v_add_f32 v243, v243, v27
v_add_f32 v244, v244, v28
v_add_f32 v245, v245, v29
v_add_f32 v246, v246, v30
v_add_f32 v247, v247, v31
v_lshlrev_b32 v24, 16, v144
v_and_b32 v25, 0xffff0000, v144
v_lshlrev_b32 v26, 16, v145
v_and_b32 v27, 0xffff0000, v145
v_lshlrev_b32 v28, 16, v146
v_and_b32 v29, 0xffff0000, v146
v_lshlrev_b32 v30, 16, v147
v_and_b32 v31, 0xffff0000, v147
v_add_f32 v240, v240, v24
v_add_f32 v241, v241, v25
v_add_f32 v242, v242, v26
v_add_f32 v243, v243, v27
v_add_f32 v244, v244, v28
v_add_f32 v245, v245, v29
v_add_f32 v246, v246, v30
v_add_f32 v247, v247, v31
v_lshlrev_b32 v24, 16, v148
v_and_b32 v25, 0xffff0000, v148
v_lshlrev_b32 v26, 16, v149
v_and_b32 v27, 0xffff0000, v149
v_lshlrev_b32 v28, 16, v150
v_and_b32 v29, 0xffff0000, v150
v_lshlrev_b32 v30, 16, v151
v_and_b32 v31, 0xffff0000, v151
v_add_f32 v240, v240, v24
v_add_f32 v241, v241, v25
v_add_f32 v242, v242, v26
v_add_f32 v243, v243, v27
v_add_f32 v244, v244, v28
v_add_f32 v245, v245, v29
v_add_f32 v246, v246, v30
v_add_f32 v247, v247, v31
v_lshlrev_b32 v24, 16, v152
s_branch Lov_7
.p2align 12
.fill 48, 4, 0xbf800000
Lst_7_0:
s_branch Lwr_147
s_nop 0
s_nop 0
Lov_7:
v_and_b32 v25, 0xffff0000, v152
v_lshlrev_b32 v26, 16, v153
v_and_b32 v27, 0xffff0000, v153
v_lshlrev_b32 v28, 16, v154
v_and_b32 v29, 0xffff0000, v154
v_lshlrev_b32 v30, 16, v155
v_and_b32 v31, 0xffff0000, v155
v_add_f32 v240, v240, v24
v_add_f32 v241, v241, v25
v_add_f32 v242, v242, v26
v_add_f32 v243, v243, v27
v_add_f32 v244, v244, v28
v_add_f32 v245, v245, v29
v_add_f32 v246, v246, v30
v_add_f32 v247, v247, v31
v_lshlrev_b32 v24, 16, v156
v_and_b32 v25, 0xffff0000, v156
v_lshlrev_b32 v26, 16, v157
v_and_b32 v27, 0xffff0000, v157
v_lshlrev_b32 v28, 16, v158
v_and_b32 v29, 0xffff0000, v158
v_lshlrev_b32 v30, 16, v159
v_and_b32 v31, 0xffff0000, v159
v_add_f32 v240, v240, v24
v_add_f32 v241, v241, v25
v_add_f32 v242, v242, v26
v_add_f32 v243, v243, v27
v_add_f32 v244, v244, v28
v_add_f32 v245, v245, v29
v_add_f32 v246, v246, v30
v_add_f32 v247, v247, v31
s_nop 0
v_permlane32_swap_b32 v240, v244
v_permlane32_swap_b32 v241, v245
v_permlane32_swap_b32 v242, v246
v_permlane32_swap_b32 v243, v247
v_add_f32 v240, v240, v244
v_add_f32 v241, v241, v245
v_add_f32 v242, v242, v246
v_add_f32 v243, v243, v247
s_nop 0
v_permlane16_swap_b32 v240, v242
v_permlane16_swap_b32 v241, v243
v_add_f32 v240, v240, v242
v_add_f32 v241, v241, v243
s_branch Lk3a
Lk2end_83:
Lk3:
s_branch Lgb_92
Lk3a:
s_mul_i32 s43, s34, 262144
s_add_u32 s8, s82, s43
s_addc_u32 s9, s83, 0
s_add_u32 s8, s8, 4194304
s_addc_u32 s9, s9, 0
s_mov_b32 s10, 262144
s_mov_b32 s11, 0x20000
s_mul_i32 s43, s34, 917504
s_add_u32 s24, s82, s43
s_addc_u32 s25, s83, 0
s_add_u32 s24, s24, 8388608
s_addc_u32 s25, s25, 0
s_mov_b32 s26, 917504
s_mov_b32 s27, 0x20000
s_add_u32 s84, s82, 27262976
s_addc_u32 s85, s83, 0
s_mov_b32 s86, 229376
s_mov_b32 s87, 0x20000
s_and_b32 s47, s36, 3
s_lshr_b32 s62, s47, 1
s_and_b32 s63, s47, 1
v_lshlrev_b32 v2, 4, v1
s_lshl_b32 s39, s47, 12
v_add_u32 v3, s39, v2
s_bitcmp0_b32 s36, 1
s_cselect_b32 s44, s72, s74
s_cselect_b32 s45, s73, s75
s_mul_i32 s43, s35, 256
s_add_u32 s12, s44, s43
s_addc_u32 s13, s45, 0
s_mov_b32 s14, 7333120
s_mov_b32 s15, 0x20000
s_and_b32 s43, s36, 1
s_mul_i32 s43, s43, 229376
v_lshrrev_b32 v28, 4, v1
v_lshlrev_b32 v29, 1, v28
v_and_b32 v4, 15, v1
v_xor_b32 v4, v4, v29
v_lshlrev_b32 v4, 4, v4
v_mul_u32_u24 v28, 7168, v28
v_add_u32 v4, v4, v28
v_add_u32 v4, s43, v4
v_xor_b32 v5, 128, v4
v_add_u32 v5, 28672, v5
s_and_b32 s43, s36, 3
s_mul_i32 s40, s43, 8192
s_add_u32 s40, s40, 16384
v_mov_b32 v6, v192
v_mov_b32 v7, v193
v_mov_b32 v8, v194
s_lshl_b32 s43, s62, 12
v_add_u32 v9, s43, v2
v_add_u32 v10, 98304, v9
v_lshrrev_b32 v27, 2, v1
v_bfe_u32 v28, v27, 2, 1
v_mul_u32_u24 v27, 192, v27
v_add_u32 v27, 16384, v27
v_and_b32 v29, 3, v1
v_lshl_add_u32 v12, v29, 3, v27
s_lshl_b32 s43, s63, 6
v_add_u32 v12, s43, v12
v_lshl_add_u32 v11, v28, 5, v12
v_xor_b32 v30, 1, v28
v_lshl_add_u32 v12, v30, 5, v12
v_xor_b32 v28, s63, v28
v_lshl_add_u32 v27, v28, 4, v27
v_lshrrev_b32 v28, 1, v29
v_lshl_add_u32 v27, v28, 5, v27
v_and_b32 v28, 1, v29
v_lshl_add_u32 v27, v28, 3, v27
v_add_u32 v13, 128, v27
v_add_u32 v14, 49152, v11
v_add_u32 v15, 49152, v12
v_add_u32 v16, 49152, v13
v_add_u32 v17, 98304, v11
v_add_u32 v18, 98304, v12
v_add_u32 v19, 98304, v13
s_cmp_lg_u32 s36, 4
s_cbranch_scc1 Lwm_94
s_branch Lst_8_1
Lwr_155:
s_branch Lwe_93
Lwm_94:
s_cmp_lg_u32 s36, 5
s_cbranch_scc1 Lwm_95
s_branch Lst_9_1
Lwr_156:
s_branch Lwe_93
Lwm_95:
s_cmp_lg_u32 s36, 6
s_cbranch_scc1 Lwm_96
s_branch Lst_10_1
Lwr_157:
s_branch Lwe_93
Lwm_96:
s_cmp_lg_u32 s36, 7
s_cbranch_scc1 Lwm_97
s_nop 0
s_branch Lwe_93
Lwm_97:
Lwe_93:
s_barrier
s_lshl_b32 s43, s47, 9
s_add_u32 s43, s43, 151552
v_and_b32 v28, 15, v1
v_lshl_add_u32 v28, v28, 5, s43
v_lshrrev_b32 v29, 4, v1
v_lshl_add_u32 v28, v29, 3, v28
ds_write_b64 v28, v[240:241]
s_waitcnt lgkmcnt(0)
s_cmp_lg_u32 s36, 4
s_cbranch_scc1 Lwm_99
s_branch Lst_11_1
Lwr_159:
s_branch Lwe_98
Lwm_99:
s_cmp_lg_u32 s36, 5
s_cbranch_scc1 Lwm_100
s_branch Lst_12_1
Lwr_160:
s_branch Lwe_98
Lwm_100:
s_cmp_lg_u32 s36, 6
s_cbranch_scc1 Lwm_101
s_branch Lst_13_1
Lwr_161:
s_branch Lwe_98
Lwm_101:
s_cmp_lg_u32 s36, 7
s_cbranch_scc1 Lwm_102
s_branch Lst_14_1
Lwr_162:
s_branch Lwe_98
Lwm_102:
Lwe_98:
s_waitcnt vmcnt(0) lgkmcnt(0)
s_barrier
ds_read_b128 v[32:35], v9 offset:0
ds_read_b64_tr_b16 v[48:49], v11 offset:0
ds_read_b64_tr_b16 v[50:51], v11 offset:3072
ds_read_b64_tr_b16 v[52:53], v12 offset:0
ds_read_b64_tr_b16 v[54:55], v12 offset:3072
ds_read_b64_tr_b16 v[56:57], v13 offset:0
ds_read_b64_tr_b16 v[58:59], v13 offset:3072
ds_read_b64_tr_b16 v[60:61], v11 offset:12288
ds_read_b64_tr_b16 v[62:63], v11 offset:15360
ds_read_b64_tr_b16 v[64:65], v12 offset:12288
ds_read_b64_tr_b16 v[66:67], v12 offset:15360
ds_read_b64_tr_b16 v[68:69], v13 offset:12288
ds_read_b64_tr_b16 v[70:71], v13 offset:15360
ds_read_b128 v[36:39], v9 offset:1024
ds_read_b128 v[40:43], v9 offset:2048
ds_read_b128 v[44:47], v9 offset:3072
s_waitcnt lgkmcnt(0)
v_mfma_f32_16x16x32_bf16 v[128:131], v[48:51], v[32:35], 0
ds_read_b128 v[72:75], v9 offset:8192
v_mfma_f32_16x16x32_bf16 v[152:155], v[48:51], v[36:39], 0
ds_read_b64_tr_b16 v[88:89], v11 offset:6144
v_mfma_f32_16x16x32_bf16 v[176:179], v[48:51], v[40:43], 0
ds_read_b64_tr_b16 v[90:91], v11 offset:9216
v_mfma_f32_16x16x32_bf16 v[200:203], v[48:51], v[44:47], 0
ds_read_b64_tr_b16 v[92:93], v12 offset:6144
v_mfma_f32_16x16x32_bf16 v[204:207], v[52:55], v[44:47], 0
ds_read_b64_tr_b16 v[94:95], v12 offset:9216
v_mfma_f32_16x16x32_bf16 v[180:183], v[52:55], v[40:43], 0
ds_read_b64_tr_b16 v[96:97], v13 offset:6144
v_mfma_f32_16x16x32_bf16 v[156:159], v[52:55], v[36:39], 0
ds_read_b64_tr_b16 v[98:99], v13 offset:9216
v_mfma_f32_16x16x32_bf16 v[132:135], v[52:55], v[32:35], 0
ds_read_b64_tr_b16 v[100:101], v11 offset:18432
v_mfma_f32_16x16x32_bf16 v[136:139], v[56:59], v[32:35], 0
ds_read_b64_tr_b16 v[102:103], v11 offset:21504
v_mfma_f32_16x16x32_bf16 v[160:163], v[56:59], v[36:39], 0
ds_read_b64_tr_b16 v[104:105], v12 offset:18432
v_mfma_f32_16x16x32_bf16 v[184:187], v[56:59], v[40:43], 0
ds_read_b64_tr_b16 v[106:107], v12 offset:21504
v_mfma_f32_16x16x32_bf16 v[208:211], v[56:59], v[44:47], 0
ds_read_b64_tr_b16 v[108:109], v13 offset:18432
v_mfma_f32_16x16x32_bf16 v[212:215], v[60:63], v[44:47], 0
ds_read_b64_tr_b16 v[110:111], v13 offset:21504
v_mfma_f32_16x16x32_bf16 v[188:191], v[60:63], v[40:43], 0
ds_read_b128 v[76:79], v9 offset:9216
v_mfma_f32_16x16x32_bf16 v[164:167], v[60:63], v[36:39], 0
ds_read_b128 v[80:83], v9 offset:10240
v_mfma_f32_16x16x32_bf16 v[140:143], v[60:63], v[32:35], 0
ds_read_b128 v[84:87], v9 offset:11264
v_mfma_f32_16x16x32_bf16 v[144:147], v[64:67], v[32:35], 0
v_mfma_f32_16x16x32_bf16 v[168:171], v[64:67], v[36:39], 0
v_mfma_f32_16x16x32_bf16 v[192:195], v[64:67], v[40:43], 0
v_mfma_f32_16x16x32_bf16 v[216:219], v[64:67], v[44:47], 0
v_mfma_f32_16x16x32_bf16 v[220:223], v[68:71], v[44:47], 0
v_mfma_f32_16x16x32_bf16 v[196:199], v[68:71], v[40:43], 0
v_mfma_f32_16x16x32_bf16 v[172:175], v[68:71], v[36:39], 0
v_mfma_f32_16x16x32_bf16 v[148:151], v[68:71], v[32:35], 0
s_waitcnt lgkmcnt(0)
s_barrier
v_mfma_f32_16x16x32_bf16 v[128:131], v[88:91], v[72:75], v[128:131]
ds_read_b128 v[32:35], v9 offset:49152
v_mfma_f32_16x16x32_bf16 v[152:155], v[88:91], v[76:79], v[152:155]
ds_read_b64_tr_b16 v[48:49], v14 offset:0
v_mfma_f32_16x16x32_bf16 v[176:179], v[88:91], v[80:83], v[176:179]
ds_read_b64_tr_b16 v[50:51], v14 offset:3072
v_mfma_f32_16x16x32_bf16 v[200:203], v[88:91], v[84:87], v[200:203]
ds_read_b64_tr_b16 v[52:53], v15 offset:0
v_mfma_f32_16x16x32_bf16 v[204:207], v[92:95], v[84:87], v[204:207]
ds_read_b64_tr_b16 v[54:55], v15 offset:3072
v_mfma_f32_16x16x32_bf16 v[180:183], v[92:95], v[80:83], v[180:183]
ds_read_b64_tr_b16 v[56:57], v16 offset:0
v_mfma_f32_16x16x32_bf16 v[156:159], v[92:95], v[76:79], v[156:159]
ds_read_b64_tr_b16 v[58:59], v16 offset:3072
v_mfma_f32_16x16x32_bf16 v[132:135], v[92:95], v[72:75], v[132:135]
ds_read_b64_tr_b16 v[60:61], v14 offset:12288
v_mfma_f32_16x16x32_bf16 v[136:139], v[96:99], v[72:75], v[136:139]
ds_read_b64_tr_b16 v[62:63], v14 offset:15360
v_mfma_f32_16x16x32_bf16 v[160:163], v[96:99], v[76:79], v[160:163]
ds_read_b64_tr_b16 v[64:65], v15 offset:12288
v_mfma_f32_16x16x32_bf16 v[184:187], v[96:99], v[80:83], v[184:187]
ds_read_b64_tr_b16 v[66:67], v15 offset:15360
v_mfma_f32_16x16x32_bf16 v[208:211], v[96:99], v[84:87], v[208:211]
ds_read_b64_tr_b16 v[68:69], v16 offset:12288
v_mfma_f32_16x16x32_bf16 v[212:215], v[100:103], v[84:87], v[212:215]
ds_read_b64_tr_b16 v[70:71], v16 offset:15360
v_mfma_f32_16x16x32_bf16 v[188:191], v[100:103], v[80:83], v[188:191]
ds_read_b128 v[36:39], v9 offset:50176
v_mfma_f32_16x16x32_bf16 v[164:167], v[100:103], v[76:79], v[164:167]
ds_read_b128 v[40:43], v9 offset:51200
v_mfma_f32_16x16x32_bf16 v[140:143], v[100:103], v[72:75], v[140:143]
ds_read_b128 v[44:47], v9 offset:52224
v_mfma_f32_16x16x32_bf16 v[144:147], v[104:107], v[72:75], v[144:147]
v_mfma_f32_16x16x32_bf16 v[168:171], v[104:107], v[76:79], v[168:171]
v_mfma_f32_16x16x32_bf16 v[192:195], v[104:107], v[80:83], v[192:195]
v_mfma_f32_16x16x32_bf16 v[216:219], v[104:107], v[84:87], v[216:219]
v_mfma_f32_16x16x32_bf16 v[220:223], v[108:111], v[84:87], v[220:223]
v_mfma_f32_16x16x32_bf16 v[196:199], v[108:111], v[80:83], v[196:199]
v_mfma_f32_16x16x32_bf16 v[172:175], v[108:111], v[76:79], v[172:175]
v_mfma_f32_16x16x32_bf16 v[148:151], v[108:111], v[72:75], v[148:151]
s_mov_b32 s41, 5
Lk3l_103:
s_waitcnt lgkmcnt(0)
v_mfma_f32_16x16x32_bf16 v[128:131], v[48:51], v[32:35], v[128:131]
ds_read_b128 v[72:75], v9 offset:57344
v_mfma_f32_16x16x32_bf16 v[152:155], v[48:51], v[36:39], v[152:155]
ds_read_b64_tr_b16 v[88:89], v14 offset:6144
v_mfma_f32_16x16x32_bf16 v[176:179], v[48:51], v[40:43], v[176:179]
ds_read_b64_tr_b16 v[90:91], v14 offset:9216
v_mfma_f32_16x16x32_bf16 v[200:203], v[48:51], v[44:47], v[200:203]
ds_read_b64_tr_b16 v[92:93], v15 offset:6144
v_mfma_f32_16x16x32_bf16 v[204:207], v[52:55], v[44:47], v[204:207]
ds_read_b64_tr_b16 v[94:95], v15 offset:9216
v_mfma_f32_16x16x32_bf16 v[180:183], v[52:55], v[40:43], v[180:183]
ds_read_b64_tr_b16 v[96:97], v16 offset:6144
v_mfma_f32_16x16x32_bf16 v[156:159], v[52:55], v[36:39], v[156:159]
ds_read_b64_tr_b16 v[98:99], v16 offset:9216
v_mfma_f32_16x16x32_bf16 v[132:135], v[52:55], v[32:35], v[132:135]
ds_read_b64_tr_b16 v[100:101], v14 offset:18432
v_mfma_f32_16x16x32_bf16 v[136:139], v[56:59], v[32:35], v[136:139]
ds_read_b64_tr_b16 v[102:103], v14 offset:21504
v_mfma_f32_16x16x32_bf16 v[160:163], v[56:59], v[36:39], v[160:163]
ds_read_b64_tr_b16 v[104:105], v15 offset:18432
v_mfma_f32_16x16x32_bf16 v[184:187], v[56:59], v[40:43], v[184:187]
ds_read_b64_tr_b16 v[106:107], v15 offset:21504
v_mfma_f32_16x16x32_bf16 v[208:211], v[56:59], v[44:47], v[208:211]
ds_read_b64_tr_b16 v[108:109], v16 offset:18432
v_mfma_f32_16x16x32_bf16 v[212:215], v[60:63], v[44:47], v[212:215]
ds_read_b64_tr_b16 v[110:111], v16 offset:21504
v_mfma_f32_16x16x32_bf16 v[188:191], v[60:63], v[40:43], v[188:191]
ds_read_b128 v[76:79], v9 offset:58368
v_mfma_f32_16x16x32_bf16 v[164:167], v[60:63], v[36:39], v[164:167]
ds_read_b128 v[80:83], v9 offset:59392
v_mfma_f32_16x16x32_bf16 v[140:143], v[60:63], v[32:35], v[140:143]
ds_read_b128 v[84:87], v9 offset:60416
v_mfma_f32_16x16x32_bf16 v[144:147], v[64:67], v[32:35], v[144:147]
v_mfma_f32_16x16x32_bf16 v[168:171], v[64:67], v[36:39], v[168:171]
v_mfma_f32_16x16x32_bf16 v[192:195], v[64:67], v[40:43], v[192:195]
v_mfma_f32_16x16x32_bf16 v[216:219], v[64:67], v[44:47], v[216:219]
v_mfma_f32_16x16x32_bf16 v[220:223], v[68:71], v[44:47], v[220:223]
v_mfma_f32_16x16x32_bf16 v[196:199], v[68:71], v[40:43], v[196:199]
v_mfma_f32_16x16x32_bf16 v[172:175], v[68:71], v[36:39], v[172:175]
v_mfma_f32_16x16x32_bf16 v[148:151], v[68:71], v[32:35], v[148:151]
s_waitcnt lgkmcnt(0)
s_barrier
v_mfma_f32_16x16x32_bf16 v[128:131], v[88:91], v[72:75], v[128:131]
ds_read_b128 v[32:35], v10 offset:0
v_mfma_f32_16x16x32_bf16 v[152:155], v[88:91], v[76:79], v[152:155]
ds_read_b64_tr_b16 v[48:49], v17 offset:0
v_mfma_f32_16x16x32_bf16 v[176:179], v[88:91], v[80:83], v[176:179]
ds_read_b64_tr_b16 v[50:51], v17 offset:3072
v_mfma_f32_16x16x32_bf16 v[200:203], v[88:91], v[84:87], v[200:203]
ds_read_b64_tr_b16 v[52:53], v18 offset:0
v_mfma_f32_16x16x32_bf16 v[204:207], v[92:95], v[84:87], v[204:207]
ds_read_b64_tr_b16 v[54:55], v18 offset:3072
v_mfma_f32_16x16x32_bf16 v[180:183], v[92:95], v[80:83], v[180:183]
ds_read_b64_tr_b16 v[56:57], v19 offset:0
v_mfma_f32_16x16x32_bf16 v[156:159], v[92:95], v[76:79], v[156:159]
ds_read_b64_tr_b16 v[58:59], v19 offset:3072
v_mfma_f32_16x16x32_bf16 v[132:135], v[92:95], v[72:75], v[132:135]
ds_read_b64_tr_b16 v[60:61], v17 offset:12288
v_mfma_f32_16x16x32_bf16 v[136:139], v[96:99], v[72:75], v[136:139]
ds_read_b64_tr_b16 v[62:63], v17 offset:15360
v_mfma_f32_16x16x32_bf16 v[160:163], v[96:99], v[76:79], v[160:163]
ds_read_b64_tr_b16 v[64:65], v18 offset:12288
v_mfma_f32_16x16x32_bf16 v[184:187], v[96:99], v[80:83], v[184:187]
ds_read_b64_tr_b16 v[66:67], v18 offset:15360
v_mfma_f32_16x16x32_bf16 v[208:211], v[96:99], v[84:87], v[208:211]
ds_read_b64_tr_b16 v[68:69], v19 offset:12288
v_mfma_f32_16x16x32_bf16 v[212:215], v[100:103], v[84:87], v[212:215]
ds_read_b64_tr_b16 v[70:71], v19 offset:15360
v_mfma_f32_16x16x32_bf16 v[188:191], v[100:103], v[80:83], v[188:191]
ds_read_b128 v[36:39], v10 offset:1024
v_mfma_f32_16x16x32_bf16 v[164:167], v[100:103], v[76:79], v[164:167]
ds_read_b128 v[40:43], v10 offset:2048
v_mfma_f32_16x16x32_bf16 v[140:143], v[100:103], v[72:75], v[140:143]
ds_read_b128 v[44:47], v10 offset:3072
v_mfma_f32_16x16x32_bf16 v[144:147], v[104:107], v[72:75], v[144:147]
v_mfma_f32_16x16x32_bf16 v[168:171], v[104:107], v[76:79], v[168:171]
v_mfma_f32_16x16x32_bf16 v[192:195], v[104:107], v[80:83], v[192:195]
v_mfma_f32_16x16x32_bf16 v[216:219], v[104:107], v[84:87], v[216:219]
v_mfma_f32_16x16x32_bf16 v[220:223], v[108:111], v[84:87], v[220:223]
v_mfma_f32_16x16x32_bf16 v[196:199], v[108:111], v[80:83], v[196:199]
v_mfma_f32_16x16x32_bf16 v[172:175], v[108:111], v[76:79], v[172:175]
v_mfma_f32_16x16x32_bf16 v[148:151], v[108:111], v[72:75], v[148:151]
s_waitcnt lgkmcnt(0)
v_mfma_f32_16x16x32_bf16 v[128:131], v[48:51], v[32:35], v[128:131]
ds_read_b128 v[72:75], v10 offset:8192
v_mfma_f32_16x16x32_bf16 v[152:155], v[48:51], v[36:39], v[152:155]
ds_read_b64_tr_b16 v[88:89], v17 offset:6144
v_mfma_f32_16x16x32_bf16 v[176:179], v[48:51], v[40:43], v[176:179]
ds_read_b64_tr_b16 v[90:91], v17 offset:9216
v_mfma_f32_16x16x32_bf16 v[200:203], v[48:51], v[44:47], v[200:203]
ds_read_b64_tr_b16 v[92:93], v18 offset:6144
v_mfma_f32_16x16x32_bf16 v[204:207], v[52:55], v[44:47], v[204:207]
ds_read_b64_tr_b16 v[94:95], v18 offset:9216
v_mfma_f32_16x16x32_bf16 v[180:183], v[52:55], v[40:43], v[180:183]
ds_read_b64_tr_b16 v[96:97], v19 offset:6144
v_mfma_f32_16x16x32_bf16 v[156:159], v[52:55], v[36:39], v[156:159]
ds_read_b64_tr_b16 v[98:99], v19 offset:9216
v_mfma_f32_16x16x32_bf16 v[132:135], v[52:55], v[32:35], v[132:135]
ds_read_b64_tr_b16 v[100:101], v17 offset:18432
v_mfma_f32_16x16x32_bf16 v[136:139], v[56:59], v[32:35], v[136:139]
ds_read_b64_tr_b16 v[102:103], v17 offset:21504
v_mfma_f32_16x16x32_bf16 v[160:163], v[56:59], v[36:39], v[160:163]
ds_read_b64_tr_b16 v[104:105], v18 offset:18432
v_mfma_f32_16x16x32_bf16 v[184:187], v[56:59], v[40:43], v[184:187]
ds_read_b64_tr_b16 v[106:107], v18 offset:21504
v_mfma_f32_16x16x32_bf16 v[208:211], v[56:59], v[44:47], v[208:211]
ds_read_b64_tr_b16 v[108:109], v19 offset:18432
v_mfma_f32_16x16x32_bf16 v[212:215], v[60:63], v[44:47], v[212:215]
ds_read_b64_tr_b16 v[110:111], v19 offset:21504
v_mfma_f32_16x16x32_bf16 v[188:191], v[60:63], v[40:43], v[188:191]
ds_read_b128 v[76:79], v10 offset:9216
v_mfma_f32_16x16x32_bf16 v[164:167], v[60:63], v[36:39], v[164:167]
ds_read_b128 v[80:83], v10 offset:10240
v_mfma_f32_16x16x32_bf16 v[140:143], v[60:63], v[32:35], v[140:143]
ds_read_b128 v[84:87], v10 offset:11264
v_mfma_f32_16x16x32_bf16 v[144:147], v[64:67], v[32:35], v[144:147]
v_mfma_f32_16x16x32_bf16 v[168:171], v[64:67], v[36:39], v[168:171]
v_mfma_f32_16x16x32_bf16 v[192:195], v[64:67], v[40:43], v[192:195]
v_mfma_f32_16x16x32_bf16 v[216:219], v[64:67], v[44:47], v[216:219]
v_mfma_f32_16x16x32_bf16 v[220:223], v[68:71], v[44:47], v[220:223]
v_mfma_f32_16x16x32_bf16 v[196:199], v[68:71], v[40:43], v[196:199]
v_mfma_f32_16x16x32_bf16 v[172:175], v[68:71], v[36:39], v[172:175]
v_mfma_f32_16x16x32_bf16 v[148:151], v[68:71], v[32:35], v[148:151]
s_waitcnt lgkmcnt(0)
s_barrier
v_mfma_f32_16x16x32_bf16 v[128:131], v[88:91], v[72:75], v[128:131]
ds_read_b128 v[32:35], v9 offset:0
v_mfma_f32_16x16x32_bf16 v[152:155], v[88:91], v[76:79], v[152:155]
ds_read_b64_tr_b16 v[48:49], v11 offset:0
v_mfma_f32_16x16x32_bf16 v[176:179], v[88:91], v[80:83], v[176:179]
ds_read_b64_tr_b16 v[50:51], v11 offset:3072
v_mfma_f32_16x16x32_bf16 v[200:203], v[88:91], v[84:87], v[200:203]
ds_read_b64_tr_b16 v[52:53], v12 offset:0
v_mfma_f32_16x16x32_bf16 v[204:207], v[92:95], v[84:87], v[204:207]
ds_read_b64_tr_b16 v[54:55], v12 offset:3072
v_mfma_f32_16x16x32_bf16 v[180:183], v[92:95], v[80:83], v[180:183]
ds_read_b64_tr_b16 v[56:57], v13 offset:0
v_mfma_f32_16x16x32_bf16 v[156:159], v[92:95], v[76:79], v[156:159]
ds_read_b64_tr_b16 v[58:59], v13 offset:3072
v_mfma_f32_16x16x32_bf16 v[132:135], v[92:95], v[72:75], v[132:135]
ds_read_b64_tr_b16 v[60:61], v11 offset:12288
v_mfma_f32_16x16x32_bf16 v[136:139], v[96:99], v[72:75], v[136:139]
ds_read_b64_tr_b16 v[62:63], v11 offset:15360
v_mfma_f32_16x16x32_bf16 v[160:163], v[96:99], v[76:79], v[160:163]
ds_read_b64_tr_b16 v[64:65], v12 offset:12288
v_mfma_f32_16x16x32_bf16 v[184:187], v[96:99], v[80:83], v[184:187]
ds_read_b64_tr_b16 v[66:67], v12 offset:15360
v_mfma_f32_16x16x32_bf16 v[208:211], v[96:99], v[84:87], v[208:211]
ds_read_b64_tr_b16 v[68:69], v13 offset:12288
v_mfma_f32_16x16x32_bf16 v[212:215], v[100:103], v[84:87], v[212:215]
ds_read_b64_tr_b16 v[70:71], v13 offset:15360
v_mfma_f32_16x16x32_bf16 v[188:191], v[100:103], v[80:83], v[188:191]
ds_read_b128 v[36:39], v9 offset:1024
v_mfma_f32_16x16x32_bf16 v[164:167], v[100:103], v[76:79], v[164:167]
ds_read_b128 v[40:43], v9 offset:2048
v_mfma_f32_16x16x32_bf16 v[140:143], v[100:103], v[72:75], v[140:143]
ds_read_b128 v[44:47], v9 offset:3072
v_mfma_f32_16x16x32_bf16 v[144:147], v[104:107], v[72:75], v[144:147]
v_mfma_f32_16x16x32_bf16 v[168:171], v[104:107], v[76:79], v[168:171]
v_mfma_f32_16x16x32_bf16 v[192:195], v[104:107], v[80:83], v[192:195]
v_mfma_f32_16x16x32_bf16 v[216:219], v[104:107], v[84:87], v[216:219]
v_mfma_f32_16x16x32_bf16 v[220:223], v[108:111], v[84:87], v[220:223]
v_mfma_f32_16x16x32_bf16 v[196:199], v[108:111], v[80:83], v[196:199]
v_mfma_f32_16x16x32_bf16 v[172:175], v[108:111], v[76:79], v[172:175]
v_mfma_f32_16x16x32_bf16 v[148:151], v[108:111], v[72:75], v[148:151]
s_waitcnt lgkmcnt(0)
v_mfma_f32_16x16x32_bf16 v[128:131], v[48:51], v[32:35], v[128:131]
ds_read_b128 v[72:75], v9 offset:8192
v_mfma_f32_16x16x32_bf16 v[152:155], v[48:51], v[36:39], v[152:155]
ds_read_b64_tr_b16 v[88:89], v11 offset:6144
v_mfma_f32_16x16x32_bf16 v[176:179], v[48:51], v[40:43], v[176:179]
ds_read_b64_tr_b16 v[90:91], v11 offset:9216
v_mfma_f32_16x16x32_bf16 v[200:203], v[48:51], v[44:47], v[200:203]
ds_read_b64_tr_b16 v[92:93], v12 offset:6144
v_mfma_f32_16x16x32_bf16 v[204:207], v[52:55], v[44:47], v[204:207]
ds_read_b64_tr_b16 v[94:95], v12 offset:9216
v_mfma_f32_16x16x32_bf16 v[180:183], v[52:55], v[40:43], v[180:183]
ds_read_b64_tr_b16 v[96:97], v13 offset:6144
v_mfma_f32_16x16x32_bf16 v[156:159], v[52:55], v[36:39], v[156:159]
ds_read_b64_tr_b16 v[98:99], v13 offset:9216
v_mfma_f32_16x16x32_bf16 v[132:135], v[52:55], v[32:35], v[132:135]
ds_read_b64_tr_b16 v[100:101], v11 offset:18432
v_mfma_f32_16x16x32_bf16 v[136:139], v[56:59], v[32:35], v[136:139]
ds_read_b64_tr_b16 v[102:103], v11 offset:21504
v_mfma_f32_16x16x32_bf16 v[160:163], v[56:59], v[36:39], v[160:163]
ds_read_b64_tr_b16 v[104:105], v12 offset:18432
v_mfma_f32_16x16x32_bf16 v[184:187], v[56:59], v[40:43], v[184:187]
ds_read_b64_tr_b16 v[106:107], v12 offset:21504
v_mfma_f32_16x16x32_bf16 v[208:211], v[56:59], v[44:47], v[208:211]
ds_read_b64_tr_b16 v[108:109], v13 offset:18432
v_mfma_f32_16x16x32_bf16 v[212:215], v[60:63], v[44:47], v[212:215]
ds_read_b64_tr_b16 v[110:111], v13 offset:21504
v_mfma_f32_16x16x32_bf16 v[188:191], v[60:63], v[40:43], v[188:191]
ds_read_b128 v[76:79], v9 offset:9216
v_mfma_f32_16x16x32_bf16 v[164:167], v[60:63], v[36:39], v[164:167]
ds_read_b128 v[80:83], v9 offset:10240
v_mfma_f32_16x16x32_bf16 v[140:143], v[60:63], v[32:35], v[140:143]
ds_read_b128 v[84:87], v9 offset:11264
v_mfma_f32_16x16x32_bf16 v[144:147], v[64:67], v[32:35], v[144:147]
v_mfma_f32_16x16x32_bf16 v[168:171], v[64:67], v[36:39], v[168:171]
v_mfma_f32_16x16x32_bf16 v[192:195], v[64:67], v[40:43], v[192:195]
v_mfma_f32_16x16x32_bf16 v[216:219], v[64:67], v[44:47], v[216:219]
v_mfma_f32_16x16x32_bf16 v[220:223], v[68:71], v[44:47], v[220:223]
v_mfma_f32_16x16x32_bf16 v[196:199], v[68:71], v[40:43], v[196:199]
v_mfma_f32_16x16x32_bf16 v[172:175], v[68:71], v[36:39], v[172:175]
v_mfma_f32_16x16x32_bf16 v[148:151], v[68:71], v[32:35], v[148:151]
s_waitcnt lgkmcnt(0)
s_barrier
v_mfma_f32_16x16x32_bf16 v[128:131], v[88:91], v[72:75], v[128:131]
ds_read_b128 v[32:35], v9 offset:49152
v_mfma_f32_16x16x32_bf16 v[152:155], v[88:91], v[76:79], v[152:155]
ds_read_b64_tr_b16 v[48:49], v14 offset:0
v_mfma_f32_16x16x32_bf16 v[176:179], v[88:91], v[80:83], v[176:179]
ds_read_b64_tr_b16 v[50:51], v14 offset:3072
v_mfma_f32_16x16x32_bf16 v[200:203], v[88:91], v[84:87], v[200:203]
ds_read_b64_tr_b16 v[52:53], v15 offset:0
v_mfma_f32_16x16x32_bf16 v[204:207], v[92:95], v[84:87], v[204:207]
ds_read_b64_tr_b16 v[54:55], v15 offset:3072
v_mfma_f32_16x16x32_bf16 v[180:183], v[92:95], v[80:83], v[180:183]
ds_read_b64_tr_b16 v[56:57], v16 offset:0
v_mfma_f32_16x16x32_bf16 v[156:159], v[92:95], v[76:79], v[156:159]
ds_read_b64_tr_b16 v[58:59], v16 offset:3072
v_mfma_f32_16x16x32_bf16 v[132:135], v[92:95], v[72:75], v[132:135]
ds_read_b64_tr_b16 v[60:61], v14 offset:12288
v_mfma_f32_16x16x32_bf16 v[136:139], v[96:99], v[72:75], v[136:139]
ds_read_b64_tr_b16 v[62:63], v14 offset:15360
v_mfma_f32_16x16x32_bf16 v[160:163], v[96:99], v[76:79], v[160:163]
ds_read_b64_tr_b16 v[64:65], v15 offset:12288
v_mfma_f32_16x16x32_bf16 v[184:187], v[96:99], v[80:83], v[184:187]
ds_read_b64_tr_b16 v[66:67], v15 offset:15360
v_mfma_f32_16x16x32_bf16 v[208:211], v[96:99], v[84:87], v[208:211]
ds_read_b64_tr_b16 v[68:69], v16 offset:12288
v_mfma_f32_16x16x32_bf16 v[212:215], v[100:103], v[84:87], v[212:215]
ds_read_b64_tr_b16 v[70:71], v16 offset:15360
v_mfma_f32_16x16x32_bf16 v[188:191], v[100:103], v[80:83], v[188:191]
ds_read_b128 v[36:39], v9 offset:50176
v_mfma_f32_16x16x32_bf16 v[164:167], v[100:103], v[76:79], v[164:167]
ds_read_b128 v[40:43], v9 offset:51200
v_mfma_f32_16x16x32_bf16 v[140:143], v[100:103], v[72:75], v[140:143]
ds_read_b128 v[44:47], v9 offset:52224
v_mfma_f32_16x16x32_bf16 v[144:147], v[104:107], v[72:75], v[144:147]
v_mfma_f32_16x16x32_bf16 v[168:171], v[104:107], v[76:79], v[168:171]
v_mfma_f32_16x16x32_bf16 v[192:195], v[104:107], v[80:83], v[192:195]
v_mfma_f32_16x16x32_bf16 v[216:219], v[104:107], v[84:87], v[216:219]
v_mfma_f32_16x16x32_bf16 v[220:223], v[108:111], v[84:87], v[220:223]
v_mfma_f32_16x16x32_bf16 v[196:199], v[108:111], v[80:83], v[196:199]
v_mfma_f32_16x16x32_bf16 v[172:175], v[108:111], v[76:79], v[172:175]
v_mfma_f32_16x16x32_bf16 v[148:151], v[108:111], v[72:75], v[148:151]
s_sub_u32 s41, s41, 1
s_cmp_lg_u32 s41, 0
s_cbranch_scc1 Lk3l_103
s_waitcnt lgkmcnt(0)
s_add_u32 s38, s35, 15
s_and_b32 s38, s38, 15
s_mul_i32 s38, s38, 458752
s_add_u32 m0, s40, 0
s_nop 0
buffer_load_dwordx4 v4, s[12:15], s38 offen lds
v_lshrrev_b32 v86, 4, v1
s_lshl_b32 s43, s63, 7
s_add_u32 s43, s43, 148992
v_lshl_add_u32 v87, v86, 4, s43
v_lshrrev_b32 v88, 1, v86
v_and_b32 v86, 1, v86
s_add_u32 m0, s40, 1024
s_nop 0
buffer_load_dwordx4 v5, s[12:15], s38 offen lds
s_lshl_b32 s43, s63, 5
s_add_u32 s43, s43, 149248
v_lshl_add_u32 v88, v88, 6, s43
v_lshl_add_u32 v88, v86, 4, v88
v_and_b32 v86, 15, v1
s_lshl_b32 s43, s62, 9
s_add_u32 m0, s40, 2048
s_add_u32 s38, s38, 57344
buffer_load_dwordx4 v4, s[12:15], s38 offen lds
s_add_u32 s43, s43, 147456
v_lshl_add_u32 v86, v86, 3, s43
ds_read_b128 v[32:35], v87 offset:0
ds_read_b128 v[36:39], v87 offset:64
ds_read_b128 v[40:43], v88 offset:0
ds_read_b128 v[44:47], v87 offset:896
s_add_u32 m0, s40, 3072
s_nop 0
buffer_load_dwordx4 v5, s[12:15], s38 offen lds
ds_read_b128 v[48:51], v87 offset:960
ds_read_b128 v[52:55], v88 offset:896
ds_read_b64 v[56:57], v86 offset:0
ds_read_b64 v[58:59], v86 offset:128
ds_read_b64 v[60:61], v86 offset:256
ds_read_b64 v[62:63], v86 offset:384
s_add_u32 m0, s40, 4096
s_branch Lov_8
.p2align 12
.fill 64, 4, 0xbf800000
Lst_8_0:
s_branch Lwr_148
Lst_8_1:
s_branch Lwr_155
s_nop 0
Lov_8:
s_add_u32 s38, s38, 57344
buffer_load_dwordx4 v4, s[12:15], s38 offen lds
s_mul_i32 s54, s35, 24576
s_lshl_b32 s43, s62, 12
s_add_u32 s54, s54, s43
s_add_u32 s54, s54, 524288
s_lshl_b32 s43, s63, 9
s_add_u32 s55, s54, s43
s_add_u32 m0, s40, 5120
s_nop 0
buffer_load_dwordx4 v5, s[12:15], s38 offen lds
s_add_u32 s55, s55, 16384
s_lshl_b32 s43, s63, 13
s_add_u32 s54, s54, s43
v_and_b32 v84, 32, v1
v_lshlrev_b32 v84, 4, v84
v_add_u32 v84, v84, v2
s_waitcnt lgkmcnt(0)
s_add_u32 m0, s40, 6144
s_add_u32 s38, s38, 57344
buffer_load_dwordx4 v4, s[12:15], s38 offen lds
s_add_u32 m0, s40, 7168
s_nop 0
buffer_load_dwordx4 v5, s[12:15], s38 offen lds
s_and_b32 s44, s36, 3
s_mul_i32 s43, s2, 28672
s_mul_i32 s44, s44, 7168
s_add_u32 s43, s43, s44
s_add_u32 s4, s76, s43
s_addc_u32 s5, s77, 0
s_barrier
s_cmp_eq_u32 s47, 3
s_cbranch_scc0 Lw_104
v_and_b32 v90, 31, v1
v_lshlrev_b32 v90, 4, v90
v_add_u32 v91, 153600, v90
ds_read_b128 v[108:111], v91 offset:0
ds_read_b128 v[112:115], v91 offset:512
ds_read_b128 v[116:119], v91 offset:1024
ds_read_b128 v[120:123], v91 offset:1536
s_and_b32 s44, s2, 15
s_mul_i32 s44, s44, 14336
s_lshr_b32 s43, s2, 4
s_lshl_b32 s43, s43, 9
s_add_u32 s44, s44, s43
s_waitcnt lgkmcnt(0)
v_add_f32 v108, v108, v112
v_add_f32 v116, v116, v120
v_add_f32 v109, v109, v113
v_add_f32 v117, v117, v121
v_add_f32 v110, v110, v114
v_add_f32 v118, v118, v122
v_add_f32 v111, v111, v115
v_add_f32 v119, v119, v123
v_add_f32 v108, v108, v116
v_add_f32 v109, v109, v117
v_add_f32 v110, v110, v118
v_add_f32 v111, v111, v119
s_mov_b64 exec, 0xffffffff
buffer_store_dwordx4 v[108:111], v90, s[84:87], s44 offen sc1
s_mov_b64 exec, -1
Lw_104:
s_waitcnt lgkmcnt(0)
s_add_u32 s37, s35, 0
s_and_b32 s37, s37, 15
s_mul_i32 s37, s37, 16384
s_add_u32 m0, s39, 49152
s_nop 0
buffer_load_dwordx4 v3, s[8:11], s37 offen sc1 lds
s_load_dword s3, s[4:5], 1792
s_load_dword s3, s[4:5], 1856
s_load_dword s3, s[4:5], 1920
s_load_dword s3, s[4:5], 1984
s_load_dword s3, s[4:5], 2048
s_load_dword s3, s[4:5], 2112
s_load_dword s3, s[4:5], 2176
buffer_load_dwordx4 v3, s[8:11], s37 offen offset:1024 sc1 lds
s_load_dword s3, s[4:5], 2240
s_load_dword s3, s[4:5], 2304
s_load_dword s3, s[4:5], 2368
s_load_dword s3, s[4:5], 2432
s_load_dword s3, s[4:5], 2496
s_load_dword s3, s[4:5], 2560
s_load_dword s3, s[4:5], 2624
buffer_load_dwordx4 v3, s[8:11], s37 offen offset:2048 sc1 lds
v_mul_f32 v66, v57, v57
v_mul_f32 v64, 0xc0135761, v57
v_mul_f32 v65, 0xbdd2d3e8, v57
v_mul_f32 v65, v65, v66
v_rcp_f32 v66, v66
v_mul_f32 v70, v59, v59
v_mul_f32 v68, 0xc0135761, v59
buffer_load_dwordx4 v3, s[8:11], s37 offen offset:3072 sc1 lds
v_mul_f32 v69, 0xbdd2d3e8, v59
v_mul_f32 v69, v69, v70
v_rcp_f32 v70, v70
v_fma_f32 v128, -v56, v32, v128
v_fma_f32 v129, -v56, v33, v129
v_fma_f32 v130, -v56, v34, v130
v_fma_f32 v131, -v56, v35, v131
v_fma_f32 v152, -v58, v32, v152
s_add_u32 s38, s35, 0
s_and_b32 s38, s38, 15
s_mul_i32 s38, s38, 458752
s_add_u32 m0, s40, 49152
s_nop 0
buffer_load_dwordx4 v4, s[12:15], s38 offen lds
v_fma_f32 v153, -v58, v33, v153
v_fma_f32 v154, -v58, v34, v154
v_fma_f32 v155, -v58, v35, v155
v_mul_f32 v72, v128, v128
v_mul_f32 v73, v129, v129
v_mul_f32 v74, v130, v130
v_mul_f32 v75, v131, v131
s_add_u32 m0, s40, 50176
s_nop 0
buffer_load_dwordx4 v5, s[12:15], s38 offen lds
v_mul_f32 v76, v152, v152
v_mul_f32 v77, v153, v153
v_mul_f32 v78, v154, v154
v_mul_f32 v79, v155, v155
v_fma_f32 v72, v72, v65, v64
v_fma_f32 v73, v73, v65, v64
v_fma_f32 v74, v74, v65, v64
s_add_u32 m0, s40, 51200
s_add_u32 s38, s38, 57344
buffer_load_dwordx4 v4, s[12:15], s38 offen lds
v_fma_f32 v75, v75, v65, v64
v_fma_f32 v76, v76, v69, v68
v_fma_f32 v77, v77, v69, v68
v_fma_f32 v78, v78, v69, v68
v_fma_f32 v79, v79, v69, v68
v_mul_f32 v72, v72, v128
v_mul_f32 v73, v73, v129
v_mul_f32 v74, v74, v130
s_add_u32 m0, s40, 52224
s_nop 0
buffer_load_dwordx4 v5, s[12:15], s38 offen lds
v_mul_f32 v75, v75, v131
v_mul_f32 v76, v76, v152
v_mul_f32 v77, v77, v153
v_mul_f32 v78, v78, v154
v_mul_f32 v79, v79, v155
v_exp_f32 v72, v72
v_exp_f32 v73, v73
s_add_u32 m0, s40, 53248
s_add_u32 s38, s38, 57344
buffer_load_dwordx4 v4, s[12:15], s38 offen lds
v_exp_f32 v74, v74
v_exp_f32 v75, v75
v_exp_f32 v76, v76
v_exp_f32 v77, v77
v_exp_f32 v78, v78
v_exp_f32 v79, v79
v_fma_f32 v140, -v56, v44, v140
s_add_u32 m0, s40, 54272
s_nop 0
buffer_load_dwordx4 v5, s[12:15], s38 offen lds
v_fma_f32 v141, -v56, v45, v141
v_fma_f32 v142, -v56, v46, v142
v_fma_f32 v143, -v56, v47, v143
v_fma_f32 v164, -v58, v44, v164
v_fma_f32 v165, -v58, v45, v165
v_fma_f32 v166, -v58, v46, v166
v_fma_f32 v167, -v58, v47, v167
v_fma_f32 v72, v72, v66, v66
s_add_u32 m0, s40, 55296
s_add_u32 s38, s38, 57344
buffer_load_dwordx4 v4, s[12:15], s38 offen lds
s_add_u32 m0, s40, 56320
s_nop 0
buffer_load_dwordx4 v5, s[12:15], s38 offen lds
s_waitcnt vmcnt(12)
s_barrier
s_add_u32 s37, s35, 1
s_and_b32 s37, s37, 15
s_mul_i32 s37, s37, 16384
s_add_u32 m0, s39, 98304
s_nop 0
buffer_load_dwordx4 v3, s[8:11], s37 offen sc1 lds
v_fma_f32 v73, v73, v66, v66
v_fma_f32 v74, v74, v66, v66
v_fma_f32 v75, v75, v66, v66
v_fma_f32 v76, v76, v70, v70
v_fma_f32 v77, v77, v70, v70
v_fma_f32 v78, v78, v70, v70
buffer_load_dwordx4 v3, s[8:11], s37 offen offset:1024 sc1 lds
v_fma_f32 v79, v79, v70, v70
v_rcp_f32 v72, v72
v_rcp_f32 v73, v73
v_rcp_f32 v74, v74
v_rcp_f32 v75, v75
v_rcp_f32 v76, v76
buffer_load_dwordx4 v3, s[8:11], s37 offen offset:2048 sc1 lds
v_rcp_f32 v77, v77
v_rcp_f32 v78, v78
v_rcp_f32 v79, v79
v_mul_f32 v140, v128, v140
v_mul_f32 v141, v129, v141
v_mul_f32 v142, v130, v142
buffer_load_dwordx4 v3, s[8:11], s37 offen offset:3072 sc1 lds
v_mul_f32 v143, v131, v143
v_mul_f32 v164, v152, v164
v_mul_f32 v165, v153, v165
v_mul_f32 v166, v154, v166
v_mul_f32 v167, v155, v167
v_mul_f32 v140, v140, v72
s_add_u32 s38, s35, 1
s_and_b32 s38, s38, 15
s_mul_i32 s38, s38, 458752
s_add_u32 m0, s40, 98304
s_nop 0
buffer_load_dwordx4 v4, s[12:15], s38 offen lds
v_mul_f32 v141, v141, v73
v_mul_f32 v142, v142, v74
v_mul_f32 v143, v143, v75
v_mul_f32 v164, v164, v76
v_mul_f32 v165, v165, v77
v_mul_f32 v166, v166, v78
s_add_u32 m0, s40, 99328
s_nop 0
buffer_load_dwordx4 v5, s[12:15], s38 offen lds
v_mul_f32 v167, v167, v79
v_cvt_pk_bf16_f32 v128, v140, v141
v_cvt_pk_bf16_f32 v129, v142, v143
v_cvt_pk_bf16_f32 v152, v164, v165
v_cvt_pk_bf16_f32 v153, v166, v167
v_fma_f32 v132, -v56, v36, v132
s_add_u32 m0, s40, 100352
s_add_u32 s38, s38, 57344
buffer_load_dwordx4 v4, s[12:15], s38 offen lds
v_fma_f32 v133, -v56, v37, v133
v_fma_f32 v134, -v56, v38, v134
v_fma_f32 v135, -v56, v39, v135
v_fma_f32 v156, -v58, v36, v156
v_fma_f32 v157, -v58, v37, v157
v_fma_f32 v158, -v58, v38, v158
s_add_u32 m0, s40, 101376
s_nop 0
buffer_load_dwordx4 v5, s[12:15], s38 offen lds
v_fma_f32 v159, -v58, v39, v159
v_mul_f32 v72, v132, v132
v_mul_f32 v73, v133, v133
v_mul_f32 v74, v134, v134
v_mul_f32 v75, v135, v135
v_mul_f32 v76, v156, v156
s_add_u32 m0, s40, 102400
s_add_u32 s38, s38, 57344
buffer_load_dwordx4 v4, s[12:15], s38 offen lds
v_mul_f32 v77, v157, v157
v_mul_f32 v78, v158, v158
v_mul_f32 v79, v159, v159
v_fma_f32 v72, v72, v65, v64
v_fma_f32 v73, v73, v65, v64
v_fma_f32 v74, v74, v65, v64
s_add_u32 m0, s40, 103424
s_nop 0
buffer_load_dwordx4 v5, s[12:15], s38 offen lds
v_fma_f32 v75, v75, v65, v64
v_fma_f32 v76, v76, v69, v68
v_fma_f32 v77, v77, v69, v68
v_fma_f32 v78, v78, v69, v68
v_fma_f32 v79, v79, v69, v68
v_mul_f32 v72, v72, v132
s_add_u32 m0, s40, 104448
s_add_u32 s38, s38, 57344
buffer_load_dwordx4 v4, s[12:15], s38 offen lds
s_add_u32 m0, s40, 105472
s_nop 0
buffer_load_dwordx4 v5, s[12:15], s38 offen lds
s_waitcnt vmcnt(12)
s_barrier
s_cmp_eq_u32 s47, 3
s_cbranch_scc0 Lw_105
s_lshr_b32 s43, s2, 4
s_add_u32 s43, s43, 80
s_lshl_b32 s43, s43, 7
v_mov_b32 v90, s43
v_mov_b32 v91, 1
s_mov_b64 exec, 1
buffer_atomic_add v91, v90, s[56:59], 0 offen sc1
s_mov_b64 exec, -1
Lw_105:
s_waitcnt lgkmcnt(0)
s_add_u32 s37, s35, 2
s_and_b32 s37, s37, 15
s_mul_i32 s37, s37, 16384
s_add_u32 m0, s39, 0
s_nop 0
buffer_load_dwordx4 v3, s[8:11], s37 offen sc1 lds
s_load_dword s3, s[4:5], 2688
s_load_dword s3, s[4:5], 2752
s_load_dword s3, s[4:5], 2816
s_load_dword s3, s[4:5], 2880
s_load_dword s3, s[4:5], 2944
s_load_dword s3, s[4:5], 3008
s_load_dword s3, s[4:5], 3072
buffer_load_dwordx4 v3, s[8:11], s37 offen offset:1024 sc1 lds
s_load_dword s3, s[4:5], 3136
s_load_dword s3, s[4:5], 3200
s_load_dword s3, s[4:5], 3264
s_load_dword s3, s[4:5], 3328
s_load_dword s3, s[4:5], 3392
s_load_dword s3, s[4:5], 3456
s_load_dword s3, s[4:5], 3520
buffer_load_dwordx4 v3, s[8:11], s37 offen offset:2048 sc1 lds
v_mul_f32 v73, v73, v133
v_mul_f32 v74, v74, v134
v_mul_f32 v75, v75, v135
v_mul_f32 v76, v76, v156
v_mul_f32 v77, v77, v157
v_mul_f32 v78, v78, v158
v_mul_f32 v79, v79, v159
v_exp_f32 v72, v72
buffer_load_dwordx4 v3, s[8:11], s37 offen offset:3072 sc1 lds
v_exp_f32 v73, v73
v_exp_f32 v74, v74
v_exp_f32 v75, v75
v_exp_f32 v76, v76
v_exp_f32 v77, v77
v_exp_f32 v78, v78
v_exp_f32 v79, v79
s_add_u32 s38, s35, 2
s_and_b32 s38, s38, 15
s_mul_i32 s38, s38, 458752
s_add_u32 m0, s40, 0
s_nop 0
buffer_load_dwordx4 v4, s[12:15], s38 offen lds
v_fma_f32 v144, -v56, v48, v144
v_fma_f32 v145, -v56, v49, v145
v_fma_f32 v146, -v56, v50, v146
v_fma_f32 v147, -v56, v51, v147
v_fma_f32 v168, -v58, v48, v168
v_fma_f32 v169, -v58, v49, v169
v_fma_f32 v170, -v58, v50, v170
v_fma_f32 v171, -v58, v51, v171
s_add_u32 m0, s40, 1024
s_nop 0
buffer_load_dwordx4 v5, s[12:15], s38 offen lds
v_fma_f32 v72, v72, v66, v66
v_fma_f32 v73, v73, v66, v66
v_fma_f32 v74, v74, v66, v66
v_fma_f32 v75, v75, v66, v66
v_fma_f32 v76, v76, v70, v70
v_fma_f32 v77, v77, v70, v70
v_fma_f32 v78, v78, v70, v70
s_add_u32 m0, s40, 2048
s_add_u32 s38, s38, 57344
buffer_load_dwordx4 v4, s[12:15], s38 offen lds
v_fma_f32 v79, v79, v70, v70
v_rcp_f32 v72, v72
v_rcp_f32 v73, v73
v_rcp_f32 v74, v74
v_rcp_f32 v75, v75
v_rcp_f32 v76, v76
v_rcp_f32 v77, v77
s_add_u32 m0, s40, 3072
s_nop 0
buffer_load_dwordx4 v5, s[12:15], s38 offen lds
v_rcp_f32 v78, v78
v_rcp_f32 v79, v79
v_mul_f32 v144, v132, v144
v_mul_f32 v145, v133, v145
v_mul_f32 v146, v134, v146
v_mul_f32 v147, v135, v147
v_mul_f32 v168, v156, v168
v_mul_f32 v169, v157, v169
s_add_u32 m0, s40, 4096
s_add_u32 s38, s38, 57344
buffer_load_dwordx4 v4, s[12:15], s38 offen lds
v_mul_f32 v170, v158, v170
v_mul_f32 v171, v159, v171
v_mul_f32 v144, v144, v72
v_mul_f32 v145, v145, v73
v_mul_f32 v146, v146, v74
v_mul_f32 v147, v147, v75
v_mul_f32 v168, v168, v76
s_add_u32 m0, s40, 5120
s_nop 0
buffer_load_dwordx4 v5, s[12:15], s38 offen lds
v_mul_f32 v169, v169, v77
v_mul_f32 v170, v170, v78
v_mul_f32 v171, v171, v79
v_cvt_pk_bf16_f32 v130, v144, v145
v_cvt_pk_bf16_f32 v131, v146, v147
v_cvt_pk_bf16_f32 v154, v168, v169
v_cvt_pk_bf16_f32 v155, v170, v171
buffer_store_dwordx4 v[128:131], v2, s[24:27], s54 offen offset:0 sc1
s_add_u32 m0, s40, 6144
s_add_u32 s38, s38, 57344
buffer_load_dwordx4 v4, s[12:15], s38 offen lds
s_add_u32 m0, s40, 7168
s_nop 0
buffer_load_dwordx4 v5, s[12:15], s38 offen lds
s_waitcnt vmcnt(13)
s_barrier
s_add_u32 s37, s35, 3
s_and_b32 s37, s37, 15
s_mul_i32 s37, s37, 16384
s_add_u32 m0, s39, 49152
s_nop 0
buffer_load_dwordx4 v3, s[8:11], s37 offen sc1 lds
buffer_store_dwordx4 v[152:155], v2, s[24:27], s54 offen offset:1024 sc1
v_fma_f32 v136, -v56, v40, v136
v_fma_f32 v137, -v56, v41, v137
v_fma_f32 v138, -v56, v42, v138
v_fma_f32 v139, -v56, v43, v139
v_fma_f32 v160, -v58, v40, v160
buffer_load_dwordx4 v3, s[8:11], s37 offen offset:1024 sc1 lds
v_fma_f32 v161, -v58, v41, v161
v_fma_f32 v162, -v58, v42, v162
v_fma_f32 v163, -v58, v43, v163
v_mul_f32 v72, v136, v136
v_mul_f32 v73, v137, v137
v_mul_f32 v74, v138, v138
buffer_load_dwordx4 v3, s[8:11], s37 offen offset:2048 sc1 lds
v_mul_f32 v75, v139, v139
v_mul_f32 v76, v160, v160
v_mul_f32 v77, v161, v161
v_mul_f32 v78, v162, v162
v_mul_f32 v79, v163, v163
v_fma_f32 v72, v72, v65, v64
buffer_load_dwordx4 v3, s[8:11], s37 offen offset:3072 sc1 lds
v_fma_f32 v73, v73, v65, v64
v_fma_f32 v74, v74, v65, v64
v_fma_f32 v75, v75, v65, v64
v_fma_f32 v76, v76, v69, v68
v_fma_f32 v77, v77, v69, v68
v_fma_f32 v78, v78, v69, v68
s_add_u32 s38, s35, 3
s_and_b32 s38, s38, 15
s_mul_i32 s38, s38, 458752
s_add_u32 m0, s40, 49152
s_nop 0
buffer_load_dwordx4 v4, s[12:15], s38 offen lds
v_fma_f32 v79, v79, v69, v68
v_mul_f32 v72, v72, v136
v_mul_f32 v73, v73, v137
v_mul_f32 v74, v74, v138
v_mul_f32 v75, v75, v139
v_mul_f32 v76, v76, v160
s_add_u32 m0, s40, 50176
s_nop 0
buffer_load_dwordx4 v5, s[12:15], s38 offen lds
v_mul_f32 v77, v77, v161
v_mul_f32 v78, v78, v162
v_mul_f32 v79, v79, v163
v_exp_f32 v72, v72
v_exp_f32 v73, v73
v_exp_f32 v74, v74
s_add_u32 m0, s40, 51200
s_add_u32 s38, s38, 57344
buffer_load_dwordx4 v4, s[12:15], s38 offen lds
v_exp_f32 v75, v75
v_exp_f32 v76, v76
v_exp_f32 v77, v77
v_exp_f32 v78, v78
v_exp_f32 v79, v79
v_fma_f32 v148, -v56, v52, v148
s_add_u32 m0, s40, 52224
s_nop 0
buffer_load_dwordx4 v5, s[12:15], s38 offen lds
v_fma_f32 v149, -v56, v53, v149
v_fma_f32 v150, -v56, v54, v150
v_fma_f32 v151, -v56, v55, v151
v_fma_f32 v172, -v58, v52, v172
v_fma_f32 v173, -v58, v53, v173
v_fma_f32 v174, -v58, v54, v174
s_add_u32 m0, s40, 53248
s_add_u32 s38, s38, 57344
buffer_load_dwordx4 v4, s[12:15], s38 offen lds
v_fma_f32 v175, -v58, v55, v175
v_fma_f32 v72, v72, v66, v66
v_fma_f32 v73, v73, v66, v66
v_fma_f32 v74, v74, v66, v66
v_fma_f32 v75, v75, v66, v66
v_fma_f32 v76, v76, v70, v70
s_add_u32 m0, s40, 54272
s_nop 0
buffer_load_dwordx4 v5, s[12:15], s38 offen lds
v_fma_f32 v77, v77, v70, v70
v_fma_f32 v78, v78, v70, v70
v_fma_f32 v79, v79, v70, v70
v_rcp_f32 v72, v72
v_rcp_f32 v73, v73
v_rcp_f32 v74, v74
s_add_u32 m0, s40, 55296
s_add_u32 s38, s38, 57344
buffer_load_dwordx4 v4, s[12:15], s38 offen lds
s_add_u32 m0, s40, 56320
s_nop 0
buffer_load_dwordx4 v5, s[12:15], s38 offen lds
s_waitcnt vmcnt(13)
s_barrier
s_waitcnt lgkmcnt(0)
s_add_u32 s37, s35, 4
s_and_b32 s37, s37, 15
s_mul_i32 s37, s37, 16384
s_add_u32 m0, s39, 98304
s_nop 0
buffer_load_dwordx4 v3, s[8:11], s37 offen sc1 lds
s_load_dword s3, s[4:5], 3584
s_load_dword s3, s[4:5], 3648
s_load_dword s3, s[4:5], 3712
s_load_dword s3, s[4:5], 3776
s_load_dword s3, s[4:5], 3840
s_load_dword s3, s[4:5], 3904
s_load_dword s3, s[4:5], 3968
buffer_load_dwordx4 v3, s[8:11], s37 offen offset:1024 sc1 lds
s_load_dword s3, s[4:5], 4032
s_load_dword s3, s[4:5], 4096
s_load_dword s3, s[4:5], 4160
s_load_dword s3, s[4:5], 4224
s_load_dword s3, s[4:5], 4288
s_load_dword s3, s[4:5], 4352
s_load_dword s3, s[4:5], 4416
buffer_load_dwordx4 v3, s[8:11], s37 offen offset:2048 sc1 lds
v_rcp_f32 v75, v75
v_rcp_f32 v76, v76
v_rcp_f32 v77, v77
v_rcp_f32 v78, v78
v_rcp_f32 v79, v79
v_mul_f32 v148, v136, v148
v_mul_f32 v149, v137, v149
buffer_load_dwordx4 v3, s[8:11], s37 offen offset:3072 sc1 lds
v_mul_f32 v150, v138, v150
v_mul_f32 v151, v139, v151
v_mul_f32 v172, v160, v172
v_mul_f32 v173, v161, v173
v_mul_f32 v174, v162, v174
v_mul_f32 v175, v163, v175
v_mul_f32 v148, v148, v72
v_mul_f32 v149, v149, v73
s_add_u32 s38, s35, 4
s_and_b32 s38, s38, 15
s_mul_i32 s38, s38, 458752
s_add_u32 m0, s40, 98304
s_nop 0
buffer_load_dwordx4 v4, s[12:15], s38 offen lds
v_mul_f32 v150, v150, v74
v_mul_f32 v151, v151, v75
v_mul_f32 v172, v172, v76
v_mul_f32 v173, v173, v77
v_mul_f32 v174, v174, v78
v_mul_f32 v175, v175, v79
v_cvt_pk_bf16_f32 v80, v148, v149
s_add_u32 m0, s40, 99328
s_nop 0
buffer_load_dwordx4 v5, s[12:15], s38 offen lds
v_cvt_pk_bf16_f32 v81, v150, v151
v_cvt_pk_bf16_f32 v82, v172, v173
v_cvt_pk_bf16_f32 v83, v174, v175
s_nop 1
v_permlane32_swap_b32 v80, v82
v_permlane32_swap_b32 v81, v83
buffer_store_dwordx4 v[80:83], v84, s[24:27], s55 offen offset:0 sc1
s_add_u32 m0, s40, 100352
s_add_u32 s38, s38, 57344
buffer_load_dwordx4 v4, s[12:15], s38 offen lds
s_nop 1
v_mul_f32 v66, v61, v61
v_mul_f32 v64, 0xc0135761, v61
v_mul_f32 v65, 0xbdd2d3e8, v61
v_mul_f32 v65, v65, v66
v_rcp_f32 v66, v66
v_mul_f32 v70, v63, v63
v_mul_f32 v68, 0xc0135761, v63
s_add_u32 m0, s40, 101376
s_nop 0
buffer_load_dwordx4 v5, s[12:15], s38 offen lds
v_mul_f32 v69, 0xbdd2d3e8, v63
v_mul_f32 v69, v69, v70
v_rcp_f32 v70, v70
v_fma_f32 v176, -v60, v32, v176
v_fma_f32 v177, -v60, v33, v177
v_fma_f32 v178, -v60, v34, v178
v_fma_f32 v179, -v60, v35, v179
s_add_u32 m0, s40, 102400
s_add_u32 s38, s38, 57344
buffer_load_dwordx4 v4, s[12:15], s38 offen lds
v_fma_f32 v200, -v62, v32, v200
v_fma_f32 v201, -v62, v33, v201
v_fma_f32 v202, -v62, v34, v202
v_fma_f32 v203, -v62, v35, v203
v_mul_f32 v72, v176, v176
v_mul_f32 v73, v177, v177
v_mul_f32 v74, v178, v178
s_add_u32 m0, s40, 103424
s_nop 0
buffer_load_dwordx4 v5, s[12:15], s38 offen lds
v_mul_f32 v75, v179, v179
v_mul_f32 v76, v200, v200
v_mul_f32 v77, v201, v201
v_mul_f32 v78, v202, v202
v_mul_f32 v79, v203, v203
v_fma_f32 v72, v72, v65, v64
v_fma_f32 v73, v73, v65, v64
v_fma_f32 v74, v74, v65, v64
s_add_u32 m0, s40, 104448
s_add_u32 s38, s38, 57344
buffer_load_dwordx4 v4, s[12:15], s38 offen lds
s_add_u32 m0, s40, 105472
s_nop 0
buffer_load_dwordx4 v5, s[12:15], s38 offen lds
s_waitcnt vmcnt(13)
s_barrier
s_add_u32 s37, s35, 5
s_and_b32 s37, s37, 15
s_mul_i32 s37, s37, 16384
s_add_u32 m0, s39, 0
s_nop 0
buffer_load_dwordx4 v3, s[8:11], s37 offen sc1 lds
v_fma_f32 v75, v75, v65, v64
v_fma_f32 v76, v76, v69, v68
v_fma_f32 v77, v77, v69, v68
v_fma_f32 v78, v78, v69, v68
v_fma_f32 v79, v79, v69, v68
v_mul_f32 v72, v72, v176
buffer_load_dwordx4 v3, s[8:11], s37 offen offset:1024 sc1 lds
v_mul_f32 v73, v73, v177
v_mul_f32 v74, v74, v178
v_mul_f32 v75, v75, v179
v_mul_f32 v76, v76, v200
v_mul_f32 v77, v77, v201
v_mul_f32 v78, v78, v202
s_branch Lov_9
.p2align 12
.fill 64, 4, 0xbf800000
Lst_9_0:
s_branch Lwr_149
Lst_9_1:
s_branch Lwr_156
s_nop 0
Lov_9:
buffer_load_dwordx4 v3, s[8:11], s37 offen offset:2048 sc1 lds
v_mul_f32 v79, v79, v203
v_exp_f32 v72, v72
v_exp_f32 v73, v73
v_exp_f32 v74, v74
v_exp_f32 v75, v75
v_exp_f32 v76, v76
buffer_load_dwordx4 v3, s[8:11], s37 offen offset:3072 sc1 lds
v_exp_f32 v77, v77
v_exp_f32 v78, v78
v_exp_f32 v79, v79
v_fma_f32 v188, -v60, v44, v188
v_fma_f32 v189, -v60, v45, v189
v_fma_f32 v190, -v60, v46, v190
s_add_u32 s38, s35, 5
s_and_b32 s38, s38, 15
s_mul_i32 s38, s38, 458752
s_add_u32 m0, s40, 0
s_nop 0
buffer_load_dwordx4 v4, s[12:15], s38 offen lds
v_fma_f32 v191, -v60, v47, v191
v_fma_f32 v212, -v62, v44, v212
v_fma_f32 v213, -v62, v45, v213
v_fma_f32 v214, -v62, v46, v214
v_fma_f32 v215, -v62, v47, v215
v_fma_f32 v72, v72, v66, v66
s_add_u32 m0, s40, 1024
s_nop 0
buffer_load_dwordx4 v5, s[12:15], s38 offen lds
v_fma_f32 v73, v73, v66, v66
v_fma_f32 v74, v74, v66, v66
v_fma_f32 v75, v75, v66, v66
v_fma_f32 v76, v76, v70, v70
v_fma_f32 v77, v77, v70, v70
v_fma_f32 v78, v78, v70, v70
s_add_u32 m0, s40, 2048
s_add_u32 s38, s38, 57344
buffer_load_dwordx4 v4, s[12:15], s38 offen lds
v_fma_f32 v79, v79, v70, v70
v_rcp_f32 v72, v72
v_rcp_f32 v73, v73
v_rcp_f32 v74, v74
v_rcp_f32 v75, v75
v_rcp_f32 v76, v76
s_add_u32 m0, s40, 3072
s_nop 0
buffer_load_dwordx4 v5, s[12:15], s38 offen lds
v_rcp_f32 v77, v77
v_rcp_f32 v78, v78
v_rcp_f32 v79, v79
v_mul_f32 v188, v176, v188
v_mul_f32 v189, v177, v189
v_mul_f32 v190, v178, v190
s_add_u32 m0, s40, 4096
s_add_u32 s38, s38, 57344
buffer_load_dwordx4 v4, s[12:15], s38 offen lds
v_mul_f32 v191, v179, v191
v_mul_f32 v212, v200, v212
v_mul_f32 v213, v201, v213
v_mul_f32 v214, v202, v214
v_mul_f32 v215, v203, v215
v_mul_f32 v188, v188, v72
s_add_u32 m0, s40, 5120
s_nop 0
buffer_load_dwordx4 v5, s[12:15], s38 offen lds
v_mul_f32 v189, v189, v73
v_mul_f32 v190, v190, v74
v_mul_f32 v191, v191, v75
v_mul_f32 v212, v212, v76
v_mul_f32 v213, v213, v77
v_mul_f32 v214, v214, v78
s_add_u32 m0, s40, 6144
s_add_u32 s38, s38, 57344
buffer_load_dwordx4 v4, s[12:15], s38 offen lds
s_add_u32 m0, s40, 7168
s_nop 0
buffer_load_dwordx4 v5, s[12:15], s38 offen lds
s_waitcnt vmcnt(12)
s_barrier
s_waitcnt lgkmcnt(0)
s_cmp_eq_u32 s47, 3
s_cbranch_scc0 Lw_106
s_lshl_b32 s60, s35, 7
s_add_u32 s60, s60, 28321792
s_mov_b32 s61, s60
s_load_dword s92, s[82:83], s60 glc
s_load_dword s93, s[82:83], s61 glc
Lw_106:
s_add_u32 s37, s35, 6
s_and_b32 s37, s37, 15
s_mul_i32 s37, s37, 16384
s_add_u32 m0, s39, 49152
s_nop 0
buffer_load_dwordx4 v3, s[8:11], s37 offen sc1 lds
s_load_dword s3, s[4:5], 4480
s_load_dword s3, s[4:5], 4544
s_load_dword s3, s[4:5], 4608
s_load_dword s3, s[4:5], 4672
s_load_dword s3, s[4:5], 4736
s_load_dword s3, s[4:5], 4800
s_load_dword s3, s[4:5], 4864
buffer_load_dwordx4 v3, s[8:11], s37 offen offset:1024 sc1 lds
s_load_dword s3, s[4:5], 4928
s_load_dword s3, s[4:5], 4992
s_load_dword s3, s[4:5], 5056
s_load_dword s3, s[4:5], 5120
s_load_dword s3, s[4:5], 5184
s_load_dword s3, s[4:5], 5248
s_load_dword s3, s[4:5], 5312
buffer_load_dwordx4 v3, s[8:11], s37 offen offset:2048 sc1 lds
v_mul_f32 v215, v215, v79
v_cvt_pk_bf16_f32 v176, v188, v189
v_cvt_pk_bf16_f32 v177, v190, v191
v_cvt_pk_bf16_f32 v200, v212, v213
v_cvt_pk_bf16_f32 v201, v214, v215
v_fma_f32 v180, -v60, v36, v180
v_fma_f32 v181, -v60, v37, v181
v_fma_f32 v182, -v60, v38, v182
buffer_load_dwordx4 v3, s[8:11], s37 offen offset:3072 sc1 lds
v_fma_f32 v183, -v60, v39, v183
v_fma_f32 v204, -v62, v36, v204
v_fma_f32 v205, -v62, v37, v205
v_fma_f32 v206, -v62, v38, v206
v_fma_f32 v207, -v62, v39, v207
v_mul_f32 v72, v180, v180
v_mul_f32 v73, v181, v181
s_add_u32 s38, s35, 6
s_and_b32 s38, s38, 15
s_mul_i32 s38, s38, 458752
s_add_u32 m0, s40, 49152
s_nop 0
buffer_load_dwordx4 v4, s[12:15], s38 offen lds
v_mul_f32 v74, v182, v182
v_mul_f32 v75, v183, v183
v_mul_f32 v76, v204, v204
v_mul_f32 v77, v205, v205
v_mul_f32 v78, v206, v206
v_mul_f32 v79, v207, v207
v_fma_f32 v72, v72, v65, v64
v_fma_f32 v73, v73, v65, v64
s_add_u32 m0, s40, 50176
s_nop 0
buffer_load_dwordx4 v5, s[12:15], s38 offen lds
v_fma_f32 v74, v74, v65, v64
v_fma_f32 v75, v75, v65, v64
v_fma_f32 v76, v76, v69, v68
v_fma_f32 v77, v77, v69, v68
v_fma_f32 v78, v78, v69, v68
v_fma_f32 v79, v79, v69, v68
v_mul_f32 v72, v72, v180
s_add_u32 m0, s40, 51200
s_add_u32 s38, s38, 57344
buffer_load_dwordx4 v4, s[12:15], s38 offen lds
v_mul_f32 v73, v73, v181
v_mul_f32 v74, v74, v182
v_mul_f32 v75, v75, v183
v_mul_f32 v76, v76, v204
v_mul_f32 v77, v77, v205
v_mul_f32 v78, v78, v206
v_mul_f32 v79, v79, v207
s_add_u32 m0, s40, 52224
s_nop 0
buffer_load_dwordx4 v5, s[12:15], s38 offen lds
v_exp_f32 v72, v72
v_exp_f32 v73, v73
v_exp_f32 v74, v74
v_exp_f32 v75, v75
v_exp_f32 v76, v76
v_exp_f32 v77, v77
v_exp_f32 v78, v78
v_exp_f32 v79, v79
s_add_u32 m0, s40, 53248
s_add_u32 s38, s38, 57344
buffer_load_dwordx4 v4, s[12:15], s38 offen lds
v_fma_f32 v192, -v60, v48, v192
v_fma_f32 v193, -v60, v49, v193
v_fma_f32 v194, -v60, v50, v194
v_fma_f32 v195, -v60, v51, v195
v_fma_f32 v216, -v62, v48, v216
v_fma_f32 v217, -v62, v49, v217
v_fma_f32 v218, -v62, v50, v218
s_add_u32 m0, s40, 54272
s_nop 0
buffer_load_dwordx4 v5, s[12:15], s38 offen lds
v_fma_f32 v219, -v62, v51, v219
v_fma_f32 v72, v72, v66, v66
v_fma_f32 v73, v73, v66, v66
v_fma_f32 v74, v74, v66, v66
v_fma_f32 v75, v75, v66, v66
v_fma_f32 v76, v76, v70, v70
v_fma_f32 v77, v77, v70, v70
v_fma_f32 v78, v78, v70, v70
s_add_u32 m0, s40, 55296
s_add_u32 s38, s38, 57344
buffer_load_dwordx4 v4, s[12:15], s38 offen lds
s_add_u32 m0, s40, 56320
s_nop 0
buffer_load_dwordx4 v5, s[12:15], s38 offen lds
s_waitcnt vmcnt(12)
s_barrier
s_add_u32 s37, s35, 7
s_and_b32 s37, s37, 15
s_mul_i32 s37, s37, 16384
s_add_u32 m0, s39, 98304
s_nop 0
buffer_load_dwordx4 v3, s[8:11], s37 offen sc1 lds
v_fma_f32 v79, v79, v70, v70
v_rcp_f32 v72, v72
v_rcp_f32 v73, v73
v_rcp_f32 v74, v74
v_rcp_f32 v75, v75
v_rcp_f32 v76, v76
buffer_load_dwordx4 v3, s[8:11], s37 offen offset:1024 sc1 lds
v_rcp_f32 v77, v77
v_rcp_f32 v78, v78
v_rcp_f32 v79, v79
v_mul_f32 v192, v180, v192
v_mul_f32 v193, v181, v193
v_mul_f32 v194, v182, v194
buffer_load_dwordx4 v3, s[8:11], s37 offen offset:2048 sc1 lds
v_mul_f32 v195, v183, v195
v_mul_f32 v216, v204, v216
v_mul_f32 v217, v205, v217
v_mul_f32 v218, v206, v218
v_mul_f32 v219, v207, v219
v_mul_f32 v192, v192, v72
buffer_load_dwordx4 v3, s[8:11], s37 offen offset:3072 sc1 lds
v_mul_f32 v193, v193, v73
v_mul_f32 v194, v194, v74
v_mul_f32 v195, v195, v75
v_mul_f32 v216, v216, v76
v_mul_f32 v217, v217, v77
v_mul_f32 v218, v218, v78
s_add_u32 s38, s35, 7
s_and_b32 s38, s38, 15
s_mul_i32 s38, s38, 458752
s_add_u32 m0, s40, 98304
s_nop 0
buffer_load_dwordx4 v4, s[12:15], s38 offen lds
v_mul_f32 v219, v219, v79
v_cvt_pk_bf16_f32 v178, v192, v193
v_cvt_pk_bf16_f32 v179, v194, v195
v_cvt_pk_bf16_f32 v202, v216, v217
v_cvt_pk_bf16_f32 v203, v218, v219
buffer_store_dwordx4 v[176:179], v2, s[24:27], s54 offen offset:2048 sc1
s_add_u32 m0, s40, 99328
s_nop 0
buffer_load_dwordx4 v5, s[12:15], s38 offen lds
buffer_store_dwordx4 v[200:203], v2, s[24:27], s54 offen offset:3072 sc1
v_fma_f32 v184, -v60, v40, v184
v_fma_f32 v185, -v60, v41, v185
v_fma_f32 v186, -v60, v42, v186
v_fma_f32 v187, -v60, v43, v187
v_fma_f32 v208, -v62, v40, v208
s_add_u32 m0, s40, 100352
s_add_u32 s38, s38, 57344
buffer_load_dwordx4 v4, s[12:15], s38 offen lds
v_fma_f32 v209, -v62, v41, v209
v_fma_f32 v210, -v62, v42, v210
v_fma_f32 v211, -v62, v43, v211
v_mul_f32 v72, v184, v184
v_mul_f32 v73, v185, v185
v_mul_f32 v74, v186, v186
s_add_u32 m0, s40, 101376
s_nop 0
buffer_load_dwordx4 v5, s[12:15], s38 offen lds
v_mul_f32 v75, v187, v187
v_mul_f32 v76, v208, v208
v_mul_f32 v77, v209, v209
v_mul_f32 v78, v210, v210
v_mul_f32 v79, v211, v211
v_fma_f32 v72, v72, v65, v64
s_add_u32 m0, s40, 102400
s_add_u32 s38, s38, 57344
buffer_load_dwordx4 v4, s[12:15], s38 offen lds
v_fma_f32 v73, v73, v65, v64
v_fma_f32 v74, v74, v65, v64
v_fma_f32 v75, v75, v65, v64
v_fma_f32 v76, v76, v69, v68
v_fma_f32 v77, v77, v69, v68
v_fma_f32 v78, v78, v69, v68
s_add_u32 m0, s40, 103424
s_nop 0
buffer_load_dwordx4 v5, s[12:15], s38 offen lds
v_fma_f32 v79, v79, v69, v68
v_mul_f32 v72, v72, v184
v_mul_f32 v73, v73, v185
v_mul_f32 v74, v74, v186
v_mul_f32 v75, v75, v187
v_mul_f32 v76, v76, v208
s_add_u32 m0, s40, 104448
s_add_u32 s38, s38, 57344
buffer_load_dwordx4 v4, s[12:15], s38 offen lds
s_add_u32 m0, s40, 105472
s_nop 0
buffer_load_dwordx4 v5, s[12:15], s38 offen lds
s_waitcnt vmcnt(14)
s_cmp_eq_u32 s47, 3
s_cbranch_scc0 Lw_107
s_mov_b32 s41, 0x40000
Lcp_108:
s_waitcnt lgkmcnt(0)
s_and_b32 s92, s92, s93
s_cmp_eq_u32 s92, 16
s_cbranch_scc1 Lco_109
s_load_dword s92, s[82:83], s60 glc
s_load_dword s93, s[82:83], s61 glc
s_sub_u32 s41, s41, 1
s_cmp_lg_u32 s41, 0
s_cbranch_scc1 Lcp_108
s_waitcnt lgkmcnt(0)
Lco_109:
Lw_107:
s_barrier
s_lshl_b32 s60, s35, 9
s_lshl_b32 s43, s47, 7
s_add_u32 s60, s60, s43
s_add_u32 s61, s60, 14336
s_add_u32 s52, s43, 148480
s_add_u32 s53, s52, 896
v_lshrrev_b32 v104, 3, v1
v_mul_u32_u24 v104, 28672, v104
v_and_b32 v105, 7, v1
v_lshl_add_u32 v104, v105, 4, v104
s_waitcnt lgkmcnt(0)
buffer_load_dwordx4 v[96:99], v104, s[84:87], s60 offen sc1
s_load_dword s3, s[4:5], 5376
s_load_dword s3, s[4:5], 5440
s_load_dword s3, s[4:5], 5504
s_load_dword s3, s[4:5], 5568
s_load_dword s3, s[4:5], 5632
s_load_dword s3, s[4:5], 5696
buffer_load_dwordx4 v[100:103], v104, s[84:87], s61 offen sc1
s_load_dword s3, s[4:5], 5760
s_load_dword s3, s[4:5], 5824
s_load_dword s3, s[4:5], 5888
s_load_dword s3, s[4:5], 5952
s_load_dword s3, s[4:5], 6016
s_load_dword s3, s[4:5], 6080
s_load_dword s3, s[4:5], 6144
s_add_u32 s37, s35, 8
s_and_b32 s37, s37, 15
s_mul_i32 s37, s37, 16384
s_add_u32 m0, s39, 0
s_nop 0
buffer_load_dwordx4 v3, s[8:11], s37 offen sc1 lds
s_load_dword s3, s[4:5], 6208
v_mul_f32 v77, v77, v209
v_mul_f32 v78, v78, v210
v_mul_f32 v79, v79, v211
v_exp_f32 v72, v72
v_exp_f32 v73, v73
v_exp_f32 v74, v74
buffer_load_dwordx4 v3, s[8:11], s37 offen offset:1024 sc1 lds
v_exp_f32 v75, v75
v_exp_f32 v76, v76
v_exp_f32 v77, v77
v_exp_f32 v78, v78
v_exp_f32 v79, v79
v_fma_f32 v196, -v60, v52, v196
v_fma_f32 v197, -v60, v53, v197
buffer_load_dwordx4 v3, s[8:11], s37 offen offset:2048 sc1 lds
v_fma_f32 v198, -v60, v54, v198
v_fma_f32 v199, -v60, v55, v199
v_fma_f32 v220, -v62, v52, v220
v_fma_f32 v221, -v62, v53, v221
v_fma_f32 v222, -v62, v54, v222
v_fma_f32 v223, -v62, v55, v223
buffer_load_dwordx4 v3, s[8:11], s37 offen offset:3072 sc1 lds
v_fma_f32 v72, v72, v66, v66
v_fma_f32 v73, v73, v66, v66
v_fma_f32 v74, v74, v66, v66
v_fma_f32 v75, v75, v66, v66
v_fma_f32 v76, v76, v70, v70
v_fma_f32 v77, v77, v70, v70
v_fma_f32 v78, v78, v70, v70
s_add_u32 s38, s35, 8
s_and_b32 s38, s38, 15
s_mul_i32 s38, s38, 458752
s_add_u32 m0, s40, 0
s_nop 0
buffer_load_dwordx4 v4, s[12:15], s38 offen lds
v_fma_f32 v79, v79, v70, v70
v_rcp_f32 v72, v72
v_rcp_f32 v73, v73
v_rcp_f32 v74, v74
v_rcp_f32 v75, v75
v_rcp_f32 v76, v76
v_rcp_f32 v77, v77
s_add_u32 m0, s40, 1024
s_nop 0
buffer_load_dwordx4 v5, s[12:15], s38 offen lds
v_rcp_f32 v78, v78
v_rcp_f32 v79, v79
v_mul_f32 v196, v184, v196
v_mul_f32 v197, v185, v197
v_mul_f32 v198, v186, v198
v_mul_f32 v199, v187, v199
v_mul_f32 v220, v208, v220
s_add_u32 m0, s40, 2048
s_add_u32 s38, s38, 57344
buffer_load_dwordx4 v4, s[12:15], s38 offen lds
v_mul_f32 v221, v209, v221
v_mul_f32 v222, v210, v222
v_mul_f32 v223, v211, v223
v_mul_f32 v196, v196, v72
v_mul_f32 v197, v197, v73
v_mul_f32 v198, v198, v74
s_add_u32 m0, s40, 3072
s_nop 0
buffer_load_dwordx4 v5, s[12:15], s38 offen lds
v_mul_f32 v199, v199, v75
v_mul_f32 v220, v220, v76
v_mul_f32 v221, v221, v77
v_mul_f32 v222, v222, v78
v_mul_f32 v223, v223, v79
v_cvt_pk_bf16_f32 v80, v196, v197
v_cvt_pk_bf16_f32 v81, v198, v199
s_add_u32 m0, s40, 4096
s_add_u32 s38, s38, 57344
buffer_load_dwordx4 v4, s[12:15], s38 offen lds
v_cvt_pk_bf16_f32 v82, v220, v221
v_cvt_pk_bf16_f32 v83, v222, v223
s_nop 1
v_permlane32_swap_b32 v80, v82
v_permlane32_swap_b32 v81, v83
buffer_store_dwordx4 v[80:83], v84, s[24:27], s55 offen offset:2048 sc1
s_nop 1
s_add_u32 m0, s40, 5120
s_nop 0
buffer_load_dwordx4 v5, s[12:15], s38 offen lds
v_cmp_gt_u32 vcc, 32, v1
v_mov_b32 v104, s52
v_mov_b32 v106, s53
v_cndmask_b32 v104, v106, v104, vcc
v_lshl_add_u32 v104, v105, 4, v104
v_bfe_u32 v105, v1, 4, 1
v_lshl_add_u32 v104, v105, 2, v104
s_add_u32 m0, s40, 6144
s_add_u32 s38, s38, 57344
buffer_load_dwordx4 v4, s[12:15], s38 offen lds
s_add_u32 m0, s40, 7168
s_nop 0
buffer_load_dwordx4 v5, s[12:15], s38 offen lds
s_waitcnt vmcnt(15)
s_barrier
s_add_u32 s37, s35, 9
s_and_b32 s37, s37, 15
s_mul_i32 s37, s37, 16384
s_add_u32 m0, s39, 49152
s_nop 0
buffer_load_dwordx4 v3, s[8:11], s37 offen sc1 lds
buffer_load_dwordx4 v3, s[8:11], s37 offen offset:1024 sc1 lds
buffer_load_dwordx4 v3, s[8:11], s37 offen offset:2048 sc1 lds
buffer_load_dwordx4 v3, s[8:11], s37 offen offset:3072 sc1 lds
s_add_u32 s38, s35, 9
s_and_b32 s38, s38, 15
s_mul_i32 s38, s38, 458752
s_add_u32 m0, s40, 49152
s_nop 0
buffer_load_dwordx4 v4, s[12:15], s38 offen lds
s_add_u32 m0, s40, 50176
s_nop 0
buffer_load_dwordx4 v5, s[12:15], s38 offen lds
s_add_u32 m0, s40, 51200
s_add_u32 s38, s38, 57344
buffer_load_dwordx4 v4, s[12:15], s38 offen lds
s_add_u32 m0, s40, 52224
s_nop 0
buffer_load_dwordx4 v5, s[12:15], s38 offen lds
s_add_u32 m0, s40, 53248
s_add_u32 s38, s38, 57344
buffer_load_dwordx4 v4, s[12:15], s38 offen lds
s_add_u32 m0, s40, 54272
s_nop 0
buffer_load_dwordx4 v5, s[12:15], s38 offen lds
s_add_u32 m0, s40, 55296
s_add_u32 s38, s38, 57344
buffer_load_dwordx4 v4, s[12:15], s38 offen lds
s_add_u32 m0, s40, 56320
s_nop 0
buffer_load_dwordx4 v5, s[12:15], s38 offen lds
s_waitcnt vmcnt(12)
s_barrier
s_cmp_eq_u32 s47, 0
s_cbranch_scc0 Lw_110
s_add_u32 s7, s34, 32
s_lshl_b32 s7, s7, 7
v_mov_b32 v90, s7
v_mov_b32 v91, 1
s_mov_b64 exec, 1
buffer_atomic_add v91, v90, s[56:59], 0 offen sc1
s_mov_b64 exec, -1
Lw_110:
v_permlane32_swap_b32 v96, v100
v_permlane32_swap_b32 v97, v101
v_permlane32_swap_b32 v98, v102
v_permlane32_swap_b32 v99, v103
v_add_f32 v96, v96, v100
v_add_f32 v97, v97, v101
v_add_f32 v98, v98, v102
v_add_f32 v99, v99, v103
s_nop 1
v_permlane16_swap_b32 v96, v97
v_permlane16_swap_b32 v98, v99
v_add_f32 v96, v96, v97
v_add_f32 v98, v98, v99
s_nop 1
v_add_f32_dpp v96, v96, v96 row_ror:8 row_mask:0xf bank_mask:0xf
v_add_f32_dpp v98, v98, v98 row_ror:8 row_mask:0xf bank_mask:0xf
ds_write_b32 v104, v96
ds_write_b32 v104, v98 offset:8
s_waitcnt lgkmcnt(0)
s_add_u32 s37, s35, 10
s_and_b32 s37, s37, 15
s_mul_i32 s37, s37, 16384
s_add_u32 m0, s39, 98304
s_nop 0
buffer_load_dwordx4 v3, s[8:11], s37 offen sc1 lds
s_load_dword s3, s[4:5], 6272
s_load_dword s3, s[4:5], 6336
s_load_dword s3, s[4:5], 6400
s_load_dword s3, s[4:5], 6464
s_load_dword s3, s[4:5], 6528
s_load_dword s3, s[4:5], 6592
buffer_load_dwordx4 v3, s[8:11], s37 offen offset:1024 sc1 lds
s_load_dword s3, s[4:5], 6656
s_load_dword s3, s[4:5], 6720
s_load_dword s3, s[4:5], 6784
s_load_dword s3, s[4:5], 6848
s_load_dword s3, s[4:5], 6912
s_load_dword s3, s[4:5], 6976
s_load_dword s3, s[4:5], 7040
buffer_load_dwordx4 v3, s[8:11], s37 offen offset:2048 sc1 lds
s_load_dword s3, s[4:5], 7104
s_bfe_u32 s61, s35, 0x10002
s_lshr_b32 s60, s35, 3
s_lshl_b32 s60, s60, 2
s_and_b32 s43, s35, 3
s_add_u32 s60, s60, s43
buffer_load_dwordx4 v3, s[8:11], s37 offen offset:3072 sc1 lds
s_lshl_b32 s43, s60, 8
s_add_u32 s28, s76, s43
s_addc_u32 s29, s77, 0
s_mov_b32 s30, 7338240
s_mov_b32 s31, 0x20000
s_mul_i32 s52, s61, 196608
s_mul_i32 s53, s61, 1572864
s_add_u32 s38, s35, 10
s_and_b32 s38, s38, 15
s_mul_i32 s38, s38, 458752
s_add_u32 m0, s40, 98304
s_nop 0
buffer_load_dwordx4 v4, s[12:15], s38 offen lds
s_mul_i32 s90, s61, 163840
s_mul_i32 s91, s61, 1310720
s_and_b32 s43, s35, 3
s_mul_i32 s32, s43, 3
s_mul_i32 s33, s43, 10
s_lshr_b32 s33, s33, 2
s_add_u32 m0, s40, 99328
s_nop 0
buffer_load_dwordx4 v5, s[12:15], s38 offen lds
s_lshl_b32 s51, s47, 11
s_lshl_b32 s44, s47, 15
v_lshrrev_b32 v122, 4, v1
v_lshlrev_b32 v123, 1, v122
v_and_b32 v23, 15, v1
v_xor_b32 v23, v23, v123
v_lshlrev_b32 v23, 4, v23
s_add_u32 m0, s40, 100352
s_add_u32 s38, s38, 57344
buffer_load_dwordx4 v4, s[12:15], s38 offen lds
v_mul_u32_u24 v122, 2048, v122
v_add_u32 v23, v23, v122
v_add_u32 v23, s44, v23
v_xor_b32 v24, 128, v23
v_add_u32 v24, 8192, v24
s_lshl_b32 s43, s60, 2
s_add_u32 m0, s40, 101376
s_nop 0
buffer_load_dwordx4 v5, s[12:15], s38 offen lds
s_lshl_b32 s44, s61, 1
s_add_u32 s43, s43, s44
s_add_u32 s43, s43, s63
s_lshl_b32 s43, s43, 13
s_lshl_b32 s44, s62, 12
s_add_u32 s49, s43, s44
v_add_u32 v17, s44, v2
s_add_u32 m0, s40, 102400
s_add_u32 s38, s38, 57344
buffer_load_dwordx4 v4, s[12:15], s38 offen lds
v_add_u32 v18, 0x10000, v17
v_add_u32 v19, 0x20000, v17
v_lshrrev_b32 v122, 2, v1
v_and_b32 v123, 7, v122
v_mul_u32_u24 v122, 256, v122
v_lshl_add_u32 v122, v123, 5, v122
s_add_u32 m0, s40, 103424
s_nop 0
buffer_load_dwordx4 v5, s[12:15], s38 offen lds
v_and_b32 v123, 3, v1
v_lshl_add_u32 v9, v123, 3, v122
s_lshl_b32 s43, s61, 7
s_lshl_b32 s44, s63, 6
s_add_u32 s43, s43, s44
v_xor_b32 v9, s43, v9
v_xor_b32 v10, 32, v9
s_add_u32 m0, s40, 104448
s_add_u32 s38, s38, 57344
buffer_load_dwordx4 v4, s[12:15], s38 offen lds
s_add_u32 m0, s40, 105472
s_nop 0
buffer_load_dwordx4 v5, s[12:15], s38 offen lds
s_waitcnt vmcnt(12)
s_barrier
buffer_load_dwordx4 v[160:163], v2, s[8:11], s49 offen offset:0 sc1
v_xor_b32 v11, 128, v9
v_xor_b32 v12, 128, v10
v_add_u32 v13, 65536, v9
buffer_load_dwordx4 v[164:167], v2, s[8:11], s49 offen offset:1024 sc1
v_add_u32 v14, 65536, v10
v_add_u32 v15, 65536, v11
v_add_u32 v16, 65536, v12
v_add_u32 v25, 131072, v9
buffer_load_dwordx4 v[168:171], v2, s[8:11], s49 offen offset:2048 sc1
v_add_u32 v26, 131072, v10
s_branch Lov_10
.p2align 12
.fill 80, 4, 0xbf800000
Lst_10_0:
s_branch Lwr_150
Lst_10_1:
s_branch Lwr_157
s_nop 0
Lov_10:
v_add_u32 v27, 131072, v11
v_add_u32 v28, 131072, v12
v_lshrrev_b32 v122, 2, v1
buffer_load_dwordx4 v[172:175], v2, s[8:11], s49 offen offset:3072 sc1
v_bfe_u32 v123, v122, 1, 2
v_mul_u32_u24 v122, 128, v122
v_lshl_add_u32 v122, v123, 5, v122
s_add_u32 s37, s35, 11
s_and_b32 s37, s37, 15
s_mul_i32 s37, s37, 16384
s_add_u32 m0, s39, 0
s_nop 0
buffer_load_dwordx4 v3, s[8:11], s37 offen sc1 lds
v_and_b32 v123, 3, v1
v_lshl_add_u32 v224, v123, 3, v122
v_xor_b32 v224, s44, v224
v_xor_b32 v225, 32, v224
buffer_load_dwordx4 v3, s[8:11], s37 offen offset:1024 sc1 lds
v_add_u32 v226, 65536, v224
v_add_u32 v227, 65536, v225
v_add_u32 v228, 131072, v224
v_add_u32 v229, 131072, v225
buffer_load_dwordx4 v3, s[8:11], s37 offen offset:2048 sc1 lds
s_add_u32 s84, s82, 33554432
s_addc_u32 s85, s83, 0
s_mov_b32 s86, 4194304
s_mov_b32 s87, 0x20000
buffer_load_dwordx4 v3, s[8:11], s37 offen offset:3072 sc1 lds
s_xor_b32 s43, s2, 2
s_lshl_b32 s44, s43, 2
s_add_u32 s44, s44, s47
s_add_u32 s38, s35, 11
s_and_b32 s38, s38, 15
s_mul_i32 s38, s38, 458752
s_add_u32 m0, s40, 0
s_nop 0
buffer_load_dwordx4 v4, s[12:15], s38 offen lds
s_lshl_b32 s45, s44, 12
s_lshl_b32 s46, s2, 2
s_add_u32 s46, s46, s47
s_lshl_b32 s46, s46, 12
s_add_u32 m0, s40, 1024
s_nop 0
buffer_load_dwordx4 v5, s[12:15], s38 offen lds
s_lshl_b32 s43, s34, 18
s_lshl_b32 s42, s60, 8
s_add_u32 s43, s43, s42
s_lshl_b32 s42, s61, 7
s_add_u32 m0, s40, 2048
s_add_u32 s38, s38, 57344
buffer_load_dwordx4 v4, s[12:15], s38 offen lds
s_add_u32 s43, s43, s42
s_lshl_b32 s42, s63, 6
s_add_u32 s43, s43, s42
s_add_u32 m0, s40, 3072
s_nop 0
buffer_load_dwordx4 v5, s[12:15], s38 offen lds
s_add_u32 s20, s78, s43
s_addc_u32 s21, s79, 0
s_mov_b32 s22, 260160
s_mov_b32 s23, 0x20000
s_add_u32 m0, s40, 4096
s_add_u32 s38, s38, 57344
buffer_load_dwordx4 v4, s[12:15], s38 offen lds
v_and_b32 v230, 15, v1
v_lshlrev_b32 v230, 12, v230
v_bfe_u32 v231, v1, 4, 1
v_lshl_add_u32 v230, v231, 5, v230
s_add_u32 m0, s40, 5120
s_nop 0
buffer_load_dwordx4 v5, s[12:15], s38 offen lds
v_bfe_u32 v231, v1, 5, 1
v_lshl_add_u32 v230, v231, 4, v230
s_lshl_b32 s54, s62, 17
s_add_u32 s55, s54, 65536
s_add_u32 m0, s40, 6144
s_add_u32 s38, s38, 57344
buffer_load_dwordx4 v4, s[12:15], s38 offen lds
s_add_u32 m0, s40, 7168
s_nop 0
buffer_load_dwordx4 v5, s[12:15], s38 offen lds
s_waitcnt vmcnt(16)
s_barrier
s_cmp_eq_u32 s47, 3
s_cbranch_scc0 Lw_111
s_lshl_b32 s92, s34, 7
s_add_u32 s92, s92, 28315648
s_load_dword s93, s[82:83], s92 glc
Lw_111:
s_add_u32 s37, s35, 12
s_and_b32 s37, s37, 15
s_mul_i32 s37, s37, 16384
s_add_u32 m0, s39, 49152
s_nop 0
buffer_load_dwordx4 v3, s[8:11], s37 offen sc1 lds
buffer_load_dwordx4 v3, s[8:11], s37 offen offset:1024 sc1 lds
buffer_load_dwordx4 v3, s[8:11], s37 offen offset:2048 sc1 lds
buffer_load_dwordx4 v3, s[8:11], s37 offen offset:3072 sc1 lds
s_add_u32 s38, s35, 12
s_and_b32 s38, s38, 15
s_mul_i32 s38, s38, 458752
s_add_u32 m0, s40, 49152
s_nop 0
buffer_load_dwordx4 v4, s[12:15], s38 offen lds
s_add_u32 m0, s40, 50176
s_nop 0
buffer_load_dwordx4 v5, s[12:15], s38 offen lds
s_add_u32 m0, s40, 51200
s_add_u32 s38, s38, 57344
buffer_load_dwordx4 v4, s[12:15], s38 offen lds
s_add_u32 m0, s40, 52224
s_nop 0
buffer_load_dwordx4 v5, s[12:15], s38 offen lds
s_add_u32 m0, s40, 53248
s_add_u32 s38, s38, 57344
buffer_load_dwordx4 v4, s[12:15], s38 offen lds
s_add_u32 m0, s40, 54272
s_nop 0
buffer_load_dwordx4 v5, s[12:15], s38 offen lds
s_add_u32 m0, s40, 55296
s_add_u32 s38, s38, 57344
buffer_load_dwordx4 v4, s[12:15], s38 offen lds
s_add_u32 m0, s40, 56320
s_nop 0
buffer_load_dwordx4 v5, s[12:15], s38 offen lds
s_waitcnt vmcnt(12)
s_cmp_eq_u32 s47, 3
s_cbranch_scc0 Lw_112
s_mov_b32 s41, 0x40000
s_branch Lpchk_115
Lpoll_113:
s_load_dword s93, s[82:83], s92 glc
Lpchk_115:
s_waitcnt lgkmcnt(0)
s_cmp_eq_u32 s93, 16
s_cbranch_scc1 Lpok_114
s_sub_u32 s41, s41, 1
s_cmp_lg_u32 s41, 0
s_cbranch_scc1 Lpoll_113
Lpok_114:
Lw_112:
s_barrier
s_add_u32 s37, s52, 524288
s_add_u32 m0, s39, 98304
s_nop 0
buffer_load_dwordx4 v3, s[24:27], s37 offen sc1 lds
v_lshlrev_b32 v128, 16, v160
v_and_b32 v129, 0xffff0000, v160
v_lshlrev_b32 v130, 16, v161
v_and_b32 v131, 0xffff0000, v161
v_lshlrev_b32 v132, 16, v162
buffer_load_dwordx4 v3, s[24:27], s37 offen offset:1024 sc1 lds
v_and_b32 v133, 0xffff0000, v162
v_lshlrev_b32 v134, 16, v163
v_and_b32 v135, 0xffff0000, v163
v_lshlrev_b32 v136, 16, v164
v_and_b32 v137, 0xffff0000, v164
buffer_load_dwordx4 v3, s[24:27], s37 offen offset:2048 sc1 lds
v_lshlrev_b32 v138, 16, v165
v_and_b32 v139, 0xffff0000, v165
v_lshlrev_b32 v140, 16, v166
v_and_b32 v141, 0xffff0000, v166
v_lshlrev_b32 v142, 16, v167
v_and_b32 v143, 0xffff0000, v167
buffer_load_dwordx4 v3, s[24:27], s37 offen offset:3072 sc1 lds
v_lshlrev_b32 v144, 16, v168
v_and_b32 v145, 0xffff0000, v168
v_lshlrev_b32 v146, 16, v169
v_and_b32 v147, 0xffff0000, v169
v_lshlrev_b32 v148, 16, v170
s_add_u32 s38, s53, 4194304
s_add_u32 m0, s39, 114688
s_nop 0
buffer_load_dwordx4 v23, s[28:31], s38 offen lds
v_and_b32 v149, 0xffff0000, v170
v_lshlrev_b32 v150, 16, v171
v_and_b32 v151, 0xffff0000, v171
v_lshlrev_b32 v152, 16, v172
v_and_b32 v153, 0xffff0000, v172
s_add_u32 m0, s39, 115712
s_nop 0
buffer_load_dwordx4 v24, s[28:31], s38 offen lds
v_lshlrev_b32 v154, 16, v173
v_and_b32 v155, 0xffff0000, v173
v_lshlrev_b32 v156, 16, v174
v_and_b32 v157, 0xffff0000, v174
v_lshlrev_b32 v158, 16, v175
v_and_b32 v159, 0xffff0000, v175
s_add_u32 m0, s39, 116736
s_add_u32 s38, s38, 16384
buffer_load_dwordx4 v23, s[28:31], s38 offen lds
s_add_u32 m0, s39, 117760
s_nop 0
buffer_load_dwordx4 v24, s[28:31], s38 offen lds
s_waitcnt vmcnt(8)
s_barrier
s_add_u32 s37, s52, 540672
s_add_u32 m0, s39, 131072
s_nop 0
buffer_load_dwordx4 v3, s[24:27], s37 offen sc1 lds
buffer_load_dwordx4 v3, s[24:27], s37 offen offset:1024 sc1 lds
buffer_load_dwordx4 v3, s[24:27], s37 offen offset:2048 sc1 lds
buffer_load_dwordx4 v3, s[24:27], s37 offen offset:3072 sc1 lds
s_add_u32 s38, s53, 4325376
s_add_u32 m0, s39, 0
s_nop 0
buffer_load_dwordx4 v23, s[28:31], s38 offen lds
s_add_u32 m0, s39, 1024
s_nop 0
buffer_load_dwordx4 v24, s[28:31], s38 offen lds
s_add_u32 m0, s39, 2048
s_add_u32 s38, s38, 16384
buffer_load_dwordx4 v23, s[28:31], s38 offen lds
s_add_u32 m0, s39, 3072
s_nop 0
buffer_load_dwordx4 v24, s[28:31], s38 offen lds
s_add_u32 s37, s52, 557056
s_add_u32 m0, s39, 16384
s_nop 0
buffer_load_dwordx4 v3, s[24:27], s37 offen sc1 lds
buffer_load_dwordx4 v3, s[24:27], s37 offen offset:1024 sc1 lds
buffer_load_dwordx4 v3, s[24:27], s37 offen offset:2048 sc1 lds
buffer_load_dwordx4 v3, s[24:27], s37 offen offset:3072 sc1 lds
s_add_u32 s38, s53, 4456448
s_add_u32 m0, s39, 32768
s_nop 0
buffer_load_dwordx4 v23, s[28:31], s38 offen lds
s_add_u32 m0, s39, 33792
s_nop 0
buffer_load_dwordx4 v24, s[28:31], s38 offen lds
s_add_u32 m0, s39, 34816
s_add_u32 s38, s38, 16384
buffer_load_dwordx4 v23, s[28:31], s38 offen lds
s_add_u32 m0, s39, 35840
s_nop 0
buffer_load_dwordx4 v24, s[28:31], s38 offen lds
s_waitcnt vmcnt(16)
s_barrier
ds_read_b128 v[32:35], v18 offset:32768
ds_read_b64_tr_b16 v[48:49], v13 offset:49152
ds_read_b64_tr_b16 v[50:51], v13 offset:53248
ds_read_b64_tr_b16 v[52:53], v14 offset:49152
ds_read_b64_tr_b16 v[54:55], v14 offset:53248
ds_read_b64_tr_b16 v[56:57], v15 offset:49152
ds_read_b64_tr_b16 v[58:59], v15 offset:53248
ds_read_b64_tr_b16 v[60:61], v16 offset:49152
ds_read_b64_tr_b16 v[62:63], v16 offset:53248
ds_read_b128 v[36:39], v18 offset:33792
ds_read_b128 v[40:43], v18 offset:34816
ds_read_b128 v[44:47], v18 offset:35840
ds_read_b128 v[64:67], v18 offset:40960
ds_read_b64_tr_b16 v[80:81], v13 offset:57344
ds_read_b64_tr_b16 v[82:83], v13 offset:61440
ds_read_b64_tr_b16 v[84:85], v14 offset:57344
ds_read_b64_tr_b16 v[86:87], v14 offset:61440
ds_read_b64_tr_b16 v[88:89], v15 offset:57344
ds_read_b64_tr_b16 v[90:91], v15 offset:61440
ds_read_b64_tr_b16 v[92:93], v16 offset:57344
ds_read_b64_tr_b16 v[94:95], v16 offset:61440
ds_read_b128 v[68:71], v18 offset:41984
ds_read_b128 v[72:75], v18 offset:43008
ds_read_b128 v[76:79], v18 offset:44032
s_add_u32 s37, s52, 573440
s_add_u32 m0, s39, 49152
s_nop 0
buffer_load_dwordx4 v3, s[24:27], s37 offen sc1 lds
buffer_load_dwordx4 v3, s[24:27], s37 offen offset:1024 sc1 lds
buffer_load_dwordx4 v3, s[24:27], s37 offen offset:2048 sc1 lds
buffer_load_dwordx4 v3, s[24:27], s37 offen offset:3072 sc1 lds
s_add_u32 s38, s53, 4587520
s_add_u32 m0, s39, 65536
s_nop 0
buffer_load_dwordx4 v23, s[28:31], s38 offen lds
s_add_u32 m0, s39, 66560
s_nop 0
buffer_load_dwordx4 v24, s[28:31], s38 offen lds
s_add_u32 m0, s39, 67584
s_add_u32 s38, s38, 16384
buffer_load_dwordx4 v23, s[28:31], s38 offen lds
s_add_u32 m0, s39, 68608
s_nop 0
buffer_load_dwordx4 v24, s[28:31], s38 offen lds
Lk4c:
s_waitcnt vmcnt(16)
s_waitcnt lgkmcnt(0)
s_barrier
v_mfma_f32_16x16x32_bf16 v[128:131], v[48:51], v[32:35], v[128:131]
ds_read_b128 v[96:99], v19 offset:0
v_mfma_f32_16x16x32_bf16 v[136:139], v[48:51], v[36:39], v[136:139]
ds_read_b64_tr_b16 v[112:113], v9 offset:0
v_mfma_f32_16x16x32_bf16 v[144:147], v[48:51], v[40:43], v[144:147]
ds_read_b64_tr_b16 v[114:115], v9 offset:4096
v_mfma_f32_16x16x32_bf16 v[152:155], v[48:51], v[44:47], v[152:155]
ds_read_b64_tr_b16 v[116:117], v10 offset:0
v_mfma_f32_16x16x32_bf16 v[156:159], v[52:55], v[44:47], v[156:159]
ds_read_b64_tr_b16 v[118:119], v10 offset:4096
v_mfma_f32_16x16x32_bf16 v[148:151], v[52:55], v[40:43], v[148:151]
ds_read_b64_tr_b16 v[120:121], v11 offset:0
v_mfma_f32_16x16x32_bf16 v[140:143], v[52:55], v[36:39], v[140:143]
ds_read_b64_tr_b16 v[122:123], v11 offset:4096
v_mfma_f32_16x16x32_bf16 v[132:135], v[52:55], v[32:35], v[132:135]
ds_read_b64_tr_b16 v[124:125], v12 offset:0
v_mfma_f32_16x16x32_bf16 v[160:163], v[56:59], v[32:35], 0
ds_read_b64_tr_b16 v[126:127], v12 offset:4096
v_mfma_f32_16x16x32_bf16 v[168:171], v[56:59], v[36:39], 0
ds_read_b128 v[100:103], v19 offset:1024
v_mfma_f32_16x16x32_bf16 v[176:179], v[56:59], v[40:43], 0
ds_read_b128 v[104:107], v19 offset:2048
v_mfma_f32_16x16x32_bf16 v[184:187], v[56:59], v[44:47], 0
ds_read_b128 v[108:111], v19 offset:3072
v_mfma_f32_16x16x32_bf16 v[188:191], v[60:63], v[44:47], 0
ds_read_b128 v[192:195], v19 offset:8192
v_mfma_f32_16x16x32_bf16 v[180:183], v[60:63], v[40:43], 0
ds_read_b64_tr_b16 v[208:209], v9 offset:8192
v_mfma_f32_16x16x32_bf16 v[172:175], v[60:63], v[36:39], 0
ds_read_b64_tr_b16 v[210:211], v9 offset:12288
v_mfma_f32_16x16x32_bf16 v[164:167], v[60:63], v[32:35], 0
ds_read_b64_tr_b16 v[212:213], v10 offset:8192
v_mfma_f32_16x16x32_bf16 v[128:131], v[80:83], v[64:67], v[128:131]
ds_read_b64_tr_b16 v[214:215], v10 offset:12288
v_mfma_f32_16x16x32_bf16 v[136:139], v[80:83], v[68:71], v[136:139]
ds_read_b64_tr_b16 v[216:217], v11 offset:8192
v_mfma_f32_16x16x32_bf16 v[144:147], v[80:83], v[72:75], v[144:147]
ds_read_b64_tr_b16 v[218:219], v11 offset:12288
v_mfma_f32_16x16x32_bf16 v[152:155], v[80:83], v[76:79], v[152:155]
ds_read_b64_tr_b16 v[220:221], v12 offset:8192
v_mfma_f32_16x16x32_bf16 v[156:159], v[84:87], v[76:79], v[156:159]
ds_read_b64_tr_b16 v[222:223], v12 offset:12288
v_mfma_f32_16x16x32_bf16 v[148:151], v[84:87], v[72:75], v[148:151]
ds_read_b128 v[196:199], v19 offset:9216
v_mfma_f32_16x16x32_bf16 v[140:143], v[84:87], v[68:71], v[140:143]
ds_read_b128 v[200:203], v19 offset:10240
v_mfma_f32_16x16x32_bf16 v[132:135], v[84:87], v[64:67], v[132:135]
ds_read_b128 v[204:207], v19 offset:11264
v_mfma_f32_16x16x32_bf16 v[160:163], v[88:91], v[64:67], v[160:163]
v_mfma_f32_16x16x32_bf16 v[168:171], v[88:91], v[68:71], v[168:171]
v_mfma_f32_16x16x32_bf16 v[176:179], v[88:91], v[72:75], v[176:179]
v_mfma_f32_16x16x32_bf16 v[184:187], v[88:91], v[76:79], v[184:187]
v_mfma_f32_16x16x32_bf16 v[188:191], v[92:95], v[76:79], v[188:191]
v_mfma_f32_16x16x32_bf16 v[180:183], v[92:95], v[72:75], v[180:183]
v_mfma_f32_16x16x32_bf16 v[172:175], v[92:95], v[68:71], v[172:175]
v_mfma_f32_16x16x32_bf16 v[164:167], v[92:95], v[64:67], v[164:167]
s_mov_b32 s41, 2
Lk4_116:
s_waitcnt vmcnt(8)
s_waitcnt lgkmcnt(0)
s_barrier
v_mfma_f32_16x16x32_bf16 v[128:131], v[112:115], v[96:99], v[128:131]
ds_read_b128 v[32:35], v17 offset:16384
v_mfma_f32_16x16x32_bf16 v[136:139], v[112:115], v[100:103], v[136:139]
ds_read_b64_tr_b16 v[48:49], v9 offset:32768
v_mfma_f32_16x16x32_bf16 v[144:147], v[112:115], v[104:107], v[144:147]
ds_read_b64_tr_b16 v[50:51], v9 offset:36864
v_mfma_f32_16x16x32_bf16 v[152:155], v[112:115], v[108:111], v[152:155]
ds_read_b64_tr_b16 v[52:53], v10 offset:32768
v_mfma_f32_16x16x32_bf16 v[156:159], v[116:119], v[108:111], v[156:159]
ds_read_b64_tr_b16 v[54:55], v10 offset:36864
v_mfma_f32_16x16x32_bf16 v[148:151], v[116:119], v[104:107], v[148:151]
ds_read_b64_tr_b16 v[56:57], v11 offset:32768
v_mfma_f32_16x16x32_bf16 v[140:143], v[116:119], v[100:103], v[140:143]
ds_read_b64_tr_b16 v[58:59], v11 offset:36864
v_mfma_f32_16x16x32_bf16 v[132:135], v[116:119], v[96:99], v[132:135]
ds_read_b64_tr_b16 v[60:61], v12 offset:32768
v_mfma_f32_16x16x32_bf16 v[160:163], v[120:123], v[96:99], v[160:163]
ds_read_b64_tr_b16 v[62:63], v12 offset:36864
v_mfma_f32_16x16x32_bf16 v[168:171], v[120:123], v[100:103], v[168:171]
ds_read_b128 v[36:39], v17 offset:17408
v_mfma_f32_16x16x32_bf16 v[176:179], v[120:123], v[104:107], v[176:179]
ds_read_b128 v[40:43], v17 offset:18432
v_mfma_f32_16x16x32_bf16 v[184:187], v[120:123], v[108:111], v[184:187]
ds_read_b128 v[44:47], v17 offset:19456
v_mfma_f32_16x16x32_bf16 v[188:191], v[124:127], v[108:111], v[188:191]
ds_read_b128 v[64:67], v17 offset:24576
v_mfma_f32_16x16x32_bf16 v[180:183], v[124:127], v[104:107], v[180:183]
ds_read_b64_tr_b16 v[80:81], v9 offset:40960
v_mfma_f32_16x16x32_bf16 v[172:175], v[124:127], v[100:103], v[172:175]
ds_read_b64_tr_b16 v[82:83], v9 offset:45056
v_mfma_f32_16x16x32_bf16 v[164:167], v[124:127], v[96:99], v[164:167]
ds_read_b64_tr_b16 v[84:85], v10 offset:40960
v_mfma_f32_16x16x32_bf16 v[128:131], v[208:211], v[192:195], v[128:131]
ds_read_b64_tr_b16 v[86:87], v10 offset:45056
v_mfma_f32_16x16x32_bf16 v[136:139], v[208:211], v[196:199], v[136:139]
ds_read_b64_tr_b16 v[88:89], v11 offset:40960
v_mfma_f32_16x16x32_bf16 v[144:147], v[208:211], v[200:203], v[144:147]
ds_read_b64_tr_b16 v[90:91], v11 offset:45056
v_mfma_f32_16x16x32_bf16 v[152:155], v[208:211], v[204:207], v[152:155]
ds_read_b64_tr_b16 v[92:93], v12 offset:40960
v_mfma_f32_16x16x32_bf16 v[156:159], v[212:215], v[204:207], v[156:159]
ds_read_b64_tr_b16 v[94:95], v12 offset:45056
v_mfma_f32_16x16x32_bf16 v[148:151], v[212:215], v[200:203], v[148:151]
ds_read_b128 v[68:71], v17 offset:25600
v_mfma_f32_16x16x32_bf16 v[140:143], v[212:215], v[196:199], v[140:143]
ds_read_b128 v[72:75], v17 offset:26624
v_mfma_f32_16x16x32_bf16 v[132:135], v[212:215], v[192:195], v[132:135]
ds_read_b128 v[76:79], v17 offset:27648
v_mfma_f32_16x16x32_bf16 v[160:163], v[216:219], v[192:195], v[160:163]
v_mfma_f32_16x16x32_bf16 v[168:171], v[216:219], v[196:199], v[168:171]
v_mfma_f32_16x16x32_bf16 v[176:179], v[216:219], v[200:203], v[176:179]
v_mfma_f32_16x16x32_bf16 v[184:187], v[216:219], v[204:207], v[184:187]
v_mfma_f32_16x16x32_bf16 v[188:191], v[220:223], v[204:207], v[188:191]
v_mfma_f32_16x16x32_bf16 v[180:183], v[220:223], v[200:203], v[180:183]
v_mfma_f32_16x16x32_bf16 v[172:175], v[220:223], v[196:199], v[172:175]
v_mfma_f32_16x16x32_bf16 v[164:167], v[220:223], v[192:195], v[164:167]
s_waitcnt vmcnt(0)
s_waitcnt lgkmcnt(0)
s_barrier
v_mfma_f32_16x16x32_bf16 v[128:131], v[48:51], v[32:35], v[128:131]
ds_read_b128 v[96:99], v17 offset:49152
v_mfma_f32_16x16x32_bf16 v[136:139], v[48:51], v[36:39], v[136:139]
ds_read_b64_tr_b16 v[112:113], v13 offset:0
v_mfma_f32_16x16x32_bf16 v[144:147], v[48:51], v[40:43], v[144:147]
ds_read_b64_tr_b16 v[114:115], v13 offset:4096
v_mfma_f32_16x16x32_bf16 v[152:155], v[48:51], v[44:47], v[152:155]
ds_read_b64_tr_b16 v[116:117], v14 offset:0
v_mfma_f32_16x16x32_bf16 v[156:159], v[52:55], v[44:47], v[156:159]
ds_read_b64_tr_b16 v[118:119], v14 offset:4096
v_mfma_f32_16x16x32_bf16 v[148:151], v[52:55], v[40:43], v[148:151]
ds_read_b64_tr_b16 v[120:121], v15 offset:0
v_mfma_f32_16x16x32_bf16 v[140:143], v[52:55], v[36:39], v[140:143]
ds_read_b64_tr_b16 v[122:123], v15 offset:4096
v_mfma_f32_16x16x32_bf16 v[132:135], v[52:55], v[32:35], v[132:135]
ds_read_b64_tr_b16 v[124:125], v16 offset:0
v_mfma_f32_16x16x32_bf16 v[160:163], v[56:59], v[32:35], v[160:163]
ds_read_b64_tr_b16 v[126:127], v16 offset:4096
v_mfma_f32_16x16x32_bf16 v[168:171], v[56:59], v[36:39], v[168:171]
ds_read_b128 v[100:103], v17 offset:50176
v_mfma_f32_16x16x32_bf16 v[176:179], v[56:59], v[40:43], v[176:179]
ds_read_b128 v[104:107], v17 offset:51200
v_mfma_f32_16x16x32_bf16 v[184:187], v[56:59], v[44:47], v[184:187]
ds_read_b128 v[108:111], v17 offset:52224
v_mfma_f32_16x16x32_bf16 v[188:191], v[60:63], v[44:47], v[188:191]
ds_read_b128 v[192:195], v17 offset:57344
v_mfma_f32_16x16x32_bf16 v[180:183], v[60:63], v[40:43], v[180:183]
ds_read_b64_tr_b16 v[208:209], v13 offset:8192
v_mfma_f32_16x16x32_bf16 v[172:175], v[60:63], v[36:39], v[172:175]
ds_read_b64_tr_b16 v[210:211], v13 offset:12288
v_mfma_f32_16x16x32_bf16 v[164:167], v[60:63], v[32:35], v[164:167]
ds_read_b64_tr_b16 v[212:213], v14 offset:8192
v_mfma_f32_16x16x32_bf16 v[128:131], v[80:83], v[64:67], v[128:131]
ds_read_b64_tr_b16 v[214:215], v14 offset:12288
v_mfma_f32_16x16x32_bf16 v[136:139], v[80:83], v[68:71], v[136:139]
ds_read_b64_tr_b16 v[216:217], v15 offset:8192
v_mfma_f32_16x16x32_bf16 v[144:147], v[80:83], v[72:75], v[144:147]
ds_read_b64_tr_b16 v[218:219], v15 offset:12288
v_mfma_f32_16x16x32_bf16 v[152:155], v[80:83], v[76:79], v[152:155]
ds_read_b64_tr_b16 v[220:221], v16 offset:8192
v_mfma_f32_16x16x32_bf16 v[156:159], v[84:87], v[76:79], v[156:159]
ds_read_b64_tr_b16 v[222:223], v16 offset:12288
v_mfma_f32_16x16x32_bf16 v[148:151], v[84:87], v[72:75], v[148:151]
ds_read_b128 v[196:199], v17 offset:58368
v_mfma_f32_16x16x32_bf16 v[140:143], v[84:87], v[68:71], v[140:143]
ds_read_b128 v[200:203], v17 offset:59392
v_mfma_f32_16x16x32_bf16 v[132:135], v[84:87], v[64:67], v[132:135]
ds_read_b128 v[204:207], v17 offset:60416
v_mfma_f32_16x16x32_bf16 v[160:163], v[88:91], v[64:67], v[160:163]
v_mfma_f32_16x16x32_bf16 v[168:171], v[88:91], v[68:71], v[168:171]
v_mfma_f32_16x16x32_bf16 v[176:179], v[88:91], v[72:75], v[176:179]
v_mfma_f32_16x16x32_bf16 v[184:187], v[88:91], v[76:79], v[184:187]
v_mfma_f32_16x16x32_bf16 v[188:191], v[92:95], v[76:79], v[188:191]
v_mfma_f32_16x16x32_bf16 v[180:183], v[92:95], v[72:75], v[180:183]
v_mfma_f32_16x16x32_bf16 v[172:175], v[92:95], v[68:71], v[172:175]
v_mfma_f32_16x16x32_bf16 v[164:167], v[92:95], v[64:67], v[164:167]
s_waitcnt lgkmcnt(0)
s_barrier
v_mfma_f32_16x16x32_bf16 v[128:131], v[112:115], v[96:99], v[128:131]
ds_read_b128 v[32:35], v18 offset:16384
v_mfma_f32_16x16x32_bf16 v[136:139], v[112:115], v[100:103], v[136:139]
ds_read_b64_tr_b16 v[48:49], v25 offset:16384
v_mfma_f32_16x16x32_bf16 v[144:147], v[112:115], v[104:107], v[144:147]
ds_read_b64_tr_b16 v[50:51], v25 offset:20480
v_mfma_f32_16x16x32_bf16 v[152:155], v[112:115], v[108:111], v[152:155]
ds_read_b64_tr_b16 v[52:53], v26 offset:16384
v_mfma_f32_16x16x32_bf16 v[156:159], v[116:119], v[108:111], v[156:159]
ds_read_b64_tr_b16 v[54:55], v26 offset:20480
v_mfma_f32_16x16x32_bf16 v[148:151], v[116:119], v[104:107], v[148:151]
ds_read_b64_tr_b16 v[56:57], v27 offset:16384
v_mfma_f32_16x16x32_bf16 v[140:143], v[116:119], v[100:103], v[140:143]
ds_read_b64_tr_b16 v[58:59], v27 offset:20480
v_mfma_f32_16x16x32_bf16 v[132:135], v[116:119], v[96:99], v[132:135]
ds_read_b64_tr_b16 v[60:61], v28 offset:16384
v_mfma_f32_16x16x32_bf16 v[160:163], v[120:123], v[96:99], v[160:163]
ds_read_b64_tr_b16 v[62:63], v28 offset:20480
v_mfma_f32_16x16x32_bf16 v[168:171], v[120:123], v[100:103], v[168:171]
ds_read_b128 v[36:39], v18 offset:17408
v_mfma_f32_16x16x32_bf16 v[176:179], v[120:123], v[104:107], v[176:179]
ds_read_b128 v[40:43], v18 offset:18432
v_mfma_f32_16x16x32_bf16 v[184:187], v[120:123], v[108:111], v[184:187]
ds_read_b128 v[44:47], v18 offset:19456
v_mfma_f32_16x16x32_bf16 v[188:191], v[124:127], v[108:111], v[188:191]
ds_read_b128 v[64:67], v18 offset:24576
v_mfma_f32_16x16x32_bf16 v[180:183], v[124:127], v[104:107], v[180:183]
ds_read_b64_tr_b16 v[80:81], v25 offset:24576
v_mfma_f32_16x16x32_bf16 v[172:175], v[124:127], v[100:103], v[172:175]
ds_read_b64_tr_b16 v[82:83], v25 offset:28672
v_mfma_f32_16x16x32_bf16 v[164:167], v[124:127], v[96:99], v[164:167]
ds_read_b64_tr_b16 v[84:85], v26 offset:24576
v_mfma_f32_16x16x32_bf16 v[128:131], v[208:211], v[192:195], v[128:131]
ds_read_b64_tr_b16 v[86:87], v26 offset:28672
v_mfma_f32_16x16x32_bf16 v[136:139], v[208:211], v[196:199], v[136:139]
ds_read_b64_tr_b16 v[88:89], v27 offset:24576
v_mfma_f32_16x16x32_bf16 v[144:147], v[208:211], v[200:203], v[144:147]
ds_read_b64_tr_b16 v[90:91], v27 offset:28672
v_mfma_f32_16x16x32_bf16 v[152:155], v[208:211], v[204:207], v[152:155]
ds_read_b64_tr_b16 v[92:93], v28 offset:24576
v_mfma_f32_16x16x32_bf16 v[156:159], v[212:215], v[204:207], v[156:159]
ds_read_b64_tr_b16 v[94:95], v28 offset:28672
v_mfma_f32_16x16x32_bf16 v[148:151], v[212:215], v[200:203], v[148:151]
ds_read_b128 v[68:71], v18 offset:25600
v_mfma_f32_16x16x32_bf16 v[140:143], v[212:215], v[196:199], v[140:143]
ds_read_b128 v[72:75], v18 offset:26624
v_mfma_f32_16x16x32_bf16 v[132:135], v[212:215], v[192:195], v[132:135]
ds_read_b128 v[76:79], v18 offset:27648
v_mfma_f32_16x16x32_bf16 v[160:163], v[216:219], v[192:195], v[160:163]
v_mfma_f32_16x16x32_bf16 v[168:171], v[216:219], v[196:199], v[168:171]
v_mfma_f32_16x16x32_bf16 v[176:179], v[216:219], v[200:203], v[176:179]
v_mfma_f32_16x16x32_bf16 v[184:187], v[216:219], v[204:207], v[184:187]
v_mfma_f32_16x16x32_bf16 v[188:191], v[220:223], v[204:207], v[188:191]
v_mfma_f32_16x16x32_bf16 v[180:183], v[220:223], v[200:203], v[180:183]
v_mfma_f32_16x16x32_bf16 v[172:175], v[220:223], v[196:199], v[172:175]
v_mfma_f32_16x16x32_bf16 v[164:167], v[220:223], v[192:195], v[164:167]
s_waitcnt lgkmcnt(0)
s_barrier
v_mfma_f32_16x16x32_bf16 v[128:131], v[48:51], v[32:35], v[128:131]
ds_read_b128 v[96:99], v18 offset:32768
v_mfma_f32_16x16x32_bf16 v[136:139], v[48:51], v[36:39], v[136:139]
ds_read_b64_tr_b16 v[112:113], v13 offset:49152
v_mfma_f32_16x16x32_bf16 v[144:147], v[48:51], v[40:43], v[144:147]
ds_read_b64_tr_b16 v[114:115], v13 offset:53248
v_mfma_f32_16x16x32_bf16 v[152:155], v[48:51], v[44:47], v[152:155]
ds_read_b64_tr_b16 v[116:117], v14 offset:49152
v_mfma_f32_16x16x32_bf16 v[156:159], v[52:55], v[44:47], v[156:159]
ds_read_b64_tr_b16 v[118:119], v14 offset:53248
v_mfma_f32_16x16x32_bf16 v[148:151], v[52:55], v[40:43], v[148:151]
s_branch Lov_11
.p2align 12
.fill 80, 4, 0xbf800000
Lst_11_0:
s_branch Lwr_151
Lst_11_1:
s_branch Lst_15_0
s_nop 0
Lov_11:
ds_read_b64_tr_b16 v[120:121], v15 offset:49152
v_mfma_f32_16x16x32_bf16 v[140:143], v[52:55], v[36:39], v[140:143]
ds_read_b64_tr_b16 v[122:123], v15 offset:53248
v_mfma_f32_16x16x32_bf16 v[132:135], v[52:55], v[32:35], v[132:135]
ds_read_b64_tr_b16 v[124:125], v16 offset:49152
v_mfma_f32_16x16x32_bf16 v[160:163], v[56:59], v[32:35], v[160:163]
ds_read_b64_tr_b16 v[126:127], v16 offset:53248
v_mfma_f32_16x16x32_bf16 v[168:171], v[56:59], v[36:39], v[168:171]
ds_read_b128 v[100:103], v18 offset:33792
v_mfma_f32_16x16x32_bf16 v[176:179], v[56:59], v[40:43], v[176:179]
ds_read_b128 v[104:107], v18 offset:34816
v_mfma_f32_16x16x32_bf16 v[184:187], v[56:59], v[44:47], v[184:187]
ds_read_b128 v[108:111], v18 offset:35840
v_mfma_f32_16x16x32_bf16 v[188:191], v[60:63], v[44:47], v[188:191]
ds_read_b128 v[192:195], v18 offset:40960
v_mfma_f32_16x16x32_bf16 v[180:183], v[60:63], v[40:43], v[180:183]
ds_read_b64_tr_b16 v[208:209], v13 offset:57344
v_mfma_f32_16x16x32_bf16 v[172:175], v[60:63], v[36:39], v[172:175]
ds_read_b64_tr_b16 v[210:211], v13 offset:61440
v_mfma_f32_16x16x32_bf16 v[164:167], v[60:63], v[32:35], v[164:167]
ds_read_b64_tr_b16 v[212:213], v14 offset:57344
v_mfma_f32_16x16x32_bf16 v[128:131], v[80:83], v[64:67], v[128:131]
ds_read_b64_tr_b16 v[214:215], v14 offset:61440
v_mfma_f32_16x16x32_bf16 v[136:139], v[80:83], v[68:71], v[136:139]
ds_read_b64_tr_b16 v[216:217], v15 offset:57344
v_mfma_f32_16x16x32_bf16 v[144:147], v[80:83], v[72:75], v[144:147]
ds_read_b64_tr_b16 v[218:219], v15 offset:61440
v_mfma_f32_16x16x32_bf16 v[152:155], v[80:83], v[76:79], v[152:155]
ds_read_b64_tr_b16 v[220:221], v16 offset:57344
v_mfma_f32_16x16x32_bf16 v[156:159], v[84:87], v[76:79], v[156:159]
ds_read_b64_tr_b16 v[222:223], v16 offset:61440
v_mfma_f32_16x16x32_bf16 v[148:151], v[84:87], v[72:75], v[148:151]
ds_read_b128 v[196:199], v18 offset:41984
v_mfma_f32_16x16x32_bf16 v[140:143], v[84:87], v[68:71], v[140:143]
ds_read_b128 v[200:203], v18 offset:43008
v_mfma_f32_16x16x32_bf16 v[132:135], v[84:87], v[64:67], v[132:135]
ds_read_b128 v[204:207], v18 offset:44032
v_mfma_f32_16x16x32_bf16 v[160:163], v[88:91], v[64:67], v[160:163]
v_mfma_f32_16x16x32_bf16 v[168:171], v[88:91], v[68:71], v[168:171]
v_mfma_f32_16x16x32_bf16 v[176:179], v[88:91], v[72:75], v[176:179]
v_mfma_f32_16x16x32_bf16 v[184:187], v[88:91], v[76:79], v[184:187]
v_mfma_f32_16x16x32_bf16 v[188:191], v[92:95], v[76:79], v[188:191]
v_mfma_f32_16x16x32_bf16 v[180:183], v[92:95], v[72:75], v[180:183]
v_mfma_f32_16x16x32_bf16 v[172:175], v[92:95], v[68:71], v[172:175]
v_mfma_f32_16x16x32_bf16 v[164:167], v[92:95], v[64:67], v[164:167]
s_waitcnt lgkmcnt(0)
s_barrier
v_mfma_f32_16x16x32_bf16 v[128:131], v[112:115], v[96:99], v[128:131]
ds_read_b128 v[32:35], v19 offset:0
v_mfma_f32_16x16x32_bf16 v[136:139], v[112:115], v[100:103], v[136:139]
ds_read_b64_tr_b16 v[48:49], v9 offset:0
v_mfma_f32_16x16x32_bf16 v[144:147], v[112:115], v[104:107], v[144:147]
ds_read_b64_tr_b16 v[50:51], v9 offset:4096
v_mfma_f32_16x16x32_bf16 v[152:155], v[112:115], v[108:111], v[152:155]
ds_read_b64_tr_b16 v[52:53], v10 offset:0
v_mfma_f32_16x16x32_bf16 v[156:159], v[116:119], v[108:111], v[156:159]
ds_read_b64_tr_b16 v[54:55], v10 offset:4096
v_mfma_f32_16x16x32_bf16 v[148:151], v[116:119], v[104:107], v[148:151]
ds_read_b64_tr_b16 v[56:57], v11 offset:0
v_mfma_f32_16x16x32_bf16 v[140:143], v[116:119], v[100:103], v[140:143]
ds_read_b64_tr_b16 v[58:59], v11 offset:4096
v_mfma_f32_16x16x32_bf16 v[132:135], v[116:119], v[96:99], v[132:135]
ds_read_b64_tr_b16 v[60:61], v12 offset:0
v_mfma_f32_16x16x32_bf16 v[160:163], v[120:123], v[96:99], v[160:163]
ds_read_b64_tr_b16 v[62:63], v12 offset:4096
v_mfma_f32_16x16x32_bf16 v[168:171], v[120:123], v[100:103], v[168:171]
ds_read_b128 v[36:39], v19 offset:1024
v_mfma_f32_16x16x32_bf16 v[176:179], v[120:123], v[104:107], v[176:179]
ds_read_b128 v[40:43], v19 offset:2048
v_mfma_f32_16x16x32_bf16 v[184:187], v[120:123], v[108:111], v[184:187]
ds_read_b128 v[44:47], v19 offset:3072
v_mfma_f32_16x16x32_bf16 v[188:191], v[124:127], v[108:111], v[188:191]
ds_read_b128 v[64:67], v19 offset:8192
v_mfma_f32_16x16x32_bf16 v[180:183], v[124:127], v[104:107], v[180:183]
ds_read_b64_tr_b16 v[80:81], v9 offset:8192
v_mfma_f32_16x16x32_bf16 v[172:175], v[124:127], v[100:103], v[172:175]
ds_read_b64_tr_b16 v[82:83], v9 offset:12288
v_mfma_f32_16x16x32_bf16 v[164:167], v[124:127], v[96:99], v[164:167]
ds_read_b64_tr_b16 v[84:85], v10 offset:8192
v_mfma_f32_16x16x32_bf16 v[128:131], v[208:211], v[192:195], v[128:131]
ds_read_b64_tr_b16 v[86:87], v10 offset:12288
v_mfma_f32_16x16x32_bf16 v[136:139], v[208:211], v[196:199], v[136:139]
ds_read_b64_tr_b16 v[88:89], v11 offset:8192
v_mfma_f32_16x16x32_bf16 v[144:147], v[208:211], v[200:203], v[144:147]
ds_read_b64_tr_b16 v[90:91], v11 offset:12288
v_mfma_f32_16x16x32_bf16 v[152:155], v[208:211], v[204:207], v[152:155]
ds_read_b64_tr_b16 v[92:93], v12 offset:8192
v_mfma_f32_16x16x32_bf16 v[156:159], v[212:215], v[204:207], v[156:159]
ds_read_b64_tr_b16 v[94:95], v12 offset:12288
v_mfma_f32_16x16x32_bf16 v[148:151], v[212:215], v[200:203], v[148:151]
ds_read_b128 v[68:71], v19 offset:9216
v_mfma_f32_16x16x32_bf16 v[140:143], v[212:215], v[196:199], v[140:143]
ds_read_b128 v[72:75], v19 offset:10240
v_mfma_f32_16x16x32_bf16 v[132:135], v[212:215], v[192:195], v[132:135]
ds_read_b128 v[76:79], v19 offset:11264
v_mfma_f32_16x16x32_bf16 v[160:163], v[216:219], v[192:195], v[160:163]
v_mfma_f32_16x16x32_bf16 v[168:171], v[216:219], v[196:199], v[168:171]
v_mfma_f32_16x16x32_bf16 v[176:179], v[216:219], v[200:203], v[176:179]
v_mfma_f32_16x16x32_bf16 v[184:187], v[216:219], v[204:207], v[184:187]
v_mfma_f32_16x16x32_bf16 v[188:191], v[220:223], v[204:207], v[188:191]
v_mfma_f32_16x16x32_bf16 v[180:183], v[220:223], v[200:203], v[180:183]
v_mfma_f32_16x16x32_bf16 v[172:175], v[220:223], v[196:199], v[172:175]
v_mfma_f32_16x16x32_bf16 v[164:167], v[220:223], v[192:195], v[164:167]
s_waitcnt lgkmcnt(0)
s_barrier
v_mfma_f32_16x16x32_bf16 v[128:131], v[48:51], v[32:35], v[128:131]
ds_read_b128 v[96:99], v17 offset:16384
v_mfma_f32_16x16x32_bf16 v[136:139], v[48:51], v[36:39], v[136:139]
ds_read_b64_tr_b16 v[112:113], v9 offset:32768
v_mfma_f32_16x16x32_bf16 v[144:147], v[48:51], v[40:43], v[144:147]
ds_read_b64_tr_b16 v[114:115], v9 offset:36864
v_mfma_f32_16x16x32_bf16 v[152:155], v[48:51], v[44:47], v[152:155]
ds_read_b64_tr_b16 v[116:117], v10 offset:32768
v_mfma_f32_16x16x32_bf16 v[156:159], v[52:55], v[44:47], v[156:159]
ds_read_b64_tr_b16 v[118:119], v10 offset:36864
v_mfma_f32_16x16x32_bf16 v[148:151], v[52:55], v[40:43], v[148:151]
ds_read_b64_tr_b16 v[120:121], v11 offset:32768
v_mfma_f32_16x16x32_bf16 v[140:143], v[52:55], v[36:39], v[140:143]
ds_read_b64_tr_b16 v[122:123], v11 offset:36864
v_mfma_f32_16x16x32_bf16 v[132:135], v[52:55], v[32:35], v[132:135]
ds_read_b64_tr_b16 v[124:125], v12 offset:32768
v_mfma_f32_16x16x32_bf16 v[160:163], v[56:59], v[32:35], v[160:163]
ds_read_b64_tr_b16 v[126:127], v12 offset:36864
v_mfma_f32_16x16x32_bf16 v[168:171], v[56:59], v[36:39], v[168:171]
ds_read_b128 v[100:103], v17 offset:17408
v_mfma_f32_16x16x32_bf16 v[176:179], v[56:59], v[40:43], v[176:179]
ds_read_b128 v[104:107], v17 offset:18432
v_mfma_f32_16x16x32_bf16 v[184:187], v[56:59], v[44:47], v[184:187]
ds_read_b128 v[108:111], v17 offset:19456
v_mfma_f32_16x16x32_bf16 v[188:191], v[60:63], v[44:47], v[188:191]
ds_read_b128 v[192:195], v17 offset:24576
v_mfma_f32_16x16x32_bf16 v[180:183], v[60:63], v[40:43], v[180:183]
ds_read_b64_tr_b16 v[208:209], v9 offset:40960
v_mfma_f32_16x16x32_bf16 v[172:175], v[60:63], v[36:39], v[172:175]
ds_read_b64_tr_b16 v[210:211], v9 offset:45056
v_mfma_f32_16x16x32_bf16 v[164:167], v[60:63], v[32:35], v[164:167]
ds_read_b64_tr_b16 v[212:213], v10 offset:40960
v_mfma_f32_16x16x32_bf16 v[128:131], v[80:83], v[64:67], v[128:131]
ds_read_b64_tr_b16 v[214:215], v10 offset:45056
v_mfma_f32_16x16x32_bf16 v[136:139], v[80:83], v[68:71], v[136:139]
ds_read_b64_tr_b16 v[216:217], v11 offset:40960
v_mfma_f32_16x16x32_bf16 v[144:147], v[80:83], v[72:75], v[144:147]
ds_read_b64_tr_b16 v[218:219], v11 offset:45056
v_mfma_f32_16x16x32_bf16 v[152:155], v[80:83], v[76:79], v[152:155]
ds_read_b64_tr_b16 v[220:221], v12 offset:40960
v_mfma_f32_16x16x32_bf16 v[156:159], v[84:87], v[76:79], v[156:159]
ds_read_b64_tr_b16 v[222:223], v12 offset:45056
v_mfma_f32_16x16x32_bf16 v[148:151], v[84:87], v[72:75], v[148:151]
ds_read_b128 v[196:199], v17 offset:25600
v_mfma_f32_16x16x32_bf16 v[140:143], v[84:87], v[68:71], v[140:143]
ds_read_b128 v[200:203], v17 offset:26624
v_mfma_f32_16x16x32_bf16 v[132:135], v[84:87], v[64:67], v[132:135]
ds_read_b128 v[204:207], v17 offset:27648
v_mfma_f32_16x16x32_bf16 v[160:163], v[88:91], v[64:67], v[160:163]
v_mfma_f32_16x16x32_bf16 v[168:171], v[88:91], v[68:71], v[168:171]
v_mfma_f32_16x16x32_bf16 v[176:179], v[88:91], v[72:75], v[176:179]
v_mfma_f32_16x16x32_bf16 v[184:187], v[88:91], v[76:79], v[184:187]
v_mfma_f32_16x16x32_bf16 v[188:191], v[92:95], v[76:79], v[188:191]
v_mfma_f32_16x16x32_bf16 v[180:183], v[92:95], v[72:75], v[180:183]
v_mfma_f32_16x16x32_bf16 v[172:175], v[92:95], v[68:71], v[172:175]
v_mfma_f32_16x16x32_bf16 v[164:167], v[92:95], v[64:67], v[164:167]
s_waitcnt lgkmcnt(0)
s_barrier
v_mfma_f32_16x16x32_bf16 v[128:131], v[112:115], v[96:99], v[128:131]
ds_read_b128 v[32:35], v17 offset:49152
v_mfma_f32_16x16x32_bf16 v[136:139], v[112:115], v[100:103], v[136:139]
ds_read_b64_tr_b16 v[48:49], v13 offset:0
v_mfma_f32_16x16x32_bf16 v[144:147], v[112:115], v[104:107], v[144:147]
ds_read_b64_tr_b16 v[50:51], v13 offset:4096
v_mfma_f32_16x16x32_bf16 v[152:155], v[112:115], v[108:111], v[152:155]
ds_read_b64_tr_b16 v[52:53], v14 offset:0
v_mfma_f32_16x16x32_bf16 v[156:159], v[116:119], v[108:111], v[156:159]
ds_read_b64_tr_b16 v[54:55], v14 offset:4096
v_mfma_f32_16x16x32_bf16 v[148:151], v[116:119], v[104:107], v[148:151]
ds_read_b64_tr_b16 v[56:57], v15 offset:0
v_mfma_f32_16x16x32_bf16 v[140:143], v[116:119], v[100:103], v[140:143]
ds_read_b64_tr_b16 v[58:59], v15 offset:4096
v_mfma_f32_16x16x32_bf16 v[132:135], v[116:119], v[96:99], v[132:135]
ds_read_b64_tr_b16 v[60:61], v16 offset:0
v_mfma_f32_16x16x32_bf16 v[160:163], v[120:123], v[96:99], v[160:163]
ds_read_b64_tr_b16 v[62:63], v16 offset:4096
v_mfma_f32_16x16x32_bf16 v[168:171], v[120:123], v[100:103], v[168:171]
ds_read_b128 v[36:39], v17 offset:50176
v_mfma_f32_16x16x32_bf16 v[176:179], v[120:123], v[104:107], v[176:179]
ds_read_b128 v[40:43], v17 offset:51200
v_mfma_f32_16x16x32_bf16 v[184:187], v[120:123], v[108:111], v[184:187]
ds_read_b128 v[44:47], v17 offset:52224
v_mfma_f32_16x16x32_bf16 v[188:191], v[124:127], v[108:111], v[188:191]
ds_read_b128 v[64:67], v17 offset:57344
v_mfma_f32_16x16x32_bf16 v[180:183], v[124:127], v[104:107], v[180:183]
ds_read_b64_tr_b16 v[80:81], v13 offset:8192
v_mfma_f32_16x16x32_bf16 v[172:175], v[124:127], v[100:103], v[172:175]
ds_read_b64_tr_b16 v[82:83], v13 offset:12288
v_mfma_f32_16x16x32_bf16 v[164:167], v[124:127], v[96:99], v[164:167]
ds_read_b64_tr_b16 v[84:85], v14 offset:8192
v_mfma_f32_16x16x32_bf16 v[128:131], v[208:211], v[192:195], v[128:131]
ds_read_b64_tr_b16 v[86:87], v14 offset:12288
v_mfma_f32_16x16x32_bf16 v[136:139], v[208:211], v[196:199], v[136:139]
ds_read_b64_tr_b16 v[88:89], v15 offset:8192
v_mfma_f32_16x16x32_bf16 v[144:147], v[208:211], v[200:203], v[144:147]
ds_read_b64_tr_b16 v[90:91], v15 offset:12288
v_mfma_f32_16x16x32_bf16 v[152:155], v[208:211], v[204:207], v[152:155]
ds_read_b64_tr_b16 v[92:93], v16 offset:8192
v_mfma_f32_16x16x32_bf16 v[156:159], v[212:215], v[204:207], v[156:159]
ds_read_b64_tr_b16 v[94:95], v16 offset:12288
v_mfma_f32_16x16x32_bf16 v[148:151], v[212:215], v[200:203], v[148:151]
ds_read_b128 v[68:71], v17 offset:58368
v_mfma_f32_16x16x32_bf16 v[140:143], v[212:215], v[196:199], v[140:143]
ds_read_b128 v[72:75], v17 offset:59392
v_mfma_f32_16x16x32_bf16 v[132:135], v[212:215], v[192:195], v[132:135]
ds_read_b128 v[76:79], v17 offset:60416
v_mfma_f32_16x16x32_bf16 v[160:163], v[216:219], v[192:195], v[160:163]
v_mfma_f32_16x16x32_bf16 v[168:171], v[216:219], v[196:199], v[168:171]
v_mfma_f32_16x16x32_bf16 v[176:179], v[216:219], v[200:203], v[176:179]
v_mfma_f32_16x16x32_bf16 v[184:187], v[216:219], v[204:207], v[184:187]
v_mfma_f32_16x16x32_bf16 v[188:191], v[220:223], v[204:207], v[188:191]
v_mfma_f32_16x16x32_bf16 v[180:183], v[220:223], v[200:203], v[180:183]
v_mfma_f32_16x16x32_bf16 v[172:175], v[220:223], v[196:199], v[172:175]
v_mfma_f32_16x16x32_bf16 v[164:167], v[220:223], v[192:195], v[164:167]
s_waitcnt lgkmcnt(0)
s_barrier
v_mfma_f32_16x16x32_bf16 v[128:131], v[48:51], v[32:35], v[128:131]
ds_read_b128 v[96:99], v18 offset:16384
v_mfma_f32_16x16x32_bf16 v[136:139], v[48:51], v[36:39], v[136:139]
ds_read_b64_tr_b16 v[112:113], v25 offset:16384
v_mfma_f32_16x16x32_bf16 v[144:147], v[48:51], v[40:43], v[144:147]
ds_read_b64_tr_b16 v[114:115], v25 offset:20480
v_mfma_f32_16x16x32_bf16 v[152:155], v[48:51], v[44:47], v[152:155]
ds_read_b64_tr_b16 v[116:117], v26 offset:16384
v_mfma_f32_16x16x32_bf16 v[156:159], v[52:55], v[44:47], v[156:159]
ds_read_b64_tr_b16 v[118:119], v26 offset:20480
v_mfma_f32_16x16x32_bf16 v[148:151], v[52:55], v[40:43], v[148:151]
ds_read_b64_tr_b16 v[120:121], v27 offset:16384
v_mfma_f32_16x16x32_bf16 v[140:143], v[52:55], v[36:39], v[140:143]
ds_read_b64_tr_b16 v[122:123], v27 offset:20480
v_mfma_f32_16x16x32_bf16 v[132:135], v[52:55], v[32:35], v[132:135]
ds_read_b64_tr_b16 v[124:125], v28 offset:16384
v_mfma_f32_16x16x32_bf16 v[160:163], v[56:59], v[32:35], v[160:163]
ds_read_b64_tr_b16 v[126:127], v28 offset:20480
v_mfma_f32_16x16x32_bf16 v[168:171], v[56:59], v[36:39], v[168:171]
ds_read_b128 v[100:103], v18 offset:17408
v_mfma_f32_16x16x32_bf16 v[176:179], v[56:59], v[40:43], v[176:179]
ds_read_b128 v[104:107], v18 offset:18432
v_mfma_f32_16x16x32_bf16 v[184:187], v[56:59], v[44:47], v[184:187]
ds_read_b128 v[108:111], v18 offset:19456
v_mfma_f32_16x16x32_bf16 v[188:191], v[60:63], v[44:47], v[188:191]
ds_read_b128 v[192:195], v18 offset:24576
v_mfma_f32_16x16x32_bf16 v[180:183], v[60:63], v[40:43], v[180:183]
ds_read_b64_tr_b16 v[208:209], v25 offset:24576
v_mfma_f32_16x16x32_bf16 v[172:175], v[60:63], v[36:39], v[172:175]
ds_read_b64_tr_b16 v[210:211], v25 offset:28672
v_mfma_f32_16x16x32_bf16 v[164:167], v[60:63], v[32:35], v[164:167]
ds_read_b64_tr_b16 v[212:213], v26 offset:24576
v_mfma_f32_16x16x32_bf16 v[128:131], v[80:83], v[64:67], v[128:131]
ds_read_b64_tr_b16 v[214:215], v26 offset:28672
v_mfma_f32_16x16x32_bf16 v[136:139], v[80:83], v[68:71], v[136:139]
ds_read_b64_tr_b16 v[216:217], v27 offset:24576
v_mfma_f32_16x16x32_bf16 v[144:147], v[80:83], v[72:75], v[144:147]
ds_read_b64_tr_b16 v[218:219], v27 offset:28672
v_mfma_f32_16x16x32_bf16 v[152:155], v[80:83], v[76:79], v[152:155]
ds_read_b64_tr_b16 v[220:221], v28 offset:24576
v_mfma_f32_16x16x32_bf16 v[156:159], v[84:87], v[76:79], v[156:159]
ds_read_b64_tr_b16 v[222:223], v28 offset:28672
v_mfma_f32_16x16x32_bf16 v[148:151], v[84:87], v[72:75], v[148:151]
ds_read_b128 v[196:199], v18 offset:25600
v_mfma_f32_16x16x32_bf16 v[140:143], v[84:87], v[68:71], v[140:143]
ds_read_b128 v[200:203], v18 offset:26624
v_mfma_f32_16x16x32_bf16 v[132:135], v[84:87], v[64:67], v[132:135]
ds_read_b128 v[204:207], v18 offset:27648
v_mfma_f32_16x16x32_bf16 v[160:163], v[88:91], v[64:67], v[160:163]
v_mfma_f32_16x16x32_bf16 v[168:171], v[88:91], v[68:71], v[168:171]
v_mfma_f32_16x16x32_bf16 v[176:179], v[88:91], v[72:75], v[176:179]
v_mfma_f32_16x16x32_bf16 v[184:187], v[88:91], v[76:79], v[184:187]
v_mfma_f32_16x16x32_bf16 v[188:191], v[92:95], v[76:79], v[188:191]
v_mfma_f32_16x16x32_bf16 v[180:183], v[92:95], v[72:75], v[180:183]
v_mfma_f32_16x16x32_bf16 v[172:175], v[92:95], v[68:71], v[172:175]
v_mfma_f32_16x16x32_bf16 v[164:167], v[92:95], v[64:67], v[164:167]
s_waitcnt lgkmcnt(0)
s_barrier
v_mfma_f32_16x16x32_bf16 v[128:131], v[112:115], v[96:99], v[128:131]
ds_read_b128 v[32:35], v18 offset:32768
v_mfma_f32_16x16x32_bf16 v[136:139], v[112:115], v[100:103], v[136:139]
ds_read_b64_tr_b16 v[48:49], v13 offset:49152
v_mfma_f32_16x16x32_bf16 v[144:147], v[112:115], v[104:107], v[144:147]
ds_read_b64_tr_b16 v[50:51], v13 offset:53248
v_mfma_f32_16x16x32_bf16 v[152:155], v[112:115], v[108:111], v[152:155]
ds_read_b64_tr_b16 v[52:53], v14 offset:49152
v_mfma_f32_16x16x32_bf16 v[156:159], v[116:119], v[108:111], v[156:159]
ds_read_b64_tr_b16 v[54:55], v14 offset:53248
v_mfma_f32_16x16x32_bf16 v[148:151], v[116:119], v[104:107], v[148:151]
ds_read_b64_tr_b16 v[56:57], v15 offset:49152
v_mfma_f32_16x16x32_bf16 v[140:143], v[116:119], v[100:103], v[140:143]
ds_read_b64_tr_b16 v[58:59], v15 offset:53248
v_mfma_f32_16x16x32_bf16 v[132:135], v[116:119], v[96:99], v[132:135]
ds_read_b64_tr_b16 v[60:61], v16 offset:49152
v_mfma_f32_16x16x32_bf16 v[160:163], v[120:123], v[96:99], v[160:163]
ds_read_b64_tr_b16 v[62:63], v16 offset:53248
v_mfma_f32_16x16x32_bf16 v[168:171], v[120:123], v[100:103], v[168:171]
ds_read_b128 v[36:39], v18 offset:33792
v_mfma_f32_16x16x32_bf16 v[176:179], v[120:123], v[104:107], v[176:179]
ds_read_b128 v[40:43], v18 offset:34816
v_mfma_f32_16x16x32_bf16 v[184:187], v[120:123], v[108:111], v[184:187]
ds_read_b128 v[44:47], v18 offset:35840
v_mfma_f32_16x16x32_bf16 v[188:191], v[124:127], v[108:111], v[188:191]
ds_read_b128 v[64:67], v18 offset:40960
v_mfma_f32_16x16x32_bf16 v[180:183], v[124:127], v[104:107], v[180:183]
ds_read_b64_tr_b16 v[80:81], v13 offset:57344
v_mfma_f32_16x16x32_bf16 v[172:175], v[124:127], v[100:103], v[172:175]
ds_read_b64_tr_b16 v[82:83], v13 offset:61440
v_mfma_f32_16x16x32_bf16 v[164:167], v[124:127], v[96:99], v[164:167]
ds_read_b64_tr_b16 v[84:85], v14 offset:57344
v_mfma_f32_16x16x32_bf16 v[128:131], v[208:211], v[192:195], v[128:131]
ds_read_b64_tr_b16 v[86:87], v14 offset:61440
v_mfma_f32_16x16x32_bf16 v[136:139], v[208:211], v[196:199], v[136:139]
ds_read_b64_tr_b16 v[88:89], v15 offset:57344
v_mfma_f32_16x16x32_bf16 v[144:147], v[208:211], v[200:203], v[144:147]
ds_read_b64_tr_b16 v[90:91], v15 offset:61440
v_mfma_f32_16x16x32_bf16 v[152:155], v[208:211], v[204:207], v[152:155]
ds_read_b64_tr_b16 v[92:93], v16 offset:57344
v_mfma_f32_16x16x32_bf16 v[156:159], v[212:215], v[204:207], v[156:159]
ds_read_b64_tr_b16 v[94:95], v16 offset:61440
v_mfma_f32_16x16x32_bf16 v[148:151], v[212:215], v[200:203], v[148:151]
ds_read_b128 v[68:71], v18 offset:41984
v_mfma_f32_16x16x32_bf16 v[140:143], v[212:215], v[196:199], v[140:143]
ds_read_b128 v[72:75], v18 offset:43008
v_mfma_f32_16x16x32_bf16 v[132:135], v[212:215], v[192:195], v[132:135]
ds_read_b128 v[76:79], v18 offset:44032
v_mfma_f32_16x16x32_bf16 v[160:163], v[216:219], v[192:195], v[160:163]
v_mfma_f32_16x16x32_bf16 v[168:171], v[216:219], v[196:199], v[168:171]
v_mfma_f32_16x16x32_bf16 v[176:179], v[216:219], v[200:203], v[176:179]
v_mfma_f32_16x16x32_bf16 v[184:187], v[216:219], v[204:207], v[184:187]
v_mfma_f32_16x16x32_bf16 v[188:191], v[220:223], v[204:207], v[188:191]
v_mfma_f32_16x16x32_bf16 v[180:183], v[220:223], v[200:203], v[180:183]
v_mfma_f32_16x16x32_bf16 v[172:175], v[220:223], v[196:199], v[172:175]
v_mfma_f32_16x16x32_bf16 v[164:167], v[220:223], v[192:195], v[164:167]
s_waitcnt lgkmcnt(0)
s_barrier
v_mfma_f32_16x16x32_bf16 v[128:131], v[48:51], v[32:35], v[128:131]
ds_read_b128 v[96:99], v19 offset:0
v_mfma_f32_16x16x32_bf16 v[136:139], v[48:51], v[36:39], v[136:139]
ds_read_b64_tr_b16 v[112:113], v9 offset:0
v_mfma_f32_16x16x32_bf16 v[144:147], v[48:51], v[40:43], v[144:147]
ds_read_b64_tr_b16 v[114:115], v9 offset:4096
v_mfma_f32_16x16x32_bf16 v[152:155], v[48:51], v[44:47], v[152:155]
ds_read_b64_tr_b16 v[116:117], v10 offset:0
v_mfma_f32_16x16x32_bf16 v[156:159], v[52:55], v[44:47], v[156:159]
ds_read_b64_tr_b16 v[118:119], v10 offset:4096
v_mfma_f32_16x16x32_bf16 v[148:151], v[52:55], v[40:43], v[148:151]
ds_read_b64_tr_b16 v[120:121], v11 offset:0
v_mfma_f32_16x16x32_bf16 v[140:143], v[52:55], v[36:39], v[140:143]
ds_read_b64_tr_b16 v[122:123], v11 offset:4096
v_mfma_f32_16x16x32_bf16 v[132:135], v[52:55], v[32:35], v[132:135]
ds_read_b64_tr_b16 v[124:125], v12 offset:0
v_mfma_f32_16x16x32_bf16 v[160:163], v[56:59], v[32:35], v[160:163]
ds_read_b64_tr_b16 v[126:127], v12 offset:4096
v_mfma_f32_16x16x32_bf16 v[168:171], v[56:59], v[36:39], v[168:171]
ds_read_b128 v[100:103], v19 offset:1024
v_mfma_f32_16x16x32_bf16 v[176:179], v[56:59], v[40:43], v[176:179]
ds_read_b128 v[104:107], v19 offset:2048
v_mfma_f32_16x16x32_bf16 v[184:187], v[56:59], v[44:47], v[184:187]
ds_read_b128 v[108:111], v19 offset:3072
v_mfma_f32_16x16x32_bf16 v[188:191], v[60:63], v[44:47], v[188:191]
ds_read_b128 v[192:195], v19 offset:8192
v_mfma_f32_16x16x32_bf16 v[180:183], v[60:63], v[40:43], v[180:183]
ds_read_b64_tr_b16 v[208:209], v9 offset:8192
v_mfma_f32_16x16x32_bf16 v[172:175], v[60:63], v[36:39], v[172:175]
ds_read_b64_tr_b16 v[210:211], v9 offset:12288
v_mfma_f32_16x16x32_bf16 v[164:167], v[60:63], v[32:35], v[164:167]
ds_read_b64_tr_b16 v[212:213], v10 offset:8192
v_mfma_f32_16x16x32_bf16 v[128:131], v[80:83], v[64:67], v[128:131]
ds_read_b64_tr_b16 v[214:215], v10 offset:12288
v_mfma_f32_16x16x32_bf16 v[136:139], v[80:83], v[68:71], v[136:139]
ds_read_b64_tr_b16 v[216:217], v11 offset:8192
v_mfma_f32_16x16x32_bf16 v[144:147], v[80:83], v[72:75], v[144:147]
ds_read_b64_tr_b16 v[218:219], v11 offset:12288
v_mfma_f32_16x16x32_bf16 v[152:155], v[80:83], v[76:79], v[152:155]
ds_read_b64_tr_b16 v[220:221], v12 offset:8192
v_mfma_f32_16x16x32_bf16 v[156:159], v[84:87], v[76:79], v[156:159]
ds_read_b64_tr_b16 v[222:223], v12 offset:12288
v_mfma_f32_16x16x32_bf16 v[148:151], v[84:87], v[72:75], v[148:151]
ds_read_b128 v[196:199], v19 offset:9216
v_mfma_f32_16x16x32_bf16 v[140:143], v[84:87], v[68:71], v[140:143]
ds_read_b128 v[200:203], v19 offset:10240
v_mfma_f32_16x16x32_bf16 v[132:135], v[84:87], v[64:67], v[132:135]
ds_read_b128 v[204:207], v19 offset:11264
v_mfma_f32_16x16x32_bf16 v[160:163], v[88:91], v[64:67], v[160:163]
v_mfma_f32_16x16x32_bf16 v[168:171], v[88:91], v[68:71], v[168:171]
v_mfma_f32_16x16x32_bf16 v[176:179], v[88:91], v[72:75], v[176:179]
v_mfma_f32_16x16x32_bf16 v[184:187], v[88:91], v[76:79], v[184:187]
v_mfma_f32_16x16x32_bf16 v[188:191], v[92:95], v[76:79], v[188:191]
v_mfma_f32_16x16x32_bf16 v[180:183], v[92:95], v[72:75], v[180:183]
v_mfma_f32_16x16x32_bf16 v[172:175], v[92:95], v[68:71], v[172:175]
v_mfma_f32_16x16x32_bf16 v[164:167], v[92:95], v[64:67], v[164:167]
s_sub_u32 s41, s41, 1
s_cmp_lg_u32 s41, 0
s_cbranch_scc1 Lk4_116
s_waitcnt lgkmcnt(0)
s_barrier
v_mfma_f32_16x16x32_bf16 v[128:131], v[112:115], v[96:99], v[128:131]
ds_read_b128 v[32:35], v17 offset:16384
v_mfma_f32_16x16x32_bf16 v[136:139], v[112:115], v[100:103], v[136:139]
ds_read_b64_tr_b16 v[48:49], v224 offset:32768
v_mfma_f32_16x16x32_bf16 v[144:147], v[112:115], v[104:107], v[144:147]
ds_read_b64_tr_b16 v[50:51], v224 offset:34816
v_mfma_f32_16x16x32_bf16 v[152:155], v[112:115], v[108:111], v[152:155]
ds_read_b64_tr_b16 v[52:53], v225 offset:32768
v_mfma_f32_16x16x32_bf16 v[156:159], v[116:119], v[108:111], v[156:159]
ds_read_b64_tr_b16 v[54:55], v225 offset:34816
v_mfma_f32_16x16x32_bf16 v[148:151], v[116:119], v[104:107], v[148:151]
ds_read_b128 v[36:39], v17 offset:17408
v_mfma_f32_16x16x32_bf16 v[140:143], v[116:119], v[100:103], v[140:143]
ds_read_b128 v[40:43], v17 offset:18432
v_mfma_f32_16x16x32_bf16 v[132:135], v[116:119], v[96:99], v[132:135]
ds_read_b128 v[44:47], v17 offset:19456
v_mfma_f32_16x16x32_bf16 v[160:163], v[120:123], v[96:99], v[160:163]
ds_read_b128 v[64:67], v17 offset:24576
v_mfma_f32_16x16x32_bf16 v[168:171], v[120:123], v[100:103], v[168:171]
ds_read_b64_tr_b16 v[80:81], v224 offset:36864
v_mfma_f32_16x16x32_bf16 v[176:179], v[120:123], v[104:107], v[176:179]
ds_read_b64_tr_b16 v[82:83], v224 offset:38912
v_mfma_f32_16x16x32_bf16 v[184:187], v[120:123], v[108:111], v[184:187]
ds_read_b64_tr_b16 v[84:85], v225 offset:36864
v_mfma_f32_16x16x32_bf16 v[188:191], v[124:127], v[108:111], v[188:191]
ds_read_b64_tr_b16 v[86:87], v225 offset:38912
v_mfma_f32_16x16x32_bf16 v[180:183], v[124:127], v[104:107], v[180:183]
ds_read_b128 v[68:71], v17 offset:25600
v_mfma_f32_16x16x32_bf16 v[172:175], v[124:127], v[100:103], v[172:175]
ds_read_b128 v[72:75], v17 offset:26624
v_mfma_f32_16x16x32_bf16 v[164:167], v[124:127], v[96:99], v[164:167]
ds_read_b128 v[76:79], v17 offset:27648
v_mfma_f32_16x16x32_bf16 v[128:131], v[208:211], v[192:195], v[128:131]
v_mfma_f32_16x16x32_bf16 v[136:139], v[208:211], v[196:199], v[136:139]
v_mfma_f32_16x16x32_bf16 v[144:147], v[208:211], v[200:203], v[144:147]
v_mfma_f32_16x16x32_bf16 v[152:155], v[208:211], v[204:207], v[152:155]
v_mfma_f32_16x16x32_bf16 v[156:159], v[212:215], v[204:207], v[156:159]
v_mfma_f32_16x16x32_bf16 v[148:151], v[212:215], v[200:203], v[148:151]
v_mfma_f32_16x16x32_bf16 v[140:143], v[212:215], v[196:199], v[140:143]
v_mfma_f32_16x16x32_bf16 v[132:135], v[212:215], v[192:195], v[132:135]
v_mfma_f32_16x16x32_bf16 v[160:163], v[216:219], v[192:195], v[160:163]
v_mfma_f32_16x16x32_bf16 v[168:171], v[216:219], v[196:199], v[168:171]
v_mfma_f32_16x16x32_bf16 v[176:179], v[216:219], v[200:203], v[176:179]
v_mfma_f32_16x16x32_bf16 v[184:187], v[216:219], v[204:207], v[184:187]
v_mfma_f32_16x16x32_bf16 v[188:191], v[220:223], v[204:207], v[188:191]
v_mfma_f32_16x16x32_bf16 v[180:183], v[220:223], v[200:203], v[180:183]
v_mfma_f32_16x16x32_bf16 v[172:175], v[220:223], v[196:199], v[172:175]
v_mfma_f32_16x16x32_bf16 v[164:167], v[220:223], v[192:195], v[164:167]
s_waitcnt lgkmcnt(0)
s_barrier
v_mfma_f32_16x16x32_bf16 v[128:131], v[48:51], v[32:35], v[128:131]
ds_read_b128 v[96:99], v17 offset:49152
ds_read_b64_tr_b16 v[112:113], v226 offset:0
v_mfma_f32_16x16x32_bf16 v[136:139], v[48:51], v[36:39], v[136:139]
ds_read_b64_tr_b16 v[114:115], v226 offset:2048
ds_read_b64_tr_b16 v[116:117], v227 offset:0
v_mfma_f32_16x16x32_bf16 v[144:147], v[48:51], v[40:43], v[144:147]
ds_read_b64_tr_b16 v[118:119], v227 offset:2048
ds_read_b128 v[100:103], v17 offset:50176
v_mfma_f32_16x16x32_bf16 v[152:155], v[48:51], v[44:47], v[152:155]
ds_read_b128 v[104:107], v17 offset:51200
ds_read_b128 v[108:111], v17 offset:52224
v_mfma_f32_16x16x32_bf16 v[156:159], v[52:55], v[44:47], v[156:159]
ds_read_b128 v[192:195], v17 offset:57344
v_mfma_f32_16x16x32_bf16 v[148:151], v[52:55], v[40:43], v[148:151]
ds_read_b64_tr_b16 v[208:209], v226 offset:4096
v_mfma_f32_16x16x32_bf16 v[140:143], v[52:55], v[36:39], v[140:143]
ds_read_b64_tr_b16 v[210:211], v226 offset:6144
v_cvt_pk_bf16_f32 v160, v160, v161
v_cvt_pk_bf16_f32 v161, v162, v163
v_mfma_f32_16x16x32_bf16 v[132:135], v[52:55], v[32:35], v[132:135]
ds_read_b64_tr_b16 v[212:213], v227 offset:4096
v_cvt_pk_bf16_f32 v162, v164, v165
v_cvt_pk_bf16_f32 v163, v166, v167
v_mfma_f32_16x16x32_bf16 v[128:131], v[80:83], v[64:67], v[128:131]
ds_read_b64_tr_b16 v[214:215], v227 offset:6144
v_cvt_pk_bf16_f32 v164, v168, v169
v_cvt_pk_bf16_f32 v165, v170, v171
v_mfma_f32_16x16x32_bf16 v[136:139], v[80:83], v[68:71], v[136:139]
ds_read_b128 v[196:199], v17 offset:58368
v_cvt_pk_bf16_f32 v166, v172, v173
s_branch Lov_12
.p2align 12
.fill 96, 4, 0xbf800000
Lst_12_0:
s_branch Lwr_152
Lst_12_1:
s_branch Lst_16_0
s_nop 0
Lov_12:
v_cvt_pk_bf16_f32 v167, v174, v175
v_mfma_f32_16x16x32_bf16 v[144:147], v[80:83], v[72:75], v[144:147]
ds_read_b128 v[200:203], v17 offset:59392
v_cvt_pk_bf16_f32 v168, v176, v177
v_cvt_pk_bf16_f32 v169, v178, v179
v_mfma_f32_16x16x32_bf16 v[152:155], v[80:83], v[76:79], v[152:155]
ds_read_b128 v[204:207], v17 offset:60416
v_cvt_pk_bf16_f32 v170, v180, v181
v_cvt_pk_bf16_f32 v171, v182, v183
v_mfma_f32_16x16x32_bf16 v[156:159], v[84:87], v[76:79], v[156:159]
v_cvt_pk_bf16_f32 v172, v184, v185
v_cvt_pk_bf16_f32 v173, v186, v187
v_mfma_f32_16x16x32_bf16 v[148:151], v[84:87], v[72:75], v[148:151]
v_cvt_pk_bf16_f32 v174, v188, v189
v_cvt_pk_bf16_f32 v175, v190, v191
v_mfma_f32_16x16x32_bf16 v[140:143], v[84:87], v[68:71], v[140:143]
v_mfma_f32_16x16x32_bf16 v[132:135], v[84:87], v[64:67], v[132:135]
buffer_store_dwordx4 v[160:163], v2, s[84:87], s45 offen offset:0 sc1
s_waitcnt lgkmcnt(0)
s_barrier
v_mfma_f32_16x16x32_bf16 v[128:131], v[112:115], v[96:99], v[128:131]
ds_read_b128 v[32:35], v18 offset:16384
ds_read_b64_tr_b16 v[48:49], v228 offset:16384
v_mfma_f32_16x16x32_bf16 v[136:139], v[112:115], v[100:103], v[136:139]
ds_read_b64_tr_b16 v[50:51], v228 offset:18432
ds_read_b64_tr_b16 v[52:53], v229 offset:16384
v_mfma_f32_16x16x32_bf16 v[144:147], v[112:115], v[104:107], v[144:147]
ds_read_b64_tr_b16 v[54:55], v229 offset:18432
ds_read_b128 v[36:39], v18 offset:17408
v_mfma_f32_16x16x32_bf16 v[152:155], v[112:115], v[108:111], v[152:155]
ds_read_b128 v[40:43], v18 offset:18432
ds_read_b128 v[44:47], v18 offset:19456
v_mfma_f32_16x16x32_bf16 v[156:159], v[116:119], v[108:111], v[156:159]
ds_read_b128 v[64:67], v18 offset:24576
v_mfma_f32_16x16x32_bf16 v[148:151], v[116:119], v[104:107], v[148:151]
ds_read_b64_tr_b16 v[80:81], v228 offset:20480
v_mfma_f32_16x16x32_bf16 v[140:143], v[116:119], v[100:103], v[140:143]
ds_read_b64_tr_b16 v[82:83], v228 offset:22528
v_mfma_f32_16x16x32_bf16 v[132:135], v[116:119], v[96:99], v[132:135]
ds_read_b64_tr_b16 v[84:85], v229 offset:20480
v_mfma_f32_16x16x32_bf16 v[128:131], v[208:211], v[192:195], v[128:131]
ds_read_b64_tr_b16 v[86:87], v229 offset:22528
buffer_store_dwordx4 v[164:167], v2, s[84:87], s45 offen offset:1024 sc1
v_mfma_f32_16x16x32_bf16 v[136:139], v[208:211], v[196:199], v[136:139]
ds_read_b128 v[68:71], v18 offset:25600
v_mfma_f32_16x16x32_bf16 v[144:147], v[208:211], v[200:203], v[144:147]
ds_read_b128 v[72:75], v18 offset:26624
v_mfma_f32_16x16x32_bf16 v[152:155], v[208:211], v[204:207], v[152:155]
ds_read_b128 v[76:79], v18 offset:27648
v_mfma_f32_16x16x32_bf16 v[156:159], v[212:215], v[204:207], v[156:159]
v_mfma_f32_16x16x32_bf16 v[148:151], v[212:215], v[200:203], v[148:151]
v_mfma_f32_16x16x32_bf16 v[140:143], v[212:215], v[196:199], v[140:143]
v_mfma_f32_16x16x32_bf16 v[132:135], v[212:215], v[192:195], v[132:135]
s_waitcnt lgkmcnt(0)
s_barrier
v_mfma_f32_16x16x32_bf16 v[128:131], v[48:51], v[32:35], v[128:131]
ds_read_b128 v[96:99], v18 offset:32768
ds_read_b64_tr_b16 v[112:113], v226 offset:49152
v_mfma_f32_16x16x32_bf16 v[136:139], v[48:51], v[36:39], v[136:139]
ds_read_b64_tr_b16 v[114:115], v226 offset:51200
ds_read_b64_tr_b16 v[116:117], v227 offset:49152
v_mfma_f32_16x16x32_bf16 v[144:147], v[48:51], v[40:43], v[144:147]
ds_read_b64_tr_b16 v[118:119], v227 offset:51200
ds_read_b128 v[100:103], v18 offset:33792
v_mfma_f32_16x16x32_bf16 v[152:155], v[48:51], v[44:47], v[152:155]
ds_read_b128 v[104:107], v18 offset:34816
ds_read_b128 v[108:111], v18 offset:35840
v_mfma_f32_16x16x32_bf16 v[156:159], v[52:55], v[44:47], v[156:159]
ds_read_b128 v[192:195], v18 offset:40960
v_mfma_f32_16x16x32_bf16 v[148:151], v[52:55], v[40:43], v[148:151]
ds_read_b64_tr_b16 v[208:209], v226 offset:53248
v_mfma_f32_16x16x32_bf16 v[140:143], v[52:55], v[36:39], v[140:143]
ds_read_b64_tr_b16 v[210:211], v226 offset:55296
v_mfma_f32_16x16x32_bf16 v[132:135], v[52:55], v[32:35], v[132:135]
ds_read_b64_tr_b16 v[212:213], v227 offset:53248
v_mfma_f32_16x16x32_bf16 v[128:131], v[80:83], v[64:67], v[128:131]
ds_read_b64_tr_b16 v[214:215], v227 offset:55296
buffer_store_dwordx4 v[168:171], v2, s[84:87], s45 offen offset:2048 sc1
v_mfma_f32_16x16x32_bf16 v[136:139], v[80:83], v[68:71], v[136:139]
ds_read_b128 v[196:199], v18 offset:41984
v_mfma_f32_16x16x32_bf16 v[144:147], v[80:83], v[72:75], v[144:147]
ds_read_b128 v[200:203], v18 offset:43008
v_mfma_f32_16x16x32_bf16 v[152:155], v[80:83], v[76:79], v[152:155]
ds_read_b128 v[204:207], v18 offset:44032
v_mfma_f32_16x16x32_bf16 v[156:159], v[84:87], v[76:79], v[156:159]
v_mfma_f32_16x16x32_bf16 v[148:151], v[84:87], v[72:75], v[148:151]
v_mfma_f32_16x16x32_bf16 v[140:143], v[84:87], v[68:71], v[140:143]
v_mfma_f32_16x16x32_bf16 v[132:135], v[84:87], v[64:67], v[132:135]
s_waitcnt lgkmcnt(0)
s_barrier
v_mfma_f32_16x16x32_bf16 v[128:131], v[112:115], v[96:99], v[128:131]
ds_read_b128 v[32:35], v19 offset:0
ds_read_b64_tr_b16 v[48:49], v224 offset:0
v_mfma_f32_16x16x32_bf16 v[136:139], v[112:115], v[100:103], v[136:139]
ds_read_b64_tr_b16 v[50:51], v224 offset:2048
ds_read_b64_tr_b16 v[52:53], v225 offset:0
v_mfma_f32_16x16x32_bf16 v[144:147], v[112:115], v[104:107], v[144:147]
ds_read_b64_tr_b16 v[54:55], v225 offset:2048
ds_read_b128 v[36:39], v19 offset:1024
v_mfma_f32_16x16x32_bf16 v[152:155], v[112:115], v[108:111], v[152:155]
ds_read_b128 v[40:43], v19 offset:2048
ds_read_b128 v[44:47], v19 offset:3072
v_mfma_f32_16x16x32_bf16 v[156:159], v[116:119], v[108:111], v[156:159]
ds_read_b128 v[64:67], v19 offset:8192
v_mfma_f32_16x16x32_bf16 v[148:151], v[116:119], v[104:107], v[148:151]
ds_read_b64_tr_b16 v[80:81], v224 offset:4096
v_mfma_f32_16x16x32_bf16 v[140:143], v[116:119], v[100:103], v[140:143]
ds_read_b64_tr_b16 v[82:83], v224 offset:6144
v_mfma_f32_16x16x32_bf16 v[132:135], v[116:119], v[96:99], v[132:135]
ds_read_b64_tr_b16 v[84:85], v225 offset:4096
v_mfma_f32_16x16x32_bf16 v[128:131], v[208:211], v[192:195], v[128:131]
ds_read_b64_tr_b16 v[86:87], v225 offset:6144
buffer_store_dwordx4 v[172:175], v2, s[84:87], s45 offen offset:3072 sc1
v_mfma_f32_16x16x32_bf16 v[136:139], v[208:211], v[196:199], v[136:139]
ds_read_b128 v[68:71], v19 offset:9216
v_mfma_f32_16x16x32_bf16 v[144:147], v[208:211], v[200:203], v[144:147]
ds_read_b128 v[72:75], v19 offset:10240
v_mfma_f32_16x16x32_bf16 v[152:155], v[208:211], v[204:207], v[152:155]
ds_read_b128 v[76:79], v19 offset:11264
v_mfma_f32_16x16x32_bf16 v[156:159], v[212:215], v[204:207], v[156:159]
v_mfma_f32_16x16x32_bf16 v[148:151], v[212:215], v[200:203], v[148:151]
v_mfma_f32_16x16x32_bf16 v[140:143], v[212:215], v[196:199], v[140:143]
v_mfma_f32_16x16x32_bf16 v[132:135], v[212:215], v[192:195], v[132:135]
s_waitcnt lgkmcnt(0)
s_barrier
v_mfma_f32_16x16x32_bf16 v[128:131], v[48:51], v[32:35], v[128:131]
ds_read_b128 v[96:99], v17 offset:16384
ds_read_b64_tr_b16 v[112:113], v224 offset:32768
v_mfma_f32_16x16x32_bf16 v[136:139], v[48:51], v[36:39], v[136:139]
ds_read_b64_tr_b16 v[114:115], v224 offset:34816
ds_read_b64_tr_b16 v[116:117], v225 offset:32768
v_mfma_f32_16x16x32_bf16 v[144:147], v[48:51], v[40:43], v[144:147]
ds_read_b64_tr_b16 v[118:119], v225 offset:34816
ds_read_b128 v[100:103], v17 offset:17408
v_mfma_f32_16x16x32_bf16 v[152:155], v[48:51], v[44:47], v[152:155]
ds_read_b128 v[104:107], v17 offset:18432
ds_read_b128 v[108:111], v17 offset:19456
v_mfma_f32_16x16x32_bf16 v[156:159], v[52:55], v[44:47], v[156:159]
ds_read_b128 v[192:195], v17 offset:24576
v_mfma_f32_16x16x32_bf16 v[148:151], v[52:55], v[40:43], v[148:151]
ds_read_b64_tr_b16 v[208:209], v224 offset:36864
v_mfma_f32_16x16x32_bf16 v[140:143], v[52:55], v[36:39], v[140:143]
ds_read_b64_tr_b16 v[210:211], v224 offset:38912
v_mfma_f32_16x16x32_bf16 v[132:135], v[52:55], v[32:35], v[132:135]
ds_read_b64_tr_b16 v[212:213], v225 offset:36864
v_mfma_f32_16x16x32_bf16 v[128:131], v[80:83], v[64:67], v[128:131]
ds_read_b64_tr_b16 v[214:215], v225 offset:38912
v_mfma_f32_16x16x32_bf16 v[136:139], v[80:83], v[68:71], v[136:139]
ds_read_b128 v[196:199], v17 offset:25600
v_mfma_f32_16x16x32_bf16 v[144:147], v[80:83], v[72:75], v[144:147]
ds_read_b128 v[200:203], v17 offset:26624
v_mfma_f32_16x16x32_bf16 v[152:155], v[80:83], v[76:79], v[152:155]
ds_read_b128 v[204:207], v17 offset:27648
v_mfma_f32_16x16x32_bf16 v[156:159], v[84:87], v[76:79], v[156:159]
v_mfma_f32_16x16x32_bf16 v[148:151], v[84:87], v[72:75], v[148:151]
v_mfma_f32_16x16x32_bf16 v[140:143], v[84:87], v[68:71], v[140:143]
v_mfma_f32_16x16x32_bf16 v[132:135], v[84:87], v[64:67], v[132:135]
s_waitcnt vmcnt(0)
s_waitcnt lgkmcnt(0)
s_barrier
v_mfma_f32_16x16x32_bf16 v[128:131], v[112:115], v[96:99], v[128:131]
ds_read_b128 v[32:35], v17 offset:49152
ds_read_b64_tr_b16 v[48:49], v226 offset:0
v_mfma_f32_16x16x32_bf16 v[136:139], v[112:115], v[100:103], v[136:139]
ds_read_b64_tr_b16 v[50:51], v226 offset:2048
ds_read_b64_tr_b16 v[52:53], v227 offset:0
v_mfma_f32_16x16x32_bf16 v[144:147], v[112:115], v[104:107], v[144:147]
ds_read_b64_tr_b16 v[54:55], v227 offset:2048
ds_read_b128 v[36:39], v17 offset:50176
v_mfma_f32_16x16x32_bf16 v[152:155], v[112:115], v[108:111], v[152:155]
ds_read_b128 v[40:43], v17 offset:51200
ds_read_b128 v[44:47], v17 offset:52224
v_mfma_f32_16x16x32_bf16 v[156:159], v[116:119], v[108:111], v[156:159]
ds_read_b128 v[64:67], v17 offset:57344
v_mfma_f32_16x16x32_bf16 v[148:151], v[116:119], v[104:107], v[148:151]
ds_read_b64_tr_b16 v[80:81], v226 offset:4096
v_mfma_f32_16x16x32_bf16 v[140:143], v[116:119], v[100:103], v[140:143]
ds_read_b64_tr_b16 v[82:83], v226 offset:6144
v_mfma_f32_16x16x32_bf16 v[132:135], v[116:119], v[96:99], v[132:135]
ds_read_b64_tr_b16 v[84:85], v227 offset:4096
v_mfma_f32_16x16x32_bf16 v[128:131], v[208:211], v[192:195], v[128:131]
ds_read_b64_tr_b16 v[86:87], v227 offset:6144
v_mfma_f32_16x16x32_bf16 v[136:139], v[208:211], v[196:199], v[136:139]
ds_read_b128 v[68:71], v17 offset:58368
v_mfma_f32_16x16x32_bf16 v[144:147], v[208:211], v[200:203], v[144:147]
ds_read_b128 v[72:75], v17 offset:59392
v_mfma_f32_16x16x32_bf16 v[152:155], v[208:211], v[204:207], v[152:155]
ds_read_b128 v[76:79], v17 offset:60416
v_mfma_f32_16x16x32_bf16 v[156:159], v[212:215], v[204:207], v[156:159]
v_mfma_f32_16x16x32_bf16 v[148:151], v[212:215], v[200:203], v[148:151]
v_mfma_f32_16x16x32_bf16 v[140:143], v[212:215], v[196:199], v[140:143]
v_mfma_f32_16x16x32_bf16 v[132:135], v[212:215], v[192:195], v[132:135]
s_waitcnt lgkmcnt(0)
s_barrier
v_mfma_f32_16x16x32_bf16 v[128:131], v[48:51], v[32:35], v[128:131]
ds_read_b128 v[96:99], v18 offset:16384
ds_read_b64_tr_b16 v[112:113], v228 offset:16384
v_mfma_f32_16x16x32_bf16 v[136:139], v[48:51], v[36:39], v[136:139]
ds_read_b64_tr_b16 v[114:115], v228 offset:18432
ds_read_b64_tr_b16 v[116:117], v229 offset:16384
v_mfma_f32_16x16x32_bf16 v[144:147], v[48:51], v[40:43], v[144:147]
ds_read_b64_tr_b16 v[118:119], v229 offset:18432
ds_read_b128 v[100:103], v18 offset:17408
v_mfma_f32_16x16x32_bf16 v[152:155], v[48:51], v[44:47], v[152:155]
ds_read_b128 v[104:107], v18 offset:18432
ds_read_b128 v[108:111], v18 offset:19456
v_mfma_f32_16x16x32_bf16 v[156:159], v[52:55], v[44:47], v[156:159]
ds_read_b128 v[192:195], v18 offset:24576
v_mfma_f32_16x16x32_bf16 v[148:151], v[52:55], v[40:43], v[148:151]
ds_read_b64_tr_b16 v[208:209], v228 offset:20480
v_mfma_f32_16x16x32_bf16 v[140:143], v[52:55], v[36:39], v[140:143]
ds_read_b64_tr_b16 v[210:211], v228 offset:22528
v_mfma_f32_16x16x32_bf16 v[132:135], v[52:55], v[32:35], v[132:135]
ds_read_b64_tr_b16 v[212:213], v229 offset:20480
v_mfma_f32_16x16x32_bf16 v[128:131], v[80:83], v[64:67], v[128:131]
ds_read_b64_tr_b16 v[214:215], v229 offset:22528
v_mfma_f32_16x16x32_bf16 v[136:139], v[80:83], v[68:71], v[136:139]
ds_read_b128 v[196:199], v18 offset:25600
v_mfma_f32_16x16x32_bf16 v[144:147], v[80:83], v[72:75], v[144:147]
ds_read_b128 v[200:203], v18 offset:26624
v_mfma_f32_16x16x32_bf16 v[152:155], v[80:83], v[76:79], v[152:155]
ds_read_b128 v[204:207], v18 offset:27648
v_mfma_f32_16x16x32_bf16 v[156:159], v[84:87], v[76:79], v[156:159]
v_mfma_f32_16x16x32_bf16 v[148:151], v[84:87], v[72:75], v[148:151]
v_mfma_f32_16x16x32_bf16 v[140:143], v[84:87], v[68:71], v[140:143]
v_mfma_f32_16x16x32_bf16 v[132:135], v[84:87], v[64:67], v[132:135]
s_waitcnt lgkmcnt(0)
s_barrier
v_mfma_f32_16x16x32_bf16 v[128:131], v[112:115], v[96:99], v[128:131]
ds_read_b128 v[32:35], v18 offset:32768
ds_read_b64_tr_b16 v[48:49], v226 offset:49152
v_mfma_f32_16x16x32_bf16 v[136:139], v[112:115], v[100:103], v[136:139]
ds_read_b64_tr_b16 v[50:51], v226 offset:51200
ds_read_b64_tr_b16 v[52:53], v227 offset:49152
v_mfma_f32_16x16x32_bf16 v[144:147], v[112:115], v[104:107], v[144:147]
ds_read_b64_tr_b16 v[54:55], v227 offset:51200
ds_read_b128 v[36:39], v18 offset:33792
v_mfma_f32_16x16x32_bf16 v[152:155], v[112:115], v[108:111], v[152:155]
ds_read_b128 v[40:43], v18 offset:34816
ds_read_b128 v[44:47], v18 offset:35840
v_mfma_f32_16x16x32_bf16 v[156:159], v[116:119], v[108:111], v[156:159]
ds_read_b128 v[64:67], v18 offset:40960
v_mfma_f32_16x16x32_bf16 v[148:151], v[116:119], v[104:107], v[148:151]
ds_read_b64_tr_b16 v[80:81], v226 offset:53248
v_mfma_f32_16x16x32_bf16 v[140:143], v[116:119], v[100:103], v[140:143]
ds_read_b64_tr_b16 v[82:83], v226 offset:55296
v_mfma_f32_16x16x32_bf16 v[132:135], v[116:119], v[96:99], v[132:135]
ds_read_b64_tr_b16 v[84:85], v227 offset:53248
v_mfma_f32_16x16x32_bf16 v[128:131], v[208:211], v[192:195], v[128:131]
ds_read_b64_tr_b16 v[86:87], v227 offset:55296
v_mfma_f32_16x16x32_bf16 v[136:139], v[208:211], v[196:199], v[136:139]
ds_read_b128 v[68:71], v18 offset:41984
v_mfma_f32_16x16x32_bf16 v[144:147], v[208:211], v[200:203], v[144:147]
ds_read_b128 v[72:75], v18 offset:43008
v_mfma_f32_16x16x32_bf16 v[152:155], v[208:211], v[204:207], v[152:155]
ds_read_b128 v[76:79], v18 offset:44032
v_mfma_f32_16x16x32_bf16 v[156:159], v[212:215], v[204:207], v[156:159]
v_mfma_f32_16x16x32_bf16 v[148:151], v[212:215], v[200:203], v[148:151]
v_mfma_f32_16x16x32_bf16 v[140:143], v[212:215], v[196:199], v[140:143]
v_mfma_f32_16x16x32_bf16 v[132:135], v[212:215], v[192:195], v[132:135]
s_waitcnt lgkmcnt(0)
s_barrier
buffer_load_dwordx4 v[232:235], v2, s[84:87], s46 offen offset:0 sc1
buffer_load_dwordx4 v[236:239], v2, s[84:87], s46 offen offset:1024 sc1
buffer_load_dwordx4 v[240:243], v2, s[84:87], s46 offen offset:2048 sc1
buffer_load_dwordx4 v[244:247], v2, s[84:87], s46 offen offset:3072 sc1
v_mfma_f32_16x16x32_bf16 v[128:131], v[48:51], v[32:35], v[128:131]
ds_read_b128 v[96:99], v19 offset:0
ds_read_b64_tr_b16 v[112:113], v224 offset:0
v_mfma_f32_16x16x32_bf16 v[136:139], v[48:51], v[36:39], v[136:139]
ds_read_b64_tr_b16 v[114:115], v224 offset:2048
ds_read_b64_tr_b16 v[116:117], v225 offset:0
v_mfma_f32_16x16x32_bf16 v[144:147], v[48:51], v[40:43], v[144:147]
ds_read_b64_tr_b16 v[118:119], v225 offset:2048
ds_read_b128 v[100:103], v19 offset:1024
v_mfma_f32_16x16x32_bf16 v[152:155], v[48:51], v[44:47], v[152:155]
ds_read_b128 v[104:107], v19 offset:2048
ds_read_b128 v[108:111], v19 offset:3072
v_mfma_f32_16x16x32_bf16 v[156:159], v[52:55], v[44:47], v[156:159]
ds_read_b128 v[192:195], v19 offset:8192
v_mfma_f32_16x16x32_bf16 v[148:151], v[52:55], v[40:43], v[148:151]
ds_read_b64_tr_b16 v[208:209], v224 offset:4096
v_mfma_f32_16x16x32_bf16 v[140:143], v[52:55], v[36:39], v[140:143]
ds_read_b64_tr_b16 v[210:211], v224 offset:6144
v_mfma_f32_16x16x32_bf16 v[132:135], v[52:55], v[32:35], v[132:135]
ds_read_b64_tr_b16 v[212:213], v225 offset:4096
v_mfma_f32_16x16x32_bf16 v[128:131], v[80:83], v[64:67], v[128:131]
ds_read_b64_tr_b16 v[214:215], v225 offset:6144
v_mfma_f32_16x16x32_bf16 v[136:139], v[80:83], v[68:71], v[136:139]
ds_read_b128 v[196:199], v19 offset:9216
v_mfma_f32_16x16x32_bf16 v[144:147], v[80:83], v[72:75], v[144:147]
ds_read_b128 v[200:203], v19 offset:10240
v_mfma_f32_16x16x32_bf16 v[152:155], v[80:83], v[76:79], v[152:155]
ds_read_b128 v[204:207], v19 offset:11264
v_mfma_f32_16x16x32_bf16 v[156:159], v[84:87], v[76:79], v[156:159]
v_mfma_f32_16x16x32_bf16 v[148:151], v[84:87], v[72:75], v[148:151]
v_mfma_f32_16x16x32_bf16 v[140:143], v[84:87], v[68:71], v[140:143]
v_mfma_f32_16x16x32_bf16 v[132:135], v[84:87], v[64:67], v[132:135]
s_waitcnt lgkmcnt(0)
s_barrier
v_mfma_f32_16x16x32_bf16 v[128:131], v[112:115], v[96:99], v[128:131]
ds_read_b128 v[32:35], v17 offset:16384
ds_read_b64_tr_b16 v[48:49], v224 offset:32768
v_mfma_f32_16x16x32_bf16 v[136:139], v[112:115], v[100:103], v[136:139]
ds_read_b64_tr_b16 v[50:51], v224 offset:34816
ds_read_b64_tr_b16 v[52:53], v225 offset:32768
v_mfma_f32_16x16x32_bf16 v[144:147], v[112:115], v[104:107], v[144:147]
ds_read_b64_tr_b16 v[54:55], v225 offset:34816
ds_read_b128 v[36:39], v17 offset:17408
v_mfma_f32_16x16x32_bf16 v[152:155], v[112:115], v[108:111], v[152:155]
ds_read_b128 v[40:43], v17 offset:18432
ds_read_b128 v[44:47], v17 offset:19456
v_mfma_f32_16x16x32_bf16 v[156:159], v[116:119], v[108:111], v[156:159]
ds_read_b128 v[64:67], v17 offset:24576
v_mfma_f32_16x16x32_bf16 v[148:151], v[116:119], v[104:107], v[148:151]
ds_read_b64_tr_b16 v[80:81], v224 offset:36864
v_mfma_f32_16x16x32_bf16 v[140:143], v[116:119], v[100:103], v[140:143]
ds_read_b64_tr_b16 v[82:83], v224 offset:38912
v_mfma_f32_16x16x32_bf16 v[132:135], v[116:119], v[96:99], v[132:135]
ds_read_b64_tr_b16 v[84:85], v225 offset:36864
v_mfma_f32_16x16x32_bf16 v[128:131], v[208:211], v[192:195], v[128:131]
ds_read_b64_tr_b16 v[86:87], v225 offset:38912
v_mfma_f32_16x16x32_bf16 v[136:139], v[208:211], v[196:199], v[136:139]
ds_read_b128 v[68:71], v17 offset:25600
v_mfma_f32_16x16x32_bf16 v[144:147], v[208:211], v[200:203], v[144:147]
ds_read_b128 v[72:75], v17 offset:26624
v_mfma_f32_16x16x32_bf16 v[152:155], v[208:211], v[204:207], v[152:155]
ds_read_b128 v[76:79], v17 offset:27648
v_mfma_f32_16x16x32_bf16 v[156:159], v[212:215], v[204:207], v[156:159]
v_mfma_f32_16x16x32_bf16 v[148:151], v[212:215], v[200:203], v[148:151]
v_mfma_f32_16x16x32_bf16 v[140:143], v[212:215], v[196:199], v[140:143]
v_mfma_f32_16x16x32_bf16 v[132:135], v[212:215], v[192:195], v[132:135]
s_waitcnt lgkmcnt(0)
s_barrier
v_mfma_f32_16x16x32_bf16 v[128:131], v[48:51], v[32:35], v[128:131]
ds_read_b128 v[96:99], v17 offset:49152
ds_read_b64_tr_b16 v[112:113], v226 offset:0
v_mfma_f32_16x16x32_bf16 v[136:139], v[48:51], v[36:39], v[136:139]
ds_read_b64_tr_b16 v[114:115], v226 offset:2048
ds_read_b64_tr_b16 v[116:117], v227 offset:0
v_mfma_f32_16x16x32_bf16 v[144:147], v[48:51], v[40:43], v[144:147]
ds_read_b64_tr_b16 v[118:119], v227 offset:2048
ds_read_b128 v[100:103], v17 offset:50176
v_mfma_f32_16x16x32_bf16 v[152:155], v[48:51], v[44:47], v[152:155]
ds_read_b128 v[104:107], v17 offset:51200
ds_read_b128 v[108:111], v17 offset:52224
v_mfma_f32_16x16x32_bf16 v[156:159], v[52:55], v[44:47], v[156:159]
ds_read_b128 v[192:195], v17 offset:57344
v_mfma_f32_16x16x32_bf16 v[148:151], v[52:55], v[40:43], v[148:151]
ds_read_b64_tr_b16 v[208:209], v226 offset:4096
v_mfma_f32_16x16x32_bf16 v[140:143], v[52:55], v[36:39], v[140:143]
ds_read_b64_tr_b16 v[210:211], v226 offset:6144
v_mfma_f32_16x16x32_bf16 v[132:135], v[52:55], v[32:35], v[132:135]
ds_read_b64_tr_b16 v[212:213], v227 offset:4096
v_mfma_f32_16x16x32_bf16 v[128:131], v[80:83], v[64:67], v[128:131]
ds_read_b64_tr_b16 v[214:215], v227 offset:6144
v_mfma_f32_16x16x32_bf16 v[136:139], v[80:83], v[68:71], v[136:139]
ds_read_b128 v[196:199], v17 offset:58368
v_mfma_f32_16x16x32_bf16 v[144:147], v[80:83], v[72:75], v[144:147]
ds_read_b128 v[200:203], v17 offset:59392
v_mfma_f32_16x16x32_bf16 v[152:155], v[80:83], v[76:79], v[152:155]
ds_read_b128 v[204:207], v17 offset:60416
v_mfma_f32_16x16x32_bf16 v[156:159], v[84:87], v[76:79], v[156:159]
v_mfma_f32_16x16x32_bf16 v[148:151], v[84:87], v[72:75], v[148:151]
v_mfma_f32_16x16x32_bf16 v[140:143], v[84:87], v[68:71], v[140:143]
v_mfma_f32_16x16x32_bf16 v[132:135], v[84:87], v[64:67], v[132:135]
s_waitcnt vmcnt(0)
s_waitcnt lgkmcnt(0)
s_barrier
v_mfma_f32_16x16x32_bf16 v[128:131], v[112:115], v[96:99], v[128:131]
v_lshlrev_b32 v160, 16, v232
v_and_b32 v161, 0xffff0000, v232
v_lshlrev_b32 v162, 16, v233
v_and_b32 v163, 0xffff0000, v233
v_mfma_f32_16x16x32_bf16 v[132:135], v[116:119], v[96:99], v[132:135]
v_lshlrev_b32 v164, 16, v234
v_and_b32 v165, 0xffff0000, v234
v_lshlrev_b32 v166, 16, v235
v_and_b32 v167, 0xffff0000, v235
v_mfma_f32_16x16x32_bf16 v[128:131], v[208:211], v[192:195], v[128:131]
v_lshlrev_b32 v168, 16, v236
v_and_b32 v169, 0xffff0000, v236
v_lshlrev_b32 v170, 16, v237
v_and_b32 v171, 0xffff0000, v237
v_mfma_f32_16x16x32_bf16 v[132:135], v[212:215], v[192:195], v[132:135]
v_lshlrev_b32 v172, 16, v238
v_and_b32 v173, 0xffff0000, v238
v_lshlrev_b32 v174, 16, v239
v_and_b32 v175, 0xffff0000, v239
v_mfma_f32_16x16x32_bf16 v[136:139], v[112:115], v[100:103], v[136:139]
v_lshlrev_b32 v176, 16, v240
v_and_b32 v177, 0xffff0000, v240
v_lshlrev_b32 v178, 16, v241
v_and_b32 v179, 0xffff0000, v241
v_mfma_f32_16x16x32_bf16 v[140:143], v[116:119], v[100:103], v[140:143]
v_lshlrev_b32 v180, 16, v242
v_and_b32 v181, 0xffff0000, v242
v_lshlrev_b32 v182, 16, v243
v_and_b32 v183, 0xffff0000, v243
v_mfma_f32_16x16x32_bf16 v[136:139], v[208:211], v[196:199], v[136:139]
v_lshlrev_b32 v184, 16, v244
v_and_b32 v185, 0xffff0000, v244
v_lshlrev_b32 v186, 16, v245
v_and_b32 v187, 0xffff0000, v245
v_mfma_f32_16x16x32_bf16 v[140:143], v[212:215], v[196:199], v[140:143]
v_lshlrev_b32 v188, 16, v246
v_and_b32 v189, 0xffff0000, v246
v_lshlrev_b32 v190, 16, v247
v_and_b32 v191, 0xffff0000, v247
v_mfma_f32_16x16x32_bf16 v[144:147], v[112:115], v[104:107], v[144:147]
v_add_f32 v128, v128, v160
v_add_f32 v129, v129, v161
v_add_f32 v130, v130, v162
v_mfma_f32_16x16x32_bf16 v[148:151], v[116:119], v[104:107], v[148:151]
v_add_f32 v131, v131, v163
v_add_f32 v132, v132, v164
v_add_f32 v133, v133, v165
v_mfma_f32_16x16x32_bf16 v[144:147], v[208:211], v[200:203], v[144:147]
v_add_f32 v134, v134, v166
v_add_f32 v135, v135, v167
v_cvt_pk_bf16_f32 v232, v128, v129
v_mfma_f32_16x16x32_bf16 v[148:151], v[212:215], v[200:203], v[148:151]
v_cvt_pk_bf16_f32 v233, v130, v131
v_cvt_pk_bf16_f32 v234, v132, v133
v_cvt_pk_bf16_f32 v235, v134, v135
v_mfma_f32_16x16x32_bf16 v[152:155], v[112:115], v[108:111], v[152:155]
v_add_f32 v136, v136, v168
v_add_f32 v137, v137, v169
v_add_f32 v138, v138, v170
v_mfma_f32_16x16x32_bf16 v[156:159], v[116:119], v[108:111], v[156:159]
v_add_f32 v139, v139, v171
v_add_f32 v140, v140, v172
v_add_f32 v141, v141, v173
v_add_f32 v142, v142, v174
v_mfma_f32_16x16x32_bf16 v[152:155], v[208:211], v[204:207], v[152:155]
v_add_f32 v143, v143, v175
v_cvt_pk_bf16_f32 v236, v136, v137
v_cvt_pk_bf16_f32 v237, v138, v139
v_cvt_pk_bf16_f32 v238, v140, v141
v_mfma_f32_16x16x32_bf16 v[156:159], v[212:215], v[204:207], v[156:159]
v_cvt_pk_bf16_f32 v239, v142, v143
v_permlane16_swap_b32 v232, v234
v_permlane16_swap_b32 v233, v235
buffer_store_dwordx4 v[232:235], v230, s[20:23], s54 offen offset:0 nt
v_permlane16_swap_b32 v236, v238
v_permlane16_swap_b32 v237, v239
buffer_store_dwordx4 v[236:239], v230, s[20:23], s54 offen offset:2048 nt
v_add_f32 v144, v144, v176
v_add_f32 v145, v145, v177
v_add_f32 v146, v146, v178
v_add_f32 v147, v147, v179
v_add_f32 v148, v148, v180
v_add_f32 v149, v149, v181
v_add_f32 v150, v150, v182
v_add_f32 v151, v151, v183
v_cvt_pk_bf16_f32 v240, v144, v145
v_cvt_pk_bf16_f32 v241, v146, v147
v_cvt_pk_bf16_f32 v242, v148, v149
v_cvt_pk_bf16_f32 v243, v150, v151
s_nop 0
v_add_f32 v152, v152, v184
v_add_f32 v153, v153, v185
v_add_f32 v154, v154, v186
v_add_f32 v155, v155, v187
v_add_f32 v156, v156, v188
v_add_f32 v157, v157, v189
v_add_f32 v158, v158, v190
v_add_f32 v159, v159, v191
v_cvt_pk_bf16_f32 v244, v152, v153
v_cvt_pk_bf16_f32 v245, v154, v155
v_cvt_pk_bf16_f32 v246, v156, v157
v_cvt_pk_bf16_f32 v247, v158, v159
v_permlane16_swap_b32 v240, v242
v_permlane16_swap_b32 v241, v243
buffer_store_dwordx4 v[240:243], v230, s[20:23], s55 offen offset:0 nt
v_permlane16_swap_b32 v244, v246
v_permlane16_swap_b32 v245, v247
buffer_store_dwordx4 v[244:247], v230, s[20:23], s55 offen offset:2048 nt
s_branch Ldone_1
Lgb_92:
s_mul_i32 s43, s34, 262144
s_add_u32 s8, s82, s43
s_addc_u32 s9, s83, 0
s_add_u32 s8, s8, 4194304
s_addc_u32 s9, s9, 0
s_mov_b32 s10, 262144
s_mov_b32 s11, 0x20000
s_lshl_b32 s39, s36, 12
v_lshlrev_b32 v2, 4, v1
v_add_u32 v3, s39, v2
s_add_u32 s37, s35, 0
s_and_b32 s37, s37, 15
s_mul_i32 s37, s37, 16384
s_add_u32 m0, s39, 0
s_nop 0
buffer_load_dwordx4 v3, s[8:11], s37 offen sc1 lds
buffer_load_dwordx4 v3, s[8:11], s37 offen offset:1024 sc1 lds
buffer_load_dwordx4 v3, s[8:11], s37 offen offset:2048 sc1 lds
buffer_load_dwordx4 v3, s[8:11], s37 offen offset:3072 sc1 lds
s_mul_i32 s43, s34, 262144
s_add_u32 s8, s82, s43
s_addc_u32 s9, s83, 0
s_add_u32 s8, s8, 4194304
s_addc_u32 s9, s9, 0
s_mov_b32 s10, 262144
s_mov_b32 s11, 0x20000
s_mul_i32 s43, s34, 917504
s_add_u32 s24, s82, s43
s_addc_u32 s25, s83, 0
s_add_u32 s24, s24, 8388608
s_addc_u32 s25, s25, 0
s_mov_b32 s26, 917504
s_branch Lov_13
.p2align 12
.fill 96, 4, 0xbf800000
Lst_13_0:
s_branch Lwr_153
Lst_13_1:
s_branch Lst_17_0
s_nop 0
Lov_13:
s_mov_b32 s27, 0x20000
s_add_u32 s84, s82, 27262976
s_addc_u32 s85, s83, 0
s_mov_b32 s86, 229376
s_mov_b32 s87, 0x20000
s_and_b32 s47, s36, 3
s_lshr_b32 s62, s47, 1
s_and_b32 s63, s47, 1
v_lshlrev_b32 v2, 4, v1
s_lshl_b32 s39, s47, 12
v_add_u32 v3, s39, v2
s_bitcmp0_b32 s36, 1
s_cselect_b32 s44, s72, s74
s_cselect_b32 s45, s73, s75
s_mul_i32 s43, s35, 256
s_add_u32 s12, s44, s43
s_addc_u32 s13, s45, 0
s_mov_b32 s14, 7333120
s_mov_b32 s15, 0x20000
s_and_b32 s43, s36, 1
s_mul_i32 s43, s43, 229376
v_lshrrev_b32 v28, 4, v1
v_lshlrev_b32 v29, 1, v28
v_and_b32 v4, 15, v1
v_xor_b32 v4, v4, v29
v_lshlrev_b32 v4, 4, v4
v_mul_u32_u24 v28, 7168, v28
v_add_u32 v4, v4, v28
v_add_u32 v4, s43, v4
v_xor_b32 v5, 128, v4
v_add_u32 v5, 28672, v5
s_and_b32 s43, s36, 3
s_mul_i32 s40, s43, 8192
s_add_u32 s40, s40, 16384
v_mov_b32 v6, v192
v_mov_b32 v7, v193
v_mov_b32 v8, v194
s_lshl_b32 s43, s62, 12
v_add_u32 v9, s43, v2
v_add_u32 v10, 98304, v9
v_mov_b32 v24, v195
s_mul_i32 s43, s34, 16384
s_add_u32 s20, s82, s43
s_addc_u32 s21, s83, 0
s_add_u32 s20, s20, 25165824
s_addc_u32 s21, s21, 0
s_mov_b32 s22, 16384
s_mov_b32 s23, 0x20000
s_add_u32 s38, s35, 2
s_and_b32 s38, s38, 15
s_mul_i32 s38, s38, 458752
s_add_u32 m0, s50, 98304
s_nop 0
buffer_load_dwordx4 v6, s[16:19], s38 offen lds
s_add_u32 m0, s50, 99328
s_nop 0
buffer_load_dwordx4 v7, s[16:19], s38 offen lds
s_add_u32 m0, s50, 100352
s_nop 0
buffer_load_dwordx4 v8, s[16:19], s38 offen lds
s_add_u32 m0, s50, 101376
s_add_u32 s38, s38, 114688
buffer_load_dwordx4 v6, s[16:19], s38 offen lds
s_add_u32 m0, s50, 102400
s_nop 0
buffer_load_dwordx4 v7, s[16:19], s38 offen lds
s_add_u32 m0, s50, 103424
s_nop 0
buffer_load_dwordx4 v8, s[16:19], s38 offen lds
s_cmp_eq_u32 s47, 1
s_cbranch_scc0 Lw_117
s_lshl_b32 s92, s34, 4
s_add_u32 s92, s92, s35
s_lshl_b32 s92, s92, 8
s_add_u32 s92, s92, 49280
s_add_u32 s92, s92, 28311552
s_mov_b32 s41, 0x40000
Lpoll_118:
s_load_dword s93, s[82:83], s92 glc
Lpchk_120:
s_waitcnt lgkmcnt(0)
s_cmp_eq_u32 s93, 16
s_cbranch_scc1 Lpok_119
s_sub_u32 s41, s41, 1
s_cmp_lg_u32 s41, 0
s_cbranch_scc1 Lpoll_118
Lpok_119:
Lw_117:
s_waitcnt vmcnt(0)
s_barrier
s_add_u32 s37, s35, 1
s_and_b32 s37, s37, 15
s_mul_i32 s37, s37, 16384
s_add_u32 m0, s39, 49152
s_nop 0
buffer_load_dwordx4 v3, s[8:11], s37 offen sc1 lds
buffer_load_dwordx4 v3, s[8:11], s37 offen offset:1024 sc1 lds
buffer_load_dwordx4 v3, s[8:11], s37 offen offset:2048 sc1 lds
buffer_load_dwordx4 v3, s[8:11], s37 offen offset:3072 sc1 lds
s_add_u32 s37, s35, 2
s_and_b32 s37, s37, 15
s_mul_i32 s37, s37, 16384
s_add_u32 m0, s39, 98304
s_nop 0
buffer_load_dwordx4 v3, s[8:11], s37 offen sc1 lds
buffer_load_dwordx4 v3, s[8:11], s37 offen offset:1024 sc1 lds
buffer_load_dwordx4 v3, s[8:11], s37 offen offset:2048 sc1 lds
buffer_load_dwordx4 v3, s[8:11], s37 offen offset:3072 sc1 lds
buffer_load_dwordx4 v[96:99], v3, s[20:23], 0 offen offset:0 sc1
buffer_load_dwordx4 v[100:103], v3, s[20:23], 0 offen offset:1024 sc1
buffer_load_dwordx4 v[104:107], v3, s[20:23], 0 offen offset:2048 sc1
buffer_load_dwordx4 v[108:111], v3, s[20:23], 0 offen offset:3072 sc1
s_and_b32 s44, s36, 3
s_mul_i32 s44, s44, 32
s_bfe_u32 s43, s2, 0x30001
s_lshl_b32 s43, s43, 7
s_add_u32 s44, s44, s43
s_add_u32 s44, s44, 0
s_mul_i32 s44, s44, 7168
s_lshr_b32 s43, s2, 4
s_lshl_b32 s43, s43, 8
s_add_u32 s43, s43, s44
s_bitcmp0_b32 s2, 0
s_cselect_b32 s4, s72, s74
s_cselect_b32 s5, s73, s75
s_add_u32 s4, s4, s43
s_addc_u32 s5, s5, 0
s_waitcnt vmcnt(8)
s_barrier
s_cmp_eq_u32 s47, 3
s_cbranch_scc0 Lw_121
v_and_b32 v90, 31, v1
v_lshlrev_b32 v90, 4, v90
v_add_u32 v91, 151552, v90
ds_read_b128 v[112:115], v91 offset:0
ds_read_b128 v[116:119], v91 offset:512
ds_read_b128 v[120:123], v91 offset:1024
ds_read_b128 v[124:127], v91 offset:1536
s_and_b32 s44, s2, 15
s_mul_i32 s44, s44, 14336
s_lshr_b32 s43, s2, 4
s_lshl_b32 s43, s43, 9
s_add_u32 s44, s44, s43
s_add_u32 s44, s44, 8192
s_cmp_lt_u32 s2, 192
s_cselect_b32 s44, s44, 0x7fffffff
s_waitcnt lgkmcnt(0)
v_add_f32 v112, v112, v116
v_add_f32 v120, v120, v124
v_add_f32 v113, v113, v117
v_add_f32 v121, v121, v125
v_add_f32 v114, v114, v118
v_add_f32 v122, v122, v126
v_add_f32 v115, v115, v119
v_add_f32 v123, v123, v127
v_add_f32 v112, v112, v120
v_add_f32 v113, v113, v121
v_add_f32 v114, v114, v122
v_add_f32 v115, v115, v123
s_mov_b64 exec, 0xffffffff
buffer_store_dwordx4 v[112:115], v90, s[84:87], s44 offen sc1
s_mov_b64 exec, -1
Lw_121:
s_add_u32 s37, s35, 3
s_and_b32 s37, s37, 15
s_mul_i32 s37, s37, 16384
s_add_u32 m0, s39, 0
s_nop 0
buffer_load_dwordx4 v3, s[8:11], s37 offen sc1 lds
s_load_dword s3, s[4:5], 0
buffer_load_dwordx4 v3, s[8:11], s37 offen offset:1024 sc1 lds
s_load_dword s3, s[4:5], 64
buffer_load_dwordx4 v3, s[8:11], s37 offen offset:2048 sc1 lds
s_load_dword s3, s[4:5], 128
buffer_load_dwordx4 v3, s[8:11], s37 offen offset:3072 sc1 lds
s_load_dword s3, s[4:5], 192
s_load_dword s3, s[4:5], 7168
s_add_u32 s38, s35, 3
s_and_b32 s38, s38, 15
s_mul_i32 s38, s38, 458752
s_add_u32 m0, s50, 0
s_nop 0
buffer_load_dwordx4 v6, s[16:19], s38 offen lds
s_load_dword s3, s[4:5], 7232
s_add_u32 m0, s50, 1024
s_nop 0
buffer_load_dwordx4 v7, s[16:19], s38 offen lds
s_load_dword s3, s[4:5], 7296
s_add_u32 m0, s50, 2048
s_nop 0
buffer_load_dwordx4 v8, s[16:19], s38 offen lds
s_load_dword s3, s[4:5], 7360
s_add_u32 m0, s50, 3072
s_add_u32 s38, s38, 114688
buffer_load_dwordx4 v6, s[16:19], s38 offen lds
s_load_dword s3, s[4:5], 14336
s_load_dword s3, s[4:5], 14400
s_add_u32 m0, s50, 4096
s_nop 0
buffer_load_dwordx4 v7, s[16:19], s38 offen lds
s_add_u32 m0, s50, 5120
s_nop 0
buffer_load_dwordx4 v8, s[16:19], s38 offen lds
s_waitcnt vmcnt(14)
s_barrier
s_add_u32 s37, s35, 4
s_and_b32 s37, s37, 15
s_mul_i32 s37, s37, 16384
s_add_u32 m0, s39, 49152
s_nop 0
buffer_load_dwordx4 v3, s[8:11], s37 offen sc1 lds
s_load_dword s3, s[4:5], 14464
buffer_load_dwordx4 v3, s[8:11], s37 offen offset:1024 sc1 lds
s_load_dword s3, s[4:5], 14528
buffer_load_dwordx4 v3, s[8:11], s37 offen offset:2048 sc1 lds
s_load_dword s3, s[4:5], 21504
buffer_load_dwordx4 v3, s[8:11], s37 offen offset:3072 sc1 lds
s_load_dword s3, s[4:5], 21568
s_load_dword s3, s[4:5], 21632
s_add_u32 s38, s35, 4
s_and_b32 s38, s38, 15
s_mul_i32 s38, s38, 458752
s_add_u32 m0, s50, 49152
s_nop 0
buffer_load_dwordx4 v6, s[16:19], s38 offen lds
s_load_dword s3, s[4:5], 21696
s_add_u32 m0, s50, 50176
s_nop 0
buffer_load_dwordx4 v7, s[16:19], s38 offen lds
s_load_dword s3, s[4:5], 28672
s_add_u32 m0, s50, 51200
s_nop 0
buffer_load_dwordx4 v8, s[16:19], s38 offen lds
s_load_dword s3, s[4:5], 28736
s_add_u32 m0, s50, 52224
s_add_u32 s38, s38, 114688
buffer_load_dwordx4 v6, s[16:19], s38 offen lds
s_load_dword s3, s[4:5], 28800
s_load_dword s3, s[4:5], 28864
s_add_u32 m0, s50, 53248
s_nop 0
buffer_load_dwordx4 v7, s[16:19], s38 offen lds
s_add_u32 m0, s50, 54272
s_nop 0
buffer_load_dwordx4 v8, s[16:19], s38 offen lds
s_waitcnt vmcnt(10)
s_barrier
s_cmp_eq_u32 s47, 3
s_cbranch_scc0 Lw_122
s_cmp_lt_u32 s2, 192
s_cbranch_scc0 Lw_122
s_lshr_b32 s43, s2, 4
s_add_u32 s43, s43, 96
s_lshl_b32 s43, s43, 7
v_mov_b32 v90, s43
v_mov_b32 v91, 1
s_mov_b64 exec, 1
buffer_atomic_add v91, v90, s[56:59], 0 offen sc1
s_mov_b64 exec, -1
Lw_122:
s_add_u32 s37, s35, 5
s_and_b32 s37, s37, 15
s_mul_i32 s37, s37, 16384
s_add_u32 m0, s39, 98304
s_nop 0
buffer_load_dwordx4 v3, s[8:11], s37 offen sc1 lds
v_add_f32 v96, v96, v100
v_add_f32 v97, v97, v101
v_add_f32 v98, v98, v102
buffer_load_dwordx4 v3, s[8:11], s37 offen offset:1024 sc1 lds
v_add_f32 v99, v99, v103
v_add_f32 v104, v104, v108
v_add_f32 v105, v105, v109
buffer_load_dwordx4 v3, s[8:11], s37 offen offset:2048 sc1 lds
v_add_f32 v106, v106, v110
v_add_f32 v107, v107, v111
s_nop 0
buffer_load_dwordx4 v3, s[8:11], s37 offen offset:3072 sc1 lds
v_permlane32_swap_b32 v96, v104
v_permlane32_swap_b32 v97, v105
v_permlane32_swap_b32 v98, v106
v_permlane32_swap_b32 v99, v107
s_add_u32 s38, s35, 5
s_and_b32 s38, s38, 15
s_mul_i32 s38, s38, 458752
s_add_u32 m0, s50, 98304
s_nop 0
buffer_load_dwordx4 v6, s[16:19], s38 offen lds
v_add_f32 v96, v96, v104
v_add_f32 v97, v97, v105
v_add_f32 v98, v98, v106
s_add_u32 m0, s50, 99328
s_nop 0
buffer_load_dwordx4 v7, s[16:19], s38 offen lds
v_add_f32 v99, v99, v107
v_mov_b32 v100, v96
v_mov_b32 v101, v97
s_add_u32 m0, s50, 100352
s_nop 0
buffer_load_dwordx4 v8, s[16:19], s38 offen lds
v_mov_b32 v102, v98
v_mov_b32 v103, v99
s_nop 0
s_add_u32 m0, s50, 101376
s_add_u32 s38, s38, 114688
buffer_load_dwordx4 v6, s[16:19], s38 offen lds
v_permlane16_swap_b32 v96, v100
v_permlane16_swap_b32 v97, v101
v_permlane16_swap_b32 v98, v102
v_permlane16_swap_b32 v99, v103
s_add_u32 m0, s50, 102400
s_nop 0
buffer_load_dwordx4 v7, s[16:19], s38 offen lds
s_add_u32 m0, s50, 103424
s_nop 0
buffer_load_dwordx4 v8, s[16:19], s38 offen lds
s_waitcnt vmcnt(10)
s_barrier
s_add_u32 s37, s35, 6
s_and_b32 s37, s37, 15
s_mul_i32 s37, s37, 16384
s_add_u32 m0, s39, 0
s_nop 0
buffer_load_dwordx4 v3, s[8:11], s37 offen sc1 lds
v_add_f32 v96, v96, v100
v_add_f32 v97, v97, v101
v_add_f32 v98, v98, v102
buffer_load_dwordx4 v3, s[8:11], s37 offen offset:1024 sc1 lds
v_add_f32 v99, v99, v103
s_nop 0
v_add_f32_dpp v96, v96, v96 row_ror:8 row_mask:0xf bank_mask:0xf
buffer_load_dwordx4 v3, s[8:11], s37 offen offset:2048 sc1 lds
v_add_f32_dpp v97, v97, v97 row_ror:8 row_mask:0xf bank_mask:0xf
v_add_f32_dpp v98, v98, v98 row_ror:8 row_mask:0xf bank_mask:0xf
v_add_f32_dpp v99, v99, v99 row_ror:8 row_mask:0xf bank_mask:0xf
v_mul_f32 v96, 0x3a800000, v96
buffer_load_dwordx4 v3, s[8:11], s37 offen offset:3072 sc1 lds
v_mul_f32 v97, 0x3a800000, v97
v_mul_f32 v98, 0x3a800000, v98
v_mul_f32 v99, 0x3a800000, v99
s_add_u32 s38, s35, 6
s_and_b32 s38, s38, 15
s_mul_i32 s38, s38, 458752
s_add_u32 m0, s50, 0
s_nop 0
buffer_load_dwordx4 v6, s[16:19], s38 offen lds
v_fma_f32 v97, -v96, v96, v97
v_fma_f32 v99, -v98, v98, v99
v_max_f32 v97, 0, v97
s_add_u32 m0, s50, 1024
s_nop 0
buffer_load_dwordx4 v7, s[16:19], s38 offen lds
v_max_f32 v99, 0, v99
v_add_f32 v97, 0x3727c5ac, v97
v_add_f32 v99, 0x3727c5ac, v99
v_rsq_f32 v97, v97
s_add_u32 m0, s50, 2048
s_nop 0
buffer_load_dwordx4 v8, s[16:19], s38 offen lds
v_rsq_f32 v99, v99
v_and_b32 v100, 7, v1
s_lshl_b32 s43, s47, 8
s_add_u32 m0, s50, 3072
s_add_u32 s38, s38, 114688
buffer_load_dwordx4 v6, s[16:19], s38 offen lds
s_add_u32 s43, s43, 147456
v_lshl_add_u32 v100, v100, 4, s43
v_lshrrev_b32 v101, 5, v1
v_lshl_add_u32 v100, v101, 7, v100
s_add_u32 m0, s50, 4096
s_nop 0
buffer_load_dwordx4 v7, s[16:19], s38 offen lds
s_add_u32 m0, s50, 5120
s_nop 0
buffer_load_dwordx4 v8, s[16:19], s38 offen lds
s_waitcnt vmcnt(10)
s_barrier
ds_write_b128 v100, v[96:99]
s_waitcnt lgkmcnt(0)
s_add_u32 s37, s35, 7
s_and_b32 s37, s37, 15
s_mul_i32 s37, s37, 16384
s_add_u32 m0, s39, 49152
s_nop 0
buffer_load_dwordx4 v3, s[8:11], s37 offen sc1 lds
s_load_dword s3, s[4:5], 35840
buffer_load_dwordx4 v3, s[8:11], s37 offen offset:1024 sc1 lds
s_load_dword s3, s[4:5], 35904
buffer_load_dwordx4 v3, s[8:11], s37 offen offset:2048 sc1 lds
s_load_dword s3, s[4:5], 35968
s_load_dword s3, s[4:5], 36032
buffer_load_dwordx4 v3, s[8:11], s37 offen offset:3072 sc1 lds
s_load_dword s3, s[4:5], 43008
s_add_u32 s38, s35, 7
s_and_b32 s38, s38, 15
s_mul_i32 s38, s38, 458752
s_add_u32 m0, s50, 49152
s_nop 0
buffer_load_dwordx4 v6, s[16:19], s38 offen lds
s_load_dword s3, s[4:5], 43072
s_add_u32 m0, s50, 50176
s_nop 0
buffer_load_dwordx4 v7, s[16:19], s38 offen lds
s_load_dword s3, s[4:5], 43136
s_load_dword s3, s[4:5], 43200
s_add_u32 m0, s50, 51200
s_nop 0
buffer_load_dwordx4 v8, s[16:19], s38 offen lds
s_load_dword s3, s[4:5], 50176
s_add_u32 m0, s50, 52224
s_add_u32 s38, s38, 114688
buffer_load_dwordx4 v6, s[16:19], s38 offen lds
s_load_dword s3, s[4:5], 50240
s_load_dword s3, s[4:5], 50304
s_add_u32 m0, s50, 53248
s_nop 0
buffer_load_dwordx4 v7, s[16:19], s38 offen lds
s_add_u32 m0, s50, 54272
s_nop 0
buffer_load_dwordx4 v8, s[16:19], s38 offen lds
s_waitcnt vmcnt(10)
s_barrier
s_add_u32 s37, s35, 8
s_and_b32 s37, s37, 15
s_mul_i32 s37, s37, 16384
s_add_u32 m0, s39, 98304
s_nop 0
buffer_load_dwordx4 v3, s[8:11], s37 offen sc1 lds
s_load_dword s3, s[4:5], 50368
s_load_dword s3, s[4:5], 57344
s_load_dword s3, s[4:5], 57408
buffer_load_dwordx4 v3, s[8:11], s37 offen offset:1024 sc1 lds
s_load_dword s3, s[4:5], 57472
s_load_dword s3, s[4:5], 57536
s_load_dword s3, s[4:5], 64512
s_load_dword s3, s[4:5], 64576
buffer_load_dwordx4 v3, s[8:11], s37 offen offset:2048 sc1 lds
s_load_dword s3, s[4:5], 64640
s_load_dword s3, s[4:5], 64704
s_load_dword s3, s[4:5], 71680
s_load_dword s3, s[4:5], 71744
buffer_load_dwordx4 v3, s[8:11], s37 offen offset:3072 sc1 lds
v_lshrrev_b32 v28, 2, v1
v_and_b32 v29, 7, v28
v_mul_u32_u24 v28, 256, v28
v_lshl_add_u32 v28, v29, 5, v28
s_add_u32 s38, s35, 8
s_and_b32 s38, s38, 15
s_mul_i32 s38, s38, 458752
s_add_u32 m0, s50, 98304
s_nop 0
buffer_load_dwordx4 v6, s[16:19], s38 offen lds
v_and_b32 v29, 3, v1
v_lshl_add_u32 v11, v29, 3, v28
s_lshl_b32 s43, s63, 7
v_xor_b32 v11, s43, v11
s_add_u32 m0, s50, 99328
s_nop 0
buffer_load_dwordx4 v7, s[16:19], s38 offen lds
v_add_u32 v11, 16384, v11
v_xor_b32 v12, 32, v11
v_xor_b32 v13, 64, v11
v_xor_b32 v14, 96, v11
s_add_u32 m0, s50, 100352
s_nop 0
buffer_load_dwordx4 v8, s[16:19], s38 offen lds
v_add_u32 v15, 49152, v11
v_add_u32 v16, 49152, v12
v_add_u32 v17, 49152, v13
v_add_u32 v18, 49152, v14
s_add_u32 m0, s50, 101376
s_add_u32 s38, s38, 114688
buffer_load_dwordx4 v6, s[16:19], s38 offen lds
v_add_u32 v19, 98304, v11
v_add_u32 v20, 98304, v12
v_add_u32 v21, 98304, v13
v_add_u32 v22, 98304, v14
s_add_u32 m0, s50, 102400
s_nop 0
buffer_load_dwordx4 v7, s[16:19], s38 offen lds
s_add_u32 m0, s50, 103424
s_nop 0
buffer_load_dwordx4 v8, s[16:19], s38 offen lds
s_waitcnt vmcnt(10)
s_barrier
s_cmp_eq_u32 s47, 3
s_cbranch_scc0 Lw_123
s_mul_i32 s60, s35, 96
s_add_u32 s61, s60, 95
s_and_b32 s60, s60, 0xff80
s_and_b32 s61, s61, 0xff80
s_add_u32 s60, s60, 28323840
s_add_u32 s61, s61, 28323840
s_load_dword s92, s[82:83], s60 glc
s_load_dword s93, s[82:83], s61 glc
Lw_123:
s_add_u32 s37, s35, 9
s_and_b32 s37, s37, 15
s_mul_i32 s37, s37, 16384
s_add_u32 m0, s39, 0
s_nop 0
buffer_load_dwordx4 v3, s[8:11], s37 offen sc1 lds
buffer_load_dwordx4 v3, s[8:11], s37 offen offset:1024 sc1 lds
buffer_load_dwordx4 v3, s[8:11], s37 offen offset:2048 sc1 lds
buffer_load_dwordx4 v3, s[8:11], s37 offen offset:3072 sc1 lds
s_add_u32 s38, s35, 9
s_and_b32 s38, s38, 15
s_mul_i32 s38, s38, 458752
s_add_u32 m0, s50, 0
s_nop 0
buffer_load_dwordx4 v6, s[16:19], s38 offen lds
s_add_u32 m0, s50, 1024
s_nop 0
buffer_load_dwordx4 v7, s[16:19], s38 offen lds
s_add_u32 m0, s50, 2048
s_nop 0
buffer_load_dwordx4 v8, s[16:19], s38 offen lds
s_add_u32 m0, s50, 3072
s_add_u32 s38, s38, 114688
buffer_load_dwordx4 v6, s[16:19], s38 offen lds
s_add_u32 m0, s50, 4096
s_nop 0
buffer_load_dwordx4 v7, s[16:19], s38 offen lds
s_add_u32 m0, s50, 5120
s_nop 0
buffer_load_dwordx4 v8, s[16:19], s38 offen lds
s_waitcnt vmcnt(10)
s_barrier
s_add_u32 s37, s35, 10
s_and_b32 s37, s37, 15
s_mul_i32 s37, s37, 16384
s_add_u32 m0, s39, 49152
s_nop 0
buffer_load_dwordx4 v3, s[8:11], s37 offen sc1 lds
buffer_load_dwordx4 v3, s[8:11], s37 offen offset:1024 sc1 lds
buffer_load_dwordx4 v3, s[8:11], s37 offen offset:2048 sc1 lds
buffer_load_dwordx4 v3, s[8:11], s37 offen offset:3072 sc1 lds
s_add_u32 s38, s35, 10
s_and_b32 s38, s38, 15
s_mul_i32 s38, s38, 458752
s_add_u32 m0, s50, 49152
s_nop 0
buffer_load_dwordx4 v6, s[16:19], s38 offen lds
s_add_u32 m0, s50, 50176
s_nop 0
buffer_load_dwordx4 v7, s[16:19], s38 offen lds
s_add_u32 m0, s50, 51200
s_nop 0
buffer_load_dwordx4 v8, s[16:19], s38 offen lds
s_add_u32 m0, s50, 52224
s_add_u32 s38, s38, 114688
buffer_load_dwordx4 v6, s[16:19], s38 offen lds
s_add_u32 m0, s50, 53248
s_nop 0
buffer_load_dwordx4 v7, s[16:19], s38 offen lds
s_add_u32 m0, s50, 54272
s_nop 0
buffer_load_dwordx4 v8, s[16:19], s38 offen lds
s_mov_b32 s38, 0
buffer_load_dwordx4 v[40:43], v24, s[88:91], s38 offen
s_mov_b32 s38, 28672
buffer_load_dwordx4 v[44:47], v24, s[88:91], s38 offen
s_mov_b32 s38, 57344
buffer_load_dwordx4 v[48:51], v24, s[88:91], s38 offen
s_mov_b32 s38, 86016
buffer_load_dwordx4 v[52:55], v24, s[88:91], s38 offen
s_mov_b32 s38, 114688
buffer_load_dwordx4 v[56:59], v24, s[88:91], s38 offen
s_mov_b32 s38, 143360
buffer_load_dwordx4 v[60:63], v24, s[88:91], s38 offen
s_mov_b32 s38, 172032
buffer_load_dwordx4 v[64:67], v24, s[88:91], s38 offen
s_mov_b32 s38, 200704
buffer_load_dwordx4 v[68:71], v24, s[88:91], s38 offen
s_waitcnt vmcnt(18)
s_cmp_eq_u32 s47, 3
s_cbranch_scc0 Lw_124
s_mov_b32 s41, 0x40000
Lcp_125:
s_waitcnt lgkmcnt(0)
s_and_b32 s92, s92, s93
s_cmp_eq_u32 s92, 16
s_cbranch_scc1 Lco_126
s_load_dword s92, s[82:83], s60 glc
s_load_dword s93, s[82:83], s61 glc
s_sub_u32 s41, s41, 1
s_cmp_lg_u32 s41, 0
s_cbranch_scc1 Lcp_125
s_waitcnt lgkmcnt(0)
Lco_126:
Lw_124:
s_barrier
s_mov_b32 s45, s47
s_cmp_ge_u32 s45, 3
s_cselect_b32 s43, 1, 0
s_mul_i32 s44, s43, 3
s_sub_u32 s45, s45, s44
s_lshl_b32 s45, s45, 7
s_mul_i32 s52, s43, 896
s_add_u32 s52, s52, s45
s_add_u32 s52, s52, 148992
s_mul_i32 s43, s43, 14336
s_add_u32 s43, s43, s45
s_mul_i32 s44, s35, 384
s_add_u32 s43, s43, s44
s_add_u32 s60, s43, 8192
s_add_u32 s45, s47, 4
s_min_u32 s45, s45, 5
s_cmp_ge_u32 s45, 3
s_cselect_b32 s43, 1, 0
s_branch Lov_14
.p2align 12
.fill 112, 4, 0xbf800000
Lst_14_0:
s_branch Lwr_154
Lst_14_1:
s_branch Lwr_162
s_nop 0
Lov_14:
s_mul_i32 s44, s43, 3
s_sub_u32 s45, s45, s44
s_lshl_b32 s45, s45, 7
s_mul_i32 s53, s43, 896
s_add_u32 s53, s53, s45
s_add_u32 s53, s53, 148992
s_mul_i32 s43, s43, 14336
s_add_u32 s43, s43, s45
s_mul_i32 s44, s35, 384
s_add_u32 s43, s43, s44
s_add_u32 s61, s43, 8192
v_lshrrev_b32 v104, 3, v1
v_mul_u32_u24 v104, 28672, v104
v_and_b32 v105, 7, v1
v_lshl_add_u32 v104, v105, 4, v104
buffer_load_dwordx4 v[96:99], v104, s[84:87], s60 offen sc1
s_load_dword s3, s[4:5], 71808
s_load_dword s3, s[4:5], 71872
buffer_load_dwordx4 v[100:103], v104, s[84:87], s61 offen sc1
s_and_b32 s44, s36, 3
s_mul_i32 s43, s2, 28672
s_add_u32 s37, s35, 11
s_and_b32 s37, s37, 15
s_mul_i32 s37, s37, 16384
s_add_u32 m0, s39, 98304
s_nop 0
buffer_load_dwordx4 v3, s[8:11], s37 offen sc1 lds
s_mul_i32 s44, s44, 7168
s_add_u32 s43, s43, s44
buffer_load_dwordx4 v3, s[8:11], s37 offen offset:1024 sc1 lds
s_add_u32 s4, s76, s43
s_addc_u32 s5, s77, 0
s_load_dword s3, s[4:5], 0
buffer_load_dwordx4 v3, s[8:11], s37 offen offset:2048 sc1 lds
s_load_dword s3, s[4:5], 64
s_load_dword s3, s[4:5], 128
buffer_load_dwordx4 v3, s[8:11], s37 offen offset:3072 sc1 lds
s_load_dword s3, s[4:5], 192
s_load_dword s3, s[4:5], 256
s_add_u32 s38, s35, 11
s_and_b32 s38, s38, 15
s_mul_i32 s38, s38, 458752
s_add_u32 m0, s50, 98304
s_nop 0
buffer_load_dwordx4 v6, s[16:19], s38 offen lds
s_load_dword s3, s[4:5], 320
s_load_dword s3, s[4:5], 384
s_load_dword s3, s[4:5], 448
s_add_u32 m0, s50, 99328
s_nop 0
buffer_load_dwordx4 v7, s[16:19], s38 offen lds
v_cmp_gt_u32 vcc, 32, v1
v_mov_b32 v104, s52
s_add_u32 m0, s50, 100352
s_nop 0
buffer_load_dwordx4 v8, s[16:19], s38 offen lds
v_mov_b32 v106, s53
v_cndmask_b32 v104, v106, v104, vcc
s_add_u32 m0, s50, 101376
s_add_u32 s38, s38, 114688
buffer_load_dwordx4 v6, s[16:19], s38 offen lds
v_lshl_add_u32 v104, v105, 4, v104
v_bfe_u32 v105, v1, 4, 1
v_lshl_add_u32 v104, v105, 2, v104
s_add_u32 m0, s50, 102400
s_nop 0
buffer_load_dwordx4 v7, s[16:19], s38 offen lds
s_add_u32 m0, s50, 103424
s_nop 0
buffer_load_dwordx4 v8, s[16:19], s38 offen lds
s_waitcnt vmcnt(20)
s_barrier
s_add_u32 s37, s35, 12
s_and_b32 s37, s37, 15
s_mul_i32 s37, s37, 16384
s_add_u32 m0, s39, 0
s_nop 0
buffer_load_dwordx4 v3, s[8:11], s37 offen sc1 lds
buffer_load_dwordx4 v3, s[8:11], s37 offen offset:1024 sc1 lds
buffer_load_dwordx4 v3, s[8:11], s37 offen offset:2048 sc1 lds
buffer_load_dwordx4 v3, s[8:11], s37 offen offset:3072 sc1 lds
s_add_u32 s38, s35, 12
s_and_b32 s38, s38, 15
s_mul_i32 s38, s38, 458752
s_add_u32 m0, s50, 0
s_nop 0
buffer_load_dwordx4 v6, s[16:19], s38 offen lds
s_add_u32 m0, s50, 1024
s_nop 0
buffer_load_dwordx4 v7, s[16:19], s38 offen lds
s_add_u32 m0, s50, 2048
s_nop 0
buffer_load_dwordx4 v8, s[16:19], s38 offen lds
s_add_u32 m0, s50, 3072
s_add_u32 s38, s38, 114688
buffer_load_dwordx4 v6, s[16:19], s38 offen lds
s_add_u32 m0, s50, 4096
s_nop 0
buffer_load_dwordx4 v7, s[16:19], s38 offen lds
s_add_u32 m0, s50, 5120
s_nop 0
buffer_load_dwordx4 v8, s[16:19], s38 offen lds
s_waitcnt vmcnt(10)
s_barrier
v_permlane32_swap_b32 v96, v100
v_permlane32_swap_b32 v97, v101
v_permlane32_swap_b32 v98, v102
v_permlane32_swap_b32 v99, v103
v_add_f32 v96, v96, v100
v_add_f32 v97, v97, v101
v_add_f32 v98, v98, v102
v_add_f32 v99, v99, v103
s_nop 1
v_permlane16_swap_b32 v96, v97
v_permlane16_swap_b32 v98, v99
v_add_f32 v96, v96, v97
v_add_f32 v98, v98, v99
s_nop 1
v_add_f32_dpp v96, v96, v96 row_ror:8 row_mask:0xf bank_mask:0xf
v_add_f32_dpp v98, v98, v98 row_ror:8 row_mask:0xf bank_mask:0xf
ds_write_b32 v104, v96
ds_write_b32 v104, v98 offset:8
s_waitcnt lgkmcnt(0)
s_add_u32 s37, s35, 13
s_and_b32 s37, s37, 15
s_mul_i32 s37, s37, 16384
s_add_u32 m0, s39, 49152
s_nop 0
buffer_load_dwordx4 v3, s[8:11], s37 offen sc1 lds
s_load_dword s3, s[4:5], 512
s_load_dword s3, s[4:5], 576
s_load_dword s3, s[4:5], 640
s_load_dword s3, s[4:5], 704
s_load_dword s3, s[4:5], 768
buffer_load_dwordx4 v3, s[8:11], s37 offen offset:1024 sc1 lds
s_load_dword s3, s[4:5], 832
s_load_dword s3, s[4:5], 896
s_load_dword s3, s[4:5], 960
s_load_dword s3, s[4:5], 1024
s_load_dword s3, s[4:5], 1088
buffer_load_dwordx4 v3, s[8:11], s37 offen offset:2048 sc1 lds
v_lshlrev_b32 v72, 16, v40
v_and_b32 v73, 0xffff0000, v40
v_lshlrev_b32 v74, 16, v41
v_and_b32 v75, 0xffff0000, v41
v_lshlrev_b32 v76, 16, v42
v_and_b32 v77, 0xffff0000, v42
buffer_load_dwordx4 v3, s[8:11], s37 offen offset:3072 sc1 lds
v_lshlrev_b32 v78, 16, v43
v_and_b32 v79, 0xffff0000, v43
v_lshlrev_b32 v80, 16, v44
v_and_b32 v81, 0xffff0000, v44
v_lshlrev_b32 v82, 16, v45
s_add_u32 s38, s35, 13
s_and_b32 s38, s38, 15
s_mul_i32 s38, s38, 458752
s_add_u32 m0, s50, 49152
s_nop 0
buffer_load_dwordx4 v6, s[16:19], s38 offen lds
v_and_b32 v83, 0xffff0000, v45
v_lshlrev_b32 v84, 16, v46
v_and_b32 v85, 0xffff0000, v46
v_lshlrev_b32 v86, 16, v47
v_and_b32 v87, 0xffff0000, v47
s_add_u32 m0, s50, 50176
s_nop 0
buffer_load_dwordx4 v7, s[16:19], s38 offen lds
v_add_f32 v72, v72, v80
v_add_f32 v73, v73, v81
v_add_f32 v74, v74, v82
v_add_f32 v75, v75, v83
v_add_f32 v76, v76, v84
v_add_f32 v77, v77, v85
s_add_u32 m0, s50, 51200
s_nop 0
buffer_load_dwordx4 v8, s[16:19], s38 offen lds
v_add_f32 v78, v78, v86
v_add_f32 v79, v79, v87
v_lshlrev_b32 v80, 16, v48
v_and_b32 v81, 0xffff0000, v48
v_lshlrev_b32 v82, 16, v49
s_add_u32 m0, s50, 52224
s_add_u32 s38, s38, 114688
buffer_load_dwordx4 v6, s[16:19], s38 offen lds
v_and_b32 v83, 0xffff0000, v49
v_lshlrev_b32 v84, 16, v50
v_and_b32 v85, 0xffff0000, v50
v_lshlrev_b32 v86, 16, v51
v_and_b32 v87, 0xffff0000, v51
v_add_f32 v72, v72, v80
s_add_u32 m0, s50, 53248
s_nop 0
buffer_load_dwordx4 v7, s[16:19], s38 offen lds
s_add_u32 m0, s50, 54272
s_nop 0
buffer_load_dwordx4 v8, s[16:19], s38 offen lds
s_waitcnt vmcnt(10)
s_barrier
s_add_u32 s37, s35, 14
s_and_b32 s37, s37, 15
s_mul_i32 s37, s37, 16384
s_add_u32 m0, s39, 98304
s_nop 0
buffer_load_dwordx4 v3, s[8:11], s37 offen sc1 lds
s_load_dword s3, s[4:5], 1152
s_load_dword s3, s[4:5], 1216
s_load_dword s3, s[4:5], 1280
s_load_dword s3, s[4:5], 1344
s_load_dword s3, s[4:5], 1408
buffer_load_dwordx4 v3, s[8:11], s37 offen offset:1024 sc1 lds
s_load_dword s3, s[4:5], 1472
s_load_dword s3, s[4:5], 1536
s_load_dword s3, s[4:5], 1600
s_load_dword s3, s[4:5], 1664
s_load_dword s3, s[4:5], 1728
v_add_f32 v73, v73, v81
buffer_load_dwordx4 v3, s[8:11], s37 offen offset:2048 sc1 lds
v_add_f32 v74, v74, v82
v_add_f32 v75, v75, v83
v_add_f32 v76, v76, v84
v_add_f32 v77, v77, v85
v_add_f32 v78, v78, v86
buffer_load_dwordx4 v3, s[8:11], s37 offen offset:3072 sc1 lds
v_add_f32 v79, v79, v87
v_lshlrev_b32 v80, 16, v52
v_and_b32 v81, 0xffff0000, v52
v_lshlrev_b32 v82, 16, v53
v_and_b32 v83, 0xffff0000, v53
v_lshlrev_b32 v84, 16, v54
s_add_u32 s38, s35, 14
s_and_b32 s38, s38, 15
s_mul_i32 s38, s38, 458752
s_add_u32 m0, s50, 98304
s_nop 0
buffer_load_dwordx4 v6, s[16:19], s38 offen lds
v_and_b32 v85, 0xffff0000, v54
v_lshlrev_b32 v86, 16, v55
v_and_b32 v87, 0xffff0000, v55
v_add_f32 v72, v72, v80
v_add_f32 v73, v73, v81
s_add_u32 m0, s50, 99328
s_nop 0
buffer_load_dwordx4 v7, s[16:19], s38 offen lds
v_add_f32 v74, v74, v82
v_add_f32 v75, v75, v83
v_add_f32 v76, v76, v84
v_add_f32 v77, v77, v85
v_add_f32 v78, v78, v86
v_add_f32 v79, v79, v87
s_add_u32 m0, s50, 100352
s_nop 0
buffer_load_dwordx4 v8, s[16:19], s38 offen lds
v_lshlrev_b32 v80, 16, v56
v_and_b32 v81, 0xffff0000, v56
v_lshlrev_b32 v82, 16, v57
v_and_b32 v83, 0xffff0000, v57
v_lshlrev_b32 v84, 16, v58
s_add_u32 m0, s50, 101376
s_add_u32 s38, s38, 114688
buffer_load_dwordx4 v6, s[16:19], s38 offen lds
v_and_b32 v85, 0xffff0000, v58
v_lshlrev_b32 v86, 16, v59
v_and_b32 v87, 0xffff0000, v59
v_add_f32 v72, v72, v80
v_add_f32 v73, v73, v81
v_add_f32 v74, v74, v82
s_add_u32 m0, s50, 102400
s_nop 0
buffer_load_dwordx4 v7, s[16:19], s38 offen lds
s_add_u32 m0, s50, 103424
s_nop 0
buffer_load_dwordx4 v8, s[16:19], s38 offen lds
s_waitcnt vmcnt(10)
s_barrier
s_add_u32 s37, s35, 15
s_and_b32 s37, s37, 15
s_mul_i32 s37, s37, 16384
s_add_u32 m0, s39, 0
s_nop 0
buffer_load_dwordx4 v3, s[8:11], s37 offen sc1 lds
v_add_f32 v75, v75, v83
v_add_f32 v76, v76, v84
v_add_f32 v77, v77, v85
v_add_f32 v78, v78, v86
buffer_load_dwordx4 v3, s[8:11], s37 offen offset:1024 sc1 lds
v_add_f32 v79, v79, v87
v_lshlrev_b32 v80, 16, v60
v_and_b32 v81, 0xffff0000, v60
v_lshlrev_b32 v82, 16, v61
buffer_load_dwordx4 v3, s[8:11], s37 offen offset:2048 sc1 lds
v_and_b32 v83, 0xffff0000, v61
v_lshlrev_b32 v84, 16, v62
v_and_b32 v85, 0xffff0000, v62
v_lshlrev_b32 v86, 16, v63
buffer_load_dwordx4 v3, s[8:11], s37 offen offset:3072 sc1 lds
v_and_b32 v87, 0xffff0000, v63
v_add_f32 v72, v72, v80
v_add_f32 v73, v73, v81
v_add_f32 v74, v74, v82
s_add_u32 s38, s35, 15
s_and_b32 s38, s38, 15
s_mul_i32 s38, s38, 458752
s_add_u32 m0, s50, 0
s_nop 0
buffer_load_dwordx4 v6, s[16:19], s38 offen lds
v_add_f32 v75, v75, v83
v_add_f32 v76, v76, v84
v_add_f32 v77, v77, v85
v_add_f32 v78, v78, v86
s_add_u32 m0, s50, 1024
s_nop 0
buffer_load_dwordx4 v7, s[16:19], s38 offen lds
v_add_f32 v79, v79, v87
v_lshlrev_b32 v80, 16, v64
v_and_b32 v81, 0xffff0000, v64
v_lshlrev_b32 v82, 16, v65
s_add_u32 m0, s50, 2048
s_nop 0
buffer_load_dwordx4 v8, s[16:19], s38 offen lds
v_and_b32 v83, 0xffff0000, v65
v_lshlrev_b32 v84, 16, v66
v_and_b32 v85, 0xffff0000, v66
v_lshlrev_b32 v86, 16, v67
s_add_u32 m0, s50, 3072
s_add_u32 s38, s38, 114688
buffer_load_dwordx4 v6, s[16:19], s38 offen lds
v_and_b32 v87, 0xffff0000, v67
v_add_f32 v72, v72, v80
v_add_f32 v73, v73, v81
v_add_f32 v74, v74, v82
v_add_f32 v75, v75, v83
s_add_u32 m0, s50, 4096
s_nop 0
buffer_load_dwordx4 v7, s[16:19], s38 offen lds
s_add_u32 m0, s50, 5120
s_nop 0
buffer_load_dwordx4 v8, s[16:19], s38 offen lds
s_waitcnt vmcnt(10)
s_barrier
s_add_u32 s38, s35, 13
s_and_b32 s38, s38, 15
s_mul_i32 s38, s38, 458752
s_add_u32 m0, s40, 49152
s_nop 0
buffer_load_dwordx4 v4, s[12:15], s38 offen lds
v_add_f32 v76, v76, v84
v_add_f32 v77, v77, v85
v_add_f32 v78, v78, v86
v_add_f32 v79, v79, v87
v_lshlrev_b32 v80, 16, v68
s_add_u32 m0, s40, 50176
s_nop 0
buffer_load_dwordx4 v5, s[12:15], s38 offen lds
v_and_b32 v81, 0xffff0000, v68
v_lshlrev_b32 v82, 16, v69
v_and_b32 v83, 0xffff0000, v69
v_lshlrev_b32 v84, 16, v70
v_and_b32 v85, 0xffff0000, v70
v_lshlrev_b32 v86, 16, v71
s_add_u32 m0, s40, 51200
s_add_u32 s38, s38, 57344
buffer_load_dwordx4 v4, s[12:15], s38 offen lds
v_and_b32 v87, 0xffff0000, v71
v_add_f32 v72, v72, v80
v_add_f32 v73, v73, v81
v_add_f32 v74, v74, v82
v_add_f32 v75, v75, v83
v_add_f32 v76, v76, v84
s_add_u32 m0, s40, 52224
s_nop 0
buffer_load_dwordx4 v5, s[12:15], s38 offen lds
v_add_f32 v77, v77, v85
v_add_f32 v78, v78, v86
v_add_f32 v79, v79, v87
s_nop 0
v_permlane32_swap_b32 v72, v76
s_add_u32 m0, s40, 53248
s_add_u32 s38, s38, 57344
buffer_load_dwordx4 v4, s[12:15], s38 offen lds
v_permlane32_swap_b32 v73, v77
v_permlane32_swap_b32 v74, v78
v_permlane32_swap_b32 v75, v79
v_add_f32 v72, v72, v76
v_add_f32 v73, v73, v77
v_add_f32 v74, v74, v78
s_add_u32 m0, s40, 54272
s_nop 0
buffer_load_dwordx4 v5, s[12:15], s38 offen lds
v_add_f32 v75, v75, v79
s_nop 0
v_permlane16_swap_b32 v72, v74
v_permlane16_swap_b32 v73, v75
v_add_f32 v72, v72, v74
v_add_f32 v73, v73, v75
s_add_u32 m0, s40, 55296
s_add_u32 s38, s38, 57344
buffer_load_dwordx4 v4, s[12:15], s38 offen lds
s_add_u32 m0, s40, 56320
s_nop 0
buffer_load_dwordx4 v5, s[12:15], s38 offen lds
s_waitcnt vmcnt(8)
s_barrier
s_lshl_b32 s43, s47, 9
s_add_u32 s43, s43, 153600
v_and_b32 v80, 15, v1
v_lshl_add_u32 v80, v80, 5, s43
v_lshrrev_b32 v81, 4, v1
v_lshl_add_u32 v80, v81, 3, v80
ds_write_b64 v80, v[72:73]
s_waitcnt lgkmcnt(0)
s_add_u32 s38, s35, 14
s_and_b32 s38, s38, 15
s_mul_i32 s38, s38, 458752
s_add_u32 m0, s40, 98304
s_nop 0
buffer_load_dwordx4 v4, s[12:15], s38 offen lds
s_bfe_u32 s61, s35, 0x10002
s_lshr_b32 s60, s35, 3
s_lshl_b32 s60, s60, 2
s_and_b32 s43, s35, 3
s_add_u32 s60, s60, s43
s_add_u32 m0, s40, 99328
s_nop 0
buffer_load_dwordx4 v5, s[12:15], s38 offen lds
s_lshl_b32 s43, s60, 8
s_add_u32 s28, s76, s43
s_addc_u32 s29, s77, 0
s_mov_b32 s30, 7338240
s_mov_b32 s31, 0x20000
s_add_u32 m0, s40, 100352
s_add_u32 s38, s38, 57344
buffer_load_dwordx4 v4, s[12:15], s38 offen lds
s_mul_i32 s52, s61, 196608
s_mul_i32 s53, s61, 1572864
s_mul_i32 s90, s61, 163840
s_mul_i32 s91, s61, 1310720
s_and_b32 s43, s35, 3
s_add_u32 m0, s40, 101376
s_nop 0
buffer_load_dwordx4 v5, s[12:15], s38 offen lds
s_mul_i32 s32, s43, 3
s_mul_i32 s33, s43, 10
s_lshr_b32 s33, s33, 2
s_lshl_b32 s51, s47, 11
s_lshl_b32 s44, s47, 15
s_add_u32 m0, s40, 102400
s_add_u32 s38, s38, 57344
buffer_load_dwordx4 v4, s[12:15], s38 offen lds
v_lshrrev_b32 v122, 4, v1
v_lshlrev_b32 v123, 1, v122
v_and_b32 v23, 15, v1
v_xor_b32 v23, v23, v123
v_lshlrev_b32 v23, 4, v23
s_add_u32 m0, s40, 103424
s_nop 0
buffer_load_dwordx4 v5, s[12:15], s38 offen lds
v_mul_u32_u24 v122, 2048, v122
v_add_u32 v23, v23, v122
v_add_u32 v23, s44, v23
v_xor_b32 v24, 128, v23
v_add_u32 v24, 8192, v24
s_add_u32 m0, s40, 104448
s_add_u32 s38, s38, 57344
buffer_load_dwordx4 v4, s[12:15], s38 offen lds
s_add_u32 m0, s40, 105472
s_nop 0
buffer_load_dwordx4 v5, s[12:15], s38 offen lds
s_waitcnt vmcnt(8)
s_barrier
ds_read_b128 v[28:31], v9 offset:49152
ds_read_b64_tr_b16 v[44:45], v15 offset:0
ds_read_b64_tr_b16 v[46:47], v15 offset:4096
ds_read_b64_tr_b16 v[48:49], v16 offset:0
ds_read_b64_tr_b16 v[50:51], v16 offset:4096
ds_read_b64_tr_b16 v[52:53], v17 offset:0
ds_read_b64_tr_b16 v[54:55], v17 offset:4096
ds_read_b64_tr_b16 v[56:57], v18 offset:0
ds_read_b64_tr_b16 v[58:59], v18 offset:4096
ds_read_b64_tr_b16 v[60:61], v15 offset:16384
ds_read_b64_tr_b16 v[62:63], v15 offset:20480
ds_read_b64_tr_b16 v[64:65], v16 offset:16384
ds_read_b64_tr_b16 v[66:67], v16 offset:20480
ds_read_b64_tr_b16 v[68:69], v17 offset:16384
ds_read_b64_tr_b16 v[70:71], v17 offset:20480
ds_read_b64_tr_b16 v[72:73], v18 offset:16384
ds_read_b64_tr_b16 v[74:75], v18 offset:20480
ds_read_b128 v[32:35], v9 offset:50176
ds_read_b128 v[36:39], v9 offset:51200
ds_read_b128 v[40:43], v9 offset:52224
s_waitcnt lgkmcnt(0)
v_mfma_f32_16x16x32_bf16 v[124:127], v[44:47], v[28:31], 0
ds_read_b128 v[76:79], v9 offset:57344
v_mfma_f32_16x16x32_bf16 v[156:159], v[44:47], v[32:35], 0
ds_read_b64_tr_b16 v[92:93], v15 offset:8192
v_mfma_f32_16x16x32_bf16 v[188:191], v[44:47], v[36:39], 0
ds_read_b64_tr_b16 v[94:95], v15 offset:12288
v_mfma_f32_16x16x32_bf16 v[220:223], v[44:47], v[40:43], 0
ds_read_b64_tr_b16 v[96:97], v16 offset:8192
v_mfma_f32_16x16x32_bf16 v[224:227], v[48:51], v[40:43], 0
ds_read_b64_tr_b16 v[98:99], v16 offset:12288
v_mfma_f32_16x16x32_bf16 v[192:195], v[48:51], v[36:39], 0
ds_read_b64_tr_b16 v[100:101], v17 offset:8192
v_mfma_f32_16x16x32_bf16 v[160:163], v[48:51], v[32:35], 0
ds_read_b64_tr_b16 v[102:103], v17 offset:12288
v_mfma_f32_16x16x32_bf16 v[128:131], v[48:51], v[28:31], 0
ds_read_b64_tr_b16 v[104:105], v18 offset:8192
v_mfma_f32_16x16x32_bf16 v[132:135], v[52:55], v[28:31], 0
ds_read_b64_tr_b16 v[106:107], v18 offset:12288
v_mfma_f32_16x16x32_bf16 v[164:167], v[52:55], v[32:35], 0
ds_read_b64_tr_b16 v[108:109], v15 offset:24576
v_mfma_f32_16x16x32_bf16 v[196:199], v[52:55], v[36:39], 0
ds_read_b64_tr_b16 v[110:111], v15 offset:28672
v_mfma_f32_16x16x32_bf16 v[228:231], v[52:55], v[40:43], 0
ds_read_b64_tr_b16 v[112:113], v16 offset:24576
v_mfma_f32_16x16x32_bf16 v[232:235], v[56:59], v[40:43], 0
ds_read_b64_tr_b16 v[114:115], v16 offset:28672
v_mfma_f32_16x16x32_bf16 v[200:203], v[56:59], v[36:39], 0
ds_read_b64_tr_b16 v[116:117], v17 offset:24576
v_mfma_f32_16x16x32_bf16 v[168:171], v[56:59], v[32:35], 0
ds_read_b64_tr_b16 v[118:119], v17 offset:28672
v_mfma_f32_16x16x32_bf16 v[136:139], v[56:59], v[28:31], 0
ds_read_b64_tr_b16 v[120:121], v18 offset:24576
v_mfma_f32_16x16x32_bf16 v[140:143], v[60:63], v[28:31], 0
ds_read_b64_tr_b16 v[122:123], v18 offset:28672
v_mfma_f32_16x16x32_bf16 v[172:175], v[60:63], v[32:35], 0
ds_read_b128 v[80:83], v9 offset:58368
v_mfma_f32_16x16x32_bf16 v[204:207], v[60:63], v[36:39], 0
ds_read_b128 v[84:87], v9 offset:59392
v_mfma_f32_16x16x32_bf16 v[236:239], v[60:63], v[40:43], 0
ds_read_b128 v[88:91], v9 offset:60416
v_mfma_f32_16x16x32_bf16 v[240:243], v[64:67], v[40:43], 0
v_mfma_f32_16x16x32_bf16 v[208:211], v[64:67], v[36:39], 0
v_mfma_f32_16x16x32_bf16 v[176:179], v[64:67], v[32:35], 0
v_mfma_f32_16x16x32_bf16 v[144:147], v[64:67], v[28:31], 0
v_mfma_f32_16x16x32_bf16 v[148:151], v[68:71], v[28:31], 0
v_mfma_f32_16x16x32_bf16 v[180:183], v[68:71], v[32:35], 0
v_mfma_f32_16x16x32_bf16 v[212:215], v[68:71], v[36:39], 0
v_mfma_f32_16x16x32_bf16 v[244:247], v[68:71], v[40:43], 0
v_mfma_f32_16x16x32_bf16 v[248:251], v[72:75], v[40:43], 0
v_mfma_f32_16x16x32_bf16 v[216:219], v[72:75], v[36:39], 0
v_mfma_f32_16x16x32_bf16 v[184:187], v[72:75], v[32:35], 0
v_mfma_f32_16x16x32_bf16 v[152:155], v[72:75], v[28:31], 0
s_waitcnt vmcnt(0)
s_waitcnt lgkmcnt(0)
s_barrier
v_mfma_f32_16x16x32_bf16 v[124:127], v[92:95], v[76:79], v[124:127]
ds_read_b128 v[28:31], v10 offset:0
v_mfma_f32_16x16x32_bf16 v[156:159], v[92:95], v[80:83], v[156:159]
ds_read_b64_tr_b16 v[44:45], v19 offset:0
v_mfma_f32_16x16x32_bf16 v[188:191], v[92:95], v[84:87], v[188:191]
ds_read_b64_tr_b16 v[46:47], v19 offset:4096
v_mfma_f32_16x16x32_bf16 v[220:223], v[92:95], v[88:91], v[220:223]
ds_read_b64_tr_b16 v[48:49], v20 offset:0
v_mfma_f32_16x16x32_bf16 v[224:227], v[96:99], v[88:91], v[224:227]
ds_read_b64_tr_b16 v[50:51], v20 offset:4096
v_mfma_f32_16x16x32_bf16 v[192:195], v[96:99], v[84:87], v[192:195]
ds_read_b64_tr_b16 v[52:53], v21 offset:0
v_mfma_f32_16x16x32_bf16 v[160:163], v[96:99], v[80:83], v[160:163]
ds_read_b64_tr_b16 v[54:55], v21 offset:4096
v_mfma_f32_16x16x32_bf16 v[128:131], v[96:99], v[76:79], v[128:131]
ds_read_b64_tr_b16 v[56:57], v22 offset:0
v_mfma_f32_16x16x32_bf16 v[132:135], v[100:103], v[76:79], v[132:135]
ds_read_b64_tr_b16 v[58:59], v22 offset:4096
v_mfma_f32_16x16x32_bf16 v[164:167], v[100:103], v[80:83], v[164:167]
ds_read_b64_tr_b16 v[60:61], v19 offset:16384
v_mfma_f32_16x16x32_bf16 v[196:199], v[100:103], v[84:87], v[196:199]
ds_read_b64_tr_b16 v[62:63], v19 offset:20480
v_mfma_f32_16x16x32_bf16 v[228:231], v[100:103], v[88:91], v[228:231]
ds_read_b64_tr_b16 v[64:65], v20 offset:16384
v_mfma_f32_16x16x32_bf16 v[232:235], v[104:107], v[88:91], v[232:235]
ds_read_b64_tr_b16 v[66:67], v20 offset:20480
v_mfma_f32_16x16x32_bf16 v[200:203], v[104:107], v[84:87], v[200:203]
ds_read_b64_tr_b16 v[68:69], v21 offset:16384
v_mfma_f32_16x16x32_bf16 v[168:171], v[104:107], v[80:83], v[168:171]
ds_read_b64_tr_b16 v[70:71], v21 offset:20480
s_branch Lov_15
.p2align 12
.fill 112, 4, 0xbf800000
Lst_15_0:
s_branch Lwr_159
s_nop 0
s_nop 0
Lov_15:
v_mfma_f32_16x16x32_bf16 v[136:139], v[104:107], v[76:79], v[136:139]
ds_read_b64_tr_b16 v[72:73], v22 offset:16384
v_mfma_f32_16x16x32_bf16 v[140:143], v[108:111], v[76:79], v[140:143]
ds_read_b64_tr_b16 v[74:75], v22 offset:20480
v_mfma_f32_16x16x32_bf16 v[172:175], v[108:111], v[80:83], v[172:175]
ds_read_b128 v[32:35], v10 offset:1024
v_mfma_f32_16x16x32_bf16 v[204:207], v[108:111], v[84:87], v[204:207]
ds_read_b128 v[36:39], v10 offset:2048
v_mfma_f32_16x16x32_bf16 v[236:239], v[108:111], v[88:91], v[236:239]
ds_read_b128 v[40:43], v10 offset:3072
v_mfma_f32_16x16x32_bf16 v[240:243], v[112:115], v[88:91], v[240:243]
v_mfma_f32_16x16x32_bf16 v[208:211], v[112:115], v[84:87], v[208:211]
v_mfma_f32_16x16x32_bf16 v[176:179], v[112:115], v[80:83], v[176:179]
v_mfma_f32_16x16x32_bf16 v[144:147], v[112:115], v[76:79], v[144:147]
v_mfma_f32_16x16x32_bf16 v[148:151], v[116:119], v[76:79], v[148:151]
v_mfma_f32_16x16x32_bf16 v[180:183], v[116:119], v[80:83], v[180:183]
v_mfma_f32_16x16x32_bf16 v[212:215], v[116:119], v[84:87], v[212:215]
v_mfma_f32_16x16x32_bf16 v[244:247], v[116:119], v[88:91], v[244:247]
v_mfma_f32_16x16x32_bf16 v[248:251], v[120:123], v[88:91], v[248:251]
v_mfma_f32_16x16x32_bf16 v[216:219], v[120:123], v[84:87], v[216:219]
v_mfma_f32_16x16x32_bf16 v[184:187], v[120:123], v[80:83], v[184:187]
v_mfma_f32_16x16x32_bf16 v[152:155], v[120:123], v[76:79], v[152:155]
s_mov_b32 s41, 5
Lk3l_127:
s_waitcnt lgkmcnt(0)
v_mfma_f32_16x16x32_bf16 v[124:127], v[44:47], v[28:31], v[124:127]
ds_read_b128 v[76:79], v10 offset:8192
v_mfma_f32_16x16x32_bf16 v[156:159], v[44:47], v[32:35], v[156:159]
ds_read_b64_tr_b16 v[92:93], v19 offset:8192
v_mfma_f32_16x16x32_bf16 v[188:191], v[44:47], v[36:39], v[188:191]
ds_read_b64_tr_b16 v[94:95], v19 offset:12288
v_mfma_f32_16x16x32_bf16 v[220:223], v[44:47], v[40:43], v[220:223]
ds_read_b64_tr_b16 v[96:97], v20 offset:8192
v_mfma_f32_16x16x32_bf16 v[224:227], v[48:51], v[40:43], v[224:227]
ds_read_b64_tr_b16 v[98:99], v20 offset:12288
v_mfma_f32_16x16x32_bf16 v[192:195], v[48:51], v[36:39], v[192:195]
ds_read_b64_tr_b16 v[100:101], v21 offset:8192
v_mfma_f32_16x16x32_bf16 v[160:163], v[48:51], v[32:35], v[160:163]
ds_read_b64_tr_b16 v[102:103], v21 offset:12288
v_mfma_f32_16x16x32_bf16 v[128:131], v[48:51], v[28:31], v[128:131]
ds_read_b64_tr_b16 v[104:105], v22 offset:8192
v_mfma_f32_16x16x32_bf16 v[132:135], v[52:55], v[28:31], v[132:135]
ds_read_b64_tr_b16 v[106:107], v22 offset:12288
v_mfma_f32_16x16x32_bf16 v[164:167], v[52:55], v[32:35], v[164:167]
ds_read_b64_tr_b16 v[108:109], v19 offset:24576
v_mfma_f32_16x16x32_bf16 v[196:199], v[52:55], v[36:39], v[196:199]
ds_read_b64_tr_b16 v[110:111], v19 offset:28672
v_mfma_f32_16x16x32_bf16 v[228:231], v[52:55], v[40:43], v[228:231]
ds_read_b64_tr_b16 v[112:113], v20 offset:24576
v_mfma_f32_16x16x32_bf16 v[232:235], v[56:59], v[40:43], v[232:235]
ds_read_b64_tr_b16 v[114:115], v20 offset:28672
v_mfma_f32_16x16x32_bf16 v[200:203], v[56:59], v[36:39], v[200:203]
ds_read_b64_tr_b16 v[116:117], v21 offset:24576
v_mfma_f32_16x16x32_bf16 v[168:171], v[56:59], v[32:35], v[168:171]
ds_read_b64_tr_b16 v[118:119], v21 offset:28672
v_mfma_f32_16x16x32_bf16 v[136:139], v[56:59], v[28:31], v[136:139]
ds_read_b64_tr_b16 v[120:121], v22 offset:24576
v_mfma_f32_16x16x32_bf16 v[140:143], v[60:63], v[28:31], v[140:143]
ds_read_b64_tr_b16 v[122:123], v22 offset:28672
v_mfma_f32_16x16x32_bf16 v[172:175], v[60:63], v[32:35], v[172:175]
ds_read_b128 v[80:83], v10 offset:9216
v_mfma_f32_16x16x32_bf16 v[204:207], v[60:63], v[36:39], v[204:207]
ds_read_b128 v[84:87], v10 offset:10240
v_mfma_f32_16x16x32_bf16 v[236:239], v[60:63], v[40:43], v[236:239]
ds_read_b128 v[88:91], v10 offset:11264
v_mfma_f32_16x16x32_bf16 v[240:243], v[64:67], v[40:43], v[240:243]
v_mfma_f32_16x16x32_bf16 v[208:211], v[64:67], v[36:39], v[208:211]
v_mfma_f32_16x16x32_bf16 v[176:179], v[64:67], v[32:35], v[176:179]
v_mfma_f32_16x16x32_bf16 v[144:147], v[64:67], v[28:31], v[144:147]
v_mfma_f32_16x16x32_bf16 v[148:151], v[68:71], v[28:31], v[148:151]
v_mfma_f32_16x16x32_bf16 v[180:183], v[68:71], v[32:35], v[180:183]
v_mfma_f32_16x16x32_bf16 v[212:215], v[68:71], v[36:39], v[212:215]
v_mfma_f32_16x16x32_bf16 v[244:247], v[68:71], v[40:43], v[244:247]
v_mfma_f32_16x16x32_bf16 v[248:251], v[72:75], v[40:43], v[248:251]
v_mfma_f32_16x16x32_bf16 v[216:219], v[72:75], v[36:39], v[216:219]
v_mfma_f32_16x16x32_bf16 v[184:187], v[72:75], v[32:35], v[184:187]
v_mfma_f32_16x16x32_bf16 v[152:155], v[72:75], v[28:31], v[152:155]
s_waitcnt lgkmcnt(0)
s_barrier
v_mfma_f32_16x16x32_bf16 v[124:127], v[92:95], v[76:79], v[124:127]
ds_read_b128 v[28:31], v9 offset:0
v_mfma_f32_16x16x32_bf16 v[156:159], v[92:95], v[80:83], v[156:159]
ds_read_b64_tr_b16 v[44:45], v11 offset:0
v_mfma_f32_16x16x32_bf16 v[188:191], v[92:95], v[84:87], v[188:191]
ds_read_b64_tr_b16 v[46:47], v11 offset:4096
v_mfma_f32_16x16x32_bf16 v[220:223], v[92:95], v[88:91], v[220:223]
ds_read_b64_tr_b16 v[48:49], v12 offset:0
v_mfma_f32_16x16x32_bf16 v[224:227], v[96:99], v[88:91], v[224:227]
ds_read_b64_tr_b16 v[50:51], v12 offset:4096
v_mfma_f32_16x16x32_bf16 v[192:195], v[96:99], v[84:87], v[192:195]
ds_read_b64_tr_b16 v[52:53], v13 offset:0
v_mfma_f32_16x16x32_bf16 v[160:163], v[96:99], v[80:83], v[160:163]
ds_read_b64_tr_b16 v[54:55], v13 offset:4096
v_mfma_f32_16x16x32_bf16 v[128:131], v[96:99], v[76:79], v[128:131]
ds_read_b64_tr_b16 v[56:57], v14 offset:0
v_mfma_f32_16x16x32_bf16 v[132:135], v[100:103], v[76:79], v[132:135]
ds_read_b64_tr_b16 v[58:59], v14 offset:4096
v_mfma_f32_16x16x32_bf16 v[164:167], v[100:103], v[80:83], v[164:167]
ds_read_b64_tr_b16 v[60:61], v11 offset:16384
v_mfma_f32_16x16x32_bf16 v[196:199], v[100:103], v[84:87], v[196:199]
ds_read_b64_tr_b16 v[62:63], v11 offset:20480
v_mfma_f32_16x16x32_bf16 v[228:231], v[100:103], v[88:91], v[228:231]
ds_read_b64_tr_b16 v[64:65], v12 offset:16384
v_mfma_f32_16x16x32_bf16 v[232:235], v[104:107], v[88:91], v[232:235]
ds_read_b64_tr_b16 v[66:67], v12 offset:20480
v_mfma_f32_16x16x32_bf16 v[200:203], v[104:107], v[84:87], v[200:203]
ds_read_b64_tr_b16 v[68:69], v13 offset:16384
v_mfma_f32_16x16x32_bf16 v[168:171], v[104:107], v[80:83], v[168:171]
ds_read_b64_tr_b16 v[70:71], v13 offset:20480
v_mfma_f32_16x16x32_bf16 v[136:139], v[104:107], v[76:79], v[136:139]
ds_read_b64_tr_b16 v[72:73], v14 offset:16384
v_mfma_f32_16x16x32_bf16 v[140:143], v[108:111], v[76:79], v[140:143]
ds_read_b64_tr_b16 v[74:75], v14 offset:20480
v_mfma_f32_16x16x32_bf16 v[172:175], v[108:111], v[80:83], v[172:175]
ds_read_b128 v[32:35], v9 offset:1024
v_mfma_f32_16x16x32_bf16 v[204:207], v[108:111], v[84:87], v[204:207]
ds_read_b128 v[36:39], v9 offset:2048
v_mfma_f32_16x16x32_bf16 v[236:239], v[108:111], v[88:91], v[236:239]
ds_read_b128 v[40:43], v9 offset:3072
v_mfma_f32_16x16x32_bf16 v[240:243], v[112:115], v[88:91], v[240:243]
v_mfma_f32_16x16x32_bf16 v[208:211], v[112:115], v[84:87], v[208:211]
v_mfma_f32_16x16x32_bf16 v[176:179], v[112:115], v[80:83], v[176:179]
v_mfma_f32_16x16x32_bf16 v[144:147], v[112:115], v[76:79], v[144:147]
v_mfma_f32_16x16x32_bf16 v[148:151], v[116:119], v[76:79], v[148:151]
v_mfma_f32_16x16x32_bf16 v[180:183], v[116:119], v[80:83], v[180:183]
v_mfma_f32_16x16x32_bf16 v[212:215], v[116:119], v[84:87], v[212:215]
v_mfma_f32_16x16x32_bf16 v[244:247], v[116:119], v[88:91], v[244:247]
v_mfma_f32_16x16x32_bf16 v[248:251], v[120:123], v[88:91], v[248:251]
v_mfma_f32_16x16x32_bf16 v[216:219], v[120:123], v[84:87], v[216:219]
v_mfma_f32_16x16x32_bf16 v[184:187], v[120:123], v[80:83], v[184:187]
v_mfma_f32_16x16x32_bf16 v[152:155], v[120:123], v[76:79], v[152:155]
s_waitcnt lgkmcnt(0)
v_mfma_f32_16x16x32_bf16 v[124:127], v[44:47], v[28:31], v[124:127]
ds_read_b128 v[76:79], v9 offset:8192
v_mfma_f32_16x16x32_bf16 v[156:159], v[44:47], v[32:35], v[156:159]
ds_read_b64_tr_b16 v[92:93], v11 offset:8192
v_mfma_f32_16x16x32_bf16 v[188:191], v[44:47], v[36:39], v[188:191]
ds_read_b64_tr_b16 v[94:95], v11 offset:12288
v_mfma_f32_16x16x32_bf16 v[220:223], v[44:47], v[40:43], v[220:223]
ds_read_b64_tr_b16 v[96:97], v12 offset:8192
v_mfma_f32_16x16x32_bf16 v[224:227], v[48:51], v[40:43], v[224:227]
ds_read_b64_tr_b16 v[98:99], v12 offset:12288
v_mfma_f32_16x16x32_bf16 v[192:195], v[48:51], v[36:39], v[192:195]
ds_read_b64_tr_b16 v[100:101], v13 offset:8192
v_mfma_f32_16x16x32_bf16 v[160:163], v[48:51], v[32:35], v[160:163]
ds_read_b64_tr_b16 v[102:103], v13 offset:12288
v_mfma_f32_16x16x32_bf16 v[128:131], v[48:51], v[28:31], v[128:131]
ds_read_b64_tr_b16 v[104:105], v14 offset:8192
v_mfma_f32_16x16x32_bf16 v[132:135], v[52:55], v[28:31], v[132:135]
ds_read_b64_tr_b16 v[106:107], v14 offset:12288
v_mfma_f32_16x16x32_bf16 v[164:167], v[52:55], v[32:35], v[164:167]
ds_read_b64_tr_b16 v[108:109], v11 offset:24576
v_mfma_f32_16x16x32_bf16 v[196:199], v[52:55], v[36:39], v[196:199]
ds_read_b64_tr_b16 v[110:111], v11 offset:28672
v_mfma_f32_16x16x32_bf16 v[228:231], v[52:55], v[40:43], v[228:231]
ds_read_b64_tr_b16 v[112:113], v12 offset:24576
v_mfma_f32_16x16x32_bf16 v[232:235], v[56:59], v[40:43], v[232:235]
ds_read_b64_tr_b16 v[114:115], v12 offset:28672
v_mfma_f32_16x16x32_bf16 v[200:203], v[56:59], v[36:39], v[200:203]
ds_read_b64_tr_b16 v[116:117], v13 offset:24576
v_mfma_f32_16x16x32_bf16 v[168:171], v[56:59], v[32:35], v[168:171]
ds_read_b64_tr_b16 v[118:119], v13 offset:28672
v_mfma_f32_16x16x32_bf16 v[136:139], v[56:59], v[28:31], v[136:139]
ds_read_b64_tr_b16 v[120:121], v14 offset:24576
v_mfma_f32_16x16x32_bf16 v[140:143], v[60:63], v[28:31], v[140:143]
ds_read_b64_tr_b16 v[122:123], v14 offset:28672
v_mfma_f32_16x16x32_bf16 v[172:175], v[60:63], v[32:35], v[172:175]
ds_read_b128 v[80:83], v9 offset:9216
v_mfma_f32_16x16x32_bf16 v[204:207], v[60:63], v[36:39], v[204:207]
ds_read_b128 v[84:87], v9 offset:10240
v_mfma_f32_16x16x32_bf16 v[236:239], v[60:63], v[40:43], v[236:239]
ds_read_b128 v[88:91], v9 offset:11264
v_mfma_f32_16x16x32_bf16 v[240:243], v[64:67], v[40:43], v[240:243]
v_mfma_f32_16x16x32_bf16 v[208:211], v[64:67], v[36:39], v[208:211]
v_mfma_f32_16x16x32_bf16 v[176:179], v[64:67], v[32:35], v[176:179]
v_mfma_f32_16x16x32_bf16 v[144:147], v[64:67], v[28:31], v[144:147]
v_mfma_f32_16x16x32_bf16 v[148:151], v[68:71], v[28:31], v[148:151]
v_mfma_f32_16x16x32_bf16 v[180:183], v[68:71], v[32:35], v[180:183]
v_mfma_f32_16x16x32_bf16 v[212:215], v[68:71], v[36:39], v[212:215]
v_mfma_f32_16x16x32_bf16 v[244:247], v[68:71], v[40:43], v[244:247]
v_mfma_f32_16x16x32_bf16 v[248:251], v[72:75], v[40:43], v[248:251]
v_mfma_f32_16x16x32_bf16 v[216:219], v[72:75], v[36:39], v[216:219]
v_mfma_f32_16x16x32_bf16 v[184:187], v[72:75], v[32:35], v[184:187]
v_mfma_f32_16x16x32_bf16 v[152:155], v[72:75], v[28:31], v[152:155]
s_waitcnt lgkmcnt(0)
s_barrier
v_mfma_f32_16x16x32_bf16 v[124:127], v[92:95], v[76:79], v[124:127]
ds_read_b128 v[28:31], v9 offset:49152
v_mfma_f32_16x16x32_bf16 v[156:159], v[92:95], v[80:83], v[156:159]
ds_read_b64_tr_b16 v[44:45], v15 offset:0
v_mfma_f32_16x16x32_bf16 v[188:191], v[92:95], v[84:87], v[188:191]
ds_read_b64_tr_b16 v[46:47], v15 offset:4096
v_mfma_f32_16x16x32_bf16 v[220:223], v[92:95], v[88:91], v[220:223]
ds_read_b64_tr_b16 v[48:49], v16 offset:0
v_mfma_f32_16x16x32_bf16 v[224:227], v[96:99], v[88:91], v[224:227]
ds_read_b64_tr_b16 v[50:51], v16 offset:4096
v_mfma_f32_16x16x32_bf16 v[192:195], v[96:99], v[84:87], v[192:195]
ds_read_b64_tr_b16 v[52:53], v17 offset:0
v_mfma_f32_16x16x32_bf16 v[160:163], v[96:99], v[80:83], v[160:163]
ds_read_b64_tr_b16 v[54:55], v17 offset:4096
v_mfma_f32_16x16x32_bf16 v[128:131], v[96:99], v[76:79], v[128:131]
ds_read_b64_tr_b16 v[56:57], v18 offset:0
v_mfma_f32_16x16x32_bf16 v[132:135], v[100:103], v[76:79], v[132:135]
ds_read_b64_tr_b16 v[58:59], v18 offset:4096
v_mfma_f32_16x16x32_bf16 v[164:167], v[100:103], v[80:83], v[164:167]
ds_read_b64_tr_b16 v[60:61], v15 offset:16384
v_mfma_f32_16x16x32_bf16 v[196:199], v[100:103], v[84:87], v[196:199]
ds_read_b64_tr_b16 v[62:63], v15 offset:20480
v_mfma_f32_16x16x32_bf16 v[228:231], v[100:103], v[88:91], v[228:231]
ds_read_b64_tr_b16 v[64:65], v16 offset:16384
v_mfma_f32_16x16x32_bf16 v[232:235], v[104:107], v[88:91], v[232:235]
ds_read_b64_tr_b16 v[66:67], v16 offset:20480
v_mfma_f32_16x16x32_bf16 v[200:203], v[104:107], v[84:87], v[200:203]
ds_read_b64_tr_b16 v[68:69], v17 offset:16384
v_mfma_f32_16x16x32_bf16 v[168:171], v[104:107], v[80:83], v[168:171]
ds_read_b64_tr_b16 v[70:71], v17 offset:20480
v_mfma_f32_16x16x32_bf16 v[136:139], v[104:107], v[76:79], v[136:139]
ds_read_b64_tr_b16 v[72:73], v18 offset:16384
v_mfma_f32_16x16x32_bf16 v[140:143], v[108:111], v[76:79], v[140:143]
ds_read_b64_tr_b16 v[74:75], v18 offset:20480
v_mfma_f32_16x16x32_bf16 v[172:175], v[108:111], v[80:83], v[172:175]
ds_read_b128 v[32:35], v9 offset:50176
v_mfma_f32_16x16x32_bf16 v[204:207], v[108:111], v[84:87], v[204:207]
ds_read_b128 v[36:39], v9 offset:51200
v_mfma_f32_16x16x32_bf16 v[236:239], v[108:111], v[88:91], v[236:239]
ds_read_b128 v[40:43], v9 offset:52224
v_mfma_f32_16x16x32_bf16 v[240:243], v[112:115], v[88:91], v[240:243]
v_mfma_f32_16x16x32_bf16 v[208:211], v[112:115], v[84:87], v[208:211]
v_mfma_f32_16x16x32_bf16 v[176:179], v[112:115], v[80:83], v[176:179]
v_mfma_f32_16x16x32_bf16 v[144:147], v[112:115], v[76:79], v[144:147]
v_mfma_f32_16x16x32_bf16 v[148:151], v[116:119], v[76:79], v[148:151]
v_mfma_f32_16x16x32_bf16 v[180:183], v[116:119], v[80:83], v[180:183]
v_mfma_f32_16x16x32_bf16 v[212:215], v[116:119], v[84:87], v[212:215]
v_mfma_f32_16x16x32_bf16 v[244:247], v[116:119], v[88:91], v[244:247]
v_mfma_f32_16x16x32_bf16 v[248:251], v[120:123], v[88:91], v[248:251]
v_mfma_f32_16x16x32_bf16 v[216:219], v[120:123], v[84:87], v[216:219]
v_mfma_f32_16x16x32_bf16 v[184:187], v[120:123], v[80:83], v[184:187]
v_mfma_f32_16x16x32_bf16 v[152:155], v[120:123], v[76:79], v[152:155]
s_waitcnt lgkmcnt(0)
v_mfma_f32_16x16x32_bf16 v[124:127], v[44:47], v[28:31], v[124:127]
ds_read_b128 v[76:79], v9 offset:57344
v_mfma_f32_16x16x32_bf16 v[156:159], v[44:47], v[32:35], v[156:159]
ds_read_b64_tr_b16 v[92:93], v15 offset:8192
v_mfma_f32_16x16x32_bf16 v[188:191], v[44:47], v[36:39], v[188:191]
ds_read_b64_tr_b16 v[94:95], v15 offset:12288
v_mfma_f32_16x16x32_bf16 v[220:223], v[44:47], v[40:43], v[220:223]
ds_read_b64_tr_b16 v[96:97], v16 offset:8192
v_mfma_f32_16x16x32_bf16 v[224:227], v[48:51], v[40:43], v[224:227]
ds_read_b64_tr_b16 v[98:99], v16 offset:12288
v_mfma_f32_16x16x32_bf16 v[192:195], v[48:51], v[36:39], v[192:195]
ds_read_b64_tr_b16 v[100:101], v17 offset:8192
v_mfma_f32_16x16x32_bf16 v[160:163], v[48:51], v[32:35], v[160:163]
ds_read_b64_tr_b16 v[102:103], v17 offset:12288
v_mfma_f32_16x16x32_bf16 v[128:131], v[48:51], v[28:31], v[128:131]
ds_read_b64_tr_b16 v[104:105], v18 offset:8192
v_mfma_f32_16x16x32_bf16 v[132:135], v[52:55], v[28:31], v[132:135]
ds_read_b64_tr_b16 v[106:107], v18 offset:12288
v_mfma_f32_16x16x32_bf16 v[164:167], v[52:55], v[32:35], v[164:167]
ds_read_b64_tr_b16 v[108:109], v15 offset:24576
v_mfma_f32_16x16x32_bf16 v[196:199], v[52:55], v[36:39], v[196:199]
ds_read_b64_tr_b16 v[110:111], v15 offset:28672
v_mfma_f32_16x16x32_bf16 v[228:231], v[52:55], v[40:43], v[228:231]
ds_read_b64_tr_b16 v[112:113], v16 offset:24576
v_mfma_f32_16x16x32_bf16 v[232:235], v[56:59], v[40:43], v[232:235]
ds_read_b64_tr_b16 v[114:115], v16 offset:28672
v_mfma_f32_16x16x32_bf16 v[200:203], v[56:59], v[36:39], v[200:203]
ds_read_b64_tr_b16 v[116:117], v17 offset:24576
v_mfma_f32_16x16x32_bf16 v[168:171], v[56:59], v[32:35], v[168:171]
ds_read_b64_tr_b16 v[118:119], v17 offset:28672
v_mfma_f32_16x16x32_bf16 v[136:139], v[56:59], v[28:31], v[136:139]
ds_read_b64_tr_b16 v[120:121], v18 offset:24576
v_mfma_f32_16x16x32_bf16 v[140:143], v[60:63], v[28:31], v[140:143]
ds_read_b64_tr_b16 v[122:123], v18 offset:28672
v_mfma_f32_16x16x32_bf16 v[172:175], v[60:63], v[32:35], v[172:175]
ds_read_b128 v[80:83], v9 offset:58368
v_mfma_f32_16x16x32_bf16 v[204:207], v[60:63], v[36:39], v[204:207]
ds_read_b128 v[84:87], v9 offset:59392
v_mfma_f32_16x16x32_bf16 v[236:239], v[60:63], v[40:43], v[236:239]
ds_read_b128 v[88:91], v9 offset:60416
v_mfma_f32_16x16x32_bf16 v[240:243], v[64:67], v[40:43], v[240:243]
v_mfma_f32_16x16x32_bf16 v[208:211], v[64:67], v[36:39], v[208:211]
v_mfma_f32_16x16x32_bf16 v[176:179], v[64:67], v[32:35], v[176:179]
v_mfma_f32_16x16x32_bf16 v[144:147], v[64:67], v[28:31], v[144:147]
v_mfma_f32_16x16x32_bf16 v[148:151], v[68:71], v[28:31], v[148:151]
v_mfma_f32_16x16x32_bf16 v[180:183], v[68:71], v[32:35], v[180:183]
v_mfma_f32_16x16x32_bf16 v[212:215], v[68:71], v[36:39], v[212:215]
v_mfma_f32_16x16x32_bf16 v[244:247], v[68:71], v[40:43], v[244:247]
v_mfma_f32_16x16x32_bf16 v[248:251], v[72:75], v[40:43], v[248:251]
v_mfma_f32_16x16x32_bf16 v[216:219], v[72:75], v[36:39], v[216:219]
v_mfma_f32_16x16x32_bf16 v[184:187], v[72:75], v[32:35], v[184:187]
v_mfma_f32_16x16x32_bf16 v[152:155], v[72:75], v[28:31], v[152:155]
s_waitcnt lgkmcnt(0)
s_barrier
v_mfma_f32_16x16x32_bf16 v[124:127], v[92:95], v[76:79], v[124:127]
ds_read_b128 v[28:31], v10 offset:0
v_mfma_f32_16x16x32_bf16 v[156:159], v[92:95], v[80:83], v[156:159]
ds_read_b64_tr_b16 v[44:45], v19 offset:0
v_mfma_f32_16x16x32_bf16 v[188:191], v[92:95], v[84:87], v[188:191]
ds_read_b64_tr_b16 v[46:47], v19 offset:4096
v_mfma_f32_16x16x32_bf16 v[220:223], v[92:95], v[88:91], v[220:223]
ds_read_b64_tr_b16 v[48:49], v20 offset:0
v_mfma_f32_16x16x32_bf16 v[224:227], v[96:99], v[88:91], v[224:227]
ds_read_b64_tr_b16 v[50:51], v20 offset:4096
v_mfma_f32_16x16x32_bf16 v[192:195], v[96:99], v[84:87], v[192:195]
ds_read_b64_tr_b16 v[52:53], v21 offset:0
v_mfma_f32_16x16x32_bf16 v[160:163], v[96:99], v[80:83], v[160:163]
ds_read_b64_tr_b16 v[54:55], v21 offset:4096
v_mfma_f32_16x16x32_bf16 v[128:131], v[96:99], v[76:79], v[128:131]
ds_read_b64_tr_b16 v[56:57], v22 offset:0
v_mfma_f32_16x16x32_bf16 v[132:135], v[100:103], v[76:79], v[132:135]
ds_read_b64_tr_b16 v[58:59], v22 offset:4096
v_mfma_f32_16x16x32_bf16 v[164:167], v[100:103], v[80:83], v[164:167]
ds_read_b64_tr_b16 v[60:61], v19 offset:16384
v_mfma_f32_16x16x32_bf16 v[196:199], v[100:103], v[84:87], v[196:199]
ds_read_b64_tr_b16 v[62:63], v19 offset:20480
v_mfma_f32_16x16x32_bf16 v[228:231], v[100:103], v[88:91], v[228:231]
ds_read_b64_tr_b16 v[64:65], v20 offset:16384
v_mfma_f32_16x16x32_bf16 v[232:235], v[104:107], v[88:91], v[232:235]
ds_read_b64_tr_b16 v[66:67], v20 offset:20480
v_mfma_f32_16x16x32_bf16 v[200:203], v[104:107], v[84:87], v[200:203]
ds_read_b64_tr_b16 v[68:69], v21 offset:16384
v_mfma_f32_16x16x32_bf16 v[168:171], v[104:107], v[80:83], v[168:171]
ds_read_b64_tr_b16 v[70:71], v21 offset:20480
v_mfma_f32_16x16x32_bf16 v[136:139], v[104:107], v[76:79], v[136:139]
ds_read_b64_tr_b16 v[72:73], v22 offset:16384
v_mfma_f32_16x16x32_bf16 v[140:143], v[108:111], v[76:79], v[140:143]
ds_read_b64_tr_b16 v[74:75], v22 offset:20480
v_mfma_f32_16x16x32_bf16 v[172:175], v[108:111], v[80:83], v[172:175]
ds_read_b128 v[32:35], v10 offset:1024
v_mfma_f32_16x16x32_bf16 v[204:207], v[108:111], v[84:87], v[204:207]
ds_read_b128 v[36:39], v10 offset:2048
v_mfma_f32_16x16x32_bf16 v[236:239], v[108:111], v[88:91], v[236:239]
ds_read_b128 v[40:43], v10 offset:3072
v_mfma_f32_16x16x32_bf16 v[240:243], v[112:115], v[88:91], v[240:243]
v_mfma_f32_16x16x32_bf16 v[208:211], v[112:115], v[84:87], v[208:211]
v_mfma_f32_16x16x32_bf16 v[176:179], v[112:115], v[80:83], v[176:179]
v_mfma_f32_16x16x32_bf16 v[144:147], v[112:115], v[76:79], v[144:147]
v_mfma_f32_16x16x32_bf16 v[148:151], v[116:119], v[76:79], v[148:151]
v_mfma_f32_16x16x32_bf16 v[180:183], v[116:119], v[80:83], v[180:183]
v_mfma_f32_16x16x32_bf16 v[212:215], v[116:119], v[84:87], v[212:215]
v_mfma_f32_16x16x32_bf16 v[244:247], v[116:119], v[88:91], v[244:247]
v_mfma_f32_16x16x32_bf16 v[248:251], v[120:123], v[88:91], v[248:251]
v_mfma_f32_16x16x32_bf16 v[216:219], v[120:123], v[84:87], v[216:219]
v_mfma_f32_16x16x32_bf16 v[184:187], v[120:123], v[80:83], v[184:187]
v_mfma_f32_16x16x32_bf16 v[152:155], v[120:123], v[76:79], v[152:155]
s_sub_u32 s41, s41, 1
s_cmp_lg_u32 s41, 0
s_cbranch_scc1 Lk3l_127
s_waitcnt lgkmcnt(0)
v_lshrrev_b32 v84, 4, v1
s_lshl_b32 s43, s63, 8
s_add_u32 s43, s43, 148480
v_lshl_add_u32 v85, v84, 4, s43
v_and_b32 v84, 15, v1
s_lshl_b32 s43, s62, 9
s_add_u32 s43, s43, 147456
v_lshl_add_u32 v84, v84, 3, s43
ds_read_b128 v[28:31], v85 offset:0
ds_read_b128 v[32:35], v85 offset:64
ds_read_b128 v[36:39], v85 offset:128
ds_read_b128 v[40:43], v85 offset:192
ds_read_b128 v[44:47], v85 offset:896
ds_read_b128 v[48:51], v85 offset:960
ds_read_b128 v[52:55], v85 offset:1024
ds_read_b128 v[56:59], v85 offset:1088
ds_read_b64 v[60:61], v84 offset:0
ds_read_b64 v[62:63], v84 offset:128
ds_read_b64 v[64:65], v84 offset:256
ds_read_b64 v[66:67], v84 offset:384
s_lshl_b32 s54, s35, 15
s_lshl_b32 s43, s63, 14
s_add_u32 s54, s54, s43
s_lshl_b32 s43, s62, 12
s_add_u32 s54, s54, s43
s_add_u32 s55, s54, 8192
v_lshrrev_b32 v122, 3, v1
v_and_b32 v123, 6, v122
v_and_b32 v25, 7, v1
v_xor_b32 v25, v25, v123
v_lshlrev_b32 v25, 4, v25
v_mul_u32_u24 v122, 2048, v122
v_add_u32 v25, v25, v122
s_lshl_b32 s43, s61, 7
s_lshl_b32 s44, s47, 15
s_add_u32 s43, s43, s44
v_add_u32 v25, s43, v25
s_waitcnt lgkmcnt(0)
v_mul_f32 v70, v61, v61
v_mul_f32 v68, 0xc0135761, v61
v_mul_f32 v69, 0xbdd2d3e8, v61
v_mul_f32 v69, v69, v70
v_rcp_f32 v70, v70
v_mul_f32 v74, v63, v63
v_mul_f32 v72, 0xc0135761, v63
v_mul_f32 v73, 0xbdd2d3e8, v63
v_mul_f32 v73, v73, v74
v_rcp_f32 v74, v74
v_pk_fma_f32 v[124:125], v[60:61], v[28:29], v[124:125] op_sel_hi:[0,1,1] neg_lo:[1,0,0] neg_hi:[1,0,0]
v_pk_fma_f32 v[126:127], v[60:61], v[30:31], v[126:127] op_sel_hi:[0,1,1] neg_lo:[1,0,0] neg_hi:[1,0,0]
v_pk_fma_f32 v[156:157], v[62:63], v[28:29], v[156:157] op_sel_hi:[0,1,1] neg_lo:[1,0,0] neg_hi:[1,0,0]
v_pk_fma_f32 v[158:159], v[62:63], v[30:31], v[158:159] op_sel_hi:[0,1,1] neg_lo:[1,0,0] neg_hi:[1,0,0]
v_pk_mul_f32 v[76:77], v[124:125], v[124:125]
v_pk_mul_f32 v[78:79], v[126:127], v[126:127]
v_pk_mul_f32 v[80:81], v[156:157], v[156:157]
v_pk_mul_f32 v[82:83], v[158:159], v[158:159]
v_pk_fma_f32 v[76:77], v[76:77], v[68:69], v[68:69] op_sel:[0,1,0] op_sel_hi:[1,1,0]
v_pk_fma_f32 v[78:79], v[78:79], v[68:69], v[68:69] op_sel:[0,1,0] op_sel_hi:[1,1,0]
v_pk_fma_f32 v[80:81], v[80:81], v[72:73], v[72:73] op_sel:[0,1,0] op_sel_hi:[1,1,0]
v_pk_fma_f32 v[82:83], v[82:83], v[72:73], v[72:73] op_sel:[0,1,0] op_sel_hi:[1,1,0]
v_pk_mul_f32 v[76:77], v[76:77], v[124:125]
v_pk_mul_f32 v[78:79], v[78:79], v[126:127]
v_pk_mul_f32 v[80:81], v[80:81], v[156:157]
v_pk_mul_f32 v[82:83], v[82:83], v[158:159]
v_exp_f32 v76, v76
v_exp_f32 v77, v77
v_exp_f32 v78, v78
v_exp_f32 v79, v79
v_exp_f32 v80, v80
v_exp_f32 v81, v81
v_exp_f32 v82, v82
v_exp_f32 v83, v83
v_pk_fma_f32 v[140:141], v[60:61], v[44:45], v[140:141] op_sel_hi:[0,1,1] neg_lo:[1,0,0] neg_hi:[1,0,0]
v_pk_fma_f32 v[142:143], v[60:61], v[46:47], v[142:143] op_sel_hi:[0,1,1] neg_lo:[1,0,0] neg_hi:[1,0,0]
v_pk_fma_f32 v[172:173], v[62:63], v[44:45], v[172:173] op_sel_hi:[0,1,1] neg_lo:[1,0,0] neg_hi:[1,0,0]
v_pk_fma_f32 v[174:175], v[62:63], v[46:47], v[174:175] op_sel_hi:[0,1,1] neg_lo:[1,0,0] neg_hi:[1,0,0]
v_pk_fma_f32 v[76:77], v[76:77], v[70:71], v[70:71] op_sel_hi:[1,0,0]
v_pk_fma_f32 v[78:79], v[78:79], v[70:71], v[70:71] op_sel_hi:[1,0,0]
v_pk_fma_f32 v[80:81], v[80:81], v[74:75], v[74:75] op_sel_hi:[1,0,0]
v_pk_fma_f32 v[82:83], v[82:83], v[74:75], v[74:75] op_sel_hi:[1,0,0]
v_rcp_f32 v76, v76
v_rcp_f32 v77, v77
v_rcp_f32 v78, v78
v_rcp_f32 v79, v79
v_rcp_f32 v80, v80
v_rcp_f32 v81, v81
v_rcp_f32 v82, v82
v_rcp_f32 v83, v83
v_pk_mul_f32 v[140:141], v[124:125], v[140:141]
v_pk_mul_f32 v[142:143], v[126:127], v[142:143]
v_pk_mul_f32 v[172:173], v[156:157], v[172:173]
v_pk_mul_f32 v[174:175], v[158:159], v[174:175]
v_pk_mul_f32 v[140:141], v[140:141], v[76:77]
v_pk_mul_f32 v[142:143], v[142:143], v[78:79]
v_pk_mul_f32 v[172:173], v[172:173], v[80:81]
v_pk_mul_f32 v[174:175], v[174:175], v[82:83]
v_cvt_pk_bf16_f32 v124, v140, v141
v_cvt_pk_bf16_f32 v125, v142, v143
v_cvt_pk_bf16_f32 v156, v172, v173
v_cvt_pk_bf16_f32 v157, v174, v175
v_pk_fma_f32 v[128:129], v[60:61], v[32:33], v[128:129] op_sel_hi:[0,1,1] neg_lo:[1,0,0] neg_hi:[1,0,0]
v_pk_fma_f32 v[130:131], v[60:61], v[34:35], v[130:131] op_sel_hi:[0,1,1] neg_lo:[1,0,0] neg_hi:[1,0,0]
v_pk_fma_f32 v[160:161], v[62:63], v[32:33], v[160:161] op_sel_hi:[0,1,1] neg_lo:[1,0,0] neg_hi:[1,0,0]
v_pk_fma_f32 v[162:163], v[62:63], v[34:35], v[162:163] op_sel_hi:[0,1,1] neg_lo:[1,0,0] neg_hi:[1,0,0]
v_pk_mul_f32 v[76:77], v[128:129], v[128:129]
v_pk_mul_f32 v[78:79], v[130:131], v[130:131]
v_pk_mul_f32 v[80:81], v[160:161], v[160:161]
v_pk_mul_f32 v[82:83], v[162:163], v[162:163]
v_pk_fma_f32 v[76:77], v[76:77], v[68:69], v[68:69] op_sel:[0,1,0] op_sel_hi:[1,1,0]
v_pk_fma_f32 v[78:79], v[78:79], v[68:69], v[68:69] op_sel:[0,1,0] op_sel_hi:[1,1,0]
v_pk_fma_f32 v[80:81], v[80:81], v[72:73], v[72:73] op_sel:[0,1,0] op_sel_hi:[1,1,0]
v_pk_fma_f32 v[82:83], v[82:83], v[72:73], v[72:73] op_sel:[0,1,0] op_sel_hi:[1,1,0]
v_pk_mul_f32 v[76:77], v[76:77], v[128:129]
v_pk_mul_f32 v[78:79], v[78:79], v[130:131]
v_pk_mul_f32 v[80:81], v[80:81], v[160:161]
v_pk_mul_f32 v[82:83], v[82:83], v[162:163]
v_exp_f32 v76, v76
v_exp_f32 v77, v77
v_exp_f32 v78, v78
v_exp_f32 v79, v79
v_exp_f32 v80, v80
v_exp_f32 v81, v81
v_exp_f32 v82, v82
v_exp_f32 v83, v83
v_pk_fma_f32 v[144:145], v[60:61], v[48:49], v[144:145] op_sel_hi:[0,1,1] neg_lo:[1,0,0] neg_hi:[1,0,0]
v_pk_fma_f32 v[146:147], v[60:61], v[50:51], v[146:147] op_sel_hi:[0,1,1] neg_lo:[1,0,0] neg_hi:[1,0,0]
v_pk_fma_f32 v[176:177], v[62:63], v[48:49], v[176:177] op_sel_hi:[0,1,1] neg_lo:[1,0,0] neg_hi:[1,0,0]
v_pk_fma_f32 v[178:179], v[62:63], v[50:51], v[178:179] op_sel_hi:[0,1,1] neg_lo:[1,0,0] neg_hi:[1,0,0]
v_pk_fma_f32 v[76:77], v[76:77], v[70:71], v[70:71] op_sel_hi:[1,0,0]
v_pk_fma_f32 v[78:79], v[78:79], v[70:71], v[70:71] op_sel_hi:[1,0,0]
v_pk_fma_f32 v[80:81], v[80:81], v[74:75], v[74:75] op_sel_hi:[1,0,0]
v_pk_fma_f32 v[82:83], v[82:83], v[74:75], v[74:75] op_sel_hi:[1,0,0]
v_rcp_f32 v76, v76
v_rcp_f32 v77, v77
v_rcp_f32 v78, v78
v_rcp_f32 v79, v79
v_rcp_f32 v80, v80
v_rcp_f32 v81, v81
v_rcp_f32 v82, v82
v_rcp_f32 v83, v83
v_pk_mul_f32 v[144:145], v[128:129], v[144:145]
v_pk_mul_f32 v[146:147], v[130:131], v[146:147]
s_branch Lov_16
.p2align 12
.fill 128, 4, 0xbf800000
Lst_16_0:
s_branch Lwr_160
s_nop 0
s_nop 0
Lov_16:
v_pk_mul_f32 v[176:177], v[160:161], v[176:177]
v_pk_mul_f32 v[178:179], v[162:163], v[178:179]
v_pk_mul_f32 v[144:145], v[144:145], v[76:77]
v_pk_mul_f32 v[146:147], v[146:147], v[78:79]
v_pk_mul_f32 v[176:177], v[176:177], v[80:81]
v_pk_mul_f32 v[178:179], v[178:179], v[82:83]
v_cvt_pk_bf16_f32 v126, v144, v145
v_cvt_pk_bf16_f32 v127, v146, v147
v_cvt_pk_bf16_f32 v158, v176, v177
v_cvt_pk_bf16_f32 v159, v178, v179
buffer_store_dwordx4 v[124:127], v2, s[24:27], s54 offen offset:0 sc1
buffer_store_dwordx4 v[156:159], v2, s[24:27], s54 offen offset:1024 sc1
v_pk_fma_f32 v[132:133], v[60:61], v[36:37], v[132:133] op_sel_hi:[0,1,1] neg_lo:[1,0,0] neg_hi:[1,0,0]
v_pk_fma_f32 v[134:135], v[60:61], v[38:39], v[134:135] op_sel_hi:[0,1,1] neg_lo:[1,0,0] neg_hi:[1,0,0]
v_pk_fma_f32 v[164:165], v[62:63], v[36:37], v[164:165] op_sel_hi:[0,1,1] neg_lo:[1,0,0] neg_hi:[1,0,0]
v_pk_fma_f32 v[166:167], v[62:63], v[38:39], v[166:167] op_sel_hi:[0,1,1] neg_lo:[1,0,0] neg_hi:[1,0,0]
v_pk_mul_f32 v[76:77], v[132:133], v[132:133]
v_pk_mul_f32 v[78:79], v[134:135], v[134:135]
v_pk_mul_f32 v[80:81], v[164:165], v[164:165]
v_pk_mul_f32 v[82:83], v[166:167], v[166:167]
v_pk_fma_f32 v[76:77], v[76:77], v[68:69], v[68:69] op_sel:[0,1,0] op_sel_hi:[1,1,0]
v_pk_fma_f32 v[78:79], v[78:79], v[68:69], v[68:69] op_sel:[0,1,0] op_sel_hi:[1,1,0]
v_pk_fma_f32 v[80:81], v[80:81], v[72:73], v[72:73] op_sel:[0,1,0] op_sel_hi:[1,1,0]
v_pk_fma_f32 v[82:83], v[82:83], v[72:73], v[72:73] op_sel:[0,1,0] op_sel_hi:[1,1,0]
v_pk_mul_f32 v[76:77], v[76:77], v[132:133]
v_pk_mul_f32 v[78:79], v[78:79], v[134:135]
v_pk_mul_f32 v[80:81], v[80:81], v[164:165]
v_pk_mul_f32 v[82:83], v[82:83], v[166:167]
v_exp_f32 v76, v76
v_exp_f32 v77, v77
v_exp_f32 v78, v78
v_exp_f32 v79, v79
v_exp_f32 v80, v80
v_exp_f32 v81, v81
v_exp_f32 v82, v82
v_exp_f32 v83, v83
v_pk_fma_f32 v[148:149], v[60:61], v[52:53], v[148:149] op_sel_hi:[0,1,1] neg_lo:[1,0,0] neg_hi:[1,0,0]
v_pk_fma_f32 v[150:151], v[60:61], v[54:55], v[150:151] op_sel_hi:[0,1,1] neg_lo:[1,0,0] neg_hi:[1,0,0]
v_pk_fma_f32 v[180:181], v[62:63], v[52:53], v[180:181] op_sel_hi:[0,1,1] neg_lo:[1,0,0] neg_hi:[1,0,0]
v_pk_fma_f32 v[182:183], v[62:63], v[54:55], v[182:183] op_sel_hi:[0,1,1] neg_lo:[1,0,0] neg_hi:[1,0,0]
v_pk_fma_f32 v[76:77], v[76:77], v[70:71], v[70:71] op_sel_hi:[1,0,0]
v_pk_fma_f32 v[78:79], v[78:79], v[70:71], v[70:71] op_sel_hi:[1,0,0]
v_pk_fma_f32 v[80:81], v[80:81], v[74:75], v[74:75] op_sel_hi:[1,0,0]
v_pk_fma_f32 v[82:83], v[82:83], v[74:75], v[74:75] op_sel_hi:[1,0,0]
v_rcp_f32 v76, v76
v_rcp_f32 v77, v77
v_rcp_f32 v78, v78
v_rcp_f32 v79, v79
v_rcp_f32 v80, v80
v_rcp_f32 v81, v81
v_rcp_f32 v82, v82
v_rcp_f32 v83, v83
v_pk_mul_f32 v[148:149], v[132:133], v[148:149]
v_pk_mul_f32 v[150:151], v[134:135], v[150:151]
v_pk_mul_f32 v[180:181], v[164:165], v[180:181]
v_pk_mul_f32 v[182:183], v[166:167], v[182:183]
v_pk_mul_f32 v[148:149], v[148:149], v[76:77]
v_pk_mul_f32 v[150:151], v[150:151], v[78:79]
v_pk_mul_f32 v[180:181], v[180:181], v[80:81]
v_pk_mul_f32 v[182:183], v[182:183], v[82:83]
v_cvt_pk_bf16_f32 v132, v148, v149
v_cvt_pk_bf16_f32 v133, v150, v151
v_cvt_pk_bf16_f32 v164, v180, v181
v_cvt_pk_bf16_f32 v165, v182, v183
v_pk_fma_f32 v[136:137], v[60:61], v[40:41], v[136:137] op_sel_hi:[0,1,1] neg_lo:[1,0,0] neg_hi:[1,0,0]
v_pk_fma_f32 v[138:139], v[60:61], v[42:43], v[138:139] op_sel_hi:[0,1,1] neg_lo:[1,0,0] neg_hi:[1,0,0]
v_pk_fma_f32 v[168:169], v[62:63], v[40:41], v[168:169] op_sel_hi:[0,1,1] neg_lo:[1,0,0] neg_hi:[1,0,0]
v_pk_fma_f32 v[170:171], v[62:63], v[42:43], v[170:171] op_sel_hi:[0,1,1] neg_lo:[1,0,0] neg_hi:[1,0,0]
v_pk_mul_f32 v[76:77], v[136:137], v[136:137]
v_pk_mul_f32 v[78:79], v[138:139], v[138:139]
v_pk_mul_f32 v[80:81], v[168:169], v[168:169]
v_pk_mul_f32 v[82:83], v[170:171], v[170:171]
v_pk_fma_f32 v[76:77], v[76:77], v[68:69], v[68:69] op_sel:[0,1,0] op_sel_hi:[1,1,0]
v_pk_fma_f32 v[78:79], v[78:79], v[68:69], v[68:69] op_sel:[0,1,0] op_sel_hi:[1,1,0]
v_pk_fma_f32 v[80:81], v[80:81], v[72:73], v[72:73] op_sel:[0,1,0] op_sel_hi:[1,1,0]
v_pk_fma_f32 v[82:83], v[82:83], v[72:73], v[72:73] op_sel:[0,1,0] op_sel_hi:[1,1,0]
v_pk_mul_f32 v[76:77], v[76:77], v[136:137]
v_pk_mul_f32 v[78:79], v[78:79], v[138:139]
v_pk_mul_f32 v[80:81], v[80:81], v[168:169]
v_pk_mul_f32 v[82:83], v[82:83], v[170:171]
v_exp_f32 v76, v76
v_exp_f32 v77, v77
v_exp_f32 v78, v78
v_exp_f32 v79, v79
v_exp_f32 v80, v80
v_exp_f32 v81, v81
v_exp_f32 v82, v82
v_exp_f32 v83, v83
v_pk_fma_f32 v[152:153], v[60:61], v[56:57], v[152:153] op_sel_hi:[0,1,1] neg_lo:[1,0,0] neg_hi:[1,0,0]
v_pk_fma_f32 v[154:155], v[60:61], v[58:59], v[154:155] op_sel_hi:[0,1,1] neg_lo:[1,0,0] neg_hi:[1,0,0]
v_pk_fma_f32 v[184:185], v[62:63], v[56:57], v[184:185] op_sel_hi:[0,1,1] neg_lo:[1,0,0] neg_hi:[1,0,0]
v_pk_fma_f32 v[186:187], v[62:63], v[58:59], v[186:187] op_sel_hi:[0,1,1] neg_lo:[1,0,0] neg_hi:[1,0,0]
v_pk_fma_f32 v[76:77], v[76:77], v[70:71], v[70:71] op_sel_hi:[1,0,0]
v_pk_fma_f32 v[78:79], v[78:79], v[70:71], v[70:71] op_sel_hi:[1,0,0]
v_pk_fma_f32 v[80:81], v[80:81], v[74:75], v[74:75] op_sel_hi:[1,0,0]
v_pk_fma_f32 v[82:83], v[82:83], v[74:75], v[74:75] op_sel_hi:[1,0,0]
v_rcp_f32 v76, v76
v_rcp_f32 v77, v77
v_rcp_f32 v78, v78
v_rcp_f32 v79, v79
v_rcp_f32 v80, v80
v_rcp_f32 v81, v81
v_rcp_f32 v82, v82
v_rcp_f32 v83, v83
v_pk_mul_f32 v[152:153], v[136:137], v[152:153]
v_pk_mul_f32 v[154:155], v[138:139], v[154:155]
v_pk_mul_f32 v[184:185], v[168:169], v[184:185]
v_pk_mul_f32 v[186:187], v[170:171], v[186:187]
v_pk_mul_f32 v[152:153], v[152:153], v[76:77]
v_pk_mul_f32 v[154:155], v[154:155], v[78:79]
v_pk_mul_f32 v[184:185], v[184:185], v[80:81]
v_pk_mul_f32 v[186:187], v[186:187], v[82:83]
v_cvt_pk_bf16_f32 v134, v152, v153
v_cvt_pk_bf16_f32 v135, v154, v155
v_cvt_pk_bf16_f32 v166, v184, v185
v_cvt_pk_bf16_f32 v167, v186, v187
buffer_store_dwordx4 v[132:135], v2, s[24:27], s55 offen offset:0 sc1
buffer_store_dwordx4 v[164:167], v2, s[24:27], s55 offen offset:1024 sc1
v_mul_f32 v70, v65, v65
v_mul_f32 v68, 0xc0135761, v65
v_mul_f32 v69, 0xbdd2d3e8, v65
v_mul_f32 v69, v69, v70
v_rcp_f32 v70, v70
v_mul_f32 v74, v67, v67
v_mul_f32 v72, 0xc0135761, v67
v_mul_f32 v73, 0xbdd2d3e8, v67
v_mul_f32 v73, v73, v74
v_rcp_f32 v74, v74
v_pk_fma_f32 v[188:189], v[64:65], v[28:29], v[188:189] op_sel_hi:[0,1,1] neg_lo:[1,0,0] neg_hi:[1,0,0]
v_pk_fma_f32 v[190:191], v[64:65], v[30:31], v[190:191] op_sel_hi:[0,1,1] neg_lo:[1,0,0] neg_hi:[1,0,0]
v_pk_fma_f32 v[220:221], v[66:67], v[28:29], v[220:221] op_sel_hi:[0,1,1] neg_lo:[1,0,0] neg_hi:[1,0,0]
v_pk_fma_f32 v[222:223], v[66:67], v[30:31], v[222:223] op_sel_hi:[0,1,1] neg_lo:[1,0,0] neg_hi:[1,0,0]
v_pk_mul_f32 v[76:77], v[188:189], v[188:189]
v_pk_mul_f32 v[78:79], v[190:191], v[190:191]
v_pk_mul_f32 v[80:81], v[220:221], v[220:221]
v_pk_mul_f32 v[82:83], v[222:223], v[222:223]
v_pk_fma_f32 v[76:77], v[76:77], v[68:69], v[68:69] op_sel:[0,1,0] op_sel_hi:[1,1,0]
v_pk_fma_f32 v[78:79], v[78:79], v[68:69], v[68:69] op_sel:[0,1,0] op_sel_hi:[1,1,0]
v_pk_fma_f32 v[80:81], v[80:81], v[72:73], v[72:73] op_sel:[0,1,0] op_sel_hi:[1,1,0]
v_pk_fma_f32 v[82:83], v[82:83], v[72:73], v[72:73] op_sel:[0,1,0] op_sel_hi:[1,1,0]
v_pk_mul_f32 v[76:77], v[76:77], v[188:189]
v_pk_mul_f32 v[78:79], v[78:79], v[190:191]
v_pk_mul_f32 v[80:81], v[80:81], v[220:221]
v_pk_mul_f32 v[82:83], v[82:83], v[222:223]
v_exp_f32 v76, v76
v_exp_f32 v77, v77
v_exp_f32 v78, v78
v_exp_f32 v79, v79
v_exp_f32 v80, v80
v_exp_f32 v81, v81
v_exp_f32 v82, v82
v_exp_f32 v83, v83
v_pk_fma_f32 v[204:205], v[64:65], v[44:45], v[204:205] op_sel_hi:[0,1,1] neg_lo:[1,0,0] neg_hi:[1,0,0]
v_pk_fma_f32 v[206:207], v[64:65], v[46:47], v[206:207] op_sel_hi:[0,1,1] neg_lo:[1,0,0] neg_hi:[1,0,0]
v_pk_fma_f32 v[236:237], v[66:67], v[44:45], v[236:237] op_sel_hi:[0,1,1] neg_lo:[1,0,0] neg_hi:[1,0,0]
v_pk_fma_f32 v[238:239], v[66:67], v[46:47], v[238:239] op_sel_hi:[0,1,1] neg_lo:[1,0,0] neg_hi:[1,0,0]
v_pk_fma_f32 v[76:77], v[76:77], v[70:71], v[70:71] op_sel_hi:[1,0,0]
v_pk_fma_f32 v[78:79], v[78:79], v[70:71], v[70:71] op_sel_hi:[1,0,0]
v_pk_fma_f32 v[80:81], v[80:81], v[74:75], v[74:75] op_sel_hi:[1,0,0]
v_pk_fma_f32 v[82:83], v[82:83], v[74:75], v[74:75] op_sel_hi:[1,0,0]
v_rcp_f32 v76, v76
v_rcp_f32 v77, v77
v_rcp_f32 v78, v78
v_rcp_f32 v79, v79
v_rcp_f32 v80, v80
v_rcp_f32 v81, v81
v_rcp_f32 v82, v82
v_rcp_f32 v83, v83
v_pk_mul_f32 v[204:205], v[188:189], v[204:205]
v_pk_mul_f32 v[206:207], v[190:191], v[206:207]
v_pk_mul_f32 v[236:237], v[220:221], v[236:237]
v_pk_mul_f32 v[238:239], v[222:223], v[238:239]
v_pk_mul_f32 v[204:205], v[204:205], v[76:77]
v_pk_mul_f32 v[206:207], v[206:207], v[78:79]
v_pk_mul_f32 v[236:237], v[236:237], v[80:81]
v_pk_mul_f32 v[238:239], v[238:239], v[82:83]
v_cvt_pk_bf16_f32 v188, v204, v205
v_cvt_pk_bf16_f32 v189, v206, v207
v_cvt_pk_bf16_f32 v220, v236, v237
v_cvt_pk_bf16_f32 v221, v238, v239
v_pk_fma_f32 v[192:193], v[64:65], v[32:33], v[192:193] op_sel_hi:[0,1,1] neg_lo:[1,0,0] neg_hi:[1,0,0]
v_pk_fma_f32 v[194:195], v[64:65], v[34:35], v[194:195] op_sel_hi:[0,1,1] neg_lo:[1,0,0] neg_hi:[1,0,0]
v_pk_fma_f32 v[224:225], v[66:67], v[32:33], v[224:225] op_sel_hi:[0,1,1] neg_lo:[1,0,0] neg_hi:[1,0,0]
v_pk_fma_f32 v[226:227], v[66:67], v[34:35], v[226:227] op_sel_hi:[0,1,1] neg_lo:[1,0,0] neg_hi:[1,0,0]
v_pk_mul_f32 v[76:77], v[192:193], v[192:193]
v_pk_mul_f32 v[78:79], v[194:195], v[194:195]
v_pk_mul_f32 v[80:81], v[224:225], v[224:225]
v_pk_mul_f32 v[82:83], v[226:227], v[226:227]
v_pk_fma_f32 v[76:77], v[76:77], v[68:69], v[68:69] op_sel:[0,1,0] op_sel_hi:[1,1,0]
v_pk_fma_f32 v[78:79], v[78:79], v[68:69], v[68:69] op_sel:[0,1,0] op_sel_hi:[1,1,0]
v_pk_fma_f32 v[80:81], v[80:81], v[72:73], v[72:73] op_sel:[0,1,0] op_sel_hi:[1,1,0]
v_pk_fma_f32 v[82:83], v[82:83], v[72:73], v[72:73] op_sel:[0,1,0] op_sel_hi:[1,1,0]
v_pk_mul_f32 v[76:77], v[76:77], v[192:193]
v_pk_mul_f32 v[78:79], v[78:79], v[194:195]
v_pk_mul_f32 v[80:81], v[80:81], v[224:225]
v_pk_mul_f32 v[82:83], v[82:83], v[226:227]
v_exp_f32 v76, v76
v_exp_f32 v77, v77
v_exp_f32 v78, v78
v_exp_f32 v79, v79
v_exp_f32 v80, v80
v_exp_f32 v81, v81
v_exp_f32 v82, v82
v_exp_f32 v83, v83
v_pk_fma_f32 v[208:209], v[64:65], v[48:49], v[208:209] op_sel_hi:[0,1,1] neg_lo:[1,0,0] neg_hi:[1,0,0]
v_pk_fma_f32 v[210:211], v[64:65], v[50:51], v[210:211] op_sel_hi:[0,1,1] neg_lo:[1,0,0] neg_hi:[1,0,0]
v_pk_fma_f32 v[240:241], v[66:67], v[48:49], v[240:241] op_sel_hi:[0,1,1] neg_lo:[1,0,0] neg_hi:[1,0,0]
v_pk_fma_f32 v[242:243], v[66:67], v[50:51], v[242:243] op_sel_hi:[0,1,1] neg_lo:[1,0,0] neg_hi:[1,0,0]
v_pk_fma_f32 v[76:77], v[76:77], v[70:71], v[70:71] op_sel_hi:[1,0,0]
v_pk_fma_f32 v[78:79], v[78:79], v[70:71], v[70:71] op_sel_hi:[1,0,0]
v_pk_fma_f32 v[80:81], v[80:81], v[74:75], v[74:75] op_sel_hi:[1,0,0]
v_pk_fma_f32 v[82:83], v[82:83], v[74:75], v[74:75] op_sel_hi:[1,0,0]
v_rcp_f32 v76, v76
v_rcp_f32 v77, v77
v_rcp_f32 v78, v78
v_rcp_f32 v79, v79
v_rcp_f32 v80, v80
v_rcp_f32 v81, v81
v_rcp_f32 v82, v82
v_rcp_f32 v83, v83
v_pk_mul_f32 v[208:209], v[192:193], v[208:209]
v_pk_mul_f32 v[210:211], v[194:195], v[210:211]
v_pk_mul_f32 v[240:241], v[224:225], v[240:241]
v_pk_mul_f32 v[242:243], v[226:227], v[242:243]
v_pk_mul_f32 v[208:209], v[208:209], v[76:77]
v_pk_mul_f32 v[210:211], v[210:211], v[78:79]
v_pk_mul_f32 v[240:241], v[240:241], v[80:81]
v_pk_mul_f32 v[242:243], v[242:243], v[82:83]
v_cvt_pk_bf16_f32 v190, v208, v209
v_cvt_pk_bf16_f32 v191, v210, v211
v_cvt_pk_bf16_f32 v222, v240, v241
v_cvt_pk_bf16_f32 v223, v242, v243
buffer_store_dwordx4 v[188:191], v2, s[24:27], s54 offen offset:2048 sc1
buffer_store_dwordx4 v[220:223], v2, s[24:27], s54 offen offset:3072 sc1
v_pk_fma_f32 v[196:197], v[64:65], v[36:37], v[196:197] op_sel_hi:[0,1,1] neg_lo:[1,0,0] neg_hi:[1,0,0]
v_pk_fma_f32 v[198:199], v[64:65], v[38:39], v[198:199] op_sel_hi:[0,1,1] neg_lo:[1,0,0] neg_hi:[1,0,0]
v_pk_fma_f32 v[228:229], v[66:67], v[36:37], v[228:229] op_sel_hi:[0,1,1] neg_lo:[1,0,0] neg_hi:[1,0,0]
v_pk_fma_f32 v[230:231], v[66:67], v[38:39], v[230:231] op_sel_hi:[0,1,1] neg_lo:[1,0,0] neg_hi:[1,0,0]
v_pk_mul_f32 v[76:77], v[196:197], v[196:197]
v_pk_mul_f32 v[78:79], v[198:199], v[198:199]
v_pk_mul_f32 v[80:81], v[228:229], v[228:229]
v_pk_mul_f32 v[82:83], v[230:231], v[230:231]
v_pk_fma_f32 v[76:77], v[76:77], v[68:69], v[68:69] op_sel:[0,1,0] op_sel_hi:[1,1,0]
v_pk_fma_f32 v[78:79], v[78:79], v[68:69], v[68:69] op_sel:[0,1,0] op_sel_hi:[1,1,0]
v_pk_fma_f32 v[80:81], v[80:81], v[72:73], v[72:73] op_sel:[0,1,0] op_sel_hi:[1,1,0]
v_pk_fma_f32 v[82:83], v[82:83], v[72:73], v[72:73] op_sel:[0,1,0] op_sel_hi:[1,1,0]
v_pk_mul_f32 v[76:77], v[76:77], v[196:197]
v_pk_mul_f32 v[78:79], v[78:79], v[198:199]
v_pk_mul_f32 v[80:81], v[80:81], v[228:229]
v_pk_mul_f32 v[82:83], v[82:83], v[230:231]
v_exp_f32 v76, v76
v_exp_f32 v77, v77
v_exp_f32 v78, v78
v_exp_f32 v79, v79
v_exp_f32 v80, v80
v_exp_f32 v81, v81
v_exp_f32 v82, v82
v_exp_f32 v83, v83
v_pk_fma_f32 v[212:213], v[64:65], v[52:53], v[212:213] op_sel_hi:[0,1,1] neg_lo:[1,0,0] neg_hi:[1,0,0]
v_pk_fma_f32 v[214:215], v[64:65], v[54:55], v[214:215] op_sel_hi:[0,1,1] neg_lo:[1,0,0] neg_hi:[1,0,0]
v_pk_fma_f32 v[244:245], v[66:67], v[52:53], v[244:245] op_sel_hi:[0,1,1] neg_lo:[1,0,0] neg_hi:[1,0,0]
v_pk_fma_f32 v[246:247], v[66:67], v[54:55], v[246:247] op_sel_hi:[0,1,1] neg_lo:[1,0,0] neg_hi:[1,0,0]
v_pk_fma_f32 v[76:77], v[76:77], v[70:71], v[70:71] op_sel_hi:[1,0,0]
v_pk_fma_f32 v[78:79], v[78:79], v[70:71], v[70:71] op_sel_hi:[1,0,0]
v_pk_fma_f32 v[80:81], v[80:81], v[74:75], v[74:75] op_sel_hi:[1,0,0]
v_pk_fma_f32 v[82:83], v[82:83], v[74:75], v[74:75] op_sel_hi:[1,0,0]
v_rcp_f32 v76, v76
v_rcp_f32 v77, v77
v_rcp_f32 v78, v78
v_rcp_f32 v79, v79
v_rcp_f32 v80, v80
v_rcp_f32 v81, v81
v_rcp_f32 v82, v82
v_rcp_f32 v83, v83
v_pk_mul_f32 v[212:213], v[196:197], v[212:213]
v_pk_mul_f32 v[214:215], v[198:199], v[214:215]
v_pk_mul_f32 v[244:245], v[228:229], v[244:245]
v_pk_mul_f32 v[246:247], v[230:231], v[246:247]
v_pk_mul_f32 v[212:213], v[212:213], v[76:77]
v_pk_mul_f32 v[214:215], v[214:215], v[78:79]
v_pk_mul_f32 v[244:245], v[244:245], v[80:81]
v_pk_mul_f32 v[246:247], v[246:247], v[82:83]
v_cvt_pk_bf16_f32 v196, v212, v213
v_cvt_pk_bf16_f32 v197, v214, v215
v_cvt_pk_bf16_f32 v228, v244, v245
v_cvt_pk_bf16_f32 v229, v246, v247
v_pk_fma_f32 v[200:201], v[64:65], v[40:41], v[200:201] op_sel_hi:[0,1,1] neg_lo:[1,0,0] neg_hi:[1,0,0]
v_pk_fma_f32 v[202:203], v[64:65], v[42:43], v[202:203] op_sel_hi:[0,1,1] neg_lo:[1,0,0] neg_hi:[1,0,0]
v_pk_fma_f32 v[232:233], v[66:67], v[40:41], v[232:233] op_sel_hi:[0,1,1] neg_lo:[1,0,0] neg_hi:[1,0,0]
v_pk_fma_f32 v[234:235], v[66:67], v[42:43], v[234:235] op_sel_hi:[0,1,1] neg_lo:[1,0,0] neg_hi:[1,0,0]
v_pk_mul_f32 v[76:77], v[200:201], v[200:201]
v_pk_mul_f32 v[78:79], v[202:203], v[202:203]
v_pk_mul_f32 v[80:81], v[232:233], v[232:233]
v_pk_mul_f32 v[82:83], v[234:235], v[234:235]
v_pk_fma_f32 v[76:77], v[76:77], v[68:69], v[68:69] op_sel:[0,1,0] op_sel_hi:[1,1,0]
v_pk_fma_f32 v[78:79], v[78:79], v[68:69], v[68:69] op_sel:[0,1,0] op_sel_hi:[1,1,0]
v_pk_fma_f32 v[80:81], v[80:81], v[72:73], v[72:73] op_sel:[0,1,0] op_sel_hi:[1,1,0]
v_pk_fma_f32 v[82:83], v[82:83], v[72:73], v[72:73] op_sel:[0,1,0] op_sel_hi:[1,1,0]
v_pk_mul_f32 v[76:77], v[76:77], v[200:201]
v_pk_mul_f32 v[78:79], v[78:79], v[202:203]
v_pk_mul_f32 v[80:81], v[80:81], v[232:233]
v_pk_mul_f32 v[82:83], v[82:83], v[234:235]
v_exp_f32 v76, v76
v_exp_f32 v77, v77
v_exp_f32 v78, v78
v_exp_f32 v79, v79
v_exp_f32 v80, v80
v_exp_f32 v81, v81
v_exp_f32 v82, v82
v_exp_f32 v83, v83
v_pk_fma_f32 v[216:217], v[64:65], v[56:57], v[216:217] op_sel_hi:[0,1,1] neg_lo:[1,0,0] neg_hi:[1,0,0]
v_pk_fma_f32 v[218:219], v[64:65], v[58:59], v[218:219] op_sel_hi:[0,1,1] neg_lo:[1,0,0] neg_hi:[1,0,0]
v_pk_fma_f32 v[248:249], v[66:67], v[56:57], v[248:249] op_sel_hi:[0,1,1] neg_lo:[1,0,0] neg_hi:[1,0,0]
v_pk_fma_f32 v[250:251], v[66:67], v[58:59], v[250:251] op_sel_hi:[0,1,1] neg_lo:[1,0,0] neg_hi:[1,0,0]
v_pk_fma_f32 v[76:77], v[76:77], v[70:71], v[70:71] op_sel_hi:[1,0,0]
v_pk_fma_f32 v[78:79], v[78:79], v[70:71], v[70:71] op_sel_hi:[1,0,0]
v_pk_fma_f32 v[80:81], v[80:81], v[74:75], v[74:75] op_sel_hi:[1,0,0]
v_pk_fma_f32 v[82:83], v[82:83], v[74:75], v[74:75] op_sel_hi:[1,0,0]
v_rcp_f32 v76, v76
v_rcp_f32 v77, v77
v_rcp_f32 v78, v78
v_rcp_f32 v79, v79
v_rcp_f32 v80, v80
v_rcp_f32 v81, v81
v_rcp_f32 v82, v82
v_rcp_f32 v83, v83
v_pk_mul_f32 v[216:217], v[200:201], v[216:217]
v_pk_mul_f32 v[218:219], v[202:203], v[218:219]
v_pk_mul_f32 v[248:249], v[232:233], v[248:249]
v_pk_mul_f32 v[250:251], v[234:235], v[250:251]
v_pk_mul_f32 v[216:217], v[216:217], v[76:77]
v_pk_mul_f32 v[218:219], v[218:219], v[78:79]
v_pk_mul_f32 v[248:249], v[248:249], v[80:81]
v_pk_mul_f32 v[250:251], v[250:251], v[82:83]
v_cvt_pk_bf16_f32 v198, v216, v217
v_cvt_pk_bf16_f32 v199, v218, v219
v_cvt_pk_bf16_f32 v230, v248, v249
v_cvt_pk_bf16_f32 v231, v250, v251
buffer_store_dwordx4 v[196:199], v2, s[24:27], s55 offen offset:2048 sc1
buffer_store_dwordx4 v[228:231], v2, s[24:27], s55 offen offset:3072 sc1
s_barrier
s_add_u32 s37, s52, 589824
s_add_u32 m0, s39, 81920
s_nop 0
buffer_load_dwordx4 v3, s[24:27], s37 offen sc1 lds
buffer_load_dwordx4 v3, s[24:27], s37 offen offset:1024 sc1 lds
buffer_load_dwordx4 v3, s[24:27], s37 offen offset:2048 sc1 lds
buffer_load_dwordx4 v3, s[24:27], s37 offen offset:3072 sc1 lds
s_add_u32 s38, s53, 4718592
s_add_u32 m0, s39, 147456
s_nop 0
buffer_load_dwordx4 v23, s[28:31], s38 offen lds
s_add_u32 m0, s39, 148480
s_nop 0
buffer_load_dwordx4 v24, s[28:31], s38 offen lds
s_add_u32 m0, s39, 149504
s_add_u32 s38, s38, 16384
buffer_load_dwordx4 v23, s[28:31], s38 offen lds
s_add_u32 m0, s39, 150528
s_nop 0
buffer_load_dwordx4 v24, s[28:31], s38 offen lds
s_add_u32 s37, s52, 606208
s_add_u32 m0, s39, 98304
s_nop 0
buffer_load_dwordx4 v3, s[24:27], s37 offen sc1 lds
buffer_load_dwordx4 v3, s[24:27], s37 offen offset:1024 sc1 lds
buffer_load_dwordx4 v3, s[24:27], s37 offen offset:2048 sc1 lds
buffer_load_dwordx4 v3, s[24:27], s37 offen offset:3072 sc1 lds
s_add_u32 s38, s53, 4849664
s_add_u32 m0, s39, 114688
s_nop 0
buffer_load_dwordx4 v23, s[28:31], s38 offen lds
s_add_u32 m0, s39, 115712
s_nop 0
buffer_load_dwordx4 v24, s[28:31], s38 offen lds
s_add_u32 m0, s39, 116736
s_add_u32 s38, s38, 16384
buffer_load_dwordx4 v23, s[28:31], s38 offen lds
s_add_u32 m0, s39, 117760
s_nop 0
buffer_load_dwordx4 v24, s[28:31], s38 offen lds
s_barrier
s_add_u32 s37, s52, 622592
s_add_u32 m0, s39, 131072
s_nop 0
buffer_load_dwordx4 v3, s[24:27], s37 offen sc1 lds
buffer_load_dwordx4 v3, s[24:27], s37 offen offset:1024 sc1 lds
buffer_load_dwordx4 v3, s[24:27], s37 offen offset:2048 sc1 lds
buffer_load_dwordx4 v3, s[24:27], s37 offen offset:3072 sc1 lds
s_add_u32 s38, s53, 4980736
s_add_u32 m0, s39, 0
s_nop 0
buffer_load_dwordx4 v23, s[28:31], s38 offen lds
s_add_u32 m0, s39, 1024
s_nop 0
buffer_load_dwordx4 v24, s[28:31], s38 offen lds
s_add_u32 m0, s39, 2048
s_add_u32 s38, s38, 16384
buffer_load_dwordx4 v23, s[28:31], s38 offen lds
s_add_u32 m0, s39, 3072
s_nop 0
buffer_load_dwordx4 v24, s[28:31], s38 offen lds
s_waitcnt vmcnt(24)
s_barrier
s_cmp_eq_u32 s47, 0
s_cbranch_scc0 Lw_128
s_add_u32 s7, s34, 48
s_lshl_b32 s7, s7, 7
v_mov_b32 v26, s7
v_mov_b32 v27, 1
s_mov_b64 exec, 1
buffer_atomic_add v27, v26, s[56:59], 0 offen sc1
s_mov_b64 exec, -1
Lw_128:
s_add_u32 s37, s52, 638976
s_add_u32 m0, s39, 16384
s_nop 0
buffer_load_dwordx4 v3, s[24:27], s37 offen sc1 lds
buffer_load_dwordx4 v3, s[24:27], s37 offen offset:1024 sc1 lds
buffer_load_dwordx4 v3, s[24:27], s37 offen offset:2048 sc1 lds
buffer_load_dwordx4 v3, s[24:27], s37 offen offset:3072 sc1 lds
s_add_u32 s38, s53, 5111808
s_add_u32 m0, s39, 32768
s_nop 0
buffer_load_dwordx4 v23, s[28:31], s38 offen lds
s_add_u32 m0, s39, 33792
s_nop 0
buffer_load_dwordx4 v24, s[28:31], s38 offen lds
s_add_u32 m0, s39, 34816
s_add_u32 s38, s38, 16384
buffer_load_dwordx4 v23, s[28:31], s38 offen lds
s_add_u32 m0, s39, 35840
s_nop 0
buffer_load_dwordx4 v24, s[28:31], s38 offen lds
s_waitcnt vmcnt(24)
s_barrier
s_add_u32 s37, s52, 655360
s_add_u32 m0, s39, 49152
s_nop 0
buffer_load_dwordx4 v3, s[24:27], s37 offen sc1 lds
buffer_load_dwordx4 v3, s[24:27], s37 offen offset:1024 sc1 lds
buffer_load_dwordx4 v3, s[24:27], s37 offen offset:2048 sc1 lds
buffer_load_dwordx4 v3, s[24:27], s37 offen offset:3072 sc1 lds
s_add_u32 s38, s53, 5242880
s_add_u32 m0, s39, 65536
s_nop 0
buffer_load_dwordx4 v23, s[28:31], s38 offen lds
s_add_u32 m0, s39, 66560
s_nop 0
buffer_load_dwordx4 v24, s[28:31], s38 offen lds
s_add_u32 m0, s39, 67584
s_add_u32 s38, s38, 16384
buffer_load_dwordx4 v23, s[28:31], s38 offen lds
s_add_u32 m0, s39, 68608
s_nop 0
buffer_load_dwordx4 v24, s[28:31], s38 offen lds
s_waitcnt vmcnt(24)
s_barrier
s_add_u32 s37, s52, 671744
s_add_u32 m0, s39, 81920
s_nop 0
buffer_load_dwordx4 v3, s[24:27], s37 offen sc1 lds
buffer_load_dwordx4 v3, s[24:27], s37 offen offset:1024 sc1 lds
buffer_load_dwordx4 v3, s[24:27], s37 offen offset:2048 sc1 lds
buffer_load_dwordx4 v3, s[24:27], s37 offen offset:3072 sc1 lds
s_add_u32 s38, s53, 5373952
s_add_u32 m0, s39, 147456
s_nop 0
buffer_load_dwordx4 v23, s[28:31], s38 offen lds
s_add_u32 m0, s39, 148480
s_nop 0
buffer_load_dwordx4 v24, s[28:31], s38 offen lds
s_add_u32 m0, s39, 149504
s_add_u32 s38, s38, 16384
buffer_load_dwordx4 v23, s[28:31], s38 offen lds
s_add_u32 m0, s39, 150528
s_nop 0
buffer_load_dwordx4 v24, s[28:31], s38 offen lds
s_waitcnt vmcnt(24)
s_barrier
s_add_u32 s37, s52, 688128
s_add_u32 m0, s39, 98304
s_nop 0
buffer_load_dwordx4 v3, s[24:27], s37 offen sc1 lds
buffer_load_dwordx4 v3, s[24:27], s37 offen offset:1024 sc1 lds
buffer_load_dwordx4 v3, s[24:27], s37 offen offset:2048 sc1 lds
buffer_load_dwordx4 v3, s[24:27], s37 offen offset:3072 sc1 lds
s_add_u32 s38, s53, 5505024
s_add_u32 m0, s39, 114688
s_nop 0
buffer_load_dwordx4 v23, s[28:31], s38 offen lds
s_add_u32 m0, s39, 115712
s_nop 0
buffer_load_dwordx4 v24, s[28:31], s38 offen lds
s_add_u32 m0, s39, 116736
s_add_u32 s38, s38, 16384
buffer_load_dwordx4 v23, s[28:31], s38 offen lds
s_add_u32 m0, s39, 117760
s_nop 0
buffer_load_dwordx4 v24, s[28:31], s38 offen lds
s_waitcnt vmcnt(24)
s_barrier
s_cmp_eq_u32 s47, 3
s_cbranch_scc0 Lw_129
s_lshl_b32 s92, s34, 7
s_add_u32 s92, s92, 28317696
s_load_dword s93, s[82:83], s92 glc
Lw_129:
s_add_u32 s37, s52, 704512
s_add_u32 m0, s39, 131072
s_nop 0
buffer_load_dwordx4 v3, s[24:27], s37 offen sc1 lds
buffer_load_dwordx4 v3, s[24:27], s37 offen offset:1024 sc1 lds
buffer_load_dwordx4 v3, s[24:27], s37 offen offset:2048 sc1 lds
buffer_load_dwordx4 v3, s[24:27], s37 offen offset:3072 sc1 lds
s_add_u32 s38, s53, 5636096
s_add_u32 m0, s39, 0
s_nop 0
buffer_load_dwordx4 v23, s[28:31], s38 offen lds
s_add_u32 m0, s39, 1024
s_nop 0
buffer_load_dwordx4 v24, s[28:31], s38 offen lds
s_add_u32 m0, s39, 2048
s_add_u32 s38, s38, 16384
buffer_load_dwordx4 v23, s[28:31], s38 offen lds
s_add_u32 m0, s39, 3072
s_nop 0
s_branch Lov_17
.p2align 12
.fill 128, 4, 0xbf800000
Lst_17_0:
s_branch Lwr_161
s_nop 0
s_nop 0
Lov_17:
buffer_load_dwordx4 v24, s[28:31], s38 offen lds
s_waitcnt vmcnt(24)
s_cmp_eq_u32 s47, 3
s_cbranch_scc0 Lw_130
s_mov_b32 s41, 0x40000
s_branch Lpchk_133
Lpoll_131:
s_load_dword s93, s[82:83], s92 glc
Lpchk_133:
s_waitcnt lgkmcnt(0)
s_cmp_eq_u32 s93, 16
s_cbranch_scc1 Lpok_132
s_sub_u32 s41, s41, 1
s_cmp_lg_u32 s41, 0
s_cbranch_scc1 Lpoll_131
Lpok_132:
Lw_130:
s_barrier
s_add_u32 s37, s90, 0
s_add_u32 m0, s39, 16384
s_nop 0
buffer_load_dwordx4 v3, s[24:27], s37 offen sc1 lds
buffer_load_dwordx4 v3, s[24:27], s37 offen offset:1024 sc1 lds
buffer_load_dwordx4 v3, s[24:27], s37 offen offset:2048 sc1 lds
buffer_load_dwordx4 v3, s[24:27], s37 offen offset:3072 sc1 lds
s_add_u32 s38, s91, 0
s_add_u32 m0, s39, 32768
s_nop 0
buffer_load_dwordx4 v23, s[28:31], s38 offen lds
s_add_u32 m0, s39, 33792
s_nop 0
buffer_load_dwordx4 v24, s[28:31], s38 offen lds
s_add_u32 m0, s39, 34816
s_add_u32 s38, s38, 16384
buffer_load_dwordx4 v23, s[28:31], s38 offen lds
s_add_u32 m0, s39, 35840
s_nop 0
buffer_load_dwordx4 v24, s[28:31], s38 offen lds
s_waitcnt vmcnt(24)
s_barrier
s_add_u32 s37, s90, 16384
s_add_u32 m0, s39, 49152
s_nop 0
buffer_load_dwordx4 v3, s[24:27], s37 offen sc1 lds
buffer_load_dwordx4 v3, s[24:27], s37 offen offset:1024 sc1 lds
buffer_load_dwordx4 v3, s[24:27], s37 offen offset:2048 sc1 lds
buffer_load_dwordx4 v3, s[24:27], s37 offen offset:3072 sc1 lds
s_add_u32 s38, s91, 131072
s_add_u32 m0, s39, 65536
s_nop 0
buffer_load_dwordx4 v23, s[28:31], s38 offen lds
s_add_u32 m0, s39, 66560
s_nop 0
buffer_load_dwordx4 v24, s[28:31], s38 offen lds
s_add_u32 m0, s39, 67584
s_add_u32 s38, s38, 16384
buffer_load_dwordx4 v23, s[28:31], s38 offen lds
s_add_u32 m0, s39, 68608
s_nop 0
buffer_load_dwordx4 v24, s[28:31], s38 offen lds
s_waitcnt vmcnt(24)
s_barrier
s_add_u32 s37, s90, 32768
s_add_u32 m0, s39, 81920
s_nop 0
buffer_load_dwordx4 v3, s[24:27], s37 offen sc1 lds
buffer_load_dwordx4 v3, s[24:27], s37 offen offset:1024 sc1 lds
buffer_load_dwordx4 v3, s[24:27], s37 offen offset:2048 sc1 lds
buffer_load_dwordx4 v3, s[24:27], s37 offen offset:3072 sc1 lds
s_add_u32 s38, s91, 262144
s_add_u32 m0, s39, 147456
s_nop 0
buffer_load_dwordx4 v23, s[28:31], s38 offen lds
s_add_u32 m0, s39, 148480
s_nop 0
buffer_load_dwordx4 v24, s[28:31], s38 offen lds
s_add_u32 m0, s39, 149504
s_add_u32 s38, s38, 16384
buffer_load_dwordx4 v23, s[28:31], s38 offen lds
s_add_u32 m0, s39, 150528
s_nop 0
buffer_load_dwordx4 v24, s[28:31], s38 offen lds
s_waitcnt vmcnt(24)
s_barrier
s_add_u32 s37, s90, 49152
s_add_u32 m0, s39, 98304
s_nop 0
buffer_load_dwordx4 v3, s[24:27], s37 offen sc1 lds
buffer_load_dwordx4 v3, s[24:27], s37 offen offset:1024 sc1 lds
buffer_load_dwordx4 v3, s[24:27], s37 offen offset:2048 sc1 lds
buffer_load_dwordx4 v3, s[24:27], s37 offen offset:3072 sc1 lds
s_add_u32 s38, s91, 393216
s_add_u32 m0, s39, 114688
s_nop 0
buffer_load_dwordx4 v23, s[28:31], s38 offen lds
s_add_u32 m0, s39, 115712
s_nop 0
buffer_load_dwordx4 v24, s[28:31], s38 offen lds
s_add_u32 m0, s39, 116736
s_add_u32 s38, s38, 16384
buffer_load_dwordx4 v23, s[28:31], s38 offen lds
s_add_u32 m0, s39, 117760
s_nop 0
buffer_load_dwordx4 v24, s[28:31], s38 offen lds
s_waitcnt vmcnt(24)
s_barrier
s_add_u32 s37, s90, 65536
s_add_u32 m0, s39, 131072
s_nop 0
buffer_load_dwordx4 v3, s[24:27], s37 offen sc1 lds
buffer_load_dwordx4 v3, s[24:27], s37 offen offset:1024 sc1 lds
buffer_load_dwordx4 v3, s[24:27], s37 offen offset:2048 sc1 lds
buffer_load_dwordx4 v3, s[24:27], s37 offen offset:3072 sc1 lds
s_add_u32 s38, s91, 524288
s_add_u32 m0, s39, 0
s_nop 0
buffer_load_dwordx4 v23, s[28:31], s38 offen lds
s_add_u32 m0, s39, 1024
s_nop 0
buffer_load_dwordx4 v24, s[28:31], s38 offen lds
s_add_u32 m0, s39, 2048
s_add_u32 s38, s38, 16384
buffer_load_dwordx4 v23, s[28:31], s38 offen lds
s_add_u32 m0, s39, 3072
s_nop 0
buffer_load_dwordx4 v24, s[28:31], s38 offen lds
s_waitcnt vmcnt(24)
s_barrier
s_add_u32 s37, s90, 81920
s_add_u32 m0, s39, 16384
s_nop 0
buffer_load_dwordx4 v3, s[24:27], s37 offen sc1 lds
buffer_load_dwordx4 v3, s[24:27], s37 offen offset:1024 sc1 lds
buffer_load_dwordx4 v3, s[24:27], s37 offen offset:2048 sc1 lds
buffer_load_dwordx4 v3, s[24:27], s37 offen offset:3072 sc1 lds
s_add_u32 s38, s91, 655360
s_add_u32 m0, s39, 32768
s_nop 0
buffer_load_dwordx4 v23, s[28:31], s38 offen lds
s_add_u32 m0, s39, 33792
s_nop 0
buffer_load_dwordx4 v24, s[28:31], s38 offen lds
s_add_u32 m0, s39, 34816
s_add_u32 s38, s38, 16384
buffer_load_dwordx4 v23, s[28:31], s38 offen lds
s_add_u32 m0, s39, 35840
s_nop 0
buffer_load_dwordx4 v24, s[28:31], s38 offen lds
s_waitcnt vmcnt(24)
s_barrier
s_add_u32 s37, s90, 98304
s_add_u32 m0, s39, 49152
s_nop 0
buffer_load_dwordx4 v3, s[24:27], s37 offen sc1 lds
buffer_load_dwordx4 v3, s[24:27], s37 offen offset:1024 sc1 lds
buffer_load_dwordx4 v3, s[24:27], s37 offen offset:2048 sc1 lds
buffer_load_dwordx4 v3, s[24:27], s37 offen offset:3072 sc1 lds
s_add_u32 s38, s91, 786432
s_add_u32 m0, s39, 65536
s_nop 0
buffer_load_dwordx4 v23, s[28:31], s38 offen lds
s_add_u32 m0, s39, 66560
s_nop 0
buffer_load_dwordx4 v24, s[28:31], s38 offen lds
s_add_u32 m0, s39, 67584
s_add_u32 s38, s38, 16384
buffer_load_dwordx4 v23, s[28:31], s38 offen lds
s_add_u32 m0, s39, 68608
s_nop 0
buffer_load_dwordx4 v24, s[28:31], s38 offen lds
s_waitcnt vmcnt(24)
s_barrier
s_add_u32 s37, s90, 114688
s_add_u32 m0, s39, 81920
s_nop 0
buffer_load_dwordx4 v3, s[24:27], s37 offen sc1 lds
buffer_load_dwordx4 v3, s[24:27], s37 offen offset:1024 sc1 lds
buffer_load_dwordx4 v3, s[24:27], s37 offen offset:2048 sc1 lds
buffer_load_dwordx4 v3, s[24:27], s37 offen offset:3072 sc1 lds
s_add_u32 s38, s91, 917504
s_add_u32 m0, s39, 147456
s_nop 0
buffer_load_dwordx4 v23, s[28:31], s38 offen lds
s_add_u32 m0, s39, 148480
s_nop 0
buffer_load_dwordx4 v24, s[28:31], s38 offen lds
s_add_u32 m0, s39, 149504
s_add_u32 s38, s38, 16384
buffer_load_dwordx4 v23, s[28:31], s38 offen lds
s_add_u32 m0, s39, 150528
s_nop 0
buffer_load_dwordx4 v24, s[28:31], s38 offen lds
s_waitcnt vmcnt(24)
s_barrier
s_add_u32 s37, s90, 131072
s_add_u32 m0, s39, 98304
s_nop 0
buffer_load_dwordx4 v3, s[24:27], s37 offen sc1 lds
buffer_load_dwordx4 v3, s[24:27], s37 offen offset:1024 sc1 lds
buffer_load_dwordx4 v3, s[24:27], s37 offen offset:2048 sc1 lds
buffer_load_dwordx4 v3, s[24:27], s37 offen offset:3072 sc1 lds
s_add_u32 s38, s91, 1048576
s_add_u32 m0, s39, 114688
s_nop 0
buffer_load_dwordx4 v23, s[28:31], s38 offen lds
s_add_u32 m0, s39, 115712
s_nop 0
buffer_load_dwordx4 v24, s[28:31], s38 offen lds
s_add_u32 m0, s39, 116736
s_add_u32 s38, s38, 16384
buffer_load_dwordx4 v23, s[28:31], s38 offen lds
s_add_u32 m0, s39, 117760
s_nop 0
buffer_load_dwordx4 v24, s[28:31], s38 offen lds
s_waitcnt vmcnt(24)
s_barrier
s_add_u32 s37, s90, 147456
s_add_u32 m0, s39, 131072
s_nop 0
buffer_load_dwordx4 v3, s[24:27], s37 offen sc1 lds
buffer_load_dwordx4 v3, s[24:27], s37 offen offset:1024 sc1 lds
buffer_load_dwordx4 v3, s[24:27], s37 offen offset:2048 sc1 lds
buffer_load_dwordx4 v3, s[24:27], s37 offen offset:3072 sc1 lds
s_add_u32 s38, s91, 1179648
s_add_u32 m0, s39, 0
s_nop 0
buffer_load_dwordx4 v23, s[28:31], s38 offen lds
s_add_u32 m0, s39, 1024
s_nop 0
buffer_load_dwordx4 v24, s[28:31], s38 offen lds
s_add_u32 m0, s39, 2048
s_add_u32 s38, s38, 16384
buffer_load_dwordx4 v23, s[28:31], s38 offen lds
s_add_u32 m0, s39, 3072
s_nop 0
buffer_load_dwordx4 v24, s[28:31], s38 offen lds
s_waitcnt vmcnt(24)
s_barrier
s_mov_b32 s37, 327680
s_add_u32 m0, s39, 16384
s_nop 0
buffer_load_dwordx4 v3, s[24:27], s37 offen sc1 lds
buffer_load_dwordx4 v3, s[24:27], s37 offen offset:1024 sc1 lds
buffer_load_dwordx4 v3, s[24:27], s37 offen offset:2048 sc1 lds
buffer_load_dwordx4 v3, s[24:27], s37 offen offset:3072 sc1 lds
s_mov_b32 s38, 2621440
s_add_u32 m0, s51, 32768
s_nop 0
buffer_load_dwordx4 v25, s[28:31], s38 offen lds
s_add_u32 m0, s51, 33792
s_add_u32 s38, s38, 16384
buffer_load_dwordx4 v25, s[28:31], s38 offen lds
s_waitcnt vmcnt(22)
s_barrier
s_mov_b32 s37, 344064
s_add_u32 m0, s39, 49152
s_nop 0
buffer_load_dwordx4 v3, s[24:27], s37 offen sc1 lds
buffer_load_dwordx4 v3, s[24:27], s37 offen offset:1024 sc1 lds
buffer_load_dwordx4 v3, s[24:27], s37 offen offset:2048 sc1 lds
buffer_load_dwordx4 v3, s[24:27], s37 offen offset:3072 sc1 lds
s_mov_b32 s38, 2752512
s_add_u32 m0, s51, 65536
s_nop 0
buffer_load_dwordx4 v25, s[28:31], s38 offen lds
s_add_u32 m0, s51, 66560
s_add_u32 s38, s38, 16384
buffer_load_dwordx4 v25, s[28:31], s38 offen lds
s_waitcnt vmcnt(20)
s_barrier
s_mov_b32 s37, 360448
s_add_u32 m0, s39, 81920
s_nop 0
buffer_load_dwordx4 v3, s[24:27], s37 offen sc1 lds
buffer_load_dwordx4 v3, s[24:27], s37 offen offset:1024 sc1 lds
buffer_load_dwordx4 v3, s[24:27], s37 offen offset:2048 sc1 lds
buffer_load_dwordx4 v3, s[24:27], s37 offen offset:3072 sc1 lds
s_mov_b32 s38, 2883584
s_add_u32 m0, s51, 147456
s_nop 0
buffer_load_dwordx4 v25, s[28:31], s38 offen lds
s_add_u32 m0, s51, 148480
s_add_u32 s38, s38, 16384
buffer_load_dwordx4 v25, s[28:31], s38 offen lds
s_waitcnt vmcnt(18)
s_barrier
s_mov_b32 s37, 376832
s_add_u32 m0, s39, 98304
s_nop 0
buffer_load_dwordx4 v3, s[24:27], s37 offen sc1 lds
buffer_load_dwordx4 v3, s[24:27], s37 offen offset:1024 sc1 lds
buffer_load_dwordx4 v3, s[24:27], s37 offen offset:2048 sc1 lds
buffer_load_dwordx4 v3, s[24:27], s37 offen offset:3072 sc1 lds
s_mov_b32 s38, 3014656
s_add_u32 m0, s51, 114688
s_nop 0
buffer_load_dwordx4 v25, s[28:31], s38 offen lds
s_add_u32 m0, s51, 115712
s_add_u32 s38, s38, 16384
buffer_load_dwordx4 v25, s[28:31], s38 offen lds
s_waitcnt vmcnt(18)
s_barrier
s_mov_b32 s37, 393216
s_add_u32 m0, s39, 131072
s_nop 0
buffer_load_dwordx4 v3, s[24:27], s37 offen sc1 lds
buffer_load_dwordx4 v3, s[24:27], s37 offen offset:1024 sc1 lds
buffer_load_dwordx4 v3, s[24:27], s37 offen offset:2048 sc1 lds
buffer_load_dwordx4 v3, s[24:27], s37 offen offset:3072 sc1 lds
s_mov_b32 s38, 3145728
s_add_u32 m0, s51, 0
s_nop 0
buffer_load_dwordx4 v25, s[28:31], s38 offen lds
s_add_u32 m0, s51, 1024
s_add_u32 s38, s38, 16384
buffer_load_dwordx4 v25, s[28:31], s38 offen lds
s_waitcnt vmcnt(18)
s_barrier
s_mov_b32 s37, 409600
s_add_u32 m0, s39, 16384
s_nop 0
buffer_load_dwordx4 v3, s[24:27], s37 offen sc1 lds
buffer_load_dwordx4 v3, s[24:27], s37 offen offset:1024 sc1 lds
buffer_load_dwordx4 v3, s[24:27], s37 offen offset:2048 sc1 lds
buffer_load_dwordx4 v3, s[24:27], s37 offen offset:3072 sc1 lds
s_mov_b32 s38, 3276800
s_add_u32 m0, s51, 32768
s_nop 0
buffer_load_dwordx4 v25, s[28:31], s38 offen lds
s_add_u32 m0, s51, 33792
s_add_u32 s38, s38, 16384
buffer_load_dwordx4 v25, s[28:31], s38 offen lds
s_waitcnt vmcnt(18)
s_barrier
s_mov_b32 s37, 425984
s_add_u32 m0, s39, 49152
s_nop 0
buffer_load_dwordx4 v3, s[24:27], s37 offen sc1 lds
buffer_load_dwordx4 v3, s[24:27], s37 offen offset:1024 sc1 lds
buffer_load_dwordx4 v3, s[24:27], s37 offen offset:2048 sc1 lds
buffer_load_dwordx4 v3, s[24:27], s37 offen offset:3072 sc1 lds
s_mov_b32 s38, 3407872
s_add_u32 m0, s51, 65536
s_nop 0
buffer_load_dwordx4 v25, s[28:31], s38 offen lds
s_add_u32 m0, s51, 66560
s_add_u32 s38, s38, 16384
buffer_load_dwordx4 v25, s[28:31], s38 offen lds
s_waitcnt vmcnt(18)
s_barrier
s_mov_b32 s37, 442368
s_add_u32 m0, s39, 81920
s_nop 0
buffer_load_dwordx4 v3, s[24:27], s37 offen sc1 lds
buffer_load_dwordx4 v3, s[24:27], s37 offen offset:1024 sc1 lds
buffer_load_dwordx4 v3, s[24:27], s37 offen offset:2048 sc1 lds
buffer_load_dwordx4 v3, s[24:27], s37 offen offset:3072 sc1 lds
s_mov_b32 s38, 3538944
s_add_u32 m0, s51, 147456
s_nop 0
buffer_load_dwordx4 v25, s[28:31], s38 offen lds
s_add_u32 m0, s51, 148480
s_add_u32 s38, s38, 16384
buffer_load_dwordx4 v25, s[28:31], s38 offen lds
s_waitcnt vmcnt(18)
s_barrier
s_mov_b32 s37, 458752
s_add_u32 m0, s39, 98304
s_nop 0
buffer_load_dwordx4 v3, s[24:27], s37 offen sc1 lds
buffer_load_dwordx4 v3, s[24:27], s37 offen offset:1024 sc1 lds
buffer_load_dwordx4 v3, s[24:27], s37 offen offset:2048 sc1 lds
buffer_load_dwordx4 v3, s[24:27], s37 offen offset:3072 sc1 lds
s_mov_b32 s38, 3670016
s_add_u32 m0, s51, 114688
s_nop 0
buffer_load_dwordx4 v25, s[28:31], s38 offen lds
s_add_u32 m0, s51, 115712
s_add_u32 s38, s38, 16384
buffer_load_dwordx4 v25, s[28:31], s38 offen lds
s_waitcnt vmcnt(18)
s_barrier
s_mov_b32 s37, 475136
s_add_u32 m0, s39, 131072
s_nop 0
buffer_load_dwordx4 v3, s[24:27], s37 offen sc1 lds
buffer_load_dwordx4 v3, s[24:27], s37 offen offset:1024 sc1 lds
buffer_load_dwordx4 v3, s[24:27], s37 offen offset:2048 sc1 lds
buffer_load_dwordx4 v3, s[24:27], s37 offen offset:3072 sc1 lds
s_mov_b32 s38, 3801088
s_add_u32 m0, s51, 0
s_nop 0
buffer_load_dwordx4 v25, s[28:31], s38 offen lds
s_add_u32 m0, s51, 1024
s_add_u32 s38, s38, 16384
buffer_load_dwordx4 v25, s[28:31], s38 offen lds
s_waitcnt vmcnt(18)
s_barrier
s_cmp_eq_u32 s47, 0
s_cbranch_scc0 Lw_134
s_xor_b32 s43, s2, 2
s_add_u32 s43, s43, 128
s_lshl_b32 s43, s43, 7
v_mov_b32 v26, s43
v_mov_b32 v27, 1
s_mov_b64 exec, 1
buffer_store_dword v27, v26, s[56:59], 0 offen sc1
s_mov_b64 exec, -1
Lw_134:
s_mov_b32 s37, 491520
s_add_u32 m0, s39, 16384
s_nop 0
buffer_load_dwordx4 v3, s[24:27], s37 offen sc1 lds
buffer_load_dwordx4 v3, s[24:27], s37 offen offset:1024 sc1 lds
buffer_load_dwordx4 v3, s[24:27], s37 offen offset:2048 sc1 lds
buffer_load_dwordx4 v3, s[24:27], s37 offen offset:3072 sc1 lds
s_mov_b32 s38, 3932160
s_add_u32 m0, s51, 32768
s_nop 0
buffer_load_dwordx4 v25, s[28:31], s38 offen lds
s_add_u32 m0, s51, 33792
s_add_u32 s38, s38, 16384
buffer_load_dwordx4 v25, s[28:31], s38 offen lds
s_waitcnt vmcnt(18)
s_barrier
s_mov_b32 s37, 507904
s_add_u32 m0, s39, 49152
s_nop 0
buffer_load_dwordx4 v3, s[24:27], s37 offen sc1 lds
buffer_load_dwordx4 v3, s[24:27], s37 offen offset:1024 sc1 lds
buffer_load_dwordx4 v3, s[24:27], s37 offen offset:2048 sc1 lds
buffer_load_dwordx4 v3, s[24:27], s37 offen offset:3072 sc1 lds
s_mov_b32 s38, 4063232
s_add_u32 m0, s51, 65536
s_nop 0
buffer_load_dwordx4 v25, s[28:31], s38 offen lds
s_add_u32 m0, s51, 66560
s_add_u32 s38, s38, 16384
buffer_load_dwordx4 v25, s[28:31], s38 offen lds
s_waitcnt vmcnt(18)
s_barrier
s_cmp_eq_u32 s47, 3
s_cbranch_scc0 Lw_135
s_lshl_b32 s92, s2, 7
s_add_u32 s92, s92, 28327936
s_load_dword s93, s[82:83], s92 glc
Lw_135:
s_waitcnt vmcnt(12)
s_cmp_eq_u32 s47, 3
s_cbranch_scc0 Lw_136
s_mov_b32 s41, 0x40000
s_branch Lpchk_139
Lpoll_137:
s_load_dword s93, s[82:83], s92 glc
Lpchk_139:
s_waitcnt lgkmcnt(0)
s_cmp_eq_u32 s93, 1
s_cbranch_scc1 Lpok_138
s_sub_u32 s41, s41, 1
s_cmp_lg_u32 s41, 0
s_cbranch_scc1 Lpoll_137
Lpok_138:
Lw_136:
s_barrier
s_waitcnt vmcnt(6)
s_barrier
s_waitcnt vmcnt(0)
s_barrier
s_barrier
s_branch Ldone_1
Ldone_1:
Lfin:
Lexit_2:
s_endpgm
.fill 2304, 4, 0xbf800000
.section .rodata,"a"
.p2align 6
.amdhsa_kernel sequential_preLN__sliding_local_dilated__glu_gated_geglu__prompt_kernel
  .amdhsa_next_free_vgpr 256
  .amdhsa_next_free_sgpr 102
  .amdhsa_accum_offset 256
  .amdhsa_group_segment_fixed_size 0
  .amdhsa_kernarg_size 80
  .amdhsa_user_sgpr_count 2
  .amdhsa_user_sgpr_kernarg_segment_ptr 1
  .amdhsa_system_sgpr_workgroup_id_x 1
  .amdhsa_float_denorm_mode_32 3
  .amdhsa_float_denorm_mode_16_64 3
.end_amdhsa_kernel
```
